```python
import torch

def _softmax(x, axis=-1):
    return torch.softmax(x, dim=axis)

def _gelu(x):
    return torch.nn.functional.gelu(x, approximate='tanh')

def _silu(x):
    return torch.nn.functional.silu(x)

def _sigmoid(x):
    return torch.sigmoid(x)

def _layernorm(x, axis=-1, eps=1e-05):
    m = x.mean(dim=axis, keepdim=True)
    v = x.var(dim=axis, keepdim=True, unbiased=False)
    return (x - m) / torch.sqrt(v + eps)

def _scatter_add(tgt, idx, src, axis=0):
    return tgt.clone().index_add_(axis, idx, src)

def _segment_sum(src, seg, n):
    out = torch.zeros((n,) + src.shape[1:], dtype=src.dtype)
    return out.index_add_(0, seg, src)

def _pad(x, pw):
    flat = tuple((v for pair in reversed(pw) for v in pair))
    return torch.nn.functional.pad(x, flat)
kernel_name = 'adaLN_cond__memory_aug_recurrent_mem_tr__mixer_s_mlp__prompt'

def setup_inputs():

    _w = lambda a: (lambda t: t.to(torch.bfloat16) if t.is_floating_point() else t)(torch.as_tensor(a))

    def _A_setup():
        B, S, Dm = (1, 2048, 1024)
        H, Dh = (32, 128)
        M, seg = (8, 32)
        seg = min(seg, S)
        S = S // seg * seg
        return {'x': _w((lambda *s: torch.randn(*s, dtype=torch.bfloat16) * 0.05)(B, S, Dm)), 'mem0': _w((lambda *s: torch.randn(*s, dtype=torch.bfloat16) * 0.4)(B, M, Dm)), 'Wq': _w((lambda *s: torch.randn(*s, dtype=torch.bfloat16) * 3.2)(Dm, H, Dh) * Dm ** (-0.5)), 'Wk': _w((lambda *s: torch.randn(*s, dtype=torch.bfloat16) * 3.2)(Dm, H, Dh) * Dm ** (-0.5)), 'Wv': _w((lambda *s: torch.randn(*s, dtype=torch.bfloat16) * 0.4)(Dm, H, Dh) * Dm ** (-0.5)), 'Wo': _w((lambda *s: torch.randn(*s, dtype=torch.bfloat16) * 0.4)(H, Dh, Dm) * (H * Dh) ** (-0.5)), 'seg_len': seg}
    _A_in = _A_setup()

    def _B_setup():
        B, S, D, F = (1, 2048, 1024, 3584)
        return {'x': _w((lambda *s: torch.randn(*s, dtype=torch.bfloat16) * 0.05)(B, S, D)), 'w1': _w((lambda *s: torch.randn(*s, dtype=torch.bfloat16) * 3.2)(D, D) * D ** (-0.5)), 'w2': _w((lambda *s: torch.randn(*s, dtype=torch.bfloat16) * 3.2)(D, D) * D ** (-0.5)), 'w3': _w((lambda *s: torch.randn(*s, dtype=torch.bfloat16) * 3.2)(D, F) * D ** (-0.5)), 'w4': _w((lambda *s: torch.randn(*s, dtype=torch.bfloat16) * 3.2)(F, D) * F ** (-0.5))}
    _B_in = _B_setup()
    return {'A_x': _A_in['x'], 'A_mem0': _A_in['mem0'], 'A_Wq': _A_in['Wq'], 'A_Wk': _A_in['Wk'], 'A_Wv': _A_in['Wv'], 'A_Wo': _A_in['Wo'], 'A_seg_len': _A_in['seg_len'], 'B_x': _B_in['x'], 'B_w1': _B_in['w1'], 'B_w2': _B_in['w2'], 'B_w3': _B_in['w3'], 'B_w4': _B_in['w4'], 'c': _w((lambda *s: torch.randn(*s, dtype=torch.bfloat16) * 0.1)(1, 1024) * 8.0), 'w_mod': _w((lambda *s: torch.randn(*s, dtype=torch.bfloat16) * 0.1)(1024, 6 * 1024) * 1024 ** (-0.5) * 8.0)}

def reference(A_x, A_mem0, A_Wq, A_Wk, A_Wv, A_Wo, A_seg_len, B_x, B_w1, B_w2, B_w3, B_w4, c, w_mod):

    def _A_ref(x, mem0, Wq, Wk, Wv, Wo, seg_len):
        B, S, Dm = x.shape
        H, Dh = (Wq.shape[1], Wq.shape[2])
        M = mem0.shape[1]
        scale = Dh ** (-0.5)
        n_seg = S // seg_len
        L = M + seg_len
        idx = torch.arange(L)
        mask = (idx[:, None] < M) | (idx[:, None] >= idx[None, :])
        mem = mem0
        outs = []
        for s in range(n_seg):
            xs = x[:, s * seg_len:(s + 1) * seg_len, :].clone()
            h = torch.concatenate([mem, xs], axis=1)
            q = torch.einsum('btd,dhe->bhte', h, Wq)
            k = torch.einsum('btd,dhe->bhte', h, Wk)
            v = torch.einsum('btd,dhe->bhte', h, Wv)
            scores = torch.einsum('bhqe,bhke->bhqk', q, k) * scale
            scores = torch.where(mask[None, None], scores, -1000000000.0)
            p = _softmax(scores, axis=-1)
            o = torch.einsum('bhqk,bhke->bhqe', p, v)
            o = torch.einsum('bhte,hed->btd', o, Wo)
            mem = o[:, :M, :].clone()
            outs.append(o[:, M:, :])
        return torch.concatenate(outs, axis=1)

    def _B_ref(x, w1, w2, w3, w4):
        B, S, D = x.shape
        h = _gelu(_layernorm(x, axis=-1) @ w1)
        c = D // 4
        g0 = _pad(h[:, :, 0 * c:1 * c], ((0, 0), (1, 0), (0, 0)))[:, :S, :]
        g1 = _pad(h[:, :, 1 * c:2 * c], ((0, 0), (0, 1), (0, 0)))[:, 1:, :]
        g2 = _pad(h[:, :, 2 * c:3 * c], ((0, 0), (2, 0), (0, 0)))[:, :S, :]
        g3 = _pad(h[:, :, 3 * c:], ((0, 0), (0, 2), (0, 0)))[:, 2:, :]
        hs = torch.concatenate([g0, g1, g2, g3], axis=-1) @ w2
        x1 = x + hs
        h2 = _gelu(_layernorm(x1, axis=-1) @ w3) @ w4
        return x1 + h2
    x = A_x
    mod = (_silu(c) @ w_mod).reshape(c.shape[0], 6, 1, -1)
    sa, ca, ga, sb, cb, gb = (mod[:, 0].clone(), mod[:, 1].clone(), mod[:, 2].clone(), mod[:, 3].clone(), mod[:, 4].clone(), mod[:, 5].clone())
    h = _layernorm(x, axis=-1) * (1 + ca) + sa
    x = x + ga * _A_ref(h, A_mem0, A_Wq, A_Wk, A_Wv, A_Wo, A_seg_len)
    h = _layernorm(x, axis=-1) * (1 + cb) + sb
    x = x + gb * _B_ref(h, B_w1, B_w2, B_w3, B_w4)
    return x
```

```asm
; @launch kernel=mega_kernel grid=(256,1,1) block=(256,1,1) lds=163840
.amdgcn_target "amdgcn-amd-amdhsa--gfx950"
.text
.globl mega_kernel
.p2align 8
.type mega_kernel,@function
mega_kernel:
s_cmp_ge_u32 s2,256
s_cbranch_scc1 done_1
s_load_dwordx4 s[16:19],s[0:1],120
s_load_dword s3,s[0:1],0
s_getpc_b64 s[4:5]
pc_2:
s_sub_u32 s8,s4,pc_2-mega_kernel
s_subb_u32 s9,s5,0
s_and_b32 s9,s9,0xffff
s_mov_b32 s10,code_end-mega_kernel
s_mov_b32 s11,0x20000
v_lshlrev_b32 v180,7,v0
v_cmp_gt_u32 vcc,64,v0
s_cbranch_vccnz nocpf_3
buffer_load_dword v181,v180,s[8:11],0 offen
s_mov_b32 s12,0x8000
buffer_load_dword v182,v180,s[8:11],s12 offen
s_lshr_b32 s12,s2,3
s_and_b32 s12,s12,7
s_add_u32 s12,s12,2
s_lshl_b32 s12,s12,15
buffer_load_dword v183,v180,s[8:11],s12 offen
nocpf_3:
v_and_b32 v1,63,v0
v_lshrrev_b32 v2,6,v0
s_getreg_b32 s51,hwreg(HW_REG_XCC_ID)
v_readfirstlane_b32 s50,v2
s_and_b32 s51,s51,7
s_waitcnt lgkmcnt(0)
s_mov_b32 s20,s18
s_and_b32 s21,s19,0xffff
s_mov_b32 s22,0x10000000
s_mov_b32 s23,0x20000
s_mov_b32 s44,s16
s_and_b32 s45,s17,0xffff
s_mov_b32 s46,0x100
s_mov_b32 s47,0x20000
s_mov_b32 s90,400000
s_mov_b32 s91,s50
v_mov_b32 v187,158976
s_cmp_lg_u32 s50,0
s_cbranch_scc1 norole_4
s_mov_b64 exec,1
v_mov_b32 v184,1
v_mov_b32 v185,0
s_and_b32 s52,s51,3
s_lshl_b32 s52,s52,2
s_lshr_b32 s53,s51,2
s_lshl_b32 s53,s53,7
s_add_u32 s52,s52,s53
buffer_atomic_add v184,v185,s[44:47],s52 offen sc0 sc1
s_mov_b64 exec,-1
buffer_load_dword v181,v180,s[8:11],0 offen
s_mov_b32 s12,0x8000
buffer_load_dword v182,v180,s[8:11],s12 offen
s_lshr_b32 s12,s2,3
s_and_b32 s12,s12,7
s_add_u32 s12,s12,2
s_lshl_b32 s12,s12,15
buffer_load_dword v183,v180,s[8:11],s12 offen
s_mov_b64 exec,1
s_waitcnt vmcnt(3)
ds_write_b32 v187,v184
s_waitcnt lgkmcnt(0)
s_mov_b64 exec,-1
norole_4:
s_barrier
ds_read_b32 v186,v187
s_waitcnt lgkmcnt(0)
v_readfirstlane_b32 s54,v186
s_mov_b32 s56,2
s_lshl_b32 s57,s51,5
s_add_u32 s57,s57,s54
s_cmp_lt_u32 s54,32
s_cselect_b32 s57,s57,999
s_cmp_ge_u32 s57,256
s_cbranch_scc1 verify_6
s_cmp_ge_u32 s57,128
s_cbranch_scc1 pre_8
setup_5:
s_load_dwordx8 s[4:11],s[0:1],8
s_load_dwordx2 s[12:13],s[0:1],40
v_and_b32 v3,15,v1
v_lshrrev_b32 v4,4,v1
v_lshlrev_b32 v16,4,v1
v_lshrrev_b32 v30,2,v1
v_and_b32 v31,3,v1
v_lshlrev_b32 v7,13,v30
v_lshl_add_u32 v7,v31,4,v7
v_lshlrev_b32 v8,11,v30
v_lshl_add_u32 v8,v31,4,v8
s_lshr_b32 s58,s57,5
s_and_b32 s59,s57,31
s_lshl_b32 s60,s57,6
s_lshl_b32 s61,s50,14
s_lshl_b32 s62,s50,21
s_add_u32 s62,s62,s60
s_lshl_b32 s63,s58,21
s_lshl_b32 s64,s50,19
s_add_u32 s63,s63,s64
s_lshl_b32 s64,s59,6
s_add_u32 s63,s63,s64
s_waitcnt lgkmcnt(0)
s_mov_b32 s28,s8
s_and_b32 s29,s9,0xffff
s_mov_b32 s30,0x800000
s_mov_b32 s31,0x20000
s_mov_b32 s32,s10
s_and_b32 s33,s11,0xffff
s_mov_b32 s34,0x800000
s_mov_b32 s35,0x20000
s_mov_b32 s36,s6
s_and_b32 s37,s7,0xffff
s_mov_b32 s38,0x800000
s_mov_b32 s39,0x20000
s_mov_b32 s40,s12
s_and_b32 s41,s13,0xffff
s_mov_b32 s42,0x800000
s_mov_b32 s43,0x20000
s_mov_b32 s8,s4
s_and_b32 s9,s5,0xffff
s_mov_b32 s10,0x4000
s_mov_b32 s11,0x20000
v_lshlrev_b32 v9,7,v3
v_lshl_add_u32 v10,v4,11,v9
v_lshl_add_u32 v9,v4,13,v9
s_lshl_b32 s64,s59,2
s_add_u32 s64,s64,s50
s_lshl_b32 s65,s64,16
s_lshl_b32 s66,s58,11
s_add_u32 s65,s65,s66
s_lshl_b32 s66,s64,14
s_lshl_b32 s67,s58,21
s_add_u32 s66,s66,s67
s_add_u32 s64,s62,0
s_add_u32 m0,s61,0
s_nop 0
buffer_load_dwordx4 v7,s[28:31],s64 offen nt lds
s_add_u32 s64,s62,131072
s_add_u32 m0,s61,1024
s_nop 0
buffer_load_dwordx4 v7,s[28:31],s64 offen nt lds
s_add_u32 s64,s62,262144
s_add_u32 m0,s61,2048
s_nop 0
buffer_load_dwordx4 v7,s[28:31],s64 offen nt lds
s_add_u32 s64,s62,393216
s_add_u32 m0,s61,3072
s_nop 0
buffer_load_dwordx4 v7,s[28:31],s64 offen nt lds
s_add_u32 s64,s62,524288
s_add_u32 m0,s61,4096
s_nop 0
buffer_load_dwordx4 v7,s[28:31],s64 offen nt lds
s_add_u32 s64,s62,655360
s_add_u32 m0,s61,5120
s_nop 0
buffer_load_dwordx4 v7,s[28:31],s64 offen nt lds
s_add_u32 s64,s62,786432
s_add_u32 m0,s61,6144
s_nop 0
buffer_load_dwordx4 v7,s[28:31],s64 offen nt lds
s_add_u32 s64,s62,917504
s_add_u32 m0,s61,7168
s_nop 0
buffer_load_dwordx4 v7,s[28:31],s64 offen nt lds
s_add_u32 s64,s62,1048576
s_add_u32 m0,s61,8192
s_nop 0
buffer_load_dwordx4 v7,s[28:31],s64 offen nt lds
s_add_u32 s64,s62,1179648
s_add_u32 m0,s61,9216
s_nop 0
buffer_load_dwordx4 v7,s[28:31],s64 offen nt lds
s_add_u32 s64,s62,1310720
s_add_u32 m0,s61,10240
s_nop 0
buffer_load_dwordx4 v7,s[28:31],s64 offen nt lds
s_add_u32 s64,s62,1441792
s_add_u32 m0,s61,11264
s_nop 0
buffer_load_dwordx4 v7,s[28:31],s64 offen nt lds
s_add_u32 s64,s62,1572864
s_add_u32 m0,s61,12288
s_nop 0
buffer_load_dwordx4 v7,s[28:31],s64 offen nt lds
s_add_u32 s64,s62,1703936
s_add_u32 m0,s61,13312
s_nop 0
buffer_load_dwordx4 v7,s[28:31],s64 offen nt lds
s_add_u32 s64,s62,1835008
s_add_u32 m0,s61,14336
s_nop 0
buffer_load_dwordx4 v7,s[28:31],s64 offen nt lds
s_add_u32 s64,s62,1966080
s_add_u32 m0,s61,15360
s_nop 0
buffer_load_dwordx4 v7,s[28:31],s64 offen nt lds
s_add_u32 s64,s62,0
s_add_u32 m0,s61,65536
s_nop 0
buffer_load_dwordx4 v7,s[32:35],s64 offen nt lds
s_add_u32 s64,s62,131072
s_add_u32 m0,s61,66560
s_nop 0
buffer_load_dwordx4 v7,s[32:35],s64 offen nt lds
s_add_u32 s64,s62,262144
s_add_u32 m0,s61,67584
s_nop 0
buffer_load_dwordx4 v7,s[32:35],s64 offen nt lds
s_add_u32 s64,s62,393216
s_add_u32 m0,s61,68608
s_nop 0
buffer_load_dwordx4 v7,s[32:35],s64 offen nt lds
s_add_u32 s64,s62,524288
s_add_u32 m0,s61,69632
s_nop 0
buffer_load_dwordx4 v7,s[32:35],s64 offen nt lds
s_add_u32 s64,s62,655360
s_add_u32 m0,s61,70656
s_nop 0
buffer_load_dwordx4 v7,s[32:35],s64 offen nt lds
s_add_u32 s64,s62,786432
s_add_u32 m0,s61,71680
s_nop 0
buffer_load_dwordx4 v7,s[32:35],s64 offen nt lds
s_add_u32 s64,s62,917504
s_add_u32 m0,s61,72704
s_nop 0
buffer_load_dwordx4 v7,s[32:35],s64 offen nt lds
s_add_u32 s64,s62,1048576
s_add_u32 m0,s61,73728
s_nop 0
buffer_load_dwordx4 v7,s[32:35],s64 offen nt lds
s_add_u32 s64,s62,1179648
s_add_u32 m0,s61,74752
s_nop 0
buffer_load_dwordx4 v7,s[32:35],s64 offen nt lds
s_add_u32 s64,s62,1310720
s_add_u32 m0,s61,75776
s_nop 0
buffer_load_dwordx4 v7,s[32:35],s64 offen nt lds
s_add_u32 s64,s62,1441792
s_add_u32 m0,s61,76800
s_nop 0
buffer_load_dwordx4 v7,s[32:35],s64 offen nt lds
s_add_u32 s64,s62,1572864
s_add_u32 m0,s61,77824
s_nop 0
buffer_load_dwordx4 v7,s[32:35],s64 offen nt lds
s_add_u32 s64,s62,1703936
s_add_u32 m0,s61,78848
s_nop 0
buffer_load_dwordx4 v7,s[32:35],s64 offen nt lds
s_add_u32 s64,s62,1835008
s_add_u32 m0,s61,79872
s_nop 0
buffer_load_dwordx4 v7,s[32:35],s64 offen nt lds
s_add_u32 s64,s62,1966080
s_add_u32 m0,s61,80896
s_nop 0
buffer_load_dwordx4 v7,s[32:35],s64 offen nt lds
v_lshrrev_b32 v184,3,v3
v_bfe_u32 v185,v3,2,1
v_lshrrev_b32 v186,1,v4
v_and_b32 v187,1,v4
v_lshl_add_u32 v188,v184,3,v185
v_lshl_add_u32 v188,v186,4,v188
v_lshl_add_u32 v188,v187,2,v188
v_lshl_add_u32 v189,v184,2,v185
v_lshl_add_u32 v189,v186,3,v189
v_lshl_add_u32 v189,v187,4,v189
v_and_b32 v187,3,v3
v_lshlrev_b32 v187,3,v187
v_lshl_add_u32 v188,v188,6,v187
v_lshl_add_u32 v189,v189,6,v187
s_lshr_b32 s64,s50,1
s_lshl_b32 s64,s64,5
v_add_u32 v190,s64,v188
v_add_u32 v191,0x10000,v190
s_lshl_b32 s64,s64,10
s_add_u32 s64,s64,0x10000
v_add_u32 v192,s64,v189
s_add_u32 s68,s50,1
s_mov_b32 s69,0
s_waitcnt vmcnt(16)
s_barrier
s_bitcmp1_b32 s68,1
s_cbranch_scc0 ws_11
rq_14:
ds_read_b64_tr_b16 a[0:1],v190 offset:0
ds_read_b64_tr_b16 a[2:3],v190 offset:128
ds_read_b64_tr_b16 a[4:5],v190 offset:2048
ds_read_b64_tr_b16 a[6:7],v190 offset:2176
ds_read_b64_tr_b16 a[8:9],v190 offset:4096
ds_read_b64_tr_b16 a[10:11],v190 offset:4224
ds_read_b64_tr_b16 a[12:13],v190 offset:6144
ds_read_b64_tr_b16 a[14:15],v190 offset:6272
s_waitcnt lgkmcnt(0)
ds_read_b64_tr_b16 a[16:17],v190 offset:8192
ds_read_b64_tr_b16 a[18:19],v190 offset:8320
ds_read_b64_tr_b16 a[20:21],v190 offset:10240
ds_read_b64_tr_b16 a[22:23],v190 offset:10368
ds_read_b64_tr_b16 a[24:25],v190 offset:12288
ds_read_b64_tr_b16 a[26:27],v190 offset:12416
ds_read_b64_tr_b16 a[28:29],v190 offset:14336
ds_read_b64_tr_b16 a[30:31],v190 offset:14464
s_waitcnt lgkmcnt(0)
ds_read_b64_tr_b16 a[32:33],v190 offset:16384
ds_read_b64_tr_b16 a[34:35],v190 offset:16512
ds_read_b64_tr_b16 a[36:37],v190 offset:18432
ds_read_b64_tr_b16 a[38:39],v190 offset:18560
ds_read_b64_tr_b16 a[40:41],v190 offset:20480
ds_read_b64_tr_b16 a[42:43],v190 offset:20608
ds_read_b64_tr_b16 a[44:45],v190 offset:22528
ds_read_b64_tr_b16 a[46:47],v190 offset:22656
s_waitcnt lgkmcnt(0)
ds_read_b64_tr_b16 a[48:49],v190 offset:24576
ds_read_b64_tr_b16 a[50:51],v190 offset:24704
ds_read_b64_tr_b16 a[52:53],v190 offset:26624
ds_read_b64_tr_b16 a[54:55],v190 offset:26752
ds_read_b64_tr_b16 a[56:57],v190 offset:28672
ds_read_b64_tr_b16 a[58:59],v190 offset:28800
ds_read_b64_tr_b16 a[60:61],v190 offset:30720
ds_read_b64_tr_b16 a[62:63],v190 offset:30848
s_waitcnt lgkmcnt(0)
ds_read_b64_tr_b16 a[64:65],v190 offset:32768
ds_read_b64_tr_b16 a[66:67],v190 offset:32896
ds_read_b64_tr_b16 a[68:69],v190 offset:34816
ds_read_b64_tr_b16 a[70:71],v190 offset:34944
ds_read_b64_tr_b16 a[72:73],v190 offset:36864
ds_read_b64_tr_b16 a[74:75],v190 offset:36992
ds_read_b64_tr_b16 a[76:77],v190 offset:38912
ds_read_b64_tr_b16 a[78:79],v190 offset:39040
s_waitcnt lgkmcnt(0)
ds_read_b64_tr_b16 a[80:81],v190 offset:40960
ds_read_b64_tr_b16 a[82:83],v190 offset:41088
ds_read_b64_tr_b16 a[84:85],v190 offset:43008
ds_read_b64_tr_b16 a[86:87],v190 offset:43136
ds_read_b64_tr_b16 a[88:89],v190 offset:45056
ds_read_b64_tr_b16 a[90:91],v190 offset:45184
ds_read_b64_tr_b16 a[92:93],v190 offset:47104
ds_read_b64_tr_b16 a[94:95],v190 offset:47232
s_waitcnt lgkmcnt(0)
ds_read_b64_tr_b16 a[96:97],v190 offset:49152
ds_read_b64_tr_b16 a[98:99],v190 offset:49280
ds_read_b64_tr_b16 a[100:101],v190 offset:51200
ds_read_b64_tr_b16 a[102:103],v190 offset:51328
ds_read_b64_tr_b16 a[104:105],v190 offset:53248
ds_read_b64_tr_b16 a[106:107],v190 offset:53376
ds_read_b64_tr_b16 a[108:109],v190 offset:55296
ds_read_b64_tr_b16 a[110:111],v190 offset:55424
s_waitcnt lgkmcnt(0)
ds_read_b64_tr_b16 a[112:113],v190 offset:57344
ds_read_b64_tr_b16 a[114:115],v190 offset:57472
ds_read_b64_tr_b16 a[116:117],v190 offset:59392
ds_read_b64_tr_b16 a[118:119],v190 offset:59520
ds_read_b64_tr_b16 a[120:121],v190 offset:61440
ds_read_b64_tr_b16 a[122:123],v190 offset:61568
ds_read_b64_tr_b16 a[124:125],v190 offset:63488
ds_read_b64_tr_b16 a[126:127],v190 offset:63616
s_waitcnt lgkmcnt(0)
s_cmp_lg_u32 s69,0
s_cbranch_scc1 rqb_15
ws_11:
s_waitcnt vmcnt(0)
s_barrier
s_add_u32 s64,s62,0
s_add_u32 m0,s61,0
s_nop 0
buffer_load_dwordx4 v7,s[36:39],s64 offen nt lds
s_add_u32 s64,s62,131072
s_add_u32 m0,s61,1024
s_nop 0
buffer_load_dwordx4 v7,s[36:39],s64 offen nt lds
s_add_u32 s64,s62,262144
s_add_u32 m0,s61,2048
s_nop 0
buffer_load_dwordx4 v7,s[36:39],s64 offen nt lds
s_add_u32 s64,s62,393216
s_add_u32 m0,s61,3072
s_nop 0
buffer_load_dwordx4 v7,s[36:39],s64 offen nt lds
s_add_u32 s64,s62,524288
s_add_u32 m0,s61,4096
s_nop 0
buffer_load_dwordx4 v7,s[36:39],s64 offen nt lds
s_add_u32 s64,s62,655360
s_add_u32 m0,s61,5120
s_nop 0
buffer_load_dwordx4 v7,s[36:39],s64 offen nt lds
s_add_u32 s64,s62,786432
s_add_u32 m0,s61,6144
s_nop 0
buffer_load_dwordx4 v7,s[36:39],s64 offen nt lds
s_add_u32 s64,s62,917504
s_add_u32 m0,s61,7168
s_nop 0
buffer_load_dwordx4 v7,s[36:39],s64 offen nt lds
s_add_u32 s64,s62,1048576
s_add_u32 m0,s61,8192
s_nop 0
buffer_load_dwordx4 v7,s[36:39],s64 offen nt lds
s_add_u32 s64,s62,1179648
s_add_u32 m0,s61,9216
s_nop 0
buffer_load_dwordx4 v7,s[36:39],s64 offen nt lds
s_add_u32 s64,s62,1310720
s_add_u32 m0,s61,10240
s_nop 0
buffer_load_dwordx4 v7,s[36:39],s64 offen nt lds
s_add_u32 s64,s62,1441792
s_add_u32 m0,s61,11264
s_nop 0
buffer_load_dwordx4 v7,s[36:39],s64 offen nt lds
s_add_u32 s64,s62,1572864
s_add_u32 m0,s61,12288
s_nop 0
buffer_load_dwordx4 v7,s[36:39],s64 offen nt lds
s_add_u32 s64,s62,1703936
s_add_u32 m0,s61,13312
s_nop 0
buffer_load_dwordx4 v7,s[36:39],s64 offen nt lds
s_add_u32 s64,s62,1835008
s_add_u32 m0,s61,14336
s_nop 0
buffer_load_dwordx4 v7,s[36:39],s64 offen nt lds
s_add_u32 s64,s62,1966080
s_add_u32 m0,s61,15360
s_nop 0
buffer_load_dwordx4 v7,s[36:39],s64 offen nt lds
s_bitcmp1_b32 s68,1
s_cbranch_scc0 ws_12
ds_read_b64_tr_b16 a[128:129],v191 offset:0
ds_read_b64_tr_b16 a[130:131],v191 offset:128
ds_read_b64_tr_b16 a[132:133],v191 offset:2048
ds_read_b64_tr_b16 a[134:135],v191 offset:2176
ds_read_b64_tr_b16 a[136:137],v191 offset:4096
ds_read_b64_tr_b16 a[138:139],v191 offset:4224
ds_read_b64_tr_b16 a[140:141],v191 offset:6144
ds_read_b64_tr_b16 a[142:143],v191 offset:6272
s_waitcnt lgkmcnt(0)
ds_read_b64_tr_b16 a[144:145],v191 offset:8192
ds_read_b64_tr_b16 a[146:147],v191 offset:8320
ds_read_b64_tr_b16 a[148:149],v191 offset:10240
ds_read_b64_tr_b16 a[150:151],v191 offset:10368
ds_read_b64_tr_b16 a[152:153],v191 offset:12288
ds_read_b64_tr_b16 a[154:155],v191 offset:12416
ds_read_b64_tr_b16 a[156:157],v191 offset:14336
ds_read_b64_tr_b16 a[158:159],v191 offset:14464
s_waitcnt lgkmcnt(0)
ds_read_b64_tr_b16 a[160:161],v191 offset:16384
ds_read_b64_tr_b16 a[162:163],v191 offset:16512
ds_read_b64_tr_b16 a[164:165],v191 offset:18432
ds_read_b64_tr_b16 a[166:167],v191 offset:18560
ds_read_b64_tr_b16 a[168:169],v191 offset:20480
ds_read_b64_tr_b16 a[170:171],v191 offset:20608
ds_read_b64_tr_b16 a[172:173],v191 offset:22528
ds_read_b64_tr_b16 a[174:175],v191 offset:22656
s_waitcnt lgkmcnt(0)
ds_read_b64_tr_b16 a[176:177],v191 offset:24576
ds_read_b64_tr_b16 a[178:179],v191 offset:24704
ds_read_b64_tr_b16 a[180:181],v191 offset:26624
ds_read_b64_tr_b16 a[182:183],v191 offset:26752
ds_read_b64_tr_b16 a[184:185],v191 offset:28672
ds_read_b64_tr_b16 a[186:187],v191 offset:28800
ds_read_b64_tr_b16 a[188:189],v191 offset:30720
ds_read_b64_tr_b16 a[190:191],v191 offset:30848
s_waitcnt lgkmcnt(0)
ds_read_b64_tr_b16 a[192:193],v191 offset:32768
ds_read_b64_tr_b16 a[194:195],v191 offset:32896
ds_read_b64_tr_b16 a[196:197],v191 offset:34816
ds_read_b64_tr_b16 a[198:199],v191 offset:34944
ds_read_b64_tr_b16 a[200:201],v191 offset:36864
ds_read_b64_tr_b16 a[202:203],v191 offset:36992
ds_read_b64_tr_b16 a[204:205],v191 offset:38912
ds_read_b64_tr_b16 a[206:207],v191 offset:39040
s_waitcnt lgkmcnt(0)
ds_read_b64_tr_b16 a[208:209],v191 offset:40960
ds_read_b64_tr_b16 a[210:211],v191 offset:41088
ds_read_b64_tr_b16 a[212:213],v191 offset:43008
ds_read_b64_tr_b16 a[214:215],v191 offset:43136
ds_read_b64_tr_b16 a[216:217],v191 offset:45056
ds_read_b64_tr_b16 a[218:219],v191 offset:45184
ds_read_b64_tr_b16 a[220:221],v191 offset:47104
ds_read_b64_tr_b16 a[222:223],v191 offset:47232
s_waitcnt lgkmcnt(0)
ds_read_b64_tr_b16 a[224:225],v191 offset:49152
ds_read_b64_tr_b16 a[226:227],v191 offset:49280
ds_read_b64_tr_b16 a[228:229],v191 offset:51200
ds_read_b64_tr_b16 a[230:231],v191 offset:51328
ds_read_b64_tr_b16 a[232:233],v191 offset:53248
ds_read_b64_tr_b16 a[234:235],v191 offset:53376
ds_read_b64_tr_b16 a[236:237],v191 offset:55296
ds_read_b64_tr_b16 a[238:239],v191 offset:55424
s_waitcnt lgkmcnt(0)
ds_read_b64_tr_b16 a[240:241],v191 offset:57344
ds_read_b64_tr_b16 a[242:243],v191 offset:57472
ds_read_b64_tr_b16 a[244:245],v191 offset:59392
ds_read_b64_tr_b16 a[246:247],v191 offset:59520
ds_read_b64_tr_b16 a[248:249],v191 offset:61440
ds_read_b64_tr_b16 a[250:251],v191 offset:61568
ds_read_b64_tr_b16 a[252:253],v191 offset:63488
ds_read_b64_tr_b16 a[254:255],v191 offset:63616
s_waitcnt lgkmcnt(0)
ws_12:
s_barrier
s_add_u32 s64,s63,0
s_add_u32 m0,s61,65536
s_nop 0
buffer_load_dwordx4 v8,s[40:43],s64 offen nt lds
s_add_u32 s64,s63,32768
s_add_u32 m0,s61,66560
s_nop 0
buffer_load_dwordx4 v8,s[40:43],s64 offen nt lds
s_add_u32 s64,s63,65536
s_add_u32 m0,s61,67584
s_nop 0
buffer_load_dwordx4 v8,s[40:43],s64 offen nt lds
s_add_u32 s64,s63,98304
s_add_u32 m0,s61,68608
s_nop 0
buffer_load_dwordx4 v8,s[40:43],s64 offen nt lds
s_add_u32 s64,s63,131072
s_add_u32 m0,s61,69632
s_nop 0
buffer_load_dwordx4 v8,s[40:43],s64 offen nt lds
s_add_u32 s64,s63,163840
s_add_u32 m0,s61,70656
s_nop 0
buffer_load_dwordx4 v8,s[40:43],s64 offen nt lds
s_add_u32 s64,s63,196608
s_add_u32 m0,s61,71680
s_nop 0
buffer_load_dwordx4 v8,s[40:43],s64 offen nt lds
s_add_u32 s64,s63,229376
s_add_u32 m0,s61,72704
s_nop 0
buffer_load_dwordx4 v8,s[40:43],s64 offen nt lds
s_add_u32 s64,s63,262144
s_add_u32 m0,s61,73728
s_nop 0
buffer_load_dwordx4 v8,s[40:43],s64 offen nt lds
s_add_u32 s64,s63,294912
s_add_u32 m0,s61,74752
s_nop 0
buffer_load_dwordx4 v8,s[40:43],s64 offen nt lds
s_add_u32 s64,s63,327680
s_add_u32 m0,s61,75776
s_nop 0
buffer_load_dwordx4 v8,s[40:43],s64 offen nt lds
s_add_u32 s64,s63,360448
s_add_u32 m0,s61,76800
s_nop 0
buffer_load_dwordx4 v8,s[40:43],s64 offen nt lds
s_add_u32 s64,s63,393216
s_add_u32 m0,s61,77824
s_nop 0
buffer_load_dwordx4 v8,s[40:43],s64 offen nt lds
s_add_u32 s64,s63,425984
s_add_u32 m0,s61,78848
s_nop 0
buffer_load_dwordx4 v8,s[40:43],s64 offen nt lds
s_add_u32 s64,s63,458752
s_add_u32 m0,s61,79872
s_nop 0
buffer_load_dwordx4 v8,s[40:43],s64 offen nt lds
s_add_u32 s64,s63,491520
s_add_u32 m0,s61,80896
s_nop 0
buffer_load_dwordx4 v8,s[40:43],s64 offen nt lds
s_mov_b32 s69,1
s_waitcnt vmcnt(16)
s_barrier
s_bitcmp1_b32 s68,1
s_cbranch_scc0 rq_14
rqb_15:
s_waitcnt vmcnt(0)
s_barrier
s_bitcmp1_b32 s68,1
s_cbranch_scc1 ws_13
ds_read_b64_tr_b16 a[128:129],v192 offset:0
ds_read_b64_tr_b16 a[130:131],v192 offset:128
ds_read_b64_tr_b16 a[132:133],v192 offset:2048
ds_read_b64_tr_b16 a[134:135],v192 offset:2176
ds_read_b64_tr_b16 a[136:137],v192 offset:32
ds_read_b64_tr_b16 a[138:139],v192 offset:160
ds_read_b64_tr_b16 a[140:141],v192 offset:2080
ds_read_b64_tr_b16 a[142:143],v192 offset:2208
s_waitcnt lgkmcnt(0)
ds_read_b64_tr_b16 a[144:145],v192 offset:4096
ds_read_b64_tr_b16 a[146:147],v192 offset:4224
ds_read_b64_tr_b16 a[148:149],v192 offset:6144
ds_read_b64_tr_b16 a[150:151],v192 offset:6272
ds_read_b64_tr_b16 a[152:153],v192 offset:4128
ds_read_b64_tr_b16 a[154:155],v192 offset:4256
ds_read_b64_tr_b16 a[156:157],v192 offset:6176
ds_read_b64_tr_b16 a[158:159],v192 offset:6304
s_waitcnt lgkmcnt(0)
ds_read_b64_tr_b16 a[160:161],v192 offset:8192
ds_read_b64_tr_b16 a[162:163],v192 offset:8320
ds_read_b64_tr_b16 a[164:165],v192 offset:10240
ds_read_b64_tr_b16 a[166:167],v192 offset:10368
ds_read_b64_tr_b16 a[168:169],v192 offset:8224
ds_read_b64_tr_b16 a[170:171],v192 offset:8352
ds_read_b64_tr_b16 a[172:173],v192 offset:10272
ds_read_b64_tr_b16 a[174:175],v192 offset:10400
s_waitcnt lgkmcnt(0)
ds_read_b64_tr_b16 a[176:177],v192 offset:12288
ds_read_b64_tr_b16 a[178:179],v192 offset:12416
ds_read_b64_tr_b16 a[180:181],v192 offset:14336
ds_read_b64_tr_b16 a[182:183],v192 offset:14464
ds_read_b64_tr_b16 a[184:185],v192 offset:12320
ds_read_b64_tr_b16 a[186:187],v192 offset:12448
ds_read_b64_tr_b16 a[188:189],v192 offset:14368
ds_read_b64_tr_b16 a[190:191],v192 offset:14496
s_waitcnt lgkmcnt(0)
ds_read_b64_tr_b16 a[192:193],v192 offset:16384
ds_read_b64_tr_b16 a[194:195],v192 offset:16512
ds_read_b64_tr_b16 a[196:197],v192 offset:18432
ds_read_b64_tr_b16 a[198:199],v192 offset:18560
ds_read_b64_tr_b16 a[200:201],v192 offset:16416
ds_read_b64_tr_b16 a[202:203],v192 offset:16544
ds_read_b64_tr_b16 a[204:205],v192 offset:18464
ds_read_b64_tr_b16 a[206:207],v192 offset:18592
s_waitcnt lgkmcnt(0)
ds_read_b64_tr_b16 a[208:209],v192 offset:20480
ds_read_b64_tr_b16 a[210:211],v192 offset:20608
ds_read_b64_tr_b16 a[212:213],v192 offset:22528
ds_read_b64_tr_b16 a[214:215],v192 offset:22656
ds_read_b64_tr_b16 a[216:217],v192 offset:20512
ds_read_b64_tr_b16 a[218:219],v192 offset:20640
ds_read_b64_tr_b16 a[220:221],v192 offset:22560
ds_read_b64_tr_b16 a[222:223],v192 offset:22688
s_waitcnt lgkmcnt(0)
ds_read_b64_tr_b16 a[224:225],v192 offset:24576
ds_read_b64_tr_b16 a[226:227],v192 offset:24704
ds_read_b64_tr_b16 a[228:229],v192 offset:26624
ds_read_b64_tr_b16 a[230:231],v192 offset:26752
ds_read_b64_tr_b16 a[232:233],v192 offset:24608
ds_read_b64_tr_b16 a[234:235],v192 offset:24736
ds_read_b64_tr_b16 a[236:237],v192 offset:26656
ds_read_b64_tr_b16 a[238:239],v192 offset:26784
s_waitcnt lgkmcnt(0)
ds_read_b64_tr_b16 a[240:241],v192 offset:28672
ds_read_b64_tr_b16 a[242:243],v192 offset:28800
ds_read_b64_tr_b16 a[244:245],v192 offset:30720
ds_read_b64_tr_b16 a[246:247],v192 offset:30848
ds_read_b64_tr_b16 a[248:249],v192 offset:28704
ds_read_b64_tr_b16 a[250:251],v192 offset:28832
ds_read_b64_tr_b16 a[252:253],v192 offset:30752
ds_read_b64_tr_b16 a[254:255],v192 offset:30880
s_waitcnt lgkmcnt(0)
ws_13:
s_barrier
s_mov_b32 s61,0
s_cmp_eq_u32 s56,1
s_cbranch_scc1 loops_7
v_mov_b32 v187,158976
s_cmp_lg_u32 s50,0
s_cbranch_scc1 sh0_16
v_and_b32 v184,3,v1
v_bfe_u32 v185,v1,2,1
v_lshlrev_b32 v184,2,v184
v_lshl_add_u32 v184,v185,7,v184
v_writelane_b32 v184,32,8
s_mov_b64 exec,0x1ff
vpoll_17:
buffer_load_dword v185,v184,s[44:47],0 offen sc1
s_waitcnt vmcnt(0)
v_readlane_b32 s92,v185,0
v_readlane_b32 s93,v185,1
v_readlane_b32 s94,v185,2
v_readlane_b32 s95,v185,3
v_readlane_b32 s96,v185,4
v_readlane_b32 s97,v185,5
v_readlane_b32 s98,v185,6
v_readlane_b32 s99,v185,7
v_readlane_b32 s61,v185,8
s_add_u32 s64,s92,s93
s_add_u32 s64,s64,s94
s_add_u32 s64,s64,s95
s_add_u32 s64,s64,s96
s_add_u32 s64,s64,s97
s_add_u32 s64,s64,s98
s_add_u32 s64,s64,s99
s_min_u32 s65,s92,s93
s_min_u32 s66,s94,s95
s_min_u32 s65,s65,s66
s_min_u32 s66,s96,s97
s_min_u32 s65,s65,s66
s_min_u32 s66,s98,s99
s_min_u32 s65,s65,s66
s_cmp_lt_u32 s65,32
s_cselect_b32 s65,1,0
s_cmp_lt_u32 s64,256
s_cbranch_scc1 vslp_19
s_or_b32 s66,s65,s61
s_cmp_lg_u32 s66,0
s_cbranch_scc1 vgot_18
vslp_19:
s_sleep 8
s_sub_u32 s90,s90,1
s_cmp_gt_i32 s90,0
s_cbranch_scc1 vpoll_17
vgot_18:
s_mov_b64 exec,-1
s_and_b32 s61,s61,1
s_lshl_b32 s61,s61,13
s_mov_b32 s66,s54
s_cmp_gt_u32 s51,0
s_cselect_b32 s64,s92,0
s_add_u32 s66,s66,s64
s_cmp_gt_u32 s51,1
s_cselect_b32 s64,s93,0
s_add_u32 s66,s66,s64
s_cmp_gt_u32 s51,2
s_cselect_b32 s64,s94,0
s_add_u32 s66,s66,s64
s_cmp_gt_u32 s51,3
s_cselect_b32 s64,s95,0
s_add_u32 s66,s66,s64
s_cmp_gt_u32 s51,4
s_cselect_b32 s64,s96,0
s_add_u32 s66,s66,s64
s_cmp_gt_u32 s51,5
s_cselect_b32 s64,s97,0
s_add_u32 s66,s66,s64
s_cmp_gt_u32 s51,6
s_cselect_b32 s64,s98,0
s_add_u32 s66,s66,s64
v_mov_b32 v184,s65
v_mov_b32 v185,s66
v_mov_b32 v186,s61
ds_write_b96 v187,v[184:186] offset:16
s_waitcnt lgkmcnt(0)
sh0_16:
s_barrier
ds_read_b96 v[184:186],v187 offset:16
s_waitcnt lgkmcnt(0)
v_readfirstlane_b32 s65,v184
v_readfirstlane_b32 s66,v185
v_readfirstlane_b32 s61,v186
s_cmp_lg_u32 s65,0
s_cbranch_scc1 slowrole_10
s_mov_b32 s56,0
s_branch loops_7
pre_8:
s_sub_u32 s55,s57,128
s_load_dwordx4 s[4:7],s[0:1],96
s_load_dwordx2 s[8:9],s[0:1],0
v_and_b32 v1,63,v0
v_lshrrev_b32 v2,6,v0
v_and_b32 v3,7,v0
v_lshrrev_b32 v4,3,v0
v_mul_u32_u24 v5,12288,v4
v_lshl_add_u32 v5,v3,4,v5
v_lshlrev_b32 v6,1,v4
s_and_b32 s24,s55,31
s_lshr_b32 s25,s55,5
s_lshl_b32 s26,s24,7
s_mul_i32 s27,s25,3145728
s_add_u32 s26,s26,s27
s_lshl_b32 s27,s25,9
s_waitcnt lgkmcnt(0)
s_mov_b32 s12,s4
s_and_b32 s13,s5,0xffff
s_mov_b32 s14,0x800
s_mov_b32 s15,0x20000
s_mov_b32 s28,s6
s_and_b32 s29,s7,0xffff
s_mov_b32 s30,0xc00000
s_mov_b32 s31,0x20000
s_mov_b32 s32,s8
s_and_b32 s33,s9,0xffff
s_mov_b32 s34,0x400000
s_mov_b32 s35,0x20000
buffer_load_dwordx4 v[64:67],v5,s[28:31],s26 offen
s_add_u32 s26,s26,393216
buffer_load_dwordx4 v[68:71],v5,s[28:31],s26 offen
s_add_u32 s26,s26,393216
buffer_load_dwordx4 v[72:75],v5,s[28:31],s26 offen
s_add_u32 s26,s26,393216
buffer_load_dwordx4 v[76:79],v5,s[28:31],s26 offen
s_add_u32 s26,s26,393216
buffer_load_dwordx4 v[80:83],v5,s[28:31],s26 offen
s_add_u32 s26,s26,393216
buffer_load_dwordx4 v[84:87],v5,s[28:31],s26 offen
s_add_u32 s26,s26,393216
buffer_load_dwordx4 v[88:91],v5,s[28:31],s26 offen
s_add_u32 s26,s26,393216
buffer_load_dwordx4 v[92:95],v5,s[28:31],s26 offen
buffer_load_ushort v96,v6,s[12:15],s27 offen offset:0
buffer_load_ushort v97,v6,s[12:15],s27 offen offset:64
buffer_load_ushort v98,v6,s[12:15],s27 offen offset:128
buffer_load_ushort v99,v6,s[12:15],s27 offen offset:192
buffer_load_ushort v100,v6,s[12:15],s27 offen offset:256
buffer_load_ushort v101,v6,s[12:15],s27 offen offset:320
buffer_load_ushort v102,v6,s[12:15],s27 offen offset:384
buffer_load_ushort v103,v6,s[12:15],s27 offen offset:448
v_and_b32 v3,3,v1
v_lshrrev_b32 v4,2,v1
v_lshl_add_u32 v5,v2,2,v3
v_lshlrev_b32 v5,11,v5
v_lshl_add_u32 v5,v4,5,v5
s_lshl_b32 s36,s55,15
buffer_load_dwordx4 v[8:11],v5,s[32:35],s36 offen offset:0
buffer_load_dwordx4 v[12:15],v5,s[32:35],s36 offen offset:16
buffer_load_dwordx4 v[16:19],v5,s[32:35],s36 offen offset:512
buffer_load_dwordx4 v[20:23],v5,s[32:35],s36 offen offset:528
buffer_load_dwordx4 v[24:27],v5,s[32:35],s36 offen offset:1024
buffer_load_dwordx4 v[28:31],v5,s[32:35],s36 offen offset:1040
buffer_load_dwordx4 v[32:35],v5,s[32:35],s36 offen offset:1536
buffer_load_dwordx4 v[36:39],v5,s[32:35],s36 offen offset:1552
v_lshrrev_b32 v6,1,v4
v_lshlrev_b32 v6,11,v6
v_and_b32 v7,1,v4
v_lshl_add_u32 v6,v7,9,v6
v_and_b32 v7,1,v2
v_lshl_add_u32 v6,v7,10,v6
v_lshrrev_b32 v7,1,v2
v_lshl_add_u32 v7,v7,2,v3
v_lshl_add_u32 v6,v7,4,v6
v_lshlrev_b32 v4,6,v4
s_lshr_b32 s37,s55,1
s_lshl_b32 s37,s37,16
s_and_b32 s38,s55,1
s_lshl_b32 s38,s38,7
s_add_u32 s37,s37,s38
s_add_u32 s37,s37,57344
s_mov_b32 s38,0xbfb8aa3b
s_mov_b32 s39,0xffff0000
s_cmp_lg_u32 s50,1
s_cbranch_scc1 nz_20
s_lshl_b32 s40,s55,8
s_add_u32 s40,s40,21037056
s_lshr_b32 s41,s55,2
s_lshl_b32 s41,s41,11
s_and_b32 s42,s55,3
s_lshl_b32 s42,s42,8
s_add_u32 s41,s41,s42
s_add_u32 s42,s41,16965312
s_add_u32 s41,s41,12771072
v_mov_b32 v104,s40
v_mov_b32 v105,s41
v_cmp_gt_u32 vcc,16,v1
s_nop 1
v_cndmask_b32 v104,v105,v104,vcc
v_mov_b32 v105,s42
v_cmp_gt_u32 vcc,20,v1
s_nop 1
v_cndmask_b32 v104,v105,v104,vcc
v_lshl_add_u32 v104,v1,4,v104
s_lshl_b32 s41,s55,7
s_add_u32 s41,s41,21102592
v_writelane_b32 v104,s41,24
v_mov_b32 v108,0
v_mov_b32 v109,0
v_mov_b32 v110,0
v_mov_b32 v111,0
s_mov_b64 exec,0x1ffffff
buffer_store_dwordx4 v[108:111],v104,s[20:23],0 offen sc1
s_mov_b64 exec,-1
nz_20:
v_mov_b32 v112,0
v_mov_b32 v113,0
v_mov_b32 v114,0
v_mov_b32 v115,0
v_mov_b32 v116,0
v_mov_b32 v117,0
v_mov_b32 v118,0
v_mov_b32 v119,0
s_waitcnt vmcnt(8)
v_lshlrev_b32 v96,16,v96
v_mul_f32 v104,s38,v96
v_exp_f32 v104,v104
s_nop 0
v_add_f32 v104,1.0,v104
v_rcp_f32 v104,v104
s_nop 0
v_mul_f32 v104,v104,v96
v_cvt_pk_bf16_f32 v104,v104,v104
v_and_b32 v96,s39,v104
v_lshlrev_b32 v105,16,v64
v_and_b32 v106,s39,v64
v_fmac_f32 v112,v105,v96
v_fmac_f32 v113,v106,v96
v_lshlrev_b32 v105,16,v65
v_and_b32 v106,s39,v65
v_fmac_f32 v114,v105,v96
v_fmac_f32 v115,v106,v96
v_lshlrev_b32 v105,16,v66
v_and_b32 v106,s39,v66
v_fmac_f32 v116,v105,v96
v_fmac_f32 v117,v106,v96
v_lshlrev_b32 v105,16,v67
v_and_b32 v106,s39,v67
v_fmac_f32 v118,v105,v96
v_fmac_f32 v119,v106,v96
v_lshlrev_b32 v97,16,v97
v_mul_f32 v104,s38,v97
v_exp_f32 v104,v104
s_nop 0
v_add_f32 v104,1.0,v104
v_rcp_f32 v104,v104
s_nop 0
v_mul_f32 v104,v104,v97
v_cvt_pk_bf16_f32 v104,v104,v104
v_and_b32 v97,s39,v104
v_lshlrev_b32 v105,16,v68
v_and_b32 v106,s39,v68
v_fmac_f32 v112,v105,v97
v_fmac_f32 v113,v106,v97
v_lshlrev_b32 v105,16,v69
v_and_b32 v106,s39,v69
v_fmac_f32 v114,v105,v97
v_fmac_f32 v115,v106,v97
v_lshlrev_b32 v105,16,v70
v_and_b32 v106,s39,v70
v_fmac_f32 v116,v105,v97
v_fmac_f32 v117,v106,v97
v_lshlrev_b32 v105,16,v71
v_and_b32 v106,s39,v71
v_fmac_f32 v118,v105,v97
v_fmac_f32 v119,v106,v97
v_lshlrev_b32 v98,16,v98
v_mul_f32 v104,s38,v98
v_exp_f32 v104,v104
s_nop 0
v_add_f32 v104,1.0,v104
v_rcp_f32 v104,v104
s_nop 0
v_mul_f32 v104,v104,v98
v_cvt_pk_bf16_f32 v104,v104,v104
v_and_b32 v98,s39,v104
v_lshlrev_b32 v105,16,v72
v_and_b32 v106,s39,v72
v_fmac_f32 v112,v105,v98
v_fmac_f32 v113,v106,v98
v_lshlrev_b32 v105,16,v73
v_and_b32 v106,s39,v73
v_fmac_f32 v114,v105,v98
v_fmac_f32 v115,v106,v98
v_lshlrev_b32 v105,16,v74
v_and_b32 v106,s39,v74
v_fmac_f32 v116,v105,v98
v_fmac_f32 v117,v106,v98
v_lshlrev_b32 v105,16,v75
v_and_b32 v106,s39,v75
v_fmac_f32 v118,v105,v98
v_fmac_f32 v119,v106,v98
v_lshlrev_b32 v99,16,v99
v_mul_f32 v104,s38,v99
v_exp_f32 v104,v104
s_nop 0
v_add_f32 v104,1.0,v104
v_rcp_f32 v104,v104
s_nop 0
v_mul_f32 v104,v104,v99
v_cvt_pk_bf16_f32 v104,v104,v104
v_and_b32 v99,s39,v104
v_lshlrev_b32 v105,16,v76
v_and_b32 v106,s39,v76
v_fmac_f32 v112,v105,v99
v_fmac_f32 v113,v106,v99
v_lshlrev_b32 v105,16,v77
v_and_b32 v106,s39,v77
v_fmac_f32 v114,v105,v99
v_fmac_f32 v115,v106,v99
v_lshlrev_b32 v105,16,v78
v_and_b32 v106,s39,v78
v_fmac_f32 v116,v105,v99
v_fmac_f32 v117,v106,v99
v_lshlrev_b32 v105,16,v79
v_and_b32 v106,s39,v79
v_fmac_f32 v118,v105,v99
v_fmac_f32 v119,v106,v99
v_lshlrev_b32 v100,16,v100
v_mul_f32 v104,s38,v100
v_exp_f32 v104,v104
s_nop 0
v_add_f32 v104,1.0,v104
v_rcp_f32 v104,v104
s_nop 0
v_mul_f32 v104,v104,v100
v_cvt_pk_bf16_f32 v104,v104,v104
v_and_b32 v100,s39,v104
v_lshlrev_b32 v105,16,v80
v_and_b32 v106,s39,v80
v_fmac_f32 v112,v105,v100
v_fmac_f32 v113,v106,v100
v_lshlrev_b32 v105,16,v81
v_and_b32 v106,s39,v81
v_fmac_f32 v114,v105,v100
v_fmac_f32 v115,v106,v100
v_lshlrev_b32 v105,16,v82
v_and_b32 v106,s39,v82
v_fmac_f32 v116,v105,v100
v_fmac_f32 v117,v106,v100
v_lshlrev_b32 v105,16,v83
v_and_b32 v106,s39,v83
v_fmac_f32 v118,v105,v100
v_fmac_f32 v119,v106,v100
v_lshlrev_b32 v101,16,v101
v_mul_f32 v104,s38,v101
v_exp_f32 v104,v104
s_nop 0
v_add_f32 v104,1.0,v104
v_rcp_f32 v104,v104
s_nop 0
v_mul_f32 v104,v104,v101
v_cvt_pk_bf16_f32 v104,v104,v104
v_and_b32 v101,s39,v104
v_lshlrev_b32 v105,16,v84
v_and_b32 v106,s39,v84
v_fmac_f32 v112,v105,v101
v_fmac_f32 v113,v106,v101
v_lshlrev_b32 v105,16,v85
v_and_b32 v106,s39,v85
v_fmac_f32 v114,v105,v101
v_fmac_f32 v115,v106,v101
v_lshlrev_b32 v105,16,v86
v_and_b32 v106,s39,v86
v_fmac_f32 v116,v105,v101
v_fmac_f32 v117,v106,v101
v_lshlrev_b32 v105,16,v87
v_and_b32 v106,s39,v87
v_fmac_f32 v118,v105,v101
v_fmac_f32 v119,v106,v101
v_lshlrev_b32 v102,16,v102
v_mul_f32 v104,s38,v102
v_exp_f32 v104,v104
s_nop 0
v_add_f32 v104,1.0,v104
v_rcp_f32 v104,v104
s_nop 0
v_mul_f32 v104,v104,v102
v_cvt_pk_bf16_f32 v104,v104,v104
v_and_b32 v102,s39,v104
v_lshlrev_b32 v105,16,v88
v_and_b32 v106,s39,v88
v_fmac_f32 v112,v105,v102
v_fmac_f32 v113,v106,v102
v_lshlrev_b32 v105,16,v89
v_and_b32 v106,s39,v89
v_fmac_f32 v114,v105,v102
v_fmac_f32 v115,v106,v102
v_lshlrev_b32 v105,16,v90
v_and_b32 v106,s39,v90
v_fmac_f32 v116,v105,v102
v_fmac_f32 v117,v106,v102
v_lshlrev_b32 v105,16,v91
v_and_b32 v106,s39,v91
v_fmac_f32 v118,v105,v102
v_fmac_f32 v119,v106,v102
v_lshlrev_b32 v103,16,v103
v_mul_f32 v104,s38,v103
v_exp_f32 v104,v104
s_nop 0
v_add_f32 v104,1.0,v104
v_rcp_f32 v104,v104
s_nop 0
v_mul_f32 v104,v104,v103
v_cvt_pk_bf16_f32 v104,v104,v104
v_and_b32 v103,s39,v104
v_lshlrev_b32 v105,16,v92
v_and_b32 v106,s39,v92
v_fmac_f32 v112,v105,v103
v_fmac_f32 v113,v106,v103
v_lshlrev_b32 v105,16,v93
v_and_b32 v106,s39,v93
v_fmac_f32 v114,v105,v103
v_fmac_f32 v115,v106,v103
v_lshlrev_b32 v105,16,v94
v_and_b32 v106,s39,v94
v_fmac_f32 v116,v105,v103
v_fmac_f32 v117,v106,v103
v_lshlrev_b32 v105,16,v95
v_and_b32 v106,s39,v95
v_fmac_f32 v118,v105,v103
v_fmac_f32 v119,v106,v103
v_permlane32_swap_b32 v112,v116
v_permlane32_swap_b32 v113,v117
v_permlane32_swap_b32 v114,v118
v_permlane32_swap_b32 v115,v119
v_add_f32 v112,v112,v116
v_add_f32 v113,v113,v117
v_add_f32 v114,v114,v118
v_add_f32 v115,v115,v119
s_nop 0
v_permlane16_swap_b32 v112,v114
v_permlane16_swap_b32 v113,v115
v_add_f32 v112,v112,v114
v_add_f32 v113,v113,v115
s_nop 0
v_add_f32_dpp v112,v112,v112 row_ror:8 row_mask:0xf bank_mask:0xf
v_add_f32_dpp v113,v113,v113 row_ror:8 row_mask:0xf bank_mask:0xf
v_and_b32 v104,7,v1
v_lshlrev_b32 v104,5,v104
v_lshrrev_b32 v105,5,v1
v_lshl_add_u32 v104,v105,4,v104
v_bfe_u32 v105,v1,4,1
v_lshl_add_u32 v104,v105,3,v104
v_lshl_add_u32 v104,v2,8,v104
ds_write_b64 v104,v[112:113]
v_lshlrev_b32 v105,2,v1
s_lshl_b32 s40,s25,13
s_lshl_b32 s41,s24,8
s_add_u32 s40,s40,s41
s_add_u32 s40,s40,24576
s_waitcnt lgkmcnt(0)
s_barrier
s_cmp_lg_u32 s50,0
s_cbranch_scc1 m1n0_21
ds_read_b32 v112,v105 offset:0
ds_read_b32 v113,v105 offset:256
ds_read_b32 v114,v105 offset:512
ds_read_b32 v115,v105 offset:768
s_waitcnt lgkmcnt(0)
v_add_f32 v112,v112,v113
v_add_f32 v114,v114,v115
v_add_f32 v112,v112,v114
buffer_store_dword v112,v105,s[20:23],s40 offen sc1
m1n0_21:
s_waitcnt vmcnt(0)
s_barrier
s_cmp_lg_u32 s50,0
s_cbranch_scc1 post_9
s_mov_b64 exec,1
v_mov_b32 v184,1
v_mov_b32 v185,0
s_and_b32 s52,s56,1
s_lshl_b32 s52,s52,2
s_add_u32 s52,s52,160
buffer_atomic_add v184,v185,s[44:47],s52 offen sc0 sc1
s_waitcnt vmcnt(0)
v_readfirstlane_b32 s64,v184
s_mov_b64 exec,-1
s_cmp_eq_u32 s56,1
s_cbranch_scc1 post_9
s_cmp_lg_u32 s64,127
s_cbranch_scc1 post_9
v_and_b32 v184,3,v1
v_bfe_u32 v185,v1,2,1
v_lshlrev_b32 v184,2,v184
v_lshl_add_u32 v184,v185,7,v184
v_writelane_b32 v184,32,8
s_mov_b64 exec,0x1ff
vpoll_23:
buffer_load_dword v185,v184,s[44:47],0 offen sc1
s_waitcnt vmcnt(0)
v_readlane_b32 s92,v185,0
v_readlane_b32 s93,v185,1
v_readlane_b32 s94,v185,2
v_readlane_b32 s95,v185,3
v_readlane_b32 s96,v185,4
v_readlane_b32 s97,v185,5
v_readlane_b32 s98,v185,6
v_readlane_b32 s99,v185,7
v_readlane_b32 s61,v185,8
s_add_u32 s64,s92,s93
s_add_u32 s64,s64,s94
s_add_u32 s64,s64,s95
s_add_u32 s64,s64,s96
s_add_u32 s64,s64,s97
s_add_u32 s64,s64,s98
s_add_u32 s64,s64,s99
s_min_u32 s65,s92,s93
s_min_u32 s66,s94,s95
s_min_u32 s65,s65,s66
s_min_u32 s66,s96,s97
s_min_u32 s65,s65,s66
s_min_u32 s66,s98,s99
s_min_u32 s65,s65,s66
s_cmp_lt_u32 s65,32
s_cselect_b32 s65,1,0
s_cmp_lt_u32 s64,256
s_cbranch_scc1 vslp_25
s_branch vgot_24
vslp_25:
s_sleep 8
s_sub_u32 s90,s90,1
s_cmp_gt_i32 s90,0
s_cbranch_scc1 vpoll_23
vgot_24:
s_mov_b64 exec,-1
s_and_b32 s61,s61,1
s_lshl_b32 s61,s61,13
s_cmp_lg_u32 s65,0
s_cbranch_scc1 post_9
v_lshlrev_b32 v184,7,v1
v_mov_b32 v185,1
s_mov_b32 s64,21102592
s_mov_b32 s65,21110784
buffer_store_dword v185,v184,s[20:23],s64 offen sc1
buffer_store_dword v185,v184,s[20:23],s65 offen sc1
s_branch post_9
verify_6:
v_mov_b32 v187,158976
s_cmp_lg_u32 s50,0
s_cbranch_scc1 sh0_26
v_and_b32 v184,3,v1
v_bfe_u32 v185,v1,2,1
v_lshlrev_b32 v184,2,v184
v_lshl_add_u32 v184,v185,7,v184
v_writelane_b32 v184,32,8
s_mov_b64 exec,0x1ff
vpoll_27:
buffer_load_dword v185,v184,s[44:47],0 offen sc1
s_waitcnt vmcnt(0)
v_readlane_b32 s92,v185,0
v_readlane_b32 s93,v185,1
v_readlane_b32 s94,v185,2
v_readlane_b32 s95,v185,3
v_readlane_b32 s96,v185,4
v_readlane_b32 s97,v185,5
v_readlane_b32 s98,v185,6
v_readlane_b32 s99,v185,7
v_readlane_b32 s61,v185,8
s_add_u32 s64,s92,s93
s_add_u32 s64,s64,s94
s_add_u32 s64,s64,s95
s_add_u32 s64,s64,s96
s_add_u32 s64,s64,s97
s_add_u32 s64,s64,s98
s_add_u32 s64,s64,s99
s_min_u32 s65,s92,s93
s_min_u32 s66,s94,s95
s_min_u32 s65,s65,s66
s_min_u32 s66,s96,s97
s_min_u32 s65,s65,s66
s_min_u32 s66,s98,s99
s_min_u32 s65,s65,s66
s_cmp_lt_u32 s65,32
s_cselect_b32 s65,1,0
s_cmp_lt_u32 s64,256
s_cbranch_scc1 vslp_29
s_branch vgot_28
vslp_29:
s_sleep 8
s_sub_u32 s90,s90,1
s_cmp_gt_i32 s90,0
s_cbranch_scc1 vpoll_27
vgot_28:
s_mov_b64 exec,-1
s_and_b32 s61,s61,1
s_lshl_b32 s61,s61,13
s_mov_b32 s66,s54
s_cmp_gt_u32 s51,0
s_cselect_b32 s64,s92,0
s_add_u32 s66,s66,s64
s_cmp_gt_u32 s51,1
s_cselect_b32 s64,s93,0
s_add_u32 s66,s66,s64
s_cmp_gt_u32 s51,2
s_cselect_b32 s64,s94,0
s_add_u32 s66,s66,s64
s_cmp_gt_u32 s51,3
s_cselect_b32 s64,s95,0
s_add_u32 s66,s66,s64
s_cmp_gt_u32 s51,4
s_cselect_b32 s64,s96,0
s_add_u32 s66,s66,s64
s_cmp_gt_u32 s51,5
s_cselect_b32 s64,s97,0
s_add_u32 s66,s66,s64
s_cmp_gt_u32 s51,6
s_cselect_b32 s64,s98,0
s_add_u32 s66,s66,s64
v_mov_b32 v184,s65
v_mov_b32 v185,s66
v_mov_b32 v186,s61
ds_write_b96 v187,v[184:186] offset:16
s_waitcnt lgkmcnt(0)
sh0_26:
s_barrier
ds_read_b96 v[184:186],v187 offset:16
s_waitcnt lgkmcnt(0)
v_readfirstlane_b32 s65,v184
v_readfirstlane_b32 s66,v185
v_readfirstlane_b32 s61,v186
s_cmp_lg_u32 s65,0
s_cbranch_scc1 slowrole_10
s_mov_b32 s56,0
s_branch done_1
slowrole_10:
s_mov_b32 s57,s66
s_mov_b32 s56,1
s_waitcnt vmcnt(0)
s_barrier
s_cmp_ge_u32 s57,128
s_cbranch_scc1 pre_8
s_cmp_lg_u32 s50,0
s_cbranch_scc1 nadd_30
s_mov_b64 exec,1
v_mov_b32 v184,1
v_mov_b32 v185,0
s_mov_b32 s52,164
buffer_atomic_add v184,v185,s[44:47],s52 offen sc1
s_mov_b64 exec,-1
nadd_30:
s_branch setup_5
post_9:
s_sub_u32 s65,s57,255
s_and_b32 s66,s56,1
s_or_b32 s65,s65,s66
s_or_b32 s65,s65,s50
s_cmp_lg_u32 s65,0
s_cbranch_scc1 nomeas_31
s_mov_b64 exec,1
v_mov_b32 v184,0
s_mov_b32 s52,20971520
s_mov_b32 s53,20979712
s_mov_b32 s70,0x7fffffff
s_mov_b32 s71,0x7fffffff
s_memtime s[72:73]
s_waitcnt lgkmcnt(0)
buffer_store_dword v184,v184,s[20:23],s52 offen sc1
s_waitcnt vmcnt(0)
s_memtime s[74:75]
s_waitcnt lgkmcnt(0)
s_sub_u32 s74,s74,s72
s_min_u32 s70,s70,s74
s_memtime s[72:73]
s_waitcnt lgkmcnt(0)
buffer_store_dword v184,v184,s[20:23],s53 offen sc1
s_waitcnt vmcnt(0)
s_memtime s[74:75]
s_waitcnt lgkmcnt(0)
s_sub_u32 s74,s74,s72
s_min_u32 s71,s71,s74
s_memtime s[72:73]
s_waitcnt lgkmcnt(0)
buffer_store_dword v184,v184,s[20:23],s52 offen sc1
s_waitcnt vmcnt(0)
s_memtime s[74:75]
s_waitcnt lgkmcnt(0)
s_sub_u32 s74,s74,s72
s_min_u32 s70,s70,s74
s_memtime s[72:73]
s_waitcnt lgkmcnt(0)
buffer_store_dword v184,v184,s[20:23],s53 offen sc1
s_waitcnt vmcnt(0)
s_memtime s[74:75]
s_waitcnt lgkmcnt(0)
s_sub_u32 s74,s74,s72
s_min_u32 s71,s71,s74
s_memtime s[72:73]
s_waitcnt lgkmcnt(0)
buffer_store_dword v184,v184,s[20:23],s52 offen sc1
s_waitcnt vmcnt(0)
s_memtime s[74:75]
s_waitcnt lgkmcnt(0)
s_sub_u32 s74,s74,s72
s_min_u32 s70,s70,s74
s_memtime s[72:73]
s_waitcnt lgkmcnt(0)
buffer_store_dword v184,v184,s[20:23],s53 offen sc1
s_waitcnt vmcnt(0)
s_memtime s[74:75]
s_waitcnt lgkmcnt(0)
s_sub_u32 s74,s74,s72
s_min_u32 s71,s71,s74
s_memtime s[72:73]
s_waitcnt lgkmcnt(0)
buffer_store_dword v184,v184,s[20:23],s52 offen sc1
s_waitcnt vmcnt(0)
s_memtime s[74:75]
s_waitcnt lgkmcnt(0)
s_sub_u32 s74,s74,s72
s_min_u32 s70,s70,s74
s_memtime s[72:73]
s_waitcnt lgkmcnt(0)
buffer_store_dword v184,v184,s[20:23],s53 offen sc1
s_waitcnt vmcnt(0)
s_memtime s[74:75]
s_waitcnt lgkmcnt(0)
s_sub_u32 s74,s74,s72
s_min_u32 s71,s71,s74
s_cmp_gt_u32 s71,s70
s_cselect_b32 s65,3,2
v_mov_b32 v185,s65
buffer_store_dword v185,v184,s[44:47],32 offen sc1
s_mov_b64 exec,-1
nomeas_31:
v_and_b32 v103,s39,v39
v_lshlrev_b32 v102,16,v39
v_and_b32 v101,s39,v38
v_lshlrev_b32 v100,16,v38
v_and_b32 v99,s39,v37
v_lshlrev_b32 v98,16,v37
v_and_b32 v97,s39,v36
v_lshlrev_b32 v96,16,v36
v_and_b32 v95,s39,v35
v_lshlrev_b32 v94,16,v35
v_and_b32 v93,s39,v34
v_lshlrev_b32 v92,16,v34
v_and_b32 v91,s39,v33
v_lshlrev_b32 v90,16,v33
v_and_b32 v89,s39,v32
v_lshlrev_b32 v88,16,v32
v_and_b32 v87,s39,v31
v_lshlrev_b32 v86,16,v31
v_and_b32 v85,s39,v30
v_lshlrev_b32 v84,16,v30
v_and_b32 v83,s39,v29
v_lshlrev_b32 v82,16,v29
v_and_b32 v81,s39,v28
v_lshlrev_b32 v80,16,v28
v_and_b32 v79,s39,v27
v_lshlrev_b32 v78,16,v27
v_and_b32 v77,s39,v26
v_lshlrev_b32 v76,16,v26
v_and_b32 v75,s39,v25
v_lshlrev_b32 v74,16,v25
v_and_b32 v73,s39,v24
v_lshlrev_b32 v72,16,v24
v_and_b32 v71,s39,v23
v_lshlrev_b32 v70,16,v23
v_and_b32 v69,s39,v22
v_lshlrev_b32 v68,16,v22
v_and_b32 v67,s39,v21
v_lshlrev_b32 v66,16,v21
v_and_b32 v65,s39,v20
v_lshlrev_b32 v64,16,v20
v_and_b32 v63,s39,v19
v_lshlrev_b32 v62,16,v19
v_and_b32 v61,s39,v18
v_lshlrev_b32 v60,16,v18
v_and_b32 v59,s39,v17
v_lshlrev_b32 v58,16,v17
v_and_b32 v57,s39,v16
v_lshlrev_b32 v56,16,v16
v_and_b32 v55,s39,v15
v_lshlrev_b32 v54,16,v15
v_and_b32 v53,s39,v14
v_lshlrev_b32 v52,16,v14
v_and_b32 v51,s39,v13
v_lshlrev_b32 v50,16,v13
v_and_b32 v49,s39,v12
v_lshlrev_b32 v48,16,v12
v_and_b32 v47,s39,v11
v_lshlrev_b32 v46,16,v11
v_and_b32 v45,s39,v10
v_lshlrev_b32 v44,16,v10
v_and_b32 v43,s39,v9
v_lshlrev_b32 v42,16,v9
v_and_b32 v41,s39,v8
v_lshlrev_b32 v40,16,v8
v_pk_add_f32 v[8:9],v[40:41],v[42:43]
v_pk_add_f32 v[10:11],v[44:45],v[46:47]
v_pk_add_f32 v[8:9],v[8:9],v[48:49]
v_pk_add_f32 v[10:11],v[10:11],v[50:51]
v_pk_add_f32 v[8:9],v[8:9],v[52:53]
v_pk_add_f32 v[10:11],v[10:11],v[54:55]
v_pk_add_f32 v[8:9],v[8:9],v[56:57]
v_pk_add_f32 v[10:11],v[10:11],v[58:59]
v_pk_add_f32 v[8:9],v[8:9],v[60:61]
v_pk_add_f32 v[10:11],v[10:11],v[62:63]
v_pk_add_f32 v[8:9],v[8:9],v[64:65]
v_pk_add_f32 v[10:11],v[10:11],v[66:67]
v_pk_add_f32 v[8:9],v[8:9],v[68:69]
v_pk_add_f32 v[10:11],v[10:11],v[70:71]
v_pk_add_f32 v[8:9],v[8:9],v[72:73]
v_pk_add_f32 v[10:11],v[10:11],v[74:75]
v_pk_add_f32 v[8:9],v[8:9],v[76:77]
v_pk_add_f32 v[10:11],v[10:11],v[78:79]
v_pk_add_f32 v[8:9],v[8:9],v[80:81]
v_pk_add_f32 v[10:11],v[10:11],v[82:83]
v_pk_add_f32 v[8:9],v[8:9],v[84:85]
v_pk_add_f32 v[10:11],v[10:11],v[86:87]
v_pk_add_f32 v[8:9],v[8:9],v[88:89]
v_pk_add_f32 v[10:11],v[10:11],v[90:91]
v_pk_add_f32 v[8:9],v[8:9],v[92:93]
v_pk_add_f32 v[10:11],v[10:11],v[94:95]
v_pk_add_f32 v[8:9],v[8:9],v[96:97]
v_pk_add_f32 v[10:11],v[10:11],v[98:99]
v_pk_add_f32 v[8:9],v[8:9],v[100:101]
v_pk_add_f32 v[10:11],v[10:11],v[102:103]
v_pk_add_f32 v[8:9],v[8:9],v[10:11]
v_add_f32 v8,v8,v9
s_nop 1
v_add_f32_dpp v8,v8,v8 row_ror:4 row_mask:0xf bank_mask:0xf
s_nop 1
v_add_f32_dpp v8,v8,v8 row_ror:8 row_mask:0xf bank_mask:0xf
v_mov_b32 v12,v8
s_nop 1
v_permlane16_swap_b32 v12,v8
v_add_f32 v8,v8,v12
v_mov_b32 v12,v8
s_nop 1
v_permlane32_swap_b32 v12,v8
v_add_f32 v8,v8,v12
v_mul_f32 v8,0xba800000,v8
v_pk_add_f32 v[40:41],v[40:41],v[8:9] op_sel_hi:[1,0]
v_pk_add_f32 v[42:43],v[42:43],v[8:9] op_sel_hi:[1,0]
v_pk_add_f32 v[44:45],v[44:45],v[8:9] op_sel_hi:[1,0]
v_pk_add_f32 v[46:47],v[46:47],v[8:9] op_sel_hi:[1,0]
v_pk_add_f32 v[48:49],v[48:49],v[8:9] op_sel_hi:[1,0]
v_pk_add_f32 v[50:51],v[50:51],v[8:9] op_sel_hi:[1,0]
v_pk_add_f32 v[52:53],v[52:53],v[8:9] op_sel_hi:[1,0]
v_pk_add_f32 v[54:55],v[54:55],v[8:9] op_sel_hi:[1,0]
v_pk_add_f32 v[56:57],v[56:57],v[8:9] op_sel_hi:[1,0]
v_pk_add_f32 v[58:59],v[58:59],v[8:9] op_sel_hi:[1,0]
v_pk_add_f32 v[60:61],v[60:61],v[8:9] op_sel_hi:[1,0]
v_pk_add_f32 v[62:63],v[62:63],v[8:9] op_sel_hi:[1,0]
v_pk_add_f32 v[64:65],v[64:65],v[8:9] op_sel_hi:[1,0]
v_pk_add_f32 v[66:67],v[66:67],v[8:9] op_sel_hi:[1,0]
v_pk_add_f32 v[68:69],v[68:69],v[8:9] op_sel_hi:[1,0]
v_pk_add_f32 v[70:71],v[70:71],v[8:9] op_sel_hi:[1,0]
v_pk_add_f32 v[72:73],v[72:73],v[8:9] op_sel_hi:[1,0]
v_pk_add_f32 v[74:75],v[74:75],v[8:9] op_sel_hi:[1,0]
v_pk_add_f32 v[76:77],v[76:77],v[8:9] op_sel_hi:[1,0]
v_pk_add_f32 v[78:79],v[78:79],v[8:9] op_sel_hi:[1,0]
v_pk_add_f32 v[80:81],v[80:81],v[8:9] op_sel_hi:[1,0]
v_pk_add_f32 v[82:83],v[82:83],v[8:9] op_sel_hi:[1,0]
v_pk_add_f32 v[84:85],v[84:85],v[8:9] op_sel_hi:[1,0]
v_pk_add_f32 v[86:87],v[86:87],v[8:9] op_sel_hi:[1,0]
v_pk_add_f32 v[88:89],v[88:89],v[8:9] op_sel_hi:[1,0]
v_pk_add_f32 v[90:91],v[90:91],v[8:9] op_sel_hi:[1,0]
v_pk_add_f32 v[92:93],v[92:93],v[8:9] op_sel_hi:[1,0]
v_pk_add_f32 v[94:95],v[94:95],v[8:9] op_sel_hi:[1,0]
v_pk_add_f32 v[96:97],v[96:97],v[8:9] op_sel_hi:[1,0]
v_pk_add_f32 v[98:99],v[98:99],v[8:9] op_sel_hi:[1,0]
v_pk_add_f32 v[100:101],v[100:101],v[8:9] op_sel_hi:[1,0]
v_pk_add_f32 v[102:103],v[102:103],v[8:9] op_sel_hi:[1,0]
v_pk_mul_f32 v[10:11],v[40:41],v[40:41]
v_pk_mul_f32 v[14:15],v[42:43],v[42:43]
v_pk_fma_f32 v[10:11],v[44:45],v[44:45],v[10:11]
v_pk_fma_f32 v[14:15],v[46:47],v[46:47],v[14:15]
v_pk_fma_f32 v[10:11],v[48:49],v[48:49],v[10:11]
v_pk_fma_f32 v[14:15],v[50:51],v[50:51],v[14:15]
v_pk_fma_f32 v[10:11],v[52:53],v[52:53],v[10:11]
v_pk_fma_f32 v[14:15],v[54:55],v[54:55],v[14:15]
v_pk_fma_f32 v[10:11],v[56:57],v[56:57],v[10:11]
v_pk_fma_f32 v[14:15],v[58:59],v[58:59],v[14:15]
v_pk_fma_f32 v[10:11],v[60:61],v[60:61],v[10:11]
v_pk_fma_f32 v[14:15],v[62:63],v[62:63],v[14:15]
v_pk_fma_f32 v[10:11],v[64:65],v[64:65],v[10:11]
v_pk_fma_f32 v[14:15],v[66:67],v[66:67],v[14:15]
v_pk_fma_f32 v[10:11],v[68:69],v[68:69],v[10:11]
v_pk_fma_f32 v[14:15],v[70:71],v[70:71],v[14:15]
v_pk_fma_f32 v[10:11],v[72:73],v[72:73],v[10:11]
v_pk_fma_f32 v[14:15],v[74:75],v[74:75],v[14:15]
v_pk_fma_f32 v[10:11],v[76:77],v[76:77],v[10:11]
v_pk_fma_f32 v[14:15],v[78:79],v[78:79],v[14:15]
v_pk_fma_f32 v[10:11],v[80:81],v[80:81],v[10:11]
v_pk_fma_f32 v[14:15],v[82:83],v[82:83],v[14:15]
v_pk_fma_f32 v[10:11],v[84:85],v[84:85],v[10:11]
v_pk_fma_f32 v[14:15],v[86:87],v[86:87],v[14:15]
v_pk_fma_f32 v[10:11],v[88:89],v[88:89],v[10:11]
v_pk_fma_f32 v[14:15],v[90:91],v[90:91],v[14:15]
v_pk_fma_f32 v[10:11],v[92:93],v[92:93],v[10:11]
v_pk_fma_f32 v[14:15],v[94:95],v[94:95],v[14:15]
v_pk_fma_f32 v[10:11],v[96:97],v[96:97],v[10:11]
v_pk_fma_f32 v[14:15],v[98:99],v[98:99],v[14:15]
v_pk_fma_f32 v[10:11],v[100:101],v[100:101],v[10:11]
v_pk_fma_f32 v[14:15],v[102:103],v[102:103],v[14:15]
v_pk_add_f32 v[10:11],v[10:11],v[14:15]
v_add_f32 v10,v10,v11
s_nop 1
v_add_f32_dpp v10,v10,v10 row_ror:4 row_mask:0xf bank_mask:0xf
s_nop 1
v_add_f32_dpp v10,v10,v10 row_ror:8 row_mask:0xf bank_mask:0xf
v_mov_b32 v12,v10
s_nop 1
v_permlane16_swap_b32 v12,v10
v_add_f32 v10,v10,v12
v_mov_b32 v12,v10
s_nop 1
v_permlane32_swap_b32 v12,v10
v_add_f32 v10,v10,v12
v_mov_b32 v12,0x3727c5ac
v_fmac_f32 v12,0x3a800000,v10
v_rsq_f32 v10,v12
s_nop 0
v_pk_mul_f32 v[40:41],v[40:41],v[10:11] op_sel_hi:[1,0]
v_pk_mul_f32 v[42:43],v[42:43],v[10:11] op_sel_hi:[1,0]
v_pk_mul_f32 v[44:45],v[44:45],v[10:11] op_sel_hi:[1,0]
v_pk_mul_f32 v[46:47],v[46:47],v[10:11] op_sel_hi:[1,0]
v_pk_mul_f32 v[48:49],v[48:49],v[10:11] op_sel_hi:[1,0]
v_pk_mul_f32 v[50:51],v[50:51],v[10:11] op_sel_hi:[1,0]
v_pk_mul_f32 v[52:53],v[52:53],v[10:11] op_sel_hi:[1,0]
v_pk_mul_f32 v[54:55],v[54:55],v[10:11] op_sel_hi:[1,0]
v_pk_mul_f32 v[56:57],v[56:57],v[10:11] op_sel_hi:[1,0]
v_pk_mul_f32 v[58:59],v[58:59],v[10:11] op_sel_hi:[1,0]
v_pk_mul_f32 v[60:61],v[60:61],v[10:11] op_sel_hi:[1,0]
v_pk_mul_f32 v[62:63],v[62:63],v[10:11] op_sel_hi:[1,0]
v_pk_mul_f32 v[64:65],v[64:65],v[10:11] op_sel_hi:[1,0]
v_pk_mul_f32 v[66:67],v[66:67],v[10:11] op_sel_hi:[1,0]
v_pk_mul_f32 v[68:69],v[68:69],v[10:11] op_sel_hi:[1,0]
v_pk_mul_f32 v[70:71],v[70:71],v[10:11] op_sel_hi:[1,0]
v_pk_mul_f32 v[72:73],v[72:73],v[10:11] op_sel_hi:[1,0]
v_pk_mul_f32 v[74:75],v[74:75],v[10:11] op_sel_hi:[1,0]
v_pk_mul_f32 v[76:77],v[76:77],v[10:11] op_sel_hi:[1,0]
v_pk_mul_f32 v[78:79],v[78:79],v[10:11] op_sel_hi:[1,0]
v_pk_mul_f32 v[80:81],v[80:81],v[10:11] op_sel_hi:[1,0]
v_pk_mul_f32 v[82:83],v[82:83],v[10:11] op_sel_hi:[1,0]
v_pk_mul_f32 v[84:85],v[84:85],v[10:11] op_sel_hi:[1,0]
v_pk_mul_f32 v[86:87],v[86:87],v[10:11] op_sel_hi:[1,0]
v_pk_mul_f32 v[88:89],v[88:89],v[10:11] op_sel_hi:[1,0]
v_pk_mul_f32 v[90:91],v[90:91],v[10:11] op_sel_hi:[1,0]
v_pk_mul_f32 v[92:93],v[92:93],v[10:11] op_sel_hi:[1,0]
v_pk_mul_f32 v[94:95],v[94:95],v[10:11] op_sel_hi:[1,0]
v_pk_mul_f32 v[96:97],v[96:97],v[10:11] op_sel_hi:[1,0]
v_pk_mul_f32 v[98:99],v[98:99],v[10:11] op_sel_hi:[1,0]
v_pk_mul_f32 v[100:101],v[100:101],v[10:11] op_sel_hi:[1,0]
v_pk_mul_f32 v[102:103],v[102:103],v[10:11] op_sel_hi:[1,0]
v_mov_b32 v187,158976
s_cmp_lg_u32 s50,0
s_cbranch_scc1 sh0_32
s_mov_b32 s65,0
s_cmp_eq_u32 s56,1
s_cbranch_scc1 m1s_33
s_lshl_b32 s52,s55,7
s_add_u32 s52,s52,21102592
s_mov_b32 s53,0
m1l_34:
v_mov_b32 v184,0
buffer_load_dword v185,v184,s[20:23],s52 offen sc1
s_waitcnt vmcnt(0)
v_readfirstlane_b32 s64,v185
s_mov_b32 s65,0
s_cmp_eq_u32 s64,1
s_cbranch_scc1 m1ok_35
s_sub_u32 s90,s90,1
s_cmp_lt_i32 s90,0
s_cbranch_scc1 m1ok_35
s_add_u32 s53,s53,1
s_and_b32 s64,s53,31
s_cbranch_scc1 m1l_34
v_and_b32 v184,3,v1
v_bfe_u32 v185,v1,2,1
v_lshlrev_b32 v184,2,v184
v_lshl_add_u32 v184,v185,7,v184
v_writelane_b32 v184,32,8
s_mov_b64 exec,0x1ff
vpoll_36:
buffer_load_dword v185,v184,s[44:47],0 offen sc1
s_waitcnt vmcnt(0)
v_readlane_b32 s92,v185,0
v_readlane_b32 s93,v185,1
v_readlane_b32 s94,v185,2
v_readlane_b32 s95,v185,3
v_readlane_b32 s96,v185,4
v_readlane_b32 s97,v185,5
v_readlane_b32 s98,v185,6
v_readlane_b32 s99,v185,7
v_readlane_b32 s61,v185,8
s_add_u32 s64,s92,s93
s_add_u32 s64,s64,s94
s_add_u32 s64,s64,s95
s_add_u32 s64,s64,s96
s_add_u32 s64,s64,s97
s_add_u32 s64,s64,s98
s_add_u32 s64,s64,s99
s_min_u32 s65,s92,s93
s_min_u32 s66,s94,s95
s_min_u32 s65,s65,s66
s_min_u32 s66,s96,s97
s_min_u32 s65,s65,s66
s_min_u32 s66,s98,s99
s_min_u32 s65,s65,s66
s_cmp_lt_u32 s65,32
s_cselect_b32 s65,1,0
s_cmp_lt_u32 s64,256
s_cbranch_scc1 vslp_38
s_branch vgot_37
vslp_38:
s_sleep 8
s_sub_u32 s90,s90,1
s_cmp_gt_i32 s90,0
s_cbranch_scc1 vpoll_36
vgot_37:
s_mov_b64 exec,-1
s_and_b32 s61,s61,1
s_lshl_b32 s61,s61,13
s_mov_b32 s66,s54
s_cmp_gt_u32 s51,0
s_cselect_b32 s64,s92,0
s_add_u32 s66,s66,s64
s_cmp_gt_u32 s51,1
s_cselect_b32 s64,s93,0
s_add_u32 s66,s66,s64
s_cmp_gt_u32 s51,2
s_cselect_b32 s64,s94,0
s_add_u32 s66,s66,s64
s_cmp_gt_u32 s51,3
s_cselect_b32 s64,s95,0
s_add_u32 s66,s66,s64
s_cmp_gt_u32 s51,4
s_cselect_b32 s64,s96,0
s_add_u32 s66,s66,s64
s_cmp_gt_u32 s51,5
s_cselect_b32 s64,s97,0
s_add_u32 s66,s66,s64
s_cmp_gt_u32 s51,6
s_cselect_b32 s64,s98,0
s_add_u32 s66,s66,s64
s_cmp_eq_u32 s65,0
s_cbranch_scc1 m1l_34
s_branch m1ok_35
m1s_33:
s_mov_b32 s53,256
s_mov_b32 s52,164
v_mov_b32 v184,0
dp_39:
buffer_load_dword v185,v184,s[44:47],s52 offen sc1
s_waitcnt vmcnt(0)
v_cmp_ne_u32 vcc,s53,v185
s_cbranch_vccz dpok_40
s_sleep 8
s_sub_u32 s90,s90,1
s_cmp_gt_i32 s90,0
s_cbranch_scc1 dp_39
dpok_40:
m1ok_35:
v_mov_b32 v184,s65
v_mov_b32 v185,s66
v_mov_b32 v186,s61
ds_write_b96 v187,v[184:186] offset:16
s_waitcnt lgkmcnt(0)
sh0_32:
s_barrier
ds_read_b96 v[184:186],v187 offset:16
s_waitcnt lgkmcnt(0)
v_readfirstlane_b32 s65,v184
v_readfirstlane_b32 s66,v185
v_readfirstlane_b32 s61,v186
s_cmp_lg_u32 s65,0
s_cbranch_scc1 slowrole_10
s_and_b32 s56,s56,1
v_lshlrev_b32 v7,5,v0
s_mov_b32 s40,24576
buffer_load_dwordx4 v[104:107],v7,s[20:23],s40 offen offset:0 sc1
buffer_load_dwordx4 v[108:111],v7,s[20:23],s40 offen offset:16 sc1
s_add_u32 s40,s40,8192
buffer_load_dwordx4 v[112:115],v7,s[20:23],s40 offen offset:0 sc1
buffer_load_dwordx4 v[116:119],v7,s[20:23],s40 offen offset:16 sc1
s_add_u32 s40,s40,8192
buffer_load_dwordx4 v[120:123],v7,s[20:23],s40 offen offset:0 sc1
buffer_load_dwordx4 v[124:127],v7,s[20:23],s40 offen offset:16 sc1
s_add_u32 s40,s40,8192
buffer_load_dwordx4 v[128:131],v7,s[20:23],s40 offen offset:0 sc1
buffer_load_dwordx4 v[132:135],v7,s[20:23],s40 offen offset:16 sc1
v_mov_b32 v14,1.0
v_cmp_lt_u32 vcc,127,v0
s_nop 1
v_cndmask_b32 v14,0,v14,vcc
s_waitcnt vmcnt(0)
v_pk_add_f32 v[104:105],v[104:105],v[112:113]
v_pk_add_f32 v[120:121],v[120:121],v[128:129]
v_pk_add_f32 v[106:107],v[106:107],v[114:115]
v_pk_add_f32 v[122:123],v[122:123],v[130:131]
v_pk_add_f32 v[108:109],v[108:109],v[116:117]
v_pk_add_f32 v[124:125],v[124:125],v[132:133]
v_pk_add_f32 v[110:111],v[110:111],v[118:119]
v_pk_add_f32 v[126:127],v[126:127],v[134:135]
v_pk_add_f32 v[104:105],v[104:105],v[120:121]
v_pk_add_f32 v[106:107],v[106:107],v[122:123]
v_pk_add_f32 v[108:109],v[108:109],v[124:125]
v_pk_add_f32 v[110:111],v[110:111],v[126:127]
v_cvt_pk_bf16_f32 v112,v104,v105
v_cvt_pk_bf16_f32 v113,v106,v107
v_cvt_pk_bf16_f32 v114,v108,v109
v_cvt_pk_bf16_f32 v115,v110,v111
v_lshlrev_b32 v104,16,v112
v_and_b32 v105,s39,v112
v_lshlrev_b32 v106,16,v113
v_and_b32 v107,s39,v113
v_lshlrev_b32 v108,16,v114
v_and_b32 v109,s39,v114
v_lshlrev_b32 v110,16,v115
v_and_b32 v111,s39,v115
v_pk_add_f32 v[104:105],v[104:105],v[14:15] op_sel_hi:[1,0]
v_pk_add_f32 v[106:107],v[106:107],v[14:15] op_sel_hi:[1,0]
v_pk_add_f32 v[108:109],v[108:109],v[14:15] op_sel_hi:[1,0]
v_pk_add_f32 v[110:111],v[110:111],v[14:15] op_sel_hi:[1,0]
ds_write_b128 v7,v[104:107] offset:4096
ds_write_b128 v7,v[108:111] offset:4112
s_waitcnt lgkmcnt(0)
s_barrier
ds_read_b128 v[104:107],v4 offset:8192
ds_read_b128 v[168:171],v4 offset:4096
ds_read_b128 v[108:111],v4 offset:8208
ds_read_b128 v[172:175],v4 offset:4112
ds_read_b128 v[112:115],v4 offset:8224
ds_read_b128 v[176:179],v4 offset:4128
ds_read_b128 v[116:119],v4 offset:8240
ds_read_b128 v[180:183],v4 offset:4144
ds_read_b128 v[120:123],v4 offset:9216
ds_read_b128 v[184:187],v4 offset:5120
ds_read_b128 v[124:127],v4 offset:9232
ds_read_b128 v[188:191],v4 offset:5136
ds_read_b128 v[128:131],v4 offset:9248
ds_read_b128 v[192:195],v4 offset:5152
ds_read_b128 v[132:135],v4 offset:9264
ds_read_b128 v[196:199],v4 offset:5168
ds_read_b128 v[136:139],v4 offset:10240
ds_read_b128 v[200:203],v4 offset:6144
ds_read_b128 v[140:143],v4 offset:10256
ds_read_b128 v[204:207],v4 offset:6160
ds_read_b128 v[144:147],v4 offset:10272
ds_read_b128 v[208:211],v4 offset:6176
ds_read_b128 v[148:151],v4 offset:10288
ds_read_b128 v[212:215],v4 offset:6192
ds_read_b128 v[152:155],v4 offset:11264
ds_read_b128 v[216:219],v4 offset:7168
ds_read_b128 v[156:159],v4 offset:11280
ds_read_b128 v[220:223],v4 offset:7184
ds_read_b128 v[160:163],v4 offset:11296
ds_read_b128 v[224:227],v4 offset:7200
ds_read_b128 v[164:167],v4 offset:11312
ds_read_b128 v[228:231],v4 offset:7216
s_waitcnt lgkmcnt(15)
v_pk_fma_f32 v[40:41],v[40:41],v[104:105],v[168:169]
v_pk_fma_f32 v[42:43],v[42:43],v[106:107],v[170:171]
v_pk_fma_f32 v[44:45],v[44:45],v[108:109],v[172:173]
v_pk_fma_f32 v[46:47],v[46:47],v[110:111],v[174:175]
v_pk_fma_f32 v[48:49],v[48:49],v[112:113],v[176:177]
v_pk_fma_f32 v[50:51],v[50:51],v[114:115],v[178:179]
v_pk_fma_f32 v[52:53],v[52:53],v[116:117],v[180:181]
v_pk_fma_f32 v[54:55],v[54:55],v[118:119],v[182:183]
v_cvt_pk_bf16_f32 v16,v40,v41
v_cvt_pk_bf16_f32 v17,v48,v49
v_cvt_pk_bf16_f32 v18,v42,v43
v_cvt_pk_bf16_f32 v19,v50,v51
buffer_store_dwordx4 v[16:19],v6,s[20:23],s37 offen offset:0 sc1
v_cvt_pk_bf16_f32 v20,v44,v45
v_cvt_pk_bf16_f32 v21,v52,v53
v_cvt_pk_bf16_f32 v22,v46,v47
v_cvt_pk_bf16_f32 v23,v54,v55
buffer_store_dwordx4 v[20:23],v6,s[20:23],s37 offen offset:256 sc1
s_waitcnt lgkmcnt(15)
v_pk_fma_f32 v[56:57],v[56:57],v[120:121],v[184:185]
v_pk_fma_f32 v[58:59],v[58:59],v[122:123],v[186:187]
v_pk_fma_f32 v[60:61],v[60:61],v[124:125],v[188:189]
v_pk_fma_f32 v[62:63],v[62:63],v[126:127],v[190:191]
v_pk_fma_f32 v[64:65],v[64:65],v[128:129],v[192:193]
v_pk_fma_f32 v[66:67],v[66:67],v[130:131],v[194:195]
v_pk_fma_f32 v[68:69],v[68:69],v[132:133],v[196:197]
v_pk_fma_f32 v[70:71],v[70:71],v[134:135],v[198:199]
v_cvt_pk_bf16_f32 v24,v56,v57
v_cvt_pk_bf16_f32 v25,v64,v65
v_cvt_pk_bf16_f32 v26,v58,v59
v_cvt_pk_bf16_f32 v27,v66,v67
s_add_u32 s37,s37,16384
buffer_store_dwordx4 v[24:27],v6,s[20:23],s37 offen offset:0 sc1
v_cvt_pk_bf16_f32 v28,v60,v61
v_cvt_pk_bf16_f32 v29,v68,v69
v_cvt_pk_bf16_f32 v30,v62,v63
v_cvt_pk_bf16_f32 v31,v70,v71
buffer_store_dwordx4 v[28:31],v6,s[20:23],s37 offen offset:256 sc1
s_waitcnt lgkmcnt(8)
v_pk_fma_f32 v[72:73],v[72:73],v[136:137],v[200:201]
v_pk_fma_f32 v[74:75],v[74:75],v[138:139],v[202:203]
v_pk_fma_f32 v[76:77],v[76:77],v[140:141],v[204:205]
v_pk_fma_f32 v[78:79],v[78:79],v[142:143],v[206:207]
v_pk_fma_f32 v[80:81],v[80:81],v[144:145],v[208:209]
v_pk_fma_f32 v[82:83],v[82:83],v[146:147],v[210:211]
v_pk_fma_f32 v[84:85],v[84:85],v[148:149],v[212:213]
v_pk_fma_f32 v[86:87],v[86:87],v[150:151],v[214:215]
v_cvt_pk_bf16_f32 v16,v72,v73
v_cvt_pk_bf16_f32 v17,v80,v81
v_cvt_pk_bf16_f32 v18,v74,v75
v_cvt_pk_bf16_f32 v19,v82,v83
s_add_u32 s37,s37,16384
buffer_store_dwordx4 v[16:19],v6,s[20:23],s37 offen offset:0 sc1
v_cvt_pk_bf16_f32 v20,v76,v77
v_cvt_pk_bf16_f32 v21,v84,v85
v_cvt_pk_bf16_f32 v22,v78,v79
v_cvt_pk_bf16_f32 v23,v86,v87
buffer_store_dwordx4 v[20:23],v6,s[20:23],s37 offen offset:256 sc1
s_waitcnt lgkmcnt(0)
v_pk_fma_f32 v[88:89],v[88:89],v[152:153],v[216:217]
v_pk_fma_f32 v[90:91],v[90:91],v[154:155],v[218:219]
v_pk_fma_f32 v[92:93],v[92:93],v[156:157],v[220:221]
v_pk_fma_f32 v[94:95],v[94:95],v[158:159],v[222:223]
v_pk_fma_f32 v[96:97],v[96:97],v[160:161],v[224:225]
v_pk_fma_f32 v[98:99],v[98:99],v[162:163],v[226:227]
v_pk_fma_f32 v[100:101],v[100:101],v[164:165],v[228:229]
v_pk_fma_f32 v[102:103],v[102:103],v[166:167],v[230:231]
v_cvt_pk_bf16_f32 v24,v88,v89
v_cvt_pk_bf16_f32 v25,v96,v97
v_cvt_pk_bf16_f32 v26,v90,v91
v_cvt_pk_bf16_f32 v27,v98,v99
s_add_u32 s37,s37,16384
buffer_store_dwordx4 v[24:27],v6,s[20:23],s37 offen offset:0 sc1
v_cvt_pk_bf16_f32 v28,v92,v93
v_cvt_pk_bf16_f32 v29,v100,v101
v_cvt_pk_bf16_f32 v30,v94,v95
v_cvt_pk_bf16_f32 v31,v102,v103
buffer_store_dwordx4 v[28:31],v6,s[20:23],s37 offen offset:256 sc1
s_waitcnt vmcnt(0)
s_barrier
v_mov_b32 v187,158976
s_cmp_lg_u32 s50,0
s_cbranch_scc1 sh0_41
s_cmp_ge_u32 s55,16
s_cbranch_scc1 nodln_42
s_mov_b64 exec,1
v_mov_b32 v184,1
v_mov_b32 v185,0
buffer_atomic_add v184,v185,s[44:47],40 offen sc1
s_mov_b64 exec,-1
nodln_42:
s_mov_b32 s61,0
s_cmp_eq_u32 s56,1
s_cbranch_scc1 nopar_43
v_mov_b32 v184,0
dp_44:
buffer_load_dword v185,v184,s[44:47],32 offen sc1
s_waitcnt vmcnt(0)
v_cmp_eq_u32 vcc,0,v185
s_cbranch_vccz dpok_45
s_sleep 4
s_sub_u32 s90,s90,1
s_cmp_gt_i32 s90,0
s_cbranch_scc1 dp_44
dpok_45:
v_readfirstlane_b32 s65,v185
s_and_b32 s65,s65,1
s_lshl_b32 s61,s65,13
nopar_43:
v_mov_b32 v184,s65
v_mov_b32 v185,s66
v_mov_b32 v186,s61
ds_write_b96 v187,v[184:186] offset:16
s_waitcnt lgkmcnt(0)
sh0_41:
s_barrier
ds_read_b96 v[184:186],v187 offset:16
s_waitcnt lgkmcnt(0)
v_readfirstlane_b32 s65,v184
v_readfirstlane_b32 s66,v185
v_readfirstlane_b32 s61,v186
s_sub_u32 s55,s57,128
s_cmp_lg_u32 s50,0
s_cbranch_scc1 nsig_46
s_lshr_b32 s95,s55,4
s_lshl_b32 s95,s95,6
s_add_u32 s95,s95,21052416
s_mov_b64 exec,1
v_mov_b32 v184,112
v_mov_b32 v185,0
buffer_atomic_add v184,v185,s[20:23],s95 offen sc1
s_mov_b64 exec,-1
nsig_46:
s_branch pipe_worker
loops_7:
s_mov_b64 s[24:25],s[20:21]
s_mov_b64 s[28:29],s[20:21]
s_mov_b32 s27,0x20000
s_mov_b32 s31,0x20000
s_cmp_eq_u32 s56,0
s_cselect_b32 s26,s22,0
s_cselect_b32 s30,0,s22
s_lshl_b32 s64,s58,14
s_add_u32 s64,s64,23068672
v_add_u32 v26,s64,v16
v_add_u32 v27,4096,v26
v_add_u32 v28,8192,v26
v_add_u32 v29,12288,v26
s_lshl_b32 s65,s59,9
s_add_u32 s66,s64,s65
s_lshl_b32 s64,s58,7
s_add_u32 s64,s64,23592960
v_and_b32 v18,31,v1
v_lshl_add_u32 v18,v18,2,s64
s_lshl_b32 s65,s59,2
s_add_u32 s64,s64,s65
v_mov_b32 v13,s64
v_mov_b32 v14,0x4444
v_mov_b32 v22,0xeeee
v_cmp_lt_u32 vcc,7,v3
s_nop 1
v_cndmask_b32 v14,v14,v22,vcc
v_and_b32 v22,1,v3
v_cmp_eq_u32 vcc,0,v22
v_mov_b32 v15,0x03020706
v_mov_b32 v23,0x05040100
v_cndmask_b32 v15,v15,v23,vcc
v_lshlrev_b32 v19,5,v22
v_lshl_add_u32 v19,v4,6,v19
v_lshrrev_b32 v23,1,v3
v_lshl_add_u32 v19,v23,2,v19
s_lshl_b32 s67,s57,10
s_add_u32 s67,s67,23199744
s_lshl_b32 s64,s50,2
s_lshr_b32 s64,0x1320,s64
s_and_b32 s64,s64,3
s_lshl_b32 s64,s64,8
s_add_u32 s64,s64,s67
v_add_u32 v19,s64,v19
v_add_u32 v24,131072,v16
v_mov_b32 v21,158720
v_mov_b32 v25,0
v_mov_b32 v20,v16
v_and_b32 v22,1,v4
v_lshrrev_b32 v23,1,v4
v_lshl_add_u32 v23,v23,4,v3
v_lshlrev_b32 v23,4,v23
v_lshl_add_u32 v23,v22,10,v23
s_lshr_b32 s64,s50,1
s_lshl_b32 s64,s64,9
v_add_u32 v23,s64,v23
s_lshr_b32 s64,s57,2
s_add_u32 s65,s64,32
s_lshl_b32 s65,s65,14
s_and_b32 s68,s57,3
s_lshl_b32 s68,s68,11
s_add_u32 s65,s65,s68
s_add_u32 s65,s65,29360128
v_add_u32 v17,s65,v23
s_lshl_b32 s69,s57,11
s_add_u32 s69,s69,23330816
v_add_u32 v2,s69,v23
s_mov_b32 s81,0x3e0293ee
s_mov_b32 s84,0xff00ff
s_mov_b32 s85,0xff00ff
s_mov_b32 s86,0x33333333
s_mov_b32 s87,0x33333333
s_mov_b32 s62,0x10000
s_mov_b32 s79,-2
ds_write_b32 v21,v25
ds_write_b32 v21,v25 offset:4
ds_write_b32 v21,v25 offset:8
ds_write_b32 v21,v25 offset:12
ds_write_b32 v21,v25 offset:16
v_mov_b32 v100,0
v_mov_b32 v101,0
v_mov_b32 v102,0
v_mov_b32 v103,0
s_lshr_b32 s64,s59,3
s_lshl_b32 s64,s64,14
s_and_b32 s65,s59,7
s_lshl_b32 s65,s65,10
s_add_u32 s64,s64,s65
s_lshl_b32 s65,s58,16
s_add_u32 s64,s64,s65
s_add_u32 s64,s64,31195136
v_add_u32 v8,s64,v16
s_lshl_b32 s64,s50,21
s_lshl_b32 s65,s50,13
s_and_b32 s65,s65,0x2000
s_xor_b32 s65,s65,s61
s_add_u32 s64,s64,s65
buffer_store_dwordx4 v[100:103],v8,s[20:23],s64 offen sc1
s_lshr_b32 s65,s57,3
s_add_u32 s65,s65,96
s_lshl_b32 s65,s65,14
s_add_u32 s64,s64,s65
s_and_b32 s65,s57,7
s_lshl_b32 s65,s65,10
s_add_u32 s64,s64,s65
s_add_u32 s64,s64,29360128
buffer_store_dwordx4 v[100:103],v16,s[20:23],s64 offen sc1
s_lshl_b32 s64,s50,20
s_mov_b64 exec,1
buffer_store_dword v25,v13,s[24:27],s64 offen
buffer_store_dword v25,v13,s[24:27],s64 offen offset:512
buffer_store_dword v25,v13,s[28:31],s64 offen sc1
buffer_store_dword v25,v13,s[28:31],s64 offen offset:512 sc1
s_mov_b64 exec,-1
s_cmp_gt_u32 s50,1
s_cbranch_scc1 rs1_47
v_add_u32 v9,s67,v16
v_add_u32 v10,s66,v16
s_add_u32 s65,s64,65536
buffer_store_dwordx4 v[100:103],v9,s[24:27],s64 offen
buffer_store_dwordx4 v[100:103],v9,s[28:31],s64 offen sc1
s_mov_b32 exec_hi,0
buffer_store_dwordx4 v[100:103],v10,s[24:27],s64 offen
buffer_store_dwordx4 v[100:103],v10,s[24:27],s65 offen
buffer_store_dwordx4 v[100:103],v10,s[28:31],s64 offen sc1
buffer_store_dwordx4 v[100:103],v10,s[28:31],s65 offen sc1
s_mov_b64 exec,-1
rs1_47:
s_waitcnt vmcnt(0)
s_barrier
s_cmp_lg_u32 s50,0
s_cbranch_scc1 nadd_48
s_mov_b64 exec,1
v_mov_b32 v184,1
v_mov_b32 v185,0
s_mov_b32 s52,36
buffer_atomic_add v184,v185,s[44:47],s52 offen sc1
s_mov_b64 exec,-1
nadd_48:
s_cmp_lg_u32 s50,1
s_cbranch_scc1 rs2_49
v_mov_b32 v184,0
dp_50:
buffer_load_dword v185,v184,s[44:47],40 offen sc1
s_waitcnt vmcnt(0)
v_cmp_ne_u32 vcc,16,v185
s_cbranch_vccz dpok_51
s_sleep 6
s_sub_u32 s90,s90,1
s_cmp_gt_i32 s90,0
s_cbranch_scc1 dp_50
dpok_51:
rs2_49:
s_barrier
s_lshl_b32 s64,s50,14
s_add_u32 m0,s64,0
s_add_u32 s65,s64,57344
buffer_load_dwordx4 v16,s[20:23],s65 offen offset:0 lds
buffer_load_dwordx4 v16,s[20:23],s65 offen offset:1024 lds
buffer_load_dwordx4 v16,s[20:23],s65 offen offset:2048 lds
buffer_load_dwordx4 v16,s[20:23],s65 offen offset:3072 lds
s_add_u32 m0,s64,4096
s_add_u32 s65,s64,61440
buffer_load_dwordx4 v16,s[20:23],s65 offen offset:0 lds
buffer_load_dwordx4 v16,s[20:23],s65 offen offset:1024 lds
buffer_load_dwordx4 v16,s[20:23],s65 offen offset:2048 lds
buffer_load_dwordx4 v16,s[20:23],s65 offen offset:3072 lds
s_add_u32 m0,s64,8192
s_add_u32 s65,s64,65536
buffer_load_dwordx4 v16,s[20:23],s65 offen offset:0 lds
buffer_load_dwordx4 v16,s[20:23],s65 offen offset:1024 lds
buffer_load_dwordx4 v16,s[20:23],s65 offen offset:2048 lds
buffer_load_dwordx4 v16,s[20:23],s65 offen offset:3072 lds
s_add_u32 m0,s64,12288
s_add_u32 s65,s64,69632
buffer_load_dwordx4 v16,s[20:23],s65 offen offset:0 lds
buffer_load_dwordx4 v16,s[20:23],s65 offen offset:1024 lds
buffer_load_dwordx4 v16,s[20:23],s65 offen offset:2048 lds
buffer_load_dwordx4 v16,s[20:23],s65 offen offset:3072 lds
s_add_u32 m0,s64,65536
s_add_u32 s65,s64,122880
buffer_load_dwordx4 v16,s[20:23],s65 offen offset:0 lds
buffer_load_dwordx4 v16,s[20:23],s65 offen offset:1024 lds
buffer_load_dwordx4 v16,s[20:23],s65 offen offset:2048 lds
buffer_load_dwordx4 v16,s[20:23],s65 offen offset:3072 lds
s_add_u32 m0,s64,69632
s_add_u32 s65,s64,126976
buffer_load_dwordx4 v16,s[20:23],s65 offen offset:0 lds
buffer_load_dwordx4 v16,s[20:23],s65 offen offset:1024 lds
buffer_load_dwordx4 v16,s[20:23],s65 offen offset:2048 lds
buffer_load_dwordx4 v16,s[20:23],s65 offen offset:3072 lds
s_add_u32 m0,s64,73728
s_add_u32 s65,s64,131072
buffer_load_dwordx4 v16,s[20:23],s65 offen offset:0 lds
buffer_load_dwordx4 v16,s[20:23],s65 offen offset:1024 lds
buffer_load_dwordx4 v16,s[20:23],s65 offen offset:2048 lds
buffer_load_dwordx4 v16,s[20:23],s65 offen offset:3072 lds
s_add_u32 m0,s64,77824
s_add_u32 s65,s64,135168
buffer_load_dwordx4 v16,s[20:23],s65 offen offset:0 lds
buffer_load_dwordx4 v16,s[20:23],s65 offen offset:1024 lds
buffer_load_dwordx4 v16,s[20:23],s65 offen offset:2048 lds
buffer_load_dwordx4 v16,s[20:23],s65 offen offset:3072 lds
s_cmp_eq_u32 s50,3
s_cbranch_scc1 w3_56
s_cmp_eq_u32 s50,1
s_cbranch_scc1 w1_54
s_cmp_eq_u32 s50,2
s_cbranch_scc1 w2_55
w0_53:
v_and_b32 v22,7,v3
v_lshrrev_b32 v23,2,v22
v_and_b32 v5,2,v22
v_or_b32 v23,v23,v5
v_and_b32 v5,1,v22
v_lshl_add_u32 v23,v23,1,v5
v_lshlrev_b32 v23,5,v23
v_lshrrev_b32 v5,3,v3
v_lshl_add_u32 v23,v5,9,v23
v_lshrrev_b32 v5,1,v4
v_lshl_add_u32 v23,v5,8,v23
v_and_b32 v5,1,v4
v_lshl_add_u32 v23,v5,4,v23
v_add_u32 v8,s67,v23
v_xor_b32 v9,1024,v8
v_xor_b32 v10,2048,v8
v_xor_b32 v11,3072,v8
v_lshlrev_b32 v31,4,v3
v_lshl_add_u32 v31,v5,3,v31
v_add_u32 v31,155648,v31
v_lshl_add_u32 v23,v4,3,v22
v_lshlrev_b32 v23,4,v23
v_add_u32 v12,155648,v23
v_add_u32 v30,s66,v23
v_cmp_gt_u32 vcc,8,v3
v_cmp_lt_u32 s[52:53],1,v4
s_and_b64 vcc,vcc,s[52:53]
v_mov_b32 v22,0xf149f2ca
v_cndmask_b32 v156,v22,0,vcc
v_mov_b32 v157,v156
v_mov_b32 v158,v156
v_mov_b32 v159,v156
v_add_u32 v2,s69,v16
v_xor_b32 v5,2048,v2
v_xor_b32 v6,4096,v2
v_xor_b32 v7,6144,v2
s_lshr_b32 s64,s57,3
s_add_u32 s64,s64,96
s_lshl_b32 s64,s64,14
s_and_b32 s65,s57,7
s_lshl_b32 s65,s65,10
s_add_u32 s64,s64,s65
s_add_u32 s64,s64,29360128
v_add_u32 v3,s64,v16
v_mov_b32 v136,0
v_mov_b32 v137,0
v_mov_b32 v138,0
v_mov_b32 v139,0
v_mov_b32 v140,0
v_mov_b32 v141,0
v_mov_b32 v142,0
v_mov_b32 v143,0
v_mov_b32 v144,0
v_mov_b32 v145,0
v_mov_b32 v146,0
v_mov_b32 v147,0
v_mov_b32 v152,0x3f803f80
v_mov_b32 v153,0x3f803f80
v_mov_b32 v154,0x3f803f80
v_mov_b32 v155,0x3f803f80
s_branch first_57
loop_58:
s_barrier
buffer_load_dword v248,v18,s[20:23],s70 offen offset:0 sc1
s_nop 15
s_nop 5
hl_60:
buffer_load_dword v249,v18,s[20:23],s70 offen offset:0 sc1
s_waitcnt vmcnt(1)
v_cmp_eq_u32 vcc,v25,v248
s_bcnt1_i32_b32 s64,vcc_lo
s_cmp_ge_u32 s64,8
s_cbranch_scc1 hg_61
buffer_load_dword v248,v18,s[20:23],s70 offen offset:0 sc1
s_waitcnt vmcnt(1)
v_cmp_eq_u32 vcc,v25,v249
s_bcnt1_i32_b32 s64,vcc_lo
s_cmp_ge_u32 s64,8
s_cbranch_scc1 hg_61
s_sub_u32 s90,s90,1
s_cmp_gt_i32 s90,0
s_cbranch_scc1 hl_60
hg_61:
buffer_load_dwordx4 v[32:35],v26,s[20:23],s70 offen offset:0 sc1
buffer_load_dwordx4 v[36:39],v26,s[20:23],s70 offen offset:1024 sc1
buffer_load_dwordx4 v[40:43],v26,s[20:23],s70 offen offset:2048 sc1
buffer_load_dwordx4 v[44:47],v26,s[20:23],s70 offen offset:3072 sc1
s_waitcnt vmcnt(3)
ds_write_b128 v24,v[32:35] offset:0
v_min3_u32 v22,v32,v33,v34
v_min_u32 v22,v22,v35
s_waitcnt vmcnt(2)
ds_write_b128 v24,v[36:39] offset:1024
v_min3_u32 v22,v22,v36,v37
v_min3_u32 v22,v22,v38,v39
s_waitcnt vmcnt(1)
ds_write_b128 v24,v[40:43] offset:2048
v_min3_u32 v22,v22,v40,v41
v_min3_u32 v22,v22,v42,v43
s_waitcnt vmcnt(0)
ds_write_b128 v24,v[44:47] offset:3072
v_min3_u32 v22,v22,v44,v45
v_min3_u32 v22,v22,v46,v47
v_cmp_eq_u32 vcc,0,v22
s_cbranch_vccnz art_62
abk_63:
v_smfmac_f32_16x16x64_bf16 v[176:179],v[32:35],a[0:7],v14
s_waitcnt lgkmcnt(0)
s_barrier
ds_read_b128 v[48:51],v24 offset:4096
ds_read_b128 v[52:55],v24 offset:5120
ds_read_b128 v[56:59],v24 offset:6144
ds_read_b128 v[60:63],v24 offset:7168
v_smfmac_f32_16x16x64_bf16 v[176:179],v[36:39],a[8:15],v14
ds_read_b128 v[64:67],v24 offset:8192
ds_read_b128 v[68:71],v24 offset:9216
v_smfmac_f32_16x16x64_bf16 v[176:179],v[40:43],a[16:23],v14
ds_read_b128 v[72:75],v24 offset:10240
ds_read_b128 v[76:79],v24 offset:11264
v_smfmac_f32_16x16x64_bf16 v[176:179],v[44:47],a[24:31],v14
ds_read_b128 v[80:83],v24 offset:12288
ds_read_b128 v[84:87],v24 offset:13312
s_waitcnt lgkmcnt(9)
v_smfmac_f32_16x16x64_bf16 v[176:179],v[48:51],a[32:39],v14
ds_read_b128 v[88:91],v24 offset:14336
s_waitcnt lgkmcnt(9)
v_smfmac_f32_16x16x64_bf16 v[176:179],v[52:55],a[40:47],v14
ds_read_b128 v[92:95],v24 offset:15360
s_waitcnt lgkmcnt(9)
v_smfmac_f32_16x16x64_bf16 v[176:179],v[56:59],a[48:55],v14
s_waitcnt lgkmcnt(8)
v_smfmac_f32_16x16x64_bf16 v[176:179],v[60:63],a[56:63],v14
s_waitcnt lgkmcnt(7)
v_smfmac_f32_16x16x64_bf16 v[176:179],v[64:67],a[64:71],v14
s_waitcnt lgkmcnt(6)
v_smfmac_f32_16x16x64_bf16 v[176:179],v[68:71],a[72:79],v14
s_waitcnt lgkmcnt(5)
v_smfmac_f32_16x16x64_bf16 v[176:179],v[72:75],a[80:87],v14
s_waitcnt lgkmcnt(4)
v_smfmac_f32_16x16x64_bf16 v[176:179],v[76:79],a[88:95],v14
s_waitcnt lgkmcnt(3)
v_smfmac_f32_16x16x64_bf16 v[176:179],v[80:83],a[96:103],v14
s_waitcnt lgkmcnt(2)
v_smfmac_f32_16x16x64_bf16 v[176:179],v[84:87],a[104:111],v14
s_waitcnt lgkmcnt(1)
v_smfmac_f32_16x16x64_bf16 v[176:179],v[88:91],a[112:119],v14
s_waitcnt lgkmcnt(0)
v_smfmac_f32_16x16x64_bf16 v[176:179],v[92:95],a[120:127],v14
s_nop 7
v_permlane32_swap_b32 v176,v178
v_permlane32_swap_b32 v177,v179
v_add_f32 v176,v176,v178
v_add_f32 v177,v177,v179
v_cvt_pk_bf16_f32 v216,v176,v177
s_nop 1
v_mov_b32_dpp v217,v216 quad_perm:[1,0,3,2] row_mask:0xf bank_mask:0xf
v_perm_b32 v216,v217,v216,v15
v_max_u32 v216,1,v216
buffer_store_dword v216,v19,s[24:27],s70 offen
buffer_store_dword v216,v19,s[28:31],s70 offen sc1
s_lshr_b32 s64,s70,9
v_add_u32 v22,s64,v24
s_cmp_eq_u32 s79,0
ds_read_b128 v[128:131],v22 offset:16384
ds_read_b128 v[132:135],v22 offset:17408
s_cbranch_scc1 kt0_64
kt0b_65:
s_nop 15
s_nop 15
s_nop 11
buffer_load_dwordx4 v[32:35],v8,s[20:23],s70 offen sc1
buffer_load_dwordx4 v[36:39],v9,s[20:23],s70 offen sc1
buffer_load_dwordx4 v[40:43],v10,s[20:23],s70 offen sc1
buffer_load_dwordx4 v[44:47],v11,s[20:23],s70 offen sc1
s_nop 9
scp_66:
buffer_load_dwordx4 v[48:51],v8,s[20:23],s70 offen sc1
buffer_load_dwordx4 v[52:55],v9,s[20:23],s70 offen sc1
buffer_load_dwordx4 v[56:59],v10,s[20:23],s70 offen sc1
buffer_load_dwordx4 v[60:63],v11,s[20:23],s70 offen sc1
s_waitcnt vmcnt(4)
v_mfma_f32_16x16x32_bf16 v[168:171],v[32:35],v[32:35],v[156:159]
v_min3_u32 v22,v32,v33,v34
v_min3_u32 v22,v22,v35,v36
v_mfma_f32_16x16x32_bf16 v[164:167],v[100:103],v[32:35],0
v_min3_u32 v22,v22,v37,v38
v_min3_u32 v22,v22,v39,v40
v_mfma_f32_16x16x32_bf16 v[160:163],v[96:99],v[32:35],0
v_min3_u32 v22,v22,v41,v42
v_min3_u32 v22,v22,v43,v44
v_mfma_f32_16x16x32_bf16 v[168:171],v[36:39],v[36:39],v[168:171]
v_min3_u32 v22,v22,v45,v46
v_min_u32 v22,v22,v47
v_mfma_f32_16x16x32_bf16 v[164:167],v[108:111],v[36:39],v[164:167]
v_cmp_eq_u32 vcc,0,v22
s_cbranch_vccnz nx_68
v_mfma_f32_16x16x32_bf16 v[160:163],v[104:107],v[36:39],v[160:163]
v_mov_b32 v172,v32
v_mfma_f32_16x16x32_bf16 v[168:171],v[40:43],v[40:43],v[168:171]
v_mov_b32 v173,v33
v_mfma_f32_16x16x32_bf16 v[164:167],v[116:119],v[40:43],v[164:167]
v_mov_b32 v174,v34
v_mfma_f32_16x16x32_bf16 v[160:163],v[112:115],v[40:43],v[160:163]
v_mov_b32 v175,v35
v_mfma_f32_16x16x32_bf16 v[168:171],v[44:47],v[44:47],v[168:171]
v_mfma_f32_16x16x32_bf16 v[164:167],v[124:127],v[44:47],v[164:167]
v_mfma_f32_16x16x32_bf16 v[160:163],v[120:123],v[44:47],v[160:163]
s_nop 1
s_branch scok_67
nx_68:
buffer_load_dwordx4 v[32:35],v8,s[20:23],s70 offen sc1
buffer_load_dwordx4 v[36:39],v9,s[20:23],s70 offen sc1
buffer_load_dwordx4 v[40:43],v10,s[20:23],s70 offen sc1
buffer_load_dwordx4 v[44:47],v11,s[20:23],s70 offen sc1
s_waitcnt vmcnt(4)
v_mfma_f32_16x16x32_bf16 v[168:171],v[48:51],v[48:51],v[156:159]
v_min3_u32 v22,v48,v49,v50
v_min3_u32 v22,v22,v51,v52
v_mfma_f32_16x16x32_bf16 v[164:167],v[100:103],v[48:51],0
v_min3_u32 v22,v22,v53,v54
v_min3_u32 v22,v22,v55,v56
v_mfma_f32_16x16x32_bf16 v[160:163],v[96:99],v[48:51],0
v_min3_u32 v22,v22,v57,v58
v_min3_u32 v22,v22,v59,v60
v_mfma_f32_16x16x32_bf16 v[168:171],v[52:55],v[52:55],v[168:171]
v_min3_u32 v22,v22,v61,v62
v_min_u32 v22,v22,v63
v_mfma_f32_16x16x32_bf16 v[164:167],v[108:111],v[52:55],v[164:167]
v_cmp_eq_u32 vcc,0,v22
s_cbranch_vccnz nx_69
v_mfma_f32_16x16x32_bf16 v[160:163],v[104:107],v[52:55],v[160:163]
v_mov_b32 v172,v48
v_mfma_f32_16x16x32_bf16 v[168:171],v[56:59],v[56:59],v[168:171]
v_mov_b32 v173,v49
v_mfma_f32_16x16x32_bf16 v[164:167],v[116:119],v[56:59],v[164:167]
v_mov_b32 v174,v50
v_mfma_f32_16x16x32_bf16 v[160:163],v[112:115],v[56:59],v[160:163]
v_mov_b32 v175,v51
v_mfma_f32_16x16x32_bf16 v[168:171],v[60:63],v[60:63],v[168:171]
v_mfma_f32_16x16x32_bf16 v[164:167],v[124:127],v[60:63],v[164:167]
v_mfma_f32_16x16x32_bf16 v[160:163],v[120:123],v[60:63],v[160:163]
s_nop 1
s_branch scok_67
nx_69:
s_sub_u32 s90,s90,1
s_cmp_gt_i32 s90,0
s_cbranch_scc1 scp_66
s_nop 7
scok_67:
ds_read_b64 v[220:221],v21
ds_read_b64 v[136:137],v31
ds_read_b64 v[140:141],v31 offset:256
s_cmp_eq_u32 s79,63
s_cbranch_scc1 last0_70
v_max3_f32 v216,v168,v169,v170
v_mov_b32_dpp v160,v164 row_ror:8 row_mask:0xf bank_mask:0xc
v_mov_b32_dpp v161,v165 row_ror:8 row_mask:0xf bank_mask:0xc
v_mov_b32_dpp v162,v166 row_ror:8 row_mask:0xf bank_mask:0xc
v_mov_b32_dpp v163,v167 row_ror:8 row_mask:0xf bank_mask:0xc
v_max3_f32 v217,v171,v160,v161
v_max3_f32 v216,v216,v162,v163
v_max_f32 v216,v216,v217
s_nop 1
v_max_f32_dpp v216,v216,v216 row_ror:8 row_mask:0xf bank_mask:0xf
v_mov_b32 v217,v216
s_nop 1
v_permlane16_swap_b32 v217,v216
v_max_f32 v216,v216,v217
v_mov_b32 v217,v216
s_nop 1
v_permlane32_swap_b32 v217,v216
v_max_f32 v216,v216,v217
v_mul_f32 v216,s81,v216
v_fma_f32 v160,v160,s81,-v216
v_fma_f32 v161,v161,s81,-v216
v_fma_f32 v162,v162,s81,-v216
v_fma_f32 v163,v163,s81,-v216
v_fma_f32 v168,v168,s81,-v216
v_fma_f32 v169,v169,s81,-v216
v_fma_f32 v170,v170,s81,-v216
v_fma_f32 v171,v171,s81,-v216
v_exp_f32 v160,v160
v_exp_f32 v161,v161
v_exp_f32 v162,v162
v_exp_f32 v163,v163
v_exp_f32 v168,v168
v_exp_f32 v169,v169
v_exp_f32 v170,v170
v_exp_f32 v171,v171
v_cvt_pk_bf16_f32 v148,v160,v161
v_cvt_pk_bf16_f32 v149,v162,v163
v_cvt_pk_bf16_f32 v144,v168,v169
v_mov_b32_dpp v150,v148 row_ror:8 row_mask:0xf bank_mask:0xf
v_mov_b32_dpp v151,v149 row_ror:8 row_mask:0xf bank_mask:0xf
v_cvt_pk_bf16_f32 v145,v170,v171
s_waitcnt lgkmcnt(0)
v_min_u32 v220,v220,v221
v_mfma_f32_16x16x32_bf16 v[232:235],v[152:155],v[148:151],0
v_cmp_ne_u32 vcc,v220,v25
v_mfma_f32_16x16x32_bf16 v[232:235],v[152:155],v[144:147],v[232:235]
v_mfma_f32_16x16x32_bf16 v[224:227],v[128:131],v[148:151],0
v_mfma_f32_16x16x32_bf16 v[228:231],v[132:135],v[148:151],0
s_cbranch_vccnz vw_71
vb_72:
v_mfma_f32_16x16x32_bf16 v[224:227],v[136:139],v[144:147],v[224:227]
v_mfma_f32_16x16x32_bf16 v[228:231],v[140:143],v[144:147],v[228:231]
s_mov_b64 exec,s[84:85]
s_nop 1
v_rcp_f32 v236,v232
s_nop 2
v_pk_mul_f32 v[224:225],v[224:225],v[236:237] op_sel_hi:[1,0]
v_pk_mul_f32 v[226:227],v[226:227],v[236:237] op_sel_hi:[1,0]
v_pk_mul_f32 v[228:229],v[228:229],v[236:237] op_sel_hi:[1,0]
v_pk_mul_f32 v[230:231],v[230:231],v[236:237] op_sel_hi:[1,0]
v_cvt_pk_bf16_f32 v216,v224,v225
v_cvt_pk_bf16_f32 v217,v226,v227
v_cvt_pk_bf16_f32 v218,v228,v229
v_cvt_pk_bf16_f32 v219,v230,v231
v_max_u32 v216,1,v216
v_max_u32 v217,1,v217
v_max_u32 v218,1,v218
v_max_u32 v219,1,v219
buffer_store_dwordx4 v[216:219],v30,s[24:27],s71 offen
buffer_store_dwordx4 v[216:219],v30,s[28:31],s71 offen sc1
s_mov_b64 exec,1
buffer_store_dword v25,v13,s[24:27],s70 offen offset:512
buffer_store_dword v25,v13,s[28:31],s70 offen offset:512 sc1
s_mov_b64 exec,-1
ds_write_b32 v21,v25 offset:8
hl_73:
buffer_load_dword v248,v18,s[20:23],s70 offen offset:512 sc1
s_waitcnt vmcnt(0)
v_cmp_eq_u32 vcc,v25,v248
s_bcnt1_i32_b32 s64,vcc_lo
s_cmp_ge_u32 s64,16
s_cbranch_scc1 hg_74
s_sub_u32 s90,s90,1
s_cmp_gt_i32 s90,0
s_cbranch_scc1 hl_73
hg_74:
buffer_load_dwordx4 v[32:35],v26,s[20:23],s71 offen offset:0 sc1
buffer_load_dwordx4 v[36:39],v26,s[20:23],s71 offen offset:1024 sc1
buffer_load_dwordx4 v[40:43],v26,s[20:23],s71 offen offset:2048 sc1
buffer_load_dwordx4 v[44:47],v26,s[20:23],s71 offen offset:3072 sc1
buffer_load_dwordx4 v[48:51],v27,s[20:23],s71 offen offset:0 sc1
buffer_load_dwordx4 v[52:55],v27,s[20:23],s71 offen offset:1024 sc1
buffer_load_dwordx4 v[56:59],v27,s[20:23],s71 offen offset:2048 sc1
buffer_load_dwordx4 v[60:63],v27,s[20:23],s71 offen offset:3072 sc1
s_mov_b32 s68,0
s_waitcnt vmcnt(6)
v_smfmac_f32_16x16x64_bf16 v[184:187],v[32:35],a[128:135],v14
v_min3_u32 v22,v32,v33,v34
v_min3_u32 v22,v22,v35,v36
v_smfmac_f32_16x16x64_bf16 v[188:191],v[32:35],a[136:143],v14
v_min3_u32 v22,v22,v37,v38
v_smfmac_f32_16x16x64_bf16 v[184:187],v[36:39],a[144:151],v14
v_min_u32 v22,v22,v39
v_smfmac_f32_16x16x64_bf16 v[188:191],v[36:39],a[152:159],v14
v_cmp_eq_u32 s[52:53],0,v22
s_waitcnt vmcnt(4)
v_smfmac_f32_16x16x64_bf16 v[184:187],v[40:43],a[160:167],v14
v_min3_u32 v22,v40,v41,v42
s_cmp_lg_u64 s[52:53],0
v_smfmac_f32_16x16x64_bf16 v[188:191],v[40:43],a[168:175],v14
s_cbranch_scc1 ms_75
bk_76:
v_min3_u32 v22,v22,v43,v44
v_smfmac_f32_16x16x64_bf16 v[184:187],v[44:47],a[176:183],v14
v_min3_u32 v22,v22,v45,v46
v_min_u32 v22,v22,v47
v_smfmac_f32_16x16x64_bf16 v[188:191],v[44:47],a[184:191],v14
v_cmp_eq_u32 s[54:55],0,v22
s_waitcnt vmcnt(2)
v_smfmac_f32_16x16x64_bf16 v[184:187],v[48:51],a[192:199],v14
v_min3_u32 v22,v48,v49,v50
s_cmp_lg_u64 s[54:55],0
v_smfmac_f32_16x16x64_bf16 v[188:191],v[48:51],a[200:207],v14
s_cbranch_scc1 ms_77
bk_78:
v_min3_u32 v22,v22,v51,v52
v_smfmac_f32_16x16x64_bf16 v[184:187],v[52:55],a[208:215],v14
v_min3_u32 v22,v22,v53,v54
v_min_u32 v22,v22,v55
v_smfmac_f32_16x16x64_bf16 v[188:191],v[52:55],a[216:223],v14
v_cmp_eq_u32 s[52:53],0,v22
s_waitcnt vmcnt(0)
v_smfmac_f32_16x16x64_bf16 v[184:187],v[56:59],a[224:231],v14
v_min3_u32 v22,v56,v57,v58
s_cmp_lg_u64 s[52:53],0
v_smfmac_f32_16x16x64_bf16 v[188:191],v[56:59],a[232:239],v14
s_cbranch_scc1 ms_79
bk_80:
v_min3_u32 v22,v22,v59,v60
v_smfmac_f32_16x16x64_bf16 v[184:187],v[60:63],a[240:247],v14
v_min3_u32 v22,v22,v61,v62
v_min_u32 v22,v22,v63
v_smfmac_f32_16x16x64_bf16 v[188:191],v[60:63],a[248:255],v14
v_cmp_eq_u32 s[54:55],0,v22
s_cmp_lg_u64 s[54:55],0
s_cbranch_scc1 ms_83
bk_84:
s_cmp_lg_u32 s68,0
s_cbranch_scc1 rl2_85
fin_81:
s_nop 2
v_permlane32_swap_b32 v184,v188
v_permlane32_swap_b32 v185,v189
v_permlane32_swap_b32 v186,v190
v_permlane32_swap_b32 v187,v191
v_pk_add_f32 v[184:185],v[184:185],v[188:189]
v_pk_add_f32 v[186:187],v[186:187],v[190:191]
ds_write_b128 v24,v[184:187] offset:25600
ds_write_b32 v21,v25 offset:12
s_mov_b64 exec,s[84:85]
ds_read_b128 v[172:175],v12
s_mov_b64 exec,-1
buffer_load_dwordx4 v[96:99],v2,s[20:23],s72 offen offset:0 sc1
buffer_load_dwordx4 v[100:103],v2,s[20:23],s72 offen offset:1024 sc1
buffer_load_dwordx4 v[104:107],v5,s[20:23],s72 offen offset:0 sc1
buffer_load_dwordx4 v[108:111],v5,s[20:23],s72 offen offset:1024 sc1
buffer_load_dwordx4 v[112:115],v6,s[20:23],s72 offen offset:0 sc1
buffer_load_dwordx4 v[116:119],v6,s[20:23],s72 offen offset:1024 sc1
buffer_load_dwordx4 v[120:123],v7,s[20:23],s72 offen offset:0 sc1
buffer_load_dwordx4 v[124:127],v7,s[20:23],s72 offen offset:1024 sc1
s_waitcnt lgkmcnt(0)
buffer_store_dwordx4 v[172:175],v3,s[20:23],s77 offen sc1
s_xor_b32 s62,s62,0x10000
s_add_u32 s63,s79,1
s_and_b32 s64,s63,3
s_lshl_b32 s70,s64,20
s_add_u32 s65,s63,2
s_and_b32 s65,s65,3
s_lshl_b32 s73,s65,20
s_add_u32 s55,s63,3
s_lshl_b32 s78,s55,16
s_add_u32 s78,s78,57344
s_cmp_lt_u32 s55,64
s_cselect_b32 s78,s78,0x7fff0000
s_add_u32 s71,s70,65536
s_add_u32 s60,s63,1
s_and_b32 s60,s60,3
s_lshl_b32 s72,s60,20
v_mov_b32 v184,0
v_mov_b32 v185,0
v_mov_b32 v186,0
v_mov_b32 v187,0
v_mov_b32 v188,0
v_mov_b32 v189,0
v_mov_b32 v190,0
v_mov_b32 v191,0
s_lshl_b32 s77,s63,21
s_lshl_b32 s55,s63,13
s_and_b32 s55,s55,0x2000
s_xor_b32 s55,s55,s61
s_add_u32 s77,s77,s55
v_mov_b32 v176,0
v_mov_b32 v177,0
v_mov_b32 v178,0
v_mov_b32 v179,0
s_add_u32 s79,s79,1
v_add_u32 v25,1,v25
s_waitcnt vmcnt(0) lgkmcnt(0)
s_branch loop_58
last0_70:
wf_86:
ds_read_b32 v23,v21 offset:0
s_sub_u32 s90,s90,1
s_waitcnt lgkmcnt(0)
v_cmp_ne_u32 vcc,v23,v25
s_cmp_lt_i32 s90,0
s_cselect_b64 vcc,0,vcc
s_cbranch_vccnz wf_86
wf_87:
ds_read_b32 v23,v21 offset:4
s_sub_u32 s90,s90,1
s_waitcnt lgkmcnt(0)
v_cmp_ne_u32 vcc,v23,v25
s_cmp_lt_i32 s90,0
s_cselect_b64 vcc,0,vcc
s_cbranch_vccnz wf_87
s_mov_b64 exec,s[84:85]
ds_read_b128 v[172:175],v12
s_mov_b64 exec,-1
s_waitcnt lgkmcnt(0)
buffer_store_dwordx4 v[172:175],v3,s[20:23],s77 offen sc1
s_branch end_52
art_62:
s_sub_u32 s90,s90,1
s_cmp_lt_i32 s90,0
s_cbranch_scc1 abk_63
buffer_load_dwordx4 v[32:35],v26,s[20:23],s70 offen offset:0 sc1
buffer_load_dwordx4 v[36:39],v26,s[20:23],s70 offen offset:1024 sc1
buffer_load_dwordx4 v[40:43],v26,s[20:23],s70 offen offset:2048 sc1
buffer_load_dwordx4 v[44:47],v26,s[20:23],s70 offen offset:3072 sc1
s_waitcnt vmcnt(3)
ds_write_b128 v24,v[32:35] offset:0
v_min3_u32 v22,v32,v33,v34
v_min_u32 v22,v22,v35
s_waitcnt vmcnt(2)
ds_write_b128 v24,v[36:39] offset:1024
v_min3_u32 v22,v22,v36,v37
v_min3_u32 v22,v22,v38,v39
s_waitcnt vmcnt(1)
ds_write_b128 v24,v[40:43] offset:2048
v_min3_u32 v22,v22,v40,v41
v_min3_u32 v22,v22,v42,v43
s_waitcnt vmcnt(0)
ds_write_b128 v24,v[44:47] offset:3072
v_min3_u32 v22,v22,v44,v45
v_min3_u32 v22,v22,v46,v47
v_cmp_eq_u32 vcc,0,v22
s_cbranch_vccnz art_62
s_branch abk_63
kt0_64:
buffer_load_dwordx4 v[96:99],v2,s[20:23],s70 offen offset:0 sc1
buffer_load_dwordx4 v[100:103],v2,s[20:23],s70 offen offset:1024 sc1
buffer_load_dwordx4 v[104:107],v5,s[20:23],s70 offen offset:0 sc1
buffer_load_dwordx4 v[108:111],v5,s[20:23],s70 offen offset:1024 sc1
buffer_load_dwordx4 v[112:115],v6,s[20:23],s70 offen offset:0 sc1
buffer_load_dwordx4 v[116:119],v6,s[20:23],s70 offen offset:1024 sc1
buffer_load_dwordx4 v[120:123],v7,s[20:23],s70 offen offset:0 sc1
buffer_load_dwordx4 v[124:127],v7,s[20:23],s70 offen offset:1024 sc1
s_branch kt0b_65
vw_71:
wf_88:
ds_read_b32 v23,v21 offset:0
s_sub_u32 s90,s90,1
s_waitcnt lgkmcnt(0)
v_cmp_ne_u32 vcc,v23,v25
s_cmp_lt_i32 s90,0
s_cselect_b64 vcc,0,vcc
s_cbranch_vccnz wf_88
wf_89:
ds_read_b32 v23,v21 offset:4
s_sub_u32 s90,s90,1
s_waitcnt lgkmcnt(0)
v_cmp_ne_u32 vcc,v23,v25
s_cmp_lt_i32 s90,0
s_cselect_b64 vcc,0,vcc
s_cbranch_vccnz wf_89
ds_read_b64 v[220:221],v21
ds_read_b64 v[136:137],v31
ds_read_b64 v[140:141],v31 offset:256
s_waitcnt lgkmcnt(0)
s_branch vb_72
ms_75:
s_waitcnt vmcnt(0)
buffer_load_dwordx4 v[64:67],v26,s[20:23],s71 offen offset:0 sc1
buffer_load_dwordx4 v[68:71],v26,s[20:23],s71 offen offset:1024 sc1
s_bitset1_b32 s68,0
s_branch bk_76
ms_77:
s_waitcnt vmcnt(0)
buffer_load_dwordx4 v[72:75],v26,s[20:23],s71 offen offset:2048 sc1
buffer_load_dwordx4 v[76:79],v26,s[20:23],s71 offen offset:3072 sc1
s_bitset1_b32 s68,1
s_branch bk_78
ms_79:
s_waitcnt vmcnt(0)
buffer_load_dwordx4 v[80:83],v27,s[20:23],s71 offen offset:0 sc1
buffer_load_dwordx4 v[84:87],v27,s[20:23],s71 offen offset:1024 sc1
s_bitset1_b32 s68,2
s_branch bk_80
ms_83:
s_waitcnt vmcnt(0)
buffer_load_dwordx4 v[88:91],v27,s[20:23],s71 offen offset:2048 sc1
buffer_load_dwordx4 v[92:95],v27,s[20:23],s71 offen offset:3072 sc1
s_bitset1_b32 s68,3
s_branch bk_84
rl_82:
s_bitcmp1_b32 s68,0
s_cbranch_scc0 sk_90
buffer_load_dwordx4 v[64:67],v26,s[20:23],s71 offen offset:0 sc1
buffer_load_dwordx4 v[68:71],v26,s[20:23],s71 offen offset:1024 sc1
sk_90:
s_bitcmp1_b32 s68,1
s_cbranch_scc0 sk_91
buffer_load_dwordx4 v[72:75],v26,s[20:23],s71 offen offset:2048 sc1
buffer_load_dwordx4 v[76:79],v26,s[20:23],s71 offen offset:3072 sc1
sk_91:
s_bitcmp1_b32 s68,2
s_cbranch_scc0 sk_92
buffer_load_dwordx4 v[80:83],v27,s[20:23],s71 offen offset:0 sc1
buffer_load_dwordx4 v[84:87],v27,s[20:23],s71 offen offset:1024 sc1
sk_92:
s_bitcmp1_b32 s68,3
s_cbranch_scc0 sk_93
buffer_load_dwordx4 v[88:91],v27,s[20:23],s71 offen offset:2048 sc1
buffer_load_dwordx4 v[92:95],v27,s[20:23],s71 offen offset:3072 sc1
sk_93:
rl2_85:
s_sub_u32 s90,s90,1
s_cmp_lt_i32 s90,0
s_cbranch_scc1 fin_81
s_waitcnt vmcnt(0)
s_bitcmp1_b32 s68,0
s_cbranch_scc0 sk_94
v_min3_u32 v22,v64,v65,v66
v_min3_u32 v22,v22,v67,v68
v_min3_u32 v22,v22,v69,v70
v_min_u32 v22,v22,v71
v_cmp_eq_u32 vcc,0,v22
v_xor_b32 v64,v32,v64
v_xor_b32 v65,v33,v65
v_xor_b32 v66,v34,v66
v_xor_b32 v67,v35,v67
v_xor_b32 v68,v36,v68
v_xor_b32 v69,v37,v69
v_xor_b32 v70,v38,v70
v_xor_b32 v71,v39,v71
s_cbranch_vccnz nb_95
s_bitset0_b32 s68,0
v_smfmac_f32_16x16x64_bf16 v[184:187],v[64:67],a[128:135],v14
v_smfmac_f32_16x16x64_bf16 v[188:191],v[64:67],a[136:143],v14
v_smfmac_f32_16x16x64_bf16 v[184:187],v[68:71],a[144:151],v14
v_smfmac_f32_16x16x64_bf16 v[188:191],v[68:71],a[152:159],v14
nb_95:
sk_94:
s_bitcmp1_b32 s68,1
s_cbranch_scc0 sk_96
v_min3_u32 v22,v72,v73,v74
v_min3_u32 v22,v22,v75,v76
v_min3_u32 v22,v22,v77,v78
v_min_u32 v22,v22,v79
v_cmp_eq_u32 vcc,0,v22
v_xor_b32 v72,v40,v72
v_xor_b32 v73,v41,v73
v_xor_b32 v74,v42,v74
v_xor_b32 v75,v43,v75
v_xor_b32 v76,v44,v76
v_xor_b32 v77,v45,v77
v_xor_b32 v78,v46,v78
v_xor_b32 v79,v47,v79
s_cbranch_vccnz nb_97
s_bitset0_b32 s68,1
v_smfmac_f32_16x16x64_bf16 v[184:187],v[72:75],a[160:167],v14
v_smfmac_f32_16x16x64_bf16 v[188:191],v[72:75],a[168:175],v14
v_smfmac_f32_16x16x64_bf16 v[184:187],v[76:79],a[176:183],v14
v_smfmac_f32_16x16x64_bf16 v[188:191],v[76:79],a[184:191],v14
nb_97:
sk_96:
s_bitcmp1_b32 s68,2
s_cbranch_scc0 sk_98
v_min3_u32 v22,v80,v81,v82
v_min3_u32 v22,v22,v83,v84
v_min3_u32 v22,v22,v85,v86
v_min_u32 v22,v22,v87
v_cmp_eq_u32 vcc,0,v22
v_xor_b32 v80,v48,v80
v_xor_b32 v81,v49,v81
v_xor_b32 v82,v50,v82
v_xor_b32 v83,v51,v83
v_xor_b32 v84,v52,v84
v_xor_b32 v85,v53,v85
v_xor_b32 v86,v54,v86
v_xor_b32 v87,v55,v87
s_cbranch_vccnz nb_99
s_bitset0_b32 s68,2
v_smfmac_f32_16x16x64_bf16 v[184:187],v[80:83],a[192:199],v14
v_smfmac_f32_16x16x64_bf16 v[188:191],v[80:83],a[200:207],v14
v_smfmac_f32_16x16x64_bf16 v[184:187],v[84:87],a[208:215],v14
v_smfmac_f32_16x16x64_bf16 v[188:191],v[84:87],a[216:223],v14
nb_99:
sk_98:
s_bitcmp1_b32 s68,3
s_cbranch_scc0 sk_100
v_min3_u32 v22,v88,v89,v90
v_min3_u32 v22,v22,v91,v92
v_min3_u32 v22,v22,v93,v94
v_min_u32 v22,v22,v95
v_cmp_eq_u32 vcc,0,v22
v_xor_b32 v88,v56,v88
v_xor_b32 v89,v57,v89
v_xor_b32 v90,v58,v90
v_xor_b32 v91,v59,v91
v_xor_b32 v92,v60,v92
v_xor_b32 v93,v61,v93
v_xor_b32 v94,v62,v94
v_xor_b32 v95,v63,v95
s_cbranch_vccnz nb_101
s_bitset0_b32 s68,3
v_smfmac_f32_16x16x64_bf16 v[184:187],v[88:91],a[224:231],v14
v_smfmac_f32_16x16x64_bf16 v[188:191],v[88:91],a[232:239],v14
v_smfmac_f32_16x16x64_bf16 v[184:187],v[92:95],a[240:247],v14
v_smfmac_f32_16x16x64_bf16 v[188:191],v[92:95],a[248:255],v14
nb_101:
sk_100:
s_cmp_lg_u32 s68,0
s_cbranch_scc1 rl_82
s_nop 2
s_branch fin_81
first_57:
s_waitcnt vmcnt(0) lgkmcnt(0)
s_barrier
s_barrier
s_mov_b32 m0,0
s_mov_b32 s65,188416
buffer_load_dwordx4 v16,s[20:23],s65 offen offset:0 lds
buffer_load_dwordx4 v16,s[20:23],s65 offen offset:1024 lds
buffer_load_dwordx4 v16,s[20:23],s65 offen offset:2048 lds
buffer_load_dwordx4 v16,s[20:23],s65 offen offset:3072 lds
s_mov_b32 m0,4096
s_mov_b32 s65,192512
buffer_load_dwordx4 v16,s[20:23],s65 offen offset:0 lds
buffer_load_dwordx4 v16,s[20:23],s65 offen offset:1024 lds
buffer_load_dwordx4 v16,s[20:23],s65 offen offset:2048 lds
buffer_load_dwordx4 v16,s[20:23],s65 offen offset:3072 lds
s_mov_b32 m0,8192
s_mov_b32 s65,196608
buffer_load_dwordx4 v16,s[20:23],s65 offen offset:0 lds
buffer_load_dwordx4 v16,s[20:23],s65 offen offset:1024 lds
buffer_load_dwordx4 v16,s[20:23],s65 offen offset:2048 lds
buffer_load_dwordx4 v16,s[20:23],s65 offen offset:3072 lds
s_mov_b32 m0,12288
s_mov_b32 s65,200704
buffer_load_dwordx4 v16,s[20:23],s65 offen offset:0 lds
buffer_load_dwordx4 v16,s[20:23],s65 offen offset:1024 lds
buffer_load_dwordx4 v16,s[20:23],s65 offen offset:2048 lds
buffer_load_dwordx4 v16,s[20:23],s65 offen offset:3072 lds
s_mov_b32 m0,16384
s_mov_b32 s65,204800
buffer_load_dwordx4 v16,s[20:23],s65 offen offset:0 lds
buffer_load_dwordx4 v16,s[20:23],s65 offen offset:1024 lds
buffer_load_dwordx4 v16,s[20:23],s65 offen offset:2048 lds
buffer_load_dwordx4 v16,s[20:23],s65 offen offset:3072 lds
s_mov_b32 m0,20480
s_mov_b32 s65,208896
buffer_load_dwordx4 v16,s[20:23],s65 offen offset:0 lds
buffer_load_dwordx4 v16,s[20:23],s65 offen offset:1024 lds
buffer_load_dwordx4 v16,s[20:23],s65 offen offset:2048 lds
buffer_load_dwordx4 v16,s[20:23],s65 offen offset:3072 lds
s_mov_b32 m0,24576
s_mov_b32 s65,212992
buffer_load_dwordx4 v16,s[20:23],s65 offen offset:0 lds
buffer_load_dwordx4 v16,s[20:23],s65 offen offset:1024 lds
buffer_load_dwordx4 v16,s[20:23],s65 offen offset:2048 lds
buffer_load_dwordx4 v16,s[20:23],s65 offen offset:3072 lds
s_mov_b32 m0,28672
s_mov_b32 s65,217088
buffer_load_dwordx4 v16,s[20:23],s65 offen offset:0 lds
buffer_load_dwordx4 v16,s[20:23],s65 offen offset:1024 lds
buffer_load_dwordx4 v16,s[20:23],s65 offen offset:2048 lds
buffer_load_dwordx4 v16,s[20:23],s65 offen offset:3072 lds
s_mov_b32 s79,0
s_add_u32 s63,s79,0
s_and_b32 s64,s63,3
s_lshl_b32 s70,s64,20
s_add_u32 s65,s63,2
s_and_b32 s65,s65,3
s_lshl_b32 s73,s65,20
s_add_u32 s55,s63,3
s_lshl_b32 s78,s55,16
s_add_u32 s78,s78,57344
s_cmp_lt_u32 s55,64
s_cselect_b32 s78,s78,0x7fff0000
s_add_u32 s71,s70,65536
s_add_u32 s60,s63,1
s_and_b32 s60,s60,3
s_lshl_b32 s72,s60,20
v_mov_b32 v184,0
v_mov_b32 v185,0
v_mov_b32 v186,0
v_mov_b32 v187,0
v_mov_b32 v188,0
v_mov_b32 v189,0
v_mov_b32 v190,0
v_mov_b32 v191,0
s_lshl_b32 s77,s63,21
s_lshl_b32 s55,s63,13
s_and_b32 s55,s55,0x2000
s_xor_b32 s55,s55,s61
s_add_u32 s77,s77,s55
v_mov_b32 v176,0
v_mov_b32 v177,0
v_mov_b32 v178,0
v_mov_b32 v179,0
v_mov_b32 v25,1
s_waitcnt vmcnt(0) lgkmcnt(0)
s_barrier
s_branch loop_58
w1_54:
s_lshr_b32 s64,s57,2
s_add_u32 s64,s64,64
s_lshl_b32 s64,s64,14
s_add_u32 s64,s64,s68
s_add_u32 s64,s64,29360128
v_add_u32 v12,s64,v16
v_and_b32 v22,1,v4
v_lshrrev_b32 v23,1,v4
v_lshl_add_u32 v22,v22,1,v23
v_lshlrev_b32 v22,2,v22
v_lshl_add_u32 v22,v3,4,v22
v_add_u32 v31,155648,v22
v_add_u32 v8,s66,v16
v_add_u32 v9,s67,v16
v_mov_b32 v10,1792
v_mov_b32 v11,0
s_branch first_102
loop_103:
s_barrier
buffer_load_dword v248,v18,s[20:23],s70 offen offset:0 sc1
s_nop 15
s_nop 5
hl_105:
buffer_load_dword v249,v18,s[20:23],s70 offen offset:0 sc1
s_waitcnt vmcnt(1)
v_cmp_eq_u32 vcc,v25,v248
s_bcnt1_i32_b32 s64,vcc_lo
s_cmp_ge_u32 s64,8
s_cbranch_scc1 hg_106
buffer_load_dword v248,v18,s[20:23],s70 offen offset:0 sc1
s_waitcnt vmcnt(1)
v_cmp_eq_u32 vcc,v25,v249
s_bcnt1_i32_b32 s64,vcc_lo
s_cmp_ge_u32 s64,8
s_cbranch_scc1 hg_106
s_sub_u32 s90,s90,1
s_cmp_gt_i32 s90,0
s_cbranch_scc1 hl_105
hg_106:
buffer_load_dwordx4 v[48:51],v27,s[20:23],s70 offen offset:0 sc1
buffer_load_dwordx4 v[52:55],v27,s[20:23],s70 offen offset:1024 sc1
buffer_load_dwordx4 v[56:59],v27,s[20:23],s70 offen offset:2048 sc1
buffer_load_dwordx4 v[60:63],v27,s[20:23],s70 offen offset:3072 sc1
s_waitcnt vmcnt(3)
ds_write_b128 v24,v[48:51] offset:4096
v_min3_u32 v22,v48,v49,v50
v_min_u32 v22,v22,v51
s_waitcnt vmcnt(2)
ds_write_b128 v24,v[52:55] offset:5120
v_min3_u32 v22,v22,v52,v53
v_min3_u32 v22,v22,v54,v55
s_waitcnt vmcnt(1)
ds_write_b128 v24,v[56:59] offset:6144
v_min3_u32 v22,v22,v56,v57
v_min3_u32 v22,v22,v58,v59
s_waitcnt vmcnt(0)
ds_write_b128 v24,v[60:63] offset:7168
v_min3_u32 v22,v22,v60,v61
v_min3_u32 v22,v22,v62,v63
v_cmp_eq_u32 vcc,0,v22
s_cbranch_vccnz art_107
abk_108:
v_smfmac_f32_16x16x64_bf16 v[176:179],v[48:51],a[32:39],v14
s_waitcnt lgkmcnt(0)
s_barrier
ds_read_b128 v[64:67],v24 offset:8192
ds_read_b128 v[68:71],v24 offset:9216
ds_read_b128 v[72:75],v24 offset:10240
ds_read_b128 v[76:79],v24 offset:11264
buffer_store_dwordx4 v[212:215],v12,s[20:23],s76 offen sc1
v_smfmac_f32_16x16x64_bf16 v[176:179],v[52:55],a[40:47],v14
ds_read_b128 v[80:83],v24 offset:12288
ds_read_b128 v[84:87],v24 offset:13312
v_smfmac_f32_16x16x64_bf16 v[176:179],v[56:59],a[48:55],v14
ds_read_b128 v[88:91],v24 offset:14336
ds_read_b128 v[92:95],v24 offset:15360
v_smfmac_f32_16x16x64_bf16 v[176:179],v[60:63],a[56:63],v14
ds_read_b128 v[32:35],v24 offset:0
ds_read_b128 v[36:39],v24 offset:1024
s_waitcnt lgkmcnt(9)
v_smfmac_f32_16x16x64_bf16 v[176:179],v[64:67],a[64:71],v14
ds_read_b128 v[40:43],v24 offset:2048
s_waitcnt lgkmcnt(9)
v_smfmac_f32_16x16x64_bf16 v[176:179],v[68:71],a[72:79],v14
ds_read_b128 v[44:47],v24 offset:3072
s_waitcnt lgkmcnt(9)
v_smfmac_f32_16x16x64_bf16 v[176:179],v[72:75],a[80:87],v14
s_waitcnt lgkmcnt(8)
v_smfmac_f32_16x16x64_bf16 v[176:179],v[76:79],a[88:95],v14
s_waitcnt lgkmcnt(7)
v_smfmac_f32_16x16x64_bf16 v[176:179],v[80:83],a[96:103],v14
s_waitcnt lgkmcnt(6)
v_smfmac_f32_16x16x64_bf16 v[176:179],v[84:87],a[104:111],v14
s_waitcnt lgkmcnt(5)
v_smfmac_f32_16x16x64_bf16 v[176:179],v[88:91],a[112:119],v14
s_waitcnt lgkmcnt(4)
v_smfmac_f32_16x16x64_bf16 v[176:179],v[92:95],a[120:127],v14
s_waitcnt lgkmcnt(3)
v_smfmac_f32_16x16x64_bf16 v[176:179],v[32:35],a[0:7],v14
s_waitcnt lgkmcnt(2)
v_smfmac_f32_16x16x64_bf16 v[176:179],v[36:39],a[8:15],v14
s_waitcnt lgkmcnt(1)
v_smfmac_f32_16x16x64_bf16 v[176:179],v[40:43],a[16:23],v14
s_waitcnt lgkmcnt(0)
v_smfmac_f32_16x16x64_bf16 v[176:179],v[44:47],a[24:31],v14
v_smfmac_f32_16x16x64_bf16 v[180:183],v[32:35],a[128:135],v14
v_smfmac_f32_16x16x64_bf16 v[180:183],v[36:39],a[136:143],v14
s_nop 5
v_permlane32_swap_b32 v176,v178
v_permlane32_swap_b32 v177,v179
v_add_f32 v176,v176,v178
v_add_f32 v177,v177,v179
v_cvt_pk_bf16_f32 v216,v176,v177
s_nop 1
v_mov_b32_dpp v217,v216 quad_perm:[1,0,3,2] row_mask:0xf bank_mask:0xf
v_perm_b32 v216,v217,v216,v15
v_max_u32 v216,1,v216
buffer_store_dword v216,v19,s[24:27],s70 offen
buffer_store_dword v216,v19,s[28:31],s70 offen sc1
v_smfmac_f32_16x16x64_bf16 v[180:183],v[40:43],a[144:151],v14
v_smfmac_f32_16x16x64_bf16 v[180:183],v[44:47],a[152:159],v14
v_smfmac_f32_16x16x64_bf16 v[180:183],v[48:51],a[160:167],v14
v_smfmac_f32_16x16x64_bf16 v[180:183],v[52:55],a[168:175],v14
v_smfmac_f32_16x16x64_bf16 v[180:183],v[56:59],a[176:183],v14
v_smfmac_f32_16x16x64_bf16 v[180:183],v[60:63],a[184:191],v14
v_smfmac_f32_16x16x64_bf16 v[180:183],v[64:67],a[192:199],v14
v_smfmac_f32_16x16x64_bf16 v[180:183],v[68:71],a[200:207],v14
v_smfmac_f32_16x16x64_bf16 v[180:183],v[72:75],a[208:215],v14
v_smfmac_f32_16x16x64_bf16 v[180:183],v[76:79],a[216:223],v14
v_smfmac_f32_16x16x64_bf16 v[180:183],v[80:83],a[224:231],v14
v_smfmac_f32_16x16x64_bf16 v[180:183],v[84:87],a[232:239],v14
v_smfmac_f32_16x16x64_bf16 v[180:183],v[88:91],a[240:247],v14
v_smfmac_f32_16x16x64_bf16 v[180:183],v[92:95],a[248:255],v14
s_nop 7
v_permlane32_swap_b32 v180,v182
v_permlane32_swap_b32 v181,v183
v_add_f32 v180,v180,v182
v_add_f32 v181,v181,v183
v_cvt_pk_bf16_f32 v216,v180,v181
v_max_u32 v216,1,v216
ds_write_b32 v31,v216
ds_write_b32 v21,v25 offset:0
s_cmp_eq_u32 s79,63
s_cbranch_scc1 end_52
s_cmp_ge_i32 s79,62
s_cbranch_scc1 bgx_110
bge_109:
ds_read_b128 v[64:67],v20 offset:0
ds_read_b128 v[68:71],v20 offset:1024
ds_read_b128 v[72:75],v20 offset:2048
s_waitcnt lgkmcnt(2)
v_mfma_f32_16x16x32_bf16 v[192:195],a[0:3],v[64:67],0
ds_read_b128 v[76:79],v20 offset:3072
v_mfma_f32_16x16x32_bf16 v[200:203],v[64:67],a[128:131],0
s_waitcnt lgkmcnt(2)
v_mfma_f32_16x16x32_bf16 v[196:199],a[0:3],v[68:71],0
ds_read_b128 v[64:67],v20 offset:4096
v_mfma_f32_16x16x32_bf16 v[204:207],v[68:71],a[128:131],0
s_waitcnt lgkmcnt(2)
v_mfma_f32_16x16x32_bf16 v[192:195],a[4:7],v[72:75],v[192:195]
ds_read_b128 v[68:71],v20 offset:5120
v_mfma_f32_16x16x32_bf16 v[200:203],v[72:75],a[132:135],v[200:203]
s_waitcnt lgkmcnt(2)
v_mfma_f32_16x16x32_bf16 v[196:199],a[4:7],v[76:79],v[196:199]
ds_read_b128 v[72:75],v20 offset:6144
v_mfma_f32_16x16x32_bf16 v[204:207],v[76:79],a[132:135],v[204:207]
s_waitcnt lgkmcnt(2)
v_mfma_f32_16x16x32_bf16 v[192:195],a[8:11],v[64:67],v[192:195]
ds_read_b128 v[76:79],v20 offset:7168
v_mfma_f32_16x16x32_bf16 v[200:203],v[64:67],a[136:139],v[200:203]
s_waitcnt lgkmcnt(2)
v_mfma_f32_16x16x32_bf16 v[196:199],a[8:11],v[68:71],v[196:199]
ds_read_b128 v[64:67],v20 offset:8192
v_mfma_f32_16x16x32_bf16 v[204:207],v[68:71],a[136:139],v[204:207]
s_waitcnt lgkmcnt(2)
v_mfma_f32_16x16x32_bf16 v[192:195],a[12:15],v[72:75],v[192:195]
ds_read_b128 v[68:71],v20 offset:9216
v_mfma_f32_16x16x32_bf16 v[200:203],v[72:75],a[140:143],v[200:203]
s_waitcnt lgkmcnt(2)
v_mfma_f32_16x16x32_bf16 v[196:199],a[12:15],v[76:79],v[196:199]
ds_read_b128 v[72:75],v20 offset:10240
v_mfma_f32_16x16x32_bf16 v[204:207],v[76:79],a[140:143],v[204:207]
s_add_u32 m0,s62,0
s_add_u32 s69,s78,0
s_waitcnt lgkmcnt(2)
v_mfma_f32_16x16x32_bf16 v[192:195],a[16:19],v[64:67],v[192:195]
ds_read_b128 v[76:79],v20 offset:11264
v_mfma_f32_16x16x32_bf16 v[200:203],v[64:67],a[144:147],v[200:203]
buffer_load_dwordx4 v16,s[20:23],s69 offen offset:0 lds
s_waitcnt lgkmcnt(2)
v_mfma_f32_16x16x32_bf16 v[196:199],a[16:19],v[68:71],v[196:199]
ds_read_b128 v[64:67],v20 offset:12288
v_mfma_f32_16x16x32_bf16 v[204:207],v[68:71],a[144:147],v[204:207]
buffer_load_dwordx4 v16,s[20:23],s69 offen offset:1024 lds
s_waitcnt lgkmcnt(2)
v_mfma_f32_16x16x32_bf16 v[192:195],a[20:23],v[72:75],v[192:195]
ds_read_b128 v[68:71],v20 offset:13312
v_mfma_f32_16x16x32_bf16 v[200:203],v[72:75],a[148:151],v[200:203]
buffer_load_dwordx4 v16,s[20:23],s69 offen offset:2048 lds
s_waitcnt lgkmcnt(2)
v_mfma_f32_16x16x32_bf16 v[196:199],a[20:23],v[76:79],v[196:199]
ds_read_b128 v[72:75],v20 offset:14336
v_mfma_f32_16x16x32_bf16 v[204:207],v[76:79],a[148:151],v[204:207]
buffer_load_dwordx4 v16,s[20:23],s69 offen offset:3072 lds
s_waitcnt lgkmcnt(2)
v_mfma_f32_16x16x32_bf16 v[192:195],a[24:27],v[64:67],v[192:195]
ds_read_b128 v[76:79],v20 offset:15360
v_mfma_f32_16x16x32_bf16 v[200:203],v[64:67],a[152:155],v[200:203]
s_add_u32 m0,s62,4096
s_add_u32 s69,s78,4096
s_waitcnt lgkmcnt(2)
v_mfma_f32_16x16x32_bf16 v[196:199],a[24:27],v[68:71],v[196:199]
ds_read_b128 v[64:67],v20 offset:16384
v_mfma_f32_16x16x32_bf16 v[204:207],v[68:71],a[152:155],v[204:207]
buffer_load_dwordx4 v16,s[20:23],s69 offen offset:0 lds
s_waitcnt lgkmcnt(2)
v_mfma_f32_16x16x32_bf16 v[192:195],a[28:31],v[72:75],v[192:195]
ds_read_b128 v[68:71],v20 offset:17408
v_mfma_f32_16x16x32_bf16 v[200:203],v[72:75],a[156:159],v[200:203]
buffer_load_dwordx4 v16,s[20:23],s69 offen offset:1024 lds
s_waitcnt lgkmcnt(2)
v_mfma_f32_16x16x32_bf16 v[196:199],a[28:31],v[76:79],v[196:199]
ds_read_b128 v[72:75],v20 offset:18432
v_mfma_f32_16x16x32_bf16 v[204:207],v[76:79],a[156:159],v[204:207]
buffer_load_dwordx4 v16,s[20:23],s69 offen offset:2048 lds
s_waitcnt lgkmcnt(2)
v_mfma_f32_16x16x32_bf16 v[192:195],a[32:35],v[64:67],v[192:195]
ds_read_b128 v[76:79],v20 offset:19456
v_mfma_f32_16x16x32_bf16 v[200:203],v[64:67],a[160:163],v[200:203]
buffer_load_dwordx4 v16,s[20:23],s69 offen offset:3072 lds
s_waitcnt lgkmcnt(2)
v_mfma_f32_16x16x32_bf16 v[196:199],a[32:35],v[68:71],v[196:199]
ds_read_b128 v[64:67],v20 offset:20480
v_mfma_f32_16x16x32_bf16 v[204:207],v[68:71],a[160:163],v[204:207]
s_add_u32 m0,s62,8192
s_add_u32 s69,s78,8192
s_waitcnt lgkmcnt(2)
v_mfma_f32_16x16x32_bf16 v[192:195],a[36:39],v[72:75],v[192:195]
ds_read_b128 v[68:71],v20 offset:21504
v_mfma_f32_16x16x32_bf16 v[200:203],v[72:75],a[164:167],v[200:203]
buffer_load_dwordx4 v16,s[20:23],s69 offen offset:0 lds
s_waitcnt lgkmcnt(2)
v_mfma_f32_16x16x32_bf16 v[196:199],a[36:39],v[76:79],v[196:199]
ds_read_b128 v[72:75],v20 offset:22528
v_mfma_f32_16x16x32_bf16 v[204:207],v[76:79],a[164:167],v[204:207]
buffer_load_dwordx4 v16,s[20:23],s69 offen offset:1024 lds
s_waitcnt lgkmcnt(2)
v_mfma_f32_16x16x32_bf16 v[192:195],a[40:43],v[64:67],v[192:195]
ds_read_b128 v[76:79],v20 offset:23552
v_mfma_f32_16x16x32_bf16 v[200:203],v[64:67],a[168:171],v[200:203]
buffer_load_dwordx4 v16,s[20:23],s69 offen offset:2048 lds
s_waitcnt lgkmcnt(2)
v_mfma_f32_16x16x32_bf16 v[196:199],a[40:43],v[68:71],v[196:199]
ds_read_b128 v[64:67],v20 offset:24576
v_mfma_f32_16x16x32_bf16 v[204:207],v[68:71],a[168:171],v[204:207]
buffer_load_dwordx4 v16,s[20:23],s69 offen offset:3072 lds
s_waitcnt lgkmcnt(2)
v_mfma_f32_16x16x32_bf16 v[192:195],a[44:47],v[72:75],v[192:195]
ds_read_b128 v[68:71],v20 offset:25600
v_mfma_f32_16x16x32_bf16 v[200:203],v[72:75],a[172:175],v[200:203]
s_add_u32 m0,s62,12288
s_add_u32 s69,s78,12288
s_waitcnt lgkmcnt(2)
v_mfma_f32_16x16x32_bf16 v[196:199],a[44:47],v[76:79],v[196:199]
ds_read_b128 v[72:75],v20 offset:26624
v_mfma_f32_16x16x32_bf16 v[204:207],v[76:79],a[172:175],v[204:207]
buffer_load_dwordx4 v16,s[20:23],s69 offen offset:0 lds
s_waitcnt lgkmcnt(2)
v_mfma_f32_16x16x32_bf16 v[192:195],a[48:51],v[64:67],v[192:195]
ds_read_b128 v[76:79],v20 offset:27648
v_mfma_f32_16x16x32_bf16 v[200:203],v[64:67],a[176:179],v[200:203]
buffer_load_dwordx4 v16,s[20:23],s69 offen offset:1024 lds
s_waitcnt lgkmcnt(2)
v_mfma_f32_16x16x32_bf16 v[196:199],a[48:51],v[68:71],v[196:199]
ds_read_b128 v[64:67],v20 offset:28672
v_mfma_f32_16x16x32_bf16 v[204:207],v[68:71],a[176:179],v[204:207]
buffer_load_dwordx4 v16,s[20:23],s69 offen offset:2048 lds
s_waitcnt lgkmcnt(2)
v_mfma_f32_16x16x32_bf16 v[192:195],a[52:55],v[72:75],v[192:195]
ds_read_b128 v[68:71],v20 offset:29696
v_mfma_f32_16x16x32_bf16 v[200:203],v[72:75],a[180:183],v[200:203]
buffer_load_dwordx4 v16,s[20:23],s69 offen offset:3072 lds
s_waitcnt lgkmcnt(2)
v_mfma_f32_16x16x32_bf16 v[196:199],a[52:55],v[76:79],v[196:199]
ds_read_b128 v[72:75],v20 offset:30720
v_mfma_f32_16x16x32_bf16 v[204:207],v[76:79],a[180:183],v[204:207]
s_waitcnt lgkmcnt(2)
v_mfma_f32_16x16x32_bf16 v[192:195],a[56:59],v[64:67],v[192:195]
ds_read_b128 v[76:79],v20 offset:31744
v_mfma_f32_16x16x32_bf16 v[200:203],v[64:67],a[184:187],v[200:203]
s_waitcnt lgkmcnt(2)
v_mfma_f32_16x16x32_bf16 v[196:199],a[56:59],v[68:71],v[196:199]
ds_read_b128 v[64:67],v20 offset:32768
v_mfma_f32_16x16x32_bf16 v[204:207],v[68:71],a[184:187],v[204:207]
s_waitcnt lgkmcnt(2)
v_mfma_f32_16x16x32_bf16 v[192:195],a[60:63],v[72:75],v[192:195]
ds_read_b128 v[68:71],v20 offset:33792
v_mfma_f32_16x16x32_bf16 v[200:203],v[72:75],a[188:191],v[200:203]
s_waitcnt lgkmcnt(2)
v_mfma_f32_16x16x32_bf16 v[196:199],a[60:63],v[76:79],v[196:199]
ds_read_b128 v[72:75],v20 offset:34816
v_mfma_f32_16x16x32_bf16 v[204:207],v[76:79],a[188:191],v[204:207]
s_waitcnt lgkmcnt(2)
v_mfma_f32_16x16x32_bf16 v[192:195],a[64:67],v[64:67],v[192:195]
ds_read_b128 v[76:79],v20 offset:35840
v_mfma_f32_16x16x32_bf16 v[200:203],v[64:67],a[192:195],v[200:203]
s_waitcnt lgkmcnt(2)
v_mfma_f32_16x16x32_bf16 v[196:199],a[64:67],v[68:71],v[196:199]
ds_read_b128 v[64:67],v20 offset:36864
v_mfma_f32_16x16x32_bf16 v[204:207],v[68:71],a[192:195],v[204:207]
s_waitcnt lgkmcnt(2)
v_mfma_f32_16x16x32_bf16 v[192:195],a[68:71],v[72:75],v[192:195]
ds_read_b128 v[68:71],v20 offset:37888
v_mfma_f32_16x16x32_bf16 v[200:203],v[72:75],a[196:199],v[200:203]
s_waitcnt lgkmcnt(2)
v_mfma_f32_16x16x32_bf16 v[196:199],a[68:71],v[76:79],v[196:199]
ds_read_b128 v[72:75],v20 offset:38912
v_mfma_f32_16x16x32_bf16 v[204:207],v[76:79],a[196:199],v[204:207]
s_waitcnt lgkmcnt(2)
v_mfma_f32_16x16x32_bf16 v[192:195],a[72:75],v[64:67],v[192:195]
ds_read_b128 v[76:79],v20 offset:39936
v_mfma_f32_16x16x32_bf16 v[200:203],v[64:67],a[200:203],v[200:203]
s_waitcnt lgkmcnt(2)
v_mfma_f32_16x16x32_bf16 v[196:199],a[72:75],v[68:71],v[196:199]
ds_read_b128 v[64:67],v20 offset:40960
v_mfma_f32_16x16x32_bf16 v[204:207],v[68:71],a[200:203],v[204:207]
s_waitcnt lgkmcnt(2)
v_mfma_f32_16x16x32_bf16 v[192:195],a[76:79],v[72:75],v[192:195]
ds_read_b128 v[68:71],v20 offset:41984
v_mfma_f32_16x16x32_bf16 v[200:203],v[72:75],a[204:207],v[200:203]
s_waitcnt lgkmcnt(2)
v_mfma_f32_16x16x32_bf16 v[196:199],a[76:79],v[76:79],v[196:199]
ds_read_b128 v[72:75],v20 offset:43008
v_mfma_f32_16x16x32_bf16 v[204:207],v[76:79],a[204:207],v[204:207]
s_waitcnt lgkmcnt(2)
v_mfma_f32_16x16x32_bf16 v[192:195],a[80:83],v[64:67],v[192:195]
ds_read_b128 v[76:79],v20 offset:44032
v_mfma_f32_16x16x32_bf16 v[200:203],v[64:67],a[208:211],v[200:203]
s_waitcnt lgkmcnt(2)
v_mfma_f32_16x16x32_bf16 v[196:199],a[80:83],v[68:71],v[196:199]
ds_read_b128 v[64:67],v20 offset:45056
v_mfma_f32_16x16x32_bf16 v[204:207],v[68:71],a[208:211],v[204:207]
s_waitcnt lgkmcnt(2)
v_mfma_f32_16x16x32_bf16 v[192:195],a[84:87],v[72:75],v[192:195]
ds_read_b128 v[68:71],v20 offset:46080
v_mfma_f32_16x16x32_bf16 v[200:203],v[72:75],a[212:215],v[200:203]
s_waitcnt lgkmcnt(2)
v_mfma_f32_16x16x32_bf16 v[196:199],a[84:87],v[76:79],v[196:199]
ds_read_b128 v[72:75],v20 offset:47104
v_mfma_f32_16x16x32_bf16 v[204:207],v[76:79],a[212:215],v[204:207]
s_waitcnt lgkmcnt(2)
v_mfma_f32_16x16x32_bf16 v[192:195],a[88:91],v[64:67],v[192:195]
ds_read_b128 v[76:79],v20 offset:48128
v_mfma_f32_16x16x32_bf16 v[200:203],v[64:67],a[216:219],v[200:203]
s_waitcnt lgkmcnt(2)
v_mfma_f32_16x16x32_bf16 v[196:199],a[88:91],v[68:71],v[196:199]
ds_read_b128 v[64:67],v20 offset:49152
v_mfma_f32_16x16x32_bf16 v[204:207],v[68:71],a[216:219],v[204:207]
s_waitcnt lgkmcnt(2)
v_mfma_f32_16x16x32_bf16 v[192:195],a[92:95],v[72:75],v[192:195]
ds_read_b128 v[68:71],v20 offset:50176
v_mfma_f32_16x16x32_bf16 v[200:203],v[72:75],a[220:223],v[200:203]
s_waitcnt lgkmcnt(2)
v_mfma_f32_16x16x32_bf16 v[196:199],a[92:95],v[76:79],v[196:199]
ds_read_b128 v[72:75],v20 offset:51200
v_mfma_f32_16x16x32_bf16 v[204:207],v[76:79],a[220:223],v[204:207]
s_waitcnt lgkmcnt(2)
v_mfma_f32_16x16x32_bf16 v[192:195],a[96:99],v[64:67],v[192:195]
ds_read_b128 v[76:79],v20 offset:52224
v_mfma_f32_16x16x32_bf16 v[200:203],v[64:67],a[224:227],v[200:203]
s_waitcnt lgkmcnt(2)
v_mfma_f32_16x16x32_bf16 v[196:199],a[96:99],v[68:71],v[196:199]
ds_read_b128 v[64:67],v20 offset:53248
v_mfma_f32_16x16x32_bf16 v[204:207],v[68:71],a[224:227],v[204:207]
s_waitcnt lgkmcnt(2)
v_mfma_f32_16x16x32_bf16 v[192:195],a[100:103],v[72:75],v[192:195]
ds_read_b128 v[68:71],v20 offset:54272
s_add_u32 m0,s62,32768
s_add_u32 s69,s78,32768
v_mfma_f32_16x16x32_bf16 v[200:203],v[72:75],a[228:231],v[200:203]
s_waitcnt lgkmcnt(2)
v_mfma_f32_16x16x32_bf16 v[196:199],a[100:103],v[76:79],v[196:199]
ds_read_b128 v[72:75],v20 offset:55296
buffer_load_dwordx4 v16,s[20:23],s69 offen offset:0 lds
v_mfma_f32_16x16x32_bf16 v[204:207],v[76:79],a[228:231],v[204:207]
s_waitcnt lgkmcnt(2)
v_mfma_f32_16x16x32_bf16 v[192:195],a[104:107],v[64:67],v[192:195]
ds_read_b128 v[76:79],v20 offset:56320
buffer_load_dwordx4 v16,s[20:23],s69 offen offset:1024 lds
v_mfma_f32_16x16x32_bf16 v[200:203],v[64:67],a[232:235],v[200:203]
s_waitcnt lgkmcnt(2)
v_mfma_f32_16x16x32_bf16 v[196:199],a[104:107],v[68:71],v[196:199]
ds_read_b128 v[64:67],v20 offset:57344
buffer_load_dwordx4 v16,s[20:23],s69 offen offset:2048 lds
v_mfma_f32_16x16x32_bf16 v[204:207],v[68:71],a[232:235],v[204:207]
s_waitcnt lgkmcnt(2)
v_mfma_f32_16x16x32_bf16 v[192:195],a[108:111],v[72:75],v[192:195]
ds_read_b128 v[68:71],v20 offset:58368
buffer_load_dwordx4 v16,s[20:23],s69 offen offset:3072 lds
v_mfma_f32_16x16x32_bf16 v[200:203],v[72:75],a[236:239],v[200:203]
s_waitcnt lgkmcnt(2)
v_mfma_f32_16x16x32_bf16 v[196:199],a[108:111],v[76:79],v[196:199]
ds_read_b128 v[72:75],v20 offset:59392
s_add_u32 m0,s62,36864
s_add_u32 s69,s78,36864
v_mfma_f32_16x16x32_bf16 v[204:207],v[76:79],a[236:239],v[204:207]
s_waitcnt lgkmcnt(2)
v_mfma_f32_16x16x32_bf16 v[192:195],a[112:115],v[64:67],v[192:195]
ds_read_b128 v[76:79],v20 offset:60416
buffer_load_dwordx4 v16,s[20:23],s69 offen offset:0 lds
v_mfma_f32_16x16x32_bf16 v[200:203],v[64:67],a[240:243],v[200:203]
s_waitcnt lgkmcnt(2)
v_mfma_f32_16x16x32_bf16 v[196:199],a[112:115],v[68:71],v[196:199]
ds_read_b128 v[64:67],v20 offset:61440
v_mfma_f32_16x16x32_bf16 v[204:207],v[68:71],a[240:243],v[204:207]
buffer_load_dwordx4 v16,s[20:23],s69 offen offset:1024 lds
s_waitcnt lgkmcnt(2)
v_mfma_f32_16x16x32_bf16 v[192:195],a[116:119],v[72:75],v[192:195]
ds_read_b128 v[68:71],v20 offset:62464
v_mfma_f32_16x16x32_bf16 v[200:203],v[72:75],a[244:247],v[200:203]
buffer_load_dwordx4 v16,s[20:23],s69 offen offset:2048 lds
s_waitcnt lgkmcnt(2)
v_mfma_f32_16x16x32_bf16 v[196:199],a[116:119],v[76:79],v[196:199]
ds_read_b128 v[72:75],v20 offset:63488
v_mfma_f32_16x16x32_bf16 v[204:207],v[76:79],a[244:247],v[204:207]
buffer_load_dwordx4 v16,s[20:23],s69 offen offset:3072 lds
s_waitcnt lgkmcnt(2)
v_mfma_f32_16x16x32_bf16 v[192:195],a[120:123],v[64:67],v[192:195]
ds_read_b128 v[76:79],v20 offset:64512
v_mfma_f32_16x16x32_bf16 v[200:203],v[64:67],a[248:251],v[200:203]
s_add_u32 m0,s62,40960
s_add_u32 s69,s78,40960
s_waitcnt lgkmcnt(2)
v_mfma_f32_16x16x32_bf16 v[196:199],a[120:123],v[68:71],v[196:199]
v_mfma_f32_16x16x32_bf16 v[204:207],v[68:71],a[248:251],v[204:207]
buffer_load_dwordx4 v16,s[20:23],s69 offen offset:0 lds
s_waitcnt lgkmcnt(1)
v_mfma_f32_16x16x32_bf16 v[192:195],a[124:127],v[72:75],v[192:195]
v_mfma_f32_16x16x32_bf16 v[200:203],v[72:75],a[252:255],v[200:203]
buffer_load_dwordx4 v16,s[20:23],s69 offen offset:1024 lds
s_waitcnt lgkmcnt(0)
v_mfma_f32_16x16x32_bf16 v[196:199],a[124:127],v[76:79],v[196:199]
v_mfma_f32_16x16x32_bf16 v[204:207],v[76:79],a[252:255],v[204:207]
v_xor_b32 v20,0x10000,v20
s_xor_b32 s62,s62,0x10000
s_lshr_b32 s64,s73,9
v_add_u32 v22,s64,v24
v_cvt_pk_bf16_f32 v208,v192,v193
v_cvt_pk_bf16_f32 v209,v194,v195
s_nop 0
v_cvt_pk_bf16_f32 v210,v196,v197
v_cvt_pk_bf16_f32 v211,v198,v199
v_cvt_pk_bf16_f32 v212,v200,v201
v_cvt_pk_bf16_f32 v213,v202,v203
v_cvt_pk_bf16_f32 v214,v204,v205
v_cvt_pk_bf16_f32 v215,v206,v207
v_permlane16_swap_b32 v208,v210
v_permlane16_swap_b32 v209,v211
buffer_store_dwordx4 v[208:211],v2,s[24:27],s73 offen
buffer_store_dwordx4 v[208:211],v2,s[28:31],s73 offen sc1
ds_write_b128 v22,v[212:215] offset:16384
buffer_store_dwordx4 v[208:211],v17,s[20:23],s12 offen sc1
s_cmp_lt_i32 s79,0
s_cbranch_scc1 pn_104
bgx_110:
buffer_store_dwordx4 v[100:103],v9,s[24:27],s73 offen
buffer_store_dwordx4 v[100:103],v9,s[28:31],s73 offen sc1
s_mov_b32 exec_hi,0
buffer_store_dwordx4 v[100:103],v8,s[24:27],s73 offen
buffer_store_dwordx4 v[100:103],v8,s[24:27],s71 offen
buffer_store_dwordx4 v[100:103],v8,s[28:31],s73 offen sc1
buffer_store_dwordx4 v[100:103],v8,s[28:31],s71 offen sc1
s_mov_b64 exec,-1
s_waitcnt lgkmcnt(0)
s_add_u32 s63,s79,1
s_and_b32 s64,s63,3
s_lshl_b32 s70,s64,20
s_add_u32 s65,s63,2
s_and_b32 s65,s65,3
s_lshl_b32 s73,s65,20
s_add_u32 s55,s63,3
s_lshl_b32 s78,s55,16
s_add_u32 s78,s78,57344
s_cmp_lt_u32 s55,64
s_cselect_b32 s78,s78,0x7fff0000
s_add_u32 s60,s63,1
s_lshl_b32 s76,s60,21
s_lshl_b32 s55,s60,13
s_and_b32 s55,s55,0x2000
s_xor_b32 s55,s55,s61
s_add_u32 s76,s76,s55
s_cmp_lt_u32 s60,64
s_cselect_b32 s76,s76,0x7fff0000
s_add_u32 s60,s63,2
s_lshl_b32 s12,s60,21
s_lshl_b32 s55,s60,13
s_and_b32 s55,s55,0x2000
s_xor_b32 s55,s55,s61
s_add_u32 s12,s12,s55
s_cmp_lt_u32 s60,64
s_cselect_b32 s12,s12,0x7fff0000
s_add_u32 s71,s73,65536
v_mov_b32 v176,0
v_mov_b32 v177,0
v_mov_b32 v178,0
v_mov_b32 v179,0
v_mov_b32 v180,0
v_mov_b32 v181,0
v_mov_b32 v182,0
v_mov_b32 v183,0
s_add_u32 s79,s79,1
v_add_u32 v25,1,v25
s_waitcnt vmcnt(0)
s_branch loop_103
art_107:
s_sub_u32 s90,s90,1
s_cmp_lt_i32 s90,0
s_cbranch_scc1 abk_108
buffer_load_dwordx4 v[48:51],v27,s[20:23],s70 offen offset:0 sc1
buffer_load_dwordx4 v[52:55],v27,s[20:23],s70 offen offset:1024 sc1
buffer_load_dwordx4 v[56:59],v27,s[20:23],s70 offen offset:2048 sc1
buffer_load_dwordx4 v[60:63],v27,s[20:23],s70 offen offset:3072 sc1
s_waitcnt vmcnt(3)
ds_write_b128 v24,v[48:51] offset:4096
v_min3_u32 v22,v48,v49,v50
v_min_u32 v22,v22,v51
s_waitcnt vmcnt(2)
ds_write_b128 v24,v[52:55] offset:5120
v_min3_u32 v22,v22,v52,v53
v_min3_u32 v22,v22,v54,v55
s_waitcnt vmcnt(1)
ds_write_b128 v24,v[56:59] offset:6144
v_min3_u32 v22,v22,v56,v57
v_min3_u32 v22,v22,v58,v59
s_waitcnt vmcnt(0)
ds_write_b128 v24,v[60:63] offset:7168
v_min3_u32 v22,v22,v60,v61
v_min3_u32 v22,v22,v62,v63
v_cmp_eq_u32 vcc,0,v22
s_cbranch_vccnz art_107
s_branch abk_108
first_102:
s_add_u32 s63,s79,0
s_and_b32 s64,s63,3
s_lshl_b32 s70,s64,20
s_add_u32 s65,s63,2
s_and_b32 s65,s65,3
s_lshl_b32 s73,s65,20
s_add_u32 s55,s63,3
s_lshl_b32 s78,s55,16
s_add_u32 s78,s78,57344
s_cmp_lt_u32 s55,64
s_cselect_b32 s78,s78,0x7fff0000
s_add_u32 s60,s63,1
s_lshl_b32 s76,s60,21
s_lshl_b32 s55,s60,13
s_and_b32 s55,s55,0x2000
s_xor_b32 s55,s55,s61
s_add_u32 s76,s76,s55
s_cmp_lt_u32 s60,64
s_cselect_b32 s76,s76,0x7fff0000
s_add_u32 s60,s63,2
s_lshl_b32 s12,s60,21
s_lshl_b32 s55,s60,13
s_and_b32 s55,s55,0x2000
s_xor_b32 s55,s55,s61
s_add_u32 s12,s12,s55
s_cmp_lt_u32 s60,64
s_cselect_b32 s12,s12,0x7fff0000
s_add_u32 s71,s73,65536
v_mov_b32 v176,0
v_mov_b32 v177,0
v_mov_b32 v178,0
v_mov_b32 v179,0
v_mov_b32 v180,0
v_mov_b32 v181,0
v_mov_b32 v182,0
v_mov_b32 v183,0
s_waitcnt vmcnt(0) lgkmcnt(0)
s_barrier
s_branch bge_109
pn_104:
s_add_u32 s63,s79,1
s_and_b32 s64,s63,3
s_lshl_b32 s70,s64,20
s_add_u32 s65,s63,2
s_and_b32 s65,s65,3
s_lshl_b32 s73,s65,20
s_add_u32 s55,s63,3
s_lshl_b32 s78,s55,16
s_add_u32 s78,s78,57344
s_cmp_lt_u32 s55,64
s_cselect_b32 s78,s78,0x7fff0000
s_add_u32 s60,s63,1
s_lshl_b32 s76,s60,21
s_lshl_b32 s55,s60,13
s_and_b32 s55,s55,0x2000
s_xor_b32 s55,s55,s61
s_add_u32 s76,s76,s55
s_cmp_lt_u32 s60,64
s_cselect_b32 s76,s76,0x7fff0000
s_add_u32 s60,s63,2
s_lshl_b32 s12,s60,21
s_lshl_b32 s55,s60,13
s_and_b32 s55,s55,0x2000
s_xor_b32 s55,s55,s61
s_add_u32 s12,s12,s55
s_cmp_lt_u32 s60,64
s_cselect_b32 s12,s12,0x7fff0000
s_add_u32 s71,s73,65536
v_mov_b32 v176,0
v_mov_b32 v177,0
v_mov_b32 v178,0
v_mov_b32 v179,0
v_mov_b32 v180,0
v_mov_b32 v181,0
v_mov_b32 v182,0
v_mov_b32 v183,0
s_add_u32 s79,s79,1
s_cmp_eq_u32 s79,0
s_cbranch_scc1 pn2_111
buffer_store_dwordx4 v[212:215],v12,s[20:23],s76 offen sc1
s_waitcnt vmcnt(0) lgkmcnt(0)
s_barrier
s_branch bge_109
pn2_111:
v_mov_b32 v25,1
s_waitcnt vmcnt(0) lgkmcnt(0)
s_barrier
s_branch loop_103
w2_55:
s_lshr_b32 s64,s57,2
s_add_u32 s64,s64,64
s_lshl_b32 s64,s64,14
s_add_u32 s64,s64,s68
s_add_u32 s64,s64,29361152
v_add_u32 v12,s64,v16
v_and_b32 v22,1,v4
v_lshrrev_b32 v23,1,v4
v_lshl_add_u32 v22,v22,1,v23
v_lshlrev_b32 v22,2,v22
v_lshl_add_u32 v22,v3,4,v22
v_add_u32 v31,155904,v22
s_branch first_112
loop_113:
s_barrier
buffer_load_dword v248,v18,s[20:23],s70 offen offset:0 sc1
s_nop 15
s_nop 5
hl_115:
buffer_load_dword v249,v18,s[20:23],s70 offen offset:0 sc1
s_waitcnt vmcnt(1)
v_cmp_eq_u32 vcc,v25,v248
s_bcnt1_i32_b32 s64,vcc_lo
s_cmp_ge_u32 s64,8
s_cbranch_scc1 hg_116
buffer_load_dword v248,v18,s[20:23],s70 offen offset:0 sc1
s_waitcnt vmcnt(1)
v_cmp_eq_u32 vcc,v25,v249
s_bcnt1_i32_b32 s64,vcc_lo
s_cmp_ge_u32 s64,8
s_cbranch_scc1 hg_116
s_sub_u32 s90,s90,1
s_cmp_gt_i32 s90,0
s_cbranch_scc1 hl_115
hg_116:
buffer_load_dwordx4 v[64:67],v28,s[20:23],s70 offen offset:0 sc1
buffer_load_dwordx4 v[68:71],v28,s[20:23],s70 offen offset:1024 sc1
buffer_load_dwordx4 v[72:75],v28,s[20:23],s70 offen offset:2048 sc1
buffer_load_dwordx4 v[76:79],v28,s[20:23],s70 offen offset:3072 sc1
s_waitcnt vmcnt(3)
ds_write_b128 v24,v[64:67] offset:8192
v_min3_u32 v22,v64,v65,v66
v_min_u32 v22,v22,v67
s_waitcnt vmcnt(2)
ds_write_b128 v24,v[68:71] offset:9216
v_min3_u32 v22,v22,v68,v69
v_min3_u32 v22,v22,v70,v71
s_waitcnt vmcnt(1)
ds_write_b128 v24,v[72:75] offset:10240
v_min3_u32 v22,v22,v72,v73
v_min3_u32 v22,v22,v74,v75
s_waitcnt vmcnt(0)
ds_write_b128 v24,v[76:79] offset:11264
v_min3_u32 v22,v22,v76,v77
v_min3_u32 v22,v22,v78,v79
v_cmp_eq_u32 vcc,0,v22
s_cbranch_vccnz art_117
abk_118:
v_smfmac_f32_16x16x64_bf16 v[176:179],v[64:67],a[64:71],v14
s_waitcnt lgkmcnt(0)
s_barrier
ds_read_b128 v[80:83],v24 offset:12288
ds_read_b128 v[84:87],v24 offset:13312
ds_read_b128 v[88:91],v24 offset:14336
ds_read_b128 v[92:95],v24 offset:15360
buffer_store_dwordx4 v[212:215],v12,s[20:23],s76 offen sc1
v_smfmac_f32_16x16x64_bf16 v[176:179],v[68:71],a[72:79],v14
ds_read_b128 v[32:35],v24 offset:0
ds_read_b128 v[36:39],v24 offset:1024
v_smfmac_f32_16x16x64_bf16 v[176:179],v[72:75],a[80:87],v14
ds_read_b128 v[40:43],v24 offset:2048
ds_read_b128 v[44:47],v24 offset:3072
v_smfmac_f32_16x16x64_bf16 v[176:179],v[76:79],a[88:95],v14
ds_read_b128 v[48:51],v24 offset:4096
ds_read_b128 v[52:55],v24 offset:5120
s_waitcnt lgkmcnt(9)
v_smfmac_f32_16x16x64_bf16 v[176:179],v[80:83],a[96:103],v14
ds_read_b128 v[56:59],v24 offset:6144
s_waitcnt lgkmcnt(9)
v_smfmac_f32_16x16x64_bf16 v[176:179],v[84:87],a[104:111],v14
ds_read_b128 v[60:63],v24 offset:7168
s_waitcnt lgkmcnt(9)
v_smfmac_f32_16x16x64_bf16 v[176:179],v[88:91],a[112:119],v14
s_waitcnt lgkmcnt(8)
v_smfmac_f32_16x16x64_bf16 v[176:179],v[92:95],a[120:127],v14
s_waitcnt lgkmcnt(7)
v_smfmac_f32_16x16x64_bf16 v[176:179],v[32:35],a[0:7],v14
s_waitcnt lgkmcnt(6)
v_smfmac_f32_16x16x64_bf16 v[176:179],v[36:39],a[8:15],v14
s_waitcnt lgkmcnt(5)
v_smfmac_f32_16x16x64_bf16 v[176:179],v[40:43],a[16:23],v14
s_waitcnt lgkmcnt(4)
v_smfmac_f32_16x16x64_bf16 v[176:179],v[44:47],a[24:31],v14
s_waitcnt lgkmcnt(3)
v_smfmac_f32_16x16x64_bf16 v[176:179],v[48:51],a[32:39],v14
s_waitcnt lgkmcnt(2)
v_smfmac_f32_16x16x64_bf16 v[176:179],v[52:55],a[40:47],v14
s_waitcnt lgkmcnt(1)
v_smfmac_f32_16x16x64_bf16 v[176:179],v[56:59],a[48:55],v14
s_waitcnt lgkmcnt(0)
v_smfmac_f32_16x16x64_bf16 v[176:179],v[60:63],a[56:63],v14
v_smfmac_f32_16x16x64_bf16 v[180:183],v[32:35],a[128:135],v14
v_smfmac_f32_16x16x64_bf16 v[180:183],v[36:39],a[136:143],v14
s_nop 5
v_permlane32_swap_b32 v176,v178
v_permlane32_swap_b32 v177,v179
v_add_f32 v176,v176,v178
v_add_f32 v177,v177,v179
v_cvt_pk_bf16_f32 v216,v176,v177
s_nop 1
v_mov_b32_dpp v217,v216 quad_perm:[1,0,3,2] row_mask:0xf bank_mask:0xf
v_perm_b32 v216,v217,v216,v15
v_max_u32 v216,1,v216
buffer_store_dword v216,v19,s[24:27],s70 offen
buffer_store_dword v216,v19,s[28:31],s70 offen sc1
v_smfmac_f32_16x16x64_bf16 v[180:183],v[40:43],a[144:151],v14
v_smfmac_f32_16x16x64_bf16 v[180:183],v[44:47],a[152:159],v14
v_smfmac_f32_16x16x64_bf16 v[180:183],v[48:51],a[160:167],v14
v_smfmac_f32_16x16x64_bf16 v[180:183],v[52:55],a[168:175],v14
v_smfmac_f32_16x16x64_bf16 v[180:183],v[56:59],a[176:183],v14
v_smfmac_f32_16x16x64_bf16 v[180:183],v[60:63],a[184:191],v14
v_smfmac_f32_16x16x64_bf16 v[180:183],v[64:67],a[192:199],v14
v_smfmac_f32_16x16x64_bf16 v[180:183],v[68:71],a[200:207],v14
v_smfmac_f32_16x16x64_bf16 v[180:183],v[72:75],a[208:215],v14
v_smfmac_f32_16x16x64_bf16 v[180:183],v[76:79],a[216:223],v14
v_smfmac_f32_16x16x64_bf16 v[180:183],v[80:83],a[224:231],v14
v_smfmac_f32_16x16x64_bf16 v[180:183],v[84:87],a[232:239],v14
v_smfmac_f32_16x16x64_bf16 v[180:183],v[88:91],a[240:247],v14
v_smfmac_f32_16x16x64_bf16 v[180:183],v[92:95],a[248:255],v14
s_nop 7
v_permlane32_swap_b32 v180,v182
v_permlane32_swap_b32 v181,v183
v_add_f32 v180,v180,v182
v_add_f32 v181,v181,v183
v_cvt_pk_bf16_f32 v216,v180,v181
v_max_u32 v216,1,v216
ds_write_b32 v31,v216
ds_write_b32 v21,v25 offset:4
s_cmp_eq_u32 s79,63
s_cbranch_scc1 end_52
s_cmp_ge_i32 s79,62
s_cbranch_scc1 bgx_120
bge_119:
ds_read_b128 v[64:67],v20 offset:0
ds_read_b128 v[68:71],v20 offset:1024
ds_read_b128 v[72:75],v20 offset:2048
s_waitcnt lgkmcnt(2)
v_mfma_f32_16x16x32_bf16 v[192:195],a[0:3],v[64:67],0
ds_read_b128 v[76:79],v20 offset:3072
v_mfma_f32_16x16x32_bf16 v[200:203],v[64:67],a[128:131],0
s_waitcnt lgkmcnt(2)
v_mfma_f32_16x16x32_bf16 v[196:199],a[0:3],v[68:71],0
ds_read_b128 v[64:67],v20 offset:4096
v_mfma_f32_16x16x32_bf16 v[204:207],v[68:71],a[128:131],0
s_waitcnt lgkmcnt(2)
v_mfma_f32_16x16x32_bf16 v[192:195],a[4:7],v[72:75],v[192:195]
ds_read_b128 v[68:71],v20 offset:5120
v_mfma_f32_16x16x32_bf16 v[200:203],v[72:75],a[132:135],v[200:203]
s_waitcnt lgkmcnt(2)
v_mfma_f32_16x16x32_bf16 v[196:199],a[4:7],v[76:79],v[196:199]
ds_read_b128 v[72:75],v20 offset:6144
v_mfma_f32_16x16x32_bf16 v[204:207],v[76:79],a[132:135],v[204:207]
s_waitcnt lgkmcnt(2)
v_mfma_f32_16x16x32_bf16 v[192:195],a[8:11],v[64:67],v[192:195]
ds_read_b128 v[76:79],v20 offset:7168
v_mfma_f32_16x16x32_bf16 v[200:203],v[64:67],a[136:139],v[200:203]
s_waitcnt lgkmcnt(2)
v_mfma_f32_16x16x32_bf16 v[196:199],a[8:11],v[68:71],v[196:199]
ds_read_b128 v[64:67],v20 offset:8192
v_mfma_f32_16x16x32_bf16 v[204:207],v[68:71],a[136:139],v[204:207]
s_waitcnt lgkmcnt(2)
v_mfma_f32_16x16x32_bf16 v[192:195],a[12:15],v[72:75],v[192:195]
ds_read_b128 v[68:71],v20 offset:9216
v_mfma_f32_16x16x32_bf16 v[200:203],v[72:75],a[140:143],v[200:203]
s_waitcnt lgkmcnt(2)
v_mfma_f32_16x16x32_bf16 v[196:199],a[12:15],v[76:79],v[196:199]
ds_read_b128 v[72:75],v20 offset:10240
v_mfma_f32_16x16x32_bf16 v[204:207],v[76:79],a[140:143],v[204:207]
s_add_u32 m0,s62,16384
s_add_u32 s69,s78,16384
s_waitcnt lgkmcnt(2)
v_mfma_f32_16x16x32_bf16 v[192:195],a[16:19],v[64:67],v[192:195]
ds_read_b128 v[76:79],v20 offset:11264
v_mfma_f32_16x16x32_bf16 v[200:203],v[64:67],a[144:147],v[200:203]
buffer_load_dwordx4 v16,s[20:23],s69 offen offset:0 lds
s_waitcnt lgkmcnt(2)
v_mfma_f32_16x16x32_bf16 v[196:199],a[16:19],v[68:71],v[196:199]
ds_read_b128 v[64:67],v20 offset:12288
v_mfma_f32_16x16x32_bf16 v[204:207],v[68:71],a[144:147],v[204:207]
buffer_load_dwordx4 v16,s[20:23],s69 offen offset:1024 lds
s_waitcnt lgkmcnt(2)
v_mfma_f32_16x16x32_bf16 v[192:195],a[20:23],v[72:75],v[192:195]
ds_read_b128 v[68:71],v20 offset:13312
v_mfma_f32_16x16x32_bf16 v[200:203],v[72:75],a[148:151],v[200:203]
buffer_load_dwordx4 v16,s[20:23],s69 offen offset:2048 lds
s_waitcnt lgkmcnt(2)
v_mfma_f32_16x16x32_bf16 v[196:199],a[20:23],v[76:79],v[196:199]
ds_read_b128 v[72:75],v20 offset:14336
v_mfma_f32_16x16x32_bf16 v[204:207],v[76:79],a[148:151],v[204:207]
buffer_load_dwordx4 v16,s[20:23],s69 offen offset:3072 lds
s_waitcnt lgkmcnt(2)
v_mfma_f32_16x16x32_bf16 v[192:195],a[24:27],v[64:67],v[192:195]
ds_read_b128 v[76:79],v20 offset:15360
v_mfma_f32_16x16x32_bf16 v[200:203],v[64:67],a[152:155],v[200:203]
s_add_u32 m0,s62,20480
s_add_u32 s69,s78,20480
s_waitcnt lgkmcnt(2)
v_mfma_f32_16x16x32_bf16 v[196:199],a[24:27],v[68:71],v[196:199]
ds_read_b128 v[64:67],v20 offset:16384
v_mfma_f32_16x16x32_bf16 v[204:207],v[68:71],a[152:155],v[204:207]
buffer_load_dwordx4 v16,s[20:23],s69 offen offset:0 lds
s_waitcnt lgkmcnt(2)
v_mfma_f32_16x16x32_bf16 v[192:195],a[28:31],v[72:75],v[192:195]
ds_read_b128 v[68:71],v20 offset:17408
v_mfma_f32_16x16x32_bf16 v[200:203],v[72:75],a[156:159],v[200:203]
buffer_load_dwordx4 v16,s[20:23],s69 offen offset:1024 lds
s_waitcnt lgkmcnt(2)
v_mfma_f32_16x16x32_bf16 v[196:199],a[28:31],v[76:79],v[196:199]
ds_read_b128 v[72:75],v20 offset:18432
v_mfma_f32_16x16x32_bf16 v[204:207],v[76:79],a[156:159],v[204:207]
buffer_load_dwordx4 v16,s[20:23],s69 offen offset:2048 lds
s_waitcnt lgkmcnt(2)
v_mfma_f32_16x16x32_bf16 v[192:195],a[32:35],v[64:67],v[192:195]
ds_read_b128 v[76:79],v20 offset:19456
v_mfma_f32_16x16x32_bf16 v[200:203],v[64:67],a[160:163],v[200:203]
buffer_load_dwordx4 v16,s[20:23],s69 offen offset:3072 lds
s_waitcnt lgkmcnt(2)
v_mfma_f32_16x16x32_bf16 v[196:199],a[32:35],v[68:71],v[196:199]
ds_read_b128 v[64:67],v20 offset:20480
v_mfma_f32_16x16x32_bf16 v[204:207],v[68:71],a[160:163],v[204:207]
s_add_u32 m0,s62,24576
s_add_u32 s69,s78,24576
s_waitcnt lgkmcnt(2)
v_mfma_f32_16x16x32_bf16 v[192:195],a[36:39],v[72:75],v[192:195]
ds_read_b128 v[68:71],v20 offset:21504
v_mfma_f32_16x16x32_bf16 v[200:203],v[72:75],a[164:167],v[200:203]
buffer_load_dwordx4 v16,s[20:23],s69 offen offset:0 lds
s_waitcnt lgkmcnt(2)
v_mfma_f32_16x16x32_bf16 v[196:199],a[36:39],v[76:79],v[196:199]
ds_read_b128 v[72:75],v20 offset:22528
v_mfma_f32_16x16x32_bf16 v[204:207],v[76:79],a[164:167],v[204:207]
buffer_load_dwordx4 v16,s[20:23],s69 offen offset:1024 lds
s_waitcnt lgkmcnt(2)
v_mfma_f32_16x16x32_bf16 v[192:195],a[40:43],v[64:67],v[192:195]
ds_read_b128 v[76:79],v20 offset:23552
v_mfma_f32_16x16x32_bf16 v[200:203],v[64:67],a[168:171],v[200:203]
buffer_load_dwordx4 v16,s[20:23],s69 offen offset:2048 lds
s_waitcnt lgkmcnt(2)
v_mfma_f32_16x16x32_bf16 v[196:199],a[40:43],v[68:71],v[196:199]
ds_read_b128 v[64:67],v20 offset:24576
v_mfma_f32_16x16x32_bf16 v[204:207],v[68:71],a[168:171],v[204:207]
buffer_load_dwordx4 v16,s[20:23],s69 offen offset:3072 lds
s_waitcnt lgkmcnt(2)
v_mfma_f32_16x16x32_bf16 v[192:195],a[44:47],v[72:75],v[192:195]
ds_read_b128 v[68:71],v20 offset:25600
v_mfma_f32_16x16x32_bf16 v[200:203],v[72:75],a[172:175],v[200:203]
s_add_u32 m0,s62,28672
s_add_u32 s69,s78,28672
s_waitcnt lgkmcnt(2)
v_mfma_f32_16x16x32_bf16 v[196:199],a[44:47],v[76:79],v[196:199]
ds_read_b128 v[72:75],v20 offset:26624
v_mfma_f32_16x16x32_bf16 v[204:207],v[76:79],a[172:175],v[204:207]
buffer_load_dwordx4 v16,s[20:23],s69 offen offset:0 lds
s_waitcnt lgkmcnt(2)
v_mfma_f32_16x16x32_bf16 v[192:195],a[48:51],v[64:67],v[192:195]
ds_read_b128 v[76:79],v20 offset:27648
v_mfma_f32_16x16x32_bf16 v[200:203],v[64:67],a[176:179],v[200:203]
buffer_load_dwordx4 v16,s[20:23],s69 offen offset:1024 lds
s_waitcnt lgkmcnt(2)
v_mfma_f32_16x16x32_bf16 v[196:199],a[48:51],v[68:71],v[196:199]
ds_read_b128 v[64:67],v20 offset:28672
v_mfma_f32_16x16x32_bf16 v[204:207],v[68:71],a[176:179],v[204:207]
buffer_load_dwordx4 v16,s[20:23],s69 offen offset:2048 lds
s_waitcnt lgkmcnt(2)
v_mfma_f32_16x16x32_bf16 v[192:195],a[52:55],v[72:75],v[192:195]
ds_read_b128 v[68:71],v20 offset:29696
v_mfma_f32_16x16x32_bf16 v[200:203],v[72:75],a[180:183],v[200:203]
buffer_load_dwordx4 v16,s[20:23],s69 offen offset:3072 lds
s_waitcnt lgkmcnt(2)
v_mfma_f32_16x16x32_bf16 v[196:199],a[52:55],v[76:79],v[196:199]
ds_read_b128 v[72:75],v20 offset:30720
v_mfma_f32_16x16x32_bf16 v[204:207],v[76:79],a[180:183],v[204:207]
s_waitcnt lgkmcnt(2)
v_mfma_f32_16x16x32_bf16 v[192:195],a[56:59],v[64:67],v[192:195]
ds_read_b128 v[76:79],v20 offset:31744
v_mfma_f32_16x16x32_bf16 v[200:203],v[64:67],a[184:187],v[200:203]
s_waitcnt lgkmcnt(2)
v_mfma_f32_16x16x32_bf16 v[196:199],a[56:59],v[68:71],v[196:199]
ds_read_b128 v[64:67],v20 offset:32768
v_mfma_f32_16x16x32_bf16 v[204:207],v[68:71],a[184:187],v[204:207]
s_waitcnt lgkmcnt(2)
v_mfma_f32_16x16x32_bf16 v[192:195],a[60:63],v[72:75],v[192:195]
ds_read_b128 v[68:71],v20 offset:33792
v_mfma_f32_16x16x32_bf16 v[200:203],v[72:75],a[188:191],v[200:203]
s_waitcnt lgkmcnt(2)
v_mfma_f32_16x16x32_bf16 v[196:199],a[60:63],v[76:79],v[196:199]
ds_read_b128 v[72:75],v20 offset:34816
v_mfma_f32_16x16x32_bf16 v[204:207],v[76:79],a[188:191],v[204:207]
s_waitcnt lgkmcnt(2)
v_mfma_f32_16x16x32_bf16 v[192:195],a[64:67],v[64:67],v[192:195]
ds_read_b128 v[76:79],v20 offset:35840
v_mfma_f32_16x16x32_bf16 v[200:203],v[64:67],a[192:195],v[200:203]
s_waitcnt lgkmcnt(2)
v_mfma_f32_16x16x32_bf16 v[196:199],a[64:67],v[68:71],v[196:199]
ds_read_b128 v[64:67],v20 offset:36864
v_mfma_f32_16x16x32_bf16 v[204:207],v[68:71],a[192:195],v[204:207]
s_waitcnt lgkmcnt(2)
v_mfma_f32_16x16x32_bf16 v[192:195],a[68:71],v[72:75],v[192:195]
ds_read_b128 v[68:71],v20 offset:37888
v_mfma_f32_16x16x32_bf16 v[200:203],v[72:75],a[196:199],v[200:203]
s_waitcnt lgkmcnt(2)
v_mfma_f32_16x16x32_bf16 v[196:199],a[68:71],v[76:79],v[196:199]
ds_read_b128 v[72:75],v20 offset:38912
v_mfma_f32_16x16x32_bf16 v[204:207],v[76:79],a[196:199],v[204:207]
s_waitcnt lgkmcnt(2)
v_mfma_f32_16x16x32_bf16 v[192:195],a[72:75],v[64:67],v[192:195]
ds_read_b128 v[76:79],v20 offset:39936
v_mfma_f32_16x16x32_bf16 v[200:203],v[64:67],a[200:203],v[200:203]
s_waitcnt lgkmcnt(2)
v_mfma_f32_16x16x32_bf16 v[196:199],a[72:75],v[68:71],v[196:199]
ds_read_b128 v[64:67],v20 offset:40960
v_mfma_f32_16x16x32_bf16 v[204:207],v[68:71],a[200:203],v[204:207]
s_waitcnt lgkmcnt(2)
v_mfma_f32_16x16x32_bf16 v[192:195],a[76:79],v[72:75],v[192:195]
ds_read_b128 v[68:71],v20 offset:41984
v_mfma_f32_16x16x32_bf16 v[200:203],v[72:75],a[204:207],v[200:203]
s_waitcnt lgkmcnt(2)
v_mfma_f32_16x16x32_bf16 v[196:199],a[76:79],v[76:79],v[196:199]
ds_read_b128 v[72:75],v20 offset:43008
v_mfma_f32_16x16x32_bf16 v[204:207],v[76:79],a[204:207],v[204:207]
s_waitcnt lgkmcnt(2)
v_mfma_f32_16x16x32_bf16 v[192:195],a[80:83],v[64:67],v[192:195]
ds_read_b128 v[76:79],v20 offset:44032
v_mfma_f32_16x16x32_bf16 v[200:203],v[64:67],a[208:211],v[200:203]
s_waitcnt lgkmcnt(2)
v_mfma_f32_16x16x32_bf16 v[196:199],a[80:83],v[68:71],v[196:199]
ds_read_b128 v[64:67],v20 offset:45056
v_mfma_f32_16x16x32_bf16 v[204:207],v[68:71],a[208:211],v[204:207]
s_waitcnt lgkmcnt(2)
v_mfma_f32_16x16x32_bf16 v[192:195],a[84:87],v[72:75],v[192:195]
ds_read_b128 v[68:71],v20 offset:46080
v_mfma_f32_16x16x32_bf16 v[200:203],v[72:75],a[212:215],v[200:203]
s_waitcnt lgkmcnt(2)
v_mfma_f32_16x16x32_bf16 v[196:199],a[84:87],v[76:79],v[196:199]
ds_read_b128 v[72:75],v20 offset:47104
v_mfma_f32_16x16x32_bf16 v[204:207],v[76:79],a[212:215],v[204:207]
s_waitcnt lgkmcnt(2)
v_mfma_f32_16x16x32_bf16 v[192:195],a[88:91],v[64:67],v[192:195]
ds_read_b128 v[76:79],v20 offset:48128
v_mfma_f32_16x16x32_bf16 v[200:203],v[64:67],a[216:219],v[200:203]
s_waitcnt lgkmcnt(2)
v_mfma_f32_16x16x32_bf16 v[196:199],a[88:91],v[68:71],v[196:199]
ds_read_b128 v[64:67],v20 offset:49152
v_mfma_f32_16x16x32_bf16 v[204:207],v[68:71],a[216:219],v[204:207]
s_waitcnt lgkmcnt(2)
v_mfma_f32_16x16x32_bf16 v[192:195],a[92:95],v[72:75],v[192:195]
ds_read_b128 v[68:71],v20 offset:50176
v_mfma_f32_16x16x32_bf16 v[200:203],v[72:75],a[220:223],v[200:203]
s_waitcnt lgkmcnt(2)
v_mfma_f32_16x16x32_bf16 v[196:199],a[92:95],v[76:79],v[196:199]
ds_read_b128 v[72:75],v20 offset:51200
v_mfma_f32_16x16x32_bf16 v[204:207],v[76:79],a[220:223],v[204:207]
s_waitcnt lgkmcnt(2)
v_mfma_f32_16x16x32_bf16 v[192:195],a[96:99],v[64:67],v[192:195]
ds_read_b128 v[76:79],v20 offset:52224
v_mfma_f32_16x16x32_bf16 v[200:203],v[64:67],a[224:227],v[200:203]
s_waitcnt lgkmcnt(2)
v_mfma_f32_16x16x32_bf16 v[196:199],a[96:99],v[68:71],v[196:199]
ds_read_b128 v[64:67],v20 offset:53248
v_mfma_f32_16x16x32_bf16 v[204:207],v[68:71],a[224:227],v[204:207]
s_waitcnt lgkmcnt(2)
v_mfma_f32_16x16x32_bf16 v[192:195],a[100:103],v[72:75],v[192:195]
ds_read_b128 v[68:71],v20 offset:54272
s_add_u32 m0,s62,43008
s_add_u32 s69,s78,43008
v_mfma_f32_16x16x32_bf16 v[200:203],v[72:75],a[228:231],v[200:203]
s_waitcnt lgkmcnt(2)
v_mfma_f32_16x16x32_bf16 v[196:199],a[100:103],v[76:79],v[196:199]
ds_read_b128 v[72:75],v20 offset:55296
buffer_load_dwordx4 v16,s[20:23],s69 offen offset:0 lds
v_mfma_f32_16x16x32_bf16 v[204:207],v[76:79],a[228:231],v[204:207]
s_waitcnt lgkmcnt(2)
v_mfma_f32_16x16x32_bf16 v[192:195],a[104:107],v[64:67],v[192:195]
ds_read_b128 v[76:79],v20 offset:56320
buffer_load_dwordx4 v16,s[20:23],s69 offen offset:1024 lds
v_mfma_f32_16x16x32_bf16 v[200:203],v[64:67],a[232:235],v[200:203]
s_waitcnt lgkmcnt(2)
v_mfma_f32_16x16x32_bf16 v[196:199],a[104:107],v[68:71],v[196:199]
ds_read_b128 v[64:67],v20 offset:57344
buffer_load_dwordx4 v16,s[20:23],s69 offen offset:2048 lds
v_mfma_f32_16x16x32_bf16 v[204:207],v[68:71],a[232:235],v[204:207]
s_waitcnt lgkmcnt(2)
v_mfma_f32_16x16x32_bf16 v[192:195],a[108:111],v[72:75],v[192:195]
ds_read_b128 v[68:71],v20 offset:58368
buffer_load_dwordx4 v16,s[20:23],s69 offen offset:3072 lds
v_mfma_f32_16x16x32_bf16 v[200:203],v[72:75],a[236:239],v[200:203]
s_waitcnt lgkmcnt(2)
v_mfma_f32_16x16x32_bf16 v[196:199],a[108:111],v[76:79],v[196:199]
ds_read_b128 v[72:75],v20 offset:59392
s_add_u32 m0,s62,47104
s_add_u32 s69,s78,47104
v_mfma_f32_16x16x32_bf16 v[204:207],v[76:79],a[236:239],v[204:207]
s_waitcnt lgkmcnt(2)
v_mfma_f32_16x16x32_bf16 v[192:195],a[112:115],v[64:67],v[192:195]
ds_read_b128 v[76:79],v20 offset:60416
buffer_load_dwordx4 v16,s[20:23],s69 offen offset:0 lds
v_mfma_f32_16x16x32_bf16 v[200:203],v[64:67],a[240:243],v[200:203]
s_waitcnt lgkmcnt(2)
v_mfma_f32_16x16x32_bf16 v[196:199],a[112:115],v[68:71],v[196:199]
ds_read_b128 v[64:67],v20 offset:61440
v_mfma_f32_16x16x32_bf16 v[204:207],v[68:71],a[240:243],v[204:207]
buffer_load_dwordx4 v16,s[20:23],s69 offen offset:1024 lds
s_waitcnt lgkmcnt(2)
v_mfma_f32_16x16x32_bf16 v[192:195],a[116:119],v[72:75],v[192:195]
ds_read_b128 v[68:71],v20 offset:62464
v_mfma_f32_16x16x32_bf16 v[200:203],v[72:75],a[244:247],v[200:203]
buffer_load_dwordx4 v16,s[20:23],s69 offen offset:2048 lds
s_waitcnt lgkmcnt(2)
v_mfma_f32_16x16x32_bf16 v[196:199],a[116:119],v[76:79],v[196:199]
ds_read_b128 v[72:75],v20 offset:63488
v_mfma_f32_16x16x32_bf16 v[204:207],v[76:79],a[244:247],v[204:207]
buffer_load_dwordx4 v16,s[20:23],s69 offen offset:3072 lds
s_waitcnt lgkmcnt(2)
v_mfma_f32_16x16x32_bf16 v[192:195],a[120:123],v[64:67],v[192:195]
ds_read_b128 v[76:79],v20 offset:64512
v_mfma_f32_16x16x32_bf16 v[200:203],v[64:67],a[248:251],v[200:203]
s_add_u32 m0,s62,51200
s_add_u32 s69,s78,51200
s_waitcnt lgkmcnt(2)
v_mfma_f32_16x16x32_bf16 v[196:199],a[120:123],v[68:71],v[196:199]
v_mfma_f32_16x16x32_bf16 v[204:207],v[68:71],a[248:251],v[204:207]
buffer_load_dwordx4 v16,s[20:23],s69 offen offset:0 lds
s_waitcnt lgkmcnt(1)
v_mfma_f32_16x16x32_bf16 v[192:195],a[124:127],v[72:75],v[192:195]
v_mfma_f32_16x16x32_bf16 v[200:203],v[72:75],a[252:255],v[200:203]
buffer_load_dwordx4 v16,s[20:23],s69 offen offset:1024 lds
s_waitcnt lgkmcnt(0)
v_mfma_f32_16x16x32_bf16 v[196:199],a[124:127],v[76:79],v[196:199]
v_mfma_f32_16x16x32_bf16 v[204:207],v[76:79],a[252:255],v[204:207]
v_xor_b32 v20,0x10000,v20
s_xor_b32 s62,s62,0x10000
s_lshr_b32 s64,s73,9
v_add_u32 v22,s64,v24
v_cvt_pk_bf16_f32 v208,v192,v193
v_cvt_pk_bf16_f32 v209,v194,v195
s_nop 0
v_cvt_pk_bf16_f32 v210,v196,v197
v_cvt_pk_bf16_f32 v211,v198,v199
v_cvt_pk_bf16_f32 v212,v200,v201
v_cvt_pk_bf16_f32 v213,v202,v203
v_cvt_pk_bf16_f32 v214,v204,v205
v_cvt_pk_bf16_f32 v215,v206,v207
v_permlane16_swap_b32 v208,v210
v_permlane16_swap_b32 v209,v211
buffer_store_dwordx4 v[208:211],v2,s[24:27],s73 offen
buffer_store_dwordx4 v[208:211],v2,s[28:31],s73 offen sc1
ds_write_b128 v22,v[212:215] offset:17408
buffer_store_dwordx4 v[208:211],v17,s[20:23],s12 offen sc1
s_cmp_lt_i32 s79,0
s_cbranch_scc1 pn_114
bgx_120:
s_waitcnt lgkmcnt(0)
s_cmp_eq_u32 s79,2
s_cbranch_scc1 late_121
lateb_122:
s_buffer_load_dword s48,s[20:23],s80 offset:0
s_buffer_load_dword s48,s[20:23],s80 offset:64
s_buffer_load_dword s48,s[20:23],s80 offset:128
s_buffer_load_dword s48,s[20:23],s80 offset:192
s_buffer_load_dword s48,s[20:23],s80 offset:256
s_buffer_load_dword s48,s[20:23],s80 offset:320
s_buffer_load_dword s48,s[20:23],s80 offset:384
s_buffer_load_dword s48,s[20:23],s80 offset:448
s_buffer_load_dword s48,s[20:23],s80 offset:512
s_buffer_load_dword s48,s[20:23],s80 offset:576
s_buffer_load_dword s48,s[20:23],s80 offset:640
s_buffer_load_dword s48,s[20:23],s80 offset:704
s_buffer_load_dword s48,s[20:23],s80 offset:768
s_buffer_load_dword s48,s[20:23],s80 offset:832
s_buffer_load_dword s48,s[20:23],s80 offset:896
s_buffer_load_dword s48,s[20:23],s80 offset:960
s_buffer_load_dword s48,s[20:23],s80 offset:1024
s_buffer_load_dword s48,s[20:23],s80 offset:1088
s_buffer_load_dword s48,s[20:23],s80 offset:1152
s_buffer_load_dword s48,s[20:23],s80 offset:1216
s_buffer_load_dword s48,s[20:23],s80 offset:1280
s_buffer_load_dword s48,s[20:23],s80 offset:1344
s_buffer_load_dword s48,s[20:23],s80 offset:1408
s_buffer_load_dword s48,s[20:23],s80 offset:1472
s_buffer_load_dword s48,s[20:23],s80 offset:1536
s_buffer_load_dword s48,s[20:23],s80 offset:1600
s_buffer_load_dword s48,s[20:23],s80 offset:1664
s_buffer_load_dword s48,s[20:23],s80 offset:1728
s_buffer_load_dword s48,s[20:23],s80 offset:1792
s_buffer_load_dword s48,s[20:23],s80 offset:1856
s_buffer_load_dword s48,s[20:23],s80 offset:1920
s_buffer_load_dword s48,s[20:23],s80 offset:1984
s_add_u32 s63,s79,1
s_and_b32 s64,s63,3
s_lshl_b32 s70,s64,20
s_add_u32 s65,s63,2
s_and_b32 s65,s65,3
s_lshl_b32 s73,s65,20
s_add_u32 s55,s63,3
s_lshl_b32 s78,s55,16
s_add_u32 s78,s78,57344
s_cmp_lt_u32 s55,64
s_cselect_b32 s78,s78,0x7fff0000
s_add_u32 s60,s63,1
s_lshl_b32 s76,s60,21
s_lshl_b32 s55,s60,13
s_and_b32 s55,s55,0x2000
s_xor_b32 s55,s55,s61
s_add_u32 s76,s76,s55
s_cmp_lt_u32 s60,64
s_cselect_b32 s76,s76,0x7fff0000
s_add_u32 s60,s63,2
s_lshl_b32 s12,s60,21
s_lshl_b32 s55,s60,13
s_and_b32 s55,s55,0x2000
s_xor_b32 s55,s55,s61
s_add_u32 s12,s12,s55
s_cmp_lt_u32 s60,64
s_cselect_b32 s12,s12,0x7fff0000
s_add_u32 s55,s63,5
s_min_u32 s55,s55,63
s_lshl_b32 s55,s55,16
s_lshl_b32 s60,s59,11
s_add_u32 s80,s55,s60
s_add_u32 s80,s80,57344
v_mov_b32 v176,0
v_mov_b32 v177,0
v_mov_b32 v178,0
v_mov_b32 v179,0
v_mov_b32 v180,0
v_mov_b32 v181,0
v_mov_b32 v182,0
v_mov_b32 v183,0
s_add_u32 s79,s79,1
v_add_u32 v25,1,v25
s_waitcnt vmcnt(0)
s_branch loop_113
art_117:
s_sub_u32 s90,s90,1
s_cmp_lt_i32 s90,0
s_cbranch_scc1 abk_118
buffer_load_dwordx4 v[64:67],v28,s[20:23],s70 offen offset:0 sc1
buffer_load_dwordx4 v[68:71],v28,s[20:23],s70 offen offset:1024 sc1
buffer_load_dwordx4 v[72:75],v28,s[20:23],s70 offen offset:2048 sc1
buffer_load_dwordx4 v[76:79],v28,s[20:23],s70 offen offset:3072 sc1
s_waitcnt vmcnt(3)
ds_write_b128 v24,v[64:67] offset:8192
v_min3_u32 v22,v64,v65,v66
v_min_u32 v22,v22,v67
s_waitcnt vmcnt(2)
ds_write_b128 v24,v[68:71] offset:9216
v_min3_u32 v22,v22,v68,v69
v_min3_u32 v22,v22,v70,v71
s_waitcnt vmcnt(1)
ds_write_b128 v24,v[72:75] offset:10240
v_min3_u32 v22,v22,v72,v73
v_min3_u32 v22,v22,v74,v75
s_waitcnt vmcnt(0)
ds_write_b128 v24,v[76:79] offset:11264
v_min3_u32 v22,v22,v76,v77
v_min3_u32 v22,v22,v78,v79
v_cmp_eq_u32 vcc,0,v22
s_cbranch_vccnz art_117
s_branch abk_118
late_121:
v_lshlrev_b32 v184,2,v16
s_mov_b32 s52,21052416
s_mov_b32 s53,1792
s_mov_b64 exec,0x1ff
dp_123:
buffer_load_dword v185,v184,s[20:23],s52 offen sc1
s_waitcnt vmcnt(0)
v_cmp_ne_u32 vcc,s53,v185
s_cbranch_vccz dpok_124
s_sleep 2
s_sub_u32 s90,s90,1
s_cmp_gt_i32 s90,0
s_cbranch_scc1 dp_123
dpok_124:
s_mov_b64 exec,-1
s_branch lateb_122
first_112:
s_add_u32 s63,s79,0
s_and_b32 s64,s63,3
s_lshl_b32 s70,s64,20
s_add_u32 s65,s63,2
s_and_b32 s65,s65,3
s_lshl_b32 s73,s65,20
s_add_u32 s55,s63,3
s_lshl_b32 s78,s55,16
s_add_u32 s78,s78,57344
s_cmp_lt_u32 s55,64
s_cselect_b32 s78,s78,0x7fff0000
s_add_u32 s60,s63,1
s_lshl_b32 s76,s60,21
s_lshl_b32 s55,s60,13
s_and_b32 s55,s55,0x2000
s_xor_b32 s55,s55,s61
s_add_u32 s76,s76,s55
s_cmp_lt_u32 s60,64
s_cselect_b32 s76,s76,0x7fff0000
s_add_u32 s60,s63,2
s_lshl_b32 s12,s60,21
s_lshl_b32 s55,s60,13
s_and_b32 s55,s55,0x2000
s_xor_b32 s55,s55,s61
s_add_u32 s12,s12,s55
s_cmp_lt_u32 s60,64
s_cselect_b32 s12,s12,0x7fff0000
s_add_u32 s55,s63,5
s_min_u32 s55,s55,63
s_lshl_b32 s55,s55,16
s_lshl_b32 s60,s59,11
s_add_u32 s80,s55,s60
s_add_u32 s80,s80,57344
v_mov_b32 v176,0
v_mov_b32 v177,0
v_mov_b32 v178,0
v_mov_b32 v179,0
v_mov_b32 v180,0
v_mov_b32 v181,0
v_mov_b32 v182,0
v_mov_b32 v183,0
s_waitcnt vmcnt(0) lgkmcnt(0)
s_barrier
s_branch bge_119
pn_114:
s_add_u32 s63,s79,1
s_and_b32 s64,s63,3
s_lshl_b32 s70,s64,20
s_add_u32 s65,s63,2
s_and_b32 s65,s65,3
s_lshl_b32 s73,s65,20
s_add_u32 s55,s63,3
s_lshl_b32 s78,s55,16
s_add_u32 s78,s78,57344
s_cmp_lt_u32 s55,64
s_cselect_b32 s78,s78,0x7fff0000
s_add_u32 s60,s63,1
s_lshl_b32 s76,s60,21
s_lshl_b32 s55,s60,13
s_and_b32 s55,s55,0x2000
s_xor_b32 s55,s55,s61
s_add_u32 s76,s76,s55
s_cmp_lt_u32 s60,64
s_cselect_b32 s76,s76,0x7fff0000
s_add_u32 s60,s63,2
s_lshl_b32 s12,s60,21
s_lshl_b32 s55,s60,13
s_and_b32 s55,s55,0x2000
s_xor_b32 s55,s55,s61
s_add_u32 s12,s12,s55
s_cmp_lt_u32 s60,64
s_cselect_b32 s12,s12,0x7fff0000
s_add_u32 s55,s63,5
s_min_u32 s55,s55,63
s_lshl_b32 s55,s55,16
s_lshl_b32 s60,s59,11
s_add_u32 s80,s55,s60
s_add_u32 s80,s80,57344
v_mov_b32 v176,0
v_mov_b32 v177,0
v_mov_b32 v178,0
v_mov_b32 v179,0
v_mov_b32 v180,0
v_mov_b32 v181,0
v_mov_b32 v182,0
v_mov_b32 v183,0
s_add_u32 s79,s79,1
s_cmp_eq_u32 s79,0
s_cbranch_scc1 pn2_125
buffer_store_dwordx4 v[212:215],v12,s[20:23],s76 offen sc1
s_waitcnt vmcnt(0) lgkmcnt(0)
s_barrier
s_branch bge_119
pn2_125:
v_mov_b32 v25,1
s_waitcnt vmcnt(0) lgkmcnt(0)
s_barrier
s_branch loop_113
w3_56:
v_xor_b32 v9,0x10000,v8
v_xor_b32 v10,0x20000,v8
v_xor_b32 v11,0x30000,v8
v_and_b32 v22,2,v4
v_lshrrev_b32 v23,3,v3
v_add_u32 v22,v22,v23
v_lshlrev_b32 v22,3,v22
v_and_b32 v23,1,v4
v_lshl_add_u32 v22,v23,2,v22
v_and_b32 v23,3,v3
v_add_u32 v22,v22,v23
v_lshlrev_b32 v22,4,v22
v_bfe_u32 v23,v3,2,1
v_lshl_add_u32 v22,v23,3,v22
v_add_u32 v30,s66,v22
v_and_b32 v22,7,v3
v_lshl_add_u32 v12,v4,3,v22
v_lshlrev_b32 v12,4,v12
v_add_u32 v12,s66,v12
v_lshlrev_b32 v31,11,v22
v_lshl_add_u32 v31,v4,4,v31
s_branch first_126
loop_127:
s_barrier
buffer_load_dword v248,v18,s[20:23],s70 offen offset:0 sc1
s_nop 15
s_nop 5
hl_129:
buffer_load_dword v249,v18,s[20:23],s70 offen offset:0 sc1
s_waitcnt vmcnt(1)
v_cmp_eq_u32 vcc,v25,v248
s_bcnt1_i32_b32 s64,vcc_lo
s_cmp_ge_u32 s64,8
s_cbranch_scc1 hg_130
buffer_load_dword v248,v18,s[20:23],s70 offen offset:0 sc1
s_waitcnt vmcnt(1)
v_cmp_eq_u32 vcc,v25,v249
s_bcnt1_i32_b32 s64,vcc_lo
s_cmp_ge_u32 s64,8
s_cbranch_scc1 hg_130
s_sub_u32 s90,s90,1
s_cmp_gt_i32 s90,0
s_cbranch_scc1 hl_129
hg_130:
buffer_load_dwordx4 v[80:83],v29,s[20:23],s70 offen offset:0 sc1
buffer_load_dwordx4 v[84:87],v29,s[20:23],s70 offen offset:1024 sc1
buffer_load_dwordx4 v[88:91],v29,s[20:23],s70 offen offset:2048 sc1
buffer_load_dwordx4 v[92:95],v29,s[20:23],s70 offen offset:3072 sc1
s_waitcnt vmcnt(3)
ds_write_b128 v24,v[80:83] offset:12288
v_min3_u32 v22,v80,v81,v82
v_min_u32 v22,v22,v83
s_waitcnt vmcnt(2)
ds_write_b128 v24,v[84:87] offset:13312
v_min3_u32 v22,v22,v84,v85
v_min3_u32 v22,v22,v86,v87
s_waitcnt vmcnt(1)
ds_write_b128 v24,v[88:91] offset:14336
v_min3_u32 v22,v22,v88,v89
v_min3_u32 v22,v22,v90,v91
s_waitcnt vmcnt(0)
ds_write_b128 v24,v[92:95] offset:15360
v_min3_u32 v22,v22,v92,v93
v_min3_u32 v22,v22,v94,v95
v_cmp_eq_u32 vcc,0,v22
s_cbranch_vccnz art_131
abk_132:
v_smfmac_f32_16x16x64_bf16 v[176:179],v[80:83],a[96:103],v14
s_waitcnt lgkmcnt(0)
s_barrier
ds_read_b128 v[32:35],v24 offset:0
ds_read_b128 v[36:39],v24 offset:1024
ds_read_b128 v[40:43],v24 offset:2048
ds_read_b128 v[44:47],v24 offset:3072
v_smfmac_f32_16x16x64_bf16 v[176:179],v[84:87],a[104:111],v14
ds_read_b128 v[48:51],v24 offset:4096
ds_read_b128 v[52:55],v24 offset:5120
v_smfmac_f32_16x16x64_bf16 v[176:179],v[88:91],a[112:119],v14
ds_read_b128 v[56:59],v24 offset:6144
ds_read_b128 v[60:63],v24 offset:7168
v_smfmac_f32_16x16x64_bf16 v[176:179],v[92:95],a[120:127],v14
ds_read_b128 v[64:67],v24 offset:8192
ds_read_b128 v[68:71],v24 offset:9216
s_waitcnt lgkmcnt(9)
v_smfmac_f32_16x16x64_bf16 v[176:179],v[32:35],a[0:7],v14
ds_read_b128 v[72:75],v24 offset:10240
s_waitcnt lgkmcnt(9)
v_smfmac_f32_16x16x64_bf16 v[176:179],v[36:39],a[8:15],v14
ds_read_b128 v[76:79],v24 offset:11264
s_waitcnt lgkmcnt(9)
v_smfmac_f32_16x16x64_bf16 v[176:179],v[40:43],a[16:23],v14
s_waitcnt lgkmcnt(8)
v_smfmac_f32_16x16x64_bf16 v[176:179],v[44:47],a[24:31],v14
s_waitcnt lgkmcnt(7)
v_smfmac_f32_16x16x64_bf16 v[176:179],v[48:51],a[32:39],v14
s_waitcnt lgkmcnt(6)
v_smfmac_f32_16x16x64_bf16 v[176:179],v[52:55],a[40:47],v14
s_waitcnt lgkmcnt(5)
v_smfmac_f32_16x16x64_bf16 v[176:179],v[56:59],a[48:55],v14
s_waitcnt lgkmcnt(4)
v_smfmac_f32_16x16x64_bf16 v[176:179],v[60:63],a[56:63],v14
s_waitcnt lgkmcnt(3)
v_smfmac_f32_16x16x64_bf16 v[176:179],v[64:67],a[64:71],v14
s_waitcnt lgkmcnt(2)
v_smfmac_f32_16x16x64_bf16 v[176:179],v[68:71],a[72:79],v14
s_waitcnt lgkmcnt(1)
v_smfmac_f32_16x16x64_bf16 v[176:179],v[72:75],a[80:87],v14
s_waitcnt lgkmcnt(0)
v_smfmac_f32_16x16x64_bf16 v[176:179],v[76:79],a[88:95],v14
s_nop 7
v_permlane32_swap_b32 v176,v178
v_permlane32_swap_b32 v177,v179
v_add_f32 v176,v176,v178
v_add_f32 v177,v177,v179
v_cvt_pk_bf16_f32 v216,v176,v177
s_nop 1
v_mov_b32_dpp v217,v216 quad_perm:[1,0,3,2] row_mask:0xf bank_mask:0xf
v_perm_b32 v216,v217,v216,v15
v_max_u32 v216,1,v216
buffer_store_dword v216,v19,s[24:27],s70 offen
buffer_store_dword v216,v19,s[28:31],s70 offen sc1
s_cmp_eq_u32 s79,63
s_cbranch_scc1 end_52
s_nop 15
s_nop 15
s_nop 15
s_nop 15
s_nop 10
s_add_u32 m0,s62,53248
s_add_u32 s69,s78,53248
buffer_load_dwordx4 v16,s[20:23],s69 offen offset:0 lds
s_nop 3
buffer_load_dwordx4 v16,s[20:23],s69 offen offset:1024 lds
s_nop 3
buffer_load_dwordx4 v16,s[20:23],s69 offen offset:2048 lds
s_nop 3
buffer_load_dwordx4 v16,s[20:23],s69 offen offset:3072 lds
s_nop 3
s_add_u32 m0,s62,57344
s_add_u32 s69,s78,57344
buffer_load_dwordx4 v16,s[20:23],s69 offen offset:0 lds
s_nop 3
buffer_load_dwordx4 v16,s[20:23],s69 offen offset:1024 lds
s_nop 3
buffer_load_dwordx4 v16,s[20:23],s69 offen offset:2048 lds
s_nop 3
buffer_load_dwordx4 v16,s[20:23],s69 offen offset:3072 lds
s_nop 3
s_add_u32 m0,s62,61440
s_add_u32 s69,s78,61440
buffer_load_dwordx4 v16,s[20:23],s69 offen offset:0 lds
s_nop 3
buffer_load_dwordx4 v16,s[20:23],s69 offen offset:1024 lds
s_nop 3
buffer_load_dwordx4 v16,s[20:23],s69 offen offset:2048 lds
s_nop 3
buffer_load_dwordx4 v16,s[20:23],s69 offen offset:3072 lds
s_nop 3
s_xor_b32 s62,s62,0x10000
wf_133:
ds_read_b32 v23,v21 offset:8
s_sub_u32 s90,s90,1
s_waitcnt lgkmcnt(0)
v_cmp_ne_u32 vcc,v23,v25
s_cmp_lt_i32 s90,0
s_cselect_b64 vcc,0,vcc
s_cbranch_vccnz wf_133
hl_134:
buffer_load_dword v248,v18,s[20:23],s70 offen offset:512 sc1
s_waitcnt vmcnt(0)
v_cmp_eq_u32 vcc,v25,v248
s_bcnt1_i32_b32 s64,vcc_lo
s_cmp_ge_u32 s64,16
s_cbranch_scc1 hg_135
s_sub_u32 s90,s90,1
s_cmp_gt_i32 s90,0
s_cbranch_scc1 hl_134
hg_135:
buffer_load_dwordx4 v[32:35],v28,s[20:23],s71 offen offset:0 sc1
buffer_load_dwordx4 v[36:39],v28,s[20:23],s71 offen offset:1024 sc1
buffer_load_dwordx4 v[40:43],v28,s[20:23],s71 offen offset:2048 sc1
buffer_load_dwordx4 v[44:47],v28,s[20:23],s71 offen offset:3072 sc1
buffer_load_dwordx4 v[48:51],v29,s[20:23],s71 offen offset:0 sc1
buffer_load_dwordx4 v[52:55],v29,s[20:23],s71 offen offset:1024 sc1
buffer_load_dwordx4 v[56:59],v29,s[20:23],s71 offen offset:2048 sc1
buffer_load_dwordx4 v[60:63],v29,s[20:23],s71 offen offset:3072 sc1
s_mov_b32 s68,0
s_waitcnt vmcnt(6)
v_smfmac_f32_16x16x64_bf16 v[184:187],v[32:35],a[128:135],v14
v_min3_u32 v22,v32,v33,v34
v_min3_u32 v22,v22,v35,v36
v_smfmac_f32_16x16x64_bf16 v[188:191],v[32:35],a[136:143],v14
v_min3_u32 v22,v22,v37,v38
v_smfmac_f32_16x16x64_bf16 v[184:187],v[36:39],a[144:151],v14
v_min_u32 v22,v22,v39
v_smfmac_f32_16x16x64_bf16 v[188:191],v[36:39],a[152:159],v14
v_cmp_eq_u32 s[52:53],0,v22
s_waitcnt vmcnt(4)
v_smfmac_f32_16x16x64_bf16 v[184:187],v[40:43],a[160:167],v14
v_min3_u32 v22,v40,v41,v42
s_cmp_lg_u64 s[52:53],0
v_smfmac_f32_16x16x64_bf16 v[188:191],v[40:43],a[168:175],v14
s_cbranch_scc1 ms_136
bk_137:
v_min3_u32 v22,v22,v43,v44
v_smfmac_f32_16x16x64_bf16 v[184:187],v[44:47],a[176:183],v14
v_min3_u32 v22,v22,v45,v46
v_min_u32 v22,v22,v47
v_smfmac_f32_16x16x64_bf16 v[188:191],v[44:47],a[184:191],v14
v_cmp_eq_u32 s[54:55],0,v22
s_waitcnt vmcnt(2)
v_smfmac_f32_16x16x64_bf16 v[184:187],v[48:51],a[192:199],v14
v_min3_u32 v22,v48,v49,v50
s_cmp_lg_u64 s[54:55],0
v_smfmac_f32_16x16x64_bf16 v[188:191],v[48:51],a[200:207],v14
s_cbranch_scc1 ms_138
bk_139:
v_min3_u32 v22,v22,v51,v52
v_smfmac_f32_16x16x64_bf16 v[184:187],v[52:55],a[208:215],v14
v_min3_u32 v22,v22,v53,v54
v_min_u32 v22,v22,v55
v_smfmac_f32_16x16x64_bf16 v[188:191],v[52:55],a[216:223],v14
v_cmp_eq_u32 s[52:53],0,v22
s_waitcnt vmcnt(0)
v_smfmac_f32_16x16x64_bf16 v[184:187],v[56:59],a[224:231],v14
v_min3_u32 v22,v56,v57,v58
s_cmp_lg_u64 s[52:53],0
v_smfmac_f32_16x16x64_bf16 v[188:191],v[56:59],a[232:239],v14
s_cbranch_scc1 ms_140
bk_141:
v_min3_u32 v22,v22,v59,v60
v_smfmac_f32_16x16x64_bf16 v[184:187],v[60:63],a[240:247],v14
v_min3_u32 v22,v22,v61,v62
v_min_u32 v22,v22,v63
v_smfmac_f32_16x16x64_bf16 v[188:191],v[60:63],a[248:255],v14
v_cmp_eq_u32 s[54:55],0,v22
s_cmp_lg_u64 s[54:55],0
s_cbranch_scc1 ms_144
bk_145:
s_cmp_lg_u32 s68,0
s_cbranch_scc1 rl2_146
fin_142:
s_nop 2
v_permlane32_swap_b32 v184,v188
v_permlane32_swap_b32 v185,v189
v_permlane32_swap_b32 v186,v190
v_permlane32_swap_b32 v187,v191
v_pk_add_f32 v[184:185],v[184:185],v[188:189]
v_pk_add_f32 v[186:187],v[186:187],v[190:191]
wf_147:
ds_read_b32 v23,v21 offset:12
ds_read_b128 v[216:219],v24 offset:25600
s_sub_u32 s90,s90,1
s_waitcnt lgkmcnt(0)
v_cmp_ne_u32 vcc,v23,v25
s_cmp_lt_i32 s90,0
s_cselect_b64 vcc,0,vcc
v_pk_add_f32 v[216:217],v[216:217],v[184:185]
v_pk_add_f32 v[218:219],v[218:219],v[186:187]
s_cbranch_vccnz wf_147
v_max_u32 v216,1,v216
v_max_u32 v217,1,v217
v_max_u32 v218,1,v218
v_max_u32 v219,1,v219
buffer_store_dwordx4 v[216:219],v8,s[20:23],s74 offen sc1
s_mov_b32 s88,s74
s_mov_b32 s89,s72
v_add_u32 v25,1,v25
s_add_u32 s63,s79,1
s_and_b32 s64,s63,3
s_lshl_b32 s70,s64,20
s_add_u32 s65,s63,2
s_and_b32 s65,s65,3
s_lshl_b32 s73,s65,20
s_add_u32 s55,s63,3
s_lshl_b32 s78,s55,16
s_add_u32 s78,s78,57344
s_cmp_lt_u32 s55,64
s_cselect_b32 s78,s78,0x7fff0000
s_add_u32 s71,s70,65536
s_add_u32 s60,s63,1
s_and_b32 s60,s60,3
s_lshl_b32 s72,s60,20
v_mov_b32 v184,0
v_mov_b32 v185,0
v_mov_b32 v186,0
v_mov_b32 v187,0
v_mov_b32 v188,0
v_mov_b32 v189,0
v_mov_b32 v190,0
v_mov_b32 v191,0
s_lshl_b32 s74,s63,21
s_lshl_b32 s55,s63,13
s_and_b32 s55,s55,0x2000
s_xor_b32 s55,s55,s61
s_add_u32 s74,s74,s55
v_mov_b32 v176,0
v_mov_b32 v177,0
v_mov_b32 v178,0
v_mov_b32 v179,0
s_nop 15
s_nop 15
s_nop 15
s_nop 15
s_nop 5
pp_148:
buffer_load_dwordx4 v[32:35],v9,s[20:23],s88 offen sc1
buffer_load_dwordx4 v[36:39],v10,s[20:23],s88 offen sc1
buffer_load_dwordx4 v[40:43],v11,s[20:23],s88 offen sc1
s_waitcnt vmcnt(2)
v_min3_u32 v22,v32,v33,v34
v_pk_add_f32 v[220:221],v[216:217],v[32:33]
v_pk_add_f32 v[222:223],v[218:219],v[34:35]
s_waitcnt vmcnt(0)
v_min3_u32 v22,v22,v35,v36
v_min3_u32 v22,v22,v37,v38
v_min3_u32 v22,v22,v39,v40
v_min3_u32 v22,v22,v41,v42
v_min_u32 v22,v22,v43
v_pk_add_f32 v[36:37],v[36:37],v[40:41]
v_cmp_eq_u32 vcc,0,v22
v_pk_add_f32 v[38:39],v[38:39],v[42:43]
s_cbranch_vccz pok_149
s_sub_u32 s90,s90,1
s_cmp_gt_i32 s90,0
s_cbranch_scc1 pp_148
pok_149:
v_pk_add_f32 v[220:221],v[220:221],v[36:37]
v_pk_add_f32 v[222:223],v[222:223],v[38:39]
s_mov_b64 vcc,s[86:87]
v_cvt_pk_bf16_f32 v216,v220,v221
v_cvt_pk_bf16_f32 v217,v222,v223
s_nop 0
v_mov_b32_dpp v218,v216 quad_perm:[1,0,3,2] row_mask:0xf bank_mask:0xf
v_mov_b32_dpp v219,v217 quad_perm:[1,0,3,2] row_mask:0xf bank_mask:0xf
v_perm_b32 v216,v218,v216,v15
v_perm_b32 v217,v219,v217,v15
s_nop 1
v_cndmask_b32_dpp v220,v217,v216,vcc quad_perm:[2,3,0,1] row_mask:0xf bank_mask:0xf
s_not_b64 vcc,vcc
v_cndmask_b32_dpp v221,v216,v217,vcc quad_perm:[2,3,0,1] row_mask:0xf bank_mask:0xf
v_max_u32 v220,1,v220
v_max_u32 v221,1,v221
buffer_store_dwordx2 v[220:221],v30,s[24:27],s89 offen
buffer_store_dwordx2 v[220:221],v30,s[28:31],s89 offen sc1
s_mov_b64 exec,1
buffer_store_dword v25,v13,s[24:27],s89 offen
buffer_store_dword v25,v13,s[28:31],s89 offen sc1
s_mov_b64 exec,-1
s_add_u32 s79,s79,1
s_branch loop_127
art_131:
s_sub_u32 s90,s90,1
s_cmp_lt_i32 s90,0
s_cbranch_scc1 abk_132
buffer_load_dwordx4 v[80:83],v29,s[20:23],s70 offen offset:0 sc1
buffer_load_dwordx4 v[84:87],v29,s[20:23],s70 offen offset:1024 sc1
buffer_load_dwordx4 v[88:91],v29,s[20:23],s70 offen offset:2048 sc1
buffer_load_dwordx4 v[92:95],v29,s[20:23],s70 offen offset:3072 sc1
s_waitcnt vmcnt(3)
ds_write_b128 v24,v[80:83] offset:12288
v_min3_u32 v22,v80,v81,v82
v_min_u32 v22,v22,v83
s_waitcnt vmcnt(2)
ds_write_b128 v24,v[84:87] offset:13312
v_min3_u32 v22,v22,v84,v85
v_min3_u32 v22,v22,v86,v87
s_waitcnt vmcnt(1)
ds_write_b128 v24,v[88:91] offset:14336
v_min3_u32 v22,v22,v88,v89
v_min3_u32 v22,v22,v90,v91
s_waitcnt vmcnt(0)
ds_write_b128 v24,v[92:95] offset:15360
v_min3_u32 v22,v22,v92,v93
v_min3_u32 v22,v22,v94,v95
v_cmp_eq_u32 vcc,0,v22
s_cbranch_vccnz art_131
s_branch abk_132
ms_136:
s_waitcnt vmcnt(0)
buffer_load_dwordx4 v[64:67],v28,s[20:23],s71 offen offset:0 sc1
buffer_load_dwordx4 v[68:71],v28,s[20:23],s71 offen offset:1024 sc1
s_bitset1_b32 s68,0
s_branch bk_137
ms_138:
s_waitcnt vmcnt(0)
buffer_load_dwordx4 v[72:75],v28,s[20:23],s71 offen offset:2048 sc1
buffer_load_dwordx4 v[76:79],v28,s[20:23],s71 offen offset:3072 sc1
s_bitset1_b32 s68,1
s_branch bk_139
ms_140:
s_waitcnt vmcnt(0)
buffer_load_dwordx4 v[80:83],v29,s[20:23],s71 offen offset:0 sc1
buffer_load_dwordx4 v[84:87],v29,s[20:23],s71 offen offset:1024 sc1
s_bitset1_b32 s68,2
s_branch bk_141
ms_144:
s_waitcnt vmcnt(0)
buffer_load_dwordx4 v[88:91],v29,s[20:23],s71 offen offset:2048 sc1
buffer_load_dwordx4 v[92:95],v29,s[20:23],s71 offen offset:3072 sc1
s_bitset1_b32 s68,3
s_branch bk_145
rl_143:
s_bitcmp1_b32 s68,0
s_cbranch_scc0 sk_150
buffer_load_dwordx4 v[64:67],v28,s[20:23],s71 offen offset:0 sc1
buffer_load_dwordx4 v[68:71],v28,s[20:23],s71 offen offset:1024 sc1
sk_150:
s_bitcmp1_b32 s68,1
s_cbranch_scc0 sk_151
buffer_load_dwordx4 v[72:75],v28,s[20:23],s71 offen offset:2048 sc1
buffer_load_dwordx4 v[76:79],v28,s[20:23],s71 offen offset:3072 sc1
sk_151:
s_bitcmp1_b32 s68,2
s_cbranch_scc0 sk_152
buffer_load_dwordx4 v[80:83],v29,s[20:23],s71 offen offset:0 sc1
buffer_load_dwordx4 v[84:87],v29,s[20:23],s71 offen offset:1024 sc1
sk_152:
s_bitcmp1_b32 s68,3
s_cbranch_scc0 sk_153
buffer_load_dwordx4 v[88:91],v29,s[20:23],s71 offen offset:2048 sc1
buffer_load_dwordx4 v[92:95],v29,s[20:23],s71 offen offset:3072 sc1
sk_153:
rl2_146:
s_sub_u32 s90,s90,1
s_cmp_lt_i32 s90,0
s_cbranch_scc1 fin_142
s_waitcnt vmcnt(0)
s_bitcmp1_b32 s68,0
s_cbranch_scc0 sk_154
v_min3_u32 v22,v64,v65,v66
v_min3_u32 v22,v22,v67,v68
v_min3_u32 v22,v22,v69,v70
v_min_u32 v22,v22,v71
v_cmp_eq_u32 vcc,0,v22
v_xor_b32 v64,v32,v64
v_xor_b32 v65,v33,v65
v_xor_b32 v66,v34,v66
v_xor_b32 v67,v35,v67
v_xor_b32 v68,v36,v68
v_xor_b32 v69,v37,v69
v_xor_b32 v70,v38,v70
v_xor_b32 v71,v39,v71
s_cbranch_vccnz nb_155
s_bitset0_b32 s68,0
v_smfmac_f32_16x16x64_bf16 v[184:187],v[64:67],a[128:135],v14
v_smfmac_f32_16x16x64_bf16 v[188:191],v[64:67],a[136:143],v14
v_smfmac_f32_16x16x64_bf16 v[184:187],v[68:71],a[144:151],v14
v_smfmac_f32_16x16x64_bf16 v[188:191],v[68:71],a[152:159],v14
nb_155:
sk_154:
s_bitcmp1_b32 s68,1
s_cbranch_scc0 sk_156
v_min3_u32 v22,v72,v73,v74
v_min3_u32 v22,v22,v75,v76
v_min3_u32 v22,v22,v77,v78
v_min_u32 v22,v22,v79
v_cmp_eq_u32 vcc,0,v22
v_xor_b32 v72,v40,v72
v_xor_b32 v73,v41,v73
v_xor_b32 v74,v42,v74
v_xor_b32 v75,v43,v75
v_xor_b32 v76,v44,v76
v_xor_b32 v77,v45,v77
v_xor_b32 v78,v46,v78
v_xor_b32 v79,v47,v79
s_cbranch_vccnz nb_157
s_bitset0_b32 s68,1
v_smfmac_f32_16x16x64_bf16 v[184:187],v[72:75],a[160:167],v14
v_smfmac_f32_16x16x64_bf16 v[188:191],v[72:75],a[168:175],v14
v_smfmac_f32_16x16x64_bf16 v[184:187],v[76:79],a[176:183],v14
v_smfmac_f32_16x16x64_bf16 v[188:191],v[76:79],a[184:191],v14
nb_157:
sk_156:
s_bitcmp1_b32 s68,2
s_cbranch_scc0 sk_158
v_min3_u32 v22,v80,v81,v82
v_min3_u32 v22,v22,v83,v84
v_min3_u32 v22,v22,v85,v86
v_min_u32 v22,v22,v87
v_cmp_eq_u32 vcc,0,v22
v_xor_b32 v80,v48,v80
v_xor_b32 v81,v49,v81
v_xor_b32 v82,v50,v82
v_xor_b32 v83,v51,v83
v_xor_b32 v84,v52,v84
v_xor_b32 v85,v53,v85
v_xor_b32 v86,v54,v86
v_xor_b32 v87,v55,v87
s_cbranch_vccnz nb_159
s_bitset0_b32 s68,2
v_smfmac_f32_16x16x64_bf16 v[184:187],v[80:83],a[192:199],v14
v_smfmac_f32_16x16x64_bf16 v[188:191],v[80:83],a[200:207],v14
v_smfmac_f32_16x16x64_bf16 v[184:187],v[84:87],a[208:215],v14
v_smfmac_f32_16x16x64_bf16 v[188:191],v[84:87],a[216:223],v14
nb_159:
sk_158:
s_bitcmp1_b32 s68,3
s_cbranch_scc0 sk_160
v_min3_u32 v22,v88,v89,v90
v_min3_u32 v22,v22,v91,v92
v_min3_u32 v22,v22,v93,v94
v_min_u32 v22,v22,v95
v_cmp_eq_u32 vcc,0,v22
v_xor_b32 v88,v56,v88
v_xor_b32 v89,v57,v89
v_xor_b32 v90,v58,v90
v_xor_b32 v91,v59,v91
v_xor_b32 v92,v60,v92
v_xor_b32 v93,v61,v93
v_xor_b32 v94,v62,v94
v_xor_b32 v95,v63,v95
s_cbranch_vccnz nb_161
s_bitset0_b32 s68,3
v_smfmac_f32_16x16x64_bf16 v[184:187],v[88:91],a[224:231],v14
v_smfmac_f32_16x16x64_bf16 v[188:191],v[88:91],a[232:239],v14
v_smfmac_f32_16x16x64_bf16 v[184:187],v[92:95],a[240:247],v14
v_smfmac_f32_16x16x64_bf16 v[188:191],v[92:95],a[248:255],v14
nb_161:
sk_160:
s_cmp_lg_u32 s68,0
s_cbranch_scc1 rl_143
s_nop 2
s_branch fin_142
first_126:
s_waitcnt vmcnt(0) lgkmcnt(0)
s_barrier
s_mov_b32 s53,128
v_mov_b32 v184,0
dp_162:
buffer_load_dword v185,v184,s[44:47],36 offen sc1
s_waitcnt vmcnt(0)
v_cmp_ne_u32 vcc,s53,v185
s_cbranch_vccz dpok_163
s_sleep 4
s_sub_u32 s90,s90,1
s_cmp_gt_i32 s90,0
s_cbranch_scc1 dp_162
dpok_163:
s_barrier
s_mov_b32 m0,32768
s_mov_b32 s65,221184
buffer_load_dwordx4 v16,s[20:23],s65 offen offset:0 lds
buffer_load_dwordx4 v16,s[20:23],s65 offen offset:1024 lds
buffer_load_dwordx4 v16,s[20:23],s65 offen offset:2048 lds
buffer_load_dwordx4 v16,s[20:23],s65 offen offset:3072 lds
s_mov_b32 m0,36864
s_mov_b32 s65,225280
buffer_load_dwordx4 v16,s[20:23],s65 offen offset:0 lds
buffer_load_dwordx4 v16,s[20:23],s65 offen offset:1024 lds
buffer_load_dwordx4 v16,s[20:23],s65 offen offset:2048 lds
buffer_load_dwordx4 v16,s[20:23],s65 offen offset:3072 lds
s_mov_b32 m0,40960
s_mov_b32 s65,229376
buffer_load_dwordx4 v16,s[20:23],s65 offen offset:0 lds
buffer_load_dwordx4 v16,s[20:23],s65 offen offset:1024 lds
buffer_load_dwordx4 v16,s[20:23],s65 offen offset:2048 lds
buffer_load_dwordx4 v16,s[20:23],s65 offen offset:3072 lds
s_mov_b32 m0,45056
s_mov_b32 s65,233472
buffer_load_dwordx4 v16,s[20:23],s65 offen offset:0 lds
buffer_load_dwordx4 v16,s[20:23],s65 offen offset:1024 lds
buffer_load_dwordx4 v16,s[20:23],s65 offen offset:2048 lds
buffer_load_dwordx4 v16,s[20:23],s65 offen offset:3072 lds
s_mov_b32 m0,49152
s_mov_b32 s65,237568
buffer_load_dwordx4 v16,s[20:23],s65 offen offset:0 lds
buffer_load_dwordx4 v16,s[20:23],s65 offen offset:1024 lds
buffer_load_dwordx4 v16,s[20:23],s65 offen offset:2048 lds
buffer_load_dwordx4 v16,s[20:23],s65 offen offset:3072 lds
s_mov_b32 m0,53248
s_mov_b32 s65,241664
buffer_load_dwordx4 v16,s[20:23],s65 offen offset:0 lds
buffer_load_dwordx4 v16,s[20:23],s65 offen offset:1024 lds
buffer_load_dwordx4 v16,s[20:23],s65 offen offset:2048 lds
buffer_load_dwordx4 v16,s[20:23],s65 offen offset:3072 lds
s_mov_b32 m0,57344
s_mov_b32 s65,245760
buffer_load_dwordx4 v16,s[20:23],s65 offen offset:0 lds
buffer_load_dwordx4 v16,s[20:23],s65 offen offset:1024 lds
buffer_load_dwordx4 v16,s[20:23],s65 offen offset:2048 lds
buffer_load_dwordx4 v16,s[20:23],s65 offen offset:3072 lds
s_mov_b32 m0,61440
s_mov_b32 s65,249856
buffer_load_dwordx4 v16,s[20:23],s65 offen offset:0 lds
buffer_load_dwordx4 v16,s[20:23],s65 offen offset:1024 lds
buffer_load_dwordx4 v16,s[20:23],s65 offen offset:2048 lds
buffer_load_dwordx4 v16,s[20:23],s65 offen offset:3072 lds
s_mov_b32 s79,0
s_add_u32 s63,s79,0
s_and_b32 s64,s63,3
s_lshl_b32 s70,s64,20
s_add_u32 s65,s63,2
s_and_b32 s65,s65,3
s_lshl_b32 s73,s65,20
s_add_u32 s55,s63,3
s_lshl_b32 s78,s55,16
s_add_u32 s78,s78,57344
s_cmp_lt_u32 s55,64
s_cselect_b32 s78,s78,0x7fff0000
s_add_u32 s71,s70,65536
s_add_u32 s60,s63,1
s_and_b32 s60,s60,3
s_lshl_b32 s72,s60,20
v_mov_b32 v184,0
v_mov_b32 v185,0
v_mov_b32 v186,0
v_mov_b32 v187,0
v_mov_b32 v188,0
v_mov_b32 v189,0
v_mov_b32 v190,0
v_mov_b32 v191,0
s_lshl_b32 s74,s63,21
s_lshl_b32 s55,s63,13
s_and_b32 s55,s55,0x2000
s_xor_b32 s55,s55,s61
s_add_u32 s74,s74,s55
v_mov_b32 v176,0
v_mov_b32 v177,0
v_mov_b32 v178,0
v_mov_b32 v179,0
v_mov_b32 v25,1
s_waitcnt vmcnt(0) lgkmcnt(0)
s_barrier
s_lshl_b32 s64,s59,6
buffer_load_dwordx4 v[216:219],v31,s[8:11],s64 offen
s_waitcnt vmcnt(0)
v_max_u32 v216,1,v216
v_max_u32 v217,1,v217
v_max_u32 v218,1,v218
v_max_u32 v219,1,v219
s_mov_b64 exec,s[84:85]
buffer_store_dwordx4 v[216:219],v12,s[24:27],s70 offen
buffer_store_dwordx4 v[216:219],v12,s[28:31],s70 offen sc1
s_mov_b64 exec,1
buffer_store_dword v25,v13,s[24:27],s70 offen
buffer_store_dword v25,v13,s[28:31],s70 offen sc1
s_mov_b64 exec,-1
s_branch loop_127
end_52:
s_waitcnt vmcnt(0)
s_barrier
s_mov_b32 s50,s91
done_1:
s_endpgm
pipe_worker:
v_and_b32 v1,63,v0
v_and_b32 v3,15,v1
v_lshrrev_b32 v4,4,v1
v_lshlrev_b32 v16,4,v1
v_mov_b32 v128,0
v_mov_b32 v129,0
v_mov_b32 v130,0
v_mov_b32 v131,0
s_lshr_b32 s58,s55,5
s_and_b32 s59,s55,31
s_xor_b32 s62,s61,0x2000
s_add_u32 s63,s62,21053440
s_load_dwordx2 s[4:5],s[0:1],16
v_lshlrev_b32 v5,4,v0
s_lshl_b32 s64,s55,14
s_add_u32 s64,s64,17825792
buffer_store_dwordx4 v[128:131],v5,s[20:23],s64 offen sc1
s_add_u32 s64,s64,4096
buffer_store_dwordx4 v[128:131],v5,s[20:23],s64 offen sc1
s_add_u32 s64,s64,4096
buffer_store_dwordx4 v[128:131],v5,s[20:23],s64 offen sc1
s_add_u32 s64,s64,4096
buffer_store_dwordx4 v[128:131],v5,s[20:23],s64 offen sc1
s_add_u32 s64,s64,4096
s_and_b32 s79,s55,1
s_add_u32 s64,s79,0
s_lshl_b32 s65,s64,21
s_lshl_b32 s64,s64,13
s_and_b32 s64,s64,0x2000
s_xor_b32 s64,s64,s62
s_add_u32 s65,s65,s64
s_add_u32 s65,s65,29360128
s_lshr_b32 s64,s55,1
s_lshl_b32 s64,s64,14
s_add_u32 s65,s65,s64
s_add_u32 s65,s65,524288
s_add_u32 s64,s65,4096
buffer_store_dwordx4 v[128:131],v5,s[20:23],s65 offen sc1
buffer_store_dwordx4 v[128:131],v5,s[20:23],s64 offen sc1
s_cmp_ge_u32 s55,32
s_cbranch_scc1 nopz2_166
s_add_u32 s65,s65,1048576
s_add_u32 s64,s65,4096
buffer_store_dwordx4 v[128:131],v5,s[20:23],s65 offen sc1
buffer_store_dwordx4 v[128:131],v5,s[20:23],s64 offen sc1
nopz2_166:
s_cmp_ge_u32 s55,120
s_cbranch_scc1 nopz_165
s_lshr_b32 s79,s55,1
s_add_u32 s64,s79,4
s_lshl_b32 s65,s64,21
s_lshl_b32 s64,s64,13
s_and_b32 s64,s64,0x2000
s_xor_b32 s64,s64,s61
s_add_u32 s65,s65,s64
s_add_u32 s65,s65,29360128
s_and_b32 s64,s55,1
s_lshl_b32 s64,s64,18
s_add_u32 s65,s65,s64
s_add_u32 s65,s65,1572864
buffer_store_dwordx4 v[128:131],v5,s[20:23],s65 offen sc1
s_add_u32 s65,s65,4096
buffer_store_dwordx4 v[128:131],v5,s[20:23],s65 offen sc1
s_add_u32 s65,s65,12288
buffer_store_dwordx4 v[128:131],v5,s[20:23],s65 offen sc1
s_add_u32 s65,s65,4096
buffer_store_dwordx4 v[128:131],v5,s[20:23],s65 offen sc1
s_add_u32 s65,s65,12288
buffer_store_dwordx4 v[128:131],v5,s[20:23],s65 offen sc1
s_add_u32 s65,s65,4096
buffer_store_dwordx4 v[128:131],v5,s[20:23],s65 offen sc1
s_add_u32 s65,s65,12288
buffer_store_dwordx4 v[128:131],v5,s[20:23],s65 offen sc1
s_add_u32 s65,s65,4096
buffer_store_dwordx4 v[128:131],v5,s[20:23],s65 offen sc1
s_add_u32 s65,s65,12288
buffer_store_dwordx4 v[128:131],v5,s[20:23],s65 offen sc1
s_add_u32 s65,s65,4096
buffer_store_dwordx4 v[128:131],v5,s[20:23],s65 offen sc1
s_add_u32 s65,s65,12288
buffer_store_dwordx4 v[128:131],v5,s[20:23],s65 offen sc1
s_add_u32 s65,s65,4096
buffer_store_dwordx4 v[128:131],v5,s[20:23],s65 offen sc1
s_add_u32 s65,s65,12288
buffer_store_dwordx4 v[128:131],v5,s[20:23],s65 offen sc1
s_add_u32 s65,s65,4096
buffer_store_dwordx4 v[128:131],v5,s[20:23],s65 offen sc1
s_add_u32 s65,s65,12288
buffer_store_dwordx4 v[128:131],v5,s[20:23],s65 offen sc1
s_add_u32 s65,s65,4096
buffer_store_dwordx4 v[128:131],v5,s[20:23],s65 offen sc1
s_add_u32 s65,s65,12288
buffer_store_dwordx4 v[128:131],v5,s[20:23],s65 offen sc1
s_add_u32 s65,s65,4096
buffer_store_dwordx4 v[128:131],v5,s[20:23],s65 offen sc1
s_add_u32 s65,s65,12288
buffer_store_dwordx4 v[128:131],v5,s[20:23],s65 offen sc1
s_add_u32 s65,s65,4096
buffer_store_dwordx4 v[128:131],v5,s[20:23],s65 offen sc1
s_add_u32 s65,s65,12288
buffer_store_dwordx4 v[128:131],v5,s[20:23],s65 offen sc1
s_add_u32 s65,s65,4096
buffer_store_dwordx4 v[128:131],v5,s[20:23],s65 offen sc1
s_add_u32 s65,s65,12288
buffer_store_dwordx4 v[128:131],v5,s[20:23],s65 offen sc1
s_add_u32 s65,s65,4096
buffer_store_dwordx4 v[128:131],v5,s[20:23],s65 offen sc1
s_add_u32 s65,s65,12288
buffer_store_dwordx4 v[128:131],v5,s[20:23],s65 offen sc1
s_add_u32 s65,s65,4096
buffer_store_dwordx4 v[128:131],v5,s[20:23],s65 offen sc1
s_add_u32 s65,s65,12288
buffer_store_dwordx4 v[128:131],v5,s[20:23],s65 offen sc1
s_add_u32 s65,s65,4096
buffer_store_dwordx4 v[128:131],v5,s[20:23],s65 offen sc1
s_add_u32 s65,s65,12288
buffer_store_dwordx4 v[128:131],v5,s[20:23],s65 offen sc1
s_add_u32 s65,s65,4096
buffer_store_dwordx4 v[128:131],v5,s[20:23],s65 offen sc1
s_add_u32 s65,s65,12288
buffer_store_dwordx4 v[128:131],v5,s[20:23],s65 offen sc1
s_add_u32 s65,s65,4096
buffer_store_dwordx4 v[128:131],v5,s[20:23],s65 offen sc1
s_add_u32 s65,s65,12288
nopz_165:
s_waitcnt lgkmcnt(0)
s_mov_b32 s32,s4
s_and_b32 s33,s5,0xffff
s_mov_b32 s34,0x800000
s_mov_b32 s35,0x20000
v_lshrrev_b32 v5,3,v3
v_bfe_u32 v6,v3,2,1
v_lshl_add_u32 v7,v5,3,v6
v_lshl_add_u32 v6,v5,2,v6
v_lshrrev_b32 v5,1,v4
v_lshl_add_u32 v7,v5,4,v7
v_and_b32 v5,1,v4
v_lshl_add_u32 v7,v5,2,v7
v_lshl_add_u32 v6,v5,1,v6
v_bfe_u32 v5,v3,1,1
s_lshl_b32 s64,s50,1
v_add_u32 v5,s64,v5
v_xor_b32 v5,v5,v6
v_lshlrev_b32 v5,5,v5
v_lshl_add_u32 v5,v7,8,v5
v_and_b32 v6,1,v3
v_lshl_add_u32 v12,v6,4,v5
s_lshl_b32 s66,s59,8
v_and_b32 v5,15,v1
v_and_b32 v6,1,v4
v_lshlrev_b32 v6,1,v6
v_xor_b32 v5,v5,v6
v_mul_u32_u24 v6,8192,v4
v_xor_b32 v7,0,v5
v_lshl_add_u32 v8,v7,4,v6
v_xor_b32 v7,4,v5
v_lshl_add_u32 v9,v7,4,v6
v_xor_b32 v7,8,v5
v_lshl_add_u32 v10,v7,4,v6
v_xor_b32 v7,12,v5
v_lshl_add_u32 v11,v7,4,v6
s_mul_i32 s74,s50,524288
s_add_u32 s74,s74,s66
s_lshl_b32 s75,s50,14
s_mul_i32 s76,s50,262144
s_add_u32 s76,s76,s66
s_lshl_b32 s77,s50,13
s_add_u32 s64,s74,0
s_add_u32 m0,s75,0
s_nop 0
buffer_load_dwordx4 v8,s[32:35],s64 offen  lds
s_add_u32 s64,s74,32768
s_add_u32 m0,s75,1024
s_nop 0
buffer_load_dwordx4 v9,s[32:35],s64 offen  lds
s_add_u32 s64,s74,65536
s_add_u32 m0,s75,2048
s_nop 0
buffer_load_dwordx4 v10,s[32:35],s64 offen  lds
s_add_u32 s64,s74,98304
s_add_u32 m0,s75,3072
s_nop 0
buffer_load_dwordx4 v11,s[32:35],s64 offen  lds
s_add_u32 s64,s74,131072
s_add_u32 m0,s75,4096
s_nop 0
buffer_load_dwordx4 v8,s[32:35],s64 offen  lds
s_add_u32 s64,s74,163840
s_add_u32 m0,s75,5120
s_nop 0
buffer_load_dwordx4 v9,s[32:35],s64 offen  lds
s_add_u32 s64,s74,196608
s_add_u32 m0,s75,6144
s_nop 0
buffer_load_dwordx4 v10,s[32:35],s64 offen  lds
s_add_u32 s64,s74,229376
s_add_u32 m0,s75,7168
s_nop 0
buffer_load_dwordx4 v11,s[32:35],s64 offen  lds
s_add_u32 s64,s74,262144
s_add_u32 m0,s75,8192
s_nop 0
buffer_load_dwordx4 v8,s[32:35],s64 offen  lds
s_add_u32 s64,s74,294912
s_add_u32 m0,s75,9216
s_nop 0
buffer_load_dwordx4 v9,s[32:35],s64 offen  lds
s_add_u32 s64,s74,327680
s_add_u32 m0,s75,10240
s_nop 0
buffer_load_dwordx4 v10,s[32:35],s64 offen  lds
s_add_u32 s64,s74,360448
s_add_u32 m0,s75,11264
s_nop 0
buffer_load_dwordx4 v11,s[32:35],s64 offen  lds
s_add_u32 s64,s74,393216
s_add_u32 m0,s75,12288
s_nop 0
buffer_load_dwordx4 v8,s[32:35],s64 offen  lds
s_add_u32 s64,s74,425984
s_add_u32 m0,s75,13312
s_nop 0
buffer_load_dwordx4 v9,s[32:35],s64 offen  lds
s_add_u32 s64,s74,458752
s_add_u32 m0,s75,14336
s_nop 0
buffer_load_dwordx4 v10,s[32:35],s64 offen  lds
s_add_u32 s64,s74,491520
s_add_u32 m0,s75,15360
s_nop 0
buffer_load_dwordx4 v11,s[32:35],s64 offen  lds
s_add_u32 s64,s74,2097152
s_add_u32 m0,s75,65536
s_nop 0
buffer_load_dwordx4 v8,s[32:35],s64 offen  lds
s_add_u32 s64,s74,2129920
s_add_u32 m0,s75,66560
s_nop 0
buffer_load_dwordx4 v9,s[32:35],s64 offen  lds
s_add_u32 s64,s74,2162688
s_add_u32 m0,s75,67584
s_nop 0
buffer_load_dwordx4 v10,s[32:35],s64 offen  lds
s_add_u32 s64,s74,2195456
s_add_u32 m0,s75,68608
s_nop 0
buffer_load_dwordx4 v11,s[32:35],s64 offen  lds
s_add_u32 s64,s74,2228224
s_add_u32 m0,s75,69632
s_nop 0
buffer_load_dwordx4 v8,s[32:35],s64 offen  lds
s_add_u32 s64,s74,2260992
s_add_u32 m0,s75,70656
s_nop 0
buffer_load_dwordx4 v9,s[32:35],s64 offen  lds
s_add_u32 s64,s74,2293760
s_add_u32 m0,s75,71680
s_nop 0
buffer_load_dwordx4 v10,s[32:35],s64 offen  lds
s_add_u32 s64,s74,2326528
s_add_u32 m0,s75,72704
s_nop 0
buffer_load_dwordx4 v11,s[32:35],s64 offen  lds
s_add_u32 s64,s74,2359296
s_add_u32 m0,s75,73728
s_nop 0
buffer_load_dwordx4 v8,s[32:35],s64 offen  lds
s_add_u32 s64,s74,2392064
s_add_u32 m0,s75,74752
s_nop 0
buffer_load_dwordx4 v9,s[32:35],s64 offen  lds
s_add_u32 s64,s74,2424832
s_add_u32 m0,s75,75776
s_nop 0
buffer_load_dwordx4 v10,s[32:35],s64 offen  lds
s_add_u32 s64,s74,2457600
s_add_u32 m0,s75,76800
s_nop 0
buffer_load_dwordx4 v11,s[32:35],s64 offen  lds
s_add_u32 s64,s74,2490368
s_add_u32 m0,s75,77824
s_nop 0
buffer_load_dwordx4 v8,s[32:35],s64 offen  lds
s_add_u32 s64,s74,2523136
s_add_u32 m0,s75,78848
s_nop 0
buffer_load_dwordx4 v9,s[32:35],s64 offen  lds
s_add_u32 s64,s74,2555904
s_add_u32 m0,s75,79872
s_nop 0
buffer_load_dwordx4 v10,s[32:35],s64 offen  lds
s_add_u32 s64,s74,2588672
s_add_u32 m0,s75,80896
s_nop 0
buffer_load_dwordx4 v11,s[32:35],s64 offen  lds
s_waitcnt vmcnt(16)
s_barrier
s_cmp_lg_u32 s50,0
s_cbranch_scc1 ow_167
s_mov_b64 exec,1
v_mov_b32 v22,14
v_mov_b32 v23,0
s_mov_b32 s64,21052928
buffer_atomic_add v22,v23,s[20:23],s64 offen sc1
s_mov_b64 exec,-1
ow_167:
ds_read_b64_tr_b16 a[0:1],v12 offset:0
ds_read_b64_tr_b16 a[2:3],v12 offset:512
ds_read_b64_tr_b16 a[128:129],v12 offset:8
ds_read_b64_tr_b16 a[130:131],v12 offset:520
ds_read_b64_tr_b16 a[4:5],v12 offset:8192
ds_read_b64_tr_b16 a[6:7],v12 offset:8704
ds_read_b64_tr_b16 a[132:133],v12 offset:8200
ds_read_b64_tr_b16 a[134:135],v12 offset:8712
s_waitcnt lgkmcnt(4)
ds_read_b64_tr_b16 a[8:9],v12 offset:16384
ds_read_b64_tr_b16 a[10:11],v12 offset:16896
ds_read_b64_tr_b16 a[136:137],v12 offset:16392
ds_read_b64_tr_b16 a[138:139],v12 offset:16904
ds_read_b64_tr_b16 a[12:13],v12 offset:24576
ds_read_b64_tr_b16 a[14:15],v12 offset:25088
ds_read_b64_tr_b16 a[140:141],v12 offset:24584
ds_read_b64_tr_b16 a[142:143],v12 offset:25096
s_waitcnt lgkmcnt(4)
ds_read_b64_tr_b16 a[16:17],v12 offset:32768
ds_read_b64_tr_b16 a[18:19],v12 offset:33280
ds_read_b64_tr_b16 a[144:145],v12 offset:32776
ds_read_b64_tr_b16 a[146:147],v12 offset:33288
ds_read_b64_tr_b16 a[20:21],v12 offset:40960
ds_read_b64_tr_b16 a[22:23],v12 offset:41472
ds_read_b64_tr_b16 a[148:149],v12 offset:40968
ds_read_b64_tr_b16 a[150:151],v12 offset:41480
s_waitcnt lgkmcnt(4)
ds_read_b64_tr_b16 a[24:25],v12 offset:49152
ds_read_b64_tr_b16 a[26:27],v12 offset:49664
ds_read_b64_tr_b16 a[152:153],v12 offset:49160
ds_read_b64_tr_b16 a[154:155],v12 offset:49672
ds_read_b64_tr_b16 a[28:29],v12 offset:57344
ds_read_b64_tr_b16 a[30:31],v12 offset:57856
ds_read_b64_tr_b16 a[156:157],v12 offset:57352
ds_read_b64_tr_b16 a[158:159],v12 offset:57864
s_waitcnt lgkmcnt(4)
v_xor_b32 v12,0x10000,v12
s_waitcnt lgkmcnt(0)
s_barrier
s_add_u32 s64,s74,4194304
s_add_u32 m0,s75,0
s_nop 0
buffer_load_dwordx4 v8,s[32:35],s64 offen  lds
s_add_u32 s64,s74,4227072
s_add_u32 m0,s75,1024
s_nop 0
buffer_load_dwordx4 v9,s[32:35],s64 offen  lds
s_add_u32 s64,s74,4259840
s_add_u32 m0,s75,2048
s_nop 0
buffer_load_dwordx4 v10,s[32:35],s64 offen  lds
s_add_u32 s64,s74,4292608
s_add_u32 m0,s75,3072
s_nop 0
buffer_load_dwordx4 v11,s[32:35],s64 offen  lds
s_add_u32 s64,s74,4325376
s_add_u32 m0,s75,4096
s_nop 0
buffer_load_dwordx4 v8,s[32:35],s64 offen  lds
s_add_u32 s64,s74,4358144
s_add_u32 m0,s75,5120
s_nop 0
buffer_load_dwordx4 v9,s[32:35],s64 offen  lds
s_add_u32 s64,s74,4390912
s_add_u32 m0,s75,6144
s_nop 0
buffer_load_dwordx4 v10,s[32:35],s64 offen  lds
s_add_u32 s64,s74,4423680
s_add_u32 m0,s75,7168
s_nop 0
buffer_load_dwordx4 v11,s[32:35],s64 offen  lds
s_add_u32 s64,s74,4456448
s_add_u32 m0,s75,8192
s_nop 0
buffer_load_dwordx4 v8,s[32:35],s64 offen  lds
s_add_u32 s64,s74,4489216
s_add_u32 m0,s75,9216
s_nop 0
buffer_load_dwordx4 v9,s[32:35],s64 offen  lds
s_add_u32 s64,s74,4521984
s_add_u32 m0,s75,10240
s_nop 0
buffer_load_dwordx4 v10,s[32:35],s64 offen  lds
s_add_u32 s64,s74,4554752
s_add_u32 m0,s75,11264
s_nop 0
buffer_load_dwordx4 v11,s[32:35],s64 offen  lds
s_add_u32 s64,s74,4587520
s_add_u32 m0,s75,12288
s_nop 0
buffer_load_dwordx4 v8,s[32:35],s64 offen  lds
s_add_u32 s64,s74,4620288
s_add_u32 m0,s75,13312
s_nop 0
buffer_load_dwordx4 v9,s[32:35],s64 offen  lds
s_add_u32 s64,s74,4653056
s_add_u32 m0,s75,14336
s_nop 0
buffer_load_dwordx4 v10,s[32:35],s64 offen  lds
s_add_u32 s64,s74,4685824
s_add_u32 m0,s75,15360
s_nop 0
buffer_load_dwordx4 v11,s[32:35],s64 offen  lds
s_waitcnt vmcnt(16)
s_barrier
ds_read_b64_tr_b16 a[32:33],v12 offset:0
ds_read_b64_tr_b16 a[34:35],v12 offset:512
ds_read_b64_tr_b16 a[160:161],v12 offset:8
ds_read_b64_tr_b16 a[162:163],v12 offset:520
ds_read_b64_tr_b16 a[36:37],v12 offset:8192
ds_read_b64_tr_b16 a[38:39],v12 offset:8704
ds_read_b64_tr_b16 a[164:165],v12 offset:8200
ds_read_b64_tr_b16 a[166:167],v12 offset:8712
s_waitcnt lgkmcnt(4)
ds_read_b64_tr_b16 a[40:41],v12 offset:16384
ds_read_b64_tr_b16 a[42:43],v12 offset:16896
ds_read_b64_tr_b16 a[168:169],v12 offset:16392
ds_read_b64_tr_b16 a[170:171],v12 offset:16904
ds_read_b64_tr_b16 a[44:45],v12 offset:24576
ds_read_b64_tr_b16 a[46:47],v12 offset:25088
ds_read_b64_tr_b16 a[172:173],v12 offset:24584
ds_read_b64_tr_b16 a[174:175],v12 offset:25096
s_waitcnt lgkmcnt(4)
ds_read_b64_tr_b16 a[48:49],v12 offset:32768
ds_read_b64_tr_b16 a[50:51],v12 offset:33280
ds_read_b64_tr_b16 a[176:177],v12 offset:32776
ds_read_b64_tr_b16 a[178:179],v12 offset:33288
ds_read_b64_tr_b16 a[52:53],v12 offset:40960
ds_read_b64_tr_b16 a[54:55],v12 offset:41472
ds_read_b64_tr_b16 a[180:181],v12 offset:40968
ds_read_b64_tr_b16 a[182:183],v12 offset:41480
s_waitcnt lgkmcnt(4)
ds_read_b64_tr_b16 a[56:57],v12 offset:49152
ds_read_b64_tr_b16 a[58:59],v12 offset:49664
ds_read_b64_tr_b16 a[184:185],v12 offset:49160
ds_read_b64_tr_b16 a[186:187],v12 offset:49672
ds_read_b64_tr_b16 a[60:61],v12 offset:57344
ds_read_b64_tr_b16 a[62:63],v12 offset:57856
ds_read_b64_tr_b16 a[188:189],v12 offset:57352
ds_read_b64_tr_b16 a[190:191],v12 offset:57864
s_waitcnt lgkmcnt(4)
v_xor_b32 v12,0x10000,v12
s_waitcnt lgkmcnt(0)
s_barrier
s_add_u32 s64,s74,6291456
s_add_u32 m0,s75,65536
s_nop 0
buffer_load_dwordx4 v8,s[32:35],s64 offen  lds
s_add_u32 s64,s74,6324224
s_add_u32 m0,s75,66560
s_nop 0
buffer_load_dwordx4 v9,s[32:35],s64 offen  lds
s_add_u32 s64,s74,6356992
s_add_u32 m0,s75,67584
s_nop 0
buffer_load_dwordx4 v10,s[32:35],s64 offen  lds
s_add_u32 s64,s74,6389760
s_add_u32 m0,s75,68608
s_nop 0
buffer_load_dwordx4 v11,s[32:35],s64 offen  lds
s_add_u32 s64,s74,6422528
s_add_u32 m0,s75,69632
s_nop 0
buffer_load_dwordx4 v8,s[32:35],s64 offen  lds
s_add_u32 s64,s74,6455296
s_add_u32 m0,s75,70656
s_nop 0
buffer_load_dwordx4 v9,s[32:35],s64 offen  lds
s_add_u32 s64,s74,6488064
s_add_u32 m0,s75,71680
s_nop 0
buffer_load_dwordx4 v10,s[32:35],s64 offen  lds
s_add_u32 s64,s74,6520832
s_add_u32 m0,s75,72704
s_nop 0
buffer_load_dwordx4 v11,s[32:35],s64 offen  lds
s_add_u32 s64,s74,6553600
s_add_u32 m0,s75,73728
s_nop 0
buffer_load_dwordx4 v8,s[32:35],s64 offen  lds
s_add_u32 s64,s74,6586368
s_add_u32 m0,s75,74752
s_nop 0
buffer_load_dwordx4 v9,s[32:35],s64 offen  lds
s_add_u32 s64,s74,6619136
s_add_u32 m0,s75,75776
s_nop 0
buffer_load_dwordx4 v10,s[32:35],s64 offen  lds
s_add_u32 s64,s74,6651904
s_add_u32 m0,s75,76800
s_nop 0
buffer_load_dwordx4 v11,s[32:35],s64 offen  lds
s_add_u32 s64,s74,6684672
s_add_u32 m0,s75,77824
s_nop 0
buffer_load_dwordx4 v8,s[32:35],s64 offen  lds
s_add_u32 s64,s74,6717440
s_add_u32 m0,s75,78848
s_nop 0
buffer_load_dwordx4 v9,s[32:35],s64 offen  lds
s_add_u32 s64,s74,6750208
s_add_u32 m0,s75,79872
s_nop 0
buffer_load_dwordx4 v10,s[32:35],s64 offen  lds
s_add_u32 s64,s74,6782976
s_add_u32 m0,s75,80896
s_nop 0
buffer_load_dwordx4 v11,s[32:35],s64 offen  lds
s_waitcnt vmcnt(16)
s_barrier
ds_read_b64_tr_b16 a[64:65],v12 offset:0
ds_read_b64_tr_b16 a[66:67],v12 offset:512
ds_read_b64_tr_b16 a[192:193],v12 offset:8
ds_read_b64_tr_b16 a[194:195],v12 offset:520
ds_read_b64_tr_b16 a[68:69],v12 offset:8192
ds_read_b64_tr_b16 a[70:71],v12 offset:8704
ds_read_b64_tr_b16 a[196:197],v12 offset:8200
ds_read_b64_tr_b16 a[198:199],v12 offset:8712
s_waitcnt lgkmcnt(4)
ds_read_b64_tr_b16 a[72:73],v12 offset:16384
ds_read_b64_tr_b16 a[74:75],v12 offset:16896
ds_read_b64_tr_b16 a[200:201],v12 offset:16392
ds_read_b64_tr_b16 a[202:203],v12 offset:16904
ds_read_b64_tr_b16 a[76:77],v12 offset:24576
ds_read_b64_tr_b16 a[78:79],v12 offset:25088
ds_read_b64_tr_b16 a[204:205],v12 offset:24584
ds_read_b64_tr_b16 a[206:207],v12 offset:25096
s_waitcnt lgkmcnt(4)
ds_read_b64_tr_b16 a[80:81],v12 offset:32768
ds_read_b64_tr_b16 a[82:83],v12 offset:33280
ds_read_b64_tr_b16 a[208:209],v12 offset:32776
ds_read_b64_tr_b16 a[210:211],v12 offset:33288
ds_read_b64_tr_b16 a[84:85],v12 offset:40960
ds_read_b64_tr_b16 a[86:87],v12 offset:41472
ds_read_b64_tr_b16 a[212:213],v12 offset:40968
ds_read_b64_tr_b16 a[214:215],v12 offset:41480
s_waitcnt lgkmcnt(4)
ds_read_b64_tr_b16 a[88:89],v12 offset:49152
ds_read_b64_tr_b16 a[90:91],v12 offset:49664
ds_read_b64_tr_b16 a[216:217],v12 offset:49160
ds_read_b64_tr_b16 a[218:219],v12 offset:49672
ds_read_b64_tr_b16 a[92:93],v12 offset:57344
ds_read_b64_tr_b16 a[94:95],v12 offset:57856
ds_read_b64_tr_b16 a[220:221],v12 offset:57352
ds_read_b64_tr_b16 a[222:223],v12 offset:57864
s_waitcnt lgkmcnt(4)
v_xor_b32 v12,0x10000,v12
s_waitcnt lgkmcnt(0)
s_barrier
s_waitcnt vmcnt(0)
s_barrier
ds_read_b64_tr_b16 a[96:97],v12 offset:0
ds_read_b64_tr_b16 a[98:99],v12 offset:512
ds_read_b64_tr_b16 a[224:225],v12 offset:8
ds_read_b64_tr_b16 a[226:227],v12 offset:520
ds_read_b64_tr_b16 a[100:101],v12 offset:8192
ds_read_b64_tr_b16 a[102:103],v12 offset:8704
ds_read_b64_tr_b16 a[228:229],v12 offset:8200
ds_read_b64_tr_b16 a[230:231],v12 offset:8712
s_waitcnt lgkmcnt(4)
ds_read_b64_tr_b16 a[104:105],v12 offset:16384
ds_read_b64_tr_b16 a[106:107],v12 offset:16896
ds_read_b64_tr_b16 a[232:233],v12 offset:16392
ds_read_b64_tr_b16 a[234:235],v12 offset:16904
ds_read_b64_tr_b16 a[108:109],v12 offset:24576
ds_read_b64_tr_b16 a[110:111],v12 offset:25088
ds_read_b64_tr_b16 a[236:237],v12 offset:24584
ds_read_b64_tr_b16 a[238:239],v12 offset:25096
s_waitcnt lgkmcnt(4)
ds_read_b64_tr_b16 a[112:113],v12 offset:32768
ds_read_b64_tr_b16 a[114:115],v12 offset:33280
ds_read_b64_tr_b16 a[240:241],v12 offset:32776
ds_read_b64_tr_b16 a[242:243],v12 offset:33288
ds_read_b64_tr_b16 a[116:117],v12 offset:40960
ds_read_b64_tr_b16 a[118:119],v12 offset:41472
ds_read_b64_tr_b16 a[244:245],v12 offset:40968
ds_read_b64_tr_b16 a[246:247],v12 offset:41480
s_waitcnt lgkmcnt(4)
ds_read_b64_tr_b16 a[120:121],v12 offset:49152
ds_read_b64_tr_b16 a[122:123],v12 offset:49664
ds_read_b64_tr_b16 a[248:249],v12 offset:49160
ds_read_b64_tr_b16 a[250:251],v12 offset:49672
ds_read_b64_tr_b16 a[124:125],v12 offset:57344
ds_read_b64_tr_b16 a[126:127],v12 offset:57856
ds_read_b64_tr_b16 a[252:253],v12 offset:57352
ds_read_b64_tr_b16 a[254:255],v12 offset:57864
s_waitcnt lgkmcnt(4)
v_xor_b32 v12,0x10000,v12
s_waitcnt lgkmcnt(0)
s_barrier
v_and_b32 v21,7,v1
v_lshlrev_b32 v21,6,v21
s_mov_b32 s65,21052416
s_mov_b32 s66,1792
pl_168:
buffer_load_dword v22,v21,s[20:23],s65 offen sc1
s_waitcnt vmcnt(0)
v_cmp_gt_u32 vcc,s66,v22
s_cbranch_vccz pok_169
s_sleep 1
s_sub_u32 s90,s90,1
s_cmp_gt_i32 s90,0
s_cbranch_scc1 pl_168
pok_169:
s_lshl_b32 s72,s50,14
s_lshl_b32 s74,s58,16
s_add_u32 s74,s74,s72
s_add_u32 s74,s74,57344
v_mov_b32 v17,v16
s_lshl_b32 s64,s59,14
s_lshl_b32 s65,s50,11
s_add_u32 s64,s64,s65
v_add_u32 v18,s64,v16
s_lshl_b32 s73,s55,2
s_add_u32 s73,s73,s63
s_mov_b32 s79,s58
s_add_u32 m0,s72,0
s_add_u32 s65,s74,0
buffer_load_dwordx4 v16,s[20:23],s65 offen offset:0  lds
buffer_load_dwordx4 v16,s[20:23],s65 offen offset:1024  lds
buffer_load_dwordx4 v16,s[20:23],s65 offen offset:2048  lds
buffer_load_dwordx4 v16,s[20:23],s65 offen offset:3072  lds
s_add_u32 m0,s72,4096
s_add_u32 s65,s74,4096
buffer_load_dwordx4 v16,s[20:23],s65 offen offset:0  lds
buffer_load_dwordx4 v16,s[20:23],s65 offen offset:1024  lds
buffer_load_dwordx4 v16,s[20:23],s65 offen offset:2048  lds
buffer_load_dwordx4 v16,s[20:23],s65 offen offset:3072  lds
s_add_u32 m0,s72,8192
s_add_u32 s65,s74,8192
buffer_load_dwordx4 v16,s[20:23],s65 offen offset:0  lds
buffer_load_dwordx4 v16,s[20:23],s65 offen offset:1024  lds
buffer_load_dwordx4 v16,s[20:23],s65 offen offset:2048  lds
buffer_load_dwordx4 v16,s[20:23],s65 offen offset:3072  lds
s_add_u32 m0,s72,12288
s_add_u32 s65,s74,12288
buffer_load_dwordx4 v16,s[20:23],s65 offen offset:0  lds
buffer_load_dwordx4 v16,s[20:23],s65 offen offset:1024  lds
buffer_load_dwordx4 v16,s[20:23],s65 offen offset:2048  lds
buffer_load_dwordx4 v16,s[20:23],s65 offen offset:3072  lds
s_waitcnt vmcnt(0)
qloop_170:
s_waitcnt vmcnt(2)
s_barrier
s_xor_b32 s72,s72,0x10000
s_add_u32 s74,s74,262144
s_cmp_lt_u32 s79,60
s_cselect_b32 s74,s74,0x7fff0000
s_add_u32 s64,s79,0
s_lshl_b32 s70,s64,21
s_lshl_b32 s64,s64,13
s_and_b32 s64,s64,0x2000
s_xor_b32 s64,s64,s62
s_add_u32 s70,s70,s64
s_add_u32 s70,s70,29360128
ds_read_b128 v[32:35],v17 offset:0
ds_read_b128 v[36:39],v17 offset:1024
ds_read_b128 v[40:43],v17 offset:2048
s_waitcnt lgkmcnt(2)
v_mfma_f32_16x16x32_bf16 v[64:67],a[0:3],v[32:35],0
ds_read_b128 v[44:47],v17 offset:3072
v_mfma_f32_16x16x32_bf16 v[72:75],a[128:131],v[32:35],0
s_waitcnt lgkmcnt(2)
v_mfma_f32_16x16x32_bf16 v[68:71],a[0:3],v[36:39],0
ds_read_b128 v[32:35],v17 offset:4096
v_mfma_f32_16x16x32_bf16 v[76:79],a[128:131],v[36:39],0
s_waitcnt lgkmcnt(2)
v_mfma_f32_16x16x32_bf16 v[64:67],a[4:7],v[40:43],v[64:67]
ds_read_b128 v[36:39],v17 offset:5120
v_mfma_f32_16x16x32_bf16 v[72:75],a[132:135],v[40:43],v[72:75]
s_waitcnt lgkmcnt(2)
v_mfma_f32_16x16x32_bf16 v[68:71],a[4:7],v[44:47],v[68:71]
ds_read_b128 v[40:43],v17 offset:6144
v_mfma_f32_16x16x32_bf16 v[76:79],a[132:135],v[44:47],v[76:79]
s_waitcnt lgkmcnt(2)
v_mfma_f32_16x16x32_bf16 v[64:67],a[8:11],v[32:35],v[64:67]
ds_read_b128 v[44:47],v17 offset:7168
s_add_u32 m0,s72,0
s_add_u32 s65,s74,0
v_mfma_f32_16x16x32_bf16 v[72:75],a[136:139],v[32:35],v[72:75]
s_waitcnt lgkmcnt(2)
v_mfma_f32_16x16x32_bf16 v[68:71],a[8:11],v[36:39],v[68:71]
ds_read_b128 v[32:35],v17 offset:8192
v_mfma_f32_16x16x32_bf16 v[76:79],a[136:139],v[36:39],v[76:79]
s_waitcnt lgkmcnt(2)
v_mfma_f32_16x16x32_bf16 v[64:67],a[12:15],v[40:43],v[64:67]
ds_read_b128 v[36:39],v17 offset:9216
v_mfma_f32_16x16x32_bf16 v[72:75],a[140:143],v[40:43],v[72:75]
buffer_load_dwordx4 v16,s[20:23],s65 offen offset:0  lds
s_waitcnt lgkmcnt(2)
v_mfma_f32_16x16x32_bf16 v[68:71],a[12:15],v[44:47],v[68:71]
ds_read_b128 v[40:43],v17 offset:10240
v_mfma_f32_16x16x32_bf16 v[76:79],a[140:143],v[44:47],v[76:79]
s_waitcnt lgkmcnt(2)
v_mfma_f32_16x16x32_bf16 v[64:67],a[16:19],v[32:35],v[64:67]
ds_read_b128 v[44:47],v17 offset:11264
v_mfma_f32_16x16x32_bf16 v[72:75],a[144:147],v[32:35],v[72:75]
s_waitcnt lgkmcnt(2)
v_mfma_f32_16x16x32_bf16 v[68:71],a[16:19],v[36:39],v[68:71]
ds_read_b128 v[32:35],v17 offset:12288
buffer_load_dwordx4 v16,s[20:23],s65 offen offset:1024  lds
v_mfma_f32_16x16x32_bf16 v[76:79],a[144:147],v[36:39],v[76:79]
s_waitcnt lgkmcnt(2)
v_mfma_f32_16x16x32_bf16 v[64:67],a[20:23],v[40:43],v[64:67]
ds_read_b128 v[36:39],v17 offset:13312
v_mfma_f32_16x16x32_bf16 v[72:75],a[148:151],v[40:43],v[72:75]
s_waitcnt lgkmcnt(2)
v_mfma_f32_16x16x32_bf16 v[68:71],a[20:23],v[44:47],v[68:71]
ds_read_b128 v[40:43],v17 offset:14336
v_mfma_f32_16x16x32_bf16 v[76:79],a[148:151],v[44:47],v[76:79]
buffer_load_dwordx4 v16,s[20:23],s65 offen offset:2048  lds
s_waitcnt lgkmcnt(2)
v_mfma_f32_16x16x32_bf16 v[64:67],a[24:27],v[32:35],v[64:67]
ds_read_b128 v[44:47],v17 offset:15360
v_mfma_f32_16x16x32_bf16 v[72:75],a[152:155],v[32:35],v[72:75]
s_waitcnt lgkmcnt(2)
v_mfma_f32_16x16x32_bf16 v[68:71],a[24:27],v[36:39],v[68:71]
ds_read_b128 v[32:35],v17 offset:16384
v_mfma_f32_16x16x32_bf16 v[76:79],a[152:155],v[36:39],v[76:79]
s_waitcnt lgkmcnt(2)
v_mfma_f32_16x16x32_bf16 v[64:67],a[28:31],v[40:43],v[64:67]
ds_read_b128 v[36:39],v17 offset:17408
buffer_load_dwordx4 v16,s[20:23],s65 offen offset:3072  lds
v_mfma_f32_16x16x32_bf16 v[72:75],a[156:159],v[40:43],v[72:75]
s_waitcnt lgkmcnt(2)
v_mfma_f32_16x16x32_bf16 v[68:71],a[28:31],v[44:47],v[68:71]
ds_read_b128 v[40:43],v17 offset:18432
v_mfma_f32_16x16x32_bf16 v[76:79],a[156:159],v[44:47],v[76:79]
s_waitcnt lgkmcnt(2)
v_mfma_f32_16x16x32_bf16 v[64:67],a[32:35],v[32:35],v[64:67]
ds_read_b128 v[44:47],v17 offset:19456
s_add_u32 m0,s72,4096
s_add_u32 s65,s74,4096
v_mfma_f32_16x16x32_bf16 v[72:75],a[160:163],v[32:35],v[72:75]
s_waitcnt lgkmcnt(2)
v_mfma_f32_16x16x32_bf16 v[68:71],a[32:35],v[36:39],v[68:71]
ds_read_b128 v[32:35],v17 offset:20480
v_mfma_f32_16x16x32_bf16 v[76:79],a[160:163],v[36:39],v[76:79]
s_waitcnt lgkmcnt(2)
v_mfma_f32_16x16x32_bf16 v[64:67],a[36:39],v[40:43],v[64:67]
ds_read_b128 v[36:39],v17 offset:21504
v_mfma_f32_16x16x32_bf16 v[72:75],a[164:167],v[40:43],v[72:75]
buffer_load_dwordx4 v16,s[20:23],s65 offen offset:0  lds
s_waitcnt lgkmcnt(2)
v_mfma_f32_16x16x32_bf16 v[68:71],a[36:39],v[44:47],v[68:71]
ds_read_b128 v[40:43],v17 offset:22528
v_mfma_f32_16x16x32_bf16 v[76:79],a[164:167],v[44:47],v[76:79]
s_waitcnt lgkmcnt(2)
v_mfma_f32_16x16x32_bf16 v[64:67],a[40:43],v[32:35],v[64:67]
ds_read_b128 v[44:47],v17 offset:23552
v_mfma_f32_16x16x32_bf16 v[72:75],a[168:171],v[32:35],v[72:75]
s_waitcnt lgkmcnt(2)
v_mfma_f32_16x16x32_bf16 v[68:71],a[40:43],v[36:39],v[68:71]
ds_read_b128 v[32:35],v17 offset:24576
buffer_load_dwordx4 v16,s[20:23],s65 offen offset:1024  lds
v_mfma_f32_16x16x32_bf16 v[76:79],a[168:171],v[36:39],v[76:79]
s_waitcnt lgkmcnt(2)
v_mfma_f32_16x16x32_bf16 v[64:67],a[44:47],v[40:43],v[64:67]
ds_read_b128 v[36:39],v17 offset:25600
v_mfma_f32_16x16x32_bf16 v[72:75],a[172:175],v[40:43],v[72:75]
s_waitcnt lgkmcnt(2)
v_mfma_f32_16x16x32_bf16 v[68:71],a[44:47],v[44:47],v[68:71]
ds_read_b128 v[40:43],v17 offset:26624
v_mfma_f32_16x16x32_bf16 v[76:79],a[172:175],v[44:47],v[76:79]
buffer_load_dwordx4 v16,s[20:23],s65 offen offset:2048  lds
s_waitcnt lgkmcnt(2)
v_mfma_f32_16x16x32_bf16 v[64:67],a[48:51],v[32:35],v[64:67]
ds_read_b128 v[44:47],v17 offset:27648
v_mfma_f32_16x16x32_bf16 v[72:75],a[176:179],v[32:35],v[72:75]
s_waitcnt lgkmcnt(2)
v_mfma_f32_16x16x32_bf16 v[68:71],a[48:51],v[36:39],v[68:71]
ds_read_b128 v[32:35],v17 offset:28672
v_mfma_f32_16x16x32_bf16 v[76:79],a[176:179],v[36:39],v[76:79]
s_waitcnt lgkmcnt(2)
v_mfma_f32_16x16x32_bf16 v[64:67],a[52:55],v[40:43],v[64:67]
ds_read_b128 v[36:39],v17 offset:29696
buffer_load_dwordx4 v16,s[20:23],s65 offen offset:3072  lds
v_mfma_f32_16x16x32_bf16 v[72:75],a[180:183],v[40:43],v[72:75]
s_waitcnt lgkmcnt(2)
v_mfma_f32_16x16x32_bf16 v[68:71],a[52:55],v[44:47],v[68:71]
ds_read_b128 v[40:43],v17 offset:30720
v_mfma_f32_16x16x32_bf16 v[76:79],a[180:183],v[44:47],v[76:79]
s_waitcnt lgkmcnt(2)
v_mfma_f32_16x16x32_bf16 v[64:67],a[56:59],v[32:35],v[64:67]
ds_read_b128 v[44:47],v17 offset:31744
s_add_u32 m0,s72,8192
s_add_u32 s65,s74,8192
v_mfma_f32_16x16x32_bf16 v[72:75],a[184:187],v[32:35],v[72:75]
s_waitcnt lgkmcnt(2)
v_mfma_f32_16x16x32_bf16 v[68:71],a[56:59],v[36:39],v[68:71]
ds_read_b128 v[32:35],v17 offset:32768
v_mfma_f32_16x16x32_bf16 v[76:79],a[184:187],v[36:39],v[76:79]
s_waitcnt lgkmcnt(2)
v_mfma_f32_16x16x32_bf16 v[64:67],a[60:63],v[40:43],v[64:67]
ds_read_b128 v[36:39],v17 offset:33792
v_mfma_f32_16x16x32_bf16 v[72:75],a[188:191],v[40:43],v[72:75]
buffer_load_dwordx4 v16,s[20:23],s65 offen offset:0  lds
s_waitcnt lgkmcnt(2)
v_mfma_f32_16x16x32_bf16 v[68:71],a[60:63],v[44:47],v[68:71]
ds_read_b128 v[40:43],v17 offset:34816
v_mfma_f32_16x16x32_bf16 v[76:79],a[188:191],v[44:47],v[76:79]
s_waitcnt lgkmcnt(2)
v_mfma_f32_16x16x32_bf16 v[64:67],a[64:67],v[32:35],v[64:67]
ds_read_b128 v[44:47],v17 offset:35840
v_mfma_f32_16x16x32_bf16 v[72:75],a[192:195],v[32:35],v[72:75]
s_waitcnt lgkmcnt(2)
v_mfma_f32_16x16x32_bf16 v[68:71],a[64:67],v[36:39],v[68:71]
ds_read_b128 v[32:35],v17 offset:36864
buffer_load_dwordx4 v16,s[20:23],s65 offen offset:1024  lds
v_mfma_f32_16x16x32_bf16 v[76:79],a[192:195],v[36:39],v[76:79]
s_waitcnt lgkmcnt(2)
v_mfma_f32_16x16x32_bf16 v[64:67],a[68:71],v[40:43],v[64:67]
ds_read_b128 v[36:39],v17 offset:37888
v_mfma_f32_16x16x32_bf16 v[72:75],a[196:199],v[40:43],v[72:75]
s_waitcnt lgkmcnt(2)
v_mfma_f32_16x16x32_bf16 v[68:71],a[68:71],v[44:47],v[68:71]
ds_read_b128 v[40:43],v17 offset:38912
v_mfma_f32_16x16x32_bf16 v[76:79],a[196:199],v[44:47],v[76:79]
buffer_load_dwordx4 v16,s[20:23],s65 offen offset:2048  lds
s_waitcnt lgkmcnt(2)
v_mfma_f32_16x16x32_bf16 v[64:67],a[72:75],v[32:35],v[64:67]
ds_read_b128 v[44:47],v17 offset:39936
v_mfma_f32_16x16x32_bf16 v[72:75],a[200:203],v[32:35],v[72:75]
s_waitcnt lgkmcnt(2)
v_mfma_f32_16x16x32_bf16 v[68:71],a[72:75],v[36:39],v[68:71]
ds_read_b128 v[32:35],v17 offset:40960
v_mfma_f32_16x16x32_bf16 v[76:79],a[200:203],v[36:39],v[76:79]
s_waitcnt lgkmcnt(2)
v_mfma_f32_16x16x32_bf16 v[64:67],a[76:79],v[40:43],v[64:67]
ds_read_b128 v[36:39],v17 offset:41984
buffer_load_dwordx4 v16,s[20:23],s65 offen offset:3072  lds
v_mfma_f32_16x16x32_bf16 v[72:75],a[204:207],v[40:43],v[72:75]
s_waitcnt lgkmcnt(2)
v_mfma_f32_16x16x32_bf16 v[68:71],a[76:79],v[44:47],v[68:71]
ds_read_b128 v[40:43],v17 offset:43008
v_mfma_f32_16x16x32_bf16 v[76:79],a[204:207],v[44:47],v[76:79]
s_waitcnt lgkmcnt(2)
v_mfma_f32_16x16x32_bf16 v[64:67],a[80:83],v[32:35],v[64:67]
ds_read_b128 v[44:47],v17 offset:44032
s_add_u32 m0,s72,12288
s_add_u32 s65,s74,12288
v_mfma_f32_16x16x32_bf16 v[72:75],a[208:211],v[32:35],v[72:75]
s_waitcnt lgkmcnt(2)
v_mfma_f32_16x16x32_bf16 v[68:71],a[80:83],v[36:39],v[68:71]
ds_read_b128 v[32:35],v17 offset:45056
v_mfma_f32_16x16x32_bf16 v[76:79],a[208:211],v[36:39],v[76:79]
s_waitcnt lgkmcnt(2)
v_mfma_f32_16x16x32_bf16 v[64:67],a[84:87],v[40:43],v[64:67]
ds_read_b128 v[36:39],v17 offset:46080
v_mfma_f32_16x16x32_bf16 v[72:75],a[212:215],v[40:43],v[72:75]
buffer_load_dwordx4 v16,s[20:23],s65 offen offset:0  lds
s_waitcnt lgkmcnt(2)
v_mfma_f32_16x16x32_bf16 v[68:71],a[84:87],v[44:47],v[68:71]
ds_read_b128 v[40:43],v17 offset:47104
v_mfma_f32_16x16x32_bf16 v[76:79],a[212:215],v[44:47],v[76:79]
s_waitcnt lgkmcnt(2)
v_mfma_f32_16x16x32_bf16 v[64:67],a[88:91],v[32:35],v[64:67]
ds_read_b128 v[44:47],v17 offset:48128
v_mfma_f32_16x16x32_bf16 v[72:75],a[216:219],v[32:35],v[72:75]
s_waitcnt lgkmcnt(2)
v_mfma_f32_16x16x32_bf16 v[68:71],a[88:91],v[36:39],v[68:71]
ds_read_b128 v[32:35],v17 offset:49152
buffer_load_dwordx4 v16,s[20:23],s65 offen offset:1024  lds
v_mfma_f32_16x16x32_bf16 v[76:79],a[216:219],v[36:39],v[76:79]
s_waitcnt lgkmcnt(2)
v_mfma_f32_16x16x32_bf16 v[64:67],a[92:95],v[40:43],v[64:67]
ds_read_b128 v[36:39],v17 offset:50176
v_mfma_f32_16x16x32_bf16 v[72:75],a[220:223],v[40:43],v[72:75]
s_waitcnt lgkmcnt(2)
v_mfma_f32_16x16x32_bf16 v[68:71],a[92:95],v[44:47],v[68:71]
ds_read_b128 v[40:43],v17 offset:51200
v_mfma_f32_16x16x32_bf16 v[76:79],a[220:223],v[44:47],v[76:79]
buffer_load_dwordx4 v16,s[20:23],s65 offen offset:2048  lds
s_waitcnt lgkmcnt(2)
v_mfma_f32_16x16x32_bf16 v[64:67],a[96:99],v[32:35],v[64:67]
ds_read_b128 v[44:47],v17 offset:52224
v_mfma_f32_16x16x32_bf16 v[72:75],a[224:227],v[32:35],v[72:75]
s_waitcnt lgkmcnt(2)
v_mfma_f32_16x16x32_bf16 v[68:71],a[96:99],v[36:39],v[68:71]
ds_read_b128 v[32:35],v17 offset:53248
v_mfma_f32_16x16x32_bf16 v[76:79],a[224:227],v[36:39],v[76:79]
s_waitcnt lgkmcnt(2)
v_mfma_f32_16x16x32_bf16 v[64:67],a[100:103],v[40:43],v[64:67]
ds_read_b128 v[36:39],v17 offset:54272
buffer_load_dwordx4 v16,s[20:23],s65 offen offset:3072  lds
v_mfma_f32_16x16x32_bf16 v[72:75],a[228:231],v[40:43],v[72:75]
s_waitcnt lgkmcnt(2)
v_mfma_f32_16x16x32_bf16 v[68:71],a[100:103],v[44:47],v[68:71]
ds_read_b128 v[40:43],v17 offset:55296
v_mfma_f32_16x16x32_bf16 v[76:79],a[228:231],v[44:47],v[76:79]
s_waitcnt lgkmcnt(2)
v_mfma_f32_16x16x32_bf16 v[64:67],a[104:107],v[32:35],v[64:67]
ds_read_b128 v[44:47],v17 offset:56320
v_mfma_f32_16x16x32_bf16 v[72:75],a[232:235],v[32:35],v[72:75]
s_waitcnt lgkmcnt(2)
v_mfma_f32_16x16x32_bf16 v[68:71],a[104:107],v[36:39],v[68:71]
ds_read_b128 v[32:35],v17 offset:57344
v_mfma_f32_16x16x32_bf16 v[76:79],a[232:235],v[36:39],v[76:79]
s_waitcnt lgkmcnt(2)
v_mfma_f32_16x16x32_bf16 v[64:67],a[108:111],v[40:43],v[64:67]
ds_read_b128 v[36:39],v17 offset:58368
v_mfma_f32_16x16x32_bf16 v[72:75],a[236:239],v[40:43],v[72:75]
s_waitcnt lgkmcnt(2)
v_mfma_f32_16x16x32_bf16 v[68:71],a[108:111],v[44:47],v[68:71]
ds_read_b128 v[40:43],v17 offset:59392
v_mfma_f32_16x16x32_bf16 v[76:79],a[236:239],v[44:47],v[76:79]
s_waitcnt lgkmcnt(2)
v_mfma_f32_16x16x32_bf16 v[64:67],a[112:115],v[32:35],v[64:67]
ds_read_b128 v[44:47],v17 offset:60416
v_mfma_f32_16x16x32_bf16 v[72:75],a[240:243],v[32:35],v[72:75]
s_waitcnt lgkmcnt(2)
v_mfma_f32_16x16x32_bf16 v[68:71],a[112:115],v[36:39],v[68:71]
ds_read_b128 v[32:35],v17 offset:61440
v_mfma_f32_16x16x32_bf16 v[76:79],a[240:243],v[36:39],v[76:79]
s_waitcnt lgkmcnt(2)
v_mfma_f32_16x16x32_bf16 v[64:67],a[116:119],v[40:43],v[64:67]
ds_read_b128 v[36:39],v17 offset:62464
v_mfma_f32_16x16x32_bf16 v[72:75],a[244:247],v[40:43],v[72:75]
s_waitcnt lgkmcnt(2)
v_mfma_f32_16x16x32_bf16 v[68:71],a[116:119],v[44:47],v[68:71]
ds_read_b128 v[40:43],v17 offset:63488
v_mfma_f32_16x16x32_bf16 v[76:79],a[244:247],v[44:47],v[76:79]
s_waitcnt lgkmcnt(2)
v_mfma_f32_16x16x32_bf16 v[64:67],a[120:123],v[32:35],v[64:67]
ds_read_b128 v[44:47],v17 offset:64512
v_mfma_f32_16x16x32_bf16 v[72:75],a[248:251],v[32:35],v[72:75]
s_waitcnt lgkmcnt(2)
v_mfma_f32_16x16x32_bf16 v[68:71],a[120:123],v[36:39],v[68:71]
v_mfma_f32_16x16x32_bf16 v[76:79],a[248:251],v[36:39],v[76:79]
s_waitcnt lgkmcnt(1)
v_mfma_f32_16x16x32_bf16 v[64:67],a[124:127],v[40:43],v[64:67]
v_mfma_f32_16x16x32_bf16 v[72:75],a[252:255],v[40:43],v[72:75]
s_waitcnt lgkmcnt(0)
v_mfma_f32_16x16x32_bf16 v[68:71],a[124:127],v[44:47],v[68:71]
v_mfma_f32_16x16x32_bf16 v[76:79],a[252:255],v[44:47],v[76:79]
v_xor_b32 v17,0x10000,v17
s_add_u32 s79,s79,4
s_nop 1
v_cvt_pk_bf16_f32 v80,v64,v65
v_cvt_pk_bf16_f32 v81,v66,v67
v_cvt_pk_bf16_f32 v82,v72,v73
v_cvt_pk_bf16_f32 v83,v74,v75
buffer_store_dwordx4 v[80:83],v18,s[20:23],s70 offen offset:0 sc1
v_cvt_pk_bf16_f32 v84,v68,v69
v_cvt_pk_bf16_f32 v85,v70,v71
v_cvt_pk_bf16_f32 v86,v76,v77
v_cvt_pk_bf16_f32 v87,v78,v79
buffer_store_dwordx4 v[84:87],v18,s[20:23],s70 offen offset:1024 sc1
s_cmp_lt_u32 s79,64
s_cbranch_scc1 qloop_170
s_waitcnt vmcnt(0)
s_barrier
s_cmp_lg_u32 s50,0
s_cbranch_scc1 ow_171
s_mov_b64 exec,1
v_mov_b32 v22,16
v_mov_b32 v23,0
buffer_store_dword v22,v23,s[20:23],s73 offen sc1
s_mov_b64 exec,-1
ow_171:
s_add_u32 s40,s55,64
pmod_173:
s_load_dwordx2 s[4:5],s[0:1],96
s_load_dwordx2 s[6:7],s[0:1],104
s_load_dwordx2 s[8:9],s[0:1],128
s_waitcnt lgkmcnt(0)
s_mov_b32 s12,s4
s_and_b32 s13,s5,0xffff
s_mov_b32 s14,0x800
s_mov_b32 s15,0x20000
s_mov_b32 s16,s6
s_and_b32 s17,s7,0xffff
s_mov_b32 s18,0xc00000
s_mov_b32 s19,0x20000
s_mov_b32 s20,s8
s_and_b32 s21,s9,0xffff
s_mov_b32 s22,0x10000000
s_mov_b32 s23,0x20000
v_and_b32 v1,3,v0
v_lshrrev_b32 v2,2,v0
v_mul_u32_u24 v3,12288,v2
v_lshl_add_u32 v3,v1,4,v3
s_lshl_b32 s24,s40,6
v_lshlrev_b32 v4,1,v2
s_add_u32 s25,s24,0
buffer_load_dwordx4 v[32:35],v3,s[16:19],s25 offen
s_add_u32 s25,s24,786432
buffer_load_dwordx4 v[36:39],v3,s[16:19],s25 offen
s_add_u32 s25,s24,1572864
buffer_load_dwordx4 v[40:43],v3,s[16:19],s25 offen
s_add_u32 s25,s24,2359296
buffer_load_dwordx4 v[44:47],v3,s[16:19],s25 offen
s_add_u32 s25,s24,3145728
buffer_load_dwordx4 v[48:51],v3,s[16:19],s25 offen
s_add_u32 s25,s24,3932160
buffer_load_dwordx4 v[52:55],v3,s[16:19],s25 offen
s_add_u32 s25,s24,4718592
buffer_load_dwordx4 v[56:59],v3,s[16:19],s25 offen
s_add_u32 s25,s24,5505024
buffer_load_dwordx4 v[60:63],v3,s[16:19],s25 offen
s_add_u32 s25,s24,6291456
buffer_load_dwordx4 v[64:67],v3,s[16:19],s25 offen
s_add_u32 s25,s24,7077888
buffer_load_dwordx4 v[68:71],v3,s[16:19],s25 offen
s_add_u32 s25,s24,7864320
buffer_load_dwordx4 v[72:75],v3,s[16:19],s25 offen
s_add_u32 s25,s24,8650752
buffer_load_dwordx4 v[76:79],v3,s[16:19],s25 offen
s_add_u32 s25,s24,9437184
buffer_load_dwordx4 v[80:83],v3,s[16:19],s25 offen
s_add_u32 s25,s24,10223616
buffer_load_dwordx4 v[84:87],v3,s[16:19],s25 offen
s_add_u32 s25,s24,11010048
buffer_load_dwordx4 v[88:91],v3,s[16:19],s25 offen
s_add_u32 s25,s24,11796480
buffer_load_dwordx4 v[92:95],v3,s[16:19],s25 offen
buffer_load_ushort v8,v4,s[12:15],0 offen offset:0
buffer_load_ushort v9,v4,s[12:15],0 offen offset:128
buffer_load_ushort v10,v4,s[12:15],0 offen offset:256
buffer_load_ushort v11,v4,s[12:15],0 offen offset:384
buffer_load_ushort v12,v4,s[12:15],0 offen offset:512
buffer_load_ushort v13,v4,s[12:15],0 offen offset:640
buffer_load_ushort v14,v4,s[12:15],0 offen offset:768
buffer_load_ushort v15,v4,s[12:15],0 offen offset:896
buffer_load_ushort v16,v4,s[12:15],0 offen offset:1024
buffer_load_ushort v17,v4,s[12:15],0 offen offset:1152
buffer_load_ushort v18,v4,s[12:15],0 offen offset:1280
buffer_load_ushort v19,v4,s[12:15],0 offen offset:1408
buffer_load_ushort v20,v4,s[12:15],0 offen offset:1536
buffer_load_ushort v21,v4,s[12:15],0 offen offset:1664
buffer_load_ushort v22,v4,s[12:15],0 offen offset:1792
buffer_load_ushort v23,v4,s[12:15],0 offen offset:1920
v_mov_b32 v24,0
v_mov_b32 v25,0
v_mov_b32 v26,0
v_mov_b32 v27,0
v_mov_b32 v28,0
v_mov_b32 v29,0
v_mov_b32 v30,0
v_mov_b32 v31,0
s_waitcnt vmcnt(0)
s_mov_b32 s26,0xbfb8aa3b
s_mov_b32 s27,0xffff0000
v_lshlrev_b32 v8,16,v8
v_mul_f32 v5,s26,v8
v_exp_f32 v5,v5
s_nop 0
v_add_f32 v5,1.0,v5
v_rcp_f32 v5,v5
s_nop 0
v_mul_f32 v5,v5,v8
v_cvt_pk_bf16_f32 v5,v5,v5
v_and_b32 v8,s27,v5
v_lshlrev_b32 v6,16,v32
v_and_b32 v7,s27,v32
v_fmac_f32 v24,v6,v8
v_fmac_f32 v25,v7,v8
v_lshlrev_b32 v6,16,v33
v_and_b32 v7,s27,v33
v_fmac_f32 v26,v6,v8
v_fmac_f32 v27,v7,v8
v_lshlrev_b32 v6,16,v34
v_and_b32 v7,s27,v34
v_fmac_f32 v28,v6,v8
v_fmac_f32 v29,v7,v8
v_lshlrev_b32 v6,16,v35
v_and_b32 v7,s27,v35
v_fmac_f32 v30,v6,v8
v_fmac_f32 v31,v7,v8
v_lshlrev_b32 v9,16,v9
v_mul_f32 v5,s26,v9
v_exp_f32 v5,v5
s_nop 0
v_add_f32 v5,1.0,v5
v_rcp_f32 v5,v5
s_nop 0
v_mul_f32 v5,v5,v9
v_cvt_pk_bf16_f32 v5,v5,v5
v_and_b32 v9,s27,v5
v_lshlrev_b32 v6,16,v36
v_and_b32 v7,s27,v36
v_fmac_f32 v24,v6,v9
v_fmac_f32 v25,v7,v9
v_lshlrev_b32 v6,16,v37
v_and_b32 v7,s27,v37
v_fmac_f32 v26,v6,v9
v_fmac_f32 v27,v7,v9
v_lshlrev_b32 v6,16,v38
v_and_b32 v7,s27,v38
v_fmac_f32 v28,v6,v9
v_fmac_f32 v29,v7,v9
v_lshlrev_b32 v6,16,v39
v_and_b32 v7,s27,v39
v_fmac_f32 v30,v6,v9
v_fmac_f32 v31,v7,v9
v_lshlrev_b32 v10,16,v10
v_mul_f32 v5,s26,v10
v_exp_f32 v5,v5
s_nop 0
v_add_f32 v5,1.0,v5
v_rcp_f32 v5,v5
s_nop 0
v_mul_f32 v5,v5,v10
v_cvt_pk_bf16_f32 v5,v5,v5
v_and_b32 v10,s27,v5
v_lshlrev_b32 v6,16,v40
v_and_b32 v7,s27,v40
v_fmac_f32 v24,v6,v10
v_fmac_f32 v25,v7,v10
v_lshlrev_b32 v6,16,v41
v_and_b32 v7,s27,v41
v_fmac_f32 v26,v6,v10
v_fmac_f32 v27,v7,v10
v_lshlrev_b32 v6,16,v42
v_and_b32 v7,s27,v42
v_fmac_f32 v28,v6,v10
v_fmac_f32 v29,v7,v10
v_lshlrev_b32 v6,16,v43
v_and_b32 v7,s27,v43
v_fmac_f32 v30,v6,v10
v_fmac_f32 v31,v7,v10
v_lshlrev_b32 v11,16,v11
v_mul_f32 v5,s26,v11
v_exp_f32 v5,v5
s_nop 0
v_add_f32 v5,1.0,v5
v_rcp_f32 v5,v5
s_nop 0
v_mul_f32 v5,v5,v11
v_cvt_pk_bf16_f32 v5,v5,v5
v_and_b32 v11,s27,v5
v_lshlrev_b32 v6,16,v44
v_and_b32 v7,s27,v44
v_fmac_f32 v24,v6,v11
v_fmac_f32 v25,v7,v11
v_lshlrev_b32 v6,16,v45
v_and_b32 v7,s27,v45
v_fmac_f32 v26,v6,v11
v_fmac_f32 v27,v7,v11
v_lshlrev_b32 v6,16,v46
v_and_b32 v7,s27,v46
v_fmac_f32 v28,v6,v11
v_fmac_f32 v29,v7,v11
v_lshlrev_b32 v6,16,v47
v_and_b32 v7,s27,v47
v_fmac_f32 v30,v6,v11
v_fmac_f32 v31,v7,v11
v_lshlrev_b32 v12,16,v12
v_mul_f32 v5,s26,v12
v_exp_f32 v5,v5
s_nop 0
v_add_f32 v5,1.0,v5
v_rcp_f32 v5,v5
s_nop 0
v_mul_f32 v5,v5,v12
v_cvt_pk_bf16_f32 v5,v5,v5
v_and_b32 v12,s27,v5
v_lshlrev_b32 v6,16,v48
v_and_b32 v7,s27,v48
v_fmac_f32 v24,v6,v12
v_fmac_f32 v25,v7,v12
v_lshlrev_b32 v6,16,v49
v_and_b32 v7,s27,v49
v_fmac_f32 v26,v6,v12
v_fmac_f32 v27,v7,v12
v_lshlrev_b32 v6,16,v50
v_and_b32 v7,s27,v50
v_fmac_f32 v28,v6,v12
v_fmac_f32 v29,v7,v12
v_lshlrev_b32 v6,16,v51
v_and_b32 v7,s27,v51
v_fmac_f32 v30,v6,v12
v_fmac_f32 v31,v7,v12
v_lshlrev_b32 v13,16,v13
v_mul_f32 v5,s26,v13
v_exp_f32 v5,v5
s_nop 0
v_add_f32 v5,1.0,v5
v_rcp_f32 v5,v5
s_nop 0
v_mul_f32 v5,v5,v13
v_cvt_pk_bf16_f32 v5,v5,v5
v_and_b32 v13,s27,v5
v_lshlrev_b32 v6,16,v52
v_and_b32 v7,s27,v52
v_fmac_f32 v24,v6,v13
v_fmac_f32 v25,v7,v13
v_lshlrev_b32 v6,16,v53
v_and_b32 v7,s27,v53
v_fmac_f32 v26,v6,v13
v_fmac_f32 v27,v7,v13
v_lshlrev_b32 v6,16,v54
v_and_b32 v7,s27,v54
v_fmac_f32 v28,v6,v13
v_fmac_f32 v29,v7,v13
v_lshlrev_b32 v6,16,v55
v_and_b32 v7,s27,v55
v_fmac_f32 v30,v6,v13
v_fmac_f32 v31,v7,v13
v_lshlrev_b32 v14,16,v14
v_mul_f32 v5,s26,v14
v_exp_f32 v5,v5
s_nop 0
v_add_f32 v5,1.0,v5
v_rcp_f32 v5,v5
s_nop 0
v_mul_f32 v5,v5,v14
v_cvt_pk_bf16_f32 v5,v5,v5
v_and_b32 v14,s27,v5
v_lshlrev_b32 v6,16,v56
v_and_b32 v7,s27,v56
v_fmac_f32 v24,v6,v14
v_fmac_f32 v25,v7,v14
v_lshlrev_b32 v6,16,v57
v_and_b32 v7,s27,v57
v_fmac_f32 v26,v6,v14
v_fmac_f32 v27,v7,v14
v_lshlrev_b32 v6,16,v58
v_and_b32 v7,s27,v58
v_fmac_f32 v28,v6,v14
v_fmac_f32 v29,v7,v14
v_lshlrev_b32 v6,16,v59
v_and_b32 v7,s27,v59
v_fmac_f32 v30,v6,v14
v_fmac_f32 v31,v7,v14
v_lshlrev_b32 v15,16,v15
v_mul_f32 v5,s26,v15
v_exp_f32 v5,v5
s_nop 0
v_add_f32 v5,1.0,v5
v_rcp_f32 v5,v5
s_nop 0
v_mul_f32 v5,v5,v15
v_cvt_pk_bf16_f32 v5,v5,v5
v_and_b32 v15,s27,v5
v_lshlrev_b32 v6,16,v60
v_and_b32 v7,s27,v60
v_fmac_f32 v24,v6,v15
v_fmac_f32 v25,v7,v15
v_lshlrev_b32 v6,16,v61
v_and_b32 v7,s27,v61
v_fmac_f32 v26,v6,v15
v_fmac_f32 v27,v7,v15
v_lshlrev_b32 v6,16,v62
v_and_b32 v7,s27,v62
v_fmac_f32 v28,v6,v15
v_fmac_f32 v29,v7,v15
v_lshlrev_b32 v6,16,v63
v_and_b32 v7,s27,v63
v_fmac_f32 v30,v6,v15
v_fmac_f32 v31,v7,v15
v_lshlrev_b32 v16,16,v16
v_mul_f32 v5,s26,v16
v_exp_f32 v5,v5
s_nop 0
v_add_f32 v5,1.0,v5
v_rcp_f32 v5,v5
s_nop 0
v_mul_f32 v5,v5,v16
v_cvt_pk_bf16_f32 v5,v5,v5
v_and_b32 v16,s27,v5
v_lshlrev_b32 v6,16,v64
v_and_b32 v7,s27,v64
v_fmac_f32 v24,v6,v16
v_fmac_f32 v25,v7,v16
v_lshlrev_b32 v6,16,v65
v_and_b32 v7,s27,v65
v_fmac_f32 v26,v6,v16
v_fmac_f32 v27,v7,v16
v_lshlrev_b32 v6,16,v66
v_and_b32 v7,s27,v66
v_fmac_f32 v28,v6,v16
v_fmac_f32 v29,v7,v16
v_lshlrev_b32 v6,16,v67
v_and_b32 v7,s27,v67
v_fmac_f32 v30,v6,v16
v_fmac_f32 v31,v7,v16
v_lshlrev_b32 v17,16,v17
v_mul_f32 v5,s26,v17
v_exp_f32 v5,v5
s_nop 0
v_add_f32 v5,1.0,v5
v_rcp_f32 v5,v5
s_nop 0
v_mul_f32 v5,v5,v17
v_cvt_pk_bf16_f32 v5,v5,v5
v_and_b32 v17,s27,v5
v_lshlrev_b32 v6,16,v68
v_and_b32 v7,s27,v68
v_fmac_f32 v24,v6,v17
v_fmac_f32 v25,v7,v17
v_lshlrev_b32 v6,16,v69
v_and_b32 v7,s27,v69
v_fmac_f32 v26,v6,v17
v_fmac_f32 v27,v7,v17
v_lshlrev_b32 v6,16,v70
v_and_b32 v7,s27,v70
v_fmac_f32 v28,v6,v17
v_fmac_f32 v29,v7,v17
v_lshlrev_b32 v6,16,v71
v_and_b32 v7,s27,v71
v_fmac_f32 v30,v6,v17
v_fmac_f32 v31,v7,v17
v_lshlrev_b32 v18,16,v18
v_mul_f32 v5,s26,v18
v_exp_f32 v5,v5
s_nop 0
v_add_f32 v5,1.0,v5
v_rcp_f32 v5,v5
s_nop 0
v_mul_f32 v5,v5,v18
v_cvt_pk_bf16_f32 v5,v5,v5
v_and_b32 v18,s27,v5
v_lshlrev_b32 v6,16,v72
v_and_b32 v7,s27,v72
v_fmac_f32 v24,v6,v18
v_fmac_f32 v25,v7,v18
v_lshlrev_b32 v6,16,v73
v_and_b32 v7,s27,v73
v_fmac_f32 v26,v6,v18
v_fmac_f32 v27,v7,v18
v_lshlrev_b32 v6,16,v74
v_and_b32 v7,s27,v74
v_fmac_f32 v28,v6,v18
v_fmac_f32 v29,v7,v18
v_lshlrev_b32 v6,16,v75
v_and_b32 v7,s27,v75
v_fmac_f32 v30,v6,v18
v_fmac_f32 v31,v7,v18
v_lshlrev_b32 v19,16,v19
v_mul_f32 v5,s26,v19
v_exp_f32 v5,v5
s_nop 0
v_add_f32 v5,1.0,v5
v_rcp_f32 v5,v5
s_nop 0
v_mul_f32 v5,v5,v19
v_cvt_pk_bf16_f32 v5,v5,v5
v_and_b32 v19,s27,v5
v_lshlrev_b32 v6,16,v76
v_and_b32 v7,s27,v76
v_fmac_f32 v24,v6,v19
v_fmac_f32 v25,v7,v19
v_lshlrev_b32 v6,16,v77
v_and_b32 v7,s27,v77
v_fmac_f32 v26,v6,v19
v_fmac_f32 v27,v7,v19
v_lshlrev_b32 v6,16,v78
v_and_b32 v7,s27,v78
v_fmac_f32 v28,v6,v19
v_fmac_f32 v29,v7,v19
v_lshlrev_b32 v6,16,v79
v_and_b32 v7,s27,v79
v_fmac_f32 v30,v6,v19
v_fmac_f32 v31,v7,v19
v_lshlrev_b32 v20,16,v20
v_mul_f32 v5,s26,v20
v_exp_f32 v5,v5
s_nop 0
v_add_f32 v5,1.0,v5
v_rcp_f32 v5,v5
s_nop 0
v_mul_f32 v5,v5,v20
v_cvt_pk_bf16_f32 v5,v5,v5
v_and_b32 v20,s27,v5
v_lshlrev_b32 v6,16,v80
v_and_b32 v7,s27,v80
v_fmac_f32 v24,v6,v20
v_fmac_f32 v25,v7,v20
v_lshlrev_b32 v6,16,v81
v_and_b32 v7,s27,v81
v_fmac_f32 v26,v6,v20
v_fmac_f32 v27,v7,v20
v_lshlrev_b32 v6,16,v82
v_and_b32 v7,s27,v82
v_fmac_f32 v28,v6,v20
v_fmac_f32 v29,v7,v20
v_lshlrev_b32 v6,16,v83
v_and_b32 v7,s27,v83
v_fmac_f32 v30,v6,v20
v_fmac_f32 v31,v7,v20
v_lshlrev_b32 v21,16,v21
v_mul_f32 v5,s26,v21
v_exp_f32 v5,v5
s_nop 0
v_add_f32 v5,1.0,v5
v_rcp_f32 v5,v5
s_nop 0
v_mul_f32 v5,v5,v21
v_cvt_pk_bf16_f32 v5,v5,v5
v_and_b32 v21,s27,v5
v_lshlrev_b32 v6,16,v84
v_and_b32 v7,s27,v84
v_fmac_f32 v24,v6,v21
v_fmac_f32 v25,v7,v21
v_lshlrev_b32 v6,16,v85
v_and_b32 v7,s27,v85
v_fmac_f32 v26,v6,v21
v_fmac_f32 v27,v7,v21
v_lshlrev_b32 v6,16,v86
v_and_b32 v7,s27,v86
v_fmac_f32 v28,v6,v21
v_fmac_f32 v29,v7,v21
v_lshlrev_b32 v6,16,v87
v_and_b32 v7,s27,v87
v_fmac_f32 v30,v6,v21
v_fmac_f32 v31,v7,v21
v_lshlrev_b32 v22,16,v22
v_mul_f32 v5,s26,v22
v_exp_f32 v5,v5
s_nop 0
v_add_f32 v5,1.0,v5
v_rcp_f32 v5,v5
s_nop 0
v_mul_f32 v5,v5,v22
v_cvt_pk_bf16_f32 v5,v5,v5
v_and_b32 v22,s27,v5
v_lshlrev_b32 v6,16,v88
v_and_b32 v7,s27,v88
v_fmac_f32 v24,v6,v22
v_fmac_f32 v25,v7,v22
v_lshlrev_b32 v6,16,v89
v_and_b32 v7,s27,v89
v_fmac_f32 v26,v6,v22
v_fmac_f32 v27,v7,v22
v_lshlrev_b32 v6,16,v90
v_and_b32 v7,s27,v90
v_fmac_f32 v28,v6,v22
v_fmac_f32 v29,v7,v22
v_lshlrev_b32 v6,16,v91
v_and_b32 v7,s27,v91
v_fmac_f32 v30,v6,v22
v_fmac_f32 v31,v7,v22
v_lshlrev_b32 v23,16,v23
v_mul_f32 v5,s26,v23
v_exp_f32 v5,v5
s_nop 0
v_add_f32 v5,1.0,v5
v_rcp_f32 v5,v5
s_nop 0
v_mul_f32 v5,v5,v23
v_cvt_pk_bf16_f32 v5,v5,v5
v_and_b32 v23,s27,v5
v_lshlrev_b32 v6,16,v92
v_and_b32 v7,s27,v92
v_fmac_f32 v24,v6,v23
v_fmac_f32 v25,v7,v23
v_lshlrev_b32 v6,16,v93
v_and_b32 v7,s27,v93
v_fmac_f32 v26,v6,v23
v_fmac_f32 v27,v7,v23
v_lshlrev_b32 v6,16,v94
v_and_b32 v7,s27,v94
v_fmac_f32 v28,v6,v23
v_fmac_f32 v29,v7,v23
v_lshlrev_b32 v6,16,v95
v_and_b32 v7,s27,v95
v_fmac_f32 v30,v6,v23
v_fmac_f32 v31,v7,v23
v_lshlrev_b32 v5,5,v0
ds_write_b128 v5,v[24:27]
ds_write_b128 v5,v[28:31] offset:16
s_waitcnt lgkmcnt(0)
s_barrier
v_and_b32 v1,31,v0
v_lshrrev_b32 v2,5,v0
v_lshlrev_b32 v3,10,v2
v_lshl_add_u32 v3,v1,2,v3
ds_read_b32 v8,v3 offset:0
ds_read_b32 v9,v3 offset:128
ds_read_b32 v10,v3 offset:256
ds_read_b32 v11,v3 offset:384
ds_read_b32 v12,v3 offset:512
ds_read_b32 v13,v3 offset:640
ds_read_b32 v14,v3 offset:768
ds_read_b32 v15,v3 offset:896
s_waitcnt lgkmcnt(0)
v_add_f32 v8,v8,v9
v_add_f32 v8,v8,v10
v_add_f32 v8,v8,v11
v_add_f32 v8,v8,v12
v_add_f32 v8,v8,v13
v_add_f32 v8,v8,v14
v_add_f32 v8,v8,v15
s_barrier
v_lshlrev_b32 v3,2,v0
ds_write_b32 v3,v8
s_waitcnt lgkmcnt(0)
s_barrier
v_lshlrev_b32 v3,2,v1
ds_read_b32 v8,v3 offset:0
ds_read_b32 v9,v3 offset:128
ds_read_b32 v10,v3 offset:256
ds_read_b32 v11,v3 offset:384
ds_read_b32 v12,v3 offset:512
ds_read_b32 v13,v3 offset:640
ds_read_b32 v14,v3 offset:768
ds_read_b32 v15,v3 offset:896
s_waitcnt lgkmcnt(0)
v_add_f32 v8,v8,v9
v_add_f32 v8,v8,v10
v_add_f32 v8,v8,v11
v_add_f32 v8,v8,v12
v_add_f32 v8,v8,v13
v_add_f32 v8,v8,v14
v_add_f32 v8,v8,v15
v_cvt_pk_bf16_f32 v8,v8,v8
v_and_b32 v8,s27,v8
s_lshl_b32 s24,s40,7
s_add_u32 s24,s24,0
v_cmp_gt_u32 vcc,32,v0
s_and_saveexec_b64 s[36:37],vcc
s_cbranch_execz nost_176
buffer_store_dword v8,v3,s[20:23],s24 offen sc1
nost_176:
s_mov_b64 exec,s[36:37]
s_branch moddone_172
moddone_172:
s_waitcnt vmcnt(0)
s_barrier
s_cmp_lg_u32 s50,0
s_cbranch_scc1 ow_177
s_mov_b64 exec,1
v_mov_b32 v22,14
v_mov_b32 v23,0
s_mov_b32 s64,21052032
buffer_atomic_add v22,v23,s[20:23],s64 offen sc1
s_mov_b64 exec,-1
ow_177:
v_and_b32 v1,63,v0
v_and_b32 v3,15,v1
v_lshrrev_b32 v4,4,v1
v_lshlrev_b32 v16,4,v1
v_mov_b32 v128,0
v_mov_b32 v129,0
v_mov_b32 v130,0
v_mov_b32 v131,0
s_mov_b64 s[24:25],s[20:21]
s_mov_b64 s[28:29],s[20:21]
s_mov_b32 s27,0x20000
s_mov_b32 s31,0x20000
s_cmp_eq_u32 s56,0
s_cselect_b32 s26,s22,0
s_cselect_b32 s30,0,s22
s_mov_b32 s79,0
s_mov_b32 s71,1
s_mov_b32 s83,0
v_mov_b32 v29,0
s_mov_b32 s80,0xffff0000
s_cmp_eq_u32 s58,0
s_cbranch_scc1 r_wo_178
s_cmp_eq_u32 s58,1
s_cbranch_scc1 r_w3_179
s_cmp_eq_u32 s58,2
s_cbranch_scc1 r_w4_180
s_and_b32 s41,s59,15
s_cmp_lt_u32 s59,16
s_cbranch_scc1 r_at_183
s_cmp_ge_u32 s59,24
s_cbranch_scc1 r_w2_181
s_load_dwordx2 s[4:5],s[0:1],64
s_and_b32 s41,s59,7
s_lshl_b32 s66,s41,8
s_lshl_b32 s67,s50,1
s_waitcnt lgkmcnt(0)
s_mov_b32 s32,s4
s_and_b32 s33,s5,0xffff
s_mov_b32 s34,0x200000
s_mov_b32 s35,0x20000
v_lshrrev_b32 v5,2,v3
v_lshl_add_u32 v7,v4,3,v5
v_and_b32 v6,3,v3
v_lshlrev_b32 v6,3,v6
v_lshl_add_u32 v6,v7,8,v6
v_and_b32 v7,1,v4
v_lshl_add_u32 v5,v7,2,v5
v_xor_b32 v5,s67,v5
v_lshl_add_u32 v12,v5,5,v6
v_xor_b32 v13,32,v12
v_and_b32 v5,15,v1
v_and_b32 v6,3,v4
v_lshlrev_b32 v6,1,v6
v_xor_b32 v5,v5,v6
v_mul_u32_u24 v6,2048,v4
v_xor_b32 v7,0,v5
v_lshl_add_u32 v8,v7,4,v6
v_xor_b32 v7,8,v5
v_lshl_add_u32 v9,v7,4,v6
s_mul_i32 s74,s50,131072
s_add_u32 s74,s74,s66
s_lshl_b32 s75,s50,14
s_mul_i32 s76,s50,65536
s_add_u32 s76,s76,s66
s_lshl_b32 s77,s50,13
s_add_u32 s64,s74,0
s_add_u32 m0,s75,0
s_nop 0
buffer_load_dwordx4 v8,s[32:35],s64 offen  lds
s_add_u32 s64,s74,8192
s_add_u32 m0,s75,1024
s_nop 0
buffer_load_dwordx4 v8,s[32:35],s64 offen  lds
s_add_u32 s64,s74,16384
s_add_u32 m0,s75,2048
s_nop 0
buffer_load_dwordx4 v9,s[32:35],s64 offen  lds
s_add_u32 s64,s74,24576
s_add_u32 m0,s75,3072
s_nop 0
buffer_load_dwordx4 v9,s[32:35],s64 offen  lds
s_add_u32 s64,s74,32768
s_add_u32 m0,s75,4096
s_nop 0
buffer_load_dwordx4 v8,s[32:35],s64 offen  lds
s_add_u32 s64,s74,40960
s_add_u32 m0,s75,5120
s_nop 0
buffer_load_dwordx4 v8,s[32:35],s64 offen  lds
s_add_u32 s64,s74,49152
s_add_u32 m0,s75,6144
s_nop 0
buffer_load_dwordx4 v9,s[32:35],s64 offen  lds
s_add_u32 s64,s74,57344
s_add_u32 m0,s75,7168
s_nop 0
buffer_load_dwordx4 v9,s[32:35],s64 offen  lds
s_add_u32 s64,s74,65536
s_add_u32 m0,s75,8192
s_nop 0
buffer_load_dwordx4 v8,s[32:35],s64 offen  lds
s_add_u32 s64,s74,73728
s_add_u32 m0,s75,9216
s_nop 0
buffer_load_dwordx4 v8,s[32:35],s64 offen  lds
s_add_u32 s64,s74,81920
s_add_u32 m0,s75,10240
s_nop 0
buffer_load_dwordx4 v9,s[32:35],s64 offen  lds
s_add_u32 s64,s74,90112
s_add_u32 m0,s75,11264
s_nop 0
buffer_load_dwordx4 v9,s[32:35],s64 offen  lds
s_add_u32 s64,s74,98304
s_add_u32 m0,s75,12288
s_nop 0
buffer_load_dwordx4 v8,s[32:35],s64 offen  lds
s_add_u32 s64,s74,106496
s_add_u32 m0,s75,13312
s_nop 0
buffer_load_dwordx4 v8,s[32:35],s64 offen  lds
s_add_u32 s64,s74,114688
s_add_u32 m0,s75,14336
s_nop 0
buffer_load_dwordx4 v9,s[32:35],s64 offen  lds
s_add_u32 s64,s74,122880
s_add_u32 m0,s75,15360
s_nop 0
buffer_load_dwordx4 v9,s[32:35],s64 offen  lds
s_add_u32 s64,s74,524288
s_add_u32 m0,s75,65536
s_nop 0
buffer_load_dwordx4 v8,s[32:35],s64 offen  lds
s_add_u32 s64,s74,532480
s_add_u32 m0,s75,66560
s_nop 0
buffer_load_dwordx4 v8,s[32:35],s64 offen  lds
s_add_u32 s64,s74,540672
s_add_u32 m0,s75,67584
s_nop 0
buffer_load_dwordx4 v9,s[32:35],s64 offen  lds
s_add_u32 s64,s74,548864
s_add_u32 m0,s75,68608
s_nop 0
buffer_load_dwordx4 v9,s[32:35],s64 offen  lds
s_add_u32 s64,s74,557056
s_add_u32 m0,s75,69632
s_nop 0
buffer_load_dwordx4 v8,s[32:35],s64 offen  lds
s_add_u32 s64,s74,565248
s_add_u32 m0,s75,70656
s_nop 0
buffer_load_dwordx4 v8,s[32:35],s64 offen  lds
s_add_u32 s64,s74,573440
s_add_u32 m0,s75,71680
s_nop 0
buffer_load_dwordx4 v9,s[32:35],s64 offen  lds
s_add_u32 s64,s74,581632
s_add_u32 m0,s75,72704
s_nop 0
buffer_load_dwordx4 v9,s[32:35],s64 offen  lds
s_add_u32 s64,s74,589824
s_add_u32 m0,s75,73728
s_nop 0
buffer_load_dwordx4 v8,s[32:35],s64 offen  lds
s_add_u32 s64,s74,598016
s_add_u32 m0,s75,74752
s_nop 0
buffer_load_dwordx4 v8,s[32:35],s64 offen  lds
s_add_u32 s64,s74,606208
s_add_u32 m0,s75,75776
s_nop 0
buffer_load_dwordx4 v9,s[32:35],s64 offen  lds
s_add_u32 s64,s74,614400
s_add_u32 m0,s75,76800
s_nop 0
buffer_load_dwordx4 v9,s[32:35],s64 offen  lds
s_add_u32 s64,s74,622592
s_add_u32 m0,s75,77824
s_nop 0
buffer_load_dwordx4 v8,s[32:35],s64 offen  lds
s_add_u32 s64,s74,630784
s_add_u32 m0,s75,78848
s_nop 0
buffer_load_dwordx4 v8,s[32:35],s64 offen  lds
s_add_u32 s64,s74,638976
s_add_u32 m0,s75,79872
s_nop 0
buffer_load_dwordx4 v9,s[32:35],s64 offen  lds
s_add_u32 s64,s74,647168
s_add_u32 m0,s75,80896
s_nop 0
buffer_load_dwordx4 v9,s[32:35],s64 offen  lds
s_waitcnt vmcnt(16)
s_barrier
ds_read_b64_tr_b16 a[0:1],v12 offset:0
ds_read_b64_tr_b16 a[128:129],v13 offset:0
ds_read_b64_tr_b16 a[2:3],v12 offset:1024
ds_read_b64_tr_b16 a[130:131],v13 offset:1024
ds_read_b64_tr_b16 a[4:5],v12 offset:8192
ds_read_b64_tr_b16 a[132:133],v13 offset:8192
ds_read_b64_tr_b16 a[6:7],v12 offset:9216
ds_read_b64_tr_b16 a[134:135],v13 offset:9216
s_waitcnt lgkmcnt(4)
ds_read_b64_tr_b16 a[8:9],v12 offset:16384
ds_read_b64_tr_b16 a[136:137],v13 offset:16384
ds_read_b64_tr_b16 a[10:11],v12 offset:17408
ds_read_b64_tr_b16 a[138:139],v13 offset:17408
ds_read_b64_tr_b16 a[12:13],v12 offset:24576
ds_read_b64_tr_b16 a[140:141],v13 offset:24576
ds_read_b64_tr_b16 a[14:15],v12 offset:25600
ds_read_b64_tr_b16 a[142:143],v13 offset:25600
s_waitcnt lgkmcnt(4)
ds_read_b64_tr_b16 a[16:17],v12 offset:32768
ds_read_b64_tr_b16 a[144:145],v13 offset:32768
ds_read_b64_tr_b16 a[18:19],v12 offset:33792
ds_read_b64_tr_b16 a[146:147],v13 offset:33792
ds_read_b64_tr_b16 a[20:21],v12 offset:40960
ds_read_b64_tr_b16 a[148:149],v13 offset:40960
ds_read_b64_tr_b16 a[22:23],v12 offset:41984
ds_read_b64_tr_b16 a[150:151],v13 offset:41984
s_waitcnt lgkmcnt(4)
ds_read_b64_tr_b16 a[24:25],v12 offset:49152
ds_read_b64_tr_b16 a[152:153],v13 offset:49152
ds_read_b64_tr_b16 a[26:27],v12 offset:50176
ds_read_b64_tr_b16 a[154:155],v13 offset:50176
ds_read_b64_tr_b16 a[28:29],v12 offset:57344
ds_read_b64_tr_b16 a[156:157],v13 offset:57344
ds_read_b64_tr_b16 a[30:31],v12 offset:58368
ds_read_b64_tr_b16 a[158:159],v13 offset:58368
s_waitcnt lgkmcnt(4)
v_xor_b32 v12,0x10000,v12
v_xor_b32 v13,0x10000,v13
s_waitcnt lgkmcnt(0)
s_barrier
s_add_u32 s64,s74,1048576
s_add_u32 m0,s75,0
s_nop 0
buffer_load_dwordx4 v8,s[32:35],s64 offen  lds
s_add_u32 s64,s74,1056768
s_add_u32 m0,s75,1024
s_nop 0
buffer_load_dwordx4 v8,s[32:35],s64 offen  lds
s_add_u32 s64,s74,1064960
s_add_u32 m0,s75,2048
s_nop 0
buffer_load_dwordx4 v9,s[32:35],s64 offen  lds
s_add_u32 s64,s74,1073152
s_add_u32 m0,s75,3072
s_nop 0
buffer_load_dwordx4 v9,s[32:35],s64 offen  lds
s_add_u32 s64,s74,1081344
s_add_u32 m0,s75,4096
s_nop 0
buffer_load_dwordx4 v8,s[32:35],s64 offen  lds
s_add_u32 s64,s74,1089536
s_add_u32 m0,s75,5120
s_nop 0
buffer_load_dwordx4 v8,s[32:35],s64 offen  lds
s_add_u32 s64,s74,1097728
s_add_u32 m0,s75,6144
s_nop 0
buffer_load_dwordx4 v9,s[32:35],s64 offen  lds
s_add_u32 s64,s74,1105920
s_add_u32 m0,s75,7168
s_nop 0
buffer_load_dwordx4 v9,s[32:35],s64 offen  lds
s_add_u32 s64,s74,1114112
s_add_u32 m0,s75,8192
s_nop 0
buffer_load_dwordx4 v8,s[32:35],s64 offen  lds
s_add_u32 s64,s74,1122304
s_add_u32 m0,s75,9216
s_nop 0
buffer_load_dwordx4 v8,s[32:35],s64 offen  lds
s_add_u32 s64,s74,1130496
s_add_u32 m0,s75,10240
s_nop 0
buffer_load_dwordx4 v9,s[32:35],s64 offen  lds
s_add_u32 s64,s74,1138688
s_add_u32 m0,s75,11264
s_nop 0
buffer_load_dwordx4 v9,s[32:35],s64 offen  lds
s_add_u32 s64,s74,1146880
s_add_u32 m0,s75,12288
s_nop 0
buffer_load_dwordx4 v8,s[32:35],s64 offen  lds
s_add_u32 s64,s74,1155072
s_add_u32 m0,s75,13312
s_nop 0
buffer_load_dwordx4 v8,s[32:35],s64 offen  lds
s_add_u32 s64,s74,1163264
s_add_u32 m0,s75,14336
s_nop 0
buffer_load_dwordx4 v9,s[32:35],s64 offen  lds
s_add_u32 s64,s74,1171456
s_add_u32 m0,s75,15360
s_nop 0
buffer_load_dwordx4 v9,s[32:35],s64 offen  lds
s_waitcnt vmcnt(16)
s_barrier
ds_read_b64_tr_b16 a[32:33],v12 offset:0
ds_read_b64_tr_b16 a[160:161],v13 offset:0
ds_read_b64_tr_b16 a[34:35],v12 offset:1024
ds_read_b64_tr_b16 a[162:163],v13 offset:1024
ds_read_b64_tr_b16 a[36:37],v12 offset:8192
ds_read_b64_tr_b16 a[164:165],v13 offset:8192
ds_read_b64_tr_b16 a[38:39],v12 offset:9216
ds_read_b64_tr_b16 a[166:167],v13 offset:9216
s_waitcnt lgkmcnt(4)
ds_read_b64_tr_b16 a[40:41],v12 offset:16384
ds_read_b64_tr_b16 a[168:169],v13 offset:16384
ds_read_b64_tr_b16 a[42:43],v12 offset:17408
ds_read_b64_tr_b16 a[170:171],v13 offset:17408
ds_read_b64_tr_b16 a[44:45],v12 offset:24576
ds_read_b64_tr_b16 a[172:173],v13 offset:24576
ds_read_b64_tr_b16 a[46:47],v12 offset:25600
ds_read_b64_tr_b16 a[174:175],v13 offset:25600
s_waitcnt lgkmcnt(4)
ds_read_b64_tr_b16 a[48:49],v12 offset:32768
ds_read_b64_tr_b16 a[176:177],v13 offset:32768
ds_read_b64_tr_b16 a[50:51],v12 offset:33792
ds_read_b64_tr_b16 a[178:179],v13 offset:33792
ds_read_b64_tr_b16 a[52:53],v12 offset:40960
ds_read_b64_tr_b16 a[180:181],v13 offset:40960
ds_read_b64_tr_b16 a[54:55],v12 offset:41984
ds_read_b64_tr_b16 a[182:183],v13 offset:41984
s_waitcnt lgkmcnt(4)
ds_read_b64_tr_b16 a[56:57],v12 offset:49152
ds_read_b64_tr_b16 a[184:185],v13 offset:49152
ds_read_b64_tr_b16 a[58:59],v12 offset:50176
ds_read_b64_tr_b16 a[186:187],v13 offset:50176
ds_read_b64_tr_b16 a[60:61],v12 offset:57344
ds_read_b64_tr_b16 a[188:189],v13 offset:57344
ds_read_b64_tr_b16 a[62:63],v12 offset:58368
ds_read_b64_tr_b16 a[190:191],v13 offset:58368
s_waitcnt lgkmcnt(4)
v_xor_b32 v12,0x10000,v12
v_xor_b32 v13,0x10000,v13
s_waitcnt lgkmcnt(0)
s_barrier
s_add_u32 s64,s74,1572864
s_add_u32 m0,s75,65536
s_nop 0
buffer_load_dwordx4 v8,s[32:35],s64 offen  lds
s_add_u32 s64,s74,1581056
s_add_u32 m0,s75,66560
s_nop 0
buffer_load_dwordx4 v8,s[32:35],s64 offen  lds
s_add_u32 s64,s74,1589248
s_add_u32 m0,s75,67584
s_nop 0
buffer_load_dwordx4 v9,s[32:35],s64 offen  lds
s_add_u32 s64,s74,1597440
s_add_u32 m0,s75,68608
s_nop 0
buffer_load_dwordx4 v9,s[32:35],s64 offen  lds
s_add_u32 s64,s74,1605632
s_add_u32 m0,s75,69632
s_nop 0
buffer_load_dwordx4 v8,s[32:35],s64 offen  lds
s_add_u32 s64,s74,1613824
s_add_u32 m0,s75,70656
s_nop 0
buffer_load_dwordx4 v8,s[32:35],s64 offen  lds
s_add_u32 s64,s74,1622016
s_add_u32 m0,s75,71680
s_nop 0
buffer_load_dwordx4 v9,s[32:35],s64 offen  lds
s_add_u32 s64,s74,1630208
s_add_u32 m0,s75,72704
s_nop 0
buffer_load_dwordx4 v9,s[32:35],s64 offen  lds
s_add_u32 s64,s74,1638400
s_add_u32 m0,s75,73728
s_nop 0
buffer_load_dwordx4 v8,s[32:35],s64 offen  lds
s_add_u32 s64,s74,1646592
s_add_u32 m0,s75,74752
s_nop 0
buffer_load_dwordx4 v8,s[32:35],s64 offen  lds
s_add_u32 s64,s74,1654784
s_add_u32 m0,s75,75776
s_nop 0
buffer_load_dwordx4 v9,s[32:35],s64 offen  lds
s_add_u32 s64,s74,1662976
s_add_u32 m0,s75,76800
s_nop 0
buffer_load_dwordx4 v9,s[32:35],s64 offen  lds
s_add_u32 s64,s74,1671168
s_add_u32 m0,s75,77824
s_nop 0
buffer_load_dwordx4 v8,s[32:35],s64 offen  lds
s_add_u32 s64,s74,1679360
s_add_u32 m0,s75,78848
s_nop 0
buffer_load_dwordx4 v8,s[32:35],s64 offen  lds
s_add_u32 s64,s74,1687552
s_add_u32 m0,s75,79872
s_nop 0
buffer_load_dwordx4 v9,s[32:35],s64 offen  lds
s_add_u32 s64,s74,1695744
s_add_u32 m0,s75,80896
s_nop 0
buffer_load_dwordx4 v9,s[32:35],s64 offen  lds
s_waitcnt vmcnt(16)
s_barrier
ds_read_b64_tr_b16 a[64:65],v12 offset:0
ds_read_b64_tr_b16 a[192:193],v13 offset:0
ds_read_b64_tr_b16 a[66:67],v12 offset:1024
ds_read_b64_tr_b16 a[194:195],v13 offset:1024
ds_read_b64_tr_b16 a[68:69],v12 offset:8192
ds_read_b64_tr_b16 a[196:197],v13 offset:8192
ds_read_b64_tr_b16 a[70:71],v12 offset:9216
ds_read_b64_tr_b16 a[198:199],v13 offset:9216
s_waitcnt lgkmcnt(4)
ds_read_b64_tr_b16 a[72:73],v12 offset:16384
ds_read_b64_tr_b16 a[200:201],v13 offset:16384
ds_read_b64_tr_b16 a[74:75],v12 offset:17408
ds_read_b64_tr_b16 a[202:203],v13 offset:17408
ds_read_b64_tr_b16 a[76:77],v12 offset:24576
ds_read_b64_tr_b16 a[204:205],v13 offset:24576
ds_read_b64_tr_b16 a[78:79],v12 offset:25600
ds_read_b64_tr_b16 a[206:207],v13 offset:25600
s_waitcnt lgkmcnt(4)
ds_read_b64_tr_b16 a[80:81],v12 offset:32768
ds_read_b64_tr_b16 a[208:209],v13 offset:32768
ds_read_b64_tr_b16 a[82:83],v12 offset:33792
ds_read_b64_tr_b16 a[210:211],v13 offset:33792
ds_read_b64_tr_b16 a[84:85],v12 offset:40960
ds_read_b64_tr_b16 a[212:213],v13 offset:40960
ds_read_b64_tr_b16 a[86:87],v12 offset:41984
ds_read_b64_tr_b16 a[214:215],v13 offset:41984
s_waitcnt lgkmcnt(4)
ds_read_b64_tr_b16 a[88:89],v12 offset:49152
ds_read_b64_tr_b16 a[216:217],v13 offset:49152
ds_read_b64_tr_b16 a[90:91],v12 offset:50176
ds_read_b64_tr_b16 a[218:219],v13 offset:50176
ds_read_b64_tr_b16 a[92:93],v12 offset:57344
ds_read_b64_tr_b16 a[220:221],v13 offset:57344
ds_read_b64_tr_b16 a[94:95],v12 offset:58368
ds_read_b64_tr_b16 a[222:223],v13 offset:58368
s_waitcnt lgkmcnt(4)
v_xor_b32 v12,0x10000,v12
v_xor_b32 v13,0x10000,v13
s_waitcnt lgkmcnt(0)
s_barrier
s_waitcnt vmcnt(0)
s_barrier
ds_read_b64_tr_b16 a[96:97],v12 offset:0
ds_read_b64_tr_b16 a[224:225],v13 offset:0
ds_read_b64_tr_b16 a[98:99],v12 offset:1024
ds_read_b64_tr_b16 a[226:227],v13 offset:1024
ds_read_b64_tr_b16 a[100:101],v12 offset:8192
ds_read_b64_tr_b16 a[228:229],v13 offset:8192
ds_read_b64_tr_b16 a[102:103],v12 offset:9216
ds_read_b64_tr_b16 a[230:231],v13 offset:9216
s_waitcnt lgkmcnt(4)
ds_read_b64_tr_b16 a[104:105],v12 offset:16384
ds_read_b64_tr_b16 a[232:233],v13 offset:16384
ds_read_b64_tr_b16 a[106:107],v12 offset:17408
ds_read_b64_tr_b16 a[234:235],v13 offset:17408
ds_read_b64_tr_b16 a[108:109],v12 offset:24576
ds_read_b64_tr_b16 a[236:237],v13 offset:24576
ds_read_b64_tr_b16 a[110:111],v12 offset:25600
ds_read_b64_tr_b16 a[238:239],v13 offset:25600
s_waitcnt lgkmcnt(4)
ds_read_b64_tr_b16 a[112:113],v12 offset:32768
ds_read_b64_tr_b16 a[240:241],v13 offset:32768
ds_read_b64_tr_b16 a[114:115],v12 offset:33792
ds_read_b64_tr_b16 a[242:243],v13 offset:33792
ds_read_b64_tr_b16 a[116:117],v12 offset:40960
ds_read_b64_tr_b16 a[244:245],v13 offset:40960
ds_read_b64_tr_b16 a[118:119],v12 offset:41984
ds_read_b64_tr_b16 a[246:247],v13 offset:41984
s_waitcnt lgkmcnt(4)
ds_read_b64_tr_b16 a[120:121],v12 offset:49152
ds_read_b64_tr_b16 a[248:249],v13 offset:49152
ds_read_b64_tr_b16 a[122:123],v12 offset:50176
ds_read_b64_tr_b16 a[250:251],v13 offset:50176
ds_read_b64_tr_b16 a[124:125],v12 offset:57344
ds_read_b64_tr_b16 a[252:253],v13 offset:57344
ds_read_b64_tr_b16 a[126:127],v12 offset:58368
ds_read_b64_tr_b16 a[254:255],v13 offset:58368
s_waitcnt lgkmcnt(4)
v_xor_b32 v12,0x10000,v12
v_xor_b32 v13,0x10000,v13
s_waitcnt lgkmcnt(0)
s_barrier
v_and_b32 v21,1,v1
v_mul_u32_u24 v21,896,v21
s_mov_b32 s65,21052032
s_mov_b32 s66,1792
pl_184:
buffer_load_dword v22,v21,s[20:23],s65 offen sc1
s_waitcnt vmcnt(0)
v_cmp_gt_u32 vcc,s66,v22
s_cbranch_vccz pok_185
s_sleep 1
s_sub_u32 s90,s90,1
s_cmp_gt_i32 s90,0
s_cbranch_scc1 pl_184
pok_185:
s_mov_b32 s81,0xbdd2d3e8
v_mov_b32 v28,0xc0135761
v_mov_b32 v17,v16
v_and_b32 v21,31,v1
v_lshlrev_b32 v21,2,v21
s_add_u32 s74,s63,2560
s_lshl_b32 s42,s41,2
s_add_u32 s42,s42,s50
s_lshl_b32 s73,s42,2
s_add_u32 s73,s73,s63
s_add_u32 s73,s73,3072
s_lshl_b32 s72,s50,12
s_add_u32 s75,s72,8577024
s_lshr_b32 s64,s41,1
s_lshl_b32 s64,s64,2
s_lshr_b32 s64,0x0413,s64
s_and_b32 s64,s64,7
s_lshl_b32 s65,s42,11
s_add_u32 s65,s65,12771328
v_lshl_add_u32 v7,v4,8,s65
v_add_u32 v6,s64,v3
v_and_b32 v5,15,v6
v_lshl_add_u32 v5,v5,4,v7
v_bfe_u32 v8,v6,4,1
v_lshl_add_u32 v5,v8,10,v5
v_lshrrev_b32 v6,5,v6
v_lshl_add_u32 v18,v6,16,v5
s_add_u32 s64,s64,16
v_add_u32 v6,s64,v3
v_and_b32 v5,15,v6
v_lshl_add_u32 v5,v5,4,v7
v_bfe_u32 v8,v6,4,1
v_lshl_add_u32 v5,v8,10,v5
v_lshrrev_b32 v6,5,v6
v_lshl_add_u32 v19,v6,16,v5
s_add_u32 s64,s64,16
ml_186:
s_lshl_b32 s78,s79,16
s_add_u32 s67,s78,s75
s_add_u32 s89,s67,65536
s_xor_b32 s91,s72,0x10000
s_cmp_lg_u32 s83,0
s_cbranch_scc1 pre_187
v_cmp_gt_u32 vcc,s71,v29
s_cbranch_vccz nopoll_188
pl_189:
buffer_load_dword v22,v21,s[20:23],s74 offen sc1
s_waitcnt vmcnt(0)
v_cmp_gt_u32 vcc,s71,v22
s_cbranch_vccz pok_190
s_sleep 1
s_sub_u32 s90,s90,1
s_cmp_gt_i32 s90,0
s_cbranch_scc1 pl_189
pok_190:
v_mov_b32 v29,v22
nopoll_188:
s_add_u32 m0,s72,0
s_add_u32 s65,s67,0
buffer_load_dwordx4 v16,s[20:23],s65 offen offset:0 sc1 lds
buffer_load_dwordx4 v16,s[20:23],s65 offen offset:1024 sc1 lds
buffer_load_dwordx4 v16,s[20:23],s65 offen offset:2048 sc1 lds
buffer_load_dwordx4 v16,s[20:23],s65 offen offset:3072 sc1 lds
s_add_u32 m0,s72,16384
s_add_u32 s65,s67,16384
buffer_load_dwordx4 v16,s[20:23],s65 offen offset:0 sc1 lds
buffer_load_dwordx4 v16,s[20:23],s65 offen offset:1024 sc1 lds
buffer_load_dwordx4 v16,s[20:23],s65 offen offset:2048 sc1 lds
buffer_load_dwordx4 v16,s[20:23],s65 offen offset:3072 sc1 lds
s_add_u32 m0,s72,32768
s_add_u32 s65,s67,32768
buffer_load_dwordx4 v16,s[20:23],s65 offen offset:0 sc1 lds
buffer_load_dwordx4 v16,s[20:23],s65 offen offset:1024 sc1 lds
buffer_load_dwordx4 v16,s[20:23],s65 offen offset:2048 sc1 lds
buffer_load_dwordx4 v16,s[20:23],s65 offen offset:3072 sc1 lds
s_add_u32 m0,s72,49152
s_add_u32 s65,s67,49152
buffer_load_dwordx4 v16,s[20:23],s65 offen offset:0 sc1 lds
buffer_load_dwordx4 v16,s[20:23],s65 offen offset:1024 sc1 lds
buffer_load_dwordx4 v16,s[20:23],s65 offen offset:2048 sc1 lds
buffer_load_dwordx4 v16,s[20:23],s65 offen offset:3072 sc1 lds
pre_187:
s_add_u32 s64,s71,1
v_cmp_gt_u32 vcc,s64,v29
s_cmp_eq_u64 vcc,0
s_cselect_b32 s83,1,0
s_cselect_b32 s89,s89,0x7fff0000
s_waitcnt vmcnt(12)
s_barrier
ds_read_b128 v[32:35],v17 offset:0
ds_read_b128 v[36:39],v17 offset:1024
ds_read_b128 v[40:43],v17 offset:2048
s_waitcnt lgkmcnt(2)
v_mfma_f32_16x16x32_bf16 v[64:67],a[0:3],v[32:35],0
ds_read_b128 v[44:47],v17 offset:3072
v_mfma_f32_16x16x32_bf16 v[72:75],a[128:131],v[32:35],0
s_waitcnt lgkmcnt(2)
v_mfma_f32_16x16x32_bf16 v[68:71],a[0:3],v[36:39],0
ds_read_b128 v[32:35],v17 offset:4096
s_add_u32 m0,s91,0
s_add_u32 s65,s89,0
v_mfma_f32_16x16x32_bf16 v[76:79],a[128:131],v[36:39],0
s_waitcnt lgkmcnt(2)
v_mfma_f32_16x16x32_bf16 v[64:67],a[4:7],v[40:43],v[64:67]
ds_read_b128 v[36:39],v17 offset:5120
v_mfma_f32_16x16x32_bf16 v[72:75],a[132:135],v[40:43],v[72:75]
s_waitcnt lgkmcnt(2)
v_mfma_f32_16x16x32_bf16 v[68:71],a[4:7],v[44:47],v[68:71]
ds_read_b128 v[40:43],v17 offset:6144
buffer_load_dwordx4 v16,s[20:23],s65 offen offset:0 sc1 lds
v_mfma_f32_16x16x32_bf16 v[76:79],a[132:135],v[44:47],v[76:79]
s_waitcnt lgkmcnt(2)
v_mfma_f32_16x16x32_bf16 v[64:67],a[8:11],v[32:35],v[64:67]
ds_read_b128 v[44:47],v17 offset:7168
v_mfma_f32_16x16x32_bf16 v[72:75],a[136:139],v[32:35],v[72:75]
s_waitcnt lgkmcnt(2)
v_mfma_f32_16x16x32_bf16 v[68:71],a[8:11],v[36:39],v[68:71]
ds_read_b128 v[32:35],v17 offset:8192
v_mfma_f32_16x16x32_bf16 v[76:79],a[136:139],v[36:39],v[76:79]
buffer_load_dwordx4 v16,s[20:23],s65 offen offset:1024 sc1 lds
s_waitcnt lgkmcnt(2)
v_mfma_f32_16x16x32_bf16 v[64:67],a[12:15],v[40:43],v[64:67]
ds_read_b128 v[36:39],v17 offset:9216
v_mfma_f32_16x16x32_bf16 v[72:75],a[140:143],v[40:43],v[72:75]
s_waitcnt lgkmcnt(2)
v_mfma_f32_16x16x32_bf16 v[68:71],a[12:15],v[44:47],v[68:71]
ds_read_b128 v[40:43],v17 offset:10240
v_mfma_f32_16x16x32_bf16 v[76:79],a[140:143],v[44:47],v[76:79]
s_waitcnt lgkmcnt(2)
v_mfma_f32_16x16x32_bf16 v[64:67],a[16:19],v[32:35],v[64:67]
ds_read_b128 v[44:47],v17 offset:11264
buffer_load_dwordx4 v16,s[20:23],s65 offen offset:2048 sc1 lds
v_mfma_f32_16x16x32_bf16 v[72:75],a[144:147],v[32:35],v[72:75]
s_waitcnt lgkmcnt(2)
v_mfma_f32_16x16x32_bf16 v[68:71],a[16:19],v[36:39],v[68:71]
ds_read_b128 v[32:35],v17 offset:12288
v_mfma_f32_16x16x32_bf16 v[76:79],a[144:147],v[36:39],v[76:79]
s_waitcnt lgkmcnt(2)
v_mfma_f32_16x16x32_bf16 v[64:67],a[20:23],v[40:43],v[64:67]
ds_read_b128 v[36:39],v17 offset:13312
buffer_load_dwordx4 v16,s[20:23],s65 offen offset:3072 sc1 lds
v_mfma_f32_16x16x32_bf16 v[72:75],a[148:151],v[40:43],v[72:75]
s_waitcnt lgkmcnt(2)
v_mfma_f32_16x16x32_bf16 v[68:71],a[20:23],v[44:47],v[68:71]
ds_read_b128 v[40:43],v17 offset:14336
v_mfma_f32_16x16x32_bf16 v[76:79],a[148:151],v[44:47],v[76:79]
s_waitcnt lgkmcnt(2)
v_mfma_f32_16x16x32_bf16 v[64:67],a[24:27],v[32:35],v[64:67]
ds_read_b128 v[44:47],v17 offset:15360
v_mfma_f32_16x16x32_bf16 v[72:75],a[152:155],v[32:35],v[72:75]
s_add_u32 m0,s91,16384
s_add_u32 s65,s89,16384
s_waitcnt lgkmcnt(2)
v_mfma_f32_16x16x32_bf16 v[68:71],a[24:27],v[36:39],v[68:71]
s_waitcnt vmcnt(12)
s_barrier
ds_read_b128 v[32:35],v17 offset:16384
v_mfma_f32_16x16x32_bf16 v[76:79],a[152:155],v[36:39],v[76:79]
s_waitcnt lgkmcnt(2)
v_mfma_f32_16x16x32_bf16 v[64:67],a[28:31],v[40:43],v[64:67]
ds_read_b128 v[36:39],v17 offset:17408
v_mfma_f32_16x16x32_bf16 v[72:75],a[156:159],v[40:43],v[72:75]
s_waitcnt lgkmcnt(2)
v_mfma_f32_16x16x32_bf16 v[68:71],a[28:31],v[44:47],v[68:71]
ds_read_b128 v[40:43],v17 offset:18432
buffer_load_dwordx4 v16,s[20:23],s65 offen offset:0 sc1 lds
v_mfma_f32_16x16x32_bf16 v[76:79],a[156:159],v[44:47],v[76:79]
s_waitcnt lgkmcnt(2)
v_mfma_f32_16x16x32_bf16 v[64:67],a[32:35],v[32:35],v[64:67]
ds_read_b128 v[44:47],v17 offset:19456
v_mfma_f32_16x16x32_bf16 v[72:75],a[160:163],v[32:35],v[72:75]
s_waitcnt lgkmcnt(2)
v_mfma_f32_16x16x32_bf16 v[68:71],a[32:35],v[36:39],v[68:71]
ds_read_b128 v[32:35],v17 offset:20480
buffer_load_dwordx4 v16,s[20:23],s65 offen offset:1024 sc1 lds
v_mfma_f32_16x16x32_bf16 v[76:79],a[160:163],v[36:39],v[76:79]
s_waitcnt lgkmcnt(2)
v_mfma_f32_16x16x32_bf16 v[64:67],a[36:39],v[40:43],v[64:67]
ds_read_b128 v[36:39],v17 offset:21504
v_mfma_f32_16x16x32_bf16 v[72:75],a[164:167],v[40:43],v[72:75]
s_waitcnt lgkmcnt(2)
v_mfma_f32_16x16x32_bf16 v[68:71],a[36:39],v[44:47],v[68:71]
ds_read_b128 v[40:43],v17 offset:22528
v_mfma_f32_16x16x32_bf16 v[76:79],a[164:167],v[44:47],v[76:79]
buffer_load_dwordx4 v16,s[20:23],s65 offen offset:2048 sc1 lds
s_waitcnt lgkmcnt(2)
v_mfma_f32_16x16x32_bf16 v[64:67],a[40:43],v[32:35],v[64:67]
ds_read_b128 v[44:47],v17 offset:23552
v_mfma_f32_16x16x32_bf16 v[72:75],a[168:171],v[32:35],v[72:75]
s_waitcnt lgkmcnt(2)
v_mfma_f32_16x16x32_bf16 v[68:71],a[40:43],v[36:39],v[68:71]
ds_read_b128 v[32:35],v17 offset:24576
v_mfma_f32_16x16x32_bf16 v[76:79],a[168:171],v[36:39],v[76:79]
s_waitcnt lgkmcnt(2)
v_mfma_f32_16x16x32_bf16 v[64:67],a[44:47],v[40:43],v[64:67]
ds_read_b128 v[36:39],v17 offset:25600
buffer_load_dwordx4 v16,s[20:23],s65 offen offset:3072 sc1 lds
v_mfma_f32_16x16x32_bf16 v[72:75],a[172:175],v[40:43],v[72:75]
s_waitcnt lgkmcnt(2)
v_mfma_f32_16x16x32_bf16 v[68:71],a[44:47],v[44:47],v[68:71]
ds_read_b128 v[40:43],v17 offset:26624
v_mfma_f32_16x16x32_bf16 v[76:79],a[172:175],v[44:47],v[76:79]
s_waitcnt lgkmcnt(2)
v_mfma_f32_16x16x32_bf16 v[64:67],a[48:51],v[32:35],v[64:67]
ds_read_b128 v[44:47],v17 offset:27648
v_mfma_f32_16x16x32_bf16 v[72:75],a[176:179],v[32:35],v[72:75]
s_add_u32 m0,s91,32768
s_add_u32 s65,s89,32768
s_waitcnt lgkmcnt(2)
v_mfma_f32_16x16x32_bf16 v[68:71],a[48:51],v[36:39],v[68:71]
ds_read_b128 v[32:35],v17 offset:28672
v_mfma_f32_16x16x32_bf16 v[76:79],a[176:179],v[36:39],v[76:79]
s_waitcnt lgkmcnt(2)
v_mfma_f32_16x16x32_bf16 v[64:67],a[52:55],v[40:43],v[64:67]
ds_read_b128 v[36:39],v17 offset:29696
v_mfma_f32_16x16x32_bf16 v[72:75],a[180:183],v[40:43],v[72:75]
buffer_load_dwordx4 v16,s[20:23],s65 offen offset:0 sc1 lds
s_waitcnt lgkmcnt(2)
v_mfma_f32_16x16x32_bf16 v[68:71],a[52:55],v[44:47],v[68:71]
ds_read_b128 v[40:43],v17 offset:30720
v_mfma_f32_16x16x32_bf16 v[76:79],a[180:183],v[44:47],v[76:79]
s_waitcnt lgkmcnt(2)
v_mfma_f32_16x16x32_bf16 v[64:67],a[56:59],v[32:35],v[64:67]
ds_read_b128 v[44:47],v17 offset:31744
v_mfma_f32_16x16x32_bf16 v[72:75],a[184:187],v[32:35],v[72:75]
s_waitcnt lgkmcnt(2)
v_mfma_f32_16x16x32_bf16 v[68:71],a[56:59],v[36:39],v[68:71]
s_waitcnt vmcnt(13)
s_barrier
ds_read_b128 v[32:35],v17 offset:32768
buffer_load_dwordx4 v16,s[20:23],s65 offen offset:1024 sc1 lds
v_mfma_f32_16x16x32_bf16 v[76:79],a[184:187],v[36:39],v[76:79]
s_waitcnt lgkmcnt(2)
v_mfma_f32_16x16x32_bf16 v[64:67],a[60:63],v[40:43],v[64:67]
ds_read_b128 v[36:39],v17 offset:33792
v_mfma_f32_16x16x32_bf16 v[72:75],a[188:191],v[40:43],v[72:75]
s_waitcnt lgkmcnt(2)
v_mfma_f32_16x16x32_bf16 v[68:71],a[60:63],v[44:47],v[68:71]
ds_read_b128 v[40:43],v17 offset:34816
v_mfma_f32_16x16x32_bf16 v[76:79],a[188:191],v[44:47],v[76:79]
buffer_load_dwordx4 v16,s[20:23],s65 offen offset:2048 sc1 lds
s_waitcnt lgkmcnt(2)
v_mfma_f32_16x16x32_bf16 v[64:67],a[64:67],v[32:35],v[64:67]
ds_read_b128 v[44:47],v17 offset:35840
v_mfma_f32_16x16x32_bf16 v[72:75],a[192:195],v[32:35],v[72:75]
s_waitcnt lgkmcnt(2)
v_mfma_f32_16x16x32_bf16 v[68:71],a[64:67],v[36:39],v[68:71]
ds_read_b128 v[32:35],v17 offset:36864
v_mfma_f32_16x16x32_bf16 v[76:79],a[192:195],v[36:39],v[76:79]
buffer_load_dwordx4 v16,s[20:23],s65 offen offset:3072 sc1 lds
s_waitcnt lgkmcnt(2)
v_mfma_f32_16x16x32_bf16 v[64:67],a[68:71],v[40:43],v[64:67]
ds_read_b128 v[36:39],v17 offset:37888
v_mfma_f32_16x16x32_bf16 v[72:75],a[196:199],v[40:43],v[72:75]
s_waitcnt lgkmcnt(2)
v_mfma_f32_16x16x32_bf16 v[68:71],a[68:71],v[44:47],v[68:71]
ds_read_b128 v[40:43],v17 offset:38912
v_mfma_f32_16x16x32_bf16 v[76:79],a[196:199],v[44:47],v[76:79]
s_waitcnt lgkmcnt(2)
v_mfma_f32_16x16x32_bf16 v[64:67],a[72:75],v[32:35],v[64:67]
ds_read_b128 v[44:47],v17 offset:39936
s_add_u32 m0,s91,49152
s_add_u32 s65,s89,49152
v_mfma_f32_16x16x32_bf16 v[72:75],a[200:203],v[32:35],v[72:75]
s_waitcnt lgkmcnt(2)
v_mfma_f32_16x16x32_bf16 v[68:71],a[72:75],v[36:39],v[68:71]
ds_read_b128 v[32:35],v17 offset:40960
v_mfma_f32_16x16x32_bf16 v[76:79],a[200:203],v[36:39],v[76:79]
s_waitcnt lgkmcnt(2)
v_mfma_f32_16x16x32_bf16 v[64:67],a[76:79],v[40:43],v[64:67]
ds_read_b128 v[36:39],v17 offset:41984
v_mfma_f32_16x16x32_bf16 v[72:75],a[204:207],v[40:43],v[72:75]
buffer_load_dwordx4 v16,s[20:23],s65 offen offset:0 sc1 lds
s_waitcnt lgkmcnt(2)
v_mfma_f32_16x16x32_bf16 v[68:71],a[76:79],v[44:47],v[68:71]
ds_read_b128 v[40:43],v17 offset:43008
v_mfma_f32_16x16x32_bf16 v[76:79],a[204:207],v[44:47],v[76:79]
s_waitcnt lgkmcnt(2)
v_mfma_f32_16x16x32_bf16 v[64:67],a[80:83],v[32:35],v[64:67]
ds_read_b128 v[44:47],v17 offset:44032
v_mfma_f32_16x16x32_bf16 v[72:75],a[208:211],v[32:35],v[72:75]
buffer_load_dwordx4 v16,s[20:23],s65 offen offset:1024 sc1 lds
s_waitcnt lgkmcnt(2)
v_mfma_f32_16x16x32_bf16 v[68:71],a[80:83],v[36:39],v[68:71]
ds_read_b128 v[32:35],v17 offset:45056
v_mfma_f32_16x16x32_bf16 v[76:79],a[208:211],v[36:39],v[76:79]
s_waitcnt lgkmcnt(2)
v_mfma_f32_16x16x32_bf16 v[64:67],a[84:87],v[40:43],v[64:67]
ds_read_b128 v[36:39],v17 offset:46080
v_mfma_f32_16x16x32_bf16 v[72:75],a[212:215],v[40:43],v[72:75]
s_waitcnt lgkmcnt(2)
v_mfma_f32_16x16x32_bf16 v[68:71],a[84:87],v[44:47],v[68:71]
ds_read_b128 v[40:43],v17 offset:47104
buffer_load_dwordx4 v16,s[20:23],s65 offen offset:2048 sc1 lds
v_mfma_f32_16x16x32_bf16 v[76:79],a[212:215],v[44:47],v[76:79]
s_waitcnt lgkmcnt(2)
v_mfma_f32_16x16x32_bf16 v[64:67],a[88:91],v[32:35],v[64:67]
ds_read_b128 v[44:47],v17 offset:48128
v_mfma_f32_16x16x32_bf16 v[72:75],a[216:219],v[32:35],v[72:75]
s_waitcnt lgkmcnt(2)
v_mfma_f32_16x16x32_bf16 v[68:71],a[88:91],v[36:39],v[68:71]
s_waitcnt vmcnt(15)
s_barrier
ds_read_b128 v[32:35],v17 offset:49152
v_mfma_f32_16x16x32_bf16 v[76:79],a[216:219],v[36:39],v[76:79]
buffer_load_dwordx4 v16,s[20:23],s65 offen offset:3072 sc1 lds
s_waitcnt lgkmcnt(2)
v_mfma_f32_16x16x32_bf16 v[64:67],a[92:95],v[40:43],v[64:67]
ds_read_b128 v[36:39],v17 offset:50176
v_mfma_f32_16x16x32_bf16 v[72:75],a[220:223],v[40:43],v[72:75]
s_waitcnt lgkmcnt(2)
v_mfma_f32_16x16x32_bf16 v[68:71],a[92:95],v[44:47],v[68:71]
ds_read_b128 v[40:43],v17 offset:51200
v_mfma_f32_16x16x32_bf16 v[76:79],a[220:223],v[44:47],v[76:79]
s_waitcnt lgkmcnt(2)
v_mfma_f32_16x16x32_bf16 v[64:67],a[96:99],v[32:35],v[64:67]
ds_read_b128 v[44:47],v17 offset:52224
v_mfma_f32_16x16x32_bf16 v[72:75],a[224:227],v[32:35],v[72:75]
s_waitcnt lgkmcnt(2)
v_mfma_f32_16x16x32_bf16 v[68:71],a[96:99],v[36:39],v[68:71]
ds_read_b128 v[32:35],v17 offset:53248
v_mfma_f32_16x16x32_bf16 v[76:79],a[224:227],v[36:39],v[76:79]
s_waitcnt lgkmcnt(2)
v_mfma_f32_16x16x32_bf16 v[64:67],a[100:103],v[40:43],v[64:67]
ds_read_b128 v[36:39],v17 offset:54272
v_mfma_f32_16x16x32_bf16 v[72:75],a[228:231],v[40:43],v[72:75]
s_waitcnt lgkmcnt(2)
v_mfma_f32_16x16x32_bf16 v[68:71],a[100:103],v[44:47],v[68:71]
ds_read_b128 v[40:43],v17 offset:55296
v_mfma_f32_16x16x32_bf16 v[76:79],a[228:231],v[44:47],v[76:79]
s_waitcnt lgkmcnt(2)
v_mfma_f32_16x16x32_bf16 v[64:67],a[104:107],v[32:35],v[64:67]
ds_read_b128 v[44:47],v17 offset:56320
v_mfma_f32_16x16x32_bf16 v[72:75],a[232:235],v[32:35],v[72:75]
s_waitcnt lgkmcnt(2)
v_mfma_f32_16x16x32_bf16 v[68:71],a[104:107],v[36:39],v[68:71]
ds_read_b128 v[32:35],v17 offset:57344
v_mfma_f32_16x16x32_bf16 v[76:79],a[232:235],v[36:39],v[76:79]
s_waitcnt lgkmcnt(2)
v_mfma_f32_16x16x32_bf16 v[64:67],a[108:111],v[40:43],v[64:67]
ds_read_b128 v[36:39],v17 offset:58368
v_mfma_f32_16x16x32_bf16 v[72:75],a[236:239],v[40:43],v[72:75]
s_waitcnt lgkmcnt(2)
v_mfma_f32_16x16x32_bf16 v[68:71],a[108:111],v[44:47],v[68:71]
ds_read_b128 v[40:43],v17 offset:59392
v_mfma_f32_16x16x32_bf16 v[76:79],a[236:239],v[44:47],v[76:79]
s_waitcnt lgkmcnt(2)
v_mfma_f32_16x16x32_bf16 v[64:67],a[112:115],v[32:35],v[64:67]
ds_read_b128 v[44:47],v17 offset:60416
v_mfma_f32_16x16x32_bf16 v[72:75],a[240:243],v[32:35],v[72:75]
s_waitcnt lgkmcnt(2)
v_mfma_f32_16x16x32_bf16 v[68:71],a[112:115],v[36:39],v[68:71]
ds_read_b128 v[32:35],v17 offset:61440
v_mfma_f32_16x16x32_bf16 v[76:79],a[240:243],v[36:39],v[76:79]
s_waitcnt lgkmcnt(2)
v_mfma_f32_16x16x32_bf16 v[64:67],a[116:119],v[40:43],v[64:67]
ds_read_b128 v[36:39],v17 offset:62464
v_mfma_f32_16x16x32_bf16 v[72:75],a[244:247],v[40:43],v[72:75]
s_waitcnt lgkmcnt(2)
v_mfma_f32_16x16x32_bf16 v[68:71],a[116:119],v[44:47],v[68:71]
ds_read_b128 v[40:43],v17 offset:63488
v_mfma_f32_16x16x32_bf16 v[76:79],a[244:247],v[44:47],v[76:79]
s_waitcnt lgkmcnt(2)
v_mfma_f32_16x16x32_bf16 v[64:67],a[120:123],v[32:35],v[64:67]
ds_read_b128 v[44:47],v17 offset:64512
v_mfma_f32_16x16x32_bf16 v[72:75],a[248:251],v[32:35],v[72:75]
s_waitcnt lgkmcnt(2)
v_mfma_f32_16x16x32_bf16 v[68:71],a[120:123],v[36:39],v[68:71]
v_mfma_f32_16x16x32_bf16 v[76:79],a[248:251],v[36:39],v[76:79]
s_waitcnt lgkmcnt(1)
v_mfma_f32_16x16x32_bf16 v[64:67],a[124:127],v[40:43],v[64:67]
v_mfma_f32_16x16x32_bf16 v[72:75],a[252:255],v[40:43],v[72:75]
s_waitcnt lgkmcnt(0)
v_mfma_f32_16x16x32_bf16 v[68:71],a[124:127],v[44:47],v[68:71]
v_mfma_f32_16x16x32_bf16 v[76:79],a[252:255],v[44:47],v[76:79]
buffer_load_dword v29,v21,s[20:23],s74 offen sc1
v_xor_b32 v17,0x10000,v17
s_mov_b32 s72,s91
s_nop 0
v_mul_f32 v80,v64,v64
v_mul_f32 v81,v65,v65
v_mul_f32 v82,v66,v66
v_mul_f32 v83,v67,v67
v_mul_f32 v84,v72,v72
v_mul_f32 v85,v73,v73
v_mul_f32 v86,v74,v74
v_mul_f32 v87,v75,v75
v_mul_f32 v88,v68,v68
v_mul_f32 v89,v69,v69
v_mul_f32 v90,v70,v70
v_mul_f32 v91,v71,v71
v_mul_f32 v92,v76,v76
v_mul_f32 v93,v77,v77
v_mul_f32 v94,v78,v78
v_mul_f32 v95,v79,v79
v_fma_f32 v80,v80,s81,v28
v_fma_f32 v81,v81,s81,v28
v_fma_f32 v82,v82,s81,v28
v_fma_f32 v83,v83,s81,v28
v_fma_f32 v84,v84,s81,v28
v_fma_f32 v85,v85,s81,v28
v_fma_f32 v86,v86,s81,v28
v_fma_f32 v87,v87,s81,v28
v_fma_f32 v88,v88,s81,v28
v_fma_f32 v89,v89,s81,v28
v_fma_f32 v90,v90,s81,v28
v_fma_f32 v91,v91,s81,v28
v_fma_f32 v92,v92,s81,v28
v_fma_f32 v93,v93,s81,v28
v_fma_f32 v94,v94,s81,v28
v_fma_f32 v95,v95,s81,v28
v_mul_f32 v80,v80,v64
v_mul_f32 v81,v81,v65
v_mul_f32 v82,v82,v66
v_mul_f32 v83,v83,v67
v_mul_f32 v84,v84,v72
v_mul_f32 v85,v85,v73
v_mul_f32 v86,v86,v74
v_mul_f32 v87,v87,v75
v_mul_f32 v88,v88,v68
v_mul_f32 v89,v89,v69
v_mul_f32 v90,v90,v70
v_mul_f32 v91,v91,v71
v_mul_f32 v92,v92,v76
v_mul_f32 v93,v93,v77
v_mul_f32 v94,v94,v78
v_mul_f32 v95,v95,v79
v_exp_f32 v80,v80
v_exp_f32 v81,v81
v_exp_f32 v82,v82
v_exp_f32 v83,v83
v_exp_f32 v84,v84
v_exp_f32 v85,v85
v_exp_f32 v86,v86
v_exp_f32 v87,v87
v_exp_f32 v88,v88
v_exp_f32 v89,v89
v_exp_f32 v90,v90
v_exp_f32 v91,v91
v_exp_f32 v92,v92
v_exp_f32 v93,v93
v_exp_f32 v94,v94
v_exp_f32 v95,v95
v_add_f32 v80,1.0,v80
v_add_f32 v81,1.0,v81
v_add_f32 v82,1.0,v82
v_add_f32 v83,1.0,v83
v_add_f32 v84,1.0,v84
v_add_f32 v85,1.0,v85
v_add_f32 v86,1.0,v86
v_add_f32 v87,1.0,v87
v_add_f32 v88,1.0,v88
v_add_f32 v89,1.0,v89
v_add_f32 v90,1.0,v90
v_add_f32 v91,1.0,v91
v_add_f32 v92,1.0,v92
v_add_f32 v93,1.0,v93
v_add_f32 v94,1.0,v94
v_add_f32 v95,1.0,v95
v_rcp_f32 v80,v80
v_rcp_f32 v81,v81
v_rcp_f32 v82,v82
v_rcp_f32 v83,v83
v_rcp_f32 v84,v84
v_rcp_f32 v85,v85
v_rcp_f32 v86,v86
v_rcp_f32 v87,v87
v_rcp_f32 v88,v88
v_rcp_f32 v89,v89
v_rcp_f32 v90,v90
v_rcp_f32 v91,v91
v_rcp_f32 v92,v92
v_rcp_f32 v93,v93
v_rcp_f32 v94,v94
v_rcp_f32 v95,v95
v_mul_f32 v80,v80,v64
v_mul_f32 v81,v81,v65
v_mul_f32 v82,v82,v66
v_mul_f32 v83,v83,v67
v_mul_f32 v84,v84,v72
v_mul_f32 v85,v85,v73
v_mul_f32 v86,v86,v74
v_mul_f32 v87,v87,v75
v_mul_f32 v88,v88,v68
v_mul_f32 v89,v89,v69
v_mul_f32 v90,v90,v70
v_mul_f32 v91,v91,v71
v_mul_f32 v92,v92,v76
v_mul_f32 v93,v93,v77
v_mul_f32 v94,v94,v78
v_mul_f32 v95,v95,v79
v_cvt_pk_bf16_f32 v96,v80,v81
v_cvt_pk_bf16_f32 v97,v82,v83
v_cvt_pk_bf16_f32 v98,v84,v85
v_cvt_pk_bf16_f32 v99,v86,v87
buffer_store_dwordx4 v[96:99],v18,s[24:27],s78 offen
buffer_store_dwordx4 v[96:99],v18,s[28:31],s78 offen sc1
v_cvt_pk_bf16_f32 v100,v88,v89
v_cvt_pk_bf16_f32 v101,v90,v91
v_cvt_pk_bf16_f32 v102,v92,v93
v_cvt_pk_bf16_f32 v103,v94,v95
buffer_store_dwordx4 v[100:103],v19,s[24:27],s78 offen
buffer_store_dwordx4 v[100:103],v19,s[28:31],s78 offen sc1
s_waitcnt vmcnt(0)
s_mov_b64 exec,1
v_mov_b32 v22,s71
v_mov_b32 v23,0
buffer_store_dword v22,v23,s[24:27],s73 offen
buffer_store_dword v22,v23,s[28:31],s73 offen sc1
s_mov_b64 exec,-1
s_add_u32 s79,s79,1
s_add_u32 s71,s71,1
s_cmp_lt_u32 s79,64
s_cbranch_scc1 ml_186
s_endpgm
r_w2_181:
s_load_dwordx2 s[4:5],s[0:1],72
s_and_b32 s41,s59,7
s_lshl_b32 s66,s41,8
s_lshl_b32 s67,s50,1
s_waitcnt lgkmcnt(0)
s_mov_b32 s32,s4
s_and_b32 s33,s5,0xffff
s_mov_b32 s34,0x200000
s_mov_b32 s35,0x20000
v_lshrrev_b32 v5,2,v3
v_lshl_add_u32 v5,v4,2,v5
v_and_b32 v6,3,v3
v_lshlrev_b32 v6,3,v6
v_lshl_add_u32 v6,v5,8,v6
v_and_b32 v5,7,v5
v_xor_b32 v5,s67,v5
v_lshl_add_u32 v12,v5,5,v6
v_xor_b32 v13,32,v12
v_and_b32 v5,15,v1
v_and_b32 v6,3,v4
v_lshlrev_b32 v6,1,v6
v_xor_b32 v5,v5,v6
v_mul_u32_u24 v6,2048,v4
v_xor_b32 v7,0,v5
v_lshl_add_u32 v8,v7,4,v6
v_xor_b32 v7,8,v5
v_lshl_add_u32 v9,v7,4,v6
s_mul_i32 s74,s50,131072
s_add_u32 s74,s74,s66
s_lshl_b32 s75,s50,14
s_mul_i32 s76,s50,65536
s_add_u32 s76,s76,s66
s_lshl_b32 s77,s50,13
s_add_u32 s64,s74,0
s_add_u32 m0,s75,0
s_nop 0
buffer_load_dwordx4 v8,s[32:35],s64 offen  lds
s_add_u32 s64,s74,8192
s_add_u32 m0,s75,1024
s_nop 0
buffer_load_dwordx4 v9,s[32:35],s64 offen  lds
s_add_u32 s64,s74,16384
s_add_u32 m0,s75,2048
s_nop 0
buffer_load_dwordx4 v8,s[32:35],s64 offen  lds
s_add_u32 s64,s74,24576
s_add_u32 m0,s75,3072
s_nop 0
buffer_load_dwordx4 v9,s[32:35],s64 offen  lds
s_add_u32 s64,s74,32768
s_add_u32 m0,s75,4096
s_nop 0
buffer_load_dwordx4 v8,s[32:35],s64 offen  lds
s_add_u32 s64,s74,40960
s_add_u32 m0,s75,5120
s_nop 0
buffer_load_dwordx4 v9,s[32:35],s64 offen  lds
s_add_u32 s64,s74,49152
s_add_u32 m0,s75,6144
s_nop 0
buffer_load_dwordx4 v8,s[32:35],s64 offen  lds
s_add_u32 s64,s74,57344
s_add_u32 m0,s75,7168
s_nop 0
buffer_load_dwordx4 v9,s[32:35],s64 offen  lds
s_add_u32 s64,s74,65536
s_add_u32 m0,s75,8192
s_nop 0
buffer_load_dwordx4 v8,s[32:35],s64 offen  lds
s_add_u32 s64,s74,73728
s_add_u32 m0,s75,9216
s_nop 0
buffer_load_dwordx4 v9,s[32:35],s64 offen  lds
s_add_u32 s64,s74,81920
s_add_u32 m0,s75,10240
s_nop 0
buffer_load_dwordx4 v8,s[32:35],s64 offen  lds
s_add_u32 s64,s74,90112
s_add_u32 m0,s75,11264
s_nop 0
buffer_load_dwordx4 v9,s[32:35],s64 offen  lds
s_add_u32 s64,s74,98304
s_add_u32 m0,s75,12288
s_nop 0
buffer_load_dwordx4 v8,s[32:35],s64 offen  lds
s_add_u32 s64,s74,106496
s_add_u32 m0,s75,13312
s_nop 0
buffer_load_dwordx4 v9,s[32:35],s64 offen  lds
s_add_u32 s64,s74,114688
s_add_u32 m0,s75,14336
s_nop 0
buffer_load_dwordx4 v8,s[32:35],s64 offen  lds
s_add_u32 s64,s74,122880
s_add_u32 m0,s75,15360
s_nop 0
buffer_load_dwordx4 v9,s[32:35],s64 offen  lds
s_add_u32 s64,s74,524288
s_add_u32 m0,s75,65536
s_nop 0
buffer_load_dwordx4 v8,s[32:35],s64 offen  lds
s_add_u32 s64,s74,532480
s_add_u32 m0,s75,66560
s_nop 0
buffer_load_dwordx4 v9,s[32:35],s64 offen  lds
s_add_u32 s64,s74,540672
s_add_u32 m0,s75,67584
s_nop 0
buffer_load_dwordx4 v8,s[32:35],s64 offen  lds
s_add_u32 s64,s74,548864
s_add_u32 m0,s75,68608
s_nop 0
buffer_load_dwordx4 v9,s[32:35],s64 offen  lds
s_add_u32 s64,s74,557056
s_add_u32 m0,s75,69632
s_nop 0
buffer_load_dwordx4 v8,s[32:35],s64 offen  lds
s_add_u32 s64,s74,565248
s_add_u32 m0,s75,70656
s_nop 0
buffer_load_dwordx4 v9,s[32:35],s64 offen  lds
s_add_u32 s64,s74,573440
s_add_u32 m0,s75,71680
s_nop 0
buffer_load_dwordx4 v8,s[32:35],s64 offen  lds
s_add_u32 s64,s74,581632
s_add_u32 m0,s75,72704
s_nop 0
buffer_load_dwordx4 v9,s[32:35],s64 offen  lds
s_add_u32 s64,s74,589824
s_add_u32 m0,s75,73728
s_nop 0
buffer_load_dwordx4 v8,s[32:35],s64 offen  lds
s_add_u32 s64,s74,598016
s_add_u32 m0,s75,74752
s_nop 0
buffer_load_dwordx4 v9,s[32:35],s64 offen  lds
s_add_u32 s64,s74,606208
s_add_u32 m0,s75,75776
s_nop 0
buffer_load_dwordx4 v8,s[32:35],s64 offen  lds
s_add_u32 s64,s74,614400
s_add_u32 m0,s75,76800
s_nop 0
buffer_load_dwordx4 v9,s[32:35],s64 offen  lds
s_add_u32 s64,s74,622592
s_add_u32 m0,s75,77824
s_nop 0
buffer_load_dwordx4 v8,s[32:35],s64 offen  lds
s_add_u32 s64,s74,630784
s_add_u32 m0,s75,78848
s_nop 0
buffer_load_dwordx4 v9,s[32:35],s64 offen  lds
s_add_u32 s64,s74,638976
s_add_u32 m0,s75,79872
s_nop 0
buffer_load_dwordx4 v8,s[32:35],s64 offen  lds
s_add_u32 s64,s74,647168
s_add_u32 m0,s75,80896
s_nop 0
buffer_load_dwordx4 v9,s[32:35],s64 offen  lds
s_waitcnt vmcnt(16)
s_barrier
ds_read_b64_tr_b16 a[0:1],v12 offset:0
ds_read_b64_tr_b16 a[128:129],v13 offset:0
ds_read_b64_tr_b16 a[2:3],v12 offset:4096
ds_read_b64_tr_b16 a[130:131],v13 offset:4096
ds_read_b64_tr_b16 a[4:5],v12 offset:8192
ds_read_b64_tr_b16 a[132:133],v13 offset:8192
ds_read_b64_tr_b16 a[6:7],v12 offset:12288
ds_read_b64_tr_b16 a[134:135],v13 offset:12288
s_waitcnt lgkmcnt(4)
ds_read_b64_tr_b16 a[8:9],v12 offset:16384
ds_read_b64_tr_b16 a[136:137],v13 offset:16384
ds_read_b64_tr_b16 a[10:11],v12 offset:20480
ds_read_b64_tr_b16 a[138:139],v13 offset:20480
ds_read_b64_tr_b16 a[12:13],v12 offset:24576
ds_read_b64_tr_b16 a[140:141],v13 offset:24576
ds_read_b64_tr_b16 a[14:15],v12 offset:28672
ds_read_b64_tr_b16 a[142:143],v13 offset:28672
s_waitcnt lgkmcnt(4)
ds_read_b64_tr_b16 a[16:17],v12 offset:32768
ds_read_b64_tr_b16 a[144:145],v13 offset:32768
ds_read_b64_tr_b16 a[18:19],v12 offset:36864
ds_read_b64_tr_b16 a[146:147],v13 offset:36864
ds_read_b64_tr_b16 a[20:21],v12 offset:40960
ds_read_b64_tr_b16 a[148:149],v13 offset:40960
ds_read_b64_tr_b16 a[22:23],v12 offset:45056
ds_read_b64_tr_b16 a[150:151],v13 offset:45056
s_waitcnt lgkmcnt(4)
ds_read_b64_tr_b16 a[24:25],v12 offset:49152
ds_read_b64_tr_b16 a[152:153],v13 offset:49152
ds_read_b64_tr_b16 a[26:27],v12 offset:53248
ds_read_b64_tr_b16 a[154:155],v13 offset:53248
ds_read_b64_tr_b16 a[28:29],v12 offset:57344
ds_read_b64_tr_b16 a[156:157],v13 offset:57344
ds_read_b64_tr_b16 a[30:31],v12 offset:61440
ds_read_b64_tr_b16 a[158:159],v13 offset:61440
s_waitcnt lgkmcnt(4)
v_xor_b32 v12,0x10000,v12
v_xor_b32 v13,0x10000,v13
s_waitcnt lgkmcnt(0)
s_barrier
s_add_u32 s64,s74,1048576
s_add_u32 m0,s75,0
s_nop 0
buffer_load_dwordx4 v8,s[32:35],s64 offen  lds
s_add_u32 s64,s74,1056768
s_add_u32 m0,s75,1024
s_nop 0
buffer_load_dwordx4 v9,s[32:35],s64 offen  lds
s_add_u32 s64,s74,1064960
s_add_u32 m0,s75,2048
s_nop 0
buffer_load_dwordx4 v8,s[32:35],s64 offen  lds
s_add_u32 s64,s74,1073152
s_add_u32 m0,s75,3072
s_nop 0
buffer_load_dwordx4 v9,s[32:35],s64 offen  lds
s_add_u32 s64,s74,1081344
s_add_u32 m0,s75,4096
s_nop 0
buffer_load_dwordx4 v8,s[32:35],s64 offen  lds
s_add_u32 s64,s74,1089536
s_add_u32 m0,s75,5120
s_nop 0
buffer_load_dwordx4 v9,s[32:35],s64 offen  lds
s_add_u32 s64,s74,1097728
s_add_u32 m0,s75,6144
s_nop 0
buffer_load_dwordx4 v8,s[32:35],s64 offen  lds
s_add_u32 s64,s74,1105920
s_add_u32 m0,s75,7168
s_nop 0
buffer_load_dwordx4 v9,s[32:35],s64 offen  lds
s_add_u32 s64,s74,1114112
s_add_u32 m0,s75,8192
s_nop 0
buffer_load_dwordx4 v8,s[32:35],s64 offen  lds
s_add_u32 s64,s74,1122304
s_add_u32 m0,s75,9216
s_nop 0
buffer_load_dwordx4 v9,s[32:35],s64 offen  lds
s_add_u32 s64,s74,1130496
s_add_u32 m0,s75,10240
s_nop 0
buffer_load_dwordx4 v8,s[32:35],s64 offen  lds
s_add_u32 s64,s74,1138688
s_add_u32 m0,s75,11264
s_nop 0
buffer_load_dwordx4 v9,s[32:35],s64 offen  lds
s_add_u32 s64,s74,1146880
s_add_u32 m0,s75,12288
s_nop 0
buffer_load_dwordx4 v8,s[32:35],s64 offen  lds
s_add_u32 s64,s74,1155072
s_add_u32 m0,s75,13312
s_nop 0
buffer_load_dwordx4 v9,s[32:35],s64 offen  lds
s_add_u32 s64,s74,1163264
s_add_u32 m0,s75,14336
s_nop 0
buffer_load_dwordx4 v8,s[32:35],s64 offen  lds
s_add_u32 s64,s74,1171456
s_add_u32 m0,s75,15360
s_nop 0
buffer_load_dwordx4 v9,s[32:35],s64 offen  lds
s_waitcnt vmcnt(16)
s_barrier
ds_read_b64_tr_b16 a[32:33],v12 offset:0
ds_read_b64_tr_b16 a[160:161],v13 offset:0
ds_read_b64_tr_b16 a[34:35],v12 offset:4096
ds_read_b64_tr_b16 a[162:163],v13 offset:4096
ds_read_b64_tr_b16 a[36:37],v12 offset:8192
ds_read_b64_tr_b16 a[164:165],v13 offset:8192
ds_read_b64_tr_b16 a[38:39],v12 offset:12288
ds_read_b64_tr_b16 a[166:167],v13 offset:12288
s_waitcnt lgkmcnt(4)
ds_read_b64_tr_b16 a[40:41],v12 offset:16384
ds_read_b64_tr_b16 a[168:169],v13 offset:16384
ds_read_b64_tr_b16 a[42:43],v12 offset:20480
ds_read_b64_tr_b16 a[170:171],v13 offset:20480
ds_read_b64_tr_b16 a[44:45],v12 offset:24576
ds_read_b64_tr_b16 a[172:173],v13 offset:24576
ds_read_b64_tr_b16 a[46:47],v12 offset:28672
ds_read_b64_tr_b16 a[174:175],v13 offset:28672
s_waitcnt lgkmcnt(4)
ds_read_b64_tr_b16 a[48:49],v12 offset:32768
ds_read_b64_tr_b16 a[176:177],v13 offset:32768
ds_read_b64_tr_b16 a[50:51],v12 offset:36864
ds_read_b64_tr_b16 a[178:179],v13 offset:36864
ds_read_b64_tr_b16 a[52:53],v12 offset:40960
ds_read_b64_tr_b16 a[180:181],v13 offset:40960
ds_read_b64_tr_b16 a[54:55],v12 offset:45056
ds_read_b64_tr_b16 a[182:183],v13 offset:45056
s_waitcnt lgkmcnt(4)
ds_read_b64_tr_b16 a[56:57],v12 offset:49152
ds_read_b64_tr_b16 a[184:185],v13 offset:49152
ds_read_b64_tr_b16 a[58:59],v12 offset:53248
ds_read_b64_tr_b16 a[186:187],v13 offset:53248
ds_read_b64_tr_b16 a[60:61],v12 offset:57344
ds_read_b64_tr_b16 a[188:189],v13 offset:57344
ds_read_b64_tr_b16 a[62:63],v12 offset:61440
ds_read_b64_tr_b16 a[190:191],v13 offset:61440
s_waitcnt lgkmcnt(4)
v_xor_b32 v12,0x10000,v12
v_xor_b32 v13,0x10000,v13
s_waitcnt lgkmcnt(0)
s_barrier
s_add_u32 s64,s74,1572864
s_add_u32 m0,s75,65536
s_nop 0
buffer_load_dwordx4 v8,s[32:35],s64 offen  lds
s_add_u32 s64,s74,1581056
s_add_u32 m0,s75,66560
s_nop 0
buffer_load_dwordx4 v9,s[32:35],s64 offen  lds
s_add_u32 s64,s74,1589248
s_add_u32 m0,s75,67584
s_nop 0
buffer_load_dwordx4 v8,s[32:35],s64 offen  lds
s_add_u32 s64,s74,1597440
s_add_u32 m0,s75,68608
s_nop 0
buffer_load_dwordx4 v9,s[32:35],s64 offen  lds
s_add_u32 s64,s74,1605632
s_add_u32 m0,s75,69632
s_nop 0
buffer_load_dwordx4 v8,s[32:35],s64 offen  lds
s_add_u32 s64,s74,1613824
s_add_u32 m0,s75,70656
s_nop 0
buffer_load_dwordx4 v9,s[32:35],s64 offen  lds
s_add_u32 s64,s74,1622016
s_add_u32 m0,s75,71680
s_nop 0
buffer_load_dwordx4 v8,s[32:35],s64 offen  lds
s_add_u32 s64,s74,1630208
s_add_u32 m0,s75,72704
s_nop 0
buffer_load_dwordx4 v9,s[32:35],s64 offen  lds
s_add_u32 s64,s74,1638400
s_add_u32 m0,s75,73728
s_nop 0
buffer_load_dwordx4 v8,s[32:35],s64 offen  lds
s_add_u32 s64,s74,1646592
s_add_u32 m0,s75,74752
s_nop 0
buffer_load_dwordx4 v9,s[32:35],s64 offen  lds
s_add_u32 s64,s74,1654784
s_add_u32 m0,s75,75776
s_nop 0
buffer_load_dwordx4 v8,s[32:35],s64 offen  lds
s_add_u32 s64,s74,1662976
s_add_u32 m0,s75,76800
s_nop 0
buffer_load_dwordx4 v9,s[32:35],s64 offen  lds
s_add_u32 s64,s74,1671168
s_add_u32 m0,s75,77824
s_nop 0
buffer_load_dwordx4 v8,s[32:35],s64 offen  lds
s_add_u32 s64,s74,1679360
s_add_u32 m0,s75,78848
s_nop 0
buffer_load_dwordx4 v9,s[32:35],s64 offen  lds
s_add_u32 s64,s74,1687552
s_add_u32 m0,s75,79872
s_nop 0
buffer_load_dwordx4 v8,s[32:35],s64 offen  lds
s_add_u32 s64,s74,1695744
s_add_u32 m0,s75,80896
s_nop 0
buffer_load_dwordx4 v9,s[32:35],s64 offen  lds
s_waitcnt vmcnt(16)
s_barrier
ds_read_b64_tr_b16 a[64:65],v12 offset:0
ds_read_b64_tr_b16 a[192:193],v13 offset:0
ds_read_b64_tr_b16 a[66:67],v12 offset:4096
ds_read_b64_tr_b16 a[194:195],v13 offset:4096
ds_read_b64_tr_b16 a[68:69],v12 offset:8192
ds_read_b64_tr_b16 a[196:197],v13 offset:8192
ds_read_b64_tr_b16 a[70:71],v12 offset:12288
ds_read_b64_tr_b16 a[198:199],v13 offset:12288
s_waitcnt lgkmcnt(4)
ds_read_b64_tr_b16 a[72:73],v12 offset:16384
ds_read_b64_tr_b16 a[200:201],v13 offset:16384
ds_read_b64_tr_b16 a[74:75],v12 offset:20480
ds_read_b64_tr_b16 a[202:203],v13 offset:20480
ds_read_b64_tr_b16 a[76:77],v12 offset:24576
ds_read_b64_tr_b16 a[204:205],v13 offset:24576
ds_read_b64_tr_b16 a[78:79],v12 offset:28672
ds_read_b64_tr_b16 a[206:207],v13 offset:28672
s_waitcnt lgkmcnt(4)
ds_read_b64_tr_b16 a[80:81],v12 offset:32768
ds_read_b64_tr_b16 a[208:209],v13 offset:32768
ds_read_b64_tr_b16 a[82:83],v12 offset:36864
ds_read_b64_tr_b16 a[210:211],v13 offset:36864
ds_read_b64_tr_b16 a[84:85],v12 offset:40960
ds_read_b64_tr_b16 a[212:213],v13 offset:40960
ds_read_b64_tr_b16 a[86:87],v12 offset:45056
ds_read_b64_tr_b16 a[214:215],v13 offset:45056
s_waitcnt lgkmcnt(4)
ds_read_b64_tr_b16 a[88:89],v12 offset:49152
ds_read_b64_tr_b16 a[216:217],v13 offset:49152
ds_read_b64_tr_b16 a[90:91],v12 offset:53248
ds_read_b64_tr_b16 a[218:219],v13 offset:53248
ds_read_b64_tr_b16 a[92:93],v12 offset:57344
ds_read_b64_tr_b16 a[220:221],v13 offset:57344
ds_read_b64_tr_b16 a[94:95],v12 offset:61440
ds_read_b64_tr_b16 a[222:223],v13 offset:61440
s_waitcnt lgkmcnt(4)
v_xor_b32 v12,0x10000,v12
v_xor_b32 v13,0x10000,v13
s_waitcnt lgkmcnt(0)
s_barrier
s_waitcnt vmcnt(0)
s_barrier
ds_read_b64_tr_b16 a[96:97],v12 offset:0
ds_read_b64_tr_b16 a[224:225],v13 offset:0
ds_read_b64_tr_b16 a[98:99],v12 offset:4096
ds_read_b64_tr_b16 a[226:227],v13 offset:4096
ds_read_b64_tr_b16 a[100:101],v12 offset:8192
ds_read_b64_tr_b16 a[228:229],v13 offset:8192
ds_read_b64_tr_b16 a[102:103],v12 offset:12288
ds_read_b64_tr_b16 a[230:231],v13 offset:12288
s_waitcnt lgkmcnt(4)
ds_read_b64_tr_b16 a[104:105],v12 offset:16384
ds_read_b64_tr_b16 a[232:233],v13 offset:16384
ds_read_b64_tr_b16 a[106:107],v12 offset:20480
ds_read_b64_tr_b16 a[234:235],v13 offset:20480
ds_read_b64_tr_b16 a[108:109],v12 offset:24576
ds_read_b64_tr_b16 a[236:237],v13 offset:24576
ds_read_b64_tr_b16 a[110:111],v12 offset:28672
ds_read_b64_tr_b16 a[238:239],v13 offset:28672
s_waitcnt lgkmcnt(4)
ds_read_b64_tr_b16 a[112:113],v12 offset:32768
ds_read_b64_tr_b16 a[240:241],v13 offset:32768
ds_read_b64_tr_b16 a[114:115],v12 offset:36864
ds_read_b64_tr_b16 a[242:243],v13 offset:36864
ds_read_b64_tr_b16 a[116:117],v12 offset:40960
ds_read_b64_tr_b16 a[244:245],v13 offset:40960
ds_read_b64_tr_b16 a[118:119],v12 offset:45056
ds_read_b64_tr_b16 a[246:247],v13 offset:45056
s_waitcnt lgkmcnt(4)
ds_read_b64_tr_b16 a[120:121],v12 offset:49152
ds_read_b64_tr_b16 a[248:249],v13 offset:49152
ds_read_b64_tr_b16 a[122:123],v12 offset:53248
ds_read_b64_tr_b16 a[250:251],v13 offset:53248
ds_read_b64_tr_b16 a[124:125],v12 offset:57344
ds_read_b64_tr_b16 a[252:253],v13 offset:57344
ds_read_b64_tr_b16 a[126:127],v12 offset:61440
ds_read_b64_tr_b16 a[254:255],v13 offset:61440
s_waitcnt lgkmcnt(4)
v_xor_b32 v12,0x10000,v12
v_xor_b32 v13,0x10000,v13
s_waitcnt lgkmcnt(0)
s_barrier
v_and_b32 v21,1,v1
v_mul_u32_u24 v21,896,v21
s_mov_b32 s65,21052032
s_mov_b32 s66,1792
pl_193:
buffer_load_dword v22,v21,s[20:23],s65 offen sc1
s_waitcnt vmcnt(0)
v_cmp_gt_u32 vcc,s66,v22
s_cbranch_vccz pok_194
s_sleep 1
s_sub_u32 s90,s90,1
s_cmp_gt_i32 s90,0
s_cbranch_scc1 pl_193
pok_194:
s_mov_b32 s81,0xbdd2d3e8
v_mov_b32 v28,0xc0135761
v_mov_b32 v17,v16
v_and_b32 v21,31,v1
v_lshlrev_b32 v21,2,v21
s_add_u32 s74,s63,3072
s_lshl_b32 s42,s41,2
s_add_u32 s42,s42,s50
s_lshl_b32 s73,s42,2
s_add_u32 s73,s73,s63
s_add_u32 s73,s73,3584
s_lshl_b32 s72,s50,12
s_add_u32 s75,s72,12771328
s_add_u32 s64,s41,72
s_lshl_b32 s64,s64,14
s_lshl_b32 s65,s50,11
s_add_u32 s64,s64,s65
v_add_u32 v18,s64,v16
s_lshl_b32 s64,s42,8
s_add_u32 s64,s64,1310720
v_lshl_add_u32 v24,v3,4,s64
s_lshl_b32 s64,s42,6
v_lshlrev_b32 v6,11,v3
v_lshl_add_u32 v6,v4,3,v6
v_add_u32 v20,s64,v6
ml_195:
s_lshl_b32 s78,s79,16
s_add_u32 s67,s78,s75
s_add_u32 s89,s67,65536
s_xor_b32 s91,s72,0x10000
s_add_u32 s64,s79,0
s_lshl_b32 s70,s64,21
s_lshl_b32 s64,s64,13
s_and_b32 s64,s64,0x2000
s_xor_b32 s64,s64,s62
s_add_u32 s70,s70,s64
s_add_u32 s70,s70,29360128
s_min_u32 s66,s71,64
s_waitcnt vmcnt(7)
s_cmp_lg_u32 s83,0
s_cbranch_scc1 pre_196
v_cmp_gt_u32 vcc,s66,v29
s_cbranch_vccz nopoll_197
pl_198:
buffer_load_dword v22,v21,s[20:23],s74 offen sc1
s_waitcnt vmcnt(0)
v_cmp_gt_u32 vcc,s66,v22
s_cbranch_vccz pok_199
s_sleep 1
s_sub_u32 s90,s90,1
s_cmp_gt_i32 s90,0
s_cbranch_scc1 pl_198
pok_199:
v_mov_b32 v29,v22
nopoll_197:
s_add_u32 m0,s72,0
s_add_u32 s65,s67,0
buffer_load_dwordx4 v16,s[20:23],s65 offen offset:0 sc1 lds
buffer_load_dwordx4 v16,s[20:23],s65 offen offset:1024 sc1 lds
buffer_load_dwordx4 v16,s[20:23],s65 offen offset:2048 sc1 lds
buffer_load_dwordx4 v16,s[20:23],s65 offen offset:3072 sc1 lds
s_add_u32 m0,s72,16384
s_add_u32 s65,s67,16384
buffer_load_dwordx4 v16,s[20:23],s65 offen offset:0 sc1 lds
buffer_load_dwordx4 v16,s[20:23],s65 offen offset:1024 sc1 lds
buffer_load_dwordx4 v16,s[20:23],s65 offen offset:2048 sc1 lds
buffer_load_dwordx4 v16,s[20:23],s65 offen offset:3072 sc1 lds
s_add_u32 m0,s72,32768
s_add_u32 s65,s67,32768
buffer_load_dwordx4 v16,s[20:23],s65 offen offset:0 sc1 lds
buffer_load_dwordx4 v16,s[20:23],s65 offen offset:1024 sc1 lds
buffer_load_dwordx4 v16,s[20:23],s65 offen offset:2048 sc1 lds
buffer_load_dwordx4 v16,s[20:23],s65 offen offset:3072 sc1 lds
s_add_u32 m0,s72,49152
s_add_u32 s65,s67,49152
buffer_load_dwordx4 v16,s[20:23],s65 offen offset:0 sc1 lds
buffer_load_dwordx4 v16,s[20:23],s65 offen offset:1024 sc1 lds
buffer_load_dwordx4 v16,s[20:23],s65 offen offset:2048 sc1 lds
buffer_load_dwordx4 v16,s[20:23],s65 offen offset:3072 sc1 lds
pre_196:
s_add_u32 s64,s71,1
s_min_u32 s64,s64,64
v_cmp_gt_u32 vcc,s64,v29
s_cmp_eq_u64 vcc,0
s_cselect_b32 s83,1,0
s_cselect_b32 s89,s89,0x7fff0000
s_waitcnt vmcnt(12)
s_barrier
ds_read_b128 v[32:35],v17 offset:0
ds_read_b128 v[36:39],v17 offset:1024
ds_read_b128 v[40:43],v17 offset:2048
s_waitcnt lgkmcnt(2)
v_mfma_f32_16x16x32_bf16 v[64:67],a[0:3],v[32:35],0
ds_read_b128 v[44:47],v17 offset:3072
v_mfma_f32_16x16x32_bf16 v[72:75],a[128:131],v[32:35],0
s_waitcnt lgkmcnt(2)
v_mfma_f32_16x16x32_bf16 v[68:71],a[0:3],v[36:39],0
ds_read_b128 v[32:35],v17 offset:4096
s_add_u32 m0,s91,0
s_add_u32 s65,s89,0
v_mfma_f32_16x16x32_bf16 v[76:79],a[128:131],v[36:39],0
s_waitcnt lgkmcnt(2)
v_mfma_f32_16x16x32_bf16 v[64:67],a[4:7],v[40:43],v[64:67]
ds_read_b128 v[36:39],v17 offset:5120
v_mfma_f32_16x16x32_bf16 v[72:75],a[132:135],v[40:43],v[72:75]
s_waitcnt lgkmcnt(2)
v_mfma_f32_16x16x32_bf16 v[68:71],a[4:7],v[44:47],v[68:71]
ds_read_b128 v[40:43],v17 offset:6144
buffer_load_dwordx4 v16,s[20:23],s65 offen offset:0 sc1 lds
v_mfma_f32_16x16x32_bf16 v[76:79],a[132:135],v[44:47],v[76:79]
s_waitcnt lgkmcnt(2)
v_mfma_f32_16x16x32_bf16 v[64:67],a[8:11],v[32:35],v[64:67]
ds_read_b128 v[44:47],v17 offset:7168
v_mfma_f32_16x16x32_bf16 v[72:75],a[136:139],v[32:35],v[72:75]
s_waitcnt lgkmcnt(2)
v_mfma_f32_16x16x32_bf16 v[68:71],a[8:11],v[36:39],v[68:71]
ds_read_b128 v[32:35],v17 offset:8192
v_mfma_f32_16x16x32_bf16 v[76:79],a[136:139],v[36:39],v[76:79]
buffer_load_dwordx4 v16,s[20:23],s65 offen offset:1024 sc1 lds
s_waitcnt lgkmcnt(2)
v_mfma_f32_16x16x32_bf16 v[64:67],a[12:15],v[40:43],v[64:67]
ds_read_b128 v[36:39],v17 offset:9216
v_mfma_f32_16x16x32_bf16 v[72:75],a[140:143],v[40:43],v[72:75]
s_waitcnt lgkmcnt(2)
v_mfma_f32_16x16x32_bf16 v[68:71],a[12:15],v[44:47],v[68:71]
ds_read_b128 v[40:43],v17 offset:10240
v_mfma_f32_16x16x32_bf16 v[76:79],a[140:143],v[44:47],v[76:79]
s_waitcnt lgkmcnt(2)
v_mfma_f32_16x16x32_bf16 v[64:67],a[16:19],v[32:35],v[64:67]
ds_read_b128 v[44:47],v17 offset:11264
buffer_load_dwordx4 v16,s[20:23],s65 offen offset:2048 sc1 lds
v_mfma_f32_16x16x32_bf16 v[72:75],a[144:147],v[32:35],v[72:75]
s_waitcnt lgkmcnt(2)
v_mfma_f32_16x16x32_bf16 v[68:71],a[16:19],v[36:39],v[68:71]
ds_read_b128 v[32:35],v17 offset:12288
v_mfma_f32_16x16x32_bf16 v[76:79],a[144:147],v[36:39],v[76:79]
s_waitcnt lgkmcnt(2)
v_mfma_f32_16x16x32_bf16 v[64:67],a[20:23],v[40:43],v[64:67]
ds_read_b128 v[36:39],v17 offset:13312
buffer_load_dwordx4 v16,s[20:23],s65 offen offset:3072 sc1 lds
v_mfma_f32_16x16x32_bf16 v[72:75],a[148:151],v[40:43],v[72:75]
s_waitcnt lgkmcnt(2)
v_mfma_f32_16x16x32_bf16 v[68:71],a[20:23],v[44:47],v[68:71]
ds_read_b128 v[40:43],v17 offset:14336
v_mfma_f32_16x16x32_bf16 v[76:79],a[148:151],v[44:47],v[76:79]
s_waitcnt lgkmcnt(2)
v_mfma_f32_16x16x32_bf16 v[64:67],a[24:27],v[32:35],v[64:67]
ds_read_b128 v[44:47],v17 offset:15360
v_mfma_f32_16x16x32_bf16 v[72:75],a[152:155],v[32:35],v[72:75]
s_add_u32 m0,s91,16384
s_add_u32 s65,s89,16384
s_waitcnt lgkmcnt(2)
v_mfma_f32_16x16x32_bf16 v[68:71],a[24:27],v[36:39],v[68:71]
s_waitcnt vmcnt(12)
s_barrier
ds_read_b128 v[32:35],v17 offset:16384
v_mfma_f32_16x16x32_bf16 v[76:79],a[152:155],v[36:39],v[76:79]
s_waitcnt lgkmcnt(2)
v_mfma_f32_16x16x32_bf16 v[64:67],a[28:31],v[40:43],v[64:67]
ds_read_b128 v[36:39],v17 offset:17408
v_mfma_f32_16x16x32_bf16 v[72:75],a[156:159],v[40:43],v[72:75]
s_waitcnt lgkmcnt(2)
v_mfma_f32_16x16x32_bf16 v[68:71],a[28:31],v[44:47],v[68:71]
ds_read_b128 v[40:43],v17 offset:18432
buffer_load_dwordx4 v16,s[20:23],s65 offen offset:0 sc1 lds
v_mfma_f32_16x16x32_bf16 v[76:79],a[156:159],v[44:47],v[76:79]
s_waitcnt lgkmcnt(2)
v_mfma_f32_16x16x32_bf16 v[64:67],a[32:35],v[32:35],v[64:67]
ds_read_b128 v[44:47],v17 offset:19456
v_mfma_f32_16x16x32_bf16 v[72:75],a[160:163],v[32:35],v[72:75]
s_waitcnt lgkmcnt(2)
v_mfma_f32_16x16x32_bf16 v[68:71],a[32:35],v[36:39],v[68:71]
ds_read_b128 v[32:35],v17 offset:20480
buffer_load_dwordx4 v16,s[20:23],s65 offen offset:1024 sc1 lds
v_mfma_f32_16x16x32_bf16 v[76:79],a[160:163],v[36:39],v[76:79]
s_waitcnt lgkmcnt(2)
v_mfma_f32_16x16x32_bf16 v[64:67],a[36:39],v[40:43],v[64:67]
ds_read_b128 v[36:39],v17 offset:21504
v_mfma_f32_16x16x32_bf16 v[72:75],a[164:167],v[40:43],v[72:75]
s_waitcnt lgkmcnt(2)
v_mfma_f32_16x16x32_bf16 v[68:71],a[36:39],v[44:47],v[68:71]
ds_read_b128 v[40:43],v17 offset:22528
v_mfma_f32_16x16x32_bf16 v[76:79],a[164:167],v[44:47],v[76:79]
buffer_load_dwordx4 v16,s[20:23],s65 offen offset:2048 sc1 lds
s_waitcnt lgkmcnt(2)
v_mfma_f32_16x16x32_bf16 v[64:67],a[40:43],v[32:35],v[64:67]
ds_read_b128 v[44:47],v17 offset:23552
v_mfma_f32_16x16x32_bf16 v[72:75],a[168:171],v[32:35],v[72:75]
s_waitcnt lgkmcnt(2)
v_mfma_f32_16x16x32_bf16 v[68:71],a[40:43],v[36:39],v[68:71]
ds_read_b128 v[32:35],v17 offset:24576
v_mfma_f32_16x16x32_bf16 v[76:79],a[168:171],v[36:39],v[76:79]
s_waitcnt lgkmcnt(2)
v_mfma_f32_16x16x32_bf16 v[64:67],a[44:47],v[40:43],v[64:67]
ds_read_b128 v[36:39],v17 offset:25600
buffer_load_dwordx4 v16,s[20:23],s65 offen offset:3072 sc1 lds
v_mfma_f32_16x16x32_bf16 v[72:75],a[172:175],v[40:43],v[72:75]
s_waitcnt lgkmcnt(2)
v_mfma_f32_16x16x32_bf16 v[68:71],a[44:47],v[44:47],v[68:71]
ds_read_b128 v[40:43],v17 offset:26624
v_mfma_f32_16x16x32_bf16 v[76:79],a[172:175],v[44:47],v[76:79]
s_waitcnt lgkmcnt(2)
v_mfma_f32_16x16x32_bf16 v[64:67],a[48:51],v[32:35],v[64:67]
ds_read_b128 v[44:47],v17 offset:27648
v_mfma_f32_16x16x32_bf16 v[72:75],a[176:179],v[32:35],v[72:75]
s_add_u32 m0,s91,32768
s_add_u32 s65,s89,32768
s_waitcnt lgkmcnt(2)
v_mfma_f32_16x16x32_bf16 v[68:71],a[48:51],v[36:39],v[68:71]
ds_read_b128 v[32:35],v17 offset:28672
v_mfma_f32_16x16x32_bf16 v[76:79],a[176:179],v[36:39],v[76:79]
s_waitcnt lgkmcnt(2)
v_mfma_f32_16x16x32_bf16 v[64:67],a[52:55],v[40:43],v[64:67]
ds_read_b128 v[36:39],v17 offset:29696
v_mfma_f32_16x16x32_bf16 v[72:75],a[180:183],v[40:43],v[72:75]
buffer_load_dwordx4 v16,s[20:23],s65 offen offset:0 sc1 lds
s_waitcnt lgkmcnt(2)
v_mfma_f32_16x16x32_bf16 v[68:71],a[52:55],v[44:47],v[68:71]
ds_read_b128 v[40:43],v17 offset:30720
v_mfma_f32_16x16x32_bf16 v[76:79],a[180:183],v[44:47],v[76:79]
s_waitcnt lgkmcnt(2)
v_mfma_f32_16x16x32_bf16 v[64:67],a[56:59],v[32:35],v[64:67]
ds_read_b128 v[44:47],v17 offset:31744
v_mfma_f32_16x16x32_bf16 v[72:75],a[184:187],v[32:35],v[72:75]
s_waitcnt lgkmcnt(2)
v_mfma_f32_16x16x32_bf16 v[68:71],a[56:59],v[36:39],v[68:71]
s_waitcnt vmcnt(13)
s_barrier
ds_read_b128 v[32:35],v17 offset:32768
buffer_load_dwordx4 v16,s[20:23],s65 offen offset:1024 sc1 lds
v_mfma_f32_16x16x32_bf16 v[76:79],a[184:187],v[36:39],v[76:79]
s_waitcnt lgkmcnt(2)
v_mfma_f32_16x16x32_bf16 v[64:67],a[60:63],v[40:43],v[64:67]
ds_read_b128 v[36:39],v17 offset:33792
v_mfma_f32_16x16x32_bf16 v[72:75],a[188:191],v[40:43],v[72:75]
s_waitcnt lgkmcnt(2)
v_mfma_f32_16x16x32_bf16 v[68:71],a[60:63],v[44:47],v[68:71]
ds_read_b128 v[40:43],v17 offset:34816
v_mfma_f32_16x16x32_bf16 v[76:79],a[188:191],v[44:47],v[76:79]
buffer_load_dwordx4 v16,s[20:23],s65 offen offset:2048 sc1 lds
s_waitcnt lgkmcnt(2)
v_mfma_f32_16x16x32_bf16 v[64:67],a[64:67],v[32:35],v[64:67]
ds_read_b128 v[44:47],v17 offset:35840
v_mfma_f32_16x16x32_bf16 v[72:75],a[192:195],v[32:35],v[72:75]
s_waitcnt lgkmcnt(2)
v_mfma_f32_16x16x32_bf16 v[68:71],a[64:67],v[36:39],v[68:71]
ds_read_b128 v[32:35],v17 offset:36864
v_mfma_f32_16x16x32_bf16 v[76:79],a[192:195],v[36:39],v[76:79]
buffer_load_dwordx4 v16,s[20:23],s65 offen offset:3072 sc1 lds
s_waitcnt lgkmcnt(2)
v_mfma_f32_16x16x32_bf16 v[64:67],a[68:71],v[40:43],v[64:67]
ds_read_b128 v[36:39],v17 offset:37888
v_mfma_f32_16x16x32_bf16 v[72:75],a[196:199],v[40:43],v[72:75]
s_waitcnt lgkmcnt(2)
v_mfma_f32_16x16x32_bf16 v[68:71],a[68:71],v[44:47],v[68:71]
ds_read_b128 v[40:43],v17 offset:38912
v_mfma_f32_16x16x32_bf16 v[76:79],a[196:199],v[44:47],v[76:79]
s_waitcnt lgkmcnt(2)
v_mfma_f32_16x16x32_bf16 v[64:67],a[72:75],v[32:35],v[64:67]
ds_read_b128 v[44:47],v17 offset:39936
s_add_u32 m0,s91,49152
s_add_u32 s65,s89,49152
v_mfma_f32_16x16x32_bf16 v[72:75],a[200:203],v[32:35],v[72:75]
s_waitcnt lgkmcnt(2)
v_mfma_f32_16x16x32_bf16 v[68:71],a[72:75],v[36:39],v[68:71]
ds_read_b128 v[32:35],v17 offset:40960
v_mfma_f32_16x16x32_bf16 v[76:79],a[200:203],v[36:39],v[76:79]
s_waitcnt lgkmcnt(2)
v_mfma_f32_16x16x32_bf16 v[64:67],a[76:79],v[40:43],v[64:67]
ds_read_b128 v[36:39],v17 offset:41984
v_mfma_f32_16x16x32_bf16 v[72:75],a[204:207],v[40:43],v[72:75]
buffer_load_dwordx4 v16,s[20:23],s65 offen offset:0 sc1 lds
s_waitcnt lgkmcnt(2)
v_mfma_f32_16x16x32_bf16 v[68:71],a[76:79],v[44:47],v[68:71]
ds_read_b128 v[40:43],v17 offset:43008
v_mfma_f32_16x16x32_bf16 v[76:79],a[204:207],v[44:47],v[76:79]
s_waitcnt lgkmcnt(2)
v_mfma_f32_16x16x32_bf16 v[64:67],a[80:83],v[32:35],v[64:67]
ds_read_b128 v[44:47],v17 offset:44032
v_mfma_f32_16x16x32_bf16 v[72:75],a[208:211],v[32:35],v[72:75]
buffer_load_dwordx4 v16,s[20:23],s65 offen offset:1024 sc1 lds
s_waitcnt lgkmcnt(2)
v_mfma_f32_16x16x32_bf16 v[68:71],a[80:83],v[36:39],v[68:71]
ds_read_b128 v[32:35],v17 offset:45056
v_mfma_f32_16x16x32_bf16 v[76:79],a[208:211],v[36:39],v[76:79]
s_waitcnt lgkmcnt(2)
v_mfma_f32_16x16x32_bf16 v[64:67],a[84:87],v[40:43],v[64:67]
ds_read_b128 v[36:39],v17 offset:46080
v_mfma_f32_16x16x32_bf16 v[72:75],a[212:215],v[40:43],v[72:75]
s_waitcnt lgkmcnt(2)
v_mfma_f32_16x16x32_bf16 v[68:71],a[84:87],v[44:47],v[68:71]
ds_read_b128 v[40:43],v17 offset:47104
buffer_load_dwordx4 v16,s[20:23],s65 offen offset:2048 sc1 lds
v_mfma_f32_16x16x32_bf16 v[76:79],a[212:215],v[44:47],v[76:79]
s_waitcnt lgkmcnt(2)
v_mfma_f32_16x16x32_bf16 v[64:67],a[88:91],v[32:35],v[64:67]
ds_read_b128 v[44:47],v17 offset:48128
v_mfma_f32_16x16x32_bf16 v[72:75],a[216:219],v[32:35],v[72:75]
s_waitcnt lgkmcnt(2)
v_mfma_f32_16x16x32_bf16 v[68:71],a[88:91],v[36:39],v[68:71]
s_waitcnt vmcnt(15)
s_barrier
ds_read_b128 v[32:35],v17 offset:49152
v_mfma_f32_16x16x32_bf16 v[76:79],a[216:219],v[36:39],v[76:79]
buffer_load_dwordx4 v16,s[20:23],s65 offen offset:3072 sc1 lds
s_waitcnt lgkmcnt(2)
v_mfma_f32_16x16x32_bf16 v[64:67],a[92:95],v[40:43],v[64:67]
ds_read_b128 v[36:39],v17 offset:50176
v_mfma_f32_16x16x32_bf16 v[72:75],a[220:223],v[40:43],v[72:75]
s_waitcnt lgkmcnt(2)
v_mfma_f32_16x16x32_bf16 v[68:71],a[92:95],v[44:47],v[68:71]
ds_read_b128 v[40:43],v17 offset:51200
v_mfma_f32_16x16x32_bf16 v[76:79],a[220:223],v[44:47],v[76:79]
s_waitcnt lgkmcnt(2)
v_mfma_f32_16x16x32_bf16 v[64:67],a[96:99],v[32:35],v[64:67]
ds_read_b128 v[44:47],v17 offset:52224
v_mfma_f32_16x16x32_bf16 v[72:75],a[224:227],v[32:35],v[72:75]
s_waitcnt lgkmcnt(2)
v_mfma_f32_16x16x32_bf16 v[68:71],a[96:99],v[36:39],v[68:71]
ds_read_b128 v[32:35],v17 offset:53248
v_mfma_f32_16x16x32_bf16 v[76:79],a[224:227],v[36:39],v[76:79]
s_waitcnt lgkmcnt(2)
v_mfma_f32_16x16x32_bf16 v[64:67],a[100:103],v[40:43],v[64:67]
ds_read_b128 v[36:39],v17 offset:54272
s_add_u32 s66,s78,4247552
buffer_load_dwordx2 v[120:121],v20,s[20:23],s66 offen offset:0 sc1
buffer_load_dwordx2 v[122:123],v20,s[20:23],s66 offen offset:32 sc1
s_add_u32 s66,s78,4280320
buffer_load_dwordx2 v[124:125],v20,s[20:23],s66 offen offset:0 sc1
buffer_load_dwordx2 v[126:127],v20,s[20:23],s66 offen offset:32 sc1
v_mfma_f32_16x16x32_bf16 v[72:75],a[228:231],v[40:43],v[72:75]
s_waitcnt lgkmcnt(2)
v_mfma_f32_16x16x32_bf16 v[68:71],a[100:103],v[44:47],v[68:71]
ds_read_b128 v[40:43],v17 offset:55296
v_mfma_f32_16x16x32_bf16 v[76:79],a[228:231],v[44:47],v[76:79]
s_waitcnt lgkmcnt(2)
v_mfma_f32_16x16x32_bf16 v[64:67],a[104:107],v[32:35],v[64:67]
ds_read_b128 v[44:47],v17 offset:56320
v_mfma_f32_16x16x32_bf16 v[72:75],a[232:235],v[32:35],v[72:75]
s_waitcnt lgkmcnt(2)
v_mfma_f32_16x16x32_bf16 v[68:71],a[104:107],v[36:39],v[68:71]
ds_read_b128 v[32:35],v17 offset:57344
v_mfma_f32_16x16x32_bf16 v[76:79],a[232:235],v[36:39],v[76:79]
s_waitcnt lgkmcnt(2)
v_mfma_f32_16x16x32_bf16 v[64:67],a[108:111],v[40:43],v[64:67]
ds_read_b128 v[36:39],v17 offset:58368
v_mfma_f32_16x16x32_bf16 v[72:75],a[236:239],v[40:43],v[72:75]
s_waitcnt lgkmcnt(2)
v_mfma_f32_16x16x32_bf16 v[68:71],a[108:111],v[44:47],v[68:71]
ds_read_b128 v[40:43],v17 offset:59392
v_mfma_f32_16x16x32_bf16 v[76:79],a[236:239],v[44:47],v[76:79]
s_waitcnt lgkmcnt(2)
v_mfma_f32_16x16x32_bf16 v[64:67],a[112:115],v[32:35],v[64:67]
ds_read_b128 v[44:47],v17 offset:60416
v_mfma_f32_16x16x32_bf16 v[72:75],a[240:243],v[32:35],v[72:75]
s_waitcnt lgkmcnt(2)
v_mfma_f32_16x16x32_bf16 v[68:71],a[112:115],v[36:39],v[68:71]
ds_read_b128 v[32:35],v17 offset:61440
v_mfma_f32_16x16x32_bf16 v[76:79],a[240:243],v[36:39],v[76:79]
s_waitcnt lgkmcnt(2)
v_mfma_f32_16x16x32_bf16 v[64:67],a[116:119],v[40:43],v[64:67]
ds_read_b128 v[36:39],v17 offset:62464
v_mfma_f32_16x16x32_bf16 v[72:75],a[244:247],v[40:43],v[72:75]
s_waitcnt lgkmcnt(2)
v_mfma_f32_16x16x32_bf16 v[68:71],a[116:119],v[44:47],v[68:71]
ds_read_b128 v[40:43],v17 offset:63488
v_mfma_f32_16x16x32_bf16 v[76:79],a[244:247],v[44:47],v[76:79]
s_waitcnt lgkmcnt(2)
v_mfma_f32_16x16x32_bf16 v[64:67],a[120:123],v[32:35],v[64:67]
ds_read_b128 v[44:47],v17 offset:64512
v_mfma_f32_16x16x32_bf16 v[72:75],a[248:251],v[32:35],v[72:75]
s_waitcnt lgkmcnt(2)
v_mfma_f32_16x16x32_bf16 v[68:71],a[120:123],v[36:39],v[68:71]
v_mfma_f32_16x16x32_bf16 v[76:79],a[248:251],v[36:39],v[76:79]
s_waitcnt lgkmcnt(1)
v_mfma_f32_16x16x32_bf16 v[64:67],a[124:127],v[40:43],v[64:67]
v_mfma_f32_16x16x32_bf16 v[72:75],a[252:255],v[40:43],v[72:75]
s_waitcnt lgkmcnt(0)
v_mfma_f32_16x16x32_bf16 v[68:71],a[124:127],v[44:47],v[68:71]
v_mfma_f32_16x16x32_bf16 v[76:79],a[252:255],v[44:47],v[76:79]
buffer_load_dword v29,v21,s[20:23],s74 offen sc1
v_xor_b32 v17,0x10000,v17
s_mov_b32 s72,s91
s_waitcnt vmcnt(1)
v_lshlrev_b32 v80,16,v120
v_and_b32 v81,s80,v120
v_lshlrev_b32 v82,16,v121
v_and_b32 v83,s80,v121
v_lshlrev_b32 v84,16,v122
v_and_b32 v85,s80,v122
v_lshlrev_b32 v86,16,v123
v_and_b32 v87,s80,v123
v_lshlrev_b32 v88,16,v124
v_and_b32 v89,s80,v124
v_lshlrev_b32 v90,16,v125
v_and_b32 v91,s80,v125
v_lshlrev_b32 v92,16,v126
v_and_b32 v93,s80,v126
v_lshlrev_b32 v94,16,v127
v_and_b32 v95,s80,v127
v_pk_add_f32 v[64:65],v[64:65],v[80:81]
v_pk_add_f32 v[66:67],v[66:67],v[82:83]
v_pk_add_f32 v[72:73],v[72:73],v[84:85]
v_pk_add_f32 v[74:75],v[74:75],v[86:87]
v_pk_add_f32 v[68:69],v[68:69],v[88:89]
v_pk_add_f32 v[70:71],v[70:71],v[90:91]
v_pk_add_f32 v[76:77],v[76:77],v[92:93]
v_pk_add_f32 v[78:79],v[78:79],v[94:95]
v_cvt_pk_bf16_f32 v96,v64,v65
v_cvt_pk_bf16_f32 v97,v66,v67
v_cvt_pk_bf16_f32 v98,v72,v73
v_cvt_pk_bf16_f32 v99,v74,v75
v_max_u32 v96,1,v96
buffer_store_dwordx4 v[96:99],v18,s[20:23],s70 offen offset:0 sc1
v_cvt_pk_bf16_f32 v100,v68,v69
v_cvt_pk_bf16_f32 v101,v70,v71
v_cvt_pk_bf16_f32 v102,v76,v77
v_cvt_pk_bf16_f32 v103,v78,v79
v_max_u32 v100,1,v100
buffer_store_dwordx4 v[100:103],v18,s[20:23],s70 offen offset:1024 sc1
v_lshlrev_b32 v80,16,v96
v_and_b32 v81,s80,v96
v_lshlrev_b32 v82,16,v97
v_and_b32 v83,s80,v97
v_lshlrev_b32 v84,16,v98
v_and_b32 v85,s80,v98
v_lshlrev_b32 v86,16,v99
v_and_b32 v87,s80,v99
v_lshlrev_b32 v88,16,v100
v_and_b32 v89,s80,v100
v_lshlrev_b32 v90,16,v101
v_and_b32 v91,s80,v101
v_lshlrev_b32 v92,16,v102
v_and_b32 v93,s80,v102
v_lshlrev_b32 v94,16,v103
v_and_b32 v95,s80,v103
v_pk_mul_f32 v[106:107],v[80:81],v[80:81]
v_pk_add_f32 v[104:105],v[80:81],v[82:83]
v_pk_mul_f32 v[110:111],v[88:89],v[88:89]
v_pk_add_f32 v[108:109],v[88:89],v[90:91]
v_pk_fma_f32 v[106:107],v[82:83],v[82:83],v[106:107]
v_pk_fma_f32 v[110:111],v[90:91],v[90:91],v[110:111]
v_pk_fma_f32 v[106:107],v[84:85],v[84:85],v[106:107]
v_pk_add_f32 v[104:105],v[104:105],v[84:85]
v_pk_fma_f32 v[110:111],v[92:93],v[92:93],v[110:111]
v_pk_add_f32 v[108:109],v[108:109],v[92:93]
v_pk_fma_f32 v[106:107],v[86:87],v[86:87],v[106:107]
v_pk_add_f32 v[104:105],v[104:105],v[86:87]
v_pk_fma_f32 v[110:111],v[94:95],v[94:95],v[110:111]
v_pk_add_f32 v[108:109],v[108:109],v[94:95]
v_add_f32 v80,v104,v105
v_add_f32 v81,v106,v107
v_add_f32 v82,v108,v109
v_add_f32 v83,v110,v111
v_mov_b32 v84,v80
v_mov_b32 v85,v81
v_mov_b32 v86,v82
v_mov_b32 v87,v83
v_permlane16_swap_b32 v84,v80
v_permlane16_swap_b32 v85,v81
v_permlane16_swap_b32 v86,v82
v_permlane16_swap_b32 v87,v83
v_pk_add_f32 v[80:81],v[80:81],v[84:85]
v_pk_add_f32 v[82:83],v[82:83],v[86:87]
v_mov_b32 v84,v80
v_mov_b32 v85,v81
v_mov_b32 v86,v82
v_mov_b32 v87,v83
v_permlane32_swap_b32 v84,v80
v_permlane32_swap_b32 v85,v81
v_permlane32_swap_b32 v86,v82
v_permlane32_swap_b32 v87,v83
v_pk_add_f32 v[80:81],v[80:81],v[84:85]
v_pk_add_f32 v[82:83],v[82:83],v[86:87]
v_max_u32 v81,1,v81
s_mov_b64 exec,0xffff
buffer_store_dwordx4 v[80:83],v24,s[20:23],s70 offen sc1
s_mov_b64 exec,-1
s_mov_b64 exec,1
v_mov_b32 v22,s71
v_mov_b32 v23,0
buffer_store_dword v22,v23,s[20:23],s73 offen sc1
s_mov_b64 exec,-1
s_add_u32 s65,s70,4194304
buffer_store_dwordx4 v[128:131],v18,s[20:23],s65 offen offset:0 sc1
buffer_store_dwordx4 v[128:131],v18,s[20:23],s65 offen offset:1024 sc1
s_mov_b64 exec,0xffff
buffer_store_dwordx4 v[128:131],v24,s[20:23],s65 offen sc1
s_mov_b64 exec,-1
s_add_u32 s79,s79,1
s_add_u32 s71,s71,1
s_cmp_lt_u32 s79,65
s_cbranch_scc1 ml_195
s_endpgm
r_at_183:
v_and_b32 v21,1,v1
v_mul_u32_u24 v21,896,v21
s_mov_b32 s65,21052032
s_mov_b32 s66,1792
pl_202:
buffer_load_dword v22,v21,s[20:23],s65 offen sc1
s_waitcnt vmcnt(0)
v_cmp_gt_u32 vcc,s66,v22
s_cbranch_vccz pok_203
s_sleep 1
s_sub_u32 s90,s90,1
s_cmp_gt_i32 s90,0
s_cbranch_scc1 pl_202
pok_203:
s_cmp_ge_u32 s50,2
s_cbranch_scc1 r_ln_182
s_lshl_b32 s41,s41,1
s_add_u32 s41,s41,s50
v_and_b32 v21,3,v1
v_lshlrev_b32 v21,7,v21
s_lshl_b32 s65,s41,2
s_add_u32 s65,s65,s63
pl_204:
buffer_load_dword v22,v21,s[20:23],s65 offen sc1
s_waitcnt vmcnt(0)
v_cmp_gt_u32 vcc,16,v22
s_cbranch_vccz pok_205
s_sleep 1
s_sub_u32 s90,s90,1
s_cmp_gt_i32 s90,0
s_cbranch_scc1 pl_204
pok_205:
v_mov_b32 v21,0
s_mov_b32 s66,128
pl_206:
buffer_load_dword v22,v21,s[44:47],36 offen sc1
s_waitcnt vmcnt(0)
v_cmp_gt_u32 vcc,s66,v22
s_cbranch_vccz pok_207
s_sleep 1
s_sub_u32 s90,s90,1
s_cmp_gt_i32 s90,0
s_cbranch_scc1 pl_206
pok_207:
s_lshl_b32 s42,s41,14
s_lshr_b32 s43,s41,1
s_lshl_b32 s43,s43,14
s_and_b32 s64,s41,1
s_lshl_b32 s64,s64,12
s_add_u32 s43,s43,s64
s_add_u32 s43,s43,1572864
s_lshr_b32 s64,s41,3
s_lshl_b32 s64,s64,7
s_and_b32 s65,s41,7
s_lshl_b32 s65,s65,2
s_add_u32 s73,s64,s65
s_add_u32 s73,s73,s63
s_add_u32 s73,s73,1024
v_lshrrev_b32 v6,3,v3
v_and_b32 v7,7,v3
v_lshl_add_u32 v6,v6,4,v7
v_lshlrev_b32 v6,4,v6
v_and_b32 v7,1,v4
v_lshl_add_u32 v6,v7,3,v6
v_lshrrev_b32 v8,2,v3
v_and_b32 v9,3,v3
v_lshl_add_u32 v8,v8,3,v9
s_mov_b32 s80,0x3e0293ee
v_mov_b32 v97,0xff800000
v_lshlrev_b32 v98,3,v4
v_sub_u32 v98,v98,v8
v_cmp_lt_u32 s[48:49],1,v4
v_cmp_ge_i32 s[4:5],-7,v98
v_cmp_ge_i32 s[6:7],-6,v98
v_cmp_ge_i32 s[8:9],-5,v98
v_cmp_ge_i32 s[10:11],-4,v98
v_cmp_ge_i32 s[12:13],-3,v98
v_cmp_ge_i32 s[14:15],-2,v98
v_cmp_ge_i32 s[16:17],-1,v98
v_cmp_ge_i32 s[18:19],0,v98
v_cmp_ge_i32 s[32:33],1,v98
v_cmp_ge_i32 s[34:35],2,v98
v_cmp_ge_i32 s[36:37],3,v98
v_cmp_ge_i32 s[38:39],4,v98
s_add_u32 s64,s79,0
s_lshl_b32 s74,s64,21
s_lshl_b32 s64,s64,13
s_and_b32 s64,s64,0x2000
s_xor_b32 s64,s64,s61
s_add_u32 s74,s74,s64
s_add_u32 s74,s74,29360128
s_add_u32 s66,s74,s43
kp_208:
buffer_load_dwordx4 v[136:139],v16,s[20:23],s66 offen offset:0 sc1
buffer_load_dwordx4 v[140:143],v16,s[20:23],s66 offen offset:1024 sc1
buffer_load_dwordx4 v[144:147],v16,s[20:23],s66 offen offset:2048 sc1
buffer_load_dwordx4 v[148:151],v16,s[20:23],s66 offen offset:3072 sc1
s_waitcnt vmcnt(0)
kck_210:
v_min3_u32 v22,v136,v140,v144
v_min_u32 v22,v22,v148
v_cmp_eq_u32 vcc,0,v22
s_cbranch_vccz kok_209
s_sleep 1
s_sub_u32 s90,s90,1
s_cmp_gt_i32 s90,0
s_cbranch_scc1 kp_208
kok_209:
s_add_u32 s64,s79,0
s_lshl_b32 s75,s64,21
s_lshl_b32 s64,s64,13
s_and_b32 s64,s64,0x2000
s_xor_b32 s64,s64,s61
s_add_u32 s75,s75,s64
s_add_u32 s75,s75,29360128
s_add_u32 s64,s79,0
s_lshl_b32 s76,s64,21
s_lshl_b32 s64,s64,13
s_and_b32 s64,s64,0x2000
s_xor_b32 s64,s64,s62
s_add_u32 s76,s76,s64
s_add_u32 s76,s76,29360128
s_add_u32 s75,s75,s42
s_add_u32 s76,s76,s42
s_add_u32 s65,s75,524288
buffer_load_dwordx4 a[32:35],v16,s[20:23],s65 offen offset:0 sc1
buffer_load_dwordx4 a[36:39],v16,s[20:23],s65 offen offset:1024 sc1
buffer_load_dwordx4 a[40:43],v16,s[20:23],s65 offen offset:2048 sc1
buffer_load_dwordx4 a[44:47],v16,s[20:23],s65 offen offset:3072 sc1
s_add_u32 s65,s75,528384
buffer_load_dwordx4 a[48:51],v16,s[20:23],s65 offen offset:0 sc1
buffer_load_dwordx4 a[52:55],v16,s[20:23],s65 offen offset:1024 sc1
buffer_load_dwordx4 a[56:59],v16,s[20:23],s65 offen offset:2048 sc1
buffer_load_dwordx4 a[60:63],v16,s[20:23],s65 offen offset:3072 sc1
s_add_u32 s65,s76,0
buffer_load_dwordx4 a[0:3],v16,s[20:23],s65 offen offset:0 sc1
buffer_load_dwordx4 a[4:7],v16,s[20:23],s65 offen offset:1024 sc1
buffer_load_dwordx4 a[8:11],v16,s[20:23],s65 offen offset:2048 sc1
buffer_load_dwordx4 a[12:15],v16,s[20:23],s65 offen offset:3072 sc1
s_add_u32 s65,s76,4096
buffer_load_dwordx4 a[16:19],v16,s[20:23],s65 offen offset:0 sc1
buffer_load_dwordx4 a[20:23],v16,s[20:23],s65 offen offset:1024 sc1
buffer_load_dwordx4 a[24:27],v16,s[20:23],s65 offen offset:2048 sc1
buffer_load_dwordx4 a[28:31],v16,s[20:23],s65 offen offset:3072 sc1
s_waitcnt vmcnt(0)
aloop_211:
s_add_u32 s64,s79,0
s_lshl_b32 s74,s64,21
s_lshl_b32 s64,s64,13
s_and_b32 s64,s64,0x2000
s_xor_b32 s64,s64,s61
s_add_u32 s74,s74,s64
s_add_u32 s74,s74,29360128
s_add_u32 s64,s79,0
s_lshl_b32 s70,s64,21
s_lshl_b32 s64,s64,13
s_and_b32 s64,s64,0x2000
s_xor_b32 s64,s64,s62
s_add_u32 s70,s70,s64
s_add_u32 s70,s70,29360128
s_add_u32 s66,s74,s43
s_waitcnt vmcnt(17)
s_branch kck_214
kp_212:
buffer_load_dwordx4 v[136:139],v16,s[20:23],s66 offen offset:0 sc1
buffer_load_dwordx4 v[140:143],v16,s[20:23],s66 offen offset:1024 sc1
buffer_load_dwordx4 v[144:147],v16,s[20:23],s66 offen offset:2048 sc1
buffer_load_dwordx4 v[148:151],v16,s[20:23],s66 offen offset:3072 sc1
s_waitcnt vmcnt(0)
kck_214:
v_min3_u32 v22,v136,v140,v144
v_min_u32 v22,v22,v148
v_cmp_eq_u32 vcc,0,v22
s_cbranch_vccz kok_213
s_sleep 1
s_sub_u32 s90,s90,1
s_cmp_gt_i32 s90,0
s_cbranch_scc1 kp_212
kok_213:
buffer_load_dwordx2 v[100:101],v6,s[20:23],s66 offen offset:0 sc1
buffer_load_dwordx2 v[102:103],v6,s[20:23],s66 offen offset:512 sc1
buffer_load_dwordx2 v[104:105],v6,s[20:23],s66 offen offset:1024 sc1
buffer_load_dwordx2 v[106:107],v6,s[20:23],s66 offen offset:1536 sc1
buffer_load_dwordx2 v[108:109],v6,s[20:23],s66 offen offset:2048 sc1
buffer_load_dwordx2 v[110:111],v6,s[20:23],s66 offen offset:2560 sc1
buffer_load_dwordx2 v[112:113],v6,s[20:23],s66 offen offset:3072 sc1
buffer_load_dwordx2 v[114:115],v6,s[20:23],s66 offen offset:3584 sc1
s_add_u32 s74,s74,s42
s_add_u32 s65,s74,1048576
buffer_load_dwordx4 a[64:67],v16,s[20:23],s65 offen offset:0 sc1
buffer_load_dwordx4 a[68:71],v16,s[20:23],s65 offen offset:1024 sc1
buffer_load_dwordx4 a[72:75],v16,s[20:23],s65 offen offset:2048 sc1
buffer_load_dwordx4 a[76:79],v16,s[20:23],s65 offen offset:3072 sc1
s_add_u32 s65,s74,1052672
buffer_load_dwordx4 a[80:83],v16,s[20:23],s65 offen offset:0 sc1
buffer_load_dwordx4 a[84:87],v16,s[20:23],s65 offen offset:1024 sc1
buffer_load_dwordx4 a[88:91],v16,s[20:23],s65 offen offset:2048 sc1
buffer_load_dwordx4 a[92:95],v16,s[20:23],s65 offen offset:3072 sc1
v_mfma_f32_16x16x32_bf16 v[168:171],a[32:35],a[0:3],0
v_mfma_f32_16x16x32_bf16 v[172:175],a[36:39],a[0:3],0
v_mfma_f32_16x16x32_bf16 v[176:179],v[136:139],a[0:3],0
v_mfma_f32_16x16x32_bf16 v[180:183],a[32:35],a[4:7],0
v_mfma_f32_16x16x32_bf16 v[184:187],a[36:39],a[4:7],0
v_mfma_f32_16x16x32_bf16 v[188:191],v[136:139],a[4:7],0
v_mfma_f32_16x16x32_bf16 v[168:171],a[40:43],a[8:11],v[168:171]
v_mfma_f32_16x16x32_bf16 v[172:175],a[44:47],a[8:11],v[172:175]
v_mfma_f32_16x16x32_bf16 v[176:179],v[140:143],a[8:11],v[176:179]
v_mfma_f32_16x16x32_bf16 v[180:183],a[40:43],a[12:15],v[180:183]
v_mfma_f32_16x16x32_bf16 v[184:187],a[44:47],a[12:15],v[184:187]
v_mfma_f32_16x16x32_bf16 v[188:191],v[140:143],a[12:15],v[188:191]
v_mfma_f32_16x16x32_bf16 v[168:171],a[48:51],a[16:19],v[168:171]
v_mfma_f32_16x16x32_bf16 v[172:175],a[52:55],a[16:19],v[172:175]
v_mfma_f32_16x16x32_bf16 v[176:179],v[144:147],a[16:19],v[176:179]
v_mfma_f32_16x16x32_bf16 v[180:183],a[48:51],a[20:23],v[180:183]
v_mfma_f32_16x16x32_bf16 v[184:187],a[52:55],a[20:23],v[184:187]
v_mfma_f32_16x16x32_bf16 v[188:191],v[144:147],a[20:23],v[188:191]
v_mfma_f32_16x16x32_bf16 v[168:171],a[56:59],a[24:27],v[168:171]
v_mfma_f32_16x16x32_bf16 v[172:175],a[60:63],a[24:27],v[172:175]
v_mfma_f32_16x16x32_bf16 v[176:179],v[148:151],a[24:27],v[176:179]
v_mfma_f32_16x16x32_bf16 v[180:183],a[56:59],a[28:31],v[180:183]
v_mfma_f32_16x16x32_bf16 v[184:187],a[60:63],a[28:31],v[184:187]
v_mfma_f32_16x16x32_bf16 v[188:191],v[148:151],a[28:31],v[188:191]
s_nop 2
v_cndmask_b32 v168,v97,v168,s[18:19]
v_cndmask_b32 v169,v97,v169,s[16:17]
v_cndmask_b32 v170,v97,v170,s[14:15]
v_cndmask_b32 v171,v97,v171,s[12:13]
v_cndmask_b32 v172,v97,v172,s[10:11]
v_cndmask_b32 v173,v97,v173,s[8:9]
v_cndmask_b32 v174,v97,v174,s[6:7]
v_cndmask_b32 v175,v97,v175,s[4:5]
v_cndmask_b32 v176,v97,v176,s[48:49]
v_cndmask_b32 v177,v97,v177,s[48:49]
v_cndmask_b32 v178,v97,v178,s[48:49]
v_cndmask_b32 v179,v97,v179,s[48:49]
v_max3_f32 v24,v168,v169,v170
v_max3_f32 v24,v24,v171,v172
v_max3_f32 v24,v24,v173,v174
v_max3_f32 v24,v24,v175,v176
v_max3_f32 v24,v24,v177,v178
v_max_f32 v24,v24,v179
v_mov_b32 v25,v24
s_nop 1
v_permlane16_swap_b32 v25,v24
v_max_f32 v24,v24,v25
v_mov_b32 v25,v24
s_nop 1
v_permlane32_swap_b32 v25,v24
v_max_f32 v24,v24,v25
v_mul_f32 v24,s80,v24
v_fma_f32 v168,v168,s80,-v24
v_fma_f32 v169,v169,s80,-v24
v_fma_f32 v170,v170,s80,-v24
v_fma_f32 v171,v171,s80,-v24
v_fma_f32 v172,v172,s80,-v24
v_fma_f32 v173,v173,s80,-v24
v_fma_f32 v174,v174,s80,-v24
v_fma_f32 v175,v175,s80,-v24
v_fma_f32 v176,v176,s80,-v24
v_fma_f32 v177,v177,s80,-v24
v_fma_f32 v178,v178,s80,-v24
v_fma_f32 v179,v179,s80,-v24
v_exp_f32 v168,v168
v_exp_f32 v169,v169
v_exp_f32 v170,v170
v_exp_f32 v171,v171
v_exp_f32 v172,v172
v_exp_f32 v173,v173
v_exp_f32 v174,v174
v_exp_f32 v175,v175
v_exp_f32 v176,v176
v_exp_f32 v177,v177
v_exp_f32 v178,v178
v_exp_f32 v179,v179
v_add_f32 v26,v168,v169
v_add_f32 v27,v170,v171
v_add_f32 v26,v26,v172
v_add_f32 v27,v27,v173
v_add_f32 v26,v26,v174
v_add_f32 v27,v27,v175
v_add_f32 v26,v26,v176
v_add_f32 v27,v27,v177
v_add_f32 v26,v26,v178
v_add_f32 v27,v27,v179
v_add_f32 v26,v26,v27
v_mov_b32 v25,v26
s_nop 1
v_permlane16_swap_b32 v25,v26
v_add_f32 v26,v26,v25
v_mov_b32 v25,v26
s_nop 1
v_permlane32_swap_b32 v25,v26
v_add_f32 v26,v26,v25
v_rcp_f32 v27,v26
s_nop 0
v_mul_f32 v168,v168,v27
v_mul_f32 v169,v169,v27
v_mul_f32 v170,v170,v27
v_mul_f32 v171,v171,v27
v_mul_f32 v172,v172,v27
v_mul_f32 v173,v173,v27
v_mul_f32 v174,v174,v27
v_mul_f32 v175,v175,v27
v_mul_f32 v176,v176,v27
v_mul_f32 v177,v177,v27
v_mul_f32 v178,v178,v27
v_mul_f32 v179,v179,v27
v_cvt_pk_bf16_f32 v48,v168,v169
v_cvt_pk_bf16_f32 v49,v170,v171
v_cvt_pk_bf16_f32 v50,v172,v173
v_cvt_pk_bf16_f32 v51,v174,v175
v_cvt_pk_bf16_f32 v52,v176,v177
v_cvt_pk_bf16_f32 v53,v178,v179
v_cndmask_b32 v180,v97,v180,s[38:39]
v_cndmask_b32 v181,v97,v181,s[36:37]
v_cndmask_b32 v182,v97,v182,s[34:35]
v_cndmask_b32 v183,v97,v183,s[32:33]
v_cndmask_b32 v184,v97,v184,s[18:19]
v_cndmask_b32 v185,v97,v185,s[16:17]
v_cndmask_b32 v186,v97,v186,s[14:15]
v_cndmask_b32 v187,v97,v187,s[12:13]
v_cndmask_b32 v188,v97,v188,s[48:49]
v_cndmask_b32 v189,v97,v189,s[48:49]
v_cndmask_b32 v190,v97,v190,s[48:49]
v_cndmask_b32 v191,v97,v191,s[48:49]
s_add_u32 s64,s79,1
s_lshl_b32 s75,s64,21
s_lshl_b32 s64,s64,13
s_and_b32 s64,s64,0x2000
s_xor_b32 s64,s64,s61
s_add_u32 s75,s75,s64
s_add_u32 s75,s75,29360128
s_add_u32 s64,s79,1
s_lshl_b32 s76,s64,21
s_lshl_b32 s64,s64,13
s_and_b32 s64,s64,0x2000
s_xor_b32 s64,s64,s62
s_add_u32 s76,s76,s64
s_add_u32 s76,s76,29360128
s_add_u32 s66,s75,s43
buffer_load_dwordx4 v[136:139],v16,s[20:23],s66 offen offset:0 sc1
buffer_load_dwordx4 v[140:143],v16,s[20:23],s66 offen offset:1024 sc1
buffer_load_dwordx4 v[144:147],v16,s[20:23],s66 offen offset:2048 sc1
buffer_load_dwordx4 v[148:151],v16,s[20:23],s66 offen offset:3072 sc1
s_add_u32 s75,s75,s42
s_add_u32 s76,s76,s42
s_add_u32 s65,s75,524288
buffer_load_dwordx4 a[32:35],v16,s[20:23],s65 offen offset:0 sc1
buffer_load_dwordx4 a[36:39],v16,s[20:23],s65 offen offset:1024 sc1
buffer_load_dwordx4 a[40:43],v16,s[20:23],s65 offen offset:2048 sc1
buffer_load_dwordx4 a[44:47],v16,s[20:23],s65 offen offset:3072 sc1
s_add_u32 s65,s75,528384
buffer_load_dwordx4 a[48:51],v16,s[20:23],s65 offen offset:0 sc1
buffer_load_dwordx4 a[52:55],v16,s[20:23],s65 offen offset:1024 sc1
buffer_load_dwordx4 a[56:59],v16,s[20:23],s65 offen offset:2048 sc1
buffer_load_dwordx4 a[60:63],v16,s[20:23],s65 offen offset:3072 sc1
s_add_u32 s65,s76,0
buffer_load_dwordx4 a[0:3],v16,s[20:23],s65 offen offset:0 sc1
buffer_load_dwordx4 a[4:7],v16,s[20:23],s65 offen offset:1024 sc1
buffer_load_dwordx4 a[8:11],v16,s[20:23],s65 offen offset:2048 sc1
buffer_load_dwordx4 a[12:15],v16,s[20:23],s65 offen offset:3072 sc1
s_add_u32 s65,s76,4096
buffer_load_dwordx4 a[16:19],v16,s[20:23],s65 offen offset:0 sc1
buffer_load_dwordx4 a[20:23],v16,s[20:23],s65 offen offset:1024 sc1
buffer_load_dwordx4 a[24:27],v16,s[20:23],s65 offen offset:2048 sc1
buffer_load_dwordx4 a[28:31],v16,s[20:23],s65 offen offset:3072 sc1
v_max3_f32 v24,v180,v181,v182
v_max3_f32 v24,v24,v183,v184
v_max3_f32 v24,v24,v185,v186
v_max3_f32 v24,v24,v187,v188
v_max3_f32 v24,v24,v189,v190
v_max_f32 v24,v24,v191
v_mov_b32 v25,v24
s_nop 1
v_permlane16_swap_b32 v25,v24
v_max_f32 v24,v24,v25
v_mov_b32 v25,v24
s_nop 1
v_permlane32_swap_b32 v25,v24
v_max_f32 v24,v24,v25
v_mul_f32 v24,s80,v24
v_fma_f32 v180,v180,s80,-v24
v_fma_f32 v181,v181,s80,-v24
v_fma_f32 v182,v182,s80,-v24
v_fma_f32 v183,v183,s80,-v24
v_fma_f32 v184,v184,s80,-v24
v_fma_f32 v185,v185,s80,-v24
v_fma_f32 v186,v186,s80,-v24
v_fma_f32 v187,v187,s80,-v24
v_fma_f32 v188,v188,s80,-v24
v_fma_f32 v189,v189,s80,-v24
v_fma_f32 v190,v190,s80,-v24
v_fma_f32 v191,v191,s80,-v24
v_exp_f32 v180,v180
v_exp_f32 v181,v181
v_exp_f32 v182,v182
v_exp_f32 v183,v183
v_exp_f32 v184,v184
v_exp_f32 v185,v185
v_exp_f32 v186,v186
v_exp_f32 v187,v187
v_exp_f32 v188,v188
v_exp_f32 v189,v189
v_exp_f32 v190,v190
v_exp_f32 v191,v191
v_add_f32 v26,v180,v181
v_add_f32 v27,v182,v183
v_add_f32 v26,v26,v184
v_add_f32 v27,v27,v185
v_add_f32 v26,v26,v186
v_add_f32 v27,v27,v187
v_add_f32 v26,v26,v188
v_add_f32 v27,v27,v189
v_add_f32 v26,v26,v190
v_add_f32 v27,v27,v191
v_add_f32 v26,v26,v27
v_mov_b32 v25,v26
s_nop 1
v_permlane16_swap_b32 v25,v26
v_add_f32 v26,v26,v25
v_mov_b32 v25,v26
s_nop 1
v_permlane32_swap_b32 v25,v26
v_add_f32 v26,v26,v25
v_rcp_f32 v27,v26
s_nop 0
v_mul_f32 v180,v180,v27
v_mul_f32 v181,v181,v27
v_mul_f32 v182,v182,v27
v_mul_f32 v183,v183,v27
v_mul_f32 v184,v184,v27
v_mul_f32 v185,v185,v27
v_mul_f32 v186,v186,v27
v_mul_f32 v187,v187,v27
v_mul_f32 v188,v188,v27
v_mul_f32 v189,v189,v27
v_mul_f32 v190,v190,v27
v_mul_f32 v191,v191,v27
v_cvt_pk_bf16_f32 v56,v180,v181
v_cvt_pk_bf16_f32 v57,v182,v183
v_cvt_pk_bf16_f32 v58,v184,v185
v_cvt_pk_bf16_f32 v59,v186,v187
v_cvt_pk_bf16_f32 v60,v188,v189
v_cvt_pk_bf16_f32 v61,v190,v191
s_waitcnt vmcnt(20)
v_mfma_f32_16x16x32_bf16 v[192:195],a[64:67],v[48:51],0
v_mfma_f32_16x16x32_bf16 v[196:199],a[64:67],v[56:59],0
v_mfma_f32_16x16x32_bf16 v[200:203],a[68:71],v[48:51],0
v_mfma_f32_16x16x32_bf16 v[204:207],a[68:71],v[56:59],0
v_mfma_f32_16x16x32_bf16 v[208:211],a[72:75],v[48:51],0
v_mfma_f32_16x16x32_bf16 v[212:215],a[72:75],v[56:59],0
v_mfma_f32_16x16x32_bf16 v[216:219],a[76:79],v[48:51],0
v_mfma_f32_16x16x32_bf16 v[220:223],a[76:79],v[56:59],0
v_mfma_f32_16x16x32_bf16 v[224:227],a[80:83],v[48:51],0
v_mfma_f32_16x16x32_bf16 v[228:231],a[80:83],v[56:59],0
v_mfma_f32_16x16x32_bf16 v[232:235],a[84:87],v[48:51],0
v_mfma_f32_16x16x32_bf16 v[236:239],a[84:87],v[56:59],0
v_mfma_f32_16x16x32_bf16 v[240:243],a[88:91],v[48:51],0
v_mfma_f32_16x16x32_bf16 v[244:247],a[88:91],v[56:59],0
v_mfma_f32_16x16x32_bf16 v[248:251],a[92:95],v[48:51],0
v_mfma_f32_16x16x32_bf16 v[252:255],a[92:95],v[56:59],0
v_mfma_f32_16x16x16_bf16 v[192:195],v[100:101],v[52:53],v[192:195]
v_mfma_f32_16x16x16_bf16 v[196:199],v[100:101],v[60:61],v[196:199]
v_mfma_f32_16x16x16_bf16 v[200:203],v[102:103],v[52:53],v[200:203]
v_mfma_f32_16x16x16_bf16 v[204:207],v[102:103],v[60:61],v[204:207]
v_mfma_f32_16x16x16_bf16 v[208:211],v[104:105],v[52:53],v[208:211]
v_mfma_f32_16x16x16_bf16 v[212:215],v[104:105],v[60:61],v[212:215]
v_mfma_f32_16x16x16_bf16 v[216:219],v[106:107],v[52:53],v[216:219]
v_mfma_f32_16x16x16_bf16 v[220:223],v[106:107],v[60:61],v[220:223]
v_mfma_f32_16x16x16_bf16 v[224:227],v[108:109],v[52:53],v[224:227]
v_mfma_f32_16x16x16_bf16 v[228:231],v[108:109],v[60:61],v[228:231]
v_mfma_f32_16x16x16_bf16 v[232:235],v[110:111],v[52:53],v[232:235]
v_mfma_f32_16x16x16_bf16 v[236:239],v[110:111],v[60:61],v[236:239]
v_mfma_f32_16x16x16_bf16 v[240:243],v[112:113],v[52:53],v[240:243]
v_mfma_f32_16x16x16_bf16 v[244:247],v[112:113],v[60:61],v[244:247]
v_mfma_f32_16x16x16_bf16 v[248:251],v[114:115],v[52:53],v[248:251]
v_mfma_f32_16x16x16_bf16 v[252:255],v[114:115],v[60:61],v[252:255]
s_add_u32 s70,s70,s42
s_add_u32 s65,s70,524288
v_cvt_pk_bf16_f32 v64,v192,v193
v_cvt_pk_bf16_f32 v65,v194,v195
v_cvt_pk_bf16_f32 v66,v200,v201
v_cvt_pk_bf16_f32 v67,v202,v203
v_max_u32 v64,1,v64
buffer_store_dwordx4 v[64:67],v16,s[20:23],s65 offen offset:0 sc1
v_cvt_pk_bf16_f32 v68,v196,v197
v_cvt_pk_bf16_f32 v69,v198,v199
v_cvt_pk_bf16_f32 v70,v204,v205
v_cvt_pk_bf16_f32 v71,v206,v207
v_max_u32 v68,1,v68
buffer_store_dwordx4 v[68:71],v16,s[20:23],s65 offen offset:1024 sc1
v_cvt_pk_bf16_f32 v72,v208,v209
v_cvt_pk_bf16_f32 v73,v210,v211
v_cvt_pk_bf16_f32 v74,v216,v217
v_cvt_pk_bf16_f32 v75,v218,v219
v_max_u32 v72,1,v72
buffer_store_dwordx4 v[72:75],v16,s[20:23],s65 offen offset:2048 sc1
v_cvt_pk_bf16_f32 v76,v212,v213
v_cvt_pk_bf16_f32 v77,v214,v215
v_cvt_pk_bf16_f32 v78,v220,v221
v_cvt_pk_bf16_f32 v79,v222,v223
v_max_u32 v76,1,v76
buffer_store_dwordx4 v[76:79],v16,s[20:23],s65 offen offset:3072 sc1
s_add_u32 s65,s70,528384
v_cvt_pk_bf16_f32 v64,v224,v225
v_cvt_pk_bf16_f32 v65,v226,v227
v_cvt_pk_bf16_f32 v66,v232,v233
v_cvt_pk_bf16_f32 v67,v234,v235
v_max_u32 v64,1,v64
buffer_store_dwordx4 v[64:67],v16,s[20:23],s65 offen offset:0 sc1
v_cvt_pk_bf16_f32 v68,v228,v229
v_cvt_pk_bf16_f32 v69,v230,v231
v_cvt_pk_bf16_f32 v70,v236,v237
v_cvt_pk_bf16_f32 v71,v238,v239
v_max_u32 v68,1,v68
buffer_store_dwordx4 v[68:71],v16,s[20:23],s65 offen offset:1024 sc1
v_cvt_pk_bf16_f32 v72,v240,v241
v_cvt_pk_bf16_f32 v73,v242,v243
v_cvt_pk_bf16_f32 v74,v248,v249
v_cvt_pk_bf16_f32 v75,v250,v251
v_max_u32 v72,1,v72
buffer_store_dwordx4 v[72:75],v16,s[20:23],s65 offen offset:2048 sc1
v_cvt_pk_bf16_f32 v76,v244,v245
v_cvt_pk_bf16_f32 v77,v246,v247
v_cvt_pk_bf16_f32 v78,v252,v253
v_cvt_pk_bf16_f32 v79,v254,v255
v_max_u32 v76,1,v76
buffer_store_dwordx4 v[76:79],v16,s[20:23],s65 offen offset:3072 sc1
s_mov_b64 exec,1
v_mov_b32 v22,s71
v_mov_b32 v23,0
buffer_store_dword v22,v23,s[20:23],s73 offen sc1
s_mov_b64 exec,-1
s_add_u32 s65,s70,4718592
buffer_store_dwordx4 v[128:131],v16,s[20:23],s65 offen offset:0 sc1
buffer_store_dwordx4 v[128:131],v16,s[20:23],s65 offen offset:1024 sc1
buffer_store_dwordx4 v[128:131],v16,s[20:23],s65 offen offset:2048 sc1
buffer_store_dwordx4 v[128:131],v16,s[20:23],s65 offen offset:3072 sc1
s_add_u32 s65,s70,4722688
buffer_store_dwordx4 v[128:131],v16,s[20:23],s65 offen offset:0 sc1
buffer_store_dwordx4 v[128:131],v16,s[20:23],s65 offen offset:1024 sc1
buffer_store_dwordx4 v[128:131],v16,s[20:23],s65 offen offset:2048 sc1
buffer_store_dwordx4 v[128:131],v16,s[20:23],s65 offen offset:3072 sc1
s_add_u32 s79,s79,1
s_add_u32 s71,s71,1
s_cmp_lt_u32 s79,64
s_cbranch_scc1 aloop_211
s_endpgm
r_ln_182:
s_lshl_b32 s41,s59,1
s_add_u32 s41,s41,s50
s_sub_u32 s41,s41,2
v_lshlrev_b32 v5,5,v1
s_mov_b32 s64,16384
buffer_load_dwordx4 v[40:43],v5,s[20:23],s64 offen offset:0 sc1
buffer_load_dwordx4 v[44:47],v5,s[20:23],s64 offen offset:16 sc1
buffer_load_dwordx4 v[48:51],v5,s[20:23],s64 offen offset:2048 sc1
buffer_load_dwordx4 v[52:55],v5,s[20:23],s64 offen offset:2064 sc1
s_mov_b32 s64,12288
buffer_load_dwordx4 v[56:59],v5,s[20:23],s64 offen offset:0 sc1
buffer_load_dwordx4 v[60:63],v5,s[20:23],s64 offen offset:16 sc1
buffer_load_dwordx4 v[64:67],v5,s[20:23],s64 offen offset:2048 sc1
buffer_load_dwordx4 v[68:71],v5,s[20:23],s64 offen offset:2064 sc1
s_lshr_b32 s64,s41,2
s_add_u32 s64,s64,64
s_lshl_b32 s64,s64,14
s_and_b32 s65,s41,3
s_lshl_b32 s65,s65,11
s_add_u32 s64,s64,s65
v_add_u32 v17,s64,v16
s_lshl_b32 s64,s41,11
v_add_u32 v18,s64,v16
s_lshr_b32 s64,s41,4
s_lshl_b32 s64,s64,10
s_and_b32 s65,s41,15
s_lshl_b32 s65,s65,4
s_add_u32 s64,s64,s65
v_lshrrev_b32 v5,2,v1
v_and_b32 v6,3,v1
v_lshlrev_b32 v5,11,v5
v_lshl_add_u32 v5,v6,8,v5
v_add_u32 v19,s64,v5
v_add_u32 v20,32768,v19
v_and_b32 v21,31,v1
v_lshlrev_b32 v21,2,v21
s_add_u32 s74,s63,2048
s_lshl_b32 s73,s41,2
s_add_u32 s73,s73,s63
s_add_u32 s73,s73,2560
s_waitcnt vmcnt(0)
v_add_f32 v40,1.0,v40
v_add_f32 v41,1.0,v41
v_add_f32 v42,1.0,v42
v_add_f32 v43,1.0,v43
v_add_f32 v44,1.0,v44
v_add_f32 v45,1.0,v45
v_add_f32 v46,1.0,v46
v_add_f32 v47,1.0,v47
v_add_f32 v48,1.0,v48
v_add_f32 v49,1.0,v49
v_add_f32 v50,1.0,v50
v_add_f32 v51,1.0,v51
v_add_f32 v52,1.0,v52
v_add_f32 v53,1.0,v53
v_add_f32 v54,1.0,v54
v_add_f32 v55,1.0,v55
lloop_215:
s_add_u32 s64,s79,0
s_lshl_b32 s70,s64,21
s_lshl_b32 s64,s64,13
s_and_b32 s64,s64,0x2000
s_xor_b32 s64,s64,s62
s_add_u32 s70,s70,s64
s_add_u32 s70,s70,29360128
s_lshl_b32 s75,s79,16
s_add_u32 s76,s75,8577024
s_add_u32 s75,s75,4251648
xp_216:
buffer_load_dwordx4 v[8:11],v17,s[20:23],s70 offen sc1
buffer_load_dwordx4 v[12:15],v17,s[20:23],s70 offen offset:1024 sc1
s_waitcnt vmcnt(0)
v_min3_u32 v22,v8,v10,v12
v_min_u32 v22,v22,v14
v_cmp_eq_u32 vcc,0,v22
s_cbranch_vccz xk_217
s_sleep 1
s_sub_u32 s90,s90,1
s_cmp_gt_i32 s90,0
s_cbranch_scc1 xp_216
xk_217:
v_lshlrev_b32 v80,16,v8
v_and_b32 v81,s80,v8
v_lshlrev_b32 v82,16,v9
v_and_b32 v83,s80,v9
v_lshlrev_b32 v84,16,v10
v_and_b32 v85,s80,v10
v_lshlrev_b32 v86,16,v11
v_and_b32 v87,s80,v11
v_lshlrev_b32 v88,16,v12
v_and_b32 v89,s80,v12
v_lshlrev_b32 v90,16,v13
v_and_b32 v91,s80,v13
v_lshlrev_b32 v92,16,v14
v_and_b32 v93,s80,v14
v_lshlrev_b32 v94,16,v15
v_and_b32 v95,s80,v15
v_add_f32 v5,v80,v81
v_add_f32 v5,v5,v82
v_add_f32 v5,v5,v83
v_add_f32 v5,v5,v84
v_add_f32 v5,v5,v85
v_add_f32 v5,v5,v86
v_add_f32 v5,v5,v87
v_add_f32 v5,v5,v88
v_add_f32 v5,v5,v89
v_add_f32 v5,v5,v90
v_add_f32 v5,v5,v91
v_add_f32 v5,v5,v92
v_add_f32 v5,v5,v93
v_add_f32 v5,v5,v94
v_add_f32 v5,v5,v95
s_nop 1
v_add_f32_dpp v5,v5,v5 quad_perm:[1,0,3,2] row_mask:0xf bank_mask:0xf
s_nop 1
v_add_f32_dpp v5,v5,v5 quad_perm:[2,3,0,1] row_mask:0xf bank_mask:0xf
s_nop 1
v_add_f32_dpp v5,v5,v5 row_half_mirror row_mask:0xf bank_mask:0xf
s_nop 1
v_add_f32_dpp v5,v5,v5 row_mirror row_mask:0xf bank_mask:0xf
v_mov_b32 v7,v5
s_nop 1
v_permlane16_swap_b32 v7,v5
v_add_f32 v5,v5,v7
v_mov_b32 v7,v5
s_nop 1
v_permlane32_swap_b32 v7,v5
v_add_f32 v5,v5,v7
v_mul_f32 v5,0x3a800000,v5
v_sub_f32 v80,v80,v5
v_sub_f32 v81,v81,v5
v_sub_f32 v82,v82,v5
v_sub_f32 v83,v83,v5
v_sub_f32 v84,v84,v5
v_sub_f32 v85,v85,v5
v_sub_f32 v86,v86,v5
v_sub_f32 v87,v87,v5
v_sub_f32 v88,v88,v5
v_sub_f32 v89,v89,v5
v_sub_f32 v90,v90,v5
v_sub_f32 v91,v91,v5
v_sub_f32 v92,v92,v5
v_sub_f32 v93,v93,v5
v_sub_f32 v94,v94,v5
v_sub_f32 v95,v95,v5
v_mul_f32 v6,v80,v80
v_fmac_f32 v6,v81,v81
v_fmac_f32 v6,v82,v82
v_fmac_f32 v6,v83,v83
v_fmac_f32 v6,v84,v84
v_fmac_f32 v6,v85,v85
v_fmac_f32 v6,v86,v86
v_fmac_f32 v6,v87,v87
v_fmac_f32 v6,v88,v88
v_fmac_f32 v6,v89,v89
v_fmac_f32 v6,v90,v90
v_fmac_f32 v6,v91,v91
v_fmac_f32 v6,v92,v92
v_fmac_f32 v6,v93,v93
v_fmac_f32 v6,v94,v94
v_fmac_f32 v6,v95,v95
s_nop 1
v_add_f32_dpp v6,v6,v6 quad_perm:[1,0,3,2] row_mask:0xf bank_mask:0xf
s_nop 1
v_add_f32_dpp v6,v6,v6 quad_perm:[2,3,0,1] row_mask:0xf bank_mask:0xf
s_nop 1
v_add_f32_dpp v6,v6,v6 row_half_mirror row_mask:0xf bank_mask:0xf
s_nop 1
v_add_f32_dpp v6,v6,v6 row_mirror row_mask:0xf bank_mask:0xf
v_mov_b32 v7,v6
s_nop 1
v_permlane16_swap_b32 v7,v6
v_add_f32 v6,v6,v7
v_mov_b32 v7,v6
s_nop 1
v_permlane32_swap_b32 v7,v6
v_add_f32 v6,v6,v7
v_mov_b32 v7,0x3727c5ac
v_fmac_f32 v7,0x3a800000,v6
v_rsq_f32 v6,v7
s_nop 0
v_mul_f32 v80,v80,v6
v_mul_f32 v81,v81,v6
v_mul_f32 v82,v82,v6
v_mul_f32 v83,v83,v6
v_mul_f32 v84,v84,v6
v_mul_f32 v85,v85,v6
v_mul_f32 v86,v86,v6
v_mul_f32 v87,v87,v6
v_mul_f32 v88,v88,v6
v_mul_f32 v89,v89,v6
v_mul_f32 v90,v90,v6
v_mul_f32 v91,v91,v6
v_mul_f32 v92,v92,v6
v_mul_f32 v93,v93,v6
v_mul_f32 v94,v94,v6
v_mul_f32 v95,v95,v6
v_fma_f32 v80,v80,v40,v56
v_fma_f32 v81,v81,v41,v57
v_fma_f32 v82,v82,v42,v58
v_fma_f32 v83,v83,v43,v59
v_fma_f32 v84,v84,v44,v60
v_fma_f32 v85,v85,v45,v61
v_fma_f32 v86,v86,v46,v62
v_fma_f32 v87,v87,v47,v63
v_fma_f32 v88,v88,v48,v64
v_fma_f32 v89,v89,v49,v65
v_fma_f32 v90,v90,v50,v66
v_fma_f32 v91,v91,v51,v67
v_fma_f32 v92,v92,v52,v68
v_fma_f32 v93,v93,v53,v69
v_fma_f32 v94,v94,v54,v70
v_fma_f32 v95,v95,v55,v71
v_cvt_pk_bf16_f32 v8,v80,v81
v_cvt_pk_bf16_f32 v9,v82,v83
v_cvt_pk_bf16_f32 v10,v84,v85
v_cvt_pk_bf16_f32 v11,v86,v87
v_cvt_pk_bf16_f32 v12,v88,v89
v_cvt_pk_bf16_f32 v13,v90,v91
v_cvt_pk_bf16_f32 v14,v92,v93
v_cvt_pk_bf16_f32 v15,v94,v95
buffer_store_dwordx4 v[8:11],v18,s[24:27],s75 offen
buffer_store_dwordx4 v[8:11],v18,s[28:31],s75 offen sc1
buffer_store_dwordx4 v[12:15],v18,s[24:27],s75 offen offset:1024
buffer_store_dwordx4 v[12:15],v18,s[28:31],s75 offen offset:1024 sc1
v_lshlrev_b32 v80,16,v8
v_and_b32 v81,s80,v8
v_lshlrev_b32 v82,16,v9
v_and_b32 v83,s80,v9
v_lshlrev_b32 v84,16,v10
v_and_b32 v85,s80,v10
v_lshlrev_b32 v86,16,v11
v_and_b32 v87,s80,v11
v_lshlrev_b32 v88,16,v12
v_and_b32 v89,s80,v12
v_lshlrev_b32 v90,16,v13
v_and_b32 v91,s80,v13
v_lshlrev_b32 v92,16,v14
v_and_b32 v93,s80,v14
v_lshlrev_b32 v94,16,v15
v_and_b32 v95,s80,v15
v_add_f32 v5,v80,v81
v_add_f32 v5,v5,v82
v_add_f32 v5,v5,v83
v_add_f32 v5,v5,v84
v_add_f32 v5,v5,v85
v_add_f32 v5,v5,v86
v_add_f32 v5,v5,v87
v_add_f32 v5,v5,v88
v_add_f32 v5,v5,v89
v_add_f32 v5,v5,v90
v_add_f32 v5,v5,v91
v_add_f32 v5,v5,v92
v_add_f32 v5,v5,v93
v_add_f32 v5,v5,v94
v_add_f32 v5,v5,v95
s_nop 1
v_add_f32_dpp v5,v5,v5 quad_perm:[1,0,3,2] row_mask:0xf bank_mask:0xf
s_nop 1
v_add_f32_dpp v5,v5,v5 quad_perm:[2,3,0,1] row_mask:0xf bank_mask:0xf
s_nop 1
v_add_f32_dpp v5,v5,v5 row_half_mirror row_mask:0xf bank_mask:0xf
s_nop 1
v_add_f32_dpp v5,v5,v5 row_mirror row_mask:0xf bank_mask:0xf
v_mov_b32 v7,v5
s_nop 1
v_permlane16_swap_b32 v7,v5
v_add_f32 v5,v5,v7
v_mov_b32 v7,v5
s_nop 1
v_permlane32_swap_b32 v7,v5
v_add_f32 v5,v5,v7
v_mul_f32 v5,0x3a800000,v5
v_sub_f32 v80,v80,v5
v_sub_f32 v81,v81,v5
v_sub_f32 v82,v82,v5
v_sub_f32 v83,v83,v5
v_sub_f32 v84,v84,v5
v_sub_f32 v85,v85,v5
v_sub_f32 v86,v86,v5
v_sub_f32 v87,v87,v5
v_sub_f32 v88,v88,v5
v_sub_f32 v89,v89,v5
v_sub_f32 v90,v90,v5
v_sub_f32 v91,v91,v5
v_sub_f32 v92,v92,v5
v_sub_f32 v93,v93,v5
v_sub_f32 v94,v94,v5
v_sub_f32 v95,v95,v5
v_mul_f32 v6,v80,v80
v_fmac_f32 v6,v81,v81
v_fmac_f32 v6,v82,v82
v_fmac_f32 v6,v83,v83
v_fmac_f32 v6,v84,v84
v_fmac_f32 v6,v85,v85
v_fmac_f32 v6,v86,v86
v_fmac_f32 v6,v87,v87
v_fmac_f32 v6,v88,v88
v_fmac_f32 v6,v89,v89
v_fmac_f32 v6,v90,v90
v_fmac_f32 v6,v91,v91
v_fmac_f32 v6,v92,v92
v_fmac_f32 v6,v93,v93
v_fmac_f32 v6,v94,v94
v_fmac_f32 v6,v95,v95
s_nop 1
v_add_f32_dpp v6,v6,v6 quad_perm:[1,0,3,2] row_mask:0xf bank_mask:0xf
s_nop 1
v_add_f32_dpp v6,v6,v6 quad_perm:[2,3,0,1] row_mask:0xf bank_mask:0xf
s_nop 1
v_add_f32_dpp v6,v6,v6 row_half_mirror row_mask:0xf bank_mask:0xf
s_nop 1
v_add_f32_dpp v6,v6,v6 row_mirror row_mask:0xf bank_mask:0xf
v_mov_b32 v7,v6
s_nop 1
v_permlane16_swap_b32 v7,v6
v_add_f32 v6,v6,v7
v_mov_b32 v7,v6
s_nop 1
v_permlane32_swap_b32 v7,v6
v_add_f32 v6,v6,v7
v_mov_b32 v7,0x3727c5ac
v_fmac_f32 v7,0x3a800000,v6
v_rsq_f32 v6,v7
s_nop 0
v_mul_f32 v80,v80,v6
v_mul_f32 v81,v81,v6
v_mul_f32 v82,v82,v6
v_mul_f32 v83,v83,v6
v_mul_f32 v84,v84,v6
v_mul_f32 v85,v85,v6
v_mul_f32 v86,v86,v6
v_mul_f32 v87,v87,v6
v_mul_f32 v88,v88,v6
v_mul_f32 v89,v89,v6
v_mul_f32 v90,v90,v6
v_mul_f32 v91,v91,v6
v_mul_f32 v92,v92,v6
v_mul_f32 v93,v93,v6
v_mul_f32 v94,v94,v6
v_mul_f32 v95,v95,v6
v_cvt_pk_bf16_f32 v72,v80,v81
v_cvt_pk_bf16_f32 v73,v82,v83
v_cvt_pk_bf16_f32 v74,v84,v85
v_cvt_pk_bf16_f32 v75,v86,v87
v_cvt_pk_bf16_f32 v76,v88,v89
v_cvt_pk_bf16_f32 v77,v90,v91
v_cvt_pk_bf16_f32 v78,v92,v93
v_cvt_pk_bf16_f32 v79,v94,v95
buffer_store_dwordx4 v[72:75],v19,s[24:27],s76 offen
buffer_store_dwordx4 v[72:75],v19,s[28:31],s76 offen sc1
buffer_store_dwordx4 v[76:79],v20,s[24:27],s76 offen
buffer_store_dwordx4 v[76:79],v20,s[28:31],s76 offen sc1
s_waitcnt vmcnt(0)
s_mov_b64 exec,1
v_mov_b32 v22,s71
v_mov_b32 v23,0
buffer_store_dword v22,v23,s[24:27],s73 offen
buffer_store_dword v22,v23,s[28:31],s73 offen sc1
s_mov_b64 exec,-1
s_add_u32 s79,s79,1
s_add_u32 s71,s71,1
s_cmp_lt_u32 s79,64
s_cbranch_scc1 lloop_215
s_endpgm
r_wo_178:
s_load_dwordx2 s[4:5],s[0:1],40
s_load_dwordx2 s[6:7],s[0:1],0
s_lshr_b32 s41,s59,3
s_and_b32 s42,s59,7
s_mul_i32 s66,s41,2097152
s_lshl_b32 s64,s42,8
s_add_u32 s66,s66,s64
s_lshl_b32 s67,s50,1
s_and_b32 s64,s41,1
s_add_u32 s67,s67,s64
s_waitcnt lgkmcnt(0)
s_mov_b32 s32,s4
s_and_b32 s33,s5,0xffff
s_mov_b32 s34,0x800000
s_mov_b32 s35,0x20000
s_mov_b32 s36,s6
s_and_b32 s37,s7,0xffff
s_mov_b32 s38,0x400000
s_mov_b32 s39,0x20000
v_lshrrev_b32 v5,2,v3
v_lshl_add_u32 v5,v4,2,v5
v_and_b32 v6,3,v3
v_lshlrev_b32 v6,3,v6
v_lshl_add_u32 v6,v5,8,v6
v_and_b32 v5,7,v5
v_xor_b32 v5,s67,v5
v_lshl_add_u32 v12,v5,5,v6
v_xor_b32 v13,32,v12
v_and_b32 v5,15,v1
v_and_b32 v6,3,v4
v_lshlrev_b32 v6,1,v6
v_xor_b32 v5,v5,v6
v_mul_u32_u24 v6,2048,v4
v_xor_b32 v7,0,v5
v_lshl_add_u32 v8,v7,4,v6
v_xor_b32 v7,8,v5
v_lshl_add_u32 v9,v7,4,v6
s_mul_i32 s74,s50,131072
s_add_u32 s74,s74,s66
s_lshl_b32 s75,s50,14
s_mul_i32 s76,s50,65536
s_add_u32 s76,s76,s66
s_lshl_b32 s77,s50,13
s_add_u32 s64,s74,0
s_add_u32 m0,s75,0
s_nop 0
buffer_load_dwordx4 v8,s[32:35],s64 offen  lds
s_add_u32 s64,s74,8192
s_add_u32 m0,s75,1024
s_nop 0
buffer_load_dwordx4 v9,s[32:35],s64 offen  lds
s_add_u32 s64,s74,16384
s_add_u32 m0,s75,2048
s_nop 0
buffer_load_dwordx4 v8,s[32:35],s64 offen  lds
s_add_u32 s64,s74,24576
s_add_u32 m0,s75,3072
s_nop 0
buffer_load_dwordx4 v9,s[32:35],s64 offen  lds
s_add_u32 s64,s74,32768
s_add_u32 m0,s75,4096
s_nop 0
buffer_load_dwordx4 v8,s[32:35],s64 offen  lds
s_add_u32 s64,s74,40960
s_add_u32 m0,s75,5120
s_nop 0
buffer_load_dwordx4 v9,s[32:35],s64 offen  lds
s_add_u32 s64,s74,49152
s_add_u32 m0,s75,6144
s_nop 0
buffer_load_dwordx4 v8,s[32:35],s64 offen  lds
s_add_u32 s64,s74,57344
s_add_u32 m0,s75,7168
s_nop 0
buffer_load_dwordx4 v9,s[32:35],s64 offen  lds
s_add_u32 s64,s74,65536
s_add_u32 m0,s75,8192
s_nop 0
buffer_load_dwordx4 v8,s[32:35],s64 offen  lds
s_add_u32 s64,s74,73728
s_add_u32 m0,s75,9216
s_nop 0
buffer_load_dwordx4 v9,s[32:35],s64 offen  lds
s_add_u32 s64,s74,81920
s_add_u32 m0,s75,10240
s_nop 0
buffer_load_dwordx4 v8,s[32:35],s64 offen  lds
s_add_u32 s64,s74,90112
s_add_u32 m0,s75,11264
s_nop 0
buffer_load_dwordx4 v9,s[32:35],s64 offen  lds
s_add_u32 s64,s74,98304
s_add_u32 m0,s75,12288
s_nop 0
buffer_load_dwordx4 v8,s[32:35],s64 offen  lds
s_add_u32 s64,s74,106496
s_add_u32 m0,s75,13312
s_nop 0
buffer_load_dwordx4 v9,s[32:35],s64 offen  lds
s_add_u32 s64,s74,114688
s_add_u32 m0,s75,14336
s_nop 0
buffer_load_dwordx4 v8,s[32:35],s64 offen  lds
s_add_u32 s64,s74,122880
s_add_u32 m0,s75,15360
s_nop 0
buffer_load_dwordx4 v9,s[32:35],s64 offen  lds
s_add_u32 s64,s74,524288
s_add_u32 m0,s75,65536
s_nop 0
buffer_load_dwordx4 v8,s[32:35],s64 offen  lds
s_add_u32 s64,s74,532480
s_add_u32 m0,s75,66560
s_nop 0
buffer_load_dwordx4 v9,s[32:35],s64 offen  lds
s_add_u32 s64,s74,540672
s_add_u32 m0,s75,67584
s_nop 0
buffer_load_dwordx4 v8,s[32:35],s64 offen  lds
s_add_u32 s64,s74,548864
s_add_u32 m0,s75,68608
s_nop 0
buffer_load_dwordx4 v9,s[32:35],s64 offen  lds
s_add_u32 s64,s74,557056
s_add_u32 m0,s75,69632
s_nop 0
buffer_load_dwordx4 v8,s[32:35],s64 offen  lds
s_add_u32 s64,s74,565248
s_add_u32 m0,s75,70656
s_nop 0
buffer_load_dwordx4 v9,s[32:35],s64 offen  lds
s_add_u32 s64,s74,573440
s_add_u32 m0,s75,71680
s_nop 0
buffer_load_dwordx4 v8,s[32:35],s64 offen  lds
s_add_u32 s64,s74,581632
s_add_u32 m0,s75,72704
s_nop 0
buffer_load_dwordx4 v9,s[32:35],s64 offen  lds
s_add_u32 s64,s74,589824
s_add_u32 m0,s75,73728
s_nop 0
buffer_load_dwordx4 v8,s[32:35],s64 offen  lds
s_add_u32 s64,s74,598016
s_add_u32 m0,s75,74752
s_nop 0
buffer_load_dwordx4 v9,s[32:35],s64 offen  lds
s_add_u32 s64,s74,606208
s_add_u32 m0,s75,75776
s_nop 0
buffer_load_dwordx4 v8,s[32:35],s64 offen  lds
s_add_u32 s64,s74,614400
s_add_u32 m0,s75,76800
s_nop 0
buffer_load_dwordx4 v9,s[32:35],s64 offen  lds
s_add_u32 s64,s74,622592
s_add_u32 m0,s75,77824
s_nop 0
buffer_load_dwordx4 v8,s[32:35],s64 offen  lds
s_add_u32 s64,s74,630784
s_add_u32 m0,s75,78848
s_nop 0
buffer_load_dwordx4 v9,s[32:35],s64 offen  lds
s_add_u32 s64,s74,638976
s_add_u32 m0,s75,79872
s_nop 0
buffer_load_dwordx4 v8,s[32:35],s64 offen  lds
s_add_u32 s64,s74,647168
s_add_u32 m0,s75,80896
s_nop 0
buffer_load_dwordx4 v9,s[32:35],s64 offen  lds
s_waitcnt vmcnt(16)
s_barrier
ds_read_b64_tr_b16 a[0:1],v12 offset:0
ds_read_b64_tr_b16 a[128:129],v13 offset:0
ds_read_b64_tr_b16 a[2:3],v12 offset:4096
ds_read_b64_tr_b16 a[130:131],v13 offset:4096
ds_read_b64_tr_b16 a[4:5],v12 offset:8192
ds_read_b64_tr_b16 a[132:133],v13 offset:8192
ds_read_b64_tr_b16 a[6:7],v12 offset:12288
ds_read_b64_tr_b16 a[134:135],v13 offset:12288
s_waitcnt lgkmcnt(4)
ds_read_b64_tr_b16 a[8:9],v12 offset:16384
ds_read_b64_tr_b16 a[136:137],v13 offset:16384
ds_read_b64_tr_b16 a[10:11],v12 offset:20480
ds_read_b64_tr_b16 a[138:139],v13 offset:20480
ds_read_b64_tr_b16 a[12:13],v12 offset:24576
ds_read_b64_tr_b16 a[140:141],v13 offset:24576
ds_read_b64_tr_b16 a[14:15],v12 offset:28672
ds_read_b64_tr_b16 a[142:143],v13 offset:28672
s_waitcnt lgkmcnt(4)
ds_read_b64_tr_b16 a[16:17],v12 offset:32768
ds_read_b64_tr_b16 a[144:145],v13 offset:32768
ds_read_b64_tr_b16 a[18:19],v12 offset:36864
ds_read_b64_tr_b16 a[146:147],v13 offset:36864
ds_read_b64_tr_b16 a[20:21],v12 offset:40960
ds_read_b64_tr_b16 a[148:149],v13 offset:40960
ds_read_b64_tr_b16 a[22:23],v12 offset:45056
ds_read_b64_tr_b16 a[150:151],v13 offset:45056
s_waitcnt lgkmcnt(4)
ds_read_b64_tr_b16 a[24:25],v12 offset:49152
ds_read_b64_tr_b16 a[152:153],v13 offset:49152
ds_read_b64_tr_b16 a[26:27],v12 offset:53248
ds_read_b64_tr_b16 a[154:155],v13 offset:53248
ds_read_b64_tr_b16 a[28:29],v12 offset:57344
ds_read_b64_tr_b16 a[156:157],v13 offset:57344
ds_read_b64_tr_b16 a[30:31],v12 offset:61440
ds_read_b64_tr_b16 a[158:159],v13 offset:61440
s_waitcnt lgkmcnt(4)
v_xor_b32 v12,0x10000,v12
v_xor_b32 v13,0x10000,v13
s_waitcnt lgkmcnt(0)
s_barrier
s_add_u32 s64,s74,1048576
s_add_u32 m0,s75,0
s_nop 0
buffer_load_dwordx4 v8,s[32:35],s64 offen  lds
s_add_u32 s64,s74,1056768
s_add_u32 m0,s75,1024
s_nop 0
buffer_load_dwordx4 v9,s[32:35],s64 offen  lds
s_add_u32 s64,s74,1064960
s_add_u32 m0,s75,2048
s_nop 0
buffer_load_dwordx4 v8,s[32:35],s64 offen  lds
s_add_u32 s64,s74,1073152
s_add_u32 m0,s75,3072
s_nop 0
buffer_load_dwordx4 v9,s[32:35],s64 offen  lds
s_add_u32 s64,s74,1081344
s_add_u32 m0,s75,4096
s_nop 0
buffer_load_dwordx4 v8,s[32:35],s64 offen  lds
s_add_u32 s64,s74,1089536
s_add_u32 m0,s75,5120
s_nop 0
buffer_load_dwordx4 v9,s[32:35],s64 offen  lds
s_add_u32 s64,s74,1097728
s_add_u32 m0,s75,6144
s_nop 0
buffer_load_dwordx4 v8,s[32:35],s64 offen  lds
s_add_u32 s64,s74,1105920
s_add_u32 m0,s75,7168
s_nop 0
buffer_load_dwordx4 v9,s[32:35],s64 offen  lds
s_add_u32 s64,s74,1114112
s_add_u32 m0,s75,8192
s_nop 0
buffer_load_dwordx4 v8,s[32:35],s64 offen  lds
s_add_u32 s64,s74,1122304
s_add_u32 m0,s75,9216
s_nop 0
buffer_load_dwordx4 v9,s[32:35],s64 offen  lds
s_add_u32 s64,s74,1130496
s_add_u32 m0,s75,10240
s_nop 0
buffer_load_dwordx4 v8,s[32:35],s64 offen  lds
s_add_u32 s64,s74,1138688
s_add_u32 m0,s75,11264
s_nop 0
buffer_load_dwordx4 v9,s[32:35],s64 offen  lds
s_add_u32 s64,s74,1146880
s_add_u32 m0,s75,12288
s_nop 0
buffer_load_dwordx4 v8,s[32:35],s64 offen  lds
s_add_u32 s64,s74,1155072
s_add_u32 m0,s75,13312
s_nop 0
buffer_load_dwordx4 v9,s[32:35],s64 offen  lds
s_add_u32 s64,s74,1163264
s_add_u32 m0,s75,14336
s_nop 0
buffer_load_dwordx4 v8,s[32:35],s64 offen  lds
s_add_u32 s64,s74,1171456
s_add_u32 m0,s75,15360
s_nop 0
buffer_load_dwordx4 v9,s[32:35],s64 offen  lds
s_waitcnt vmcnt(16)
s_barrier
ds_read_b64_tr_b16 a[32:33],v12 offset:0
ds_read_b64_tr_b16 a[160:161],v13 offset:0
ds_read_b64_tr_b16 a[34:35],v12 offset:4096
ds_read_b64_tr_b16 a[162:163],v13 offset:4096
ds_read_b64_tr_b16 a[36:37],v12 offset:8192
ds_read_b64_tr_b16 a[164:165],v13 offset:8192
ds_read_b64_tr_b16 a[38:39],v12 offset:12288
ds_read_b64_tr_b16 a[166:167],v13 offset:12288
s_waitcnt lgkmcnt(4)
ds_read_b64_tr_b16 a[40:41],v12 offset:16384
ds_read_b64_tr_b16 a[168:169],v13 offset:16384
ds_read_b64_tr_b16 a[42:43],v12 offset:20480
ds_read_b64_tr_b16 a[170:171],v13 offset:20480
ds_read_b64_tr_b16 a[44:45],v12 offset:24576
ds_read_b64_tr_b16 a[172:173],v13 offset:24576
ds_read_b64_tr_b16 a[46:47],v12 offset:28672
ds_read_b64_tr_b16 a[174:175],v13 offset:28672
s_waitcnt lgkmcnt(4)
ds_read_b64_tr_b16 a[48:49],v12 offset:32768
ds_read_b64_tr_b16 a[176:177],v13 offset:32768
ds_read_b64_tr_b16 a[50:51],v12 offset:36864
ds_read_b64_tr_b16 a[178:179],v13 offset:36864
ds_read_b64_tr_b16 a[52:53],v12 offset:40960
ds_read_b64_tr_b16 a[180:181],v13 offset:40960
ds_read_b64_tr_b16 a[54:55],v12 offset:45056
ds_read_b64_tr_b16 a[182:183],v13 offset:45056
s_waitcnt lgkmcnt(4)
ds_read_b64_tr_b16 a[56:57],v12 offset:49152
ds_read_b64_tr_b16 a[184:185],v13 offset:49152
ds_read_b64_tr_b16 a[58:59],v12 offset:53248
ds_read_b64_tr_b16 a[186:187],v13 offset:53248
ds_read_b64_tr_b16 a[60:61],v12 offset:57344
ds_read_b64_tr_b16 a[188:189],v13 offset:57344
ds_read_b64_tr_b16 a[62:63],v12 offset:61440
ds_read_b64_tr_b16 a[190:191],v13 offset:61440
s_waitcnt lgkmcnt(4)
v_xor_b32 v12,0x10000,v12
v_xor_b32 v13,0x10000,v13
s_waitcnt lgkmcnt(0)
s_barrier
s_add_u32 s64,s74,1572864
s_add_u32 m0,s75,65536
s_nop 0
buffer_load_dwordx4 v8,s[32:35],s64 offen  lds
s_add_u32 s64,s74,1581056
s_add_u32 m0,s75,66560
s_nop 0
buffer_load_dwordx4 v9,s[32:35],s64 offen  lds
s_add_u32 s64,s74,1589248
s_add_u32 m0,s75,67584
s_nop 0
buffer_load_dwordx4 v8,s[32:35],s64 offen  lds
s_add_u32 s64,s74,1597440
s_add_u32 m0,s75,68608
s_nop 0
buffer_load_dwordx4 v9,s[32:35],s64 offen  lds
s_add_u32 s64,s74,1605632
s_add_u32 m0,s75,69632
s_nop 0
buffer_load_dwordx4 v8,s[32:35],s64 offen  lds
s_add_u32 s64,s74,1613824
s_add_u32 m0,s75,70656
s_nop 0
buffer_load_dwordx4 v9,s[32:35],s64 offen  lds
s_add_u32 s64,s74,1622016
s_add_u32 m0,s75,71680
s_nop 0
buffer_load_dwordx4 v8,s[32:35],s64 offen  lds
s_add_u32 s64,s74,1630208
s_add_u32 m0,s75,72704
s_nop 0
buffer_load_dwordx4 v9,s[32:35],s64 offen  lds
s_add_u32 s64,s74,1638400
s_add_u32 m0,s75,73728
s_nop 0
buffer_load_dwordx4 v8,s[32:35],s64 offen  lds
s_add_u32 s64,s74,1646592
s_add_u32 m0,s75,74752
s_nop 0
buffer_load_dwordx4 v9,s[32:35],s64 offen  lds
s_add_u32 s64,s74,1654784
s_add_u32 m0,s75,75776
s_nop 0
buffer_load_dwordx4 v8,s[32:35],s64 offen  lds
s_add_u32 s64,s74,1662976
s_add_u32 m0,s75,76800
s_nop 0
buffer_load_dwordx4 v9,s[32:35],s64 offen  lds
s_add_u32 s64,s74,1671168
s_add_u32 m0,s75,77824
s_nop 0
buffer_load_dwordx4 v8,s[32:35],s64 offen  lds
s_add_u32 s64,s74,1679360
s_add_u32 m0,s75,78848
s_nop 0
buffer_load_dwordx4 v9,s[32:35],s64 offen  lds
s_add_u32 s64,s74,1687552
s_add_u32 m0,s75,79872
s_nop 0
buffer_load_dwordx4 v8,s[32:35],s64 offen  lds
s_add_u32 s64,s74,1695744
s_add_u32 m0,s75,80896
s_nop 0
buffer_load_dwordx4 v9,s[32:35],s64 offen  lds
s_waitcnt vmcnt(16)
s_barrier
ds_read_b64_tr_b16 a[64:65],v12 offset:0
ds_read_b64_tr_b16 a[192:193],v13 offset:0
ds_read_b64_tr_b16 a[66:67],v12 offset:4096
ds_read_b64_tr_b16 a[194:195],v13 offset:4096
ds_read_b64_tr_b16 a[68:69],v12 offset:8192
ds_read_b64_tr_b16 a[196:197],v13 offset:8192
ds_read_b64_tr_b16 a[70:71],v12 offset:12288
ds_read_b64_tr_b16 a[198:199],v13 offset:12288
s_waitcnt lgkmcnt(4)
ds_read_b64_tr_b16 a[72:73],v12 offset:16384
ds_read_b64_tr_b16 a[200:201],v13 offset:16384
ds_read_b64_tr_b16 a[74:75],v12 offset:20480
ds_read_b64_tr_b16 a[202:203],v13 offset:20480
ds_read_b64_tr_b16 a[76:77],v12 offset:24576
ds_read_b64_tr_b16 a[204:205],v13 offset:24576
ds_read_b64_tr_b16 a[78:79],v12 offset:28672
ds_read_b64_tr_b16 a[206:207],v13 offset:28672
s_waitcnt lgkmcnt(4)
ds_read_b64_tr_b16 a[80:81],v12 offset:32768
ds_read_b64_tr_b16 a[208:209],v13 offset:32768
ds_read_b64_tr_b16 a[82:83],v12 offset:36864
ds_read_b64_tr_b16 a[210:211],v13 offset:36864
ds_read_b64_tr_b16 a[84:85],v12 offset:40960
ds_read_b64_tr_b16 a[212:213],v13 offset:40960
ds_read_b64_tr_b16 a[86:87],v12 offset:45056
ds_read_b64_tr_b16 a[214:215],v13 offset:45056
s_waitcnt lgkmcnt(4)
ds_read_b64_tr_b16 a[88:89],v12 offset:49152
ds_read_b64_tr_b16 a[216:217],v13 offset:49152
ds_read_b64_tr_b16 a[90:91],v12 offset:53248
ds_read_b64_tr_b16 a[218:219],v13 offset:53248
ds_read_b64_tr_b16 a[92:93],v12 offset:57344
ds_read_b64_tr_b16 a[220:221],v13 offset:57344
ds_read_b64_tr_b16 a[94:95],v12 offset:61440
ds_read_b64_tr_b16 a[222:223],v13 offset:61440
s_waitcnt lgkmcnt(4)
v_xor_b32 v12,0x10000,v12
v_xor_b32 v13,0x10000,v13
s_waitcnt lgkmcnt(0)
s_barrier
s_waitcnt vmcnt(0)
s_barrier
ds_read_b64_tr_b16 a[96:97],v12 offset:0
ds_read_b64_tr_b16 a[224:225],v13 offset:0
ds_read_b64_tr_b16 a[98:99],v12 offset:4096
ds_read_b64_tr_b16 a[226:227],v13 offset:4096
ds_read_b64_tr_b16 a[100:101],v12 offset:8192
ds_read_b64_tr_b16 a[228:229],v13 offset:8192
ds_read_b64_tr_b16 a[102:103],v12 offset:12288
ds_read_b64_tr_b16 a[230:231],v13 offset:12288
s_waitcnt lgkmcnt(4)
ds_read_b64_tr_b16 a[104:105],v12 offset:16384
ds_read_b64_tr_b16 a[232:233],v13 offset:16384
ds_read_b64_tr_b16 a[106:107],v12 offset:20480
ds_read_b64_tr_b16 a[234:235],v13 offset:20480
ds_read_b64_tr_b16 a[108:109],v12 offset:24576
ds_read_b64_tr_b16 a[236:237],v13 offset:24576
ds_read_b64_tr_b16 a[110:111],v12 offset:28672
ds_read_b64_tr_b16 a[238:239],v13 offset:28672
s_waitcnt lgkmcnt(4)
ds_read_b64_tr_b16 a[112:113],v12 offset:32768
ds_read_b64_tr_b16 a[240:241],v13 offset:32768
ds_read_b64_tr_b16 a[114:115],v12 offset:36864
ds_read_b64_tr_b16 a[242:243],v13 offset:36864
ds_read_b64_tr_b16 a[116:117],v12 offset:40960
ds_read_b64_tr_b16 a[244:245],v13 offset:40960
ds_read_b64_tr_b16 a[118:119],v12 offset:45056
ds_read_b64_tr_b16 a[246:247],v13 offset:45056
s_waitcnt lgkmcnt(4)
ds_read_b64_tr_b16 a[120:121],v12 offset:49152
ds_read_b64_tr_b16 a[248:249],v13 offset:49152
ds_read_b64_tr_b16 a[122:123],v12 offset:53248
ds_read_b64_tr_b16 a[250:251],v13 offset:53248
ds_read_b64_tr_b16 a[124:125],v12 offset:57344
ds_read_b64_tr_b16 a[252:253],v13 offset:57344
ds_read_b64_tr_b16 a[126:127],v12 offset:61440
ds_read_b64_tr_b16 a[254:255],v13 offset:61440
s_waitcnt lgkmcnt(4)
v_xor_b32 v12,0x10000,v12
v_xor_b32 v13,0x10000,v13
s_waitcnt lgkmcnt(0)
s_barrier
v_and_b32 v21,1,v1
v_mul_u32_u24 v21,896,v21
s_mov_b32 s65,21052032
s_mov_b32 s66,1792
pl_218:
buffer_load_dword v22,v21,s[20:23],s65 offen sc1
s_waitcnt vmcnt(0)
v_cmp_gt_u32 vcc,s66,v22
s_cbranch_vccz pok_219
s_sleep 1
s_sub_u32 s90,s90,1
s_cmp_gt_i32 s90,0
s_cbranch_scc1 pl_218
pok_219:
s_lshr_b32 s43,s41,1
s_and_b32 s48,s41,1
s_lshl_b32 s64,s42,7
s_lshl_b32 s65,s50,5
s_add_u32 s64,s64,s65
s_lshl_b32 s65,s48,4
s_add_u32 s64,s64,s65
v_lshl_add_u32 v5,v4,2,s64
v_lshlrev_b32 v6,2,v5
s_mov_b32 s64,8192
buffer_load_dwordx4 v[132:135],v6,s[20:23],s64 offen sc1
v_lshlrev_b32 v5,1,v5
s_lshl_b32 s64,s43,10
v_add_u32 v17,s64,v16
v_xor_b32 v18,1024,v17
s_lshl_b32 s64,s59,14
s_lshl_b32 s65,s50,12
s_add_u32 s64,s64,s65
s_add_u32 s64,s64,17825792
v_add_u32 v26,s64,v16
s_lshl_b32 s64,s42,14
s_add_u32 s64,s64,s65
s_add_u32 s64,s64,17825792
v_add_u32 v25,s64,v16
s_xor_b32 s86,s41,1
s_xor_b32 s87,s41,2
s_xor_b32 s88,s41,3
s_lshl_b32 s86,s86,17
s_lshl_b32 s87,s87,17
s_lshl_b32 s88,s88,17
v_and_b32 v21,7,v1
v_lshlrev_b32 v21,2,v21
s_lshl_b32 s74,s41,7
s_add_u32 s74,s74,s63
s_add_u32 s74,s74,1024
s_mul_i32 s75,s41,131072
s_add_u32 s75,s75,524288
s_lshl_b32 s64,s50,1
s_add_u32 s64,s64,s42
s_and_b32 s64,s64,7
s_lshl_b32 s64,s64,14
s_add_u32 s64,s64,s75
v_lshl_add_u32 v2,v1,7,s64
s_lshl_b32 s76,s50,11
s_add_u32 s76,s76,s75
s_lshr_b32 s64,s50,1
s_lshl_b32 s64,s64,14
s_add_u32 s75,s75,s64
s_and_b32 s64,s50,1
s_lshl_b32 s64,s64,12
s_add_u32 s75,s75,s64
s_lshl_b32 s72,s50,12
s_lshl_b32 s49,s50,11
s_lshl_b32 s73,s59,2
s_add_u32 s73,s73,s63
s_add_u32 s73,s73,2048
v_lshrrev_b32 v6,2,v3
v_and_b32 v7,3,v3
v_lshl_add_u32 v6,v6,1,s43
v_lshl_add_u32 v7,v7,11,v5
v_lshl_add_u32 v20,v6,13,v7
v_lshl_add_u32 v19,v6,14,v7
v_add_u32 v19,1048576,v19
skl_220:
s_add_u32 s64,s79,0
s_lshl_b32 s70,s64,21
s_lshl_b32 s64,s64,13
s_and_b32 s64,s64,0x2000
s_xor_b32 s64,s64,s62
s_add_u32 s70,s70,s64
s_add_u32 s70,s70,29360128
s_add_u32 s64,s79,1
s_lshl_b32 s89,s64,21
s_lshl_b32 s64,s64,13
s_and_b32 s64,s64,0x2000
s_xor_b32 s64,s64,s62
s_add_u32 s89,s89,s64
s_add_u32 s89,s89,29360128
s_and_b32 s77,s79,1
s_lshl_b32 s77,s77,19
s_lshl_b32 s78,s79,16
s_xor_b32 s91,s72,0x10000
s_xor_b32 s92,s49,0x10000
s_cmp_lg_u32 s83,0
s_cbranch_scc1 pre_221
v_cmp_gt_u32 vcc,s71,v29
s_cbranch_vccz nopoll_222
pl_223:
buffer_load_dword v22,v21,s[20:23],s74 offen sc1
s_waitcnt vmcnt(0)
v_cmp_gt_u32 vcc,s71,v22
s_cbranch_vccz pok_224
s_sleep 1
s_sub_u32 s90,s90,1
s_cmp_gt_i32 s90,0
s_cbranch_scc1 pl_223
pok_224:
v_mov_b32 v29,v22
nopoll_222:
s_add_u32 m0,s72,0
s_add_u32 s65,s70,s75
s_add_u32 s65,s65,0
buffer_load_dwordx4 v16,s[20:23],s65 offen offset:0 sc1 lds
buffer_load_dwordx4 v16,s[20:23],s65 offen offset:1024 sc1 lds
buffer_load_dwordx4 v16,s[20:23],s65 offen offset:2048 sc1 lds
buffer_load_dwordx4 v16,s[20:23],s65 offen offset:3072 sc1 lds
s_add_u32 m0,s72,16384
s_add_u32 s65,s70,s75
s_add_u32 s65,s65,32768
buffer_load_dwordx4 v16,s[20:23],s65 offen offset:0 sc1 lds
buffer_load_dwordx4 v16,s[20:23],s65 offen offset:1024 sc1 lds
buffer_load_dwordx4 v16,s[20:23],s65 offen offset:2048 sc1 lds
buffer_load_dwordx4 v16,s[20:23],s65 offen offset:3072 sc1 lds
s_add_u32 m0,s72,32768
s_add_u32 s65,s70,s75
s_add_u32 s65,s65,65536
buffer_load_dwordx4 v16,s[20:23],s65 offen offset:0 sc1 lds
buffer_load_dwordx4 v16,s[20:23],s65 offen offset:1024 sc1 lds
buffer_load_dwordx4 v16,s[20:23],s65 offen offset:2048 sc1 lds
buffer_load_dwordx4 v16,s[20:23],s65 offen offset:3072 sc1 lds
s_add_u32 m0,s72,49152
s_add_u32 s65,s70,s75
s_add_u32 s65,s65,98304
buffer_load_dwordx4 v16,s[20:23],s65 offen offset:0 sc1 lds
buffer_load_dwordx4 v16,s[20:23],s65 offen offset:1024 sc1 lds
buffer_load_dwordx4 v16,s[20:23],s65 offen offset:2048 sc1 lds
buffer_load_dwordx4 v16,s[20:23],s65 offen offset:3072 sc1 lds
pre_221:
s_add_u32 s64,s71,1
v_cmp_gt_u32 vcc,s64,v29
s_cmp_eq_u64 vcc,0
s_cselect_b32 s83,1,0
s_cselect_b32 s89,s89,0x7fff0000
s_waitcnt vmcnt(12)
s_barrier
ds_read_b128 v[32:35],v17 offset:0
ds_read_b128 v[36:39],v18 offset:0
ds_read_b128 v[40:43],v17 offset:2048
s_waitcnt lgkmcnt(2)
v_mfma_f32_16x16x32_bf16 v[64:67],a[0:3],v[32:35],0
ds_read_b128 v[44:47],v18 offset:2048
v_mfma_f32_16x16x32_bf16 v[72:75],a[128:131],v[32:35],0
s_waitcnt lgkmcnt(2)
v_min_u32 v27,v32,v36
v_mfma_f32_16x16x32_bf16 v[68:71],a[0:3],v[36:39],0
ds_read_b128 v[32:35],v17 offset:4096
s_add_u32 m0,s91,0
s_add_u32 s65,s89,s75
s_add_u32 s65,s65,0
v_mfma_f32_16x16x32_bf16 v[76:79],a[128:131],v[36:39],0
s_waitcnt lgkmcnt(2)
v_mfma_f32_16x16x32_bf16 v[64:67],a[4:7],v[40:43],v[64:67]
ds_read_b128 v[36:39],v18 offset:4096
v_mfma_f32_16x16x32_bf16 v[72:75],a[132:135],v[40:43],v[72:75]
s_waitcnt lgkmcnt(2)
v_min3_u32 v27,v27,v40,v44
v_mfma_f32_16x16x32_bf16 v[68:71],a[4:7],v[44:47],v[68:71]
ds_read_b128 v[40:43],v17 offset:6144
buffer_load_dwordx4 v16,s[20:23],s65 offen offset:0 sc1 lds
v_mfma_f32_16x16x32_bf16 v[76:79],a[132:135],v[44:47],v[76:79]
s_waitcnt lgkmcnt(2)
v_mfma_f32_16x16x32_bf16 v[64:67],a[8:11],v[32:35],v[64:67]
ds_read_b128 v[44:47],v18 offset:6144
v_mfma_f32_16x16x32_bf16 v[72:75],a[136:139],v[32:35],v[72:75]
s_waitcnt lgkmcnt(2)
v_min3_u32 v27,v27,v32,v36
v_mfma_f32_16x16x32_bf16 v[68:71],a[8:11],v[36:39],v[68:71]
ds_read_b128 v[32:35],v17 offset:8192
v_mfma_f32_16x16x32_bf16 v[76:79],a[136:139],v[36:39],v[76:79]
buffer_load_dwordx4 v16,s[20:23],s65 offen offset:1024 sc1 lds
s_waitcnt lgkmcnt(2)
v_mfma_f32_16x16x32_bf16 v[64:67],a[12:15],v[40:43],v[64:67]
ds_read_b128 v[36:39],v18 offset:8192
v_mfma_f32_16x16x32_bf16 v[72:75],a[140:143],v[40:43],v[72:75]
s_waitcnt lgkmcnt(2)
v_min3_u32 v27,v27,v40,v44
v_mfma_f32_16x16x32_bf16 v[68:71],a[12:15],v[44:47],v[68:71]
ds_read_b128 v[40:43],v17 offset:10240
v_mfma_f32_16x16x32_bf16 v[76:79],a[140:143],v[44:47],v[76:79]
s_waitcnt lgkmcnt(2)
v_mfma_f32_16x16x32_bf16 v[64:67],a[16:19],v[32:35],v[64:67]
ds_read_b128 v[44:47],v18 offset:10240
buffer_load_dwordx4 v16,s[20:23],s65 offen offset:2048 sc1 lds
v_mfma_f32_16x16x32_bf16 v[72:75],a[144:147],v[32:35],v[72:75]
s_waitcnt lgkmcnt(2)
v_min3_u32 v27,v27,v32,v36
v_mfma_f32_16x16x32_bf16 v[68:71],a[16:19],v[36:39],v[68:71]
ds_read_b128 v[32:35],v17 offset:12288
v_mfma_f32_16x16x32_bf16 v[76:79],a[144:147],v[36:39],v[76:79]
s_waitcnt lgkmcnt(2)
v_mfma_f32_16x16x32_bf16 v[64:67],a[20:23],v[40:43],v[64:67]
ds_read_b128 v[36:39],v18 offset:12288
buffer_load_dwordx4 v16,s[20:23],s65 offen offset:3072 sc1 lds
v_mfma_f32_16x16x32_bf16 v[72:75],a[148:151],v[40:43],v[72:75]
s_waitcnt lgkmcnt(2)
v_min3_u32 v27,v27,v40,v44
v_mfma_f32_16x16x32_bf16 v[68:71],a[20:23],v[44:47],v[68:71]
ds_read_b128 v[40:43],v17 offset:14336
v_mfma_f32_16x16x32_bf16 v[76:79],a[148:151],v[44:47],v[76:79]
s_waitcnt lgkmcnt(2)
v_mfma_f32_16x16x32_bf16 v[64:67],a[24:27],v[32:35],v[64:67]
ds_read_b128 v[44:47],v18 offset:14336
v_mfma_f32_16x16x32_bf16 v[72:75],a[152:155],v[32:35],v[72:75]
s_add_u32 m0,s91,16384
s_add_u32 s65,s89,s75
s_add_u32 s65,s65,32768
s_waitcnt lgkmcnt(2)
v_min3_u32 v27,v27,v32,v36
v_mfma_f32_16x16x32_bf16 v[68:71],a[24:27],v[36:39],v[68:71]
s_waitcnt vmcnt(12)
s_barrier
ds_read_b128 v[32:35],v17 offset:16384
v_mfma_f32_16x16x32_bf16 v[76:79],a[152:155],v[36:39],v[76:79]
s_waitcnt lgkmcnt(2)
v_mfma_f32_16x16x32_bf16 v[64:67],a[28:31],v[40:43],v[64:67]
ds_read_b128 v[36:39],v18 offset:16384
v_mfma_f32_16x16x32_bf16 v[72:75],a[156:159],v[40:43],v[72:75]
s_waitcnt lgkmcnt(2)
v_min3_u32 v27,v27,v40,v44
v_mfma_f32_16x16x32_bf16 v[68:71],a[28:31],v[44:47],v[68:71]
ds_read_b128 v[40:43],v17 offset:18432
buffer_load_dwordx4 v16,s[20:23],s65 offen offset:0 sc1 lds
v_mfma_f32_16x16x32_bf16 v[76:79],a[156:159],v[44:47],v[76:79]
s_waitcnt lgkmcnt(2)
v_mfma_f32_16x16x32_bf16 v[64:67],a[32:35],v[32:35],v[64:67]
ds_read_b128 v[44:47],v18 offset:18432
v_mfma_f32_16x16x32_bf16 v[72:75],a[160:163],v[32:35],v[72:75]
s_waitcnt lgkmcnt(2)
v_min3_u32 v27,v27,v32,v36
v_mfma_f32_16x16x32_bf16 v[68:71],a[32:35],v[36:39],v[68:71]
ds_read_b128 v[32:35],v17 offset:20480
buffer_load_dwordx4 v16,s[20:23],s65 offen offset:1024 sc1 lds
v_mfma_f32_16x16x32_bf16 v[76:79],a[160:163],v[36:39],v[76:79]
s_waitcnt lgkmcnt(2)
v_mfma_f32_16x16x32_bf16 v[64:67],a[36:39],v[40:43],v[64:67]
ds_read_b128 v[36:39],v18 offset:20480
v_mfma_f32_16x16x32_bf16 v[72:75],a[164:167],v[40:43],v[72:75]
s_waitcnt lgkmcnt(2)
v_min3_u32 v27,v27,v40,v44
v_mfma_f32_16x16x32_bf16 v[68:71],a[36:39],v[44:47],v[68:71]
ds_read_b128 v[40:43],v17 offset:22528
v_mfma_f32_16x16x32_bf16 v[76:79],a[164:167],v[44:47],v[76:79]
buffer_load_dwordx4 v16,s[20:23],s65 offen offset:2048 sc1 lds
s_waitcnt lgkmcnt(2)
v_mfma_f32_16x16x32_bf16 v[64:67],a[40:43],v[32:35],v[64:67]
ds_read_b128 v[44:47],v18 offset:22528
v_mfma_f32_16x16x32_bf16 v[72:75],a[168:171],v[32:35],v[72:75]
s_waitcnt lgkmcnt(2)
v_min3_u32 v27,v27,v32,v36
v_mfma_f32_16x16x32_bf16 v[68:71],a[40:43],v[36:39],v[68:71]
ds_read_b128 v[32:35],v17 offset:24576
v_mfma_f32_16x16x32_bf16 v[76:79],a[168:171],v[36:39],v[76:79]
s_waitcnt lgkmcnt(2)
v_mfma_f32_16x16x32_bf16 v[64:67],a[44:47],v[40:43],v[64:67]
ds_read_b128 v[36:39],v18 offset:24576
buffer_load_dwordx4 v16,s[20:23],s65 offen offset:3072 sc1 lds
v_mfma_f32_16x16x32_bf16 v[72:75],a[172:175],v[40:43],v[72:75]
s_waitcnt lgkmcnt(2)
v_min3_u32 v27,v27,v40,v44
v_mfma_f32_16x16x32_bf16 v[68:71],a[44:47],v[44:47],v[68:71]
ds_read_b128 v[40:43],v17 offset:26624
v_mfma_f32_16x16x32_bf16 v[76:79],a[172:175],v[44:47],v[76:79]
s_waitcnt lgkmcnt(2)
v_mfma_f32_16x16x32_bf16 v[64:67],a[48:51],v[32:35],v[64:67]
ds_read_b128 v[44:47],v18 offset:26624
v_mfma_f32_16x16x32_bf16 v[72:75],a[176:179],v[32:35],v[72:75]
s_add_u32 m0,s91,32768
s_add_u32 s65,s89,s75
s_add_u32 s65,s65,65536
s_waitcnt lgkmcnt(2)
v_min3_u32 v27,v27,v32,v36
v_mfma_f32_16x16x32_bf16 v[68:71],a[48:51],v[36:39],v[68:71]
ds_read_b128 v[32:35],v17 offset:28672
v_mfma_f32_16x16x32_bf16 v[76:79],a[176:179],v[36:39],v[76:79]
s_waitcnt lgkmcnt(2)
v_mfma_f32_16x16x32_bf16 v[64:67],a[52:55],v[40:43],v[64:67]
ds_read_b128 v[36:39],v18 offset:28672
v_mfma_f32_16x16x32_bf16 v[72:75],a[180:183],v[40:43],v[72:75]
buffer_load_dwordx4 v16,s[20:23],s65 offen offset:0 sc1 lds
s_waitcnt lgkmcnt(2)
v_min3_u32 v27,v27,v40,v44
v_mfma_f32_16x16x32_bf16 v[68:71],a[52:55],v[44:47],v[68:71]
ds_read_b128 v[40:43],v17 offset:30720
v_mfma_f32_16x16x32_bf16 v[76:79],a[180:183],v[44:47],v[76:79]
s_waitcnt lgkmcnt(2)
v_mfma_f32_16x16x32_bf16 v[64:67],a[56:59],v[32:35],v[64:67]
ds_read_b128 v[44:47],v18 offset:30720
v_mfma_f32_16x16x32_bf16 v[72:75],a[184:187],v[32:35],v[72:75]
s_waitcnt lgkmcnt(2)
v_min3_u32 v27,v27,v32,v36
v_mfma_f32_16x16x32_bf16 v[68:71],a[56:59],v[36:39],v[68:71]
s_waitcnt vmcnt(13)
s_barrier
ds_read_b128 v[32:35],v17 offset:32768
buffer_load_dwordx4 v16,s[20:23],s65 offen offset:1024 sc1 lds
v_mfma_f32_16x16x32_bf16 v[76:79],a[184:187],v[36:39],v[76:79]
s_waitcnt lgkmcnt(2)
v_mfma_f32_16x16x32_bf16 v[64:67],a[60:63],v[40:43],v[64:67]
ds_read_b128 v[36:39],v18 offset:32768
v_mfma_f32_16x16x32_bf16 v[72:75],a[188:191],v[40:43],v[72:75]
s_waitcnt lgkmcnt(2)
v_min3_u32 v27,v27,v40,v44
v_mfma_f32_16x16x32_bf16 v[68:71],a[60:63],v[44:47],v[68:71]
ds_read_b128 v[40:43],v17 offset:34816
v_mfma_f32_16x16x32_bf16 v[76:79],a[188:191],v[44:47],v[76:79]
buffer_load_dwordx4 v16,s[20:23],s65 offen offset:2048 sc1 lds
s_waitcnt lgkmcnt(2)
v_mfma_f32_16x16x32_bf16 v[64:67],a[64:67],v[32:35],v[64:67]
ds_read_b128 v[44:47],v18 offset:34816
v_mfma_f32_16x16x32_bf16 v[72:75],a[192:195],v[32:35],v[72:75]
s_waitcnt lgkmcnt(2)
v_min3_u32 v27,v27,v32,v36
v_mfma_f32_16x16x32_bf16 v[68:71],a[64:67],v[36:39],v[68:71]
ds_read_b128 v[32:35],v17 offset:36864
v_mfma_f32_16x16x32_bf16 v[76:79],a[192:195],v[36:39],v[76:79]
buffer_load_dwordx4 v16,s[20:23],s65 offen offset:3072 sc1 lds
s_waitcnt lgkmcnt(2)
v_mfma_f32_16x16x32_bf16 v[64:67],a[68:71],v[40:43],v[64:67]
ds_read_b128 v[36:39],v18 offset:36864
v_mfma_f32_16x16x32_bf16 v[72:75],a[196:199],v[40:43],v[72:75]
s_waitcnt lgkmcnt(2)
v_min3_u32 v27,v27,v40,v44
v_mfma_f32_16x16x32_bf16 v[68:71],a[68:71],v[44:47],v[68:71]
ds_read_b128 v[40:43],v17 offset:38912
v_mfma_f32_16x16x32_bf16 v[76:79],a[196:199],v[44:47],v[76:79]
s_waitcnt lgkmcnt(2)
v_mfma_f32_16x16x32_bf16 v[64:67],a[72:75],v[32:35],v[64:67]
ds_read_b128 v[44:47],v18 offset:38912
s_add_u32 m0,s91,49152
s_add_u32 s65,s89,s75
s_add_u32 s65,s65,98304
v_mfma_f32_16x16x32_bf16 v[72:75],a[200:203],v[32:35],v[72:75]
s_waitcnt lgkmcnt(2)
v_min3_u32 v27,v27,v32,v36
v_mfma_f32_16x16x32_bf16 v[68:71],a[72:75],v[36:39],v[68:71]
ds_read_b128 v[32:35],v17 offset:40960
v_mfma_f32_16x16x32_bf16 v[76:79],a[200:203],v[36:39],v[76:79]
s_waitcnt lgkmcnt(2)
v_mfma_f32_16x16x32_bf16 v[64:67],a[76:79],v[40:43],v[64:67]
ds_read_b128 v[36:39],v18 offset:40960
v_mfma_f32_16x16x32_bf16 v[72:75],a[204:207],v[40:43],v[72:75]
buffer_load_dwordx4 v16,s[20:23],s65 offen offset:0 sc1 lds
s_waitcnt lgkmcnt(2)
v_min3_u32 v27,v27,v40,v44
v_mfma_f32_16x16x32_bf16 v[68:71],a[76:79],v[44:47],v[68:71]
ds_read_b128 v[40:43],v17 offset:43008
v_mfma_f32_16x16x32_bf16 v[76:79],a[204:207],v[44:47],v[76:79]
s_waitcnt lgkmcnt(2)
v_mfma_f32_16x16x32_bf16 v[64:67],a[80:83],v[32:35],v[64:67]
ds_read_b128 v[44:47],v18 offset:43008
v_mfma_f32_16x16x32_bf16 v[72:75],a[208:211],v[32:35],v[72:75]
buffer_load_dwordx4 v16,s[20:23],s65 offen offset:1024 sc1 lds
s_waitcnt lgkmcnt(2)
v_min3_u32 v27,v27,v32,v36
v_mfma_f32_16x16x32_bf16 v[68:71],a[80:83],v[36:39],v[68:71]
ds_read_b128 v[32:35],v17 offset:45056
v_mfma_f32_16x16x32_bf16 v[76:79],a[208:211],v[36:39],v[76:79]
s_waitcnt lgkmcnt(2)
v_mfma_f32_16x16x32_bf16 v[64:67],a[84:87],v[40:43],v[64:67]
ds_read_b128 v[36:39],v18 offset:45056
v_mfma_f32_16x16x32_bf16 v[72:75],a[212:215],v[40:43],v[72:75]
s_waitcnt lgkmcnt(2)
v_min3_u32 v27,v27,v40,v44
v_mfma_f32_16x16x32_bf16 v[68:71],a[84:87],v[44:47],v[68:71]
ds_read_b128 v[40:43],v17 offset:47104
buffer_load_dwordx4 v16,s[20:23],s65 offen offset:2048 sc1 lds
v_mfma_f32_16x16x32_bf16 v[76:79],a[212:215],v[44:47],v[76:79]
s_waitcnt lgkmcnt(2)
v_mfma_f32_16x16x32_bf16 v[64:67],a[88:91],v[32:35],v[64:67]
ds_read_b128 v[44:47],v18 offset:47104
v_mfma_f32_16x16x32_bf16 v[72:75],a[216:219],v[32:35],v[72:75]
s_waitcnt lgkmcnt(2)
v_min3_u32 v27,v27,v32,v36
v_mfma_f32_16x16x32_bf16 v[68:71],a[88:91],v[36:39],v[68:71]
s_waitcnt vmcnt(15)
s_barrier
ds_read_b128 v[32:35],v17 offset:49152
v_mfma_f32_16x16x32_bf16 v[76:79],a[216:219],v[36:39],v[76:79]
buffer_load_dwordx4 v16,s[20:23],s65 offen offset:3072 sc1 lds
s_waitcnt lgkmcnt(2)
v_mfma_f32_16x16x32_bf16 v[64:67],a[92:95],v[40:43],v[64:67]
ds_read_b128 v[36:39],v18 offset:49152
v_mfma_f32_16x16x32_bf16 v[72:75],a[220:223],v[40:43],v[72:75]
s_waitcnt lgkmcnt(2)
v_min3_u32 v27,v27,v40,v44
v_mfma_f32_16x16x32_bf16 v[68:71],a[92:95],v[44:47],v[68:71]
ds_read_b128 v[40:43],v17 offset:51200
v_mfma_f32_16x16x32_bf16 v[76:79],a[220:223],v[44:47],v[76:79]
s_waitcnt lgkmcnt(2)
v_mfma_f32_16x16x32_bf16 v[64:67],a[96:99],v[32:35],v[64:67]
ds_read_b128 v[44:47],v18 offset:51200
v_mfma_f32_16x16x32_bf16 v[72:75],a[224:227],v[32:35],v[72:75]
s_waitcnt lgkmcnt(2)
v_min3_u32 v27,v27,v32,v36
v_mfma_f32_16x16x32_bf16 v[68:71],a[96:99],v[36:39],v[68:71]
ds_read_b128 v[32:35],v17 offset:53248
v_mfma_f32_16x16x32_bf16 v[76:79],a[224:227],v[36:39],v[76:79]
s_waitcnt lgkmcnt(2)
v_mfma_f32_16x16x32_bf16 v[64:67],a[100:103],v[40:43],v[64:67]
ds_read_b128 v[36:39],v18 offset:53248
buffer_load_dwordx2 v[120:121],v20,s[36:39],s78 offen
v_mfma_f32_16x16x32_bf16 v[72:75],a[228:231],v[40:43],v[72:75]
s_waitcnt lgkmcnt(2)
v_min3_u32 v27,v27,v40,v44
v_mfma_f32_16x16x32_bf16 v[68:71],a[100:103],v[44:47],v[68:71]
ds_read_b128 v[40:43],v17 offset:55296
v_mfma_f32_16x16x32_bf16 v[76:79],a[228:231],v[44:47],v[76:79]
s_waitcnt lgkmcnt(2)
v_mfma_f32_16x16x32_bf16 v[64:67],a[104:107],v[32:35],v[64:67]
ds_read_b128 v[44:47],v18 offset:55296
v_mfma_f32_16x16x32_bf16 v[72:75],a[232:235],v[32:35],v[72:75]
s_waitcnt lgkmcnt(2)
v_min3_u32 v27,v27,v32,v36
v_mfma_f32_16x16x32_bf16 v[68:71],a[104:107],v[36:39],v[68:71]
ds_read_b128 v[32:35],v17 offset:57344
v_mfma_f32_16x16x32_bf16 v[76:79],a[232:235],v[36:39],v[76:79]
s_waitcnt lgkmcnt(2)
v_mfma_f32_16x16x32_bf16 v[64:67],a[108:111],v[40:43],v[64:67]
ds_read_b128 v[36:39],v18 offset:57344
v_mfma_f32_16x16x32_bf16 v[72:75],a[236:239],v[40:43],v[72:75]
s_waitcnt lgkmcnt(2)
v_min3_u32 v27,v27,v40,v44
v_mfma_f32_16x16x32_bf16 v[68:71],a[108:111],v[44:47],v[68:71]
ds_read_b128 v[40:43],v17 offset:59392
v_mfma_f32_16x16x32_bf16 v[76:79],a[236:239],v[44:47],v[76:79]
s_waitcnt lgkmcnt(2)
v_mfma_f32_16x16x32_bf16 v[64:67],a[112:115],v[32:35],v[64:67]
ds_read_b128 v[44:47],v18 offset:59392
v_mfma_f32_16x16x32_bf16 v[72:75],a[240:243],v[32:35],v[72:75]
s_waitcnt lgkmcnt(2)
v_min3_u32 v27,v27,v32,v36
v_mfma_f32_16x16x32_bf16 v[68:71],a[112:115],v[36:39],v[68:71]
ds_read_b128 v[32:35],v17 offset:61440
v_mfma_f32_16x16x32_bf16 v[76:79],a[240:243],v[36:39],v[76:79]
s_waitcnt lgkmcnt(2)
v_mfma_f32_16x16x32_bf16 v[64:67],a[116:119],v[40:43],v[64:67]
ds_read_b128 v[36:39],v18 offset:61440
v_mfma_f32_16x16x32_bf16 v[72:75],a[244:247],v[40:43],v[72:75]
s_waitcnt lgkmcnt(2)
v_min3_u32 v27,v27,v40,v44
v_mfma_f32_16x16x32_bf16 v[68:71],a[116:119],v[44:47],v[68:71]
ds_read_b128 v[40:43],v17 offset:63488
v_mfma_f32_16x16x32_bf16 v[76:79],a[244:247],v[44:47],v[76:79]
s_waitcnt lgkmcnt(2)
v_mfma_f32_16x16x32_bf16 v[64:67],a[120:123],v[32:35],v[64:67]
ds_read_b128 v[44:47],v18 offset:63488
v_mfma_f32_16x16x32_bf16 v[72:75],a[248:251],v[32:35],v[72:75]
s_waitcnt lgkmcnt(2)
v_min3_u32 v27,v27,v32,v36
v_mfma_f32_16x16x32_bf16 v[68:71],a[120:123],v[36:39],v[68:71]
v_mfma_f32_16x16x32_bf16 v[76:79],a[248:251],v[36:39],v[76:79]
s_waitcnt lgkmcnt(1)
v_mfma_f32_16x16x32_bf16 v[64:67],a[124:127],v[40:43],v[64:67]
v_mfma_f32_16x16x32_bf16 v[72:75],a[252:255],v[40:43],v[72:75]
s_waitcnt lgkmcnt(0)
v_min3_u32 v27,v27,v40,v44
v_mfma_f32_16x16x32_bf16 v[68:71],a[124:127],v[44:47],v[68:71]
v_mfma_f32_16x16x32_bf16 v[76:79],a[252:255],v[44:47],v[76:79]
v_cmp_eq_u32 vcc,0,v27
s_cbranch_vccnz retry_225
valid_226:
buffer_load_dword v29,v21,s[20:23],s74 offen sc1
v_xor_b32 v17,0x10000,v17
v_xor_b32 v18,0x10000,v18
s_mov_b32 s72,s91
s_mov_b32 s49,s92
v_max_u32 v72,1,v72
s_add_u32 s65,s77,s86
buffer_store_dwordx4 v[72:75],v25,s[24:27],s65 offen offset:1024
buffer_store_dwordx4 v[72:75],v25,s[28:31],s65 offen offset:1024 sc1
v_max_u32 v68,1,v68
s_add_u32 s65,s77,s87
buffer_store_dwordx4 v[68:71],v25,s[24:27],s65 offen offset:2048
buffer_store_dwordx4 v[68:71],v25,s[28:31],s65 offen offset:2048 sc1
v_max_u32 v76,1,v76
s_add_u32 s65,s77,s88
buffer_store_dwordx4 v[76:79],v25,s[24:27],s65 offen offset:3072
buffer_store_dwordx4 v[76:79],v25,s[28:31],s65 offen offset:3072 sc1
ip_227:
buffer_load_dwordx4 v[84:87],v26,s[20:23],s77 offen offset:1024 sc1
buffer_load_dwordx4 v[88:91],v26,s[20:23],s77 offen offset:2048 sc1
buffer_load_dwordx4 v[92:95],v26,s[20:23],s77 offen offset:3072 sc1
s_waitcnt vmcnt(0)
v_min3_u32 v22,v84,v88,v92
v_cmp_eq_u32 vcc,0,v22
s_cbranch_vccz ik_228
s_sub_u32 s90,s90,1
s_cmp_gt_i32 s90,0
s_cbranch_scc1 ip_227
ik_228:
v_pk_add_f32 v[80:81],v[64:65],v[84:85]
v_pk_add_f32 v[88:89],v[88:89],v[92:93]
v_pk_add_f32 v[82:83],v[66:67],v[86:87]
v_pk_add_f32 v[90:91],v[90:91],v[94:95]
v_pk_add_f32 v[80:81],v[80:81],v[88:89]
v_pk_add_f32 v[82:83],v[82:83],v[90:91]
v_lshlrev_b32 v84,16,v120
v_and_b32 v85,s80,v120
v_lshlrev_b32 v86,16,v121
v_and_b32 v87,s80,v121
v_pk_fma_f32 v[80:81],v[80:81],v[132:133],v[84:85]
v_pk_fma_f32 v[82:83],v[82:83],v[134:135],v[86:87]
v_cvt_pk_bf16_f32 v80,v80,v81
v_cvt_pk_bf16_f32 v81,v82,v83
v_max_u32 v80,1,v80
s_add_u32 s65,s70,4194304
buffer_store_dwordx2 v[80:81],v19,s[20:23],s70 offen sc1
buffer_store_dwordx2 v[128:129],v19,s[20:23],s65 offen sc1
buffer_store_dwordx4 v[128:131],v26,s[24:27],s77 offen offset:1024
buffer_store_dwordx4 v[128:131],v26,s[28:31],s77 offen offset:1024 sc1
buffer_store_dwordx4 v[128:131],v26,s[24:27],s77 offen offset:2048
buffer_store_dwordx4 v[128:131],v26,s[28:31],s77 offen offset:2048 sc1
buffer_store_dwordx4 v[128:131],v26,s[24:27],s77 offen offset:3072
buffer_store_dwordx4 v[128:131],v26,s[28:31],s77 offen offset:3072 sc1
s_add_u32 s79,s79,1
s_add_u32 s71,s71,1
s_cmp_lt_u32 s79,64
s_cbranch_scc1 skl_220
s_endpgm
retry_225:
s_sub_u32 s90,s90,1
s_cmp_lt_i32 s90,0
s_cbranch_scc1 valid_226
s_mov_b32 s83,1
v_mov_b32 v29,0
s_barrier
s_add_u32 m0,s72,0
s_add_u32 s65,s70,s75
s_add_u32 s65,s65,0
buffer_load_dwordx4 v16,s[20:23],s65 offen offset:0 sc1 lds
buffer_load_dwordx4 v16,s[20:23],s65 offen offset:1024 sc1 lds
buffer_load_dwordx4 v16,s[20:23],s65 offen offset:2048 sc1 lds
buffer_load_dwordx4 v16,s[20:23],s65 offen offset:3072 sc1 lds
s_add_u32 m0,s72,16384
s_add_u32 s65,s70,s75
s_add_u32 s65,s65,32768
buffer_load_dwordx4 v16,s[20:23],s65 offen offset:0 sc1 lds
buffer_load_dwordx4 v16,s[20:23],s65 offen offset:1024 sc1 lds
buffer_load_dwordx4 v16,s[20:23],s65 offen offset:2048 sc1 lds
buffer_load_dwordx4 v16,s[20:23],s65 offen offset:3072 sc1 lds
s_add_u32 m0,s72,32768
s_add_u32 s65,s70,s75
s_add_u32 s65,s65,65536
buffer_load_dwordx4 v16,s[20:23],s65 offen offset:0 sc1 lds
buffer_load_dwordx4 v16,s[20:23],s65 offen offset:1024 sc1 lds
buffer_load_dwordx4 v16,s[20:23],s65 offen offset:2048 sc1 lds
buffer_load_dwordx4 v16,s[20:23],s65 offen offset:3072 sc1 lds
s_add_u32 m0,s72,49152
s_add_u32 s65,s70,s75
s_add_u32 s65,s65,98304
buffer_load_dwordx4 v16,s[20:23],s65 offen offset:0 sc1 lds
buffer_load_dwordx4 v16,s[20:23],s65 offen offset:1024 sc1 lds
buffer_load_dwordx4 v16,s[20:23],s65 offen offset:2048 sc1 lds
buffer_load_dwordx4 v16,s[20:23],s65 offen offset:3072 sc1 lds
s_branch skl_220
r_w4_180:
s_load_dwordx2 s[4:5],s[0:1],88
s_load_dwordx2 s[6:7],s[0:1],112
s_lshr_b32 s41,s59,3
s_and_b32 s42,s59,7
s_mul_i32 s66,s41,1835008
s_lshl_b32 s64,s42,8
s_add_u32 s66,s66,s64
s_lshl_b32 s67,s50,1
s_and_b32 s64,s41,1
s_add_u32 s67,s67,s64
s_waitcnt lgkmcnt(0)
s_mov_b32 s32,s4
s_and_b32 s33,s5,0xffff
s_mov_b32 s34,0x700000
s_mov_b32 s35,0x20000
s_sub_u32 s36,s6,0x1000
s_subb_u32 s37,s7,0
s_and_b32 s37,s37,0xffff
s_mov_b32 s38,0x401000
s_mov_b32 s39,0x20000
v_lshrrev_b32 v5,2,v3
v_lshl_add_u32 v5,v4,2,v5
v_and_b32 v6,3,v3
v_lshlrev_b32 v6,3,v6
v_lshl_add_u32 v6,v5,8,v6
v_and_b32 v5,7,v5
v_xor_b32 v5,s67,v5
v_lshl_add_u32 v12,v5,5,v6
v_xor_b32 v13,32,v12
v_and_b32 v5,15,v1
v_and_b32 v6,3,v4
v_lshlrev_b32 v6,1,v6
v_xor_b32 v5,v5,v6
v_mul_u32_u24 v6,2048,v4
v_xor_b32 v7,0,v5
v_lshl_add_u32 v8,v7,4,v6
v_xor_b32 v7,8,v5
v_lshl_add_u32 v9,v7,4,v6
s_mul_i32 s74,s50,131072
s_add_u32 s74,s74,s66
s_lshl_b32 s75,s50,14
s_mul_i32 s76,s50,65536
s_add_u32 s76,s76,s66
s_lshl_b32 s77,s50,13
s_add_u32 s64,s74,0
s_add_u32 m0,s75,0
s_nop 0
buffer_load_dwordx4 v8,s[32:35],s64 offen  lds
s_add_u32 s64,s74,8192
s_add_u32 m0,s75,1024
s_nop 0
buffer_load_dwordx4 v9,s[32:35],s64 offen  lds
s_add_u32 s64,s74,16384
s_add_u32 m0,s75,2048
s_nop 0
buffer_load_dwordx4 v8,s[32:35],s64 offen  lds
s_add_u32 s64,s74,24576
s_add_u32 m0,s75,3072
s_nop 0
buffer_load_dwordx4 v9,s[32:35],s64 offen  lds
s_add_u32 s64,s74,32768
s_add_u32 m0,s75,4096
s_nop 0
buffer_load_dwordx4 v8,s[32:35],s64 offen  lds
s_add_u32 s64,s74,40960
s_add_u32 m0,s75,5120
s_nop 0
buffer_load_dwordx4 v9,s[32:35],s64 offen  lds
s_add_u32 s64,s74,49152
s_add_u32 m0,s75,6144
s_nop 0
buffer_load_dwordx4 v8,s[32:35],s64 offen  lds
s_add_u32 s64,s74,57344
s_add_u32 m0,s75,7168
s_nop 0
buffer_load_dwordx4 v9,s[32:35],s64 offen  lds
s_add_u32 s64,s74,65536
s_add_u32 m0,s75,8192
s_nop 0
buffer_load_dwordx4 v8,s[32:35],s64 offen  lds
s_add_u32 s64,s74,73728
s_add_u32 m0,s75,9216
s_nop 0
buffer_load_dwordx4 v9,s[32:35],s64 offen  lds
s_add_u32 s64,s74,81920
s_add_u32 m0,s75,10240
s_nop 0
buffer_load_dwordx4 v8,s[32:35],s64 offen  lds
s_add_u32 s64,s74,90112
s_add_u32 m0,s75,11264
s_nop 0
buffer_load_dwordx4 v9,s[32:35],s64 offen  lds
s_add_u32 s64,s74,98304
s_add_u32 m0,s75,12288
s_nop 0
buffer_load_dwordx4 v8,s[32:35],s64 offen  lds
s_add_u32 s64,s74,106496
s_add_u32 m0,s75,13312
s_nop 0
buffer_load_dwordx4 v9,s[32:35],s64 offen  lds
s_add_u32 s64,s74,114688
s_add_u32 m0,s75,14336
s_nop 0
buffer_load_dwordx4 v8,s[32:35],s64 offen  lds
s_add_u32 s64,s74,122880
s_add_u32 m0,s75,15360
s_nop 0
buffer_load_dwordx4 v9,s[32:35],s64 offen  lds
s_add_u32 s64,s74,524288
s_add_u32 m0,s75,65536
s_nop 0
buffer_load_dwordx4 v8,s[32:35],s64 offen  lds
s_add_u32 s64,s74,532480
s_add_u32 m0,s75,66560
s_nop 0
buffer_load_dwordx4 v9,s[32:35],s64 offen  lds
s_add_u32 s64,s74,540672
s_add_u32 m0,s75,67584
s_nop 0
buffer_load_dwordx4 v8,s[32:35],s64 offen  lds
s_add_u32 s64,s74,548864
s_add_u32 m0,s75,68608
s_nop 0
buffer_load_dwordx4 v9,s[32:35],s64 offen  lds
s_add_u32 s64,s74,557056
s_add_u32 m0,s75,69632
s_nop 0
buffer_load_dwordx4 v8,s[32:35],s64 offen  lds
s_add_u32 s64,s74,565248
s_add_u32 m0,s75,70656
s_nop 0
buffer_load_dwordx4 v9,s[32:35],s64 offen  lds
s_add_u32 s64,s74,573440
s_add_u32 m0,s75,71680
s_nop 0
buffer_load_dwordx4 v8,s[32:35],s64 offen  lds
s_add_u32 s64,s74,581632
s_add_u32 m0,s75,72704
s_nop 0
buffer_load_dwordx4 v9,s[32:35],s64 offen  lds
s_add_u32 s64,s74,589824
s_add_u32 m0,s75,73728
s_nop 0
buffer_load_dwordx4 v8,s[32:35],s64 offen  lds
s_add_u32 s64,s74,598016
s_add_u32 m0,s75,74752
s_nop 0
buffer_load_dwordx4 v9,s[32:35],s64 offen  lds
s_add_u32 s64,s74,606208
s_add_u32 m0,s75,75776
s_nop 0
buffer_load_dwordx4 v8,s[32:35],s64 offen  lds
s_add_u32 s64,s74,614400
s_add_u32 m0,s75,76800
s_nop 0
buffer_load_dwordx4 v9,s[32:35],s64 offen  lds
s_add_u32 s64,s74,622592
s_add_u32 m0,s75,77824
s_nop 0
buffer_load_dwordx4 v8,s[32:35],s64 offen  lds
s_add_u32 s64,s74,630784
s_add_u32 m0,s75,78848
s_nop 0
buffer_load_dwordx4 v9,s[32:35],s64 offen  lds
s_add_u32 s64,s74,638976
s_add_u32 m0,s75,79872
s_nop 0
buffer_load_dwordx4 v8,s[32:35],s64 offen  lds
s_add_u32 s64,s74,647168
s_add_u32 m0,s75,80896
s_nop 0
buffer_load_dwordx4 v9,s[32:35],s64 offen  lds
s_waitcnt vmcnt(16)
s_barrier
ds_read_b64_tr_b16 a[0:1],v12 offset:0
ds_read_b64_tr_b16 a[112:113],v13 offset:0
ds_read_b64_tr_b16 a[2:3],v12 offset:4096
ds_read_b64_tr_b16 a[114:115],v13 offset:4096
ds_read_b64_tr_b16 a[4:5],v12 offset:8192
ds_read_b64_tr_b16 a[116:117],v13 offset:8192
ds_read_b64_tr_b16 a[6:7],v12 offset:12288
ds_read_b64_tr_b16 a[118:119],v13 offset:12288
s_waitcnt lgkmcnt(4)
ds_read_b64_tr_b16 a[8:9],v12 offset:16384
ds_read_b64_tr_b16 a[120:121],v13 offset:16384
ds_read_b64_tr_b16 a[10:11],v12 offset:20480
ds_read_b64_tr_b16 a[122:123],v13 offset:20480
ds_read_b64_tr_b16 a[12:13],v12 offset:28672
ds_read_b64_tr_b16 a[124:125],v13 offset:28672
ds_read_b64_tr_b16 a[14:15],v12 offset:32768
ds_read_b64_tr_b16 a[126:127],v13 offset:32768
s_waitcnt lgkmcnt(4)
ds_read_b64_tr_b16 a[16:17],v12 offset:36864
ds_read_b64_tr_b16 a[128:129],v13 offset:36864
ds_read_b64_tr_b16 a[18:19],v12 offset:40960
ds_read_b64_tr_b16 a[130:131],v13 offset:40960
ds_read_b64_tr_b16 a[20:21],v12 offset:45056
ds_read_b64_tr_b16 a[132:133],v13 offset:45056
ds_read_b64_tr_b16 a[22:23],v12 offset:49152
ds_read_b64_tr_b16 a[134:135],v13 offset:49152
s_waitcnt lgkmcnt(4)
ds_read_b64_tr_b16 a[24:25],v12 offset:57344
ds_read_b64_tr_b16 a[136:137],v13 offset:57344
ds_read_b64_tr_b16 a[26:27],v12 offset:61440
ds_read_b64_tr_b16 a[138:139],v13 offset:61440
ds_read_b64_tr_b16 a[96:97],v12 offset:24576
ds_read_b64_tr_b16 a[208:209],v13 offset:24576
ds_read_b64_tr_b16 a[98:99],v12 offset:53248
ds_read_b64_tr_b16 a[210:211],v13 offset:53248
s_waitcnt lgkmcnt(4)
v_xor_b32 v12,0x10000,v12
v_xor_b32 v13,0x10000,v13
s_waitcnt lgkmcnt(0)
s_barrier
s_add_u32 s64,s74,1048576
s_add_u32 m0,s75,0
s_nop 0
buffer_load_dwordx4 v8,s[32:35],s64 offen  lds
s_add_u32 s64,s74,1056768
s_add_u32 m0,s75,1024
s_nop 0
buffer_load_dwordx4 v9,s[32:35],s64 offen  lds
s_add_u32 s64,s74,1064960
s_add_u32 m0,s75,2048
s_nop 0
buffer_load_dwordx4 v8,s[32:35],s64 offen  lds
s_add_u32 s64,s74,1073152
s_add_u32 m0,s75,3072
s_nop 0
buffer_load_dwordx4 v9,s[32:35],s64 offen  lds
s_add_u32 s64,s74,1081344
s_add_u32 m0,s75,4096
s_nop 0
buffer_load_dwordx4 v8,s[32:35],s64 offen  lds
s_add_u32 s64,s74,1089536
s_add_u32 m0,s75,5120
s_nop 0
buffer_load_dwordx4 v9,s[32:35],s64 offen  lds
s_add_u32 s64,s74,1097728
s_add_u32 m0,s75,6144
s_nop 0
buffer_load_dwordx4 v8,s[32:35],s64 offen  lds
s_add_u32 s64,s74,1105920
s_add_u32 m0,s75,7168
s_nop 0
buffer_load_dwordx4 v9,s[32:35],s64 offen  lds
s_add_u32 s64,s74,1114112
s_add_u32 m0,s75,8192
s_nop 0
buffer_load_dwordx4 v8,s[32:35],s64 offen  lds
s_add_u32 s64,s74,1122304
s_add_u32 m0,s75,9216
s_nop 0
buffer_load_dwordx4 v9,s[32:35],s64 offen  lds
s_add_u32 s64,s74,1130496
s_add_u32 m0,s75,10240
s_nop 0
buffer_load_dwordx4 v8,s[32:35],s64 offen  lds
s_add_u32 s64,s74,1138688
s_add_u32 m0,s75,11264
s_nop 0
buffer_load_dwordx4 v9,s[32:35],s64 offen  lds
s_add_u32 s64,s74,1146880
s_add_u32 m0,s75,12288
s_nop 0
buffer_load_dwordx4 v8,s[32:35],s64 offen  lds
s_add_u32 s64,s74,1155072
s_add_u32 m0,s75,13312
s_nop 0
buffer_load_dwordx4 v9,s[32:35],s64 offen  lds
s_add_u32 s64,s74,1163264
s_add_u32 m0,s75,14336
s_nop 0
buffer_load_dwordx4 v8,s[32:35],s64 offen  lds
s_add_u32 s64,s74,1171456
s_add_u32 m0,s75,15360
s_nop 0
buffer_load_dwordx4 v9,s[32:35],s64 offen  lds
s_waitcnt vmcnt(16)
s_barrier
ds_read_b64_tr_b16 a[28:29],v12 offset:0
ds_read_b64_tr_b16 a[140:141],v13 offset:0
ds_read_b64_tr_b16 a[30:31],v12 offset:4096
ds_read_b64_tr_b16 a[142:143],v13 offset:4096
ds_read_b64_tr_b16 a[32:33],v12 offset:8192
ds_read_b64_tr_b16 a[144:145],v13 offset:8192
ds_read_b64_tr_b16 a[34:35],v12 offset:12288
ds_read_b64_tr_b16 a[146:147],v13 offset:12288
s_waitcnt lgkmcnt(4)
ds_read_b64_tr_b16 a[36:37],v12 offset:20480
ds_read_b64_tr_b16 a[148:149],v13 offset:20480
ds_read_b64_tr_b16 a[38:39],v12 offset:24576
ds_read_b64_tr_b16 a[150:151],v13 offset:24576
ds_read_b64_tr_b16 a[40:41],v12 offset:28672
ds_read_b64_tr_b16 a[152:153],v13 offset:28672
ds_read_b64_tr_b16 a[42:43],v12 offset:32768
ds_read_b64_tr_b16 a[154:155],v13 offset:32768
s_waitcnt lgkmcnt(4)
ds_read_b64_tr_b16 a[44:45],v12 offset:36864
ds_read_b64_tr_b16 a[156:157],v13 offset:36864
ds_read_b64_tr_b16 a[46:47],v12 offset:40960
ds_read_b64_tr_b16 a[158:159],v13 offset:40960
ds_read_b64_tr_b16 a[48:49],v12 offset:49152
ds_read_b64_tr_b16 a[160:161],v13 offset:49152
ds_read_b64_tr_b16 a[50:51],v12 offset:53248
ds_read_b64_tr_b16 a[162:163],v13 offset:53248
s_waitcnt lgkmcnt(4)
ds_read_b64_tr_b16 a[52:53],v12 offset:57344
ds_read_b64_tr_b16 a[164:165],v13 offset:57344
ds_read_b64_tr_b16 a[54:55],v12 offset:61440
ds_read_b64_tr_b16 a[166:167],v13 offset:61440
ds_read_b64_tr_b16 a[100:101],v12 offset:16384
ds_read_b64_tr_b16 a[212:213],v13 offset:16384
ds_read_b64_tr_b16 a[102:103],v12 offset:45056
ds_read_b64_tr_b16 a[214:215],v13 offset:45056
s_waitcnt lgkmcnt(4)
v_xor_b32 v12,0x10000,v12
v_xor_b32 v13,0x10000,v13
s_waitcnt lgkmcnt(0)
s_barrier
s_add_u32 s64,s76,1572864
s_add_u32 m0,s77,65536
s_nop 0
buffer_load_dwordx4 v8,s[32:35],s64 offen  lds
s_add_u32 s64,s76,1581056
s_add_u32 m0,s77,66560
s_nop 0
buffer_load_dwordx4 v9,s[32:35],s64 offen  lds
s_add_u32 s64,s76,1589248
s_add_u32 m0,s77,67584
s_nop 0
buffer_load_dwordx4 v8,s[32:35],s64 offen  lds
s_add_u32 s64,s76,1597440
s_add_u32 m0,s77,68608
s_nop 0
buffer_load_dwordx4 v9,s[32:35],s64 offen  lds
s_add_u32 s64,s76,1605632
s_add_u32 m0,s77,69632
s_nop 0
buffer_load_dwordx4 v8,s[32:35],s64 offen  lds
s_add_u32 s64,s76,1613824
s_add_u32 m0,s77,70656
s_nop 0
buffer_load_dwordx4 v9,s[32:35],s64 offen  lds
s_add_u32 s64,s76,1622016
s_add_u32 m0,s77,71680
s_nop 0
buffer_load_dwordx4 v8,s[32:35],s64 offen  lds
s_add_u32 s64,s76,1630208
s_add_u32 m0,s77,72704
s_nop 0
buffer_load_dwordx4 v9,s[32:35],s64 offen  lds
s_waitcnt vmcnt(8)
s_barrier
ds_read_b64_tr_b16 a[56:57],v12 offset:0
ds_read_b64_tr_b16 a[168:169],v13 offset:0
ds_read_b64_tr_b16 a[58:59],v12 offset:4096
ds_read_b64_tr_b16 a[170:171],v13 offset:4096
ds_read_b64_tr_b16 a[60:61],v12 offset:12288
ds_read_b64_tr_b16 a[172:173],v13 offset:12288
ds_read_b64_tr_b16 a[62:63],v12 offset:16384
ds_read_b64_tr_b16 a[174:175],v13 offset:16384
s_waitcnt lgkmcnt(4)
ds_read_b64_tr_b16 a[64:65],v12 offset:20480
ds_read_b64_tr_b16 a[176:177],v13 offset:20480
ds_read_b64_tr_b16 a[66:67],v12 offset:24576
ds_read_b64_tr_b16 a[178:179],v13 offset:24576
ds_read_b64_tr_b16 a[68:69],v12 offset:28672
ds_read_b64_tr_b16 a[180:181],v13 offset:28672
ds_read_b64_tr_b16 a[70:71],v12 offset:32768
ds_read_b64_tr_b16 a[182:183],v13 offset:32768
s_waitcnt lgkmcnt(4)
ds_read_b64_tr_b16 a[72:73],v12 offset:40960
ds_read_b64_tr_b16 a[184:185],v13 offset:40960
ds_read_b64_tr_b16 a[74:75],v12 offset:45056
ds_read_b64_tr_b16 a[186:187],v13 offset:45056
ds_read_b64_tr_b16 a[76:77],v12 offset:49152
ds_read_b64_tr_b16 a[188:189],v13 offset:49152
ds_read_b64_tr_b16 a[78:79],v12 offset:53248
ds_read_b64_tr_b16 a[190:191],v13 offset:53248
s_waitcnt lgkmcnt(4)
ds_read_b64_tr_b16 a[80:81],v12 offset:57344
ds_read_b64_tr_b16 a[192:193],v13 offset:57344
ds_read_b64_tr_b16 a[82:83],v12 offset:61440
ds_read_b64_tr_b16 a[194:195],v13 offset:61440
ds_read_b64_tr_b16 a[104:105],v12 offset:8192
ds_read_b64_tr_b16 a[216:217],v13 offset:8192
ds_read_b64_tr_b16 a[106:107],v12 offset:36864
ds_read_b64_tr_b16 a[218:219],v13 offset:36864
s_waitcnt lgkmcnt(4)
v_xor_b32 v12,0x10000,v12
v_xor_b32 v13,0x10000,v13
s_waitcnt lgkmcnt(0)
s_barrier
s_waitcnt vmcnt(0)
s_barrier
ds_read_b64_tr_b16 a[84:85],v12 offset:4096
ds_read_b64_tr_b16 a[196:197],v13 offset:4096
ds_read_b64_tr_b16 a[86:87],v12 offset:8192
ds_read_b64_tr_b16 a[198:199],v13 offset:8192
ds_read_b64_tr_b16 a[88:89],v12 offset:12288
ds_read_b64_tr_b16 a[200:201],v13 offset:12288
ds_read_b64_tr_b16 a[90:91],v12 offset:16384
ds_read_b64_tr_b16 a[202:203],v13 offset:16384
s_waitcnt lgkmcnt(4)
ds_read_b64_tr_b16 a[92:93],v12 offset:20480
ds_read_b64_tr_b16 a[204:205],v13 offset:20480
ds_read_b64_tr_b16 a[94:95],v12 offset:24576
ds_read_b64_tr_b16 a[206:207],v13 offset:24576
ds_read_b64_tr_b16 a[108:109],v12 offset:0
ds_read_b64_tr_b16 a[220:221],v13 offset:0
ds_read_b64_tr_b16 a[110:111],v12 offset:28672
ds_read_b64_tr_b16 a[222:223],v13 offset:28672
s_waitcnt lgkmcnt(4)
v_xor_b32 v12,0x10000,v12
v_xor_b32 v13,0x10000,v13
s_waitcnt lgkmcnt(0)
s_barrier
v_and_b32 v21,1,v1
v_mul_u32_u24 v21,896,v21
s_mov_b32 s65,21052032
s_mov_b32 s66,1792
pl_229:
buffer_load_dword v22,v21,s[20:23],s65 offen sc1
s_waitcnt vmcnt(0)
v_cmp_gt_u32 vcc,s66,v22
s_cbranch_vccz pok_230
s_sleep 1
s_sub_u32 s90,s90,1
s_cmp_gt_i32 s90,0
s_cbranch_scc1 pl_229
pok_230:
s_lshr_b32 s43,s41,1
s_and_b32 s48,s41,1
s_lshl_b32 s64,s42,7
s_lshl_b32 s65,s50,5
s_add_u32 s64,s64,s65
s_lshl_b32 s65,s48,4
s_add_u32 s64,s64,s65
v_lshl_add_u32 v5,v4,2,s64
v_lshlrev_b32 v6,2,v5
s_mov_b32 s64,20480
buffer_load_dwordx4 v[132:135],v6,s[20:23],s64 offen sc1
v_lshlrev_b32 v5,1,v5
s_lshl_b32 s64,s43,10
v_add_u32 v17,s64,v16
v_xor_b32 v18,1024,v17
s_lshl_b32 s64,s59,14
s_lshl_b32 s65,s50,12
s_add_u32 s64,s64,s65
s_add_u32 s64,s64,18874368
v_add_u32 v26,s64,v16
s_lshl_b32 s64,s42,14
s_add_u32 s64,s64,s65
s_add_u32 s64,s64,18874368
v_add_u32 v25,s64,v16
s_xor_b32 s86,s41,1
s_xor_b32 s87,s41,2
s_xor_b32 s88,s41,3
s_lshl_b32 s86,s86,17
s_lshl_b32 s87,s87,17
s_lshl_b32 s88,s88,17
v_and_b32 v21,31,v1
v_lshlrev_b32 v21,2,v21
s_lshl_b32 s74,s41,7
s_add_u32 s74,s74,s63
s_add_u32 s74,s74,4096
s_mul_i32 s75,s41,114688
s_add_u32 s75,s75,1327104
s_lshl_b32 s64,s50,1
s_add_u32 s64,s64,s42
s_and_b32 s64,s64,7
s_lshl_b32 s64,s64,14
s_add_u32 s64,s64,s75
v_lshl_add_u32 v2,v1,7,s64
s_lshl_b32 s76,s50,11
s_add_u32 s76,s76,s75
s_lshr_b32 s64,s50,1
s_lshl_b32 s64,s64,14
s_add_u32 s75,s75,s64
s_and_b32 s64,s50,1
s_lshl_b32 s64,s64,12
s_add_u32 s75,s75,s64
s_lshl_b32 s72,s50,12
s_lshl_b32 s49,s50,11
s_lshl_b32 s73,s59,2
s_add_u32 s73,s73,s63
s_add_u32 s73,s73,2048
s_lshl_b32 s64,s43,4
v_add_u32 v6,s64,v3
v_lshl_add_u32 v19,v6,11,v5
v_add_u32 v6,30,v6
v_and_b32 v7,3,v6
v_lshl_add_u32 v7,v7,11,v5
v_bfe_u32 v8,v6,2,3
v_lshl_add_u32 v7,v8,14,v7
v_mov_b32 v8,0x2000
v_mov_b32 v9,2097152
v_cmp_gt_u32 vcc,32,v6
s_nop 1
v_cndmask_b32 v8,v9,v8,vcc
v_add_u32 v7,v7,v8
v_add_u32 v7,1048576,v7
v_xor_b32 v20,s62,v7
s_lshl_b32 s64,s42,14
s_lshl_b32 s65,s50,11
s_add_u32 s64,s64,s65
s_lshl_b32 s65,s43,10
s_add_u32 s64,s64,s65
s_lshl_b32 s65,s48,3
s_add_u32 s64,s64,s65
s_add_u32 s64,s64,1179648
v_add_u32 v24,s64,v16
s_mov_b32 s84,0xfffcfffc
s_cmp_eq_u32 s43,0
s_cselect_b32 s84,s84,-1
s_mov_b32 s85,s84
skl_231:
s_add_u32 s64,s79,0
s_lshl_b32 s70,s64,21
s_lshl_b32 s64,s64,13
s_and_b32 s64,s64,0x2000
s_xor_b32 s64,s64,s62
s_add_u32 s70,s70,s64
s_add_u32 s70,s70,29360128
s_add_u32 s64,s79,1
s_lshl_b32 s89,s64,21
s_lshl_b32 s64,s64,13
s_and_b32 s64,s64,0x2000
s_xor_b32 s64,s64,s62
s_add_u32 s89,s89,s64
s_add_u32 s89,s89,29360128
s_and_b32 s77,s79,1
s_lshl_b32 s77,s77,19
s_lshl_b32 s78,s79,16
s_xor_b32 s91,s72,0x10000
s_xor_b32 s92,s49,0x10000
s_cmp_lg_u32 s83,0
s_cbranch_scc1 pre_232
v_cmp_gt_u32 vcc,s71,v29
s_cbranch_vccz nopoll_233
pl_234:
buffer_load_dword v22,v21,s[20:23],s74 offen sc1
s_waitcnt vmcnt(0)
v_cmp_gt_u32 vcc,s71,v22
s_cbranch_vccz pok_235
s_sleep 1
s_sub_u32 s90,s90,1
s_cmp_gt_i32 s90,0
s_cbranch_scc1 pl_234
pok_235:
v_mov_b32 v29,v22
nopoll_233:
s_add_u32 m0,s72,0
s_add_u32 s65,s70,s75
s_add_u32 s65,s65,0
buffer_load_dwordx4 v16,s[20:23],s65 offen offset:0 sc1 lds
buffer_load_dwordx4 v16,s[20:23],s65 offen offset:1024 sc1 lds
buffer_load_dwordx4 v16,s[20:23],s65 offen offset:2048 sc1 lds
buffer_load_dwordx4 v16,s[20:23],s65 offen offset:3072 sc1 lds
s_add_u32 m0,s72,16384
s_add_u32 s65,s70,s75
s_add_u32 s65,s65,32768
buffer_load_dwordx4 v16,s[20:23],s65 offen offset:0 sc1 lds
buffer_load_dwordx4 v16,s[20:23],s65 offen offset:1024 sc1 lds
buffer_load_dwordx4 v16,s[20:23],s65 offen offset:2048 sc1 lds
buffer_load_dwordx4 v16,s[20:23],s65 offen offset:3072 sc1 lds
s_add_u32 m0,s72,32768
s_add_u32 s65,s70,s75
s_add_u32 s65,s65,65536
buffer_load_dwordx4 v16,s[20:23],s65 offen offset:0 sc1 lds
buffer_load_dwordx4 v16,s[20:23],s65 offen offset:1024 sc1 lds
buffer_load_dwordx4 v16,s[20:23],s65 offen offset:2048 sc1 lds
buffer_load_dwordx4 v16,s[20:23],s65 offen offset:3072 sc1 lds
s_add_u32 m0,s49,49152
s_add_u32 s65,s70,s76
s_add_u32 s65,s65,98304
buffer_load_dwordx4 v16,s[20:23],s65 offen offset:0 sc1 lds
buffer_load_dwordx4 v16,s[20:23],s65 offen offset:1024 sc1 lds
pre_232:
s_add_u32 s64,s71,1
v_cmp_gt_u32 vcc,s64,v29
s_cmp_eq_u64 vcc,0
s_cselect_b32 s83,1,0
s_cselect_b32 s89,s89,0x7fff0000
s_waitcnt vmcnt(10)
s_barrier
ds_read_b128 v[32:35],v17 offset:0
ds_read_b128 v[36:39],v18 offset:0
ds_read_b128 v[40:43],v17 offset:2048
s_waitcnt lgkmcnt(2)
v_mfma_f32_16x16x32_bf16 v[64:67],a[0:3],v[32:35],0
ds_read_b128 v[44:47],v18 offset:2048
v_mfma_f32_16x16x32_bf16 v[72:75],a[112:115],v[32:35],0
s_waitcnt lgkmcnt(2)
v_min_u32 v27,v32,v36
v_mfma_f32_16x16x32_bf16 v[68:71],a[0:3],v[36:39],0
ds_read_b128 v[32:35],v17 offset:4096
s_add_u32 m0,s91,0
s_add_u32 s65,s89,s75
s_add_u32 s65,s65,0
v_mfma_f32_16x16x32_bf16 v[76:79],a[112:115],v[36:39],0
s_waitcnt lgkmcnt(2)
v_mfma_f32_16x16x32_bf16 v[64:67],a[4:7],v[40:43],v[64:67]
ds_read_b128 v[36:39],v18 offset:4096
v_mfma_f32_16x16x32_bf16 v[72:75],a[116:119],v[40:43],v[72:75]
s_waitcnt lgkmcnt(2)
v_min3_u32 v27,v27,v40,v44
v_mfma_f32_16x16x32_bf16 v[68:71],a[4:7],v[44:47],v[68:71]
ds_read_b128 v[40:43],v17 offset:6144
v_mfma_f32_16x16x32_bf16 v[76:79],a[116:119],v[44:47],v[76:79]
buffer_load_dwordx4 v16,s[20:23],s65 offen offset:0 sc1 lds
s_waitcnt lgkmcnt(2)
v_mfma_f32_16x16x32_bf16 v[64:67],a[8:11],v[32:35],v[64:67]
ds_read_b128 v[44:47],v18 offset:6144
v_mfma_f32_16x16x32_bf16 v[72:75],a[120:123],v[32:35],v[72:75]
s_waitcnt lgkmcnt(2)
v_min3_u32 v27,v27,v32,v36
v_mfma_f32_16x16x32_bf16 v[68:71],a[8:11],v[36:39],v[68:71]
ds_read_b128 v[32:35],v17 offset:8192
v_mfma_f32_16x16x32_bf16 v[76:79],a[120:123],v[36:39],v[76:79]
s_waitcnt lgkmcnt(2)
v_mfma_f32_16x16x32_bf16 v[64:67],a[12:15],v[40:43],v[64:67]
ds_read_b128 v[36:39],v18 offset:8192
buffer_load_dwordx4 v16,s[20:23],s65 offen offset:1024 sc1 lds
v_mfma_f32_16x16x32_bf16 v[72:75],a[124:127],v[40:43],v[72:75]
s_waitcnt lgkmcnt(2)
v_min3_u32 v27,v27,v40,v44
v_mfma_f32_16x16x32_bf16 v[68:71],a[12:15],v[44:47],v[68:71]
ds_read_b128 v[40:43],v17 offset:10240
v_mfma_f32_16x16x32_bf16 v[76:79],a[124:127],v[44:47],v[76:79]
s_waitcnt lgkmcnt(2)
v_mfma_f32_16x16x32_bf16 v[64:67],a[16:19],v[32:35],v[64:67]
ds_read_b128 v[44:47],v18 offset:10240
v_mfma_f32_16x16x32_bf16 v[72:75],a[128:131],v[32:35],v[72:75]
buffer_load_dwordx4 v16,s[20:23],s65 offen offset:2048 sc1 lds
s_waitcnt lgkmcnt(2)
v_min3_u32 v27,v27,v32,v36
v_mfma_f32_16x16x32_bf16 v[68:71],a[16:19],v[36:39],v[68:71]
ds_read_b128 v[32:35],v17 offset:12288
v_mfma_f32_16x16x32_bf16 v[76:79],a[128:131],v[36:39],v[76:79]
s_waitcnt lgkmcnt(2)
v_mfma_f32_16x16x32_bf16 v[64:67],a[20:23],v[40:43],v[64:67]
ds_read_b128 v[36:39],v18 offset:12288
v_mfma_f32_16x16x32_bf16 v[72:75],a[132:135],v[40:43],v[72:75]
s_waitcnt lgkmcnt(2)
v_min3_u32 v27,v27,v40,v44
v_mfma_f32_16x16x32_bf16 v[68:71],a[20:23],v[44:47],v[68:71]
ds_read_b128 v[40:43],v17 offset:14336
buffer_load_dwordx4 v16,s[20:23],s65 offen offset:3072 sc1 lds
v_mfma_f32_16x16x32_bf16 v[76:79],a[132:135],v[44:47],v[76:79]
s_waitcnt lgkmcnt(2)
v_mfma_f32_16x16x32_bf16 v[64:67],a[24:27],v[32:35],v[64:67]
ds_read_b128 v[44:47],v18 offset:14336
v_mfma_f32_16x16x32_bf16 v[72:75],a[136:139],v[32:35],v[72:75]
s_waitcnt lgkmcnt(2)
v_min3_u32 v27,v27,v32,v36
v_mfma_f32_16x16x32_bf16 v[68:71],a[24:27],v[36:39],v[68:71]
s_waitcnt vmcnt(10)
s_barrier
ds_read_b128 v[32:35],v17 offset:16384
v_mfma_f32_16x16x32_bf16 v[76:79],a[136:139],v[36:39],v[76:79]
s_waitcnt lgkmcnt(2)
v_mfma_f32_16x16x32_bf16 v[64:67],a[28:31],v[40:43],v[64:67]
ds_read_b128 v[36:39],v18 offset:16384
s_add_u32 m0,s91,16384
s_add_u32 s65,s89,s75
s_add_u32 s65,s65,32768
v_mfma_f32_16x16x32_bf16 v[72:75],a[140:143],v[40:43],v[72:75]
s_waitcnt lgkmcnt(2)
v_min3_u32 v27,v27,v40,v44
v_mfma_f32_16x16x32_bf16 v[68:71],a[28:31],v[44:47],v[68:71]
ds_read_b128 v[40:43],v17 offset:18432
v_mfma_f32_16x16x32_bf16 v[76:79],a[140:143],v[44:47],v[76:79]
s_waitcnt lgkmcnt(2)
v_mfma_f32_16x16x32_bf16 v[64:67],a[32:35],v[32:35],v[64:67]
ds_read_b128 v[44:47],v18 offset:18432
v_mfma_f32_16x16x32_bf16 v[72:75],a[144:147],v[32:35],v[72:75]
buffer_load_dwordx4 v16,s[20:23],s65 offen offset:0 sc1 lds
s_waitcnt lgkmcnt(2)
v_min3_u32 v27,v27,v32,v36
v_mfma_f32_16x16x32_bf16 v[68:71],a[32:35],v[36:39],v[68:71]
ds_read_b128 v[32:35],v17 offset:20480
v_mfma_f32_16x16x32_bf16 v[76:79],a[144:147],v[36:39],v[76:79]
s_waitcnt lgkmcnt(2)
v_mfma_f32_16x16x32_bf16 v[64:67],a[36:39],v[40:43],v[64:67]
ds_read_b128 v[36:39],v18 offset:20480
v_mfma_f32_16x16x32_bf16 v[72:75],a[148:151],v[40:43],v[72:75]
s_waitcnt lgkmcnt(2)
v_min3_u32 v27,v27,v40,v44
v_mfma_f32_16x16x32_bf16 v[68:71],a[36:39],v[44:47],v[68:71]
ds_read_b128 v[40:43],v17 offset:22528
buffer_load_dwordx4 v16,s[20:23],s65 offen offset:1024 sc1 lds
v_mfma_f32_16x16x32_bf16 v[76:79],a[148:151],v[44:47],v[76:79]
s_waitcnt lgkmcnt(2)
v_mfma_f32_16x16x32_bf16 v[64:67],a[40:43],v[32:35],v[64:67]
ds_read_b128 v[44:47],v18 offset:22528
v_mfma_f32_16x16x32_bf16 v[72:75],a[152:155],v[32:35],v[72:75]
s_waitcnt lgkmcnt(2)
v_min3_u32 v27,v27,v32,v36
v_mfma_f32_16x16x32_bf16 v[68:71],a[40:43],v[36:39],v[68:71]
ds_read_b128 v[32:35],v17 offset:24576
v_mfma_f32_16x16x32_bf16 v[76:79],a[152:155],v[36:39],v[76:79]
buffer_load_dwordx4 v16,s[20:23],s65 offen offset:2048 sc1 lds
s_waitcnt lgkmcnt(2)
v_mfma_f32_16x16x32_bf16 v[64:67],a[44:47],v[40:43],v[64:67]
ds_read_b128 v[36:39],v18 offset:24576
v_mfma_f32_16x16x32_bf16 v[72:75],a[156:159],v[40:43],v[72:75]
s_waitcnt lgkmcnt(2)
v_min3_u32 v27,v27,v40,v44
v_mfma_f32_16x16x32_bf16 v[68:71],a[44:47],v[44:47],v[68:71]
ds_read_b128 v[40:43],v17 offset:26624
v_mfma_f32_16x16x32_bf16 v[76:79],a[156:159],v[44:47],v[76:79]
s_waitcnt lgkmcnt(2)
v_mfma_f32_16x16x32_bf16 v[64:67],a[48:51],v[32:35],v[64:67]
ds_read_b128 v[44:47],v18 offset:26624
v_mfma_f32_16x16x32_bf16 v[72:75],a[160:163],v[32:35],v[72:75]
buffer_load_dwordx4 v16,s[20:23],s65 offen offset:3072 sc1 lds
s_waitcnt lgkmcnt(2)
v_min3_u32 v27,v27,v32,v36
v_mfma_f32_16x16x32_bf16 v[68:71],a[48:51],v[36:39],v[68:71]
ds_read_b128 v[32:35],v17 offset:28672
v_mfma_f32_16x16x32_bf16 v[76:79],a[160:163],v[36:39],v[76:79]
s_waitcnt lgkmcnt(2)
v_mfma_f32_16x16x32_bf16 v[64:67],a[52:55],v[40:43],v[64:67]
ds_read_b128 v[36:39],v18 offset:28672
v_mfma_f32_16x16x32_bf16 v[72:75],a[164:167],v[40:43],v[72:75]
s_waitcnt lgkmcnt(2)
v_min3_u32 v27,v27,v40,v44
v_mfma_f32_16x16x32_bf16 v[68:71],a[52:55],v[44:47],v[68:71]
ds_read_b128 v[40:43],v17 offset:30720
s_add_u32 m0,s91,32768
s_add_u32 s65,s89,s75
s_add_u32 s65,s65,65536
v_mfma_f32_16x16x32_bf16 v[76:79],a[164:167],v[44:47],v[76:79]
s_waitcnt lgkmcnt(2)
v_mfma_f32_16x16x32_bf16 v[64:67],a[56:59],v[32:35],v[64:67]
ds_read_b128 v[44:47],v18 offset:30720
v_mfma_f32_16x16x32_bf16 v[72:75],a[168:171],v[32:35],v[72:75]
s_waitcnt lgkmcnt(2)
v_min3_u32 v27,v27,v32,v36
v_mfma_f32_16x16x32_bf16 v[68:71],a[56:59],v[36:39],v[68:71]
s_waitcnt vmcnt(10)
s_barrier
ds_read_b128 v[32:35],v17 offset:32768
v_mfma_f32_16x16x32_bf16 v[76:79],a[168:171],v[36:39],v[76:79]
buffer_load_dwordx4 v16,s[20:23],s65 offen offset:0 sc1 lds
s_waitcnt lgkmcnt(2)
v_mfma_f32_16x16x32_bf16 v[64:67],a[60:63],v[40:43],v[64:67]
ds_read_b128 v[36:39],v18 offset:32768
v_mfma_f32_16x16x32_bf16 v[72:75],a[172:175],v[40:43],v[72:75]
s_waitcnt lgkmcnt(2)
v_min3_u32 v27,v27,v40,v44
v_mfma_f32_16x16x32_bf16 v[68:71],a[60:63],v[44:47],v[68:71]
ds_read_b128 v[40:43],v17 offset:34816
v_mfma_f32_16x16x32_bf16 v[76:79],a[172:175],v[44:47],v[76:79]
s_waitcnt lgkmcnt(2)
v_mfma_f32_16x16x32_bf16 v[64:67],a[64:67],v[32:35],v[64:67]
ds_read_b128 v[44:47],v18 offset:34816
buffer_load_dwordx4 v16,s[20:23],s65 offen offset:1024 sc1 lds
v_mfma_f32_16x16x32_bf16 v[72:75],a[176:179],v[32:35],v[72:75]
s_waitcnt lgkmcnt(2)
v_min3_u32 v27,v27,v32,v36
v_mfma_f32_16x16x32_bf16 v[68:71],a[64:67],v[36:39],v[68:71]
ds_read_b128 v[32:35],v17 offset:36864
v_mfma_f32_16x16x32_bf16 v[76:79],a[176:179],v[36:39],v[76:79]
s_waitcnt lgkmcnt(2)
v_mfma_f32_16x16x32_bf16 v[64:67],a[68:71],v[40:43],v[64:67]
ds_read_b128 v[36:39],v18 offset:36864
v_mfma_f32_16x16x32_bf16 v[72:75],a[180:183],v[40:43],v[72:75]
buffer_load_dwordx4 v16,s[20:23],s65 offen offset:2048 sc1 lds
s_waitcnt lgkmcnt(2)
v_min3_u32 v27,v27,v40,v44
v_mfma_f32_16x16x32_bf16 v[68:71],a[68:71],v[44:47],v[68:71]
ds_read_b128 v[40:43],v17 offset:38912
v_mfma_f32_16x16x32_bf16 v[76:79],a[180:183],v[44:47],v[76:79]
s_waitcnt lgkmcnt(2)
v_mfma_f32_16x16x32_bf16 v[64:67],a[72:75],v[32:35],v[64:67]
ds_read_b128 v[44:47],v18 offset:38912
v_mfma_f32_16x16x32_bf16 v[72:75],a[184:187],v[32:35],v[72:75]
s_waitcnt lgkmcnt(2)
v_min3_u32 v27,v27,v32,v36
v_mfma_f32_16x16x32_bf16 v[68:71],a[72:75],v[36:39],v[68:71]
ds_read_b128 v[32:35],v17 offset:40960
v_mfma_f32_16x16x32_bf16 v[76:79],a[184:187],v[36:39],v[76:79]
buffer_load_dwordx4 v16,s[20:23],s65 offen offset:3072 sc1 lds
s_waitcnt lgkmcnt(2)
v_mfma_f32_16x16x32_bf16 v[64:67],a[76:79],v[40:43],v[64:67]
ds_read_b128 v[36:39],v18 offset:40960
v_mfma_f32_16x16x32_bf16 v[72:75],a[188:191],v[40:43],v[72:75]
s_waitcnt lgkmcnt(2)
v_min3_u32 v27,v27,v40,v44
v_mfma_f32_16x16x32_bf16 v[68:71],a[76:79],v[44:47],v[68:71]
ds_read_b128 v[40:43],v17 offset:43008
v_mfma_f32_16x16x32_bf16 v[76:79],a[188:191],v[44:47],v[76:79]
s_waitcnt lgkmcnt(2)
v_mfma_f32_16x16x32_bf16 v[64:67],a[80:83],v[32:35],v[64:67]
ds_read_b128 v[44:47],v18 offset:43008
s_add_u32 m0,s92,49152
s_add_u32 s65,s89,s76
s_add_u32 s65,s65,98304
v_mfma_f32_16x16x32_bf16 v[72:75],a[192:195],v[32:35],v[72:75]
s_waitcnt lgkmcnt(2)
v_min3_u32 v27,v27,v32,v36
v_mfma_f32_16x16x32_bf16 v[68:71],a[80:83],v[36:39],v[68:71]
ds_read_b128 v[32:35],v17 offset:45056
v_mfma_f32_16x16x32_bf16 v[76:79],a[192:195],v[36:39],v[76:79]
s_waitcnt lgkmcnt(2)
v_mfma_f32_16x16x32_bf16 v[64:67],a[84:87],v[40:43],v[64:67]
ds_read_b128 v[36:39],v18 offset:45056
v_mfma_f32_16x16x32_bf16 v[72:75],a[196:199],v[40:43],v[72:75]
buffer_load_dwordx4 v16,s[20:23],s65 offen offset:0 sc1 lds
s_waitcnt lgkmcnt(2)
v_min3_u32 v27,v27,v40,v44
v_mfma_f32_16x16x32_bf16 v[68:71],a[84:87],v[44:47],v[68:71]
ds_read_b128 v[40:43],v17 offset:47104
v_mfma_f32_16x16x32_bf16 v[76:79],a[196:199],v[44:47],v[76:79]
s_lshl_b32 s64,s79,21
s_add_u32 s64,s64,27262976
buffer_load_dwordx2 v[120:121],v20,s[20:23],s64 offen sc1
buffer_load_dwordx2 v[122:123],v24,s[20:23],s70 offen sc1
s_waitcnt lgkmcnt(2)
v_mfma_f32_16x16x32_bf16 v[64:67],a[88:91],v[32:35],v[64:67]
ds_read_b128 v[44:47],v18 offset:47104
v_mfma_f32_16x16x32_bf16 v[72:75],a[200:203],v[32:35],v[72:75]
s_waitcnt lgkmcnt(2)
v_min3_u32 v27,v27,v32,v36
v_mfma_f32_16x16x32_bf16 v[68:71],a[88:91],v[36:39],v[68:71]
s_waitcnt vmcnt(15)
s_barrier
ds_read_b128 v[32:35],v17 offset:49152
buffer_load_dwordx4 v16,s[20:23],s65 offen offset:1024 sc1 lds
v_mfma_f32_16x16x32_bf16 v[76:79],a[200:203],v[36:39],v[76:79]
s_waitcnt lgkmcnt(2)
v_mfma_f32_16x16x32_bf16 v[64:67],a[92:95],v[40:43],v[64:67]
ds_read_b128 v[36:39],v18 offset:49152
v_mfma_f32_16x16x32_bf16 v[72:75],a[204:207],v[40:43],v[72:75]
s_waitcnt lgkmcnt(2)
v_min3_u32 v27,v27,v40,v44
v_mfma_f32_16x16x32_bf16 v[68:71],a[92:95],v[44:47],v[68:71]
ds_read_b128 v[40:43],v17 offset:51200
v_mfma_f32_16x16x32_bf16 v[76:79],a[204:207],v[44:47],v[76:79]
s_waitcnt lgkmcnt(2)
v_mfma_f32_16x16x32_bf16 v[64:67],a[96:99],v[32:35],v[64:67]
ds_read_b128 v[44:47],v18 offset:51200
v_mfma_f32_16x16x32_bf16 v[72:75],a[208:211],v[32:35],v[72:75]
s_waitcnt lgkmcnt(2)
v_min3_u32 v27,v27,v32,v36
v_min3_u32 v27,v27,v34,v38
v_mfma_f32_16x16x32_bf16 v[68:71],a[96:99],v[36:39],v[68:71]
ds_read_b128 v[32:35],v17 offset:53248
v_mfma_f32_16x16x32_bf16 v[76:79],a[208:211],v[36:39],v[76:79]
s_waitcnt lgkmcnt(2)
v_mfma_f32_16x16x32_bf16 v[64:67],a[100:103],v[40:43],v[64:67]
ds_read_b128 v[36:39],v18 offset:53248
v_mfma_f32_16x16x32_bf16 v[72:75],a[212:215],v[40:43],v[72:75]
s_waitcnt lgkmcnt(2)
v_min3_u32 v27,v27,v40,v44
v_min3_u32 v27,v27,v42,v46
v_mfma_f32_16x16x32_bf16 v[68:71],a[100:103],v[44:47],v[68:71]
ds_read_b128 v[40:43],v17 offset:55296
v_mfma_f32_16x16x32_bf16 v[76:79],a[212:215],v[44:47],v[76:79]
s_waitcnt lgkmcnt(2)
v_mfma_f32_16x16x32_bf16 v[64:67],a[104:107],v[32:35],v[64:67]
ds_read_b128 v[44:47],v18 offset:55296
v_mfma_f32_16x16x32_bf16 v[72:75],a[216:219],v[32:35],v[72:75]
s_waitcnt lgkmcnt(2)
v_min3_u32 v27,v27,v32,v36
v_min3_u32 v27,v27,v34,v38
v_mfma_f32_16x16x32_bf16 v[68:71],a[104:107],v[36:39],v[68:71]
v_mfma_f32_16x16x32_bf16 v[76:79],a[216:219],v[36:39],v[76:79]
s_waitcnt lgkmcnt(1)
v_mfma_f32_16x16x32_bf16 v[64:67],a[108:111],v[40:43],v[64:67]
v_mfma_f32_16x16x32_bf16 v[72:75],a[220:223],v[40:43],v[72:75]
s_waitcnt lgkmcnt(0)
v_min3_u32 v27,v27,v40,v44
v_min3_u32 v27,v27,v42,v46
v_mfma_f32_16x16x32_bf16 v[68:71],a[108:111],v[44:47],v[68:71]
v_mfma_f32_16x16x32_bf16 v[76:79],a[220:223],v[44:47],v[76:79]
v_cmp_eq_u32 vcc,0,v27
s_cbranch_vccnz retry_236
valid_237:
buffer_load_dword v29,v21,s[20:23],s74 offen sc1
v_xor_b32 v17,0x10000,v17
v_xor_b32 v18,0x10000,v18
s_mov_b32 s72,s91
s_mov_b32 s49,s92
v_xor_b32 v20,0x2000,v20
v_max_u32 v72,1,v72
s_add_u32 s65,s77,s86
buffer_store_dwordx4 v[72:75],v25,s[24:27],s65 offen offset:1024
buffer_store_dwordx4 v[72:75],v25,s[28:31],s65 offen offset:1024 sc1
v_max_u32 v68,1,v68
s_add_u32 s65,s77,s87
buffer_store_dwordx4 v[68:71],v25,s[24:27],s65 offen offset:2048
buffer_store_dwordx4 v[68:71],v25,s[28:31],s65 offen offset:2048 sc1
v_max_u32 v76,1,v76
s_add_u32 s65,s77,s88
buffer_store_dwordx4 v[76:79],v25,s[24:27],s65 offen offset:3072
buffer_store_dwordx4 v[76:79],v25,s[28:31],s65 offen offset:3072 sc1
ip_238:
buffer_load_dwordx4 v[84:87],v26,s[20:23],s77 offen offset:1024 sc1
buffer_load_dwordx4 v[88:91],v26,s[20:23],s77 offen offset:2048 sc1
buffer_load_dwordx4 v[92:95],v26,s[20:23],s77 offen offset:3072 sc1
s_waitcnt vmcnt(0)
v_min3_u32 v22,v84,v88,v92
v_cmp_eq_u32 vcc,0,v22
s_cbranch_vccz ik_239
s_sub_u32 s90,s90,1
s_cmp_gt_i32 s90,0
s_cbranch_scc1 ip_238
ik_239:
v_pk_add_f32 v[80:81],v[64:65],v[84:85]
v_pk_add_f32 v[88:89],v[88:89],v[92:93]
v_pk_add_f32 v[82:83],v[66:67],v[86:87]
v_pk_add_f32 v[90:91],v[90:91],v[94:95]
v_pk_add_f32 v[80:81],v[80:81],v[88:89]
v_pk_add_f32 v[82:83],v[82:83],v[90:91]
v_lshlrev_b32 v84,16,v122
v_and_b32 v85,s80,v122
v_lshlrev_b32 v86,16,v123
v_and_b32 v87,s80,v123
v_pk_add_f32 v[80:81],v[80:81],v[84:85]
v_pk_add_f32 v[82:83],v[82:83],v[86:87]
v_lshlrev_b32 v84,16,v120
v_and_b32 v85,s80,v120
v_lshlrev_b32 v86,16,v121
v_and_b32 v87,s80,v121
v_pk_fma_f32 v[80:81],v[80:81],v[132:133],v[84:85]
v_pk_fma_f32 v[82:83],v[82:83],v[134:135],v[86:87]
v_cvt_pk_bf16_f32 v80,v80,v81
v_cvt_pk_bf16_f32 v81,v82,v83
s_mov_b64 exec,s[84:85]
buffer_store_dwordx2 v[80:81],v19,s[36:39],s78 offen
s_mov_b64 exec,-1
s_mov_b64 s[84:85],-1
buffer_store_dwordx4 v[128:131],v26,s[24:27],s77 offen offset:1024
buffer_store_dwordx4 v[128:131],v26,s[28:31],s77 offen offset:1024 sc1
buffer_store_dwordx4 v[128:131],v26,s[24:27],s77 offen offset:2048
buffer_store_dwordx4 v[128:131],v26,s[28:31],s77 offen offset:2048 sc1
buffer_store_dwordx4 v[128:131],v26,s[24:27],s77 offen offset:3072
buffer_store_dwordx4 v[128:131],v26,s[28:31],s77 offen offset:3072 sc1
s_add_u32 s79,s79,1
s_add_u32 s71,s71,1
s_cmp_lt_u32 s79,65
s_cbranch_scc1 skl_231
s_endpgm
retry_236:
s_sub_u32 s90,s90,1
s_cmp_lt_i32 s90,0
s_cbranch_scc1 valid_237
s_mov_b32 s83,1
v_mov_b32 v29,0
s_barrier
s_add_u32 m0,s72,0
s_add_u32 s65,s70,s75
s_add_u32 s65,s65,0
buffer_load_dwordx4 v16,s[20:23],s65 offen offset:0 sc1 lds
buffer_load_dwordx4 v16,s[20:23],s65 offen offset:1024 sc1 lds
buffer_load_dwordx4 v16,s[20:23],s65 offen offset:2048 sc1 lds
buffer_load_dwordx4 v16,s[20:23],s65 offen offset:3072 sc1 lds
s_add_u32 m0,s72,16384
s_add_u32 s65,s70,s75
s_add_u32 s65,s65,32768
buffer_load_dwordx4 v16,s[20:23],s65 offen offset:0 sc1 lds
buffer_load_dwordx4 v16,s[20:23],s65 offen offset:1024 sc1 lds
buffer_load_dwordx4 v16,s[20:23],s65 offen offset:2048 sc1 lds
buffer_load_dwordx4 v16,s[20:23],s65 offen offset:3072 sc1 lds
s_add_u32 m0,s72,32768
s_add_u32 s65,s70,s75
s_add_u32 s65,s65,65536
buffer_load_dwordx4 v16,s[20:23],s65 offen offset:0 sc1 lds
buffer_load_dwordx4 v16,s[20:23],s65 offen offset:1024 sc1 lds
buffer_load_dwordx4 v16,s[20:23],s65 offen offset:2048 sc1 lds
buffer_load_dwordx4 v16,s[20:23],s65 offen offset:3072 sc1 lds
s_add_u32 m0,s49,49152
s_add_u32 s65,s70,s76
s_add_u32 s65,s65,98304
buffer_load_dwordx4 v16,s[20:23],s65 offen offset:0 sc1 lds
buffer_load_dwordx4 v16,s[20:23],s65 offen offset:1024 sc1 lds
s_branch skl_231
r_w3_179:
s_load_dwordx2 s[4:5],s[0:1],80
s_mul_i32 s66,s59,224
s_lshl_b32 s67,s50,1
s_waitcnt lgkmcnt(0)
s_mov_b32 s32,s4
s_and_b32 s33,s5,0xffff
s_mov_b32 s34,0x700000
s_mov_b32 s35,0x20000
v_lshrrev_b32 v5,2,v3
v_lshl_add_u32 v5,v4,2,v5
v_and_b32 v6,3,v3
v_lshlrev_b32 v6,3,v6
v_lshl_add_u32 v6,v5,8,v6
v_and_b32 v5,7,v5
v_xor_b32 v5,s67,v5
v_lshl_add_u32 v12,v5,5,v6
v_xor_b32 v13,32,v12
v_and_b32 v5,15,v1
v_and_b32 v6,3,v4
v_lshlrev_b32 v6,1,v6
v_xor_b32 v5,v5,v6
v_mul_u32_u24 v6,7168,v4
v_xor_b32 v7,0,v5
v_lshl_add_u32 v8,v7,4,v6
v_xor_b32 v7,8,v5
v_lshl_add_u32 v9,v7,4,v6
s_mul_i32 s74,s50,458752
s_add_u32 s74,s74,s66
s_lshl_b32 s75,s50,14
s_mul_i32 s76,s50,229376
s_add_u32 s76,s76,s66
s_lshl_b32 s77,s50,13
s_add_u32 s64,s74,0
s_add_u32 m0,s75,0
s_nop 0
buffer_load_dwordx4 v8,s[32:35],s64 offen  lds
s_add_u32 s64,s74,28672
s_add_u32 m0,s75,1024
s_nop 0
buffer_load_dwordx4 v9,s[32:35],s64 offen  lds
s_add_u32 s64,s74,57344
s_add_u32 m0,s75,2048
s_nop 0
buffer_load_dwordx4 v8,s[32:35],s64 offen  lds
s_add_u32 s64,s74,86016
s_add_u32 m0,s75,3072
s_nop 0
buffer_load_dwordx4 v9,s[32:35],s64 offen  lds
s_add_u32 s64,s74,114688
s_add_u32 m0,s75,4096
s_nop 0
buffer_load_dwordx4 v8,s[32:35],s64 offen  lds
s_add_u32 s64,s74,143360
s_add_u32 m0,s75,5120
s_nop 0
buffer_load_dwordx4 v9,s[32:35],s64 offen  lds
s_add_u32 s64,s74,172032
s_add_u32 m0,s75,6144
s_nop 0
buffer_load_dwordx4 v8,s[32:35],s64 offen  lds
s_add_u32 s64,s74,200704
s_add_u32 m0,s75,7168
s_nop 0
buffer_load_dwordx4 v9,s[32:35],s64 offen  lds
s_add_u32 s64,s74,229376
s_add_u32 m0,s75,8192
s_nop 0
buffer_load_dwordx4 v8,s[32:35],s64 offen  lds
s_add_u32 s64,s74,258048
s_add_u32 m0,s75,9216
s_nop 0
buffer_load_dwordx4 v9,s[32:35],s64 offen  lds
s_add_u32 s64,s74,286720
s_add_u32 m0,s75,10240
s_nop 0
buffer_load_dwordx4 v8,s[32:35],s64 offen  lds
s_add_u32 s64,s74,315392
s_add_u32 m0,s75,11264
s_nop 0
buffer_load_dwordx4 v9,s[32:35],s64 offen  lds
s_add_u32 s64,s74,344064
s_add_u32 m0,s75,12288
s_nop 0
buffer_load_dwordx4 v8,s[32:35],s64 offen  lds
s_add_u32 s64,s74,372736
s_add_u32 m0,s75,13312
s_nop 0
buffer_load_dwordx4 v9,s[32:35],s64 offen  lds
s_add_u32 s64,s74,401408
s_add_u32 m0,s75,14336
s_nop 0
buffer_load_dwordx4 v8,s[32:35],s64 offen  lds
s_add_u32 s64,s74,430080
s_add_u32 m0,s75,15360
s_nop 0
buffer_load_dwordx4 v9,s[32:35],s64 offen  lds
s_add_u32 s64,s74,1835008
s_add_u32 m0,s75,65536
s_nop 0
buffer_load_dwordx4 v8,s[32:35],s64 offen  lds
s_add_u32 s64,s74,1863680
s_add_u32 m0,s75,66560
s_nop 0
buffer_load_dwordx4 v9,s[32:35],s64 offen  lds
s_add_u32 s64,s74,1892352
s_add_u32 m0,s75,67584
s_nop 0
buffer_load_dwordx4 v8,s[32:35],s64 offen  lds
s_add_u32 s64,s74,1921024
s_add_u32 m0,s75,68608
s_nop 0
buffer_load_dwordx4 v9,s[32:35],s64 offen  lds
s_add_u32 s64,s74,1949696
s_add_u32 m0,s75,69632
s_nop 0
buffer_load_dwordx4 v8,s[32:35],s64 offen  lds
s_add_u32 s64,s74,1978368
s_add_u32 m0,s75,70656
s_nop 0
buffer_load_dwordx4 v9,s[32:35],s64 offen  lds
s_add_u32 s64,s74,2007040
s_add_u32 m0,s75,71680
s_nop 0
buffer_load_dwordx4 v8,s[32:35],s64 offen  lds
s_add_u32 s64,s74,2035712
s_add_u32 m0,s75,72704
s_nop 0
buffer_load_dwordx4 v9,s[32:35],s64 offen  lds
s_add_u32 s64,s74,2064384
s_add_u32 m0,s75,73728
s_nop 0
buffer_load_dwordx4 v8,s[32:35],s64 offen  lds
s_add_u32 s64,s74,2093056
s_add_u32 m0,s75,74752
s_nop 0
buffer_load_dwordx4 v9,s[32:35],s64 offen  lds
s_add_u32 s64,s74,2121728
s_add_u32 m0,s75,75776
s_nop 0
buffer_load_dwordx4 v8,s[32:35],s64 offen  lds
s_add_u32 s64,s74,2150400
s_add_u32 m0,s75,76800
s_nop 0
buffer_load_dwordx4 v9,s[32:35],s64 offen  lds
s_add_u32 s64,s74,2179072
s_add_u32 m0,s75,77824
s_nop 0
buffer_load_dwordx4 v8,s[32:35],s64 offen  lds
s_add_u32 s64,s74,2207744
s_add_u32 m0,s75,78848
s_nop 0
buffer_load_dwordx4 v9,s[32:35],s64 offen  lds
s_add_u32 s64,s74,2236416
s_add_u32 m0,s75,79872
s_nop 0
buffer_load_dwordx4 v8,s[32:35],s64 offen  lds
s_add_u32 s64,s74,2265088
s_add_u32 m0,s75,80896
s_nop 0
buffer_load_dwordx4 v9,s[32:35],s64 offen  lds
s_waitcnt vmcnt(16)
s_barrier
ds_read_b64_tr_b16 a[0:1],v12 offset:0
ds_read_b64_tr_b16 a[128:129],v13 offset:0
ds_read_b64_tr_b16 a[2:3],v12 offset:4096
ds_read_b64_tr_b16 a[130:131],v13 offset:4096
ds_read_b64_tr_b16 a[4:5],v12 offset:8192
ds_read_b64_tr_b16 a[132:133],v13 offset:8192
ds_read_b64_tr_b16 a[6:7],v12 offset:12288
ds_read_b64_tr_b16 a[134:135],v13 offset:12288
s_waitcnt lgkmcnt(4)
ds_read_b64_tr_b16 a[8:9],v12 offset:16384
ds_read_b64_tr_b16 a[136:137],v13 offset:16384
ds_read_b64_tr_b16 a[10:11],v12 offset:20480
ds_read_b64_tr_b16 a[138:139],v13 offset:20480
ds_read_b64_tr_b16 a[12:13],v12 offset:24576
ds_read_b64_tr_b16 a[140:141],v13 offset:24576
ds_read_b64_tr_b16 a[14:15],v12 offset:28672
ds_read_b64_tr_b16 a[142:143],v13 offset:28672
s_waitcnt lgkmcnt(4)
ds_read_b64_tr_b16 a[16:17],v12 offset:32768
ds_read_b64_tr_b16 a[144:145],v13 offset:32768
ds_read_b64_tr_b16 a[18:19],v12 offset:36864
ds_read_b64_tr_b16 a[146:147],v13 offset:36864
ds_read_b64_tr_b16 a[20:21],v12 offset:40960
ds_read_b64_tr_b16 a[148:149],v13 offset:40960
ds_read_b64_tr_b16 a[22:23],v12 offset:45056
ds_read_b64_tr_b16 a[150:151],v13 offset:45056
s_waitcnt lgkmcnt(4)
ds_read_b64_tr_b16 a[24:25],v12 offset:49152
ds_read_b64_tr_b16 a[152:153],v13 offset:49152
ds_read_b64_tr_b16 a[26:27],v12 offset:53248
ds_read_b64_tr_b16 a[154:155],v13 offset:53248
ds_read_b64_tr_b16 a[28:29],v12 offset:57344
ds_read_b64_tr_b16 a[156:157],v13 offset:57344
ds_read_b64_tr_b16 a[30:31],v12 offset:61440
ds_read_b64_tr_b16 a[158:159],v13 offset:61440
s_waitcnt lgkmcnt(4)
v_xor_b32 v12,0x10000,v12
v_xor_b32 v13,0x10000,v13
s_waitcnt lgkmcnt(0)
s_barrier
s_add_u32 s64,s74,3670016
s_add_u32 m0,s75,0
s_nop 0
buffer_load_dwordx4 v8,s[32:35],s64 offen  lds
s_add_u32 s64,s74,3698688
s_add_u32 m0,s75,1024
s_nop 0
buffer_load_dwordx4 v9,s[32:35],s64 offen  lds
s_add_u32 s64,s74,3727360
s_add_u32 m0,s75,2048
s_nop 0
buffer_load_dwordx4 v8,s[32:35],s64 offen  lds
s_add_u32 s64,s74,3756032
s_add_u32 m0,s75,3072
s_nop 0
buffer_load_dwordx4 v9,s[32:35],s64 offen  lds
s_add_u32 s64,s74,3784704
s_add_u32 m0,s75,4096
s_nop 0
buffer_load_dwordx4 v8,s[32:35],s64 offen  lds
s_add_u32 s64,s74,3813376
s_add_u32 m0,s75,5120
s_nop 0
buffer_load_dwordx4 v9,s[32:35],s64 offen  lds
s_add_u32 s64,s74,3842048
s_add_u32 m0,s75,6144
s_nop 0
buffer_load_dwordx4 v8,s[32:35],s64 offen  lds
s_add_u32 s64,s74,3870720
s_add_u32 m0,s75,7168
s_nop 0
buffer_load_dwordx4 v9,s[32:35],s64 offen  lds
s_add_u32 s64,s74,3899392
s_add_u32 m0,s75,8192
s_nop 0
buffer_load_dwordx4 v8,s[32:35],s64 offen  lds
s_add_u32 s64,s74,3928064
s_add_u32 m0,s75,9216
s_nop 0
buffer_load_dwordx4 v9,s[32:35],s64 offen  lds
s_add_u32 s64,s74,3956736
s_add_u32 m0,s75,10240
s_nop 0
buffer_load_dwordx4 v8,s[32:35],s64 offen  lds
s_add_u32 s64,s74,3985408
s_add_u32 m0,s75,11264
s_nop 0
buffer_load_dwordx4 v9,s[32:35],s64 offen  lds
s_add_u32 s64,s74,4014080
s_add_u32 m0,s75,12288
s_nop 0
buffer_load_dwordx4 v8,s[32:35],s64 offen  lds
s_add_u32 s64,s74,4042752
s_add_u32 m0,s75,13312
s_nop 0
buffer_load_dwordx4 v9,s[32:35],s64 offen  lds
s_add_u32 s64,s74,4071424
s_add_u32 m0,s75,14336
s_nop 0
buffer_load_dwordx4 v8,s[32:35],s64 offen  lds
s_add_u32 s64,s74,4100096
s_add_u32 m0,s75,15360
s_nop 0
buffer_load_dwordx4 v9,s[32:35],s64 offen  lds
s_waitcnt vmcnt(16)
s_barrier
ds_read_b64_tr_b16 a[32:33],v12 offset:0
ds_read_b64_tr_b16 a[160:161],v13 offset:0
ds_read_b64_tr_b16 a[34:35],v12 offset:4096
ds_read_b64_tr_b16 a[162:163],v13 offset:4096
ds_read_b64_tr_b16 a[36:37],v12 offset:8192
ds_read_b64_tr_b16 a[164:165],v13 offset:8192
ds_read_b64_tr_b16 a[38:39],v12 offset:12288
ds_read_b64_tr_b16 a[166:167],v13 offset:12288
s_waitcnt lgkmcnt(4)
ds_read_b64_tr_b16 a[40:41],v12 offset:16384
ds_read_b64_tr_b16 a[168:169],v13 offset:16384
ds_read_b64_tr_b16 a[42:43],v12 offset:20480
ds_read_b64_tr_b16 a[170:171],v13 offset:20480
ds_read_b64_tr_b16 a[44:45],v12 offset:24576
ds_read_b64_tr_b16 a[172:173],v13 offset:24576
ds_read_b64_tr_b16 a[46:47],v12 offset:28672
ds_read_b64_tr_b16 a[174:175],v13 offset:28672
s_waitcnt lgkmcnt(4)
ds_read_b64_tr_b16 a[48:49],v12 offset:32768
ds_read_b64_tr_b16 a[176:177],v13 offset:32768
ds_read_b64_tr_b16 a[50:51],v12 offset:36864
ds_read_b64_tr_b16 a[178:179],v13 offset:36864
ds_read_b64_tr_b16 a[52:53],v12 offset:40960
ds_read_b64_tr_b16 a[180:181],v13 offset:40960
ds_read_b64_tr_b16 a[54:55],v12 offset:45056
ds_read_b64_tr_b16 a[182:183],v13 offset:45056
s_waitcnt lgkmcnt(4)
ds_read_b64_tr_b16 a[56:57],v12 offset:49152
ds_read_b64_tr_b16 a[184:185],v13 offset:49152
ds_read_b64_tr_b16 a[58:59],v12 offset:53248
ds_read_b64_tr_b16 a[186:187],v13 offset:53248
ds_read_b64_tr_b16 a[60:61],v12 offset:57344
ds_read_b64_tr_b16 a[188:189],v13 offset:57344
ds_read_b64_tr_b16 a[62:63],v12 offset:61440
ds_read_b64_tr_b16 a[190:191],v13 offset:61440
s_waitcnt lgkmcnt(4)
v_xor_b32 v12,0x10000,v12
v_xor_b32 v13,0x10000,v13
s_waitcnt lgkmcnt(0)
s_barrier
s_add_u32 s64,s74,5505024
s_add_u32 m0,s75,65536
s_nop 0
buffer_load_dwordx4 v8,s[32:35],s64 offen  lds
s_add_u32 s64,s74,5533696
s_add_u32 m0,s75,66560
s_nop 0
buffer_load_dwordx4 v9,s[32:35],s64 offen  lds
s_add_u32 s64,s74,5562368
s_add_u32 m0,s75,67584
s_nop 0
buffer_load_dwordx4 v8,s[32:35],s64 offen  lds
s_add_u32 s64,s74,5591040
s_add_u32 m0,s75,68608
s_nop 0
buffer_load_dwordx4 v9,s[32:35],s64 offen  lds
s_add_u32 s64,s74,5619712
s_add_u32 m0,s75,69632
s_nop 0
buffer_load_dwordx4 v8,s[32:35],s64 offen  lds
s_add_u32 s64,s74,5648384
s_add_u32 m0,s75,70656
s_nop 0
buffer_load_dwordx4 v9,s[32:35],s64 offen  lds
s_add_u32 s64,s74,5677056
s_add_u32 m0,s75,71680
s_nop 0
buffer_load_dwordx4 v8,s[32:35],s64 offen  lds
s_add_u32 s64,s74,5705728
s_add_u32 m0,s75,72704
s_nop 0
buffer_load_dwordx4 v9,s[32:35],s64 offen  lds
s_add_u32 s64,s74,5734400
s_add_u32 m0,s75,73728
s_nop 0
buffer_load_dwordx4 v8,s[32:35],s64 offen  lds
s_add_u32 s64,s74,5763072
s_add_u32 m0,s75,74752
s_nop 0
buffer_load_dwordx4 v9,s[32:35],s64 offen  lds
s_add_u32 s64,s74,5791744
s_add_u32 m0,s75,75776
s_nop 0
buffer_load_dwordx4 v8,s[32:35],s64 offen  lds
s_add_u32 s64,s74,5820416
s_add_u32 m0,s75,76800
s_nop 0
buffer_load_dwordx4 v9,s[32:35],s64 offen  lds
s_add_u32 s64,s74,5849088
s_add_u32 m0,s75,77824
s_nop 0
buffer_load_dwordx4 v8,s[32:35],s64 offen  lds
s_add_u32 s64,s74,5877760
s_add_u32 m0,s75,78848
s_nop 0
buffer_load_dwordx4 v9,s[32:35],s64 offen  lds
s_add_u32 s64,s74,5906432
s_add_u32 m0,s75,79872
s_nop 0
buffer_load_dwordx4 v8,s[32:35],s64 offen  lds
s_add_u32 s64,s74,5935104
s_add_u32 m0,s75,80896
s_nop 0
buffer_load_dwordx4 v9,s[32:35],s64 offen  lds
s_waitcnt vmcnt(16)
s_barrier
ds_read_b64_tr_b16 a[64:65],v12 offset:0
ds_read_b64_tr_b16 a[192:193],v13 offset:0
ds_read_b64_tr_b16 a[66:67],v12 offset:4096
ds_read_b64_tr_b16 a[194:195],v13 offset:4096
ds_read_b64_tr_b16 a[68:69],v12 offset:8192
ds_read_b64_tr_b16 a[196:197],v13 offset:8192
ds_read_b64_tr_b16 a[70:71],v12 offset:12288
ds_read_b64_tr_b16 a[198:199],v13 offset:12288
s_waitcnt lgkmcnt(4)
ds_read_b64_tr_b16 a[72:73],v12 offset:16384
ds_read_b64_tr_b16 a[200:201],v13 offset:16384
ds_read_b64_tr_b16 a[74:75],v12 offset:20480
ds_read_b64_tr_b16 a[202:203],v13 offset:20480
ds_read_b64_tr_b16 a[76:77],v12 offset:24576
ds_read_b64_tr_b16 a[204:205],v13 offset:24576
ds_read_b64_tr_b16 a[78:79],v12 offset:28672
ds_read_b64_tr_b16 a[206:207],v13 offset:28672
s_waitcnt lgkmcnt(4)
ds_read_b64_tr_b16 a[80:81],v12 offset:32768
ds_read_b64_tr_b16 a[208:209],v13 offset:32768
ds_read_b64_tr_b16 a[82:83],v12 offset:36864
ds_read_b64_tr_b16 a[210:211],v13 offset:36864
ds_read_b64_tr_b16 a[84:85],v12 offset:40960
ds_read_b64_tr_b16 a[212:213],v13 offset:40960
ds_read_b64_tr_b16 a[86:87],v12 offset:45056
ds_read_b64_tr_b16 a[214:215],v13 offset:45056
s_waitcnt lgkmcnt(4)
ds_read_b64_tr_b16 a[88:89],v12 offset:49152
ds_read_b64_tr_b16 a[216:217],v13 offset:49152
ds_read_b64_tr_b16 a[90:91],v12 offset:53248
ds_read_b64_tr_b16 a[218:219],v13 offset:53248
ds_read_b64_tr_b16 a[92:93],v12 offset:57344
ds_read_b64_tr_b16 a[220:221],v13 offset:57344
ds_read_b64_tr_b16 a[94:95],v12 offset:61440
ds_read_b64_tr_b16 a[222:223],v13 offset:61440
s_waitcnt lgkmcnt(4)
v_xor_b32 v12,0x10000,v12
v_xor_b32 v13,0x10000,v13
s_waitcnt lgkmcnt(0)
s_barrier
s_waitcnt vmcnt(0)
s_barrier
ds_read_b64_tr_b16 a[96:97],v12 offset:0
ds_read_b64_tr_b16 a[224:225],v13 offset:0
ds_read_b64_tr_b16 a[98:99],v12 offset:4096
ds_read_b64_tr_b16 a[226:227],v13 offset:4096
ds_read_b64_tr_b16 a[100:101],v12 offset:8192
ds_read_b64_tr_b16 a[228:229],v13 offset:8192
ds_read_b64_tr_b16 a[102:103],v12 offset:12288
ds_read_b64_tr_b16 a[230:231],v13 offset:12288
s_waitcnt lgkmcnt(4)
ds_read_b64_tr_b16 a[104:105],v12 offset:16384
ds_read_b64_tr_b16 a[232:233],v13 offset:16384
ds_read_b64_tr_b16 a[106:107],v12 offset:20480
ds_read_b64_tr_b16 a[234:235],v13 offset:20480
ds_read_b64_tr_b16 a[108:109],v12 offset:24576
ds_read_b64_tr_b16 a[236:237],v13 offset:24576
ds_read_b64_tr_b16 a[110:111],v12 offset:28672
ds_read_b64_tr_b16 a[238:239],v13 offset:28672
s_waitcnt lgkmcnt(4)
ds_read_b64_tr_b16 a[112:113],v12 offset:32768
ds_read_b64_tr_b16 a[240:241],v13 offset:32768
ds_read_b64_tr_b16 a[114:115],v12 offset:36864
ds_read_b64_tr_b16 a[242:243],v13 offset:36864
ds_read_b64_tr_b16 a[116:117],v12 offset:40960
ds_read_b64_tr_b16 a[244:245],v13 offset:40960
ds_read_b64_tr_b16 a[118:119],v12 offset:45056
ds_read_b64_tr_b16 a[246:247],v13 offset:45056
s_waitcnt lgkmcnt(4)
ds_read_b64_tr_b16 a[120:121],v12 offset:49152
ds_read_b64_tr_b16 a[248:249],v13 offset:49152
ds_read_b64_tr_b16 a[122:123],v12 offset:53248
ds_read_b64_tr_b16 a[250:251],v13 offset:53248
ds_read_b64_tr_b16 a[124:125],v12 offset:57344
ds_read_b64_tr_b16 a[252:253],v13 offset:57344
ds_read_b64_tr_b16 a[126:127],v12 offset:61440
ds_read_b64_tr_b16 a[254:255],v13 offset:61440
s_waitcnt lgkmcnt(4)
v_xor_b32 v12,0x10000,v12
v_xor_b32 v13,0x10000,v13
s_waitcnt lgkmcnt(0)
s_barrier
v_mov_b32 v80,0x3f803f80
v_mov_b32 v81,0x3f803f80
v_mov_b32 v82,0x3f803f80
v_mov_b32 v83,0x3f803f80
s_nop 1
v_mfma_f32_16x16x32_bf16 v[132:135],a[0:3],v[80:83],0
v_mfma_f32_16x16x32_bf16 v[136:139],a[128:131],v[80:83],0
v_mfma_f32_16x16x32_bf16 v[132:135],a[4:7],v[80:83],v[132:135]
v_mfma_f32_16x16x32_bf16 v[136:139],a[132:135],v[80:83],v[136:139]
v_mfma_f32_16x16x32_bf16 v[132:135],a[8:11],v[80:83],v[132:135]
v_mfma_f32_16x16x32_bf16 v[136:139],a[136:139],v[80:83],v[136:139]
v_mfma_f32_16x16x32_bf16 v[132:135],a[12:15],v[80:83],v[132:135]
v_mfma_f32_16x16x32_bf16 v[136:139],a[140:143],v[80:83],v[136:139]
v_mfma_f32_16x16x32_bf16 v[132:135],a[16:19],v[80:83],v[132:135]
v_mfma_f32_16x16x32_bf16 v[136:139],a[144:147],v[80:83],v[136:139]
v_mfma_f32_16x16x32_bf16 v[132:135],a[20:23],v[80:83],v[132:135]
v_mfma_f32_16x16x32_bf16 v[136:139],a[148:151],v[80:83],v[136:139]
v_mfma_f32_16x16x32_bf16 v[132:135],a[24:27],v[80:83],v[132:135]
v_mfma_f32_16x16x32_bf16 v[136:139],a[152:155],v[80:83],v[136:139]
v_mfma_f32_16x16x32_bf16 v[132:135],a[28:31],v[80:83],v[132:135]
v_mfma_f32_16x16x32_bf16 v[136:139],a[156:159],v[80:83],v[136:139]
v_mfma_f32_16x16x32_bf16 v[132:135],a[32:35],v[80:83],v[132:135]
v_mfma_f32_16x16x32_bf16 v[136:139],a[160:163],v[80:83],v[136:139]
v_mfma_f32_16x16x32_bf16 v[132:135],a[36:39],v[80:83],v[132:135]
v_mfma_f32_16x16x32_bf16 v[136:139],a[164:167],v[80:83],v[136:139]
v_mfma_f32_16x16x32_bf16 v[132:135],a[40:43],v[80:83],v[132:135]
v_mfma_f32_16x16x32_bf16 v[136:139],a[168:171],v[80:83],v[136:139]
v_mfma_f32_16x16x32_bf16 v[132:135],a[44:47],v[80:83],v[132:135]
v_mfma_f32_16x16x32_bf16 v[136:139],a[172:175],v[80:83],v[136:139]
v_mfma_f32_16x16x32_bf16 v[132:135],a[48:51],v[80:83],v[132:135]
v_mfma_f32_16x16x32_bf16 v[136:139],a[176:179],v[80:83],v[136:139]
v_mfma_f32_16x16x32_bf16 v[132:135],a[52:55],v[80:83],v[132:135]
v_mfma_f32_16x16x32_bf16 v[136:139],a[180:183],v[80:83],v[136:139]
v_mfma_f32_16x16x32_bf16 v[132:135],a[56:59],v[80:83],v[132:135]
v_mfma_f32_16x16x32_bf16 v[136:139],a[184:187],v[80:83],v[136:139]
v_mfma_f32_16x16x32_bf16 v[132:135],a[60:63],v[80:83],v[132:135]
v_mfma_f32_16x16x32_bf16 v[136:139],a[188:191],v[80:83],v[136:139]
v_mfma_f32_16x16x32_bf16 v[132:135],a[64:67],v[80:83],v[132:135]
v_mfma_f32_16x16x32_bf16 v[136:139],a[192:195],v[80:83],v[136:139]
v_mfma_f32_16x16x32_bf16 v[132:135],a[68:71],v[80:83],v[132:135]
v_mfma_f32_16x16x32_bf16 v[136:139],a[196:199],v[80:83],v[136:139]
v_mfma_f32_16x16x32_bf16 v[132:135],a[72:75],v[80:83],v[132:135]
v_mfma_f32_16x16x32_bf16 v[136:139],a[200:203],v[80:83],v[136:139]
v_mfma_f32_16x16x32_bf16 v[132:135],a[76:79],v[80:83],v[132:135]
v_mfma_f32_16x16x32_bf16 v[136:139],a[204:207],v[80:83],v[136:139]
v_mfma_f32_16x16x32_bf16 v[132:135],a[80:83],v[80:83],v[132:135]
v_mfma_f32_16x16x32_bf16 v[136:139],a[208:211],v[80:83],v[136:139]
v_mfma_f32_16x16x32_bf16 v[132:135],a[84:87],v[80:83],v[132:135]
v_mfma_f32_16x16x32_bf16 v[136:139],a[212:215],v[80:83],v[136:139]
v_mfma_f32_16x16x32_bf16 v[132:135],a[88:91],v[80:83],v[132:135]
v_mfma_f32_16x16x32_bf16 v[136:139],a[216:219],v[80:83],v[136:139]
v_mfma_f32_16x16x32_bf16 v[132:135],a[92:95],v[80:83],v[132:135]
v_mfma_f32_16x16x32_bf16 v[136:139],a[220:223],v[80:83],v[136:139]
v_mfma_f32_16x16x32_bf16 v[132:135],a[96:99],v[80:83],v[132:135]
v_mfma_f32_16x16x32_bf16 v[136:139],a[224:227],v[80:83],v[136:139]
v_mfma_f32_16x16x32_bf16 v[132:135],a[100:103],v[80:83],v[132:135]
v_mfma_f32_16x16x32_bf16 v[136:139],a[228:231],v[80:83],v[136:139]
v_mfma_f32_16x16x32_bf16 v[132:135],a[104:107],v[80:83],v[132:135]
v_mfma_f32_16x16x32_bf16 v[136:139],a[232:235],v[80:83],v[136:139]
v_mfma_f32_16x16x32_bf16 v[132:135],a[108:111],v[80:83],v[132:135]
v_mfma_f32_16x16x32_bf16 v[136:139],a[236:239],v[80:83],v[136:139]
v_mfma_f32_16x16x32_bf16 v[132:135],a[112:115],v[80:83],v[132:135]
v_mfma_f32_16x16x32_bf16 v[136:139],a[240:243],v[80:83],v[136:139]
v_mfma_f32_16x16x32_bf16 v[132:135],a[116:119],v[80:83],v[132:135]
v_mfma_f32_16x16x32_bf16 v[136:139],a[244:247],v[80:83],v[136:139]
v_mfma_f32_16x16x32_bf16 v[132:135],a[120:123],v[80:83],v[132:135]
v_mfma_f32_16x16x32_bf16 v[136:139],a[248:251],v[80:83],v[136:139]
v_mfma_f32_16x16x32_bf16 v[132:135],a[124:127],v[80:83],v[132:135]
v_mfma_f32_16x16x32_bf16 v[136:139],a[252:255],v[80:83],v[136:139]
v_and_b32 v21,1,v1
v_mul_u32_u24 v21,896,v21
s_mov_b32 s65,21052032
s_mov_b32 s66,1792
pl_240:
buffer_load_dword v22,v21,s[20:23],s65 offen sc1
s_waitcnt vmcnt(0)
v_cmp_gt_u32 vcc,s66,v22
s_cbranch_vccz pok_241
s_sleep 1
s_sub_u32 s90,s90,1
s_cmp_gt_i32 s90,0
s_cbranch_scc1 pl_240
pok_241:
s_mov_b32 s81,0xbdd2d3e8
v_mov_b32 v28,0xc0135761
s_lshr_b32 s41,s59,3
s_and_b32 s42,s59,7
s_mul_i32 s64,s42,3
s_add_u32 s64,s64,s50
s_lshr_b32 s65,s42,1
s_add_u32 s65,s65,24
s_cmp_eq_u32 s50,3
s_cselect_b32 s64,s65,s64
s_and_b32 s65,s42,1
s_lshl_b32 s65,s65,3
s_cmp_eq_u32 s50,3
s_cselect_b32 s65,s65,0
s_and_b32 s66,s64,3
s_lshl_b32 s66,s66,11
s_add_u32 s65,s65,s66
s_lshr_b32 s64,s64,2
s_mul_i32 s66,s41,7
s_add_u32 s64,s64,s66
s_add_u32 s64,s64,81
s_lshl_b32 s64,s64,14
s_add_u32 s64,s64,s65
v_add_u32 v18,s64,v16
v_mov_b32 v17,v16
v_lshlrev_b32 v19,4,v3
v_add_u32 v19,131072,v19
v_and_b32 v21,31,v1
v_lshlrev_b32 v21,2,v21
s_add_u32 s74,s63,3584
s_lshr_b32 s64,s50,1
s_lshl_b32 s64,s64,14
s_and_b32 s75,s50,1
s_lshl_b32 s75,s75,12
s_add_u32 s75,s75,s64
s_add_u32 s75,s75,1179648
s_lshl_b32 s64,s50,1
s_add_u32 s64,s64,s59
s_and_b32 s64,s64,7
s_add_u32 s64,s64,72
s_lshl_b32 s64,s64,14
v_lshl_add_u32 v2,v1,7,s64
s_lshl_b32 s72,s50,12
s_lshl_b32 s64,s41,7
s_lshl_b32 s73,s42,4
s_add_u32 s73,s73,s64
s_lshl_b32 s64,s50,2
s_add_u32 s73,s73,s64
s_add_u32 s73,s73,s63
s_add_u32 s73,s73,4096
s_cmp_eq_u32 s50,3
s_cbranch_scc1 w3b_242
w3l_243:
s_add_u32 s64,s79,0
s_lshl_b32 s70,s64,21
s_lshl_b32 s64,s64,13
s_and_b32 s64,s64,0x2000
s_xor_b32 s64,s64,s62
s_add_u32 s70,s70,s64
s_add_u32 s70,s70,29360128
s_add_u32 s64,s79,1
s_lshl_b32 s89,s64,21
s_lshl_b32 s64,s64,13
s_and_b32 s64,s64,0x2000
s_xor_b32 s64,s64,s62
s_add_u32 s89,s89,s64
s_add_u32 s89,s89,29360128
s_xor_b32 s91,s72,0x10000
s_add_u32 s66,s70,1310720
s_add_u32 s67,s66,4096
s_waitcnt vmcnt(5)
s_cmp_lg_u32 s83,0
s_cbranch_scc1 pre_244
v_cmp_gt_u32 vcc,s71,v29
s_cbranch_vccz nopoll_245
pl_246:
buffer_load_dword v22,v21,s[20:23],s74 offen sc1
s_waitcnt vmcnt(0)
v_cmp_gt_u32 vcc,s71,v22
s_cbranch_vccz pok_247
s_sleep 1
s_sub_u32 s90,s90,1
s_cmp_gt_i32 s90,0
s_cbranch_scc1 pl_246
pok_247:
v_mov_b32 v29,v22
nopoll_245:
s_add_u32 m0,s72,0
s_add_u32 s65,s70,s75
s_add_u32 s65,s65,0
buffer_load_dwordx4 v16,s[20:23],s65 offen offset:0 sc1 lds
buffer_load_dwordx4 v16,s[20:23],s65 offen offset:1024 sc1 lds
buffer_load_dwordx4 v16,s[20:23],s65 offen offset:2048 sc1 lds
buffer_load_dwordx4 v16,s[20:23],s65 offen offset:3072 sc1 lds
s_add_u32 m0,s72,16384
s_add_u32 s65,s70,s75
s_add_u32 s65,s65,32768
buffer_load_dwordx4 v16,s[20:23],s65 offen offset:0 sc1 lds
buffer_load_dwordx4 v16,s[20:23],s65 offen offset:1024 sc1 lds
buffer_load_dwordx4 v16,s[20:23],s65 offen offset:2048 sc1 lds
buffer_load_dwordx4 v16,s[20:23],s65 offen offset:3072 sc1 lds
s_add_u32 m0,s72,32768
s_add_u32 s65,s70,s75
s_add_u32 s65,s65,65536
buffer_load_dwordx4 v16,s[20:23],s65 offen offset:0 sc1 lds
buffer_load_dwordx4 v16,s[20:23],s65 offen offset:1024 sc1 lds
buffer_load_dwordx4 v16,s[20:23],s65 offen offset:2048 sc1 lds
buffer_load_dwordx4 v16,s[20:23],s65 offen offset:3072 sc1 lds
s_add_u32 m0,s72,49152
s_add_u32 s65,s70,s75
s_add_u32 s65,s65,98304
buffer_load_dwordx4 v16,s[20:23],s65 offen offset:0 sc1 lds
buffer_load_dwordx4 v16,s[20:23],s65 offen offset:1024 sc1 lds
buffer_load_dwordx4 v16,s[20:23],s65 offen offset:2048 sc1 lds
buffer_load_dwordx4 v16,s[20:23],s65 offen offset:3072 sc1 lds
pre_244:
s_add_u32 s64,s71,1
v_cmp_gt_u32 vcc,s64,v29
s_cmp_eq_u64 vcc,0
s_cselect_b32 s83,1,0
s_cselect_b32 s89,s89,0x7fff0000
s_waitcnt vmcnt(12)
s_barrier
ds_read_b128 v[32:35],v17 offset:0
ds_read_b128 v[36:39],v17 offset:1024
ds_read_b128 v[40:43],v17 offset:2048
s_waitcnt lgkmcnt(2)
v_mfma_f32_16x16x32_bf16 v[64:67],a[0:3],v[32:35],0
ds_read_b128 v[44:47],v17 offset:3072
v_mfma_f32_16x16x32_bf16 v[72:75],a[128:131],v[32:35],0
s_waitcnt lgkmcnt(2)
v_min_u32 v27,v32,v36
v_mfma_f32_16x16x32_bf16 v[68:71],a[0:3],v[36:39],0
ds_read_b128 v[32:35],v17 offset:4096
s_add_u32 m0,s91,0
s_add_u32 s65,s89,s75
s_add_u32 s65,s65,0
v_mfma_f32_16x16x32_bf16 v[76:79],a[128:131],v[36:39],0
s_waitcnt lgkmcnt(2)
v_mfma_f32_16x16x32_bf16 v[64:67],a[4:7],v[40:43],v[64:67]
ds_read_b128 v[36:39],v17 offset:5120
v_mfma_f32_16x16x32_bf16 v[72:75],a[132:135],v[40:43],v[72:75]
s_waitcnt lgkmcnt(2)
v_min3_u32 v27,v27,v40,v44
v_mfma_f32_16x16x32_bf16 v[68:71],a[4:7],v[44:47],v[68:71]
ds_read_b128 v[40:43],v17 offset:6144
buffer_load_dwordx4 v16,s[20:23],s65 offen offset:0 sc1 lds
v_mfma_f32_16x16x32_bf16 v[76:79],a[132:135],v[44:47],v[76:79]
s_waitcnt lgkmcnt(2)
v_mfma_f32_16x16x32_bf16 v[64:67],a[8:11],v[32:35],v[64:67]
ds_read_b128 v[44:47],v17 offset:7168
v_mfma_f32_16x16x32_bf16 v[72:75],a[136:139],v[32:35],v[72:75]
s_waitcnt lgkmcnt(2)
v_min3_u32 v27,v27,v32,v36
v_mfma_f32_16x16x32_bf16 v[68:71],a[8:11],v[36:39],v[68:71]
ds_read_b128 v[32:35],v17 offset:8192
v_mfma_f32_16x16x32_bf16 v[76:79],a[136:139],v[36:39],v[76:79]
buffer_load_dwordx4 v16,s[20:23],s65 offen offset:1024 sc1 lds
s_waitcnt lgkmcnt(2)
v_mfma_f32_16x16x32_bf16 v[64:67],a[12:15],v[40:43],v[64:67]
ds_read_b128 v[36:39],v17 offset:9216
v_mfma_f32_16x16x32_bf16 v[72:75],a[140:143],v[40:43],v[72:75]
s_waitcnt lgkmcnt(2)
v_min3_u32 v27,v27,v40,v44
v_mfma_f32_16x16x32_bf16 v[68:71],a[12:15],v[44:47],v[68:71]
ds_read_b128 v[40:43],v17 offset:10240
v_mfma_f32_16x16x32_bf16 v[76:79],a[140:143],v[44:47],v[76:79]
s_waitcnt lgkmcnt(2)
v_mfma_f32_16x16x32_bf16 v[64:67],a[16:19],v[32:35],v[64:67]
ds_read_b128 v[44:47],v17 offset:11264
buffer_load_dwordx4 v16,s[20:23],s65 offen offset:2048 sc1 lds
v_mfma_f32_16x16x32_bf16 v[72:75],a[144:147],v[32:35],v[72:75]
s_waitcnt lgkmcnt(2)
v_min3_u32 v27,v27,v32,v36
v_mfma_f32_16x16x32_bf16 v[68:71],a[16:19],v[36:39],v[68:71]
ds_read_b128 v[32:35],v17 offset:12288
v_mfma_f32_16x16x32_bf16 v[76:79],a[144:147],v[36:39],v[76:79]
s_waitcnt lgkmcnt(2)
v_mfma_f32_16x16x32_bf16 v[64:67],a[20:23],v[40:43],v[64:67]
ds_read_b128 v[36:39],v17 offset:13312
buffer_load_dwordx4 v16,s[20:23],s65 offen offset:3072 sc1 lds
v_mfma_f32_16x16x32_bf16 v[72:75],a[148:151],v[40:43],v[72:75]
s_waitcnt lgkmcnt(2)
v_min3_u32 v27,v27,v40,v44
v_mfma_f32_16x16x32_bf16 v[68:71],a[20:23],v[44:47],v[68:71]
ds_read_b128 v[40:43],v17 offset:14336
v_mfma_f32_16x16x32_bf16 v[76:79],a[148:151],v[44:47],v[76:79]
s_waitcnt lgkmcnt(2)
v_mfma_f32_16x16x32_bf16 v[64:67],a[24:27],v[32:35],v[64:67]
ds_read_b128 v[44:47],v17 offset:15360
v_mfma_f32_16x16x32_bf16 v[72:75],a[152:155],v[32:35],v[72:75]
s_add_u32 m0,s91,16384
s_add_u32 s65,s89,s75
s_add_u32 s65,s65,32768
s_waitcnt lgkmcnt(2)
v_min3_u32 v27,v27,v32,v36
v_mfma_f32_16x16x32_bf16 v[68:71],a[24:27],v[36:39],v[68:71]
s_waitcnt vmcnt(12)
s_barrier
ds_read_b128 v[32:35],v17 offset:16384
v_mfma_f32_16x16x32_bf16 v[76:79],a[152:155],v[36:39],v[76:79]
s_waitcnt lgkmcnt(2)
v_mfma_f32_16x16x32_bf16 v[64:67],a[28:31],v[40:43],v[64:67]
ds_read_b128 v[36:39],v17 offset:17408
v_mfma_f32_16x16x32_bf16 v[72:75],a[156:159],v[40:43],v[72:75]
s_waitcnt lgkmcnt(2)
v_min3_u32 v27,v27,v40,v44
v_mfma_f32_16x16x32_bf16 v[68:71],a[28:31],v[44:47],v[68:71]
ds_read_b128 v[40:43],v17 offset:18432
buffer_load_dwordx4 v16,s[20:23],s65 offen offset:0 sc1 lds
v_mfma_f32_16x16x32_bf16 v[76:79],a[156:159],v[44:47],v[76:79]
s_waitcnt lgkmcnt(2)
v_mfma_f32_16x16x32_bf16 v[64:67],a[32:35],v[32:35],v[64:67]
ds_read_b128 v[44:47],v17 offset:19456
v_mfma_f32_16x16x32_bf16 v[72:75],a[160:163],v[32:35],v[72:75]
s_waitcnt lgkmcnt(2)
v_min3_u32 v27,v27,v32,v36
v_mfma_f32_16x16x32_bf16 v[68:71],a[32:35],v[36:39],v[68:71]
ds_read_b128 v[32:35],v17 offset:20480
buffer_load_dwordx4 v16,s[20:23],s65 offen offset:1024 sc1 lds
v_mfma_f32_16x16x32_bf16 v[76:79],a[160:163],v[36:39],v[76:79]
s_waitcnt lgkmcnt(2)
v_mfma_f32_16x16x32_bf16 v[64:67],a[36:39],v[40:43],v[64:67]
ds_read_b128 v[36:39],v17 offset:21504
v_mfma_f32_16x16x32_bf16 v[72:75],a[164:167],v[40:43],v[72:75]
s_waitcnt lgkmcnt(2)
v_min3_u32 v27,v27,v40,v44
v_mfma_f32_16x16x32_bf16 v[68:71],a[36:39],v[44:47],v[68:71]
ds_read_b128 v[40:43],v17 offset:22528
v_mfma_f32_16x16x32_bf16 v[76:79],a[164:167],v[44:47],v[76:79]
buffer_load_dwordx4 v16,s[20:23],s65 offen offset:2048 sc1 lds
s_waitcnt lgkmcnt(2)
v_mfma_f32_16x16x32_bf16 v[64:67],a[40:43],v[32:35],v[64:67]
ds_read_b128 v[44:47],v17 offset:23552
v_mfma_f32_16x16x32_bf16 v[72:75],a[168:171],v[32:35],v[72:75]
s_waitcnt lgkmcnt(2)
v_min3_u32 v27,v27,v32,v36
v_mfma_f32_16x16x32_bf16 v[68:71],a[40:43],v[36:39],v[68:71]
ds_read_b128 v[32:35],v17 offset:24576
v_mfma_f32_16x16x32_bf16 v[76:79],a[168:171],v[36:39],v[76:79]
s_waitcnt lgkmcnt(2)
v_mfma_f32_16x16x32_bf16 v[64:67],a[44:47],v[40:43],v[64:67]
ds_read_b128 v[36:39],v17 offset:25600
buffer_load_dwordx4 v16,s[20:23],s65 offen offset:3072 sc1 lds
v_mfma_f32_16x16x32_bf16 v[72:75],a[172:175],v[40:43],v[72:75]
s_waitcnt lgkmcnt(2)
v_min3_u32 v27,v27,v40,v44
v_mfma_f32_16x16x32_bf16 v[68:71],a[44:47],v[44:47],v[68:71]
ds_read_b128 v[40:43],v17 offset:26624
v_mfma_f32_16x16x32_bf16 v[76:79],a[172:175],v[44:47],v[76:79]
s_waitcnt lgkmcnt(2)
v_mfma_f32_16x16x32_bf16 v[64:67],a[48:51],v[32:35],v[64:67]
ds_read_b128 v[44:47],v17 offset:27648
v_mfma_f32_16x16x32_bf16 v[72:75],a[176:179],v[32:35],v[72:75]
s_add_u32 m0,s91,32768
s_add_u32 s65,s89,s75
s_add_u32 s65,s65,65536
s_waitcnt lgkmcnt(2)
v_min3_u32 v27,v27,v32,v36
v_mfma_f32_16x16x32_bf16 v[68:71],a[48:51],v[36:39],v[68:71]
ds_read_b128 v[32:35],v17 offset:28672
v_mfma_f32_16x16x32_bf16 v[76:79],a[176:179],v[36:39],v[76:79]
s_waitcnt lgkmcnt(2)
v_mfma_f32_16x16x32_bf16 v[64:67],a[52:55],v[40:43],v[64:67]
ds_read_b128 v[36:39],v17 offset:29696
v_mfma_f32_16x16x32_bf16 v[72:75],a[180:183],v[40:43],v[72:75]
buffer_load_dwordx4 v16,s[20:23],s65 offen offset:0 sc1 lds
s_waitcnt lgkmcnt(2)
v_min3_u32 v27,v27,v40,v44
v_mfma_f32_16x16x32_bf16 v[68:71],a[52:55],v[44:47],v[68:71]
ds_read_b128 v[40:43],v17 offset:30720
v_mfma_f32_16x16x32_bf16 v[76:79],a[180:183],v[44:47],v[76:79]
s_waitcnt lgkmcnt(2)
v_mfma_f32_16x16x32_bf16 v[64:67],a[56:59],v[32:35],v[64:67]
ds_read_b128 v[44:47],v17 offset:31744
v_mfma_f32_16x16x32_bf16 v[72:75],a[184:187],v[32:35],v[72:75]
s_waitcnt lgkmcnt(2)
v_min3_u32 v27,v27,v32,v36
v_mfma_f32_16x16x32_bf16 v[68:71],a[56:59],v[36:39],v[68:71]
s_waitcnt vmcnt(13)
s_barrier
ds_read_b128 v[32:35],v17 offset:32768
buffer_load_dwordx4 v16,s[20:23],s65 offen offset:1024 sc1 lds
v_mfma_f32_16x16x32_bf16 v[76:79],a[184:187],v[36:39],v[76:79]
s_waitcnt lgkmcnt(2)
v_mfma_f32_16x16x32_bf16 v[64:67],a[60:63],v[40:43],v[64:67]
ds_read_b128 v[36:39],v17 offset:33792
v_mfma_f32_16x16x32_bf16 v[72:75],a[188:191],v[40:43],v[72:75]
s_waitcnt lgkmcnt(2)
v_min3_u32 v27,v27,v40,v44
v_mfma_f32_16x16x32_bf16 v[68:71],a[60:63],v[44:47],v[68:71]
ds_read_b128 v[40:43],v17 offset:34816
v_mfma_f32_16x16x32_bf16 v[76:79],a[188:191],v[44:47],v[76:79]
buffer_load_dwordx4 v16,s[20:23],s65 offen offset:2048 sc1 lds
s_waitcnt lgkmcnt(2)
v_mfma_f32_16x16x32_bf16 v[64:67],a[64:67],v[32:35],v[64:67]
ds_read_b128 v[44:47],v17 offset:35840
v_mfma_f32_16x16x32_bf16 v[72:75],a[192:195],v[32:35],v[72:75]
s_waitcnt lgkmcnt(2)
v_min3_u32 v27,v27,v32,v36
v_mfma_f32_16x16x32_bf16 v[68:71],a[64:67],v[36:39],v[68:71]
ds_read_b128 v[32:35],v17 offset:36864
v_mfma_f32_16x16x32_bf16 v[76:79],a[192:195],v[36:39],v[76:79]
buffer_load_dwordx4 v16,s[20:23],s65 offen offset:3072 sc1 lds
s_waitcnt lgkmcnt(2)
v_mfma_f32_16x16x32_bf16 v[64:67],a[68:71],v[40:43],v[64:67]
ds_read_b128 v[36:39],v17 offset:37888
v_mfma_f32_16x16x32_bf16 v[72:75],a[196:199],v[40:43],v[72:75]
s_waitcnt lgkmcnt(2)
v_min3_u32 v27,v27,v40,v44
v_mfma_f32_16x16x32_bf16 v[68:71],a[68:71],v[44:47],v[68:71]
ds_read_b128 v[40:43],v17 offset:38912
v_mfma_f32_16x16x32_bf16 v[76:79],a[196:199],v[44:47],v[76:79]
s_waitcnt lgkmcnt(2)
v_mfma_f32_16x16x32_bf16 v[64:67],a[72:75],v[32:35],v[64:67]
ds_read_b128 v[44:47],v17 offset:39936
s_add_u32 m0,s91,49152
s_add_u32 s65,s89,s75
s_add_u32 s65,s65,98304
v_mfma_f32_16x16x32_bf16 v[72:75],a[200:203],v[32:35],v[72:75]
s_waitcnt lgkmcnt(2)
v_min3_u32 v27,v27,v32,v36
v_mfma_f32_16x16x32_bf16 v[68:71],a[72:75],v[36:39],v[68:71]
ds_read_b128 v[32:35],v17 offset:40960
v_mfma_f32_16x16x32_bf16 v[76:79],a[200:203],v[36:39],v[76:79]
s_waitcnt lgkmcnt(2)
v_mfma_f32_16x16x32_bf16 v[64:67],a[76:79],v[40:43],v[64:67]
ds_read_b128 v[36:39],v17 offset:41984
v_mfma_f32_16x16x32_bf16 v[72:75],a[204:207],v[40:43],v[72:75]
buffer_load_dwordx4 v16,s[20:23],s65 offen offset:0 sc1 lds
s_waitcnt lgkmcnt(2)
v_min3_u32 v27,v27,v40,v44
v_mfma_f32_16x16x32_bf16 v[68:71],a[76:79],v[44:47],v[68:71]
ds_read_b128 v[40:43],v17 offset:43008
v_mfma_f32_16x16x32_bf16 v[76:79],a[204:207],v[44:47],v[76:79]
s_waitcnt lgkmcnt(2)
v_mfma_f32_16x16x32_bf16 v[64:67],a[80:83],v[32:35],v[64:67]
ds_read_b128 v[44:47],v17 offset:44032
v_mfma_f32_16x16x32_bf16 v[72:75],a[208:211],v[32:35],v[72:75]
buffer_load_dwordx4 v16,s[20:23],s65 offen offset:1024 sc1 lds
s_waitcnt lgkmcnt(2)
v_min3_u32 v27,v27,v32,v36
v_mfma_f32_16x16x32_bf16 v[68:71],a[80:83],v[36:39],v[68:71]
ds_read_b128 v[32:35],v17 offset:45056
v_mfma_f32_16x16x32_bf16 v[76:79],a[208:211],v[36:39],v[76:79]
s_waitcnt lgkmcnt(2)
v_mfma_f32_16x16x32_bf16 v[64:67],a[84:87],v[40:43],v[64:67]
ds_read_b128 v[36:39],v17 offset:46080
v_mfma_f32_16x16x32_bf16 v[72:75],a[212:215],v[40:43],v[72:75]
s_waitcnt lgkmcnt(2)
v_min3_u32 v27,v27,v40,v44
v_mfma_f32_16x16x32_bf16 v[68:71],a[84:87],v[44:47],v[68:71]
ds_read_b128 v[40:43],v17 offset:47104
buffer_load_dwordx4 v16,s[20:23],s65 offen offset:2048 sc1 lds
v_mfma_f32_16x16x32_bf16 v[76:79],a[212:215],v[44:47],v[76:79]
s_waitcnt lgkmcnt(2)
v_mfma_f32_16x16x32_bf16 v[64:67],a[88:91],v[32:35],v[64:67]
ds_read_b128 v[44:47],v17 offset:48128
v_mfma_f32_16x16x32_bf16 v[72:75],a[216:219],v[32:35],v[72:75]
s_waitcnt lgkmcnt(2)
v_min3_u32 v27,v27,v32,v36
v_mfma_f32_16x16x32_bf16 v[68:71],a[88:91],v[36:39],v[68:71]
s_waitcnt vmcnt(15)
s_barrier
ds_read_b128 v[32:35],v17 offset:49152
v_mfma_f32_16x16x32_bf16 v[76:79],a[216:219],v[36:39],v[76:79]
buffer_load_dwordx4 v16,s[20:23],s65 offen offset:3072 sc1 lds
s_waitcnt lgkmcnt(2)
v_mfma_f32_16x16x32_bf16 v[64:67],a[92:95],v[40:43],v[64:67]
ds_read_b128 v[36:39],v17 offset:50176
v_mfma_f32_16x16x32_bf16 v[72:75],a[220:223],v[40:43],v[72:75]
s_waitcnt lgkmcnt(2)
v_min3_u32 v27,v27,v40,v44
v_mfma_f32_16x16x32_bf16 v[68:71],a[92:95],v[44:47],v[68:71]
ds_read_b128 v[40:43],v17 offset:51200
v_mfma_f32_16x16x32_bf16 v[76:79],a[220:223],v[44:47],v[76:79]
s_waitcnt lgkmcnt(2)
v_mfma_f32_16x16x32_bf16 v[64:67],a[96:99],v[32:35],v[64:67]
ds_read_b128 v[44:47],v17 offset:52224
v_mfma_f32_16x16x32_bf16 v[72:75],a[224:227],v[32:35],v[72:75]
s_waitcnt lgkmcnt(2)
v_min3_u32 v27,v27,v32,v36
v_mfma_f32_16x16x32_bf16 v[68:71],a[96:99],v[36:39],v[68:71]
ds_read_b128 v[32:35],v17 offset:53248
v_mfma_f32_16x16x32_bf16 v[76:79],a[224:227],v[36:39],v[76:79]
s_waitcnt lgkmcnt(2)
v_mfma_f32_16x16x32_bf16 v[64:67],a[100:103],v[40:43],v[64:67]
ds_read_b128 v[36:39],v17 offset:54272
v_mfma_f32_16x16x32_bf16 v[72:75],a[228:231],v[40:43],v[72:75]
s_waitcnt lgkmcnt(2)
v_min3_u32 v27,v27,v40,v44
v_mfma_f32_16x16x32_bf16 v[68:71],a[100:103],v[44:47],v[68:71]
ds_read_b128 v[40:43],v17 offset:55296
v_mfma_f32_16x16x32_bf16 v[76:79],a[228:231],v[44:47],v[76:79]
s_waitcnt lgkmcnt(2)
v_mfma_f32_16x16x32_bf16 v[64:67],a[104:107],v[32:35],v[64:67]
ds_read_b128 v[44:47],v17 offset:56320
v_mfma_f32_16x16x32_bf16 v[72:75],a[232:235],v[32:35],v[72:75]
s_waitcnt lgkmcnt(2)
v_min3_u32 v27,v27,v32,v36
v_mfma_f32_16x16x32_bf16 v[68:71],a[104:107],v[36:39],v[68:71]
ds_read_b128 v[32:35],v17 offset:57344
v_mfma_f32_16x16x32_bf16 v[76:79],a[232:235],v[36:39],v[76:79]
s_waitcnt lgkmcnt(2)
v_mfma_f32_16x16x32_bf16 v[64:67],a[108:111],v[40:43],v[64:67]
ds_read_b128 v[36:39],v17 offset:58368
v_mfma_f32_16x16x32_bf16 v[72:75],a[236:239],v[40:43],v[72:75]
s_waitcnt lgkmcnt(2)
v_min3_u32 v27,v27,v40,v44
v_mfma_f32_16x16x32_bf16 v[68:71],a[108:111],v[44:47],v[68:71]
ds_read_b128 v[40:43],v17 offset:59392
v_mfma_f32_16x16x32_bf16 v[76:79],a[236:239],v[44:47],v[76:79]
s_waitcnt lgkmcnt(2)
v_mfma_f32_16x16x32_bf16 v[64:67],a[112:115],v[32:35],v[64:67]
ds_read_b128 v[44:47],v17 offset:60416
v_mfma_f32_16x16x32_bf16 v[72:75],a[240:243],v[32:35],v[72:75]
s_waitcnt lgkmcnt(2)
v_min3_u32 v27,v27,v32,v36
v_mfma_f32_16x16x32_bf16 v[68:71],a[112:115],v[36:39],v[68:71]
ds_read_b128 v[32:35],v17 offset:61440
v_mfma_f32_16x16x32_bf16 v[76:79],a[240:243],v[36:39],v[76:79]
s_waitcnt lgkmcnt(2)
v_mfma_f32_16x16x32_bf16 v[64:67],a[116:119],v[40:43],v[64:67]
ds_read_b128 v[36:39],v17 offset:62464
v_mfma_f32_16x16x32_bf16 v[72:75],a[244:247],v[40:43],v[72:75]
s_waitcnt lgkmcnt(2)
v_min3_u32 v27,v27,v40,v44
v_mfma_f32_16x16x32_bf16 v[68:71],a[116:119],v[44:47],v[68:71]
ds_read_b128 v[40:43],v17 offset:63488
v_mfma_f32_16x16x32_bf16 v[76:79],a[244:247],v[44:47],v[76:79]
s_waitcnt lgkmcnt(2)
v_mfma_f32_16x16x32_bf16 v[64:67],a[120:123],v[32:35],v[64:67]
s_barrier
ds_read_b128 v[44:47],v17 offset:64512
v_mfma_f32_16x16x32_bf16 v[72:75],a[248:251],v[32:35],v[72:75]
s_waitcnt lgkmcnt(2)
v_min3_u32 v27,v27,v32,v36
v_mfma_f32_16x16x32_bf16 v[68:71],a[120:123],v[36:39],v[68:71]
v_mfma_f32_16x16x32_bf16 v[76:79],a[248:251],v[36:39],v[76:79]
s_waitcnt lgkmcnt(1)
v_mfma_f32_16x16x32_bf16 v[64:67],a[124:127],v[40:43],v[64:67]
v_mfma_f32_16x16x32_bf16 v[72:75],a[252:255],v[40:43],v[72:75]
s_waitcnt lgkmcnt(0)
v_min3_u32 v27,v27,v40,v44
v_mfma_f32_16x16x32_bf16 v[68:71],a[124:127],v[44:47],v[68:71]
v_mfma_f32_16x16x32_bf16 v[76:79],a[252:255],v[44:47],v[76:79]
v_cmp_eq_u32 vcc,0,v27
s_cbranch_vccnz retry_248
valid_249:
buffer_load_dword v29,v21,s[20:23],s74 offen sc1
ds_read_b128 v[112:115],v19
v_xor_b32 v17,0x10000,v17
s_mov_b32 s72,s91
s_waitcnt lgkmcnt(0)
v_mul_f32 v64,v64,v112
v_mul_f32 v65,v65,v112
v_mul_f32 v66,v66,v112
v_mul_f32 v67,v67,v112
v_mul_f32 v72,v72,v112
v_mul_f32 v73,v73,v112
v_mul_f32 v74,v74,v112
v_mul_f32 v75,v75,v112
v_mul_f32 v68,v68,v114
v_mul_f32 v69,v69,v114
v_mul_f32 v70,v70,v114
v_mul_f32 v71,v71,v114
v_mul_f32 v76,v76,v114
v_mul_f32 v77,v77,v114
v_mul_f32 v78,v78,v114
v_mul_f32 v79,v79,v114
v_fmac_f32 v64,v113,v132
v_fmac_f32 v65,v113,v133
v_fmac_f32 v66,v113,v134
v_fmac_f32 v67,v113,v135
v_fmac_f32 v72,v113,v136
v_fmac_f32 v73,v113,v137
v_fmac_f32 v74,v113,v138
v_fmac_f32 v75,v113,v139
v_fmac_f32 v68,v115,v132
v_fmac_f32 v69,v115,v133
v_fmac_f32 v70,v115,v134
v_fmac_f32 v71,v115,v135
v_fmac_f32 v76,v115,v136
v_fmac_f32 v77,v115,v137
v_fmac_f32 v78,v115,v138
v_fmac_f32 v79,v115,v139
v_mul_f32 v80,v64,v64
v_mul_f32 v81,v65,v65
v_mul_f32 v82,v66,v66
v_mul_f32 v83,v67,v67
v_mul_f32 v84,v72,v72
v_mul_f32 v85,v73,v73
v_mul_f32 v86,v74,v74
v_mul_f32 v87,v75,v75
v_mul_f32 v88,v68,v68
v_mul_f32 v89,v69,v69
v_mul_f32 v90,v70,v70
v_mul_f32 v91,v71,v71
v_mul_f32 v92,v76,v76
v_mul_f32 v93,v77,v77
v_mul_f32 v94,v78,v78
v_mul_f32 v95,v79,v79
v_fma_f32 v80,v80,s81,v28
v_fma_f32 v81,v81,s81,v28
v_fma_f32 v82,v82,s81,v28
v_fma_f32 v83,v83,s81,v28
v_fma_f32 v84,v84,s81,v28
v_fma_f32 v85,v85,s81,v28
v_fma_f32 v86,v86,s81,v28
v_fma_f32 v87,v87,s81,v28
v_fma_f32 v88,v88,s81,v28
v_fma_f32 v89,v89,s81,v28
v_fma_f32 v90,v90,s81,v28
v_fma_f32 v91,v91,s81,v28
v_fma_f32 v92,v92,s81,v28
v_fma_f32 v93,v93,s81,v28
v_fma_f32 v94,v94,s81,v28
v_fma_f32 v95,v95,s81,v28
v_mul_f32 v80,v80,v64
v_mul_f32 v81,v81,v65
v_mul_f32 v82,v82,v66
v_mul_f32 v83,v83,v67
v_mul_f32 v84,v84,v72
v_mul_f32 v85,v85,v73
v_mul_f32 v86,v86,v74
v_mul_f32 v87,v87,v75
v_mul_f32 v88,v88,v68
v_mul_f32 v89,v89,v69
v_mul_f32 v90,v90,v70
v_mul_f32 v91,v91,v71
v_mul_f32 v92,v92,v76
v_mul_f32 v93,v93,v77
v_mul_f32 v94,v94,v78
v_mul_f32 v95,v95,v79
v_exp_f32 v80,v80
v_exp_f32 v81,v81
v_exp_f32 v82,v82
v_exp_f32 v83,v83
v_exp_f32 v84,v84
v_exp_f32 v85,v85
v_exp_f32 v86,v86
v_exp_f32 v87,v87
v_exp_f32 v88,v88
v_exp_f32 v89,v89
v_exp_f32 v90,v90
v_exp_f32 v91,v91
v_exp_f32 v92,v92
v_exp_f32 v93,v93
v_exp_f32 v94,v94
v_exp_f32 v95,v95
v_add_f32 v80,1.0,v80
v_add_f32 v81,1.0,v81
v_add_f32 v82,1.0,v82
v_add_f32 v83,1.0,v83
v_add_f32 v84,1.0,v84
v_add_f32 v85,1.0,v85
v_add_f32 v86,1.0,v86
v_add_f32 v87,1.0,v87
v_add_f32 v88,1.0,v88
v_add_f32 v89,1.0,v89
v_add_f32 v90,1.0,v90
v_add_f32 v91,1.0,v91
v_add_f32 v92,1.0,v92
v_add_f32 v93,1.0,v93
v_add_f32 v94,1.0,v94
v_add_f32 v95,1.0,v95
v_rcp_f32 v80,v80
v_rcp_f32 v81,v81
v_rcp_f32 v82,v82
v_rcp_f32 v83,v83
v_rcp_f32 v84,v84
v_rcp_f32 v85,v85
v_rcp_f32 v86,v86
v_rcp_f32 v87,v87
v_rcp_f32 v88,v88
v_rcp_f32 v89,v89
v_rcp_f32 v90,v90
v_rcp_f32 v91,v91
v_rcp_f32 v92,v92
v_rcp_f32 v93,v93
v_rcp_f32 v94,v94
v_rcp_f32 v95,v95
v_mul_f32 v80,v80,v64
v_mul_f32 v81,v81,v65
v_mul_f32 v82,v82,v66
v_mul_f32 v83,v83,v67
v_mul_f32 v84,v84,v72
v_mul_f32 v85,v85,v73
v_mul_f32 v86,v86,v74
v_mul_f32 v87,v87,v75
v_mul_f32 v88,v88,v68
v_mul_f32 v89,v89,v69
v_mul_f32 v90,v90,v70
v_mul_f32 v91,v91,v71
v_mul_f32 v92,v92,v76
v_mul_f32 v93,v93,v77
v_mul_f32 v94,v94,v78
v_mul_f32 v95,v95,v79
v_cvt_pk_bf16_f32 v96,v80,v81
v_cvt_pk_bf16_f32 v97,v82,v83
v_cvt_pk_bf16_f32 v98,v84,v85
v_cvt_pk_bf16_f32 v99,v86,v87
v_max_u32 v96,1,v96
buffer_store_dwordx4 v[96:99],v18,s[20:23],s70 offen offset:0 sc1
v_cvt_pk_bf16_f32 v100,v88,v89
v_cvt_pk_bf16_f32 v101,v90,v91
v_cvt_pk_bf16_f32 v102,v92,v93
v_cvt_pk_bf16_f32 v103,v94,v95
v_max_u32 v100,1,v100
buffer_store_dwordx4 v[100:103],v18,s[20:23],s70 offen offset:1024 sc1
s_mov_b64 exec,1
v_mov_b32 v22,s71
v_mov_b32 v23,0
buffer_store_dword v22,v23,s[20:23],s73 offen sc1
s_mov_b64 exec,-1
s_add_u32 s65,s70,4194304
buffer_store_dwordx4 v[128:131],v18,s[20:23],s65 offen offset:0 sc1
buffer_store_dwordx4 v[128:131],v18,s[20:23],s65 offen offset:1024 sc1
s_add_u32 s79,s79,1
s_add_u32 s71,s71,1
s_cmp_lt_u32 s79,65
s_cbranch_scc1 w3l_243
s_endpgm
retry_248:
s_sub_u32 s90,s90,1
s_cmp_lt_i32 s90,0
s_cbranch_scc1 valid_249
s_mov_b32 s83,1
v_mov_b32 v29,0
s_barrier
s_add_u32 m0,s72,0
s_add_u32 s65,s70,s75
s_add_u32 s65,s65,0
buffer_load_dwordx4 v16,s[20:23],s65 offen offset:0 sc1 lds
buffer_load_dwordx4 v16,s[20:23],s65 offen offset:1024 sc1 lds
buffer_load_dwordx4 v16,s[20:23],s65 offen offset:2048 sc1 lds
buffer_load_dwordx4 v16,s[20:23],s65 offen offset:3072 sc1 lds
s_add_u32 m0,s72,16384
s_add_u32 s65,s70,s75
s_add_u32 s65,s65,32768
buffer_load_dwordx4 v16,s[20:23],s65 offen offset:0 sc1 lds
buffer_load_dwordx4 v16,s[20:23],s65 offen offset:1024 sc1 lds
buffer_load_dwordx4 v16,s[20:23],s65 offen offset:2048 sc1 lds
buffer_load_dwordx4 v16,s[20:23],s65 offen offset:3072 sc1 lds
s_add_u32 m0,s72,32768
s_add_u32 s65,s70,s75
s_add_u32 s65,s65,65536
buffer_load_dwordx4 v16,s[20:23],s65 offen offset:0 sc1 lds
buffer_load_dwordx4 v16,s[20:23],s65 offen offset:1024 sc1 lds
buffer_load_dwordx4 v16,s[20:23],s65 offen offset:2048 sc1 lds
buffer_load_dwordx4 v16,s[20:23],s65 offen offset:3072 sc1 lds
s_add_u32 m0,s72,49152
s_add_u32 s65,s70,s75
s_add_u32 s65,s65,98304
buffer_load_dwordx4 v16,s[20:23],s65 offen offset:0 sc1 lds
buffer_load_dwordx4 v16,s[20:23],s65 offen offset:1024 sc1 lds
buffer_load_dwordx4 v16,s[20:23],s65 offen offset:2048 sc1 lds
buffer_load_dwordx4 v16,s[20:23],s65 offen offset:3072 sc1 lds
s_branch w3l_243
w3b_242:
w3l_250:
s_add_u32 s64,s79,0
s_lshl_b32 s70,s64,21
s_lshl_b32 s64,s64,13
s_and_b32 s64,s64,0x2000
s_xor_b32 s64,s64,s62
s_add_u32 s70,s70,s64
s_add_u32 s70,s70,29360128
s_add_u32 s64,s79,1
s_lshl_b32 s89,s64,21
s_lshl_b32 s64,s64,13
s_and_b32 s64,s64,0x2000
s_xor_b32 s64,s64,s62
s_add_u32 s89,s89,s64
s_add_u32 s89,s89,29360128
s_xor_b32 s91,s72,0x10000
s_add_u32 s66,s70,1310720
s_add_u32 s67,s66,4096
s_waitcnt vmcnt(5)
s_cmp_lg_u32 s83,0
s_cbranch_scc1 pre_251
v_cmp_gt_u32 vcc,s71,v29
s_cbranch_vccz nopoll_252
pl_253:
buffer_load_dword v22,v21,s[20:23],s74 offen sc1
s_waitcnt vmcnt(0)
v_cmp_gt_u32 vcc,s71,v22
s_cbranch_vccz pok_254
s_sleep 1
s_sub_u32 s90,s90,1
s_cmp_gt_i32 s90,0
s_cbranch_scc1 pl_253
pok_254:
v_mov_b32 v29,v22
nopoll_252:
s_add_u32 m0,s72,0
s_add_u32 s65,s70,s75
s_add_u32 s65,s65,0
buffer_load_dwordx4 v16,s[20:23],s65 offen offset:0 sc1 lds
buffer_load_dwordx4 v16,s[20:23],s65 offen offset:1024 sc1 lds
buffer_load_dwordx4 v16,s[20:23],s65 offen offset:2048 sc1 lds
buffer_load_dwordx4 v16,s[20:23],s65 offen offset:3072 sc1 lds
s_add_u32 m0,s72,16384
s_add_u32 s65,s70,s75
s_add_u32 s65,s65,32768
buffer_load_dwordx4 v16,s[20:23],s65 offen offset:0 sc1 lds
buffer_load_dwordx4 v16,s[20:23],s65 offen offset:1024 sc1 lds
buffer_load_dwordx4 v16,s[20:23],s65 offen offset:2048 sc1 lds
buffer_load_dwordx4 v16,s[20:23],s65 offen offset:3072 sc1 lds
s_add_u32 m0,s72,32768
s_add_u32 s65,s70,s75
s_add_u32 s65,s65,65536
buffer_load_dwordx4 v16,s[20:23],s65 offen offset:0 sc1 lds
buffer_load_dwordx4 v16,s[20:23],s65 offen offset:1024 sc1 lds
buffer_load_dwordx4 v16,s[20:23],s65 offen offset:2048 sc1 lds
buffer_load_dwordx4 v16,s[20:23],s65 offen offset:3072 sc1 lds
s_add_u32 m0,s72,49152
s_add_u32 s65,s70,s75
s_add_u32 s65,s65,98304
buffer_load_dwordx4 v16,s[20:23],s65 offen offset:0 sc1 lds
buffer_load_dwordx4 v16,s[20:23],s65 offen offset:1024 sc1 lds
buffer_load_dwordx4 v16,s[20:23],s65 offen offset:2048 sc1 lds
buffer_load_dwordx4 v16,s[20:23],s65 offen offset:3072 sc1 lds
pre_251:
s_add_u32 s64,s71,1
v_cmp_gt_u32 vcc,s64,v29
s_cmp_eq_u64 vcc,0
s_cselect_b32 s83,1,0
s_cselect_b32 s89,s89,0x7fff0000
buffer_load_dwordx4 v[80:83],v16,s[20:23],s66 offen offset:0 sc1
buffer_load_dwordx4 v[84:87],v16,s[20:23],s66 offen offset:1024 sc1
buffer_load_dwordx4 v[88:91],v16,s[20:23],s66 offen offset:2048 sc1
buffer_load_dwordx4 v[92:95],v16,s[20:23],s66 offen offset:3072 sc1
buffer_load_dwordx4 v[96:99],v16,s[20:23],s67 offen offset:0 sc1
buffer_load_dwordx4 v[100:103],v16,s[20:23],s67 offen offset:1024 sc1
buffer_load_dwordx4 v[104:107],v16,s[20:23],s67 offen offset:2048 sc1
buffer_load_dwordx4 v[108:111],v16,s[20:23],s67 offen offset:3072 sc1
s_mov_b32 s82,0x3a800000
s_waitcnt vmcnt(20)
s_barrier
ds_read_b128 v[32:35],v17 offset:0
ds_read_b128 v[36:39],v17 offset:1024
ds_read_b128 v[40:43],v17 offset:2048
s_waitcnt lgkmcnt(2)
v_mfma_f32_16x16x32_bf16 v[64:67],a[0:3],v[32:35],0
ds_read_b128 v[44:47],v17 offset:3072
s_waitcnt lgkmcnt(2)
v_min_u32 v27,v32,v36
v_mfma_f32_16x16x32_bf16 v[68:71],a[0:3],v[36:39],0
ds_read_b128 v[32:35],v17 offset:4096
s_add_u32 m0,s91,0
s_add_u32 s65,s89,s75
s_add_u32 s65,s65,0
s_waitcnt lgkmcnt(2)
v_mfma_f32_16x16x32_bf16 v[64:67],a[4:7],v[40:43],v[64:67]
ds_read_b128 v[36:39],v17 offset:5120
s_waitcnt lgkmcnt(2)
v_min3_u32 v27,v27,v40,v44
v_mfma_f32_16x16x32_bf16 v[68:71],a[4:7],v[44:47],v[68:71]
ds_read_b128 v[40:43],v17 offset:6144
buffer_load_dwordx4 v16,s[20:23],s65 offen offset:0 sc1 lds
s_waitcnt lgkmcnt(2)
v_mfma_f32_16x16x32_bf16 v[64:67],a[8:11],v[32:35],v[64:67]
ds_read_b128 v[44:47],v17 offset:7168
s_waitcnt lgkmcnt(2)
v_min3_u32 v27,v27,v32,v36
v_mfma_f32_16x16x32_bf16 v[68:71],a[8:11],v[36:39],v[68:71]
ds_read_b128 v[32:35],v17 offset:8192
buffer_load_dwordx4 v16,s[20:23],s65 offen offset:1024 sc1 lds
s_waitcnt lgkmcnt(2)
v_mfma_f32_16x16x32_bf16 v[64:67],a[12:15],v[40:43],v[64:67]
ds_read_b128 v[36:39],v17 offset:9216
s_waitcnt lgkmcnt(2)
v_min3_u32 v27,v27,v40,v44
v_mfma_f32_16x16x32_bf16 v[68:71],a[12:15],v[44:47],v[68:71]
ds_read_b128 v[40:43],v17 offset:10240
s_waitcnt lgkmcnt(2)
v_mfma_f32_16x16x32_bf16 v[64:67],a[16:19],v[32:35],v[64:67]
ds_read_b128 v[44:47],v17 offset:11264
buffer_load_dwordx4 v16,s[20:23],s65 offen offset:2048 sc1 lds
s_waitcnt lgkmcnt(2)
v_min3_u32 v27,v27,v32,v36
v_mfma_f32_16x16x32_bf16 v[68:71],a[16:19],v[36:39],v[68:71]
ds_read_b128 v[32:35],v17 offset:12288
s_waitcnt lgkmcnt(2)
v_mfma_f32_16x16x32_bf16 v[64:67],a[20:23],v[40:43],v[64:67]
ds_read_b128 v[36:39],v17 offset:13312
buffer_load_dwordx4 v16,s[20:23],s65 offen offset:3072 sc1 lds
s_waitcnt lgkmcnt(2)
v_min3_u32 v27,v27,v40,v44
v_mfma_f32_16x16x32_bf16 v[68:71],a[20:23],v[44:47],v[68:71]
ds_read_b128 v[40:43],v17 offset:14336
s_waitcnt lgkmcnt(2)
v_mfma_f32_16x16x32_bf16 v[64:67],a[24:27],v[32:35],v[64:67]
ds_read_b128 v[44:47],v17 offset:15360
s_add_u32 m0,s91,16384
s_add_u32 s65,s89,s75
s_add_u32 s65,s65,32768
s_waitcnt lgkmcnt(2)
v_min3_u32 v27,v27,v32,v36
v_mfma_f32_16x16x32_bf16 v[68:71],a[24:27],v[36:39],v[68:71]
s_waitcnt vmcnt(20)
s_barrier
ds_read_b128 v[32:35],v17 offset:16384
s_waitcnt lgkmcnt(2)
v_mfma_f32_16x16x32_bf16 v[64:67],a[28:31],v[40:43],v[64:67]
ds_read_b128 v[36:39],v17 offset:17408
s_waitcnt lgkmcnt(2)
v_min3_u32 v27,v27,v40,v44
v_mfma_f32_16x16x32_bf16 v[68:71],a[28:31],v[44:47],v[68:71]
ds_read_b128 v[40:43],v17 offset:18432
buffer_load_dwordx4 v16,s[20:23],s65 offen offset:0 sc1 lds
s_waitcnt lgkmcnt(2)
v_mfma_f32_16x16x32_bf16 v[64:67],a[32:35],v[32:35],v[64:67]
ds_read_b128 v[44:47],v17 offset:19456
s_waitcnt lgkmcnt(2)
v_min3_u32 v27,v27,v32,v36
v_mfma_f32_16x16x32_bf16 v[68:71],a[32:35],v[36:39],v[68:71]
ds_read_b128 v[32:35],v17 offset:20480
buffer_load_dwordx4 v16,s[20:23],s65 offen offset:1024 sc1 lds
s_waitcnt lgkmcnt(2)
v_mfma_f32_16x16x32_bf16 v[64:67],a[36:39],v[40:43],v[64:67]
ds_read_b128 v[36:39],v17 offset:21504
s_waitcnt lgkmcnt(2)
v_min3_u32 v27,v27,v40,v44
v_mfma_f32_16x16x32_bf16 v[68:71],a[36:39],v[44:47],v[68:71]
ds_read_b128 v[40:43],v17 offset:22528
buffer_load_dwordx4 v16,s[20:23],s65 offen offset:2048 sc1 lds
s_waitcnt lgkmcnt(2)
v_mfma_f32_16x16x32_bf16 v[64:67],a[40:43],v[32:35],v[64:67]
ds_read_b128 v[44:47],v17 offset:23552
s_waitcnt lgkmcnt(2)
v_min3_u32 v27,v27,v32,v36
v_mfma_f32_16x16x32_bf16 v[68:71],a[40:43],v[36:39],v[68:71]
ds_read_b128 v[32:35],v17 offset:24576
s_waitcnt lgkmcnt(2)
v_mfma_f32_16x16x32_bf16 v[64:67],a[44:47],v[40:43],v[64:67]
ds_read_b128 v[36:39],v17 offset:25600
buffer_load_dwordx4 v16,s[20:23],s65 offen offset:3072 sc1 lds
s_waitcnt lgkmcnt(2)
v_min3_u32 v27,v27,v40,v44
v_mfma_f32_16x16x32_bf16 v[68:71],a[44:47],v[44:47],v[68:71]
ds_read_b128 v[40:43],v17 offset:26624
s_waitcnt lgkmcnt(2)
v_mfma_f32_16x16x32_bf16 v[64:67],a[48:51],v[32:35],v[64:67]
ds_read_b128 v[44:47],v17 offset:27648
s_add_u32 m0,s91,32768
s_add_u32 s65,s89,s75
s_add_u32 s65,s65,65536
s_waitcnt lgkmcnt(2)
v_min3_u32 v27,v27,v32,v36
v_mfma_f32_16x16x32_bf16 v[68:71],a[48:51],v[36:39],v[68:71]
ds_read_b128 v[32:35],v17 offset:28672
s_waitcnt lgkmcnt(2)
v_mfma_f32_16x16x32_bf16 v[64:67],a[52:55],v[40:43],v[64:67]
ds_read_b128 v[36:39],v17 offset:29696
buffer_load_dwordx4 v16,s[20:23],s65 offen offset:0 sc1 lds
s_waitcnt lgkmcnt(2)
v_min3_u32 v27,v27,v40,v44
v_mfma_f32_16x16x32_bf16 v[68:71],a[52:55],v[44:47],v[68:71]
ds_read_b128 v[40:43],v17 offset:30720
s_waitcnt lgkmcnt(2)
v_mfma_f32_16x16x32_bf16 v[64:67],a[56:59],v[32:35],v[64:67]
ds_read_b128 v[44:47],v17 offset:31744
s_waitcnt lgkmcnt(2)
v_min3_u32 v27,v27,v32,v36
v_mfma_f32_16x16x32_bf16 v[68:71],a[56:59],v[36:39],v[68:71]
s_waitcnt vmcnt(21)
s_barrier
ds_read_b128 v[32:35],v17 offset:32768
buffer_load_dwordx4 v16,s[20:23],s65 offen offset:1024 sc1 lds
s_waitcnt lgkmcnt(2)
v_mfma_f32_16x16x32_bf16 v[64:67],a[60:63],v[40:43],v[64:67]
ds_read_b128 v[36:39],v17 offset:33792
s_waitcnt lgkmcnt(2)
v_min3_u32 v27,v27,v40,v44
v_mfma_f32_16x16x32_bf16 v[68:71],a[60:63],v[44:47],v[68:71]
ds_read_b128 v[40:43],v17 offset:34816
buffer_load_dwordx4 v16,s[20:23],s65 offen offset:2048 sc1 lds
s_waitcnt lgkmcnt(2)
v_mfma_f32_16x16x32_bf16 v[64:67],a[64:67],v[32:35],v[64:67]
ds_read_b128 v[44:47],v17 offset:35840
s_waitcnt lgkmcnt(2)
v_min3_u32 v27,v27,v32,v36
v_mfma_f32_16x16x32_bf16 v[68:71],a[64:67],v[36:39],v[68:71]
ds_read_b128 v[32:35],v17 offset:36864
buffer_load_dwordx4 v16,s[20:23],s65 offen offset:3072 sc1 lds
s_waitcnt lgkmcnt(2)
v_mfma_f32_16x16x32_bf16 v[64:67],a[68:71],v[40:43],v[64:67]
ds_read_b128 v[36:39],v17 offset:37888
s_waitcnt lgkmcnt(2)
v_min3_u32 v27,v27,v40,v44
v_mfma_f32_16x16x32_bf16 v[68:71],a[68:71],v[44:47],v[68:71]
ds_read_b128 v[40:43],v17 offset:38912
s_waitcnt lgkmcnt(2)
v_mfma_f32_16x16x32_bf16 v[64:67],a[72:75],v[32:35],v[64:67]
ds_read_b128 v[44:47],v17 offset:39936
s_add_u32 m0,s91,49152
s_add_u32 s65,s89,s75
s_add_u32 s65,s65,98304
s_waitcnt lgkmcnt(2)
v_min3_u32 v27,v27,v32,v36
v_mfma_f32_16x16x32_bf16 v[68:71],a[72:75],v[36:39],v[68:71]
ds_read_b128 v[32:35],v17 offset:40960
s_waitcnt lgkmcnt(2)
v_mfma_f32_16x16x32_bf16 v[64:67],a[76:79],v[40:43],v[64:67]
ds_read_b128 v[36:39],v17 offset:41984
buffer_load_dwordx4 v16,s[20:23],s65 offen offset:0 sc1 lds
s_waitcnt lgkmcnt(2)
v_min3_u32 v27,v27,v40,v44
v_mfma_f32_16x16x32_bf16 v[68:71],a[76:79],v[44:47],v[68:71]
ds_read_b128 v[40:43],v17 offset:43008
s_waitcnt lgkmcnt(2)
v_mfma_f32_16x16x32_bf16 v[64:67],a[80:83],v[32:35],v[64:67]
ds_read_b128 v[44:47],v17 offset:44032
buffer_load_dwordx4 v16,s[20:23],s65 offen offset:1024 sc1 lds
s_waitcnt lgkmcnt(2)
v_min3_u32 v27,v27,v32,v36
v_mfma_f32_16x16x32_bf16 v[68:71],a[80:83],v[36:39],v[68:71]
ds_read_b128 v[32:35],v17 offset:45056
s_waitcnt lgkmcnt(2)
v_mfma_f32_16x16x32_bf16 v[64:67],a[84:87],v[40:43],v[64:67]
ds_read_b128 v[36:39],v17 offset:46080
s_waitcnt lgkmcnt(2)
v_min3_u32 v27,v27,v40,v44
v_mfma_f32_16x16x32_bf16 v[68:71],a[84:87],v[44:47],v[68:71]
ds_read_b128 v[40:43],v17 offset:47104
buffer_load_dwordx4 v16,s[20:23],s65 offen offset:2048 sc1 lds
s_waitcnt lgkmcnt(2)
v_mfma_f32_16x16x32_bf16 v[64:67],a[88:91],v[32:35],v[64:67]
ds_read_b128 v[44:47],v17 offset:48128
s_waitcnt lgkmcnt(2)
v_min3_u32 v27,v27,v32,v36
v_mfma_f32_16x16x32_bf16 v[68:71],a[88:91],v[36:39],v[68:71]
s_waitcnt vmcnt(23)
s_barrier
ds_read_b128 v[32:35],v17 offset:49152
buffer_load_dwordx4 v16,s[20:23],s65 offen offset:3072 sc1 lds
s_waitcnt lgkmcnt(2)
v_mfma_f32_16x16x32_bf16 v[64:67],a[92:95],v[40:43],v[64:67]
ds_read_b128 v[36:39],v17 offset:50176
s_waitcnt vmcnt(16)
stk_256:
v_min3_u32 v22,v81,v85,v89
v_min3_u32 v22,v22,v93,v97
v_min3_u32 v22,v22,v101,v105
v_min_u32 v22,v22,v109
v_cmp_eq_u32 vcc,0,v22
s_cmp_lt_i32 s90,0
s_cselect_b64 vcc,0,vcc
s_cbranch_vccnz str_255
s_waitcnt lgkmcnt(2)
v_min3_u32 v27,v27,v40,v44
v_mfma_f32_16x16x32_bf16 v[68:71],a[92:95],v[44:47],v[68:71]
ds_read_b128 v[40:43],v17 offset:51200
v_add_f32 v80,v80,v96
v_add_f32 v81,v81,v97
v_add_f32 v82,v82,v98
v_add_f32 v83,v83,v99
v_add_f32 v84,v84,v100
v_add_f32 v85,v85,v101
s_waitcnt lgkmcnt(2)
v_mfma_f32_16x16x32_bf16 v[64:67],a[96:99],v[32:35],v[64:67]
ds_read_b128 v[44:47],v17 offset:52224
v_add_f32 v86,v86,v102
v_add_f32 v87,v87,v103
v_add_f32 v88,v88,v104
v_add_f32 v89,v89,v105
v_add_f32 v90,v90,v106
v_add_f32 v91,v91,v107
s_waitcnt lgkmcnt(2)
v_min3_u32 v27,v27,v32,v36
v_mfma_f32_16x16x32_bf16 v[68:71],a[96:99],v[36:39],v[68:71]
ds_read_b128 v[32:35],v17 offset:53248
v_add_f32 v92,v92,v108
v_add_f32 v93,v93,v109
v_add_f32 v94,v94,v110
v_add_f32 v95,v95,v111
v_add_f32 v80,v80,v88
v_add_f32 v81,v81,v89
s_waitcnt lgkmcnt(2)
v_mfma_f32_16x16x32_bf16 v[64:67],a[100:103],v[40:43],v[64:67]
ds_read_b128 v[36:39],v17 offset:54272
v_add_f32 v82,v82,v90
v_add_f32 v83,v83,v91
v_add_f32 v84,v84,v92
v_add_f32 v85,v85,v93
v_add_f32 v86,v86,v94
v_add_f32 v87,v87,v95
s_waitcnt lgkmcnt(2)
v_min3_u32 v27,v27,v40,v44
v_mfma_f32_16x16x32_bf16 v[68:71],a[100:103],v[44:47],v[68:71]
ds_read_b128 v[40:43],v17 offset:55296
v_add_f32 v80,v80,v84
v_add_f32 v81,v81,v85
v_add_f32 v82,v82,v86
v_add_f32 v83,v83,v87
v_mov_b32 v84,v80
v_mov_b32 v85,v81
s_waitcnt lgkmcnt(2)
v_mfma_f32_16x16x32_bf16 v[64:67],a[104:107],v[32:35],v[64:67]
ds_read_b128 v[44:47],v17 offset:56320
v_mov_b32 v86,v82
v_mov_b32 v87,v83
v_permlane16_swap_b32 v84,v80
v_permlane16_swap_b32 v85,v81
v_permlane16_swap_b32 v86,v82
v_permlane16_swap_b32 v87,v83
s_waitcnt lgkmcnt(2)
v_min3_u32 v27,v27,v32,v36
v_mfma_f32_16x16x32_bf16 v[68:71],a[104:107],v[36:39],v[68:71]
ds_read_b128 v[32:35],v17 offset:57344
v_add_f32 v80,v80,v84
v_add_f32 v81,v81,v85
v_add_f32 v82,v82,v86
v_add_f32 v83,v83,v87
v_mov_b32 v84,v80
v_mov_b32 v85,v81
s_waitcnt lgkmcnt(2)
v_mfma_f32_16x16x32_bf16 v[64:67],a[108:111],v[40:43],v[64:67]
ds_read_b128 v[36:39],v17 offset:58368
v_mov_b32 v86,v82
v_mov_b32 v87,v83
v_permlane32_swap_b32 v84,v80
v_permlane32_swap_b32 v85,v81
v_permlane32_swap_b32 v86,v82
v_permlane32_swap_b32 v87,v83
s_waitcnt lgkmcnt(2)
v_min3_u32 v27,v27,v40,v44
v_mfma_f32_16x16x32_bf16 v[68:71],a[108:111],v[44:47],v[68:71]
ds_read_b128 v[40:43],v17 offset:59392
v_add_f32 v80,v80,v84
v_add_f32 v81,v81,v85
v_add_f32 v82,v82,v86
v_add_f32 v83,v83,v87
v_mul_f32 v80,0xba800000,v80
v_mul_f32 v82,0xba800000,v82
s_waitcnt lgkmcnt(2)
v_mfma_f32_16x16x32_bf16 v[64:67],a[112:115],v[32:35],v[64:67]
ds_read_b128 v[44:47],v17 offset:60416
v_mul_f32 v84,v80,v80
v_mul_f32 v85,v82,v82
v_fma_f32 v84,v81,s82,-v84
v_fma_f32 v85,v83,s82,-v85
v_max_f32 v84,0,v84
v_max_f32 v85,0,v85
s_waitcnt lgkmcnt(2)
v_min3_u32 v27,v27,v32,v36
v_mfma_f32_16x16x32_bf16 v[68:71],a[112:115],v[36:39],v[68:71]
ds_read_b128 v[32:35],v17 offset:61440
v_add_f32 v84,0x3727c5ac,v84
v_add_f32 v85,0x3727c5ac,v85
v_rsq_f32 v112,v84
v_rsq_f32 v114,v85
s_nop 0
v_mul_f32 v113,v112,v80
s_waitcnt lgkmcnt(2)
v_mfma_f32_16x16x32_bf16 v[64:67],a[116:119],v[40:43],v[64:67]
ds_read_b128 v[36:39],v17 offset:62464
v_mul_f32 v115,v114,v82
ds_write_b128 v19,v[112:115]
s_waitcnt lgkmcnt(2)
v_min3_u32 v27,v27,v40,v44
v_mfma_f32_16x16x32_bf16 v[68:71],a[116:119],v[44:47],v[68:71]
ds_read_b128 v[40:43],v17 offset:63488
s_waitcnt lgkmcnt(2)
v_mfma_f32_16x16x32_bf16 v[64:67],a[120:123],v[32:35],v[64:67]
s_waitcnt lgkmcnt(0)
s_barrier
ds_read_b128 v[44:47],v17 offset:64512
s_waitcnt lgkmcnt(2)
v_min3_u32 v27,v27,v32,v36
v_mfma_f32_16x16x32_bf16 v[68:71],a[120:123],v[36:39],v[68:71]
s_waitcnt lgkmcnt(1)
v_mfma_f32_16x16x32_bf16 v[64:67],a[124:127],v[40:43],v[64:67]
s_waitcnt lgkmcnt(0)
v_min3_u32 v27,v27,v40,v44
v_mfma_f32_16x16x32_bf16 v[68:71],a[124:127],v[44:47],v[68:71]
v_cmp_eq_u32 vcc,0,v27
s_cbranch_vccnz retry_257
valid_258:
buffer_load_dword v29,v21,s[20:23],s74 offen sc1
v_xor_b32 v17,0x10000,v17
s_mov_b32 s72,s91
v_mul_f32 v64,v64,v112
v_mul_f32 v65,v65,v112
v_mul_f32 v66,v66,v112
v_mul_f32 v67,v67,v112
v_mul_f32 v68,v68,v114
v_mul_f32 v69,v69,v114
v_mul_f32 v70,v70,v114
v_mul_f32 v71,v71,v114
v_fmac_f32 v64,v113,v132
v_fmac_f32 v65,v113,v133
v_fmac_f32 v66,v113,v134
v_fmac_f32 v67,v113,v135
v_fmac_f32 v68,v115,v132
v_fmac_f32 v69,v115,v133
v_fmac_f32 v70,v115,v134
v_fmac_f32 v71,v115,v135
v_mul_f32 v80,v64,v64
v_mul_f32 v81,v65,v65
v_mul_f32 v82,v66,v66
v_mul_f32 v83,v67,v67
v_mul_f32 v84,v68,v68
v_mul_f32 v85,v69,v69
v_mul_f32 v86,v70,v70
v_mul_f32 v87,v71,v71
v_fma_f32 v80,v80,s81,v28
v_fma_f32 v81,v81,s81,v28
v_fma_f32 v82,v82,s81,v28
v_fma_f32 v83,v83,s81,v28
v_fma_f32 v84,v84,s81,v28
v_fma_f32 v85,v85,s81,v28
v_fma_f32 v86,v86,s81,v28
v_fma_f32 v87,v87,s81,v28
v_mul_f32 v80,v80,v64
v_mul_f32 v81,v81,v65
v_mul_f32 v82,v82,v66
v_mul_f32 v83,v83,v67
v_mul_f32 v84,v84,v68
v_mul_f32 v85,v85,v69
v_mul_f32 v86,v86,v70
v_mul_f32 v87,v87,v71
v_exp_f32 v80,v80
v_exp_f32 v81,v81
v_exp_f32 v82,v82
v_exp_f32 v83,v83
v_exp_f32 v84,v84
v_exp_f32 v85,v85
v_exp_f32 v86,v86
v_exp_f32 v87,v87
v_add_f32 v80,1.0,v80
v_add_f32 v81,1.0,v81
v_add_f32 v82,1.0,v82
v_add_f32 v83,1.0,v83
v_add_f32 v84,1.0,v84
v_add_f32 v85,1.0,v85
v_add_f32 v86,1.0,v86
v_add_f32 v87,1.0,v87
v_rcp_f32 v80,v80
v_rcp_f32 v81,v81
v_rcp_f32 v82,v82
v_rcp_f32 v83,v83
v_rcp_f32 v84,v84
v_rcp_f32 v85,v85
v_rcp_f32 v86,v86
v_rcp_f32 v87,v87
v_mul_f32 v80,v80,v64
v_mul_f32 v81,v81,v65
v_mul_f32 v82,v82,v66
v_mul_f32 v83,v83,v67
v_mul_f32 v84,v84,v68
v_mul_f32 v85,v85,v69
v_mul_f32 v86,v86,v70
v_mul_f32 v87,v87,v71
v_cvt_pk_bf16_f32 v96,v80,v81
v_cvt_pk_bf16_f32 v97,v82,v83
v_max_u32 v96,1,v96
buffer_store_dwordx2 v[96:97],v18,s[20:23],s70 offen offset:0 sc1
v_cvt_pk_bf16_f32 v100,v84,v85
v_cvt_pk_bf16_f32 v101,v86,v87
v_max_u32 v100,1,v100
buffer_store_dwordx2 v[100:101],v18,s[20:23],s70 offen offset:1024 sc1
s_mov_b64 exec,1
v_mov_b32 v22,s71
v_mov_b32 v23,0
buffer_store_dword v22,v23,s[20:23],s73 offen sc1
s_mov_b64 exec,-1
s_add_u32 s65,s70,4194304
buffer_store_dwordx2 v[128:129],v18,s[20:23],s65 offen offset:0 sc1
buffer_store_dwordx2 v[128:129],v18,s[20:23],s65 offen offset:1024 sc1
s_add_u32 s79,s79,1
s_add_u32 s71,s71,1
s_cmp_lt_u32 s79,65
s_cbranch_scc1 w3l_250
s_endpgm
retry_257:
s_sub_u32 s90,s90,1
s_cmp_lt_i32 s90,0
s_cbranch_scc1 valid_258
s_mov_b32 s83,1
v_mov_b32 v29,0
s_barrier
s_add_u32 m0,s72,0
s_add_u32 s65,s70,s75
s_add_u32 s65,s65,0
buffer_load_dwordx4 v16,s[20:23],s65 offen offset:0 sc1 lds
buffer_load_dwordx4 v16,s[20:23],s65 offen offset:1024 sc1 lds
buffer_load_dwordx4 v16,s[20:23],s65 offen offset:2048 sc1 lds
buffer_load_dwordx4 v16,s[20:23],s65 offen offset:3072 sc1 lds
s_add_u32 m0,s72,16384
s_add_u32 s65,s70,s75
s_add_u32 s65,s65,32768
buffer_load_dwordx4 v16,s[20:23],s65 offen offset:0 sc1 lds
buffer_load_dwordx4 v16,s[20:23],s65 offen offset:1024 sc1 lds
buffer_load_dwordx4 v16,s[20:23],s65 offen offset:2048 sc1 lds
buffer_load_dwordx4 v16,s[20:23],s65 offen offset:3072 sc1 lds
s_add_u32 m0,s72,32768
s_add_u32 s65,s70,s75
s_add_u32 s65,s65,65536
buffer_load_dwordx4 v16,s[20:23],s65 offen offset:0 sc1 lds
buffer_load_dwordx4 v16,s[20:23],s65 offen offset:1024 sc1 lds
buffer_load_dwordx4 v16,s[20:23],s65 offen offset:2048 sc1 lds
buffer_load_dwordx4 v16,s[20:23],s65 offen offset:3072 sc1 lds
s_add_u32 m0,s72,49152
s_add_u32 s65,s70,s75
s_add_u32 s65,s65,98304
buffer_load_dwordx4 v16,s[20:23],s65 offen offset:0 sc1 lds
buffer_load_dwordx4 v16,s[20:23],s65 offen offset:1024 sc1 lds
buffer_load_dwordx4 v16,s[20:23],s65 offen offset:2048 sc1 lds
buffer_load_dwordx4 v16,s[20:23],s65 offen offset:3072 sc1 lds
s_branch w3l_250
str_255:
buffer_load_dwordx4 v[80:83],v16,s[20:23],s66 offen offset:0 sc1
buffer_load_dwordx4 v[84:87],v16,s[20:23],s66 offen offset:1024 sc1
buffer_load_dwordx4 v[88:91],v16,s[20:23],s66 offen offset:2048 sc1
buffer_load_dwordx4 v[92:95],v16,s[20:23],s66 offen offset:3072 sc1
buffer_load_dwordx4 v[96:99],v16,s[20:23],s67 offen offset:0 sc1
buffer_load_dwordx4 v[100:103],v16,s[20:23],s67 offen offset:1024 sc1
buffer_load_dwordx4 v[104:107],v16,s[20:23],s67 offen offset:2048 sc1
buffer_load_dwordx4 v[108:111],v16,s[20:23],s67 offen offset:3072 sc1
s_sub_u32 s90,s90,1
s_waitcnt vmcnt(0)
s_branch stk_256
code_end:
.section .rodata,"a"
.p2align 6
.amdhsa_kernel mega_kernel
  .amdhsa_next_free_vgpr 512
  .amdhsa_next_free_sgpr 102
  .amdhsa_accum_offset 256
  .amdhsa_group_segment_fixed_size 0
  .amdhsa_kernarg_size 136
  .amdhsa_user_sgpr_count 2
  .amdhsa_user_sgpr_kernarg_segment_ptr 1
  .amdhsa_system_sgpr_workgroup_id_x 1
.end_amdhsa_kernel
```

```asm
; @launch kernel=mega_kernel grid=(256,1,1) block=(256,1,1) lds=163840
.amdgcn_target "amdgcn-amd-amdhsa--gfx950"
.text
.globl mega_kernel
.p2align 8
.type mega_kernel,@function
mega_kernel:
s_cmp_ge_u32 s2,256
s_cbranch_scc1 done_1
s_load_dwordx4 s[16:19],s[0:1],120
s_load_dword s3,s[0:1],0
s_getpc_b64 s[4:5]
pc_2:
s_sub_u32 s8,s4,pc_2-mega_kernel
s_subb_u32 s9,s5,0
s_and_b32 s9,s9,0xffff
s_mov_b32 s10,code_end-mega_kernel
s_mov_b32 s11,0x20000
v_lshlrev_b32 v180,7,v0
v_cmp_gt_u32 vcc,64,v0
s_cbranch_vccnz nocpf_3
buffer_load_dword v181,v180,s[8:11],0 offen
s_mov_b32 s12,0x8000
buffer_load_dword v182,v180,s[8:11],s12 offen
s_lshr_b32 s12,s2,3
s_and_b32 s12,s12,7
s_add_u32 s12,s12,2
s_lshl_b32 s12,s12,15
buffer_load_dword v183,v180,s[8:11],s12 offen
nocpf_3:
v_and_b32 v1,63,v0
v_lshrrev_b32 v2,6,v0
s_getreg_b32 s51,hwreg(HW_REG_XCC_ID)
v_readfirstlane_b32 s50,v2
s_and_b32 s51,s51,7
s_waitcnt lgkmcnt(0)
s_mov_b32 s20,s18
s_and_b32 s21,s19,0xffff
s_mov_b32 s22,0x10000000
s_mov_b32 s23,0x20000
s_mov_b32 s44,s16
s_and_b32 s45,s17,0xffff
s_mov_b32 s46,0x100
s_mov_b32 s47,0x20000
s_mov_b32 s90,400000
s_mov_b32 s91,s50
v_mov_b32 v187,158976
s_cmp_lg_u32 s50,0
s_cbranch_scc1 norole_4
s_mov_b64 exec,1
v_mov_b32 v184,1
v_mov_b32 v185,0
s_and_b32 s52,s51,3
s_lshl_b32 s52,s52,2
s_lshr_b32 s53,s51,2
s_lshl_b32 s53,s53,7
s_add_u32 s52,s52,s53
buffer_atomic_add v184,v185,s[44:47],s52 offen sc0 sc1
s_mov_b64 exec,-1
buffer_load_dword v181,v180,s[8:11],0 offen
s_mov_b32 s12,0x8000
buffer_load_dword v182,v180,s[8:11],s12 offen
s_lshr_b32 s12,s2,3
s_and_b32 s12,s12,7
s_add_u32 s12,s12,2
s_lshl_b32 s12,s12,15
buffer_load_dword v183,v180,s[8:11],s12 offen
s_mov_b64 exec,1
s_waitcnt vmcnt(3)
ds_write_b32 v187,v184
s_waitcnt lgkmcnt(0)
s_mov_b64 exec,-1
norole_4:
s_barrier
ds_read_b32 v186,v187
s_waitcnt lgkmcnt(0)
v_readfirstlane_b32 s54,v186
s_mov_b32 s56,2
s_lshl_b32 s57,s51,5
s_add_u32 s57,s57,s54
s_cmp_lt_u32 s54,32
s_cselect_b32 s57,s57,999
s_cmp_ge_u32 s57,256
s_cbranch_scc1 verify_6
s_cmp_ge_u32 s57,128
s_cbranch_scc1 pre_8
setup_5:
s_load_dwordx8 s[4:11],s[0:1],8
s_load_dwordx2 s[12:13],s[0:1],40
v_and_b32 v3,15,v1
v_lshrrev_b32 v4,4,v1
v_lshlrev_b32 v16,4,v1
v_lshrrev_b32 v30,2,v1
v_and_b32 v31,3,v1
v_lshlrev_b32 v7,13,v30
v_lshl_add_u32 v7,v31,4,v7
v_lshlrev_b32 v8,11,v30
v_lshl_add_u32 v8,v31,4,v8
s_lshr_b32 s58,s57,5
s_and_b32 s59,s57,31
s_xor_b32 s60,s57,0
s_lshl_b32 s60,s60,6
s_lshl_b32 s61,s50,14
s_lshl_b32 s62,s50,21
s_add_u32 s62,s62,s60
s_lshl_b32 s63,s58,21
s_lshl_b32 s64,s50,19
s_add_u32 s63,s63,s64
s_xor_b32 s64,s59,0
s_lshl_b32 s64,s64,6
s_add_u32 s63,s63,s64
s_waitcnt lgkmcnt(0)
s_mov_b32 s28,s8
s_and_b32 s29,s9,0xffff
s_mov_b32 s30,0x800000
s_mov_b32 s31,0x20000
s_mov_b32 s32,s10
s_and_b32 s33,s11,0xffff
s_mov_b32 s34,0x800000
s_mov_b32 s35,0x20000
s_mov_b32 s36,s6
s_and_b32 s37,s7,0xffff
s_mov_b32 s38,0x800000
s_mov_b32 s39,0x20000
s_mov_b32 s40,s12
s_and_b32 s41,s13,0xffff
s_mov_b32 s42,0x800000
s_mov_b32 s43,0x20000
s_mov_b32 s8,s4
s_and_b32 s9,s5,0xffff
s_mov_b32 s10,0x4000
s_mov_b32 s11,0x20000
v_lshlrev_b32 v9,7,v3
v_lshl_add_u32 v10,v4,11,v9
v_lshl_add_u32 v9,v4,13,v9
s_lshl_b32 s64,s59,2
s_add_u32 s64,s64,s50
s_lshl_b32 s65,s64,16
s_lshl_b32 s66,s58,11
s_add_u32 s65,s65,s66
s_lshl_b32 s66,s64,14
s_lshl_b32 s67,s58,21
s_add_u32 s66,s66,s67
v_and_b32 v9,7,v1
v_lshrrev_b32 v10,3,v1
s_cmp_eq_u32 s58,3
s_cselect_b32 s64,15,3
v_mov_b32 v11,3
v_cmp_eq_u32 vcc,1,v10
s_nop 1
v_cndmask_b32 v11,v11,11,vcc
v_lshlrev_b32 v12,7,v11
v_lshl_add_u32 v12,v9,11,v12
v_mov_b32 v13,s64
v_cmp_eq_u32 vcc,2,v10
s_nop 1
v_cndmask_b32 v11,v11,v13,vcc
v_lshlrev_b32 v11,7,v11
v_lshl_add_u32 v11,v9,13,v11
v_mov_b32 v100,0
v_mov_b32 v101,0
v_mov_b32 v102,0
v_mov_b32 v103,0
s_mov_b32 s53,s65
s_mov_b32 s55,s66
v_and_b32 v22,7,v3
v_lshlrev_b32 v31,11,v22
v_lshl_add_u32 v31,v4,4,v31
s_lshr_b32 s64,s59,3
s_lshl_b32 s64,s64,14
s_and_b32 s65,s59,7
s_lshl_b32 s65,s65,10
s_add_u32 s64,s64,s65
s_lshl_b32 s65,s58,16
s_add_u32 s64,s64,s65
s_add_u32 s64,s64,31195136
s_lshr_b32 s65,s57,3
s_add_u32 s65,s65,96
s_lshl_b32 s65,s65,14
s_and_b32 s66,s57,7
s_lshl_b32 s66,s66,10
s_add_u32 s65,s65,s66
s_add_u32 s65,s65,29360128
v_add_u32 v206,s64,v16
v_add_u32 v207,s65,v16
s_and_b32 s64,s50,1
s_lshl_b32 s64,s64,21
s_lshr_b32 s65,s50,1
s_lshl_b32 s65,s65,13
s_add_u32 s64,s64,s65
buffer_store_dwordx4 v[100:103],v206,s[20:23],s64 offen sc1
buffer_store_dwordx4 v[100:103],v207,s[20:23],s64 offen sc1
s_lshl_b32 s64,s50,20
s_add_u32 s64,s64,23068672
s_cmp_lt_u32 s50,2
s_cselect_b32 s67,s64,0x7fff0000
s_lshl_b32 s65,s57,10
s_add_u32 s65,s65,131072
s_add_u32 s65,s65,s67
buffer_store_dwordx4 v[100:103],v16,s[20:23],s65 offen sc1
s_lshl_b32 s65,s57,9
s_add_u32 s65,s65,s67
s_add_u32 s66,s65,65536
s_mov_b32 exec_hi,0
buffer_store_dwordx4 v[100:103],v16,s[20:23],s65 offen sc1
buffer_store_dwordx4 v[100:103],v16,s[20:23],s66 offen sc1
s_lshl_b32 s65,s57,2
s_add_u32 s65,s65,s64
s_add_u32 s65,s65,524288
s_lshl_b32 s52,s57,7
s_add_u32 s52,s52,21168128
s_mov_b64 exec,1
buffer_store_dword v100,v100,s[20:23],s65 offen sc1
buffer_store_dword v100,v100,s[20:23],s65 offen offset:512 sc1
buffer_store_dword v100,v100,s[20:23],s52 offen sc1
s_mov_b64 exec,-1
s_mov_b32 s65,s53
s_mov_b32 s66,s55
s_add_u32 s64,s62,0
s_add_u32 m0,s61,0
s_nop 0
buffer_load_dwordx4 v7,s[28:31],s64 offen nt lds
s_add_u32 s64,s62,131072
s_add_u32 m0,s61,1024
s_nop 0
buffer_load_dwordx4 v7,s[28:31],s64 offen nt lds
s_add_u32 s64,s62,262144
s_add_u32 m0,s61,2048
s_nop 0
buffer_load_dwordx4 v7,s[28:31],s64 offen nt lds
s_add_u32 s64,s62,393216
s_add_u32 m0,s61,3072
s_nop 0
buffer_load_dwordx4 v7,s[28:31],s64 offen nt lds
s_add_u32 s64,s62,524288
s_add_u32 m0,s61,4096
s_nop 0
buffer_load_dwordx4 v7,s[28:31],s64 offen nt lds
s_add_u32 s64,s62,655360
s_add_u32 m0,s61,5120
s_nop 0
buffer_load_dwordx4 v7,s[28:31],s64 offen nt lds
s_add_u32 s64,s62,786432
s_add_u32 m0,s61,6144
s_nop 0
buffer_load_dwordx4 v7,s[28:31],s64 offen nt lds
s_add_u32 s64,s62,917504
s_add_u32 m0,s61,7168
s_nop 0
buffer_load_dwordx4 v7,s[28:31],s64 offen nt lds
s_add_u32 s64,s62,1048576
s_add_u32 m0,s61,8192
s_nop 0
buffer_load_dwordx4 v7,s[28:31],s64 offen nt lds
s_add_u32 s64,s62,1179648
s_add_u32 m0,s61,9216
s_nop 0
buffer_load_dwordx4 v7,s[28:31],s64 offen nt lds
s_add_u32 s64,s62,1310720
s_add_u32 m0,s61,10240
s_nop 0
buffer_load_dwordx4 v7,s[28:31],s64 offen nt lds
s_add_u32 s64,s62,1441792
s_add_u32 m0,s61,11264
s_nop 0
buffer_load_dwordx4 v7,s[28:31],s64 offen nt lds
s_add_u32 s64,s62,1572864
s_add_u32 m0,s61,12288
s_nop 0
buffer_load_dwordx4 v7,s[28:31],s64 offen nt lds
s_add_u32 s64,s62,1703936
s_add_u32 m0,s61,13312
s_nop 0
buffer_load_dwordx4 v7,s[28:31],s64 offen nt lds
s_add_u32 s64,s62,1835008
s_add_u32 m0,s61,14336
s_nop 0
buffer_load_dwordx4 v7,s[28:31],s64 offen nt lds
s_add_u32 s64,s62,1966080
s_add_u32 m0,s61,15360
s_nop 0
buffer_load_dwordx4 v7,s[28:31],s64 offen nt lds
s_mov_b64 exec,0xffffff
buffer_load_dword v201,v11,s[32:35],s65 offen
buffer_load_dword v202,v11,s[36:39],s65 offen
s_mov_b64 exec,0xffff
buffer_load_dword v203,v12,s[40:43],s66 offen
s_mov_b64 exec,-1
s_add_u32 s64,s62,0
s_add_u32 m0,s61,65536
s_nop 0
buffer_load_dwordx4 v7,s[32:35],s64 offen nt lds
s_add_u32 s64,s62,131072
s_add_u32 m0,s61,66560
s_nop 0
buffer_load_dwordx4 v7,s[32:35],s64 offen nt lds
s_add_u32 s64,s62,262144
s_add_u32 m0,s61,67584
s_nop 0
buffer_load_dwordx4 v7,s[32:35],s64 offen nt lds
s_add_u32 s64,s62,393216
s_add_u32 m0,s61,68608
s_nop 0
buffer_load_dwordx4 v7,s[32:35],s64 offen nt lds
s_add_u32 s64,s62,524288
s_add_u32 m0,s61,69632
s_nop 0
buffer_load_dwordx4 v7,s[32:35],s64 offen nt lds
s_add_u32 s64,s62,655360
s_add_u32 m0,s61,70656
s_nop 0
buffer_load_dwordx4 v7,s[32:35],s64 offen nt lds
s_add_u32 s64,s62,786432
s_add_u32 m0,s61,71680
s_nop 0
buffer_load_dwordx4 v7,s[32:35],s64 offen nt lds
s_add_u32 s64,s62,917504
s_add_u32 m0,s61,72704
s_nop 0
buffer_load_dwordx4 v7,s[32:35],s64 offen nt lds
s_add_u32 s64,s62,1048576
s_add_u32 m0,s61,73728
s_nop 0
buffer_load_dwordx4 v7,s[32:35],s64 offen nt lds
s_add_u32 s64,s62,1179648
s_add_u32 m0,s61,74752
s_nop 0
buffer_load_dwordx4 v7,s[32:35],s64 offen nt lds
s_add_u32 s64,s62,1310720
s_add_u32 m0,s61,75776
s_nop 0
buffer_load_dwordx4 v7,s[32:35],s64 offen nt lds
s_add_u32 s64,s62,1441792
s_add_u32 m0,s61,76800
s_nop 0
buffer_load_dwordx4 v7,s[32:35],s64 offen nt lds
s_add_u32 s64,s62,1572864
s_add_u32 m0,s61,77824
s_nop 0
buffer_load_dwordx4 v7,s[32:35],s64 offen nt lds
s_add_u32 s64,s62,1703936
s_add_u32 m0,s61,78848
s_nop 0
buffer_load_dwordx4 v7,s[32:35],s64 offen nt lds
s_add_u32 s64,s62,1835008
s_add_u32 m0,s61,79872
s_nop 0
buffer_load_dwordx4 v7,s[32:35],s64 offen nt lds
s_add_u32 s64,s62,1966080
s_add_u32 m0,s61,80896
s_nop 0
buffer_load_dwordx4 v7,s[32:35],s64 offen nt lds
s_lshl_b32 s64,s59,6
buffer_load_dwordx4 v[216:219],v31,s[8:11],s64 offen
v_lshrrev_b32 v184,3,v3
v_bfe_u32 v185,v3,2,1
v_lshrrev_b32 v186,1,v4
v_and_b32 v187,1,v4
v_lshl_add_u32 v188,v184,3,v185
v_lshl_add_u32 v188,v186,4,v188
v_lshl_add_u32 v188,v187,2,v188
v_lshl_add_u32 v189,v184,2,v185
v_lshl_add_u32 v189,v186,3,v189
v_lshl_add_u32 v189,v187,4,v189
v_and_b32 v187,3,v3
v_lshlrev_b32 v187,3,v187
v_lshl_add_u32 v188,v188,6,v187
v_lshl_add_u32 v189,v189,6,v187
s_lshr_b32 s64,s50,1
s_lshl_b32 s64,s64,5
v_add_u32 v190,s64,v188
v_add_u32 v191,0x10000,v190
s_lshl_b32 s64,s64,10
v_add_u32 v192,s64,v189
s_add_u32 s64,s61,0x10000
v_add_u32 v193,s64,v16
s_add_u32 s68,s50,1
s_mov_b32 s69,0
s_waitcnt vmcnt(20)
s_barrier
s_cmp_lg_u32 s50,1
s_cbranch_scc1 ws_14
s_and_b32 s64,s56,1
s_lshl_b32 s64,s64,2
s_add_u32 s64,s64,36
s_mov_b64 exec,1
v_mov_b32 v204,1
v_mov_b32 v185,0
buffer_atomic_add v204,v185,s[44:47],s64 offen sc0 sc1
s_mov_b64 exec,-1
ws_14:
s_bitcmp1_b32 s68,1
s_cbranch_scc0 ws_11
rq_15:
ds_read_b64_tr_b16 a[0:1],v190 offset:0
ds_read_b64_tr_b16 a[2:3],v190 offset:128
ds_read_b64_tr_b16 a[4:5],v190 offset:2048
ds_read_b64_tr_b16 a[6:7],v190 offset:2176
ds_read_b64_tr_b16 a[8:9],v190 offset:4096
ds_read_b64_tr_b16 a[10:11],v190 offset:4224
ds_read_b64_tr_b16 a[12:13],v190 offset:6144
ds_read_b64_tr_b16 a[14:15],v190 offset:6272
s_waitcnt lgkmcnt(0)
ds_read_b64_tr_b16 a[16:17],v190 offset:8192
ds_read_b64_tr_b16 a[18:19],v190 offset:8320
ds_read_b64_tr_b16 a[20:21],v190 offset:10240
ds_read_b64_tr_b16 a[22:23],v190 offset:10368
ds_read_b64_tr_b16 a[24:25],v190 offset:12288
ds_read_b64_tr_b16 a[26:27],v190 offset:12416
ds_read_b64_tr_b16 a[28:29],v190 offset:14336
ds_read_b64_tr_b16 a[30:31],v190 offset:14464
s_waitcnt lgkmcnt(0)
ds_read_b64_tr_b16 a[32:33],v190 offset:16384
ds_read_b64_tr_b16 a[34:35],v190 offset:16512
ds_read_b64_tr_b16 a[36:37],v190 offset:18432
ds_read_b64_tr_b16 a[38:39],v190 offset:18560
ds_read_b64_tr_b16 a[40:41],v190 offset:20480
ds_read_b64_tr_b16 a[42:43],v190 offset:20608
ds_read_b64_tr_b16 a[44:45],v190 offset:22528
ds_read_b64_tr_b16 a[46:47],v190 offset:22656
s_waitcnt lgkmcnt(0)
ds_read_b64_tr_b16 a[48:49],v190 offset:24576
ds_read_b64_tr_b16 a[50:51],v190 offset:24704
ds_read_b64_tr_b16 a[52:53],v190 offset:26624
ds_read_b64_tr_b16 a[54:55],v190 offset:26752
ds_read_b64_tr_b16 a[56:57],v190 offset:28672
ds_read_b64_tr_b16 a[58:59],v190 offset:28800
ds_read_b64_tr_b16 a[60:61],v190 offset:30720
ds_read_b64_tr_b16 a[62:63],v190 offset:30848
s_waitcnt lgkmcnt(0)
ds_read_b64_tr_b16 a[64:65],v190 offset:32768
ds_read_b64_tr_b16 a[66:67],v190 offset:32896
ds_read_b64_tr_b16 a[68:69],v190 offset:34816
ds_read_b64_tr_b16 a[70:71],v190 offset:34944
ds_read_b64_tr_b16 a[72:73],v190 offset:36864
ds_read_b64_tr_b16 a[74:75],v190 offset:36992
ds_read_b64_tr_b16 a[76:77],v190 offset:38912
ds_read_b64_tr_b16 a[78:79],v190 offset:39040
s_waitcnt lgkmcnt(0)
ds_read_b64_tr_b16 a[80:81],v190 offset:40960
ds_read_b64_tr_b16 a[82:83],v190 offset:41088
ds_read_b64_tr_b16 a[84:85],v190 offset:43008
ds_read_b64_tr_b16 a[86:87],v190 offset:43136
ds_read_b64_tr_b16 a[88:89],v190 offset:45056
ds_read_b64_tr_b16 a[90:91],v190 offset:45184
ds_read_b64_tr_b16 a[92:93],v190 offset:47104
ds_read_b64_tr_b16 a[94:95],v190 offset:47232
s_waitcnt lgkmcnt(0)
ds_read_b64_tr_b16 a[96:97],v190 offset:49152
ds_read_b64_tr_b16 a[98:99],v190 offset:49280
ds_read_b64_tr_b16 a[100:101],v190 offset:51200
ds_read_b64_tr_b16 a[102:103],v190 offset:51328
ds_read_b64_tr_b16 a[104:105],v190 offset:53248
ds_read_b64_tr_b16 a[106:107],v190 offset:53376
ds_read_b64_tr_b16 a[108:109],v190 offset:55296
ds_read_b64_tr_b16 a[110:111],v190 offset:55424
s_waitcnt lgkmcnt(0)
ds_read_b64_tr_b16 a[112:113],v190 offset:57344
ds_read_b64_tr_b16 a[114:115],v190 offset:57472
ds_read_b64_tr_b16 a[116:117],v190 offset:59392
ds_read_b64_tr_b16 a[118:119],v190 offset:59520
ds_read_b64_tr_b16 a[120:121],v190 offset:61440
ds_read_b64_tr_b16 a[122:123],v190 offset:61568
ds_read_b64_tr_b16 a[124:125],v190 offset:63488
ds_read_b64_tr_b16 a[126:127],v190 offset:63616
s_waitcnt lgkmcnt(0)
s_cmp_lg_u32 s69,0
s_cbranch_scc1 rqb_16
ws_11:
s_add_u32 s64,s62,0
buffer_load_dwordx4 v[32:35],v7,s[36:39],s64 offen nt
s_add_u32 s64,s62,131072
buffer_load_dwordx4 v[36:39],v7,s[36:39],s64 offen nt
s_add_u32 s64,s62,262144
buffer_load_dwordx4 v[40:43],v7,s[36:39],s64 offen nt
s_add_u32 s64,s62,393216
buffer_load_dwordx4 v[44:47],v7,s[36:39],s64 offen nt
s_add_u32 s64,s62,524288
buffer_load_dwordx4 v[48:51],v7,s[36:39],s64 offen nt
s_add_u32 s64,s62,655360
buffer_load_dwordx4 v[52:55],v7,s[36:39],s64 offen nt
s_add_u32 s64,s62,786432
buffer_load_dwordx4 v[56:59],v7,s[36:39],s64 offen nt
s_add_u32 s64,s62,917504
buffer_load_dwordx4 v[60:63],v7,s[36:39],s64 offen nt
s_add_u32 s64,s62,1048576
buffer_load_dwordx4 v[64:67],v7,s[36:39],s64 offen nt
s_add_u32 s64,s62,1179648
buffer_load_dwordx4 v[68:71],v7,s[36:39],s64 offen nt
s_add_u32 s64,s62,1310720
buffer_load_dwordx4 v[72:75],v7,s[36:39],s64 offen nt
s_add_u32 s64,s62,1441792
buffer_load_dwordx4 v[76:79],v7,s[36:39],s64 offen nt
s_add_u32 s64,s62,1572864
buffer_load_dwordx4 v[80:83],v7,s[36:39],s64 offen nt
s_add_u32 s64,s62,1703936
buffer_load_dwordx4 v[84:87],v7,s[36:39],s64 offen nt
s_add_u32 s64,s62,1835008
buffer_load_dwordx4 v[88:91],v7,s[36:39],s64 offen nt
s_add_u32 s64,s62,1966080
buffer_load_dwordx4 v[92:95],v7,s[36:39],s64 offen nt
s_barrier
s_add_u32 s64,s63,0
s_add_u32 m0,s61,0
s_nop 0
buffer_load_dwordx4 v8,s[40:43],s64 offen nt lds
s_add_u32 s64,s63,32768
s_add_u32 m0,s61,1024
s_nop 0
buffer_load_dwordx4 v8,s[40:43],s64 offen nt lds
s_add_u32 s64,s63,65536
s_add_u32 m0,s61,2048
s_nop 0
buffer_load_dwordx4 v8,s[40:43],s64 offen nt lds
s_add_u32 s64,s63,98304
s_add_u32 m0,s61,3072
s_nop 0
buffer_load_dwordx4 v8,s[40:43],s64 offen nt lds
s_add_u32 s64,s63,131072
s_add_u32 m0,s61,4096
s_nop 0
buffer_load_dwordx4 v8,s[40:43],s64 offen nt lds
s_add_u32 s64,s63,163840
s_add_u32 m0,s61,5120
s_nop 0
buffer_load_dwordx4 v8,s[40:43],s64 offen nt lds
s_add_u32 s64,s63,196608
s_add_u32 m0,s61,6144
s_nop 0
buffer_load_dwordx4 v8,s[40:43],s64 offen nt lds
s_add_u32 s64,s63,229376
s_add_u32 m0,s61,7168
s_nop 0
buffer_load_dwordx4 v8,s[40:43],s64 offen nt lds
s_add_u32 s64,s63,262144
s_add_u32 m0,s61,8192
s_nop 0
buffer_load_dwordx4 v8,s[40:43],s64 offen nt lds
s_add_u32 s64,s63,294912
s_add_u32 m0,s61,9216
s_nop 0
buffer_load_dwordx4 v8,s[40:43],s64 offen nt lds
s_add_u32 s64,s63,327680
s_add_u32 m0,s61,10240
s_nop 0
buffer_load_dwordx4 v8,s[40:43],s64 offen nt lds
s_add_u32 s64,s63,360448
s_add_u32 m0,s61,11264
s_nop 0
buffer_load_dwordx4 v8,s[40:43],s64 offen nt lds
s_add_u32 s64,s63,393216
s_add_u32 m0,s61,12288
s_nop 0
buffer_load_dwordx4 v8,s[40:43],s64 offen nt lds
s_add_u32 s64,s63,425984
s_add_u32 m0,s61,13312
s_nop 0
buffer_load_dwordx4 v8,s[40:43],s64 offen nt lds
s_add_u32 s64,s63,458752
s_add_u32 m0,s61,14336
s_nop 0
buffer_load_dwordx4 v8,s[40:43],s64 offen nt lds
s_add_u32 s64,s63,491520
s_add_u32 m0,s61,15360
s_nop 0
buffer_load_dwordx4 v8,s[40:43],s64 offen nt lds
s_waitcnt vmcnt(32)
s_barrier
s_bitcmp1_b32 s68,1
s_cbranch_scc0 ws_12
ds_read_b64_tr_b16 a[128:129],v191 offset:0
ds_read_b64_tr_b16 a[130:131],v191 offset:128
ds_read_b64_tr_b16 a[132:133],v191 offset:2048
ds_read_b64_tr_b16 a[134:135],v191 offset:2176
ds_read_b64_tr_b16 a[136:137],v191 offset:4096
ds_read_b64_tr_b16 a[138:139],v191 offset:4224
ds_read_b64_tr_b16 a[140:141],v191 offset:6144
ds_read_b64_tr_b16 a[142:143],v191 offset:6272
s_waitcnt lgkmcnt(0)
ds_read_b64_tr_b16 a[144:145],v191 offset:8192
ds_read_b64_tr_b16 a[146:147],v191 offset:8320
ds_read_b64_tr_b16 a[148:149],v191 offset:10240
ds_read_b64_tr_b16 a[150:151],v191 offset:10368
ds_read_b64_tr_b16 a[152:153],v191 offset:12288
ds_read_b64_tr_b16 a[154:155],v191 offset:12416
ds_read_b64_tr_b16 a[156:157],v191 offset:14336
ds_read_b64_tr_b16 a[158:159],v191 offset:14464
s_waitcnt lgkmcnt(0)
ds_read_b64_tr_b16 a[160:161],v191 offset:16384
ds_read_b64_tr_b16 a[162:163],v191 offset:16512
ds_read_b64_tr_b16 a[164:165],v191 offset:18432
ds_read_b64_tr_b16 a[166:167],v191 offset:18560
ds_read_b64_tr_b16 a[168:169],v191 offset:20480
ds_read_b64_tr_b16 a[170:171],v191 offset:20608
ds_read_b64_tr_b16 a[172:173],v191 offset:22528
ds_read_b64_tr_b16 a[174:175],v191 offset:22656
s_waitcnt lgkmcnt(0)
ds_read_b64_tr_b16 a[176:177],v191 offset:24576
ds_read_b64_tr_b16 a[178:179],v191 offset:24704
ds_read_b64_tr_b16 a[180:181],v191 offset:26624
ds_read_b64_tr_b16 a[182:183],v191 offset:26752
ds_read_b64_tr_b16 a[184:185],v191 offset:28672
ds_read_b64_tr_b16 a[186:187],v191 offset:28800
ds_read_b64_tr_b16 a[188:189],v191 offset:30720
ds_read_b64_tr_b16 a[190:191],v191 offset:30848
s_waitcnt lgkmcnt(0)
ds_read_b64_tr_b16 a[192:193],v191 offset:32768
ds_read_b64_tr_b16 a[194:195],v191 offset:32896
ds_read_b64_tr_b16 a[196:197],v191 offset:34816
ds_read_b64_tr_b16 a[198:199],v191 offset:34944
ds_read_b64_tr_b16 a[200:201],v191 offset:36864
ds_read_b64_tr_b16 a[202:203],v191 offset:36992
ds_read_b64_tr_b16 a[204:205],v191 offset:38912
ds_read_b64_tr_b16 a[206:207],v191 offset:39040
s_waitcnt lgkmcnt(0)
ds_read_b64_tr_b16 a[208:209],v191 offset:40960
ds_read_b64_tr_b16 a[210:211],v191 offset:41088
ds_read_b64_tr_b16 a[212:213],v191 offset:43008
ds_read_b64_tr_b16 a[214:215],v191 offset:43136
ds_read_b64_tr_b16 a[216:217],v191 offset:45056
ds_read_b64_tr_b16 a[218:219],v191 offset:45184
ds_read_b64_tr_b16 a[220:221],v191 offset:47104
ds_read_b64_tr_b16 a[222:223],v191 offset:47232
s_waitcnt lgkmcnt(0)
ds_read_b64_tr_b16 a[224:225],v191 offset:49152
ds_read_b64_tr_b16 a[226:227],v191 offset:49280
ds_read_b64_tr_b16 a[228:229],v191 offset:51200
ds_read_b64_tr_b16 a[230:231],v191 offset:51328
ds_read_b64_tr_b16 a[232:233],v191 offset:53248
ds_read_b64_tr_b16 a[234:235],v191 offset:53376
ds_read_b64_tr_b16 a[236:237],v191 offset:55296
ds_read_b64_tr_b16 a[238:239],v191 offset:55424
s_waitcnt lgkmcnt(0)
ds_read_b64_tr_b16 a[240:241],v191 offset:57344
ds_read_b64_tr_b16 a[242:243],v191 offset:57472
ds_read_b64_tr_b16 a[244:245],v191 offset:59392
ds_read_b64_tr_b16 a[246:247],v191 offset:59520
ds_read_b64_tr_b16 a[248:249],v191 offset:61440
ds_read_b64_tr_b16 a[250:251],v191 offset:61568
ds_read_b64_tr_b16 a[252:253],v191 offset:63488
ds_read_b64_tr_b16 a[254:255],v191 offset:63616
s_waitcnt lgkmcnt(0)
ws_12:
s_waitcnt vmcnt(16)
s_barrier
ds_write_b128 v193,v[32:35] offset:0
ds_write_b128 v193,v[36:39] offset:1024
ds_write_b128 v193,v[40:43] offset:2048
ds_write_b128 v193,v[44:47] offset:3072
ds_write_b128 v193,v[48:51] offset:4096
ds_write_b128 v193,v[52:55] offset:5120
ds_write_b128 v193,v[56:59] offset:6144
ds_write_b128 v193,v[60:63] offset:7168
ds_write_b128 v193,v[64:67] offset:8192
ds_write_b128 v193,v[68:71] offset:9216
ds_write_b128 v193,v[72:75] offset:10240
ds_write_b128 v193,v[76:79] offset:11264
ds_write_b128 v193,v[80:83] offset:12288
ds_write_b128 v193,v[84:87] offset:13312
ds_write_b128 v193,v[88:91] offset:14336
ds_write_b128 v193,v[92:95] offset:15360
s_mov_b32 s69,1
v_mov_b32 v190,v191
s_waitcnt lgkmcnt(0)
s_barrier
s_bitcmp1_b32 s68,1
s_cbranch_scc0 rq_15
rqb_16:
s_waitcnt vmcnt(0)
s_barrier
s_bitcmp1_b32 s68,1
s_cbranch_scc1 ws_13
ds_read_b64_tr_b16 a[128:129],v192 offset:0
ds_read_b64_tr_b16 a[130:131],v192 offset:128
ds_read_b64_tr_b16 a[132:133],v192 offset:2048
ds_read_b64_tr_b16 a[134:135],v192 offset:2176
ds_read_b64_tr_b16 a[136:137],v192 offset:32
ds_read_b64_tr_b16 a[138:139],v192 offset:160
ds_read_b64_tr_b16 a[140:141],v192 offset:2080
ds_read_b64_tr_b16 a[142:143],v192 offset:2208
s_waitcnt lgkmcnt(0)
ds_read_b64_tr_b16 a[144:145],v192 offset:4096
ds_read_b64_tr_b16 a[146:147],v192 offset:4224
ds_read_b64_tr_b16 a[148:149],v192 offset:6144
ds_read_b64_tr_b16 a[150:151],v192 offset:6272
ds_read_b64_tr_b16 a[152:153],v192 offset:4128
ds_read_b64_tr_b16 a[154:155],v192 offset:4256
ds_read_b64_tr_b16 a[156:157],v192 offset:6176
ds_read_b64_tr_b16 a[158:159],v192 offset:6304
s_waitcnt lgkmcnt(0)
ds_read_b64_tr_b16 a[160:161],v192 offset:8192
ds_read_b64_tr_b16 a[162:163],v192 offset:8320
ds_read_b64_tr_b16 a[164:165],v192 offset:10240
ds_read_b64_tr_b16 a[166:167],v192 offset:10368
ds_read_b64_tr_b16 a[168:169],v192 offset:8224
ds_read_b64_tr_b16 a[170:171],v192 offset:8352
ds_read_b64_tr_b16 a[172:173],v192 offset:10272
ds_read_b64_tr_b16 a[174:175],v192 offset:10400
s_waitcnt lgkmcnt(0)
ds_read_b64_tr_b16 a[176:177],v192 offset:12288
ds_read_b64_tr_b16 a[178:179],v192 offset:12416
ds_read_b64_tr_b16 a[180:181],v192 offset:14336
ds_read_b64_tr_b16 a[182:183],v192 offset:14464
ds_read_b64_tr_b16 a[184:185],v192 offset:12320
ds_read_b64_tr_b16 a[186:187],v192 offset:12448
ds_read_b64_tr_b16 a[188:189],v192 offset:14368
ds_read_b64_tr_b16 a[190:191],v192 offset:14496
s_waitcnt lgkmcnt(0)
ds_read_b64_tr_b16 a[192:193],v192 offset:16384
ds_read_b64_tr_b16 a[194:195],v192 offset:16512
ds_read_b64_tr_b16 a[196:197],v192 offset:18432
ds_read_b64_tr_b16 a[198:199],v192 offset:18560
ds_read_b64_tr_b16 a[200:201],v192 offset:16416
ds_read_b64_tr_b16 a[202:203],v192 offset:16544
ds_read_b64_tr_b16 a[204:205],v192 offset:18464
ds_read_b64_tr_b16 a[206:207],v192 offset:18592
s_waitcnt lgkmcnt(0)
ds_read_b64_tr_b16 a[208:209],v192 offset:20480
ds_read_b64_tr_b16 a[210:211],v192 offset:20608
ds_read_b64_tr_b16 a[212:213],v192 offset:22528
ds_read_b64_tr_b16 a[214:215],v192 offset:22656
ds_read_b64_tr_b16 a[216:217],v192 offset:20512
ds_read_b64_tr_b16 a[218:219],v192 offset:20640
ds_read_b64_tr_b16 a[220:221],v192 offset:22560
ds_read_b64_tr_b16 a[222:223],v192 offset:22688
s_waitcnt lgkmcnt(0)
ds_read_b64_tr_b16 a[224:225],v192 offset:24576
ds_read_b64_tr_b16 a[226:227],v192 offset:24704
ds_read_b64_tr_b16 a[228:229],v192 offset:26624
ds_read_b64_tr_b16 a[230:231],v192 offset:26752
ds_read_b64_tr_b16 a[232:233],v192 offset:24608
ds_read_b64_tr_b16 a[234:235],v192 offset:24736
ds_read_b64_tr_b16 a[236:237],v192 offset:26656
ds_read_b64_tr_b16 a[238:239],v192 offset:26784
s_waitcnt lgkmcnt(0)
ds_read_b64_tr_b16 a[240:241],v192 offset:28672
ds_read_b64_tr_b16 a[242:243],v192 offset:28800
ds_read_b64_tr_b16 a[244:245],v192 offset:30720
ds_read_b64_tr_b16 a[246:247],v192 offset:30848
ds_read_b64_tr_b16 a[248:249],v192 offset:28704
ds_read_b64_tr_b16 a[250:251],v192 offset:28832
ds_read_b64_tr_b16 a[252:253],v192 offset:30752
ds_read_b64_tr_b16 a[254:255],v192 offset:30880
s_waitcnt lgkmcnt(0)
ws_13:
v_mov_b32 v187,158976
s_cmp_lg_u32 s50,1
s_cbranch_scc1 sh0_17
v_readfirstlane_b32 s64,v204
s_cmp_lg_u32 s64,143
s_cbranch_scc1 narr_20
s_mov_b32 s65,0
s_cmp_eq_u32 s56,1
s_cbranch_scc1 nopar_21
v_mov_b32 v184,0
dp_22:
buffer_load_dword v185,v184,s[44:47],32 offen sc1
s_waitcnt vmcnt(0)
v_cmp_eq_u32 vcc,0,v185
s_cbranch_vccz dpok_23
s_sleep 4
s_sub_u32 s90,s90,1
s_cmp_gt_i32 s90,0
s_cbranch_scc1 dp_22
dpok_23:
v_readfirstlane_b32 s65,v185
s_and_b32 s65,s65,1
s_lshl_b32 s61,s65,13
nopar_21:
s_add_u32 s65,s65,2
v_lshlrev_b32 v184,7,v1
v_mov_b32 v185,s65
s_mov_b32 s64,21168128
s_mov_b32 s65,21176320
buffer_store_dword v185,v184,s[20:23],s64 offen sc1
buffer_store_dword v185,v184,s[20:23],s65 offen sc1
narr_20:
s_mov_b32 s53,0
stl_18:
v_mov_b32 v184,0
buffer_load_dword v185,v184,s[20:23],s52 offen sc1
s_waitcnt vmcnt(0)
v_readfirstlane_b32 s64,v185
s_mov_b32 s65,0
s_and_b32 s61,s64,1
s_lshl_b32 s61,s61,13
s_cmp_lg_u32 s64,0
s_cbranch_scc1 stok_19
s_sub_u32 s90,s90,1
s_cmp_lt_i32 s90,0
s_cbranch_scc1 stok_19
s_add_u32 s53,s53,1
s_and_b32 s64,s53,31
s_cbranch_scc1 stl_18
s_cmp_eq_u32 s56,1
s_cbranch_scc1 stl_18
v_and_b32 v184,3,v1
v_bfe_u32 v185,v1,2,1
v_lshlrev_b32 v184,2,v184
v_lshl_add_u32 v184,v185,7,v184
v_writelane_b32 v184,32,8
s_mov_b64 exec,0x1ff
vpoll_24:
buffer_load_dword v185,v184,s[44:47],0 offen sc1
s_waitcnt vmcnt(0)
v_readlane_b32 s92,v185,0
v_readlane_b32 s93,v185,1
v_readlane_b32 s94,v185,2
v_readlane_b32 s95,v185,3
v_readlane_b32 s96,v185,4
v_readlane_b32 s97,v185,5
v_readlane_b32 s98,v185,6
v_readlane_b32 s99,v185,7
v_readlane_b32 s61,v185,8
s_add_u32 s64,s92,s93
s_add_u32 s64,s64,s94
s_add_u32 s64,s64,s95
s_add_u32 s64,s64,s96
s_add_u32 s64,s64,s97
s_add_u32 s64,s64,s98
s_add_u32 s64,s64,s99
s_min_u32 s65,s92,s93
s_min_u32 s66,s94,s95
s_min_u32 s65,s65,s66
s_min_u32 s66,s96,s97
s_min_u32 s65,s65,s66
s_min_u32 s66,s98,s99
s_min_u32 s65,s65,s66
s_cmp_lt_u32 s65,32
s_cselect_b32 s65,1,0
s_cmp_lt_u32 s64,256
s_cbranch_scc1 vslp_26
s_branch vgot_25
vslp_26:
s_sleep 8
s_sub_u32 s90,s90,1
s_cmp_gt_i32 s90,0
s_cbranch_scc1 vpoll_24
vgot_25:
s_mov_b64 exec,-1
s_and_b32 s61,s61,1
s_lshl_b32 s61,s61,13
s_mov_b32 s66,s54
s_cmp_gt_u32 s51,0
s_cselect_b32 s64,s92,0
s_add_u32 s66,s66,s64
s_cmp_gt_u32 s51,1
s_cselect_b32 s64,s93,0
s_add_u32 s66,s66,s64
s_cmp_gt_u32 s51,2
s_cselect_b32 s64,s94,0
s_add_u32 s66,s66,s64
s_cmp_gt_u32 s51,3
s_cselect_b32 s64,s95,0
s_add_u32 s66,s66,s64
s_cmp_gt_u32 s51,4
s_cselect_b32 s64,s96,0
s_add_u32 s66,s66,s64
s_cmp_gt_u32 s51,5
s_cselect_b32 s64,s97,0
s_add_u32 s66,s66,s64
s_cmp_gt_u32 s51,6
s_cselect_b32 s64,s98,0
s_add_u32 s66,s66,s64
s_cmp_eq_u32 s65,0
s_cbranch_scc1 stl_18
stok_19:
v_mov_b32 v184,s65
v_mov_b32 v185,s66
v_mov_b32 v186,s61
ds_write_b96 v187,v[184:186] offset:16
s_waitcnt lgkmcnt(0)
sh0_17:
s_barrier
ds_read_b96 v[184:186],v187 offset:16
s_waitcnt lgkmcnt(0)
v_readfirstlane_b32 s65,v184
v_readfirstlane_b32 s66,v185
v_readfirstlane_b32 s61,v186
s_cmp_lg_u32 s65,0
s_cbranch_scc1 slowrole_10
s_and_b32 s56,s56,1
s_branch loops_7
pre_8:
s_sub_u32 s55,s57,128
s_load_dwordx4 s[4:7],s[0:1],96
s_load_dwordx2 s[8:9],s[0:1],0
v_and_b32 v1,63,v0
v_lshrrev_b32 v2,6,v0
v_and_b32 v3,7,v0
v_lshrrev_b32 v4,3,v0
v_mul_u32_u24 v5,12288,v4
v_lshl_add_u32 v5,v3,4,v5
v_lshlrev_b32 v6,1,v4
s_and_b32 s24,s55,31
s_lshr_b32 s25,s55,5
s_lshl_b32 s26,s24,7
s_mul_i32 s27,s25,3145728
s_add_u32 s26,s26,s27
s_lshl_b32 s27,s25,9
s_waitcnt lgkmcnt(0)
s_mov_b32 s12,s4
s_and_b32 s13,s5,0xffff
s_mov_b32 s14,0x800
s_mov_b32 s15,0x20000
s_mov_b32 s28,s6
s_and_b32 s29,s7,0xffff
s_mov_b32 s30,0xc00000
s_mov_b32 s31,0x20000
s_mov_b32 s32,s8
s_and_b32 s33,s9,0xffff
s_mov_b32 s34,0x400000
s_mov_b32 s35,0x20000
buffer_load_dwordx4 v[64:67],v5,s[28:31],s26 offen nt
s_add_u32 s26,s26,393216
buffer_load_dwordx4 v[68:71],v5,s[28:31],s26 offen nt
s_add_u32 s26,s26,393216
buffer_load_dwordx4 v[72:75],v5,s[28:31],s26 offen nt
s_add_u32 s26,s26,393216
buffer_load_dwordx4 v[76:79],v5,s[28:31],s26 offen nt
s_add_u32 s26,s26,393216
buffer_load_dwordx4 v[80:83],v5,s[28:31],s26 offen nt
s_add_u32 s26,s26,393216
buffer_load_dwordx4 v[84:87],v5,s[28:31],s26 offen nt
s_add_u32 s26,s26,393216
buffer_load_dwordx4 v[88:91],v5,s[28:31],s26 offen nt
s_add_u32 s26,s26,393216
buffer_load_dwordx4 v[92:95],v5,s[28:31],s26 offen nt
buffer_load_ushort v96,v6,s[12:15],s27 offen offset:0
buffer_load_ushort v97,v6,s[12:15],s27 offen offset:64
buffer_load_ushort v98,v6,s[12:15],s27 offen offset:128
buffer_load_ushort v99,v6,s[12:15],s27 offen offset:192
buffer_load_ushort v100,v6,s[12:15],s27 offen offset:256
buffer_load_ushort v101,v6,s[12:15],s27 offen offset:320
buffer_load_ushort v102,v6,s[12:15],s27 offen offset:384
buffer_load_ushort v103,v6,s[12:15],s27 offen offset:448
v_and_b32 v3,3,v1
v_lshrrev_b32 v4,2,v1
v_lshl_add_u32 v5,v2,2,v3
v_lshlrev_b32 v5,11,v5
v_lshl_add_u32 v5,v4,5,v5
s_lshl_b32 s36,s55,15
buffer_load_dwordx4 v[8:11],v5,s[32:35],s36 offen offset:0
buffer_load_dwordx4 v[12:15],v5,s[32:35],s36 offen offset:16
buffer_load_dwordx4 v[16:19],v5,s[32:35],s36 offen offset:512
buffer_load_dwordx4 v[20:23],v5,s[32:35],s36 offen offset:528
buffer_load_dwordx4 v[24:27],v5,s[32:35],s36 offen offset:1024
buffer_load_dwordx4 v[28:31],v5,s[32:35],s36 offen offset:1040
buffer_load_dwordx4 v[32:35],v5,s[32:35],s36 offen offset:1536
buffer_load_dwordx4 v[36:39],v5,s[32:35],s36 offen offset:1552
v_lshrrev_b32 v6,1,v4
v_lshlrev_b32 v6,11,v6
v_and_b32 v7,1,v4
v_lshl_add_u32 v6,v7,9,v6
v_and_b32 v7,1,v2
v_lshl_add_u32 v6,v7,10,v6
v_lshrrev_b32 v7,1,v2
v_lshl_add_u32 v7,v7,2,v3
v_lshl_add_u32 v6,v7,4,v6
v_lshlrev_b32 v4,6,v4
s_lshr_b32 s37,s55,1
s_lshl_b32 s37,s37,16
s_and_b32 s38,s55,1
s_lshl_b32 s38,s38,7
s_add_u32 s37,s37,s38
s_add_u32 s37,s37,57344
s_mov_b32 s38,0xbfb8aa3b
s_mov_b32 s39,0xffff0000
s_cmp_lg_u32 s50,1
s_cbranch_scc1 nz_27
s_lshl_b32 s40,s55,8
s_add_u32 s40,s40,21037056
s_lshr_b32 s41,s55,2
s_lshl_b32 s41,s41,11
s_and_b32 s42,s55,3
s_lshl_b32 s42,s42,8
s_add_u32 s41,s41,s42
s_add_u32 s42,s41,16965312
s_add_u32 s41,s41,12771072
v_mov_b32 v104,s40
v_mov_b32 v105,s41
v_cmp_gt_u32 vcc,16,v1
s_nop 1
v_cndmask_b32 v104,v105,v104,vcc
v_mov_b32 v105,s42
v_cmp_gt_u32 vcc,20,v1
s_nop 1
v_cndmask_b32 v104,v105,v104,vcc
v_lshl_add_u32 v104,v1,4,v104
s_lshl_b32 s41,s55,7
s_add_u32 s41,s41,21102592
v_writelane_b32 v104,s41,24
v_mov_b32 v108,0
v_mov_b32 v109,0
v_mov_b32 v110,0
v_mov_b32 v111,0
s_mov_b64 exec,0x1ffffff
buffer_store_dwordx4 v[108:111],v104,s[20:23],0 offen sc1
s_mov_b64 exec,-1
nz_27:
v_mov_b32 v112,0
v_mov_b32 v113,0
v_mov_b32 v114,0
v_mov_b32 v115,0
v_mov_b32 v116,0
v_mov_b32 v117,0
v_mov_b32 v118,0
v_mov_b32 v119,0
s_waitcnt vmcnt(8)
v_lshlrev_b32 v96,16,v96
v_mul_f32 v104,s38,v96
v_exp_f32 v104,v104
s_nop 0
v_add_f32 v104,1.0,v104
v_rcp_f32 v104,v104
s_nop 0
v_mul_f32 v104,v104,v96
v_cvt_pk_bf16_f32 v104,v104,v104
v_and_b32 v96,s39,v104
v_lshlrev_b32 v105,16,v64
v_and_b32 v106,s39,v64
v_fmac_f32 v112,v105,v96
v_fmac_f32 v113,v106,v96
v_lshlrev_b32 v105,16,v65
v_and_b32 v106,s39,v65
v_fmac_f32 v114,v105,v96
v_fmac_f32 v115,v106,v96
v_lshlrev_b32 v105,16,v66
v_and_b32 v106,s39,v66
v_fmac_f32 v116,v105,v96
v_fmac_f32 v117,v106,v96
v_lshlrev_b32 v105,16,v67
v_and_b32 v106,s39,v67
v_fmac_f32 v118,v105,v96
v_fmac_f32 v119,v106,v96
v_lshlrev_b32 v97,16,v97
v_mul_f32 v104,s38,v97
v_exp_f32 v104,v104
s_nop 0
v_add_f32 v104,1.0,v104
v_rcp_f32 v104,v104
s_nop 0
v_mul_f32 v104,v104,v97
v_cvt_pk_bf16_f32 v104,v104,v104
v_and_b32 v97,s39,v104
v_lshlrev_b32 v105,16,v68
v_and_b32 v106,s39,v68
v_fmac_f32 v112,v105,v97
v_fmac_f32 v113,v106,v97
v_lshlrev_b32 v105,16,v69
v_and_b32 v106,s39,v69
v_fmac_f32 v114,v105,v97
v_fmac_f32 v115,v106,v97
v_lshlrev_b32 v105,16,v70
v_and_b32 v106,s39,v70
v_fmac_f32 v116,v105,v97
v_fmac_f32 v117,v106,v97
v_lshlrev_b32 v105,16,v71
v_and_b32 v106,s39,v71
v_fmac_f32 v118,v105,v97
v_fmac_f32 v119,v106,v97
v_lshlrev_b32 v98,16,v98
v_mul_f32 v104,s38,v98
v_exp_f32 v104,v104
s_nop 0
v_add_f32 v104,1.0,v104
v_rcp_f32 v104,v104
s_nop 0
v_mul_f32 v104,v104,v98
v_cvt_pk_bf16_f32 v104,v104,v104
v_and_b32 v98,s39,v104
v_lshlrev_b32 v105,16,v72
v_and_b32 v106,s39,v72
v_fmac_f32 v112,v105,v98
v_fmac_f32 v113,v106,v98
v_lshlrev_b32 v105,16,v73
v_and_b32 v106,s39,v73
v_fmac_f32 v114,v105,v98
v_fmac_f32 v115,v106,v98
v_lshlrev_b32 v105,16,v74
v_and_b32 v106,s39,v74
v_fmac_f32 v116,v105,v98
v_fmac_f32 v117,v106,v98
v_lshlrev_b32 v105,16,v75
v_and_b32 v106,s39,v75
v_fmac_f32 v118,v105,v98
v_fmac_f32 v119,v106,v98
v_lshlrev_b32 v99,16,v99
v_mul_f32 v104,s38,v99
v_exp_f32 v104,v104
s_nop 0
v_add_f32 v104,1.0,v104
v_rcp_f32 v104,v104
s_nop 0
v_mul_f32 v104,v104,v99
v_cvt_pk_bf16_f32 v104,v104,v104
v_and_b32 v99,s39,v104
v_lshlrev_b32 v105,16,v76
v_and_b32 v106,s39,v76
v_fmac_f32 v112,v105,v99
v_fmac_f32 v113,v106,v99
v_lshlrev_b32 v105,16,v77
v_and_b32 v106,s39,v77
v_fmac_f32 v114,v105,v99
v_fmac_f32 v115,v106,v99
v_lshlrev_b32 v105,16,v78
v_and_b32 v106,s39,v78
v_fmac_f32 v116,v105,v99
v_fmac_f32 v117,v106,v99
v_lshlrev_b32 v105,16,v79
v_and_b32 v106,s39,v79
v_fmac_f32 v118,v105,v99
v_fmac_f32 v119,v106,v99
v_lshlrev_b32 v100,16,v100
v_mul_f32 v104,s38,v100
v_exp_f32 v104,v104
s_nop 0
v_add_f32 v104,1.0,v104
v_rcp_f32 v104,v104
s_nop 0
v_mul_f32 v104,v104,v100
v_cvt_pk_bf16_f32 v104,v104,v104
v_and_b32 v100,s39,v104
v_lshlrev_b32 v105,16,v80
v_and_b32 v106,s39,v80
v_fmac_f32 v112,v105,v100
v_fmac_f32 v113,v106,v100
v_lshlrev_b32 v105,16,v81
v_and_b32 v106,s39,v81
v_fmac_f32 v114,v105,v100
v_fmac_f32 v115,v106,v100
v_lshlrev_b32 v105,16,v82
v_and_b32 v106,s39,v82
v_fmac_f32 v116,v105,v100
v_fmac_f32 v117,v106,v100
v_lshlrev_b32 v105,16,v83
v_and_b32 v106,s39,v83
v_fmac_f32 v118,v105,v100
v_fmac_f32 v119,v106,v100
v_lshlrev_b32 v101,16,v101
v_mul_f32 v104,s38,v101
v_exp_f32 v104,v104
s_nop 0
v_add_f32 v104,1.0,v104
v_rcp_f32 v104,v104
s_nop 0
v_mul_f32 v104,v104,v101
v_cvt_pk_bf16_f32 v104,v104,v104
v_and_b32 v101,s39,v104
v_lshlrev_b32 v105,16,v84
v_and_b32 v106,s39,v84
v_fmac_f32 v112,v105,v101
v_fmac_f32 v113,v106,v101
v_lshlrev_b32 v105,16,v85
v_and_b32 v106,s39,v85
v_fmac_f32 v114,v105,v101
v_fmac_f32 v115,v106,v101
v_lshlrev_b32 v105,16,v86
v_and_b32 v106,s39,v86
v_fmac_f32 v116,v105,v101
v_fmac_f32 v117,v106,v101
v_lshlrev_b32 v105,16,v87
v_and_b32 v106,s39,v87
v_fmac_f32 v118,v105,v101
v_fmac_f32 v119,v106,v101
v_lshlrev_b32 v102,16,v102
v_mul_f32 v104,s38,v102
v_exp_f32 v104,v104
s_nop 0
v_add_f32 v104,1.0,v104
v_rcp_f32 v104,v104
s_nop 0
v_mul_f32 v104,v104,v102
v_cvt_pk_bf16_f32 v104,v104,v104
v_and_b32 v102,s39,v104
v_lshlrev_b32 v105,16,v88
v_and_b32 v106,s39,v88
v_fmac_f32 v112,v105,v102
v_fmac_f32 v113,v106,v102
v_lshlrev_b32 v105,16,v89
v_and_b32 v106,s39,v89
v_fmac_f32 v114,v105,v102
v_fmac_f32 v115,v106,v102
v_lshlrev_b32 v105,16,v90
v_and_b32 v106,s39,v90
v_fmac_f32 v116,v105,v102
v_fmac_f32 v117,v106,v102
v_lshlrev_b32 v105,16,v91
v_and_b32 v106,s39,v91
v_fmac_f32 v118,v105,v102
v_fmac_f32 v119,v106,v102
v_lshlrev_b32 v103,16,v103
v_mul_f32 v104,s38,v103
v_exp_f32 v104,v104
s_nop 0
v_add_f32 v104,1.0,v104
v_rcp_f32 v104,v104
s_nop 0
v_mul_f32 v104,v104,v103
v_cvt_pk_bf16_f32 v104,v104,v104
v_and_b32 v103,s39,v104
v_lshlrev_b32 v105,16,v92
v_and_b32 v106,s39,v92
v_fmac_f32 v112,v105,v103
v_fmac_f32 v113,v106,v103
v_lshlrev_b32 v105,16,v93
v_and_b32 v106,s39,v93
v_fmac_f32 v114,v105,v103
v_fmac_f32 v115,v106,v103
v_lshlrev_b32 v105,16,v94
v_and_b32 v106,s39,v94
v_fmac_f32 v116,v105,v103
v_fmac_f32 v117,v106,v103
v_lshlrev_b32 v105,16,v95
v_and_b32 v106,s39,v95
v_fmac_f32 v118,v105,v103
v_fmac_f32 v119,v106,v103
v_permlane32_swap_b32 v112,v116
v_permlane32_swap_b32 v113,v117
v_permlane32_swap_b32 v114,v118
v_permlane32_swap_b32 v115,v119
v_add_f32 v112,v112,v116
v_add_f32 v113,v113,v117
v_add_f32 v114,v114,v118
v_add_f32 v115,v115,v119
s_nop 0
v_permlane16_swap_b32 v112,v114
v_permlane16_swap_b32 v113,v115
v_add_f32 v112,v112,v114
v_add_f32 v113,v113,v115
s_nop 0
v_add_f32_dpp v112,v112,v112 row_ror:8 row_mask:0xf bank_mask:0xf
v_add_f32_dpp v113,v113,v113 row_ror:8 row_mask:0xf bank_mask:0xf
v_and_b32 v104,7,v1
v_lshlrev_b32 v104,5,v104
v_lshrrev_b32 v105,5,v1
v_lshl_add_u32 v104,v105,4,v104
v_bfe_u32 v105,v1,4,1
v_lshl_add_u32 v104,v105,3,v104
v_lshl_add_u32 v104,v2,8,v104
ds_write_b64 v104,v[112:113]
v_lshlrev_b32 v105,2,v1
s_lshl_b32 s40,s25,13
s_lshl_b32 s41,s24,8
s_add_u32 s40,s40,s41
s_add_u32 s40,s40,24576
s_waitcnt lgkmcnt(0)
s_barrier
s_cmp_lg_u32 s50,0
s_cbranch_scc1 m1n0_28
ds_read_b32 v112,v105 offset:0
ds_read_b32 v113,v105 offset:256
ds_read_b32 v114,v105 offset:512
ds_read_b32 v115,v105 offset:768
s_waitcnt lgkmcnt(0)
v_add_f32 v112,v112,v113
v_add_f32 v114,v114,v115
v_add_f32 v112,v112,v114
buffer_store_dword v112,v105,s[20:23],s40 offen sc1
m1n0_28:
s_waitcnt vmcnt(0)
s_barrier
s_cmp_lg_u32 s50,0
s_cbranch_scc1 post_9
s_mov_b64 exec,1
v_mov_b32 v184,1
v_mov_b32 v185,0
s_and_b32 s52,s56,1
s_lshl_b32 s52,s52,2
s_add_u32 s52,s52,160
buffer_atomic_add v184,v185,s[44:47],s52 offen sc0 sc1
s_waitcnt vmcnt(0)
v_readfirstlane_b32 s64,v184
s_mov_b64 exec,-1
s_cmp_eq_u32 s56,1
s_cbranch_scc1 post_9
s_cmp_lg_u32 s64,127
s_cbranch_scc1 post_9
v_and_b32 v184,3,v1
v_bfe_u32 v185,v1,2,1
v_lshlrev_b32 v184,2,v184
v_lshl_add_u32 v184,v185,7,v184
v_writelane_b32 v184,32,8
s_mov_b64 exec,0x1ff
vpoll_30:
buffer_load_dword v185,v184,s[44:47],0 offen sc1
s_waitcnt vmcnt(0)
v_readlane_b32 s92,v185,0
v_readlane_b32 s93,v185,1
v_readlane_b32 s94,v185,2
v_readlane_b32 s95,v185,3
v_readlane_b32 s96,v185,4
v_readlane_b32 s97,v185,5
v_readlane_b32 s98,v185,6
v_readlane_b32 s99,v185,7
v_readlane_b32 s61,v185,8
s_add_u32 s64,s92,s93
s_add_u32 s64,s64,s94
s_add_u32 s64,s64,s95
s_add_u32 s64,s64,s96
s_add_u32 s64,s64,s97
s_add_u32 s64,s64,s98
s_add_u32 s64,s64,s99
s_min_u32 s65,s92,s93
s_min_u32 s66,s94,s95
s_min_u32 s65,s65,s66
s_min_u32 s66,s96,s97
s_min_u32 s65,s65,s66
s_min_u32 s66,s98,s99
s_min_u32 s65,s65,s66
s_cmp_lt_u32 s65,32
s_cselect_b32 s65,1,0
s_cmp_lt_u32 s64,256
s_cbranch_scc1 vslp_32
s_branch vgot_31
vslp_32:
s_sleep 8
s_sub_u32 s90,s90,1
s_cmp_gt_i32 s90,0
s_cbranch_scc1 vpoll_30
vgot_31:
s_mov_b64 exec,-1
s_and_b32 s61,s61,1
s_lshl_b32 s61,s61,13
s_cmp_lg_u32 s65,0
s_cbranch_scc1 post_9
v_lshlrev_b32 v184,7,v1
v_mov_b32 v185,1
s_mov_b32 s64,21102592
s_mov_b32 s65,21110784
buffer_store_dword v185,v184,s[20:23],s64 offen sc1
buffer_store_dword v185,v184,s[20:23],s65 offen sc1
s_branch post_9
verify_6:
v_mov_b32 v187,158976
s_cmp_lg_u32 s50,0
s_cbranch_scc1 sh0_33
v_and_b32 v184,3,v1
v_bfe_u32 v185,v1,2,1
v_lshlrev_b32 v184,2,v184
v_lshl_add_u32 v184,v185,7,v184
v_writelane_b32 v184,32,8
s_mov_b64 exec,0x1ff
vpoll_34:
buffer_load_dword v185,v184,s[44:47],0 offen sc1
s_waitcnt vmcnt(0)
v_readlane_b32 s92,v185,0
v_readlane_b32 s93,v185,1
v_readlane_b32 s94,v185,2
v_readlane_b32 s95,v185,3
v_readlane_b32 s96,v185,4
v_readlane_b32 s97,v185,5
v_readlane_b32 s98,v185,6
v_readlane_b32 s99,v185,7
v_readlane_b32 s61,v185,8
s_add_u32 s64,s92,s93
s_add_u32 s64,s64,s94
s_add_u32 s64,s64,s95
s_add_u32 s64,s64,s96
s_add_u32 s64,s64,s97
s_add_u32 s64,s64,s98
s_add_u32 s64,s64,s99
s_min_u32 s65,s92,s93
s_min_u32 s66,s94,s95
s_min_u32 s65,s65,s66
s_min_u32 s66,s96,s97
s_min_u32 s65,s65,s66
s_min_u32 s66,s98,s99
s_min_u32 s65,s65,s66
s_cmp_lt_u32 s65,32
s_cselect_b32 s65,1,0
s_cmp_lt_u32 s64,256
s_cbranch_scc1 vslp_36
s_branch vgot_35
vslp_36:
s_sleep 8
s_sub_u32 s90,s90,1
s_cmp_gt_i32 s90,0
s_cbranch_scc1 vpoll_34
vgot_35:
s_mov_b64 exec,-1
s_and_b32 s61,s61,1
s_lshl_b32 s61,s61,13
s_mov_b32 s66,s54
s_cmp_gt_u32 s51,0
s_cselect_b32 s64,s92,0
s_add_u32 s66,s66,s64
s_cmp_gt_u32 s51,1
s_cselect_b32 s64,s93,0
s_add_u32 s66,s66,s64
s_cmp_gt_u32 s51,2
s_cselect_b32 s64,s94,0
s_add_u32 s66,s66,s64
s_cmp_gt_u32 s51,3
s_cselect_b32 s64,s95,0
s_add_u32 s66,s66,s64
s_cmp_gt_u32 s51,4
s_cselect_b32 s64,s96,0
s_add_u32 s66,s66,s64
s_cmp_gt_u32 s51,5
s_cselect_b32 s64,s97,0
s_add_u32 s66,s66,s64
s_cmp_gt_u32 s51,6
s_cselect_b32 s64,s98,0
s_add_u32 s66,s66,s64
v_mov_b32 v184,s65
v_mov_b32 v185,s66
v_mov_b32 v186,s61
ds_write_b96 v187,v[184:186] offset:16
s_waitcnt lgkmcnt(0)
sh0_33:
s_barrier
ds_read_b96 v[184:186],v187 offset:16
s_waitcnt lgkmcnt(0)
v_readfirstlane_b32 s65,v184
v_readfirstlane_b32 s66,v185
v_readfirstlane_b32 s61,v186
s_cmp_lg_u32 s65,0
s_cbranch_scc1 slowrole_10
s_mov_b32 s56,0
s_branch done_1
slowrole_10:
s_mov_b32 s57,s66
s_mov_b32 s56,1
s_waitcnt vmcnt(0)
s_barrier
s_cmp_ge_u32 s57,128
s_cbranch_scc1 pre_8
s_cmp_lg_u32 s50,0
s_cbranch_scc1 nadd_37
s_mov_b64 exec,1
v_mov_b32 v184,1
v_mov_b32 v185,0
s_mov_b32 s52,164
buffer_atomic_add v184,v185,s[44:47],s52 offen sc1
s_mov_b64 exec,-1
nadd_37:
s_branch setup_5
post_9:
s_sub_u32 s65,s57,255
s_and_b32 s66,s56,1
s_or_b32 s65,s65,s66
s_or_b32 s65,s65,s50
s_cmp_lg_u32 s65,0
s_cbranch_scc1 nomeas_38
s_mov_b64 exec,1
v_mov_b32 v184,0
s_mov_b32 s52,20971520
s_mov_b32 s53,20979712
s_mov_b32 s70,0x7fffffff
s_mov_b32 s71,0x7fffffff
s_memtime s[72:73]
s_waitcnt lgkmcnt(0)
buffer_store_dword v184,v184,s[20:23],s52 offen sc1
s_waitcnt vmcnt(0)
s_memtime s[74:75]
s_waitcnt lgkmcnt(0)
s_sub_u32 s74,s74,s72
s_min_u32 s70,s70,s74
s_memtime s[72:73]
s_waitcnt lgkmcnt(0)
buffer_store_dword v184,v184,s[20:23],s53 offen sc1
s_waitcnt vmcnt(0)
s_memtime s[74:75]
s_waitcnt lgkmcnt(0)
s_sub_u32 s74,s74,s72
s_min_u32 s71,s71,s74
s_memtime s[72:73]
s_waitcnt lgkmcnt(0)
buffer_store_dword v184,v184,s[20:23],s52 offen sc1
s_waitcnt vmcnt(0)
s_memtime s[74:75]
s_waitcnt lgkmcnt(0)
s_sub_u32 s74,s74,s72
s_min_u32 s70,s70,s74
s_memtime s[72:73]
s_waitcnt lgkmcnt(0)
buffer_store_dword v184,v184,s[20:23],s53 offen sc1
s_waitcnt vmcnt(0)
s_memtime s[74:75]
s_waitcnt lgkmcnt(0)
s_sub_u32 s74,s74,s72
s_min_u32 s71,s71,s74
s_memtime s[72:73]
s_waitcnt lgkmcnt(0)
buffer_store_dword v184,v184,s[20:23],s52 offen sc1
s_waitcnt vmcnt(0)
s_memtime s[74:75]
s_waitcnt lgkmcnt(0)
s_sub_u32 s74,s74,s72
s_min_u32 s70,s70,s74
s_memtime s[72:73]
s_waitcnt lgkmcnt(0)
buffer_store_dword v184,v184,s[20:23],s53 offen sc1
s_waitcnt vmcnt(0)
s_memtime s[74:75]
s_waitcnt lgkmcnt(0)
s_sub_u32 s74,s74,s72
s_min_u32 s71,s71,s74
s_memtime s[72:73]
s_waitcnt lgkmcnt(0)
buffer_store_dword v184,v184,s[20:23],s52 offen sc1
s_waitcnt vmcnt(0)
s_memtime s[74:75]
s_waitcnt lgkmcnt(0)
s_sub_u32 s74,s74,s72
s_min_u32 s70,s70,s74
s_memtime s[72:73]
s_waitcnt lgkmcnt(0)
buffer_store_dword v184,v184,s[20:23],s53 offen sc1
s_waitcnt vmcnt(0)
s_memtime s[74:75]
s_waitcnt lgkmcnt(0)
s_sub_u32 s74,s74,s72
s_min_u32 s71,s71,s74
s_cmp_gt_u32 s71,s70
s_cselect_b32 s65,3,2
v_mov_b32 v185,s65
buffer_store_dword v185,v184,s[44:47],32 offen sc1
s_mov_b64 exec,-1
nomeas_38:
v_and_b32 v103,s39,v39
v_lshlrev_b32 v102,16,v39
v_and_b32 v101,s39,v38
v_lshlrev_b32 v100,16,v38
v_and_b32 v99,s39,v37
v_lshlrev_b32 v98,16,v37
v_and_b32 v97,s39,v36
v_lshlrev_b32 v96,16,v36
v_and_b32 v95,s39,v35
v_lshlrev_b32 v94,16,v35
v_and_b32 v93,s39,v34
v_lshlrev_b32 v92,16,v34
v_and_b32 v91,s39,v33
v_lshlrev_b32 v90,16,v33
v_and_b32 v89,s39,v32
v_lshlrev_b32 v88,16,v32
v_and_b32 v87,s39,v31
v_lshlrev_b32 v86,16,v31
v_and_b32 v85,s39,v30
v_lshlrev_b32 v84,16,v30
v_and_b32 v83,s39,v29
v_lshlrev_b32 v82,16,v29
v_and_b32 v81,s39,v28
v_lshlrev_b32 v80,16,v28
v_and_b32 v79,s39,v27
v_lshlrev_b32 v78,16,v27
v_and_b32 v77,s39,v26
v_lshlrev_b32 v76,16,v26
v_and_b32 v75,s39,v25
v_lshlrev_b32 v74,16,v25
v_and_b32 v73,s39,v24
v_lshlrev_b32 v72,16,v24
v_and_b32 v71,s39,v23
v_lshlrev_b32 v70,16,v23
v_and_b32 v69,s39,v22
v_lshlrev_b32 v68,16,v22
v_and_b32 v67,s39,v21
v_lshlrev_b32 v66,16,v21
v_and_b32 v65,s39,v20
v_lshlrev_b32 v64,16,v20
v_and_b32 v63,s39,v19
v_lshlrev_b32 v62,16,v19
v_and_b32 v61,s39,v18
v_lshlrev_b32 v60,16,v18
v_and_b32 v59,s39,v17
v_lshlrev_b32 v58,16,v17
v_and_b32 v57,s39,v16
v_lshlrev_b32 v56,16,v16
v_and_b32 v55,s39,v15
v_lshlrev_b32 v54,16,v15
v_and_b32 v53,s39,v14
v_lshlrev_b32 v52,16,v14
v_and_b32 v51,s39,v13
v_lshlrev_b32 v50,16,v13
v_and_b32 v49,s39,v12
v_lshlrev_b32 v48,16,v12
v_and_b32 v47,s39,v11
v_lshlrev_b32 v46,16,v11
v_and_b32 v45,s39,v10
v_lshlrev_b32 v44,16,v10
v_and_b32 v43,s39,v9
v_lshlrev_b32 v42,16,v9
v_and_b32 v41,s39,v8
v_lshlrev_b32 v40,16,v8
v_pk_add_f32 v[8:9],v[40:41],v[42:43]
v_pk_add_f32 v[10:11],v[44:45],v[46:47]
v_pk_add_f32 v[8:9],v[8:9],v[48:49]
v_pk_add_f32 v[10:11],v[10:11],v[50:51]
v_pk_add_f32 v[8:9],v[8:9],v[52:53]
v_pk_add_f32 v[10:11],v[10:11],v[54:55]
v_pk_add_f32 v[8:9],v[8:9],v[56:57]
v_pk_add_f32 v[10:11],v[10:11],v[58:59]
v_pk_add_f32 v[8:9],v[8:9],v[60:61]
v_pk_add_f32 v[10:11],v[10:11],v[62:63]
v_pk_add_f32 v[8:9],v[8:9],v[64:65]
v_pk_add_f32 v[10:11],v[10:11],v[66:67]
v_pk_add_f32 v[8:9],v[8:9],v[68:69]
v_pk_add_f32 v[10:11],v[10:11],v[70:71]
v_pk_add_f32 v[8:9],v[8:9],v[72:73]
v_pk_add_f32 v[10:11],v[10:11],v[74:75]
v_pk_add_f32 v[8:9],v[8:9],v[76:77]
v_pk_add_f32 v[10:11],v[10:11],v[78:79]
v_pk_add_f32 v[8:9],v[8:9],v[80:81]
v_pk_add_f32 v[10:11],v[10:11],v[82:83]
v_pk_add_f32 v[8:9],v[8:9],v[84:85]
v_pk_add_f32 v[10:11],v[10:11],v[86:87]
v_pk_add_f32 v[8:9],v[8:9],v[88:89]
v_pk_add_f32 v[10:11],v[10:11],v[90:91]
v_pk_add_f32 v[8:9],v[8:9],v[92:93]
v_pk_add_f32 v[10:11],v[10:11],v[94:95]
v_pk_add_f32 v[8:9],v[8:9],v[96:97]
v_pk_add_f32 v[10:11],v[10:11],v[98:99]
v_pk_add_f32 v[8:9],v[8:9],v[100:101]
v_pk_add_f32 v[10:11],v[10:11],v[102:103]
v_pk_add_f32 v[8:9],v[8:9],v[10:11]
v_add_f32 v8,v8,v9
s_nop 1
v_add_f32_dpp v8,v8,v8 row_ror:4 row_mask:0xf bank_mask:0xf
s_nop 1
v_add_f32_dpp v8,v8,v8 row_ror:8 row_mask:0xf bank_mask:0xf
v_mov_b32 v12,v8
s_nop 1
v_permlane16_swap_b32 v12,v8
v_add_f32 v8,v8,v12
v_mov_b32 v12,v8
s_nop 1
v_permlane32_swap_b32 v12,v8
v_add_f32 v8,v8,v12
v_mul_f32 v8,0xba800000,v8
v_pk_add_f32 v[40:41],v[40:41],v[8:9] op_sel_hi:[1,0]
v_pk_add_f32 v[42:43],v[42:43],v[8:9] op_sel_hi:[1,0]
v_pk_add_f32 v[44:45],v[44:45],v[8:9] op_sel_hi:[1,0]
v_pk_add_f32 v[46:47],v[46:47],v[8:9] op_sel_hi:[1,0]
v_pk_add_f32 v[48:49],v[48:49],v[8:9] op_sel_hi:[1,0]
v_pk_add_f32 v[50:51],v[50:51],v[8:9] op_sel_hi:[1,0]
v_pk_add_f32 v[52:53],v[52:53],v[8:9] op_sel_hi:[1,0]
v_pk_add_f32 v[54:55],v[54:55],v[8:9] op_sel_hi:[1,0]
v_pk_add_f32 v[56:57],v[56:57],v[8:9] op_sel_hi:[1,0]
v_pk_add_f32 v[58:59],v[58:59],v[8:9] op_sel_hi:[1,0]
v_pk_add_f32 v[60:61],v[60:61],v[8:9] op_sel_hi:[1,0]
v_pk_add_f32 v[62:63],v[62:63],v[8:9] op_sel_hi:[1,0]
v_pk_add_f32 v[64:65],v[64:65],v[8:9] op_sel_hi:[1,0]
v_pk_add_f32 v[66:67],v[66:67],v[8:9] op_sel_hi:[1,0]
v_pk_add_f32 v[68:69],v[68:69],v[8:9] op_sel_hi:[1,0]
v_pk_add_f32 v[70:71],v[70:71],v[8:9] op_sel_hi:[1,0]
v_pk_add_f32 v[72:73],v[72:73],v[8:9] op_sel_hi:[1,0]
v_pk_add_f32 v[74:75],v[74:75],v[8:9] op_sel_hi:[1,0]
v_pk_add_f32 v[76:77],v[76:77],v[8:9] op_sel_hi:[1,0]
v_pk_add_f32 v[78:79],v[78:79],v[8:9] op_sel_hi:[1,0]
v_pk_add_f32 v[80:81],v[80:81],v[8:9] op_sel_hi:[1,0]
v_pk_add_f32 v[82:83],v[82:83],v[8:9] op_sel_hi:[1,0]
v_pk_add_f32 v[84:85],v[84:85],v[8:9] op_sel_hi:[1,0]
v_pk_add_f32 v[86:87],v[86:87],v[8:9] op_sel_hi:[1,0]
v_pk_add_f32 v[88:89],v[88:89],v[8:9] op_sel_hi:[1,0]
v_pk_add_f32 v[90:91],v[90:91],v[8:9] op_sel_hi:[1,0]
v_pk_add_f32 v[92:93],v[92:93],v[8:9] op_sel_hi:[1,0]
v_pk_add_f32 v[94:95],v[94:95],v[8:9] op_sel_hi:[1,0]
v_pk_add_f32 v[96:97],v[96:97],v[8:9] op_sel_hi:[1,0]
v_pk_add_f32 v[98:99],v[98:99],v[8:9] op_sel_hi:[1,0]
v_pk_add_f32 v[100:101],v[100:101],v[8:9] op_sel_hi:[1,0]
v_pk_add_f32 v[102:103],v[102:103],v[8:9] op_sel_hi:[1,0]
v_pk_mul_f32 v[10:11],v[40:41],v[40:41]
v_pk_mul_f32 v[14:15],v[42:43],v[42:43]
v_pk_fma_f32 v[10:11],v[44:45],v[44:45],v[10:11]
v_pk_fma_f32 v[14:15],v[46:47],v[46:47],v[14:15]
v_pk_fma_f32 v[10:11],v[48:49],v[48:49],v[10:11]
v_pk_fma_f32 v[14:15],v[50:51],v[50:51],v[14:15]
v_pk_fma_f32 v[10:11],v[52:53],v[52:53],v[10:11]
v_pk_fma_f32 v[14:15],v[54:55],v[54:55],v[14:15]
v_pk_fma_f32 v[10:11],v[56:57],v[56:57],v[10:11]
v_pk_fma_f32 v[14:15],v[58:59],v[58:59],v[14:15]
v_pk_fma_f32 v[10:11],v[60:61],v[60:61],v[10:11]
v_pk_fma_f32 v[14:15],v[62:63],v[62:63],v[14:15]
v_pk_fma_f32 v[10:11],v[64:65],v[64:65],v[10:11]
v_pk_fma_f32 v[14:15],v[66:67],v[66:67],v[14:15]
v_pk_fma_f32 v[10:11],v[68:69],v[68:69],v[10:11]
v_pk_fma_f32 v[14:15],v[70:71],v[70:71],v[14:15]
v_pk_fma_f32 v[10:11],v[72:73],v[72:73],v[10:11]
v_pk_fma_f32 v[14:15],v[74:75],v[74:75],v[14:15]
v_pk_fma_f32 v[10:11],v[76:77],v[76:77],v[10:11]
v_pk_fma_f32 v[14:15],v[78:79],v[78:79],v[14:15]
v_pk_fma_f32 v[10:11],v[80:81],v[80:81],v[10:11]
v_pk_fma_f32 v[14:15],v[82:83],v[82:83],v[14:15]
v_pk_fma_f32 v[10:11],v[84:85],v[84:85],v[10:11]
v_pk_fma_f32 v[14:15],v[86:87],v[86:87],v[14:15]
v_pk_fma_f32 v[10:11],v[88:89],v[88:89],v[10:11]
v_pk_fma_f32 v[14:15],v[90:91],v[90:91],v[14:15]
v_pk_fma_f32 v[10:11],v[92:93],v[92:93],v[10:11]
v_pk_fma_f32 v[14:15],v[94:95],v[94:95],v[14:15]
v_pk_fma_f32 v[10:11],v[96:97],v[96:97],v[10:11]
v_pk_fma_f32 v[14:15],v[98:99],v[98:99],v[14:15]
v_pk_fma_f32 v[10:11],v[100:101],v[100:101],v[10:11]
v_pk_fma_f32 v[14:15],v[102:103],v[102:103],v[14:15]
v_pk_add_f32 v[10:11],v[10:11],v[14:15]
v_add_f32 v10,v10,v11
s_nop 1
v_add_f32_dpp v10,v10,v10 row_ror:4 row_mask:0xf bank_mask:0xf
s_nop 1
v_add_f32_dpp v10,v10,v10 row_ror:8 row_mask:0xf bank_mask:0xf
v_mov_b32 v12,v10
s_nop 1
v_permlane16_swap_b32 v12,v10
v_add_f32 v10,v10,v12
v_mov_b32 v12,v10
s_nop 1
v_permlane32_swap_b32 v12,v10
v_add_f32 v10,v10,v12
v_mov_b32 v12,0x3727c5ac
v_fmac_f32 v12,0x3a800000,v10
v_rsq_f32 v10,v12
s_nop 0
v_pk_mul_f32 v[40:41],v[40:41],v[10:11] op_sel_hi:[1,0]
v_pk_mul_f32 v[42:43],v[42:43],v[10:11] op_sel_hi:[1,0]
v_pk_mul_f32 v[44:45],v[44:45],v[10:11] op_sel_hi:[1,0]
v_pk_mul_f32 v[46:47],v[46:47],v[10:11] op_sel_hi:[1,0]
v_pk_mul_f32 v[48:49],v[48:49],v[10:11] op_sel_hi:[1,0]
v_pk_mul_f32 v[50:51],v[50:51],v[10:11] op_sel_hi:[1,0]
v_pk_mul_f32 v[52:53],v[52:53],v[10:11] op_sel_hi:[1,0]
v_pk_mul_f32 v[54:55],v[54:55],v[10:11] op_sel_hi:[1,0]
v_pk_mul_f32 v[56:57],v[56:57],v[10:11] op_sel_hi:[1,0]
v_pk_mul_f32 v[58:59],v[58:59],v[10:11] op_sel_hi:[1,0]
v_pk_mul_f32 v[60:61],v[60:61],v[10:11] op_sel_hi:[1,0]
v_pk_mul_f32 v[62:63],v[62:63],v[10:11] op_sel_hi:[1,0]
v_pk_mul_f32 v[64:65],v[64:65],v[10:11] op_sel_hi:[1,0]
v_pk_mul_f32 v[66:67],v[66:67],v[10:11] op_sel_hi:[1,0]
v_pk_mul_f32 v[68:69],v[68:69],v[10:11] op_sel_hi:[1,0]
v_pk_mul_f32 v[70:71],v[70:71],v[10:11] op_sel_hi:[1,0]
v_pk_mul_f32 v[72:73],v[72:73],v[10:11] op_sel_hi:[1,0]
v_pk_mul_f32 v[74:75],v[74:75],v[10:11] op_sel_hi:[1,0]
v_pk_mul_f32 v[76:77],v[76:77],v[10:11] op_sel_hi:[1,0]
v_pk_mul_f32 v[78:79],v[78:79],v[10:11] op_sel_hi:[1,0]
v_pk_mul_f32 v[80:81],v[80:81],v[10:11] op_sel_hi:[1,0]
v_pk_mul_f32 v[82:83],v[82:83],v[10:11] op_sel_hi:[1,0]
v_pk_mul_f32 v[84:85],v[84:85],v[10:11] op_sel_hi:[1,0]
v_pk_mul_f32 v[86:87],v[86:87],v[10:11] op_sel_hi:[1,0]
v_pk_mul_f32 v[88:89],v[88:89],v[10:11] op_sel_hi:[1,0]
v_pk_mul_f32 v[90:91],v[90:91],v[10:11] op_sel_hi:[1,0]
v_pk_mul_f32 v[92:93],v[92:93],v[10:11] op_sel_hi:[1,0]
v_pk_mul_f32 v[94:95],v[94:95],v[10:11] op_sel_hi:[1,0]
v_pk_mul_f32 v[96:97],v[96:97],v[10:11] op_sel_hi:[1,0]
v_pk_mul_f32 v[98:99],v[98:99],v[10:11] op_sel_hi:[1,0]
v_pk_mul_f32 v[100:101],v[100:101],v[10:11] op_sel_hi:[1,0]
v_pk_mul_f32 v[102:103],v[102:103],v[10:11] op_sel_hi:[1,0]
v_mov_b32 v187,158976
s_cmp_lg_u32 s50,0
s_cbranch_scc1 sh0_39
s_mov_b32 s65,0
s_cmp_eq_u32 s56,1
s_cbranch_scc1 m1s_40
s_lshl_b32 s52,s55,7
s_add_u32 s52,s52,21102592
s_mov_b32 s53,0
m1l_41:
v_mov_b32 v184,0
buffer_load_dword v185,v184,s[20:23],s52 offen sc1
s_waitcnt vmcnt(0)
v_readfirstlane_b32 s64,v185
s_mov_b32 s65,0
s_cmp_eq_u32 s64,1
s_cbranch_scc1 m1ok_42
s_sub_u32 s90,s90,1
s_cmp_lt_i32 s90,0
s_cbranch_scc1 m1ok_42
s_add_u32 s53,s53,1
s_and_b32 s64,s53,31
s_cbranch_scc1 m1l_41
v_and_b32 v184,3,v1
v_bfe_u32 v185,v1,2,1
v_lshlrev_b32 v184,2,v184
v_lshl_add_u32 v184,v185,7,v184
v_writelane_b32 v184,32,8
s_mov_b64 exec,0x1ff
vpoll_43:
buffer_load_dword v185,v184,s[44:47],0 offen sc1
s_waitcnt vmcnt(0)
v_readlane_b32 s92,v185,0
v_readlane_b32 s93,v185,1
v_readlane_b32 s94,v185,2
v_readlane_b32 s95,v185,3
v_readlane_b32 s96,v185,4
v_readlane_b32 s97,v185,5
v_readlane_b32 s98,v185,6
v_readlane_b32 s99,v185,7
v_readlane_b32 s61,v185,8
s_add_u32 s64,s92,s93
s_add_u32 s64,s64,s94
s_add_u32 s64,s64,s95
s_add_u32 s64,s64,s96
s_add_u32 s64,s64,s97
s_add_u32 s64,s64,s98
s_add_u32 s64,s64,s99
s_min_u32 s65,s92,s93
s_min_u32 s66,s94,s95
s_min_u32 s65,s65,s66
s_min_u32 s66,s96,s97
s_min_u32 s65,s65,s66
s_min_u32 s66,s98,s99
s_min_u32 s65,s65,s66
s_cmp_lt_u32 s65,32
s_cselect_b32 s65,1,0
s_cmp_lt_u32 s64,256
s_cbranch_scc1 vslp_45
s_branch vgot_44
vslp_45:
s_sleep 8
s_sub_u32 s90,s90,1
s_cmp_gt_i32 s90,0
s_cbranch_scc1 vpoll_43
vgot_44:
s_mov_b64 exec,-1
s_and_b32 s61,s61,1
s_lshl_b32 s61,s61,13
s_mov_b32 s66,s54
s_cmp_gt_u32 s51,0
s_cselect_b32 s64,s92,0
s_add_u32 s66,s66,s64
s_cmp_gt_u32 s51,1
s_cselect_b32 s64,s93,0
s_add_u32 s66,s66,s64
s_cmp_gt_u32 s51,2
s_cselect_b32 s64,s94,0
s_add_u32 s66,s66,s64
s_cmp_gt_u32 s51,3
s_cselect_b32 s64,s95,0
s_add_u32 s66,s66,s64
s_cmp_gt_u32 s51,4
s_cselect_b32 s64,s96,0
s_add_u32 s66,s66,s64
s_cmp_gt_u32 s51,5
s_cselect_b32 s64,s97,0
s_add_u32 s66,s66,s64
s_cmp_gt_u32 s51,6
s_cselect_b32 s64,s98,0
s_add_u32 s66,s66,s64
s_cmp_eq_u32 s65,0
s_cbranch_scc1 m1l_41
s_branch m1ok_42
m1s_40:
s_mov_b32 s53,256
s_mov_b32 s52,164
v_mov_b32 v184,0
dp_46:
buffer_load_dword v185,v184,s[44:47],s52 offen sc1
s_waitcnt vmcnt(0)
v_cmp_ne_u32 vcc,s53,v185
s_cbranch_vccz dpok_47
s_sleep 8
s_sub_u32 s90,s90,1
s_cmp_gt_i32 s90,0
s_cbranch_scc1 dp_46
dpok_47:
m1ok_42:
v_mov_b32 v184,s65
v_mov_b32 v185,s66
v_mov_b32 v186,s61
ds_write_b96 v187,v[184:186] offset:16
s_waitcnt lgkmcnt(0)
sh0_39:
s_barrier
ds_read_b96 v[184:186],v187 offset:16
s_waitcnt lgkmcnt(0)
v_readfirstlane_b32 s65,v184
v_readfirstlane_b32 s66,v185
v_readfirstlane_b32 s61,v186
s_cmp_lg_u32 s65,0
s_cbranch_scc1 slowrole_10
s_and_b32 s56,s56,1
v_lshlrev_b32 v7,5,v0
s_mov_b32 s40,24576
buffer_load_dwordx4 v[104:107],v7,s[20:23],s40 offen offset:0 sc1
buffer_load_dwordx4 v[108:111],v7,s[20:23],s40 offen offset:16 sc1
s_add_u32 s40,s40,8192
buffer_load_dwordx4 v[112:115],v7,s[20:23],s40 offen offset:0 sc1
buffer_load_dwordx4 v[116:119],v7,s[20:23],s40 offen offset:16 sc1
s_add_u32 s40,s40,8192
buffer_load_dwordx4 v[120:123],v7,s[20:23],s40 offen offset:0 sc1
buffer_load_dwordx4 v[124:127],v7,s[20:23],s40 offen offset:16 sc1
s_add_u32 s40,s40,8192
buffer_load_dwordx4 v[128:131],v7,s[20:23],s40 offen offset:0 sc1
buffer_load_dwordx4 v[132:135],v7,s[20:23],s40 offen offset:16 sc1
v_mov_b32 v14,1.0
v_cmp_lt_u32 vcc,127,v0
s_nop 1
v_cndmask_b32 v14,0,v14,vcc
s_waitcnt vmcnt(0)
v_pk_add_f32 v[104:105],v[104:105],v[112:113]
v_pk_add_f32 v[120:121],v[120:121],v[128:129]
v_pk_add_f32 v[106:107],v[106:107],v[114:115]
v_pk_add_f32 v[122:123],v[122:123],v[130:131]
v_pk_add_f32 v[108:109],v[108:109],v[116:117]
v_pk_add_f32 v[124:125],v[124:125],v[132:133]
v_pk_add_f32 v[110:111],v[110:111],v[118:119]
v_pk_add_f32 v[126:127],v[126:127],v[134:135]
v_pk_add_f32 v[104:105],v[104:105],v[120:121]
v_pk_add_f32 v[106:107],v[106:107],v[122:123]
v_pk_add_f32 v[108:109],v[108:109],v[124:125]
v_pk_add_f32 v[110:111],v[110:111],v[126:127]
v_cvt_pk_bf16_f32 v112,v104,v105
v_cvt_pk_bf16_f32 v113,v106,v107
v_cvt_pk_bf16_f32 v114,v108,v109
v_cvt_pk_bf16_f32 v115,v110,v111
v_lshlrev_b32 v104,16,v112
v_and_b32 v105,s39,v112
v_lshlrev_b32 v106,16,v113
v_and_b32 v107,s39,v113
v_lshlrev_b32 v108,16,v114
v_and_b32 v109,s39,v114
v_lshlrev_b32 v110,16,v115
v_and_b32 v111,s39,v115
v_pk_add_f32 v[104:105],v[104:105],v[14:15] op_sel_hi:[1,0]
v_pk_add_f32 v[106:107],v[106:107],v[14:15] op_sel_hi:[1,0]
v_pk_add_f32 v[108:109],v[108:109],v[14:15] op_sel_hi:[1,0]
v_pk_add_f32 v[110:111],v[110:111],v[14:15] op_sel_hi:[1,0]
ds_write_b128 v7,v[104:107] offset:4096
ds_write_b128 v7,v[108:111] offset:4112
s_waitcnt lgkmcnt(0)
s_barrier
ds_read_b128 v[104:107],v4 offset:8192
ds_read_b128 v[168:171],v4 offset:4096
ds_read_b128 v[108:111],v4 offset:8208
ds_read_b128 v[172:175],v4 offset:4112
ds_read_b128 v[112:115],v4 offset:8224
ds_read_b128 v[176:179],v4 offset:4128
ds_read_b128 v[116:119],v4 offset:8240
ds_read_b128 v[180:183],v4 offset:4144
ds_read_b128 v[120:123],v4 offset:9216
ds_read_b128 v[184:187],v4 offset:5120
ds_read_b128 v[124:127],v4 offset:9232
ds_read_b128 v[188:191],v4 offset:5136
ds_read_b128 v[128:131],v4 offset:9248
ds_read_b128 v[192:195],v4 offset:5152
ds_read_b128 v[132:135],v4 offset:9264
ds_read_b128 v[196:199],v4 offset:5168
ds_read_b128 v[136:139],v4 offset:10240
ds_read_b128 v[200:203],v4 offset:6144
ds_read_b128 v[140:143],v4 offset:10256
ds_read_b128 v[204:207],v4 offset:6160
ds_read_b128 v[144:147],v4 offset:10272
ds_read_b128 v[208:211],v4 offset:6176
ds_read_b128 v[148:151],v4 offset:10288
ds_read_b128 v[212:215],v4 offset:6192
ds_read_b128 v[152:155],v4 offset:11264
ds_read_b128 v[216:219],v4 offset:7168
ds_read_b128 v[156:159],v4 offset:11280
ds_read_b128 v[220:223],v4 offset:7184
ds_read_b128 v[160:163],v4 offset:11296
ds_read_b128 v[224:227],v4 offset:7200
ds_read_b128 v[164:167],v4 offset:11312
ds_read_b128 v[228:231],v4 offset:7216
s_waitcnt lgkmcnt(15)
v_pk_fma_f32 v[40:41],v[40:41],v[104:105],v[168:169]
v_pk_fma_f32 v[42:43],v[42:43],v[106:107],v[170:171]
v_pk_fma_f32 v[44:45],v[44:45],v[108:109],v[172:173]
v_pk_fma_f32 v[46:47],v[46:47],v[110:111],v[174:175]
v_pk_fma_f32 v[48:49],v[48:49],v[112:113],v[176:177]
v_pk_fma_f32 v[50:51],v[50:51],v[114:115],v[178:179]
v_pk_fma_f32 v[52:53],v[52:53],v[116:117],v[180:181]
v_pk_fma_f32 v[54:55],v[54:55],v[118:119],v[182:183]
v_cvt_pk_bf16_f32 v16,v40,v41
v_cvt_pk_bf16_f32 v17,v48,v49
v_cvt_pk_bf16_f32 v18,v42,v43
v_cvt_pk_bf16_f32 v19,v50,v51
buffer_store_dwordx4 v[16:19],v6,s[20:23],s37 offen offset:0 sc1
v_cvt_pk_bf16_f32 v20,v44,v45
v_cvt_pk_bf16_f32 v21,v52,v53
v_cvt_pk_bf16_f32 v22,v46,v47
v_cvt_pk_bf16_f32 v23,v54,v55
buffer_store_dwordx4 v[20:23],v6,s[20:23],s37 offen offset:256 sc1
s_waitcnt lgkmcnt(15)
v_pk_fma_f32 v[56:57],v[56:57],v[120:121],v[184:185]
v_pk_fma_f32 v[58:59],v[58:59],v[122:123],v[186:187]
v_pk_fma_f32 v[60:61],v[60:61],v[124:125],v[188:189]
v_pk_fma_f32 v[62:63],v[62:63],v[126:127],v[190:191]
v_pk_fma_f32 v[64:65],v[64:65],v[128:129],v[192:193]
v_pk_fma_f32 v[66:67],v[66:67],v[130:131],v[194:195]
v_pk_fma_f32 v[68:69],v[68:69],v[132:133],v[196:197]
v_pk_fma_f32 v[70:71],v[70:71],v[134:135],v[198:199]
v_cvt_pk_bf16_f32 v24,v56,v57
v_cvt_pk_bf16_f32 v25,v64,v65
v_cvt_pk_bf16_f32 v26,v58,v59
v_cvt_pk_bf16_f32 v27,v66,v67
s_add_u32 s37,s37,16384
buffer_store_dwordx4 v[24:27],v6,s[20:23],s37 offen offset:0 sc1
v_cvt_pk_bf16_f32 v28,v60,v61
v_cvt_pk_bf16_f32 v29,v68,v69
v_cvt_pk_bf16_f32 v30,v62,v63
v_cvt_pk_bf16_f32 v31,v70,v71
buffer_store_dwordx4 v[28:31],v6,s[20:23],s37 offen offset:256 sc1
s_waitcnt lgkmcnt(8)
v_pk_fma_f32 v[72:73],v[72:73],v[136:137],v[200:201]
v_pk_fma_f32 v[74:75],v[74:75],v[138:139],v[202:203]
v_pk_fma_f32 v[76:77],v[76:77],v[140:141],v[204:205]
v_pk_fma_f32 v[78:79],v[78:79],v[142:143],v[206:207]
v_pk_fma_f32 v[80:81],v[80:81],v[144:145],v[208:209]
v_pk_fma_f32 v[82:83],v[82:83],v[146:147],v[210:211]
v_pk_fma_f32 v[84:85],v[84:85],v[148:149],v[212:213]
v_pk_fma_f32 v[86:87],v[86:87],v[150:151],v[214:215]
v_cvt_pk_bf16_f32 v16,v72,v73
v_cvt_pk_bf16_f32 v17,v80,v81
v_cvt_pk_bf16_f32 v18,v74,v75
v_cvt_pk_bf16_f32 v19,v82,v83
s_add_u32 s37,s37,16384
buffer_store_dwordx4 v[16:19],v6,s[20:23],s37 offen offset:0 sc1
v_cvt_pk_bf16_f32 v20,v76,v77
v_cvt_pk_bf16_f32 v21,v84,v85
v_cvt_pk_bf16_f32 v22,v78,v79
v_cvt_pk_bf16_f32 v23,v86,v87
buffer_store_dwordx4 v[20:23],v6,s[20:23],s37 offen offset:256 sc1
s_waitcnt lgkmcnt(0)
v_pk_fma_f32 v[88:89],v[88:89],v[152:153],v[216:217]
v_pk_fma_f32 v[90:91],v[90:91],v[154:155],v[218:219]
v_pk_fma_f32 v[92:93],v[92:93],v[156:157],v[220:221]
v_pk_fma_f32 v[94:95],v[94:95],v[158:159],v[222:223]
v_pk_fma_f32 v[96:97],v[96:97],v[160:161],v[224:225]
v_pk_fma_f32 v[98:99],v[98:99],v[162:163],v[226:227]
v_pk_fma_f32 v[100:101],v[100:101],v[164:165],v[228:229]
v_pk_fma_f32 v[102:103],v[102:103],v[166:167],v[230:231]
v_cvt_pk_bf16_f32 v24,v88,v89
v_cvt_pk_bf16_f32 v25,v96,v97
v_cvt_pk_bf16_f32 v26,v90,v91
v_cvt_pk_bf16_f32 v27,v98,v99
s_add_u32 s37,s37,16384
buffer_store_dwordx4 v[24:27],v6,s[20:23],s37 offen offset:0 sc1
v_cvt_pk_bf16_f32 v28,v92,v93
v_cvt_pk_bf16_f32 v29,v100,v101
v_cvt_pk_bf16_f32 v30,v94,v95
v_cvt_pk_bf16_f32 v31,v102,v103
buffer_store_dwordx4 v[28:31],v6,s[20:23],s37 offen offset:256 sc1
s_waitcnt vmcnt(0)
s_barrier
v_mov_b32 v187,158976
s_cmp_lg_u32 s50,0
s_cbranch_scc1 sh0_48
s_cmp_ge_u32 s55,16
s_cbranch_scc1 nodln_49
s_and_b32 s64,s56,1
s_lshl_b32 s64,s64,2
s_add_u32 s64,s64,36
s_mov_b64 exec,1
v_mov_b32 v184,1
v_mov_b32 v185,0
buffer_atomic_add v184,v185,s[44:47],s64 offen sc0 sc1
s_mov_b64 exec,-1
s_waitcnt vmcnt(0)
v_readfirstlane_b32 s64,v184
s_cmp_lg_u32 s64,143
s_cbranch_scc1 narr_51
s_mov_b32 s65,0
s_cmp_eq_u32 s56,1
s_cbranch_scc1 nopar_52
v_mov_b32 v184,0
dp_53:
buffer_load_dword v185,v184,s[44:47],32 offen sc1
s_waitcnt vmcnt(0)
v_cmp_eq_u32 vcc,0,v185
s_cbranch_vccz dpok_54
s_sleep 4
s_sub_u32 s90,s90,1
s_cmp_gt_i32 s90,0
s_cbranch_scc1 dp_53
dpok_54:
v_readfirstlane_b32 s65,v185
s_and_b32 s65,s65,1
s_lshl_b32 s61,s65,13
nopar_52:
s_add_u32 s65,s65,2
v_lshlrev_b32 v184,7,v1
v_mov_b32 v185,s65
s_mov_b32 s64,21168128
s_mov_b32 s65,21176320
buffer_store_dword v185,v184,s[20:23],s64 offen sc1
buffer_store_dword v185,v184,s[20:23],s65 offen sc1
narr_51:
nodln_49:
s_mov_b32 s61,0
s_cmp_eq_u32 s56,1
s_cbranch_scc1 nopar_50
v_mov_b32 v184,0
dp_55:
buffer_load_dword v185,v184,s[44:47],32 offen sc1
s_waitcnt vmcnt(0)
v_cmp_eq_u32 vcc,0,v185
s_cbranch_vccz dpok_56
s_sleep 4
s_sub_u32 s90,s90,1
s_cmp_gt_i32 s90,0
s_cbranch_scc1 dp_55
dpok_56:
v_readfirstlane_b32 s65,v185
s_and_b32 s65,s65,1
s_lshl_b32 s61,s65,13
nopar_50:
v_mov_b32 v184,s65
v_mov_b32 v185,s66
v_mov_b32 v186,s61
ds_write_b96 v187,v[184:186] offset:16
s_waitcnt lgkmcnt(0)
sh0_48:
s_barrier
ds_read_b96 v[184:186],v187 offset:16
s_waitcnt lgkmcnt(0)
v_readfirstlane_b32 s65,v184
v_readfirstlane_b32 s66,v185
v_readfirstlane_b32 s61,v186
s_sub_u32 s55,s57,128
s_cmp_lg_u32 s50,0
s_cbranch_scc1 nsig_57
s_lshr_b32 s95,s55,4
s_lshl_b32 s95,s95,6
s_add_u32 s95,s95,21052416
s_mov_b64 exec,1
v_mov_b32 v184,112
v_mov_b32 v185,0
buffer_atomic_add v184,v185,s[20:23],s95 offen sc1
s_mov_b64 exec,-1
nsig_57:
s_branch pipe_worker
loops_7:
s_lshl_b32 s64,s50,14
s_add_u32 m0,s64,0
s_add_u32 s65,s64,57344
buffer_load_dwordx4 v16,s[20:23],s65 offen offset:0 lds
buffer_load_dwordx4 v16,s[20:23],s65 offen offset:1024 lds
buffer_load_dwordx4 v16,s[20:23],s65 offen offset:2048 lds
buffer_load_dwordx4 v16,s[20:23],s65 offen offset:3072 lds
s_add_u32 m0,s64,4096
s_add_u32 s65,s64,61440
buffer_load_dwordx4 v16,s[20:23],s65 offen offset:0 lds
buffer_load_dwordx4 v16,s[20:23],s65 offen offset:1024 lds
buffer_load_dwordx4 v16,s[20:23],s65 offen offset:2048 lds
buffer_load_dwordx4 v16,s[20:23],s65 offen offset:3072 lds
s_add_u32 m0,s64,8192
s_add_u32 s65,s64,65536
buffer_load_dwordx4 v16,s[20:23],s65 offen offset:0 lds
buffer_load_dwordx4 v16,s[20:23],s65 offen offset:1024 lds
buffer_load_dwordx4 v16,s[20:23],s65 offen offset:2048 lds
buffer_load_dwordx4 v16,s[20:23],s65 offen offset:3072 lds
s_add_u32 m0,s64,12288
s_add_u32 s65,s64,69632
buffer_load_dwordx4 v16,s[20:23],s65 offen offset:0 lds
buffer_load_dwordx4 v16,s[20:23],s65 offen offset:1024 lds
buffer_load_dwordx4 v16,s[20:23],s65 offen offset:2048 lds
buffer_load_dwordx4 v16,s[20:23],s65 offen offset:3072 lds
s_mov_b64 s[24:25],s[20:21]
s_mov_b64 s[28:29],s[20:21]
s_mov_b32 s27,0x20000
s_mov_b32 s31,0x20000
s_cmp_eq_u32 s56,0
s_cselect_b32 s26,s22,0
s_cselect_b32 s30,0,s22
s_lshl_b32 s64,s58,14
s_add_u32 s64,s64,23068672
v_add_u32 v26,s64,v16
v_add_u32 v27,4096,v26
v_add_u32 v28,8192,v26
v_add_u32 v29,12288,v26
s_lshl_b32 s65,s59,9
s_add_u32 s66,s64,s65
s_lshl_b32 s64,s58,7
s_add_u32 s64,s64,23592960
v_and_b32 v18,31,v1
v_lshl_add_u32 v18,v18,2,s64
s_lshl_b32 s65,s59,2
s_add_u32 s64,s64,s65
v_mov_b32 v13,s64
v_mov_b32 v14,0x4444
v_mov_b32 v22,0xeeee
v_cmp_lt_u32 vcc,7,v3
s_nop 1
v_cndmask_b32 v14,v14,v22,vcc
v_and_b32 v22,1,v3
v_cmp_eq_u32 vcc,0,v22
v_mov_b32 v15,0x03020706
v_mov_b32 v23,0x05040100
v_cndmask_b32 v15,v15,v23,vcc
v_lshlrev_b32 v19,5,v22
v_lshl_add_u32 v19,v4,6,v19
v_lshrrev_b32 v23,1,v3
v_lshl_add_u32 v19,v23,2,v19
s_lshl_b32 s67,s57,10
s_add_u32 s67,s67,23199744
s_lshl_b32 s64,s50,2
s_lshr_b32 s64,0x1320,s64
s_and_b32 s64,s64,3
s_lshl_b32 s64,s64,8
s_add_u32 s64,s64,s67
v_add_u32 v19,s64,v19
v_add_u32 v24,131072,v16
v_mov_b32 v21,158720
v_mov_b32 v25,0
v_mov_b32 v20,v16
v_and_b32 v22,1,v4
v_lshrrev_b32 v23,1,v4
v_lshl_add_u32 v23,v23,4,v3
v_lshlrev_b32 v23,4,v23
v_lshl_add_u32 v23,v22,10,v23
s_lshr_b32 s64,s50,1
s_lshl_b32 s64,s64,9
v_add_u32 v23,s64,v23
s_lshr_b32 s64,s57,2
s_add_u32 s65,s64,32
s_lshl_b32 s65,s65,14
s_and_b32 s68,s57,3
s_lshl_b32 s68,s68,11
s_add_u32 s65,s65,s68
s_add_u32 s65,s65,29360128
v_add_u32 v17,s65,v23
s_lshl_b32 s69,s57,11
s_add_u32 s69,s69,23330816
v_add_u32 v2,s69,v23
s_mov_b32 s81,0x3e0293ee
s_mov_b32 s84,0xff00ff
s_mov_b32 s85,0xff00ff
s_mov_b32 s86,0x33333333
s_mov_b32 s87,0x33333333
s_mov_b32 s62,0x10000
s_mov_b32 s79,-2
ds_write_b32 v21,v25
ds_write_b32 v21,v25 offset:4
ds_write_b32 v21,v25 offset:8
ds_write_b32 v21,v25 offset:12
ds_write_b32 v21,v25 offset:16
v_mov_b32 v100,0
v_mov_b32 v101,0
v_mov_b32 v102,0
v_mov_b32 v103,0
s_lshr_b32 s64,s59,3
s_lshl_b32 s64,s64,14
s_and_b32 s65,s59,7
s_lshl_b32 s65,s65,10
s_add_u32 s64,s64,s65
s_lshl_b32 s65,s58,16
s_add_u32 s64,s64,s65
s_add_u32 s64,s64,31195136
v_add_u32 v8,s64,v16
s_cmp_eq_u32 s50,3
s_cbranch_scc1 w3_62
s_cmp_eq_u32 s50,1
s_cbranch_scc1 w1_60
s_cmp_eq_u32 s50,2
s_cbranch_scc1 w2_61
w0_59:
v_and_b32 v22,7,v3
v_lshrrev_b32 v23,2,v22
v_and_b32 v5,2,v22
v_or_b32 v23,v23,v5
v_and_b32 v5,1,v22
v_lshl_add_u32 v23,v23,1,v5
v_lshlrev_b32 v23,5,v23
v_lshrrev_b32 v5,3,v3
v_lshl_add_u32 v23,v5,9,v23
v_lshrrev_b32 v5,1,v4
v_lshl_add_u32 v23,v5,8,v23
v_and_b32 v5,1,v4
v_lshl_add_u32 v23,v5,4,v23
v_add_u32 v8,s67,v23
v_xor_b32 v9,1024,v8
v_xor_b32 v10,2048,v8
v_xor_b32 v11,3072,v8
v_lshlrev_b32 v31,4,v3
v_lshl_add_u32 v31,v5,3,v31
v_add_u32 v31,155648,v31
v_lshl_add_u32 v23,v4,3,v22
v_lshlrev_b32 v23,4,v23
v_add_u32 v12,155648,v23
v_add_u32 v30,s66,v23
v_cmp_gt_u32 vcc,8,v3
v_cmp_lt_u32 s[52:53],1,v4
s_and_b64 vcc,vcc,s[52:53]
v_mov_b32 v22,0xf149f2ca
v_cndmask_b32 v156,v22,0,vcc
v_mov_b32 v157,v156
v_mov_b32 v158,v156
v_mov_b32 v159,v156
v_add_u32 v2,s69,v16
v_xor_b32 v5,2048,v2
v_xor_b32 v6,4096,v2
v_xor_b32 v7,6144,v2
s_lshr_b32 s64,s57,3
s_add_u32 s64,s64,96
s_lshl_b32 s64,s64,14
s_and_b32 s65,s57,7
s_lshl_b32 s65,s65,10
s_add_u32 s64,s64,s65
s_add_u32 s64,s64,29360128
v_add_u32 v3,s64,v16
v_mov_b32 v136,0
v_mov_b32 v137,0
v_mov_b32 v138,0
v_mov_b32 v139,0
v_mov_b32 v140,0
v_mov_b32 v141,0
v_mov_b32 v142,0
v_mov_b32 v143,0
v_mov_b32 v144,0
v_mov_b32 v145,0
v_mov_b32 v146,0
v_mov_b32 v147,0
v_mov_b32 v152,0x3f803f80
v_mov_b32 v153,0x3f803f80
v_mov_b32 v154,0x3f803f80
v_mov_b32 v155,0x3f803f80
s_branch first_63
loop_64:
s_barrier
buffer_load_dword v248,v18,s[20:23],s70 offen offset:0 sc1
s_nop 15
s_nop 5
hl_66:
buffer_load_dword v249,v18,s[20:23],s70 offen offset:0 sc1
s_waitcnt vmcnt(1)
v_cmp_eq_u32 vcc,v25,v248
s_bcnt1_i32_b32 s64,vcc_lo
s_cmp_ge_u32 s64,8
s_cbranch_scc1 hg_67
buffer_load_dword v248,v18,s[20:23],s70 offen offset:0 sc1
s_waitcnt vmcnt(1)
v_cmp_eq_u32 vcc,v25,v249
s_bcnt1_i32_b32 s64,vcc_lo
s_cmp_ge_u32 s64,8
s_cbranch_scc1 hg_67
s_sub_u32 s90,s90,1
s_cmp_gt_i32 s90,0
s_cbranch_scc1 hl_66
hg_67:
buffer_load_dwordx4 v[32:35],v26,s[20:23],s70 offen offset:0 sc1
buffer_load_dwordx4 v[36:39],v26,s[20:23],s70 offen offset:1024 sc1
buffer_load_dwordx4 v[40:43],v26,s[20:23],s70 offen offset:2048 sc1
buffer_load_dwordx4 v[44:47],v26,s[20:23],s70 offen offset:3072 sc1
s_waitcnt vmcnt(3)
ds_write_b128 v24,v[32:35] offset:0
v_min3_u32 v22,v32,v33,v34
v_min_u32 v22,v22,v35
s_waitcnt vmcnt(2)
ds_write_b128 v24,v[36:39] offset:1024
v_min3_u32 v22,v22,v36,v37
v_min3_u32 v22,v22,v38,v39
s_waitcnt vmcnt(1)
ds_write_b128 v24,v[40:43] offset:2048
v_min3_u32 v22,v22,v40,v41
v_min3_u32 v22,v22,v42,v43
s_waitcnt vmcnt(0)
ds_write_b128 v24,v[44:47] offset:3072
v_min3_u32 v22,v22,v44,v45
v_min3_u32 v22,v22,v46,v47
v_cmp_eq_u32 vcc,0,v22
s_cbranch_vccnz art_68
abk_69:
v_smfmac_f32_16x16x64_bf16 v[176:179],v[32:35],a[0:7],v14
s_waitcnt lgkmcnt(0)
s_barrier
ds_read_b128 v[48:51],v24 offset:4096
ds_read_b128 v[52:55],v24 offset:5120
ds_read_b128 v[56:59],v24 offset:6144
ds_read_b128 v[60:63],v24 offset:7168
v_smfmac_f32_16x16x64_bf16 v[176:179],v[36:39],a[8:15],v14
ds_read_b128 v[64:67],v24 offset:8192
ds_read_b128 v[68:71],v24 offset:9216
v_smfmac_f32_16x16x64_bf16 v[176:179],v[40:43],a[16:23],v14
ds_read_b128 v[72:75],v24 offset:10240
ds_read_b128 v[76:79],v24 offset:11264
v_smfmac_f32_16x16x64_bf16 v[176:179],v[44:47],a[24:31],v14
ds_read_b128 v[80:83],v24 offset:12288
ds_read_b128 v[84:87],v24 offset:13312
s_waitcnt lgkmcnt(9)
v_smfmac_f32_16x16x64_bf16 v[176:179],v[48:51],a[32:39],v14
ds_read_b128 v[88:91],v24 offset:14336
s_waitcnt lgkmcnt(9)
v_smfmac_f32_16x16x64_bf16 v[176:179],v[52:55],a[40:47],v14
ds_read_b128 v[92:95],v24 offset:15360
s_waitcnt lgkmcnt(9)
v_smfmac_f32_16x16x64_bf16 v[176:179],v[56:59],a[48:55],v14
s_waitcnt lgkmcnt(8)
v_smfmac_f32_16x16x64_bf16 v[176:179],v[60:63],a[56:63],v14
s_waitcnt lgkmcnt(7)
v_smfmac_f32_16x16x64_bf16 v[176:179],v[64:67],a[64:71],v14
s_waitcnt lgkmcnt(6)
v_smfmac_f32_16x16x64_bf16 v[176:179],v[68:71],a[72:79],v14
s_waitcnt lgkmcnt(5)
v_smfmac_f32_16x16x64_bf16 v[176:179],v[72:75],a[80:87],v14
s_waitcnt lgkmcnt(4)
v_smfmac_f32_16x16x64_bf16 v[176:179],v[76:79],a[88:95],v14
s_waitcnt lgkmcnt(3)
v_smfmac_f32_16x16x64_bf16 v[176:179],v[80:83],a[96:103],v14
s_waitcnt lgkmcnt(2)
v_smfmac_f32_16x16x64_bf16 v[176:179],v[84:87],a[104:111],v14
s_waitcnt lgkmcnt(1)
v_smfmac_f32_16x16x64_bf16 v[176:179],v[88:91],a[112:119],v14
s_waitcnt lgkmcnt(0)
v_smfmac_f32_16x16x64_bf16 v[176:179],v[92:95],a[120:127],v14
s_nop 7
v_permlane32_swap_b32 v176,v178
v_permlane32_swap_b32 v177,v179
v_add_f32 v176,v176,v178
v_add_f32 v177,v177,v179
v_cvt_pk_bf16_f32 v216,v176,v177
s_nop 1
v_mov_b32_dpp v217,v216 quad_perm:[1,0,3,2] row_mask:0xf bank_mask:0xf
v_perm_b32 v216,v217,v216,v15
v_max_u32 v216,1,v216
buffer_store_dword v216,v19,s[24:27],s70 offen
buffer_store_dword v216,v19,s[28:31],s70 offen sc1
s_lshr_b32 s64,s70,9
v_add_u32 v22,s64,v24
s_cmp_eq_u32 s79,0
ds_read_b128 v[128:131],v22 offset:16384
ds_read_b128 v[132:135],v22 offset:17408
s_cbranch_scc1 kt0_70
kt0b_71:
s_nop 15
s_nop 15
s_nop 11
buffer_load_dwordx4 v[32:35],v8,s[20:23],s70 offen sc1
buffer_load_dwordx4 v[36:39],v9,s[20:23],s70 offen sc1
buffer_load_dwordx4 v[40:43],v10,s[20:23],s70 offen sc1
buffer_load_dwordx4 v[44:47],v11,s[20:23],s70 offen sc1
s_nop 9
scp_72:
buffer_load_dwordx4 v[48:51],v8,s[20:23],s70 offen sc1
buffer_load_dwordx4 v[52:55],v9,s[20:23],s70 offen sc1
buffer_load_dwordx4 v[56:59],v10,s[20:23],s70 offen sc1
buffer_load_dwordx4 v[60:63],v11,s[20:23],s70 offen sc1
s_waitcnt vmcnt(4)
v_mfma_f32_16x16x32_bf16 v[168:171],v[32:35],v[32:35],v[156:159]
v_min3_u32 v22,v32,v33,v34
v_min3_u32 v22,v22,v35,v36
v_mfma_f32_16x16x32_bf16 v[164:167],v[100:103],v[32:35],0
v_min3_u32 v22,v22,v37,v38
v_min3_u32 v22,v22,v39,v40
v_mfma_f32_16x16x32_bf16 v[160:163],v[96:99],v[32:35],0
v_min3_u32 v22,v22,v41,v42
v_min3_u32 v22,v22,v43,v44
v_mfma_f32_16x16x32_bf16 v[168:171],v[36:39],v[36:39],v[168:171]
v_min3_u32 v22,v22,v45,v46
v_min_u32 v22,v22,v47
v_mfma_f32_16x16x32_bf16 v[164:167],v[108:111],v[36:39],v[164:167]
v_cmp_eq_u32 vcc,0,v22
s_cbranch_vccnz nx_74
v_mfma_f32_16x16x32_bf16 v[160:163],v[104:107],v[36:39],v[160:163]
v_mov_b32 v172,v32
v_mfma_f32_16x16x32_bf16 v[168:171],v[40:43],v[40:43],v[168:171]
v_mov_b32 v173,v33
v_mfma_f32_16x16x32_bf16 v[164:167],v[116:119],v[40:43],v[164:167]
v_mov_b32 v174,v34
v_mfma_f32_16x16x32_bf16 v[160:163],v[112:115],v[40:43],v[160:163]
v_mov_b32 v175,v35
v_mfma_f32_16x16x32_bf16 v[168:171],v[44:47],v[44:47],v[168:171]
v_mfma_f32_16x16x32_bf16 v[164:167],v[124:127],v[44:47],v[164:167]
v_mfma_f32_16x16x32_bf16 v[160:163],v[120:123],v[44:47],v[160:163]
s_nop 1
s_branch scok_73
nx_74:
buffer_load_dwordx4 v[32:35],v8,s[20:23],s70 offen sc1
buffer_load_dwordx4 v[36:39],v9,s[20:23],s70 offen sc1
buffer_load_dwordx4 v[40:43],v10,s[20:23],s70 offen sc1
buffer_load_dwordx4 v[44:47],v11,s[20:23],s70 offen sc1
s_waitcnt vmcnt(4)
v_mfma_f32_16x16x32_bf16 v[168:171],v[48:51],v[48:51],v[156:159]
v_min3_u32 v22,v48,v49,v50
v_min3_u32 v22,v22,v51,v52
v_mfma_f32_16x16x32_bf16 v[164:167],v[100:103],v[48:51],0
v_min3_u32 v22,v22,v53,v54
v_min3_u32 v22,v22,v55,v56
v_mfma_f32_16x16x32_bf16 v[160:163],v[96:99],v[48:51],0
v_min3_u32 v22,v22,v57,v58
v_min3_u32 v22,v22,v59,v60
v_mfma_f32_16x16x32_bf16 v[168:171],v[52:55],v[52:55],v[168:171]
v_min3_u32 v22,v22,v61,v62
v_min_u32 v22,v22,v63
v_mfma_f32_16x16x32_bf16 v[164:167],v[108:111],v[52:55],v[164:167]
v_cmp_eq_u32 vcc,0,v22
s_cbranch_vccnz nx_75
v_mfma_f32_16x16x32_bf16 v[160:163],v[104:107],v[52:55],v[160:163]
v_mov_b32 v172,v48
v_mfma_f32_16x16x32_bf16 v[168:171],v[56:59],v[56:59],v[168:171]
v_mov_b32 v173,v49
v_mfma_f32_16x16x32_bf16 v[164:167],v[116:119],v[56:59],v[164:167]
v_mov_b32 v174,v50
v_mfma_f32_16x16x32_bf16 v[160:163],v[112:115],v[56:59],v[160:163]
v_mov_b32 v175,v51
v_mfma_f32_16x16x32_bf16 v[168:171],v[60:63],v[60:63],v[168:171]
v_mfma_f32_16x16x32_bf16 v[164:167],v[124:127],v[60:63],v[164:167]
v_mfma_f32_16x16x32_bf16 v[160:163],v[120:123],v[60:63],v[160:163]
s_nop 1
s_branch scok_73
nx_75:
s_sub_u32 s90,s90,1
s_cmp_gt_i32 s90,0
s_cbranch_scc1 scp_72
s_nop 7
scok_73:
ds_read_b64 v[220:221],v21
ds_read_b64 v[136:137],v31
ds_read_b64 v[140:141],v31 offset:256
s_cmp_eq_u32 s79,63
s_cbranch_scc1 last0_76
v_max3_f32 v216,v168,v169,v170
v_mov_b32_dpp v160,v164 row_ror:8 row_mask:0xf bank_mask:0xc
v_mov_b32_dpp v161,v165 row_ror:8 row_mask:0xf bank_mask:0xc
v_mov_b32_dpp v162,v166 row_ror:8 row_mask:0xf bank_mask:0xc
v_mov_b32_dpp v163,v167 row_ror:8 row_mask:0xf bank_mask:0xc
v_max3_f32 v217,v171,v160,v161
v_max3_f32 v216,v216,v162,v163
v_max_f32 v216,v216,v217
s_nop 1
v_max_f32_dpp v216,v216,v216 row_ror:8 row_mask:0xf bank_mask:0xf
v_mov_b32 v217,v216
s_nop 1
v_permlane16_swap_b32 v217,v216
v_max_f32 v216,v216,v217
v_mov_b32 v217,v216
s_nop 1
v_permlane32_swap_b32 v217,v216
v_max_f32 v216,v216,v217
v_mul_f32 v216,s81,v216
v_fma_f32 v160,v160,s81,-v216
v_fma_f32 v161,v161,s81,-v216
v_fma_f32 v162,v162,s81,-v216
v_fma_f32 v163,v163,s81,-v216
v_fma_f32 v168,v168,s81,-v216
v_fma_f32 v169,v169,s81,-v216
v_fma_f32 v170,v170,s81,-v216
v_fma_f32 v171,v171,s81,-v216
v_exp_f32 v160,v160
v_exp_f32 v161,v161
v_exp_f32 v162,v162
v_exp_f32 v163,v163
v_exp_f32 v168,v168
v_exp_f32 v169,v169
v_exp_f32 v170,v170
v_exp_f32 v171,v171
v_cvt_pk_bf16_f32 v148,v160,v161
v_cvt_pk_bf16_f32 v149,v162,v163
v_cvt_pk_bf16_f32 v144,v168,v169
v_mov_b32_dpp v150,v148 row_ror:8 row_mask:0xf bank_mask:0xf
v_mov_b32_dpp v151,v149 row_ror:8 row_mask:0xf bank_mask:0xf
v_cvt_pk_bf16_f32 v145,v170,v171
s_waitcnt lgkmcnt(0)
v_min_u32 v220,v220,v221
v_mfma_f32_16x16x32_bf16 v[232:235],v[152:155],v[148:151],0
v_cmp_ne_u32 vcc,v220,v25
v_mfma_f32_16x16x32_bf16 v[232:235],v[152:155],v[144:147],v[232:235]
v_mfma_f32_16x16x32_bf16 v[224:227],v[128:131],v[148:151],0
v_mfma_f32_16x16x32_bf16 v[228:231],v[132:135],v[148:151],0
s_cbranch_vccnz vw_77
vb_78:
v_mfma_f32_16x16x32_bf16 v[224:227],v[136:139],v[144:147],v[224:227]
v_mfma_f32_16x16x32_bf16 v[228:231],v[140:143],v[144:147],v[228:231]
s_mov_b64 exec,s[84:85]
s_nop 1
v_rcp_f32 v236,v232
s_nop 2
v_pk_mul_f32 v[224:225],v[224:225],v[236:237] op_sel_hi:[1,0]
v_pk_mul_f32 v[226:227],v[226:227],v[236:237] op_sel_hi:[1,0]
v_pk_mul_f32 v[228:229],v[228:229],v[236:237] op_sel_hi:[1,0]
v_pk_mul_f32 v[230:231],v[230:231],v[236:237] op_sel_hi:[1,0]
v_cvt_pk_bf16_f32 v216,v224,v225
v_cvt_pk_bf16_f32 v217,v226,v227
v_cvt_pk_bf16_f32 v218,v228,v229
v_cvt_pk_bf16_f32 v219,v230,v231
v_max_u32 v216,1,v216
v_max_u32 v217,1,v217
v_max_u32 v218,1,v218
v_max_u32 v219,1,v219
buffer_store_dwordx4 v[216:219],v30,s[24:27],s71 offen
buffer_store_dwordx4 v[216:219],v30,s[28:31],s71 offen sc1
s_mov_b64 exec,1
buffer_store_dword v25,v13,s[24:27],s70 offen offset:512
buffer_store_dword v25,v13,s[28:31],s70 offen offset:512 sc1
s_mov_b64 exec,-1
ds_write_b32 v21,v25 offset:8
hl_79:
buffer_load_dword v248,v18,s[20:23],s70 offen offset:512 sc1
s_waitcnt vmcnt(0)
v_cmp_eq_u32 vcc,v25,v248
s_bcnt1_i32_b32 s64,vcc_lo
s_cmp_ge_u32 s64,16
s_cbranch_scc1 hg_80
s_sub_u32 s90,s90,1
s_cmp_gt_i32 s90,0
s_cbranch_scc1 hl_79
hg_80:
buffer_load_dwordx4 v[32:35],v26,s[20:23],s71 offen offset:0 sc1
buffer_load_dwordx4 v[36:39],v26,s[20:23],s71 offen offset:1024 sc1
buffer_load_dwordx4 v[40:43],v26,s[20:23],s71 offen offset:2048 sc1
buffer_load_dwordx4 v[44:47],v26,s[20:23],s71 offen offset:3072 sc1
buffer_load_dwordx4 v[48:51],v27,s[20:23],s71 offen offset:0 sc1
buffer_load_dwordx4 v[52:55],v27,s[20:23],s71 offen offset:1024 sc1
buffer_load_dwordx4 v[56:59],v27,s[20:23],s71 offen offset:2048 sc1
buffer_load_dwordx4 v[60:63],v27,s[20:23],s71 offen offset:3072 sc1
s_mov_b32 s68,0
s_waitcnt vmcnt(6)
v_smfmac_f32_16x16x64_bf16 v[184:187],v[32:35],a[128:135],v14
v_min3_u32 v22,v32,v33,v34
v_min3_u32 v22,v22,v35,v36
v_smfmac_f32_16x16x64_bf16 v[188:191],v[32:35],a[136:143],v14
v_min3_u32 v22,v22,v37,v38
v_smfmac_f32_16x16x64_bf16 v[184:187],v[36:39],a[144:151],v14
v_min_u32 v22,v22,v39
v_smfmac_f32_16x16x64_bf16 v[188:191],v[36:39],a[152:159],v14
v_cmp_eq_u32 s[52:53],0,v22
s_waitcnt vmcnt(4)
v_smfmac_f32_16x16x64_bf16 v[184:187],v[40:43],a[160:167],v14
v_min3_u32 v22,v40,v41,v42
s_cmp_lg_u64 s[52:53],0
v_smfmac_f32_16x16x64_bf16 v[188:191],v[40:43],a[168:175],v14
s_cbranch_scc1 ms_81
bk_82:
v_min3_u32 v22,v22,v43,v44
v_smfmac_f32_16x16x64_bf16 v[184:187],v[44:47],a[176:183],v14
v_min3_u32 v22,v22,v45,v46
v_min_u32 v22,v22,v47
v_smfmac_f32_16x16x64_bf16 v[188:191],v[44:47],a[184:191],v14
v_cmp_eq_u32 s[54:55],0,v22
s_waitcnt vmcnt(2)
v_smfmac_f32_16x16x64_bf16 v[184:187],v[48:51],a[192:199],v14
v_min3_u32 v22,v48,v49,v50
s_cmp_lg_u64 s[54:55],0
v_smfmac_f32_16x16x64_bf16 v[188:191],v[48:51],a[200:207],v14
s_cbranch_scc1 ms_83
bk_84:
v_min3_u32 v22,v22,v51,v52
v_smfmac_f32_16x16x64_bf16 v[184:187],v[52:55],a[208:215],v14
v_min3_u32 v22,v22,v53,v54
v_min_u32 v22,v22,v55
v_smfmac_f32_16x16x64_bf16 v[188:191],v[52:55],a[216:223],v14
v_cmp_eq_u32 s[52:53],0,v22
s_waitcnt vmcnt(0)
v_smfmac_f32_16x16x64_bf16 v[184:187],v[56:59],a[224:231],v14
v_min3_u32 v22,v56,v57,v58
s_cmp_lg_u64 s[52:53],0
v_smfmac_f32_16x16x64_bf16 v[188:191],v[56:59],a[232:239],v14
s_cbranch_scc1 ms_85
bk_86:
v_min3_u32 v22,v22,v59,v60
v_smfmac_f32_16x16x64_bf16 v[184:187],v[60:63],a[240:247],v14
v_min3_u32 v22,v22,v61,v62
v_min_u32 v22,v22,v63
v_smfmac_f32_16x16x64_bf16 v[188:191],v[60:63],a[248:255],v14
v_cmp_eq_u32 s[54:55],0,v22
s_cmp_lg_u64 s[54:55],0
s_cbranch_scc1 ms_89
bk_90:
s_cmp_lg_u32 s68,0
s_cbranch_scc1 rl2_91
fin_87:
s_nop 2
v_permlane32_swap_b32 v184,v188
v_permlane32_swap_b32 v185,v189
v_permlane32_swap_b32 v186,v190
v_permlane32_swap_b32 v187,v191
v_pk_add_f32 v[184:185],v[184:185],v[188:189]
v_pk_add_f32 v[186:187],v[186:187],v[190:191]
ds_write_b128 v24,v[184:187] offset:25600
ds_write_b32 v21,v25 offset:12
s_mov_b64 exec,s[84:85]
ds_read_b128 v[172:175],v12
s_mov_b64 exec,-1
buffer_load_dwordx4 v[96:99],v2,s[20:23],s72 offen offset:0 sc1
buffer_load_dwordx4 v[100:103],v2,s[20:23],s72 offen offset:1024 sc1
buffer_load_dwordx4 v[104:107],v5,s[20:23],s72 offen offset:0 sc1
buffer_load_dwordx4 v[108:111],v5,s[20:23],s72 offen offset:1024 sc1
buffer_load_dwordx4 v[112:115],v6,s[20:23],s72 offen offset:0 sc1
buffer_load_dwordx4 v[116:119],v6,s[20:23],s72 offen offset:1024 sc1
buffer_load_dwordx4 v[120:123],v7,s[20:23],s72 offen offset:0 sc1
buffer_load_dwordx4 v[124:127],v7,s[20:23],s72 offen offset:1024 sc1
s_waitcnt lgkmcnt(0)
buffer_store_dwordx4 v[172:175],v3,s[20:23],s77 offen sc1
s_xor_b32 s62,s62,0x10000
s_add_u32 s63,s79,1
s_and_b32 s64,s63,3
s_lshl_b32 s70,s64,20
s_add_u32 s65,s63,2
s_and_b32 s65,s65,3
s_lshl_b32 s73,s65,20
s_add_u32 s55,s63,3
s_lshl_b32 s78,s55,16
s_add_u32 s78,s78,57344
s_cmp_lt_u32 s55,64
s_cselect_b32 s78,s78,0x7fff0000
s_add_u32 s71,s70,65536
s_add_u32 s60,s63,1
s_and_b32 s60,s60,3
s_lshl_b32 s72,s60,20
v_mov_b32 v184,0
v_mov_b32 v185,0
v_mov_b32 v186,0
v_mov_b32 v187,0
v_mov_b32 v188,0
v_mov_b32 v189,0
v_mov_b32 v190,0
v_mov_b32 v191,0
s_lshl_b32 s77,s63,21
s_lshl_b32 s55,s63,13
s_and_b32 s55,s55,0x2000
s_xor_b32 s55,s55,s61
s_add_u32 s77,s77,s55
v_mov_b32 v176,0
v_mov_b32 v177,0
v_mov_b32 v178,0
v_mov_b32 v179,0
s_add_u32 s79,s79,1
v_add_u32 v25,1,v25
s_waitcnt vmcnt(0) lgkmcnt(0)
s_branch loop_64
last0_76:
wf_92:
ds_read_b32 v23,v21 offset:0
s_sub_u32 s90,s90,1
s_waitcnt lgkmcnt(0)
v_cmp_ne_u32 vcc,v23,v25
s_cmp_lt_i32 s90,0
s_cselect_b64 vcc,0,vcc
s_cbranch_vccnz wf_92
wf_93:
ds_read_b32 v23,v21 offset:4
s_sub_u32 s90,s90,1
s_waitcnt lgkmcnt(0)
v_cmp_ne_u32 vcc,v23,v25
s_cmp_lt_i32 s90,0
s_cselect_b64 vcc,0,vcc
s_cbranch_vccnz wf_93
s_mov_b64 exec,s[84:85]
ds_read_b128 v[172:175],v12
s_mov_b64 exec,-1
s_waitcnt lgkmcnt(0)
buffer_store_dwordx4 v[172:175],v3,s[20:23],s77 offen sc1
s_branch end_58
art_68:
s_sub_u32 s90,s90,1
s_cmp_lt_i32 s90,0
s_cbranch_scc1 abk_69
buffer_load_dwordx4 v[32:35],v26,s[20:23],s70 offen offset:0 sc1
buffer_load_dwordx4 v[36:39],v26,s[20:23],s70 offen offset:1024 sc1
buffer_load_dwordx4 v[40:43],v26,s[20:23],s70 offen offset:2048 sc1
buffer_load_dwordx4 v[44:47],v26,s[20:23],s70 offen offset:3072 sc1
s_waitcnt vmcnt(3)
ds_write_b128 v24,v[32:35] offset:0
v_min3_u32 v22,v32,v33,v34
v_min_u32 v22,v22,v35
s_waitcnt vmcnt(2)
ds_write_b128 v24,v[36:39] offset:1024
v_min3_u32 v22,v22,v36,v37
v_min3_u32 v22,v22,v38,v39
s_waitcnt vmcnt(1)
ds_write_b128 v24,v[40:43] offset:2048
v_min3_u32 v22,v22,v40,v41
v_min3_u32 v22,v22,v42,v43
s_waitcnt vmcnt(0)
ds_write_b128 v24,v[44:47] offset:3072
v_min3_u32 v22,v22,v44,v45
v_min3_u32 v22,v22,v46,v47
v_cmp_eq_u32 vcc,0,v22
s_cbranch_vccnz art_68
s_branch abk_69
kt0_70:
buffer_load_dwordx4 v[96:99],v2,s[20:23],s70 offen offset:0 sc1
buffer_load_dwordx4 v[100:103],v2,s[20:23],s70 offen offset:1024 sc1
buffer_load_dwordx4 v[104:107],v5,s[20:23],s70 offen offset:0 sc1
buffer_load_dwordx4 v[108:111],v5,s[20:23],s70 offen offset:1024 sc1
buffer_load_dwordx4 v[112:115],v6,s[20:23],s70 offen offset:0 sc1
buffer_load_dwordx4 v[116:119],v6,s[20:23],s70 offen offset:1024 sc1
buffer_load_dwordx4 v[120:123],v7,s[20:23],s70 offen offset:0 sc1
buffer_load_dwordx4 v[124:127],v7,s[20:23],s70 offen offset:1024 sc1
s_branch kt0b_71
vw_77:
wf_94:
ds_read_b32 v23,v21 offset:0
s_sub_u32 s90,s90,1
s_waitcnt lgkmcnt(0)
v_cmp_ne_u32 vcc,v23,v25
s_cmp_lt_i32 s90,0
s_cselect_b64 vcc,0,vcc
s_cbranch_vccnz wf_94
wf_95:
ds_read_b32 v23,v21 offset:4
s_sub_u32 s90,s90,1
s_waitcnt lgkmcnt(0)
v_cmp_ne_u32 vcc,v23,v25
s_cmp_lt_i32 s90,0
s_cselect_b64 vcc,0,vcc
s_cbranch_vccnz wf_95
ds_read_b64 v[220:221],v21
ds_read_b64 v[136:137],v31
ds_read_b64 v[140:141],v31 offset:256
s_waitcnt lgkmcnt(0)
s_branch vb_78
ms_81:
s_waitcnt vmcnt(0)
buffer_load_dwordx4 v[64:67],v26,s[20:23],s71 offen offset:0 sc1
buffer_load_dwordx4 v[68:71],v26,s[20:23],s71 offen offset:1024 sc1
s_bitset1_b32 s68,0
s_branch bk_82
ms_83:
s_waitcnt vmcnt(0)
buffer_load_dwordx4 v[72:75],v26,s[20:23],s71 offen offset:2048 sc1
buffer_load_dwordx4 v[76:79],v26,s[20:23],s71 offen offset:3072 sc1
s_bitset1_b32 s68,1
s_branch bk_84
ms_85:
s_waitcnt vmcnt(0)
buffer_load_dwordx4 v[80:83],v27,s[20:23],s71 offen offset:0 sc1
buffer_load_dwordx4 v[84:87],v27,s[20:23],s71 offen offset:1024 sc1
s_bitset1_b32 s68,2
s_branch bk_86
ms_89:
s_waitcnt vmcnt(0)
buffer_load_dwordx4 v[88:91],v27,s[20:23],s71 offen offset:2048 sc1
buffer_load_dwordx4 v[92:95],v27,s[20:23],s71 offen offset:3072 sc1
s_bitset1_b32 s68,3
s_branch bk_90
rl_88:
s_bitcmp1_b32 s68,0
s_cbranch_scc0 sk_96
buffer_load_dwordx4 v[64:67],v26,s[20:23],s71 offen offset:0 sc1
buffer_load_dwordx4 v[68:71],v26,s[20:23],s71 offen offset:1024 sc1
sk_96:
s_bitcmp1_b32 s68,1
s_cbranch_scc0 sk_97
buffer_load_dwordx4 v[72:75],v26,s[20:23],s71 offen offset:2048 sc1
buffer_load_dwordx4 v[76:79],v26,s[20:23],s71 offen offset:3072 sc1
sk_97:
s_bitcmp1_b32 s68,2
s_cbranch_scc0 sk_98
buffer_load_dwordx4 v[80:83],v27,s[20:23],s71 offen offset:0 sc1
buffer_load_dwordx4 v[84:87],v27,s[20:23],s71 offen offset:1024 sc1
sk_98:
s_bitcmp1_b32 s68,3
s_cbranch_scc0 sk_99
buffer_load_dwordx4 v[88:91],v27,s[20:23],s71 offen offset:2048 sc1
buffer_load_dwordx4 v[92:95],v27,s[20:23],s71 offen offset:3072 sc1
sk_99:
rl2_91:
s_sub_u32 s90,s90,1
s_cmp_lt_i32 s90,0
s_cbranch_scc1 fin_87
s_waitcnt vmcnt(0)
s_bitcmp1_b32 s68,0
s_cbranch_scc0 sk_100
v_min3_u32 v22,v64,v65,v66
v_min3_u32 v22,v22,v67,v68
v_min3_u32 v22,v22,v69,v70
v_min_u32 v22,v22,v71
v_cmp_eq_u32 vcc,0,v22
v_xor_b32 v64,v32,v64
v_xor_b32 v65,v33,v65
v_xor_b32 v66,v34,v66
v_xor_b32 v67,v35,v67
v_xor_b32 v68,v36,v68
v_xor_b32 v69,v37,v69
v_xor_b32 v70,v38,v70
v_xor_b32 v71,v39,v71
s_cbranch_vccnz nb_101
s_bitset0_b32 s68,0
v_smfmac_f32_16x16x64_bf16 v[184:187],v[64:67],a[128:135],v14
v_smfmac_f32_16x16x64_bf16 v[188:191],v[64:67],a[136:143],v14
v_smfmac_f32_16x16x64_bf16 v[184:187],v[68:71],a[144:151],v14
v_smfmac_f32_16x16x64_bf16 v[188:191],v[68:71],a[152:159],v14
nb_101:
sk_100:
s_bitcmp1_b32 s68,1
s_cbranch_scc0 sk_102
v_min3_u32 v22,v72,v73,v74
v_min3_u32 v22,v22,v75,v76
v_min3_u32 v22,v22,v77,v78
v_min_u32 v22,v22,v79
v_cmp_eq_u32 vcc,0,v22
v_xor_b32 v72,v40,v72
v_xor_b32 v73,v41,v73
v_xor_b32 v74,v42,v74
v_xor_b32 v75,v43,v75
v_xor_b32 v76,v44,v76
v_xor_b32 v77,v45,v77
v_xor_b32 v78,v46,v78
v_xor_b32 v79,v47,v79
s_cbranch_vccnz nb_103
s_bitset0_b32 s68,1
v_smfmac_f32_16x16x64_bf16 v[184:187],v[72:75],a[160:167],v14
v_smfmac_f32_16x16x64_bf16 v[188:191],v[72:75],a[168:175],v14
v_smfmac_f32_16x16x64_bf16 v[184:187],v[76:79],a[176:183],v14
v_smfmac_f32_16x16x64_bf16 v[188:191],v[76:79],a[184:191],v14
nb_103:
sk_102:
s_bitcmp1_b32 s68,2
s_cbranch_scc0 sk_104
v_min3_u32 v22,v80,v81,v82
v_min3_u32 v22,v22,v83,v84
v_min3_u32 v22,v22,v85,v86
v_min_u32 v22,v22,v87
v_cmp_eq_u32 vcc,0,v22
v_xor_b32 v80,v48,v80
v_xor_b32 v81,v49,v81
v_xor_b32 v82,v50,v82
v_xor_b32 v83,v51,v83
v_xor_b32 v84,v52,v84
v_xor_b32 v85,v53,v85
v_xor_b32 v86,v54,v86
v_xor_b32 v87,v55,v87
s_cbranch_vccnz nb_105
s_bitset0_b32 s68,2
v_smfmac_f32_16x16x64_bf16 v[184:187],v[80:83],a[192:199],v14
v_smfmac_f32_16x16x64_bf16 v[188:191],v[80:83],a[200:207],v14
v_smfmac_f32_16x16x64_bf16 v[184:187],v[84:87],a[208:215],v14
v_smfmac_f32_16x16x64_bf16 v[188:191],v[84:87],a[216:223],v14
nb_105:
sk_104:
s_bitcmp1_b32 s68,3
s_cbranch_scc0 sk_106
v_min3_u32 v22,v88,v89,v90
v_min3_u32 v22,v22,v91,v92
v_min3_u32 v22,v22,v93,v94
v_min_u32 v22,v22,v95
v_cmp_eq_u32 vcc,0,v22
v_xor_b32 v88,v56,v88
v_xor_b32 v89,v57,v89
v_xor_b32 v90,v58,v90
v_xor_b32 v91,v59,v91
v_xor_b32 v92,v60,v92
v_xor_b32 v93,v61,v93
v_xor_b32 v94,v62,v94
v_xor_b32 v95,v63,v95
s_cbranch_vccnz nb_107
s_bitset0_b32 s68,3
v_smfmac_f32_16x16x64_bf16 v[184:187],v[88:91],a[224:231],v14
v_smfmac_f32_16x16x64_bf16 v[188:191],v[88:91],a[232:239],v14
v_smfmac_f32_16x16x64_bf16 v[184:187],v[92:95],a[240:247],v14
v_smfmac_f32_16x16x64_bf16 v[188:191],v[92:95],a[248:255],v14
nb_107:
sk_106:
s_cmp_lg_u32 s68,0
s_cbranch_scc1 rl_88
s_nop 2
s_branch fin_87
first_63:
s_waitcnt vmcnt(0) lgkmcnt(0)
s_barrier
s_mov_b32 m0,65536
s_mov_b32 s65,122880
buffer_load_dwordx4 v16,s[20:23],s65 offen offset:0 lds
buffer_load_dwordx4 v16,s[20:23],s65 offen offset:1024 lds
buffer_load_dwordx4 v16,s[20:23],s65 offen offset:2048 lds
buffer_load_dwordx4 v16,s[20:23],s65 offen offset:3072 lds
s_mov_b32 m0,69632
s_mov_b32 s65,126976
buffer_load_dwordx4 v16,s[20:23],s65 offen offset:0 lds
buffer_load_dwordx4 v16,s[20:23],s65 offen offset:1024 lds
buffer_load_dwordx4 v16,s[20:23],s65 offen offset:2048 lds
buffer_load_dwordx4 v16,s[20:23],s65 offen offset:3072 lds
s_mov_b32 m0,73728
s_mov_b32 s65,131072
buffer_load_dwordx4 v16,s[20:23],s65 offen offset:0 lds
buffer_load_dwordx4 v16,s[20:23],s65 offen offset:1024 lds
buffer_load_dwordx4 v16,s[20:23],s65 offen offset:2048 lds
buffer_load_dwordx4 v16,s[20:23],s65 offen offset:3072 lds
s_mov_b32 m0,77824
s_mov_b32 s65,135168
buffer_load_dwordx4 v16,s[20:23],s65 offen offset:0 lds
buffer_load_dwordx4 v16,s[20:23],s65 offen offset:1024 lds
buffer_load_dwordx4 v16,s[20:23],s65 offen offset:2048 lds
buffer_load_dwordx4 v16,s[20:23],s65 offen offset:3072 lds
s_mov_b32 m0,81920
s_mov_b32 s65,139264
buffer_load_dwordx4 v16,s[20:23],s65 offen offset:0 lds
buffer_load_dwordx4 v16,s[20:23],s65 offen offset:1024 lds
buffer_load_dwordx4 v16,s[20:23],s65 offen offset:2048 lds
buffer_load_dwordx4 v16,s[20:23],s65 offen offset:3072 lds
s_mov_b32 m0,86016
s_mov_b32 s65,143360
buffer_load_dwordx4 v16,s[20:23],s65 offen offset:0 lds
buffer_load_dwordx4 v16,s[20:23],s65 offen offset:1024 lds
buffer_load_dwordx4 v16,s[20:23],s65 offen offset:2048 lds
buffer_load_dwordx4 v16,s[20:23],s65 offen offset:3072 lds
s_mov_b32 m0,90112
s_mov_b32 s65,147456
buffer_load_dwordx4 v16,s[20:23],s65 offen offset:0 lds
buffer_load_dwordx4 v16,s[20:23],s65 offen offset:1024 lds
buffer_load_dwordx4 v16,s[20:23],s65 offen offset:2048 lds
buffer_load_dwordx4 v16,s[20:23],s65 offen offset:3072 lds
s_mov_b32 m0,94208
s_mov_b32 s65,151552
buffer_load_dwordx4 v16,s[20:23],s65 offen offset:0 lds
buffer_load_dwordx4 v16,s[20:23],s65 offen offset:1024 lds
buffer_load_dwordx4 v16,s[20:23],s65 offen offset:2048 lds
buffer_load_dwordx4 v16,s[20:23],s65 offen offset:3072 lds
s_xor_b32 s64,s61,4194304
buffer_store_dwordx4 v[100:103],v206,s[20:23],s64 offen sc1
buffer_store_dwordx4 v[100:103],v207,s[20:23],s64 offen sc1
s_xor_b32 s64,s61,6299648
buffer_store_dwordx4 v[100:103],v206,s[20:23],s64 offen sc1
buffer_store_dwordx4 v[100:103],v207,s[20:23],s64 offen sc1
s_xor_b32 s64,s61,8388608
buffer_store_dwordx4 v[100:103],v206,s[20:23],s64 offen sc1
buffer_store_dwordx4 v[100:103],v207,s[20:23],s64 offen sc1
s_waitcnt vmcnt(6)
s_barrier
s_mov_b32 m0,0
s_mov_b32 s65,188416
buffer_load_dwordx4 v16,s[20:23],s65 offen offset:0 lds
buffer_load_dwordx4 v16,s[20:23],s65 offen offset:1024 lds
buffer_load_dwordx4 v16,s[20:23],s65 offen offset:2048 lds
buffer_load_dwordx4 v16,s[20:23],s65 offen offset:3072 lds
s_mov_b32 m0,4096
s_mov_b32 s65,192512
buffer_load_dwordx4 v16,s[20:23],s65 offen offset:0 lds
buffer_load_dwordx4 v16,s[20:23],s65 offen offset:1024 lds
buffer_load_dwordx4 v16,s[20:23],s65 offen offset:2048 lds
buffer_load_dwordx4 v16,s[20:23],s65 offen offset:3072 lds
s_mov_b32 m0,8192
s_mov_b32 s65,196608
buffer_load_dwordx4 v16,s[20:23],s65 offen offset:0 lds
buffer_load_dwordx4 v16,s[20:23],s65 offen offset:1024 lds
buffer_load_dwordx4 v16,s[20:23],s65 offen offset:2048 lds
buffer_load_dwordx4 v16,s[20:23],s65 offen offset:3072 lds
s_mov_b32 m0,12288
s_mov_b32 s65,200704
buffer_load_dwordx4 v16,s[20:23],s65 offen offset:0 lds
buffer_load_dwordx4 v16,s[20:23],s65 offen offset:1024 lds
buffer_load_dwordx4 v16,s[20:23],s65 offen offset:2048 lds
buffer_load_dwordx4 v16,s[20:23],s65 offen offset:3072 lds
s_mov_b32 m0,16384
s_mov_b32 s65,204800
buffer_load_dwordx4 v16,s[20:23],s65 offen offset:0 lds
buffer_load_dwordx4 v16,s[20:23],s65 offen offset:1024 lds
buffer_load_dwordx4 v16,s[20:23],s65 offen offset:2048 lds
buffer_load_dwordx4 v16,s[20:23],s65 offen offset:3072 lds
s_mov_b32 m0,20480
s_mov_b32 s65,208896
buffer_load_dwordx4 v16,s[20:23],s65 offen offset:0 lds
buffer_load_dwordx4 v16,s[20:23],s65 offen offset:1024 lds
buffer_load_dwordx4 v16,s[20:23],s65 offen offset:2048 lds
buffer_load_dwordx4 v16,s[20:23],s65 offen offset:3072 lds
s_mov_b32 m0,24576
s_mov_b32 s65,212992
buffer_load_dwordx4 v16,s[20:23],s65 offen offset:0 lds
buffer_load_dwordx4 v16,s[20:23],s65 offen offset:1024 lds
buffer_load_dwordx4 v16,s[20:23],s65 offen offset:2048 lds
buffer_load_dwordx4 v16,s[20:23],s65 offen offset:3072 lds
s_mov_b32 m0,28672
s_mov_b32 s65,217088
buffer_load_dwordx4 v16,s[20:23],s65 offen offset:0 lds
buffer_load_dwordx4 v16,s[20:23],s65 offen offset:1024 lds
buffer_load_dwordx4 v16,s[20:23],s65 offen offset:2048 lds
buffer_load_dwordx4 v16,s[20:23],s65 offen offset:3072 lds
s_mov_b32 s79,0
s_add_u32 s63,s79,0
s_and_b32 s64,s63,3
s_lshl_b32 s70,s64,20
s_add_u32 s65,s63,2
s_and_b32 s65,s65,3
s_lshl_b32 s73,s65,20
s_add_u32 s55,s63,3
s_lshl_b32 s78,s55,16
s_add_u32 s78,s78,57344
s_cmp_lt_u32 s55,64
s_cselect_b32 s78,s78,0x7fff0000
s_add_u32 s71,s70,65536
s_add_u32 s60,s63,1
s_and_b32 s60,s60,3
s_lshl_b32 s72,s60,20
v_mov_b32 v184,0
v_mov_b32 v185,0
v_mov_b32 v186,0
v_mov_b32 v187,0
v_mov_b32 v188,0
v_mov_b32 v189,0
v_mov_b32 v190,0
v_mov_b32 v191,0
s_lshl_b32 s77,s63,21
s_lshl_b32 s55,s63,13
s_and_b32 s55,s55,0x2000
s_xor_b32 s55,s55,s61
s_add_u32 s77,s77,s55
v_mov_b32 v176,0
v_mov_b32 v177,0
v_mov_b32 v178,0
v_mov_b32 v179,0
v_mov_b32 v25,1
s_waitcnt vmcnt(0) lgkmcnt(0)
s_barrier
s_branch loop_64
w1_60:
s_lshr_b32 s64,s57,2
s_add_u32 s64,s64,64
s_lshl_b32 s64,s64,14
s_add_u32 s64,s64,s68
s_add_u32 s64,s64,29360128
v_add_u32 v12,s64,v16
v_and_b32 v22,1,v4
v_lshrrev_b32 v23,1,v4
v_lshl_add_u32 v22,v22,1,v23
v_lshlrev_b32 v22,2,v22
v_lshl_add_u32 v22,v3,4,v22
v_add_u32 v31,155648,v22
v_add_u32 v8,s66,v16
v_add_u32 v9,s67,v16
v_mov_b32 v10,1792
v_mov_b32 v11,0
s_branch first_108
loop_109:
s_barrier
buffer_load_dword v248,v18,s[20:23],s70 offen offset:0 sc1
s_nop 15
s_nop 5
hl_111:
buffer_load_dword v249,v18,s[20:23],s70 offen offset:0 sc1
s_waitcnt vmcnt(1)
v_cmp_eq_u32 vcc,v25,v248
s_bcnt1_i32_b32 s64,vcc_lo
s_cmp_ge_u32 s64,8
s_cbranch_scc1 hg_112
buffer_load_dword v248,v18,s[20:23],s70 offen offset:0 sc1
s_waitcnt vmcnt(1)
v_cmp_eq_u32 vcc,v25,v249
s_bcnt1_i32_b32 s64,vcc_lo
s_cmp_ge_u32 s64,8
s_cbranch_scc1 hg_112
s_sub_u32 s90,s90,1
s_cmp_gt_i32 s90,0
s_cbranch_scc1 hl_111
hg_112:
buffer_load_dwordx4 v[48:51],v27,s[20:23],s70 offen offset:0 sc1
buffer_load_dwordx4 v[52:55],v27,s[20:23],s70 offen offset:1024 sc1
buffer_load_dwordx4 v[56:59],v27,s[20:23],s70 offen offset:2048 sc1
buffer_load_dwordx4 v[60:63],v27,s[20:23],s70 offen offset:3072 sc1
s_waitcnt vmcnt(3)
ds_write_b128 v24,v[48:51] offset:4096
v_min3_u32 v22,v48,v49,v50
v_min_u32 v22,v22,v51
s_waitcnt vmcnt(2)
ds_write_b128 v24,v[52:55] offset:5120
v_min3_u32 v22,v22,v52,v53
v_min3_u32 v22,v22,v54,v55
s_waitcnt vmcnt(1)
ds_write_b128 v24,v[56:59] offset:6144
v_min3_u32 v22,v22,v56,v57
v_min3_u32 v22,v22,v58,v59
s_waitcnt vmcnt(0)
ds_write_b128 v24,v[60:63] offset:7168
v_min3_u32 v22,v22,v60,v61
v_min3_u32 v22,v22,v62,v63
v_cmp_eq_u32 vcc,0,v22
s_cbranch_vccnz art_113
abk_114:
v_smfmac_f32_16x16x64_bf16 v[176:179],v[48:51],a[32:39],v14
s_waitcnt lgkmcnt(0)
s_barrier
ds_read_b128 v[64:67],v24 offset:8192
ds_read_b128 v[68:71],v24 offset:9216
ds_read_b128 v[72:75],v24 offset:10240
ds_read_b128 v[76:79],v24 offset:11264
buffer_store_dwordx4 v[212:215],v12,s[20:23],s76 offen sc1
v_smfmac_f32_16x16x64_bf16 v[176:179],v[52:55],a[40:47],v14
ds_read_b128 v[80:83],v24 offset:12288
ds_read_b128 v[84:87],v24 offset:13312
v_smfmac_f32_16x16x64_bf16 v[176:179],v[56:59],a[48:55],v14
ds_read_b128 v[88:91],v24 offset:14336
ds_read_b128 v[92:95],v24 offset:15360
v_smfmac_f32_16x16x64_bf16 v[176:179],v[60:63],a[56:63],v14
ds_read_b128 v[32:35],v24 offset:0
ds_read_b128 v[36:39],v24 offset:1024
s_waitcnt lgkmcnt(9)
v_smfmac_f32_16x16x64_bf16 v[176:179],v[64:67],a[64:71],v14
ds_read_b128 v[40:43],v24 offset:2048
s_waitcnt lgkmcnt(9)
v_smfmac_f32_16x16x64_bf16 v[176:179],v[68:71],a[72:79],v14
ds_read_b128 v[44:47],v24 offset:3072
s_waitcnt lgkmcnt(9)
v_smfmac_f32_16x16x64_bf16 v[176:179],v[72:75],a[80:87],v14
s_waitcnt lgkmcnt(8)
v_smfmac_f32_16x16x64_bf16 v[176:179],v[76:79],a[88:95],v14
s_waitcnt lgkmcnt(7)
v_smfmac_f32_16x16x64_bf16 v[176:179],v[80:83],a[96:103],v14
s_waitcnt lgkmcnt(6)
v_smfmac_f32_16x16x64_bf16 v[176:179],v[84:87],a[104:111],v14
s_waitcnt lgkmcnt(5)
v_smfmac_f32_16x16x64_bf16 v[176:179],v[88:91],a[112:119],v14
s_waitcnt lgkmcnt(4)
v_smfmac_f32_16x16x64_bf16 v[176:179],v[92:95],a[120:127],v14
s_waitcnt lgkmcnt(3)
v_smfmac_f32_16x16x64_bf16 v[176:179],v[32:35],a[0:7],v14
s_waitcnt lgkmcnt(2)
v_smfmac_f32_16x16x64_bf16 v[176:179],v[36:39],a[8:15],v14
s_waitcnt lgkmcnt(1)
v_smfmac_f32_16x16x64_bf16 v[176:179],v[40:43],a[16:23],v14
s_waitcnt lgkmcnt(0)
v_smfmac_f32_16x16x64_bf16 v[176:179],v[44:47],a[24:31],v14
v_smfmac_f32_16x16x64_bf16 v[180:183],v[32:35],a[128:135],v14
v_smfmac_f32_16x16x64_bf16 v[180:183],v[36:39],a[136:143],v14
s_nop 5
v_permlane32_swap_b32 v176,v178
v_permlane32_swap_b32 v177,v179
v_add_f32 v176,v176,v178
v_add_f32 v177,v177,v179
v_cvt_pk_bf16_f32 v216,v176,v177
s_nop 1
v_mov_b32_dpp v217,v216 quad_perm:[1,0,3,2] row_mask:0xf bank_mask:0xf
v_perm_b32 v216,v217,v216,v15
v_max_u32 v216,1,v216
buffer_store_dword v216,v19,s[24:27],s70 offen
buffer_store_dword v216,v19,s[28:31],s70 offen sc1
v_smfmac_f32_16x16x64_bf16 v[180:183],v[40:43],a[144:151],v14
v_smfmac_f32_16x16x64_bf16 v[180:183],v[44:47],a[152:159],v14
v_smfmac_f32_16x16x64_bf16 v[180:183],v[48:51],a[160:167],v14
v_smfmac_f32_16x16x64_bf16 v[180:183],v[52:55],a[168:175],v14
v_smfmac_f32_16x16x64_bf16 v[180:183],v[56:59],a[176:183],v14
v_smfmac_f32_16x16x64_bf16 v[180:183],v[60:63],a[184:191],v14
v_smfmac_f32_16x16x64_bf16 v[180:183],v[64:67],a[192:199],v14
v_smfmac_f32_16x16x64_bf16 v[180:183],v[68:71],a[200:207],v14
v_smfmac_f32_16x16x64_bf16 v[180:183],v[72:75],a[208:215],v14
v_smfmac_f32_16x16x64_bf16 v[180:183],v[76:79],a[216:223],v14
v_smfmac_f32_16x16x64_bf16 v[180:183],v[80:83],a[224:231],v14
v_smfmac_f32_16x16x64_bf16 v[180:183],v[84:87],a[232:239],v14
v_smfmac_f32_16x16x64_bf16 v[180:183],v[88:91],a[240:247],v14
v_smfmac_f32_16x16x64_bf16 v[180:183],v[92:95],a[248:255],v14
s_nop 7
v_permlane32_swap_b32 v180,v182
v_permlane32_swap_b32 v181,v183
v_add_f32 v180,v180,v182
v_add_f32 v181,v181,v183
v_cvt_pk_bf16_f32 v216,v180,v181
v_max_u32 v216,1,v216
ds_write_b32 v31,v216
ds_write_b32 v21,v25 offset:0
s_cmp_eq_u32 s79,63
s_cbranch_scc1 end_58
s_cmp_ge_i32 s79,62
s_cbranch_scc1 bgx_115
ds_read_b128 v[64:67],v20 offset:0
ds_read_b128 v[68:71],v20 offset:1024
ds_read_b128 v[72:75],v20 offset:2048
s_waitcnt lgkmcnt(2)
v_mfma_f32_16x16x32_bf16 v[192:195],a[0:3],v[64:67],0
ds_read_b128 v[76:79],v20 offset:3072
v_mfma_f32_16x16x32_bf16 v[200:203],v[64:67],a[128:131],0
s_waitcnt lgkmcnt(2)
v_mfma_f32_16x16x32_bf16 v[196:199],a[0:3],v[68:71],0
ds_read_b128 v[64:67],v20 offset:4096
v_mfma_f32_16x16x32_bf16 v[204:207],v[68:71],a[128:131],0
s_waitcnt lgkmcnt(2)
v_mfma_f32_16x16x32_bf16 v[192:195],a[4:7],v[72:75],v[192:195]
ds_read_b128 v[68:71],v20 offset:5120
v_mfma_f32_16x16x32_bf16 v[200:203],v[72:75],a[132:135],v[200:203]
s_waitcnt lgkmcnt(2)
v_mfma_f32_16x16x32_bf16 v[196:199],a[4:7],v[76:79],v[196:199]
ds_read_b128 v[72:75],v20 offset:6144
v_mfma_f32_16x16x32_bf16 v[204:207],v[76:79],a[132:135],v[204:207]
s_waitcnt lgkmcnt(2)
v_mfma_f32_16x16x32_bf16 v[192:195],a[8:11],v[64:67],v[192:195]
ds_read_b128 v[76:79],v20 offset:7168
v_mfma_f32_16x16x32_bf16 v[200:203],v[64:67],a[136:139],v[200:203]
s_waitcnt lgkmcnt(2)
v_mfma_f32_16x16x32_bf16 v[196:199],a[8:11],v[68:71],v[196:199]
ds_read_b128 v[64:67],v20 offset:8192
v_mfma_f32_16x16x32_bf16 v[204:207],v[68:71],a[136:139],v[204:207]
s_waitcnt lgkmcnt(2)
v_mfma_f32_16x16x32_bf16 v[192:195],a[12:15],v[72:75],v[192:195]
ds_read_b128 v[68:71],v20 offset:9216
v_mfma_f32_16x16x32_bf16 v[200:203],v[72:75],a[140:143],v[200:203]
s_waitcnt lgkmcnt(2)
v_mfma_f32_16x16x32_bf16 v[196:199],a[12:15],v[76:79],v[196:199]
ds_read_b128 v[72:75],v20 offset:10240
v_mfma_f32_16x16x32_bf16 v[204:207],v[76:79],a[140:143],v[204:207]
s_add_u32 m0,s62,0
s_add_u32 s69,s78,0
s_waitcnt lgkmcnt(2)
v_mfma_f32_16x16x32_bf16 v[192:195],a[16:19],v[64:67],v[192:195]
ds_read_b128 v[76:79],v20 offset:11264
v_mfma_f32_16x16x32_bf16 v[200:203],v[64:67],a[144:147],v[200:203]
buffer_load_dwordx4 v16,s[20:23],s69 offen offset:0 lds
s_waitcnt lgkmcnt(2)
v_mfma_f32_16x16x32_bf16 v[196:199],a[16:19],v[68:71],v[196:199]
ds_read_b128 v[64:67],v20 offset:12288
v_mfma_f32_16x16x32_bf16 v[204:207],v[68:71],a[144:147],v[204:207]
buffer_load_dwordx4 v16,s[20:23],s69 offen offset:1024 lds
s_waitcnt lgkmcnt(2)
v_mfma_f32_16x16x32_bf16 v[192:195],a[20:23],v[72:75],v[192:195]
ds_read_b128 v[68:71],v20 offset:13312
v_mfma_f32_16x16x32_bf16 v[200:203],v[72:75],a[148:151],v[200:203]
buffer_load_dwordx4 v16,s[20:23],s69 offen offset:2048 lds
s_waitcnt lgkmcnt(2)
v_mfma_f32_16x16x32_bf16 v[196:199],a[20:23],v[76:79],v[196:199]
ds_read_b128 v[72:75],v20 offset:14336
v_mfma_f32_16x16x32_bf16 v[204:207],v[76:79],a[148:151],v[204:207]
buffer_load_dwordx4 v16,s[20:23],s69 offen offset:3072 lds
s_waitcnt lgkmcnt(2)
v_mfma_f32_16x16x32_bf16 v[192:195],a[24:27],v[64:67],v[192:195]
ds_read_b128 v[76:79],v20 offset:15360
v_mfma_f32_16x16x32_bf16 v[200:203],v[64:67],a[152:155],v[200:203]
s_add_u32 m0,s62,4096
s_add_u32 s69,s78,4096
s_waitcnt lgkmcnt(2)
v_mfma_f32_16x16x32_bf16 v[196:199],a[24:27],v[68:71],v[196:199]
ds_read_b128 v[64:67],v20 offset:16384
v_mfma_f32_16x16x32_bf16 v[204:207],v[68:71],a[152:155],v[204:207]
buffer_load_dwordx4 v16,s[20:23],s69 offen offset:0 lds
s_waitcnt lgkmcnt(2)
v_mfma_f32_16x16x32_bf16 v[192:195],a[28:31],v[72:75],v[192:195]
ds_read_b128 v[68:71],v20 offset:17408
v_mfma_f32_16x16x32_bf16 v[200:203],v[72:75],a[156:159],v[200:203]
buffer_load_dwordx4 v16,s[20:23],s69 offen offset:1024 lds
s_waitcnt lgkmcnt(2)
v_mfma_f32_16x16x32_bf16 v[196:199],a[28:31],v[76:79],v[196:199]
ds_read_b128 v[72:75],v20 offset:18432
v_mfma_f32_16x16x32_bf16 v[204:207],v[76:79],a[156:159],v[204:207]
buffer_load_dwordx4 v16,s[20:23],s69 offen offset:2048 lds
s_waitcnt lgkmcnt(2)
v_mfma_f32_16x16x32_bf16 v[192:195],a[32:35],v[64:67],v[192:195]
ds_read_b128 v[76:79],v20 offset:19456
v_mfma_f32_16x16x32_bf16 v[200:203],v[64:67],a[160:163],v[200:203]
buffer_load_dwordx4 v16,s[20:23],s69 offen offset:3072 lds
s_waitcnt lgkmcnt(2)
v_mfma_f32_16x16x32_bf16 v[196:199],a[32:35],v[68:71],v[196:199]
ds_read_b128 v[64:67],v20 offset:20480
v_mfma_f32_16x16x32_bf16 v[204:207],v[68:71],a[160:163],v[204:207]
s_add_u32 m0,s62,8192
s_add_u32 s69,s78,8192
s_waitcnt lgkmcnt(2)
v_mfma_f32_16x16x32_bf16 v[192:195],a[36:39],v[72:75],v[192:195]
ds_read_b128 v[68:71],v20 offset:21504
v_mfma_f32_16x16x32_bf16 v[200:203],v[72:75],a[164:167],v[200:203]
buffer_load_dwordx4 v16,s[20:23],s69 offen offset:0 lds
s_waitcnt lgkmcnt(2)
v_mfma_f32_16x16x32_bf16 v[196:199],a[36:39],v[76:79],v[196:199]
ds_read_b128 v[72:75],v20 offset:22528
v_mfma_f32_16x16x32_bf16 v[204:207],v[76:79],a[164:167],v[204:207]
buffer_load_dwordx4 v16,s[20:23],s69 offen offset:1024 lds
s_waitcnt lgkmcnt(2)
v_mfma_f32_16x16x32_bf16 v[192:195],a[40:43],v[64:67],v[192:195]
ds_read_b128 v[76:79],v20 offset:23552
v_mfma_f32_16x16x32_bf16 v[200:203],v[64:67],a[168:171],v[200:203]
buffer_load_dwordx4 v16,s[20:23],s69 offen offset:2048 lds
s_waitcnt lgkmcnt(2)
v_mfma_f32_16x16x32_bf16 v[196:199],a[40:43],v[68:71],v[196:199]
ds_read_b128 v[64:67],v20 offset:24576
v_mfma_f32_16x16x32_bf16 v[204:207],v[68:71],a[168:171],v[204:207]
buffer_load_dwordx4 v16,s[20:23],s69 offen offset:3072 lds
s_waitcnt lgkmcnt(2)
v_mfma_f32_16x16x32_bf16 v[192:195],a[44:47],v[72:75],v[192:195]
ds_read_b128 v[68:71],v20 offset:25600
v_mfma_f32_16x16x32_bf16 v[200:203],v[72:75],a[172:175],v[200:203]
s_add_u32 m0,s62,12288
s_add_u32 s69,s78,12288
s_waitcnt lgkmcnt(2)
v_mfma_f32_16x16x32_bf16 v[196:199],a[44:47],v[76:79],v[196:199]
ds_read_b128 v[72:75],v20 offset:26624
v_mfma_f32_16x16x32_bf16 v[204:207],v[76:79],a[172:175],v[204:207]
buffer_load_dwordx4 v16,s[20:23],s69 offen offset:0 lds
s_waitcnt lgkmcnt(2)
v_mfma_f32_16x16x32_bf16 v[192:195],a[48:51],v[64:67],v[192:195]
ds_read_b128 v[76:79],v20 offset:27648
v_mfma_f32_16x16x32_bf16 v[200:203],v[64:67],a[176:179],v[200:203]
buffer_load_dwordx4 v16,s[20:23],s69 offen offset:1024 lds
s_waitcnt lgkmcnt(2)
v_mfma_f32_16x16x32_bf16 v[196:199],a[48:51],v[68:71],v[196:199]
ds_read_b128 v[64:67],v20 offset:28672
v_mfma_f32_16x16x32_bf16 v[204:207],v[68:71],a[176:179],v[204:207]
buffer_load_dwordx4 v16,s[20:23],s69 offen offset:2048 lds
s_waitcnt lgkmcnt(2)
v_mfma_f32_16x16x32_bf16 v[192:195],a[52:55],v[72:75],v[192:195]
ds_read_b128 v[68:71],v20 offset:29696
v_mfma_f32_16x16x32_bf16 v[200:203],v[72:75],a[180:183],v[200:203]
buffer_load_dwordx4 v16,s[20:23],s69 offen offset:3072 lds
s_waitcnt lgkmcnt(2)
v_mfma_f32_16x16x32_bf16 v[196:199],a[52:55],v[76:79],v[196:199]
ds_read_b128 v[72:75],v20 offset:30720
v_mfma_f32_16x16x32_bf16 v[204:207],v[76:79],a[180:183],v[204:207]
s_waitcnt lgkmcnt(2)
v_mfma_f32_16x16x32_bf16 v[192:195],a[56:59],v[64:67],v[192:195]
ds_read_b128 v[76:79],v20 offset:31744
v_mfma_f32_16x16x32_bf16 v[200:203],v[64:67],a[184:187],v[200:203]
s_waitcnt lgkmcnt(2)
v_mfma_f32_16x16x32_bf16 v[196:199],a[56:59],v[68:71],v[196:199]
ds_read_b128 v[64:67],v20 offset:32768
v_mfma_f32_16x16x32_bf16 v[204:207],v[68:71],a[184:187],v[204:207]
s_waitcnt lgkmcnt(2)
v_mfma_f32_16x16x32_bf16 v[192:195],a[60:63],v[72:75],v[192:195]
ds_read_b128 v[68:71],v20 offset:33792
v_mfma_f32_16x16x32_bf16 v[200:203],v[72:75],a[188:191],v[200:203]
s_waitcnt lgkmcnt(2)
v_mfma_f32_16x16x32_bf16 v[196:199],a[60:63],v[76:79],v[196:199]
ds_read_b128 v[72:75],v20 offset:34816
v_mfma_f32_16x16x32_bf16 v[204:207],v[76:79],a[188:191],v[204:207]
s_waitcnt lgkmcnt(2)
v_mfma_f32_16x16x32_bf16 v[192:195],a[64:67],v[64:67],v[192:195]
ds_read_b128 v[76:79],v20 offset:35840
v_mfma_f32_16x16x32_bf16 v[200:203],v[64:67],a[192:195],v[200:203]
s_waitcnt lgkmcnt(2)
v_mfma_f32_16x16x32_bf16 v[196:199],a[64:67],v[68:71],v[196:199]
ds_read_b128 v[64:67],v20 offset:36864
v_mfma_f32_16x16x32_bf16 v[204:207],v[68:71],a[192:195],v[204:207]
s_waitcnt lgkmcnt(2)
v_mfma_f32_16x16x32_bf16 v[192:195],a[68:71],v[72:75],v[192:195]
ds_read_b128 v[68:71],v20 offset:37888
v_mfma_f32_16x16x32_bf16 v[200:203],v[72:75],a[196:199],v[200:203]
s_waitcnt lgkmcnt(2)
v_mfma_f32_16x16x32_bf16 v[196:199],a[68:71],v[76:79],v[196:199]
ds_read_b128 v[72:75],v20 offset:38912
v_mfma_f32_16x16x32_bf16 v[204:207],v[76:79],a[196:199],v[204:207]
s_waitcnt lgkmcnt(2)
v_mfma_f32_16x16x32_bf16 v[192:195],a[72:75],v[64:67],v[192:195]
ds_read_b128 v[76:79],v20 offset:39936
v_mfma_f32_16x16x32_bf16 v[200:203],v[64:67],a[200:203],v[200:203]
s_waitcnt lgkmcnt(2)
v_mfma_f32_16x16x32_bf16 v[196:199],a[72:75],v[68:71],v[196:199]
ds_read_b128 v[64:67],v20 offset:40960
v_mfma_f32_16x16x32_bf16 v[204:207],v[68:71],a[200:203],v[204:207]
s_waitcnt lgkmcnt(2)
v_mfma_f32_16x16x32_bf16 v[192:195],a[76:79],v[72:75],v[192:195]
ds_read_b128 v[68:71],v20 offset:41984
v_mfma_f32_16x16x32_bf16 v[200:203],v[72:75],a[204:207],v[200:203]
s_waitcnt lgkmcnt(2)
v_mfma_f32_16x16x32_bf16 v[196:199],a[76:79],v[76:79],v[196:199]
ds_read_b128 v[72:75],v20 offset:43008
v_mfma_f32_16x16x32_bf16 v[204:207],v[76:79],a[204:207],v[204:207]
s_waitcnt lgkmcnt(2)
v_mfma_f32_16x16x32_bf16 v[192:195],a[80:83],v[64:67],v[192:195]
ds_read_b128 v[76:79],v20 offset:44032
v_mfma_f32_16x16x32_bf16 v[200:203],v[64:67],a[208:211],v[200:203]
s_waitcnt lgkmcnt(2)
v_mfma_f32_16x16x32_bf16 v[196:199],a[80:83],v[68:71],v[196:199]
ds_read_b128 v[64:67],v20 offset:45056
v_mfma_f32_16x16x32_bf16 v[204:207],v[68:71],a[208:211],v[204:207]
s_waitcnt lgkmcnt(2)
v_mfma_f32_16x16x32_bf16 v[192:195],a[84:87],v[72:75],v[192:195]
ds_read_b128 v[68:71],v20 offset:46080
v_mfma_f32_16x16x32_bf16 v[200:203],v[72:75],a[212:215],v[200:203]
s_waitcnt lgkmcnt(2)
v_mfma_f32_16x16x32_bf16 v[196:199],a[84:87],v[76:79],v[196:199]
ds_read_b128 v[72:75],v20 offset:47104
v_mfma_f32_16x16x32_bf16 v[204:207],v[76:79],a[212:215],v[204:207]
s_waitcnt lgkmcnt(2)
v_mfma_f32_16x16x32_bf16 v[192:195],a[88:91],v[64:67],v[192:195]
ds_read_b128 v[76:79],v20 offset:48128
v_mfma_f32_16x16x32_bf16 v[200:203],v[64:67],a[216:219],v[200:203]
s_waitcnt lgkmcnt(2)
v_mfma_f32_16x16x32_bf16 v[196:199],a[88:91],v[68:71],v[196:199]
ds_read_b128 v[64:67],v20 offset:49152
v_mfma_f32_16x16x32_bf16 v[204:207],v[68:71],a[216:219],v[204:207]
s_waitcnt lgkmcnt(2)
v_mfma_f32_16x16x32_bf16 v[192:195],a[92:95],v[72:75],v[192:195]
ds_read_b128 v[68:71],v20 offset:50176
v_mfma_f32_16x16x32_bf16 v[200:203],v[72:75],a[220:223],v[200:203]
s_waitcnt lgkmcnt(2)
v_mfma_f32_16x16x32_bf16 v[196:199],a[92:95],v[76:79],v[196:199]
ds_read_b128 v[72:75],v20 offset:51200
v_mfma_f32_16x16x32_bf16 v[204:207],v[76:79],a[220:223],v[204:207]
s_waitcnt lgkmcnt(2)
v_mfma_f32_16x16x32_bf16 v[192:195],a[96:99],v[64:67],v[192:195]
ds_read_b128 v[76:79],v20 offset:52224
v_mfma_f32_16x16x32_bf16 v[200:203],v[64:67],a[224:227],v[200:203]
s_waitcnt lgkmcnt(2)
v_mfma_f32_16x16x32_bf16 v[196:199],a[96:99],v[68:71],v[196:199]
ds_read_b128 v[64:67],v20 offset:53248
v_mfma_f32_16x16x32_bf16 v[204:207],v[68:71],a[224:227],v[204:207]
s_waitcnt lgkmcnt(2)
v_mfma_f32_16x16x32_bf16 v[192:195],a[100:103],v[72:75],v[192:195]
ds_read_b128 v[68:71],v20 offset:54272
s_add_u32 m0,s62,32768
s_add_u32 s69,s78,32768
v_mfma_f32_16x16x32_bf16 v[200:203],v[72:75],a[228:231],v[200:203]
s_waitcnt lgkmcnt(2)
v_mfma_f32_16x16x32_bf16 v[196:199],a[100:103],v[76:79],v[196:199]
ds_read_b128 v[72:75],v20 offset:55296
buffer_load_dwordx4 v16,s[20:23],s69 offen offset:0 lds
v_mfma_f32_16x16x32_bf16 v[204:207],v[76:79],a[228:231],v[204:207]
s_waitcnt lgkmcnt(2)
v_mfma_f32_16x16x32_bf16 v[192:195],a[104:107],v[64:67],v[192:195]
ds_read_b128 v[76:79],v20 offset:56320
buffer_load_dwordx4 v16,s[20:23],s69 offen offset:1024 lds
v_mfma_f32_16x16x32_bf16 v[200:203],v[64:67],a[232:235],v[200:203]
s_waitcnt lgkmcnt(2)
v_mfma_f32_16x16x32_bf16 v[196:199],a[104:107],v[68:71],v[196:199]
ds_read_b128 v[64:67],v20 offset:57344
buffer_load_dwordx4 v16,s[20:23],s69 offen offset:2048 lds
v_mfma_f32_16x16x32_bf16 v[204:207],v[68:71],a[232:235],v[204:207]
s_waitcnt lgkmcnt(2)
v_mfma_f32_16x16x32_bf16 v[192:195],a[108:111],v[72:75],v[192:195]
ds_read_b128 v[68:71],v20 offset:58368
buffer_load_dwordx4 v16,s[20:23],s69 offen offset:3072 lds
v_mfma_f32_16x16x32_bf16 v[200:203],v[72:75],a[236:239],v[200:203]
s_waitcnt lgkmcnt(2)
v_mfma_f32_16x16x32_bf16 v[196:199],a[108:111],v[76:79],v[196:199]
ds_read_b128 v[72:75],v20 offset:59392
s_add_u32 m0,s62,36864
s_add_u32 s69,s78,36864
v_mfma_f32_16x16x32_bf16 v[204:207],v[76:79],a[236:239],v[204:207]
s_waitcnt lgkmcnt(2)
v_mfma_f32_16x16x32_bf16 v[192:195],a[112:115],v[64:67],v[192:195]
ds_read_b128 v[76:79],v20 offset:60416
buffer_load_dwordx4 v16,s[20:23],s69 offen offset:0 lds
v_mfma_f32_16x16x32_bf16 v[200:203],v[64:67],a[240:243],v[200:203]
s_waitcnt lgkmcnt(2)
v_mfma_f32_16x16x32_bf16 v[196:199],a[112:115],v[68:71],v[196:199]
ds_read_b128 v[64:67],v20 offset:61440
v_mfma_f32_16x16x32_bf16 v[204:207],v[68:71],a[240:243],v[204:207]
buffer_load_dwordx4 v16,s[20:23],s69 offen offset:1024 lds
s_waitcnt lgkmcnt(2)
v_mfma_f32_16x16x32_bf16 v[192:195],a[116:119],v[72:75],v[192:195]
ds_read_b128 v[68:71],v20 offset:62464
v_mfma_f32_16x16x32_bf16 v[200:203],v[72:75],a[244:247],v[200:203]
buffer_load_dwordx4 v16,s[20:23],s69 offen offset:2048 lds
s_waitcnt lgkmcnt(2)
v_mfma_f32_16x16x32_bf16 v[196:199],a[116:119],v[76:79],v[196:199]
ds_read_b128 v[72:75],v20 offset:63488
v_mfma_f32_16x16x32_bf16 v[204:207],v[76:79],a[244:247],v[204:207]
buffer_load_dwordx4 v16,s[20:23],s69 offen offset:3072 lds
s_waitcnt lgkmcnt(2)
v_mfma_f32_16x16x32_bf16 v[192:195],a[120:123],v[64:67],v[192:195]
ds_read_b128 v[76:79],v20 offset:64512
v_mfma_f32_16x16x32_bf16 v[200:203],v[64:67],a[248:251],v[200:203]
s_add_u32 m0,s62,40960
s_add_u32 s69,s78,40960
s_waitcnt lgkmcnt(2)
v_mfma_f32_16x16x32_bf16 v[196:199],a[120:123],v[68:71],v[196:199]
v_mfma_f32_16x16x32_bf16 v[204:207],v[68:71],a[248:251],v[204:207]
buffer_load_dwordx4 v16,s[20:23],s69 offen offset:0 lds
s_waitcnt lgkmcnt(1)
v_mfma_f32_16x16x32_bf16 v[192:195],a[124:127],v[72:75],v[192:195]
v_mfma_f32_16x16x32_bf16 v[200:203],v[72:75],a[252:255],v[200:203]
buffer_load_dwordx4 v16,s[20:23],s69 offen offset:1024 lds
s_waitcnt lgkmcnt(0)
v_mfma_f32_16x16x32_bf16 v[196:199],a[124:127],v[76:79],v[196:199]
v_mfma_f32_16x16x32_bf16 v[204:207],v[76:79],a[252:255],v[204:207]
v_xor_b32 v20,0x10000,v20
s_xor_b32 s62,s62,0x10000
s_lshr_b32 s64,s73,9
v_add_u32 v22,s64,v24
v_cvt_pk_bf16_f32 v208,v192,v193
v_cvt_pk_bf16_f32 v209,v194,v195
s_nop 0
v_cvt_pk_bf16_f32 v210,v196,v197
v_cvt_pk_bf16_f32 v211,v198,v199
v_cvt_pk_bf16_f32 v212,v200,v201
v_cvt_pk_bf16_f32 v213,v202,v203
v_cvt_pk_bf16_f32 v214,v204,v205
v_cvt_pk_bf16_f32 v215,v206,v207
v_permlane16_swap_b32 v208,v210
v_permlane16_swap_b32 v209,v211
buffer_store_dwordx4 v[208:211],v2,s[24:27],s73 offen
buffer_store_dwordx4 v[208:211],v2,s[28:31],s73 offen sc1
ds_write_b128 v22,v[212:215] offset:16384
buffer_store_dwordx4 v[208:211],v17,s[20:23],s12 offen sc1
bgx_115:
buffer_store_dwordx4 v[100:103],v9,s[24:27],s73 offen
buffer_store_dwordx4 v[100:103],v9,s[28:31],s73 offen sc1
s_mov_b32 exec_hi,0
buffer_store_dwordx4 v[100:103],v8,s[24:27],s73 offen
buffer_store_dwordx4 v[100:103],v8,s[24:27],s71 offen
buffer_store_dwordx4 v[100:103],v8,s[28:31],s73 offen sc1
buffer_store_dwordx4 v[100:103],v8,s[28:31],s71 offen sc1
s_mov_b64 exec,-1
s_waitcnt lgkmcnt(0)
s_add_u32 s63,s79,1
s_and_b32 s64,s63,3
s_lshl_b32 s70,s64,20
s_add_u32 s65,s63,2
s_and_b32 s65,s65,3
s_lshl_b32 s73,s65,20
s_add_u32 s55,s63,3
s_lshl_b32 s78,s55,16
s_add_u32 s78,s78,57344
s_cmp_lt_u32 s55,64
s_cselect_b32 s78,s78,0x7fff0000
s_add_u32 s60,s63,1
s_lshl_b32 s76,s60,21
s_lshl_b32 s55,s60,13
s_and_b32 s55,s55,0x2000
s_xor_b32 s55,s55,s61
s_add_u32 s76,s76,s55
s_cmp_lt_u32 s60,64
s_cselect_b32 s76,s76,0x7fff0000
s_add_u32 s60,s63,2
s_lshl_b32 s12,s60,21
s_lshl_b32 s55,s60,13
s_and_b32 s55,s55,0x2000
s_xor_b32 s55,s55,s61
s_add_u32 s12,s12,s55
s_cmp_lt_u32 s60,64
s_cselect_b32 s12,s12,0x7fff0000
s_add_u32 s71,s73,65536
v_mov_b32 v176,0
v_mov_b32 v177,0
v_mov_b32 v178,0
v_mov_b32 v179,0
v_mov_b32 v180,0
v_mov_b32 v181,0
v_mov_b32 v182,0
v_mov_b32 v183,0
s_add_u32 s79,s79,1
v_add_u32 v25,1,v25
s_waitcnt vmcnt(0)
s_branch loop_109
art_113:
s_sub_u32 s90,s90,1
s_cmp_lt_i32 s90,0
s_cbranch_scc1 abk_114
buffer_load_dwordx4 v[48:51],v27,s[20:23],s70 offen offset:0 sc1
buffer_load_dwordx4 v[52:55],v27,s[20:23],s70 offen offset:1024 sc1
buffer_load_dwordx4 v[56:59],v27,s[20:23],s70 offen offset:2048 sc1
buffer_load_dwordx4 v[60:63],v27,s[20:23],s70 offen offset:3072 sc1
s_waitcnt vmcnt(3)
ds_write_b128 v24,v[48:51] offset:4096
v_min3_u32 v22,v48,v49,v50
v_min_u32 v22,v22,v51
s_waitcnt vmcnt(2)
ds_write_b128 v24,v[52:55] offset:5120
v_min3_u32 v22,v22,v52,v53
v_min3_u32 v22,v22,v54,v55
s_waitcnt vmcnt(1)
ds_write_b128 v24,v[56:59] offset:6144
v_min3_u32 v22,v22,v56,v57
v_min3_u32 v22,v22,v58,v59
s_waitcnt vmcnt(0)
ds_write_b128 v24,v[60:63] offset:7168
v_min3_u32 v22,v22,v60,v61
v_min3_u32 v22,v22,v62,v63
v_cmp_eq_u32 vcc,0,v22
s_cbranch_vccnz art_113
s_branch abk_114
first_108:
s_add_u32 s63,s79,0
s_and_b32 s64,s63,3
s_lshl_b32 s70,s64,20
s_add_u32 s65,s63,2
s_and_b32 s65,s65,3
s_lshl_b32 s73,s65,20
s_add_u32 s55,s63,3
s_lshl_b32 s78,s55,16
s_add_u32 s78,s78,57344
s_cmp_lt_u32 s55,64
s_cselect_b32 s78,s78,0x7fff0000
s_add_u32 s60,s63,1
s_lshl_b32 s76,s60,21
s_lshl_b32 s55,s60,13
s_and_b32 s55,s55,0x2000
s_xor_b32 s55,s55,s61
s_add_u32 s76,s76,s55
s_cmp_lt_u32 s60,64
s_cselect_b32 s76,s76,0x7fff0000
s_add_u32 s60,s63,2
s_lshl_b32 s12,s60,21
s_lshl_b32 s55,s60,13
s_and_b32 s55,s55,0x2000
s_xor_b32 s55,s55,s61
s_add_u32 s12,s12,s55
s_cmp_lt_u32 s60,64
s_cselect_b32 s12,s12,0x7fff0000
s_add_u32 s71,s73,65536
v_mov_b32 v176,0
v_mov_b32 v177,0
v_mov_b32 v178,0
v_mov_b32 v179,0
v_mov_b32 v180,0
v_mov_b32 v181,0
v_mov_b32 v182,0
v_mov_b32 v183,0
s_waitcnt vmcnt(0) lgkmcnt(0)
pn1_116:
s_barrier
ds_read_b128 v[64:67],v20 offset:0
ds_read_b128 v[68:71],v20 offset:1024
ds_read_b128 v[72:75],v20 offset:2048
s_waitcnt lgkmcnt(2)
v_mfma_f32_16x16x32_bf16 v[192:195],a[0:3],v[64:67],0
ds_read_b128 v[76:79],v20 offset:3072
v_mfma_f32_16x16x32_bf16 v[200:203],v[64:67],a[128:131],0
s_waitcnt lgkmcnt(2)
v_mfma_f32_16x16x32_bf16 v[196:199],a[0:3],v[68:71],0
ds_read_b128 v[64:67],v20 offset:4096
v_mfma_f32_16x16x32_bf16 v[204:207],v[68:71],a[128:131],0
s_waitcnt lgkmcnt(2)
v_mfma_f32_16x16x32_bf16 v[192:195],a[4:7],v[72:75],v[192:195]
ds_read_b128 v[68:71],v20 offset:5120
v_mfma_f32_16x16x32_bf16 v[200:203],v[72:75],a[132:135],v[200:203]
s_waitcnt lgkmcnt(2)
v_mfma_f32_16x16x32_bf16 v[196:199],a[4:7],v[76:79],v[196:199]
ds_read_b128 v[72:75],v20 offset:6144
v_mfma_f32_16x16x32_bf16 v[204:207],v[76:79],a[132:135],v[204:207]
s_waitcnt lgkmcnt(2)
v_mfma_f32_16x16x32_bf16 v[192:195],a[8:11],v[64:67],v[192:195]
ds_read_b128 v[76:79],v20 offset:7168
v_mfma_f32_16x16x32_bf16 v[200:203],v[64:67],a[136:139],v[200:203]
s_waitcnt lgkmcnt(2)
v_mfma_f32_16x16x32_bf16 v[196:199],a[8:11],v[68:71],v[196:199]
ds_read_b128 v[64:67],v20 offset:8192
v_mfma_f32_16x16x32_bf16 v[204:207],v[68:71],a[136:139],v[204:207]
s_waitcnt lgkmcnt(2)
v_mfma_f32_16x16x32_bf16 v[192:195],a[12:15],v[72:75],v[192:195]
ds_read_b128 v[68:71],v20 offset:9216
v_mfma_f32_16x16x32_bf16 v[200:203],v[72:75],a[140:143],v[200:203]
s_waitcnt lgkmcnt(2)
v_mfma_f32_16x16x32_bf16 v[196:199],a[12:15],v[76:79],v[196:199]
ds_read_b128 v[72:75],v20 offset:10240
v_mfma_f32_16x16x32_bf16 v[204:207],v[76:79],a[140:143],v[204:207]
s_waitcnt lgkmcnt(2)
v_mfma_f32_16x16x32_bf16 v[192:195],a[16:19],v[64:67],v[192:195]
ds_read_b128 v[76:79],v20 offset:11264
v_mfma_f32_16x16x32_bf16 v[200:203],v[64:67],a[144:147],v[200:203]
s_waitcnt lgkmcnt(2)
v_mfma_f32_16x16x32_bf16 v[196:199],a[16:19],v[68:71],v[196:199]
ds_read_b128 v[64:67],v20 offset:12288
v_mfma_f32_16x16x32_bf16 v[204:207],v[68:71],a[144:147],v[204:207]
s_waitcnt lgkmcnt(2)
v_mfma_f32_16x16x32_bf16 v[192:195],a[20:23],v[72:75],v[192:195]
ds_read_b128 v[68:71],v20 offset:13312
v_mfma_f32_16x16x32_bf16 v[200:203],v[72:75],a[148:151],v[200:203]
s_waitcnt lgkmcnt(2)
v_mfma_f32_16x16x32_bf16 v[196:199],a[20:23],v[76:79],v[196:199]
ds_read_b128 v[72:75],v20 offset:14336
v_mfma_f32_16x16x32_bf16 v[204:207],v[76:79],a[148:151],v[204:207]
s_waitcnt lgkmcnt(2)
v_mfma_f32_16x16x32_bf16 v[192:195],a[24:27],v[64:67],v[192:195]
ds_read_b128 v[76:79],v20 offset:15360
v_mfma_f32_16x16x32_bf16 v[200:203],v[64:67],a[152:155],v[200:203]
s_waitcnt lgkmcnt(2)
v_mfma_f32_16x16x32_bf16 v[196:199],a[24:27],v[68:71],v[196:199]
ds_read_b128 v[64:67],v20 offset:16384
v_mfma_f32_16x16x32_bf16 v[204:207],v[68:71],a[152:155],v[204:207]
s_waitcnt lgkmcnt(2)
v_mfma_f32_16x16x32_bf16 v[192:195],a[28:31],v[72:75],v[192:195]
ds_read_b128 v[68:71],v20 offset:17408
v_mfma_f32_16x16x32_bf16 v[200:203],v[72:75],a[156:159],v[200:203]
s_waitcnt lgkmcnt(2)
v_mfma_f32_16x16x32_bf16 v[196:199],a[28:31],v[76:79],v[196:199]
ds_read_b128 v[72:75],v20 offset:18432
v_mfma_f32_16x16x32_bf16 v[204:207],v[76:79],a[156:159],v[204:207]
s_waitcnt lgkmcnt(2)
v_mfma_f32_16x16x32_bf16 v[192:195],a[32:35],v[64:67],v[192:195]
ds_read_b128 v[76:79],v20 offset:19456
v_mfma_f32_16x16x32_bf16 v[200:203],v[64:67],a[160:163],v[200:203]
s_waitcnt lgkmcnt(2)
v_mfma_f32_16x16x32_bf16 v[196:199],a[32:35],v[68:71],v[196:199]
ds_read_b128 v[64:67],v20 offset:20480
v_mfma_f32_16x16x32_bf16 v[204:207],v[68:71],a[160:163],v[204:207]
s_waitcnt lgkmcnt(2)
v_mfma_f32_16x16x32_bf16 v[192:195],a[36:39],v[72:75],v[192:195]
ds_read_b128 v[68:71],v20 offset:21504
v_mfma_f32_16x16x32_bf16 v[200:203],v[72:75],a[164:167],v[200:203]
s_waitcnt lgkmcnt(2)
v_mfma_f32_16x16x32_bf16 v[196:199],a[36:39],v[76:79],v[196:199]
ds_read_b128 v[72:75],v20 offset:22528
v_mfma_f32_16x16x32_bf16 v[204:207],v[76:79],a[164:167],v[204:207]
s_waitcnt lgkmcnt(2)
v_mfma_f32_16x16x32_bf16 v[192:195],a[40:43],v[64:67],v[192:195]
ds_read_b128 v[76:79],v20 offset:23552
v_mfma_f32_16x16x32_bf16 v[200:203],v[64:67],a[168:171],v[200:203]
s_waitcnt lgkmcnt(2)
v_mfma_f32_16x16x32_bf16 v[196:199],a[40:43],v[68:71],v[196:199]
ds_read_b128 v[64:67],v20 offset:24576
v_mfma_f32_16x16x32_bf16 v[204:207],v[68:71],a[168:171],v[204:207]
s_waitcnt lgkmcnt(2)
v_mfma_f32_16x16x32_bf16 v[192:195],a[44:47],v[72:75],v[192:195]
ds_read_b128 v[68:71],v20 offset:25600
v_mfma_f32_16x16x32_bf16 v[200:203],v[72:75],a[172:175],v[200:203]
s_waitcnt lgkmcnt(2)
v_mfma_f32_16x16x32_bf16 v[196:199],a[44:47],v[76:79],v[196:199]
ds_read_b128 v[72:75],v20 offset:26624
v_mfma_f32_16x16x32_bf16 v[204:207],v[76:79],a[172:175],v[204:207]
s_waitcnt lgkmcnt(2)
v_mfma_f32_16x16x32_bf16 v[192:195],a[48:51],v[64:67],v[192:195]
ds_read_b128 v[76:79],v20 offset:27648
v_mfma_f32_16x16x32_bf16 v[200:203],v[64:67],a[176:179],v[200:203]
s_waitcnt lgkmcnt(2)
v_mfma_f32_16x16x32_bf16 v[196:199],a[48:51],v[68:71],v[196:199]
ds_read_b128 v[64:67],v20 offset:28672
v_mfma_f32_16x16x32_bf16 v[204:207],v[68:71],a[176:179],v[204:207]
s_waitcnt lgkmcnt(2)
v_mfma_f32_16x16x32_bf16 v[192:195],a[52:55],v[72:75],v[192:195]
ds_read_b128 v[68:71],v20 offset:29696
v_mfma_f32_16x16x32_bf16 v[200:203],v[72:75],a[180:183],v[200:203]
s_waitcnt lgkmcnt(2)
v_mfma_f32_16x16x32_bf16 v[196:199],a[52:55],v[76:79],v[196:199]
ds_read_b128 v[72:75],v20 offset:30720
v_mfma_f32_16x16x32_bf16 v[204:207],v[76:79],a[180:183],v[204:207]
s_waitcnt lgkmcnt(2)
v_mfma_f32_16x16x32_bf16 v[192:195],a[56:59],v[64:67],v[192:195]
ds_read_b128 v[76:79],v20 offset:31744
v_mfma_f32_16x16x32_bf16 v[200:203],v[64:67],a[184:187],v[200:203]
s_waitcnt lgkmcnt(2)
v_mfma_f32_16x16x32_bf16 v[196:199],a[56:59],v[68:71],v[196:199]
ds_read_b128 v[64:67],v20 offset:32768
v_mfma_f32_16x16x32_bf16 v[204:207],v[68:71],a[184:187],v[204:207]
s_waitcnt lgkmcnt(2)
v_mfma_f32_16x16x32_bf16 v[192:195],a[60:63],v[72:75],v[192:195]
ds_read_b128 v[68:71],v20 offset:33792
v_mfma_f32_16x16x32_bf16 v[200:203],v[72:75],a[188:191],v[200:203]
s_waitcnt lgkmcnt(2)
v_mfma_f32_16x16x32_bf16 v[196:199],a[60:63],v[76:79],v[196:199]
ds_read_b128 v[72:75],v20 offset:34816
v_mfma_f32_16x16x32_bf16 v[204:207],v[76:79],a[188:191],v[204:207]
s_waitcnt lgkmcnt(2)
v_mfma_f32_16x16x32_bf16 v[192:195],a[64:67],v[64:67],v[192:195]
ds_read_b128 v[76:79],v20 offset:35840
v_mfma_f32_16x16x32_bf16 v[200:203],v[64:67],a[192:195],v[200:203]
s_waitcnt lgkmcnt(2)
v_mfma_f32_16x16x32_bf16 v[196:199],a[64:67],v[68:71],v[196:199]
ds_read_b128 v[64:67],v20 offset:36864
v_mfma_f32_16x16x32_bf16 v[204:207],v[68:71],a[192:195],v[204:207]
s_waitcnt lgkmcnt(2)
v_mfma_f32_16x16x32_bf16 v[192:195],a[68:71],v[72:75],v[192:195]
ds_read_b128 v[68:71],v20 offset:37888
v_mfma_f32_16x16x32_bf16 v[200:203],v[72:75],a[196:199],v[200:203]
s_waitcnt lgkmcnt(2)
v_mfma_f32_16x16x32_bf16 v[196:199],a[68:71],v[76:79],v[196:199]
ds_read_b128 v[72:75],v20 offset:38912
v_mfma_f32_16x16x32_bf16 v[204:207],v[76:79],a[196:199],v[204:207]
s_waitcnt lgkmcnt(2)
v_mfma_f32_16x16x32_bf16 v[192:195],a[72:75],v[64:67],v[192:195]
ds_read_b128 v[76:79],v20 offset:39936
v_mfma_f32_16x16x32_bf16 v[200:203],v[64:67],a[200:203],v[200:203]
s_waitcnt lgkmcnt(2)
v_mfma_f32_16x16x32_bf16 v[196:199],a[72:75],v[68:71],v[196:199]
ds_read_b128 v[64:67],v20 offset:40960
v_mfma_f32_16x16x32_bf16 v[204:207],v[68:71],a[200:203],v[204:207]
s_waitcnt lgkmcnt(2)
v_mfma_f32_16x16x32_bf16 v[192:195],a[76:79],v[72:75],v[192:195]
ds_read_b128 v[68:71],v20 offset:41984
v_mfma_f32_16x16x32_bf16 v[200:203],v[72:75],a[204:207],v[200:203]
s_waitcnt lgkmcnt(2)
v_mfma_f32_16x16x32_bf16 v[196:199],a[76:79],v[76:79],v[196:199]
ds_read_b128 v[72:75],v20 offset:43008
v_mfma_f32_16x16x32_bf16 v[204:207],v[76:79],a[204:207],v[204:207]
s_waitcnt lgkmcnt(2)
v_mfma_f32_16x16x32_bf16 v[192:195],a[80:83],v[64:67],v[192:195]
ds_read_b128 v[76:79],v20 offset:44032
v_mfma_f32_16x16x32_bf16 v[200:203],v[64:67],a[208:211],v[200:203]
s_waitcnt lgkmcnt(2)
v_mfma_f32_16x16x32_bf16 v[196:199],a[80:83],v[68:71],v[196:199]
ds_read_b128 v[64:67],v20 offset:45056
v_mfma_f32_16x16x32_bf16 v[204:207],v[68:71],a[208:211],v[204:207]
s_waitcnt lgkmcnt(2)
v_mfma_f32_16x16x32_bf16 v[192:195],a[84:87],v[72:75],v[192:195]
ds_read_b128 v[68:71],v20 offset:46080
v_mfma_f32_16x16x32_bf16 v[200:203],v[72:75],a[212:215],v[200:203]
s_waitcnt lgkmcnt(2)
v_mfma_f32_16x16x32_bf16 v[196:199],a[84:87],v[76:79],v[196:199]
ds_read_b128 v[72:75],v20 offset:47104
v_mfma_f32_16x16x32_bf16 v[204:207],v[76:79],a[212:215],v[204:207]
s_waitcnt lgkmcnt(2)
v_mfma_f32_16x16x32_bf16 v[192:195],a[88:91],v[64:67],v[192:195]
ds_read_b128 v[76:79],v20 offset:48128
v_mfma_f32_16x16x32_bf16 v[200:203],v[64:67],a[216:219],v[200:203]
s_waitcnt lgkmcnt(2)
v_mfma_f32_16x16x32_bf16 v[196:199],a[88:91],v[68:71],v[196:199]
ds_read_b128 v[64:67],v20 offset:49152
v_mfma_f32_16x16x32_bf16 v[204:207],v[68:71],a[216:219],v[204:207]
s_waitcnt lgkmcnt(2)
v_mfma_f32_16x16x32_bf16 v[192:195],a[92:95],v[72:75],v[192:195]
ds_read_b128 v[68:71],v20 offset:50176
v_mfma_f32_16x16x32_bf16 v[200:203],v[72:75],a[220:223],v[200:203]
s_waitcnt lgkmcnt(2)
v_mfma_f32_16x16x32_bf16 v[196:199],a[92:95],v[76:79],v[196:199]
ds_read_b128 v[72:75],v20 offset:51200
v_mfma_f32_16x16x32_bf16 v[204:207],v[76:79],a[220:223],v[204:207]
s_waitcnt lgkmcnt(2)
v_mfma_f32_16x16x32_bf16 v[192:195],a[96:99],v[64:67],v[192:195]
ds_read_b128 v[76:79],v20 offset:52224
v_mfma_f32_16x16x32_bf16 v[200:203],v[64:67],a[224:227],v[200:203]
s_waitcnt lgkmcnt(2)
v_mfma_f32_16x16x32_bf16 v[196:199],a[96:99],v[68:71],v[196:199]
ds_read_b128 v[64:67],v20 offset:53248
v_mfma_f32_16x16x32_bf16 v[204:207],v[68:71],a[224:227],v[204:207]
s_waitcnt lgkmcnt(2)
v_mfma_f32_16x16x32_bf16 v[192:195],a[100:103],v[72:75],v[192:195]
ds_read_b128 v[68:71],v20 offset:54272
v_mfma_f32_16x16x32_bf16 v[200:203],v[72:75],a[228:231],v[200:203]
s_waitcnt lgkmcnt(2)
v_mfma_f32_16x16x32_bf16 v[196:199],a[100:103],v[76:79],v[196:199]
ds_read_b128 v[72:75],v20 offset:55296
v_mfma_f32_16x16x32_bf16 v[204:207],v[76:79],a[228:231],v[204:207]
s_waitcnt lgkmcnt(2)
v_mfma_f32_16x16x32_bf16 v[192:195],a[104:107],v[64:67],v[192:195]
ds_read_b128 v[76:79],v20 offset:56320
v_mfma_f32_16x16x32_bf16 v[200:203],v[64:67],a[232:235],v[200:203]
s_waitcnt lgkmcnt(2)
v_mfma_f32_16x16x32_bf16 v[196:199],a[104:107],v[68:71],v[196:199]
ds_read_b128 v[64:67],v20 offset:57344
v_mfma_f32_16x16x32_bf16 v[204:207],v[68:71],a[232:235],v[204:207]
s_waitcnt lgkmcnt(2)
v_mfma_f32_16x16x32_bf16 v[192:195],a[108:111],v[72:75],v[192:195]
ds_read_b128 v[68:71],v20 offset:58368
v_mfma_f32_16x16x32_bf16 v[200:203],v[72:75],a[236:239],v[200:203]
s_waitcnt lgkmcnt(2)
v_mfma_f32_16x16x32_bf16 v[196:199],a[108:111],v[76:79],v[196:199]
ds_read_b128 v[72:75],v20 offset:59392
v_mfma_f32_16x16x32_bf16 v[204:207],v[76:79],a[236:239],v[204:207]
s_waitcnt lgkmcnt(2)
v_mfma_f32_16x16x32_bf16 v[192:195],a[112:115],v[64:67],v[192:195]
ds_read_b128 v[76:79],v20 offset:60416
v_mfma_f32_16x16x32_bf16 v[200:203],v[64:67],a[240:243],v[200:203]
s_waitcnt lgkmcnt(2)
v_mfma_f32_16x16x32_bf16 v[196:199],a[112:115],v[68:71],v[196:199]
ds_read_b128 v[64:67],v20 offset:61440
v_mfma_f32_16x16x32_bf16 v[204:207],v[68:71],a[240:243],v[204:207]
s_waitcnt lgkmcnt(2)
v_mfma_f32_16x16x32_bf16 v[192:195],a[116:119],v[72:75],v[192:195]
ds_read_b128 v[68:71],v20 offset:62464
v_mfma_f32_16x16x32_bf16 v[200:203],v[72:75],a[244:247],v[200:203]
s_waitcnt lgkmcnt(2)
v_mfma_f32_16x16x32_bf16 v[196:199],a[116:119],v[76:79],v[196:199]
ds_read_b128 v[72:75],v20 offset:63488
v_mfma_f32_16x16x32_bf16 v[204:207],v[76:79],a[244:247],v[204:207]
s_waitcnt lgkmcnt(2)
v_mfma_f32_16x16x32_bf16 v[192:195],a[120:123],v[64:67],v[192:195]
ds_read_b128 v[76:79],v20 offset:64512
v_mfma_f32_16x16x32_bf16 v[200:203],v[64:67],a[248:251],v[200:203]
s_waitcnt lgkmcnt(2)
v_mfma_f32_16x16x32_bf16 v[196:199],a[120:123],v[68:71],v[196:199]
v_mfma_f32_16x16x32_bf16 v[204:207],v[68:71],a[248:251],v[204:207]
s_waitcnt lgkmcnt(1)
v_mfma_f32_16x16x32_bf16 v[192:195],a[124:127],v[72:75],v[192:195]
v_mfma_f32_16x16x32_bf16 v[200:203],v[72:75],a[252:255],v[200:203]
s_waitcnt lgkmcnt(0)
v_mfma_f32_16x16x32_bf16 v[196:199],a[124:127],v[76:79],v[196:199]
v_mfma_f32_16x16x32_bf16 v[204:207],v[76:79],a[252:255],v[204:207]
v_xor_b32 v20,0x10000,v20
s_xor_b32 s62,s62,0x10000
s_lshr_b32 s64,s73,9
v_add_u32 v22,s64,v24
v_cvt_pk_bf16_f32 v208,v192,v193
v_cvt_pk_bf16_f32 v209,v194,v195
s_nop 0
v_cvt_pk_bf16_f32 v210,v196,v197
v_cvt_pk_bf16_f32 v211,v198,v199
v_cvt_pk_bf16_f32 v212,v200,v201
v_cvt_pk_bf16_f32 v213,v202,v203
v_cvt_pk_bf16_f32 v214,v204,v205
v_cvt_pk_bf16_f32 v215,v206,v207
v_permlane16_swap_b32 v208,v210
v_permlane16_swap_b32 v209,v211
buffer_store_dwordx4 v[208:211],v2,s[24:27],s73 offen
buffer_store_dwordx4 v[208:211],v2,s[28:31],s73 offen sc1
ds_write_b128 v22,v[212:215] offset:16384
buffer_store_dwordx4 v[208:211],v17,s[20:23],s12 offen sc1
bgx_118:
s_add_u32 s63,s79,1
s_and_b32 s64,s63,3
s_lshl_b32 s70,s64,20
s_add_u32 s65,s63,2
s_and_b32 s65,s65,3
s_lshl_b32 s73,s65,20
s_add_u32 s55,s63,3
s_lshl_b32 s78,s55,16
s_add_u32 s78,s78,57344
s_cmp_lt_u32 s55,64
s_cselect_b32 s78,s78,0x7fff0000
s_add_u32 s60,s63,1
s_lshl_b32 s76,s60,21
s_lshl_b32 s55,s60,13
s_and_b32 s55,s55,0x2000
s_xor_b32 s55,s55,s61
s_add_u32 s76,s76,s55
s_cmp_lt_u32 s60,64
s_cselect_b32 s76,s76,0x7fff0000
s_add_u32 s60,s63,2
s_lshl_b32 s12,s60,21
s_lshl_b32 s55,s60,13
s_and_b32 s55,s55,0x2000
s_xor_b32 s55,s55,s61
s_add_u32 s12,s12,s55
s_cmp_lt_u32 s60,64
s_cselect_b32 s12,s12,0x7fff0000
s_add_u32 s71,s73,65536
v_mov_b32 v176,0
v_mov_b32 v177,0
v_mov_b32 v178,0
v_mov_b32 v179,0
v_mov_b32 v180,0
v_mov_b32 v181,0
v_mov_b32 v182,0
v_mov_b32 v183,0
s_add_u32 s79,s79,1
s_cmp_eq_u32 s79,0
s_cbranch_scc1 pn2_117
buffer_store_dwordx4 v[212:215],v12,s[20:23],s76 offen sc1
s_waitcnt lgkmcnt(0)
s_branch pn1_116
pn2_117:
v_mov_b32 v25,1
s_waitcnt vmcnt(1) lgkmcnt(0)
s_barrier
s_branch loop_109
w2_61:
s_lshr_b32 s64,s57,2
s_add_u32 s64,s64,64
s_lshl_b32 s64,s64,14
s_add_u32 s64,s64,s68
s_add_u32 s64,s64,29361152
v_add_u32 v12,s64,v16
v_and_b32 v22,1,v4
v_lshrrev_b32 v23,1,v4
v_lshl_add_u32 v22,v22,1,v23
v_lshlrev_b32 v22,2,v22
v_lshl_add_u32 v22,v3,4,v22
v_add_u32 v31,155904,v22
s_branch first_119
loop_120:
s_barrier
buffer_load_dword v248,v18,s[20:23],s70 offen offset:0 sc1
s_nop 15
s_nop 5
hl_122:
buffer_load_dword v249,v18,s[20:23],s70 offen offset:0 sc1
s_waitcnt vmcnt(1)
v_cmp_eq_u32 vcc,v25,v248
s_bcnt1_i32_b32 s64,vcc_lo
s_cmp_ge_u32 s64,8
s_cbranch_scc1 hg_123
buffer_load_dword v248,v18,s[20:23],s70 offen offset:0 sc1
s_waitcnt vmcnt(1)
v_cmp_eq_u32 vcc,v25,v249
s_bcnt1_i32_b32 s64,vcc_lo
s_cmp_ge_u32 s64,8
s_cbranch_scc1 hg_123
s_sub_u32 s90,s90,1
s_cmp_gt_i32 s90,0
s_cbranch_scc1 hl_122
hg_123:
buffer_load_dwordx4 v[64:67],v28,s[20:23],s70 offen offset:0 sc1
buffer_load_dwordx4 v[68:71],v28,s[20:23],s70 offen offset:1024 sc1
buffer_load_dwordx4 v[72:75],v28,s[20:23],s70 offen offset:2048 sc1
buffer_load_dwordx4 v[76:79],v28,s[20:23],s70 offen offset:3072 sc1
s_waitcnt vmcnt(3)
ds_write_b128 v24,v[64:67] offset:8192
v_min3_u32 v22,v64,v65,v66
v_min_u32 v22,v22,v67
s_waitcnt vmcnt(2)
ds_write_b128 v24,v[68:71] offset:9216
v_min3_u32 v22,v22,v68,v69
v_min3_u32 v22,v22,v70,v71
s_waitcnt vmcnt(1)
ds_write_b128 v24,v[72:75] offset:10240
v_min3_u32 v22,v22,v72,v73
v_min3_u32 v22,v22,v74,v75
s_waitcnt vmcnt(0)
ds_write_b128 v24,v[76:79] offset:11264
v_min3_u32 v22,v22,v76,v77
v_min3_u32 v22,v22,v78,v79
v_cmp_eq_u32 vcc,0,v22
s_cbranch_vccnz art_124
abk_125:
v_smfmac_f32_16x16x64_bf16 v[176:179],v[64:67],a[64:71],v14
s_waitcnt lgkmcnt(0)
s_barrier
ds_read_b128 v[80:83],v24 offset:12288
ds_read_b128 v[84:87],v24 offset:13312
ds_read_b128 v[88:91],v24 offset:14336
ds_read_b128 v[92:95],v24 offset:15360
buffer_store_dwordx4 v[212:215],v12,s[20:23],s76 offen sc1
v_smfmac_f32_16x16x64_bf16 v[176:179],v[68:71],a[72:79],v14
ds_read_b128 v[32:35],v24 offset:0
ds_read_b128 v[36:39],v24 offset:1024
v_smfmac_f32_16x16x64_bf16 v[176:179],v[72:75],a[80:87],v14
ds_read_b128 v[40:43],v24 offset:2048
ds_read_b128 v[44:47],v24 offset:3072
v_smfmac_f32_16x16x64_bf16 v[176:179],v[76:79],a[88:95],v14
ds_read_b128 v[48:51],v24 offset:4096
ds_read_b128 v[52:55],v24 offset:5120
s_waitcnt lgkmcnt(9)
v_smfmac_f32_16x16x64_bf16 v[176:179],v[80:83],a[96:103],v14
ds_read_b128 v[56:59],v24 offset:6144
s_waitcnt lgkmcnt(9)
v_smfmac_f32_16x16x64_bf16 v[176:179],v[84:87],a[104:111],v14
ds_read_b128 v[60:63],v24 offset:7168
s_waitcnt lgkmcnt(9)
v_smfmac_f32_16x16x64_bf16 v[176:179],v[88:91],a[112:119],v14
s_waitcnt lgkmcnt(8)
v_smfmac_f32_16x16x64_bf16 v[176:179],v[92:95],a[120:127],v14
s_waitcnt lgkmcnt(7)
v_smfmac_f32_16x16x64_bf16 v[176:179],v[32:35],a[0:7],v14
s_waitcnt lgkmcnt(6)
v_smfmac_f32_16x16x64_bf16 v[176:179],v[36:39],a[8:15],v14
s_waitcnt lgkmcnt(5)
v_smfmac_f32_16x16x64_bf16 v[176:179],v[40:43],a[16:23],v14
s_waitcnt lgkmcnt(4)
v_smfmac_f32_16x16x64_bf16 v[176:179],v[44:47],a[24:31],v14
s_waitcnt lgkmcnt(3)
v_smfmac_f32_16x16x64_bf16 v[176:179],v[48:51],a[32:39],v14
s_waitcnt lgkmcnt(2)
v_smfmac_f32_16x16x64_bf16 v[176:179],v[52:55],a[40:47],v14
s_waitcnt lgkmcnt(1)
v_smfmac_f32_16x16x64_bf16 v[176:179],v[56:59],a[48:55],v14
s_waitcnt lgkmcnt(0)
v_smfmac_f32_16x16x64_bf16 v[176:179],v[60:63],a[56:63],v14
v_smfmac_f32_16x16x64_bf16 v[180:183],v[32:35],a[128:135],v14
v_smfmac_f32_16x16x64_bf16 v[180:183],v[36:39],a[136:143],v14
s_nop 5
v_permlane32_swap_b32 v176,v178
v_permlane32_swap_b32 v177,v179
v_add_f32 v176,v176,v178
v_add_f32 v177,v177,v179
v_cvt_pk_bf16_f32 v216,v176,v177
s_nop 1
v_mov_b32_dpp v217,v216 quad_perm:[1,0,3,2] row_mask:0xf bank_mask:0xf
v_perm_b32 v216,v217,v216,v15
v_max_u32 v216,1,v216
buffer_store_dword v216,v19,s[24:27],s70 offen
buffer_store_dword v216,v19,s[28:31],s70 offen sc1
v_smfmac_f32_16x16x64_bf16 v[180:183],v[40:43],a[144:151],v14
v_smfmac_f32_16x16x64_bf16 v[180:183],v[44:47],a[152:159],v14
v_smfmac_f32_16x16x64_bf16 v[180:183],v[48:51],a[160:167],v14
v_smfmac_f32_16x16x64_bf16 v[180:183],v[52:55],a[168:175],v14
v_smfmac_f32_16x16x64_bf16 v[180:183],v[56:59],a[176:183],v14
v_smfmac_f32_16x16x64_bf16 v[180:183],v[60:63],a[184:191],v14
v_smfmac_f32_16x16x64_bf16 v[180:183],v[64:67],a[192:199],v14
v_smfmac_f32_16x16x64_bf16 v[180:183],v[68:71],a[200:207],v14
v_smfmac_f32_16x16x64_bf16 v[180:183],v[72:75],a[208:215],v14
v_smfmac_f32_16x16x64_bf16 v[180:183],v[76:79],a[216:223],v14
v_smfmac_f32_16x16x64_bf16 v[180:183],v[80:83],a[224:231],v14
v_smfmac_f32_16x16x64_bf16 v[180:183],v[84:87],a[232:239],v14
v_smfmac_f32_16x16x64_bf16 v[180:183],v[88:91],a[240:247],v14
v_smfmac_f32_16x16x64_bf16 v[180:183],v[92:95],a[248:255],v14
s_nop 7
v_permlane32_swap_b32 v180,v182
v_permlane32_swap_b32 v181,v183
v_add_f32 v180,v180,v182
v_add_f32 v181,v181,v183
v_cvt_pk_bf16_f32 v216,v180,v181
v_max_u32 v216,1,v216
ds_write_b32 v31,v216
ds_write_b32 v21,v25 offset:4
s_cmp_eq_u32 s79,63
s_cbranch_scc1 end_58
s_cmp_ge_i32 s79,62
s_cbranch_scc1 bgx_126
ds_read_b128 v[64:67],v20 offset:0
ds_read_b128 v[68:71],v20 offset:1024
ds_read_b128 v[72:75],v20 offset:2048
s_waitcnt lgkmcnt(2)
v_mfma_f32_16x16x32_bf16 v[192:195],a[0:3],v[64:67],0
ds_read_b128 v[76:79],v20 offset:3072
v_mfma_f32_16x16x32_bf16 v[200:203],v[64:67],a[128:131],0
s_waitcnt lgkmcnt(2)
v_mfma_f32_16x16x32_bf16 v[196:199],a[0:3],v[68:71],0
ds_read_b128 v[64:67],v20 offset:4096
v_mfma_f32_16x16x32_bf16 v[204:207],v[68:71],a[128:131],0
s_waitcnt lgkmcnt(2)
v_mfma_f32_16x16x32_bf16 v[192:195],a[4:7],v[72:75],v[192:195]
ds_read_b128 v[68:71],v20 offset:5120
v_mfma_f32_16x16x32_bf16 v[200:203],v[72:75],a[132:135],v[200:203]
s_waitcnt lgkmcnt(2)
v_mfma_f32_16x16x32_bf16 v[196:199],a[4:7],v[76:79],v[196:199]
ds_read_b128 v[72:75],v20 offset:6144
v_mfma_f32_16x16x32_bf16 v[204:207],v[76:79],a[132:135],v[204:207]
s_waitcnt lgkmcnt(2)
v_mfma_f32_16x16x32_bf16 v[192:195],a[8:11],v[64:67],v[192:195]
ds_read_b128 v[76:79],v20 offset:7168
v_mfma_f32_16x16x32_bf16 v[200:203],v[64:67],a[136:139],v[200:203]
s_waitcnt lgkmcnt(2)
v_mfma_f32_16x16x32_bf16 v[196:199],a[8:11],v[68:71],v[196:199]
ds_read_b128 v[64:67],v20 offset:8192
v_mfma_f32_16x16x32_bf16 v[204:207],v[68:71],a[136:139],v[204:207]
s_waitcnt lgkmcnt(2)
v_mfma_f32_16x16x32_bf16 v[192:195],a[12:15],v[72:75],v[192:195]
ds_read_b128 v[68:71],v20 offset:9216
v_mfma_f32_16x16x32_bf16 v[200:203],v[72:75],a[140:143],v[200:203]
s_waitcnt lgkmcnt(2)
v_mfma_f32_16x16x32_bf16 v[196:199],a[12:15],v[76:79],v[196:199]
ds_read_b128 v[72:75],v20 offset:10240
v_mfma_f32_16x16x32_bf16 v[204:207],v[76:79],a[140:143],v[204:207]
s_add_u32 m0,s62,16384
s_add_u32 s69,s78,16384
s_waitcnt lgkmcnt(2)
v_mfma_f32_16x16x32_bf16 v[192:195],a[16:19],v[64:67],v[192:195]
ds_read_b128 v[76:79],v20 offset:11264
v_mfma_f32_16x16x32_bf16 v[200:203],v[64:67],a[144:147],v[200:203]
buffer_load_dwordx4 v16,s[20:23],s69 offen offset:0 lds
s_waitcnt lgkmcnt(2)
v_mfma_f32_16x16x32_bf16 v[196:199],a[16:19],v[68:71],v[196:199]
ds_read_b128 v[64:67],v20 offset:12288
v_mfma_f32_16x16x32_bf16 v[204:207],v[68:71],a[144:147],v[204:207]
buffer_load_dwordx4 v16,s[20:23],s69 offen offset:1024 lds
s_waitcnt lgkmcnt(2)
v_mfma_f32_16x16x32_bf16 v[192:195],a[20:23],v[72:75],v[192:195]
ds_read_b128 v[68:71],v20 offset:13312
v_mfma_f32_16x16x32_bf16 v[200:203],v[72:75],a[148:151],v[200:203]
buffer_load_dwordx4 v16,s[20:23],s69 offen offset:2048 lds
s_waitcnt lgkmcnt(2)
v_mfma_f32_16x16x32_bf16 v[196:199],a[20:23],v[76:79],v[196:199]
ds_read_b128 v[72:75],v20 offset:14336
v_mfma_f32_16x16x32_bf16 v[204:207],v[76:79],a[148:151],v[204:207]
buffer_load_dwordx4 v16,s[20:23],s69 offen offset:3072 lds
s_waitcnt lgkmcnt(2)
v_mfma_f32_16x16x32_bf16 v[192:195],a[24:27],v[64:67],v[192:195]
ds_read_b128 v[76:79],v20 offset:15360
v_mfma_f32_16x16x32_bf16 v[200:203],v[64:67],a[152:155],v[200:203]
s_add_u32 m0,s62,20480
s_add_u32 s69,s78,20480
s_waitcnt lgkmcnt(2)
v_mfma_f32_16x16x32_bf16 v[196:199],a[24:27],v[68:71],v[196:199]
ds_read_b128 v[64:67],v20 offset:16384
v_mfma_f32_16x16x32_bf16 v[204:207],v[68:71],a[152:155],v[204:207]
buffer_load_dwordx4 v16,s[20:23],s69 offen offset:0 lds
s_waitcnt lgkmcnt(2)
v_mfma_f32_16x16x32_bf16 v[192:195],a[28:31],v[72:75],v[192:195]
ds_read_b128 v[68:71],v20 offset:17408
v_mfma_f32_16x16x32_bf16 v[200:203],v[72:75],a[156:159],v[200:203]
buffer_load_dwordx4 v16,s[20:23],s69 offen offset:1024 lds
s_waitcnt lgkmcnt(2)
v_mfma_f32_16x16x32_bf16 v[196:199],a[28:31],v[76:79],v[196:199]
ds_read_b128 v[72:75],v20 offset:18432
v_mfma_f32_16x16x32_bf16 v[204:207],v[76:79],a[156:159],v[204:207]
buffer_load_dwordx4 v16,s[20:23],s69 offen offset:2048 lds
s_waitcnt lgkmcnt(2)
v_mfma_f32_16x16x32_bf16 v[192:195],a[32:35],v[64:67],v[192:195]
ds_read_b128 v[76:79],v20 offset:19456
v_mfma_f32_16x16x32_bf16 v[200:203],v[64:67],a[160:163],v[200:203]
buffer_load_dwordx4 v16,s[20:23],s69 offen offset:3072 lds
s_waitcnt lgkmcnt(2)
v_mfma_f32_16x16x32_bf16 v[196:199],a[32:35],v[68:71],v[196:199]
ds_read_b128 v[64:67],v20 offset:20480
v_mfma_f32_16x16x32_bf16 v[204:207],v[68:71],a[160:163],v[204:207]
s_add_u32 m0,s62,24576
s_add_u32 s69,s78,24576
s_waitcnt lgkmcnt(2)
v_mfma_f32_16x16x32_bf16 v[192:195],a[36:39],v[72:75],v[192:195]
ds_read_b128 v[68:71],v20 offset:21504
v_mfma_f32_16x16x32_bf16 v[200:203],v[72:75],a[164:167],v[200:203]
buffer_load_dwordx4 v16,s[20:23],s69 offen offset:0 lds
s_waitcnt lgkmcnt(2)
v_mfma_f32_16x16x32_bf16 v[196:199],a[36:39],v[76:79],v[196:199]
ds_read_b128 v[72:75],v20 offset:22528
v_mfma_f32_16x16x32_bf16 v[204:207],v[76:79],a[164:167],v[204:207]
buffer_load_dwordx4 v16,s[20:23],s69 offen offset:1024 lds
s_waitcnt lgkmcnt(2)
v_mfma_f32_16x16x32_bf16 v[192:195],a[40:43],v[64:67],v[192:195]
ds_read_b128 v[76:79],v20 offset:23552
v_mfma_f32_16x16x32_bf16 v[200:203],v[64:67],a[168:171],v[200:203]
buffer_load_dwordx4 v16,s[20:23],s69 offen offset:2048 lds
s_waitcnt lgkmcnt(2)
v_mfma_f32_16x16x32_bf16 v[196:199],a[40:43],v[68:71],v[196:199]
ds_read_b128 v[64:67],v20 offset:24576
v_mfma_f32_16x16x32_bf16 v[204:207],v[68:71],a[168:171],v[204:207]
buffer_load_dwordx4 v16,s[20:23],s69 offen offset:3072 lds
s_waitcnt lgkmcnt(2)
v_mfma_f32_16x16x32_bf16 v[192:195],a[44:47],v[72:75],v[192:195]
ds_read_b128 v[68:71],v20 offset:25600
v_mfma_f32_16x16x32_bf16 v[200:203],v[72:75],a[172:175],v[200:203]
s_add_u32 m0,s62,28672
s_add_u32 s69,s78,28672
s_waitcnt lgkmcnt(2)
v_mfma_f32_16x16x32_bf16 v[196:199],a[44:47],v[76:79],v[196:199]
ds_read_b128 v[72:75],v20 offset:26624
v_mfma_f32_16x16x32_bf16 v[204:207],v[76:79],a[172:175],v[204:207]
buffer_load_dwordx4 v16,s[20:23],s69 offen offset:0 lds
s_waitcnt lgkmcnt(2)
v_mfma_f32_16x16x32_bf16 v[192:195],a[48:51],v[64:67],v[192:195]
ds_read_b128 v[76:79],v20 offset:27648
v_mfma_f32_16x16x32_bf16 v[200:203],v[64:67],a[176:179],v[200:203]
buffer_load_dwordx4 v16,s[20:23],s69 offen offset:1024 lds
s_waitcnt lgkmcnt(2)
v_mfma_f32_16x16x32_bf16 v[196:199],a[48:51],v[68:71],v[196:199]
ds_read_b128 v[64:67],v20 offset:28672
v_mfma_f32_16x16x32_bf16 v[204:207],v[68:71],a[176:179],v[204:207]
buffer_load_dwordx4 v16,s[20:23],s69 offen offset:2048 lds
s_waitcnt lgkmcnt(2)
v_mfma_f32_16x16x32_bf16 v[192:195],a[52:55],v[72:75],v[192:195]
ds_read_b128 v[68:71],v20 offset:29696
v_mfma_f32_16x16x32_bf16 v[200:203],v[72:75],a[180:183],v[200:203]
buffer_load_dwordx4 v16,s[20:23],s69 offen offset:3072 lds
s_waitcnt lgkmcnt(2)
v_mfma_f32_16x16x32_bf16 v[196:199],a[52:55],v[76:79],v[196:199]
ds_read_b128 v[72:75],v20 offset:30720
v_mfma_f32_16x16x32_bf16 v[204:207],v[76:79],a[180:183],v[204:207]
s_waitcnt lgkmcnt(2)
v_mfma_f32_16x16x32_bf16 v[192:195],a[56:59],v[64:67],v[192:195]
ds_read_b128 v[76:79],v20 offset:31744
v_mfma_f32_16x16x32_bf16 v[200:203],v[64:67],a[184:187],v[200:203]
s_waitcnt lgkmcnt(2)
v_mfma_f32_16x16x32_bf16 v[196:199],a[56:59],v[68:71],v[196:199]
ds_read_b128 v[64:67],v20 offset:32768
v_mfma_f32_16x16x32_bf16 v[204:207],v[68:71],a[184:187],v[204:207]
s_waitcnt lgkmcnt(2)
v_mfma_f32_16x16x32_bf16 v[192:195],a[60:63],v[72:75],v[192:195]
ds_read_b128 v[68:71],v20 offset:33792
v_mfma_f32_16x16x32_bf16 v[200:203],v[72:75],a[188:191],v[200:203]
s_waitcnt lgkmcnt(2)
v_mfma_f32_16x16x32_bf16 v[196:199],a[60:63],v[76:79],v[196:199]
ds_read_b128 v[72:75],v20 offset:34816
v_mfma_f32_16x16x32_bf16 v[204:207],v[76:79],a[188:191],v[204:207]
s_waitcnt lgkmcnt(2)
v_mfma_f32_16x16x32_bf16 v[192:195],a[64:67],v[64:67],v[192:195]
ds_read_b128 v[76:79],v20 offset:35840
v_mfma_f32_16x16x32_bf16 v[200:203],v[64:67],a[192:195],v[200:203]
s_waitcnt lgkmcnt(2)
v_mfma_f32_16x16x32_bf16 v[196:199],a[64:67],v[68:71],v[196:199]
ds_read_b128 v[64:67],v20 offset:36864
v_mfma_f32_16x16x32_bf16 v[204:207],v[68:71],a[192:195],v[204:207]
s_waitcnt lgkmcnt(2)
v_mfma_f32_16x16x32_bf16 v[192:195],a[68:71],v[72:75],v[192:195]
ds_read_b128 v[68:71],v20 offset:37888
v_mfma_f32_16x16x32_bf16 v[200:203],v[72:75],a[196:199],v[200:203]
s_waitcnt lgkmcnt(2)
v_mfma_f32_16x16x32_bf16 v[196:199],a[68:71],v[76:79],v[196:199]
ds_read_b128 v[72:75],v20 offset:38912
v_mfma_f32_16x16x32_bf16 v[204:207],v[76:79],a[196:199],v[204:207]
s_waitcnt lgkmcnt(2)
v_mfma_f32_16x16x32_bf16 v[192:195],a[72:75],v[64:67],v[192:195]
ds_read_b128 v[76:79],v20 offset:39936
v_mfma_f32_16x16x32_bf16 v[200:203],v[64:67],a[200:203],v[200:203]
s_waitcnt lgkmcnt(2)
v_mfma_f32_16x16x32_bf16 v[196:199],a[72:75],v[68:71],v[196:199]
ds_read_b128 v[64:67],v20 offset:40960
v_mfma_f32_16x16x32_bf16 v[204:207],v[68:71],a[200:203],v[204:207]
s_waitcnt lgkmcnt(2)
v_mfma_f32_16x16x32_bf16 v[192:195],a[76:79],v[72:75],v[192:195]
ds_read_b128 v[68:71],v20 offset:41984
v_mfma_f32_16x16x32_bf16 v[200:203],v[72:75],a[204:207],v[200:203]
s_waitcnt lgkmcnt(2)
v_mfma_f32_16x16x32_bf16 v[196:199],a[76:79],v[76:79],v[196:199]
ds_read_b128 v[72:75],v20 offset:43008
v_mfma_f32_16x16x32_bf16 v[204:207],v[76:79],a[204:207],v[204:207]
s_waitcnt lgkmcnt(2)
v_mfma_f32_16x16x32_bf16 v[192:195],a[80:83],v[64:67],v[192:195]
ds_read_b128 v[76:79],v20 offset:44032
v_mfma_f32_16x16x32_bf16 v[200:203],v[64:67],a[208:211],v[200:203]
s_waitcnt lgkmcnt(2)
v_mfma_f32_16x16x32_bf16 v[196:199],a[80:83],v[68:71],v[196:199]
ds_read_b128 v[64:67],v20 offset:45056
v_mfma_f32_16x16x32_bf16 v[204:207],v[68:71],a[208:211],v[204:207]
s_waitcnt lgkmcnt(2)
v_mfma_f32_16x16x32_bf16 v[192:195],a[84:87],v[72:75],v[192:195]
ds_read_b128 v[68:71],v20 offset:46080
v_mfma_f32_16x16x32_bf16 v[200:203],v[72:75],a[212:215],v[200:203]
s_waitcnt lgkmcnt(2)
v_mfma_f32_16x16x32_bf16 v[196:199],a[84:87],v[76:79],v[196:199]
ds_read_b128 v[72:75],v20 offset:47104
v_mfma_f32_16x16x32_bf16 v[204:207],v[76:79],a[212:215],v[204:207]
s_waitcnt lgkmcnt(2)
v_mfma_f32_16x16x32_bf16 v[192:195],a[88:91],v[64:67],v[192:195]
ds_read_b128 v[76:79],v20 offset:48128
v_mfma_f32_16x16x32_bf16 v[200:203],v[64:67],a[216:219],v[200:203]
s_waitcnt lgkmcnt(2)
v_mfma_f32_16x16x32_bf16 v[196:199],a[88:91],v[68:71],v[196:199]
ds_read_b128 v[64:67],v20 offset:49152
v_mfma_f32_16x16x32_bf16 v[204:207],v[68:71],a[216:219],v[204:207]
s_waitcnt lgkmcnt(2)
v_mfma_f32_16x16x32_bf16 v[192:195],a[92:95],v[72:75],v[192:195]
ds_read_b128 v[68:71],v20 offset:50176
v_mfma_f32_16x16x32_bf16 v[200:203],v[72:75],a[220:223],v[200:203]
s_waitcnt lgkmcnt(2)
v_mfma_f32_16x16x32_bf16 v[196:199],a[92:95],v[76:79],v[196:199]
ds_read_b128 v[72:75],v20 offset:51200
v_mfma_f32_16x16x32_bf16 v[204:207],v[76:79],a[220:223],v[204:207]
s_waitcnt lgkmcnt(2)
v_mfma_f32_16x16x32_bf16 v[192:195],a[96:99],v[64:67],v[192:195]
ds_read_b128 v[76:79],v20 offset:52224
v_mfma_f32_16x16x32_bf16 v[200:203],v[64:67],a[224:227],v[200:203]
s_waitcnt lgkmcnt(2)
v_mfma_f32_16x16x32_bf16 v[196:199],a[96:99],v[68:71],v[196:199]
ds_read_b128 v[64:67],v20 offset:53248
v_mfma_f32_16x16x32_bf16 v[204:207],v[68:71],a[224:227],v[204:207]
s_waitcnt lgkmcnt(2)
v_mfma_f32_16x16x32_bf16 v[192:195],a[100:103],v[72:75],v[192:195]
ds_read_b128 v[68:71],v20 offset:54272
s_add_u32 m0,s62,43008
s_add_u32 s69,s78,43008
v_mfma_f32_16x16x32_bf16 v[200:203],v[72:75],a[228:231],v[200:203]
s_waitcnt lgkmcnt(2)
v_mfma_f32_16x16x32_bf16 v[196:199],a[100:103],v[76:79],v[196:199]
ds_read_b128 v[72:75],v20 offset:55296
buffer_load_dwordx4 v16,s[20:23],s69 offen offset:0 lds
v_mfma_f32_16x16x32_bf16 v[204:207],v[76:79],a[228:231],v[204:207]
s_waitcnt lgkmcnt(2)
v_mfma_f32_16x16x32_bf16 v[192:195],a[104:107],v[64:67],v[192:195]
ds_read_b128 v[76:79],v20 offset:56320
buffer_load_dwordx4 v16,s[20:23],s69 offen offset:1024 lds
v_mfma_f32_16x16x32_bf16 v[200:203],v[64:67],a[232:235],v[200:203]
s_waitcnt lgkmcnt(2)
v_mfma_f32_16x16x32_bf16 v[196:199],a[104:107],v[68:71],v[196:199]
ds_read_b128 v[64:67],v20 offset:57344
buffer_load_dwordx4 v16,s[20:23],s69 offen offset:2048 lds
v_mfma_f32_16x16x32_bf16 v[204:207],v[68:71],a[232:235],v[204:207]
s_waitcnt lgkmcnt(2)
v_mfma_f32_16x16x32_bf16 v[192:195],a[108:111],v[72:75],v[192:195]
ds_read_b128 v[68:71],v20 offset:58368
buffer_load_dwordx4 v16,s[20:23],s69 offen offset:3072 lds
v_mfma_f32_16x16x32_bf16 v[200:203],v[72:75],a[236:239],v[200:203]
s_waitcnt lgkmcnt(2)
v_mfma_f32_16x16x32_bf16 v[196:199],a[108:111],v[76:79],v[196:199]
ds_read_b128 v[72:75],v20 offset:59392
s_add_u32 m0,s62,47104
s_add_u32 s69,s78,47104
v_mfma_f32_16x16x32_bf16 v[204:207],v[76:79],a[236:239],v[204:207]
s_waitcnt lgkmcnt(2)
v_mfma_f32_16x16x32_bf16 v[192:195],a[112:115],v[64:67],v[192:195]
ds_read_b128 v[76:79],v20 offset:60416
buffer_load_dwordx4 v16,s[20:23],s69 offen offset:0 lds
v_mfma_f32_16x16x32_bf16 v[200:203],v[64:67],a[240:243],v[200:203]
s_waitcnt lgkmcnt(2)
v_mfma_f32_16x16x32_bf16 v[196:199],a[112:115],v[68:71],v[196:199]
ds_read_b128 v[64:67],v20 offset:61440
v_mfma_f32_16x16x32_bf16 v[204:207],v[68:71],a[240:243],v[204:207]
buffer_load_dwordx4 v16,s[20:23],s69 offen offset:1024 lds
s_waitcnt lgkmcnt(2)
v_mfma_f32_16x16x32_bf16 v[192:195],a[116:119],v[72:75],v[192:195]
ds_read_b128 v[68:71],v20 offset:62464
v_mfma_f32_16x16x32_bf16 v[200:203],v[72:75],a[244:247],v[200:203]
buffer_load_dwordx4 v16,s[20:23],s69 offen offset:2048 lds
s_waitcnt lgkmcnt(2)
v_mfma_f32_16x16x32_bf16 v[196:199],a[116:119],v[76:79],v[196:199]
ds_read_b128 v[72:75],v20 offset:63488
v_mfma_f32_16x16x32_bf16 v[204:207],v[76:79],a[244:247],v[204:207]
buffer_load_dwordx4 v16,s[20:23],s69 offen offset:3072 lds
s_waitcnt lgkmcnt(2)
v_mfma_f32_16x16x32_bf16 v[192:195],a[120:123],v[64:67],v[192:195]
ds_read_b128 v[76:79],v20 offset:64512
v_mfma_f32_16x16x32_bf16 v[200:203],v[64:67],a[248:251],v[200:203]
s_add_u32 m0,s62,51200
s_add_u32 s69,s78,51200
s_waitcnt lgkmcnt(2)
v_mfma_f32_16x16x32_bf16 v[196:199],a[120:123],v[68:71],v[196:199]
v_mfma_f32_16x16x32_bf16 v[204:207],v[68:71],a[248:251],v[204:207]
buffer_load_dwordx4 v16,s[20:23],s69 offen offset:0 lds
s_waitcnt lgkmcnt(1)
v_mfma_f32_16x16x32_bf16 v[192:195],a[124:127],v[72:75],v[192:195]
v_mfma_f32_16x16x32_bf16 v[200:203],v[72:75],a[252:255],v[200:203]
buffer_load_dwordx4 v16,s[20:23],s69 offen offset:1024 lds
s_waitcnt lgkmcnt(0)
v_mfma_f32_16x16x32_bf16 v[196:199],a[124:127],v[76:79],v[196:199]
v_mfma_f32_16x16x32_bf16 v[204:207],v[76:79],a[252:255],v[204:207]
v_xor_b32 v20,0x10000,v20
s_xor_b32 s62,s62,0x10000
s_lshr_b32 s64,s73,9
v_add_u32 v22,s64,v24
v_cvt_pk_bf16_f32 v208,v192,v193
v_cvt_pk_bf16_f32 v209,v194,v195
s_nop 0
v_cvt_pk_bf16_f32 v210,v196,v197
v_cvt_pk_bf16_f32 v211,v198,v199
v_cvt_pk_bf16_f32 v212,v200,v201
v_cvt_pk_bf16_f32 v213,v202,v203
v_cvt_pk_bf16_f32 v214,v204,v205
v_cvt_pk_bf16_f32 v215,v206,v207
v_permlane16_swap_b32 v208,v210
v_permlane16_swap_b32 v209,v211
buffer_store_dwordx4 v[208:211],v2,s[24:27],s73 offen
buffer_store_dwordx4 v[208:211],v2,s[28:31],s73 offen sc1
ds_write_b128 v22,v[212:215] offset:17408
buffer_store_dwordx4 v[208:211],v17,s[20:23],s12 offen sc1
bgx_126:
s_waitcnt lgkmcnt(0)
s_andn2_b32 s64,s79,4
s_cmp_eq_u32 s64,2
s_cbranch_scc1 late_127
lateb_128:
s_buffer_load_dword s48,s[20:23],s80 offset:0
s_buffer_load_dword s48,s[20:23],s80 offset:64
s_buffer_load_dword s48,s[20:23],s80 offset:128
s_buffer_load_dword s48,s[20:23],s80 offset:192
s_buffer_load_dword s48,s[20:23],s80 offset:256
s_buffer_load_dword s48,s[20:23],s80 offset:320
s_buffer_load_dword s48,s[20:23],s80 offset:384
s_buffer_load_dword s48,s[20:23],s80 offset:448
s_buffer_load_dword s48,s[20:23],s80 offset:512
s_buffer_load_dword s48,s[20:23],s80 offset:576
s_buffer_load_dword s48,s[20:23],s80 offset:640
s_buffer_load_dword s48,s[20:23],s80 offset:704
s_buffer_load_dword s48,s[20:23],s80 offset:768
s_buffer_load_dword s48,s[20:23],s80 offset:832
s_buffer_load_dword s48,s[20:23],s80 offset:896
s_buffer_load_dword s48,s[20:23],s80 offset:960
s_buffer_load_dword s48,s[20:23],s80 offset:1024
s_buffer_load_dword s48,s[20:23],s80 offset:1088
s_buffer_load_dword s48,s[20:23],s80 offset:1152
s_buffer_load_dword s48,s[20:23],s80 offset:1216
s_buffer_load_dword s48,s[20:23],s80 offset:1280
s_buffer_load_dword s48,s[20:23],s80 offset:1344
s_buffer_load_dword s48,s[20:23],s80 offset:1408
s_buffer_load_dword s48,s[20:23],s80 offset:1472
s_buffer_load_dword s48,s[20:23],s80 offset:1536
s_buffer_load_dword s48,s[20:23],s80 offset:1600
s_buffer_load_dword s48,s[20:23],s80 offset:1664
s_buffer_load_dword s48,s[20:23],s80 offset:1728
s_buffer_load_dword s48,s[20:23],s80 offset:1792
s_buffer_load_dword s48,s[20:23],s80 offset:1856
s_buffer_load_dword s48,s[20:23],s80 offset:1920
s_buffer_load_dword s48,s[20:23],s80 offset:1984
s_add_u32 s63,s79,1
s_and_b32 s64,s63,3
s_lshl_b32 s70,s64,20
s_add_u32 s65,s63,2
s_and_b32 s65,s65,3
s_lshl_b32 s73,s65,20
s_add_u32 s55,s63,3
s_lshl_b32 s78,s55,16
s_add_u32 s78,s78,57344
s_cmp_lt_u32 s55,64
s_cselect_b32 s78,s78,0x7fff0000
s_add_u32 s60,s63,1
s_lshl_b32 s76,s60,21
s_lshl_b32 s55,s60,13
s_and_b32 s55,s55,0x2000
s_xor_b32 s55,s55,s61
s_add_u32 s76,s76,s55
s_cmp_lt_u32 s60,64
s_cselect_b32 s76,s76,0x7fff0000
s_add_u32 s60,s63,2
s_lshl_b32 s12,s60,21
s_lshl_b32 s55,s60,13
s_and_b32 s55,s55,0x2000
s_xor_b32 s55,s55,s61
s_add_u32 s12,s12,s55
s_cmp_lt_u32 s60,64
s_cselect_b32 s12,s12,0x7fff0000
s_add_u32 s55,s63,5
s_min_u32 s55,s55,63
s_lshl_b32 s55,s55,16
s_lshl_b32 s60,s59,11
s_add_u32 s80,s55,s60
s_add_u32 s80,s80,57344
v_mov_b32 v176,0
v_mov_b32 v177,0
v_mov_b32 v178,0
v_mov_b32 v179,0
v_mov_b32 v180,0
v_mov_b32 v181,0
v_mov_b32 v182,0
v_mov_b32 v183,0
s_add_u32 s79,s79,1
v_add_u32 v25,1,v25
s_waitcnt vmcnt(0)
s_branch loop_120
art_124:
s_sub_u32 s90,s90,1
s_cmp_lt_i32 s90,0
s_cbranch_scc1 abk_125
buffer_load_dwordx4 v[64:67],v28,s[20:23],s70 offen offset:0 sc1
buffer_load_dwordx4 v[68:71],v28,s[20:23],s70 offen offset:1024 sc1
buffer_load_dwordx4 v[72:75],v28,s[20:23],s70 offen offset:2048 sc1
buffer_load_dwordx4 v[76:79],v28,s[20:23],s70 offen offset:3072 sc1
s_waitcnt vmcnt(3)
ds_write_b128 v24,v[64:67] offset:8192
v_min3_u32 v22,v64,v65,v66
v_min_u32 v22,v22,v67
s_waitcnt vmcnt(2)
ds_write_b128 v24,v[68:71] offset:9216
v_min3_u32 v22,v22,v68,v69
v_min3_u32 v22,v22,v70,v71
s_waitcnt vmcnt(1)
ds_write_b128 v24,v[72:75] offset:10240
v_min3_u32 v22,v22,v72,v73
v_min3_u32 v22,v22,v74,v75
s_waitcnt vmcnt(0)
ds_write_b128 v24,v[76:79] offset:11264
v_min3_u32 v22,v22,v76,v77
v_min3_u32 v22,v22,v78,v79
v_cmp_eq_u32 vcc,0,v22
s_cbranch_vccnz art_124
s_branch abk_125
late_127:
v_lshlrev_b32 v184,2,v16
s_mov_b32 s52,21052416
s_mov_b32 s53,1792
s_add_u32 s64,s79,0xfd
s_and_b32 exec_lo,s64,0x1fc
s_cmp_eq_u32 s79,2
s_cselect_b32 exec_lo,s64,exec_lo
s_mov_b32 exec_hi,0
dp_129:
buffer_load_dword v185,v184,s[20:23],s52 offen sc1
s_waitcnt vmcnt(0)
v_cmp_ne_u32 vcc,s53,v185
s_cbranch_vccz dpok_130
s_sleep 2
s_sub_u32 s90,s90,1
s_cmp_gt_i32 s90,0
s_cbranch_scc1 dp_129
dpok_130:
s_mov_b64 exec,-1
s_branch lateb_128
first_119:
s_add_u32 s63,s79,0
s_and_b32 s64,s63,3
s_lshl_b32 s70,s64,20
s_add_u32 s65,s63,2
s_and_b32 s65,s65,3
s_lshl_b32 s73,s65,20
s_add_u32 s55,s63,3
s_lshl_b32 s78,s55,16
s_add_u32 s78,s78,57344
s_cmp_lt_u32 s55,64
s_cselect_b32 s78,s78,0x7fff0000
s_add_u32 s60,s63,1
s_lshl_b32 s76,s60,21
s_lshl_b32 s55,s60,13
s_and_b32 s55,s55,0x2000
s_xor_b32 s55,s55,s61
s_add_u32 s76,s76,s55
s_cmp_lt_u32 s60,64
s_cselect_b32 s76,s76,0x7fff0000
s_add_u32 s60,s63,2
s_lshl_b32 s12,s60,21
s_lshl_b32 s55,s60,13
s_and_b32 s55,s55,0x2000
s_xor_b32 s55,s55,s61
s_add_u32 s12,s12,s55
s_cmp_lt_u32 s60,64
s_cselect_b32 s12,s12,0x7fff0000
s_add_u32 s55,s63,5
s_min_u32 s55,s55,63
s_lshl_b32 s55,s55,16
s_lshl_b32 s60,s59,11
s_add_u32 s80,s55,s60
s_add_u32 s80,s80,57344
v_mov_b32 v176,0
v_mov_b32 v177,0
v_mov_b32 v178,0
v_mov_b32 v179,0
v_mov_b32 v180,0
v_mov_b32 v181,0
v_mov_b32 v182,0
v_mov_b32 v183,0
s_waitcnt vmcnt(0) lgkmcnt(0)
pn1_131:
s_barrier
ds_read_b128 v[64:67],v20 offset:0
ds_read_b128 v[68:71],v20 offset:1024
ds_read_b128 v[72:75],v20 offset:2048
s_waitcnt lgkmcnt(2)
v_mfma_f32_16x16x32_bf16 v[192:195],a[0:3],v[64:67],0
ds_read_b128 v[76:79],v20 offset:3072
v_mfma_f32_16x16x32_bf16 v[200:203],v[64:67],a[128:131],0
s_waitcnt lgkmcnt(2)
v_mfma_f32_16x16x32_bf16 v[196:199],a[0:3],v[68:71],0
ds_read_b128 v[64:67],v20 offset:4096
v_mfma_f32_16x16x32_bf16 v[204:207],v[68:71],a[128:131],0
s_waitcnt lgkmcnt(2)
v_mfma_f32_16x16x32_bf16 v[192:195],a[4:7],v[72:75],v[192:195]
ds_read_b128 v[68:71],v20 offset:5120
v_mfma_f32_16x16x32_bf16 v[200:203],v[72:75],a[132:135],v[200:203]
s_waitcnt lgkmcnt(2)
v_mfma_f32_16x16x32_bf16 v[196:199],a[4:7],v[76:79],v[196:199]
ds_read_b128 v[72:75],v20 offset:6144
v_mfma_f32_16x16x32_bf16 v[204:207],v[76:79],a[132:135],v[204:207]
s_waitcnt lgkmcnt(2)
v_mfma_f32_16x16x32_bf16 v[192:195],a[8:11],v[64:67],v[192:195]
ds_read_b128 v[76:79],v20 offset:7168
v_mfma_f32_16x16x32_bf16 v[200:203],v[64:67],a[136:139],v[200:203]
s_waitcnt lgkmcnt(2)
v_mfma_f32_16x16x32_bf16 v[196:199],a[8:11],v[68:71],v[196:199]
ds_read_b128 v[64:67],v20 offset:8192
v_mfma_f32_16x16x32_bf16 v[204:207],v[68:71],a[136:139],v[204:207]
s_waitcnt lgkmcnt(2)
v_mfma_f32_16x16x32_bf16 v[192:195],a[12:15],v[72:75],v[192:195]
ds_read_b128 v[68:71],v20 offset:9216
v_mfma_f32_16x16x32_bf16 v[200:203],v[72:75],a[140:143],v[200:203]
s_waitcnt lgkmcnt(2)
v_mfma_f32_16x16x32_bf16 v[196:199],a[12:15],v[76:79],v[196:199]
ds_read_b128 v[72:75],v20 offset:10240
v_mfma_f32_16x16x32_bf16 v[204:207],v[76:79],a[140:143],v[204:207]
s_waitcnt lgkmcnt(2)
v_mfma_f32_16x16x32_bf16 v[192:195],a[16:19],v[64:67],v[192:195]
ds_read_b128 v[76:79],v20 offset:11264
v_mfma_f32_16x16x32_bf16 v[200:203],v[64:67],a[144:147],v[200:203]
s_waitcnt lgkmcnt(2)
v_mfma_f32_16x16x32_bf16 v[196:199],a[16:19],v[68:71],v[196:199]
ds_read_b128 v[64:67],v20 offset:12288
v_mfma_f32_16x16x32_bf16 v[204:207],v[68:71],a[144:147],v[204:207]
s_waitcnt lgkmcnt(2)
v_mfma_f32_16x16x32_bf16 v[192:195],a[20:23],v[72:75],v[192:195]
ds_read_b128 v[68:71],v20 offset:13312
v_mfma_f32_16x16x32_bf16 v[200:203],v[72:75],a[148:151],v[200:203]
s_waitcnt lgkmcnt(2)
v_mfma_f32_16x16x32_bf16 v[196:199],a[20:23],v[76:79],v[196:199]
ds_read_b128 v[72:75],v20 offset:14336
v_mfma_f32_16x16x32_bf16 v[204:207],v[76:79],a[148:151],v[204:207]
s_waitcnt lgkmcnt(2)
v_mfma_f32_16x16x32_bf16 v[192:195],a[24:27],v[64:67],v[192:195]
ds_read_b128 v[76:79],v20 offset:15360
v_mfma_f32_16x16x32_bf16 v[200:203],v[64:67],a[152:155],v[200:203]
s_waitcnt lgkmcnt(2)
v_mfma_f32_16x16x32_bf16 v[196:199],a[24:27],v[68:71],v[196:199]
ds_read_b128 v[64:67],v20 offset:16384
v_mfma_f32_16x16x32_bf16 v[204:207],v[68:71],a[152:155],v[204:207]
s_waitcnt lgkmcnt(2)
v_mfma_f32_16x16x32_bf16 v[192:195],a[28:31],v[72:75],v[192:195]
ds_read_b128 v[68:71],v20 offset:17408
v_mfma_f32_16x16x32_bf16 v[200:203],v[72:75],a[156:159],v[200:203]
s_waitcnt lgkmcnt(2)
v_mfma_f32_16x16x32_bf16 v[196:199],a[28:31],v[76:79],v[196:199]
ds_read_b128 v[72:75],v20 offset:18432
v_mfma_f32_16x16x32_bf16 v[204:207],v[76:79],a[156:159],v[204:207]
s_waitcnt lgkmcnt(2)
v_mfma_f32_16x16x32_bf16 v[192:195],a[32:35],v[64:67],v[192:195]
ds_read_b128 v[76:79],v20 offset:19456
v_mfma_f32_16x16x32_bf16 v[200:203],v[64:67],a[160:163],v[200:203]
s_waitcnt lgkmcnt(2)
v_mfma_f32_16x16x32_bf16 v[196:199],a[32:35],v[68:71],v[196:199]
ds_read_b128 v[64:67],v20 offset:20480
v_mfma_f32_16x16x32_bf16 v[204:207],v[68:71],a[160:163],v[204:207]
s_waitcnt lgkmcnt(2)
v_mfma_f32_16x16x32_bf16 v[192:195],a[36:39],v[72:75],v[192:195]
ds_read_b128 v[68:71],v20 offset:21504
v_mfma_f32_16x16x32_bf16 v[200:203],v[72:75],a[164:167],v[200:203]
s_waitcnt lgkmcnt(2)
v_mfma_f32_16x16x32_bf16 v[196:199],a[36:39],v[76:79],v[196:199]
ds_read_b128 v[72:75],v20 offset:22528
v_mfma_f32_16x16x32_bf16 v[204:207],v[76:79],a[164:167],v[204:207]
s_waitcnt lgkmcnt(2)
v_mfma_f32_16x16x32_bf16 v[192:195],a[40:43],v[64:67],v[192:195]
ds_read_b128 v[76:79],v20 offset:23552
v_mfma_f32_16x16x32_bf16 v[200:203],v[64:67],a[168:171],v[200:203]
s_waitcnt lgkmcnt(2)
v_mfma_f32_16x16x32_bf16 v[196:199],a[40:43],v[68:71],v[196:199]
ds_read_b128 v[64:67],v20 offset:24576
v_mfma_f32_16x16x32_bf16 v[204:207],v[68:71],a[168:171],v[204:207]
s_waitcnt lgkmcnt(2)
v_mfma_f32_16x16x32_bf16 v[192:195],a[44:47],v[72:75],v[192:195]
ds_read_b128 v[68:71],v20 offset:25600
v_mfma_f32_16x16x32_bf16 v[200:203],v[72:75],a[172:175],v[200:203]
s_waitcnt lgkmcnt(2)
v_mfma_f32_16x16x32_bf16 v[196:199],a[44:47],v[76:79],v[196:199]
ds_read_b128 v[72:75],v20 offset:26624
v_mfma_f32_16x16x32_bf16 v[204:207],v[76:79],a[172:175],v[204:207]
s_waitcnt lgkmcnt(2)
v_mfma_f32_16x16x32_bf16 v[192:195],a[48:51],v[64:67],v[192:195]
ds_read_b128 v[76:79],v20 offset:27648
v_mfma_f32_16x16x32_bf16 v[200:203],v[64:67],a[176:179],v[200:203]
s_waitcnt lgkmcnt(2)
v_mfma_f32_16x16x32_bf16 v[196:199],a[48:51],v[68:71],v[196:199]
ds_read_b128 v[64:67],v20 offset:28672
v_mfma_f32_16x16x32_bf16 v[204:207],v[68:71],a[176:179],v[204:207]
s_waitcnt lgkmcnt(2)
v_mfma_f32_16x16x32_bf16 v[192:195],a[52:55],v[72:75],v[192:195]
ds_read_b128 v[68:71],v20 offset:29696
v_mfma_f32_16x16x32_bf16 v[200:203],v[72:75],a[180:183],v[200:203]
s_waitcnt lgkmcnt(2)
v_mfma_f32_16x16x32_bf16 v[196:199],a[52:55],v[76:79],v[196:199]
ds_read_b128 v[72:75],v20 offset:30720
v_mfma_f32_16x16x32_bf16 v[204:207],v[76:79],a[180:183],v[204:207]
s_waitcnt lgkmcnt(2)
v_mfma_f32_16x16x32_bf16 v[192:195],a[56:59],v[64:67],v[192:195]
ds_read_b128 v[76:79],v20 offset:31744
v_mfma_f32_16x16x32_bf16 v[200:203],v[64:67],a[184:187],v[200:203]
s_waitcnt lgkmcnt(2)
v_mfma_f32_16x16x32_bf16 v[196:199],a[56:59],v[68:71],v[196:199]
ds_read_b128 v[64:67],v20 offset:32768
v_mfma_f32_16x16x32_bf16 v[204:207],v[68:71],a[184:187],v[204:207]
s_waitcnt lgkmcnt(2)
v_mfma_f32_16x16x32_bf16 v[192:195],a[60:63],v[72:75],v[192:195]
ds_read_b128 v[68:71],v20 offset:33792
v_mfma_f32_16x16x32_bf16 v[200:203],v[72:75],a[188:191],v[200:203]
s_waitcnt lgkmcnt(2)
v_mfma_f32_16x16x32_bf16 v[196:199],a[60:63],v[76:79],v[196:199]
ds_read_b128 v[72:75],v20 offset:34816
v_mfma_f32_16x16x32_bf16 v[204:207],v[76:79],a[188:191],v[204:207]
s_waitcnt lgkmcnt(2)
v_mfma_f32_16x16x32_bf16 v[192:195],a[64:67],v[64:67],v[192:195]
ds_read_b128 v[76:79],v20 offset:35840
v_mfma_f32_16x16x32_bf16 v[200:203],v[64:67],a[192:195],v[200:203]
s_waitcnt lgkmcnt(2)
v_mfma_f32_16x16x32_bf16 v[196:199],a[64:67],v[68:71],v[196:199]
ds_read_b128 v[64:67],v20 offset:36864
v_mfma_f32_16x16x32_bf16 v[204:207],v[68:71],a[192:195],v[204:207]
s_waitcnt lgkmcnt(2)
v_mfma_f32_16x16x32_bf16 v[192:195],a[68:71],v[72:75],v[192:195]
ds_read_b128 v[68:71],v20 offset:37888
v_mfma_f32_16x16x32_bf16 v[200:203],v[72:75],a[196:199],v[200:203]
s_waitcnt lgkmcnt(2)
v_mfma_f32_16x16x32_bf16 v[196:199],a[68:71],v[76:79],v[196:199]
ds_read_b128 v[72:75],v20 offset:38912
v_mfma_f32_16x16x32_bf16 v[204:207],v[76:79],a[196:199],v[204:207]
s_waitcnt lgkmcnt(2)
v_mfma_f32_16x16x32_bf16 v[192:195],a[72:75],v[64:67],v[192:195]
ds_read_b128 v[76:79],v20 offset:39936
v_mfma_f32_16x16x32_bf16 v[200:203],v[64:67],a[200:203],v[200:203]
s_waitcnt lgkmcnt(2)
v_mfma_f32_16x16x32_bf16 v[196:199],a[72:75],v[68:71],v[196:199]
ds_read_b128 v[64:67],v20 offset:40960
v_mfma_f32_16x16x32_bf16 v[204:207],v[68:71],a[200:203],v[204:207]
s_waitcnt lgkmcnt(2)
v_mfma_f32_16x16x32_bf16 v[192:195],a[76:79],v[72:75],v[192:195]
ds_read_b128 v[68:71],v20 offset:41984
v_mfma_f32_16x16x32_bf16 v[200:203],v[72:75],a[204:207],v[200:203]
s_waitcnt lgkmcnt(2)
v_mfma_f32_16x16x32_bf16 v[196:199],a[76:79],v[76:79],v[196:199]
ds_read_b128 v[72:75],v20 offset:43008
v_mfma_f32_16x16x32_bf16 v[204:207],v[76:79],a[204:207],v[204:207]
s_waitcnt lgkmcnt(2)
v_mfma_f32_16x16x32_bf16 v[192:195],a[80:83],v[64:67],v[192:195]
ds_read_b128 v[76:79],v20 offset:44032
v_mfma_f32_16x16x32_bf16 v[200:203],v[64:67],a[208:211],v[200:203]
s_waitcnt lgkmcnt(2)
v_mfma_f32_16x16x32_bf16 v[196:199],a[80:83],v[68:71],v[196:199]
ds_read_b128 v[64:67],v20 offset:45056
v_mfma_f32_16x16x32_bf16 v[204:207],v[68:71],a[208:211],v[204:207]
s_waitcnt lgkmcnt(2)
v_mfma_f32_16x16x32_bf16 v[192:195],a[84:87],v[72:75],v[192:195]
ds_read_b128 v[68:71],v20 offset:46080
v_mfma_f32_16x16x32_bf16 v[200:203],v[72:75],a[212:215],v[200:203]
s_waitcnt lgkmcnt(2)
v_mfma_f32_16x16x32_bf16 v[196:199],a[84:87],v[76:79],v[196:199]
ds_read_b128 v[72:75],v20 offset:47104
v_mfma_f32_16x16x32_bf16 v[204:207],v[76:79],a[212:215],v[204:207]
s_waitcnt lgkmcnt(2)
v_mfma_f32_16x16x32_bf16 v[192:195],a[88:91],v[64:67],v[192:195]
ds_read_b128 v[76:79],v20 offset:48128
v_mfma_f32_16x16x32_bf16 v[200:203],v[64:67],a[216:219],v[200:203]
s_waitcnt lgkmcnt(2)
v_mfma_f32_16x16x32_bf16 v[196:199],a[88:91],v[68:71],v[196:199]
ds_read_b128 v[64:67],v20 offset:49152
v_mfma_f32_16x16x32_bf16 v[204:207],v[68:71],a[216:219],v[204:207]
s_waitcnt lgkmcnt(2)
v_mfma_f32_16x16x32_bf16 v[192:195],a[92:95],v[72:75],v[192:195]
ds_read_b128 v[68:71],v20 offset:50176
v_mfma_f32_16x16x32_bf16 v[200:203],v[72:75],a[220:223],v[200:203]
s_waitcnt lgkmcnt(2)
v_mfma_f32_16x16x32_bf16 v[196:199],a[92:95],v[76:79],v[196:199]
ds_read_b128 v[72:75],v20 offset:51200
v_mfma_f32_16x16x32_bf16 v[204:207],v[76:79],a[220:223],v[204:207]
s_waitcnt lgkmcnt(2)
v_mfma_f32_16x16x32_bf16 v[192:195],a[96:99],v[64:67],v[192:195]
ds_read_b128 v[76:79],v20 offset:52224
v_mfma_f32_16x16x32_bf16 v[200:203],v[64:67],a[224:227],v[200:203]
s_waitcnt lgkmcnt(2)
v_mfma_f32_16x16x32_bf16 v[196:199],a[96:99],v[68:71],v[196:199]
ds_read_b128 v[64:67],v20 offset:53248
v_mfma_f32_16x16x32_bf16 v[204:207],v[68:71],a[224:227],v[204:207]
s_waitcnt lgkmcnt(2)
v_mfma_f32_16x16x32_bf16 v[192:195],a[100:103],v[72:75],v[192:195]
ds_read_b128 v[68:71],v20 offset:54272
v_mfma_f32_16x16x32_bf16 v[200:203],v[72:75],a[228:231],v[200:203]
s_waitcnt lgkmcnt(2)
v_mfma_f32_16x16x32_bf16 v[196:199],a[100:103],v[76:79],v[196:199]
ds_read_b128 v[72:75],v20 offset:55296
v_mfma_f32_16x16x32_bf16 v[204:207],v[76:79],a[228:231],v[204:207]
s_waitcnt lgkmcnt(2)
v_mfma_f32_16x16x32_bf16 v[192:195],a[104:107],v[64:67],v[192:195]
ds_read_b128 v[76:79],v20 offset:56320
v_mfma_f32_16x16x32_bf16 v[200:203],v[64:67],a[232:235],v[200:203]
s_waitcnt lgkmcnt(2)
v_mfma_f32_16x16x32_bf16 v[196:199],a[104:107],v[68:71],v[196:199]
ds_read_b128 v[64:67],v20 offset:57344
v_mfma_f32_16x16x32_bf16 v[204:207],v[68:71],a[232:235],v[204:207]
s_waitcnt lgkmcnt(2)
v_mfma_f32_16x16x32_bf16 v[192:195],a[108:111],v[72:75],v[192:195]
ds_read_b128 v[68:71],v20 offset:58368
v_mfma_f32_16x16x32_bf16 v[200:203],v[72:75],a[236:239],v[200:203]
s_waitcnt lgkmcnt(2)
v_mfma_f32_16x16x32_bf16 v[196:199],a[108:111],v[76:79],v[196:199]
ds_read_b128 v[72:75],v20 offset:59392
v_mfma_f32_16x16x32_bf16 v[204:207],v[76:79],a[236:239],v[204:207]
s_waitcnt lgkmcnt(2)
v_mfma_f32_16x16x32_bf16 v[192:195],a[112:115],v[64:67],v[192:195]
ds_read_b128 v[76:79],v20 offset:60416
v_mfma_f32_16x16x32_bf16 v[200:203],v[64:67],a[240:243],v[200:203]
s_waitcnt lgkmcnt(2)
v_mfma_f32_16x16x32_bf16 v[196:199],a[112:115],v[68:71],v[196:199]
ds_read_b128 v[64:67],v20 offset:61440
v_mfma_f32_16x16x32_bf16 v[204:207],v[68:71],a[240:243],v[204:207]
s_waitcnt lgkmcnt(2)
v_mfma_f32_16x16x32_bf16 v[192:195],a[116:119],v[72:75],v[192:195]
ds_read_b128 v[68:71],v20 offset:62464
v_mfma_f32_16x16x32_bf16 v[200:203],v[72:75],a[244:247],v[200:203]
s_waitcnt lgkmcnt(2)
v_mfma_f32_16x16x32_bf16 v[196:199],a[116:119],v[76:79],v[196:199]
ds_read_b128 v[72:75],v20 offset:63488
v_mfma_f32_16x16x32_bf16 v[204:207],v[76:79],a[244:247],v[204:207]
s_waitcnt lgkmcnt(2)
v_mfma_f32_16x16x32_bf16 v[192:195],a[120:123],v[64:67],v[192:195]
ds_read_b128 v[76:79],v20 offset:64512
v_mfma_f32_16x16x32_bf16 v[200:203],v[64:67],a[248:251],v[200:203]
s_waitcnt lgkmcnt(2)
v_mfma_f32_16x16x32_bf16 v[196:199],a[120:123],v[68:71],v[196:199]
v_mfma_f32_16x16x32_bf16 v[204:207],v[68:71],a[248:251],v[204:207]
s_waitcnt lgkmcnt(1)
v_mfma_f32_16x16x32_bf16 v[192:195],a[124:127],v[72:75],v[192:195]
v_mfma_f32_16x16x32_bf16 v[200:203],v[72:75],a[252:255],v[200:203]
s_waitcnt lgkmcnt(0)
v_mfma_f32_16x16x32_bf16 v[196:199],a[124:127],v[76:79],v[196:199]
v_mfma_f32_16x16x32_bf16 v[204:207],v[76:79],a[252:255],v[204:207]
v_xor_b32 v20,0x10000,v20
s_xor_b32 s62,s62,0x10000
s_lshr_b32 s64,s73,9
v_add_u32 v22,s64,v24
v_cvt_pk_bf16_f32 v208,v192,v193
v_cvt_pk_bf16_f32 v209,v194,v195
s_nop 0
v_cvt_pk_bf16_f32 v210,v196,v197
v_cvt_pk_bf16_f32 v211,v198,v199
v_cvt_pk_bf16_f32 v212,v200,v201
v_cvt_pk_bf16_f32 v213,v202,v203
v_cvt_pk_bf16_f32 v214,v204,v205
v_cvt_pk_bf16_f32 v215,v206,v207
v_permlane16_swap_b32 v208,v210
v_permlane16_swap_b32 v209,v211
buffer_store_dwordx4 v[208:211],v2,s[24:27],s73 offen
buffer_store_dwordx4 v[208:211],v2,s[28:31],s73 offen sc1
ds_write_b128 v22,v[212:215] offset:17408
buffer_store_dwordx4 v[208:211],v17,s[20:23],s12 offen sc1
bgx_133:
s_add_u32 s63,s79,1
s_and_b32 s64,s63,3
s_lshl_b32 s70,s64,20
s_add_u32 s65,s63,2
s_and_b32 s65,s65,3
s_lshl_b32 s73,s65,20
s_add_u32 s55,s63,3
s_lshl_b32 s78,s55,16
s_add_u32 s78,s78,57344
s_cmp_lt_u32 s55,64
s_cselect_b32 s78,s78,0x7fff0000
s_add_u32 s60,s63,1
s_lshl_b32 s76,s60,21
s_lshl_b32 s55,s60,13
s_and_b32 s55,s55,0x2000
s_xor_b32 s55,s55,s61
s_add_u32 s76,s76,s55
s_cmp_lt_u32 s60,64
s_cselect_b32 s76,s76,0x7fff0000
s_add_u32 s60,s63,2
s_lshl_b32 s12,s60,21
s_lshl_b32 s55,s60,13
s_and_b32 s55,s55,0x2000
s_xor_b32 s55,s55,s61
s_add_u32 s12,s12,s55
s_cmp_lt_u32 s60,64
s_cselect_b32 s12,s12,0x7fff0000
s_add_u32 s55,s63,5
s_min_u32 s55,s55,63
s_lshl_b32 s55,s55,16
s_lshl_b32 s60,s59,11
s_add_u32 s80,s55,s60
s_add_u32 s80,s80,57344
v_mov_b32 v176,0
v_mov_b32 v177,0
v_mov_b32 v178,0
v_mov_b32 v179,0
v_mov_b32 v180,0
v_mov_b32 v181,0
v_mov_b32 v182,0
v_mov_b32 v183,0
s_add_u32 s79,s79,1
s_cmp_eq_u32 s79,0
s_cbranch_scc1 pn2_132
buffer_store_dwordx4 v[212:215],v12,s[20:23],s76 offen sc1
s_waitcnt lgkmcnt(0)
s_branch pn1_131
pn2_132:
v_mov_b32 v25,1
s_waitcnt vmcnt(1) lgkmcnt(0)
s_barrier
s_branch loop_120
w3_62:
v_xor_b32 v9,0x10000,v8
v_xor_b32 v10,0x20000,v8
v_xor_b32 v11,0x30000,v8
v_and_b32 v22,2,v4
v_lshrrev_b32 v23,3,v3
v_add_u32 v22,v22,v23
v_lshlrev_b32 v22,3,v22
v_and_b32 v23,1,v4
v_lshl_add_u32 v22,v23,2,v22
v_and_b32 v23,3,v3
v_add_u32 v22,v22,v23
v_lshlrev_b32 v22,4,v22
v_bfe_u32 v23,v3,2,1
v_lshl_add_u32 v22,v23,3,v22
v_add_u32 v30,s66,v22
v_and_b32 v22,7,v3
v_lshl_add_u32 v12,v4,3,v22
v_lshlrev_b32 v12,4,v12
v_add_u32 v12,s66,v12
s_branch first_134
loop_135:
s_barrier
buffer_load_dword v248,v18,s[20:23],s70 offen offset:0 sc1
s_nop 15
s_nop 5
hl_137:
buffer_load_dword v249,v18,s[20:23],s70 offen offset:0 sc1
s_waitcnt vmcnt(1)
v_cmp_eq_u32 vcc,v25,v248
s_bcnt1_i32_b32 s64,vcc_lo
s_cmp_ge_u32 s64,8
s_cbranch_scc1 hg_138
buffer_load_dword v248,v18,s[20:23],s70 offen offset:0 sc1
s_waitcnt vmcnt(1)
v_cmp_eq_u32 vcc,v25,v249
s_bcnt1_i32_b32 s64,vcc_lo
s_cmp_ge_u32 s64,8
s_cbranch_scc1 hg_138
s_sub_u32 s90,s90,1
s_cmp_gt_i32 s90,0
s_cbranch_scc1 hl_137
hg_138:
buffer_load_dwordx4 v[80:83],v29,s[20:23],s70 offen offset:0 sc1
buffer_load_dwordx4 v[84:87],v29,s[20:23],s70 offen offset:1024 sc1
buffer_load_dwordx4 v[88:91],v29,s[20:23],s70 offen offset:2048 sc1
buffer_load_dwordx4 v[92:95],v29,s[20:23],s70 offen offset:3072 sc1
s_waitcnt vmcnt(3)
ds_write_b128 v24,v[80:83] offset:12288
v_min3_u32 v22,v80,v81,v82
v_min_u32 v22,v22,v83
s_waitcnt vmcnt(2)
ds_write_b128 v24,v[84:87] offset:13312
v_min3_u32 v22,v22,v84,v85
v_min3_u32 v22,v22,v86,v87
s_waitcnt vmcnt(1)
ds_write_b128 v24,v[88:91] offset:14336
v_min3_u32 v22,v22,v88,v89
v_min3_u32 v22,v22,v90,v91
s_waitcnt vmcnt(0)
ds_write_b128 v24,v[92:95] offset:15360
v_min3_u32 v22,v22,v92,v93
v_min3_u32 v22,v22,v94,v95
v_cmp_eq_u32 vcc,0,v22
s_cbranch_vccnz art_139
abk_140:
v_smfmac_f32_16x16x64_bf16 v[176:179],v[80:83],a[96:103],v14
s_waitcnt lgkmcnt(0)
s_barrier
ds_read_b128 v[32:35],v24 offset:0
ds_read_b128 v[36:39],v24 offset:1024
ds_read_b128 v[40:43],v24 offset:2048
ds_read_b128 v[44:47],v24 offset:3072
v_smfmac_f32_16x16x64_bf16 v[176:179],v[84:87],a[104:111],v14
ds_read_b128 v[48:51],v24 offset:4096
ds_read_b128 v[52:55],v24 offset:5120
v_smfmac_f32_16x16x64_bf16 v[176:179],v[88:91],a[112:119],v14
ds_read_b128 v[56:59],v24 offset:6144
ds_read_b128 v[60:63],v24 offset:7168
v_smfmac_f32_16x16x64_bf16 v[176:179],v[92:95],a[120:127],v14
ds_read_b128 v[64:67],v24 offset:8192
ds_read_b128 v[68:71],v24 offset:9216
s_waitcnt lgkmcnt(9)
v_smfmac_f32_16x16x64_bf16 v[176:179],v[32:35],a[0:7],v14
ds_read_b128 v[72:75],v24 offset:10240
s_waitcnt lgkmcnt(9)
v_smfmac_f32_16x16x64_bf16 v[176:179],v[36:39],a[8:15],v14
ds_read_b128 v[76:79],v24 offset:11264
s_waitcnt lgkmcnt(9)
v_smfmac_f32_16x16x64_bf16 v[176:179],v[40:43],a[16:23],v14
s_waitcnt lgkmcnt(8)
v_smfmac_f32_16x16x64_bf16 v[176:179],v[44:47],a[24:31],v14
s_waitcnt lgkmcnt(7)
v_smfmac_f32_16x16x64_bf16 v[176:179],v[48:51],a[32:39],v14
s_waitcnt lgkmcnt(6)
v_smfmac_f32_16x16x64_bf16 v[176:179],v[52:55],a[40:47],v14
s_waitcnt lgkmcnt(5)
v_smfmac_f32_16x16x64_bf16 v[176:179],v[56:59],a[48:55],v14
s_waitcnt lgkmcnt(4)
v_smfmac_f32_16x16x64_bf16 v[176:179],v[60:63],a[56:63],v14
s_waitcnt lgkmcnt(3)
v_smfmac_f32_16x16x64_bf16 v[176:179],v[64:67],a[64:71],v14
s_waitcnt lgkmcnt(2)
v_smfmac_f32_16x16x64_bf16 v[176:179],v[68:71],a[72:79],v14
s_waitcnt lgkmcnt(1)
v_smfmac_f32_16x16x64_bf16 v[176:179],v[72:75],a[80:87],v14
s_waitcnt lgkmcnt(0)
v_smfmac_f32_16x16x64_bf16 v[176:179],v[76:79],a[88:95],v14
s_nop 7
v_permlane32_swap_b32 v176,v178
v_permlane32_swap_b32 v177,v179
v_add_f32 v176,v176,v178
v_add_f32 v177,v177,v179
v_cvt_pk_bf16_f32 v216,v176,v177
s_nop 1
v_mov_b32_dpp v217,v216 quad_perm:[1,0,3,2] row_mask:0xf bank_mask:0xf
v_perm_b32 v216,v217,v216,v15
v_max_u32 v216,1,v216
buffer_store_dword v216,v19,s[24:27],s70 offen
buffer_store_dword v216,v19,s[28:31],s70 offen sc1
s_cmp_eq_u32 s79,63
s_cbranch_scc1 end_58
s_nop 15
s_nop 15
s_nop 15
s_nop 15
s_nop 10
s_add_u32 m0,s62,53248
s_add_u32 s69,s78,53248
buffer_load_dwordx4 v16,s[20:23],s69 offen offset:0 lds
s_nop 3
buffer_load_dwordx4 v16,s[20:23],s69 offen offset:1024 lds
s_nop 3
buffer_load_dwordx4 v16,s[20:23],s69 offen offset:2048 lds
s_nop 3
buffer_load_dwordx4 v16,s[20:23],s69 offen offset:3072 lds
s_nop 3
s_add_u32 m0,s62,57344
s_add_u32 s69,s78,57344
buffer_load_dwordx4 v16,s[20:23],s69 offen offset:0 lds
s_nop 3
buffer_load_dwordx4 v16,s[20:23],s69 offen offset:1024 lds
s_nop 3
buffer_load_dwordx4 v16,s[20:23],s69 offen offset:2048 lds
s_nop 3
buffer_load_dwordx4 v16,s[20:23],s69 offen offset:3072 lds
s_nop 3
s_add_u32 m0,s62,61440
s_add_u32 s69,s78,61440
buffer_load_dwordx4 v16,s[20:23],s69 offen offset:0 lds
s_nop 3
buffer_load_dwordx4 v16,s[20:23],s69 offen offset:1024 lds
s_nop 3
buffer_load_dwordx4 v16,s[20:23],s69 offen offset:2048 lds
s_nop 3
buffer_load_dwordx4 v16,s[20:23],s69 offen offset:3072 lds
s_nop 3
s_xor_b32 s62,s62,0x10000
wf_141:
ds_read_b32 v23,v21 offset:8
s_sub_u32 s90,s90,1
s_waitcnt lgkmcnt(0)
v_cmp_ne_u32 vcc,v23,v25
s_cmp_lt_i32 s90,0
s_cselect_b64 vcc,0,vcc
s_cbranch_vccnz wf_141
hl_142:
buffer_load_dword v248,v18,s[20:23],s70 offen offset:512 sc1
s_waitcnt vmcnt(0)
v_cmp_eq_u32 vcc,v25,v248
s_bcnt1_i32_b32 s64,vcc_lo
s_cmp_ge_u32 s64,16
s_cbranch_scc1 hg_143
s_sub_u32 s90,s90,1
s_cmp_gt_i32 s90,0
s_cbranch_scc1 hl_142
hg_143:
buffer_load_dwordx4 v[32:35],v28,s[20:23],s71 offen offset:0 sc1
buffer_load_dwordx4 v[36:39],v28,s[20:23],s71 offen offset:1024 sc1
buffer_load_dwordx4 v[40:43],v28,s[20:23],s71 offen offset:2048 sc1
buffer_load_dwordx4 v[44:47],v28,s[20:23],s71 offen offset:3072 sc1
buffer_load_dwordx4 v[48:51],v29,s[20:23],s71 offen offset:0 sc1
buffer_load_dwordx4 v[52:55],v29,s[20:23],s71 offen offset:1024 sc1
buffer_load_dwordx4 v[56:59],v29,s[20:23],s71 offen offset:2048 sc1
buffer_load_dwordx4 v[60:63],v29,s[20:23],s71 offen offset:3072 sc1
s_mov_b32 s68,0
s_waitcnt vmcnt(6)
v_smfmac_f32_16x16x64_bf16 v[184:187],v[32:35],a[128:135],v14
v_min3_u32 v22,v32,v33,v34
v_min3_u32 v22,v22,v35,v36
v_smfmac_f32_16x16x64_bf16 v[188:191],v[32:35],a[136:143],v14
v_min3_u32 v22,v22,v37,v38
v_smfmac_f32_16x16x64_bf16 v[184:187],v[36:39],a[144:151],v14
v_min_u32 v22,v22,v39
v_smfmac_f32_16x16x64_bf16 v[188:191],v[36:39],a[152:159],v14
v_cmp_eq_u32 s[52:53],0,v22
s_waitcnt vmcnt(4)
v_smfmac_f32_16x16x64_bf16 v[184:187],v[40:43],a[160:167],v14
v_min3_u32 v22,v40,v41,v42
s_cmp_lg_u64 s[52:53],0
v_smfmac_f32_16x16x64_bf16 v[188:191],v[40:43],a[168:175],v14
s_cbranch_scc1 ms_144
bk_145:
v_min3_u32 v22,v22,v43,v44
v_smfmac_f32_16x16x64_bf16 v[184:187],v[44:47],a[176:183],v14
v_min3_u32 v22,v22,v45,v46
v_min_u32 v22,v22,v47
v_smfmac_f32_16x16x64_bf16 v[188:191],v[44:47],a[184:191],v14
v_cmp_eq_u32 s[54:55],0,v22
s_waitcnt vmcnt(2)
v_smfmac_f32_16x16x64_bf16 v[184:187],v[48:51],a[192:199],v14
v_min3_u32 v22,v48,v49,v50
s_cmp_lg_u64 s[54:55],0
v_smfmac_f32_16x16x64_bf16 v[188:191],v[48:51],a[200:207],v14
s_cbranch_scc1 ms_146
bk_147:
v_min3_u32 v22,v22,v51,v52
v_smfmac_f32_16x16x64_bf16 v[184:187],v[52:55],a[208:215],v14
v_min3_u32 v22,v22,v53,v54
v_min_u32 v22,v22,v55
v_smfmac_f32_16x16x64_bf16 v[188:191],v[52:55],a[216:223],v14
v_cmp_eq_u32 s[52:53],0,v22
s_waitcnt vmcnt(0)
v_smfmac_f32_16x16x64_bf16 v[184:187],v[56:59],a[224:231],v14
v_min3_u32 v22,v56,v57,v58
s_cmp_lg_u64 s[52:53],0
v_smfmac_f32_16x16x64_bf16 v[188:191],v[56:59],a[232:239],v14
s_cbranch_scc1 ms_148
bk_149:
v_min3_u32 v22,v22,v59,v60
v_smfmac_f32_16x16x64_bf16 v[184:187],v[60:63],a[240:247],v14
v_min3_u32 v22,v22,v61,v62
v_min_u32 v22,v22,v63
v_smfmac_f32_16x16x64_bf16 v[188:191],v[60:63],a[248:255],v14
v_cmp_eq_u32 s[54:55],0,v22
s_cmp_lg_u64 s[54:55],0
s_cbranch_scc1 ms_152
bk_153:
s_cmp_lg_u32 s68,0
s_cbranch_scc1 rl2_154
fin_150:
s_nop 2
v_permlane32_swap_b32 v184,v188
v_permlane32_swap_b32 v185,v189
v_permlane32_swap_b32 v186,v190
v_permlane32_swap_b32 v187,v191
v_pk_add_f32 v[184:185],v[184:185],v[188:189]
v_pk_add_f32 v[186:187],v[186:187],v[190:191]
wf_155:
ds_read_b32 v23,v21 offset:12
ds_read_b128 v[216:219],v24 offset:25600
s_sub_u32 s90,s90,1
s_waitcnt lgkmcnt(0)
v_cmp_ne_u32 vcc,v23,v25
s_cmp_lt_i32 s90,0
s_cselect_b64 vcc,0,vcc
v_pk_add_f32 v[216:217],v[216:217],v[184:185]
v_pk_add_f32 v[218:219],v[218:219],v[186:187]
s_cbranch_vccnz wf_155
v_max_u32 v216,1,v216
v_max_u32 v217,1,v217
v_max_u32 v218,1,v218
v_max_u32 v219,1,v219
buffer_store_dwordx4 v[216:219],v8,s[20:23],s74 offen sc1
s_mov_b32 s88,s74
s_mov_b32 s89,s72
v_add_u32 v25,1,v25
s_add_u32 s63,s79,1
s_and_b32 s64,s63,3
s_lshl_b32 s70,s64,20
s_add_u32 s65,s63,2
s_and_b32 s65,s65,3
s_lshl_b32 s73,s65,20
s_add_u32 s55,s63,3
s_lshl_b32 s78,s55,16
s_add_u32 s78,s78,57344
s_cmp_lt_u32 s55,64
s_cselect_b32 s78,s78,0x7fff0000
s_add_u32 s71,s70,65536
s_add_u32 s60,s63,1
s_and_b32 s60,s60,3
s_lshl_b32 s72,s60,20
v_mov_b32 v184,0
v_mov_b32 v185,0
v_mov_b32 v186,0
v_mov_b32 v187,0
v_mov_b32 v188,0
v_mov_b32 v189,0
v_mov_b32 v190,0
v_mov_b32 v191,0
s_lshl_b32 s74,s63,21
s_lshl_b32 s55,s63,13
s_and_b32 s55,s55,0x2000
s_xor_b32 s55,s55,s61
s_add_u32 s74,s74,s55
v_mov_b32 v176,0
v_mov_b32 v177,0
v_mov_b32 v178,0
v_mov_b32 v179,0
s_nop 15
s_nop 15
s_nop 15
s_nop 15
s_nop 5
pp_156:
buffer_load_dwordx4 v[32:35],v9,s[20:23],s88 offen sc1
buffer_load_dwordx4 v[36:39],v10,s[20:23],s88 offen sc1
buffer_load_dwordx4 v[40:43],v11,s[20:23],s88 offen sc1
s_waitcnt vmcnt(2)
v_min3_u32 v22,v32,v33,v34
v_pk_add_f32 v[220:221],v[216:217],v[32:33]
v_pk_add_f32 v[222:223],v[218:219],v[34:35]
s_waitcnt vmcnt(0)
v_min3_u32 v22,v22,v35,v36
v_min3_u32 v22,v22,v37,v38
v_min3_u32 v22,v22,v39,v40
v_min3_u32 v22,v22,v41,v42
v_min_u32 v22,v22,v43
v_pk_add_f32 v[36:37],v[36:37],v[40:41]
v_cmp_eq_u32 vcc,0,v22
v_pk_add_f32 v[38:39],v[38:39],v[42:43]
s_cbranch_vccz pok_157
s_sub_u32 s90,s90,1
s_cmp_gt_i32 s90,0
s_cbranch_scc1 pp_156
pok_157:
v_pk_add_f32 v[220:221],v[220:221],v[36:37]
v_pk_add_f32 v[222:223],v[222:223],v[38:39]
s_mov_b64 vcc,s[86:87]
v_cvt_pk_bf16_f32 v216,v220,v221
v_cvt_pk_bf16_f32 v217,v222,v223
s_nop 0
v_mov_b32_dpp v218,v216 quad_perm:[1,0,3,2] row_mask:0xf bank_mask:0xf
v_mov_b32_dpp v219,v217 quad_perm:[1,0,3,2] row_mask:0xf bank_mask:0xf
v_perm_b32 v216,v218,v216,v15
v_perm_b32 v217,v219,v217,v15
s_nop 1
v_cndmask_b32_dpp v220,v217,v216,vcc quad_perm:[2,3,0,1] row_mask:0xf bank_mask:0xf
s_not_b64 vcc,vcc
v_cndmask_b32_dpp v221,v216,v217,vcc quad_perm:[2,3,0,1] row_mask:0xf bank_mask:0xf
v_max_u32 v220,1,v220
v_max_u32 v221,1,v221
buffer_store_dwordx2 v[220:221],v30,s[24:27],s89 offen
buffer_store_dwordx2 v[220:221],v30,s[28:31],s89 offen sc1
s_mov_b64 exec,1
buffer_store_dword v25,v13,s[24:27],s89 offen
buffer_store_dword v25,v13,s[28:31],s89 offen sc1
s_mov_b64 exec,-1
s_add_u32 s79,s79,1
s_branch loop_135
art_139:
s_sub_u32 s90,s90,1
s_cmp_lt_i32 s90,0
s_cbranch_scc1 abk_140
buffer_load_dwordx4 v[80:83],v29,s[20:23],s70 offen offset:0 sc1
buffer_load_dwordx4 v[84:87],v29,s[20:23],s70 offen offset:1024 sc1
buffer_load_dwordx4 v[88:91],v29,s[20:23],s70 offen offset:2048 sc1
buffer_load_dwordx4 v[92:95],v29,s[20:23],s70 offen offset:3072 sc1
s_waitcnt vmcnt(3)
ds_write_b128 v24,v[80:83] offset:12288
v_min3_u32 v22,v80,v81,v82
v_min_u32 v22,v22,v83
s_waitcnt vmcnt(2)
ds_write_b128 v24,v[84:87] offset:13312
v_min3_u32 v22,v22,v84,v85
v_min3_u32 v22,v22,v86,v87
s_waitcnt vmcnt(1)
ds_write_b128 v24,v[88:91] offset:14336
v_min3_u32 v22,v22,v88,v89
v_min3_u32 v22,v22,v90,v91
s_waitcnt vmcnt(0)
ds_write_b128 v24,v[92:95] offset:15360
v_min3_u32 v22,v22,v92,v93
v_min3_u32 v22,v22,v94,v95
v_cmp_eq_u32 vcc,0,v22
s_cbranch_vccnz art_139
s_branch abk_140
ms_144:
s_waitcnt vmcnt(0)
buffer_load_dwordx4 v[64:67],v28,s[20:23],s71 offen offset:0 sc1
buffer_load_dwordx4 v[68:71],v28,s[20:23],s71 offen offset:1024 sc1
s_bitset1_b32 s68,0
s_branch bk_145
ms_146:
s_waitcnt vmcnt(0)
buffer_load_dwordx4 v[72:75],v28,s[20:23],s71 offen offset:2048 sc1
buffer_load_dwordx4 v[76:79],v28,s[20:23],s71 offen offset:3072 sc1
s_bitset1_b32 s68,1
s_branch bk_147
ms_148:
s_waitcnt vmcnt(0)
buffer_load_dwordx4 v[80:83],v29,s[20:23],s71 offen offset:0 sc1
buffer_load_dwordx4 v[84:87],v29,s[20:23],s71 offen offset:1024 sc1
s_bitset1_b32 s68,2
s_branch bk_149
ms_152:
s_waitcnt vmcnt(0)
buffer_load_dwordx4 v[88:91],v29,s[20:23],s71 offen offset:2048 sc1
buffer_load_dwordx4 v[92:95],v29,s[20:23],s71 offen offset:3072 sc1
s_bitset1_b32 s68,3
s_branch bk_153
rl_151:
s_bitcmp1_b32 s68,0
s_cbranch_scc0 sk_158
buffer_load_dwordx4 v[64:67],v28,s[20:23],s71 offen offset:0 sc1
buffer_load_dwordx4 v[68:71],v28,s[20:23],s71 offen offset:1024 sc1
sk_158:
s_bitcmp1_b32 s68,1
s_cbranch_scc0 sk_159
buffer_load_dwordx4 v[72:75],v28,s[20:23],s71 offen offset:2048 sc1
buffer_load_dwordx4 v[76:79],v28,s[20:23],s71 offen offset:3072 sc1
sk_159:
s_bitcmp1_b32 s68,2
s_cbranch_scc0 sk_160
buffer_load_dwordx4 v[80:83],v29,s[20:23],s71 offen offset:0 sc1
buffer_load_dwordx4 v[84:87],v29,s[20:23],s71 offen offset:1024 sc1
sk_160:
s_bitcmp1_b32 s68,3
s_cbranch_scc0 sk_161
buffer_load_dwordx4 v[88:91],v29,s[20:23],s71 offen offset:2048 sc1
buffer_load_dwordx4 v[92:95],v29,s[20:23],s71 offen offset:3072 sc1
sk_161:
rl2_154:
s_sub_u32 s90,s90,1
s_cmp_lt_i32 s90,0
s_cbranch_scc1 fin_150
s_waitcnt vmcnt(0)
s_bitcmp1_b32 s68,0
s_cbranch_scc0 sk_162
v_min3_u32 v22,v64,v65,v66
v_min3_u32 v22,v22,v67,v68
v_min3_u32 v22,v22,v69,v70
v_min_u32 v22,v22,v71
v_cmp_eq_u32 vcc,0,v22
v_xor_b32 v64,v32,v64
v_xor_b32 v65,v33,v65
v_xor_b32 v66,v34,v66
v_xor_b32 v67,v35,v67
v_xor_b32 v68,v36,v68
v_xor_b32 v69,v37,v69
v_xor_b32 v70,v38,v70
v_xor_b32 v71,v39,v71
s_cbranch_vccnz nb_163
s_bitset0_b32 s68,0
v_smfmac_f32_16x16x64_bf16 v[184:187],v[64:67],a[128:135],v14
v_smfmac_f32_16x16x64_bf16 v[188:191],v[64:67],a[136:143],v14
v_smfmac_f32_16x16x64_bf16 v[184:187],v[68:71],a[144:151],v14
v_smfmac_f32_16x16x64_bf16 v[188:191],v[68:71],a[152:159],v14
nb_163:
sk_162:
s_bitcmp1_b32 s68,1
s_cbranch_scc0 sk_164
v_min3_u32 v22,v72,v73,v74
v_min3_u32 v22,v22,v75,v76
v_min3_u32 v22,v22,v77,v78
v_min_u32 v22,v22,v79
v_cmp_eq_u32 vcc,0,v22
v_xor_b32 v72,v40,v72
v_xor_b32 v73,v41,v73
v_xor_b32 v74,v42,v74
v_xor_b32 v75,v43,v75
v_xor_b32 v76,v44,v76
v_xor_b32 v77,v45,v77
v_xor_b32 v78,v46,v78
v_xor_b32 v79,v47,v79
s_cbranch_vccnz nb_165
s_bitset0_b32 s68,1
v_smfmac_f32_16x16x64_bf16 v[184:187],v[72:75],a[160:167],v14
v_smfmac_f32_16x16x64_bf16 v[188:191],v[72:75],a[168:175],v14
v_smfmac_f32_16x16x64_bf16 v[184:187],v[76:79],a[176:183],v14
v_smfmac_f32_16x16x64_bf16 v[188:191],v[76:79],a[184:191],v14
nb_165:
sk_164:
s_bitcmp1_b32 s68,2
s_cbranch_scc0 sk_166
v_min3_u32 v22,v80,v81,v82
v_min3_u32 v22,v22,v83,v84
v_min3_u32 v22,v22,v85,v86
v_min_u32 v22,v22,v87
v_cmp_eq_u32 vcc,0,v22
v_xor_b32 v80,v48,v80
v_xor_b32 v81,v49,v81
v_xor_b32 v82,v50,v82
v_xor_b32 v83,v51,v83
v_xor_b32 v84,v52,v84
v_xor_b32 v85,v53,v85
v_xor_b32 v86,v54,v86
v_xor_b32 v87,v55,v87
s_cbranch_vccnz nb_167
s_bitset0_b32 s68,2
v_smfmac_f32_16x16x64_bf16 v[184:187],v[80:83],a[192:199],v14
v_smfmac_f32_16x16x64_bf16 v[188:191],v[80:83],a[200:207],v14
v_smfmac_f32_16x16x64_bf16 v[184:187],v[84:87],a[208:215],v14
v_smfmac_f32_16x16x64_bf16 v[188:191],v[84:87],a[216:223],v14
nb_167:
sk_166:
s_bitcmp1_b32 s68,3
s_cbranch_scc0 sk_168
v_min3_u32 v22,v88,v89,v90
v_min3_u32 v22,v22,v91,v92
v_min3_u32 v22,v22,v93,v94
v_min_u32 v22,v22,v95
v_cmp_eq_u32 vcc,0,v22
v_xor_b32 v88,v56,v88
v_xor_b32 v89,v57,v89
v_xor_b32 v90,v58,v90
v_xor_b32 v91,v59,v91
v_xor_b32 v92,v60,v92
v_xor_b32 v93,v61,v93
v_xor_b32 v94,v62,v94
v_xor_b32 v95,v63,v95
s_cbranch_vccnz nb_169
s_bitset0_b32 s68,3
v_smfmac_f32_16x16x64_bf16 v[184:187],v[88:91],a[224:231],v14
v_smfmac_f32_16x16x64_bf16 v[188:191],v[88:91],a[232:239],v14
v_smfmac_f32_16x16x64_bf16 v[184:187],v[92:95],a[240:247],v14
v_smfmac_f32_16x16x64_bf16 v[188:191],v[92:95],a[248:255],v14
nb_169:
sk_168:
s_cmp_lg_u32 s68,0
s_cbranch_scc1 rl_151
s_nop 2
s_branch fin_150
first_134:
s_waitcnt vmcnt(0) lgkmcnt(0)
s_barrier
s_mov_b32 m0,98304
s_mov_b32 s65,155648
buffer_load_dwordx4 v16,s[20:23],s65 offen offset:0 lds
buffer_load_dwordx4 v16,s[20:23],s65 offen offset:1024 lds
buffer_load_dwordx4 v16,s[20:23],s65 offen offset:2048 lds
buffer_load_dwordx4 v16,s[20:23],s65 offen offset:3072 lds
s_mov_b32 m0,102400
s_mov_b32 s65,159744
buffer_load_dwordx4 v16,s[20:23],s65 offen offset:0 lds
buffer_load_dwordx4 v16,s[20:23],s65 offen offset:1024 lds
buffer_load_dwordx4 v16,s[20:23],s65 offen offset:2048 lds
buffer_load_dwordx4 v16,s[20:23],s65 offen offset:3072 lds
s_mov_b32 m0,106496
s_mov_b32 s65,163840
buffer_load_dwordx4 v16,s[20:23],s65 offen offset:0 lds
buffer_load_dwordx4 v16,s[20:23],s65 offen offset:1024 lds
buffer_load_dwordx4 v16,s[20:23],s65 offen offset:2048 lds
buffer_load_dwordx4 v16,s[20:23],s65 offen offset:3072 lds
s_mov_b32 m0,110592
s_mov_b32 s65,167936
buffer_load_dwordx4 v16,s[20:23],s65 offen offset:0 lds
buffer_load_dwordx4 v16,s[20:23],s65 offen offset:1024 lds
buffer_load_dwordx4 v16,s[20:23],s65 offen offset:2048 lds
buffer_load_dwordx4 v16,s[20:23],s65 offen offset:3072 lds
s_mov_b32 m0,114688
s_mov_b32 s65,172032
buffer_load_dwordx4 v16,s[20:23],s65 offen offset:0 lds
buffer_load_dwordx4 v16,s[20:23],s65 offen offset:1024 lds
buffer_load_dwordx4 v16,s[20:23],s65 offen offset:2048 lds
buffer_load_dwordx4 v16,s[20:23],s65 offen offset:3072 lds
s_mov_b32 m0,118784
s_mov_b32 s65,176128
buffer_load_dwordx4 v16,s[20:23],s65 offen offset:0 lds
buffer_load_dwordx4 v16,s[20:23],s65 offen offset:1024 lds
buffer_load_dwordx4 v16,s[20:23],s65 offen offset:2048 lds
buffer_load_dwordx4 v16,s[20:23],s65 offen offset:3072 lds
s_mov_b32 m0,122880
s_mov_b32 s65,180224
buffer_load_dwordx4 v16,s[20:23],s65 offen offset:0 lds
buffer_load_dwordx4 v16,s[20:23],s65 offen offset:1024 lds
buffer_load_dwordx4 v16,s[20:23],s65 offen offset:2048 lds
buffer_load_dwordx4 v16,s[20:23],s65 offen offset:3072 lds
s_mov_b32 m0,126976
s_mov_b32 s65,184320
buffer_load_dwordx4 v16,s[20:23],s65 offen offset:0 lds
buffer_load_dwordx4 v16,s[20:23],s65 offen offset:1024 lds
buffer_load_dwordx4 v16,s[20:23],s65 offen offset:2048 lds
buffer_load_dwordx4 v16,s[20:23],s65 offen offset:3072 lds
s_xor_b32 s64,s61,10493952
buffer_store_dwordx4 v[100:103],v206,s[20:23],s64 offen sc1
buffer_store_dwordx4 v[100:103],v207,s[20:23],s64 offen sc1
s_xor_b32 s64,s61,12582912
buffer_store_dwordx4 v[100:103],v206,s[20:23],s64 offen sc1
buffer_store_dwordx4 v[100:103],v207,s[20:23],s64 offen sc1
s_xor_b32 s64,s61,14688256
buffer_store_dwordx4 v[100:103],v206,s[20:23],s64 offen sc1
buffer_store_dwordx4 v[100:103],v207,s[20:23],s64 offen sc1
s_waitcnt vmcnt(6)
s_barrier
s_mov_b32 m0,32768
s_mov_b32 s65,221184
buffer_load_dwordx4 v16,s[20:23],s65 offen offset:0 lds
buffer_load_dwordx4 v16,s[20:23],s65 offen offset:1024 lds
buffer_load_dwordx4 v16,s[20:23],s65 offen offset:2048 lds
buffer_load_dwordx4 v16,s[20:23],s65 offen offset:3072 lds
s_mov_b32 m0,36864
s_mov_b32 s65,225280
buffer_load_dwordx4 v16,s[20:23],s65 offen offset:0 lds
buffer_load_dwordx4 v16,s[20:23],s65 offen offset:1024 lds
buffer_load_dwordx4 v16,s[20:23],s65 offen offset:2048 lds
buffer_load_dwordx4 v16,s[20:23],s65 offen offset:3072 lds
s_mov_b32 m0,40960
s_mov_b32 s65,229376
buffer_load_dwordx4 v16,s[20:23],s65 offen offset:0 lds
buffer_load_dwordx4 v16,s[20:23],s65 offen offset:1024 lds
buffer_load_dwordx4 v16,s[20:23],s65 offen offset:2048 lds
buffer_load_dwordx4 v16,s[20:23],s65 offen offset:3072 lds
s_mov_b32 m0,45056
s_mov_b32 s65,233472
buffer_load_dwordx4 v16,s[20:23],s65 offen offset:0 lds
buffer_load_dwordx4 v16,s[20:23],s65 offen offset:1024 lds
buffer_load_dwordx4 v16,s[20:23],s65 offen offset:2048 lds
buffer_load_dwordx4 v16,s[20:23],s65 offen offset:3072 lds
s_mov_b32 m0,49152
s_mov_b32 s65,237568
buffer_load_dwordx4 v16,s[20:23],s65 offen offset:0 lds
buffer_load_dwordx4 v16,s[20:23],s65 offen offset:1024 lds
buffer_load_dwordx4 v16,s[20:23],s65 offen offset:2048 lds
buffer_load_dwordx4 v16,s[20:23],s65 offen offset:3072 lds
s_mov_b32 m0,53248
s_mov_b32 s65,241664
buffer_load_dwordx4 v16,s[20:23],s65 offen offset:0 lds
buffer_load_dwordx4 v16,s[20:23],s65 offen offset:1024 lds
buffer_load_dwordx4 v16,s[20:23],s65 offen offset:2048 lds
buffer_load_dwordx4 v16,s[20:23],s65 offen offset:3072 lds
s_mov_b32 m0,57344
s_mov_b32 s65,245760
buffer_load_dwordx4 v16,s[20:23],s65 offen offset:0 lds
buffer_load_dwordx4 v16,s[20:23],s65 offen offset:1024 lds
buffer_load_dwordx4 v16,s[20:23],s65 offen offset:2048 lds
buffer_load_dwordx4 v16,s[20:23],s65 offen offset:3072 lds
s_mov_b32 m0,61440
s_mov_b32 s65,249856
buffer_load_dwordx4 v16,s[20:23],s65 offen offset:0 lds
buffer_load_dwordx4 v16,s[20:23],s65 offen offset:1024 lds
buffer_load_dwordx4 v16,s[20:23],s65 offen offset:2048 lds
buffer_load_dwordx4 v16,s[20:23],s65 offen offset:3072 lds
s_mov_b32 s79,0
s_add_u32 s63,s79,0
s_and_b32 s64,s63,3
s_lshl_b32 s70,s64,20
s_add_u32 s65,s63,2
s_and_b32 s65,s65,3
s_lshl_b32 s73,s65,20
s_add_u32 s55,s63,3
s_lshl_b32 s78,s55,16
s_add_u32 s78,s78,57344
s_cmp_lt_u32 s55,64
s_cselect_b32 s78,s78,0x7fff0000
s_add_u32 s71,s70,65536
s_add_u32 s60,s63,1
s_and_b32 s60,s60,3
s_lshl_b32 s72,s60,20
v_mov_b32 v184,0
v_mov_b32 v185,0
v_mov_b32 v186,0
v_mov_b32 v187,0
v_mov_b32 v188,0
v_mov_b32 v189,0
v_mov_b32 v190,0
v_mov_b32 v191,0
s_lshl_b32 s74,s63,21
s_lshl_b32 s55,s63,13
s_and_b32 s55,s55,0x2000
s_xor_b32 s55,s55,s61
s_add_u32 s74,s74,s55
v_mov_b32 v176,0
v_mov_b32 v177,0
v_mov_b32 v178,0
v_mov_b32 v179,0
v_mov_b32 v25,1
s_waitcnt vmcnt(0) lgkmcnt(0)
s_barrier
v_max_u32 v216,1,v216
v_max_u32 v217,1,v217
v_max_u32 v218,1,v218
v_max_u32 v219,1,v219
s_mov_b64 exec,s[84:85]
buffer_store_dwordx4 v[216:219],v12,s[24:27],s70 offen
buffer_store_dwordx4 v[216:219],v12,s[28:31],s70 offen sc1
s_mov_b64 exec,1
buffer_store_dword v25,v13,s[24:27],s70 offen
buffer_store_dword v25,v13,s[28:31],s70 offen sc1
s_mov_b64 exec,-1
s_branch loop_135
end_58:
s_waitcnt vmcnt(0)
s_barrier
s_mov_b32 s50,s91
done_1:
s_endpgm
pipe_worker:
v_and_b32 v1,63,v0
v_and_b32 v3,15,v1
v_lshrrev_b32 v4,4,v1
v_lshlrev_b32 v16,4,v1
v_mov_b32 v48,0
v_mov_b32 v49,0
v_mov_b32 v50,0
v_mov_b32 v51,0
s_lshr_b32 s58,s55,5
s_and_b32 s59,s55,31
s_xor_b32 s62,s61,0x2000
s_add_u32 s63,s62,21053440
s_load_dwordx2 s[4:5],s[0:1],16
v_lshlrev_b32 v5,4,v0
s_lshl_b32 s64,s55,14
s_add_u32 s64,s64,17825792
buffer_store_dwordx4 v[48:51],v5,s[20:23],s64 offen sc1
s_add_u32 s64,s64,4096
buffer_store_dwordx4 v[48:51],v5,s[20:23],s64 offen sc1
s_add_u32 s64,s64,4096
buffer_store_dwordx4 v[48:51],v5,s[20:23],s64 offen sc1
s_add_u32 s64,s64,4096
buffer_store_dwordx4 v[48:51],v5,s[20:23],s64 offen sc1
s_add_u32 s64,s64,4096
s_lshr_b32 s79,s55,1
s_add_u32 s64,s79,8
s_lshl_b32 s93,s64,21
s_lshl_b32 s64,s64,13
s_and_b32 s64,s64,0x2000
s_xor_b32 s64,s64,s61
s_add_u32 s93,s93,s64
s_add_u32 s93,s93,29360128
s_and_b32 s64,s55,1
s_lshl_b32 s64,s64,18
s_add_u32 s93,s93,s64
s_add_u32 s93,s93,1572864
s_cmp_ge_u32 s55,112
s_cselect_b32 s93,0x7fff0000,s93
s_waitcnt lgkmcnt(0)
s_mov_b32 s32,s4
s_and_b32 s33,s5,0xffff
s_mov_b32 s34,0x800000
s_mov_b32 s35,0x20000
v_lshrrev_b32 v5,3,v3
v_bfe_u32 v6,v3,2,1
v_lshl_add_u32 v7,v5,3,v6
v_lshl_add_u32 v6,v5,2,v6
v_lshrrev_b32 v5,1,v4
v_lshl_add_u32 v7,v5,4,v7
v_and_b32 v5,1,v4
v_lshl_add_u32 v7,v5,2,v7
v_lshl_add_u32 v6,v5,1,v6
v_bfe_u32 v5,v3,1,1
s_lshl_b32 s64,s50,1
v_add_u32 v5,s64,v5
v_xor_b32 v5,v5,v6
v_lshlrev_b32 v5,5,v5
v_lshl_add_u32 v5,v7,8,v5
v_and_b32 v6,1,v3
v_lshl_add_u32 v12,v6,4,v5
s_lshl_b32 s66,s59,8
v_and_b32 v5,15,v1
v_and_b32 v6,1,v4
v_lshlrev_b32 v6,1,v6
v_xor_b32 v5,v5,v6
v_mul_u32_u24 v6,8192,v4
v_xor_b32 v7,0,v5
v_lshl_add_u32 v8,v7,4,v6
v_xor_b32 v7,4,v5
v_lshl_add_u32 v9,v7,4,v6
v_xor_b32 v7,8,v5
v_lshl_add_u32 v10,v7,4,v6
v_xor_b32 v7,12,v5
v_lshl_add_u32 v11,v7,4,v6
s_mul_i32 s74,s50,524288
s_add_u32 s74,s74,s66
s_lshl_b32 s75,s50,14
s_mul_i32 s76,s50,262144
s_add_u32 s76,s76,s66
s_lshl_b32 s77,s50,13
s_add_u32 s64,s74,0
s_add_u32 m0,s75,0
s_nop 0
buffer_load_dwordx4 v8,s[32:35],s64 offen  lds
s_add_u32 s64,s74,32768
s_add_u32 m0,s75,1024
s_nop 0
buffer_load_dwordx4 v9,s[32:35],s64 offen  lds
s_add_u32 s64,s74,65536
s_add_u32 m0,s75,2048
s_nop 0
buffer_load_dwordx4 v10,s[32:35],s64 offen  lds
s_add_u32 s64,s74,98304
s_add_u32 m0,s75,3072
s_nop 0
buffer_load_dwordx4 v11,s[32:35],s64 offen  lds
s_add_u32 s64,s74,131072
s_add_u32 m0,s75,4096
s_nop 0
buffer_load_dwordx4 v8,s[32:35],s64 offen  lds
s_add_u32 s64,s74,163840
s_add_u32 m0,s75,5120
s_nop 0
buffer_load_dwordx4 v9,s[32:35],s64 offen  lds
s_add_u32 s64,s74,196608
s_add_u32 m0,s75,6144
s_nop 0
buffer_load_dwordx4 v10,s[32:35],s64 offen  lds
s_add_u32 s64,s74,229376
s_add_u32 m0,s75,7168
s_nop 0
buffer_load_dwordx4 v11,s[32:35],s64 offen  lds
s_add_u32 s64,s74,262144
s_add_u32 m0,s75,8192
s_nop 0
buffer_load_dwordx4 v8,s[32:35],s64 offen  lds
s_add_u32 s64,s74,294912
s_add_u32 m0,s75,9216
s_nop 0
buffer_load_dwordx4 v9,s[32:35],s64 offen  lds
s_add_u32 s64,s74,327680
s_add_u32 m0,s75,10240
s_nop 0
buffer_load_dwordx4 v10,s[32:35],s64 offen  lds
s_add_u32 s64,s74,360448
s_add_u32 m0,s75,11264
s_nop 0
buffer_load_dwordx4 v11,s[32:35],s64 offen  lds
s_add_u32 s64,s74,393216
s_add_u32 m0,s75,12288
s_nop 0
buffer_load_dwordx4 v8,s[32:35],s64 offen  lds
s_add_u32 s64,s74,425984
s_add_u32 m0,s75,13312
s_nop 0
buffer_load_dwordx4 v9,s[32:35],s64 offen  lds
s_add_u32 s64,s74,458752
s_add_u32 m0,s75,14336
s_nop 0
buffer_load_dwordx4 v10,s[32:35],s64 offen  lds
s_add_u32 s64,s74,491520
s_add_u32 m0,s75,15360
s_nop 0
buffer_load_dwordx4 v11,s[32:35],s64 offen  lds
s_add_u32 s64,s74,2097152
s_add_u32 m0,s75,65536
s_nop 0
buffer_load_dwordx4 v8,s[32:35],s64 offen  lds
s_add_u32 s64,s74,2129920
s_add_u32 m0,s75,66560
s_nop 0
buffer_load_dwordx4 v9,s[32:35],s64 offen  lds
s_add_u32 s64,s74,2162688
s_add_u32 m0,s75,67584
s_nop 0
buffer_load_dwordx4 v10,s[32:35],s64 offen  lds
s_add_u32 s64,s74,2195456
s_add_u32 m0,s75,68608
s_nop 0
buffer_load_dwordx4 v11,s[32:35],s64 offen  lds
s_add_u32 s64,s74,2228224
s_add_u32 m0,s75,69632
s_nop 0
buffer_load_dwordx4 v8,s[32:35],s64 offen  lds
s_add_u32 s64,s74,2260992
s_add_u32 m0,s75,70656
s_nop 0
buffer_load_dwordx4 v9,s[32:35],s64 offen  lds
s_add_u32 s64,s74,2293760
s_add_u32 m0,s75,71680
s_nop 0
buffer_load_dwordx4 v10,s[32:35],s64 offen  lds
s_add_u32 s64,s74,2326528
s_add_u32 m0,s75,72704
s_nop 0
buffer_load_dwordx4 v11,s[32:35],s64 offen  lds
s_add_u32 s64,s74,2359296
s_add_u32 m0,s75,73728
s_nop 0
buffer_load_dwordx4 v8,s[32:35],s64 offen  lds
s_add_u32 s64,s74,2392064
s_add_u32 m0,s75,74752
s_nop 0
buffer_load_dwordx4 v9,s[32:35],s64 offen  lds
s_add_u32 s64,s74,2424832
s_add_u32 m0,s75,75776
s_nop 0
buffer_load_dwordx4 v10,s[32:35],s64 offen  lds
s_add_u32 s64,s74,2457600
s_add_u32 m0,s75,76800
s_nop 0
buffer_load_dwordx4 v11,s[32:35],s64 offen  lds
s_add_u32 s64,s74,2490368
s_add_u32 m0,s75,77824
s_nop 0
buffer_load_dwordx4 v8,s[32:35],s64 offen  lds
s_add_u32 s64,s74,2523136
s_add_u32 m0,s75,78848
s_nop 0
buffer_load_dwordx4 v9,s[32:35],s64 offen  lds
s_add_u32 s64,s74,2555904
s_add_u32 m0,s75,79872
s_nop 0
buffer_load_dwordx4 v10,s[32:35],s64 offen  lds
s_add_u32 s64,s74,2588672
s_add_u32 m0,s75,80896
s_nop 0
buffer_load_dwordx4 v11,s[32:35],s64 offen  lds
s_waitcnt vmcnt(16)
s_barrier
ds_read_b64_tr_b16 a[0:1],v12 offset:0
ds_read_b64_tr_b16 a[2:3],v12 offset:512
ds_read_b64_tr_b16 a[128:129],v12 offset:8
ds_read_b64_tr_b16 a[130:131],v12 offset:520
ds_read_b64_tr_b16 a[4:5],v12 offset:8192
ds_read_b64_tr_b16 a[6:7],v12 offset:8704
ds_read_b64_tr_b16 a[132:133],v12 offset:8200
ds_read_b64_tr_b16 a[134:135],v12 offset:8712
s_waitcnt lgkmcnt(4)
ds_read_b64_tr_b16 a[8:9],v12 offset:16384
ds_read_b64_tr_b16 a[10:11],v12 offset:16896
ds_read_b64_tr_b16 a[136:137],v12 offset:16392
ds_read_b64_tr_b16 a[138:139],v12 offset:16904
ds_read_b64_tr_b16 a[12:13],v12 offset:24576
ds_read_b64_tr_b16 a[14:15],v12 offset:25088
ds_read_b64_tr_b16 a[140:141],v12 offset:24584
ds_read_b64_tr_b16 a[142:143],v12 offset:25096
s_waitcnt lgkmcnt(4)
ds_read_b64_tr_b16 a[16:17],v12 offset:32768
ds_read_b64_tr_b16 a[18:19],v12 offset:33280
ds_read_b64_tr_b16 a[144:145],v12 offset:32776
ds_read_b64_tr_b16 a[146:147],v12 offset:33288
ds_read_b64_tr_b16 a[20:21],v12 offset:40960
ds_read_b64_tr_b16 a[22:23],v12 offset:41472
ds_read_b64_tr_b16 a[148:149],v12 offset:40968
ds_read_b64_tr_b16 a[150:151],v12 offset:41480
s_waitcnt lgkmcnt(4)
ds_read_b64_tr_b16 a[24:25],v12 offset:49152
ds_read_b64_tr_b16 a[26:27],v12 offset:49664
ds_read_b64_tr_b16 a[152:153],v12 offset:49160
ds_read_b64_tr_b16 a[154:155],v12 offset:49672
ds_read_b64_tr_b16 a[28:29],v12 offset:57344
ds_read_b64_tr_b16 a[30:31],v12 offset:57856
ds_read_b64_tr_b16 a[156:157],v12 offset:57352
ds_read_b64_tr_b16 a[158:159],v12 offset:57864
s_waitcnt lgkmcnt(4)
v_xor_b32 v12,0x10000,v12
s_waitcnt lgkmcnt(0)
s_barrier
s_add_u32 s64,s74,4194304
s_add_u32 m0,s75,0
s_nop 0
buffer_load_dwordx4 v8,s[32:35],s64 offen  lds
s_add_u32 s64,s74,4227072
s_add_u32 m0,s75,1024
s_nop 0
buffer_load_dwordx4 v9,s[32:35],s64 offen  lds
s_add_u32 s64,s74,4259840
s_add_u32 m0,s75,2048
s_nop 0
buffer_load_dwordx4 v10,s[32:35],s64 offen  lds
s_add_u32 s64,s74,4292608
s_add_u32 m0,s75,3072
s_nop 0
buffer_load_dwordx4 v11,s[32:35],s64 offen  lds
s_add_u32 s64,s74,4325376
s_add_u32 m0,s75,4096
s_nop 0
buffer_load_dwordx4 v8,s[32:35],s64 offen  lds
s_add_u32 s64,s74,4358144
s_add_u32 m0,s75,5120
s_nop 0
buffer_load_dwordx4 v9,s[32:35],s64 offen  lds
s_add_u32 s64,s74,4390912
s_add_u32 m0,s75,6144
s_nop 0
buffer_load_dwordx4 v10,s[32:35],s64 offen  lds
s_add_u32 s64,s74,4423680
s_add_u32 m0,s75,7168
s_nop 0
buffer_load_dwordx4 v11,s[32:35],s64 offen  lds
s_add_u32 s64,s74,4456448
s_add_u32 m0,s75,8192
s_nop 0
buffer_load_dwordx4 v8,s[32:35],s64 offen  lds
s_add_u32 s64,s74,4489216
s_add_u32 m0,s75,9216
s_nop 0
buffer_load_dwordx4 v9,s[32:35],s64 offen  lds
s_add_u32 s64,s74,4521984
s_add_u32 m0,s75,10240
s_nop 0
buffer_load_dwordx4 v10,s[32:35],s64 offen  lds
s_add_u32 s64,s74,4554752
s_add_u32 m0,s75,11264
s_nop 0
buffer_load_dwordx4 v11,s[32:35],s64 offen  lds
s_add_u32 s64,s74,4587520
s_add_u32 m0,s75,12288
s_nop 0
buffer_load_dwordx4 v8,s[32:35],s64 offen  lds
s_add_u32 s64,s74,4620288
s_add_u32 m0,s75,13312
s_nop 0
buffer_load_dwordx4 v9,s[32:35],s64 offen  lds
s_add_u32 s64,s74,4653056
s_add_u32 m0,s75,14336
s_nop 0
buffer_load_dwordx4 v10,s[32:35],s64 offen  lds
s_add_u32 s64,s74,4685824
s_add_u32 m0,s75,15360
s_nop 0
buffer_load_dwordx4 v11,s[32:35],s64 offen  lds
s_waitcnt vmcnt(16)
s_barrier
ds_read_b64_tr_b16 a[32:33],v12 offset:0
ds_read_b64_tr_b16 a[34:35],v12 offset:512
ds_read_b64_tr_b16 a[160:161],v12 offset:8
ds_read_b64_tr_b16 a[162:163],v12 offset:520
ds_read_b64_tr_b16 a[36:37],v12 offset:8192
ds_read_b64_tr_b16 a[38:39],v12 offset:8704
ds_read_b64_tr_b16 a[164:165],v12 offset:8200
ds_read_b64_tr_b16 a[166:167],v12 offset:8712
s_waitcnt lgkmcnt(4)
ds_read_b64_tr_b16 a[40:41],v12 offset:16384
ds_read_b64_tr_b16 a[42:43],v12 offset:16896
ds_read_b64_tr_b16 a[168:169],v12 offset:16392
ds_read_b64_tr_b16 a[170:171],v12 offset:16904
ds_read_b64_tr_b16 a[44:45],v12 offset:24576
ds_read_b64_tr_b16 a[46:47],v12 offset:25088
ds_read_b64_tr_b16 a[172:173],v12 offset:24584
ds_read_b64_tr_b16 a[174:175],v12 offset:25096
s_waitcnt lgkmcnt(4)
ds_read_b64_tr_b16 a[48:49],v12 offset:32768
ds_read_b64_tr_b16 a[50:51],v12 offset:33280
ds_read_b64_tr_b16 a[176:177],v12 offset:32776
ds_read_b64_tr_b16 a[178:179],v12 offset:33288
ds_read_b64_tr_b16 a[52:53],v12 offset:40960
ds_read_b64_tr_b16 a[54:55],v12 offset:41472
ds_read_b64_tr_b16 a[180:181],v12 offset:40968
ds_read_b64_tr_b16 a[182:183],v12 offset:41480
s_waitcnt lgkmcnt(4)
ds_read_b64_tr_b16 a[56:57],v12 offset:49152
ds_read_b64_tr_b16 a[58:59],v12 offset:49664
ds_read_b64_tr_b16 a[184:185],v12 offset:49160
ds_read_b64_tr_b16 a[186:187],v12 offset:49672
ds_read_b64_tr_b16 a[60:61],v12 offset:57344
ds_read_b64_tr_b16 a[62:63],v12 offset:57856
ds_read_b64_tr_b16 a[188:189],v12 offset:57352
ds_read_b64_tr_b16 a[190:191],v12 offset:57864
s_waitcnt lgkmcnt(4)
v_xor_b32 v12,0x10000,v12
s_waitcnt lgkmcnt(0)
s_barrier
s_add_u32 s64,s74,6291456
s_add_u32 m0,s75,65536
s_nop 0
buffer_load_dwordx4 v8,s[32:35],s64 offen  lds
s_add_u32 s64,s74,6324224
s_add_u32 m0,s75,66560
s_nop 0
buffer_load_dwordx4 v9,s[32:35],s64 offen  lds
s_add_u32 s64,s74,6356992
s_add_u32 m0,s75,67584
s_nop 0
buffer_load_dwordx4 v10,s[32:35],s64 offen  lds
s_add_u32 s64,s74,6389760
s_add_u32 m0,s75,68608
s_nop 0
buffer_load_dwordx4 v11,s[32:35],s64 offen  lds
s_add_u32 s64,s74,6422528
s_add_u32 m0,s75,69632
s_nop 0
buffer_load_dwordx4 v8,s[32:35],s64 offen  lds
s_add_u32 s64,s74,6455296
s_add_u32 m0,s75,70656
s_nop 0
buffer_load_dwordx4 v9,s[32:35],s64 offen  lds
s_add_u32 s64,s74,6488064
s_add_u32 m0,s75,71680
s_nop 0
buffer_load_dwordx4 v10,s[32:35],s64 offen  lds
s_add_u32 s64,s74,6520832
s_add_u32 m0,s75,72704
s_nop 0
buffer_load_dwordx4 v11,s[32:35],s64 offen  lds
s_add_u32 s64,s74,6553600
s_add_u32 m0,s75,73728
s_nop 0
buffer_load_dwordx4 v8,s[32:35],s64 offen  lds
s_add_u32 s64,s74,6586368
s_add_u32 m0,s75,74752
s_nop 0
buffer_load_dwordx4 v9,s[32:35],s64 offen  lds
s_add_u32 s64,s74,6619136
s_add_u32 m0,s75,75776
s_nop 0
buffer_load_dwordx4 v10,s[32:35],s64 offen  lds
s_add_u32 s64,s74,6651904
s_add_u32 m0,s75,76800
s_nop 0
buffer_load_dwordx4 v11,s[32:35],s64 offen  lds
s_add_u32 s64,s74,6684672
s_add_u32 m0,s75,77824
s_nop 0
buffer_load_dwordx4 v8,s[32:35],s64 offen  lds
s_add_u32 s64,s74,6717440
s_add_u32 m0,s75,78848
s_nop 0
buffer_load_dwordx4 v9,s[32:35],s64 offen  lds
s_add_u32 s64,s74,6750208
s_add_u32 m0,s75,79872
s_nop 0
buffer_load_dwordx4 v10,s[32:35],s64 offen  lds
s_add_u32 s64,s74,6782976
s_add_u32 m0,s75,80896
s_nop 0
buffer_load_dwordx4 v11,s[32:35],s64 offen  lds
s_waitcnt vmcnt(16)
s_barrier
ds_read_b64_tr_b16 a[64:65],v12 offset:0
ds_read_b64_tr_b16 a[66:67],v12 offset:512
ds_read_b64_tr_b16 a[192:193],v12 offset:8
ds_read_b64_tr_b16 a[194:195],v12 offset:520
ds_read_b64_tr_b16 a[68:69],v12 offset:8192
ds_read_b64_tr_b16 a[70:71],v12 offset:8704
ds_read_b64_tr_b16 a[196:197],v12 offset:8200
ds_read_b64_tr_b16 a[198:199],v12 offset:8712
s_waitcnt lgkmcnt(4)
ds_read_b64_tr_b16 a[72:73],v12 offset:16384
ds_read_b64_tr_b16 a[74:75],v12 offset:16896
ds_read_b64_tr_b16 a[200:201],v12 offset:16392
ds_read_b64_tr_b16 a[202:203],v12 offset:16904
ds_read_b64_tr_b16 a[76:77],v12 offset:24576
ds_read_b64_tr_b16 a[78:79],v12 offset:25088
ds_read_b64_tr_b16 a[204:205],v12 offset:24584
ds_read_b64_tr_b16 a[206:207],v12 offset:25096
s_waitcnt lgkmcnt(4)
ds_read_b64_tr_b16 a[80:81],v12 offset:32768
ds_read_b64_tr_b16 a[82:83],v12 offset:33280
ds_read_b64_tr_b16 a[208:209],v12 offset:32776
ds_read_b64_tr_b16 a[210:211],v12 offset:33288
ds_read_b64_tr_b16 a[84:85],v12 offset:40960
ds_read_b64_tr_b16 a[86:87],v12 offset:41472
ds_read_b64_tr_b16 a[212:213],v12 offset:40968
ds_read_b64_tr_b16 a[214:215],v12 offset:41480
s_waitcnt lgkmcnt(4)
ds_read_b64_tr_b16 a[88:89],v12 offset:49152
ds_read_b64_tr_b16 a[90:91],v12 offset:49664
ds_read_b64_tr_b16 a[216:217],v12 offset:49160
ds_read_b64_tr_b16 a[218:219],v12 offset:49672
ds_read_b64_tr_b16 a[92:93],v12 offset:57344
ds_read_b64_tr_b16 a[94:95],v12 offset:57856
ds_read_b64_tr_b16 a[220:221],v12 offset:57352
ds_read_b64_tr_b16 a[222:223],v12 offset:57864
s_waitcnt lgkmcnt(4)
v_xor_b32 v12,0x10000,v12
s_waitcnt lgkmcnt(0)
s_barrier
s_waitcnt vmcnt(0)
s_barrier
ds_read_b64_tr_b16 a[96:97],v12 offset:0
ds_read_b64_tr_b16 a[98:99],v12 offset:512
ds_read_b64_tr_b16 a[224:225],v12 offset:8
ds_read_b64_tr_b16 a[226:227],v12 offset:520
ds_read_b64_tr_b16 a[100:101],v12 offset:8192
ds_read_b64_tr_b16 a[102:103],v12 offset:8704
ds_read_b64_tr_b16 a[228:229],v12 offset:8200
ds_read_b64_tr_b16 a[230:231],v12 offset:8712
s_waitcnt lgkmcnt(4)
ds_read_b64_tr_b16 a[104:105],v12 offset:16384
ds_read_b64_tr_b16 a[106:107],v12 offset:16896
ds_read_b64_tr_b16 a[232:233],v12 offset:16392
ds_read_b64_tr_b16 a[234:235],v12 offset:16904
ds_read_b64_tr_b16 a[108:109],v12 offset:24576
ds_read_b64_tr_b16 a[110:111],v12 offset:25088
ds_read_b64_tr_b16 a[236:237],v12 offset:24584
ds_read_b64_tr_b16 a[238:239],v12 offset:25096
s_waitcnt lgkmcnt(4)
ds_read_b64_tr_b16 a[112:113],v12 offset:32768
ds_read_b64_tr_b16 a[114:115],v12 offset:33280
ds_read_b64_tr_b16 a[240:241],v12 offset:32776
ds_read_b64_tr_b16 a[242:243],v12 offset:33288
ds_read_b64_tr_b16 a[116:117],v12 offset:40960
ds_read_b64_tr_b16 a[118:119],v12 offset:41472
ds_read_b64_tr_b16 a[244:245],v12 offset:40968
ds_read_b64_tr_b16 a[246:247],v12 offset:41480
s_waitcnt lgkmcnt(4)
ds_read_b64_tr_b16 a[120:121],v12 offset:49152
ds_read_b64_tr_b16 a[122:123],v12 offset:49664
ds_read_b64_tr_b16 a[248:249],v12 offset:49160
ds_read_b64_tr_b16 a[250:251],v12 offset:49672
ds_read_b64_tr_b16 a[124:125],v12 offset:57344
ds_read_b64_tr_b16 a[126:127],v12 offset:57856
ds_read_b64_tr_b16 a[252:253],v12 offset:57352
ds_read_b64_tr_b16 a[254:255],v12 offset:57864
s_waitcnt lgkmcnt(4)
v_xor_b32 v12,0x10000,v12
s_waitcnt lgkmcnt(0)
s_barrier
v_and_b32 v21,7,v1
v_lshlrev_b32 v21,6,v21
s_mov_b32 s65,21052416
s_mov_b32 s66,1792
pl_173:
buffer_load_dword v22,v21,s[20:23],s65 offen sc1
s_waitcnt vmcnt(0)
v_cmp_gt_u32 vcc,s66,v22
s_cbranch_vccz pok_174
s_sleep 1
s_sub_u32 s90,s90,1
s_cmp_gt_i32 s90,0
s_cbranch_scc1 pl_173
pok_174:
s_lshl_b32 s72,s50,14
s_lshl_b32 s74,s58,16
s_add_u32 s74,s74,s72
s_add_u32 s74,s74,57344
v_mov_b32 v17,v16
s_lshl_b32 s64,s59,14
s_lshl_b32 s65,s50,11
s_add_u32 s64,s64,s65
v_add_u32 v18,s64,v16
s_lshl_b32 s73,s55,2
s_add_u32 s73,s73,s63
v_lshlrev_b32 v24,4,v0
s_mov_b32 s79,s58
s_add_u32 m0,s72,0
s_add_u32 s65,s74,0
buffer_load_dwordx4 v16,s[20:23],s65 offen offset:0  lds
buffer_load_dwordx4 v16,s[20:23],s65 offen offset:1024  lds
buffer_load_dwordx4 v16,s[20:23],s65 offen offset:2048  lds
buffer_load_dwordx4 v16,s[20:23],s65 offen offset:3072  lds
s_add_u32 m0,s72,4096
s_add_u32 s65,s74,4096
buffer_load_dwordx4 v16,s[20:23],s65 offen offset:0  lds
buffer_load_dwordx4 v16,s[20:23],s65 offen offset:1024  lds
buffer_load_dwordx4 v16,s[20:23],s65 offen offset:2048  lds
buffer_load_dwordx4 v16,s[20:23],s65 offen offset:3072  lds
s_add_u32 m0,s72,8192
s_add_u32 s65,s74,8192
buffer_load_dwordx4 v16,s[20:23],s65 offen offset:0  lds
buffer_load_dwordx4 v16,s[20:23],s65 offen offset:1024  lds
buffer_load_dwordx4 v16,s[20:23],s65 offen offset:2048  lds
buffer_load_dwordx4 v16,s[20:23],s65 offen offset:3072  lds
s_add_u32 m0,s72,12288
s_add_u32 s65,s74,12288
buffer_load_dwordx4 v16,s[20:23],s65 offen offset:0  lds
buffer_load_dwordx4 v16,s[20:23],s65 offen offset:1024  lds
buffer_load_dwordx4 v16,s[20:23],s65 offen offset:2048  lds
buffer_load_dwordx4 v16,s[20:23],s65 offen offset:3072  lds
s_waitcnt vmcnt(0)
qloop_175:
s_waitcnt vmcnt(10)
s_barrier
s_lshr_b32 s64,s79,2
s_cmp_lg_u32 s64,5
s_cbranch_scc1 npz_176
s_cmp_lg_u32 s50,0
s_cbranch_scc1 ow_177
s_mov_b64 exec,1
v_mov_b32 v22,14
v_mov_b32 v23,0
s_mov_b32 s64,21052928
buffer_atomic_add v22,v23,s[20:23],s64 offen sc1
s_mov_b64 exec,-1
ow_177:
npz_176:
s_cmp_lt_u32 s79,16
s_cselect_b32 s93,s93,0x7fff0000
s_xor_b32 s72,s72,0x10000
s_add_u32 s74,s74,262144
s_cmp_lt_u32 s79,60
s_cselect_b32 s74,s74,0x7fff0000
s_add_u32 s64,s79,0
s_lshl_b32 s70,s64,21
s_lshl_b32 s64,s64,13
s_and_b32 s64,s64,0x2000
s_xor_b32 s64,s64,s62
s_add_u32 s70,s70,s64
s_add_u32 s70,s70,29360128
ds_read_b128 v[32:35],v17 offset:0
ds_read_b128 v[36:39],v17 offset:1024
ds_read_b128 v[40:43],v17 offset:2048
s_waitcnt lgkmcnt(2)
v_mfma_f32_16x16x32_bf16 v[64:67],a[0:3],v[32:35],0
ds_read_b128 v[44:47],v17 offset:3072
v_mfma_f32_16x16x32_bf16 v[72:75],a[128:131],v[32:35],0
s_waitcnt lgkmcnt(2)
v_mfma_f32_16x16x32_bf16 v[68:71],a[0:3],v[36:39],0
ds_read_b128 v[32:35],v17 offset:4096
v_mfma_f32_16x16x32_bf16 v[76:79],a[128:131],v[36:39],0
s_waitcnt lgkmcnt(2)
v_mfma_f32_16x16x32_bf16 v[64:67],a[4:7],v[40:43],v[64:67]
ds_read_b128 v[36:39],v17 offset:5120
v_mfma_f32_16x16x32_bf16 v[72:75],a[132:135],v[40:43],v[72:75]
s_waitcnt lgkmcnt(2)
v_mfma_f32_16x16x32_bf16 v[68:71],a[4:7],v[44:47],v[68:71]
ds_read_b128 v[40:43],v17 offset:6144
v_mfma_f32_16x16x32_bf16 v[76:79],a[132:135],v[44:47],v[76:79]
s_waitcnt lgkmcnt(2)
v_mfma_f32_16x16x32_bf16 v[64:67],a[8:11],v[32:35],v[64:67]
ds_read_b128 v[44:47],v17 offset:7168
s_add_u32 m0,s72,0
s_add_u32 s65,s74,0
v_mfma_f32_16x16x32_bf16 v[72:75],a[136:139],v[32:35],v[72:75]
s_waitcnt lgkmcnt(2)
v_mfma_f32_16x16x32_bf16 v[68:71],a[8:11],v[36:39],v[68:71]
ds_read_b128 v[32:35],v17 offset:8192
v_mfma_f32_16x16x32_bf16 v[76:79],a[136:139],v[36:39],v[76:79]
s_waitcnt lgkmcnt(2)
v_mfma_f32_16x16x32_bf16 v[64:67],a[12:15],v[40:43],v[64:67]
ds_read_b128 v[36:39],v17 offset:9216
v_mfma_f32_16x16x32_bf16 v[72:75],a[140:143],v[40:43],v[72:75]
buffer_load_dwordx4 v16,s[20:23],s65 offen offset:0  lds
s_waitcnt lgkmcnt(2)
v_mfma_f32_16x16x32_bf16 v[68:71],a[12:15],v[44:47],v[68:71]
ds_read_b128 v[40:43],v17 offset:10240
v_mfma_f32_16x16x32_bf16 v[76:79],a[140:143],v[44:47],v[76:79]
s_waitcnt lgkmcnt(2)
v_mfma_f32_16x16x32_bf16 v[64:67],a[16:19],v[32:35],v[64:67]
ds_read_b128 v[44:47],v17 offset:11264
v_mfma_f32_16x16x32_bf16 v[72:75],a[144:147],v[32:35],v[72:75]
s_waitcnt lgkmcnt(2)
v_mfma_f32_16x16x32_bf16 v[68:71],a[16:19],v[36:39],v[68:71]
ds_read_b128 v[32:35],v17 offset:12288
buffer_load_dwordx4 v16,s[20:23],s65 offen offset:1024  lds
v_mfma_f32_16x16x32_bf16 v[76:79],a[144:147],v[36:39],v[76:79]
s_waitcnt lgkmcnt(2)
v_mfma_f32_16x16x32_bf16 v[64:67],a[20:23],v[40:43],v[64:67]
ds_read_b128 v[36:39],v17 offset:13312
v_mfma_f32_16x16x32_bf16 v[72:75],a[148:151],v[40:43],v[72:75]
s_waitcnt lgkmcnt(2)
v_mfma_f32_16x16x32_bf16 v[68:71],a[20:23],v[44:47],v[68:71]
ds_read_b128 v[40:43],v17 offset:14336
v_mfma_f32_16x16x32_bf16 v[76:79],a[148:151],v[44:47],v[76:79]
buffer_load_dwordx4 v16,s[20:23],s65 offen offset:2048  lds
s_waitcnt lgkmcnt(2)
v_mfma_f32_16x16x32_bf16 v[64:67],a[24:27],v[32:35],v[64:67]
ds_read_b128 v[44:47],v17 offset:15360
v_mfma_f32_16x16x32_bf16 v[72:75],a[152:155],v[32:35],v[72:75]
s_waitcnt lgkmcnt(2)
v_mfma_f32_16x16x32_bf16 v[68:71],a[24:27],v[36:39],v[68:71]
ds_read_b128 v[32:35],v17 offset:16384
v_mfma_f32_16x16x32_bf16 v[76:79],a[152:155],v[36:39],v[76:79]
s_waitcnt lgkmcnt(2)
v_mfma_f32_16x16x32_bf16 v[64:67],a[28:31],v[40:43],v[64:67]
ds_read_b128 v[36:39],v17 offset:17408
buffer_load_dwordx4 v16,s[20:23],s65 offen offset:3072  lds
v_mfma_f32_16x16x32_bf16 v[72:75],a[156:159],v[40:43],v[72:75]
s_waitcnt lgkmcnt(2)
v_mfma_f32_16x16x32_bf16 v[68:71],a[28:31],v[44:47],v[68:71]
ds_read_b128 v[40:43],v17 offset:18432
v_mfma_f32_16x16x32_bf16 v[76:79],a[156:159],v[44:47],v[76:79]
s_waitcnt lgkmcnt(2)
v_mfma_f32_16x16x32_bf16 v[64:67],a[32:35],v[32:35],v[64:67]
ds_read_b128 v[44:47],v17 offset:19456
s_add_u32 m0,s72,4096
s_add_u32 s65,s74,4096
v_mfma_f32_16x16x32_bf16 v[72:75],a[160:163],v[32:35],v[72:75]
s_waitcnt lgkmcnt(2)
v_mfma_f32_16x16x32_bf16 v[68:71],a[32:35],v[36:39],v[68:71]
ds_read_b128 v[32:35],v17 offset:20480
v_mfma_f32_16x16x32_bf16 v[76:79],a[160:163],v[36:39],v[76:79]
s_waitcnt lgkmcnt(2)
v_mfma_f32_16x16x32_bf16 v[64:67],a[36:39],v[40:43],v[64:67]
ds_read_b128 v[36:39],v17 offset:21504
v_mfma_f32_16x16x32_bf16 v[72:75],a[164:167],v[40:43],v[72:75]
buffer_load_dwordx4 v16,s[20:23],s65 offen offset:0  lds
s_waitcnt lgkmcnt(2)
v_mfma_f32_16x16x32_bf16 v[68:71],a[36:39],v[44:47],v[68:71]
ds_read_b128 v[40:43],v17 offset:22528
v_mfma_f32_16x16x32_bf16 v[76:79],a[164:167],v[44:47],v[76:79]
s_waitcnt lgkmcnt(2)
v_mfma_f32_16x16x32_bf16 v[64:67],a[40:43],v[32:35],v[64:67]
ds_read_b128 v[44:47],v17 offset:23552
v_mfma_f32_16x16x32_bf16 v[72:75],a[168:171],v[32:35],v[72:75]
s_waitcnt lgkmcnt(2)
v_mfma_f32_16x16x32_bf16 v[68:71],a[40:43],v[36:39],v[68:71]
ds_read_b128 v[32:35],v17 offset:24576
buffer_load_dwordx4 v16,s[20:23],s65 offen offset:1024  lds
v_mfma_f32_16x16x32_bf16 v[76:79],a[168:171],v[36:39],v[76:79]
s_waitcnt lgkmcnt(2)
v_mfma_f32_16x16x32_bf16 v[64:67],a[44:47],v[40:43],v[64:67]
ds_read_b128 v[36:39],v17 offset:25600
v_mfma_f32_16x16x32_bf16 v[72:75],a[172:175],v[40:43],v[72:75]
s_waitcnt lgkmcnt(2)
v_mfma_f32_16x16x32_bf16 v[68:71],a[44:47],v[44:47],v[68:71]
ds_read_b128 v[40:43],v17 offset:26624
v_mfma_f32_16x16x32_bf16 v[76:79],a[172:175],v[44:47],v[76:79]
buffer_load_dwordx4 v16,s[20:23],s65 offen offset:2048  lds
s_waitcnt lgkmcnt(2)
v_mfma_f32_16x16x32_bf16 v[64:67],a[48:51],v[32:35],v[64:67]
ds_read_b128 v[44:47],v17 offset:27648
v_mfma_f32_16x16x32_bf16 v[72:75],a[176:179],v[32:35],v[72:75]
s_waitcnt lgkmcnt(2)
v_mfma_f32_16x16x32_bf16 v[68:71],a[48:51],v[36:39],v[68:71]
ds_read_b128 v[32:35],v17 offset:28672
v_mfma_f32_16x16x32_bf16 v[76:79],a[176:179],v[36:39],v[76:79]
s_waitcnt lgkmcnt(2)
v_mfma_f32_16x16x32_bf16 v[64:67],a[52:55],v[40:43],v[64:67]
ds_read_b128 v[36:39],v17 offset:29696
buffer_load_dwordx4 v16,s[20:23],s65 offen offset:3072  lds
v_mfma_f32_16x16x32_bf16 v[72:75],a[180:183],v[40:43],v[72:75]
s_waitcnt lgkmcnt(2)
v_mfma_f32_16x16x32_bf16 v[68:71],a[52:55],v[44:47],v[68:71]
ds_read_b128 v[40:43],v17 offset:30720
v_mfma_f32_16x16x32_bf16 v[76:79],a[180:183],v[44:47],v[76:79]
s_waitcnt lgkmcnt(2)
v_mfma_f32_16x16x32_bf16 v[64:67],a[56:59],v[32:35],v[64:67]
ds_read_b128 v[44:47],v17 offset:31744
s_add_u32 m0,s72,8192
s_add_u32 s65,s74,8192
v_mfma_f32_16x16x32_bf16 v[72:75],a[184:187],v[32:35],v[72:75]
s_waitcnt lgkmcnt(2)
v_mfma_f32_16x16x32_bf16 v[68:71],a[56:59],v[36:39],v[68:71]
ds_read_b128 v[32:35],v17 offset:32768
v_mfma_f32_16x16x32_bf16 v[76:79],a[184:187],v[36:39],v[76:79]
s_waitcnt lgkmcnt(2)
v_mfma_f32_16x16x32_bf16 v[64:67],a[60:63],v[40:43],v[64:67]
ds_read_b128 v[36:39],v17 offset:33792
v_mfma_f32_16x16x32_bf16 v[72:75],a[188:191],v[40:43],v[72:75]
buffer_load_dwordx4 v16,s[20:23],s65 offen offset:0  lds
s_waitcnt lgkmcnt(2)
v_mfma_f32_16x16x32_bf16 v[68:71],a[60:63],v[44:47],v[68:71]
ds_read_b128 v[40:43],v17 offset:34816
v_mfma_f32_16x16x32_bf16 v[76:79],a[188:191],v[44:47],v[76:79]
s_waitcnt lgkmcnt(2)
v_mfma_f32_16x16x32_bf16 v[64:67],a[64:67],v[32:35],v[64:67]
ds_read_b128 v[44:47],v17 offset:35840
v_mfma_f32_16x16x32_bf16 v[72:75],a[192:195],v[32:35],v[72:75]
s_waitcnt lgkmcnt(2)
v_mfma_f32_16x16x32_bf16 v[68:71],a[64:67],v[36:39],v[68:71]
ds_read_b128 v[32:35],v17 offset:36864
buffer_load_dwordx4 v16,s[20:23],s65 offen offset:1024  lds
v_mfma_f32_16x16x32_bf16 v[76:79],a[192:195],v[36:39],v[76:79]
s_waitcnt lgkmcnt(2)
v_mfma_f32_16x16x32_bf16 v[64:67],a[68:71],v[40:43],v[64:67]
ds_read_b128 v[36:39],v17 offset:37888
v_mfma_f32_16x16x32_bf16 v[72:75],a[196:199],v[40:43],v[72:75]
s_waitcnt lgkmcnt(2)
v_mfma_f32_16x16x32_bf16 v[68:71],a[68:71],v[44:47],v[68:71]
ds_read_b128 v[40:43],v17 offset:38912
v_mfma_f32_16x16x32_bf16 v[76:79],a[196:199],v[44:47],v[76:79]
buffer_load_dwordx4 v16,s[20:23],s65 offen offset:2048  lds
s_waitcnt lgkmcnt(2)
v_mfma_f32_16x16x32_bf16 v[64:67],a[72:75],v[32:35],v[64:67]
ds_read_b128 v[44:47],v17 offset:39936
v_mfma_f32_16x16x32_bf16 v[72:75],a[200:203],v[32:35],v[72:75]
s_waitcnt lgkmcnt(2)
v_mfma_f32_16x16x32_bf16 v[68:71],a[72:75],v[36:39],v[68:71]
ds_read_b128 v[32:35],v17 offset:40960
v_mfma_f32_16x16x32_bf16 v[76:79],a[200:203],v[36:39],v[76:79]
s_waitcnt lgkmcnt(2)
v_mfma_f32_16x16x32_bf16 v[64:67],a[76:79],v[40:43],v[64:67]
ds_read_b128 v[36:39],v17 offset:41984
buffer_load_dwordx4 v16,s[20:23],s65 offen offset:3072  lds
v_mfma_f32_16x16x32_bf16 v[72:75],a[204:207],v[40:43],v[72:75]
s_waitcnt lgkmcnt(2)
v_mfma_f32_16x16x32_bf16 v[68:71],a[76:79],v[44:47],v[68:71]
ds_read_b128 v[40:43],v17 offset:43008
v_mfma_f32_16x16x32_bf16 v[76:79],a[204:207],v[44:47],v[76:79]
s_waitcnt lgkmcnt(2)
v_mfma_f32_16x16x32_bf16 v[64:67],a[80:83],v[32:35],v[64:67]
ds_read_b128 v[44:47],v17 offset:44032
s_add_u32 m0,s72,12288
s_add_u32 s65,s74,12288
v_mfma_f32_16x16x32_bf16 v[72:75],a[208:211],v[32:35],v[72:75]
s_waitcnt lgkmcnt(2)
v_mfma_f32_16x16x32_bf16 v[68:71],a[80:83],v[36:39],v[68:71]
ds_read_b128 v[32:35],v17 offset:45056
v_mfma_f32_16x16x32_bf16 v[76:79],a[208:211],v[36:39],v[76:79]
s_waitcnt lgkmcnt(2)
v_mfma_f32_16x16x32_bf16 v[64:67],a[84:87],v[40:43],v[64:67]
ds_read_b128 v[36:39],v17 offset:46080
v_mfma_f32_16x16x32_bf16 v[72:75],a[212:215],v[40:43],v[72:75]
buffer_load_dwordx4 v16,s[20:23],s65 offen offset:0  lds
s_waitcnt lgkmcnt(2)
v_mfma_f32_16x16x32_bf16 v[68:71],a[84:87],v[44:47],v[68:71]
ds_read_b128 v[40:43],v17 offset:47104
v_mfma_f32_16x16x32_bf16 v[76:79],a[212:215],v[44:47],v[76:79]
s_waitcnt lgkmcnt(2)
v_mfma_f32_16x16x32_bf16 v[64:67],a[88:91],v[32:35],v[64:67]
ds_read_b128 v[44:47],v17 offset:48128
v_mfma_f32_16x16x32_bf16 v[72:75],a[216:219],v[32:35],v[72:75]
s_waitcnt lgkmcnt(2)
v_mfma_f32_16x16x32_bf16 v[68:71],a[88:91],v[36:39],v[68:71]
ds_read_b128 v[32:35],v17 offset:49152
buffer_load_dwordx4 v16,s[20:23],s65 offen offset:1024  lds
v_mfma_f32_16x16x32_bf16 v[76:79],a[216:219],v[36:39],v[76:79]
s_waitcnt lgkmcnt(2)
v_mfma_f32_16x16x32_bf16 v[64:67],a[92:95],v[40:43],v[64:67]
ds_read_b128 v[36:39],v17 offset:50176
v_mfma_f32_16x16x32_bf16 v[72:75],a[220:223],v[40:43],v[72:75]
s_waitcnt lgkmcnt(2)
v_mfma_f32_16x16x32_bf16 v[68:71],a[92:95],v[44:47],v[68:71]
ds_read_b128 v[40:43],v17 offset:51200
v_mfma_f32_16x16x32_bf16 v[76:79],a[220:223],v[44:47],v[76:79]
buffer_load_dwordx4 v16,s[20:23],s65 offen offset:2048  lds
s_waitcnt lgkmcnt(2)
v_mfma_f32_16x16x32_bf16 v[64:67],a[96:99],v[32:35],v[64:67]
ds_read_b128 v[44:47],v17 offset:52224
v_mfma_f32_16x16x32_bf16 v[72:75],a[224:227],v[32:35],v[72:75]
s_waitcnt lgkmcnt(2)
v_mfma_f32_16x16x32_bf16 v[68:71],a[96:99],v[36:39],v[68:71]
ds_read_b128 v[32:35],v17 offset:53248
v_mfma_f32_16x16x32_bf16 v[76:79],a[224:227],v[36:39],v[76:79]
s_waitcnt lgkmcnt(2)
v_mfma_f32_16x16x32_bf16 v[64:67],a[100:103],v[40:43],v[64:67]
ds_read_b128 v[36:39],v17 offset:54272
buffer_load_dwordx4 v16,s[20:23],s65 offen offset:3072  lds
v_mfma_f32_16x16x32_bf16 v[72:75],a[228:231],v[40:43],v[72:75]
s_waitcnt lgkmcnt(2)
v_mfma_f32_16x16x32_bf16 v[68:71],a[100:103],v[44:47],v[68:71]
ds_read_b128 v[40:43],v17 offset:55296
v_mfma_f32_16x16x32_bf16 v[76:79],a[228:231],v[44:47],v[76:79]
s_waitcnt lgkmcnt(2)
v_mfma_f32_16x16x32_bf16 v[64:67],a[104:107],v[32:35],v[64:67]
ds_read_b128 v[44:47],v17 offset:56320
buffer_store_dwordx4 v[48:51],v24,s[20:23],s93 offen sc1
s_add_u32 s93,s93,4096
v_mfma_f32_16x16x32_bf16 v[72:75],a[232:235],v[32:35],v[72:75]
s_waitcnt lgkmcnt(2)
v_mfma_f32_16x16x32_bf16 v[68:71],a[104:107],v[36:39],v[68:71]
ds_read_b128 v[32:35],v17 offset:57344
v_mfma_f32_16x16x32_bf16 v[76:79],a[232:235],v[36:39],v[76:79]
buffer_store_dwordx4 v[48:51],v24,s[20:23],s93 offen sc1
s_add_u32 s93,s93,12288
s_waitcnt lgkmcnt(2)
v_mfma_f32_16x16x32_bf16 v[64:67],a[108:111],v[40:43],v[64:67]
ds_read_b128 v[36:39],v17 offset:58368
v_mfma_f32_16x16x32_bf16 v[72:75],a[236:239],v[40:43],v[72:75]
s_waitcnt lgkmcnt(2)
v_mfma_f32_16x16x32_bf16 v[68:71],a[108:111],v[44:47],v[68:71]
ds_read_b128 v[40:43],v17 offset:59392
buffer_store_dwordx4 v[48:51],v24,s[20:23],s93 offen sc1
s_add_u32 s93,s93,4096
v_mfma_f32_16x16x32_bf16 v[76:79],a[236:239],v[44:47],v[76:79]
s_waitcnt lgkmcnt(2)
v_mfma_f32_16x16x32_bf16 v[64:67],a[112:115],v[32:35],v[64:67]
ds_read_b128 v[44:47],v17 offset:60416
v_mfma_f32_16x16x32_bf16 v[72:75],a[240:243],v[32:35],v[72:75]
buffer_store_dwordx4 v[48:51],v24,s[20:23],s93 offen sc1
s_add_u32 s93,s93,12288
s_waitcnt lgkmcnt(2)
v_mfma_f32_16x16x32_bf16 v[68:71],a[112:115],v[36:39],v[68:71]
ds_read_b128 v[32:35],v17 offset:61440
v_mfma_f32_16x16x32_bf16 v[76:79],a[240:243],v[36:39],v[76:79]
s_waitcnt lgkmcnt(2)
v_mfma_f32_16x16x32_bf16 v[64:67],a[116:119],v[40:43],v[64:67]
ds_read_b128 v[36:39],v17 offset:62464
buffer_store_dwordx4 v[48:51],v24,s[20:23],s93 offen sc1
s_add_u32 s93,s93,4096
v_mfma_f32_16x16x32_bf16 v[72:75],a[244:247],v[40:43],v[72:75]
s_waitcnt lgkmcnt(2)
v_mfma_f32_16x16x32_bf16 v[68:71],a[116:119],v[44:47],v[68:71]
ds_read_b128 v[40:43],v17 offset:63488
v_mfma_f32_16x16x32_bf16 v[76:79],a[244:247],v[44:47],v[76:79]
buffer_store_dwordx4 v[48:51],v24,s[20:23],s93 offen sc1
s_add_u32 s93,s93,12288
s_waitcnt lgkmcnt(2)
v_mfma_f32_16x16x32_bf16 v[64:67],a[120:123],v[32:35],v[64:67]
ds_read_b128 v[44:47],v17 offset:64512
v_mfma_f32_16x16x32_bf16 v[72:75],a[248:251],v[32:35],v[72:75]
s_waitcnt lgkmcnt(2)
v_mfma_f32_16x16x32_bf16 v[68:71],a[120:123],v[36:39],v[68:71]
buffer_store_dwordx4 v[48:51],v24,s[20:23],s93 offen sc1
s_add_u32 s93,s93,4096
v_mfma_f32_16x16x32_bf16 v[76:79],a[248:251],v[36:39],v[76:79]
s_waitcnt lgkmcnt(1)
v_mfma_f32_16x16x32_bf16 v[64:67],a[124:127],v[40:43],v[64:67]
v_mfma_f32_16x16x32_bf16 v[72:75],a[252:255],v[40:43],v[72:75]
buffer_store_dwordx4 v[48:51],v24,s[20:23],s93 offen sc1
s_add_u32 s93,s93,12288
s_waitcnt lgkmcnt(0)
v_mfma_f32_16x16x32_bf16 v[68:71],a[124:127],v[44:47],v[68:71]
v_mfma_f32_16x16x32_bf16 v[76:79],a[252:255],v[44:47],v[76:79]
v_xor_b32 v17,0x10000,v17
s_add_u32 s79,s79,4
v_cvt_pk_bf16_f32 v88,v64,v65
v_cvt_pk_bf16_f32 v89,v66,v67
v_cvt_pk_bf16_f32 v90,v72,v73
v_cvt_pk_bf16_f32 v91,v74,v75
buffer_store_dwordx4 v[88:91],v18,s[20:23],s70 offen offset:0 sc1
v_cvt_pk_bf16_f32 v92,v68,v69
v_cvt_pk_bf16_f32 v93,v70,v71
v_cvt_pk_bf16_f32 v94,v76,v77
v_cvt_pk_bf16_f32 v95,v78,v79
buffer_store_dwordx4 v[92:95],v18,s[20:23],s70 offen offset:1024 sc1
s_cmp_lt_u32 s79,64
s_cbranch_scc1 qloop_175
s_waitcnt vmcnt(0)
s_barrier
s_cmp_lg_u32 s50,0
s_cbranch_scc1 ow_178
s_mov_b64 exec,1
v_mov_b32 v22,16
v_mov_b32 v23,0
buffer_store_dword v22,v23,s[20:23],s73 offen sc1
s_mov_b64 exec,-1
ow_178:
s_add_u32 s40,s55,64
pmod_180:
s_load_dwordx2 s[4:5],s[0:1],96
s_load_dwordx2 s[6:7],s[0:1],104
s_load_dwordx2 s[8:9],s[0:1],128
s_waitcnt lgkmcnt(0)
s_mov_b32 s12,s4
s_and_b32 s13,s5,0xffff
s_mov_b32 s14,0x800
s_mov_b32 s15,0x20000
s_mov_b32 s16,s6
s_and_b32 s17,s7,0xffff
s_mov_b32 s18,0xc00000
s_mov_b32 s19,0x20000
s_mov_b32 s20,s8
s_and_b32 s21,s9,0xffff
s_mov_b32 s22,0x10000000
s_mov_b32 s23,0x20000
v_and_b32 v1,3,v0
v_lshrrev_b32 v2,2,v0
v_mul_u32_u24 v3,12288,v2
v_lshl_add_u32 v3,v1,4,v3
s_lshl_b32 s24,s40,6
v_lshlrev_b32 v4,1,v2
s_add_u32 s25,s24,0
buffer_load_dwordx4 v[32:35],v3,s[16:19],s25 offen
s_add_u32 s25,s24,786432
buffer_load_dwordx4 v[36:39],v3,s[16:19],s25 offen
s_add_u32 s25,s24,1572864
buffer_load_dwordx4 v[40:43],v3,s[16:19],s25 offen
s_add_u32 s25,s24,2359296
buffer_load_dwordx4 v[44:47],v3,s[16:19],s25 offen
s_add_u32 s25,s24,3145728
buffer_load_dwordx4 v[48:51],v3,s[16:19],s25 offen
s_add_u32 s25,s24,3932160
buffer_load_dwordx4 v[52:55],v3,s[16:19],s25 offen
s_add_u32 s25,s24,4718592
buffer_load_dwordx4 v[56:59],v3,s[16:19],s25 offen
s_add_u32 s25,s24,5505024
buffer_load_dwordx4 v[60:63],v3,s[16:19],s25 offen
s_add_u32 s25,s24,6291456
buffer_load_dwordx4 v[64:67],v3,s[16:19],s25 offen
s_add_u32 s25,s24,7077888
buffer_load_dwordx4 v[68:71],v3,s[16:19],s25 offen
s_add_u32 s25,s24,7864320
buffer_load_dwordx4 v[72:75],v3,s[16:19],s25 offen
s_add_u32 s25,s24,8650752
buffer_load_dwordx4 v[76:79],v3,s[16:19],s25 offen
s_add_u32 s25,s24,9437184
buffer_load_dwordx4 v[80:83],v3,s[16:19],s25 offen
s_add_u32 s25,s24,10223616
buffer_load_dwordx4 v[84:87],v3,s[16:19],s25 offen
s_add_u32 s25,s24,11010048
buffer_load_dwordx4 v[88:91],v3,s[16:19],s25 offen
s_add_u32 s25,s24,11796480
buffer_load_dwordx4 v[92:95],v3,s[16:19],s25 offen
buffer_load_ushort v8,v4,s[12:15],0 offen offset:0
buffer_load_ushort v9,v4,s[12:15],0 offen offset:128
buffer_load_ushort v10,v4,s[12:15],0 offen offset:256
buffer_load_ushort v11,v4,s[12:15],0 offen offset:384
buffer_load_ushort v12,v4,s[12:15],0 offen offset:512
buffer_load_ushort v13,v4,s[12:15],0 offen offset:640
buffer_load_ushort v14,v4,s[12:15],0 offen offset:768
buffer_load_ushort v15,v4,s[12:15],0 offen offset:896
buffer_load_ushort v16,v4,s[12:15],0 offen offset:1024
buffer_load_ushort v17,v4,s[12:15],0 offen offset:1152
buffer_load_ushort v18,v4,s[12:15],0 offen offset:1280
buffer_load_ushort v19,v4,s[12:15],0 offen offset:1408
buffer_load_ushort v20,v4,s[12:15],0 offen offset:1536
buffer_load_ushort v21,v4,s[12:15],0 offen offset:1664
buffer_load_ushort v22,v4,s[12:15],0 offen offset:1792
buffer_load_ushort v23,v4,s[12:15],0 offen offset:1920
v_mov_b32 v24,0
v_mov_b32 v25,0
v_mov_b32 v26,0
v_mov_b32 v27,0
v_mov_b32 v28,0
v_mov_b32 v29,0
v_mov_b32 v30,0
v_mov_b32 v31,0
s_waitcnt vmcnt(0)
s_mov_b32 s26,0xbfb8aa3b
s_mov_b32 s27,0xffff0000
v_lshlrev_b32 v8,16,v8
v_mul_f32 v5,s26,v8
v_exp_f32 v5,v5
s_nop 0
v_add_f32 v5,1.0,v5
v_rcp_f32 v5,v5
s_nop 0
v_mul_f32 v5,v5,v8
v_cvt_pk_bf16_f32 v5,v5,v5
v_and_b32 v8,s27,v5
v_lshlrev_b32 v6,16,v32
v_and_b32 v7,s27,v32
v_fmac_f32 v24,v6,v8
v_fmac_f32 v25,v7,v8
v_lshlrev_b32 v6,16,v33
v_and_b32 v7,s27,v33
v_fmac_f32 v26,v6,v8
v_fmac_f32 v27,v7,v8
v_lshlrev_b32 v6,16,v34
v_and_b32 v7,s27,v34
v_fmac_f32 v28,v6,v8
v_fmac_f32 v29,v7,v8
v_lshlrev_b32 v6,16,v35
v_and_b32 v7,s27,v35
v_fmac_f32 v30,v6,v8
v_fmac_f32 v31,v7,v8
v_lshlrev_b32 v9,16,v9
v_mul_f32 v5,s26,v9
v_exp_f32 v5,v5
s_nop 0
v_add_f32 v5,1.0,v5
v_rcp_f32 v5,v5
s_nop 0
v_mul_f32 v5,v5,v9
v_cvt_pk_bf16_f32 v5,v5,v5
v_and_b32 v9,s27,v5
v_lshlrev_b32 v6,16,v36
v_and_b32 v7,s27,v36
v_fmac_f32 v24,v6,v9
v_fmac_f32 v25,v7,v9
v_lshlrev_b32 v6,16,v37
v_and_b32 v7,s27,v37
v_fmac_f32 v26,v6,v9
v_fmac_f32 v27,v7,v9
v_lshlrev_b32 v6,16,v38
v_and_b32 v7,s27,v38
v_fmac_f32 v28,v6,v9
v_fmac_f32 v29,v7,v9
v_lshlrev_b32 v6,16,v39
v_and_b32 v7,s27,v39
v_fmac_f32 v30,v6,v9
v_fmac_f32 v31,v7,v9
v_lshlrev_b32 v10,16,v10
v_mul_f32 v5,s26,v10
v_exp_f32 v5,v5
s_nop 0
v_add_f32 v5,1.0,v5
v_rcp_f32 v5,v5
s_nop 0
v_mul_f32 v5,v5,v10
v_cvt_pk_bf16_f32 v5,v5,v5
v_and_b32 v10,s27,v5
v_lshlrev_b32 v6,16,v40
v_and_b32 v7,s27,v40
v_fmac_f32 v24,v6,v10
v_fmac_f32 v25,v7,v10
v_lshlrev_b32 v6,16,v41
v_and_b32 v7,s27,v41
v_fmac_f32 v26,v6,v10
v_fmac_f32 v27,v7,v10
v_lshlrev_b32 v6,16,v42
v_and_b32 v7,s27,v42
v_fmac_f32 v28,v6,v10
v_fmac_f32 v29,v7,v10
v_lshlrev_b32 v6,16,v43
v_and_b32 v7,s27,v43
v_fmac_f32 v30,v6,v10
v_fmac_f32 v31,v7,v10
v_lshlrev_b32 v11,16,v11
v_mul_f32 v5,s26,v11
v_exp_f32 v5,v5
s_nop 0
v_add_f32 v5,1.0,v5
v_rcp_f32 v5,v5
s_nop 0
v_mul_f32 v5,v5,v11
v_cvt_pk_bf16_f32 v5,v5,v5
v_and_b32 v11,s27,v5
v_lshlrev_b32 v6,16,v44
v_and_b32 v7,s27,v44
v_fmac_f32 v24,v6,v11
v_fmac_f32 v25,v7,v11
v_lshlrev_b32 v6,16,v45
v_and_b32 v7,s27,v45
v_fmac_f32 v26,v6,v11
v_fmac_f32 v27,v7,v11
v_lshlrev_b32 v6,16,v46
v_and_b32 v7,s27,v46
v_fmac_f32 v28,v6,v11
v_fmac_f32 v29,v7,v11
v_lshlrev_b32 v6,16,v47
v_and_b32 v7,s27,v47
v_fmac_f32 v30,v6,v11
v_fmac_f32 v31,v7,v11
v_lshlrev_b32 v12,16,v12
v_mul_f32 v5,s26,v12
v_exp_f32 v5,v5
s_nop 0
v_add_f32 v5,1.0,v5
v_rcp_f32 v5,v5
s_nop 0
v_mul_f32 v5,v5,v12
v_cvt_pk_bf16_f32 v5,v5,v5
v_and_b32 v12,s27,v5
v_lshlrev_b32 v6,16,v48
v_and_b32 v7,s27,v48
v_fmac_f32 v24,v6,v12
v_fmac_f32 v25,v7,v12
v_lshlrev_b32 v6,16,v49
v_and_b32 v7,s27,v49
v_fmac_f32 v26,v6,v12
v_fmac_f32 v27,v7,v12
v_lshlrev_b32 v6,16,v50
v_and_b32 v7,s27,v50
v_fmac_f32 v28,v6,v12
v_fmac_f32 v29,v7,v12
v_lshlrev_b32 v6,16,v51
v_and_b32 v7,s27,v51
v_fmac_f32 v30,v6,v12
v_fmac_f32 v31,v7,v12
v_lshlrev_b32 v13,16,v13
v_mul_f32 v5,s26,v13
v_exp_f32 v5,v5
s_nop 0
v_add_f32 v5,1.0,v5
v_rcp_f32 v5,v5
s_nop 0
v_mul_f32 v5,v5,v13
v_cvt_pk_bf16_f32 v5,v5,v5
v_and_b32 v13,s27,v5
v_lshlrev_b32 v6,16,v52
v_and_b32 v7,s27,v52
v_fmac_f32 v24,v6,v13
v_fmac_f32 v25,v7,v13
v_lshlrev_b32 v6,16,v53
v_and_b32 v7,s27,v53
v_fmac_f32 v26,v6,v13
v_fmac_f32 v27,v7,v13
v_lshlrev_b32 v6,16,v54
v_and_b32 v7,s27,v54
v_fmac_f32 v28,v6,v13
v_fmac_f32 v29,v7,v13
v_lshlrev_b32 v6,16,v55
v_and_b32 v7,s27,v55
v_fmac_f32 v30,v6,v13
v_fmac_f32 v31,v7,v13
v_lshlrev_b32 v14,16,v14
v_mul_f32 v5,s26,v14
v_exp_f32 v5,v5
s_nop 0
v_add_f32 v5,1.0,v5
v_rcp_f32 v5,v5
s_nop 0
v_mul_f32 v5,v5,v14
v_cvt_pk_bf16_f32 v5,v5,v5
v_and_b32 v14,s27,v5
v_lshlrev_b32 v6,16,v56
v_and_b32 v7,s27,v56
v_fmac_f32 v24,v6,v14
v_fmac_f32 v25,v7,v14
v_lshlrev_b32 v6,16,v57
v_and_b32 v7,s27,v57
v_fmac_f32 v26,v6,v14
v_fmac_f32 v27,v7,v14
v_lshlrev_b32 v6,16,v58
v_and_b32 v7,s27,v58
v_fmac_f32 v28,v6,v14
v_fmac_f32 v29,v7,v14
v_lshlrev_b32 v6,16,v59
v_and_b32 v7,s27,v59
v_fmac_f32 v30,v6,v14
v_fmac_f32 v31,v7,v14
v_lshlrev_b32 v15,16,v15
v_mul_f32 v5,s26,v15
v_exp_f32 v5,v5
s_nop 0
v_add_f32 v5,1.0,v5
v_rcp_f32 v5,v5
s_nop 0
v_mul_f32 v5,v5,v15
v_cvt_pk_bf16_f32 v5,v5,v5
v_and_b32 v15,s27,v5
v_lshlrev_b32 v6,16,v60
v_and_b32 v7,s27,v60
v_fmac_f32 v24,v6,v15
v_fmac_f32 v25,v7,v15
v_lshlrev_b32 v6,16,v61
v_and_b32 v7,s27,v61
v_fmac_f32 v26,v6,v15
v_fmac_f32 v27,v7,v15
v_lshlrev_b32 v6,16,v62
v_and_b32 v7,s27,v62
v_fmac_f32 v28,v6,v15
v_fmac_f32 v29,v7,v15
v_lshlrev_b32 v6,16,v63
v_and_b32 v7,s27,v63
v_fmac_f32 v30,v6,v15
v_fmac_f32 v31,v7,v15
v_lshlrev_b32 v16,16,v16
v_mul_f32 v5,s26,v16
v_exp_f32 v5,v5
s_nop 0
v_add_f32 v5,1.0,v5
v_rcp_f32 v5,v5
s_nop 0
v_mul_f32 v5,v5,v16
v_cvt_pk_bf16_f32 v5,v5,v5
v_and_b32 v16,s27,v5
v_lshlrev_b32 v6,16,v64
v_and_b32 v7,s27,v64
v_fmac_f32 v24,v6,v16
v_fmac_f32 v25,v7,v16
v_lshlrev_b32 v6,16,v65
v_and_b32 v7,s27,v65
v_fmac_f32 v26,v6,v16
v_fmac_f32 v27,v7,v16
v_lshlrev_b32 v6,16,v66
v_and_b32 v7,s27,v66
v_fmac_f32 v28,v6,v16
v_fmac_f32 v29,v7,v16
v_lshlrev_b32 v6,16,v67
v_and_b32 v7,s27,v67
v_fmac_f32 v30,v6,v16
v_fmac_f32 v31,v7,v16
v_lshlrev_b32 v17,16,v17
v_mul_f32 v5,s26,v17
v_exp_f32 v5,v5
s_nop 0
v_add_f32 v5,1.0,v5
v_rcp_f32 v5,v5
s_nop 0
v_mul_f32 v5,v5,v17
v_cvt_pk_bf16_f32 v5,v5,v5
v_and_b32 v17,s27,v5
v_lshlrev_b32 v6,16,v68
v_and_b32 v7,s27,v68
v_fmac_f32 v24,v6,v17
v_fmac_f32 v25,v7,v17
v_lshlrev_b32 v6,16,v69
v_and_b32 v7,s27,v69
v_fmac_f32 v26,v6,v17
v_fmac_f32 v27,v7,v17
v_lshlrev_b32 v6,16,v70
v_and_b32 v7,s27,v70
v_fmac_f32 v28,v6,v17
v_fmac_f32 v29,v7,v17
v_lshlrev_b32 v6,16,v71
v_and_b32 v7,s27,v71
v_fmac_f32 v30,v6,v17
v_fmac_f32 v31,v7,v17
v_lshlrev_b32 v18,16,v18
v_mul_f32 v5,s26,v18
v_exp_f32 v5,v5
s_nop 0
v_add_f32 v5,1.0,v5
v_rcp_f32 v5,v5
s_nop 0
v_mul_f32 v5,v5,v18
v_cvt_pk_bf16_f32 v5,v5,v5
v_and_b32 v18,s27,v5
v_lshlrev_b32 v6,16,v72
v_and_b32 v7,s27,v72
v_fmac_f32 v24,v6,v18
v_fmac_f32 v25,v7,v18
v_lshlrev_b32 v6,16,v73
v_and_b32 v7,s27,v73
v_fmac_f32 v26,v6,v18
v_fmac_f32 v27,v7,v18
v_lshlrev_b32 v6,16,v74
v_and_b32 v7,s27,v74
v_fmac_f32 v28,v6,v18
v_fmac_f32 v29,v7,v18
v_lshlrev_b32 v6,16,v75
v_and_b32 v7,s27,v75
v_fmac_f32 v30,v6,v18
v_fmac_f32 v31,v7,v18
v_lshlrev_b32 v19,16,v19
v_mul_f32 v5,s26,v19
v_exp_f32 v5,v5
s_nop 0
v_add_f32 v5,1.0,v5
v_rcp_f32 v5,v5
s_nop 0
v_mul_f32 v5,v5,v19
v_cvt_pk_bf16_f32 v5,v5,v5
v_and_b32 v19,s27,v5
v_lshlrev_b32 v6,16,v76
v_and_b32 v7,s27,v76
v_fmac_f32 v24,v6,v19
v_fmac_f32 v25,v7,v19
v_lshlrev_b32 v6,16,v77
v_and_b32 v7,s27,v77
v_fmac_f32 v26,v6,v19
v_fmac_f32 v27,v7,v19
v_lshlrev_b32 v6,16,v78
v_and_b32 v7,s27,v78
v_fmac_f32 v28,v6,v19
v_fmac_f32 v29,v7,v19
v_lshlrev_b32 v6,16,v79
v_and_b32 v7,s27,v79
v_fmac_f32 v30,v6,v19
v_fmac_f32 v31,v7,v19
v_lshlrev_b32 v20,16,v20
v_mul_f32 v5,s26,v20
v_exp_f32 v5,v5
s_nop 0
v_add_f32 v5,1.0,v5
v_rcp_f32 v5,v5
s_nop 0
v_mul_f32 v5,v5,v20
v_cvt_pk_bf16_f32 v5,v5,v5
v_and_b32 v20,s27,v5
v_lshlrev_b32 v6,16,v80
v_and_b32 v7,s27,v80
v_fmac_f32 v24,v6,v20
v_fmac_f32 v25,v7,v20
v_lshlrev_b32 v6,16,v81
v_and_b32 v7,s27,v81
v_fmac_f32 v26,v6,v20
v_fmac_f32 v27,v7,v20
v_lshlrev_b32 v6,16,v82
v_and_b32 v7,s27,v82
v_fmac_f32 v28,v6,v20
v_fmac_f32 v29,v7,v20
v_lshlrev_b32 v6,16,v83
v_and_b32 v7,s27,v83
v_fmac_f32 v30,v6,v20
v_fmac_f32 v31,v7,v20
v_lshlrev_b32 v21,16,v21
v_mul_f32 v5,s26,v21
v_exp_f32 v5,v5
s_nop 0
v_add_f32 v5,1.0,v5
v_rcp_f32 v5,v5
s_nop 0
v_mul_f32 v5,v5,v21
v_cvt_pk_bf16_f32 v5,v5,v5
v_and_b32 v21,s27,v5
v_lshlrev_b32 v6,16,v84
v_and_b32 v7,s27,v84
v_fmac_f32 v24,v6,v21
v_fmac_f32 v25,v7,v21
v_lshlrev_b32 v6,16,v85
v_and_b32 v7,s27,v85
v_fmac_f32 v26,v6,v21
v_fmac_f32 v27,v7,v21
v_lshlrev_b32 v6,16,v86
v_and_b32 v7,s27,v86
v_fmac_f32 v28,v6,v21
v_fmac_f32 v29,v7,v21
v_lshlrev_b32 v6,16,v87
v_and_b32 v7,s27,v87
v_fmac_f32 v30,v6,v21
v_fmac_f32 v31,v7,v21
v_lshlrev_b32 v22,16,v22
v_mul_f32 v5,s26,v22
v_exp_f32 v5,v5
s_nop 0
v_add_f32 v5,1.0,v5
v_rcp_f32 v5,v5
s_nop 0
v_mul_f32 v5,v5,v22
v_cvt_pk_bf16_f32 v5,v5,v5
v_and_b32 v22,s27,v5
v_lshlrev_b32 v6,16,v88
v_and_b32 v7,s27,v88
v_fmac_f32 v24,v6,v22
v_fmac_f32 v25,v7,v22
v_lshlrev_b32 v6,16,v89
v_and_b32 v7,s27,v89
v_fmac_f32 v26,v6,v22
v_fmac_f32 v27,v7,v22
v_lshlrev_b32 v6,16,v90
v_and_b32 v7,s27,v90
v_fmac_f32 v28,v6,v22
v_fmac_f32 v29,v7,v22
v_lshlrev_b32 v6,16,v91
v_and_b32 v7,s27,v91
v_fmac_f32 v30,v6,v22
v_fmac_f32 v31,v7,v22
v_lshlrev_b32 v23,16,v23
v_mul_f32 v5,s26,v23
v_exp_f32 v5,v5
s_nop 0
v_add_f32 v5,1.0,v5
v_rcp_f32 v5,v5
s_nop 0
v_mul_f32 v5,v5,v23
v_cvt_pk_bf16_f32 v5,v5,v5
v_and_b32 v23,s27,v5
v_lshlrev_b32 v6,16,v92
v_and_b32 v7,s27,v92
v_fmac_f32 v24,v6,v23
v_fmac_f32 v25,v7,v23
v_lshlrev_b32 v6,16,v93
v_and_b32 v7,s27,v93
v_fmac_f32 v26,v6,v23
v_fmac_f32 v27,v7,v23
v_lshlrev_b32 v6,16,v94
v_and_b32 v7,s27,v94
v_fmac_f32 v28,v6,v23
v_fmac_f32 v29,v7,v23
v_lshlrev_b32 v6,16,v95
v_and_b32 v7,s27,v95
v_fmac_f32 v30,v6,v23
v_fmac_f32 v31,v7,v23
v_lshlrev_b32 v5,5,v0
ds_write_b128 v5,v[24:27]
ds_write_b128 v5,v[28:31] offset:16
s_waitcnt lgkmcnt(0)
s_barrier
v_and_b32 v1,31,v0
v_lshrrev_b32 v2,5,v0
v_lshlrev_b32 v3,10,v2
v_lshl_add_u32 v3,v1,2,v3
ds_read_b32 v8,v3 offset:0
ds_read_b32 v9,v3 offset:128
ds_read_b32 v10,v3 offset:256
ds_read_b32 v11,v3 offset:384
ds_read_b32 v12,v3 offset:512
ds_read_b32 v13,v3 offset:640
ds_read_b32 v14,v3 offset:768
ds_read_b32 v15,v3 offset:896
s_waitcnt lgkmcnt(0)
v_add_f32 v8,v8,v9
v_add_f32 v8,v8,v10
v_add_f32 v8,v8,v11
v_add_f32 v8,v8,v12
v_add_f32 v8,v8,v13
v_add_f32 v8,v8,v14
v_add_f32 v8,v8,v15
s_barrier
v_lshlrev_b32 v3,2,v0
ds_write_b32 v3,v8
s_waitcnt lgkmcnt(0)
s_barrier
v_lshlrev_b32 v3,2,v1
ds_read_b32 v8,v3 offset:0
ds_read_b32 v9,v3 offset:128
ds_read_b32 v10,v3 offset:256
ds_read_b32 v11,v3 offset:384
ds_read_b32 v12,v3 offset:512
ds_read_b32 v13,v3 offset:640
ds_read_b32 v14,v3 offset:768
ds_read_b32 v15,v3 offset:896
s_waitcnt lgkmcnt(0)
v_add_f32 v8,v8,v9
v_add_f32 v8,v8,v10
v_add_f32 v8,v8,v11
v_add_f32 v8,v8,v12
v_add_f32 v8,v8,v13
v_add_f32 v8,v8,v14
v_add_f32 v8,v8,v15
v_cvt_pk_bf16_f32 v8,v8,v8
v_and_b32 v8,s27,v8
s_lshl_b32 s24,s40,7
s_add_u32 s24,s24,0
v_cmp_gt_u32 vcc,32,v0
s_and_saveexec_b64 s[36:37],vcc
s_cbranch_execz nost_183
buffer_store_dword v8,v3,s[20:23],s24 offen sc1
nost_183:
s_mov_b64 exec,s[36:37]
s_branch moddone_179
moddone_179:
s_waitcnt vmcnt(0)
s_barrier
s_cmp_lg_u32 s50,0
s_cbranch_scc1 ow_184
s_mov_b64 exec,1
v_mov_b32 v22,14
v_mov_b32 v23,0
s_mov_b32 s64,21052032
buffer_atomic_add v22,v23,s[20:23],s64 offen sc1
s_mov_b64 exec,-1
ow_184:
v_and_b32 v1,63,v0
v_and_b32 v3,15,v1
v_lshrrev_b32 v4,4,v1
v_lshlrev_b32 v16,4,v1
v_mov_b32 v48,0
v_mov_b32 v49,0
v_mov_b32 v50,0
v_mov_b32 v51,0
s_mov_b64 s[24:25],s[20:21]
s_mov_b64 s[28:29],s[20:21]
s_mov_b32 s27,0x20000
s_mov_b32 s31,0x20000
s_cmp_eq_u32 s56,0
s_cselect_b32 s26,s22,0
s_cselect_b32 s30,0,s22
s_mov_b32 s79,0
s_mov_b32 s71,1
s_mov_b32 s98,0
s_mov_b32 s99,0
v_mov_b32 v29,0
v_cmp_eq_u32 vcc,0,v1
v_mov_b32 v23,0x40000000
s_nop 0
v_cndmask_b32 v23,v23,v48,vcc
s_mov_b32 s80,0xffff0000
s_cmp_eq_u32 s58,0
s_cbranch_scc1 r_wo_185
s_cmp_eq_u32 s58,1
s_cbranch_scc1 r_w3_186
s_cmp_eq_u32 s58,2
s_cbranch_scc1 r_w4_187
s_and_b32 s41,s59,15
s_cmp_lt_u32 s59,16
s_cbranch_scc1 r_at_190
s_cmp_ge_u32 s59,24
s_cbranch_scc1 r_w2_188
s_load_dwordx2 s[4:5],s[0:1],64
s_and_b32 s41,s59,7
s_lshl_b32 s66,s41,8
s_lshl_b32 s67,s50,1
s_waitcnt lgkmcnt(0)
s_mov_b32 s32,s4
s_and_b32 s33,s5,0xffff
s_mov_b32 s34,0x200000
s_mov_b32 s35,0x20000
v_lshrrev_b32 v5,2,v3
v_lshl_add_u32 v7,v4,3,v5
v_and_b32 v6,3,v3
v_lshlrev_b32 v6,3,v6
v_lshl_add_u32 v6,v7,8,v6
v_and_b32 v7,1,v4
v_lshl_add_u32 v5,v7,2,v5
v_xor_b32 v5,s67,v5
v_lshl_add_u32 v12,v5,5,v6
v_xor_b32 v13,32,v12
v_and_b32 v5,15,v1
v_and_b32 v6,3,v4
v_lshlrev_b32 v6,1,v6
v_xor_b32 v5,v5,v6
v_mul_u32_u24 v6,2048,v4
v_xor_b32 v7,0,v5
v_lshl_add_u32 v8,v7,4,v6
v_xor_b32 v7,8,v5
v_lshl_add_u32 v9,v7,4,v6
s_mul_i32 s74,s50,131072
s_add_u32 s74,s74,s66
s_lshl_b32 s75,s50,14
s_mul_i32 s76,s50,65536
s_add_u32 s76,s76,s66
s_lshl_b32 s77,s50,13
s_add_u32 s64,s74,0
s_add_u32 m0,s75,0
s_nop 0
buffer_load_dwordx4 v8,s[32:35],s64 offen  lds
s_add_u32 s64,s74,8192
s_add_u32 m0,s75,1024
s_nop 0
buffer_load_dwordx4 v8,s[32:35],s64 offen  lds
s_add_u32 s64,s74,16384
s_add_u32 m0,s75,2048
s_nop 0
buffer_load_dwordx4 v9,s[32:35],s64 offen  lds
s_add_u32 s64,s74,24576
s_add_u32 m0,s75,3072
s_nop 0
buffer_load_dwordx4 v9,s[32:35],s64 offen  lds
s_add_u32 s64,s74,32768
s_add_u32 m0,s75,4096
s_nop 0
buffer_load_dwordx4 v8,s[32:35],s64 offen  lds
s_add_u32 s64,s74,40960
s_add_u32 m0,s75,5120
s_nop 0
buffer_load_dwordx4 v8,s[32:35],s64 offen  lds
s_add_u32 s64,s74,49152
s_add_u32 m0,s75,6144
s_nop 0
buffer_load_dwordx4 v9,s[32:35],s64 offen  lds
s_add_u32 s64,s74,57344
s_add_u32 m0,s75,7168
s_nop 0
buffer_load_dwordx4 v9,s[32:35],s64 offen  lds
s_add_u32 s64,s74,65536
s_add_u32 m0,s75,8192
s_nop 0
buffer_load_dwordx4 v8,s[32:35],s64 offen  lds
s_add_u32 s64,s74,73728
s_add_u32 m0,s75,9216
s_nop 0
buffer_load_dwordx4 v8,s[32:35],s64 offen  lds
s_add_u32 s64,s74,81920
s_add_u32 m0,s75,10240
s_nop 0
buffer_load_dwordx4 v9,s[32:35],s64 offen  lds
s_add_u32 s64,s74,90112
s_add_u32 m0,s75,11264
s_nop 0
buffer_load_dwordx4 v9,s[32:35],s64 offen  lds
s_add_u32 s64,s74,98304
s_add_u32 m0,s75,12288
s_nop 0
buffer_load_dwordx4 v8,s[32:35],s64 offen  lds
s_add_u32 s64,s74,106496
s_add_u32 m0,s75,13312
s_nop 0
buffer_load_dwordx4 v8,s[32:35],s64 offen  lds
s_add_u32 s64,s74,114688
s_add_u32 m0,s75,14336
s_nop 0
buffer_load_dwordx4 v9,s[32:35],s64 offen  lds
s_add_u32 s64,s74,122880
s_add_u32 m0,s75,15360
s_nop 0
buffer_load_dwordx4 v9,s[32:35],s64 offen  lds
s_add_u32 s64,s74,524288
s_add_u32 m0,s75,65536
s_nop 0
buffer_load_dwordx4 v8,s[32:35],s64 offen  lds
s_add_u32 s64,s74,532480
s_add_u32 m0,s75,66560
s_nop 0
buffer_load_dwordx4 v8,s[32:35],s64 offen  lds
s_add_u32 s64,s74,540672
s_add_u32 m0,s75,67584
s_nop 0
buffer_load_dwordx4 v9,s[32:35],s64 offen  lds
s_add_u32 s64,s74,548864
s_add_u32 m0,s75,68608
s_nop 0
buffer_load_dwordx4 v9,s[32:35],s64 offen  lds
s_add_u32 s64,s74,557056
s_add_u32 m0,s75,69632
s_nop 0
buffer_load_dwordx4 v8,s[32:35],s64 offen  lds
s_add_u32 s64,s74,565248
s_add_u32 m0,s75,70656
s_nop 0
buffer_load_dwordx4 v8,s[32:35],s64 offen  lds
s_add_u32 s64,s74,573440
s_add_u32 m0,s75,71680
s_nop 0
buffer_load_dwordx4 v9,s[32:35],s64 offen  lds
s_add_u32 s64,s74,581632
s_add_u32 m0,s75,72704
s_nop 0
buffer_load_dwordx4 v9,s[32:35],s64 offen  lds
s_add_u32 s64,s74,589824
s_add_u32 m0,s75,73728
s_nop 0
buffer_load_dwordx4 v8,s[32:35],s64 offen  lds
s_add_u32 s64,s74,598016
s_add_u32 m0,s75,74752
s_nop 0
buffer_load_dwordx4 v8,s[32:35],s64 offen  lds
s_add_u32 s64,s74,606208
s_add_u32 m0,s75,75776
s_nop 0
buffer_load_dwordx4 v9,s[32:35],s64 offen  lds
s_add_u32 s64,s74,614400
s_add_u32 m0,s75,76800
s_nop 0
buffer_load_dwordx4 v9,s[32:35],s64 offen  lds
s_add_u32 s64,s74,622592
s_add_u32 m0,s75,77824
s_nop 0
buffer_load_dwordx4 v8,s[32:35],s64 offen  lds
s_add_u32 s64,s74,630784
s_add_u32 m0,s75,78848
s_nop 0
buffer_load_dwordx4 v8,s[32:35],s64 offen  lds
s_add_u32 s64,s74,638976
s_add_u32 m0,s75,79872
s_nop 0
buffer_load_dwordx4 v9,s[32:35],s64 offen  lds
s_add_u32 s64,s74,647168
s_add_u32 m0,s75,80896
s_nop 0
buffer_load_dwordx4 v9,s[32:35],s64 offen  lds
s_waitcnt vmcnt(16)
s_barrier
ds_read_b64_tr_b16 a[0:1],v12 offset:0
ds_read_b64_tr_b16 a[128:129],v13 offset:0
ds_read_b64_tr_b16 a[2:3],v12 offset:1024
ds_read_b64_tr_b16 a[130:131],v13 offset:1024
ds_read_b64_tr_b16 a[4:5],v12 offset:8192
ds_read_b64_tr_b16 a[132:133],v13 offset:8192
ds_read_b64_tr_b16 a[6:7],v12 offset:9216
ds_read_b64_tr_b16 a[134:135],v13 offset:9216
s_waitcnt lgkmcnt(4)
ds_read_b64_tr_b16 a[8:9],v12 offset:16384
ds_read_b64_tr_b16 a[136:137],v13 offset:16384
ds_read_b64_tr_b16 a[10:11],v12 offset:17408
ds_read_b64_tr_b16 a[138:139],v13 offset:17408
ds_read_b64_tr_b16 a[12:13],v12 offset:24576
ds_read_b64_tr_b16 a[140:141],v13 offset:24576
ds_read_b64_tr_b16 a[14:15],v12 offset:25600
ds_read_b64_tr_b16 a[142:143],v13 offset:25600
s_waitcnt lgkmcnt(4)
ds_read_b64_tr_b16 a[16:17],v12 offset:32768
ds_read_b64_tr_b16 a[144:145],v13 offset:32768
ds_read_b64_tr_b16 a[18:19],v12 offset:33792
ds_read_b64_tr_b16 a[146:147],v13 offset:33792
ds_read_b64_tr_b16 a[20:21],v12 offset:40960
ds_read_b64_tr_b16 a[148:149],v13 offset:40960
ds_read_b64_tr_b16 a[22:23],v12 offset:41984
ds_read_b64_tr_b16 a[150:151],v13 offset:41984
s_waitcnt lgkmcnt(4)
ds_read_b64_tr_b16 a[24:25],v12 offset:49152
ds_read_b64_tr_b16 a[152:153],v13 offset:49152
ds_read_b64_tr_b16 a[26:27],v12 offset:50176
ds_read_b64_tr_b16 a[154:155],v13 offset:50176
ds_read_b64_tr_b16 a[28:29],v12 offset:57344
ds_read_b64_tr_b16 a[156:157],v13 offset:57344
ds_read_b64_tr_b16 a[30:31],v12 offset:58368
ds_read_b64_tr_b16 a[158:159],v13 offset:58368
s_waitcnt lgkmcnt(4)
v_xor_b32 v12,0x10000,v12
v_xor_b32 v13,0x10000,v13
s_waitcnt lgkmcnt(0)
s_barrier
s_add_u32 s64,s74,1048576
s_add_u32 m0,s75,0
s_nop 0
buffer_load_dwordx4 v8,s[32:35],s64 offen  lds
s_add_u32 s64,s74,1056768
s_add_u32 m0,s75,1024
s_nop 0
buffer_load_dwordx4 v8,s[32:35],s64 offen  lds
s_add_u32 s64,s74,1064960
s_add_u32 m0,s75,2048
s_nop 0
buffer_load_dwordx4 v9,s[32:35],s64 offen  lds
s_add_u32 s64,s74,1073152
s_add_u32 m0,s75,3072
s_nop 0
buffer_load_dwordx4 v9,s[32:35],s64 offen  lds
s_add_u32 s64,s74,1081344
s_add_u32 m0,s75,4096
s_nop 0
buffer_load_dwordx4 v8,s[32:35],s64 offen  lds
s_add_u32 s64,s74,1089536
s_add_u32 m0,s75,5120
s_nop 0
buffer_load_dwordx4 v8,s[32:35],s64 offen  lds
s_add_u32 s64,s74,1097728
s_add_u32 m0,s75,6144
s_nop 0
buffer_load_dwordx4 v9,s[32:35],s64 offen  lds
s_add_u32 s64,s74,1105920
s_add_u32 m0,s75,7168
s_nop 0
buffer_load_dwordx4 v9,s[32:35],s64 offen  lds
s_add_u32 s64,s74,1114112
s_add_u32 m0,s75,8192
s_nop 0
buffer_load_dwordx4 v8,s[32:35],s64 offen  lds
s_add_u32 s64,s74,1122304
s_add_u32 m0,s75,9216
s_nop 0
buffer_load_dwordx4 v8,s[32:35],s64 offen  lds
s_add_u32 s64,s74,1130496
s_add_u32 m0,s75,10240
s_nop 0
buffer_load_dwordx4 v9,s[32:35],s64 offen  lds
s_add_u32 s64,s74,1138688
s_add_u32 m0,s75,11264
s_nop 0
buffer_load_dwordx4 v9,s[32:35],s64 offen  lds
s_add_u32 s64,s74,1146880
s_add_u32 m0,s75,12288
s_nop 0
buffer_load_dwordx4 v8,s[32:35],s64 offen  lds
s_add_u32 s64,s74,1155072
s_add_u32 m0,s75,13312
s_nop 0
buffer_load_dwordx4 v8,s[32:35],s64 offen  lds
s_add_u32 s64,s74,1163264
s_add_u32 m0,s75,14336
s_nop 0
buffer_load_dwordx4 v9,s[32:35],s64 offen  lds
s_add_u32 s64,s74,1171456
s_add_u32 m0,s75,15360
s_nop 0
buffer_load_dwordx4 v9,s[32:35],s64 offen  lds
s_waitcnt vmcnt(16)
s_barrier
ds_read_b64_tr_b16 a[32:33],v12 offset:0
ds_read_b64_tr_b16 a[160:161],v13 offset:0
ds_read_b64_tr_b16 a[34:35],v12 offset:1024
ds_read_b64_tr_b16 a[162:163],v13 offset:1024
ds_read_b64_tr_b16 a[36:37],v12 offset:8192
ds_read_b64_tr_b16 a[164:165],v13 offset:8192
ds_read_b64_tr_b16 a[38:39],v12 offset:9216
ds_read_b64_tr_b16 a[166:167],v13 offset:9216
s_waitcnt lgkmcnt(4)
ds_read_b64_tr_b16 a[40:41],v12 offset:16384
ds_read_b64_tr_b16 a[168:169],v13 offset:16384
ds_read_b64_tr_b16 a[42:43],v12 offset:17408
ds_read_b64_tr_b16 a[170:171],v13 offset:17408
ds_read_b64_tr_b16 a[44:45],v12 offset:24576
ds_read_b64_tr_b16 a[172:173],v13 offset:24576
ds_read_b64_tr_b16 a[46:47],v12 offset:25600
ds_read_b64_tr_b16 a[174:175],v13 offset:25600
s_waitcnt lgkmcnt(4)
ds_read_b64_tr_b16 a[48:49],v12 offset:32768
ds_read_b64_tr_b16 a[176:177],v13 offset:32768
ds_read_b64_tr_b16 a[50:51],v12 offset:33792
ds_read_b64_tr_b16 a[178:179],v13 offset:33792
ds_read_b64_tr_b16 a[52:53],v12 offset:40960
ds_read_b64_tr_b16 a[180:181],v13 offset:40960
ds_read_b64_tr_b16 a[54:55],v12 offset:41984
ds_read_b64_tr_b16 a[182:183],v13 offset:41984
s_waitcnt lgkmcnt(4)
ds_read_b64_tr_b16 a[56:57],v12 offset:49152
ds_read_b64_tr_b16 a[184:185],v13 offset:49152
ds_read_b64_tr_b16 a[58:59],v12 offset:50176
ds_read_b64_tr_b16 a[186:187],v13 offset:50176
ds_read_b64_tr_b16 a[60:61],v12 offset:57344
ds_read_b64_tr_b16 a[188:189],v13 offset:57344
ds_read_b64_tr_b16 a[62:63],v12 offset:58368
ds_read_b64_tr_b16 a[190:191],v13 offset:58368
s_waitcnt lgkmcnt(4)
v_xor_b32 v12,0x10000,v12
v_xor_b32 v13,0x10000,v13
s_waitcnt lgkmcnt(0)
s_barrier
s_add_u32 s64,s74,1572864
s_add_u32 m0,s75,65536
s_nop 0
buffer_load_dwordx4 v8,s[32:35],s64 offen  lds
s_add_u32 s64,s74,1581056
s_add_u32 m0,s75,66560
s_nop 0
buffer_load_dwordx4 v8,s[32:35],s64 offen  lds
s_add_u32 s64,s74,1589248
s_add_u32 m0,s75,67584
s_nop 0
buffer_load_dwordx4 v9,s[32:35],s64 offen  lds
s_add_u32 s64,s74,1597440
s_add_u32 m0,s75,68608
s_nop 0
buffer_load_dwordx4 v9,s[32:35],s64 offen  lds
s_add_u32 s64,s74,1605632
s_add_u32 m0,s75,69632
s_nop 0
buffer_load_dwordx4 v8,s[32:35],s64 offen  lds
s_add_u32 s64,s74,1613824
s_add_u32 m0,s75,70656
s_nop 0
buffer_load_dwordx4 v8,s[32:35],s64 offen  lds
s_add_u32 s64,s74,1622016
s_add_u32 m0,s75,71680
s_nop 0
buffer_load_dwordx4 v9,s[32:35],s64 offen  lds
s_add_u32 s64,s74,1630208
s_add_u32 m0,s75,72704
s_nop 0
buffer_load_dwordx4 v9,s[32:35],s64 offen  lds
s_add_u32 s64,s74,1638400
s_add_u32 m0,s75,73728
s_nop 0
buffer_load_dwordx4 v8,s[32:35],s64 offen  lds
s_add_u32 s64,s74,1646592
s_add_u32 m0,s75,74752
s_nop 0
buffer_load_dwordx4 v8,s[32:35],s64 offen  lds
s_add_u32 s64,s74,1654784
s_add_u32 m0,s75,75776
s_nop 0
buffer_load_dwordx4 v9,s[32:35],s64 offen  lds
s_add_u32 s64,s74,1662976
s_add_u32 m0,s75,76800
s_nop 0
buffer_load_dwordx4 v9,s[32:35],s64 offen  lds
s_add_u32 s64,s74,1671168
s_add_u32 m0,s75,77824
s_nop 0
buffer_load_dwordx4 v8,s[32:35],s64 offen  lds
s_add_u32 s64,s74,1679360
s_add_u32 m0,s75,78848
s_nop 0
buffer_load_dwordx4 v8,s[32:35],s64 offen  lds
s_add_u32 s64,s74,1687552
s_add_u32 m0,s75,79872
s_nop 0
buffer_load_dwordx4 v9,s[32:35],s64 offen  lds
s_add_u32 s64,s74,1695744
s_add_u32 m0,s75,80896
s_nop 0
buffer_load_dwordx4 v9,s[32:35],s64 offen  lds
s_waitcnt vmcnt(16)
s_barrier
ds_read_b64_tr_b16 a[64:65],v12 offset:0
ds_read_b64_tr_b16 a[192:193],v13 offset:0
ds_read_b64_tr_b16 a[66:67],v12 offset:1024
ds_read_b64_tr_b16 a[194:195],v13 offset:1024
ds_read_b64_tr_b16 a[68:69],v12 offset:8192
ds_read_b64_tr_b16 a[196:197],v13 offset:8192
ds_read_b64_tr_b16 a[70:71],v12 offset:9216
ds_read_b64_tr_b16 a[198:199],v13 offset:9216
s_waitcnt lgkmcnt(4)
ds_read_b64_tr_b16 a[72:73],v12 offset:16384
ds_read_b64_tr_b16 a[200:201],v13 offset:16384
ds_read_b64_tr_b16 a[74:75],v12 offset:17408
ds_read_b64_tr_b16 a[202:203],v13 offset:17408
ds_read_b64_tr_b16 a[76:77],v12 offset:24576
ds_read_b64_tr_b16 a[204:205],v13 offset:24576
ds_read_b64_tr_b16 a[78:79],v12 offset:25600
ds_read_b64_tr_b16 a[206:207],v13 offset:25600
s_waitcnt lgkmcnt(4)
ds_read_b64_tr_b16 a[80:81],v12 offset:32768
ds_read_b64_tr_b16 a[208:209],v13 offset:32768
ds_read_b64_tr_b16 a[82:83],v12 offset:33792
ds_read_b64_tr_b16 a[210:211],v13 offset:33792
ds_read_b64_tr_b16 a[84:85],v12 offset:40960
ds_read_b64_tr_b16 a[212:213],v13 offset:40960
ds_read_b64_tr_b16 a[86:87],v12 offset:41984
ds_read_b64_tr_b16 a[214:215],v13 offset:41984
s_waitcnt lgkmcnt(4)
ds_read_b64_tr_b16 a[88:89],v12 offset:49152
ds_read_b64_tr_b16 a[216:217],v13 offset:49152
ds_read_b64_tr_b16 a[90:91],v12 offset:50176
ds_read_b64_tr_b16 a[218:219],v13 offset:50176
ds_read_b64_tr_b16 a[92:93],v12 offset:57344
ds_read_b64_tr_b16 a[220:221],v13 offset:57344
ds_read_b64_tr_b16 a[94:95],v12 offset:58368
ds_read_b64_tr_b16 a[222:223],v13 offset:58368
s_waitcnt lgkmcnt(4)
v_xor_b32 v12,0x10000,v12
v_xor_b32 v13,0x10000,v13
s_waitcnt lgkmcnt(0)
s_barrier
s_waitcnt vmcnt(0)
s_barrier
ds_read_b64_tr_b16 a[96:97],v12 offset:0
ds_read_b64_tr_b16 a[224:225],v13 offset:0
ds_read_b64_tr_b16 a[98:99],v12 offset:1024
ds_read_b64_tr_b16 a[226:227],v13 offset:1024
ds_read_b64_tr_b16 a[100:101],v12 offset:8192
ds_read_b64_tr_b16 a[228:229],v13 offset:8192
ds_read_b64_tr_b16 a[102:103],v12 offset:9216
ds_read_b64_tr_b16 a[230:231],v13 offset:9216
s_waitcnt lgkmcnt(4)
ds_read_b64_tr_b16 a[104:105],v12 offset:16384
ds_read_b64_tr_b16 a[232:233],v13 offset:16384
ds_read_b64_tr_b16 a[106:107],v12 offset:17408
ds_read_b64_tr_b16 a[234:235],v13 offset:17408
ds_read_b64_tr_b16 a[108:109],v12 offset:24576
ds_read_b64_tr_b16 a[236:237],v13 offset:24576
ds_read_b64_tr_b16 a[110:111],v12 offset:25600
ds_read_b64_tr_b16 a[238:239],v13 offset:25600
s_waitcnt lgkmcnt(4)
ds_read_b64_tr_b16 a[112:113],v12 offset:32768
ds_read_b64_tr_b16 a[240:241],v13 offset:32768
ds_read_b64_tr_b16 a[114:115],v12 offset:33792
ds_read_b64_tr_b16 a[242:243],v13 offset:33792
ds_read_b64_tr_b16 a[116:117],v12 offset:40960
ds_read_b64_tr_b16 a[244:245],v13 offset:40960
ds_read_b64_tr_b16 a[118:119],v12 offset:41984
ds_read_b64_tr_b16 a[246:247],v13 offset:41984
s_waitcnt lgkmcnt(4)
ds_read_b64_tr_b16 a[120:121],v12 offset:49152
ds_read_b64_tr_b16 a[248:249],v13 offset:49152
ds_read_b64_tr_b16 a[122:123],v12 offset:50176
ds_read_b64_tr_b16 a[250:251],v13 offset:50176
ds_read_b64_tr_b16 a[124:125],v12 offset:57344
ds_read_b64_tr_b16 a[252:253],v13 offset:57344
ds_read_b64_tr_b16 a[126:127],v12 offset:58368
ds_read_b64_tr_b16 a[254:255],v13 offset:58368
s_waitcnt lgkmcnt(4)
v_xor_b32 v12,0x10000,v12
v_xor_b32 v13,0x10000,v13
s_waitcnt lgkmcnt(0)
s_barrier
v_and_b32 v21,1,v1
v_mul_u32_u24 v21,896,v21
s_mov_b32 s65,21052032
s_mov_b32 s66,1792
pl_191:
buffer_load_dword v22,v21,s[20:23],s65 offen sc1
s_waitcnt vmcnt(0)
v_cmp_gt_u32 vcc,s66,v22
s_cbranch_vccz pok_192
s_sleep 1
s_sub_u32 s90,s90,1
s_cmp_gt_i32 s90,0
s_cbranch_scc1 pl_191
pok_192:
s_mov_b32 s81,0xbdd2d3e8
v_mov_b32 v28,0xc0135761
v_mov_b32 v17,v16
v_and_b32 v21,31,v1
v_lshlrev_b32 v21,2,v21
s_add_u32 s74,s63,2560
s_lshl_b32 s42,s41,2
s_add_u32 s42,s42,s50
s_lshl_b32 s73,s42,2
s_add_u32 s73,s73,s63
s_add_u32 s73,s73,3072
s_lshl_b32 s43,s50,11
s_mov_b32 s78,29360128
s_mov_b32 s64,0
s_lshr_b32 s65,s50,1
s_and_b32 s66,s50,1
s_lshl_b32 s72,s65,13
s_lshl_b32 s64,s66,11
s_add_u32 s72,s72,s64
s_add_u32 s72,s72,0x10000
s_lshl_b32 s75,s66,15
s_lshl_b32 s64,s65,7
s_add_u32 s75,s75,s64
s_add_u32 s75,s75,1835008
s_lshl_b32 s64,s66,2
v_add_u32 v5,s64,v4
v_and_b32 v6,7,v1
v_xor_b32 v5,v5,v6
v_lshlrev_b32 v5,4,v5
v_bfe_u32 v6,v1,3,2
v_lshl_add_u32 v5,v6,11,v5
v_lshrrev_b32 v6,5,v1
v_lshl_add_u32 v42,v6,14,v5
v_lshrrev_b32 v5,1,v3
v_xor_b32 v5,v5,v4
v_lshlrev_b32 v5,4,v5
v_and_b32 v6,7,v3
v_lshl_add_u32 v5,v6,7,v5
v_lshrrev_b32 v6,3,v3
v_lshl_add_u32 v17,v6,11,v5
v_xor_b32 v43,64,v17
s_lshr_b32 s64,s41,1
s_lshl_b32 s64,s64,2
s_lshr_b32 s64,0x0413,s64
s_and_b32 s64,s64,7
s_add_u32 s65,s41,120
s_lshl_b32 s65,s65,14
s_add_u32 s65,s65,s43
v_lshl_add_u32 v7,v4,8,s65
v_mov_b32 v9,2105344
v_add_u32 v6,s64,v3
v_and_b32 v5,15,v6
v_lshl_add_u32 v5,v5,4,v7
v_bfe_u32 v8,v6,4,1
v_lshl_add_u32 v5,v8,10,v5
v_cmp_lt_u32 vcc,31,v6
s_nop 1
v_cndmask_b32 v8,0,v9,vcc
v_add_u32 v5,v5,v8
v_xor_b32 v18,s62,v5
s_add_u32 s64,s64,16
v_add_u32 v6,s64,v3
v_and_b32 v5,15,v6
v_lshl_add_u32 v5,v5,4,v7
v_bfe_u32 v8,v6,4,1
v_lshl_add_u32 v5,v8,10,v5
v_cmp_lt_u32 vcc,31,v6
s_nop 1
v_cndmask_b32 v8,0,v9,vcc
v_add_u32 v5,v5,v8
v_xor_b32 v19,s62,v5
s_add_u32 s64,s64,16
s_mov_b64 s[84:85],vcc
v_mov_b32 v88,1
v_mov_b32 v89,0
v_mov_b32 v90,0
v_mov_b32 v91,0
v_xor_b32 v5,0x2000,v19
s_mov_b32 s64,163577856
buffer_store_dwordx4 v[88:91],v18,s[20:23],s64 offen sc1
s_andn2_b64 exec,exec,s[84:85]
buffer_store_dwordx4 v[88:91],v19,s[20:23],s64 offen sc1
s_mov_b64 exec,-1
v_mov_b32 v6,0x7fff0000
v_cndmask_b32 v5,v6,v5,s[84:85]
s_mov_b32 s64,27262976
buffer_store_dwordx4 v[88:91],v5,s[20:23],s64 offen sc1
s_waitcnt vmcnt(0)
s_add_u32 s64,s79,0
s_lshl_b32 s70,s64,21
s_lshl_b32 s64,s64,13
s_and_b32 s64,s64,0x2000
s_xor_b32 s64,s64,s62
s_add_u32 s70,s70,s64
s_add_u32 s70,s70,29360128
s_mov_b32 s83,1
s_mov_b32 s87,s74
s_cmp_eq_u32 s50,0
s_cselect_b32 s74,s74,0x7fff0000
v_mov_b32 v45,132096
s_lshl_b32 s64,s50,2
s_add_u32 s64,s64,132112
v_mov_b32 v46,s64
v_mov_b32 v2,0
v_mov_b32 v44,1
ds_write_b32 v45,v44
s_waitcnt lgkmcnt(0)
seg_194:
s_cmp_eq_u32 s83,0
s_cbranch_scc1 ahead_195
s_add_u32 s94,s70,s75
s_add_u32 s95,s94,65536
s_xor_b32 s91,s72,0x10000
s_waitcnt lgkmcnt(0)
v_cmp_gt_u32 vcc,s71,v2
s_cbranch_vccz nb_198
s_waitcnt vmcnt(3)
v_cmp_gt_u32 vcc,s71,v29
s_cbranch_vccz nb_198
s_waitcnt vmcnt(0)
v_add_u32 v22,s71,-1
buffer_store_dword v22,v23,s[24:27],s73 offen
buffer_store_dword v22,v23,s[28:31],s73 offen sc1
s_cmp_lg_u32 s50,0
s_cbranch_scc1 nb_198
buffer_load_dword v32,v21,s[20:23],s74 offen sc1
s_sleep 2
pl_199:
buffer_load_dword v33,v21,s[20:23],s74 offen sc1
s_waitcnt vmcnt(1)
v_cmp_gt_u32 vcc,s71,v32
s_cbranch_vccz pok_200
buffer_load_dword v32,v21,s[20:23],s74 offen sc1
s_waitcnt vmcnt(1)
v_cmp_gt_u32 vcc,s71,v33
s_cbranch_vccz pok_200
s_sub_u32 s90,s90,1
s_cmp_gt_i32 s90,0
s_cbranch_scc1 pl_199
pok_200:
nb_198:
s_barrier
s_xor_b32 m0,s91,0
s_add_u32 s65,s94,0
buffer_load_dwordx4 v42,s[20:23],s65 offen offset:0 sc1 lds
buffer_load_dwordx4 v42,s[20:23],s65 offen offset:1024 sc1 lds
ds_read_b32 v44,v45
s_xor_b32 m0,s91,16384
s_add_u32 s65,s94,256
buffer_load_dwordx4 v42,s[20:23],s65 offen offset:0 sc1 lds
buffer_load_dwordx4 v42,s[20:23],s65 offen offset:1024 sc1 lds
s_xor_b32 m0,s91,32768
s_add_u32 s65,s94,512
buffer_load_dwordx4 v42,s[20:23],s65 offen offset:0 sc1 lds
buffer_load_dwordx4 v42,s[20:23],s65 offen offset:1024 sc1 lds
s_xor_b32 m0,s91,49152
s_add_u32 s65,s94,768
buffer_load_dwordx4 v42,s[20:23],s65 offen offset:0 sc1 lds
buffer_load_dwordx4 v42,s[20:23],s65 offen offset:1024 sc1 lds
s_xor_b32 m0,s91,4096
s_add_u32 s65,s95,0
buffer_load_dwordx4 v42,s[20:23],s65 offen offset:0 sc1 lds
buffer_load_dwordx4 v42,s[20:23],s65 offen offset:1024 sc1 lds
s_waitcnt lgkmcnt(0)
v_readfirstlane_b32 s83,v44
s_cmp_eq_u32 s83,0
s_cbranch_scc1 both_197
s_waitcnt vmcnt(8)
s_barrier
ds_read_b128 v[224:227],v17 offset:0
ds_read_b128 v[228:231],v43 offset:0
ds_read_b128 v[232:235],v17 offset:8192
ds_read_b128 v[236:239],v43 offset:8192
ds_read_b128 v[240:243],v17 offset:1024
ds_read_b128 v[244:247],v43 offset:1024
ds_read_b128 v[248:251],v17 offset:9216
s_waitcnt lgkmcnt(5)
v_mfma_f32_16x16x32_bf16 v[64:67],a[0:3],v[224:227],0
v_min_u32 v27,v224,v228
s_xor_b32 m0,s91,20480
v_mfma_f32_16x16x32_bf16 v[72:75],a[128:131],v[224:227],0
ds_read_b128 v[252:255],v43 offset:9216
v_mfma_f32_16x16x32_bf16 v[64:67],a[4:7],v[228:231],v[64:67]
s_add_u32 s65,s95,256
v_mfma_f32_16x16x32_bf16 v[72:75],a[132:135],v[228:231],v[72:75]
s_waitcnt vmcnt(6)
s_barrier
ds_read_b128 v[224:227],v17 offset:16384
s_waitcnt lgkmcnt(5)
v_mfma_f32_16x16x32_bf16 v[64:67],a[8:11],v[232:235],v[64:67]
v_min3_u32 v27,v27,v232,v236
buffer_load_dwordx4 v42,s[20:23],s65 offen offset:0 sc1 lds
v_mfma_f32_16x16x32_bf16 v[72:75],a[136:139],v[232:235],v[72:75]
ds_read_b128 v[228:231],v43 offset:16384
v_mfma_f32_16x16x32_bf16 v[64:67],a[12:15],v[236:239],v[64:67]
buffer_load_dwordx4 v42,s[20:23],s65 offen offset:1024 sc1 lds
v_mfma_f32_16x16x32_bf16 v[72:75],a[140:143],v[236:239],v[72:75]
ds_read_b128 v[232:235],v17 offset:24576
s_waitcnt lgkmcnt(5)
v_mfma_f32_16x16x32_bf16 v[64:67],a[64:67],v[240:243],v[64:67]
v_min3_u32 v27,v27,v240,v244
s_xor_b32 m0,s91,36864
v_mfma_f32_16x16x32_bf16 v[72:75],a[192:195],v[240:243],v[72:75]
ds_read_b128 v[236:239],v43 offset:24576
v_mfma_f32_16x16x32_bf16 v[64:67],a[68:71],v[244:247],v[64:67]
s_add_u32 s65,s95,512
v_mfma_f32_16x16x32_bf16 v[72:75],a[196:199],v[244:247],v[72:75]
ds_read_b128 v[240:243],v17 offset:17408
s_waitcnt lgkmcnt(5)
v_mfma_f32_16x16x32_bf16 v[64:67],a[72:75],v[248:251],v[64:67]
v_min3_u32 v27,v27,v248,v252
buffer_load_dwordx4 v42,s[20:23],s65 offen offset:0 sc1 lds
v_mfma_f32_16x16x32_bf16 v[72:75],a[200:203],v[248:251],v[72:75]
ds_read_b128 v[244:247],v43 offset:17408
v_mfma_f32_16x16x32_bf16 v[64:67],a[76:79],v[252:255],v[64:67]
buffer_load_dwordx4 v42,s[20:23],s65 offen offset:1024 sc1 lds
v_mfma_f32_16x16x32_bf16 v[72:75],a[204:207],v[252:255],v[72:75]
ds_read_b128 v[248:251],v17 offset:25600
s_waitcnt lgkmcnt(5)
v_mfma_f32_16x16x32_bf16 v[64:67],a[16:19],v[224:227],v[64:67]
v_min3_u32 v27,v27,v224,v228
s_xor_b32 m0,s91,53248
v_mfma_f32_16x16x32_bf16 v[72:75],a[144:147],v[224:227],v[72:75]
ds_read_b128 v[252:255],v43 offset:25600
v_mfma_f32_16x16x32_bf16 v[64:67],a[20:23],v[228:231],v[64:67]
s_add_u32 s65,s95,768
v_mfma_f32_16x16x32_bf16 v[72:75],a[148:151],v[228:231],v[72:75]
s_waitcnt vmcnt(6)
s_barrier
ds_read_b128 v[224:227],v17 offset:32768
s_waitcnt lgkmcnt(5)
v_mfma_f32_16x16x32_bf16 v[64:67],a[24:27],v[232:235],v[64:67]
v_min3_u32 v27,v27,v232,v236
buffer_load_dwordx4 v42,s[20:23],s65 offen offset:0 sc1 lds
v_mfma_f32_16x16x32_bf16 v[72:75],a[152:155],v[232:235],v[72:75]
ds_read_b128 v[228:231],v43 offset:32768
v_mfma_f32_16x16x32_bf16 v[64:67],a[28:31],v[236:239],v[64:67]
buffer_load_dwordx4 v42,s[20:23],s65 offen offset:1024 sc1 lds
v_mfma_f32_16x16x32_bf16 v[72:75],a[156:159],v[236:239],v[72:75]
ds_read_b128 v[232:235],v17 offset:40960
s_waitcnt lgkmcnt(5)
v_mfma_f32_16x16x32_bf16 v[64:67],a[80:83],v[240:243],v[64:67]
v_min3_u32 v27,v27,v240,v244
v_mfma_f32_16x16x32_bf16 v[72:75],a[208:211],v[240:243],v[72:75]
ds_read_b128 v[236:239],v43 offset:40960
v_mfma_f32_16x16x32_bf16 v[64:67],a[84:87],v[244:247],v[64:67]
v_add_u32 v22,s71,-1
v_mfma_f32_16x16x32_bf16 v[72:75],a[212:215],v[244:247],v[72:75]
ds_read_b128 v[240:243],v17 offset:33792
s_waitcnt lgkmcnt(5)
v_mfma_f32_16x16x32_bf16 v[64:67],a[88:91],v[248:251],v[64:67]
v_min3_u32 v27,v27,v248,v252
v_mfma_f32_16x16x32_bf16 v[72:75],a[216:219],v[248:251],v[72:75]
ds_read_b128 v[244:247],v43 offset:33792
v_mfma_f32_16x16x32_bf16 v[64:67],a[92:95],v[252:255],v[64:67]
buffer_store_dword v22,v23,s[24:27],s73 offen
v_mfma_f32_16x16x32_bf16 v[72:75],a[220:223],v[252:255],v[72:75]
ds_read_b128 v[248:251],v17 offset:41984
s_waitcnt lgkmcnt(5)
v_mfma_f32_16x16x32_bf16 v[64:67],a[32:35],v[224:227],v[64:67]
v_min3_u32 v27,v27,v224,v228
v_mfma_f32_16x16x32_bf16 v[72:75],a[160:163],v[224:227],v[72:75]
ds_read_b128 v[252:255],v43 offset:41984
v_mfma_f32_16x16x32_bf16 v[64:67],a[36:39],v[228:231],v[64:67]
buffer_store_dword v22,v23,s[28:31],s73 offen sc1
v_mfma_f32_16x16x32_bf16 v[72:75],a[164:167],v[228:231],v[72:75]
ds_read_b128 v[224:227],v17 offset:49152
s_waitcnt lgkmcnt(5)
v_mfma_f32_16x16x32_bf16 v[64:67],a[40:43],v[232:235],v[64:67]
v_min3_u32 v27,v27,v232,v236
v_mfma_f32_16x16x32_bf16 v[72:75],a[168:171],v[232:235],v[72:75]
ds_read_b128 v[228:231],v43 offset:49152
v_mfma_f32_16x16x32_bf16 v[64:67],a[44:47],v[236:239],v[64:67]
v_mfma_f32_16x16x32_bf16 v[72:75],a[172:175],v[236:239],v[72:75]
ds_read_b128 v[232:235],v17 offset:57344
s_waitcnt lgkmcnt(5)
v_mfma_f32_16x16x32_bf16 v[64:67],a[96:99],v[240:243],v[64:67]
v_min3_u32 v27,v27,v240,v244
v_mfma_f32_16x16x32_bf16 v[72:75],a[224:227],v[240:243],v[72:75]
ds_read_b128 v[236:239],v43 offset:57344
v_mfma_f32_16x16x32_bf16 v[64:67],a[100:103],v[244:247],v[64:67]
v_mfma_f32_16x16x32_bf16 v[72:75],a[228:231],v[244:247],v[72:75]
ds_read_b128 v[240:243],v17 offset:50176
s_waitcnt lgkmcnt(5)
v_mfma_f32_16x16x32_bf16 v[64:67],a[104:107],v[248:251],v[64:67]
v_min3_u32 v27,v27,v248,v252
v_mfma_f32_16x16x32_bf16 v[72:75],a[232:235],v[248:251],v[72:75]
ds_read_b128 v[244:247],v43 offset:50176
v_mfma_f32_16x16x32_bf16 v[64:67],a[108:111],v[252:255],v[64:67]
v_mfma_f32_16x16x32_bf16 v[72:75],a[236:239],v[252:255],v[72:75]
ds_read_b128 v[248:251],v17 offset:58368
s_waitcnt lgkmcnt(5)
v_mfma_f32_16x16x32_bf16 v[64:67],a[48:51],v[224:227],v[64:67]
v_min3_u32 v27,v27,v224,v228
v_mfma_f32_16x16x32_bf16 v[72:75],a[176:179],v[224:227],v[72:75]
ds_read_b128 v[252:255],v43 offset:58368
v_mfma_f32_16x16x32_bf16 v[64:67],a[52:55],v[228:231],v[64:67]
v_mfma_f32_16x16x32_bf16 v[72:75],a[180:183],v[228:231],v[72:75]
s_waitcnt vmcnt(2)
s_barrier
ds_read_b128 v[224:227],v17 offset:4096
s_waitcnt lgkmcnt(5)
v_mfma_f32_16x16x32_bf16 v[64:67],a[56:59],v[232:235],v[64:67]
v_min3_u32 v27,v27,v232,v236
s_add_u32 s92,s78,8388608
v_mfma_f32_16x16x32_bf16 v[72:75],a[184:187],v[232:235],v[72:75]
ds_read_b128 v[228:231],v43 offset:4096
s_sub_u32 s93,s71,53
v_mfma_f32_16x16x32_bf16 v[64:67],a[60:63],v[236:239],v[64:67]
s_cmp_lt_u32 s93,8
s_cselect_b32 s92,s92,0x7fff0000
v_mfma_f32_16x16x32_bf16 v[72:75],a[188:191],v[236:239],v[72:75]
ds_read_b128 v[232:235],v17 offset:12288
s_waitcnt lgkmcnt(5)
v_mfma_f32_16x16x32_bf16 v[64:67],a[112:115],v[240:243],v[64:67]
v_min3_u32 v27,v27,v240,v244
v_mfma_f32_16x16x32_bf16 v[72:75],a[240:243],v[240:243],v[72:75]
ds_read_b128 v[236:239],v43 offset:12288
v_mfma_f32_16x16x32_bf16 v[64:67],a[116:119],v[244:247],v[64:67]
v_mfma_f32_16x16x32_bf16 v[72:75],a[244:247],v[244:247],v[72:75]
ds_read_b128 v[240:243],v17 offset:5120
s_waitcnt lgkmcnt(5)
v_mfma_f32_16x16x32_bf16 v[64:67],a[120:123],v[248:251],v[64:67]
v_min3_u32 v27,v27,v248,v252
v_mfma_f32_16x16x32_bf16 v[72:75],a[248:251],v[248:251],v[72:75]
ds_read_b128 v[244:247],v43 offset:5120
v_mfma_f32_16x16x32_bf16 v[64:67],a[124:127],v[252:255],v[64:67]
buffer_load_dword v2,v21,s[20:23],s87 offen sc1
s_add_u32 s96,s71,2
v_mfma_f32_16x16x32_bf16 v[72:75],a[252:255],v[252:255],v[72:75]
ds_read_b128 v[248:251],v17 offset:13312
s_waitcnt lgkmcnt(5)
v_mfma_f32_16x16x32_bf16 v[68:71],a[0:3],v[224:227],0
v_cmp_eq_u32 vcc,0,v27
s_cbranch_vccnz retry_193
v_mfma_f32_16x16x32_bf16 v[76:79],a[128:131],v[224:227],0
ds_read_b128 v[252:255],v43 offset:13312
v_min3_u32 v27,v27,v224,v228
v_mfma_f32_16x16x32_bf16 v[68:71],a[4:7],v[228:231],v[68:71]
s_cmp_gt_u32 s96,56
s_addc_u32 s96,s96,0
v_mfma_f32_16x16x32_bf16 v[76:79],a[132:135],v[228:231],v[76:79]
ds_read_b128 v[224:227],v17 offset:20480
s_waitcnt lgkmcnt(5)
v_mfma_f32_16x16x32_bf16 v[68:71],a[8:11],v[232:235],v[68:71]
v_min3_u32 v27,v27,v232,v236
v_mul_f32 v88,v64,v64
v_mul_f32 v89,v65,v65
v_mfma_f32_16x16x32_bf16 v[76:79],a[136:139],v[232:235],v[76:79]
ds_read_b128 v[228:231],v43 offset:20480
v_mul_f32 v90,v66,v66
v_mul_f32 v91,v67,v67
v_mfma_f32_16x16x32_bf16 v[68:71],a[12:15],v[236:239],v[68:71]
buffer_store_dwordx4 v[48:51],v18,s[20:23],s92 offen sc1
v_mul_f32 v92,v72,v72
v_mfma_f32_16x16x32_bf16 v[76:79],a[140:143],v[236:239],v[76:79]
ds_read_b128 v[232:235],v17 offset:28672
v_mul_f32 v93,v73,v73
s_waitcnt lgkmcnt(5)
v_mfma_f32_16x16x32_bf16 v[68:71],a[64:67],v[240:243],v[68:71]
v_min3_u32 v27,v27,v240,v244
v_fma_f32 v88,v88,s81,v28
v_mul_f32 v94,v74,v74
v_mfma_f32_16x16x32_bf16 v[76:79],a[192:195],v[240:243],v[76:79]
ds_read_b128 v[236:239],v43 offset:28672
v_fma_f32 v89,v89,s81,v28
v_mul_f32 v95,v75,v75
v_mfma_f32_16x16x32_bf16 v[68:71],a[68:71],v[244:247],v[68:71]
buffer_store_dwordx4 v[48:51],v19,s[20:23],s92 offen sc1
v_fma_f32 v92,v92,s81,v28
v_mfma_f32_16x16x32_bf16 v[76:79],a[196:199],v[244:247],v[76:79]
ds_read_b128 v[240:243],v17 offset:21504
v_fma_f32 v93,v93,s81,v28
s_waitcnt lgkmcnt(5)
v_mfma_f32_16x16x32_bf16 v[68:71],a[72:75],v[248:251],v[68:71]
v_min3_u32 v27,v27,v248,v252
v_fma_f32 v90,v90,s81,v28
v_fma_f32 v94,v94,s81,v28
v_mfma_f32_16x16x32_bf16 v[76:79],a[200:203],v[248:251],v[76:79]
ds_read_b128 v[244:247],v43 offset:21504
v_fma_f32 v91,v91,s81,v28
v_fma_f32 v95,v95,s81,v28
v_mfma_f32_16x16x32_bf16 v[68:71],a[76:79],v[252:255],v[68:71]
v_mul_f32 v88,v88,v64
v_mul_f32 v89,v89,v65
v_mul_f32 v92,v92,v72
v_mfma_f32_16x16x32_bf16 v[76:79],a[204:207],v[252:255],v[76:79]
ds_read_b128 v[248:251],v17 offset:29696
v_mul_f32 v93,v93,v73
s_waitcnt lgkmcnt(5)
v_mfma_f32_16x16x32_bf16 v[68:71],a[16:19],v[224:227],v[68:71]
v_min3_u32 v27,v27,v224,v228
v_mul_f32 v90,v90,v66
v_mul_f32 v94,v94,v74
v_mfma_f32_16x16x32_bf16 v[76:79],a[144:147],v[224:227],v[76:79]
ds_read_b128 v[252:255],v43 offset:29696
v_mul_f32 v91,v91,v67
v_mul_f32 v95,v95,v75
v_mfma_f32_16x16x32_bf16 v[68:71],a[20:23],v[228:231],v[68:71]
v_exp_f32 v88,v88
v_mfma_f32_16x16x32_bf16 v[76:79],a[148:151],v[228:231],v[76:79]
ds_read_b128 v[224:227],v17 offset:36864
s_waitcnt lgkmcnt(5)
v_mfma_f32_16x16x32_bf16 v[68:71],a[24:27],v[232:235],v[68:71]
v_min3_u32 v27,v27,v232,v236
v_exp_f32 v92,v92
v_mfma_f32_16x16x32_bf16 v[76:79],a[152:155],v[232:235],v[76:79]
ds_read_b128 v[228:231],v43 offset:36864
v_exp_f32 v93,v93
v_mfma_f32_16x16x32_bf16 v[68:71],a[28:31],v[236:239],v[68:71]
v_exp_f32 v89,v89
v_mfma_f32_16x16x32_bf16 v[76:79],a[156:159],v[236:239],v[76:79]
ds_read_b128 v[232:235],v17 offset:45056
s_waitcnt lgkmcnt(5)
v_mfma_f32_16x16x32_bf16 v[68:71],a[80:83],v[240:243],v[68:71]
v_min3_u32 v27,v27,v240,v244
v_exp_f32 v94,v94
v_mfma_f32_16x16x32_bf16 v[76:79],a[208:211],v[240:243],v[76:79]
ds_read_b128 v[236:239],v43 offset:45056
v_exp_f32 v95,v95
v_mfma_f32_16x16x32_bf16 v[68:71],a[84:87],v[244:247],v[68:71]
v_exp_f32 v90,v90
v_add_f32 v92,1.0,v92
v_mfma_f32_16x16x32_bf16 v[76:79],a[212:215],v[244:247],v[76:79]
ds_read_b128 v[240:243],v17 offset:37888
v_add_f32 v93,1.0,v93
s_waitcnt lgkmcnt(5)
v_mfma_f32_16x16x32_bf16 v[68:71],a[88:91],v[248:251],v[68:71]
v_min3_u32 v27,v27,v248,v252
v_add_f32 v94,1.0,v94
v_add_f32 v95,1.0,v95
v_mfma_f32_16x16x32_bf16 v[76:79],a[216:219],v[248:251],v[76:79]
ds_read_b128 v[244:247],v43 offset:37888
v_rcp_f32 v92,v92
v_mfma_f32_16x16x32_bf16 v[68:71],a[92:95],v[252:255],v[68:71]
v_exp_f32 v91,v91
v_mfma_f32_16x16x32_bf16 v[76:79],a[220:223],v[252:255],v[76:79]
ds_read_b128 v[248:251],v17 offset:46080
s_waitcnt lgkmcnt(5)
v_mfma_f32_16x16x32_bf16 v[68:71],a[32:35],v[224:227],v[68:71]
v_min3_u32 v27,v27,v224,v228
v_add_f32 v88,1.0,v88
v_mfma_f32_16x16x32_bf16 v[76:79],a[160:163],v[224:227],v[76:79]
ds_read_b128 v[252:255],v43 offset:46080
v_add_f32 v89,1.0,v89
v_mfma_f32_16x16x32_bf16 v[68:71],a[36:39],v[228:231],v[68:71]
v_add_f32 v90,1.0,v90
v_add_f32 v91,1.0,v91
v_mfma_f32_16x16x32_bf16 v[76:79],a[164:167],v[228:231],v[76:79]
ds_read_b128 v[224:227],v17 offset:53248
s_waitcnt lgkmcnt(5)
v_mfma_f32_16x16x32_bf16 v[68:71],a[40:43],v[232:235],v[68:71]
v_min3_u32 v27,v27,v232,v236
v_rcp_f32 v93,v93
v_mfma_f32_16x16x32_bf16 v[76:79],a[168:171],v[232:235],v[76:79]
ds_read_b128 v[228:231],v43 offset:53248
v_rcp_f32 v94,v94
v_mfma_f32_16x16x32_bf16 v[68:71],a[44:47],v[236:239],v[68:71]
v_rcp_f32 v88,v88
v_mfma_f32_16x16x32_bf16 v[76:79],a[172:175],v[236:239],v[76:79]
ds_read_b128 v[232:235],v17 offset:61440
s_waitcnt lgkmcnt(5)
v_mfma_f32_16x16x32_bf16 v[68:71],a[96:99],v[240:243],v[68:71]
v_min3_u32 v27,v27,v240,v244
v_rcp_f32 v95,v95
v_mfma_f32_16x16x32_bf16 v[76:79],a[224:227],v[240:243],v[76:79]
ds_read_b128 v[236:239],v43 offset:61440
v_mul_f32 v92,v92,v72
v_mfma_f32_16x16x32_bf16 v[68:71],a[100:103],v[244:247],v[68:71]
v_rcp_f32 v89,v89
v_mfma_f32_16x16x32_bf16 v[76:79],a[228:231],v[244:247],v[76:79]
ds_read_b128 v[240:243],v17 offset:54272
s_waitcnt lgkmcnt(5)
v_mfma_f32_16x16x32_bf16 v[68:71],a[104:107],v[248:251],v[68:71]
v_min3_u32 v27,v27,v248,v252
v_mul_f32 v93,v93,v73
v_mfma_f32_16x16x32_bf16 v[76:79],a[232:235],v[248:251],v[76:79]
ds_read_b128 v[244:247],v43 offset:54272
v_mul_f32 v94,v94,v74
v_mfma_f32_16x16x32_bf16 v[68:71],a[108:111],v[252:255],v[68:71]
v_rcp_f32 v90,v90
v_mfma_f32_16x16x32_bf16 v[76:79],a[236:239],v[252:255],v[76:79]
ds_read_b128 v[248:251],v17 offset:62464
s_waitcnt lgkmcnt(5)
v_mfma_f32_16x16x32_bf16 v[68:71],a[48:51],v[224:227],v[68:71]
v_min3_u32 v27,v27,v224,v228
v_mul_f32 v95,v95,v75
v_mfma_f32_16x16x32_bf16 v[76:79],a[176:179],v[224:227],v[76:79]
ds_read_b128 v[252:255],v43 offset:62464
v_mfma_f32_16x16x32_bf16 v[68:71],a[52:55],v[228:231],v[68:71]
v_rcp_f32 v91,v91
v_mfma_f32_16x16x32_bf16 v[76:79],a[180:183],v[228:231],v[76:79]
v_mul_f32 v88,v88,v64
s_waitcnt lgkmcnt(4)
v_mfma_f32_16x16x32_bf16 v[68:71],a[56:59],v[232:235],v[68:71]
v_min3_u32 v27,v27,v232,v236
s_waitcnt vmcnt(2)
v_mfma_f32_16x16x32_bf16 v[76:79],a[184:187],v[232:235],v[76:79]
v_cmp_gt_u32 vcc,s96,v2
s_mov_b32 s96,vcc_lo
v_mfma_f32_16x16x32_bf16 v[68:71],a[60:63],v[236:239],v[68:71]
v_mov_b32 v44,s96
ds_write_b32 v46,v44
v_mfma_f32_16x16x32_bf16 v[76:79],a[188:191],v[236:239],v[76:79]
v_mul_f32 v89,v89,v65
s_waitcnt lgkmcnt(3)
v_mfma_f32_16x16x32_bf16 v[68:71],a[112:115],v[240:243],v[68:71]
v_min3_u32 v27,v27,v240,v244
v_mul_f32 v90,v90,v66
v_mfma_f32_16x16x32_bf16 v[76:79],a[240:243],v[240:243],v[76:79]
v_mul_f32 v91,v91,v67
v_cvt_pk_bf16_f32 v96,v88,v89
v_mfma_f32_16x16x32_bf16 v[68:71],a[116:119],v[244:247],v[68:71]
v_cvt_pk_bf16_f32 v97,v90,v91
v_cvt_pk_bf16_f32 v98,v92,v93
v_mfma_f32_16x16x32_bf16 v[76:79],a[244:247],v[244:247],v[76:79]
v_cvt_pk_bf16_f32 v99,v94,v95
s_waitcnt lgkmcnt(1)
v_mfma_f32_16x16x32_bf16 v[68:71],a[120:123],v[248:251],v[68:71]
v_min3_u32 v27,v27,v248,v252
v_max_u32 v96,1,v96
v_mfma_f32_16x16x32_bf16 v[76:79],a[248:251],v[248:251],v[76:79]
buffer_store_dwordx4 v[96:99],v18,s[20:23],s78 offen sc1
v_mfma_f32_16x16x32_bf16 v[68:71],a[124:127],v[252:255],v[68:71]
v_mfma_f32_16x16x32_bf16 v[76:79],a[252:255],v[252:255],v[76:79]
v_cmp_eq_u32 vcc,0,v27
s_cbranch_vccnz retry_193
s_branch epi_196
both_197:
s_waitcnt vmcnt(8)
s_barrier
ds_read_b128 v[224:227],v17 offset:0
ds_read_b128 v[228:231],v43 offset:0
ds_read_b128 v[232:235],v17 offset:8192
ds_read_b128 v[236:239],v43 offset:8192
ds_read_b128 v[240:243],v17 offset:1024
ds_read_b128 v[244:247],v43 offset:1024
ds_read_b128 v[248:251],v17 offset:9216
s_waitcnt lgkmcnt(5)
v_mfma_f32_16x16x32_bf16 v[64:67],a[0:3],v[224:227],0
v_min_u32 v27,v224,v228
s_xor_b32 m0,s91,20480
v_mfma_f32_16x16x32_bf16 v[72:75],a[128:131],v[224:227],0
ds_read_b128 v[252:255],v43 offset:9216
s_add_u32 s88,s70,s75
v_mfma_f32_16x16x32_bf16 v[64:67],a[4:7],v[228:231],v[64:67]
s_add_u32 s65,s95,256
s_add_u32 s88,s88,2097152
v_mfma_f32_16x16x32_bf16 v[72:75],a[132:135],v[228:231],v[72:75]
s_waitcnt vmcnt(6)
s_barrier
ds_read_b128 v[224:227],v17 offset:16384
s_waitcnt lgkmcnt(5)
v_mfma_f32_16x16x32_bf16 v[64:67],a[8:11],v[232:235],v[64:67]
v_min3_u32 v27,v27,v232,v236
buffer_load_dwordx4 v42,s[20:23],s65 offen offset:0 sc1 lds
v_mfma_f32_16x16x32_bf16 v[72:75],a[136:139],v[232:235],v[72:75]
ds_read_b128 v[228:231],v43 offset:16384
s_xor_b32 s88,s88,0x2000
v_mfma_f32_16x16x32_bf16 v[64:67],a[12:15],v[236:239],v[64:67]
buffer_load_dwordx4 v42,s[20:23],s65 offen offset:1024 sc1 lds
v_mfma_f32_16x16x32_bf16 v[72:75],a[140:143],v[236:239],v[72:75]
ds_read_b128 v[232:235],v17 offset:24576
s_waitcnt lgkmcnt(5)
v_mfma_f32_16x16x32_bf16 v[64:67],a[64:67],v[240:243],v[64:67]
v_min3_u32 v27,v27,v240,v244
s_xor_b32 m0,s91,36864
v_mfma_f32_16x16x32_bf16 v[72:75],a[192:195],v[240:243],v[72:75]
ds_read_b128 v[236:239],v43 offset:24576
s_add_u32 s89,s88,65536
v_mfma_f32_16x16x32_bf16 v[64:67],a[68:71],v[244:247],v[64:67]
s_add_u32 s65,s95,512
v_mfma_f32_16x16x32_bf16 v[72:75],a[196:199],v[244:247],v[72:75]
ds_read_b128 v[240:243],v17 offset:17408
s_waitcnt lgkmcnt(5)
v_mfma_f32_16x16x32_bf16 v[64:67],a[72:75],v[248:251],v[64:67]
v_min3_u32 v27,v27,v248,v252
buffer_load_dwordx4 v42,s[20:23],s65 offen offset:0 sc1 lds
v_mfma_f32_16x16x32_bf16 v[72:75],a[200:203],v[248:251],v[72:75]
ds_read_b128 v[244:247],v43 offset:17408
v_mfma_f32_16x16x32_bf16 v[64:67],a[76:79],v[252:255],v[64:67]
buffer_load_dwordx4 v42,s[20:23],s65 offen offset:1024 sc1 lds
v_mfma_f32_16x16x32_bf16 v[72:75],a[204:207],v[252:255],v[72:75]
ds_read_b128 v[248:251],v17 offset:25600
s_waitcnt lgkmcnt(5)
v_mfma_f32_16x16x32_bf16 v[64:67],a[16:19],v[224:227],v[64:67]
v_min3_u32 v27,v27,v224,v228
s_xor_b32 m0,s91,53248
v_mfma_f32_16x16x32_bf16 v[72:75],a[144:147],v[224:227],v[72:75]
ds_read_b128 v[252:255],v43 offset:25600
v_mfma_f32_16x16x32_bf16 v[64:67],a[20:23],v[228:231],v[64:67]
s_add_u32 s65,s95,768
v_mfma_f32_16x16x32_bf16 v[72:75],a[148:151],v[228:231],v[72:75]
s_waitcnt vmcnt(6)
s_barrier
ds_read_b128 v[224:227],v17 offset:32768
s_waitcnt lgkmcnt(5)
v_mfma_f32_16x16x32_bf16 v[64:67],a[24:27],v[232:235],v[64:67]
v_min3_u32 v27,v27,v232,v236
buffer_load_dwordx4 v42,s[20:23],s65 offen offset:0 sc1 lds
v_mfma_f32_16x16x32_bf16 v[72:75],a[152:155],v[232:235],v[72:75]
ds_read_b128 v[228:231],v43 offset:32768
v_mfma_f32_16x16x32_bf16 v[64:67],a[28:31],v[236:239],v[64:67]
buffer_load_dwordx4 v42,s[20:23],s65 offen offset:1024 sc1 lds
v_mfma_f32_16x16x32_bf16 v[72:75],a[156:159],v[236:239],v[72:75]
ds_read_b128 v[232:235],v17 offset:40960
s_waitcnt lgkmcnt(5)
v_mfma_f32_16x16x32_bf16 v[64:67],a[80:83],v[240:243],v[64:67]
v_min3_u32 v27,v27,v240,v244
v_mfma_f32_16x16x32_bf16 v[72:75],a[208:211],v[240:243],v[72:75]
ds_read_b128 v[236:239],v43 offset:40960
v_mfma_f32_16x16x32_bf16 v[64:67],a[84:87],v[244:247],v[64:67]
v_add_u32 v22,s71,-1
v_mfma_f32_16x16x32_bf16 v[72:75],a[212:215],v[244:247],v[72:75]
ds_read_b128 v[240:243],v17 offset:33792
s_waitcnt lgkmcnt(5)
v_mfma_f32_16x16x32_bf16 v[64:67],a[88:91],v[248:251],v[64:67]
v_min3_u32 v27,v27,v248,v252
v_mfma_f32_16x16x32_bf16 v[72:75],a[216:219],v[248:251],v[72:75]
ds_read_b128 v[244:247],v43 offset:33792
v_mfma_f32_16x16x32_bf16 v[64:67],a[92:95],v[252:255],v[64:67]
buffer_store_dword v22,v23,s[24:27],s73 offen
v_mfma_f32_16x16x32_bf16 v[72:75],a[220:223],v[252:255],v[72:75]
ds_read_b128 v[248:251],v17 offset:41984
s_waitcnt lgkmcnt(5)
v_mfma_f32_16x16x32_bf16 v[64:67],a[32:35],v[224:227],v[64:67]
v_min3_u32 v27,v27,v224,v228
s_xor_b32 m0,s72,0
v_mfma_f32_16x16x32_bf16 v[72:75],a[160:163],v[224:227],v[72:75]
ds_read_b128 v[252:255],v43 offset:41984
s_add_u32 s65,s88,0
v_mfma_f32_16x16x32_bf16 v[64:67],a[36:39],v[228:231],v[64:67]
buffer_store_dword v22,v23,s[28:31],s73 offen sc1
v_mfma_f32_16x16x32_bf16 v[72:75],a[164:167],v[228:231],v[72:75]
ds_read_b128 v[224:227],v17 offset:49152
buffer_load_dwordx4 v42,s[20:23],s65 offen offset:0 sc1 lds
s_waitcnt lgkmcnt(5)
v_mfma_f32_16x16x32_bf16 v[64:67],a[40:43],v[232:235],v[64:67]
v_min3_u32 v27,v27,v232,v236
v_mfma_f32_16x16x32_bf16 v[72:75],a[168:171],v[232:235],v[72:75]
ds_read_b128 v[228:231],v43 offset:49152
buffer_load_dwordx4 v42,s[20:23],s65 offen offset:1024 sc1 lds
v_mfma_f32_16x16x32_bf16 v[64:67],a[44:47],v[236:239],v[64:67]
v_mfma_f32_16x16x32_bf16 v[72:75],a[172:175],v[236:239],v[72:75]
ds_read_b128 v[232:235],v17 offset:57344
s_xor_b32 m0,s72,16384
s_waitcnt lgkmcnt(5)
v_mfma_f32_16x16x32_bf16 v[64:67],a[96:99],v[240:243],v[64:67]
v_min3_u32 v27,v27,v240,v244
s_add_u32 s65,s88,256
v_mfma_f32_16x16x32_bf16 v[72:75],a[224:227],v[240:243],v[72:75]
ds_read_b128 v[236:239],v43 offset:57344
v_mfma_f32_16x16x32_bf16 v[64:67],a[100:103],v[244:247],v[64:67]
buffer_load_dwordx4 v42,s[20:23],s65 offen offset:0 sc1 lds
v_mfma_f32_16x16x32_bf16 v[72:75],a[228:231],v[244:247],v[72:75]
ds_read_b128 v[240:243],v17 offset:50176
s_waitcnt lgkmcnt(5)
v_mfma_f32_16x16x32_bf16 v[64:67],a[104:107],v[248:251],v[64:67]
v_min3_u32 v27,v27,v248,v252
buffer_load_dwordx4 v42,s[20:23],s65 offen offset:1024 sc1 lds
v_mfma_f32_16x16x32_bf16 v[72:75],a[232:235],v[248:251],v[72:75]
ds_read_b128 v[244:247],v43 offset:50176
v_mfma_f32_16x16x32_bf16 v[64:67],a[108:111],v[252:255],v[64:67]
s_xor_b32 m0,s72,32768
v_mfma_f32_16x16x32_bf16 v[72:75],a[236:239],v[252:255],v[72:75]
ds_read_b128 v[248:251],v17 offset:58368
s_add_u32 s65,s88,512
s_waitcnt lgkmcnt(5)
v_mfma_f32_16x16x32_bf16 v[64:67],a[48:51],v[224:227],v[64:67]
v_min3_u32 v27,v27,v224,v228
v_mfma_f32_16x16x32_bf16 v[72:75],a[176:179],v[224:227],v[72:75]
ds_read_b128 v[252:255],v43 offset:58368
buffer_load_dwordx4 v42,s[20:23],s65 offen offset:0 sc1 lds
v_mfma_f32_16x16x32_bf16 v[64:67],a[52:55],v[228:231],v[64:67]
v_mfma_f32_16x16x32_bf16 v[72:75],a[180:183],v[228:231],v[72:75]
s_waitcnt vmcnt(7)
s_barrier
ds_read_b128 v[224:227],v17 offset:4096
s_waitcnt lgkmcnt(5)
v_mfma_f32_16x16x32_bf16 v[64:67],a[56:59],v[232:235],v[64:67]
v_min3_u32 v27,v27,v232,v236
s_add_u32 s92,s78,8388608
buffer_load_dwordx4 v42,s[20:23],s65 offen offset:1024 sc1 lds
v_mfma_f32_16x16x32_bf16 v[72:75],a[184:187],v[232:235],v[72:75]
ds_read_b128 v[228:231],v43 offset:4096
s_sub_u32 s93,s71,53
s_xor_b32 m0,s72,49152
v_mfma_f32_16x16x32_bf16 v[64:67],a[60:63],v[236:239],v[64:67]
s_cmp_lt_u32 s93,8
s_cselect_b32 s92,s92,0x7fff0000
s_add_u32 s65,s88,768
v_mfma_f32_16x16x32_bf16 v[72:75],a[188:191],v[236:239],v[72:75]
ds_read_b128 v[232:235],v17 offset:12288
s_waitcnt lgkmcnt(5)
v_mfma_f32_16x16x32_bf16 v[64:67],a[112:115],v[240:243],v[64:67]
v_min3_u32 v27,v27,v240,v244
buffer_load_dwordx4 v42,s[20:23],s65 offen offset:0 sc1 lds
v_mfma_f32_16x16x32_bf16 v[72:75],a[240:243],v[240:243],v[72:75]
ds_read_b128 v[236:239],v43 offset:12288
v_mfma_f32_16x16x32_bf16 v[64:67],a[116:119],v[244:247],v[64:67]
buffer_load_dwordx4 v42,s[20:23],s65 offen offset:1024 sc1 lds
v_mfma_f32_16x16x32_bf16 v[72:75],a[244:247],v[244:247],v[72:75]
ds_read_b128 v[240:243],v17 offset:5120
s_waitcnt lgkmcnt(5)
v_mfma_f32_16x16x32_bf16 v[64:67],a[120:123],v[248:251],v[64:67]
v_min3_u32 v27,v27,v248,v252
s_xor_b32 m0,s72,4096
v_mfma_f32_16x16x32_bf16 v[72:75],a[248:251],v[248:251],v[72:75]
ds_read_b128 v[244:247],v43 offset:5120
s_add_u32 s65,s89,0
v_mfma_f32_16x16x32_bf16 v[64:67],a[124:127],v[252:255],v[64:67]
buffer_load_dword v2,v21,s[20:23],s87 offen sc1
s_add_u32 s96,s71,2
v_mfma_f32_16x16x32_bf16 v[72:75],a[252:255],v[252:255],v[72:75]
ds_read_b128 v[248:251],v17 offset:13312
buffer_load_dwordx4 v42,s[20:23],s65 offen offset:0 sc1 lds
s_waitcnt lgkmcnt(5)
v_mfma_f32_16x16x32_bf16 v[68:71],a[0:3],v[224:227],0
v_cmp_eq_u32 vcc,0,v27
s_cbranch_vccnz retry_193
v_mfma_f32_16x16x32_bf16 v[76:79],a[128:131],v[224:227],0
ds_read_b128 v[252:255],v43 offset:13312
v_min3_u32 v27,v27,v224,v228
buffer_load_dwordx4 v42,s[20:23],s65 offen offset:1024 sc1 lds
v_mfma_f32_16x16x32_bf16 v[68:71],a[4:7],v[228:231],v[68:71]
s_cmp_gt_u32 s96,56
s_addc_u32 s96,s96,0
v_mfma_f32_16x16x32_bf16 v[76:79],a[132:135],v[228:231],v[76:79]
ds_read_b128 v[224:227],v17 offset:20480
s_xor_b32 m0,s72,20480
s_waitcnt lgkmcnt(5)
v_mfma_f32_16x16x32_bf16 v[68:71],a[8:11],v[232:235],v[68:71]
v_min3_u32 v27,v27,v232,v236
v_mul_f32 v88,v64,v64
v_mul_f32 v89,v65,v65
s_add_u32 s65,s89,256
v_mfma_f32_16x16x32_bf16 v[76:79],a[136:139],v[232:235],v[76:79]
ds_read_b128 v[228:231],v43 offset:20480
v_mul_f32 v90,v66,v66
v_mul_f32 v91,v67,v67
v_mfma_f32_16x16x32_bf16 v[68:71],a[12:15],v[236:239],v[68:71]
buffer_store_dwordx4 v[48:51],v18,s[20:23],s92 offen sc1
v_mul_f32 v92,v72,v72
v_mfma_f32_16x16x32_bf16 v[76:79],a[140:143],v[236:239],v[76:79]
ds_read_b128 v[232:235],v17 offset:28672
v_mul_f32 v93,v73,v73
s_waitcnt lgkmcnt(5)
v_mfma_f32_16x16x32_bf16 v[68:71],a[64:67],v[240:243],v[68:71]
v_min3_u32 v27,v27,v240,v244
v_fma_f32 v88,v88,s81,v28
v_mul_f32 v94,v74,v74
v_mfma_f32_16x16x32_bf16 v[76:79],a[192:195],v[240:243],v[76:79]
ds_read_b128 v[236:239],v43 offset:28672
v_fma_f32 v89,v89,s81,v28
v_mul_f32 v95,v75,v75
v_mfma_f32_16x16x32_bf16 v[68:71],a[68:71],v[244:247],v[68:71]
buffer_store_dwordx4 v[48:51],v19,s[20:23],s92 offen sc1
v_fma_f32 v92,v92,s81,v28
v_mfma_f32_16x16x32_bf16 v[76:79],a[196:199],v[244:247],v[76:79]
ds_read_b128 v[240:243],v17 offset:21504
v_fma_f32 v93,v93,s81,v28
s_waitcnt lgkmcnt(5)
v_mfma_f32_16x16x32_bf16 v[68:71],a[72:75],v[248:251],v[68:71]
v_min3_u32 v27,v27,v248,v252
v_fma_f32 v90,v90,s81,v28
v_fma_f32 v94,v94,s81,v28
v_mfma_f32_16x16x32_bf16 v[76:79],a[200:203],v[248:251],v[76:79]
ds_read_b128 v[244:247],v43 offset:21504
v_fma_f32 v91,v91,s81,v28
v_fma_f32 v95,v95,s81,v28
v_mfma_f32_16x16x32_bf16 v[68:71],a[76:79],v[252:255],v[68:71]
v_mul_f32 v88,v88,v64
v_mul_f32 v89,v89,v65
v_mul_f32 v92,v92,v72
v_mfma_f32_16x16x32_bf16 v[76:79],a[204:207],v[252:255],v[76:79]
ds_read_b128 v[248:251],v17 offset:29696
v_mul_f32 v93,v93,v73
s_waitcnt lgkmcnt(5)
v_mfma_f32_16x16x32_bf16 v[68:71],a[16:19],v[224:227],v[68:71]
v_min3_u32 v27,v27,v224,v228
v_mul_f32 v90,v90,v66
v_mul_f32 v94,v94,v74
v_mfma_f32_16x16x32_bf16 v[76:79],a[144:147],v[224:227],v[76:79]
ds_read_b128 v[252:255],v43 offset:29696
v_mul_f32 v91,v91,v67
v_mul_f32 v95,v95,v75
v_mfma_f32_16x16x32_bf16 v[68:71],a[20:23],v[228:231],v[68:71]
v_exp_f32 v88,v88
buffer_load_dwordx4 v42,s[20:23],s65 offen offset:0 sc1 lds
v_mfma_f32_16x16x32_bf16 v[76:79],a[148:151],v[228:231],v[76:79]
ds_read_b128 v[224:227],v17 offset:36864
buffer_load_dwordx4 v42,s[20:23],s65 offen offset:1024 sc1 lds
s_waitcnt lgkmcnt(5)
v_mfma_f32_16x16x32_bf16 v[68:71],a[24:27],v[232:235],v[68:71]
v_min3_u32 v27,v27,v232,v236
v_exp_f32 v92,v92
s_xor_b32 m0,s72,36864
v_mfma_f32_16x16x32_bf16 v[76:79],a[152:155],v[232:235],v[76:79]
ds_read_b128 v[228:231],v43 offset:36864
v_exp_f32 v93,v93
s_add_u32 s65,s89,512
v_mfma_f32_16x16x32_bf16 v[68:71],a[28:31],v[236:239],v[68:71]
v_exp_f32 v89,v89
buffer_load_dwordx4 v42,s[20:23],s65 offen offset:0 sc1 lds
v_mfma_f32_16x16x32_bf16 v[76:79],a[156:159],v[236:239],v[76:79]
ds_read_b128 v[232:235],v17 offset:45056
buffer_load_dwordx4 v42,s[20:23],s65 offen offset:1024 sc1 lds
s_waitcnt lgkmcnt(5)
v_mfma_f32_16x16x32_bf16 v[68:71],a[80:83],v[240:243],v[68:71]
v_min3_u32 v27,v27,v240,v244
v_exp_f32 v94,v94
s_xor_b32 m0,s72,53248
v_mfma_f32_16x16x32_bf16 v[76:79],a[208:211],v[240:243],v[76:79]
ds_read_b128 v[236:239],v43 offset:45056
v_exp_f32 v95,v95
v_mfma_f32_16x16x32_bf16 v[68:71],a[84:87],v[244:247],v[68:71]
v_exp_f32 v90,v90
v_add_f32 v92,1.0,v92
v_mfma_f32_16x16x32_bf16 v[76:79],a[212:215],v[244:247],v[76:79]
ds_read_b128 v[240:243],v17 offset:37888
v_add_f32 v93,1.0,v93
s_waitcnt lgkmcnt(5)
v_mfma_f32_16x16x32_bf16 v[68:71],a[88:91],v[248:251],v[68:71]
v_min3_u32 v27,v27,v248,v252
v_add_f32 v94,1.0,v94
v_add_f32 v95,1.0,v95
v_mfma_f32_16x16x32_bf16 v[76:79],a[216:219],v[248:251],v[76:79]
ds_read_b128 v[244:247],v43 offset:37888
v_rcp_f32 v92,v92
v_mfma_f32_16x16x32_bf16 v[68:71],a[92:95],v[252:255],v[68:71]
v_exp_f32 v91,v91
v_mfma_f32_16x16x32_bf16 v[76:79],a[220:223],v[252:255],v[76:79]
ds_read_b128 v[248:251],v17 offset:46080
s_waitcnt lgkmcnt(5)
v_mfma_f32_16x16x32_bf16 v[68:71],a[32:35],v[224:227],v[68:71]
v_min3_u32 v27,v27,v224,v228
v_add_f32 v88,1.0,v88
v_mfma_f32_16x16x32_bf16 v[76:79],a[160:163],v[224:227],v[76:79]
ds_read_b128 v[252:255],v43 offset:46080
v_add_f32 v89,1.0,v89
v_mfma_f32_16x16x32_bf16 v[68:71],a[36:39],v[228:231],v[68:71]
v_add_f32 v90,1.0,v90
v_add_f32 v91,1.0,v91
v_mfma_f32_16x16x32_bf16 v[76:79],a[164:167],v[228:231],v[76:79]
ds_read_b128 v[224:227],v17 offset:53248
s_waitcnt lgkmcnt(5)
v_mfma_f32_16x16x32_bf16 v[68:71],a[40:43],v[232:235],v[68:71]
v_min3_u32 v27,v27,v232,v236
v_rcp_f32 v93,v93
v_mfma_f32_16x16x32_bf16 v[76:79],a[168:171],v[232:235],v[76:79]
ds_read_b128 v[228:231],v43 offset:53248
v_rcp_f32 v94,v94
v_mfma_f32_16x16x32_bf16 v[68:71],a[44:47],v[236:239],v[68:71]
v_rcp_f32 v88,v88
v_mfma_f32_16x16x32_bf16 v[76:79],a[172:175],v[236:239],v[76:79]
ds_read_b128 v[232:235],v17 offset:61440
s_waitcnt lgkmcnt(5)
v_mfma_f32_16x16x32_bf16 v[68:71],a[96:99],v[240:243],v[68:71]
v_min3_u32 v27,v27,v240,v244
v_rcp_f32 v95,v95
v_mfma_f32_16x16x32_bf16 v[76:79],a[224:227],v[240:243],v[76:79]
ds_read_b128 v[236:239],v43 offset:61440
v_mul_f32 v92,v92,v72
v_mfma_f32_16x16x32_bf16 v[68:71],a[100:103],v[244:247],v[68:71]
v_rcp_f32 v89,v89
v_mfma_f32_16x16x32_bf16 v[76:79],a[228:231],v[244:247],v[76:79]
ds_read_b128 v[240:243],v17 offset:54272
s_waitcnt lgkmcnt(5)
v_mfma_f32_16x16x32_bf16 v[68:71],a[104:107],v[248:251],v[68:71]
v_min3_u32 v27,v27,v248,v252
v_mul_f32 v93,v93,v73
v_mfma_f32_16x16x32_bf16 v[76:79],a[232:235],v[248:251],v[76:79]
ds_read_b128 v[244:247],v43 offset:54272
v_mul_f32 v94,v94,v74
v_mfma_f32_16x16x32_bf16 v[68:71],a[108:111],v[252:255],v[68:71]
v_rcp_f32 v90,v90
v_mfma_f32_16x16x32_bf16 v[76:79],a[236:239],v[252:255],v[76:79]
ds_read_b128 v[248:251],v17 offset:62464
s_waitcnt lgkmcnt(5)
v_mfma_f32_16x16x32_bf16 v[68:71],a[48:51],v[224:227],v[68:71]
v_min3_u32 v27,v27,v224,v228
v_mul_f32 v95,v95,v75
v_mfma_f32_16x16x32_bf16 v[76:79],a[176:179],v[224:227],v[76:79]
ds_read_b128 v[252:255],v43 offset:62464
s_add_u32 s65,s89,768
v_mfma_f32_16x16x32_bf16 v[68:71],a[52:55],v[228:231],v[68:71]
v_rcp_f32 v91,v91
v_mfma_f32_16x16x32_bf16 v[76:79],a[180:183],v[228:231],v[76:79]
v_mul_f32 v88,v88,v64
s_waitcnt lgkmcnt(4)
v_mfma_f32_16x16x32_bf16 v[68:71],a[56:59],v[232:235],v[68:71]
v_min3_u32 v27,v27,v232,v236
s_waitcnt vmcnt(8)
v_mfma_f32_16x16x32_bf16 v[76:79],a[184:187],v[232:235],v[76:79]
v_cmp_gt_u32 vcc,s96,v2
s_mov_b32 s96,vcc_lo
v_mfma_f32_16x16x32_bf16 v[68:71],a[60:63],v[236:239],v[68:71]
v_mov_b32 v44,s96
ds_write_b32 v46,v44
v_mfma_f32_16x16x32_bf16 v[76:79],a[188:191],v[236:239],v[76:79]
v_mul_f32 v89,v89,v65
s_waitcnt lgkmcnt(3)
v_mfma_f32_16x16x32_bf16 v[68:71],a[112:115],v[240:243],v[68:71]
v_min3_u32 v27,v27,v240,v244
v_mul_f32 v90,v90,v66
v_mfma_f32_16x16x32_bf16 v[76:79],a[240:243],v[240:243],v[76:79]
v_mul_f32 v91,v91,v67
v_cvt_pk_bf16_f32 v96,v88,v89
v_mfma_f32_16x16x32_bf16 v[68:71],a[116:119],v[244:247],v[68:71]
v_cvt_pk_bf16_f32 v97,v90,v91
v_cvt_pk_bf16_f32 v98,v92,v93
v_mfma_f32_16x16x32_bf16 v[76:79],a[244:247],v[244:247],v[76:79]
v_cvt_pk_bf16_f32 v99,v94,v95
s_waitcnt lgkmcnt(1)
v_mfma_f32_16x16x32_bf16 v[68:71],a[120:123],v[248:251],v[68:71]
v_min3_u32 v27,v27,v248,v252
v_max_u32 v96,1,v96
v_mfma_f32_16x16x32_bf16 v[76:79],a[248:251],v[248:251],v[76:79]
buffer_store_dwordx4 v[96:99],v18,s[20:23],s78 offen sc1
v_mfma_f32_16x16x32_bf16 v[68:71],a[124:127],v[252:255],v[68:71]
buffer_load_dwordx4 v42,s[20:23],s65 offen offset:0 sc1 lds
v_mfma_f32_16x16x32_bf16 v[76:79],a[252:255],v[252:255],v[76:79]
buffer_load_dwordx4 v42,s[20:23],s65 offen offset:1024 sc1 lds
v_cmp_eq_u32 vcc,0,v27
s_cbranch_vccnz retry_193
s_branch epi_196
ahead_195:
s_waitcnt vmcnt(4) lgkmcnt(0)
s_barrier
ds_read_b32 v44,v45
ds_read_b128 v[224:227],v17 offset:0
ds_read_b128 v[228:231],v43 offset:0
ds_read_b128 v[232:235],v17 offset:8192
ds_read_b128 v[236:239],v43 offset:8192
ds_read_b128 v[240:243],v17 offset:1024
ds_read_b128 v[244:247],v43 offset:1024
ds_read_b128 v[248:251],v17 offset:9216
s_waitcnt lgkmcnt(5)
v_mfma_f32_16x16x32_bf16 v[64:67],a[0:3],v[224:227],0
s_add_u32 s88,s70,s75
s_add_u32 s88,s88,2097152
v_mfma_f32_16x16x32_bf16 v[72:75],a[128:131],v[224:227],0
ds_read_b128 v[252:255],v43 offset:9216
s_xor_b32 s88,s88,0x2000
v_mfma_f32_16x16x32_bf16 v[64:67],a[4:7],v[228:231],v[64:67]
v_readfirstlane_b32 s83,v44
v_mfma_f32_16x16x32_bf16 v[72:75],a[132:135],v[228:231],v[72:75]
ds_read_b128 v[224:227],v17 offset:16384
s_waitcnt lgkmcnt(5)
v_mfma_f32_16x16x32_bf16 v[64:67],a[8:11],v[232:235],v[64:67]
s_cmp_eq_u32 s83,0
s_cselect_b32 s88,s88,0x7fff0000
v_mfma_f32_16x16x32_bf16 v[72:75],a[136:139],v[232:235],v[72:75]
ds_read_b128 v[228:231],v43 offset:16384
s_add_u32 s89,s88,65536
v_mfma_f32_16x16x32_bf16 v[64:67],a[12:15],v[236:239],v[64:67]
s_xor_b32 m0,s72,0
v_mfma_f32_16x16x32_bf16 v[72:75],a[140:143],v[236:239],v[72:75]
ds_read_b128 v[232:235],v17 offset:24576
s_waitcnt lgkmcnt(5)
v_mfma_f32_16x16x32_bf16 v[64:67],a[64:67],v[240:243],v[64:67]
s_add_u32 s65,s88,0
v_mfma_f32_16x16x32_bf16 v[72:75],a[192:195],v[240:243],v[72:75]
ds_read_b128 v[236:239],v43 offset:24576
v_mfma_f32_16x16x32_bf16 v[64:67],a[68:71],v[244:247],v[64:67]
buffer_load_dwordx4 v42,s[20:23],s65 offen offset:0 sc1 lds
v_mfma_f32_16x16x32_bf16 v[72:75],a[196:199],v[244:247],v[72:75]
ds_read_b128 v[240:243],v17 offset:17408
s_waitcnt lgkmcnt(5)
v_mfma_f32_16x16x32_bf16 v[64:67],a[72:75],v[248:251],v[64:67]
buffer_load_dwordx4 v42,s[20:23],s65 offen offset:1024 sc1 lds
v_mfma_f32_16x16x32_bf16 v[72:75],a[200:203],v[248:251],v[72:75]
ds_read_b128 v[244:247],v43 offset:17408
s_xor_b32 m0,s72,16384
v_mfma_f32_16x16x32_bf16 v[64:67],a[76:79],v[252:255],v[64:67]
s_add_u32 s65,s88,256
v_mfma_f32_16x16x32_bf16 v[72:75],a[204:207],v[252:255],v[72:75]
ds_read_b128 v[248:251],v17 offset:25600
s_waitcnt lgkmcnt(5)
v_mfma_f32_16x16x32_bf16 v[64:67],a[16:19],v[224:227],v[64:67]
buffer_load_dwordx4 v42,s[20:23],s65 offen offset:0 sc1 lds
v_mfma_f32_16x16x32_bf16 v[72:75],a[144:147],v[224:227],v[72:75]
ds_read_b128 v[252:255],v43 offset:25600
v_mfma_f32_16x16x32_bf16 v[64:67],a[20:23],v[228:231],v[64:67]
buffer_load_dwordx4 v42,s[20:23],s65 offen offset:1024 sc1 lds
v_mfma_f32_16x16x32_bf16 v[72:75],a[148:151],v[228:231],v[72:75]
ds_read_b128 v[224:227],v17 offset:32768
s_waitcnt lgkmcnt(5)
v_mfma_f32_16x16x32_bf16 v[64:67],a[24:27],v[232:235],v[64:67]
s_xor_b32 m0,s72,32768
v_mfma_f32_16x16x32_bf16 v[72:75],a[152:155],v[232:235],v[72:75]
ds_read_b128 v[228:231],v43 offset:32768
s_add_u32 s65,s88,512
v_mfma_f32_16x16x32_bf16 v[64:67],a[28:31],v[236:239],v[64:67]
v_mfma_f32_16x16x32_bf16 v[72:75],a[156:159],v[236:239],v[72:75]
ds_read_b128 v[232:235],v17 offset:40960
s_waitcnt lgkmcnt(5)
v_mfma_f32_16x16x32_bf16 v[64:67],a[80:83],v[240:243],v[64:67]
buffer_load_dwordx4 v42,s[20:23],s65 offen offset:0 sc1 lds
v_mfma_f32_16x16x32_bf16 v[72:75],a[208:211],v[240:243],v[72:75]
ds_read_b128 v[236:239],v43 offset:40960
v_mfma_f32_16x16x32_bf16 v[64:67],a[84:87],v[244:247],v[64:67]
buffer_load_dwordx4 v42,s[20:23],s65 offen offset:1024 sc1 lds
v_mfma_f32_16x16x32_bf16 v[72:75],a[212:215],v[244:247],v[72:75]
ds_read_b128 v[240:243],v17 offset:33792
s_waitcnt lgkmcnt(5)
v_mfma_f32_16x16x32_bf16 v[64:67],a[88:91],v[248:251],v[64:67]
s_xor_b32 m0,s72,49152
s_add_u32 s65,s88,768
v_mfma_f32_16x16x32_bf16 v[72:75],a[216:219],v[248:251],v[72:75]
ds_read_b128 v[244:247],v43 offset:33792
v_mfma_f32_16x16x32_bf16 v[64:67],a[92:95],v[252:255],v[64:67]
buffer_load_dwordx4 v42,s[20:23],s65 offen offset:0 sc1 lds
v_mfma_f32_16x16x32_bf16 v[72:75],a[220:223],v[252:255],v[72:75]
ds_read_b128 v[248:251],v17 offset:41984
s_waitcnt lgkmcnt(5)
v_mfma_f32_16x16x32_bf16 v[64:67],a[32:35],v[224:227],v[64:67]
buffer_load_dwordx4 v42,s[20:23],s65 offen offset:1024 sc1 lds
v_mfma_f32_16x16x32_bf16 v[72:75],a[160:163],v[224:227],v[72:75]
ds_read_b128 v[252:255],v43 offset:41984
v_mfma_f32_16x16x32_bf16 v[64:67],a[36:39],v[228:231],v[64:67]
s_xor_b32 m0,s72,4096
v_mfma_f32_16x16x32_bf16 v[72:75],a[164:167],v[228:231],v[72:75]
ds_read_b128 v[224:227],v17 offset:49152
s_waitcnt lgkmcnt(5)
v_mfma_f32_16x16x32_bf16 v[64:67],a[40:43],v[232:235],v[64:67]
s_add_u32 s65,s89,0
v_mfma_f32_16x16x32_bf16 v[72:75],a[168:171],v[232:235],v[72:75]
ds_read_b128 v[228:231],v43 offset:49152
v_mfma_f32_16x16x32_bf16 v[64:67],a[44:47],v[236:239],v[64:67]
buffer_load_dwordx4 v42,s[20:23],s65 offen offset:0 sc1 lds
v_mfma_f32_16x16x32_bf16 v[72:75],a[172:175],v[236:239],v[72:75]
ds_read_b128 v[232:235],v17 offset:57344
s_waitcnt lgkmcnt(5)
v_mfma_f32_16x16x32_bf16 v[64:67],a[96:99],v[240:243],v[64:67]
buffer_load_dwordx4 v42,s[20:23],s65 offen offset:1024 sc1 lds
v_mfma_f32_16x16x32_bf16 v[72:75],a[224:227],v[240:243],v[72:75]
ds_read_b128 v[236:239],v43 offset:57344
s_xor_b32 m0,s72,20480
v_mfma_f32_16x16x32_bf16 v[64:67],a[100:103],v[244:247],v[64:67]
s_add_u32 s65,s89,256
v_mfma_f32_16x16x32_bf16 v[72:75],a[228:231],v[244:247],v[72:75]
ds_read_b128 v[240:243],v17 offset:50176
s_waitcnt lgkmcnt(5)
v_mfma_f32_16x16x32_bf16 v[64:67],a[104:107],v[248:251],v[64:67]
buffer_load_dwordx4 v42,s[20:23],s65 offen offset:0 sc1 lds
v_mfma_f32_16x16x32_bf16 v[72:75],a[232:235],v[248:251],v[72:75]
ds_read_b128 v[244:247],v43 offset:50176
v_mfma_f32_16x16x32_bf16 v[64:67],a[108:111],v[252:255],v[64:67]
buffer_load_dwordx4 v42,s[20:23],s65 offen offset:1024 sc1 lds
v_mfma_f32_16x16x32_bf16 v[72:75],a[236:239],v[252:255],v[72:75]
ds_read_b128 v[248:251],v17 offset:58368
s_waitcnt lgkmcnt(5)
v_mfma_f32_16x16x32_bf16 v[64:67],a[48:51],v[224:227],v[64:67]
s_xor_b32 m0,s72,36864
v_mfma_f32_16x16x32_bf16 v[72:75],a[176:179],v[224:227],v[72:75]
ds_read_b128 v[252:255],v43 offset:58368
s_add_u32 s65,s89,512
v_mfma_f32_16x16x32_bf16 v[64:67],a[52:55],v[228:231],v[64:67]
s_waitcnt vmcnt(12)
v_add_u32 v22,s71,-1
v_mfma_f32_16x16x32_bf16 v[72:75],a[180:183],v[228:231],v[72:75]
ds_read_b128 v[224:227],v17 offset:4096
s_waitcnt lgkmcnt(5)
v_mfma_f32_16x16x32_bf16 v[64:67],a[56:59],v[232:235],v[64:67]
buffer_store_dword v22,v23,s[24:27],s73 offen
v_mfma_f32_16x16x32_bf16 v[72:75],a[184:187],v[232:235],v[72:75]
ds_read_b128 v[228:231],v43 offset:4096
s_add_u32 s92,s78,8388608
v_mfma_f32_16x16x32_bf16 v[64:67],a[60:63],v[236:239],v[64:67]
buffer_store_dword v22,v23,s[28:31],s73 offen sc1
v_mfma_f32_16x16x32_bf16 v[72:75],a[188:191],v[236:239],v[72:75]
ds_read_b128 v[232:235],v17 offset:12288
s_waitcnt lgkmcnt(5)
v_mfma_f32_16x16x32_bf16 v[64:67],a[112:115],v[240:243],v[64:67]
s_sub_u32 s93,s71,53
v_mfma_f32_16x16x32_bf16 v[72:75],a[240:243],v[240:243],v[72:75]
ds_read_b128 v[236:239],v43 offset:12288
v_mfma_f32_16x16x32_bf16 v[64:67],a[116:119],v[244:247],v[64:67]
s_cmp_lt_u32 s93,8
s_cselect_b32 s92,s92,0x7fff0000
v_mfma_f32_16x16x32_bf16 v[72:75],a[244:247],v[244:247],v[72:75]
ds_read_b128 v[240:243],v17 offset:5120
s_waitcnt lgkmcnt(5)
v_mfma_f32_16x16x32_bf16 v[64:67],a[120:123],v[248:251],v[64:67]
buffer_load_dwordx4 v42,s[20:23],s65 offen offset:0 sc1 lds
v_mfma_f32_16x16x32_bf16 v[72:75],a[248:251],v[248:251],v[72:75]
ds_read_b128 v[244:247],v43 offset:5120
v_mfma_f32_16x16x32_bf16 v[64:67],a[124:127],v[252:255],v[64:67]
buffer_load_dword v2,v21,s[20:23],s87 offen sc1
v_mfma_f32_16x16x32_bf16 v[72:75],a[252:255],v[252:255],v[72:75]
ds_read_b128 v[248:251],v17 offset:13312
s_waitcnt lgkmcnt(5)
v_mfma_f32_16x16x32_bf16 v[68:71],a[0:3],v[224:227],0
s_add_u32 s96,s71,2
v_mfma_f32_16x16x32_bf16 v[76:79],a[128:131],v[224:227],0
ds_read_b128 v[252:255],v43 offset:13312
v_mfma_f32_16x16x32_bf16 v[68:71],a[4:7],v[228:231],v[68:71]
s_cmp_gt_u32 s96,56
s_addc_u32 s96,s96,0
v_mfma_f32_16x16x32_bf16 v[76:79],a[132:135],v[228:231],v[76:79]
ds_read_b128 v[224:227],v17 offset:20480
s_waitcnt lgkmcnt(5)
v_mfma_f32_16x16x32_bf16 v[68:71],a[8:11],v[232:235],v[68:71]
v_mul_f32 v88,v64,v64
v_mul_f32 v89,v65,v65
v_mul_f32 v92,v72,v72
v_mfma_f32_16x16x32_bf16 v[76:79],a[136:139],v[232:235],v[76:79]
ds_read_b128 v[228:231],v43 offset:20480
v_mul_f32 v90,v66,v66
v_mul_f32 v93,v73,v73
v_mfma_f32_16x16x32_bf16 v[68:71],a[12:15],v[236:239],v[68:71]
buffer_store_dwordx4 v[48:51],v18,s[20:23],s92 offen sc1
v_mul_f32 v94,v74,v74
v_mfma_f32_16x16x32_bf16 v[76:79],a[140:143],v[236:239],v[76:79]
ds_read_b128 v[232:235],v17 offset:28672
v_mul_f32 v95,v75,v75
s_waitcnt lgkmcnt(5)
v_mfma_f32_16x16x32_bf16 v[68:71],a[64:67],v[240:243],v[68:71]
buffer_store_dwordx4 v[48:51],v19,s[20:23],s92 offen sc1
v_fma_f32 v92,v92,s81,v28
v_mfma_f32_16x16x32_bf16 v[76:79],a[192:195],v[240:243],v[76:79]
ds_read_b128 v[236:239],v43 offset:28672
v_mul_f32 v91,v67,v67
v_fma_f32 v93,v93,s81,v28
v_mfma_f32_16x16x32_bf16 v[68:71],a[68:71],v[244:247],v[68:71]
v_fma_f32 v88,v88,s81,v28
v_fma_f32 v89,v89,s81,v28
v_fma_f32 v94,v94,s81,v28
v_mfma_f32_16x16x32_bf16 v[76:79],a[196:199],v[244:247],v[76:79]
ds_read_b128 v[240:243],v17 offset:21504
v_fma_f32 v95,v95,s81,v28
s_waitcnt lgkmcnt(5)
v_mfma_f32_16x16x32_bf16 v[68:71],a[72:75],v[248:251],v[68:71]
v_fma_f32 v90,v90,s81,v28
v_fma_f32 v91,v91,s81,v28
v_mul_f32 v92,v92,v72
v_mfma_f32_16x16x32_bf16 v[76:79],a[200:203],v[248:251],v[76:79]
ds_read_b128 v[244:247],v43 offset:21504
v_mul_f32 v88,v88,v64
v_mul_f32 v93,v93,v73
v_mfma_f32_16x16x32_bf16 v[68:71],a[76:79],v[252:255],v[68:71]
v_mul_f32 v89,v89,v65
v_mul_f32 v90,v90,v66
v_mul_f32 v94,v94,v74
v_mfma_f32_16x16x32_bf16 v[76:79],a[204:207],v[252:255],v[76:79]
ds_read_b128 v[248:251],v17 offset:29696
v_mul_f32 v95,v95,v75
s_waitcnt lgkmcnt(5)
v_mfma_f32_16x16x32_bf16 v[68:71],a[16:19],v[224:227],v[68:71]
v_mul_f32 v91,v91,v67
v_exp_f32 v92,v92
v_mfma_f32_16x16x32_bf16 v[76:79],a[144:147],v[224:227],v[76:79]
ds_read_b128 v[252:255],v43 offset:29696
v_exp_f32 v93,v93
v_mfma_f32_16x16x32_bf16 v[68:71],a[20:23],v[228:231],v[68:71]
v_exp_f32 v88,v88
v_mfma_f32_16x16x32_bf16 v[76:79],a[148:151],v[228:231],v[76:79]
ds_read_b128 v[224:227],v17 offset:36864
s_waitcnt lgkmcnt(5)
v_mfma_f32_16x16x32_bf16 v[68:71],a[24:27],v[232:235],v[68:71]
v_exp_f32 v89,v89
v_mfma_f32_16x16x32_bf16 v[76:79],a[152:155],v[232:235],v[76:79]
ds_read_b128 v[228:231],v43 offset:36864
v_exp_f32 v94,v94
v_mfma_f32_16x16x32_bf16 v[68:71],a[28:31],v[236:239],v[68:71]
v_exp_f32 v90,v90
v_mfma_f32_16x16x32_bf16 v[76:79],a[156:159],v[236:239],v[76:79]
ds_read_b128 v[232:235],v17 offset:45056
s_waitcnt lgkmcnt(5)
v_mfma_f32_16x16x32_bf16 v[68:71],a[80:83],v[240:243],v[68:71]
v_exp_f32 v91,v91
v_mfma_f32_16x16x32_bf16 v[76:79],a[208:211],v[240:243],v[76:79]
ds_read_b128 v[236:239],v43 offset:45056
v_add_f32 v88,1.0,v88
v_mfma_f32_16x16x32_bf16 v[68:71],a[84:87],v[244:247],v[68:71]
v_add_f32 v89,1.0,v89
v_add_f32 v90,1.0,v90
v_mfma_f32_16x16x32_bf16 v[76:79],a[212:215],v[244:247],v[76:79]
ds_read_b128 v[240:243],v17 offset:37888
s_waitcnt lgkmcnt(5)
v_mfma_f32_16x16x32_bf16 v[68:71],a[88:91],v[248:251],v[68:71]
v_add_f32 v91,1.0,v91
v_exp_f32 v95,v95
v_mfma_f32_16x16x32_bf16 v[76:79],a[216:219],v[248:251],v[76:79]
ds_read_b128 v[244:247],v43 offset:37888
v_add_f32 v92,1.0,v92
v_mfma_f32_16x16x32_bf16 v[68:71],a[92:95],v[252:255],v[68:71]
v_rcp_f32 v88,v88
v_mfma_f32_16x16x32_bf16 v[76:79],a[220:223],v[252:255],v[76:79]
ds_read_b128 v[248:251],v17 offset:46080
s_waitcnt lgkmcnt(5)
v_mfma_f32_16x16x32_bf16 v[68:71],a[32:35],v[224:227],v[68:71]
v_rcp_f32 v89,v89
v_mfma_f32_16x16x32_bf16 v[76:79],a[160:163],v[224:227],v[76:79]
ds_read_b128 v[252:255],v43 offset:46080
v_add_f32 v93,1.0,v93
v_mfma_f32_16x16x32_bf16 v[68:71],a[36:39],v[228:231],v[68:71]
v_rcp_f32 v90,v90
v_mfma_f32_16x16x32_bf16 v[76:79],a[164:167],v[228:231],v[76:79]
ds_read_b128 v[224:227],v17 offset:53248
s_waitcnt lgkmcnt(5)
v_mfma_f32_16x16x32_bf16 v[68:71],a[40:43],v[232:235],v[68:71]
v_rcp_f32 v91,v91
v_mfma_f32_16x16x32_bf16 v[76:79],a[168:171],v[232:235],v[76:79]
ds_read_b128 v[228:231],v43 offset:53248
v_mul_f32 v88,v88,v64
v_mfma_f32_16x16x32_bf16 v[68:71],a[44:47],v[236:239],v[68:71]
v_mul_f32 v89,v89,v65
v_mul_f32 v90,v90,v66
v_mfma_f32_16x16x32_bf16 v[76:79],a[172:175],v[236:239],v[76:79]
ds_read_b128 v[232:235],v17 offset:61440
s_waitcnt lgkmcnt(5)
v_mfma_f32_16x16x32_bf16 v[68:71],a[96:99],v[240:243],v[68:71]
v_mul_f32 v91,v91,v67
v_add_f32 v94,1.0,v94
v_mfma_f32_16x16x32_bf16 v[76:79],a[224:227],v[240:243],v[76:79]
ds_read_b128 v[236:239],v43 offset:61440
v_add_f32 v95,1.0,v95
v_mfma_f32_16x16x32_bf16 v[68:71],a[100:103],v[244:247],v[68:71]
v_rcp_f32 v92,v92
v_mfma_f32_16x16x32_bf16 v[76:79],a[228:231],v[244:247],v[76:79]
ds_read_b128 v[240:243],v17 offset:54272
s_waitcnt lgkmcnt(5)
v_mfma_f32_16x16x32_bf16 v[68:71],a[104:107],v[248:251],v[68:71]
v_rcp_f32 v93,v93
v_mfma_f32_16x16x32_bf16 v[76:79],a[232:235],v[248:251],v[76:79]
ds_read_b128 v[244:247],v43 offset:54272
v_mfma_f32_16x16x32_bf16 v[68:71],a[108:111],v[252:255],v[68:71]
v_rcp_f32 v94,v94
v_mfma_f32_16x16x32_bf16 v[76:79],a[236:239],v[252:255],v[76:79]
ds_read_b128 v[248:251],v17 offset:62464
s_waitcnt lgkmcnt(5)
v_mfma_f32_16x16x32_bf16 v[68:71],a[48:51],v[224:227],v[68:71]
v_rcp_f32 v95,v95
v_mfma_f32_16x16x32_bf16 v[76:79],a[176:179],v[224:227],v[76:79]
ds_read_b128 v[252:255],v43 offset:62464
v_mul_f32 v92,v92,v72
v_mfma_f32_16x16x32_bf16 v[68:71],a[52:55],v[228:231],v[68:71]
v_mul_f32 v93,v93,v73
v_mul_f32 v94,v94,v74
v_mfma_f32_16x16x32_bf16 v[76:79],a[180:183],v[228:231],v[76:79]
v_mul_f32 v95,v95,v75
s_waitcnt lgkmcnt(4)
v_mfma_f32_16x16x32_bf16 v[68:71],a[56:59],v[232:235],v[68:71]
s_waitcnt vmcnt(2)
v_cvt_pk_bf16_f32 v96,v88,v89
v_mfma_f32_16x16x32_bf16 v[76:79],a[184:187],v[232:235],v[76:79]
v_cmp_gt_u32 vcc,s96,v2
s_mov_b32 s96,vcc_lo
v_mfma_f32_16x16x32_bf16 v[68:71],a[60:63],v[236:239],v[68:71]
v_mov_b32 v44,s96
ds_write_b32 v46,v44
v_mfma_f32_16x16x32_bf16 v[76:79],a[188:191],v[236:239],v[76:79]
v_cvt_pk_bf16_f32 v97,v90,v91
s_waitcnt lgkmcnt(3)
v_mfma_f32_16x16x32_bf16 v[68:71],a[112:115],v[240:243],v[68:71]
v_cvt_pk_bf16_f32 v98,v92,v93
v_cvt_pk_bf16_f32 v99,v94,v95
v_mfma_f32_16x16x32_bf16 v[76:79],a[240:243],v[240:243],v[76:79]
v_max_u32 v96,1,v96
v_mfma_f32_16x16x32_bf16 v[68:71],a[116:119],v[244:247],v[68:71]
buffer_store_dwordx4 v[96:99],v18,s[20:23],s78 offen sc1
v_mfma_f32_16x16x32_bf16 v[76:79],a[244:247],v[244:247],v[76:79]
s_waitcnt lgkmcnt(1)
v_mfma_f32_16x16x32_bf16 v[68:71],a[120:123],v[248:251],v[68:71]
buffer_load_dwordx4 v42,s[20:23],s65 offen offset:1024 sc1 lds
v_mfma_f32_16x16x32_bf16 v[76:79],a[248:251],v[248:251],v[76:79]
s_xor_b32 m0,s72,53248
s_add_u32 s65,s89,768
v_mfma_f32_16x16x32_bf16 v[68:71],a[124:127],v[252:255],v[68:71]
buffer_load_dwordx4 v42,s[20:23],s65 offen offset:0 sc1 lds
v_mfma_f32_16x16x32_bf16 v[76:79],a[252:255],v[252:255],v[76:79]
buffer_load_dwordx4 v42,s[20:23],s65 offen offset:1024 sc1 lds
epi_196:
buffer_load_dword v29,v21,s[20:23],s87 offen sc1
s_nop 3
v_pk_mul_f32 v[88:89],v[68:69],v[68:69]
v_pk_mul_f32 v[90:91],v[70:71],v[70:71]
v_pk_mul_f32 v[92:93],v[76:77],v[76:77]
v_pk_mul_f32 v[94:95],v[78:79],v[78:79]
v_pk_fma_f32 v[88:89],v[88:89],s[80:81],v[28:29] op_sel:[0,1,0] op_sel_hi:[1,1,0]
v_pk_fma_f32 v[90:91],v[90:91],s[80:81],v[28:29] op_sel:[0,1,0] op_sel_hi:[1,1,0]
v_pk_fma_f32 v[92:93],v[92:93],s[80:81],v[28:29] op_sel:[0,1,0] op_sel_hi:[1,1,0]
v_pk_fma_f32 v[94:95],v[94:95],s[80:81],v[28:29] op_sel:[0,1,0] op_sel_hi:[1,1,0]
v_pk_mul_f32 v[88:89],v[88:89],v[68:69]
v_pk_mul_f32 v[90:91],v[90:91],v[70:71]
v_pk_mul_f32 v[92:93],v[92:93],v[76:77]
v_pk_mul_f32 v[94:95],v[94:95],v[78:79]
v_exp_f32 v88,v88
v_exp_f32 v89,v89
v_exp_f32 v90,v90
v_exp_f32 v91,v91
v_exp_f32 v92,v92
v_exp_f32 v93,v93
v_exp_f32 v94,v94
v_exp_f32 v95,v95
v_pk_add_f32 v[88:89],v[88:89],1.0 op_sel_hi:[1,0]
v_pk_add_f32 v[90:91],v[90:91],1.0 op_sel_hi:[1,0]
v_pk_add_f32 v[92:93],v[92:93],1.0 op_sel_hi:[1,0]
v_pk_add_f32 v[94:95],v[94:95],1.0 op_sel_hi:[1,0]
v_rcp_f32 v88,v88
v_rcp_f32 v89,v89
v_rcp_f32 v90,v90
v_rcp_f32 v91,v91
v_rcp_f32 v92,v92
v_rcp_f32 v93,v93
v_rcp_f32 v94,v94
v_rcp_f32 v95,v95
v_pk_mul_f32 v[88:89],v[88:89],v[68:69]
v_pk_mul_f32 v[90:91],v[90:91],v[70:71]
v_pk_mul_f32 v[92:93],v[92:93],v[76:77]
v_pk_mul_f32 v[94:95],v[94:95],v[78:79]
v_cvt_pk_bf16_f32 v96,v88,v89
v_cvt_pk_bf16_f32 v97,v90,v91
v_cvt_pk_bf16_f32 v98,v92,v93
v_cvt_pk_bf16_f32 v99,v94,v95
v_max_u32 v96,1,v96
buffer_store_dwordx4 v[96:99],v19,s[20:23],s78 offen sc1
v_xor_b32 v18,0x2000,v18
v_xor_b32 v19,0x2000,v19
s_add_u32 s78,s78,2097152
s_cmp_gt_u32 s71,56
s_cselect_b32 s65,s73,0x7fff0000
v_mov_b32 v22,s71
buffer_store_dword v22,v23,s[24:27],s65 offen
buffer_store_dword v22,v23,s[28:31],s65 offen sc1
v_xor_b32 v43,0x10000,v43
v_xor_b32 v17,0x10000,v17
v_xor_b32 v45,16,v45
v_xor_b32 v46,16,v46
s_xor_b32 s72,s72,0x10000
s_add_u32 s70,s70,2097152
s_xor_b32 s70,s70,0x2000
s_add_u32 s71,s71,1
s_cmp_le_u32 s71,64
s_cbranch_scc1 seg_194
s_endpgm
retry_193:
s_sub_u32 s90,s90,64
s_cmp_lt_i32 s90,0
s_cbranch_scc1 giveup_170
s_mov_b32 s83,1
s_waitcnt vmcnt(0) lgkmcnt(0)
s_barrier
s_branch seg_194
r_w2_188:
s_load_dwordx2 s[4:5],s[0:1],72
s_and_b32 s41,s59,7
s_lshl_b32 s66,s41,8
s_lshl_b32 s67,s50,1
s_waitcnt lgkmcnt(0)
s_mov_b32 s32,s4
s_and_b32 s33,s5,0xffff
s_mov_b32 s34,0x200000
s_mov_b32 s35,0x20000
v_lshrrev_b32 v5,2,v3
v_lshl_add_u32 v5,v4,2,v5
v_and_b32 v6,3,v3
v_lshlrev_b32 v6,3,v6
v_lshl_add_u32 v6,v5,8,v6
v_and_b32 v5,7,v5
v_xor_b32 v5,s67,v5
v_lshl_add_u32 v12,v5,5,v6
v_xor_b32 v13,32,v12
v_and_b32 v5,15,v1
v_and_b32 v6,3,v4
v_lshlrev_b32 v6,1,v6
v_xor_b32 v5,v5,v6
v_mul_u32_u24 v6,2048,v4
v_xor_b32 v7,0,v5
v_lshl_add_u32 v8,v7,4,v6
v_xor_b32 v7,8,v5
v_lshl_add_u32 v9,v7,4,v6
s_mul_i32 s74,s50,131072
s_add_u32 s74,s74,s66
s_lshl_b32 s75,s50,14
s_mul_i32 s76,s50,65536
s_add_u32 s76,s76,s66
s_lshl_b32 s77,s50,13
s_add_u32 s64,s74,0
s_add_u32 m0,s75,0
s_nop 0
buffer_load_dwordx4 v8,s[32:35],s64 offen  lds
s_add_u32 s64,s74,8192
s_add_u32 m0,s75,1024
s_nop 0
buffer_load_dwordx4 v9,s[32:35],s64 offen  lds
s_add_u32 s64,s74,16384
s_add_u32 m0,s75,2048
s_nop 0
buffer_load_dwordx4 v8,s[32:35],s64 offen  lds
s_add_u32 s64,s74,24576
s_add_u32 m0,s75,3072
s_nop 0
buffer_load_dwordx4 v9,s[32:35],s64 offen  lds
s_add_u32 s64,s74,32768
s_add_u32 m0,s75,4096
s_nop 0
buffer_load_dwordx4 v8,s[32:35],s64 offen  lds
s_add_u32 s64,s74,40960
s_add_u32 m0,s75,5120
s_nop 0
buffer_load_dwordx4 v9,s[32:35],s64 offen  lds
s_add_u32 s64,s74,49152
s_add_u32 m0,s75,6144
s_nop 0
buffer_load_dwordx4 v8,s[32:35],s64 offen  lds
s_add_u32 s64,s74,57344
s_add_u32 m0,s75,7168
s_nop 0
buffer_load_dwordx4 v9,s[32:35],s64 offen  lds
s_add_u32 s64,s74,65536
s_add_u32 m0,s75,8192
s_nop 0
buffer_load_dwordx4 v8,s[32:35],s64 offen  lds
s_add_u32 s64,s74,73728
s_add_u32 m0,s75,9216
s_nop 0
buffer_load_dwordx4 v9,s[32:35],s64 offen  lds
s_add_u32 s64,s74,81920
s_add_u32 m0,s75,10240
s_nop 0
buffer_load_dwordx4 v8,s[32:35],s64 offen  lds
s_add_u32 s64,s74,90112
s_add_u32 m0,s75,11264
s_nop 0
buffer_load_dwordx4 v9,s[32:35],s64 offen  lds
s_add_u32 s64,s74,98304
s_add_u32 m0,s75,12288
s_nop 0
buffer_load_dwordx4 v8,s[32:35],s64 offen  lds
s_add_u32 s64,s74,106496
s_add_u32 m0,s75,13312
s_nop 0
buffer_load_dwordx4 v9,s[32:35],s64 offen  lds
s_add_u32 s64,s74,114688
s_add_u32 m0,s75,14336
s_nop 0
buffer_load_dwordx4 v8,s[32:35],s64 offen  lds
s_add_u32 s64,s74,122880
s_add_u32 m0,s75,15360
s_nop 0
buffer_load_dwordx4 v9,s[32:35],s64 offen  lds
s_add_u32 s64,s74,524288
s_add_u32 m0,s75,65536
s_nop 0
buffer_load_dwordx4 v8,s[32:35],s64 offen  lds
s_add_u32 s64,s74,532480
s_add_u32 m0,s75,66560
s_nop 0
buffer_load_dwordx4 v9,s[32:35],s64 offen  lds
s_add_u32 s64,s74,540672
s_add_u32 m0,s75,67584
s_nop 0
buffer_load_dwordx4 v8,s[32:35],s64 offen  lds
s_add_u32 s64,s74,548864
s_add_u32 m0,s75,68608
s_nop 0
buffer_load_dwordx4 v9,s[32:35],s64 offen  lds
s_add_u32 s64,s74,557056
s_add_u32 m0,s75,69632
s_nop 0
buffer_load_dwordx4 v8,s[32:35],s64 offen  lds
s_add_u32 s64,s74,565248
s_add_u32 m0,s75,70656
s_nop 0
buffer_load_dwordx4 v9,s[32:35],s64 offen  lds
s_add_u32 s64,s74,573440
s_add_u32 m0,s75,71680
s_nop 0
buffer_load_dwordx4 v8,s[32:35],s64 offen  lds
s_add_u32 s64,s74,581632
s_add_u32 m0,s75,72704
s_nop 0
buffer_load_dwordx4 v9,s[32:35],s64 offen  lds
s_add_u32 s64,s74,589824
s_add_u32 m0,s75,73728
s_nop 0
buffer_load_dwordx4 v8,s[32:35],s64 offen  lds
s_add_u32 s64,s74,598016
s_add_u32 m0,s75,74752
s_nop 0
buffer_load_dwordx4 v9,s[32:35],s64 offen  lds
s_add_u32 s64,s74,606208
s_add_u32 m0,s75,75776
s_nop 0
buffer_load_dwordx4 v8,s[32:35],s64 offen  lds
s_add_u32 s64,s74,614400
s_add_u32 m0,s75,76800
s_nop 0
buffer_load_dwordx4 v9,s[32:35],s64 offen  lds
s_add_u32 s64,s74,622592
s_add_u32 m0,s75,77824
s_nop 0
buffer_load_dwordx4 v8,s[32:35],s64 offen  lds
s_add_u32 s64,s74,630784
s_add_u32 m0,s75,78848
s_nop 0
buffer_load_dwordx4 v9,s[32:35],s64 offen  lds
s_add_u32 s64,s74,638976
s_add_u32 m0,s75,79872
s_nop 0
buffer_load_dwordx4 v8,s[32:35],s64 offen  lds
s_add_u32 s64,s74,647168
s_add_u32 m0,s75,80896
s_nop 0
buffer_load_dwordx4 v9,s[32:35],s64 offen  lds
s_waitcnt vmcnt(16)
s_barrier
ds_read_b64_tr_b16 a[0:1],v12 offset:0
ds_read_b64_tr_b16 a[128:129],v13 offset:0
ds_read_b64_tr_b16 a[2:3],v12 offset:4096
ds_read_b64_tr_b16 a[130:131],v13 offset:4096
ds_read_b64_tr_b16 a[4:5],v12 offset:8192
ds_read_b64_tr_b16 a[132:133],v13 offset:8192
ds_read_b64_tr_b16 a[6:7],v12 offset:12288
ds_read_b64_tr_b16 a[134:135],v13 offset:12288
s_waitcnt lgkmcnt(4)
ds_read_b64_tr_b16 a[8:9],v12 offset:16384
ds_read_b64_tr_b16 a[136:137],v13 offset:16384
ds_read_b64_tr_b16 a[10:11],v12 offset:20480
ds_read_b64_tr_b16 a[138:139],v13 offset:20480
ds_read_b64_tr_b16 a[12:13],v12 offset:24576
ds_read_b64_tr_b16 a[140:141],v13 offset:24576
ds_read_b64_tr_b16 a[14:15],v12 offset:28672
ds_read_b64_tr_b16 a[142:143],v13 offset:28672
s_waitcnt lgkmcnt(4)
ds_read_b64_tr_b16 a[16:17],v12 offset:32768
ds_read_b64_tr_b16 a[144:145],v13 offset:32768
ds_read_b64_tr_b16 a[18:19],v12 offset:36864
ds_read_b64_tr_b16 a[146:147],v13 offset:36864
ds_read_b64_tr_b16 a[20:21],v12 offset:40960
ds_read_b64_tr_b16 a[148:149],v13 offset:40960
ds_read_b64_tr_b16 a[22:23],v12 offset:45056
ds_read_b64_tr_b16 a[150:151],v13 offset:45056
s_waitcnt lgkmcnt(4)
ds_read_b64_tr_b16 a[24:25],v12 offset:49152
ds_read_b64_tr_b16 a[152:153],v13 offset:49152
ds_read_b64_tr_b16 a[26:27],v12 offset:53248
ds_read_b64_tr_b16 a[154:155],v13 offset:53248
ds_read_b64_tr_b16 a[28:29],v12 offset:57344
ds_read_b64_tr_b16 a[156:157],v13 offset:57344
ds_read_b64_tr_b16 a[30:31],v12 offset:61440
ds_read_b64_tr_b16 a[158:159],v13 offset:61440
s_waitcnt lgkmcnt(4)
v_xor_b32 v12,0x10000,v12
v_xor_b32 v13,0x10000,v13
s_waitcnt lgkmcnt(0)
s_barrier
s_add_u32 s64,s74,1048576
s_add_u32 m0,s75,0
s_nop 0
buffer_load_dwordx4 v8,s[32:35],s64 offen  lds
s_add_u32 s64,s74,1056768
s_add_u32 m0,s75,1024
s_nop 0
buffer_load_dwordx4 v9,s[32:35],s64 offen  lds
s_add_u32 s64,s74,1064960
s_add_u32 m0,s75,2048
s_nop 0
buffer_load_dwordx4 v8,s[32:35],s64 offen  lds
s_add_u32 s64,s74,1073152
s_add_u32 m0,s75,3072
s_nop 0
buffer_load_dwordx4 v9,s[32:35],s64 offen  lds
s_add_u32 s64,s74,1081344
s_add_u32 m0,s75,4096
s_nop 0
buffer_load_dwordx4 v8,s[32:35],s64 offen  lds
s_add_u32 s64,s74,1089536
s_add_u32 m0,s75,5120
s_nop 0
buffer_load_dwordx4 v9,s[32:35],s64 offen  lds
s_add_u32 s64,s74,1097728
s_add_u32 m0,s75,6144
s_nop 0
buffer_load_dwordx4 v8,s[32:35],s64 offen  lds
s_add_u32 s64,s74,1105920
s_add_u32 m0,s75,7168
s_nop 0
buffer_load_dwordx4 v9,s[32:35],s64 offen  lds
s_add_u32 s64,s74,1114112
s_add_u32 m0,s75,8192
s_nop 0
buffer_load_dwordx4 v8,s[32:35],s64 offen  lds
s_add_u32 s64,s74,1122304
s_add_u32 m0,s75,9216
s_nop 0
buffer_load_dwordx4 v9,s[32:35],s64 offen  lds
s_add_u32 s64,s74,1130496
s_add_u32 m0,s75,10240
s_nop 0
buffer_load_dwordx4 v8,s[32:35],s64 offen  lds
s_add_u32 s64,s74,1138688
s_add_u32 m0,s75,11264
s_nop 0
buffer_load_dwordx4 v9,s[32:35],s64 offen  lds
s_add_u32 s64,s74,1146880
s_add_u32 m0,s75,12288
s_nop 0
buffer_load_dwordx4 v8,s[32:35],s64 offen  lds
s_add_u32 s64,s74,1155072
s_add_u32 m0,s75,13312
s_nop 0
buffer_load_dwordx4 v9,s[32:35],s64 offen  lds
s_add_u32 s64,s74,1163264
s_add_u32 m0,s75,14336
s_nop 0
buffer_load_dwordx4 v8,s[32:35],s64 offen  lds
s_add_u32 s64,s74,1171456
s_add_u32 m0,s75,15360
s_nop 0
buffer_load_dwordx4 v9,s[32:35],s64 offen  lds
s_waitcnt vmcnt(16)
s_barrier
ds_read_b64_tr_b16 a[32:33],v12 offset:0
ds_read_b64_tr_b16 a[160:161],v13 offset:0
ds_read_b64_tr_b16 a[34:35],v12 offset:4096
ds_read_b64_tr_b16 a[162:163],v13 offset:4096
ds_read_b64_tr_b16 a[36:37],v12 offset:8192
ds_read_b64_tr_b16 a[164:165],v13 offset:8192
ds_read_b64_tr_b16 a[38:39],v12 offset:12288
ds_read_b64_tr_b16 a[166:167],v13 offset:12288
s_waitcnt lgkmcnt(4)
ds_read_b64_tr_b16 a[40:41],v12 offset:16384
ds_read_b64_tr_b16 a[168:169],v13 offset:16384
ds_read_b64_tr_b16 a[42:43],v12 offset:20480
ds_read_b64_tr_b16 a[170:171],v13 offset:20480
ds_read_b64_tr_b16 a[44:45],v12 offset:24576
ds_read_b64_tr_b16 a[172:173],v13 offset:24576
ds_read_b64_tr_b16 a[46:47],v12 offset:28672
ds_read_b64_tr_b16 a[174:175],v13 offset:28672
s_waitcnt lgkmcnt(4)
ds_read_b64_tr_b16 a[48:49],v12 offset:32768
ds_read_b64_tr_b16 a[176:177],v13 offset:32768
ds_read_b64_tr_b16 a[50:51],v12 offset:36864
ds_read_b64_tr_b16 a[178:179],v13 offset:36864
ds_read_b64_tr_b16 a[52:53],v12 offset:40960
ds_read_b64_tr_b16 a[180:181],v13 offset:40960
ds_read_b64_tr_b16 a[54:55],v12 offset:45056
ds_read_b64_tr_b16 a[182:183],v13 offset:45056
s_waitcnt lgkmcnt(4)
ds_read_b64_tr_b16 a[56:57],v12 offset:49152
ds_read_b64_tr_b16 a[184:185],v13 offset:49152
ds_read_b64_tr_b16 a[58:59],v12 offset:53248
ds_read_b64_tr_b16 a[186:187],v13 offset:53248
ds_read_b64_tr_b16 a[60:61],v12 offset:57344
ds_read_b64_tr_b16 a[188:189],v13 offset:57344
ds_read_b64_tr_b16 a[62:63],v12 offset:61440
ds_read_b64_tr_b16 a[190:191],v13 offset:61440
s_waitcnt lgkmcnt(4)
v_xor_b32 v12,0x10000,v12
v_xor_b32 v13,0x10000,v13
s_waitcnt lgkmcnt(0)
s_barrier
s_add_u32 s64,s74,1572864
s_add_u32 m0,s75,65536
s_nop 0
buffer_load_dwordx4 v8,s[32:35],s64 offen  lds
s_add_u32 s64,s74,1581056
s_add_u32 m0,s75,66560
s_nop 0
buffer_load_dwordx4 v9,s[32:35],s64 offen  lds
s_add_u32 s64,s74,1589248
s_add_u32 m0,s75,67584
s_nop 0
buffer_load_dwordx4 v8,s[32:35],s64 offen  lds
s_add_u32 s64,s74,1597440
s_add_u32 m0,s75,68608
s_nop 0
buffer_load_dwordx4 v9,s[32:35],s64 offen  lds
s_add_u32 s64,s74,1605632
s_add_u32 m0,s75,69632
s_nop 0
buffer_load_dwordx4 v8,s[32:35],s64 offen  lds
s_add_u32 s64,s74,1613824
s_add_u32 m0,s75,70656
s_nop 0
buffer_load_dwordx4 v9,s[32:35],s64 offen  lds
s_add_u32 s64,s74,1622016
s_add_u32 m0,s75,71680
s_nop 0
buffer_load_dwordx4 v8,s[32:35],s64 offen  lds
s_add_u32 s64,s74,1630208
s_add_u32 m0,s75,72704
s_nop 0
buffer_load_dwordx4 v9,s[32:35],s64 offen  lds
s_add_u32 s64,s74,1638400
s_add_u32 m0,s75,73728
s_nop 0
buffer_load_dwordx4 v8,s[32:35],s64 offen  lds
s_add_u32 s64,s74,1646592
s_add_u32 m0,s75,74752
s_nop 0
buffer_load_dwordx4 v9,s[32:35],s64 offen  lds
s_add_u32 s64,s74,1654784
s_add_u32 m0,s75,75776
s_nop 0
buffer_load_dwordx4 v8,s[32:35],s64 offen  lds
s_add_u32 s64,s74,1662976
s_add_u32 m0,s75,76800
s_nop 0
buffer_load_dwordx4 v9,s[32:35],s64 offen  lds
s_add_u32 s64,s74,1671168
s_add_u32 m0,s75,77824
s_nop 0
buffer_load_dwordx4 v8,s[32:35],s64 offen  lds
s_add_u32 s64,s74,1679360
s_add_u32 m0,s75,78848
s_nop 0
buffer_load_dwordx4 v9,s[32:35],s64 offen  lds
s_add_u32 s64,s74,1687552
s_add_u32 m0,s75,79872
s_nop 0
buffer_load_dwordx4 v8,s[32:35],s64 offen  lds
s_add_u32 s64,s74,1695744
s_add_u32 m0,s75,80896
s_nop 0
buffer_load_dwordx4 v9,s[32:35],s64 offen  lds
s_waitcnt vmcnt(16)
s_barrier
ds_read_b64_tr_b16 a[64:65],v12 offset:0
ds_read_b64_tr_b16 a[192:193],v13 offset:0
ds_read_b64_tr_b16 a[66:67],v12 offset:4096
ds_read_b64_tr_b16 a[194:195],v13 offset:4096
ds_read_b64_tr_b16 a[68:69],v12 offset:8192
ds_read_b64_tr_b16 a[196:197],v13 offset:8192
ds_read_b64_tr_b16 a[70:71],v12 offset:12288
ds_read_b64_tr_b16 a[198:199],v13 offset:12288
s_waitcnt lgkmcnt(4)
ds_read_b64_tr_b16 a[72:73],v12 offset:16384
ds_read_b64_tr_b16 a[200:201],v13 offset:16384
ds_read_b64_tr_b16 a[74:75],v12 offset:20480
ds_read_b64_tr_b16 a[202:203],v13 offset:20480
ds_read_b64_tr_b16 a[76:77],v12 offset:24576
ds_read_b64_tr_b16 a[204:205],v13 offset:24576
ds_read_b64_tr_b16 a[78:79],v12 offset:28672
ds_read_b64_tr_b16 a[206:207],v13 offset:28672
s_waitcnt lgkmcnt(4)
ds_read_b64_tr_b16 a[80:81],v12 offset:32768
ds_read_b64_tr_b16 a[208:209],v13 offset:32768
ds_read_b64_tr_b16 a[82:83],v12 offset:36864
ds_read_b64_tr_b16 a[210:211],v13 offset:36864
ds_read_b64_tr_b16 a[84:85],v12 offset:40960
ds_read_b64_tr_b16 a[212:213],v13 offset:40960
ds_read_b64_tr_b16 a[86:87],v12 offset:45056
ds_read_b64_tr_b16 a[214:215],v13 offset:45056
s_waitcnt lgkmcnt(4)
ds_read_b64_tr_b16 a[88:89],v12 offset:49152
ds_read_b64_tr_b16 a[216:217],v13 offset:49152
ds_read_b64_tr_b16 a[90:91],v12 offset:53248
ds_read_b64_tr_b16 a[218:219],v13 offset:53248
ds_read_b64_tr_b16 a[92:93],v12 offset:57344
ds_read_b64_tr_b16 a[220:221],v13 offset:57344
ds_read_b64_tr_b16 a[94:95],v12 offset:61440
ds_read_b64_tr_b16 a[222:223],v13 offset:61440
s_waitcnt lgkmcnt(4)
v_xor_b32 v12,0x10000,v12
v_xor_b32 v13,0x10000,v13
s_waitcnt lgkmcnt(0)
s_barrier
s_waitcnt vmcnt(0)
s_barrier
ds_read_b64_tr_b16 a[96:97],v12 offset:0
ds_read_b64_tr_b16 a[224:225],v13 offset:0
ds_read_b64_tr_b16 a[98:99],v12 offset:4096
ds_read_b64_tr_b16 a[226:227],v13 offset:4096
ds_read_b64_tr_b16 a[100:101],v12 offset:8192
ds_read_b64_tr_b16 a[228:229],v13 offset:8192
ds_read_b64_tr_b16 a[102:103],v12 offset:12288
ds_read_b64_tr_b16 a[230:231],v13 offset:12288
s_waitcnt lgkmcnt(4)
ds_read_b64_tr_b16 a[104:105],v12 offset:16384
ds_read_b64_tr_b16 a[232:233],v13 offset:16384
ds_read_b64_tr_b16 a[106:107],v12 offset:20480
ds_read_b64_tr_b16 a[234:235],v13 offset:20480
ds_read_b64_tr_b16 a[108:109],v12 offset:24576
ds_read_b64_tr_b16 a[236:237],v13 offset:24576
ds_read_b64_tr_b16 a[110:111],v12 offset:28672
ds_read_b64_tr_b16 a[238:239],v13 offset:28672
s_waitcnt lgkmcnt(4)
ds_read_b64_tr_b16 a[112:113],v12 offset:32768
ds_read_b64_tr_b16 a[240:241],v13 offset:32768
ds_read_b64_tr_b16 a[114:115],v12 offset:36864
ds_read_b64_tr_b16 a[242:243],v13 offset:36864
ds_read_b64_tr_b16 a[116:117],v12 offset:40960
ds_read_b64_tr_b16 a[244:245],v13 offset:40960
ds_read_b64_tr_b16 a[118:119],v12 offset:45056
ds_read_b64_tr_b16 a[246:247],v13 offset:45056
s_waitcnt lgkmcnt(4)
ds_read_b64_tr_b16 a[120:121],v12 offset:49152
ds_read_b64_tr_b16 a[248:249],v13 offset:49152
ds_read_b64_tr_b16 a[122:123],v12 offset:53248
ds_read_b64_tr_b16 a[250:251],v13 offset:53248
ds_read_b64_tr_b16 a[124:125],v12 offset:57344
ds_read_b64_tr_b16 a[252:253],v13 offset:57344
ds_read_b64_tr_b16 a[126:127],v12 offset:61440
ds_read_b64_tr_b16 a[254:255],v13 offset:61440
s_waitcnt lgkmcnt(4)
v_xor_b32 v12,0x10000,v12
v_xor_b32 v13,0x10000,v13
s_waitcnt lgkmcnt(0)
s_barrier
v_and_b32 v21,1,v1
v_mul_u32_u24 v21,896,v21
s_mov_b32 s65,21052032
s_mov_b32 s66,1792
pl_203:
buffer_load_dword v22,v21,s[20:23],s65 offen sc1
s_waitcnt vmcnt(0)
v_cmp_gt_u32 vcc,s66,v22
s_cbranch_vccz pok_204
s_sleep 1
s_sub_u32 s90,s90,1
s_cmp_gt_i32 s90,0
s_cbranch_scc1 pl_203
pok_204:
s_mov_b32 s81,0xbdd2d3e8
v_mov_b32 v28,0xc0135761
v_mov_b32 v17,v16
v_and_b32 v21,31,v1
v_lshlrev_b32 v21,2,v21
s_add_u32 s74,s63,3072
s_lshl_b32 s42,s41,2
s_add_u32 s42,s42,s50
s_lshl_b32 s73,s42,2
s_add_u32 s73,s73,s63
s_add_u32 s73,s73,3584
s_lshl_b32 s43,s50,11
s_mov_b32 s78,27262976
s_mov_b32 s64,0
s_lshr_b32 s65,s50,1
s_and_b32 s66,s50,1
s_lshl_b32 s66,s66,12
s_add_u32 s66,s66,s64
s_lshl_b32 s72,s65,13
s_add_u32 s72,s72,s66
s_add_u32 s72,s72,0x10000
s_lshl_b32 s65,s65,14
s_add_u32 s75,s65,s66
s_add_u32 s75,s75,1966080
s_add_u32 s64,s41,72
s_lshl_b32 s64,s64,14
s_add_u32 s64,s64,s43
v_add_u32 v18,s64,v16
s_lshl_b32 s64,s42,8
s_add_u32 s64,s64,1310720
v_lshl_add_u32 v24,v3,4,s64
v_mov_b32 v5,0x40000000
v_cmp_gt_u32 vcc,16,v1
s_nop 1
v_cndmask_b32 v24,v5,v24,vcc
s_lshl_b32 s64,s42,6
v_and_b32 v5,3,v1
v_xor_b32 v5,v5,v4
v_lshl_add_u32 v5,v5,4,s64
v_lshrrev_b32 v11,2,v1
s_add_u32 s43,s43,133120
v_lshrrev_b32 v6,2,v3
v_lshrrev_b32 v7,1,v4
v_xor_b32 v6,v6,v7
v_lshlrev_b32 v6,4,v6
v_lshl_add_u32 v6,v3,6,v6
v_and_b32 v7,1,v4
v_lshl_add_u32 v6,v7,3,v6
v_add_u32 v40,s43,v6
v_xor_b32 v41,32,v40
v_add_u32 v6,30,v11
v_lshl_add_u32 v9,v6,7,v5
v_and_b32 v9,2047,v9
v_and_b32 v7,3,v6
v_lshl_add_u32 v7,v7,11,v9
v_bfe_u32 v8,v6,2,3
v_lshl_add_u32 v7,v8,14,v7
v_mov_b32 v8,0x2000
v_mov_b32 v9,2097152
v_cmp_gt_u32 vcc,32,v6
s_nop 1
v_cndmask_b32 v8,v9,v8,vcc
v_add_u32 v7,v7,v8
v_add_u32 v7,0,v7
v_xor_b32 v19,s62,v7
v_add_u32 v6,46,v11
v_lshl_add_u32 v9,v6,7,v5
v_and_b32 v9,2047,v9
v_and_b32 v7,3,v6
v_lshl_add_u32 v7,v7,11,v9
v_bfe_u32 v8,v6,2,3
v_lshl_add_u32 v7,v8,14,v7
v_mov_b32 v8,0x2000
v_mov_b32 v9,2097152
v_cmp_gt_u32 vcc,32,v6
s_nop 1
v_cndmask_b32 v8,v9,v8,vcc
v_add_u32 v7,v7,v8
v_add_u32 v7,0,v7
v_xor_b32 v20,s62,v7
s_add_u32 s64,s79,0
s_lshl_b32 s70,s64,21
s_lshl_b32 s64,s64,13
s_and_b32 s64,s64,0x2000
s_xor_b32 s64,s64,s62
s_add_u32 s70,s70,s64
s_add_u32 s70,s70,29360128
s_mov_b32 s83,1
s_mov_b32 s87,s74
s_cmp_eq_u32 s50,0
s_cselect_b32 s74,s74,0x7fff0000
v_mov_b32 v45,132096
s_lshl_b32 s64,s50,2
s_add_u32 s64,s64,132112
v_mov_b32 v46,s64
v_mov_b32 v2,0
v_mov_b32 v44,1
ds_write_b32 v45,v44
s_waitcnt lgkmcnt(0)
seg_206:
s_cmp_eq_u32 s83,0
s_cbranch_scc1 ahead_207
s_add_u32 s94,s70,s75
s_xor_b32 s95,s94,1024
s_xor_b32 s91,s72,0x10000
s_min_u32 s66,s71,64
s_waitcnt lgkmcnt(0)
v_cmp_gt_u32 vcc,s66,v2
s_cbranch_vccz nb_210
s_waitcnt vmcnt(3)
v_cmp_gt_u32 vcc,s66,v29
s_cbranch_vccz nb_210
s_waitcnt vmcnt(0)
v_add_u32 v22,s71,-1
buffer_store_dword v22,v23,s[20:23],s73 offen sc1
s_cmp_lg_u32 s50,0
s_cbranch_scc1 nb_210
buffer_load_dword v32,v21,s[20:23],s74 offen sc1
s_sleep 2
pl_211:
buffer_load_dword v33,v21,s[20:23],s74 offen sc1
s_waitcnt vmcnt(1)
v_cmp_gt_u32 vcc,s66,v32
s_cbranch_vccz pok_212
buffer_load_dword v32,v21,s[20:23],s74 offen sc1
s_waitcnt vmcnt(1)
v_cmp_gt_u32 vcc,s66,v33
s_cbranch_vccz pok_212
s_sub_u32 s90,s90,1
s_cmp_gt_i32 s90,0
s_cbranch_scc1 pl_211
pok_212:
nb_210:
s_barrier
s_xor_b32 m0,s91,0
s_add_u32 s65,s94,0
buffer_load_dwordx4 v16,s[20:23],s65 offen offset:0 sc1 lds
buffer_load_dwordx4 v16,s[20:23],s65 offen offset:2048 sc1 lds
ds_read_b32 v44,v45
s_xor_b32 m0,s91,16384
s_add_u32 s65,s94,32768
buffer_load_dwordx4 v16,s[20:23],s65 offen offset:0 sc1 lds
buffer_load_dwordx4 v16,s[20:23],s65 offen offset:2048 sc1 lds
s_xor_b32 m0,s91,32768
s_add_u32 s65,s94,65536
buffer_load_dwordx4 v16,s[20:23],s65 offen offset:0 sc1 lds
buffer_load_dwordx4 v16,s[20:23],s65 offen offset:2048 sc1 lds
s_xor_b32 m0,s91,49152
s_add_u32 s65,s94,98304
buffer_load_dwordx4 v16,s[20:23],s65 offen offset:0 sc1 lds
buffer_load_dwordx4 v16,s[20:23],s65 offen offset:2048 sc1 lds
s_xor_b32 m0,s91,1024
s_add_u32 s65,s95,0
buffer_load_dwordx4 v16,s[20:23],s65 offen offset:0 sc1 lds
buffer_load_dwordx4 v16,s[20:23],s65 offen offset:2048 sc1 lds
s_waitcnt lgkmcnt(0)
v_readfirstlane_b32 s83,v44
s_cmp_eq_u32 s83,0
s_cbranch_scc1 both_209
s_waitcnt vmcnt(8)
s_barrier
ds_read_b128 v[224:227],v17 offset:0
ds_read_b128 v[228:231],v17 offset:2048
ds_read_b128 v[232:235],v17 offset:4096
ds_read_b128 v[236:239],v17 offset:6144
ds_read_b128 v[240:243],v17 offset:8192
ds_read_b128 v[244:247],v17 offset:10240
ds_read_b128 v[248:251],v17 offset:12288
s_waitcnt lgkmcnt(5)
v_mfma_f32_16x16x32_bf16 v[64:67],a[0:3],v[224:227],0
v_min_u32 v27,v224,v228
s_xor_b32 m0,s91,17408
v_mfma_f32_16x16x32_bf16 v[72:75],a[128:131],v[224:227],0
ds_read_b128 v[252:255],v17 offset:14336
v_mfma_f32_16x16x32_bf16 v[64:67],a[4:7],v[228:231],v[64:67]
s_add_u32 s65,s95,32768
v_mfma_f32_16x16x32_bf16 v[72:75],a[132:135],v[228:231],v[72:75]
s_waitcnt vmcnt(6)
s_barrier
ds_read_b128 v[224:227],v17 offset:16384
s_waitcnt lgkmcnt(5)
v_mfma_f32_16x16x32_bf16 v[64:67],a[8:11],v[232:235],v[64:67]
v_min3_u32 v27,v27,v232,v236
buffer_load_dwordx4 v16,s[20:23],s65 offen offset:0 sc1 lds
v_mfma_f32_16x16x32_bf16 v[72:75],a[136:139],v[232:235],v[72:75]
ds_read_b128 v[228:231],v17 offset:18432
v_mfma_f32_16x16x32_bf16 v[64:67],a[12:15],v[236:239],v[64:67]
buffer_load_dwordx4 v16,s[20:23],s65 offen offset:2048 sc1 lds
v_mfma_f32_16x16x32_bf16 v[72:75],a[140:143],v[236:239],v[72:75]
ds_read_b128 v[232:235],v17 offset:20480
s_waitcnt lgkmcnt(5)
v_mfma_f32_16x16x32_bf16 v[64:67],a[16:19],v[240:243],v[64:67]
v_min3_u32 v27,v27,v240,v244
s_xor_b32 m0,s91,33792
v_mfma_f32_16x16x32_bf16 v[72:75],a[144:147],v[240:243],v[72:75]
ds_read_b128 v[236:239],v17 offset:22528
v_mfma_f32_16x16x32_bf16 v[64:67],a[20:23],v[244:247],v[64:67]
s_add_u32 s65,s95,65536
v_mfma_f32_16x16x32_bf16 v[72:75],a[148:151],v[244:247],v[72:75]
ds_read_b128 v[240:243],v17 offset:24576
s_waitcnt lgkmcnt(5)
v_mfma_f32_16x16x32_bf16 v[64:67],a[24:27],v[248:251],v[64:67]
v_min3_u32 v27,v27,v248,v252
buffer_load_dwordx4 v16,s[20:23],s65 offen offset:0 sc1 lds
v_mfma_f32_16x16x32_bf16 v[72:75],a[152:155],v[248:251],v[72:75]
ds_read_b128 v[244:247],v17 offset:26624
v_mfma_f32_16x16x32_bf16 v[64:67],a[28:31],v[252:255],v[64:67]
buffer_load_dwordx4 v16,s[20:23],s65 offen offset:2048 sc1 lds
v_mfma_f32_16x16x32_bf16 v[72:75],a[156:159],v[252:255],v[72:75]
ds_read_b128 v[248:251],v17 offset:28672
s_waitcnt lgkmcnt(5)
v_mfma_f32_16x16x32_bf16 v[64:67],a[32:35],v[224:227],v[64:67]
v_min3_u32 v27,v27,v224,v228
s_xor_b32 m0,s91,50176
v_mfma_f32_16x16x32_bf16 v[72:75],a[160:163],v[224:227],v[72:75]
ds_read_b128 v[252:255],v17 offset:30720
v_mfma_f32_16x16x32_bf16 v[64:67],a[36:39],v[228:231],v[64:67]
s_add_u32 s65,s95,98304
v_mfma_f32_16x16x32_bf16 v[72:75],a[164:167],v[228:231],v[72:75]
s_waitcnt vmcnt(6)
s_barrier
ds_read_b128 v[224:227],v17 offset:32768
s_waitcnt lgkmcnt(5)
v_mfma_f32_16x16x32_bf16 v[64:67],a[40:43],v[232:235],v[64:67]
v_min3_u32 v27,v27,v232,v236
buffer_load_dwordx4 v16,s[20:23],s65 offen offset:0 sc1 lds
v_mfma_f32_16x16x32_bf16 v[72:75],a[168:171],v[232:235],v[72:75]
ds_read_b128 v[228:231],v17 offset:34816
v_mfma_f32_16x16x32_bf16 v[64:67],a[44:47],v[236:239],v[64:67]
buffer_load_dwordx4 v16,s[20:23],s65 offen offset:2048 sc1 lds
v_mfma_f32_16x16x32_bf16 v[72:75],a[172:175],v[236:239],v[72:75]
ds_read_b128 v[232:235],v17 offset:36864
s_waitcnt lgkmcnt(5)
v_mfma_f32_16x16x32_bf16 v[64:67],a[48:51],v[240:243],v[64:67]
v_min3_u32 v27,v27,v240,v244
v_mfma_f32_16x16x32_bf16 v[72:75],a[176:179],v[240:243],v[72:75]
ds_read_b128 v[236:239],v17 offset:38912
v_mfma_f32_16x16x32_bf16 v[64:67],a[52:55],v[244:247],v[64:67]
v_add_u32 v22,s71,-1
s_add_u32 m0,s43,0
s_nop 0
buffer_load_dwordx4 v19,s[20:23],s78 offen sc1 lds
v_mfma_f32_16x16x32_bf16 v[72:75],a[180:183],v[244:247],v[72:75]
ds_read_b128 v[240:243],v17 offset:40960
s_add_u32 m0,s43,1024
s_waitcnt lgkmcnt(5)
v_mfma_f32_16x16x32_bf16 v[64:67],a[56:59],v[248:251],v[64:67]
v_min3_u32 v27,v27,v248,v252
buffer_load_dwordx4 v20,s[20:23],s78 offen sc1 lds
v_mfma_f32_16x16x32_bf16 v[72:75],a[184:187],v[248:251],v[72:75]
ds_read_b128 v[244:247],v17 offset:43008
v_mfma_f32_16x16x32_bf16 v[64:67],a[60:63],v[252:255],v[64:67]
buffer_store_dword v22,v23,s[20:23],s73 offen sc1
v_mfma_f32_16x16x32_bf16 v[72:75],a[188:191],v[252:255],v[72:75]
ds_read_b128 v[248:251],v17 offset:45056
s_waitcnt lgkmcnt(5)
v_mfma_f32_16x16x32_bf16 v[64:67],a[64:67],v[224:227],v[64:67]
v_min3_u32 v27,v27,v224,v228
v_mfma_f32_16x16x32_bf16 v[72:75],a[192:195],v[224:227],v[72:75]
ds_read_b128 v[252:255],v17 offset:47104
v_mfma_f32_16x16x32_bf16 v[64:67],a[68:71],v[228:231],v[64:67]
v_mfma_f32_16x16x32_bf16 v[72:75],a[196:199],v[228:231],v[72:75]
ds_read_b128 v[224:227],v17 offset:49152
s_waitcnt lgkmcnt(5)
v_mfma_f32_16x16x32_bf16 v[64:67],a[72:75],v[232:235],v[64:67]
v_min3_u32 v27,v27,v232,v236
v_mfma_f32_16x16x32_bf16 v[72:75],a[200:203],v[232:235],v[72:75]
ds_read_b128 v[228:231],v17 offset:51200
v_mfma_f32_16x16x32_bf16 v[64:67],a[76:79],v[236:239],v[64:67]
v_mfma_f32_16x16x32_bf16 v[72:75],a[204:207],v[236:239],v[72:75]
ds_read_b128 v[232:235],v17 offset:53248
s_waitcnt lgkmcnt(5)
v_mfma_f32_16x16x32_bf16 v[64:67],a[80:83],v[240:243],v[64:67]
v_min3_u32 v27,v27,v240,v244
v_mfma_f32_16x16x32_bf16 v[72:75],a[208:211],v[240:243],v[72:75]
ds_read_b128 v[236:239],v17 offset:55296
v_mfma_f32_16x16x32_bf16 v[64:67],a[84:87],v[244:247],v[64:67]
v_mfma_f32_16x16x32_bf16 v[72:75],a[212:215],v[244:247],v[72:75]
ds_read_b128 v[240:243],v17 offset:57344
s_waitcnt lgkmcnt(5)
v_mfma_f32_16x16x32_bf16 v[64:67],a[88:91],v[248:251],v[64:67]
v_min3_u32 v27,v27,v248,v252
v_mfma_f32_16x16x32_bf16 v[72:75],a[216:219],v[248:251],v[72:75]
ds_read_b128 v[244:247],v17 offset:59392
v_mfma_f32_16x16x32_bf16 v[64:67],a[92:95],v[252:255],v[64:67]
v_mfma_f32_16x16x32_bf16 v[72:75],a[220:223],v[252:255],v[72:75]
ds_read_b128 v[248:251],v17 offset:61440
s_waitcnt lgkmcnt(5)
v_mfma_f32_16x16x32_bf16 v[64:67],a[96:99],v[224:227],v[64:67]
v_min3_u32 v27,v27,v224,v228
v_mfma_f32_16x16x32_bf16 v[72:75],a[224:227],v[224:227],v[72:75]
ds_read_b128 v[252:255],v17 offset:63488
v_mfma_f32_16x16x32_bf16 v[64:67],a[100:103],v[228:231],v[64:67]
v_mfma_f32_16x16x32_bf16 v[72:75],a[228:231],v[228:231],v[72:75]
s_waitcnt vmcnt(3)
s_barrier
ds_read_b128 v[224:227],v17 offset:1024
s_waitcnt lgkmcnt(5)
v_mfma_f32_16x16x32_bf16 v[64:67],a[104:107],v[232:235],v[64:67]
v_min3_u32 v27,v27,v232,v236
s_add_u32 s92,s70,8388608
v_mfma_f32_16x16x32_bf16 v[72:75],a[232:235],v[232:235],v[72:75]
ds_read_b128 v[228:231],v17 offset:3072
s_sub_u32 s93,s71,53
v_mfma_f32_16x16x32_bf16 v[64:67],a[108:111],v[236:239],v[64:67]
s_cmp_lt_u32 s93,9
s_cselect_b32 s92,s92,0x7fff0000
v_mfma_f32_16x16x32_bf16 v[72:75],a[236:239],v[236:239],v[72:75]
ds_read_b128 v[232:235],v17 offset:5120
s_waitcnt lgkmcnt(5)
v_mfma_f32_16x16x32_bf16 v[64:67],a[112:115],v[240:243],v[64:67]
v_min3_u32 v27,v27,v240,v244
s_waitcnt vmcnt(1)
v_mfma_f32_16x16x32_bf16 v[72:75],a[240:243],v[240:243],v[72:75]
ds_read_b128 v[236:239],v17 offset:7168
ds_read_b64 v[120:121],v40 offset:0
v_mfma_f32_16x16x32_bf16 v[64:67],a[116:119],v[244:247],v[64:67]
ds_read_b64 v[122:123],v41 offset:0
ds_read_b64 v[124:125],v40 offset:1024
v_mfma_f32_16x16x32_bf16 v[72:75],a[244:247],v[244:247],v[72:75]
ds_read_b128 v[240:243],v17 offset:9216
s_waitcnt lgkmcnt(8)
v_mfma_f32_16x16x32_bf16 v[64:67],a[120:123],v[248:251],v[64:67]
v_min3_u32 v27,v27,v248,v252
ds_read_b64 v[126:127],v41 offset:1024
v_mfma_f32_16x16x32_bf16 v[72:75],a[248:251],v[248:251],v[72:75]
ds_read_b128 v[244:247],v17 offset:11264
v_mfma_f32_16x16x32_bf16 v[64:67],a[124:127],v[252:255],v[64:67]
buffer_load_dword v2,v21,s[20:23],s87 offen sc1
s_add_u32 s96,s71,2
v_mfma_f32_16x16x32_bf16 v[72:75],a[252:255],v[252:255],v[72:75]
ds_read_b128 v[248:251],v17 offset:13312
s_waitcnt lgkmcnt(9)
v_mfma_f32_16x16x32_bf16 v[68:71],a[0:3],v[224:227],0
v_cmp_eq_u32 vcc,0,v27
s_cbranch_vccnz retry_205
v_mfma_f32_16x16x32_bf16 v[76:79],a[128:131],v[224:227],0
ds_read_b128 v[252:255],v17 offset:15360
v_min3_u32 v27,v27,v224,v228
v_mfma_f32_16x16x32_bf16 v[68:71],a[4:7],v[228:231],v[68:71]
s_cmp_gt_u32 s96,56
s_addc_u32 s96,s96,0
v_mfma_f32_16x16x32_bf16 v[76:79],a[132:135],v[228:231],v[76:79]
ds_read_b128 v[224:227],v17 offset:17408
s_waitcnt lgkmcnt(9)
v_mfma_f32_16x16x32_bf16 v[68:71],a[8:11],v[232:235],v[68:71]
v_min3_u32 v27,v27,v232,v236
s_waitcnt lgkmcnt(4)
v_lshlrev_b32 v88,16,v120
v_mfma_f32_16x16x32_bf16 v[76:79],a[136:139],v[232:235],v[76:79]
ds_read_b128 v[228:231],v17 offset:19456
v_and_b32 v89,s80,v120
v_lshlrev_b32 v90,16,v121
v_mfma_f32_16x16x32_bf16 v[68:71],a[12:15],v[236:239],v[68:71]
buffer_store_dwordx4 v[48:51],v18,s[20:23],s92 offen offset:0 sc1
v_and_b32 v91,s80,v121
v_mfma_f32_16x16x32_bf16 v[76:79],a[140:143],v[236:239],v[76:79]
ds_read_b128 v[232:235],v17 offset:21504
v_lshlrev_b32 v92,16,v122
s_waitcnt lgkmcnt(5)
v_mfma_f32_16x16x32_bf16 v[68:71],a[16:19],v[240:243],v[68:71]
v_min3_u32 v27,v27,v240,v244
v_and_b32 v93,s80,v122
v_lshlrev_b32 v94,16,v123
v_mfma_f32_16x16x32_bf16 v[76:79],a[144:147],v[240:243],v[76:79]
ds_read_b128 v[236:239],v17 offset:23552
v_and_b32 v95,s80,v123
v_add_f32 v88,v64,v88
v_mfma_f32_16x16x32_bf16 v[68:71],a[20:23],v[244:247],v[68:71]
buffer_store_dwordx4 v[48:51],v18,s[20:23],s92 offen offset:1024 sc1
v_add_f32 v89,v65,v89
v_mfma_f32_16x16x32_bf16 v[76:79],a[148:151],v[244:247],v[76:79]
ds_read_b128 v[240:243],v17 offset:25600
v_add_f32 v90,v66,v90
s_waitcnt lgkmcnt(5)
v_mfma_f32_16x16x32_bf16 v[68:71],a[24:27],v[248:251],v[68:71]
v_min3_u32 v27,v27,v248,v252
v_add_f32 v91,v67,v91
v_add_f32 v92,v72,v92
v_mfma_f32_16x16x32_bf16 v[76:79],a[152:155],v[248:251],v[76:79]
ds_read_b128 v[244:247],v17 offset:27648
v_add_f32 v93,v73,v93
v_add_f32 v94,v74,v94
v_mfma_f32_16x16x32_bf16 v[68:71],a[28:31],v[252:255],v[68:71]
buffer_store_dwordx4 v[48:51],v24,s[20:23],s92 offen sc1
v_add_f32 v95,v75,v95
v_mfma_f32_16x16x32_bf16 v[76:79],a[156:159],v[252:255],v[76:79]
ds_read_b128 v[248:251],v17 offset:29696
v_cvt_pk_bf16_f32 v96,v88,v89
s_waitcnt lgkmcnt(5)
v_mfma_f32_16x16x32_bf16 v[68:71],a[32:35],v[224:227],v[68:71]
v_min3_u32 v27,v27,v224,v228
v_cvt_pk_bf16_f32 v97,v90,v91
v_cvt_pk_bf16_f32 v98,v92,v93
v_mfma_f32_16x16x32_bf16 v[76:79],a[160:163],v[224:227],v[76:79]
ds_read_b128 v[252:255],v17 offset:31744
v_cvt_pk_bf16_f32 v99,v94,v95
v_max_u32 v96,1,v96
v_mfma_f32_16x16x32_bf16 v[68:71],a[36:39],v[228:231],v[68:71]
buffer_store_dwordx4 v[96:99],v18,s[20:23],s70 offen offset:0 sc1
v_mfma_f32_16x16x32_bf16 v[76:79],a[164:167],v[228:231],v[76:79]
ds_read_b128 v[224:227],v17 offset:33792
s_waitcnt lgkmcnt(5)
v_mfma_f32_16x16x32_bf16 v[68:71],a[40:43],v[232:235],v[68:71]
v_min3_u32 v27,v27,v232,v236
v_lshlrev_b32 v88,16,v96
v_mfma_f32_16x16x32_bf16 v[76:79],a[168:171],v[232:235],v[76:79]
ds_read_b128 v[228:231],v17 offset:35840
v_and_b32 v89,s80,v96
v_mfma_f32_16x16x32_bf16 v[68:71],a[44:47],v[236:239],v[68:71]
v_lshlrev_b32 v90,16,v97
v_and_b32 v91,s80,v97
v_mfma_f32_16x16x32_bf16 v[76:79],a[172:175],v[236:239],v[76:79]
ds_read_b128 v[232:235],v17 offset:37888
s_waitcnt lgkmcnt(5)
v_mfma_f32_16x16x32_bf16 v[68:71],a[48:51],v[240:243],v[68:71]
v_min3_u32 v27,v27,v240,v244
v_lshlrev_b32 v92,16,v98
v_mfma_f32_16x16x32_bf16 v[76:79],a[176:179],v[240:243],v[76:79]
ds_read_b128 v[236:239],v17 offset:39936
v_and_b32 v93,s80,v98
v_mfma_f32_16x16x32_bf16 v[68:71],a[52:55],v[244:247],v[68:71]
v_lshlrev_b32 v94,16,v99
v_and_b32 v95,s80,v99
v_mfma_f32_16x16x32_bf16 v[76:79],a[180:183],v[244:247],v[76:79]
ds_read_b128 v[240:243],v17 offset:41984
s_waitcnt lgkmcnt(5)
v_mfma_f32_16x16x32_bf16 v[68:71],a[56:59],v[248:251],v[68:71]
v_min3_u32 v27,v27,v248,v252
v_add_f32 v108,v88,v89
v_mfma_f32_16x16x32_bf16 v[76:79],a[184:187],v[248:251],v[76:79]
ds_read_b128 v[244:247],v17 offset:44032
v_mul_f32 v109,v88,v88
v_mfma_f32_16x16x32_bf16 v[68:71],a[60:63],v[252:255],v[68:71]
v_add_f32 v100,v90,v91
v_mul_f32 v101,v89,v89
v_mfma_f32_16x16x32_bf16 v[76:79],a[188:191],v[252:255],v[76:79]
ds_read_b128 v[248:251],v17 offset:46080
s_waitcnt lgkmcnt(5)
v_mfma_f32_16x16x32_bf16 v[68:71],a[64:67],v[224:227],v[68:71]
v_min3_u32 v27,v27,v224,v228
v_fmac_f32 v109,v90,v90
v_mfma_f32_16x16x32_bf16 v[76:79],a[192:195],v[224:227],v[76:79]
ds_read_b128 v[252:255],v17 offset:48128
v_fmac_f32 v101,v91,v91
v_mfma_f32_16x16x32_bf16 v[68:71],a[68:71],v[228:231],v[68:71]
v_fmac_f32 v109,v92,v92
v_fmac_f32 v101,v93,v93
v_mfma_f32_16x16x32_bf16 v[76:79],a[196:199],v[228:231],v[76:79]
ds_read_b128 v[224:227],v17 offset:50176
s_waitcnt lgkmcnt(5)
v_mfma_f32_16x16x32_bf16 v[68:71],a[72:75],v[232:235],v[68:71]
v_min3_u32 v27,v27,v232,v236
v_add_f32 v108,v108,v92
v_mfma_f32_16x16x32_bf16 v[76:79],a[200:203],v[232:235],v[76:79]
ds_read_b128 v[228:231],v17 offset:52224
v_add_f32 v100,v100,v93
v_mfma_f32_16x16x32_bf16 v[68:71],a[76:79],v[236:239],v[68:71]
v_fmac_f32 v109,v94,v94
v_fmac_f32 v101,v95,v95
v_mfma_f32_16x16x32_bf16 v[76:79],a[204:207],v[236:239],v[76:79]
ds_read_b128 v[232:235],v17 offset:54272
s_waitcnt lgkmcnt(5)
v_mfma_f32_16x16x32_bf16 v[68:71],a[80:83],v[240:243],v[68:71]
v_min3_u32 v27,v27,v240,v244
v_add_f32 v108,v108,v94
v_mfma_f32_16x16x32_bf16 v[76:79],a[208:211],v[240:243],v[76:79]
ds_read_b128 v[236:239],v17 offset:56320
v_add_f32 v100,v100,v95
v_mfma_f32_16x16x32_bf16 v[68:71],a[84:87],v[244:247],v[68:71]
v_add_f32 v108,v108,v100
v_add_f32 v109,v109,v101
v_mfma_f32_16x16x32_bf16 v[76:79],a[212:215],v[244:247],v[76:79]
ds_read_b128 v[240:243],v17 offset:58368
s_waitcnt lgkmcnt(5)
v_mfma_f32_16x16x32_bf16 v[68:71],a[88:91],v[248:251],v[68:71]
v_min3_u32 v27,v27,v248,v252
v_mov_b32 v100,v108
v_mfma_f32_16x16x32_bf16 v[76:79],a[216:219],v[248:251],v[76:79]
ds_read_b128 v[244:247],v17 offset:60416
v_mov_b32 v101,v109
v_mfma_f32_16x16x32_bf16 v[68:71],a[92:95],v[252:255],v[68:71]
v_permlane16_swap_b32 v100,v108
v_permlane16_swap_b32 v101,v109
v_mfma_f32_16x16x32_bf16 v[76:79],a[220:223],v[252:255],v[76:79]
ds_read_b128 v[248:251],v17 offset:62464
s_waitcnt lgkmcnt(5)
v_mfma_f32_16x16x32_bf16 v[68:71],a[96:99],v[224:227],v[68:71]
v_min3_u32 v27,v27,v224,v228
v_add_f32 v108,v108,v100
v_mfma_f32_16x16x32_bf16 v[76:79],a[224:227],v[224:227],v[76:79]
ds_read_b128 v[252:255],v17 offset:64512
v_add_f32 v109,v109,v101
v_mfma_f32_16x16x32_bf16 v[68:71],a[100:103],v[228:231],v[68:71]
v_mov_b32 v100,v108
v_mov_b32 v101,v109
v_mfma_f32_16x16x32_bf16 v[76:79],a[228:231],v[228:231],v[76:79]
v_permlane32_swap_b32 v100,v108
s_waitcnt lgkmcnt(4)
v_mfma_f32_16x16x32_bf16 v[68:71],a[104:107],v[232:235],v[68:71]
v_min3_u32 v27,v27,v232,v236
s_waitcnt vmcnt(4)
v_mfma_f32_16x16x32_bf16 v[76:79],a[232:235],v[232:235],v[76:79]
v_cmp_gt_u32 vcc,s96,v2
s_mov_b32 s96,vcc_lo
v_mfma_f32_16x16x32_bf16 v[68:71],a[108:111],v[236:239],v[68:71]
v_mov_b32 v44,s96
ds_write_b32 v46,v44
v_mfma_f32_16x16x32_bf16 v[76:79],a[236:239],v[236:239],v[76:79]
v_permlane32_swap_b32 v101,v109
s_waitcnt lgkmcnt(3)
v_mfma_f32_16x16x32_bf16 v[68:71],a[112:115],v[240:243],v[68:71]
v_min3_u32 v27,v27,v240,v244
v_add_f32 v108,v108,v100
v_mfma_f32_16x16x32_bf16 v[76:79],a[240:243],v[240:243],v[76:79]
v_add_f32 v109,v109,v101
v_lshlrev_b32 v32,16,v124
v_mfma_f32_16x16x32_bf16 v[68:71],a[116:119],v[244:247],v[68:71]
v_and_b32 v33,s80,v124
v_lshlrev_b32 v34,16,v125
v_mfma_f32_16x16x32_bf16 v[76:79],a[244:247],v[244:247],v[76:79]
v_and_b32 v35,s80,v125
s_waitcnt lgkmcnt(1)
v_mfma_f32_16x16x32_bf16 v[68:71],a[120:123],v[248:251],v[68:71]
v_min3_u32 v27,v27,v248,v252
v_lshlrev_b32 v36,16,v126
v_mfma_f32_16x16x32_bf16 v[76:79],a[248:251],v[248:251],v[76:79]
v_and_b32 v37,s80,v126
v_lshlrev_b32 v38,16,v127
v_mfma_f32_16x16x32_bf16 v[68:71],a[124:127],v[252:255],v[68:71]
v_and_b32 v39,s80,v127
v_mfma_f32_16x16x32_bf16 v[76:79],a[252:255],v[252:255],v[76:79]
v_cmp_eq_u32 vcc,0,v27
s_cbranch_vccnz retry_205
s_branch epi_208
both_209:
s_waitcnt vmcnt(8)
s_barrier
ds_read_b128 v[224:227],v17 offset:0
ds_read_b128 v[228:231],v17 offset:2048
ds_read_b128 v[232:235],v17 offset:4096
ds_read_b128 v[236:239],v17 offset:6144
ds_read_b128 v[240:243],v17 offset:8192
ds_read_b128 v[244:247],v17 offset:10240
ds_read_b128 v[248:251],v17 offset:12288
s_waitcnt lgkmcnt(5)
v_mfma_f32_16x16x32_bf16 v[64:67],a[0:3],v[224:227],0
v_min_u32 v27,v224,v228
s_xor_b32 m0,s91,17408
v_mfma_f32_16x16x32_bf16 v[72:75],a[128:131],v[224:227],0
ds_read_b128 v[252:255],v17 offset:14336
s_add_u32 s88,s70,s75
v_mfma_f32_16x16x32_bf16 v[64:67],a[4:7],v[228:231],v[64:67]
s_add_u32 s65,s95,32768
s_add_u32 s88,s88,2097152
v_mfma_f32_16x16x32_bf16 v[72:75],a[132:135],v[228:231],v[72:75]
s_waitcnt vmcnt(6)
s_barrier
ds_read_b128 v[224:227],v17 offset:16384
s_waitcnt lgkmcnt(5)
v_mfma_f32_16x16x32_bf16 v[64:67],a[8:11],v[232:235],v[64:67]
v_min3_u32 v27,v27,v232,v236
buffer_load_dwordx4 v16,s[20:23],s65 offen offset:0 sc1 lds
v_mfma_f32_16x16x32_bf16 v[72:75],a[136:139],v[232:235],v[72:75]
ds_read_b128 v[228:231],v17 offset:18432
s_xor_b32 s88,s88,0x2000
v_mfma_f32_16x16x32_bf16 v[64:67],a[12:15],v[236:239],v[64:67]
buffer_load_dwordx4 v16,s[20:23],s65 offen offset:2048 sc1 lds
v_mfma_f32_16x16x32_bf16 v[72:75],a[140:143],v[236:239],v[72:75]
ds_read_b128 v[232:235],v17 offset:20480
s_waitcnt lgkmcnt(5)
v_mfma_f32_16x16x32_bf16 v[64:67],a[16:19],v[240:243],v[64:67]
v_min3_u32 v27,v27,v240,v244
s_xor_b32 m0,s91,33792
v_mfma_f32_16x16x32_bf16 v[72:75],a[144:147],v[240:243],v[72:75]
ds_read_b128 v[236:239],v17 offset:22528
s_xor_b32 s89,s88,1024
v_mfma_f32_16x16x32_bf16 v[64:67],a[20:23],v[244:247],v[64:67]
s_add_u32 s65,s95,65536
v_mfma_f32_16x16x32_bf16 v[72:75],a[148:151],v[244:247],v[72:75]
ds_read_b128 v[240:243],v17 offset:24576
s_waitcnt lgkmcnt(5)
v_mfma_f32_16x16x32_bf16 v[64:67],a[24:27],v[248:251],v[64:67]
v_min3_u32 v27,v27,v248,v252
buffer_load_dwordx4 v16,s[20:23],s65 offen offset:0 sc1 lds
v_mfma_f32_16x16x32_bf16 v[72:75],a[152:155],v[248:251],v[72:75]
ds_read_b128 v[244:247],v17 offset:26624
v_mfma_f32_16x16x32_bf16 v[64:67],a[28:31],v[252:255],v[64:67]
buffer_load_dwordx4 v16,s[20:23],s65 offen offset:2048 sc1 lds
v_mfma_f32_16x16x32_bf16 v[72:75],a[156:159],v[252:255],v[72:75]
ds_read_b128 v[248:251],v17 offset:28672
s_waitcnt lgkmcnt(5)
v_mfma_f32_16x16x32_bf16 v[64:67],a[32:35],v[224:227],v[64:67]
v_min3_u32 v27,v27,v224,v228
s_xor_b32 m0,s91,50176
v_mfma_f32_16x16x32_bf16 v[72:75],a[160:163],v[224:227],v[72:75]
ds_read_b128 v[252:255],v17 offset:30720
v_mfma_f32_16x16x32_bf16 v[64:67],a[36:39],v[228:231],v[64:67]
s_add_u32 s65,s95,98304
v_mfma_f32_16x16x32_bf16 v[72:75],a[164:167],v[228:231],v[72:75]
s_waitcnt vmcnt(6)
s_barrier
ds_read_b128 v[224:227],v17 offset:32768
s_waitcnt lgkmcnt(5)
v_mfma_f32_16x16x32_bf16 v[64:67],a[40:43],v[232:235],v[64:67]
v_min3_u32 v27,v27,v232,v236
buffer_load_dwordx4 v16,s[20:23],s65 offen offset:0 sc1 lds
v_mfma_f32_16x16x32_bf16 v[72:75],a[168:171],v[232:235],v[72:75]
ds_read_b128 v[228:231],v17 offset:34816
v_mfma_f32_16x16x32_bf16 v[64:67],a[44:47],v[236:239],v[64:67]
buffer_load_dwordx4 v16,s[20:23],s65 offen offset:2048 sc1 lds
v_mfma_f32_16x16x32_bf16 v[72:75],a[172:175],v[236:239],v[72:75]
ds_read_b128 v[232:235],v17 offset:36864
s_waitcnt lgkmcnt(5)
v_mfma_f32_16x16x32_bf16 v[64:67],a[48:51],v[240:243],v[64:67]
v_min3_u32 v27,v27,v240,v244
v_mfma_f32_16x16x32_bf16 v[72:75],a[176:179],v[240:243],v[72:75]
ds_read_b128 v[236:239],v17 offset:38912
v_mfma_f32_16x16x32_bf16 v[64:67],a[52:55],v[244:247],v[64:67]
v_add_u32 v22,s71,-1
s_add_u32 m0,s43,0
s_nop 0
buffer_load_dwordx4 v19,s[20:23],s78 offen sc1 lds
v_mfma_f32_16x16x32_bf16 v[72:75],a[180:183],v[244:247],v[72:75]
ds_read_b128 v[240:243],v17 offset:40960
s_add_u32 m0,s43,1024
s_waitcnt lgkmcnt(5)
v_mfma_f32_16x16x32_bf16 v[64:67],a[56:59],v[248:251],v[64:67]
v_min3_u32 v27,v27,v248,v252
buffer_load_dwordx4 v20,s[20:23],s78 offen sc1 lds
v_mfma_f32_16x16x32_bf16 v[72:75],a[184:187],v[248:251],v[72:75]
ds_read_b128 v[244:247],v17 offset:43008
v_mfma_f32_16x16x32_bf16 v[64:67],a[60:63],v[252:255],v[64:67]
buffer_store_dword v22,v23,s[20:23],s73 offen sc1
v_mfma_f32_16x16x32_bf16 v[72:75],a[188:191],v[252:255],v[72:75]
ds_read_b128 v[248:251],v17 offset:45056
s_waitcnt lgkmcnt(5)
v_mfma_f32_16x16x32_bf16 v[64:67],a[64:67],v[224:227],v[64:67]
v_min3_u32 v27,v27,v224,v228
s_xor_b32 m0,s72,0
v_mfma_f32_16x16x32_bf16 v[72:75],a[192:195],v[224:227],v[72:75]
ds_read_b128 v[252:255],v17 offset:47104
s_add_u32 s65,s88,0
v_mfma_f32_16x16x32_bf16 v[64:67],a[68:71],v[228:231],v[64:67]
v_mfma_f32_16x16x32_bf16 v[72:75],a[196:199],v[228:231],v[72:75]
ds_read_b128 v[224:227],v17 offset:49152
buffer_load_dwordx4 v16,s[20:23],s65 offen offset:0 sc1 lds
s_waitcnt lgkmcnt(5)
v_mfma_f32_16x16x32_bf16 v[64:67],a[72:75],v[232:235],v[64:67]
v_min3_u32 v27,v27,v232,v236
v_mfma_f32_16x16x32_bf16 v[72:75],a[200:203],v[232:235],v[72:75]
ds_read_b128 v[228:231],v17 offset:51200
buffer_load_dwordx4 v16,s[20:23],s65 offen offset:2048 sc1 lds
v_mfma_f32_16x16x32_bf16 v[64:67],a[76:79],v[236:239],v[64:67]
v_mfma_f32_16x16x32_bf16 v[72:75],a[204:207],v[236:239],v[72:75]
ds_read_b128 v[232:235],v17 offset:53248
s_xor_b32 m0,s72,16384
s_waitcnt lgkmcnt(5)
v_mfma_f32_16x16x32_bf16 v[64:67],a[80:83],v[240:243],v[64:67]
v_min3_u32 v27,v27,v240,v244
s_add_u32 s65,s88,32768
v_mfma_f32_16x16x32_bf16 v[72:75],a[208:211],v[240:243],v[72:75]
ds_read_b128 v[236:239],v17 offset:55296
v_mfma_f32_16x16x32_bf16 v[64:67],a[84:87],v[244:247],v[64:67]
buffer_load_dwordx4 v16,s[20:23],s65 offen offset:0 sc1 lds
v_mfma_f32_16x16x32_bf16 v[72:75],a[212:215],v[244:247],v[72:75]
ds_read_b128 v[240:243],v17 offset:57344
s_waitcnt lgkmcnt(5)
v_mfma_f32_16x16x32_bf16 v[64:67],a[88:91],v[248:251],v[64:67]
v_min3_u32 v27,v27,v248,v252
buffer_load_dwordx4 v16,s[20:23],s65 offen offset:2048 sc1 lds
v_mfma_f32_16x16x32_bf16 v[72:75],a[216:219],v[248:251],v[72:75]
ds_read_b128 v[244:247],v17 offset:59392
v_mfma_f32_16x16x32_bf16 v[64:67],a[92:95],v[252:255],v[64:67]
s_xor_b32 m0,s72,32768
v_mfma_f32_16x16x32_bf16 v[72:75],a[220:223],v[252:255],v[72:75]
ds_read_b128 v[248:251],v17 offset:61440
s_add_u32 s65,s88,65536
s_waitcnt lgkmcnt(5)
v_mfma_f32_16x16x32_bf16 v[64:67],a[96:99],v[224:227],v[64:67]
v_min3_u32 v27,v27,v224,v228
v_mfma_f32_16x16x32_bf16 v[72:75],a[224:227],v[224:227],v[72:75]
ds_read_b128 v[252:255],v17 offset:63488
buffer_load_dwordx4 v16,s[20:23],s65 offen offset:0 sc1 lds
v_mfma_f32_16x16x32_bf16 v[64:67],a[100:103],v[228:231],v[64:67]
v_mfma_f32_16x16x32_bf16 v[72:75],a[228:231],v[228:231],v[72:75]
s_waitcnt vmcnt(8)
s_barrier
ds_read_b128 v[224:227],v17 offset:1024
s_waitcnt lgkmcnt(5)
v_mfma_f32_16x16x32_bf16 v[64:67],a[104:107],v[232:235],v[64:67]
v_min3_u32 v27,v27,v232,v236
s_add_u32 s92,s70,8388608
buffer_load_dwordx4 v16,s[20:23],s65 offen offset:2048 sc1 lds
v_mfma_f32_16x16x32_bf16 v[72:75],a[232:235],v[232:235],v[72:75]
ds_read_b128 v[228:231],v17 offset:3072
s_sub_u32 s93,s71,53
s_xor_b32 m0,s72,49152
v_mfma_f32_16x16x32_bf16 v[64:67],a[108:111],v[236:239],v[64:67]
s_cmp_lt_u32 s93,9
s_cselect_b32 s92,s92,0x7fff0000
s_add_u32 s65,s88,98304
v_mfma_f32_16x16x32_bf16 v[72:75],a[236:239],v[236:239],v[72:75]
ds_read_b128 v[232:235],v17 offset:5120
s_waitcnt lgkmcnt(5)
v_mfma_f32_16x16x32_bf16 v[64:67],a[112:115],v[240:243],v[64:67]
v_min3_u32 v27,v27,v240,v244
s_waitcnt vmcnt(7)
buffer_load_dwordx4 v16,s[20:23],s65 offen offset:0 sc1 lds
v_mfma_f32_16x16x32_bf16 v[72:75],a[240:243],v[240:243],v[72:75]
ds_read_b128 v[236:239],v17 offset:7168
ds_read_b64 v[120:121],v40 offset:0
v_mfma_f32_16x16x32_bf16 v[64:67],a[116:119],v[244:247],v[64:67]
ds_read_b64 v[122:123],v41 offset:0
ds_read_b64 v[124:125],v40 offset:1024
buffer_load_dwordx4 v16,s[20:23],s65 offen offset:2048 sc1 lds
v_mfma_f32_16x16x32_bf16 v[72:75],a[244:247],v[244:247],v[72:75]
ds_read_b128 v[240:243],v17 offset:9216
s_waitcnt lgkmcnt(8)
v_mfma_f32_16x16x32_bf16 v[64:67],a[120:123],v[248:251],v[64:67]
v_min3_u32 v27,v27,v248,v252
ds_read_b64 v[126:127],v41 offset:1024
s_xor_b32 m0,s72,1024
v_mfma_f32_16x16x32_bf16 v[72:75],a[248:251],v[248:251],v[72:75]
ds_read_b128 v[244:247],v17 offset:11264
s_add_u32 s65,s89,0
v_mfma_f32_16x16x32_bf16 v[64:67],a[124:127],v[252:255],v[64:67]
buffer_load_dword v2,v21,s[20:23],s87 offen sc1
s_add_u32 s96,s71,2
v_mfma_f32_16x16x32_bf16 v[72:75],a[252:255],v[252:255],v[72:75]
ds_read_b128 v[248:251],v17 offset:13312
buffer_load_dwordx4 v16,s[20:23],s65 offen offset:0 sc1 lds
s_waitcnt lgkmcnt(9)
v_mfma_f32_16x16x32_bf16 v[68:71],a[0:3],v[224:227],0
v_cmp_eq_u32 vcc,0,v27
s_cbranch_vccnz retry_205
v_mfma_f32_16x16x32_bf16 v[76:79],a[128:131],v[224:227],0
ds_read_b128 v[252:255],v17 offset:15360
v_min3_u32 v27,v27,v224,v228
buffer_load_dwordx4 v16,s[20:23],s65 offen offset:2048 sc1 lds
v_mfma_f32_16x16x32_bf16 v[68:71],a[4:7],v[228:231],v[68:71]
s_cmp_gt_u32 s96,56
s_addc_u32 s96,s96,0
v_mfma_f32_16x16x32_bf16 v[76:79],a[132:135],v[228:231],v[76:79]
ds_read_b128 v[224:227],v17 offset:17408
s_xor_b32 m0,s72,17408
s_waitcnt lgkmcnt(9)
v_mfma_f32_16x16x32_bf16 v[68:71],a[8:11],v[232:235],v[68:71]
v_min3_u32 v27,v27,v232,v236
s_waitcnt lgkmcnt(4)
v_lshlrev_b32 v88,16,v120
s_add_u32 s65,s89,32768
v_mfma_f32_16x16x32_bf16 v[76:79],a[136:139],v[232:235],v[76:79]
ds_read_b128 v[228:231],v17 offset:19456
v_and_b32 v89,s80,v120
v_lshlrev_b32 v90,16,v121
v_mfma_f32_16x16x32_bf16 v[68:71],a[12:15],v[236:239],v[68:71]
buffer_store_dwordx4 v[48:51],v18,s[20:23],s92 offen offset:0 sc1
v_and_b32 v91,s80,v121
v_mfma_f32_16x16x32_bf16 v[76:79],a[140:143],v[236:239],v[76:79]
ds_read_b128 v[232:235],v17 offset:21504
v_lshlrev_b32 v92,16,v122
s_waitcnt lgkmcnt(5)
v_mfma_f32_16x16x32_bf16 v[68:71],a[16:19],v[240:243],v[68:71]
v_min3_u32 v27,v27,v240,v244
v_and_b32 v93,s80,v122
v_lshlrev_b32 v94,16,v123
v_mfma_f32_16x16x32_bf16 v[76:79],a[144:147],v[240:243],v[76:79]
ds_read_b128 v[236:239],v17 offset:23552
v_and_b32 v95,s80,v123
v_add_f32 v88,v64,v88
v_mfma_f32_16x16x32_bf16 v[68:71],a[20:23],v[244:247],v[68:71]
buffer_store_dwordx4 v[48:51],v18,s[20:23],s92 offen offset:1024 sc1
v_add_f32 v89,v65,v89
v_mfma_f32_16x16x32_bf16 v[76:79],a[148:151],v[244:247],v[76:79]
ds_read_b128 v[240:243],v17 offset:25600
v_add_f32 v90,v66,v90
s_waitcnt lgkmcnt(5)
v_mfma_f32_16x16x32_bf16 v[68:71],a[24:27],v[248:251],v[68:71]
v_min3_u32 v27,v27,v248,v252
v_add_f32 v91,v67,v91
v_add_f32 v92,v72,v92
v_mfma_f32_16x16x32_bf16 v[76:79],a[152:155],v[248:251],v[76:79]
ds_read_b128 v[244:247],v17 offset:27648
v_add_f32 v93,v73,v93
v_add_f32 v94,v74,v94
v_mfma_f32_16x16x32_bf16 v[68:71],a[28:31],v[252:255],v[68:71]
buffer_store_dwordx4 v[48:51],v24,s[20:23],s92 offen sc1
v_add_f32 v95,v75,v95
v_mfma_f32_16x16x32_bf16 v[76:79],a[156:159],v[252:255],v[76:79]
ds_read_b128 v[248:251],v17 offset:29696
v_cvt_pk_bf16_f32 v96,v88,v89
s_waitcnt lgkmcnt(5)
v_mfma_f32_16x16x32_bf16 v[68:71],a[32:35],v[224:227],v[68:71]
v_min3_u32 v27,v27,v224,v228
v_cvt_pk_bf16_f32 v97,v90,v91
v_cvt_pk_bf16_f32 v98,v92,v93
v_mfma_f32_16x16x32_bf16 v[76:79],a[160:163],v[224:227],v[76:79]
ds_read_b128 v[252:255],v17 offset:31744
v_cvt_pk_bf16_f32 v99,v94,v95
v_max_u32 v96,1,v96
v_mfma_f32_16x16x32_bf16 v[68:71],a[36:39],v[228:231],v[68:71]
buffer_store_dwordx4 v[96:99],v18,s[20:23],s70 offen offset:0 sc1
buffer_load_dwordx4 v16,s[20:23],s65 offen offset:0 sc1 lds
v_mfma_f32_16x16x32_bf16 v[76:79],a[164:167],v[228:231],v[76:79]
ds_read_b128 v[224:227],v17 offset:33792
buffer_load_dwordx4 v16,s[20:23],s65 offen offset:2048 sc1 lds
s_waitcnt lgkmcnt(5)
v_mfma_f32_16x16x32_bf16 v[68:71],a[40:43],v[232:235],v[68:71]
v_min3_u32 v27,v27,v232,v236
v_lshlrev_b32 v88,16,v96
s_xor_b32 m0,s72,33792
s_add_u32 s65,s89,65536
v_mfma_f32_16x16x32_bf16 v[76:79],a[168:171],v[232:235],v[76:79]
ds_read_b128 v[228:231],v17 offset:35840
v_and_b32 v89,s80,v96
buffer_load_dwordx4 v16,s[20:23],s65 offen offset:0 sc1 lds
v_mfma_f32_16x16x32_bf16 v[68:71],a[44:47],v[236:239],v[68:71]
v_lshlrev_b32 v90,16,v97
v_and_b32 v91,s80,v97
buffer_load_dwordx4 v16,s[20:23],s65 offen offset:2048 sc1 lds
v_mfma_f32_16x16x32_bf16 v[76:79],a[172:175],v[236:239],v[76:79]
ds_read_b128 v[232:235],v17 offset:37888
s_xor_b32 m0,s72,50176
s_add_u32 s65,s89,98304
s_waitcnt lgkmcnt(5)
v_mfma_f32_16x16x32_bf16 v[68:71],a[48:51],v[240:243],v[68:71]
v_min3_u32 v27,v27,v240,v244
v_lshlrev_b32 v92,16,v98
buffer_load_dwordx4 v16,s[20:23],s65 offen offset:0 sc1 lds
v_mfma_f32_16x16x32_bf16 v[76:79],a[176:179],v[240:243],v[76:79]
ds_read_b128 v[236:239],v17 offset:39936
v_and_b32 v93,s80,v98
v_mfma_f32_16x16x32_bf16 v[68:71],a[52:55],v[244:247],v[68:71]
v_lshlrev_b32 v94,16,v99
v_and_b32 v95,s80,v99
v_mfma_f32_16x16x32_bf16 v[76:79],a[180:183],v[244:247],v[76:79]
ds_read_b128 v[240:243],v17 offset:41984
s_waitcnt lgkmcnt(5)
v_mfma_f32_16x16x32_bf16 v[68:71],a[56:59],v[248:251],v[68:71]
v_min3_u32 v27,v27,v248,v252
v_add_f32 v108,v88,v89
v_mfma_f32_16x16x32_bf16 v[76:79],a[184:187],v[248:251],v[76:79]
ds_read_b128 v[244:247],v17 offset:44032
v_mul_f32 v109,v88,v88
v_mfma_f32_16x16x32_bf16 v[68:71],a[60:63],v[252:255],v[68:71]
v_add_f32 v100,v90,v91
v_mul_f32 v101,v89,v89
v_mfma_f32_16x16x32_bf16 v[76:79],a[188:191],v[252:255],v[76:79]
ds_read_b128 v[248:251],v17 offset:46080
s_waitcnt lgkmcnt(5)
v_mfma_f32_16x16x32_bf16 v[68:71],a[64:67],v[224:227],v[68:71]
v_min3_u32 v27,v27,v224,v228
v_fmac_f32 v109,v90,v90
v_mfma_f32_16x16x32_bf16 v[76:79],a[192:195],v[224:227],v[76:79]
ds_read_b128 v[252:255],v17 offset:48128
v_fmac_f32 v101,v91,v91
v_mfma_f32_16x16x32_bf16 v[68:71],a[68:71],v[228:231],v[68:71]
v_fmac_f32 v109,v92,v92
v_fmac_f32 v101,v93,v93
v_mfma_f32_16x16x32_bf16 v[76:79],a[196:199],v[228:231],v[76:79]
ds_read_b128 v[224:227],v17 offset:50176
s_waitcnt lgkmcnt(5)
v_mfma_f32_16x16x32_bf16 v[68:71],a[72:75],v[232:235],v[68:71]
v_min3_u32 v27,v27,v232,v236
v_add_f32 v108,v108,v92
v_mfma_f32_16x16x32_bf16 v[76:79],a[200:203],v[232:235],v[76:79]
ds_read_b128 v[228:231],v17 offset:52224
v_add_f32 v100,v100,v93
v_mfma_f32_16x16x32_bf16 v[68:71],a[76:79],v[236:239],v[68:71]
v_fmac_f32 v109,v94,v94
v_fmac_f32 v101,v95,v95
v_mfma_f32_16x16x32_bf16 v[76:79],a[204:207],v[236:239],v[76:79]
ds_read_b128 v[232:235],v17 offset:54272
s_waitcnt lgkmcnt(5)
v_mfma_f32_16x16x32_bf16 v[68:71],a[80:83],v[240:243],v[68:71]
v_min3_u32 v27,v27,v240,v244
v_add_f32 v108,v108,v94
v_mfma_f32_16x16x32_bf16 v[76:79],a[208:211],v[240:243],v[76:79]
ds_read_b128 v[236:239],v17 offset:56320
v_add_f32 v100,v100,v95
v_mfma_f32_16x16x32_bf16 v[68:71],a[84:87],v[244:247],v[68:71]
v_add_f32 v108,v108,v100
v_add_f32 v109,v109,v101
v_mfma_f32_16x16x32_bf16 v[76:79],a[212:215],v[244:247],v[76:79]
ds_read_b128 v[240:243],v17 offset:58368
s_waitcnt lgkmcnt(5)
v_mfma_f32_16x16x32_bf16 v[68:71],a[88:91],v[248:251],v[68:71]
v_min3_u32 v27,v27,v248,v252
v_mov_b32 v100,v108
v_mfma_f32_16x16x32_bf16 v[76:79],a[216:219],v[248:251],v[76:79]
ds_read_b128 v[244:247],v17 offset:60416
v_mov_b32 v101,v109
v_mfma_f32_16x16x32_bf16 v[68:71],a[92:95],v[252:255],v[68:71]
v_permlane16_swap_b32 v100,v108
v_permlane16_swap_b32 v101,v109
v_mfma_f32_16x16x32_bf16 v[76:79],a[220:223],v[252:255],v[76:79]
ds_read_b128 v[248:251],v17 offset:62464
s_waitcnt lgkmcnt(5)
v_mfma_f32_16x16x32_bf16 v[68:71],a[96:99],v[224:227],v[68:71]
v_min3_u32 v27,v27,v224,v228
v_add_f32 v108,v108,v100
v_mfma_f32_16x16x32_bf16 v[76:79],a[224:227],v[224:227],v[76:79]
ds_read_b128 v[252:255],v17 offset:64512
v_add_f32 v109,v109,v101
v_mfma_f32_16x16x32_bf16 v[68:71],a[100:103],v[228:231],v[68:71]
v_mov_b32 v100,v108
v_mov_b32 v101,v109
v_mfma_f32_16x16x32_bf16 v[76:79],a[228:231],v[228:231],v[76:79]
v_permlane32_swap_b32 v100,v108
s_waitcnt lgkmcnt(4)
v_mfma_f32_16x16x32_bf16 v[68:71],a[104:107],v[232:235],v[68:71]
v_min3_u32 v27,v27,v232,v236
s_waitcnt vmcnt(11)
v_mfma_f32_16x16x32_bf16 v[76:79],a[232:235],v[232:235],v[76:79]
v_cmp_gt_u32 vcc,s96,v2
s_mov_b32 s96,vcc_lo
v_mfma_f32_16x16x32_bf16 v[68:71],a[108:111],v[236:239],v[68:71]
v_mov_b32 v44,s96
ds_write_b32 v46,v44
v_mfma_f32_16x16x32_bf16 v[76:79],a[236:239],v[236:239],v[76:79]
v_permlane32_swap_b32 v101,v109
s_waitcnt lgkmcnt(3)
v_mfma_f32_16x16x32_bf16 v[68:71],a[112:115],v[240:243],v[68:71]
v_min3_u32 v27,v27,v240,v244
v_add_f32 v108,v108,v100
v_mfma_f32_16x16x32_bf16 v[76:79],a[240:243],v[240:243],v[76:79]
v_add_f32 v109,v109,v101
v_lshlrev_b32 v32,16,v124
v_mfma_f32_16x16x32_bf16 v[68:71],a[116:119],v[244:247],v[68:71]
v_and_b32 v33,s80,v124
v_lshlrev_b32 v34,16,v125
v_mfma_f32_16x16x32_bf16 v[76:79],a[244:247],v[244:247],v[76:79]
v_and_b32 v35,s80,v125
s_waitcnt lgkmcnt(1)
v_mfma_f32_16x16x32_bf16 v[68:71],a[120:123],v[248:251],v[68:71]
v_min3_u32 v27,v27,v248,v252
v_lshlrev_b32 v36,16,v126
v_mfma_f32_16x16x32_bf16 v[76:79],a[248:251],v[248:251],v[76:79]
v_and_b32 v37,s80,v126
v_lshlrev_b32 v38,16,v127
v_mfma_f32_16x16x32_bf16 v[68:71],a[124:127],v[252:255],v[68:71]
v_and_b32 v39,s80,v127
v_mfma_f32_16x16x32_bf16 v[76:79],a[252:255],v[252:255],v[76:79]
buffer_load_dwordx4 v16,s[20:23],s65 offen offset:2048 sc1 lds
v_cmp_eq_u32 vcc,0,v27
s_cbranch_vccnz retry_205
s_branch epi_208
ahead_207:
s_waitcnt vmcnt(4) lgkmcnt(0)
s_barrier
ds_read_b32 v44,v45
ds_read_b128 v[224:227],v17 offset:0
ds_read_b128 v[228:231],v17 offset:2048
ds_read_b128 v[232:235],v17 offset:4096
ds_read_b128 v[236:239],v17 offset:6144
ds_read_b128 v[240:243],v17 offset:8192
ds_read_b128 v[244:247],v17 offset:10240
ds_read_b128 v[248:251],v17 offset:12288
s_waitcnt lgkmcnt(5)
v_mfma_f32_16x16x32_bf16 v[64:67],a[0:3],v[224:227],0
s_add_u32 s88,s70,s75
s_add_u32 s88,s88,2097152
s_add_u32 m0,s43,0
v_mfma_f32_16x16x32_bf16 v[72:75],a[128:131],v[224:227],0
ds_read_b128 v[252:255],v17 offset:14336
s_xor_b32 s88,s88,0x2000
buffer_load_dwordx4 v19,s[20:23],s78 offen sc1 lds
v_mfma_f32_16x16x32_bf16 v[64:67],a[4:7],v[228:231],v[64:67]
v_readfirstlane_b32 s83,v44
s_add_u32 m0,s43,1024
v_mfma_f32_16x16x32_bf16 v[72:75],a[132:135],v[228:231],v[72:75]
ds_read_b128 v[224:227],v17 offset:16384
buffer_load_dwordx4 v20,s[20:23],s78 offen sc1 lds
s_waitcnt lgkmcnt(5)
v_mfma_f32_16x16x32_bf16 v[64:67],a[8:11],v[232:235],v[64:67]
s_cmp_eq_u32 s83,0
s_cselect_b32 s88,s88,0x7fff0000
v_mfma_f32_16x16x32_bf16 v[72:75],a[136:139],v[232:235],v[72:75]
ds_read_b128 v[228:231],v17 offset:18432
s_xor_b32 s89,s88,1024
v_mfma_f32_16x16x32_bf16 v[64:67],a[12:15],v[236:239],v[64:67]
s_xor_b32 m0,s72,0
v_mfma_f32_16x16x32_bf16 v[72:75],a[140:143],v[236:239],v[72:75]
ds_read_b128 v[232:235],v17 offset:20480
s_add_u32 s65,s88,0
s_waitcnt lgkmcnt(5)
v_mfma_f32_16x16x32_bf16 v[64:67],a[16:19],v[240:243],v[64:67]
v_mfma_f32_16x16x32_bf16 v[72:75],a[144:147],v[240:243],v[72:75]
ds_read_b128 v[236:239],v17 offset:22528
buffer_load_dwordx4 v16,s[20:23],s65 offen offset:0 sc1 lds
v_mfma_f32_16x16x32_bf16 v[64:67],a[20:23],v[244:247],v[64:67]
v_mfma_f32_16x16x32_bf16 v[72:75],a[148:151],v[244:247],v[72:75]
ds_read_b128 v[240:243],v17 offset:24576
s_waitcnt lgkmcnt(5)
v_mfma_f32_16x16x32_bf16 v[64:67],a[24:27],v[248:251],v[64:67]
buffer_load_dwordx4 v16,s[20:23],s65 offen offset:2048 sc1 lds
v_mfma_f32_16x16x32_bf16 v[72:75],a[152:155],v[248:251],v[72:75]
ds_read_b128 v[244:247],v17 offset:26624
s_xor_b32 m0,s72,16384
v_mfma_f32_16x16x32_bf16 v[64:67],a[28:31],v[252:255],v[64:67]
s_add_u32 s65,s88,32768
v_mfma_f32_16x16x32_bf16 v[72:75],a[156:159],v[252:255],v[72:75]
ds_read_b128 v[248:251],v17 offset:28672
s_waitcnt lgkmcnt(5)
v_mfma_f32_16x16x32_bf16 v[64:67],a[32:35],v[224:227],v[64:67]
buffer_load_dwordx4 v16,s[20:23],s65 offen offset:0 sc1 lds
v_mfma_f32_16x16x32_bf16 v[72:75],a[160:163],v[224:227],v[72:75]
ds_read_b128 v[252:255],v17 offset:30720
v_mfma_f32_16x16x32_bf16 v[64:67],a[36:39],v[228:231],v[64:67]
buffer_load_dwordx4 v16,s[20:23],s65 offen offset:2048 sc1 lds
v_mfma_f32_16x16x32_bf16 v[72:75],a[164:167],v[228:231],v[72:75]
ds_read_b128 v[224:227],v17 offset:32768
s_waitcnt lgkmcnt(5)
v_mfma_f32_16x16x32_bf16 v[64:67],a[40:43],v[232:235],v[64:67]
s_xor_b32 m0,s72,32768
v_mfma_f32_16x16x32_bf16 v[72:75],a[168:171],v[232:235],v[72:75]
ds_read_b128 v[228:231],v17 offset:34816
s_add_u32 s65,s88,65536
v_mfma_f32_16x16x32_bf16 v[64:67],a[44:47],v[236:239],v[64:67]
v_mfma_f32_16x16x32_bf16 v[72:75],a[172:175],v[236:239],v[72:75]
ds_read_b128 v[232:235],v17 offset:36864
s_waitcnt lgkmcnt(5)
v_mfma_f32_16x16x32_bf16 v[64:67],a[48:51],v[240:243],v[64:67]
buffer_load_dwordx4 v16,s[20:23],s65 offen offset:0 sc1 lds
v_mfma_f32_16x16x32_bf16 v[72:75],a[176:179],v[240:243],v[72:75]
ds_read_b128 v[236:239],v17 offset:38912
buffer_load_dwordx4 v16,s[20:23],s65 offen offset:2048 sc1 lds
v_mfma_f32_16x16x32_bf16 v[64:67],a[52:55],v[244:247],v[64:67]
v_mfma_f32_16x16x32_bf16 v[72:75],a[180:183],v[244:247],v[72:75]
ds_read_b128 v[240:243],v17 offset:40960
s_xor_b32 m0,s72,49152
s_waitcnt lgkmcnt(5)
v_mfma_f32_16x16x32_bf16 v[64:67],a[56:59],v[248:251],v[64:67]
s_add_u32 s65,s88,98304
v_mfma_f32_16x16x32_bf16 v[72:75],a[184:187],v[248:251],v[72:75]
ds_read_b128 v[244:247],v17 offset:43008
v_mfma_f32_16x16x32_bf16 v[64:67],a[60:63],v[252:255],v[64:67]
buffer_load_dwordx4 v16,s[20:23],s65 offen offset:0 sc1 lds
v_mfma_f32_16x16x32_bf16 v[72:75],a[188:191],v[252:255],v[72:75]
ds_read_b128 v[248:251],v17 offset:45056
s_waitcnt lgkmcnt(5)
v_mfma_f32_16x16x32_bf16 v[64:67],a[64:67],v[224:227],v[64:67]
buffer_load_dwordx4 v16,s[20:23],s65 offen offset:2048 sc1 lds
v_mfma_f32_16x16x32_bf16 v[72:75],a[192:195],v[224:227],v[72:75]
ds_read_b128 v[252:255],v17 offset:47104
v_mfma_f32_16x16x32_bf16 v[64:67],a[68:71],v[228:231],v[64:67]
s_xor_b32 m0,s72,1024
v_mfma_f32_16x16x32_bf16 v[72:75],a[196:199],v[228:231],v[72:75]
ds_read_b128 v[224:227],v17 offset:49152
s_add_u32 s65,s89,0
s_waitcnt lgkmcnt(5)
v_mfma_f32_16x16x32_bf16 v[64:67],a[72:75],v[232:235],v[64:67]
v_mfma_f32_16x16x32_bf16 v[72:75],a[200:203],v[232:235],v[72:75]
ds_read_b128 v[228:231],v17 offset:51200
buffer_load_dwordx4 v16,s[20:23],s65 offen offset:0 sc1 lds
v_mfma_f32_16x16x32_bf16 v[64:67],a[76:79],v[236:239],v[64:67]
v_mfma_f32_16x16x32_bf16 v[72:75],a[204:207],v[236:239],v[72:75]
ds_read_b128 v[232:235],v17 offset:53248
s_waitcnt lgkmcnt(5)
v_mfma_f32_16x16x32_bf16 v[64:67],a[80:83],v[240:243],v[64:67]
buffer_load_dwordx4 v16,s[20:23],s65 offen offset:2048 sc1 lds
v_mfma_f32_16x16x32_bf16 v[72:75],a[208:211],v[240:243],v[72:75]
ds_read_b128 v[236:239],v17 offset:55296
s_xor_b32 m0,s72,17408
v_mfma_f32_16x16x32_bf16 v[64:67],a[84:87],v[244:247],v[64:67]
s_add_u32 s65,s89,32768
v_mfma_f32_16x16x32_bf16 v[72:75],a[212:215],v[244:247],v[72:75]
ds_read_b128 v[240:243],v17 offset:57344
s_waitcnt lgkmcnt(5)
v_mfma_f32_16x16x32_bf16 v[64:67],a[88:91],v[248:251],v[64:67]
buffer_load_dwordx4 v16,s[20:23],s65 offen offset:0 sc1 lds
v_mfma_f32_16x16x32_bf16 v[72:75],a[216:219],v[248:251],v[72:75]
ds_read_b128 v[244:247],v17 offset:59392
v_mfma_f32_16x16x32_bf16 v[64:67],a[92:95],v[252:255],v[64:67]
buffer_load_dwordx4 v16,s[20:23],s65 offen offset:2048 sc1 lds
v_mfma_f32_16x16x32_bf16 v[72:75],a[220:223],v[252:255],v[72:75]
ds_read_b128 v[248:251],v17 offset:61440
s_waitcnt lgkmcnt(5)
v_mfma_f32_16x16x32_bf16 v[64:67],a[96:99],v[224:227],v[64:67]
s_xor_b32 m0,s72,33792
v_mfma_f32_16x16x32_bf16 v[72:75],a[224:227],v[224:227],v[72:75]
ds_read_b128 v[252:255],v17 offset:63488
s_add_u32 s65,s89,65536
v_mfma_f32_16x16x32_bf16 v[64:67],a[100:103],v[228:231],v[64:67]
s_waitcnt vmcnt(14)
v_add_u32 v22,s71,-1
v_mfma_f32_16x16x32_bf16 v[72:75],a[228:231],v[228:231],v[72:75]
ds_read_b128 v[224:227],v17 offset:1024
s_waitcnt lgkmcnt(5)
v_mfma_f32_16x16x32_bf16 v[64:67],a[104:107],v[232:235],v[64:67]
buffer_store_dword v22,v23,s[20:23],s73 offen sc1
v_mfma_f32_16x16x32_bf16 v[72:75],a[232:235],v[232:235],v[72:75]
ds_read_b128 v[228:231],v17 offset:3072
s_add_u32 s92,s70,8388608
v_mfma_f32_16x16x32_bf16 v[64:67],a[108:111],v[236:239],v[64:67]
s_sub_u32 s93,s71,53
s_waitcnt vmcnt(13)
v_mfma_f32_16x16x32_bf16 v[72:75],a[236:239],v[236:239],v[72:75]
ds_read_b128 v[232:235],v17 offset:5120
s_waitcnt lgkmcnt(5)
v_mfma_f32_16x16x32_bf16 v[64:67],a[112:115],v[240:243],v[64:67]
s_cmp_lt_u32 s93,9
s_cselect_b32 s92,s92,0x7fff0000
v_mfma_f32_16x16x32_bf16 v[72:75],a[240:243],v[240:243],v[72:75]
ds_read_b128 v[236:239],v17 offset:7168
ds_read_b64 v[120:121],v40 offset:0
v_mfma_f32_16x16x32_bf16 v[64:67],a[116:119],v[244:247],v[64:67]
ds_read_b64 v[122:123],v41 offset:0
ds_read_b64 v[124:125],v40 offset:1024
v_mfma_f32_16x16x32_bf16 v[72:75],a[244:247],v[244:247],v[72:75]
ds_read_b128 v[240:243],v17 offset:9216
s_waitcnt lgkmcnt(8)
v_mfma_f32_16x16x32_bf16 v[64:67],a[120:123],v[248:251],v[64:67]
ds_read_b64 v[126:127],v41 offset:1024
buffer_load_dwordx4 v16,s[20:23],s65 offen offset:0 sc1 lds
v_mfma_f32_16x16x32_bf16 v[72:75],a[248:251],v[248:251],v[72:75]
ds_read_b128 v[244:247],v17 offset:11264
buffer_load_dwordx4 v16,s[20:23],s65 offen offset:2048 sc1 lds
v_mfma_f32_16x16x32_bf16 v[64:67],a[124:127],v[252:255],v[64:67]
buffer_load_dword v2,v21,s[20:23],s87 offen sc1
v_mfma_f32_16x16x32_bf16 v[72:75],a[252:255],v[252:255],v[72:75]
ds_read_b128 v[248:251],v17 offset:13312
s_waitcnt lgkmcnt(9)
v_mfma_f32_16x16x32_bf16 v[68:71],a[0:3],v[224:227],0
s_add_u32 s96,s71,2
s_xor_b32 m0,s72,50176
v_mfma_f32_16x16x32_bf16 v[76:79],a[128:131],v[224:227],0
ds_read_b128 v[252:255],v17 offset:15360
s_add_u32 s65,s89,98304
v_mfma_f32_16x16x32_bf16 v[68:71],a[4:7],v[228:231],v[68:71]
s_cmp_gt_u32 s96,56
s_addc_u32 s96,s96,0
v_mfma_f32_16x16x32_bf16 v[76:79],a[132:135],v[228:231],v[76:79]
ds_read_b128 v[224:227],v17 offset:17408
s_waitcnt lgkmcnt(9)
v_mfma_f32_16x16x32_bf16 v[68:71],a[8:11],v[232:235],v[68:71]
s_waitcnt lgkmcnt(4)
v_lshlrev_b32 v88,16,v120
v_mfma_f32_16x16x32_bf16 v[76:79],a[136:139],v[232:235],v[76:79]
ds_read_b128 v[228:231],v17 offset:19456
v_and_b32 v89,s80,v120
v_mfma_f32_16x16x32_bf16 v[68:71],a[12:15],v[236:239],v[68:71]
buffer_store_dwordx4 v[48:51],v18,s[20:23],s92 offen offset:0 sc1
v_mfma_f32_16x16x32_bf16 v[76:79],a[140:143],v[236:239],v[76:79]
ds_read_b128 v[232:235],v17 offset:21504
s_waitcnt lgkmcnt(5)
v_mfma_f32_16x16x32_bf16 v[68:71],a[16:19],v[240:243],v[68:71]
buffer_store_dwordx4 v[48:51],v18,s[20:23],s92 offen offset:1024 sc1
v_mfma_f32_16x16x32_bf16 v[76:79],a[144:147],v[240:243],v[76:79]
ds_read_b128 v[236:239],v17 offset:23552
v_lshlrev_b32 v90,16,v121
v_mfma_f32_16x16x32_bf16 v[68:71],a[20:23],v[244:247],v[68:71]
buffer_store_dwordx4 v[48:51],v24,s[20:23],s92 offen sc1
v_mfma_f32_16x16x32_bf16 v[76:79],a[148:151],v[244:247],v[76:79]
ds_read_b128 v[240:243],v17 offset:25600
s_waitcnt lgkmcnt(5)
v_mfma_f32_16x16x32_bf16 v[68:71],a[24:27],v[248:251],v[68:71]
v_and_b32 v91,s80,v121
v_lshlrev_b32 v92,16,v122
v_mfma_f32_16x16x32_bf16 v[76:79],a[152:155],v[248:251],v[76:79]
ds_read_b128 v[244:247],v17 offset:27648
v_and_b32 v93,s80,v122
v_mfma_f32_16x16x32_bf16 v[68:71],a[28:31],v[252:255],v[68:71]
v_lshlrev_b32 v94,16,v123
v_and_b32 v95,s80,v123
v_mfma_f32_16x16x32_bf16 v[76:79],a[156:159],v[252:255],v[76:79]
ds_read_b128 v[248:251],v17 offset:29696
s_waitcnt lgkmcnt(5)
v_mfma_f32_16x16x32_bf16 v[68:71],a[32:35],v[224:227],v[68:71]
v_add_f32 v88,v64,v88
v_add_f32 v89,v65,v89
v_mfma_f32_16x16x32_bf16 v[76:79],a[160:163],v[224:227],v[76:79]
ds_read_b128 v[252:255],v17 offset:31744
v_add_f32 v90,v66,v90
v_mfma_f32_16x16x32_bf16 v[68:71],a[36:39],v[228:231],v[68:71]
v_add_f32 v91,v67,v91
v_add_f32 v92,v72,v92
v_mfma_f32_16x16x32_bf16 v[76:79],a[164:167],v[228:231],v[76:79]
ds_read_b128 v[224:227],v17 offset:33792
s_waitcnt lgkmcnt(5)
v_mfma_f32_16x16x32_bf16 v[68:71],a[40:43],v[232:235],v[68:71]
v_add_f32 v93,v73,v93
v_add_f32 v94,v74,v94
v_mfma_f32_16x16x32_bf16 v[76:79],a[168:171],v[232:235],v[76:79]
ds_read_b128 v[228:231],v17 offset:35840
v_add_f32 v95,v75,v95
v_mfma_f32_16x16x32_bf16 v[68:71],a[44:47],v[236:239],v[68:71]
v_cvt_pk_bf16_f32 v96,v88,v89
v_cvt_pk_bf16_f32 v97,v90,v91
v_mfma_f32_16x16x32_bf16 v[76:79],a[172:175],v[236:239],v[76:79]
ds_read_b128 v[232:235],v17 offset:37888
s_waitcnt lgkmcnt(5)
v_mfma_f32_16x16x32_bf16 v[68:71],a[48:51],v[240:243],v[68:71]
v_cvt_pk_bf16_f32 v98,v92,v93
v_cvt_pk_bf16_f32 v99,v94,v95
v_mfma_f32_16x16x32_bf16 v[76:79],a[176:179],v[240:243],v[76:79]
ds_read_b128 v[236:239],v17 offset:39936
v_max_u32 v96,1,v96
v_mfma_f32_16x16x32_bf16 v[68:71],a[52:55],v[244:247],v[68:71]
buffer_store_dwordx4 v[96:99],v18,s[20:23],s70 offen offset:0 sc1
v_mfma_f32_16x16x32_bf16 v[76:79],a[180:183],v[244:247],v[76:79]
ds_read_b128 v[240:243],v17 offset:41984
s_waitcnt lgkmcnt(5)
v_mfma_f32_16x16x32_bf16 v[68:71],a[56:59],v[248:251],v[68:71]
v_lshlrev_b32 v88,16,v96
v_and_b32 v89,s80,v96
v_mfma_f32_16x16x32_bf16 v[76:79],a[184:187],v[248:251],v[76:79]
ds_read_b128 v[244:247],v17 offset:44032
v_lshlrev_b32 v90,16,v97
v_mfma_f32_16x16x32_bf16 v[68:71],a[60:63],v[252:255],v[68:71]
v_and_b32 v91,s80,v97
v_lshlrev_b32 v92,16,v98
v_mfma_f32_16x16x32_bf16 v[76:79],a[188:191],v[252:255],v[76:79]
ds_read_b128 v[248:251],v17 offset:46080
s_waitcnt lgkmcnt(5)
v_mfma_f32_16x16x32_bf16 v[68:71],a[64:67],v[224:227],v[68:71]
v_and_b32 v93,s80,v98
v_lshlrev_b32 v94,16,v99
v_mfma_f32_16x16x32_bf16 v[76:79],a[192:195],v[224:227],v[76:79]
ds_read_b128 v[252:255],v17 offset:48128
v_and_b32 v95,s80,v99
v_mfma_f32_16x16x32_bf16 v[68:71],a[68:71],v[228:231],v[68:71]
v_add_f32 v108,v88,v89
v_mul_f32 v109,v88,v88
v_mfma_f32_16x16x32_bf16 v[76:79],a[196:199],v[228:231],v[76:79]
ds_read_b128 v[224:227],v17 offset:50176
s_waitcnt lgkmcnt(5)
v_mfma_f32_16x16x32_bf16 v[68:71],a[72:75],v[232:235],v[68:71]
v_add_f32 v100,v90,v91
v_mul_f32 v101,v89,v89
v_mfma_f32_16x16x32_bf16 v[76:79],a[200:203],v[232:235],v[76:79]
ds_read_b128 v[228:231],v17 offset:52224
v_fmac_f32 v109,v90,v90
v_mfma_f32_16x16x32_bf16 v[68:71],a[76:79],v[236:239],v[68:71]
v_fmac_f32 v101,v91,v91
v_fmac_f32 v109,v92,v92
v_mfma_f32_16x16x32_bf16 v[76:79],a[204:207],v[236:239],v[76:79]
ds_read_b128 v[232:235],v17 offset:54272
s_waitcnt lgkmcnt(5)
v_mfma_f32_16x16x32_bf16 v[68:71],a[80:83],v[240:243],v[68:71]
v_fmac_f32 v101,v93,v93
v_add_f32 v108,v108,v92
v_mfma_f32_16x16x32_bf16 v[76:79],a[208:211],v[240:243],v[76:79]
ds_read_b128 v[236:239],v17 offset:56320
v_add_f32 v100,v100,v93
v_mfma_f32_16x16x32_bf16 v[68:71],a[84:87],v[244:247],v[68:71]
v_fmac_f32 v109,v94,v94
v_fmac_f32 v101,v95,v95
v_mfma_f32_16x16x32_bf16 v[76:79],a[212:215],v[244:247],v[76:79]
ds_read_b128 v[240:243],v17 offset:58368
s_waitcnt lgkmcnt(5)
v_mfma_f32_16x16x32_bf16 v[68:71],a[88:91],v[248:251],v[68:71]
v_add_f32 v108,v108,v94
v_add_f32 v100,v100,v95
v_mfma_f32_16x16x32_bf16 v[76:79],a[216:219],v[248:251],v[76:79]
ds_read_b128 v[244:247],v17 offset:60416
v_add_f32 v108,v108,v100
v_mfma_f32_16x16x32_bf16 v[68:71],a[92:95],v[252:255],v[68:71]
v_add_f32 v109,v109,v101
v_mov_b32 v100,v108
v_mfma_f32_16x16x32_bf16 v[76:79],a[220:223],v[252:255],v[76:79]
ds_read_b128 v[248:251],v17 offset:62464
s_waitcnt lgkmcnt(5)
v_mfma_f32_16x16x32_bf16 v[68:71],a[96:99],v[224:227],v[68:71]
v_mov_b32 v101,v109
v_permlane16_swap_b32 v100,v108
v_mfma_f32_16x16x32_bf16 v[76:79],a[224:227],v[224:227],v[76:79]
ds_read_b128 v[252:255],v17 offset:64512
v_permlane16_swap_b32 v101,v109
v_mfma_f32_16x16x32_bf16 v[68:71],a[100:103],v[228:231],v[68:71]
v_add_f32 v108,v108,v100
v_add_f32 v109,v109,v101
v_mfma_f32_16x16x32_bf16 v[76:79],a[228:231],v[228:231],v[76:79]
v_mov_b32 v100,v108
s_waitcnt lgkmcnt(4)
v_mfma_f32_16x16x32_bf16 v[68:71],a[104:107],v[232:235],v[68:71]
s_waitcnt vmcnt(4)
v_mov_b32 v101,v109
v_mfma_f32_16x16x32_bf16 v[76:79],a[232:235],v[232:235],v[76:79]
v_cmp_gt_u32 vcc,s96,v2
s_mov_b32 s96,vcc_lo
v_mfma_f32_16x16x32_bf16 v[68:71],a[108:111],v[236:239],v[68:71]
v_mov_b32 v44,s96
ds_write_b32 v46,v44
v_mfma_f32_16x16x32_bf16 v[76:79],a[236:239],v[236:239],v[76:79]
v_permlane32_swap_b32 v100,v108
s_waitcnt lgkmcnt(3)
v_mfma_f32_16x16x32_bf16 v[68:71],a[112:115],v[240:243],v[68:71]
v_permlane32_swap_b32 v101,v109
v_add_f32 v108,v108,v100
v_mfma_f32_16x16x32_bf16 v[76:79],a[240:243],v[240:243],v[76:79]
v_add_f32 v109,v109,v101
v_lshlrev_b32 v32,16,v124
v_mfma_f32_16x16x32_bf16 v[68:71],a[116:119],v[244:247],v[68:71]
v_and_b32 v33,s80,v124
v_lshlrev_b32 v34,16,v125
v_mfma_f32_16x16x32_bf16 v[76:79],a[244:247],v[244:247],v[76:79]
v_and_b32 v35,s80,v125
s_waitcnt lgkmcnt(1)
v_mfma_f32_16x16x32_bf16 v[68:71],a[120:123],v[248:251],v[68:71]
v_lshlrev_b32 v36,16,v126
v_and_b32 v37,s80,v126
v_mfma_f32_16x16x32_bf16 v[76:79],a[248:251],v[248:251],v[76:79]
v_lshlrev_b32 v38,16,v127
v_and_b32 v39,s80,v127
v_mfma_f32_16x16x32_bf16 v[68:71],a[124:127],v[252:255],v[68:71]
buffer_load_dwordx4 v16,s[20:23],s65 offen offset:0 sc1 lds
v_mfma_f32_16x16x32_bf16 v[76:79],a[252:255],v[252:255],v[76:79]
buffer_load_dwordx4 v16,s[20:23],s65 offen offset:2048 sc1 lds
epi_208:
buffer_load_dword v29,v21,s[20:23],s87 offen sc1
s_nop 3
v_pk_add_f32 v[88:89],v[68:69],v[32:33]
v_pk_add_f32 v[90:91],v[70:71],v[34:35]
v_pk_add_f32 v[92:93],v[76:77],v[36:37]
v_pk_add_f32 v[94:95],v[78:79],v[38:39]
v_cvt_pk_bf16_f32 v96,v88,v89
v_cvt_pk_bf16_f32 v97,v90,v91
v_cvt_pk_bf16_f32 v98,v92,v93
v_cvt_pk_bf16_f32 v99,v94,v95
v_max_u32 v96,1,v96
buffer_store_dwordx4 v[96:99],v18,s[20:23],s70 offen offset:1024 sc1
v_lshlrev_b32 v88,16,v96
v_and_b32 v89,s80,v96
v_lshlrev_b32 v90,16,v97
v_and_b32 v91,s80,v97
v_lshlrev_b32 v92,16,v98
v_and_b32 v93,s80,v98
v_lshlrev_b32 v94,16,v99
v_and_b32 v95,s80,v99
v_pk_mul_f32 v[102:103],v[88:89],v[88:89]
v_pk_add_f32 v[100:101],v[88:89],v[90:91]
v_pk_mul_f32 v[106:107],v[90:91],v[90:91]
v_pk_add_f32 v[104:105],v[92:93],v[94:95]
v_pk_fma_f32 v[102:103],v[92:93],v[92:93],v[102:103]
v_pk_fma_f32 v[106:107],v[94:95],v[94:95],v[106:107]
v_pk_add_f32 v[100:101],v[100:101],v[104:105]
v_pk_add_f32 v[102:103],v[102:103],v[106:107]
v_add_f32 v110,v100,v101
v_add_f32 v111,v102,v103
v_mov_b32 v100,v110
v_mov_b32 v101,v111
s_nop 0
v_permlane16_swap_b32 v100,v110
v_permlane16_swap_b32 v101,v111
v_add_f32 v110,v110,v100
v_add_f32 v111,v111,v101
v_mov_b32 v100,v110
v_mov_b32 v101,v111
s_nop 0
v_permlane32_swap_b32 v100,v110
v_permlane32_swap_b32 v101,v111
v_add_f32 v110,v110,v100
v_add_f32 v111,v111,v101
v_max_u32 v109,1,v109
buffer_store_dwordx4 v[108:111],v24,s[20:23],s70 offen sc1
v_xor_b32 v19,0x2000,v19
v_xor_b32 v20,0x2000,v20
s_add_u32 s78,s78,2097152
s_cmp_gt_u32 s71,56
s_cselect_b32 s65,s73,0x7fff0000
v_mov_b32 v22,s71
buffer_store_dword v22,v23,s[20:23],s65 offen sc1
v_xor_b32 v17,0x10000,v17
v_xor_b32 v45,16,v45
v_xor_b32 v46,16,v46
s_xor_b32 s72,s72,0x10000
s_add_u32 s70,s70,2097152
s_xor_b32 s70,s70,0x2000
s_add_u32 s71,s71,1
s_cmp_le_u32 s71,65
s_cbranch_scc1 seg_206
s_endpgm
retry_205:
s_sub_u32 s90,s90,64
s_cmp_lt_i32 s90,0
s_cbranch_scc1 giveup_170
s_mov_b32 s83,1
s_waitcnt vmcnt(0) lgkmcnt(0)
s_barrier
s_branch seg_206
r_at_190:
v_mov_b32 v128,0
v_mov_b32 v129,0
v_mov_b32 v130,0
v_mov_b32 v131,0
v_and_b32 v21,1,v1
v_mul_u32_u24 v21,896,v21
s_mov_b32 s65,21052032
s_mov_b32 s66,1792
pl_215:
buffer_load_dword v22,v21,s[20:23],s65 offen sc1
s_waitcnt vmcnt(0)
v_cmp_gt_u32 vcc,s66,v22
s_cbranch_vccz pok_216
s_sleep 1
s_sub_u32 s90,s90,1
s_cmp_gt_i32 s90,0
s_cbranch_scc1 pl_215
pok_216:
s_cmp_ge_u32 s50,2
s_cbranch_scc1 r_ln_189
s_lshl_b32 s41,s41,1
s_add_u32 s41,s41,s50
v_and_b32 v21,3,v1
v_lshlrev_b32 v21,7,v21
s_lshl_b32 s65,s41,2
s_add_u32 s65,s65,s63
pl_217:
buffer_load_dword v22,v21,s[20:23],s65 offen sc1
s_waitcnt vmcnt(0)
v_cmp_gt_u32 vcc,16,v22
s_cbranch_vccz pok_218
s_sleep 1
s_sub_u32 s90,s90,1
s_cmp_gt_i32 s90,0
s_cbranch_scc1 pl_217
pok_218:
v_mov_b32 v21,s56
v_lshlrev_b32 v21,2,v21
s_mov_b32 s66,144
pl_219:
buffer_load_dword v22,v21,s[44:47],36 offen sc1
s_waitcnt vmcnt(0)
v_cmp_gt_u32 vcc,s66,v22
s_cbranch_vccz pok_220
s_sleep 1
s_sub_u32 s90,s90,1
s_cmp_gt_i32 s90,0
s_cbranch_scc1 pl_219
pok_220:
s_lshl_b32 s42,s41,14
s_lshr_b32 s43,s41,1
s_lshl_b32 s43,s43,14
s_and_b32 s64,s41,1
s_lshl_b32 s64,s64,12
s_add_u32 s43,s43,s64
s_add_u32 s43,s43,1572864
s_lshr_b32 s64,s41,3
s_lshl_b32 s64,s64,7
s_and_b32 s65,s41,7
s_lshl_b32 s65,s65,2
s_add_u32 s73,s64,s65
s_add_u32 s73,s73,s63
s_add_u32 s73,s73,1024
v_lshrrev_b32 v6,3,v3
v_and_b32 v7,7,v3
v_lshl_add_u32 v6,v6,4,v7
v_lshlrev_b32 v6,4,v6
v_and_b32 v7,1,v4
v_lshl_add_u32 v6,v7,3,v6
v_lshrrev_b32 v8,2,v3
v_and_b32 v9,3,v3
v_lshl_add_u32 v8,v8,3,v9
s_mov_b32 s80,0x3e0293ee
v_mov_b32 v97,0xff800000
v_lshlrev_b32 v98,3,v4
v_sub_u32 v98,v98,v8
v_cmp_lt_u32 s[48:49],1,v4
v_cmp_ge_i32 s[4:5],-7,v98
v_cmp_ge_i32 s[6:7],-6,v98
v_cmp_ge_i32 s[8:9],-5,v98
v_cmp_ge_i32 s[10:11],-4,v98
v_cmp_ge_i32 s[12:13],-3,v98
v_cmp_ge_i32 s[14:15],-2,v98
v_cmp_ge_i32 s[16:17],-1,v98
v_cmp_ge_i32 s[18:19],0,v98
v_cmp_ge_i32 s[32:33],1,v98
v_cmp_ge_i32 s[34:35],2,v98
v_cmp_ge_i32 s[36:37],3,v98
v_cmp_ge_i32 s[38:39],4,v98
s_add_u32 s64,s79,0
s_lshl_b32 s74,s64,21
s_lshl_b32 s64,s64,13
s_and_b32 s64,s64,0x2000
s_xor_b32 s64,s64,s61
s_add_u32 s74,s74,s64
s_add_u32 s74,s74,29360128
s_add_u32 s66,s74,s43
kp_221:
buffer_load_dwordx4 v[136:139],v16,s[20:23],s66 offen offset:0 sc1
buffer_load_dwordx4 v[140:143],v16,s[20:23],s66 offen offset:1024 sc1
buffer_load_dwordx4 v[144:147],v16,s[20:23],s66 offen offset:2048 sc1
buffer_load_dwordx4 v[148:151],v16,s[20:23],s66 offen offset:3072 sc1
s_waitcnt vmcnt(0)
kck_223:
v_min3_u32 v22,v136,v140,v144
v_min_u32 v22,v22,v148
v_cmp_eq_u32 vcc,0,v22
s_cbranch_vccz kok_222
s_sleep 1
s_sub_u32 s90,s90,1
s_cmp_gt_i32 s90,0
s_cbranch_scc1 kp_221
kok_222:
s_add_u32 s64,s79,0
s_lshl_b32 s75,s64,21
s_lshl_b32 s64,s64,13
s_and_b32 s64,s64,0x2000
s_xor_b32 s64,s64,s61
s_add_u32 s75,s75,s64
s_add_u32 s75,s75,29360128
s_add_u32 s64,s79,0
s_lshl_b32 s76,s64,21
s_lshl_b32 s64,s64,13
s_and_b32 s64,s64,0x2000
s_xor_b32 s64,s64,s62
s_add_u32 s76,s76,s64
s_add_u32 s76,s76,29360128
s_add_u32 s75,s75,s42
s_add_u32 s76,s76,s42
s_add_u32 s65,s75,524288
buffer_load_dwordx4 a[32:35],v16,s[20:23],s65 offen offset:0 sc1
buffer_load_dwordx4 a[36:39],v16,s[20:23],s65 offen offset:1024 sc1
buffer_load_dwordx4 a[40:43],v16,s[20:23],s65 offen offset:2048 sc1
buffer_load_dwordx4 a[44:47],v16,s[20:23],s65 offen offset:3072 sc1
s_add_u32 s65,s75,528384
buffer_load_dwordx4 a[48:51],v16,s[20:23],s65 offen offset:0 sc1
buffer_load_dwordx4 a[52:55],v16,s[20:23],s65 offen offset:1024 sc1
buffer_load_dwordx4 a[56:59],v16,s[20:23],s65 offen offset:2048 sc1
buffer_load_dwordx4 a[60:63],v16,s[20:23],s65 offen offset:3072 sc1
s_add_u32 s65,s76,0
buffer_load_dwordx4 a[0:3],v16,s[20:23],s65 offen offset:0 sc1
buffer_load_dwordx4 a[4:7],v16,s[20:23],s65 offen offset:1024 sc1
buffer_load_dwordx4 a[8:11],v16,s[20:23],s65 offen offset:2048 sc1
buffer_load_dwordx4 a[12:15],v16,s[20:23],s65 offen offset:3072 sc1
s_add_u32 s65,s76,4096
buffer_load_dwordx4 a[16:19],v16,s[20:23],s65 offen offset:0 sc1
buffer_load_dwordx4 a[20:23],v16,s[20:23],s65 offen offset:1024 sc1
buffer_load_dwordx4 a[24:27],v16,s[20:23],s65 offen offset:2048 sc1
buffer_load_dwordx4 a[28:31],v16,s[20:23],s65 offen offset:3072 sc1
s_waitcnt vmcnt(0)
aloop_224:
s_add_u32 s64,s79,0
s_lshl_b32 s74,s64,21
s_lshl_b32 s64,s64,13
s_and_b32 s64,s64,0x2000
s_xor_b32 s64,s64,s61
s_add_u32 s74,s74,s64
s_add_u32 s74,s74,29360128
s_add_u32 s64,s79,0
s_lshl_b32 s70,s64,21
s_lshl_b32 s64,s64,13
s_and_b32 s64,s64,0x2000
s_xor_b32 s64,s64,s62
s_add_u32 s70,s70,s64
s_add_u32 s70,s70,29360128
s_add_u32 s66,s74,s43
s_waitcnt vmcnt(24)
v_add_u32 v22,s71,-1
buffer_store_dword v22,v23,s[20:23],s73 offen sc1
s_branch kck_227
kp_225:
buffer_load_dwordx4 v[136:139],v16,s[20:23],s66 offen offset:0 sc1
buffer_load_dwordx4 v[140:143],v16,s[20:23],s66 offen offset:1024 sc1
buffer_load_dwordx4 v[144:147],v16,s[20:23],s66 offen offset:2048 sc1
buffer_load_dwordx4 v[148:151],v16,s[20:23],s66 offen offset:3072 sc1
s_waitcnt vmcnt(0)
kck_227:
v_min3_u32 v22,v136,v140,v144
v_min_u32 v22,v22,v148
v_cmp_eq_u32 vcc,0,v22
s_cbranch_vccz kok_226
s_sleep 1
s_sub_u32 s90,s90,1
s_cmp_gt_i32 s90,0
s_cbranch_scc1 kp_225
kok_226:
buffer_load_dwordx2 v[100:101],v6,s[20:23],s66 offen offset:0 sc1
buffer_load_dwordx2 v[102:103],v6,s[20:23],s66 offen offset:512 sc1
buffer_load_dwordx2 v[104:105],v6,s[20:23],s66 offen offset:1024 sc1
buffer_load_dwordx2 v[106:107],v6,s[20:23],s66 offen offset:1536 sc1
buffer_load_dwordx2 v[108:109],v6,s[20:23],s66 offen offset:2048 sc1
buffer_load_dwordx2 v[110:111],v6,s[20:23],s66 offen offset:2560 sc1
buffer_load_dwordx2 v[112:113],v6,s[20:23],s66 offen offset:3072 sc1
buffer_load_dwordx2 v[114:115],v6,s[20:23],s66 offen offset:3584 sc1
s_add_u32 s74,s74,s42
s_add_u32 s65,s74,1048576
buffer_load_dwordx4 a[64:67],v16,s[20:23],s65 offen offset:0 sc1
buffer_load_dwordx4 a[68:71],v16,s[20:23],s65 offen offset:1024 sc1
buffer_load_dwordx4 a[72:75],v16,s[20:23],s65 offen offset:2048 sc1
buffer_load_dwordx4 a[76:79],v16,s[20:23],s65 offen offset:3072 sc1
s_add_u32 s65,s74,1052672
buffer_load_dwordx4 a[80:83],v16,s[20:23],s65 offen offset:0 sc1
buffer_load_dwordx4 a[84:87],v16,s[20:23],s65 offen offset:1024 sc1
buffer_load_dwordx4 a[88:91],v16,s[20:23],s65 offen offset:2048 sc1
buffer_load_dwordx4 a[92:95],v16,s[20:23],s65 offen offset:3072 sc1
s_waitcnt vmcnt(25)
v_mfma_f32_16x16x32_bf16 v[168:171],a[32:35],a[0:3],0
v_mfma_f32_16x16x32_bf16 v[172:175],a[36:39],a[0:3],0
v_mfma_f32_16x16x32_bf16 v[176:179],v[136:139],a[0:3],0
v_mfma_f32_16x16x32_bf16 v[180:183],a[32:35],a[4:7],0
v_mfma_f32_16x16x32_bf16 v[184:187],a[36:39],a[4:7],0
v_mfma_f32_16x16x32_bf16 v[188:191],v[136:139],a[4:7],0
v_mfma_f32_16x16x32_bf16 v[168:171],a[40:43],a[8:11],v[168:171]
v_mfma_f32_16x16x32_bf16 v[172:175],a[44:47],a[8:11],v[172:175]
v_mfma_f32_16x16x32_bf16 v[176:179],v[140:143],a[8:11],v[176:179]
v_mfma_f32_16x16x32_bf16 v[180:183],a[40:43],a[12:15],v[180:183]
v_mfma_f32_16x16x32_bf16 v[184:187],a[44:47],a[12:15],v[184:187]
v_mfma_f32_16x16x32_bf16 v[188:191],v[140:143],a[12:15],v[188:191]
v_mfma_f32_16x16x32_bf16 v[168:171],a[48:51],a[16:19],v[168:171]
v_mfma_f32_16x16x32_bf16 v[172:175],a[52:55],a[16:19],v[172:175]
v_mfma_f32_16x16x32_bf16 v[176:179],v[144:147],a[16:19],v[176:179]
v_mfma_f32_16x16x32_bf16 v[180:183],a[48:51],a[20:23],v[180:183]
v_mfma_f32_16x16x32_bf16 v[184:187],a[52:55],a[20:23],v[184:187]
v_mfma_f32_16x16x32_bf16 v[188:191],v[144:147],a[20:23],v[188:191]
v_mfma_f32_16x16x32_bf16 v[168:171],a[56:59],a[24:27],v[168:171]
v_mfma_f32_16x16x32_bf16 v[172:175],a[60:63],a[24:27],v[172:175]
v_mfma_f32_16x16x32_bf16 v[176:179],v[148:151],a[24:27],v[176:179]
v_mfma_f32_16x16x32_bf16 v[180:183],a[56:59],a[28:31],v[180:183]
v_mfma_f32_16x16x32_bf16 v[184:187],a[60:63],a[28:31],v[184:187]
v_mfma_f32_16x16x32_bf16 v[188:191],v[148:151],a[28:31],v[188:191]
s_nop 2
v_cndmask_b32 v168,v97,v168,s[18:19]
v_cndmask_b32 v169,v97,v169,s[16:17]
v_cndmask_b32 v170,v97,v170,s[14:15]
v_cndmask_b32 v171,v97,v171,s[12:13]
v_cndmask_b32 v172,v97,v172,s[10:11]
v_cndmask_b32 v173,v97,v173,s[8:9]
v_cndmask_b32 v174,v97,v174,s[6:7]
v_cndmask_b32 v175,v97,v175,s[4:5]
v_cndmask_b32 v176,v97,v176,s[48:49]
v_cndmask_b32 v177,v97,v177,s[48:49]
v_cndmask_b32 v178,v97,v178,s[48:49]
v_cndmask_b32 v179,v97,v179,s[48:49]
v_max3_f32 v24,v168,v169,v170
v_max3_f32 v24,v24,v171,v172
v_max3_f32 v24,v24,v173,v174
v_max3_f32 v24,v24,v175,v176
v_max3_f32 v24,v24,v177,v178
v_max_f32 v24,v24,v179
v_mov_b32 v25,v24
s_nop 1
v_permlane16_swap_b32 v25,v24
v_max_f32 v24,v24,v25
v_mov_b32 v25,v24
s_nop 1
v_permlane32_swap_b32 v25,v24
v_max_f32 v24,v24,v25
v_mul_f32 v24,s80,v24
v_fma_f32 v168,v168,s80,-v24
v_fma_f32 v169,v169,s80,-v24
v_fma_f32 v170,v170,s80,-v24
v_fma_f32 v171,v171,s80,-v24
v_fma_f32 v172,v172,s80,-v24
v_fma_f32 v173,v173,s80,-v24
v_fma_f32 v174,v174,s80,-v24
v_fma_f32 v175,v175,s80,-v24
v_fma_f32 v176,v176,s80,-v24
v_fma_f32 v177,v177,s80,-v24
v_fma_f32 v178,v178,s80,-v24
v_fma_f32 v179,v179,s80,-v24
v_exp_f32 v168,v168
v_exp_f32 v169,v169
v_exp_f32 v170,v170
v_exp_f32 v171,v171
v_exp_f32 v172,v172
v_exp_f32 v173,v173
v_exp_f32 v174,v174
v_exp_f32 v175,v175
v_exp_f32 v176,v176
v_exp_f32 v177,v177
v_exp_f32 v178,v178
v_exp_f32 v179,v179
v_add_f32 v26,v168,v169
v_add_f32 v27,v170,v171
v_add_f32 v26,v26,v172
v_add_f32 v27,v27,v173
v_add_f32 v26,v26,v174
v_add_f32 v27,v27,v175
v_add_f32 v26,v26,v176
v_add_f32 v27,v27,v177
v_add_f32 v26,v26,v178
v_add_f32 v27,v27,v179
v_add_f32 v26,v26,v27
v_mov_b32 v25,v26
s_nop 1
v_permlane16_swap_b32 v25,v26
v_add_f32 v26,v26,v25
v_mov_b32 v25,v26
s_nop 1
v_permlane32_swap_b32 v25,v26
v_add_f32 v26,v26,v25
v_rcp_f32 v27,v26
s_nop 0
v_mul_f32 v168,v168,v27
v_mul_f32 v169,v169,v27
v_mul_f32 v170,v170,v27
v_mul_f32 v171,v171,v27
v_mul_f32 v172,v172,v27
v_mul_f32 v173,v173,v27
v_mul_f32 v174,v174,v27
v_mul_f32 v175,v175,v27
v_mul_f32 v176,v176,v27
v_mul_f32 v177,v177,v27
v_mul_f32 v178,v178,v27
v_mul_f32 v179,v179,v27
v_cvt_pk_bf16_f32 v48,v168,v169
v_cvt_pk_bf16_f32 v49,v170,v171
v_cvt_pk_bf16_f32 v50,v172,v173
v_cvt_pk_bf16_f32 v51,v174,v175
v_cvt_pk_bf16_f32 v52,v176,v177
v_cvt_pk_bf16_f32 v53,v178,v179
v_cndmask_b32 v180,v97,v180,s[38:39]
v_cndmask_b32 v181,v97,v181,s[36:37]
v_cndmask_b32 v182,v97,v182,s[34:35]
v_cndmask_b32 v183,v97,v183,s[32:33]
v_cndmask_b32 v184,v97,v184,s[18:19]
v_cndmask_b32 v185,v97,v185,s[16:17]
v_cndmask_b32 v186,v97,v186,s[14:15]
v_cndmask_b32 v187,v97,v187,s[12:13]
v_cndmask_b32 v188,v97,v188,s[48:49]
v_cndmask_b32 v189,v97,v189,s[48:49]
v_cndmask_b32 v190,v97,v190,s[48:49]
v_cndmask_b32 v191,v97,v191,s[48:49]
v_max3_f32 v24,v180,v181,v182
v_max3_f32 v24,v24,v183,v184
v_max3_f32 v24,v24,v185,v186
v_max3_f32 v24,v24,v187,v188
v_max3_f32 v24,v24,v189,v190
v_max_f32 v24,v24,v191
v_mov_b32 v25,v24
s_nop 1
v_permlane16_swap_b32 v25,v24
v_max_f32 v24,v24,v25
v_mov_b32 v25,v24
s_nop 1
v_permlane32_swap_b32 v25,v24
v_max_f32 v24,v24,v25
v_mul_f32 v24,s80,v24
v_fma_f32 v180,v180,s80,-v24
v_fma_f32 v181,v181,s80,-v24
v_fma_f32 v182,v182,s80,-v24
v_fma_f32 v183,v183,s80,-v24
v_fma_f32 v184,v184,s80,-v24
v_fma_f32 v185,v185,s80,-v24
v_fma_f32 v186,v186,s80,-v24
v_fma_f32 v187,v187,s80,-v24
v_fma_f32 v188,v188,s80,-v24
v_fma_f32 v189,v189,s80,-v24
v_fma_f32 v190,v190,s80,-v24
v_fma_f32 v191,v191,s80,-v24
v_exp_f32 v180,v180
v_exp_f32 v181,v181
v_exp_f32 v182,v182
v_exp_f32 v183,v183
v_exp_f32 v184,v184
v_exp_f32 v185,v185
v_exp_f32 v186,v186
v_exp_f32 v187,v187
v_exp_f32 v188,v188
v_exp_f32 v189,v189
v_exp_f32 v190,v190
v_exp_f32 v191,v191
v_add_f32 v26,v180,v181
v_add_f32 v27,v182,v183
v_add_f32 v26,v26,v184
v_add_f32 v27,v27,v185
v_add_f32 v26,v26,v186
v_add_f32 v27,v27,v187
v_add_f32 v26,v26,v188
v_add_f32 v27,v27,v189
v_add_f32 v26,v26,v190
v_add_f32 v27,v27,v191
v_add_f32 v26,v26,v27
v_mov_b32 v25,v26
s_nop 1
v_permlane16_swap_b32 v25,v26
v_add_f32 v26,v26,v25
v_mov_b32 v25,v26
s_nop 1
v_permlane32_swap_b32 v25,v26
v_add_f32 v26,v26,v25
v_rcp_f32 v27,v26
s_nop 0
v_mul_f32 v180,v180,v27
v_mul_f32 v181,v181,v27
v_mul_f32 v182,v182,v27
v_mul_f32 v183,v183,v27
v_mul_f32 v184,v184,v27
v_mul_f32 v185,v185,v27
v_mul_f32 v186,v186,v27
v_mul_f32 v187,v187,v27
v_mul_f32 v188,v188,v27
v_mul_f32 v189,v189,v27
v_mul_f32 v190,v190,v27
v_mul_f32 v191,v191,v27
v_cvt_pk_bf16_f32 v56,v180,v181
v_cvt_pk_bf16_f32 v57,v182,v183
v_cvt_pk_bf16_f32 v58,v184,v185
v_cvt_pk_bf16_f32 v59,v186,v187
v_cvt_pk_bf16_f32 v60,v188,v189
v_cvt_pk_bf16_f32 v61,v190,v191
s_waitcnt vmcnt(0)
v_mfma_f32_16x16x32_bf16 v[192:195],a[64:67],v[48:51],0
v_mfma_f32_16x16x32_bf16 v[196:199],a[64:67],v[56:59],0
v_mfma_f32_16x16x32_bf16 v[200:203],a[68:71],v[48:51],0
v_mfma_f32_16x16x32_bf16 v[204:207],a[68:71],v[56:59],0
v_mfma_f32_16x16x32_bf16 v[208:211],a[72:75],v[48:51],0
v_mfma_f32_16x16x32_bf16 v[212:215],a[72:75],v[56:59],0
v_mfma_f32_16x16x32_bf16 v[216:219],a[76:79],v[48:51],0
v_mfma_f32_16x16x32_bf16 v[220:223],a[76:79],v[56:59],0
v_mfma_f32_16x16x32_bf16 v[224:227],a[80:83],v[48:51],0
v_mfma_f32_16x16x32_bf16 v[228:231],a[80:83],v[56:59],0
v_mfma_f32_16x16x32_bf16 v[232:235],a[84:87],v[48:51],0
v_mfma_f32_16x16x32_bf16 v[236:239],a[84:87],v[56:59],0
v_mfma_f32_16x16x32_bf16 v[240:243],a[88:91],v[48:51],0
v_mfma_f32_16x16x32_bf16 v[244:247],a[88:91],v[56:59],0
v_mfma_f32_16x16x32_bf16 v[248:251],a[92:95],v[48:51],0
v_mfma_f32_16x16x32_bf16 v[252:255],a[92:95],v[56:59],0
v_mfma_f32_16x16x16_bf16 v[192:195],v[100:101],v[52:53],v[192:195]
v_mfma_f32_16x16x16_bf16 v[196:199],v[100:101],v[60:61],v[196:199]
v_mfma_f32_16x16x16_bf16 v[200:203],v[102:103],v[52:53],v[200:203]
v_mfma_f32_16x16x16_bf16 v[204:207],v[102:103],v[60:61],v[204:207]
v_mfma_f32_16x16x16_bf16 v[208:211],v[104:105],v[52:53],v[208:211]
v_mfma_f32_16x16x16_bf16 v[212:215],v[104:105],v[60:61],v[212:215]
v_mfma_f32_16x16x16_bf16 v[216:219],v[106:107],v[52:53],v[216:219]
v_mfma_f32_16x16x16_bf16 v[220:223],v[106:107],v[60:61],v[220:223]
v_mfma_f32_16x16x16_bf16 v[224:227],v[108:109],v[52:53],v[224:227]
v_mfma_f32_16x16x16_bf16 v[228:231],v[108:109],v[60:61],v[228:231]
v_mfma_f32_16x16x16_bf16 v[232:235],v[110:111],v[52:53],v[232:235]
v_mfma_f32_16x16x16_bf16 v[236:239],v[110:111],v[60:61],v[236:239]
v_mfma_f32_16x16x16_bf16 v[240:243],v[112:113],v[52:53],v[240:243]
v_mfma_f32_16x16x16_bf16 v[244:247],v[112:113],v[60:61],v[244:247]
v_mfma_f32_16x16x16_bf16 v[248:251],v[114:115],v[52:53],v[248:251]
v_mfma_f32_16x16x16_bf16 v[252:255],v[114:115],v[60:61],v[252:255]
s_add_u32 s70,s70,s42
s_add_u32 s65,s70,524288
v_cvt_pk_bf16_f32 v64,v192,v193
v_cvt_pk_bf16_f32 v65,v194,v195
v_cvt_pk_bf16_f32 v66,v200,v201
v_cvt_pk_bf16_f32 v67,v202,v203
v_max_u32 v64,1,v64
buffer_store_dwordx4 v[64:67],v16,s[20:23],s65 offen offset:0 sc1
v_cvt_pk_bf16_f32 v68,v196,v197
v_cvt_pk_bf16_f32 v69,v198,v199
v_cvt_pk_bf16_f32 v70,v204,v205
v_cvt_pk_bf16_f32 v71,v206,v207
v_max_u32 v68,1,v68
buffer_store_dwordx4 v[68:71],v16,s[20:23],s65 offen offset:1024 sc1
v_cvt_pk_bf16_f32 v72,v208,v209
v_cvt_pk_bf16_f32 v73,v210,v211
v_cvt_pk_bf16_f32 v74,v216,v217
v_cvt_pk_bf16_f32 v75,v218,v219
v_max_u32 v72,1,v72
buffer_store_dwordx4 v[72:75],v16,s[20:23],s65 offen offset:2048 sc1
v_cvt_pk_bf16_f32 v76,v212,v213
v_cvt_pk_bf16_f32 v77,v214,v215
v_cvt_pk_bf16_f32 v78,v220,v221
v_cvt_pk_bf16_f32 v79,v222,v223
v_max_u32 v76,1,v76
buffer_store_dwordx4 v[76:79],v16,s[20:23],s65 offen offset:3072 sc1
s_add_u32 s65,s70,528384
v_cvt_pk_bf16_f32 v64,v224,v225
v_cvt_pk_bf16_f32 v65,v226,v227
v_cvt_pk_bf16_f32 v66,v232,v233
v_cvt_pk_bf16_f32 v67,v234,v235
v_max_u32 v64,1,v64
buffer_store_dwordx4 v[64:67],v16,s[20:23],s65 offen offset:0 sc1
v_cvt_pk_bf16_f32 v68,v228,v229
v_cvt_pk_bf16_f32 v69,v230,v231
v_cvt_pk_bf16_f32 v70,v236,v237
v_cvt_pk_bf16_f32 v71,v238,v239
v_max_u32 v68,1,v68
buffer_store_dwordx4 v[68:71],v16,s[20:23],s65 offen offset:1024 sc1
v_cvt_pk_bf16_f32 v72,v240,v241
v_cvt_pk_bf16_f32 v73,v242,v243
v_cvt_pk_bf16_f32 v74,v248,v249
v_cvt_pk_bf16_f32 v75,v250,v251
v_max_u32 v72,1,v72
buffer_store_dwordx4 v[72:75],v16,s[20:23],s65 offen offset:2048 sc1
v_cvt_pk_bf16_f32 v76,v244,v245
v_cvt_pk_bf16_f32 v77,v246,v247
v_cvt_pk_bf16_f32 v78,v252,v253
v_cvt_pk_bf16_f32 v79,v254,v255
v_max_u32 v76,1,v76
buffer_store_dwordx4 v[76:79],v16,s[20:23],s65 offen offset:3072 sc1
s_cmp_le_u32 s71,56
s_cbranch_scc1 alater_228
v_mov_b32 v22,s71
buffer_store_dword v22,v23,s[20:23],s73 offen sc1
alater_228:
s_add_u32 s64,s79,1
s_lshl_b32 s75,s64,21
s_lshl_b32 s64,s64,13
s_and_b32 s64,s64,0x2000
s_xor_b32 s64,s64,s61
s_add_u32 s75,s75,s64
s_add_u32 s75,s75,29360128
s_add_u32 s64,s79,1
s_lshl_b32 s76,s64,21
s_lshl_b32 s64,s64,13
s_and_b32 s64,s64,0x2000
s_xor_b32 s64,s64,s62
s_add_u32 s76,s76,s64
s_add_u32 s76,s76,29360128
s_add_u32 s66,s75,s43
buffer_load_dwordx4 v[136:139],v16,s[20:23],s66 offen offset:0 sc1
buffer_load_dwordx4 v[140:143],v16,s[20:23],s66 offen offset:1024 sc1
buffer_load_dwordx4 v[144:147],v16,s[20:23],s66 offen offset:2048 sc1
buffer_load_dwordx4 v[148:151],v16,s[20:23],s66 offen offset:3072 sc1
s_add_u32 s75,s75,s42
s_add_u32 s76,s76,s42
s_add_u32 s65,s75,524288
buffer_load_dwordx4 a[32:35],v16,s[20:23],s65 offen offset:0 sc1
buffer_load_dwordx4 a[36:39],v16,s[20:23],s65 offen offset:1024 sc1
buffer_load_dwordx4 a[40:43],v16,s[20:23],s65 offen offset:2048 sc1
buffer_load_dwordx4 a[44:47],v16,s[20:23],s65 offen offset:3072 sc1
s_add_u32 s65,s75,528384
buffer_load_dwordx4 a[48:51],v16,s[20:23],s65 offen offset:0 sc1
buffer_load_dwordx4 a[52:55],v16,s[20:23],s65 offen offset:1024 sc1
buffer_load_dwordx4 a[56:59],v16,s[20:23],s65 offen offset:2048 sc1
buffer_load_dwordx4 a[60:63],v16,s[20:23],s65 offen offset:3072 sc1
s_add_u32 s65,s76,0
buffer_load_dwordx4 a[0:3],v16,s[20:23],s65 offen offset:0 sc1
buffer_load_dwordx4 a[4:7],v16,s[20:23],s65 offen offset:1024 sc1
buffer_load_dwordx4 a[8:11],v16,s[20:23],s65 offen offset:2048 sc1
buffer_load_dwordx4 a[12:15],v16,s[20:23],s65 offen offset:3072 sc1
s_add_u32 s65,s76,4096
buffer_load_dwordx4 a[16:19],v16,s[20:23],s65 offen offset:0 sc1
buffer_load_dwordx4 a[20:23],v16,s[20:23],s65 offen offset:1024 sc1
buffer_load_dwordx4 a[24:27],v16,s[20:23],s65 offen offset:2048 sc1
buffer_load_dwordx4 a[28:31],v16,s[20:23],s65 offen offset:3072 sc1
s_add_u32 s65,s70,8388608
s_sub_u32 s64,s71,53
s_cmp_lt_u32 s64,8
s_cselect_b32 s65,s65,0x7fff0000
s_add_u32 s65,s65,524288
s_add_u32 s66,s65,4096
buffer_store_dwordx4 v[128:131],v16,s[20:23],s65 offen offset:0 sc1
buffer_store_dwordx4 v[128:131],v16,s[20:23],s65 offen offset:1024 sc1
buffer_store_dwordx4 v[128:131],v16,s[20:23],s65 offen offset:2048 sc1
buffer_store_dwordx4 v[128:131],v16,s[20:23],s65 offen offset:3072 sc1
buffer_store_dwordx4 v[128:131],v16,s[20:23],s66 offen offset:0 sc1
buffer_store_dwordx4 v[128:131],v16,s[20:23],s66 offen offset:1024 sc1
buffer_store_dwordx4 v[128:131],v16,s[20:23],s66 offen offset:2048 sc1
buffer_store_dwordx4 v[128:131],v16,s[20:23],s66 offen offset:3072 sc1
s_add_u32 s79,s79,1
s_add_u32 s71,s71,1
s_cmp_lt_u32 s79,64
s_cbranch_scc1 aloop_224
s_endpgm
r_ln_189:
s_lshl_b32 s41,s59,1
s_add_u32 s41,s41,s50
s_sub_u32 s41,s41,2
v_lshlrev_b32 v5,5,v1
s_mov_b32 s64,16384
buffer_load_dwordx4 v[40:43],v5,s[20:23],s64 offen offset:0 sc1
buffer_load_dwordx4 v[44:47],v5,s[20:23],s64 offen offset:16 sc1
buffer_load_dwordx4 v[48:51],v5,s[20:23],s64 offen offset:2048 sc1
buffer_load_dwordx4 v[52:55],v5,s[20:23],s64 offen offset:2064 sc1
s_mov_b32 s64,12288
buffer_load_dwordx4 v[56:59],v5,s[20:23],s64 offen offset:0 sc1
buffer_load_dwordx4 v[60:63],v5,s[20:23],s64 offen offset:16 sc1
buffer_load_dwordx4 v[64:67],v5,s[20:23],s64 offen offset:2048 sc1
buffer_load_dwordx4 v[68:71],v5,s[20:23],s64 offen offset:2064 sc1
s_lshr_b32 s64,s41,2
s_add_u32 s64,s64,64
s_lshl_b32 s64,s64,14
s_and_b32 s65,s41,3
s_lshl_b32 s65,s65,11
s_add_u32 s64,s64,s65
v_add_u32 v19,s64,v16
v_add_u32 v19,786432,v19
s_lshl_b32 s65,s41,7
v_add_u32 v5,s65,v16
v_and_b32 v5,2047,v5
v_add_u32 v17,s64,v5
v_xor_b32 v18,1024,v17
v_add_u32 v24,0xfff00000,v17
v_xor_b32 v25,1024,v24
v_lshlrev_b32 v21,2,v1
s_and_b32 s64,s41,4
s_lshl_b32 s64,s64,6
s_add_u32 s74,s63,s64
s_add_u32 s74,s74,2048
s_mov_b32 s83,1
s_lshl_b32 s73,s41,2
s_add_u32 s73,s73,s63
s_add_u32 s73,s73,2560
s_waitcnt vmcnt(0)
v_add_f32 v40,1.0,v40
v_add_f32 v41,1.0,v41
v_add_f32 v42,1.0,v42
v_add_f32 v43,1.0,v43
v_add_f32 v44,1.0,v44
v_add_f32 v45,1.0,v45
v_add_f32 v46,1.0,v46
v_add_f32 v47,1.0,v47
v_add_f32 v48,1.0,v48
v_add_f32 v49,1.0,v49
v_add_f32 v50,1.0,v50
v_add_f32 v51,1.0,v51
v_add_f32 v52,1.0,v52
v_add_f32 v53,1.0,v53
v_add_f32 v54,1.0,v54
v_add_f32 v55,1.0,v55
s_add_u32 s64,s79,0
s_lshl_b32 s70,s64,21
s_lshl_b32 s64,s64,13
s_and_b32 s64,s64,0x2000
s_xor_b32 s64,s64,s62
s_add_u32 s70,s70,s64
s_add_u32 s70,s70,29360128
lloop_229:
s_add_u32 s75,s70,2097152
s_xor_b32 s75,s75,0x2000
s_add_u32 s96,s71,1
s_cmp_gt_u32 s96,56
s_addc_u32 s96,s96,0
s_cmp_eq_u32 s83,0
s_cbranch_scc1 lahead_232
s_cmp_gt_u32 s71,56
s_cbranch_scc1 xp_230
pl_234:
buffer_load_dword v29,v21,s[20:23],s74 offen sc1
s_waitcnt vmcnt(0)
v_cmp_gt_u32 vcc,s71,v29
s_cbranch_vccz pok_235
s_sleep 1
s_sub_u32 s90,s90,1
s_cmp_gt_i32 s90,0
s_cbranch_scc1 pl_234
pok_235:
xp_230:
buffer_load_dwordx4 v[8:11],v17,s[20:23],s70 offen sc1
buffer_load_dwordx4 v[12:15],v18,s[20:23],s70 offen sc1
s_waitcnt vmcnt(0)
v_min3_u32 v22,v8,v10,v12
v_min_u32 v22,v22,v14
v_cmp_eq_u32 vcc,0,v22
s_cbranch_vccz xk_231
s_sleep 1
s_sub_u32 s90,s90,1
s_cmp_gt_i32 s90,0
s_cbranch_scc1 xp_230
s_branch xk_231
lahead_232:
s_waitcnt vmcnt(6)
v_mov_b32 v8,v104
v_mov_b32 v9,v105
v_mov_b32 v10,v106
v_mov_b32 v11,v107
v_mov_b32 v12,v108
v_mov_b32 v13,v109
v_mov_b32 v14,v110
v_mov_b32 v15,v111
xk_231:
v_cmp_gt_u32 vcc,s96,v29
s_or_b32 s83,vcc_lo,vcc_hi
s_cselect_b32 s76,0x7fff0000,s75
buffer_load_dwordx4 v[104:107],v17,s[20:23],s76 offen sc1
buffer_load_dwordx4 v[108:111],v18,s[20:23],s76 offen sc1
buffer_load_dword v29,v21,s[20:23],s74 offen sc1
v_lshlrev_b32 v80,16,v8
v_and_b32 v81,s80,v8
v_lshlrev_b32 v82,16,v9
v_and_b32 v83,s80,v9
v_lshlrev_b32 v84,16,v10
v_and_b32 v85,s80,v10
v_lshlrev_b32 v86,16,v11
v_and_b32 v87,s80,v11
v_lshlrev_b32 v88,16,v12
v_and_b32 v89,s80,v12
v_lshlrev_b32 v90,16,v13
v_and_b32 v91,s80,v13
v_lshlrev_b32 v92,16,v14
v_and_b32 v93,s80,v14
v_lshlrev_b32 v94,16,v15
v_and_b32 v95,s80,v15
v_add_f32 v5,v80,v81
v_add_f32 v5,v5,v82
v_add_f32 v5,v5,v83
v_add_f32 v5,v5,v84
v_add_f32 v5,v5,v85
v_add_f32 v5,v5,v86
v_add_f32 v5,v5,v87
v_add_f32 v5,v5,v88
v_add_f32 v5,v5,v89
v_add_f32 v5,v5,v90
v_add_f32 v5,v5,v91
v_add_f32 v5,v5,v92
v_add_f32 v5,v5,v93
v_add_f32 v5,v5,v94
v_add_f32 v5,v5,v95
s_nop 1
v_add_f32_dpp v5,v5,v5 quad_perm:[1,0,3,2] row_mask:0xf bank_mask:0xf
s_nop 1
v_add_f32_dpp v5,v5,v5 quad_perm:[2,3,0,1] row_mask:0xf bank_mask:0xf
s_nop 1
v_add_f32_dpp v5,v5,v5 row_half_mirror row_mask:0xf bank_mask:0xf
s_nop 1
v_add_f32_dpp v5,v5,v5 row_mirror row_mask:0xf bank_mask:0xf
v_mov_b32 v7,v5
s_nop 1
v_permlane16_swap_b32 v7,v5
v_add_f32 v5,v5,v7
v_mov_b32 v7,v5
s_nop 1
v_permlane32_swap_b32 v7,v5
v_add_f32 v5,v5,v7
v_mul_f32 v5,0x3a800000,v5
v_sub_f32 v80,v80,v5
v_sub_f32 v81,v81,v5
v_sub_f32 v82,v82,v5
v_sub_f32 v83,v83,v5
v_sub_f32 v84,v84,v5
v_sub_f32 v85,v85,v5
v_sub_f32 v86,v86,v5
v_sub_f32 v87,v87,v5
v_sub_f32 v88,v88,v5
v_sub_f32 v89,v89,v5
v_sub_f32 v90,v90,v5
v_sub_f32 v91,v91,v5
v_sub_f32 v92,v92,v5
v_sub_f32 v93,v93,v5
v_sub_f32 v94,v94,v5
v_sub_f32 v95,v95,v5
v_mul_f32 v6,v80,v80
v_fmac_f32 v6,v81,v81
v_fmac_f32 v6,v82,v82
v_fmac_f32 v6,v83,v83
v_fmac_f32 v6,v84,v84
v_fmac_f32 v6,v85,v85
v_fmac_f32 v6,v86,v86
v_fmac_f32 v6,v87,v87
v_fmac_f32 v6,v88,v88
v_fmac_f32 v6,v89,v89
v_fmac_f32 v6,v90,v90
v_fmac_f32 v6,v91,v91
v_fmac_f32 v6,v92,v92
v_fmac_f32 v6,v93,v93
v_fmac_f32 v6,v94,v94
v_fmac_f32 v6,v95,v95
s_nop 1
v_add_f32_dpp v6,v6,v6 quad_perm:[1,0,3,2] row_mask:0xf bank_mask:0xf
s_nop 1
v_add_f32_dpp v6,v6,v6 quad_perm:[2,3,0,1] row_mask:0xf bank_mask:0xf
s_nop 1
v_add_f32_dpp v6,v6,v6 row_half_mirror row_mask:0xf bank_mask:0xf
s_nop 1
v_add_f32_dpp v6,v6,v6 row_mirror row_mask:0xf bank_mask:0xf
v_mov_b32 v7,v6
s_nop 1
v_permlane16_swap_b32 v7,v6
v_add_f32 v6,v6,v7
v_mov_b32 v7,v6
s_nop 1
v_permlane32_swap_b32 v7,v6
v_add_f32 v6,v6,v7
v_mov_b32 v7,0x3727c5ac
v_fmac_f32 v7,0x3a800000,v6
v_rsq_f32 v6,v7
s_nop 0
v_mul_f32 v80,v80,v6
v_mul_f32 v81,v81,v6
v_mul_f32 v82,v82,v6
v_mul_f32 v83,v83,v6
v_mul_f32 v84,v84,v6
v_mul_f32 v85,v85,v6
v_mul_f32 v86,v86,v6
v_mul_f32 v87,v87,v6
v_mul_f32 v88,v88,v6
v_mul_f32 v89,v89,v6
v_mul_f32 v90,v90,v6
v_mul_f32 v91,v91,v6
v_mul_f32 v92,v92,v6
v_mul_f32 v93,v93,v6
v_mul_f32 v94,v94,v6
v_mul_f32 v95,v95,v6
v_fma_f32 v80,v80,v40,v56
v_fma_f32 v81,v81,v41,v57
v_fma_f32 v82,v82,v42,v58
v_fma_f32 v83,v83,v43,v59
v_fma_f32 v84,v84,v44,v60
v_fma_f32 v85,v85,v45,v61
v_fma_f32 v86,v86,v46,v62
v_fma_f32 v87,v87,v47,v63
v_fma_f32 v88,v88,v48,v64
v_fma_f32 v89,v89,v49,v65
v_fma_f32 v90,v90,v50,v66
v_fma_f32 v91,v91,v51,v67
v_fma_f32 v92,v92,v52,v68
v_fma_f32 v93,v93,v53,v69
v_fma_f32 v94,v94,v54,v70
v_fma_f32 v95,v95,v55,v71
v_cvt_pk_bf16_f32 v8,v80,v81
v_cvt_pk_bf16_f32 v9,v82,v83
v_cvt_pk_bf16_f32 v10,v84,v85
v_cvt_pk_bf16_f32 v11,v86,v87
v_cvt_pk_bf16_f32 v12,v88,v89
v_cvt_pk_bf16_f32 v13,v90,v91
v_cvt_pk_bf16_f32 v14,v92,v93
v_cvt_pk_bf16_f32 v15,v94,v95
s_waitcnt vmcnt(3)
v_add_u32 v22,s71,-1
buffer_store_dword v22,v23,s[24:27],s73 offen
buffer_store_dword v22,v23,s[28:31],s73 offen sc1
buffer_store_dwordx4 v[8:11],v24,s[20:23],s70 offen sc1
buffer_store_dwordx4 v[12:15],v25,s[20:23],s70 offen sc1
v_lshlrev_b32 v80,16,v8
v_and_b32 v81,s80,v8
v_lshlrev_b32 v82,16,v9
v_and_b32 v83,s80,v9
v_lshlrev_b32 v84,16,v10
v_and_b32 v85,s80,v10
v_lshlrev_b32 v86,16,v11
v_and_b32 v87,s80,v11
v_lshlrev_b32 v88,16,v12
v_and_b32 v89,s80,v12
v_lshlrev_b32 v90,16,v13
v_and_b32 v91,s80,v13
v_lshlrev_b32 v92,16,v14
v_and_b32 v93,s80,v14
v_lshlrev_b32 v94,16,v15
v_and_b32 v95,s80,v15
v_add_f32 v5,v80,v81
v_add_f32 v5,v5,v82
v_add_f32 v5,v5,v83
v_add_f32 v5,v5,v84
v_add_f32 v5,v5,v85
v_add_f32 v5,v5,v86
v_add_f32 v5,v5,v87
v_add_f32 v5,v5,v88
v_add_f32 v5,v5,v89
v_add_f32 v5,v5,v90
v_add_f32 v5,v5,v91
v_add_f32 v5,v5,v92
v_add_f32 v5,v5,v93
v_add_f32 v5,v5,v94
v_add_f32 v5,v5,v95
s_nop 1
v_add_f32_dpp v5,v5,v5 quad_perm:[1,0,3,2] row_mask:0xf bank_mask:0xf
s_nop 1
v_add_f32_dpp v5,v5,v5 quad_perm:[2,3,0,1] row_mask:0xf bank_mask:0xf
s_nop 1
v_add_f32_dpp v5,v5,v5 row_half_mirror row_mask:0xf bank_mask:0xf
s_nop 1
v_add_f32_dpp v5,v5,v5 row_mirror row_mask:0xf bank_mask:0xf
v_mov_b32 v7,v5
s_nop 1
v_permlane16_swap_b32 v7,v5
v_add_f32 v5,v5,v7
v_mov_b32 v7,v5
s_nop 1
v_permlane32_swap_b32 v7,v5
v_add_f32 v5,v5,v7
v_mul_f32 v5,0x3a800000,v5
v_sub_f32 v80,v80,v5
v_sub_f32 v81,v81,v5
v_sub_f32 v82,v82,v5
v_sub_f32 v83,v83,v5
v_sub_f32 v84,v84,v5
v_sub_f32 v85,v85,v5
v_sub_f32 v86,v86,v5
v_sub_f32 v87,v87,v5
v_sub_f32 v88,v88,v5
v_sub_f32 v89,v89,v5
v_sub_f32 v90,v90,v5
v_sub_f32 v91,v91,v5
v_sub_f32 v92,v92,v5
v_sub_f32 v93,v93,v5
v_sub_f32 v94,v94,v5
v_sub_f32 v95,v95,v5
v_mul_f32 v6,v80,v80
v_fmac_f32 v6,v81,v81
v_fmac_f32 v6,v82,v82
v_fmac_f32 v6,v83,v83
v_fmac_f32 v6,v84,v84
v_fmac_f32 v6,v85,v85
v_fmac_f32 v6,v86,v86
v_fmac_f32 v6,v87,v87
v_fmac_f32 v6,v88,v88
v_fmac_f32 v6,v89,v89
v_fmac_f32 v6,v90,v90
v_fmac_f32 v6,v91,v91
v_fmac_f32 v6,v92,v92
v_fmac_f32 v6,v93,v93
v_fmac_f32 v6,v94,v94
v_fmac_f32 v6,v95,v95
s_nop 1
v_add_f32_dpp v6,v6,v6 quad_perm:[1,0,3,2] row_mask:0xf bank_mask:0xf
s_nop 1
v_add_f32_dpp v6,v6,v6 quad_perm:[2,3,0,1] row_mask:0xf bank_mask:0xf
s_nop 1
v_add_f32_dpp v6,v6,v6 row_half_mirror row_mask:0xf bank_mask:0xf
s_nop 1
v_add_f32_dpp v6,v6,v6 row_mirror row_mask:0xf bank_mask:0xf
v_mov_b32 v7,v6
s_nop 1
v_permlane16_swap_b32 v7,v6
v_add_f32 v6,v6,v7
v_mov_b32 v7,v6
s_nop 1
v_permlane32_swap_b32 v7,v6
v_add_f32 v6,v6,v7
v_mov_b32 v7,0x3727c5ac
v_fmac_f32 v7,0x3a800000,v6
v_rsq_f32 v6,v7
s_nop 0
v_mul_f32 v80,v80,v6
v_mul_f32 v81,v81,v6
v_mul_f32 v82,v82,v6
v_mul_f32 v83,v83,v6
v_mul_f32 v84,v84,v6
v_mul_f32 v85,v85,v6
v_mul_f32 v86,v86,v6
v_mul_f32 v87,v87,v6
v_mul_f32 v88,v88,v6
v_mul_f32 v89,v89,v6
v_mul_f32 v90,v90,v6
v_mul_f32 v91,v91,v6
v_mul_f32 v92,v92,v6
v_mul_f32 v93,v93,v6
v_mul_f32 v94,v94,v6
v_mul_f32 v95,v95,v6
v_cvt_pk_bf16_f32 v72,v80,v81
v_cvt_pk_bf16_f32 v73,v82,v83
v_cvt_pk_bf16_f32 v74,v84,v85
v_cvt_pk_bf16_f32 v75,v86,v87
v_cvt_pk_bf16_f32 v76,v88,v89
v_cvt_pk_bf16_f32 v77,v90,v91
v_cvt_pk_bf16_f32 v78,v92,v93
v_cvt_pk_bf16_f32 v79,v94,v95
v_max_u32 v72,1,v72
v_max_u32 v76,1,v76
s_cmp_le_u32 s71,56
s_cbranch_scc1 lw_233
s_waitcnt vmcnt(0)
lw_233:
buffer_store_dwordx4 v[72:75],v19,s[20:23],s70 offen sc1
buffer_store_dwordx4 v[76:79],v19,s[20:23],s70 offen offset:1024 sc1
s_cmp_gt_u32 s71,56
s_cbranch_scc1 fnow_236
s_cmp_eq_u32 s83,0
s_cbranch_scc1 flater_237
s_waitcnt vmcnt(0)
fnow_236:
v_mov_b32 v22,s71
buffer_store_dword v22,v23,s[24:27],s73 offen
buffer_store_dword v22,v23,s[28:31],s73 offen sc1
flater_237:
s_add_u32 s65,s70,8388608
s_sub_u32 s64,s71,53
s_cmp_lt_u32 s64,8
s_cselect_b32 s65,s65,0x7fff0000
buffer_store_dwordx4 v[128:131],v19,s[20:23],s65 offen offset:0 sc1
buffer_store_dwordx4 v[128:131],v19,s[20:23],s65 offen offset:1024 sc1
s_mov_b32 s70,s75
s_add_u32 s79,s79,1
s_add_u32 s71,s71,1
s_cmp_lt_u32 s79,64
s_cbranch_scc1 lloop_229
s_endpgm
r_wo_185:
s_load_dwordx2 s[4:5],s[0:1],40
s_load_dwordx2 s[6:7],s[0:1],0
s_lshr_b32 s41,s59,3
s_and_b32 s42,s59,7
s_mul_i32 s66,s41,2097152
s_lshl_b32 s64,s42,8
s_add_u32 s66,s66,s64
s_lshl_b32 s67,s50,1
s_and_b32 s64,s41,1
s_add_u32 s67,s67,s64
s_waitcnt lgkmcnt(0)
s_mov_b32 s32,s4
s_and_b32 s33,s5,0xffff
s_mov_b32 s34,0x800000
s_mov_b32 s35,0x20000
s_mov_b32 s36,s6
s_and_b32 s37,s7,0xffff
s_mov_b32 s38,0x400000
s_mov_b32 s39,0x20000
v_lshrrev_b32 v5,2,v3
v_lshl_add_u32 v5,v4,2,v5
v_and_b32 v6,3,v3
v_lshlrev_b32 v6,3,v6
v_lshl_add_u32 v6,v5,8,v6
v_and_b32 v5,7,v5
v_xor_b32 v5,s67,v5
v_lshl_add_u32 v12,v5,5,v6
v_xor_b32 v13,32,v12
v_and_b32 v5,15,v1
v_and_b32 v6,3,v4
v_lshlrev_b32 v6,1,v6
v_xor_b32 v5,v5,v6
v_mul_u32_u24 v6,2048,v4
v_xor_b32 v7,0,v5
v_lshl_add_u32 v8,v7,4,v6
v_xor_b32 v7,8,v5
v_lshl_add_u32 v9,v7,4,v6
s_mul_i32 s74,s50,131072
s_add_u32 s74,s74,s66
s_lshl_b32 s75,s50,14
s_mul_i32 s76,s50,65536
s_add_u32 s76,s76,s66
s_lshl_b32 s77,s50,13
s_add_u32 s64,s74,0
s_add_u32 m0,s75,0
s_nop 0
buffer_load_dwordx4 v8,s[32:35],s64 offen  lds
s_add_u32 s64,s74,8192
s_add_u32 m0,s75,1024
s_nop 0
buffer_load_dwordx4 v9,s[32:35],s64 offen  lds
s_add_u32 s64,s74,16384
s_add_u32 m0,s75,2048
s_nop 0
buffer_load_dwordx4 v8,s[32:35],s64 offen  lds
s_add_u32 s64,s74,24576
s_add_u32 m0,s75,3072
s_nop 0
buffer_load_dwordx4 v9,s[32:35],s64 offen  lds
s_add_u32 s64,s74,32768
s_add_u32 m0,s75,4096
s_nop 0
buffer_load_dwordx4 v8,s[32:35],s64 offen  lds
s_add_u32 s64,s74,40960
s_add_u32 m0,s75,5120
s_nop 0
buffer_load_dwordx4 v9,s[32:35],s64 offen  lds
s_add_u32 s64,s74,49152
s_add_u32 m0,s75,6144
s_nop 0
buffer_load_dwordx4 v8,s[32:35],s64 offen  lds
s_add_u32 s64,s74,57344
s_add_u32 m0,s75,7168
s_nop 0
buffer_load_dwordx4 v9,s[32:35],s64 offen  lds
s_add_u32 s64,s74,65536
s_add_u32 m0,s75,8192
s_nop 0
buffer_load_dwordx4 v8,s[32:35],s64 offen  lds
s_add_u32 s64,s74,73728
s_add_u32 m0,s75,9216
s_nop 0
buffer_load_dwordx4 v9,s[32:35],s64 offen  lds
s_add_u32 s64,s74,81920
s_add_u32 m0,s75,10240
s_nop 0
buffer_load_dwordx4 v8,s[32:35],s64 offen  lds
s_add_u32 s64,s74,90112
s_add_u32 m0,s75,11264
s_nop 0
buffer_load_dwordx4 v9,s[32:35],s64 offen  lds
s_add_u32 s64,s74,98304
s_add_u32 m0,s75,12288
s_nop 0
buffer_load_dwordx4 v8,s[32:35],s64 offen  lds
s_add_u32 s64,s74,106496
s_add_u32 m0,s75,13312
s_nop 0
buffer_load_dwordx4 v9,s[32:35],s64 offen  lds
s_add_u32 s64,s74,114688
s_add_u32 m0,s75,14336
s_nop 0
buffer_load_dwordx4 v8,s[32:35],s64 offen  lds
s_add_u32 s64,s74,122880
s_add_u32 m0,s75,15360
s_nop 0
buffer_load_dwordx4 v9,s[32:35],s64 offen  lds
s_add_u32 s64,s74,524288
s_add_u32 m0,s75,65536
s_nop 0
buffer_load_dwordx4 v8,s[32:35],s64 offen  lds
s_add_u32 s64,s74,532480
s_add_u32 m0,s75,66560
s_nop 0
buffer_load_dwordx4 v9,s[32:35],s64 offen  lds
s_add_u32 s64,s74,540672
s_add_u32 m0,s75,67584
s_nop 0
buffer_load_dwordx4 v8,s[32:35],s64 offen  lds
s_add_u32 s64,s74,548864
s_add_u32 m0,s75,68608
s_nop 0
buffer_load_dwordx4 v9,s[32:35],s64 offen  lds
s_add_u32 s64,s74,557056
s_add_u32 m0,s75,69632
s_nop 0
buffer_load_dwordx4 v8,s[32:35],s64 offen  lds
s_add_u32 s64,s74,565248
s_add_u32 m0,s75,70656
s_nop 0
buffer_load_dwordx4 v9,s[32:35],s64 offen  lds
s_add_u32 s64,s74,573440
s_add_u32 m0,s75,71680
s_nop 0
buffer_load_dwordx4 v8,s[32:35],s64 offen  lds
s_add_u32 s64,s74,581632
s_add_u32 m0,s75,72704
s_nop 0
buffer_load_dwordx4 v9,s[32:35],s64 offen  lds
s_add_u32 s64,s74,589824
s_add_u32 m0,s75,73728
s_nop 0
buffer_load_dwordx4 v8,s[32:35],s64 offen  lds
s_add_u32 s64,s74,598016
s_add_u32 m0,s75,74752
s_nop 0
buffer_load_dwordx4 v9,s[32:35],s64 offen  lds
s_add_u32 s64,s74,606208
s_add_u32 m0,s75,75776
s_nop 0
buffer_load_dwordx4 v8,s[32:35],s64 offen  lds
s_add_u32 s64,s74,614400
s_add_u32 m0,s75,76800
s_nop 0
buffer_load_dwordx4 v9,s[32:35],s64 offen  lds
s_add_u32 s64,s74,622592
s_add_u32 m0,s75,77824
s_nop 0
buffer_load_dwordx4 v8,s[32:35],s64 offen  lds
s_add_u32 s64,s74,630784
s_add_u32 m0,s75,78848
s_nop 0
buffer_load_dwordx4 v9,s[32:35],s64 offen  lds
s_add_u32 s64,s74,638976
s_add_u32 m0,s75,79872
s_nop 0
buffer_load_dwordx4 v8,s[32:35],s64 offen  lds
s_add_u32 s64,s74,647168
s_add_u32 m0,s75,80896
s_nop 0
buffer_load_dwordx4 v9,s[32:35],s64 offen  lds
s_waitcnt vmcnt(16)
s_barrier
ds_read_b64_tr_b16 a[0:1],v12 offset:0
ds_read_b64_tr_b16 a[128:129],v13 offset:0
ds_read_b64_tr_b16 a[2:3],v12 offset:4096
ds_read_b64_tr_b16 a[130:131],v13 offset:4096
ds_read_b64_tr_b16 a[4:5],v12 offset:8192
ds_read_b64_tr_b16 a[132:133],v13 offset:8192
ds_read_b64_tr_b16 a[6:7],v12 offset:12288
ds_read_b64_tr_b16 a[134:135],v13 offset:12288
s_waitcnt lgkmcnt(4)
ds_read_b64_tr_b16 a[8:9],v12 offset:16384
ds_read_b64_tr_b16 a[136:137],v13 offset:16384
ds_read_b64_tr_b16 a[10:11],v12 offset:20480
ds_read_b64_tr_b16 a[138:139],v13 offset:20480
ds_read_b64_tr_b16 a[12:13],v12 offset:24576
ds_read_b64_tr_b16 a[140:141],v13 offset:24576
ds_read_b64_tr_b16 a[14:15],v12 offset:28672
ds_read_b64_tr_b16 a[142:143],v13 offset:28672
s_waitcnt lgkmcnt(4)
ds_read_b64_tr_b16 a[16:17],v12 offset:32768
ds_read_b64_tr_b16 a[144:145],v13 offset:32768
ds_read_b64_tr_b16 a[18:19],v12 offset:36864
ds_read_b64_tr_b16 a[146:147],v13 offset:36864
ds_read_b64_tr_b16 a[20:21],v12 offset:40960
ds_read_b64_tr_b16 a[148:149],v13 offset:40960
ds_read_b64_tr_b16 a[22:23],v12 offset:45056
ds_read_b64_tr_b16 a[150:151],v13 offset:45056
s_waitcnt lgkmcnt(4)
ds_read_b64_tr_b16 a[24:25],v12 offset:49152
ds_read_b64_tr_b16 a[152:153],v13 offset:49152
ds_read_b64_tr_b16 a[26:27],v12 offset:53248
ds_read_b64_tr_b16 a[154:155],v13 offset:53248
ds_read_b64_tr_b16 a[28:29],v12 offset:57344
ds_read_b64_tr_b16 a[156:157],v13 offset:57344
ds_read_b64_tr_b16 a[30:31],v12 offset:61440
ds_read_b64_tr_b16 a[158:159],v13 offset:61440
s_waitcnt lgkmcnt(4)
v_xor_b32 v12,0x10000,v12
v_xor_b32 v13,0x10000,v13
s_waitcnt lgkmcnt(0)
s_barrier
s_add_u32 s64,s74,1048576
s_add_u32 m0,s75,0
s_nop 0
buffer_load_dwordx4 v8,s[32:35],s64 offen  lds
s_add_u32 s64,s74,1056768
s_add_u32 m0,s75,1024
s_nop 0
buffer_load_dwordx4 v9,s[32:35],s64 offen  lds
s_add_u32 s64,s74,1064960
s_add_u32 m0,s75,2048
s_nop 0
buffer_load_dwordx4 v8,s[32:35],s64 offen  lds
s_add_u32 s64,s74,1073152
s_add_u32 m0,s75,3072
s_nop 0
buffer_load_dwordx4 v9,s[32:35],s64 offen  lds
s_add_u32 s64,s74,1081344
s_add_u32 m0,s75,4096
s_nop 0
buffer_load_dwordx4 v8,s[32:35],s64 offen  lds
s_add_u32 s64,s74,1089536
s_add_u32 m0,s75,5120
s_nop 0
buffer_load_dwordx4 v9,s[32:35],s64 offen  lds
s_add_u32 s64,s74,1097728
s_add_u32 m0,s75,6144
s_nop 0
buffer_load_dwordx4 v8,s[32:35],s64 offen  lds
s_add_u32 s64,s74,1105920
s_add_u32 m0,s75,7168
s_nop 0
buffer_load_dwordx4 v9,s[32:35],s64 offen  lds
s_add_u32 s64,s74,1114112
s_add_u32 m0,s75,8192
s_nop 0
buffer_load_dwordx4 v8,s[32:35],s64 offen  lds
s_add_u32 s64,s74,1122304
s_add_u32 m0,s75,9216
s_nop 0
buffer_load_dwordx4 v9,s[32:35],s64 offen  lds
s_add_u32 s64,s74,1130496
s_add_u32 m0,s75,10240
s_nop 0
buffer_load_dwordx4 v8,s[32:35],s64 offen  lds
s_add_u32 s64,s74,1138688
s_add_u32 m0,s75,11264
s_nop 0
buffer_load_dwordx4 v9,s[32:35],s64 offen  lds
s_add_u32 s64,s74,1146880
s_add_u32 m0,s75,12288
s_nop 0
buffer_load_dwordx4 v8,s[32:35],s64 offen  lds
s_add_u32 s64,s74,1155072
s_add_u32 m0,s75,13312
s_nop 0
buffer_load_dwordx4 v9,s[32:35],s64 offen  lds
s_add_u32 s64,s74,1163264
s_add_u32 m0,s75,14336
s_nop 0
buffer_load_dwordx4 v8,s[32:35],s64 offen  lds
s_add_u32 s64,s74,1171456
s_add_u32 m0,s75,15360
s_nop 0
buffer_load_dwordx4 v9,s[32:35],s64 offen  lds
s_waitcnt vmcnt(16)
s_barrier
ds_read_b64_tr_b16 a[32:33],v12 offset:0
ds_read_b64_tr_b16 a[160:161],v13 offset:0
ds_read_b64_tr_b16 a[34:35],v12 offset:4096
ds_read_b64_tr_b16 a[162:163],v13 offset:4096
ds_read_b64_tr_b16 a[36:37],v12 offset:8192
ds_read_b64_tr_b16 a[164:165],v13 offset:8192
ds_read_b64_tr_b16 a[38:39],v12 offset:12288
ds_read_b64_tr_b16 a[166:167],v13 offset:12288
s_waitcnt lgkmcnt(4)
ds_read_b64_tr_b16 a[40:41],v12 offset:16384
ds_read_b64_tr_b16 a[168:169],v13 offset:16384
ds_read_b64_tr_b16 a[42:43],v12 offset:20480
ds_read_b64_tr_b16 a[170:171],v13 offset:20480
ds_read_b64_tr_b16 a[44:45],v12 offset:24576
ds_read_b64_tr_b16 a[172:173],v13 offset:24576
ds_read_b64_tr_b16 a[46:47],v12 offset:28672
ds_read_b64_tr_b16 a[174:175],v13 offset:28672
s_waitcnt lgkmcnt(4)
ds_read_b64_tr_b16 a[48:49],v12 offset:32768
ds_read_b64_tr_b16 a[176:177],v13 offset:32768
ds_read_b64_tr_b16 a[50:51],v12 offset:36864
ds_read_b64_tr_b16 a[178:179],v13 offset:36864
ds_read_b64_tr_b16 a[52:53],v12 offset:40960
ds_read_b64_tr_b16 a[180:181],v13 offset:40960
ds_read_b64_tr_b16 a[54:55],v12 offset:45056
ds_read_b64_tr_b16 a[182:183],v13 offset:45056
s_waitcnt lgkmcnt(4)
ds_read_b64_tr_b16 a[56:57],v12 offset:49152
ds_read_b64_tr_b16 a[184:185],v13 offset:49152
ds_read_b64_tr_b16 a[58:59],v12 offset:53248
ds_read_b64_tr_b16 a[186:187],v13 offset:53248
ds_read_b64_tr_b16 a[60:61],v12 offset:57344
ds_read_b64_tr_b16 a[188:189],v13 offset:57344
ds_read_b64_tr_b16 a[62:63],v12 offset:61440
ds_read_b64_tr_b16 a[190:191],v13 offset:61440
s_waitcnt lgkmcnt(4)
v_xor_b32 v12,0x10000,v12
v_xor_b32 v13,0x10000,v13
s_waitcnt lgkmcnt(0)
s_barrier
s_add_u32 s64,s74,1572864
s_add_u32 m0,s75,65536
s_nop 0
buffer_load_dwordx4 v8,s[32:35],s64 offen  lds
s_add_u32 s64,s74,1581056
s_add_u32 m0,s75,66560
s_nop 0
buffer_load_dwordx4 v9,s[32:35],s64 offen  lds
s_add_u32 s64,s74,1589248
s_add_u32 m0,s75,67584
s_nop 0
buffer_load_dwordx4 v8,s[32:35],s64 offen  lds
s_add_u32 s64,s74,1597440
s_add_u32 m0,s75,68608
s_nop 0
buffer_load_dwordx4 v9,s[32:35],s64 offen  lds
s_add_u32 s64,s74,1605632
s_add_u32 m0,s75,69632
s_nop 0
buffer_load_dwordx4 v8,s[32:35],s64 offen  lds
s_add_u32 s64,s74,1613824
s_add_u32 m0,s75,70656
s_nop 0
buffer_load_dwordx4 v9,s[32:35],s64 offen  lds
s_add_u32 s64,s74,1622016
s_add_u32 m0,s75,71680
s_nop 0
buffer_load_dwordx4 v8,s[32:35],s64 offen  lds
s_add_u32 s64,s74,1630208
s_add_u32 m0,s75,72704
s_nop 0
buffer_load_dwordx4 v9,s[32:35],s64 offen  lds
s_add_u32 s64,s74,1638400
s_add_u32 m0,s75,73728
s_nop 0
buffer_load_dwordx4 v8,s[32:35],s64 offen  lds
s_add_u32 s64,s74,1646592
s_add_u32 m0,s75,74752
s_nop 0
buffer_load_dwordx4 v9,s[32:35],s64 offen  lds
s_add_u32 s64,s74,1654784
s_add_u32 m0,s75,75776
s_nop 0
buffer_load_dwordx4 v8,s[32:35],s64 offen  lds
s_add_u32 s64,s74,1662976
s_add_u32 m0,s75,76800
s_nop 0
buffer_load_dwordx4 v9,s[32:35],s64 offen  lds
s_add_u32 s64,s74,1671168
s_add_u32 m0,s75,77824
s_nop 0
buffer_load_dwordx4 v8,s[32:35],s64 offen  lds
s_add_u32 s64,s74,1679360
s_add_u32 m0,s75,78848
s_nop 0
buffer_load_dwordx4 v9,s[32:35],s64 offen  lds
s_add_u32 s64,s74,1687552
s_add_u32 m0,s75,79872
s_nop 0
buffer_load_dwordx4 v8,s[32:35],s64 offen  lds
s_add_u32 s64,s74,1695744
s_add_u32 m0,s75,80896
s_nop 0
buffer_load_dwordx4 v9,s[32:35],s64 offen  lds
s_waitcnt vmcnt(16)
s_barrier
ds_read_b64_tr_b16 a[64:65],v12 offset:0
ds_read_b64_tr_b16 a[192:193],v13 offset:0
ds_read_b64_tr_b16 a[66:67],v12 offset:4096
ds_read_b64_tr_b16 a[194:195],v13 offset:4096
ds_read_b64_tr_b16 a[68:69],v12 offset:8192
ds_read_b64_tr_b16 a[196:197],v13 offset:8192
ds_read_b64_tr_b16 a[70:71],v12 offset:12288
ds_read_b64_tr_b16 a[198:199],v13 offset:12288
s_waitcnt lgkmcnt(4)
ds_read_b64_tr_b16 a[72:73],v12 offset:16384
ds_read_b64_tr_b16 a[200:201],v13 offset:16384
ds_read_b64_tr_b16 a[74:75],v12 offset:20480
ds_read_b64_tr_b16 a[202:203],v13 offset:20480
ds_read_b64_tr_b16 a[76:77],v12 offset:24576
ds_read_b64_tr_b16 a[204:205],v13 offset:24576
ds_read_b64_tr_b16 a[78:79],v12 offset:28672
ds_read_b64_tr_b16 a[206:207],v13 offset:28672
s_waitcnt lgkmcnt(4)
ds_read_b64_tr_b16 a[80:81],v12 offset:32768
ds_read_b64_tr_b16 a[208:209],v13 offset:32768
ds_read_b64_tr_b16 a[82:83],v12 offset:36864
ds_read_b64_tr_b16 a[210:211],v13 offset:36864
ds_read_b64_tr_b16 a[84:85],v12 offset:40960
ds_read_b64_tr_b16 a[212:213],v13 offset:40960
ds_read_b64_tr_b16 a[86:87],v12 offset:45056
ds_read_b64_tr_b16 a[214:215],v13 offset:45056
s_waitcnt lgkmcnt(4)
ds_read_b64_tr_b16 a[88:89],v12 offset:49152
ds_read_b64_tr_b16 a[216:217],v13 offset:49152
ds_read_b64_tr_b16 a[90:91],v12 offset:53248
ds_read_b64_tr_b16 a[218:219],v13 offset:53248
ds_read_b64_tr_b16 a[92:93],v12 offset:57344
ds_read_b64_tr_b16 a[220:221],v13 offset:57344
ds_read_b64_tr_b16 a[94:95],v12 offset:61440
ds_read_b64_tr_b16 a[222:223],v13 offset:61440
s_waitcnt lgkmcnt(4)
v_xor_b32 v12,0x10000,v12
v_xor_b32 v13,0x10000,v13
s_waitcnt lgkmcnt(0)
s_barrier
s_waitcnt vmcnt(0)
s_barrier
ds_read_b64_tr_b16 a[96:97],v12 offset:0
ds_read_b64_tr_b16 a[224:225],v13 offset:0
ds_read_b64_tr_b16 a[98:99],v12 offset:4096
ds_read_b64_tr_b16 a[226:227],v13 offset:4096
ds_read_b64_tr_b16 a[100:101],v12 offset:8192
ds_read_b64_tr_b16 a[228:229],v13 offset:8192
ds_read_b64_tr_b16 a[102:103],v12 offset:12288
ds_read_b64_tr_b16 a[230:231],v13 offset:12288
s_waitcnt lgkmcnt(4)
ds_read_b64_tr_b16 a[104:105],v12 offset:16384
ds_read_b64_tr_b16 a[232:233],v13 offset:16384
ds_read_b64_tr_b16 a[106:107],v12 offset:20480
ds_read_b64_tr_b16 a[234:235],v13 offset:20480
ds_read_b64_tr_b16 a[108:109],v12 offset:24576
ds_read_b64_tr_b16 a[236:237],v13 offset:24576
ds_read_b64_tr_b16 a[110:111],v12 offset:28672
ds_read_b64_tr_b16 a[238:239],v13 offset:28672
s_waitcnt lgkmcnt(4)
ds_read_b64_tr_b16 a[112:113],v12 offset:32768
ds_read_b64_tr_b16 a[240:241],v13 offset:32768
ds_read_b64_tr_b16 a[114:115],v12 offset:36864
ds_read_b64_tr_b16 a[242:243],v13 offset:36864
ds_read_b64_tr_b16 a[116:117],v12 offset:40960
ds_read_b64_tr_b16 a[244:245],v13 offset:40960
ds_read_b64_tr_b16 a[118:119],v12 offset:45056
ds_read_b64_tr_b16 a[246:247],v13 offset:45056
s_waitcnt lgkmcnt(4)
ds_read_b64_tr_b16 a[120:121],v12 offset:49152
ds_read_b64_tr_b16 a[248:249],v13 offset:49152
ds_read_b64_tr_b16 a[122:123],v12 offset:53248
ds_read_b64_tr_b16 a[250:251],v13 offset:53248
ds_read_b64_tr_b16 a[124:125],v12 offset:57344
ds_read_b64_tr_b16 a[252:253],v13 offset:57344
ds_read_b64_tr_b16 a[126:127],v12 offset:61440
ds_read_b64_tr_b16 a[254:255],v13 offset:61440
s_waitcnt lgkmcnt(4)
v_xor_b32 v12,0x10000,v12
v_xor_b32 v13,0x10000,v13
s_waitcnt lgkmcnt(0)
s_barrier
v_and_b32 v21,1,v1
v_mul_u32_u24 v21,896,v21
s_mov_b32 s65,21052032
s_mov_b32 s66,1792
pl_238:
buffer_load_dword v22,v21,s[20:23],s65 offen sc1
s_waitcnt vmcnt(0)
v_cmp_gt_u32 vcc,s66,v22
s_cbranch_vccz pok_239
s_sleep 1
s_sub_u32 s90,s90,1
s_cmp_gt_i32 s90,0
s_cbranch_scc1 pl_238
pok_239:
s_lshr_b32 s43,s41,1
s_and_b32 s48,s41,1
s_lshl_b32 s64,s42,7
s_lshl_b32 s65,s50,5
s_add_u32 s64,s64,s65
s_lshl_b32 s65,s48,4
s_add_u32 s64,s64,s65
v_lshl_add_u32 v5,v4,2,s64
v_lshlrev_b32 v6,2,v5
s_mov_b32 s64,8192
buffer_load_dwordx4 v[52:55],v6,s[20:23],s64 offen sc1
v_lshlrev_b32 v10,1,v5
v_and_b32 v6,3,v1
v_sub_u32 v5,v6,v4
v_lshl_add_u32 v5,v5,3,v10
v_lshrrev_b32 v11,2,v1
v_lshl_add_u32 v40,v6,4,v11
v_lshlrev_b32 v40,2,v40
v_lshl_add_u32 v41,v3,2,v4
v_lshlrev_b32 v41,2,v41
s_lshl_b32 s64,s43,10
v_add_u32 v17,s64,v16
v_xor_b32 v18,1024,v17
s_xor_b32 s64,s64,1024
s_lshr_b32 s65,s50,1
s_and_b32 s66,s50,1
s_lshl_b32 s66,s66,12
s_add_u32 s66,s66,s64
s_lshl_b32 s72,s65,13
s_add_u32 s72,s72,s66
s_add_u32 s72,s72,0x10000
s_lshl_b32 s65,s65,14
s_add_u32 s75,s65,s66
s_add_u32 s75,s75,524288
s_mul_i32 s64,s41,131072
s_add_u32 s75,s75,s64
s_cmp_lt_u32 s50,2
s_cselect_b32 s86,98304,0x40000000
s_mov_b32 s76,27262976
s_mov_b32 s77,0
s_mov_b32 s78,0
s_mov_b32 s49,0
s_lshl_b32 s64,s59,14
s_lshl_b32 s65,s50,12
s_add_u32 s64,s64,s65
s_add_u32 s64,s64,17825792
v_add_u32 v26,s64,v16
s_lshl_b32 s64,s42,14
s_add_u32 s64,s64,s65
s_add_u32 s64,s64,17825792
v_add_u32 v25,s64,v16
s_xor_b32 s33,s41,1
s_xor_b32 s34,s41,2
s_xor_b32 s35,s41,3
s_lshl_b32 s33,s33,17
s_lshl_b32 s34,s34,17
s_lshl_b32 s35,s35,17
v_and_b32 v21,7,v1
v_lshlrev_b32 v21,2,v21
s_lshl_b32 s74,s41,7
s_add_u32 s74,s74,s63
s_add_u32 s74,s74,1024
v_lshrrev_b32 v6,2,v11
v_and_b32 v7,3,v11
v_lshl_add_u32 v6,v6,1,s43
v_lshl_add_u32 v8,v6,2,v7
v_lshl_add_u32 v8,v8,7,v5
v_and_b32 v8,2047,v8
v_lshl_add_u32 v8,v7,11,v8
v_lshl_add_u32 v7,v7,11,v5
v_lshl_add_u32 v20,v6,13,v7
v_lshl_add_u32 v19,v6,14,v8
v_add_u32 v19,1048576,v19
s_lshl_b32 s73,s59,2
s_add_u32 s73,s73,s50
s_lshl_b32 s73,s73,2
s_add_u32 s73,s73,s63
s_add_u32 s73,s73,2048
s_mov_b32 s48,0x7fff0000
s_waitcnt vmcnt(0)
s_add_u32 s64,s79,0
s_lshl_b32 s70,s64,21
s_lshl_b32 s64,s64,13
s_and_b32 s64,s64,0x2000
s_xor_b32 s64,s64,s62
s_add_u32 s70,s70,s64
s_add_u32 s70,s70,29360128
s_mov_b32 s83,1
s_mov_b32 s87,s74
s_cmp_eq_u32 s50,0
s_cselect_b32 s74,s74,0x7fff0000
v_mov_b32 v45,132096
s_lshl_b32 s64,s50,2
s_add_u32 s64,s64,132112
v_mov_b32 v46,s64
v_mov_b32 v2,0
v_mov_b32 v44,1
ds_write_b32 v45,v44
s_waitcnt lgkmcnt(0)
seg_241:
s_cmp_eq_u32 s83,0
s_cbranch_scc1 ahead_242
s_add_u32 s94,s70,s75
s_xor_b32 s95,s94,1024
s_xor_b32 s91,s72,0x10000
s_waitcnt lgkmcnt(0)
v_cmp_gt_u32 vcc,s71,v2
s_cbranch_vccz nb_245
s_waitcnt vmcnt(2)
v_cmp_gt_u32 vcc,s71,v29
s_cbranch_vccz nb_245
s_waitcnt vmcnt(0)
v_add_u32 v22,s71,-1
buffer_store_dword v22,v23,s[20:23],s73 offen sc1
s_cmp_lg_u32 s50,0
s_cbranch_scc1 nb_245
buffer_load_dword v32,v21,s[20:23],s74 offen sc1
s_sleep 2
pl_246:
buffer_load_dword v33,v21,s[20:23],s74 offen sc1
s_waitcnt vmcnt(1)
v_cmp_gt_u32 vcc,s71,v32
s_cbranch_vccz pok_247
buffer_load_dword v32,v21,s[20:23],s74 offen sc1
s_waitcnt vmcnt(1)
v_cmp_gt_u32 vcc,s71,v33
s_cbranch_vccz pok_247
s_sub_u32 s90,s90,1
s_cmp_gt_i32 s90,0
s_cbranch_scc1 pl_246
pok_247:
nb_245:
s_barrier
s_xor_b32 m0,s91,0
s_add_u32 s65,s94,0
buffer_load_dwordx4 v16,s[20:23],s65 offen offset:0 sc1 lds
buffer_load_dwordx4 v16,s[20:23],s65 offen offset:2048 sc1 lds
ds_read_b32 v44,v45
s_xor_b32 m0,s91,16384
s_add_u32 s65,s94,32768
buffer_load_dwordx4 v16,s[20:23],s65 offen offset:0 sc1 lds
buffer_load_dwordx4 v16,s[20:23],s65 offen offset:2048 sc1 lds
s_xor_b32 m0,s91,32768
s_add_u32 s65,s94,65536
buffer_load_dwordx4 v16,s[20:23],s65 offen offset:0 sc1 lds
buffer_load_dwordx4 v16,s[20:23],s65 offen offset:2048 sc1 lds
s_xor_b32 m0,s91,49152
s_add_u32 s65,s94,98304
buffer_load_dwordx4 v16,s[20:23],s65 offen offset:0 sc1 lds
buffer_load_dwordx4 v16,s[20:23],s65 offen offset:2048 sc1 lds
s_xor_b32 m0,s91,1024
s_add_u32 s65,s95,0
buffer_load_dwordx4 v16,s[20:23],s65 offen offset:0 sc1 lds
buffer_load_dwordx4 v16,s[20:23],s65 offen offset:2048 sc1 lds
s_waitcnt lgkmcnt(0)
v_readfirstlane_b32 s83,v44
s_cmp_eq_u32 s83,0
s_cbranch_scc1 both_244
s_waitcnt vmcnt(8)
s_barrier
ds_read_b128 v[224:227],v18 offset:0
ds_read_b128 v[228:231],v18 offset:2048
ds_read_b128 v[232:235],v18 offset:4096
ds_read_b128 v[236:239],v18 offset:6144
ds_read_b128 v[240:243],v18 offset:8192
ds_read_b128 v[244:247],v18 offset:10240
ds_read_b128 v[248:251],v18 offset:12288
s_waitcnt lgkmcnt(5)
v_mfma_f32_16x16x32_bf16 v[64:67],a[0:3],v[224:227],0
v_min_u32 v27,v224,v228
s_xor_b32 m0,s91,17408
v_mfma_f32_16x16x32_bf16 v[68:71],a[128:131],v[224:227],0
ds_read_b128 v[252:255],v18 offset:14336
v_mfma_f32_16x16x32_bf16 v[64:67],a[4:7],v[228:231],v[64:67]
s_add_u32 s65,s95,32768
v_mfma_f32_16x16x32_bf16 v[68:71],a[132:135],v[228:231],v[68:71]
s_waitcnt vmcnt(6)
s_barrier
ds_read_b128 v[224:227],v18 offset:16384
s_waitcnt lgkmcnt(5)
v_mfma_f32_16x16x32_bf16 v[64:67],a[8:11],v[232:235],v[64:67]
v_min3_u32 v27,v27,v232,v236
buffer_load_dwordx4 v16,s[20:23],s65 offen offset:0 sc1 lds
v_mfma_f32_16x16x32_bf16 v[68:71],a[136:139],v[232:235],v[68:71]
ds_read_b128 v[228:231],v18 offset:18432
v_mfma_f32_16x16x32_bf16 v[64:67],a[12:15],v[236:239],v[64:67]
buffer_load_dwordx4 v16,s[20:23],s65 offen offset:2048 sc1 lds
v_mfma_f32_16x16x32_bf16 v[68:71],a[140:143],v[236:239],v[68:71]
ds_read_b128 v[232:235],v18 offset:20480
s_waitcnt lgkmcnt(5)
v_mfma_f32_16x16x32_bf16 v[64:67],a[16:19],v[240:243],v[64:67]
v_min3_u32 v27,v27,v240,v244
s_xor_b32 m0,s91,33792
v_mfma_f32_16x16x32_bf16 v[68:71],a[144:147],v[240:243],v[68:71]
ds_read_b128 v[236:239],v18 offset:22528
v_mfma_f32_16x16x32_bf16 v[64:67],a[20:23],v[244:247],v[64:67]
s_add_u32 s65,s95,65536
v_mfma_f32_16x16x32_bf16 v[68:71],a[148:151],v[244:247],v[68:71]
ds_read_b128 v[240:243],v18 offset:24576
s_waitcnt lgkmcnt(5)
v_mfma_f32_16x16x32_bf16 v[64:67],a[24:27],v[248:251],v[64:67]
v_min3_u32 v27,v27,v248,v252
buffer_load_dwordx4 v16,s[20:23],s65 offen offset:0 sc1 lds
v_mfma_f32_16x16x32_bf16 v[68:71],a[152:155],v[248:251],v[68:71]
ds_read_b128 v[244:247],v18 offset:26624
v_mfma_f32_16x16x32_bf16 v[64:67],a[28:31],v[252:255],v[64:67]
buffer_load_dwordx4 v16,s[20:23],s65 offen offset:2048 sc1 lds
v_mfma_f32_16x16x32_bf16 v[68:71],a[156:159],v[252:255],v[68:71]
ds_read_b128 v[248:251],v18 offset:28672
s_waitcnt lgkmcnt(5)
v_mfma_f32_16x16x32_bf16 v[64:67],a[32:35],v[224:227],v[64:67]
v_min3_u32 v27,v27,v224,v228
s_xor_b32 m0,s91,50176
v_mfma_f32_16x16x32_bf16 v[68:71],a[160:163],v[224:227],v[68:71]
ds_read_b128 v[252:255],v18 offset:30720
v_mfma_f32_16x16x32_bf16 v[64:67],a[36:39],v[228:231],v[64:67]
s_add_u32 s65,s95,98304
v_mfma_f32_16x16x32_bf16 v[68:71],a[164:167],v[228:231],v[68:71]
s_waitcnt vmcnt(6)
s_barrier
ds_read_b128 v[224:227],v18 offset:32768
s_waitcnt lgkmcnt(5)
v_mfma_f32_16x16x32_bf16 v[64:67],a[40:43],v[232:235],v[64:67]
v_min3_u32 v27,v27,v232,v236
buffer_load_dwordx4 v16,s[20:23],s65 offen offset:0 sc1 lds
v_mfma_f32_16x16x32_bf16 v[68:71],a[168:171],v[232:235],v[68:71]
ds_read_b128 v[228:231],v18 offset:34816
v_mfma_f32_16x16x32_bf16 v[64:67],a[44:47],v[236:239],v[64:67]
buffer_load_dwordx4 v16,s[20:23],s65 offen offset:2048 sc1 lds
v_mfma_f32_16x16x32_bf16 v[68:71],a[172:175],v[236:239],v[68:71]
ds_read_b128 v[232:235],v18 offset:36864
s_waitcnt lgkmcnt(5)
v_mfma_f32_16x16x32_bf16 v[64:67],a[48:51],v[240:243],v[64:67]
v_min3_u32 v27,v27,v240,v244
v_mfma_f32_16x16x32_bf16 v[68:71],a[176:179],v[240:243],v[68:71]
ds_read_b128 v[236:239],v18 offset:38912
v_mfma_f32_16x16x32_bf16 v[64:67],a[52:55],v[244:247],v[64:67]
v_add_u32 v22,s71,-1
buffer_store_dwordx4 v[48:51],v26,s[24:27],s48 offen offset:1024
v_mfma_f32_16x16x32_bf16 v[68:71],a[180:183],v[244:247],v[68:71]
ds_read_b128 v[240:243],v18 offset:40960
s_waitcnt lgkmcnt(5)
v_mfma_f32_16x16x32_bf16 v[64:67],a[56:59],v[248:251],v[64:67]
v_min3_u32 v27,v27,v248,v252
buffer_store_dwordx4 v[48:51],v26,s[28:31],s48 offen offset:1024 sc1
v_mfma_f32_16x16x32_bf16 v[68:71],a[184:187],v[248:251],v[68:71]
ds_read_b128 v[244:247],v18 offset:43008
buffer_store_dwordx4 v[48:51],v26,s[24:27],s48 offen offset:2048
v_mfma_f32_16x16x32_bf16 v[64:67],a[60:63],v[252:255],v[64:67]
buffer_store_dword v22,v23,s[20:23],s73 offen sc1
v_mfma_f32_16x16x32_bf16 v[68:71],a[188:191],v[252:255],v[68:71]
ds_read_b128 v[248:251],v18 offset:45056
s_waitcnt lgkmcnt(5)
v_mfma_f32_16x16x32_bf16 v[64:67],a[64:67],v[224:227],v[64:67]
v_min3_u32 v27,v27,v224,v228
buffer_store_dwordx4 v[48:51],v26,s[28:31],s48 offen offset:2048 sc1
v_mfma_f32_16x16x32_bf16 v[68:71],a[192:195],v[224:227],v[68:71]
ds_read_b128 v[252:255],v18 offset:47104
buffer_store_dwordx4 v[48:51],v26,s[24:27],s48 offen offset:3072
v_mfma_f32_16x16x32_bf16 v[64:67],a[68:71],v[228:231],v[64:67]
buffer_store_dwordx4 v[48:51],v26,s[28:31],s48 offen offset:3072 sc1
v_mfma_f32_16x16x32_bf16 v[68:71],a[196:199],v[228:231],v[68:71]
ds_read_b128 v[224:227],v18 offset:49152
s_waitcnt lgkmcnt(5)
v_mfma_f32_16x16x32_bf16 v[64:67],a[72:75],v[232:235],v[64:67]
v_min3_u32 v27,v27,v232,v236
s_mov_b32 s48,0x7fff0000
v_mfma_f32_16x16x32_bf16 v[68:71],a[200:203],v[232:235],v[68:71]
ds_read_b128 v[228:231],v18 offset:51200
v_mfma_f32_16x16x32_bf16 v[64:67],a[76:79],v[236:239],v[64:67]
buffer_load_dwordx2 v[120:121],v20,s[36:39],s78 offen
v_mfma_f32_16x16x32_bf16 v[68:71],a[204:207],v[236:239],v[68:71]
ds_read_b128 v[232:235],v18 offset:53248
s_waitcnt lgkmcnt(5)
v_mfma_f32_16x16x32_bf16 v[64:67],a[80:83],v[240:243],v[64:67]
s_waitcnt vmcnt(12)
s_barrier
ds_read_b128 v[128:131],v17 offset:0
ds_read_b128 v[132:135],v17 offset:2048
v_mfma_f32_16x16x32_bf16 v[68:71],a[208:211],v[240:243],v[68:71]
ds_read_b128 v[236:239],v18 offset:55296
v_min3_u32 v27,v27,v240,v244
v_mfma_f32_16x16x32_bf16 v[64:67],a[84:87],v[244:247],v[64:67]
ds_read_b128 v[136:139],v17 offset:4096
v_mfma_f32_16x16x32_bf16 v[68:71],a[212:215],v[244:247],v[68:71]
ds_read_b128 v[240:243],v18 offset:57344
s_waitcnt lgkmcnt(8)
v_mfma_f32_16x16x32_bf16 v[64:67],a[88:91],v[248:251],v[64:67]
ds_read_b128 v[140:143],v17 offset:6144
v_min3_u32 v27,v27,v248,v252
v_mfma_f32_16x16x32_bf16 v[68:71],a[216:219],v[248:251],v[68:71]
ds_read_b128 v[244:247],v18 offset:59392
s_add_u32 s92,s70,8388608
v_mfma_f32_16x16x32_bf16 v[64:67],a[92:95],v[252:255],v[64:67]
ds_read_b128 v[144:147],v17 offset:8192
ds_read_b128 v[148:151],v17 offset:10240
v_mfma_f32_16x16x32_bf16 v[68:71],a[220:223],v[252:255],v[68:71]
ds_read_b128 v[248:251],v18 offset:61440
s_waitcnt lgkmcnt(11)
v_mfma_f32_16x16x32_bf16 v[64:67],a[96:99],v[224:227],v[64:67]
ds_read_b128 v[152:155],v17 offset:12288
v_min3_u32 v27,v27,v224,v228
v_mfma_f32_16x16x32_bf16 v[68:71],a[224:227],v[224:227],v[68:71]
ds_read_b128 v[252:255],v18 offset:63488
s_sub_u32 s93,s71,53
v_mfma_f32_16x16x32_bf16 v[64:67],a[100:103],v[228:231],v[64:67]
ds_read_b128 v[156:159],v17 offset:14336
v_mfma_f32_16x16x32_bf16 v[68:71],a[228:231],v[228:231],v[68:71]
s_waitcnt lgkmcnt(10)
v_mfma_f32_16x16x32_bf16 v[64:67],a[104:107],v[232:235],v[64:67]
ds_read_b128 v[160:163],v17 offset:16384
ds_read_b128 v[164:167],v17 offset:18432
v_mfma_f32_16x16x32_bf16 v[68:71],a[232:235],v[232:235],v[68:71]
v_min3_u32 v27,v27,v232,v236
v_mfma_f32_16x16x32_bf16 v[64:67],a[108:111],v[236:239],v[64:67]
ds_read_b128 v[168:171],v17 offset:20480
v_mfma_f32_16x16x32_bf16 v[68:71],a[236:239],v[236:239],v[68:71]
s_waitcnt lgkmcnt(9)
v_mfma_f32_16x16x32_bf16 v[64:67],a[112:115],v[240:243],v[64:67]
ds_read_b128 v[172:175],v17 offset:22528
v_min3_u32 v27,v27,v240,v244
v_mfma_f32_16x16x32_bf16 v[68:71],a[240:243],v[240:243],v[68:71]
s_cmp_lt_u32 s93,8
s_cselect_b32 s92,s92,0x7fff0000
v_mfma_f32_16x16x32_bf16 v[64:67],a[116:119],v[244:247],v[64:67]
ds_read_b128 v[176:179],v17 offset:24576
ds_read_b128 v[180:183],v17 offset:26624
v_mfma_f32_16x16x32_bf16 v[68:71],a[244:247],v[244:247],v[68:71]
s_waitcnt lgkmcnt(7)
v_mfma_f32_16x16x32_bf16 v[64:67],a[120:123],v[248:251],v[64:67]
ds_read_b128 v[184:187],v17 offset:28672
v_min3_u32 v27,v27,v248,v252
v_mfma_f32_16x16x32_bf16 v[68:71],a[248:251],v[248:251],v[68:71]
buffer_store_dwordx2 v[48:49],v19,s[20:23],s92 offen sc1
v_mfma_f32_16x16x32_bf16 v[64:67],a[124:127],v[252:255],v[64:67]
ds_read_b128 v[188:191],v17 offset:30720
buffer_load_dword v2,v21,s[20:23],s87 offen sc1
v_mfma_f32_16x16x32_bf16 v[68:71],a[252:255],v[252:255],v[68:71]
s_add_u32 s96,s71,2
v_mfma_f32_16x16x32_bf16 v[72:75],a[128:131],v[128:131],0
v_cmp_eq_u32 vcc,0,v27
s_cbranch_vccnz retry_240
v_mfma_f32_16x16x32_bf16 v[76:79],a[132:135],v[132:135],0
v_min3_u32 v27,v27,v128,v132
s_cmp_gt_u32 s96,56
s_addc_u32 s96,s96,0
v_mfma_f32_16x16x32_bf16 v[72:75],a[136:139],v[136:139],v[72:75]
s_waitcnt vmcnt(10)
s_barrier
ds_read_b128 v[192:195],v17 offset:32768
v_mfma_f32_16x16x32_bf16 v[76:79],a[140:143],v[140:143],v[76:79]
ds_read_b128 v[196:199],v17 offset:34816
s_waitcnt lgkmcnt(10)
v_mfma_f32_16x16x32_bf16 v[72:75],a[144:147],v[144:147],v[72:75]
ds_read_b128 v[200:203],v17 offset:36864
v_min3_u32 v27,v27,v136,v140
s_waitcnt vmcnt(2)
v_mfma_f32_16x16x32_bf16 v[76:79],a[148:151],v[148:151],v[76:79]
ds_read_b128 v[204:207],v17 offset:38912
v_min3_u32 v27,v27,v144,v148
v_max_u32 v64,1,v64
v_mfma_f32_16x16x32_bf16 v[72:75],a[152:155],v[152:155],v[72:75]
ds_read_b128 v[208:211],v17 offset:40960
s_add_u32 s64,s49,s34
v_mfma_f32_16x16x32_bf16 v[76:79],a[156:159],v[156:159],v[76:79]
v_min3_u32 v27,v27,v152,v156
s_waitcnt lgkmcnt(9)
v_mfma_f32_16x16x32_bf16 v[72:75],a[160:163],v[160:163],v[72:75]
ds_read_b128 v[212:215],v17 offset:43008
buffer_store_dwordx4 v[64:67],v25,s[24:27],s64 offen offset:2048
v_mfma_f32_16x16x32_bf16 v[76:79],a[164:167],v[164:167],v[76:79]
ds_read_b128 v[216:219],v17 offset:45056
v_min3_u32 v27,v27,v160,v164
v_mfma_f32_16x16x32_bf16 v[72:75],a[168:171],v[168:171],v[72:75]
ds_read_b128 v[220:223],v17 offset:47104
buffer_store_dwordx4 v[64:67],v25,s[28:31],s64 offen offset:2048 sc1
v_mfma_f32_16x16x32_bf16 v[76:79],a[172:175],v[172:175],v[76:79]
ds_read_b128 v[224:227],v17 offset:49152
v_max_u32 v68,1,v68
s_waitcnt lgkmcnt(9)
v_mfma_f32_16x16x32_bf16 v[72:75],a[176:179],v[176:179],v[72:75]
ds_read_b128 v[228:231],v17 offset:51200
v_min3_u32 v27,v27,v168,v172
s_add_u32 s64,s49,s35
v_mfma_f32_16x16x32_bf16 v[76:79],a[180:183],v[180:183],v[76:79]
v_min3_u32 v27,v27,v176,v180
buffer_store_dwordx4 v[68:71],v25,s[24:27],s64 offen offset:3072
v_mfma_f32_16x16x32_bf16 v[72:75],a[184:187],v[184:187],v[72:75]
ds_read_b128 v[232:235],v17 offset:53248
buffer_store_dwordx4 v[68:71],v25,s[28:31],s64 offen offset:3072 sc1
v_mfma_f32_16x16x32_bf16 v[76:79],a[188:191],v[188:191],v[76:79]
ds_read_b128 v[236:239],v17 offset:55296
s_mov_b32 s49,0x7fff0000
s_waitcnt lgkmcnt(8)
v_mfma_f32_16x16x32_bf16 v[72:75],a[192:195],v[192:195],v[72:75]
ds_read_b128 v[240:243],v17 offset:57344
v_min3_u32 v27,v27,v184,v188
v_mfma_f32_16x16x32_bf16 v[76:79],a[196:199],v[196:199],v[76:79]
ds_read_b128 v[244:247],v17 offset:59392
v_min3_u32 v27,v27,v192,v196
v_mfma_f32_16x16x32_bf16 v[72:75],a[200:203],v[200:203],v[72:75]
ds_read_b128 v[248:251],v17 offset:61440
ds_bpermute_b32 v124,v41,v120
v_mfma_f32_16x16x32_bf16 v[76:79],a[204:207],v[204:207],v[76:79]
v_min3_u32 v27,v27,v200,v204
s_waitcnt lgkmcnt(8)
v_mfma_f32_16x16x32_bf16 v[72:75],a[208:211],v[208:211],v[72:75]
ds_read_b128 v[252:255],v17 offset:63488
ds_bpermute_b32 v125,v41,v121
v_mfma_f32_16x16x32_bf16 v[76:79],a[212:215],v[212:215],v[76:79]
v_min3_u32 v27,v27,v208,v212
v_mfma_f32_16x16x32_bf16 v[72:75],a[216:219],v[216:219],v[72:75]
v_mfma_f32_16x16x32_bf16 v[76:79],a[220:223],v[220:223],v[76:79]
v_min3_u32 v27,v27,v216,v220
s_waitcnt lgkmcnt(6)
v_mfma_f32_16x16x32_bf16 v[72:75],a[224:227],v[224:227],v[72:75]
s_waitcnt lgkmcnt(0)
v_mfma_f32_16x16x32_bf16 v[76:79],a[228:231],v[228:231],v[76:79]
v_min3_u32 v27,v27,v224,v228
v_mfma_f32_16x16x32_bf16 v[72:75],a[232:235],v[232:235],v[72:75]
v_lshlrev_b32 v104,16,v124
v_mfma_f32_16x16x32_bf16 v[76:79],a[236:239],v[236:239],v[76:79]
v_min3_u32 v27,v27,v232,v236
v_mfma_f32_16x16x32_bf16 v[72:75],a[240:243],v[240:243],v[72:75]
v_mfma_f32_16x16x32_bf16 v[76:79],a[244:247],v[244:247],v[76:79]
v_min3_u32 v27,v27,v240,v244
v_mfma_f32_16x16x32_bf16 v[72:75],a[248:251],v[248:251],v[72:75]
v_and_b32 v105,s80,v124
v_mfma_f32_16x16x32_bf16 v[76:79],a[252:255],v[252:255],v[76:79]
v_min3_u32 v27,v27,v248,v252
v_mfma_f32_16x16x32_bf16 v[80:83],a[0:3],v[128:131],0
v_cmp_eq_u32 vcc,0,v27
s_cbranch_vccnz retry_240
v_mfma_f32_16x16x32_bf16 v[84:87],a[4:7],v[132:135],0
v_lshlrev_b32 v106,16,v125
v_mfma_f32_16x16x32_bf16 v[80:83],a[8:11],v[136:139],v[80:83]
v_mfma_f32_16x16x32_bf16 v[84:87],a[12:15],v[140:143],v[84:87]
v_mfma_f32_16x16x32_bf16 v[80:83],a[16:19],v[144:147],v[80:83]
v_and_b32 v107,s80,v125
v_add_f32 v72,v72,v76
v_mfma_f32_16x16x32_bf16 v[84:87],a[20:23],v[148:151],v[84:87]
v_add_f32 v73,v73,v77
v_add_f32 v74,v74,v78
v_mfma_f32_16x16x32_bf16 v[80:83],a[24:27],v[152:155],v[80:83]
v_add_f32 v75,v75,v79
v_max_u32 v72,1,v72
v_mfma_f32_16x16x32_bf16 v[84:87],a[28:31],v[156:159],v[84:87]
s_add_u32 s64,s77,s33
v_mfma_f32_16x16x32_bf16 v[80:83],a[32:35],v[160:163],v[80:83]
buffer_store_dwordx4 v[72:75],v25,s[24:27],s64 offen offset:1024
v_mfma_f32_16x16x32_bf16 v[84:87],a[36:39],v[164:167],v[84:87]
buffer_store_dwordx4 v[72:75],v25,s[28:31],s64 offen offset:1024 sc1
v_mfma_f32_16x16x32_bf16 v[80:83],a[40:43],v[168:171],v[80:83]
v_mfma_f32_16x16x32_bf16 v[84:87],a[44:47],v[172:175],v[84:87]
v_mfma_f32_16x16x32_bf16 v[80:83],a[48:51],v[176:179],v[80:83]
v_mfma_f32_16x16x32_bf16 v[84:87],a[52:55],v[180:183],v[84:87]
v_mfma_f32_16x16x32_bf16 v[80:83],a[56:59],v[184:187],v[80:83]
v_mfma_f32_16x16x32_bf16 v[84:87],a[60:63],v[188:191],v[84:87]
v_mfma_f32_16x16x32_bf16 v[80:83],a[64:67],v[192:195],v[80:83]
buffer_load_dwordx4 v[96:99],v26,s[20:23],s77 offen offset:2048 sc1
v_mfma_f32_16x16x32_bf16 v[84:87],a[68:71],v[196:199],v[84:87]
buffer_load_dwordx4 v[100:103],v26,s[20:23],s77 offen offset:3072 sc1
v_mfma_f32_16x16x32_bf16 v[80:83],a[72:75],v[200:203],v[80:83]
v_mfma_f32_16x16x32_bf16 v[84:87],a[76:79],v[204:207],v[84:87]
v_mfma_f32_16x16x32_bf16 v[80:83],a[80:83],v[208:211],v[80:83]
s_waitcnt vmcnt(8)
v_mfma_f32_16x16x32_bf16 v[84:87],a[84:87],v[212:215],v[84:87]
v_cmp_gt_u32 vcc,s96,v2
s_mov_b32 s96,vcc_lo
v_mfma_f32_16x16x32_bf16 v[80:83],a[88:91],v[216:219],v[80:83]
v_mov_b32 v44,s96
ds_write_b32 v46,v44
v_mfma_f32_16x16x32_bf16 v[84:87],a[92:95],v[220:223],v[84:87]
v_mfma_f32_16x16x32_bf16 v[80:83],a[96:99],v[224:227],v[80:83]
v_mfma_f32_16x16x32_bf16 v[84:87],a[100:103],v[228:231],v[84:87]
v_mfma_f32_16x16x32_bf16 v[80:83],a[104:107],v[232:235],v[80:83]
buffer_load_dwordx4 v[92:95],v26,s[20:23],s77 offen offset:1024 sc1
v_mfma_f32_16x16x32_bf16 v[84:87],a[108:111],v[236:239],v[84:87]
v_mfma_f32_16x16x32_bf16 v[80:83],a[112:115],v[240:243],v[80:83]
v_mfma_f32_16x16x32_bf16 v[84:87],a[116:119],v[244:247],v[84:87]
v_mfma_f32_16x16x32_bf16 v[80:83],a[120:123],v[248:251],v[80:83]
v_mfma_f32_16x16x32_bf16 v[84:87],a[124:127],v[252:255],v[84:87]
s_branch epi_243
both_244:
s_waitcnt vmcnt(8)
s_barrier
ds_read_b128 v[224:227],v18 offset:0
ds_read_b128 v[228:231],v18 offset:2048
ds_read_b128 v[232:235],v18 offset:4096
ds_read_b128 v[236:239],v18 offset:6144
ds_read_b128 v[240:243],v18 offset:8192
ds_read_b128 v[244:247],v18 offset:10240
ds_read_b128 v[248:251],v18 offset:12288
s_waitcnt lgkmcnt(5)
v_mfma_f32_16x16x32_bf16 v[64:67],a[0:3],v[224:227],0
v_min_u32 v27,v224,v228
s_xor_b32 m0,s91,17408
v_mfma_f32_16x16x32_bf16 v[68:71],a[128:131],v[224:227],0
ds_read_b128 v[252:255],v18 offset:14336
s_add_u32 s88,s70,s75
v_mfma_f32_16x16x32_bf16 v[64:67],a[4:7],v[228:231],v[64:67]
s_add_u32 s65,s95,32768
s_add_u32 s88,s88,2097152
v_mfma_f32_16x16x32_bf16 v[68:71],a[132:135],v[228:231],v[68:71]
s_waitcnt vmcnt(6)
s_barrier
ds_read_b128 v[224:227],v18 offset:16384
s_waitcnt lgkmcnt(5)
v_mfma_f32_16x16x32_bf16 v[64:67],a[8:11],v[232:235],v[64:67]
v_min3_u32 v27,v27,v232,v236
buffer_load_dwordx4 v16,s[20:23],s65 offen offset:0 sc1 lds
v_mfma_f32_16x16x32_bf16 v[68:71],a[136:139],v[232:235],v[68:71]
ds_read_b128 v[228:231],v18 offset:18432
s_xor_b32 s88,s88,0x2000
v_mfma_f32_16x16x32_bf16 v[64:67],a[12:15],v[236:239],v[64:67]
buffer_load_dwordx4 v16,s[20:23],s65 offen offset:2048 sc1 lds
v_mfma_f32_16x16x32_bf16 v[68:71],a[140:143],v[236:239],v[68:71]
ds_read_b128 v[232:235],v18 offset:20480
s_waitcnt lgkmcnt(5)
v_mfma_f32_16x16x32_bf16 v[64:67],a[16:19],v[240:243],v[64:67]
v_min3_u32 v27,v27,v240,v244
s_xor_b32 m0,s91,33792
v_mfma_f32_16x16x32_bf16 v[68:71],a[144:147],v[240:243],v[68:71]
ds_read_b128 v[236:239],v18 offset:22528
s_xor_b32 s89,s88,1024
v_mfma_f32_16x16x32_bf16 v[64:67],a[20:23],v[244:247],v[64:67]
s_add_u32 s65,s95,65536
v_mfma_f32_16x16x32_bf16 v[68:71],a[148:151],v[244:247],v[68:71]
ds_read_b128 v[240:243],v18 offset:24576
s_waitcnt lgkmcnt(5)
v_mfma_f32_16x16x32_bf16 v[64:67],a[24:27],v[248:251],v[64:67]
v_min3_u32 v27,v27,v248,v252
buffer_load_dwordx4 v16,s[20:23],s65 offen offset:0 sc1 lds
v_mfma_f32_16x16x32_bf16 v[68:71],a[152:155],v[248:251],v[68:71]
ds_read_b128 v[244:247],v18 offset:26624
v_mfma_f32_16x16x32_bf16 v[64:67],a[28:31],v[252:255],v[64:67]
buffer_load_dwordx4 v16,s[20:23],s65 offen offset:2048 sc1 lds
v_mfma_f32_16x16x32_bf16 v[68:71],a[156:159],v[252:255],v[68:71]
ds_read_b128 v[248:251],v18 offset:28672
s_waitcnt lgkmcnt(5)
v_mfma_f32_16x16x32_bf16 v[64:67],a[32:35],v[224:227],v[64:67]
v_min3_u32 v27,v27,v224,v228
s_xor_b32 m0,s91,50176
v_mfma_f32_16x16x32_bf16 v[68:71],a[160:163],v[224:227],v[68:71]
ds_read_b128 v[252:255],v18 offset:30720
v_mfma_f32_16x16x32_bf16 v[64:67],a[36:39],v[228:231],v[64:67]
s_add_u32 s65,s95,98304
v_mfma_f32_16x16x32_bf16 v[68:71],a[164:167],v[228:231],v[68:71]
s_waitcnt vmcnt(6)
s_barrier
ds_read_b128 v[224:227],v18 offset:32768
s_waitcnt lgkmcnt(5)
v_mfma_f32_16x16x32_bf16 v[64:67],a[40:43],v[232:235],v[64:67]
v_min3_u32 v27,v27,v232,v236
buffer_load_dwordx4 v16,s[20:23],s65 offen offset:0 sc1 lds
v_mfma_f32_16x16x32_bf16 v[68:71],a[168:171],v[232:235],v[68:71]
ds_read_b128 v[228:231],v18 offset:34816
v_mfma_f32_16x16x32_bf16 v[64:67],a[44:47],v[236:239],v[64:67]
buffer_load_dwordx4 v16,s[20:23],s65 offen offset:2048 sc1 lds
v_mfma_f32_16x16x32_bf16 v[68:71],a[172:175],v[236:239],v[68:71]
ds_read_b128 v[232:235],v18 offset:36864
s_waitcnt lgkmcnt(5)
v_mfma_f32_16x16x32_bf16 v[64:67],a[48:51],v[240:243],v[64:67]
v_min3_u32 v27,v27,v240,v244
v_mfma_f32_16x16x32_bf16 v[68:71],a[176:179],v[240:243],v[68:71]
ds_read_b128 v[236:239],v18 offset:38912
v_mfma_f32_16x16x32_bf16 v[64:67],a[52:55],v[244:247],v[64:67]
v_add_u32 v22,s71,-1
buffer_store_dwordx4 v[48:51],v26,s[24:27],s48 offen offset:1024
v_mfma_f32_16x16x32_bf16 v[68:71],a[180:183],v[244:247],v[68:71]
ds_read_b128 v[240:243],v18 offset:40960
s_waitcnt lgkmcnt(5)
v_mfma_f32_16x16x32_bf16 v[64:67],a[56:59],v[248:251],v[64:67]
v_min3_u32 v27,v27,v248,v252
buffer_store_dwordx4 v[48:51],v26,s[28:31],s48 offen offset:1024 sc1
v_mfma_f32_16x16x32_bf16 v[68:71],a[184:187],v[248:251],v[68:71]
ds_read_b128 v[244:247],v18 offset:43008
buffer_store_dwordx4 v[48:51],v26,s[24:27],s48 offen offset:2048
v_mfma_f32_16x16x32_bf16 v[64:67],a[60:63],v[252:255],v[64:67]
buffer_store_dword v22,v23,s[20:23],s73 offen sc1
v_mfma_f32_16x16x32_bf16 v[68:71],a[188:191],v[252:255],v[68:71]
ds_read_b128 v[248:251],v18 offset:45056
s_waitcnt lgkmcnt(5)
v_mfma_f32_16x16x32_bf16 v[64:67],a[64:67],v[224:227],v[64:67]
v_min3_u32 v27,v27,v224,v228
buffer_store_dwordx4 v[48:51],v26,s[28:31],s48 offen offset:2048 sc1
v_mfma_f32_16x16x32_bf16 v[68:71],a[192:195],v[224:227],v[68:71]
ds_read_b128 v[252:255],v18 offset:47104
buffer_store_dwordx4 v[48:51],v26,s[24:27],s48 offen offset:3072
v_mfma_f32_16x16x32_bf16 v[64:67],a[68:71],v[228:231],v[64:67]
buffer_store_dwordx4 v[48:51],v26,s[28:31],s48 offen offset:3072 sc1
s_xor_b32 m0,s72,0
v_mfma_f32_16x16x32_bf16 v[68:71],a[196:199],v[228:231],v[68:71]
ds_read_b128 v[224:227],v18 offset:49152
s_add_u32 s65,s88,0
s_waitcnt lgkmcnt(5)
v_mfma_f32_16x16x32_bf16 v[64:67],a[72:75],v[232:235],v[64:67]
v_min3_u32 v27,v27,v232,v236
s_mov_b32 s48,0x7fff0000
v_mfma_f32_16x16x32_bf16 v[68:71],a[200:203],v[232:235],v[68:71]
ds_read_b128 v[228:231],v18 offset:51200
buffer_load_dwordx4 v16,s[20:23],s65 offen offset:0 sc1 lds
v_mfma_f32_16x16x32_bf16 v[64:67],a[76:79],v[236:239],v[64:67]
buffer_load_dwordx2 v[120:121],v20,s[36:39],s78 offen
v_mfma_f32_16x16x32_bf16 v[68:71],a[204:207],v[236:239],v[68:71]
ds_read_b128 v[232:235],v18 offset:53248
s_waitcnt lgkmcnt(5)
v_mfma_f32_16x16x32_bf16 v[64:67],a[80:83],v[240:243],v[64:67]
s_waitcnt vmcnt(13)
s_barrier
ds_read_b128 v[128:131],v17 offset:0
ds_read_b128 v[132:135],v17 offset:2048
v_mfma_f32_16x16x32_bf16 v[68:71],a[208:211],v[240:243],v[68:71]
ds_read_b128 v[236:239],v18 offset:55296
v_min3_u32 v27,v27,v240,v244
v_mfma_f32_16x16x32_bf16 v[64:67],a[84:87],v[244:247],v[64:67]
ds_read_b128 v[136:139],v17 offset:4096
buffer_load_dwordx4 v16,s[20:23],s65 offen offset:2048 sc1 lds
v_mfma_f32_16x16x32_bf16 v[68:71],a[212:215],v[244:247],v[68:71]
ds_read_b128 v[240:243],v18 offset:57344
s_waitcnt lgkmcnt(8)
v_mfma_f32_16x16x32_bf16 v[64:67],a[88:91],v[248:251],v[64:67]
ds_read_b128 v[140:143],v17 offset:6144
v_min3_u32 v27,v27,v248,v252
v_mfma_f32_16x16x32_bf16 v[68:71],a[216:219],v[248:251],v[68:71]
ds_read_b128 v[244:247],v18 offset:59392
s_add_u32 s92,s70,8388608
v_mfma_f32_16x16x32_bf16 v[64:67],a[92:95],v[252:255],v[64:67]
ds_read_b128 v[144:147],v17 offset:8192
ds_read_b128 v[148:151],v17 offset:10240
v_mfma_f32_16x16x32_bf16 v[68:71],a[220:223],v[252:255],v[68:71]
ds_read_b128 v[248:251],v18 offset:61440
s_waitcnt lgkmcnt(11)
v_mfma_f32_16x16x32_bf16 v[64:67],a[96:99],v[224:227],v[64:67]
ds_read_b128 v[152:155],v17 offset:12288
v_min3_u32 v27,v27,v224,v228
v_mfma_f32_16x16x32_bf16 v[68:71],a[224:227],v[224:227],v[68:71]
ds_read_b128 v[252:255],v18 offset:63488
s_sub_u32 s93,s71,53
v_mfma_f32_16x16x32_bf16 v[64:67],a[100:103],v[228:231],v[64:67]
ds_read_b128 v[156:159],v17 offset:14336
s_xor_b32 m0,s72,16384
v_mfma_f32_16x16x32_bf16 v[68:71],a[228:231],v[228:231],v[68:71]
s_add_u32 s65,s88,32768
s_waitcnt lgkmcnt(10)
v_mfma_f32_16x16x32_bf16 v[64:67],a[104:107],v[232:235],v[64:67]
ds_read_b128 v[160:163],v17 offset:16384
ds_read_b128 v[164:167],v17 offset:18432
v_mfma_f32_16x16x32_bf16 v[68:71],a[232:235],v[232:235],v[68:71]
v_min3_u32 v27,v27,v232,v236
v_mfma_f32_16x16x32_bf16 v[64:67],a[108:111],v[236:239],v[64:67]
ds_read_b128 v[168:171],v17 offset:20480
v_mfma_f32_16x16x32_bf16 v[68:71],a[236:239],v[236:239],v[68:71]
s_waitcnt lgkmcnt(9)
v_mfma_f32_16x16x32_bf16 v[64:67],a[112:115],v[240:243],v[64:67]
ds_read_b128 v[172:175],v17 offset:22528
v_min3_u32 v27,v27,v240,v244
v_mfma_f32_16x16x32_bf16 v[68:71],a[240:243],v[240:243],v[68:71]
s_cmp_lt_u32 s93,8
s_cselect_b32 s92,s92,0x7fff0000
v_mfma_f32_16x16x32_bf16 v[64:67],a[116:119],v[244:247],v[64:67]
ds_read_b128 v[176:179],v17 offset:24576
ds_read_b128 v[180:183],v17 offset:26624
v_mfma_f32_16x16x32_bf16 v[68:71],a[244:247],v[244:247],v[68:71]
s_waitcnt lgkmcnt(7)
v_mfma_f32_16x16x32_bf16 v[64:67],a[120:123],v[248:251],v[64:67]
ds_read_b128 v[184:187],v17 offset:28672
v_min3_u32 v27,v27,v248,v252
v_mfma_f32_16x16x32_bf16 v[68:71],a[248:251],v[248:251],v[68:71]
buffer_store_dwordx2 v[48:49],v19,s[20:23],s92 offen sc1
v_mfma_f32_16x16x32_bf16 v[64:67],a[124:127],v[252:255],v[64:67]
ds_read_b128 v[188:191],v17 offset:30720
buffer_load_dword v2,v21,s[20:23],s87 offen sc1
v_mfma_f32_16x16x32_bf16 v[68:71],a[252:255],v[252:255],v[68:71]
s_add_u32 s96,s71,2
v_mfma_f32_16x16x32_bf16 v[72:75],a[128:131],v[128:131],0
v_cmp_eq_u32 vcc,0,v27
s_cbranch_vccnz retry_240
v_mfma_f32_16x16x32_bf16 v[76:79],a[132:135],v[132:135],0
v_min3_u32 v27,v27,v128,v132
s_cmp_gt_u32 s96,56
s_addc_u32 s96,s96,0
v_mfma_f32_16x16x32_bf16 v[72:75],a[136:139],v[136:139],v[72:75]
s_waitcnt vmcnt(12)
s_barrier
ds_read_b128 v[192:195],v17 offset:32768
v_mfma_f32_16x16x32_bf16 v[76:79],a[140:143],v[140:143],v[76:79]
ds_read_b128 v[196:199],v17 offset:34816
s_waitcnt lgkmcnt(10)
v_mfma_f32_16x16x32_bf16 v[72:75],a[144:147],v[144:147],v[72:75]
ds_read_b128 v[200:203],v17 offset:36864
v_min3_u32 v27,v27,v136,v140
s_waitcnt vmcnt(3)
v_mfma_f32_16x16x32_bf16 v[76:79],a[148:151],v[148:151],v[76:79]
ds_read_b128 v[204:207],v17 offset:38912
v_min3_u32 v27,v27,v144,v148
v_max_u32 v64,1,v64
v_mfma_f32_16x16x32_bf16 v[72:75],a[152:155],v[152:155],v[72:75]
ds_read_b128 v[208:211],v17 offset:40960
s_add_u32 s64,s49,s34
v_mfma_f32_16x16x32_bf16 v[76:79],a[156:159],v[156:159],v[76:79]
v_min3_u32 v27,v27,v152,v156
s_waitcnt lgkmcnt(9)
v_mfma_f32_16x16x32_bf16 v[72:75],a[160:163],v[160:163],v[72:75]
ds_read_b128 v[212:215],v17 offset:43008
buffer_store_dwordx4 v[64:67],v25,s[24:27],s64 offen offset:2048
v_mfma_f32_16x16x32_bf16 v[76:79],a[164:167],v[164:167],v[76:79]
ds_read_b128 v[216:219],v17 offset:45056
v_min3_u32 v27,v27,v160,v164
v_mfma_f32_16x16x32_bf16 v[72:75],a[168:171],v[168:171],v[72:75]
ds_read_b128 v[220:223],v17 offset:47104
buffer_store_dwordx4 v[64:67],v25,s[28:31],s64 offen offset:2048 sc1
v_mfma_f32_16x16x32_bf16 v[76:79],a[172:175],v[172:175],v[76:79]
ds_read_b128 v[224:227],v17 offset:49152
v_max_u32 v68,1,v68
s_waitcnt lgkmcnt(9)
v_mfma_f32_16x16x32_bf16 v[72:75],a[176:179],v[176:179],v[72:75]
ds_read_b128 v[228:231],v17 offset:51200
v_min3_u32 v27,v27,v168,v172
s_add_u32 s64,s49,s35
v_mfma_f32_16x16x32_bf16 v[76:79],a[180:183],v[180:183],v[76:79]
v_min3_u32 v27,v27,v176,v180
buffer_store_dwordx4 v[68:71],v25,s[24:27],s64 offen offset:3072
v_mfma_f32_16x16x32_bf16 v[72:75],a[184:187],v[184:187],v[72:75]
ds_read_b128 v[232:235],v17 offset:53248
buffer_store_dwordx4 v[68:71],v25,s[28:31],s64 offen offset:3072 sc1
v_mfma_f32_16x16x32_bf16 v[76:79],a[188:191],v[188:191],v[76:79]
ds_read_b128 v[236:239],v17 offset:55296
s_mov_b32 s49,0x7fff0000
s_waitcnt lgkmcnt(8)
v_mfma_f32_16x16x32_bf16 v[72:75],a[192:195],v[192:195],v[72:75]
ds_read_b128 v[240:243],v17 offset:57344
v_min3_u32 v27,v27,v184,v188
v_mfma_f32_16x16x32_bf16 v[76:79],a[196:199],v[196:199],v[76:79]
ds_read_b128 v[244:247],v17 offset:59392
v_min3_u32 v27,v27,v192,v196
v_mfma_f32_16x16x32_bf16 v[72:75],a[200:203],v[200:203],v[72:75]
ds_read_b128 v[248:251],v17 offset:61440
ds_bpermute_b32 v124,v41,v120
v_mfma_f32_16x16x32_bf16 v[76:79],a[204:207],v[204:207],v[76:79]
v_min3_u32 v27,v27,v200,v204
s_waitcnt lgkmcnt(8)
v_mfma_f32_16x16x32_bf16 v[72:75],a[208:211],v[208:211],v[72:75]
ds_read_b128 v[252:255],v17 offset:63488
ds_bpermute_b32 v125,v41,v121
v_mfma_f32_16x16x32_bf16 v[76:79],a[212:215],v[212:215],v[76:79]
v_min3_u32 v27,v27,v208,v212
v_mfma_f32_16x16x32_bf16 v[72:75],a[216:219],v[216:219],v[72:75]
buffer_load_dwordx4 v16,s[20:23],s65 offen offset:0 sc1 lds
v_mfma_f32_16x16x32_bf16 v[76:79],a[220:223],v[220:223],v[76:79]
v_min3_u32 v27,v27,v216,v220
s_waitcnt lgkmcnt(6)
v_mfma_f32_16x16x32_bf16 v[72:75],a[224:227],v[224:227],v[72:75]
s_waitcnt lgkmcnt(0)
v_mfma_f32_16x16x32_bf16 v[76:79],a[228:231],v[228:231],v[76:79]
v_min3_u32 v27,v27,v224,v228
v_mfma_f32_16x16x32_bf16 v[72:75],a[232:235],v[232:235],v[72:75]
v_lshlrev_b32 v104,16,v124
v_mfma_f32_16x16x32_bf16 v[76:79],a[236:239],v[236:239],v[76:79]
v_min3_u32 v27,v27,v232,v236
v_mfma_f32_16x16x32_bf16 v[72:75],a[240:243],v[240:243],v[72:75]
buffer_load_dwordx4 v16,s[20:23],s65 offen offset:2048 sc1 lds
v_mfma_f32_16x16x32_bf16 v[76:79],a[244:247],v[244:247],v[76:79]
v_min3_u32 v27,v27,v240,v244
s_xor_b32 m0,s72,32768
v_mfma_f32_16x16x32_bf16 v[72:75],a[248:251],v[248:251],v[72:75]
v_and_b32 v105,s80,v124
s_add_u32 s65,s88,65536
v_mfma_f32_16x16x32_bf16 v[76:79],a[252:255],v[252:255],v[76:79]
v_min3_u32 v27,v27,v248,v252
v_mfma_f32_16x16x32_bf16 v[80:83],a[0:3],v[128:131],0
v_cmp_eq_u32 vcc,0,v27
s_cbranch_vccnz retry_240
v_mfma_f32_16x16x32_bf16 v[84:87],a[4:7],v[132:135],0
v_lshlrev_b32 v106,16,v125
v_mfma_f32_16x16x32_bf16 v[80:83],a[8:11],v[136:139],v[80:83]
buffer_load_dwordx4 v16,s[20:23],s65 offen offset:0 sc1 lds
v_mfma_f32_16x16x32_bf16 v[84:87],a[12:15],v[140:143],v[84:87]
buffer_load_dwordx4 v16,s[20:23],s65 offen offset:2048 sc1 lds
v_mfma_f32_16x16x32_bf16 v[80:83],a[16:19],v[144:147],v[80:83]
v_and_b32 v107,s80,v125
v_add_f32 v72,v72,v76
v_mfma_f32_16x16x32_bf16 v[84:87],a[20:23],v[148:151],v[84:87]
v_add_f32 v73,v73,v77
v_add_f32 v74,v74,v78
v_mfma_f32_16x16x32_bf16 v[80:83],a[24:27],v[152:155],v[80:83]
v_add_f32 v75,v75,v79
v_max_u32 v72,1,v72
v_mfma_f32_16x16x32_bf16 v[84:87],a[28:31],v[156:159],v[84:87]
s_add_u32 s64,s77,s33
s_xor_b32 m0,s72,49152
v_mfma_f32_16x16x32_bf16 v[80:83],a[32:35],v[160:163],v[80:83]
buffer_store_dwordx4 v[72:75],v25,s[24:27],s64 offen offset:1024
v_mfma_f32_16x16x32_bf16 v[84:87],a[36:39],v[164:167],v[84:87]
buffer_store_dwordx4 v[72:75],v25,s[28:31],s64 offen offset:1024 sc1
v_mfma_f32_16x16x32_bf16 v[80:83],a[40:43],v[168:171],v[80:83]
s_add_u32 s65,s88,98304
v_mfma_f32_16x16x32_bf16 v[84:87],a[44:47],v[172:175],v[84:87]
buffer_load_dwordx4 v16,s[20:23],s65 offen offset:0 sc1 lds
v_mfma_f32_16x16x32_bf16 v[80:83],a[48:51],v[176:179],v[80:83]
buffer_load_dwordx4 v16,s[20:23],s65 offen offset:2048 sc1 lds
v_mfma_f32_16x16x32_bf16 v[84:87],a[52:55],v[180:183],v[84:87]
s_xor_b32 m0,s72,1024
s_add_u32 s65,s89,0
v_mfma_f32_16x16x32_bf16 v[80:83],a[56:59],v[184:187],v[80:83]
buffer_load_dwordx4 v16,s[20:23],s65 offen offset:0 sc1 lds
v_mfma_f32_16x16x32_bf16 v[84:87],a[60:63],v[188:191],v[84:87]
buffer_load_dwordx4 v16,s[20:23],s65 offen offset:2048 sc1 lds
v_mfma_f32_16x16x32_bf16 v[80:83],a[64:67],v[192:195],v[80:83]
buffer_load_dwordx4 v[96:99],v26,s[20:23],s77 offen offset:2048 sc1
v_mfma_f32_16x16x32_bf16 v[84:87],a[68:71],v[196:199],v[84:87]
buffer_load_dwordx4 v[100:103],v26,s[20:23],s77 offen offset:3072 sc1
v_mfma_f32_16x16x32_bf16 v[80:83],a[72:75],v[200:203],v[80:83]
s_xor_b32 m0,s72,17408
s_add_u32 s65,s89,32768
v_mfma_f32_16x16x32_bf16 v[84:87],a[76:79],v[204:207],v[84:87]
buffer_load_dwordx4 v16,s[20:23],s65 offen offset:0 sc1 lds
v_mfma_f32_16x16x32_bf16 v[80:83],a[80:83],v[208:211],v[80:83]
s_waitcnt vmcnt(17)
v_mfma_f32_16x16x32_bf16 v[84:87],a[84:87],v[212:215],v[84:87]
v_cmp_gt_u32 vcc,s96,v2
s_mov_b32 s96,vcc_lo
v_mfma_f32_16x16x32_bf16 v[80:83],a[88:91],v[216:219],v[80:83]
v_mov_b32 v44,s96
ds_write_b32 v46,v44
v_mfma_f32_16x16x32_bf16 v[84:87],a[92:95],v[220:223],v[84:87]
buffer_load_dwordx4 v16,s[20:23],s65 offen offset:2048 sc1 lds
v_mfma_f32_16x16x32_bf16 v[80:83],a[96:99],v[224:227],v[80:83]
s_xor_b32 m0,s72,33792
s_add_u32 s65,s89,65536
v_mfma_f32_16x16x32_bf16 v[84:87],a[100:103],v[228:231],v[84:87]
buffer_load_dwordx4 v16,s[20:23],s65 offen offset:0 sc1 lds
v_mfma_f32_16x16x32_bf16 v[80:83],a[104:107],v[232:235],v[80:83]
buffer_load_dwordx4 v[92:95],v26,s[20:23],s77 offen offset:1024 sc1
v_mfma_f32_16x16x32_bf16 v[84:87],a[108:111],v[236:239],v[84:87]
buffer_load_dwordx4 v16,s[20:23],s65 offen offset:2048 sc1 lds
v_mfma_f32_16x16x32_bf16 v[80:83],a[112:115],v[240:243],v[80:83]
s_xor_b32 m0,s72,50176
s_add_u32 s65,s89,98304
v_mfma_f32_16x16x32_bf16 v[84:87],a[116:119],v[244:247],v[84:87]
buffer_load_dwordx4 v16,s[20:23],s65 offen offset:0 sc1 lds
v_mfma_f32_16x16x32_bf16 v[80:83],a[120:123],v[248:251],v[80:83]
buffer_load_dwordx4 v16,s[20:23],s65 offen offset:2048 sc1 lds
v_mfma_f32_16x16x32_bf16 v[84:87],a[124:127],v[252:255],v[84:87]
s_branch epi_243
ahead_242:
s_waitcnt vmcnt(3) lgkmcnt(0)
s_barrier
ds_read_b32 v44,v45
ds_read_b128 v[224:227],v18 offset:0
ds_read_b128 v[228:231],v18 offset:2048
ds_read_b128 v[232:235],v18 offset:4096
ds_read_b128 v[236:239],v18 offset:6144
ds_read_b128 v[240:243],v18 offset:8192
ds_read_b128 v[244:247],v18 offset:10240
ds_read_b128 v[248:251],v18 offset:12288
s_waitcnt lgkmcnt(5)
v_mfma_f32_16x16x32_bf16 v[64:67],a[0:3],v[224:227],0
s_add_u32 s88,s70,s75
s_add_u32 s88,s88,2097152
v_mfma_f32_16x16x32_bf16 v[68:71],a[128:131],v[224:227],0
ds_read_b128 v[252:255],v18 offset:14336
s_xor_b32 s88,s88,0x2000
v_mfma_f32_16x16x32_bf16 v[64:67],a[4:7],v[228:231],v[64:67]
v_readfirstlane_b32 s83,v44
v_mfma_f32_16x16x32_bf16 v[68:71],a[132:135],v[228:231],v[68:71]
ds_read_b128 v[224:227],v18 offset:16384
s_waitcnt lgkmcnt(5)
v_mfma_f32_16x16x32_bf16 v[64:67],a[8:11],v[232:235],v[64:67]
s_cmp_eq_u32 s83,0
s_cselect_b32 s88,s88,0x7fff0000
v_mfma_f32_16x16x32_bf16 v[68:71],a[136:139],v[232:235],v[68:71]
ds_read_b128 v[228:231],v18 offset:18432
s_xor_b32 s89,s88,1024
v_mfma_f32_16x16x32_bf16 v[64:67],a[12:15],v[236:239],v[64:67]
buffer_store_dwordx4 v[48:51],v26,s[24:27],s48 offen offset:1024
v_mfma_f32_16x16x32_bf16 v[68:71],a[140:143],v[236:239],v[68:71]
ds_read_b128 v[232:235],v18 offset:20480
s_waitcnt lgkmcnt(5)
v_mfma_f32_16x16x32_bf16 v[64:67],a[16:19],v[240:243],v[64:67]
buffer_store_dwordx4 v[48:51],v26,s[28:31],s48 offen offset:1024 sc1
v_mfma_f32_16x16x32_bf16 v[68:71],a[144:147],v[240:243],v[68:71]
ds_read_b128 v[236:239],v18 offset:22528
s_xor_b32 m0,s72,0
v_mfma_f32_16x16x32_bf16 v[64:67],a[20:23],v[244:247],v[64:67]
buffer_store_dwordx4 v[48:51],v26,s[24:27],s48 offen offset:2048
v_mfma_f32_16x16x32_bf16 v[68:71],a[148:151],v[244:247],v[68:71]
ds_read_b128 v[240:243],v18 offset:24576
s_waitcnt lgkmcnt(5)
v_mfma_f32_16x16x32_bf16 v[64:67],a[24:27],v[248:251],v[64:67]
buffer_store_dwordx4 v[48:51],v26,s[28:31],s48 offen offset:2048 sc1
v_mfma_f32_16x16x32_bf16 v[68:71],a[152:155],v[248:251],v[68:71]
ds_read_b128 v[244:247],v18 offset:26624
s_add_u32 s65,s88,0
v_mfma_f32_16x16x32_bf16 v[64:67],a[28:31],v[252:255],v[64:67]
buffer_store_dwordx4 v[48:51],v26,s[24:27],s48 offen offset:3072
v_mfma_f32_16x16x32_bf16 v[68:71],a[156:159],v[252:255],v[68:71]
ds_read_b128 v[248:251],v18 offset:28672
s_waitcnt lgkmcnt(5)
v_mfma_f32_16x16x32_bf16 v[64:67],a[32:35],v[224:227],v[64:67]
buffer_store_dwordx4 v[48:51],v26,s[28:31],s48 offen offset:3072 sc1
v_mfma_f32_16x16x32_bf16 v[68:71],a[160:163],v[224:227],v[68:71]
ds_read_b128 v[252:255],v18 offset:30720
s_mov_b32 s48,0x7fff0000
v_mfma_f32_16x16x32_bf16 v[64:67],a[36:39],v[228:231],v[64:67]
buffer_load_dwordx2 v[120:121],v20,s[36:39],s78 offen
v_mfma_f32_16x16x32_bf16 v[68:71],a[164:167],v[228:231],v[68:71]
ds_read_b128 v[224:227],v18 offset:32768
s_waitcnt lgkmcnt(5)
v_mfma_f32_16x16x32_bf16 v[64:67],a[40:43],v[232:235],v[64:67]
buffer_load_dwordx4 v16,s[20:23],s65 offen offset:0 sc1 lds
v_mfma_f32_16x16x32_bf16 v[68:71],a[168:171],v[232:235],v[68:71]
ds_read_b128 v[228:231],v18 offset:34816
v_mfma_f32_16x16x32_bf16 v[64:67],a[44:47],v[236:239],v[64:67]
buffer_load_dwordx4 v16,s[20:23],s65 offen offset:2048 sc1 lds
v_mfma_f32_16x16x32_bf16 v[68:71],a[172:175],v[236:239],v[68:71]
ds_read_b128 v[232:235],v18 offset:36864
s_waitcnt lgkmcnt(5)
v_mfma_f32_16x16x32_bf16 v[64:67],a[48:51],v[240:243],v[64:67]
s_xor_b32 m0,s72,16384
s_add_u32 s65,s88,32768
v_mfma_f32_16x16x32_bf16 v[68:71],a[176:179],v[240:243],v[68:71]
ds_read_b128 v[236:239],v18 offset:38912
v_mfma_f32_16x16x32_bf16 v[64:67],a[52:55],v[244:247],v[64:67]
buffer_load_dwordx4 v16,s[20:23],s65 offen offset:0 sc1 lds
v_mfma_f32_16x16x32_bf16 v[68:71],a[180:183],v[244:247],v[68:71]
ds_read_b128 v[240:243],v18 offset:40960
s_waitcnt lgkmcnt(5)
v_mfma_f32_16x16x32_bf16 v[64:67],a[56:59],v[248:251],v[64:67]
buffer_load_dwordx4 v16,s[20:23],s65 offen offset:2048 sc1 lds
v_mfma_f32_16x16x32_bf16 v[68:71],a[184:187],v[248:251],v[68:71]
ds_read_b128 v[244:247],v18 offset:43008
s_xor_b32 m0,s72,32768
v_mfma_f32_16x16x32_bf16 v[64:67],a[60:63],v[252:255],v[64:67]
s_add_u32 s65,s88,65536
v_mfma_f32_16x16x32_bf16 v[68:71],a[188:191],v[252:255],v[68:71]
ds_read_b128 v[248:251],v18 offset:45056
s_waitcnt lgkmcnt(5)
v_mfma_f32_16x16x32_bf16 v[64:67],a[64:67],v[224:227],v[64:67]
buffer_load_dwordx4 v16,s[20:23],s65 offen offset:0 sc1 lds
v_mfma_f32_16x16x32_bf16 v[68:71],a[192:195],v[224:227],v[68:71]
ds_read_b128 v[252:255],v18 offset:47104
v_mfma_f32_16x16x32_bf16 v[64:67],a[68:71],v[228:231],v[64:67]
buffer_load_dwordx4 v16,s[20:23],s65 offen offset:2048 sc1 lds
v_mfma_f32_16x16x32_bf16 v[68:71],a[196:199],v[228:231],v[68:71]
ds_read_b128 v[224:227],v18 offset:49152
s_waitcnt lgkmcnt(5)
v_mfma_f32_16x16x32_bf16 v[64:67],a[72:75],v[232:235],v[64:67]
s_xor_b32 m0,s72,49152
s_add_u32 s65,s88,98304
v_mfma_f32_16x16x32_bf16 v[68:71],a[200:203],v[232:235],v[68:71]
ds_read_b128 v[228:231],v18 offset:51200
v_mfma_f32_16x16x32_bf16 v[64:67],a[76:79],v[236:239],v[64:67]
buffer_load_dwordx4 v16,s[20:23],s65 offen offset:0 sc1 lds
v_mfma_f32_16x16x32_bf16 v[68:71],a[204:207],v[236:239],v[68:71]
ds_read_b128 v[232:235],v18 offset:53248
s_waitcnt lgkmcnt(5)
v_mfma_f32_16x16x32_bf16 v[64:67],a[80:83],v[240:243],v[64:67]
ds_read_b128 v[128:131],v17 offset:0
ds_read_b128 v[132:135],v17 offset:2048
v_mfma_f32_16x16x32_bf16 v[68:71],a[208:211],v[240:243],v[68:71]
ds_read_b128 v[236:239],v18 offset:55296
v_mfma_f32_16x16x32_bf16 v[64:67],a[84:87],v[244:247],v[64:67]
ds_read_b128 v[136:139],v17 offset:4096
v_mfma_f32_16x16x32_bf16 v[68:71],a[212:215],v[244:247],v[68:71]
ds_read_b128 v[240:243],v18 offset:57344
s_waitcnt lgkmcnt(8)
v_mfma_f32_16x16x32_bf16 v[64:67],a[88:91],v[248:251],v[64:67]
ds_read_b128 v[140:143],v17 offset:6144
v_mfma_f32_16x16x32_bf16 v[68:71],a[216:219],v[248:251],v[68:71]
ds_read_b128 v[244:247],v18 offset:59392
s_add_u32 s92,s70,8388608
v_mfma_f32_16x16x32_bf16 v[64:67],a[92:95],v[252:255],v[64:67]
ds_read_b128 v[144:147],v17 offset:8192
ds_read_b128 v[148:151],v17 offset:10240
v_mfma_f32_16x16x32_bf16 v[68:71],a[220:223],v[252:255],v[68:71]
ds_read_b128 v[248:251],v18 offset:61440
s_waitcnt lgkmcnt(11)
v_mfma_f32_16x16x32_bf16 v[64:67],a[96:99],v[224:227],v[64:67]
ds_read_b128 v[152:155],v17 offset:12288
s_sub_u32 s93,s71,53
v_mfma_f32_16x16x32_bf16 v[68:71],a[224:227],v[224:227],v[68:71]
ds_read_b128 v[252:255],v18 offset:63488
v_mfma_f32_16x16x32_bf16 v[64:67],a[100:103],v[228:231],v[64:67]
ds_read_b128 v[156:159],v17 offset:14336
s_waitcnt vmcnt(14)
v_mfma_f32_16x16x32_bf16 v[68:71],a[228:231],v[228:231],v[68:71]
v_add_u32 v22,s71,-1
s_waitcnt lgkmcnt(10)
v_mfma_f32_16x16x32_bf16 v[64:67],a[104:107],v[232:235],v[64:67]
ds_read_b128 v[160:163],v17 offset:16384
ds_read_b128 v[164:167],v17 offset:18432
v_mfma_f32_16x16x32_bf16 v[68:71],a[232:235],v[232:235],v[68:71]
buffer_store_dword v22,v23,s[20:23],s73 offen sc1
v_mfma_f32_16x16x32_bf16 v[64:67],a[108:111],v[236:239],v[64:67]
ds_read_b128 v[168:171],v17 offset:20480
v_mfma_f32_16x16x32_bf16 v[68:71],a[236:239],v[236:239],v[68:71]
s_waitcnt lgkmcnt(9)
v_mfma_f32_16x16x32_bf16 v[64:67],a[112:115],v[240:243],v[64:67]
ds_read_b128 v[172:175],v17 offset:22528
v_mfma_f32_16x16x32_bf16 v[68:71],a[240:243],v[240:243],v[68:71]
s_cmp_lt_u32 s93,8
s_cselect_b32 s92,s92,0x7fff0000
v_mfma_f32_16x16x32_bf16 v[64:67],a[116:119],v[244:247],v[64:67]
ds_read_b128 v[176:179],v17 offset:24576
ds_read_b128 v[180:183],v17 offset:26624
v_mfma_f32_16x16x32_bf16 v[68:71],a[244:247],v[244:247],v[68:71]
s_waitcnt lgkmcnt(7)
v_mfma_f32_16x16x32_bf16 v[64:67],a[120:123],v[248:251],v[64:67]
ds_read_b128 v[184:187],v17 offset:28672
v_mfma_f32_16x16x32_bf16 v[68:71],a[248:251],v[248:251],v[68:71]
buffer_store_dwordx2 v[48:49],v19,s[20:23],s92 offen sc1
v_mfma_f32_16x16x32_bf16 v[64:67],a[124:127],v[252:255],v[64:67]
ds_read_b128 v[188:191],v17 offset:30720
buffer_load_dword v2,v21,s[20:23],s87 offen sc1
v_mfma_f32_16x16x32_bf16 v[68:71],a[252:255],v[252:255],v[68:71]
s_add_u32 s96,s71,2
v_mfma_f32_16x16x32_bf16 v[72:75],a[128:131],v[128:131],0
s_cmp_gt_u32 s96,56
s_addc_u32 s96,s96,0
v_mfma_f32_16x16x32_bf16 v[76:79],a[132:135],v[132:135],0
buffer_load_dwordx4 v16,s[20:23],s65 offen offset:2048 sc1 lds
v_mfma_f32_16x16x32_bf16 v[72:75],a[136:139],v[136:139],v[72:75]
ds_read_b128 v[192:195],v17 offset:32768
s_xor_b32 m0,s72,1024
v_mfma_f32_16x16x32_bf16 v[76:79],a[140:143],v[140:143],v[76:79]
ds_read_b128 v[196:199],v17 offset:34816
s_waitcnt lgkmcnt(10)
v_mfma_f32_16x16x32_bf16 v[72:75],a[144:147],v[144:147],v[72:75]
ds_read_b128 v[200:203],v17 offset:36864
s_waitcnt vmcnt(11)
v_max_u32 v64,1,v64
v_mfma_f32_16x16x32_bf16 v[76:79],a[148:151],v[148:151],v[76:79]
ds_read_b128 v[204:207],v17 offset:38912
s_add_u32 s64,s49,s34
v_mfma_f32_16x16x32_bf16 v[72:75],a[152:155],v[152:155],v[72:75]
ds_read_b128 v[208:211],v17 offset:40960
buffer_store_dwordx4 v[64:67],v25,s[24:27],s64 offen offset:2048
v_mfma_f32_16x16x32_bf16 v[76:79],a[156:159],v[156:159],v[76:79]
buffer_store_dwordx4 v[64:67],v25,s[28:31],s64 offen offset:2048 sc1
s_waitcnt lgkmcnt(9)
v_mfma_f32_16x16x32_bf16 v[72:75],a[160:163],v[160:163],v[72:75]
ds_read_b128 v[212:215],v17 offset:43008
v_max_u32 v68,1,v68
s_add_u32 s64,s49,s35
v_mfma_f32_16x16x32_bf16 v[76:79],a[164:167],v[164:167],v[76:79]
ds_read_b128 v[216:219],v17 offset:45056
buffer_store_dwordx4 v[68:71],v25,s[24:27],s64 offen offset:3072
v_mfma_f32_16x16x32_bf16 v[72:75],a[168:171],v[168:171],v[72:75]
ds_read_b128 v[220:223],v17 offset:47104
s_add_u32 s65,s89,0
v_mfma_f32_16x16x32_bf16 v[76:79],a[172:175],v[172:175],v[76:79]
ds_read_b128 v[224:227],v17 offset:49152
s_waitcnt lgkmcnt(9)
v_mfma_f32_16x16x32_bf16 v[72:75],a[176:179],v[176:179],v[72:75]
ds_read_b128 v[228:231],v17 offset:51200
v_mfma_f32_16x16x32_bf16 v[76:79],a[180:183],v[180:183],v[76:79]
buffer_store_dwordx4 v[68:71],v25,s[28:31],s64 offen offset:3072 sc1
v_mfma_f32_16x16x32_bf16 v[72:75],a[184:187],v[184:187],v[72:75]
ds_read_b128 v[232:235],v17 offset:53248
s_mov_b32 s49,0x7fff0000
v_mfma_f32_16x16x32_bf16 v[76:79],a[188:191],v[188:191],v[76:79]
ds_read_b128 v[236:239],v17 offset:55296
s_waitcnt lgkmcnt(8)
v_mfma_f32_16x16x32_bf16 v[72:75],a[192:195],v[192:195],v[72:75]
ds_read_b128 v[240:243],v17 offset:57344
v_mfma_f32_16x16x32_bf16 v[76:79],a[196:199],v[196:199],v[76:79]
ds_read_b128 v[244:247],v17 offset:59392
ds_bpermute_b32 v124,v41,v120
v_mfma_f32_16x16x32_bf16 v[72:75],a[200:203],v[200:203],v[72:75]
ds_read_b128 v[248:251],v17 offset:61440
v_mfma_f32_16x16x32_bf16 v[76:79],a[204:207],v[204:207],v[76:79]
s_waitcnt lgkmcnt(8)
v_mfma_f32_16x16x32_bf16 v[72:75],a[208:211],v[208:211],v[72:75]
ds_read_b128 v[252:255],v17 offset:63488
ds_bpermute_b32 v125,v41,v121
v_mfma_f32_16x16x32_bf16 v[76:79],a[212:215],v[212:215],v[76:79]
buffer_load_dwordx4 v16,s[20:23],s65 offen offset:0 sc1 lds
v_mfma_f32_16x16x32_bf16 v[72:75],a[216:219],v[216:219],v[72:75]
buffer_load_dwordx4 v16,s[20:23],s65 offen offset:2048 sc1 lds
v_mfma_f32_16x16x32_bf16 v[76:79],a[220:223],v[220:223],v[76:79]
s_waitcnt lgkmcnt(0)
v_mfma_f32_16x16x32_bf16 v[72:75],a[224:227],v[224:227],v[72:75]
s_xor_b32 m0,s72,17408
s_add_u32 s65,s89,32768
v_mfma_f32_16x16x32_bf16 v[76:79],a[228:231],v[228:231],v[76:79]
buffer_load_dwordx4 v16,s[20:23],s65 offen offset:0 sc1 lds
v_mfma_f32_16x16x32_bf16 v[72:75],a[232:235],v[232:235],v[72:75]
v_lshlrev_b32 v104,16,v124
v_mfma_f32_16x16x32_bf16 v[76:79],a[236:239],v[236:239],v[76:79]
v_mfma_f32_16x16x32_bf16 v[72:75],a[240:243],v[240:243],v[72:75]
buffer_load_dwordx4 v16,s[20:23],s65 offen offset:2048 sc1 lds
v_mfma_f32_16x16x32_bf16 v[76:79],a[244:247],v[244:247],v[76:79]
s_xor_b32 m0,s72,33792
s_add_u32 s65,s89,65536
v_mfma_f32_16x16x32_bf16 v[72:75],a[248:251],v[248:251],v[72:75]
v_and_b32 v105,s80,v124
v_mfma_f32_16x16x32_bf16 v[76:79],a[252:255],v[252:255],v[76:79]
buffer_load_dwordx4 v16,s[20:23],s65 offen offset:0 sc1 lds
v_mfma_f32_16x16x32_bf16 v[80:83],a[0:3],v[128:131],0
buffer_load_dwordx4 v16,s[20:23],s65 offen offset:2048 sc1 lds
v_mfma_f32_16x16x32_bf16 v[84:87],a[4:7],v[132:135],0
v_lshlrev_b32 v106,16,v125
s_xor_b32 m0,s72,50176
v_mfma_f32_16x16x32_bf16 v[80:83],a[8:11],v[136:139],v[80:83]
s_add_u32 s65,s89,98304
v_mfma_f32_16x16x32_bf16 v[84:87],a[12:15],v[140:143],v[84:87]
buffer_load_dwordx4 v16,s[20:23],s65 offen offset:0 sc1 lds
v_mfma_f32_16x16x32_bf16 v[80:83],a[16:19],v[144:147],v[80:83]
v_and_b32 v107,s80,v125
v_add_f32 v72,v72,v76
v_mfma_f32_16x16x32_bf16 v[84:87],a[20:23],v[148:151],v[84:87]
v_add_f32 v73,v73,v77
v_add_f32 v74,v74,v78
v_mfma_f32_16x16x32_bf16 v[80:83],a[24:27],v[152:155],v[80:83]
v_add_f32 v75,v75,v79
v_max_u32 v72,1,v72
v_mfma_f32_16x16x32_bf16 v[84:87],a[28:31],v[156:159],v[84:87]
s_add_u32 s64,s77,s33
v_mfma_f32_16x16x32_bf16 v[80:83],a[32:35],v[160:163],v[80:83]
buffer_store_dwordx4 v[72:75],v25,s[24:27],s64 offen offset:1024
v_mfma_f32_16x16x32_bf16 v[84:87],a[36:39],v[164:167],v[84:87]
buffer_store_dwordx4 v[72:75],v25,s[28:31],s64 offen offset:1024 sc1
v_mfma_f32_16x16x32_bf16 v[80:83],a[40:43],v[168:171],v[80:83]
buffer_load_dwordx4 v16,s[20:23],s65 offen offset:2048 sc1 lds
v_mfma_f32_16x16x32_bf16 v[84:87],a[44:47],v[172:175],v[84:87]
v_mfma_f32_16x16x32_bf16 v[80:83],a[48:51],v[176:179],v[80:83]
v_mfma_f32_16x16x32_bf16 v[84:87],a[52:55],v[180:183],v[84:87]
v_mfma_f32_16x16x32_bf16 v[80:83],a[56:59],v[184:187],v[80:83]
v_mfma_f32_16x16x32_bf16 v[84:87],a[60:63],v[188:191],v[84:87]
v_mfma_f32_16x16x32_bf16 v[80:83],a[64:67],v[192:195],v[80:83]
buffer_load_dwordx4 v[96:99],v26,s[20:23],s77 offen offset:2048 sc1
v_mfma_f32_16x16x32_bf16 v[84:87],a[68:71],v[196:199],v[84:87]
buffer_load_dwordx4 v[100:103],v26,s[20:23],s77 offen offset:3072 sc1
v_mfma_f32_16x16x32_bf16 v[80:83],a[72:75],v[200:203],v[80:83]
v_mfma_f32_16x16x32_bf16 v[84:87],a[76:79],v[204:207],v[84:87]
v_mfma_f32_16x16x32_bf16 v[80:83],a[80:83],v[208:211],v[80:83]
s_waitcnt vmcnt(17)
v_mfma_f32_16x16x32_bf16 v[84:87],a[84:87],v[212:215],v[84:87]
v_cmp_gt_u32 vcc,s96,v2
s_mov_b32 s96,vcc_lo
v_mfma_f32_16x16x32_bf16 v[80:83],a[88:91],v[216:219],v[80:83]
v_mov_b32 v44,s96
ds_write_b32 v46,v44
v_mfma_f32_16x16x32_bf16 v[84:87],a[92:95],v[220:223],v[84:87]
v_mfma_f32_16x16x32_bf16 v[80:83],a[96:99],v[224:227],v[80:83]
v_mfma_f32_16x16x32_bf16 v[84:87],a[100:103],v[228:231],v[84:87]
v_mfma_f32_16x16x32_bf16 v[80:83],a[104:107],v[232:235],v[80:83]
buffer_load_dwordx4 v[92:95],v26,s[20:23],s77 offen offset:1024 sc1
v_mfma_f32_16x16x32_bf16 v[84:87],a[108:111],v[236:239],v[84:87]
v_mfma_f32_16x16x32_bf16 v[80:83],a[112:115],v[240:243],v[80:83]
v_mfma_f32_16x16x32_bf16 v[84:87],a[116:119],v[244:247],v[84:87]
v_mfma_f32_16x16x32_bf16 v[80:83],a[120:123],v[248:251],v[80:83]
v_mfma_f32_16x16x32_bf16 v[84:87],a[124:127],v[252:255],v[84:87]
epi_243:
buffer_load_dword v29,v21,s[20:23],s87 offen sc1
s_nop 6
v_pk_add_f32 v[88:89],v[80:81],v[84:85]
v_pk_add_f32 v[90:91],v[82:83],v[86:87]
s_waitcnt vmcnt(1)
s_branch ic_250
ip_248:
buffer_load_dwordx4 v[92:95],v26,s[20:23],s77 offen offset:1024 sc1
buffer_load_dwordx4 v[96:99],v26,s[20:23],s77 offen offset:2048 sc1
buffer_load_dwordx4 v[100:103],v26,s[20:23],s77 offen offset:3072 sc1
s_waitcnt vmcnt(0)
ic_250:
v_min3_u32 v22,v92,v96,v100
v_cmp_eq_u32 vcc,0,v22
s_cbranch_vccz ik_249
s_sub_u32 s90,s90,1
s_cmp_gt_i32 s90,0
s_cbranch_scc1 ip_248
ik_249:
v_pk_add_f32 v[88:89],v[88:89],v[92:93]
v_pk_add_f32 v[96:97],v[96:97],v[100:101]
v_pk_add_f32 v[90:91],v[90:91],v[94:95]
v_pk_add_f32 v[98:99],v[98:99],v[102:103]
v_pk_add_f32 v[88:89],v[88:89],v[96:97]
v_pk_add_f32 v[90:91],v[90:91],v[98:99]
v_pk_fma_f32 v[88:89],v[88:89],v[52:53],v[104:105]
v_pk_fma_f32 v[90:91],v[90:91],v[54:55],v[106:107]
v_cvt_pk_bf16_f32 v88,v88,v89
v_cvt_pk_bf16_f32 v89,v90,v91
v_max_u32 v88,1,v88
ds_bpermute_b32 v88,v40,v88
ds_bpermute_b32 v89,v40,v89
v_xor_b32 v18,0x10000,v18
s_xor_b32 s49,s77,524288
s_waitcnt lgkmcnt(0)
buffer_store_dwordx2 v[88:89],v19,s[20:23],s70 offen sc1
s_mov_b32 s48,s77
s_mov_b32 s77,s49
s_add_u32 s78,s78,65536
s_cmp_gt_u32 s71,56
s_cselect_b32 s65,s73,0x7fff0000
v_mov_b32 v22,s71
buffer_store_dword v22,v23,s[20:23],s65 offen sc1
v_xor_b32 v17,0x10000,v17
v_xor_b32 v45,16,v45
v_xor_b32 v46,16,v46
s_xor_b32 s72,s72,0x10000
s_add_u32 s70,s70,2097152
s_xor_b32 s70,s70,0x2000
s_add_u32 s71,s71,1
s_cmp_le_u32 s71,64
s_cbranch_scc1 seg_241
s_endpgm
retry_240:
s_sub_u32 s90,s90,64
s_cmp_lt_i32 s90,0
s_cbranch_scc1 giveup_170
s_mov_b32 s83,1
s_waitcnt vmcnt(0) lgkmcnt(0)
s_barrier
s_branch seg_241
r_w4_187:
s_load_dwordx2 s[4:5],s[0:1],88
s_load_dwordx2 s[6:7],s[0:1],112
s_lshr_b32 s41,s59,3
s_and_b32 s42,s59,7
s_mul_i32 s66,s41,1835008
s_lshl_b32 s64,s42,8
s_add_u32 s66,s66,s64
s_lshl_b32 s67,s50,1
s_and_b32 s64,s41,1
s_add_u32 s67,s67,s64
s_waitcnt lgkmcnt(0)
s_mov_b32 s32,s4
s_and_b32 s33,s5,0xffff
s_mov_b32 s34,0x700000
s_mov_b32 s35,0x20000
s_sub_u32 s36,s6,0x1000
s_subb_u32 s37,s7,0
s_and_b32 s37,s37,0xffff
s_mov_b32 s38,0x401000
s_mov_b32 s39,0x20000
v_lshrrev_b32 v5,2,v3
v_lshl_add_u32 v5,v4,2,v5
v_and_b32 v6,3,v3
v_lshlrev_b32 v6,3,v6
v_lshl_add_u32 v6,v5,8,v6
v_and_b32 v5,7,v5
v_xor_b32 v5,s67,v5
v_lshl_add_u32 v12,v5,5,v6
v_xor_b32 v13,32,v12
v_and_b32 v5,15,v1
v_and_b32 v6,3,v4
v_lshlrev_b32 v6,1,v6
v_xor_b32 v5,v5,v6
v_mul_u32_u24 v6,2048,v4
v_xor_b32 v7,0,v5
v_lshl_add_u32 v8,v7,4,v6
v_xor_b32 v7,8,v5
v_lshl_add_u32 v9,v7,4,v6
s_mul_i32 s74,s50,131072
s_add_u32 s74,s74,s66
s_lshl_b32 s75,s50,14
s_mul_i32 s76,s50,65536
s_add_u32 s76,s76,s66
s_lshl_b32 s77,s50,13
s_add_u32 s64,s74,0
s_add_u32 m0,s75,0
s_nop 0
buffer_load_dwordx4 v8,s[32:35],s64 offen  lds
s_add_u32 s64,s74,8192
s_add_u32 m0,s75,1024
s_nop 0
buffer_load_dwordx4 v9,s[32:35],s64 offen  lds
s_add_u32 s64,s74,16384
s_add_u32 m0,s75,2048
s_nop 0
buffer_load_dwordx4 v8,s[32:35],s64 offen  lds
s_add_u32 s64,s74,24576
s_add_u32 m0,s75,3072
s_nop 0
buffer_load_dwordx4 v9,s[32:35],s64 offen  lds
s_add_u32 s64,s74,32768
s_add_u32 m0,s75,4096
s_nop 0
buffer_load_dwordx4 v8,s[32:35],s64 offen  lds
s_add_u32 s64,s74,40960
s_add_u32 m0,s75,5120
s_nop 0
buffer_load_dwordx4 v9,s[32:35],s64 offen  lds
s_add_u32 s64,s74,49152
s_add_u32 m0,s75,6144
s_nop 0
buffer_load_dwordx4 v8,s[32:35],s64 offen  lds
s_add_u32 s64,s74,57344
s_add_u32 m0,s75,7168
s_nop 0
buffer_load_dwordx4 v9,s[32:35],s64 offen  lds
s_add_u32 s64,s74,65536
s_add_u32 m0,s75,8192
s_nop 0
buffer_load_dwordx4 v8,s[32:35],s64 offen  lds
s_add_u32 s64,s74,73728
s_add_u32 m0,s75,9216
s_nop 0
buffer_load_dwordx4 v9,s[32:35],s64 offen  lds
s_add_u32 s64,s74,81920
s_add_u32 m0,s75,10240
s_nop 0
buffer_load_dwordx4 v8,s[32:35],s64 offen  lds
s_add_u32 s64,s74,90112
s_add_u32 m0,s75,11264
s_nop 0
buffer_load_dwordx4 v9,s[32:35],s64 offen  lds
s_add_u32 s64,s74,98304
s_add_u32 m0,s75,12288
s_nop 0
buffer_load_dwordx4 v8,s[32:35],s64 offen  lds
s_add_u32 s64,s74,106496
s_add_u32 m0,s75,13312
s_nop 0
buffer_load_dwordx4 v9,s[32:35],s64 offen  lds
s_add_u32 s64,s74,114688
s_add_u32 m0,s75,14336
s_nop 0
buffer_load_dwordx4 v8,s[32:35],s64 offen  lds
s_add_u32 s64,s74,122880
s_add_u32 m0,s75,15360
s_nop 0
buffer_load_dwordx4 v9,s[32:35],s64 offen  lds
s_add_u32 s64,s74,524288
s_add_u32 m0,s75,65536
s_nop 0
buffer_load_dwordx4 v8,s[32:35],s64 offen  lds
s_add_u32 s64,s74,532480
s_add_u32 m0,s75,66560
s_nop 0
buffer_load_dwordx4 v9,s[32:35],s64 offen  lds
s_add_u32 s64,s74,540672
s_add_u32 m0,s75,67584
s_nop 0
buffer_load_dwordx4 v8,s[32:35],s64 offen  lds
s_add_u32 s64,s74,548864
s_add_u32 m0,s75,68608
s_nop 0
buffer_load_dwordx4 v9,s[32:35],s64 offen  lds
s_add_u32 s64,s74,557056
s_add_u32 m0,s75,69632
s_nop 0
buffer_load_dwordx4 v8,s[32:35],s64 offen  lds
s_add_u32 s64,s74,565248
s_add_u32 m0,s75,70656
s_nop 0
buffer_load_dwordx4 v9,s[32:35],s64 offen  lds
s_add_u32 s64,s74,573440
s_add_u32 m0,s75,71680
s_nop 0
buffer_load_dwordx4 v8,s[32:35],s64 offen  lds
s_add_u32 s64,s74,581632
s_add_u32 m0,s75,72704
s_nop 0
buffer_load_dwordx4 v9,s[32:35],s64 offen  lds
s_add_u32 s64,s74,589824
s_add_u32 m0,s75,73728
s_nop 0
buffer_load_dwordx4 v8,s[32:35],s64 offen  lds
s_add_u32 s64,s74,598016
s_add_u32 m0,s75,74752
s_nop 0
buffer_load_dwordx4 v9,s[32:35],s64 offen  lds
s_add_u32 s64,s74,606208
s_add_u32 m0,s75,75776
s_nop 0
buffer_load_dwordx4 v8,s[32:35],s64 offen  lds
s_add_u32 s64,s74,614400
s_add_u32 m0,s75,76800
s_nop 0
buffer_load_dwordx4 v9,s[32:35],s64 offen  lds
s_add_u32 s64,s74,622592
s_add_u32 m0,s75,77824
s_nop 0
buffer_load_dwordx4 v8,s[32:35],s64 offen  lds
s_add_u32 s64,s74,630784
s_add_u32 m0,s75,78848
s_nop 0
buffer_load_dwordx4 v9,s[32:35],s64 offen  lds
s_add_u32 s64,s74,638976
s_add_u32 m0,s75,79872
s_nop 0
buffer_load_dwordx4 v8,s[32:35],s64 offen  lds
s_add_u32 s64,s74,647168
s_add_u32 m0,s75,80896
s_nop 0
buffer_load_dwordx4 v9,s[32:35],s64 offen  lds
s_waitcnt vmcnt(16)
s_barrier
ds_read_b64_tr_b16 a[0:1],v12 offset:0
ds_read_b64_tr_b16 a[112:113],v13 offset:0
ds_read_b64_tr_b16 a[2:3],v12 offset:4096
ds_read_b64_tr_b16 a[114:115],v13 offset:4096
ds_read_b64_tr_b16 a[4:5],v12 offset:8192
ds_read_b64_tr_b16 a[116:117],v13 offset:8192
ds_read_b64_tr_b16 a[6:7],v12 offset:12288
ds_read_b64_tr_b16 a[118:119],v13 offset:12288
s_waitcnt lgkmcnt(4)
ds_read_b64_tr_b16 a[8:9],v12 offset:16384
ds_read_b64_tr_b16 a[120:121],v13 offset:16384
ds_read_b64_tr_b16 a[10:11],v12 offset:20480
ds_read_b64_tr_b16 a[122:123],v13 offset:20480
ds_read_b64_tr_b16 a[12:13],v12 offset:28672
ds_read_b64_tr_b16 a[124:125],v13 offset:28672
ds_read_b64_tr_b16 a[14:15],v12 offset:32768
ds_read_b64_tr_b16 a[126:127],v13 offset:32768
s_waitcnt lgkmcnt(4)
ds_read_b64_tr_b16 a[16:17],v12 offset:36864
ds_read_b64_tr_b16 a[128:129],v13 offset:36864
ds_read_b64_tr_b16 a[18:19],v12 offset:40960
ds_read_b64_tr_b16 a[130:131],v13 offset:40960
ds_read_b64_tr_b16 a[20:21],v12 offset:45056
ds_read_b64_tr_b16 a[132:133],v13 offset:45056
ds_read_b64_tr_b16 a[22:23],v12 offset:49152
ds_read_b64_tr_b16 a[134:135],v13 offset:49152
s_waitcnt lgkmcnt(4)
ds_read_b64_tr_b16 a[24:25],v12 offset:57344
ds_read_b64_tr_b16 a[136:137],v13 offset:57344
ds_read_b64_tr_b16 a[26:27],v12 offset:61440
ds_read_b64_tr_b16 a[138:139],v13 offset:61440
ds_read_b64_tr_b16 a[96:97],v12 offset:24576
ds_read_b64_tr_b16 a[208:209],v13 offset:24576
ds_read_b64_tr_b16 a[98:99],v12 offset:53248
ds_read_b64_tr_b16 a[210:211],v13 offset:53248
s_waitcnt lgkmcnt(4)
v_xor_b32 v12,0x10000,v12
v_xor_b32 v13,0x10000,v13
s_waitcnt lgkmcnt(0)
s_barrier
s_add_u32 s64,s74,1048576
s_add_u32 m0,s75,0
s_nop 0
buffer_load_dwordx4 v8,s[32:35],s64 offen  lds
s_add_u32 s64,s74,1056768
s_add_u32 m0,s75,1024
s_nop 0
buffer_load_dwordx4 v9,s[32:35],s64 offen  lds
s_add_u32 s64,s74,1064960
s_add_u32 m0,s75,2048
s_nop 0
buffer_load_dwordx4 v8,s[32:35],s64 offen  lds
s_add_u32 s64,s74,1073152
s_add_u32 m0,s75,3072
s_nop 0
buffer_load_dwordx4 v9,s[32:35],s64 offen  lds
s_add_u32 s64,s74,1081344
s_add_u32 m0,s75,4096
s_nop 0
buffer_load_dwordx4 v8,s[32:35],s64 offen  lds
s_add_u32 s64,s74,1089536
s_add_u32 m0,s75,5120
s_nop 0
buffer_load_dwordx4 v9,s[32:35],s64 offen  lds
s_add_u32 s64,s74,1097728
s_add_u32 m0,s75,6144
s_nop 0
buffer_load_dwordx4 v8,s[32:35],s64 offen  lds
s_add_u32 s64,s74,1105920
s_add_u32 m0,s75,7168
s_nop 0
buffer_load_dwordx4 v9,s[32:35],s64 offen  lds
s_add_u32 s64,s74,1114112
s_add_u32 m0,s75,8192
s_nop 0
buffer_load_dwordx4 v8,s[32:35],s64 offen  lds
s_add_u32 s64,s74,1122304
s_add_u32 m0,s75,9216
s_nop 0
buffer_load_dwordx4 v9,s[32:35],s64 offen  lds
s_add_u32 s64,s74,1130496
s_add_u32 m0,s75,10240
s_nop 0
buffer_load_dwordx4 v8,s[32:35],s64 offen  lds
s_add_u32 s64,s74,1138688
s_add_u32 m0,s75,11264
s_nop 0
buffer_load_dwordx4 v9,s[32:35],s64 offen  lds
s_add_u32 s64,s74,1146880
s_add_u32 m0,s75,12288
s_nop 0
buffer_load_dwordx4 v8,s[32:35],s64 offen  lds
s_add_u32 s64,s74,1155072
s_add_u32 m0,s75,13312
s_nop 0
buffer_load_dwordx4 v9,s[32:35],s64 offen  lds
s_add_u32 s64,s74,1163264
s_add_u32 m0,s75,14336
s_nop 0
buffer_load_dwordx4 v8,s[32:35],s64 offen  lds
s_add_u32 s64,s74,1171456
s_add_u32 m0,s75,15360
s_nop 0
buffer_load_dwordx4 v9,s[32:35],s64 offen  lds
s_waitcnt vmcnt(16)
s_barrier
ds_read_b64_tr_b16 a[28:29],v12 offset:0
ds_read_b64_tr_b16 a[140:141],v13 offset:0
ds_read_b64_tr_b16 a[30:31],v12 offset:4096
ds_read_b64_tr_b16 a[142:143],v13 offset:4096
ds_read_b64_tr_b16 a[32:33],v12 offset:8192
ds_read_b64_tr_b16 a[144:145],v13 offset:8192
ds_read_b64_tr_b16 a[34:35],v12 offset:12288
ds_read_b64_tr_b16 a[146:147],v13 offset:12288
s_waitcnt lgkmcnt(4)
ds_read_b64_tr_b16 a[36:37],v12 offset:20480
ds_read_b64_tr_b16 a[148:149],v13 offset:20480
ds_read_b64_tr_b16 a[38:39],v12 offset:24576
ds_read_b64_tr_b16 a[150:151],v13 offset:24576
ds_read_b64_tr_b16 a[40:41],v12 offset:28672
ds_read_b64_tr_b16 a[152:153],v13 offset:28672
ds_read_b64_tr_b16 a[42:43],v12 offset:32768
ds_read_b64_tr_b16 a[154:155],v13 offset:32768
s_waitcnt lgkmcnt(4)
ds_read_b64_tr_b16 a[44:45],v12 offset:36864
ds_read_b64_tr_b16 a[156:157],v13 offset:36864
ds_read_b64_tr_b16 a[46:47],v12 offset:40960
ds_read_b64_tr_b16 a[158:159],v13 offset:40960
ds_read_b64_tr_b16 a[48:49],v12 offset:49152
ds_read_b64_tr_b16 a[160:161],v13 offset:49152
ds_read_b64_tr_b16 a[50:51],v12 offset:53248
ds_read_b64_tr_b16 a[162:163],v13 offset:53248
s_waitcnt lgkmcnt(4)
ds_read_b64_tr_b16 a[52:53],v12 offset:57344
ds_read_b64_tr_b16 a[164:165],v13 offset:57344
ds_read_b64_tr_b16 a[54:55],v12 offset:61440
ds_read_b64_tr_b16 a[166:167],v13 offset:61440
ds_read_b64_tr_b16 a[100:101],v12 offset:16384
ds_read_b64_tr_b16 a[212:213],v13 offset:16384
ds_read_b64_tr_b16 a[102:103],v12 offset:45056
ds_read_b64_tr_b16 a[214:215],v13 offset:45056
s_waitcnt lgkmcnt(4)
v_xor_b32 v12,0x10000,v12
v_xor_b32 v13,0x10000,v13
s_waitcnt lgkmcnt(0)
s_barrier
s_add_u32 s64,s76,1572864
s_add_u32 m0,s77,65536
s_nop 0
buffer_load_dwordx4 v8,s[32:35],s64 offen  lds
s_add_u32 s64,s76,1581056
s_add_u32 m0,s77,66560
s_nop 0
buffer_load_dwordx4 v9,s[32:35],s64 offen  lds
s_add_u32 s64,s76,1589248
s_add_u32 m0,s77,67584
s_nop 0
buffer_load_dwordx4 v8,s[32:35],s64 offen  lds
s_add_u32 s64,s76,1597440
s_add_u32 m0,s77,68608
s_nop 0
buffer_load_dwordx4 v9,s[32:35],s64 offen  lds
s_add_u32 s64,s76,1605632
s_add_u32 m0,s77,69632
s_nop 0
buffer_load_dwordx4 v8,s[32:35],s64 offen  lds
s_add_u32 s64,s76,1613824
s_add_u32 m0,s77,70656
s_nop 0
buffer_load_dwordx4 v9,s[32:35],s64 offen  lds
s_add_u32 s64,s76,1622016
s_add_u32 m0,s77,71680
s_nop 0
buffer_load_dwordx4 v8,s[32:35],s64 offen  lds
s_add_u32 s64,s76,1630208
s_add_u32 m0,s77,72704
s_nop 0
buffer_load_dwordx4 v9,s[32:35],s64 offen  lds
s_waitcnt vmcnt(8)
s_barrier
ds_read_b64_tr_b16 a[56:57],v12 offset:0
ds_read_b64_tr_b16 a[168:169],v13 offset:0
ds_read_b64_tr_b16 a[58:59],v12 offset:4096
ds_read_b64_tr_b16 a[170:171],v13 offset:4096
ds_read_b64_tr_b16 a[60:61],v12 offset:12288
ds_read_b64_tr_b16 a[172:173],v13 offset:12288
ds_read_b64_tr_b16 a[62:63],v12 offset:16384
ds_read_b64_tr_b16 a[174:175],v13 offset:16384
s_waitcnt lgkmcnt(4)
ds_read_b64_tr_b16 a[64:65],v12 offset:20480
ds_read_b64_tr_b16 a[176:177],v13 offset:20480
ds_read_b64_tr_b16 a[66:67],v12 offset:24576
ds_read_b64_tr_b16 a[178:179],v13 offset:24576
ds_read_b64_tr_b16 a[68:69],v12 offset:28672
ds_read_b64_tr_b16 a[180:181],v13 offset:28672
ds_read_b64_tr_b16 a[70:71],v12 offset:32768
ds_read_b64_tr_b16 a[182:183],v13 offset:32768
s_waitcnt lgkmcnt(4)
ds_read_b64_tr_b16 a[72:73],v12 offset:40960
ds_read_b64_tr_b16 a[184:185],v13 offset:40960
ds_read_b64_tr_b16 a[74:75],v12 offset:45056
ds_read_b64_tr_b16 a[186:187],v13 offset:45056
ds_read_b64_tr_b16 a[76:77],v12 offset:49152
ds_read_b64_tr_b16 a[188:189],v13 offset:49152
ds_read_b64_tr_b16 a[78:79],v12 offset:53248
ds_read_b64_tr_b16 a[190:191],v13 offset:53248
s_waitcnt lgkmcnt(4)
ds_read_b64_tr_b16 a[80:81],v12 offset:57344
ds_read_b64_tr_b16 a[192:193],v13 offset:57344
ds_read_b64_tr_b16 a[82:83],v12 offset:61440
ds_read_b64_tr_b16 a[194:195],v13 offset:61440
ds_read_b64_tr_b16 a[104:105],v12 offset:8192
ds_read_b64_tr_b16 a[216:217],v13 offset:8192
ds_read_b64_tr_b16 a[106:107],v12 offset:36864
ds_read_b64_tr_b16 a[218:219],v13 offset:36864
s_waitcnt lgkmcnt(4)
v_xor_b32 v12,0x10000,v12
v_xor_b32 v13,0x10000,v13
s_waitcnt lgkmcnt(0)
s_barrier
s_waitcnt vmcnt(0)
s_barrier
ds_read_b64_tr_b16 a[84:85],v12 offset:4096
ds_read_b64_tr_b16 a[196:197],v13 offset:4096
ds_read_b64_tr_b16 a[86:87],v12 offset:8192
ds_read_b64_tr_b16 a[198:199],v13 offset:8192
ds_read_b64_tr_b16 a[88:89],v12 offset:12288
ds_read_b64_tr_b16 a[200:201],v13 offset:12288
ds_read_b64_tr_b16 a[90:91],v12 offset:16384
ds_read_b64_tr_b16 a[202:203],v13 offset:16384
s_waitcnt lgkmcnt(4)
ds_read_b64_tr_b16 a[92:93],v12 offset:20480
ds_read_b64_tr_b16 a[204:205],v13 offset:20480
ds_read_b64_tr_b16 a[94:95],v12 offset:24576
ds_read_b64_tr_b16 a[206:207],v13 offset:24576
ds_read_b64_tr_b16 a[108:109],v12 offset:0
ds_read_b64_tr_b16 a[220:221],v13 offset:0
ds_read_b64_tr_b16 a[110:111],v12 offset:28672
ds_read_b64_tr_b16 a[222:223],v13 offset:28672
s_waitcnt lgkmcnt(4)
v_xor_b32 v12,0x10000,v12
v_xor_b32 v13,0x10000,v13
s_waitcnt lgkmcnt(0)
s_barrier
v_and_b32 v21,1,v1
v_mul_u32_u24 v21,896,v21
s_mov_b32 s65,21052032
s_mov_b32 s66,1792
pl_253:
buffer_load_dword v22,v21,s[20:23],s65 offen sc1
s_waitcnt vmcnt(0)
v_cmp_gt_u32 vcc,s66,v22
s_cbranch_vccz pok_254
s_sleep 1
s_sub_u32 s90,s90,1
s_cmp_gt_i32 s90,0
s_cbranch_scc1 pl_253
pok_254:
s_lshr_b32 s43,s41,1
s_and_b32 s48,s41,1
s_lshl_b32 s64,s42,7
s_lshl_b32 s65,s50,5
s_add_u32 s64,s64,s65
s_lshl_b32 s65,s48,4
s_add_u32 s64,s64,s65
v_lshl_add_u32 v5,v4,2,s64
v_lshlrev_b32 v6,2,v5
s_mov_b32 s64,20480
buffer_load_dwordx4 v[52:55],v6,s[20:23],s64 offen sc1
v_lshlrev_b32 v10,1,v5
v_and_b32 v6,3,v1
v_sub_u32 v5,v6,v4
v_lshl_add_u32 v5,v5,3,v10
v_lshrrev_b32 v11,2,v1
v_lshl_add_u32 v40,v6,4,v11
v_lshlrev_b32 v40,2,v40
v_lshl_add_u32 v41,v3,2,v4
v_lshlrev_b32 v41,2,v41
s_lshl_b32 s64,s43,10
v_add_u32 v17,s64,v16
v_xor_b32 v18,1024,v17
s_xor_b32 s64,s64,1024
s_lshr_b32 s65,s50,1
s_and_b32 s66,s50,1
s_lshl_b32 s66,s66,12
s_add_u32 s66,s66,s64
s_lshl_b32 s72,s65,13
s_add_u32 s72,s72,s66
s_add_u32 s72,s72,0x10000
s_lshl_b32 s65,s65,14
s_add_u32 s75,s65,s66
s_add_u32 s75,s75,1327104
s_mul_i32 s64,s41,114688
s_add_u32 s75,s75,s64
s_cmp_lt_u32 s50,2
s_cselect_b32 s86,98304,0x40000000
s_mov_b32 s76,27262976
s_mov_b32 s77,0
s_mov_b32 s78,0
s_mov_b32 s49,0
s_lshl_b32 s64,s59,14
s_lshl_b32 s65,s50,12
s_add_u32 s64,s64,s65
s_add_u32 s64,s64,18874368
v_add_u32 v26,s64,v16
s_lshl_b32 s64,s42,14
s_add_u32 s64,s64,s65
s_add_u32 s64,s64,18874368
v_add_u32 v25,s64,v16
s_xor_b32 s33,s41,1
s_xor_b32 s34,s41,2
s_xor_b32 s35,s41,3
s_lshl_b32 s33,s33,17
s_lshl_b32 s34,s34,17
s_lshl_b32 s35,s35,17
v_and_b32 v21,31,v1
v_lshlrev_b32 v21,2,v21
s_lshl_b32 s74,s41,7
s_add_u32 s74,s74,s63
s_add_u32 s74,s74,4096
s_lshl_b32 s64,s43,4
v_add_u32 v6,s64,v11
v_lshl_add_u32 v19,v6,11,v5
v_add_u32 v6,s64,v11
v_add_u32 v6,30,v6
v_lshl_add_u32 v9,v6,7,v5
v_and_b32 v9,2047,v9
v_and_b32 v7,3,v6
v_lshl_add_u32 v7,v7,11,v9
v_bfe_u32 v8,v6,2,3
v_lshl_add_u32 v7,v8,14,v7
v_mov_b32 v8,0x2000
v_mov_b32 v9,2097152
v_cmp_gt_u32 vcc,32,v6
s_nop 1
v_cndmask_b32 v8,v9,v8,vcc
v_add_u32 v7,v7,v8
v_add_u32 v7,1048576,v7
v_xor_b32 v20,s62,v7
s_lshl_b32 s64,s42,14
s_lshl_b32 s65,s50,11
s_add_u32 s64,s64,s65
s_lshl_b32 s65,s43,10
s_add_u32 s64,s64,s65
s_lshl_b32 s65,s48,3
s_add_u32 s64,s64,s65
s_add_u32 s64,s64,1179648
v_add_u32 v24,s64,v16
s_mov_b32 s84,0xffffff00
s_cmp_eq_u32 s43,0
s_cselect_b32 s84,s84,-1
s_mov_b32 s85,-1
s_mov_b32 s48,0x7fff0000
s_waitcnt vmcnt(0)
s_add_u32 s64,s79,0
s_lshl_b32 s70,s64,21
s_lshl_b32 s64,s64,13
s_and_b32 s64,s64,0x2000
s_xor_b32 s64,s64,s62
s_add_u32 s70,s70,s64
s_add_u32 s70,s70,29360128
s_mov_b32 s83,1
s_mov_b32 s87,s74
s_cmp_eq_u32 s50,0
s_cselect_b32 s74,s74,0x7fff0000
v_mov_b32 v45,132096
s_lshl_b32 s64,s50,2
s_add_u32 s64,s64,132112
v_mov_b32 v46,s64
v_mov_b32 v2,0
v_mov_b32 v44,1
ds_write_b32 v45,v44
s_waitcnt lgkmcnt(0)
seg_256:
s_cmp_eq_u32 s83,0
s_cbranch_scc1 ahead_257
s_add_u32 s94,s70,s75
s_xor_b32 s95,s94,1024
s_xor_b32 s91,s72,0x10000
s_waitcnt lgkmcnt(0)
v_cmp_gt_u32 vcc,s71,v2
s_cbranch_vccz nb_260
s_waitcnt vmcnt(1)
v_cmp_gt_u32 vcc,s71,v29
s_cbranch_vccz nb_260
s_cmp_lg_u32 s50,0
s_cbranch_scc1 nb_260
buffer_load_dword v32,v21,s[20:23],s74 offen sc1
s_sleep 2
pl_261:
buffer_load_dword v33,v21,s[20:23],s74 offen sc1
s_waitcnt vmcnt(1)
v_cmp_gt_u32 vcc,s71,v32
s_cbranch_vccz pok_262
buffer_load_dword v32,v21,s[20:23],s74 offen sc1
s_waitcnt vmcnt(1)
v_cmp_gt_u32 vcc,s71,v33
s_cbranch_vccz pok_262
s_sub_u32 s90,s90,1
s_cmp_gt_i32 s90,0
s_cbranch_scc1 pl_261
pok_262:
nb_260:
s_barrier
s_xor_b32 m0,s91,0
s_add_u32 s65,s94,0
buffer_load_dwordx4 v16,s[20:23],s65 offen offset:0 sc1 lds
buffer_load_dwordx4 v16,s[20:23],s65 offen offset:2048 sc1 lds
ds_read_b32 v44,v45
s_xor_b32 m0,s91,16384
s_add_u32 s65,s94,32768
buffer_load_dwordx4 v16,s[20:23],s65 offen offset:0 sc1 lds
buffer_load_dwordx4 v16,s[20:23],s65 offen offset:2048 sc1 lds
s_xor_b32 m0,s91,32768
s_add_u32 s65,s94,65536
buffer_load_dwordx4 v16,s[20:23],s65 offen offset:0 sc1 lds
buffer_load_dwordx4 v16,s[20:23],s65 offen offset:2048 sc1 lds
s_xor_b32 m0,s91,49152
s_add_u32 s65,s94,s86
buffer_load_dwordx4 v16,s[20:23],s65 offen offset:0 sc1 lds
buffer_load_dwordx4 v16,s[20:23],s65 offen offset:2048 sc1 lds
s_xor_b32 m0,s91,1024
s_add_u32 s65,s95,0
buffer_load_dwordx4 v16,s[20:23],s65 offen offset:0 sc1 lds
buffer_load_dwordx4 v16,s[20:23],s65 offen offset:2048 sc1 lds
s_waitcnt lgkmcnt(0)
v_readfirstlane_b32 s83,v44
s_cmp_eq_u32 s83,0
s_cbranch_scc1 both_259
s_waitcnt vmcnt(8)
s_barrier
ds_read_b128 v[224:227],v18 offset:0
ds_read_b128 v[228:231],v18 offset:2048
ds_read_b128 v[232:235],v18 offset:4096
ds_read_b128 v[236:239],v18 offset:6144
ds_read_b128 v[240:243],v18 offset:8192
ds_read_b128 v[244:247],v18 offset:10240
ds_read_b128 v[248:251],v18 offset:12288
s_waitcnt lgkmcnt(5)
v_mfma_f32_16x16x32_bf16 v[64:67],a[0:3],v[224:227],0
v_min_u32 v27,v224,v228
s_xor_b32 m0,s91,17408
v_mfma_f32_16x16x32_bf16 v[68:71],a[112:115],v[224:227],0
ds_read_b128 v[252:255],v18 offset:14336
v_mfma_f32_16x16x32_bf16 v[64:67],a[4:7],v[228:231],v[64:67]
s_add_u32 s65,s95,32768
v_mfma_f32_16x16x32_bf16 v[68:71],a[116:119],v[228:231],v[68:71]
s_waitcnt vmcnt(6)
s_barrier
ds_read_b128 v[224:227],v18 offset:16384
s_waitcnt lgkmcnt(5)
v_mfma_f32_16x16x32_bf16 v[64:67],a[8:11],v[232:235],v[64:67]
v_min3_u32 v27,v27,v232,v236
buffer_load_dwordx4 v16,s[20:23],s65 offen offset:0 sc1 lds
v_mfma_f32_16x16x32_bf16 v[68:71],a[120:123],v[232:235],v[68:71]
ds_read_b128 v[228:231],v18 offset:18432
v_mfma_f32_16x16x32_bf16 v[64:67],a[12:15],v[236:239],v[64:67]
buffer_load_dwordx4 v16,s[20:23],s65 offen offset:2048 sc1 lds
v_mfma_f32_16x16x32_bf16 v[68:71],a[124:127],v[236:239],v[68:71]
ds_read_b128 v[232:235],v18 offset:20480
s_waitcnt lgkmcnt(5)
v_mfma_f32_16x16x32_bf16 v[64:67],a[16:19],v[240:243],v[64:67]
v_min3_u32 v27,v27,v240,v244
s_xor_b32 m0,s91,33792
v_mfma_f32_16x16x32_bf16 v[68:71],a[128:131],v[240:243],v[68:71]
ds_read_b128 v[236:239],v18 offset:22528
v_mfma_f32_16x16x32_bf16 v[64:67],a[20:23],v[244:247],v[64:67]
s_add_u32 s65,s95,65536
v_mfma_f32_16x16x32_bf16 v[68:71],a[132:135],v[244:247],v[68:71]
ds_read_b128 v[240:243],v18 offset:24576
s_waitcnt lgkmcnt(5)
v_mfma_f32_16x16x32_bf16 v[64:67],a[24:27],v[248:251],v[64:67]
v_min3_u32 v27,v27,v248,v252
buffer_load_dwordx4 v16,s[20:23],s65 offen offset:0 sc1 lds
v_mfma_f32_16x16x32_bf16 v[68:71],a[136:139],v[248:251],v[68:71]
ds_read_b128 v[244:247],v18 offset:26624
v_mfma_f32_16x16x32_bf16 v[64:67],a[28:31],v[252:255],v[64:67]
buffer_load_dwordx4 v16,s[20:23],s65 offen offset:2048 sc1 lds
v_mfma_f32_16x16x32_bf16 v[68:71],a[140:143],v[252:255],v[68:71]
ds_read_b128 v[248:251],v18 offset:28672
s_waitcnt lgkmcnt(5)
v_mfma_f32_16x16x32_bf16 v[64:67],a[32:35],v[224:227],v[64:67]
v_min3_u32 v27,v27,v224,v228
s_xor_b32 m0,s91,50176
v_mfma_f32_16x16x32_bf16 v[68:71],a[144:147],v[224:227],v[68:71]
ds_read_b128 v[252:255],v18 offset:30720
v_mfma_f32_16x16x32_bf16 v[64:67],a[36:39],v[228:231],v[64:67]
s_add_u32 s65,s95,s86
v_mfma_f32_16x16x32_bf16 v[68:71],a[148:151],v[228:231],v[68:71]
s_waitcnt vmcnt(6)
s_barrier
ds_read_b128 v[224:227],v18 offset:32768
s_waitcnt lgkmcnt(5)
v_mfma_f32_16x16x32_bf16 v[64:67],a[40:43],v[232:235],v[64:67]
v_min3_u32 v27,v27,v232,v236
buffer_load_dwordx4 v16,s[20:23],s65 offen offset:0 sc1 lds
v_mfma_f32_16x16x32_bf16 v[68:71],a[152:155],v[232:235],v[68:71]
ds_read_b128 v[228:231],v18 offset:34816
v_mfma_f32_16x16x32_bf16 v[64:67],a[44:47],v[236:239],v[64:67]
buffer_load_dwordx4 v16,s[20:23],s65 offen offset:2048 sc1 lds
v_mfma_f32_16x16x32_bf16 v[68:71],a[156:159],v[236:239],v[68:71]
ds_read_b128 v[232:235],v18 offset:36864
s_waitcnt lgkmcnt(5)
v_mfma_f32_16x16x32_bf16 v[64:67],a[48:51],v[240:243],v[64:67]
v_min3_u32 v27,v27,v240,v244
v_mfma_f32_16x16x32_bf16 v[68:71],a[160:163],v[240:243],v[68:71]
ds_read_b128 v[236:239],v18 offset:38912
v_mfma_f32_16x16x32_bf16 v[64:67],a[52:55],v[244:247],v[64:67]
buffer_store_dwordx4 v[48:51],v26,s[24:27],s48 offen offset:1024
v_mfma_f32_16x16x32_bf16 v[68:71],a[164:167],v[244:247],v[68:71]
ds_read_b128 v[240:243],v18 offset:40960
s_waitcnt lgkmcnt(5)
v_mfma_f32_16x16x32_bf16 v[64:67],a[56:59],v[248:251],v[64:67]
v_min3_u32 v27,v27,v248,v252
buffer_store_dwordx4 v[48:51],v26,s[28:31],s48 offen offset:1024 sc1
v_mfma_f32_16x16x32_bf16 v[68:71],a[168:171],v[248:251],v[68:71]
ds_read_b128 v[244:247],v18 offset:43008
buffer_store_dwordx4 v[48:51],v26,s[24:27],s48 offen offset:2048
v_mfma_f32_16x16x32_bf16 v[64:67],a[60:63],v[252:255],v[64:67]
buffer_store_dwordx4 v[48:51],v26,s[28:31],s48 offen offset:2048 sc1
v_mfma_f32_16x16x32_bf16 v[68:71],a[172:175],v[252:255],v[68:71]
ds_read_b128 v[248:251],v18 offset:45056
s_waitcnt lgkmcnt(5)
v_mfma_f32_16x16x32_bf16 v[64:67],a[64:67],v[224:227],v[64:67]
s_waitcnt vmcnt(8)
s_barrier
ds_read_b128 v[128:131],v17 offset:0
ds_read_b128 v[132:135],v17 offset:2048
v_mfma_f32_16x16x32_bf16 v[68:71],a[176:179],v[224:227],v[68:71]
ds_read_b128 v[252:255],v18 offset:47104
v_min3_u32 v27,v27,v224,v228
v_mfma_f32_16x16x32_bf16 v[64:67],a[68:71],v[228:231],v[64:67]
ds_read_b128 v[136:139],v17 offset:4096
buffer_store_dwordx4 v[48:51],v26,s[24:27],s48 offen offset:3072
v_mfma_f32_16x16x32_bf16 v[68:71],a[180:183],v[228:231],v[68:71]
ds_read_b128 v[224:227],v18 offset:49152
s_waitcnt lgkmcnt(8)
v_mfma_f32_16x16x32_bf16 v[64:67],a[72:75],v[232:235],v[64:67]
ds_read_b128 v[140:143],v17 offset:6144
v_min3_u32 v27,v27,v232,v236
v_mfma_f32_16x16x32_bf16 v[68:71],a[184:187],v[232:235],v[68:71]
ds_read_b128 v[228:231],v18 offset:51200
buffer_store_dwordx4 v[48:51],v26,s[28:31],s48 offen offset:3072 sc1
v_mfma_f32_16x16x32_bf16 v[64:67],a[76:79],v[236:239],v[64:67]
ds_read_b128 v[144:147],v17 offset:8192
ds_read_b128 v[148:151],v17 offset:10240
s_mov_b32 s48,0x7fff0000
v_mfma_f32_16x16x32_bf16 v[68:71],a[188:191],v[236:239],v[68:71]
ds_read_b128 v[232:235],v18 offset:53248
s_waitcnt lgkmcnt(11)
v_mfma_f32_16x16x32_bf16 v[64:67],a[80:83],v[240:243],v[64:67]
ds_read_b128 v[152:155],v17 offset:12288
v_min3_u32 v27,v27,v240,v244
v_mfma_f32_16x16x32_bf16 v[68:71],a[192:195],v[240:243],v[68:71]
ds_read_b128 v[236:239],v18 offset:55296
buffer_load_dwordx2 v[120:121],v20,s[20:23],s76 offen sc1
v_mfma_f32_16x16x32_bf16 v[64:67],a[84:87],v[244:247],v[64:67]
ds_read_b128 v[156:159],v17 offset:14336
buffer_load_dwordx2 v[122:123],v24,s[20:23],s70 offen sc1
v_mfma_f32_16x16x32_bf16 v[68:71],a[196:199],v[244:247],v[68:71]
s_waitcnt lgkmcnt(10)
v_mfma_f32_16x16x32_bf16 v[64:67],a[88:91],v[248:251],v[64:67]
ds_read_b128 v[160:163],v17 offset:16384
ds_read_b128 v[164:167],v17 offset:18432
v_mfma_f32_16x16x32_bf16 v[68:71],a[200:203],v[248:251],v[68:71]
v_min3_u32 v27,v27,v248,v252
v_mfma_f32_16x16x32_bf16 v[64:67],a[92:95],v[252:255],v[64:67]
ds_read_b128 v[168:171],v17 offset:20480
v_mfma_f32_16x16x32_bf16 v[68:71],a[204:207],v[252:255],v[68:71]
s_waitcnt lgkmcnt(9)
v_mfma_f32_16x16x32_bf16 v[64:67],a[96:99],v[224:227],v[64:67]
ds_read_b128 v[172:175],v17 offset:22528
v_min3_u32 v27,v27,v224,v228
v_mfma_f32_16x16x32_bf16 v[68:71],a[208:211],v[224:227],v[68:71]
v_min3_u32 v27,v27,v226,v230
v_mfma_f32_16x16x32_bf16 v[64:67],a[100:103],v[228:231],v[64:67]
ds_read_b128 v[176:179],v17 offset:24576
ds_read_b128 v[180:183],v17 offset:26624
v_mfma_f32_16x16x32_bf16 v[68:71],a[212:215],v[228:231],v[68:71]
s_waitcnt lgkmcnt(7)
v_mfma_f32_16x16x32_bf16 v[64:67],a[104:107],v[232:235],v[64:67]
ds_read_b128 v[184:187],v17 offset:28672
v_min3_u32 v27,v27,v232,v236
v_mfma_f32_16x16x32_bf16 v[68:71],a[216:219],v[232:235],v[68:71]
v_min3_u32 v27,v27,v234,v238
v_mfma_f32_16x16x32_bf16 v[64:67],a[108:111],v[236:239],v[64:67]
ds_read_b128 v[188:191],v17 offset:30720
buffer_load_dword v2,v21,s[20:23],s87 offen sc1
v_mfma_f32_16x16x32_bf16 v[68:71],a[220:223],v[236:239],v[68:71]
s_add_u32 s96,s71,2
v_mfma_f32_16x16x32_bf16 v[72:75],a[112:115],v[128:131],0
v_cmp_eq_u32 vcc,0,v27
s_cbranch_vccnz retry_255
v_mfma_f32_16x16x32_bf16 v[76:79],a[116:119],v[132:135],0
v_min3_u32 v27,v27,v128,v132
s_cmp_gt_u32 s96,56
s_addc_u32 s96,s96,0
v_mfma_f32_16x16x32_bf16 v[72:75],a[120:123],v[136:139],v[72:75]
s_waitcnt vmcnt(9)
s_barrier
ds_read_b128 v[192:195],v17 offset:32768
v_mfma_f32_16x16x32_bf16 v[76:79],a[124:127],v[140:143],v[76:79]
ds_read_b128 v[196:199],v17 offset:34816
s_waitcnt lgkmcnt(10)
v_mfma_f32_16x16x32_bf16 v[72:75],a[128:131],v[144:147],v[72:75]
ds_read_b128 v[200:203],v17 offset:36864
v_min3_u32 v27,v27,v136,v140
s_waitcnt vmcnt(1)
v_mfma_f32_16x16x32_bf16 v[76:79],a[132:135],v[148:151],v[76:79]
ds_read_b128 v[204:207],v17 offset:38912
v_min3_u32 v27,v27,v144,v148
v_max_u32 v64,1,v64
v_mfma_f32_16x16x32_bf16 v[72:75],a[136:139],v[152:155],v[72:75]
ds_read_b128 v[208:211],v17 offset:40960
s_add_u32 s64,s49,s34
v_mfma_f32_16x16x32_bf16 v[76:79],a[140:143],v[156:159],v[76:79]
v_min3_u32 v27,v27,v152,v156
s_waitcnt lgkmcnt(9)
v_mfma_f32_16x16x32_bf16 v[72:75],a[144:147],v[160:163],v[72:75]
ds_read_b128 v[212:215],v17 offset:43008
buffer_store_dwordx4 v[64:67],v25,s[24:27],s64 offen offset:2048
v_mfma_f32_16x16x32_bf16 v[76:79],a[148:151],v[164:167],v[76:79]
ds_read_b128 v[216:219],v17 offset:45056
v_min3_u32 v27,v27,v160,v164
v_mfma_f32_16x16x32_bf16 v[72:75],a[152:155],v[168:171],v[72:75]
ds_read_b128 v[220:223],v17 offset:47104
buffer_store_dwordx4 v[64:67],v25,s[28:31],s64 offen offset:2048 sc1
v_mfma_f32_16x16x32_bf16 v[76:79],a[156:159],v[172:175],v[76:79]
ds_read_b128 v[224:227],v17 offset:49152
v_max_u32 v68,1,v68
s_waitcnt lgkmcnt(9)
v_mfma_f32_16x16x32_bf16 v[72:75],a[160:163],v[176:179],v[72:75]
ds_read_b128 v[228:231],v17 offset:51200
v_min3_u32 v27,v27,v168,v172
s_add_u32 s64,s49,s35
v_mfma_f32_16x16x32_bf16 v[76:79],a[164:167],v[180:183],v[76:79]
v_min3_u32 v27,v27,v176,v180
buffer_store_dwordx4 v[68:71],v25,s[24:27],s64 offen offset:3072
v_mfma_f32_16x16x32_bf16 v[72:75],a[168:171],v[184:187],v[72:75]
ds_read_b128 v[232:235],v17 offset:53248
buffer_store_dwordx4 v[68:71],v25,s[28:31],s64 offen offset:3072 sc1
v_mfma_f32_16x16x32_bf16 v[76:79],a[172:175],v[188:191],v[76:79]
ds_read_b128 v[236:239],v17 offset:55296
s_waitcnt lgkmcnt(8)
v_mfma_f32_16x16x32_bf16 v[72:75],a[176:179],v[192:195],v[72:75]
v_min3_u32 v27,v27,v184,v188
s_mov_b32 s49,0x7fff0000
v_mfma_f32_16x16x32_bf16 v[76:79],a[180:183],v[196:199],v[76:79]
v_min3_u32 v27,v27,v192,v196
ds_bpermute_b32 v124,v41,v120
v_mfma_f32_16x16x32_bf16 v[72:75],a[184:187],v[200:203],v[72:75]
v_mfma_f32_16x16x32_bf16 v[76:79],a[188:191],v[204:207],v[76:79]
v_min3_u32 v27,v27,v200,v204
s_waitcnt lgkmcnt(5)
v_mfma_f32_16x16x32_bf16 v[72:75],a[192:195],v[208:211],v[72:75]
ds_bpermute_b32 v125,v41,v121
v_mfma_f32_16x16x32_bf16 v[76:79],a[196:199],v[212:215],v[76:79]
v_min3_u32 v27,v27,v208,v212
v_lshlrev_b32 v108,16,v122
v_mfma_f32_16x16x32_bf16 v[72:75],a[200:203],v[216:219],v[72:75]
v_mfma_f32_16x16x32_bf16 v[76:79],a[204:207],v[220:223],v[76:79]
v_min3_u32 v27,v27,v216,v220
s_waitcnt lgkmcnt(2)
v_mfma_f32_16x16x32_bf16 v[72:75],a[208:211],v[224:227],v[72:75]
v_and_b32 v109,s80,v122
v_mfma_f32_16x16x32_bf16 v[76:79],a[212:215],v[228:231],v[76:79]
v_min3_u32 v27,v27,v224,v228
v_min3_u32 v27,v27,v226,v230
v_mfma_f32_16x16x32_bf16 v[72:75],a[216:219],v[232:235],v[72:75]
v_lshlrev_b32 v110,16,v123
v_mfma_f32_16x16x32_bf16 v[76:79],a[220:223],v[236:239],v[76:79]
v_min3_u32 v27,v27,v232,v236
v_min3_u32 v27,v27,v234,v238
v_mfma_f32_16x16x32_bf16 v[80:83],a[0:3],v[128:131],0
v_cmp_eq_u32 vcc,0,v27
s_cbranch_vccnz retry_255
v_mfma_f32_16x16x32_bf16 v[84:87],a[4:7],v[132:135],0
v_and_b32 v111,s80,v123
s_waitcnt lgkmcnt(0)
v_mfma_f32_16x16x32_bf16 v[80:83],a[8:11],v[136:139],v[80:83]
v_mfma_f32_16x16x32_bf16 v[84:87],a[12:15],v[140:143],v[84:87]
v_lshlrev_b32 v104,16,v124
v_mfma_f32_16x16x32_bf16 v[80:83],a[16:19],v[144:147],v[80:83]
v_add_f32 v72,v72,v76
v_add_f32 v73,v73,v77
v_mfma_f32_16x16x32_bf16 v[84:87],a[20:23],v[148:151],v[84:87]
v_and_b32 v105,s80,v124
v_add_f32 v74,v74,v78
v_mfma_f32_16x16x32_bf16 v[80:83],a[24:27],v[152:155],v[80:83]
v_add_f32 v75,v75,v79
v_max_u32 v72,1,v72
v_mfma_f32_16x16x32_bf16 v[84:87],a[28:31],v[156:159],v[84:87]
v_lshlrev_b32 v106,16,v125
s_add_u32 s64,s77,s33
v_mfma_f32_16x16x32_bf16 v[80:83],a[32:35],v[160:163],v[80:83]
buffer_store_dwordx4 v[72:75],v25,s[24:27],s64 offen offset:1024
v_mfma_f32_16x16x32_bf16 v[84:87],a[36:39],v[164:167],v[84:87]
v_and_b32 v107,s80,v125
v_mfma_f32_16x16x32_bf16 v[80:83],a[40:43],v[168:171],v[80:83]
buffer_store_dwordx4 v[72:75],v25,s[28:31],s64 offen offset:1024 sc1
v_mfma_f32_16x16x32_bf16 v[84:87],a[44:47],v[172:175],v[84:87]
v_mfma_f32_16x16x32_bf16 v[80:83],a[48:51],v[176:179],v[80:83]
buffer_load_dwordx4 v[96:99],v26,s[20:23],s77 offen offset:2048 sc1
v_mfma_f32_16x16x32_bf16 v[84:87],a[52:55],v[180:183],v[84:87]
buffer_load_dwordx4 v[100:103],v26,s[20:23],s77 offen offset:3072 sc1
v_mfma_f32_16x16x32_bf16 v[80:83],a[56:59],v[184:187],v[80:83]
v_mfma_f32_16x16x32_bf16 v[84:87],a[60:63],v[188:191],v[84:87]
v_mfma_f32_16x16x32_bf16 v[80:83],a[64:67],v[192:195],v[80:83]
s_waitcnt vmcnt(8)
v_mfma_f32_16x16x32_bf16 v[84:87],a[68:71],v[196:199],v[84:87]
v_cmp_gt_u32 vcc,s96,v2
s_mov_b32 s96,vcc_lo
v_mfma_f32_16x16x32_bf16 v[80:83],a[72:75],v[200:203],v[80:83]
v_mov_b32 v44,s96
ds_write_b32 v46,v44
v_mfma_f32_16x16x32_bf16 v[84:87],a[76:79],v[204:207],v[84:87]
v_mfma_f32_16x16x32_bf16 v[80:83],a[80:83],v[208:211],v[80:83]
v_mfma_f32_16x16x32_bf16 v[84:87],a[84:87],v[212:215],v[84:87]
v_mfma_f32_16x16x32_bf16 v[80:83],a[88:91],v[216:219],v[80:83]
buffer_load_dwordx4 v[92:95],v26,s[20:23],s77 offen offset:1024 sc1
v_mfma_f32_16x16x32_bf16 v[84:87],a[92:95],v[220:223],v[84:87]
v_mfma_f32_16x16x32_bf16 v[80:83],a[96:99],v[224:227],v[80:83]
v_mfma_f32_16x16x32_bf16 v[84:87],a[100:103],v[228:231],v[84:87]
v_mfma_f32_16x16x32_bf16 v[80:83],a[104:107],v[232:235],v[80:83]
v_mfma_f32_16x16x32_bf16 v[84:87],a[108:111],v[236:239],v[84:87]
s_branch epi_258
both_259:
s_waitcnt vmcnt(8)
s_barrier
ds_read_b128 v[224:227],v18 offset:0
ds_read_b128 v[228:231],v18 offset:2048
ds_read_b128 v[232:235],v18 offset:4096
ds_read_b128 v[236:239],v18 offset:6144
ds_read_b128 v[240:243],v18 offset:8192
ds_read_b128 v[244:247],v18 offset:10240
ds_read_b128 v[248:251],v18 offset:12288
s_waitcnt lgkmcnt(5)
v_mfma_f32_16x16x32_bf16 v[64:67],a[0:3],v[224:227],0
v_min_u32 v27,v224,v228
s_xor_b32 m0,s91,17408
v_mfma_f32_16x16x32_bf16 v[68:71],a[112:115],v[224:227],0
ds_read_b128 v[252:255],v18 offset:14336
s_add_u32 s88,s70,s75
v_mfma_f32_16x16x32_bf16 v[64:67],a[4:7],v[228:231],v[64:67]
s_add_u32 s65,s95,32768
s_add_u32 s88,s88,2097152
v_mfma_f32_16x16x32_bf16 v[68:71],a[116:119],v[228:231],v[68:71]
s_waitcnt vmcnt(6)
s_barrier
ds_read_b128 v[224:227],v18 offset:16384
s_waitcnt lgkmcnt(5)
v_mfma_f32_16x16x32_bf16 v[64:67],a[8:11],v[232:235],v[64:67]
v_min3_u32 v27,v27,v232,v236
buffer_load_dwordx4 v16,s[20:23],s65 offen offset:0 sc1 lds
v_mfma_f32_16x16x32_bf16 v[68:71],a[120:123],v[232:235],v[68:71]
ds_read_b128 v[228:231],v18 offset:18432
s_xor_b32 s88,s88,0x2000
v_mfma_f32_16x16x32_bf16 v[64:67],a[12:15],v[236:239],v[64:67]
buffer_load_dwordx4 v16,s[20:23],s65 offen offset:2048 sc1 lds
v_mfma_f32_16x16x32_bf16 v[68:71],a[124:127],v[236:239],v[68:71]
ds_read_b128 v[232:235],v18 offset:20480
s_waitcnt lgkmcnt(5)
v_mfma_f32_16x16x32_bf16 v[64:67],a[16:19],v[240:243],v[64:67]
v_min3_u32 v27,v27,v240,v244
s_xor_b32 m0,s91,33792
v_mfma_f32_16x16x32_bf16 v[68:71],a[128:131],v[240:243],v[68:71]
ds_read_b128 v[236:239],v18 offset:22528
s_xor_b32 s89,s88,1024
v_mfma_f32_16x16x32_bf16 v[64:67],a[20:23],v[244:247],v[64:67]
s_add_u32 s65,s95,65536
v_mfma_f32_16x16x32_bf16 v[68:71],a[132:135],v[244:247],v[68:71]
ds_read_b128 v[240:243],v18 offset:24576
s_waitcnt lgkmcnt(5)
v_mfma_f32_16x16x32_bf16 v[64:67],a[24:27],v[248:251],v[64:67]
v_min3_u32 v27,v27,v248,v252
buffer_load_dwordx4 v16,s[20:23],s65 offen offset:0 sc1 lds
v_mfma_f32_16x16x32_bf16 v[68:71],a[136:139],v[248:251],v[68:71]
ds_read_b128 v[244:247],v18 offset:26624
v_mfma_f32_16x16x32_bf16 v[64:67],a[28:31],v[252:255],v[64:67]
buffer_load_dwordx4 v16,s[20:23],s65 offen offset:2048 sc1 lds
v_mfma_f32_16x16x32_bf16 v[68:71],a[140:143],v[252:255],v[68:71]
ds_read_b128 v[248:251],v18 offset:28672
s_waitcnt lgkmcnt(5)
v_mfma_f32_16x16x32_bf16 v[64:67],a[32:35],v[224:227],v[64:67]
v_min3_u32 v27,v27,v224,v228
s_xor_b32 m0,s91,50176
v_mfma_f32_16x16x32_bf16 v[68:71],a[144:147],v[224:227],v[68:71]
ds_read_b128 v[252:255],v18 offset:30720
v_mfma_f32_16x16x32_bf16 v[64:67],a[36:39],v[228:231],v[64:67]
s_add_u32 s65,s95,s86
v_mfma_f32_16x16x32_bf16 v[68:71],a[148:151],v[228:231],v[68:71]
s_waitcnt vmcnt(6)
s_barrier
ds_read_b128 v[224:227],v18 offset:32768
s_waitcnt lgkmcnt(5)
v_mfma_f32_16x16x32_bf16 v[64:67],a[40:43],v[232:235],v[64:67]
v_min3_u32 v27,v27,v232,v236
buffer_load_dwordx4 v16,s[20:23],s65 offen offset:0 sc1 lds
v_mfma_f32_16x16x32_bf16 v[68:71],a[152:155],v[232:235],v[68:71]
ds_read_b128 v[228:231],v18 offset:34816
v_mfma_f32_16x16x32_bf16 v[64:67],a[44:47],v[236:239],v[64:67]
buffer_load_dwordx4 v16,s[20:23],s65 offen offset:2048 sc1 lds
v_mfma_f32_16x16x32_bf16 v[68:71],a[156:159],v[236:239],v[68:71]
ds_read_b128 v[232:235],v18 offset:36864
s_waitcnt lgkmcnt(5)
v_mfma_f32_16x16x32_bf16 v[64:67],a[48:51],v[240:243],v[64:67]
v_min3_u32 v27,v27,v240,v244
v_mfma_f32_16x16x32_bf16 v[68:71],a[160:163],v[240:243],v[68:71]
ds_read_b128 v[236:239],v18 offset:38912
v_mfma_f32_16x16x32_bf16 v[64:67],a[52:55],v[244:247],v[64:67]
buffer_store_dwordx4 v[48:51],v26,s[24:27],s48 offen offset:1024
v_mfma_f32_16x16x32_bf16 v[68:71],a[164:167],v[244:247],v[68:71]
ds_read_b128 v[240:243],v18 offset:40960
s_waitcnt lgkmcnt(5)
v_mfma_f32_16x16x32_bf16 v[64:67],a[56:59],v[248:251],v[64:67]
v_min3_u32 v27,v27,v248,v252
buffer_store_dwordx4 v[48:51],v26,s[28:31],s48 offen offset:1024 sc1
v_mfma_f32_16x16x32_bf16 v[68:71],a[168:171],v[248:251],v[68:71]
ds_read_b128 v[244:247],v18 offset:43008
buffer_store_dwordx4 v[48:51],v26,s[24:27],s48 offen offset:2048
v_mfma_f32_16x16x32_bf16 v[64:67],a[60:63],v[252:255],v[64:67]
buffer_store_dwordx4 v[48:51],v26,s[28:31],s48 offen offset:2048 sc1
v_mfma_f32_16x16x32_bf16 v[68:71],a[172:175],v[252:255],v[68:71]
ds_read_b128 v[248:251],v18 offset:45056
s_waitcnt lgkmcnt(5)
v_mfma_f32_16x16x32_bf16 v[64:67],a[64:67],v[224:227],v[64:67]
s_waitcnt vmcnt(8)
s_barrier
ds_read_b128 v[128:131],v17 offset:0
ds_read_b128 v[132:135],v17 offset:2048
v_mfma_f32_16x16x32_bf16 v[68:71],a[176:179],v[224:227],v[68:71]
ds_read_b128 v[252:255],v18 offset:47104
v_min3_u32 v27,v27,v224,v228
s_xor_b32 m0,s72,0
v_mfma_f32_16x16x32_bf16 v[64:67],a[68:71],v[228:231],v[64:67]
ds_read_b128 v[136:139],v17 offset:4096
buffer_store_dwordx4 v[48:51],v26,s[24:27],s48 offen offset:3072
v_mfma_f32_16x16x32_bf16 v[68:71],a[180:183],v[228:231],v[68:71]
ds_read_b128 v[224:227],v18 offset:49152
s_add_u32 s65,s88,0
s_waitcnt lgkmcnt(8)
v_mfma_f32_16x16x32_bf16 v[64:67],a[72:75],v[232:235],v[64:67]
ds_read_b128 v[140:143],v17 offset:6144
v_min3_u32 v27,v27,v232,v236
v_mfma_f32_16x16x32_bf16 v[68:71],a[184:187],v[232:235],v[68:71]
ds_read_b128 v[228:231],v18 offset:51200
buffer_store_dwordx4 v[48:51],v26,s[28:31],s48 offen offset:3072 sc1
v_mfma_f32_16x16x32_bf16 v[64:67],a[76:79],v[236:239],v[64:67]
ds_read_b128 v[144:147],v17 offset:8192
ds_read_b128 v[148:151],v17 offset:10240
s_mov_b32 s48,0x7fff0000
v_mfma_f32_16x16x32_bf16 v[68:71],a[188:191],v[236:239],v[68:71]
ds_read_b128 v[232:235],v18 offset:53248
s_waitcnt lgkmcnt(11)
v_mfma_f32_16x16x32_bf16 v[64:67],a[80:83],v[240:243],v[64:67]
ds_read_b128 v[152:155],v17 offset:12288
v_min3_u32 v27,v27,v240,v244
v_mfma_f32_16x16x32_bf16 v[68:71],a[192:195],v[240:243],v[68:71]
ds_read_b128 v[236:239],v18 offset:55296
buffer_load_dwordx2 v[120:121],v20,s[20:23],s76 offen sc1
v_mfma_f32_16x16x32_bf16 v[64:67],a[84:87],v[244:247],v[64:67]
ds_read_b128 v[156:159],v17 offset:14336
buffer_load_dwordx2 v[122:123],v24,s[20:23],s70 offen sc1
v_mfma_f32_16x16x32_bf16 v[68:71],a[196:199],v[244:247],v[68:71]
buffer_load_dwordx4 v16,s[20:23],s65 offen offset:0 sc1 lds
s_waitcnt lgkmcnt(10)
v_mfma_f32_16x16x32_bf16 v[64:67],a[88:91],v[248:251],v[64:67]
ds_read_b128 v[160:163],v17 offset:16384
ds_read_b128 v[164:167],v17 offset:18432
v_mfma_f32_16x16x32_bf16 v[68:71],a[200:203],v[248:251],v[68:71]
v_min3_u32 v27,v27,v248,v252
buffer_load_dwordx4 v16,s[20:23],s65 offen offset:2048 sc1 lds
v_mfma_f32_16x16x32_bf16 v[64:67],a[92:95],v[252:255],v[64:67]
ds_read_b128 v[168:171],v17 offset:20480
s_xor_b32 m0,s72,16384
s_add_u32 s65,s88,32768
v_mfma_f32_16x16x32_bf16 v[68:71],a[204:207],v[252:255],v[68:71]
buffer_load_dwordx4 v16,s[20:23],s65 offen offset:0 sc1 lds
s_waitcnt lgkmcnt(9)
v_mfma_f32_16x16x32_bf16 v[64:67],a[96:99],v[224:227],v[64:67]
ds_read_b128 v[172:175],v17 offset:22528
v_min3_u32 v27,v27,v224,v228
v_mfma_f32_16x16x32_bf16 v[68:71],a[208:211],v[224:227],v[68:71]
v_min3_u32 v27,v27,v226,v230
buffer_load_dwordx4 v16,s[20:23],s65 offen offset:2048 sc1 lds
v_mfma_f32_16x16x32_bf16 v[64:67],a[100:103],v[228:231],v[64:67]
ds_read_b128 v[176:179],v17 offset:24576
ds_read_b128 v[180:183],v17 offset:26624
s_xor_b32 m0,s72,32768
v_mfma_f32_16x16x32_bf16 v[68:71],a[212:215],v[228:231],v[68:71]
s_add_u32 s65,s88,65536
s_waitcnt lgkmcnt(7)
v_mfma_f32_16x16x32_bf16 v[64:67],a[104:107],v[232:235],v[64:67]
ds_read_b128 v[184:187],v17 offset:28672
v_min3_u32 v27,v27,v232,v236
v_mfma_f32_16x16x32_bf16 v[68:71],a[216:219],v[232:235],v[68:71]
v_min3_u32 v27,v27,v234,v238
buffer_load_dwordx4 v16,s[20:23],s65 offen offset:0 sc1 lds
v_mfma_f32_16x16x32_bf16 v[64:67],a[108:111],v[236:239],v[64:67]
ds_read_b128 v[188:191],v17 offset:30720
buffer_load_dword v2,v21,s[20:23],s87 offen sc1
v_mfma_f32_16x16x32_bf16 v[68:71],a[220:223],v[236:239],v[68:71]
s_add_u32 s96,s71,2
v_mfma_f32_16x16x32_bf16 v[72:75],a[112:115],v[128:131],0
v_cmp_eq_u32 vcc,0,v27
s_cbranch_vccnz retry_255
v_mfma_f32_16x16x32_bf16 v[76:79],a[116:119],v[132:135],0
v_min3_u32 v27,v27,v128,v132
s_cmp_gt_u32 s96,56
s_addc_u32 s96,s96,0
v_mfma_f32_16x16x32_bf16 v[72:75],a[120:123],v[136:139],v[72:75]
s_waitcnt vmcnt(14)
s_barrier
ds_read_b128 v[192:195],v17 offset:32768
v_mfma_f32_16x16x32_bf16 v[76:79],a[124:127],v[140:143],v[76:79]
ds_read_b128 v[196:199],v17 offset:34816
s_waitcnt lgkmcnt(10)
v_mfma_f32_16x16x32_bf16 v[72:75],a[128:131],v[144:147],v[72:75]
ds_read_b128 v[200:203],v17 offset:36864
v_min3_u32 v27,v27,v136,v140
s_waitcnt vmcnt(6)
v_mfma_f32_16x16x32_bf16 v[76:79],a[132:135],v[148:151],v[76:79]
ds_read_b128 v[204:207],v17 offset:38912
v_min3_u32 v27,v27,v144,v148
v_max_u32 v64,1,v64
v_mfma_f32_16x16x32_bf16 v[72:75],a[136:139],v[152:155],v[72:75]
ds_read_b128 v[208:211],v17 offset:40960
s_add_u32 s64,s49,s34
v_mfma_f32_16x16x32_bf16 v[76:79],a[140:143],v[156:159],v[76:79]
v_min3_u32 v27,v27,v152,v156
s_waitcnt lgkmcnt(9)
v_mfma_f32_16x16x32_bf16 v[72:75],a[144:147],v[160:163],v[72:75]
ds_read_b128 v[212:215],v17 offset:43008
buffer_store_dwordx4 v[64:67],v25,s[24:27],s64 offen offset:2048
v_mfma_f32_16x16x32_bf16 v[76:79],a[148:151],v[164:167],v[76:79]
ds_read_b128 v[216:219],v17 offset:45056
v_min3_u32 v27,v27,v160,v164
v_mfma_f32_16x16x32_bf16 v[72:75],a[152:155],v[168:171],v[72:75]
ds_read_b128 v[220:223],v17 offset:47104
buffer_store_dwordx4 v[64:67],v25,s[28:31],s64 offen offset:2048 sc1
v_mfma_f32_16x16x32_bf16 v[76:79],a[156:159],v[172:175],v[76:79]
ds_read_b128 v[224:227],v17 offset:49152
v_max_u32 v68,1,v68
s_waitcnt lgkmcnt(9)
v_mfma_f32_16x16x32_bf16 v[72:75],a[160:163],v[176:179],v[72:75]
ds_read_b128 v[228:231],v17 offset:51200
v_min3_u32 v27,v27,v168,v172
s_add_u32 s64,s49,s35
v_mfma_f32_16x16x32_bf16 v[76:79],a[164:167],v[180:183],v[76:79]
v_min3_u32 v27,v27,v176,v180
buffer_store_dwordx4 v[68:71],v25,s[24:27],s64 offen offset:3072
v_mfma_f32_16x16x32_bf16 v[72:75],a[168:171],v[184:187],v[72:75]
ds_read_b128 v[232:235],v17 offset:53248
buffer_store_dwordx4 v[68:71],v25,s[28:31],s64 offen offset:3072 sc1
v_mfma_f32_16x16x32_bf16 v[76:79],a[172:175],v[188:191],v[76:79]
ds_read_b128 v[236:239],v17 offset:55296
s_waitcnt lgkmcnt(8)
v_mfma_f32_16x16x32_bf16 v[72:75],a[176:179],v[192:195],v[72:75]
v_min3_u32 v27,v27,v184,v188
s_mov_b32 s49,0x7fff0000
v_mfma_f32_16x16x32_bf16 v[76:79],a[180:183],v[196:199],v[76:79]
v_min3_u32 v27,v27,v192,v196
ds_bpermute_b32 v124,v41,v120
v_mfma_f32_16x16x32_bf16 v[72:75],a[184:187],v[200:203],v[72:75]
buffer_load_dwordx4 v16,s[20:23],s65 offen offset:2048 sc1 lds
s_xor_b32 m0,s72,49152
v_mfma_f32_16x16x32_bf16 v[76:79],a[188:191],v[204:207],v[76:79]
v_min3_u32 v27,v27,v200,v204
s_waitcnt lgkmcnt(5)
v_mfma_f32_16x16x32_bf16 v[72:75],a[192:195],v[208:211],v[72:75]
ds_bpermute_b32 v125,v41,v121
s_add_u32 s65,s88,s86
v_mfma_f32_16x16x32_bf16 v[76:79],a[196:199],v[212:215],v[76:79]
v_min3_u32 v27,v27,v208,v212
v_lshlrev_b32 v108,16,v122
v_mfma_f32_16x16x32_bf16 v[72:75],a[200:203],v[216:219],v[72:75]
buffer_load_dwordx4 v16,s[20:23],s65 offen offset:0 sc1 lds
v_mfma_f32_16x16x32_bf16 v[76:79],a[204:207],v[220:223],v[76:79]
v_min3_u32 v27,v27,v216,v220
s_waitcnt lgkmcnt(2)
v_mfma_f32_16x16x32_bf16 v[72:75],a[208:211],v[224:227],v[72:75]
v_and_b32 v109,s80,v122
v_mfma_f32_16x16x32_bf16 v[76:79],a[212:215],v[228:231],v[76:79]
v_min3_u32 v27,v27,v224,v228
v_min3_u32 v27,v27,v226,v230
v_mfma_f32_16x16x32_bf16 v[72:75],a[216:219],v[232:235],v[72:75]
v_lshlrev_b32 v110,16,v123
v_mfma_f32_16x16x32_bf16 v[76:79],a[220:223],v[236:239],v[76:79]
v_min3_u32 v27,v27,v232,v236
v_min3_u32 v27,v27,v234,v238
v_mfma_f32_16x16x32_bf16 v[80:83],a[0:3],v[128:131],0
v_cmp_eq_u32 vcc,0,v27
s_cbranch_vccnz retry_255
v_mfma_f32_16x16x32_bf16 v[84:87],a[4:7],v[132:135],0
v_and_b32 v111,s80,v123
s_waitcnt lgkmcnt(0)
v_mfma_f32_16x16x32_bf16 v[80:83],a[8:11],v[136:139],v[80:83]
buffer_load_dwordx4 v16,s[20:23],s65 offen offset:2048 sc1 lds
v_mfma_f32_16x16x32_bf16 v[84:87],a[12:15],v[140:143],v[84:87]
v_lshlrev_b32 v104,16,v124
s_xor_b32 m0,s72,1024
v_mfma_f32_16x16x32_bf16 v[80:83],a[16:19],v[144:147],v[80:83]
v_add_f32 v72,v72,v76
v_add_f32 v73,v73,v77
v_mfma_f32_16x16x32_bf16 v[84:87],a[20:23],v[148:151],v[84:87]
v_and_b32 v105,s80,v124
v_add_f32 v74,v74,v78
v_mfma_f32_16x16x32_bf16 v[80:83],a[24:27],v[152:155],v[80:83]
v_add_f32 v75,v75,v79
v_max_u32 v72,1,v72
v_mfma_f32_16x16x32_bf16 v[84:87],a[28:31],v[156:159],v[84:87]
v_lshlrev_b32 v106,16,v125
s_add_u32 s64,s77,s33
v_mfma_f32_16x16x32_bf16 v[80:83],a[32:35],v[160:163],v[80:83]
buffer_store_dwordx4 v[72:75],v25,s[24:27],s64 offen offset:1024
v_mfma_f32_16x16x32_bf16 v[84:87],a[36:39],v[164:167],v[84:87]
v_and_b32 v107,s80,v125
s_add_u32 s65,s89,0
v_mfma_f32_16x16x32_bf16 v[80:83],a[40:43],v[168:171],v[80:83]
buffer_store_dwordx4 v[72:75],v25,s[28:31],s64 offen offset:1024 sc1
v_mfma_f32_16x16x32_bf16 v[84:87],a[44:47],v[172:175],v[84:87]
buffer_load_dwordx4 v16,s[20:23],s65 offen offset:0 sc1 lds
v_mfma_f32_16x16x32_bf16 v[80:83],a[48:51],v[176:179],v[80:83]
buffer_load_dwordx4 v[96:99],v26,s[20:23],s77 offen offset:2048 sc1
v_mfma_f32_16x16x32_bf16 v[84:87],a[52:55],v[180:183],v[84:87]
buffer_load_dwordx4 v[100:103],v26,s[20:23],s77 offen offset:3072 sc1
v_mfma_f32_16x16x32_bf16 v[80:83],a[56:59],v[184:187],v[80:83]
buffer_load_dwordx4 v16,s[20:23],s65 offen offset:2048 sc1 lds
v_mfma_f32_16x16x32_bf16 v[84:87],a[60:63],v[188:191],v[84:87]
s_xor_b32 m0,s72,17408
s_add_u32 s65,s89,32768
v_mfma_f32_16x16x32_bf16 v[80:83],a[64:67],v[192:195],v[80:83]
s_waitcnt vmcnt(13)
v_mfma_f32_16x16x32_bf16 v[84:87],a[68:71],v[196:199],v[84:87]
v_cmp_gt_u32 vcc,s96,v2
s_mov_b32 s96,vcc_lo
v_mfma_f32_16x16x32_bf16 v[80:83],a[72:75],v[200:203],v[80:83]
v_mov_b32 v44,s96
ds_write_b32 v46,v44
v_mfma_f32_16x16x32_bf16 v[84:87],a[76:79],v[204:207],v[84:87]
buffer_load_dwordx4 v16,s[20:23],s65 offen offset:0 sc1 lds
v_mfma_f32_16x16x32_bf16 v[80:83],a[80:83],v[208:211],v[80:83]
buffer_load_dwordx4 v16,s[20:23],s65 offen offset:2048 sc1 lds
v_mfma_f32_16x16x32_bf16 v[84:87],a[84:87],v[212:215],v[84:87]
s_xor_b32 m0,s72,33792
s_add_u32 s65,s89,65536
v_mfma_f32_16x16x32_bf16 v[80:83],a[88:91],v[216:219],v[80:83]
buffer_load_dwordx4 v[92:95],v26,s[20:23],s77 offen offset:1024 sc1
v_mfma_f32_16x16x32_bf16 v[84:87],a[92:95],v[220:223],v[84:87]
buffer_load_dwordx4 v16,s[20:23],s65 offen offset:0 sc1 lds
v_mfma_f32_16x16x32_bf16 v[80:83],a[96:99],v[224:227],v[80:83]
buffer_load_dwordx4 v16,s[20:23],s65 offen offset:2048 sc1 lds
v_mfma_f32_16x16x32_bf16 v[84:87],a[100:103],v[228:231],v[84:87]
s_xor_b32 m0,s72,50176
s_add_u32 s65,s89,s86
v_mfma_f32_16x16x32_bf16 v[80:83],a[104:107],v[232:235],v[80:83]
buffer_load_dwordx4 v16,s[20:23],s65 offen offset:0 sc1 lds
v_mfma_f32_16x16x32_bf16 v[84:87],a[108:111],v[236:239],v[84:87]
buffer_load_dwordx4 v16,s[20:23],s65 offen offset:2048 sc1 lds
s_branch epi_258
ahead_257:
s_waitcnt vmcnt(2) lgkmcnt(0)
s_barrier
ds_read_b32 v44,v45
ds_read_b128 v[224:227],v18 offset:0
ds_read_b128 v[228:231],v18 offset:2048
ds_read_b128 v[232:235],v18 offset:4096
ds_read_b128 v[236:239],v18 offset:6144
ds_read_b128 v[240:243],v18 offset:8192
ds_read_b128 v[244:247],v18 offset:10240
ds_read_b128 v[248:251],v18 offset:12288
s_waitcnt lgkmcnt(5)
v_mfma_f32_16x16x32_bf16 v[64:67],a[0:3],v[224:227],0
s_add_u32 s88,s70,s75
s_add_u32 s88,s88,2097152
v_mfma_f32_16x16x32_bf16 v[68:71],a[112:115],v[224:227],0
ds_read_b128 v[252:255],v18 offset:14336
s_xor_b32 s88,s88,0x2000
v_mfma_f32_16x16x32_bf16 v[64:67],a[4:7],v[228:231],v[64:67]
v_readfirstlane_b32 s83,v44
v_mfma_f32_16x16x32_bf16 v[68:71],a[116:119],v[228:231],v[68:71]
ds_read_b128 v[224:227],v18 offset:16384
s_waitcnt lgkmcnt(5)
v_mfma_f32_16x16x32_bf16 v[64:67],a[8:11],v[232:235],v[64:67]
s_cmp_eq_u32 s83,0
s_cselect_b32 s88,s88,0x7fff0000
v_mfma_f32_16x16x32_bf16 v[68:71],a[120:123],v[232:235],v[68:71]
ds_read_b128 v[228:231],v18 offset:18432
s_xor_b32 s89,s88,1024
v_mfma_f32_16x16x32_bf16 v[64:67],a[12:15],v[236:239],v[64:67]
buffer_store_dwordx4 v[48:51],v26,s[24:27],s48 offen offset:1024
v_mfma_f32_16x16x32_bf16 v[68:71],a[124:127],v[236:239],v[68:71]
ds_read_b128 v[232:235],v18 offset:20480
s_waitcnt lgkmcnt(5)
v_mfma_f32_16x16x32_bf16 v[64:67],a[16:19],v[240:243],v[64:67]
buffer_store_dwordx4 v[48:51],v26,s[28:31],s48 offen offset:1024 sc1
v_mfma_f32_16x16x32_bf16 v[68:71],a[128:131],v[240:243],v[68:71]
ds_read_b128 v[236:239],v18 offset:22528
s_xor_b32 m0,s72,0
v_mfma_f32_16x16x32_bf16 v[64:67],a[20:23],v[244:247],v[64:67]
buffer_store_dwordx4 v[48:51],v26,s[24:27],s48 offen offset:2048
v_mfma_f32_16x16x32_bf16 v[68:71],a[132:135],v[244:247],v[68:71]
ds_read_b128 v[240:243],v18 offset:24576
s_waitcnt lgkmcnt(5)
v_mfma_f32_16x16x32_bf16 v[64:67],a[24:27],v[248:251],v[64:67]
buffer_store_dwordx4 v[48:51],v26,s[28:31],s48 offen offset:2048 sc1
v_mfma_f32_16x16x32_bf16 v[68:71],a[136:139],v[248:251],v[68:71]
ds_read_b128 v[244:247],v18 offset:26624
s_add_u32 s65,s88,0
v_mfma_f32_16x16x32_bf16 v[64:67],a[28:31],v[252:255],v[64:67]
buffer_store_dwordx4 v[48:51],v26,s[24:27],s48 offen offset:3072
v_mfma_f32_16x16x32_bf16 v[68:71],a[140:143],v[252:255],v[68:71]
ds_read_b128 v[248:251],v18 offset:28672
s_waitcnt lgkmcnt(5)
v_mfma_f32_16x16x32_bf16 v[64:67],a[32:35],v[224:227],v[64:67]
buffer_store_dwordx4 v[48:51],v26,s[28:31],s48 offen offset:3072 sc1
v_mfma_f32_16x16x32_bf16 v[68:71],a[144:147],v[224:227],v[68:71]
ds_read_b128 v[252:255],v18 offset:30720
s_mov_b32 s48,0x7fff0000
v_mfma_f32_16x16x32_bf16 v[64:67],a[36:39],v[228:231],v[64:67]
buffer_load_dwordx2 v[120:121],v20,s[20:23],s76 offen sc1
v_mfma_f32_16x16x32_bf16 v[68:71],a[148:151],v[228:231],v[68:71]
ds_read_b128 v[224:227],v18 offset:32768
s_waitcnt lgkmcnt(5)
v_mfma_f32_16x16x32_bf16 v[64:67],a[40:43],v[232:235],v[64:67]
buffer_load_dwordx2 v[122:123],v24,s[20:23],s70 offen sc1
v_mfma_f32_16x16x32_bf16 v[68:71],a[152:155],v[232:235],v[68:71]
ds_read_b128 v[228:231],v18 offset:34816
v_mfma_f32_16x16x32_bf16 v[64:67],a[44:47],v[236:239],v[64:67]
buffer_load_dwordx4 v16,s[20:23],s65 offen offset:0 sc1 lds
v_mfma_f32_16x16x32_bf16 v[68:71],a[156:159],v[236:239],v[68:71]
ds_read_b128 v[232:235],v18 offset:36864
s_waitcnt lgkmcnt(5)
v_mfma_f32_16x16x32_bf16 v[64:67],a[48:51],v[240:243],v[64:67]
buffer_load_dwordx4 v16,s[20:23],s65 offen offset:2048 sc1 lds
v_mfma_f32_16x16x32_bf16 v[68:71],a[160:163],v[240:243],v[68:71]
ds_read_b128 v[236:239],v18 offset:38912
s_xor_b32 m0,s72,16384
v_mfma_f32_16x16x32_bf16 v[64:67],a[52:55],v[244:247],v[64:67]
s_add_u32 s65,s88,32768
v_mfma_f32_16x16x32_bf16 v[68:71],a[164:167],v[244:247],v[68:71]
ds_read_b128 v[240:243],v18 offset:40960
s_waitcnt lgkmcnt(5)
v_mfma_f32_16x16x32_bf16 v[64:67],a[56:59],v[248:251],v[64:67]
buffer_load_dwordx4 v16,s[20:23],s65 offen offset:0 sc1 lds
v_mfma_f32_16x16x32_bf16 v[68:71],a[168:171],v[248:251],v[68:71]
ds_read_b128 v[244:247],v18 offset:43008
v_mfma_f32_16x16x32_bf16 v[64:67],a[60:63],v[252:255],v[64:67]
buffer_load_dwordx4 v16,s[20:23],s65 offen offset:2048 sc1 lds
v_mfma_f32_16x16x32_bf16 v[68:71],a[172:175],v[252:255],v[68:71]
ds_read_b128 v[248:251],v18 offset:45056
s_waitcnt lgkmcnt(5)
v_mfma_f32_16x16x32_bf16 v[64:67],a[64:67],v[224:227],v[64:67]
ds_read_b128 v[128:131],v17 offset:0
ds_read_b128 v[132:135],v17 offset:2048
v_mfma_f32_16x16x32_bf16 v[68:71],a[176:179],v[224:227],v[68:71]
ds_read_b128 v[252:255],v18 offset:47104
s_xor_b32 m0,s72,32768
v_mfma_f32_16x16x32_bf16 v[64:67],a[68:71],v[228:231],v[64:67]
ds_read_b128 v[136:139],v17 offset:4096
s_add_u32 s65,s88,65536
v_mfma_f32_16x16x32_bf16 v[68:71],a[180:183],v[228:231],v[68:71]
ds_read_b128 v[224:227],v18 offset:49152
s_waitcnt lgkmcnt(8)
v_mfma_f32_16x16x32_bf16 v[64:67],a[72:75],v[232:235],v[64:67]
ds_read_b128 v[140:143],v17 offset:6144
v_mfma_f32_16x16x32_bf16 v[68:71],a[184:187],v[232:235],v[68:71]
ds_read_b128 v[228:231],v18 offset:51200
v_mfma_f32_16x16x32_bf16 v[64:67],a[76:79],v[236:239],v[64:67]
ds_read_b128 v[144:147],v17 offset:8192
ds_read_b128 v[148:151],v17 offset:10240
v_mfma_f32_16x16x32_bf16 v[68:71],a[188:191],v[236:239],v[68:71]
ds_read_b128 v[232:235],v18 offset:53248
s_waitcnt lgkmcnt(11)
v_mfma_f32_16x16x32_bf16 v[64:67],a[80:83],v[240:243],v[64:67]
ds_read_b128 v[152:155],v17 offset:12288
v_mfma_f32_16x16x32_bf16 v[68:71],a[192:195],v[240:243],v[68:71]
ds_read_b128 v[236:239],v18 offset:55296
v_mfma_f32_16x16x32_bf16 v[64:67],a[84:87],v[244:247],v[64:67]
ds_read_b128 v[156:159],v17 offset:14336
v_mfma_f32_16x16x32_bf16 v[68:71],a[196:199],v[244:247],v[68:71]
s_waitcnt lgkmcnt(10)
v_mfma_f32_16x16x32_bf16 v[64:67],a[88:91],v[248:251],v[64:67]
ds_read_b128 v[160:163],v17 offset:16384
ds_read_b128 v[164:167],v17 offset:18432
v_mfma_f32_16x16x32_bf16 v[68:71],a[200:203],v[248:251],v[68:71]
buffer_load_dwordx4 v16,s[20:23],s65 offen offset:0 sc1 lds
v_mfma_f32_16x16x32_bf16 v[64:67],a[92:95],v[252:255],v[64:67]
ds_read_b128 v[168:171],v17 offset:20480
v_mfma_f32_16x16x32_bf16 v[68:71],a[204:207],v[252:255],v[68:71]
s_waitcnt lgkmcnt(9)
v_mfma_f32_16x16x32_bf16 v[64:67],a[96:99],v[224:227],v[64:67]
ds_read_b128 v[172:175],v17 offset:22528
v_mfma_f32_16x16x32_bf16 v[68:71],a[208:211],v[224:227],v[68:71]
buffer_load_dwordx4 v16,s[20:23],s65 offen offset:2048 sc1 lds
v_mfma_f32_16x16x32_bf16 v[64:67],a[100:103],v[228:231],v[64:67]
ds_read_b128 v[176:179],v17 offset:24576
ds_read_b128 v[180:183],v17 offset:26624
v_mfma_f32_16x16x32_bf16 v[68:71],a[212:215],v[228:231],v[68:71]
s_xor_b32 m0,s72,49152
s_waitcnt lgkmcnt(7)
v_mfma_f32_16x16x32_bf16 v[64:67],a[104:107],v[232:235],v[64:67]
ds_read_b128 v[184:187],v17 offset:28672
s_add_u32 s65,s88,s86
v_mfma_f32_16x16x32_bf16 v[68:71],a[216:219],v[232:235],v[68:71]
buffer_load_dwordx4 v16,s[20:23],s65 offen offset:0 sc1 lds
v_mfma_f32_16x16x32_bf16 v[64:67],a[108:111],v[236:239],v[64:67]
ds_read_b128 v[188:191],v17 offset:30720
buffer_load_dword v2,v21,s[20:23],s87 offen sc1
v_mfma_f32_16x16x32_bf16 v[68:71],a[220:223],v[236:239],v[68:71]
s_add_u32 s96,s71,2
v_mfma_f32_16x16x32_bf16 v[72:75],a[112:115],v[128:131],0
s_cmp_gt_u32 s96,56
s_addc_u32 s96,s96,0
v_mfma_f32_16x16x32_bf16 v[76:79],a[116:119],v[132:135],0
buffer_load_dwordx4 v16,s[20:23],s65 offen offset:2048 sc1 lds
v_mfma_f32_16x16x32_bf16 v[72:75],a[120:123],v[136:139],v[72:75]
ds_read_b128 v[192:195],v17 offset:32768
s_xor_b32 m0,s72,1024
v_mfma_f32_16x16x32_bf16 v[76:79],a[124:127],v[140:143],v[76:79]
ds_read_b128 v[196:199],v17 offset:34816
s_waitcnt lgkmcnt(10)
v_mfma_f32_16x16x32_bf16 v[72:75],a[128:131],v[144:147],v[72:75]
ds_read_b128 v[200:203],v17 offset:36864
s_waitcnt vmcnt(9)
v_max_u32 v64,1,v64
v_mfma_f32_16x16x32_bf16 v[76:79],a[132:135],v[148:151],v[76:79]
ds_read_b128 v[204:207],v17 offset:38912
s_add_u32 s64,s49,s34
v_mfma_f32_16x16x32_bf16 v[72:75],a[136:139],v[152:155],v[72:75]
ds_read_b128 v[208:211],v17 offset:40960
buffer_store_dwordx4 v[64:67],v25,s[24:27],s64 offen offset:2048
v_mfma_f32_16x16x32_bf16 v[76:79],a[140:143],v[156:159],v[76:79]
buffer_store_dwordx4 v[64:67],v25,s[28:31],s64 offen offset:2048 sc1
s_waitcnt lgkmcnt(9)
v_mfma_f32_16x16x32_bf16 v[72:75],a[144:147],v[160:163],v[72:75]
ds_read_b128 v[212:215],v17 offset:43008
v_max_u32 v68,1,v68
s_add_u32 s64,s49,s35
v_mfma_f32_16x16x32_bf16 v[76:79],a[148:151],v[164:167],v[76:79]
ds_read_b128 v[216:219],v17 offset:45056
buffer_store_dwordx4 v[68:71],v25,s[24:27],s64 offen offset:3072
v_mfma_f32_16x16x32_bf16 v[72:75],a[152:155],v[168:171],v[72:75]
ds_read_b128 v[220:223],v17 offset:47104
s_add_u32 s65,s89,0
v_mfma_f32_16x16x32_bf16 v[76:79],a[156:159],v[172:175],v[76:79]
ds_read_b128 v[224:227],v17 offset:49152
s_waitcnt lgkmcnt(9)
v_mfma_f32_16x16x32_bf16 v[72:75],a[160:163],v[176:179],v[72:75]
ds_read_b128 v[228:231],v17 offset:51200
v_mfma_f32_16x16x32_bf16 v[76:79],a[164:167],v[180:183],v[76:79]
buffer_store_dwordx4 v[68:71],v25,s[28:31],s64 offen offset:3072 sc1
v_mfma_f32_16x16x32_bf16 v[72:75],a[168:171],v[184:187],v[72:75]
ds_read_b128 v[232:235],v17 offset:53248
s_mov_b32 s49,0x7fff0000
v_mfma_f32_16x16x32_bf16 v[76:79],a[172:175],v[188:191],v[76:79]
ds_read_b128 v[236:239],v17 offset:55296
s_waitcnt lgkmcnt(8)
v_mfma_f32_16x16x32_bf16 v[72:75],a[176:179],v[192:195],v[72:75]
buffer_load_dwordx4 v16,s[20:23],s65 offen offset:0 sc1 lds
v_mfma_f32_16x16x32_bf16 v[76:79],a[180:183],v[196:199],v[76:79]
ds_bpermute_b32 v124,v41,v120
v_mfma_f32_16x16x32_bf16 v[72:75],a[184:187],v[200:203],v[72:75]
buffer_load_dwordx4 v16,s[20:23],s65 offen offset:2048 sc1 lds
v_mfma_f32_16x16x32_bf16 v[76:79],a[188:191],v[204:207],v[76:79]
ds_bpermute_b32 v125,v41,v121
s_waitcnt lgkmcnt(6)
v_mfma_f32_16x16x32_bf16 v[72:75],a[192:195],v[208:211],v[72:75]
s_xor_b32 m0,s72,17408
s_add_u32 s65,s89,32768
v_mfma_f32_16x16x32_bf16 v[76:79],a[196:199],v[212:215],v[76:79]
v_lshlrev_b32 v108,16,v122
v_mfma_f32_16x16x32_bf16 v[72:75],a[200:203],v[216:219],v[72:75]
buffer_load_dwordx4 v16,s[20:23],s65 offen offset:0 sc1 lds
v_mfma_f32_16x16x32_bf16 v[76:79],a[204:207],v[220:223],v[76:79]
v_and_b32 v109,s80,v122
s_waitcnt lgkmcnt(2)
v_mfma_f32_16x16x32_bf16 v[72:75],a[208:211],v[224:227],v[72:75]
buffer_load_dwordx4 v16,s[20:23],s65 offen offset:2048 sc1 lds
v_mfma_f32_16x16x32_bf16 v[76:79],a[212:215],v[228:231],v[76:79]
v_lshlrev_b32 v110,16,v123
s_xor_b32 m0,s72,33792
v_mfma_f32_16x16x32_bf16 v[72:75],a[216:219],v[232:235],v[72:75]
s_add_u32 s65,s89,65536
v_mfma_f32_16x16x32_bf16 v[76:79],a[220:223],v[236:239],v[76:79]
v_and_b32 v111,s80,v123
v_mfma_f32_16x16x32_bf16 v[80:83],a[0:3],v[128:131],0
buffer_load_dwordx4 v16,s[20:23],s65 offen offset:0 sc1 lds
v_mfma_f32_16x16x32_bf16 v[84:87],a[4:7],v[132:135],0
s_waitcnt lgkmcnt(0)
v_mfma_f32_16x16x32_bf16 v[80:83],a[8:11],v[136:139],v[80:83]
buffer_load_dwordx4 v16,s[20:23],s65 offen offset:2048 sc1 lds
v_mfma_f32_16x16x32_bf16 v[84:87],a[12:15],v[140:143],v[84:87]
v_lshlrev_b32 v104,16,v124
s_xor_b32 m0,s72,50176
v_mfma_f32_16x16x32_bf16 v[80:83],a[16:19],v[144:147],v[80:83]
v_add_f32 v72,v72,v76
v_add_f32 v73,v73,v77
v_mfma_f32_16x16x32_bf16 v[84:87],a[20:23],v[148:151],v[84:87]
v_and_b32 v105,s80,v124
v_add_f32 v74,v74,v78
v_mfma_f32_16x16x32_bf16 v[80:83],a[24:27],v[152:155],v[80:83]
v_add_f32 v75,v75,v79
v_max_u32 v72,1,v72
v_mfma_f32_16x16x32_bf16 v[84:87],a[28:31],v[156:159],v[84:87]
v_lshlrev_b32 v106,16,v125
s_add_u32 s64,s77,s33
v_mfma_f32_16x16x32_bf16 v[80:83],a[32:35],v[160:163],v[80:83]
buffer_store_dwordx4 v[72:75],v25,s[24:27],s64 offen offset:1024
v_mfma_f32_16x16x32_bf16 v[84:87],a[36:39],v[164:167],v[84:87]
v_and_b32 v107,s80,v125
s_add_u32 s65,s89,s86
v_mfma_f32_16x16x32_bf16 v[80:83],a[40:43],v[168:171],v[80:83]
buffer_store_dwordx4 v[72:75],v25,s[28:31],s64 offen offset:1024 sc1
v_mfma_f32_16x16x32_bf16 v[84:87],a[44:47],v[172:175],v[84:87]
buffer_load_dwordx4 v16,s[20:23],s65 offen offset:0 sc1 lds
v_mfma_f32_16x16x32_bf16 v[80:83],a[48:51],v[176:179],v[80:83]
buffer_load_dwordx4 v[96:99],v26,s[20:23],s77 offen offset:2048 sc1
v_mfma_f32_16x16x32_bf16 v[84:87],a[52:55],v[180:183],v[84:87]
buffer_load_dwordx4 v[100:103],v26,s[20:23],s77 offen offset:3072 sc1
v_mfma_f32_16x16x32_bf16 v[80:83],a[56:59],v[184:187],v[80:83]
buffer_load_dwordx4 v16,s[20:23],s65 offen offset:2048 sc1 lds
v_mfma_f32_16x16x32_bf16 v[84:87],a[60:63],v[188:191],v[84:87]
v_mfma_f32_16x16x32_bf16 v[80:83],a[64:67],v[192:195],v[80:83]
s_waitcnt vmcnt(17)
v_mfma_f32_16x16x32_bf16 v[84:87],a[68:71],v[196:199],v[84:87]
v_cmp_gt_u32 vcc,s96,v2
s_mov_b32 s96,vcc_lo
v_mfma_f32_16x16x32_bf16 v[80:83],a[72:75],v[200:203],v[80:83]
v_mov_b32 v44,s96
ds_write_b32 v46,v44
v_mfma_f32_16x16x32_bf16 v[84:87],a[76:79],v[204:207],v[84:87]
v_mfma_f32_16x16x32_bf16 v[80:83],a[80:83],v[208:211],v[80:83]
v_mfma_f32_16x16x32_bf16 v[84:87],a[84:87],v[212:215],v[84:87]
v_mfma_f32_16x16x32_bf16 v[80:83],a[88:91],v[216:219],v[80:83]
buffer_load_dwordx4 v[92:95],v26,s[20:23],s77 offen offset:1024 sc1
v_mfma_f32_16x16x32_bf16 v[84:87],a[92:95],v[220:223],v[84:87]
v_mfma_f32_16x16x32_bf16 v[80:83],a[96:99],v[224:227],v[80:83]
v_mfma_f32_16x16x32_bf16 v[84:87],a[100:103],v[228:231],v[84:87]
v_mfma_f32_16x16x32_bf16 v[80:83],a[104:107],v[232:235],v[80:83]
v_mfma_f32_16x16x32_bf16 v[84:87],a[108:111],v[236:239],v[84:87]
epi_258:
buffer_load_dword v29,v21,s[20:23],s87 offen sc1
s_nop 6
v_pk_add_f32 v[88:89],v[80:81],v[84:85]
v_pk_add_f32 v[90:91],v[82:83],v[86:87]
v_pk_add_f32 v[88:89],v[88:89],v[108:109]
v_pk_add_f32 v[90:91],v[90:91],v[110:111]
s_waitcnt vmcnt(1)
s_branch ic_265
ip_263:
buffer_load_dwordx4 v[92:95],v26,s[20:23],s77 offen offset:1024 sc1
buffer_load_dwordx4 v[96:99],v26,s[20:23],s77 offen offset:2048 sc1
buffer_load_dwordx4 v[100:103],v26,s[20:23],s77 offen offset:3072 sc1
s_waitcnt vmcnt(0)
ic_265:
v_min3_u32 v22,v92,v96,v100
v_cmp_eq_u32 vcc,0,v22
s_cbranch_vccz ik_264
s_sub_u32 s90,s90,1
s_cmp_gt_i32 s90,0
s_cbranch_scc1 ip_263
ik_264:
v_pk_add_f32 v[88:89],v[88:89],v[92:93]
v_pk_add_f32 v[96:97],v[96:97],v[100:101]
v_pk_add_f32 v[90:91],v[90:91],v[94:95]
v_pk_add_f32 v[98:99],v[98:99],v[102:103]
v_pk_add_f32 v[88:89],v[88:89],v[96:97]
v_pk_add_f32 v[90:91],v[90:91],v[98:99]
v_pk_fma_f32 v[88:89],v[88:89],v[52:53],v[104:105]
v_pk_fma_f32 v[90:91],v[90:91],v[54:55],v[106:107]
v_cvt_pk_bf16_f32 v88,v88,v89
v_cvt_pk_bf16_f32 v89,v90,v91
ds_bpermute_b32 v88,v40,v88
ds_bpermute_b32 v89,v40,v89
v_xor_b32 v18,0x10000,v18
s_xor_b32 s49,s77,524288
v_xor_b32 v20,0x2000,v20
s_add_u32 s76,s76,2097152
s_waitcnt lgkmcnt(0)
s_mov_b64 exec,s[84:85]
buffer_store_dwordx2 v[88:89],v19,s[36:39],s78 offen
s_mov_b64 exec,-1
s_mov_b64 s[84:85],-1
s_mov_b32 s48,s77
s_mov_b32 s77,s49
s_add_u32 s78,s78,65536
v_xor_b32 v17,0x10000,v17
v_xor_b32 v45,16,v45
v_xor_b32 v46,16,v46
s_xor_b32 s72,s72,0x10000
s_add_u32 s70,s70,2097152
s_xor_b32 s70,s70,0x2000
s_add_u32 s71,s71,1
s_cmp_le_u32 s71,65
s_cbranch_scc1 seg_256
s_endpgm
retry_255:
s_sub_u32 s90,s90,64
s_cmp_lt_i32 s90,0
s_cbranch_scc1 giveup_170
s_mov_b32 s83,1
s_waitcnt vmcnt(0) lgkmcnt(0)
s_barrier
s_branch seg_256
r_w3_186:
s_load_dwordx2 s[4:5],s[0:1],80
s_mul_i32 s66,s59,224
s_lshl_b32 s67,s50,1
s_waitcnt lgkmcnt(0)
s_mov_b32 s32,s4
s_and_b32 s33,s5,0xffff
s_mov_b32 s34,0x700000
s_mov_b32 s35,0x20000
v_lshrrev_b32 v5,2,v3
v_lshl_add_u32 v5,v4,2,v5
v_and_b32 v6,3,v3
v_lshlrev_b32 v6,3,v6
v_lshl_add_u32 v6,v5,8,v6
v_and_b32 v5,7,v5
v_xor_b32 v5,s67,v5
v_lshl_add_u32 v12,v5,5,v6
v_xor_b32 v13,32,v12
v_and_b32 v5,15,v1
v_and_b32 v6,3,v4
v_lshlrev_b32 v6,1,v6
v_xor_b32 v5,v5,v6
v_mul_u32_u24 v6,7168,v4
v_xor_b32 v7,0,v5
v_lshl_add_u32 v8,v7,4,v6
v_xor_b32 v7,8,v5
v_lshl_add_u32 v9,v7,4,v6
s_mul_i32 s74,s50,458752
s_add_u32 s74,s74,s66
s_lshl_b32 s75,s50,14
s_mul_i32 s76,s50,229376
s_add_u32 s76,s76,s66
s_lshl_b32 s77,s50,13
s_add_u32 s64,s74,0
s_add_u32 m0,s75,0
s_nop 0
buffer_load_dwordx4 v8,s[32:35],s64 offen  lds
s_add_u32 s64,s74,28672
s_add_u32 m0,s75,1024
s_nop 0
buffer_load_dwordx4 v9,s[32:35],s64 offen  lds
s_add_u32 s64,s74,57344
s_add_u32 m0,s75,2048
s_nop 0
buffer_load_dwordx4 v8,s[32:35],s64 offen  lds
s_add_u32 s64,s74,86016
s_add_u32 m0,s75,3072
s_nop 0
buffer_load_dwordx4 v9,s[32:35],s64 offen  lds
s_add_u32 s64,s74,114688
s_add_u32 m0,s75,4096
s_nop 0
buffer_load_dwordx4 v8,s[32:35],s64 offen  lds
s_add_u32 s64,s74,143360
s_add_u32 m0,s75,5120
s_nop 0
buffer_load_dwordx4 v9,s[32:35],s64 offen  lds
s_add_u32 s64,s74,172032
s_add_u32 m0,s75,6144
s_nop 0
buffer_load_dwordx4 v8,s[32:35],s64 offen  lds
s_add_u32 s64,s74,200704
s_add_u32 m0,s75,7168
s_nop 0
buffer_load_dwordx4 v9,s[32:35],s64 offen  lds
s_add_u32 s64,s74,229376
s_add_u32 m0,s75,8192
s_nop 0
buffer_load_dwordx4 v8,s[32:35],s64 offen  lds
s_add_u32 s64,s74,258048
s_add_u32 m0,s75,9216
s_nop 0
buffer_load_dwordx4 v9,s[32:35],s64 offen  lds
s_add_u32 s64,s74,286720
s_add_u32 m0,s75,10240
s_nop 0
buffer_load_dwordx4 v8,s[32:35],s64 offen  lds
s_add_u32 s64,s74,315392
s_add_u32 m0,s75,11264
s_nop 0
buffer_load_dwordx4 v9,s[32:35],s64 offen  lds
s_add_u32 s64,s74,344064
s_add_u32 m0,s75,12288
s_nop 0
buffer_load_dwordx4 v8,s[32:35],s64 offen  lds
s_add_u32 s64,s74,372736
s_add_u32 m0,s75,13312
s_nop 0
buffer_load_dwordx4 v9,s[32:35],s64 offen  lds
s_add_u32 s64,s74,401408
s_add_u32 m0,s75,14336
s_nop 0
buffer_load_dwordx4 v8,s[32:35],s64 offen  lds
s_add_u32 s64,s74,430080
s_add_u32 m0,s75,15360
s_nop 0
buffer_load_dwordx4 v9,s[32:35],s64 offen  lds
s_add_u32 s64,s74,1835008
s_add_u32 m0,s75,65536
s_nop 0
buffer_load_dwordx4 v8,s[32:35],s64 offen  lds
s_add_u32 s64,s74,1863680
s_add_u32 m0,s75,66560
s_nop 0
buffer_load_dwordx4 v9,s[32:35],s64 offen  lds
s_add_u32 s64,s74,1892352
s_add_u32 m0,s75,67584
s_nop 0
buffer_load_dwordx4 v8,s[32:35],s64 offen  lds
s_add_u32 s64,s74,1921024
s_add_u32 m0,s75,68608
s_nop 0
buffer_load_dwordx4 v9,s[32:35],s64 offen  lds
s_add_u32 s64,s74,1949696
s_add_u32 m0,s75,69632
s_nop 0
buffer_load_dwordx4 v8,s[32:35],s64 offen  lds
s_add_u32 s64,s74,1978368
s_add_u32 m0,s75,70656
s_nop 0
buffer_load_dwordx4 v9,s[32:35],s64 offen  lds
s_add_u32 s64,s74,2007040
s_add_u32 m0,s75,71680
s_nop 0
buffer_load_dwordx4 v8,s[32:35],s64 offen  lds
s_add_u32 s64,s74,2035712
s_add_u32 m0,s75,72704
s_nop 0
buffer_load_dwordx4 v9,s[32:35],s64 offen  lds
s_add_u32 s64,s74,2064384
s_add_u32 m0,s75,73728
s_nop 0
buffer_load_dwordx4 v8,s[32:35],s64 offen  lds
s_add_u32 s64,s74,2093056
s_add_u32 m0,s75,74752
s_nop 0
buffer_load_dwordx4 v9,s[32:35],s64 offen  lds
s_add_u32 s64,s74,2121728
s_add_u32 m0,s75,75776
s_nop 0
buffer_load_dwordx4 v8,s[32:35],s64 offen  lds
s_add_u32 s64,s74,2150400
s_add_u32 m0,s75,76800
s_nop 0
buffer_load_dwordx4 v9,s[32:35],s64 offen  lds
s_add_u32 s64,s74,2179072
s_add_u32 m0,s75,77824
s_nop 0
buffer_load_dwordx4 v8,s[32:35],s64 offen  lds
s_add_u32 s64,s74,2207744
s_add_u32 m0,s75,78848
s_nop 0
buffer_load_dwordx4 v9,s[32:35],s64 offen  lds
s_add_u32 s64,s74,2236416
s_add_u32 m0,s75,79872
s_nop 0
buffer_load_dwordx4 v8,s[32:35],s64 offen  lds
s_add_u32 s64,s74,2265088
s_add_u32 m0,s75,80896
s_nop 0
buffer_load_dwordx4 v9,s[32:35],s64 offen  lds
s_waitcnt vmcnt(16)
s_barrier
ds_read_b64_tr_b16 a[0:1],v12 offset:0
ds_read_b64_tr_b16 a[128:129],v13 offset:0
ds_read_b64_tr_b16 a[2:3],v12 offset:4096
ds_read_b64_tr_b16 a[130:131],v13 offset:4096
ds_read_b64_tr_b16 a[4:5],v12 offset:8192
ds_read_b64_tr_b16 a[132:133],v13 offset:8192
ds_read_b64_tr_b16 a[6:7],v12 offset:12288
ds_read_b64_tr_b16 a[134:135],v13 offset:12288
s_waitcnt lgkmcnt(4)
ds_read_b64_tr_b16 a[8:9],v12 offset:16384
ds_read_b64_tr_b16 a[136:137],v13 offset:16384
ds_read_b64_tr_b16 a[10:11],v12 offset:20480
ds_read_b64_tr_b16 a[138:139],v13 offset:20480
ds_read_b64_tr_b16 a[12:13],v12 offset:24576
ds_read_b64_tr_b16 a[140:141],v13 offset:24576
ds_read_b64_tr_b16 a[14:15],v12 offset:28672
ds_read_b64_tr_b16 a[142:143],v13 offset:28672
s_waitcnt lgkmcnt(4)
ds_read_b64_tr_b16 a[16:17],v12 offset:32768
ds_read_b64_tr_b16 a[144:145],v13 offset:32768
ds_read_b64_tr_b16 a[18:19],v12 offset:36864
ds_read_b64_tr_b16 a[146:147],v13 offset:36864
ds_read_b64_tr_b16 a[20:21],v12 offset:40960
ds_read_b64_tr_b16 a[148:149],v13 offset:40960
ds_read_b64_tr_b16 a[22:23],v12 offset:45056
ds_read_b64_tr_b16 a[150:151],v13 offset:45056
s_waitcnt lgkmcnt(4)
ds_read_b64_tr_b16 a[24:25],v12 offset:49152
ds_read_b64_tr_b16 a[152:153],v13 offset:49152
ds_read_b64_tr_b16 a[26:27],v12 offset:53248
ds_read_b64_tr_b16 a[154:155],v13 offset:53248
ds_read_b64_tr_b16 a[28:29],v12 offset:57344
ds_read_b64_tr_b16 a[156:157],v13 offset:57344
ds_read_b64_tr_b16 a[30:31],v12 offset:61440
ds_read_b64_tr_b16 a[158:159],v13 offset:61440
s_waitcnt lgkmcnt(4)
v_xor_b32 v12,0x10000,v12
v_xor_b32 v13,0x10000,v13
s_waitcnt lgkmcnt(0)
s_barrier
s_add_u32 s64,s74,3670016
s_add_u32 m0,s75,0
s_nop 0
buffer_load_dwordx4 v8,s[32:35],s64 offen  lds
s_add_u32 s64,s74,3698688
s_add_u32 m0,s75,1024
s_nop 0
buffer_load_dwordx4 v9,s[32:35],s64 offen  lds
s_add_u32 s64,s74,3727360
s_add_u32 m0,s75,2048
s_nop 0
buffer_load_dwordx4 v8,s[32:35],s64 offen  lds
s_add_u32 s64,s74,3756032
s_add_u32 m0,s75,3072
s_nop 0
buffer_load_dwordx4 v9,s[32:35],s64 offen  lds
s_add_u32 s64,s74,3784704
s_add_u32 m0,s75,4096
s_nop 0
buffer_load_dwordx4 v8,s[32:35],s64 offen  lds
s_add_u32 s64,s74,3813376
s_add_u32 m0,s75,5120
s_nop 0
buffer_load_dwordx4 v9,s[32:35],s64 offen  lds
s_add_u32 s64,s74,3842048
s_add_u32 m0,s75,6144
s_nop 0
buffer_load_dwordx4 v8,s[32:35],s64 offen  lds
s_add_u32 s64,s74,3870720
s_add_u32 m0,s75,7168
s_nop 0
buffer_load_dwordx4 v9,s[32:35],s64 offen  lds
s_add_u32 s64,s74,3899392
s_add_u32 m0,s75,8192
s_nop 0
buffer_load_dwordx4 v8,s[32:35],s64 offen  lds
s_add_u32 s64,s74,3928064
s_add_u32 m0,s75,9216
s_nop 0
buffer_load_dwordx4 v9,s[32:35],s64 offen  lds
s_add_u32 s64,s74,3956736
s_add_u32 m0,s75,10240
s_nop 0
buffer_load_dwordx4 v8,s[32:35],s64 offen  lds
s_add_u32 s64,s74,3985408
s_add_u32 m0,s75,11264
s_nop 0
buffer_load_dwordx4 v9,s[32:35],s64 offen  lds
s_add_u32 s64,s74,4014080
s_add_u32 m0,s75,12288
s_nop 0
buffer_load_dwordx4 v8,s[32:35],s64 offen  lds
s_add_u32 s64,s74,4042752
s_add_u32 m0,s75,13312
s_nop 0
buffer_load_dwordx4 v9,s[32:35],s64 offen  lds
s_add_u32 s64,s74,4071424
s_add_u32 m0,s75,14336
s_nop 0
buffer_load_dwordx4 v8,s[32:35],s64 offen  lds
s_add_u32 s64,s74,4100096
s_add_u32 m0,s75,15360
s_nop 0
buffer_load_dwordx4 v9,s[32:35],s64 offen  lds
s_waitcnt vmcnt(16)
s_barrier
ds_read_b64_tr_b16 a[32:33],v12 offset:0
ds_read_b64_tr_b16 a[160:161],v13 offset:0
ds_read_b64_tr_b16 a[34:35],v12 offset:4096
ds_read_b64_tr_b16 a[162:163],v13 offset:4096
ds_read_b64_tr_b16 a[36:37],v12 offset:8192
ds_read_b64_tr_b16 a[164:165],v13 offset:8192
ds_read_b64_tr_b16 a[38:39],v12 offset:12288
ds_read_b64_tr_b16 a[166:167],v13 offset:12288
s_waitcnt lgkmcnt(4)
ds_read_b64_tr_b16 a[40:41],v12 offset:16384
ds_read_b64_tr_b16 a[168:169],v13 offset:16384
ds_read_b64_tr_b16 a[42:43],v12 offset:20480
ds_read_b64_tr_b16 a[170:171],v13 offset:20480
ds_read_b64_tr_b16 a[44:45],v12 offset:24576
ds_read_b64_tr_b16 a[172:173],v13 offset:24576
ds_read_b64_tr_b16 a[46:47],v12 offset:28672
ds_read_b64_tr_b16 a[174:175],v13 offset:28672
s_waitcnt lgkmcnt(4)
ds_read_b64_tr_b16 a[48:49],v12 offset:32768
ds_read_b64_tr_b16 a[176:177],v13 offset:32768
ds_read_b64_tr_b16 a[50:51],v12 offset:36864
ds_read_b64_tr_b16 a[178:179],v13 offset:36864
ds_read_b64_tr_b16 a[52:53],v12 offset:40960
ds_read_b64_tr_b16 a[180:181],v13 offset:40960
ds_read_b64_tr_b16 a[54:55],v12 offset:45056
ds_read_b64_tr_b16 a[182:183],v13 offset:45056
s_waitcnt lgkmcnt(4)
ds_read_b64_tr_b16 a[56:57],v12 offset:49152
ds_read_b64_tr_b16 a[184:185],v13 offset:49152
ds_read_b64_tr_b16 a[58:59],v12 offset:53248
ds_read_b64_tr_b16 a[186:187],v13 offset:53248
ds_read_b64_tr_b16 a[60:61],v12 offset:57344
ds_read_b64_tr_b16 a[188:189],v13 offset:57344
ds_read_b64_tr_b16 a[62:63],v12 offset:61440
ds_read_b64_tr_b16 a[190:191],v13 offset:61440
s_waitcnt lgkmcnt(4)
v_xor_b32 v12,0x10000,v12
v_xor_b32 v13,0x10000,v13
s_waitcnt lgkmcnt(0)
s_barrier
s_add_u32 s64,s74,5505024
s_add_u32 m0,s75,65536
s_nop 0
buffer_load_dwordx4 v8,s[32:35],s64 offen  lds
s_add_u32 s64,s74,5533696
s_add_u32 m0,s75,66560
s_nop 0
buffer_load_dwordx4 v9,s[32:35],s64 offen  lds
s_add_u32 s64,s74,5562368
s_add_u32 m0,s75,67584
s_nop 0
buffer_load_dwordx4 v8,s[32:35],s64 offen  lds
s_add_u32 s64,s74,5591040
s_add_u32 m0,s75,68608
s_nop 0
buffer_load_dwordx4 v9,s[32:35],s64 offen  lds
s_add_u32 s64,s74,5619712
s_add_u32 m0,s75,69632
s_nop 0
buffer_load_dwordx4 v8,s[32:35],s64 offen  lds
s_add_u32 s64,s74,5648384
s_add_u32 m0,s75,70656
s_nop 0
buffer_load_dwordx4 v9,s[32:35],s64 offen  lds
s_add_u32 s64,s74,5677056
s_add_u32 m0,s75,71680
s_nop 0
buffer_load_dwordx4 v8,s[32:35],s64 offen  lds
s_add_u32 s64,s74,5705728
s_add_u32 m0,s75,72704
s_nop 0
buffer_load_dwordx4 v9,s[32:35],s64 offen  lds
s_add_u32 s64,s74,5734400
s_add_u32 m0,s75,73728
s_nop 0
buffer_load_dwordx4 v8,s[32:35],s64 offen  lds
s_add_u32 s64,s74,5763072
s_add_u32 m0,s75,74752
s_nop 0
buffer_load_dwordx4 v9,s[32:35],s64 offen  lds
s_add_u32 s64,s74,5791744
s_add_u32 m0,s75,75776
s_nop 0
buffer_load_dwordx4 v8,s[32:35],s64 offen  lds
s_add_u32 s64,s74,5820416
s_add_u32 m0,s75,76800
s_nop 0
buffer_load_dwordx4 v9,s[32:35],s64 offen  lds
s_add_u32 s64,s74,5849088
s_add_u32 m0,s75,77824
s_nop 0
buffer_load_dwordx4 v8,s[32:35],s64 offen  lds
s_add_u32 s64,s74,5877760
s_add_u32 m0,s75,78848
s_nop 0
buffer_load_dwordx4 v9,s[32:35],s64 offen  lds
s_add_u32 s64,s74,5906432
s_add_u32 m0,s75,79872
s_nop 0
buffer_load_dwordx4 v8,s[32:35],s64 offen  lds
s_add_u32 s64,s74,5935104
s_add_u32 m0,s75,80896
s_nop 0
buffer_load_dwordx4 v9,s[32:35],s64 offen  lds
s_waitcnt vmcnt(16)
s_barrier
ds_read_b64_tr_b16 a[64:65],v12 offset:0
ds_read_b64_tr_b16 a[192:193],v13 offset:0
ds_read_b64_tr_b16 a[66:67],v12 offset:4096
ds_read_b64_tr_b16 a[194:195],v13 offset:4096
ds_read_b64_tr_b16 a[68:69],v12 offset:8192
ds_read_b64_tr_b16 a[196:197],v13 offset:8192
ds_read_b64_tr_b16 a[70:71],v12 offset:12288
ds_read_b64_tr_b16 a[198:199],v13 offset:12288
s_waitcnt lgkmcnt(4)
ds_read_b64_tr_b16 a[72:73],v12 offset:16384
ds_read_b64_tr_b16 a[200:201],v13 offset:16384
ds_read_b64_tr_b16 a[74:75],v12 offset:20480
ds_read_b64_tr_b16 a[202:203],v13 offset:20480
ds_read_b64_tr_b16 a[76:77],v12 offset:24576
ds_read_b64_tr_b16 a[204:205],v13 offset:24576
ds_read_b64_tr_b16 a[78:79],v12 offset:28672
ds_read_b64_tr_b16 a[206:207],v13 offset:28672
s_waitcnt lgkmcnt(4)
ds_read_b64_tr_b16 a[80:81],v12 offset:32768
ds_read_b64_tr_b16 a[208:209],v13 offset:32768
ds_read_b64_tr_b16 a[82:83],v12 offset:36864
ds_read_b64_tr_b16 a[210:211],v13 offset:36864
ds_read_b64_tr_b16 a[84:85],v12 offset:40960
ds_read_b64_tr_b16 a[212:213],v13 offset:40960
ds_read_b64_tr_b16 a[86:87],v12 offset:45056
ds_read_b64_tr_b16 a[214:215],v13 offset:45056
s_waitcnt lgkmcnt(4)
ds_read_b64_tr_b16 a[88:89],v12 offset:49152
ds_read_b64_tr_b16 a[216:217],v13 offset:49152
ds_read_b64_tr_b16 a[90:91],v12 offset:53248
ds_read_b64_tr_b16 a[218:219],v13 offset:53248
ds_read_b64_tr_b16 a[92:93],v12 offset:57344
ds_read_b64_tr_b16 a[220:221],v13 offset:57344
ds_read_b64_tr_b16 a[94:95],v12 offset:61440
ds_read_b64_tr_b16 a[222:223],v13 offset:61440
s_waitcnt lgkmcnt(4)
v_xor_b32 v12,0x10000,v12
v_xor_b32 v13,0x10000,v13
s_waitcnt lgkmcnt(0)
s_barrier
s_waitcnt vmcnt(0)
s_barrier
ds_read_b64_tr_b16 a[96:97],v12 offset:0
ds_read_b64_tr_b16 a[224:225],v13 offset:0
ds_read_b64_tr_b16 a[98:99],v12 offset:4096
ds_read_b64_tr_b16 a[226:227],v13 offset:4096
ds_read_b64_tr_b16 a[100:101],v12 offset:8192
ds_read_b64_tr_b16 a[228:229],v13 offset:8192
ds_read_b64_tr_b16 a[102:103],v12 offset:12288
ds_read_b64_tr_b16 a[230:231],v13 offset:12288
s_waitcnt lgkmcnt(4)
ds_read_b64_tr_b16 a[104:105],v12 offset:16384
ds_read_b64_tr_b16 a[232:233],v13 offset:16384
ds_read_b64_tr_b16 a[106:107],v12 offset:20480
ds_read_b64_tr_b16 a[234:235],v13 offset:20480
ds_read_b64_tr_b16 a[108:109],v12 offset:24576
ds_read_b64_tr_b16 a[236:237],v13 offset:24576
ds_read_b64_tr_b16 a[110:111],v12 offset:28672
ds_read_b64_tr_b16 a[238:239],v13 offset:28672
s_waitcnt lgkmcnt(4)
ds_read_b64_tr_b16 a[112:113],v12 offset:32768
ds_read_b64_tr_b16 a[240:241],v13 offset:32768
ds_read_b64_tr_b16 a[114:115],v12 offset:36864
ds_read_b64_tr_b16 a[242:243],v13 offset:36864
ds_read_b64_tr_b16 a[116:117],v12 offset:40960
ds_read_b64_tr_b16 a[244:245],v13 offset:40960
ds_read_b64_tr_b16 a[118:119],v12 offset:45056
ds_read_b64_tr_b16 a[246:247],v13 offset:45056
s_waitcnt lgkmcnt(4)
ds_read_b64_tr_b16 a[120:121],v12 offset:49152
ds_read_b64_tr_b16 a[248:249],v13 offset:49152
ds_read_b64_tr_b16 a[122:123],v12 offset:53248
ds_read_b64_tr_b16 a[250:251],v13 offset:53248
ds_read_b64_tr_b16 a[124:125],v12 offset:57344
ds_read_b64_tr_b16 a[252:253],v13 offset:57344
ds_read_b64_tr_b16 a[126:127],v12 offset:61440
ds_read_b64_tr_b16 a[254:255],v13 offset:61440
s_waitcnt lgkmcnt(4)
v_xor_b32 v12,0x10000,v12
v_xor_b32 v13,0x10000,v13
s_waitcnt lgkmcnt(0)
s_barrier
v_mov_b32 v88,0x3f803f80
v_mov_b32 v89,0x3f803f80
v_mov_b32 v90,0x3f803f80
v_mov_b32 v91,0x3f803f80
s_nop 1
v_mfma_f32_16x16x32_bf16 v[52:55],a[0:3],v[88:91],0
v_mfma_f32_16x16x32_bf16 v[56:59],a[128:131],v[88:91],0
v_mfma_f32_16x16x32_bf16 v[52:55],a[4:7],v[88:91],v[52:55]
v_mfma_f32_16x16x32_bf16 v[56:59],a[132:135],v[88:91],v[56:59]
v_mfma_f32_16x16x32_bf16 v[52:55],a[8:11],v[88:91],v[52:55]
v_mfma_f32_16x16x32_bf16 v[56:59],a[136:139],v[88:91],v[56:59]
v_mfma_f32_16x16x32_bf16 v[52:55],a[12:15],v[88:91],v[52:55]
v_mfma_f32_16x16x32_bf16 v[56:59],a[140:143],v[88:91],v[56:59]
v_mfma_f32_16x16x32_bf16 v[52:55],a[16:19],v[88:91],v[52:55]
v_mfma_f32_16x16x32_bf16 v[56:59],a[144:147],v[88:91],v[56:59]
v_mfma_f32_16x16x32_bf16 v[52:55],a[20:23],v[88:91],v[52:55]
v_mfma_f32_16x16x32_bf16 v[56:59],a[148:151],v[88:91],v[56:59]
v_mfma_f32_16x16x32_bf16 v[52:55],a[24:27],v[88:91],v[52:55]
v_mfma_f32_16x16x32_bf16 v[56:59],a[152:155],v[88:91],v[56:59]
v_mfma_f32_16x16x32_bf16 v[52:55],a[28:31],v[88:91],v[52:55]
v_mfma_f32_16x16x32_bf16 v[56:59],a[156:159],v[88:91],v[56:59]
v_mfma_f32_16x16x32_bf16 v[52:55],a[32:35],v[88:91],v[52:55]
v_mfma_f32_16x16x32_bf16 v[56:59],a[160:163],v[88:91],v[56:59]
v_mfma_f32_16x16x32_bf16 v[52:55],a[36:39],v[88:91],v[52:55]
v_mfma_f32_16x16x32_bf16 v[56:59],a[164:167],v[88:91],v[56:59]
v_mfma_f32_16x16x32_bf16 v[52:55],a[40:43],v[88:91],v[52:55]
v_mfma_f32_16x16x32_bf16 v[56:59],a[168:171],v[88:91],v[56:59]
v_mfma_f32_16x16x32_bf16 v[52:55],a[44:47],v[88:91],v[52:55]
v_mfma_f32_16x16x32_bf16 v[56:59],a[172:175],v[88:91],v[56:59]
v_mfma_f32_16x16x32_bf16 v[52:55],a[48:51],v[88:91],v[52:55]
v_mfma_f32_16x16x32_bf16 v[56:59],a[176:179],v[88:91],v[56:59]
v_mfma_f32_16x16x32_bf16 v[52:55],a[52:55],v[88:91],v[52:55]
v_mfma_f32_16x16x32_bf16 v[56:59],a[180:183],v[88:91],v[56:59]
v_mfma_f32_16x16x32_bf16 v[52:55],a[56:59],v[88:91],v[52:55]
v_mfma_f32_16x16x32_bf16 v[56:59],a[184:187],v[88:91],v[56:59]
v_mfma_f32_16x16x32_bf16 v[52:55],a[60:63],v[88:91],v[52:55]
v_mfma_f32_16x16x32_bf16 v[56:59],a[188:191],v[88:91],v[56:59]
v_mfma_f32_16x16x32_bf16 v[52:55],a[64:67],v[88:91],v[52:55]
v_mfma_f32_16x16x32_bf16 v[56:59],a[192:195],v[88:91],v[56:59]
v_mfma_f32_16x16x32_bf16 v[52:55],a[68:71],v[88:91],v[52:55]
v_mfma_f32_16x16x32_bf16 v[56:59],a[196:199],v[88:91],v[56:59]
v_mfma_f32_16x16x32_bf16 v[52:55],a[72:75],v[88:91],v[52:55]
v_mfma_f32_16x16x32_bf16 v[56:59],a[200:203],v[88:91],v[56:59]
v_mfma_f32_16x16x32_bf16 v[52:55],a[76:79],v[88:91],v[52:55]
v_mfma_f32_16x16x32_bf16 v[56:59],a[204:207],v[88:91],v[56:59]
v_mfma_f32_16x16x32_bf16 v[52:55],a[80:83],v[88:91],v[52:55]
v_mfma_f32_16x16x32_bf16 v[56:59],a[208:211],v[88:91],v[56:59]
v_mfma_f32_16x16x32_bf16 v[52:55],a[84:87],v[88:91],v[52:55]
v_mfma_f32_16x16x32_bf16 v[56:59],a[212:215],v[88:91],v[56:59]
v_mfma_f32_16x16x32_bf16 v[52:55],a[88:91],v[88:91],v[52:55]
v_mfma_f32_16x16x32_bf16 v[56:59],a[216:219],v[88:91],v[56:59]
v_mfma_f32_16x16x32_bf16 v[52:55],a[92:95],v[88:91],v[52:55]
v_mfma_f32_16x16x32_bf16 v[56:59],a[220:223],v[88:91],v[56:59]
v_mfma_f32_16x16x32_bf16 v[52:55],a[96:99],v[88:91],v[52:55]
v_mfma_f32_16x16x32_bf16 v[56:59],a[224:227],v[88:91],v[56:59]
v_mfma_f32_16x16x32_bf16 v[52:55],a[100:103],v[88:91],v[52:55]
v_mfma_f32_16x16x32_bf16 v[56:59],a[228:231],v[88:91],v[56:59]
v_mfma_f32_16x16x32_bf16 v[52:55],a[104:107],v[88:91],v[52:55]
v_mfma_f32_16x16x32_bf16 v[56:59],a[232:235],v[88:91],v[56:59]
v_mfma_f32_16x16x32_bf16 v[52:55],a[108:111],v[88:91],v[52:55]
v_mfma_f32_16x16x32_bf16 v[56:59],a[236:239],v[88:91],v[56:59]
v_mfma_f32_16x16x32_bf16 v[52:55],a[112:115],v[88:91],v[52:55]
v_mfma_f32_16x16x32_bf16 v[56:59],a[240:243],v[88:91],v[56:59]
v_mfma_f32_16x16x32_bf16 v[52:55],a[116:119],v[88:91],v[52:55]
v_mfma_f32_16x16x32_bf16 v[56:59],a[244:247],v[88:91],v[56:59]
v_mfma_f32_16x16x32_bf16 v[52:55],a[120:123],v[88:91],v[52:55]
v_mfma_f32_16x16x32_bf16 v[56:59],a[248:251],v[88:91],v[56:59]
v_mfma_f32_16x16x32_bf16 v[52:55],a[124:127],v[88:91],v[52:55]
v_mfma_f32_16x16x32_bf16 v[56:59],a[252:255],v[88:91],v[56:59]
v_and_b32 v21,1,v1
v_mul_u32_u24 v21,896,v21
s_mov_b32 s65,21052032
s_mov_b32 s66,1792
pl_266:
buffer_load_dword v22,v21,s[20:23],s65 offen sc1
s_waitcnt vmcnt(0)
v_cmp_gt_u32 vcc,s66,v22
s_cbranch_vccz pok_267
s_sleep 1
s_sub_u32 s90,s90,1
s_cmp_gt_i32 s90,0
s_cbranch_scc1 pl_266
pok_267:
s_mov_b32 s81,0xbdd2d3e8
v_mov_b32 v28,0xc0135761
s_lshr_b32 s41,s59,3
s_and_b32 s42,s59,7
s_mul_i32 s64,s42,3
s_add_u32 s64,s64,s50
s_lshr_b32 s65,s42,1
s_add_u32 s65,s65,24
s_cmp_eq_u32 s50,3
s_cselect_b32 s64,s65,s64
s_and_b32 s65,s42,1
s_lshl_b32 s65,s65,3
s_cmp_eq_u32 s50,3
s_cselect_b32 s65,s65,0
s_and_b32 s66,s64,3
s_lshl_b32 s66,s66,11
s_add_u32 s65,s65,s66
s_lshr_b32 s64,s64,2
s_mul_i32 s66,s41,7
s_add_u32 s64,s64,s66
s_add_u32 s64,s64,81
s_lshl_b32 s64,s64,14
s_add_u32 s64,s64,s65
v_add_u32 v18,s64,v16
v_mov_b32 v17,v16
v_lshlrev_b32 v19,4,v3
v_add_u32 v19,131072,v19
v_and_b32 v21,31,v1
v_lshlrev_b32 v21,2,v21
s_add_u32 s74,s63,3584
s_lshl_b32 s64,s41,7
s_lshl_b32 s73,s42,4
s_add_u32 s73,s73,s64
s_lshl_b32 s64,s50,2
s_add_u32 s73,s73,s64
s_add_u32 s73,s73,s63
s_add_u32 s73,s73,4096
s_mov_b32 s82,0x3a800000
s_mov_b32 s64,0
s_lshr_b32 s65,s50,1
s_and_b32 s66,s50,1
s_lshl_b32 s66,s66,12
s_add_u32 s66,s66,s64
s_lshl_b32 s72,s65,13
s_add_u32 s72,s72,s66
s_add_u32 s72,s72,0x10000
s_lshl_b32 s65,s65,14
s_add_u32 s75,s65,s66
s_add_u32 s75,s75,1179648
s_cmp_eq_u32 s50,3
s_cbranch_scc1 w3b_268
s_add_u32 s64,s79,0
s_lshl_b32 s70,s64,21
s_lshl_b32 s64,s64,13
s_and_b32 s64,s64,0x2000
s_xor_b32 s64,s64,s62
s_add_u32 s70,s70,s64
s_add_u32 s70,s70,29360128
s_mov_b32 s83,1
s_mov_b32 s87,s74
s_cmp_eq_u32 s50,0
s_cselect_b32 s74,s74,0x7fff0000
v_mov_b32 v45,132096
s_lshl_b32 s64,s50,2
s_add_u32 s64,s64,132112
v_mov_b32 v46,s64
v_mov_b32 v2,0
v_mov_b32 v44,1
ds_write_b32 v45,v44
s_waitcnt lgkmcnt(0)
seg_270:
s_cmp_eq_u32 s83,0
s_cbranch_scc1 ahead_271
s_add_u32 s94,s70,s75
s_xor_b32 s95,s94,1024
s_xor_b32 s91,s72,0x10000
s_waitcnt lgkmcnt(0)
v_cmp_gt_u32 vcc,s71,v2
s_cbranch_vccz nb_274
s_waitcnt vmcnt(2)
v_cmp_gt_u32 vcc,s71,v29
s_cbranch_vccz nb_274
s_waitcnt vmcnt(0)
v_add_u32 v22,s71,-1
buffer_store_dword v22,v23,s[20:23],s73 offen sc1
s_cmp_lg_u32 s50,0
s_cbranch_scc1 nb_274
buffer_load_dword v32,v21,s[20:23],s74 offen sc1
s_sleep 2
pl_275:
buffer_load_dword v33,v21,s[20:23],s74 offen sc1
s_waitcnt vmcnt(1)
v_cmp_gt_u32 vcc,s71,v32
s_cbranch_vccz pok_276
buffer_load_dword v32,v21,s[20:23],s74 offen sc1
s_waitcnt vmcnt(1)
v_cmp_gt_u32 vcc,s71,v33
s_cbranch_vccz pok_276
s_sub_u32 s90,s90,1
s_cmp_gt_i32 s90,0
s_cbranch_scc1 pl_275
pok_276:
nb_274:
s_barrier
s_xor_b32 m0,s91,0
s_add_u32 s65,s94,0
buffer_load_dwordx4 v16,s[20:23],s65 offen offset:0 sc1 lds
buffer_load_dwordx4 v16,s[20:23],s65 offen offset:2048 sc1 lds
ds_read_b32 v44,v45
s_xor_b32 m0,s91,16384
s_add_u32 s65,s94,32768
buffer_load_dwordx4 v16,s[20:23],s65 offen offset:0 sc1 lds
buffer_load_dwordx4 v16,s[20:23],s65 offen offset:2048 sc1 lds
s_xor_b32 m0,s91,32768
s_add_u32 s65,s94,65536
buffer_load_dwordx4 v16,s[20:23],s65 offen offset:0 sc1 lds
buffer_load_dwordx4 v16,s[20:23],s65 offen offset:2048 sc1 lds
s_xor_b32 m0,s91,49152
s_add_u32 s65,s94,98304
buffer_load_dwordx4 v16,s[20:23],s65 offen offset:0 sc1 lds
buffer_load_dwordx4 v16,s[20:23],s65 offen offset:2048 sc1 lds
s_xor_b32 m0,s91,1024
s_add_u32 s65,s95,0
buffer_load_dwordx4 v16,s[20:23],s65 offen offset:0 sc1 lds
buffer_load_dwordx4 v16,s[20:23],s65 offen offset:2048 sc1 lds
s_waitcnt lgkmcnt(0)
v_readfirstlane_b32 s83,v44
s_cmp_eq_u32 s83,0
s_cbranch_scc1 both_273
s_waitcnt vmcnt(8)
s_barrier
ds_read_b128 v[224:227],v17 offset:0
ds_read_b128 v[228:231],v17 offset:2048
ds_read_b128 v[232:235],v17 offset:4096
ds_read_b128 v[236:239],v17 offset:6144
ds_read_b128 v[240:243],v17 offset:8192
ds_read_b128 v[244:247],v17 offset:10240
ds_read_b128 v[248:251],v17 offset:12288
s_waitcnt lgkmcnt(5)
v_mfma_f32_16x16x32_bf16 v[64:67],a[0:3],v[224:227],0
v_min_u32 v27,v224,v228
s_xor_b32 m0,s91,17408
v_mfma_f32_16x16x32_bf16 v[72:75],a[128:131],v[224:227],0
ds_read_b128 v[252:255],v17 offset:14336
v_mfma_f32_16x16x32_bf16 v[64:67],a[4:7],v[228:231],v[64:67]
s_add_u32 s65,s95,32768
v_mfma_f32_16x16x32_bf16 v[72:75],a[132:135],v[228:231],v[72:75]
s_waitcnt vmcnt(6)
s_barrier
ds_read_b128 v[224:227],v17 offset:16384
s_waitcnt lgkmcnt(5)
v_mfma_f32_16x16x32_bf16 v[64:67],a[8:11],v[232:235],v[64:67]
v_min3_u32 v27,v27,v232,v236
buffer_load_dwordx4 v16,s[20:23],s65 offen offset:0 sc1 lds
v_mfma_f32_16x16x32_bf16 v[72:75],a[136:139],v[232:235],v[72:75]
ds_read_b128 v[228:231],v17 offset:18432
v_mfma_f32_16x16x32_bf16 v[64:67],a[12:15],v[236:239],v[64:67]
buffer_load_dwordx4 v16,s[20:23],s65 offen offset:2048 sc1 lds
v_mfma_f32_16x16x32_bf16 v[72:75],a[140:143],v[236:239],v[72:75]
ds_read_b128 v[232:235],v17 offset:20480
s_waitcnt lgkmcnt(5)
v_mfma_f32_16x16x32_bf16 v[64:67],a[16:19],v[240:243],v[64:67]
v_min3_u32 v27,v27,v240,v244
s_xor_b32 m0,s91,33792
v_mfma_f32_16x16x32_bf16 v[72:75],a[144:147],v[240:243],v[72:75]
ds_read_b128 v[236:239],v17 offset:22528
v_mfma_f32_16x16x32_bf16 v[64:67],a[20:23],v[244:247],v[64:67]
s_add_u32 s65,s95,65536
v_mfma_f32_16x16x32_bf16 v[72:75],a[148:151],v[244:247],v[72:75]
ds_read_b128 v[240:243],v17 offset:24576
s_waitcnt lgkmcnt(5)
v_mfma_f32_16x16x32_bf16 v[64:67],a[24:27],v[248:251],v[64:67]
v_min3_u32 v27,v27,v248,v252
buffer_load_dwordx4 v16,s[20:23],s65 offen offset:0 sc1 lds
v_mfma_f32_16x16x32_bf16 v[72:75],a[152:155],v[248:251],v[72:75]
ds_read_b128 v[244:247],v17 offset:26624
v_mfma_f32_16x16x32_bf16 v[64:67],a[28:31],v[252:255],v[64:67]
buffer_load_dwordx4 v16,s[20:23],s65 offen offset:2048 sc1 lds
v_mfma_f32_16x16x32_bf16 v[72:75],a[156:159],v[252:255],v[72:75]
ds_read_b128 v[248:251],v17 offset:28672
s_waitcnt lgkmcnt(5)
v_mfma_f32_16x16x32_bf16 v[64:67],a[32:35],v[224:227],v[64:67]
v_min3_u32 v27,v27,v224,v228
s_xor_b32 m0,s91,50176
v_mfma_f32_16x16x32_bf16 v[72:75],a[160:163],v[224:227],v[72:75]
ds_read_b128 v[252:255],v17 offset:30720
v_mfma_f32_16x16x32_bf16 v[64:67],a[36:39],v[228:231],v[64:67]
s_add_u32 s65,s95,98304
v_mfma_f32_16x16x32_bf16 v[72:75],a[164:167],v[228:231],v[72:75]
s_waitcnt vmcnt(6)
s_barrier
ds_read_b128 v[224:227],v17 offset:32768
s_waitcnt lgkmcnt(5)
v_mfma_f32_16x16x32_bf16 v[64:67],a[40:43],v[232:235],v[64:67]
v_min3_u32 v27,v27,v232,v236
buffer_load_dwordx4 v16,s[20:23],s65 offen offset:0 sc1 lds
v_mfma_f32_16x16x32_bf16 v[72:75],a[168:171],v[232:235],v[72:75]
ds_read_b128 v[228:231],v17 offset:34816
v_mfma_f32_16x16x32_bf16 v[64:67],a[44:47],v[236:239],v[64:67]
buffer_load_dwordx4 v16,s[20:23],s65 offen offset:2048 sc1 lds
v_mfma_f32_16x16x32_bf16 v[72:75],a[172:175],v[236:239],v[72:75]
ds_read_b128 v[232:235],v17 offset:36864
s_waitcnt lgkmcnt(5)
v_mfma_f32_16x16x32_bf16 v[64:67],a[48:51],v[240:243],v[64:67]
v_min3_u32 v27,v27,v240,v244
v_mfma_f32_16x16x32_bf16 v[72:75],a[176:179],v[240:243],v[72:75]
ds_read_b128 v[236:239],v17 offset:38912
v_mfma_f32_16x16x32_bf16 v[64:67],a[52:55],v[244:247],v[64:67]
v_add_u32 v22,s71,-1
v_mfma_f32_16x16x32_bf16 v[72:75],a[180:183],v[244:247],v[72:75]
ds_read_b128 v[240:243],v17 offset:40960
s_waitcnt lgkmcnt(5)
v_mfma_f32_16x16x32_bf16 v[64:67],a[56:59],v[248:251],v[64:67]
v_min3_u32 v27,v27,v248,v252
v_mfma_f32_16x16x32_bf16 v[72:75],a[184:187],v[248:251],v[72:75]
ds_read_b128 v[244:247],v17 offset:43008
v_mfma_f32_16x16x32_bf16 v[64:67],a[60:63],v[252:255],v[64:67]
buffer_store_dword v22,v23,s[20:23],s73 offen sc1
v_mfma_f32_16x16x32_bf16 v[72:75],a[188:191],v[252:255],v[72:75]
ds_read_b128 v[248:251],v17 offset:45056
s_waitcnt lgkmcnt(5)
v_mfma_f32_16x16x32_bf16 v[64:67],a[64:67],v[224:227],v[64:67]
v_min3_u32 v27,v27,v224,v228
v_mfma_f32_16x16x32_bf16 v[72:75],a[192:195],v[224:227],v[72:75]
ds_read_b128 v[252:255],v17 offset:47104
v_mfma_f32_16x16x32_bf16 v[64:67],a[68:71],v[228:231],v[64:67]
v_mfma_f32_16x16x32_bf16 v[72:75],a[196:199],v[228:231],v[72:75]
ds_read_b128 v[224:227],v17 offset:49152
s_waitcnt lgkmcnt(5)
v_mfma_f32_16x16x32_bf16 v[64:67],a[72:75],v[232:235],v[64:67]
v_min3_u32 v27,v27,v232,v236
v_mfma_f32_16x16x32_bf16 v[72:75],a[200:203],v[232:235],v[72:75]
ds_read_b128 v[228:231],v17 offset:51200
v_mfma_f32_16x16x32_bf16 v[64:67],a[76:79],v[236:239],v[64:67]
v_mfma_f32_16x16x32_bf16 v[72:75],a[204:207],v[236:239],v[72:75]
ds_read_b128 v[232:235],v17 offset:53248
s_waitcnt lgkmcnt(5)
v_mfma_f32_16x16x32_bf16 v[64:67],a[80:83],v[240:243],v[64:67]
v_min3_u32 v27,v27,v240,v244
v_mfma_f32_16x16x32_bf16 v[72:75],a[208:211],v[240:243],v[72:75]
ds_read_b128 v[236:239],v17 offset:55296
v_mfma_f32_16x16x32_bf16 v[64:67],a[84:87],v[244:247],v[64:67]
v_mfma_f32_16x16x32_bf16 v[72:75],a[212:215],v[244:247],v[72:75]
ds_read_b128 v[240:243],v17 offset:57344
s_waitcnt lgkmcnt(5)
v_mfma_f32_16x16x32_bf16 v[64:67],a[88:91],v[248:251],v[64:67]
v_min3_u32 v27,v27,v248,v252
v_mfma_f32_16x16x32_bf16 v[72:75],a[216:219],v[248:251],v[72:75]
ds_read_b128 v[244:247],v17 offset:59392
v_mfma_f32_16x16x32_bf16 v[64:67],a[92:95],v[252:255],v[64:67]
v_mfma_f32_16x16x32_bf16 v[72:75],a[220:223],v[252:255],v[72:75]
ds_read_b128 v[248:251],v17 offset:61440
s_waitcnt lgkmcnt(5)
v_mfma_f32_16x16x32_bf16 v[64:67],a[96:99],v[224:227],v[64:67]
v_min3_u32 v27,v27,v224,v228
v_mfma_f32_16x16x32_bf16 v[72:75],a[224:227],v[224:227],v[72:75]
ds_read_b128 v[252:255],v17 offset:63488
v_mfma_f32_16x16x32_bf16 v[64:67],a[100:103],v[228:231],v[64:67]
v_mfma_f32_16x16x32_bf16 v[72:75],a[228:231],v[228:231],v[72:75]
s_waitcnt vmcnt(1)
s_barrier
ds_read_b128 v[224:227],v17 offset:1024
s_waitcnt lgkmcnt(5)
v_mfma_f32_16x16x32_bf16 v[64:67],a[104:107],v[232:235],v[64:67]
v_min3_u32 v27,v27,v232,v236
s_add_u32 s92,s70,8388608
v_mfma_f32_16x16x32_bf16 v[72:75],a[232:235],v[232:235],v[72:75]
ds_read_b128 v[228:231],v17 offset:3072
s_sub_u32 s93,s71,53
v_mfma_f32_16x16x32_bf16 v[64:67],a[108:111],v[236:239],v[64:67]
s_cmp_lt_u32 s93,9
s_cselect_b32 s92,s92,0x7fff0000
v_mfma_f32_16x16x32_bf16 v[72:75],a[236:239],v[236:239],v[72:75]
ds_read_b128 v[232:235],v17 offset:5120
s_waitcnt lgkmcnt(5)
v_mfma_f32_16x16x32_bf16 v[64:67],a[112:115],v[240:243],v[64:67]
v_min3_u32 v27,v27,v240,v244
ds_read_b128 v[124:127],v19 offset:256
v_mfma_f32_16x16x32_bf16 v[72:75],a[240:243],v[240:243],v[72:75]
ds_read_b128 v[236:239],v17 offset:7168
ds_read_b128 v[120:123],v19 offset:0
v_mfma_f32_16x16x32_bf16 v[64:67],a[116:119],v[244:247],v[64:67]
v_mfma_f32_16x16x32_bf16 v[72:75],a[244:247],v[244:247],v[72:75]
ds_read_b128 v[240:243],v17 offset:9216
s_waitcnt lgkmcnt(7)
v_mfma_f32_16x16x32_bf16 v[64:67],a[120:123],v[248:251],v[64:67]
v_min3_u32 v27,v27,v248,v252
v_mfma_f32_16x16x32_bf16 v[72:75],a[248:251],v[248:251],v[72:75]
ds_read_b128 v[244:247],v17 offset:11264
v_mfma_f32_16x16x32_bf16 v[64:67],a[124:127],v[252:255],v[64:67]
buffer_load_dword v2,v21,s[20:23],s87 offen sc1
s_add_u32 s96,s71,2
v_mfma_f32_16x16x32_bf16 v[72:75],a[252:255],v[252:255],v[72:75]
ds_read_b128 v[248:251],v17 offset:13312
s_waitcnt lgkmcnt(7)
v_mfma_f32_16x16x32_bf16 v[68:71],a[0:3],v[224:227],0
v_cmp_eq_u32 vcc,0,v27
s_cbranch_vccnz retry_269
v_mfma_f32_16x16x32_bf16 v[76:79],a[128:131],v[224:227],0
ds_read_b128 v[252:255],v17 offset:15360
v_min3_u32 v27,v27,v224,v228
s_waitcnt lgkmcnt(4)
v_mfma_f32_16x16x32_bf16 v[68:71],a[4:7],v[228:231],v[68:71]
s_cmp_gt_u32 s96,56
s_addc_u32 s96,s96,0
v_mfma_f32_16x16x32_bf16 v[76:79],a[132:135],v[228:231],v[76:79]
ds_read_b128 v[224:227],v17 offset:17408
v_mfma_f32_16x16x32_bf16 v[68:71],a[8:11],v[232:235],v[68:71]
v_min3_u32 v27,v27,v232,v236
v_fmac_f32 v64,v52,v120
v_fmac_f32 v65,v53,v120
v_mfma_f32_16x16x32_bf16 v[76:79],a[136:139],v[232:235],v[76:79]
ds_read_b128 v[228:231],v17 offset:19456
v_fmac_f32 v66,v54,v120
v_fmac_f32 v67,v55,v120
v_mfma_f32_16x16x32_bf16 v[68:71],a[12:15],v[236:239],v[68:71]
buffer_store_dwordx4 v[48:51],v18,s[20:23],s92 offen offset:0 sc1
v_mul_f32 v88,v64,v64
v_mfma_f32_16x16x32_bf16 v[76:79],a[140:143],v[236:239],v[76:79]
ds_read_b128 v[232:235],v17 offset:21504
v_mul_f32 v89,v65,v65
s_waitcnt lgkmcnt(5)
v_mfma_f32_16x16x32_bf16 v[68:71],a[16:19],v[240:243],v[68:71]
v_min3_u32 v27,v27,v240,v244
v_mul_f32 v90,v66,v66
v_mul_f32 v91,v67,v67
v_mfma_f32_16x16x32_bf16 v[76:79],a[144:147],v[240:243],v[76:79]
ds_read_b128 v[236:239],v17 offset:23552
v_fma_f32 v88,v88,v121,v122
v_fma_f32 v89,v89,v121,v122
v_mfma_f32_16x16x32_bf16 v[68:71],a[20:23],v[244:247],v[68:71]
buffer_store_dwordx4 v[48:51],v18,s[20:23],s92 offen offset:1024 sc1
v_fmac_f32 v72,v56,v120
v_mfma_f32_16x16x32_bf16 v[76:79],a[148:151],v[244:247],v[76:79]
ds_read_b128 v[240:243],v17 offset:25600
v_fmac_f32 v73,v57,v120
s_waitcnt lgkmcnt(5)
v_mfma_f32_16x16x32_bf16 v[68:71],a[24:27],v[248:251],v[68:71]
v_min3_u32 v27,v27,v248,v252
v_fma_f32 v90,v90,v121,v122
v_fmac_f32 v74,v58,v120
v_mfma_f32_16x16x32_bf16 v[76:79],a[152:155],v[248:251],v[76:79]
ds_read_b128 v[244:247],v17 offset:27648
v_fma_f32 v91,v91,v121,v122
v_fmac_f32 v75,v59,v120
v_mfma_f32_16x16x32_bf16 v[68:71],a[28:31],v[252:255],v[68:71]
v_mul_f32 v88,v88,v64
v_mul_f32 v89,v89,v65
v_mul_f32 v92,v72,v72
v_mfma_f32_16x16x32_bf16 v[76:79],a[156:159],v[252:255],v[76:79]
ds_read_b128 v[248:251],v17 offset:29696
v_mul_f32 v93,v73,v73
s_waitcnt lgkmcnt(5)
v_mfma_f32_16x16x32_bf16 v[68:71],a[32:35],v[224:227],v[68:71]
v_min3_u32 v27,v27,v224,v228
v_mul_f32 v90,v90,v66
v_mul_f32 v94,v74,v74
v_mfma_f32_16x16x32_bf16 v[76:79],a[160:163],v[224:227],v[76:79]
ds_read_b128 v[252:255],v17 offset:31744
v_mul_f32 v91,v91,v67
v_mul_f32 v95,v75,v75
v_mfma_f32_16x16x32_bf16 v[68:71],a[36:39],v[228:231],v[68:71]
v_exp_f32 v88,v88
v_fma_f32 v92,v92,v121,v122
v_mfma_f32_16x16x32_bf16 v[76:79],a[164:167],v[228:231],v[76:79]
ds_read_b128 v[224:227],v17 offset:33792
v_fma_f32 v93,v93,v121,v122
s_waitcnt lgkmcnt(5)
v_mfma_f32_16x16x32_bf16 v[68:71],a[40:43],v[232:235],v[68:71]
v_min3_u32 v27,v27,v232,v236
v_fma_f32 v94,v94,v121,v122
v_fma_f32 v95,v95,v121,v122
v_mfma_f32_16x16x32_bf16 v[76:79],a[168:171],v[232:235],v[76:79]
ds_read_b128 v[228:231],v17 offset:35840
v_mul_f32 v92,v92,v72
v_mul_f32 v93,v93,v73
v_mfma_f32_16x16x32_bf16 v[68:71],a[44:47],v[236:239],v[68:71]
v_exp_f32 v89,v89
v_mul_f32 v94,v94,v74
v_mfma_f32_16x16x32_bf16 v[76:79],a[172:175],v[236:239],v[76:79]
ds_read_b128 v[232:235],v17 offset:37888
v_mul_f32 v95,v95,v75
s_waitcnt lgkmcnt(5)
v_mfma_f32_16x16x32_bf16 v[68:71],a[48:51],v[240:243],v[68:71]
v_min3_u32 v27,v27,v240,v244
v_exp_f32 v92,v92
v_mfma_f32_16x16x32_bf16 v[76:79],a[176:179],v[240:243],v[76:79]
ds_read_b128 v[236:239],v17 offset:39936
v_exp_f32 v93,v93
v_mfma_f32_16x16x32_bf16 v[68:71],a[52:55],v[244:247],v[68:71]
v_exp_f32 v90,v90
v_mfma_f32_16x16x32_bf16 v[76:79],a[180:183],v[244:247],v[76:79]
ds_read_b128 v[240:243],v17 offset:41984
s_waitcnt lgkmcnt(5)
v_mfma_f32_16x16x32_bf16 v[68:71],a[56:59],v[248:251],v[68:71]
v_min3_u32 v27,v27,v248,v252
v_exp_f32 v94,v94
v_mfma_f32_16x16x32_bf16 v[76:79],a[184:187],v[248:251],v[76:79]
ds_read_b128 v[244:247],v17 offset:44032
v_exp_f32 v95,v95
v_mfma_f32_16x16x32_bf16 v[68:71],a[60:63],v[252:255],v[68:71]
v_exp_f32 v91,v91
v_fma_f32 v92,v92,v123,v123
v_mfma_f32_16x16x32_bf16 v[76:79],a[188:191],v[252:255],v[76:79]
ds_read_b128 v[248:251],v17 offset:46080
v_fma_f32 v93,v93,v123,v123
s_waitcnt lgkmcnt(5)
v_mfma_f32_16x16x32_bf16 v[68:71],a[64:67],v[224:227],v[68:71]
v_min3_u32 v27,v27,v224,v228
v_fma_f32 v88,v88,v123,v123
v_fma_f32 v94,v94,v123,v123
v_mfma_f32_16x16x32_bf16 v[76:79],a[192:195],v[224:227],v[76:79]
ds_read_b128 v[252:255],v17 offset:48128
v_fma_f32 v89,v89,v123,v123
v_fma_f32 v95,v95,v123,v123
v_mfma_f32_16x16x32_bf16 v[68:71],a[68:71],v[228:231],v[68:71]
v_fma_f32 v90,v90,v123,v123
v_fma_f32 v91,v91,v123,v123
v_mfma_f32_16x16x32_bf16 v[76:79],a[196:199],v[228:231],v[76:79]
ds_read_b128 v[224:227],v17 offset:50176
s_waitcnt lgkmcnt(5)
v_mfma_f32_16x16x32_bf16 v[68:71],a[72:75],v[232:235],v[68:71]
v_min3_u32 v27,v27,v232,v236
v_rcp_f32 v92,v92
v_mfma_f32_16x16x32_bf16 v[76:79],a[200:203],v[232:235],v[76:79]
ds_read_b128 v[228:231],v17 offset:52224
v_rcp_f32 v93,v93
v_mfma_f32_16x16x32_bf16 v[68:71],a[76:79],v[236:239],v[68:71]
v_rcp_f32 v88,v88
v_mfma_f32_16x16x32_bf16 v[76:79],a[204:207],v[236:239],v[76:79]
ds_read_b128 v[232:235],v17 offset:54272
s_waitcnt lgkmcnt(5)
v_mfma_f32_16x16x32_bf16 v[68:71],a[80:83],v[240:243],v[68:71]
v_min3_u32 v27,v27,v240,v244
v_rcp_f32 v94,v94
v_mfma_f32_16x16x32_bf16 v[76:79],a[208:211],v[240:243],v[76:79]
ds_read_b128 v[236:239],v17 offset:56320
v_rcp_f32 v95,v95
v_mfma_f32_16x16x32_bf16 v[68:71],a[84:87],v[244:247],v[68:71]
v_rcp_f32 v89,v89
v_mfma_f32_16x16x32_bf16 v[76:79],a[212:215],v[244:247],v[76:79]
ds_read_b128 v[240:243],v17 offset:58368
s_waitcnt lgkmcnt(5)
v_mfma_f32_16x16x32_bf16 v[68:71],a[88:91],v[248:251],v[68:71]
v_min3_u32 v27,v27,v248,v252
v_mul_f32 v92,v92,v72
v_mfma_f32_16x16x32_bf16 v[76:79],a[216:219],v[248:251],v[76:79]
ds_read_b128 v[244:247],v17 offset:60416
v_mul_f32 v93,v93,v73
v_mfma_f32_16x16x32_bf16 v[68:71],a[92:95],v[252:255],v[68:71]
v_rcp_f32 v90,v90
v_mfma_f32_16x16x32_bf16 v[76:79],a[220:223],v[252:255],v[76:79]
ds_read_b128 v[248:251],v17 offset:62464
s_waitcnt lgkmcnt(5)
v_mfma_f32_16x16x32_bf16 v[68:71],a[96:99],v[224:227],v[68:71]
v_min3_u32 v27,v27,v224,v228
v_mul_f32 v94,v94,v74
v_mfma_f32_16x16x32_bf16 v[76:79],a[224:227],v[224:227],v[76:79]
ds_read_b128 v[252:255],v17 offset:64512
v_mul_f32 v95,v95,v75
v_mfma_f32_16x16x32_bf16 v[68:71],a[100:103],v[228:231],v[68:71]
v_rcp_f32 v91,v91
v_mfma_f32_16x16x32_bf16 v[76:79],a[228:231],v[228:231],v[76:79]
v_mul_f32 v88,v88,v64
s_waitcnt lgkmcnt(4)
v_mfma_f32_16x16x32_bf16 v[68:71],a[104:107],v[232:235],v[68:71]
v_min3_u32 v27,v27,v232,v236
s_waitcnt vmcnt(2)
v_mfma_f32_16x16x32_bf16 v[76:79],a[232:235],v[232:235],v[76:79]
v_cmp_gt_u32 vcc,s96,v2
s_mov_b32 s96,vcc_lo
v_mfma_f32_16x16x32_bf16 v[68:71],a[108:111],v[236:239],v[68:71]
v_mov_b32 v44,s96
ds_write_b32 v46,v44
v_mfma_f32_16x16x32_bf16 v[76:79],a[236:239],v[236:239],v[76:79]
v_mul_f32 v89,v89,v65
s_waitcnt lgkmcnt(3)
v_mfma_f32_16x16x32_bf16 v[68:71],a[112:115],v[240:243],v[68:71]
v_min3_u32 v27,v27,v240,v244
v_mul_f32 v90,v90,v66
v_mfma_f32_16x16x32_bf16 v[76:79],a[240:243],v[240:243],v[76:79]
v_mul_f32 v91,v91,v67
v_cvt_pk_bf16_f32 v96,v88,v89
v_mfma_f32_16x16x32_bf16 v[68:71],a[116:119],v[244:247],v[68:71]
v_cvt_pk_bf16_f32 v97,v90,v91
v_cvt_pk_bf16_f32 v98,v92,v93
v_mfma_f32_16x16x32_bf16 v[76:79],a[244:247],v[244:247],v[76:79]
v_cvt_pk_bf16_f32 v99,v94,v95
s_waitcnt lgkmcnt(1)
v_mfma_f32_16x16x32_bf16 v[68:71],a[120:123],v[248:251],v[68:71]
v_min3_u32 v27,v27,v248,v252
v_max_u32 v96,1,v96
v_mfma_f32_16x16x32_bf16 v[76:79],a[248:251],v[248:251],v[76:79]
buffer_store_dwordx4 v[96:99],v18,s[20:23],s70 offen offset:0 sc1
v_mfma_f32_16x16x32_bf16 v[68:71],a[124:127],v[252:255],v[68:71]
v_mfma_f32_16x16x32_bf16 v[76:79],a[252:255],v[252:255],v[76:79]
v_cmp_eq_u32 vcc,0,v27
s_cbranch_vccnz retry_269
s_branch epi_272
both_273:
s_waitcnt vmcnt(8)
s_barrier
ds_read_b128 v[224:227],v17 offset:0
ds_read_b128 v[228:231],v17 offset:2048
ds_read_b128 v[232:235],v17 offset:4096
ds_read_b128 v[236:239],v17 offset:6144
ds_read_b128 v[240:243],v17 offset:8192
ds_read_b128 v[244:247],v17 offset:10240
ds_read_b128 v[248:251],v17 offset:12288
s_waitcnt lgkmcnt(5)
v_mfma_f32_16x16x32_bf16 v[64:67],a[0:3],v[224:227],0
v_min_u32 v27,v224,v228
s_xor_b32 m0,s91,17408
v_mfma_f32_16x16x32_bf16 v[72:75],a[128:131],v[224:227],0
ds_read_b128 v[252:255],v17 offset:14336
s_add_u32 s88,s70,s75
v_mfma_f32_16x16x32_bf16 v[64:67],a[4:7],v[228:231],v[64:67]
s_add_u32 s65,s95,32768
s_add_u32 s88,s88,2097152
v_mfma_f32_16x16x32_bf16 v[72:75],a[132:135],v[228:231],v[72:75]
s_waitcnt vmcnt(6)
s_barrier
ds_read_b128 v[224:227],v17 offset:16384
s_waitcnt lgkmcnt(5)
v_mfma_f32_16x16x32_bf16 v[64:67],a[8:11],v[232:235],v[64:67]
v_min3_u32 v27,v27,v232,v236
buffer_load_dwordx4 v16,s[20:23],s65 offen offset:0 sc1 lds
v_mfma_f32_16x16x32_bf16 v[72:75],a[136:139],v[232:235],v[72:75]
ds_read_b128 v[228:231],v17 offset:18432
s_xor_b32 s88,s88,0x2000
v_mfma_f32_16x16x32_bf16 v[64:67],a[12:15],v[236:239],v[64:67]
buffer_load_dwordx4 v16,s[20:23],s65 offen offset:2048 sc1 lds
v_mfma_f32_16x16x32_bf16 v[72:75],a[140:143],v[236:239],v[72:75]
ds_read_b128 v[232:235],v17 offset:20480
s_waitcnt lgkmcnt(5)
v_mfma_f32_16x16x32_bf16 v[64:67],a[16:19],v[240:243],v[64:67]
v_min3_u32 v27,v27,v240,v244
s_xor_b32 m0,s91,33792
v_mfma_f32_16x16x32_bf16 v[72:75],a[144:147],v[240:243],v[72:75]
ds_read_b128 v[236:239],v17 offset:22528
s_xor_b32 s89,s88,1024
v_mfma_f32_16x16x32_bf16 v[64:67],a[20:23],v[244:247],v[64:67]
s_add_u32 s65,s95,65536
v_mfma_f32_16x16x32_bf16 v[72:75],a[148:151],v[244:247],v[72:75]
ds_read_b128 v[240:243],v17 offset:24576
s_waitcnt lgkmcnt(5)
v_mfma_f32_16x16x32_bf16 v[64:67],a[24:27],v[248:251],v[64:67]
v_min3_u32 v27,v27,v248,v252
buffer_load_dwordx4 v16,s[20:23],s65 offen offset:0 sc1 lds
v_mfma_f32_16x16x32_bf16 v[72:75],a[152:155],v[248:251],v[72:75]
ds_read_b128 v[244:247],v17 offset:26624
v_mfma_f32_16x16x32_bf16 v[64:67],a[28:31],v[252:255],v[64:67]
buffer_load_dwordx4 v16,s[20:23],s65 offen offset:2048 sc1 lds
v_mfma_f32_16x16x32_bf16 v[72:75],a[156:159],v[252:255],v[72:75]
ds_read_b128 v[248:251],v17 offset:28672
s_waitcnt lgkmcnt(5)
v_mfma_f32_16x16x32_bf16 v[64:67],a[32:35],v[224:227],v[64:67]
v_min3_u32 v27,v27,v224,v228
s_xor_b32 m0,s91,50176
v_mfma_f32_16x16x32_bf16 v[72:75],a[160:163],v[224:227],v[72:75]
ds_read_b128 v[252:255],v17 offset:30720
v_mfma_f32_16x16x32_bf16 v[64:67],a[36:39],v[228:231],v[64:67]
s_add_u32 s65,s95,98304
v_mfma_f32_16x16x32_bf16 v[72:75],a[164:167],v[228:231],v[72:75]
s_waitcnt vmcnt(6)
s_barrier
ds_read_b128 v[224:227],v17 offset:32768
s_waitcnt lgkmcnt(5)
v_mfma_f32_16x16x32_bf16 v[64:67],a[40:43],v[232:235],v[64:67]
v_min3_u32 v27,v27,v232,v236
buffer_load_dwordx4 v16,s[20:23],s65 offen offset:0 sc1 lds
v_mfma_f32_16x16x32_bf16 v[72:75],a[168:171],v[232:235],v[72:75]
ds_read_b128 v[228:231],v17 offset:34816
v_mfma_f32_16x16x32_bf16 v[64:67],a[44:47],v[236:239],v[64:67]
buffer_load_dwordx4 v16,s[20:23],s65 offen offset:2048 sc1 lds
v_mfma_f32_16x16x32_bf16 v[72:75],a[172:175],v[236:239],v[72:75]
ds_read_b128 v[232:235],v17 offset:36864
s_waitcnt lgkmcnt(5)
v_mfma_f32_16x16x32_bf16 v[64:67],a[48:51],v[240:243],v[64:67]
v_min3_u32 v27,v27,v240,v244
v_mfma_f32_16x16x32_bf16 v[72:75],a[176:179],v[240:243],v[72:75]
ds_read_b128 v[236:239],v17 offset:38912
v_mfma_f32_16x16x32_bf16 v[64:67],a[52:55],v[244:247],v[64:67]
v_add_u32 v22,s71,-1
v_mfma_f32_16x16x32_bf16 v[72:75],a[180:183],v[244:247],v[72:75]
ds_read_b128 v[240:243],v17 offset:40960
s_waitcnt lgkmcnt(5)
v_mfma_f32_16x16x32_bf16 v[64:67],a[56:59],v[248:251],v[64:67]
v_min3_u32 v27,v27,v248,v252
v_mfma_f32_16x16x32_bf16 v[72:75],a[184:187],v[248:251],v[72:75]
ds_read_b128 v[244:247],v17 offset:43008
v_mfma_f32_16x16x32_bf16 v[64:67],a[60:63],v[252:255],v[64:67]
buffer_store_dword v22,v23,s[20:23],s73 offen sc1
v_mfma_f32_16x16x32_bf16 v[72:75],a[188:191],v[252:255],v[72:75]
ds_read_b128 v[248:251],v17 offset:45056
s_waitcnt lgkmcnt(5)
v_mfma_f32_16x16x32_bf16 v[64:67],a[64:67],v[224:227],v[64:67]
v_min3_u32 v27,v27,v224,v228
s_xor_b32 m0,s72,0
v_mfma_f32_16x16x32_bf16 v[72:75],a[192:195],v[224:227],v[72:75]
ds_read_b128 v[252:255],v17 offset:47104
s_add_u32 s65,s88,0
v_mfma_f32_16x16x32_bf16 v[64:67],a[68:71],v[228:231],v[64:67]
v_mfma_f32_16x16x32_bf16 v[72:75],a[196:199],v[228:231],v[72:75]
ds_read_b128 v[224:227],v17 offset:49152
buffer_load_dwordx4 v16,s[20:23],s65 offen offset:0 sc1 lds
s_waitcnt lgkmcnt(5)
v_mfma_f32_16x16x32_bf16 v[64:67],a[72:75],v[232:235],v[64:67]
v_min3_u32 v27,v27,v232,v236
v_mfma_f32_16x16x32_bf16 v[72:75],a[200:203],v[232:235],v[72:75]
ds_read_b128 v[228:231],v17 offset:51200
buffer_load_dwordx4 v16,s[20:23],s65 offen offset:2048 sc1 lds
v_mfma_f32_16x16x32_bf16 v[64:67],a[76:79],v[236:239],v[64:67]
v_mfma_f32_16x16x32_bf16 v[72:75],a[204:207],v[236:239],v[72:75]
ds_read_b128 v[232:235],v17 offset:53248
s_xor_b32 m0,s72,16384
s_waitcnt lgkmcnt(5)
v_mfma_f32_16x16x32_bf16 v[64:67],a[80:83],v[240:243],v[64:67]
v_min3_u32 v27,v27,v240,v244
s_add_u32 s65,s88,32768
v_mfma_f32_16x16x32_bf16 v[72:75],a[208:211],v[240:243],v[72:75]
ds_read_b128 v[236:239],v17 offset:55296
v_mfma_f32_16x16x32_bf16 v[64:67],a[84:87],v[244:247],v[64:67]
buffer_load_dwordx4 v16,s[20:23],s65 offen offset:0 sc1 lds
v_mfma_f32_16x16x32_bf16 v[72:75],a[212:215],v[244:247],v[72:75]
ds_read_b128 v[240:243],v17 offset:57344
s_waitcnt lgkmcnt(5)
v_mfma_f32_16x16x32_bf16 v[64:67],a[88:91],v[248:251],v[64:67]
v_min3_u32 v27,v27,v248,v252
buffer_load_dwordx4 v16,s[20:23],s65 offen offset:2048 sc1 lds
v_mfma_f32_16x16x32_bf16 v[72:75],a[216:219],v[248:251],v[72:75]
ds_read_b128 v[244:247],v17 offset:59392
v_mfma_f32_16x16x32_bf16 v[64:67],a[92:95],v[252:255],v[64:67]
s_xor_b32 m0,s72,32768
v_mfma_f32_16x16x32_bf16 v[72:75],a[220:223],v[252:255],v[72:75]
ds_read_b128 v[248:251],v17 offset:61440
s_add_u32 s65,s88,65536
s_waitcnt lgkmcnt(5)
v_mfma_f32_16x16x32_bf16 v[64:67],a[96:99],v[224:227],v[64:67]
v_min3_u32 v27,v27,v224,v228
v_mfma_f32_16x16x32_bf16 v[72:75],a[224:227],v[224:227],v[72:75]
ds_read_b128 v[252:255],v17 offset:63488
buffer_load_dwordx4 v16,s[20:23],s65 offen offset:0 sc1 lds
v_mfma_f32_16x16x32_bf16 v[64:67],a[100:103],v[228:231],v[64:67]
v_mfma_f32_16x16x32_bf16 v[72:75],a[228:231],v[228:231],v[72:75]
s_waitcnt vmcnt(6)
s_barrier
ds_read_b128 v[224:227],v17 offset:1024
s_waitcnt lgkmcnt(5)
v_mfma_f32_16x16x32_bf16 v[64:67],a[104:107],v[232:235],v[64:67]
v_min3_u32 v27,v27,v232,v236
s_add_u32 s92,s70,8388608
buffer_load_dwordx4 v16,s[20:23],s65 offen offset:2048 sc1 lds
v_mfma_f32_16x16x32_bf16 v[72:75],a[232:235],v[232:235],v[72:75]
ds_read_b128 v[228:231],v17 offset:3072
s_sub_u32 s93,s71,53
s_xor_b32 m0,s72,49152
v_mfma_f32_16x16x32_bf16 v[64:67],a[108:111],v[236:239],v[64:67]
s_cmp_lt_u32 s93,9
s_cselect_b32 s92,s92,0x7fff0000
s_add_u32 s65,s88,98304
v_mfma_f32_16x16x32_bf16 v[72:75],a[236:239],v[236:239],v[72:75]
ds_read_b128 v[232:235],v17 offset:5120
s_waitcnt lgkmcnt(5)
v_mfma_f32_16x16x32_bf16 v[64:67],a[112:115],v[240:243],v[64:67]
v_min3_u32 v27,v27,v240,v244
ds_read_b128 v[124:127],v19 offset:256
buffer_load_dwordx4 v16,s[20:23],s65 offen offset:0 sc1 lds
v_mfma_f32_16x16x32_bf16 v[72:75],a[240:243],v[240:243],v[72:75]
ds_read_b128 v[236:239],v17 offset:7168
ds_read_b128 v[120:123],v19 offset:0
v_mfma_f32_16x16x32_bf16 v[64:67],a[116:119],v[244:247],v[64:67]
buffer_load_dwordx4 v16,s[20:23],s65 offen offset:2048 sc1 lds
v_mfma_f32_16x16x32_bf16 v[72:75],a[244:247],v[244:247],v[72:75]
ds_read_b128 v[240:243],v17 offset:9216
s_waitcnt lgkmcnt(7)
v_mfma_f32_16x16x32_bf16 v[64:67],a[120:123],v[248:251],v[64:67]
v_min3_u32 v27,v27,v248,v252
s_xor_b32 m0,s72,1024
v_mfma_f32_16x16x32_bf16 v[72:75],a[248:251],v[248:251],v[72:75]
ds_read_b128 v[244:247],v17 offset:11264
s_add_u32 s65,s89,0
v_mfma_f32_16x16x32_bf16 v[64:67],a[124:127],v[252:255],v[64:67]
buffer_load_dword v2,v21,s[20:23],s87 offen sc1
s_add_u32 s96,s71,2
v_mfma_f32_16x16x32_bf16 v[72:75],a[252:255],v[252:255],v[72:75]
ds_read_b128 v[248:251],v17 offset:13312
buffer_load_dwordx4 v16,s[20:23],s65 offen offset:0 sc1 lds
s_waitcnt lgkmcnt(7)
v_mfma_f32_16x16x32_bf16 v[68:71],a[0:3],v[224:227],0
v_cmp_eq_u32 vcc,0,v27
s_cbranch_vccnz retry_269
v_mfma_f32_16x16x32_bf16 v[76:79],a[128:131],v[224:227],0
ds_read_b128 v[252:255],v17 offset:15360
v_min3_u32 v27,v27,v224,v228
s_waitcnt lgkmcnt(4)
v_mfma_f32_16x16x32_bf16 v[68:71],a[4:7],v[228:231],v[68:71]
s_cmp_gt_u32 s96,56
s_addc_u32 s96,s96,0
buffer_load_dwordx4 v16,s[20:23],s65 offen offset:2048 sc1 lds
v_mfma_f32_16x16x32_bf16 v[76:79],a[132:135],v[228:231],v[76:79]
ds_read_b128 v[224:227],v17 offset:17408
s_xor_b32 m0,s72,17408
v_mfma_f32_16x16x32_bf16 v[68:71],a[8:11],v[232:235],v[68:71]
v_min3_u32 v27,v27,v232,v236
v_fmac_f32 v64,v52,v120
v_fmac_f32 v65,v53,v120
s_add_u32 s65,s89,32768
v_mfma_f32_16x16x32_bf16 v[76:79],a[136:139],v[232:235],v[76:79]
ds_read_b128 v[228:231],v17 offset:19456
v_fmac_f32 v66,v54,v120
v_fmac_f32 v67,v55,v120
v_mfma_f32_16x16x32_bf16 v[68:71],a[12:15],v[236:239],v[68:71]
buffer_store_dwordx4 v[48:51],v18,s[20:23],s92 offen offset:0 sc1
v_mul_f32 v88,v64,v64
v_mfma_f32_16x16x32_bf16 v[76:79],a[140:143],v[236:239],v[76:79]
ds_read_b128 v[232:235],v17 offset:21504
v_mul_f32 v89,v65,v65
s_waitcnt lgkmcnt(5)
v_mfma_f32_16x16x32_bf16 v[68:71],a[16:19],v[240:243],v[68:71]
v_min3_u32 v27,v27,v240,v244
v_mul_f32 v90,v66,v66
v_mul_f32 v91,v67,v67
v_mfma_f32_16x16x32_bf16 v[76:79],a[144:147],v[240:243],v[76:79]
ds_read_b128 v[236:239],v17 offset:23552
v_fma_f32 v88,v88,v121,v122
v_fma_f32 v89,v89,v121,v122
v_mfma_f32_16x16x32_bf16 v[68:71],a[20:23],v[244:247],v[68:71]
buffer_store_dwordx4 v[48:51],v18,s[20:23],s92 offen offset:1024 sc1
v_fmac_f32 v72,v56,v120
v_mfma_f32_16x16x32_bf16 v[76:79],a[148:151],v[244:247],v[76:79]
ds_read_b128 v[240:243],v17 offset:25600
v_fmac_f32 v73,v57,v120
s_waitcnt lgkmcnt(5)
v_mfma_f32_16x16x32_bf16 v[68:71],a[24:27],v[248:251],v[68:71]
v_min3_u32 v27,v27,v248,v252
v_fma_f32 v90,v90,v121,v122
v_fmac_f32 v74,v58,v120
v_mfma_f32_16x16x32_bf16 v[76:79],a[152:155],v[248:251],v[76:79]
ds_read_b128 v[244:247],v17 offset:27648
v_fma_f32 v91,v91,v121,v122
v_fmac_f32 v75,v59,v120
v_mfma_f32_16x16x32_bf16 v[68:71],a[28:31],v[252:255],v[68:71]
v_mul_f32 v88,v88,v64
v_mul_f32 v89,v89,v65
v_mul_f32 v92,v72,v72
v_mfma_f32_16x16x32_bf16 v[76:79],a[156:159],v[252:255],v[76:79]
ds_read_b128 v[248:251],v17 offset:29696
v_mul_f32 v93,v73,v73
s_waitcnt lgkmcnt(5)
v_mfma_f32_16x16x32_bf16 v[68:71],a[32:35],v[224:227],v[68:71]
v_min3_u32 v27,v27,v224,v228
v_mul_f32 v90,v90,v66
v_mul_f32 v94,v74,v74
v_mfma_f32_16x16x32_bf16 v[76:79],a[160:163],v[224:227],v[76:79]
ds_read_b128 v[252:255],v17 offset:31744
v_mul_f32 v91,v91,v67
v_mul_f32 v95,v75,v75
v_mfma_f32_16x16x32_bf16 v[68:71],a[36:39],v[228:231],v[68:71]
v_exp_f32 v88,v88
v_fma_f32 v92,v92,v121,v122
v_mfma_f32_16x16x32_bf16 v[76:79],a[164:167],v[228:231],v[76:79]
ds_read_b128 v[224:227],v17 offset:33792
v_fma_f32 v93,v93,v121,v122
s_waitcnt lgkmcnt(5)
v_mfma_f32_16x16x32_bf16 v[68:71],a[40:43],v[232:235],v[68:71]
v_min3_u32 v27,v27,v232,v236
v_fma_f32 v94,v94,v121,v122
v_fma_f32 v95,v95,v121,v122
v_mfma_f32_16x16x32_bf16 v[76:79],a[168:171],v[232:235],v[76:79]
ds_read_b128 v[228:231],v17 offset:35840
v_mul_f32 v92,v92,v72
v_mul_f32 v93,v93,v73
v_mfma_f32_16x16x32_bf16 v[68:71],a[44:47],v[236:239],v[68:71]
v_exp_f32 v89,v89
v_mul_f32 v94,v94,v74
v_mfma_f32_16x16x32_bf16 v[76:79],a[172:175],v[236:239],v[76:79]
ds_read_b128 v[232:235],v17 offset:37888
v_mul_f32 v95,v95,v75
s_waitcnt lgkmcnt(5)
v_mfma_f32_16x16x32_bf16 v[68:71],a[48:51],v[240:243],v[68:71]
v_min3_u32 v27,v27,v240,v244
v_exp_f32 v92,v92
v_mfma_f32_16x16x32_bf16 v[76:79],a[176:179],v[240:243],v[76:79]
ds_read_b128 v[236:239],v17 offset:39936
v_exp_f32 v93,v93
v_mfma_f32_16x16x32_bf16 v[68:71],a[52:55],v[244:247],v[68:71]
v_exp_f32 v90,v90
buffer_load_dwordx4 v16,s[20:23],s65 offen offset:0 sc1 lds
v_mfma_f32_16x16x32_bf16 v[76:79],a[180:183],v[244:247],v[76:79]
ds_read_b128 v[240:243],v17 offset:41984
buffer_load_dwordx4 v16,s[20:23],s65 offen offset:2048 sc1 lds
s_waitcnt lgkmcnt(5)
v_mfma_f32_16x16x32_bf16 v[68:71],a[56:59],v[248:251],v[68:71]
v_min3_u32 v27,v27,v248,v252
v_exp_f32 v94,v94
s_xor_b32 m0,s72,33792
v_mfma_f32_16x16x32_bf16 v[76:79],a[184:187],v[248:251],v[76:79]
ds_read_b128 v[244:247],v17 offset:44032
v_exp_f32 v95,v95
s_add_u32 s65,s89,65536
v_mfma_f32_16x16x32_bf16 v[68:71],a[60:63],v[252:255],v[68:71]
v_exp_f32 v91,v91
v_fma_f32 v92,v92,v123,v123
v_mfma_f32_16x16x32_bf16 v[76:79],a[188:191],v[252:255],v[76:79]
ds_read_b128 v[248:251],v17 offset:46080
v_fma_f32 v93,v93,v123,v123
s_waitcnt lgkmcnt(5)
v_mfma_f32_16x16x32_bf16 v[68:71],a[64:67],v[224:227],v[68:71]
v_min3_u32 v27,v27,v224,v228
v_fma_f32 v88,v88,v123,v123
v_fma_f32 v94,v94,v123,v123
v_mfma_f32_16x16x32_bf16 v[76:79],a[192:195],v[224:227],v[76:79]
ds_read_b128 v[252:255],v17 offset:48128
v_fma_f32 v89,v89,v123,v123
v_fma_f32 v95,v95,v123,v123
v_mfma_f32_16x16x32_bf16 v[68:71],a[68:71],v[228:231],v[68:71]
v_fma_f32 v90,v90,v123,v123
v_fma_f32 v91,v91,v123,v123
buffer_load_dwordx4 v16,s[20:23],s65 offen offset:0 sc1 lds
v_mfma_f32_16x16x32_bf16 v[76:79],a[196:199],v[228:231],v[76:79]
ds_read_b128 v[224:227],v17 offset:50176
buffer_load_dwordx4 v16,s[20:23],s65 offen offset:2048 sc1 lds
s_waitcnt lgkmcnt(5)
v_mfma_f32_16x16x32_bf16 v[68:71],a[72:75],v[232:235],v[68:71]
v_min3_u32 v27,v27,v232,v236
v_rcp_f32 v92,v92
s_xor_b32 m0,s72,50176
v_mfma_f32_16x16x32_bf16 v[76:79],a[200:203],v[232:235],v[76:79]
ds_read_b128 v[228:231],v17 offset:52224
v_rcp_f32 v93,v93
s_add_u32 s65,s89,98304
v_mfma_f32_16x16x32_bf16 v[68:71],a[76:79],v[236:239],v[68:71]
v_rcp_f32 v88,v88
v_mfma_f32_16x16x32_bf16 v[76:79],a[204:207],v[236:239],v[76:79]
ds_read_b128 v[232:235],v17 offset:54272
s_waitcnt lgkmcnt(5)
v_mfma_f32_16x16x32_bf16 v[68:71],a[80:83],v[240:243],v[68:71]
v_min3_u32 v27,v27,v240,v244
v_rcp_f32 v94,v94
v_mfma_f32_16x16x32_bf16 v[76:79],a[208:211],v[240:243],v[76:79]
ds_read_b128 v[236:239],v17 offset:56320
v_rcp_f32 v95,v95
v_mfma_f32_16x16x32_bf16 v[68:71],a[84:87],v[244:247],v[68:71]
v_rcp_f32 v89,v89
v_mfma_f32_16x16x32_bf16 v[76:79],a[212:215],v[244:247],v[76:79]
ds_read_b128 v[240:243],v17 offset:58368
s_waitcnt lgkmcnt(5)
v_mfma_f32_16x16x32_bf16 v[68:71],a[88:91],v[248:251],v[68:71]
v_min3_u32 v27,v27,v248,v252
v_mul_f32 v92,v92,v72
v_mfma_f32_16x16x32_bf16 v[76:79],a[216:219],v[248:251],v[76:79]
ds_read_b128 v[244:247],v17 offset:60416
v_mul_f32 v93,v93,v73
v_mfma_f32_16x16x32_bf16 v[68:71],a[92:95],v[252:255],v[68:71]
v_rcp_f32 v90,v90
v_mfma_f32_16x16x32_bf16 v[76:79],a[220:223],v[252:255],v[76:79]
ds_read_b128 v[248:251],v17 offset:62464
s_waitcnt lgkmcnt(5)
v_mfma_f32_16x16x32_bf16 v[68:71],a[96:99],v[224:227],v[68:71]
v_min3_u32 v27,v27,v224,v228
v_mul_f32 v94,v94,v74
v_mfma_f32_16x16x32_bf16 v[76:79],a[224:227],v[224:227],v[76:79]
ds_read_b128 v[252:255],v17 offset:64512
v_mul_f32 v95,v95,v75
v_mfma_f32_16x16x32_bf16 v[68:71],a[100:103],v[228:231],v[68:71]
v_rcp_f32 v91,v91
v_mfma_f32_16x16x32_bf16 v[76:79],a[228:231],v[228:231],v[76:79]
v_mul_f32 v88,v88,v64
s_waitcnt lgkmcnt(4)
v_mfma_f32_16x16x32_bf16 v[68:71],a[104:107],v[232:235],v[68:71]
v_min3_u32 v27,v27,v232,v236
s_waitcnt vmcnt(8)
v_mfma_f32_16x16x32_bf16 v[76:79],a[232:235],v[232:235],v[76:79]
v_cmp_gt_u32 vcc,s96,v2
s_mov_b32 s96,vcc_lo
v_mfma_f32_16x16x32_bf16 v[68:71],a[108:111],v[236:239],v[68:71]
v_mov_b32 v44,s96
ds_write_b32 v46,v44
v_mfma_f32_16x16x32_bf16 v[76:79],a[236:239],v[236:239],v[76:79]
v_mul_f32 v89,v89,v65
s_waitcnt lgkmcnt(3)
v_mfma_f32_16x16x32_bf16 v[68:71],a[112:115],v[240:243],v[68:71]
v_min3_u32 v27,v27,v240,v244
v_mul_f32 v90,v90,v66
v_mfma_f32_16x16x32_bf16 v[76:79],a[240:243],v[240:243],v[76:79]
v_mul_f32 v91,v91,v67
v_cvt_pk_bf16_f32 v96,v88,v89
v_mfma_f32_16x16x32_bf16 v[68:71],a[116:119],v[244:247],v[68:71]
v_cvt_pk_bf16_f32 v97,v90,v91
v_cvt_pk_bf16_f32 v98,v92,v93
v_mfma_f32_16x16x32_bf16 v[76:79],a[244:247],v[244:247],v[76:79]
v_cvt_pk_bf16_f32 v99,v94,v95
s_waitcnt lgkmcnt(1)
v_mfma_f32_16x16x32_bf16 v[68:71],a[120:123],v[248:251],v[68:71]
v_min3_u32 v27,v27,v248,v252
v_max_u32 v96,1,v96
v_mfma_f32_16x16x32_bf16 v[76:79],a[248:251],v[248:251],v[76:79]
buffer_store_dwordx4 v[96:99],v18,s[20:23],s70 offen offset:0 sc1
v_mfma_f32_16x16x32_bf16 v[68:71],a[124:127],v[252:255],v[68:71]
buffer_load_dwordx4 v16,s[20:23],s65 offen offset:0 sc1 lds
v_mfma_f32_16x16x32_bf16 v[76:79],a[252:255],v[252:255],v[76:79]
buffer_load_dwordx4 v16,s[20:23],s65 offen offset:2048 sc1 lds
v_cmp_eq_u32 vcc,0,v27
s_cbranch_vccnz retry_269
s_branch epi_272
ahead_271:
s_waitcnt vmcnt(3) lgkmcnt(0)
s_barrier
ds_read_b32 v44,v45
ds_read_b128 v[224:227],v17 offset:0
ds_read_b128 v[228:231],v17 offset:2048
ds_read_b128 v[232:235],v17 offset:4096
ds_read_b128 v[236:239],v17 offset:6144
ds_read_b128 v[240:243],v17 offset:8192
ds_read_b128 v[244:247],v17 offset:10240
ds_read_b128 v[248:251],v17 offset:12288
s_waitcnt lgkmcnt(5)
v_mfma_f32_16x16x32_bf16 v[64:67],a[0:3],v[224:227],0
s_add_u32 s88,s70,s75
s_add_u32 s88,s88,2097152
v_mfma_f32_16x16x32_bf16 v[72:75],a[128:131],v[224:227],0
ds_read_b128 v[252:255],v17 offset:14336
s_xor_b32 s88,s88,0x2000
v_mfma_f32_16x16x32_bf16 v[64:67],a[4:7],v[228:231],v[64:67]
v_readfirstlane_b32 s83,v44
v_mfma_f32_16x16x32_bf16 v[72:75],a[132:135],v[228:231],v[72:75]
ds_read_b128 v[224:227],v17 offset:16384
s_waitcnt lgkmcnt(5)
v_mfma_f32_16x16x32_bf16 v[64:67],a[8:11],v[232:235],v[64:67]
s_cmp_eq_u32 s83,0
s_cselect_b32 s88,s88,0x7fff0000
v_mfma_f32_16x16x32_bf16 v[72:75],a[136:139],v[232:235],v[72:75]
ds_read_b128 v[228:231],v17 offset:18432
s_xor_b32 s89,s88,1024
v_mfma_f32_16x16x32_bf16 v[64:67],a[12:15],v[236:239],v[64:67]
s_xor_b32 m0,s72,0
v_mfma_f32_16x16x32_bf16 v[72:75],a[140:143],v[236:239],v[72:75]
ds_read_b128 v[232:235],v17 offset:20480
s_add_u32 s65,s88,0
s_waitcnt lgkmcnt(5)
v_mfma_f32_16x16x32_bf16 v[64:67],a[16:19],v[240:243],v[64:67]
v_mfma_f32_16x16x32_bf16 v[72:75],a[144:147],v[240:243],v[72:75]
ds_read_b128 v[236:239],v17 offset:22528
buffer_load_dwordx4 v16,s[20:23],s65 offen offset:0 sc1 lds
v_mfma_f32_16x16x32_bf16 v[64:67],a[20:23],v[244:247],v[64:67]
v_mfma_f32_16x16x32_bf16 v[72:75],a[148:151],v[244:247],v[72:75]
ds_read_b128 v[240:243],v17 offset:24576
s_waitcnt lgkmcnt(5)
v_mfma_f32_16x16x32_bf16 v[64:67],a[24:27],v[248:251],v[64:67]
buffer_load_dwordx4 v16,s[20:23],s65 offen offset:2048 sc1 lds
v_mfma_f32_16x16x32_bf16 v[72:75],a[152:155],v[248:251],v[72:75]
ds_read_b128 v[244:247],v17 offset:26624
s_xor_b32 m0,s72,16384
v_mfma_f32_16x16x32_bf16 v[64:67],a[28:31],v[252:255],v[64:67]
s_add_u32 s65,s88,32768
v_mfma_f32_16x16x32_bf16 v[72:75],a[156:159],v[252:255],v[72:75]
ds_read_b128 v[248:251],v17 offset:28672
s_waitcnt lgkmcnt(5)
v_mfma_f32_16x16x32_bf16 v[64:67],a[32:35],v[224:227],v[64:67]
buffer_load_dwordx4 v16,s[20:23],s65 offen offset:0 sc1 lds
v_mfma_f32_16x16x32_bf16 v[72:75],a[160:163],v[224:227],v[72:75]
ds_read_b128 v[252:255],v17 offset:30720
v_mfma_f32_16x16x32_bf16 v[64:67],a[36:39],v[228:231],v[64:67]
buffer_load_dwordx4 v16,s[20:23],s65 offen offset:2048 sc1 lds
v_mfma_f32_16x16x32_bf16 v[72:75],a[164:167],v[228:231],v[72:75]
ds_read_b128 v[224:227],v17 offset:32768
s_waitcnt lgkmcnt(5)
v_mfma_f32_16x16x32_bf16 v[64:67],a[40:43],v[232:235],v[64:67]
s_xor_b32 m0,s72,32768
v_mfma_f32_16x16x32_bf16 v[72:75],a[168:171],v[232:235],v[72:75]
ds_read_b128 v[228:231],v17 offset:34816
s_add_u32 s65,s88,65536
v_mfma_f32_16x16x32_bf16 v[64:67],a[44:47],v[236:239],v[64:67]
v_mfma_f32_16x16x32_bf16 v[72:75],a[172:175],v[236:239],v[72:75]
ds_read_b128 v[232:235],v17 offset:36864
s_waitcnt lgkmcnt(5)
v_mfma_f32_16x16x32_bf16 v[64:67],a[48:51],v[240:243],v[64:67]
buffer_load_dwordx4 v16,s[20:23],s65 offen offset:0 sc1 lds
v_mfma_f32_16x16x32_bf16 v[72:75],a[176:179],v[240:243],v[72:75]
ds_read_b128 v[236:239],v17 offset:38912
buffer_load_dwordx4 v16,s[20:23],s65 offen offset:2048 sc1 lds
v_mfma_f32_16x16x32_bf16 v[64:67],a[52:55],v[244:247],v[64:67]
v_mfma_f32_16x16x32_bf16 v[72:75],a[180:183],v[244:247],v[72:75]
ds_read_b128 v[240:243],v17 offset:40960
s_xor_b32 m0,s72,49152
s_waitcnt lgkmcnt(5)
v_mfma_f32_16x16x32_bf16 v[64:67],a[56:59],v[248:251],v[64:67]
s_add_u32 s65,s88,98304
v_mfma_f32_16x16x32_bf16 v[72:75],a[184:187],v[248:251],v[72:75]
ds_read_b128 v[244:247],v17 offset:43008
v_mfma_f32_16x16x32_bf16 v[64:67],a[60:63],v[252:255],v[64:67]
buffer_load_dwordx4 v16,s[20:23],s65 offen offset:0 sc1 lds
v_mfma_f32_16x16x32_bf16 v[72:75],a[188:191],v[252:255],v[72:75]
ds_read_b128 v[248:251],v17 offset:45056
s_waitcnt lgkmcnt(5)
v_mfma_f32_16x16x32_bf16 v[64:67],a[64:67],v[224:227],v[64:67]
buffer_load_dwordx4 v16,s[20:23],s65 offen offset:2048 sc1 lds
v_mfma_f32_16x16x32_bf16 v[72:75],a[192:195],v[224:227],v[72:75]
ds_read_b128 v[252:255],v17 offset:47104
v_mfma_f32_16x16x32_bf16 v[64:67],a[68:71],v[228:231],v[64:67]
s_xor_b32 m0,s72,1024
v_mfma_f32_16x16x32_bf16 v[72:75],a[196:199],v[228:231],v[72:75]
ds_read_b128 v[224:227],v17 offset:49152
s_add_u32 s65,s89,0
s_waitcnt lgkmcnt(5)
v_mfma_f32_16x16x32_bf16 v[64:67],a[72:75],v[232:235],v[64:67]
v_mfma_f32_16x16x32_bf16 v[72:75],a[200:203],v[232:235],v[72:75]
ds_read_b128 v[228:231],v17 offset:51200
buffer_load_dwordx4 v16,s[20:23],s65 offen offset:0 sc1 lds
v_mfma_f32_16x16x32_bf16 v[64:67],a[76:79],v[236:239],v[64:67]
v_mfma_f32_16x16x32_bf16 v[72:75],a[204:207],v[236:239],v[72:75]
ds_read_b128 v[232:235],v17 offset:53248
s_waitcnt lgkmcnt(5)
v_mfma_f32_16x16x32_bf16 v[64:67],a[80:83],v[240:243],v[64:67]
buffer_load_dwordx4 v16,s[20:23],s65 offen offset:2048 sc1 lds
v_mfma_f32_16x16x32_bf16 v[72:75],a[208:211],v[240:243],v[72:75]
ds_read_b128 v[236:239],v17 offset:55296
s_xor_b32 m0,s72,17408
v_mfma_f32_16x16x32_bf16 v[64:67],a[84:87],v[244:247],v[64:67]
s_add_u32 s65,s89,32768
v_mfma_f32_16x16x32_bf16 v[72:75],a[212:215],v[244:247],v[72:75]
ds_read_b128 v[240:243],v17 offset:57344
s_waitcnt lgkmcnt(5)
v_mfma_f32_16x16x32_bf16 v[64:67],a[88:91],v[248:251],v[64:67]
buffer_load_dwordx4 v16,s[20:23],s65 offen offset:0 sc1 lds
v_mfma_f32_16x16x32_bf16 v[72:75],a[216:219],v[248:251],v[72:75]
ds_read_b128 v[244:247],v17 offset:59392
v_mfma_f32_16x16x32_bf16 v[64:67],a[92:95],v[252:255],v[64:67]
buffer_load_dwordx4 v16,s[20:23],s65 offen offset:2048 sc1 lds
v_mfma_f32_16x16x32_bf16 v[72:75],a[220:223],v[252:255],v[72:75]
ds_read_b128 v[248:251],v17 offset:61440
s_waitcnt lgkmcnt(5)
v_mfma_f32_16x16x32_bf16 v[64:67],a[96:99],v[224:227],v[64:67]
s_xor_b32 m0,s72,33792
v_mfma_f32_16x16x32_bf16 v[72:75],a[224:227],v[224:227],v[72:75]
ds_read_b128 v[252:255],v17 offset:63488
s_add_u32 s65,s89,65536
v_mfma_f32_16x16x32_bf16 v[64:67],a[100:103],v[228:231],v[64:67]
s_waitcnt vmcnt(12)
v_add_u32 v22,s71,-1
v_mfma_f32_16x16x32_bf16 v[72:75],a[228:231],v[228:231],v[72:75]
s_barrier
ds_read_b128 v[224:227],v17 offset:1024
s_waitcnt lgkmcnt(5)
v_mfma_f32_16x16x32_bf16 v[64:67],a[104:107],v[232:235],v[64:67]
buffer_store_dword v22,v23,s[20:23],s73 offen sc1
v_mfma_f32_16x16x32_bf16 v[72:75],a[232:235],v[232:235],v[72:75]
ds_read_b128 v[228:231],v17 offset:3072
s_add_u32 s92,s70,8388608
v_mfma_f32_16x16x32_bf16 v[64:67],a[108:111],v[236:239],v[64:67]
s_sub_u32 s93,s71,53
ds_read_b128 v[124:127],v19 offset:256
v_mfma_f32_16x16x32_bf16 v[72:75],a[236:239],v[236:239],v[72:75]
ds_read_b128 v[232:235],v17 offset:5120
s_waitcnt lgkmcnt(6)
v_mfma_f32_16x16x32_bf16 v[64:67],a[112:115],v[240:243],v[64:67]
s_cmp_lt_u32 s93,9
s_cselect_b32 s92,s92,0x7fff0000
v_mfma_f32_16x16x32_bf16 v[72:75],a[240:243],v[240:243],v[72:75]
ds_read_b128 v[236:239],v17 offset:7168
ds_read_b128 v[120:123],v19 offset:0
v_mfma_f32_16x16x32_bf16 v[64:67],a[116:119],v[244:247],v[64:67]
buffer_load_dwordx4 v16,s[20:23],s65 offen offset:0 sc1 lds
v_mfma_f32_16x16x32_bf16 v[72:75],a[244:247],v[244:247],v[72:75]
ds_read_b128 v[240:243],v17 offset:9216
s_waitcnt lgkmcnt(7)
v_mfma_f32_16x16x32_bf16 v[64:67],a[120:123],v[248:251],v[64:67]
buffer_load_dwordx4 v16,s[20:23],s65 offen offset:2048 sc1 lds
s_xor_b32 m0,s72,50176
v_mfma_f32_16x16x32_bf16 v[72:75],a[248:251],v[248:251],v[72:75]
ds_read_b128 v[244:247],v17 offset:11264
s_add_u32 s65,s89,98304
v_mfma_f32_16x16x32_bf16 v[64:67],a[124:127],v[252:255],v[64:67]
buffer_load_dword v2,v21,s[20:23],s87 offen sc1
v_mfma_f32_16x16x32_bf16 v[72:75],a[252:255],v[252:255],v[72:75]
ds_read_b128 v[248:251],v17 offset:13312
s_waitcnt lgkmcnt(7)
v_mfma_f32_16x16x32_bf16 v[68:71],a[0:3],v[224:227],0
s_add_u32 s96,s71,2
buffer_load_dwordx4 v16,s[20:23],s65 offen offset:0 sc1 lds
v_mfma_f32_16x16x32_bf16 v[76:79],a[128:131],v[224:227],0
ds_read_b128 v[252:255],v17 offset:15360
s_waitcnt lgkmcnt(4)
v_mfma_f32_16x16x32_bf16 v[68:71],a[4:7],v[228:231],v[68:71]
s_cmp_gt_u32 s96,56
s_addc_u32 s96,s96,0
v_mfma_f32_16x16x32_bf16 v[76:79],a[132:135],v[228:231],v[76:79]
ds_read_b128 v[224:227],v17 offset:17408
v_mfma_f32_16x16x32_bf16 v[68:71],a[8:11],v[232:235],v[68:71]
v_fmac_f32 v64,v52,v120
v_fmac_f32 v65,v53,v120
v_fmac_f32 v72,v56,v120
v_mfma_f32_16x16x32_bf16 v[76:79],a[136:139],v[232:235],v[76:79]
ds_read_b128 v[228:231],v17 offset:19456
v_fmac_f32 v66,v54,v120
v_fmac_f32 v73,v57,v120
v_mfma_f32_16x16x32_bf16 v[68:71],a[12:15],v[236:239],v[68:71]
buffer_store_dwordx4 v[48:51],v18,s[20:23],s92 offen offset:0 sc1
v_fmac_f32 v74,v58,v120
v_mfma_f32_16x16x32_bf16 v[76:79],a[140:143],v[236:239],v[76:79]
ds_read_b128 v[232:235],v17 offset:21504
v_fmac_f32 v75,v59,v120
s_waitcnt lgkmcnt(5)
v_mfma_f32_16x16x32_bf16 v[68:71],a[16:19],v[240:243],v[68:71]
buffer_store_dwordx4 v[48:51],v18,s[20:23],s92 offen offset:1024 sc1
v_mul_f32 v92,v72,v72
v_mfma_f32_16x16x32_bf16 v[76:79],a[144:147],v[240:243],v[76:79]
ds_read_b128 v[236:239],v17 offset:23552
v_fmac_f32 v67,v55,v120
v_mul_f32 v93,v73,v73
v_mfma_f32_16x16x32_bf16 v[68:71],a[20:23],v[244:247],v[68:71]
v_mul_f32 v88,v64,v64
v_mul_f32 v89,v65,v65
v_mul_f32 v94,v74,v74
v_mfma_f32_16x16x32_bf16 v[76:79],a[148:151],v[244:247],v[76:79]
ds_read_b128 v[240:243],v17 offset:25600
v_mul_f32 v95,v75,v75
s_waitcnt lgkmcnt(5)
v_mfma_f32_16x16x32_bf16 v[68:71],a[24:27],v[248:251],v[68:71]
v_mul_f32 v90,v66,v66
v_mul_f32 v91,v67,v67
v_fma_f32 v92,v92,v121,v122
v_mfma_f32_16x16x32_bf16 v[76:79],a[152:155],v[248:251],v[76:79]
ds_read_b128 v[244:247],v17 offset:27648
v_fma_f32 v88,v88,v121,v122
v_fma_f32 v93,v93,v121,v122
v_mfma_f32_16x16x32_bf16 v[68:71],a[28:31],v[252:255],v[68:71]
v_fma_f32 v89,v89,v121,v122
v_fma_f32 v90,v90,v121,v122
v_fma_f32 v94,v94,v121,v122
v_mfma_f32_16x16x32_bf16 v[76:79],a[156:159],v[252:255],v[76:79]
ds_read_b128 v[248:251],v17 offset:29696
v_fma_f32 v95,v95,v121,v122
s_waitcnt lgkmcnt(5)
v_mfma_f32_16x16x32_bf16 v[68:71],a[32:35],v[224:227],v[68:71]
v_fma_f32 v91,v91,v121,v122
v_mul_f32 v88,v88,v64
v_mul_f32 v92,v92,v72
v_mfma_f32_16x16x32_bf16 v[76:79],a[160:163],v[224:227],v[76:79]
ds_read_b128 v[252:255],v17 offset:31744
v_mul_f32 v89,v89,v65
v_mul_f32 v93,v93,v73
v_mfma_f32_16x16x32_bf16 v[68:71],a[36:39],v[228:231],v[68:71]
v_mul_f32 v90,v90,v66
v_mul_f32 v91,v91,v67
v_mul_f32 v94,v94,v74
v_mfma_f32_16x16x32_bf16 v[76:79],a[164:167],v[228:231],v[76:79]
ds_read_b128 v[224:227],v17 offset:33792
v_mul_f32 v95,v95,v75
s_waitcnt lgkmcnt(5)
v_mfma_f32_16x16x32_bf16 v[68:71],a[40:43],v[232:235],v[68:71]
v_exp_f32 v88,v88
v_mfma_f32_16x16x32_bf16 v[76:79],a[168:171],v[232:235],v[76:79]
ds_read_b128 v[228:231],v17 offset:35840
v_exp_f32 v92,v92
v_mfma_f32_16x16x32_bf16 v[68:71],a[44:47],v[236:239],v[68:71]
v_exp_f32 v89,v89
v_mfma_f32_16x16x32_bf16 v[76:79],a[172:175],v[236:239],v[76:79]
ds_read_b128 v[232:235],v17 offset:37888
s_waitcnt lgkmcnt(5)
v_mfma_f32_16x16x32_bf16 v[68:71],a[48:51],v[240:243],v[68:71]
v_exp_f32 v90,v90
v_mfma_f32_16x16x32_bf16 v[76:79],a[176:179],v[240:243],v[76:79]
ds_read_b128 v[236:239],v17 offset:39936
v_exp_f32 v93,v93
v_mfma_f32_16x16x32_bf16 v[68:71],a[52:55],v[244:247],v[68:71]
v_exp_f32 v91,v91
v_mfma_f32_16x16x32_bf16 v[76:79],a[180:183],v[244:247],v[76:79]
ds_read_b128 v[240:243],v17 offset:41984
s_waitcnt lgkmcnt(5)
v_mfma_f32_16x16x32_bf16 v[68:71],a[56:59],v[248:251],v[68:71]
v_fma_f32 v88,v88,v123,v123
v_fma_f32 v89,v89,v123,v123
v_mfma_f32_16x16x32_bf16 v[76:79],a[184:187],v[248:251],v[76:79]
ds_read_b128 v[244:247],v17 offset:44032
v_fma_f32 v90,v90,v123,v123
v_mfma_f32_16x16x32_bf16 v[68:71],a[60:63],v[252:255],v[68:71]
v_fma_f32 v91,v91,v123,v123
v_exp_f32 v94,v94
v_mfma_f32_16x16x32_bf16 v[76:79],a[188:191],v[252:255],v[76:79]
ds_read_b128 v[248:251],v17 offset:46080
s_waitcnt lgkmcnt(5)
v_mfma_f32_16x16x32_bf16 v[68:71],a[64:67],v[224:227],v[68:71]
v_rcp_f32 v88,v88
v_mfma_f32_16x16x32_bf16 v[76:79],a[192:195],v[224:227],v[76:79]
ds_read_b128 v[252:255],v17 offset:48128
v_exp_f32 v95,v95
v_mfma_f32_16x16x32_bf16 v[68:71],a[68:71],v[228:231],v[68:71]
v_rcp_f32 v89,v89
v_mfma_f32_16x16x32_bf16 v[76:79],a[196:199],v[228:231],v[76:79]
ds_read_b128 v[224:227],v17 offset:50176
s_waitcnt lgkmcnt(5)
v_mfma_f32_16x16x32_bf16 v[68:71],a[72:75],v[232:235],v[68:71]
v_rcp_f32 v90,v90
v_mfma_f32_16x16x32_bf16 v[76:79],a[200:203],v[232:235],v[76:79]
ds_read_b128 v[228:231],v17 offset:52224
v_fma_f32 v92,v92,v123,v123
v_mfma_f32_16x16x32_bf16 v[68:71],a[76:79],v[236:239],v[68:71]
v_rcp_f32 v91,v91
v_mfma_f32_16x16x32_bf16 v[76:79],a[204:207],v[236:239],v[76:79]
ds_read_b128 v[232:235],v17 offset:54272
s_waitcnt lgkmcnt(5)
v_mfma_f32_16x16x32_bf16 v[68:71],a[80:83],v[240:243],v[68:71]
v_mul_f32 v88,v88,v64
v_mul_f32 v89,v89,v65
v_mfma_f32_16x16x32_bf16 v[76:79],a[208:211],v[240:243],v[76:79]
ds_read_b128 v[236:239],v17 offset:56320
v_mul_f32 v90,v90,v66
v_mfma_f32_16x16x32_bf16 v[68:71],a[84:87],v[244:247],v[68:71]
v_mul_f32 v91,v91,v67
v_fma_f32 v93,v93,v123,v123
v_mfma_f32_16x16x32_bf16 v[76:79],a[212:215],v[244:247],v[76:79]
ds_read_b128 v[240:243],v17 offset:58368
s_waitcnt lgkmcnt(5)
v_mfma_f32_16x16x32_bf16 v[68:71],a[88:91],v[248:251],v[68:71]
v_fma_f32 v94,v94,v123,v123
v_fma_f32 v95,v95,v123,v123
v_mfma_f32_16x16x32_bf16 v[76:79],a[216:219],v[248:251],v[76:79]
ds_read_b128 v[244:247],v17 offset:60416
v_mfma_f32_16x16x32_bf16 v[68:71],a[92:95],v[252:255],v[68:71]
v_rcp_f32 v92,v92
v_mfma_f32_16x16x32_bf16 v[76:79],a[220:223],v[252:255],v[76:79]
ds_read_b128 v[248:251],v17 offset:62464
s_waitcnt lgkmcnt(5)
v_mfma_f32_16x16x32_bf16 v[68:71],a[96:99],v[224:227],v[68:71]
v_rcp_f32 v93,v93
v_mfma_f32_16x16x32_bf16 v[76:79],a[224:227],v[224:227],v[76:79]
ds_read_b128 v[252:255],v17 offset:64512
v_mfma_f32_16x16x32_bf16 v[68:71],a[100:103],v[228:231],v[68:71]
v_rcp_f32 v94,v94
v_mfma_f32_16x16x32_bf16 v[76:79],a[228:231],v[228:231],v[76:79]
s_waitcnt lgkmcnt(4)
v_mfma_f32_16x16x32_bf16 v[68:71],a[104:107],v[232:235],v[68:71]
s_waitcnt vmcnt(3)
v_mfma_f32_16x16x32_bf16 v[76:79],a[232:235],v[232:235],v[76:79]
v_cmp_gt_u32 vcc,s96,v2
s_mov_b32 s96,vcc_lo
v_mfma_f32_16x16x32_bf16 v[68:71],a[108:111],v[236:239],v[68:71]
v_mov_b32 v44,s96
ds_write_b32 v46,v44
v_mfma_f32_16x16x32_bf16 v[76:79],a[236:239],v[236:239],v[76:79]
s_waitcnt lgkmcnt(3)
v_mfma_f32_16x16x32_bf16 v[68:71],a[112:115],v[240:243],v[68:71]
v_rcp_f32 v95,v95
v_mfma_f32_16x16x32_bf16 v[76:79],a[240:243],v[240:243],v[76:79]
v_mul_f32 v92,v92,v72
v_mul_f32 v93,v93,v73
v_mfma_f32_16x16x32_bf16 v[68:71],a[116:119],v[244:247],v[68:71]
v_mul_f32 v94,v94,v74
v_mul_f32 v95,v95,v75
v_mfma_f32_16x16x32_bf16 v[76:79],a[244:247],v[244:247],v[76:79]
v_cvt_pk_bf16_f32 v96,v88,v89
s_waitcnt lgkmcnt(1)
v_mfma_f32_16x16x32_bf16 v[68:71],a[120:123],v[248:251],v[68:71]
v_cvt_pk_bf16_f32 v97,v90,v91
v_cvt_pk_bf16_f32 v98,v92,v93
v_mfma_f32_16x16x32_bf16 v[76:79],a[248:251],v[248:251],v[76:79]
v_cvt_pk_bf16_f32 v99,v94,v95
v_max_u32 v96,1,v96
v_mfma_f32_16x16x32_bf16 v[68:71],a[124:127],v[252:255],v[68:71]
buffer_store_dwordx4 v[96:99],v18,s[20:23],s70 offen offset:0 sc1
v_mfma_f32_16x16x32_bf16 v[76:79],a[252:255],v[252:255],v[76:79]
buffer_load_dwordx4 v16,s[20:23],s65 offen offset:2048 sc1 lds
epi_272:
buffer_load_dword v29,v21,s[20:23],s87 offen sc1
s_nop 3
v_pk_fma_f32 v[68:69],v[52:53],v[124:125],v[68:69] op_sel_hi:[1,0,1]
v_pk_fma_f32 v[70:71],v[54:55],v[124:125],v[70:71] op_sel_hi:[1,0,1]
v_pk_fma_f32 v[76:77],v[56:57],v[124:125],v[76:77] op_sel_hi:[1,0,1]
v_pk_fma_f32 v[78:79],v[58:59],v[124:125],v[78:79] op_sel_hi:[1,0,1]
v_pk_mul_f32 v[88:89],v[68:69],v[68:69]
v_pk_mul_f32 v[90:91],v[70:71],v[70:71]
v_pk_mul_f32 v[92:93],v[76:77],v[76:77]
v_pk_mul_f32 v[94:95],v[78:79],v[78:79]
v_pk_fma_f32 v[88:89],v[88:89],v[124:125],v[126:127] op_sel:[0,1,0] op_sel_hi:[1,1,0]
v_pk_fma_f32 v[90:91],v[90:91],v[124:125],v[126:127] op_sel:[0,1,0] op_sel_hi:[1,1,0]
v_pk_fma_f32 v[92:93],v[92:93],v[124:125],v[126:127] op_sel:[0,1,0] op_sel_hi:[1,1,0]
v_pk_fma_f32 v[94:95],v[94:95],v[124:125],v[126:127] op_sel:[0,1,0] op_sel_hi:[1,1,0]
v_pk_mul_f32 v[88:89],v[88:89],v[68:69]
v_pk_mul_f32 v[90:91],v[90:91],v[70:71]
v_pk_mul_f32 v[92:93],v[92:93],v[76:77]
v_pk_mul_f32 v[94:95],v[94:95],v[78:79]
v_exp_f32 v88,v88
v_exp_f32 v89,v89
v_exp_f32 v90,v90
v_exp_f32 v91,v91
v_exp_f32 v92,v92
v_exp_f32 v93,v93
v_exp_f32 v94,v94
v_exp_f32 v95,v95
v_pk_fma_f32 v[88:89],v[88:89],v[126:127],v[126:127] op_sel:[0,1,1] op_sel_hi:[1,1,1]
v_pk_fma_f32 v[90:91],v[90:91],v[126:127],v[126:127] op_sel:[0,1,1] op_sel_hi:[1,1,1]
v_pk_fma_f32 v[92:93],v[92:93],v[126:127],v[126:127] op_sel:[0,1,1] op_sel_hi:[1,1,1]
v_pk_fma_f32 v[94:95],v[94:95],v[126:127],v[126:127] op_sel:[0,1,1] op_sel_hi:[1,1,1]
v_rcp_f32 v88,v88
v_rcp_f32 v89,v89
v_rcp_f32 v90,v90
v_rcp_f32 v91,v91
v_rcp_f32 v92,v92
v_rcp_f32 v93,v93
v_rcp_f32 v94,v94
v_rcp_f32 v95,v95
v_pk_mul_f32 v[88:89],v[88:89],v[68:69]
v_pk_mul_f32 v[90:91],v[90:91],v[70:71]
v_pk_mul_f32 v[92:93],v[92:93],v[76:77]
v_pk_mul_f32 v[94:95],v[94:95],v[78:79]
v_cvt_pk_bf16_f32 v96,v88,v89
v_cvt_pk_bf16_f32 v97,v90,v91
v_cvt_pk_bf16_f32 v98,v92,v93
v_cvt_pk_bf16_f32 v99,v94,v95
v_max_u32 v96,1,v96
buffer_store_dwordx4 v[96:99],v18,s[20:23],s70 offen offset:1024 sc1
s_cmp_gt_u32 s71,56
s_cselect_b32 s65,s73,0x7fff0000
v_mov_b32 v22,s71
buffer_store_dword v22,v23,s[20:23],s65 offen sc1
v_xor_b32 v17,0x10000,v17
v_xor_b32 v45,16,v45
v_xor_b32 v46,16,v46
s_xor_b32 s72,s72,0x10000
s_add_u32 s70,s70,2097152
s_xor_b32 s70,s70,0x2000
s_add_u32 s71,s71,1
s_cmp_le_u32 s71,65
s_cbranch_scc1 seg_270
s_endpgm
retry_269:
s_sub_u32 s90,s90,64
s_cmp_lt_i32 s90,0
s_cbranch_scc1 giveup_170
s_mov_b32 s83,1
s_waitcnt vmcnt(0) lgkmcnt(0)
s_barrier
s_branch seg_270
w3b_268:
s_add_u32 s64,s79,0
s_lshl_b32 s70,s64,21
s_lshl_b32 s64,s64,13
s_and_b32 s64,s64,0x2000
s_xor_b32 s64,s64,s62
s_add_u32 s70,s70,s64
s_add_u32 s70,s70,29360128
s_mov_b32 s83,1
s_mov_b32 s87,s74
s_cmp_eq_u32 s50,0
s_cselect_b32 s74,s74,0x7fff0000
v_mov_b32 v45,132096
s_lshl_b32 s64,s50,2
s_add_u32 s64,s64,132112
v_mov_b32 v46,s64
v_mov_b32 v2,0
v_mov_b32 v44,1
ds_write_b32 v45,v44
s_waitcnt lgkmcnt(0)
seg_280:
s_cmp_eq_u32 s83,0
s_cbranch_scc1 ahead_281
s_add_u32 s94,s70,s75
s_xor_b32 s95,s94,1024
s_xor_b32 s91,s72,0x10000
s_waitcnt lgkmcnt(0)
v_cmp_gt_u32 vcc,s71,v2
s_cbranch_vccz nb_284
s_waitcnt vmcnt(2)
v_cmp_gt_u32 vcc,s71,v29
s_cbranch_vccz nb_284
s_waitcnt vmcnt(0)
v_add_u32 v22,s71,-1
buffer_store_dword v22,v23,s[20:23],s73 offen sc1
s_cmp_lg_u32 s50,0
s_cbranch_scc1 nb_284
buffer_load_dword v32,v21,s[20:23],s74 offen sc1
s_sleep 2
pl_285:
buffer_load_dword v33,v21,s[20:23],s74 offen sc1
s_waitcnt vmcnt(1)
v_cmp_gt_u32 vcc,s71,v32
s_cbranch_vccz pok_286
buffer_load_dword v32,v21,s[20:23],s74 offen sc1
s_waitcnt vmcnt(1)
v_cmp_gt_u32 vcc,s71,v33
s_cbranch_vccz pok_286
s_sub_u32 s90,s90,1
s_cmp_gt_i32 s90,0
s_cbranch_scc1 pl_285
pok_286:
nb_284:
s_barrier
s_xor_b32 m0,s91,0
s_add_u32 s65,s94,0
buffer_load_dwordx4 v16,s[20:23],s65 offen offset:0 sc1 lds
buffer_load_dwordx4 v16,s[20:23],s65 offen offset:2048 sc1 lds
ds_read_b32 v44,v45
s_xor_b32 m0,s91,16384
s_add_u32 s65,s94,32768
buffer_load_dwordx4 v16,s[20:23],s65 offen offset:0 sc1 lds
buffer_load_dwordx4 v16,s[20:23],s65 offen offset:2048 sc1 lds
s_xor_b32 m0,s91,32768
s_add_u32 s65,s94,65536
buffer_load_dwordx4 v16,s[20:23],s65 offen offset:0 sc1 lds
buffer_load_dwordx4 v16,s[20:23],s65 offen offset:2048 sc1 lds
s_xor_b32 m0,s91,49152
s_add_u32 s65,s94,98304
buffer_load_dwordx4 v16,s[20:23],s65 offen offset:0 sc1 lds
buffer_load_dwordx4 v16,s[20:23],s65 offen offset:2048 sc1 lds
s_add_u32 s66,s94,110592
buffer_load_dwordx4 v[128:131],v16,s[20:23],s66 offen offset:0 sc1
buffer_load_dwordx4 v[132:135],v16,s[20:23],s66 offen offset:1024 sc1
buffer_load_dwordx4 v[136:139],v16,s[20:23],s66 offen offset:2048 sc1
buffer_load_dwordx4 v[140:143],v16,s[20:23],s66 offen offset:3072 sc1
s_add_u32 s66,s94,114688
buffer_load_dwordx4 v[144:147],v16,s[20:23],s66 offen offset:0 sc1
buffer_load_dwordx4 v[148:151],v16,s[20:23],s66 offen offset:1024 sc1
buffer_load_dwordx4 v[152:155],v16,s[20:23],s66 offen offset:2048 sc1
buffer_load_dwordx4 v[156:159],v16,s[20:23],s66 offen offset:3072 sc1
s_waitcnt lgkmcnt(0)
v_readfirstlane_b32 s83,v44
s_cmp_eq_u32 s83,0
s_cbranch_scc1 both_283
s_waitcnt vmcnt(14)
s_barrier
ds_read_b128 v[224:227],v17 offset:0
ds_read_b128 v[228:231],v17 offset:2048
ds_read_b128 v[232:235],v17 offset:4096
ds_read_b128 v[236:239],v17 offset:6144
ds_read_b128 v[240:243],v17 offset:8192
ds_read_b128 v[244:247],v17 offset:10240
ds_read_b128 v[248:251],v17 offset:12288
s_waitcnt lgkmcnt(5)
v_mfma_f32_16x16x32_bf16 v[64:67],a[0:3],v[224:227],0
ds_read_b128 v[252:255],v17 offset:14336
v_min_u32 v27,v224,v228
s_xor_b32 m0,s91,1024
s_add_u32 s65,s95,0
buffer_load_dwordx4 v16,s[20:23],s65 offen offset:0 sc1 lds
v_mfma_f32_16x16x32_bf16 v[72:75],a[4:7],v[228:231],0
s_waitcnt vmcnt(13)
s_barrier
ds_read_b128 v[224:227],v17 offset:16384
buffer_load_dwordx4 v16,s[20:23],s65 offen offset:2048 sc1 lds
s_xor_b32 m0,s91,17408
s_waitcnt lgkmcnt(5)
v_mfma_f32_16x16x32_bf16 v[64:67],a[8:11],v[232:235],v[64:67]
ds_read_b128 v[228:231],v17 offset:18432
v_min3_u32 v27,v27,v232,v236
s_add_u32 s65,s95,32768
buffer_load_dwordx4 v16,s[20:23],s65 offen offset:0 sc1 lds
buffer_load_dwordx4 v16,s[20:23],s65 offen offset:2048 sc1 lds
v_mfma_f32_16x16x32_bf16 v[72:75],a[12:15],v[236:239],v[72:75]
ds_read_b128 v[232:235],v17 offset:20480
s_xor_b32 m0,s91,33792
s_add_u32 s65,s95,65536
buffer_load_dwordx4 v16,s[20:23],s65 offen offset:0 sc1 lds
s_waitcnt lgkmcnt(5)
v_mfma_f32_16x16x32_bf16 v[64:67],a[16:19],v[240:243],v[64:67]
ds_read_b128 v[236:239],v17 offset:22528
v_min3_u32 v27,v27,v240,v244
buffer_load_dwordx4 v16,s[20:23],s65 offen offset:2048 sc1 lds
s_xor_b32 m0,s91,50176
s_add_u32 s65,s95,98304
v_mfma_f32_16x16x32_bf16 v[72:75],a[20:23],v[244:247],v[72:75]
ds_read_b128 v[240:243],v17 offset:24576
buffer_load_dwordx4 v16,s[20:23],s65 offen offset:0 sc1 lds
buffer_load_dwordx4 v16,s[20:23],s65 offen offset:2048 sc1 lds
s_waitcnt lgkmcnt(5)
v_mfma_f32_16x16x32_bf16 v[64:67],a[24:27],v[248:251],v[64:67]
ds_read_b128 v[244:247],v17 offset:26624
v_min3_u32 v27,v27,v248,v252
v_mfma_f32_16x16x32_bf16 v[72:75],a[28:31],v[252:255],v[72:75]
ds_read_b128 v[248:251],v17 offset:28672
s_waitcnt lgkmcnt(5)
v_mfma_f32_16x16x32_bf16 v[64:67],a[32:35],v[224:227],v[64:67]
ds_read_b128 v[252:255],v17 offset:30720
v_min3_u32 v27,v27,v224,v228
v_mfma_f32_16x16x32_bf16 v[72:75],a[36:39],v[228:231],v[72:75]
s_waitcnt vmcnt(16)
s_barrier
ds_read_b128 v[224:227],v17 offset:32768
s_waitcnt lgkmcnt(5)
v_mfma_f32_16x16x32_bf16 v[64:67],a[40:43],v[232:235],v[64:67]
ds_read_b128 v[228:231],v17 offset:34816
v_min3_u32 v27,v27,v232,v236
v_mfma_f32_16x16x32_bf16 v[72:75],a[44:47],v[236:239],v[72:75]
ds_read_b128 v[232:235],v17 offset:36864
s_waitcnt lgkmcnt(5)
v_mfma_f32_16x16x32_bf16 v[64:67],a[48:51],v[240:243],v[64:67]
ds_read_b128 v[236:239],v17 offset:38912
v_min3_u32 v27,v27,v240,v244
v_mfma_f32_16x16x32_bf16 v[72:75],a[52:55],v[244:247],v[72:75]
ds_read_b128 v[240:243],v17 offset:40960
s_waitcnt lgkmcnt(5)
v_mfma_f32_16x16x32_bf16 v[64:67],a[56:59],v[248:251],v[64:67]
ds_read_b128 v[244:247],v17 offset:43008
v_min3_u32 v27,v27,v248,v252
v_mfma_f32_16x16x32_bf16 v[72:75],a[60:63],v[252:255],v[72:75]
ds_read_b128 v[248:251],v17 offset:45056
s_waitcnt lgkmcnt(5)
v_mfma_f32_16x16x32_bf16 v[64:67],a[64:67],v[224:227],v[64:67]
ds_read_b128 v[252:255],v17 offset:47104
v_min3_u32 v27,v27,v224,v228
v_mfma_f32_16x16x32_bf16 v[72:75],a[68:71],v[228:231],v[72:75]
ds_read_b128 v[224:227],v17 offset:49152
s_waitcnt lgkmcnt(5)
v_mfma_f32_16x16x32_bf16 v[64:67],a[72:75],v[232:235],v[64:67]
ds_read_b128 v[228:231],v17 offset:51200
v_min3_u32 v27,v27,v232,v236
v_mfma_f32_16x16x32_bf16 v[72:75],a[76:79],v[236:239],v[72:75]
ds_read_b128 v[232:235],v17 offset:53248
s_waitcnt lgkmcnt(5)
v_mfma_f32_16x16x32_bf16 v[64:67],a[80:83],v[240:243],v[64:67]
ds_read_b128 v[236:239],v17 offset:55296
v_min3_u32 v27,v27,v240,v244
s_add_u32 s92,s70,8388608
s_sub_u32 s93,s71,53
s_cmp_lt_u32 s93,9
s_cselect_b32 s92,s92,0x7fff0000
v_mfma_f32_16x16x32_bf16 v[72:75],a[84:87],v[244:247],v[72:75]
ds_read_b128 v[240:243],v17 offset:57344
s_waitcnt lgkmcnt(5)
v_mfma_f32_16x16x32_bf16 v[64:67],a[88:91],v[248:251],v[64:67]
ds_read_b128 v[244:247],v17 offset:59392
v_min3_u32 v27,v27,v248,v252
v_mfma_f32_16x16x32_bf16 v[72:75],a[92:95],v[252:255],v[72:75]
ds_read_b128 v[248:251],v17 offset:61440
s_waitcnt vmcnt(8)
stk_289:
v_min3_u32 v22,v129,v133,v137
v_min3_u32 v22,v22,v141,v145
v_min3_u32 v22,v22,v149,v153
v_min_u32 v22,v22,v157
v_cmp_eq_u32 vcc,0,v22
s_cmp_lt_i32 s90,0
s_cselect_b64 vcc,0,vcc
s_cbranch_vccnz str_290
v_pk_add_f32 v[88:89],v[128:129],v[144:145]
v_pk_add_f32 v[90:91],v[130:131],v[146:147]
v_pk_add_f32 v[92:93],v[132:133],v[148:149]
v_pk_add_f32 v[94:95],v[134:135],v[150:151]
v_pk_add_f32 v[96:97],v[136:137],v[152:153]
v_pk_add_f32 v[98:99],v[138:139],v[154:155]
v_pk_add_f32 v[100:101],v[140:141],v[156:157]
v_pk_add_f32 v[102:103],v[142:143],v[158:159]
v_pk_add_f32 v[88:89],v[88:89],v[96:97]
v_pk_add_f32 v[90:91],v[90:91],v[98:99]
v_pk_add_f32 v[92:93],v[92:93],v[100:101]
v_pk_add_f32 v[94:95],v[94:95],v[102:103]
v_pk_add_f32 v[88:89],v[88:89],v[92:93]
v_pk_add_f32 v[90:91],v[90:91],v[94:95]
v_mov_b32 v92,v88
v_mov_b32 v93,v89
v_mov_b32 v94,v90
v_mov_b32 v95,v91
v_permlane16_swap_b32 v92,v88
v_permlane16_swap_b32 v93,v89
v_permlane16_swap_b32 v94,v90
v_permlane16_swap_b32 v95,v91
v_pk_add_f32 v[88:89],v[88:89],v[92:93]
v_pk_add_f32 v[90:91],v[90:91],v[94:95]
v_mov_b32 v92,v88
v_mov_b32 v93,v89
s_waitcnt lgkmcnt(5)
v_mfma_f32_16x16x32_bf16 v[64:67],a[96:99],v[224:227],v[64:67]
ds_read_b128 v[252:255],v17 offset:63488
v_min3_u32 v27,v27,v224,v228
v_mov_b32 v94,v90
v_mov_b32 v95,v91
v_permlane32_swap_b32 v92,v88
v_permlane32_swap_b32 v93,v89
v_permlane32_swap_b32 v94,v90
v_permlane32_swap_b32 v95,v91
v_pk_add_f32 v[88:89],v[88:89],v[92:93]
v_pk_add_f32 v[90:91],v[90:91],v[94:95]
v_mul_f32 v120,0xba800000,v88
v_mul_f32 v124,0xba800000,v90
v_mul_f32 v92,v120,v120
v_mul_f32 v93,v124,v124
v_fma_f32 v92,v89,s82,-v92
v_fma_f32 v93,v91,s82,-v93
v_max_f32 v92,0,v92
v_max_f32 v93,0,v93
v_add_f32 v92,0x3727c5ac,v92
v_add_f32 v93,0x3727c5ac,v93
v_rsq_f32 v94,v92
v_rsq_f32 v95,v93
v_mul_f32 v123,v92,v94
v_mul_f32 v127,v93,v95
v_mul_f32 v122,v28,v94
v_mul_f32 v126,v28,v95
v_mul_f32 v92,v94,v94
v_mul_f32 v93,v95,v95
v_mul_f32 v94,s81,v94
v_mul_f32 v95,s81,v95
v_mul_f32 v121,v92,v94
v_mul_f32 v125,v93,v95
ds_write_b128 v19,v[120:123] offset:0
ds_write_b128 v19,v[124:127] offset:256
v_mfma_f32_16x16x32_bf16 v[72:75],a[100:103],v[228:231],v[72:75]
s_waitcnt vmcnt(0) lgkmcnt(0)
s_barrier
ds_read_b128 v[224:227],v17 offset:1024
v_mfma_f32_16x16x32_bf16 v[64:67],a[104:107],v[232:235],v[64:67]
ds_read_b128 v[228:231],v17 offset:3072
v_min3_u32 v27,v27,v232,v236
v_add_u32 v22,s71,-1
buffer_store_dword v22,v23,s[20:23],s73 offen sc1
v_mfma_f32_16x16x32_bf16 v[72:75],a[108:111],v[236:239],v[72:75]
ds_read_b128 v[232:235],v17 offset:5120
v_mfma_f32_16x16x32_bf16 v[64:67],a[112:115],v[240:243],v[64:67]
ds_read_b128 v[236:239],v17 offset:7168
v_min3_u32 v27,v27,v240,v244
v_mfma_f32_16x16x32_bf16 v[72:75],a[116:119],v[244:247],v[72:75]
ds_read_b128 v[240:243],v17 offset:9216
v_mfma_f32_16x16x32_bf16 v[64:67],a[120:123],v[248:251],v[64:67]
ds_read_b128 v[244:247],v17 offset:11264
v_min3_u32 v27,v27,v248,v252
v_mfma_f32_16x16x32_bf16 v[72:75],a[124:127],v[252:255],v[72:75]
ds_read_b128 v[248:251],v17 offset:13312
buffer_load_dword v2,v21,s[20:23],s87 offen sc1
s_add_u32 s96,s71,2
s_waitcnt lgkmcnt(5)
v_mfma_f32_16x16x32_bf16 v[68:71],a[0:3],v[224:227],0
ds_read_b128 v[252:255],v17 offset:15360
v_cmp_eq_u32 vcc,0,v27
s_cbranch_vccnz retry_279
v_min3_u32 v27,v27,v224,v228
s_cmp_gt_u32 s96,56
s_addc_u32 s96,s96,0
v_mfma_f32_16x16x32_bf16 v[76:79],a[4:7],v[228:231],0
ds_read_b128 v[224:227],v17 offset:17408
s_waitcnt lgkmcnt(5)
v_mfma_f32_16x16x32_bf16 v[68:71],a[8:11],v[232:235],v[68:71]
ds_read_b128 v[228:231],v17 offset:19456
v_min3_u32 v27,v27,v232,v236
v_mfma_f32_16x16x32_bf16 v[76:79],a[12:15],v[236:239],v[76:79]
ds_read_b128 v[232:235],v17 offset:21504
s_waitcnt lgkmcnt(5)
v_mfma_f32_16x16x32_bf16 v[68:71],a[16:19],v[240:243],v[68:71]
ds_read_b128 v[236:239],v17 offset:23552
v_min3_u32 v27,v27,v240,v244
v_add_f32 v64,v64,v72
v_add_f32 v65,v65,v73
v_add_f32 v66,v66,v74
v_add_f32 v67,v67,v75
v_mfma_f32_16x16x32_bf16 v[76:79],a[20:23],v[244:247],v[76:79]
ds_read_b128 v[240:243],v17 offset:25600
v_fmac_f32 v64,v52,v120
v_fmac_f32 v65,v53,v120
v_fmac_f32 v66,v54,v120
v_fmac_f32 v67,v55,v120
s_waitcnt lgkmcnt(5)
v_mfma_f32_16x16x32_bf16 v[68:71],a[24:27],v[248:251],v[68:71]
ds_read_b128 v[244:247],v17 offset:27648
v_min3_u32 v27,v27,v248,v252
buffer_store_dwordx2 v[48:49],v18,s[20:23],s92 offen offset:0 sc1
buffer_store_dwordx2 v[48:49],v18,s[20:23],s92 offen offset:1024 sc1
v_mfma_f32_16x16x32_bf16 v[76:79],a[28:31],v[252:255],v[76:79]
ds_read_b128 v[248:251],v17 offset:29696
v_mul_f32 v88,v64,v64
v_mul_f32 v89,v65,v65
v_mul_f32 v90,v66,v66
v_mul_f32 v91,v67,v67
s_waitcnt lgkmcnt(5)
v_mfma_f32_16x16x32_bf16 v[68:71],a[32:35],v[224:227],v[68:71]
ds_read_b128 v[252:255],v17 offset:31744
v_min3_u32 v27,v27,v224,v228
v_fma_f32 v88,v88,v121,v122
v_fma_f32 v89,v89,v121,v122
v_fma_f32 v90,v90,v121,v122
v_fma_f32 v91,v91,v121,v122
v_mfma_f32_16x16x32_bf16 v[76:79],a[36:39],v[228:231],v[76:79]
ds_read_b128 v[224:227],v17 offset:33792
v_mul_f32 v88,v88,v64
v_mul_f32 v89,v89,v65
v_mul_f32 v90,v90,v66
v_mul_f32 v91,v91,v67
s_waitcnt lgkmcnt(5)
v_mfma_f32_16x16x32_bf16 v[68:71],a[40:43],v[232:235],v[68:71]
ds_read_b128 v[228:231],v17 offset:35840
v_min3_u32 v27,v27,v232,v236
v_exp_f32 v88,v88
v_exp_f32 v89,v89
v_mfma_f32_16x16x32_bf16 v[76:79],a[44:47],v[236:239],v[76:79]
ds_read_b128 v[232:235],v17 offset:37888
v_exp_f32 v90,v90
v_exp_f32 v91,v91
s_waitcnt lgkmcnt(5)
v_mfma_f32_16x16x32_bf16 v[68:71],a[48:51],v[240:243],v[68:71]
ds_read_b128 v[236:239],v17 offset:39936
v_min3_u32 v27,v27,v240,v244
v_fma_f32 v88,v88,v123,v123
v_fma_f32 v89,v89,v123,v123
v_fma_f32 v90,v90,v123,v123
v_fma_f32 v91,v91,v123,v123
v_mfma_f32_16x16x32_bf16 v[76:79],a[52:55],v[244:247],v[76:79]
ds_read_b128 v[240:243],v17 offset:41984
v_rcp_f32 v88,v88
v_rcp_f32 v89,v89
s_waitcnt lgkmcnt(5)
v_mfma_f32_16x16x32_bf16 v[68:71],a[56:59],v[248:251],v[68:71]
ds_read_b128 v[244:247],v17 offset:44032
v_min3_u32 v27,v27,v248,v252
v_rcp_f32 v90,v90
v_rcp_f32 v91,v91
v_mfma_f32_16x16x32_bf16 v[76:79],a[60:63],v[252:255],v[76:79]
ds_read_b128 v[248:251],v17 offset:46080
v_mul_f32 v88,v88,v64
v_mul_f32 v89,v89,v65
v_mul_f32 v90,v90,v66
v_mul_f32 v91,v91,v67
s_waitcnt lgkmcnt(5)
v_mfma_f32_16x16x32_bf16 v[68:71],a[64:67],v[224:227],v[68:71]
ds_read_b128 v[252:255],v17 offset:48128
v_min3_u32 v27,v27,v224,v228
v_cvt_pk_bf16_f32 v96,v88,v89
v_cvt_pk_bf16_f32 v97,v90,v91
v_max_u32 v96,1,v96
v_mfma_f32_16x16x32_bf16 v[76:79],a[68:71],v[228:231],v[76:79]
ds_read_b128 v[224:227],v17 offset:50176
buffer_store_dwordx2 v[96:97],v18,s[20:23],s70 offen offset:0 sc1
s_waitcnt lgkmcnt(5)
v_mfma_f32_16x16x32_bf16 v[68:71],a[72:75],v[232:235],v[68:71]
ds_read_b128 v[228:231],v17 offset:52224
v_min3_u32 v27,v27,v232,v236
v_mfma_f32_16x16x32_bf16 v[76:79],a[76:79],v[236:239],v[76:79]
ds_read_b128 v[232:235],v17 offset:54272
s_waitcnt lgkmcnt(5)
v_mfma_f32_16x16x32_bf16 v[68:71],a[80:83],v[240:243],v[68:71]
ds_read_b128 v[236:239],v17 offset:56320
v_min3_u32 v27,v27,v240,v244
v_mfma_f32_16x16x32_bf16 v[76:79],a[84:87],v[244:247],v[76:79]
ds_read_b128 v[240:243],v17 offset:58368
s_waitcnt lgkmcnt(5)
v_mfma_f32_16x16x32_bf16 v[68:71],a[88:91],v[248:251],v[68:71]
ds_read_b128 v[244:247],v17 offset:60416
v_min3_u32 v27,v27,v248,v252
v_mfma_f32_16x16x32_bf16 v[76:79],a[92:95],v[252:255],v[76:79]
ds_read_b128 v[248:251],v17 offset:62464
s_waitcnt lgkmcnt(5)
v_mfma_f32_16x16x32_bf16 v[68:71],a[96:99],v[224:227],v[68:71]
ds_read_b128 v[252:255],v17 offset:64512
v_min3_u32 v27,v27,v224,v228
v_mfma_f32_16x16x32_bf16 v[76:79],a[100:103],v[228:231],v[76:79]
s_waitcnt lgkmcnt(4)
v_mfma_f32_16x16x32_bf16 v[68:71],a[104:107],v[232:235],v[68:71]
v_min3_u32 v27,v27,v232,v236
s_waitcnt vmcnt(3)
v_cmp_gt_u32 vcc,s96,v2
s_mov_b32 s96,vcc_lo
v_mov_b32 v44,s96
ds_write_b32 v46,v44
v_mfma_f32_16x16x32_bf16 v[76:79],a[108:111],v[236:239],v[76:79]
s_waitcnt lgkmcnt(3)
v_mfma_f32_16x16x32_bf16 v[68:71],a[112:115],v[240:243],v[68:71]
v_min3_u32 v27,v27,v240,v244
v_mfma_f32_16x16x32_bf16 v[76:79],a[116:119],v[244:247],v[76:79]
s_waitcnt lgkmcnt(1)
v_mfma_f32_16x16x32_bf16 v[68:71],a[120:123],v[248:251],v[68:71]
v_min3_u32 v27,v27,v248,v252
v_mfma_f32_16x16x32_bf16 v[76:79],a[124:127],v[252:255],v[76:79]
v_cmp_eq_u32 vcc,0,v27
s_cbranch_vccnz retry_279
s_branch epi_282
both_283:
s_waitcnt vmcnt(14)
s_barrier
ds_read_b128 v[224:227],v17 offset:0
ds_read_b128 v[228:231],v17 offset:2048
ds_read_b128 v[232:235],v17 offset:4096
ds_read_b128 v[236:239],v17 offset:6144
ds_read_b128 v[240:243],v17 offset:8192
ds_read_b128 v[244:247],v17 offset:10240
ds_read_b128 v[248:251],v17 offset:12288
s_waitcnt lgkmcnt(5)
v_mfma_f32_16x16x32_bf16 v[64:67],a[0:3],v[224:227],0
ds_read_b128 v[252:255],v17 offset:14336
v_min_u32 v27,v224,v228
s_xor_b32 m0,s91,1024
s_add_u32 s65,s95,0
buffer_load_dwordx4 v16,s[20:23],s65 offen offset:0 sc1 lds
s_add_u32 s88,s70,s75
v_mfma_f32_16x16x32_bf16 v[72:75],a[4:7],v[228:231],0
s_waitcnt vmcnt(13)
s_barrier
ds_read_b128 v[224:227],v17 offset:16384
buffer_load_dwordx4 v16,s[20:23],s65 offen offset:2048 sc1 lds
s_xor_b32 m0,s91,17408
s_waitcnt lgkmcnt(5)
v_mfma_f32_16x16x32_bf16 v[64:67],a[8:11],v[232:235],v[64:67]
ds_read_b128 v[228:231],v17 offset:18432
v_min3_u32 v27,v27,v232,v236
s_add_u32 s65,s95,32768
buffer_load_dwordx4 v16,s[20:23],s65 offen offset:0 sc1 lds
buffer_load_dwordx4 v16,s[20:23],s65 offen offset:2048 sc1 lds
v_mfma_f32_16x16x32_bf16 v[72:75],a[12:15],v[236:239],v[72:75]
ds_read_b128 v[232:235],v17 offset:20480
s_xor_b32 m0,s91,33792
s_add_u32 s65,s95,65536
buffer_load_dwordx4 v16,s[20:23],s65 offen offset:0 sc1 lds
s_add_u32 s88,s88,2097152
s_waitcnt lgkmcnt(5)
v_mfma_f32_16x16x32_bf16 v[64:67],a[16:19],v[240:243],v[64:67]
ds_read_b128 v[236:239],v17 offset:22528
v_min3_u32 v27,v27,v240,v244
buffer_load_dwordx4 v16,s[20:23],s65 offen offset:2048 sc1 lds
s_xor_b32 m0,s91,50176
s_add_u32 s65,s95,98304
s_xor_b32 s88,s88,0x2000
v_mfma_f32_16x16x32_bf16 v[72:75],a[20:23],v[244:247],v[72:75]
ds_read_b128 v[240:243],v17 offset:24576
buffer_load_dwordx4 v16,s[20:23],s65 offen offset:0 sc1 lds
buffer_load_dwordx4 v16,s[20:23],s65 offen offset:2048 sc1 lds
s_xor_b32 s89,s88,1024
s_waitcnt lgkmcnt(5)
v_mfma_f32_16x16x32_bf16 v[64:67],a[24:27],v[248:251],v[64:67]
ds_read_b128 v[244:247],v17 offset:26624
v_min3_u32 v27,v27,v248,v252
v_mfma_f32_16x16x32_bf16 v[72:75],a[28:31],v[252:255],v[72:75]
ds_read_b128 v[248:251],v17 offset:28672
s_waitcnt lgkmcnt(5)
v_mfma_f32_16x16x32_bf16 v[64:67],a[32:35],v[224:227],v[64:67]
ds_read_b128 v[252:255],v17 offset:30720
v_min3_u32 v27,v27,v224,v228
v_mfma_f32_16x16x32_bf16 v[72:75],a[36:39],v[228:231],v[72:75]
s_waitcnt vmcnt(16)
s_barrier
ds_read_b128 v[224:227],v17 offset:32768
s_waitcnt lgkmcnt(5)
v_mfma_f32_16x16x32_bf16 v[64:67],a[40:43],v[232:235],v[64:67]
ds_read_b128 v[228:231],v17 offset:34816
v_min3_u32 v27,v27,v232,v236
v_mfma_f32_16x16x32_bf16 v[72:75],a[44:47],v[236:239],v[72:75]
ds_read_b128 v[232:235],v17 offset:36864
s_waitcnt lgkmcnt(5)
v_mfma_f32_16x16x32_bf16 v[64:67],a[48:51],v[240:243],v[64:67]
ds_read_b128 v[236:239],v17 offset:38912
v_min3_u32 v27,v27,v240,v244
v_mfma_f32_16x16x32_bf16 v[72:75],a[52:55],v[244:247],v[72:75]
ds_read_b128 v[240:243],v17 offset:40960
s_waitcnt lgkmcnt(5)
v_mfma_f32_16x16x32_bf16 v[64:67],a[56:59],v[248:251],v[64:67]
ds_read_b128 v[244:247],v17 offset:43008
v_min3_u32 v27,v27,v248,v252
v_mfma_f32_16x16x32_bf16 v[72:75],a[60:63],v[252:255],v[72:75]
ds_read_b128 v[248:251],v17 offset:45056
s_waitcnt lgkmcnt(5)
v_mfma_f32_16x16x32_bf16 v[64:67],a[64:67],v[224:227],v[64:67]
ds_read_b128 v[252:255],v17 offset:47104
v_min3_u32 v27,v27,v224,v228
v_mfma_f32_16x16x32_bf16 v[72:75],a[68:71],v[228:231],v[72:75]
ds_read_b128 v[224:227],v17 offset:49152
s_waitcnt lgkmcnt(5)
v_mfma_f32_16x16x32_bf16 v[64:67],a[72:75],v[232:235],v[64:67]
ds_read_b128 v[228:231],v17 offset:51200
v_min3_u32 v27,v27,v232,v236
v_mfma_f32_16x16x32_bf16 v[72:75],a[76:79],v[236:239],v[72:75]
ds_read_b128 v[232:235],v17 offset:53248
s_waitcnt lgkmcnt(5)
v_mfma_f32_16x16x32_bf16 v[64:67],a[80:83],v[240:243],v[64:67]
ds_read_b128 v[236:239],v17 offset:55296
v_min3_u32 v27,v27,v240,v244
s_add_u32 s92,s70,8388608
s_sub_u32 s93,s71,53
s_cmp_lt_u32 s93,9
s_cselect_b32 s92,s92,0x7fff0000
v_mfma_f32_16x16x32_bf16 v[72:75],a[84:87],v[244:247],v[72:75]
ds_read_b128 v[240:243],v17 offset:57344
s_waitcnt lgkmcnt(5)
v_mfma_f32_16x16x32_bf16 v[64:67],a[88:91],v[248:251],v[64:67]
ds_read_b128 v[244:247],v17 offset:59392
v_min3_u32 v27,v27,v248,v252
v_mfma_f32_16x16x32_bf16 v[72:75],a[92:95],v[252:255],v[72:75]
ds_read_b128 v[248:251],v17 offset:61440
s_waitcnt vmcnt(8)
stk_291:
v_min3_u32 v22,v129,v133,v137
v_min3_u32 v22,v22,v141,v145
v_min3_u32 v22,v22,v149,v153
v_min_u32 v22,v22,v157
v_cmp_eq_u32 vcc,0,v22
s_cmp_lt_i32 s90,0
s_cselect_b64 vcc,0,vcc
s_cbranch_vccnz str_292
v_pk_add_f32 v[88:89],v[128:129],v[144:145]
v_pk_add_f32 v[90:91],v[130:131],v[146:147]
v_pk_add_f32 v[92:93],v[132:133],v[148:149]
v_pk_add_f32 v[94:95],v[134:135],v[150:151]
v_pk_add_f32 v[96:97],v[136:137],v[152:153]
v_pk_add_f32 v[98:99],v[138:139],v[154:155]
v_pk_add_f32 v[100:101],v[140:141],v[156:157]
v_pk_add_f32 v[102:103],v[142:143],v[158:159]
v_pk_add_f32 v[88:89],v[88:89],v[96:97]
v_pk_add_f32 v[90:91],v[90:91],v[98:99]
v_pk_add_f32 v[92:93],v[92:93],v[100:101]
v_pk_add_f32 v[94:95],v[94:95],v[102:103]
v_pk_add_f32 v[88:89],v[88:89],v[92:93]
v_pk_add_f32 v[90:91],v[90:91],v[94:95]
v_mov_b32 v92,v88
v_mov_b32 v93,v89
v_mov_b32 v94,v90
v_mov_b32 v95,v91
v_permlane16_swap_b32 v92,v88
v_permlane16_swap_b32 v93,v89
v_permlane16_swap_b32 v94,v90
v_permlane16_swap_b32 v95,v91
v_pk_add_f32 v[88:89],v[88:89],v[92:93]
v_pk_add_f32 v[90:91],v[90:91],v[94:95]
v_mov_b32 v92,v88
v_mov_b32 v93,v89
s_waitcnt lgkmcnt(5)
v_mfma_f32_16x16x32_bf16 v[64:67],a[96:99],v[224:227],v[64:67]
ds_read_b128 v[252:255],v17 offset:63488
v_min3_u32 v27,v27,v224,v228
v_mov_b32 v94,v90
v_mov_b32 v95,v91
v_permlane32_swap_b32 v92,v88
v_permlane32_swap_b32 v93,v89
v_permlane32_swap_b32 v94,v90
v_permlane32_swap_b32 v95,v91
v_pk_add_f32 v[88:89],v[88:89],v[92:93]
v_pk_add_f32 v[90:91],v[90:91],v[94:95]
v_mul_f32 v120,0xba800000,v88
v_mul_f32 v124,0xba800000,v90
v_mul_f32 v92,v120,v120
v_mul_f32 v93,v124,v124
v_fma_f32 v92,v89,s82,-v92
v_fma_f32 v93,v91,s82,-v93
v_max_f32 v92,0,v92
v_max_f32 v93,0,v93
v_add_f32 v92,0x3727c5ac,v92
v_add_f32 v93,0x3727c5ac,v93
v_rsq_f32 v94,v92
v_rsq_f32 v95,v93
v_mul_f32 v123,v92,v94
v_mul_f32 v127,v93,v95
v_mul_f32 v122,v28,v94
v_mul_f32 v126,v28,v95
v_mul_f32 v92,v94,v94
v_mul_f32 v93,v95,v95
v_mul_f32 v94,s81,v94
v_mul_f32 v95,s81,v95
v_mul_f32 v121,v92,v94
v_mul_f32 v125,v93,v95
ds_write_b128 v19,v[120:123] offset:0
ds_write_b128 v19,v[124:127] offset:256
v_mfma_f32_16x16x32_bf16 v[72:75],a[100:103],v[228:231],v[72:75]
s_waitcnt vmcnt(0) lgkmcnt(0)
s_barrier
ds_read_b128 v[224:227],v17 offset:1024
v_mfma_f32_16x16x32_bf16 v[64:67],a[104:107],v[232:235],v[64:67]
ds_read_b128 v[228:231],v17 offset:3072
v_min3_u32 v27,v27,v232,v236
v_add_u32 v22,s71,-1
buffer_store_dword v22,v23,s[20:23],s73 offen sc1
v_mfma_f32_16x16x32_bf16 v[72:75],a[108:111],v[236:239],v[72:75]
ds_read_b128 v[232:235],v17 offset:5120
s_add_u32 s66,s88,110592
buffer_load_dwordx4 v[128:131],v16,s[20:23],s66 offen offset:0 sc1
v_mfma_f32_16x16x32_bf16 v[64:67],a[112:115],v[240:243],v[64:67]
ds_read_b128 v[236:239],v17 offset:7168
v_min3_u32 v27,v27,v240,v244
buffer_load_dwordx4 v[132:135],v16,s[20:23],s66 offen offset:1024 sc1
buffer_load_dwordx4 v[136:139],v16,s[20:23],s66 offen offset:2048 sc1
v_mfma_f32_16x16x32_bf16 v[72:75],a[116:119],v[244:247],v[72:75]
ds_read_b128 v[240:243],v17 offset:9216
buffer_load_dwordx4 v[140:143],v16,s[20:23],s66 offen offset:3072 sc1
v_mfma_f32_16x16x32_bf16 v[64:67],a[120:123],v[248:251],v[64:67]
ds_read_b128 v[244:247],v17 offset:11264
v_min3_u32 v27,v27,v248,v252
s_add_u32 s66,s88,114688
buffer_load_dwordx4 v[144:147],v16,s[20:23],s66 offen offset:0 sc1
v_mfma_f32_16x16x32_bf16 v[72:75],a[124:127],v[252:255],v[72:75]
ds_read_b128 v[248:251],v17 offset:13312
buffer_load_dword v2,v21,s[20:23],s87 offen sc1
s_add_u32 s96,s71,2
s_waitcnt lgkmcnt(5)
v_mfma_f32_16x16x32_bf16 v[68:71],a[0:3],v[224:227],0
ds_read_b128 v[252:255],v17 offset:15360
v_cmp_eq_u32 vcc,0,v27
s_cbranch_vccnz retry_279
v_min3_u32 v27,v27,v224,v228
s_cmp_gt_u32 s96,56
s_addc_u32 s96,s96,0
v_mfma_f32_16x16x32_bf16 v[76:79],a[4:7],v[228:231],0
ds_read_b128 v[224:227],v17 offset:17408
buffer_load_dwordx4 v[148:151],v16,s[20:23],s66 offen offset:1024 sc1
buffer_load_dwordx4 v[152:155],v16,s[20:23],s66 offen offset:2048 sc1
s_waitcnt lgkmcnt(5)
v_mfma_f32_16x16x32_bf16 v[68:71],a[8:11],v[232:235],v[68:71]
ds_read_b128 v[228:231],v17 offset:19456
v_min3_u32 v27,v27,v232,v236
buffer_load_dwordx4 v[156:159],v16,s[20:23],s66 offen offset:3072 sc1
s_xor_b32 m0,s72,0
s_add_u32 s65,s88,0
v_mfma_f32_16x16x32_bf16 v[76:79],a[12:15],v[236:239],v[76:79]
ds_read_b128 v[232:235],v17 offset:21504
buffer_load_dwordx4 v16,s[20:23],s65 offen offset:0 sc1 lds
buffer_load_dwordx4 v16,s[20:23],s65 offen offset:2048 sc1 lds
s_waitcnt lgkmcnt(5)
v_mfma_f32_16x16x32_bf16 v[68:71],a[16:19],v[240:243],v[68:71]
ds_read_b128 v[236:239],v17 offset:23552
v_min3_u32 v27,v27,v240,v244
v_add_f32 v64,v64,v72
v_add_f32 v65,v65,v73
v_add_f32 v66,v66,v74
v_add_f32 v67,v67,v75
v_mfma_f32_16x16x32_bf16 v[76:79],a[20:23],v[244:247],v[76:79]
ds_read_b128 v[240:243],v17 offset:25600
v_fmac_f32 v64,v52,v120
v_fmac_f32 v65,v53,v120
v_fmac_f32 v66,v54,v120
v_fmac_f32 v67,v55,v120
s_waitcnt lgkmcnt(5)
v_mfma_f32_16x16x32_bf16 v[68:71],a[24:27],v[248:251],v[68:71]
ds_read_b128 v[244:247],v17 offset:27648
v_min3_u32 v27,v27,v248,v252
buffer_store_dwordx2 v[48:49],v18,s[20:23],s92 offen offset:0 sc1
buffer_store_dwordx2 v[48:49],v18,s[20:23],s92 offen offset:1024 sc1
v_mfma_f32_16x16x32_bf16 v[76:79],a[28:31],v[252:255],v[76:79]
ds_read_b128 v[248:251],v17 offset:29696
v_mul_f32 v88,v64,v64
v_mul_f32 v89,v65,v65
v_mul_f32 v90,v66,v66
v_mul_f32 v91,v67,v67
s_waitcnt lgkmcnt(5)
v_mfma_f32_16x16x32_bf16 v[68:71],a[32:35],v[224:227],v[68:71]
ds_read_b128 v[252:255],v17 offset:31744
v_min3_u32 v27,v27,v224,v228
v_fma_f32 v88,v88,v121,v122
v_fma_f32 v89,v89,v121,v122
v_fma_f32 v90,v90,v121,v122
v_fma_f32 v91,v91,v121,v122
v_mfma_f32_16x16x32_bf16 v[76:79],a[36:39],v[228:231],v[76:79]
ds_read_b128 v[224:227],v17 offset:33792
v_mul_f32 v88,v88,v64
v_mul_f32 v89,v89,v65
v_mul_f32 v90,v90,v66
v_mul_f32 v91,v91,v67
s_waitcnt lgkmcnt(5)
v_mfma_f32_16x16x32_bf16 v[68:71],a[40:43],v[232:235],v[68:71]
ds_read_b128 v[228:231],v17 offset:35840
v_min3_u32 v27,v27,v232,v236
v_exp_f32 v88,v88
v_exp_f32 v89,v89
v_mfma_f32_16x16x32_bf16 v[76:79],a[44:47],v[236:239],v[76:79]
ds_read_b128 v[232:235],v17 offset:37888
v_exp_f32 v90,v90
v_exp_f32 v91,v91
s_waitcnt lgkmcnt(5)
v_mfma_f32_16x16x32_bf16 v[68:71],a[48:51],v[240:243],v[68:71]
ds_read_b128 v[236:239],v17 offset:39936
v_min3_u32 v27,v27,v240,v244
v_fma_f32 v88,v88,v123,v123
v_fma_f32 v89,v89,v123,v123
v_fma_f32 v90,v90,v123,v123
v_fma_f32 v91,v91,v123,v123
v_mfma_f32_16x16x32_bf16 v[76:79],a[52:55],v[244:247],v[76:79]
ds_read_b128 v[240:243],v17 offset:41984
v_rcp_f32 v88,v88
v_rcp_f32 v89,v89
s_waitcnt lgkmcnt(5)
v_mfma_f32_16x16x32_bf16 v[68:71],a[56:59],v[248:251],v[68:71]
ds_read_b128 v[244:247],v17 offset:44032
v_min3_u32 v27,v27,v248,v252
v_rcp_f32 v90,v90
v_rcp_f32 v91,v91
v_mfma_f32_16x16x32_bf16 v[76:79],a[60:63],v[252:255],v[76:79]
ds_read_b128 v[248:251],v17 offset:46080
v_mul_f32 v88,v88,v64
v_mul_f32 v89,v89,v65
v_mul_f32 v90,v90,v66
v_mul_f32 v91,v91,v67
s_waitcnt lgkmcnt(5)
v_mfma_f32_16x16x32_bf16 v[68:71],a[64:67],v[224:227],v[68:71]
ds_read_b128 v[252:255],v17 offset:48128
v_min3_u32 v27,v27,v224,v228
v_cvt_pk_bf16_f32 v96,v88,v89
v_cvt_pk_bf16_f32 v97,v90,v91
v_max_u32 v96,1,v96
s_xor_b32 m0,s72,16384
v_mfma_f32_16x16x32_bf16 v[76:79],a[68:71],v[228:231],v[76:79]
ds_read_b128 v[224:227],v17 offset:50176
buffer_store_dwordx2 v[96:97],v18,s[20:23],s70 offen offset:0 sc1
s_add_u32 s65,s88,32768
s_waitcnt lgkmcnt(5)
v_mfma_f32_16x16x32_bf16 v[68:71],a[72:75],v[232:235],v[68:71]
ds_read_b128 v[228:231],v17 offset:52224
v_min3_u32 v27,v27,v232,v236
buffer_load_dwordx4 v16,s[20:23],s65 offen offset:0 sc1 lds
buffer_load_dwordx4 v16,s[20:23],s65 offen offset:2048 sc1 lds
v_mfma_f32_16x16x32_bf16 v[76:79],a[76:79],v[236:239],v[76:79]
ds_read_b128 v[232:235],v17 offset:54272
s_xor_b32 m0,s72,32768
s_add_u32 s65,s88,65536
buffer_load_dwordx4 v16,s[20:23],s65 offen offset:0 sc1 lds
s_waitcnt lgkmcnt(5)
v_mfma_f32_16x16x32_bf16 v[68:71],a[80:83],v[240:243],v[68:71]
ds_read_b128 v[236:239],v17 offset:56320
v_min3_u32 v27,v27,v240,v244
buffer_load_dwordx4 v16,s[20:23],s65 offen offset:2048 sc1 lds
s_xor_b32 m0,s72,49152
s_add_u32 s65,s88,98304
v_mfma_f32_16x16x32_bf16 v[76:79],a[84:87],v[244:247],v[76:79]
ds_read_b128 v[240:243],v17 offset:58368
buffer_load_dwordx4 v16,s[20:23],s65 offen offset:0 sc1 lds
buffer_load_dwordx4 v16,s[20:23],s65 offen offset:2048 sc1 lds
s_waitcnt lgkmcnt(5)
v_mfma_f32_16x16x32_bf16 v[68:71],a[88:91],v[248:251],v[68:71]
ds_read_b128 v[244:247],v17 offset:60416
v_min3_u32 v27,v27,v248,v252
s_xor_b32 m0,s72,1024
s_add_u32 s65,s89,0
buffer_load_dwordx4 v16,s[20:23],s65 offen offset:0 sc1 lds
v_mfma_f32_16x16x32_bf16 v[76:79],a[92:95],v[252:255],v[76:79]
ds_read_b128 v[248:251],v17 offset:62464
buffer_load_dwordx4 v16,s[20:23],s65 offen offset:2048 sc1 lds
s_xor_b32 m0,s72,17408
s_add_u32 s65,s89,32768
s_waitcnt lgkmcnt(5)
v_mfma_f32_16x16x32_bf16 v[68:71],a[96:99],v[224:227],v[68:71]
ds_read_b128 v[252:255],v17 offset:64512
v_min3_u32 v27,v27,v224,v228
buffer_load_dwordx4 v16,s[20:23],s65 offen offset:0 sc1 lds
buffer_load_dwordx4 v16,s[20:23],s65 offen offset:2048 sc1 lds
v_mfma_f32_16x16x32_bf16 v[76:79],a[100:103],v[228:231],v[76:79]
s_xor_b32 m0,s72,33792
s_add_u32 s65,s89,65536
buffer_load_dwordx4 v16,s[20:23],s65 offen offset:0 sc1 lds
s_waitcnt lgkmcnt(4)
v_mfma_f32_16x16x32_bf16 v[68:71],a[104:107],v[232:235],v[68:71]
v_min3_u32 v27,v27,v232,v236
s_waitcnt vmcnt(19)
v_cmp_gt_u32 vcc,s96,v2
s_mov_b32 s96,vcc_lo
v_mov_b32 v44,s96
ds_write_b32 v46,v44
v_mfma_f32_16x16x32_bf16 v[76:79],a[108:111],v[236:239],v[76:79]
buffer_load_dwordx4 v16,s[20:23],s65 offen offset:2048 sc1 lds
s_xor_b32 m0,s72,50176
s_add_u32 s65,s89,98304
s_waitcnt lgkmcnt(3)
v_mfma_f32_16x16x32_bf16 v[68:71],a[112:115],v[240:243],v[68:71]
v_min3_u32 v27,v27,v240,v244
buffer_load_dwordx4 v16,s[20:23],s65 offen offset:0 sc1 lds
buffer_load_dwordx4 v16,s[20:23],s65 offen offset:2048 sc1 lds
v_mfma_f32_16x16x32_bf16 v[76:79],a[116:119],v[244:247],v[76:79]
s_waitcnt lgkmcnt(1)
v_mfma_f32_16x16x32_bf16 v[68:71],a[120:123],v[248:251],v[68:71]
v_min3_u32 v27,v27,v248,v252
v_mfma_f32_16x16x32_bf16 v[76:79],a[124:127],v[252:255],v[76:79]
v_cmp_eq_u32 vcc,0,v27
s_cbranch_vccnz retry_279
s_branch epi_282
ahead_281:
s_waitcnt vmcnt(3) lgkmcnt(0)
s_barrier
ds_read_b32 v44,v45
ds_read_b128 v[224:227],v17 offset:0
ds_read_b128 v[228:231],v17 offset:2048
ds_read_b128 v[232:235],v17 offset:4096
ds_read_b128 v[236:239],v17 offset:6144
ds_read_b128 v[240:243],v17 offset:8192
ds_read_b128 v[244:247],v17 offset:10240
ds_read_b128 v[248:251],v17 offset:12288
s_waitcnt lgkmcnt(5)
v_mfma_f32_16x16x32_bf16 v[64:67],a[0:3],v[224:227],0
ds_read_b128 v[252:255],v17 offset:14336
s_add_u32 s88,s70,s75
s_add_u32 s88,s88,2097152
s_xor_b32 s88,s88,0x2000
v_readfirstlane_b32 s83,v44
v_mfma_f32_16x16x32_bf16 v[72:75],a[4:7],v[228:231],0
ds_read_b128 v[224:227],v17 offset:16384
s_cmp_eq_u32 s83,0
s_cselect_b32 s88,s88,0x7fff0000
s_xor_b32 s89,s88,1024
s_waitcnt lgkmcnt(5)
v_mfma_f32_16x16x32_bf16 v[64:67],a[8:11],v[232:235],v[64:67]
ds_read_b128 v[228:231],v17 offset:18432
s_waitcnt vmcnt(4)
stk_293:
v_min3_u32 v22,v129,v133,v137
v_min3_u32 v22,v22,v141,v145
v_min3_u32 v22,v22,v149,v153
v_min_u32 v22,v22,v157
v_cmp_eq_u32 vcc,0,v22
s_cmp_lt_i32 s90,0
s_cselect_b64 vcc,0,vcc
s_cbranch_vccnz str_294
v_mfma_f32_16x16x32_bf16 v[72:75],a[12:15],v[236:239],v[72:75]
ds_read_b128 v[232:235],v17 offset:20480
v_pk_add_f32 v[88:89],v[128:129],v[144:145]
v_pk_add_f32 v[90:91],v[130:131],v[146:147]
v_pk_add_f32 v[92:93],v[132:133],v[148:149]
v_pk_add_f32 v[94:95],v[134:135],v[150:151]
s_waitcnt lgkmcnt(5)
v_mfma_f32_16x16x32_bf16 v[64:67],a[16:19],v[240:243],v[64:67]
ds_read_b128 v[236:239],v17 offset:22528
v_pk_add_f32 v[96:97],v[136:137],v[152:153]
v_pk_add_f32 v[98:99],v[138:139],v[154:155]
v_pk_add_f32 v[100:101],v[140:141],v[156:157]
v_pk_add_f32 v[102:103],v[142:143],v[158:159]
v_pk_add_f32 v[88:89],v[88:89],v[96:97]
v_mfma_f32_16x16x32_bf16 v[72:75],a[20:23],v[244:247],v[72:75]
ds_read_b128 v[240:243],v17 offset:24576
v_pk_add_f32 v[90:91],v[90:91],v[98:99]
v_pk_add_f32 v[92:93],v[92:93],v[100:101]
v_pk_add_f32 v[94:95],v[94:95],v[102:103]
v_pk_add_f32 v[88:89],v[88:89],v[92:93]
s_waitcnt lgkmcnt(5)
v_mfma_f32_16x16x32_bf16 v[64:67],a[24:27],v[248:251],v[64:67]
ds_read_b128 v[244:247],v17 offset:26624
v_pk_add_f32 v[90:91],v[90:91],v[94:95]
v_mov_b32 v92,v88
v_mov_b32 v93,v89
v_mov_b32 v94,v90
v_mfma_f32_16x16x32_bf16 v[72:75],a[28:31],v[252:255],v[72:75]
ds_read_b128 v[248:251],v17 offset:28672
v_mov_b32 v95,v91
v_permlane16_swap_b32 v92,v88
v_permlane16_swap_b32 v93,v89
s_waitcnt lgkmcnt(5)
v_mfma_f32_16x16x32_bf16 v[64:67],a[32:35],v[224:227],v[64:67]
ds_read_b128 v[252:255],v17 offset:30720
v_permlane16_swap_b32 v94,v90
v_permlane16_swap_b32 v95,v91
s_add_u32 s66,s88,110592
buffer_load_dwordx4 v[128:131],v16,s[20:23],s66 offen offset:0 sc1
v_mfma_f32_16x16x32_bf16 v[72:75],a[36:39],v[228:231],v[72:75]
ds_read_b128 v[224:227],v17 offset:32768
v_pk_add_f32 v[88:89],v[88:89],v[92:93]
v_pk_add_f32 v[90:91],v[90:91],v[94:95]
v_mov_b32 v92,v88
s_waitcnt lgkmcnt(5)
v_mfma_f32_16x16x32_bf16 v[64:67],a[40:43],v[232:235],v[64:67]
ds_read_b128 v[228:231],v17 offset:34816
v_mov_b32 v93,v89
v_mov_b32 v94,v90
v_mov_b32 v95,v91
buffer_load_dwordx4 v[132:135],v16,s[20:23],s66 offen offset:1024 sc1
v_mfma_f32_16x16x32_bf16 v[72:75],a[44:47],v[236:239],v[72:75]
ds_read_b128 v[232:235],v17 offset:36864
v_permlane32_swap_b32 v92,v88
v_permlane32_swap_b32 v93,v89
v_permlane32_swap_b32 v94,v90
s_waitcnt lgkmcnt(5)
v_mfma_f32_16x16x32_bf16 v[64:67],a[48:51],v[240:243],v[64:67]
ds_read_b128 v[236:239],v17 offset:38912
v_permlane32_swap_b32 v95,v91
v_pk_add_f32 v[88:89],v[88:89],v[92:93]
buffer_load_dwordx4 v[136:139],v16,s[20:23],s66 offen offset:2048 sc1
v_mfma_f32_16x16x32_bf16 v[72:75],a[52:55],v[244:247],v[72:75]
ds_read_b128 v[240:243],v17 offset:40960
v_pk_add_f32 v[90:91],v[90:91],v[94:95]
v_mul_f32 v120,0xba800000,v88
v_mul_f32 v124,0xba800000,v90
s_waitcnt lgkmcnt(5)
v_mfma_f32_16x16x32_bf16 v[64:67],a[56:59],v[248:251],v[64:67]
ds_read_b128 v[244:247],v17 offset:43008
v_mul_f32 v92,v120,v120
v_mul_f32 v93,v124,v124
v_fma_f32 v92,v89,s82,-v92
buffer_load_dwordx4 v[140:143],v16,s[20:23],s66 offen offset:3072 sc1
v_mfma_f32_16x16x32_bf16 v[72:75],a[60:63],v[252:255],v[72:75]
ds_read_b128 v[248:251],v17 offset:45056
v_fma_f32 v93,v91,s82,-v93
v_max_f32 v92,0,v92
v_max_f32 v93,0,v93
s_waitcnt lgkmcnt(5)
v_mfma_f32_16x16x32_bf16 v[64:67],a[64:67],v[224:227],v[64:67]
ds_read_b128 v[252:255],v17 offset:47104
v_add_f32 v92,0x3727c5ac,v92
v_add_f32 v93,0x3727c5ac,v93
v_rsq_f32 v94,v92
v_mfma_f32_16x16x32_bf16 v[72:75],a[68:71],v[228:231],v[72:75]
ds_read_b128 v[224:227],v17 offset:49152
v_rsq_f32 v95,v93
v_mul_f32 v123,v92,v94
s_waitcnt lgkmcnt(5)
v_mfma_f32_16x16x32_bf16 v[64:67],a[72:75],v[232:235],v[64:67]
ds_read_b128 v[228:231],v17 offset:51200
v_mul_f32 v127,v93,v95
v_mul_f32 v122,v28,v94
v_mul_f32 v126,v28,v95
v_mfma_f32_16x16x32_bf16 v[72:75],a[76:79],v[236:239],v[72:75]
ds_read_b128 v[232:235],v17 offset:53248
v_mul_f32 v92,v94,v94
v_mul_f32 v93,v95,v95
v_mul_f32 v94,s81,v94
s_waitcnt lgkmcnt(5)
v_mfma_f32_16x16x32_bf16 v[64:67],a[80:83],v[240:243],v[64:67]
ds_read_b128 v[236:239],v17 offset:55296
s_add_u32 s92,s70,8388608
s_sub_u32 s93,s71,53
s_cmp_lt_u32 s93,9
s_cselect_b32 s92,s92,0x7fff0000
v_mul_f32 v95,s81,v95
v_mfma_f32_16x16x32_bf16 v[72:75],a[84:87],v[244:247],v[72:75]
ds_read_b128 v[240:243],v17 offset:57344
v_mul_f32 v121,v92,v94
v_mul_f32 v125,v93,v95
ds_write_b128 v19,v[120:123] offset:0
ds_write_b128 v19,v[124:127] offset:256
s_waitcnt lgkmcnt(7)
v_mfma_f32_16x16x32_bf16 v[64:67],a[88:91],v[248:251],v[64:67]
ds_read_b128 v[244:247],v17 offset:59392
s_add_u32 s66,s88,114688
buffer_load_dwordx4 v[144:147],v16,s[20:23],s66 offen offset:0 sc1
buffer_load_dwordx4 v[148:151],v16,s[20:23],s66 offen offset:1024 sc1
v_mfma_f32_16x16x32_bf16 v[72:75],a[92:95],v[252:255],v[72:75]
ds_read_b128 v[248:251],v17 offset:61440
buffer_load_dwordx4 v[152:155],v16,s[20:23],s66 offen offset:2048 sc1
buffer_load_dwordx4 v[156:159],v16,s[20:23],s66 offen offset:3072 sc1
s_waitcnt lgkmcnt(7)
v_mfma_f32_16x16x32_bf16 v[64:67],a[96:99],v[224:227],v[64:67]
ds_read_b128 v[252:255],v17 offset:63488
s_xor_b32 m0,s72,0
s_add_u32 s65,s88,0
buffer_load_dwordx4 v16,s[20:23],s65 offen offset:0 sc1 lds
v_mfma_f32_16x16x32_bf16 v[72:75],a[100:103],v[228:231],v[72:75]
s_waitcnt lgkmcnt(0)
s_barrier
ds_read_b128 v[224:227],v17 offset:1024
s_waitcnt vmcnt(9)
v_add_u32 v22,s71,-1
v_mfma_f32_16x16x32_bf16 v[64:67],a[104:107],v[232:235],v[64:67]
ds_read_b128 v[228:231],v17 offset:3072
buffer_store_dword v22,v23,s[20:23],s73 offen sc1
buffer_load_dwordx4 v16,s[20:23],s65 offen offset:2048 sc1 lds
s_xor_b32 m0,s72,16384
v_mfma_f32_16x16x32_bf16 v[72:75],a[108:111],v[236:239],v[72:75]
ds_read_b128 v[232:235],v17 offset:5120
s_add_u32 s65,s88,32768
buffer_load_dwordx4 v16,s[20:23],s65 offen offset:0 sc1 lds
v_mfma_f32_16x16x32_bf16 v[64:67],a[112:115],v[240:243],v[64:67]
ds_read_b128 v[236:239],v17 offset:7168
buffer_load_dwordx4 v16,s[20:23],s65 offen offset:2048 sc1 lds
s_xor_b32 m0,s72,32768
s_add_u32 s65,s88,65536
v_mfma_f32_16x16x32_bf16 v[72:75],a[116:119],v[244:247],v[72:75]
ds_read_b128 v[240:243],v17 offset:9216
buffer_load_dwordx4 v16,s[20:23],s65 offen offset:0 sc1 lds
buffer_load_dwordx4 v16,s[20:23],s65 offen offset:2048 sc1 lds
v_mfma_f32_16x16x32_bf16 v[64:67],a[120:123],v[248:251],v[64:67]
ds_read_b128 v[244:247],v17 offset:11264
s_xor_b32 m0,s72,49152
s_add_u32 s65,s88,98304
buffer_load_dwordx4 v16,s[20:23],s65 offen offset:0 sc1 lds
v_mfma_f32_16x16x32_bf16 v[72:75],a[124:127],v[252:255],v[72:75]
ds_read_b128 v[248:251],v17 offset:13312
buffer_load_dword v2,v21,s[20:23],s87 offen sc1
s_add_u32 s96,s71,2
s_waitcnt lgkmcnt(5)
v_mfma_f32_16x16x32_bf16 v[68:71],a[0:3],v[224:227],0
ds_read_b128 v[252:255],v17 offset:15360
s_cmp_gt_u32 s96,56
s_addc_u32 s96,s96,0
buffer_load_dwordx4 v16,s[20:23],s65 offen offset:2048 sc1 lds
s_xor_b32 m0,s72,1024
v_mfma_f32_16x16x32_bf16 v[76:79],a[4:7],v[228:231],0
ds_read_b128 v[224:227],v17 offset:17408
s_add_u32 s65,s89,0
buffer_load_dwordx4 v16,s[20:23],s65 offen offset:0 sc1 lds
s_waitcnt lgkmcnt(5)
v_mfma_f32_16x16x32_bf16 v[68:71],a[8:11],v[232:235],v[68:71]
ds_read_b128 v[228:231],v17 offset:19456
buffer_load_dwordx4 v16,s[20:23],s65 offen offset:2048 sc1 lds
s_xor_b32 m0,s72,17408
s_add_u32 s65,s89,32768
v_mfma_f32_16x16x32_bf16 v[76:79],a[12:15],v[236:239],v[76:79]
ds_read_b128 v[232:235],v17 offset:21504
buffer_load_dwordx4 v16,s[20:23],s65 offen offset:0 sc1 lds
buffer_load_dwordx4 v16,s[20:23],s65 offen offset:2048 sc1 lds
s_waitcnt lgkmcnt(5)
v_mfma_f32_16x16x32_bf16 v[68:71],a[16:19],v[240:243],v[68:71]
ds_read_b128 v[236:239],v17 offset:23552
v_add_f32 v64,v64,v72
v_add_f32 v65,v65,v73
v_add_f32 v66,v66,v74
v_add_f32 v67,v67,v75
v_fmac_f32 v64,v52,v120
v_mfma_f32_16x16x32_bf16 v[76:79],a[20:23],v[244:247],v[76:79]
ds_read_b128 v[240:243],v17 offset:25600
v_fmac_f32 v65,v53,v120
v_fmac_f32 v66,v54,v120
v_fmac_f32 v67,v55,v120
v_mul_f32 v88,v64,v64
s_waitcnt lgkmcnt(5)
v_mfma_f32_16x16x32_bf16 v[68:71],a[24:27],v[248:251],v[68:71]
ds_read_b128 v[244:247],v17 offset:27648
buffer_store_dwordx2 v[48:49],v18,s[20:23],s92 offen offset:0 sc1
buffer_store_dwordx2 v[48:49],v18,s[20:23],s92 offen offset:1024 sc1
v_mul_f32 v89,v65,v65
v_mfma_f32_16x16x32_bf16 v[76:79],a[28:31],v[252:255],v[76:79]
ds_read_b128 v[248:251],v17 offset:29696
v_mul_f32 v90,v66,v66
v_mul_f32 v91,v67,v67
v_fma_f32 v88,v88,v121,v122
v_fma_f32 v89,v89,v121,v122
s_waitcnt lgkmcnt(5)
v_mfma_f32_16x16x32_bf16 v[68:71],a[32:35],v[224:227],v[68:71]
ds_read_b128 v[252:255],v17 offset:31744
v_fma_f32 v90,v90,v121,v122
v_fma_f32 v91,v91,v121,v122
v_mul_f32 v88,v88,v64
v_mul_f32 v89,v89,v65
v_mul_f32 v90,v90,v66
v_mfma_f32_16x16x32_bf16 v[76:79],a[36:39],v[228:231],v[76:79]
ds_read_b128 v[224:227],v17 offset:33792
v_mul_f32 v91,v91,v67
v_exp_f32 v88,v88
s_xor_b32 m0,s72,33792
s_waitcnt lgkmcnt(5)
v_mfma_f32_16x16x32_bf16 v[68:71],a[40:43],v[232:235],v[68:71]
ds_read_b128 v[228:231],v17 offset:35840
v_exp_f32 v89,v89
v_exp_f32 v90,v90
s_add_u32 s65,s89,65536
v_mfma_f32_16x16x32_bf16 v[76:79],a[44:47],v[236:239],v[76:79]
ds_read_b128 v[232:235],v17 offset:37888
v_exp_f32 v91,v91
v_fma_f32 v88,v88,v123,v123
v_fma_f32 v89,v89,v123,v123
s_waitcnt lgkmcnt(5)
v_mfma_f32_16x16x32_bf16 v[68:71],a[48:51],v[240:243],v[68:71]
ds_read_b128 v[236:239],v17 offset:39936
v_fma_f32 v90,v90,v123,v123
v_fma_f32 v91,v91,v123,v123
v_rcp_f32 v88,v88
v_mfma_f32_16x16x32_bf16 v[76:79],a[52:55],v[244:247],v[76:79]
ds_read_b128 v[240:243],v17 offset:41984
v_rcp_f32 v89,v89
v_rcp_f32 v90,v90
s_waitcnt lgkmcnt(5)
v_mfma_f32_16x16x32_bf16 v[68:71],a[56:59],v[248:251],v[68:71]
ds_read_b128 v[244:247],v17 offset:44032
v_rcp_f32 v91,v91
v_mul_f32 v88,v88,v64
v_mul_f32 v89,v89,v65
v_mul_f32 v90,v90,v66
v_mfma_f32_16x16x32_bf16 v[76:79],a[60:63],v[252:255],v[76:79]
ds_read_b128 v[248:251],v17 offset:46080
v_mul_f32 v91,v91,v67
v_cvt_pk_bf16_f32 v96,v88,v89
v_cvt_pk_bf16_f32 v97,v90,v91
v_max_u32 v96,1,v96
s_waitcnt lgkmcnt(5)
v_mfma_f32_16x16x32_bf16 v[68:71],a[64:67],v[224:227],v[68:71]
ds_read_b128 v[252:255],v17 offset:48128
buffer_store_dwordx2 v[96:97],v18,s[20:23],s70 offen offset:0 sc1
buffer_load_dwordx4 v16,s[20:23],s65 offen offset:0 sc1 lds
v_mfma_f32_16x16x32_bf16 v[76:79],a[68:71],v[228:231],v[76:79]
ds_read_b128 v[224:227],v17 offset:50176
buffer_load_dwordx4 v16,s[20:23],s65 offen offset:2048 sc1 lds
s_xor_b32 m0,s72,50176
s_add_u32 s65,s89,98304
s_waitcnt lgkmcnt(5)
v_mfma_f32_16x16x32_bf16 v[68:71],a[72:75],v[232:235],v[68:71]
ds_read_b128 v[228:231],v17 offset:52224
buffer_load_dwordx4 v16,s[20:23],s65 offen offset:0 sc1 lds
buffer_load_dwordx4 v16,s[20:23],s65 offen offset:2048 sc1 lds
v_mfma_f32_16x16x32_bf16 v[76:79],a[76:79],v[236:239],v[76:79]
ds_read_b128 v[232:235],v17 offset:54272
s_waitcnt lgkmcnt(5)
v_mfma_f32_16x16x32_bf16 v[68:71],a[80:83],v[240:243],v[68:71]
ds_read_b128 v[236:239],v17 offset:56320
v_mfma_f32_16x16x32_bf16 v[76:79],a[84:87],v[244:247],v[76:79]
ds_read_b128 v[240:243],v17 offset:58368
s_waitcnt lgkmcnt(5)
v_mfma_f32_16x16x32_bf16 v[68:71],a[88:91],v[248:251],v[68:71]
ds_read_b128 v[244:247],v17 offset:60416
v_mfma_f32_16x16x32_bf16 v[76:79],a[92:95],v[252:255],v[76:79]
ds_read_b128 v[248:251],v17 offset:62464
s_waitcnt lgkmcnt(5)
v_mfma_f32_16x16x32_bf16 v[68:71],a[96:99],v[224:227],v[68:71]
ds_read_b128 v[252:255],v17 offset:64512
v_mfma_f32_16x16x32_bf16 v[76:79],a[100:103],v[228:231],v[76:79]
s_waitcnt lgkmcnt(4)
v_mfma_f32_16x16x32_bf16 v[68:71],a[104:107],v[232:235],v[68:71]
s_waitcnt vmcnt(12)
v_cmp_gt_u32 vcc,s96,v2
s_mov_b32 s96,vcc_lo
v_mov_b32 v44,s96
ds_write_b32 v46,v44
v_mfma_f32_16x16x32_bf16 v[76:79],a[108:111],v[236:239],v[76:79]
s_waitcnt lgkmcnt(3)
v_mfma_f32_16x16x32_bf16 v[68:71],a[112:115],v[240:243],v[68:71]
v_mfma_f32_16x16x32_bf16 v[76:79],a[116:119],v[244:247],v[76:79]
s_waitcnt lgkmcnt(1)
v_mfma_f32_16x16x32_bf16 v[68:71],a[120:123],v[248:251],v[68:71]
v_mfma_f32_16x16x32_bf16 v[76:79],a[124:127],v[252:255],v[76:79]
epi_282:
buffer_load_dword v29,v21,s[20:23],s87 offen sc1
s_nop 6
v_pk_add_f32 v[68:69],v[68:69],v[76:77]
v_pk_add_f32 v[70:71],v[70:71],v[78:79]
v_pk_fma_f32 v[68:69],v[52:53],v[124:125],v[68:69] op_sel_hi:[1,0,1]
v_pk_fma_f32 v[70:71],v[54:55],v[124:125],v[70:71] op_sel_hi:[1,0,1]
v_pk_mul_f32 v[88:89],v[68:69],v[68:69]
v_pk_mul_f32 v[90:91],v[70:71],v[70:71]
v_pk_fma_f32 v[88:89],v[88:89],v[124:125],v[126:127] op_sel:[0,1,0] op_sel_hi:[1,1,0]
v_pk_fma_f32 v[90:91],v[90:91],v[124:125],v[126:127] op_sel:[0,1,0] op_sel_hi:[1,1,0]
v_pk_mul_f32 v[88:89],v[88:89],v[68:69]
v_pk_mul_f32 v[90:91],v[90:91],v[70:71]
v_exp_f32 v88,v88
v_exp_f32 v89,v89
v_exp_f32 v90,v90
v_exp_f32 v91,v91
v_pk_fma_f32 v[88:89],v[88:89],v[126:127],v[126:127] op_sel:[0,1,1] op_sel_hi:[1,1,1]
v_pk_fma_f32 v[90:91],v[90:91],v[126:127],v[126:127] op_sel:[0,1,1] op_sel_hi:[1,1,1]
v_rcp_f32 v88,v88
v_rcp_f32 v89,v89
v_rcp_f32 v90,v90
v_rcp_f32 v91,v91
v_pk_mul_f32 v[88:89],v[88:89],v[68:69]
v_pk_mul_f32 v[90:91],v[90:91],v[70:71]
v_cvt_pk_bf16_f32 v96,v88,v89
v_cvt_pk_bf16_f32 v97,v90,v91
v_max_u32 v96,1,v96
buffer_store_dwordx2 v[96:97],v18,s[20:23],s70 offen offset:1024 sc1
s_cmp_gt_u32 s71,56
s_cselect_b32 s65,s73,0x7fff0000
v_mov_b32 v22,s71
buffer_store_dword v22,v23,s[20:23],s65 offen sc1
v_xor_b32 v17,0x10000,v17
v_xor_b32 v45,16,v45
v_xor_b32 v46,16,v46
s_xor_b32 s72,s72,0x10000
s_add_u32 s70,s70,2097152
s_xor_b32 s70,s70,0x2000
s_add_u32 s71,s71,1
s_cmp_le_u32 s71,65
s_cbranch_scc1 seg_280
s_endpgm
retry_279:
s_sub_u32 s90,s90,64
s_cmp_lt_i32 s90,0
s_cbranch_scc1 giveup_170
s_mov_b32 s83,1
s_waitcnt vmcnt(0) lgkmcnt(0)
s_barrier
s_branch seg_280
str_290:
s_add_u32 s94,s70,s75
s_add_u32 s66,s94,110592
buffer_load_dwordx4 v[128:131],v16,s[20:23],s66 offen offset:0 sc1
buffer_load_dwordx4 v[132:135],v16,s[20:23],s66 offen offset:1024 sc1
buffer_load_dwordx4 v[136:139],v16,s[20:23],s66 offen offset:2048 sc1
buffer_load_dwordx4 v[140:143],v16,s[20:23],s66 offen offset:3072 sc1
s_add_u32 s66,s94,114688
buffer_load_dwordx4 v[144:147],v16,s[20:23],s66 offen offset:0 sc1
buffer_load_dwordx4 v[148:151],v16,s[20:23],s66 offen offset:1024 sc1
buffer_load_dwordx4 v[152:155],v16,s[20:23],s66 offen offset:2048 sc1
buffer_load_dwordx4 v[156:159],v16,s[20:23],s66 offen offset:3072 sc1
s_sub_u32 s90,s90,1
s_waitcnt vmcnt(0)
s_branch stk_289
str_292:
s_add_u32 s94,s70,s75
s_add_u32 s66,s94,110592
buffer_load_dwordx4 v[128:131],v16,s[20:23],s66 offen offset:0 sc1
buffer_load_dwordx4 v[132:135],v16,s[20:23],s66 offen offset:1024 sc1
buffer_load_dwordx4 v[136:139],v16,s[20:23],s66 offen offset:2048 sc1
buffer_load_dwordx4 v[140:143],v16,s[20:23],s66 offen offset:3072 sc1
s_add_u32 s66,s94,114688
buffer_load_dwordx4 v[144:147],v16,s[20:23],s66 offen offset:0 sc1
buffer_load_dwordx4 v[148:151],v16,s[20:23],s66 offen offset:1024 sc1
buffer_load_dwordx4 v[152:155],v16,s[20:23],s66 offen offset:2048 sc1
buffer_load_dwordx4 v[156:159],v16,s[20:23],s66 offen offset:3072 sc1
s_sub_u32 s90,s90,1
s_waitcnt vmcnt(0)
s_branch stk_291
str_294:
s_add_u32 s94,s70,s75
s_add_u32 s66,s94,110592
buffer_load_dwordx4 v[128:131],v16,s[20:23],s66 offen offset:0 sc1
buffer_load_dwordx4 v[132:135],v16,s[20:23],s66 offen offset:1024 sc1
buffer_load_dwordx4 v[136:139],v16,s[20:23],s66 offen offset:2048 sc1
buffer_load_dwordx4 v[140:143],v16,s[20:23],s66 offen offset:3072 sc1
s_add_u32 s66,s94,114688
buffer_load_dwordx4 v[144:147],v16,s[20:23],s66 offen offset:0 sc1
buffer_load_dwordx4 v[148:151],v16,s[20:23],s66 offen offset:1024 sc1
buffer_load_dwordx4 v[152:155],v16,s[20:23],s66 offen offset:2048 sc1
buffer_load_dwordx4 v[156:159],v16,s[20:23],s66 offen offset:3072 sc1
s_sub_u32 s90,s90,1
s_waitcnt vmcnt(0)
s_branch stk_293
giveup_170:
s_endpgm
code_end:
.section .rodata,"a"
.p2align 6
.amdhsa_kernel mega_kernel
  .amdhsa_next_free_vgpr 512
  .amdhsa_next_free_sgpr 102
  .amdhsa_accum_offset 256
  .amdhsa_group_segment_fixed_size 0
  .amdhsa_kernarg_size 136
  .amdhsa_user_sgpr_count 2
  .amdhsa_user_sgpr_kernarg_segment_ptr 1
  .amdhsa_system_sgpr_workgroup_id_x 1
.end_amdhsa_kernel
```

```asm
; @launch kernel=mega_kernel grid=(256,1,1) block=(256,1,1) lds=163840
.amdgcn_target "amdgcn-amd-amdhsa--gfx950"
.text
.globl mega_kernel
.p2align 8
.type mega_kernel,@function
mega_kernel:
s_cmp_ge_u32 s2,256
s_cbranch_scc1 done_1
s_load_dwordx4 s[16:19],s[0:1],120
s_load_dword s3,s[0:1],0
s_getpc_b64 s[4:5]
pc_2:
s_sub_u32 s8,s4,pc_2-mega_kernel
s_subb_u32 s9,s5,0
s_and_b32 s9,s9,0xffff
s_mov_b32 s10,code_end-mega_kernel
s_mov_b32 s11,0x20000
v_lshlrev_b32 v180,7,v0
v_cmp_gt_u32 vcc,64,v0
s_cbranch_vccnz nocpf_3
buffer_load_dword v181,v180,s[8:11],0 offen
s_mov_b32 s12,0x8000
buffer_load_dword v182,v180,s[8:11],s12 offen
s_lshr_b32 s12,s2,3
s_and_b32 s12,s12,7
s_add_u32 s12,s12,2
s_lshl_b32 s12,s12,15
buffer_load_dword v183,v180,s[8:11],s12 offen
nocpf_3:
v_and_b32 v1,63,v0
v_lshrrev_b32 v2,6,v0
s_getreg_b32 s51,hwreg(HW_REG_XCC_ID)
v_readfirstlane_b32 s50,v2
s_and_b32 s51,s51,7
s_waitcnt lgkmcnt(0)
s_mov_b32 s20,s18
s_and_b32 s21,s19,0xffff
s_mov_b32 s22,0x10000000
s_mov_b32 s23,0x20000
s_mov_b32 s44,s16
s_and_b32 s45,s17,0xffff
s_mov_b32 s46,0x100
s_mov_b32 s47,0x20000
s_mov_b32 s90,400000
s_mov_b32 s91,s50
v_mov_b32 v187,158976
s_cmp_lg_u32 s50,0
s_cbranch_scc1 norole_4
s_mov_b64 exec,1
v_mov_b32 v184,1
v_mov_b32 v185,0
s_and_b32 s52,s51,3
s_lshl_b32 s52,s52,2
s_lshr_b32 s53,s51,2
s_lshl_b32 s53,s53,7
s_add_u32 s52,s52,s53
buffer_atomic_add v184,v185,s[44:47],s52 offen sc0 sc1
s_mov_b64 exec,-1
buffer_load_dword v181,v180,s[8:11],0 offen
s_mov_b32 s12,0x8000
buffer_load_dword v182,v180,s[8:11],s12 offen
s_lshr_b32 s12,s2,3
s_and_b32 s12,s12,7
s_add_u32 s12,s12,2
s_lshl_b32 s12,s12,15
buffer_load_dword v183,v180,s[8:11],s12 offen
s_mov_b64 exec,1
s_waitcnt vmcnt(3)
ds_write_b32 v187,v184
s_waitcnt lgkmcnt(0)
s_mov_b64 exec,-1
norole_4:
s_barrier
ds_read_b32 v186,v187
s_waitcnt lgkmcnt(0)
v_readfirstlane_b32 s54,v186
s_mov_b32 s56,2
s_lshl_b32 s57,s51,5
s_add_u32 s57,s57,s54
s_cmp_lt_u32 s54,32
s_cselect_b32 s57,s57,999
s_cmp_ge_u32 s57,256
s_cbranch_scc1 verify_6
s_cmp_ge_u32 s57,128
s_cbranch_scc1 pre_8
setup_5:
s_load_dwordx8 s[4:11],s[0:1],8
s_load_dwordx2 s[12:13],s[0:1],40
v_and_b32 v3,15,v1
v_lshrrev_b32 v4,4,v1
v_lshlrev_b32 v16,4,v1
v_lshrrev_b32 v30,2,v1
v_and_b32 v31,3,v1
v_lshlrev_b32 v7,13,v30
v_lshl_add_u32 v7,v31,4,v7
v_lshlrev_b32 v8,11,v30
v_lshl_add_u32 v8,v31,4,v8
s_lshr_b32 s58,s57,5
s_and_b32 s59,s57,31
s_xor_b32 s60,s57,0
s_lshl_b32 s60,s60,6
s_lshl_b32 s61,s50,14
s_lshl_b32 s62,s50,21
s_add_u32 s62,s62,s60
s_lshl_b32 s63,s58,21
s_lshl_b32 s64,s50,19
s_add_u32 s63,s63,s64
s_xor_b32 s64,s59,0
s_lshl_b32 s64,s64,6
s_add_u32 s63,s63,s64
s_waitcnt lgkmcnt(0)
s_mov_b32 s28,s8
s_and_b32 s29,s9,0xffff
s_mov_b32 s30,0x800000
s_mov_b32 s31,0x20000
s_mov_b32 s32,s10
s_and_b32 s33,s11,0xffff
s_mov_b32 s34,0x800000
s_mov_b32 s35,0x20000
s_mov_b32 s36,s6
s_and_b32 s37,s7,0xffff
s_mov_b32 s38,0x800000
s_mov_b32 s39,0x20000
s_mov_b32 s40,s12
s_and_b32 s41,s13,0xffff
s_mov_b32 s42,0x800000
s_mov_b32 s43,0x20000
s_mov_b32 s8,s4
s_and_b32 s9,s5,0xffff
s_mov_b32 s10,0x4000
s_mov_b32 s11,0x20000
v_lshlrev_b32 v9,7,v3
v_lshl_add_u32 v10,v4,11,v9
v_lshl_add_u32 v9,v4,13,v9
s_lshl_b32 s64,s59,2
s_add_u32 s64,s64,s50
s_lshl_b32 s65,s64,16
s_lshl_b32 s66,s58,11
s_add_u32 s65,s65,s66
s_lshl_b32 s66,s64,14
s_lshl_b32 s67,s58,21
s_add_u32 s66,s66,s67
v_and_b32 v9,7,v1
v_lshrrev_b32 v10,3,v1
s_cmp_eq_u32 s58,3
s_cselect_b32 s64,15,3
v_mov_b32 v11,3
v_cmp_eq_u32 vcc,1,v10
s_nop 1
v_cndmask_b32 v11,v11,11,vcc
v_lshlrev_b32 v12,7,v11
v_lshl_add_u32 v12,v9,11,v12
v_mov_b32 v13,s64
v_cmp_eq_u32 vcc,2,v10
s_nop 1
v_cndmask_b32 v11,v11,v13,vcc
v_lshlrev_b32 v11,7,v11
v_lshl_add_u32 v11,v9,13,v11
v_mov_b32 v100,0
v_mov_b32 v101,0
v_mov_b32 v102,0
v_mov_b32 v103,0
s_mov_b32 s53,s65
s_mov_b32 s55,s66
v_and_b32 v22,7,v3
v_lshlrev_b32 v31,11,v22
v_lshl_add_u32 v31,v4,4,v31
s_lshr_b32 s64,s59,3
s_lshl_b32 s64,s64,14
s_and_b32 s65,s59,7
s_lshl_b32 s65,s65,10
s_add_u32 s64,s64,s65
s_lshl_b32 s65,s58,16
s_add_u32 s64,s64,s65
s_add_u32 s64,s64,31195136
s_lshr_b32 s65,s57,3
s_add_u32 s65,s65,96
s_lshl_b32 s65,s65,14
s_and_b32 s66,s57,7
s_lshl_b32 s66,s66,10
s_add_u32 s65,s65,s66
s_add_u32 s65,s65,29360128
v_add_u32 v206,s64,v16
v_add_u32 v207,s65,v16
s_and_b32 s64,s50,1
s_lshl_b32 s64,s64,21
s_lshr_b32 s65,s50,1
s_lshl_b32 s65,s65,13
s_add_u32 s64,s64,s65
buffer_store_dwordx4 v[100:103],v206,s[20:23],s64 offen sc1
buffer_store_dwordx4 v[100:103],v207,s[20:23],s64 offen sc1
s_lshl_b32 s64,s50,20
s_add_u32 s64,s64,23068672
s_cmp_lt_u32 s50,2
s_cselect_b32 s67,s64,0x7fff0000
s_lshl_b32 s65,s57,10
s_add_u32 s65,s65,131072
s_add_u32 s65,s65,s67
buffer_store_dwordx4 v[100:103],v16,s[20:23],s65 offen sc1
s_lshl_b32 s65,s57,9
s_add_u32 s65,s65,s67
s_add_u32 s66,s65,65536
s_mov_b32 exec_hi,0
buffer_store_dwordx4 v[100:103],v16,s[20:23],s65 offen sc1
buffer_store_dwordx4 v[100:103],v16,s[20:23],s66 offen sc1
s_lshl_b32 s65,s57,2
s_add_u32 s65,s65,s64
s_add_u32 s65,s65,524288
s_lshl_b32 s52,s57,7
s_add_u32 s52,s52,21168128
s_mov_b64 exec,1
buffer_store_dword v100,v100,s[20:23],s65 offen sc1
buffer_store_dword v100,v100,s[20:23],s65 offen offset:512 sc1
buffer_store_dword v100,v100,s[20:23],s52 offen sc1
s_mov_b64 exec,-1
s_mov_b32 s65,s53
s_mov_b32 s66,s55
s_add_u32 s64,s62,0
s_add_u32 m0,s61,0
s_nop 0
buffer_load_dwordx4 v7,s[28:31],s64 offen nt lds
s_add_u32 s64,s62,131072
s_add_u32 m0,s61,1024
s_nop 0
buffer_load_dwordx4 v7,s[28:31],s64 offen nt lds
s_add_u32 s64,s62,262144
s_add_u32 m0,s61,2048
s_nop 0
buffer_load_dwordx4 v7,s[28:31],s64 offen nt lds
s_add_u32 s64,s62,393216
s_add_u32 m0,s61,3072
s_nop 0
buffer_load_dwordx4 v7,s[28:31],s64 offen nt lds
s_add_u32 s64,s62,524288
s_add_u32 m0,s61,4096
s_nop 0
buffer_load_dwordx4 v7,s[28:31],s64 offen nt lds
s_add_u32 s64,s62,655360
s_add_u32 m0,s61,5120
s_nop 0
buffer_load_dwordx4 v7,s[28:31],s64 offen nt lds
s_add_u32 s64,s62,786432
s_add_u32 m0,s61,6144
s_nop 0
buffer_load_dwordx4 v7,s[28:31],s64 offen nt lds
s_add_u32 s64,s62,917504
s_add_u32 m0,s61,7168
s_nop 0
buffer_load_dwordx4 v7,s[28:31],s64 offen nt lds
s_add_u32 s64,s62,1048576
s_add_u32 m0,s61,8192
s_nop 0
buffer_load_dwordx4 v7,s[28:31],s64 offen nt lds
s_add_u32 s64,s62,1179648
s_add_u32 m0,s61,9216
s_nop 0
buffer_load_dwordx4 v7,s[28:31],s64 offen nt lds
s_add_u32 s64,s62,1310720
s_add_u32 m0,s61,10240
s_nop 0
buffer_load_dwordx4 v7,s[28:31],s64 offen nt lds
s_add_u32 s64,s62,1441792
s_add_u32 m0,s61,11264
s_nop 0
buffer_load_dwordx4 v7,s[28:31],s64 offen nt lds
s_add_u32 s64,s62,1572864
s_add_u32 m0,s61,12288
s_nop 0
buffer_load_dwordx4 v7,s[28:31],s64 offen nt lds
s_add_u32 s64,s62,1703936
s_add_u32 m0,s61,13312
s_nop 0
buffer_load_dwordx4 v7,s[28:31],s64 offen nt lds
s_add_u32 s64,s62,1835008
s_add_u32 m0,s61,14336
s_nop 0
buffer_load_dwordx4 v7,s[28:31],s64 offen nt lds
s_add_u32 s64,s62,1966080
s_add_u32 m0,s61,15360
s_nop 0
buffer_load_dwordx4 v7,s[28:31],s64 offen nt lds
s_mov_b64 exec,0xffffff
buffer_load_dword v201,v11,s[32:35],s65 offen
buffer_load_dword v202,v11,s[36:39],s65 offen
s_mov_b64 exec,0xffff
buffer_load_dword v203,v12,s[40:43],s66 offen
s_mov_b64 exec,-1
s_add_u32 s64,s62,0
s_add_u32 m0,s61,65536
s_nop 0
buffer_load_dwordx4 v7,s[32:35],s64 offen nt lds
s_add_u32 s64,s62,131072
s_add_u32 m0,s61,66560
s_nop 0
buffer_load_dwordx4 v7,s[32:35],s64 offen nt lds
s_add_u32 s64,s62,262144
s_add_u32 m0,s61,67584
s_nop 0
buffer_load_dwordx4 v7,s[32:35],s64 offen nt lds
s_add_u32 s64,s62,393216
s_add_u32 m0,s61,68608
s_nop 0
buffer_load_dwordx4 v7,s[32:35],s64 offen nt lds
s_add_u32 s64,s62,524288
s_add_u32 m0,s61,69632
s_nop 0
buffer_load_dwordx4 v7,s[32:35],s64 offen nt lds
s_add_u32 s64,s62,655360
s_add_u32 m0,s61,70656
s_nop 0
buffer_load_dwordx4 v7,s[32:35],s64 offen nt lds
s_add_u32 s64,s62,786432
s_add_u32 m0,s61,71680
s_nop 0
buffer_load_dwordx4 v7,s[32:35],s64 offen nt lds
s_add_u32 s64,s62,917504
s_add_u32 m0,s61,72704
s_nop 0
buffer_load_dwordx4 v7,s[32:35],s64 offen nt lds
s_add_u32 s64,s62,1048576
s_add_u32 m0,s61,73728
s_nop 0
buffer_load_dwordx4 v7,s[32:35],s64 offen nt lds
s_add_u32 s64,s62,1179648
s_add_u32 m0,s61,74752
s_nop 0
buffer_load_dwordx4 v7,s[32:35],s64 offen nt lds
s_add_u32 s64,s62,1310720
s_add_u32 m0,s61,75776
s_nop 0
buffer_load_dwordx4 v7,s[32:35],s64 offen nt lds
s_add_u32 s64,s62,1441792
s_add_u32 m0,s61,76800
s_nop 0
buffer_load_dwordx4 v7,s[32:35],s64 offen nt lds
s_add_u32 s64,s62,1572864
s_add_u32 m0,s61,77824
s_nop 0
buffer_load_dwordx4 v7,s[32:35],s64 offen nt lds
s_add_u32 s64,s62,1703936
s_add_u32 m0,s61,78848
s_nop 0
buffer_load_dwordx4 v7,s[32:35],s64 offen nt lds
s_add_u32 s64,s62,1835008
s_add_u32 m0,s61,79872
s_nop 0
buffer_load_dwordx4 v7,s[32:35],s64 offen nt lds
s_add_u32 s64,s62,1966080
s_add_u32 m0,s61,80896
s_nop 0
buffer_load_dwordx4 v7,s[32:35],s64 offen nt lds
s_lshl_b32 s64,s59,6
buffer_load_dwordx4 v[216:219],v31,s[8:11],s64 offen
v_lshrrev_b32 v184,3,v3
v_bfe_u32 v185,v3,2,1
v_lshrrev_b32 v186,1,v4
v_and_b32 v187,1,v4
v_lshl_add_u32 v188,v184,3,v185
v_lshl_add_u32 v188,v186,4,v188
v_lshl_add_u32 v188,v187,2,v188
v_lshl_add_u32 v189,v184,2,v185
v_lshl_add_u32 v189,v186,3,v189
v_lshl_add_u32 v189,v187,4,v189
v_and_b32 v187,3,v3
v_lshlrev_b32 v187,3,v187
v_lshl_add_u32 v188,v188,6,v187
v_lshl_add_u32 v189,v189,6,v187
s_lshr_b32 s64,s50,1
s_lshl_b32 s64,s64,5
v_add_u32 v190,s64,v188
v_add_u32 v191,0x10000,v190
s_lshl_b32 s64,s64,10
v_add_u32 v192,s64,v189
s_add_u32 s64,s61,0x10000
v_add_u32 v193,s64,v16
s_add_u32 s68,s50,1
s_mov_b32 s69,0
s_waitcnt vmcnt(20)
s_barrier
s_lshl_b32 s64,s57,9
v_mov_b32 v194,s64
s_add_u32 s65,s64,65024
v_mov_b32 v195,s65
v_cmp_lt_u32 vcc,3,v1
s_nop 1
v_cndmask_b32 v194,v194,v195,vcc
s_lshl_b32 s65,s57,10
s_add_u32 s65,s65,130048
v_mov_b32 v195,s65
v_cmp_lt_u32 vcc,7,v1
s_nop 1
v_cndmask_b32 v194,v194,v195,vcc
s_lshl_b32 s65,s57,11
s_add_u32 s65,s65,260096
v_mov_b32 v195,s65
v_cmp_lt_u32 vcc,15,v1
s_nop 1
v_cndmask_b32 v194,v194,v195,vcc
v_lshl_add_u32 v194,v1,7,v194
s_lshl_b32 s65,s58,7
s_add_u32 s65,s65,524288
v_writelane_b32 v194,s65,32
s_add_u32 s65,s65,512
v_writelane_b32 v194,s65,33
s_lshl_b32 s64,s50,20
s_add_u32 s64,s64,23068672
s_mov_b32 exec_hi,3
buffer_load_dword v183,v194,s[20:23],s64 offen sc1
s_mov_b64 exec,-1
s_cmp_lg_u32 s50,1
s_cbranch_scc1 ws_14
s_and_b32 s64,s56,1
s_lshl_b32 s64,s64,2
s_add_u32 s64,s64,36
s_mov_b64 exec,1
v_mov_b32 v204,1
v_mov_b32 v185,0
buffer_atomic_add v204,v185,s[44:47],s64 offen sc0 sc1
s_mov_b64 exec,-1
ws_14:
s_bitcmp1_b32 s68,1
s_cbranch_scc0 ws_11
rq_15:
ds_read_b64_tr_b16 a[0:1],v190 offset:0
ds_read_b64_tr_b16 a[2:3],v190 offset:128
ds_read_b64_tr_b16 a[4:5],v190 offset:2048
ds_read_b64_tr_b16 a[6:7],v190 offset:2176
ds_read_b64_tr_b16 a[8:9],v190 offset:4096
ds_read_b64_tr_b16 a[10:11],v190 offset:4224
ds_read_b64_tr_b16 a[12:13],v190 offset:6144
ds_read_b64_tr_b16 a[14:15],v190 offset:6272
s_waitcnt lgkmcnt(0)
ds_read_b64_tr_b16 a[16:17],v190 offset:8192
ds_read_b64_tr_b16 a[18:19],v190 offset:8320
ds_read_b64_tr_b16 a[20:21],v190 offset:10240
ds_read_b64_tr_b16 a[22:23],v190 offset:10368
ds_read_b64_tr_b16 a[24:25],v190 offset:12288
ds_read_b64_tr_b16 a[26:27],v190 offset:12416
ds_read_b64_tr_b16 a[28:29],v190 offset:14336
ds_read_b64_tr_b16 a[30:31],v190 offset:14464
s_waitcnt lgkmcnt(0)
ds_read_b64_tr_b16 a[32:33],v190 offset:16384
ds_read_b64_tr_b16 a[34:35],v190 offset:16512
ds_read_b64_tr_b16 a[36:37],v190 offset:18432
ds_read_b64_tr_b16 a[38:39],v190 offset:18560
ds_read_b64_tr_b16 a[40:41],v190 offset:20480
ds_read_b64_tr_b16 a[42:43],v190 offset:20608
ds_read_b64_tr_b16 a[44:45],v190 offset:22528
ds_read_b64_tr_b16 a[46:47],v190 offset:22656
s_waitcnt lgkmcnt(0)
ds_read_b64_tr_b16 a[48:49],v190 offset:24576
ds_read_b64_tr_b16 a[50:51],v190 offset:24704
ds_read_b64_tr_b16 a[52:53],v190 offset:26624
ds_read_b64_tr_b16 a[54:55],v190 offset:26752
ds_read_b64_tr_b16 a[56:57],v190 offset:28672
ds_read_b64_tr_b16 a[58:59],v190 offset:28800
ds_read_b64_tr_b16 a[60:61],v190 offset:30720
ds_read_b64_tr_b16 a[62:63],v190 offset:30848
s_waitcnt lgkmcnt(0)
ds_read_b64_tr_b16 a[64:65],v190 offset:32768
ds_read_b64_tr_b16 a[66:67],v190 offset:32896
ds_read_b64_tr_b16 a[68:69],v190 offset:34816
ds_read_b64_tr_b16 a[70:71],v190 offset:34944
ds_read_b64_tr_b16 a[72:73],v190 offset:36864
ds_read_b64_tr_b16 a[74:75],v190 offset:36992
ds_read_b64_tr_b16 a[76:77],v190 offset:38912
ds_read_b64_tr_b16 a[78:79],v190 offset:39040
s_waitcnt lgkmcnt(0)
ds_read_b64_tr_b16 a[80:81],v190 offset:40960
ds_read_b64_tr_b16 a[82:83],v190 offset:41088
ds_read_b64_tr_b16 a[84:85],v190 offset:43008
ds_read_b64_tr_b16 a[86:87],v190 offset:43136
ds_read_b64_tr_b16 a[88:89],v190 offset:45056
ds_read_b64_tr_b16 a[90:91],v190 offset:45184
ds_read_b64_tr_b16 a[92:93],v190 offset:47104
ds_read_b64_tr_b16 a[94:95],v190 offset:47232
s_waitcnt lgkmcnt(0)
ds_read_b64_tr_b16 a[96:97],v190 offset:49152
ds_read_b64_tr_b16 a[98:99],v190 offset:49280
ds_read_b64_tr_b16 a[100:101],v190 offset:51200
ds_read_b64_tr_b16 a[102:103],v190 offset:51328
ds_read_b64_tr_b16 a[104:105],v190 offset:53248
ds_read_b64_tr_b16 a[106:107],v190 offset:53376
ds_read_b64_tr_b16 a[108:109],v190 offset:55296
ds_read_b64_tr_b16 a[110:111],v190 offset:55424
s_waitcnt lgkmcnt(0)
ds_read_b64_tr_b16 a[112:113],v190 offset:57344
ds_read_b64_tr_b16 a[114:115],v190 offset:57472
ds_read_b64_tr_b16 a[116:117],v190 offset:59392
ds_read_b64_tr_b16 a[118:119],v190 offset:59520
ds_read_b64_tr_b16 a[120:121],v190 offset:61440
ds_read_b64_tr_b16 a[122:123],v190 offset:61568
ds_read_b64_tr_b16 a[124:125],v190 offset:63488
ds_read_b64_tr_b16 a[126:127],v190 offset:63616
s_waitcnt lgkmcnt(0)
s_cmp_lg_u32 s69,0
s_cbranch_scc1 rqb_16
ws_11:
s_add_u32 s64,s62,0
buffer_load_dwordx4 v[32:35],v7,s[36:39],s64 offen nt
s_add_u32 s64,s62,131072
buffer_load_dwordx4 v[36:39],v7,s[36:39],s64 offen nt
s_add_u32 s64,s62,262144
buffer_load_dwordx4 v[40:43],v7,s[36:39],s64 offen nt
s_add_u32 s64,s62,393216
buffer_load_dwordx4 v[44:47],v7,s[36:39],s64 offen nt
s_add_u32 s64,s62,524288
buffer_load_dwordx4 v[48:51],v7,s[36:39],s64 offen nt
s_add_u32 s64,s62,655360
buffer_load_dwordx4 v[52:55],v7,s[36:39],s64 offen nt
s_add_u32 s64,s62,786432
buffer_load_dwordx4 v[56:59],v7,s[36:39],s64 offen nt
s_add_u32 s64,s62,917504
buffer_load_dwordx4 v[60:63],v7,s[36:39],s64 offen nt
s_add_u32 s64,s62,1048576
buffer_load_dwordx4 v[64:67],v7,s[36:39],s64 offen nt
s_add_u32 s64,s62,1179648
buffer_load_dwordx4 v[68:71],v7,s[36:39],s64 offen nt
s_add_u32 s64,s62,1310720
buffer_load_dwordx4 v[72:75],v7,s[36:39],s64 offen nt
s_add_u32 s64,s62,1441792
buffer_load_dwordx4 v[76:79],v7,s[36:39],s64 offen nt
s_add_u32 s64,s62,1572864
buffer_load_dwordx4 v[80:83],v7,s[36:39],s64 offen nt
s_add_u32 s64,s62,1703936
buffer_load_dwordx4 v[84:87],v7,s[36:39],s64 offen nt
s_add_u32 s64,s62,1835008
buffer_load_dwordx4 v[88:91],v7,s[36:39],s64 offen nt
s_add_u32 s64,s62,1966080
buffer_load_dwordx4 v[92:95],v7,s[36:39],s64 offen nt
s_barrier
s_add_u32 s64,s63,0
s_add_u32 m0,s61,0
s_nop 0
buffer_load_dwordx4 v8,s[40:43],s64 offen nt lds
s_add_u32 s64,s63,32768
s_add_u32 m0,s61,1024
s_nop 0
buffer_load_dwordx4 v8,s[40:43],s64 offen nt lds
s_add_u32 s64,s63,65536
s_add_u32 m0,s61,2048
s_nop 0
buffer_load_dwordx4 v8,s[40:43],s64 offen nt lds
s_add_u32 s64,s63,98304
s_add_u32 m0,s61,3072
s_nop 0
buffer_load_dwordx4 v8,s[40:43],s64 offen nt lds
s_add_u32 s64,s63,131072
s_add_u32 m0,s61,4096
s_nop 0
buffer_load_dwordx4 v8,s[40:43],s64 offen nt lds
s_add_u32 s64,s63,163840
s_add_u32 m0,s61,5120
s_nop 0
buffer_load_dwordx4 v8,s[40:43],s64 offen nt lds
s_add_u32 s64,s63,196608
s_add_u32 m0,s61,6144
s_nop 0
buffer_load_dwordx4 v8,s[40:43],s64 offen nt lds
s_add_u32 s64,s63,229376
s_add_u32 m0,s61,7168
s_nop 0
buffer_load_dwordx4 v8,s[40:43],s64 offen nt lds
s_add_u32 s64,s63,262144
s_add_u32 m0,s61,8192
s_nop 0
buffer_load_dwordx4 v8,s[40:43],s64 offen nt lds
s_add_u32 s64,s63,294912
s_add_u32 m0,s61,9216
s_nop 0
buffer_load_dwordx4 v8,s[40:43],s64 offen nt lds
s_add_u32 s64,s63,327680
s_add_u32 m0,s61,10240
s_nop 0
buffer_load_dwordx4 v8,s[40:43],s64 offen nt lds
s_add_u32 s64,s63,360448
s_add_u32 m0,s61,11264
s_nop 0
buffer_load_dwordx4 v8,s[40:43],s64 offen nt lds
s_add_u32 s64,s63,393216
s_add_u32 m0,s61,12288
s_nop 0
buffer_load_dwordx4 v8,s[40:43],s64 offen nt lds
s_add_u32 s64,s63,425984
s_add_u32 m0,s61,13312
s_nop 0
buffer_load_dwordx4 v8,s[40:43],s64 offen nt lds
s_add_u32 s64,s63,458752
s_add_u32 m0,s61,14336
s_nop 0
buffer_load_dwordx4 v8,s[40:43],s64 offen nt lds
s_add_u32 s64,s63,491520
s_add_u32 m0,s61,15360
s_nop 0
buffer_load_dwordx4 v8,s[40:43],s64 offen nt lds
s_waitcnt vmcnt(32)
s_barrier
s_bitcmp1_b32 s68,1
s_cbranch_scc0 ws_12
ds_read_b64_tr_b16 a[128:129],v191 offset:0
ds_read_b64_tr_b16 a[130:131],v191 offset:128
ds_read_b64_tr_b16 a[132:133],v191 offset:2048
ds_read_b64_tr_b16 a[134:135],v191 offset:2176
ds_read_b64_tr_b16 a[136:137],v191 offset:4096
ds_read_b64_tr_b16 a[138:139],v191 offset:4224
ds_read_b64_tr_b16 a[140:141],v191 offset:6144
ds_read_b64_tr_b16 a[142:143],v191 offset:6272
s_waitcnt lgkmcnt(0)
ds_read_b64_tr_b16 a[144:145],v191 offset:8192
ds_read_b64_tr_b16 a[146:147],v191 offset:8320
ds_read_b64_tr_b16 a[148:149],v191 offset:10240
ds_read_b64_tr_b16 a[150:151],v191 offset:10368
ds_read_b64_tr_b16 a[152:153],v191 offset:12288
ds_read_b64_tr_b16 a[154:155],v191 offset:12416
ds_read_b64_tr_b16 a[156:157],v191 offset:14336
ds_read_b64_tr_b16 a[158:159],v191 offset:14464
s_waitcnt lgkmcnt(0)
ds_read_b64_tr_b16 a[160:161],v191 offset:16384
ds_read_b64_tr_b16 a[162:163],v191 offset:16512
ds_read_b64_tr_b16 a[164:165],v191 offset:18432
ds_read_b64_tr_b16 a[166:167],v191 offset:18560
ds_read_b64_tr_b16 a[168:169],v191 offset:20480
ds_read_b64_tr_b16 a[170:171],v191 offset:20608
ds_read_b64_tr_b16 a[172:173],v191 offset:22528
ds_read_b64_tr_b16 a[174:175],v191 offset:22656
s_waitcnt lgkmcnt(0)
ds_read_b64_tr_b16 a[176:177],v191 offset:24576
ds_read_b64_tr_b16 a[178:179],v191 offset:24704
ds_read_b64_tr_b16 a[180:181],v191 offset:26624
ds_read_b64_tr_b16 a[182:183],v191 offset:26752
ds_read_b64_tr_b16 a[184:185],v191 offset:28672
ds_read_b64_tr_b16 a[186:187],v191 offset:28800
ds_read_b64_tr_b16 a[188:189],v191 offset:30720
ds_read_b64_tr_b16 a[190:191],v191 offset:30848
s_waitcnt lgkmcnt(0)
ds_read_b64_tr_b16 a[192:193],v191 offset:32768
ds_read_b64_tr_b16 a[194:195],v191 offset:32896
ds_read_b64_tr_b16 a[196:197],v191 offset:34816
ds_read_b64_tr_b16 a[198:199],v191 offset:34944
ds_read_b64_tr_b16 a[200:201],v191 offset:36864
ds_read_b64_tr_b16 a[202:203],v191 offset:36992
ds_read_b64_tr_b16 a[204:205],v191 offset:38912
ds_read_b64_tr_b16 a[206:207],v191 offset:39040
s_waitcnt lgkmcnt(0)
ds_read_b64_tr_b16 a[208:209],v191 offset:40960
ds_read_b64_tr_b16 a[210:211],v191 offset:41088
ds_read_b64_tr_b16 a[212:213],v191 offset:43008
ds_read_b64_tr_b16 a[214:215],v191 offset:43136
ds_read_b64_tr_b16 a[216:217],v191 offset:45056
ds_read_b64_tr_b16 a[218:219],v191 offset:45184
ds_read_b64_tr_b16 a[220:221],v191 offset:47104
ds_read_b64_tr_b16 a[222:223],v191 offset:47232
s_waitcnt lgkmcnt(0)
ds_read_b64_tr_b16 a[224:225],v191 offset:49152
ds_read_b64_tr_b16 a[226:227],v191 offset:49280
ds_read_b64_tr_b16 a[228:229],v191 offset:51200
ds_read_b64_tr_b16 a[230:231],v191 offset:51328
ds_read_b64_tr_b16 a[232:233],v191 offset:53248
ds_read_b64_tr_b16 a[234:235],v191 offset:53376
ds_read_b64_tr_b16 a[236:237],v191 offset:55296
ds_read_b64_tr_b16 a[238:239],v191 offset:55424
s_waitcnt lgkmcnt(0)
ds_read_b64_tr_b16 a[240:241],v191 offset:57344
ds_read_b64_tr_b16 a[242:243],v191 offset:57472
ds_read_b64_tr_b16 a[244:245],v191 offset:59392
ds_read_b64_tr_b16 a[246:247],v191 offset:59520
ds_read_b64_tr_b16 a[248:249],v191 offset:61440
ds_read_b64_tr_b16 a[250:251],v191 offset:61568
ds_read_b64_tr_b16 a[252:253],v191 offset:63488
ds_read_b64_tr_b16 a[254:255],v191 offset:63616
s_waitcnt lgkmcnt(0)
ws_12:
s_waitcnt vmcnt(16)
s_barrier
ds_write_b128 v193,v[32:35] offset:0
ds_write_b128 v193,v[36:39] offset:1024
ds_write_b128 v193,v[40:43] offset:2048
ds_write_b128 v193,v[44:47] offset:3072
ds_write_b128 v193,v[48:51] offset:4096
ds_write_b128 v193,v[52:55] offset:5120
ds_write_b128 v193,v[56:59] offset:6144
ds_write_b128 v193,v[60:63] offset:7168
ds_write_b128 v193,v[64:67] offset:8192
ds_write_b128 v193,v[68:71] offset:9216
ds_write_b128 v193,v[72:75] offset:10240
ds_write_b128 v193,v[76:79] offset:11264
ds_write_b128 v193,v[80:83] offset:12288
ds_write_b128 v193,v[84:87] offset:13312
ds_write_b128 v193,v[88:91] offset:14336
ds_write_b128 v193,v[92:95] offset:15360
s_mov_b32 s69,1
v_mov_b32 v190,v191
s_waitcnt lgkmcnt(0)
s_barrier
s_bitcmp1_b32 s68,1
s_cbranch_scc0 rq_15
rqb_16:
s_waitcnt vmcnt(0)
s_barrier
s_bitcmp1_b32 s68,1
s_cbranch_scc1 ws_13
ds_read_b64_tr_b16 a[128:129],v192 offset:0
ds_read_b64_tr_b16 a[130:131],v192 offset:128
ds_read_b64_tr_b16 a[132:133],v192 offset:2048
ds_read_b64_tr_b16 a[134:135],v192 offset:2176
ds_read_b64_tr_b16 a[136:137],v192 offset:32
ds_read_b64_tr_b16 a[138:139],v192 offset:160
ds_read_b64_tr_b16 a[140:141],v192 offset:2080
ds_read_b64_tr_b16 a[142:143],v192 offset:2208
s_waitcnt lgkmcnt(0)
ds_read_b64_tr_b16 a[144:145],v192 offset:4096
ds_read_b64_tr_b16 a[146:147],v192 offset:4224
ds_read_b64_tr_b16 a[148:149],v192 offset:6144
ds_read_b64_tr_b16 a[150:151],v192 offset:6272
ds_read_b64_tr_b16 a[152:153],v192 offset:4128
ds_read_b64_tr_b16 a[154:155],v192 offset:4256
ds_read_b64_tr_b16 a[156:157],v192 offset:6176
ds_read_b64_tr_b16 a[158:159],v192 offset:6304
s_waitcnt lgkmcnt(0)
ds_read_b64_tr_b16 a[160:161],v192 offset:8192
ds_read_b64_tr_b16 a[162:163],v192 offset:8320
ds_read_b64_tr_b16 a[164:165],v192 offset:10240
ds_read_b64_tr_b16 a[166:167],v192 offset:10368
ds_read_b64_tr_b16 a[168:169],v192 offset:8224
ds_read_b64_tr_b16 a[170:171],v192 offset:8352
ds_read_b64_tr_b16 a[172:173],v192 offset:10272
ds_read_b64_tr_b16 a[174:175],v192 offset:10400
s_waitcnt lgkmcnt(0)
ds_read_b64_tr_b16 a[176:177],v192 offset:12288
ds_read_b64_tr_b16 a[178:179],v192 offset:12416
ds_read_b64_tr_b16 a[180:181],v192 offset:14336
ds_read_b64_tr_b16 a[182:183],v192 offset:14464
ds_read_b64_tr_b16 a[184:185],v192 offset:12320
ds_read_b64_tr_b16 a[186:187],v192 offset:12448
ds_read_b64_tr_b16 a[188:189],v192 offset:14368
ds_read_b64_tr_b16 a[190:191],v192 offset:14496
s_waitcnt lgkmcnt(0)
ds_read_b64_tr_b16 a[192:193],v192 offset:16384
ds_read_b64_tr_b16 a[194:195],v192 offset:16512
ds_read_b64_tr_b16 a[196:197],v192 offset:18432
ds_read_b64_tr_b16 a[198:199],v192 offset:18560
ds_read_b64_tr_b16 a[200:201],v192 offset:16416
ds_read_b64_tr_b16 a[202:203],v192 offset:16544
ds_read_b64_tr_b16 a[204:205],v192 offset:18464
ds_read_b64_tr_b16 a[206:207],v192 offset:18592
s_waitcnt lgkmcnt(0)
ds_read_b64_tr_b16 a[208:209],v192 offset:20480
ds_read_b64_tr_b16 a[210:211],v192 offset:20608
ds_read_b64_tr_b16 a[212:213],v192 offset:22528
ds_read_b64_tr_b16 a[214:215],v192 offset:22656
ds_read_b64_tr_b16 a[216:217],v192 offset:20512
ds_read_b64_tr_b16 a[218:219],v192 offset:20640
ds_read_b64_tr_b16 a[220:221],v192 offset:22560
ds_read_b64_tr_b16 a[222:223],v192 offset:22688
s_waitcnt lgkmcnt(0)
ds_read_b64_tr_b16 a[224:225],v192 offset:24576
ds_read_b64_tr_b16 a[226:227],v192 offset:24704
ds_read_b64_tr_b16 a[228:229],v192 offset:26624
ds_read_b64_tr_b16 a[230:231],v192 offset:26752
ds_read_b64_tr_b16 a[232:233],v192 offset:24608
ds_read_b64_tr_b16 a[234:235],v192 offset:24736
ds_read_b64_tr_b16 a[236:237],v192 offset:26656
ds_read_b64_tr_b16 a[238:239],v192 offset:26784
s_waitcnt lgkmcnt(0)
ds_read_b64_tr_b16 a[240:241],v192 offset:28672
ds_read_b64_tr_b16 a[242:243],v192 offset:28800
ds_read_b64_tr_b16 a[244:245],v192 offset:30720
ds_read_b64_tr_b16 a[246:247],v192 offset:30848
ds_read_b64_tr_b16 a[248:249],v192 offset:28704
ds_read_b64_tr_b16 a[250:251],v192 offset:28832
ds_read_b64_tr_b16 a[252:253],v192 offset:30752
ds_read_b64_tr_b16 a[254:255],v192 offset:30880
s_waitcnt lgkmcnt(0)
ws_13:
v_mov_b32 v187,158976
s_cmp_lg_u32 s50,1
s_cbranch_scc1 sh0_17
v_readfirstlane_b32 s64,v204
s_cmp_lg_u32 s64,143
s_cbranch_scc1 narr_20
s_mov_b32 s65,0
s_cmp_eq_u32 s56,1
s_cbranch_scc1 nopar_21
v_mov_b32 v184,0
dp_22:
buffer_load_dword v185,v184,s[44:47],32 offen sc1
s_waitcnt vmcnt(0)
v_cmp_eq_u32 vcc,0,v185
s_cbranch_vccz dpok_23
s_sleep 4
s_sub_u32 s90,s90,1
s_cmp_gt_i32 s90,0
s_cbranch_scc1 dp_22
dpok_23:
v_readfirstlane_b32 s65,v185
s_and_b32 s65,s65,1
s_lshl_b32 s61,s65,13
nopar_21:
s_add_u32 s65,s65,2
v_lshlrev_b32 v184,7,v1
v_mov_b32 v185,s65
s_mov_b32 s64,21168128
s_mov_b32 s65,21176320
buffer_store_dword v185,v184,s[20:23],s64 offen sc1
buffer_store_dword v185,v184,s[20:23],s65 offen sc1
narr_20:
s_mov_b32 s53,0
stl_18:
v_mov_b32 v184,0
buffer_load_dword v185,v184,s[20:23],s52 offen sc1
s_waitcnt vmcnt(0)
v_readfirstlane_b32 s64,v185
s_mov_b32 s65,0
s_and_b32 s61,s64,1
s_lshl_b32 s61,s61,13
s_cmp_lg_u32 s64,0
s_cbranch_scc1 stok_19
s_sub_u32 s90,s90,1
s_cmp_lt_i32 s90,0
s_cbranch_scc1 stok_19
s_add_u32 s53,s53,1
s_and_b32 s64,s53,31
s_cbranch_scc1 stl_18
s_cmp_eq_u32 s56,1
s_cbranch_scc1 stl_18
v_and_b32 v184,3,v1
v_bfe_u32 v185,v1,2,1
v_lshlrev_b32 v184,2,v184
v_lshl_add_u32 v184,v185,7,v184
v_writelane_b32 v184,32,8
s_mov_b64 exec,0x1ff
vpoll_24:
buffer_load_dword v185,v184,s[44:47],0 offen sc1
s_waitcnt vmcnt(0)
v_readlane_b32 s92,v185,0
v_readlane_b32 s93,v185,1
v_readlane_b32 s94,v185,2
v_readlane_b32 s95,v185,3
v_readlane_b32 s96,v185,4
v_readlane_b32 s97,v185,5
v_readlane_b32 s98,v185,6
v_readlane_b32 s99,v185,7
v_readlane_b32 s61,v185,8
s_add_u32 s64,s92,s93
s_add_u32 s64,s64,s94
s_add_u32 s64,s64,s95
s_add_u32 s64,s64,s96
s_add_u32 s64,s64,s97
s_add_u32 s64,s64,s98
s_add_u32 s64,s64,s99
s_min_u32 s65,s92,s93
s_min_u32 s66,s94,s95
s_min_u32 s65,s65,s66
s_min_u32 s66,s96,s97
s_min_u32 s65,s65,s66
s_min_u32 s66,s98,s99
s_min_u32 s65,s65,s66
s_cmp_lt_u32 s65,32
s_cselect_b32 s65,1,0
s_cmp_lt_u32 s64,256
s_cbranch_scc1 vslp_26
s_branch vgot_25
vslp_26:
s_sleep 8
s_sub_u32 s90,s90,1
s_cmp_gt_i32 s90,0
s_cbranch_scc1 vpoll_24
vgot_25:
s_mov_b64 exec,-1
s_and_b32 s61,s61,1
s_lshl_b32 s61,s61,13
s_mov_b32 s66,s54
s_cmp_gt_u32 s51,0
s_cselect_b32 s64,s92,0
s_add_u32 s66,s66,s64
s_cmp_gt_u32 s51,1
s_cselect_b32 s64,s93,0
s_add_u32 s66,s66,s64
s_cmp_gt_u32 s51,2
s_cselect_b32 s64,s94,0
s_add_u32 s66,s66,s64
s_cmp_gt_u32 s51,3
s_cselect_b32 s64,s95,0
s_add_u32 s66,s66,s64
s_cmp_gt_u32 s51,4
s_cselect_b32 s64,s96,0
s_add_u32 s66,s66,s64
s_cmp_gt_u32 s51,5
s_cselect_b32 s64,s97,0
s_add_u32 s66,s66,s64
s_cmp_gt_u32 s51,6
s_cselect_b32 s64,s98,0
s_add_u32 s66,s66,s64
s_cmp_eq_u32 s65,0
s_cbranch_scc1 stl_18
stok_19:
v_mov_b32 v184,s65
v_mov_b32 v185,s66
v_mov_b32 v186,s61
ds_write_b96 v187,v[184:186] offset:16
s_waitcnt lgkmcnt(0)
sh0_17:
s_barrier
ds_read_b96 v[184:186],v187 offset:16
s_waitcnt lgkmcnt(0)
v_readfirstlane_b32 s65,v184
v_readfirstlane_b32 s66,v185
v_readfirstlane_b32 s61,v186
s_cmp_lg_u32 s65,0
s_cbranch_scc1 slowrole_10
s_and_b32 s56,s56,1
s_branch loops_7
pre_8:
s_sub_u32 s55,s57,128
s_load_dwordx4 s[4:7],s[0:1],96
s_load_dwordx2 s[8:9],s[0:1],0
v_and_b32 v1,63,v0
v_lshrrev_b32 v2,6,v0
v_and_b32 v3,7,v0
v_lshrrev_b32 v4,3,v0
v_mul_u32_u24 v5,12288,v4
v_lshl_add_u32 v5,v3,4,v5
v_lshlrev_b32 v6,1,v4
s_and_b32 s24,s55,31
s_lshr_b32 s25,s55,5
s_lshl_b32 s26,s24,7
s_mul_i32 s27,s25,3145728
s_add_u32 s26,s26,s27
s_lshl_b32 s27,s25,9
s_waitcnt lgkmcnt(0)
s_mov_b32 s12,s4
s_and_b32 s13,s5,0xffff
s_mov_b32 s14,0x800
s_mov_b32 s15,0x20000
s_mov_b32 s28,s6
s_and_b32 s29,s7,0xffff
s_mov_b32 s30,0xc00000
s_mov_b32 s31,0x20000
s_mov_b32 s32,s8
s_and_b32 s33,s9,0xffff
s_mov_b32 s34,0x400000
s_mov_b32 s35,0x20000
buffer_load_dwordx4 v[64:67],v5,s[28:31],s26 offen nt
s_add_u32 s26,s26,393216
buffer_load_dwordx4 v[68:71],v5,s[28:31],s26 offen nt
s_add_u32 s26,s26,393216
buffer_load_dwordx4 v[72:75],v5,s[28:31],s26 offen nt
s_add_u32 s26,s26,393216
buffer_load_dwordx4 v[76:79],v5,s[28:31],s26 offen nt
s_add_u32 s26,s26,393216
buffer_load_dwordx4 v[80:83],v5,s[28:31],s26 offen nt
s_add_u32 s26,s26,393216
buffer_load_dwordx4 v[84:87],v5,s[28:31],s26 offen nt
s_add_u32 s26,s26,393216
buffer_load_dwordx4 v[88:91],v5,s[28:31],s26 offen nt
s_add_u32 s26,s26,393216
buffer_load_dwordx4 v[92:95],v5,s[28:31],s26 offen nt
buffer_load_ushort v96,v6,s[12:15],s27 offen offset:0
buffer_load_ushort v97,v6,s[12:15],s27 offen offset:64
buffer_load_ushort v98,v6,s[12:15],s27 offen offset:128
buffer_load_ushort v99,v6,s[12:15],s27 offen offset:192
buffer_load_ushort v100,v6,s[12:15],s27 offen offset:256
buffer_load_ushort v101,v6,s[12:15],s27 offen offset:320
buffer_load_ushort v102,v6,s[12:15],s27 offen offset:384
buffer_load_ushort v103,v6,s[12:15],s27 offen offset:448
v_and_b32 v3,3,v1
v_lshrrev_b32 v4,2,v1
v_lshl_add_u32 v5,v2,2,v3
v_lshlrev_b32 v5,11,v5
v_lshl_add_u32 v5,v4,5,v5
s_lshl_b32 s36,s55,15
buffer_load_dwordx4 v[8:11],v5,s[32:35],s36 offen offset:0
buffer_load_dwordx4 v[12:15],v5,s[32:35],s36 offen offset:16
buffer_load_dwordx4 v[16:19],v5,s[32:35],s36 offen offset:512
buffer_load_dwordx4 v[20:23],v5,s[32:35],s36 offen offset:528
buffer_load_dwordx4 v[24:27],v5,s[32:35],s36 offen offset:1024
buffer_load_dwordx4 v[28:31],v5,s[32:35],s36 offen offset:1040
buffer_load_dwordx4 v[32:35],v5,s[32:35],s36 offen offset:1536
buffer_load_dwordx4 v[36:39],v5,s[32:35],s36 offen offset:1552
v_lshrrev_b32 v6,1,v4
v_lshlrev_b32 v6,11,v6
v_and_b32 v7,1,v4
v_lshl_add_u32 v6,v7,9,v6
v_and_b32 v7,1,v2
v_lshl_add_u32 v6,v7,10,v6
v_lshrrev_b32 v7,1,v2
v_lshl_add_u32 v7,v7,2,v3
v_lshl_add_u32 v6,v7,4,v6
v_lshlrev_b32 v4,6,v4
s_lshr_b32 s37,s55,1
s_lshl_b32 s37,s37,16
s_and_b32 s38,s55,1
s_lshl_b32 s38,s38,7
s_add_u32 s37,s37,s38
s_add_u32 s37,s37,57344
s_mov_b32 s38,0xbfb8aa3b
s_mov_b32 s39,0xffff0000
s_cmp_lg_u32 s50,1
s_cbranch_scc1 nz_27
s_lshl_b32 s40,s55,9
s_add_u32 s40,s40,21037056
v_lshl_add_u32 v104,v1,4,s40
s_lshl_b32 s41,s55,7
s_add_u32 s41,s41,21102592
v_writelane_b32 v104,s41,32
v_mov_b32 v108,0
v_mov_b32 v109,0
v_mov_b32 v110,0
v_mov_b32 v111,0
s_mov_b32 exec_hi,1
buffer_store_dwordx4 v[108:111],v104,s[20:23],0 offen sc1
s_mov_b64 exec,-1
nz_27:
v_mov_b32 v112,0
v_mov_b32 v113,0
v_mov_b32 v114,0
v_mov_b32 v115,0
v_mov_b32 v116,0
v_mov_b32 v117,0
v_mov_b32 v118,0
v_mov_b32 v119,0
s_waitcnt vmcnt(8)
v_lshlrev_b32 v96,16,v96
v_mul_f32 v104,s38,v96
v_exp_f32 v104,v104
s_nop 0
v_add_f32 v104,1.0,v104
v_rcp_f32 v104,v104
s_nop 0
v_mul_f32 v104,v104,v96
v_cvt_pk_bf16_f32 v104,v104,v104
v_and_b32 v96,s39,v104
v_lshlrev_b32 v105,16,v64
v_and_b32 v106,s39,v64
v_fmac_f32 v112,v105,v96
v_fmac_f32 v113,v106,v96
v_lshlrev_b32 v105,16,v65
v_and_b32 v106,s39,v65
v_fmac_f32 v114,v105,v96
v_fmac_f32 v115,v106,v96
v_lshlrev_b32 v105,16,v66
v_and_b32 v106,s39,v66
v_fmac_f32 v116,v105,v96
v_fmac_f32 v117,v106,v96
v_lshlrev_b32 v105,16,v67
v_and_b32 v106,s39,v67
v_fmac_f32 v118,v105,v96
v_fmac_f32 v119,v106,v96
v_lshlrev_b32 v97,16,v97
v_mul_f32 v104,s38,v97
v_exp_f32 v104,v104
s_nop 0
v_add_f32 v104,1.0,v104
v_rcp_f32 v104,v104
s_nop 0
v_mul_f32 v104,v104,v97
v_cvt_pk_bf16_f32 v104,v104,v104
v_and_b32 v97,s39,v104
v_lshlrev_b32 v105,16,v68
v_and_b32 v106,s39,v68
v_fmac_f32 v112,v105,v97
v_fmac_f32 v113,v106,v97
v_lshlrev_b32 v105,16,v69
v_and_b32 v106,s39,v69
v_fmac_f32 v114,v105,v97
v_fmac_f32 v115,v106,v97
v_lshlrev_b32 v105,16,v70
v_and_b32 v106,s39,v70
v_fmac_f32 v116,v105,v97
v_fmac_f32 v117,v106,v97
v_lshlrev_b32 v105,16,v71
v_and_b32 v106,s39,v71
v_fmac_f32 v118,v105,v97
v_fmac_f32 v119,v106,v97
v_lshlrev_b32 v98,16,v98
v_mul_f32 v104,s38,v98
v_exp_f32 v104,v104
s_nop 0
v_add_f32 v104,1.0,v104
v_rcp_f32 v104,v104
s_nop 0
v_mul_f32 v104,v104,v98
v_cvt_pk_bf16_f32 v104,v104,v104
v_and_b32 v98,s39,v104
v_lshlrev_b32 v105,16,v72
v_and_b32 v106,s39,v72
v_fmac_f32 v112,v105,v98
v_fmac_f32 v113,v106,v98
v_lshlrev_b32 v105,16,v73
v_and_b32 v106,s39,v73
v_fmac_f32 v114,v105,v98
v_fmac_f32 v115,v106,v98
v_lshlrev_b32 v105,16,v74
v_and_b32 v106,s39,v74
v_fmac_f32 v116,v105,v98
v_fmac_f32 v117,v106,v98
v_lshlrev_b32 v105,16,v75
v_and_b32 v106,s39,v75
v_fmac_f32 v118,v105,v98
v_fmac_f32 v119,v106,v98
v_lshlrev_b32 v99,16,v99
v_mul_f32 v104,s38,v99
v_exp_f32 v104,v104
s_nop 0
v_add_f32 v104,1.0,v104
v_rcp_f32 v104,v104
s_nop 0
v_mul_f32 v104,v104,v99
v_cvt_pk_bf16_f32 v104,v104,v104
v_and_b32 v99,s39,v104
v_lshlrev_b32 v105,16,v76
v_and_b32 v106,s39,v76
v_fmac_f32 v112,v105,v99
v_fmac_f32 v113,v106,v99
v_lshlrev_b32 v105,16,v77
v_and_b32 v106,s39,v77
v_fmac_f32 v114,v105,v99
v_fmac_f32 v115,v106,v99
v_lshlrev_b32 v105,16,v78
v_and_b32 v106,s39,v78
v_fmac_f32 v116,v105,v99
v_fmac_f32 v117,v106,v99
v_lshlrev_b32 v105,16,v79
v_and_b32 v106,s39,v79
v_fmac_f32 v118,v105,v99
v_fmac_f32 v119,v106,v99
v_lshlrev_b32 v100,16,v100
v_mul_f32 v104,s38,v100
v_exp_f32 v104,v104
s_nop 0
v_add_f32 v104,1.0,v104
v_rcp_f32 v104,v104
s_nop 0
v_mul_f32 v104,v104,v100
v_cvt_pk_bf16_f32 v104,v104,v104
v_and_b32 v100,s39,v104
v_lshlrev_b32 v105,16,v80
v_and_b32 v106,s39,v80
v_fmac_f32 v112,v105,v100
v_fmac_f32 v113,v106,v100
v_lshlrev_b32 v105,16,v81
v_and_b32 v106,s39,v81
v_fmac_f32 v114,v105,v100
v_fmac_f32 v115,v106,v100
v_lshlrev_b32 v105,16,v82
v_and_b32 v106,s39,v82
v_fmac_f32 v116,v105,v100
v_fmac_f32 v117,v106,v100
v_lshlrev_b32 v105,16,v83
v_and_b32 v106,s39,v83
v_fmac_f32 v118,v105,v100
v_fmac_f32 v119,v106,v100
v_lshlrev_b32 v101,16,v101
v_mul_f32 v104,s38,v101
v_exp_f32 v104,v104
s_nop 0
v_add_f32 v104,1.0,v104
v_rcp_f32 v104,v104
s_nop 0
v_mul_f32 v104,v104,v101
v_cvt_pk_bf16_f32 v104,v104,v104
v_and_b32 v101,s39,v104
v_lshlrev_b32 v105,16,v84
v_and_b32 v106,s39,v84
v_fmac_f32 v112,v105,v101
v_fmac_f32 v113,v106,v101
v_lshlrev_b32 v105,16,v85
v_and_b32 v106,s39,v85
v_fmac_f32 v114,v105,v101
v_fmac_f32 v115,v106,v101
v_lshlrev_b32 v105,16,v86
v_and_b32 v106,s39,v86
v_fmac_f32 v116,v105,v101
v_fmac_f32 v117,v106,v101
v_lshlrev_b32 v105,16,v87
v_and_b32 v106,s39,v87
v_fmac_f32 v118,v105,v101
v_fmac_f32 v119,v106,v101
v_lshlrev_b32 v102,16,v102
v_mul_f32 v104,s38,v102
v_exp_f32 v104,v104
s_nop 0
v_add_f32 v104,1.0,v104
v_rcp_f32 v104,v104
s_nop 0
v_mul_f32 v104,v104,v102
v_cvt_pk_bf16_f32 v104,v104,v104
v_and_b32 v102,s39,v104
v_lshlrev_b32 v105,16,v88
v_and_b32 v106,s39,v88
v_fmac_f32 v112,v105,v102
v_fmac_f32 v113,v106,v102
v_lshlrev_b32 v105,16,v89
v_and_b32 v106,s39,v89
v_fmac_f32 v114,v105,v102
v_fmac_f32 v115,v106,v102
v_lshlrev_b32 v105,16,v90
v_and_b32 v106,s39,v90
v_fmac_f32 v116,v105,v102
v_fmac_f32 v117,v106,v102
v_lshlrev_b32 v105,16,v91
v_and_b32 v106,s39,v91
v_fmac_f32 v118,v105,v102
v_fmac_f32 v119,v106,v102
v_lshlrev_b32 v103,16,v103
v_mul_f32 v104,s38,v103
v_exp_f32 v104,v104
s_nop 0
v_add_f32 v104,1.0,v104
v_rcp_f32 v104,v104
s_nop 0
v_mul_f32 v104,v104,v103
v_cvt_pk_bf16_f32 v104,v104,v104
v_and_b32 v103,s39,v104
v_lshlrev_b32 v105,16,v92
v_and_b32 v106,s39,v92
v_fmac_f32 v112,v105,v103
v_fmac_f32 v113,v106,v103
v_lshlrev_b32 v105,16,v93
v_and_b32 v106,s39,v93
v_fmac_f32 v114,v105,v103
v_fmac_f32 v115,v106,v103
v_lshlrev_b32 v105,16,v94
v_and_b32 v106,s39,v94
v_fmac_f32 v116,v105,v103
v_fmac_f32 v117,v106,v103
v_lshlrev_b32 v105,16,v95
v_and_b32 v106,s39,v95
v_fmac_f32 v118,v105,v103
v_fmac_f32 v119,v106,v103
v_permlane32_swap_b32 v112,v116
v_permlane32_swap_b32 v113,v117
v_permlane32_swap_b32 v114,v118
v_permlane32_swap_b32 v115,v119
v_add_f32 v112,v112,v116
v_add_f32 v113,v113,v117
v_add_f32 v114,v114,v118
v_add_f32 v115,v115,v119
s_nop 0
v_permlane16_swap_b32 v112,v114
v_permlane16_swap_b32 v113,v115
v_add_f32 v112,v112,v114
v_add_f32 v113,v113,v115
s_nop 0
v_add_f32_dpp v112,v112,v112 row_ror:8 row_mask:0xf bank_mask:0xf
v_add_f32_dpp v113,v113,v113 row_ror:8 row_mask:0xf bank_mask:0xf
v_and_b32 v104,7,v1
v_lshlrev_b32 v104,5,v104
v_lshrrev_b32 v105,5,v1
v_lshl_add_u32 v104,v105,4,v104
v_bfe_u32 v105,v1,4,1
v_lshl_add_u32 v104,v105,3,v104
v_lshl_add_u32 v104,v2,8,v104
ds_write_b64 v104,v[112:113]
v_lshlrev_b32 v105,2,v1
s_lshl_b32 s40,s25,13
s_lshl_b32 s41,s24,8
s_add_u32 s40,s40,s41
s_add_u32 s40,s40,24576
s_waitcnt lgkmcnt(0)
s_barrier
s_cmp_lg_u32 s50,0
s_cbranch_scc1 m1n0_28
ds_read_b32 v112,v105 offset:0
ds_read_b32 v113,v105 offset:256
ds_read_b32 v114,v105 offset:512
ds_read_b32 v115,v105 offset:768
s_waitcnt lgkmcnt(0)
v_add_f32 v112,v112,v113
v_add_f32 v114,v114,v115
v_add_f32 v112,v112,v114
buffer_store_dword v112,v105,s[20:23],s40 offen sc1
m1n0_28:
s_waitcnt vmcnt(0)
s_barrier
s_cmp_lg_u32 s50,0
s_cbranch_scc1 post_9
s_mov_b64 exec,1
v_mov_b32 v184,1
v_mov_b32 v185,0
s_and_b32 s52,s56,1
s_lshl_b32 s52,s52,2
s_add_u32 s52,s52,160
buffer_atomic_add v184,v185,s[44:47],s52 offen sc0 sc1
s_waitcnt vmcnt(0)
v_readfirstlane_b32 s64,v184
s_mov_b64 exec,-1
s_cmp_eq_u32 s56,1
s_cbranch_scc1 post_9
s_cmp_lg_u32 s64,127
s_cbranch_scc1 post_9
v_and_b32 v184,3,v1
v_bfe_u32 v185,v1,2,1
v_lshlrev_b32 v184,2,v184
v_lshl_add_u32 v184,v185,7,v184
v_writelane_b32 v184,32,8
s_mov_b64 exec,0x1ff
vpoll_30:
buffer_load_dword v185,v184,s[44:47],0 offen sc1
s_waitcnt vmcnt(0)
v_readlane_b32 s92,v185,0
v_readlane_b32 s93,v185,1
v_readlane_b32 s94,v185,2
v_readlane_b32 s95,v185,3
v_readlane_b32 s96,v185,4
v_readlane_b32 s97,v185,5
v_readlane_b32 s98,v185,6
v_readlane_b32 s99,v185,7
v_readlane_b32 s61,v185,8
s_add_u32 s64,s92,s93
s_add_u32 s64,s64,s94
s_add_u32 s64,s64,s95
s_add_u32 s64,s64,s96
s_add_u32 s64,s64,s97
s_add_u32 s64,s64,s98
s_add_u32 s64,s64,s99
s_min_u32 s65,s92,s93
s_min_u32 s66,s94,s95
s_min_u32 s65,s65,s66
s_min_u32 s66,s96,s97
s_min_u32 s65,s65,s66
s_min_u32 s66,s98,s99
s_min_u32 s65,s65,s66
s_cmp_lt_u32 s65,32
s_cselect_b32 s65,1,0
s_cmp_lt_u32 s64,256
s_cbranch_scc1 vslp_32
s_branch vgot_31
vslp_32:
s_sleep 8
s_sub_u32 s90,s90,1
s_cmp_gt_i32 s90,0
s_cbranch_scc1 vpoll_30
vgot_31:
s_mov_b64 exec,-1
s_and_b32 s61,s61,1
s_lshl_b32 s61,s61,13
s_cmp_lg_u32 s65,0
s_cbranch_scc1 post_9
v_lshlrev_b32 v184,7,v1
v_mov_b32 v185,1
s_mov_b32 s64,21102592
s_mov_b32 s65,21110784
buffer_store_dword v185,v184,s[20:23],s64 offen sc1
buffer_store_dword v185,v184,s[20:23],s65 offen sc1
s_branch post_9
verify_6:
v_mov_b32 v187,158976
s_cmp_lg_u32 s50,0
s_cbranch_scc1 sh0_33
v_and_b32 v184,3,v1
v_bfe_u32 v185,v1,2,1
v_lshlrev_b32 v184,2,v184
v_lshl_add_u32 v184,v185,7,v184
v_writelane_b32 v184,32,8
s_mov_b64 exec,0x1ff
vpoll_34:
buffer_load_dword v185,v184,s[44:47],0 offen sc1
s_waitcnt vmcnt(0)
v_readlane_b32 s92,v185,0
v_readlane_b32 s93,v185,1
v_readlane_b32 s94,v185,2
v_readlane_b32 s95,v185,3
v_readlane_b32 s96,v185,4
v_readlane_b32 s97,v185,5
v_readlane_b32 s98,v185,6
v_readlane_b32 s99,v185,7
v_readlane_b32 s61,v185,8
s_add_u32 s64,s92,s93
s_add_u32 s64,s64,s94
s_add_u32 s64,s64,s95
s_add_u32 s64,s64,s96
s_add_u32 s64,s64,s97
s_add_u32 s64,s64,s98
s_add_u32 s64,s64,s99
s_min_u32 s65,s92,s93
s_min_u32 s66,s94,s95
s_min_u32 s65,s65,s66
s_min_u32 s66,s96,s97
s_min_u32 s65,s65,s66
s_min_u32 s66,s98,s99
s_min_u32 s65,s65,s66
s_cmp_lt_u32 s65,32
s_cselect_b32 s65,1,0
s_cmp_lt_u32 s64,256
s_cbranch_scc1 vslp_36
s_branch vgot_35
vslp_36:
s_sleep 8
s_sub_u32 s90,s90,1
s_cmp_gt_i32 s90,0
s_cbranch_scc1 vpoll_34
vgot_35:
s_mov_b64 exec,-1
s_and_b32 s61,s61,1
s_lshl_b32 s61,s61,13
s_mov_b32 s66,s54
s_cmp_gt_u32 s51,0
s_cselect_b32 s64,s92,0
s_add_u32 s66,s66,s64
s_cmp_gt_u32 s51,1
s_cselect_b32 s64,s93,0
s_add_u32 s66,s66,s64
s_cmp_gt_u32 s51,2
s_cselect_b32 s64,s94,0
s_add_u32 s66,s66,s64
s_cmp_gt_u32 s51,3
s_cselect_b32 s64,s95,0
s_add_u32 s66,s66,s64
s_cmp_gt_u32 s51,4
s_cselect_b32 s64,s96,0
s_add_u32 s66,s66,s64
s_cmp_gt_u32 s51,5
s_cselect_b32 s64,s97,0
s_add_u32 s66,s66,s64
s_cmp_gt_u32 s51,6
s_cselect_b32 s64,s98,0
s_add_u32 s66,s66,s64
v_mov_b32 v184,s65
v_mov_b32 v185,s66
v_mov_b32 v186,s61
ds_write_b96 v187,v[184:186] offset:16
s_waitcnt lgkmcnt(0)
sh0_33:
s_barrier
ds_read_b96 v[184:186],v187 offset:16
s_waitcnt lgkmcnt(0)
v_readfirstlane_b32 s65,v184
v_readfirstlane_b32 s66,v185
v_readfirstlane_b32 s61,v186
s_cmp_lg_u32 s65,0
s_cbranch_scc1 slowrole_10
s_mov_b32 s56,0
s_branch done_1
slowrole_10:
s_mov_b32 s57,s66
s_mov_b32 s56,1
s_waitcnt vmcnt(0)
s_barrier
s_cmp_ge_u32 s57,128
s_cbranch_scc1 pre_8
s_cmp_lg_u32 s50,0
s_cbranch_scc1 nadd_37
s_mov_b64 exec,1
v_mov_b32 v184,1
v_mov_b32 v185,0
s_mov_b32 s52,164
buffer_atomic_add v184,v185,s[44:47],s52 offen sc1
s_mov_b64 exec,-1
nadd_37:
s_branch setup_5
post_9:
s_sub_u32 s65,s57,255
s_and_b32 s66,s56,1
s_or_b32 s65,s65,s66
s_or_b32 s65,s65,s50
s_cmp_lg_u32 s65,0
s_cbranch_scc1 nomeas_38
s_mov_b64 exec,1
v_mov_b32 v184,0
s_mov_b32 s52,20971520
s_mov_b32 s53,20979712
s_mov_b32 s70,0x7fffffff
s_mov_b32 s71,0x7fffffff
s_memtime s[72:73]
s_waitcnt lgkmcnt(0)
buffer_store_dword v184,v184,s[20:23],s52 offen sc1
s_waitcnt vmcnt(0)
s_memtime s[74:75]
s_waitcnt lgkmcnt(0)
s_sub_u32 s74,s74,s72
s_min_u32 s70,s70,s74
s_memtime s[72:73]
s_waitcnt lgkmcnt(0)
buffer_store_dword v184,v184,s[20:23],s53 offen sc1
s_waitcnt vmcnt(0)
s_memtime s[74:75]
s_waitcnt lgkmcnt(0)
s_sub_u32 s74,s74,s72
s_min_u32 s71,s71,s74
s_memtime s[72:73]
s_waitcnt lgkmcnt(0)
buffer_store_dword v184,v184,s[20:23],s52 offen sc1
s_waitcnt vmcnt(0)
s_memtime s[74:75]
s_waitcnt lgkmcnt(0)
s_sub_u32 s74,s74,s72
s_min_u32 s70,s70,s74
s_memtime s[72:73]
s_waitcnt lgkmcnt(0)
buffer_store_dword v184,v184,s[20:23],s53 offen sc1
s_waitcnt vmcnt(0)
s_memtime s[74:75]
s_waitcnt lgkmcnt(0)
s_sub_u32 s74,s74,s72
s_min_u32 s71,s71,s74
s_memtime s[72:73]
s_waitcnt lgkmcnt(0)
buffer_store_dword v184,v184,s[20:23],s52 offen sc1
s_waitcnt vmcnt(0)
s_memtime s[74:75]
s_waitcnt lgkmcnt(0)
s_sub_u32 s74,s74,s72
s_min_u32 s70,s70,s74
s_memtime s[72:73]
s_waitcnt lgkmcnt(0)
buffer_store_dword v184,v184,s[20:23],s53 offen sc1
s_waitcnt vmcnt(0)
s_memtime s[74:75]
s_waitcnt lgkmcnt(0)
s_sub_u32 s74,s74,s72
s_min_u32 s71,s71,s74
s_memtime s[72:73]
s_waitcnt lgkmcnt(0)
buffer_store_dword v184,v184,s[20:23],s52 offen sc1
s_waitcnt vmcnt(0)
s_memtime s[74:75]
s_waitcnt lgkmcnt(0)
s_sub_u32 s74,s74,s72
s_min_u32 s70,s70,s74
s_memtime s[72:73]
s_waitcnt lgkmcnt(0)
buffer_store_dword v184,v184,s[20:23],s53 offen sc1
s_waitcnt vmcnt(0)
s_memtime s[74:75]
s_waitcnt lgkmcnt(0)
s_sub_u32 s74,s74,s72
s_min_u32 s71,s71,s74
s_cmp_gt_u32 s71,s70
s_cselect_b32 s65,3,2
v_mov_b32 v185,s65
buffer_store_dword v185,v184,s[44:47],32 offen sc1
s_mov_b64 exec,-1
nomeas_38:
v_and_b32 v103,s39,v39
v_lshlrev_b32 v102,16,v39
v_and_b32 v101,s39,v38
v_lshlrev_b32 v100,16,v38
v_and_b32 v99,s39,v37
v_lshlrev_b32 v98,16,v37
v_and_b32 v97,s39,v36
v_lshlrev_b32 v96,16,v36
v_and_b32 v95,s39,v35
v_lshlrev_b32 v94,16,v35
v_and_b32 v93,s39,v34
v_lshlrev_b32 v92,16,v34
v_and_b32 v91,s39,v33
v_lshlrev_b32 v90,16,v33
v_and_b32 v89,s39,v32
v_lshlrev_b32 v88,16,v32
v_and_b32 v87,s39,v31
v_lshlrev_b32 v86,16,v31
v_and_b32 v85,s39,v30
v_lshlrev_b32 v84,16,v30
v_and_b32 v83,s39,v29
v_lshlrev_b32 v82,16,v29
v_and_b32 v81,s39,v28
v_lshlrev_b32 v80,16,v28
v_and_b32 v79,s39,v27
v_lshlrev_b32 v78,16,v27
v_and_b32 v77,s39,v26
v_lshlrev_b32 v76,16,v26
v_and_b32 v75,s39,v25
v_lshlrev_b32 v74,16,v25
v_and_b32 v73,s39,v24
v_lshlrev_b32 v72,16,v24
v_and_b32 v71,s39,v23
v_lshlrev_b32 v70,16,v23
v_and_b32 v69,s39,v22
v_lshlrev_b32 v68,16,v22
v_and_b32 v67,s39,v21
v_lshlrev_b32 v66,16,v21
v_and_b32 v65,s39,v20
v_lshlrev_b32 v64,16,v20
v_and_b32 v63,s39,v19
v_lshlrev_b32 v62,16,v19
v_and_b32 v61,s39,v18
v_lshlrev_b32 v60,16,v18
v_and_b32 v59,s39,v17
v_lshlrev_b32 v58,16,v17
v_and_b32 v57,s39,v16
v_lshlrev_b32 v56,16,v16
v_and_b32 v55,s39,v15
v_lshlrev_b32 v54,16,v15
v_and_b32 v53,s39,v14
v_lshlrev_b32 v52,16,v14
v_and_b32 v51,s39,v13
v_lshlrev_b32 v50,16,v13
v_and_b32 v49,s39,v12
v_lshlrev_b32 v48,16,v12
v_and_b32 v47,s39,v11
v_lshlrev_b32 v46,16,v11
v_and_b32 v45,s39,v10
v_lshlrev_b32 v44,16,v10
v_and_b32 v43,s39,v9
v_lshlrev_b32 v42,16,v9
v_and_b32 v41,s39,v8
v_lshlrev_b32 v40,16,v8
v_pk_add_f32 v[8:9],v[40:41],v[42:43]
v_pk_add_f32 v[10:11],v[44:45],v[46:47]
v_pk_add_f32 v[8:9],v[8:9],v[48:49]
v_pk_add_f32 v[10:11],v[10:11],v[50:51]
v_pk_add_f32 v[8:9],v[8:9],v[52:53]
v_pk_add_f32 v[10:11],v[10:11],v[54:55]
v_pk_add_f32 v[8:9],v[8:9],v[56:57]
v_pk_add_f32 v[10:11],v[10:11],v[58:59]
v_pk_add_f32 v[8:9],v[8:9],v[60:61]
v_pk_add_f32 v[10:11],v[10:11],v[62:63]
v_pk_add_f32 v[8:9],v[8:9],v[64:65]
v_pk_add_f32 v[10:11],v[10:11],v[66:67]
v_pk_add_f32 v[8:9],v[8:9],v[68:69]
v_pk_add_f32 v[10:11],v[10:11],v[70:71]
v_pk_add_f32 v[8:9],v[8:9],v[72:73]
v_pk_add_f32 v[10:11],v[10:11],v[74:75]
v_pk_add_f32 v[8:9],v[8:9],v[76:77]
v_pk_add_f32 v[10:11],v[10:11],v[78:79]
v_pk_add_f32 v[8:9],v[8:9],v[80:81]
v_pk_add_f32 v[10:11],v[10:11],v[82:83]
v_pk_add_f32 v[8:9],v[8:9],v[84:85]
v_pk_add_f32 v[10:11],v[10:11],v[86:87]
v_pk_add_f32 v[8:9],v[8:9],v[88:89]
v_pk_add_f32 v[10:11],v[10:11],v[90:91]
v_pk_add_f32 v[8:9],v[8:9],v[92:93]
v_pk_add_f32 v[10:11],v[10:11],v[94:95]
v_pk_add_f32 v[8:9],v[8:9],v[96:97]
v_pk_add_f32 v[10:11],v[10:11],v[98:99]
v_pk_add_f32 v[8:9],v[8:9],v[100:101]
v_pk_add_f32 v[10:11],v[10:11],v[102:103]
v_pk_add_f32 v[8:9],v[8:9],v[10:11]
v_add_f32 v8,v8,v9
s_nop 1
v_add_f32_dpp v8,v8,v8 row_ror:4 row_mask:0xf bank_mask:0xf
s_nop 1
v_add_f32_dpp v8,v8,v8 row_ror:8 row_mask:0xf bank_mask:0xf
v_mov_b32 v12,v8
s_nop 1
v_permlane16_swap_b32 v12,v8
v_add_f32 v8,v8,v12
v_mov_b32 v12,v8
s_nop 1
v_permlane32_swap_b32 v12,v8
v_add_f32 v8,v8,v12
v_mul_f32 v8,0xba800000,v8
v_pk_add_f32 v[40:41],v[40:41],v[8:9] op_sel_hi:[1,0]
v_pk_add_f32 v[42:43],v[42:43],v[8:9] op_sel_hi:[1,0]
v_pk_add_f32 v[44:45],v[44:45],v[8:9] op_sel_hi:[1,0]
v_pk_add_f32 v[46:47],v[46:47],v[8:9] op_sel_hi:[1,0]
v_pk_add_f32 v[48:49],v[48:49],v[8:9] op_sel_hi:[1,0]
v_pk_add_f32 v[50:51],v[50:51],v[8:9] op_sel_hi:[1,0]
v_pk_add_f32 v[52:53],v[52:53],v[8:9] op_sel_hi:[1,0]
v_pk_add_f32 v[54:55],v[54:55],v[8:9] op_sel_hi:[1,0]
v_pk_add_f32 v[56:57],v[56:57],v[8:9] op_sel_hi:[1,0]
v_pk_add_f32 v[58:59],v[58:59],v[8:9] op_sel_hi:[1,0]
v_pk_add_f32 v[60:61],v[60:61],v[8:9] op_sel_hi:[1,0]
v_pk_add_f32 v[62:63],v[62:63],v[8:9] op_sel_hi:[1,0]
v_pk_add_f32 v[64:65],v[64:65],v[8:9] op_sel_hi:[1,0]
v_pk_add_f32 v[66:67],v[66:67],v[8:9] op_sel_hi:[1,0]
v_pk_add_f32 v[68:69],v[68:69],v[8:9] op_sel_hi:[1,0]
v_pk_add_f32 v[70:71],v[70:71],v[8:9] op_sel_hi:[1,0]
v_pk_add_f32 v[72:73],v[72:73],v[8:9] op_sel_hi:[1,0]
v_pk_add_f32 v[74:75],v[74:75],v[8:9] op_sel_hi:[1,0]
v_pk_add_f32 v[76:77],v[76:77],v[8:9] op_sel_hi:[1,0]
v_pk_add_f32 v[78:79],v[78:79],v[8:9] op_sel_hi:[1,0]
v_pk_add_f32 v[80:81],v[80:81],v[8:9] op_sel_hi:[1,0]
v_pk_add_f32 v[82:83],v[82:83],v[8:9] op_sel_hi:[1,0]
v_pk_add_f32 v[84:85],v[84:85],v[8:9] op_sel_hi:[1,0]
v_pk_add_f32 v[86:87],v[86:87],v[8:9] op_sel_hi:[1,0]
v_pk_add_f32 v[88:89],v[88:89],v[8:9] op_sel_hi:[1,0]
v_pk_add_f32 v[90:91],v[90:91],v[8:9] op_sel_hi:[1,0]
v_pk_add_f32 v[92:93],v[92:93],v[8:9] op_sel_hi:[1,0]
v_pk_add_f32 v[94:95],v[94:95],v[8:9] op_sel_hi:[1,0]
v_pk_add_f32 v[96:97],v[96:97],v[8:9] op_sel_hi:[1,0]
v_pk_add_f32 v[98:99],v[98:99],v[8:9] op_sel_hi:[1,0]
v_pk_add_f32 v[100:101],v[100:101],v[8:9] op_sel_hi:[1,0]
v_pk_add_f32 v[102:103],v[102:103],v[8:9] op_sel_hi:[1,0]
v_pk_mul_f32 v[10:11],v[40:41],v[40:41]
v_pk_mul_f32 v[14:15],v[42:43],v[42:43]
v_pk_fma_f32 v[10:11],v[44:45],v[44:45],v[10:11]
v_pk_fma_f32 v[14:15],v[46:47],v[46:47],v[14:15]
v_pk_fma_f32 v[10:11],v[48:49],v[48:49],v[10:11]
v_pk_fma_f32 v[14:15],v[50:51],v[50:51],v[14:15]
v_pk_fma_f32 v[10:11],v[52:53],v[52:53],v[10:11]
v_pk_fma_f32 v[14:15],v[54:55],v[54:55],v[14:15]
v_pk_fma_f32 v[10:11],v[56:57],v[56:57],v[10:11]
v_pk_fma_f32 v[14:15],v[58:59],v[58:59],v[14:15]
v_pk_fma_f32 v[10:11],v[60:61],v[60:61],v[10:11]
v_pk_fma_f32 v[14:15],v[62:63],v[62:63],v[14:15]
v_pk_fma_f32 v[10:11],v[64:65],v[64:65],v[10:11]
v_pk_fma_f32 v[14:15],v[66:67],v[66:67],v[14:15]
v_pk_fma_f32 v[10:11],v[68:69],v[68:69],v[10:11]
v_pk_fma_f32 v[14:15],v[70:71],v[70:71],v[14:15]
v_pk_fma_f32 v[10:11],v[72:73],v[72:73],v[10:11]
v_pk_fma_f32 v[14:15],v[74:75],v[74:75],v[14:15]
v_pk_fma_f32 v[10:11],v[76:77],v[76:77],v[10:11]
v_pk_fma_f32 v[14:15],v[78:79],v[78:79],v[14:15]
v_pk_fma_f32 v[10:11],v[80:81],v[80:81],v[10:11]
v_pk_fma_f32 v[14:15],v[82:83],v[82:83],v[14:15]
v_pk_fma_f32 v[10:11],v[84:85],v[84:85],v[10:11]
v_pk_fma_f32 v[14:15],v[86:87],v[86:87],v[14:15]
v_pk_fma_f32 v[10:11],v[88:89],v[88:89],v[10:11]
v_pk_fma_f32 v[14:15],v[90:91],v[90:91],v[14:15]
v_pk_fma_f32 v[10:11],v[92:93],v[92:93],v[10:11]
v_pk_fma_f32 v[14:15],v[94:95],v[94:95],v[14:15]
v_pk_fma_f32 v[10:11],v[96:97],v[96:97],v[10:11]
v_pk_fma_f32 v[14:15],v[98:99],v[98:99],v[14:15]
v_pk_fma_f32 v[10:11],v[100:101],v[100:101],v[10:11]
v_pk_fma_f32 v[14:15],v[102:103],v[102:103],v[14:15]
v_pk_add_f32 v[10:11],v[10:11],v[14:15]
v_add_f32 v10,v10,v11
s_nop 1
v_add_f32_dpp v10,v10,v10 row_ror:4 row_mask:0xf bank_mask:0xf
s_nop 1
v_add_f32_dpp v10,v10,v10 row_ror:8 row_mask:0xf bank_mask:0xf
v_mov_b32 v12,v10
s_nop 1
v_permlane16_swap_b32 v12,v10
v_add_f32 v10,v10,v12
v_mov_b32 v12,v10
s_nop 1
v_permlane32_swap_b32 v12,v10
v_add_f32 v10,v10,v12
v_mov_b32 v12,0x3727c5ac
v_fmac_f32 v12,0x3a800000,v10
v_rsq_f32 v10,v12
s_nop 0
v_pk_mul_f32 v[40:41],v[40:41],v[10:11] op_sel_hi:[1,0]
v_pk_mul_f32 v[42:43],v[42:43],v[10:11] op_sel_hi:[1,0]
v_pk_mul_f32 v[44:45],v[44:45],v[10:11] op_sel_hi:[1,0]
v_pk_mul_f32 v[46:47],v[46:47],v[10:11] op_sel_hi:[1,0]
v_pk_mul_f32 v[48:49],v[48:49],v[10:11] op_sel_hi:[1,0]
v_pk_mul_f32 v[50:51],v[50:51],v[10:11] op_sel_hi:[1,0]
v_pk_mul_f32 v[52:53],v[52:53],v[10:11] op_sel_hi:[1,0]
v_pk_mul_f32 v[54:55],v[54:55],v[10:11] op_sel_hi:[1,0]
v_pk_mul_f32 v[56:57],v[56:57],v[10:11] op_sel_hi:[1,0]
v_pk_mul_f32 v[58:59],v[58:59],v[10:11] op_sel_hi:[1,0]
v_pk_mul_f32 v[60:61],v[60:61],v[10:11] op_sel_hi:[1,0]
v_pk_mul_f32 v[62:63],v[62:63],v[10:11] op_sel_hi:[1,0]
v_pk_mul_f32 v[64:65],v[64:65],v[10:11] op_sel_hi:[1,0]
v_pk_mul_f32 v[66:67],v[66:67],v[10:11] op_sel_hi:[1,0]
v_pk_mul_f32 v[68:69],v[68:69],v[10:11] op_sel_hi:[1,0]
v_pk_mul_f32 v[70:71],v[70:71],v[10:11] op_sel_hi:[1,0]
v_pk_mul_f32 v[72:73],v[72:73],v[10:11] op_sel_hi:[1,0]
v_pk_mul_f32 v[74:75],v[74:75],v[10:11] op_sel_hi:[1,0]
v_pk_mul_f32 v[76:77],v[76:77],v[10:11] op_sel_hi:[1,0]
v_pk_mul_f32 v[78:79],v[78:79],v[10:11] op_sel_hi:[1,0]
v_pk_mul_f32 v[80:81],v[80:81],v[10:11] op_sel_hi:[1,0]
v_pk_mul_f32 v[82:83],v[82:83],v[10:11] op_sel_hi:[1,0]
v_pk_mul_f32 v[84:85],v[84:85],v[10:11] op_sel_hi:[1,0]
v_pk_mul_f32 v[86:87],v[86:87],v[10:11] op_sel_hi:[1,0]
v_pk_mul_f32 v[88:89],v[88:89],v[10:11] op_sel_hi:[1,0]
v_pk_mul_f32 v[90:91],v[90:91],v[10:11] op_sel_hi:[1,0]
v_pk_mul_f32 v[92:93],v[92:93],v[10:11] op_sel_hi:[1,0]
v_pk_mul_f32 v[94:95],v[94:95],v[10:11] op_sel_hi:[1,0]
v_pk_mul_f32 v[96:97],v[96:97],v[10:11] op_sel_hi:[1,0]
v_pk_mul_f32 v[98:99],v[98:99],v[10:11] op_sel_hi:[1,0]
v_pk_mul_f32 v[100:101],v[100:101],v[10:11] op_sel_hi:[1,0]
v_pk_mul_f32 v[102:103],v[102:103],v[10:11] op_sel_hi:[1,0]
v_mov_b32 v187,158976
s_cmp_lg_u32 s50,0
s_cbranch_scc1 sh0_39
s_mov_b32 s65,0
s_cmp_eq_u32 s56,1
s_cbranch_scc1 m1s_40
s_lshl_b32 s52,s55,7
s_add_u32 s52,s52,21102592
s_mov_b32 s53,0
m1l_41:
v_mov_b32 v184,0
buffer_load_dword v185,v184,s[20:23],s52 offen sc1
s_waitcnt vmcnt(0)
v_readfirstlane_b32 s64,v185
s_mov_b32 s65,0
s_cmp_eq_u32 s64,1
s_cbranch_scc1 m1ok_42
s_sub_u32 s90,s90,1
s_cmp_lt_i32 s90,0
s_cbranch_scc1 m1ok_42
s_add_u32 s53,s53,1
s_and_b32 s64,s53,31
s_cbranch_scc1 m1l_41
v_and_b32 v184,3,v1
v_bfe_u32 v185,v1,2,1
v_lshlrev_b32 v184,2,v184
v_lshl_add_u32 v184,v185,7,v184
v_writelane_b32 v184,32,8
s_mov_b64 exec,0x1ff
vpoll_43:
buffer_load_dword v185,v184,s[44:47],0 offen sc1
s_waitcnt vmcnt(0)
v_readlane_b32 s92,v185,0
v_readlane_b32 s93,v185,1
v_readlane_b32 s94,v185,2
v_readlane_b32 s95,v185,3
v_readlane_b32 s96,v185,4
v_readlane_b32 s97,v185,5
v_readlane_b32 s98,v185,6
v_readlane_b32 s99,v185,7
v_readlane_b32 s61,v185,8
s_add_u32 s64,s92,s93
s_add_u32 s64,s64,s94
s_add_u32 s64,s64,s95
s_add_u32 s64,s64,s96
s_add_u32 s64,s64,s97
s_add_u32 s64,s64,s98
s_add_u32 s64,s64,s99
s_min_u32 s65,s92,s93
s_min_u32 s66,s94,s95
s_min_u32 s65,s65,s66
s_min_u32 s66,s96,s97
s_min_u32 s65,s65,s66
s_min_u32 s66,s98,s99
s_min_u32 s65,s65,s66
s_cmp_lt_u32 s65,32
s_cselect_b32 s65,1,0
s_cmp_lt_u32 s64,256
s_cbranch_scc1 vslp_45
s_branch vgot_44
vslp_45:
s_sleep 8
s_sub_u32 s90,s90,1
s_cmp_gt_i32 s90,0
s_cbranch_scc1 vpoll_43
vgot_44:
s_mov_b64 exec,-1
s_and_b32 s61,s61,1
s_lshl_b32 s61,s61,13
s_mov_b32 s66,s54
s_cmp_gt_u32 s51,0
s_cselect_b32 s64,s92,0
s_add_u32 s66,s66,s64
s_cmp_gt_u32 s51,1
s_cselect_b32 s64,s93,0
s_add_u32 s66,s66,s64
s_cmp_gt_u32 s51,2
s_cselect_b32 s64,s94,0
s_add_u32 s66,s66,s64
s_cmp_gt_u32 s51,3
s_cselect_b32 s64,s95,0
s_add_u32 s66,s66,s64
s_cmp_gt_u32 s51,4
s_cselect_b32 s64,s96,0
s_add_u32 s66,s66,s64
s_cmp_gt_u32 s51,5
s_cselect_b32 s64,s97,0
s_add_u32 s66,s66,s64
s_cmp_gt_u32 s51,6
s_cselect_b32 s64,s98,0
s_add_u32 s66,s66,s64
s_cmp_eq_u32 s65,0
s_cbranch_scc1 m1l_41
s_branch m1ok_42
m1s_40:
s_mov_b32 s53,256
s_mov_b32 s52,164
v_mov_b32 v184,0
dp_46:
buffer_load_dword v185,v184,s[44:47],s52 offen sc1
s_waitcnt vmcnt(0)
v_cmp_ne_u32 vcc,s53,v185
s_cbranch_vccz dpok_47
s_sleep 8
s_sub_u32 s90,s90,1
s_cmp_gt_i32 s90,0
s_cbranch_scc1 dp_46
dpok_47:
m1ok_42:
v_mov_b32 v184,s65
v_mov_b32 v185,s66
v_mov_b32 v186,s61
ds_write_b96 v187,v[184:186] offset:16
s_waitcnt lgkmcnt(0)
sh0_39:
s_barrier
ds_read_b96 v[184:186],v187 offset:16
s_waitcnt lgkmcnt(0)
v_readfirstlane_b32 s65,v184
v_readfirstlane_b32 s66,v185
v_readfirstlane_b32 s61,v186
s_cmp_lg_u32 s65,0
s_cbranch_scc1 slowrole_10
s_and_b32 s56,s56,1
v_lshlrev_b32 v7,5,v0
s_mov_b32 s40,24576
buffer_load_dwordx4 v[104:107],v7,s[20:23],s40 offen offset:0 sc1
buffer_load_dwordx4 v[108:111],v7,s[20:23],s40 offen offset:16 sc1
s_add_u32 s40,s40,8192
buffer_load_dwordx4 v[112:115],v7,s[20:23],s40 offen offset:0 sc1
buffer_load_dwordx4 v[116:119],v7,s[20:23],s40 offen offset:16 sc1
s_add_u32 s40,s40,8192
buffer_load_dwordx4 v[120:123],v7,s[20:23],s40 offen offset:0 sc1
buffer_load_dwordx4 v[124:127],v7,s[20:23],s40 offen offset:16 sc1
s_add_u32 s40,s40,8192
buffer_load_dwordx4 v[128:131],v7,s[20:23],s40 offen offset:0 sc1
buffer_load_dwordx4 v[132:135],v7,s[20:23],s40 offen offset:16 sc1
v_mov_b32 v14,1.0
v_cmp_lt_u32 vcc,127,v0
s_nop 1
v_cndmask_b32 v14,0,v14,vcc
s_waitcnt vmcnt(0)
v_pk_add_f32 v[104:105],v[104:105],v[112:113]
v_pk_add_f32 v[120:121],v[120:121],v[128:129]
v_pk_add_f32 v[106:107],v[106:107],v[114:115]
v_pk_add_f32 v[122:123],v[122:123],v[130:131]
v_pk_add_f32 v[108:109],v[108:109],v[116:117]
v_pk_add_f32 v[124:125],v[124:125],v[132:133]
v_pk_add_f32 v[110:111],v[110:111],v[118:119]
v_pk_add_f32 v[126:127],v[126:127],v[134:135]
v_pk_add_f32 v[104:105],v[104:105],v[120:121]
v_pk_add_f32 v[106:107],v[106:107],v[122:123]
v_pk_add_f32 v[108:109],v[108:109],v[124:125]
v_pk_add_f32 v[110:111],v[110:111],v[126:127]
v_cvt_pk_bf16_f32 v112,v104,v105
v_cvt_pk_bf16_f32 v113,v106,v107
v_cvt_pk_bf16_f32 v114,v108,v109
v_cvt_pk_bf16_f32 v115,v110,v111
v_lshlrev_b32 v104,16,v112
v_and_b32 v105,s39,v112
v_lshlrev_b32 v106,16,v113
v_and_b32 v107,s39,v113
v_lshlrev_b32 v108,16,v114
v_and_b32 v109,s39,v114
v_lshlrev_b32 v110,16,v115
v_and_b32 v111,s39,v115
v_pk_add_f32 v[104:105],v[104:105],v[14:15] op_sel_hi:[1,0]
v_pk_add_f32 v[106:107],v[106:107],v[14:15] op_sel_hi:[1,0]
v_pk_add_f32 v[108:109],v[108:109],v[14:15] op_sel_hi:[1,0]
v_pk_add_f32 v[110:111],v[110:111],v[14:15] op_sel_hi:[1,0]
ds_write_b128 v7,v[104:107] offset:4096
ds_write_b128 v7,v[108:111] offset:4112
s_waitcnt lgkmcnt(0)
s_barrier
ds_read_b128 v[104:107],v4 offset:8192
ds_read_b128 v[168:171],v4 offset:4096
ds_read_b128 v[108:111],v4 offset:8208
ds_read_b128 v[172:175],v4 offset:4112
ds_read_b128 v[112:115],v4 offset:8224
ds_read_b128 v[176:179],v4 offset:4128
ds_read_b128 v[116:119],v4 offset:8240
ds_read_b128 v[180:183],v4 offset:4144
ds_read_b128 v[120:123],v4 offset:9216
ds_read_b128 v[184:187],v4 offset:5120
ds_read_b128 v[124:127],v4 offset:9232
ds_read_b128 v[188:191],v4 offset:5136
ds_read_b128 v[128:131],v4 offset:9248
ds_read_b128 v[192:195],v4 offset:5152
ds_read_b128 v[132:135],v4 offset:9264
ds_read_b128 v[196:199],v4 offset:5168
ds_read_b128 v[136:139],v4 offset:10240
ds_read_b128 v[200:203],v4 offset:6144
ds_read_b128 v[140:143],v4 offset:10256
ds_read_b128 v[204:207],v4 offset:6160
ds_read_b128 v[144:147],v4 offset:10272
ds_read_b128 v[208:211],v4 offset:6176
ds_read_b128 v[148:151],v4 offset:10288
ds_read_b128 v[212:215],v4 offset:6192
ds_read_b128 v[152:155],v4 offset:11264
ds_read_b128 v[216:219],v4 offset:7168
ds_read_b128 v[156:159],v4 offset:11280
ds_read_b128 v[220:223],v4 offset:7184
ds_read_b128 v[160:163],v4 offset:11296
ds_read_b128 v[224:227],v4 offset:7200
ds_read_b128 v[164:167],v4 offset:11312
ds_read_b128 v[228:231],v4 offset:7216
s_waitcnt lgkmcnt(15)
v_pk_fma_f32 v[40:41],v[40:41],v[104:105],v[168:169]
v_pk_fma_f32 v[42:43],v[42:43],v[106:107],v[170:171]
v_pk_fma_f32 v[44:45],v[44:45],v[108:109],v[172:173]
v_pk_fma_f32 v[46:47],v[46:47],v[110:111],v[174:175]
v_pk_fma_f32 v[48:49],v[48:49],v[112:113],v[176:177]
v_pk_fma_f32 v[50:51],v[50:51],v[114:115],v[178:179]
v_pk_fma_f32 v[52:53],v[52:53],v[116:117],v[180:181]
v_pk_fma_f32 v[54:55],v[54:55],v[118:119],v[182:183]
v_cvt_pk_bf16_f32 v16,v40,v41
v_cvt_pk_bf16_f32 v17,v48,v49
v_cvt_pk_bf16_f32 v18,v42,v43
v_cvt_pk_bf16_f32 v19,v50,v51
buffer_store_dwordx4 v[16:19],v6,s[20:23],s37 offen offset:0 sc1
v_cvt_pk_bf16_f32 v20,v44,v45
v_cvt_pk_bf16_f32 v21,v52,v53
v_cvt_pk_bf16_f32 v22,v46,v47
v_cvt_pk_bf16_f32 v23,v54,v55
buffer_store_dwordx4 v[20:23],v6,s[20:23],s37 offen offset:256 sc1
s_waitcnt lgkmcnt(15)
v_pk_fma_f32 v[56:57],v[56:57],v[120:121],v[184:185]
v_pk_fma_f32 v[58:59],v[58:59],v[122:123],v[186:187]
v_pk_fma_f32 v[60:61],v[60:61],v[124:125],v[188:189]
v_pk_fma_f32 v[62:63],v[62:63],v[126:127],v[190:191]
v_pk_fma_f32 v[64:65],v[64:65],v[128:129],v[192:193]
v_pk_fma_f32 v[66:67],v[66:67],v[130:131],v[194:195]
v_pk_fma_f32 v[68:69],v[68:69],v[132:133],v[196:197]
v_pk_fma_f32 v[70:71],v[70:71],v[134:135],v[198:199]
v_cvt_pk_bf16_f32 v24,v56,v57
v_cvt_pk_bf16_f32 v25,v64,v65
v_cvt_pk_bf16_f32 v26,v58,v59
v_cvt_pk_bf16_f32 v27,v66,v67
s_add_u32 s37,s37,16384
buffer_store_dwordx4 v[24:27],v6,s[20:23],s37 offen offset:0 sc1
v_cvt_pk_bf16_f32 v28,v60,v61
v_cvt_pk_bf16_f32 v29,v68,v69
v_cvt_pk_bf16_f32 v30,v62,v63
v_cvt_pk_bf16_f32 v31,v70,v71
buffer_store_dwordx4 v[28:31],v6,s[20:23],s37 offen offset:256 sc1
s_waitcnt lgkmcnt(8)
v_pk_fma_f32 v[72:73],v[72:73],v[136:137],v[200:201]
v_pk_fma_f32 v[74:75],v[74:75],v[138:139],v[202:203]
v_pk_fma_f32 v[76:77],v[76:77],v[140:141],v[204:205]
v_pk_fma_f32 v[78:79],v[78:79],v[142:143],v[206:207]
v_pk_fma_f32 v[80:81],v[80:81],v[144:145],v[208:209]
v_pk_fma_f32 v[82:83],v[82:83],v[146:147],v[210:211]
v_pk_fma_f32 v[84:85],v[84:85],v[148:149],v[212:213]
v_pk_fma_f32 v[86:87],v[86:87],v[150:151],v[214:215]
v_cvt_pk_bf16_f32 v16,v72,v73
v_cvt_pk_bf16_f32 v17,v80,v81
v_cvt_pk_bf16_f32 v18,v74,v75
v_cvt_pk_bf16_f32 v19,v82,v83
s_add_u32 s37,s37,16384
buffer_store_dwordx4 v[16:19],v6,s[20:23],s37 offen offset:0 sc1
v_cvt_pk_bf16_f32 v20,v76,v77
v_cvt_pk_bf16_f32 v21,v84,v85
v_cvt_pk_bf16_f32 v22,v78,v79
v_cvt_pk_bf16_f32 v23,v86,v87
buffer_store_dwordx4 v[20:23],v6,s[20:23],s37 offen offset:256 sc1
s_waitcnt lgkmcnt(0)
v_pk_fma_f32 v[88:89],v[88:89],v[152:153],v[216:217]
v_pk_fma_f32 v[90:91],v[90:91],v[154:155],v[218:219]
v_pk_fma_f32 v[92:93],v[92:93],v[156:157],v[220:221]
v_pk_fma_f32 v[94:95],v[94:95],v[158:159],v[222:223]
v_pk_fma_f32 v[96:97],v[96:97],v[160:161],v[224:225]
v_pk_fma_f32 v[98:99],v[98:99],v[162:163],v[226:227]
v_pk_fma_f32 v[100:101],v[100:101],v[164:165],v[228:229]
v_pk_fma_f32 v[102:103],v[102:103],v[166:167],v[230:231]
v_cvt_pk_bf16_f32 v24,v88,v89
v_cvt_pk_bf16_f32 v25,v96,v97
v_cvt_pk_bf16_f32 v26,v90,v91
v_cvt_pk_bf16_f32 v27,v98,v99
s_add_u32 s37,s37,16384
buffer_store_dwordx4 v[24:27],v6,s[20:23],s37 offen offset:0 sc1
v_cvt_pk_bf16_f32 v28,v92,v93
v_cvt_pk_bf16_f32 v29,v100,v101
v_cvt_pk_bf16_f32 v30,v94,v95
v_cvt_pk_bf16_f32 v31,v102,v103
buffer_store_dwordx4 v[28:31],v6,s[20:23],s37 offen offset:256 sc1
s_waitcnt vmcnt(0)
s_barrier
v_mov_b32 v187,158976
s_cmp_lg_u32 s50,0
s_cbranch_scc1 sh0_48
s_cmp_ge_u32 s55,16
s_cbranch_scc1 nodln_49
s_and_b32 s64,s56,1
s_lshl_b32 s64,s64,2
s_add_u32 s64,s64,36
s_mov_b64 exec,1
v_mov_b32 v184,1
v_mov_b32 v185,0
buffer_atomic_add v184,v185,s[44:47],s64 offen sc0 sc1
s_mov_b64 exec,-1
s_waitcnt vmcnt(0)
v_readfirstlane_b32 s64,v184
s_cmp_lg_u32 s64,143
s_cbranch_scc1 narr_51
s_mov_b32 s65,0
s_cmp_eq_u32 s56,1
s_cbranch_scc1 nopar_52
v_mov_b32 v184,0
dp_53:
buffer_load_dword v185,v184,s[44:47],32 offen sc1
s_waitcnt vmcnt(0)
v_cmp_eq_u32 vcc,0,v185
s_cbranch_vccz dpok_54
s_sleep 4
s_sub_u32 s90,s90,1
s_cmp_gt_i32 s90,0
s_cbranch_scc1 dp_53
dpok_54:
v_readfirstlane_b32 s65,v185
s_and_b32 s65,s65,1
s_lshl_b32 s61,s65,13
nopar_52:
s_add_u32 s65,s65,2
v_lshlrev_b32 v184,7,v1
v_mov_b32 v185,s65
s_mov_b32 s64,21168128
s_mov_b32 s65,21176320
buffer_store_dword v185,v184,s[20:23],s64 offen sc1
buffer_store_dword v185,v184,s[20:23],s65 offen sc1
narr_51:
nodln_49:
s_mov_b32 s61,0
s_cmp_eq_u32 s56,1
s_cbranch_scc1 nopar_50
v_mov_b32 v184,0
dp_55:
buffer_load_dword v185,v184,s[44:47],32 offen sc1
s_waitcnt vmcnt(0)
v_cmp_eq_u32 vcc,0,v185
s_cbranch_vccz dpok_56
s_sleep 4
s_sub_u32 s90,s90,1
s_cmp_gt_i32 s90,0
s_cbranch_scc1 dp_55
dpok_56:
v_readfirstlane_b32 s65,v185
s_and_b32 s65,s65,1
s_lshl_b32 s61,s65,13
nopar_50:
v_mov_b32 v184,s65
v_mov_b32 v185,s66
v_mov_b32 v186,s61
ds_write_b96 v187,v[184:186] offset:16
s_waitcnt lgkmcnt(0)
sh0_48:
s_barrier
ds_read_b96 v[184:186],v187 offset:16
s_waitcnt lgkmcnt(0)
v_readfirstlane_b32 s65,v184
v_readfirstlane_b32 s66,v185
v_readfirstlane_b32 s61,v186
s_sub_u32 s55,s57,128
s_cmp_lg_u32 s50,0
s_cbranch_scc1 nsig_57
s_lshr_b32 s95,s55,4
s_lshl_b32 s95,s95,6
s_add_u32 s95,s95,21052416
s_mov_b64 exec,1
v_mov_b32 v184,112
v_mov_b32 v185,0
buffer_atomic_add v184,v185,s[20:23],s95 offen sc1
s_mov_b64 exec,-1
nsig_57:
s_branch pipe_worker
loops_7:
s_lshl_b32 s64,s50,14
s_add_u32 m0,s64,0
s_add_u32 s65,s64,57344
buffer_load_dwordx4 v16,s[20:23],s65 offen offset:0 lds
buffer_load_dwordx4 v16,s[20:23],s65 offen offset:1024 lds
buffer_load_dwordx4 v16,s[20:23],s65 offen offset:2048 lds
buffer_load_dwordx4 v16,s[20:23],s65 offen offset:3072 lds
s_add_u32 m0,s64,4096
s_add_u32 s65,s64,61440
buffer_load_dwordx4 v16,s[20:23],s65 offen offset:0 lds
buffer_load_dwordx4 v16,s[20:23],s65 offen offset:1024 lds
buffer_load_dwordx4 v16,s[20:23],s65 offen offset:2048 lds
buffer_load_dwordx4 v16,s[20:23],s65 offen offset:3072 lds
s_add_u32 m0,s64,8192
s_add_u32 s65,s64,65536
buffer_load_dwordx4 v16,s[20:23],s65 offen offset:0 lds
buffer_load_dwordx4 v16,s[20:23],s65 offen offset:1024 lds
buffer_load_dwordx4 v16,s[20:23],s65 offen offset:2048 lds
buffer_load_dwordx4 v16,s[20:23],s65 offen offset:3072 lds
s_add_u32 m0,s64,12288
s_add_u32 s65,s64,69632
buffer_load_dwordx4 v16,s[20:23],s65 offen offset:0 lds
buffer_load_dwordx4 v16,s[20:23],s65 offen offset:1024 lds
buffer_load_dwordx4 v16,s[20:23],s65 offen offset:2048 lds
buffer_load_dwordx4 v16,s[20:23],s65 offen offset:3072 lds
s_mov_b64 s[24:25],s[20:21]
s_mov_b64 s[28:29],s[20:21]
s_mov_b32 s27,0x20000
s_mov_b32 s31,0x20000
s_cmp_eq_u32 s56,0
s_cselect_b32 s26,s22,0
s_cselect_b32 s30,0,s22
s_lshl_b32 s64,s58,14
s_add_u32 s64,s64,23068672
v_add_u32 v26,s64,v16
v_add_u32 v27,4096,v26
v_add_u32 v28,8192,v26
v_add_u32 v29,12288,v26
s_lshl_b32 s65,s59,9
s_add_u32 s66,s64,s65
s_lshl_b32 s64,s58,7
s_add_u32 s64,s64,23592960
v_and_b32 v18,31,v1
v_lshl_add_u32 v18,v18,2,s64
s_lshl_b32 s65,s59,2
s_add_u32 s64,s64,s65
v_mov_b32 v13,s64
v_mov_b32 v14,0x4444
v_mov_b32 v22,0xeeee
v_cmp_lt_u32 vcc,7,v3
s_nop 1
v_cndmask_b32 v14,v14,v22,vcc
v_and_b32 v22,1,v3
v_cmp_eq_u32 vcc,0,v22
v_mov_b32 v15,0x03020706
v_mov_b32 v23,0x05040100
v_cndmask_b32 v15,v15,v23,vcc
v_lshlrev_b32 v19,5,v22
v_lshl_add_u32 v19,v4,6,v19
v_lshrrev_b32 v23,1,v3
v_lshl_add_u32 v19,v23,2,v19
s_lshl_b32 s67,s57,10
s_add_u32 s67,s67,23199744
s_lshl_b32 s64,s50,2
s_lshr_b32 s64,0x1320,s64
s_and_b32 s64,s64,3
s_lshl_b32 s64,s64,8
s_add_u32 s64,s64,s67
v_add_u32 v19,s64,v19
v_add_u32 v24,131072,v16
v_mov_b32 v21,158720
v_mov_b32 v25,0
v_mov_b32 v20,v16
v_and_b32 v22,1,v4
v_lshrrev_b32 v23,1,v4
v_lshl_add_u32 v23,v23,4,v3
v_lshlrev_b32 v23,4,v23
v_lshl_add_u32 v23,v22,10,v23
s_lshr_b32 s64,s50,1
s_lshl_b32 s64,s64,9
v_add_u32 v23,s64,v23
s_lshr_b32 s64,s57,2
s_add_u32 s65,s64,32
s_lshl_b32 s65,s65,14
s_and_b32 s68,s57,3
s_lshl_b32 s68,s68,11
s_add_u32 s65,s65,s68
s_add_u32 s65,s65,29360128
v_add_u32 v17,s65,v23
s_lshl_b32 s69,s57,11
s_add_u32 s69,s69,23330816
v_add_u32 v2,s69,v23
s_mov_b32 s81,0x3e0293ee
s_mov_b32 s84,0xff00ff
s_mov_b32 s85,0xff00ff
s_mov_b32 s86,0x33333333
s_mov_b32 s87,0x33333333
s_mov_b32 s62,0x10000
s_mov_b32 s79,-2
ds_write_b32 v21,v25
ds_write_b32 v21,v25 offset:4
ds_write_b32 v21,v25 offset:8
ds_write_b32 v21,v25 offset:12
ds_write_b32 v21,v25 offset:16
ds_write_b32 v21,v25 offset:24
ds_write_b32 v21,v25 offset:28
v_mov_b32 v100,0
v_mov_b32 v101,0
v_mov_b32 v102,0
v_mov_b32 v103,0
s_lshr_b32 s64,s59,3
s_lshl_b32 s64,s64,14
s_and_b32 s65,s59,7
s_lshl_b32 s65,s65,10
s_add_u32 s64,s64,s65
s_lshl_b32 s65,s58,16
s_add_u32 s64,s64,s65
s_add_u32 s64,s64,31195136
v_add_u32 v8,s64,v16
s_cmp_eq_u32 s50,3
s_cbranch_scc1 w3_62
s_cmp_eq_u32 s50,1
s_cbranch_scc1 w1_60
s_cmp_eq_u32 s50,2
s_cbranch_scc1 w2_61
w0_59:
v_and_b32 v22,7,v3
v_lshrrev_b32 v23,2,v22
v_and_b32 v5,2,v22
v_or_b32 v23,v23,v5
v_and_b32 v5,1,v22
v_lshl_add_u32 v23,v23,1,v5
v_lshlrev_b32 v23,5,v23
v_lshrrev_b32 v5,3,v3
v_lshl_add_u32 v23,v5,9,v23
v_lshrrev_b32 v5,1,v4
v_lshl_add_u32 v23,v5,8,v23
v_and_b32 v5,1,v4
v_lshl_add_u32 v23,v5,4,v23
v_add_u32 v8,s67,v23
v_xor_b32 v9,1024,v8
v_xor_b32 v10,2048,v8
v_xor_b32 v11,3072,v8
v_lshlrev_b32 v31,4,v3
v_lshl_add_u32 v31,v5,3,v31
v_add_u32 v31,155648,v31
v_lshl_add_u32 v23,v4,3,v22
v_lshlrev_b32 v23,4,v23
v_add_u32 v12,155648,v23
v_add_u32 v30,s66,v23
v_cmp_gt_u32 vcc,8,v3
v_cmp_lt_u32 s[52:53],1,v4
s_and_b64 vcc,vcc,s[52:53]
v_mov_b32 v22,0xf149f2ca
v_cndmask_b32 v156,v22,0,vcc
v_mov_b32 v157,v156
v_mov_b32 v158,v156
v_mov_b32 v159,v156
v_add_u32 v2,s69,v16
v_xor_b32 v5,2048,v2
v_xor_b32 v6,4096,v2
v_xor_b32 v7,6144,v2
s_lshr_b32 s64,s57,3
s_add_u32 s64,s64,96
s_lshl_b32 s64,s64,14
s_and_b32 s65,s57,7
s_lshl_b32 s65,s65,10
s_add_u32 s64,s64,s65
s_add_u32 s64,s64,29360128
v_add_u32 v3,s64,v16
v_mov_b32 v136,0
v_mov_b32 v137,0
v_mov_b32 v138,0
v_mov_b32 v139,0
v_mov_b32 v140,0
v_mov_b32 v141,0
v_mov_b32 v142,0
v_mov_b32 v143,0
v_mov_b32 v144,0
v_mov_b32 v145,0
v_mov_b32 v146,0
v_mov_b32 v147,0
v_mov_b32 v152,0x3f803f80
v_mov_b32 v153,0x3f803f80
v_mov_b32 v154,0x3f803f80
v_mov_b32 v155,0x3f803f80
s_branch first_63
loop_64:
s_barrier
buffer_load_dword v248,v18,s[20:23],s70 offen offset:0 sc1
s_nop 15
s_nop 5
hl_66:
buffer_load_dword v249,v18,s[20:23],s70 offen offset:0 sc1
s_waitcnt vmcnt(1)
v_cmp_eq_u32 vcc,v25,v248
s_bcnt1_i32_b32 s64,vcc_lo
s_cmp_ge_u32 s64,8
s_cbranch_scc1 hg_67
buffer_load_dword v248,v18,s[20:23],s70 offen offset:0 sc1
s_waitcnt vmcnt(1)
v_cmp_eq_u32 vcc,v25,v249
s_bcnt1_i32_b32 s64,vcc_lo
s_cmp_ge_u32 s64,8
s_cbranch_scc1 hg_67
s_sub_u32 s90,s90,1
s_cmp_gt_i32 s90,0
s_cbranch_scc1 hl_66
hg_67:
buffer_load_dwordx4 v[32:35],v26,s[20:23],s70 offen offset:0 sc1
buffer_load_dwordx4 v[36:39],v26,s[20:23],s70 offen offset:1024 sc1
buffer_load_dwordx4 v[40:43],v26,s[20:23],s70 offen offset:2048 sc1
buffer_load_dwordx4 v[44:47],v26,s[20:23],s70 offen offset:3072 sc1
s_waitcnt vmcnt(3)
ds_write_b128 v24,v[32:35] offset:0
v_min3_u32 v22,v32,v33,v34
v_min_u32 v22,v22,v35
s_waitcnt vmcnt(2)
ds_write_b128 v24,v[36:39] offset:1024
v_min3_u32 v22,v22,v36,v37
v_min3_u32 v22,v22,v38,v39
s_waitcnt vmcnt(1)
ds_write_b128 v24,v[40:43] offset:2048
v_min3_u32 v22,v22,v40,v41
v_min3_u32 v22,v22,v42,v43
s_waitcnt vmcnt(0)
ds_write_b128 v24,v[44:47] offset:3072
v_min3_u32 v22,v22,v44,v45
v_min3_u32 v22,v22,v46,v47
v_cmp_eq_u32 vcc,0,v22
s_cbranch_vccnz art_68
abk_69:
v_smfmac_f32_16x16x64_bf16 v[176:179],v[32:35],a[0:7],v14
s_waitcnt lgkmcnt(0)
s_barrier
ds_read_b128 v[48:51],v24 offset:4096
ds_read_b128 v[52:55],v24 offset:5120
ds_read_b128 v[56:59],v24 offset:6144
ds_read_b128 v[60:63],v24 offset:7168
v_smfmac_f32_16x16x64_bf16 v[176:179],v[36:39],a[8:15],v14
ds_read_b128 v[64:67],v24 offset:8192
ds_read_b128 v[68:71],v24 offset:9216
v_smfmac_f32_16x16x64_bf16 v[176:179],v[40:43],a[16:23],v14
ds_read_b128 v[72:75],v24 offset:10240
ds_read_b128 v[76:79],v24 offset:11264
v_smfmac_f32_16x16x64_bf16 v[176:179],v[44:47],a[24:31],v14
ds_read_b128 v[80:83],v24 offset:12288
ds_read_b128 v[84:87],v24 offset:13312
s_waitcnt lgkmcnt(9)
v_smfmac_f32_16x16x64_bf16 v[176:179],v[48:51],a[32:39],v14
ds_read_b128 v[88:91],v24 offset:14336
s_waitcnt lgkmcnt(9)
v_smfmac_f32_16x16x64_bf16 v[176:179],v[52:55],a[40:47],v14
ds_read_b128 v[92:95],v24 offset:15360
s_waitcnt lgkmcnt(9)
v_smfmac_f32_16x16x64_bf16 v[176:179],v[56:59],a[48:55],v14
s_waitcnt lgkmcnt(8)
v_smfmac_f32_16x16x64_bf16 v[176:179],v[60:63],a[56:63],v14
s_waitcnt lgkmcnt(7)
v_smfmac_f32_16x16x64_bf16 v[176:179],v[64:67],a[64:71],v14
s_waitcnt lgkmcnt(6)
v_smfmac_f32_16x16x64_bf16 v[176:179],v[68:71],a[72:79],v14
s_waitcnt lgkmcnt(5)
v_smfmac_f32_16x16x64_bf16 v[176:179],v[72:75],a[80:87],v14
s_waitcnt lgkmcnt(4)
v_smfmac_f32_16x16x64_bf16 v[176:179],v[76:79],a[88:95],v14
s_waitcnt lgkmcnt(3)
v_smfmac_f32_16x16x64_bf16 v[176:179],v[80:83],a[96:103],v14
s_waitcnt lgkmcnt(2)
v_smfmac_f32_16x16x64_bf16 v[176:179],v[84:87],a[104:111],v14
s_waitcnt lgkmcnt(1)
v_smfmac_f32_16x16x64_bf16 v[176:179],v[88:91],a[112:119],v14
s_waitcnt lgkmcnt(0)
v_smfmac_f32_16x16x64_bf16 v[176:179],v[92:95],a[120:127],v14
s_nop 7
v_permlane32_swap_b32 v176,v178
v_permlane32_swap_b32 v177,v179
v_add_f32 v176,v176,v178
v_add_f32 v177,v177,v179
v_cvt_pk_bf16_f32 v216,v176,v177
s_nop 1
v_mov_b32_dpp v217,v216 quad_perm:[1,0,3,2] row_mask:0xf bank_mask:0xf
v_perm_b32 v216,v217,v216,v15
v_max_u32 v216,1,v216
buffer_store_dword v216,v19,s[24:27],s70 offen
buffer_store_dword v216,v19,s[28:31],s70 offen sc1
s_lshr_b32 s64,s70,9
v_add_u32 v22,s64,v24
s_cmp_eq_u32 s79,0
ds_read_b128 v[128:131],v22 offset:16384
ds_read_b128 v[132:135],v22 offset:17408
s_cbranch_scc1 kt0_70
kt0b_71:
s_nop 15
s_nop 15
s_nop 11
buffer_load_dwordx4 v[32:35],v8,s[20:23],s70 offen sc1
buffer_load_dwordx4 v[36:39],v9,s[20:23],s70 offen sc1
buffer_load_dwordx4 v[40:43],v10,s[20:23],s70 offen sc1
buffer_load_dwordx4 v[44:47],v11,s[20:23],s70 offen sc1
s_nop 9
scp_72:
buffer_load_dwordx4 v[48:51],v8,s[20:23],s70 offen sc1
buffer_load_dwordx4 v[52:55],v9,s[20:23],s70 offen sc1
buffer_load_dwordx4 v[56:59],v10,s[20:23],s70 offen sc1
buffer_load_dwordx4 v[60:63],v11,s[20:23],s70 offen sc1
s_waitcnt vmcnt(4)
v_mfma_f32_16x16x32_bf16 v[168:171],v[32:35],v[32:35],v[156:159]
v_min3_u32 v22,v32,v33,v34
v_min3_u32 v22,v22,v35,v36
v_mfma_f32_16x16x32_bf16 v[164:167],v[100:103],v[32:35],0
v_min3_u32 v22,v22,v37,v38
v_min3_u32 v22,v22,v39,v40
v_mfma_f32_16x16x32_bf16 v[160:163],v[96:99],v[32:35],0
v_min3_u32 v22,v22,v41,v42
v_min3_u32 v22,v22,v43,v44
v_mfma_f32_16x16x32_bf16 v[168:171],v[36:39],v[36:39],v[168:171]
v_min3_u32 v22,v22,v45,v46
v_min_u32 v22,v22,v47
v_mfma_f32_16x16x32_bf16 v[164:167],v[108:111],v[36:39],v[164:167]
v_cmp_eq_u32 vcc,0,v22
s_cbranch_vccnz nx_74
v_mfma_f32_16x16x32_bf16 v[160:163],v[104:107],v[36:39],v[160:163]
v_mov_b32 v172,v32
v_mfma_f32_16x16x32_bf16 v[168:171],v[40:43],v[40:43],v[168:171]
v_mov_b32 v173,v33
v_mfma_f32_16x16x32_bf16 v[164:167],v[116:119],v[40:43],v[164:167]
v_mov_b32 v174,v34
v_mfma_f32_16x16x32_bf16 v[160:163],v[112:115],v[40:43],v[160:163]
v_mov_b32 v175,v35
v_mfma_f32_16x16x32_bf16 v[168:171],v[44:47],v[44:47],v[168:171]
v_mfma_f32_16x16x32_bf16 v[164:167],v[124:127],v[44:47],v[164:167]
v_mfma_f32_16x16x32_bf16 v[160:163],v[120:123],v[44:47],v[160:163]
s_nop 1
s_branch scok_73
nx_74:
buffer_load_dwordx4 v[32:35],v8,s[20:23],s70 offen sc1
buffer_load_dwordx4 v[36:39],v9,s[20:23],s70 offen sc1
buffer_load_dwordx4 v[40:43],v10,s[20:23],s70 offen sc1
buffer_load_dwordx4 v[44:47],v11,s[20:23],s70 offen sc1
s_waitcnt vmcnt(4)
v_mfma_f32_16x16x32_bf16 v[168:171],v[48:51],v[48:51],v[156:159]
v_min3_u32 v22,v48,v49,v50
v_min3_u32 v22,v22,v51,v52
v_mfma_f32_16x16x32_bf16 v[164:167],v[100:103],v[48:51],0
v_min3_u32 v22,v22,v53,v54
v_min3_u32 v22,v22,v55,v56
v_mfma_f32_16x16x32_bf16 v[160:163],v[96:99],v[48:51],0
v_min3_u32 v22,v22,v57,v58
v_min3_u32 v22,v22,v59,v60
v_mfma_f32_16x16x32_bf16 v[168:171],v[52:55],v[52:55],v[168:171]
v_min3_u32 v22,v22,v61,v62
v_min_u32 v22,v22,v63
v_mfma_f32_16x16x32_bf16 v[164:167],v[108:111],v[52:55],v[164:167]
v_cmp_eq_u32 vcc,0,v22
s_cbranch_vccnz nx_75
v_mfma_f32_16x16x32_bf16 v[160:163],v[104:107],v[52:55],v[160:163]
v_mov_b32 v172,v48
v_mfma_f32_16x16x32_bf16 v[168:171],v[56:59],v[56:59],v[168:171]
v_mov_b32 v173,v49
v_mfma_f32_16x16x32_bf16 v[164:167],v[116:119],v[56:59],v[164:167]
v_mov_b32 v174,v50
v_mfma_f32_16x16x32_bf16 v[160:163],v[112:115],v[56:59],v[160:163]
v_mov_b32 v175,v51
v_mfma_f32_16x16x32_bf16 v[168:171],v[60:63],v[60:63],v[168:171]
v_mfma_f32_16x16x32_bf16 v[164:167],v[124:127],v[60:63],v[164:167]
v_mfma_f32_16x16x32_bf16 v[160:163],v[120:123],v[60:63],v[160:163]
s_nop 1
s_branch scok_73
nx_75:
s_sub_u32 s90,s90,1
s_cmp_gt_i32 s90,0
s_cbranch_scc1 scp_72
s_nop 7
scok_73:
ds_read_b64 v[220:221],v21
ds_read_b64 v[136:137],v31
ds_read_b64 v[140:141],v31 offset:256
s_cmp_eq_u32 s79,63
s_cbranch_scc1 last0_76
v_max3_f32 v216,v168,v169,v170
v_mov_b32_dpp v160,v164 row_ror:8 row_mask:0xf bank_mask:0xc
v_mov_b32_dpp v161,v165 row_ror:8 row_mask:0xf bank_mask:0xc
v_mov_b32_dpp v162,v166 row_ror:8 row_mask:0xf bank_mask:0xc
v_mov_b32_dpp v163,v167 row_ror:8 row_mask:0xf bank_mask:0xc
v_max3_f32 v217,v171,v160,v161
v_max3_f32 v216,v216,v162,v163
v_max_f32 v216,v216,v217
s_nop 1
v_max_f32_dpp v216,v216,v216 row_ror:8 row_mask:0xf bank_mask:0xf
v_mov_b32 v217,v216
s_nop 1
v_permlane16_swap_b32 v217,v216
v_max_f32 v216,v216,v217
v_mov_b32 v217,v216
s_nop 1
v_permlane32_swap_b32 v217,v216
v_max_f32 v216,v216,v217
v_mul_f32 v216,s81,v216
v_fma_f32 v160,v160,s81,-v216
v_fma_f32 v161,v161,s81,-v216
v_fma_f32 v162,v162,s81,-v216
v_fma_f32 v163,v163,s81,-v216
v_fma_f32 v168,v168,s81,-v216
v_fma_f32 v169,v169,s81,-v216
v_fma_f32 v170,v170,s81,-v216
v_fma_f32 v171,v171,s81,-v216
v_exp_f32 v160,v160
v_exp_f32 v161,v161
v_exp_f32 v162,v162
v_exp_f32 v163,v163
v_exp_f32 v168,v168
v_exp_f32 v169,v169
v_exp_f32 v170,v170
v_exp_f32 v171,v171
v_cvt_pk_bf16_f32 v148,v160,v161
v_cvt_pk_bf16_f32 v149,v162,v163
v_cvt_pk_bf16_f32 v144,v168,v169
v_mov_b32_dpp v150,v148 row_ror:8 row_mask:0xf bank_mask:0xf
v_mov_b32_dpp v151,v149 row_ror:8 row_mask:0xf bank_mask:0xf
v_cvt_pk_bf16_f32 v145,v170,v171
s_waitcnt lgkmcnt(0)
v_min_u32 v220,v220,v221
v_mfma_f32_16x16x32_bf16 v[232:235],v[152:155],v[148:151],0
v_cmp_ne_u32 vcc,v220,v25
v_mfma_f32_16x16x32_bf16 v[232:235],v[152:155],v[144:147],v[232:235]
v_mfma_f32_16x16x32_bf16 v[224:227],v[128:131],v[148:151],0
v_mfma_f32_16x16x32_bf16 v[228:231],v[132:135],v[148:151],0
s_cbranch_vccnz vw_77
vb_78:
v_mfma_f32_16x16x32_bf16 v[224:227],v[136:139],v[144:147],v[224:227]
v_mfma_f32_16x16x32_bf16 v[228:231],v[140:143],v[144:147],v[228:231]
s_mov_b64 exec,s[84:85]
s_nop 1
v_rcp_f32 v236,v232
s_nop 2
v_pk_mul_f32 v[224:225],v[224:225],v[236:237] op_sel_hi:[1,0]
v_pk_mul_f32 v[226:227],v[226:227],v[236:237] op_sel_hi:[1,0]
v_pk_mul_f32 v[228:229],v[228:229],v[236:237] op_sel_hi:[1,0]
v_pk_mul_f32 v[230:231],v[230:231],v[236:237] op_sel_hi:[1,0]
v_cvt_pk_bf16_f32 v216,v224,v225
v_cvt_pk_bf16_f32 v217,v226,v227
v_cvt_pk_bf16_f32 v218,v228,v229
v_cvt_pk_bf16_f32 v219,v230,v231
v_max_u32 v216,1,v216
v_max_u32 v217,1,v217
v_max_u32 v218,1,v218
v_max_u32 v219,1,v219
buffer_store_dwordx4 v[216:219],v30,s[24:27],s71 offen
buffer_store_dwordx4 v[216:219],v30,s[28:31],s71 offen sc1
s_mov_b64 exec,1
buffer_store_dword v25,v13,s[24:27],s70 offen offset:512
buffer_store_dword v25,v13,s[28:31],s70 offen offset:512 sc1
s_mov_b64 exec,-1
ds_write_b32 v21,v25 offset:8
hl_79:
buffer_load_dword v248,v18,s[20:23],s70 offen offset:512 sc1
s_waitcnt vmcnt(0)
v_cmp_eq_u32 vcc,v25,v248
s_bcnt1_i32_b32 s64,vcc_lo
s_cmp_ge_u32 s64,16
s_cbranch_scc1 hg_80
s_sub_u32 s90,s90,1
s_cmp_gt_i32 s90,0
s_cbranch_scc1 hl_79
hg_80:
buffer_load_dwordx4 v[32:35],v26,s[20:23],s71 offen offset:0 sc1
buffer_load_dwordx4 v[36:39],v26,s[20:23],s71 offen offset:1024 sc1
buffer_load_dwordx4 v[40:43],v26,s[20:23],s71 offen offset:2048 sc1
buffer_load_dwordx4 v[44:47],v26,s[20:23],s71 offen offset:3072 sc1
buffer_load_dwordx4 v[48:51],v27,s[20:23],s71 offen offset:0 sc1
buffer_load_dwordx4 v[52:55],v27,s[20:23],s71 offen offset:1024 sc1
buffer_load_dwordx4 v[56:59],v27,s[20:23],s71 offen offset:2048 sc1
buffer_load_dwordx4 v[60:63],v27,s[20:23],s71 offen offset:3072 sc1
s_mov_b32 s68,0
s_waitcnt vmcnt(6)
v_smfmac_f32_16x16x64_bf16 v[184:187],v[32:35],a[128:135],v14
v_min3_u32 v22,v32,v33,v34
v_min3_u32 v22,v22,v35,v36
v_smfmac_f32_16x16x64_bf16 v[188:191],v[32:35],a[136:143],v14
v_min3_u32 v22,v22,v37,v38
v_smfmac_f32_16x16x64_bf16 v[184:187],v[36:39],a[144:151],v14
v_min_u32 v22,v22,v39
v_smfmac_f32_16x16x64_bf16 v[188:191],v[36:39],a[152:159],v14
v_cmp_eq_u32 s[52:53],0,v22
s_waitcnt vmcnt(4)
v_smfmac_f32_16x16x64_bf16 v[184:187],v[40:43],a[160:167],v14
v_min3_u32 v22,v40,v41,v42
s_cmp_lg_u64 s[52:53],0
v_smfmac_f32_16x16x64_bf16 v[188:191],v[40:43],a[168:175],v14
s_cbranch_scc1 ms_81
bk_82:
v_min3_u32 v22,v22,v43,v44
v_smfmac_f32_16x16x64_bf16 v[184:187],v[44:47],a[176:183],v14
v_min3_u32 v22,v22,v45,v46
v_min_u32 v22,v22,v47
v_smfmac_f32_16x16x64_bf16 v[188:191],v[44:47],a[184:191],v14
v_cmp_eq_u32 s[54:55],0,v22
s_waitcnt vmcnt(2)
v_smfmac_f32_16x16x64_bf16 v[184:187],v[48:51],a[192:199],v14
v_min3_u32 v22,v48,v49,v50
s_cmp_lg_u64 s[54:55],0
v_smfmac_f32_16x16x64_bf16 v[188:191],v[48:51],a[200:207],v14
s_cbranch_scc1 ms_83
bk_84:
v_min3_u32 v22,v22,v51,v52
v_smfmac_f32_16x16x64_bf16 v[184:187],v[52:55],a[208:215],v14
v_min3_u32 v22,v22,v53,v54
v_min_u32 v22,v22,v55
v_smfmac_f32_16x16x64_bf16 v[188:191],v[52:55],a[216:223],v14
v_cmp_eq_u32 s[52:53],0,v22
s_waitcnt vmcnt(0)
v_smfmac_f32_16x16x64_bf16 v[184:187],v[56:59],a[224:231],v14
v_min3_u32 v22,v56,v57,v58
s_cmp_lg_u64 s[52:53],0
v_smfmac_f32_16x16x64_bf16 v[188:191],v[56:59],a[232:239],v14
s_cbranch_scc1 ms_85
bk_86:
v_min3_u32 v22,v22,v59,v60
v_smfmac_f32_16x16x64_bf16 v[184:187],v[60:63],a[240:247],v14
v_min3_u32 v22,v22,v61,v62
v_min_u32 v22,v22,v63
v_smfmac_f32_16x16x64_bf16 v[188:191],v[60:63],a[248:255],v14
v_cmp_eq_u32 s[54:55],0,v22
s_cmp_lg_u64 s[54:55],0
s_cbranch_scc1 ms_89
bk_90:
s_cmp_lg_u32 s68,0
s_cbranch_scc1 rl2_91
fin_87:
s_nop 2
v_permlane32_swap_b32 v184,v188
v_permlane32_swap_b32 v185,v189
v_permlane32_swap_b32 v186,v190
v_permlane32_swap_b32 v187,v191
v_pk_add_f32 v[184:185],v[184:185],v[188:189]
v_pk_add_f32 v[186:187],v[186:187],v[190:191]
ds_write_b128 v24,v[184:187] offset:25600
ds_write_b32 v21,v25 offset:12
s_mov_b64 exec,s[84:85]
ds_read_b128 v[172:175],v12
s_mov_b64 exec,-1
ds_read_b64 v[220:221],v21 offset:24
buffer_load_dwordx4 v[96:99],v2,s[20:23],s72 offen offset:0 sc1
buffer_load_dwordx4 v[100:103],v2,s[20:23],s72 offen offset:1024 sc1
buffer_load_dwordx4 v[104:107],v5,s[20:23],s72 offen offset:0 sc1
buffer_load_dwordx4 v[108:111],v5,s[20:23],s72 offen offset:1024 sc1
buffer_load_dwordx4 v[112:115],v6,s[20:23],s72 offen offset:0 sc1
buffer_load_dwordx4 v[116:119],v6,s[20:23],s72 offen offset:1024 sc1
buffer_load_dwordx4 v[120:123],v7,s[20:23],s72 offen offset:0 sc1
buffer_load_dwordx4 v[124:127],v7,s[20:23],s72 offen offset:1024 sc1
s_waitcnt lgkmcnt(0)
v_min_u32 v220,v220,v221
v_cmp_ne_u32 vcc,v220,v25
s_cbranch_vccnz v2w_92
v2b_93:
buffer_store_dwordx4 v[172:175],v3,s[20:23],s77 offen sc1
s_xor_b32 s62,s62,0x10000
s_add_u32 s63,s79,1
s_and_b32 s64,s63,3
s_lshl_b32 s70,s64,20
s_add_u32 s65,s63,2
s_and_b32 s65,s65,3
s_lshl_b32 s73,s65,20
s_add_u32 s55,s63,3
s_lshl_b32 s78,s55,16
s_add_u32 s78,s78,57344
s_cmp_lt_u32 s55,64
s_cselect_b32 s78,s78,0x7fff0000
s_add_u32 s71,s70,65536
s_add_u32 s60,s63,1
s_and_b32 s60,s60,3
s_lshl_b32 s72,s60,20
v_mov_b32 v184,0
v_mov_b32 v185,0
v_mov_b32 v186,0
v_mov_b32 v187,0
v_mov_b32 v188,0
v_mov_b32 v189,0
v_mov_b32 v190,0
v_mov_b32 v191,0
s_lshl_b32 s77,s63,21
s_lshl_b32 s55,s63,13
s_and_b32 s55,s55,0x2000
s_xor_b32 s55,s55,s61
s_add_u32 s77,s77,s55
v_mov_b32 v176,0
v_mov_b32 v177,0
v_mov_b32 v178,0
v_mov_b32 v179,0
s_add_u32 s79,s79,1
v_add_u32 v25,1,v25
s_waitcnt vmcnt(0) lgkmcnt(0)
s_branch loop_64
last0_76:
wf_94:
ds_read_b32 v23,v21 offset:0
s_sub_u32 s90,s90,1
s_waitcnt lgkmcnt(0)
v_cmp_ne_u32 vcc,v23,v25
s_cmp_lt_i32 s90,0
s_cselect_b64 vcc,0,vcc
s_cbranch_vccnz wf_94
wf_95:
ds_read_b32 v23,v21 offset:4
s_sub_u32 s90,s90,1
s_waitcnt lgkmcnt(0)
v_cmp_ne_u32 vcc,v23,v25
s_cmp_lt_i32 s90,0
s_cselect_b64 vcc,0,vcc
s_cbranch_vccnz wf_95
s_mov_b64 exec,s[84:85]
ds_read_b128 v[172:175],v12
s_mov_b64 exec,-1
s_waitcnt lgkmcnt(0)
buffer_store_dwordx4 v[172:175],v3,s[20:23],s77 offen sc1
s_branch end_58
art_68:
s_sub_u32 s90,s90,1
s_cmp_lt_i32 s90,0
s_cbranch_scc1 abk_69
buffer_load_dwordx4 v[32:35],v26,s[20:23],s70 offen offset:0 sc1
buffer_load_dwordx4 v[36:39],v26,s[20:23],s70 offen offset:1024 sc1
buffer_load_dwordx4 v[40:43],v26,s[20:23],s70 offen offset:2048 sc1
buffer_load_dwordx4 v[44:47],v26,s[20:23],s70 offen offset:3072 sc1
s_waitcnt vmcnt(3)
ds_write_b128 v24,v[32:35] offset:0
v_min3_u32 v22,v32,v33,v34
v_min_u32 v22,v22,v35
s_waitcnt vmcnt(2)
ds_write_b128 v24,v[36:39] offset:1024
v_min3_u32 v22,v22,v36,v37
v_min3_u32 v22,v22,v38,v39
s_waitcnt vmcnt(1)
ds_write_b128 v24,v[40:43] offset:2048
v_min3_u32 v22,v22,v40,v41
v_min3_u32 v22,v22,v42,v43
s_waitcnt vmcnt(0)
ds_write_b128 v24,v[44:47] offset:3072
v_min3_u32 v22,v22,v44,v45
v_min3_u32 v22,v22,v46,v47
v_cmp_eq_u32 vcc,0,v22
s_cbranch_vccnz art_68
s_branch abk_69
kt0_70:
buffer_load_dwordx4 v[96:99],v2,s[20:23],s70 offen offset:0 sc1
buffer_load_dwordx4 v[100:103],v2,s[20:23],s70 offen offset:1024 sc1
buffer_load_dwordx4 v[104:107],v5,s[20:23],s70 offen offset:0 sc1
buffer_load_dwordx4 v[108:111],v5,s[20:23],s70 offen offset:1024 sc1
buffer_load_dwordx4 v[112:115],v6,s[20:23],s70 offen offset:0 sc1
buffer_load_dwordx4 v[116:119],v6,s[20:23],s70 offen offset:1024 sc1
buffer_load_dwordx4 v[120:123],v7,s[20:23],s70 offen offset:0 sc1
buffer_load_dwordx4 v[124:127],v7,s[20:23],s70 offen offset:1024 sc1
s_branch kt0b_71
vw_77:
wf_96:
ds_read_b32 v23,v21 offset:0
s_sub_u32 s90,s90,1
s_waitcnt lgkmcnt(0)
v_cmp_ne_u32 vcc,v23,v25
s_cmp_lt_i32 s90,0
s_cselect_b64 vcc,0,vcc
s_cbranch_vccnz wf_96
wf_97:
ds_read_b32 v23,v21 offset:4
s_sub_u32 s90,s90,1
s_waitcnt lgkmcnt(0)
v_cmp_ne_u32 vcc,v23,v25
s_cmp_lt_i32 s90,0
s_cselect_b64 vcc,0,vcc
s_cbranch_vccnz wf_97
ds_read_b64 v[220:221],v21
ds_read_b64 v[136:137],v31
ds_read_b64 v[140:141],v31 offset:256
s_waitcnt lgkmcnt(0)
s_branch vb_78
ms_81:
s_waitcnt vmcnt(0)
buffer_load_dwordx4 v[64:67],v26,s[20:23],s71 offen offset:0 sc1
buffer_load_dwordx4 v[68:71],v26,s[20:23],s71 offen offset:1024 sc1
s_bitset1_b32 s68,0
s_branch bk_82
ms_83:
s_waitcnt vmcnt(0)
buffer_load_dwordx4 v[72:75],v26,s[20:23],s71 offen offset:2048 sc1
buffer_load_dwordx4 v[76:79],v26,s[20:23],s71 offen offset:3072 sc1
s_bitset1_b32 s68,1
s_branch bk_84
ms_85:
s_waitcnt vmcnt(0)
buffer_load_dwordx4 v[80:83],v27,s[20:23],s71 offen offset:0 sc1
buffer_load_dwordx4 v[84:87],v27,s[20:23],s71 offen offset:1024 sc1
s_bitset1_b32 s68,2
s_branch bk_86
ms_89:
s_waitcnt vmcnt(0)
buffer_load_dwordx4 v[88:91],v27,s[20:23],s71 offen offset:2048 sc1
buffer_load_dwordx4 v[92:95],v27,s[20:23],s71 offen offset:3072 sc1
s_bitset1_b32 s68,3
s_branch bk_90
rl_88:
s_bitcmp1_b32 s68,0
s_cbranch_scc0 sk_98
buffer_load_dwordx4 v[64:67],v26,s[20:23],s71 offen offset:0 sc1
buffer_load_dwordx4 v[68:71],v26,s[20:23],s71 offen offset:1024 sc1
sk_98:
s_bitcmp1_b32 s68,1
s_cbranch_scc0 sk_99
buffer_load_dwordx4 v[72:75],v26,s[20:23],s71 offen offset:2048 sc1
buffer_load_dwordx4 v[76:79],v26,s[20:23],s71 offen offset:3072 sc1
sk_99:
s_bitcmp1_b32 s68,2
s_cbranch_scc0 sk_100
buffer_load_dwordx4 v[80:83],v27,s[20:23],s71 offen offset:0 sc1
buffer_load_dwordx4 v[84:87],v27,s[20:23],s71 offen offset:1024 sc1
sk_100:
s_bitcmp1_b32 s68,3
s_cbranch_scc0 sk_101
buffer_load_dwordx4 v[88:91],v27,s[20:23],s71 offen offset:2048 sc1
buffer_load_dwordx4 v[92:95],v27,s[20:23],s71 offen offset:3072 sc1
sk_101:
rl2_91:
s_sub_u32 s90,s90,1
s_cmp_lt_i32 s90,0
s_cbranch_scc1 fin_87
s_waitcnt vmcnt(0)
s_bitcmp1_b32 s68,0
s_cbranch_scc0 sk_102
v_min3_u32 v22,v64,v65,v66
v_min3_u32 v22,v22,v67,v68
v_min3_u32 v22,v22,v69,v70
v_min_u32 v22,v22,v71
v_cmp_eq_u32 vcc,0,v22
v_xor_b32 v64,v32,v64
v_xor_b32 v65,v33,v65
v_xor_b32 v66,v34,v66
v_xor_b32 v67,v35,v67
v_xor_b32 v68,v36,v68
v_xor_b32 v69,v37,v69
v_xor_b32 v70,v38,v70
v_xor_b32 v71,v39,v71
s_cbranch_vccnz nb_103
s_bitset0_b32 s68,0
v_smfmac_f32_16x16x64_bf16 v[184:187],v[64:67],a[128:135],v14
v_smfmac_f32_16x16x64_bf16 v[188:191],v[64:67],a[136:143],v14
v_smfmac_f32_16x16x64_bf16 v[184:187],v[68:71],a[144:151],v14
v_smfmac_f32_16x16x64_bf16 v[188:191],v[68:71],a[152:159],v14
nb_103:
sk_102:
s_bitcmp1_b32 s68,1
s_cbranch_scc0 sk_104
v_min3_u32 v22,v72,v73,v74
v_min3_u32 v22,v22,v75,v76
v_min3_u32 v22,v22,v77,v78
v_min_u32 v22,v22,v79
v_cmp_eq_u32 vcc,0,v22
v_xor_b32 v72,v40,v72
v_xor_b32 v73,v41,v73
v_xor_b32 v74,v42,v74
v_xor_b32 v75,v43,v75
v_xor_b32 v76,v44,v76
v_xor_b32 v77,v45,v77
v_xor_b32 v78,v46,v78
v_xor_b32 v79,v47,v79
s_cbranch_vccnz nb_105
s_bitset0_b32 s68,1
v_smfmac_f32_16x16x64_bf16 v[184:187],v[72:75],a[160:167],v14
v_smfmac_f32_16x16x64_bf16 v[188:191],v[72:75],a[168:175],v14
v_smfmac_f32_16x16x64_bf16 v[184:187],v[76:79],a[176:183],v14
v_smfmac_f32_16x16x64_bf16 v[188:191],v[76:79],a[184:191],v14
nb_105:
sk_104:
s_bitcmp1_b32 s68,2
s_cbranch_scc0 sk_106
v_min3_u32 v22,v80,v81,v82
v_min3_u32 v22,v22,v83,v84
v_min3_u32 v22,v22,v85,v86
v_min_u32 v22,v22,v87
v_cmp_eq_u32 vcc,0,v22
v_xor_b32 v80,v48,v80
v_xor_b32 v81,v49,v81
v_xor_b32 v82,v50,v82
v_xor_b32 v83,v51,v83
v_xor_b32 v84,v52,v84
v_xor_b32 v85,v53,v85
v_xor_b32 v86,v54,v86
v_xor_b32 v87,v55,v87
s_cbranch_vccnz nb_107
s_bitset0_b32 s68,2
v_smfmac_f32_16x16x64_bf16 v[184:187],v[80:83],a[192:199],v14
v_smfmac_f32_16x16x64_bf16 v[188:191],v[80:83],a[200:207],v14
v_smfmac_f32_16x16x64_bf16 v[184:187],v[84:87],a[208:215],v14
v_smfmac_f32_16x16x64_bf16 v[188:191],v[84:87],a[216:223],v14
nb_107:
sk_106:
s_bitcmp1_b32 s68,3
s_cbranch_scc0 sk_108
v_min3_u32 v22,v88,v89,v90
v_min3_u32 v22,v22,v91,v92
v_min3_u32 v22,v22,v93,v94
v_min_u32 v22,v22,v95
v_cmp_eq_u32 vcc,0,v22
v_xor_b32 v88,v56,v88
v_xor_b32 v89,v57,v89
v_xor_b32 v90,v58,v90
v_xor_b32 v91,v59,v91
v_xor_b32 v92,v60,v92
v_xor_b32 v93,v61,v93
v_xor_b32 v94,v62,v94
v_xor_b32 v95,v63,v95
s_cbranch_vccnz nb_109
s_bitset0_b32 s68,3
v_smfmac_f32_16x16x64_bf16 v[184:187],v[88:91],a[224:231],v14
v_smfmac_f32_16x16x64_bf16 v[188:191],v[88:91],a[232:239],v14
v_smfmac_f32_16x16x64_bf16 v[184:187],v[92:95],a[240:247],v14
v_smfmac_f32_16x16x64_bf16 v[188:191],v[92:95],a[248:255],v14
nb_109:
sk_108:
s_cmp_lg_u32 s68,0
s_cbranch_scc1 rl_88
s_nop 2
s_branch fin_87
v2w_92:
wf_110:
ds_read_b32 v23,v21 offset:24
s_sub_u32 s90,s90,1
s_waitcnt lgkmcnt(0)
v_cmp_ne_u32 vcc,v23,v25
s_cmp_lt_i32 s90,0
s_cselect_b64 vcc,0,vcc
s_cbranch_vccnz wf_110
wf_111:
ds_read_b32 v23,v21 offset:28
s_sub_u32 s90,s90,1
s_waitcnt lgkmcnt(0)
v_cmp_ne_u32 vcc,v23,v25
s_cmp_lt_i32 s90,0
s_cselect_b64 vcc,0,vcc
s_cbranch_vccnz wf_111
s_branch v2b_93
first_63:
s_waitcnt vmcnt(0) lgkmcnt(0)
s_barrier
s_mov_b32 m0,65536
s_mov_b32 s65,122880
buffer_load_dwordx4 v16,s[20:23],s65 offen offset:0 lds
buffer_load_dwordx4 v16,s[20:23],s65 offen offset:1024 lds
buffer_load_dwordx4 v16,s[20:23],s65 offen offset:2048 lds
buffer_load_dwordx4 v16,s[20:23],s65 offen offset:3072 lds
s_mov_b32 m0,69632
s_mov_b32 s65,126976
buffer_load_dwordx4 v16,s[20:23],s65 offen offset:0 lds
buffer_load_dwordx4 v16,s[20:23],s65 offen offset:1024 lds
buffer_load_dwordx4 v16,s[20:23],s65 offen offset:2048 lds
buffer_load_dwordx4 v16,s[20:23],s65 offen offset:3072 lds
s_mov_b32 m0,73728
s_mov_b32 s65,131072
buffer_load_dwordx4 v16,s[20:23],s65 offen offset:0 lds
buffer_load_dwordx4 v16,s[20:23],s65 offen offset:1024 lds
buffer_load_dwordx4 v16,s[20:23],s65 offen offset:2048 lds
buffer_load_dwordx4 v16,s[20:23],s65 offen offset:3072 lds
s_mov_b32 m0,77824
s_mov_b32 s65,135168
buffer_load_dwordx4 v16,s[20:23],s65 offen offset:0 lds
buffer_load_dwordx4 v16,s[20:23],s65 offen offset:1024 lds
buffer_load_dwordx4 v16,s[20:23],s65 offen offset:2048 lds
buffer_load_dwordx4 v16,s[20:23],s65 offen offset:3072 lds
s_mov_b32 m0,81920
s_mov_b32 s65,139264
buffer_load_dwordx4 v16,s[20:23],s65 offen offset:0 lds
buffer_load_dwordx4 v16,s[20:23],s65 offen offset:1024 lds
buffer_load_dwordx4 v16,s[20:23],s65 offen offset:2048 lds
buffer_load_dwordx4 v16,s[20:23],s65 offen offset:3072 lds
s_mov_b32 m0,86016
s_mov_b32 s65,143360
buffer_load_dwordx4 v16,s[20:23],s65 offen offset:0 lds
buffer_load_dwordx4 v16,s[20:23],s65 offen offset:1024 lds
buffer_load_dwordx4 v16,s[20:23],s65 offen offset:2048 lds
buffer_load_dwordx4 v16,s[20:23],s65 offen offset:3072 lds
s_mov_b32 m0,90112
s_mov_b32 s65,147456
buffer_load_dwordx4 v16,s[20:23],s65 offen offset:0 lds
buffer_load_dwordx4 v16,s[20:23],s65 offen offset:1024 lds
buffer_load_dwordx4 v16,s[20:23],s65 offen offset:2048 lds
buffer_load_dwordx4 v16,s[20:23],s65 offen offset:3072 lds
s_mov_b32 m0,94208
s_mov_b32 s65,151552
buffer_load_dwordx4 v16,s[20:23],s65 offen offset:0 lds
buffer_load_dwordx4 v16,s[20:23],s65 offen offset:1024 lds
buffer_load_dwordx4 v16,s[20:23],s65 offen offset:2048 lds
buffer_load_dwordx4 v16,s[20:23],s65 offen offset:3072 lds
s_xor_b32 s64,s61,4194304
buffer_store_dwordx4 v[100:103],v206,s[20:23],s64 offen sc1
buffer_store_dwordx4 v[100:103],v207,s[20:23],s64 offen sc1
s_xor_b32 s64,s61,6299648
buffer_store_dwordx4 v[100:103],v206,s[20:23],s64 offen sc1
buffer_store_dwordx4 v[100:103],v207,s[20:23],s64 offen sc1
s_xor_b32 s64,s61,8388608
buffer_store_dwordx4 v[100:103],v206,s[20:23],s64 offen sc1
buffer_store_dwordx4 v[100:103],v207,s[20:23],s64 offen sc1
s_waitcnt vmcnt(6)
s_barrier
s_mov_b32 m0,0
s_mov_b32 s65,188416
buffer_load_dwordx4 v16,s[20:23],s65 offen offset:0 lds
buffer_load_dwordx4 v16,s[20:23],s65 offen offset:1024 lds
buffer_load_dwordx4 v16,s[20:23],s65 offen offset:2048 lds
buffer_load_dwordx4 v16,s[20:23],s65 offen offset:3072 lds
s_mov_b32 m0,4096
s_mov_b32 s65,192512
buffer_load_dwordx4 v16,s[20:23],s65 offen offset:0 lds
buffer_load_dwordx4 v16,s[20:23],s65 offen offset:1024 lds
buffer_load_dwordx4 v16,s[20:23],s65 offen offset:2048 lds
buffer_load_dwordx4 v16,s[20:23],s65 offen offset:3072 lds
s_mov_b32 m0,8192
s_mov_b32 s65,196608
buffer_load_dwordx4 v16,s[20:23],s65 offen offset:0 lds
buffer_load_dwordx4 v16,s[20:23],s65 offen offset:1024 lds
buffer_load_dwordx4 v16,s[20:23],s65 offen offset:2048 lds
buffer_load_dwordx4 v16,s[20:23],s65 offen offset:3072 lds
s_mov_b32 m0,12288
s_mov_b32 s65,200704
buffer_load_dwordx4 v16,s[20:23],s65 offen offset:0 lds
buffer_load_dwordx4 v16,s[20:23],s65 offen offset:1024 lds
buffer_load_dwordx4 v16,s[20:23],s65 offen offset:2048 lds
buffer_load_dwordx4 v16,s[20:23],s65 offen offset:3072 lds
s_mov_b32 m0,16384
s_mov_b32 s65,204800
buffer_load_dwordx4 v16,s[20:23],s65 offen offset:0 lds
buffer_load_dwordx4 v16,s[20:23],s65 offen offset:1024 lds
buffer_load_dwordx4 v16,s[20:23],s65 offen offset:2048 lds
buffer_load_dwordx4 v16,s[20:23],s65 offen offset:3072 lds
s_mov_b32 m0,20480
s_mov_b32 s65,208896
buffer_load_dwordx4 v16,s[20:23],s65 offen offset:0 lds
buffer_load_dwordx4 v16,s[20:23],s65 offen offset:1024 lds
buffer_load_dwordx4 v16,s[20:23],s65 offen offset:2048 lds
buffer_load_dwordx4 v16,s[20:23],s65 offen offset:3072 lds
s_mov_b32 m0,24576
s_mov_b32 s65,212992
buffer_load_dwordx4 v16,s[20:23],s65 offen offset:0 lds
buffer_load_dwordx4 v16,s[20:23],s65 offen offset:1024 lds
buffer_load_dwordx4 v16,s[20:23],s65 offen offset:2048 lds
buffer_load_dwordx4 v16,s[20:23],s65 offen offset:3072 lds
s_mov_b32 m0,28672
s_mov_b32 s65,217088
buffer_load_dwordx4 v16,s[20:23],s65 offen offset:0 lds
buffer_load_dwordx4 v16,s[20:23],s65 offen offset:1024 lds
buffer_load_dwordx4 v16,s[20:23],s65 offen offset:2048 lds
buffer_load_dwordx4 v16,s[20:23],s65 offen offset:3072 lds
s_mov_b32 s79,0
s_add_u32 s63,s79,0
s_and_b32 s64,s63,3
s_lshl_b32 s70,s64,20
s_add_u32 s65,s63,2
s_and_b32 s65,s65,3
s_lshl_b32 s73,s65,20
s_add_u32 s55,s63,3
s_lshl_b32 s78,s55,16
s_add_u32 s78,s78,57344
s_cmp_lt_u32 s55,64
s_cselect_b32 s78,s78,0x7fff0000
s_add_u32 s71,s70,65536
s_add_u32 s60,s63,1
s_and_b32 s60,s60,3
s_lshl_b32 s72,s60,20
v_mov_b32 v184,0
v_mov_b32 v185,0
v_mov_b32 v186,0
v_mov_b32 v187,0
v_mov_b32 v188,0
v_mov_b32 v189,0
v_mov_b32 v190,0
v_mov_b32 v191,0
s_lshl_b32 s77,s63,21
s_lshl_b32 s55,s63,13
s_and_b32 s55,s55,0x2000
s_xor_b32 s55,s55,s61
s_add_u32 s77,s77,s55
v_mov_b32 v176,0
v_mov_b32 v177,0
v_mov_b32 v178,0
v_mov_b32 v179,0
v_mov_b32 v25,1
s_waitcnt vmcnt(0) lgkmcnt(0)
s_barrier
s_branch loop_64
w1_60:
s_lshr_b32 s64,s57,2
s_add_u32 s64,s64,64
s_lshl_b32 s64,s64,14
s_add_u32 s64,s64,s68
s_add_u32 s64,s64,29360128
v_add_u32 v12,s64,v16
v_and_b32 v22,1,v4
v_lshrrev_b32 v23,1,v4
v_lshl_add_u32 v22,v22,1,v23
v_lshlrev_b32 v22,2,v22
v_lshl_add_u32 v22,v3,4,v22
v_add_u32 v31,155648,v22
v_add_u32 v8,s66,v16
v_add_u32 v9,s67,v16
v_mov_b32 v10,1792
v_mov_b32 v11,0
s_branch first_112
loop_113:
s_barrier
buffer_load_dword v248,v18,s[20:23],s70 offen offset:0 sc1
s_nop 15
s_nop 5
hl_115:
buffer_load_dword v249,v18,s[20:23],s70 offen offset:0 sc1
s_waitcnt vmcnt(1)
v_cmp_eq_u32 vcc,v25,v248
s_bcnt1_i32_b32 s64,vcc_lo
s_cmp_ge_u32 s64,8
s_cbranch_scc1 hg_116
buffer_load_dword v248,v18,s[20:23],s70 offen offset:0 sc1
s_waitcnt vmcnt(1)
v_cmp_eq_u32 vcc,v25,v249
s_bcnt1_i32_b32 s64,vcc_lo
s_cmp_ge_u32 s64,8
s_cbranch_scc1 hg_116
s_sub_u32 s90,s90,1
s_cmp_gt_i32 s90,0
s_cbranch_scc1 hl_115
hg_116:
buffer_load_dwordx4 v[48:51],v27,s[20:23],s70 offen offset:0 sc1
buffer_load_dwordx4 v[52:55],v27,s[20:23],s70 offen offset:1024 sc1
buffer_load_dwordx4 v[56:59],v27,s[20:23],s70 offen offset:2048 sc1
buffer_load_dwordx4 v[60:63],v27,s[20:23],s70 offen offset:3072 sc1
s_waitcnt vmcnt(3)
ds_write_b128 v24,v[48:51] offset:4096
v_min3_u32 v22,v48,v49,v50
v_min_u32 v22,v22,v51
s_waitcnt vmcnt(2)
ds_write_b128 v24,v[52:55] offset:5120
v_min3_u32 v22,v22,v52,v53
v_min3_u32 v22,v22,v54,v55
s_waitcnt vmcnt(1)
ds_write_b128 v24,v[56:59] offset:6144
v_min3_u32 v22,v22,v56,v57
v_min3_u32 v22,v22,v58,v59
s_waitcnt vmcnt(0)
ds_write_b128 v24,v[60:63] offset:7168
v_min3_u32 v22,v22,v60,v61
v_min3_u32 v22,v22,v62,v63
v_cmp_eq_u32 vcc,0,v22
s_cbranch_vccnz art_117
abk_118:
v_smfmac_f32_16x16x64_bf16 v[176:179],v[48:51],a[32:39],v14
s_waitcnt lgkmcnt(0)
s_barrier
ds_read_b128 v[64:67],v24 offset:8192
ds_read_b128 v[68:71],v24 offset:9216
ds_read_b128 v[72:75],v24 offset:10240
ds_read_b128 v[76:79],v24 offset:11264
buffer_store_dwordx4 v[212:215],v12,s[20:23],s76 offen sc1
v_smfmac_f32_16x16x64_bf16 v[176:179],v[52:55],a[40:47],v14
ds_read_b128 v[80:83],v24 offset:12288
ds_read_b128 v[84:87],v24 offset:13312
v_smfmac_f32_16x16x64_bf16 v[176:179],v[56:59],a[48:55],v14
ds_read_b128 v[88:91],v24 offset:14336
ds_read_b128 v[92:95],v24 offset:15360
v_smfmac_f32_16x16x64_bf16 v[176:179],v[60:63],a[56:63],v14
ds_read_b128 v[32:35],v24 offset:0
ds_read_b128 v[36:39],v24 offset:1024
s_waitcnt lgkmcnt(9)
v_smfmac_f32_16x16x64_bf16 v[176:179],v[64:67],a[64:71],v14
ds_read_b128 v[40:43],v24 offset:2048
s_waitcnt lgkmcnt(9)
v_smfmac_f32_16x16x64_bf16 v[176:179],v[68:71],a[72:79],v14
ds_read_b128 v[44:47],v24 offset:3072
s_waitcnt lgkmcnt(9)
v_smfmac_f32_16x16x64_bf16 v[176:179],v[72:75],a[80:87],v14
s_waitcnt lgkmcnt(8)
v_smfmac_f32_16x16x64_bf16 v[176:179],v[76:79],a[88:95],v14
s_waitcnt lgkmcnt(7)
v_smfmac_f32_16x16x64_bf16 v[176:179],v[80:83],a[96:103],v14
s_waitcnt lgkmcnt(6)
v_smfmac_f32_16x16x64_bf16 v[176:179],v[84:87],a[104:111],v14
s_waitcnt lgkmcnt(5)
v_smfmac_f32_16x16x64_bf16 v[176:179],v[88:91],a[112:119],v14
s_waitcnt lgkmcnt(4)
v_smfmac_f32_16x16x64_bf16 v[176:179],v[92:95],a[120:127],v14
s_waitcnt lgkmcnt(3)
v_smfmac_f32_16x16x64_bf16 v[176:179],v[32:35],a[0:7],v14
s_waitcnt lgkmcnt(2)
v_smfmac_f32_16x16x64_bf16 v[176:179],v[36:39],a[8:15],v14
s_waitcnt lgkmcnt(1)
v_smfmac_f32_16x16x64_bf16 v[176:179],v[40:43],a[16:23],v14
s_waitcnt lgkmcnt(0)
v_smfmac_f32_16x16x64_bf16 v[176:179],v[44:47],a[24:31],v14
v_smfmac_f32_16x16x64_bf16 v[180:183],v[32:35],a[128:135],v14
v_smfmac_f32_16x16x64_bf16 v[180:183],v[36:39],a[136:143],v14
s_nop 5
v_permlane32_swap_b32 v176,v178
v_permlane32_swap_b32 v177,v179
v_add_f32 v176,v176,v178
v_add_f32 v177,v177,v179
v_cvt_pk_bf16_f32 v216,v176,v177
s_nop 1
v_mov_b32_dpp v217,v216 quad_perm:[1,0,3,2] row_mask:0xf bank_mask:0xf
v_perm_b32 v216,v217,v216,v15
v_max_u32 v216,1,v216
buffer_store_dword v216,v19,s[24:27],s70 offen
buffer_store_dword v216,v19,s[28:31],s70 offen sc1
v_smfmac_f32_16x16x64_bf16 v[180:183],v[40:43],a[144:151],v14
v_smfmac_f32_16x16x64_bf16 v[180:183],v[44:47],a[152:159],v14
v_smfmac_f32_16x16x64_bf16 v[180:183],v[48:51],a[160:167],v14
v_smfmac_f32_16x16x64_bf16 v[180:183],v[52:55],a[168:175],v14
v_smfmac_f32_16x16x64_bf16 v[180:183],v[56:59],a[176:183],v14
v_smfmac_f32_16x16x64_bf16 v[180:183],v[60:63],a[184:191],v14
v_smfmac_f32_16x16x64_bf16 v[180:183],v[64:67],a[192:199],v14
v_smfmac_f32_16x16x64_bf16 v[180:183],v[68:71],a[200:207],v14
v_smfmac_f32_16x16x64_bf16 v[180:183],v[72:75],a[208:215],v14
v_smfmac_f32_16x16x64_bf16 v[180:183],v[76:79],a[216:223],v14
v_smfmac_f32_16x16x64_bf16 v[180:183],v[80:83],a[224:231],v14
v_smfmac_f32_16x16x64_bf16 v[180:183],v[84:87],a[232:239],v14
v_smfmac_f32_16x16x64_bf16 v[180:183],v[88:91],a[240:247],v14
v_smfmac_f32_16x16x64_bf16 v[180:183],v[92:95],a[248:255],v14
s_nop 7
v_permlane32_swap_b32 v180,v182
v_permlane32_swap_b32 v181,v183
v_add_f32 v180,v180,v182
v_add_f32 v181,v181,v183
v_cvt_pk_bf16_f32 v216,v180,v181
v_max_u32 v216,1,v216
ds_write_b32 v31,v216
ds_write_b32 v21,v25 offset:0
s_cmp_eq_u32 s79,63
s_cbranch_scc1 end_58
s_cmp_ge_i32 s79,62
s_cbranch_scc1 bgsk_120
ds_read_b128 v[64:67],v20 offset:0
ds_read_b128 v[68:71],v20 offset:1024
ds_read_b128 v[72:75],v20 offset:2048
s_waitcnt lgkmcnt(2)
v_mfma_f32_16x16x32_bf16 v[192:195],a[0:3],v[64:67],0
ds_read_b128 v[76:79],v20 offset:3072
v_mfma_f32_16x16x32_bf16 v[200:203],v[64:67],a[128:131],0
s_waitcnt lgkmcnt(2)
v_mfma_f32_16x16x32_bf16 v[196:199],a[0:3],v[68:71],0
ds_read_b128 v[64:67],v20 offset:4096
v_mfma_f32_16x16x32_bf16 v[204:207],v[68:71],a[128:131],0
s_waitcnt lgkmcnt(2)
v_mfma_f32_16x16x32_bf16 v[192:195],a[4:7],v[72:75],v[192:195]
ds_read_b128 v[68:71],v20 offset:5120
v_mfma_f32_16x16x32_bf16 v[200:203],v[72:75],a[132:135],v[200:203]
s_waitcnt lgkmcnt(2)
v_mfma_f32_16x16x32_bf16 v[196:199],a[4:7],v[76:79],v[196:199]
ds_read_b128 v[72:75],v20 offset:6144
v_mfma_f32_16x16x32_bf16 v[204:207],v[76:79],a[132:135],v[204:207]
s_waitcnt lgkmcnt(2)
v_mfma_f32_16x16x32_bf16 v[192:195],a[8:11],v[64:67],v[192:195]
ds_read_b128 v[76:79],v20 offset:7168
v_mfma_f32_16x16x32_bf16 v[200:203],v[64:67],a[136:139],v[200:203]
s_waitcnt lgkmcnt(2)
v_mfma_f32_16x16x32_bf16 v[196:199],a[8:11],v[68:71],v[196:199]
ds_read_b128 v[64:67],v20 offset:8192
v_mfma_f32_16x16x32_bf16 v[204:207],v[68:71],a[136:139],v[204:207]
s_waitcnt lgkmcnt(2)
v_mfma_f32_16x16x32_bf16 v[192:195],a[12:15],v[72:75],v[192:195]
ds_read_b128 v[68:71],v20 offset:9216
v_mfma_f32_16x16x32_bf16 v[200:203],v[72:75],a[140:143],v[200:203]
s_waitcnt lgkmcnt(2)
v_mfma_f32_16x16x32_bf16 v[196:199],a[12:15],v[76:79],v[196:199]
ds_read_b128 v[72:75],v20 offset:10240
v_mfma_f32_16x16x32_bf16 v[204:207],v[76:79],a[140:143],v[204:207]
s_add_u32 m0,s62,0
s_add_u32 s69,s78,0
s_waitcnt lgkmcnt(2)
v_mfma_f32_16x16x32_bf16 v[192:195],a[16:19],v[64:67],v[192:195]
ds_read_b128 v[76:79],v20 offset:11264
v_mfma_f32_16x16x32_bf16 v[200:203],v[64:67],a[144:147],v[200:203]
buffer_load_dwordx4 v16,s[20:23],s69 offen offset:0 lds
s_waitcnt lgkmcnt(2)
v_mfma_f32_16x16x32_bf16 v[196:199],a[16:19],v[68:71],v[196:199]
ds_read_b128 v[64:67],v20 offset:12288
v_mfma_f32_16x16x32_bf16 v[204:207],v[68:71],a[144:147],v[204:207]
buffer_load_dwordx4 v16,s[20:23],s69 offen offset:1024 lds
s_waitcnt lgkmcnt(2)
v_mfma_f32_16x16x32_bf16 v[192:195],a[20:23],v[72:75],v[192:195]
ds_read_b128 v[68:71],v20 offset:13312
v_mfma_f32_16x16x32_bf16 v[200:203],v[72:75],a[148:151],v[200:203]
buffer_load_dwordx4 v16,s[20:23],s69 offen offset:2048 lds
s_waitcnt lgkmcnt(2)
v_mfma_f32_16x16x32_bf16 v[196:199],a[20:23],v[76:79],v[196:199]
ds_read_b128 v[72:75],v20 offset:14336
v_mfma_f32_16x16x32_bf16 v[204:207],v[76:79],a[148:151],v[204:207]
buffer_load_dwordx4 v16,s[20:23],s69 offen offset:3072 lds
s_waitcnt lgkmcnt(2)
v_mfma_f32_16x16x32_bf16 v[192:195],a[24:27],v[64:67],v[192:195]
ds_read_b128 v[76:79],v20 offset:15360
v_mfma_f32_16x16x32_bf16 v[200:203],v[64:67],a[152:155],v[200:203]
s_add_u32 m0,s62,4096
s_add_u32 s69,s78,4096
s_waitcnt lgkmcnt(2)
v_mfma_f32_16x16x32_bf16 v[196:199],a[24:27],v[68:71],v[196:199]
ds_read_b128 v[64:67],v20 offset:16384
v_mfma_f32_16x16x32_bf16 v[204:207],v[68:71],a[152:155],v[204:207]
buffer_load_dwordx4 v16,s[20:23],s69 offen offset:0 lds
s_waitcnt lgkmcnt(2)
v_mfma_f32_16x16x32_bf16 v[192:195],a[28:31],v[72:75],v[192:195]
ds_read_b128 v[68:71],v20 offset:17408
v_mfma_f32_16x16x32_bf16 v[200:203],v[72:75],a[156:159],v[200:203]
buffer_load_dwordx4 v16,s[20:23],s69 offen offset:1024 lds
s_waitcnt lgkmcnt(2)
v_mfma_f32_16x16x32_bf16 v[196:199],a[28:31],v[76:79],v[196:199]
ds_read_b128 v[72:75],v20 offset:18432
v_mfma_f32_16x16x32_bf16 v[204:207],v[76:79],a[156:159],v[204:207]
buffer_load_dwordx4 v16,s[20:23],s69 offen offset:2048 lds
s_waitcnt lgkmcnt(2)
v_mfma_f32_16x16x32_bf16 v[192:195],a[32:35],v[64:67],v[192:195]
ds_read_b128 v[76:79],v20 offset:19456
v_mfma_f32_16x16x32_bf16 v[200:203],v[64:67],a[160:163],v[200:203]
buffer_load_dwordx4 v16,s[20:23],s69 offen offset:3072 lds
s_waitcnt lgkmcnt(2)
v_mfma_f32_16x16x32_bf16 v[196:199],a[32:35],v[68:71],v[196:199]
ds_read_b128 v[64:67],v20 offset:20480
v_mfma_f32_16x16x32_bf16 v[204:207],v[68:71],a[160:163],v[204:207]
s_add_u32 m0,s62,8192
s_add_u32 s69,s78,8192
s_waitcnt lgkmcnt(2)
v_mfma_f32_16x16x32_bf16 v[192:195],a[36:39],v[72:75],v[192:195]
ds_read_b128 v[68:71],v20 offset:21504
v_mfma_f32_16x16x32_bf16 v[200:203],v[72:75],a[164:167],v[200:203]
buffer_load_dwordx4 v16,s[20:23],s69 offen offset:0 lds
s_waitcnt lgkmcnt(2)
v_mfma_f32_16x16x32_bf16 v[196:199],a[36:39],v[76:79],v[196:199]
ds_read_b128 v[72:75],v20 offset:22528
v_mfma_f32_16x16x32_bf16 v[204:207],v[76:79],a[164:167],v[204:207]
buffer_load_dwordx4 v16,s[20:23],s69 offen offset:1024 lds
s_waitcnt lgkmcnt(2)
v_mfma_f32_16x16x32_bf16 v[192:195],a[40:43],v[64:67],v[192:195]
ds_read_b128 v[76:79],v20 offset:23552
v_mfma_f32_16x16x32_bf16 v[200:203],v[64:67],a[168:171],v[200:203]
buffer_load_dwordx4 v16,s[20:23],s69 offen offset:2048 lds
s_waitcnt lgkmcnt(2)
v_mfma_f32_16x16x32_bf16 v[196:199],a[40:43],v[68:71],v[196:199]
ds_read_b128 v[64:67],v20 offset:24576
v_mfma_f32_16x16x32_bf16 v[204:207],v[68:71],a[168:171],v[204:207]
buffer_load_dwordx4 v16,s[20:23],s69 offen offset:3072 lds
s_waitcnt lgkmcnt(2)
v_mfma_f32_16x16x32_bf16 v[192:195],a[44:47],v[72:75],v[192:195]
ds_read_b128 v[68:71],v20 offset:25600
v_mfma_f32_16x16x32_bf16 v[200:203],v[72:75],a[172:175],v[200:203]
s_add_u32 m0,s62,12288
s_add_u32 s69,s78,12288
s_waitcnt lgkmcnt(2)
v_mfma_f32_16x16x32_bf16 v[196:199],a[44:47],v[76:79],v[196:199]
ds_read_b128 v[72:75],v20 offset:26624
v_mfma_f32_16x16x32_bf16 v[204:207],v[76:79],a[172:175],v[204:207]
buffer_load_dwordx4 v16,s[20:23],s69 offen offset:0 lds
s_waitcnt lgkmcnt(2)
v_mfma_f32_16x16x32_bf16 v[192:195],a[48:51],v[64:67],v[192:195]
ds_read_b128 v[76:79],v20 offset:27648
v_mfma_f32_16x16x32_bf16 v[200:203],v[64:67],a[176:179],v[200:203]
buffer_load_dwordx4 v16,s[20:23],s69 offen offset:1024 lds
s_waitcnt lgkmcnt(2)
v_mfma_f32_16x16x32_bf16 v[196:199],a[48:51],v[68:71],v[196:199]
ds_read_b128 v[64:67],v20 offset:28672
v_mfma_f32_16x16x32_bf16 v[204:207],v[68:71],a[176:179],v[204:207]
buffer_load_dwordx4 v16,s[20:23],s69 offen offset:2048 lds
s_waitcnt lgkmcnt(2)
v_mfma_f32_16x16x32_bf16 v[192:195],a[52:55],v[72:75],v[192:195]
ds_read_b128 v[68:71],v20 offset:29696
v_mfma_f32_16x16x32_bf16 v[200:203],v[72:75],a[180:183],v[200:203]
buffer_load_dwordx4 v16,s[20:23],s69 offen offset:3072 lds
s_waitcnt lgkmcnt(2)
v_mfma_f32_16x16x32_bf16 v[196:199],a[52:55],v[76:79],v[196:199]
ds_read_b128 v[72:75],v20 offset:30720
v_mfma_f32_16x16x32_bf16 v[204:207],v[76:79],a[180:183],v[204:207]
s_waitcnt lgkmcnt(2)
v_mfma_f32_16x16x32_bf16 v[192:195],a[56:59],v[64:67],v[192:195]
ds_read_b128 v[76:79],v20 offset:31744
v_mfma_f32_16x16x32_bf16 v[200:203],v[64:67],a[184:187],v[200:203]
s_waitcnt lgkmcnt(2)
v_mfma_f32_16x16x32_bf16 v[196:199],a[56:59],v[68:71],v[196:199]
ds_read_b128 v[64:67],v20 offset:32768
v_mfma_f32_16x16x32_bf16 v[204:207],v[68:71],a[184:187],v[204:207]
s_waitcnt lgkmcnt(2)
v_mfma_f32_16x16x32_bf16 v[192:195],a[60:63],v[72:75],v[192:195]
ds_read_b128 v[68:71],v20 offset:33792
v_mfma_f32_16x16x32_bf16 v[200:203],v[72:75],a[188:191],v[200:203]
s_waitcnt lgkmcnt(2)
v_mfma_f32_16x16x32_bf16 v[196:199],a[60:63],v[76:79],v[196:199]
ds_read_b128 v[72:75],v20 offset:34816
v_mfma_f32_16x16x32_bf16 v[204:207],v[76:79],a[188:191],v[204:207]
s_waitcnt lgkmcnt(2)
v_mfma_f32_16x16x32_bf16 v[192:195],a[64:67],v[64:67],v[192:195]
ds_read_b128 v[76:79],v20 offset:35840
v_mfma_f32_16x16x32_bf16 v[200:203],v[64:67],a[192:195],v[200:203]
s_waitcnt lgkmcnt(2)
v_mfma_f32_16x16x32_bf16 v[196:199],a[64:67],v[68:71],v[196:199]
ds_read_b128 v[64:67],v20 offset:36864
v_mfma_f32_16x16x32_bf16 v[204:207],v[68:71],a[192:195],v[204:207]
s_waitcnt lgkmcnt(2)
v_mfma_f32_16x16x32_bf16 v[192:195],a[68:71],v[72:75],v[192:195]
ds_read_b128 v[68:71],v20 offset:37888
v_mfma_f32_16x16x32_bf16 v[200:203],v[72:75],a[196:199],v[200:203]
s_waitcnt lgkmcnt(2)
v_mfma_f32_16x16x32_bf16 v[196:199],a[68:71],v[76:79],v[196:199]
ds_read_b128 v[72:75],v20 offset:38912
v_mfma_f32_16x16x32_bf16 v[204:207],v[76:79],a[196:199],v[204:207]
s_waitcnt lgkmcnt(2)
v_mfma_f32_16x16x32_bf16 v[192:195],a[72:75],v[64:67],v[192:195]
ds_read_b128 v[76:79],v20 offset:39936
v_mfma_f32_16x16x32_bf16 v[200:203],v[64:67],a[200:203],v[200:203]
s_waitcnt lgkmcnt(2)
v_mfma_f32_16x16x32_bf16 v[196:199],a[72:75],v[68:71],v[196:199]
ds_read_b128 v[64:67],v20 offset:40960
v_mfma_f32_16x16x32_bf16 v[204:207],v[68:71],a[200:203],v[204:207]
s_waitcnt lgkmcnt(2)
v_mfma_f32_16x16x32_bf16 v[192:195],a[76:79],v[72:75],v[192:195]
ds_read_b128 v[68:71],v20 offset:41984
v_mfma_f32_16x16x32_bf16 v[200:203],v[72:75],a[204:207],v[200:203]
s_waitcnt lgkmcnt(2)
v_mfma_f32_16x16x32_bf16 v[196:199],a[76:79],v[76:79],v[196:199]
ds_read_b128 v[72:75],v20 offset:43008
v_mfma_f32_16x16x32_bf16 v[204:207],v[76:79],a[204:207],v[204:207]
s_waitcnt lgkmcnt(2)
v_mfma_f32_16x16x32_bf16 v[192:195],a[80:83],v[64:67],v[192:195]
ds_read_b128 v[76:79],v20 offset:44032
v_mfma_f32_16x16x32_bf16 v[200:203],v[64:67],a[208:211],v[200:203]
s_waitcnt lgkmcnt(2)
v_mfma_f32_16x16x32_bf16 v[196:199],a[80:83],v[68:71],v[196:199]
ds_read_b128 v[64:67],v20 offset:45056
v_mfma_f32_16x16x32_bf16 v[204:207],v[68:71],a[208:211],v[204:207]
s_waitcnt lgkmcnt(2)
v_mfma_f32_16x16x32_bf16 v[192:195],a[84:87],v[72:75],v[192:195]
ds_read_b128 v[68:71],v20 offset:46080
v_mfma_f32_16x16x32_bf16 v[200:203],v[72:75],a[212:215],v[200:203]
s_waitcnt lgkmcnt(2)
v_mfma_f32_16x16x32_bf16 v[196:199],a[84:87],v[76:79],v[196:199]
ds_read_b128 v[72:75],v20 offset:47104
v_mfma_f32_16x16x32_bf16 v[204:207],v[76:79],a[212:215],v[204:207]
s_waitcnt lgkmcnt(2)
v_mfma_f32_16x16x32_bf16 v[192:195],a[88:91],v[64:67],v[192:195]
ds_read_b128 v[76:79],v20 offset:48128
v_mfma_f32_16x16x32_bf16 v[200:203],v[64:67],a[216:219],v[200:203]
s_waitcnt lgkmcnt(2)
v_mfma_f32_16x16x32_bf16 v[196:199],a[88:91],v[68:71],v[196:199]
ds_read_b128 v[64:67],v20 offset:49152
v_mfma_f32_16x16x32_bf16 v[204:207],v[68:71],a[216:219],v[204:207]
s_waitcnt lgkmcnt(2)
v_mfma_f32_16x16x32_bf16 v[192:195],a[92:95],v[72:75],v[192:195]
ds_read_b128 v[68:71],v20 offset:50176
v_mfma_f32_16x16x32_bf16 v[200:203],v[72:75],a[220:223],v[200:203]
s_waitcnt lgkmcnt(2)
v_mfma_f32_16x16x32_bf16 v[196:199],a[92:95],v[76:79],v[196:199]
ds_read_b128 v[72:75],v20 offset:51200
v_mfma_f32_16x16x32_bf16 v[204:207],v[76:79],a[220:223],v[204:207]
s_waitcnt lgkmcnt(2)
v_mfma_f32_16x16x32_bf16 v[192:195],a[96:99],v[64:67],v[192:195]
ds_read_b128 v[76:79],v20 offset:52224
v_mfma_f32_16x16x32_bf16 v[200:203],v[64:67],a[224:227],v[200:203]
s_waitcnt lgkmcnt(2)
v_mfma_f32_16x16x32_bf16 v[196:199],a[96:99],v[68:71],v[196:199]
ds_read_b128 v[64:67],v20 offset:53248
v_mfma_f32_16x16x32_bf16 v[204:207],v[68:71],a[224:227],v[204:207]
s_waitcnt lgkmcnt(2)
v_mfma_f32_16x16x32_bf16 v[192:195],a[100:103],v[72:75],v[192:195]
ds_read_b128 v[68:71],v20 offset:54272
s_add_u32 m0,s62,32768
s_add_u32 s69,s78,32768
v_mfma_f32_16x16x32_bf16 v[200:203],v[72:75],a[228:231],v[200:203]
s_waitcnt lgkmcnt(2)
v_mfma_f32_16x16x32_bf16 v[196:199],a[100:103],v[76:79],v[196:199]
ds_read_b128 v[72:75],v20 offset:55296
buffer_load_dwordx4 v16,s[20:23],s69 offen offset:0 lds
v_mfma_f32_16x16x32_bf16 v[204:207],v[76:79],a[228:231],v[204:207]
s_waitcnt lgkmcnt(2)
v_mfma_f32_16x16x32_bf16 v[192:195],a[104:107],v[64:67],v[192:195]
ds_read_b128 v[76:79],v20 offset:56320
buffer_load_dwordx4 v16,s[20:23],s69 offen offset:1024 lds
v_mfma_f32_16x16x32_bf16 v[200:203],v[64:67],a[232:235],v[200:203]
s_waitcnt lgkmcnt(2)
v_mfma_f32_16x16x32_bf16 v[196:199],a[104:107],v[68:71],v[196:199]
ds_read_b128 v[64:67],v20 offset:57344
buffer_load_dwordx4 v16,s[20:23],s69 offen offset:2048 lds
v_mfma_f32_16x16x32_bf16 v[204:207],v[68:71],a[232:235],v[204:207]
s_waitcnt lgkmcnt(2)
v_mfma_f32_16x16x32_bf16 v[192:195],a[108:111],v[72:75],v[192:195]
ds_read_b128 v[68:71],v20 offset:58368
buffer_load_dwordx4 v16,s[20:23],s69 offen offset:3072 lds
v_mfma_f32_16x16x32_bf16 v[200:203],v[72:75],a[236:239],v[200:203]
s_waitcnt lgkmcnt(2)
v_mfma_f32_16x16x32_bf16 v[196:199],a[108:111],v[76:79],v[196:199]
ds_read_b128 v[72:75],v20 offset:59392
s_add_u32 m0,s62,36864
s_add_u32 s69,s78,36864
v_mfma_f32_16x16x32_bf16 v[204:207],v[76:79],a[236:239],v[204:207]
s_waitcnt lgkmcnt(2)
v_mfma_f32_16x16x32_bf16 v[192:195],a[112:115],v[64:67],v[192:195]
ds_read_b128 v[76:79],v20 offset:60416
buffer_load_dwordx4 v16,s[20:23],s69 offen offset:0 lds
v_mfma_f32_16x16x32_bf16 v[200:203],v[64:67],a[240:243],v[200:203]
s_waitcnt lgkmcnt(2)
v_mfma_f32_16x16x32_bf16 v[196:199],a[112:115],v[68:71],v[196:199]
ds_read_b128 v[64:67],v20 offset:61440
v_mfma_f32_16x16x32_bf16 v[204:207],v[68:71],a[240:243],v[204:207]
buffer_load_dwordx4 v16,s[20:23],s69 offen offset:1024 lds
s_waitcnt lgkmcnt(2)
v_mfma_f32_16x16x32_bf16 v[192:195],a[116:119],v[72:75],v[192:195]
ds_read_b128 v[68:71],v20 offset:62464
v_mfma_f32_16x16x32_bf16 v[200:203],v[72:75],a[244:247],v[200:203]
buffer_load_dwordx4 v16,s[20:23],s69 offen offset:2048 lds
s_waitcnt lgkmcnt(2)
v_mfma_f32_16x16x32_bf16 v[196:199],a[116:119],v[76:79],v[196:199]
ds_read_b128 v[72:75],v20 offset:63488
v_mfma_f32_16x16x32_bf16 v[204:207],v[76:79],a[244:247],v[204:207]
buffer_load_dwordx4 v16,s[20:23],s69 offen offset:3072 lds
s_waitcnt lgkmcnt(2)
v_mfma_f32_16x16x32_bf16 v[192:195],a[120:123],v[64:67],v[192:195]
ds_read_b128 v[76:79],v20 offset:64512
v_mfma_f32_16x16x32_bf16 v[200:203],v[64:67],a[248:251],v[200:203]
s_add_u32 m0,s62,40960
s_add_u32 s69,s78,40960
s_waitcnt lgkmcnt(2)
v_mfma_f32_16x16x32_bf16 v[196:199],a[120:123],v[68:71],v[196:199]
v_mfma_f32_16x16x32_bf16 v[204:207],v[68:71],a[248:251],v[204:207]
buffer_load_dwordx4 v16,s[20:23],s69 offen offset:0 lds
s_waitcnt lgkmcnt(1)
v_mfma_f32_16x16x32_bf16 v[192:195],a[124:127],v[72:75],v[192:195]
v_mfma_f32_16x16x32_bf16 v[200:203],v[72:75],a[252:255],v[200:203]
buffer_load_dwordx4 v16,s[20:23],s69 offen offset:1024 lds
s_waitcnt lgkmcnt(0)
v_mfma_f32_16x16x32_bf16 v[196:199],a[124:127],v[76:79],v[196:199]
v_mfma_f32_16x16x32_bf16 v[204:207],v[76:79],a[252:255],v[204:207]
s_waitcnt vmcnt(26)
ds_write_b32 v21,v25 offset:24
v_xor_b32 v20,0x10000,v20
s_xor_b32 s62,s62,0x10000
s_lshr_b32 s64,s73,9
v_add_u32 v22,s64,v24
v_cvt_pk_bf16_f32 v208,v192,v193
v_cvt_pk_bf16_f32 v209,v194,v195
v_cvt_pk_bf16_f32 v210,v196,v197
v_cvt_pk_bf16_f32 v211,v198,v199
v_cvt_pk_bf16_f32 v212,v200,v201
v_cvt_pk_bf16_f32 v213,v202,v203
v_cvt_pk_bf16_f32 v214,v204,v205
v_cvt_pk_bf16_f32 v215,v206,v207
v_permlane16_swap_b32 v208,v210
v_permlane16_swap_b32 v209,v211
buffer_store_dwordx4 v[208:211],v2,s[24:27],s73 offen
buffer_store_dwordx4 v[208:211],v2,s[28:31],s73 offen sc1
ds_write_b128 v22,v[212:215] offset:16384
buffer_store_dwordx4 v[208:211],v17,s[20:23],s12 offen sc1
bgx_119:
buffer_store_dwordx4 v[100:103],v9,s[24:27],s73 offen
buffer_store_dwordx4 v[100:103],v9,s[28:31],s73 offen sc1
s_mov_b32 exec_hi,0
buffer_store_dwordx4 v[100:103],v8,s[24:27],s73 offen
buffer_store_dwordx4 v[100:103],v8,s[24:27],s71 offen
buffer_store_dwordx4 v[100:103],v8,s[28:31],s73 offen sc1
buffer_store_dwordx4 v[100:103],v8,s[28:31],s71 offen sc1
s_mov_b64 exec,-1
s_waitcnt lgkmcnt(0)
s_add_u32 s63,s79,1
s_and_b32 s64,s63,3
s_lshl_b32 s70,s64,20
s_add_u32 s65,s63,2
s_and_b32 s65,s65,3
s_lshl_b32 s73,s65,20
s_add_u32 s55,s63,3
s_lshl_b32 s78,s55,16
s_add_u32 s78,s78,57344
s_cmp_lt_u32 s55,64
s_cselect_b32 s78,s78,0x7fff0000
s_add_u32 s60,s63,1
s_lshl_b32 s76,s60,21
s_lshl_b32 s55,s60,13
s_and_b32 s55,s55,0x2000
s_xor_b32 s55,s55,s61
s_add_u32 s76,s76,s55
s_cmp_lt_u32 s60,64
s_cselect_b32 s76,s76,0x7fff0000
s_add_u32 s60,s63,2
s_lshl_b32 s12,s60,21
s_lshl_b32 s55,s60,13
s_and_b32 s55,s55,0x2000
s_xor_b32 s55,s55,s61
s_add_u32 s12,s12,s55
s_cmp_lt_u32 s60,64
s_cselect_b32 s12,s12,0x7fff0000
s_add_u32 s71,s73,65536
v_mov_b32 v176,0
v_mov_b32 v177,0
v_mov_b32 v178,0
v_mov_b32 v179,0
v_mov_b32 v180,0
v_mov_b32 v181,0
v_mov_b32 v182,0
v_mov_b32 v183,0
s_add_u32 s79,s79,1
v_add_u32 v25,1,v25
s_waitcnt vmcnt(0)
s_branch loop_113
art_117:
s_sub_u32 s90,s90,1
s_cmp_lt_i32 s90,0
s_cbranch_scc1 abk_118
buffer_load_dwordx4 v[48:51],v27,s[20:23],s70 offen offset:0 sc1
buffer_load_dwordx4 v[52:55],v27,s[20:23],s70 offen offset:1024 sc1
buffer_load_dwordx4 v[56:59],v27,s[20:23],s70 offen offset:2048 sc1
buffer_load_dwordx4 v[60:63],v27,s[20:23],s70 offen offset:3072 sc1
s_waitcnt vmcnt(3)
ds_write_b128 v24,v[48:51] offset:4096
v_min3_u32 v22,v48,v49,v50
v_min_u32 v22,v22,v51
s_waitcnt vmcnt(2)
ds_write_b128 v24,v[52:55] offset:5120
v_min3_u32 v22,v22,v52,v53
v_min3_u32 v22,v22,v54,v55
s_waitcnt vmcnt(1)
ds_write_b128 v24,v[56:59] offset:6144
v_min3_u32 v22,v22,v56,v57
v_min3_u32 v22,v22,v58,v59
s_waitcnt vmcnt(0)
ds_write_b128 v24,v[60:63] offset:7168
v_min3_u32 v22,v22,v60,v61
v_min3_u32 v22,v22,v62,v63
v_cmp_eq_u32 vcc,0,v22
s_cbranch_vccnz art_117
s_branch abk_118
bgsk_120:
s_waitcnt vmcnt(0)
ds_write_b32 v21,v25 offset:24
s_branch bgx_119
first_112:
s_add_u32 s63,s79,0
s_and_b32 s64,s63,3
s_lshl_b32 s70,s64,20
s_add_u32 s65,s63,2
s_and_b32 s65,s65,3
s_lshl_b32 s73,s65,20
s_add_u32 s55,s63,3
s_lshl_b32 s78,s55,16
s_add_u32 s78,s78,57344
s_cmp_lt_u32 s55,64
s_cselect_b32 s78,s78,0x7fff0000
s_add_u32 s60,s63,1
s_lshl_b32 s76,s60,21
s_lshl_b32 s55,s60,13
s_and_b32 s55,s55,0x2000
s_xor_b32 s55,s55,s61
s_add_u32 s76,s76,s55
s_cmp_lt_u32 s60,64
s_cselect_b32 s76,s76,0x7fff0000
s_add_u32 s60,s63,2
s_lshl_b32 s12,s60,21
s_lshl_b32 s55,s60,13
s_and_b32 s55,s55,0x2000
s_xor_b32 s55,s55,s61
s_add_u32 s12,s12,s55
s_cmp_lt_u32 s60,64
s_cselect_b32 s12,s12,0x7fff0000
s_add_u32 s71,s73,65536
v_mov_b32 v176,0
v_mov_b32 v177,0
v_mov_b32 v178,0
v_mov_b32 v179,0
v_mov_b32 v180,0
v_mov_b32 v181,0
v_mov_b32 v182,0
v_mov_b32 v183,0
s_waitcnt vmcnt(0) lgkmcnt(0)
pn1_121:
s_barrier
ds_read_b128 v[64:67],v20 offset:0
ds_read_b128 v[68:71],v20 offset:1024
ds_read_b128 v[72:75],v20 offset:2048
s_waitcnt lgkmcnt(2)
v_mfma_f32_16x16x32_bf16 v[192:195],a[0:3],v[64:67],0
ds_read_b128 v[76:79],v20 offset:3072
v_mfma_f32_16x16x32_bf16 v[200:203],v[64:67],a[128:131],0
s_waitcnt lgkmcnt(2)
v_mfma_f32_16x16x32_bf16 v[196:199],a[0:3],v[68:71],0
ds_read_b128 v[64:67],v20 offset:4096
v_mfma_f32_16x16x32_bf16 v[204:207],v[68:71],a[128:131],0
s_waitcnt lgkmcnt(2)
v_mfma_f32_16x16x32_bf16 v[192:195],a[4:7],v[72:75],v[192:195]
ds_read_b128 v[68:71],v20 offset:5120
v_mfma_f32_16x16x32_bf16 v[200:203],v[72:75],a[132:135],v[200:203]
s_waitcnt lgkmcnt(2)
v_mfma_f32_16x16x32_bf16 v[196:199],a[4:7],v[76:79],v[196:199]
ds_read_b128 v[72:75],v20 offset:6144
v_mfma_f32_16x16x32_bf16 v[204:207],v[76:79],a[132:135],v[204:207]
s_waitcnt lgkmcnt(2)
v_mfma_f32_16x16x32_bf16 v[192:195],a[8:11],v[64:67],v[192:195]
ds_read_b128 v[76:79],v20 offset:7168
v_mfma_f32_16x16x32_bf16 v[200:203],v[64:67],a[136:139],v[200:203]
s_waitcnt lgkmcnt(2)
v_mfma_f32_16x16x32_bf16 v[196:199],a[8:11],v[68:71],v[196:199]
ds_read_b128 v[64:67],v20 offset:8192
v_mfma_f32_16x16x32_bf16 v[204:207],v[68:71],a[136:139],v[204:207]
s_waitcnt lgkmcnt(2)
v_mfma_f32_16x16x32_bf16 v[192:195],a[12:15],v[72:75],v[192:195]
ds_read_b128 v[68:71],v20 offset:9216
v_mfma_f32_16x16x32_bf16 v[200:203],v[72:75],a[140:143],v[200:203]
s_waitcnt lgkmcnt(2)
v_mfma_f32_16x16x32_bf16 v[196:199],a[12:15],v[76:79],v[196:199]
ds_read_b128 v[72:75],v20 offset:10240
v_mfma_f32_16x16x32_bf16 v[204:207],v[76:79],a[140:143],v[204:207]
s_waitcnt lgkmcnt(2)
v_mfma_f32_16x16x32_bf16 v[192:195],a[16:19],v[64:67],v[192:195]
ds_read_b128 v[76:79],v20 offset:11264
v_mfma_f32_16x16x32_bf16 v[200:203],v[64:67],a[144:147],v[200:203]
s_waitcnt lgkmcnt(2)
v_mfma_f32_16x16x32_bf16 v[196:199],a[16:19],v[68:71],v[196:199]
ds_read_b128 v[64:67],v20 offset:12288
v_mfma_f32_16x16x32_bf16 v[204:207],v[68:71],a[144:147],v[204:207]
s_waitcnt lgkmcnt(2)
v_mfma_f32_16x16x32_bf16 v[192:195],a[20:23],v[72:75],v[192:195]
ds_read_b128 v[68:71],v20 offset:13312
v_mfma_f32_16x16x32_bf16 v[200:203],v[72:75],a[148:151],v[200:203]
s_waitcnt lgkmcnt(2)
v_mfma_f32_16x16x32_bf16 v[196:199],a[20:23],v[76:79],v[196:199]
ds_read_b128 v[72:75],v20 offset:14336
v_mfma_f32_16x16x32_bf16 v[204:207],v[76:79],a[148:151],v[204:207]
s_waitcnt lgkmcnt(2)
v_mfma_f32_16x16x32_bf16 v[192:195],a[24:27],v[64:67],v[192:195]
ds_read_b128 v[76:79],v20 offset:15360
v_mfma_f32_16x16x32_bf16 v[200:203],v[64:67],a[152:155],v[200:203]
s_waitcnt lgkmcnt(2)
v_mfma_f32_16x16x32_bf16 v[196:199],a[24:27],v[68:71],v[196:199]
ds_read_b128 v[64:67],v20 offset:16384
v_mfma_f32_16x16x32_bf16 v[204:207],v[68:71],a[152:155],v[204:207]
s_waitcnt lgkmcnt(2)
v_mfma_f32_16x16x32_bf16 v[192:195],a[28:31],v[72:75],v[192:195]
ds_read_b128 v[68:71],v20 offset:17408
v_mfma_f32_16x16x32_bf16 v[200:203],v[72:75],a[156:159],v[200:203]
s_waitcnt lgkmcnt(2)
v_mfma_f32_16x16x32_bf16 v[196:199],a[28:31],v[76:79],v[196:199]
ds_read_b128 v[72:75],v20 offset:18432
v_mfma_f32_16x16x32_bf16 v[204:207],v[76:79],a[156:159],v[204:207]
s_waitcnt lgkmcnt(2)
v_mfma_f32_16x16x32_bf16 v[192:195],a[32:35],v[64:67],v[192:195]
ds_read_b128 v[76:79],v20 offset:19456
v_mfma_f32_16x16x32_bf16 v[200:203],v[64:67],a[160:163],v[200:203]
s_waitcnt lgkmcnt(2)
v_mfma_f32_16x16x32_bf16 v[196:199],a[32:35],v[68:71],v[196:199]
ds_read_b128 v[64:67],v20 offset:20480
v_mfma_f32_16x16x32_bf16 v[204:207],v[68:71],a[160:163],v[204:207]
s_waitcnt lgkmcnt(2)
v_mfma_f32_16x16x32_bf16 v[192:195],a[36:39],v[72:75],v[192:195]
ds_read_b128 v[68:71],v20 offset:21504
v_mfma_f32_16x16x32_bf16 v[200:203],v[72:75],a[164:167],v[200:203]
s_waitcnt lgkmcnt(2)
v_mfma_f32_16x16x32_bf16 v[196:199],a[36:39],v[76:79],v[196:199]
ds_read_b128 v[72:75],v20 offset:22528
v_mfma_f32_16x16x32_bf16 v[204:207],v[76:79],a[164:167],v[204:207]
s_waitcnt lgkmcnt(2)
v_mfma_f32_16x16x32_bf16 v[192:195],a[40:43],v[64:67],v[192:195]
ds_read_b128 v[76:79],v20 offset:23552
v_mfma_f32_16x16x32_bf16 v[200:203],v[64:67],a[168:171],v[200:203]
s_waitcnt lgkmcnt(2)
v_mfma_f32_16x16x32_bf16 v[196:199],a[40:43],v[68:71],v[196:199]
ds_read_b128 v[64:67],v20 offset:24576
v_mfma_f32_16x16x32_bf16 v[204:207],v[68:71],a[168:171],v[204:207]
s_waitcnt lgkmcnt(2)
v_mfma_f32_16x16x32_bf16 v[192:195],a[44:47],v[72:75],v[192:195]
ds_read_b128 v[68:71],v20 offset:25600
v_mfma_f32_16x16x32_bf16 v[200:203],v[72:75],a[172:175],v[200:203]
s_waitcnt lgkmcnt(2)
v_mfma_f32_16x16x32_bf16 v[196:199],a[44:47],v[76:79],v[196:199]
ds_read_b128 v[72:75],v20 offset:26624
v_mfma_f32_16x16x32_bf16 v[204:207],v[76:79],a[172:175],v[204:207]
s_waitcnt lgkmcnt(2)
v_mfma_f32_16x16x32_bf16 v[192:195],a[48:51],v[64:67],v[192:195]
ds_read_b128 v[76:79],v20 offset:27648
v_mfma_f32_16x16x32_bf16 v[200:203],v[64:67],a[176:179],v[200:203]
s_waitcnt lgkmcnt(2)
v_mfma_f32_16x16x32_bf16 v[196:199],a[48:51],v[68:71],v[196:199]
ds_read_b128 v[64:67],v20 offset:28672
v_mfma_f32_16x16x32_bf16 v[204:207],v[68:71],a[176:179],v[204:207]
s_waitcnt lgkmcnt(2)
v_mfma_f32_16x16x32_bf16 v[192:195],a[52:55],v[72:75],v[192:195]
ds_read_b128 v[68:71],v20 offset:29696
v_mfma_f32_16x16x32_bf16 v[200:203],v[72:75],a[180:183],v[200:203]
s_waitcnt lgkmcnt(2)
v_mfma_f32_16x16x32_bf16 v[196:199],a[52:55],v[76:79],v[196:199]
ds_read_b128 v[72:75],v20 offset:30720
v_mfma_f32_16x16x32_bf16 v[204:207],v[76:79],a[180:183],v[204:207]
s_waitcnt lgkmcnt(2)
v_mfma_f32_16x16x32_bf16 v[192:195],a[56:59],v[64:67],v[192:195]
ds_read_b128 v[76:79],v20 offset:31744
v_mfma_f32_16x16x32_bf16 v[200:203],v[64:67],a[184:187],v[200:203]
s_waitcnt lgkmcnt(2)
v_mfma_f32_16x16x32_bf16 v[196:199],a[56:59],v[68:71],v[196:199]
ds_read_b128 v[64:67],v20 offset:32768
v_mfma_f32_16x16x32_bf16 v[204:207],v[68:71],a[184:187],v[204:207]
s_waitcnt lgkmcnt(2)
v_mfma_f32_16x16x32_bf16 v[192:195],a[60:63],v[72:75],v[192:195]
ds_read_b128 v[68:71],v20 offset:33792
v_mfma_f32_16x16x32_bf16 v[200:203],v[72:75],a[188:191],v[200:203]
s_waitcnt lgkmcnt(2)
v_mfma_f32_16x16x32_bf16 v[196:199],a[60:63],v[76:79],v[196:199]
ds_read_b128 v[72:75],v20 offset:34816
v_mfma_f32_16x16x32_bf16 v[204:207],v[76:79],a[188:191],v[204:207]
s_waitcnt lgkmcnt(2)
v_mfma_f32_16x16x32_bf16 v[192:195],a[64:67],v[64:67],v[192:195]
ds_read_b128 v[76:79],v20 offset:35840
v_mfma_f32_16x16x32_bf16 v[200:203],v[64:67],a[192:195],v[200:203]
s_waitcnt lgkmcnt(2)
v_mfma_f32_16x16x32_bf16 v[196:199],a[64:67],v[68:71],v[196:199]
ds_read_b128 v[64:67],v20 offset:36864
v_mfma_f32_16x16x32_bf16 v[204:207],v[68:71],a[192:195],v[204:207]
s_waitcnt lgkmcnt(2)
v_mfma_f32_16x16x32_bf16 v[192:195],a[68:71],v[72:75],v[192:195]
ds_read_b128 v[68:71],v20 offset:37888
v_mfma_f32_16x16x32_bf16 v[200:203],v[72:75],a[196:199],v[200:203]
s_waitcnt lgkmcnt(2)
v_mfma_f32_16x16x32_bf16 v[196:199],a[68:71],v[76:79],v[196:199]
ds_read_b128 v[72:75],v20 offset:38912
v_mfma_f32_16x16x32_bf16 v[204:207],v[76:79],a[196:199],v[204:207]
s_waitcnt lgkmcnt(2)
v_mfma_f32_16x16x32_bf16 v[192:195],a[72:75],v[64:67],v[192:195]
ds_read_b128 v[76:79],v20 offset:39936
v_mfma_f32_16x16x32_bf16 v[200:203],v[64:67],a[200:203],v[200:203]
s_waitcnt lgkmcnt(2)
v_mfma_f32_16x16x32_bf16 v[196:199],a[72:75],v[68:71],v[196:199]
ds_read_b128 v[64:67],v20 offset:40960
v_mfma_f32_16x16x32_bf16 v[204:207],v[68:71],a[200:203],v[204:207]
s_waitcnt lgkmcnt(2)
v_mfma_f32_16x16x32_bf16 v[192:195],a[76:79],v[72:75],v[192:195]
ds_read_b128 v[68:71],v20 offset:41984
v_mfma_f32_16x16x32_bf16 v[200:203],v[72:75],a[204:207],v[200:203]
s_waitcnt lgkmcnt(2)
v_mfma_f32_16x16x32_bf16 v[196:199],a[76:79],v[76:79],v[196:199]
ds_read_b128 v[72:75],v20 offset:43008
v_mfma_f32_16x16x32_bf16 v[204:207],v[76:79],a[204:207],v[204:207]
s_waitcnt lgkmcnt(2)
v_mfma_f32_16x16x32_bf16 v[192:195],a[80:83],v[64:67],v[192:195]
ds_read_b128 v[76:79],v20 offset:44032
v_mfma_f32_16x16x32_bf16 v[200:203],v[64:67],a[208:211],v[200:203]
s_waitcnt lgkmcnt(2)
v_mfma_f32_16x16x32_bf16 v[196:199],a[80:83],v[68:71],v[196:199]
ds_read_b128 v[64:67],v20 offset:45056
v_mfma_f32_16x16x32_bf16 v[204:207],v[68:71],a[208:211],v[204:207]
s_waitcnt lgkmcnt(2)
v_mfma_f32_16x16x32_bf16 v[192:195],a[84:87],v[72:75],v[192:195]
ds_read_b128 v[68:71],v20 offset:46080
v_mfma_f32_16x16x32_bf16 v[200:203],v[72:75],a[212:215],v[200:203]
s_waitcnt lgkmcnt(2)
v_mfma_f32_16x16x32_bf16 v[196:199],a[84:87],v[76:79],v[196:199]
ds_read_b128 v[72:75],v20 offset:47104
v_mfma_f32_16x16x32_bf16 v[204:207],v[76:79],a[212:215],v[204:207]
s_waitcnt lgkmcnt(2)
v_mfma_f32_16x16x32_bf16 v[192:195],a[88:91],v[64:67],v[192:195]
ds_read_b128 v[76:79],v20 offset:48128
v_mfma_f32_16x16x32_bf16 v[200:203],v[64:67],a[216:219],v[200:203]
s_waitcnt lgkmcnt(2)
v_mfma_f32_16x16x32_bf16 v[196:199],a[88:91],v[68:71],v[196:199]
ds_read_b128 v[64:67],v20 offset:49152
v_mfma_f32_16x16x32_bf16 v[204:207],v[68:71],a[216:219],v[204:207]
s_waitcnt lgkmcnt(2)
v_mfma_f32_16x16x32_bf16 v[192:195],a[92:95],v[72:75],v[192:195]
ds_read_b128 v[68:71],v20 offset:50176
v_mfma_f32_16x16x32_bf16 v[200:203],v[72:75],a[220:223],v[200:203]
s_waitcnt lgkmcnt(2)
v_mfma_f32_16x16x32_bf16 v[196:199],a[92:95],v[76:79],v[196:199]
ds_read_b128 v[72:75],v20 offset:51200
v_mfma_f32_16x16x32_bf16 v[204:207],v[76:79],a[220:223],v[204:207]
s_waitcnt lgkmcnt(2)
v_mfma_f32_16x16x32_bf16 v[192:195],a[96:99],v[64:67],v[192:195]
ds_read_b128 v[76:79],v20 offset:52224
v_mfma_f32_16x16x32_bf16 v[200:203],v[64:67],a[224:227],v[200:203]
s_waitcnt lgkmcnt(2)
v_mfma_f32_16x16x32_bf16 v[196:199],a[96:99],v[68:71],v[196:199]
ds_read_b128 v[64:67],v20 offset:53248
v_mfma_f32_16x16x32_bf16 v[204:207],v[68:71],a[224:227],v[204:207]
s_waitcnt lgkmcnt(2)
v_mfma_f32_16x16x32_bf16 v[192:195],a[100:103],v[72:75],v[192:195]
ds_read_b128 v[68:71],v20 offset:54272
v_mfma_f32_16x16x32_bf16 v[200:203],v[72:75],a[228:231],v[200:203]
s_waitcnt lgkmcnt(2)
v_mfma_f32_16x16x32_bf16 v[196:199],a[100:103],v[76:79],v[196:199]
ds_read_b128 v[72:75],v20 offset:55296
v_mfma_f32_16x16x32_bf16 v[204:207],v[76:79],a[228:231],v[204:207]
s_waitcnt lgkmcnt(2)
v_mfma_f32_16x16x32_bf16 v[192:195],a[104:107],v[64:67],v[192:195]
ds_read_b128 v[76:79],v20 offset:56320
v_mfma_f32_16x16x32_bf16 v[200:203],v[64:67],a[232:235],v[200:203]
s_waitcnt lgkmcnt(2)
v_mfma_f32_16x16x32_bf16 v[196:199],a[104:107],v[68:71],v[196:199]
ds_read_b128 v[64:67],v20 offset:57344
v_mfma_f32_16x16x32_bf16 v[204:207],v[68:71],a[232:235],v[204:207]
s_waitcnt lgkmcnt(2)
v_mfma_f32_16x16x32_bf16 v[192:195],a[108:111],v[72:75],v[192:195]
ds_read_b128 v[68:71],v20 offset:58368
v_mfma_f32_16x16x32_bf16 v[200:203],v[72:75],a[236:239],v[200:203]
s_waitcnt lgkmcnt(2)
v_mfma_f32_16x16x32_bf16 v[196:199],a[108:111],v[76:79],v[196:199]
ds_read_b128 v[72:75],v20 offset:59392
v_mfma_f32_16x16x32_bf16 v[204:207],v[76:79],a[236:239],v[204:207]
s_waitcnt lgkmcnt(2)
v_mfma_f32_16x16x32_bf16 v[192:195],a[112:115],v[64:67],v[192:195]
ds_read_b128 v[76:79],v20 offset:60416
v_mfma_f32_16x16x32_bf16 v[200:203],v[64:67],a[240:243],v[200:203]
s_waitcnt lgkmcnt(2)
v_mfma_f32_16x16x32_bf16 v[196:199],a[112:115],v[68:71],v[196:199]
ds_read_b128 v[64:67],v20 offset:61440
v_mfma_f32_16x16x32_bf16 v[204:207],v[68:71],a[240:243],v[204:207]
s_waitcnt lgkmcnt(2)
v_mfma_f32_16x16x32_bf16 v[192:195],a[116:119],v[72:75],v[192:195]
ds_read_b128 v[68:71],v20 offset:62464
v_mfma_f32_16x16x32_bf16 v[200:203],v[72:75],a[244:247],v[200:203]
s_waitcnt lgkmcnt(2)
v_mfma_f32_16x16x32_bf16 v[196:199],a[116:119],v[76:79],v[196:199]
ds_read_b128 v[72:75],v20 offset:63488
v_mfma_f32_16x16x32_bf16 v[204:207],v[76:79],a[244:247],v[204:207]
s_waitcnt lgkmcnt(2)
v_mfma_f32_16x16x32_bf16 v[192:195],a[120:123],v[64:67],v[192:195]
ds_read_b128 v[76:79],v20 offset:64512
v_mfma_f32_16x16x32_bf16 v[200:203],v[64:67],a[248:251],v[200:203]
s_waitcnt lgkmcnt(2)
v_mfma_f32_16x16x32_bf16 v[196:199],a[120:123],v[68:71],v[196:199]
v_mfma_f32_16x16x32_bf16 v[204:207],v[68:71],a[248:251],v[204:207]
s_waitcnt lgkmcnt(1)
v_mfma_f32_16x16x32_bf16 v[192:195],a[124:127],v[72:75],v[192:195]
v_mfma_f32_16x16x32_bf16 v[200:203],v[72:75],a[252:255],v[200:203]
s_waitcnt lgkmcnt(0)
v_mfma_f32_16x16x32_bf16 v[196:199],a[124:127],v[76:79],v[196:199]
v_mfma_f32_16x16x32_bf16 v[204:207],v[76:79],a[252:255],v[204:207]
v_xor_b32 v20,0x10000,v20
s_xor_b32 s62,s62,0x10000
s_lshr_b32 s64,s73,9
v_add_u32 v22,s64,v24
v_cvt_pk_bf16_f32 v208,v192,v193
v_cvt_pk_bf16_f32 v209,v194,v195
s_nop 0
v_cvt_pk_bf16_f32 v210,v196,v197
v_cvt_pk_bf16_f32 v211,v198,v199
v_cvt_pk_bf16_f32 v212,v200,v201
v_cvt_pk_bf16_f32 v213,v202,v203
v_cvt_pk_bf16_f32 v214,v204,v205
v_cvt_pk_bf16_f32 v215,v206,v207
v_permlane16_swap_b32 v208,v210
v_permlane16_swap_b32 v209,v211
buffer_store_dwordx4 v[208:211],v2,s[24:27],s73 offen
buffer_store_dwordx4 v[208:211],v2,s[28:31],s73 offen sc1
ds_write_b128 v22,v[212:215] offset:16384
buffer_store_dwordx4 v[208:211],v17,s[20:23],s12 offen sc1
bgx_123:
s_add_u32 s63,s79,1
s_and_b32 s64,s63,3
s_lshl_b32 s70,s64,20
s_add_u32 s65,s63,2
s_and_b32 s65,s65,3
s_lshl_b32 s73,s65,20
s_add_u32 s55,s63,3
s_lshl_b32 s78,s55,16
s_add_u32 s78,s78,57344
s_cmp_lt_u32 s55,64
s_cselect_b32 s78,s78,0x7fff0000
s_add_u32 s60,s63,1
s_lshl_b32 s76,s60,21
s_lshl_b32 s55,s60,13
s_and_b32 s55,s55,0x2000
s_xor_b32 s55,s55,s61
s_add_u32 s76,s76,s55
s_cmp_lt_u32 s60,64
s_cselect_b32 s76,s76,0x7fff0000
s_add_u32 s60,s63,2
s_lshl_b32 s12,s60,21
s_lshl_b32 s55,s60,13
s_and_b32 s55,s55,0x2000
s_xor_b32 s55,s55,s61
s_add_u32 s12,s12,s55
s_cmp_lt_u32 s60,64
s_cselect_b32 s12,s12,0x7fff0000
s_add_u32 s71,s73,65536
v_mov_b32 v176,0
v_mov_b32 v177,0
v_mov_b32 v178,0
v_mov_b32 v179,0
v_mov_b32 v180,0
v_mov_b32 v181,0
v_mov_b32 v182,0
v_mov_b32 v183,0
s_add_u32 s79,s79,1
s_cmp_eq_u32 s79,0
s_cbranch_scc1 pn2_122
buffer_store_dwordx4 v[212:215],v12,s[20:23],s76 offen sc1
s_waitcnt lgkmcnt(0)
s_branch pn1_121
pn2_122:
v_mov_b32 v25,1
s_waitcnt vmcnt(1) lgkmcnt(0)
s_barrier
s_branch loop_113
w2_61:
s_lshr_b32 s64,s57,2
s_add_u32 s64,s64,64
s_lshl_b32 s64,s64,14
s_add_u32 s64,s64,s68
s_add_u32 s64,s64,29361152
v_add_u32 v12,s64,v16
v_and_b32 v22,1,v4
v_lshrrev_b32 v23,1,v4
v_lshl_add_u32 v22,v22,1,v23
v_lshlrev_b32 v22,2,v22
v_lshl_add_u32 v22,v3,4,v22
v_add_u32 v31,155904,v22
s_branch first_124
loop_125:
s_barrier
buffer_load_dword v248,v18,s[20:23],s70 offen offset:0 sc1
s_nop 15
s_nop 5
hl_127:
buffer_load_dword v249,v18,s[20:23],s70 offen offset:0 sc1
s_waitcnt vmcnt(1)
v_cmp_eq_u32 vcc,v25,v248
s_bcnt1_i32_b32 s64,vcc_lo
s_cmp_ge_u32 s64,8
s_cbranch_scc1 hg_128
buffer_load_dword v248,v18,s[20:23],s70 offen offset:0 sc1
s_waitcnt vmcnt(1)
v_cmp_eq_u32 vcc,v25,v249
s_bcnt1_i32_b32 s64,vcc_lo
s_cmp_ge_u32 s64,8
s_cbranch_scc1 hg_128
s_sub_u32 s90,s90,1
s_cmp_gt_i32 s90,0
s_cbranch_scc1 hl_127
hg_128:
buffer_load_dwordx4 v[64:67],v28,s[20:23],s70 offen offset:0 sc1
buffer_load_dwordx4 v[68:71],v28,s[20:23],s70 offen offset:1024 sc1
buffer_load_dwordx4 v[72:75],v28,s[20:23],s70 offen offset:2048 sc1
buffer_load_dwordx4 v[76:79],v28,s[20:23],s70 offen offset:3072 sc1
s_waitcnt vmcnt(3)
ds_write_b128 v24,v[64:67] offset:8192
v_min3_u32 v22,v64,v65,v66
v_min_u32 v22,v22,v67
s_waitcnt vmcnt(2)
ds_write_b128 v24,v[68:71] offset:9216
v_min3_u32 v22,v22,v68,v69
v_min3_u32 v22,v22,v70,v71
s_waitcnt vmcnt(1)
ds_write_b128 v24,v[72:75] offset:10240
v_min3_u32 v22,v22,v72,v73
v_min3_u32 v22,v22,v74,v75
s_waitcnt vmcnt(0)
ds_write_b128 v24,v[76:79] offset:11264
v_min3_u32 v22,v22,v76,v77
v_min3_u32 v22,v22,v78,v79
v_cmp_eq_u32 vcc,0,v22
s_cbranch_vccnz art_129
abk_130:
v_smfmac_f32_16x16x64_bf16 v[176:179],v[64:67],a[64:71],v14
s_waitcnt lgkmcnt(0)
s_barrier
ds_read_b128 v[80:83],v24 offset:12288
ds_read_b128 v[84:87],v24 offset:13312
ds_read_b128 v[88:91],v24 offset:14336
ds_read_b128 v[92:95],v24 offset:15360
buffer_store_dwordx4 v[212:215],v12,s[20:23],s76 offen sc1
v_smfmac_f32_16x16x64_bf16 v[176:179],v[68:71],a[72:79],v14
ds_read_b128 v[32:35],v24 offset:0
ds_read_b128 v[36:39],v24 offset:1024
v_smfmac_f32_16x16x64_bf16 v[176:179],v[72:75],a[80:87],v14
ds_read_b128 v[40:43],v24 offset:2048
ds_read_b128 v[44:47],v24 offset:3072
v_smfmac_f32_16x16x64_bf16 v[176:179],v[76:79],a[88:95],v14
ds_read_b128 v[48:51],v24 offset:4096
ds_read_b128 v[52:55],v24 offset:5120
s_waitcnt lgkmcnt(9)
v_smfmac_f32_16x16x64_bf16 v[176:179],v[80:83],a[96:103],v14
ds_read_b128 v[56:59],v24 offset:6144
s_waitcnt lgkmcnt(9)
v_smfmac_f32_16x16x64_bf16 v[176:179],v[84:87],a[104:111],v14
ds_read_b128 v[60:63],v24 offset:7168
s_waitcnt lgkmcnt(9)
v_smfmac_f32_16x16x64_bf16 v[176:179],v[88:91],a[112:119],v14
s_waitcnt lgkmcnt(8)
v_smfmac_f32_16x16x64_bf16 v[176:179],v[92:95],a[120:127],v14
s_waitcnt lgkmcnt(7)
v_smfmac_f32_16x16x64_bf16 v[176:179],v[32:35],a[0:7],v14
s_waitcnt lgkmcnt(6)
v_smfmac_f32_16x16x64_bf16 v[176:179],v[36:39],a[8:15],v14
s_waitcnt lgkmcnt(5)
v_smfmac_f32_16x16x64_bf16 v[176:179],v[40:43],a[16:23],v14
s_waitcnt lgkmcnt(4)
v_smfmac_f32_16x16x64_bf16 v[176:179],v[44:47],a[24:31],v14
s_waitcnt lgkmcnt(3)
v_smfmac_f32_16x16x64_bf16 v[176:179],v[48:51],a[32:39],v14
s_waitcnt lgkmcnt(2)
v_smfmac_f32_16x16x64_bf16 v[176:179],v[52:55],a[40:47],v14
s_waitcnt lgkmcnt(1)
v_smfmac_f32_16x16x64_bf16 v[176:179],v[56:59],a[48:55],v14
s_waitcnt lgkmcnt(0)
v_smfmac_f32_16x16x64_bf16 v[176:179],v[60:63],a[56:63],v14
v_smfmac_f32_16x16x64_bf16 v[180:183],v[32:35],a[128:135],v14
v_smfmac_f32_16x16x64_bf16 v[180:183],v[36:39],a[136:143],v14
s_nop 5
v_permlane32_swap_b32 v176,v178
v_permlane32_swap_b32 v177,v179
v_add_f32 v176,v176,v178
v_add_f32 v177,v177,v179
v_cvt_pk_bf16_f32 v216,v176,v177
s_nop 1
v_mov_b32_dpp v217,v216 quad_perm:[1,0,3,2] row_mask:0xf bank_mask:0xf
v_perm_b32 v216,v217,v216,v15
v_max_u32 v216,1,v216
buffer_store_dword v216,v19,s[24:27],s70 offen
buffer_store_dword v216,v19,s[28:31],s70 offen sc1
v_smfmac_f32_16x16x64_bf16 v[180:183],v[40:43],a[144:151],v14
v_smfmac_f32_16x16x64_bf16 v[180:183],v[44:47],a[152:159],v14
v_smfmac_f32_16x16x64_bf16 v[180:183],v[48:51],a[160:167],v14
v_smfmac_f32_16x16x64_bf16 v[180:183],v[52:55],a[168:175],v14
v_smfmac_f32_16x16x64_bf16 v[180:183],v[56:59],a[176:183],v14
v_smfmac_f32_16x16x64_bf16 v[180:183],v[60:63],a[184:191],v14
v_smfmac_f32_16x16x64_bf16 v[180:183],v[64:67],a[192:199],v14
v_smfmac_f32_16x16x64_bf16 v[180:183],v[68:71],a[200:207],v14
v_smfmac_f32_16x16x64_bf16 v[180:183],v[72:75],a[208:215],v14
v_smfmac_f32_16x16x64_bf16 v[180:183],v[76:79],a[216:223],v14
v_smfmac_f32_16x16x64_bf16 v[180:183],v[80:83],a[224:231],v14
v_smfmac_f32_16x16x64_bf16 v[180:183],v[84:87],a[232:239],v14
v_smfmac_f32_16x16x64_bf16 v[180:183],v[88:91],a[240:247],v14
v_smfmac_f32_16x16x64_bf16 v[180:183],v[92:95],a[248:255],v14
s_nop 7
v_permlane32_swap_b32 v180,v182
v_permlane32_swap_b32 v181,v183
v_add_f32 v180,v180,v182
v_add_f32 v181,v181,v183
v_cvt_pk_bf16_f32 v216,v180,v181
v_max_u32 v216,1,v216
ds_write_b32 v31,v216
ds_write_b32 v21,v25 offset:4
s_cmp_eq_u32 s79,63
s_cbranch_scc1 end_58
s_cmp_ge_i32 s79,62
s_cbranch_scc1 bgsk_132
ds_read_b128 v[64:67],v20 offset:0
ds_read_b128 v[68:71],v20 offset:1024
ds_read_b128 v[72:75],v20 offset:2048
s_waitcnt lgkmcnt(2)
v_mfma_f32_16x16x32_bf16 v[192:195],a[0:3],v[64:67],0
ds_read_b128 v[76:79],v20 offset:3072
v_mfma_f32_16x16x32_bf16 v[200:203],v[64:67],a[128:131],0
s_waitcnt lgkmcnt(2)
v_mfma_f32_16x16x32_bf16 v[196:199],a[0:3],v[68:71],0
ds_read_b128 v[64:67],v20 offset:4096
v_mfma_f32_16x16x32_bf16 v[204:207],v[68:71],a[128:131],0
s_waitcnt lgkmcnt(2)
v_mfma_f32_16x16x32_bf16 v[192:195],a[4:7],v[72:75],v[192:195]
ds_read_b128 v[68:71],v20 offset:5120
v_mfma_f32_16x16x32_bf16 v[200:203],v[72:75],a[132:135],v[200:203]
s_waitcnt lgkmcnt(2)
v_mfma_f32_16x16x32_bf16 v[196:199],a[4:7],v[76:79],v[196:199]
ds_read_b128 v[72:75],v20 offset:6144
v_mfma_f32_16x16x32_bf16 v[204:207],v[76:79],a[132:135],v[204:207]
s_waitcnt lgkmcnt(2)
v_mfma_f32_16x16x32_bf16 v[192:195],a[8:11],v[64:67],v[192:195]
ds_read_b128 v[76:79],v20 offset:7168
v_mfma_f32_16x16x32_bf16 v[200:203],v[64:67],a[136:139],v[200:203]
s_waitcnt lgkmcnt(2)
v_mfma_f32_16x16x32_bf16 v[196:199],a[8:11],v[68:71],v[196:199]
ds_read_b128 v[64:67],v20 offset:8192
v_mfma_f32_16x16x32_bf16 v[204:207],v[68:71],a[136:139],v[204:207]
s_waitcnt lgkmcnt(2)
v_mfma_f32_16x16x32_bf16 v[192:195],a[12:15],v[72:75],v[192:195]
ds_read_b128 v[68:71],v20 offset:9216
v_mfma_f32_16x16x32_bf16 v[200:203],v[72:75],a[140:143],v[200:203]
s_waitcnt lgkmcnt(2)
v_mfma_f32_16x16x32_bf16 v[196:199],a[12:15],v[76:79],v[196:199]
ds_read_b128 v[72:75],v20 offset:10240
v_mfma_f32_16x16x32_bf16 v[204:207],v[76:79],a[140:143],v[204:207]
s_add_u32 m0,s62,16384
s_add_u32 s69,s78,16384
s_waitcnt lgkmcnt(2)
v_mfma_f32_16x16x32_bf16 v[192:195],a[16:19],v[64:67],v[192:195]
ds_read_b128 v[76:79],v20 offset:11264
v_mfma_f32_16x16x32_bf16 v[200:203],v[64:67],a[144:147],v[200:203]
buffer_load_dwordx4 v16,s[20:23],s69 offen offset:0 lds
s_waitcnt lgkmcnt(2)
v_mfma_f32_16x16x32_bf16 v[196:199],a[16:19],v[68:71],v[196:199]
ds_read_b128 v[64:67],v20 offset:12288
v_mfma_f32_16x16x32_bf16 v[204:207],v[68:71],a[144:147],v[204:207]
buffer_load_dwordx4 v16,s[20:23],s69 offen offset:1024 lds
s_waitcnt lgkmcnt(2)
v_mfma_f32_16x16x32_bf16 v[192:195],a[20:23],v[72:75],v[192:195]
ds_read_b128 v[68:71],v20 offset:13312
v_mfma_f32_16x16x32_bf16 v[200:203],v[72:75],a[148:151],v[200:203]
buffer_load_dwordx4 v16,s[20:23],s69 offen offset:2048 lds
s_waitcnt lgkmcnt(2)
v_mfma_f32_16x16x32_bf16 v[196:199],a[20:23],v[76:79],v[196:199]
ds_read_b128 v[72:75],v20 offset:14336
v_mfma_f32_16x16x32_bf16 v[204:207],v[76:79],a[148:151],v[204:207]
buffer_load_dwordx4 v16,s[20:23],s69 offen offset:3072 lds
s_waitcnt lgkmcnt(2)
v_mfma_f32_16x16x32_bf16 v[192:195],a[24:27],v[64:67],v[192:195]
ds_read_b128 v[76:79],v20 offset:15360
v_mfma_f32_16x16x32_bf16 v[200:203],v[64:67],a[152:155],v[200:203]
s_add_u32 m0,s62,20480
s_add_u32 s69,s78,20480
s_waitcnt lgkmcnt(2)
v_mfma_f32_16x16x32_bf16 v[196:199],a[24:27],v[68:71],v[196:199]
ds_read_b128 v[64:67],v20 offset:16384
v_mfma_f32_16x16x32_bf16 v[204:207],v[68:71],a[152:155],v[204:207]
buffer_load_dwordx4 v16,s[20:23],s69 offen offset:0 lds
s_waitcnt lgkmcnt(2)
v_mfma_f32_16x16x32_bf16 v[192:195],a[28:31],v[72:75],v[192:195]
ds_read_b128 v[68:71],v20 offset:17408
v_mfma_f32_16x16x32_bf16 v[200:203],v[72:75],a[156:159],v[200:203]
buffer_load_dwordx4 v16,s[20:23],s69 offen offset:1024 lds
s_waitcnt lgkmcnt(2)
v_mfma_f32_16x16x32_bf16 v[196:199],a[28:31],v[76:79],v[196:199]
ds_read_b128 v[72:75],v20 offset:18432
v_mfma_f32_16x16x32_bf16 v[204:207],v[76:79],a[156:159],v[204:207]
buffer_load_dwordx4 v16,s[20:23],s69 offen offset:2048 lds
s_waitcnt lgkmcnt(2)
v_mfma_f32_16x16x32_bf16 v[192:195],a[32:35],v[64:67],v[192:195]
ds_read_b128 v[76:79],v20 offset:19456
v_mfma_f32_16x16x32_bf16 v[200:203],v[64:67],a[160:163],v[200:203]
buffer_load_dwordx4 v16,s[20:23],s69 offen offset:3072 lds
s_waitcnt lgkmcnt(2)
v_mfma_f32_16x16x32_bf16 v[196:199],a[32:35],v[68:71],v[196:199]
ds_read_b128 v[64:67],v20 offset:20480
v_mfma_f32_16x16x32_bf16 v[204:207],v[68:71],a[160:163],v[204:207]
s_add_u32 m0,s62,24576
s_add_u32 s69,s78,24576
s_waitcnt lgkmcnt(2)
v_mfma_f32_16x16x32_bf16 v[192:195],a[36:39],v[72:75],v[192:195]
ds_read_b128 v[68:71],v20 offset:21504
v_mfma_f32_16x16x32_bf16 v[200:203],v[72:75],a[164:167],v[200:203]
buffer_load_dwordx4 v16,s[20:23],s69 offen offset:0 lds
s_waitcnt lgkmcnt(2)
v_mfma_f32_16x16x32_bf16 v[196:199],a[36:39],v[76:79],v[196:199]
ds_read_b128 v[72:75],v20 offset:22528
v_mfma_f32_16x16x32_bf16 v[204:207],v[76:79],a[164:167],v[204:207]
buffer_load_dwordx4 v16,s[20:23],s69 offen offset:1024 lds
s_waitcnt lgkmcnt(2)
v_mfma_f32_16x16x32_bf16 v[192:195],a[40:43],v[64:67],v[192:195]
ds_read_b128 v[76:79],v20 offset:23552
v_mfma_f32_16x16x32_bf16 v[200:203],v[64:67],a[168:171],v[200:203]
buffer_load_dwordx4 v16,s[20:23],s69 offen offset:2048 lds
s_waitcnt lgkmcnt(2)
v_mfma_f32_16x16x32_bf16 v[196:199],a[40:43],v[68:71],v[196:199]
ds_read_b128 v[64:67],v20 offset:24576
v_mfma_f32_16x16x32_bf16 v[204:207],v[68:71],a[168:171],v[204:207]
buffer_load_dwordx4 v16,s[20:23],s69 offen offset:3072 lds
s_waitcnt lgkmcnt(2)
v_mfma_f32_16x16x32_bf16 v[192:195],a[44:47],v[72:75],v[192:195]
ds_read_b128 v[68:71],v20 offset:25600
v_mfma_f32_16x16x32_bf16 v[200:203],v[72:75],a[172:175],v[200:203]
s_add_u32 m0,s62,28672
s_add_u32 s69,s78,28672
s_waitcnt lgkmcnt(2)
v_mfma_f32_16x16x32_bf16 v[196:199],a[44:47],v[76:79],v[196:199]
ds_read_b128 v[72:75],v20 offset:26624
v_mfma_f32_16x16x32_bf16 v[204:207],v[76:79],a[172:175],v[204:207]
buffer_load_dwordx4 v16,s[20:23],s69 offen offset:0 lds
s_waitcnt lgkmcnt(2)
v_mfma_f32_16x16x32_bf16 v[192:195],a[48:51],v[64:67],v[192:195]
ds_read_b128 v[76:79],v20 offset:27648
v_mfma_f32_16x16x32_bf16 v[200:203],v[64:67],a[176:179],v[200:203]
buffer_load_dwordx4 v16,s[20:23],s69 offen offset:1024 lds
s_waitcnt lgkmcnt(2)
v_mfma_f32_16x16x32_bf16 v[196:199],a[48:51],v[68:71],v[196:199]
ds_read_b128 v[64:67],v20 offset:28672
v_mfma_f32_16x16x32_bf16 v[204:207],v[68:71],a[176:179],v[204:207]
buffer_load_dwordx4 v16,s[20:23],s69 offen offset:2048 lds
s_waitcnt lgkmcnt(2)
v_mfma_f32_16x16x32_bf16 v[192:195],a[52:55],v[72:75],v[192:195]
ds_read_b128 v[68:71],v20 offset:29696
v_mfma_f32_16x16x32_bf16 v[200:203],v[72:75],a[180:183],v[200:203]
buffer_load_dwordx4 v16,s[20:23],s69 offen offset:3072 lds
s_waitcnt lgkmcnt(2)
v_mfma_f32_16x16x32_bf16 v[196:199],a[52:55],v[76:79],v[196:199]
ds_read_b128 v[72:75],v20 offset:30720
v_mfma_f32_16x16x32_bf16 v[204:207],v[76:79],a[180:183],v[204:207]
s_waitcnt lgkmcnt(2)
v_mfma_f32_16x16x32_bf16 v[192:195],a[56:59],v[64:67],v[192:195]
ds_read_b128 v[76:79],v20 offset:31744
v_mfma_f32_16x16x32_bf16 v[200:203],v[64:67],a[184:187],v[200:203]
s_waitcnt lgkmcnt(2)
v_mfma_f32_16x16x32_bf16 v[196:199],a[56:59],v[68:71],v[196:199]
ds_read_b128 v[64:67],v20 offset:32768
v_mfma_f32_16x16x32_bf16 v[204:207],v[68:71],a[184:187],v[204:207]
s_waitcnt lgkmcnt(2)
v_mfma_f32_16x16x32_bf16 v[192:195],a[60:63],v[72:75],v[192:195]
ds_read_b128 v[68:71],v20 offset:33792
v_mfma_f32_16x16x32_bf16 v[200:203],v[72:75],a[188:191],v[200:203]
s_waitcnt lgkmcnt(2)
v_mfma_f32_16x16x32_bf16 v[196:199],a[60:63],v[76:79],v[196:199]
ds_read_b128 v[72:75],v20 offset:34816
v_mfma_f32_16x16x32_bf16 v[204:207],v[76:79],a[188:191],v[204:207]
s_waitcnt lgkmcnt(2)
v_mfma_f32_16x16x32_bf16 v[192:195],a[64:67],v[64:67],v[192:195]
ds_read_b128 v[76:79],v20 offset:35840
v_mfma_f32_16x16x32_bf16 v[200:203],v[64:67],a[192:195],v[200:203]
s_waitcnt lgkmcnt(2)
v_mfma_f32_16x16x32_bf16 v[196:199],a[64:67],v[68:71],v[196:199]
ds_read_b128 v[64:67],v20 offset:36864
v_mfma_f32_16x16x32_bf16 v[204:207],v[68:71],a[192:195],v[204:207]
s_waitcnt lgkmcnt(2)
v_mfma_f32_16x16x32_bf16 v[192:195],a[68:71],v[72:75],v[192:195]
ds_read_b128 v[68:71],v20 offset:37888
v_mfma_f32_16x16x32_bf16 v[200:203],v[72:75],a[196:199],v[200:203]
s_waitcnt lgkmcnt(2)
v_mfma_f32_16x16x32_bf16 v[196:199],a[68:71],v[76:79],v[196:199]
ds_read_b128 v[72:75],v20 offset:38912
v_mfma_f32_16x16x32_bf16 v[204:207],v[76:79],a[196:199],v[204:207]
s_waitcnt lgkmcnt(2)
v_mfma_f32_16x16x32_bf16 v[192:195],a[72:75],v[64:67],v[192:195]
ds_read_b128 v[76:79],v20 offset:39936
v_mfma_f32_16x16x32_bf16 v[200:203],v[64:67],a[200:203],v[200:203]
s_waitcnt lgkmcnt(2)
v_mfma_f32_16x16x32_bf16 v[196:199],a[72:75],v[68:71],v[196:199]
ds_read_b128 v[64:67],v20 offset:40960
v_mfma_f32_16x16x32_bf16 v[204:207],v[68:71],a[200:203],v[204:207]
s_waitcnt lgkmcnt(2)
v_mfma_f32_16x16x32_bf16 v[192:195],a[76:79],v[72:75],v[192:195]
ds_read_b128 v[68:71],v20 offset:41984
v_mfma_f32_16x16x32_bf16 v[200:203],v[72:75],a[204:207],v[200:203]
s_waitcnt lgkmcnt(2)
v_mfma_f32_16x16x32_bf16 v[196:199],a[76:79],v[76:79],v[196:199]
ds_read_b128 v[72:75],v20 offset:43008
v_mfma_f32_16x16x32_bf16 v[204:207],v[76:79],a[204:207],v[204:207]
s_waitcnt lgkmcnt(2)
v_mfma_f32_16x16x32_bf16 v[192:195],a[80:83],v[64:67],v[192:195]
ds_read_b128 v[76:79],v20 offset:44032
v_mfma_f32_16x16x32_bf16 v[200:203],v[64:67],a[208:211],v[200:203]
s_waitcnt lgkmcnt(2)
v_mfma_f32_16x16x32_bf16 v[196:199],a[80:83],v[68:71],v[196:199]
ds_read_b128 v[64:67],v20 offset:45056
v_mfma_f32_16x16x32_bf16 v[204:207],v[68:71],a[208:211],v[204:207]
s_waitcnt lgkmcnt(2)
v_mfma_f32_16x16x32_bf16 v[192:195],a[84:87],v[72:75],v[192:195]
ds_read_b128 v[68:71],v20 offset:46080
v_mfma_f32_16x16x32_bf16 v[200:203],v[72:75],a[212:215],v[200:203]
s_waitcnt lgkmcnt(2)
v_mfma_f32_16x16x32_bf16 v[196:199],a[84:87],v[76:79],v[196:199]
ds_read_b128 v[72:75],v20 offset:47104
v_mfma_f32_16x16x32_bf16 v[204:207],v[76:79],a[212:215],v[204:207]
s_waitcnt lgkmcnt(2)
v_mfma_f32_16x16x32_bf16 v[192:195],a[88:91],v[64:67],v[192:195]
ds_read_b128 v[76:79],v20 offset:48128
v_mfma_f32_16x16x32_bf16 v[200:203],v[64:67],a[216:219],v[200:203]
s_waitcnt lgkmcnt(2)
v_mfma_f32_16x16x32_bf16 v[196:199],a[88:91],v[68:71],v[196:199]
ds_read_b128 v[64:67],v20 offset:49152
v_mfma_f32_16x16x32_bf16 v[204:207],v[68:71],a[216:219],v[204:207]
s_waitcnt lgkmcnt(2)
v_mfma_f32_16x16x32_bf16 v[192:195],a[92:95],v[72:75],v[192:195]
ds_read_b128 v[68:71],v20 offset:50176
v_mfma_f32_16x16x32_bf16 v[200:203],v[72:75],a[220:223],v[200:203]
s_waitcnt lgkmcnt(2)
v_mfma_f32_16x16x32_bf16 v[196:199],a[92:95],v[76:79],v[196:199]
ds_read_b128 v[72:75],v20 offset:51200
v_mfma_f32_16x16x32_bf16 v[204:207],v[76:79],a[220:223],v[204:207]
s_waitcnt lgkmcnt(2)
v_mfma_f32_16x16x32_bf16 v[192:195],a[96:99],v[64:67],v[192:195]
ds_read_b128 v[76:79],v20 offset:52224
v_mfma_f32_16x16x32_bf16 v[200:203],v[64:67],a[224:227],v[200:203]
s_waitcnt lgkmcnt(2)
v_mfma_f32_16x16x32_bf16 v[196:199],a[96:99],v[68:71],v[196:199]
ds_read_b128 v[64:67],v20 offset:53248
v_mfma_f32_16x16x32_bf16 v[204:207],v[68:71],a[224:227],v[204:207]
s_waitcnt lgkmcnt(2)
v_mfma_f32_16x16x32_bf16 v[192:195],a[100:103],v[72:75],v[192:195]
ds_read_b128 v[68:71],v20 offset:54272
s_add_u32 m0,s62,43008
s_add_u32 s69,s78,43008
v_mfma_f32_16x16x32_bf16 v[200:203],v[72:75],a[228:231],v[200:203]
s_waitcnt lgkmcnt(2)
v_mfma_f32_16x16x32_bf16 v[196:199],a[100:103],v[76:79],v[196:199]
ds_read_b128 v[72:75],v20 offset:55296
buffer_load_dwordx4 v16,s[20:23],s69 offen offset:0 lds
v_mfma_f32_16x16x32_bf16 v[204:207],v[76:79],a[228:231],v[204:207]
s_waitcnt lgkmcnt(2)
v_mfma_f32_16x16x32_bf16 v[192:195],a[104:107],v[64:67],v[192:195]
ds_read_b128 v[76:79],v20 offset:56320
buffer_load_dwordx4 v16,s[20:23],s69 offen offset:1024 lds
v_mfma_f32_16x16x32_bf16 v[200:203],v[64:67],a[232:235],v[200:203]
s_waitcnt lgkmcnt(2)
v_mfma_f32_16x16x32_bf16 v[196:199],a[104:107],v[68:71],v[196:199]
ds_read_b128 v[64:67],v20 offset:57344
buffer_load_dwordx4 v16,s[20:23],s69 offen offset:2048 lds
v_mfma_f32_16x16x32_bf16 v[204:207],v[68:71],a[232:235],v[204:207]
s_waitcnt lgkmcnt(2)
v_mfma_f32_16x16x32_bf16 v[192:195],a[108:111],v[72:75],v[192:195]
ds_read_b128 v[68:71],v20 offset:58368
buffer_load_dwordx4 v16,s[20:23],s69 offen offset:3072 lds
v_mfma_f32_16x16x32_bf16 v[200:203],v[72:75],a[236:239],v[200:203]
s_waitcnt lgkmcnt(2)
v_mfma_f32_16x16x32_bf16 v[196:199],a[108:111],v[76:79],v[196:199]
ds_read_b128 v[72:75],v20 offset:59392
s_add_u32 m0,s62,47104
s_add_u32 s69,s78,47104
v_mfma_f32_16x16x32_bf16 v[204:207],v[76:79],a[236:239],v[204:207]
s_waitcnt lgkmcnt(2)
v_mfma_f32_16x16x32_bf16 v[192:195],a[112:115],v[64:67],v[192:195]
ds_read_b128 v[76:79],v20 offset:60416
buffer_load_dwordx4 v16,s[20:23],s69 offen offset:0 lds
v_mfma_f32_16x16x32_bf16 v[200:203],v[64:67],a[240:243],v[200:203]
s_waitcnt lgkmcnt(2)
v_mfma_f32_16x16x32_bf16 v[196:199],a[112:115],v[68:71],v[196:199]
ds_read_b128 v[64:67],v20 offset:61440
v_mfma_f32_16x16x32_bf16 v[204:207],v[68:71],a[240:243],v[204:207]
buffer_load_dwordx4 v16,s[20:23],s69 offen offset:1024 lds
s_waitcnt lgkmcnt(2)
v_mfma_f32_16x16x32_bf16 v[192:195],a[116:119],v[72:75],v[192:195]
ds_read_b128 v[68:71],v20 offset:62464
v_mfma_f32_16x16x32_bf16 v[200:203],v[72:75],a[244:247],v[200:203]
buffer_load_dwordx4 v16,s[20:23],s69 offen offset:2048 lds
s_waitcnt lgkmcnt(2)
v_mfma_f32_16x16x32_bf16 v[196:199],a[116:119],v[76:79],v[196:199]
ds_read_b128 v[72:75],v20 offset:63488
v_mfma_f32_16x16x32_bf16 v[204:207],v[76:79],a[244:247],v[204:207]
buffer_load_dwordx4 v16,s[20:23],s69 offen offset:3072 lds
s_waitcnt lgkmcnt(2)
v_mfma_f32_16x16x32_bf16 v[192:195],a[120:123],v[64:67],v[192:195]
ds_read_b128 v[76:79],v20 offset:64512
v_mfma_f32_16x16x32_bf16 v[200:203],v[64:67],a[248:251],v[200:203]
s_add_u32 m0,s62,51200
s_add_u32 s69,s78,51200
s_waitcnt lgkmcnt(2)
v_mfma_f32_16x16x32_bf16 v[196:199],a[120:123],v[68:71],v[196:199]
v_mfma_f32_16x16x32_bf16 v[204:207],v[68:71],a[248:251],v[204:207]
buffer_load_dwordx4 v16,s[20:23],s69 offen offset:0 lds
s_waitcnt lgkmcnt(1)
v_mfma_f32_16x16x32_bf16 v[192:195],a[124:127],v[72:75],v[192:195]
v_mfma_f32_16x16x32_bf16 v[200:203],v[72:75],a[252:255],v[200:203]
buffer_load_dwordx4 v16,s[20:23],s69 offen offset:1024 lds
s_waitcnt lgkmcnt(0)
v_mfma_f32_16x16x32_bf16 v[196:199],a[124:127],v[76:79],v[196:199]
v_mfma_f32_16x16x32_bf16 v[204:207],v[76:79],a[252:255],v[204:207]
s_waitcnt vmcnt(26)
ds_write_b32 v21,v25 offset:28
v_xor_b32 v20,0x10000,v20
s_xor_b32 s62,s62,0x10000
s_lshr_b32 s64,s73,9
v_add_u32 v22,s64,v24
v_cvt_pk_bf16_f32 v208,v192,v193
v_cvt_pk_bf16_f32 v209,v194,v195
v_cvt_pk_bf16_f32 v210,v196,v197
v_cvt_pk_bf16_f32 v211,v198,v199
v_cvt_pk_bf16_f32 v212,v200,v201
v_cvt_pk_bf16_f32 v213,v202,v203
v_cvt_pk_bf16_f32 v214,v204,v205
v_cvt_pk_bf16_f32 v215,v206,v207
v_permlane16_swap_b32 v208,v210
v_permlane16_swap_b32 v209,v211
buffer_store_dwordx4 v[208:211],v2,s[24:27],s73 offen
buffer_store_dwordx4 v[208:211],v2,s[28:31],s73 offen sc1
ds_write_b128 v22,v[212:215] offset:17408
buffer_store_dwordx4 v[208:211],v17,s[20:23],s12 offen sc1
bgx_131:
s_waitcnt lgkmcnt(0)
s_andn2_b32 s64,s79,0x14
s_cmp_eq_u32 s64,2
s_cbranch_scc1 late_133
lateb_134:
s_buffer_load_dword s48,s[20:23],s80 offset:0
s_buffer_load_dword s48,s[20:23],s80 offset:64
s_buffer_load_dword s48,s[20:23],s80 offset:128
s_buffer_load_dword s48,s[20:23],s80 offset:192
s_buffer_load_dword s48,s[20:23],s80 offset:256
s_buffer_load_dword s48,s[20:23],s80 offset:320
s_buffer_load_dword s48,s[20:23],s80 offset:384
s_buffer_load_dword s48,s[20:23],s80 offset:448
s_buffer_load_dword s48,s[20:23],s80 offset:512
s_buffer_load_dword s48,s[20:23],s80 offset:576
s_buffer_load_dword s48,s[20:23],s80 offset:640
s_buffer_load_dword s48,s[20:23],s80 offset:704
s_buffer_load_dword s48,s[20:23],s80 offset:768
s_buffer_load_dword s48,s[20:23],s80 offset:832
s_buffer_load_dword s48,s[20:23],s80 offset:896
s_buffer_load_dword s48,s[20:23],s80 offset:960
s_buffer_load_dword s48,s[20:23],s80 offset:1024
s_buffer_load_dword s48,s[20:23],s80 offset:1088
s_buffer_load_dword s48,s[20:23],s80 offset:1152
s_buffer_load_dword s48,s[20:23],s80 offset:1216
s_buffer_load_dword s48,s[20:23],s80 offset:1280
s_buffer_load_dword s48,s[20:23],s80 offset:1344
s_buffer_load_dword s48,s[20:23],s80 offset:1408
s_buffer_load_dword s48,s[20:23],s80 offset:1472
s_buffer_load_dword s48,s[20:23],s80 offset:1536
s_buffer_load_dword s48,s[20:23],s80 offset:1600
s_buffer_load_dword s48,s[20:23],s80 offset:1664
s_buffer_load_dword s48,s[20:23],s80 offset:1728
s_buffer_load_dword s48,s[20:23],s80 offset:1792
s_buffer_load_dword s48,s[20:23],s80 offset:1856
s_buffer_load_dword s48,s[20:23],s80 offset:1920
s_buffer_load_dword s48,s[20:23],s80 offset:1984
s_add_u32 s63,s79,1
s_and_b32 s64,s63,3
s_lshl_b32 s70,s64,20
s_add_u32 s65,s63,2
s_and_b32 s65,s65,3
s_lshl_b32 s73,s65,20
s_add_u32 s55,s63,3
s_lshl_b32 s78,s55,16
s_add_u32 s78,s78,57344
s_cmp_lt_u32 s55,64
s_cselect_b32 s78,s78,0x7fff0000
s_add_u32 s60,s63,1
s_lshl_b32 s76,s60,21
s_lshl_b32 s55,s60,13
s_and_b32 s55,s55,0x2000
s_xor_b32 s55,s55,s61
s_add_u32 s76,s76,s55
s_cmp_lt_u32 s60,64
s_cselect_b32 s76,s76,0x7fff0000
s_add_u32 s60,s63,2
s_lshl_b32 s12,s60,21
s_lshl_b32 s55,s60,13
s_and_b32 s55,s55,0x2000
s_xor_b32 s55,s55,s61
s_add_u32 s12,s12,s55
s_cmp_lt_u32 s60,64
s_cselect_b32 s12,s12,0x7fff0000
s_add_u32 s55,s63,5
s_min_u32 s55,s55,63
s_lshl_b32 s55,s55,16
s_lshl_b32 s60,s59,11
s_add_u32 s80,s55,s60
s_add_u32 s80,s80,57344
v_mov_b32 v176,0
v_mov_b32 v177,0
v_mov_b32 v178,0
v_mov_b32 v179,0
v_mov_b32 v180,0
v_mov_b32 v181,0
v_mov_b32 v182,0
v_mov_b32 v183,0
s_add_u32 s79,s79,1
v_add_u32 v25,1,v25
s_waitcnt vmcnt(0)
s_branch loop_125
art_129:
s_sub_u32 s90,s90,1
s_cmp_lt_i32 s90,0
s_cbranch_scc1 abk_130
buffer_load_dwordx4 v[64:67],v28,s[20:23],s70 offen offset:0 sc1
buffer_load_dwordx4 v[68:71],v28,s[20:23],s70 offen offset:1024 sc1
buffer_load_dwordx4 v[72:75],v28,s[20:23],s70 offen offset:2048 sc1
buffer_load_dwordx4 v[76:79],v28,s[20:23],s70 offen offset:3072 sc1
s_waitcnt vmcnt(3)
ds_write_b128 v24,v[64:67] offset:8192
v_min3_u32 v22,v64,v65,v66
v_min_u32 v22,v22,v67
s_waitcnt vmcnt(2)
ds_write_b128 v24,v[68:71] offset:9216
v_min3_u32 v22,v22,v68,v69
v_min3_u32 v22,v22,v70,v71
s_waitcnt vmcnt(1)
ds_write_b128 v24,v[72:75] offset:10240
v_min3_u32 v22,v22,v72,v73
v_min3_u32 v22,v22,v74,v75
s_waitcnt vmcnt(0)
ds_write_b128 v24,v[76:79] offset:11264
v_min3_u32 v22,v22,v76,v77
v_min3_u32 v22,v22,v78,v79
v_cmp_eq_u32 vcc,0,v22
s_cbranch_vccnz art_129
s_branch abk_130
bgsk_132:
s_waitcnt vmcnt(0)
ds_write_b32 v21,v25 offset:28
s_branch bgx_131
late_133:
s_cmp_eq_u32 s79,22
s_cbranch_scc1 lateb_134
v_lshlrev_b32 v184,2,v16
s_mov_b32 s52,21052416
s_mov_b32 s53,1792
s_lshr_b32 s64,s79,4
s_lshl_b32 s64,0x100,s64
s_cmp_eq_u32 s79,2
s_cselect_b32 exec_lo,0xff,s64
s_mov_b32 exec_hi,0
dp_135:
buffer_load_dword v185,v184,s[20:23],s52 offen sc1
s_waitcnt vmcnt(0)
v_cmp_ne_u32 vcc,s53,v185
s_cbranch_vccz dpok_136
s_sleep 2
s_sub_u32 s90,s90,1
s_cmp_gt_i32 s90,0
s_cbranch_scc1 dp_135
dpok_136:
s_mov_b64 exec,-1
s_branch lateb_134
first_124:
s_add_u32 s63,s79,0
s_and_b32 s64,s63,3
s_lshl_b32 s70,s64,20
s_add_u32 s65,s63,2
s_and_b32 s65,s65,3
s_lshl_b32 s73,s65,20
s_add_u32 s55,s63,3
s_lshl_b32 s78,s55,16
s_add_u32 s78,s78,57344
s_cmp_lt_u32 s55,64
s_cselect_b32 s78,s78,0x7fff0000
s_add_u32 s60,s63,1
s_lshl_b32 s76,s60,21
s_lshl_b32 s55,s60,13
s_and_b32 s55,s55,0x2000
s_xor_b32 s55,s55,s61
s_add_u32 s76,s76,s55
s_cmp_lt_u32 s60,64
s_cselect_b32 s76,s76,0x7fff0000
s_add_u32 s60,s63,2
s_lshl_b32 s12,s60,21
s_lshl_b32 s55,s60,13
s_and_b32 s55,s55,0x2000
s_xor_b32 s55,s55,s61
s_add_u32 s12,s12,s55
s_cmp_lt_u32 s60,64
s_cselect_b32 s12,s12,0x7fff0000
s_add_u32 s55,s63,5
s_min_u32 s55,s55,63
s_lshl_b32 s55,s55,16
s_lshl_b32 s60,s59,11
s_add_u32 s80,s55,s60
s_add_u32 s80,s80,57344
v_mov_b32 v176,0
v_mov_b32 v177,0
v_mov_b32 v178,0
v_mov_b32 v179,0
v_mov_b32 v180,0
v_mov_b32 v181,0
v_mov_b32 v182,0
v_mov_b32 v183,0
s_waitcnt vmcnt(0) lgkmcnt(0)
pn1_137:
s_barrier
ds_read_b128 v[64:67],v20 offset:0
ds_read_b128 v[68:71],v20 offset:1024
ds_read_b128 v[72:75],v20 offset:2048
s_waitcnt lgkmcnt(2)
v_mfma_f32_16x16x32_bf16 v[192:195],a[0:3],v[64:67],0
ds_read_b128 v[76:79],v20 offset:3072
v_mfma_f32_16x16x32_bf16 v[200:203],v[64:67],a[128:131],0
s_waitcnt lgkmcnt(2)
v_mfma_f32_16x16x32_bf16 v[196:199],a[0:3],v[68:71],0
ds_read_b128 v[64:67],v20 offset:4096
v_mfma_f32_16x16x32_bf16 v[204:207],v[68:71],a[128:131],0
s_waitcnt lgkmcnt(2)
v_mfma_f32_16x16x32_bf16 v[192:195],a[4:7],v[72:75],v[192:195]
ds_read_b128 v[68:71],v20 offset:5120
v_mfma_f32_16x16x32_bf16 v[200:203],v[72:75],a[132:135],v[200:203]
s_waitcnt lgkmcnt(2)
v_mfma_f32_16x16x32_bf16 v[196:199],a[4:7],v[76:79],v[196:199]
ds_read_b128 v[72:75],v20 offset:6144
v_mfma_f32_16x16x32_bf16 v[204:207],v[76:79],a[132:135],v[204:207]
s_waitcnt lgkmcnt(2)
v_mfma_f32_16x16x32_bf16 v[192:195],a[8:11],v[64:67],v[192:195]
ds_read_b128 v[76:79],v20 offset:7168
v_mfma_f32_16x16x32_bf16 v[200:203],v[64:67],a[136:139],v[200:203]
s_waitcnt lgkmcnt(2)
v_mfma_f32_16x16x32_bf16 v[196:199],a[8:11],v[68:71],v[196:199]
ds_read_b128 v[64:67],v20 offset:8192
v_mfma_f32_16x16x32_bf16 v[204:207],v[68:71],a[136:139],v[204:207]
s_waitcnt lgkmcnt(2)
v_mfma_f32_16x16x32_bf16 v[192:195],a[12:15],v[72:75],v[192:195]
ds_read_b128 v[68:71],v20 offset:9216
v_mfma_f32_16x16x32_bf16 v[200:203],v[72:75],a[140:143],v[200:203]
s_waitcnt lgkmcnt(2)
v_mfma_f32_16x16x32_bf16 v[196:199],a[12:15],v[76:79],v[196:199]
ds_read_b128 v[72:75],v20 offset:10240
v_mfma_f32_16x16x32_bf16 v[204:207],v[76:79],a[140:143],v[204:207]
s_waitcnt lgkmcnt(2)
v_mfma_f32_16x16x32_bf16 v[192:195],a[16:19],v[64:67],v[192:195]
ds_read_b128 v[76:79],v20 offset:11264
v_mfma_f32_16x16x32_bf16 v[200:203],v[64:67],a[144:147],v[200:203]
s_waitcnt lgkmcnt(2)
v_mfma_f32_16x16x32_bf16 v[196:199],a[16:19],v[68:71],v[196:199]
ds_read_b128 v[64:67],v20 offset:12288
v_mfma_f32_16x16x32_bf16 v[204:207],v[68:71],a[144:147],v[204:207]
s_waitcnt lgkmcnt(2)
v_mfma_f32_16x16x32_bf16 v[192:195],a[20:23],v[72:75],v[192:195]
ds_read_b128 v[68:71],v20 offset:13312
v_mfma_f32_16x16x32_bf16 v[200:203],v[72:75],a[148:151],v[200:203]
s_waitcnt lgkmcnt(2)
v_mfma_f32_16x16x32_bf16 v[196:199],a[20:23],v[76:79],v[196:199]
ds_read_b128 v[72:75],v20 offset:14336
v_mfma_f32_16x16x32_bf16 v[204:207],v[76:79],a[148:151],v[204:207]
s_waitcnt lgkmcnt(2)
v_mfma_f32_16x16x32_bf16 v[192:195],a[24:27],v[64:67],v[192:195]
ds_read_b128 v[76:79],v20 offset:15360
v_mfma_f32_16x16x32_bf16 v[200:203],v[64:67],a[152:155],v[200:203]
s_waitcnt lgkmcnt(2)
v_mfma_f32_16x16x32_bf16 v[196:199],a[24:27],v[68:71],v[196:199]
ds_read_b128 v[64:67],v20 offset:16384
v_mfma_f32_16x16x32_bf16 v[204:207],v[68:71],a[152:155],v[204:207]
s_waitcnt lgkmcnt(2)
v_mfma_f32_16x16x32_bf16 v[192:195],a[28:31],v[72:75],v[192:195]
ds_read_b128 v[68:71],v20 offset:17408
v_mfma_f32_16x16x32_bf16 v[200:203],v[72:75],a[156:159],v[200:203]
s_waitcnt lgkmcnt(2)
v_mfma_f32_16x16x32_bf16 v[196:199],a[28:31],v[76:79],v[196:199]
ds_read_b128 v[72:75],v20 offset:18432
v_mfma_f32_16x16x32_bf16 v[204:207],v[76:79],a[156:159],v[204:207]
s_waitcnt lgkmcnt(2)
v_mfma_f32_16x16x32_bf16 v[192:195],a[32:35],v[64:67],v[192:195]
ds_read_b128 v[76:79],v20 offset:19456
v_mfma_f32_16x16x32_bf16 v[200:203],v[64:67],a[160:163],v[200:203]
s_waitcnt lgkmcnt(2)
v_mfma_f32_16x16x32_bf16 v[196:199],a[32:35],v[68:71],v[196:199]
ds_read_b128 v[64:67],v20 offset:20480
v_mfma_f32_16x16x32_bf16 v[204:207],v[68:71],a[160:163],v[204:207]
s_waitcnt lgkmcnt(2)
v_mfma_f32_16x16x32_bf16 v[192:195],a[36:39],v[72:75],v[192:195]
ds_read_b128 v[68:71],v20 offset:21504
v_mfma_f32_16x16x32_bf16 v[200:203],v[72:75],a[164:167],v[200:203]
s_waitcnt lgkmcnt(2)
v_mfma_f32_16x16x32_bf16 v[196:199],a[36:39],v[76:79],v[196:199]
ds_read_b128 v[72:75],v20 offset:22528
v_mfma_f32_16x16x32_bf16 v[204:207],v[76:79],a[164:167],v[204:207]
s_waitcnt lgkmcnt(2)
v_mfma_f32_16x16x32_bf16 v[192:195],a[40:43],v[64:67],v[192:195]
ds_read_b128 v[76:79],v20 offset:23552
v_mfma_f32_16x16x32_bf16 v[200:203],v[64:67],a[168:171],v[200:203]
s_waitcnt lgkmcnt(2)
v_mfma_f32_16x16x32_bf16 v[196:199],a[40:43],v[68:71],v[196:199]
ds_read_b128 v[64:67],v20 offset:24576
v_mfma_f32_16x16x32_bf16 v[204:207],v[68:71],a[168:171],v[204:207]
s_waitcnt lgkmcnt(2)
v_mfma_f32_16x16x32_bf16 v[192:195],a[44:47],v[72:75],v[192:195]
ds_read_b128 v[68:71],v20 offset:25600
v_mfma_f32_16x16x32_bf16 v[200:203],v[72:75],a[172:175],v[200:203]
s_waitcnt lgkmcnt(2)
v_mfma_f32_16x16x32_bf16 v[196:199],a[44:47],v[76:79],v[196:199]
ds_read_b128 v[72:75],v20 offset:26624
v_mfma_f32_16x16x32_bf16 v[204:207],v[76:79],a[172:175],v[204:207]
s_waitcnt lgkmcnt(2)
v_mfma_f32_16x16x32_bf16 v[192:195],a[48:51],v[64:67],v[192:195]
ds_read_b128 v[76:79],v20 offset:27648
v_mfma_f32_16x16x32_bf16 v[200:203],v[64:67],a[176:179],v[200:203]
s_waitcnt lgkmcnt(2)
v_mfma_f32_16x16x32_bf16 v[196:199],a[48:51],v[68:71],v[196:199]
ds_read_b128 v[64:67],v20 offset:28672
v_mfma_f32_16x16x32_bf16 v[204:207],v[68:71],a[176:179],v[204:207]
s_waitcnt lgkmcnt(2)
v_mfma_f32_16x16x32_bf16 v[192:195],a[52:55],v[72:75],v[192:195]
ds_read_b128 v[68:71],v20 offset:29696
v_mfma_f32_16x16x32_bf16 v[200:203],v[72:75],a[180:183],v[200:203]
s_waitcnt lgkmcnt(2)
v_mfma_f32_16x16x32_bf16 v[196:199],a[52:55],v[76:79],v[196:199]
ds_read_b128 v[72:75],v20 offset:30720
v_mfma_f32_16x16x32_bf16 v[204:207],v[76:79],a[180:183],v[204:207]
s_waitcnt lgkmcnt(2)
v_mfma_f32_16x16x32_bf16 v[192:195],a[56:59],v[64:67],v[192:195]
ds_read_b128 v[76:79],v20 offset:31744
v_mfma_f32_16x16x32_bf16 v[200:203],v[64:67],a[184:187],v[200:203]
s_waitcnt lgkmcnt(2)
v_mfma_f32_16x16x32_bf16 v[196:199],a[56:59],v[68:71],v[196:199]
ds_read_b128 v[64:67],v20 offset:32768
v_mfma_f32_16x16x32_bf16 v[204:207],v[68:71],a[184:187],v[204:207]
s_waitcnt lgkmcnt(2)
v_mfma_f32_16x16x32_bf16 v[192:195],a[60:63],v[72:75],v[192:195]
ds_read_b128 v[68:71],v20 offset:33792
v_mfma_f32_16x16x32_bf16 v[200:203],v[72:75],a[188:191],v[200:203]
s_waitcnt lgkmcnt(2)
v_mfma_f32_16x16x32_bf16 v[196:199],a[60:63],v[76:79],v[196:199]
ds_read_b128 v[72:75],v20 offset:34816
v_mfma_f32_16x16x32_bf16 v[204:207],v[76:79],a[188:191],v[204:207]
s_waitcnt lgkmcnt(2)
v_mfma_f32_16x16x32_bf16 v[192:195],a[64:67],v[64:67],v[192:195]
ds_read_b128 v[76:79],v20 offset:35840
v_mfma_f32_16x16x32_bf16 v[200:203],v[64:67],a[192:195],v[200:203]
s_waitcnt lgkmcnt(2)
v_mfma_f32_16x16x32_bf16 v[196:199],a[64:67],v[68:71],v[196:199]
ds_read_b128 v[64:67],v20 offset:36864
v_mfma_f32_16x16x32_bf16 v[204:207],v[68:71],a[192:195],v[204:207]
s_waitcnt lgkmcnt(2)
v_mfma_f32_16x16x32_bf16 v[192:195],a[68:71],v[72:75],v[192:195]
ds_read_b128 v[68:71],v20 offset:37888
v_mfma_f32_16x16x32_bf16 v[200:203],v[72:75],a[196:199],v[200:203]
s_waitcnt lgkmcnt(2)
v_mfma_f32_16x16x32_bf16 v[196:199],a[68:71],v[76:79],v[196:199]
ds_read_b128 v[72:75],v20 offset:38912
v_mfma_f32_16x16x32_bf16 v[204:207],v[76:79],a[196:199],v[204:207]
s_waitcnt lgkmcnt(2)
v_mfma_f32_16x16x32_bf16 v[192:195],a[72:75],v[64:67],v[192:195]
ds_read_b128 v[76:79],v20 offset:39936
v_mfma_f32_16x16x32_bf16 v[200:203],v[64:67],a[200:203],v[200:203]
s_waitcnt lgkmcnt(2)
v_mfma_f32_16x16x32_bf16 v[196:199],a[72:75],v[68:71],v[196:199]
ds_read_b128 v[64:67],v20 offset:40960
v_mfma_f32_16x16x32_bf16 v[204:207],v[68:71],a[200:203],v[204:207]
s_waitcnt lgkmcnt(2)
v_mfma_f32_16x16x32_bf16 v[192:195],a[76:79],v[72:75],v[192:195]
ds_read_b128 v[68:71],v20 offset:41984
v_mfma_f32_16x16x32_bf16 v[200:203],v[72:75],a[204:207],v[200:203]
s_waitcnt lgkmcnt(2)
v_mfma_f32_16x16x32_bf16 v[196:199],a[76:79],v[76:79],v[196:199]
ds_read_b128 v[72:75],v20 offset:43008
v_mfma_f32_16x16x32_bf16 v[204:207],v[76:79],a[204:207],v[204:207]
s_waitcnt lgkmcnt(2)
v_mfma_f32_16x16x32_bf16 v[192:195],a[80:83],v[64:67],v[192:195]
ds_read_b128 v[76:79],v20 offset:44032
v_mfma_f32_16x16x32_bf16 v[200:203],v[64:67],a[208:211],v[200:203]
s_waitcnt lgkmcnt(2)
v_mfma_f32_16x16x32_bf16 v[196:199],a[80:83],v[68:71],v[196:199]
ds_read_b128 v[64:67],v20 offset:45056
v_mfma_f32_16x16x32_bf16 v[204:207],v[68:71],a[208:211],v[204:207]
s_waitcnt lgkmcnt(2)
v_mfma_f32_16x16x32_bf16 v[192:195],a[84:87],v[72:75],v[192:195]
ds_read_b128 v[68:71],v20 offset:46080
v_mfma_f32_16x16x32_bf16 v[200:203],v[72:75],a[212:215],v[200:203]
s_waitcnt lgkmcnt(2)
v_mfma_f32_16x16x32_bf16 v[196:199],a[84:87],v[76:79],v[196:199]
ds_read_b128 v[72:75],v20 offset:47104
v_mfma_f32_16x16x32_bf16 v[204:207],v[76:79],a[212:215],v[204:207]
s_waitcnt lgkmcnt(2)
v_mfma_f32_16x16x32_bf16 v[192:195],a[88:91],v[64:67],v[192:195]
ds_read_b128 v[76:79],v20 offset:48128
v_mfma_f32_16x16x32_bf16 v[200:203],v[64:67],a[216:219],v[200:203]
s_waitcnt lgkmcnt(2)
v_mfma_f32_16x16x32_bf16 v[196:199],a[88:91],v[68:71],v[196:199]
ds_read_b128 v[64:67],v20 offset:49152
v_mfma_f32_16x16x32_bf16 v[204:207],v[68:71],a[216:219],v[204:207]
s_waitcnt lgkmcnt(2)
v_mfma_f32_16x16x32_bf16 v[192:195],a[92:95],v[72:75],v[192:195]
ds_read_b128 v[68:71],v20 offset:50176
v_mfma_f32_16x16x32_bf16 v[200:203],v[72:75],a[220:223],v[200:203]
s_waitcnt lgkmcnt(2)
v_mfma_f32_16x16x32_bf16 v[196:199],a[92:95],v[76:79],v[196:199]
ds_read_b128 v[72:75],v20 offset:51200
v_mfma_f32_16x16x32_bf16 v[204:207],v[76:79],a[220:223],v[204:207]
s_waitcnt lgkmcnt(2)
v_mfma_f32_16x16x32_bf16 v[192:195],a[96:99],v[64:67],v[192:195]
ds_read_b128 v[76:79],v20 offset:52224
v_mfma_f32_16x16x32_bf16 v[200:203],v[64:67],a[224:227],v[200:203]
s_waitcnt lgkmcnt(2)
v_mfma_f32_16x16x32_bf16 v[196:199],a[96:99],v[68:71],v[196:199]
ds_read_b128 v[64:67],v20 offset:53248
v_mfma_f32_16x16x32_bf16 v[204:207],v[68:71],a[224:227],v[204:207]
s_waitcnt lgkmcnt(2)
v_mfma_f32_16x16x32_bf16 v[192:195],a[100:103],v[72:75],v[192:195]
ds_read_b128 v[68:71],v20 offset:54272
v_mfma_f32_16x16x32_bf16 v[200:203],v[72:75],a[228:231],v[200:203]
s_waitcnt lgkmcnt(2)
v_mfma_f32_16x16x32_bf16 v[196:199],a[100:103],v[76:79],v[196:199]
ds_read_b128 v[72:75],v20 offset:55296
v_mfma_f32_16x16x32_bf16 v[204:207],v[76:79],a[228:231],v[204:207]
s_waitcnt lgkmcnt(2)
v_mfma_f32_16x16x32_bf16 v[192:195],a[104:107],v[64:67],v[192:195]
ds_read_b128 v[76:79],v20 offset:56320
v_mfma_f32_16x16x32_bf16 v[200:203],v[64:67],a[232:235],v[200:203]
s_waitcnt lgkmcnt(2)
v_mfma_f32_16x16x32_bf16 v[196:199],a[104:107],v[68:71],v[196:199]
ds_read_b128 v[64:67],v20 offset:57344
v_mfma_f32_16x16x32_bf16 v[204:207],v[68:71],a[232:235],v[204:207]
s_waitcnt lgkmcnt(2)
v_mfma_f32_16x16x32_bf16 v[192:195],a[108:111],v[72:75],v[192:195]
ds_read_b128 v[68:71],v20 offset:58368
v_mfma_f32_16x16x32_bf16 v[200:203],v[72:75],a[236:239],v[200:203]
s_waitcnt lgkmcnt(2)
v_mfma_f32_16x16x32_bf16 v[196:199],a[108:111],v[76:79],v[196:199]
ds_read_b128 v[72:75],v20 offset:59392
v_mfma_f32_16x16x32_bf16 v[204:207],v[76:79],a[236:239],v[204:207]
s_waitcnt lgkmcnt(2)
v_mfma_f32_16x16x32_bf16 v[192:195],a[112:115],v[64:67],v[192:195]
ds_read_b128 v[76:79],v20 offset:60416
v_mfma_f32_16x16x32_bf16 v[200:203],v[64:67],a[240:243],v[200:203]
s_waitcnt lgkmcnt(2)
v_mfma_f32_16x16x32_bf16 v[196:199],a[112:115],v[68:71],v[196:199]
ds_read_b128 v[64:67],v20 offset:61440
v_mfma_f32_16x16x32_bf16 v[204:207],v[68:71],a[240:243],v[204:207]
s_waitcnt lgkmcnt(2)
v_mfma_f32_16x16x32_bf16 v[192:195],a[116:119],v[72:75],v[192:195]
ds_read_b128 v[68:71],v20 offset:62464
v_mfma_f32_16x16x32_bf16 v[200:203],v[72:75],a[244:247],v[200:203]
s_waitcnt lgkmcnt(2)
v_mfma_f32_16x16x32_bf16 v[196:199],a[116:119],v[76:79],v[196:199]
ds_read_b128 v[72:75],v20 offset:63488
v_mfma_f32_16x16x32_bf16 v[204:207],v[76:79],a[244:247],v[204:207]
s_waitcnt lgkmcnt(2)
v_mfma_f32_16x16x32_bf16 v[192:195],a[120:123],v[64:67],v[192:195]
ds_read_b128 v[76:79],v20 offset:64512
v_mfma_f32_16x16x32_bf16 v[200:203],v[64:67],a[248:251],v[200:203]
s_waitcnt lgkmcnt(2)
v_mfma_f32_16x16x32_bf16 v[196:199],a[120:123],v[68:71],v[196:199]
v_mfma_f32_16x16x32_bf16 v[204:207],v[68:71],a[248:251],v[204:207]
s_waitcnt lgkmcnt(1)
v_mfma_f32_16x16x32_bf16 v[192:195],a[124:127],v[72:75],v[192:195]
v_mfma_f32_16x16x32_bf16 v[200:203],v[72:75],a[252:255],v[200:203]
s_waitcnt lgkmcnt(0)
v_mfma_f32_16x16x32_bf16 v[196:199],a[124:127],v[76:79],v[196:199]
v_mfma_f32_16x16x32_bf16 v[204:207],v[76:79],a[252:255],v[204:207]
v_xor_b32 v20,0x10000,v20
s_xor_b32 s62,s62,0x10000
s_lshr_b32 s64,s73,9
v_add_u32 v22,s64,v24
v_cvt_pk_bf16_f32 v208,v192,v193
v_cvt_pk_bf16_f32 v209,v194,v195
s_nop 0
v_cvt_pk_bf16_f32 v210,v196,v197
v_cvt_pk_bf16_f32 v211,v198,v199
v_cvt_pk_bf16_f32 v212,v200,v201
v_cvt_pk_bf16_f32 v213,v202,v203
v_cvt_pk_bf16_f32 v214,v204,v205
v_cvt_pk_bf16_f32 v215,v206,v207
v_permlane16_swap_b32 v208,v210
v_permlane16_swap_b32 v209,v211
buffer_store_dwordx4 v[208:211],v2,s[24:27],s73 offen
buffer_store_dwordx4 v[208:211],v2,s[28:31],s73 offen sc1
ds_write_b128 v22,v[212:215] offset:17408
buffer_store_dwordx4 v[208:211],v17,s[20:23],s12 offen sc1
bgx_139:
s_add_u32 s63,s79,1
s_and_b32 s64,s63,3
s_lshl_b32 s70,s64,20
s_add_u32 s65,s63,2
s_and_b32 s65,s65,3
s_lshl_b32 s73,s65,20
s_add_u32 s55,s63,3
s_lshl_b32 s78,s55,16
s_add_u32 s78,s78,57344
s_cmp_lt_u32 s55,64
s_cselect_b32 s78,s78,0x7fff0000
s_add_u32 s60,s63,1
s_lshl_b32 s76,s60,21
s_lshl_b32 s55,s60,13
s_and_b32 s55,s55,0x2000
s_xor_b32 s55,s55,s61
s_add_u32 s76,s76,s55
s_cmp_lt_u32 s60,64
s_cselect_b32 s76,s76,0x7fff0000
s_add_u32 s60,s63,2
s_lshl_b32 s12,s60,21
s_lshl_b32 s55,s60,13
s_and_b32 s55,s55,0x2000
s_xor_b32 s55,s55,s61
s_add_u32 s12,s12,s55
s_cmp_lt_u32 s60,64
s_cselect_b32 s12,s12,0x7fff0000
s_add_u32 s55,s63,5
s_min_u32 s55,s55,63
s_lshl_b32 s55,s55,16
s_lshl_b32 s60,s59,11
s_add_u32 s80,s55,s60
s_add_u32 s80,s80,57344
v_mov_b32 v176,0
v_mov_b32 v177,0
v_mov_b32 v178,0
v_mov_b32 v179,0
v_mov_b32 v180,0
v_mov_b32 v181,0
v_mov_b32 v182,0
v_mov_b32 v183,0
s_add_u32 s79,s79,1
s_cmp_eq_u32 s79,0
s_cbranch_scc1 pn2_138
buffer_store_dwordx4 v[212:215],v12,s[20:23],s76 offen sc1
s_waitcnt lgkmcnt(0)
s_branch pn1_137
pn2_138:
v_mov_b32 v25,1
s_waitcnt vmcnt(1) lgkmcnt(0)
s_barrier
s_branch loop_125
w3_62:
v_xor_b32 v9,0x10000,v8
v_xor_b32 v10,0x20000,v8
v_xor_b32 v11,0x30000,v8
v_and_b32 v22,2,v4
v_lshrrev_b32 v23,3,v3
v_add_u32 v22,v22,v23
v_lshlrev_b32 v22,3,v22
v_and_b32 v23,1,v4
v_lshl_add_u32 v22,v23,2,v22
v_and_b32 v23,3,v3
v_add_u32 v22,v22,v23
v_lshlrev_b32 v22,4,v22
v_bfe_u32 v23,v3,2,1
v_lshl_add_u32 v22,v23,3,v22
v_add_u32 v30,s66,v22
v_and_b32 v22,7,v3
v_lshl_add_u32 v12,v4,3,v22
v_lshlrev_b32 v12,4,v12
v_add_u32 v12,s66,v12
s_branch first_140
loop_141:
s_barrier
buffer_load_dword v248,v18,s[20:23],s70 offen offset:0 sc1
s_nop 15
s_nop 5
hl_143:
buffer_load_dword v249,v18,s[20:23],s70 offen offset:0 sc1
s_waitcnt vmcnt(1)
v_cmp_eq_u32 vcc,v25,v248
s_bcnt1_i32_b32 s64,vcc_lo
s_cmp_ge_u32 s64,8
s_cbranch_scc1 hg_144
buffer_load_dword v248,v18,s[20:23],s70 offen offset:0 sc1
s_waitcnt vmcnt(1)
v_cmp_eq_u32 vcc,v25,v249
s_bcnt1_i32_b32 s64,vcc_lo
s_cmp_ge_u32 s64,8
s_cbranch_scc1 hg_144
s_sub_u32 s90,s90,1
s_cmp_gt_i32 s90,0
s_cbranch_scc1 hl_143
hg_144:
buffer_load_dwordx4 v[80:83],v29,s[20:23],s70 offen offset:0 sc1
buffer_load_dwordx4 v[84:87],v29,s[20:23],s70 offen offset:1024 sc1
buffer_load_dwordx4 v[88:91],v29,s[20:23],s70 offen offset:2048 sc1
buffer_load_dwordx4 v[92:95],v29,s[20:23],s70 offen offset:3072 sc1
s_waitcnt vmcnt(3)
ds_write_b128 v24,v[80:83] offset:12288
v_min3_u32 v22,v80,v81,v82
v_min_u32 v22,v22,v83
s_waitcnt vmcnt(2)
ds_write_b128 v24,v[84:87] offset:13312
v_min3_u32 v22,v22,v84,v85
v_min3_u32 v22,v22,v86,v87
s_waitcnt vmcnt(1)
ds_write_b128 v24,v[88:91] offset:14336
v_min3_u32 v22,v22,v88,v89
v_min3_u32 v22,v22,v90,v91
s_waitcnt vmcnt(0)
ds_write_b128 v24,v[92:95] offset:15360
v_min3_u32 v22,v22,v92,v93
v_min3_u32 v22,v22,v94,v95
v_cmp_eq_u32 vcc,0,v22
s_cbranch_vccnz art_145
abk_146:
v_smfmac_f32_16x16x64_bf16 v[176:179],v[80:83],a[96:103],v14
s_waitcnt lgkmcnt(0)
s_barrier
ds_read_b128 v[32:35],v24 offset:0
ds_read_b128 v[36:39],v24 offset:1024
ds_read_b128 v[40:43],v24 offset:2048
ds_read_b128 v[44:47],v24 offset:3072
v_smfmac_f32_16x16x64_bf16 v[176:179],v[84:87],a[104:111],v14
ds_read_b128 v[48:51],v24 offset:4096
ds_read_b128 v[52:55],v24 offset:5120
v_smfmac_f32_16x16x64_bf16 v[176:179],v[88:91],a[112:119],v14
ds_read_b128 v[56:59],v24 offset:6144
ds_read_b128 v[60:63],v24 offset:7168
v_smfmac_f32_16x16x64_bf16 v[176:179],v[92:95],a[120:127],v14
ds_read_b128 v[64:67],v24 offset:8192
ds_read_b128 v[68:71],v24 offset:9216
s_waitcnt lgkmcnt(9)
v_smfmac_f32_16x16x64_bf16 v[176:179],v[32:35],a[0:7],v14
ds_read_b128 v[72:75],v24 offset:10240
s_waitcnt lgkmcnt(9)
v_smfmac_f32_16x16x64_bf16 v[176:179],v[36:39],a[8:15],v14
ds_read_b128 v[76:79],v24 offset:11264
s_waitcnt lgkmcnt(9)
v_smfmac_f32_16x16x64_bf16 v[176:179],v[40:43],a[16:23],v14
s_waitcnt lgkmcnt(8)
v_smfmac_f32_16x16x64_bf16 v[176:179],v[44:47],a[24:31],v14
s_waitcnt lgkmcnt(7)
v_smfmac_f32_16x16x64_bf16 v[176:179],v[48:51],a[32:39],v14
s_waitcnt lgkmcnt(6)
v_smfmac_f32_16x16x64_bf16 v[176:179],v[52:55],a[40:47],v14
s_waitcnt lgkmcnt(5)
v_smfmac_f32_16x16x64_bf16 v[176:179],v[56:59],a[48:55],v14
s_waitcnt lgkmcnt(4)
v_smfmac_f32_16x16x64_bf16 v[176:179],v[60:63],a[56:63],v14
s_waitcnt lgkmcnt(3)
v_smfmac_f32_16x16x64_bf16 v[176:179],v[64:67],a[64:71],v14
s_waitcnt lgkmcnt(2)
v_smfmac_f32_16x16x64_bf16 v[176:179],v[68:71],a[72:79],v14
s_waitcnt lgkmcnt(1)
v_smfmac_f32_16x16x64_bf16 v[176:179],v[72:75],a[80:87],v14
s_waitcnt lgkmcnt(0)
v_smfmac_f32_16x16x64_bf16 v[176:179],v[76:79],a[88:95],v14
s_nop 7
v_permlane32_swap_b32 v176,v178
v_permlane32_swap_b32 v177,v179
v_add_f32 v176,v176,v178
v_add_f32 v177,v177,v179
v_cvt_pk_bf16_f32 v216,v176,v177
s_nop 1
v_mov_b32_dpp v217,v216 quad_perm:[1,0,3,2] row_mask:0xf bank_mask:0xf
v_perm_b32 v216,v217,v216,v15
v_max_u32 v216,1,v216
buffer_store_dword v216,v19,s[24:27],s70 offen
buffer_store_dword v216,v19,s[28:31],s70 offen sc1
s_cmp_eq_u32 s79,63
s_cbranch_scc1 end_58
s_nop 15
s_nop 15
s_nop 15
s_nop 15
s_nop 10
s_add_u32 m0,s62,53248
s_add_u32 s69,s78,53248
buffer_load_dwordx4 v16,s[20:23],s69 offen offset:0 lds
s_nop 3
buffer_load_dwordx4 v16,s[20:23],s69 offen offset:1024 lds
s_nop 3
buffer_load_dwordx4 v16,s[20:23],s69 offen offset:2048 lds
s_nop 3
buffer_load_dwordx4 v16,s[20:23],s69 offen offset:3072 lds
s_nop 3
s_add_u32 m0,s62,57344
s_add_u32 s69,s78,57344
buffer_load_dwordx4 v16,s[20:23],s69 offen offset:0 lds
s_nop 3
buffer_load_dwordx4 v16,s[20:23],s69 offen offset:1024 lds
s_nop 3
buffer_load_dwordx4 v16,s[20:23],s69 offen offset:2048 lds
s_nop 3
buffer_load_dwordx4 v16,s[20:23],s69 offen offset:3072 lds
s_nop 3
s_add_u32 m0,s62,61440
s_add_u32 s69,s78,61440
buffer_load_dwordx4 v16,s[20:23],s69 offen offset:0 lds
s_nop 3
buffer_load_dwordx4 v16,s[20:23],s69 offen offset:1024 lds
s_nop 3
buffer_load_dwordx4 v16,s[20:23],s69 offen offset:2048 lds
s_nop 3
buffer_load_dwordx4 v16,s[20:23],s69 offen offset:3072 lds
s_nop 3
s_xor_b32 s62,s62,0x10000
wf_147:
ds_read_b32 v23,v21 offset:8
s_sub_u32 s90,s90,1
s_waitcnt lgkmcnt(0)
v_cmp_ne_u32 vcc,v23,v25
s_cmp_lt_i32 s90,0
s_cselect_b64 vcc,0,vcc
s_cbranch_vccnz wf_147
hl_148:
buffer_load_dword v248,v18,s[20:23],s70 offen offset:512 sc1
s_waitcnt vmcnt(0)
v_cmp_eq_u32 vcc,v25,v248
s_bcnt1_i32_b32 s64,vcc_lo
s_cmp_ge_u32 s64,16
s_cbranch_scc1 hg_149
s_sub_u32 s90,s90,1
s_cmp_gt_i32 s90,0
s_cbranch_scc1 hl_148
hg_149:
buffer_load_dwordx4 v[32:35],v28,s[20:23],s71 offen offset:0 sc1
buffer_load_dwordx4 v[36:39],v28,s[20:23],s71 offen offset:1024 sc1
buffer_load_dwordx4 v[40:43],v28,s[20:23],s71 offen offset:2048 sc1
buffer_load_dwordx4 v[44:47],v28,s[20:23],s71 offen offset:3072 sc1
buffer_load_dwordx4 v[48:51],v29,s[20:23],s71 offen offset:0 sc1
buffer_load_dwordx4 v[52:55],v29,s[20:23],s71 offen offset:1024 sc1
buffer_load_dwordx4 v[56:59],v29,s[20:23],s71 offen offset:2048 sc1
buffer_load_dwordx4 v[60:63],v29,s[20:23],s71 offen offset:3072 sc1
s_mov_b32 s68,0
s_waitcnt vmcnt(6)
v_smfmac_f32_16x16x64_bf16 v[184:187],v[32:35],a[128:135],v14
v_min3_u32 v22,v32,v33,v34
v_min3_u32 v22,v22,v35,v36
v_smfmac_f32_16x16x64_bf16 v[188:191],v[32:35],a[136:143],v14
v_min3_u32 v22,v22,v37,v38
v_smfmac_f32_16x16x64_bf16 v[184:187],v[36:39],a[144:151],v14
v_min_u32 v22,v22,v39
v_smfmac_f32_16x16x64_bf16 v[188:191],v[36:39],a[152:159],v14
v_cmp_eq_u32 s[52:53],0,v22
s_waitcnt vmcnt(4)
v_smfmac_f32_16x16x64_bf16 v[184:187],v[40:43],a[160:167],v14
v_min3_u32 v22,v40,v41,v42
s_cmp_lg_u64 s[52:53],0
v_smfmac_f32_16x16x64_bf16 v[188:191],v[40:43],a[168:175],v14
s_cbranch_scc1 ms_150
bk_151:
v_min3_u32 v22,v22,v43,v44
v_smfmac_f32_16x16x64_bf16 v[184:187],v[44:47],a[176:183],v14
v_min3_u32 v22,v22,v45,v46
v_min_u32 v22,v22,v47
v_smfmac_f32_16x16x64_bf16 v[188:191],v[44:47],a[184:191],v14
v_cmp_eq_u32 s[54:55],0,v22
s_waitcnt vmcnt(2)
v_smfmac_f32_16x16x64_bf16 v[184:187],v[48:51],a[192:199],v14
v_min3_u32 v22,v48,v49,v50
s_cmp_lg_u64 s[54:55],0
v_smfmac_f32_16x16x64_bf16 v[188:191],v[48:51],a[200:207],v14
s_cbranch_scc1 ms_152
bk_153:
v_min3_u32 v22,v22,v51,v52
v_smfmac_f32_16x16x64_bf16 v[184:187],v[52:55],a[208:215],v14
v_min3_u32 v22,v22,v53,v54
v_min_u32 v22,v22,v55
v_smfmac_f32_16x16x64_bf16 v[188:191],v[52:55],a[216:223],v14
v_cmp_eq_u32 s[52:53],0,v22
s_waitcnt vmcnt(0)
v_smfmac_f32_16x16x64_bf16 v[184:187],v[56:59],a[224:231],v14
v_min3_u32 v22,v56,v57,v58
s_cmp_lg_u64 s[52:53],0
v_smfmac_f32_16x16x64_bf16 v[188:191],v[56:59],a[232:239],v14
s_cbranch_scc1 ms_154
bk_155:
v_min3_u32 v22,v22,v59,v60
v_smfmac_f32_16x16x64_bf16 v[184:187],v[60:63],a[240:247],v14
v_min3_u32 v22,v22,v61,v62
v_min_u32 v22,v22,v63
v_smfmac_f32_16x16x64_bf16 v[188:191],v[60:63],a[248:255],v14
v_cmp_eq_u32 s[54:55],0,v22
s_cmp_lg_u64 s[54:55],0
s_cbranch_scc1 ms_158
bk_159:
s_cmp_lg_u32 s68,0
s_cbranch_scc1 rl2_160
fin_156:
s_nop 2
v_permlane32_swap_b32 v184,v188
v_permlane32_swap_b32 v185,v189
v_permlane32_swap_b32 v186,v190
v_permlane32_swap_b32 v187,v191
v_pk_add_f32 v[184:185],v[184:185],v[188:189]
v_pk_add_f32 v[186:187],v[186:187],v[190:191]
wf_161:
ds_read_b32 v23,v21 offset:12
ds_read_b128 v[216:219],v24 offset:25600
s_sub_u32 s90,s90,1
s_waitcnt lgkmcnt(0)
v_cmp_ne_u32 vcc,v23,v25
s_cmp_lt_i32 s90,0
s_cselect_b64 vcc,0,vcc
v_pk_add_f32 v[216:217],v[216:217],v[184:185]
v_pk_add_f32 v[218:219],v[218:219],v[186:187]
s_cbranch_vccnz wf_161
v_max_u32 v216,1,v216
v_max_u32 v217,1,v217
v_max_u32 v218,1,v218
v_max_u32 v219,1,v219
buffer_store_dwordx4 v[216:219],v8,s[20:23],s74 offen sc1
s_mov_b32 s88,s74
s_mov_b32 s89,s72
v_add_u32 v25,1,v25
s_add_u32 s63,s79,1
s_and_b32 s64,s63,3
s_lshl_b32 s70,s64,20
s_add_u32 s65,s63,2
s_and_b32 s65,s65,3
s_lshl_b32 s73,s65,20
s_add_u32 s55,s63,3
s_lshl_b32 s78,s55,16
s_add_u32 s78,s78,57344
s_cmp_lt_u32 s55,64
s_cselect_b32 s78,s78,0x7fff0000
s_add_u32 s71,s70,65536
s_add_u32 s60,s63,1
s_and_b32 s60,s60,3
s_lshl_b32 s72,s60,20
v_mov_b32 v184,0
v_mov_b32 v185,0
v_mov_b32 v186,0
v_mov_b32 v187,0
v_mov_b32 v188,0
v_mov_b32 v189,0
v_mov_b32 v190,0
v_mov_b32 v191,0
s_lshl_b32 s74,s63,21
s_lshl_b32 s55,s63,13
s_and_b32 s55,s55,0x2000
s_xor_b32 s55,s55,s61
s_add_u32 s74,s74,s55
v_mov_b32 v176,0
v_mov_b32 v177,0
v_mov_b32 v178,0
v_mov_b32 v179,0
s_nop 15
s_nop 15
s_nop 15
s_nop 15
s_nop 5
pp_162:
buffer_load_dwordx4 v[32:35],v9,s[20:23],s88 offen sc1
buffer_load_dwordx4 v[36:39],v10,s[20:23],s88 offen sc1
buffer_load_dwordx4 v[40:43],v11,s[20:23],s88 offen sc1
s_waitcnt vmcnt(2)
v_min3_u32 v22,v32,v33,v34
v_pk_add_f32 v[220:221],v[216:217],v[32:33]
v_pk_add_f32 v[222:223],v[218:219],v[34:35]
s_waitcnt vmcnt(0)
v_min3_u32 v22,v22,v35,v36
v_min3_u32 v22,v22,v37,v38
v_min3_u32 v22,v22,v39,v40
v_min3_u32 v22,v22,v41,v42
v_min_u32 v22,v22,v43
v_pk_add_f32 v[36:37],v[36:37],v[40:41]
v_cmp_eq_u32 vcc,0,v22
v_pk_add_f32 v[38:39],v[38:39],v[42:43]
s_cbranch_vccz pok_163
s_sub_u32 s90,s90,1
s_cmp_gt_i32 s90,0
s_cbranch_scc1 pp_162
pok_163:
v_pk_add_f32 v[220:221],v[220:221],v[36:37]
v_pk_add_f32 v[222:223],v[222:223],v[38:39]
s_mov_b64 vcc,s[86:87]
v_cvt_pk_bf16_f32 v216,v220,v221
v_cvt_pk_bf16_f32 v217,v222,v223
s_nop 0
v_mov_b32_dpp v218,v216 quad_perm:[1,0,3,2] row_mask:0xf bank_mask:0xf
v_mov_b32_dpp v219,v217 quad_perm:[1,0,3,2] row_mask:0xf bank_mask:0xf
v_perm_b32 v216,v218,v216,v15
v_perm_b32 v217,v219,v217,v15
s_nop 1
v_cndmask_b32_dpp v220,v217,v216,vcc quad_perm:[2,3,0,1] row_mask:0xf bank_mask:0xf
s_not_b64 vcc,vcc
v_cndmask_b32_dpp v221,v216,v217,vcc quad_perm:[2,3,0,1] row_mask:0xf bank_mask:0xf
v_max_u32 v220,1,v220
v_max_u32 v221,1,v221
buffer_store_dwordx2 v[220:221],v30,s[24:27],s89 offen
buffer_store_dwordx2 v[220:221],v30,s[28:31],s89 offen sc1
s_mov_b64 exec,1
buffer_store_dword v25,v13,s[24:27],s89 offen
buffer_store_dword v25,v13,s[28:31],s89 offen sc1
s_mov_b64 exec,-1
s_add_u32 s79,s79,1
s_branch loop_141
art_145:
s_sub_u32 s90,s90,1
s_cmp_lt_i32 s90,0
s_cbranch_scc1 abk_146
buffer_load_dwordx4 v[80:83],v29,s[20:23],s70 offen offset:0 sc1
buffer_load_dwordx4 v[84:87],v29,s[20:23],s70 offen offset:1024 sc1
buffer_load_dwordx4 v[88:91],v29,s[20:23],s70 offen offset:2048 sc1
buffer_load_dwordx4 v[92:95],v29,s[20:23],s70 offen offset:3072 sc1
s_waitcnt vmcnt(3)
ds_write_b128 v24,v[80:83] offset:12288
v_min3_u32 v22,v80,v81,v82
v_min_u32 v22,v22,v83
s_waitcnt vmcnt(2)
ds_write_b128 v24,v[84:87] offset:13312
v_min3_u32 v22,v22,v84,v85
v_min3_u32 v22,v22,v86,v87
s_waitcnt vmcnt(1)
ds_write_b128 v24,v[88:91] offset:14336
v_min3_u32 v22,v22,v88,v89
v_min3_u32 v22,v22,v90,v91
s_waitcnt vmcnt(0)
ds_write_b128 v24,v[92:95] offset:15360
v_min3_u32 v22,v22,v92,v93
v_min3_u32 v22,v22,v94,v95
v_cmp_eq_u32 vcc,0,v22
s_cbranch_vccnz art_145
s_branch abk_146
ms_150:
s_waitcnt vmcnt(0)
buffer_load_dwordx4 v[64:67],v28,s[20:23],s71 offen offset:0 sc1
buffer_load_dwordx4 v[68:71],v28,s[20:23],s71 offen offset:1024 sc1
s_bitset1_b32 s68,0
s_branch bk_151
ms_152:
s_waitcnt vmcnt(0)
buffer_load_dwordx4 v[72:75],v28,s[20:23],s71 offen offset:2048 sc1
buffer_load_dwordx4 v[76:79],v28,s[20:23],s71 offen offset:3072 sc1
s_bitset1_b32 s68,1
s_branch bk_153
ms_154:
s_waitcnt vmcnt(0)
buffer_load_dwordx4 v[80:83],v29,s[20:23],s71 offen offset:0 sc1
buffer_load_dwordx4 v[84:87],v29,s[20:23],s71 offen offset:1024 sc1
s_bitset1_b32 s68,2
s_branch bk_155
ms_158:
s_waitcnt vmcnt(0)
buffer_load_dwordx4 v[88:91],v29,s[20:23],s71 offen offset:2048 sc1
buffer_load_dwordx4 v[92:95],v29,s[20:23],s71 offen offset:3072 sc1
s_bitset1_b32 s68,3
s_branch bk_159
rl_157:
s_bitcmp1_b32 s68,0
s_cbranch_scc0 sk_164
buffer_load_dwordx4 v[64:67],v28,s[20:23],s71 offen offset:0 sc1
buffer_load_dwordx4 v[68:71],v28,s[20:23],s71 offen offset:1024 sc1
sk_164:
s_bitcmp1_b32 s68,1
s_cbranch_scc0 sk_165
buffer_load_dwordx4 v[72:75],v28,s[20:23],s71 offen offset:2048 sc1
buffer_load_dwordx4 v[76:79],v28,s[20:23],s71 offen offset:3072 sc1
sk_165:
s_bitcmp1_b32 s68,2
s_cbranch_scc0 sk_166
buffer_load_dwordx4 v[80:83],v29,s[20:23],s71 offen offset:0 sc1
buffer_load_dwordx4 v[84:87],v29,s[20:23],s71 offen offset:1024 sc1
sk_166:
s_bitcmp1_b32 s68,3
s_cbranch_scc0 sk_167
buffer_load_dwordx4 v[88:91],v29,s[20:23],s71 offen offset:2048 sc1
buffer_load_dwordx4 v[92:95],v29,s[20:23],s71 offen offset:3072 sc1
sk_167:
rl2_160:
s_sub_u32 s90,s90,1
s_cmp_lt_i32 s90,0
s_cbranch_scc1 fin_156
s_waitcnt vmcnt(0)
s_bitcmp1_b32 s68,0
s_cbranch_scc0 sk_168
v_min3_u32 v22,v64,v65,v66
v_min3_u32 v22,v22,v67,v68
v_min3_u32 v22,v22,v69,v70
v_min_u32 v22,v22,v71
v_cmp_eq_u32 vcc,0,v22
v_xor_b32 v64,v32,v64
v_xor_b32 v65,v33,v65
v_xor_b32 v66,v34,v66
v_xor_b32 v67,v35,v67
v_xor_b32 v68,v36,v68
v_xor_b32 v69,v37,v69
v_xor_b32 v70,v38,v70
v_xor_b32 v71,v39,v71
s_cbranch_vccnz nb_169
s_bitset0_b32 s68,0
v_smfmac_f32_16x16x64_bf16 v[184:187],v[64:67],a[128:135],v14
v_smfmac_f32_16x16x64_bf16 v[188:191],v[64:67],a[136:143],v14
v_smfmac_f32_16x16x64_bf16 v[184:187],v[68:71],a[144:151],v14
v_smfmac_f32_16x16x64_bf16 v[188:191],v[68:71],a[152:159],v14
nb_169:
sk_168:
s_bitcmp1_b32 s68,1
s_cbranch_scc0 sk_170
v_min3_u32 v22,v72,v73,v74
v_min3_u32 v22,v22,v75,v76
v_min3_u32 v22,v22,v77,v78
v_min_u32 v22,v22,v79
v_cmp_eq_u32 vcc,0,v22
v_xor_b32 v72,v40,v72
v_xor_b32 v73,v41,v73
v_xor_b32 v74,v42,v74
v_xor_b32 v75,v43,v75
v_xor_b32 v76,v44,v76
v_xor_b32 v77,v45,v77
v_xor_b32 v78,v46,v78
v_xor_b32 v79,v47,v79
s_cbranch_vccnz nb_171
s_bitset0_b32 s68,1
v_smfmac_f32_16x16x64_bf16 v[184:187],v[72:75],a[160:167],v14
v_smfmac_f32_16x16x64_bf16 v[188:191],v[72:75],a[168:175],v14
v_smfmac_f32_16x16x64_bf16 v[184:187],v[76:79],a[176:183],v14
v_smfmac_f32_16x16x64_bf16 v[188:191],v[76:79],a[184:191],v14
nb_171:
sk_170:
s_bitcmp1_b32 s68,2
s_cbranch_scc0 sk_172
v_min3_u32 v22,v80,v81,v82
v_min3_u32 v22,v22,v83,v84
v_min3_u32 v22,v22,v85,v86
v_min_u32 v22,v22,v87
v_cmp_eq_u32 vcc,0,v22
v_xor_b32 v80,v48,v80
v_xor_b32 v81,v49,v81
v_xor_b32 v82,v50,v82
v_xor_b32 v83,v51,v83
v_xor_b32 v84,v52,v84
v_xor_b32 v85,v53,v85
v_xor_b32 v86,v54,v86
v_xor_b32 v87,v55,v87
s_cbranch_vccnz nb_173
s_bitset0_b32 s68,2
v_smfmac_f32_16x16x64_bf16 v[184:187],v[80:83],a[192:199],v14
v_smfmac_f32_16x16x64_bf16 v[188:191],v[80:83],a[200:207],v14
v_smfmac_f32_16x16x64_bf16 v[184:187],v[84:87],a[208:215],v14
v_smfmac_f32_16x16x64_bf16 v[188:191],v[84:87],a[216:223],v14
nb_173:
sk_172:
s_bitcmp1_b32 s68,3
s_cbranch_scc0 sk_174
v_min3_u32 v22,v88,v89,v90
v_min3_u32 v22,v22,v91,v92
v_min3_u32 v22,v22,v93,v94
v_min_u32 v22,v22,v95
v_cmp_eq_u32 vcc,0,v22
v_xor_b32 v88,v56,v88
v_xor_b32 v89,v57,v89
v_xor_b32 v90,v58,v90
v_xor_b32 v91,v59,v91
v_xor_b32 v92,v60,v92
v_xor_b32 v93,v61,v93
v_xor_b32 v94,v62,v94
v_xor_b32 v95,v63,v95
s_cbranch_vccnz nb_175
s_bitset0_b32 s68,3
v_smfmac_f32_16x16x64_bf16 v[184:187],v[88:91],a[224:231],v14
v_smfmac_f32_16x16x64_bf16 v[188:191],v[88:91],a[232:239],v14
v_smfmac_f32_16x16x64_bf16 v[184:187],v[92:95],a[240:247],v14
v_smfmac_f32_16x16x64_bf16 v[188:191],v[92:95],a[248:255],v14
nb_175:
sk_174:
s_cmp_lg_u32 s68,0
s_cbranch_scc1 rl_157
s_nop 2
s_branch fin_156
first_140:
s_waitcnt vmcnt(0) lgkmcnt(0)
s_barrier
s_mov_b32 m0,98304
s_mov_b32 s65,155648
buffer_load_dwordx4 v16,s[20:23],s65 offen offset:0 lds
buffer_load_dwordx4 v16,s[20:23],s65 offen offset:1024 lds
buffer_load_dwordx4 v16,s[20:23],s65 offen offset:2048 lds
buffer_load_dwordx4 v16,s[20:23],s65 offen offset:3072 lds
s_mov_b32 m0,102400
s_mov_b32 s65,159744
buffer_load_dwordx4 v16,s[20:23],s65 offen offset:0 lds
buffer_load_dwordx4 v16,s[20:23],s65 offen offset:1024 lds
buffer_load_dwordx4 v16,s[20:23],s65 offen offset:2048 lds
buffer_load_dwordx4 v16,s[20:23],s65 offen offset:3072 lds
s_mov_b32 m0,106496
s_mov_b32 s65,163840
buffer_load_dwordx4 v16,s[20:23],s65 offen offset:0 lds
buffer_load_dwordx4 v16,s[20:23],s65 offen offset:1024 lds
buffer_load_dwordx4 v16,s[20:23],s65 offen offset:2048 lds
buffer_load_dwordx4 v16,s[20:23],s65 offen offset:3072 lds
s_mov_b32 m0,110592
s_mov_b32 s65,167936
buffer_load_dwordx4 v16,s[20:23],s65 offen offset:0 lds
buffer_load_dwordx4 v16,s[20:23],s65 offen offset:1024 lds
buffer_load_dwordx4 v16,s[20:23],s65 offen offset:2048 lds
buffer_load_dwordx4 v16,s[20:23],s65 offen offset:3072 lds
s_mov_b32 m0,114688
s_mov_b32 s65,172032
buffer_load_dwordx4 v16,s[20:23],s65 offen offset:0 lds
buffer_load_dwordx4 v16,s[20:23],s65 offen offset:1024 lds
buffer_load_dwordx4 v16,s[20:23],s65 offen offset:2048 lds
buffer_load_dwordx4 v16,s[20:23],s65 offen offset:3072 lds
s_mov_b32 m0,118784
s_mov_b32 s65,176128
buffer_load_dwordx4 v16,s[20:23],s65 offen offset:0 lds
buffer_load_dwordx4 v16,s[20:23],s65 offen offset:1024 lds
buffer_load_dwordx4 v16,s[20:23],s65 offen offset:2048 lds
buffer_load_dwordx4 v16,s[20:23],s65 offen offset:3072 lds
s_mov_b32 m0,122880
s_mov_b32 s65,180224
buffer_load_dwordx4 v16,s[20:23],s65 offen offset:0 lds
buffer_load_dwordx4 v16,s[20:23],s65 offen offset:1024 lds
buffer_load_dwordx4 v16,s[20:23],s65 offen offset:2048 lds
buffer_load_dwordx4 v16,s[20:23],s65 offen offset:3072 lds
s_mov_b32 m0,126976
s_mov_b32 s65,184320
buffer_load_dwordx4 v16,s[20:23],s65 offen offset:0 lds
buffer_load_dwordx4 v16,s[20:23],s65 offen offset:1024 lds
buffer_load_dwordx4 v16,s[20:23],s65 offen offset:2048 lds
buffer_load_dwordx4 v16,s[20:23],s65 offen offset:3072 lds
s_xor_b32 s64,s61,10493952
buffer_store_dwordx4 v[100:103],v206,s[20:23],s64 offen sc1
buffer_store_dwordx4 v[100:103],v207,s[20:23],s64 offen sc1
s_xor_b32 s64,s61,12582912
buffer_store_dwordx4 v[100:103],v206,s[20:23],s64 offen sc1
buffer_store_dwordx4 v[100:103],v207,s[20:23],s64 offen sc1
s_xor_b32 s64,s61,14688256
buffer_store_dwordx4 v[100:103],v206,s[20:23],s64 offen sc1
buffer_store_dwordx4 v[100:103],v207,s[20:23],s64 offen sc1
s_waitcnt vmcnt(6)
s_barrier
s_mov_b32 m0,32768
s_mov_b32 s65,221184
buffer_load_dwordx4 v16,s[20:23],s65 offen offset:0 lds
buffer_load_dwordx4 v16,s[20:23],s65 offen offset:1024 lds
buffer_load_dwordx4 v16,s[20:23],s65 offen offset:2048 lds
buffer_load_dwordx4 v16,s[20:23],s65 offen offset:3072 lds
s_mov_b32 m0,36864
s_mov_b32 s65,225280
buffer_load_dwordx4 v16,s[20:23],s65 offen offset:0 lds
buffer_load_dwordx4 v16,s[20:23],s65 offen offset:1024 lds
buffer_load_dwordx4 v16,s[20:23],s65 offen offset:2048 lds
buffer_load_dwordx4 v16,s[20:23],s65 offen offset:3072 lds
s_mov_b32 m0,40960
s_mov_b32 s65,229376
buffer_load_dwordx4 v16,s[20:23],s65 offen offset:0 lds
buffer_load_dwordx4 v16,s[20:23],s65 offen offset:1024 lds
buffer_load_dwordx4 v16,s[20:23],s65 offen offset:2048 lds
buffer_load_dwordx4 v16,s[20:23],s65 offen offset:3072 lds
s_mov_b32 m0,45056
s_mov_b32 s65,233472
buffer_load_dwordx4 v16,s[20:23],s65 offen offset:0 lds
buffer_load_dwordx4 v16,s[20:23],s65 offen offset:1024 lds
buffer_load_dwordx4 v16,s[20:23],s65 offen offset:2048 lds
buffer_load_dwordx4 v16,s[20:23],s65 offen offset:3072 lds
s_mov_b32 m0,49152
s_mov_b32 s65,237568
buffer_load_dwordx4 v16,s[20:23],s65 offen offset:0 lds
buffer_load_dwordx4 v16,s[20:23],s65 offen offset:1024 lds
buffer_load_dwordx4 v16,s[20:23],s65 offen offset:2048 lds
buffer_load_dwordx4 v16,s[20:23],s65 offen offset:3072 lds
s_mov_b32 m0,53248
s_mov_b32 s65,241664
buffer_load_dwordx4 v16,s[20:23],s65 offen offset:0 lds
buffer_load_dwordx4 v16,s[20:23],s65 offen offset:1024 lds
buffer_load_dwordx4 v16,s[20:23],s65 offen offset:2048 lds
buffer_load_dwordx4 v16,s[20:23],s65 offen offset:3072 lds
s_mov_b32 m0,57344
s_mov_b32 s65,245760
buffer_load_dwordx4 v16,s[20:23],s65 offen offset:0 lds
buffer_load_dwordx4 v16,s[20:23],s65 offen offset:1024 lds
buffer_load_dwordx4 v16,s[20:23],s65 offen offset:2048 lds
buffer_load_dwordx4 v16,s[20:23],s65 offen offset:3072 lds
s_mov_b32 m0,61440
s_mov_b32 s65,249856
buffer_load_dwordx4 v16,s[20:23],s65 offen offset:0 lds
buffer_load_dwordx4 v16,s[20:23],s65 offen offset:1024 lds
buffer_load_dwordx4 v16,s[20:23],s65 offen offset:2048 lds
buffer_load_dwordx4 v16,s[20:23],s65 offen offset:3072 lds
s_mov_b32 s79,0
s_add_u32 s63,s79,0
s_and_b32 s64,s63,3
s_lshl_b32 s70,s64,20
s_add_u32 s65,s63,2
s_and_b32 s65,s65,3
s_lshl_b32 s73,s65,20
s_add_u32 s55,s63,3
s_lshl_b32 s78,s55,16
s_add_u32 s78,s78,57344
s_cmp_lt_u32 s55,64
s_cselect_b32 s78,s78,0x7fff0000
s_add_u32 s71,s70,65536
s_add_u32 s60,s63,1
s_and_b32 s60,s60,3
s_lshl_b32 s72,s60,20
v_mov_b32 v184,0
v_mov_b32 v185,0
v_mov_b32 v186,0
v_mov_b32 v187,0
v_mov_b32 v188,0
v_mov_b32 v189,0
v_mov_b32 v190,0
v_mov_b32 v191,0
s_lshl_b32 s74,s63,21
s_lshl_b32 s55,s63,13
s_and_b32 s55,s55,0x2000
s_xor_b32 s55,s55,s61
s_add_u32 s74,s74,s55
v_mov_b32 v176,0
v_mov_b32 v177,0
v_mov_b32 v178,0
v_mov_b32 v179,0
v_mov_b32 v25,1
s_waitcnt vmcnt(0) lgkmcnt(0)
s_barrier
v_max_u32 v216,1,v216
v_max_u32 v217,1,v217
v_max_u32 v218,1,v218
v_max_u32 v219,1,v219
s_mov_b64 exec,s[84:85]
buffer_store_dwordx4 v[216:219],v12,s[24:27],s70 offen
buffer_store_dwordx4 v[216:219],v12,s[28:31],s70 offen sc1
s_mov_b64 exec,1
buffer_store_dword v25,v13,s[24:27],s70 offen
buffer_store_dword v25,v13,s[28:31],s70 offen sc1
s_mov_b64 exec,-1
s_branch loop_141
end_58:
s_waitcnt vmcnt(0)
s_barrier
s_mov_b32 s50,s91
done_1:
s_endpgm
pipe_worker:
v_and_b32 v1,63,v0
v_and_b32 v3,15,v1
v_lshrrev_b32 v4,4,v1
v_lshlrev_b32 v16,4,v1
v_mov_b32 v48,0
v_mov_b32 v49,0
v_mov_b32 v50,0
v_mov_b32 v51,0
s_lshr_b32 s58,s55,5
s_and_b32 s59,s55,31
s_xor_b32 s62,s61,0x2000
s_add_u32 s63,s62,21053440
s_load_dwordx2 s[4:5],s[0:1],16
v_lshlrev_b32 v5,4,v0
s_lshl_b32 s64,s55,14
s_add_u32 s64,s64,17825792
buffer_store_dwordx4 v[48:51],v5,s[20:23],s64 offen sc1
s_add_u32 s64,s64,4096
buffer_store_dwordx4 v[48:51],v5,s[20:23],s64 offen sc1
s_add_u32 s64,s64,4096
buffer_store_dwordx4 v[48:51],v5,s[20:23],s64 offen sc1
s_add_u32 s64,s64,4096
buffer_store_dwordx4 v[48:51],v5,s[20:23],s64 offen sc1
s_add_u32 s64,s64,4096
s_lshl_b32 s64,s55,12
s_add_u32 s64,s64,8577024
buffer_store_dwordx4 v[48:51],v5,s[20:23],s64 offen sc1
s_lshr_b32 s79,s55,5
s_add_u32 s64,s79,8
s_lshl_b32 s93,s64,21
s_lshl_b32 s64,s64,13
s_and_b32 s64,s64,0x2000
s_xor_b32 s64,s64,s61
s_add_u32 s93,s93,s64
s_add_u32 s93,s93,29360128
s_and_b32 s64,s55,31
s_add_u32 s64,s64,96
s_lshl_b32 s64,s64,14
s_add_u32 s93,s93,s64
s_waitcnt lgkmcnt(0)
s_mov_b32 s32,s4
s_and_b32 s33,s5,0xffff
s_mov_b32 s34,0x800000
s_mov_b32 s35,0x20000
v_lshrrev_b32 v5,3,v3
v_bfe_u32 v6,v3,2,1
v_lshl_add_u32 v7,v5,3,v6
v_lshl_add_u32 v6,v5,2,v6
v_lshrrev_b32 v5,1,v4
v_lshl_add_u32 v7,v5,4,v7
v_and_b32 v5,1,v4
v_lshl_add_u32 v7,v5,2,v7
v_lshl_add_u32 v6,v5,1,v6
v_bfe_u32 v5,v3,1,1
s_lshl_b32 s64,s50,1
v_add_u32 v5,s64,v5
v_xor_b32 v5,v5,v6
v_lshlrev_b32 v5,5,v5
v_lshl_add_u32 v5,v7,8,v5
v_and_b32 v6,1,v3
v_lshl_add_u32 v12,v6,4,v5
s_lshl_b32 s66,s59,8
v_and_b32 v5,15,v1
v_and_b32 v6,1,v4
v_lshlrev_b32 v6,1,v6
v_xor_b32 v5,v5,v6
v_mul_u32_u24 v6,8192,v4
v_xor_b32 v7,0,v5
v_lshl_add_u32 v8,v7,4,v6
v_xor_b32 v7,4,v5
v_lshl_add_u32 v9,v7,4,v6
v_xor_b32 v7,8,v5
v_lshl_add_u32 v10,v7,4,v6
v_xor_b32 v7,12,v5
v_lshl_add_u32 v11,v7,4,v6
s_mul_i32 s74,s50,524288
s_add_u32 s74,s74,s66
s_lshl_b32 s75,s50,14
s_mul_i32 s76,s50,262144
s_add_u32 s76,s76,s66
s_lshl_b32 s77,s50,13
s_add_u32 s64,s74,0
s_add_u32 m0,s75,0
s_nop 0
buffer_load_dwordx4 v8,s[32:35],s64 offen nt lds
s_add_u32 s64,s74,32768
s_add_u32 m0,s75,1024
s_nop 0
buffer_load_dwordx4 v9,s[32:35],s64 offen nt lds
s_add_u32 s64,s74,65536
s_add_u32 m0,s75,2048
s_nop 0
buffer_load_dwordx4 v10,s[32:35],s64 offen nt lds
s_add_u32 s64,s74,98304
s_add_u32 m0,s75,3072
s_nop 0
buffer_load_dwordx4 v11,s[32:35],s64 offen nt lds
s_add_u32 s64,s74,131072
s_add_u32 m0,s75,4096
s_nop 0
buffer_load_dwordx4 v8,s[32:35],s64 offen nt lds
s_add_u32 s64,s74,163840
s_add_u32 m0,s75,5120
s_nop 0
buffer_load_dwordx4 v9,s[32:35],s64 offen nt lds
s_add_u32 s64,s74,196608
s_add_u32 m0,s75,6144
s_nop 0
buffer_load_dwordx4 v10,s[32:35],s64 offen nt lds
s_add_u32 s64,s74,229376
s_add_u32 m0,s75,7168
s_nop 0
buffer_load_dwordx4 v11,s[32:35],s64 offen nt lds
s_add_u32 s64,s74,262144
s_add_u32 m0,s75,8192
s_nop 0
buffer_load_dwordx4 v8,s[32:35],s64 offen nt lds
s_add_u32 s64,s74,294912
s_add_u32 m0,s75,9216
s_nop 0
buffer_load_dwordx4 v9,s[32:35],s64 offen nt lds
s_add_u32 s64,s74,327680
s_add_u32 m0,s75,10240
s_nop 0
buffer_load_dwordx4 v10,s[32:35],s64 offen nt lds
s_add_u32 s64,s74,360448
s_add_u32 m0,s75,11264
s_nop 0
buffer_load_dwordx4 v11,s[32:35],s64 offen nt lds
s_add_u32 s64,s74,393216
s_add_u32 m0,s75,12288
s_nop 0
buffer_load_dwordx4 v8,s[32:35],s64 offen nt lds
s_add_u32 s64,s74,425984
s_add_u32 m0,s75,13312
s_nop 0
buffer_load_dwordx4 v9,s[32:35],s64 offen nt lds
s_add_u32 s64,s74,458752
s_add_u32 m0,s75,14336
s_nop 0
buffer_load_dwordx4 v10,s[32:35],s64 offen nt lds
s_add_u32 s64,s74,491520
s_add_u32 m0,s75,15360
s_nop 0
buffer_load_dwordx4 v11,s[32:35],s64 offen nt lds
s_add_u32 s64,s74,2097152
s_add_u32 m0,s75,65536
s_nop 0
buffer_load_dwordx4 v8,s[32:35],s64 offen nt lds
s_add_u32 s64,s74,2129920
s_add_u32 m0,s75,66560
s_nop 0
buffer_load_dwordx4 v9,s[32:35],s64 offen nt lds
s_add_u32 s64,s74,2162688
s_add_u32 m0,s75,67584
s_nop 0
buffer_load_dwordx4 v10,s[32:35],s64 offen nt lds
s_add_u32 s64,s74,2195456
s_add_u32 m0,s75,68608
s_nop 0
buffer_load_dwordx4 v11,s[32:35],s64 offen nt lds
s_add_u32 s64,s74,2228224
s_add_u32 m0,s75,69632
s_nop 0
buffer_load_dwordx4 v8,s[32:35],s64 offen nt lds
s_add_u32 s64,s74,2260992
s_add_u32 m0,s75,70656
s_nop 0
buffer_load_dwordx4 v9,s[32:35],s64 offen nt lds
s_add_u32 s64,s74,2293760
s_add_u32 m0,s75,71680
s_nop 0
buffer_load_dwordx4 v10,s[32:35],s64 offen nt lds
s_add_u32 s64,s74,2326528
s_add_u32 m0,s75,72704
s_nop 0
buffer_load_dwordx4 v11,s[32:35],s64 offen nt lds
s_add_u32 s64,s74,2359296
s_add_u32 m0,s75,73728
s_nop 0
buffer_load_dwordx4 v8,s[32:35],s64 offen nt lds
s_add_u32 s64,s74,2392064
s_add_u32 m0,s75,74752
s_nop 0
buffer_load_dwordx4 v9,s[32:35],s64 offen nt lds
s_add_u32 s64,s74,2424832
s_add_u32 m0,s75,75776
s_nop 0
buffer_load_dwordx4 v10,s[32:35],s64 offen nt lds
s_add_u32 s64,s74,2457600
s_add_u32 m0,s75,76800
s_nop 0
buffer_load_dwordx4 v11,s[32:35],s64 offen nt lds
s_add_u32 s64,s74,2490368
s_add_u32 m0,s75,77824
s_nop 0
buffer_load_dwordx4 v8,s[32:35],s64 offen nt lds
s_add_u32 s64,s74,2523136
s_add_u32 m0,s75,78848
s_nop 0
buffer_load_dwordx4 v9,s[32:35],s64 offen nt lds
s_add_u32 s64,s74,2555904
s_add_u32 m0,s75,79872
s_nop 0
buffer_load_dwordx4 v10,s[32:35],s64 offen nt lds
s_add_u32 s64,s74,2588672
s_add_u32 m0,s75,80896
s_nop 0
buffer_load_dwordx4 v11,s[32:35],s64 offen nt lds
s_waitcnt vmcnt(16)
s_barrier
ds_read_b64_tr_b16 a[0:1],v12 offset:0
ds_read_b64_tr_b16 a[2:3],v12 offset:512
ds_read_b64_tr_b16 a[128:129],v12 offset:8
ds_read_b64_tr_b16 a[130:131],v12 offset:520
ds_read_b64_tr_b16 a[4:5],v12 offset:8192
ds_read_b64_tr_b16 a[6:7],v12 offset:8704
ds_read_b64_tr_b16 a[132:133],v12 offset:8200
ds_read_b64_tr_b16 a[134:135],v12 offset:8712
s_waitcnt lgkmcnt(4)
ds_read_b64_tr_b16 a[8:9],v12 offset:16384
ds_read_b64_tr_b16 a[10:11],v12 offset:16896
ds_read_b64_tr_b16 a[136:137],v12 offset:16392
ds_read_b64_tr_b16 a[138:139],v12 offset:16904
ds_read_b64_tr_b16 a[12:13],v12 offset:24576
ds_read_b64_tr_b16 a[14:15],v12 offset:25088
ds_read_b64_tr_b16 a[140:141],v12 offset:24584
ds_read_b64_tr_b16 a[142:143],v12 offset:25096
s_waitcnt lgkmcnt(4)
ds_read_b64_tr_b16 a[16:17],v12 offset:32768
ds_read_b64_tr_b16 a[18:19],v12 offset:33280
ds_read_b64_tr_b16 a[144:145],v12 offset:32776
ds_read_b64_tr_b16 a[146:147],v12 offset:33288
ds_read_b64_tr_b16 a[20:21],v12 offset:40960
ds_read_b64_tr_b16 a[22:23],v12 offset:41472
ds_read_b64_tr_b16 a[148:149],v12 offset:40968
ds_read_b64_tr_b16 a[150:151],v12 offset:41480
s_waitcnt lgkmcnt(4)
ds_read_b64_tr_b16 a[24:25],v12 offset:49152
ds_read_b64_tr_b16 a[26:27],v12 offset:49664
ds_read_b64_tr_b16 a[152:153],v12 offset:49160
ds_read_b64_tr_b16 a[154:155],v12 offset:49672
ds_read_b64_tr_b16 a[28:29],v12 offset:57344
ds_read_b64_tr_b16 a[30:31],v12 offset:57856
ds_read_b64_tr_b16 a[156:157],v12 offset:57352
ds_read_b64_tr_b16 a[158:159],v12 offset:57864
s_waitcnt lgkmcnt(4)
v_xor_b32 v12,0x10000,v12
s_waitcnt lgkmcnt(0)
s_barrier
s_add_u32 s64,s74,4194304
s_add_u32 m0,s75,0
s_nop 0
buffer_load_dwordx4 v8,s[32:35],s64 offen nt lds
s_add_u32 s64,s74,4227072
s_add_u32 m0,s75,1024
s_nop 0
buffer_load_dwordx4 v9,s[32:35],s64 offen nt lds
s_add_u32 s64,s74,4259840
s_add_u32 m0,s75,2048
s_nop 0
buffer_load_dwordx4 v10,s[32:35],s64 offen nt lds
s_add_u32 s64,s74,4292608
s_add_u32 m0,s75,3072
s_nop 0
buffer_load_dwordx4 v11,s[32:35],s64 offen nt lds
s_add_u32 s64,s74,4325376
s_add_u32 m0,s75,4096
s_nop 0
buffer_load_dwordx4 v8,s[32:35],s64 offen nt lds
s_add_u32 s64,s74,4358144
s_add_u32 m0,s75,5120
s_nop 0
buffer_load_dwordx4 v9,s[32:35],s64 offen nt lds
s_add_u32 s64,s74,4390912
s_add_u32 m0,s75,6144
s_nop 0
buffer_load_dwordx4 v10,s[32:35],s64 offen nt lds
s_add_u32 s64,s74,4423680
s_add_u32 m0,s75,7168
s_nop 0
buffer_load_dwordx4 v11,s[32:35],s64 offen nt lds
s_add_u32 s64,s74,4456448
s_add_u32 m0,s75,8192
s_nop 0
buffer_load_dwordx4 v8,s[32:35],s64 offen nt lds
s_add_u32 s64,s74,4489216
s_add_u32 m0,s75,9216
s_nop 0
buffer_load_dwordx4 v9,s[32:35],s64 offen nt lds
s_add_u32 s64,s74,4521984
s_add_u32 m0,s75,10240
s_nop 0
buffer_load_dwordx4 v10,s[32:35],s64 offen nt lds
s_add_u32 s64,s74,4554752
s_add_u32 m0,s75,11264
s_nop 0
buffer_load_dwordx4 v11,s[32:35],s64 offen nt lds
s_add_u32 s64,s74,4587520
s_add_u32 m0,s75,12288
s_nop 0
buffer_load_dwordx4 v8,s[32:35],s64 offen nt lds
s_add_u32 s64,s74,4620288
s_add_u32 m0,s75,13312
s_nop 0
buffer_load_dwordx4 v9,s[32:35],s64 offen nt lds
s_add_u32 s64,s74,4653056
s_add_u32 m0,s75,14336
s_nop 0
buffer_load_dwordx4 v10,s[32:35],s64 offen nt lds
s_add_u32 s64,s74,4685824
s_add_u32 m0,s75,15360
s_nop 0
buffer_load_dwordx4 v11,s[32:35],s64 offen nt lds
s_waitcnt vmcnt(16)
s_barrier
ds_read_b64_tr_b16 a[32:33],v12 offset:0
ds_read_b64_tr_b16 a[34:35],v12 offset:512
ds_read_b64_tr_b16 a[160:161],v12 offset:8
ds_read_b64_tr_b16 a[162:163],v12 offset:520
ds_read_b64_tr_b16 a[36:37],v12 offset:8192
ds_read_b64_tr_b16 a[38:39],v12 offset:8704
ds_read_b64_tr_b16 a[164:165],v12 offset:8200
ds_read_b64_tr_b16 a[166:167],v12 offset:8712
s_waitcnt lgkmcnt(4)
ds_read_b64_tr_b16 a[40:41],v12 offset:16384
ds_read_b64_tr_b16 a[42:43],v12 offset:16896
ds_read_b64_tr_b16 a[168:169],v12 offset:16392
ds_read_b64_tr_b16 a[170:171],v12 offset:16904
ds_read_b64_tr_b16 a[44:45],v12 offset:24576
ds_read_b64_tr_b16 a[46:47],v12 offset:25088
ds_read_b64_tr_b16 a[172:173],v12 offset:24584
ds_read_b64_tr_b16 a[174:175],v12 offset:25096
s_waitcnt lgkmcnt(4)
ds_read_b64_tr_b16 a[48:49],v12 offset:32768
ds_read_b64_tr_b16 a[50:51],v12 offset:33280
ds_read_b64_tr_b16 a[176:177],v12 offset:32776
ds_read_b64_tr_b16 a[178:179],v12 offset:33288
ds_read_b64_tr_b16 a[52:53],v12 offset:40960
ds_read_b64_tr_b16 a[54:55],v12 offset:41472
ds_read_b64_tr_b16 a[180:181],v12 offset:40968
ds_read_b64_tr_b16 a[182:183],v12 offset:41480
s_waitcnt lgkmcnt(4)
ds_read_b64_tr_b16 a[56:57],v12 offset:49152
ds_read_b64_tr_b16 a[58:59],v12 offset:49664
ds_read_b64_tr_b16 a[184:185],v12 offset:49160
ds_read_b64_tr_b16 a[186:187],v12 offset:49672
ds_read_b64_tr_b16 a[60:61],v12 offset:57344
ds_read_b64_tr_b16 a[62:63],v12 offset:57856
ds_read_b64_tr_b16 a[188:189],v12 offset:57352
ds_read_b64_tr_b16 a[190:191],v12 offset:57864
s_waitcnt lgkmcnt(4)
v_xor_b32 v12,0x10000,v12
s_waitcnt lgkmcnt(0)
s_barrier
s_add_u32 s64,s74,6291456
s_add_u32 m0,s75,65536
s_nop 0
buffer_load_dwordx4 v8,s[32:35],s64 offen nt lds
s_add_u32 s64,s74,6324224
s_add_u32 m0,s75,66560
s_nop 0
buffer_load_dwordx4 v9,s[32:35],s64 offen nt lds
s_add_u32 s64,s74,6356992
s_add_u32 m0,s75,67584
s_nop 0
buffer_load_dwordx4 v10,s[32:35],s64 offen nt lds
s_add_u32 s64,s74,6389760
s_add_u32 m0,s75,68608
s_nop 0
buffer_load_dwordx4 v11,s[32:35],s64 offen nt lds
s_add_u32 s64,s74,6422528
s_add_u32 m0,s75,69632
s_nop 0
buffer_load_dwordx4 v8,s[32:35],s64 offen nt lds
s_add_u32 s64,s74,6455296
s_add_u32 m0,s75,70656
s_nop 0
buffer_load_dwordx4 v9,s[32:35],s64 offen nt lds
s_add_u32 s64,s74,6488064
s_add_u32 m0,s75,71680
s_nop 0
buffer_load_dwordx4 v10,s[32:35],s64 offen nt lds
s_add_u32 s64,s74,6520832
s_add_u32 m0,s75,72704
s_nop 0
buffer_load_dwordx4 v11,s[32:35],s64 offen nt lds
s_add_u32 s64,s74,6553600
s_add_u32 m0,s75,73728
s_nop 0
buffer_load_dwordx4 v8,s[32:35],s64 offen nt lds
s_add_u32 s64,s74,6586368
s_add_u32 m0,s75,74752
s_nop 0
buffer_load_dwordx4 v9,s[32:35],s64 offen nt lds
s_add_u32 s64,s74,6619136
s_add_u32 m0,s75,75776
s_nop 0
buffer_load_dwordx4 v10,s[32:35],s64 offen nt lds
s_add_u32 s64,s74,6651904
s_add_u32 m0,s75,76800
s_nop 0
buffer_load_dwordx4 v11,s[32:35],s64 offen nt lds
s_add_u32 s64,s74,6684672
s_add_u32 m0,s75,77824
s_nop 0
buffer_load_dwordx4 v8,s[32:35],s64 offen nt lds
s_add_u32 s64,s74,6717440
s_add_u32 m0,s75,78848
s_nop 0
buffer_load_dwordx4 v9,s[32:35],s64 offen nt lds
s_add_u32 s64,s74,6750208
s_add_u32 m0,s75,79872
s_nop 0
buffer_load_dwordx4 v10,s[32:35],s64 offen nt lds
s_add_u32 s64,s74,6782976
s_add_u32 m0,s75,80896
s_nop 0
buffer_load_dwordx4 v11,s[32:35],s64 offen nt lds
s_waitcnt vmcnt(16)
s_barrier
ds_read_b64_tr_b16 a[64:65],v12 offset:0
ds_read_b64_tr_b16 a[66:67],v12 offset:512
ds_read_b64_tr_b16 a[192:193],v12 offset:8
ds_read_b64_tr_b16 a[194:195],v12 offset:520
ds_read_b64_tr_b16 a[68:69],v12 offset:8192
ds_read_b64_tr_b16 a[70:71],v12 offset:8704
ds_read_b64_tr_b16 a[196:197],v12 offset:8200
ds_read_b64_tr_b16 a[198:199],v12 offset:8712
s_waitcnt lgkmcnt(4)
ds_read_b64_tr_b16 a[72:73],v12 offset:16384
ds_read_b64_tr_b16 a[74:75],v12 offset:16896
ds_read_b64_tr_b16 a[200:201],v12 offset:16392
ds_read_b64_tr_b16 a[202:203],v12 offset:16904
ds_read_b64_tr_b16 a[76:77],v12 offset:24576
ds_read_b64_tr_b16 a[78:79],v12 offset:25088
ds_read_b64_tr_b16 a[204:205],v12 offset:24584
ds_read_b64_tr_b16 a[206:207],v12 offset:25096
s_waitcnt lgkmcnt(4)
ds_read_b64_tr_b16 a[80:81],v12 offset:32768
ds_read_b64_tr_b16 a[82:83],v12 offset:33280
ds_read_b64_tr_b16 a[208:209],v12 offset:32776
ds_read_b64_tr_b16 a[210:211],v12 offset:33288
ds_read_b64_tr_b16 a[84:85],v12 offset:40960
ds_read_b64_tr_b16 a[86:87],v12 offset:41472
ds_read_b64_tr_b16 a[212:213],v12 offset:40968
ds_read_b64_tr_b16 a[214:215],v12 offset:41480
s_waitcnt lgkmcnt(4)
ds_read_b64_tr_b16 a[88:89],v12 offset:49152
ds_read_b64_tr_b16 a[90:91],v12 offset:49664
ds_read_b64_tr_b16 a[216:217],v12 offset:49160
ds_read_b64_tr_b16 a[218:219],v12 offset:49672
ds_read_b64_tr_b16 a[92:93],v12 offset:57344
ds_read_b64_tr_b16 a[94:95],v12 offset:57856
ds_read_b64_tr_b16 a[220:221],v12 offset:57352
ds_read_b64_tr_b16 a[222:223],v12 offset:57864
s_waitcnt lgkmcnt(4)
v_xor_b32 v12,0x10000,v12
s_waitcnt lgkmcnt(0)
s_barrier
s_waitcnt vmcnt(0)
s_barrier
ds_read_b64_tr_b16 a[96:97],v12 offset:0
ds_read_b64_tr_b16 a[98:99],v12 offset:512
ds_read_b64_tr_b16 a[224:225],v12 offset:8
ds_read_b64_tr_b16 a[226:227],v12 offset:520
ds_read_b64_tr_b16 a[100:101],v12 offset:8192
ds_read_b64_tr_b16 a[102:103],v12 offset:8704
ds_read_b64_tr_b16 a[228:229],v12 offset:8200
ds_read_b64_tr_b16 a[230:231],v12 offset:8712
s_waitcnt lgkmcnt(4)
ds_read_b64_tr_b16 a[104:105],v12 offset:16384
ds_read_b64_tr_b16 a[106:107],v12 offset:16896
ds_read_b64_tr_b16 a[232:233],v12 offset:16392
ds_read_b64_tr_b16 a[234:235],v12 offset:16904
ds_read_b64_tr_b16 a[108:109],v12 offset:24576
ds_read_b64_tr_b16 a[110:111],v12 offset:25088
ds_read_b64_tr_b16 a[236:237],v12 offset:24584
ds_read_b64_tr_b16 a[238:239],v12 offset:25096
s_waitcnt lgkmcnt(4)
ds_read_b64_tr_b16 a[112:113],v12 offset:32768
ds_read_b64_tr_b16 a[114:115],v12 offset:33280
ds_read_b64_tr_b16 a[240:241],v12 offset:32776
ds_read_b64_tr_b16 a[242:243],v12 offset:33288
ds_read_b64_tr_b16 a[116:117],v12 offset:40960
ds_read_b64_tr_b16 a[118:119],v12 offset:41472
ds_read_b64_tr_b16 a[244:245],v12 offset:40968
ds_read_b64_tr_b16 a[246:247],v12 offset:41480
s_waitcnt lgkmcnt(4)
ds_read_b64_tr_b16 a[120:121],v12 offset:49152
ds_read_b64_tr_b16 a[122:123],v12 offset:49664
ds_read_b64_tr_b16 a[248:249],v12 offset:49160
ds_read_b64_tr_b16 a[250:251],v12 offset:49672
ds_read_b64_tr_b16 a[124:125],v12 offset:57344
ds_read_b64_tr_b16 a[126:127],v12 offset:57856
ds_read_b64_tr_b16 a[252:253],v12 offset:57352
ds_read_b64_tr_b16 a[254:255],v12 offset:57864
s_waitcnt lgkmcnt(4)
v_xor_b32 v12,0x10000,v12
s_waitcnt lgkmcnt(0)
s_barrier
v_and_b32 v21,7,v1
v_lshlrev_b32 v21,6,v21
s_mov_b32 s65,21052416
s_mov_b32 s66,1792
pl_179:
buffer_load_dword v22,v21,s[20:23],s65 offen sc1
s_waitcnt vmcnt(0)
v_cmp_gt_u32 vcc,s66,v22
s_cbranch_vccz pok_180
s_sleep 1
s_sub_u32 s90,s90,1
s_cmp_gt_i32 s90,0
s_cbranch_scc1 pl_179
pok_180:
s_lshl_b32 s72,s50,14
s_lshl_b32 s74,s58,16
s_add_u32 s74,s74,s72
s_add_u32 s74,s74,57344
v_mov_b32 v17,v16
s_lshl_b32 s64,s59,14
s_lshl_b32 s65,s50,11
s_add_u32 s64,s64,s65
v_add_u32 v18,s64,v16
s_lshl_b32 s73,s55,2
s_add_u32 s73,s73,s63
v_lshlrev_b32 v24,4,v0
s_mov_b32 s79,s58
s_add_u32 m0,s72,0
s_add_u32 s65,s74,0
buffer_load_dwordx4 v16,s[20:23],s65 offen offset:0  lds
buffer_load_dwordx4 v16,s[20:23],s65 offen offset:1024  lds
buffer_load_dwordx4 v16,s[20:23],s65 offen offset:2048  lds
buffer_load_dwordx4 v16,s[20:23],s65 offen offset:3072  lds
s_add_u32 m0,s72,4096
s_add_u32 s65,s74,4096
buffer_load_dwordx4 v16,s[20:23],s65 offen offset:0  lds
buffer_load_dwordx4 v16,s[20:23],s65 offen offset:1024  lds
buffer_load_dwordx4 v16,s[20:23],s65 offen offset:2048  lds
buffer_load_dwordx4 v16,s[20:23],s65 offen offset:3072  lds
s_add_u32 m0,s72,8192
s_add_u32 s65,s74,8192
buffer_load_dwordx4 v16,s[20:23],s65 offen offset:0  lds
buffer_load_dwordx4 v16,s[20:23],s65 offen offset:1024  lds
buffer_load_dwordx4 v16,s[20:23],s65 offen offset:2048  lds
buffer_load_dwordx4 v16,s[20:23],s65 offen offset:3072  lds
s_add_u32 m0,s72,12288
s_add_u32 s65,s74,12288
buffer_load_dwordx4 v16,s[20:23],s65 offen offset:0  lds
buffer_load_dwordx4 v16,s[20:23],s65 offen offset:1024  lds
buffer_load_dwordx4 v16,s[20:23],s65 offen offset:2048  lds
buffer_load_dwordx4 v16,s[20:23],s65 offen offset:3072  lds
s_waitcnt vmcnt(0)
s_add_u32 s41,s58,55
s_sub_u32 s64,s58,1
s_cmp_lt_u32 s64,2
s_cselect_b32 s41,s41,64
s_lshl_b32 s76,s50,14
s_add_u32 s76,s76,57344
s_add_u32 s42,s55,32
s_lshl_b32 s42,s42,14
s_add_u32 s42,s42,136314880
s_xor_b32 s64,s62,8192
s_add_u32 s42,s42,s64
s_cmp_lt_u32 s55,96
s_cselect_b32 s42,s42,0x7fff0000
v_add_u32 v25,4096,v24
s_load_dwordx2 s[4:5],s[0:1],96
s_load_dwordx2 s[6:7],s[0:1],104
v_and_b32 v5,3,v0
v_lshrrev_b32 v6,2,v0
v_mul_u32_u24 v112,12288,v6
v_lshl_add_u32 v112,v5,4,v112
v_lshlrev_b32 v113,1,v6
s_add_u32 s43,s55,64
s_lshl_b32 s43,s43,6
s_mov_b32 s48,0
s_mov_b32 s80,0xffff0000
s_mov_b32 s81,0xbfb8aa3b
s_waitcnt lgkmcnt(0)
s_mov_b32 s12,s4
s_and_b32 s13,s5,0xffff
s_mov_b32 s14,0x800
s_mov_b32 s15,0x20000
s_mov_b32 s16,s6
s_and_b32 s17,s7,0xffff
s_mov_b32 s18,0xc00000
s_mov_b32 s19,0x20000
buffer_load_dwordx4 v[104:107],v112,s[16:19],s43 offen nt
buffer_load_ushort v108,v113,s[12:15],s48 offen
s_add_u32 s43,s43,786432
s_add_u32 s48,s48,128
buffer_load_dwordx4 v[116:119],v112,s[16:19],s43 offen nt
buffer_load_ushort v120,v113,s[12:15],s48 offen
s_add_u32 s43,s43,786432
s_add_u32 s48,s48,128
v_mov_b32 v96,0
v_mov_b32 v97,0
v_mov_b32 v98,0
v_mov_b32 v99,0
v_mov_b32 v100,0
v_mov_b32 v101,0
v_mov_b32 v102,0
v_mov_b32 v103,0
s_waitcnt vmcnt(0)
qloop_181:
s_lshr_b32 s64,s79,2
s_cmp_lg_u32 s64,4
s_cbranch_scc1 np2_183
s_waitcnt vmcnt(0)
s_barrier
s_cmp_lg_u32 s50,0
s_cbranch_scc1 ow_184
s_mov_b64 exec,1
v_mov_b32 v22,14
v_mov_b32 v23,0
s_mov_b32 s64,21052928
buffer_atomic_add v22,v23,s[20:23],s64 offen sc1
s_mov_b64 exec,-1
ow_184:
np2_183:
s_cmp_lg_u32 s79,s41
s_cbranch_scc1 npz_182
s_waitcnt vmcnt(0)
s_barrier
s_cmp_lg_u32 s50,0
s_cbranch_scc1 ow_185
s_mov_b64 exec,1
v_mov_b32 v22,14
v_mov_b32 v23,0
s_mov_b32 s64,21052992
buffer_atomic_add v22,v23,s[20:23],s64 offen sc1
s_mov_b64 exec,-1
ow_185:
s_cmp_lg_u32 s50,0
s_cbranch_scc1 ow_186
s_mov_b64 exec,1
v_mov_b32 v22,14
v_mov_b32 v23,0
buffer_store_dword v22,v23,s[20:23],s73 offen sc1
s_mov_b64 exec,-1
ow_186:
npz_182:
s_waitcnt vmcnt(8)
s_barrier
ds_read_b128 v[224:227],v17 offset:0
ds_read_b128 v[228:231],v17 offset:2048
ds_read_b128 v[232:235],v17 offset:4096
ds_read_b128 v[236:239],v17 offset:6144
ds_read_b128 v[240:243],v17 offset:8192
ds_read_b128 v[244:247],v17 offset:10240
ds_read_b128 v[248:251],v17 offset:12288
s_waitcnt lgkmcnt(5)
v_mfma_f32_16x16x32_bf16 v[64:67],a[0:3],v[224:227],0
s_xor_b32 s72,s72,0x10000
s_add_u32 s77,s79,2
v_mfma_f32_16x16x32_bf16 v[72:75],a[128:131],v[224:227],0
ds_read_b128 v[252:255],v17 offset:14336
s_cmp_lt_u32 s79,56
s_cselect_b32 s77,s41,s77
v_mfma_f32_16x16x32_bf16 v[64:67],a[4:7],v[228:231],v[64:67]
s_add_u32 s74,s79,4
s_cmp_lt_u32 s79,52
s_cselect_b32 s77,s74,s77
v_mfma_f32_16x16x32_bf16 v[72:75],a[132:135],v[228:231],v[72:75]
ds_read_b128 v[224:227],v17 offset:16384
s_waitcnt lgkmcnt(5)
v_mfma_f32_16x16x32_bf16 v[64:67],a[8:11],v[232:235],v[64:67]
s_lshl_b32 s74,s77,16
s_add_u32 s74,s74,s76
v_mfma_f32_16x16x32_bf16 v[72:75],a[136:139],v[232:235],v[72:75]
ds_read_b128 v[228:231],v17 offset:18432
s_add_u32 s64,s79,0
v_mfma_f32_16x16x32_bf16 v[64:67],a[12:15],v[236:239],v[64:67]
s_cmp_lt_u32 s77,64
s_cselect_b32 s74,s74,0x7fff0000
v_mfma_f32_16x16x32_bf16 v[72:75],a[140:143],v[236:239],v[72:75]
ds_read_b128 v[232:235],v17 offset:20480
s_waitcnt lgkmcnt(5)
v_mfma_f32_16x16x32_bf16 v[64:67],a[16:19],v[240:243],v[64:67]
s_add_u32 m0,s72,0
v_lshlrev_b32 v108,16,v108
v_mfma_f32_16x16x32_bf16 v[72:75],a[144:147],v[240:243],v[72:75]
ds_read_b128 v[236:239],v17 offset:22528
v_mul_f32 v109,s81,v108
v_mfma_f32_16x16x32_bf16 v[64:67],a[20:23],v[244:247],v[64:67]
s_lshl_b32 s70,s64,21
v_mfma_f32_16x16x32_bf16 v[72:75],a[148:151],v[244:247],v[72:75]
ds_read_b128 v[240:243],v17 offset:24576
s_waitcnt lgkmcnt(5)
v_mfma_f32_16x16x32_bf16 v[64:67],a[24:27],v[248:251],v[64:67]
s_add_u32 s65,s74,0
v_mfma_f32_16x16x32_bf16 v[72:75],a[152:155],v[248:251],v[72:75]
ds_read_b128 v[244:247],v17 offset:26624
v_mfma_f32_16x16x32_bf16 v[64:67],a[28:31],v[252:255],v[64:67]
buffer_load_dwordx4 v16,s[20:23],s65 offen offset:0  lds
v_mfma_f32_16x16x32_bf16 v[72:75],a[156:159],v[252:255],v[72:75]
ds_read_b128 v[248:251],v17 offset:28672
s_waitcnt lgkmcnt(5)
v_mfma_f32_16x16x32_bf16 v[64:67],a[32:35],v[224:227],v[64:67]
s_lshl_b32 s64,s64,13
v_mfma_f32_16x16x32_bf16 v[72:75],a[160:163],v[224:227],v[72:75]
ds_read_b128 v[252:255],v17 offset:30720
v_mfma_f32_16x16x32_bf16 v[64:67],a[36:39],v[228:231],v[64:67]
buffer_load_dwordx4 v16,s[20:23],s65 offen offset:1024  lds
v_mfma_f32_16x16x32_bf16 v[72:75],a[164:167],v[228:231],v[72:75]
ds_read_b128 v[224:227],v17 offset:32768
s_waitcnt lgkmcnt(5)
v_mfma_f32_16x16x32_bf16 v[64:67],a[40:43],v[232:235],v[64:67]
buffer_load_dwordx4 v16,s[20:23],s65 offen offset:2048  lds
v_mfma_f32_16x16x32_bf16 v[72:75],a[168:171],v[232:235],v[72:75]
ds_read_b128 v[228:231],v17 offset:34816
s_and_b32 s64,s64,0x2000
v_mfma_f32_16x16x32_bf16 v[64:67],a[44:47],v[236:239],v[64:67]
v_exp_f32 v109,v109
v_mfma_f32_16x16x32_bf16 v[72:75],a[172:175],v[236:239],v[72:75]
ds_read_b128 v[232:235],v17 offset:36864
s_waitcnt lgkmcnt(5)
v_mfma_f32_16x16x32_bf16 v[64:67],a[48:51],v[240:243],v[64:67]
buffer_load_dwordx4 v16,s[20:23],s65 offen offset:3072  lds
v_mfma_f32_16x16x32_bf16 v[72:75],a[176:179],v[240:243],v[72:75]
ds_read_b128 v[236:239],v17 offset:38912
s_xor_b32 s64,s64,s62
v_mfma_f32_16x16x32_bf16 v[64:67],a[52:55],v[244:247],v[64:67]
s_add_u32 m0,s72,4096
v_add_f32 v109,1.0,v109
v_mfma_f32_16x16x32_bf16 v[72:75],a[180:183],v[244:247],v[72:75]
ds_read_b128 v[240:243],v17 offset:40960
s_waitcnt lgkmcnt(5)
v_mfma_f32_16x16x32_bf16 v[64:67],a[56:59],v[248:251],v[64:67]
v_rcp_f32 v109,v109
v_mfma_f32_16x16x32_bf16 v[72:75],a[184:187],v[248:251],v[72:75]
ds_read_b128 v[244:247],v17 offset:43008
s_add_u32 s65,s74,4096
v_mfma_f32_16x16x32_bf16 v[64:67],a[60:63],v[252:255],v[64:67]
s_add_u32 s70,s70,s64
v_mul_f32 v109,v109,v108
v_mfma_f32_16x16x32_bf16 v[72:75],a[188:191],v[252:255],v[72:75]
ds_read_b128 v[248:251],v17 offset:45056
s_waitcnt lgkmcnt(5)
v_mfma_f32_16x16x32_bf16 v[64:67],a[64:67],v[224:227],v[64:67]
buffer_load_dwordx4 v16,s[20:23],s65 offen offset:0  lds
v_mfma_f32_16x16x32_bf16 v[72:75],a[192:195],v[224:227],v[72:75]
ds_read_b128 v[252:255],v17 offset:47104
v_cvt_pk_bf16_f32 v109,v109,v109
v_mfma_f32_16x16x32_bf16 v[64:67],a[68:71],v[228:231],v[64:67]
v_and_b32 v108,s80,v109
v_lshlrev_b32 v110,16,v104
v_mfma_f32_16x16x32_bf16 v[72:75],a[196:199],v[228:231],v[72:75]
ds_read_b128 v[224:227],v17 offset:49152
s_waitcnt lgkmcnt(5)
v_mfma_f32_16x16x32_bf16 v[64:67],a[72:75],v[232:235],v[64:67]
buffer_load_dwordx4 v16,s[20:23],s65 offen offset:1024  lds
v_mfma_f32_16x16x32_bf16 v[72:75],a[200:203],v[232:235],v[72:75]
ds_read_b128 v[228:231],v17 offset:51200
s_add_u32 s70,s70,29360128
v_mfma_f32_16x16x32_bf16 v[64:67],a[76:79],v[236:239],v[64:67]
buffer_load_dwordx4 v16,s[20:23],s65 offen offset:2048  lds
v_mfma_f32_16x16x32_bf16 v[72:75],a[204:207],v[236:239],v[72:75]
ds_read_b128 v[232:235],v17 offset:53248
s_waitcnt lgkmcnt(5)
v_mfma_f32_16x16x32_bf16 v[64:67],a[80:83],v[240:243],v[64:67]
v_and_b32 v111,s80,v104
v_fmac_f32 v96,v110,v108
v_mfma_f32_16x16x32_bf16 v[72:75],a[208:211],v[240:243],v[72:75]
ds_read_b128 v[236:239],v17 offset:55296
v_fmac_f32 v97,v111,v108
v_mfma_f32_16x16x32_bf16 v[64:67],a[84:87],v[244:247],v[64:67]
buffer_load_dwordx4 v16,s[20:23],s65 offen offset:3072  lds
v_mfma_f32_16x16x32_bf16 v[72:75],a[212:215],v[244:247],v[72:75]
ds_read_b128 v[240:243],v17 offset:57344
s_waitcnt lgkmcnt(5)
v_mfma_f32_16x16x32_bf16 v[64:67],a[88:91],v[248:251],v[64:67]
s_add_u32 m0,s72,8192
v_lshlrev_b32 v110,16,v105
v_mfma_f32_16x16x32_bf16 v[72:75],a[216:219],v[248:251],v[72:75]
ds_read_b128 v[244:247],v17 offset:59392
v_and_b32 v111,s80,v105
v_mfma_f32_16x16x32_bf16 v[64:67],a[92:95],v[252:255],v[64:67]
v_fmac_f32 v98,v110,v108
v_fmac_f32 v99,v111,v108
v_mfma_f32_16x16x32_bf16 v[72:75],a[220:223],v[252:255],v[72:75]
ds_read_b128 v[248:251],v17 offset:61440
s_waitcnt lgkmcnt(5)
v_mfma_f32_16x16x32_bf16 v[64:67],a[96:99],v[224:227],v[64:67]
s_add_u32 s65,s74,8192
v_lshlrev_b32 v110,16,v106
v_mfma_f32_16x16x32_bf16 v[72:75],a[224:227],v[224:227],v[72:75]
ds_read_b128 v[252:255],v17 offset:63488
v_and_b32 v111,s80,v106
v_mfma_f32_16x16x32_bf16 v[64:67],a[100:103],v[228:231],v[64:67]
buffer_load_dwordx4 v16,s[20:23],s65 offen offset:0  lds
v_mfma_f32_16x16x32_bf16 v[72:75],a[228:231],v[228:231],v[72:75]
ds_read_b128 v[224:227],v17 offset:1024
s_waitcnt lgkmcnt(5)
v_mfma_f32_16x16x32_bf16 v[64:67],a[104:107],v[232:235],v[64:67]
v_fmac_f32 v100,v110,v108
v_fmac_f32 v101,v111,v108
v_mfma_f32_16x16x32_bf16 v[72:75],a[232:235],v[232:235],v[72:75]
ds_read_b128 v[228:231],v17 offset:3072
v_lshlrev_b32 v110,16,v107
v_mfma_f32_16x16x32_bf16 v[64:67],a[108:111],v[236:239],v[64:67]
buffer_load_dwordx4 v16,s[20:23],s65 offen offset:1024  lds
v_mfma_f32_16x16x32_bf16 v[72:75],a[236:239],v[236:239],v[72:75]
ds_read_b128 v[232:235],v17 offset:5120
s_waitcnt lgkmcnt(5)
v_mfma_f32_16x16x32_bf16 v[64:67],a[112:115],v[240:243],v[64:67]
buffer_load_dwordx4 v16,s[20:23],s65 offen offset:2048  lds
v_mfma_f32_16x16x32_bf16 v[72:75],a[240:243],v[240:243],v[72:75]
ds_read_b128 v[236:239],v17 offset:7168
v_and_b32 v111,s80,v107
v_mfma_f32_16x16x32_bf16 v[64:67],a[116:119],v[244:247],v[64:67]
v_fmac_f32 v102,v110,v108
v_fmac_f32 v103,v111,v108
v_mfma_f32_16x16x32_bf16 v[72:75],a[244:247],v[244:247],v[72:75]
ds_read_b128 v[240:243],v17 offset:9216
s_waitcnt lgkmcnt(5)
v_mfma_f32_16x16x32_bf16 v[64:67],a[120:123],v[248:251],v[64:67]
buffer_load_dwordx4 v16,s[20:23],s65 offen offset:3072  lds
v_mfma_f32_16x16x32_bf16 v[72:75],a[248:251],v[248:251],v[72:75]
ds_read_b128 v[244:247],v17 offset:11264
v_mfma_f32_16x16x32_bf16 v[64:67],a[124:127],v[252:255],v[64:67]
s_add_u32 m0,s72,12288
v_mfma_f32_16x16x32_bf16 v[72:75],a[252:255],v[252:255],v[72:75]
ds_read_b128 v[248:251],v17 offset:13312
s_waitcnt lgkmcnt(5)
v_mfma_f32_16x16x32_bf16 v[68:71],a[0:3],v[224:227],0
v_mfma_f32_16x16x32_bf16 v[76:79],a[128:131],v[224:227],0
ds_read_b128 v[252:255],v17 offset:15360
s_add_u32 s65,s74,12288
v_mfma_f32_16x16x32_bf16 v[68:71],a[4:7],v[228:231],v[68:71]
v_mfma_f32_16x16x32_bf16 v[76:79],a[132:135],v[228:231],v[76:79]
ds_read_b128 v[224:227],v17 offset:17408
s_waitcnt lgkmcnt(5)
v_mfma_f32_16x16x32_bf16 v[68:71],a[8:11],v[232:235],v[68:71]
buffer_load_dwordx4 v16,s[20:23],s65 offen offset:0  lds
v_mfma_f32_16x16x32_bf16 v[76:79],a[136:139],v[232:235],v[76:79]
ds_read_b128 v[228:231],v17 offset:19456
v_cvt_pk_bf16_f32 v88,v64,v65
v_mfma_f32_16x16x32_bf16 v[68:71],a[12:15],v[236:239],v[68:71]
v_cvt_pk_bf16_f32 v89,v66,v67
v_cvt_pk_bf16_f32 v90,v72,v73
v_mfma_f32_16x16x32_bf16 v[76:79],a[140:143],v[236:239],v[76:79]
ds_read_b128 v[232:235],v17 offset:21504
s_waitcnt lgkmcnt(5)
v_mfma_f32_16x16x32_bf16 v[68:71],a[16:19],v[240:243],v[68:71]
buffer_load_dwordx4 v16,s[20:23],s65 offen offset:1024  lds
v_mfma_f32_16x16x32_bf16 v[76:79],a[144:147],v[240:243],v[76:79]
ds_read_b128 v[236:239],v17 offset:23552
v_cvt_pk_bf16_f32 v91,v74,v75
v_mfma_f32_16x16x32_bf16 v[68:71],a[20:23],v[244:247],v[68:71]
buffer_load_dwordx4 v16,s[20:23],s65 offen offset:2048  lds
v_mfma_f32_16x16x32_bf16 v[76:79],a[148:151],v[244:247],v[76:79]
ds_read_b128 v[240:243],v17 offset:25600
s_waitcnt lgkmcnt(5)
v_mfma_f32_16x16x32_bf16 v[68:71],a[24:27],v[248:251],v[68:71]
v_mfma_f32_16x16x32_bf16 v[76:79],a[152:155],v[248:251],v[76:79]
ds_read_b128 v[244:247],v17 offset:27648
v_mfma_f32_16x16x32_bf16 v[68:71],a[28:31],v[252:255],v[68:71]
buffer_load_dwordx4 v16,s[20:23],s65 offen offset:3072  lds
v_mfma_f32_16x16x32_bf16 v[76:79],a[156:159],v[252:255],v[76:79]
ds_read_b128 v[248:251],v17 offset:29696
s_waitcnt lgkmcnt(5)
v_mfma_f32_16x16x32_bf16 v[68:71],a[32:35],v[224:227],v[68:71]
v_mfma_f32_16x16x32_bf16 v[76:79],a[160:163],v[224:227],v[76:79]
ds_read_b128 v[252:255],v17 offset:31744
v_mfma_f32_16x16x32_bf16 v[68:71],a[36:39],v[228:231],v[68:71]
v_mfma_f32_16x16x32_bf16 v[76:79],a[164:167],v[228:231],v[76:79]
ds_read_b128 v[224:227],v17 offset:33792
s_waitcnt lgkmcnt(5)
v_mfma_f32_16x16x32_bf16 v[68:71],a[40:43],v[232:235],v[68:71]
buffer_store_dwordx4 v[88:91],v18,s[20:23],s70 offen offset:0 sc1
v_mfma_f32_16x16x32_bf16 v[76:79],a[168:171],v[232:235],v[76:79]
ds_read_b128 v[228:231],v17 offset:35840
v_mfma_f32_16x16x32_bf16 v[68:71],a[44:47],v[236:239],v[68:71]
buffer_load_dwordx4 v[104:107],v112,s[16:19],s43 offen nt
v_mfma_f32_16x16x32_bf16 v[76:79],a[172:175],v[236:239],v[76:79]
ds_read_b128 v[232:235],v17 offset:37888
s_waitcnt lgkmcnt(5)
v_mfma_f32_16x16x32_bf16 v[68:71],a[48:51],v[240:243],v[68:71]
v_mfma_f32_16x16x32_bf16 v[76:79],a[176:179],v[240:243],v[76:79]
ds_read_b128 v[236:239],v17 offset:39936
v_mfma_f32_16x16x32_bf16 v[68:71],a[52:55],v[244:247],v[68:71]
buffer_load_ushort v108,v113,s[12:15],s48 offen
v_mfma_f32_16x16x32_bf16 v[76:79],a[180:183],v[244:247],v[76:79]
ds_read_b128 v[240:243],v17 offset:41984
s_waitcnt lgkmcnt(5)
v_mfma_f32_16x16x32_bf16 v[68:71],a[56:59],v[248:251],v[68:71]
s_add_u32 s43,s43,786432
v_mfma_f32_16x16x32_bf16 v[76:79],a[184:187],v[248:251],v[76:79]
ds_read_b128 v[244:247],v17 offset:44032
v_mfma_f32_16x16x32_bf16 v[68:71],a[60:63],v[252:255],v[68:71]
v_mfma_f32_16x16x32_bf16 v[76:79],a[188:191],v[252:255],v[76:79]
ds_read_b128 v[248:251],v17 offset:46080
s_waitcnt lgkmcnt(5)
v_mfma_f32_16x16x32_bf16 v[68:71],a[64:67],v[224:227],v[68:71]
s_add_u32 s48,s48,128
v_mfma_f32_16x16x32_bf16 v[76:79],a[192:195],v[224:227],v[76:79]
ds_read_b128 v[252:255],v17 offset:48128
v_mfma_f32_16x16x32_bf16 v[68:71],a[68:71],v[228:231],v[68:71]
buffer_store_dwordx4 v[48:51],v24,s[20:23],s93 offen sc1
v_mfma_f32_16x16x32_bf16 v[76:79],a[196:199],v[228:231],v[76:79]
ds_read_b128 v[224:227],v17 offset:50176
s_waitcnt lgkmcnt(5)
v_mfma_f32_16x16x32_bf16 v[68:71],a[72:75],v[232:235],v[68:71]
v_mfma_f32_16x16x32_bf16 v[76:79],a[200:203],v[232:235],v[76:79]
ds_read_b128 v[228:231],v17 offset:52224
v_mfma_f32_16x16x32_bf16 v[68:71],a[76:79],v[236:239],v[68:71]
buffer_store_dwordx4 v[48:51],v25,s[20:23],s93 offen sc1
v_mfma_f32_16x16x32_bf16 v[76:79],a[204:207],v[236:239],v[76:79]
ds_read_b128 v[232:235],v17 offset:54272
s_waitcnt lgkmcnt(5)
v_mfma_f32_16x16x32_bf16 v[68:71],a[80:83],v[240:243],v[68:71]
s_add_u32 s93,s93,8388608
v_mfma_f32_16x16x32_bf16 v[76:79],a[208:211],v[240:243],v[76:79]
ds_read_b128 v[236:239],v17 offset:56320
v_mfma_f32_16x16x32_bf16 v[68:71],a[84:87],v[244:247],v[68:71]
v_mfma_f32_16x16x32_bf16 v[76:79],a[212:215],v[244:247],v[76:79]
ds_read_b128 v[240:243],v17 offset:58368
s_waitcnt lgkmcnt(5)
v_mfma_f32_16x16x32_bf16 v[68:71],a[88:91],v[248:251],v[68:71]
s_cmp_lt_u32 s93,163577856
s_cselect_b32 s93,s93,0x7fff0000
v_mfma_f32_16x16x32_bf16 v[76:79],a[216:219],v[248:251],v[76:79]
ds_read_b128 v[244:247],v17 offset:60416
v_mfma_f32_16x16x32_bf16 v[68:71],a[92:95],v[252:255],v[68:71]
buffer_store_dwordx4 v[48:51],v24,s[20:23],s42 offen sc1
v_mfma_f32_16x16x32_bf16 v[76:79],a[220:223],v[252:255],v[76:79]
ds_read_b128 v[248:251],v17 offset:62464
s_waitcnt lgkmcnt(5)
v_mfma_f32_16x16x32_bf16 v[68:71],a[96:99],v[224:227],v[68:71]
v_mfma_f32_16x16x32_bf16 v[76:79],a[224:227],v[224:227],v[76:79]
ds_read_b128 v[252:255],v17 offset:64512
v_mfma_f32_16x16x32_bf16 v[68:71],a[100:103],v[228:231],v[68:71]
buffer_store_dwordx4 v[48:51],v25,s[20:23],s42 offen sc1
v_mfma_f32_16x16x32_bf16 v[76:79],a[228:231],v[228:231],v[76:79]
s_waitcnt lgkmcnt(4)
v_mfma_f32_16x16x32_bf16 v[68:71],a[104:107],v[232:235],v[68:71]
s_add_u32 s42,s42,2097152
v_mfma_f32_16x16x32_bf16 v[76:79],a[232:235],v[232:235],v[76:79]
v_mfma_f32_16x16x32_bf16 v[68:71],a[108:111],v[236:239],v[68:71]
v_mfma_f32_16x16x32_bf16 v[76:79],a[236:239],v[236:239],v[76:79]
s_xor_b32 s42,s42,0x2000
s_waitcnt lgkmcnt(2)
v_mfma_f32_16x16x32_bf16 v[68:71],a[112:115],v[240:243],v[68:71]
v_mfma_f32_16x16x32_bf16 v[76:79],a[240:243],v[240:243],v[76:79]
v_mfma_f32_16x16x32_bf16 v[68:71],a[116:119],v[244:247],v[68:71]
s_cmp_lt_u32 s42,165675008
s_cselect_b32 s42,s42,0x7fff0000
v_mfma_f32_16x16x32_bf16 v[76:79],a[244:247],v[244:247],v[76:79]
s_waitcnt lgkmcnt(0)
v_mfma_f32_16x16x32_bf16 v[68:71],a[120:123],v[248:251],v[68:71]
v_mfma_f32_16x16x32_bf16 v[76:79],a[248:251],v[248:251],v[76:79]
v_mfma_f32_16x16x32_bf16 v[68:71],a[124:127],v[252:255],v[68:71]
v_mfma_f32_16x16x32_bf16 v[76:79],a[252:255],v[252:255],v[76:79]
v_xor_b32 v17,0x10000,v17
s_mov_b32 s79,s77
s_nop 4
v_cvt_pk_bf16_f32 v92,v68,v69
v_cvt_pk_bf16_f32 v93,v70,v71
v_cvt_pk_bf16_f32 v94,v76,v77
v_cvt_pk_bf16_f32 v95,v78,v79
buffer_store_dwordx4 v[92:95],v18,s[20:23],s70 offen offset:1024 sc1
s_waitcnt vmcnt(8)
s_barrier
ds_read_b128 v[224:227],v17 offset:0
ds_read_b128 v[228:231],v17 offset:2048
ds_read_b128 v[232:235],v17 offset:4096
ds_read_b128 v[236:239],v17 offset:6144
ds_read_b128 v[240:243],v17 offset:8192
ds_read_b128 v[244:247],v17 offset:10240
ds_read_b128 v[248:251],v17 offset:12288
s_waitcnt lgkmcnt(5)
v_mfma_f32_16x16x32_bf16 v[64:67],a[0:3],v[224:227],0
s_xor_b32 s72,s72,0x10000
s_add_u32 s77,s79,2
v_mfma_f32_16x16x32_bf16 v[72:75],a[128:131],v[224:227],0
ds_read_b128 v[252:255],v17 offset:14336
s_cmp_lt_u32 s79,56
s_cselect_b32 s77,s41,s77
v_mfma_f32_16x16x32_bf16 v[64:67],a[4:7],v[228:231],v[64:67]
s_add_u32 s74,s79,4
s_cmp_lt_u32 s79,52
s_cselect_b32 s77,s74,s77
v_mfma_f32_16x16x32_bf16 v[72:75],a[132:135],v[228:231],v[72:75]
ds_read_b128 v[224:227],v17 offset:16384
s_waitcnt lgkmcnt(5)
v_mfma_f32_16x16x32_bf16 v[64:67],a[8:11],v[232:235],v[64:67]
s_lshl_b32 s74,s77,16
s_add_u32 s74,s74,s76
v_mfma_f32_16x16x32_bf16 v[72:75],a[136:139],v[232:235],v[72:75]
ds_read_b128 v[228:231],v17 offset:18432
s_add_u32 s64,s79,0
v_mfma_f32_16x16x32_bf16 v[64:67],a[12:15],v[236:239],v[64:67]
s_cmp_lt_u32 s77,64
s_cselect_b32 s74,s74,0x7fff0000
v_mfma_f32_16x16x32_bf16 v[72:75],a[140:143],v[236:239],v[72:75]
ds_read_b128 v[232:235],v17 offset:20480
s_waitcnt lgkmcnt(5)
v_mfma_f32_16x16x32_bf16 v[64:67],a[16:19],v[240:243],v[64:67]
s_add_u32 m0,s72,0
v_lshlrev_b32 v120,16,v120
v_mfma_f32_16x16x32_bf16 v[72:75],a[144:147],v[240:243],v[72:75]
ds_read_b128 v[236:239],v17 offset:22528
v_mul_f32 v109,s81,v120
v_mfma_f32_16x16x32_bf16 v[64:67],a[20:23],v[244:247],v[64:67]
s_lshl_b32 s70,s64,21
v_mfma_f32_16x16x32_bf16 v[72:75],a[148:151],v[244:247],v[72:75]
ds_read_b128 v[240:243],v17 offset:24576
s_waitcnt lgkmcnt(5)
v_mfma_f32_16x16x32_bf16 v[64:67],a[24:27],v[248:251],v[64:67]
s_add_u32 s65,s74,0
v_mfma_f32_16x16x32_bf16 v[72:75],a[152:155],v[248:251],v[72:75]
ds_read_b128 v[244:247],v17 offset:26624
v_mfma_f32_16x16x32_bf16 v[64:67],a[28:31],v[252:255],v[64:67]
buffer_load_dwordx4 v16,s[20:23],s65 offen offset:0  lds
v_mfma_f32_16x16x32_bf16 v[72:75],a[156:159],v[252:255],v[72:75]
ds_read_b128 v[248:251],v17 offset:28672
s_waitcnt lgkmcnt(5)
v_mfma_f32_16x16x32_bf16 v[64:67],a[32:35],v[224:227],v[64:67]
s_lshl_b32 s64,s64,13
v_mfma_f32_16x16x32_bf16 v[72:75],a[160:163],v[224:227],v[72:75]
ds_read_b128 v[252:255],v17 offset:30720
v_mfma_f32_16x16x32_bf16 v[64:67],a[36:39],v[228:231],v[64:67]
buffer_load_dwordx4 v16,s[20:23],s65 offen offset:1024  lds
v_mfma_f32_16x16x32_bf16 v[72:75],a[164:167],v[228:231],v[72:75]
ds_read_b128 v[224:227],v17 offset:32768
s_waitcnt lgkmcnt(5)
v_mfma_f32_16x16x32_bf16 v[64:67],a[40:43],v[232:235],v[64:67]
buffer_load_dwordx4 v16,s[20:23],s65 offen offset:2048  lds
v_mfma_f32_16x16x32_bf16 v[72:75],a[168:171],v[232:235],v[72:75]
ds_read_b128 v[228:231],v17 offset:34816
s_and_b32 s64,s64,0x2000
v_mfma_f32_16x16x32_bf16 v[64:67],a[44:47],v[236:239],v[64:67]
v_exp_f32 v109,v109
v_mfma_f32_16x16x32_bf16 v[72:75],a[172:175],v[236:239],v[72:75]
ds_read_b128 v[232:235],v17 offset:36864
s_waitcnt lgkmcnt(5)
v_mfma_f32_16x16x32_bf16 v[64:67],a[48:51],v[240:243],v[64:67]
buffer_load_dwordx4 v16,s[20:23],s65 offen offset:3072  lds
v_mfma_f32_16x16x32_bf16 v[72:75],a[176:179],v[240:243],v[72:75]
ds_read_b128 v[236:239],v17 offset:38912
s_xor_b32 s64,s64,s62
v_mfma_f32_16x16x32_bf16 v[64:67],a[52:55],v[244:247],v[64:67]
s_add_u32 m0,s72,4096
v_add_f32 v109,1.0,v109
v_mfma_f32_16x16x32_bf16 v[72:75],a[180:183],v[244:247],v[72:75]
ds_read_b128 v[240:243],v17 offset:40960
s_waitcnt lgkmcnt(5)
v_mfma_f32_16x16x32_bf16 v[64:67],a[56:59],v[248:251],v[64:67]
v_rcp_f32 v109,v109
v_mfma_f32_16x16x32_bf16 v[72:75],a[184:187],v[248:251],v[72:75]
ds_read_b128 v[244:247],v17 offset:43008
s_add_u32 s65,s74,4096
v_mfma_f32_16x16x32_bf16 v[64:67],a[60:63],v[252:255],v[64:67]
s_add_u32 s70,s70,s64
v_mul_f32 v109,v109,v120
v_mfma_f32_16x16x32_bf16 v[72:75],a[188:191],v[252:255],v[72:75]
ds_read_b128 v[248:251],v17 offset:45056
s_waitcnt lgkmcnt(5)
v_mfma_f32_16x16x32_bf16 v[64:67],a[64:67],v[224:227],v[64:67]
buffer_load_dwordx4 v16,s[20:23],s65 offen offset:0  lds
v_mfma_f32_16x16x32_bf16 v[72:75],a[192:195],v[224:227],v[72:75]
ds_read_b128 v[252:255],v17 offset:47104
v_cvt_pk_bf16_f32 v109,v109,v109
v_mfma_f32_16x16x32_bf16 v[64:67],a[68:71],v[228:231],v[64:67]
v_and_b32 v120,s80,v109
v_lshlrev_b32 v110,16,v116
v_mfma_f32_16x16x32_bf16 v[72:75],a[196:199],v[228:231],v[72:75]
ds_read_b128 v[224:227],v17 offset:49152
s_waitcnt lgkmcnt(5)
v_mfma_f32_16x16x32_bf16 v[64:67],a[72:75],v[232:235],v[64:67]
buffer_load_dwordx4 v16,s[20:23],s65 offen offset:1024  lds
v_mfma_f32_16x16x32_bf16 v[72:75],a[200:203],v[232:235],v[72:75]
ds_read_b128 v[228:231],v17 offset:51200
s_add_u32 s70,s70,29360128
v_mfma_f32_16x16x32_bf16 v[64:67],a[76:79],v[236:239],v[64:67]
buffer_load_dwordx4 v16,s[20:23],s65 offen offset:2048  lds
v_mfma_f32_16x16x32_bf16 v[72:75],a[204:207],v[236:239],v[72:75]
ds_read_b128 v[232:235],v17 offset:53248
s_waitcnt lgkmcnt(5)
v_mfma_f32_16x16x32_bf16 v[64:67],a[80:83],v[240:243],v[64:67]
v_and_b32 v111,s80,v116
v_fmac_f32 v96,v110,v120
v_mfma_f32_16x16x32_bf16 v[72:75],a[208:211],v[240:243],v[72:75]
ds_read_b128 v[236:239],v17 offset:55296
v_fmac_f32 v97,v111,v120
v_mfma_f32_16x16x32_bf16 v[64:67],a[84:87],v[244:247],v[64:67]
buffer_load_dwordx4 v16,s[20:23],s65 offen offset:3072  lds
v_mfma_f32_16x16x32_bf16 v[72:75],a[212:215],v[244:247],v[72:75]
ds_read_b128 v[240:243],v17 offset:57344
s_waitcnt lgkmcnt(5)
v_mfma_f32_16x16x32_bf16 v[64:67],a[88:91],v[248:251],v[64:67]
s_add_u32 m0,s72,8192
v_lshlrev_b32 v110,16,v117
v_mfma_f32_16x16x32_bf16 v[72:75],a[216:219],v[248:251],v[72:75]
ds_read_b128 v[244:247],v17 offset:59392
v_and_b32 v111,s80,v117
v_mfma_f32_16x16x32_bf16 v[64:67],a[92:95],v[252:255],v[64:67]
v_fmac_f32 v98,v110,v120
v_fmac_f32 v99,v111,v120
v_mfma_f32_16x16x32_bf16 v[72:75],a[220:223],v[252:255],v[72:75]
ds_read_b128 v[248:251],v17 offset:61440
s_waitcnt lgkmcnt(5)
v_mfma_f32_16x16x32_bf16 v[64:67],a[96:99],v[224:227],v[64:67]
s_add_u32 s65,s74,8192
v_lshlrev_b32 v110,16,v118
v_mfma_f32_16x16x32_bf16 v[72:75],a[224:227],v[224:227],v[72:75]
ds_read_b128 v[252:255],v17 offset:63488
v_and_b32 v111,s80,v118
v_mfma_f32_16x16x32_bf16 v[64:67],a[100:103],v[228:231],v[64:67]
buffer_load_dwordx4 v16,s[20:23],s65 offen offset:0  lds
v_mfma_f32_16x16x32_bf16 v[72:75],a[228:231],v[228:231],v[72:75]
ds_read_b128 v[224:227],v17 offset:1024
s_waitcnt lgkmcnt(5)
v_mfma_f32_16x16x32_bf16 v[64:67],a[104:107],v[232:235],v[64:67]
v_fmac_f32 v100,v110,v120
v_fmac_f32 v101,v111,v120
v_mfma_f32_16x16x32_bf16 v[72:75],a[232:235],v[232:235],v[72:75]
ds_read_b128 v[228:231],v17 offset:3072
v_lshlrev_b32 v110,16,v119
v_mfma_f32_16x16x32_bf16 v[64:67],a[108:111],v[236:239],v[64:67]
buffer_load_dwordx4 v16,s[20:23],s65 offen offset:1024  lds
v_mfma_f32_16x16x32_bf16 v[72:75],a[236:239],v[236:239],v[72:75]
ds_read_b128 v[232:235],v17 offset:5120
s_waitcnt lgkmcnt(5)
v_mfma_f32_16x16x32_bf16 v[64:67],a[112:115],v[240:243],v[64:67]
buffer_load_dwordx4 v16,s[20:23],s65 offen offset:2048  lds
v_mfma_f32_16x16x32_bf16 v[72:75],a[240:243],v[240:243],v[72:75]
ds_read_b128 v[236:239],v17 offset:7168
v_and_b32 v111,s80,v119
v_mfma_f32_16x16x32_bf16 v[64:67],a[116:119],v[244:247],v[64:67]
v_fmac_f32 v102,v110,v120
v_fmac_f32 v103,v111,v120
v_mfma_f32_16x16x32_bf16 v[72:75],a[244:247],v[244:247],v[72:75]
ds_read_b128 v[240:243],v17 offset:9216
s_waitcnt lgkmcnt(5)
v_mfma_f32_16x16x32_bf16 v[64:67],a[120:123],v[248:251],v[64:67]
buffer_load_dwordx4 v16,s[20:23],s65 offen offset:3072  lds
v_mfma_f32_16x16x32_bf16 v[72:75],a[248:251],v[248:251],v[72:75]
ds_read_b128 v[244:247],v17 offset:11264
v_mfma_f32_16x16x32_bf16 v[64:67],a[124:127],v[252:255],v[64:67]
s_add_u32 m0,s72,12288
v_mfma_f32_16x16x32_bf16 v[72:75],a[252:255],v[252:255],v[72:75]
ds_read_b128 v[248:251],v17 offset:13312
s_waitcnt lgkmcnt(5)
v_mfma_f32_16x16x32_bf16 v[68:71],a[0:3],v[224:227],0
v_mfma_f32_16x16x32_bf16 v[76:79],a[128:131],v[224:227],0
ds_read_b128 v[252:255],v17 offset:15360
s_add_u32 s65,s74,12288
v_mfma_f32_16x16x32_bf16 v[68:71],a[4:7],v[228:231],v[68:71]
v_mfma_f32_16x16x32_bf16 v[76:79],a[132:135],v[228:231],v[76:79]
ds_read_b128 v[224:227],v17 offset:17408
s_waitcnt lgkmcnt(5)
v_mfma_f32_16x16x32_bf16 v[68:71],a[8:11],v[232:235],v[68:71]
buffer_load_dwordx4 v16,s[20:23],s65 offen offset:0  lds
v_mfma_f32_16x16x32_bf16 v[76:79],a[136:139],v[232:235],v[76:79]
ds_read_b128 v[228:231],v17 offset:19456
v_cvt_pk_bf16_f32 v88,v64,v65
v_mfma_f32_16x16x32_bf16 v[68:71],a[12:15],v[236:239],v[68:71]
v_cvt_pk_bf16_f32 v89,v66,v67
v_cvt_pk_bf16_f32 v90,v72,v73
v_mfma_f32_16x16x32_bf16 v[76:79],a[140:143],v[236:239],v[76:79]
ds_read_b128 v[232:235],v17 offset:21504
s_waitcnt lgkmcnt(5)
v_mfma_f32_16x16x32_bf16 v[68:71],a[16:19],v[240:243],v[68:71]
buffer_load_dwordx4 v16,s[20:23],s65 offen offset:1024  lds
v_mfma_f32_16x16x32_bf16 v[76:79],a[144:147],v[240:243],v[76:79]
ds_read_b128 v[236:239],v17 offset:23552
v_cvt_pk_bf16_f32 v91,v74,v75
v_mfma_f32_16x16x32_bf16 v[68:71],a[20:23],v[244:247],v[68:71]
buffer_load_dwordx4 v16,s[20:23],s65 offen offset:2048  lds
v_mfma_f32_16x16x32_bf16 v[76:79],a[148:151],v[244:247],v[76:79]
ds_read_b128 v[240:243],v17 offset:25600
s_waitcnt lgkmcnt(5)
v_mfma_f32_16x16x32_bf16 v[68:71],a[24:27],v[248:251],v[68:71]
v_mfma_f32_16x16x32_bf16 v[76:79],a[152:155],v[248:251],v[76:79]
ds_read_b128 v[244:247],v17 offset:27648
v_mfma_f32_16x16x32_bf16 v[68:71],a[28:31],v[252:255],v[68:71]
buffer_load_dwordx4 v16,s[20:23],s65 offen offset:3072  lds
v_mfma_f32_16x16x32_bf16 v[76:79],a[156:159],v[252:255],v[76:79]
ds_read_b128 v[248:251],v17 offset:29696
s_waitcnt lgkmcnt(5)
v_mfma_f32_16x16x32_bf16 v[68:71],a[32:35],v[224:227],v[68:71]
v_mfma_f32_16x16x32_bf16 v[76:79],a[160:163],v[224:227],v[76:79]
ds_read_b128 v[252:255],v17 offset:31744
v_mfma_f32_16x16x32_bf16 v[68:71],a[36:39],v[228:231],v[68:71]
v_mfma_f32_16x16x32_bf16 v[76:79],a[164:167],v[228:231],v[76:79]
ds_read_b128 v[224:227],v17 offset:33792
s_waitcnt lgkmcnt(5)
v_mfma_f32_16x16x32_bf16 v[68:71],a[40:43],v[232:235],v[68:71]
buffer_store_dwordx4 v[88:91],v18,s[20:23],s70 offen offset:0 sc1
v_mfma_f32_16x16x32_bf16 v[76:79],a[168:171],v[232:235],v[76:79]
ds_read_b128 v[228:231],v17 offset:35840
v_mfma_f32_16x16x32_bf16 v[68:71],a[44:47],v[236:239],v[68:71]
buffer_load_dwordx4 v[116:119],v112,s[16:19],s43 offen nt
v_mfma_f32_16x16x32_bf16 v[76:79],a[172:175],v[236:239],v[76:79]
ds_read_b128 v[232:235],v17 offset:37888
s_waitcnt lgkmcnt(5)
v_mfma_f32_16x16x32_bf16 v[68:71],a[48:51],v[240:243],v[68:71]
v_mfma_f32_16x16x32_bf16 v[76:79],a[176:179],v[240:243],v[76:79]
ds_read_b128 v[236:239],v17 offset:39936
v_mfma_f32_16x16x32_bf16 v[68:71],a[52:55],v[244:247],v[68:71]
buffer_load_ushort v120,v113,s[12:15],s48 offen
v_mfma_f32_16x16x32_bf16 v[76:79],a[180:183],v[244:247],v[76:79]
ds_read_b128 v[240:243],v17 offset:41984
s_waitcnt lgkmcnt(5)
v_mfma_f32_16x16x32_bf16 v[68:71],a[56:59],v[248:251],v[68:71]
s_add_u32 s43,s43,786432
v_mfma_f32_16x16x32_bf16 v[76:79],a[184:187],v[248:251],v[76:79]
ds_read_b128 v[244:247],v17 offset:44032
v_mfma_f32_16x16x32_bf16 v[68:71],a[60:63],v[252:255],v[68:71]
v_mfma_f32_16x16x32_bf16 v[76:79],a[188:191],v[252:255],v[76:79]
ds_read_b128 v[248:251],v17 offset:46080
s_waitcnt lgkmcnt(5)
v_mfma_f32_16x16x32_bf16 v[68:71],a[64:67],v[224:227],v[68:71]
s_add_u32 s48,s48,128
v_mfma_f32_16x16x32_bf16 v[76:79],a[192:195],v[224:227],v[76:79]
ds_read_b128 v[252:255],v17 offset:48128
v_mfma_f32_16x16x32_bf16 v[68:71],a[68:71],v[228:231],v[68:71]
buffer_store_dwordx4 v[48:51],v24,s[20:23],s93 offen sc1
v_mfma_f32_16x16x32_bf16 v[76:79],a[196:199],v[228:231],v[76:79]
ds_read_b128 v[224:227],v17 offset:50176
s_waitcnt lgkmcnt(5)
v_mfma_f32_16x16x32_bf16 v[68:71],a[72:75],v[232:235],v[68:71]
v_mfma_f32_16x16x32_bf16 v[76:79],a[200:203],v[232:235],v[76:79]
ds_read_b128 v[228:231],v17 offset:52224
v_mfma_f32_16x16x32_bf16 v[68:71],a[76:79],v[236:239],v[68:71]
buffer_store_dwordx4 v[48:51],v25,s[20:23],s93 offen sc1
v_mfma_f32_16x16x32_bf16 v[76:79],a[204:207],v[236:239],v[76:79]
ds_read_b128 v[232:235],v17 offset:54272
s_waitcnt lgkmcnt(5)
v_mfma_f32_16x16x32_bf16 v[68:71],a[80:83],v[240:243],v[68:71]
s_add_u32 s93,s93,8388608
v_mfma_f32_16x16x32_bf16 v[76:79],a[208:211],v[240:243],v[76:79]
ds_read_b128 v[236:239],v17 offset:56320
v_mfma_f32_16x16x32_bf16 v[68:71],a[84:87],v[244:247],v[68:71]
v_mfma_f32_16x16x32_bf16 v[76:79],a[212:215],v[244:247],v[76:79]
ds_read_b128 v[240:243],v17 offset:58368
s_waitcnt lgkmcnt(5)
v_mfma_f32_16x16x32_bf16 v[68:71],a[88:91],v[248:251],v[68:71]
s_cmp_lt_u32 s93,163577856
s_cselect_b32 s93,s93,0x7fff0000
v_mfma_f32_16x16x32_bf16 v[76:79],a[216:219],v[248:251],v[76:79]
ds_read_b128 v[244:247],v17 offset:60416
v_mfma_f32_16x16x32_bf16 v[68:71],a[92:95],v[252:255],v[68:71]
buffer_store_dwordx4 v[48:51],v24,s[20:23],s42 offen sc1
v_mfma_f32_16x16x32_bf16 v[76:79],a[220:223],v[252:255],v[76:79]
ds_read_b128 v[248:251],v17 offset:62464
s_waitcnt lgkmcnt(5)
v_mfma_f32_16x16x32_bf16 v[68:71],a[96:99],v[224:227],v[68:71]
v_mfma_f32_16x16x32_bf16 v[76:79],a[224:227],v[224:227],v[76:79]
ds_read_b128 v[252:255],v17 offset:64512
v_mfma_f32_16x16x32_bf16 v[68:71],a[100:103],v[228:231],v[68:71]
buffer_store_dwordx4 v[48:51],v25,s[20:23],s42 offen sc1
v_mfma_f32_16x16x32_bf16 v[76:79],a[228:231],v[228:231],v[76:79]
s_waitcnt lgkmcnt(4)
v_mfma_f32_16x16x32_bf16 v[68:71],a[104:107],v[232:235],v[68:71]
s_add_u32 s42,s42,2097152
v_mfma_f32_16x16x32_bf16 v[76:79],a[232:235],v[232:235],v[76:79]
v_mfma_f32_16x16x32_bf16 v[68:71],a[108:111],v[236:239],v[68:71]
v_mfma_f32_16x16x32_bf16 v[76:79],a[236:239],v[236:239],v[76:79]
s_xor_b32 s42,s42,0x2000
s_waitcnt lgkmcnt(2)
v_mfma_f32_16x16x32_bf16 v[68:71],a[112:115],v[240:243],v[68:71]
v_mfma_f32_16x16x32_bf16 v[76:79],a[240:243],v[240:243],v[76:79]
v_mfma_f32_16x16x32_bf16 v[68:71],a[116:119],v[244:247],v[68:71]
s_cmp_lt_u32 s42,165675008
s_cselect_b32 s42,s42,0x7fff0000
v_mfma_f32_16x16x32_bf16 v[76:79],a[244:247],v[244:247],v[76:79]
s_waitcnt lgkmcnt(0)
v_mfma_f32_16x16x32_bf16 v[68:71],a[120:123],v[248:251],v[68:71]
v_mfma_f32_16x16x32_bf16 v[76:79],a[248:251],v[248:251],v[76:79]
v_mfma_f32_16x16x32_bf16 v[68:71],a[124:127],v[252:255],v[68:71]
v_mfma_f32_16x16x32_bf16 v[76:79],a[252:255],v[252:255],v[76:79]
v_xor_b32 v17,0x10000,v17
s_mov_b32 s79,s77
s_nop 4
v_cvt_pk_bf16_f32 v92,v68,v69
v_cvt_pk_bf16_f32 v93,v70,v71
v_cvt_pk_bf16_f32 v94,v76,v77
v_cvt_pk_bf16_f32 v95,v78,v79
buffer_store_dwordx4 v[92:95],v18,s[20:23],s70 offen offset:1024 sc1
s_cmp_lt_u32 s79,64
s_cbranch_scc1 qloop_181
s_waitcnt vmcnt(0)
s_barrier
s_cmp_lg_u32 s41,64
s_cbranch_scc1 np3_187
s_cmp_lg_u32 s50,0
s_cbranch_scc1 ow_188
s_mov_b64 exec,1
v_mov_b32 v22,14
v_mov_b32 v23,0
s_mov_b32 s64,21052992
buffer_atomic_add v22,v23,s[20:23],s64 offen sc1
s_mov_b64 exec,-1
ow_188:
np3_187:
s_cmp_lg_u32 s50,0
s_cbranch_scc1 ow_189
s_mov_b64 exec,1
v_mov_b32 v22,18
v_mov_b32 v23,0
buffer_store_dword v22,v23,s[20:23],s73 offen sc1
s_mov_b64 exec,-1
ow_189:
v_lshlrev_b32 v108,16,v108
v_mul_f32 v109,s81,v108
v_exp_f32 v109,v109
s_nop 0
v_add_f32 v109,1.0,v109
v_rcp_f32 v109,v109
s_nop 0
v_mul_f32 v109,v109,v108
v_cvt_pk_bf16_f32 v109,v109,v109
v_and_b32 v108,s80,v109
v_lshlrev_b32 v110,16,v104
v_and_b32 v111,s80,v104
v_fmac_f32 v96,v110,v108
v_fmac_f32 v97,v111,v108
v_lshlrev_b32 v110,16,v105
v_and_b32 v111,s80,v105
v_fmac_f32 v98,v110,v108
v_fmac_f32 v99,v111,v108
v_lshlrev_b32 v110,16,v106
v_and_b32 v111,s80,v106
v_fmac_f32 v100,v110,v108
v_fmac_f32 v101,v111,v108
v_lshlrev_b32 v110,16,v107
v_and_b32 v111,s80,v107
v_fmac_f32 v102,v110,v108
v_fmac_f32 v103,v111,v108
v_lshlrev_b32 v120,16,v120
v_mul_f32 v109,s81,v120
v_exp_f32 v109,v109
s_nop 0
v_add_f32 v109,1.0,v109
v_rcp_f32 v109,v109
s_nop 0
v_mul_f32 v109,v109,v120
v_cvt_pk_bf16_f32 v109,v109,v109
v_and_b32 v120,s80,v109
v_lshlrev_b32 v110,16,v116
v_and_b32 v111,s80,v116
v_fmac_f32 v96,v110,v120
v_fmac_f32 v97,v111,v120
v_lshlrev_b32 v110,16,v117
v_and_b32 v111,s80,v117
v_fmac_f32 v98,v110,v120
v_fmac_f32 v99,v111,v120
v_lshlrev_b32 v110,16,v118
v_and_b32 v111,s80,v118
v_fmac_f32 v100,v110,v120
v_fmac_f32 v101,v111,v120
v_lshlrev_b32 v110,16,v119
v_and_b32 v111,s80,v119
v_fmac_f32 v102,v110,v120
v_fmac_f32 v103,v111,v120
v_lshlrev_b32 v5,5,v0
ds_write_b128 v5,v[96:99]
ds_write_b128 v5,v[100:103] offset:16
v_and_b32 v6,31,v0
v_lshrrev_b32 v7,5,v0
v_lshlrev_b32 v7,10,v7
v_lshl_add_u32 v7,v6,2,v7
s_waitcnt lgkmcnt(0)
s_barrier
ds_read_b32 v8,v7 offset:0
ds_read_b32 v9,v7 offset:128
ds_read_b32 v10,v7 offset:256
ds_read_b32 v11,v7 offset:384
ds_read_b32 v12,v7 offset:512
ds_read_b32 v13,v7 offset:640
ds_read_b32 v14,v7 offset:768
ds_read_b32 v15,v7 offset:896
s_waitcnt lgkmcnt(0)
v_add_f32 v8,v8,v9
v_add_f32 v8,v8,v10
v_add_f32 v8,v8,v11
v_add_f32 v8,v8,v12
v_add_f32 v8,v8,v13
v_add_f32 v8,v8,v14
v_add_f32 v8,v8,v15
v_lshlrev_b32 v5,2,v0
ds_write_b32 v5,v8 offset:8192
v_lshlrev_b32 v7,2,v6
s_waitcnt lgkmcnt(0)
s_barrier
ds_read_b32 v8,v7 offset:8192
ds_read_b32 v9,v7 offset:8320
ds_read_b32 v10,v7 offset:8448
ds_read_b32 v11,v7 offset:8576
ds_read_b32 v12,v7 offset:8704
ds_read_b32 v13,v7 offset:8832
ds_read_b32 v14,v7 offset:8960
ds_read_b32 v15,v7 offset:9088
s_waitcnt lgkmcnt(0)
v_add_f32 v8,v8,v9
v_add_f32 v8,v8,v10
v_add_f32 v8,v8,v11
v_add_f32 v8,v8,v12
v_add_f32 v8,v8,v13
v_add_f32 v8,v8,v14
v_add_f32 v8,v8,v15
v_cvt_pk_bf16_f32 v8,v8,v8
v_and_b32 v8,s80,v8
s_lshl_b32 s64,s55,7
s_add_u32 s64,s64,8192
s_cmp_lg_u32 s50,0
s_cbranch_scc1 ow_190
buffer_store_dword v8,v7,s[20:23],s64 offen sc1
ow_190:
s_waitcnt vmcnt(0)
s_barrier
s_cmp_lg_u32 s50,0
s_cbranch_scc1 ow_191
s_mov_b64 exec,1
v_mov_b32 v22,14
v_mov_b32 v23,0
s_mov_b32 s64,21052032
buffer_atomic_add v22,v23,s[20:23],s64 offen sc1
s_mov_b64 exec,-1
ow_191:
s_mov_b32 s57,65
s_mov_b32 s79,0
s_branch common_192
pipe_second:
s_cmp_ge_u32 s59,18
s_cbranch_scc1 giveup_176
s_getpc_b64 s[4:5]
pc2nd:
s_sub_u32 s8,s4,pc2nd-mega_kernel
s_subb_u32 s9,s5,0
s_and_b32 s9,s9,0xffff
s_mov_b32 s10,code_end-mega_kernel
s_mov_b32 s11,0x20000
s_lshl_b32 s12,s59,15
v_lshlrev_b32 v2,7,v0
buffer_load_dword v2,v2,s[8:11],s12 offen
s_add_u32 s55,s57,128
s_and_b32 s64,s59,1
s_lshl_b32 s65,s58,1
s_add_u32 s64,s64,s65
s_lshl_b32 s65,s59,2
s_and_b32 s65,s65,24
s_add_u32 s65,s65,s64
s_add_u32 s64,s64,24
s_cmp_ge_u32 s59,16
s_cselect_b32 s64,s64,s65
s_lshl_b32 s65,s58,3
s_add_u32 s65,s65,s59
s_lshr_b32 s58,s59,3
s_add_u32 s58,s58,1
s_cmp_lt_u32 s59,8
s_cselect_b32 s59,s65,s64
s_xor_b32 s62,s61,0x2000
s_add_u32 s63,s62,21053440
s_mov_b32 s57,65
s_mov_b32 s79,64
s_mov_b32 s90,400000
common_192:
v_and_b32 v1,63,v0
v_and_b32 v3,15,v1
v_lshrrev_b32 v4,4,v1
v_lshlrev_b32 v16,4,v1
v_mov_b32 v48,0
v_mov_b32 v49,0
v_mov_b32 v50,0
v_mov_b32 v51,0
s_mov_b64 s[24:25],s[20:21]
s_mov_b64 s[28:29],s[20:21]
s_mov_b32 s27,0x20000
s_mov_b32 s31,0x20000
s_cmp_eq_u32 s56,0
s_cselect_b32 s26,s22,0
s_cselect_b32 s30,0,s22
s_add_u32 s71,s79,1
s_lshl_b32 s60,s79,4
s_mov_b32 s98,0
s_mov_b32 s99,0
v_mov_b32 v29,0
v_cmp_eq_u32 vcc,0,v1
v_mov_b32 v23,0x40000000
s_nop 0
v_cndmask_b32 v23,v23,v48,vcc
s_mov_b32 s80,0xffff0000
s_cmp_eq_u32 s58,0
s_cbranch_scc1 r_wo_193
s_cmp_eq_u32 s58,1
s_cbranch_scc1 r_w3_194
s_cmp_eq_u32 s58,2
s_cbranch_scc1 r_w4_195
s_and_b32 s41,s59,15
s_cmp_lt_u32 s59,16
s_cbranch_scc1 r_at_198
s_cmp_ge_u32 s59,24
s_cbranch_scc1 r_w2_196
s_load_dwordx2 s[4:5],s[0:1],64
s_and_b32 s41,s59,7
s_lshl_b32 s66,s41,8
s_lshl_b32 s67,s50,1
s_waitcnt lgkmcnt(0)
s_mov_b32 s32,s4
s_and_b32 s33,s5,0xffff
s_mov_b32 s34,0x200000
s_mov_b32 s35,0x20000
v_lshrrev_b32 v5,2,v3
v_lshl_add_u32 v7,v4,3,v5
v_and_b32 v6,3,v3
v_lshlrev_b32 v6,3,v6
v_lshl_add_u32 v6,v7,8,v6
v_and_b32 v7,1,v4
v_lshl_add_u32 v5,v7,2,v5
v_xor_b32 v5,s67,v5
v_lshl_add_u32 v12,v5,5,v6
v_xor_b32 v13,32,v12
v_and_b32 v5,15,v1
v_and_b32 v6,3,v4
v_lshlrev_b32 v6,1,v6
v_xor_b32 v5,v5,v6
v_mul_u32_u24 v6,2048,v4
v_xor_b32 v7,0,v5
v_lshl_add_u32 v8,v7,4,v6
v_xor_b32 v7,8,v5
v_lshl_add_u32 v9,v7,4,v6
s_mul_i32 s74,s50,131072
s_add_u32 s74,s74,s66
s_lshl_b32 s75,s50,14
s_mul_i32 s76,s50,65536
s_add_u32 s76,s76,s66
s_lshl_b32 s77,s50,13
s_add_u32 s64,s74,0
s_add_u32 m0,s75,0
s_nop 0
buffer_load_dwordx4 v8,s[32:35],s64 offen nt lds
s_add_u32 s64,s74,8192
s_add_u32 m0,s75,1024
s_nop 0
buffer_load_dwordx4 v8,s[32:35],s64 offen nt lds
s_add_u32 s64,s74,16384
s_add_u32 m0,s75,2048
s_nop 0
buffer_load_dwordx4 v9,s[32:35],s64 offen nt lds
s_add_u32 s64,s74,24576
s_add_u32 m0,s75,3072
s_nop 0
buffer_load_dwordx4 v9,s[32:35],s64 offen nt lds
s_add_u32 s64,s74,32768
s_add_u32 m0,s75,4096
s_nop 0
buffer_load_dwordx4 v8,s[32:35],s64 offen nt lds
s_add_u32 s64,s74,40960
s_add_u32 m0,s75,5120
s_nop 0
buffer_load_dwordx4 v8,s[32:35],s64 offen nt lds
s_add_u32 s64,s74,49152
s_add_u32 m0,s75,6144
s_nop 0
buffer_load_dwordx4 v9,s[32:35],s64 offen nt lds
s_add_u32 s64,s74,57344
s_add_u32 m0,s75,7168
s_nop 0
buffer_load_dwordx4 v9,s[32:35],s64 offen nt lds
s_add_u32 s64,s74,65536
s_add_u32 m0,s75,8192
s_nop 0
buffer_load_dwordx4 v8,s[32:35],s64 offen nt lds
s_add_u32 s64,s74,73728
s_add_u32 m0,s75,9216
s_nop 0
buffer_load_dwordx4 v8,s[32:35],s64 offen nt lds
s_add_u32 s64,s74,81920
s_add_u32 m0,s75,10240
s_nop 0
buffer_load_dwordx4 v9,s[32:35],s64 offen nt lds
s_add_u32 s64,s74,90112
s_add_u32 m0,s75,11264
s_nop 0
buffer_load_dwordx4 v9,s[32:35],s64 offen nt lds
s_add_u32 s64,s74,98304
s_add_u32 m0,s75,12288
s_nop 0
buffer_load_dwordx4 v8,s[32:35],s64 offen nt lds
s_add_u32 s64,s74,106496
s_add_u32 m0,s75,13312
s_nop 0
buffer_load_dwordx4 v8,s[32:35],s64 offen nt lds
s_add_u32 s64,s74,114688
s_add_u32 m0,s75,14336
s_nop 0
buffer_load_dwordx4 v9,s[32:35],s64 offen nt lds
s_add_u32 s64,s74,122880
s_add_u32 m0,s75,15360
s_nop 0
buffer_load_dwordx4 v9,s[32:35],s64 offen nt lds
s_add_u32 s64,s74,524288
s_add_u32 m0,s75,65536
s_nop 0
buffer_load_dwordx4 v8,s[32:35],s64 offen nt lds
s_add_u32 s64,s74,532480
s_add_u32 m0,s75,66560
s_nop 0
buffer_load_dwordx4 v8,s[32:35],s64 offen nt lds
s_add_u32 s64,s74,540672
s_add_u32 m0,s75,67584
s_nop 0
buffer_load_dwordx4 v9,s[32:35],s64 offen nt lds
s_add_u32 s64,s74,548864
s_add_u32 m0,s75,68608
s_nop 0
buffer_load_dwordx4 v9,s[32:35],s64 offen nt lds
s_add_u32 s64,s74,557056
s_add_u32 m0,s75,69632
s_nop 0
buffer_load_dwordx4 v8,s[32:35],s64 offen nt lds
s_add_u32 s64,s74,565248
s_add_u32 m0,s75,70656
s_nop 0
buffer_load_dwordx4 v8,s[32:35],s64 offen nt lds
s_add_u32 s64,s74,573440
s_add_u32 m0,s75,71680
s_nop 0
buffer_load_dwordx4 v9,s[32:35],s64 offen nt lds
s_add_u32 s64,s74,581632
s_add_u32 m0,s75,72704
s_nop 0
buffer_load_dwordx4 v9,s[32:35],s64 offen nt lds
s_add_u32 s64,s74,589824
s_add_u32 m0,s75,73728
s_nop 0
buffer_load_dwordx4 v8,s[32:35],s64 offen nt lds
s_add_u32 s64,s74,598016
s_add_u32 m0,s75,74752
s_nop 0
buffer_load_dwordx4 v8,s[32:35],s64 offen nt lds
s_add_u32 s64,s74,606208
s_add_u32 m0,s75,75776
s_nop 0
buffer_load_dwordx4 v9,s[32:35],s64 offen nt lds
s_add_u32 s64,s74,614400
s_add_u32 m0,s75,76800
s_nop 0
buffer_load_dwordx4 v9,s[32:35],s64 offen nt lds
s_add_u32 s64,s74,622592
s_add_u32 m0,s75,77824
s_nop 0
buffer_load_dwordx4 v8,s[32:35],s64 offen nt lds
s_add_u32 s64,s74,630784
s_add_u32 m0,s75,78848
s_nop 0
buffer_load_dwordx4 v8,s[32:35],s64 offen nt lds
s_add_u32 s64,s74,638976
s_add_u32 m0,s75,79872
s_nop 0
buffer_load_dwordx4 v9,s[32:35],s64 offen nt lds
s_add_u32 s64,s74,647168
s_add_u32 m0,s75,80896
s_nop 0
buffer_load_dwordx4 v9,s[32:35],s64 offen nt lds
s_waitcnt vmcnt(16)
s_barrier
ds_read_b64_tr_b16 a[0:1],v12 offset:0
ds_read_b64_tr_b16 a[128:129],v13 offset:0
ds_read_b64_tr_b16 a[2:3],v12 offset:1024
ds_read_b64_tr_b16 a[130:131],v13 offset:1024
ds_read_b64_tr_b16 a[4:5],v12 offset:8192
ds_read_b64_tr_b16 a[132:133],v13 offset:8192
ds_read_b64_tr_b16 a[6:7],v12 offset:9216
ds_read_b64_tr_b16 a[134:135],v13 offset:9216
s_waitcnt lgkmcnt(4)
ds_read_b64_tr_b16 a[8:9],v12 offset:16384
ds_read_b64_tr_b16 a[136:137],v13 offset:16384
ds_read_b64_tr_b16 a[10:11],v12 offset:17408
ds_read_b64_tr_b16 a[138:139],v13 offset:17408
ds_read_b64_tr_b16 a[12:13],v12 offset:24576
ds_read_b64_tr_b16 a[140:141],v13 offset:24576
ds_read_b64_tr_b16 a[14:15],v12 offset:25600
ds_read_b64_tr_b16 a[142:143],v13 offset:25600
s_waitcnt lgkmcnt(4)
ds_read_b64_tr_b16 a[16:17],v12 offset:32768
ds_read_b64_tr_b16 a[144:145],v13 offset:32768
ds_read_b64_tr_b16 a[18:19],v12 offset:33792
ds_read_b64_tr_b16 a[146:147],v13 offset:33792
ds_read_b64_tr_b16 a[20:21],v12 offset:40960
ds_read_b64_tr_b16 a[148:149],v13 offset:40960
ds_read_b64_tr_b16 a[22:23],v12 offset:41984
ds_read_b64_tr_b16 a[150:151],v13 offset:41984
s_waitcnt lgkmcnt(4)
ds_read_b64_tr_b16 a[24:25],v12 offset:49152
ds_read_b64_tr_b16 a[152:153],v13 offset:49152
ds_read_b64_tr_b16 a[26:27],v12 offset:50176
ds_read_b64_tr_b16 a[154:155],v13 offset:50176
ds_read_b64_tr_b16 a[28:29],v12 offset:57344
ds_read_b64_tr_b16 a[156:157],v13 offset:57344
ds_read_b64_tr_b16 a[30:31],v12 offset:58368
ds_read_b64_tr_b16 a[158:159],v13 offset:58368
s_waitcnt lgkmcnt(4)
v_xor_b32 v12,0x10000,v12
v_xor_b32 v13,0x10000,v13
s_waitcnt lgkmcnt(0)
s_barrier
s_add_u32 s64,s74,1048576
s_add_u32 m0,s75,0
s_nop 0
buffer_load_dwordx4 v8,s[32:35],s64 offen nt lds
s_add_u32 s64,s74,1056768
s_add_u32 m0,s75,1024
s_nop 0
buffer_load_dwordx4 v8,s[32:35],s64 offen nt lds
s_add_u32 s64,s74,1064960
s_add_u32 m0,s75,2048
s_nop 0
buffer_load_dwordx4 v9,s[32:35],s64 offen nt lds
s_add_u32 s64,s74,1073152
s_add_u32 m0,s75,3072
s_nop 0
buffer_load_dwordx4 v9,s[32:35],s64 offen nt lds
s_add_u32 s64,s74,1081344
s_add_u32 m0,s75,4096
s_nop 0
buffer_load_dwordx4 v8,s[32:35],s64 offen nt lds
s_add_u32 s64,s74,1089536
s_add_u32 m0,s75,5120
s_nop 0
buffer_load_dwordx4 v8,s[32:35],s64 offen nt lds
s_add_u32 s64,s74,1097728
s_add_u32 m0,s75,6144
s_nop 0
buffer_load_dwordx4 v9,s[32:35],s64 offen nt lds
s_add_u32 s64,s74,1105920
s_add_u32 m0,s75,7168
s_nop 0
buffer_load_dwordx4 v9,s[32:35],s64 offen nt lds
s_add_u32 s64,s74,1114112
s_add_u32 m0,s75,8192
s_nop 0
buffer_load_dwordx4 v8,s[32:35],s64 offen nt lds
s_add_u32 s64,s74,1122304
s_add_u32 m0,s75,9216
s_nop 0
buffer_load_dwordx4 v8,s[32:35],s64 offen nt lds
s_add_u32 s64,s74,1130496
s_add_u32 m0,s75,10240
s_nop 0
buffer_load_dwordx4 v9,s[32:35],s64 offen nt lds
s_add_u32 s64,s74,1138688
s_add_u32 m0,s75,11264
s_nop 0
buffer_load_dwordx4 v9,s[32:35],s64 offen nt lds
s_add_u32 s64,s74,1146880
s_add_u32 m0,s75,12288
s_nop 0
buffer_load_dwordx4 v8,s[32:35],s64 offen nt lds
s_add_u32 s64,s74,1155072
s_add_u32 m0,s75,13312
s_nop 0
buffer_load_dwordx4 v8,s[32:35],s64 offen nt lds
s_add_u32 s64,s74,1163264
s_add_u32 m0,s75,14336
s_nop 0
buffer_load_dwordx4 v9,s[32:35],s64 offen nt lds
s_add_u32 s64,s74,1171456
s_add_u32 m0,s75,15360
s_nop 0
buffer_load_dwordx4 v9,s[32:35],s64 offen nt lds
s_waitcnt vmcnt(16)
s_barrier
ds_read_b64_tr_b16 a[32:33],v12 offset:0
ds_read_b64_tr_b16 a[160:161],v13 offset:0
ds_read_b64_tr_b16 a[34:35],v12 offset:1024
ds_read_b64_tr_b16 a[162:163],v13 offset:1024
ds_read_b64_tr_b16 a[36:37],v12 offset:8192
ds_read_b64_tr_b16 a[164:165],v13 offset:8192
ds_read_b64_tr_b16 a[38:39],v12 offset:9216
ds_read_b64_tr_b16 a[166:167],v13 offset:9216
s_waitcnt lgkmcnt(4)
ds_read_b64_tr_b16 a[40:41],v12 offset:16384
ds_read_b64_tr_b16 a[168:169],v13 offset:16384
ds_read_b64_tr_b16 a[42:43],v12 offset:17408
ds_read_b64_tr_b16 a[170:171],v13 offset:17408
ds_read_b64_tr_b16 a[44:45],v12 offset:24576
ds_read_b64_tr_b16 a[172:173],v13 offset:24576
ds_read_b64_tr_b16 a[46:47],v12 offset:25600
ds_read_b64_tr_b16 a[174:175],v13 offset:25600
s_waitcnt lgkmcnt(4)
ds_read_b64_tr_b16 a[48:49],v12 offset:32768
ds_read_b64_tr_b16 a[176:177],v13 offset:32768
ds_read_b64_tr_b16 a[50:51],v12 offset:33792
ds_read_b64_tr_b16 a[178:179],v13 offset:33792
ds_read_b64_tr_b16 a[52:53],v12 offset:40960
ds_read_b64_tr_b16 a[180:181],v13 offset:40960
ds_read_b64_tr_b16 a[54:55],v12 offset:41984
ds_read_b64_tr_b16 a[182:183],v13 offset:41984
s_waitcnt lgkmcnt(4)
ds_read_b64_tr_b16 a[56:57],v12 offset:49152
ds_read_b64_tr_b16 a[184:185],v13 offset:49152
ds_read_b64_tr_b16 a[58:59],v12 offset:50176
ds_read_b64_tr_b16 a[186:187],v13 offset:50176
ds_read_b64_tr_b16 a[60:61],v12 offset:57344
ds_read_b64_tr_b16 a[188:189],v13 offset:57344
ds_read_b64_tr_b16 a[62:63],v12 offset:58368
ds_read_b64_tr_b16 a[190:191],v13 offset:58368
s_waitcnt lgkmcnt(4)
v_xor_b32 v12,0x10000,v12
v_xor_b32 v13,0x10000,v13
s_waitcnt lgkmcnt(0)
s_barrier
s_add_u32 s64,s74,1572864
s_add_u32 m0,s75,65536
s_nop 0
buffer_load_dwordx4 v8,s[32:35],s64 offen nt lds
s_add_u32 s64,s74,1581056
s_add_u32 m0,s75,66560
s_nop 0
buffer_load_dwordx4 v8,s[32:35],s64 offen nt lds
s_add_u32 s64,s74,1589248
s_add_u32 m0,s75,67584
s_nop 0
buffer_load_dwordx4 v9,s[32:35],s64 offen nt lds
s_add_u32 s64,s74,1597440
s_add_u32 m0,s75,68608
s_nop 0
buffer_load_dwordx4 v9,s[32:35],s64 offen nt lds
s_add_u32 s64,s74,1605632
s_add_u32 m0,s75,69632
s_nop 0
buffer_load_dwordx4 v8,s[32:35],s64 offen nt lds
s_add_u32 s64,s74,1613824
s_add_u32 m0,s75,70656
s_nop 0
buffer_load_dwordx4 v8,s[32:35],s64 offen nt lds
s_add_u32 s64,s74,1622016
s_add_u32 m0,s75,71680
s_nop 0
buffer_load_dwordx4 v9,s[32:35],s64 offen nt lds
s_add_u32 s64,s74,1630208
s_add_u32 m0,s75,72704
s_nop 0
buffer_load_dwordx4 v9,s[32:35],s64 offen nt lds
s_add_u32 s64,s74,1638400
s_add_u32 m0,s75,73728
s_nop 0
buffer_load_dwordx4 v8,s[32:35],s64 offen nt lds
s_add_u32 s64,s74,1646592
s_add_u32 m0,s75,74752
s_nop 0
buffer_load_dwordx4 v8,s[32:35],s64 offen nt lds
s_add_u32 s64,s74,1654784
s_add_u32 m0,s75,75776
s_nop 0
buffer_load_dwordx4 v9,s[32:35],s64 offen nt lds
s_add_u32 s64,s74,1662976
s_add_u32 m0,s75,76800
s_nop 0
buffer_load_dwordx4 v9,s[32:35],s64 offen nt lds
s_add_u32 s64,s74,1671168
s_add_u32 m0,s75,77824
s_nop 0
buffer_load_dwordx4 v8,s[32:35],s64 offen nt lds
s_add_u32 s64,s74,1679360
s_add_u32 m0,s75,78848
s_nop 0
buffer_load_dwordx4 v8,s[32:35],s64 offen nt lds
s_add_u32 s64,s74,1687552
s_add_u32 m0,s75,79872
s_nop 0
buffer_load_dwordx4 v9,s[32:35],s64 offen nt lds
s_add_u32 s64,s74,1695744
s_add_u32 m0,s75,80896
s_nop 0
buffer_load_dwordx4 v9,s[32:35],s64 offen nt lds
s_waitcnt vmcnt(16)
s_barrier
ds_read_b64_tr_b16 a[64:65],v12 offset:0
ds_read_b64_tr_b16 a[192:193],v13 offset:0
ds_read_b64_tr_b16 a[66:67],v12 offset:1024
ds_read_b64_tr_b16 a[194:195],v13 offset:1024
ds_read_b64_tr_b16 a[68:69],v12 offset:8192
ds_read_b64_tr_b16 a[196:197],v13 offset:8192
ds_read_b64_tr_b16 a[70:71],v12 offset:9216
ds_read_b64_tr_b16 a[198:199],v13 offset:9216
s_waitcnt lgkmcnt(4)
ds_read_b64_tr_b16 a[72:73],v12 offset:16384
ds_read_b64_tr_b16 a[200:201],v13 offset:16384
ds_read_b64_tr_b16 a[74:75],v12 offset:17408
ds_read_b64_tr_b16 a[202:203],v13 offset:17408
ds_read_b64_tr_b16 a[76:77],v12 offset:24576
ds_read_b64_tr_b16 a[204:205],v13 offset:24576
ds_read_b64_tr_b16 a[78:79],v12 offset:25600
ds_read_b64_tr_b16 a[206:207],v13 offset:25600
s_waitcnt lgkmcnt(4)
ds_read_b64_tr_b16 a[80:81],v12 offset:32768
ds_read_b64_tr_b16 a[208:209],v13 offset:32768
ds_read_b64_tr_b16 a[82:83],v12 offset:33792
ds_read_b64_tr_b16 a[210:211],v13 offset:33792
ds_read_b64_tr_b16 a[84:85],v12 offset:40960
ds_read_b64_tr_b16 a[212:213],v13 offset:40960
ds_read_b64_tr_b16 a[86:87],v12 offset:41984
ds_read_b64_tr_b16 a[214:215],v13 offset:41984
s_waitcnt lgkmcnt(4)
ds_read_b64_tr_b16 a[88:89],v12 offset:49152
ds_read_b64_tr_b16 a[216:217],v13 offset:49152
ds_read_b64_tr_b16 a[90:91],v12 offset:50176
ds_read_b64_tr_b16 a[218:219],v13 offset:50176
ds_read_b64_tr_b16 a[92:93],v12 offset:57344
ds_read_b64_tr_b16 a[220:221],v13 offset:57344
ds_read_b64_tr_b16 a[94:95],v12 offset:58368
ds_read_b64_tr_b16 a[222:223],v13 offset:58368
s_waitcnt lgkmcnt(4)
v_xor_b32 v12,0x10000,v12
v_xor_b32 v13,0x10000,v13
s_waitcnt lgkmcnt(0)
s_barrier
s_waitcnt vmcnt(0)
s_barrier
ds_read_b64_tr_b16 a[96:97],v12 offset:0
ds_read_b64_tr_b16 a[224:225],v13 offset:0
ds_read_b64_tr_b16 a[98:99],v12 offset:1024
ds_read_b64_tr_b16 a[226:227],v13 offset:1024
ds_read_b64_tr_b16 a[100:101],v12 offset:8192
ds_read_b64_tr_b16 a[228:229],v13 offset:8192
ds_read_b64_tr_b16 a[102:103],v12 offset:9216
ds_read_b64_tr_b16 a[230:231],v13 offset:9216
s_waitcnt lgkmcnt(4)
ds_read_b64_tr_b16 a[104:105],v12 offset:16384
ds_read_b64_tr_b16 a[232:233],v13 offset:16384
ds_read_b64_tr_b16 a[106:107],v12 offset:17408
ds_read_b64_tr_b16 a[234:235],v13 offset:17408
ds_read_b64_tr_b16 a[108:109],v12 offset:24576
ds_read_b64_tr_b16 a[236:237],v13 offset:24576
ds_read_b64_tr_b16 a[110:111],v12 offset:25600
ds_read_b64_tr_b16 a[238:239],v13 offset:25600
s_waitcnt lgkmcnt(4)
ds_read_b64_tr_b16 a[112:113],v12 offset:32768
ds_read_b64_tr_b16 a[240:241],v13 offset:32768
ds_read_b64_tr_b16 a[114:115],v12 offset:33792
ds_read_b64_tr_b16 a[242:243],v13 offset:33792
ds_read_b64_tr_b16 a[116:117],v12 offset:40960
ds_read_b64_tr_b16 a[244:245],v13 offset:40960
ds_read_b64_tr_b16 a[118:119],v12 offset:41984
ds_read_b64_tr_b16 a[246:247],v13 offset:41984
s_waitcnt lgkmcnt(4)
ds_read_b64_tr_b16 a[120:121],v12 offset:49152
ds_read_b64_tr_b16 a[248:249],v13 offset:49152
ds_read_b64_tr_b16 a[122:123],v12 offset:50176
ds_read_b64_tr_b16 a[250:251],v13 offset:50176
ds_read_b64_tr_b16 a[124:125],v12 offset:57344
ds_read_b64_tr_b16 a[252:253],v13 offset:57344
ds_read_b64_tr_b16 a[126:127],v12 offset:58368
ds_read_b64_tr_b16 a[254:255],v13 offset:58368
s_waitcnt lgkmcnt(4)
v_xor_b32 v12,0x10000,v12
v_xor_b32 v13,0x10000,v13
s_waitcnt lgkmcnt(0)
s_barrier
v_and_b32 v21,1,v1
v_mul_u32_u24 v21,960,v21
s_mov_b32 s65,21052032
s_mov_b32 s66,1792
pl_199:
buffer_load_dword v22,v21,s[20:23],s65 offen sc1
s_waitcnt vmcnt(0)
v_cmp_gt_u32 vcc,s66,v22
s_cbranch_vccz pok_200
s_sleep 1
s_sub_u32 s90,s90,1
s_cmp_gt_i32 s90,0
s_cbranch_scc1 pl_199
pok_200:
s_mov_b32 s81,0xbdd2d3e8
v_mov_b32 v28,0xc0135761
v_mov_b32 v17,v16
v_and_b32 v21,31,v1
v_lshlrev_b32 v21,2,v21
s_mul_i32 s74,s79,40
s_add_u32 s74,s74,s63
s_add_u32 s74,s74,2560
s_lshl_b32 s42,s41,2
s_add_u32 s42,s42,s50
s_lshl_b32 s73,s41,4
s_lshl_b32 s64,s50,2
s_add_u32 s73,s73,s64
s_add_u32 s73,s73,s63
s_add_u32 s73,s73,3072
s_add_u32 s73,s73,s60
s_lshl_b32 s43,s50,11
s_lshl_b32 s78,s79,21
s_add_u32 s78,s78,29360128
s_mov_b32 s64,0
s_lshr_b32 s65,s50,1
s_and_b32 s66,s50,1
s_lshl_b32 s72,s65,13
s_lshl_b32 s64,s66,11
s_add_u32 s72,s72,s64
s_add_u32 s72,s72,0x10000
s_lshl_b32 s75,s66,15
s_lshl_b32 s64,s65,7
s_add_u32 s75,s75,s64
s_add_u32 s75,s75,1835008
s_lshl_b32 s64,s66,2
v_add_u32 v5,s64,v4
v_and_b32 v6,7,v1
v_xor_b32 v5,v5,v6
v_lshlrev_b32 v5,4,v5
v_bfe_u32 v6,v1,3,2
v_lshl_add_u32 v5,v6,11,v5
v_lshrrev_b32 v6,5,v1
v_lshl_add_u32 v42,v6,14,v5
v_lshrrev_b32 v5,1,v3
v_xor_b32 v5,v5,v4
v_lshlrev_b32 v5,4,v5
v_and_b32 v6,7,v3
v_lshl_add_u32 v5,v6,7,v5
v_lshrrev_b32 v6,3,v3
v_lshl_add_u32 v17,v6,11,v5
v_xor_b32 v43,64,v17
s_lshr_b32 s64,s41,1
s_lshl_b32 s64,s64,2
s_lshr_b32 s64,0x0413,s64
s_and_b32 s64,s64,7
s_add_u32 s65,s41,120
s_lshl_b32 s65,s65,14
s_add_u32 s65,s65,s43
v_lshl_add_u32 v7,v4,8,s65
v_mov_b32 v9,2105344
v_add_u32 v6,s64,v3
v_and_b32 v5,15,v6
v_lshl_add_u32 v5,v5,4,v7
v_bfe_u32 v8,v6,4,1
v_lshl_add_u32 v5,v8,10,v5
v_cmp_lt_u32 vcc,31,v6
s_nop 1
v_cndmask_b32 v8,0,v9,vcc
v_add_u32 v5,v5,v8
v_xor_b32 v18,s62,v5
s_add_u32 s64,s64,16
v_add_u32 v6,s64,v3
v_and_b32 v5,15,v6
v_lshl_add_u32 v5,v5,4,v7
v_bfe_u32 v8,v6,4,1
v_lshl_add_u32 v5,v8,10,v5
v_cmp_lt_u32 vcc,31,v6
s_nop 1
v_cndmask_b32 v8,0,v9,vcc
v_add_u32 v5,v5,v8
v_xor_b32 v19,s62,v5
s_add_u32 s64,s64,16
s_mov_b64 s[84:85],vcc
v_mov_b32 v88,1
v_mov_b32 v89,0
v_mov_b32 v90,0
v_mov_b32 v91,0
v_xor_b32 v5,0x2000,v19
s_mov_b32 s64,163577856
buffer_store_dwordx4 v[88:91],v18,s[20:23],s64 offen sc1
s_andn2_b64 exec,exec,s[84:85]
buffer_store_dwordx4 v[88:91],v19,s[20:23],s64 offen sc1
s_mov_b64 exec,-1
v_mov_b32 v6,0x7fff0000
v_cndmask_b32 v5,v6,v5,s[84:85]
s_mov_b32 s64,27262976
buffer_store_dwordx4 v[88:91],v5,s[20:23],s64 offen sc1
s_waitcnt vmcnt(0)
s_add_u32 s64,s79,0
s_lshl_b32 s70,s64,21
s_lshl_b32 s64,s64,13
s_and_b32 s64,s64,0x2000
s_xor_b32 s64,s64,s62
s_add_u32 s70,s70,s64
s_add_u32 s70,s70,29360128
s_mov_b32 s83,1
s_mov_b32 s87,s74
s_cmp_eq_u32 s50,0
s_cselect_b32 s74,s74,0x7fff0000
v_mov_b32 v45,132096
s_lshl_b32 s64,s50,2
s_add_u32 s64,s64,132112
v_mov_b32 v46,s64
v_mov_b32 v2,0
v_mov_b32 v44,1
ds_write_b32 v45,v44
s_mov_b32 s97,0x7fff0000
s_waitcnt lgkmcnt(0)
seg_202:
s_cmp_eq_u32 s83,0
s_cbranch_scc1 ahead_203
s_add_u32 s94,s70,s75
s_add_u32 s95,s94,65536
s_xor_b32 s91,s72,0x10000
s_waitcnt lgkmcnt(0)
v_cmp_gt_u32 vcc,s71,v2
s_cbranch_vccz nb_206
s_waitcnt vmcnt(3)
v_cmp_gt_u32 vcc,s71,v29
s_cbranch_vccz nb_206
s_waitcnt vmcnt(0)
v_add_u32 v22,s71,-1
buffer_store_dword v22,v23,s[24:27],s97 offen
buffer_store_dword v22,v23,s[28:31],s97 offen sc1
s_mov_b32 s97,0x7fff0000
s_cmp_lg_u32 s50,0
s_cbranch_scc1 nb_206
buffer_load_dword v32,v21,s[20:23],s74 offen sc1
s_sleep 2
pl_207:
buffer_load_dword v33,v21,s[20:23],s74 offen sc1
s_waitcnt vmcnt(1)
v_cmp_gt_u32 vcc,s71,v32
s_cbranch_vccz pok_208
buffer_load_dword v32,v21,s[20:23],s74 offen sc1
s_waitcnt vmcnt(1)
v_cmp_gt_u32 vcc,s71,v33
s_cbranch_vccz pok_208
s_sub_u32 s90,s90,1
s_cmp_gt_i32 s90,0
s_cbranch_scc1 pl_207
pok_208:
nb_206:
s_barrier
s_xor_b32 m0,s91,0
s_add_u32 s65,s94,0
buffer_load_dwordx4 v42,s[20:23],s65 offen offset:0 sc1 lds
buffer_load_dwordx4 v42,s[20:23],s65 offen offset:1024 sc1 lds
ds_read_b32 v44,v45
s_xor_b32 m0,s91,16384
s_add_u32 s65,s94,256
buffer_load_dwordx4 v42,s[20:23],s65 offen offset:0 sc1 lds
buffer_load_dwordx4 v42,s[20:23],s65 offen offset:1024 sc1 lds
s_xor_b32 m0,s91,32768
s_add_u32 s65,s94,512
buffer_load_dwordx4 v42,s[20:23],s65 offen offset:0 sc1 lds
buffer_load_dwordx4 v42,s[20:23],s65 offen offset:1024 sc1 lds
s_xor_b32 m0,s91,49152
s_add_u32 s65,s94,768
buffer_load_dwordx4 v42,s[20:23],s65 offen offset:0 sc1 lds
buffer_load_dwordx4 v42,s[20:23],s65 offen offset:1024 sc1 lds
s_xor_b32 m0,s91,4096
s_add_u32 s65,s95,0
buffer_load_dwordx4 v42,s[20:23],s65 offen offset:0 sc1 lds
buffer_load_dwordx4 v42,s[20:23],s65 offen offset:1024 sc1 lds
s_waitcnt vmcnt(10)
v_add_u32 v22,s71,-1
buffer_store_dword v22,v23,s[24:27],s97 offen
buffer_store_dword v22,v23,s[28:31],s97 offen sc1
s_mov_b32 s97,0x7fff0000
s_waitcnt lgkmcnt(0)
v_readfirstlane_b32 s83,v44
s_cmp_eq_u32 s83,0
s_cbranch_scc1 both_205
s_waitcnt vmcnt(10)
s_barrier
ds_read_b128 v[224:227],v17 offset:0
ds_read_b128 v[228:231],v43 offset:0
ds_read_b128 v[232:235],v17 offset:8192
ds_read_b128 v[236:239],v43 offset:8192
ds_read_b128 v[240:243],v17 offset:1024
ds_read_b128 v[244:247],v43 offset:1024
ds_read_b128 v[248:251],v17 offset:9216
s_waitcnt lgkmcnt(5)
v_mfma_f32_16x16x32_bf16 v[64:67],a[0:3],v[224:227],0
v_min_u32 v27,v224,v228
s_xor_b32 m0,s91,20480
v_mfma_f32_16x16x32_bf16 v[72:75],a[128:131],v[224:227],0
ds_read_b128 v[252:255],v43 offset:9216
v_mfma_f32_16x16x32_bf16 v[64:67],a[4:7],v[228:231],v[64:67]
s_add_u32 s65,s95,256
v_mfma_f32_16x16x32_bf16 v[72:75],a[132:135],v[228:231],v[72:75]
s_waitcnt vmcnt(8)
s_barrier
ds_read_b128 v[224:227],v17 offset:16384
s_waitcnt lgkmcnt(5)
v_mfma_f32_16x16x32_bf16 v[64:67],a[8:11],v[232:235],v[64:67]
v_min3_u32 v27,v27,v232,v236
buffer_load_dwordx4 v42,s[20:23],s65 offen offset:0 sc1 lds
v_mfma_f32_16x16x32_bf16 v[72:75],a[136:139],v[232:235],v[72:75]
ds_read_b128 v[228:231],v43 offset:16384
v_mfma_f32_16x16x32_bf16 v[64:67],a[12:15],v[236:239],v[64:67]
buffer_load_dwordx4 v42,s[20:23],s65 offen offset:1024 sc1 lds
v_mfma_f32_16x16x32_bf16 v[72:75],a[140:143],v[236:239],v[72:75]
ds_read_b128 v[232:235],v17 offset:24576
s_waitcnt lgkmcnt(5)
v_mfma_f32_16x16x32_bf16 v[64:67],a[64:67],v[240:243],v[64:67]
v_min3_u32 v27,v27,v240,v244
s_xor_b32 m0,s91,36864
v_mfma_f32_16x16x32_bf16 v[72:75],a[192:195],v[240:243],v[72:75]
ds_read_b128 v[236:239],v43 offset:24576
v_mfma_f32_16x16x32_bf16 v[64:67],a[68:71],v[244:247],v[64:67]
s_add_u32 s65,s95,512
v_mfma_f32_16x16x32_bf16 v[72:75],a[196:199],v[244:247],v[72:75]
ds_read_b128 v[240:243],v17 offset:17408
s_waitcnt lgkmcnt(5)
v_mfma_f32_16x16x32_bf16 v[64:67],a[72:75],v[248:251],v[64:67]
v_min3_u32 v27,v27,v248,v252
buffer_load_dwordx4 v42,s[20:23],s65 offen offset:0 sc1 lds
v_mfma_f32_16x16x32_bf16 v[72:75],a[200:203],v[248:251],v[72:75]
ds_read_b128 v[244:247],v43 offset:17408
v_mfma_f32_16x16x32_bf16 v[64:67],a[76:79],v[252:255],v[64:67]
buffer_load_dwordx4 v42,s[20:23],s65 offen offset:1024 sc1 lds
v_mfma_f32_16x16x32_bf16 v[72:75],a[204:207],v[252:255],v[72:75]
ds_read_b128 v[248:251],v17 offset:25600
s_waitcnt lgkmcnt(5)
v_mfma_f32_16x16x32_bf16 v[64:67],a[16:19],v[224:227],v[64:67]
v_min3_u32 v27,v27,v224,v228
s_xor_b32 m0,s91,53248
v_mfma_f32_16x16x32_bf16 v[72:75],a[144:147],v[224:227],v[72:75]
ds_read_b128 v[252:255],v43 offset:25600
v_mfma_f32_16x16x32_bf16 v[64:67],a[20:23],v[228:231],v[64:67]
s_add_u32 s65,s95,768
v_mfma_f32_16x16x32_bf16 v[72:75],a[148:151],v[228:231],v[72:75]
s_waitcnt vmcnt(8)
s_barrier
ds_read_b128 v[224:227],v17 offset:32768
s_waitcnt lgkmcnt(5)
v_mfma_f32_16x16x32_bf16 v[64:67],a[24:27],v[232:235],v[64:67]
v_min3_u32 v27,v27,v232,v236
buffer_load_dwordx4 v42,s[20:23],s65 offen offset:0 sc1 lds
v_mfma_f32_16x16x32_bf16 v[72:75],a[152:155],v[232:235],v[72:75]
ds_read_b128 v[228:231],v43 offset:32768
v_mfma_f32_16x16x32_bf16 v[64:67],a[28:31],v[236:239],v[64:67]
buffer_load_dwordx4 v42,s[20:23],s65 offen offset:1024 sc1 lds
v_mfma_f32_16x16x32_bf16 v[72:75],a[156:159],v[236:239],v[72:75]
ds_read_b128 v[232:235],v17 offset:40960
s_waitcnt lgkmcnt(5)
v_mfma_f32_16x16x32_bf16 v[64:67],a[80:83],v[240:243],v[64:67]
v_min3_u32 v27,v27,v240,v244
v_mfma_f32_16x16x32_bf16 v[72:75],a[208:211],v[240:243],v[72:75]
ds_read_b128 v[236:239],v43 offset:40960
v_mfma_f32_16x16x32_bf16 v[64:67],a[84:87],v[244:247],v[64:67]
v_mfma_f32_16x16x32_bf16 v[72:75],a[212:215],v[244:247],v[72:75]
ds_read_b128 v[240:243],v17 offset:33792
s_waitcnt lgkmcnt(5)
v_mfma_f32_16x16x32_bf16 v[64:67],a[88:91],v[248:251],v[64:67]
v_min3_u32 v27,v27,v248,v252
v_mfma_f32_16x16x32_bf16 v[72:75],a[216:219],v[248:251],v[72:75]
ds_read_b128 v[244:247],v43 offset:33792
v_mfma_f32_16x16x32_bf16 v[64:67],a[92:95],v[252:255],v[64:67]
v_mfma_f32_16x16x32_bf16 v[72:75],a[220:223],v[252:255],v[72:75]
ds_read_b128 v[248:251],v17 offset:41984
s_waitcnt lgkmcnt(5)
v_mfma_f32_16x16x32_bf16 v[64:67],a[32:35],v[224:227],v[64:67]
v_min3_u32 v27,v27,v224,v228
v_mfma_f32_16x16x32_bf16 v[72:75],a[160:163],v[224:227],v[72:75]
ds_read_b128 v[252:255],v43 offset:41984
v_mfma_f32_16x16x32_bf16 v[64:67],a[36:39],v[228:231],v[64:67]
v_mfma_f32_16x16x32_bf16 v[72:75],a[164:167],v[228:231],v[72:75]
ds_read_b128 v[224:227],v17 offset:49152
s_waitcnt lgkmcnt(5)
v_mfma_f32_16x16x32_bf16 v[64:67],a[40:43],v[232:235],v[64:67]
v_min3_u32 v27,v27,v232,v236
v_mfma_f32_16x16x32_bf16 v[72:75],a[168:171],v[232:235],v[72:75]
ds_read_b128 v[228:231],v43 offset:49152
v_mfma_f32_16x16x32_bf16 v[64:67],a[44:47],v[236:239],v[64:67]
v_mfma_f32_16x16x32_bf16 v[72:75],a[172:175],v[236:239],v[72:75]
ds_read_b128 v[232:235],v17 offset:57344
s_waitcnt lgkmcnt(5)
v_mfma_f32_16x16x32_bf16 v[64:67],a[96:99],v[240:243],v[64:67]
v_min3_u32 v27,v27,v240,v244
v_mfma_f32_16x16x32_bf16 v[72:75],a[224:227],v[240:243],v[72:75]
ds_read_b128 v[236:239],v43 offset:57344
v_mfma_f32_16x16x32_bf16 v[64:67],a[100:103],v[244:247],v[64:67]
v_mfma_f32_16x16x32_bf16 v[72:75],a[228:231],v[244:247],v[72:75]
ds_read_b128 v[240:243],v17 offset:50176
s_waitcnt lgkmcnt(5)
v_mfma_f32_16x16x32_bf16 v[64:67],a[104:107],v[248:251],v[64:67]
v_min3_u32 v27,v27,v248,v252
v_mfma_f32_16x16x32_bf16 v[72:75],a[232:235],v[248:251],v[72:75]
ds_read_b128 v[244:247],v43 offset:50176
v_mfma_f32_16x16x32_bf16 v[64:67],a[108:111],v[252:255],v[64:67]
v_mfma_f32_16x16x32_bf16 v[72:75],a[236:239],v[252:255],v[72:75]
ds_read_b128 v[248:251],v17 offset:58368
s_waitcnt lgkmcnt(5)
v_mfma_f32_16x16x32_bf16 v[64:67],a[48:51],v[224:227],v[64:67]
v_min3_u32 v27,v27,v224,v228
v_mfma_f32_16x16x32_bf16 v[72:75],a[176:179],v[224:227],v[72:75]
ds_read_b128 v[252:255],v43 offset:58368
v_mfma_f32_16x16x32_bf16 v[64:67],a[52:55],v[228:231],v[64:67]
v_mfma_f32_16x16x32_bf16 v[72:75],a[180:183],v[228:231],v[72:75]
s_waitcnt vmcnt(0)
s_barrier
ds_read_b128 v[224:227],v17 offset:4096
s_waitcnt lgkmcnt(5)
v_mfma_f32_16x16x32_bf16 v[64:67],a[56:59],v[232:235],v[64:67]
v_min3_u32 v27,v27,v232,v236
v_mfma_f32_16x16x32_bf16 v[72:75],a[184:187],v[232:235],v[72:75]
ds_read_b128 v[228:231],v43 offset:4096
v_mfma_f32_16x16x32_bf16 v[64:67],a[60:63],v[236:239],v[64:67]
v_mfma_f32_16x16x32_bf16 v[72:75],a[188:191],v[236:239],v[72:75]
ds_read_b128 v[232:235],v17 offset:12288
s_waitcnt lgkmcnt(5)
v_mfma_f32_16x16x32_bf16 v[64:67],a[112:115],v[240:243],v[64:67]
v_min3_u32 v27,v27,v240,v244
v_mfma_f32_16x16x32_bf16 v[72:75],a[240:243],v[240:243],v[72:75]
ds_read_b128 v[236:239],v43 offset:12288
v_mfma_f32_16x16x32_bf16 v[64:67],a[116:119],v[244:247],v[64:67]
v_mfma_f32_16x16x32_bf16 v[72:75],a[244:247],v[244:247],v[72:75]
ds_read_b128 v[240:243],v17 offset:5120
s_waitcnt lgkmcnt(5)
v_mfma_f32_16x16x32_bf16 v[64:67],a[120:123],v[248:251],v[64:67]
v_min3_u32 v27,v27,v248,v252
v_mfma_f32_16x16x32_bf16 v[72:75],a[248:251],v[248:251],v[72:75]
ds_read_b128 v[244:247],v43 offset:5120
v_mfma_f32_16x16x32_bf16 v[64:67],a[124:127],v[252:255],v[64:67]
buffer_load_dword v2,v21,s[20:23],s87 offen sc1
v_mfma_f32_16x16x32_bf16 v[72:75],a[252:255],v[252:255],v[72:75]
ds_read_b128 v[248:251],v17 offset:13312
s_waitcnt lgkmcnt(5)
v_mfma_f32_16x16x32_bf16 v[68:71],a[0:3],v[224:227],0
v_cmp_eq_u32 vcc,0,v27
s_cbranch_vccnz retry_201
v_mfma_f32_16x16x32_bf16 v[76:79],a[128:131],v[224:227],0
ds_read_b128 v[252:255],v43 offset:13312
v_min3_u32 v27,v27,v224,v228
v_mfma_f32_16x16x32_bf16 v[68:71],a[4:7],v[228:231],v[68:71]
s_add_u32 s96,s71,2
v_mfma_f32_16x16x32_bf16 v[76:79],a[132:135],v[228:231],v[76:79]
ds_read_b128 v[224:227],v17 offset:20480
s_waitcnt lgkmcnt(5)
v_mfma_f32_16x16x32_bf16 v[68:71],a[8:11],v[232:235],v[68:71]
v_min3_u32 v27,v27,v232,v236
v_mul_f32 v88,v64,v64
v_mul_f32 v92,v72,v72
v_mfma_f32_16x16x32_bf16 v[76:79],a[136:139],v[232:235],v[76:79]
ds_read_b128 v[228:231],v43 offset:20480
v_mul_f32 v89,v65,v65
v_mul_f32 v93,v73,v73
v_mfma_f32_16x16x32_bf16 v[68:71],a[12:15],v[236:239],v[68:71]
v_mul_f32 v90,v66,v66
v_mul_f32 v91,v67,v67
v_mul_f32 v94,v74,v74
v_mfma_f32_16x16x32_bf16 v[76:79],a[140:143],v[236:239],v[76:79]
ds_read_b128 v[232:235],v17 offset:28672
v_mul_f32 v95,v75,v75
s_waitcnt lgkmcnt(5)
v_mfma_f32_16x16x32_bf16 v[68:71],a[64:67],v[240:243],v[68:71]
v_min3_u32 v27,v27,v240,v244
v_fma_f32 v88,v88,s81,v28
v_fma_f32 v92,v92,s81,v28
v_mfma_f32_16x16x32_bf16 v[76:79],a[192:195],v[240:243],v[76:79]
ds_read_b128 v[236:239],v43 offset:28672
v_fma_f32 v89,v89,s81,v28
v_fma_f32 v93,v93,s81,v28
v_mfma_f32_16x16x32_bf16 v[68:71],a[68:71],v[244:247],v[68:71]
v_fma_f32 v90,v90,s81,v28
v_fma_f32 v91,v91,s81,v28
v_fma_f32 v94,v94,s81,v28
v_mfma_f32_16x16x32_bf16 v[76:79],a[196:199],v[244:247],v[76:79]
ds_read_b128 v[240:243],v17 offset:21504
v_fma_f32 v95,v95,s81,v28
s_waitcnt lgkmcnt(5)
v_mfma_f32_16x16x32_bf16 v[68:71],a[72:75],v[248:251],v[68:71]
v_min3_u32 v27,v27,v248,v252
v_mul_f32 v88,v88,v64
v_mul_f32 v92,v92,v72
v_mfma_f32_16x16x32_bf16 v[76:79],a[200:203],v[248:251],v[76:79]
ds_read_b128 v[244:247],v43 offset:21504
v_mul_f32 v89,v89,v65
v_mul_f32 v93,v93,v73
v_mfma_f32_16x16x32_bf16 v[68:71],a[76:79],v[252:255],v[68:71]
v_mul_f32 v90,v90,v66
v_mul_f32 v91,v91,v67
v_mul_f32 v94,v94,v74
v_mfma_f32_16x16x32_bf16 v[76:79],a[204:207],v[252:255],v[76:79]
ds_read_b128 v[248:251],v17 offset:29696
v_mul_f32 v95,v95,v75
s_waitcnt lgkmcnt(5)
v_mfma_f32_16x16x32_bf16 v[68:71],a[16:19],v[224:227],v[68:71]
v_min3_u32 v27,v27,v224,v228
v_exp_f32 v92,v92
v_mfma_f32_16x16x32_bf16 v[76:79],a[144:147],v[224:227],v[76:79]
ds_read_b128 v[252:255],v43 offset:29696
v_exp_f32 v93,v93
v_mfma_f32_16x16x32_bf16 v[68:71],a[20:23],v[228:231],v[68:71]
v_exp_f32 v88,v88
v_mfma_f32_16x16x32_bf16 v[76:79],a[148:151],v[228:231],v[76:79]
ds_read_b128 v[224:227],v17 offset:36864
s_waitcnt lgkmcnt(5)
v_mfma_f32_16x16x32_bf16 v[68:71],a[24:27],v[232:235],v[68:71]
v_min3_u32 v27,v27,v232,v236
v_exp_f32 v94,v94
v_mfma_f32_16x16x32_bf16 v[76:79],a[152:155],v[232:235],v[76:79]
ds_read_b128 v[228:231],v43 offset:36864
v_exp_f32 v95,v95
v_mfma_f32_16x16x32_bf16 v[68:71],a[28:31],v[236:239],v[68:71]
v_exp_f32 v89,v89
v_add_f32 v92,1.0,v92
v_mfma_f32_16x16x32_bf16 v[76:79],a[156:159],v[236:239],v[76:79]
ds_read_b128 v[232:235],v17 offset:45056
v_add_f32 v93,1.0,v93
s_waitcnt lgkmcnt(5)
v_mfma_f32_16x16x32_bf16 v[68:71],a[80:83],v[240:243],v[68:71]
v_min3_u32 v27,v27,v240,v244
v_add_f32 v94,1.0,v94
v_add_f32 v95,1.0,v95
v_mfma_f32_16x16x32_bf16 v[76:79],a[208:211],v[240:243],v[76:79]
ds_read_b128 v[236:239],v43 offset:45056
v_rcp_f32 v92,v92
v_mfma_f32_16x16x32_bf16 v[68:71],a[84:87],v[244:247],v[68:71]
v_exp_f32 v90,v90
v_mfma_f32_16x16x32_bf16 v[76:79],a[212:215],v[244:247],v[76:79]
ds_read_b128 v[240:243],v17 offset:37888
s_waitcnt lgkmcnt(5)
v_mfma_f32_16x16x32_bf16 v[68:71],a[88:91],v[248:251],v[68:71]
v_min3_u32 v27,v27,v248,v252
v_rcp_f32 v93,v93
v_mfma_f32_16x16x32_bf16 v[76:79],a[216:219],v[248:251],v[76:79]
ds_read_b128 v[244:247],v43 offset:37888
v_rcp_f32 v94,v94
v_mfma_f32_16x16x32_bf16 v[68:71],a[92:95],v[252:255],v[68:71]
v_exp_f32 v91,v91
v_mfma_f32_16x16x32_bf16 v[76:79],a[220:223],v[252:255],v[76:79]
ds_read_b128 v[248:251],v17 offset:46080
s_waitcnt lgkmcnt(5)
v_mfma_f32_16x16x32_bf16 v[68:71],a[32:35],v[224:227],v[68:71]
v_min3_u32 v27,v27,v224,v228
v_add_f32 v88,1.0,v88
v_mfma_f32_16x16x32_bf16 v[76:79],a[160:163],v[224:227],v[76:79]
ds_read_b128 v[252:255],v43 offset:46080
v_add_f32 v89,1.0,v89
v_mfma_f32_16x16x32_bf16 v[68:71],a[36:39],v[228:231],v[68:71]
v_add_f32 v90,1.0,v90
v_add_f32 v91,1.0,v91
v_mfma_f32_16x16x32_bf16 v[76:79],a[164:167],v[228:231],v[76:79]
ds_read_b128 v[224:227],v17 offset:53248
s_waitcnt lgkmcnt(5)
v_mfma_f32_16x16x32_bf16 v[68:71],a[40:43],v[232:235],v[68:71]
v_min3_u32 v27,v27,v232,v236
v_rcp_f32 v95,v95
v_mfma_f32_16x16x32_bf16 v[76:79],a[168:171],v[232:235],v[76:79]
ds_read_b128 v[228:231],v43 offset:53248
v_mul_f32 v92,v92,v72
v_mfma_f32_16x16x32_bf16 v[68:71],a[44:47],v[236:239],v[68:71]
v_rcp_f32 v88,v88
v_mfma_f32_16x16x32_bf16 v[76:79],a[172:175],v[236:239],v[76:79]
ds_read_b128 v[232:235],v17 offset:61440
s_waitcnt lgkmcnt(5)
v_mfma_f32_16x16x32_bf16 v[68:71],a[96:99],v[240:243],v[68:71]
v_min3_u32 v27,v27,v240,v244
v_mul_f32 v93,v93,v73
v_mfma_f32_16x16x32_bf16 v[76:79],a[224:227],v[240:243],v[76:79]
ds_read_b128 v[236:239],v43 offset:61440
v_mul_f32 v94,v94,v74
v_mfma_f32_16x16x32_bf16 v[68:71],a[100:103],v[244:247],v[68:71]
v_rcp_f32 v89,v89
v_mfma_f32_16x16x32_bf16 v[76:79],a[228:231],v[244:247],v[76:79]
ds_read_b128 v[240:243],v17 offset:54272
s_waitcnt lgkmcnt(5)
v_mfma_f32_16x16x32_bf16 v[68:71],a[104:107],v[248:251],v[68:71]
v_min3_u32 v27,v27,v248,v252
v_mul_f32 v95,v95,v75
v_mfma_f32_16x16x32_bf16 v[76:79],a[232:235],v[248:251],v[76:79]
ds_read_b128 v[244:247],v43 offset:54272
v_mfma_f32_16x16x32_bf16 v[68:71],a[108:111],v[252:255],v[68:71]
v_rcp_f32 v90,v90
v_mfma_f32_16x16x32_bf16 v[76:79],a[236:239],v[252:255],v[76:79]
ds_read_b128 v[248:251],v17 offset:62464
s_waitcnt lgkmcnt(5)
v_mfma_f32_16x16x32_bf16 v[68:71],a[48:51],v[224:227],v[68:71]
v_min3_u32 v27,v27,v224,v228
v_mfma_f32_16x16x32_bf16 v[76:79],a[176:179],v[224:227],v[76:79]
ds_read_b128 v[252:255],v43 offset:62464
v_mfma_f32_16x16x32_bf16 v[68:71],a[52:55],v[228:231],v[68:71]
v_rcp_f32 v91,v91
v_mfma_f32_16x16x32_bf16 v[76:79],a[180:183],v[228:231],v[76:79]
v_mul_f32 v88,v88,v64
s_waitcnt lgkmcnt(4)
v_mfma_f32_16x16x32_bf16 v[68:71],a[56:59],v[232:235],v[68:71]
v_min3_u32 v27,v27,v232,v236
s_waitcnt vmcnt(0)
v_mfma_f32_16x16x32_bf16 v[76:79],a[184:187],v[232:235],v[76:79]
v_cmp_gt_u32 vcc,s96,v2
s_mov_b32 s96,vcc_lo
v_mfma_f32_16x16x32_bf16 v[68:71],a[60:63],v[236:239],v[68:71]
v_mov_b32 v44,s96
ds_write_b32 v46,v44
v_mfma_f32_16x16x32_bf16 v[76:79],a[188:191],v[236:239],v[76:79]
v_mul_f32 v89,v89,v65
s_waitcnt lgkmcnt(3)
v_mfma_f32_16x16x32_bf16 v[68:71],a[112:115],v[240:243],v[68:71]
v_min3_u32 v27,v27,v240,v244
v_mul_f32 v90,v90,v66
v_mfma_f32_16x16x32_bf16 v[76:79],a[240:243],v[240:243],v[76:79]
v_mul_f32 v91,v91,v67
v_cvt_pk_bf16_f32 v96,v88,v89
v_mfma_f32_16x16x32_bf16 v[68:71],a[116:119],v[244:247],v[68:71]
v_cvt_pk_bf16_f32 v97,v90,v91
v_cvt_pk_bf16_f32 v98,v92,v93
v_mfma_f32_16x16x32_bf16 v[76:79],a[244:247],v[244:247],v[76:79]
v_cvt_pk_bf16_f32 v99,v94,v95
s_waitcnt lgkmcnt(1)
v_mfma_f32_16x16x32_bf16 v[68:71],a[120:123],v[248:251],v[68:71]
v_min3_u32 v27,v27,v248,v252
v_max_u32 v96,1,v96
v_mfma_f32_16x16x32_bf16 v[76:79],a[248:251],v[248:251],v[76:79]
buffer_store_dwordx4 v[96:99],v18,s[20:23],s78 offen sc1
v_mfma_f32_16x16x32_bf16 v[68:71],a[124:127],v[252:255],v[68:71]
v_mfma_f32_16x16x32_bf16 v[76:79],a[252:255],v[252:255],v[76:79]
v_cmp_eq_u32 vcc,0,v27
s_cbranch_vccnz retry_201
s_branch epi_204
both_205:
s_waitcnt vmcnt(10)
s_barrier
ds_read_b128 v[224:227],v17 offset:0
ds_read_b128 v[228:231],v43 offset:0
ds_read_b128 v[232:235],v17 offset:8192
ds_read_b128 v[236:239],v43 offset:8192
ds_read_b128 v[240:243],v17 offset:1024
ds_read_b128 v[244:247],v43 offset:1024
ds_read_b128 v[248:251],v17 offset:9216
s_waitcnt lgkmcnt(5)
v_mfma_f32_16x16x32_bf16 v[64:67],a[0:3],v[224:227],0
s_xor_b32 m0,s91,20480
s_add_u32 s88,s70,s75
v_min_u32 v27,v224,v228
v_mfma_f32_16x16x32_bf16 v[72:75],a[128:131],v[224:227],0
ds_read_b128 v[252:255],v43 offset:9216
s_add_u32 s88,s88,2097152
v_mfma_f32_16x16x32_bf16 v[64:67],a[4:7],v[228:231],v[64:67]
s_add_u32 s65,s95,256
s_xor_b32 s88,s88,0x2000
v_mfma_f32_16x16x32_bf16 v[72:75],a[132:135],v[228:231],v[72:75]
s_waitcnt vmcnt(8)
s_barrier
ds_read_b128 v[224:227],v17 offset:16384
s_waitcnt lgkmcnt(5)
v_mfma_f32_16x16x32_bf16 v[64:67],a[8:11],v[232:235],v[64:67]
buffer_load_dwordx4 v42,s[20:23],s65 offen offset:0 sc1 lds
v_min3_u32 v27,v27,v232,v236
v_mfma_f32_16x16x32_bf16 v[72:75],a[136:139],v[232:235],v[72:75]
ds_read_b128 v[228:231],v43 offset:16384
s_add_u32 s89,s88,65536
v_mfma_f32_16x16x32_bf16 v[64:67],a[12:15],v[236:239],v[64:67]
buffer_load_dwordx4 v42,s[20:23],s65 offen offset:1024 sc1 lds
v_mfma_f32_16x16x32_bf16 v[72:75],a[140:143],v[236:239],v[72:75]
ds_read_b128 v[232:235],v17 offset:24576
s_waitcnt lgkmcnt(5)
v_mfma_f32_16x16x32_bf16 v[64:67],a[64:67],v[240:243],v[64:67]
s_xor_b32 m0,s91,36864
v_min3_u32 v27,v27,v240,v244
v_mfma_f32_16x16x32_bf16 v[72:75],a[192:195],v[240:243],v[72:75]
ds_read_b128 v[236:239],v43 offset:24576
v_mfma_f32_16x16x32_bf16 v[64:67],a[68:71],v[244:247],v[64:67]
s_add_u32 s65,s95,512
v_mfma_f32_16x16x32_bf16 v[72:75],a[196:199],v[244:247],v[72:75]
ds_read_b128 v[240:243],v17 offset:17408
s_waitcnt lgkmcnt(5)
v_mfma_f32_16x16x32_bf16 v[64:67],a[72:75],v[248:251],v[64:67]
buffer_load_dwordx4 v42,s[20:23],s65 offen offset:0 sc1 lds
v_mfma_f32_16x16x32_bf16 v[72:75],a[200:203],v[248:251],v[72:75]
ds_read_b128 v[244:247],v43 offset:17408
v_min3_u32 v27,v27,v248,v252
v_mfma_f32_16x16x32_bf16 v[64:67],a[76:79],v[252:255],v[64:67]
buffer_load_dwordx4 v42,s[20:23],s65 offen offset:1024 sc1 lds
v_mfma_f32_16x16x32_bf16 v[72:75],a[204:207],v[252:255],v[72:75]
ds_read_b128 v[248:251],v17 offset:25600
s_waitcnt lgkmcnt(5)
v_mfma_f32_16x16x32_bf16 v[64:67],a[16:19],v[224:227],v[64:67]
s_xor_b32 m0,s91,53248
v_min3_u32 v27,v27,v224,v228
v_mfma_f32_16x16x32_bf16 v[72:75],a[144:147],v[224:227],v[72:75]
ds_read_b128 v[252:255],v43 offset:25600
v_mfma_f32_16x16x32_bf16 v[64:67],a[20:23],v[228:231],v[64:67]
s_add_u32 s65,s95,768
v_mfma_f32_16x16x32_bf16 v[72:75],a[148:151],v[228:231],v[72:75]
s_waitcnt vmcnt(8)
s_barrier
ds_read_b128 v[224:227],v17 offset:32768
s_waitcnt lgkmcnt(5)
v_mfma_f32_16x16x32_bf16 v[64:67],a[24:27],v[232:235],v[64:67]
buffer_load_dwordx4 v42,s[20:23],s65 offen offset:0 sc1 lds
v_mfma_f32_16x16x32_bf16 v[72:75],a[152:155],v[232:235],v[72:75]
ds_read_b128 v[228:231],v43 offset:32768
v_min3_u32 v27,v27,v232,v236
v_mfma_f32_16x16x32_bf16 v[64:67],a[28:31],v[236:239],v[64:67]
buffer_load_dwordx4 v42,s[20:23],s65 offen offset:1024 sc1 lds
v_mfma_f32_16x16x32_bf16 v[72:75],a[156:159],v[236:239],v[72:75]
ds_read_b128 v[232:235],v17 offset:40960
s_waitcnt lgkmcnt(5)
v_mfma_f32_16x16x32_bf16 v[64:67],a[80:83],v[240:243],v[64:67]
v_min3_u32 v27,v27,v240,v244
v_mfma_f32_16x16x32_bf16 v[72:75],a[208:211],v[240:243],v[72:75]
ds_read_b128 v[236:239],v43 offset:40960
v_mfma_f32_16x16x32_bf16 v[64:67],a[84:87],v[244:247],v[64:67]
s_xor_b32 m0,s72,0
v_mfma_f32_16x16x32_bf16 v[72:75],a[212:215],v[244:247],v[72:75]
ds_read_b128 v[240:243],v17 offset:33792
s_add_u32 s65,s88,0
s_waitcnt lgkmcnt(5)
v_mfma_f32_16x16x32_bf16 v[64:67],a[88:91],v[248:251],v[64:67]
buffer_load_dwordx4 v42,s[20:23],s65 offen offset:0 sc1 lds
v_mfma_f32_16x16x32_bf16 v[72:75],a[216:219],v[248:251],v[72:75]
ds_read_b128 v[244:247],v43 offset:33792
buffer_load_dwordx4 v42,s[20:23],s65 offen offset:1024 sc1 lds
v_mfma_f32_16x16x32_bf16 v[64:67],a[92:95],v[252:255],v[64:67]
v_min3_u32 v27,v27,v248,v252
v_mfma_f32_16x16x32_bf16 v[72:75],a[220:223],v[252:255],v[72:75]
ds_read_b128 v[248:251],v17 offset:41984
s_xor_b32 m0,s72,16384
s_waitcnt lgkmcnt(5)
v_mfma_f32_16x16x32_bf16 v[64:67],a[32:35],v[224:227],v[64:67]
s_add_u32 s65,s88,256
v_min3_u32 v27,v27,v224,v228
v_mfma_f32_16x16x32_bf16 v[72:75],a[160:163],v[224:227],v[72:75]
ds_read_b128 v[252:255],v43 offset:41984
buffer_load_dwordx4 v42,s[20:23],s65 offen offset:0 sc1 lds
v_mfma_f32_16x16x32_bf16 v[64:67],a[36:39],v[228:231],v[64:67]
v_mfma_f32_16x16x32_bf16 v[72:75],a[164:167],v[228:231],v[72:75]
ds_read_b128 v[224:227],v17 offset:49152
s_waitcnt lgkmcnt(5)
v_mfma_f32_16x16x32_bf16 v[64:67],a[40:43],v[232:235],v[64:67]
buffer_load_dwordx4 v42,s[20:23],s65 offen offset:1024 sc1 lds
s_xor_b32 m0,s72,32768
v_mfma_f32_16x16x32_bf16 v[72:75],a[168:171],v[232:235],v[72:75]
ds_read_b128 v[228:231],v43 offset:49152
s_add_u32 s65,s88,512
v_mfma_f32_16x16x32_bf16 v[64:67],a[44:47],v[236:239],v[64:67]
v_min3_u32 v27,v27,v232,v236
v_mfma_f32_16x16x32_bf16 v[72:75],a[172:175],v[236:239],v[72:75]
ds_read_b128 v[232:235],v17 offset:57344
s_waitcnt lgkmcnt(5)
v_mfma_f32_16x16x32_bf16 v[64:67],a[96:99],v[240:243],v[64:67]
buffer_load_dwordx4 v42,s[20:23],s65 offen offset:0 sc1 lds
v_mfma_f32_16x16x32_bf16 v[72:75],a[224:227],v[240:243],v[72:75]
ds_read_b128 v[236:239],v43 offset:57344
buffer_load_dwordx4 v42,s[20:23],s65 offen offset:1024 sc1 lds
v_mfma_f32_16x16x32_bf16 v[64:67],a[100:103],v[244:247],v[64:67]
s_xor_b32 m0,s72,49152
v_min3_u32 v27,v27,v240,v244
v_mfma_f32_16x16x32_bf16 v[72:75],a[228:231],v[244:247],v[72:75]
ds_read_b128 v[240:243],v17 offset:50176
s_add_u32 s65,s88,768
s_waitcnt lgkmcnt(5)
v_mfma_f32_16x16x32_bf16 v[64:67],a[104:107],v[248:251],v[64:67]
buffer_load_dwordx4 v42,s[20:23],s65 offen offset:0 sc1 lds
v_mfma_f32_16x16x32_bf16 v[72:75],a[232:235],v[248:251],v[72:75]
ds_read_b128 v[244:247],v43 offset:50176
v_min3_u32 v27,v27,v248,v252
v_mfma_f32_16x16x32_bf16 v[64:67],a[108:111],v[252:255],v[64:67]
buffer_load_dwordx4 v42,s[20:23],s65 offen offset:1024 sc1 lds
v_mfma_f32_16x16x32_bf16 v[72:75],a[236:239],v[252:255],v[72:75]
ds_read_b128 v[248:251],v17 offset:58368
s_waitcnt lgkmcnt(5)
v_mfma_f32_16x16x32_bf16 v[64:67],a[48:51],v[224:227],v[64:67]
s_xor_b32 m0,s72,4096
s_add_u32 s65,s89,0
v_mfma_f32_16x16x32_bf16 v[72:75],a[176:179],v[224:227],v[72:75]
ds_read_b128 v[252:255],v43 offset:58368
v_min3_u32 v27,v27,v224,v228
v_mfma_f32_16x16x32_bf16 v[64:67],a[52:55],v[228:231],v[64:67]
buffer_load_dwordx4 v42,s[20:23],s65 offen offset:0 sc1 lds
v_mfma_f32_16x16x32_bf16 v[72:75],a[180:183],v[228:231],v[72:75]
s_waitcnt vmcnt(9)
s_barrier
ds_read_b128 v[224:227],v17 offset:4096
s_waitcnt lgkmcnt(5)
v_mfma_f32_16x16x32_bf16 v[64:67],a[56:59],v[232:235],v[64:67]
buffer_load_dwordx4 v42,s[20:23],s65 offen offset:1024 sc1 lds
v_mfma_f32_16x16x32_bf16 v[72:75],a[184:187],v[232:235],v[72:75]
ds_read_b128 v[228:231],v43 offset:4096
s_xor_b32 m0,s72,20480
v_mfma_f32_16x16x32_bf16 v[64:67],a[60:63],v[236:239],v[64:67]
s_add_u32 s65,s89,256
v_min3_u32 v27,v27,v232,v236
v_mfma_f32_16x16x32_bf16 v[72:75],a[188:191],v[236:239],v[72:75]
ds_read_b128 v[232:235],v17 offset:12288
s_waitcnt lgkmcnt(5)
v_mfma_f32_16x16x32_bf16 v[64:67],a[112:115],v[240:243],v[64:67]
buffer_load_dwordx4 v42,s[20:23],s65 offen offset:0 sc1 lds
v_mfma_f32_16x16x32_bf16 v[72:75],a[240:243],v[240:243],v[72:75]
ds_read_b128 v[236:239],v43 offset:12288
v_min3_u32 v27,v27,v240,v244
v_mfma_f32_16x16x32_bf16 v[64:67],a[116:119],v[244:247],v[64:67]
buffer_load_dwordx4 v42,s[20:23],s65 offen offset:1024 sc1 lds
v_mfma_f32_16x16x32_bf16 v[72:75],a[244:247],v[244:247],v[72:75]
ds_read_b128 v[240:243],v17 offset:5120
s_waitcnt lgkmcnt(5)
v_mfma_f32_16x16x32_bf16 v[64:67],a[120:123],v[248:251],v[64:67]
s_xor_b32 m0,s72,36864
s_add_u32 s65,s89,512
v_mfma_f32_16x16x32_bf16 v[72:75],a[248:251],v[248:251],v[72:75]
ds_read_b128 v[244:247],v43 offset:5120
v_min3_u32 v27,v27,v248,v252
v_mfma_f32_16x16x32_bf16 v[64:67],a[124:127],v[252:255],v[64:67]
buffer_load_dwordx4 v42,s[20:23],s65 offen offset:0 sc1 lds
buffer_load_dword v2,v21,s[20:23],s87 offen sc1
v_mfma_f32_16x16x32_bf16 v[72:75],a[252:255],v[252:255],v[72:75]
ds_read_b128 v[248:251],v17 offset:13312
s_add_u32 s96,s71,2
s_waitcnt lgkmcnt(5)
v_mfma_f32_16x16x32_bf16 v[68:71],a[0:3],v[224:227],0
buffer_load_dwordx4 v42,s[20:23],s65 offen offset:1024 sc1 lds
v_min3_u32 v27,v27,v224,v228
v_mfma_f32_16x16x32_bf16 v[76:79],a[128:131],v[224:227],0
ds_read_b128 v[252:255],v43 offset:13312
s_xor_b32 m0,s72,53248
v_mfma_f32_16x16x32_bf16 v[68:71],a[4:7],v[228:231],v[68:71]
s_add_u32 s65,s89,768
v_cmp_eq_u32 vcc,0,v27
s_cbranch_vccnz retry_201
v_mfma_f32_16x16x32_bf16 v[76:79],a[132:135],v[228:231],v[76:79]
ds_read_b128 v[224:227],v17 offset:20480
s_waitcnt lgkmcnt(5)
v_mfma_f32_16x16x32_bf16 v[68:71],a[8:11],v[232:235],v[68:71]
buffer_load_dwordx4 v42,s[20:23],s65 offen offset:0 sc1 lds
v_mul_f32 v88,v64,v64
v_mfma_f32_16x16x32_bf16 v[76:79],a[136:139],v[232:235],v[76:79]
ds_read_b128 v[228:231],v43 offset:20480
v_min3_u32 v27,v27,v232,v236
v_mul_f32 v89,v65,v65
v_mfma_f32_16x16x32_bf16 v[68:71],a[12:15],v[236:239],v[68:71]
buffer_load_dwordx4 v42,s[20:23],s65 offen offset:1024 sc1 lds
v_mul_f32 v92,v72,v72
v_mfma_f32_16x16x32_bf16 v[76:79],a[140:143],v[236:239],v[76:79]
ds_read_b128 v[232:235],v17 offset:28672
v_mul_f32 v93,v73,v73
s_waitcnt lgkmcnt(5)
v_mfma_f32_16x16x32_bf16 v[68:71],a[64:67],v[240:243],v[68:71]
v_min3_u32 v27,v27,v240,v244
v_mul_f32 v90,v66,v66
v_mul_f32 v94,v74,v74
v_mfma_f32_16x16x32_bf16 v[76:79],a[192:195],v[240:243],v[76:79]
ds_read_b128 v[236:239],v43 offset:28672
v_mul_f32 v91,v67,v67
v_mul_f32 v95,v75,v75
v_mfma_f32_16x16x32_bf16 v[68:71],a[68:71],v[244:247],v[68:71]
v_fma_f32 v88,v88,s81,v28
v_fma_f32 v89,v89,s81,v28
v_fma_f32 v92,v92,s81,v28
v_mfma_f32_16x16x32_bf16 v[76:79],a[196:199],v[244:247],v[76:79]
ds_read_b128 v[240:243],v17 offset:21504
v_fma_f32 v93,v93,s81,v28
s_waitcnt lgkmcnt(5)
v_mfma_f32_16x16x32_bf16 v[68:71],a[72:75],v[248:251],v[68:71]
v_min3_u32 v27,v27,v248,v252
v_fma_f32 v90,v90,s81,v28
v_fma_f32 v94,v94,s81,v28
v_mfma_f32_16x16x32_bf16 v[76:79],a[200:203],v[248:251],v[76:79]
ds_read_b128 v[244:247],v43 offset:21504
v_fma_f32 v91,v91,s81,v28
v_fma_f32 v95,v95,s81,v28
v_mfma_f32_16x16x32_bf16 v[68:71],a[76:79],v[252:255],v[68:71]
v_mul_f32 v88,v88,v64
v_mul_f32 v89,v89,v65
v_mul_f32 v92,v92,v72
v_mfma_f32_16x16x32_bf16 v[76:79],a[204:207],v[252:255],v[76:79]
ds_read_b128 v[248:251],v17 offset:29696
v_mul_f32 v93,v93,v73
s_waitcnt lgkmcnt(5)
v_mfma_f32_16x16x32_bf16 v[68:71],a[16:19],v[224:227],v[68:71]
v_min3_u32 v27,v27,v224,v228
v_mul_f32 v90,v90,v66
v_mul_f32 v94,v94,v74
v_mfma_f32_16x16x32_bf16 v[76:79],a[144:147],v[224:227],v[76:79]
ds_read_b128 v[252:255],v43 offset:29696
v_mul_f32 v91,v91,v67
v_mul_f32 v95,v95,v75
v_mfma_f32_16x16x32_bf16 v[68:71],a[20:23],v[228:231],v[68:71]
v_exp_f32 v88,v88
v_mfma_f32_16x16x32_bf16 v[76:79],a[148:151],v[228:231],v[76:79]
ds_read_b128 v[224:227],v17 offset:36864
s_waitcnt lgkmcnt(5)
v_mfma_f32_16x16x32_bf16 v[68:71],a[24:27],v[232:235],v[68:71]
v_min3_u32 v27,v27,v232,v236
v_exp_f32 v92,v92
v_mfma_f32_16x16x32_bf16 v[76:79],a[152:155],v[232:235],v[76:79]
ds_read_b128 v[228:231],v43 offset:36864
v_exp_f32 v93,v93
v_mfma_f32_16x16x32_bf16 v[68:71],a[28:31],v[236:239],v[68:71]
v_exp_f32 v89,v89
v_mfma_f32_16x16x32_bf16 v[76:79],a[156:159],v[236:239],v[76:79]
ds_read_b128 v[232:235],v17 offset:45056
s_waitcnt lgkmcnt(5)
v_mfma_f32_16x16x32_bf16 v[68:71],a[80:83],v[240:243],v[68:71]
v_min3_u32 v27,v27,v240,v244
v_exp_f32 v94,v94
v_mfma_f32_16x16x32_bf16 v[76:79],a[208:211],v[240:243],v[76:79]
ds_read_b128 v[236:239],v43 offset:45056
v_exp_f32 v95,v95
v_mfma_f32_16x16x32_bf16 v[68:71],a[84:87],v[244:247],v[68:71]
v_exp_f32 v90,v90
v_add_f32 v92,1.0,v92
v_mfma_f32_16x16x32_bf16 v[76:79],a[212:215],v[244:247],v[76:79]
ds_read_b128 v[240:243],v17 offset:37888
v_add_f32 v93,1.0,v93
s_waitcnt lgkmcnt(5)
v_mfma_f32_16x16x32_bf16 v[68:71],a[88:91],v[248:251],v[68:71]
v_min3_u32 v27,v27,v248,v252
v_add_f32 v94,1.0,v94
v_add_f32 v95,1.0,v95
v_mfma_f32_16x16x32_bf16 v[76:79],a[216:219],v[248:251],v[76:79]
ds_read_b128 v[244:247],v43 offset:37888
v_rcp_f32 v92,v92
v_mfma_f32_16x16x32_bf16 v[68:71],a[92:95],v[252:255],v[68:71]
v_exp_f32 v91,v91
v_mfma_f32_16x16x32_bf16 v[76:79],a[220:223],v[252:255],v[76:79]
ds_read_b128 v[248:251],v17 offset:46080
s_waitcnt lgkmcnt(5)
v_mfma_f32_16x16x32_bf16 v[68:71],a[32:35],v[224:227],v[68:71]
v_min3_u32 v27,v27,v224,v228
v_add_f32 v88,1.0,v88
v_mfma_f32_16x16x32_bf16 v[76:79],a[160:163],v[224:227],v[76:79]
ds_read_b128 v[252:255],v43 offset:46080
v_add_f32 v89,1.0,v89
v_mfma_f32_16x16x32_bf16 v[68:71],a[36:39],v[228:231],v[68:71]
v_add_f32 v90,1.0,v90
v_add_f32 v91,1.0,v91
v_mfma_f32_16x16x32_bf16 v[76:79],a[164:167],v[228:231],v[76:79]
ds_read_b128 v[224:227],v17 offset:53248
s_waitcnt lgkmcnt(5)
v_mfma_f32_16x16x32_bf16 v[68:71],a[40:43],v[232:235],v[68:71]
v_min3_u32 v27,v27,v232,v236
v_rcp_f32 v93,v93
v_mfma_f32_16x16x32_bf16 v[76:79],a[168:171],v[232:235],v[76:79]
ds_read_b128 v[228:231],v43 offset:53248
v_rcp_f32 v94,v94
v_mfma_f32_16x16x32_bf16 v[68:71],a[44:47],v[236:239],v[68:71]
v_rcp_f32 v88,v88
v_mfma_f32_16x16x32_bf16 v[76:79],a[172:175],v[236:239],v[76:79]
ds_read_b128 v[232:235],v17 offset:61440
s_waitcnt lgkmcnt(5)
v_mfma_f32_16x16x32_bf16 v[68:71],a[96:99],v[240:243],v[68:71]
v_min3_u32 v27,v27,v240,v244
v_rcp_f32 v95,v95
v_mfma_f32_16x16x32_bf16 v[76:79],a[224:227],v[240:243],v[76:79]
ds_read_b128 v[236:239],v43 offset:61440
v_mul_f32 v92,v92,v72
v_mfma_f32_16x16x32_bf16 v[68:71],a[100:103],v[244:247],v[68:71]
v_rcp_f32 v89,v89
v_mfma_f32_16x16x32_bf16 v[76:79],a[228:231],v[244:247],v[76:79]
ds_read_b128 v[240:243],v17 offset:54272
s_waitcnt lgkmcnt(5)
v_mfma_f32_16x16x32_bf16 v[68:71],a[104:107],v[248:251],v[68:71]
v_min3_u32 v27,v27,v248,v252
v_mul_f32 v93,v93,v73
v_mfma_f32_16x16x32_bf16 v[76:79],a[232:235],v[248:251],v[76:79]
ds_read_b128 v[244:247],v43 offset:54272
v_mul_f32 v94,v94,v74
v_mfma_f32_16x16x32_bf16 v[68:71],a[108:111],v[252:255],v[68:71]
v_rcp_f32 v90,v90
v_mfma_f32_16x16x32_bf16 v[76:79],a[236:239],v[252:255],v[76:79]
ds_read_b128 v[248:251],v17 offset:62464
s_waitcnt lgkmcnt(5)
v_mfma_f32_16x16x32_bf16 v[68:71],a[48:51],v[224:227],v[68:71]
v_min3_u32 v27,v27,v224,v228
v_mul_f32 v95,v95,v75
v_mfma_f32_16x16x32_bf16 v[76:79],a[176:179],v[224:227],v[76:79]
ds_read_b128 v[252:255],v43 offset:62464
v_mfma_f32_16x16x32_bf16 v[68:71],a[52:55],v[228:231],v[68:71]
v_rcp_f32 v91,v91
v_mfma_f32_16x16x32_bf16 v[76:79],a[180:183],v[228:231],v[76:79]
v_mul_f32 v88,v88,v64
s_waitcnt lgkmcnt(4)
v_mfma_f32_16x16x32_bf16 v[68:71],a[56:59],v[232:235],v[68:71]
v_min3_u32 v27,v27,v232,v236
s_waitcnt vmcnt(3)
v_mfma_f32_16x16x32_bf16 v[76:79],a[184:187],v[232:235],v[76:79]
v_cmp_gt_u32 vcc,s96,v2
s_mov_b32 s96,vcc_lo
v_mfma_f32_16x16x32_bf16 v[68:71],a[60:63],v[236:239],v[68:71]
v_mov_b32 v44,s96
ds_write_b32 v46,v44
v_mfma_f32_16x16x32_bf16 v[76:79],a[188:191],v[236:239],v[76:79]
v_mul_f32 v89,v89,v65
s_waitcnt lgkmcnt(3)
v_mfma_f32_16x16x32_bf16 v[68:71],a[112:115],v[240:243],v[68:71]
v_min3_u32 v27,v27,v240,v244
v_mul_f32 v90,v90,v66
v_mfma_f32_16x16x32_bf16 v[76:79],a[240:243],v[240:243],v[76:79]
v_mul_f32 v91,v91,v67
v_cvt_pk_bf16_f32 v96,v88,v89
v_mfma_f32_16x16x32_bf16 v[68:71],a[116:119],v[244:247],v[68:71]
v_cvt_pk_bf16_f32 v97,v90,v91
v_cvt_pk_bf16_f32 v98,v92,v93
v_mfma_f32_16x16x32_bf16 v[76:79],a[244:247],v[244:247],v[76:79]
v_cvt_pk_bf16_f32 v99,v94,v95
s_waitcnt lgkmcnt(1)
v_mfma_f32_16x16x32_bf16 v[68:71],a[120:123],v[248:251],v[68:71]
v_min3_u32 v27,v27,v248,v252
v_max_u32 v96,1,v96
v_mfma_f32_16x16x32_bf16 v[76:79],a[248:251],v[248:251],v[76:79]
buffer_store_dwordx4 v[96:99],v18,s[20:23],s78 offen sc1
v_mfma_f32_16x16x32_bf16 v[68:71],a[124:127],v[252:255],v[68:71]
v_mfma_f32_16x16x32_bf16 v[76:79],a[252:255],v[252:255],v[76:79]
v_cmp_eq_u32 vcc,0,v27
s_cbranch_vccnz retry_201
s_branch epi_204
ahead_203:
s_waitcnt vmcnt(5) lgkmcnt(0)
s_barrier
ds_read_b32 v44,v45
ds_read_b128 v[224:227],v17 offset:0
ds_read_b128 v[228:231],v43 offset:0
ds_read_b128 v[232:235],v17 offset:8192
ds_read_b128 v[236:239],v43 offset:8192
ds_read_b128 v[240:243],v17 offset:1024
ds_read_b128 v[244:247],v43 offset:1024
ds_read_b128 v[248:251],v17 offset:9216
s_waitcnt lgkmcnt(5)
v_mfma_f32_16x16x32_bf16 v[64:67],a[0:3],v[224:227],0
s_add_u32 s88,s70,s75
s_add_u32 s88,s88,2097152
v_min_u32 v27,v224,v228
v_mfma_f32_16x16x32_bf16 v[72:75],a[128:131],v[224:227],0
ds_read_b128 v[252:255],v43 offset:9216
s_xor_b32 s88,s88,0x2000
v_mfma_f32_16x16x32_bf16 v[64:67],a[4:7],v[228:231],v[64:67]
v_readfirstlane_b32 s83,v44
v_mfma_f32_16x16x32_bf16 v[72:75],a[132:135],v[228:231],v[72:75]
ds_read_b128 v[224:227],v17 offset:16384
s_waitcnt lgkmcnt(5)
v_mfma_f32_16x16x32_bf16 v[64:67],a[8:11],v[232:235],v[64:67]
s_cmp_eq_u32 s83,0
s_cselect_b32 s88,s88,0x7fff0000
v_mfma_f32_16x16x32_bf16 v[72:75],a[136:139],v[232:235],v[72:75]
ds_read_b128 v[228:231],v43 offset:16384
s_add_u32 s89,s88,65536
v_mfma_f32_16x16x32_bf16 v[64:67],a[12:15],v[236:239],v[64:67]
s_xor_b32 m0,s72,0
v_min3_u32 v27,v27,v232,v236
v_mfma_f32_16x16x32_bf16 v[72:75],a[140:143],v[236:239],v[72:75]
ds_read_b128 v[232:235],v17 offset:24576
s_waitcnt lgkmcnt(5)
v_mfma_f32_16x16x32_bf16 v[64:67],a[64:67],v[240:243],v[64:67]
s_add_u32 s65,s88,0
v_min3_u32 v27,v27,v240,v244
v_mfma_f32_16x16x32_bf16 v[72:75],a[192:195],v[240:243],v[72:75]
ds_read_b128 v[236:239],v43 offset:24576
v_mfma_f32_16x16x32_bf16 v[64:67],a[68:71],v[244:247],v[64:67]
buffer_load_dwordx4 v42,s[20:23],s65 offen offset:0 sc1 lds
v_mfma_f32_16x16x32_bf16 v[72:75],a[196:199],v[244:247],v[72:75]
ds_read_b128 v[240:243],v17 offset:17408
s_waitcnt lgkmcnt(5)
v_mfma_f32_16x16x32_bf16 v[64:67],a[72:75],v[248:251],v[64:67]
buffer_load_dwordx4 v42,s[20:23],s65 offen offset:1024 sc1 lds
v_mfma_f32_16x16x32_bf16 v[72:75],a[200:203],v[248:251],v[72:75]
ds_read_b128 v[244:247],v43 offset:17408
s_xor_b32 m0,s72,16384
v_mfma_f32_16x16x32_bf16 v[64:67],a[76:79],v[252:255],v[64:67]
s_add_u32 s65,s88,256
v_min3_u32 v27,v27,v248,v252
v_mfma_f32_16x16x32_bf16 v[72:75],a[204:207],v[252:255],v[72:75]
ds_read_b128 v[248:251],v17 offset:25600
s_waitcnt lgkmcnt(5)
v_mfma_f32_16x16x32_bf16 v[64:67],a[16:19],v[224:227],v[64:67]
buffer_load_dwordx4 v42,s[20:23],s65 offen offset:0 sc1 lds
v_mfma_f32_16x16x32_bf16 v[72:75],a[144:147],v[224:227],v[72:75]
ds_read_b128 v[252:255],v43 offset:25600
v_min3_u32 v27,v27,v224,v228
v_mfma_f32_16x16x32_bf16 v[64:67],a[20:23],v[228:231],v[64:67]
buffer_load_dwordx4 v42,s[20:23],s65 offen offset:1024 sc1 lds
v_mfma_f32_16x16x32_bf16 v[72:75],a[148:151],v[228:231],v[72:75]
ds_read_b128 v[224:227],v17 offset:32768
s_waitcnt lgkmcnt(5)
v_mfma_f32_16x16x32_bf16 v[64:67],a[24:27],v[232:235],v[64:67]
s_xor_b32 m0,s72,32768
s_add_u32 s65,s88,512
v_mfma_f32_16x16x32_bf16 v[72:75],a[152:155],v[232:235],v[72:75]
ds_read_b128 v[228:231],v43 offset:32768
v_min3_u32 v27,v27,v232,v236
v_mfma_f32_16x16x32_bf16 v[64:67],a[28:31],v[236:239],v[64:67]
buffer_load_dwordx4 v42,s[20:23],s65 offen offset:0 sc1 lds
v_mfma_f32_16x16x32_bf16 v[72:75],a[156:159],v[236:239],v[72:75]
ds_read_b128 v[232:235],v17 offset:40960
s_waitcnt lgkmcnt(5)
v_mfma_f32_16x16x32_bf16 v[64:67],a[80:83],v[240:243],v[64:67]
buffer_load_dwordx4 v42,s[20:23],s65 offen offset:1024 sc1 lds
v_mfma_f32_16x16x32_bf16 v[72:75],a[208:211],v[240:243],v[72:75]
ds_read_b128 v[236:239],v43 offset:40960
s_xor_b32 m0,s72,49152
v_mfma_f32_16x16x32_bf16 v[64:67],a[84:87],v[244:247],v[64:67]
v_min3_u32 v27,v27,v240,v244
v_mfma_f32_16x16x32_bf16 v[72:75],a[212:215],v[244:247],v[72:75]
ds_read_b128 v[240:243],v17 offset:33792
s_waitcnt lgkmcnt(5)
v_mfma_f32_16x16x32_bf16 v[64:67],a[88:91],v[248:251],v[64:67]
s_add_u32 s65,s88,768
v_min3_u32 v27,v27,v248,v252
v_mfma_f32_16x16x32_bf16 v[72:75],a[216:219],v[248:251],v[72:75]
ds_read_b128 v[244:247],v43 offset:33792
v_mfma_f32_16x16x32_bf16 v[64:67],a[92:95],v[252:255],v[64:67]
buffer_load_dwordx4 v42,s[20:23],s65 offen offset:0 sc1 lds
v_mfma_f32_16x16x32_bf16 v[72:75],a[220:223],v[252:255],v[72:75]
ds_read_b128 v[248:251],v17 offset:41984
s_waitcnt lgkmcnt(5)
v_mfma_f32_16x16x32_bf16 v[64:67],a[32:35],v[224:227],v[64:67]
buffer_load_dwordx4 v42,s[20:23],s65 offen offset:1024 sc1 lds
v_mfma_f32_16x16x32_bf16 v[72:75],a[160:163],v[224:227],v[72:75]
ds_read_b128 v[252:255],v43 offset:41984
s_xor_b32 m0,s72,4096
v_mfma_f32_16x16x32_bf16 v[64:67],a[36:39],v[228:231],v[64:67]
s_add_u32 s65,s89,0
v_min3_u32 v27,v27,v224,v228
v_mfma_f32_16x16x32_bf16 v[72:75],a[164:167],v[228:231],v[72:75]
ds_read_b128 v[224:227],v17 offset:49152
s_waitcnt lgkmcnt(5)
v_mfma_f32_16x16x32_bf16 v[64:67],a[40:43],v[232:235],v[64:67]
buffer_load_dwordx4 v42,s[20:23],s65 offen offset:0 sc1 lds
v_mfma_f32_16x16x32_bf16 v[72:75],a[168:171],v[232:235],v[72:75]
ds_read_b128 v[228:231],v43 offset:49152
v_min3_u32 v27,v27,v232,v236
v_mfma_f32_16x16x32_bf16 v[64:67],a[44:47],v[236:239],v[64:67]
buffer_load_dwordx4 v42,s[20:23],s65 offen offset:1024 sc1 lds
v_mfma_f32_16x16x32_bf16 v[72:75],a[172:175],v[236:239],v[72:75]
ds_read_b128 v[232:235],v17 offset:57344
s_waitcnt lgkmcnt(5)
v_mfma_f32_16x16x32_bf16 v[64:67],a[96:99],v[240:243],v[64:67]
s_xor_b32 m0,s72,20480
s_add_u32 s65,s89,256
v_mfma_f32_16x16x32_bf16 v[72:75],a[224:227],v[240:243],v[72:75]
ds_read_b128 v[236:239],v43 offset:57344
v_min3_u32 v27,v27,v240,v244
v_mfma_f32_16x16x32_bf16 v[64:67],a[100:103],v[244:247],v[64:67]
buffer_load_dwordx4 v42,s[20:23],s65 offen offset:0 sc1 lds
v_mfma_f32_16x16x32_bf16 v[72:75],a[228:231],v[244:247],v[72:75]
ds_read_b128 v[240:243],v17 offset:50176
s_waitcnt lgkmcnt(5)
v_mfma_f32_16x16x32_bf16 v[64:67],a[104:107],v[248:251],v[64:67]
buffer_load_dwordx4 v42,s[20:23],s65 offen offset:1024 sc1 lds
v_mfma_f32_16x16x32_bf16 v[72:75],a[232:235],v[248:251],v[72:75]
ds_read_b128 v[244:247],v43 offset:50176
s_xor_b32 m0,s72,36864
v_mfma_f32_16x16x32_bf16 v[64:67],a[108:111],v[252:255],v[64:67]
s_add_u32 s65,s89,512
v_min3_u32 v27,v27,v248,v252
v_mfma_f32_16x16x32_bf16 v[72:75],a[236:239],v[252:255],v[72:75]
ds_read_b128 v[248:251],v17 offset:58368
s_waitcnt lgkmcnt(5)
v_mfma_f32_16x16x32_bf16 v[64:67],a[48:51],v[224:227],v[64:67]
buffer_load_dwordx4 v42,s[20:23],s65 offen offset:0 sc1 lds
v_mfma_f32_16x16x32_bf16 v[72:75],a[176:179],v[224:227],v[72:75]
ds_read_b128 v[252:255],v43 offset:58368
v_min3_u32 v27,v27,v224,v228
v_mfma_f32_16x16x32_bf16 v[64:67],a[52:55],v[228:231],v[64:67]
buffer_load_dwordx4 v42,s[20:23],s65 offen offset:1024 sc1 lds
s_waitcnt vmcnt(14)
v_mfma_f32_16x16x32_bf16 v[72:75],a[180:183],v[228:231],v[72:75]
ds_read_b128 v[224:227],v17 offset:4096
v_add_u32 v22,s71,-1
s_waitcnt lgkmcnt(5)
v_mfma_f32_16x16x32_bf16 v[64:67],a[56:59],v[232:235],v[64:67]
s_xor_b32 m0,s72,53248
v_min3_u32 v27,v27,v232,v236
v_mfma_f32_16x16x32_bf16 v[72:75],a[184:187],v[232:235],v[72:75]
ds_read_b128 v[228:231],v43 offset:4096
s_add_u32 s65,s89,768
v_mfma_f32_16x16x32_bf16 v[64:67],a[60:63],v[236:239],v[64:67]
buffer_load_dwordx4 v42,s[20:23],s65 offen offset:0 sc1 lds
v_mfma_f32_16x16x32_bf16 v[72:75],a[188:191],v[236:239],v[72:75]
ds_read_b128 v[232:235],v17 offset:12288
s_waitcnt lgkmcnt(5)
v_mfma_f32_16x16x32_bf16 v[64:67],a[112:115],v[240:243],v[64:67]
buffer_load_dwordx4 v42,s[20:23],s65 offen offset:1024 sc1 lds
v_mfma_f32_16x16x32_bf16 v[72:75],a[240:243],v[240:243],v[72:75]
ds_read_b128 v[236:239],v43 offset:12288
v_min3_u32 v27,v27,v240,v244
v_mfma_f32_16x16x32_bf16 v[64:67],a[116:119],v[244:247],v[64:67]
buffer_store_dword v22,v23,s[24:27],s97 offen
v_mfma_f32_16x16x32_bf16 v[72:75],a[244:247],v[244:247],v[72:75]
ds_read_b128 v[240:243],v17 offset:5120
s_waitcnt lgkmcnt(5)
v_mfma_f32_16x16x32_bf16 v[64:67],a[120:123],v[248:251],v[64:67]
v_min3_u32 v27,v27,v248,v252
buffer_store_dword v22,v23,s[28:31],s97 offen sc1
v_mfma_f32_16x16x32_bf16 v[72:75],a[248:251],v[248:251],v[72:75]
ds_read_b128 v[244:247],v43 offset:5120
s_mov_b32 s97,0x7fff0000
v_mfma_f32_16x16x32_bf16 v[64:67],a[124:127],v[252:255],v[64:67]
buffer_load_dword v2,v21,s[20:23],s87 offen sc1
v_mfma_f32_16x16x32_bf16 v[72:75],a[252:255],v[252:255],v[72:75]
ds_read_b128 v[248:251],v17 offset:13312
s_waitcnt lgkmcnt(5)
v_mfma_f32_16x16x32_bf16 v[68:71],a[0:3],v[224:227],0
v_cmp_eq_u32 vcc,0,v27
s_cbranch_vccnz retry_201
v_mfma_f32_16x16x32_bf16 v[76:79],a[128:131],v[224:227],0
ds_read_b128 v[252:255],v43 offset:13312
v_min3_u32 v27,v27,v224,v228
v_mfma_f32_16x16x32_bf16 v[68:71],a[4:7],v[228:231],v[68:71]
s_add_u32 s96,s71,2
v_mfma_f32_16x16x32_bf16 v[76:79],a[132:135],v[228:231],v[76:79]
ds_read_b128 v[224:227],v17 offset:20480
s_waitcnt lgkmcnt(5)
v_mfma_f32_16x16x32_bf16 v[68:71],a[8:11],v[232:235],v[68:71]
v_min3_u32 v27,v27,v232,v236
v_mul_f32 v88,v64,v64
v_mul_f32 v92,v72,v72
v_mfma_f32_16x16x32_bf16 v[76:79],a[136:139],v[232:235],v[76:79]
ds_read_b128 v[228:231],v43 offset:20480
v_mul_f32 v89,v65,v65
v_mul_f32 v93,v73,v73
v_mfma_f32_16x16x32_bf16 v[68:71],a[12:15],v[236:239],v[68:71]
v_mul_f32 v90,v66,v66
v_mul_f32 v91,v67,v67
v_mul_f32 v94,v74,v74
v_mfma_f32_16x16x32_bf16 v[76:79],a[140:143],v[236:239],v[76:79]
ds_read_b128 v[232:235],v17 offset:28672
v_mul_f32 v95,v75,v75
s_waitcnt lgkmcnt(5)
v_mfma_f32_16x16x32_bf16 v[68:71],a[64:67],v[240:243],v[68:71]
v_min3_u32 v27,v27,v240,v244
v_fma_f32 v88,v88,s81,v28
v_fma_f32 v92,v92,s81,v28
v_mfma_f32_16x16x32_bf16 v[76:79],a[192:195],v[240:243],v[76:79]
ds_read_b128 v[236:239],v43 offset:28672
v_fma_f32 v89,v89,s81,v28
v_fma_f32 v93,v93,s81,v28
v_mfma_f32_16x16x32_bf16 v[68:71],a[68:71],v[244:247],v[68:71]
v_fma_f32 v90,v90,s81,v28
v_fma_f32 v91,v91,s81,v28
v_fma_f32 v94,v94,s81,v28
v_mfma_f32_16x16x32_bf16 v[76:79],a[196:199],v[244:247],v[76:79]
ds_read_b128 v[240:243],v17 offset:21504
v_fma_f32 v95,v95,s81,v28
s_waitcnt lgkmcnt(5)
v_mfma_f32_16x16x32_bf16 v[68:71],a[72:75],v[248:251],v[68:71]
v_min3_u32 v27,v27,v248,v252
v_mul_f32 v88,v88,v64
v_mul_f32 v92,v92,v72
v_mfma_f32_16x16x32_bf16 v[76:79],a[200:203],v[248:251],v[76:79]
ds_read_b128 v[244:247],v43 offset:21504
v_mul_f32 v89,v89,v65
v_mul_f32 v93,v93,v73
v_mfma_f32_16x16x32_bf16 v[68:71],a[76:79],v[252:255],v[68:71]
v_mul_f32 v90,v90,v66
v_mul_f32 v91,v91,v67
v_mul_f32 v94,v94,v74
v_mfma_f32_16x16x32_bf16 v[76:79],a[204:207],v[252:255],v[76:79]
ds_read_b128 v[248:251],v17 offset:29696
v_mul_f32 v95,v95,v75
s_waitcnt lgkmcnt(5)
v_mfma_f32_16x16x32_bf16 v[68:71],a[16:19],v[224:227],v[68:71]
v_min3_u32 v27,v27,v224,v228
v_exp_f32 v92,v92
v_mfma_f32_16x16x32_bf16 v[76:79],a[144:147],v[224:227],v[76:79]
ds_read_b128 v[252:255],v43 offset:29696
v_exp_f32 v93,v93
v_mfma_f32_16x16x32_bf16 v[68:71],a[20:23],v[228:231],v[68:71]
v_exp_f32 v88,v88
v_mfma_f32_16x16x32_bf16 v[76:79],a[148:151],v[228:231],v[76:79]
ds_read_b128 v[224:227],v17 offset:36864
s_waitcnt lgkmcnt(5)
v_mfma_f32_16x16x32_bf16 v[68:71],a[24:27],v[232:235],v[68:71]
v_min3_u32 v27,v27,v232,v236
v_exp_f32 v94,v94
v_mfma_f32_16x16x32_bf16 v[76:79],a[152:155],v[232:235],v[76:79]
ds_read_b128 v[228:231],v43 offset:36864
v_exp_f32 v95,v95
v_mfma_f32_16x16x32_bf16 v[68:71],a[28:31],v[236:239],v[68:71]
v_exp_f32 v89,v89
v_add_f32 v92,1.0,v92
v_mfma_f32_16x16x32_bf16 v[76:79],a[156:159],v[236:239],v[76:79]
ds_read_b128 v[232:235],v17 offset:45056
v_add_f32 v93,1.0,v93
s_waitcnt lgkmcnt(5)
v_mfma_f32_16x16x32_bf16 v[68:71],a[80:83],v[240:243],v[68:71]
v_min3_u32 v27,v27,v240,v244
v_add_f32 v94,1.0,v94
v_add_f32 v95,1.0,v95
v_mfma_f32_16x16x32_bf16 v[76:79],a[208:211],v[240:243],v[76:79]
ds_read_b128 v[236:239],v43 offset:45056
v_rcp_f32 v92,v92
v_mfma_f32_16x16x32_bf16 v[68:71],a[84:87],v[244:247],v[68:71]
v_exp_f32 v90,v90
v_mfma_f32_16x16x32_bf16 v[76:79],a[212:215],v[244:247],v[76:79]
ds_read_b128 v[240:243],v17 offset:37888
s_waitcnt lgkmcnt(5)
v_mfma_f32_16x16x32_bf16 v[68:71],a[88:91],v[248:251],v[68:71]
v_min3_u32 v27,v27,v248,v252
v_rcp_f32 v93,v93
v_mfma_f32_16x16x32_bf16 v[76:79],a[216:219],v[248:251],v[76:79]
ds_read_b128 v[244:247],v43 offset:37888
v_rcp_f32 v94,v94
v_mfma_f32_16x16x32_bf16 v[68:71],a[92:95],v[252:255],v[68:71]
v_exp_f32 v91,v91
v_mfma_f32_16x16x32_bf16 v[76:79],a[220:223],v[252:255],v[76:79]
ds_read_b128 v[248:251],v17 offset:46080
s_waitcnt lgkmcnt(5)
v_mfma_f32_16x16x32_bf16 v[68:71],a[32:35],v[224:227],v[68:71]
v_min3_u32 v27,v27,v224,v228
v_add_f32 v88,1.0,v88
v_mfma_f32_16x16x32_bf16 v[76:79],a[160:163],v[224:227],v[76:79]
ds_read_b128 v[252:255],v43 offset:46080
v_add_f32 v89,1.0,v89
v_mfma_f32_16x16x32_bf16 v[68:71],a[36:39],v[228:231],v[68:71]
v_add_f32 v90,1.0,v90
v_add_f32 v91,1.0,v91
v_mfma_f32_16x16x32_bf16 v[76:79],a[164:167],v[228:231],v[76:79]
ds_read_b128 v[224:227],v17 offset:53248
s_waitcnt lgkmcnt(5)
v_mfma_f32_16x16x32_bf16 v[68:71],a[40:43],v[232:235],v[68:71]
v_min3_u32 v27,v27,v232,v236
v_rcp_f32 v95,v95
v_mfma_f32_16x16x32_bf16 v[76:79],a[168:171],v[232:235],v[76:79]
ds_read_b128 v[228:231],v43 offset:53248
v_mul_f32 v92,v92,v72
v_mfma_f32_16x16x32_bf16 v[68:71],a[44:47],v[236:239],v[68:71]
v_rcp_f32 v88,v88
v_mfma_f32_16x16x32_bf16 v[76:79],a[172:175],v[236:239],v[76:79]
ds_read_b128 v[232:235],v17 offset:61440
s_waitcnt lgkmcnt(5)
v_mfma_f32_16x16x32_bf16 v[68:71],a[96:99],v[240:243],v[68:71]
v_min3_u32 v27,v27,v240,v244
v_mul_f32 v93,v93,v73
v_mfma_f32_16x16x32_bf16 v[76:79],a[224:227],v[240:243],v[76:79]
ds_read_b128 v[236:239],v43 offset:61440
v_mul_f32 v94,v94,v74
v_mfma_f32_16x16x32_bf16 v[68:71],a[100:103],v[244:247],v[68:71]
v_rcp_f32 v89,v89
v_mfma_f32_16x16x32_bf16 v[76:79],a[228:231],v[244:247],v[76:79]
ds_read_b128 v[240:243],v17 offset:54272
s_waitcnt lgkmcnt(5)
v_mfma_f32_16x16x32_bf16 v[68:71],a[104:107],v[248:251],v[68:71]
v_min3_u32 v27,v27,v248,v252
v_mul_f32 v95,v95,v75
v_mfma_f32_16x16x32_bf16 v[76:79],a[232:235],v[248:251],v[76:79]
ds_read_b128 v[244:247],v43 offset:54272
v_mfma_f32_16x16x32_bf16 v[68:71],a[108:111],v[252:255],v[68:71]
v_rcp_f32 v90,v90
v_mfma_f32_16x16x32_bf16 v[76:79],a[236:239],v[252:255],v[76:79]
ds_read_b128 v[248:251],v17 offset:62464
s_waitcnt lgkmcnt(5)
v_mfma_f32_16x16x32_bf16 v[68:71],a[48:51],v[224:227],v[68:71]
v_min3_u32 v27,v27,v224,v228
v_mfma_f32_16x16x32_bf16 v[76:79],a[176:179],v[224:227],v[76:79]
ds_read_b128 v[252:255],v43 offset:62464
v_mfma_f32_16x16x32_bf16 v[68:71],a[52:55],v[228:231],v[68:71]
v_rcp_f32 v91,v91
v_mfma_f32_16x16x32_bf16 v[76:79],a[180:183],v[228:231],v[76:79]
v_mul_f32 v88,v88,v64
s_waitcnt lgkmcnt(4)
v_mfma_f32_16x16x32_bf16 v[68:71],a[56:59],v[232:235],v[68:71]
v_min3_u32 v27,v27,v232,v236
s_waitcnt vmcnt(0)
v_mfma_f32_16x16x32_bf16 v[76:79],a[184:187],v[232:235],v[76:79]
v_cmp_gt_u32 vcc,s96,v2
s_mov_b32 s96,vcc_lo
v_mfma_f32_16x16x32_bf16 v[68:71],a[60:63],v[236:239],v[68:71]
v_mov_b32 v44,s96
ds_write_b32 v46,v44
v_mfma_f32_16x16x32_bf16 v[76:79],a[188:191],v[236:239],v[76:79]
v_mul_f32 v89,v89,v65
s_waitcnt lgkmcnt(3)
v_mfma_f32_16x16x32_bf16 v[68:71],a[112:115],v[240:243],v[68:71]
v_min3_u32 v27,v27,v240,v244
v_mul_f32 v90,v90,v66
v_mfma_f32_16x16x32_bf16 v[76:79],a[240:243],v[240:243],v[76:79]
v_mul_f32 v91,v91,v67
v_cvt_pk_bf16_f32 v96,v88,v89
v_mfma_f32_16x16x32_bf16 v[68:71],a[116:119],v[244:247],v[68:71]
v_cvt_pk_bf16_f32 v97,v90,v91
v_cvt_pk_bf16_f32 v98,v92,v93
v_mfma_f32_16x16x32_bf16 v[76:79],a[244:247],v[244:247],v[76:79]
v_cvt_pk_bf16_f32 v99,v94,v95
s_waitcnt lgkmcnt(1)
v_mfma_f32_16x16x32_bf16 v[68:71],a[120:123],v[248:251],v[68:71]
v_min3_u32 v27,v27,v248,v252
v_max_u32 v96,1,v96
v_mfma_f32_16x16x32_bf16 v[76:79],a[248:251],v[248:251],v[76:79]
buffer_store_dwordx4 v[96:99],v18,s[20:23],s78 offen sc1
v_mfma_f32_16x16x32_bf16 v[68:71],a[124:127],v[252:255],v[68:71]
v_mfma_f32_16x16x32_bf16 v[76:79],a[252:255],v[252:255],v[76:79]
v_cmp_eq_u32 vcc,0,v27
s_cbranch_vccnz retry_201
epi_204:
buffer_load_dword v29,v21,s[20:23],s87 offen sc1
s_nop 3
v_pk_mul_f32 v[88:89],v[68:69],v[68:69]
v_pk_mul_f32 v[90:91],v[70:71],v[70:71]
v_pk_mul_f32 v[92:93],v[76:77],v[76:77]
v_pk_mul_f32 v[94:95],v[78:79],v[78:79]
v_pk_fma_f32 v[88:89],v[88:89],s[80:81],v[28:29] op_sel:[0,1,0] op_sel_hi:[1,1,0]
v_pk_fma_f32 v[90:91],v[90:91],s[80:81],v[28:29] op_sel:[0,1,0] op_sel_hi:[1,1,0]
v_pk_fma_f32 v[92:93],v[92:93],s[80:81],v[28:29] op_sel:[0,1,0] op_sel_hi:[1,1,0]
v_pk_fma_f32 v[94:95],v[94:95],s[80:81],v[28:29] op_sel:[0,1,0] op_sel_hi:[1,1,0]
v_pk_mul_f32 v[88:89],v[88:89],v[68:69]
v_pk_mul_f32 v[90:91],v[90:91],v[70:71]
v_pk_mul_f32 v[92:93],v[92:93],v[76:77]
v_pk_mul_f32 v[94:95],v[94:95],v[78:79]
v_exp_f32 v88,v88
v_exp_f32 v89,v89
v_exp_f32 v90,v90
v_exp_f32 v91,v91
v_exp_f32 v92,v92
v_exp_f32 v93,v93
v_exp_f32 v94,v94
v_exp_f32 v95,v95
v_pk_add_f32 v[88:89],v[88:89],1.0 op_sel_hi:[1,0]
v_pk_add_f32 v[90:91],v[90:91],1.0 op_sel_hi:[1,0]
v_pk_add_f32 v[92:93],v[92:93],1.0 op_sel_hi:[1,0]
v_pk_add_f32 v[94:95],v[94:95],1.0 op_sel_hi:[1,0]
v_rcp_f32 v88,v88
v_rcp_f32 v89,v89
v_rcp_f32 v90,v90
v_rcp_f32 v91,v91
v_rcp_f32 v92,v92
v_rcp_f32 v93,v93
v_rcp_f32 v94,v94
v_rcp_f32 v95,v95
v_pk_mul_f32 v[88:89],v[88:89],v[68:69]
v_pk_mul_f32 v[90:91],v[90:91],v[70:71]
v_pk_mul_f32 v[92:93],v[92:93],v[76:77]
v_pk_mul_f32 v[94:95],v[94:95],v[78:79]
v_cvt_pk_bf16_f32 v96,v88,v89
v_cvt_pk_bf16_f32 v97,v90,v91
v_cvt_pk_bf16_f32 v98,v92,v93
v_cvt_pk_bf16_f32 v99,v94,v95
v_max_u32 v96,1,v96
buffer_store_dwordx4 v[96:99],v19,s[20:23],s78 offen sc1
v_xor_b32 v18,0x2000,v18
v_xor_b32 v19,0x2000,v19
s_add_u32 s78,s78,2097152
s_cmp_gt_u32 s71,51
s_cselect_b32 s65,s73,0x7fff0000
s_cselect_b32 s97,0x7fff0000,s73
v_mov_b32 v22,s71
buffer_store_dword v22,v23,s[24:27],s65 offen
buffer_store_dword v22,v23,s[28:31],s65 offen sc1
v_xor_b32 v43,0x10000,v43
v_xor_b32 v17,0x10000,v17
v_xor_b32 v45,16,v45
v_xor_b32 v46,16,v46
s_xor_b32 s72,s72,0x10000
s_add_u32 s70,s70,2097152
s_xor_b32 s70,s70,0x2000
s_add_u32 s71,s71,1
s_cmp_le_u32 s71,64
s_cbranch_scc1 seg_202
s_add_u32 s65,s73,2560
v_add_u32 v22,s71,-1
buffer_store_dword v22,v23,s[20:23],s65 offen sc1
s_endpgm
retry_201:
s_sub_u32 s90,s90,64
s_cmp_lt_i32 s90,0
s_cbranch_scc1 giveup_176
s_mov_b32 s83,1
s_waitcnt vmcnt(0) lgkmcnt(0)
s_barrier
s_branch seg_202
r_w2_196:
s_load_dwordx2 s[4:5],s[0:1],72
s_and_b32 s41,s59,7
s_lshl_b32 s66,s41,8
s_lshl_b32 s67,s50,1
s_waitcnt lgkmcnt(0)
s_mov_b32 s32,s4
s_and_b32 s33,s5,0xffff
s_mov_b32 s34,0x200000
s_mov_b32 s35,0x20000
v_lshrrev_b32 v5,2,v3
v_lshl_add_u32 v5,v4,2,v5
v_and_b32 v6,3,v3
v_lshlrev_b32 v6,3,v6
v_lshl_add_u32 v6,v5,8,v6
v_and_b32 v5,7,v5
v_xor_b32 v5,s67,v5
v_lshl_add_u32 v12,v5,5,v6
v_xor_b32 v13,32,v12
v_and_b32 v5,15,v1
v_and_b32 v6,3,v4
v_lshlrev_b32 v6,1,v6
v_xor_b32 v5,v5,v6
v_mul_u32_u24 v6,2048,v4
v_xor_b32 v7,0,v5
v_lshl_add_u32 v8,v7,4,v6
v_xor_b32 v7,8,v5
v_lshl_add_u32 v9,v7,4,v6
s_mul_i32 s74,s50,131072
s_add_u32 s74,s74,s66
s_lshl_b32 s75,s50,14
s_mul_i32 s76,s50,65536
s_add_u32 s76,s76,s66
s_lshl_b32 s77,s50,13
s_add_u32 s64,s74,0
s_add_u32 m0,s75,0
s_nop 0
buffer_load_dwordx4 v8,s[32:35],s64 offen nt lds
s_add_u32 s64,s74,8192
s_add_u32 m0,s75,1024
s_nop 0
buffer_load_dwordx4 v9,s[32:35],s64 offen nt lds
s_add_u32 s64,s74,16384
s_add_u32 m0,s75,2048
s_nop 0
buffer_load_dwordx4 v8,s[32:35],s64 offen nt lds
s_add_u32 s64,s74,24576
s_add_u32 m0,s75,3072
s_nop 0
buffer_load_dwordx4 v9,s[32:35],s64 offen nt lds
s_add_u32 s64,s74,32768
s_add_u32 m0,s75,4096
s_nop 0
buffer_load_dwordx4 v8,s[32:35],s64 offen nt lds
s_add_u32 s64,s74,40960
s_add_u32 m0,s75,5120
s_nop 0
buffer_load_dwordx4 v9,s[32:35],s64 offen nt lds
s_add_u32 s64,s74,49152
s_add_u32 m0,s75,6144
s_nop 0
buffer_load_dwordx4 v8,s[32:35],s64 offen nt lds
s_add_u32 s64,s74,57344
s_add_u32 m0,s75,7168
s_nop 0
buffer_load_dwordx4 v9,s[32:35],s64 offen nt lds
s_add_u32 s64,s74,65536
s_add_u32 m0,s75,8192
s_nop 0
buffer_load_dwordx4 v8,s[32:35],s64 offen nt lds
s_add_u32 s64,s74,73728
s_add_u32 m0,s75,9216
s_nop 0
buffer_load_dwordx4 v9,s[32:35],s64 offen nt lds
s_add_u32 s64,s74,81920
s_add_u32 m0,s75,10240
s_nop 0
buffer_load_dwordx4 v8,s[32:35],s64 offen nt lds
s_add_u32 s64,s74,90112
s_add_u32 m0,s75,11264
s_nop 0
buffer_load_dwordx4 v9,s[32:35],s64 offen nt lds
s_add_u32 s64,s74,98304
s_add_u32 m0,s75,12288
s_nop 0
buffer_load_dwordx4 v8,s[32:35],s64 offen nt lds
s_add_u32 s64,s74,106496
s_add_u32 m0,s75,13312
s_nop 0
buffer_load_dwordx4 v9,s[32:35],s64 offen nt lds
s_add_u32 s64,s74,114688
s_add_u32 m0,s75,14336
s_nop 0
buffer_load_dwordx4 v8,s[32:35],s64 offen nt lds
s_add_u32 s64,s74,122880
s_add_u32 m0,s75,15360
s_nop 0
buffer_load_dwordx4 v9,s[32:35],s64 offen nt lds
s_add_u32 s64,s74,524288
s_add_u32 m0,s75,65536
s_nop 0
buffer_load_dwordx4 v8,s[32:35],s64 offen nt lds
s_add_u32 s64,s74,532480
s_add_u32 m0,s75,66560
s_nop 0
buffer_load_dwordx4 v9,s[32:35],s64 offen nt lds
s_add_u32 s64,s74,540672
s_add_u32 m0,s75,67584
s_nop 0
buffer_load_dwordx4 v8,s[32:35],s64 offen nt lds
s_add_u32 s64,s74,548864
s_add_u32 m0,s75,68608
s_nop 0
buffer_load_dwordx4 v9,s[32:35],s64 offen nt lds
s_add_u32 s64,s74,557056
s_add_u32 m0,s75,69632
s_nop 0
buffer_load_dwordx4 v8,s[32:35],s64 offen nt lds
s_add_u32 s64,s74,565248
s_add_u32 m0,s75,70656
s_nop 0
buffer_load_dwordx4 v9,s[32:35],s64 offen nt lds
s_add_u32 s64,s74,573440
s_add_u32 m0,s75,71680
s_nop 0
buffer_load_dwordx4 v8,s[32:35],s64 offen nt lds
s_add_u32 s64,s74,581632
s_add_u32 m0,s75,72704
s_nop 0
buffer_load_dwordx4 v9,s[32:35],s64 offen nt lds
s_add_u32 s64,s74,589824
s_add_u32 m0,s75,73728
s_nop 0
buffer_load_dwordx4 v8,s[32:35],s64 offen nt lds
s_add_u32 s64,s74,598016
s_add_u32 m0,s75,74752
s_nop 0
buffer_load_dwordx4 v9,s[32:35],s64 offen nt lds
s_add_u32 s64,s74,606208
s_add_u32 m0,s75,75776
s_nop 0
buffer_load_dwordx4 v8,s[32:35],s64 offen nt lds
s_add_u32 s64,s74,614400
s_add_u32 m0,s75,76800
s_nop 0
buffer_load_dwordx4 v9,s[32:35],s64 offen nt lds
s_add_u32 s64,s74,622592
s_add_u32 m0,s75,77824
s_nop 0
buffer_load_dwordx4 v8,s[32:35],s64 offen nt lds
s_add_u32 s64,s74,630784
s_add_u32 m0,s75,78848
s_nop 0
buffer_load_dwordx4 v9,s[32:35],s64 offen nt lds
s_add_u32 s64,s74,638976
s_add_u32 m0,s75,79872
s_nop 0
buffer_load_dwordx4 v8,s[32:35],s64 offen nt lds
s_add_u32 s64,s74,647168
s_add_u32 m0,s75,80896
s_nop 0
buffer_load_dwordx4 v9,s[32:35],s64 offen nt lds
s_waitcnt vmcnt(16)
s_barrier
ds_read_b64_tr_b16 a[0:1],v12 offset:0
ds_read_b64_tr_b16 a[128:129],v13 offset:0
ds_read_b64_tr_b16 a[2:3],v12 offset:4096
ds_read_b64_tr_b16 a[130:131],v13 offset:4096
ds_read_b64_tr_b16 a[4:5],v12 offset:8192
ds_read_b64_tr_b16 a[132:133],v13 offset:8192
ds_read_b64_tr_b16 a[6:7],v12 offset:12288
ds_read_b64_tr_b16 a[134:135],v13 offset:12288
s_waitcnt lgkmcnt(4)
ds_read_b64_tr_b16 a[8:9],v12 offset:16384
ds_read_b64_tr_b16 a[136:137],v13 offset:16384
ds_read_b64_tr_b16 a[10:11],v12 offset:20480
ds_read_b64_tr_b16 a[138:139],v13 offset:20480
ds_read_b64_tr_b16 a[12:13],v12 offset:24576
ds_read_b64_tr_b16 a[140:141],v13 offset:24576
ds_read_b64_tr_b16 a[14:15],v12 offset:28672
ds_read_b64_tr_b16 a[142:143],v13 offset:28672
s_waitcnt lgkmcnt(4)
ds_read_b64_tr_b16 a[16:17],v12 offset:32768
ds_read_b64_tr_b16 a[144:145],v13 offset:32768
ds_read_b64_tr_b16 a[18:19],v12 offset:36864
ds_read_b64_tr_b16 a[146:147],v13 offset:36864
ds_read_b64_tr_b16 a[20:21],v12 offset:40960
ds_read_b64_tr_b16 a[148:149],v13 offset:40960
ds_read_b64_tr_b16 a[22:23],v12 offset:45056
ds_read_b64_tr_b16 a[150:151],v13 offset:45056
s_waitcnt lgkmcnt(4)
ds_read_b64_tr_b16 a[24:25],v12 offset:49152
ds_read_b64_tr_b16 a[152:153],v13 offset:49152
ds_read_b64_tr_b16 a[26:27],v12 offset:53248
ds_read_b64_tr_b16 a[154:155],v13 offset:53248
ds_read_b64_tr_b16 a[28:29],v12 offset:57344
ds_read_b64_tr_b16 a[156:157],v13 offset:57344
ds_read_b64_tr_b16 a[30:31],v12 offset:61440
ds_read_b64_tr_b16 a[158:159],v13 offset:61440
s_waitcnt lgkmcnt(4)
v_xor_b32 v12,0x10000,v12
v_xor_b32 v13,0x10000,v13
s_waitcnt lgkmcnt(0)
s_barrier
s_add_u32 s64,s74,1048576
s_add_u32 m0,s75,0
s_nop 0
buffer_load_dwordx4 v8,s[32:35],s64 offen nt lds
s_add_u32 s64,s74,1056768
s_add_u32 m0,s75,1024
s_nop 0
buffer_load_dwordx4 v9,s[32:35],s64 offen nt lds
s_add_u32 s64,s74,1064960
s_add_u32 m0,s75,2048
s_nop 0
buffer_load_dwordx4 v8,s[32:35],s64 offen nt lds
s_add_u32 s64,s74,1073152
s_add_u32 m0,s75,3072
s_nop 0
buffer_load_dwordx4 v9,s[32:35],s64 offen nt lds
s_add_u32 s64,s74,1081344
s_add_u32 m0,s75,4096
s_nop 0
buffer_load_dwordx4 v8,s[32:35],s64 offen nt lds
s_add_u32 s64,s74,1089536
s_add_u32 m0,s75,5120
s_nop 0
buffer_load_dwordx4 v9,s[32:35],s64 offen nt lds
s_add_u32 s64,s74,1097728
s_add_u32 m0,s75,6144
s_nop 0
buffer_load_dwordx4 v8,s[32:35],s64 offen nt lds
s_add_u32 s64,s74,1105920
s_add_u32 m0,s75,7168
s_nop 0
buffer_load_dwordx4 v9,s[32:35],s64 offen nt lds
s_add_u32 s64,s74,1114112
s_add_u32 m0,s75,8192
s_nop 0
buffer_load_dwordx4 v8,s[32:35],s64 offen nt lds
s_add_u32 s64,s74,1122304
s_add_u32 m0,s75,9216
s_nop 0
buffer_load_dwordx4 v9,s[32:35],s64 offen nt lds
s_add_u32 s64,s74,1130496
s_add_u32 m0,s75,10240
s_nop 0
buffer_load_dwordx4 v8,s[32:35],s64 offen nt lds
s_add_u32 s64,s74,1138688
s_add_u32 m0,s75,11264
s_nop 0
buffer_load_dwordx4 v9,s[32:35],s64 offen nt lds
s_add_u32 s64,s74,1146880
s_add_u32 m0,s75,12288
s_nop 0
buffer_load_dwordx4 v8,s[32:35],s64 offen nt lds
s_add_u32 s64,s74,1155072
s_add_u32 m0,s75,13312
s_nop 0
buffer_load_dwordx4 v9,s[32:35],s64 offen nt lds
s_add_u32 s64,s74,1163264
s_add_u32 m0,s75,14336
s_nop 0
buffer_load_dwordx4 v8,s[32:35],s64 offen nt lds
s_add_u32 s64,s74,1171456
s_add_u32 m0,s75,15360
s_nop 0
buffer_load_dwordx4 v9,s[32:35],s64 offen nt lds
s_waitcnt vmcnt(16)
s_barrier
ds_read_b64_tr_b16 a[32:33],v12 offset:0
ds_read_b64_tr_b16 a[160:161],v13 offset:0
ds_read_b64_tr_b16 a[34:35],v12 offset:4096
ds_read_b64_tr_b16 a[162:163],v13 offset:4096
ds_read_b64_tr_b16 a[36:37],v12 offset:8192
ds_read_b64_tr_b16 a[164:165],v13 offset:8192
ds_read_b64_tr_b16 a[38:39],v12 offset:12288
ds_read_b64_tr_b16 a[166:167],v13 offset:12288
s_waitcnt lgkmcnt(4)
ds_read_b64_tr_b16 a[40:41],v12 offset:16384
ds_read_b64_tr_b16 a[168:169],v13 offset:16384
ds_read_b64_tr_b16 a[42:43],v12 offset:20480
ds_read_b64_tr_b16 a[170:171],v13 offset:20480
ds_read_b64_tr_b16 a[44:45],v12 offset:24576
ds_read_b64_tr_b16 a[172:173],v13 offset:24576
ds_read_b64_tr_b16 a[46:47],v12 offset:28672
ds_read_b64_tr_b16 a[174:175],v13 offset:28672
s_waitcnt lgkmcnt(4)
ds_read_b64_tr_b16 a[48:49],v12 offset:32768
ds_read_b64_tr_b16 a[176:177],v13 offset:32768
ds_read_b64_tr_b16 a[50:51],v12 offset:36864
ds_read_b64_tr_b16 a[178:179],v13 offset:36864
ds_read_b64_tr_b16 a[52:53],v12 offset:40960
ds_read_b64_tr_b16 a[180:181],v13 offset:40960
ds_read_b64_tr_b16 a[54:55],v12 offset:45056
ds_read_b64_tr_b16 a[182:183],v13 offset:45056
s_waitcnt lgkmcnt(4)
ds_read_b64_tr_b16 a[56:57],v12 offset:49152
ds_read_b64_tr_b16 a[184:185],v13 offset:49152
ds_read_b64_tr_b16 a[58:59],v12 offset:53248
ds_read_b64_tr_b16 a[186:187],v13 offset:53248
ds_read_b64_tr_b16 a[60:61],v12 offset:57344
ds_read_b64_tr_b16 a[188:189],v13 offset:57344
ds_read_b64_tr_b16 a[62:63],v12 offset:61440
ds_read_b64_tr_b16 a[190:191],v13 offset:61440
s_waitcnt lgkmcnt(4)
v_xor_b32 v12,0x10000,v12
v_xor_b32 v13,0x10000,v13
s_waitcnt lgkmcnt(0)
s_barrier
s_add_u32 s64,s74,1572864
s_add_u32 m0,s75,65536
s_nop 0
buffer_load_dwordx4 v8,s[32:35],s64 offen nt lds
s_add_u32 s64,s74,1581056
s_add_u32 m0,s75,66560
s_nop 0
buffer_load_dwordx4 v9,s[32:35],s64 offen nt lds
s_add_u32 s64,s74,1589248
s_add_u32 m0,s75,67584
s_nop 0
buffer_load_dwordx4 v8,s[32:35],s64 offen nt lds
s_add_u32 s64,s74,1597440
s_add_u32 m0,s75,68608
s_nop 0
buffer_load_dwordx4 v9,s[32:35],s64 offen nt lds
s_add_u32 s64,s74,1605632
s_add_u32 m0,s75,69632
s_nop 0
buffer_load_dwordx4 v8,s[32:35],s64 offen nt lds
s_add_u32 s64,s74,1613824
s_add_u32 m0,s75,70656
s_nop 0
buffer_load_dwordx4 v9,s[32:35],s64 offen nt lds
s_add_u32 s64,s74,1622016
s_add_u32 m0,s75,71680
s_nop 0
buffer_load_dwordx4 v8,s[32:35],s64 offen nt lds
s_add_u32 s64,s74,1630208
s_add_u32 m0,s75,72704
s_nop 0
buffer_load_dwordx4 v9,s[32:35],s64 offen nt lds
s_add_u32 s64,s74,1638400
s_add_u32 m0,s75,73728
s_nop 0
buffer_load_dwordx4 v8,s[32:35],s64 offen nt lds
s_add_u32 s64,s74,1646592
s_add_u32 m0,s75,74752
s_nop 0
buffer_load_dwordx4 v9,s[32:35],s64 offen nt lds
s_add_u32 s64,s74,1654784
s_add_u32 m0,s75,75776
s_nop 0
buffer_load_dwordx4 v8,s[32:35],s64 offen nt lds
s_add_u32 s64,s74,1662976
s_add_u32 m0,s75,76800
s_nop 0
buffer_load_dwordx4 v9,s[32:35],s64 offen nt lds
s_add_u32 s64,s74,1671168
s_add_u32 m0,s75,77824
s_nop 0
buffer_load_dwordx4 v8,s[32:35],s64 offen nt lds
s_add_u32 s64,s74,1679360
s_add_u32 m0,s75,78848
s_nop 0
buffer_load_dwordx4 v9,s[32:35],s64 offen nt lds
s_add_u32 s64,s74,1687552
s_add_u32 m0,s75,79872
s_nop 0
buffer_load_dwordx4 v8,s[32:35],s64 offen nt lds
s_add_u32 s64,s74,1695744
s_add_u32 m0,s75,80896
s_nop 0
buffer_load_dwordx4 v9,s[32:35],s64 offen nt lds
s_waitcnt vmcnt(16)
s_barrier
ds_read_b64_tr_b16 a[64:65],v12 offset:0
ds_read_b64_tr_b16 a[192:193],v13 offset:0
ds_read_b64_tr_b16 a[66:67],v12 offset:4096
ds_read_b64_tr_b16 a[194:195],v13 offset:4096
ds_read_b64_tr_b16 a[68:69],v12 offset:8192
ds_read_b64_tr_b16 a[196:197],v13 offset:8192
ds_read_b64_tr_b16 a[70:71],v12 offset:12288
ds_read_b64_tr_b16 a[198:199],v13 offset:12288
s_waitcnt lgkmcnt(4)
ds_read_b64_tr_b16 a[72:73],v12 offset:16384
ds_read_b64_tr_b16 a[200:201],v13 offset:16384
ds_read_b64_tr_b16 a[74:75],v12 offset:20480
ds_read_b64_tr_b16 a[202:203],v13 offset:20480
ds_read_b64_tr_b16 a[76:77],v12 offset:24576
ds_read_b64_tr_b16 a[204:205],v13 offset:24576
ds_read_b64_tr_b16 a[78:79],v12 offset:28672
ds_read_b64_tr_b16 a[206:207],v13 offset:28672
s_waitcnt lgkmcnt(4)
ds_read_b64_tr_b16 a[80:81],v12 offset:32768
ds_read_b64_tr_b16 a[208:209],v13 offset:32768
ds_read_b64_tr_b16 a[82:83],v12 offset:36864
ds_read_b64_tr_b16 a[210:211],v13 offset:36864
ds_read_b64_tr_b16 a[84:85],v12 offset:40960
ds_read_b64_tr_b16 a[212:213],v13 offset:40960
ds_read_b64_tr_b16 a[86:87],v12 offset:45056
ds_read_b64_tr_b16 a[214:215],v13 offset:45056
s_waitcnt lgkmcnt(4)
ds_read_b64_tr_b16 a[88:89],v12 offset:49152
ds_read_b64_tr_b16 a[216:217],v13 offset:49152
ds_read_b64_tr_b16 a[90:91],v12 offset:53248
ds_read_b64_tr_b16 a[218:219],v13 offset:53248
ds_read_b64_tr_b16 a[92:93],v12 offset:57344
ds_read_b64_tr_b16 a[220:221],v13 offset:57344
ds_read_b64_tr_b16 a[94:95],v12 offset:61440
ds_read_b64_tr_b16 a[222:223],v13 offset:61440
s_waitcnt lgkmcnt(4)
v_xor_b32 v12,0x10000,v12
v_xor_b32 v13,0x10000,v13
s_waitcnt lgkmcnt(0)
s_barrier
s_waitcnt vmcnt(0)
s_barrier
ds_read_b64_tr_b16 a[96:97],v12 offset:0
ds_read_b64_tr_b16 a[224:225],v13 offset:0
ds_read_b64_tr_b16 a[98:99],v12 offset:4096
ds_read_b64_tr_b16 a[226:227],v13 offset:4096
ds_read_b64_tr_b16 a[100:101],v12 offset:8192
ds_read_b64_tr_b16 a[228:229],v13 offset:8192
ds_read_b64_tr_b16 a[102:103],v12 offset:12288
ds_read_b64_tr_b16 a[230:231],v13 offset:12288
s_waitcnt lgkmcnt(4)
ds_read_b64_tr_b16 a[104:105],v12 offset:16384
ds_read_b64_tr_b16 a[232:233],v13 offset:16384
ds_read_b64_tr_b16 a[106:107],v12 offset:20480
ds_read_b64_tr_b16 a[234:235],v13 offset:20480
ds_read_b64_tr_b16 a[108:109],v12 offset:24576
ds_read_b64_tr_b16 a[236:237],v13 offset:24576
ds_read_b64_tr_b16 a[110:111],v12 offset:28672
ds_read_b64_tr_b16 a[238:239],v13 offset:28672
s_waitcnt lgkmcnt(4)
ds_read_b64_tr_b16 a[112:113],v12 offset:32768
ds_read_b64_tr_b16 a[240:241],v13 offset:32768
ds_read_b64_tr_b16 a[114:115],v12 offset:36864
ds_read_b64_tr_b16 a[242:243],v13 offset:36864
ds_read_b64_tr_b16 a[116:117],v12 offset:40960
ds_read_b64_tr_b16 a[244:245],v13 offset:40960
ds_read_b64_tr_b16 a[118:119],v12 offset:45056
ds_read_b64_tr_b16 a[246:247],v13 offset:45056
s_waitcnt lgkmcnt(4)
ds_read_b64_tr_b16 a[120:121],v12 offset:49152
ds_read_b64_tr_b16 a[248:249],v13 offset:49152
ds_read_b64_tr_b16 a[122:123],v12 offset:53248
ds_read_b64_tr_b16 a[250:251],v13 offset:53248
ds_read_b64_tr_b16 a[124:125],v12 offset:57344
ds_read_b64_tr_b16 a[252:253],v13 offset:57344
ds_read_b64_tr_b16 a[126:127],v12 offset:61440
ds_read_b64_tr_b16 a[254:255],v13 offset:61440
s_waitcnt lgkmcnt(4)
v_xor_b32 v12,0x10000,v12
v_xor_b32 v13,0x10000,v13
s_waitcnt lgkmcnt(0)
s_barrier
v_and_b32 v21,1,v1
v_mul_u32_u24 v21,960,v21
s_mov_b32 s65,21052032
s_mov_b32 s66,1792
pl_211:
buffer_load_dword v22,v21,s[20:23],s65 offen sc1
s_waitcnt vmcnt(0)
v_cmp_gt_u32 vcc,s66,v22
s_cbranch_vccz pok_212
s_sleep 1
s_sub_u32 s90,s90,1
s_cmp_gt_i32 s90,0
s_cbranch_scc1 pl_211
pok_212:
s_mov_b32 s81,0xbdd2d3e8
v_mov_b32 v28,0xc0135761
v_mov_b32 v17,v16
v_and_b32 v21,31,v1
v_lshlrev_b32 v21,2,v21
s_mul_i32 s74,s79,40
s_add_u32 s74,s74,s63
s_add_u32 s74,s74,3072
s_lshl_b32 s42,s41,2
s_add_u32 s42,s42,s50
s_lshl_b32 s73,s41,7
s_lshl_b32 s64,s50,2
s_add_u32 s73,s73,s64
s_add_u32 s73,s73,s63
s_add_u32 s73,s73,6144
s_add_u32 s73,s73,s60
s_lshl_b32 s43,s50,11
s_lshl_b32 s78,s79,21
s_add_u32 s78,s78,27262976
s_mov_b32 s64,0
s_lshr_b32 s65,s50,1
s_and_b32 s66,s50,1
s_lshl_b32 s66,s66,12
s_add_u32 s66,s66,s64
s_lshl_b32 s72,s65,13
s_add_u32 s72,s72,s66
s_add_u32 s72,s72,0x10000
s_lshl_b32 s65,s65,14
s_add_u32 s75,s65,s66
s_add_u32 s75,s75,1966080
s_add_u32 s64,s41,72
s_lshl_b32 s64,s64,14
s_add_u32 s64,s64,s43
v_add_u32 v18,s64,v16
s_lshl_b32 s64,s42,8
s_add_u32 s64,s64,1310720
v_lshl_add_u32 v24,v3,4,s64
v_mov_b32 v5,0x40000000
v_cmp_gt_u32 vcc,16,v1
s_nop 1
v_cndmask_b32 v24,v5,v24,vcc
s_lshl_b32 s64,s42,6
v_and_b32 v5,3,v1
v_xor_b32 v5,v5,v4
v_lshl_add_u32 v5,v5,4,s64
v_lshrrev_b32 v11,2,v1
s_add_u32 s43,s43,133120
v_lshrrev_b32 v6,2,v3
v_lshrrev_b32 v7,1,v4
v_xor_b32 v6,v6,v7
v_lshlrev_b32 v6,4,v6
v_lshl_add_u32 v6,v3,6,v6
v_and_b32 v7,1,v4
v_lshl_add_u32 v6,v7,3,v6
v_add_u32 v40,s43,v6
v_xor_b32 v41,32,v40
v_add_u32 v6,30,v11
v_lshl_add_u32 v9,v6,7,v5
v_and_b32 v9,2047,v9
v_and_b32 v7,3,v6
v_lshl_add_u32 v7,v7,11,v9
v_bfe_u32 v8,v6,2,3
v_lshl_add_u32 v7,v8,14,v7
v_mov_b32 v8,0x2000
v_mov_b32 v9,2097152
v_cmp_gt_u32 vcc,32,v6
s_nop 1
v_cndmask_b32 v8,v9,v8,vcc
v_add_u32 v7,v7,v8
v_add_u32 v7,0,v7
v_xor_b32 v19,s62,v7
v_add_u32 v6,46,v11
v_lshl_add_u32 v9,v6,7,v5
v_and_b32 v9,2047,v9
v_and_b32 v7,3,v6
v_lshl_add_u32 v7,v7,11,v9
v_bfe_u32 v8,v6,2,3
v_lshl_add_u32 v7,v8,14,v7
v_mov_b32 v8,0x2000
v_mov_b32 v9,2097152
v_cmp_gt_u32 vcc,32,v6
s_nop 1
v_cndmask_b32 v8,v9,v8,vcc
v_add_u32 v7,v7,v8
v_add_u32 v7,0,v7
v_xor_b32 v20,s62,v7
s_add_u32 s64,s79,0
s_lshl_b32 s70,s64,21
s_lshl_b32 s64,s64,13
s_and_b32 s64,s64,0x2000
s_xor_b32 s64,s64,s62
s_add_u32 s70,s70,s64
s_add_u32 s70,s70,29360128
s_mov_b32 s83,1
s_mov_b32 s87,s74
s_cmp_eq_u32 s50,0
s_cselect_b32 s74,s74,0x7fff0000
v_mov_b32 v45,132096
s_lshl_b32 s64,s50,2
s_add_u32 s64,s64,132112
v_mov_b32 v46,s64
v_mov_b32 v2,0
v_mov_b32 v44,1
ds_write_b32 v45,v44
s_mov_b32 s97,0x7fff0000
s_waitcnt lgkmcnt(0)
seg_214:
s_cmp_eq_u32 s83,0
s_cbranch_scc1 ahead_215
s_add_u32 s94,s70,s75
s_xor_b32 s95,s94,1024
s_xor_b32 s91,s72,0x10000
s_min_u32 s66,s71,64
s_waitcnt lgkmcnt(0)
v_cmp_gt_u32 vcc,s66,v2
s_cbranch_vccz nb_218
s_waitcnt vmcnt(3)
v_cmp_gt_u32 vcc,s66,v29
s_cbranch_vccz nb_218
s_waitcnt vmcnt(0)
v_add_u32 v22,s71,-1
buffer_store_dword v22,v23,s[20:23],s97 offen sc1
s_mov_b32 s97,0x7fff0000
s_cmp_lg_u32 s50,0
s_cbranch_scc1 nb_218
buffer_load_dword v32,v21,s[20:23],s74 offen sc1
s_sleep 2
pl_219:
buffer_load_dword v33,v21,s[20:23],s74 offen sc1
s_waitcnt vmcnt(1)
v_cmp_gt_u32 vcc,s66,v32
s_cbranch_vccz pok_220
buffer_load_dword v32,v21,s[20:23],s74 offen sc1
s_waitcnt vmcnt(1)
v_cmp_gt_u32 vcc,s66,v33
s_cbranch_vccz pok_220
s_sub_u32 s90,s90,1
s_cmp_gt_i32 s90,0
s_cbranch_scc1 pl_219
pok_220:
nb_218:
s_barrier
s_xor_b32 m0,s91,0
s_add_u32 s65,s94,0
buffer_load_dwordx4 v16,s[20:23],s65 offen offset:0 sc1 lds
buffer_load_dwordx4 v16,s[20:23],s65 offen offset:2048 sc1 lds
ds_read_b32 v44,v45
s_xor_b32 m0,s91,16384
s_add_u32 s65,s94,32768
buffer_load_dwordx4 v16,s[20:23],s65 offen offset:0 sc1 lds
buffer_load_dwordx4 v16,s[20:23],s65 offen offset:2048 sc1 lds
s_xor_b32 m0,s91,32768
s_add_u32 s65,s94,65536
buffer_load_dwordx4 v16,s[20:23],s65 offen offset:0 sc1 lds
buffer_load_dwordx4 v16,s[20:23],s65 offen offset:2048 sc1 lds
s_xor_b32 m0,s91,49152
s_add_u32 s65,s94,98304
buffer_load_dwordx4 v16,s[20:23],s65 offen offset:0 sc1 lds
buffer_load_dwordx4 v16,s[20:23],s65 offen offset:2048 sc1 lds
s_xor_b32 m0,s91,1024
s_add_u32 s65,s95,0
buffer_load_dwordx4 v16,s[20:23],s65 offen offset:0 sc1 lds
buffer_load_dwordx4 v16,s[20:23],s65 offen offset:2048 sc1 lds
s_waitcnt vmcnt(10)
v_add_u32 v22,s71,-1
buffer_store_dword v22,v23,s[20:23],s97 offen sc1
s_mov_b32 s97,0x7fff0000
s_waitcnt lgkmcnt(0)
v_readfirstlane_b32 s83,v44
s_cmp_eq_u32 s83,0
s_cbranch_scc1 both_217
s_waitcnt vmcnt(9)
s_barrier
ds_read_b128 v[224:227],v17 offset:0
ds_read_b128 v[228:231],v17 offset:2048
ds_read_b128 v[232:235],v17 offset:4096
ds_read_b128 v[236:239],v17 offset:6144
ds_read_b128 v[240:243],v17 offset:8192
ds_read_b128 v[244:247],v17 offset:10240
ds_read_b128 v[248:251],v17 offset:12288
s_waitcnt lgkmcnt(5)
v_mfma_f32_16x16x32_bf16 v[64:67],a[0:3],v[224:227],0
v_min_u32 v27,v224,v228
s_xor_b32 m0,s91,17408
v_mfma_f32_16x16x32_bf16 v[72:75],a[128:131],v[224:227],0
ds_read_b128 v[252:255],v17 offset:14336
v_mfma_f32_16x16x32_bf16 v[64:67],a[4:7],v[228:231],v[64:67]
s_add_u32 s65,s95,32768
v_mfma_f32_16x16x32_bf16 v[72:75],a[132:135],v[228:231],v[72:75]
s_waitcnt vmcnt(7)
s_barrier
ds_read_b128 v[224:227],v17 offset:16384
s_waitcnt lgkmcnt(5)
v_mfma_f32_16x16x32_bf16 v[64:67],a[8:11],v[232:235],v[64:67]
v_min3_u32 v27,v27,v232,v236
buffer_load_dwordx4 v16,s[20:23],s65 offen offset:0 sc1 lds
v_mfma_f32_16x16x32_bf16 v[72:75],a[136:139],v[232:235],v[72:75]
ds_read_b128 v[228:231],v17 offset:18432
v_mfma_f32_16x16x32_bf16 v[64:67],a[12:15],v[236:239],v[64:67]
buffer_load_dwordx4 v16,s[20:23],s65 offen offset:2048 sc1 lds
v_mfma_f32_16x16x32_bf16 v[72:75],a[140:143],v[236:239],v[72:75]
ds_read_b128 v[232:235],v17 offset:20480
s_waitcnt lgkmcnt(5)
v_mfma_f32_16x16x32_bf16 v[64:67],a[16:19],v[240:243],v[64:67]
v_min3_u32 v27,v27,v240,v244
s_xor_b32 m0,s91,33792
v_mfma_f32_16x16x32_bf16 v[72:75],a[144:147],v[240:243],v[72:75]
ds_read_b128 v[236:239],v17 offset:22528
v_mfma_f32_16x16x32_bf16 v[64:67],a[20:23],v[244:247],v[64:67]
s_add_u32 s65,s95,65536
v_mfma_f32_16x16x32_bf16 v[72:75],a[148:151],v[244:247],v[72:75]
ds_read_b128 v[240:243],v17 offset:24576
s_waitcnt lgkmcnt(5)
v_mfma_f32_16x16x32_bf16 v[64:67],a[24:27],v[248:251],v[64:67]
v_min3_u32 v27,v27,v248,v252
buffer_load_dwordx4 v16,s[20:23],s65 offen offset:0 sc1 lds
v_mfma_f32_16x16x32_bf16 v[72:75],a[152:155],v[248:251],v[72:75]
ds_read_b128 v[244:247],v17 offset:26624
v_mfma_f32_16x16x32_bf16 v[64:67],a[28:31],v[252:255],v[64:67]
buffer_load_dwordx4 v16,s[20:23],s65 offen offset:2048 sc1 lds
v_mfma_f32_16x16x32_bf16 v[72:75],a[156:159],v[252:255],v[72:75]
ds_read_b128 v[248:251],v17 offset:28672
s_waitcnt lgkmcnt(5)
v_mfma_f32_16x16x32_bf16 v[64:67],a[32:35],v[224:227],v[64:67]
v_min3_u32 v27,v27,v224,v228
s_xor_b32 m0,s91,50176
v_mfma_f32_16x16x32_bf16 v[72:75],a[160:163],v[224:227],v[72:75]
ds_read_b128 v[252:255],v17 offset:30720
v_mfma_f32_16x16x32_bf16 v[64:67],a[36:39],v[228:231],v[64:67]
s_add_u32 s65,s95,98304
v_mfma_f32_16x16x32_bf16 v[72:75],a[164:167],v[228:231],v[72:75]
s_waitcnt vmcnt(7)
s_barrier
ds_read_b128 v[224:227],v17 offset:32768
s_waitcnt lgkmcnt(5)
v_mfma_f32_16x16x32_bf16 v[64:67],a[40:43],v[232:235],v[64:67]
v_min3_u32 v27,v27,v232,v236
buffer_load_dwordx4 v16,s[20:23],s65 offen offset:0 sc1 lds
v_mfma_f32_16x16x32_bf16 v[72:75],a[168:171],v[232:235],v[72:75]
ds_read_b128 v[228:231],v17 offset:34816
v_mfma_f32_16x16x32_bf16 v[64:67],a[44:47],v[236:239],v[64:67]
buffer_load_dwordx4 v16,s[20:23],s65 offen offset:2048 sc1 lds
v_mfma_f32_16x16x32_bf16 v[72:75],a[172:175],v[236:239],v[72:75]
ds_read_b128 v[232:235],v17 offset:36864
s_waitcnt lgkmcnt(5)
v_mfma_f32_16x16x32_bf16 v[64:67],a[48:51],v[240:243],v[64:67]
v_min3_u32 v27,v27,v240,v244
v_mfma_f32_16x16x32_bf16 v[72:75],a[176:179],v[240:243],v[72:75]
ds_read_b128 v[236:239],v17 offset:38912
v_mfma_f32_16x16x32_bf16 v[64:67],a[52:55],v[244:247],v[64:67]
s_add_u32 m0,s43,0
s_nop 0
buffer_load_dwordx4 v19,s[20:23],s78 offen sc1 lds
v_mfma_f32_16x16x32_bf16 v[72:75],a[180:183],v[244:247],v[72:75]
ds_read_b128 v[240:243],v17 offset:40960
s_waitcnt lgkmcnt(5)
v_mfma_f32_16x16x32_bf16 v[64:67],a[56:59],v[248:251],v[64:67]
v_min3_u32 v27,v27,v248,v252
s_add_u32 m0,s43,1024
v_mfma_f32_16x16x32_bf16 v[72:75],a[184:187],v[248:251],v[72:75]
ds_read_b128 v[244:247],v17 offset:43008
v_mfma_f32_16x16x32_bf16 v[64:67],a[60:63],v[252:255],v[64:67]
buffer_load_dwordx4 v20,s[20:23],s78 offen sc1 lds
v_mfma_f32_16x16x32_bf16 v[72:75],a[188:191],v[252:255],v[72:75]
ds_read_b128 v[248:251],v17 offset:45056
s_waitcnt lgkmcnt(5)
v_mfma_f32_16x16x32_bf16 v[64:67],a[64:67],v[224:227],v[64:67]
v_min3_u32 v27,v27,v224,v228
v_mfma_f32_16x16x32_bf16 v[72:75],a[192:195],v[224:227],v[72:75]
ds_read_b128 v[252:255],v17 offset:47104
v_mfma_f32_16x16x32_bf16 v[64:67],a[68:71],v[228:231],v[64:67]
v_mfma_f32_16x16x32_bf16 v[72:75],a[196:199],v[228:231],v[72:75]
ds_read_b128 v[224:227],v17 offset:49152
s_waitcnt lgkmcnt(5)
v_mfma_f32_16x16x32_bf16 v[64:67],a[72:75],v[232:235],v[64:67]
v_min3_u32 v27,v27,v232,v236
v_mfma_f32_16x16x32_bf16 v[72:75],a[200:203],v[232:235],v[72:75]
ds_read_b128 v[228:231],v17 offset:51200
v_mfma_f32_16x16x32_bf16 v[64:67],a[76:79],v[236:239],v[64:67]
v_mfma_f32_16x16x32_bf16 v[72:75],a[204:207],v[236:239],v[72:75]
ds_read_b128 v[232:235],v17 offset:53248
s_waitcnt lgkmcnt(5)
v_mfma_f32_16x16x32_bf16 v[64:67],a[80:83],v[240:243],v[64:67]
v_min3_u32 v27,v27,v240,v244
v_mfma_f32_16x16x32_bf16 v[72:75],a[208:211],v[240:243],v[72:75]
ds_read_b128 v[236:239],v17 offset:55296
v_mfma_f32_16x16x32_bf16 v[64:67],a[84:87],v[244:247],v[64:67]
v_mfma_f32_16x16x32_bf16 v[72:75],a[212:215],v[244:247],v[72:75]
ds_read_b128 v[240:243],v17 offset:57344
s_waitcnt lgkmcnt(5)
v_mfma_f32_16x16x32_bf16 v[64:67],a[88:91],v[248:251],v[64:67]
v_min3_u32 v27,v27,v248,v252
v_mfma_f32_16x16x32_bf16 v[72:75],a[216:219],v[248:251],v[72:75]
ds_read_b128 v[244:247],v17 offset:59392
v_mfma_f32_16x16x32_bf16 v[64:67],a[92:95],v[252:255],v[64:67]
v_mfma_f32_16x16x32_bf16 v[72:75],a[220:223],v[252:255],v[72:75]
ds_read_b128 v[248:251],v17 offset:61440
s_waitcnt lgkmcnt(5)
v_mfma_f32_16x16x32_bf16 v[64:67],a[96:99],v[224:227],v[64:67]
v_min3_u32 v27,v27,v224,v228
v_mfma_f32_16x16x32_bf16 v[72:75],a[224:227],v[224:227],v[72:75]
ds_read_b128 v[252:255],v17 offset:63488
v_mfma_f32_16x16x32_bf16 v[64:67],a[100:103],v[228:231],v[64:67]
v_mfma_f32_16x16x32_bf16 v[72:75],a[228:231],v[228:231],v[72:75]
s_waitcnt vmcnt(2)
s_barrier
ds_read_b128 v[224:227],v17 offset:1024
s_waitcnt lgkmcnt(5)
v_mfma_f32_16x16x32_bf16 v[64:67],a[104:107],v[232:235],v[64:67]
v_min3_u32 v27,v27,v232,v236
v_mfma_f32_16x16x32_bf16 v[72:75],a[232:235],v[232:235],v[72:75]
ds_read_b128 v[228:231],v17 offset:3072
v_mfma_f32_16x16x32_bf16 v[64:67],a[108:111],v[236:239],v[64:67]
s_waitcnt vmcnt(0)
ds_read_b64 v[120:121],v40 offset:0
v_mfma_f32_16x16x32_bf16 v[72:75],a[236:239],v[236:239],v[72:75]
ds_read_b128 v[232:235],v17 offset:5120
s_waitcnt lgkmcnt(6)
v_mfma_f32_16x16x32_bf16 v[64:67],a[112:115],v[240:243],v[64:67]
v_min3_u32 v27,v27,v240,v244
ds_read_b64 v[122:123],v41 offset:0
v_mfma_f32_16x16x32_bf16 v[72:75],a[240:243],v[240:243],v[72:75]
ds_read_b128 v[236:239],v17 offset:7168
ds_read_b64 v[124:125],v40 offset:1024
v_mfma_f32_16x16x32_bf16 v[64:67],a[116:119],v[244:247],v[64:67]
ds_read_b64 v[126:127],v41 offset:1024
v_mfma_f32_16x16x32_bf16 v[72:75],a[244:247],v[244:247],v[72:75]
ds_read_b128 v[240:243],v17 offset:9216
s_waitcnt lgkmcnt(9)
v_mfma_f32_16x16x32_bf16 v[64:67],a[120:123],v[248:251],v[64:67]
v_min3_u32 v27,v27,v248,v252
v_mfma_f32_16x16x32_bf16 v[72:75],a[248:251],v[248:251],v[72:75]
ds_read_b128 v[244:247],v17 offset:11264
v_mfma_f32_16x16x32_bf16 v[64:67],a[124:127],v[252:255],v[64:67]
buffer_load_dword v2,v21,s[20:23],s87 offen sc1
v_mfma_f32_16x16x32_bf16 v[72:75],a[252:255],v[252:255],v[72:75]
ds_read_b128 v[248:251],v17 offset:13312
s_waitcnt lgkmcnt(9)
v_mfma_f32_16x16x32_bf16 v[68:71],a[0:3],v[224:227],0
v_cmp_eq_u32 vcc,0,v27
s_cbranch_vccnz retry_213
v_mfma_f32_16x16x32_bf16 v[76:79],a[128:131],v[224:227],0
ds_read_b128 v[252:255],v17 offset:15360
v_min3_u32 v27,v27,v224,v228
v_mfma_f32_16x16x32_bf16 v[68:71],a[4:7],v[228:231],v[68:71]
s_add_u32 s96,s71,2
v_mfma_f32_16x16x32_bf16 v[76:79],a[132:135],v[228:231],v[76:79]
ds_read_b128 v[224:227],v17 offset:17408
s_waitcnt lgkmcnt(7)
v_mfma_f32_16x16x32_bf16 v[68:71],a[8:11],v[232:235],v[68:71]
v_min3_u32 v27,v27,v232,v236
s_waitcnt lgkmcnt(5)
v_lshlrev_b32 v88,16,v120
v_mfma_f32_16x16x32_bf16 v[76:79],a[136:139],v[232:235],v[76:79]
ds_read_b128 v[228:231],v17 offset:19456
v_and_b32 v89,s80,v120
v_lshlrev_b32 v90,16,v121
v_mfma_f32_16x16x32_bf16 v[68:71],a[12:15],v[236:239],v[68:71]
v_and_b32 v91,s80,v121
v_lshlrev_b32 v92,16,v122
v_and_b32 v93,s80,v122
v_mfma_f32_16x16x32_bf16 v[76:79],a[140:143],v[236:239],v[76:79]
ds_read_b128 v[232:235],v17 offset:21504
v_lshlrev_b32 v94,16,v123
s_waitcnt lgkmcnt(5)
v_mfma_f32_16x16x32_bf16 v[68:71],a[16:19],v[240:243],v[68:71]
v_min3_u32 v27,v27,v240,v244
v_and_b32 v95,s80,v123
v_add_f32 v88,v64,v88
v_mfma_f32_16x16x32_bf16 v[76:79],a[144:147],v[240:243],v[76:79]
ds_read_b128 v[236:239],v17 offset:23552
v_add_f32 v89,v65,v89
v_add_f32 v90,v66,v90
v_mfma_f32_16x16x32_bf16 v[68:71],a[20:23],v[244:247],v[68:71]
v_add_f32 v91,v67,v91
v_add_f32 v92,v72,v92
v_add_f32 v93,v73,v93
v_mfma_f32_16x16x32_bf16 v[76:79],a[148:151],v[244:247],v[76:79]
ds_read_b128 v[240:243],v17 offset:25600
v_add_f32 v94,v74,v94
s_waitcnt lgkmcnt(5)
v_mfma_f32_16x16x32_bf16 v[68:71],a[24:27],v[248:251],v[68:71]
v_min3_u32 v27,v27,v248,v252
v_add_f32 v95,v75,v95
v_mfma_f32_16x16x32_bf16 v[76:79],a[152:155],v[248:251],v[76:79]
ds_read_b128 v[244:247],v17 offset:27648
v_cvt_pk_bf16_f32 v96,v88,v89
v_mfma_f32_16x16x32_bf16 v[68:71],a[28:31],v[252:255],v[68:71]
v_cvt_pk_bf16_f32 v97,v90,v91
v_cvt_pk_bf16_f32 v98,v92,v93
v_mfma_f32_16x16x32_bf16 v[76:79],a[156:159],v[252:255],v[76:79]
ds_read_b128 v[248:251],v17 offset:29696
s_waitcnt lgkmcnt(5)
v_mfma_f32_16x16x32_bf16 v[68:71],a[32:35],v[224:227],v[68:71]
v_min3_u32 v27,v27,v224,v228
v_cvt_pk_bf16_f32 v99,v94,v95
v_mfma_f32_16x16x32_bf16 v[76:79],a[160:163],v[224:227],v[76:79]
ds_read_b128 v[252:255],v17 offset:31744
v_max_u32 v96,1,v96
v_mfma_f32_16x16x32_bf16 v[68:71],a[36:39],v[228:231],v[68:71]
buffer_store_dwordx4 v[96:99],v18,s[20:23],s70 offen offset:0 sc1
v_mfma_f32_16x16x32_bf16 v[76:79],a[164:167],v[228:231],v[76:79]
ds_read_b128 v[224:227],v17 offset:33792
s_waitcnt lgkmcnt(5)
v_mfma_f32_16x16x32_bf16 v[68:71],a[40:43],v[232:235],v[68:71]
v_min3_u32 v27,v27,v232,v236
v_lshlrev_b32 v88,16,v96
v_mfma_f32_16x16x32_bf16 v[76:79],a[168:171],v[232:235],v[76:79]
ds_read_b128 v[228:231],v17 offset:35840
v_and_b32 v89,s80,v96
v_mfma_f32_16x16x32_bf16 v[68:71],a[44:47],v[236:239],v[68:71]
v_lshlrev_b32 v90,16,v97
v_and_b32 v91,s80,v97
v_mfma_f32_16x16x32_bf16 v[76:79],a[172:175],v[236:239],v[76:79]
ds_read_b128 v[232:235],v17 offset:37888
s_waitcnt lgkmcnt(5)
v_mfma_f32_16x16x32_bf16 v[68:71],a[48:51],v[240:243],v[68:71]
v_min3_u32 v27,v27,v240,v244
v_lshlrev_b32 v92,16,v98
v_mfma_f32_16x16x32_bf16 v[76:79],a[176:179],v[240:243],v[76:79]
ds_read_b128 v[236:239],v17 offset:39936
v_and_b32 v93,s80,v98
v_mfma_f32_16x16x32_bf16 v[68:71],a[52:55],v[244:247],v[68:71]
v_lshlrev_b32 v94,16,v99
v_and_b32 v95,s80,v99
v_mfma_f32_16x16x32_bf16 v[76:79],a[180:183],v[244:247],v[76:79]
ds_read_b128 v[240:243],v17 offset:41984
s_waitcnt lgkmcnt(5)
v_mfma_f32_16x16x32_bf16 v[68:71],a[56:59],v[248:251],v[68:71]
v_min3_u32 v27,v27,v248,v252
v_add_f32 v108,v88,v89
v_mfma_f32_16x16x32_bf16 v[76:79],a[184:187],v[248:251],v[76:79]
ds_read_b128 v[244:247],v17 offset:44032
v_mul_f32 v109,v88,v88
v_mfma_f32_16x16x32_bf16 v[68:71],a[60:63],v[252:255],v[68:71]
v_add_f32 v100,v90,v91
v_mul_f32 v101,v89,v89
v_mfma_f32_16x16x32_bf16 v[76:79],a[188:191],v[252:255],v[76:79]
ds_read_b128 v[248:251],v17 offset:46080
s_waitcnt lgkmcnt(5)
v_mfma_f32_16x16x32_bf16 v[68:71],a[64:67],v[224:227],v[68:71]
v_min3_u32 v27,v27,v224,v228
v_fmac_f32 v109,v90,v90
v_mfma_f32_16x16x32_bf16 v[76:79],a[192:195],v[224:227],v[76:79]
ds_read_b128 v[252:255],v17 offset:48128
v_fmac_f32 v101,v91,v91
v_mfma_f32_16x16x32_bf16 v[68:71],a[68:71],v[228:231],v[68:71]
v_fmac_f32 v109,v92,v92
v_fmac_f32 v101,v93,v93
v_mfma_f32_16x16x32_bf16 v[76:79],a[196:199],v[228:231],v[76:79]
ds_read_b128 v[224:227],v17 offset:50176
s_waitcnt lgkmcnt(5)
v_mfma_f32_16x16x32_bf16 v[68:71],a[72:75],v[232:235],v[68:71]
v_min3_u32 v27,v27,v232,v236
v_add_f32 v108,v108,v92
v_mfma_f32_16x16x32_bf16 v[76:79],a[200:203],v[232:235],v[76:79]
ds_read_b128 v[228:231],v17 offset:52224
v_add_f32 v100,v100,v93
v_mfma_f32_16x16x32_bf16 v[68:71],a[76:79],v[236:239],v[68:71]
v_fmac_f32 v109,v94,v94
v_fmac_f32 v101,v95,v95
v_mfma_f32_16x16x32_bf16 v[76:79],a[204:207],v[236:239],v[76:79]
ds_read_b128 v[232:235],v17 offset:54272
s_waitcnt lgkmcnt(5)
v_mfma_f32_16x16x32_bf16 v[68:71],a[80:83],v[240:243],v[68:71]
v_min3_u32 v27,v27,v240,v244
v_add_f32 v108,v108,v94
v_mfma_f32_16x16x32_bf16 v[76:79],a[208:211],v[240:243],v[76:79]
ds_read_b128 v[236:239],v17 offset:56320
v_add_f32 v100,v100,v95
v_mfma_f32_16x16x32_bf16 v[68:71],a[84:87],v[244:247],v[68:71]
v_add_f32 v108,v108,v100
v_add_f32 v109,v109,v101
v_mfma_f32_16x16x32_bf16 v[76:79],a[212:215],v[244:247],v[76:79]
ds_read_b128 v[240:243],v17 offset:58368
s_waitcnt lgkmcnt(5)
v_mfma_f32_16x16x32_bf16 v[68:71],a[88:91],v[248:251],v[68:71]
v_min3_u32 v27,v27,v248,v252
v_mov_b32 v100,v108
v_mfma_f32_16x16x32_bf16 v[76:79],a[216:219],v[248:251],v[76:79]
ds_read_b128 v[244:247],v17 offset:60416
v_mov_b32 v101,v109
v_mfma_f32_16x16x32_bf16 v[68:71],a[92:95],v[252:255],v[68:71]
v_permlane16_swap_b32 v100,v108
v_permlane16_swap_b32 v101,v109
v_mfma_f32_16x16x32_bf16 v[76:79],a[220:223],v[252:255],v[76:79]
ds_read_b128 v[248:251],v17 offset:62464
s_waitcnt lgkmcnt(5)
v_mfma_f32_16x16x32_bf16 v[68:71],a[96:99],v[224:227],v[68:71]
v_min3_u32 v27,v27,v224,v228
v_add_f32 v108,v108,v100
v_mfma_f32_16x16x32_bf16 v[76:79],a[224:227],v[224:227],v[76:79]
ds_read_b128 v[252:255],v17 offset:64512
v_add_f32 v109,v109,v101
v_mfma_f32_16x16x32_bf16 v[68:71],a[100:103],v[228:231],v[68:71]
v_mov_b32 v100,v108
v_mov_b32 v101,v109
v_mfma_f32_16x16x32_bf16 v[76:79],a[228:231],v[228:231],v[76:79]
v_permlane32_swap_b32 v100,v108
s_waitcnt lgkmcnt(4)
v_mfma_f32_16x16x32_bf16 v[68:71],a[104:107],v[232:235],v[68:71]
v_min3_u32 v27,v27,v232,v236
s_waitcnt vmcnt(1)
v_mfma_f32_16x16x32_bf16 v[76:79],a[232:235],v[232:235],v[76:79]
v_cmp_gt_u32 vcc,s96,v2
s_mov_b32 s96,vcc_lo
v_mfma_f32_16x16x32_bf16 v[68:71],a[108:111],v[236:239],v[68:71]
v_mov_b32 v44,s96
ds_write_b32 v46,v44
v_mfma_f32_16x16x32_bf16 v[76:79],a[236:239],v[236:239],v[76:79]
v_permlane32_swap_b32 v101,v109
s_waitcnt lgkmcnt(3)
v_mfma_f32_16x16x32_bf16 v[68:71],a[112:115],v[240:243],v[68:71]
v_min3_u32 v27,v27,v240,v244
v_add_f32 v108,v108,v100
v_mfma_f32_16x16x32_bf16 v[76:79],a[240:243],v[240:243],v[76:79]
v_add_f32 v109,v109,v101
v_lshlrev_b32 v32,16,v124
v_mfma_f32_16x16x32_bf16 v[68:71],a[116:119],v[244:247],v[68:71]
v_and_b32 v33,s80,v124
v_lshlrev_b32 v34,16,v125
v_mfma_f32_16x16x32_bf16 v[76:79],a[244:247],v[244:247],v[76:79]
v_and_b32 v35,s80,v125
s_waitcnt lgkmcnt(1)
v_mfma_f32_16x16x32_bf16 v[68:71],a[120:123],v[248:251],v[68:71]
v_min3_u32 v27,v27,v248,v252
v_lshlrev_b32 v36,16,v126
v_mfma_f32_16x16x32_bf16 v[76:79],a[248:251],v[248:251],v[76:79]
v_and_b32 v37,s80,v126
v_lshlrev_b32 v38,16,v127
v_mfma_f32_16x16x32_bf16 v[68:71],a[124:127],v[252:255],v[68:71]
v_and_b32 v39,s80,v127
v_mfma_f32_16x16x32_bf16 v[76:79],a[252:255],v[252:255],v[76:79]
v_cmp_eq_u32 vcc,0,v27
s_cbranch_vccnz retry_213
s_branch epi_216
both_217:
s_waitcnt vmcnt(9)
s_barrier
ds_read_b128 v[224:227],v17 offset:0
ds_read_b128 v[228:231],v17 offset:2048
ds_read_b128 v[232:235],v17 offset:4096
ds_read_b128 v[236:239],v17 offset:6144
ds_read_b128 v[240:243],v17 offset:8192
ds_read_b128 v[244:247],v17 offset:10240
ds_read_b128 v[248:251],v17 offset:12288
s_waitcnt lgkmcnt(5)
v_mfma_f32_16x16x32_bf16 v[64:67],a[0:3],v[224:227],0
s_xor_b32 m0,s91,17408
s_add_u32 s88,s70,s75
v_min_u32 v27,v224,v228
v_mfma_f32_16x16x32_bf16 v[72:75],a[128:131],v[224:227],0
ds_read_b128 v[252:255],v17 offset:14336
s_add_u32 s88,s88,2097152
v_mfma_f32_16x16x32_bf16 v[64:67],a[4:7],v[228:231],v[64:67]
s_add_u32 s65,s95,32768
s_xor_b32 s88,s88,0x2000
v_mfma_f32_16x16x32_bf16 v[72:75],a[132:135],v[228:231],v[72:75]
s_waitcnt vmcnt(7)
s_barrier
ds_read_b128 v[224:227],v17 offset:16384
s_waitcnt lgkmcnt(5)
v_mfma_f32_16x16x32_bf16 v[64:67],a[8:11],v[232:235],v[64:67]
buffer_load_dwordx4 v16,s[20:23],s65 offen offset:0 sc1 lds
v_min3_u32 v27,v27,v232,v236
v_mfma_f32_16x16x32_bf16 v[72:75],a[136:139],v[232:235],v[72:75]
ds_read_b128 v[228:231],v17 offset:18432
s_xor_b32 s89,s88,1024
v_mfma_f32_16x16x32_bf16 v[64:67],a[12:15],v[236:239],v[64:67]
buffer_load_dwordx4 v16,s[20:23],s65 offen offset:2048 sc1 lds
v_mfma_f32_16x16x32_bf16 v[72:75],a[140:143],v[236:239],v[72:75]
ds_read_b128 v[232:235],v17 offset:20480
s_waitcnt lgkmcnt(5)
v_mfma_f32_16x16x32_bf16 v[64:67],a[16:19],v[240:243],v[64:67]
s_xor_b32 m0,s91,33792
v_min3_u32 v27,v27,v240,v244
v_mfma_f32_16x16x32_bf16 v[72:75],a[144:147],v[240:243],v[72:75]
ds_read_b128 v[236:239],v17 offset:22528
v_mfma_f32_16x16x32_bf16 v[64:67],a[20:23],v[244:247],v[64:67]
s_add_u32 s65,s95,65536
v_mfma_f32_16x16x32_bf16 v[72:75],a[148:151],v[244:247],v[72:75]
ds_read_b128 v[240:243],v17 offset:24576
s_waitcnt lgkmcnt(5)
v_mfma_f32_16x16x32_bf16 v[64:67],a[24:27],v[248:251],v[64:67]
buffer_load_dwordx4 v16,s[20:23],s65 offen offset:0 sc1 lds
v_mfma_f32_16x16x32_bf16 v[72:75],a[152:155],v[248:251],v[72:75]
ds_read_b128 v[244:247],v17 offset:26624
v_min3_u32 v27,v27,v248,v252
v_mfma_f32_16x16x32_bf16 v[64:67],a[28:31],v[252:255],v[64:67]
buffer_load_dwordx4 v16,s[20:23],s65 offen offset:2048 sc1 lds
v_mfma_f32_16x16x32_bf16 v[72:75],a[156:159],v[252:255],v[72:75]
ds_read_b128 v[248:251],v17 offset:28672
s_waitcnt lgkmcnt(5)
v_mfma_f32_16x16x32_bf16 v[64:67],a[32:35],v[224:227],v[64:67]
s_xor_b32 m0,s91,50176
v_min3_u32 v27,v27,v224,v228
v_mfma_f32_16x16x32_bf16 v[72:75],a[160:163],v[224:227],v[72:75]
ds_read_b128 v[252:255],v17 offset:30720
v_mfma_f32_16x16x32_bf16 v[64:67],a[36:39],v[228:231],v[64:67]
s_add_u32 s65,s95,98304
v_mfma_f32_16x16x32_bf16 v[72:75],a[164:167],v[228:231],v[72:75]
s_waitcnt vmcnt(7)
s_barrier
ds_read_b128 v[224:227],v17 offset:32768
s_waitcnt lgkmcnt(5)
v_mfma_f32_16x16x32_bf16 v[64:67],a[40:43],v[232:235],v[64:67]
buffer_load_dwordx4 v16,s[20:23],s65 offen offset:0 sc1 lds
v_mfma_f32_16x16x32_bf16 v[72:75],a[168:171],v[232:235],v[72:75]
ds_read_b128 v[228:231],v17 offset:34816
v_min3_u32 v27,v27,v232,v236
v_mfma_f32_16x16x32_bf16 v[64:67],a[44:47],v[236:239],v[64:67]
buffer_load_dwordx4 v16,s[20:23],s65 offen offset:2048 sc1 lds
v_mfma_f32_16x16x32_bf16 v[72:75],a[172:175],v[236:239],v[72:75]
ds_read_b128 v[232:235],v17 offset:36864
s_waitcnt lgkmcnt(5)
v_mfma_f32_16x16x32_bf16 v[64:67],a[48:51],v[240:243],v[64:67]
v_min3_u32 v27,v27,v240,v244
v_mfma_f32_16x16x32_bf16 v[72:75],a[176:179],v[240:243],v[72:75]
ds_read_b128 v[236:239],v17 offset:38912
v_mfma_f32_16x16x32_bf16 v[64:67],a[52:55],v[244:247],v[64:67]
s_add_u32 m0,s43,0
s_nop 0
buffer_load_dwordx4 v19,s[20:23],s78 offen sc1 lds
v_mfma_f32_16x16x32_bf16 v[72:75],a[180:183],v[244:247],v[72:75]
ds_read_b128 v[240:243],v17 offset:40960
s_waitcnt lgkmcnt(5)
v_mfma_f32_16x16x32_bf16 v[64:67],a[56:59],v[248:251],v[64:67]
v_min3_u32 v27,v27,v248,v252
s_add_u32 m0,s43,1024
v_mfma_f32_16x16x32_bf16 v[72:75],a[184:187],v[248:251],v[72:75]
ds_read_b128 v[244:247],v17 offset:43008
v_mfma_f32_16x16x32_bf16 v[64:67],a[60:63],v[252:255],v[64:67]
buffer_load_dwordx4 v20,s[20:23],s78 offen sc1 lds
v_mfma_f32_16x16x32_bf16 v[72:75],a[188:191],v[252:255],v[72:75]
ds_read_b128 v[248:251],v17 offset:45056
s_waitcnt lgkmcnt(5)
v_mfma_f32_16x16x32_bf16 v[64:67],a[64:67],v[224:227],v[64:67]
s_xor_b32 m0,s72,0
v_min3_u32 v27,v27,v224,v228
v_mfma_f32_16x16x32_bf16 v[72:75],a[192:195],v[224:227],v[72:75]
ds_read_b128 v[252:255],v17 offset:47104
s_add_u32 s65,s88,0
v_mfma_f32_16x16x32_bf16 v[64:67],a[68:71],v[228:231],v[64:67]
buffer_load_dwordx4 v16,s[20:23],s65 offen offset:0 sc1 lds
v_mfma_f32_16x16x32_bf16 v[72:75],a[196:199],v[228:231],v[72:75]
ds_read_b128 v[224:227],v17 offset:49152
s_waitcnt lgkmcnt(5)
v_mfma_f32_16x16x32_bf16 v[64:67],a[72:75],v[232:235],v[64:67]
buffer_load_dwordx4 v16,s[20:23],s65 offen offset:2048 sc1 lds
s_xor_b32 m0,s72,16384
v_mfma_f32_16x16x32_bf16 v[72:75],a[200:203],v[232:235],v[72:75]
ds_read_b128 v[228:231],v17 offset:51200
s_add_u32 s65,s88,32768
v_min3_u32 v27,v27,v232,v236
v_mfma_f32_16x16x32_bf16 v[64:67],a[76:79],v[236:239],v[64:67]
buffer_load_dwordx4 v16,s[20:23],s65 offen offset:0 sc1 lds
v_mfma_f32_16x16x32_bf16 v[72:75],a[204:207],v[236:239],v[72:75]
ds_read_b128 v[232:235],v17 offset:53248
s_waitcnt lgkmcnt(5)
v_mfma_f32_16x16x32_bf16 v[64:67],a[80:83],v[240:243],v[64:67]
buffer_load_dwordx4 v16,s[20:23],s65 offen offset:2048 sc1 lds
v_mfma_f32_16x16x32_bf16 v[72:75],a[208:211],v[240:243],v[72:75]
ds_read_b128 v[236:239],v17 offset:55296
s_xor_b32 m0,s72,32768
v_mfma_f32_16x16x32_bf16 v[64:67],a[84:87],v[244:247],v[64:67]
s_add_u32 s65,s88,65536
v_min3_u32 v27,v27,v240,v244
v_mfma_f32_16x16x32_bf16 v[72:75],a[212:215],v[244:247],v[72:75]
ds_read_b128 v[240:243],v17 offset:57344
s_waitcnt lgkmcnt(5)
v_mfma_f32_16x16x32_bf16 v[64:67],a[88:91],v[248:251],v[64:67]
buffer_load_dwordx4 v16,s[20:23],s65 offen offset:0 sc1 lds
v_min3_u32 v27,v27,v248,v252
v_mfma_f32_16x16x32_bf16 v[72:75],a[216:219],v[248:251],v[72:75]
ds_read_b128 v[244:247],v17 offset:59392
buffer_load_dwordx4 v16,s[20:23],s65 offen offset:2048 sc1 lds
v_mfma_f32_16x16x32_bf16 v[64:67],a[92:95],v[252:255],v[64:67]
s_xor_b32 m0,s72,49152
s_add_u32 s65,s88,98304
v_mfma_f32_16x16x32_bf16 v[72:75],a[220:223],v[252:255],v[72:75]
ds_read_b128 v[248:251],v17 offset:61440
s_waitcnt lgkmcnt(5)
v_mfma_f32_16x16x32_bf16 v[64:67],a[96:99],v[224:227],v[64:67]
buffer_load_dwordx4 v16,s[20:23],s65 offen offset:0 sc1 lds
v_mfma_f32_16x16x32_bf16 v[72:75],a[224:227],v[224:227],v[72:75]
ds_read_b128 v[252:255],v17 offset:63488
buffer_load_dwordx4 v16,s[20:23],s65 offen offset:2048 sc1 lds
v_mfma_f32_16x16x32_bf16 v[64:67],a[100:103],v[228:231],v[64:67]
s_xor_b32 m0,s72,1024
v_min3_u32 v27,v27,v224,v228
v_mfma_f32_16x16x32_bf16 v[72:75],a[228:231],v[228:231],v[72:75]
s_waitcnt vmcnt(10)
s_barrier
ds_read_b128 v[224:227],v17 offset:1024
s_waitcnt lgkmcnt(5)
v_mfma_f32_16x16x32_bf16 v[64:67],a[104:107],v[232:235],v[64:67]
s_add_u32 s65,s89,0
buffer_load_dwordx4 v16,s[20:23],s65 offen offset:0 sc1 lds
v_mfma_f32_16x16x32_bf16 v[72:75],a[232:235],v[232:235],v[72:75]
ds_read_b128 v[228:231],v17 offset:3072
buffer_load_dwordx4 v16,s[20:23],s65 offen offset:2048 sc1 lds
v_mfma_f32_16x16x32_bf16 v[64:67],a[108:111],v[236:239],v[64:67]
s_xor_b32 m0,s72,17408
v_min3_u32 v27,v27,v232,v236
s_waitcnt vmcnt(10)
v_mfma_f32_16x16x32_bf16 v[72:75],a[236:239],v[236:239],v[72:75]
ds_read_b128 v[232:235],v17 offset:5120
s_add_u32 s65,s89,32768
s_waitcnt lgkmcnt(5)
v_mfma_f32_16x16x32_bf16 v[64:67],a[112:115],v[240:243],v[64:67]
buffer_load_dwordx4 v16,s[20:23],s65 offen offset:0 sc1 lds
ds_read_b64 v[120:121],v40 offset:0
v_mfma_f32_16x16x32_bf16 v[72:75],a[240:243],v[240:243],v[72:75]
ds_read_b128 v[236:239],v17 offset:7168
v_min3_u32 v27,v27,v240,v244
ds_read_b64 v[122:123],v41 offset:0
v_mfma_f32_16x16x32_bf16 v[64:67],a[116:119],v[244:247],v[64:67]
buffer_load_dwordx4 v16,s[20:23],s65 offen offset:2048 sc1 lds
ds_read_b64 v[124:125],v40 offset:1024
v_mfma_f32_16x16x32_bf16 v[72:75],a[244:247],v[244:247],v[72:75]
ds_read_b128 v[240:243],v17 offset:9216
ds_read_b64 v[126:127],v41 offset:1024
s_waitcnt lgkmcnt(9)
v_mfma_f32_16x16x32_bf16 v[64:67],a[120:123],v[248:251],v[64:67]
s_xor_b32 m0,s72,33792
s_add_u32 s65,s89,65536
v_mfma_f32_16x16x32_bf16 v[72:75],a[248:251],v[248:251],v[72:75]
ds_read_b128 v[244:247],v17 offset:11264
v_min3_u32 v27,v27,v248,v252
v_mfma_f32_16x16x32_bf16 v[64:67],a[124:127],v[252:255],v[64:67]
buffer_load_dwordx4 v16,s[20:23],s65 offen offset:0 sc1 lds
buffer_load_dword v2,v21,s[20:23],s87 offen sc1
v_mfma_f32_16x16x32_bf16 v[72:75],a[252:255],v[252:255],v[72:75]
ds_read_b128 v[248:251],v17 offset:13312
s_add_u32 s96,s71,2
s_waitcnt lgkmcnt(9)
v_mfma_f32_16x16x32_bf16 v[68:71],a[0:3],v[224:227],0
buffer_load_dwordx4 v16,s[20:23],s65 offen offset:2048 sc1 lds
v_min3_u32 v27,v27,v224,v228
v_mfma_f32_16x16x32_bf16 v[76:79],a[128:131],v[224:227],0
ds_read_b128 v[252:255],v17 offset:15360
s_xor_b32 m0,s72,50176
v_mfma_f32_16x16x32_bf16 v[68:71],a[4:7],v[228:231],v[68:71]
s_add_u32 s65,s89,98304
v_cmp_eq_u32 vcc,0,v27
s_cbranch_vccnz retry_213
v_mfma_f32_16x16x32_bf16 v[76:79],a[132:135],v[228:231],v[76:79]
ds_read_b128 v[224:227],v17 offset:17408
s_waitcnt lgkmcnt(8)
v_mfma_f32_16x16x32_bf16 v[68:71],a[8:11],v[232:235],v[68:71]
buffer_load_dwordx4 v16,s[20:23],s65 offen offset:0 sc1 lds
s_waitcnt lgkmcnt(4)
v_mfma_f32_16x16x32_bf16 v[76:79],a[136:139],v[232:235],v[76:79]
ds_read_b128 v[228:231],v17 offset:19456
v_min3_u32 v27,v27,v232,v236
v_lshlrev_b32 v88,16,v120
v_mfma_f32_16x16x32_bf16 v[68:71],a[12:15],v[236:239],v[68:71]
buffer_load_dwordx4 v16,s[20:23],s65 offen offset:2048 sc1 lds
v_and_b32 v89,s80,v120
v_mfma_f32_16x16x32_bf16 v[76:79],a[140:143],v[236:239],v[76:79]
ds_read_b128 v[232:235],v17 offset:21504
v_lshlrev_b32 v90,16,v121
s_waitcnt lgkmcnt(5)
v_mfma_f32_16x16x32_bf16 v[68:71],a[16:19],v[240:243],v[68:71]
v_min3_u32 v27,v27,v240,v244
v_and_b32 v91,s80,v121
v_lshlrev_b32 v92,16,v122
v_mfma_f32_16x16x32_bf16 v[76:79],a[144:147],v[240:243],v[76:79]
ds_read_b128 v[236:239],v17 offset:23552
v_and_b32 v93,s80,v122
v_lshlrev_b32 v94,16,v123
v_mfma_f32_16x16x32_bf16 v[68:71],a[20:23],v[244:247],v[68:71]
v_and_b32 v95,s80,v123
v_add_f32 v88,v64,v88
v_add_f32 v89,v65,v89
v_mfma_f32_16x16x32_bf16 v[76:79],a[148:151],v[244:247],v[76:79]
ds_read_b128 v[240:243],v17 offset:25600
v_add_f32 v90,v66,v90
s_waitcnt lgkmcnt(5)
v_mfma_f32_16x16x32_bf16 v[68:71],a[24:27],v[248:251],v[68:71]
v_min3_u32 v27,v27,v248,v252
v_add_f32 v91,v67,v91
v_add_f32 v92,v72,v92
v_mfma_f32_16x16x32_bf16 v[76:79],a[152:155],v[248:251],v[76:79]
ds_read_b128 v[244:247],v17 offset:27648
v_add_f32 v93,v73,v93
v_add_f32 v94,v74,v94
v_mfma_f32_16x16x32_bf16 v[68:71],a[28:31],v[252:255],v[68:71]
v_add_f32 v95,v75,v95
v_cvt_pk_bf16_f32 v96,v88,v89
v_cvt_pk_bf16_f32 v97,v90,v91
v_mfma_f32_16x16x32_bf16 v[76:79],a[156:159],v[252:255],v[76:79]
ds_read_b128 v[248:251],v17 offset:29696
v_cvt_pk_bf16_f32 v98,v92,v93
s_waitcnt lgkmcnt(5)
v_mfma_f32_16x16x32_bf16 v[68:71],a[32:35],v[224:227],v[68:71]
v_min3_u32 v27,v27,v224,v228
v_cvt_pk_bf16_f32 v99,v94,v95
v_mfma_f32_16x16x32_bf16 v[76:79],a[160:163],v[224:227],v[76:79]
ds_read_b128 v[252:255],v17 offset:31744
v_max_u32 v96,1,v96
v_mfma_f32_16x16x32_bf16 v[68:71],a[36:39],v[228:231],v[68:71]
buffer_store_dwordx4 v[96:99],v18,s[20:23],s70 offen offset:0 sc1
v_mfma_f32_16x16x32_bf16 v[76:79],a[164:167],v[228:231],v[76:79]
ds_read_b128 v[224:227],v17 offset:33792
s_waitcnt lgkmcnt(5)
v_mfma_f32_16x16x32_bf16 v[68:71],a[40:43],v[232:235],v[68:71]
v_min3_u32 v27,v27,v232,v236
v_lshlrev_b32 v88,16,v96
v_mfma_f32_16x16x32_bf16 v[76:79],a[168:171],v[232:235],v[76:79]
ds_read_b128 v[228:231],v17 offset:35840
v_and_b32 v89,s80,v96
v_mfma_f32_16x16x32_bf16 v[68:71],a[44:47],v[236:239],v[68:71]
v_lshlrev_b32 v90,16,v97
v_and_b32 v91,s80,v97
v_mfma_f32_16x16x32_bf16 v[76:79],a[172:175],v[236:239],v[76:79]
ds_read_b128 v[232:235],v17 offset:37888
s_waitcnt lgkmcnt(5)
v_mfma_f32_16x16x32_bf16 v[68:71],a[48:51],v[240:243],v[68:71]
v_min3_u32 v27,v27,v240,v244
v_lshlrev_b32 v92,16,v98
v_mfma_f32_16x16x32_bf16 v[76:79],a[176:179],v[240:243],v[76:79]
ds_read_b128 v[236:239],v17 offset:39936
v_and_b32 v93,s80,v98
v_mfma_f32_16x16x32_bf16 v[68:71],a[52:55],v[244:247],v[68:71]
v_lshlrev_b32 v94,16,v99
v_and_b32 v95,s80,v99
v_mfma_f32_16x16x32_bf16 v[76:79],a[180:183],v[244:247],v[76:79]
ds_read_b128 v[240:243],v17 offset:41984
s_waitcnt lgkmcnt(5)
v_mfma_f32_16x16x32_bf16 v[68:71],a[56:59],v[248:251],v[68:71]
v_min3_u32 v27,v27,v248,v252
v_add_f32 v108,v88,v89
v_mfma_f32_16x16x32_bf16 v[76:79],a[184:187],v[248:251],v[76:79]
ds_read_b128 v[244:247],v17 offset:44032
v_mul_f32 v109,v88,v88
v_mfma_f32_16x16x32_bf16 v[68:71],a[60:63],v[252:255],v[68:71]
v_add_f32 v100,v90,v91
v_mul_f32 v101,v89,v89
v_mfma_f32_16x16x32_bf16 v[76:79],a[188:191],v[252:255],v[76:79]
ds_read_b128 v[248:251],v17 offset:46080
s_waitcnt lgkmcnt(5)
v_mfma_f32_16x16x32_bf16 v[68:71],a[64:67],v[224:227],v[68:71]
v_min3_u32 v27,v27,v224,v228
v_fmac_f32 v109,v90,v90
v_mfma_f32_16x16x32_bf16 v[76:79],a[192:195],v[224:227],v[76:79]
ds_read_b128 v[252:255],v17 offset:48128
v_fmac_f32 v101,v91,v91
v_mfma_f32_16x16x32_bf16 v[68:71],a[68:71],v[228:231],v[68:71]
v_fmac_f32 v109,v92,v92
v_fmac_f32 v101,v93,v93
v_mfma_f32_16x16x32_bf16 v[76:79],a[196:199],v[228:231],v[76:79]
ds_read_b128 v[224:227],v17 offset:50176
s_waitcnt lgkmcnt(5)
v_mfma_f32_16x16x32_bf16 v[68:71],a[72:75],v[232:235],v[68:71]
v_min3_u32 v27,v27,v232,v236
v_add_f32 v108,v108,v92
v_mfma_f32_16x16x32_bf16 v[76:79],a[200:203],v[232:235],v[76:79]
ds_read_b128 v[228:231],v17 offset:52224
v_add_f32 v100,v100,v93
v_mfma_f32_16x16x32_bf16 v[68:71],a[76:79],v[236:239],v[68:71]
v_fmac_f32 v109,v94,v94
v_fmac_f32 v101,v95,v95
v_mfma_f32_16x16x32_bf16 v[76:79],a[204:207],v[236:239],v[76:79]
ds_read_b128 v[232:235],v17 offset:54272
s_waitcnt lgkmcnt(5)
v_mfma_f32_16x16x32_bf16 v[68:71],a[80:83],v[240:243],v[68:71]
v_min3_u32 v27,v27,v240,v244
v_add_f32 v108,v108,v94
v_mfma_f32_16x16x32_bf16 v[76:79],a[208:211],v[240:243],v[76:79]
ds_read_b128 v[236:239],v17 offset:56320
v_add_f32 v100,v100,v95
v_mfma_f32_16x16x32_bf16 v[68:71],a[84:87],v[244:247],v[68:71]
v_add_f32 v108,v108,v100
v_add_f32 v109,v109,v101
v_mfma_f32_16x16x32_bf16 v[76:79],a[212:215],v[244:247],v[76:79]
ds_read_b128 v[240:243],v17 offset:58368
s_waitcnt lgkmcnt(5)
v_mfma_f32_16x16x32_bf16 v[68:71],a[88:91],v[248:251],v[68:71]
v_min3_u32 v27,v27,v248,v252
v_mov_b32 v100,v108
v_mfma_f32_16x16x32_bf16 v[76:79],a[216:219],v[248:251],v[76:79]
ds_read_b128 v[244:247],v17 offset:60416
v_mov_b32 v101,v109
v_mfma_f32_16x16x32_bf16 v[68:71],a[92:95],v[252:255],v[68:71]
v_permlane16_swap_b32 v100,v108
v_permlane16_swap_b32 v101,v109
v_mfma_f32_16x16x32_bf16 v[76:79],a[220:223],v[252:255],v[76:79]
ds_read_b128 v[248:251],v17 offset:62464
s_waitcnt lgkmcnt(5)
v_mfma_f32_16x16x32_bf16 v[68:71],a[96:99],v[224:227],v[68:71]
v_min3_u32 v27,v27,v224,v228
v_add_f32 v108,v108,v100
v_mfma_f32_16x16x32_bf16 v[76:79],a[224:227],v[224:227],v[76:79]
ds_read_b128 v[252:255],v17 offset:64512
v_add_f32 v109,v109,v101
v_mfma_f32_16x16x32_bf16 v[68:71],a[100:103],v[228:231],v[68:71]
v_mov_b32 v100,v108
v_mov_b32 v101,v109
v_mfma_f32_16x16x32_bf16 v[76:79],a[228:231],v[228:231],v[76:79]
v_permlane32_swap_b32 v100,v108
s_waitcnt lgkmcnt(4)
v_mfma_f32_16x16x32_bf16 v[68:71],a[104:107],v[232:235],v[68:71]
v_min3_u32 v27,v27,v232,v236
s_waitcnt vmcnt(4)
v_mfma_f32_16x16x32_bf16 v[76:79],a[232:235],v[232:235],v[76:79]
v_cmp_gt_u32 vcc,s96,v2
s_mov_b32 s96,vcc_lo
v_mfma_f32_16x16x32_bf16 v[68:71],a[108:111],v[236:239],v[68:71]
v_mov_b32 v44,s96
ds_write_b32 v46,v44
v_mfma_f32_16x16x32_bf16 v[76:79],a[236:239],v[236:239],v[76:79]
v_permlane32_swap_b32 v101,v109
s_waitcnt lgkmcnt(3)
v_mfma_f32_16x16x32_bf16 v[68:71],a[112:115],v[240:243],v[68:71]
v_min3_u32 v27,v27,v240,v244
v_add_f32 v108,v108,v100
v_mfma_f32_16x16x32_bf16 v[76:79],a[240:243],v[240:243],v[76:79]
v_add_f32 v109,v109,v101
v_lshlrev_b32 v32,16,v124
v_mfma_f32_16x16x32_bf16 v[68:71],a[116:119],v[244:247],v[68:71]
v_and_b32 v33,s80,v124
v_lshlrev_b32 v34,16,v125
v_mfma_f32_16x16x32_bf16 v[76:79],a[244:247],v[244:247],v[76:79]
v_and_b32 v35,s80,v125
s_waitcnt lgkmcnt(1)
v_mfma_f32_16x16x32_bf16 v[68:71],a[120:123],v[248:251],v[68:71]
v_min3_u32 v27,v27,v248,v252
v_lshlrev_b32 v36,16,v126
v_mfma_f32_16x16x32_bf16 v[76:79],a[248:251],v[248:251],v[76:79]
v_and_b32 v37,s80,v126
v_lshlrev_b32 v38,16,v127
v_mfma_f32_16x16x32_bf16 v[68:71],a[124:127],v[252:255],v[68:71]
v_and_b32 v39,s80,v127
v_mfma_f32_16x16x32_bf16 v[76:79],a[252:255],v[252:255],v[76:79]
v_cmp_eq_u32 vcc,0,v27
s_cbranch_vccnz retry_213
s_branch epi_216
ahead_215:
s_waitcnt vmcnt(5) lgkmcnt(0)
s_barrier
ds_read_b32 v44,v45
ds_read_b128 v[224:227],v17 offset:0
ds_read_b128 v[228:231],v17 offset:2048
ds_read_b128 v[232:235],v17 offset:4096
ds_read_b128 v[236:239],v17 offset:6144
ds_read_b128 v[240:243],v17 offset:8192
ds_read_b128 v[244:247],v17 offset:10240
ds_read_b128 v[248:251],v17 offset:12288
s_waitcnt lgkmcnt(5)
v_mfma_f32_16x16x32_bf16 v[64:67],a[0:3],v[224:227],0
s_add_u32 s88,s70,s75
s_add_u32 s88,s88,2097152
v_min_u32 v27,v224,v228
s_add_u32 m0,s43,0
v_mfma_f32_16x16x32_bf16 v[72:75],a[128:131],v[224:227],0
ds_read_b128 v[252:255],v17 offset:14336
s_xor_b32 s88,s88,0x2000
buffer_load_dwordx4 v19,s[20:23],s78 offen sc1 lds
v_mfma_f32_16x16x32_bf16 v[64:67],a[4:7],v[228:231],v[64:67]
v_readfirstlane_b32 s83,v44
s_add_u32 m0,s43,1024
v_mfma_f32_16x16x32_bf16 v[72:75],a[132:135],v[228:231],v[72:75]
ds_read_b128 v[224:227],v17 offset:16384
buffer_load_dwordx4 v20,s[20:23],s78 offen sc1 lds
s_waitcnt lgkmcnt(5)
v_mfma_f32_16x16x32_bf16 v[64:67],a[8:11],v[232:235],v[64:67]
s_cmp_eq_u32 s83,0
s_cselect_b32 s88,s88,0x7fff0000
v_mfma_f32_16x16x32_bf16 v[72:75],a[136:139],v[232:235],v[72:75]
ds_read_b128 v[228:231],v17 offset:18432
s_xor_b32 s89,s88,1024
v_mfma_f32_16x16x32_bf16 v[64:67],a[12:15],v[236:239],v[64:67]
s_xor_b32 m0,s72,0
v_min3_u32 v27,v27,v232,v236
v_mfma_f32_16x16x32_bf16 v[72:75],a[140:143],v[236:239],v[72:75]
ds_read_b128 v[232:235],v17 offset:20480
s_waitcnt lgkmcnt(5)
v_mfma_f32_16x16x32_bf16 v[64:67],a[16:19],v[240:243],v[64:67]
s_add_u32 s65,s88,0
v_min3_u32 v27,v27,v240,v244
v_mfma_f32_16x16x32_bf16 v[72:75],a[144:147],v[240:243],v[72:75]
ds_read_b128 v[236:239],v17 offset:22528
v_mfma_f32_16x16x32_bf16 v[64:67],a[20:23],v[244:247],v[64:67]
buffer_load_dwordx4 v16,s[20:23],s65 offen offset:0 sc1 lds
v_mfma_f32_16x16x32_bf16 v[72:75],a[148:151],v[244:247],v[72:75]
ds_read_b128 v[240:243],v17 offset:24576
s_waitcnt lgkmcnt(5)
v_mfma_f32_16x16x32_bf16 v[64:67],a[24:27],v[248:251],v[64:67]
buffer_load_dwordx4 v16,s[20:23],s65 offen offset:2048 sc1 lds
v_mfma_f32_16x16x32_bf16 v[72:75],a[152:155],v[248:251],v[72:75]
ds_read_b128 v[244:247],v17 offset:26624
s_xor_b32 m0,s72,16384
v_mfma_f32_16x16x32_bf16 v[64:67],a[28:31],v[252:255],v[64:67]
s_add_u32 s65,s88,32768
v_min3_u32 v27,v27,v248,v252
v_mfma_f32_16x16x32_bf16 v[72:75],a[156:159],v[252:255],v[72:75]
ds_read_b128 v[248:251],v17 offset:28672
s_waitcnt lgkmcnt(5)
v_mfma_f32_16x16x32_bf16 v[64:67],a[32:35],v[224:227],v[64:67]
buffer_load_dwordx4 v16,s[20:23],s65 offen offset:0 sc1 lds
v_mfma_f32_16x16x32_bf16 v[72:75],a[160:163],v[224:227],v[72:75]
ds_read_b128 v[252:255],v17 offset:30720
v_min3_u32 v27,v27,v224,v228
v_mfma_f32_16x16x32_bf16 v[64:67],a[36:39],v[228:231],v[64:67]
buffer_load_dwordx4 v16,s[20:23],s65 offen offset:2048 sc1 lds
v_mfma_f32_16x16x32_bf16 v[72:75],a[164:167],v[228:231],v[72:75]
ds_read_b128 v[224:227],v17 offset:32768
s_waitcnt lgkmcnt(5)
v_mfma_f32_16x16x32_bf16 v[64:67],a[40:43],v[232:235],v[64:67]
s_xor_b32 m0,s72,32768
s_add_u32 s65,s88,65536
v_mfma_f32_16x16x32_bf16 v[72:75],a[168:171],v[232:235],v[72:75]
ds_read_b128 v[228:231],v17 offset:34816
v_min3_u32 v27,v27,v232,v236
v_mfma_f32_16x16x32_bf16 v[64:67],a[44:47],v[236:239],v[64:67]
buffer_load_dwordx4 v16,s[20:23],s65 offen offset:0 sc1 lds
v_mfma_f32_16x16x32_bf16 v[72:75],a[172:175],v[236:239],v[72:75]
ds_read_b128 v[232:235],v17 offset:36864
s_waitcnt lgkmcnt(5)
v_mfma_f32_16x16x32_bf16 v[64:67],a[48:51],v[240:243],v[64:67]
buffer_load_dwordx4 v16,s[20:23],s65 offen offset:2048 sc1 lds
v_mfma_f32_16x16x32_bf16 v[72:75],a[176:179],v[240:243],v[72:75]
ds_read_b128 v[236:239],v17 offset:38912
s_xor_b32 m0,s72,49152
v_mfma_f32_16x16x32_bf16 v[64:67],a[52:55],v[244:247],v[64:67]
v_min3_u32 v27,v27,v240,v244
v_mfma_f32_16x16x32_bf16 v[72:75],a[180:183],v[244:247],v[72:75]
ds_read_b128 v[240:243],v17 offset:40960
s_waitcnt lgkmcnt(5)
v_mfma_f32_16x16x32_bf16 v[64:67],a[56:59],v[248:251],v[64:67]
s_add_u32 s65,s88,98304
v_min3_u32 v27,v27,v248,v252
v_mfma_f32_16x16x32_bf16 v[72:75],a[184:187],v[248:251],v[72:75]
ds_read_b128 v[244:247],v17 offset:43008
v_mfma_f32_16x16x32_bf16 v[64:67],a[60:63],v[252:255],v[64:67]
buffer_load_dwordx4 v16,s[20:23],s65 offen offset:0 sc1 lds
v_mfma_f32_16x16x32_bf16 v[72:75],a[188:191],v[252:255],v[72:75]
ds_read_b128 v[248:251],v17 offset:45056
s_waitcnt lgkmcnt(5)
v_mfma_f32_16x16x32_bf16 v[64:67],a[64:67],v[224:227],v[64:67]
buffer_load_dwordx4 v16,s[20:23],s65 offen offset:2048 sc1 lds
v_mfma_f32_16x16x32_bf16 v[72:75],a[192:195],v[224:227],v[72:75]
ds_read_b128 v[252:255],v17 offset:47104
s_xor_b32 m0,s72,1024
v_mfma_f32_16x16x32_bf16 v[64:67],a[68:71],v[228:231],v[64:67]
s_add_u32 s65,s89,0
v_min3_u32 v27,v27,v224,v228
v_mfma_f32_16x16x32_bf16 v[72:75],a[196:199],v[228:231],v[72:75]
ds_read_b128 v[224:227],v17 offset:49152
s_waitcnt lgkmcnt(5)
v_mfma_f32_16x16x32_bf16 v[64:67],a[72:75],v[232:235],v[64:67]
buffer_load_dwordx4 v16,s[20:23],s65 offen offset:0 sc1 lds
v_mfma_f32_16x16x32_bf16 v[72:75],a[200:203],v[232:235],v[72:75]
ds_read_b128 v[228:231],v17 offset:51200
v_min3_u32 v27,v27,v232,v236
v_mfma_f32_16x16x32_bf16 v[64:67],a[76:79],v[236:239],v[64:67]
buffer_load_dwordx4 v16,s[20:23],s65 offen offset:2048 sc1 lds
v_mfma_f32_16x16x32_bf16 v[72:75],a[204:207],v[236:239],v[72:75]
ds_read_b128 v[232:235],v17 offset:53248
s_waitcnt lgkmcnt(5)
v_mfma_f32_16x16x32_bf16 v[64:67],a[80:83],v[240:243],v[64:67]
s_xor_b32 m0,s72,17408
s_add_u32 s65,s89,32768
v_mfma_f32_16x16x32_bf16 v[72:75],a[208:211],v[240:243],v[72:75]
ds_read_b128 v[236:239],v17 offset:55296
v_min3_u32 v27,v27,v240,v244
v_mfma_f32_16x16x32_bf16 v[64:67],a[84:87],v[244:247],v[64:67]
buffer_load_dwordx4 v16,s[20:23],s65 offen offset:0 sc1 lds
v_mfma_f32_16x16x32_bf16 v[72:75],a[212:215],v[244:247],v[72:75]
ds_read_b128 v[240:243],v17 offset:57344
s_waitcnt lgkmcnt(5)
v_mfma_f32_16x16x32_bf16 v[64:67],a[88:91],v[248:251],v[64:67]
buffer_load_dwordx4 v16,s[20:23],s65 offen offset:2048 sc1 lds
v_mfma_f32_16x16x32_bf16 v[72:75],a[216:219],v[248:251],v[72:75]
ds_read_b128 v[244:247],v17 offset:59392
s_xor_b32 m0,s72,33792
v_mfma_f32_16x16x32_bf16 v[64:67],a[92:95],v[252:255],v[64:67]
s_add_u32 s65,s89,65536
v_min3_u32 v27,v27,v248,v252
v_mfma_f32_16x16x32_bf16 v[72:75],a[220:223],v[252:255],v[72:75]
ds_read_b128 v[248:251],v17 offset:61440
s_waitcnt lgkmcnt(5)
v_mfma_f32_16x16x32_bf16 v[64:67],a[96:99],v[224:227],v[64:67]
buffer_load_dwordx4 v16,s[20:23],s65 offen offset:0 sc1 lds
v_mfma_f32_16x16x32_bf16 v[72:75],a[224:227],v[224:227],v[72:75]
ds_read_b128 v[252:255],v17 offset:63488
v_min3_u32 v27,v27,v224,v228
v_mfma_f32_16x16x32_bf16 v[64:67],a[100:103],v[228:231],v[64:67]
buffer_load_dwordx4 v16,s[20:23],s65 offen offset:2048 sc1 lds
s_waitcnt vmcnt(16)
v_mfma_f32_16x16x32_bf16 v[72:75],a[228:231],v[228:231],v[72:75]
ds_read_b128 v[224:227],v17 offset:1024
v_add_u32 v22,s71,-1
s_waitcnt lgkmcnt(5)
v_mfma_f32_16x16x32_bf16 v[64:67],a[104:107],v[232:235],v[64:67]
s_xor_b32 m0,s72,50176
v_min3_u32 v27,v27,v232,v236
v_mfma_f32_16x16x32_bf16 v[72:75],a[232:235],v[232:235],v[72:75]
ds_read_b128 v[228:231],v17 offset:3072
s_add_u32 s65,s89,98304
v_mfma_f32_16x16x32_bf16 v[64:67],a[108:111],v[236:239],v[64:67]
buffer_load_dwordx4 v16,s[20:23],s65 offen offset:0 sc1 lds
s_waitcnt vmcnt(15)
v_mfma_f32_16x16x32_bf16 v[72:75],a[236:239],v[236:239],v[72:75]
ds_read_b128 v[232:235],v17 offset:5120
ds_read_b64 v[120:121],v40 offset:0
s_waitcnt lgkmcnt(6)
v_mfma_f32_16x16x32_bf16 v[64:67],a[112:115],v[240:243],v[64:67]
buffer_load_dwordx4 v16,s[20:23],s65 offen offset:2048 sc1 lds
ds_read_b64 v[122:123],v41 offset:0
v_mfma_f32_16x16x32_bf16 v[72:75],a[240:243],v[240:243],v[72:75]
ds_read_b128 v[236:239],v17 offset:7168
v_min3_u32 v27,v27,v240,v244
ds_read_b64 v[124:125],v40 offset:1024
v_mfma_f32_16x16x32_bf16 v[64:67],a[116:119],v[244:247],v[64:67]
buffer_store_dword v22,v23,s[20:23],s97 offen sc1
v_mfma_f32_16x16x32_bf16 v[72:75],a[244:247],v[244:247],v[72:75]
ds_read_b128 v[240:243],v17 offset:9216
s_waitcnt lgkmcnt(8)
v_mfma_f32_16x16x32_bf16 v[64:67],a[120:123],v[248:251],v[64:67]
v_min3_u32 v27,v27,v248,v252
s_mov_b32 s97,0x7fff0000
v_mfma_f32_16x16x32_bf16 v[72:75],a[248:251],v[248:251],v[72:75]
ds_read_b128 v[244:247],v17 offset:11264
ds_read_b64 v[126:127],v41 offset:1024
v_mfma_f32_16x16x32_bf16 v[64:67],a[124:127],v[252:255],v[64:67]
buffer_load_dword v2,v21,s[20:23],s87 offen sc1
v_mfma_f32_16x16x32_bf16 v[72:75],a[252:255],v[252:255],v[72:75]
ds_read_b128 v[248:251],v17 offset:13312
s_waitcnt lgkmcnt(9)
v_mfma_f32_16x16x32_bf16 v[68:71],a[0:3],v[224:227],0
v_cmp_eq_u32 vcc,0,v27
s_cbranch_vccnz retry_213
v_mfma_f32_16x16x32_bf16 v[76:79],a[128:131],v[224:227],0
ds_read_b128 v[252:255],v17 offset:15360
v_min3_u32 v27,v27,v224,v228
v_mfma_f32_16x16x32_bf16 v[68:71],a[4:7],v[228:231],v[68:71]
s_add_u32 s96,s71,2
v_mfma_f32_16x16x32_bf16 v[76:79],a[132:135],v[228:231],v[76:79]
ds_read_b128 v[224:227],v17 offset:17408
s_waitcnt lgkmcnt(7)
v_mfma_f32_16x16x32_bf16 v[68:71],a[8:11],v[232:235],v[68:71]
v_min3_u32 v27,v27,v232,v236
s_waitcnt lgkmcnt(3)
v_lshlrev_b32 v88,16,v120
v_mfma_f32_16x16x32_bf16 v[76:79],a[136:139],v[232:235],v[76:79]
ds_read_b128 v[228:231],v17 offset:19456
v_and_b32 v89,s80,v120
v_lshlrev_b32 v90,16,v121
v_mfma_f32_16x16x32_bf16 v[68:71],a[12:15],v[236:239],v[68:71]
v_and_b32 v91,s80,v121
v_lshlrev_b32 v92,16,v122
v_and_b32 v93,s80,v122
v_mfma_f32_16x16x32_bf16 v[76:79],a[140:143],v[236:239],v[76:79]
ds_read_b128 v[232:235],v17 offset:21504
v_lshlrev_b32 v94,16,v123
v_mfma_f32_16x16x32_bf16 v[68:71],a[16:19],v[240:243],v[68:71]
v_min3_u32 v27,v27,v240,v244
v_and_b32 v95,s80,v123
v_add_f32 v88,v64,v88
v_mfma_f32_16x16x32_bf16 v[76:79],a[144:147],v[240:243],v[76:79]
ds_read_b128 v[236:239],v17 offset:23552
v_add_f32 v89,v65,v89
v_add_f32 v90,v66,v90
v_mfma_f32_16x16x32_bf16 v[68:71],a[20:23],v[244:247],v[68:71]
v_add_f32 v91,v67,v91
v_add_f32 v92,v72,v92
v_add_f32 v93,v73,v93
v_mfma_f32_16x16x32_bf16 v[76:79],a[148:151],v[244:247],v[76:79]
ds_read_b128 v[240:243],v17 offset:25600
v_add_f32 v94,v74,v94
s_waitcnt lgkmcnt(5)
v_mfma_f32_16x16x32_bf16 v[68:71],a[24:27],v[248:251],v[68:71]
v_min3_u32 v27,v27,v248,v252
v_add_f32 v95,v75,v95
v_mfma_f32_16x16x32_bf16 v[76:79],a[152:155],v[248:251],v[76:79]
ds_read_b128 v[244:247],v17 offset:27648
v_cvt_pk_bf16_f32 v96,v88,v89
v_mfma_f32_16x16x32_bf16 v[68:71],a[28:31],v[252:255],v[68:71]
v_cvt_pk_bf16_f32 v97,v90,v91
v_cvt_pk_bf16_f32 v98,v92,v93
v_mfma_f32_16x16x32_bf16 v[76:79],a[156:159],v[252:255],v[76:79]
ds_read_b128 v[248:251],v17 offset:29696
s_waitcnt lgkmcnt(5)
v_mfma_f32_16x16x32_bf16 v[68:71],a[32:35],v[224:227],v[68:71]
v_min3_u32 v27,v27,v224,v228
v_cvt_pk_bf16_f32 v99,v94,v95
v_mfma_f32_16x16x32_bf16 v[76:79],a[160:163],v[224:227],v[76:79]
ds_read_b128 v[252:255],v17 offset:31744
v_max_u32 v96,1,v96
v_mfma_f32_16x16x32_bf16 v[68:71],a[36:39],v[228:231],v[68:71]
buffer_store_dwordx4 v[96:99],v18,s[20:23],s70 offen offset:0 sc1
v_mfma_f32_16x16x32_bf16 v[76:79],a[164:167],v[228:231],v[76:79]
ds_read_b128 v[224:227],v17 offset:33792
s_waitcnt lgkmcnt(5)
v_mfma_f32_16x16x32_bf16 v[68:71],a[40:43],v[232:235],v[68:71]
v_min3_u32 v27,v27,v232,v236
v_lshlrev_b32 v88,16,v96
v_mfma_f32_16x16x32_bf16 v[76:79],a[168:171],v[232:235],v[76:79]
ds_read_b128 v[228:231],v17 offset:35840
v_and_b32 v89,s80,v96
v_mfma_f32_16x16x32_bf16 v[68:71],a[44:47],v[236:239],v[68:71]
v_lshlrev_b32 v90,16,v97
v_and_b32 v91,s80,v97
v_mfma_f32_16x16x32_bf16 v[76:79],a[172:175],v[236:239],v[76:79]
ds_read_b128 v[232:235],v17 offset:37888
s_waitcnt lgkmcnt(5)
v_mfma_f32_16x16x32_bf16 v[68:71],a[48:51],v[240:243],v[68:71]
v_min3_u32 v27,v27,v240,v244
v_lshlrev_b32 v92,16,v98
v_mfma_f32_16x16x32_bf16 v[76:79],a[176:179],v[240:243],v[76:79]
ds_read_b128 v[236:239],v17 offset:39936
v_and_b32 v93,s80,v98
v_mfma_f32_16x16x32_bf16 v[68:71],a[52:55],v[244:247],v[68:71]
v_lshlrev_b32 v94,16,v99
v_and_b32 v95,s80,v99
v_mfma_f32_16x16x32_bf16 v[76:79],a[180:183],v[244:247],v[76:79]
ds_read_b128 v[240:243],v17 offset:41984
s_waitcnt lgkmcnt(5)
v_mfma_f32_16x16x32_bf16 v[68:71],a[56:59],v[248:251],v[68:71]
v_min3_u32 v27,v27,v248,v252
v_add_f32 v108,v88,v89
v_mfma_f32_16x16x32_bf16 v[76:79],a[184:187],v[248:251],v[76:79]
ds_read_b128 v[244:247],v17 offset:44032
v_mul_f32 v109,v88,v88
v_mfma_f32_16x16x32_bf16 v[68:71],a[60:63],v[252:255],v[68:71]
v_add_f32 v100,v90,v91
v_mul_f32 v101,v89,v89
v_mfma_f32_16x16x32_bf16 v[76:79],a[188:191],v[252:255],v[76:79]
ds_read_b128 v[248:251],v17 offset:46080
s_waitcnt lgkmcnt(5)
v_mfma_f32_16x16x32_bf16 v[68:71],a[64:67],v[224:227],v[68:71]
v_min3_u32 v27,v27,v224,v228
v_fmac_f32 v109,v90,v90
v_mfma_f32_16x16x32_bf16 v[76:79],a[192:195],v[224:227],v[76:79]
ds_read_b128 v[252:255],v17 offset:48128
v_fmac_f32 v101,v91,v91
v_mfma_f32_16x16x32_bf16 v[68:71],a[68:71],v[228:231],v[68:71]
v_fmac_f32 v109,v92,v92
v_fmac_f32 v101,v93,v93
v_mfma_f32_16x16x32_bf16 v[76:79],a[196:199],v[228:231],v[76:79]
ds_read_b128 v[224:227],v17 offset:50176
s_waitcnt lgkmcnt(5)
v_mfma_f32_16x16x32_bf16 v[68:71],a[72:75],v[232:235],v[68:71]
v_min3_u32 v27,v27,v232,v236
v_add_f32 v108,v108,v92
v_mfma_f32_16x16x32_bf16 v[76:79],a[200:203],v[232:235],v[76:79]
ds_read_b128 v[228:231],v17 offset:52224
v_add_f32 v100,v100,v93
v_mfma_f32_16x16x32_bf16 v[68:71],a[76:79],v[236:239],v[68:71]
v_fmac_f32 v109,v94,v94
v_fmac_f32 v101,v95,v95
v_mfma_f32_16x16x32_bf16 v[76:79],a[204:207],v[236:239],v[76:79]
ds_read_b128 v[232:235],v17 offset:54272
s_waitcnt lgkmcnt(5)
v_mfma_f32_16x16x32_bf16 v[68:71],a[80:83],v[240:243],v[68:71]
v_min3_u32 v27,v27,v240,v244
v_add_f32 v108,v108,v94
v_mfma_f32_16x16x32_bf16 v[76:79],a[208:211],v[240:243],v[76:79]
ds_read_b128 v[236:239],v17 offset:56320
v_add_f32 v100,v100,v95
v_mfma_f32_16x16x32_bf16 v[68:71],a[84:87],v[244:247],v[68:71]
v_add_f32 v108,v108,v100
v_add_f32 v109,v109,v101
v_mfma_f32_16x16x32_bf16 v[76:79],a[212:215],v[244:247],v[76:79]
ds_read_b128 v[240:243],v17 offset:58368
s_waitcnt lgkmcnt(5)
v_mfma_f32_16x16x32_bf16 v[68:71],a[88:91],v[248:251],v[68:71]
v_min3_u32 v27,v27,v248,v252
v_mov_b32 v100,v108
v_mfma_f32_16x16x32_bf16 v[76:79],a[216:219],v[248:251],v[76:79]
ds_read_b128 v[244:247],v17 offset:60416
v_mov_b32 v101,v109
v_mfma_f32_16x16x32_bf16 v[68:71],a[92:95],v[252:255],v[68:71]
v_permlane16_swap_b32 v100,v108
v_permlane16_swap_b32 v101,v109
v_mfma_f32_16x16x32_bf16 v[76:79],a[220:223],v[252:255],v[76:79]
ds_read_b128 v[248:251],v17 offset:62464
s_waitcnt lgkmcnt(5)
v_mfma_f32_16x16x32_bf16 v[68:71],a[96:99],v[224:227],v[68:71]
v_min3_u32 v27,v27,v224,v228
v_add_f32 v108,v108,v100
v_mfma_f32_16x16x32_bf16 v[76:79],a[224:227],v[224:227],v[76:79]
ds_read_b128 v[252:255],v17 offset:64512
v_add_f32 v109,v109,v101
v_mfma_f32_16x16x32_bf16 v[68:71],a[100:103],v[228:231],v[68:71]
v_mov_b32 v100,v108
v_mov_b32 v101,v109
v_mfma_f32_16x16x32_bf16 v[76:79],a[228:231],v[228:231],v[76:79]
v_permlane32_swap_b32 v100,v108
s_waitcnt lgkmcnt(4)
v_mfma_f32_16x16x32_bf16 v[68:71],a[104:107],v[232:235],v[68:71]
v_min3_u32 v27,v27,v232,v236
s_waitcnt vmcnt(1)
v_mfma_f32_16x16x32_bf16 v[76:79],a[232:235],v[232:235],v[76:79]
v_cmp_gt_u32 vcc,s96,v2
s_mov_b32 s96,vcc_lo
v_mfma_f32_16x16x32_bf16 v[68:71],a[108:111],v[236:239],v[68:71]
v_mov_b32 v44,s96
ds_write_b32 v46,v44
v_mfma_f32_16x16x32_bf16 v[76:79],a[236:239],v[236:239],v[76:79]
v_permlane32_swap_b32 v101,v109
s_waitcnt lgkmcnt(3)
v_mfma_f32_16x16x32_bf16 v[68:71],a[112:115],v[240:243],v[68:71]
v_min3_u32 v27,v27,v240,v244
v_add_f32 v108,v108,v100
v_mfma_f32_16x16x32_bf16 v[76:79],a[240:243],v[240:243],v[76:79]
v_add_f32 v109,v109,v101
v_lshlrev_b32 v32,16,v124
v_mfma_f32_16x16x32_bf16 v[68:71],a[116:119],v[244:247],v[68:71]
v_and_b32 v33,s80,v124
v_lshlrev_b32 v34,16,v125
v_mfma_f32_16x16x32_bf16 v[76:79],a[244:247],v[244:247],v[76:79]
v_and_b32 v35,s80,v125
s_waitcnt lgkmcnt(1)
v_mfma_f32_16x16x32_bf16 v[68:71],a[120:123],v[248:251],v[68:71]
v_min3_u32 v27,v27,v248,v252
v_lshlrev_b32 v36,16,v126
v_mfma_f32_16x16x32_bf16 v[76:79],a[248:251],v[248:251],v[76:79]
v_and_b32 v37,s80,v126
v_lshlrev_b32 v38,16,v127
v_mfma_f32_16x16x32_bf16 v[68:71],a[124:127],v[252:255],v[68:71]
v_and_b32 v39,s80,v127
v_mfma_f32_16x16x32_bf16 v[76:79],a[252:255],v[252:255],v[76:79]
v_cmp_eq_u32 vcc,0,v27
s_cbranch_vccnz retry_213
epi_216:
buffer_load_dword v29,v21,s[20:23],s87 offen sc1
s_nop 2
v_pk_add_f32 v[88:89],v[68:69],v[32:33]
v_pk_add_f32 v[90:91],v[70:71],v[34:35]
v_pk_add_f32 v[92:93],v[76:77],v[36:37]
v_pk_add_f32 v[94:95],v[78:79],v[38:39]
v_cvt_pk_bf16_f32 v96,v88,v89
v_cvt_pk_bf16_f32 v97,v90,v91
v_cvt_pk_bf16_f32 v98,v92,v93
v_cvt_pk_bf16_f32 v99,v94,v95
v_max_u32 v96,1,v96
buffer_store_dwordx4 v[96:99],v18,s[20:23],s70 offen offset:1024 sc1
v_lshlrev_b32 v88,16,v96
v_and_b32 v89,s80,v96
v_lshlrev_b32 v90,16,v97
v_and_b32 v91,s80,v97
v_lshlrev_b32 v92,16,v98
v_and_b32 v93,s80,v98
v_lshlrev_b32 v94,16,v99
v_and_b32 v95,s80,v99
v_pk_mul_f32 v[102:103],v[88:89],v[88:89]
v_pk_add_f32 v[100:101],v[88:89],v[90:91]
v_pk_mul_f32 v[106:107],v[90:91],v[90:91]
v_pk_add_f32 v[104:105],v[92:93],v[94:95]
v_pk_fma_f32 v[102:103],v[92:93],v[92:93],v[102:103]
v_pk_fma_f32 v[106:107],v[94:95],v[94:95],v[106:107]
v_pk_add_f32 v[100:101],v[100:101],v[104:105]
v_pk_add_f32 v[102:103],v[102:103],v[106:107]
v_add_f32 v110,v100,v101
v_add_f32 v111,v102,v103
v_mov_b32 v100,v110
v_mov_b32 v101,v111
s_nop 0
v_permlane16_swap_b32 v100,v110
v_permlane16_swap_b32 v101,v111
v_add_f32 v110,v110,v100
v_add_f32 v111,v111,v101
v_mov_b32 v100,v110
v_mov_b32 v101,v111
s_nop 0
v_permlane32_swap_b32 v100,v110
v_permlane32_swap_b32 v101,v111
v_add_f32 v110,v110,v100
v_add_f32 v111,v111,v101
v_max_u32 v109,1,v109
buffer_store_dwordx4 v[108:111],v24,s[20:23],s70 offen sc1
v_xor_b32 v19,0x2000,v19
v_xor_b32 v20,0x2000,v20
s_add_u32 s78,s78,2097152
s_cmp_gt_u32 s71,51
s_cselect_b32 s65,s73,0x7fff0000
s_cselect_b32 s97,0x7fff0000,s73
v_mov_b32 v22,s71
buffer_store_dword v22,v23,s[20:23],s65 offen sc1
v_xor_b32 v17,0x10000,v17
v_xor_b32 v45,16,v45
v_xor_b32 v46,16,v46
s_xor_b32 s72,s72,0x10000
s_add_u32 s70,s70,2097152
s_xor_b32 s70,s70,0x2000
s_add_u32 s71,s71,1
s_cmp_le_u32 s71,s57
s_cbranch_scc1 seg_214
s_endpgm
retry_213:
s_sub_u32 s90,s90,64
s_cmp_lt_i32 s90,0
s_cbranch_scc1 giveup_176
s_mov_b32 s83,1
s_waitcnt vmcnt(0) lgkmcnt(0)
s_barrier
s_branch seg_214
r_at_198:
v_mov_b32 v128,0
v_mov_b32 v129,0
v_mov_b32 v130,0
v_mov_b32 v131,0
s_cmp_ge_u32 s50,2
s_cbranch_scc1 r_ln_197
v_and_b32 v21,1,v1
v_mul_u32_u24 v21,64,v21
s_mov_b32 s65,21052928
s_mov_b32 s66,1792
pl_223:
buffer_load_dword v22,v21,s[20:23],s65 offen sc1
s_waitcnt vmcnt(0)
v_cmp_gt_u32 vcc,s66,v22
s_cbranch_vccz pok_224
s_sleep 1
s_sub_u32 s90,s90,1
s_cmp_gt_i32 s90,0
s_cbranch_scc1 pl_223
pok_224:
s_lshl_b32 s41,s41,1
s_add_u32 s41,s41,s50
v_and_b32 v21,3,v1
v_lshlrev_b32 v21,7,v21
s_lshl_b32 s65,s41,2
s_add_u32 s87,s65,s63
v_mov_b32 v99,v21
pl_225:
buffer_load_dword v22,v21,s[20:23],s87 offen sc1
s_waitcnt vmcnt(0)
v_cmp_gt_u32 vcc,14,v22
s_cbranch_vccz pok_226
s_sleep 1
s_sub_u32 s90,s90,1
s_cmp_gt_i32 s90,0
s_cbranch_scc1 pl_225
pok_226:
v_mov_b32 v21,s56
v_lshlrev_b32 v21,2,v21
s_mov_b32 s66,144
pl_227:
buffer_load_dword v22,v21,s[44:47],36 offen sc1
s_waitcnt vmcnt(0)
v_cmp_gt_u32 vcc,s66,v22
s_cbranch_vccz pok_228
s_sleep 1
s_sub_u32 s90,s90,1
s_cmp_gt_i32 s90,0
s_cbranch_scc1 pl_227
pok_228:
s_lshl_b32 s42,s41,14
s_lshr_b32 s43,s41,1
s_lshl_b32 s43,s43,14
s_and_b32 s64,s41,1
s_lshl_b32 s64,s64,12
s_add_u32 s43,s43,s64
s_add_u32 s43,s43,1572864
s_lshl_b32 s73,s41,7
s_add_u32 s73,s73,s63
s_add_u32 s73,s73,16384
v_lshrrev_b32 v6,3,v3
v_and_b32 v7,7,v3
v_lshl_add_u32 v6,v6,4,v7
v_lshlrev_b32 v6,4,v6
v_and_b32 v7,1,v4
v_lshl_add_u32 v6,v7,3,v6
v_lshrrev_b32 v8,2,v3
v_and_b32 v9,3,v3
v_lshl_add_u32 v8,v8,3,v9
s_mov_b32 s80,0x3e0293ee
v_mov_b32 v97,0xff800000
v_lshlrev_b32 v98,3,v4
v_sub_u32 v98,v98,v8
v_cmp_lt_u32 s[48:49],1,v4
v_cmp_ge_i32 s[4:5],-7,v98
v_cmp_ge_i32 s[6:7],-6,v98
v_cmp_ge_i32 s[8:9],-5,v98
v_cmp_ge_i32 s[10:11],-4,v98
v_cmp_ge_i32 s[12:13],-3,v98
v_cmp_ge_i32 s[14:15],-2,v98
v_cmp_ge_i32 s[16:17],-1,v98
v_cmp_ge_i32 s[18:19],0,v98
v_cmp_ge_i32 s[32:33],1,v98
v_cmp_ge_i32 s[34:35],2,v98
v_cmp_ge_i32 s[36:37],3,v98
v_cmp_ge_i32 s[38:39],4,v98
s_add_u32 s64,s79,0
s_lshl_b32 s74,s64,21
s_lshl_b32 s64,s64,13
s_and_b32 s64,s64,0x2000
s_xor_b32 s64,s64,s61
s_add_u32 s74,s74,s64
s_add_u32 s74,s74,29360128
s_add_u32 s66,s74,s43
kp_229:
buffer_load_dwordx4 v[136:139],v16,s[20:23],s66 offen offset:0 sc1
buffer_load_dwordx4 v[140:143],v16,s[20:23],s66 offen offset:1024 sc1
buffer_load_dwordx4 v[144:147],v16,s[20:23],s66 offen offset:2048 sc1
buffer_load_dwordx4 v[148:151],v16,s[20:23],s66 offen offset:3072 sc1
s_waitcnt vmcnt(0)
kck_231:
v_min3_u32 v22,v136,v140,v144
v_min_u32 v22,v22,v148
v_cmp_eq_u32 vcc,0,v22
s_cbranch_vccz kok_230
s_sleep 1
s_sub_u32 s90,s90,1
s_cmp_gt_i32 s90,0
s_cbranch_scc1 kp_229
kok_230:
s_add_u32 s64,s79,0
s_lshl_b32 s75,s64,21
s_lshl_b32 s64,s64,13
s_and_b32 s64,s64,0x2000
s_xor_b32 s64,s64,s61
s_add_u32 s75,s75,s64
s_add_u32 s75,s75,29360128
s_add_u32 s64,s79,0
s_lshl_b32 s76,s64,21
s_lshl_b32 s64,s64,13
s_and_b32 s64,s64,0x2000
s_xor_b32 s64,s64,s62
s_add_u32 s76,s76,s64
s_add_u32 s76,s76,29360128
s_add_u32 s66,s75,s43
s_add_u32 s75,s75,s42
s_add_u32 s76,s76,s42
s_add_u32 s65,s75,524288
buffer_load_dwordx4 a[32:35],v16,s[20:23],s65 offen offset:0 sc1
buffer_load_dwordx4 a[36:39],v16,s[20:23],s65 offen offset:1024 sc1
buffer_load_dwordx4 a[40:43],v16,s[20:23],s65 offen offset:2048 sc1
buffer_load_dwordx4 a[44:47],v16,s[20:23],s65 offen offset:3072 sc1
s_add_u32 s65,s75,528384
buffer_load_dwordx4 a[48:51],v16,s[20:23],s65 offen offset:0 sc1
buffer_load_dwordx4 a[52:55],v16,s[20:23],s65 offen offset:1024 sc1
buffer_load_dwordx4 a[56:59],v16,s[20:23],s65 offen offset:2048 sc1
buffer_load_dwordx4 a[60:63],v16,s[20:23],s65 offen offset:3072 sc1
s_add_u32 s65,s76,0
buffer_load_dwordx4 a[0:3],v16,s[20:23],s65 offen offset:0 sc1
buffer_load_dwordx4 a[4:7],v16,s[20:23],s65 offen offset:1024 sc1
buffer_load_dwordx4 a[8:11],v16,s[20:23],s65 offen offset:2048 sc1
buffer_load_dwordx4 a[12:15],v16,s[20:23],s65 offen offset:3072 sc1
s_add_u32 s65,s76,4096
buffer_load_dwordx4 a[16:19],v16,s[20:23],s65 offen offset:0 sc1
buffer_load_dwordx4 a[20:23],v16,s[20:23],s65 offen offset:1024 sc1
buffer_load_dwordx4 a[24:27],v16,s[20:23],s65 offen offset:2048 sc1
buffer_load_dwordx4 a[28:31],v16,s[20:23],s65 offen offset:3072 sc1
buffer_load_dwordx4 v[136:139],v16,s[20:23],s66 offen offset:0 sc1
buffer_load_dwordx4 v[140:143],v16,s[20:23],s66 offen offset:1024 sc1
buffer_load_dwordx4 v[144:147],v16,s[20:23],s66 offen offset:2048 sc1
buffer_load_dwordx4 v[148:151],v16,s[20:23],s66 offen offset:3072 sc1
s_add_u32 s65,s75,1048576
buffer_load_dwordx4 a[64:67],v16,s[20:23],s65 offen offset:0 sc1
buffer_load_dwordx4 a[68:71],v16,s[20:23],s65 offen offset:1024 sc1
buffer_load_dwordx4 a[72:75],v16,s[20:23],s65 offen offset:2048 sc1
buffer_load_dwordx4 a[76:79],v16,s[20:23],s65 offen offset:3072 sc1
s_add_u32 s65,s75,1052672
buffer_load_dwordx4 a[80:83],v16,s[20:23],s65 offen offset:0 sc1
buffer_load_dwordx4 a[84:87],v16,s[20:23],s65 offen offset:1024 sc1
buffer_load_dwordx4 a[88:91],v16,s[20:23],s65 offen offset:2048 sc1
buffer_load_dwordx4 a[92:95],v16,s[20:23],s65 offen offset:3072 sc1
s_waitcnt vmcnt(0)
aloop_232:
s_add_u32 s64,s79,0
s_lshl_b32 s74,s64,21
s_lshl_b32 s64,s64,13
s_and_b32 s64,s64,0x2000
s_xor_b32 s64,s64,s61
s_add_u32 s74,s74,s64
s_add_u32 s74,s74,29360128
s_add_u32 s64,s79,0
s_lshl_b32 s70,s64,21
s_lshl_b32 s64,s64,13
s_and_b32 s64,s64,0x2000
s_xor_b32 s64,s64,s62
s_add_u32 s70,s70,s64
s_add_u32 s70,s70,29360128
s_cmp_gt_u32 s71,52
s_cselect_b32 s65,0x7fff0000,s73
s_waitcnt vmcnt(28)
v_add_u32 v22,s71,-1
buffer_store_dword v22,v23,s[20:23],s65 offen sc1
s_waitcnt vmcnt(13)
v_mfma_f32_16x16x32_bf16 v[168:171],a[32:35],a[0:3],0
v_mfma_f32_16x16x32_bf16 v[172:175],a[36:39],a[0:3],0
v_mfma_f32_16x16x32_bf16 v[180:183],a[32:35],a[4:7],0
v_mfma_f32_16x16x32_bf16 v[184:187],a[36:39],a[4:7],0
v_mfma_f32_16x16x32_bf16 v[168:171],a[40:43],a[8:11],v[168:171]
v_mfma_f32_16x16x32_bf16 v[172:175],a[44:47],a[8:11],v[172:175]
v_mfma_f32_16x16x32_bf16 v[180:183],a[40:43],a[12:15],v[180:183]
v_mfma_f32_16x16x32_bf16 v[184:187],a[44:47],a[12:15],v[184:187]
v_mfma_f32_16x16x32_bf16 v[168:171],a[48:51],a[16:19],v[168:171]
v_mfma_f32_16x16x32_bf16 v[172:175],a[52:55],a[16:19],v[172:175]
v_mfma_f32_16x16x32_bf16 v[180:183],a[48:51],a[20:23],v[180:183]
v_mfma_f32_16x16x32_bf16 v[184:187],a[52:55],a[20:23],v[184:187]
v_mfma_f32_16x16x32_bf16 v[168:171],a[56:59],a[24:27],v[168:171]
v_mfma_f32_16x16x32_bf16 v[172:175],a[60:63],a[24:27],v[172:175]
v_mfma_f32_16x16x32_bf16 v[180:183],a[56:59],a[28:31],v[180:183]
v_mfma_f32_16x16x32_bf16 v[184:187],a[60:63],a[28:31],v[184:187]
s_nop 4
v_cndmask_b32 v168,v97,v168,s[18:19]
s_nop 0
v_cndmask_b32 v180,v97,v180,s[38:39]
v_cndmask_b32 v169,v97,v169,s[16:17]
v_cndmask_b32 v181,v97,v181,s[36:37]
v_cndmask_b32 v170,v97,v170,s[14:15]
v_cndmask_b32 v182,v97,v182,s[34:35]
v_cndmask_b32 v171,v97,v171,s[12:13]
v_cndmask_b32 v183,v97,v183,s[32:33]
v_cndmask_b32 v172,v97,v172,s[10:11]
v_cndmask_b32 v184,v97,v184,s[18:19]
v_cndmask_b32 v173,v97,v173,s[8:9]
v_cndmask_b32 v185,v97,v185,s[16:17]
v_cndmask_b32 v174,v97,v174,s[6:7]
v_cndmask_b32 v186,v97,v186,s[14:15]
v_cndmask_b32 v175,v97,v175,s[4:5]
v_cndmask_b32 v187,v97,v187,s[12:13]
v_max3_f32 v116,v168,v169,v170
v_max3_f32 v122,v180,v181,v182
v_max3_f32 v118,v171,v172,v173
v_max3_f32 v124,v183,v184,v185
v_max3_f32 v116,v116,v174,v175
v_max3_f32 v122,v122,v186,v187
v_max_f32 v116,v116,v118
v_max_f32 v122,v122,v124
v_mov_b32 v118,v116
v_mov_b32 v124,v122
s_nop 0
v_permlane16_swap_b32 v118,v116
v_permlane16_swap_b32 v124,v122
v_max_f32 v116,v116,v118
v_max_f32 v122,v122,v124
v_mov_b32 v118,v116
v_mov_b32 v124,v122
s_nop 0
v_permlane32_swap_b32 v118,v116
v_permlane32_swap_b32 v124,v122
v_max_f32 v116,v116,v118
v_max_f32 v122,v122,v124
v_mul_f32 v116,s80,v116
v_mul_f32 v122,s80,v122
v_fma_f32 v168,v168,s80,-v116
v_fma_f32 v180,v180,s80,-v122
v_fma_f32 v169,v169,s80,-v116
v_fma_f32 v181,v181,s80,-v122
v_fma_f32 v170,v170,s80,-v116
v_fma_f32 v182,v182,s80,-v122
v_fma_f32 v171,v171,s80,-v116
v_fma_f32 v183,v183,s80,-v122
v_fma_f32 v172,v172,s80,-v116
v_fma_f32 v184,v184,s80,-v122
v_fma_f32 v173,v173,s80,-v116
v_fma_f32 v185,v185,s80,-v122
v_fma_f32 v174,v174,s80,-v116
v_fma_f32 v186,v186,s80,-v122
v_fma_f32 v175,v175,s80,-v116
v_fma_f32 v187,v187,s80,-v122
v_exp_f32 v168,v168
v_exp_f32 v180,v180
v_exp_f32 v169,v169
v_exp_f32 v181,v181
v_exp_f32 v170,v170
v_exp_f32 v182,v182
v_exp_f32 v171,v171
v_exp_f32 v183,v183
v_exp_f32 v172,v172
v_exp_f32 v184,v184
v_exp_f32 v173,v173
v_exp_f32 v185,v185
v_exp_f32 v174,v174
v_exp_f32 v186,v186
v_exp_f32 v175,v175
v_exp_f32 v187,v187
v_add_f32 v117,v168,v169
v_add_f32 v123,v180,v181
v_add_f32 v119,v170,v171
v_add_f32 v125,v182,v183
v_add_f32 v117,v117,v172
v_add_f32 v123,v123,v184
v_add_f32 v119,v119,v173
v_add_f32 v125,v125,v185
v_add_f32 v117,v117,v174
v_add_f32 v123,v123,v186
v_add_f32 v119,v119,v175
v_add_f32 v125,v125,v187
v_add_f32 v117,v117,v119
v_add_f32 v123,v123,v125
v_mov_b32 v118,v117
v_mov_b32 v124,v123
s_nop 0
v_permlane16_swap_b32 v118,v117
v_permlane16_swap_b32 v124,v123
v_add_f32 v117,v117,v118
v_add_f32 v123,v123,v124
v_mov_b32 v118,v117
v_mov_b32 v124,v123
s_nop 0
v_permlane32_swap_b32 v118,v117
v_permlane32_swap_b32 v124,v123
v_add_f32 v117,v117,v118
v_add_f32 v123,v123,v124
s_add_u32 s66,s74,s43
s_waitcnt vmcnt(9)
s_branch kck_235
kp_233:
buffer_load_dwordx4 v[136:139],v16,s[20:23],s66 offen offset:0 sc1
buffer_load_dwordx4 v[140:143],v16,s[20:23],s66 offen offset:1024 sc1
buffer_load_dwordx4 v[144:147],v16,s[20:23],s66 offen offset:2048 sc1
buffer_load_dwordx4 v[148:151],v16,s[20:23],s66 offen offset:3072 sc1
s_waitcnt vmcnt(0)
kck_235:
v_min3_u32 v22,v136,v140,v144
v_min_u32 v22,v22,v148
v_cmp_eq_u32 vcc,0,v22
s_cbranch_vccz kok_234
s_sleep 1
s_sub_u32 s90,s90,1
s_cmp_gt_i32 s90,0
s_cbranch_scc1 kp_233
kok_234:
buffer_load_dwordx2 v[100:101],v6,s[20:23],s66 offen offset:0 sc1
buffer_load_dwordx2 v[102:103],v6,s[20:23],s66 offen offset:512 sc1
buffer_load_dwordx2 v[104:105],v6,s[20:23],s66 offen offset:1024 sc1
buffer_load_dwordx2 v[106:107],v6,s[20:23],s66 offen offset:1536 sc1
buffer_load_dwordx2 v[108:109],v6,s[20:23],s66 offen offset:2048 sc1
buffer_load_dwordx2 v[110:111],v6,s[20:23],s66 offen offset:2560 sc1
buffer_load_dwordx2 v[112:113],v6,s[20:23],s66 offen offset:3072 sc1
buffer_load_dwordx2 v[114:115],v6,s[20:23],s66 offen offset:3584 sc1
v_mfma_f32_16x16x32_bf16 v[176:179],v[136:139],a[0:3],0
v_mfma_f32_16x16x32_bf16 v[188:191],v[136:139],a[4:7],0
v_mfma_f32_16x16x32_bf16 v[176:179],v[140:143],a[8:11],v[176:179]
v_mfma_f32_16x16x32_bf16 v[188:191],v[140:143],a[12:15],v[188:191]
v_mfma_f32_16x16x32_bf16 v[176:179],v[144:147],a[16:19],v[176:179]
v_mfma_f32_16x16x32_bf16 v[188:191],v[144:147],a[20:23],v[188:191]
v_mfma_f32_16x16x32_bf16 v[176:179],v[148:151],a[24:27],v[176:179]
v_mfma_f32_16x16x32_bf16 v[188:191],v[148:151],a[28:31],v[188:191]
s_nop 6
v_cndmask_b32 v176,v97,v176,s[48:49]
v_cndmask_b32 v188,v97,v188,s[48:49]
v_cndmask_b32 v177,v97,v177,s[48:49]
v_cndmask_b32 v189,v97,v189,s[48:49]
v_cndmask_b32 v178,v97,v178,s[48:49]
v_cndmask_b32 v190,v97,v190,s[48:49]
v_cndmask_b32 v179,v97,v179,s[48:49]
v_cndmask_b32 v191,v97,v191,s[48:49]
v_max3_f32 v119,v176,v177,v178
v_max3_f32 v125,v188,v189,v190
v_max_f32 v119,v119,v179
v_max_f32 v125,v125,v191
v_mov_b32 v118,v119
v_mov_b32 v124,v125
s_nop 0
v_permlane16_swap_b32 v118,v119
v_permlane16_swap_b32 v124,v125
v_max_f32 v119,v119,v118
v_max_f32 v125,v125,v124
v_mov_b32 v118,v119
v_mov_b32 v124,v125
s_nop 0
v_permlane32_swap_b32 v118,v119
v_permlane32_swap_b32 v124,v125
v_max_f32 v119,v119,v118
v_max_f32 v125,v125,v124
v_mul_f32 v119,s80,v119
v_mul_f32 v125,s80,v125
v_max_f32 v119,v119,v116
v_max_f32 v125,v125,v122
v_fma_f32 v176,v176,s80,-v119
v_fma_f32 v188,v188,s80,-v125
v_fma_f32 v177,v177,s80,-v119
v_fma_f32 v189,v189,s80,-v125
v_fma_f32 v178,v178,s80,-v119
v_fma_f32 v190,v190,s80,-v125
v_fma_f32 v179,v179,s80,-v119
v_fma_f32 v191,v191,s80,-v125
v_sub_f32 v116,v116,v119
v_sub_f32 v122,v122,v125
v_exp_f32 v176,v176
v_exp_f32 v188,v188
v_exp_f32 v177,v177
v_exp_f32 v189,v189
v_exp_f32 v178,v178
v_exp_f32 v190,v190
v_exp_f32 v179,v179
v_exp_f32 v191,v191
v_exp_f32 v116,v116
v_exp_f32 v122,v122
v_add_f32 v120,v176,v177
v_add_f32 v126,v188,v189
v_add_f32 v121,v178,v179
v_add_f32 v127,v190,v191
v_add_f32 v120,v120,v121
v_add_f32 v126,v126,v127
v_mov_b32 v118,v120
v_mov_b32 v124,v126
s_nop 0
v_permlane16_swap_b32 v118,v120
v_permlane16_swap_b32 v124,v126
v_add_f32 v120,v120,v118
v_add_f32 v126,v126,v124
v_mov_b32 v118,v120
v_mov_b32 v124,v126
s_nop 0
v_permlane32_swap_b32 v118,v120
v_permlane32_swap_b32 v124,v126
v_add_f32 v120,v120,v118
v_add_f32 v126,v126,v124
v_fmac_f32 v120,v117,v116
v_fmac_f32 v126,v123,v122
v_rcp_f32 v121,v120
v_rcp_f32 v127,v126
v_mul_f32 v119,v116,v121
v_mul_f32 v125,v122,v127
v_pk_mul_f32 v[168:169],v[168:169],v[118:119] op_sel:[0,1] op_sel_hi:[1,1]
v_pk_mul_f32 v[180:181],v[180:181],v[124:125] op_sel:[0,1] op_sel_hi:[1,1]
v_pk_mul_f32 v[170:171],v[170:171],v[118:119] op_sel:[0,1] op_sel_hi:[1,1]
v_pk_mul_f32 v[182:183],v[182:183],v[124:125] op_sel:[0,1] op_sel_hi:[1,1]
v_pk_mul_f32 v[172:173],v[172:173],v[118:119] op_sel:[0,1] op_sel_hi:[1,1]
v_pk_mul_f32 v[184:185],v[184:185],v[124:125] op_sel:[0,1] op_sel_hi:[1,1]
v_pk_mul_f32 v[174:175],v[174:175],v[118:119] op_sel:[0,1] op_sel_hi:[1,1]
v_pk_mul_f32 v[186:187],v[186:187],v[124:125] op_sel:[0,1] op_sel_hi:[1,1]
v_cvt_pk_bf16_f32 v48,v168,v169
v_cvt_pk_bf16_f32 v56,v180,v181
v_cvt_pk_bf16_f32 v49,v170,v171
v_cvt_pk_bf16_f32 v57,v182,v183
v_cvt_pk_bf16_f32 v50,v172,v173
v_cvt_pk_bf16_f32 v58,v184,v185
v_cvt_pk_bf16_f32 v51,v174,v175
v_cvt_pk_bf16_f32 v59,v186,v187
v_pk_mul_f32 v[176:177],v[176:177],v[120:121] op_sel:[0,1] op_sel_hi:[1,1]
v_pk_mul_f32 v[188:189],v[188:189],v[126:127] op_sel:[0,1] op_sel_hi:[1,1]
v_pk_mul_f32 v[178:179],v[178:179],v[120:121] op_sel:[0,1] op_sel_hi:[1,1]
v_pk_mul_f32 v[190:191],v[190:191],v[126:127] op_sel:[0,1] op_sel_hi:[1,1]
v_cvt_pk_bf16_f32 v52,v176,v177
v_cvt_pk_bf16_f32 v60,v188,v189
v_cvt_pk_bf16_f32 v53,v178,v179
v_cvt_pk_bf16_f32 v61,v190,v191
s_add_u32 s70,s70,s42
s_waitcnt vmcnt(8)
v_mfma_f32_16x16x32_bf16 v[192:195],a[64:67],v[48:51],0
v_mfma_f32_16x16x32_bf16 v[196:199],a[64:67],v[56:59],0
v_mfma_f32_16x16x32_bf16 v[200:203],a[68:71],v[48:51],0
v_mfma_f32_16x16x32_bf16 v[204:207],a[68:71],v[56:59],0
v_mfma_f32_16x16x32_bf16 v[208:211],a[72:75],v[48:51],0
v_mfma_f32_16x16x32_bf16 v[212:215],a[72:75],v[56:59],0
v_mfma_f32_16x16x32_bf16 v[216:219],a[76:79],v[48:51],0
v_mfma_f32_16x16x32_bf16 v[220:223],a[76:79],v[56:59],0
s_waitcnt vmcnt(0)
v_mfma_f32_16x16x16_bf16 v[192:195],v[100:101],v[52:53],v[192:195]
v_mfma_f32_16x16x16_bf16 v[196:199],v[100:101],v[60:61],v[196:199]
v_mfma_f32_16x16x16_bf16 v[200:203],v[102:103],v[52:53],v[200:203]
v_mfma_f32_16x16x16_bf16 v[204:207],v[102:103],v[60:61],v[204:207]
v_mfma_f32_16x16x32_bf16 v[224:227],a[80:83],v[48:51],0
v_mfma_f32_16x16x32_bf16 v[228:231],a[80:83],v[56:59],0
v_mfma_f32_16x16x32_bf16 v[232:235],a[84:87],v[48:51],0
v_mfma_f32_16x16x32_bf16 v[236:239],a[84:87],v[56:59],0
v_mfma_f32_16x16x16_bf16 v[208:211],v[104:105],v[52:53],v[208:211]
s_add_u32 s65,s70,524288
v_mfma_f32_16x16x16_bf16 v[212:215],v[104:105],v[60:61],v[212:215]
v_cvt_pk_bf16_f32 v64,v192,v193
v_cvt_pk_bf16_f32 v65,v194,v195
v_mfma_f32_16x16x16_bf16 v[216:219],v[106:107],v[52:53],v[216:219]
v_cvt_pk_bf16_f32 v66,v200,v201
v_mfma_f32_16x16x16_bf16 v[220:223],v[106:107],v[60:61],v[220:223]
v_cvt_pk_bf16_f32 v67,v202,v203
v_max_u32 v64,1,v64
v_mfma_f32_16x16x32_bf16 v[240:243],a[88:91],v[48:51],0
buffer_store_dwordx4 v[64:67],v16,s[20:23],s65 offen offset:0 sc1
v_cvt_pk_bf16_f32 v68,v196,v197
v_mfma_f32_16x16x32_bf16 v[244:247],a[88:91],v[56:59],0
v_cvt_pk_bf16_f32 v69,v198,v199
v_mfma_f32_16x16x32_bf16 v[248:251],a[92:95],v[48:51],0
v_cvt_pk_bf16_f32 v70,v204,v205
v_cvt_pk_bf16_f32 v71,v206,v207
v_mfma_f32_16x16x32_bf16 v[252:255],a[92:95],v[56:59],0
v_max_u32 v68,1,v68
buffer_store_dwordx4 v[68:71],v16,s[20:23],s65 offen offset:1024 sc1
v_mfma_f32_16x16x16_bf16 v[224:227],v[108:109],v[52:53],v[224:227]
v_cvt_pk_bf16_f32 v72,v208,v209
v_mfma_f32_16x16x16_bf16 v[228:231],v[108:109],v[60:61],v[228:231]
v_cvt_pk_bf16_f32 v73,v210,v211
v_cvt_pk_bf16_f32 v74,v216,v217
v_mfma_f32_16x16x16_bf16 v[232:235],v[110:111],v[52:53],v[232:235]
v_cvt_pk_bf16_f32 v75,v218,v219
v_mfma_f32_16x16x16_bf16 v[236:239],v[110:111],v[60:61],v[236:239]
v_max_u32 v72,1,v72
buffer_store_dwordx4 v[72:75],v16,s[20:23],s65 offen offset:2048 sc1
v_mfma_f32_16x16x16_bf16 v[240:243],v[112:113],v[52:53],v[240:243]
v_cvt_pk_bf16_f32 v76,v212,v213
v_mfma_f32_16x16x16_bf16 v[244:247],v[112:113],v[60:61],v[244:247]
v_cvt_pk_bf16_f32 v77,v214,v215
v_cvt_pk_bf16_f32 v78,v220,v221
v_mfma_f32_16x16x16_bf16 v[248:251],v[114:115],v[52:53],v[248:251]
v_cvt_pk_bf16_f32 v79,v222,v223
v_mfma_f32_16x16x16_bf16 v[252:255],v[114:115],v[60:61],v[252:255]
v_max_u32 v76,1,v76
buffer_store_dwordx4 v[76:79],v16,s[20:23],s65 offen offset:3072 sc1
s_add_u32 s65,s70,528384
v_cvt_pk_bf16_f32 v64,v224,v225
v_cvt_pk_bf16_f32 v65,v226,v227
v_cvt_pk_bf16_f32 v66,v232,v233
v_cvt_pk_bf16_f32 v67,v234,v235
v_max_u32 v64,1,v64
buffer_store_dwordx4 v[64:67],v16,s[20:23],s65 offen offset:0 sc1
v_cvt_pk_bf16_f32 v68,v228,v229
v_cvt_pk_bf16_f32 v69,v230,v231
v_cvt_pk_bf16_f32 v70,v236,v237
v_cvt_pk_bf16_f32 v71,v238,v239
v_max_u32 v68,1,v68
buffer_store_dwordx4 v[68:71],v16,s[20:23],s65 offen offset:1024 sc1
v_cvt_pk_bf16_f32 v72,v240,v241
v_cvt_pk_bf16_f32 v73,v242,v243
v_cvt_pk_bf16_f32 v74,v248,v249
v_cvt_pk_bf16_f32 v75,v250,v251
v_max_u32 v72,1,v72
buffer_store_dwordx4 v[72:75],v16,s[20:23],s65 offen offset:2048 sc1
v_cvt_pk_bf16_f32 v76,v244,v245
v_cvt_pk_bf16_f32 v77,v246,v247
v_cvt_pk_bf16_f32 v78,v252,v253
v_cvt_pk_bf16_f32 v79,v254,v255
v_max_u32 v76,1,v76
buffer_store_dwordx4 v[76:79],v16,s[20:23],s65 offen offset:3072 sc1
s_cmp_le_u32 s71,51
s_cbranch_scc1 alater_236
v_mov_b32 v22,s71
buffer_store_dword v22,v23,s[20:23],s73 offen sc1
alater_236:
s_cmp_lg_u32 s79,55
s_cbranch_scc1 q2nd_237
pl_238:
buffer_load_dword v98,v99,s[20:23],s87 offen sc1
s_waitcnt vmcnt(0)
v_cmp_gt_u32 vcc,18,v98
s_cbranch_vccz pok_239
s_sleep 1
s_sub_u32 s90,s90,1
s_cmp_gt_i32 s90,0
s_cbranch_scc1 pl_238
pok_239:
q2nd_237:
s_add_u32 s64,s79,1
s_lshl_b32 s75,s64,21
s_lshl_b32 s64,s64,13
s_and_b32 s64,s64,0x2000
s_xor_b32 s64,s64,s61
s_add_u32 s75,s75,s64
s_add_u32 s75,s75,29360128
s_add_u32 s64,s79,1
s_lshl_b32 s76,s64,21
s_lshl_b32 s64,s64,13
s_and_b32 s64,s64,0x2000
s_xor_b32 s64,s64,s62
s_add_u32 s76,s76,s64
s_add_u32 s76,s76,29360128
s_add_u32 s66,s75,s43
s_add_u32 s75,s75,s42
s_add_u32 s76,s76,s42
s_cmp_lt_u32 s79,63
s_cselect_b32 s75,s75,0x7fff0000
s_cselect_b32 s76,s76,0x7fff0000
s_cselect_b32 s66,s66,0x7fff0000
s_add_u32 s65,s75,524288
buffer_load_dwordx4 a[32:35],v16,s[20:23],s65 offen offset:0 sc1
buffer_load_dwordx4 a[36:39],v16,s[20:23],s65 offen offset:1024 sc1
buffer_load_dwordx4 a[40:43],v16,s[20:23],s65 offen offset:2048 sc1
buffer_load_dwordx4 a[44:47],v16,s[20:23],s65 offen offset:3072 sc1
s_add_u32 s65,s75,528384
buffer_load_dwordx4 a[48:51],v16,s[20:23],s65 offen offset:0 sc1
buffer_load_dwordx4 a[52:55],v16,s[20:23],s65 offen offset:1024 sc1
buffer_load_dwordx4 a[56:59],v16,s[20:23],s65 offen offset:2048 sc1
buffer_load_dwordx4 a[60:63],v16,s[20:23],s65 offen offset:3072 sc1
s_add_u32 s65,s76,0
buffer_load_dwordx4 a[0:3],v16,s[20:23],s65 offen offset:0 sc1
buffer_load_dwordx4 a[4:7],v16,s[20:23],s65 offen offset:1024 sc1
buffer_load_dwordx4 a[8:11],v16,s[20:23],s65 offen offset:2048 sc1
buffer_load_dwordx4 a[12:15],v16,s[20:23],s65 offen offset:3072 sc1
s_add_u32 s65,s76,4096
buffer_load_dwordx4 a[16:19],v16,s[20:23],s65 offen offset:0 sc1
buffer_load_dwordx4 a[20:23],v16,s[20:23],s65 offen offset:1024 sc1
buffer_load_dwordx4 a[24:27],v16,s[20:23],s65 offen offset:2048 sc1
buffer_load_dwordx4 a[28:31],v16,s[20:23],s65 offen offset:3072 sc1
buffer_load_dwordx4 v[136:139],v16,s[20:23],s66 offen offset:0 sc1
buffer_load_dwordx4 v[140:143],v16,s[20:23],s66 offen offset:1024 sc1
buffer_load_dwordx4 v[144:147],v16,s[20:23],s66 offen offset:2048 sc1
buffer_load_dwordx4 v[148:151],v16,s[20:23],s66 offen offset:3072 sc1
s_add_u32 s65,s75,1048576
buffer_load_dwordx4 a[64:67],v16,s[20:23],s65 offen offset:0 sc1
buffer_load_dwordx4 a[68:71],v16,s[20:23],s65 offen offset:1024 sc1
buffer_load_dwordx4 a[72:75],v16,s[20:23],s65 offen offset:2048 sc1
buffer_load_dwordx4 a[76:79],v16,s[20:23],s65 offen offset:3072 sc1
s_add_u32 s65,s75,1052672
buffer_load_dwordx4 a[80:83],v16,s[20:23],s65 offen offset:0 sc1
buffer_load_dwordx4 a[84:87],v16,s[20:23],s65 offen offset:1024 sc1
buffer_load_dwordx4 a[88:91],v16,s[20:23],s65 offen offset:2048 sc1
buffer_load_dwordx4 a[92:95],v16,s[20:23],s65 offen offset:3072 sc1
s_add_u32 s79,s79,1
s_add_u32 s71,s71,1
s_cmp_lt_u32 s79,64
s_cbranch_scc1 aloop_232
s_endpgm
r_ln_197:
v_and_b32 v21,1,v1
v_mul_u32_u24 v21,960,v21
s_mov_b32 s65,21052032
s_mov_b32 s66,1792
pl_240:
buffer_load_dword v22,v21,s[20:23],s65 offen sc1
s_waitcnt vmcnt(0)
v_cmp_gt_u32 vcc,s66,v22
s_cbranch_vccz pok_241
s_sleep 1
s_sub_u32 s90,s90,1
s_cmp_gt_i32 s90,0
s_cbranch_scc1 pl_240
pok_241:
s_lshl_b32 s41,s59,1
s_add_u32 s41,s41,s50
s_sub_u32 s41,s41,2
v_lshlrev_b32 v5,5,v1
s_mov_b32 s64,16384
buffer_load_dwordx4 v[40:43],v5,s[20:23],s64 offen offset:0 sc1
buffer_load_dwordx4 v[44:47],v5,s[20:23],s64 offen offset:16 sc1
buffer_load_dwordx4 v[48:51],v5,s[20:23],s64 offen offset:2048 sc1
buffer_load_dwordx4 v[52:55],v5,s[20:23],s64 offen offset:2064 sc1
s_mov_b32 s64,12288
buffer_load_dwordx4 v[56:59],v5,s[20:23],s64 offen offset:0 sc1
buffer_load_dwordx4 v[60:63],v5,s[20:23],s64 offen offset:16 sc1
buffer_load_dwordx4 v[64:67],v5,s[20:23],s64 offen offset:2048 sc1
buffer_load_dwordx4 v[68:71],v5,s[20:23],s64 offen offset:2064 sc1
s_lshr_b32 s64,s41,2
s_add_u32 s64,s64,64
s_lshl_b32 s64,s64,14
s_and_b32 s65,s41,3
s_lshl_b32 s65,s65,11
s_add_u32 s64,s64,s65
v_add_u32 v19,s64,v16
v_add_u32 v19,786432,v19
s_lshl_b32 s65,s41,7
v_add_u32 v5,s65,v16
v_and_b32 v5,2047,v5
v_add_u32 v17,s64,v5
v_xor_b32 v18,1024,v17
v_add_u32 v24,0xfff00000,v17
v_xor_b32 v25,1024,v24
v_lshlrev_b32 v21,2,v1
s_and_b32 s64,s41,4
s_lshl_b32 s64,s64,6
s_add_u32 s74,s63,s64
s_add_u32 s74,s74,2048
s_mov_b32 s83,1
s_lshl_b32 s73,s41,2
s_add_u32 s73,s73,s63
s_add_u32 s73,s73,2560
s_waitcnt vmcnt(0)
v_add_f32 v40,1.0,v40
v_add_f32 v41,1.0,v41
v_add_f32 v42,1.0,v42
v_add_f32 v43,1.0,v43
v_add_f32 v44,1.0,v44
v_add_f32 v45,1.0,v45
v_add_f32 v46,1.0,v46
v_add_f32 v47,1.0,v47
v_add_f32 v48,1.0,v48
v_add_f32 v49,1.0,v49
v_add_f32 v50,1.0,v50
v_add_f32 v51,1.0,v51
v_add_f32 v52,1.0,v52
v_add_f32 v53,1.0,v53
v_add_f32 v54,1.0,v54
v_add_f32 v55,1.0,v55
s_add_u32 s64,s79,0
s_lshl_b32 s70,s64,21
s_lshl_b32 s64,s64,13
s_and_b32 s64,s64,0x2000
s_xor_b32 s64,s64,s62
s_add_u32 s70,s70,s64
s_add_u32 s70,s70,29360128
lloop_242:
s_add_u32 s75,s70,2097152
s_xor_b32 s75,s75,0x2000
s_add_u32 s96,s71,1
s_cmp_eq_u32 s83,0
s_cbranch_scc1 lahead_245
s_cmp_gt_u32 s71,51
s_cbranch_scc1 xp_243
pl_247:
buffer_load_dword v29,v21,s[20:23],s74 offen sc1
s_waitcnt vmcnt(0)
v_cmp_gt_u32 vcc,s71,v29
s_cbranch_vccz pok_248
s_sleep 1
s_sub_u32 s90,s90,1
s_cmp_gt_i32 s90,0
s_cbranch_scc1 pl_247
pok_248:
xp_243:
buffer_load_dwordx4 v[8:11],v17,s[20:23],s70 offen sc1
buffer_load_dwordx4 v[12:15],v18,s[20:23],s70 offen sc1
s_waitcnt vmcnt(0)
v_min3_u32 v22,v8,v10,v12
v_min_u32 v22,v22,v14
v_cmp_eq_u32 vcc,0,v22
s_cbranch_vccz xk_244
s_sleep 1
s_sub_u32 s90,s90,1
s_cmp_gt_i32 s90,0
s_cbranch_scc1 xp_243
s_branch xk_244
lahead_245:
s_waitcnt vmcnt(6)
v_mov_b32 v8,v104
v_mov_b32 v9,v105
v_mov_b32 v10,v106
v_mov_b32 v11,v107
v_mov_b32 v12,v108
v_mov_b32 v13,v109
v_mov_b32 v14,v110
v_mov_b32 v15,v111
v_min3_u32 v22,v8,v10,v12
v_min_u32 v22,v22,v14
v_cmp_eq_u32 vcc,0,v22
s_cbranch_vccnz xp_243
xk_244:
v_cmp_gt_u32 vcc,s96,v29
s_or_b32 s83,vcc_lo,vcc_hi
s_cselect_b32 s76,0x7fff0000,s75
buffer_load_dwordx4 v[104:107],v17,s[20:23],s76 offen sc1
buffer_load_dwordx4 v[108:111],v18,s[20:23],s76 offen sc1
buffer_load_dword v29,v21,s[20:23],s74 offen sc1
v_lshlrev_b32 v80,16,v8
v_and_b32 v81,s80,v8
v_lshlrev_b32 v82,16,v9
v_and_b32 v83,s80,v9
v_lshlrev_b32 v84,16,v10
v_and_b32 v85,s80,v10
v_lshlrev_b32 v86,16,v11
v_and_b32 v87,s80,v11
v_lshlrev_b32 v88,16,v12
v_and_b32 v89,s80,v12
v_lshlrev_b32 v90,16,v13
v_and_b32 v91,s80,v13
v_lshlrev_b32 v92,16,v14
v_and_b32 v93,s80,v14
v_lshlrev_b32 v94,16,v15
v_and_b32 v95,s80,v15
v_add_f32 v5,v80,v81
v_add_f32 v5,v5,v82
v_add_f32 v5,v5,v83
v_add_f32 v5,v5,v84
v_add_f32 v5,v5,v85
v_add_f32 v5,v5,v86
v_add_f32 v5,v5,v87
v_add_f32 v5,v5,v88
v_add_f32 v5,v5,v89
v_add_f32 v5,v5,v90
v_add_f32 v5,v5,v91
v_add_f32 v5,v5,v92
v_add_f32 v5,v5,v93
v_add_f32 v5,v5,v94
v_add_f32 v5,v5,v95
s_nop 1
v_add_f32_dpp v5,v5,v5 quad_perm:[1,0,3,2] row_mask:0xf bank_mask:0xf
s_nop 1
v_add_f32_dpp v5,v5,v5 quad_perm:[2,3,0,1] row_mask:0xf bank_mask:0xf
s_nop 1
v_add_f32_dpp v5,v5,v5 row_half_mirror row_mask:0xf bank_mask:0xf
s_nop 1
v_add_f32_dpp v5,v5,v5 row_mirror row_mask:0xf bank_mask:0xf
v_mov_b32 v7,v5
s_nop 1
v_permlane16_swap_b32 v7,v5
v_add_f32 v5,v5,v7
v_mov_b32 v7,v5
s_nop 1
v_permlane32_swap_b32 v7,v5
v_add_f32 v5,v5,v7
v_mul_f32 v5,0x3a800000,v5
v_sub_f32 v80,v80,v5
v_sub_f32 v81,v81,v5
v_sub_f32 v82,v82,v5
v_sub_f32 v83,v83,v5
v_sub_f32 v84,v84,v5
v_sub_f32 v85,v85,v5
v_sub_f32 v86,v86,v5
v_sub_f32 v87,v87,v5
v_sub_f32 v88,v88,v5
v_sub_f32 v89,v89,v5
v_sub_f32 v90,v90,v5
v_sub_f32 v91,v91,v5
v_sub_f32 v92,v92,v5
v_sub_f32 v93,v93,v5
v_sub_f32 v94,v94,v5
v_sub_f32 v95,v95,v5
v_mul_f32 v6,v80,v80
v_fmac_f32 v6,v81,v81
v_fmac_f32 v6,v82,v82
v_fmac_f32 v6,v83,v83
v_fmac_f32 v6,v84,v84
v_fmac_f32 v6,v85,v85
v_fmac_f32 v6,v86,v86
v_fmac_f32 v6,v87,v87
v_fmac_f32 v6,v88,v88
v_fmac_f32 v6,v89,v89
v_fmac_f32 v6,v90,v90
v_fmac_f32 v6,v91,v91
v_fmac_f32 v6,v92,v92
v_fmac_f32 v6,v93,v93
v_fmac_f32 v6,v94,v94
v_fmac_f32 v6,v95,v95
s_nop 1
v_add_f32_dpp v6,v6,v6 quad_perm:[1,0,3,2] row_mask:0xf bank_mask:0xf
s_nop 1
v_add_f32_dpp v6,v6,v6 quad_perm:[2,3,0,1] row_mask:0xf bank_mask:0xf
s_nop 1
v_add_f32_dpp v6,v6,v6 row_half_mirror row_mask:0xf bank_mask:0xf
s_nop 1
v_add_f32_dpp v6,v6,v6 row_mirror row_mask:0xf bank_mask:0xf
v_mov_b32 v7,v6
s_nop 1
v_permlane16_swap_b32 v7,v6
v_add_f32 v6,v6,v7
v_mov_b32 v7,v6
s_nop 1
v_permlane32_swap_b32 v7,v6
v_add_f32 v6,v6,v7
v_mov_b32 v7,0x3727c5ac
v_fmac_f32 v7,0x3a800000,v6
v_rsq_f32 v6,v7
s_nop 0
v_mul_f32 v80,v80,v6
v_mul_f32 v81,v81,v6
v_mul_f32 v82,v82,v6
v_mul_f32 v83,v83,v6
v_mul_f32 v84,v84,v6
v_mul_f32 v85,v85,v6
v_mul_f32 v86,v86,v6
v_mul_f32 v87,v87,v6
v_mul_f32 v88,v88,v6
v_mul_f32 v89,v89,v6
v_mul_f32 v90,v90,v6
v_mul_f32 v91,v91,v6
v_mul_f32 v92,v92,v6
v_mul_f32 v93,v93,v6
v_mul_f32 v94,v94,v6
v_mul_f32 v95,v95,v6
v_fma_f32 v80,v80,v40,v56
v_fma_f32 v81,v81,v41,v57
v_fma_f32 v82,v82,v42,v58
v_fma_f32 v83,v83,v43,v59
v_fma_f32 v84,v84,v44,v60
v_fma_f32 v85,v85,v45,v61
v_fma_f32 v86,v86,v46,v62
v_fma_f32 v87,v87,v47,v63
v_fma_f32 v88,v88,v48,v64
v_fma_f32 v89,v89,v49,v65
v_fma_f32 v90,v90,v50,v66
v_fma_f32 v91,v91,v51,v67
v_fma_f32 v92,v92,v52,v68
v_fma_f32 v93,v93,v53,v69
v_fma_f32 v94,v94,v54,v70
v_fma_f32 v95,v95,v55,v71
v_cvt_pk_bf16_f32 v8,v80,v81
v_cvt_pk_bf16_f32 v9,v82,v83
v_cvt_pk_bf16_f32 v10,v84,v85
v_cvt_pk_bf16_f32 v11,v86,v87
v_cvt_pk_bf16_f32 v12,v88,v89
v_cvt_pk_bf16_f32 v13,v90,v91
v_cvt_pk_bf16_f32 v14,v92,v93
v_cvt_pk_bf16_f32 v15,v94,v95
s_waitcnt vmcnt(3)
v_add_u32 v22,s71,-1
buffer_store_dword v22,v23,s[24:27],s73 offen
buffer_store_dword v22,v23,s[28:31],s73 offen sc1
buffer_store_dwordx4 v[8:11],v24,s[20:23],s70 offen sc1
buffer_store_dwordx4 v[12:15],v25,s[20:23],s70 offen sc1
v_lshlrev_b32 v80,16,v8
v_and_b32 v81,s80,v8
v_lshlrev_b32 v82,16,v9
v_and_b32 v83,s80,v9
v_lshlrev_b32 v84,16,v10
v_and_b32 v85,s80,v10
v_lshlrev_b32 v86,16,v11
v_and_b32 v87,s80,v11
v_lshlrev_b32 v88,16,v12
v_and_b32 v89,s80,v12
v_lshlrev_b32 v90,16,v13
v_and_b32 v91,s80,v13
v_lshlrev_b32 v92,16,v14
v_and_b32 v93,s80,v14
v_lshlrev_b32 v94,16,v15
v_and_b32 v95,s80,v15
v_add_f32 v5,v80,v81
v_add_f32 v5,v5,v82
v_add_f32 v5,v5,v83
v_add_f32 v5,v5,v84
v_add_f32 v5,v5,v85
v_add_f32 v5,v5,v86
v_add_f32 v5,v5,v87
v_add_f32 v5,v5,v88
v_add_f32 v5,v5,v89
v_add_f32 v5,v5,v90
v_add_f32 v5,v5,v91
v_add_f32 v5,v5,v92
v_add_f32 v5,v5,v93
v_add_f32 v5,v5,v94
v_add_f32 v5,v5,v95
s_nop 1
v_add_f32_dpp v5,v5,v5 quad_perm:[1,0,3,2] row_mask:0xf bank_mask:0xf
s_nop 1
v_add_f32_dpp v5,v5,v5 quad_perm:[2,3,0,1] row_mask:0xf bank_mask:0xf
s_nop 1
v_add_f32_dpp v5,v5,v5 row_half_mirror row_mask:0xf bank_mask:0xf
s_nop 1
v_add_f32_dpp v5,v5,v5 row_mirror row_mask:0xf bank_mask:0xf
v_mov_b32 v7,v5
s_nop 1
v_permlane16_swap_b32 v7,v5
v_add_f32 v5,v5,v7
v_mov_b32 v7,v5
s_nop 1
v_permlane32_swap_b32 v7,v5
v_add_f32 v5,v5,v7
v_mul_f32 v5,0x3a800000,v5
v_sub_f32 v80,v80,v5
v_sub_f32 v81,v81,v5
v_sub_f32 v82,v82,v5
v_sub_f32 v83,v83,v5
v_sub_f32 v84,v84,v5
v_sub_f32 v85,v85,v5
v_sub_f32 v86,v86,v5
v_sub_f32 v87,v87,v5
v_sub_f32 v88,v88,v5
v_sub_f32 v89,v89,v5
v_sub_f32 v90,v90,v5
v_sub_f32 v91,v91,v5
v_sub_f32 v92,v92,v5
v_sub_f32 v93,v93,v5
v_sub_f32 v94,v94,v5
v_sub_f32 v95,v95,v5
v_mul_f32 v6,v80,v80
v_fmac_f32 v6,v81,v81
v_fmac_f32 v6,v82,v82
v_fmac_f32 v6,v83,v83
v_fmac_f32 v6,v84,v84
v_fmac_f32 v6,v85,v85
v_fmac_f32 v6,v86,v86
v_fmac_f32 v6,v87,v87
v_fmac_f32 v6,v88,v88
v_fmac_f32 v6,v89,v89
v_fmac_f32 v6,v90,v90
v_fmac_f32 v6,v91,v91
v_fmac_f32 v6,v92,v92
v_fmac_f32 v6,v93,v93
v_fmac_f32 v6,v94,v94
v_fmac_f32 v6,v95,v95
s_nop 1
v_add_f32_dpp v6,v6,v6 quad_perm:[1,0,3,2] row_mask:0xf bank_mask:0xf
s_nop 1
v_add_f32_dpp v6,v6,v6 quad_perm:[2,3,0,1] row_mask:0xf bank_mask:0xf
s_nop 1
v_add_f32_dpp v6,v6,v6 row_half_mirror row_mask:0xf bank_mask:0xf
s_nop 1
v_add_f32_dpp v6,v6,v6 row_mirror row_mask:0xf bank_mask:0xf
v_mov_b32 v7,v6
s_nop 1
v_permlane16_swap_b32 v7,v6
v_add_f32 v6,v6,v7
v_mov_b32 v7,v6
s_nop 1
v_permlane32_swap_b32 v7,v6
v_add_f32 v6,v6,v7
v_mov_b32 v7,0x3727c5ac
v_fmac_f32 v7,0x3a800000,v6
v_rsq_f32 v6,v7
s_nop 0
v_mul_f32 v80,v80,v6
v_mul_f32 v81,v81,v6
v_mul_f32 v82,v82,v6
v_mul_f32 v83,v83,v6
v_mul_f32 v84,v84,v6
v_mul_f32 v85,v85,v6
v_mul_f32 v86,v86,v6
v_mul_f32 v87,v87,v6
v_mul_f32 v88,v88,v6
v_mul_f32 v89,v89,v6
v_mul_f32 v90,v90,v6
v_mul_f32 v91,v91,v6
v_mul_f32 v92,v92,v6
v_mul_f32 v93,v93,v6
v_mul_f32 v94,v94,v6
v_mul_f32 v95,v95,v6
v_cvt_pk_bf16_f32 v72,v80,v81
v_cvt_pk_bf16_f32 v73,v82,v83
v_cvt_pk_bf16_f32 v74,v84,v85
v_cvt_pk_bf16_f32 v75,v86,v87
v_cvt_pk_bf16_f32 v76,v88,v89
v_cvt_pk_bf16_f32 v77,v90,v91
v_cvt_pk_bf16_f32 v78,v92,v93
v_cvt_pk_bf16_f32 v79,v94,v95
v_max_u32 v72,1,v72
v_max_u32 v76,1,v76
s_cmp_le_u32 s71,51
s_cbranch_scc1 lw_246
s_waitcnt vmcnt(0)
lw_246:
buffer_store_dwordx4 v[72:75],v19,s[20:23],s70 offen sc1
buffer_store_dwordx4 v[76:79],v19,s[20:23],s70 offen offset:1024 sc1
s_cmp_gt_u32 s71,51
s_cbranch_scc1 fnow_249
s_cmp_eq_u32 s83,0
s_cbranch_scc1 flater_250
s_waitcnt vmcnt(0)
fnow_249:
v_mov_b32 v22,s71
buffer_store_dword v22,v23,s[24:27],s73 offen
buffer_store_dword v22,v23,s[28:31],s73 offen sc1
flater_250:
s_mov_b32 s70,s75
s_add_u32 s79,s79,1
s_add_u32 s71,s71,1
s_cmp_lt_u32 s79,64
s_cbranch_scc1 lloop_242
s_endpgm
r_wo_193:
s_load_dwordx2 s[4:5],s[0:1],40
s_load_dwordx2 s[6:7],s[0:1],0
s_lshr_b32 s41,s59,3
s_and_b32 s42,s59,7
s_mul_i32 s66,s41,2097152
s_lshl_b32 s64,s42,8
s_add_u32 s66,s66,s64
s_lshl_b32 s67,s50,1
s_and_b32 s64,s41,1
s_add_u32 s67,s67,s64
s_waitcnt lgkmcnt(0)
s_mov_b32 s32,s4
s_and_b32 s33,s5,0xffff
s_mov_b32 s34,0x800000
s_mov_b32 s35,0x20000
s_mov_b32 s36,s6
s_and_b32 s37,s7,0xffff
s_mov_b32 s38,0x400000
s_mov_b32 s39,0x20000
v_lshrrev_b32 v5,2,v3
v_lshl_add_u32 v5,v4,2,v5
v_and_b32 v6,3,v3
v_lshlrev_b32 v6,3,v6
v_lshl_add_u32 v6,v5,8,v6
v_and_b32 v5,7,v5
v_xor_b32 v5,s67,v5
v_lshl_add_u32 v12,v5,5,v6
v_xor_b32 v13,32,v12
v_and_b32 v5,15,v1
v_and_b32 v6,3,v4
v_lshlrev_b32 v6,1,v6
v_xor_b32 v5,v5,v6
v_mul_u32_u24 v6,2048,v4
v_xor_b32 v7,0,v5
v_lshl_add_u32 v8,v7,4,v6
v_xor_b32 v7,8,v5
v_lshl_add_u32 v9,v7,4,v6
s_mul_i32 s74,s50,131072
s_add_u32 s74,s74,s66
s_lshl_b32 s75,s50,14
s_mul_i32 s76,s50,65536
s_add_u32 s76,s76,s66
s_lshl_b32 s77,s50,13
s_add_u32 s64,s74,0
s_add_u32 m0,s75,0
s_nop 0
buffer_load_dwordx4 v8,s[32:35],s64 offen nt lds
s_add_u32 s64,s74,8192
s_add_u32 m0,s75,1024
s_nop 0
buffer_load_dwordx4 v9,s[32:35],s64 offen nt lds
s_add_u32 s64,s74,16384
s_add_u32 m0,s75,2048
s_nop 0
buffer_load_dwordx4 v8,s[32:35],s64 offen nt lds
s_add_u32 s64,s74,24576
s_add_u32 m0,s75,3072
s_nop 0
buffer_load_dwordx4 v9,s[32:35],s64 offen nt lds
s_add_u32 s64,s74,32768
s_add_u32 m0,s75,4096
s_nop 0
buffer_load_dwordx4 v8,s[32:35],s64 offen nt lds
s_add_u32 s64,s74,40960
s_add_u32 m0,s75,5120
s_nop 0
buffer_load_dwordx4 v9,s[32:35],s64 offen nt lds
s_add_u32 s64,s74,49152
s_add_u32 m0,s75,6144
s_nop 0
buffer_load_dwordx4 v8,s[32:35],s64 offen nt lds
s_add_u32 s64,s74,57344
s_add_u32 m0,s75,7168
s_nop 0
buffer_load_dwordx4 v9,s[32:35],s64 offen nt lds
s_add_u32 s64,s74,65536
s_add_u32 m0,s75,8192
s_nop 0
buffer_load_dwordx4 v8,s[32:35],s64 offen nt lds
s_add_u32 s64,s74,73728
s_add_u32 m0,s75,9216
s_nop 0
buffer_load_dwordx4 v9,s[32:35],s64 offen nt lds
s_add_u32 s64,s74,81920
s_add_u32 m0,s75,10240
s_nop 0
buffer_load_dwordx4 v8,s[32:35],s64 offen nt lds
s_add_u32 s64,s74,90112
s_add_u32 m0,s75,11264
s_nop 0
buffer_load_dwordx4 v9,s[32:35],s64 offen nt lds
s_add_u32 s64,s74,98304
s_add_u32 m0,s75,12288
s_nop 0
buffer_load_dwordx4 v8,s[32:35],s64 offen nt lds
s_add_u32 s64,s74,106496
s_add_u32 m0,s75,13312
s_nop 0
buffer_load_dwordx4 v9,s[32:35],s64 offen nt lds
s_add_u32 s64,s74,114688
s_add_u32 m0,s75,14336
s_nop 0
buffer_load_dwordx4 v8,s[32:35],s64 offen nt lds
s_add_u32 s64,s74,122880
s_add_u32 m0,s75,15360
s_nop 0
buffer_load_dwordx4 v9,s[32:35],s64 offen nt lds
s_add_u32 s64,s74,524288
s_add_u32 m0,s75,65536
s_nop 0
buffer_load_dwordx4 v8,s[32:35],s64 offen nt lds
s_add_u32 s64,s74,532480
s_add_u32 m0,s75,66560
s_nop 0
buffer_load_dwordx4 v9,s[32:35],s64 offen nt lds
s_add_u32 s64,s74,540672
s_add_u32 m0,s75,67584
s_nop 0
buffer_load_dwordx4 v8,s[32:35],s64 offen nt lds
s_add_u32 s64,s74,548864
s_add_u32 m0,s75,68608
s_nop 0
buffer_load_dwordx4 v9,s[32:35],s64 offen nt lds
s_add_u32 s64,s74,557056
s_add_u32 m0,s75,69632
s_nop 0
buffer_load_dwordx4 v8,s[32:35],s64 offen nt lds
s_add_u32 s64,s74,565248
s_add_u32 m0,s75,70656
s_nop 0
buffer_load_dwordx4 v9,s[32:35],s64 offen nt lds
s_add_u32 s64,s74,573440
s_add_u32 m0,s75,71680
s_nop 0
buffer_load_dwordx4 v8,s[32:35],s64 offen nt lds
s_add_u32 s64,s74,581632
s_add_u32 m0,s75,72704
s_nop 0
buffer_load_dwordx4 v9,s[32:35],s64 offen nt lds
s_add_u32 s64,s74,589824
s_add_u32 m0,s75,73728
s_nop 0
buffer_load_dwordx4 v8,s[32:35],s64 offen nt lds
s_add_u32 s64,s74,598016
s_add_u32 m0,s75,74752
s_nop 0
buffer_load_dwordx4 v9,s[32:35],s64 offen nt lds
s_add_u32 s64,s74,606208
s_add_u32 m0,s75,75776
s_nop 0
buffer_load_dwordx4 v8,s[32:35],s64 offen nt lds
s_add_u32 s64,s74,614400
s_add_u32 m0,s75,76800
s_nop 0
buffer_load_dwordx4 v9,s[32:35],s64 offen nt lds
s_add_u32 s64,s74,622592
s_add_u32 m0,s75,77824
s_nop 0
buffer_load_dwordx4 v8,s[32:35],s64 offen nt lds
s_add_u32 s64,s74,630784
s_add_u32 m0,s75,78848
s_nop 0
buffer_load_dwordx4 v9,s[32:35],s64 offen nt lds
s_add_u32 s64,s74,638976
s_add_u32 m0,s75,79872
s_nop 0
buffer_load_dwordx4 v8,s[32:35],s64 offen nt lds
s_add_u32 s64,s74,647168
s_add_u32 m0,s75,80896
s_nop 0
buffer_load_dwordx4 v9,s[32:35],s64 offen nt lds
s_waitcnt vmcnt(16)
s_barrier
ds_read_b64_tr_b16 a[0:1],v12 offset:0
ds_read_b64_tr_b16 a[128:129],v13 offset:0
ds_read_b64_tr_b16 a[2:3],v12 offset:4096
ds_read_b64_tr_b16 a[130:131],v13 offset:4096
ds_read_b64_tr_b16 a[4:5],v12 offset:8192
ds_read_b64_tr_b16 a[132:133],v13 offset:8192
ds_read_b64_tr_b16 a[6:7],v12 offset:12288
ds_read_b64_tr_b16 a[134:135],v13 offset:12288
s_waitcnt lgkmcnt(4)
ds_read_b64_tr_b16 a[8:9],v12 offset:16384
ds_read_b64_tr_b16 a[136:137],v13 offset:16384
ds_read_b64_tr_b16 a[10:11],v12 offset:20480
ds_read_b64_tr_b16 a[138:139],v13 offset:20480
ds_read_b64_tr_b16 a[12:13],v12 offset:24576
ds_read_b64_tr_b16 a[140:141],v13 offset:24576
ds_read_b64_tr_b16 a[14:15],v12 offset:28672
ds_read_b64_tr_b16 a[142:143],v13 offset:28672
s_waitcnt lgkmcnt(4)
ds_read_b64_tr_b16 a[16:17],v12 offset:32768
ds_read_b64_tr_b16 a[144:145],v13 offset:32768
ds_read_b64_tr_b16 a[18:19],v12 offset:36864
ds_read_b64_tr_b16 a[146:147],v13 offset:36864
ds_read_b64_tr_b16 a[20:21],v12 offset:40960
ds_read_b64_tr_b16 a[148:149],v13 offset:40960
ds_read_b64_tr_b16 a[22:23],v12 offset:45056
ds_read_b64_tr_b16 a[150:151],v13 offset:45056
s_waitcnt lgkmcnt(4)
ds_read_b64_tr_b16 a[24:25],v12 offset:49152
ds_read_b64_tr_b16 a[152:153],v13 offset:49152
ds_read_b64_tr_b16 a[26:27],v12 offset:53248
ds_read_b64_tr_b16 a[154:155],v13 offset:53248
ds_read_b64_tr_b16 a[28:29],v12 offset:57344
ds_read_b64_tr_b16 a[156:157],v13 offset:57344
ds_read_b64_tr_b16 a[30:31],v12 offset:61440
ds_read_b64_tr_b16 a[158:159],v13 offset:61440
s_waitcnt lgkmcnt(4)
v_xor_b32 v12,0x10000,v12
v_xor_b32 v13,0x10000,v13
s_waitcnt lgkmcnt(0)
s_barrier
s_add_u32 s64,s74,1048576
s_add_u32 m0,s75,0
s_nop 0
buffer_load_dwordx4 v8,s[32:35],s64 offen nt lds
s_add_u32 s64,s74,1056768
s_add_u32 m0,s75,1024
s_nop 0
buffer_load_dwordx4 v9,s[32:35],s64 offen nt lds
s_add_u32 s64,s74,1064960
s_add_u32 m0,s75,2048
s_nop 0
buffer_load_dwordx4 v8,s[32:35],s64 offen nt lds
s_add_u32 s64,s74,1073152
s_add_u32 m0,s75,3072
s_nop 0
buffer_load_dwordx4 v9,s[32:35],s64 offen nt lds
s_add_u32 s64,s74,1081344
s_add_u32 m0,s75,4096
s_nop 0
buffer_load_dwordx4 v8,s[32:35],s64 offen nt lds
s_add_u32 s64,s74,1089536
s_add_u32 m0,s75,5120
s_nop 0
buffer_load_dwordx4 v9,s[32:35],s64 offen nt lds
s_add_u32 s64,s74,1097728
s_add_u32 m0,s75,6144
s_nop 0
buffer_load_dwordx4 v8,s[32:35],s64 offen nt lds
s_add_u32 s64,s74,1105920
s_add_u32 m0,s75,7168
s_nop 0
buffer_load_dwordx4 v9,s[32:35],s64 offen nt lds
s_add_u32 s64,s74,1114112
s_add_u32 m0,s75,8192
s_nop 0
buffer_load_dwordx4 v8,s[32:35],s64 offen nt lds
s_add_u32 s64,s74,1122304
s_add_u32 m0,s75,9216
s_nop 0
buffer_load_dwordx4 v9,s[32:35],s64 offen nt lds
s_add_u32 s64,s74,1130496
s_add_u32 m0,s75,10240
s_nop 0
buffer_load_dwordx4 v8,s[32:35],s64 offen nt lds
s_add_u32 s64,s74,1138688
s_add_u32 m0,s75,11264
s_nop 0
buffer_load_dwordx4 v9,s[32:35],s64 offen nt lds
s_add_u32 s64,s74,1146880
s_add_u32 m0,s75,12288
s_nop 0
buffer_load_dwordx4 v8,s[32:35],s64 offen nt lds
s_add_u32 s64,s74,1155072
s_add_u32 m0,s75,13312
s_nop 0
buffer_load_dwordx4 v9,s[32:35],s64 offen nt lds
s_add_u32 s64,s74,1163264
s_add_u32 m0,s75,14336
s_nop 0
buffer_load_dwordx4 v8,s[32:35],s64 offen nt lds
s_add_u32 s64,s74,1171456
s_add_u32 m0,s75,15360
s_nop 0
buffer_load_dwordx4 v9,s[32:35],s64 offen nt lds
s_waitcnt vmcnt(16)
s_barrier
ds_read_b64_tr_b16 a[32:33],v12 offset:0
ds_read_b64_tr_b16 a[160:161],v13 offset:0
ds_read_b64_tr_b16 a[34:35],v12 offset:4096
ds_read_b64_tr_b16 a[162:163],v13 offset:4096
ds_read_b64_tr_b16 a[36:37],v12 offset:8192
ds_read_b64_tr_b16 a[164:165],v13 offset:8192
ds_read_b64_tr_b16 a[38:39],v12 offset:12288
ds_read_b64_tr_b16 a[166:167],v13 offset:12288
s_waitcnt lgkmcnt(4)
ds_read_b64_tr_b16 a[40:41],v12 offset:16384
ds_read_b64_tr_b16 a[168:169],v13 offset:16384
ds_read_b64_tr_b16 a[42:43],v12 offset:20480
ds_read_b64_tr_b16 a[170:171],v13 offset:20480
ds_read_b64_tr_b16 a[44:45],v12 offset:24576
ds_read_b64_tr_b16 a[172:173],v13 offset:24576
ds_read_b64_tr_b16 a[46:47],v12 offset:28672
ds_read_b64_tr_b16 a[174:175],v13 offset:28672
s_waitcnt lgkmcnt(4)
ds_read_b64_tr_b16 a[48:49],v12 offset:32768
ds_read_b64_tr_b16 a[176:177],v13 offset:32768
ds_read_b64_tr_b16 a[50:51],v12 offset:36864
ds_read_b64_tr_b16 a[178:179],v13 offset:36864
ds_read_b64_tr_b16 a[52:53],v12 offset:40960
ds_read_b64_tr_b16 a[180:181],v13 offset:40960
ds_read_b64_tr_b16 a[54:55],v12 offset:45056
ds_read_b64_tr_b16 a[182:183],v13 offset:45056
s_waitcnt lgkmcnt(4)
ds_read_b64_tr_b16 a[56:57],v12 offset:49152
ds_read_b64_tr_b16 a[184:185],v13 offset:49152
ds_read_b64_tr_b16 a[58:59],v12 offset:53248
ds_read_b64_tr_b16 a[186:187],v13 offset:53248
ds_read_b64_tr_b16 a[60:61],v12 offset:57344
ds_read_b64_tr_b16 a[188:189],v13 offset:57344
ds_read_b64_tr_b16 a[62:63],v12 offset:61440
ds_read_b64_tr_b16 a[190:191],v13 offset:61440
s_waitcnt lgkmcnt(4)
v_xor_b32 v12,0x10000,v12
v_xor_b32 v13,0x10000,v13
s_waitcnt lgkmcnt(0)
s_barrier
s_add_u32 s64,s74,1572864
s_add_u32 m0,s75,65536
s_nop 0
buffer_load_dwordx4 v8,s[32:35],s64 offen nt lds
s_add_u32 s64,s74,1581056
s_add_u32 m0,s75,66560
s_nop 0
buffer_load_dwordx4 v9,s[32:35],s64 offen nt lds
s_add_u32 s64,s74,1589248
s_add_u32 m0,s75,67584
s_nop 0
buffer_load_dwordx4 v8,s[32:35],s64 offen nt lds
s_add_u32 s64,s74,1597440
s_add_u32 m0,s75,68608
s_nop 0
buffer_load_dwordx4 v9,s[32:35],s64 offen nt lds
s_add_u32 s64,s74,1605632
s_add_u32 m0,s75,69632
s_nop 0
buffer_load_dwordx4 v8,s[32:35],s64 offen nt lds
s_add_u32 s64,s74,1613824
s_add_u32 m0,s75,70656
s_nop 0
buffer_load_dwordx4 v9,s[32:35],s64 offen nt lds
s_add_u32 s64,s74,1622016
s_add_u32 m0,s75,71680
s_nop 0
buffer_load_dwordx4 v8,s[32:35],s64 offen nt lds
s_add_u32 s64,s74,1630208
s_add_u32 m0,s75,72704
s_nop 0
buffer_load_dwordx4 v9,s[32:35],s64 offen nt lds
s_add_u32 s64,s74,1638400
s_add_u32 m0,s75,73728
s_nop 0
buffer_load_dwordx4 v8,s[32:35],s64 offen nt lds
s_add_u32 s64,s74,1646592
s_add_u32 m0,s75,74752
s_nop 0
buffer_load_dwordx4 v9,s[32:35],s64 offen nt lds
s_add_u32 s64,s74,1654784
s_add_u32 m0,s75,75776
s_nop 0
buffer_load_dwordx4 v8,s[32:35],s64 offen nt lds
s_add_u32 s64,s74,1662976
s_add_u32 m0,s75,76800
s_nop 0
buffer_load_dwordx4 v9,s[32:35],s64 offen nt lds
s_add_u32 s64,s74,1671168
s_add_u32 m0,s75,77824
s_nop 0
buffer_load_dwordx4 v8,s[32:35],s64 offen nt lds
s_add_u32 s64,s74,1679360
s_add_u32 m0,s75,78848
s_nop 0
buffer_load_dwordx4 v9,s[32:35],s64 offen nt lds
s_add_u32 s64,s74,1687552
s_add_u32 m0,s75,79872
s_nop 0
buffer_load_dwordx4 v8,s[32:35],s64 offen nt lds
s_add_u32 s64,s74,1695744
s_add_u32 m0,s75,80896
s_nop 0
buffer_load_dwordx4 v9,s[32:35],s64 offen nt lds
s_waitcnt vmcnt(16)
s_barrier
ds_read_b64_tr_b16 a[64:65],v12 offset:0
ds_read_b64_tr_b16 a[192:193],v13 offset:0
ds_read_b64_tr_b16 a[66:67],v12 offset:4096
ds_read_b64_tr_b16 a[194:195],v13 offset:4096
ds_read_b64_tr_b16 a[68:69],v12 offset:8192
ds_read_b64_tr_b16 a[196:197],v13 offset:8192
ds_read_b64_tr_b16 a[70:71],v12 offset:12288
ds_read_b64_tr_b16 a[198:199],v13 offset:12288
s_waitcnt lgkmcnt(4)
ds_read_b64_tr_b16 a[72:73],v12 offset:16384
ds_read_b64_tr_b16 a[200:201],v13 offset:16384
ds_read_b64_tr_b16 a[74:75],v12 offset:20480
ds_read_b64_tr_b16 a[202:203],v13 offset:20480
ds_read_b64_tr_b16 a[76:77],v12 offset:24576
ds_read_b64_tr_b16 a[204:205],v13 offset:24576
ds_read_b64_tr_b16 a[78:79],v12 offset:28672
ds_read_b64_tr_b16 a[206:207],v13 offset:28672
s_waitcnt lgkmcnt(4)
ds_read_b64_tr_b16 a[80:81],v12 offset:32768
ds_read_b64_tr_b16 a[208:209],v13 offset:32768
ds_read_b64_tr_b16 a[82:83],v12 offset:36864
ds_read_b64_tr_b16 a[210:211],v13 offset:36864
ds_read_b64_tr_b16 a[84:85],v12 offset:40960
ds_read_b64_tr_b16 a[212:213],v13 offset:40960
ds_read_b64_tr_b16 a[86:87],v12 offset:45056
ds_read_b64_tr_b16 a[214:215],v13 offset:45056
s_waitcnt lgkmcnt(4)
ds_read_b64_tr_b16 a[88:89],v12 offset:49152
ds_read_b64_tr_b16 a[216:217],v13 offset:49152
ds_read_b64_tr_b16 a[90:91],v12 offset:53248
ds_read_b64_tr_b16 a[218:219],v13 offset:53248
ds_read_b64_tr_b16 a[92:93],v12 offset:57344
ds_read_b64_tr_b16 a[220:221],v13 offset:57344
ds_read_b64_tr_b16 a[94:95],v12 offset:61440
ds_read_b64_tr_b16 a[222:223],v13 offset:61440
s_waitcnt lgkmcnt(4)
v_xor_b32 v12,0x10000,v12
v_xor_b32 v13,0x10000,v13
s_waitcnt lgkmcnt(0)
s_barrier
s_waitcnt vmcnt(0)
s_barrier
ds_read_b64_tr_b16 a[96:97],v12 offset:0
ds_read_b64_tr_b16 a[224:225],v13 offset:0
ds_read_b64_tr_b16 a[98:99],v12 offset:4096
ds_read_b64_tr_b16 a[226:227],v13 offset:4096
ds_read_b64_tr_b16 a[100:101],v12 offset:8192
ds_read_b64_tr_b16 a[228:229],v13 offset:8192
ds_read_b64_tr_b16 a[102:103],v12 offset:12288
ds_read_b64_tr_b16 a[230:231],v13 offset:12288
s_waitcnt lgkmcnt(4)
ds_read_b64_tr_b16 a[104:105],v12 offset:16384
ds_read_b64_tr_b16 a[232:233],v13 offset:16384
ds_read_b64_tr_b16 a[106:107],v12 offset:20480
ds_read_b64_tr_b16 a[234:235],v13 offset:20480
ds_read_b64_tr_b16 a[108:109],v12 offset:24576
ds_read_b64_tr_b16 a[236:237],v13 offset:24576
ds_read_b64_tr_b16 a[110:111],v12 offset:28672
ds_read_b64_tr_b16 a[238:239],v13 offset:28672
s_waitcnt lgkmcnt(4)
ds_read_b64_tr_b16 a[112:113],v12 offset:32768
ds_read_b64_tr_b16 a[240:241],v13 offset:32768
ds_read_b64_tr_b16 a[114:115],v12 offset:36864
ds_read_b64_tr_b16 a[242:243],v13 offset:36864
ds_read_b64_tr_b16 a[116:117],v12 offset:40960
ds_read_b64_tr_b16 a[244:245],v13 offset:40960
ds_read_b64_tr_b16 a[118:119],v12 offset:45056
ds_read_b64_tr_b16 a[246:247],v13 offset:45056
s_waitcnt lgkmcnt(4)
ds_read_b64_tr_b16 a[120:121],v12 offset:49152
ds_read_b64_tr_b16 a[248:249],v13 offset:49152
ds_read_b64_tr_b16 a[122:123],v12 offset:53248
ds_read_b64_tr_b16 a[250:251],v13 offset:53248
ds_read_b64_tr_b16 a[124:125],v12 offset:57344
ds_read_b64_tr_b16 a[252:253],v13 offset:57344
ds_read_b64_tr_b16 a[126:127],v12 offset:61440
ds_read_b64_tr_b16 a[254:255],v13 offset:61440
s_waitcnt lgkmcnt(4)
v_xor_b32 v12,0x10000,v12
v_xor_b32 v13,0x10000,v13
s_waitcnt lgkmcnt(0)
s_barrier
v_and_b32 v21,1,v1
v_mul_u32_u24 v21,960,v21
s_mov_b32 s65,21052032
s_mov_b32 s66,1792
pl_251:
buffer_load_dword v22,v21,s[20:23],s65 offen sc1
s_waitcnt vmcnt(0)
v_cmp_gt_u32 vcc,s66,v22
s_cbranch_vccz pok_252
s_sleep 1
s_sub_u32 s90,s90,1
s_cmp_gt_i32 s90,0
s_cbranch_scc1 pl_251
pok_252:
s_lshr_b32 s43,s41,1
s_and_b32 s48,s41,1
s_lshl_b32 s64,s42,7
s_lshl_b32 s65,s50,5
s_add_u32 s64,s64,s65
s_lshl_b32 s65,s48,4
s_add_u32 s64,s64,s65
v_lshl_add_u32 v5,v4,2,s64
v_lshlrev_b32 v6,2,v5
s_mov_b32 s64,8192
buffer_load_dwordx4 v[52:55],v6,s[20:23],s64 offen sc1
v_lshlrev_b32 v10,1,v5
v_and_b32 v6,3,v1
v_sub_u32 v5,v6,v4
v_lshl_add_u32 v5,v5,3,v10
v_lshrrev_b32 v11,2,v1
v_lshl_add_u32 v40,v6,4,v11
v_lshlrev_b32 v40,2,v40
v_lshl_add_u32 v41,v3,2,v4
v_lshlrev_b32 v41,2,v41
s_lshl_b32 s64,s43,10
v_add_u32 v17,s64,v16
v_xor_b32 v18,1024,v17
s_xor_b32 s64,s64,1024
s_lshr_b32 s65,s50,1
s_and_b32 s66,s50,1
s_lshl_b32 s66,s66,12
s_add_u32 s66,s66,s64
s_lshl_b32 s72,s65,13
s_add_u32 s72,s72,s66
s_add_u32 s72,s72,0x10000
s_lshl_b32 s65,s65,14
s_add_u32 s75,s65,s66
s_add_u32 s75,s75,524288
s_mul_i32 s64,s41,131072
s_add_u32 s75,s75,s64
s_cmp_lt_u32 s50,2
s_cselect_b32 s86,98304,0x40000000
s_lshl_b32 s76,s79,21
s_add_u32 s76,s76,27262976
s_mov_b32 s77,0
s_lshl_b32 s78,s79,16
s_mov_b32 s49,0
s_cmp_eq_u32 s79,0
s_mov_b32 s66,8577024
s_cselect_b32 s66,17825792,s66
s_lshl_b32 s64,s59,14
s_lshl_b32 s65,s50,12
s_add_u32 s65,s65,s66
s_add_u32 s64,s64,s65
v_add_u32 v26,s64,v16
s_lshl_b32 s64,s42,14
s_add_u32 s64,s64,s65
v_add_u32 v25,s64,v16
s_xor_b32 s33,s41,1
s_xor_b32 s34,s41,2
s_xor_b32 s35,s41,3
s_lshl_b32 s33,s33,17
s_lshl_b32 s34,s34,17
s_lshl_b32 s35,s35,17
v_and_b32 v21,7,v1
v_lshlrev_b32 v21,7,v21
v_bfe_u32 v6,v1,3,0
v_lshl_add_u32 v21,v6,2,v21
s_lshl_b32 s74,s41,10
s_add_u32 s74,s74,s63
s_lshl_b32 s64,s60,4
s_add_u32 s74,s74,s64
s_add_u32 s74,s74,16384
v_lshrrev_b32 v6,2,v11
v_and_b32 v7,3,v11
v_lshl_add_u32 v6,v6,1,s43
v_lshl_add_u32 v8,v6,2,v7
v_lshl_add_u32 v8,v8,7,v5
v_and_b32 v8,2047,v8
v_lshl_add_u32 v8,v7,11,v8
v_lshl_add_u32 v7,v7,11,v5
v_lshl_add_u32 v20,v6,13,v7
v_lshl_add_u32 v19,v6,14,v8
v_add_u32 v19,1048576,v19
s_lshl_b32 s73,s59,2
s_add_u32 s73,s73,s50
s_lshl_b32 s73,s73,2
s_add_u32 s73,s73,s63
s_add_u32 s73,s73,2048
s_mov_b32 s48,1
s_waitcnt vmcnt(0)
s_cmp_lg_u32 s56,0
s_cbranch_scc1 kslow_253
s_add_u32 s64,s79,0
s_lshl_b32 s70,s64,21
s_lshl_b32 s64,s64,13
s_and_b32 s64,s64,0x2000
s_xor_b32 s64,s64,s62
s_add_u32 s70,s70,s64
s_add_u32 s70,s70,29360128
s_mov_b32 s83,1
s_mov_b32 s87,s74
s_cmp_eq_u32 s50,0
s_cselect_b32 s74,s74,0x7fff0000
v_mov_b32 v45,132096
s_lshl_b32 s64,s50,2
s_add_u32 s64,s64,132112
v_mov_b32 v46,s64
v_mov_b32 v2,0
v_mov_b32 v44,1
ds_write_b32 v45,v44
s_mov_b32 s97,0x7fff0000
s_waitcnt lgkmcnt(0)
seg_255:
s_cmp_eq_u32 s83,0
s_cbranch_scc1 ahead_256
s_add_u32 s94,s70,s75
s_xor_b32 s95,s94,1024
s_xor_b32 s91,s72,0x10000
s_waitcnt lgkmcnt(0)
v_cmp_gt_u32 vcc,s71,v2
s_cbranch_vccz nb_259
s_waitcnt vmcnt(2)
v_cmp_gt_u32 vcc,s71,v29
s_cbranch_vccz nb_259
s_waitcnt vmcnt(0)
v_add_u32 v22,s71,-1
buffer_store_dword v22,v23,s[20:23],s97 offen sc1
s_mov_b32 s97,0x7fff0000
s_cmp_lg_u32 s50,0
s_cbranch_scc1 nb_259
buffer_load_dword v32,v21,s[20:23],s74 offen sc1
s_sleep 2
pl_260:
buffer_load_dword v33,v21,s[20:23],s74 offen sc1
s_waitcnt vmcnt(1)
v_cmp_gt_u32 vcc,s71,v32
s_cbranch_vccz pok_261
buffer_load_dword v32,v21,s[20:23],s74 offen sc1
s_waitcnt vmcnt(1)
v_cmp_gt_u32 vcc,s71,v33
s_cbranch_vccz pok_261
s_sub_u32 s90,s90,1
s_cmp_gt_i32 s90,0
s_cbranch_scc1 pl_260
pok_261:
nb_259:
s_barrier
s_xor_b32 m0,s91,0
s_add_u32 s65,s94,0
buffer_load_dwordx4 v16,s[20:23],s65 offen offset:0 sc1 lds
buffer_load_dwordx4 v16,s[20:23],s65 offen offset:2048 sc1 lds
ds_read_b32 v44,v45
s_xor_b32 m0,s91,16384
s_add_u32 s65,s94,32768
buffer_load_dwordx4 v16,s[20:23],s65 offen offset:0 sc1 lds
buffer_load_dwordx4 v16,s[20:23],s65 offen offset:2048 sc1 lds
s_xor_b32 m0,s91,32768
s_add_u32 s65,s94,65536
buffer_load_dwordx4 v16,s[20:23],s65 offen offset:0 sc1 lds
buffer_load_dwordx4 v16,s[20:23],s65 offen offset:2048 sc1 lds
s_xor_b32 m0,s91,49152
s_add_u32 s65,s94,98304
buffer_load_dwordx4 v16,s[20:23],s65 offen offset:0 sc1 lds
buffer_load_dwordx4 v16,s[20:23],s65 offen offset:2048 sc1 lds
s_xor_b32 m0,s91,1024
s_add_u32 s65,s95,0
buffer_load_dwordx4 v16,s[20:23],s65 offen offset:0 sc1 lds
buffer_load_dwordx4 v16,s[20:23],s65 offen offset:2048 sc1 lds
s_waitcnt vmcnt(10)
v_add_u32 v22,s71,-1
buffer_store_dword v22,v23,s[20:23],s97 offen sc1
s_mov_b32 s97,0x7fff0000
s_waitcnt lgkmcnt(0)
v_readfirstlane_b32 s83,v44
s_cmp_eq_u32 s83,0
s_cbranch_scc1 both_258
s_waitcnt vmcnt(9)
s_barrier
ds_read_b128 v[224:227],v18 offset:0
ds_read_b128 v[228:231],v18 offset:2048
ds_read_b128 v[232:235],v18 offset:4096
ds_read_b128 v[236:239],v18 offset:6144
ds_read_b128 v[240:243],v18 offset:8192
ds_read_b128 v[244:247],v18 offset:10240
ds_read_b128 v[248:251],v18 offset:12288
s_waitcnt lgkmcnt(5)
v_mfma_f32_16x16x32_bf16 v[64:67],a[0:3],v[224:227],0
v_min_u32 v27,v224,v228
s_xor_b32 m0,s91,17408
v_mfma_f32_16x16x32_bf16 v[68:71],a[128:131],v[224:227],0
ds_read_b128 v[252:255],v18 offset:14336
v_mfma_f32_16x16x32_bf16 v[64:67],a[4:7],v[228:231],v[64:67]
s_add_u32 s65,s95,32768
v_mfma_f32_16x16x32_bf16 v[68:71],a[132:135],v[228:231],v[68:71]
s_waitcnt vmcnt(7)
s_barrier
ds_read_b128 v[224:227],v18 offset:16384
s_waitcnt lgkmcnt(5)
v_mfma_f32_16x16x32_bf16 v[64:67],a[8:11],v[232:235],v[64:67]
v_min3_u32 v27,v27,v232,v236
buffer_load_dwordx4 v16,s[20:23],s65 offen offset:0 sc1 lds
v_mfma_f32_16x16x32_bf16 v[68:71],a[136:139],v[232:235],v[68:71]
ds_read_b128 v[228:231],v18 offset:18432
v_mfma_f32_16x16x32_bf16 v[64:67],a[12:15],v[236:239],v[64:67]
buffer_load_dwordx4 v16,s[20:23],s65 offen offset:2048 sc1 lds
v_mfma_f32_16x16x32_bf16 v[68:71],a[140:143],v[236:239],v[68:71]
ds_read_b128 v[232:235],v18 offset:20480
s_waitcnt lgkmcnt(5)
v_mfma_f32_16x16x32_bf16 v[64:67],a[16:19],v[240:243],v[64:67]
v_min3_u32 v27,v27,v240,v244
s_xor_b32 m0,s91,33792
v_mfma_f32_16x16x32_bf16 v[68:71],a[144:147],v[240:243],v[68:71]
ds_read_b128 v[236:239],v18 offset:22528
v_mfma_f32_16x16x32_bf16 v[64:67],a[20:23],v[244:247],v[64:67]
s_add_u32 s65,s95,65536
v_mfma_f32_16x16x32_bf16 v[68:71],a[148:151],v[244:247],v[68:71]
ds_read_b128 v[240:243],v18 offset:24576
s_waitcnt lgkmcnt(5)
v_mfma_f32_16x16x32_bf16 v[64:67],a[24:27],v[248:251],v[64:67]
v_min3_u32 v27,v27,v248,v252
buffer_load_dwordx4 v16,s[20:23],s65 offen offset:0 sc1 lds
v_mfma_f32_16x16x32_bf16 v[68:71],a[152:155],v[248:251],v[68:71]
ds_read_b128 v[244:247],v18 offset:26624
v_mfma_f32_16x16x32_bf16 v[64:67],a[28:31],v[252:255],v[64:67]
buffer_load_dwordx4 v16,s[20:23],s65 offen offset:2048 sc1 lds
v_mfma_f32_16x16x32_bf16 v[68:71],a[156:159],v[252:255],v[68:71]
ds_read_b128 v[248:251],v18 offset:28672
s_waitcnt lgkmcnt(5)
v_mfma_f32_16x16x32_bf16 v[64:67],a[32:35],v[224:227],v[64:67]
v_min3_u32 v27,v27,v224,v228
s_xor_b32 m0,s91,50176
v_mfma_f32_16x16x32_bf16 v[68:71],a[160:163],v[224:227],v[68:71]
ds_read_b128 v[252:255],v18 offset:30720
v_mfma_f32_16x16x32_bf16 v[64:67],a[36:39],v[228:231],v[64:67]
s_add_u32 s65,s95,98304
v_mfma_f32_16x16x32_bf16 v[68:71],a[164:167],v[228:231],v[68:71]
s_waitcnt vmcnt(7)
s_barrier
ds_read_b128 v[224:227],v18 offset:32768
s_waitcnt lgkmcnt(5)
v_mfma_f32_16x16x32_bf16 v[64:67],a[40:43],v[232:235],v[64:67]
v_min3_u32 v27,v27,v232,v236
buffer_load_dwordx4 v16,s[20:23],s65 offen offset:0 sc1 lds
v_mfma_f32_16x16x32_bf16 v[68:71],a[168:171],v[232:235],v[68:71]
ds_read_b128 v[228:231],v18 offset:34816
v_mfma_f32_16x16x32_bf16 v[64:67],a[44:47],v[236:239],v[64:67]
buffer_load_dwordx4 v16,s[20:23],s65 offen offset:2048 sc1 lds
v_mfma_f32_16x16x32_bf16 v[68:71],a[172:175],v[236:239],v[68:71]
ds_read_b128 v[232:235],v18 offset:36864
s_waitcnt lgkmcnt(5)
v_mfma_f32_16x16x32_bf16 v[64:67],a[48:51],v[240:243],v[64:67]
v_min3_u32 v27,v27,v240,v244
v_mfma_f32_16x16x32_bf16 v[68:71],a[176:179],v[240:243],v[68:71]
ds_read_b128 v[236:239],v18 offset:38912
v_mfma_f32_16x16x32_bf16 v[64:67],a[52:55],v[244:247],v[64:67]
buffer_load_dwordx2 v[120:121],v20,s[36:39],s78 offen
v_mfma_f32_16x16x32_bf16 v[68:71],a[180:183],v[244:247],v[68:71]
ds_read_b128 v[240:243],v18 offset:40960
s_waitcnt lgkmcnt(5)
v_mfma_f32_16x16x32_bf16 v[64:67],a[56:59],v[248:251],v[64:67]
v_min3_u32 v27,v27,v248,v252
v_mfma_f32_16x16x32_bf16 v[68:71],a[184:187],v[248:251],v[68:71]
ds_read_b128 v[244:247],v18 offset:43008
v_mfma_f32_16x16x32_bf16 v[64:67],a[60:63],v[252:255],v[64:67]
v_mfma_f32_16x16x32_bf16 v[68:71],a[188:191],v[252:255],v[68:71]
ds_read_b128 v[248:251],v18 offset:45056
s_waitcnt lgkmcnt(5)
v_mfma_f32_16x16x32_bf16 v[64:67],a[64:67],v[224:227],v[64:67]
v_min3_u32 v27,v27,v224,v228
v_mfma_f32_16x16x32_bf16 v[68:71],a[192:195],v[224:227],v[68:71]
ds_read_b128 v[252:255],v18 offset:47104
v_mfma_f32_16x16x32_bf16 v[64:67],a[68:71],v[228:231],v[64:67]
v_mfma_f32_16x16x32_bf16 v[68:71],a[196:199],v[228:231],v[68:71]
ds_read_b128 v[224:227],v18 offset:49152
s_waitcnt lgkmcnt(5)
v_mfma_f32_16x16x32_bf16 v[64:67],a[72:75],v[232:235],v[64:67]
v_min3_u32 v27,v27,v232,v236
v_mfma_f32_16x16x32_bf16 v[68:71],a[200:203],v[232:235],v[68:71]
ds_read_b128 v[228:231],v18 offset:51200
v_mfma_f32_16x16x32_bf16 v[64:67],a[76:79],v[236:239],v[64:67]
v_mfma_f32_16x16x32_bf16 v[68:71],a[204:207],v[236:239],v[68:71]
ds_read_b128 v[232:235],v18 offset:53248
s_waitcnt lgkmcnt(5)
v_mfma_f32_16x16x32_bf16 v[64:67],a[80:83],v[240:243],v[64:67]
s_waitcnt vmcnt(5)
s_barrier
ds_read_b128 v[128:131],v17 offset:0
ds_read_b128 v[132:135],v17 offset:2048
v_mfma_f32_16x16x32_bf16 v[68:71],a[208:211],v[240:243],v[68:71]
ds_read_b128 v[236:239],v18 offset:55296
v_min3_u32 v27,v27,v240,v244
v_mfma_f32_16x16x32_bf16 v[64:67],a[84:87],v[244:247],v[64:67]
ds_read_b128 v[136:139],v17 offset:4096
v_mfma_f32_16x16x32_bf16 v[68:71],a[212:215],v[244:247],v[68:71]
ds_read_b128 v[240:243],v18 offset:57344
s_waitcnt lgkmcnt(8)
v_mfma_f32_16x16x32_bf16 v[64:67],a[88:91],v[248:251],v[64:67]
ds_read_b128 v[140:143],v17 offset:6144
v_min3_u32 v27,v27,v248,v252
v_mfma_f32_16x16x32_bf16 v[68:71],a[216:219],v[248:251],v[68:71]
ds_read_b128 v[244:247],v18 offset:59392
v_mfma_f32_16x16x32_bf16 v[64:67],a[92:95],v[252:255],v[64:67]
ds_read_b128 v[144:147],v17 offset:8192
ds_read_b128 v[148:151],v17 offset:10240
v_mfma_f32_16x16x32_bf16 v[68:71],a[220:223],v[252:255],v[68:71]
ds_read_b128 v[248:251],v18 offset:61440
s_waitcnt lgkmcnt(11)
v_mfma_f32_16x16x32_bf16 v[64:67],a[96:99],v[224:227],v[64:67]
ds_read_b128 v[152:155],v17 offset:12288
v_min3_u32 v27,v27,v224,v228
v_mfma_f32_16x16x32_bf16 v[68:71],a[224:227],v[224:227],v[68:71]
ds_read_b128 v[252:255],v18 offset:63488
v_mfma_f32_16x16x32_bf16 v[64:67],a[100:103],v[228:231],v[64:67]
ds_read_b128 v[156:159],v17 offset:14336
v_mfma_f32_16x16x32_bf16 v[68:71],a[228:231],v[228:231],v[68:71]
s_waitcnt lgkmcnt(10)
v_mfma_f32_16x16x32_bf16 v[64:67],a[104:107],v[232:235],v[64:67]
ds_read_b128 v[160:163],v17 offset:16384
ds_read_b128 v[164:167],v17 offset:18432
v_mfma_f32_16x16x32_bf16 v[68:71],a[232:235],v[232:235],v[68:71]
v_min3_u32 v27,v27,v232,v236
v_mfma_f32_16x16x32_bf16 v[64:67],a[108:111],v[236:239],v[64:67]
ds_read_b128 v[168:171],v17 offset:20480
v_mfma_f32_16x16x32_bf16 v[68:71],a[236:239],v[236:239],v[68:71]
s_waitcnt lgkmcnt(9)
v_mfma_f32_16x16x32_bf16 v[64:67],a[112:115],v[240:243],v[64:67]
ds_read_b128 v[172:175],v17 offset:22528
v_min3_u32 v27,v27,v240,v244
v_mfma_f32_16x16x32_bf16 v[68:71],a[240:243],v[240:243],v[68:71]
v_mfma_f32_16x16x32_bf16 v[64:67],a[116:119],v[244:247],v[64:67]
ds_read_b128 v[176:179],v17 offset:24576
ds_read_b128 v[180:183],v17 offset:26624
v_mfma_f32_16x16x32_bf16 v[68:71],a[244:247],v[244:247],v[68:71]
s_waitcnt lgkmcnt(7)
v_mfma_f32_16x16x32_bf16 v[64:67],a[120:123],v[248:251],v[64:67]
ds_read_b128 v[184:187],v17 offset:28672
v_min3_u32 v27,v27,v248,v252
v_mfma_f32_16x16x32_bf16 v[68:71],a[248:251],v[248:251],v[68:71]
v_mfma_f32_16x16x32_bf16 v[64:67],a[124:127],v[252:255],v[64:67]
ds_read_b128 v[188:191],v17 offset:30720
buffer_load_dword v2,v21,s[20:23],s87 offen sc1
v_mfma_f32_16x16x32_bf16 v[68:71],a[252:255],v[252:255],v[68:71]
s_add_u32 s96,s71,2
v_mfma_f32_16x16x32_bf16 v[72:75],a[128:131],v[128:131],0
v_cmp_eq_u32 vcc,0,v27
s_cbranch_vccnz retry_254
v_mfma_f32_16x16x32_bf16 v[76:79],a[132:135],v[132:135],0
v_min3_u32 v27,v27,v128,v132
v_mfma_f32_16x16x32_bf16 v[72:75],a[136:139],v[136:139],v[72:75]
s_waitcnt vmcnt(2)
s_barrier
ds_read_b128 v[192:195],v17 offset:32768
v_mfma_f32_16x16x32_bf16 v[76:79],a[140:143],v[140:143],v[76:79]
ds_read_b128 v[196:199],v17 offset:34816
s_waitcnt lgkmcnt(10)
v_mfma_f32_16x16x32_bf16 v[72:75],a[144:147],v[144:147],v[72:75]
ds_read_b128 v[200:203],v17 offset:36864
v_min3_u32 v27,v27,v136,v140
s_waitcnt vmcnt(1)
v_mfma_f32_16x16x32_bf16 v[76:79],a[148:151],v[148:151],v[76:79]
ds_read_b128 v[204:207],v17 offset:38912
v_min3_u32 v27,v27,v144,v148
v_and_or_b32 v64,v64,-4,s48
v_mfma_f32_16x16x32_bf16 v[72:75],a[152:155],v[152:155],v[72:75]
ds_read_b128 v[208:211],v17 offset:40960
s_add_u32 s64,s49,s34
v_mfma_f32_16x16x32_bf16 v[76:79],a[156:159],v[156:159],v[76:79]
v_min3_u32 v27,v27,v152,v156
s_waitcnt lgkmcnt(9)
v_mfma_f32_16x16x32_bf16 v[72:75],a[160:163],v[160:163],v[72:75]
ds_read_b128 v[212:215],v17 offset:43008
buffer_store_dwordx4 v[64:67],v25,s[20:23],s64 offen offset:2048
v_mfma_f32_16x16x32_bf16 v[76:79],a[164:167],v[164:167],v[76:79]
ds_read_b128 v[216:219],v17 offset:45056
v_min3_u32 v27,v27,v160,v164
v_and_or_b32 v68,v68,-4,s48
v_mfma_f32_16x16x32_bf16 v[72:75],a[168:171],v[168:171],v[72:75]
ds_read_b128 v[220:223],v17 offset:47104
s_add_u32 s64,s49,s35
v_mfma_f32_16x16x32_bf16 v[76:79],a[172:175],v[172:175],v[76:79]
ds_read_b128 v[224:227],v17 offset:49152
s_waitcnt lgkmcnt(9)
v_mfma_f32_16x16x32_bf16 v[72:75],a[176:179],v[176:179],v[72:75]
ds_read_b128 v[228:231],v17 offset:51200
v_min3_u32 v27,v27,v168,v172
v_mfma_f32_16x16x32_bf16 v[76:79],a[180:183],v[180:183],v[76:79]
v_min3_u32 v27,v27,v176,v180
buffer_store_dwordx4 v[68:71],v25,s[20:23],s64 offen offset:3072
v_mfma_f32_16x16x32_bf16 v[72:75],a[184:187],v[184:187],v[72:75]
ds_read_b128 v[232:235],v17 offset:53248
s_mov_b32 s49,0x7fff0000
v_mfma_f32_16x16x32_bf16 v[76:79],a[188:191],v[188:191],v[76:79]
ds_read_b128 v[236:239],v17 offset:55296
s_waitcnt lgkmcnt(8)
v_mfma_f32_16x16x32_bf16 v[72:75],a[192:195],v[192:195],v[72:75]
ds_read_b128 v[240:243],v17 offset:57344
v_min3_u32 v27,v27,v184,v188
v_mfma_f32_16x16x32_bf16 v[76:79],a[196:199],v[196:199],v[76:79]
ds_read_b128 v[244:247],v17 offset:59392
v_min3_u32 v27,v27,v192,v196
v_mfma_f32_16x16x32_bf16 v[72:75],a[200:203],v[200:203],v[72:75]
ds_read_b128 v[248:251],v17 offset:61440
ds_bpermute_b32 v124,v41,v120
v_mfma_f32_16x16x32_bf16 v[76:79],a[204:207],v[204:207],v[76:79]
v_min3_u32 v27,v27,v200,v204
s_waitcnt lgkmcnt(8)
v_mfma_f32_16x16x32_bf16 v[72:75],a[208:211],v[208:211],v[72:75]
ds_read_b128 v[252:255],v17 offset:63488
ds_bpermute_b32 v125,v41,v121
v_mfma_f32_16x16x32_bf16 v[76:79],a[212:215],v[212:215],v[76:79]
v_min3_u32 v27,v27,v208,v212
v_mfma_f32_16x16x32_bf16 v[72:75],a[216:219],v[216:219],v[72:75]
v_mfma_f32_16x16x32_bf16 v[76:79],a[220:223],v[220:223],v[76:79]
v_min3_u32 v27,v27,v216,v220
s_waitcnt lgkmcnt(6)
v_mfma_f32_16x16x32_bf16 v[72:75],a[224:227],v[224:227],v[72:75]
s_waitcnt lgkmcnt(0)
v_mfma_f32_16x16x32_bf16 v[76:79],a[228:231],v[228:231],v[76:79]
v_min3_u32 v27,v27,v224,v228
v_mfma_f32_16x16x32_bf16 v[72:75],a[232:235],v[232:235],v[72:75]
v_lshlrev_b32 v104,16,v124
v_mfma_f32_16x16x32_bf16 v[76:79],a[236:239],v[236:239],v[76:79]
v_min3_u32 v27,v27,v232,v236
v_mfma_f32_16x16x32_bf16 v[72:75],a[240:243],v[240:243],v[72:75]
v_mfma_f32_16x16x32_bf16 v[76:79],a[244:247],v[244:247],v[76:79]
v_min3_u32 v27,v27,v240,v244
v_mfma_f32_16x16x32_bf16 v[72:75],a[248:251],v[248:251],v[72:75]
v_and_b32 v105,s80,v124
v_mfma_f32_16x16x32_bf16 v[76:79],a[252:255],v[252:255],v[76:79]
v_min3_u32 v27,v27,v248,v252
v_mfma_f32_16x16x32_bf16 v[80:83],a[0:3],v[128:131],0
v_cmp_eq_u32 vcc,0,v27
s_cbranch_vccnz retry_254
v_mfma_f32_16x16x32_bf16 v[84:87],a[4:7],v[132:135],0
v_lshlrev_b32 v106,16,v125
v_mfma_f32_16x16x32_bf16 v[80:83],a[8:11],v[136:139],v[80:83]
v_mfma_f32_16x16x32_bf16 v[84:87],a[12:15],v[140:143],v[84:87]
v_mfma_f32_16x16x32_bf16 v[80:83],a[16:19],v[144:147],v[80:83]
v_and_b32 v107,s80,v125
v_add_f32 v72,v72,v76
v_mfma_f32_16x16x32_bf16 v[84:87],a[20:23],v[148:151],v[84:87]
v_add_f32 v73,v73,v77
v_add_f32 v74,v74,v78
v_mfma_f32_16x16x32_bf16 v[80:83],a[24:27],v[152:155],v[80:83]
v_add_f32 v75,v75,v79
v_and_or_b32 v72,v72,-4,s48
v_mfma_f32_16x16x32_bf16 v[84:87],a[28:31],v[156:159],v[84:87]
s_add_u32 s64,s77,s33
v_mfma_f32_16x16x32_bf16 v[80:83],a[32:35],v[160:163],v[80:83]
buffer_store_dwordx4 v[72:75],v25,s[20:23],s64 offen offset:1024
v_mfma_f32_16x16x32_bf16 v[84:87],a[36:39],v[164:167],v[84:87]
v_mfma_f32_16x16x32_bf16 v[80:83],a[40:43],v[168:171],v[80:83]
v_mfma_f32_16x16x32_bf16 v[84:87],a[44:47],v[172:175],v[84:87]
v_mfma_f32_16x16x32_bf16 v[80:83],a[48:51],v[176:179],v[80:83]
v_mfma_f32_16x16x32_bf16 v[84:87],a[52:55],v[180:183],v[84:87]
v_mfma_f32_16x16x32_bf16 v[80:83],a[56:59],v[184:187],v[80:83]
v_mfma_f32_16x16x32_bf16 v[84:87],a[60:63],v[188:191],v[84:87]
v_mfma_f32_16x16x32_bf16 v[80:83],a[64:67],v[192:195],v[80:83]
buffer_load_dwordx4 v[96:99],v26,s[20:23],s77 offen offset:2048 sc1
v_mfma_f32_16x16x32_bf16 v[84:87],a[68:71],v[196:199],v[84:87]
buffer_load_dwordx4 v[100:103],v26,s[20:23],s77 offen offset:3072 sc1
v_mfma_f32_16x16x32_bf16 v[80:83],a[72:75],v[200:203],v[80:83]
v_mfma_f32_16x16x32_bf16 v[84:87],a[76:79],v[204:207],v[84:87]
v_mfma_f32_16x16x32_bf16 v[80:83],a[80:83],v[208:211],v[80:83]
s_waitcnt vmcnt(5)
v_mfma_f32_16x16x32_bf16 v[84:87],a[84:87],v[212:215],v[84:87]
v_cmp_gt_u32 vcc,s96,v2
s_mov_b32 s96,vcc_lo
v_mfma_f32_16x16x32_bf16 v[80:83],a[88:91],v[216:219],v[80:83]
v_mov_b32 v44,s96
ds_write_b32 v46,v44
v_mfma_f32_16x16x32_bf16 v[84:87],a[92:95],v[220:223],v[84:87]
v_mfma_f32_16x16x32_bf16 v[80:83],a[96:99],v[224:227],v[80:83]
v_mfma_f32_16x16x32_bf16 v[84:87],a[100:103],v[228:231],v[84:87]
v_mfma_f32_16x16x32_bf16 v[80:83],a[104:107],v[232:235],v[80:83]
buffer_load_dwordx4 v[92:95],v26,s[20:23],s77 offen offset:1024 sc1
v_mfma_f32_16x16x32_bf16 v[84:87],a[108:111],v[236:239],v[84:87]
v_mfma_f32_16x16x32_bf16 v[80:83],a[112:115],v[240:243],v[80:83]
v_mfma_f32_16x16x32_bf16 v[84:87],a[116:119],v[244:247],v[84:87]
v_mfma_f32_16x16x32_bf16 v[80:83],a[120:123],v[248:251],v[80:83]
v_mfma_f32_16x16x32_bf16 v[84:87],a[124:127],v[252:255],v[84:87]
s_branch epi_257
both_258:
s_waitcnt vmcnt(9)
s_barrier
ds_read_b128 v[224:227],v18 offset:0
ds_read_b128 v[228:231],v18 offset:2048
ds_read_b128 v[232:235],v18 offset:4096
ds_read_b128 v[236:239],v18 offset:6144
ds_read_b128 v[240:243],v18 offset:8192
ds_read_b128 v[244:247],v18 offset:10240
ds_read_b128 v[248:251],v18 offset:12288
s_waitcnt lgkmcnt(5)
v_mfma_f32_16x16x32_bf16 v[64:67],a[0:3],v[224:227],0
s_xor_b32 m0,s91,17408
s_add_u32 s88,s70,s75
v_min_u32 v27,v224,v228
v_mfma_f32_16x16x32_bf16 v[68:71],a[128:131],v[224:227],0
ds_read_b128 v[252:255],v18 offset:14336
s_add_u32 s88,s88,2097152
v_mfma_f32_16x16x32_bf16 v[64:67],a[4:7],v[228:231],v[64:67]
s_add_u32 s65,s95,32768
s_xor_b32 s88,s88,0x2000
v_mfma_f32_16x16x32_bf16 v[68:71],a[132:135],v[228:231],v[68:71]
s_waitcnt vmcnt(7)
s_barrier
ds_read_b128 v[224:227],v18 offset:16384
s_waitcnt lgkmcnt(5)
v_mfma_f32_16x16x32_bf16 v[64:67],a[8:11],v[232:235],v[64:67]
buffer_load_dwordx4 v16,s[20:23],s65 offen offset:0 sc1 lds
v_min3_u32 v27,v27,v232,v236
v_mfma_f32_16x16x32_bf16 v[68:71],a[136:139],v[232:235],v[68:71]
ds_read_b128 v[228:231],v18 offset:18432
s_xor_b32 s89,s88,1024
v_mfma_f32_16x16x32_bf16 v[64:67],a[12:15],v[236:239],v[64:67]
buffer_load_dwordx4 v16,s[20:23],s65 offen offset:2048 sc1 lds
v_mfma_f32_16x16x32_bf16 v[68:71],a[140:143],v[236:239],v[68:71]
ds_read_b128 v[232:235],v18 offset:20480
s_waitcnt lgkmcnt(5)
v_mfma_f32_16x16x32_bf16 v[64:67],a[16:19],v[240:243],v[64:67]
s_xor_b32 m0,s91,33792
v_min3_u32 v27,v27,v240,v244
v_mfma_f32_16x16x32_bf16 v[68:71],a[144:147],v[240:243],v[68:71]
ds_read_b128 v[236:239],v18 offset:22528
v_mfma_f32_16x16x32_bf16 v[64:67],a[20:23],v[244:247],v[64:67]
s_add_u32 s65,s95,65536
v_mfma_f32_16x16x32_bf16 v[68:71],a[148:151],v[244:247],v[68:71]
ds_read_b128 v[240:243],v18 offset:24576
s_waitcnt lgkmcnt(5)
v_mfma_f32_16x16x32_bf16 v[64:67],a[24:27],v[248:251],v[64:67]
buffer_load_dwordx4 v16,s[20:23],s65 offen offset:0 sc1 lds
v_mfma_f32_16x16x32_bf16 v[68:71],a[152:155],v[248:251],v[68:71]
ds_read_b128 v[244:247],v18 offset:26624
v_min3_u32 v27,v27,v248,v252
v_mfma_f32_16x16x32_bf16 v[64:67],a[28:31],v[252:255],v[64:67]
buffer_load_dwordx4 v16,s[20:23],s65 offen offset:2048 sc1 lds
v_mfma_f32_16x16x32_bf16 v[68:71],a[156:159],v[252:255],v[68:71]
ds_read_b128 v[248:251],v18 offset:28672
s_waitcnt lgkmcnt(5)
v_mfma_f32_16x16x32_bf16 v[64:67],a[32:35],v[224:227],v[64:67]
s_xor_b32 m0,s91,50176
v_min3_u32 v27,v27,v224,v228
v_mfma_f32_16x16x32_bf16 v[68:71],a[160:163],v[224:227],v[68:71]
ds_read_b128 v[252:255],v18 offset:30720
v_mfma_f32_16x16x32_bf16 v[64:67],a[36:39],v[228:231],v[64:67]
s_add_u32 s65,s95,98304
v_mfma_f32_16x16x32_bf16 v[68:71],a[164:167],v[228:231],v[68:71]
s_waitcnt vmcnt(7)
s_barrier
ds_read_b128 v[224:227],v18 offset:32768
s_waitcnt lgkmcnt(5)
v_mfma_f32_16x16x32_bf16 v[64:67],a[40:43],v[232:235],v[64:67]
buffer_load_dwordx4 v16,s[20:23],s65 offen offset:0 sc1 lds
v_mfma_f32_16x16x32_bf16 v[68:71],a[168:171],v[232:235],v[68:71]
ds_read_b128 v[228:231],v18 offset:34816
v_min3_u32 v27,v27,v232,v236
v_mfma_f32_16x16x32_bf16 v[64:67],a[44:47],v[236:239],v[64:67]
buffer_load_dwordx4 v16,s[20:23],s65 offen offset:2048 sc1 lds
v_mfma_f32_16x16x32_bf16 v[68:71],a[172:175],v[236:239],v[68:71]
ds_read_b128 v[232:235],v18 offset:36864
s_waitcnt lgkmcnt(5)
v_mfma_f32_16x16x32_bf16 v[64:67],a[48:51],v[240:243],v[64:67]
v_min3_u32 v27,v27,v240,v244
v_mfma_f32_16x16x32_bf16 v[68:71],a[176:179],v[240:243],v[68:71]
ds_read_b128 v[236:239],v18 offset:38912
v_mfma_f32_16x16x32_bf16 v[64:67],a[52:55],v[244:247],v[64:67]
s_xor_b32 m0,s72,0
v_mfma_f32_16x16x32_bf16 v[68:71],a[180:183],v[244:247],v[68:71]
ds_read_b128 v[240:243],v18 offset:40960
s_add_u32 s65,s88,0
s_waitcnt lgkmcnt(5)
v_mfma_f32_16x16x32_bf16 v[64:67],a[56:59],v[248:251],v[64:67]
v_min3_u32 v27,v27,v248,v252
v_mfma_f32_16x16x32_bf16 v[68:71],a[184:187],v[248:251],v[68:71]
ds_read_b128 v[244:247],v18 offset:43008
buffer_load_dwordx4 v16,s[20:23],s65 offen offset:0 sc1 lds
v_mfma_f32_16x16x32_bf16 v[64:67],a[60:63],v[252:255],v[64:67]
buffer_load_dwordx2 v[120:121],v20,s[36:39],s78 offen
v_mfma_f32_16x16x32_bf16 v[68:71],a[188:191],v[252:255],v[68:71]
ds_read_b128 v[248:251],v18 offset:45056
s_waitcnt lgkmcnt(5)
v_mfma_f32_16x16x32_bf16 v[64:67],a[64:67],v[224:227],v[64:67]
buffer_load_dwordx4 v16,s[20:23],s65 offen offset:2048 sc1 lds
v_mfma_f32_16x16x32_bf16 v[68:71],a[192:195],v[224:227],v[68:71]
ds_read_b128 v[252:255],v18 offset:47104
s_xor_b32 m0,s72,16384
v_mfma_f32_16x16x32_bf16 v[64:67],a[68:71],v[228:231],v[64:67]
v_min3_u32 v27,v27,v224,v228
v_mfma_f32_16x16x32_bf16 v[68:71],a[196:199],v[228:231],v[68:71]
ds_read_b128 v[224:227],v18 offset:49152
s_add_u32 s65,s88,32768
s_waitcnt lgkmcnt(5)
v_mfma_f32_16x16x32_bf16 v[64:67],a[72:75],v[232:235],v[64:67]
buffer_load_dwordx4 v16,s[20:23],s65 offen offset:0 sc1 lds
v_mfma_f32_16x16x32_bf16 v[68:71],a[200:203],v[232:235],v[68:71]
ds_read_b128 v[228:231],v18 offset:51200
v_min3_u32 v27,v27,v232,v236
v_mfma_f32_16x16x32_bf16 v[64:67],a[76:79],v[236:239],v[64:67]
buffer_load_dwordx4 v16,s[20:23],s65 offen offset:2048 sc1 lds
v_mfma_f32_16x16x32_bf16 v[68:71],a[204:207],v[236:239],v[68:71]
ds_read_b128 v[232:235],v18 offset:53248
s_waitcnt lgkmcnt(5)
v_mfma_f32_16x16x32_bf16 v[64:67],a[80:83],v[240:243],v[64:67]
s_waitcnt vmcnt(9)
s_barrier
ds_read_b128 v[128:131],v17 offset:0
ds_read_b128 v[132:135],v17 offset:2048
v_mfma_f32_16x16x32_bf16 v[68:71],a[208:211],v[240:243],v[68:71]
ds_read_b128 v[236:239],v18 offset:55296
s_xor_b32 m0,s72,32768
v_min3_u32 v27,v27,v240,v244
v_mfma_f32_16x16x32_bf16 v[64:67],a[84:87],v[244:247],v[64:67]
ds_read_b128 v[136:139],v17 offset:4096
s_add_u32 s65,s88,65536
v_mfma_f32_16x16x32_bf16 v[68:71],a[212:215],v[244:247],v[68:71]
ds_read_b128 v[240:243],v18 offset:57344
s_waitcnt lgkmcnt(8)
v_mfma_f32_16x16x32_bf16 v[64:67],a[88:91],v[248:251],v[64:67]
ds_read_b128 v[140:143],v17 offset:6144
buffer_load_dwordx4 v16,s[20:23],s65 offen offset:0 sc1 lds
v_mfma_f32_16x16x32_bf16 v[68:71],a[216:219],v[248:251],v[68:71]
ds_read_b128 v[244:247],v18 offset:59392
buffer_load_dwordx4 v16,s[20:23],s65 offen offset:2048 sc1 lds
v_mfma_f32_16x16x32_bf16 v[64:67],a[92:95],v[252:255],v[64:67]
ds_read_b128 v[144:147],v17 offset:8192
ds_read_b128 v[148:151],v17 offset:10240
v_min3_u32 v27,v27,v248,v252
v_mfma_f32_16x16x32_bf16 v[68:71],a[220:223],v[252:255],v[68:71]
ds_read_b128 v[248:251],v18 offset:61440
s_xor_b32 m0,s72,49152
s_waitcnt lgkmcnt(11)
v_mfma_f32_16x16x32_bf16 v[64:67],a[96:99],v[224:227],v[64:67]
ds_read_b128 v[152:155],v17 offset:12288
v_min3_u32 v27,v27,v224,v228
v_mfma_f32_16x16x32_bf16 v[68:71],a[224:227],v[224:227],v[68:71]
ds_read_b128 v[252:255],v18 offset:63488
s_add_u32 s65,s88,98304
v_mfma_f32_16x16x32_bf16 v[64:67],a[100:103],v[228:231],v[64:67]
ds_read_b128 v[156:159],v17 offset:14336
v_mfma_f32_16x16x32_bf16 v[68:71],a[228:231],v[228:231],v[68:71]
buffer_load_dwordx4 v16,s[20:23],s65 offen offset:0 sc1 lds
s_waitcnt lgkmcnt(10)
v_mfma_f32_16x16x32_bf16 v[64:67],a[104:107],v[232:235],v[64:67]
ds_read_b128 v[160:163],v17 offset:16384
ds_read_b128 v[164:167],v17 offset:18432
v_mfma_f32_16x16x32_bf16 v[68:71],a[232:235],v[232:235],v[68:71]
buffer_load_dwordx4 v16,s[20:23],s65 offen offset:2048 sc1 lds
v_mfma_f32_16x16x32_bf16 v[64:67],a[108:111],v[236:239],v[64:67]
ds_read_b128 v[168:171],v17 offset:20480
v_min3_u32 v27,v27,v232,v236
v_mfma_f32_16x16x32_bf16 v[68:71],a[236:239],v[236:239],v[68:71]
s_xor_b32 m0,s72,1024
s_waitcnt lgkmcnt(9)
v_mfma_f32_16x16x32_bf16 v[64:67],a[112:115],v[240:243],v[64:67]
ds_read_b128 v[172:175],v17 offset:22528
s_add_u32 s65,s89,0
v_mfma_f32_16x16x32_bf16 v[68:71],a[240:243],v[240:243],v[68:71]
v_min3_u32 v27,v27,v240,v244
v_mfma_f32_16x16x32_bf16 v[64:67],a[116:119],v[244:247],v[64:67]
ds_read_b128 v[176:179],v17 offset:24576
ds_read_b128 v[180:183],v17 offset:26624
v_mfma_f32_16x16x32_bf16 v[68:71],a[244:247],v[244:247],v[68:71]
buffer_load_dwordx4 v16,s[20:23],s65 offen offset:0 sc1 lds
s_waitcnt lgkmcnt(7)
v_mfma_f32_16x16x32_bf16 v[64:67],a[120:123],v[248:251],v[64:67]
ds_read_b128 v[184:187],v17 offset:28672
buffer_load_dwordx4 v16,s[20:23],s65 offen offset:2048 sc1 lds
v_mfma_f32_16x16x32_bf16 v[68:71],a[248:251],v[248:251],v[68:71]
v_min3_u32 v27,v27,v248,v252
v_mfma_f32_16x16x32_bf16 v[64:67],a[124:127],v[252:255],v[64:67]
ds_read_b128 v[188:191],v17 offset:30720
s_xor_b32 m0,s72,17408
v_mfma_f32_16x16x32_bf16 v[68:71],a[252:255],v[252:255],v[68:71]
buffer_load_dword v2,v21,s[20:23],s87 offen sc1
v_mfma_f32_16x16x32_bf16 v[72:75],a[128:131],v[128:131],0
s_add_u32 s65,s89,32768
v_cmp_eq_u32 vcc,0,v27
s_cbranch_vccnz retry_254
v_mfma_f32_16x16x32_bf16 v[76:79],a[132:135],v[132:135],0
buffer_load_dwordx4 v16,s[20:23],s65 offen offset:0 sc1 lds
s_add_u32 s96,s71,2
v_mfma_f32_16x16x32_bf16 v[72:75],a[136:139],v[136:139],v[72:75]
s_waitcnt vmcnt(13)
s_barrier
ds_read_b128 v[192:195],v17 offset:32768
v_mfma_f32_16x16x32_bf16 v[76:79],a[140:143],v[140:143],v[76:79]
ds_read_b128 v[196:199],v17 offset:34816
s_waitcnt lgkmcnt(10)
v_mfma_f32_16x16x32_bf16 v[72:75],a[144:147],v[144:147],v[72:75]
ds_read_b128 v[200:203],v17 offset:36864
buffer_load_dwordx4 v16,s[20:23],s65 offen offset:2048 sc1 lds
s_waitcnt vmcnt(12)
v_mfma_f32_16x16x32_bf16 v[76:79],a[148:151],v[148:151],v[76:79]
ds_read_b128 v[204:207],v17 offset:38912
s_xor_b32 m0,s72,33792
v_and_or_b32 v64,v64,-4,s48
s_add_u32 s64,s49,s34
v_mfma_f32_16x16x32_bf16 v[72:75],a[152:155],v[152:155],v[72:75]
ds_read_b128 v[208:211],v17 offset:40960
v_min3_u32 v27,v27,v128,v132
buffer_store_dwordx4 v[64:67],v25,s[20:23],s64 offen offset:2048
v_mfma_f32_16x16x32_bf16 v[76:79],a[156:159],v[156:159],v[76:79]
s_add_u32 s65,s89,65536
v_and_or_b32 v68,v68,-4,s48
s_add_u32 s64,s49,s35
s_waitcnt lgkmcnt(9)
v_mfma_f32_16x16x32_bf16 v[72:75],a[160:163],v[160:163],v[72:75]
ds_read_b128 v[212:215],v17 offset:43008
v_min3_u32 v27,v27,v136,v140
buffer_store_dwordx4 v[68:71],v25,s[20:23],s64 offen offset:3072
v_mfma_f32_16x16x32_bf16 v[76:79],a[164:167],v[164:167],v[76:79]
ds_read_b128 v[216:219],v17 offset:45056
buffer_load_dwordx4 v16,s[20:23],s65 offen offset:0 sc1 lds
s_mov_b32 s49,0x7fff0000
v_mfma_f32_16x16x32_bf16 v[72:75],a[168:171],v[168:171],v[72:75]
ds_read_b128 v[220:223],v17 offset:47104
v_min3_u32 v27,v27,v144,v148
v_mfma_f32_16x16x32_bf16 v[76:79],a[172:175],v[172:175],v[76:79]
ds_read_b128 v[224:227],v17 offset:49152
s_waitcnt lgkmcnt(9)
v_mfma_f32_16x16x32_bf16 v[72:75],a[176:179],v[176:179],v[72:75]
ds_read_b128 v[228:231],v17 offset:51200
v_min3_u32 v27,v27,v152,v156
v_mfma_f32_16x16x32_bf16 v[76:79],a[180:183],v[180:183],v[76:79]
buffer_load_dwordx4 v16,s[20:23],s65 offen offset:2048 sc1 lds
v_mfma_f32_16x16x32_bf16 v[72:75],a[184:187],v[184:187],v[72:75]
ds_read_b128 v[232:235],v17 offset:53248
s_xor_b32 m0,s72,50176
v_mfma_f32_16x16x32_bf16 v[76:79],a[188:191],v[188:191],v[76:79]
ds_read_b128 v[236:239],v17 offset:55296
s_waitcnt lgkmcnt(8)
v_mfma_f32_16x16x32_bf16 v[72:75],a[192:195],v[192:195],v[72:75]
ds_read_b128 v[240:243],v17 offset:57344
s_add_u32 s65,s89,98304
v_mfma_f32_16x16x32_bf16 v[76:79],a[196:199],v[196:199],v[76:79]
ds_read_b128 v[244:247],v17 offset:59392
v_min3_u32 v27,v27,v160,v164
v_mfma_f32_16x16x32_bf16 v[72:75],a[200:203],v[200:203],v[72:75]
ds_read_b128 v[248:251],v17 offset:61440
v_min3_u32 v27,v27,v168,v172
v_mfma_f32_16x16x32_bf16 v[76:79],a[204:207],v[204:207],v[76:79]
v_min3_u32 v27,v27,v176,v180
s_waitcnt lgkmcnt(7)
v_mfma_f32_16x16x32_bf16 v[72:75],a[208:211],v[208:211],v[72:75]
ds_read_b128 v[252:255],v17 offset:63488
v_min3_u32 v27,v27,v184,v188
v_mfma_f32_16x16x32_bf16 v[76:79],a[212:215],v[212:215],v[76:79]
buffer_load_dwordx4 v16,s[20:23],s65 offen offset:0 sc1 lds
v_mfma_f32_16x16x32_bf16 v[72:75],a[216:219],v[216:219],v[72:75]
buffer_load_dwordx4 v16,s[20:23],s65 offen offset:2048 sc1 lds
v_mfma_f32_16x16x32_bf16 v[76:79],a[220:223],v[220:223],v[76:79]
v_min3_u32 v27,v27,v192,v196
s_waitcnt lgkmcnt(4)
v_mfma_f32_16x16x32_bf16 v[72:75],a[224:227],v[224:227],v[72:75]
v_min3_u32 v27,v27,v200,v204
v_min3_u32 v27,v27,v208,v212
v_mfma_f32_16x16x32_bf16 v[76:79],a[228:231],v[228:231],v[76:79]
v_min3_u32 v27,v27,v216,v220
v_min3_u32 v27,v27,v224,v228
v_mfma_f32_16x16x32_bf16 v[72:75],a[232:235],v[232:235],v[72:75]
ds_bpermute_b32 v124,v41,v120
ds_bpermute_b32 v125,v41,v121
v_mfma_f32_16x16x32_bf16 v[76:79],a[236:239],v[236:239],v[76:79]
v_min3_u32 v27,v27,v232,v236
s_waitcnt lgkmcnt(2)
v_mfma_f32_16x16x32_bf16 v[72:75],a[240:243],v[240:243],v[72:75]
s_waitcnt lgkmcnt(0)
v_lshlrev_b32 v104,16,v124
v_mfma_f32_16x16x32_bf16 v[76:79],a[244:247],v[244:247],v[76:79]
v_min3_u32 v27,v27,v240,v244
v_mfma_f32_16x16x32_bf16 v[72:75],a[248:251],v[248:251],v[72:75]
v_and_b32 v105,s80,v124
v_mfma_f32_16x16x32_bf16 v[76:79],a[252:255],v[252:255],v[76:79]
v_min3_u32 v27,v27,v248,v252
v_mfma_f32_16x16x32_bf16 v[80:83],a[0:3],v[128:131],0
v_cmp_eq_u32 vcc,0,v27
s_cbranch_vccnz retry_254
v_mfma_f32_16x16x32_bf16 v[84:87],a[4:7],v[132:135],0
v_lshlrev_b32 v106,16,v125
v_mfma_f32_16x16x32_bf16 v[80:83],a[8:11],v[136:139],v[80:83]
v_mfma_f32_16x16x32_bf16 v[84:87],a[12:15],v[140:143],v[84:87]
v_mfma_f32_16x16x32_bf16 v[80:83],a[16:19],v[144:147],v[80:83]
v_and_b32 v107,s80,v125
v_add_f32 v72,v72,v76
v_mfma_f32_16x16x32_bf16 v[84:87],a[20:23],v[148:151],v[84:87]
v_add_f32 v73,v73,v77
v_add_f32 v74,v74,v78
v_mfma_f32_16x16x32_bf16 v[80:83],a[24:27],v[152:155],v[80:83]
v_add_f32 v75,v75,v79
v_and_or_b32 v72,v72,-4,s48
v_mfma_f32_16x16x32_bf16 v[84:87],a[28:31],v[156:159],v[84:87]
s_add_u32 s64,s77,s33
v_mfma_f32_16x16x32_bf16 v[80:83],a[32:35],v[160:163],v[80:83]
buffer_store_dwordx4 v[72:75],v25,s[20:23],s64 offen offset:1024
v_mfma_f32_16x16x32_bf16 v[84:87],a[36:39],v[164:167],v[84:87]
v_mfma_f32_16x16x32_bf16 v[80:83],a[40:43],v[168:171],v[80:83]
v_mfma_f32_16x16x32_bf16 v[84:87],a[44:47],v[172:175],v[84:87]
v_mfma_f32_16x16x32_bf16 v[80:83],a[48:51],v[176:179],v[80:83]
v_mfma_f32_16x16x32_bf16 v[84:87],a[52:55],v[180:183],v[84:87]
v_mfma_f32_16x16x32_bf16 v[80:83],a[56:59],v[184:187],v[80:83]
v_mfma_f32_16x16x32_bf16 v[84:87],a[60:63],v[188:191],v[84:87]
v_mfma_f32_16x16x32_bf16 v[80:83],a[64:67],v[192:195],v[80:83]
buffer_load_dwordx4 v[96:99],v26,s[20:23],s77 offen offset:2048 sc1
v_mfma_f32_16x16x32_bf16 v[84:87],a[68:71],v[196:199],v[84:87]
buffer_load_dwordx4 v[100:103],v26,s[20:23],s77 offen offset:3072 sc1
v_mfma_f32_16x16x32_bf16 v[80:83],a[72:75],v[200:203],v[80:83]
v_mfma_f32_16x16x32_bf16 v[84:87],a[76:79],v[204:207],v[84:87]
v_mfma_f32_16x16x32_bf16 v[80:83],a[80:83],v[208:211],v[80:83]
s_waitcnt vmcnt(11)
v_mfma_f32_16x16x32_bf16 v[84:87],a[84:87],v[212:215],v[84:87]
v_cmp_gt_u32 vcc,s96,v2
s_mov_b32 s96,vcc_lo
v_mfma_f32_16x16x32_bf16 v[80:83],a[88:91],v[216:219],v[80:83]
v_mov_b32 v44,s96
ds_write_b32 v46,v44
v_mfma_f32_16x16x32_bf16 v[84:87],a[92:95],v[220:223],v[84:87]
v_mfma_f32_16x16x32_bf16 v[80:83],a[96:99],v[224:227],v[80:83]
v_mfma_f32_16x16x32_bf16 v[84:87],a[100:103],v[228:231],v[84:87]
v_mfma_f32_16x16x32_bf16 v[80:83],a[104:107],v[232:235],v[80:83]
buffer_load_dwordx4 v[92:95],v26,s[20:23],s77 offen offset:1024 sc1
v_mfma_f32_16x16x32_bf16 v[84:87],a[108:111],v[236:239],v[84:87]
v_mfma_f32_16x16x32_bf16 v[80:83],a[112:115],v[240:243],v[80:83]
v_mfma_f32_16x16x32_bf16 v[84:87],a[116:119],v[244:247],v[84:87]
v_mfma_f32_16x16x32_bf16 v[80:83],a[120:123],v[248:251],v[80:83]
v_mfma_f32_16x16x32_bf16 v[84:87],a[124:127],v[252:255],v[84:87]
s_branch epi_257
ahead_256:
s_waitcnt vmcnt(7) lgkmcnt(0)
s_barrier
ds_read_b32 v44,v45
ds_read_b128 v[224:227],v18 offset:0
ds_read_b128 v[228:231],v18 offset:2048
ds_read_b128 v[232:235],v18 offset:4096
ds_read_b128 v[236:239],v18 offset:6144
ds_read_b128 v[240:243],v18 offset:8192
ds_read_b128 v[244:247],v18 offset:10240
ds_read_b128 v[248:251],v18 offset:12288
s_waitcnt lgkmcnt(5)
v_mfma_f32_16x16x32_bf16 v[64:67],a[0:3],v[224:227],0
s_add_u32 s88,s70,s75
s_add_u32 s88,s88,2097152
v_min_u32 v27,v224,v228
v_mfma_f32_16x16x32_bf16 v[68:71],a[128:131],v[224:227],0
ds_read_b128 v[252:255],v18 offset:14336
s_xor_b32 s88,s88,0x2000
v_mfma_f32_16x16x32_bf16 v[64:67],a[4:7],v[228:231],v[64:67]
v_readfirstlane_b32 s83,v44
v_mfma_f32_16x16x32_bf16 v[68:71],a[132:135],v[228:231],v[68:71]
ds_read_b128 v[224:227],v18 offset:16384
s_waitcnt lgkmcnt(5)
v_mfma_f32_16x16x32_bf16 v[64:67],a[8:11],v[232:235],v[64:67]
s_cmp_eq_u32 s83,0
s_cselect_b32 s88,s88,0x7fff0000
v_mfma_f32_16x16x32_bf16 v[68:71],a[136:139],v[232:235],v[68:71]
ds_read_b128 v[228:231],v18 offset:18432
s_xor_b32 s89,s88,1024
v_mfma_f32_16x16x32_bf16 v[64:67],a[12:15],v[236:239],v[64:67]
s_xor_b32 m0,s72,0
v_min3_u32 v27,v27,v232,v236
v_mfma_f32_16x16x32_bf16 v[68:71],a[140:143],v[236:239],v[68:71]
ds_read_b128 v[232:235],v18 offset:20480
s_waitcnt lgkmcnt(5)
v_mfma_f32_16x16x32_bf16 v[64:67],a[16:19],v[240:243],v[64:67]
s_add_u32 s65,s88,0
v_min3_u32 v27,v27,v240,v244
v_mfma_f32_16x16x32_bf16 v[68:71],a[144:147],v[240:243],v[68:71]
ds_read_b128 v[236:239],v18 offset:22528
v_mfma_f32_16x16x32_bf16 v[64:67],a[20:23],v[244:247],v[64:67]
buffer_load_dwordx4 v16,s[20:23],s65 offen offset:0 sc1 lds
v_mfma_f32_16x16x32_bf16 v[68:71],a[148:151],v[244:247],v[68:71]
ds_read_b128 v[240:243],v18 offset:24576
s_waitcnt lgkmcnt(5)
v_mfma_f32_16x16x32_bf16 v[64:67],a[24:27],v[248:251],v[64:67]
buffer_load_dwordx4 v16,s[20:23],s65 offen offset:2048 sc1 lds
v_mfma_f32_16x16x32_bf16 v[68:71],a[152:155],v[248:251],v[68:71]
ds_read_b128 v[244:247],v18 offset:26624
v_min3_u32 v27,v27,v248,v252
v_mfma_f32_16x16x32_bf16 v[64:67],a[28:31],v[252:255],v[64:67]
s_xor_b32 m0,s72,16384
v_mfma_f32_16x16x32_bf16 v[68:71],a[156:159],v[252:255],v[68:71]
ds_read_b128 v[248:251],v18 offset:28672
s_waitcnt lgkmcnt(5)
v_mfma_f32_16x16x32_bf16 v[64:67],a[32:35],v[224:227],v[64:67]
s_add_u32 s65,s88,32768
v_min3_u32 v27,v27,v224,v228
v_mfma_f32_16x16x32_bf16 v[68:71],a[160:163],v[224:227],v[68:71]
ds_read_b128 v[252:255],v18 offset:30720
v_mfma_f32_16x16x32_bf16 v[64:67],a[36:39],v[228:231],v[64:67]
buffer_load_dwordx4 v16,s[20:23],s65 offen offset:0 sc1 lds
v_mfma_f32_16x16x32_bf16 v[68:71],a[164:167],v[228:231],v[68:71]
ds_read_b128 v[224:227],v18 offset:32768
s_waitcnt lgkmcnt(5)
v_mfma_f32_16x16x32_bf16 v[64:67],a[40:43],v[232:235],v[64:67]
buffer_load_dwordx4 v16,s[20:23],s65 offen offset:2048 sc1 lds
v_mfma_f32_16x16x32_bf16 v[68:71],a[168:171],v[232:235],v[68:71]
ds_read_b128 v[228:231],v18 offset:34816
v_min3_u32 v27,v27,v232,v236
v_mfma_f32_16x16x32_bf16 v[64:67],a[44:47],v[236:239],v[64:67]
buffer_load_dwordx2 v[120:121],v20,s[36:39],s78 offen
v_mfma_f32_16x16x32_bf16 v[68:71],a[172:175],v[236:239],v[68:71]
ds_read_b128 v[232:235],v18 offset:36864
s_xor_b32 m0,s72,32768
s_waitcnt lgkmcnt(5)
v_mfma_f32_16x16x32_bf16 v[64:67],a[48:51],v[240:243],v[64:67]
v_min3_u32 v27,v27,v240,v244
v_mfma_f32_16x16x32_bf16 v[68:71],a[176:179],v[240:243],v[68:71]
ds_read_b128 v[236:239],v18 offset:38912
s_add_u32 s65,s88,65536
v_mfma_f32_16x16x32_bf16 v[64:67],a[52:55],v[244:247],v[64:67]
v_mfma_f32_16x16x32_bf16 v[68:71],a[180:183],v[244:247],v[68:71]
ds_read_b128 v[240:243],v18 offset:40960
s_waitcnt lgkmcnt(5)
v_mfma_f32_16x16x32_bf16 v[64:67],a[56:59],v[248:251],v[64:67]
buffer_load_dwordx4 v16,s[20:23],s65 offen offset:0 sc1 lds
v_mfma_f32_16x16x32_bf16 v[68:71],a[184:187],v[248:251],v[68:71]
ds_read_b128 v[244:247],v18 offset:43008
buffer_load_dwordx4 v16,s[20:23],s65 offen offset:2048 sc1 lds
v_mfma_f32_16x16x32_bf16 v[64:67],a[60:63],v[252:255],v[64:67]
v_min3_u32 v27,v27,v248,v252
v_mfma_f32_16x16x32_bf16 v[68:71],a[188:191],v[252:255],v[68:71]
ds_read_b128 v[248:251],v18 offset:45056
s_xor_b32 m0,s72,49152
s_waitcnt lgkmcnt(5)
v_mfma_f32_16x16x32_bf16 v[64:67],a[64:67],v[224:227],v[64:67]
v_min3_u32 v27,v27,v224,v228
v_mfma_f32_16x16x32_bf16 v[68:71],a[192:195],v[224:227],v[68:71]
ds_read_b128 v[252:255],v18 offset:47104
s_add_u32 s65,s88,98304
v_mfma_f32_16x16x32_bf16 v[64:67],a[68:71],v[228:231],v[64:67]
v_mfma_f32_16x16x32_bf16 v[68:71],a[196:199],v[228:231],v[68:71]
ds_read_b128 v[224:227],v18 offset:49152
s_waitcnt lgkmcnt(5)
v_mfma_f32_16x16x32_bf16 v[64:67],a[72:75],v[232:235],v[64:67]
buffer_load_dwordx4 v16,s[20:23],s65 offen offset:0 sc1 lds
v_mfma_f32_16x16x32_bf16 v[68:71],a[200:203],v[232:235],v[68:71]
ds_read_b128 v[228:231],v18 offset:51200
buffer_load_dwordx4 v16,s[20:23],s65 offen offset:2048 sc1 lds
v_mfma_f32_16x16x32_bf16 v[64:67],a[76:79],v[236:239],v[64:67]
v_min3_u32 v27,v27,v232,v236
v_mfma_f32_16x16x32_bf16 v[68:71],a[204:207],v[236:239],v[68:71]
ds_read_b128 v[232:235],v18 offset:53248
s_waitcnt lgkmcnt(5)
v_mfma_f32_16x16x32_bf16 v[64:67],a[80:83],v[240:243],v[64:67]
ds_read_b128 v[128:131],v17 offset:0
ds_read_b128 v[132:135],v17 offset:2048
s_xor_b32 m0,s72,1024
v_mfma_f32_16x16x32_bf16 v[68:71],a[208:211],v[240:243],v[68:71]
ds_read_b128 v[236:239],v18 offset:55296
v_min3_u32 v27,v27,v240,v244
v_mfma_f32_16x16x32_bf16 v[64:67],a[84:87],v[244:247],v[64:67]
ds_read_b128 v[136:139],v17 offset:4096
s_add_u32 s65,s89,0
v_mfma_f32_16x16x32_bf16 v[68:71],a[212:215],v[244:247],v[68:71]
ds_read_b128 v[240:243],v18 offset:57344
s_waitcnt lgkmcnt(8)
v_mfma_f32_16x16x32_bf16 v[64:67],a[88:91],v[248:251],v[64:67]
ds_read_b128 v[140:143],v17 offset:6144
buffer_load_dwordx4 v16,s[20:23],s65 offen offset:0 sc1 lds
v_mfma_f32_16x16x32_bf16 v[68:71],a[216:219],v[248:251],v[68:71]
ds_read_b128 v[244:247],v18 offset:59392
v_min3_u32 v27,v27,v248,v252
v_mfma_f32_16x16x32_bf16 v[64:67],a[92:95],v[252:255],v[64:67]
ds_read_b128 v[144:147],v17 offset:8192
ds_read_b128 v[148:151],v17 offset:10240
v_mfma_f32_16x16x32_bf16 v[68:71],a[220:223],v[252:255],v[68:71]
ds_read_b128 v[248:251],v18 offset:61440
s_waitcnt lgkmcnt(11)
v_mfma_f32_16x16x32_bf16 v[64:67],a[96:99],v[224:227],v[64:67]
ds_read_b128 v[152:155],v17 offset:12288
buffer_load_dwordx4 v16,s[20:23],s65 offen offset:2048 sc1 lds
v_mfma_f32_16x16x32_bf16 v[68:71],a[224:227],v[224:227],v[68:71]
ds_read_b128 v[252:255],v18 offset:63488
s_xor_b32 m0,s72,17408
v_min3_u32 v27,v27,v224,v228
v_mfma_f32_16x16x32_bf16 v[64:67],a[100:103],v[228:231],v[64:67]
ds_read_b128 v[156:159],v17 offset:14336
s_add_u32 s65,s89,32768
s_waitcnt vmcnt(11)
v_mfma_f32_16x16x32_bf16 v[68:71],a[228:231],v[228:231],v[68:71]
v_add_u32 v22,s71,-1
s_waitcnt lgkmcnt(10)
v_mfma_f32_16x16x32_bf16 v[64:67],a[104:107],v[232:235],v[64:67]
ds_read_b128 v[160:163],v17 offset:16384
ds_read_b128 v[164:167],v17 offset:18432
v_min3_u32 v27,v27,v232,v236
v_mfma_f32_16x16x32_bf16 v[68:71],a[232:235],v[232:235],v[68:71]
buffer_load_dwordx4 v16,s[20:23],s65 offen offset:0 sc1 lds
v_mfma_f32_16x16x32_bf16 v[64:67],a[108:111],v[236:239],v[64:67]
ds_read_b128 v[168:171],v17 offset:20480
buffer_load_dwordx4 v16,s[20:23],s65 offen offset:2048 sc1 lds
v_mfma_f32_16x16x32_bf16 v[68:71],a[236:239],v[236:239],v[68:71]
buffer_store_dword v22,v23,s[20:23],s97 offen sc1
s_waitcnt lgkmcnt(9)
v_mfma_f32_16x16x32_bf16 v[64:67],a[112:115],v[240:243],v[64:67]
ds_read_b128 v[172:175],v17 offset:22528
v_min3_u32 v27,v27,v240,v244
v_mfma_f32_16x16x32_bf16 v[68:71],a[240:243],v[240:243],v[68:71]
s_xor_b32 m0,s72,33792
s_mov_b32 s97,0x7fff0000
v_mfma_f32_16x16x32_bf16 v[64:67],a[116:119],v[244:247],v[64:67]
ds_read_b128 v[176:179],v17 offset:24576
ds_read_b128 v[180:183],v17 offset:26624
v_mfma_f32_16x16x32_bf16 v[68:71],a[244:247],v[244:247],v[68:71]
s_add_u32 s65,s89,65536
s_waitcnt lgkmcnt(7)
v_mfma_f32_16x16x32_bf16 v[64:67],a[120:123],v[248:251],v[64:67]
ds_read_b128 v[184:187],v17 offset:28672
v_min3_u32 v27,v27,v248,v252
v_mfma_f32_16x16x32_bf16 v[68:71],a[248:251],v[248:251],v[68:71]
buffer_load_dwordx4 v16,s[20:23],s65 offen offset:0 sc1 lds
v_mfma_f32_16x16x32_bf16 v[64:67],a[124:127],v[252:255],v[64:67]
ds_read_b128 v[188:191],v17 offset:30720
buffer_load_dword v2,v21,s[20:23],s87 offen sc1
v_mfma_f32_16x16x32_bf16 v[68:71],a[252:255],v[252:255],v[68:71]
buffer_load_dwordx4 v16,s[20:23],s65 offen offset:2048 sc1 lds
v_mfma_f32_16x16x32_bf16 v[72:75],a[128:131],v[128:131],0
v_cmp_eq_u32 vcc,0,v27
s_cbranch_vccnz retry_254
v_mfma_f32_16x16x32_bf16 v[76:79],a[132:135],v[132:135],0
s_xor_b32 m0,s72,50176
v_min3_u32 v27,v27,v128,v132
v_mfma_f32_16x16x32_bf16 v[72:75],a[136:139],v[136:139],v[72:75]
ds_read_b128 v[192:195],v17 offset:32768
s_add_u32 s96,s71,2
v_mfma_f32_16x16x32_bf16 v[76:79],a[140:143],v[140:143],v[76:79]
ds_read_b128 v[196:199],v17 offset:34816
s_add_u32 s65,s89,98304
s_waitcnt lgkmcnt(10)
v_mfma_f32_16x16x32_bf16 v[72:75],a[144:147],v[144:147],v[72:75]
ds_read_b128 v[200:203],v17 offset:36864
v_min3_u32 v27,v27,v136,v140
s_waitcnt vmcnt(12)
v_mfma_f32_16x16x32_bf16 v[76:79],a[148:151],v[148:151],v[76:79]
ds_read_b128 v[204:207],v17 offset:38912
buffer_load_dwordx4 v16,s[20:23],s65 offen offset:0 sc1 lds
v_mfma_f32_16x16x32_bf16 v[72:75],a[152:155],v[152:155],v[72:75]
ds_read_b128 v[208:211],v17 offset:40960
v_min3_u32 v27,v27,v144,v148
v_and_or_b32 v64,v64,-4,s48
v_mfma_f32_16x16x32_bf16 v[76:79],a[156:159],v[156:159],v[76:79]
buffer_load_dwordx4 v16,s[20:23],s65 offen offset:2048 sc1 lds
s_waitcnt lgkmcnt(9)
v_mfma_f32_16x16x32_bf16 v[72:75],a[160:163],v[160:163],v[72:75]
ds_read_b128 v[212:215],v17 offset:43008
v_min3_u32 v27,v27,v152,v156
s_add_u32 s64,s49,s34
v_mfma_f32_16x16x32_bf16 v[76:79],a[164:167],v[164:167],v[76:79]
ds_read_b128 v[216:219],v17 offset:45056
v_min3_u32 v27,v27,v160,v164
v_mfma_f32_16x16x32_bf16 v[72:75],a[168:171],v[168:171],v[72:75]
ds_read_b128 v[220:223],v17 offset:47104
buffer_store_dwordx4 v[64:67],v25,s[20:23],s64 offen offset:2048
v_mfma_f32_16x16x32_bf16 v[76:79],a[172:175],v[172:175],v[76:79]
ds_read_b128 v[224:227],v17 offset:49152
v_and_or_b32 v68,v68,-4,s48
s_waitcnt lgkmcnt(9)
v_mfma_f32_16x16x32_bf16 v[72:75],a[176:179],v[176:179],v[72:75]
ds_read_b128 v[228:231],v17 offset:51200
v_min3_u32 v27,v27,v168,v172
s_add_u32 s64,s49,s35
v_mfma_f32_16x16x32_bf16 v[76:79],a[180:183],v[180:183],v[76:79]
v_min3_u32 v27,v27,v176,v180
buffer_store_dwordx4 v[68:71],v25,s[20:23],s64 offen offset:3072
v_mfma_f32_16x16x32_bf16 v[72:75],a[184:187],v[184:187],v[72:75]
ds_read_b128 v[232:235],v17 offset:53248
s_mov_b32 s49,0x7fff0000
v_mfma_f32_16x16x32_bf16 v[76:79],a[188:191],v[188:191],v[76:79]
ds_read_b128 v[236:239],v17 offset:55296
s_waitcnt lgkmcnt(8)
v_mfma_f32_16x16x32_bf16 v[72:75],a[192:195],v[192:195],v[72:75]
ds_read_b128 v[240:243],v17 offset:57344
v_min3_u32 v27,v27,v184,v188
v_mfma_f32_16x16x32_bf16 v[76:79],a[196:199],v[196:199],v[76:79]
ds_read_b128 v[244:247],v17 offset:59392
v_min3_u32 v27,v27,v192,v196
v_mfma_f32_16x16x32_bf16 v[72:75],a[200:203],v[200:203],v[72:75]
ds_read_b128 v[248:251],v17 offset:61440
ds_bpermute_b32 v124,v41,v120
v_mfma_f32_16x16x32_bf16 v[76:79],a[204:207],v[204:207],v[76:79]
v_min3_u32 v27,v27,v200,v204
s_waitcnt lgkmcnt(8)
v_mfma_f32_16x16x32_bf16 v[72:75],a[208:211],v[208:211],v[72:75]
ds_read_b128 v[252:255],v17 offset:63488
ds_bpermute_b32 v125,v41,v121
v_mfma_f32_16x16x32_bf16 v[76:79],a[212:215],v[212:215],v[76:79]
v_min3_u32 v27,v27,v208,v212
v_mfma_f32_16x16x32_bf16 v[72:75],a[216:219],v[216:219],v[72:75]
v_mfma_f32_16x16x32_bf16 v[76:79],a[220:223],v[220:223],v[76:79]
v_min3_u32 v27,v27,v216,v220
s_waitcnt lgkmcnt(6)
v_mfma_f32_16x16x32_bf16 v[72:75],a[224:227],v[224:227],v[72:75]
s_waitcnt lgkmcnt(0)
v_mfma_f32_16x16x32_bf16 v[76:79],a[228:231],v[228:231],v[76:79]
v_min3_u32 v27,v27,v224,v228
v_mfma_f32_16x16x32_bf16 v[72:75],a[232:235],v[232:235],v[72:75]
v_lshlrev_b32 v104,16,v124
v_mfma_f32_16x16x32_bf16 v[76:79],a[236:239],v[236:239],v[76:79]
v_min3_u32 v27,v27,v232,v236
v_mfma_f32_16x16x32_bf16 v[72:75],a[240:243],v[240:243],v[72:75]
v_mfma_f32_16x16x32_bf16 v[76:79],a[244:247],v[244:247],v[76:79]
v_min3_u32 v27,v27,v240,v244
v_mfma_f32_16x16x32_bf16 v[72:75],a[248:251],v[248:251],v[72:75]
v_and_b32 v105,s80,v124
v_mfma_f32_16x16x32_bf16 v[76:79],a[252:255],v[252:255],v[76:79]
v_min3_u32 v27,v27,v248,v252
v_mfma_f32_16x16x32_bf16 v[80:83],a[0:3],v[128:131],0
v_cmp_eq_u32 vcc,0,v27
s_cbranch_vccnz retry_254
v_mfma_f32_16x16x32_bf16 v[84:87],a[4:7],v[132:135],0
v_lshlrev_b32 v106,16,v125
v_mfma_f32_16x16x32_bf16 v[80:83],a[8:11],v[136:139],v[80:83]
v_mfma_f32_16x16x32_bf16 v[84:87],a[12:15],v[140:143],v[84:87]
v_mfma_f32_16x16x32_bf16 v[80:83],a[16:19],v[144:147],v[80:83]
v_and_b32 v107,s80,v125
v_add_f32 v72,v72,v76
v_mfma_f32_16x16x32_bf16 v[84:87],a[20:23],v[148:151],v[84:87]
v_add_f32 v73,v73,v77
v_add_f32 v74,v74,v78
v_mfma_f32_16x16x32_bf16 v[80:83],a[24:27],v[152:155],v[80:83]
v_add_f32 v75,v75,v79
v_and_or_b32 v72,v72,-4,s48
v_mfma_f32_16x16x32_bf16 v[84:87],a[28:31],v[156:159],v[84:87]
s_add_u32 s64,s77,s33
v_mfma_f32_16x16x32_bf16 v[80:83],a[32:35],v[160:163],v[80:83]
buffer_store_dwordx4 v[72:75],v25,s[20:23],s64 offen offset:1024
v_mfma_f32_16x16x32_bf16 v[84:87],a[36:39],v[164:167],v[84:87]
v_mfma_f32_16x16x32_bf16 v[80:83],a[40:43],v[168:171],v[80:83]
v_mfma_f32_16x16x32_bf16 v[84:87],a[44:47],v[172:175],v[84:87]
v_mfma_f32_16x16x32_bf16 v[80:83],a[48:51],v[176:179],v[80:83]
v_mfma_f32_16x16x32_bf16 v[84:87],a[52:55],v[180:183],v[84:87]
v_mfma_f32_16x16x32_bf16 v[80:83],a[56:59],v[184:187],v[80:83]
v_mfma_f32_16x16x32_bf16 v[84:87],a[60:63],v[188:191],v[84:87]
v_mfma_f32_16x16x32_bf16 v[80:83],a[64:67],v[192:195],v[80:83]
buffer_load_dwordx4 v[96:99],v26,s[20:23],s77 offen offset:2048 sc1
v_mfma_f32_16x16x32_bf16 v[84:87],a[68:71],v[196:199],v[84:87]
buffer_load_dwordx4 v[100:103],v26,s[20:23],s77 offen offset:3072 sc1
v_mfma_f32_16x16x32_bf16 v[80:83],a[72:75],v[200:203],v[80:83]
v_mfma_f32_16x16x32_bf16 v[84:87],a[76:79],v[204:207],v[84:87]
v_mfma_f32_16x16x32_bf16 v[80:83],a[80:83],v[208:211],v[80:83]
s_waitcnt vmcnt(8)
v_mfma_f32_16x16x32_bf16 v[84:87],a[84:87],v[212:215],v[84:87]
v_cmp_gt_u32 vcc,s96,v2
s_mov_b32 s96,vcc_lo
v_mfma_f32_16x16x32_bf16 v[80:83],a[88:91],v[216:219],v[80:83]
v_mov_b32 v44,s96
ds_write_b32 v46,v44
v_mfma_f32_16x16x32_bf16 v[84:87],a[92:95],v[220:223],v[84:87]
v_mfma_f32_16x16x32_bf16 v[80:83],a[96:99],v[224:227],v[80:83]
v_mfma_f32_16x16x32_bf16 v[84:87],a[100:103],v[228:231],v[84:87]
v_mfma_f32_16x16x32_bf16 v[80:83],a[104:107],v[232:235],v[80:83]
buffer_load_dwordx4 v[92:95],v26,s[20:23],s77 offen offset:1024 sc1
v_mfma_f32_16x16x32_bf16 v[84:87],a[108:111],v[236:239],v[84:87]
v_mfma_f32_16x16x32_bf16 v[80:83],a[112:115],v[240:243],v[80:83]
v_mfma_f32_16x16x32_bf16 v[84:87],a[116:119],v[244:247],v[84:87]
v_mfma_f32_16x16x32_bf16 v[80:83],a[120:123],v[248:251],v[80:83]
v_mfma_f32_16x16x32_bf16 v[84:87],a[124:127],v[252:255],v[84:87]
epi_257:
buffer_load_dword v29,v21,s[20:23],s87 offen sc1
s_nop 6
v_pk_add_f32 v[88:89],v[80:81],v[84:85]
v_pk_add_f32 v[90:91],v[82:83],v[86:87]
s_waitcnt vmcnt(1)
s_branch ic_264
ip_262:
buffer_load_dwordx4 v[92:95],v26,s[20:23],s77 offen offset:1024 sc1
buffer_load_dwordx4 v[96:99],v26,s[20:23],s77 offen offset:2048 sc1
buffer_load_dwordx4 v[100:103],v26,s[20:23],s77 offen offset:3072 sc1
s_waitcnt vmcnt(0)
ic_264:
v_bitop3_b32 v22,v92,v96,v100 bitop3:0x80
v_and_b32 v22,s48,v22
v_cmp_eq_u32 vcc,0,v22
s_cbranch_vccz ik_263
s_sub_u32 s90,s90,1
s_cmp_gt_i32 s90,0
s_cbranch_scc1 ip_262
ik_263:
v_pk_add_f32 v[88:89],v[88:89],v[92:93]
v_pk_add_f32 v[96:97],v[96:97],v[100:101]
v_pk_add_f32 v[90:91],v[90:91],v[94:95]
v_pk_add_f32 v[98:99],v[98:99],v[102:103]
v_pk_add_f32 v[88:89],v[88:89],v[96:97]
v_pk_add_f32 v[90:91],v[90:91],v[98:99]
v_pk_fma_f32 v[88:89],v[88:89],v[52:53],v[104:105]
v_pk_fma_f32 v[90:91],v[90:91],v[54:55],v[106:107]
v_cvt_pk_bf16_f32 v88,v88,v89
v_cvt_pk_bf16_f32 v89,v90,v91
v_max_u32 v88,1,v88
ds_bpermute_b32 v88,v40,v88
ds_bpermute_b32 v89,v40,v89
v_xor_b32 v18,0x10000,v18
s_xor_b32 s49,s77,524288
s_cselect_b32 s64,0,3
s_xor_b32 s48,s48,s64
s_waitcnt lgkmcnt(0)
buffer_store_dwordx2 v[88:89],v19,s[20:23],s70 offen sc1
s_mov_b32 s77,s49
s_add_u32 s78,s78,65536
s_cmp_gt_u32 s71,51
s_cselect_b32 s65,s73,0x7fff0000
s_cselect_b32 s97,0x7fff0000,s73
v_mov_b32 v22,s71
buffer_store_dword v22,v23,s[20:23],s65 offen sc1
v_xor_b32 v17,0x10000,v17
v_xor_b32 v45,16,v45
v_xor_b32 v46,16,v46
s_xor_b32 s72,s72,0x10000
s_add_u32 s70,s70,2097152
s_xor_b32 s70,s70,0x2000
s_add_u32 s71,s71,1
s_cmp_le_u32 s71,64
s_cbranch_scc1 seg_255
s_endpgm
retry_254:
s_sub_u32 s90,s90,64
s_cmp_lt_i32 s90,0
s_cbranch_scc1 giveup_176
s_mov_b32 s83,1
s_waitcnt vmcnt(0) lgkmcnt(0)
s_barrier
s_branch seg_255
kslow_253:
s_add_u32 s64,s79,0
s_lshl_b32 s70,s64,21
s_lshl_b32 s64,s64,13
s_and_b32 s64,s64,0x2000
s_xor_b32 s64,s64,s62
s_add_u32 s70,s70,s64
s_add_u32 s70,s70,29360128
s_mov_b32 s83,1
s_mov_b32 s87,s74
s_cmp_eq_u32 s50,0
s_cselect_b32 s74,s74,0x7fff0000
v_mov_b32 v45,132096
s_lshl_b32 s64,s50,2
s_add_u32 s64,s64,132112
v_mov_b32 v46,s64
v_mov_b32 v2,0
v_mov_b32 v44,1
ds_write_b32 v45,v44
s_mov_b32 s97,0x7fff0000
s_waitcnt lgkmcnt(0)
seg_268:
s_add_u32 s94,s70,s75
s_xor_b32 s95,s94,1024
s_xor_b32 s91,s72,0x10000
s_waitcnt lgkmcnt(0)
v_cmp_gt_u32 vcc,s71,v2
s_cbranch_vccz nb_272
s_waitcnt vmcnt(2)
v_cmp_gt_u32 vcc,s71,v29
s_cbranch_vccz nb_272
s_waitcnt vmcnt(0)
v_add_u32 v22,s71,-1
buffer_store_dword v22,v23,s[20:23],s97 offen sc1
s_mov_b32 s97,0x7fff0000
s_cmp_lg_u32 s50,0
s_cbranch_scc1 nb_272
buffer_load_dword v32,v21,s[20:23],s74 offen sc1
s_sleep 2
pl_273:
buffer_load_dword v33,v21,s[20:23],s74 offen sc1
s_waitcnt vmcnt(1)
v_cmp_gt_u32 vcc,s71,v32
s_cbranch_vccz pok_274
buffer_load_dword v32,v21,s[20:23],s74 offen sc1
s_waitcnt vmcnt(1)
v_cmp_gt_u32 vcc,s71,v33
s_cbranch_vccz pok_274
s_sub_u32 s90,s90,1
s_cmp_gt_i32 s90,0
s_cbranch_scc1 pl_273
pok_274:
nb_272:
s_barrier
s_xor_b32 m0,s91,0
s_add_u32 s65,s94,0
buffer_load_dwordx4 v16,s[20:23],s65 offen offset:0 sc1 lds
buffer_load_dwordx4 v16,s[20:23],s65 offen offset:2048 sc1 lds
ds_read_b32 v44,v45
s_xor_b32 m0,s91,16384
s_add_u32 s65,s94,32768
buffer_load_dwordx4 v16,s[20:23],s65 offen offset:0 sc1 lds
buffer_load_dwordx4 v16,s[20:23],s65 offen offset:2048 sc1 lds
s_xor_b32 m0,s91,32768
s_add_u32 s65,s94,65536
buffer_load_dwordx4 v16,s[20:23],s65 offen offset:0 sc1 lds
buffer_load_dwordx4 v16,s[20:23],s65 offen offset:2048 sc1 lds
s_xor_b32 m0,s91,49152
s_add_u32 s65,s94,98304
buffer_load_dwordx4 v16,s[20:23],s65 offen offset:0 sc1 lds
buffer_load_dwordx4 v16,s[20:23],s65 offen offset:2048 sc1 lds
s_xor_b32 m0,s91,1024
s_add_u32 s65,s95,0
buffer_load_dwordx4 v16,s[20:23],s65 offen offset:0 sc1 lds
buffer_load_dwordx4 v16,s[20:23],s65 offen offset:2048 sc1 lds
s_waitcnt vmcnt(10)
v_add_u32 v22,s71,-1
buffer_store_dword v22,v23,s[20:23],s97 offen sc1
s_mov_b32 s97,0x7fff0000
s_waitcnt vmcnt(9)
s_barrier
ds_read_b128 v[224:227],v18 offset:0
ds_read_b128 v[228:231],v18 offset:2048
ds_read_b128 v[232:235],v18 offset:4096
ds_read_b128 v[236:239],v18 offset:6144
ds_read_b128 v[240:243],v18 offset:8192
ds_read_b128 v[244:247],v18 offset:10240
ds_read_b128 v[248:251],v18 offset:12288
s_waitcnt lgkmcnt(5)
v_mfma_f32_16x16x32_bf16 v[64:67],a[0:3],v[224:227],0
v_min_u32 v27,v224,v228
s_xor_b32 m0,s91,17408
v_mfma_f32_16x16x32_bf16 v[68:71],a[128:131],v[224:227],0
ds_read_b128 v[252:255],v18 offset:14336
v_mfma_f32_16x16x32_bf16 v[64:67],a[4:7],v[228:231],v[64:67]
s_add_u32 s65,s95,32768
v_mfma_f32_16x16x32_bf16 v[68:71],a[132:135],v[228:231],v[68:71]
s_waitcnt vmcnt(7)
s_barrier
ds_read_b128 v[224:227],v18 offset:16384
s_waitcnt lgkmcnt(5)
v_mfma_f32_16x16x32_bf16 v[64:67],a[8:11],v[232:235],v[64:67]
v_min3_u32 v27,v27,v232,v236
buffer_load_dwordx4 v16,s[20:23],s65 offen offset:0 sc1 lds
v_mfma_f32_16x16x32_bf16 v[68:71],a[136:139],v[232:235],v[68:71]
ds_read_b128 v[228:231],v18 offset:18432
v_mfma_f32_16x16x32_bf16 v[64:67],a[12:15],v[236:239],v[64:67]
buffer_load_dwordx4 v16,s[20:23],s65 offen offset:2048 sc1 lds
v_mfma_f32_16x16x32_bf16 v[68:71],a[140:143],v[236:239],v[68:71]
ds_read_b128 v[232:235],v18 offset:20480
s_waitcnt lgkmcnt(5)
v_mfma_f32_16x16x32_bf16 v[64:67],a[16:19],v[240:243],v[64:67]
v_min3_u32 v27,v27,v240,v244
s_xor_b32 m0,s91,33792
v_mfma_f32_16x16x32_bf16 v[68:71],a[144:147],v[240:243],v[68:71]
ds_read_b128 v[236:239],v18 offset:22528
v_mfma_f32_16x16x32_bf16 v[64:67],a[20:23],v[244:247],v[64:67]
s_add_u32 s65,s95,65536
v_mfma_f32_16x16x32_bf16 v[68:71],a[148:151],v[244:247],v[68:71]
ds_read_b128 v[240:243],v18 offset:24576
s_waitcnt lgkmcnt(5)
v_mfma_f32_16x16x32_bf16 v[64:67],a[24:27],v[248:251],v[64:67]
v_min3_u32 v27,v27,v248,v252
buffer_load_dwordx4 v16,s[20:23],s65 offen offset:0 sc1 lds
v_mfma_f32_16x16x32_bf16 v[68:71],a[152:155],v[248:251],v[68:71]
ds_read_b128 v[244:247],v18 offset:26624
v_mfma_f32_16x16x32_bf16 v[64:67],a[28:31],v[252:255],v[64:67]
buffer_load_dwordx4 v16,s[20:23],s65 offen offset:2048 sc1 lds
v_mfma_f32_16x16x32_bf16 v[68:71],a[156:159],v[252:255],v[68:71]
ds_read_b128 v[248:251],v18 offset:28672
s_waitcnt lgkmcnt(5)
v_mfma_f32_16x16x32_bf16 v[64:67],a[32:35],v[224:227],v[64:67]
v_min3_u32 v27,v27,v224,v228
s_xor_b32 m0,s91,50176
v_mfma_f32_16x16x32_bf16 v[68:71],a[160:163],v[224:227],v[68:71]
ds_read_b128 v[252:255],v18 offset:30720
v_mfma_f32_16x16x32_bf16 v[64:67],a[36:39],v[228:231],v[64:67]
s_add_u32 s65,s95,98304
v_mfma_f32_16x16x32_bf16 v[68:71],a[164:167],v[228:231],v[68:71]
s_waitcnt vmcnt(7)
s_barrier
ds_read_b128 v[224:227],v18 offset:32768
s_waitcnt lgkmcnt(5)
v_mfma_f32_16x16x32_bf16 v[64:67],a[40:43],v[232:235],v[64:67]
v_min3_u32 v27,v27,v232,v236
buffer_load_dwordx4 v16,s[20:23],s65 offen offset:0 sc1 lds
v_mfma_f32_16x16x32_bf16 v[68:71],a[168:171],v[232:235],v[68:71]
ds_read_b128 v[228:231],v18 offset:34816
v_mfma_f32_16x16x32_bf16 v[64:67],a[44:47],v[236:239],v[64:67]
buffer_load_dwordx4 v16,s[20:23],s65 offen offset:2048 sc1 lds
v_mfma_f32_16x16x32_bf16 v[68:71],a[172:175],v[236:239],v[68:71]
ds_read_b128 v[232:235],v18 offset:36864
s_waitcnt lgkmcnt(5)
v_mfma_f32_16x16x32_bf16 v[64:67],a[48:51],v[240:243],v[64:67]
v_min3_u32 v27,v27,v240,v244
v_mfma_f32_16x16x32_bf16 v[68:71],a[176:179],v[240:243],v[68:71]
ds_read_b128 v[236:239],v18 offset:38912
v_mfma_f32_16x16x32_bf16 v[64:67],a[52:55],v[244:247],v[64:67]
buffer_load_dwordx2 v[120:121],v20,s[36:39],s78 offen
v_mfma_f32_16x16x32_bf16 v[68:71],a[180:183],v[244:247],v[68:71]
ds_read_b128 v[240:243],v18 offset:40960
s_waitcnt lgkmcnt(5)
v_mfma_f32_16x16x32_bf16 v[64:67],a[56:59],v[248:251],v[64:67]
v_min3_u32 v27,v27,v248,v252
v_mfma_f32_16x16x32_bf16 v[68:71],a[184:187],v[248:251],v[68:71]
ds_read_b128 v[244:247],v18 offset:43008
v_mfma_f32_16x16x32_bf16 v[64:67],a[60:63],v[252:255],v[64:67]
v_mfma_f32_16x16x32_bf16 v[68:71],a[188:191],v[252:255],v[68:71]
ds_read_b128 v[248:251],v18 offset:45056
s_waitcnt lgkmcnt(5)
v_mfma_f32_16x16x32_bf16 v[64:67],a[64:67],v[224:227],v[64:67]
v_min3_u32 v27,v27,v224,v228
v_mfma_f32_16x16x32_bf16 v[68:71],a[192:195],v[224:227],v[68:71]
ds_read_b128 v[252:255],v18 offset:47104
v_mfma_f32_16x16x32_bf16 v[64:67],a[68:71],v[228:231],v[64:67]
v_mfma_f32_16x16x32_bf16 v[68:71],a[196:199],v[228:231],v[68:71]
ds_read_b128 v[224:227],v18 offset:49152
s_waitcnt lgkmcnt(5)
v_mfma_f32_16x16x32_bf16 v[64:67],a[72:75],v[232:235],v[64:67]
v_min3_u32 v27,v27,v232,v236
v_mfma_f32_16x16x32_bf16 v[68:71],a[200:203],v[232:235],v[68:71]
ds_read_b128 v[228:231],v18 offset:51200
v_mfma_f32_16x16x32_bf16 v[64:67],a[76:79],v[236:239],v[64:67]
v_mfma_f32_16x16x32_bf16 v[68:71],a[204:207],v[236:239],v[68:71]
ds_read_b128 v[232:235],v18 offset:53248
s_waitcnt lgkmcnt(5)
v_mfma_f32_16x16x32_bf16 v[64:67],a[80:83],v[240:243],v[64:67]
s_waitcnt vmcnt(5)
s_barrier
ds_read_b128 v[128:131],v17 offset:0
ds_read_b128 v[132:135],v17 offset:2048
v_mfma_f32_16x16x32_bf16 v[68:71],a[208:211],v[240:243],v[68:71]
ds_read_b128 v[236:239],v18 offset:55296
v_min3_u32 v27,v27,v240,v244
v_mfma_f32_16x16x32_bf16 v[64:67],a[84:87],v[244:247],v[64:67]
ds_read_b128 v[136:139],v17 offset:4096
v_mfma_f32_16x16x32_bf16 v[68:71],a[212:215],v[244:247],v[68:71]
ds_read_b128 v[240:243],v18 offset:57344
s_waitcnt lgkmcnt(8)
v_mfma_f32_16x16x32_bf16 v[64:67],a[88:91],v[248:251],v[64:67]
ds_read_b128 v[140:143],v17 offset:6144
v_min3_u32 v27,v27,v248,v252
v_mfma_f32_16x16x32_bf16 v[68:71],a[216:219],v[248:251],v[68:71]
ds_read_b128 v[244:247],v18 offset:59392
v_mfma_f32_16x16x32_bf16 v[64:67],a[92:95],v[252:255],v[64:67]
ds_read_b128 v[144:147],v17 offset:8192
ds_read_b128 v[148:151],v17 offset:10240
v_mfma_f32_16x16x32_bf16 v[68:71],a[220:223],v[252:255],v[68:71]
ds_read_b128 v[248:251],v18 offset:61440
s_waitcnt lgkmcnt(11)
v_mfma_f32_16x16x32_bf16 v[64:67],a[96:99],v[224:227],v[64:67]
ds_read_b128 v[152:155],v17 offset:12288
v_min3_u32 v27,v27,v224,v228
v_mfma_f32_16x16x32_bf16 v[68:71],a[224:227],v[224:227],v[68:71]
ds_read_b128 v[252:255],v18 offset:63488
v_mfma_f32_16x16x32_bf16 v[64:67],a[100:103],v[228:231],v[64:67]
ds_read_b128 v[156:159],v17 offset:14336
v_mfma_f32_16x16x32_bf16 v[68:71],a[228:231],v[228:231],v[68:71]
s_waitcnt lgkmcnt(10)
v_mfma_f32_16x16x32_bf16 v[64:67],a[104:107],v[232:235],v[64:67]
ds_read_b128 v[160:163],v17 offset:16384
ds_read_b128 v[164:167],v17 offset:18432
v_mfma_f32_16x16x32_bf16 v[68:71],a[232:235],v[232:235],v[68:71]
v_min3_u32 v27,v27,v232,v236
v_mfma_f32_16x16x32_bf16 v[64:67],a[108:111],v[236:239],v[64:67]
ds_read_b128 v[168:171],v17 offset:20480
v_mfma_f32_16x16x32_bf16 v[68:71],a[236:239],v[236:239],v[68:71]
s_waitcnt lgkmcnt(9)
v_mfma_f32_16x16x32_bf16 v[64:67],a[112:115],v[240:243],v[64:67]
ds_read_b128 v[172:175],v17 offset:22528
v_min3_u32 v27,v27,v240,v244
v_mfma_f32_16x16x32_bf16 v[68:71],a[240:243],v[240:243],v[68:71]
v_mfma_f32_16x16x32_bf16 v[64:67],a[116:119],v[244:247],v[64:67]
ds_read_b128 v[176:179],v17 offset:24576
ds_read_b128 v[180:183],v17 offset:26624
v_mfma_f32_16x16x32_bf16 v[68:71],a[244:247],v[244:247],v[68:71]
s_waitcnt lgkmcnt(7)
v_mfma_f32_16x16x32_bf16 v[64:67],a[120:123],v[248:251],v[64:67]
ds_read_b128 v[184:187],v17 offset:28672
v_min3_u32 v27,v27,v248,v252
v_mfma_f32_16x16x32_bf16 v[68:71],a[248:251],v[248:251],v[68:71]
v_mfma_f32_16x16x32_bf16 v[64:67],a[124:127],v[252:255],v[64:67]
ds_read_b128 v[188:191],v17 offset:30720
buffer_load_dword v2,v21,s[20:23],s87 offen sc1
v_mfma_f32_16x16x32_bf16 v[68:71],a[252:255],v[252:255],v[68:71]
s_add_u32 s96,s71,2
v_mfma_f32_16x16x32_bf16 v[72:75],a[128:131],v[128:131],0
v_cmp_eq_u32 vcc,0,v27
s_cbranch_vccnz retry_267
v_mfma_f32_16x16x32_bf16 v[76:79],a[132:135],v[132:135],0
v_min3_u32 v27,v27,v128,v132
v_mfma_f32_16x16x32_bf16 v[72:75],a[136:139],v[136:139],v[72:75]
s_waitcnt vmcnt(2)
s_barrier
ds_read_b128 v[192:195],v17 offset:32768
v_mfma_f32_16x16x32_bf16 v[76:79],a[140:143],v[140:143],v[76:79]
ds_read_b128 v[196:199],v17 offset:34816
s_waitcnt lgkmcnt(10)
v_mfma_f32_16x16x32_bf16 v[72:75],a[144:147],v[144:147],v[72:75]
ds_read_b128 v[200:203],v17 offset:36864
v_min3_u32 v27,v27,v136,v140
s_waitcnt vmcnt(1)
v_mfma_f32_16x16x32_bf16 v[76:79],a[148:151],v[148:151],v[76:79]
ds_read_b128 v[204:207],v17 offset:38912
v_min3_u32 v27,v27,v144,v148
v_and_or_b32 v64,v64,-4,s48
v_mfma_f32_16x16x32_bf16 v[72:75],a[152:155],v[152:155],v[72:75]
ds_read_b128 v[208:211],v17 offset:40960
s_add_u32 s64,s49,s34
v_mfma_f32_16x16x32_bf16 v[76:79],a[156:159],v[156:159],v[76:79]
v_min3_u32 v27,v27,v152,v156
s_waitcnt lgkmcnt(9)
v_mfma_f32_16x16x32_bf16 v[72:75],a[160:163],v[160:163],v[72:75]
ds_read_b128 v[212:215],v17 offset:43008
buffer_store_dwordx4 v[64:67],v25,s[20:23],s64 offen offset:2048 sc1
v_mfma_f32_16x16x32_bf16 v[76:79],a[164:167],v[164:167],v[76:79]
ds_read_b128 v[216:219],v17 offset:45056
v_min3_u32 v27,v27,v160,v164
v_and_or_b32 v68,v68,-4,s48
v_mfma_f32_16x16x32_bf16 v[72:75],a[168:171],v[168:171],v[72:75]
ds_read_b128 v[220:223],v17 offset:47104
s_add_u32 s64,s49,s35
v_mfma_f32_16x16x32_bf16 v[76:79],a[172:175],v[172:175],v[76:79]
ds_read_b128 v[224:227],v17 offset:49152
s_waitcnt lgkmcnt(9)
v_mfma_f32_16x16x32_bf16 v[72:75],a[176:179],v[176:179],v[72:75]
ds_read_b128 v[228:231],v17 offset:51200
v_min3_u32 v27,v27,v168,v172
v_mfma_f32_16x16x32_bf16 v[76:79],a[180:183],v[180:183],v[76:79]
v_min3_u32 v27,v27,v176,v180
buffer_store_dwordx4 v[68:71],v25,s[20:23],s64 offen offset:3072 sc1
v_mfma_f32_16x16x32_bf16 v[72:75],a[184:187],v[184:187],v[72:75]
ds_read_b128 v[232:235],v17 offset:53248
s_mov_b32 s49,0x7fff0000
v_mfma_f32_16x16x32_bf16 v[76:79],a[188:191],v[188:191],v[76:79]
ds_read_b128 v[236:239],v17 offset:55296
s_waitcnt lgkmcnt(8)
v_mfma_f32_16x16x32_bf16 v[72:75],a[192:195],v[192:195],v[72:75]
ds_read_b128 v[240:243],v17 offset:57344
v_min3_u32 v27,v27,v184,v188
v_mfma_f32_16x16x32_bf16 v[76:79],a[196:199],v[196:199],v[76:79]
ds_read_b128 v[244:247],v17 offset:59392
v_min3_u32 v27,v27,v192,v196
v_mfma_f32_16x16x32_bf16 v[72:75],a[200:203],v[200:203],v[72:75]
ds_read_b128 v[248:251],v17 offset:61440
ds_bpermute_b32 v124,v41,v120
v_mfma_f32_16x16x32_bf16 v[76:79],a[204:207],v[204:207],v[76:79]
v_min3_u32 v27,v27,v200,v204
s_waitcnt lgkmcnt(8)
v_mfma_f32_16x16x32_bf16 v[72:75],a[208:211],v[208:211],v[72:75]
ds_read_b128 v[252:255],v17 offset:63488
ds_bpermute_b32 v125,v41,v121
v_mfma_f32_16x16x32_bf16 v[76:79],a[212:215],v[212:215],v[76:79]
v_min3_u32 v27,v27,v208,v212
v_mfma_f32_16x16x32_bf16 v[72:75],a[216:219],v[216:219],v[72:75]
v_mfma_f32_16x16x32_bf16 v[76:79],a[220:223],v[220:223],v[76:79]
v_min3_u32 v27,v27,v216,v220
s_waitcnt lgkmcnt(6)
v_mfma_f32_16x16x32_bf16 v[72:75],a[224:227],v[224:227],v[72:75]
s_waitcnt lgkmcnt(0)
v_mfma_f32_16x16x32_bf16 v[76:79],a[228:231],v[228:231],v[76:79]
v_min3_u32 v27,v27,v224,v228
v_mfma_f32_16x16x32_bf16 v[72:75],a[232:235],v[232:235],v[72:75]
v_lshlrev_b32 v104,16,v124
v_mfma_f32_16x16x32_bf16 v[76:79],a[236:239],v[236:239],v[76:79]
v_min3_u32 v27,v27,v232,v236
v_mfma_f32_16x16x32_bf16 v[72:75],a[240:243],v[240:243],v[72:75]
v_mfma_f32_16x16x32_bf16 v[76:79],a[244:247],v[244:247],v[76:79]
v_min3_u32 v27,v27,v240,v244
v_mfma_f32_16x16x32_bf16 v[72:75],a[248:251],v[248:251],v[72:75]
v_and_b32 v105,s80,v124
v_mfma_f32_16x16x32_bf16 v[76:79],a[252:255],v[252:255],v[76:79]
v_min3_u32 v27,v27,v248,v252
v_mfma_f32_16x16x32_bf16 v[80:83],a[0:3],v[128:131],0
v_cmp_eq_u32 vcc,0,v27
s_cbranch_vccnz retry_267
v_mfma_f32_16x16x32_bf16 v[84:87],a[4:7],v[132:135],0
v_lshlrev_b32 v106,16,v125
v_mfma_f32_16x16x32_bf16 v[80:83],a[8:11],v[136:139],v[80:83]
v_mfma_f32_16x16x32_bf16 v[84:87],a[12:15],v[140:143],v[84:87]
v_mfma_f32_16x16x32_bf16 v[80:83],a[16:19],v[144:147],v[80:83]
v_and_b32 v107,s80,v125
v_add_f32 v72,v72,v76
v_mfma_f32_16x16x32_bf16 v[84:87],a[20:23],v[148:151],v[84:87]
v_add_f32 v73,v73,v77
v_add_f32 v74,v74,v78
v_mfma_f32_16x16x32_bf16 v[80:83],a[24:27],v[152:155],v[80:83]
v_add_f32 v75,v75,v79
v_and_or_b32 v72,v72,-4,s48
v_mfma_f32_16x16x32_bf16 v[84:87],a[28:31],v[156:159],v[84:87]
s_add_u32 s64,s77,s33
v_mfma_f32_16x16x32_bf16 v[80:83],a[32:35],v[160:163],v[80:83]
buffer_store_dwordx4 v[72:75],v25,s[20:23],s64 offen offset:1024 sc1
v_mfma_f32_16x16x32_bf16 v[84:87],a[36:39],v[164:167],v[84:87]
v_mfma_f32_16x16x32_bf16 v[80:83],a[40:43],v[168:171],v[80:83]
v_mfma_f32_16x16x32_bf16 v[84:87],a[44:47],v[172:175],v[84:87]
v_mfma_f32_16x16x32_bf16 v[80:83],a[48:51],v[176:179],v[80:83]
v_mfma_f32_16x16x32_bf16 v[84:87],a[52:55],v[180:183],v[84:87]
v_mfma_f32_16x16x32_bf16 v[80:83],a[56:59],v[184:187],v[80:83]
v_mfma_f32_16x16x32_bf16 v[84:87],a[60:63],v[188:191],v[84:87]
v_mfma_f32_16x16x32_bf16 v[80:83],a[64:67],v[192:195],v[80:83]
buffer_load_dwordx4 v[96:99],v26,s[20:23],s77 offen offset:2048 sc1
v_mfma_f32_16x16x32_bf16 v[84:87],a[68:71],v[196:199],v[84:87]
buffer_load_dwordx4 v[100:103],v26,s[20:23],s77 offen offset:3072 sc1
v_mfma_f32_16x16x32_bf16 v[80:83],a[72:75],v[200:203],v[80:83]
v_mfma_f32_16x16x32_bf16 v[84:87],a[76:79],v[204:207],v[84:87]
v_mfma_f32_16x16x32_bf16 v[80:83],a[80:83],v[208:211],v[80:83]
s_waitcnt vmcnt(5)
v_mfma_f32_16x16x32_bf16 v[84:87],a[84:87],v[212:215],v[84:87]
v_cmp_gt_u32 vcc,s96,v2
s_mov_b32 s96,vcc_lo
v_mfma_f32_16x16x32_bf16 v[80:83],a[88:91],v[216:219],v[80:83]
v_mov_b32 v44,s96
ds_write_b32 v46,v44
v_mfma_f32_16x16x32_bf16 v[84:87],a[92:95],v[220:223],v[84:87]
v_mfma_f32_16x16x32_bf16 v[80:83],a[96:99],v[224:227],v[80:83]
v_mfma_f32_16x16x32_bf16 v[84:87],a[100:103],v[228:231],v[84:87]
v_mfma_f32_16x16x32_bf16 v[80:83],a[104:107],v[232:235],v[80:83]
buffer_load_dwordx4 v[92:95],v26,s[20:23],s77 offen offset:1024 sc1
v_mfma_f32_16x16x32_bf16 v[84:87],a[108:111],v[236:239],v[84:87]
v_mfma_f32_16x16x32_bf16 v[80:83],a[112:115],v[240:243],v[80:83]
v_mfma_f32_16x16x32_bf16 v[84:87],a[116:119],v[244:247],v[84:87]
v_mfma_f32_16x16x32_bf16 v[80:83],a[120:123],v[248:251],v[80:83]
v_mfma_f32_16x16x32_bf16 v[84:87],a[124:127],v[252:255],v[84:87]
epi_270:
buffer_load_dword v29,v21,s[20:23],s87 offen sc1
s_nop 6
v_pk_add_f32 v[88:89],v[80:81],v[84:85]
v_pk_add_f32 v[90:91],v[82:83],v[86:87]
s_waitcnt vmcnt(1)
s_branch ic_277
ip_275:
buffer_load_dwordx4 v[92:95],v26,s[20:23],s77 offen offset:1024 sc1
buffer_load_dwordx4 v[96:99],v26,s[20:23],s77 offen offset:2048 sc1
buffer_load_dwordx4 v[100:103],v26,s[20:23],s77 offen offset:3072 sc1
s_waitcnt vmcnt(0)
ic_277:
v_bitop3_b32 v22,v92,v96,v100 bitop3:0x80
v_and_b32 v22,s48,v22
v_cmp_eq_u32 vcc,0,v22
s_cbranch_vccz ik_276
s_sub_u32 s90,s90,1
s_cmp_gt_i32 s90,0
s_cbranch_scc1 ip_275
ik_276:
v_pk_add_f32 v[88:89],v[88:89],v[92:93]
v_pk_add_f32 v[96:97],v[96:97],v[100:101]
v_pk_add_f32 v[90:91],v[90:91],v[94:95]
v_pk_add_f32 v[98:99],v[98:99],v[102:103]
v_pk_add_f32 v[88:89],v[88:89],v[96:97]
v_pk_add_f32 v[90:91],v[90:91],v[98:99]
v_pk_fma_f32 v[88:89],v[88:89],v[52:53],v[104:105]
v_pk_fma_f32 v[90:91],v[90:91],v[54:55],v[106:107]
v_cvt_pk_bf16_f32 v88,v88,v89
v_cvt_pk_bf16_f32 v89,v90,v91
v_max_u32 v88,1,v88
ds_bpermute_b32 v88,v40,v88
ds_bpermute_b32 v89,v40,v89
v_xor_b32 v18,0x10000,v18
s_xor_b32 s49,s77,524288
s_cselect_b32 s64,0,3
s_xor_b32 s48,s48,s64
s_waitcnt lgkmcnt(0)
buffer_store_dwordx2 v[88:89],v19,s[20:23],s70 offen sc1
s_mov_b32 s77,s49
s_add_u32 s78,s78,65536
s_cmp_gt_u32 s71,51
s_cselect_b32 s65,s73,0x7fff0000
s_cselect_b32 s97,0x7fff0000,s73
v_mov_b32 v22,s71
buffer_store_dword v22,v23,s[20:23],s65 offen sc1
v_xor_b32 v17,0x10000,v17
v_xor_b32 v45,16,v45
v_xor_b32 v46,16,v46
s_xor_b32 s72,s72,0x10000
s_add_u32 s70,s70,2097152
s_xor_b32 s70,s70,0x2000
s_add_u32 s71,s71,1
s_cmp_le_u32 s71,64
s_cbranch_scc1 seg_268
s_endpgm
retry_267:
s_sub_u32 s90,s90,64
s_cmp_lt_i32 s90,0
s_cbranch_scc1 giveup_176
s_mov_b32 s83,1
s_waitcnt vmcnt(0) lgkmcnt(0)
s_barrier
s_branch seg_268
r_w4_195:
s_load_dwordx2 s[4:5],s[0:1],88
s_load_dwordx2 s[6:7],s[0:1],112
s_lshr_b32 s41,s59,3
s_and_b32 s42,s59,7
s_mul_i32 s66,s41,1835008
s_lshl_b32 s64,s42,8
s_add_u32 s66,s66,s64
s_lshl_b32 s67,s50,1
s_and_b32 s64,s41,1
s_add_u32 s67,s67,s64
s_waitcnt lgkmcnt(0)
s_mov_b32 s32,s4
s_and_b32 s33,s5,0xffff
s_mov_b32 s34,0x700000
s_mov_b32 s35,0x20000
s_sub_u32 s36,s6,0x1000
s_subb_u32 s37,s7,0
s_and_b32 s37,s37,0xffff
s_mov_b32 s38,0x401000
s_mov_b32 s39,0x20000
v_lshrrev_b32 v5,2,v3
v_lshl_add_u32 v5,v4,2,v5
v_and_b32 v6,3,v3
v_lshlrev_b32 v6,3,v6
v_lshl_add_u32 v6,v5,8,v6
v_and_b32 v5,7,v5
v_xor_b32 v5,s67,v5
v_lshl_add_u32 v12,v5,5,v6
v_xor_b32 v13,32,v12
v_and_b32 v5,15,v1
v_and_b32 v6,3,v4
v_lshlrev_b32 v6,1,v6
v_xor_b32 v5,v5,v6
v_mul_u32_u24 v6,2048,v4
v_xor_b32 v7,0,v5
v_lshl_add_u32 v8,v7,4,v6
v_xor_b32 v7,8,v5
v_lshl_add_u32 v9,v7,4,v6
s_mul_i32 s74,s50,131072
s_add_u32 s74,s74,s66
s_lshl_b32 s75,s50,14
s_mul_i32 s76,s50,65536
s_add_u32 s76,s76,s66
s_lshl_b32 s77,s50,13
s_add_u32 s64,s74,0
s_add_u32 m0,s75,0
s_nop 0
buffer_load_dwordx4 v8,s[32:35],s64 offen nt lds
s_add_u32 s64,s74,8192
s_add_u32 m0,s75,1024
s_nop 0
buffer_load_dwordx4 v9,s[32:35],s64 offen nt lds
s_add_u32 s64,s74,16384
s_add_u32 m0,s75,2048
s_nop 0
buffer_load_dwordx4 v8,s[32:35],s64 offen nt lds
s_add_u32 s64,s74,24576
s_add_u32 m0,s75,3072
s_nop 0
buffer_load_dwordx4 v9,s[32:35],s64 offen nt lds
s_add_u32 s64,s74,32768
s_add_u32 m0,s75,4096
s_nop 0
buffer_load_dwordx4 v8,s[32:35],s64 offen nt lds
s_add_u32 s64,s74,40960
s_add_u32 m0,s75,5120
s_nop 0
buffer_load_dwordx4 v9,s[32:35],s64 offen nt lds
s_add_u32 s64,s74,49152
s_add_u32 m0,s75,6144
s_nop 0
buffer_load_dwordx4 v8,s[32:35],s64 offen nt lds
s_add_u32 s64,s74,57344
s_add_u32 m0,s75,7168
s_nop 0
buffer_load_dwordx4 v9,s[32:35],s64 offen nt lds
s_add_u32 s64,s74,65536
s_add_u32 m0,s75,8192
s_nop 0
buffer_load_dwordx4 v8,s[32:35],s64 offen nt lds
s_add_u32 s64,s74,73728
s_add_u32 m0,s75,9216
s_nop 0
buffer_load_dwordx4 v9,s[32:35],s64 offen nt lds
s_add_u32 s64,s74,81920
s_add_u32 m0,s75,10240
s_nop 0
buffer_load_dwordx4 v8,s[32:35],s64 offen nt lds
s_add_u32 s64,s74,90112
s_add_u32 m0,s75,11264
s_nop 0
buffer_load_dwordx4 v9,s[32:35],s64 offen nt lds
s_add_u32 s64,s74,98304
s_add_u32 m0,s75,12288
s_nop 0
buffer_load_dwordx4 v8,s[32:35],s64 offen nt lds
s_add_u32 s64,s74,106496
s_add_u32 m0,s75,13312
s_nop 0
buffer_load_dwordx4 v9,s[32:35],s64 offen nt lds
s_add_u32 s64,s74,114688
s_add_u32 m0,s75,14336
s_nop 0
buffer_load_dwordx4 v8,s[32:35],s64 offen nt lds
s_add_u32 s64,s74,122880
s_add_u32 m0,s75,15360
s_nop 0
buffer_load_dwordx4 v9,s[32:35],s64 offen nt lds
s_add_u32 s64,s74,524288
s_add_u32 m0,s75,65536
s_nop 0
buffer_load_dwordx4 v8,s[32:35],s64 offen nt lds
s_add_u32 s64,s74,532480
s_add_u32 m0,s75,66560
s_nop 0
buffer_load_dwordx4 v9,s[32:35],s64 offen nt lds
s_add_u32 s64,s74,540672
s_add_u32 m0,s75,67584
s_nop 0
buffer_load_dwordx4 v8,s[32:35],s64 offen nt lds
s_add_u32 s64,s74,548864
s_add_u32 m0,s75,68608
s_nop 0
buffer_load_dwordx4 v9,s[32:35],s64 offen nt lds
s_add_u32 s64,s74,557056
s_add_u32 m0,s75,69632
s_nop 0
buffer_load_dwordx4 v8,s[32:35],s64 offen nt lds
s_add_u32 s64,s74,565248
s_add_u32 m0,s75,70656
s_nop 0
buffer_load_dwordx4 v9,s[32:35],s64 offen nt lds
s_add_u32 s64,s74,573440
s_add_u32 m0,s75,71680
s_nop 0
buffer_load_dwordx4 v8,s[32:35],s64 offen nt lds
s_add_u32 s64,s74,581632
s_add_u32 m0,s75,72704
s_nop 0
buffer_load_dwordx4 v9,s[32:35],s64 offen nt lds
s_add_u32 s64,s74,589824
s_add_u32 m0,s75,73728
s_nop 0
buffer_load_dwordx4 v8,s[32:35],s64 offen nt lds
s_add_u32 s64,s74,598016
s_add_u32 m0,s75,74752
s_nop 0
buffer_load_dwordx4 v9,s[32:35],s64 offen nt lds
s_add_u32 s64,s74,606208
s_add_u32 m0,s75,75776
s_nop 0
buffer_load_dwordx4 v8,s[32:35],s64 offen nt lds
s_add_u32 s64,s74,614400
s_add_u32 m0,s75,76800
s_nop 0
buffer_load_dwordx4 v9,s[32:35],s64 offen nt lds
s_add_u32 s64,s74,622592
s_add_u32 m0,s75,77824
s_nop 0
buffer_load_dwordx4 v8,s[32:35],s64 offen nt lds
s_add_u32 s64,s74,630784
s_add_u32 m0,s75,78848
s_nop 0
buffer_load_dwordx4 v9,s[32:35],s64 offen nt lds
s_add_u32 s64,s74,638976
s_add_u32 m0,s75,79872
s_nop 0
buffer_load_dwordx4 v8,s[32:35],s64 offen nt lds
s_add_u32 s64,s74,647168
s_add_u32 m0,s75,80896
s_nop 0
buffer_load_dwordx4 v9,s[32:35],s64 offen nt lds
s_waitcnt vmcnt(16)
s_barrier
ds_read_b64_tr_b16 a[0:1],v12 offset:0
ds_read_b64_tr_b16 a[112:113],v13 offset:0
ds_read_b64_tr_b16 a[2:3],v12 offset:4096
ds_read_b64_tr_b16 a[114:115],v13 offset:4096
ds_read_b64_tr_b16 a[4:5],v12 offset:8192
ds_read_b64_tr_b16 a[116:117],v13 offset:8192
ds_read_b64_tr_b16 a[6:7],v12 offset:12288
ds_read_b64_tr_b16 a[118:119],v13 offset:12288
s_waitcnt lgkmcnt(4)
ds_read_b64_tr_b16 a[8:9],v12 offset:16384
ds_read_b64_tr_b16 a[120:121],v13 offset:16384
ds_read_b64_tr_b16 a[10:11],v12 offset:20480
ds_read_b64_tr_b16 a[122:123],v13 offset:20480
ds_read_b64_tr_b16 a[12:13],v12 offset:28672
ds_read_b64_tr_b16 a[124:125],v13 offset:28672
ds_read_b64_tr_b16 a[14:15],v12 offset:32768
ds_read_b64_tr_b16 a[126:127],v13 offset:32768
s_waitcnt lgkmcnt(4)
ds_read_b64_tr_b16 a[16:17],v12 offset:36864
ds_read_b64_tr_b16 a[128:129],v13 offset:36864
ds_read_b64_tr_b16 a[18:19],v12 offset:40960
ds_read_b64_tr_b16 a[130:131],v13 offset:40960
ds_read_b64_tr_b16 a[20:21],v12 offset:45056
ds_read_b64_tr_b16 a[132:133],v13 offset:45056
ds_read_b64_tr_b16 a[22:23],v12 offset:49152
ds_read_b64_tr_b16 a[134:135],v13 offset:49152
s_waitcnt lgkmcnt(4)
ds_read_b64_tr_b16 a[24:25],v12 offset:57344
ds_read_b64_tr_b16 a[136:137],v13 offset:57344
ds_read_b64_tr_b16 a[26:27],v12 offset:61440
ds_read_b64_tr_b16 a[138:139],v13 offset:61440
ds_read_b64_tr_b16 a[96:97],v12 offset:24576
ds_read_b64_tr_b16 a[208:209],v13 offset:24576
ds_read_b64_tr_b16 a[98:99],v12 offset:53248
ds_read_b64_tr_b16 a[210:211],v13 offset:53248
s_waitcnt lgkmcnt(4)
v_xor_b32 v12,0x10000,v12
v_xor_b32 v13,0x10000,v13
s_waitcnt lgkmcnt(0)
s_barrier
s_add_u32 s64,s74,1048576
s_add_u32 m0,s75,0
s_nop 0
buffer_load_dwordx4 v8,s[32:35],s64 offen nt lds
s_add_u32 s64,s74,1056768
s_add_u32 m0,s75,1024
s_nop 0
buffer_load_dwordx4 v9,s[32:35],s64 offen nt lds
s_add_u32 s64,s74,1064960
s_add_u32 m0,s75,2048
s_nop 0
buffer_load_dwordx4 v8,s[32:35],s64 offen nt lds
s_add_u32 s64,s74,1073152
s_add_u32 m0,s75,3072
s_nop 0
buffer_load_dwordx4 v9,s[32:35],s64 offen nt lds
s_add_u32 s64,s74,1081344
s_add_u32 m0,s75,4096
s_nop 0
buffer_load_dwordx4 v8,s[32:35],s64 offen nt lds
s_add_u32 s64,s74,1089536
s_add_u32 m0,s75,5120
s_nop 0
buffer_load_dwordx4 v9,s[32:35],s64 offen nt lds
s_add_u32 s64,s74,1097728
s_add_u32 m0,s75,6144
s_nop 0
buffer_load_dwordx4 v8,s[32:35],s64 offen nt lds
s_add_u32 s64,s74,1105920
s_add_u32 m0,s75,7168
s_nop 0
buffer_load_dwordx4 v9,s[32:35],s64 offen nt lds
s_add_u32 s64,s74,1114112
s_add_u32 m0,s75,8192
s_nop 0
buffer_load_dwordx4 v8,s[32:35],s64 offen nt lds
s_add_u32 s64,s74,1122304
s_add_u32 m0,s75,9216
s_nop 0
buffer_load_dwordx4 v9,s[32:35],s64 offen nt lds
s_add_u32 s64,s74,1130496
s_add_u32 m0,s75,10240
s_nop 0
buffer_load_dwordx4 v8,s[32:35],s64 offen nt lds
s_add_u32 s64,s74,1138688
s_add_u32 m0,s75,11264
s_nop 0
buffer_load_dwordx4 v9,s[32:35],s64 offen nt lds
s_add_u32 s64,s74,1146880
s_add_u32 m0,s75,12288
s_nop 0
buffer_load_dwordx4 v8,s[32:35],s64 offen nt lds
s_add_u32 s64,s74,1155072
s_add_u32 m0,s75,13312
s_nop 0
buffer_load_dwordx4 v9,s[32:35],s64 offen nt lds
s_add_u32 s64,s74,1163264
s_add_u32 m0,s75,14336
s_nop 0
buffer_load_dwordx4 v8,s[32:35],s64 offen nt lds
s_add_u32 s64,s74,1171456
s_add_u32 m0,s75,15360
s_nop 0
buffer_load_dwordx4 v9,s[32:35],s64 offen nt lds
s_waitcnt vmcnt(16)
s_barrier
ds_read_b64_tr_b16 a[28:29],v12 offset:0
ds_read_b64_tr_b16 a[140:141],v13 offset:0
ds_read_b64_tr_b16 a[30:31],v12 offset:4096
ds_read_b64_tr_b16 a[142:143],v13 offset:4096
ds_read_b64_tr_b16 a[32:33],v12 offset:8192
ds_read_b64_tr_b16 a[144:145],v13 offset:8192
ds_read_b64_tr_b16 a[34:35],v12 offset:12288
ds_read_b64_tr_b16 a[146:147],v13 offset:12288
s_waitcnt lgkmcnt(4)
ds_read_b64_tr_b16 a[36:37],v12 offset:20480
ds_read_b64_tr_b16 a[148:149],v13 offset:20480
ds_read_b64_tr_b16 a[38:39],v12 offset:24576
ds_read_b64_tr_b16 a[150:151],v13 offset:24576
ds_read_b64_tr_b16 a[40:41],v12 offset:28672
ds_read_b64_tr_b16 a[152:153],v13 offset:28672
ds_read_b64_tr_b16 a[42:43],v12 offset:32768
ds_read_b64_tr_b16 a[154:155],v13 offset:32768
s_waitcnt lgkmcnt(4)
ds_read_b64_tr_b16 a[44:45],v12 offset:36864
ds_read_b64_tr_b16 a[156:157],v13 offset:36864
ds_read_b64_tr_b16 a[46:47],v12 offset:40960
ds_read_b64_tr_b16 a[158:159],v13 offset:40960
ds_read_b64_tr_b16 a[48:49],v12 offset:49152
ds_read_b64_tr_b16 a[160:161],v13 offset:49152
ds_read_b64_tr_b16 a[50:51],v12 offset:53248
ds_read_b64_tr_b16 a[162:163],v13 offset:53248
s_waitcnt lgkmcnt(4)
ds_read_b64_tr_b16 a[52:53],v12 offset:57344
ds_read_b64_tr_b16 a[164:165],v13 offset:57344
ds_read_b64_tr_b16 a[54:55],v12 offset:61440
ds_read_b64_tr_b16 a[166:167],v13 offset:61440
ds_read_b64_tr_b16 a[100:101],v12 offset:16384
ds_read_b64_tr_b16 a[212:213],v13 offset:16384
ds_read_b64_tr_b16 a[102:103],v12 offset:45056
ds_read_b64_tr_b16 a[214:215],v13 offset:45056
s_waitcnt lgkmcnt(4)
v_xor_b32 v12,0x10000,v12
v_xor_b32 v13,0x10000,v13
s_waitcnt lgkmcnt(0)
s_barrier
s_add_u32 s64,s76,1572864
s_add_u32 m0,s77,65536
s_nop 0
buffer_load_dwordx4 v8,s[32:35],s64 offen nt lds
s_add_u32 s64,s76,1581056
s_add_u32 m0,s77,66560
s_nop 0
buffer_load_dwordx4 v9,s[32:35],s64 offen nt lds
s_add_u32 s64,s76,1589248
s_add_u32 m0,s77,67584
s_nop 0
buffer_load_dwordx4 v8,s[32:35],s64 offen nt lds
s_add_u32 s64,s76,1597440
s_add_u32 m0,s77,68608
s_nop 0
buffer_load_dwordx4 v9,s[32:35],s64 offen nt lds
s_add_u32 s64,s76,1605632
s_add_u32 m0,s77,69632
s_nop 0
buffer_load_dwordx4 v8,s[32:35],s64 offen nt lds
s_add_u32 s64,s76,1613824
s_add_u32 m0,s77,70656
s_nop 0
buffer_load_dwordx4 v9,s[32:35],s64 offen nt lds
s_add_u32 s64,s76,1622016
s_add_u32 m0,s77,71680
s_nop 0
buffer_load_dwordx4 v8,s[32:35],s64 offen nt lds
s_add_u32 s64,s76,1630208
s_add_u32 m0,s77,72704
s_nop 0
buffer_load_dwordx4 v9,s[32:35],s64 offen nt lds
s_waitcnt vmcnt(8)
s_barrier
ds_read_b64_tr_b16 a[56:57],v12 offset:0
ds_read_b64_tr_b16 a[168:169],v13 offset:0
ds_read_b64_tr_b16 a[58:59],v12 offset:4096
ds_read_b64_tr_b16 a[170:171],v13 offset:4096
ds_read_b64_tr_b16 a[60:61],v12 offset:12288
ds_read_b64_tr_b16 a[172:173],v13 offset:12288
ds_read_b64_tr_b16 a[62:63],v12 offset:16384
ds_read_b64_tr_b16 a[174:175],v13 offset:16384
s_waitcnt lgkmcnt(4)
ds_read_b64_tr_b16 a[64:65],v12 offset:20480
ds_read_b64_tr_b16 a[176:177],v13 offset:20480
ds_read_b64_tr_b16 a[66:67],v12 offset:24576
ds_read_b64_tr_b16 a[178:179],v13 offset:24576
ds_read_b64_tr_b16 a[68:69],v12 offset:28672
ds_read_b64_tr_b16 a[180:181],v13 offset:28672
ds_read_b64_tr_b16 a[70:71],v12 offset:32768
ds_read_b64_tr_b16 a[182:183],v13 offset:32768
s_waitcnt lgkmcnt(4)
ds_read_b64_tr_b16 a[72:73],v12 offset:40960
ds_read_b64_tr_b16 a[184:185],v13 offset:40960
ds_read_b64_tr_b16 a[74:75],v12 offset:45056
ds_read_b64_tr_b16 a[186:187],v13 offset:45056
ds_read_b64_tr_b16 a[76:77],v12 offset:49152
ds_read_b64_tr_b16 a[188:189],v13 offset:49152
ds_read_b64_tr_b16 a[78:79],v12 offset:53248
ds_read_b64_tr_b16 a[190:191],v13 offset:53248
s_waitcnt lgkmcnt(4)
ds_read_b64_tr_b16 a[80:81],v12 offset:57344
ds_read_b64_tr_b16 a[192:193],v13 offset:57344
ds_read_b64_tr_b16 a[82:83],v12 offset:61440
ds_read_b64_tr_b16 a[194:195],v13 offset:61440
ds_read_b64_tr_b16 a[104:105],v12 offset:8192
ds_read_b64_tr_b16 a[216:217],v13 offset:8192
ds_read_b64_tr_b16 a[106:107],v12 offset:36864
ds_read_b64_tr_b16 a[218:219],v13 offset:36864
s_waitcnt lgkmcnt(4)
v_xor_b32 v12,0x10000,v12
v_xor_b32 v13,0x10000,v13
s_waitcnt lgkmcnt(0)
s_barrier
s_waitcnt vmcnt(0)
s_barrier
ds_read_b64_tr_b16 a[84:85],v12 offset:4096
ds_read_b64_tr_b16 a[196:197],v13 offset:4096
ds_read_b64_tr_b16 a[86:87],v12 offset:8192
ds_read_b64_tr_b16 a[198:199],v13 offset:8192
ds_read_b64_tr_b16 a[88:89],v12 offset:12288
ds_read_b64_tr_b16 a[200:201],v13 offset:12288
ds_read_b64_tr_b16 a[90:91],v12 offset:16384
ds_read_b64_tr_b16 a[202:203],v13 offset:16384
s_waitcnt lgkmcnt(4)
ds_read_b64_tr_b16 a[92:93],v12 offset:20480
ds_read_b64_tr_b16 a[204:205],v13 offset:20480
ds_read_b64_tr_b16 a[94:95],v12 offset:24576
ds_read_b64_tr_b16 a[206:207],v13 offset:24576
ds_read_b64_tr_b16 a[108:109],v12 offset:0
ds_read_b64_tr_b16 a[220:221],v13 offset:0
ds_read_b64_tr_b16 a[110:111],v12 offset:28672
ds_read_b64_tr_b16 a[222:223],v13 offset:28672
s_waitcnt lgkmcnt(4)
v_xor_b32 v12,0x10000,v12
v_xor_b32 v13,0x10000,v13
s_waitcnt lgkmcnt(0)
s_barrier
v_and_b32 v21,1,v1
v_mul_u32_u24 v21,960,v21
s_mov_b32 s65,21052032
s_mov_b32 s66,1792
pl_280:
buffer_load_dword v22,v21,s[20:23],s65 offen sc1
s_waitcnt vmcnt(0)
v_cmp_gt_u32 vcc,s66,v22
s_cbranch_vccz pok_281
s_sleep 1
s_sub_u32 s90,s90,1
s_cmp_gt_i32 s90,0
s_cbranch_scc1 pl_280
pok_281:
s_lshr_b32 s43,s41,1
s_and_b32 s48,s41,1
s_lshl_b32 s64,s42,7
s_lshl_b32 s65,s50,5
s_add_u32 s64,s64,s65
s_lshl_b32 s65,s48,4
s_add_u32 s64,s64,s65
v_lshl_add_u32 v5,v4,2,s64
v_lshlrev_b32 v6,2,v5
s_mov_b32 s64,20480
buffer_load_dwordx4 v[52:55],v6,s[20:23],s64 offen sc1
v_lshlrev_b32 v10,1,v5
v_and_b32 v6,3,v1
v_sub_u32 v5,v6,v4
v_lshl_add_u32 v5,v5,3,v10
v_lshrrev_b32 v11,2,v1
v_lshl_add_u32 v40,v6,4,v11
v_lshlrev_b32 v40,2,v40
v_lshl_add_u32 v41,v3,2,v4
v_lshlrev_b32 v41,2,v41
s_lshl_b32 s64,s43,10
v_add_u32 v17,s64,v16
v_xor_b32 v18,1024,v17
s_xor_b32 s64,s64,1024
s_lshr_b32 s65,s50,1
s_and_b32 s66,s50,1
s_lshl_b32 s66,s66,12
s_add_u32 s66,s66,s64
s_lshl_b32 s72,s65,13
s_add_u32 s72,s72,s66
s_add_u32 s72,s72,0x10000
s_lshl_b32 s65,s65,14
s_add_u32 s75,s65,s66
s_add_u32 s75,s75,1327104
s_mul_i32 s64,s41,114688
s_add_u32 s75,s75,s64
s_cmp_lt_u32 s50,2
s_cselect_b32 s86,98304,0x40000000
s_lshl_b32 s76,s79,21
s_add_u32 s76,s76,27262976
s_mov_b32 s77,0
s_lshl_b32 s78,s79,16
s_mov_b32 s49,0
s_cmp_eq_u32 s79,0
s_mov_b32 s66,8577024
s_cselect_b32 s66,18874368,s66
s_lshl_b32 s64,s59,14
s_lshl_b32 s65,s50,12
s_add_u32 s65,s65,s66
s_add_u32 s64,s64,s65
v_add_u32 v26,s64,v16
s_lshl_b32 s64,s42,14
s_add_u32 s64,s64,s65
v_add_u32 v25,s64,v16
s_xor_b32 s33,s41,1
s_xor_b32 s34,s41,2
s_xor_b32 s35,s41,3
s_lshl_b32 s33,s33,17
s_lshl_b32 s34,s34,17
s_lshl_b32 s35,s35,17
v_and_b32 v21,7,v1
v_lshlrev_b32 v21,7,v21
v_bfe_u32 v6,v1,3,2
v_lshl_add_u32 v21,v6,2,v21
s_lshl_b32 s74,s41,10
s_add_u32 s74,s74,s63
s_lshl_b32 s64,s60,4
s_add_u32 s74,s74,s64
s_add_u32 s74,s74,20480
s_lshl_b32 s64,s43,4
v_add_u32 v6,s64,v11
v_lshl_add_u32 v19,v6,11,v5
v_add_u32 v6,s64,v11
v_add_u32 v6,30,v6
v_lshl_add_u32 v9,v6,7,v5
v_and_b32 v9,2047,v9
v_and_b32 v7,3,v6
v_lshl_add_u32 v7,v7,11,v9
v_bfe_u32 v8,v6,2,3
v_lshl_add_u32 v7,v8,14,v7
v_mov_b32 v8,0x2000
v_mov_b32 v9,2097152
v_cmp_gt_u32 vcc,32,v6
s_nop 1
v_cndmask_b32 v8,v9,v8,vcc
v_add_u32 v7,v7,v8
v_add_u32 v7,1048576,v7
v_xor_b32 v20,s62,v7
s_lshl_b32 s64,s42,14
s_lshl_b32 s65,s50,11
s_add_u32 s64,s64,s65
s_lshl_b32 s65,s43,10
s_add_u32 s64,s64,s65
s_lshl_b32 s65,s48,3
s_add_u32 s64,s64,s65
s_add_u32 s64,s64,1179648
v_add_u32 v24,s64,v16
s_mov_b32 s84,0xffffff00
s_or_b32 s64,s43,s79
s_cselect_b32 s84,-1,s84
s_mov_b32 s85,-1
s_mov_b32 s48,1
s_waitcnt vmcnt(0)
s_cmp_lg_u32 s56,0
s_cbranch_scc1 kslow_282
s_add_u32 s64,s79,0
s_lshl_b32 s70,s64,21
s_lshl_b32 s64,s64,13
s_and_b32 s64,s64,0x2000
s_xor_b32 s64,s64,s62
s_add_u32 s70,s70,s64
s_add_u32 s70,s70,29360128
s_mov_b32 s83,1
s_mov_b32 s87,s74
s_cmp_eq_u32 s50,0
s_cselect_b32 s74,s74,0x7fff0000
v_mov_b32 v45,132096
s_lshl_b32 s64,s50,2
s_add_u32 s64,s64,132112
v_mov_b32 v46,s64
v_mov_b32 v2,0
v_mov_b32 v44,1
ds_write_b32 v45,v44
s_mov_b32 s97,0x7fff0000
s_waitcnt lgkmcnt(0)
seg_284:
s_cmp_eq_u32 s83,0
s_cbranch_scc1 ahead_285
s_add_u32 s94,s70,s75
s_xor_b32 s95,s94,1024
s_xor_b32 s91,s72,0x10000
s_waitcnt lgkmcnt(0)
v_cmp_gt_u32 vcc,s71,v2
s_cbranch_vccz nb_288
s_waitcnt vmcnt(1)
v_cmp_gt_u32 vcc,s71,v29
s_cbranch_vccz nb_288
s_cmp_lg_u32 s50,0
s_cbranch_scc1 nb_288
buffer_load_dword v32,v21,s[20:23],s74 offen sc1
s_sleep 2
pl_289:
buffer_load_dword v33,v21,s[20:23],s74 offen sc1
s_waitcnt vmcnt(1)
v_cmp_gt_u32 vcc,s71,v32
s_cbranch_vccz pok_290
buffer_load_dword v32,v21,s[20:23],s74 offen sc1
s_waitcnt vmcnt(1)
v_cmp_gt_u32 vcc,s71,v33
s_cbranch_vccz pok_290
s_sub_u32 s90,s90,1
s_cmp_gt_i32 s90,0
s_cbranch_scc1 pl_289
pok_290:
nb_288:
s_barrier
s_xor_b32 m0,s91,0
s_add_u32 s65,s94,0
buffer_load_dwordx4 v16,s[20:23],s65 offen offset:0 sc1 lds
buffer_load_dwordx4 v16,s[20:23],s65 offen offset:2048 sc1 lds
ds_read_b32 v44,v45
s_xor_b32 m0,s91,16384
s_add_u32 s65,s94,32768
buffer_load_dwordx4 v16,s[20:23],s65 offen offset:0 sc1 lds
buffer_load_dwordx4 v16,s[20:23],s65 offen offset:2048 sc1 lds
s_xor_b32 m0,s91,32768
s_add_u32 s65,s94,65536
buffer_load_dwordx4 v16,s[20:23],s65 offen offset:0 sc1 lds
buffer_load_dwordx4 v16,s[20:23],s65 offen offset:2048 sc1 lds
s_xor_b32 m0,s91,49152
s_add_u32 s65,s94,s86
buffer_load_dwordx4 v16,s[20:23],s65 offen offset:0 sc1 lds
buffer_load_dwordx4 v16,s[20:23],s65 offen offset:2048 sc1 lds
s_xor_b32 m0,s91,1024
s_add_u32 s65,s95,0
buffer_load_dwordx4 v16,s[20:23],s65 offen offset:0 sc1 lds
buffer_load_dwordx4 v16,s[20:23],s65 offen offset:2048 sc1 lds
s_waitcnt lgkmcnt(0)
v_readfirstlane_b32 s83,v44
s_cmp_eq_u32 s83,0
s_cbranch_scc1 both_287
s_waitcnt vmcnt(8)
s_barrier
ds_read_b128 v[224:227],v18 offset:0
ds_read_b128 v[228:231],v18 offset:2048
ds_read_b128 v[232:235],v18 offset:4096
ds_read_b128 v[236:239],v18 offset:6144
ds_read_b128 v[240:243],v18 offset:8192
ds_read_b128 v[244:247],v18 offset:10240
ds_read_b128 v[248:251],v18 offset:12288
s_waitcnt lgkmcnt(5)
v_mfma_f32_16x16x32_bf16 v[64:67],a[0:3],v[224:227],0
v_min_u32 v27,v224,v228
s_xor_b32 m0,s91,17408
v_mfma_f32_16x16x32_bf16 v[68:71],a[112:115],v[224:227],0
ds_read_b128 v[252:255],v18 offset:14336
v_mfma_f32_16x16x32_bf16 v[64:67],a[4:7],v[228:231],v[64:67]
s_add_u32 s65,s95,32768
v_mfma_f32_16x16x32_bf16 v[68:71],a[116:119],v[228:231],v[68:71]
s_waitcnt vmcnt(6)
s_barrier
ds_read_b128 v[224:227],v18 offset:16384
s_waitcnt lgkmcnt(5)
v_mfma_f32_16x16x32_bf16 v[64:67],a[8:11],v[232:235],v[64:67]
v_min3_u32 v27,v27,v232,v236
buffer_load_dwordx4 v16,s[20:23],s65 offen offset:0 sc1 lds
v_mfma_f32_16x16x32_bf16 v[68:71],a[120:123],v[232:235],v[68:71]
ds_read_b128 v[228:231],v18 offset:18432
v_mfma_f32_16x16x32_bf16 v[64:67],a[12:15],v[236:239],v[64:67]
buffer_load_dwordx4 v16,s[20:23],s65 offen offset:2048 sc1 lds
v_mfma_f32_16x16x32_bf16 v[68:71],a[124:127],v[236:239],v[68:71]
ds_read_b128 v[232:235],v18 offset:20480
s_waitcnt lgkmcnt(5)
v_mfma_f32_16x16x32_bf16 v[64:67],a[16:19],v[240:243],v[64:67]
v_min3_u32 v27,v27,v240,v244
s_xor_b32 m0,s91,33792
v_mfma_f32_16x16x32_bf16 v[68:71],a[128:131],v[240:243],v[68:71]
ds_read_b128 v[236:239],v18 offset:22528
v_mfma_f32_16x16x32_bf16 v[64:67],a[20:23],v[244:247],v[64:67]
s_add_u32 s65,s95,65536
v_mfma_f32_16x16x32_bf16 v[68:71],a[132:135],v[244:247],v[68:71]
ds_read_b128 v[240:243],v18 offset:24576
s_waitcnt lgkmcnt(5)
v_mfma_f32_16x16x32_bf16 v[64:67],a[24:27],v[248:251],v[64:67]
v_min3_u32 v27,v27,v248,v252
buffer_load_dwordx4 v16,s[20:23],s65 offen offset:0 sc1 lds
v_mfma_f32_16x16x32_bf16 v[68:71],a[136:139],v[248:251],v[68:71]
ds_read_b128 v[244:247],v18 offset:26624
v_mfma_f32_16x16x32_bf16 v[64:67],a[28:31],v[252:255],v[64:67]
buffer_load_dwordx4 v16,s[20:23],s65 offen offset:2048 sc1 lds
v_mfma_f32_16x16x32_bf16 v[68:71],a[140:143],v[252:255],v[68:71]
ds_read_b128 v[248:251],v18 offset:28672
s_waitcnt lgkmcnt(5)
v_mfma_f32_16x16x32_bf16 v[64:67],a[32:35],v[224:227],v[64:67]
v_min3_u32 v27,v27,v224,v228
s_xor_b32 m0,s91,50176
v_mfma_f32_16x16x32_bf16 v[68:71],a[144:147],v[224:227],v[68:71]
ds_read_b128 v[252:255],v18 offset:30720
v_mfma_f32_16x16x32_bf16 v[64:67],a[36:39],v[228:231],v[64:67]
s_add_u32 s65,s95,s86
v_mfma_f32_16x16x32_bf16 v[68:71],a[148:151],v[228:231],v[68:71]
s_waitcnt vmcnt(6)
s_barrier
ds_read_b128 v[224:227],v18 offset:32768
s_waitcnt lgkmcnt(5)
v_mfma_f32_16x16x32_bf16 v[64:67],a[40:43],v[232:235],v[64:67]
v_min3_u32 v27,v27,v232,v236
buffer_load_dwordx4 v16,s[20:23],s65 offen offset:0 sc1 lds
v_mfma_f32_16x16x32_bf16 v[68:71],a[152:155],v[232:235],v[68:71]
ds_read_b128 v[228:231],v18 offset:34816
v_mfma_f32_16x16x32_bf16 v[64:67],a[44:47],v[236:239],v[64:67]
buffer_load_dwordx4 v16,s[20:23],s65 offen offset:2048 sc1 lds
v_mfma_f32_16x16x32_bf16 v[68:71],a[156:159],v[236:239],v[68:71]
ds_read_b128 v[232:235],v18 offset:36864
s_waitcnt lgkmcnt(5)
v_mfma_f32_16x16x32_bf16 v[64:67],a[48:51],v[240:243],v[64:67]
v_min3_u32 v27,v27,v240,v244
v_mfma_f32_16x16x32_bf16 v[68:71],a[160:163],v[240:243],v[68:71]
ds_read_b128 v[236:239],v18 offset:38912
v_mfma_f32_16x16x32_bf16 v[64:67],a[52:55],v[244:247],v[64:67]
buffer_load_dwordx2 v[120:121],v20,s[20:23],s76 offen sc1
v_mfma_f32_16x16x32_bf16 v[68:71],a[164:167],v[244:247],v[68:71]
ds_read_b128 v[240:243],v18 offset:40960
s_waitcnt lgkmcnt(5)
v_mfma_f32_16x16x32_bf16 v[64:67],a[56:59],v[248:251],v[64:67]
v_min3_u32 v27,v27,v248,v252
v_mfma_f32_16x16x32_bf16 v[68:71],a[168:171],v[248:251],v[68:71]
ds_read_b128 v[244:247],v18 offset:43008
v_mfma_f32_16x16x32_bf16 v[64:67],a[60:63],v[252:255],v[64:67]
buffer_load_dwordx2 v[122:123],v24,s[20:23],s70 offen sc1
v_mfma_f32_16x16x32_bf16 v[68:71],a[172:175],v[252:255],v[68:71]
ds_read_b128 v[248:251],v18 offset:45056
s_waitcnt lgkmcnt(5)
v_mfma_f32_16x16x32_bf16 v[64:67],a[64:67],v[224:227],v[64:67]
s_waitcnt vmcnt(6)
s_barrier
ds_read_b128 v[128:131],v17 offset:0
ds_read_b128 v[132:135],v17 offset:2048
v_mfma_f32_16x16x32_bf16 v[68:71],a[176:179],v[224:227],v[68:71]
ds_read_b128 v[252:255],v18 offset:47104
v_min3_u32 v27,v27,v224,v228
v_mfma_f32_16x16x32_bf16 v[64:67],a[68:71],v[228:231],v[64:67]
ds_read_b128 v[136:139],v17 offset:4096
v_mfma_f32_16x16x32_bf16 v[68:71],a[180:183],v[228:231],v[68:71]
ds_read_b128 v[224:227],v18 offset:49152
s_waitcnt lgkmcnt(8)
v_mfma_f32_16x16x32_bf16 v[64:67],a[72:75],v[232:235],v[64:67]
ds_read_b128 v[140:143],v17 offset:6144
v_min3_u32 v27,v27,v232,v236
v_mfma_f32_16x16x32_bf16 v[68:71],a[184:187],v[232:235],v[68:71]
ds_read_b128 v[228:231],v18 offset:51200
v_mfma_f32_16x16x32_bf16 v[64:67],a[76:79],v[236:239],v[64:67]
ds_read_b128 v[144:147],v17 offset:8192
ds_read_b128 v[148:151],v17 offset:10240
v_mfma_f32_16x16x32_bf16 v[68:71],a[188:191],v[236:239],v[68:71]
ds_read_b128 v[232:235],v18 offset:53248
s_waitcnt lgkmcnt(11)
v_mfma_f32_16x16x32_bf16 v[64:67],a[80:83],v[240:243],v[64:67]
ds_read_b128 v[152:155],v17 offset:12288
v_min3_u32 v27,v27,v240,v244
v_mfma_f32_16x16x32_bf16 v[68:71],a[192:195],v[240:243],v[68:71]
ds_read_b128 v[236:239],v18 offset:55296
v_mfma_f32_16x16x32_bf16 v[64:67],a[84:87],v[244:247],v[64:67]
ds_read_b128 v[156:159],v17 offset:14336
v_mfma_f32_16x16x32_bf16 v[68:71],a[196:199],v[244:247],v[68:71]
s_waitcnt lgkmcnt(10)
v_mfma_f32_16x16x32_bf16 v[64:67],a[88:91],v[248:251],v[64:67]
ds_read_b128 v[160:163],v17 offset:16384
ds_read_b128 v[164:167],v17 offset:18432
v_mfma_f32_16x16x32_bf16 v[68:71],a[200:203],v[248:251],v[68:71]
v_min3_u32 v27,v27,v248,v252
v_mfma_f32_16x16x32_bf16 v[64:67],a[92:95],v[252:255],v[64:67]
ds_read_b128 v[168:171],v17 offset:20480
v_mfma_f32_16x16x32_bf16 v[68:71],a[204:207],v[252:255],v[68:71]
s_waitcnt lgkmcnt(9)
v_mfma_f32_16x16x32_bf16 v[64:67],a[96:99],v[224:227],v[64:67]
ds_read_b128 v[172:175],v17 offset:22528
v_min3_u32 v27,v27,v224,v228
v_mfma_f32_16x16x32_bf16 v[68:71],a[208:211],v[224:227],v[68:71]
v_min3_u32 v27,v27,v226,v230
v_mfma_f32_16x16x32_bf16 v[64:67],a[100:103],v[228:231],v[64:67]
ds_read_b128 v[176:179],v17 offset:24576
ds_read_b128 v[180:183],v17 offset:26624
v_mfma_f32_16x16x32_bf16 v[68:71],a[212:215],v[228:231],v[68:71]
s_waitcnt lgkmcnt(7)
v_mfma_f32_16x16x32_bf16 v[64:67],a[104:107],v[232:235],v[64:67]
ds_read_b128 v[184:187],v17 offset:28672
v_min3_u32 v27,v27,v232,v236
v_mfma_f32_16x16x32_bf16 v[68:71],a[216:219],v[232:235],v[68:71]
v_min3_u32 v27,v27,v234,v238
v_mfma_f32_16x16x32_bf16 v[64:67],a[108:111],v[236:239],v[64:67]
ds_read_b128 v[188:191],v17 offset:30720
buffer_load_dword v2,v21,s[20:23],s87 offen sc1
v_mfma_f32_16x16x32_bf16 v[68:71],a[220:223],v[236:239],v[68:71]
s_add_u32 s96,s71,2
v_mfma_f32_16x16x32_bf16 v[72:75],a[112:115],v[128:131],0
v_cmp_eq_u32 vcc,0,v27
s_cbranch_vccnz retry_283
v_mfma_f32_16x16x32_bf16 v[76:79],a[116:119],v[132:135],0
v_min3_u32 v27,v27,v128,v132
v_mfma_f32_16x16x32_bf16 v[72:75],a[120:123],v[136:139],v[72:75]
s_waitcnt vmcnt(3)
s_barrier
ds_read_b128 v[192:195],v17 offset:32768
v_mfma_f32_16x16x32_bf16 v[76:79],a[124:127],v[140:143],v[76:79]
ds_read_b128 v[196:199],v17 offset:34816
s_waitcnt lgkmcnt(10)
v_mfma_f32_16x16x32_bf16 v[72:75],a[128:131],v[144:147],v[72:75]
ds_read_b128 v[200:203],v17 offset:36864
v_min3_u32 v27,v27,v136,v140
s_waitcnt vmcnt(1)
v_mfma_f32_16x16x32_bf16 v[76:79],a[132:135],v[148:151],v[76:79]
ds_read_b128 v[204:207],v17 offset:38912
v_min3_u32 v27,v27,v144,v148
v_and_or_b32 v64,v64,-4,s48
v_mfma_f32_16x16x32_bf16 v[72:75],a[136:139],v[152:155],v[72:75]
ds_read_b128 v[208:211],v17 offset:40960
s_add_u32 s64,s49,s34
v_mfma_f32_16x16x32_bf16 v[76:79],a[140:143],v[156:159],v[76:79]
v_min3_u32 v27,v27,v152,v156
s_waitcnt lgkmcnt(9)
v_mfma_f32_16x16x32_bf16 v[72:75],a[144:147],v[160:163],v[72:75]
ds_read_b128 v[212:215],v17 offset:43008
buffer_store_dwordx4 v[64:67],v25,s[20:23],s64 offen offset:2048
v_mfma_f32_16x16x32_bf16 v[76:79],a[148:151],v[164:167],v[76:79]
ds_read_b128 v[216:219],v17 offset:45056
v_min3_u32 v27,v27,v160,v164
v_and_or_b32 v68,v68,-4,s48
v_mfma_f32_16x16x32_bf16 v[72:75],a[152:155],v[168:171],v[72:75]
ds_read_b128 v[220:223],v17 offset:47104
s_add_u32 s64,s49,s35
v_mfma_f32_16x16x32_bf16 v[76:79],a[156:159],v[172:175],v[76:79]
ds_read_b128 v[224:227],v17 offset:49152
s_waitcnt lgkmcnt(9)
v_mfma_f32_16x16x32_bf16 v[72:75],a[160:163],v[176:179],v[72:75]
ds_read_b128 v[228:231],v17 offset:51200
v_min3_u32 v27,v27,v168,v172
v_mfma_f32_16x16x32_bf16 v[76:79],a[164:167],v[180:183],v[76:79]
v_min3_u32 v27,v27,v176,v180
buffer_store_dwordx4 v[68:71],v25,s[20:23],s64 offen offset:3072
v_mfma_f32_16x16x32_bf16 v[72:75],a[168:171],v[184:187],v[72:75]
ds_read_b128 v[232:235],v17 offset:53248
s_mov_b32 s49,0x7fff0000
v_mfma_f32_16x16x32_bf16 v[76:79],a[172:175],v[188:191],v[76:79]
ds_read_b128 v[236:239],v17 offset:55296
s_waitcnt lgkmcnt(8)
v_mfma_f32_16x16x32_bf16 v[72:75],a[176:179],v[192:195],v[72:75]
v_min3_u32 v27,v27,v184,v188
v_mfma_f32_16x16x32_bf16 v[76:79],a[180:183],v[196:199],v[76:79]
v_min3_u32 v27,v27,v192,v196
ds_bpermute_b32 v124,v41,v120
v_mfma_f32_16x16x32_bf16 v[72:75],a[184:187],v[200:203],v[72:75]
v_mfma_f32_16x16x32_bf16 v[76:79],a[188:191],v[204:207],v[76:79]
v_min3_u32 v27,v27,v200,v204
s_waitcnt lgkmcnt(5)
v_mfma_f32_16x16x32_bf16 v[72:75],a[192:195],v[208:211],v[72:75]
ds_bpermute_b32 v125,v41,v121
v_mfma_f32_16x16x32_bf16 v[76:79],a[196:199],v[212:215],v[76:79]
v_min3_u32 v27,v27,v208,v212
v_lshlrev_b32 v108,16,v122
v_mfma_f32_16x16x32_bf16 v[72:75],a[200:203],v[216:219],v[72:75]
v_mfma_f32_16x16x32_bf16 v[76:79],a[204:207],v[220:223],v[76:79]
v_min3_u32 v27,v27,v216,v220
s_waitcnt lgkmcnt(2)
v_mfma_f32_16x16x32_bf16 v[72:75],a[208:211],v[224:227],v[72:75]
v_and_b32 v109,s80,v122
v_mfma_f32_16x16x32_bf16 v[76:79],a[212:215],v[228:231],v[76:79]
v_min3_u32 v27,v27,v224,v228
v_min3_u32 v27,v27,v226,v230
v_mfma_f32_16x16x32_bf16 v[72:75],a[216:219],v[232:235],v[72:75]
v_lshlrev_b32 v110,16,v123
v_mfma_f32_16x16x32_bf16 v[76:79],a[220:223],v[236:239],v[76:79]
v_min3_u32 v27,v27,v232,v236
v_min3_u32 v27,v27,v234,v238
v_mfma_f32_16x16x32_bf16 v[80:83],a[0:3],v[128:131],0
v_cmp_eq_u32 vcc,0,v27
s_cbranch_vccnz retry_283
v_mfma_f32_16x16x32_bf16 v[84:87],a[4:7],v[132:135],0
v_and_b32 v111,s80,v123
s_waitcnt lgkmcnt(0)
v_mfma_f32_16x16x32_bf16 v[80:83],a[8:11],v[136:139],v[80:83]
v_mfma_f32_16x16x32_bf16 v[84:87],a[12:15],v[140:143],v[84:87]
v_lshlrev_b32 v104,16,v124
v_mfma_f32_16x16x32_bf16 v[80:83],a[16:19],v[144:147],v[80:83]
v_add_f32 v72,v72,v76
v_add_f32 v73,v73,v77
v_mfma_f32_16x16x32_bf16 v[84:87],a[20:23],v[148:151],v[84:87]
v_and_b32 v105,s80,v124
v_add_f32 v74,v74,v78
v_mfma_f32_16x16x32_bf16 v[80:83],a[24:27],v[152:155],v[80:83]
v_add_f32 v75,v75,v79
v_and_or_b32 v72,v72,-4,s48
v_mfma_f32_16x16x32_bf16 v[84:87],a[28:31],v[156:159],v[84:87]
v_lshlrev_b32 v106,16,v125
s_add_u32 s64,s77,s33
v_mfma_f32_16x16x32_bf16 v[80:83],a[32:35],v[160:163],v[80:83]
buffer_store_dwordx4 v[72:75],v25,s[20:23],s64 offen offset:1024
v_mfma_f32_16x16x32_bf16 v[84:87],a[36:39],v[164:167],v[84:87]
v_and_b32 v107,s80,v125
v_mfma_f32_16x16x32_bf16 v[80:83],a[40:43],v[168:171],v[80:83]
v_mfma_f32_16x16x32_bf16 v[84:87],a[44:47],v[172:175],v[84:87]
v_mfma_f32_16x16x32_bf16 v[80:83],a[48:51],v[176:179],v[80:83]
buffer_load_dwordx4 v[96:99],v26,s[20:23],s77 offen offset:2048 sc1
v_mfma_f32_16x16x32_bf16 v[84:87],a[52:55],v[180:183],v[84:87]
buffer_load_dwordx4 v[100:103],v26,s[20:23],s77 offen offset:3072 sc1
v_mfma_f32_16x16x32_bf16 v[80:83],a[56:59],v[184:187],v[80:83]
v_mfma_f32_16x16x32_bf16 v[84:87],a[60:63],v[188:191],v[84:87]
v_mfma_f32_16x16x32_bf16 v[80:83],a[64:67],v[192:195],v[80:83]
s_waitcnt vmcnt(5)
v_mfma_f32_16x16x32_bf16 v[84:87],a[68:71],v[196:199],v[84:87]
v_cmp_gt_u32 vcc,s96,v2
s_mov_b32 s96,vcc_lo
v_mfma_f32_16x16x32_bf16 v[80:83],a[72:75],v[200:203],v[80:83]
v_mov_b32 v44,s96
ds_write_b32 v46,v44
v_mfma_f32_16x16x32_bf16 v[84:87],a[76:79],v[204:207],v[84:87]
v_mfma_f32_16x16x32_bf16 v[80:83],a[80:83],v[208:211],v[80:83]
v_mfma_f32_16x16x32_bf16 v[84:87],a[84:87],v[212:215],v[84:87]
v_mfma_f32_16x16x32_bf16 v[80:83],a[88:91],v[216:219],v[80:83]
buffer_load_dwordx4 v[92:95],v26,s[20:23],s77 offen offset:1024 sc1
v_mfma_f32_16x16x32_bf16 v[84:87],a[92:95],v[220:223],v[84:87]
v_mfma_f32_16x16x32_bf16 v[80:83],a[96:99],v[224:227],v[80:83]
v_mfma_f32_16x16x32_bf16 v[84:87],a[100:103],v[228:231],v[84:87]
v_mfma_f32_16x16x32_bf16 v[80:83],a[104:107],v[232:235],v[80:83]
v_mfma_f32_16x16x32_bf16 v[84:87],a[108:111],v[236:239],v[84:87]
s_branch epi_286
both_287:
s_waitcnt vmcnt(8)
s_barrier
ds_read_b128 v[224:227],v18 offset:0
ds_read_b128 v[228:231],v18 offset:2048
ds_read_b128 v[232:235],v18 offset:4096
ds_read_b128 v[236:239],v18 offset:6144
ds_read_b128 v[240:243],v18 offset:8192
ds_read_b128 v[244:247],v18 offset:10240
ds_read_b128 v[248:251],v18 offset:12288
s_waitcnt lgkmcnt(5)
v_mfma_f32_16x16x32_bf16 v[64:67],a[0:3],v[224:227],0
s_xor_b32 m0,s91,17408
s_add_u32 s88,s70,s75
v_min_u32 v27,v224,v228
v_mfma_f32_16x16x32_bf16 v[68:71],a[112:115],v[224:227],0
ds_read_b128 v[252:255],v18 offset:14336
s_add_u32 s88,s88,2097152
v_mfma_f32_16x16x32_bf16 v[64:67],a[4:7],v[228:231],v[64:67]
s_add_u32 s65,s95,32768
s_xor_b32 s88,s88,0x2000
v_mfma_f32_16x16x32_bf16 v[68:71],a[116:119],v[228:231],v[68:71]
s_waitcnt vmcnt(6)
s_barrier
ds_read_b128 v[224:227],v18 offset:16384
s_waitcnt lgkmcnt(5)
v_mfma_f32_16x16x32_bf16 v[64:67],a[8:11],v[232:235],v[64:67]
buffer_load_dwordx4 v16,s[20:23],s65 offen offset:0 sc1 lds
v_min3_u32 v27,v27,v232,v236
v_mfma_f32_16x16x32_bf16 v[68:71],a[120:123],v[232:235],v[68:71]
ds_read_b128 v[228:231],v18 offset:18432
s_xor_b32 s89,s88,1024
v_mfma_f32_16x16x32_bf16 v[64:67],a[12:15],v[236:239],v[64:67]
buffer_load_dwordx4 v16,s[20:23],s65 offen offset:2048 sc1 lds
v_mfma_f32_16x16x32_bf16 v[68:71],a[124:127],v[236:239],v[68:71]
ds_read_b128 v[232:235],v18 offset:20480
s_waitcnt lgkmcnt(5)
v_mfma_f32_16x16x32_bf16 v[64:67],a[16:19],v[240:243],v[64:67]
s_xor_b32 m0,s91,33792
v_min3_u32 v27,v27,v240,v244
v_mfma_f32_16x16x32_bf16 v[68:71],a[128:131],v[240:243],v[68:71]
ds_read_b128 v[236:239],v18 offset:22528
v_mfma_f32_16x16x32_bf16 v[64:67],a[20:23],v[244:247],v[64:67]
s_add_u32 s65,s95,65536
v_mfma_f32_16x16x32_bf16 v[68:71],a[132:135],v[244:247],v[68:71]
ds_read_b128 v[240:243],v18 offset:24576
s_waitcnt lgkmcnt(5)
v_mfma_f32_16x16x32_bf16 v[64:67],a[24:27],v[248:251],v[64:67]
buffer_load_dwordx4 v16,s[20:23],s65 offen offset:0 sc1 lds
v_mfma_f32_16x16x32_bf16 v[68:71],a[136:139],v[248:251],v[68:71]
ds_read_b128 v[244:247],v18 offset:26624
v_min3_u32 v27,v27,v248,v252
v_mfma_f32_16x16x32_bf16 v[64:67],a[28:31],v[252:255],v[64:67]
buffer_load_dwordx4 v16,s[20:23],s65 offen offset:2048 sc1 lds
v_mfma_f32_16x16x32_bf16 v[68:71],a[140:143],v[252:255],v[68:71]
ds_read_b128 v[248:251],v18 offset:28672
s_waitcnt lgkmcnt(5)
v_mfma_f32_16x16x32_bf16 v[64:67],a[32:35],v[224:227],v[64:67]
s_xor_b32 m0,s91,50176
v_min3_u32 v27,v27,v224,v228
v_mfma_f32_16x16x32_bf16 v[68:71],a[144:147],v[224:227],v[68:71]
ds_read_b128 v[252:255],v18 offset:30720
v_mfma_f32_16x16x32_bf16 v[64:67],a[36:39],v[228:231],v[64:67]
s_add_u32 s65,s95,s86
v_mfma_f32_16x16x32_bf16 v[68:71],a[148:151],v[228:231],v[68:71]
s_waitcnt vmcnt(6)
s_barrier
ds_read_b128 v[224:227],v18 offset:32768
s_waitcnt lgkmcnt(5)
v_mfma_f32_16x16x32_bf16 v[64:67],a[40:43],v[232:235],v[64:67]
buffer_load_dwordx4 v16,s[20:23],s65 offen offset:0 sc1 lds
v_mfma_f32_16x16x32_bf16 v[68:71],a[152:155],v[232:235],v[68:71]
ds_read_b128 v[228:231],v18 offset:34816
v_min3_u32 v27,v27,v232,v236
v_mfma_f32_16x16x32_bf16 v[64:67],a[44:47],v[236:239],v[64:67]
buffer_load_dwordx4 v16,s[20:23],s65 offen offset:2048 sc1 lds
v_mfma_f32_16x16x32_bf16 v[68:71],a[156:159],v[236:239],v[68:71]
ds_read_b128 v[232:235],v18 offset:36864
s_waitcnt lgkmcnt(5)
v_mfma_f32_16x16x32_bf16 v[64:67],a[48:51],v[240:243],v[64:67]
v_min3_u32 v27,v27,v240,v244
v_mfma_f32_16x16x32_bf16 v[68:71],a[160:163],v[240:243],v[68:71]
ds_read_b128 v[236:239],v18 offset:38912
v_mfma_f32_16x16x32_bf16 v[64:67],a[52:55],v[244:247],v[64:67]
s_xor_b32 m0,s72,0
buffer_load_dwordx2 v[120:121],v20,s[20:23],s76 offen sc1
v_mfma_f32_16x16x32_bf16 v[68:71],a[164:167],v[244:247],v[68:71]
ds_read_b128 v[240:243],v18 offset:40960
s_add_u32 s65,s88,0
s_waitcnt lgkmcnt(5)
v_mfma_f32_16x16x32_bf16 v[64:67],a[56:59],v[248:251],v[64:67]
v_min3_u32 v27,v27,v248,v252
buffer_load_dwordx2 v[122:123],v24,s[20:23],s70 offen sc1
v_mfma_f32_16x16x32_bf16 v[68:71],a[168:171],v[248:251],v[68:71]
ds_read_b128 v[244:247],v18 offset:43008
buffer_load_dwordx4 v16,s[20:23],s65 offen offset:0 sc1 lds
v_mfma_f32_16x16x32_bf16 v[64:67],a[60:63],v[252:255],v[64:67]
buffer_load_dwordx4 v16,s[20:23],s65 offen offset:2048 sc1 lds
v_mfma_f32_16x16x32_bf16 v[68:71],a[172:175],v[252:255],v[68:71]
ds_read_b128 v[248:251],v18 offset:45056
s_waitcnt lgkmcnt(5)
v_mfma_f32_16x16x32_bf16 v[64:67],a[64:67],v[224:227],v[64:67]
s_waitcnt vmcnt(8)
s_barrier
ds_read_b128 v[128:131],v17 offset:0
ds_read_b128 v[132:135],v17 offset:2048
v_mfma_f32_16x16x32_bf16 v[68:71],a[176:179],v[224:227],v[68:71]
ds_read_b128 v[252:255],v18 offset:47104
s_xor_b32 m0,s72,16384
s_add_u32 s65,s88,32768
v_mfma_f32_16x16x32_bf16 v[64:67],a[68:71],v[228:231],v[64:67]
ds_read_b128 v[136:139],v17 offset:4096
v_min3_u32 v27,v27,v224,v228
v_mfma_f32_16x16x32_bf16 v[68:71],a[180:183],v[228:231],v[68:71]
ds_read_b128 v[224:227],v18 offset:49152
s_waitcnt lgkmcnt(8)
v_mfma_f32_16x16x32_bf16 v[64:67],a[72:75],v[232:235],v[64:67]
ds_read_b128 v[140:143],v17 offset:6144
buffer_load_dwordx4 v16,s[20:23],s65 offen offset:0 sc1 lds
v_min3_u32 v27,v27,v232,v236
v_mfma_f32_16x16x32_bf16 v[68:71],a[184:187],v[232:235],v[68:71]
ds_read_b128 v[228:231],v18 offset:51200
buffer_load_dwordx4 v16,s[20:23],s65 offen offset:2048 sc1 lds
v_mfma_f32_16x16x32_bf16 v[64:67],a[76:79],v[236:239],v[64:67]
ds_read_b128 v[144:147],v17 offset:8192
ds_read_b128 v[148:151],v17 offset:10240
s_xor_b32 m0,s72,32768
v_mfma_f32_16x16x32_bf16 v[68:71],a[188:191],v[236:239],v[68:71]
ds_read_b128 v[232:235],v18 offset:53248
s_waitcnt lgkmcnt(11)
v_mfma_f32_16x16x32_bf16 v[64:67],a[80:83],v[240:243],v[64:67]
ds_read_b128 v[152:155],v17 offset:12288
s_add_u32 s65,s88,65536
v_mfma_f32_16x16x32_bf16 v[68:71],a[192:195],v[240:243],v[68:71]
ds_read_b128 v[236:239],v18 offset:55296
buffer_load_dwordx4 v16,s[20:23],s65 offen offset:0 sc1 lds
v_mfma_f32_16x16x32_bf16 v[64:67],a[84:87],v[244:247],v[64:67]
ds_read_b128 v[156:159],v17 offset:14336
v_min3_u32 v27,v27,v240,v244
v_mfma_f32_16x16x32_bf16 v[68:71],a[196:199],v[244:247],v[68:71]
buffer_load_dwordx4 v16,s[20:23],s65 offen offset:2048 sc1 lds
s_waitcnt lgkmcnt(10)
v_mfma_f32_16x16x32_bf16 v[64:67],a[88:91],v[248:251],v[64:67]
ds_read_b128 v[160:163],v17 offset:16384
ds_read_b128 v[164:167],v17 offset:18432
s_xor_b32 m0,s72,49152
v_mfma_f32_16x16x32_bf16 v[68:71],a[200:203],v[248:251],v[68:71]
v_min3_u32 v27,v27,v248,v252
v_mfma_f32_16x16x32_bf16 v[64:67],a[92:95],v[252:255],v[64:67]
ds_read_b128 v[168:171],v17 offset:20480
s_add_u32 s65,s88,s86
v_mfma_f32_16x16x32_bf16 v[68:71],a[204:207],v[252:255],v[68:71]
buffer_load_dwordx4 v16,s[20:23],s65 offen offset:0 sc1 lds
s_waitcnt lgkmcnt(9)
v_mfma_f32_16x16x32_bf16 v[64:67],a[96:99],v[224:227],v[64:67]
ds_read_b128 v[172:175],v17 offset:22528
v_min3_u32 v27,v27,v224,v228
v_min3_u32 v27,v27,v226,v230
v_mfma_f32_16x16x32_bf16 v[68:71],a[208:211],v[224:227],v[68:71]
buffer_load_dwordx4 v16,s[20:23],s65 offen offset:2048 sc1 lds
v_mfma_f32_16x16x32_bf16 v[64:67],a[100:103],v[228:231],v[64:67]
ds_read_b128 v[176:179],v17 offset:24576
ds_read_b128 v[180:183],v17 offset:26624
v_mfma_f32_16x16x32_bf16 v[68:71],a[212:215],v[228:231],v[68:71]
s_xor_b32 m0,s72,1024
s_waitcnt lgkmcnt(7)
v_mfma_f32_16x16x32_bf16 v[64:67],a[104:107],v[232:235],v[64:67]
ds_read_b128 v[184:187],v17 offset:28672
s_add_u32 s65,s89,0
v_mfma_f32_16x16x32_bf16 v[68:71],a[216:219],v[232:235],v[68:71]
v_min3_u32 v27,v27,v232,v236
v_min3_u32 v27,v27,v234,v238
v_mfma_f32_16x16x32_bf16 v[64:67],a[108:111],v[236:239],v[64:67]
ds_read_b128 v[188:191],v17 offset:30720
buffer_load_dwordx4 v16,s[20:23],s65 offen offset:0 sc1 lds
v_mfma_f32_16x16x32_bf16 v[68:71],a[220:223],v[236:239],v[68:71]
buffer_load_dwordx4 v16,s[20:23],s65 offen offset:2048 sc1 lds
v_mfma_f32_16x16x32_bf16 v[72:75],a[112:115],v[128:131],0
v_cmp_eq_u32 vcc,0,v27
s_cbranch_vccnz retry_283
buffer_load_dword v2,v21,s[20:23],s87 offen sc1
v_mfma_f32_16x16x32_bf16 v[76:79],a[116:119],v[132:135],0
s_xor_b32 m0,s72,17408
v_min3_u32 v27,v27,v128,v132
s_add_u32 s96,s71,2
v_mfma_f32_16x16x32_bf16 v[72:75],a[120:123],v[136:139],v[72:75]
s_waitcnt vmcnt(13)
s_barrier
ds_read_b128 v[192:195],v17 offset:32768
v_mfma_f32_16x16x32_bf16 v[76:79],a[124:127],v[140:143],v[76:79]
ds_read_b128 v[196:199],v17 offset:34816
s_add_u32 s65,s89,32768
s_waitcnt lgkmcnt(10)
v_mfma_f32_16x16x32_bf16 v[72:75],a[128:131],v[144:147],v[72:75]
ds_read_b128 v[200:203],v17 offset:36864
buffer_load_dwordx4 v16,s[20:23],s65 offen offset:0 sc1 lds
s_waitcnt vmcnt(12)
v_mfma_f32_16x16x32_bf16 v[76:79],a[132:135],v[148:151],v[76:79]
ds_read_b128 v[204:207],v17 offset:38912
v_min3_u32 v27,v27,v136,v140
v_and_or_b32 v64,v64,-4,s48
s_add_u32 s64,s49,s34
v_mfma_f32_16x16x32_bf16 v[72:75],a[136:139],v[152:155],v[72:75]
ds_read_b128 v[208:211],v17 offset:40960
v_min3_u32 v27,v27,v144,v148
buffer_store_dwordx4 v[64:67],v25,s[20:23],s64 offen offset:2048
v_mfma_f32_16x16x32_bf16 v[76:79],a[140:143],v[156:159],v[76:79]
v_min3_u32 v27,v27,v152,v156
v_and_or_b32 v68,v68,-4,s48
s_add_u32 s64,s49,s35
s_waitcnt lgkmcnt(9)
v_mfma_f32_16x16x32_bf16 v[72:75],a[144:147],v[160:163],v[72:75]
ds_read_b128 v[212:215],v17 offset:43008
buffer_store_dwordx4 v[68:71],v25,s[20:23],s64 offen offset:3072
s_mov_b32 s49,0x7fff0000
v_mfma_f32_16x16x32_bf16 v[76:79],a[148:151],v[164:167],v[76:79]
ds_read_b128 v[216:219],v17 offset:45056
v_min3_u32 v27,v27,v160,v164
v_mfma_f32_16x16x32_bf16 v[72:75],a[152:155],v[168:171],v[72:75]
ds_read_b128 v[220:223],v17 offset:47104
v_mfma_f32_16x16x32_bf16 v[76:79],a[156:159],v[172:175],v[76:79]
ds_read_b128 v[224:227],v17 offset:49152
s_waitcnt lgkmcnt(9)
v_mfma_f32_16x16x32_bf16 v[72:75],a[160:163],v[176:179],v[72:75]
ds_read_b128 v[228:231],v17 offset:51200
v_min3_u32 v27,v27,v168,v172
v_mfma_f32_16x16x32_bf16 v[76:79],a[164:167],v[180:183],v[76:79]
buffer_load_dwordx4 v16,s[20:23],s65 offen offset:2048 sc1 lds
v_mfma_f32_16x16x32_bf16 v[72:75],a[168:171],v[184:187],v[72:75]
ds_read_b128 v[232:235],v17 offset:53248
s_xor_b32 m0,s72,33792
v_mfma_f32_16x16x32_bf16 v[76:79],a[172:175],v[188:191],v[76:79]
ds_read_b128 v[236:239],v17 offset:55296
s_waitcnt lgkmcnt(8)
v_mfma_f32_16x16x32_bf16 v[72:75],a[176:179],v[192:195],v[72:75]
s_add_u32 s65,s89,65536
v_min3_u32 v27,v27,v176,v180
v_mfma_f32_16x16x32_bf16 v[76:79],a[180:183],v[196:199],v[76:79]
buffer_load_dwordx4 v16,s[20:23],s65 offen offset:0 sc1 lds
v_mfma_f32_16x16x32_bf16 v[72:75],a[184:187],v[200:203],v[72:75]
buffer_load_dwordx4 v16,s[20:23],s65 offen offset:2048 sc1 lds
v_mfma_f32_16x16x32_bf16 v[76:79],a[188:191],v[204:207],v[76:79]
s_xor_b32 m0,s72,50176
s_waitcnt lgkmcnt(4)
v_mfma_f32_16x16x32_bf16 v[72:75],a[192:195],v[208:211],v[72:75]
s_add_u32 s65,s89,s86
v_min3_u32 v27,v27,v184,v188
v_mfma_f32_16x16x32_bf16 v[76:79],a[196:199],v[212:215],v[76:79]
buffer_load_dwordx4 v16,s[20:23],s65 offen offset:0 sc1 lds
v_mfma_f32_16x16x32_bf16 v[72:75],a[200:203],v[216:219],v[72:75]
buffer_load_dwordx4 v16,s[20:23],s65 offen offset:2048 sc1 lds
v_mfma_f32_16x16x32_bf16 v[76:79],a[204:207],v[220:223],v[76:79]
v_min3_u32 v27,v27,v192,v196
s_waitcnt lgkmcnt(0)
v_mfma_f32_16x16x32_bf16 v[72:75],a[208:211],v[224:227],v[72:75]
v_min3_u32 v27,v27,v200,v204
v_min3_u32 v27,v27,v208,v212
v_mfma_f32_16x16x32_bf16 v[76:79],a[212:215],v[228:231],v[76:79]
v_min3_u32 v27,v27,v216,v220
v_min3_u32 v27,v27,v224,v228
v_mfma_f32_16x16x32_bf16 v[72:75],a[216:219],v[232:235],v[72:75]
v_min3_u32 v27,v27,v226,v230
ds_bpermute_b32 v124,v41,v120
v_mfma_f32_16x16x32_bf16 v[76:79],a[220:223],v[236:239],v[76:79]
v_min3_u32 v27,v27,v232,v236
v_min3_u32 v27,v27,v234,v238
v_mfma_f32_16x16x32_bf16 v[80:83],a[0:3],v[128:131],0
v_cmp_eq_u32 vcc,0,v27
s_cbranch_vccnz retry_283
v_mfma_f32_16x16x32_bf16 v[84:87],a[4:7],v[132:135],0
ds_bpermute_b32 v125,v41,v121
v_lshlrev_b32 v108,16,v122
v_mfma_f32_16x16x32_bf16 v[80:83],a[8:11],v[136:139],v[80:83]
v_and_b32 v109,s80,v122
v_lshlrev_b32 v110,16,v123
v_mfma_f32_16x16x32_bf16 v[84:87],a[12:15],v[140:143],v[84:87]
v_and_b32 v111,s80,v123
s_waitcnt lgkmcnt(0)
v_mfma_f32_16x16x32_bf16 v[80:83],a[16:19],v[144:147],v[80:83]
v_lshlrev_b32 v104,16,v124
v_add_f32 v72,v72,v76
v_mfma_f32_16x16x32_bf16 v[84:87],a[20:23],v[148:151],v[84:87]
v_and_b32 v105,s80,v124
v_add_f32 v73,v73,v77
v_mfma_f32_16x16x32_bf16 v[80:83],a[24:27],v[152:155],v[80:83]
v_add_f32 v74,v74,v78
v_add_f32 v75,v75,v79
v_mfma_f32_16x16x32_bf16 v[84:87],a[28:31],v[156:159],v[84:87]
v_lshlrev_b32 v106,16,v125
v_and_or_b32 v72,v72,-4,s48
v_mfma_f32_16x16x32_bf16 v[80:83],a[32:35],v[160:163],v[80:83]
s_add_u32 s64,s77,s33
v_mfma_f32_16x16x32_bf16 v[84:87],a[36:39],v[164:167],v[84:87]
v_and_b32 v107,s80,v125
v_mfma_f32_16x16x32_bf16 v[80:83],a[40:43],v[168:171],v[80:83]
buffer_store_dwordx4 v[72:75],v25,s[20:23],s64 offen offset:1024
v_mfma_f32_16x16x32_bf16 v[84:87],a[44:47],v[172:175],v[84:87]
v_mfma_f32_16x16x32_bf16 v[80:83],a[48:51],v[176:179],v[80:83]
buffer_load_dwordx4 v[96:99],v26,s[20:23],s77 offen offset:2048 sc1
v_mfma_f32_16x16x32_bf16 v[84:87],a[52:55],v[180:183],v[84:87]
buffer_load_dwordx4 v[100:103],v26,s[20:23],s77 offen offset:3072 sc1
v_mfma_f32_16x16x32_bf16 v[80:83],a[56:59],v[184:187],v[80:83]
v_mfma_f32_16x16x32_bf16 v[84:87],a[60:63],v[188:191],v[84:87]
v_mfma_f32_16x16x32_bf16 v[80:83],a[64:67],v[192:195],v[80:83]
s_waitcnt vmcnt(11)
v_mfma_f32_16x16x32_bf16 v[84:87],a[68:71],v[196:199],v[84:87]
v_cmp_gt_u32 vcc,s96,v2
s_mov_b32 s96,vcc_lo
v_mfma_f32_16x16x32_bf16 v[80:83],a[72:75],v[200:203],v[80:83]
v_mov_b32 v44,s96
ds_write_b32 v46,v44
v_mfma_f32_16x16x32_bf16 v[84:87],a[76:79],v[204:207],v[84:87]
v_mfma_f32_16x16x32_bf16 v[80:83],a[80:83],v[208:211],v[80:83]
v_mfma_f32_16x16x32_bf16 v[84:87],a[84:87],v[212:215],v[84:87]
v_mfma_f32_16x16x32_bf16 v[80:83],a[88:91],v[216:219],v[80:83]
buffer_load_dwordx4 v[92:95],v26,s[20:23],s77 offen offset:1024 sc1
v_mfma_f32_16x16x32_bf16 v[84:87],a[92:95],v[220:223],v[84:87]
v_mfma_f32_16x16x32_bf16 v[80:83],a[96:99],v[224:227],v[80:83]
v_mfma_f32_16x16x32_bf16 v[84:87],a[100:103],v[228:231],v[84:87]
v_mfma_f32_16x16x32_bf16 v[80:83],a[104:107],v[232:235],v[80:83]
v_mfma_f32_16x16x32_bf16 v[84:87],a[108:111],v[236:239],v[84:87]
s_branch epi_286
ahead_285:
s_waitcnt vmcnt(6) lgkmcnt(0)
s_barrier
ds_read_b32 v44,v45
ds_read_b128 v[224:227],v18 offset:0
ds_read_b128 v[228:231],v18 offset:2048
ds_read_b128 v[232:235],v18 offset:4096
ds_read_b128 v[236:239],v18 offset:6144
ds_read_b128 v[240:243],v18 offset:8192
ds_read_b128 v[244:247],v18 offset:10240
ds_read_b128 v[248:251],v18 offset:12288
s_waitcnt lgkmcnt(5)
v_mfma_f32_16x16x32_bf16 v[64:67],a[0:3],v[224:227],0
s_add_u32 s88,s70,s75
s_add_u32 s88,s88,2097152
v_min_u32 v27,v224,v228
v_mfma_f32_16x16x32_bf16 v[68:71],a[112:115],v[224:227],0
ds_read_b128 v[252:255],v18 offset:14336
s_xor_b32 s88,s88,0x2000
v_mfma_f32_16x16x32_bf16 v[64:67],a[4:7],v[228:231],v[64:67]
v_readfirstlane_b32 s83,v44
v_mfma_f32_16x16x32_bf16 v[68:71],a[116:119],v[228:231],v[68:71]
ds_read_b128 v[224:227],v18 offset:16384
s_waitcnt lgkmcnt(5)
v_mfma_f32_16x16x32_bf16 v[64:67],a[8:11],v[232:235],v[64:67]
s_cmp_eq_u32 s83,0
s_cselect_b32 s88,s88,0x7fff0000
v_mfma_f32_16x16x32_bf16 v[68:71],a[120:123],v[232:235],v[68:71]
ds_read_b128 v[228:231],v18 offset:18432
s_xor_b32 s89,s88,1024
v_mfma_f32_16x16x32_bf16 v[64:67],a[12:15],v[236:239],v[64:67]
s_xor_b32 m0,s72,0
v_min3_u32 v27,v27,v232,v236
v_mfma_f32_16x16x32_bf16 v[68:71],a[124:127],v[236:239],v[68:71]
ds_read_b128 v[232:235],v18 offset:20480
s_add_u32 s65,s88,0
s_waitcnt lgkmcnt(5)
v_mfma_f32_16x16x32_bf16 v[64:67],a[16:19],v[240:243],v[64:67]
v_min3_u32 v27,v27,v240,v244
v_mfma_f32_16x16x32_bf16 v[68:71],a[128:131],v[240:243],v[68:71]
ds_read_b128 v[236:239],v18 offset:22528
buffer_load_dwordx4 v16,s[20:23],s65 offen offset:0 sc1 lds
v_mfma_f32_16x16x32_bf16 v[64:67],a[20:23],v[244:247],v[64:67]
buffer_load_dwordx2 v[120:121],v20,s[20:23],s76 offen sc1
v_mfma_f32_16x16x32_bf16 v[68:71],a[132:135],v[244:247],v[68:71]
ds_read_b128 v[240:243],v18 offset:24576
s_waitcnt lgkmcnt(5)
v_mfma_f32_16x16x32_bf16 v[64:67],a[24:27],v[248:251],v[64:67]
buffer_load_dwordx4 v16,s[20:23],s65 offen offset:2048 sc1 lds
v_mfma_f32_16x16x32_bf16 v[68:71],a[136:139],v[248:251],v[68:71]
ds_read_b128 v[244:247],v18 offset:26624
s_xor_b32 m0,s72,16384
v_mfma_f32_16x16x32_bf16 v[64:67],a[28:31],v[252:255],v[64:67]
v_min3_u32 v27,v27,v248,v252
v_mfma_f32_16x16x32_bf16 v[68:71],a[140:143],v[252:255],v[68:71]
ds_read_b128 v[248:251],v18 offset:28672
s_add_u32 s65,s88,32768
s_waitcnt lgkmcnt(5)
v_mfma_f32_16x16x32_bf16 v[64:67],a[32:35],v[224:227],v[64:67]
v_min3_u32 v27,v27,v224,v228
v_mfma_f32_16x16x32_bf16 v[68:71],a[144:147],v[224:227],v[68:71]
ds_read_b128 v[252:255],v18 offset:30720
buffer_load_dwordx4 v16,s[20:23],s65 offen offset:0 sc1 lds
v_mfma_f32_16x16x32_bf16 v[64:67],a[36:39],v[228:231],v[64:67]
buffer_load_dwordx4 v16,s[20:23],s65 offen offset:2048 sc1 lds
v_mfma_f32_16x16x32_bf16 v[68:71],a[148:151],v[228:231],v[68:71]
ds_read_b128 v[224:227],v18 offset:32768
s_waitcnt lgkmcnt(5)
v_mfma_f32_16x16x32_bf16 v[64:67],a[40:43],v[232:235],v[64:67]
s_xor_b32 m0,s72,32768
v_min3_u32 v27,v27,v232,v236
v_mfma_f32_16x16x32_bf16 v[68:71],a[152:155],v[232:235],v[68:71]
ds_read_b128 v[228:231],v18 offset:34816
v_mfma_f32_16x16x32_bf16 v[64:67],a[44:47],v[236:239],v[64:67]
s_add_u32 s65,s88,65536
v_mfma_f32_16x16x32_bf16 v[68:71],a[156:159],v[236:239],v[68:71]
ds_read_b128 v[232:235],v18 offset:36864
s_waitcnt lgkmcnt(5)
v_mfma_f32_16x16x32_bf16 v[64:67],a[48:51],v[240:243],v[64:67]
buffer_load_dwordx4 v16,s[20:23],s65 offen offset:0 sc1 lds
v_mfma_f32_16x16x32_bf16 v[68:71],a[160:163],v[240:243],v[68:71]
ds_read_b128 v[236:239],v18 offset:38912
v_min3_u32 v27,v27,v240,v244
v_mfma_f32_16x16x32_bf16 v[64:67],a[52:55],v[244:247],v[64:67]
buffer_load_dwordx4 v16,s[20:23],s65 offen offset:2048 sc1 lds
v_mfma_f32_16x16x32_bf16 v[68:71],a[164:167],v[244:247],v[68:71]
ds_read_b128 v[240:243],v18 offset:40960
s_waitcnt lgkmcnt(5)
v_mfma_f32_16x16x32_bf16 v[64:67],a[56:59],v[248:251],v[64:67]
s_xor_b32 m0,s72,49152
v_min3_u32 v27,v27,v248,v252
v_mfma_f32_16x16x32_bf16 v[68:71],a[168:171],v[248:251],v[68:71]
ds_read_b128 v[244:247],v18 offset:43008
s_add_u32 s65,s88,s86
v_mfma_f32_16x16x32_bf16 v[64:67],a[60:63],v[252:255],v[64:67]
buffer_load_dwordx2 v[122:123],v24,s[20:23],s70 offen sc1
v_mfma_f32_16x16x32_bf16 v[68:71],a[172:175],v[252:255],v[68:71]
ds_read_b128 v[248:251],v18 offset:45056
s_waitcnt lgkmcnt(5)
v_mfma_f32_16x16x32_bf16 v[64:67],a[64:67],v[224:227],v[64:67]
ds_read_b128 v[128:131],v17 offset:0
ds_read_b128 v[132:135],v17 offset:2048
v_min3_u32 v27,v27,v224,v228
v_mfma_f32_16x16x32_bf16 v[68:71],a[176:179],v[224:227],v[68:71]
ds_read_b128 v[252:255],v18 offset:47104
buffer_load_dwordx4 v16,s[20:23],s65 offen offset:0 sc1 lds
v_mfma_f32_16x16x32_bf16 v[64:67],a[68:71],v[228:231],v[64:67]
ds_read_b128 v[136:139],v17 offset:4096
buffer_load_dwordx4 v16,s[20:23],s65 offen offset:2048 sc1 lds
v_mfma_f32_16x16x32_bf16 v[68:71],a[180:183],v[228:231],v[68:71]
ds_read_b128 v[224:227],v18 offset:49152
s_xor_b32 m0,s72,1024
s_waitcnt lgkmcnt(8)
v_mfma_f32_16x16x32_bf16 v[64:67],a[72:75],v[232:235],v[64:67]
ds_read_b128 v[140:143],v17 offset:6144
v_min3_u32 v27,v27,v232,v236
v_mfma_f32_16x16x32_bf16 v[68:71],a[184:187],v[232:235],v[68:71]
ds_read_b128 v[228:231],v18 offset:51200
s_add_u32 s65,s89,0
v_mfma_f32_16x16x32_bf16 v[64:67],a[76:79],v[236:239],v[64:67]
ds_read_b128 v[144:147],v17 offset:8192
ds_read_b128 v[148:151],v17 offset:10240
v_mfma_f32_16x16x32_bf16 v[68:71],a[188:191],v[236:239],v[68:71]
ds_read_b128 v[232:235],v18 offset:53248
s_waitcnt lgkmcnt(11)
v_mfma_f32_16x16x32_bf16 v[64:67],a[80:83],v[240:243],v[64:67]
ds_read_b128 v[152:155],v17 offset:12288
buffer_load_dwordx4 v16,s[20:23],s65 offen offset:0 sc1 lds
v_mfma_f32_16x16x32_bf16 v[68:71],a[192:195],v[240:243],v[68:71]
ds_read_b128 v[236:239],v18 offset:55296
buffer_load_dwordx4 v16,s[20:23],s65 offen offset:2048 sc1 lds
v_mfma_f32_16x16x32_bf16 v[64:67],a[84:87],v[244:247],v[64:67]
ds_read_b128 v[156:159],v17 offset:14336
s_xor_b32 m0,s72,17408
v_min3_u32 v27,v27,v240,v244
v_mfma_f32_16x16x32_bf16 v[68:71],a[196:199],v[244:247],v[68:71]
s_waitcnt lgkmcnt(10)
v_mfma_f32_16x16x32_bf16 v[64:67],a[88:91],v[248:251],v[64:67]
ds_read_b128 v[160:163],v17 offset:16384
ds_read_b128 v[164:167],v17 offset:18432
s_add_u32 s65,s89,32768
v_mfma_f32_16x16x32_bf16 v[68:71],a[200:203],v[248:251],v[68:71]
v_min3_u32 v27,v27,v248,v252
v_mfma_f32_16x16x32_bf16 v[64:67],a[92:95],v[252:255],v[64:67]
ds_read_b128 v[168:171],v17 offset:20480
buffer_load_dwordx4 v16,s[20:23],s65 offen offset:0 sc1 lds
v_mfma_f32_16x16x32_bf16 v[68:71],a[204:207],v[252:255],v[68:71]
s_waitcnt lgkmcnt(9)
v_mfma_f32_16x16x32_bf16 v[64:67],a[96:99],v[224:227],v[64:67]
ds_read_b128 v[172:175],v17 offset:22528
buffer_load_dwordx4 v16,s[20:23],s65 offen offset:2048 sc1 lds
v_mfma_f32_16x16x32_bf16 v[68:71],a[208:211],v[224:227],v[68:71]
v_min3_u32 v27,v27,v224,v228
v_min3_u32 v27,v27,v226,v230
v_mfma_f32_16x16x32_bf16 v[64:67],a[100:103],v[228:231],v[64:67]
ds_read_b128 v[176:179],v17 offset:24576
ds_read_b128 v[180:183],v17 offset:26624
s_xor_b32 m0,s72,33792
v_mfma_f32_16x16x32_bf16 v[68:71],a[212:215],v[228:231],v[68:71]
s_waitcnt lgkmcnt(7)
v_mfma_f32_16x16x32_bf16 v[64:67],a[104:107],v[232:235],v[64:67]
ds_read_b128 v[184:187],v17 offset:28672
s_add_u32 s65,s89,65536
v_min3_u32 v27,v27,v232,v236
v_mfma_f32_16x16x32_bf16 v[68:71],a[216:219],v[232:235],v[68:71]
buffer_load_dwordx4 v16,s[20:23],s65 offen offset:0 sc1 lds
v_mfma_f32_16x16x32_bf16 v[64:67],a[108:111],v[236:239],v[64:67]
ds_read_b128 v[188:191],v17 offset:30720
v_min3_u32 v27,v27,v234,v238
buffer_load_dword v2,v21,s[20:23],s87 offen sc1
v_mfma_f32_16x16x32_bf16 v[68:71],a[220:223],v[236:239],v[68:71]
buffer_load_dwordx4 v16,s[20:23],s65 offen offset:2048 sc1 lds
v_mfma_f32_16x16x32_bf16 v[72:75],a[112:115],v[128:131],0
v_cmp_eq_u32 vcc,0,v27
s_cbranch_vccnz retry_283
v_mfma_f32_16x16x32_bf16 v[76:79],a[116:119],v[132:135],0
s_xor_b32 m0,s72,50176
v_min3_u32 v27,v27,v128,v132
v_mfma_f32_16x16x32_bf16 v[72:75],a[120:123],v[136:139],v[72:75]
ds_read_b128 v[192:195],v17 offset:32768
s_add_u32 s96,s71,2
v_mfma_f32_16x16x32_bf16 v[76:79],a[124:127],v[140:143],v[76:79]
ds_read_b128 v[196:199],v17 offset:34816
s_add_u32 s65,s89,s86
s_waitcnt lgkmcnt(10)
v_mfma_f32_16x16x32_bf16 v[72:75],a[128:131],v[144:147],v[72:75]
ds_read_b128 v[200:203],v17 offset:36864
v_min3_u32 v27,v27,v136,v140
s_waitcnt vmcnt(9)
v_mfma_f32_16x16x32_bf16 v[76:79],a[132:135],v[148:151],v[76:79]
ds_read_b128 v[204:207],v17 offset:38912
buffer_load_dwordx4 v16,s[20:23],s65 offen offset:0 sc1 lds
v_mfma_f32_16x16x32_bf16 v[72:75],a[136:139],v[152:155],v[72:75]
ds_read_b128 v[208:211],v17 offset:40960
v_min3_u32 v27,v27,v144,v148
v_and_or_b32 v64,v64,-4,s48
v_mfma_f32_16x16x32_bf16 v[76:79],a[140:143],v[156:159],v[76:79]
buffer_load_dwordx4 v16,s[20:23],s65 offen offset:2048 sc1 lds
s_waitcnt lgkmcnt(9)
v_mfma_f32_16x16x32_bf16 v[72:75],a[144:147],v[160:163],v[72:75]
ds_read_b128 v[212:215],v17 offset:43008
v_min3_u32 v27,v27,v152,v156
s_add_u32 s64,s49,s34
v_mfma_f32_16x16x32_bf16 v[76:79],a[148:151],v[164:167],v[76:79]
ds_read_b128 v[216:219],v17 offset:45056
v_min3_u32 v27,v27,v160,v164
v_mfma_f32_16x16x32_bf16 v[72:75],a[152:155],v[168:171],v[72:75]
ds_read_b128 v[220:223],v17 offset:47104
buffer_store_dwordx4 v[64:67],v25,s[20:23],s64 offen offset:2048
v_mfma_f32_16x16x32_bf16 v[76:79],a[156:159],v[172:175],v[76:79]
ds_read_b128 v[224:227],v17 offset:49152
v_and_or_b32 v68,v68,-4,s48
s_waitcnt lgkmcnt(9)
v_mfma_f32_16x16x32_bf16 v[72:75],a[160:163],v[176:179],v[72:75]
ds_read_b128 v[228:231],v17 offset:51200
v_min3_u32 v27,v27,v168,v172
s_add_u32 s64,s49,s35
v_mfma_f32_16x16x32_bf16 v[76:79],a[164:167],v[180:183],v[76:79]
v_min3_u32 v27,v27,v176,v180
buffer_store_dwordx4 v[68:71],v25,s[20:23],s64 offen offset:3072
v_mfma_f32_16x16x32_bf16 v[72:75],a[168:171],v[184:187],v[72:75]
ds_read_b128 v[232:235],v17 offset:53248
s_mov_b32 s49,0x7fff0000
v_mfma_f32_16x16x32_bf16 v[76:79],a[172:175],v[188:191],v[76:79]
ds_read_b128 v[236:239],v17 offset:55296
s_waitcnt lgkmcnt(8)
v_mfma_f32_16x16x32_bf16 v[72:75],a[176:179],v[192:195],v[72:75]
v_min3_u32 v27,v27,v184,v188
v_mfma_f32_16x16x32_bf16 v[76:79],a[180:183],v[196:199],v[76:79]
v_min3_u32 v27,v27,v192,v196
ds_bpermute_b32 v124,v41,v120
v_mfma_f32_16x16x32_bf16 v[72:75],a[184:187],v[200:203],v[72:75]
v_mfma_f32_16x16x32_bf16 v[76:79],a[188:191],v[204:207],v[76:79]
v_min3_u32 v27,v27,v200,v204
s_waitcnt lgkmcnt(5)
v_mfma_f32_16x16x32_bf16 v[72:75],a[192:195],v[208:211],v[72:75]
ds_bpermute_b32 v125,v41,v121
v_mfma_f32_16x16x32_bf16 v[76:79],a[196:199],v[212:215],v[76:79]
v_min3_u32 v27,v27,v208,v212
v_lshlrev_b32 v108,16,v122
v_mfma_f32_16x16x32_bf16 v[72:75],a[200:203],v[216:219],v[72:75]
v_mfma_f32_16x16x32_bf16 v[76:79],a[204:207],v[220:223],v[76:79]
v_min3_u32 v27,v27,v216,v220
s_waitcnt lgkmcnt(2)
v_mfma_f32_16x16x32_bf16 v[72:75],a[208:211],v[224:227],v[72:75]
v_and_b32 v109,s80,v122
v_mfma_f32_16x16x32_bf16 v[76:79],a[212:215],v[228:231],v[76:79]
v_min3_u32 v27,v27,v224,v228
v_min3_u32 v27,v27,v226,v230
v_mfma_f32_16x16x32_bf16 v[72:75],a[216:219],v[232:235],v[72:75]
v_lshlrev_b32 v110,16,v123
v_mfma_f32_16x16x32_bf16 v[76:79],a[220:223],v[236:239],v[76:79]
v_min3_u32 v27,v27,v232,v236
v_min3_u32 v27,v27,v234,v238
v_mfma_f32_16x16x32_bf16 v[80:83],a[0:3],v[128:131],0
v_cmp_eq_u32 vcc,0,v27
s_cbranch_vccnz retry_283
v_mfma_f32_16x16x32_bf16 v[84:87],a[4:7],v[132:135],0
v_and_b32 v111,s80,v123
s_waitcnt lgkmcnt(0)
v_mfma_f32_16x16x32_bf16 v[80:83],a[8:11],v[136:139],v[80:83]
v_mfma_f32_16x16x32_bf16 v[84:87],a[12:15],v[140:143],v[84:87]
v_lshlrev_b32 v104,16,v124
v_mfma_f32_16x16x32_bf16 v[80:83],a[16:19],v[144:147],v[80:83]
v_add_f32 v72,v72,v76
v_add_f32 v73,v73,v77
v_mfma_f32_16x16x32_bf16 v[84:87],a[20:23],v[148:151],v[84:87]
v_and_b32 v105,s80,v124
v_add_f32 v74,v74,v78
v_mfma_f32_16x16x32_bf16 v[80:83],a[24:27],v[152:155],v[80:83]
v_add_f32 v75,v75,v79
v_and_or_b32 v72,v72,-4,s48
v_mfma_f32_16x16x32_bf16 v[84:87],a[28:31],v[156:159],v[84:87]
v_lshlrev_b32 v106,16,v125
s_add_u32 s64,s77,s33
v_mfma_f32_16x16x32_bf16 v[80:83],a[32:35],v[160:163],v[80:83]
buffer_store_dwordx4 v[72:75],v25,s[20:23],s64 offen offset:1024
v_mfma_f32_16x16x32_bf16 v[84:87],a[36:39],v[164:167],v[84:87]
v_and_b32 v107,s80,v125
v_mfma_f32_16x16x32_bf16 v[80:83],a[40:43],v[168:171],v[80:83]
v_mfma_f32_16x16x32_bf16 v[84:87],a[44:47],v[172:175],v[84:87]
v_mfma_f32_16x16x32_bf16 v[80:83],a[48:51],v[176:179],v[80:83]
buffer_load_dwordx4 v[96:99],v26,s[20:23],s77 offen offset:2048 sc1
v_mfma_f32_16x16x32_bf16 v[84:87],a[52:55],v[180:183],v[84:87]
buffer_load_dwordx4 v[100:103],v26,s[20:23],s77 offen offset:3072 sc1
v_mfma_f32_16x16x32_bf16 v[80:83],a[56:59],v[184:187],v[80:83]
v_mfma_f32_16x16x32_bf16 v[84:87],a[60:63],v[188:191],v[84:87]
v_mfma_f32_16x16x32_bf16 v[80:83],a[64:67],v[192:195],v[80:83]
s_waitcnt vmcnt(8)
v_mfma_f32_16x16x32_bf16 v[84:87],a[68:71],v[196:199],v[84:87]
v_cmp_gt_u32 vcc,s96,v2
s_mov_b32 s96,vcc_lo
v_mfma_f32_16x16x32_bf16 v[80:83],a[72:75],v[200:203],v[80:83]
v_mov_b32 v44,s96
ds_write_b32 v46,v44
v_mfma_f32_16x16x32_bf16 v[84:87],a[76:79],v[204:207],v[84:87]
v_mfma_f32_16x16x32_bf16 v[80:83],a[80:83],v[208:211],v[80:83]
v_mfma_f32_16x16x32_bf16 v[84:87],a[84:87],v[212:215],v[84:87]
v_mfma_f32_16x16x32_bf16 v[80:83],a[88:91],v[216:219],v[80:83]
buffer_load_dwordx4 v[92:95],v26,s[20:23],s77 offen offset:1024 sc1
v_mfma_f32_16x16x32_bf16 v[84:87],a[92:95],v[220:223],v[84:87]
v_mfma_f32_16x16x32_bf16 v[80:83],a[96:99],v[224:227],v[80:83]
v_mfma_f32_16x16x32_bf16 v[84:87],a[100:103],v[228:231],v[84:87]
v_mfma_f32_16x16x32_bf16 v[80:83],a[104:107],v[232:235],v[80:83]
v_mfma_f32_16x16x32_bf16 v[84:87],a[108:111],v[236:239],v[84:87]
epi_286:
buffer_load_dword v29,v21,s[20:23],s87 offen sc1
s_nop 6
v_pk_add_f32 v[88:89],v[80:81],v[84:85]
v_pk_add_f32 v[90:91],v[82:83],v[86:87]
v_pk_add_f32 v[88:89],v[88:89],v[108:109]
v_pk_add_f32 v[90:91],v[90:91],v[110:111]
s_waitcnt vmcnt(1)
s_branch ic_293
ip_291:
buffer_load_dwordx4 v[92:95],v26,s[20:23],s77 offen offset:1024 sc1
buffer_load_dwordx4 v[96:99],v26,s[20:23],s77 offen offset:2048 sc1
buffer_load_dwordx4 v[100:103],v26,s[20:23],s77 offen offset:3072 sc1
s_waitcnt vmcnt(0)
ic_293:
v_bitop3_b32 v22,v92,v96,v100 bitop3:0x80
v_and_b32 v22,s48,v22
v_cmp_eq_u32 vcc,0,v22
s_cbranch_vccz ik_292
s_sub_u32 s90,s90,1
s_cmp_gt_i32 s90,0
s_cbranch_scc1 ip_291
ik_292:
v_pk_add_f32 v[88:89],v[88:89],v[92:93]
v_pk_add_f32 v[96:97],v[96:97],v[100:101]
v_pk_add_f32 v[90:91],v[90:91],v[94:95]
v_pk_add_f32 v[98:99],v[98:99],v[102:103]
v_pk_add_f32 v[88:89],v[88:89],v[96:97]
v_pk_add_f32 v[90:91],v[90:91],v[98:99]
v_pk_fma_f32 v[88:89],v[88:89],v[52:53],v[104:105]
v_pk_fma_f32 v[90:91],v[90:91],v[54:55],v[106:107]
v_cvt_pk_bf16_f32 v88,v88,v89
v_cvt_pk_bf16_f32 v89,v90,v91
ds_bpermute_b32 v88,v40,v88
ds_bpermute_b32 v89,v40,v89
v_xor_b32 v18,0x10000,v18
s_xor_b32 s49,s77,524288
s_cselect_b32 s64,0,3
s_xor_b32 s48,s48,s64
v_xor_b32 v20,0x2000,v20
s_add_u32 s76,s76,2097152
s_waitcnt lgkmcnt(0)
s_mov_b64 exec,s[84:85]
buffer_store_dwordx2 v[88:89],v19,s[36:39],s78 offen
s_mov_b64 exec,-1
s_mov_b64 s[84:85],-1
s_mov_b32 s77,s49
s_add_u32 s78,s78,65536
v_xor_b32 v17,0x10000,v17
v_xor_b32 v45,16,v45
v_xor_b32 v46,16,v46
s_xor_b32 s72,s72,0x10000
s_add_u32 s70,s70,2097152
s_xor_b32 s70,s70,0x2000
s_add_u32 s71,s71,1
s_cmp_le_u32 s71,s57
s_cbranch_scc1 seg_284
s_endpgm
retry_283:
s_sub_u32 s90,s90,64
s_cmp_lt_i32 s90,0
s_cbranch_scc1 giveup_176
s_mov_b32 s83,1
s_waitcnt vmcnt(0) lgkmcnt(0)
s_barrier
s_branch seg_284
kslow_282:
s_add_u32 s64,s79,0
s_lshl_b32 s70,s64,21
s_lshl_b32 s64,s64,13
s_and_b32 s64,s64,0x2000
s_xor_b32 s64,s64,s62
s_add_u32 s70,s70,s64
s_add_u32 s70,s70,29360128
s_mov_b32 s83,1
s_mov_b32 s87,s74
s_cmp_eq_u32 s50,0
s_cselect_b32 s74,s74,0x7fff0000
v_mov_b32 v45,132096
s_lshl_b32 s64,s50,2
s_add_u32 s64,s64,132112
v_mov_b32 v46,s64
v_mov_b32 v2,0
v_mov_b32 v44,1
ds_write_b32 v45,v44
s_mov_b32 s97,0x7fff0000
s_waitcnt lgkmcnt(0)
seg_295:
s_add_u32 s94,s70,s75
s_xor_b32 s95,s94,1024
s_xor_b32 s91,s72,0x10000
s_waitcnt lgkmcnt(0)
v_cmp_gt_u32 vcc,s71,v2
s_cbranch_vccz nb_299
s_waitcnt vmcnt(1)
v_cmp_gt_u32 vcc,s71,v29
s_cbranch_vccz nb_299
s_cmp_lg_u32 s50,0
s_cbranch_scc1 nb_299
buffer_load_dword v32,v21,s[20:23],s74 offen sc1
s_sleep 2
pl_300:
buffer_load_dword v33,v21,s[20:23],s74 offen sc1
s_waitcnt vmcnt(1)
v_cmp_gt_u32 vcc,s71,v32
s_cbranch_vccz pok_301
buffer_load_dword v32,v21,s[20:23],s74 offen sc1
s_waitcnt vmcnt(1)
v_cmp_gt_u32 vcc,s71,v33
s_cbranch_vccz pok_301
s_sub_u32 s90,s90,1
s_cmp_gt_i32 s90,0
s_cbranch_scc1 pl_300
pok_301:
nb_299:
s_barrier
s_xor_b32 m0,s91,0
s_add_u32 s65,s94,0
buffer_load_dwordx4 v16,s[20:23],s65 offen offset:0 sc1 lds
buffer_load_dwordx4 v16,s[20:23],s65 offen offset:2048 sc1 lds
ds_read_b32 v44,v45
s_xor_b32 m0,s91,16384
s_add_u32 s65,s94,32768
buffer_load_dwordx4 v16,s[20:23],s65 offen offset:0 sc1 lds
buffer_load_dwordx4 v16,s[20:23],s65 offen offset:2048 sc1 lds
s_xor_b32 m0,s91,32768
s_add_u32 s65,s94,65536
buffer_load_dwordx4 v16,s[20:23],s65 offen offset:0 sc1 lds
buffer_load_dwordx4 v16,s[20:23],s65 offen offset:2048 sc1 lds
s_xor_b32 m0,s91,49152
s_add_u32 s65,s94,s86
buffer_load_dwordx4 v16,s[20:23],s65 offen offset:0 sc1 lds
buffer_load_dwordx4 v16,s[20:23],s65 offen offset:2048 sc1 lds
s_xor_b32 m0,s91,1024
s_add_u32 s65,s95,0
buffer_load_dwordx4 v16,s[20:23],s65 offen offset:0 sc1 lds
buffer_load_dwordx4 v16,s[20:23],s65 offen offset:2048 sc1 lds
s_waitcnt vmcnt(8)
s_barrier
ds_read_b128 v[224:227],v18 offset:0
ds_read_b128 v[228:231],v18 offset:2048
ds_read_b128 v[232:235],v18 offset:4096
ds_read_b128 v[236:239],v18 offset:6144
ds_read_b128 v[240:243],v18 offset:8192
ds_read_b128 v[244:247],v18 offset:10240
ds_read_b128 v[248:251],v18 offset:12288
s_waitcnt lgkmcnt(5)
v_mfma_f32_16x16x32_bf16 v[64:67],a[0:3],v[224:227],0
v_min_u32 v27,v224,v228
s_xor_b32 m0,s91,17408
v_mfma_f32_16x16x32_bf16 v[68:71],a[112:115],v[224:227],0
ds_read_b128 v[252:255],v18 offset:14336
v_mfma_f32_16x16x32_bf16 v[64:67],a[4:7],v[228:231],v[64:67]
s_add_u32 s65,s95,32768
v_mfma_f32_16x16x32_bf16 v[68:71],a[116:119],v[228:231],v[68:71]
s_waitcnt vmcnt(6)
s_barrier
ds_read_b128 v[224:227],v18 offset:16384
s_waitcnt lgkmcnt(5)
v_mfma_f32_16x16x32_bf16 v[64:67],a[8:11],v[232:235],v[64:67]
v_min3_u32 v27,v27,v232,v236
buffer_load_dwordx4 v16,s[20:23],s65 offen offset:0 sc1 lds
v_mfma_f32_16x16x32_bf16 v[68:71],a[120:123],v[232:235],v[68:71]
ds_read_b128 v[228:231],v18 offset:18432
v_mfma_f32_16x16x32_bf16 v[64:67],a[12:15],v[236:239],v[64:67]
buffer_load_dwordx4 v16,s[20:23],s65 offen offset:2048 sc1 lds
v_mfma_f32_16x16x32_bf16 v[68:71],a[124:127],v[236:239],v[68:71]
ds_read_b128 v[232:235],v18 offset:20480
s_waitcnt lgkmcnt(5)
v_mfma_f32_16x16x32_bf16 v[64:67],a[16:19],v[240:243],v[64:67]
v_min3_u32 v27,v27,v240,v244
s_xor_b32 m0,s91,33792
v_mfma_f32_16x16x32_bf16 v[68:71],a[128:131],v[240:243],v[68:71]
ds_read_b128 v[236:239],v18 offset:22528
v_mfma_f32_16x16x32_bf16 v[64:67],a[20:23],v[244:247],v[64:67]
s_add_u32 s65,s95,65536
v_mfma_f32_16x16x32_bf16 v[68:71],a[132:135],v[244:247],v[68:71]
ds_read_b128 v[240:243],v18 offset:24576
s_waitcnt lgkmcnt(5)
v_mfma_f32_16x16x32_bf16 v[64:67],a[24:27],v[248:251],v[64:67]
v_min3_u32 v27,v27,v248,v252
buffer_load_dwordx4 v16,s[20:23],s65 offen offset:0 sc1 lds
v_mfma_f32_16x16x32_bf16 v[68:71],a[136:139],v[248:251],v[68:71]
ds_read_b128 v[244:247],v18 offset:26624
v_mfma_f32_16x16x32_bf16 v[64:67],a[28:31],v[252:255],v[64:67]
buffer_load_dwordx4 v16,s[20:23],s65 offen offset:2048 sc1 lds
v_mfma_f32_16x16x32_bf16 v[68:71],a[140:143],v[252:255],v[68:71]
ds_read_b128 v[248:251],v18 offset:28672
s_waitcnt lgkmcnt(5)
v_mfma_f32_16x16x32_bf16 v[64:67],a[32:35],v[224:227],v[64:67]
v_min3_u32 v27,v27,v224,v228
s_xor_b32 m0,s91,50176
v_mfma_f32_16x16x32_bf16 v[68:71],a[144:147],v[224:227],v[68:71]
ds_read_b128 v[252:255],v18 offset:30720
v_mfma_f32_16x16x32_bf16 v[64:67],a[36:39],v[228:231],v[64:67]
s_add_u32 s65,s95,s86
v_mfma_f32_16x16x32_bf16 v[68:71],a[148:151],v[228:231],v[68:71]
s_waitcnt vmcnt(6)
s_barrier
ds_read_b128 v[224:227],v18 offset:32768
s_waitcnt lgkmcnt(5)
v_mfma_f32_16x16x32_bf16 v[64:67],a[40:43],v[232:235],v[64:67]
v_min3_u32 v27,v27,v232,v236
buffer_load_dwordx4 v16,s[20:23],s65 offen offset:0 sc1 lds
v_mfma_f32_16x16x32_bf16 v[68:71],a[152:155],v[232:235],v[68:71]
ds_read_b128 v[228:231],v18 offset:34816
v_mfma_f32_16x16x32_bf16 v[64:67],a[44:47],v[236:239],v[64:67]
buffer_load_dwordx4 v16,s[20:23],s65 offen offset:2048 sc1 lds
v_mfma_f32_16x16x32_bf16 v[68:71],a[156:159],v[236:239],v[68:71]
ds_read_b128 v[232:235],v18 offset:36864
s_waitcnt lgkmcnt(5)
v_mfma_f32_16x16x32_bf16 v[64:67],a[48:51],v[240:243],v[64:67]
v_min3_u32 v27,v27,v240,v244
v_mfma_f32_16x16x32_bf16 v[68:71],a[160:163],v[240:243],v[68:71]
ds_read_b128 v[236:239],v18 offset:38912
v_mfma_f32_16x16x32_bf16 v[64:67],a[52:55],v[244:247],v[64:67]
buffer_load_dwordx2 v[120:121],v20,s[20:23],s76 offen sc1
v_mfma_f32_16x16x32_bf16 v[68:71],a[164:167],v[244:247],v[68:71]
ds_read_b128 v[240:243],v18 offset:40960
s_waitcnt lgkmcnt(5)
v_mfma_f32_16x16x32_bf16 v[64:67],a[56:59],v[248:251],v[64:67]
v_min3_u32 v27,v27,v248,v252
v_mfma_f32_16x16x32_bf16 v[68:71],a[168:171],v[248:251],v[68:71]
ds_read_b128 v[244:247],v18 offset:43008
v_mfma_f32_16x16x32_bf16 v[64:67],a[60:63],v[252:255],v[64:67]
buffer_load_dwordx2 v[122:123],v24,s[20:23],s70 offen sc1
v_mfma_f32_16x16x32_bf16 v[68:71],a[172:175],v[252:255],v[68:71]
ds_read_b128 v[248:251],v18 offset:45056
s_waitcnt lgkmcnt(5)
v_mfma_f32_16x16x32_bf16 v[64:67],a[64:67],v[224:227],v[64:67]
s_waitcnt vmcnt(6)
s_barrier
ds_read_b128 v[128:131],v17 offset:0
ds_read_b128 v[132:135],v17 offset:2048
v_mfma_f32_16x16x32_bf16 v[68:71],a[176:179],v[224:227],v[68:71]
ds_read_b128 v[252:255],v18 offset:47104
v_min3_u32 v27,v27,v224,v228
v_mfma_f32_16x16x32_bf16 v[64:67],a[68:71],v[228:231],v[64:67]
ds_read_b128 v[136:139],v17 offset:4096
v_mfma_f32_16x16x32_bf16 v[68:71],a[180:183],v[228:231],v[68:71]
ds_read_b128 v[224:227],v18 offset:49152
s_waitcnt lgkmcnt(8)
v_mfma_f32_16x16x32_bf16 v[64:67],a[72:75],v[232:235],v[64:67]
ds_read_b128 v[140:143],v17 offset:6144
v_min3_u32 v27,v27,v232,v236
v_mfma_f32_16x16x32_bf16 v[68:71],a[184:187],v[232:235],v[68:71]
ds_read_b128 v[228:231],v18 offset:51200
v_mfma_f32_16x16x32_bf16 v[64:67],a[76:79],v[236:239],v[64:67]
ds_read_b128 v[144:147],v17 offset:8192
ds_read_b128 v[148:151],v17 offset:10240
v_mfma_f32_16x16x32_bf16 v[68:71],a[188:191],v[236:239],v[68:71]
ds_read_b128 v[232:235],v18 offset:53248
s_waitcnt lgkmcnt(11)
v_mfma_f32_16x16x32_bf16 v[64:67],a[80:83],v[240:243],v[64:67]
ds_read_b128 v[152:155],v17 offset:12288
v_min3_u32 v27,v27,v240,v244
v_mfma_f32_16x16x32_bf16 v[68:71],a[192:195],v[240:243],v[68:71]
ds_read_b128 v[236:239],v18 offset:55296
v_mfma_f32_16x16x32_bf16 v[64:67],a[84:87],v[244:247],v[64:67]
ds_read_b128 v[156:159],v17 offset:14336
v_mfma_f32_16x16x32_bf16 v[68:71],a[196:199],v[244:247],v[68:71]
s_waitcnt lgkmcnt(10)
v_mfma_f32_16x16x32_bf16 v[64:67],a[88:91],v[248:251],v[64:67]
ds_read_b128 v[160:163],v17 offset:16384
ds_read_b128 v[164:167],v17 offset:18432
v_mfma_f32_16x16x32_bf16 v[68:71],a[200:203],v[248:251],v[68:71]
v_min3_u32 v27,v27,v248,v252
v_mfma_f32_16x16x32_bf16 v[64:67],a[92:95],v[252:255],v[64:67]
ds_read_b128 v[168:171],v17 offset:20480
v_mfma_f32_16x16x32_bf16 v[68:71],a[204:207],v[252:255],v[68:71]
s_waitcnt lgkmcnt(9)
v_mfma_f32_16x16x32_bf16 v[64:67],a[96:99],v[224:227],v[64:67]
ds_read_b128 v[172:175],v17 offset:22528
v_min3_u32 v27,v27,v224,v228
v_mfma_f32_16x16x32_bf16 v[68:71],a[208:211],v[224:227],v[68:71]
v_min3_u32 v27,v27,v226,v230
v_mfma_f32_16x16x32_bf16 v[64:67],a[100:103],v[228:231],v[64:67]
ds_read_b128 v[176:179],v17 offset:24576
ds_read_b128 v[180:183],v17 offset:26624
v_mfma_f32_16x16x32_bf16 v[68:71],a[212:215],v[228:231],v[68:71]
s_waitcnt lgkmcnt(7)
v_mfma_f32_16x16x32_bf16 v[64:67],a[104:107],v[232:235],v[64:67]
ds_read_b128 v[184:187],v17 offset:28672
v_min3_u32 v27,v27,v232,v236
v_mfma_f32_16x16x32_bf16 v[68:71],a[216:219],v[232:235],v[68:71]
v_min3_u32 v27,v27,v234,v238
v_mfma_f32_16x16x32_bf16 v[64:67],a[108:111],v[236:239],v[64:67]
ds_read_b128 v[188:191],v17 offset:30720
buffer_load_dword v2,v21,s[20:23],s87 offen sc1
v_mfma_f32_16x16x32_bf16 v[68:71],a[220:223],v[236:239],v[68:71]
s_add_u32 s96,s71,2
v_mfma_f32_16x16x32_bf16 v[72:75],a[112:115],v[128:131],0
v_cmp_eq_u32 vcc,0,v27
s_cbranch_vccnz retry_294
v_mfma_f32_16x16x32_bf16 v[76:79],a[116:119],v[132:135],0
v_min3_u32 v27,v27,v128,v132
v_mfma_f32_16x16x32_bf16 v[72:75],a[120:123],v[136:139],v[72:75]
s_waitcnt vmcnt(3)
s_barrier
ds_read_b128 v[192:195],v17 offset:32768
v_mfma_f32_16x16x32_bf16 v[76:79],a[124:127],v[140:143],v[76:79]
ds_read_b128 v[196:199],v17 offset:34816
s_waitcnt lgkmcnt(10)
v_mfma_f32_16x16x32_bf16 v[72:75],a[128:131],v[144:147],v[72:75]
ds_read_b128 v[200:203],v17 offset:36864
v_min3_u32 v27,v27,v136,v140
s_waitcnt vmcnt(1)
v_mfma_f32_16x16x32_bf16 v[76:79],a[132:135],v[148:151],v[76:79]
ds_read_b128 v[204:207],v17 offset:38912
v_min3_u32 v27,v27,v144,v148
v_and_or_b32 v64,v64,-4,s48
v_mfma_f32_16x16x32_bf16 v[72:75],a[136:139],v[152:155],v[72:75]
ds_read_b128 v[208:211],v17 offset:40960
s_add_u32 s64,s49,s34
v_mfma_f32_16x16x32_bf16 v[76:79],a[140:143],v[156:159],v[76:79]
v_min3_u32 v27,v27,v152,v156
s_waitcnt lgkmcnt(9)
v_mfma_f32_16x16x32_bf16 v[72:75],a[144:147],v[160:163],v[72:75]
ds_read_b128 v[212:215],v17 offset:43008
buffer_store_dwordx4 v[64:67],v25,s[20:23],s64 offen offset:2048 sc1
v_mfma_f32_16x16x32_bf16 v[76:79],a[148:151],v[164:167],v[76:79]
ds_read_b128 v[216:219],v17 offset:45056
v_min3_u32 v27,v27,v160,v164
v_and_or_b32 v68,v68,-4,s48
v_mfma_f32_16x16x32_bf16 v[72:75],a[152:155],v[168:171],v[72:75]
ds_read_b128 v[220:223],v17 offset:47104
s_add_u32 s64,s49,s35
v_mfma_f32_16x16x32_bf16 v[76:79],a[156:159],v[172:175],v[76:79]
ds_read_b128 v[224:227],v17 offset:49152
s_waitcnt lgkmcnt(9)
v_mfma_f32_16x16x32_bf16 v[72:75],a[160:163],v[176:179],v[72:75]
ds_read_b128 v[228:231],v17 offset:51200
v_min3_u32 v27,v27,v168,v172
v_mfma_f32_16x16x32_bf16 v[76:79],a[164:167],v[180:183],v[76:79]
v_min3_u32 v27,v27,v176,v180
buffer_store_dwordx4 v[68:71],v25,s[20:23],s64 offen offset:3072 sc1
v_mfma_f32_16x16x32_bf16 v[72:75],a[168:171],v[184:187],v[72:75]
ds_read_b128 v[232:235],v17 offset:53248
s_mov_b32 s49,0x7fff0000
v_mfma_f32_16x16x32_bf16 v[76:79],a[172:175],v[188:191],v[76:79]
ds_read_b128 v[236:239],v17 offset:55296
s_waitcnt lgkmcnt(8)
v_mfma_f32_16x16x32_bf16 v[72:75],a[176:179],v[192:195],v[72:75]
v_min3_u32 v27,v27,v184,v188
v_mfma_f32_16x16x32_bf16 v[76:79],a[180:183],v[196:199],v[76:79]
v_min3_u32 v27,v27,v192,v196
ds_bpermute_b32 v124,v41,v120
v_mfma_f32_16x16x32_bf16 v[72:75],a[184:187],v[200:203],v[72:75]
v_mfma_f32_16x16x32_bf16 v[76:79],a[188:191],v[204:207],v[76:79]
v_min3_u32 v27,v27,v200,v204
s_waitcnt lgkmcnt(5)
v_mfma_f32_16x16x32_bf16 v[72:75],a[192:195],v[208:211],v[72:75]
ds_bpermute_b32 v125,v41,v121
v_mfma_f32_16x16x32_bf16 v[76:79],a[196:199],v[212:215],v[76:79]
v_min3_u32 v27,v27,v208,v212
v_lshlrev_b32 v108,16,v122
v_mfma_f32_16x16x32_bf16 v[72:75],a[200:203],v[216:219],v[72:75]
v_mfma_f32_16x16x32_bf16 v[76:79],a[204:207],v[220:223],v[76:79]
v_min3_u32 v27,v27,v216,v220
s_waitcnt lgkmcnt(2)
v_mfma_f32_16x16x32_bf16 v[72:75],a[208:211],v[224:227],v[72:75]
v_and_b32 v109,s80,v122
v_mfma_f32_16x16x32_bf16 v[76:79],a[212:215],v[228:231],v[76:79]
v_min3_u32 v27,v27,v224,v228
v_min3_u32 v27,v27,v226,v230
v_mfma_f32_16x16x32_bf16 v[72:75],a[216:219],v[232:235],v[72:75]
v_lshlrev_b32 v110,16,v123
v_mfma_f32_16x16x32_bf16 v[76:79],a[220:223],v[236:239],v[76:79]
v_min3_u32 v27,v27,v232,v236
v_min3_u32 v27,v27,v234,v238
v_mfma_f32_16x16x32_bf16 v[80:83],a[0:3],v[128:131],0
v_cmp_eq_u32 vcc,0,v27
s_cbranch_vccnz retry_294
v_mfma_f32_16x16x32_bf16 v[84:87],a[4:7],v[132:135],0
v_and_b32 v111,s80,v123
s_waitcnt lgkmcnt(0)
v_mfma_f32_16x16x32_bf16 v[80:83],a[8:11],v[136:139],v[80:83]
v_mfma_f32_16x16x32_bf16 v[84:87],a[12:15],v[140:143],v[84:87]
v_lshlrev_b32 v104,16,v124
v_mfma_f32_16x16x32_bf16 v[80:83],a[16:19],v[144:147],v[80:83]
v_add_f32 v72,v72,v76
v_add_f32 v73,v73,v77
v_mfma_f32_16x16x32_bf16 v[84:87],a[20:23],v[148:151],v[84:87]
v_and_b32 v105,s80,v124
v_add_f32 v74,v74,v78
v_mfma_f32_16x16x32_bf16 v[80:83],a[24:27],v[152:155],v[80:83]
v_add_f32 v75,v75,v79
v_and_or_b32 v72,v72,-4,s48
v_mfma_f32_16x16x32_bf16 v[84:87],a[28:31],v[156:159],v[84:87]
v_lshlrev_b32 v106,16,v125
s_add_u32 s64,s77,s33
v_mfma_f32_16x16x32_bf16 v[80:83],a[32:35],v[160:163],v[80:83]
buffer_store_dwordx4 v[72:75],v25,s[20:23],s64 offen offset:1024 sc1
v_mfma_f32_16x16x32_bf16 v[84:87],a[36:39],v[164:167],v[84:87]
v_and_b32 v107,s80,v125
v_mfma_f32_16x16x32_bf16 v[80:83],a[40:43],v[168:171],v[80:83]
v_mfma_f32_16x16x32_bf16 v[84:87],a[44:47],v[172:175],v[84:87]
v_mfma_f32_16x16x32_bf16 v[80:83],a[48:51],v[176:179],v[80:83]
buffer_load_dwordx4 v[96:99],v26,s[20:23],s77 offen offset:2048 sc1
v_mfma_f32_16x16x32_bf16 v[84:87],a[52:55],v[180:183],v[84:87]
buffer_load_dwordx4 v[100:103],v26,s[20:23],s77 offen offset:3072 sc1
v_mfma_f32_16x16x32_bf16 v[80:83],a[56:59],v[184:187],v[80:83]
v_mfma_f32_16x16x32_bf16 v[84:87],a[60:63],v[188:191],v[84:87]
v_mfma_f32_16x16x32_bf16 v[80:83],a[64:67],v[192:195],v[80:83]
s_waitcnt vmcnt(5)
v_mfma_f32_16x16x32_bf16 v[84:87],a[68:71],v[196:199],v[84:87]
v_cmp_gt_u32 vcc,s96,v2
s_mov_b32 s96,vcc_lo
v_mfma_f32_16x16x32_bf16 v[80:83],a[72:75],v[200:203],v[80:83]
v_mov_b32 v44,s96
ds_write_b32 v46,v44
v_mfma_f32_16x16x32_bf16 v[84:87],a[76:79],v[204:207],v[84:87]
v_mfma_f32_16x16x32_bf16 v[80:83],a[80:83],v[208:211],v[80:83]
v_mfma_f32_16x16x32_bf16 v[84:87],a[84:87],v[212:215],v[84:87]
v_mfma_f32_16x16x32_bf16 v[80:83],a[88:91],v[216:219],v[80:83]
buffer_load_dwordx4 v[92:95],v26,s[20:23],s77 offen offset:1024 sc1
v_mfma_f32_16x16x32_bf16 v[84:87],a[92:95],v[220:223],v[84:87]
v_mfma_f32_16x16x32_bf16 v[80:83],a[96:99],v[224:227],v[80:83]
v_mfma_f32_16x16x32_bf16 v[84:87],a[100:103],v[228:231],v[84:87]
v_mfma_f32_16x16x32_bf16 v[80:83],a[104:107],v[232:235],v[80:83]
v_mfma_f32_16x16x32_bf16 v[84:87],a[108:111],v[236:239],v[84:87]
epi_297:
buffer_load_dword v29,v21,s[20:23],s87 offen sc1
s_nop 6
v_pk_add_f32 v[88:89],v[80:81],v[84:85]
v_pk_add_f32 v[90:91],v[82:83],v[86:87]
v_pk_add_f32 v[88:89],v[88:89],v[108:109]
v_pk_add_f32 v[90:91],v[90:91],v[110:111]
s_waitcnt vmcnt(1)
s_branch ic_304
ip_302:
buffer_load_dwordx4 v[92:95],v26,s[20:23],s77 offen offset:1024 sc1
buffer_load_dwordx4 v[96:99],v26,s[20:23],s77 offen offset:2048 sc1
buffer_load_dwordx4 v[100:103],v26,s[20:23],s77 offen offset:3072 sc1
s_waitcnt vmcnt(0)
ic_304:
v_bitop3_b32 v22,v92,v96,v100 bitop3:0x80
v_and_b32 v22,s48,v22
v_cmp_eq_u32 vcc,0,v22
s_cbranch_vccz ik_303
s_sub_u32 s90,s90,1
s_cmp_gt_i32 s90,0
s_cbranch_scc1 ip_302
ik_303:
v_pk_add_f32 v[88:89],v[88:89],v[92:93]
v_pk_add_f32 v[96:97],v[96:97],v[100:101]
v_pk_add_f32 v[90:91],v[90:91],v[94:95]
v_pk_add_f32 v[98:99],v[98:99],v[102:103]
v_pk_add_f32 v[88:89],v[88:89],v[96:97]
v_pk_add_f32 v[90:91],v[90:91],v[98:99]
v_pk_fma_f32 v[88:89],v[88:89],v[52:53],v[104:105]
v_pk_fma_f32 v[90:91],v[90:91],v[54:55],v[106:107]
v_cvt_pk_bf16_f32 v88,v88,v89
v_cvt_pk_bf16_f32 v89,v90,v91
ds_bpermute_b32 v88,v40,v88
ds_bpermute_b32 v89,v40,v89
v_xor_b32 v18,0x10000,v18
s_xor_b32 s49,s77,524288
s_cselect_b32 s64,0,3
s_xor_b32 s48,s48,s64
v_xor_b32 v20,0x2000,v20
s_add_u32 s76,s76,2097152
s_waitcnt lgkmcnt(0)
s_mov_b64 exec,s[84:85]
buffer_store_dwordx2 v[88:89],v19,s[36:39],s78 offen
s_mov_b64 exec,-1
s_mov_b64 s[84:85],-1
s_mov_b32 s77,s49
s_add_u32 s78,s78,65536
v_xor_b32 v17,0x10000,v17
v_xor_b32 v45,16,v45
v_xor_b32 v46,16,v46
s_xor_b32 s72,s72,0x10000
s_add_u32 s70,s70,2097152
s_xor_b32 s70,s70,0x2000
s_add_u32 s71,s71,1
s_cmp_le_u32 s71,s57
s_cbranch_scc1 seg_295
s_endpgm
retry_294:
s_sub_u32 s90,s90,64
s_cmp_lt_i32 s90,0
s_cbranch_scc1 giveup_176
s_mov_b32 s83,1
s_waitcnt vmcnt(0) lgkmcnt(0)
s_barrier
s_branch seg_295
r_w3_194:
s_load_dwordx2 s[4:5],s[0:1],80
s_mul_i32 s66,s59,224
s_lshl_b32 s67,s50,1
s_waitcnt lgkmcnt(0)
s_mov_b32 s32,s4
s_and_b32 s33,s5,0xffff
s_mov_b32 s34,0x700000
s_mov_b32 s35,0x20000
v_lshrrev_b32 v5,2,v3
v_lshl_add_u32 v5,v4,2,v5
v_and_b32 v6,3,v3
v_lshlrev_b32 v6,3,v6
v_lshl_add_u32 v6,v5,8,v6
v_and_b32 v5,7,v5
v_xor_b32 v5,s67,v5
v_lshl_add_u32 v12,v5,5,v6
v_xor_b32 v13,32,v12
v_and_b32 v5,15,v1
v_and_b32 v6,3,v4
v_lshlrev_b32 v6,1,v6
v_xor_b32 v5,v5,v6
v_mul_u32_u24 v6,7168,v4
v_xor_b32 v7,0,v5
v_lshl_add_u32 v8,v7,4,v6
v_xor_b32 v7,8,v5
v_lshl_add_u32 v9,v7,4,v6
s_mul_i32 s74,s50,458752
s_add_u32 s74,s74,s66
s_lshl_b32 s75,s50,14
s_mul_i32 s76,s50,229376
s_add_u32 s76,s76,s66
s_lshl_b32 s77,s50,13
s_add_u32 s64,s74,0
s_add_u32 m0,s75,0
s_nop 0
buffer_load_dwordx4 v8,s[32:35],s64 offen nt lds
s_add_u32 s64,s74,28672
s_add_u32 m0,s75,1024
s_nop 0
buffer_load_dwordx4 v9,s[32:35],s64 offen nt lds
s_add_u32 s64,s74,57344
s_add_u32 m0,s75,2048
s_nop 0
buffer_load_dwordx4 v8,s[32:35],s64 offen nt lds
s_add_u32 s64,s74,86016
s_add_u32 m0,s75,3072
s_nop 0
buffer_load_dwordx4 v9,s[32:35],s64 offen nt lds
s_add_u32 s64,s74,114688
s_add_u32 m0,s75,4096
s_nop 0
buffer_load_dwordx4 v8,s[32:35],s64 offen nt lds
s_add_u32 s64,s74,143360
s_add_u32 m0,s75,5120
s_nop 0
buffer_load_dwordx4 v9,s[32:35],s64 offen nt lds
s_add_u32 s64,s74,172032
s_add_u32 m0,s75,6144
s_nop 0
buffer_load_dwordx4 v8,s[32:35],s64 offen nt lds
s_add_u32 s64,s74,200704
s_add_u32 m0,s75,7168
s_nop 0
buffer_load_dwordx4 v9,s[32:35],s64 offen nt lds
s_add_u32 s64,s74,229376
s_add_u32 m0,s75,8192
s_nop 0
buffer_load_dwordx4 v8,s[32:35],s64 offen nt lds
s_add_u32 s64,s74,258048
s_add_u32 m0,s75,9216
s_nop 0
buffer_load_dwordx4 v9,s[32:35],s64 offen nt lds
s_add_u32 s64,s74,286720
s_add_u32 m0,s75,10240
s_nop 0
buffer_load_dwordx4 v8,s[32:35],s64 offen nt lds
s_add_u32 s64,s74,315392
s_add_u32 m0,s75,11264
s_nop 0
buffer_load_dwordx4 v9,s[32:35],s64 offen nt lds
s_add_u32 s64,s74,344064
s_add_u32 m0,s75,12288
s_nop 0
buffer_load_dwordx4 v8,s[32:35],s64 offen nt lds
s_add_u32 s64,s74,372736
s_add_u32 m0,s75,13312
s_nop 0
buffer_load_dwordx4 v9,s[32:35],s64 offen nt lds
s_add_u32 s64,s74,401408
s_add_u32 m0,s75,14336
s_nop 0
buffer_load_dwordx4 v8,s[32:35],s64 offen nt lds
s_add_u32 s64,s74,430080
s_add_u32 m0,s75,15360
s_nop 0
buffer_load_dwordx4 v9,s[32:35],s64 offen nt lds
s_add_u32 s64,s74,1835008
s_add_u32 m0,s75,65536
s_nop 0
buffer_load_dwordx4 v8,s[32:35],s64 offen nt lds
s_add_u32 s64,s74,1863680
s_add_u32 m0,s75,66560
s_nop 0
buffer_load_dwordx4 v9,s[32:35],s64 offen nt lds
s_add_u32 s64,s74,1892352
s_add_u32 m0,s75,67584
s_nop 0
buffer_load_dwordx4 v8,s[32:35],s64 offen nt lds
s_add_u32 s64,s74,1921024
s_add_u32 m0,s75,68608
s_nop 0
buffer_load_dwordx4 v9,s[32:35],s64 offen nt lds
s_add_u32 s64,s74,1949696
s_add_u32 m0,s75,69632
s_nop 0
buffer_load_dwordx4 v8,s[32:35],s64 offen nt lds
s_add_u32 s64,s74,1978368
s_add_u32 m0,s75,70656
s_nop 0
buffer_load_dwordx4 v9,s[32:35],s64 offen nt lds
s_add_u32 s64,s74,2007040
s_add_u32 m0,s75,71680
s_nop 0
buffer_load_dwordx4 v8,s[32:35],s64 offen nt lds
s_add_u32 s64,s74,2035712
s_add_u32 m0,s75,72704
s_nop 0
buffer_load_dwordx4 v9,s[32:35],s64 offen nt lds
s_add_u32 s64,s74,2064384
s_add_u32 m0,s75,73728
s_nop 0
buffer_load_dwordx4 v8,s[32:35],s64 offen nt lds
s_add_u32 s64,s74,2093056
s_add_u32 m0,s75,74752
s_nop 0
buffer_load_dwordx4 v9,s[32:35],s64 offen nt lds
s_add_u32 s64,s74,2121728
s_add_u32 m0,s75,75776
s_nop 0
buffer_load_dwordx4 v8,s[32:35],s64 offen nt lds
s_add_u32 s64,s74,2150400
s_add_u32 m0,s75,76800
s_nop 0
buffer_load_dwordx4 v9,s[32:35],s64 offen nt lds
s_add_u32 s64,s74,2179072
s_add_u32 m0,s75,77824
s_nop 0
buffer_load_dwordx4 v8,s[32:35],s64 offen nt lds
s_add_u32 s64,s74,2207744
s_add_u32 m0,s75,78848
s_nop 0
buffer_load_dwordx4 v9,s[32:35],s64 offen nt lds
s_add_u32 s64,s74,2236416
s_add_u32 m0,s75,79872
s_nop 0
buffer_load_dwordx4 v8,s[32:35],s64 offen nt lds
s_add_u32 s64,s74,2265088
s_add_u32 m0,s75,80896
s_nop 0
buffer_load_dwordx4 v9,s[32:35],s64 offen nt lds
s_waitcnt vmcnt(16)
s_barrier
ds_read_b64_tr_b16 a[0:1],v12 offset:0
ds_read_b64_tr_b16 a[128:129],v13 offset:0
ds_read_b64_tr_b16 a[2:3],v12 offset:4096
ds_read_b64_tr_b16 a[130:131],v13 offset:4096
ds_read_b64_tr_b16 a[4:5],v12 offset:8192
ds_read_b64_tr_b16 a[132:133],v13 offset:8192
ds_read_b64_tr_b16 a[6:7],v12 offset:12288
ds_read_b64_tr_b16 a[134:135],v13 offset:12288
s_waitcnt lgkmcnt(4)
ds_read_b64_tr_b16 a[8:9],v12 offset:16384
ds_read_b64_tr_b16 a[136:137],v13 offset:16384
ds_read_b64_tr_b16 a[10:11],v12 offset:20480
ds_read_b64_tr_b16 a[138:139],v13 offset:20480
ds_read_b64_tr_b16 a[12:13],v12 offset:24576
ds_read_b64_tr_b16 a[140:141],v13 offset:24576
ds_read_b64_tr_b16 a[14:15],v12 offset:28672
ds_read_b64_tr_b16 a[142:143],v13 offset:28672
s_waitcnt lgkmcnt(4)
ds_read_b64_tr_b16 a[16:17],v12 offset:32768
ds_read_b64_tr_b16 a[144:145],v13 offset:32768
ds_read_b64_tr_b16 a[18:19],v12 offset:36864
ds_read_b64_tr_b16 a[146:147],v13 offset:36864
ds_read_b64_tr_b16 a[20:21],v12 offset:40960
ds_read_b64_tr_b16 a[148:149],v13 offset:40960
ds_read_b64_tr_b16 a[22:23],v12 offset:45056
ds_read_b64_tr_b16 a[150:151],v13 offset:45056
s_waitcnt lgkmcnt(4)
ds_read_b64_tr_b16 a[24:25],v12 offset:49152
ds_read_b64_tr_b16 a[152:153],v13 offset:49152
ds_read_b64_tr_b16 a[26:27],v12 offset:53248
ds_read_b64_tr_b16 a[154:155],v13 offset:53248
ds_read_b64_tr_b16 a[28:29],v12 offset:57344
ds_read_b64_tr_b16 a[156:157],v13 offset:57344
ds_read_b64_tr_b16 a[30:31],v12 offset:61440
ds_read_b64_tr_b16 a[158:159],v13 offset:61440
s_waitcnt lgkmcnt(4)
v_xor_b32 v12,0x10000,v12
v_xor_b32 v13,0x10000,v13
s_waitcnt lgkmcnt(0)
s_barrier
s_add_u32 s64,s74,3670016
s_add_u32 m0,s75,0
s_nop 0
buffer_load_dwordx4 v8,s[32:35],s64 offen nt lds
s_add_u32 s64,s74,3698688
s_add_u32 m0,s75,1024
s_nop 0
buffer_load_dwordx4 v9,s[32:35],s64 offen nt lds
s_add_u32 s64,s74,3727360
s_add_u32 m0,s75,2048
s_nop 0
buffer_load_dwordx4 v8,s[32:35],s64 offen nt lds
s_add_u32 s64,s74,3756032
s_add_u32 m0,s75,3072
s_nop 0
buffer_load_dwordx4 v9,s[32:35],s64 offen nt lds
s_add_u32 s64,s74,3784704
s_add_u32 m0,s75,4096
s_nop 0
buffer_load_dwordx4 v8,s[32:35],s64 offen nt lds
s_add_u32 s64,s74,3813376
s_add_u32 m0,s75,5120
s_nop 0
buffer_load_dwordx4 v9,s[32:35],s64 offen nt lds
s_add_u32 s64,s74,3842048
s_add_u32 m0,s75,6144
s_nop 0
buffer_load_dwordx4 v8,s[32:35],s64 offen nt lds
s_add_u32 s64,s74,3870720
s_add_u32 m0,s75,7168
s_nop 0
buffer_load_dwordx4 v9,s[32:35],s64 offen nt lds
s_add_u32 s64,s74,3899392
s_add_u32 m0,s75,8192
s_nop 0
buffer_load_dwordx4 v8,s[32:35],s64 offen nt lds
s_add_u32 s64,s74,3928064
s_add_u32 m0,s75,9216
s_nop 0
buffer_load_dwordx4 v9,s[32:35],s64 offen nt lds
s_add_u32 s64,s74,3956736
s_add_u32 m0,s75,10240
s_nop 0
buffer_load_dwordx4 v8,s[32:35],s64 offen nt lds
s_add_u32 s64,s74,3985408
s_add_u32 m0,s75,11264
s_nop 0
buffer_load_dwordx4 v9,s[32:35],s64 offen nt lds
s_add_u32 s64,s74,4014080
s_add_u32 m0,s75,12288
s_nop 0
buffer_load_dwordx4 v8,s[32:35],s64 offen nt lds
s_add_u32 s64,s74,4042752
s_add_u32 m0,s75,13312
s_nop 0
buffer_load_dwordx4 v9,s[32:35],s64 offen nt lds
s_add_u32 s64,s74,4071424
s_add_u32 m0,s75,14336
s_nop 0
buffer_load_dwordx4 v8,s[32:35],s64 offen nt lds
s_add_u32 s64,s74,4100096
s_add_u32 m0,s75,15360
s_nop 0
buffer_load_dwordx4 v9,s[32:35],s64 offen nt lds
s_waitcnt vmcnt(16)
s_barrier
ds_read_b64_tr_b16 a[32:33],v12 offset:0
ds_read_b64_tr_b16 a[160:161],v13 offset:0
ds_read_b64_tr_b16 a[34:35],v12 offset:4096
ds_read_b64_tr_b16 a[162:163],v13 offset:4096
ds_read_b64_tr_b16 a[36:37],v12 offset:8192
ds_read_b64_tr_b16 a[164:165],v13 offset:8192
ds_read_b64_tr_b16 a[38:39],v12 offset:12288
ds_read_b64_tr_b16 a[166:167],v13 offset:12288
s_waitcnt lgkmcnt(4)
ds_read_b64_tr_b16 a[40:41],v12 offset:16384
ds_read_b64_tr_b16 a[168:169],v13 offset:16384
ds_read_b64_tr_b16 a[42:43],v12 offset:20480
ds_read_b64_tr_b16 a[170:171],v13 offset:20480
ds_read_b64_tr_b16 a[44:45],v12 offset:24576
ds_read_b64_tr_b16 a[172:173],v13 offset:24576
ds_read_b64_tr_b16 a[46:47],v12 offset:28672
ds_read_b64_tr_b16 a[174:175],v13 offset:28672
s_waitcnt lgkmcnt(4)
ds_read_b64_tr_b16 a[48:49],v12 offset:32768
ds_read_b64_tr_b16 a[176:177],v13 offset:32768
ds_read_b64_tr_b16 a[50:51],v12 offset:36864
ds_read_b64_tr_b16 a[178:179],v13 offset:36864
ds_read_b64_tr_b16 a[52:53],v12 offset:40960
ds_read_b64_tr_b16 a[180:181],v13 offset:40960
ds_read_b64_tr_b16 a[54:55],v12 offset:45056
ds_read_b64_tr_b16 a[182:183],v13 offset:45056
s_waitcnt lgkmcnt(4)
ds_read_b64_tr_b16 a[56:57],v12 offset:49152
ds_read_b64_tr_b16 a[184:185],v13 offset:49152
ds_read_b64_tr_b16 a[58:59],v12 offset:53248
ds_read_b64_tr_b16 a[186:187],v13 offset:53248
ds_read_b64_tr_b16 a[60:61],v12 offset:57344
ds_read_b64_tr_b16 a[188:189],v13 offset:57344
ds_read_b64_tr_b16 a[62:63],v12 offset:61440
ds_read_b64_tr_b16 a[190:191],v13 offset:61440
s_waitcnt lgkmcnt(4)
v_xor_b32 v12,0x10000,v12
v_xor_b32 v13,0x10000,v13
s_waitcnt lgkmcnt(0)
s_barrier
s_add_u32 s64,s74,5505024
s_add_u32 m0,s75,65536
s_nop 0
buffer_load_dwordx4 v8,s[32:35],s64 offen nt lds
s_add_u32 s64,s74,5533696
s_add_u32 m0,s75,66560
s_nop 0
buffer_load_dwordx4 v9,s[32:35],s64 offen nt lds
s_add_u32 s64,s74,5562368
s_add_u32 m0,s75,67584
s_nop 0
buffer_load_dwordx4 v8,s[32:35],s64 offen nt lds
s_add_u32 s64,s74,5591040
s_add_u32 m0,s75,68608
s_nop 0
buffer_load_dwordx4 v9,s[32:35],s64 offen nt lds
s_add_u32 s64,s74,5619712
s_add_u32 m0,s75,69632
s_nop 0
buffer_load_dwordx4 v8,s[32:35],s64 offen nt lds
s_add_u32 s64,s74,5648384
s_add_u32 m0,s75,70656
s_nop 0
buffer_load_dwordx4 v9,s[32:35],s64 offen nt lds
s_add_u32 s64,s74,5677056
s_add_u32 m0,s75,71680
s_nop 0
buffer_load_dwordx4 v8,s[32:35],s64 offen nt lds
s_add_u32 s64,s74,5705728
s_add_u32 m0,s75,72704
s_nop 0
buffer_load_dwordx4 v9,s[32:35],s64 offen nt lds
s_add_u32 s64,s74,5734400
s_add_u32 m0,s75,73728
s_nop 0
buffer_load_dwordx4 v8,s[32:35],s64 offen nt lds
s_add_u32 s64,s74,5763072
s_add_u32 m0,s75,74752
s_nop 0
buffer_load_dwordx4 v9,s[32:35],s64 offen nt lds
s_add_u32 s64,s74,5791744
s_add_u32 m0,s75,75776
s_nop 0
buffer_load_dwordx4 v8,s[32:35],s64 offen nt lds
s_add_u32 s64,s74,5820416
s_add_u32 m0,s75,76800
s_nop 0
buffer_load_dwordx4 v9,s[32:35],s64 offen nt lds
s_add_u32 s64,s74,5849088
s_add_u32 m0,s75,77824
s_nop 0
buffer_load_dwordx4 v8,s[32:35],s64 offen nt lds
s_add_u32 s64,s74,5877760
s_add_u32 m0,s75,78848
s_nop 0
buffer_load_dwordx4 v9,s[32:35],s64 offen nt lds
s_add_u32 s64,s74,5906432
s_add_u32 m0,s75,79872
s_nop 0
buffer_load_dwordx4 v8,s[32:35],s64 offen nt lds
s_add_u32 s64,s74,5935104
s_add_u32 m0,s75,80896
s_nop 0
buffer_load_dwordx4 v9,s[32:35],s64 offen nt lds
s_waitcnt vmcnt(16)
s_barrier
ds_read_b64_tr_b16 a[64:65],v12 offset:0
ds_read_b64_tr_b16 a[192:193],v13 offset:0
ds_read_b64_tr_b16 a[66:67],v12 offset:4096
ds_read_b64_tr_b16 a[194:195],v13 offset:4096
ds_read_b64_tr_b16 a[68:69],v12 offset:8192
ds_read_b64_tr_b16 a[196:197],v13 offset:8192
ds_read_b64_tr_b16 a[70:71],v12 offset:12288
ds_read_b64_tr_b16 a[198:199],v13 offset:12288
s_waitcnt lgkmcnt(4)
ds_read_b64_tr_b16 a[72:73],v12 offset:16384
ds_read_b64_tr_b16 a[200:201],v13 offset:16384
ds_read_b64_tr_b16 a[74:75],v12 offset:20480
ds_read_b64_tr_b16 a[202:203],v13 offset:20480
ds_read_b64_tr_b16 a[76:77],v12 offset:24576
ds_read_b64_tr_b16 a[204:205],v13 offset:24576
ds_read_b64_tr_b16 a[78:79],v12 offset:28672
ds_read_b64_tr_b16 a[206:207],v13 offset:28672
s_waitcnt lgkmcnt(4)
ds_read_b64_tr_b16 a[80:81],v12 offset:32768
ds_read_b64_tr_b16 a[208:209],v13 offset:32768
ds_read_b64_tr_b16 a[82:83],v12 offset:36864
ds_read_b64_tr_b16 a[210:211],v13 offset:36864
ds_read_b64_tr_b16 a[84:85],v12 offset:40960
ds_read_b64_tr_b16 a[212:213],v13 offset:40960
ds_read_b64_tr_b16 a[86:87],v12 offset:45056
ds_read_b64_tr_b16 a[214:215],v13 offset:45056
s_waitcnt lgkmcnt(4)
ds_read_b64_tr_b16 a[88:89],v12 offset:49152
ds_read_b64_tr_b16 a[216:217],v13 offset:49152
ds_read_b64_tr_b16 a[90:91],v12 offset:53248
ds_read_b64_tr_b16 a[218:219],v13 offset:53248
ds_read_b64_tr_b16 a[92:93],v12 offset:57344
ds_read_b64_tr_b16 a[220:221],v13 offset:57344
ds_read_b64_tr_b16 a[94:95],v12 offset:61440
ds_read_b64_tr_b16 a[222:223],v13 offset:61440
s_waitcnt lgkmcnt(4)
v_xor_b32 v12,0x10000,v12
v_xor_b32 v13,0x10000,v13
s_waitcnt lgkmcnt(0)
s_barrier
s_waitcnt vmcnt(0)
s_barrier
ds_read_b64_tr_b16 a[96:97],v12 offset:0
ds_read_b64_tr_b16 a[224:225],v13 offset:0
ds_read_b64_tr_b16 a[98:99],v12 offset:4096
ds_read_b64_tr_b16 a[226:227],v13 offset:4096
ds_read_b64_tr_b16 a[100:101],v12 offset:8192
ds_read_b64_tr_b16 a[228:229],v13 offset:8192
ds_read_b64_tr_b16 a[102:103],v12 offset:12288
ds_read_b64_tr_b16 a[230:231],v13 offset:12288
s_waitcnt lgkmcnt(4)
ds_read_b64_tr_b16 a[104:105],v12 offset:16384
ds_read_b64_tr_b16 a[232:233],v13 offset:16384
ds_read_b64_tr_b16 a[106:107],v12 offset:20480
ds_read_b64_tr_b16 a[234:235],v13 offset:20480
ds_read_b64_tr_b16 a[108:109],v12 offset:24576
ds_read_b64_tr_b16 a[236:237],v13 offset:24576
ds_read_b64_tr_b16 a[110:111],v12 offset:28672
ds_read_b64_tr_b16 a[238:239],v13 offset:28672
s_waitcnt lgkmcnt(4)
ds_read_b64_tr_b16 a[112:113],v12 offset:32768
ds_read_b64_tr_b16 a[240:241],v13 offset:32768
ds_read_b64_tr_b16 a[114:115],v12 offset:36864
ds_read_b64_tr_b16 a[242:243],v13 offset:36864
ds_read_b64_tr_b16 a[116:117],v12 offset:40960
ds_read_b64_tr_b16 a[244:245],v13 offset:40960
ds_read_b64_tr_b16 a[118:119],v12 offset:45056
ds_read_b64_tr_b16 a[246:247],v13 offset:45056
s_waitcnt lgkmcnt(4)
ds_read_b64_tr_b16 a[120:121],v12 offset:49152
ds_read_b64_tr_b16 a[248:249],v13 offset:49152
ds_read_b64_tr_b16 a[122:123],v12 offset:53248
ds_read_b64_tr_b16 a[250:251],v13 offset:53248
ds_read_b64_tr_b16 a[124:125],v12 offset:57344
ds_read_b64_tr_b16 a[252:253],v13 offset:57344
ds_read_b64_tr_b16 a[126:127],v12 offset:61440
ds_read_b64_tr_b16 a[254:255],v13 offset:61440
s_waitcnt lgkmcnt(4)
v_xor_b32 v12,0x10000,v12
v_xor_b32 v13,0x10000,v13
s_waitcnt lgkmcnt(0)
s_barrier
v_mov_b32 v88,0x3f803f80
v_mov_b32 v89,0x3f803f80
v_mov_b32 v90,0x3f803f80
v_mov_b32 v91,0x3f803f80
s_nop 1
v_mfma_f32_16x16x32_bf16 v[52:55],a[0:3],v[88:91],0
v_mfma_f32_16x16x32_bf16 v[56:59],a[128:131],v[88:91],0
v_mfma_f32_16x16x32_bf16 v[52:55],a[4:7],v[88:91],v[52:55]
v_mfma_f32_16x16x32_bf16 v[56:59],a[132:135],v[88:91],v[56:59]
v_mfma_f32_16x16x32_bf16 v[52:55],a[8:11],v[88:91],v[52:55]
v_mfma_f32_16x16x32_bf16 v[56:59],a[136:139],v[88:91],v[56:59]
v_mfma_f32_16x16x32_bf16 v[52:55],a[12:15],v[88:91],v[52:55]
v_mfma_f32_16x16x32_bf16 v[56:59],a[140:143],v[88:91],v[56:59]
v_mfma_f32_16x16x32_bf16 v[52:55],a[16:19],v[88:91],v[52:55]
v_mfma_f32_16x16x32_bf16 v[56:59],a[144:147],v[88:91],v[56:59]
v_mfma_f32_16x16x32_bf16 v[52:55],a[20:23],v[88:91],v[52:55]
v_mfma_f32_16x16x32_bf16 v[56:59],a[148:151],v[88:91],v[56:59]
v_mfma_f32_16x16x32_bf16 v[52:55],a[24:27],v[88:91],v[52:55]
v_mfma_f32_16x16x32_bf16 v[56:59],a[152:155],v[88:91],v[56:59]
v_mfma_f32_16x16x32_bf16 v[52:55],a[28:31],v[88:91],v[52:55]
v_mfma_f32_16x16x32_bf16 v[56:59],a[156:159],v[88:91],v[56:59]
v_mfma_f32_16x16x32_bf16 v[52:55],a[32:35],v[88:91],v[52:55]
v_mfma_f32_16x16x32_bf16 v[56:59],a[160:163],v[88:91],v[56:59]
v_mfma_f32_16x16x32_bf16 v[52:55],a[36:39],v[88:91],v[52:55]
v_mfma_f32_16x16x32_bf16 v[56:59],a[164:167],v[88:91],v[56:59]
v_mfma_f32_16x16x32_bf16 v[52:55],a[40:43],v[88:91],v[52:55]
v_mfma_f32_16x16x32_bf16 v[56:59],a[168:171],v[88:91],v[56:59]
v_mfma_f32_16x16x32_bf16 v[52:55],a[44:47],v[88:91],v[52:55]
v_mfma_f32_16x16x32_bf16 v[56:59],a[172:175],v[88:91],v[56:59]
v_mfma_f32_16x16x32_bf16 v[52:55],a[48:51],v[88:91],v[52:55]
v_mfma_f32_16x16x32_bf16 v[56:59],a[176:179],v[88:91],v[56:59]
v_mfma_f32_16x16x32_bf16 v[52:55],a[52:55],v[88:91],v[52:55]
v_mfma_f32_16x16x32_bf16 v[56:59],a[180:183],v[88:91],v[56:59]
v_mfma_f32_16x16x32_bf16 v[52:55],a[56:59],v[88:91],v[52:55]
v_mfma_f32_16x16x32_bf16 v[56:59],a[184:187],v[88:91],v[56:59]
v_mfma_f32_16x16x32_bf16 v[52:55],a[60:63],v[88:91],v[52:55]
v_mfma_f32_16x16x32_bf16 v[56:59],a[188:191],v[88:91],v[56:59]
v_mfma_f32_16x16x32_bf16 v[52:55],a[64:67],v[88:91],v[52:55]
v_mfma_f32_16x16x32_bf16 v[56:59],a[192:195],v[88:91],v[56:59]
v_mfma_f32_16x16x32_bf16 v[52:55],a[68:71],v[88:91],v[52:55]
v_mfma_f32_16x16x32_bf16 v[56:59],a[196:199],v[88:91],v[56:59]
v_mfma_f32_16x16x32_bf16 v[52:55],a[72:75],v[88:91],v[52:55]
v_mfma_f32_16x16x32_bf16 v[56:59],a[200:203],v[88:91],v[56:59]
v_mfma_f32_16x16x32_bf16 v[52:55],a[76:79],v[88:91],v[52:55]
v_mfma_f32_16x16x32_bf16 v[56:59],a[204:207],v[88:91],v[56:59]
v_mfma_f32_16x16x32_bf16 v[52:55],a[80:83],v[88:91],v[52:55]
v_mfma_f32_16x16x32_bf16 v[56:59],a[208:211],v[88:91],v[56:59]
v_mfma_f32_16x16x32_bf16 v[52:55],a[84:87],v[88:91],v[52:55]
v_mfma_f32_16x16x32_bf16 v[56:59],a[212:215],v[88:91],v[56:59]
v_mfma_f32_16x16x32_bf16 v[52:55],a[88:91],v[88:91],v[52:55]
v_mfma_f32_16x16x32_bf16 v[56:59],a[216:219],v[88:91],v[56:59]
v_mfma_f32_16x16x32_bf16 v[52:55],a[92:95],v[88:91],v[52:55]
v_mfma_f32_16x16x32_bf16 v[56:59],a[220:223],v[88:91],v[56:59]
v_mfma_f32_16x16x32_bf16 v[52:55],a[96:99],v[88:91],v[52:55]
v_mfma_f32_16x16x32_bf16 v[56:59],a[224:227],v[88:91],v[56:59]
v_mfma_f32_16x16x32_bf16 v[52:55],a[100:103],v[88:91],v[52:55]
v_mfma_f32_16x16x32_bf16 v[56:59],a[228:231],v[88:91],v[56:59]
v_mfma_f32_16x16x32_bf16 v[52:55],a[104:107],v[88:91],v[52:55]
v_mfma_f32_16x16x32_bf16 v[56:59],a[232:235],v[88:91],v[56:59]
v_mfma_f32_16x16x32_bf16 v[52:55],a[108:111],v[88:91],v[52:55]
v_mfma_f32_16x16x32_bf16 v[56:59],a[236:239],v[88:91],v[56:59]
v_mfma_f32_16x16x32_bf16 v[52:55],a[112:115],v[88:91],v[52:55]
v_mfma_f32_16x16x32_bf16 v[56:59],a[240:243],v[88:91],v[56:59]
v_mfma_f32_16x16x32_bf16 v[52:55],a[116:119],v[88:91],v[52:55]
v_mfma_f32_16x16x32_bf16 v[56:59],a[244:247],v[88:91],v[56:59]
v_mfma_f32_16x16x32_bf16 v[52:55],a[120:123],v[88:91],v[52:55]
v_mfma_f32_16x16x32_bf16 v[56:59],a[248:251],v[88:91],v[56:59]
v_mfma_f32_16x16x32_bf16 v[52:55],a[124:127],v[88:91],v[52:55]
v_mfma_f32_16x16x32_bf16 v[56:59],a[252:255],v[88:91],v[56:59]
v_and_b32 v21,1,v1
v_mul_u32_u24 v21,960,v21
s_mov_b32 s65,21052032
s_mov_b32 s66,1792
pl_305:
buffer_load_dword v22,v21,s[20:23],s65 offen sc1
s_waitcnt vmcnt(0)
v_cmp_gt_u32 vcc,s66,v22
s_cbranch_vccz pok_306
s_sleep 1
s_sub_u32 s90,s90,1
s_cmp_gt_i32 s90,0
s_cbranch_scc1 pl_305
pok_306:
s_mov_b32 s81,0xbdd2d3e8
v_mov_b32 v28,0xc0135761
s_lshr_b32 s41,s59,3
s_and_b32 s42,s59,7
s_mul_i32 s64,s42,3
s_add_u32 s64,s64,s50
s_lshr_b32 s65,s42,1
s_add_u32 s65,s65,24
s_cmp_eq_u32 s50,3
s_cselect_b32 s64,s65,s64
s_and_b32 s65,s42,1
s_lshl_b32 s65,s65,3
s_cmp_eq_u32 s50,3
s_cselect_b32 s65,s65,0
s_and_b32 s66,s64,3
s_lshl_b32 s66,s66,11
s_add_u32 s65,s65,s66
s_lshr_b32 s64,s64,2
s_mul_i32 s66,s41,7
s_add_u32 s64,s64,s66
s_add_u32 s64,s64,81
s_lshl_b32 s64,s64,14
s_add_u32 s64,s64,s65
v_add_u32 v18,s64,v16
v_mov_b32 v17,v16
v_lshlrev_b32 v19,4,v3
v_add_u32 v19,131072,v19
v_and_b32 v21,7,v1
v_lshlrev_b32 v21,7,v21
v_bfe_u32 v6,v1,3,2
v_lshl_add_u32 v21,v6,2,v21
s_add_u32 s74,s63,6144
s_add_u32 s74,s74,s60
s_lshl_b32 s73,s59,7
s_lshl_b32 s64,s50,2
s_add_u32 s73,s73,s64
s_add_u32 s73,s73,s63
s_add_u32 s73,s73,20480
s_lshl_b32 s64,s60,4
s_add_u32 s73,s73,s64
s_mov_b32 s82,0x3a800000
s_mov_b32 s64,0
s_lshr_b32 s65,s50,1
s_and_b32 s66,s50,1
s_lshl_b32 s66,s66,12
s_add_u32 s66,s66,s64
s_lshl_b32 s72,s65,13
s_add_u32 s72,s72,s66
s_add_u32 s72,s72,0x10000
s_lshl_b32 s65,s65,14
s_add_u32 s75,s65,s66
s_add_u32 s75,s75,1179648
s_cmp_eq_u32 s50,3
s_cbranch_scc1 w3b_307
s_add_u32 s64,s79,0
s_lshl_b32 s70,s64,21
s_lshl_b32 s64,s64,13
s_and_b32 s64,s64,0x2000
s_xor_b32 s64,s64,s62
s_add_u32 s70,s70,s64
s_add_u32 s70,s70,29360128
s_mov_b32 s83,1
s_mov_b32 s87,s74
s_cmp_eq_u32 s50,0
s_cselect_b32 s74,s74,0x7fff0000
v_mov_b32 v45,132096
s_lshl_b32 s64,s50,2
s_add_u32 s64,s64,132112
v_mov_b32 v46,s64
v_mov_b32 v2,0
v_mov_b32 v44,1
ds_write_b32 v45,v44
s_mov_b32 s97,0x7fff0000
s_waitcnt lgkmcnt(0)
seg_309:
s_cmp_eq_u32 s83,0
s_cbranch_scc1 ahead_310
s_add_u32 s94,s70,s75
s_xor_b32 s95,s94,1024
s_xor_b32 s91,s72,0x10000
s_waitcnt lgkmcnt(0)
v_cmp_gt_u32 vcc,s71,v2
s_cbranch_vccz nb_313
s_waitcnt vmcnt(2)
v_cmp_gt_u32 vcc,s71,v29
s_cbranch_vccz nb_313
s_waitcnt vmcnt(0)
v_add_u32 v22,s71,-1
buffer_store_dword v22,v23,s[20:23],s97 offen sc1
s_mov_b32 s97,0x7fff0000
s_cmp_lg_u32 s50,0
s_cbranch_scc1 nb_313
buffer_load_dword v32,v21,s[20:23],s74 offen sc1
s_sleep 2
pl_314:
buffer_load_dword v33,v21,s[20:23],s74 offen sc1
s_waitcnt vmcnt(1)
v_cmp_gt_u32 vcc,s71,v32
s_cbranch_vccz pok_315
buffer_load_dword v32,v21,s[20:23],s74 offen sc1
s_waitcnt vmcnt(1)
v_cmp_gt_u32 vcc,s71,v33
s_cbranch_vccz pok_315
s_sub_u32 s90,s90,1
s_cmp_gt_i32 s90,0
s_cbranch_scc1 pl_314
pok_315:
nb_313:
s_barrier
s_xor_b32 m0,s91,0
s_add_u32 s65,s94,0
buffer_load_dwordx4 v16,s[20:23],s65 offen offset:0 sc1 lds
buffer_load_dwordx4 v16,s[20:23],s65 offen offset:2048 sc1 lds
ds_read_b32 v44,v45
s_xor_b32 m0,s91,16384
s_add_u32 s65,s94,32768
buffer_load_dwordx4 v16,s[20:23],s65 offen offset:0 sc1 lds
buffer_load_dwordx4 v16,s[20:23],s65 offen offset:2048 sc1 lds
s_xor_b32 m0,s91,32768
s_add_u32 s65,s94,65536
buffer_load_dwordx4 v16,s[20:23],s65 offen offset:0 sc1 lds
buffer_load_dwordx4 v16,s[20:23],s65 offen offset:2048 sc1 lds
s_xor_b32 m0,s91,49152
s_add_u32 s65,s94,98304
buffer_load_dwordx4 v16,s[20:23],s65 offen offset:0 sc1 lds
buffer_load_dwordx4 v16,s[20:23],s65 offen offset:2048 sc1 lds
s_xor_b32 m0,s91,1024
s_add_u32 s65,s95,0
buffer_load_dwordx4 v16,s[20:23],s65 offen offset:0 sc1 lds
buffer_load_dwordx4 v16,s[20:23],s65 offen offset:2048 sc1 lds
s_waitcnt vmcnt(10)
v_add_u32 v22,s71,-1
buffer_store_dword v22,v23,s[20:23],s97 offen sc1
s_mov_b32 s97,0x7fff0000
s_waitcnt lgkmcnt(0)
v_readfirstlane_b32 s83,v44
s_cmp_eq_u32 s83,0
s_cbranch_scc1 both_312
s_waitcnt vmcnt(9)
s_barrier
ds_read_b128 v[224:227],v17 offset:0
ds_read_b128 v[228:231],v17 offset:2048
ds_read_b128 v[232:235],v17 offset:4096
ds_read_b128 v[236:239],v17 offset:6144
ds_read_b128 v[240:243],v17 offset:8192
ds_read_b128 v[244:247],v17 offset:10240
ds_read_b128 v[248:251],v17 offset:12288
s_waitcnt lgkmcnt(5)
v_mfma_f32_16x16x32_bf16 v[64:67],a[0:3],v[224:227],0
v_min_u32 v27,v224,v228
s_xor_b32 m0,s91,17408
v_mfma_f32_16x16x32_bf16 v[72:75],a[128:131],v[224:227],0
ds_read_b128 v[252:255],v17 offset:14336
v_mfma_f32_16x16x32_bf16 v[64:67],a[4:7],v[228:231],v[64:67]
s_add_u32 s65,s95,32768
v_mfma_f32_16x16x32_bf16 v[72:75],a[132:135],v[228:231],v[72:75]
s_waitcnt vmcnt(7)
s_barrier
ds_read_b128 v[224:227],v17 offset:16384
s_waitcnt lgkmcnt(5)
v_mfma_f32_16x16x32_bf16 v[64:67],a[8:11],v[232:235],v[64:67]
v_min3_u32 v27,v27,v232,v236
buffer_load_dwordx4 v16,s[20:23],s65 offen offset:0 sc1 lds
v_mfma_f32_16x16x32_bf16 v[72:75],a[136:139],v[232:235],v[72:75]
ds_read_b128 v[228:231],v17 offset:18432
v_mfma_f32_16x16x32_bf16 v[64:67],a[12:15],v[236:239],v[64:67]
buffer_load_dwordx4 v16,s[20:23],s65 offen offset:2048 sc1 lds
v_mfma_f32_16x16x32_bf16 v[72:75],a[140:143],v[236:239],v[72:75]
ds_read_b128 v[232:235],v17 offset:20480
s_waitcnt lgkmcnt(5)
v_mfma_f32_16x16x32_bf16 v[64:67],a[16:19],v[240:243],v[64:67]
v_min3_u32 v27,v27,v240,v244
s_xor_b32 m0,s91,33792
v_mfma_f32_16x16x32_bf16 v[72:75],a[144:147],v[240:243],v[72:75]
ds_read_b128 v[236:239],v17 offset:22528
v_mfma_f32_16x16x32_bf16 v[64:67],a[20:23],v[244:247],v[64:67]
s_add_u32 s65,s95,65536
v_mfma_f32_16x16x32_bf16 v[72:75],a[148:151],v[244:247],v[72:75]
ds_read_b128 v[240:243],v17 offset:24576
s_waitcnt lgkmcnt(5)
v_mfma_f32_16x16x32_bf16 v[64:67],a[24:27],v[248:251],v[64:67]
v_min3_u32 v27,v27,v248,v252
buffer_load_dwordx4 v16,s[20:23],s65 offen offset:0 sc1 lds
v_mfma_f32_16x16x32_bf16 v[72:75],a[152:155],v[248:251],v[72:75]
ds_read_b128 v[244:247],v17 offset:26624
v_mfma_f32_16x16x32_bf16 v[64:67],a[28:31],v[252:255],v[64:67]
buffer_load_dwordx4 v16,s[20:23],s65 offen offset:2048 sc1 lds
v_mfma_f32_16x16x32_bf16 v[72:75],a[156:159],v[252:255],v[72:75]
ds_read_b128 v[248:251],v17 offset:28672
s_waitcnt lgkmcnt(5)
v_mfma_f32_16x16x32_bf16 v[64:67],a[32:35],v[224:227],v[64:67]
v_min3_u32 v27,v27,v224,v228
s_xor_b32 m0,s91,50176
v_mfma_f32_16x16x32_bf16 v[72:75],a[160:163],v[224:227],v[72:75]
ds_read_b128 v[252:255],v17 offset:30720
v_mfma_f32_16x16x32_bf16 v[64:67],a[36:39],v[228:231],v[64:67]
s_add_u32 s65,s95,98304
v_mfma_f32_16x16x32_bf16 v[72:75],a[164:167],v[228:231],v[72:75]
s_waitcnt vmcnt(7)
s_barrier
ds_read_b128 v[224:227],v17 offset:32768
s_waitcnt lgkmcnt(5)
v_mfma_f32_16x16x32_bf16 v[64:67],a[40:43],v[232:235],v[64:67]
v_min3_u32 v27,v27,v232,v236
buffer_load_dwordx4 v16,s[20:23],s65 offen offset:0 sc1 lds
v_mfma_f32_16x16x32_bf16 v[72:75],a[168:171],v[232:235],v[72:75]
ds_read_b128 v[228:231],v17 offset:34816
v_mfma_f32_16x16x32_bf16 v[64:67],a[44:47],v[236:239],v[64:67]
buffer_load_dwordx4 v16,s[20:23],s65 offen offset:2048 sc1 lds
v_mfma_f32_16x16x32_bf16 v[72:75],a[172:175],v[236:239],v[72:75]
ds_read_b128 v[232:235],v17 offset:36864
s_waitcnt lgkmcnt(5)
v_mfma_f32_16x16x32_bf16 v[64:67],a[48:51],v[240:243],v[64:67]
v_min3_u32 v27,v27,v240,v244
v_mfma_f32_16x16x32_bf16 v[72:75],a[176:179],v[240:243],v[72:75]
ds_read_b128 v[236:239],v17 offset:38912
v_mfma_f32_16x16x32_bf16 v[64:67],a[52:55],v[244:247],v[64:67]
v_mfma_f32_16x16x32_bf16 v[72:75],a[180:183],v[244:247],v[72:75]
ds_read_b128 v[240:243],v17 offset:40960
s_waitcnt lgkmcnt(5)
v_mfma_f32_16x16x32_bf16 v[64:67],a[56:59],v[248:251],v[64:67]
v_min3_u32 v27,v27,v248,v252
v_mfma_f32_16x16x32_bf16 v[72:75],a[184:187],v[248:251],v[72:75]
ds_read_b128 v[244:247],v17 offset:43008
v_mfma_f32_16x16x32_bf16 v[64:67],a[60:63],v[252:255],v[64:67]
v_mfma_f32_16x16x32_bf16 v[72:75],a[188:191],v[252:255],v[72:75]
ds_read_b128 v[248:251],v17 offset:45056
s_waitcnt lgkmcnt(5)
v_mfma_f32_16x16x32_bf16 v[64:67],a[64:67],v[224:227],v[64:67]
v_min3_u32 v27,v27,v224,v228
v_mfma_f32_16x16x32_bf16 v[72:75],a[192:195],v[224:227],v[72:75]
ds_read_b128 v[252:255],v17 offset:47104
v_mfma_f32_16x16x32_bf16 v[64:67],a[68:71],v[228:231],v[64:67]
v_mfma_f32_16x16x32_bf16 v[72:75],a[196:199],v[228:231],v[72:75]
ds_read_b128 v[224:227],v17 offset:49152
s_waitcnt lgkmcnt(5)
v_mfma_f32_16x16x32_bf16 v[64:67],a[72:75],v[232:235],v[64:67]
v_min3_u32 v27,v27,v232,v236
v_mfma_f32_16x16x32_bf16 v[72:75],a[200:203],v[232:235],v[72:75]
ds_read_b128 v[228:231],v17 offset:51200
v_mfma_f32_16x16x32_bf16 v[64:67],a[76:79],v[236:239],v[64:67]
v_mfma_f32_16x16x32_bf16 v[72:75],a[204:207],v[236:239],v[72:75]
ds_read_b128 v[232:235],v17 offset:53248
s_waitcnt lgkmcnt(5)
v_mfma_f32_16x16x32_bf16 v[64:67],a[80:83],v[240:243],v[64:67]
v_min3_u32 v27,v27,v240,v244
v_mfma_f32_16x16x32_bf16 v[72:75],a[208:211],v[240:243],v[72:75]
ds_read_b128 v[236:239],v17 offset:55296
v_mfma_f32_16x16x32_bf16 v[64:67],a[84:87],v[244:247],v[64:67]
v_mfma_f32_16x16x32_bf16 v[72:75],a[212:215],v[244:247],v[72:75]
ds_read_b128 v[240:243],v17 offset:57344
s_waitcnt lgkmcnt(5)
v_mfma_f32_16x16x32_bf16 v[64:67],a[88:91],v[248:251],v[64:67]
v_min3_u32 v27,v27,v248,v252
v_mfma_f32_16x16x32_bf16 v[72:75],a[216:219],v[248:251],v[72:75]
ds_read_b128 v[244:247],v17 offset:59392
v_mfma_f32_16x16x32_bf16 v[64:67],a[92:95],v[252:255],v[64:67]
v_mfma_f32_16x16x32_bf16 v[72:75],a[220:223],v[252:255],v[72:75]
ds_read_b128 v[248:251],v17 offset:61440
s_waitcnt lgkmcnt(5)
v_mfma_f32_16x16x32_bf16 v[64:67],a[96:99],v[224:227],v[64:67]
v_min3_u32 v27,v27,v224,v228
v_mfma_f32_16x16x32_bf16 v[72:75],a[224:227],v[224:227],v[72:75]
ds_read_b128 v[252:255],v17 offset:63488
v_mfma_f32_16x16x32_bf16 v[64:67],a[100:103],v[228:231],v[64:67]
v_mfma_f32_16x16x32_bf16 v[72:75],a[228:231],v[228:231],v[72:75]
s_waitcnt vmcnt(0)
s_barrier
ds_read_b128 v[224:227],v17 offset:1024
s_waitcnt lgkmcnt(5)
v_mfma_f32_16x16x32_bf16 v[64:67],a[104:107],v[232:235],v[64:67]
v_min3_u32 v27,v27,v232,v236
ds_read_b128 v[124:127],v19 offset:256
v_mfma_f32_16x16x32_bf16 v[72:75],a[232:235],v[232:235],v[72:75]
ds_read_b128 v[228:231],v17 offset:3072
ds_read_b128 v[120:123],v19 offset:0
v_mfma_f32_16x16x32_bf16 v[64:67],a[108:111],v[236:239],v[64:67]
v_mfma_f32_16x16x32_bf16 v[72:75],a[236:239],v[236:239],v[72:75]
ds_read_b128 v[232:235],v17 offset:5120
s_waitcnt lgkmcnt(7)
v_mfma_f32_16x16x32_bf16 v[64:67],a[112:115],v[240:243],v[64:67]
v_min3_u32 v27,v27,v240,v244
v_mfma_f32_16x16x32_bf16 v[72:75],a[240:243],v[240:243],v[72:75]
ds_read_b128 v[236:239],v17 offset:7168
v_mfma_f32_16x16x32_bf16 v[64:67],a[116:119],v[244:247],v[64:67]
v_mfma_f32_16x16x32_bf16 v[72:75],a[244:247],v[244:247],v[72:75]
ds_read_b128 v[240:243],v17 offset:9216
s_waitcnt lgkmcnt(7)
v_mfma_f32_16x16x32_bf16 v[64:67],a[120:123],v[248:251],v[64:67]
v_min3_u32 v27,v27,v248,v252
v_mfma_f32_16x16x32_bf16 v[72:75],a[248:251],v[248:251],v[72:75]
ds_read_b128 v[244:247],v17 offset:11264
v_mfma_f32_16x16x32_bf16 v[64:67],a[124:127],v[252:255],v[64:67]
buffer_load_dword v2,v21,s[20:23],s87 offen sc1
v_mfma_f32_16x16x32_bf16 v[72:75],a[252:255],v[252:255],v[72:75]
ds_read_b128 v[248:251],v17 offset:13312
s_waitcnt lgkmcnt(6)
v_mfma_f32_16x16x32_bf16 v[68:71],a[0:3],v[224:227],0
v_cmp_eq_u32 vcc,0,v27
s_cbranch_vccnz retry_308
v_mfma_f32_16x16x32_bf16 v[76:79],a[128:131],v[224:227],0
ds_read_b128 v[252:255],v17 offset:15360
v_min3_u32 v27,v27,v224,v228
v_mfma_f32_16x16x32_bf16 v[68:71],a[4:7],v[228:231],v[68:71]
s_add_u32 s96,s71,2
s_waitcnt lgkmcnt(6)
v_mfma_f32_16x16x32_bf16 v[76:79],a[132:135],v[228:231],v[76:79]
ds_read_b128 v[224:227],v17 offset:17408
s_waitcnt lgkmcnt(5)
v_mfma_f32_16x16x32_bf16 v[68:71],a[8:11],v[232:235],v[68:71]
v_min3_u32 v27,v27,v232,v236
v_fmac_f32 v64,v52,v120
v_fmac_f32 v65,v53,v120
v_mfma_f32_16x16x32_bf16 v[76:79],a[136:139],v[232:235],v[76:79]
ds_read_b128 v[228:231],v17 offset:19456
v_fmac_f32 v66,v54,v120
v_fmac_f32 v67,v55,v120
v_mfma_f32_16x16x32_bf16 v[68:71],a[12:15],v[236:239],v[68:71]
v_mul_f32 v88,v64,v64
v_mul_f32 v89,v65,v65
v_fmac_f32 v72,v56,v120
v_mfma_f32_16x16x32_bf16 v[76:79],a[140:143],v[236:239],v[76:79]
ds_read_b128 v[232:235],v17 offset:21504
v_fmac_f32 v73,v57,v120
s_waitcnt lgkmcnt(5)
v_mfma_f32_16x16x32_bf16 v[68:71],a[16:19],v[240:243],v[68:71]
v_min3_u32 v27,v27,v240,v244
v_mul_f32 v90,v66,v66
v_fmac_f32 v74,v58,v120
v_mfma_f32_16x16x32_bf16 v[76:79],a[144:147],v[240:243],v[76:79]
ds_read_b128 v[236:239],v17 offset:23552
v_mul_f32 v91,v67,v67
v_fmac_f32 v75,v59,v120
v_mfma_f32_16x16x32_bf16 v[68:71],a[20:23],v[244:247],v[68:71]
v_fma_f32 v88,v88,v121,v122
v_fma_f32 v89,v89,v121,v122
v_mul_f32 v92,v72,v72
v_mfma_f32_16x16x32_bf16 v[76:79],a[148:151],v[244:247],v[76:79]
ds_read_b128 v[240:243],v17 offset:25600
v_mul_f32 v93,v73,v73
s_waitcnt lgkmcnt(5)
v_mfma_f32_16x16x32_bf16 v[68:71],a[24:27],v[248:251],v[68:71]
v_min3_u32 v27,v27,v248,v252
v_fma_f32 v90,v90,v121,v122
v_mul_f32 v94,v74,v74
v_mfma_f32_16x16x32_bf16 v[76:79],a[152:155],v[248:251],v[76:79]
ds_read_b128 v[244:247],v17 offset:27648
v_fma_f32 v91,v91,v121,v122
v_mul_f32 v95,v75,v75
v_mfma_f32_16x16x32_bf16 v[68:71],a[28:31],v[252:255],v[68:71]
v_mul_f32 v88,v88,v64
v_mul_f32 v89,v89,v65
v_fma_f32 v92,v92,v121,v122
v_mfma_f32_16x16x32_bf16 v[76:79],a[156:159],v[252:255],v[76:79]
ds_read_b128 v[248:251],v17 offset:29696
v_fma_f32 v93,v93,v121,v122
s_waitcnt lgkmcnt(5)
v_mfma_f32_16x16x32_bf16 v[68:71],a[32:35],v[224:227],v[68:71]
v_min3_u32 v27,v27,v224,v228
v_mul_f32 v90,v90,v66
v_fma_f32 v94,v94,v121,v122
v_mfma_f32_16x16x32_bf16 v[76:79],a[160:163],v[224:227],v[76:79]
ds_read_b128 v[252:255],v17 offset:31744
v_mul_f32 v91,v91,v67
v_fma_f32 v95,v95,v121,v122
v_mfma_f32_16x16x32_bf16 v[68:71],a[36:39],v[228:231],v[68:71]
v_exp_f32 v88,v88
v_mul_f32 v92,v92,v72
v_mfma_f32_16x16x32_bf16 v[76:79],a[164:167],v[228:231],v[76:79]
ds_read_b128 v[224:227],v17 offset:33792
v_mul_f32 v93,v93,v73
s_waitcnt lgkmcnt(5)
v_mfma_f32_16x16x32_bf16 v[68:71],a[40:43],v[232:235],v[68:71]
v_min3_u32 v27,v27,v232,v236
v_mul_f32 v94,v94,v74
v_mul_f32 v95,v95,v75
v_mfma_f32_16x16x32_bf16 v[76:79],a[168:171],v[232:235],v[76:79]
ds_read_b128 v[228:231],v17 offset:35840
v_exp_f32 v92,v92
v_mfma_f32_16x16x32_bf16 v[68:71],a[44:47],v[236:239],v[68:71]
v_exp_f32 v89,v89
v_mfma_f32_16x16x32_bf16 v[76:79],a[172:175],v[236:239],v[76:79]
ds_read_b128 v[232:235],v17 offset:37888
s_waitcnt lgkmcnt(5)
v_mfma_f32_16x16x32_bf16 v[68:71],a[48:51],v[240:243],v[68:71]
v_min3_u32 v27,v27,v240,v244
v_exp_f32 v93,v93
v_mfma_f32_16x16x32_bf16 v[76:79],a[176:179],v[240:243],v[76:79]
ds_read_b128 v[236:239],v17 offset:39936
v_exp_f32 v94,v94
v_mfma_f32_16x16x32_bf16 v[68:71],a[52:55],v[244:247],v[68:71]
v_exp_f32 v90,v90
v_mfma_f32_16x16x32_bf16 v[76:79],a[180:183],v[244:247],v[76:79]
ds_read_b128 v[240:243],v17 offset:41984
s_waitcnt lgkmcnt(5)
v_mfma_f32_16x16x32_bf16 v[68:71],a[56:59],v[248:251],v[68:71]
v_min3_u32 v27,v27,v248,v252
v_exp_f32 v95,v95
v_mfma_f32_16x16x32_bf16 v[76:79],a[184:187],v[248:251],v[76:79]
ds_read_b128 v[244:247],v17 offset:44032
v_fma_f32 v92,v92,v123,v123
v_fma_f32 v93,v93,v123,v123
v_mfma_f32_16x16x32_bf16 v[68:71],a[60:63],v[252:255],v[68:71]
v_exp_f32 v91,v91
v_fma_f32 v94,v94,v123,v123
v_mfma_f32_16x16x32_bf16 v[76:79],a[188:191],v[252:255],v[76:79]
ds_read_b128 v[248:251],v17 offset:46080
v_fma_f32 v95,v95,v123,v123
s_waitcnt lgkmcnt(5)
v_mfma_f32_16x16x32_bf16 v[68:71],a[64:67],v[224:227],v[68:71]
v_min3_u32 v27,v27,v224,v228
v_fma_f32 v88,v88,v123,v123
v_mfma_f32_16x16x32_bf16 v[76:79],a[192:195],v[224:227],v[76:79]
ds_read_b128 v[252:255],v17 offset:48128
v_fma_f32 v89,v89,v123,v123
v_mfma_f32_16x16x32_bf16 v[68:71],a[68:71],v[228:231],v[68:71]
v_fma_f32 v90,v90,v123,v123
v_fma_f32 v91,v91,v123,v123
v_mfma_f32_16x16x32_bf16 v[76:79],a[196:199],v[228:231],v[76:79]
ds_read_b128 v[224:227],v17 offset:50176
s_waitcnt lgkmcnt(5)
v_mfma_f32_16x16x32_bf16 v[68:71],a[72:75],v[232:235],v[68:71]
v_min3_u32 v27,v27,v232,v236
v_rcp_f32 v92,v92
v_mfma_f32_16x16x32_bf16 v[76:79],a[200:203],v[232:235],v[76:79]
ds_read_b128 v[228:231],v17 offset:52224
v_rcp_f32 v93,v93
v_mfma_f32_16x16x32_bf16 v[68:71],a[76:79],v[236:239],v[68:71]
v_rcp_f32 v88,v88
v_mfma_f32_16x16x32_bf16 v[76:79],a[204:207],v[236:239],v[76:79]
ds_read_b128 v[232:235],v17 offset:54272
s_waitcnt lgkmcnt(5)
v_mfma_f32_16x16x32_bf16 v[68:71],a[80:83],v[240:243],v[68:71]
v_min3_u32 v27,v27,v240,v244
v_rcp_f32 v94,v94
v_mfma_f32_16x16x32_bf16 v[76:79],a[208:211],v[240:243],v[76:79]
ds_read_b128 v[236:239],v17 offset:56320
v_rcp_f32 v95,v95
v_mfma_f32_16x16x32_bf16 v[68:71],a[84:87],v[244:247],v[68:71]
v_rcp_f32 v89,v89
v_mfma_f32_16x16x32_bf16 v[76:79],a[212:215],v[244:247],v[76:79]
ds_read_b128 v[240:243],v17 offset:58368
s_waitcnt lgkmcnt(5)
v_mfma_f32_16x16x32_bf16 v[68:71],a[88:91],v[248:251],v[68:71]
v_min3_u32 v27,v27,v248,v252
v_mul_f32 v92,v92,v72
v_mfma_f32_16x16x32_bf16 v[76:79],a[216:219],v[248:251],v[76:79]
ds_read_b128 v[244:247],v17 offset:60416
v_mul_f32 v93,v93,v73
v_mfma_f32_16x16x32_bf16 v[68:71],a[92:95],v[252:255],v[68:71]
v_rcp_f32 v90,v90
v_mfma_f32_16x16x32_bf16 v[76:79],a[220:223],v[252:255],v[76:79]
ds_read_b128 v[248:251],v17 offset:62464
s_waitcnt lgkmcnt(5)
v_mfma_f32_16x16x32_bf16 v[68:71],a[96:99],v[224:227],v[68:71]
v_min3_u32 v27,v27,v224,v228
v_mul_f32 v94,v94,v74
v_mfma_f32_16x16x32_bf16 v[76:79],a[224:227],v[224:227],v[76:79]
ds_read_b128 v[252:255],v17 offset:64512
v_mul_f32 v95,v95,v75
v_mfma_f32_16x16x32_bf16 v[68:71],a[100:103],v[228:231],v[68:71]
v_rcp_f32 v91,v91
v_mfma_f32_16x16x32_bf16 v[76:79],a[228:231],v[228:231],v[76:79]
v_mul_f32 v88,v88,v64
s_waitcnt lgkmcnt(4)
v_mfma_f32_16x16x32_bf16 v[68:71],a[104:107],v[232:235],v[68:71]
v_min3_u32 v27,v27,v232,v236
s_waitcnt vmcnt(0)
v_mfma_f32_16x16x32_bf16 v[76:79],a[232:235],v[232:235],v[76:79]
v_cmp_gt_u32 vcc,s96,v2
s_mov_b32 s96,vcc_lo
v_mfma_f32_16x16x32_bf16 v[68:71],a[108:111],v[236:239],v[68:71]
v_mov_b32 v44,s96
ds_write_b32 v46,v44
v_mfma_f32_16x16x32_bf16 v[76:79],a[236:239],v[236:239],v[76:79]
v_mul_f32 v89,v89,v65
s_waitcnt lgkmcnt(3)
v_mfma_f32_16x16x32_bf16 v[68:71],a[112:115],v[240:243],v[68:71]
v_min3_u32 v27,v27,v240,v244
v_mul_f32 v90,v90,v66
v_mfma_f32_16x16x32_bf16 v[76:79],a[240:243],v[240:243],v[76:79]
v_mul_f32 v91,v91,v67
v_cvt_pk_bf16_f32 v96,v88,v89
v_mfma_f32_16x16x32_bf16 v[68:71],a[116:119],v[244:247],v[68:71]
v_cvt_pk_bf16_f32 v97,v90,v91
v_cvt_pk_bf16_f32 v98,v92,v93
v_mfma_f32_16x16x32_bf16 v[76:79],a[244:247],v[244:247],v[76:79]
v_cvt_pk_bf16_f32 v99,v94,v95
s_waitcnt lgkmcnt(1)
v_mfma_f32_16x16x32_bf16 v[68:71],a[120:123],v[248:251],v[68:71]
v_min3_u32 v27,v27,v248,v252
v_max_u32 v96,1,v96
v_mfma_f32_16x16x32_bf16 v[76:79],a[248:251],v[248:251],v[76:79]
buffer_store_dwordx4 v[96:99],v18,s[20:23],s70 offen offset:0 sc1
v_mfma_f32_16x16x32_bf16 v[68:71],a[124:127],v[252:255],v[68:71]
v_mfma_f32_16x16x32_bf16 v[76:79],a[252:255],v[252:255],v[76:79]
v_cmp_eq_u32 vcc,0,v27
s_cbranch_vccnz retry_308
s_branch epi_311
both_312:
s_waitcnt vmcnt(9)
s_barrier
ds_read_b128 v[224:227],v17 offset:0
ds_read_b128 v[228:231],v17 offset:2048
ds_read_b128 v[232:235],v17 offset:4096
ds_read_b128 v[236:239],v17 offset:6144
ds_read_b128 v[240:243],v17 offset:8192
ds_read_b128 v[244:247],v17 offset:10240
ds_read_b128 v[248:251],v17 offset:12288
s_waitcnt lgkmcnt(5)
v_mfma_f32_16x16x32_bf16 v[64:67],a[0:3],v[224:227],0
s_xor_b32 m0,s91,17408
s_add_u32 s88,s70,s75
v_min_u32 v27,v224,v228
v_mfma_f32_16x16x32_bf16 v[72:75],a[128:131],v[224:227],0
ds_read_b128 v[252:255],v17 offset:14336
s_add_u32 s88,s88,2097152
v_mfma_f32_16x16x32_bf16 v[64:67],a[4:7],v[228:231],v[64:67]
s_add_u32 s65,s95,32768
s_xor_b32 s88,s88,0x2000
v_mfma_f32_16x16x32_bf16 v[72:75],a[132:135],v[228:231],v[72:75]
s_waitcnt vmcnt(7)
s_barrier
ds_read_b128 v[224:227],v17 offset:16384
s_waitcnt lgkmcnt(5)
v_mfma_f32_16x16x32_bf16 v[64:67],a[8:11],v[232:235],v[64:67]
buffer_load_dwordx4 v16,s[20:23],s65 offen offset:0 sc1 lds
v_min3_u32 v27,v27,v232,v236
v_mfma_f32_16x16x32_bf16 v[72:75],a[136:139],v[232:235],v[72:75]
ds_read_b128 v[228:231],v17 offset:18432
s_xor_b32 s89,s88,1024
v_mfma_f32_16x16x32_bf16 v[64:67],a[12:15],v[236:239],v[64:67]
buffer_load_dwordx4 v16,s[20:23],s65 offen offset:2048 sc1 lds
v_mfma_f32_16x16x32_bf16 v[72:75],a[140:143],v[236:239],v[72:75]
ds_read_b128 v[232:235],v17 offset:20480
s_waitcnt lgkmcnt(5)
v_mfma_f32_16x16x32_bf16 v[64:67],a[16:19],v[240:243],v[64:67]
s_xor_b32 m0,s91,33792
v_min3_u32 v27,v27,v240,v244
v_mfma_f32_16x16x32_bf16 v[72:75],a[144:147],v[240:243],v[72:75]
ds_read_b128 v[236:239],v17 offset:22528
v_mfma_f32_16x16x32_bf16 v[64:67],a[20:23],v[244:247],v[64:67]
s_add_u32 s65,s95,65536
v_mfma_f32_16x16x32_bf16 v[72:75],a[148:151],v[244:247],v[72:75]
ds_read_b128 v[240:243],v17 offset:24576
s_waitcnt lgkmcnt(5)
v_mfma_f32_16x16x32_bf16 v[64:67],a[24:27],v[248:251],v[64:67]
buffer_load_dwordx4 v16,s[20:23],s65 offen offset:0 sc1 lds
v_mfma_f32_16x16x32_bf16 v[72:75],a[152:155],v[248:251],v[72:75]
ds_read_b128 v[244:247],v17 offset:26624
v_min3_u32 v27,v27,v248,v252
v_mfma_f32_16x16x32_bf16 v[64:67],a[28:31],v[252:255],v[64:67]
buffer_load_dwordx4 v16,s[20:23],s65 offen offset:2048 sc1 lds
v_mfma_f32_16x16x32_bf16 v[72:75],a[156:159],v[252:255],v[72:75]
ds_read_b128 v[248:251],v17 offset:28672
s_waitcnt lgkmcnt(5)
v_mfma_f32_16x16x32_bf16 v[64:67],a[32:35],v[224:227],v[64:67]
s_xor_b32 m0,s91,50176
v_min3_u32 v27,v27,v224,v228
v_mfma_f32_16x16x32_bf16 v[72:75],a[160:163],v[224:227],v[72:75]
ds_read_b128 v[252:255],v17 offset:30720
v_mfma_f32_16x16x32_bf16 v[64:67],a[36:39],v[228:231],v[64:67]
s_add_u32 s65,s95,98304
v_mfma_f32_16x16x32_bf16 v[72:75],a[164:167],v[228:231],v[72:75]
s_waitcnt vmcnt(7)
s_barrier
ds_read_b128 v[224:227],v17 offset:32768
s_waitcnt lgkmcnt(5)
v_mfma_f32_16x16x32_bf16 v[64:67],a[40:43],v[232:235],v[64:67]
buffer_load_dwordx4 v16,s[20:23],s65 offen offset:0 sc1 lds
v_mfma_f32_16x16x32_bf16 v[72:75],a[168:171],v[232:235],v[72:75]
ds_read_b128 v[228:231],v17 offset:34816
v_min3_u32 v27,v27,v232,v236
v_mfma_f32_16x16x32_bf16 v[64:67],a[44:47],v[236:239],v[64:67]
buffer_load_dwordx4 v16,s[20:23],s65 offen offset:2048 sc1 lds
v_mfma_f32_16x16x32_bf16 v[72:75],a[172:175],v[236:239],v[72:75]
ds_read_b128 v[232:235],v17 offset:36864
s_waitcnt lgkmcnt(5)
v_mfma_f32_16x16x32_bf16 v[64:67],a[48:51],v[240:243],v[64:67]
v_min3_u32 v27,v27,v240,v244
v_mfma_f32_16x16x32_bf16 v[72:75],a[176:179],v[240:243],v[72:75]
ds_read_b128 v[236:239],v17 offset:38912
v_mfma_f32_16x16x32_bf16 v[64:67],a[52:55],v[244:247],v[64:67]
s_xor_b32 m0,s72,0
v_mfma_f32_16x16x32_bf16 v[72:75],a[180:183],v[244:247],v[72:75]
ds_read_b128 v[240:243],v17 offset:40960
s_add_u32 s65,s88,0
s_waitcnt lgkmcnt(5)
v_mfma_f32_16x16x32_bf16 v[64:67],a[56:59],v[248:251],v[64:67]
buffer_load_dwordx4 v16,s[20:23],s65 offen offset:0 sc1 lds
v_mfma_f32_16x16x32_bf16 v[72:75],a[184:187],v[248:251],v[72:75]
ds_read_b128 v[244:247],v17 offset:43008
buffer_load_dwordx4 v16,s[20:23],s65 offen offset:2048 sc1 lds
v_mfma_f32_16x16x32_bf16 v[64:67],a[60:63],v[252:255],v[64:67]
v_min3_u32 v27,v27,v248,v252
v_mfma_f32_16x16x32_bf16 v[72:75],a[188:191],v[252:255],v[72:75]
ds_read_b128 v[248:251],v17 offset:45056
s_xor_b32 m0,s72,16384
s_waitcnt lgkmcnt(5)
v_mfma_f32_16x16x32_bf16 v[64:67],a[64:67],v[224:227],v[64:67]
s_add_u32 s65,s88,32768
v_min3_u32 v27,v27,v224,v228
v_mfma_f32_16x16x32_bf16 v[72:75],a[192:195],v[224:227],v[72:75]
ds_read_b128 v[252:255],v17 offset:47104
buffer_load_dwordx4 v16,s[20:23],s65 offen offset:0 sc1 lds
v_mfma_f32_16x16x32_bf16 v[64:67],a[68:71],v[228:231],v[64:67]
v_mfma_f32_16x16x32_bf16 v[72:75],a[196:199],v[228:231],v[72:75]
ds_read_b128 v[224:227],v17 offset:49152
s_waitcnt lgkmcnt(5)
v_mfma_f32_16x16x32_bf16 v[64:67],a[72:75],v[232:235],v[64:67]
buffer_load_dwordx4 v16,s[20:23],s65 offen offset:2048 sc1 lds
s_xor_b32 m0,s72,32768
v_mfma_f32_16x16x32_bf16 v[72:75],a[200:203],v[232:235],v[72:75]
ds_read_b128 v[228:231],v17 offset:51200
s_add_u32 s65,s88,65536
v_mfma_f32_16x16x32_bf16 v[64:67],a[76:79],v[236:239],v[64:67]
v_min3_u32 v27,v27,v232,v236
v_mfma_f32_16x16x32_bf16 v[72:75],a[204:207],v[236:239],v[72:75]
ds_read_b128 v[232:235],v17 offset:53248
s_waitcnt lgkmcnt(5)
v_mfma_f32_16x16x32_bf16 v[64:67],a[80:83],v[240:243],v[64:67]
buffer_load_dwordx4 v16,s[20:23],s65 offen offset:0 sc1 lds
v_mfma_f32_16x16x32_bf16 v[72:75],a[208:211],v[240:243],v[72:75]
ds_read_b128 v[236:239],v17 offset:55296
buffer_load_dwordx4 v16,s[20:23],s65 offen offset:2048 sc1 lds
v_mfma_f32_16x16x32_bf16 v[64:67],a[84:87],v[244:247],v[64:67]
s_xor_b32 m0,s72,49152
v_min3_u32 v27,v27,v240,v244
v_mfma_f32_16x16x32_bf16 v[72:75],a[212:215],v[244:247],v[72:75]
ds_read_b128 v[240:243],v17 offset:57344
s_add_u32 s65,s88,98304
s_waitcnt lgkmcnt(5)
v_mfma_f32_16x16x32_bf16 v[64:67],a[88:91],v[248:251],v[64:67]
buffer_load_dwordx4 v16,s[20:23],s65 offen offset:0 sc1 lds
v_mfma_f32_16x16x32_bf16 v[72:75],a[216:219],v[248:251],v[72:75]
ds_read_b128 v[244:247],v17 offset:59392
v_min3_u32 v27,v27,v248,v252
v_mfma_f32_16x16x32_bf16 v[64:67],a[92:95],v[252:255],v[64:67]
buffer_load_dwordx4 v16,s[20:23],s65 offen offset:2048 sc1 lds
v_mfma_f32_16x16x32_bf16 v[72:75],a[220:223],v[252:255],v[72:75]
ds_read_b128 v[248:251],v17 offset:61440
s_waitcnt lgkmcnt(5)
v_mfma_f32_16x16x32_bf16 v[64:67],a[96:99],v[224:227],v[64:67]
s_xor_b32 m0,s72,1024
s_add_u32 s65,s89,0
v_mfma_f32_16x16x32_bf16 v[72:75],a[224:227],v[224:227],v[72:75]
ds_read_b128 v[252:255],v17 offset:63488
v_min3_u32 v27,v27,v224,v228
v_mfma_f32_16x16x32_bf16 v[64:67],a[100:103],v[228:231],v[64:67]
buffer_load_dwordx4 v16,s[20:23],s65 offen offset:0 sc1 lds
v_mfma_f32_16x16x32_bf16 v[72:75],a[228:231],v[228:231],v[72:75]
s_waitcnt vmcnt(9)
s_barrier
ds_read_b128 v[224:227],v17 offset:1024
s_waitcnt lgkmcnt(5)
v_mfma_f32_16x16x32_bf16 v[64:67],a[104:107],v[232:235],v[64:67]
buffer_load_dwordx4 v16,s[20:23],s65 offen offset:2048 sc1 lds
ds_read_b128 v[124:127],v19 offset:256
v_mfma_f32_16x16x32_bf16 v[72:75],a[232:235],v[232:235],v[72:75]
ds_read_b128 v[228:231],v17 offset:3072
s_xor_b32 m0,s72,17408
ds_read_b128 v[120:123],v19 offset:0
v_mfma_f32_16x16x32_bf16 v[64:67],a[108:111],v[236:239],v[64:67]
s_add_u32 s65,s89,32768
v_min3_u32 v27,v27,v232,v236
v_mfma_f32_16x16x32_bf16 v[72:75],a[236:239],v[236:239],v[72:75]
ds_read_b128 v[232:235],v17 offset:5120
s_waitcnt lgkmcnt(7)
v_mfma_f32_16x16x32_bf16 v[64:67],a[112:115],v[240:243],v[64:67]
buffer_load_dwordx4 v16,s[20:23],s65 offen offset:0 sc1 lds
v_mfma_f32_16x16x32_bf16 v[72:75],a[240:243],v[240:243],v[72:75]
ds_read_b128 v[236:239],v17 offset:7168
v_min3_u32 v27,v27,v240,v244
v_mfma_f32_16x16x32_bf16 v[64:67],a[116:119],v[244:247],v[64:67]
buffer_load_dwordx4 v16,s[20:23],s65 offen offset:2048 sc1 lds
v_mfma_f32_16x16x32_bf16 v[72:75],a[244:247],v[244:247],v[72:75]
ds_read_b128 v[240:243],v17 offset:9216
s_waitcnt lgkmcnt(7)
v_mfma_f32_16x16x32_bf16 v[64:67],a[120:123],v[248:251],v[64:67]
s_xor_b32 m0,s72,33792
s_add_u32 s65,s89,65536
v_mfma_f32_16x16x32_bf16 v[72:75],a[248:251],v[248:251],v[72:75]
ds_read_b128 v[244:247],v17 offset:11264
v_min3_u32 v27,v27,v248,v252
v_mfma_f32_16x16x32_bf16 v[64:67],a[124:127],v[252:255],v[64:67]
buffer_load_dwordx4 v16,s[20:23],s65 offen offset:0 sc1 lds
buffer_load_dword v2,v21,s[20:23],s87 offen sc1
v_mfma_f32_16x16x32_bf16 v[72:75],a[252:255],v[252:255],v[72:75]
ds_read_b128 v[248:251],v17 offset:13312
s_add_u32 s96,s71,2
s_waitcnt lgkmcnt(6)
v_mfma_f32_16x16x32_bf16 v[68:71],a[0:3],v[224:227],0
buffer_load_dwordx4 v16,s[20:23],s65 offen offset:2048 sc1 lds
v_min3_u32 v27,v27,v224,v228
v_mfma_f32_16x16x32_bf16 v[76:79],a[128:131],v[224:227],0
ds_read_b128 v[252:255],v17 offset:15360
s_xor_b32 m0,s72,50176
s_waitcnt lgkmcnt(6)
v_mfma_f32_16x16x32_bf16 v[68:71],a[4:7],v[228:231],v[68:71]
s_add_u32 s65,s89,98304
v_cmp_eq_u32 vcc,0,v27
s_cbranch_vccnz retry_308
v_mfma_f32_16x16x32_bf16 v[76:79],a[132:135],v[228:231],v[76:79]
ds_read_b128 v[224:227],v17 offset:17408
s_waitcnt lgkmcnt(5)
v_mfma_f32_16x16x32_bf16 v[68:71],a[8:11],v[232:235],v[68:71]
buffer_load_dwordx4 v16,s[20:23],s65 offen offset:0 sc1 lds
v_fmac_f32 v64,v52,v120
v_mfma_f32_16x16x32_bf16 v[76:79],a[136:139],v[232:235],v[76:79]
ds_read_b128 v[228:231],v17 offset:19456
v_min3_u32 v27,v27,v232,v236
v_fmac_f32 v65,v53,v120
v_mfma_f32_16x16x32_bf16 v[68:71],a[12:15],v[236:239],v[68:71]
buffer_load_dwordx4 v16,s[20:23],s65 offen offset:2048 sc1 lds
v_fmac_f32 v66,v54,v120
v_mfma_f32_16x16x32_bf16 v[76:79],a[140:143],v[236:239],v[76:79]
ds_read_b128 v[232:235],v17 offset:21504
v_fmac_f32 v67,v55,v120
s_waitcnt lgkmcnt(5)
v_mfma_f32_16x16x32_bf16 v[68:71],a[16:19],v[240:243],v[68:71]
v_min3_u32 v27,v27,v240,v244
v_mul_f32 v88,v64,v64
v_mul_f32 v89,v65,v65
v_mfma_f32_16x16x32_bf16 v[76:79],a[144:147],v[240:243],v[76:79]
ds_read_b128 v[236:239],v17 offset:23552
v_mul_f32 v90,v66,v66
v_mul_f32 v91,v67,v67
v_mfma_f32_16x16x32_bf16 v[68:71],a[20:23],v[244:247],v[68:71]
v_fma_f32 v88,v88,v121,v122
v_fma_f32 v89,v89,v121,v122
v_fmac_f32 v72,v56,v120
v_mfma_f32_16x16x32_bf16 v[76:79],a[148:151],v[244:247],v[76:79]
ds_read_b128 v[240:243],v17 offset:25600
v_fmac_f32 v73,v57,v120
s_waitcnt lgkmcnt(5)
v_mfma_f32_16x16x32_bf16 v[68:71],a[24:27],v[248:251],v[68:71]
v_min3_u32 v27,v27,v248,v252
v_fma_f32 v90,v90,v121,v122
v_fmac_f32 v74,v58,v120
v_mfma_f32_16x16x32_bf16 v[76:79],a[152:155],v[248:251],v[76:79]
ds_read_b128 v[244:247],v17 offset:27648
v_fma_f32 v91,v91,v121,v122
v_fmac_f32 v75,v59,v120
v_mfma_f32_16x16x32_bf16 v[68:71],a[28:31],v[252:255],v[68:71]
v_mul_f32 v88,v88,v64
v_mul_f32 v89,v89,v65
v_mul_f32 v92,v72,v72
v_mfma_f32_16x16x32_bf16 v[76:79],a[156:159],v[252:255],v[76:79]
ds_read_b128 v[248:251],v17 offset:29696
v_mul_f32 v93,v73,v73
s_waitcnt lgkmcnt(5)
v_mfma_f32_16x16x32_bf16 v[68:71],a[32:35],v[224:227],v[68:71]
v_min3_u32 v27,v27,v224,v228
v_mul_f32 v90,v90,v66
v_mul_f32 v94,v74,v74
v_mfma_f32_16x16x32_bf16 v[76:79],a[160:163],v[224:227],v[76:79]
ds_read_b128 v[252:255],v17 offset:31744
v_mul_f32 v91,v91,v67
v_mul_f32 v95,v75,v75
v_mfma_f32_16x16x32_bf16 v[68:71],a[36:39],v[228:231],v[68:71]
v_exp_f32 v88,v88
v_fma_f32 v92,v92,v121,v122
v_mfma_f32_16x16x32_bf16 v[76:79],a[164:167],v[228:231],v[76:79]
ds_read_b128 v[224:227],v17 offset:33792
v_fma_f32 v93,v93,v121,v122
s_waitcnt lgkmcnt(5)
v_mfma_f32_16x16x32_bf16 v[68:71],a[40:43],v[232:235],v[68:71]
v_min3_u32 v27,v27,v232,v236
v_fma_f32 v94,v94,v121,v122
v_fma_f32 v95,v95,v121,v122
v_mfma_f32_16x16x32_bf16 v[76:79],a[168:171],v[232:235],v[76:79]
ds_read_b128 v[228:231],v17 offset:35840
v_mul_f32 v92,v92,v72
v_mul_f32 v93,v93,v73
v_mfma_f32_16x16x32_bf16 v[68:71],a[44:47],v[236:239],v[68:71]
v_exp_f32 v89,v89
v_mul_f32 v94,v94,v74
v_mfma_f32_16x16x32_bf16 v[76:79],a[172:175],v[236:239],v[76:79]
ds_read_b128 v[232:235],v17 offset:37888
v_mul_f32 v95,v95,v75
s_waitcnt lgkmcnt(5)
v_mfma_f32_16x16x32_bf16 v[68:71],a[48:51],v[240:243],v[68:71]
v_min3_u32 v27,v27,v240,v244
v_exp_f32 v92,v92
v_mfma_f32_16x16x32_bf16 v[76:79],a[176:179],v[240:243],v[76:79]
ds_read_b128 v[236:239],v17 offset:39936
v_exp_f32 v93,v93
v_mfma_f32_16x16x32_bf16 v[68:71],a[52:55],v[244:247],v[68:71]
v_exp_f32 v90,v90
v_mfma_f32_16x16x32_bf16 v[76:79],a[180:183],v[244:247],v[76:79]
ds_read_b128 v[240:243],v17 offset:41984
s_waitcnt lgkmcnt(5)
v_mfma_f32_16x16x32_bf16 v[68:71],a[56:59],v[248:251],v[68:71]
v_min3_u32 v27,v27,v248,v252
v_exp_f32 v94,v94
v_mfma_f32_16x16x32_bf16 v[76:79],a[184:187],v[248:251],v[76:79]
ds_read_b128 v[244:247],v17 offset:44032
v_exp_f32 v95,v95
v_mfma_f32_16x16x32_bf16 v[68:71],a[60:63],v[252:255],v[68:71]
v_exp_f32 v91,v91
v_fma_f32 v92,v92,v123,v123
v_mfma_f32_16x16x32_bf16 v[76:79],a[188:191],v[252:255],v[76:79]
ds_read_b128 v[248:251],v17 offset:46080
v_fma_f32 v93,v93,v123,v123
s_waitcnt lgkmcnt(5)
v_mfma_f32_16x16x32_bf16 v[68:71],a[64:67],v[224:227],v[68:71]
v_min3_u32 v27,v27,v224,v228
v_fma_f32 v88,v88,v123,v123
v_fma_f32 v94,v94,v123,v123
v_mfma_f32_16x16x32_bf16 v[76:79],a[192:195],v[224:227],v[76:79]
ds_read_b128 v[252:255],v17 offset:48128
v_fma_f32 v89,v89,v123,v123
v_fma_f32 v95,v95,v123,v123
v_mfma_f32_16x16x32_bf16 v[68:71],a[68:71],v[228:231],v[68:71]
v_fma_f32 v90,v90,v123,v123
v_fma_f32 v91,v91,v123,v123
v_mfma_f32_16x16x32_bf16 v[76:79],a[196:199],v[228:231],v[76:79]
ds_read_b128 v[224:227],v17 offset:50176
s_waitcnt lgkmcnt(5)
v_mfma_f32_16x16x32_bf16 v[68:71],a[72:75],v[232:235],v[68:71]
v_min3_u32 v27,v27,v232,v236
v_rcp_f32 v92,v92
v_mfma_f32_16x16x32_bf16 v[76:79],a[200:203],v[232:235],v[76:79]
ds_read_b128 v[228:231],v17 offset:52224
v_rcp_f32 v93,v93
v_mfma_f32_16x16x32_bf16 v[68:71],a[76:79],v[236:239],v[68:71]
v_rcp_f32 v88,v88
v_mfma_f32_16x16x32_bf16 v[76:79],a[204:207],v[236:239],v[76:79]
ds_read_b128 v[232:235],v17 offset:54272
s_waitcnt lgkmcnt(5)
v_mfma_f32_16x16x32_bf16 v[68:71],a[80:83],v[240:243],v[68:71]
v_min3_u32 v27,v27,v240,v244
v_rcp_f32 v94,v94
v_mfma_f32_16x16x32_bf16 v[76:79],a[208:211],v[240:243],v[76:79]
ds_read_b128 v[236:239],v17 offset:56320
v_rcp_f32 v95,v95
v_mfma_f32_16x16x32_bf16 v[68:71],a[84:87],v[244:247],v[68:71]
v_rcp_f32 v89,v89
v_mfma_f32_16x16x32_bf16 v[76:79],a[212:215],v[244:247],v[76:79]
ds_read_b128 v[240:243],v17 offset:58368
s_waitcnt lgkmcnt(5)
v_mfma_f32_16x16x32_bf16 v[68:71],a[88:91],v[248:251],v[68:71]
v_min3_u32 v27,v27,v248,v252
v_mul_f32 v92,v92,v72
v_mfma_f32_16x16x32_bf16 v[76:79],a[216:219],v[248:251],v[76:79]
ds_read_b128 v[244:247],v17 offset:60416
v_mul_f32 v93,v93,v73
v_mfma_f32_16x16x32_bf16 v[68:71],a[92:95],v[252:255],v[68:71]
v_rcp_f32 v90,v90
v_mfma_f32_16x16x32_bf16 v[76:79],a[220:223],v[252:255],v[76:79]
ds_read_b128 v[248:251],v17 offset:62464
s_waitcnt lgkmcnt(5)
v_mfma_f32_16x16x32_bf16 v[68:71],a[96:99],v[224:227],v[68:71]
v_min3_u32 v27,v27,v224,v228
v_mul_f32 v94,v94,v74
v_mfma_f32_16x16x32_bf16 v[76:79],a[224:227],v[224:227],v[76:79]
ds_read_b128 v[252:255],v17 offset:64512
v_mul_f32 v95,v95,v75
v_mfma_f32_16x16x32_bf16 v[68:71],a[100:103],v[228:231],v[68:71]
v_rcp_f32 v91,v91
v_mfma_f32_16x16x32_bf16 v[76:79],a[228:231],v[228:231],v[76:79]
v_mul_f32 v88,v88,v64
s_waitcnt lgkmcnt(4)
v_mfma_f32_16x16x32_bf16 v[68:71],a[104:107],v[232:235],v[68:71]
v_min3_u32 v27,v27,v232,v236
s_waitcnt vmcnt(3)
v_mfma_f32_16x16x32_bf16 v[76:79],a[232:235],v[232:235],v[76:79]
v_cmp_gt_u32 vcc,s96,v2
s_mov_b32 s96,vcc_lo
v_mfma_f32_16x16x32_bf16 v[68:71],a[108:111],v[236:239],v[68:71]
v_mov_b32 v44,s96
ds_write_b32 v46,v44
v_mfma_f32_16x16x32_bf16 v[76:79],a[236:239],v[236:239],v[76:79]
v_mul_f32 v89,v89,v65
s_waitcnt lgkmcnt(3)
v_mfma_f32_16x16x32_bf16 v[68:71],a[112:115],v[240:243],v[68:71]
v_min3_u32 v27,v27,v240,v244
v_mul_f32 v90,v90,v66
v_mfma_f32_16x16x32_bf16 v[76:79],a[240:243],v[240:243],v[76:79]
v_mul_f32 v91,v91,v67
v_cvt_pk_bf16_f32 v96,v88,v89
v_mfma_f32_16x16x32_bf16 v[68:71],a[116:119],v[244:247],v[68:71]
v_cvt_pk_bf16_f32 v97,v90,v91
v_cvt_pk_bf16_f32 v98,v92,v93
v_mfma_f32_16x16x32_bf16 v[76:79],a[244:247],v[244:247],v[76:79]
v_cvt_pk_bf16_f32 v99,v94,v95
s_waitcnt lgkmcnt(1)
v_mfma_f32_16x16x32_bf16 v[68:71],a[120:123],v[248:251],v[68:71]
v_min3_u32 v27,v27,v248,v252
v_max_u32 v96,1,v96
v_mfma_f32_16x16x32_bf16 v[76:79],a[248:251],v[248:251],v[76:79]
buffer_store_dwordx4 v[96:99],v18,s[20:23],s70 offen offset:0 sc1
v_mfma_f32_16x16x32_bf16 v[68:71],a[124:127],v[252:255],v[68:71]
v_mfma_f32_16x16x32_bf16 v[76:79],a[252:255],v[252:255],v[76:79]
v_cmp_eq_u32 vcc,0,v27
s_cbranch_vccnz retry_308
s_branch epi_311
ahead_310:
s_waitcnt vmcnt(4) lgkmcnt(0)
s_barrier
ds_read_b32 v44,v45
ds_read_b128 v[224:227],v17 offset:0
ds_read_b128 v[228:231],v17 offset:2048
ds_read_b128 v[232:235],v17 offset:4096
ds_read_b128 v[236:239],v17 offset:6144
ds_read_b128 v[240:243],v17 offset:8192
ds_read_b128 v[244:247],v17 offset:10240
ds_read_b128 v[248:251],v17 offset:12288
s_waitcnt lgkmcnt(5)
v_mfma_f32_16x16x32_bf16 v[64:67],a[0:3],v[224:227],0
s_add_u32 s88,s70,s75
s_add_u32 s88,s88,2097152
v_min_u32 v27,v224,v228
v_mfma_f32_16x16x32_bf16 v[72:75],a[128:131],v[224:227],0
ds_read_b128 v[252:255],v17 offset:14336
s_xor_b32 s88,s88,0x2000
v_mfma_f32_16x16x32_bf16 v[64:67],a[4:7],v[228:231],v[64:67]
v_readfirstlane_b32 s83,v44
v_mfma_f32_16x16x32_bf16 v[72:75],a[132:135],v[228:231],v[72:75]
ds_read_b128 v[224:227],v17 offset:16384
s_waitcnt lgkmcnt(5)
v_mfma_f32_16x16x32_bf16 v[64:67],a[8:11],v[232:235],v[64:67]
s_cmp_eq_u32 s83,0
s_cselect_b32 s88,s88,0x7fff0000
v_mfma_f32_16x16x32_bf16 v[72:75],a[136:139],v[232:235],v[72:75]
ds_read_b128 v[228:231],v17 offset:18432
s_xor_b32 s89,s88,1024
v_mfma_f32_16x16x32_bf16 v[64:67],a[12:15],v[236:239],v[64:67]
s_xor_b32 m0,s72,0
v_min3_u32 v27,v27,v232,v236
v_mfma_f32_16x16x32_bf16 v[72:75],a[140:143],v[236:239],v[72:75]
ds_read_b128 v[232:235],v17 offset:20480
s_waitcnt lgkmcnt(5)
v_mfma_f32_16x16x32_bf16 v[64:67],a[16:19],v[240:243],v[64:67]
s_add_u32 s65,s88,0
v_min3_u32 v27,v27,v240,v244
v_mfma_f32_16x16x32_bf16 v[72:75],a[144:147],v[240:243],v[72:75]
ds_read_b128 v[236:239],v17 offset:22528
v_mfma_f32_16x16x32_bf16 v[64:67],a[20:23],v[244:247],v[64:67]
buffer_load_dwordx4 v16,s[20:23],s65 offen offset:0 sc1 lds
v_mfma_f32_16x16x32_bf16 v[72:75],a[148:151],v[244:247],v[72:75]
ds_read_b128 v[240:243],v17 offset:24576
s_waitcnt lgkmcnt(5)
v_mfma_f32_16x16x32_bf16 v[64:67],a[24:27],v[248:251],v[64:67]
buffer_load_dwordx4 v16,s[20:23],s65 offen offset:2048 sc1 lds
v_mfma_f32_16x16x32_bf16 v[72:75],a[152:155],v[248:251],v[72:75]
ds_read_b128 v[244:247],v17 offset:26624
s_xor_b32 m0,s72,16384
v_mfma_f32_16x16x32_bf16 v[64:67],a[28:31],v[252:255],v[64:67]
s_add_u32 s65,s88,32768
v_min3_u32 v27,v27,v248,v252
v_mfma_f32_16x16x32_bf16 v[72:75],a[156:159],v[252:255],v[72:75]
ds_read_b128 v[248:251],v17 offset:28672
s_waitcnt lgkmcnt(5)
v_mfma_f32_16x16x32_bf16 v[64:67],a[32:35],v[224:227],v[64:67]
buffer_load_dwordx4 v16,s[20:23],s65 offen offset:0 sc1 lds
v_mfma_f32_16x16x32_bf16 v[72:75],a[160:163],v[224:227],v[72:75]
ds_read_b128 v[252:255],v17 offset:30720
v_min3_u32 v27,v27,v224,v228
v_mfma_f32_16x16x32_bf16 v[64:67],a[36:39],v[228:231],v[64:67]
buffer_load_dwordx4 v16,s[20:23],s65 offen offset:2048 sc1 lds
v_mfma_f32_16x16x32_bf16 v[72:75],a[164:167],v[228:231],v[72:75]
ds_read_b128 v[224:227],v17 offset:32768
s_waitcnt lgkmcnt(5)
v_mfma_f32_16x16x32_bf16 v[64:67],a[40:43],v[232:235],v[64:67]
s_xor_b32 m0,s72,32768
s_add_u32 s65,s88,65536
v_mfma_f32_16x16x32_bf16 v[72:75],a[168:171],v[232:235],v[72:75]
ds_read_b128 v[228:231],v17 offset:34816
v_min3_u32 v27,v27,v232,v236
v_mfma_f32_16x16x32_bf16 v[64:67],a[44:47],v[236:239],v[64:67]
buffer_load_dwordx4 v16,s[20:23],s65 offen offset:0 sc1 lds
v_mfma_f32_16x16x32_bf16 v[72:75],a[172:175],v[236:239],v[72:75]
ds_read_b128 v[232:235],v17 offset:36864
s_waitcnt lgkmcnt(5)
v_mfma_f32_16x16x32_bf16 v[64:67],a[48:51],v[240:243],v[64:67]
buffer_load_dwordx4 v16,s[20:23],s65 offen offset:2048 sc1 lds
v_mfma_f32_16x16x32_bf16 v[72:75],a[176:179],v[240:243],v[72:75]
ds_read_b128 v[236:239],v17 offset:38912
s_xor_b32 m0,s72,49152
v_mfma_f32_16x16x32_bf16 v[64:67],a[52:55],v[244:247],v[64:67]
v_min3_u32 v27,v27,v240,v244
v_mfma_f32_16x16x32_bf16 v[72:75],a[180:183],v[244:247],v[72:75]
ds_read_b128 v[240:243],v17 offset:40960
s_waitcnt lgkmcnt(5)
v_mfma_f32_16x16x32_bf16 v[64:67],a[56:59],v[248:251],v[64:67]
s_add_u32 s65,s88,98304
v_min3_u32 v27,v27,v248,v252
v_mfma_f32_16x16x32_bf16 v[72:75],a[184:187],v[248:251],v[72:75]
ds_read_b128 v[244:247],v17 offset:43008
v_mfma_f32_16x16x32_bf16 v[64:67],a[60:63],v[252:255],v[64:67]
buffer_load_dwordx4 v16,s[20:23],s65 offen offset:0 sc1 lds
v_mfma_f32_16x16x32_bf16 v[72:75],a[188:191],v[252:255],v[72:75]
ds_read_b128 v[248:251],v17 offset:45056
s_waitcnt lgkmcnt(5)
v_mfma_f32_16x16x32_bf16 v[64:67],a[64:67],v[224:227],v[64:67]
buffer_load_dwordx4 v16,s[20:23],s65 offen offset:2048 sc1 lds
v_mfma_f32_16x16x32_bf16 v[72:75],a[192:195],v[224:227],v[72:75]
ds_read_b128 v[252:255],v17 offset:47104
s_xor_b32 m0,s72,1024
v_mfma_f32_16x16x32_bf16 v[64:67],a[68:71],v[228:231],v[64:67]
s_add_u32 s65,s89,0
v_min3_u32 v27,v27,v224,v228
v_mfma_f32_16x16x32_bf16 v[72:75],a[196:199],v[228:231],v[72:75]
ds_read_b128 v[224:227],v17 offset:49152
s_waitcnt lgkmcnt(5)
v_mfma_f32_16x16x32_bf16 v[64:67],a[72:75],v[232:235],v[64:67]
buffer_load_dwordx4 v16,s[20:23],s65 offen offset:0 sc1 lds
v_mfma_f32_16x16x32_bf16 v[72:75],a[200:203],v[232:235],v[72:75]
ds_read_b128 v[228:231],v17 offset:51200
v_min3_u32 v27,v27,v232,v236
v_mfma_f32_16x16x32_bf16 v[64:67],a[76:79],v[236:239],v[64:67]
buffer_load_dwordx4 v16,s[20:23],s65 offen offset:2048 sc1 lds
v_mfma_f32_16x16x32_bf16 v[72:75],a[204:207],v[236:239],v[72:75]
ds_read_b128 v[232:235],v17 offset:53248
s_waitcnt lgkmcnt(5)
v_mfma_f32_16x16x32_bf16 v[64:67],a[80:83],v[240:243],v[64:67]
s_xor_b32 m0,s72,17408
s_add_u32 s65,s89,32768
v_mfma_f32_16x16x32_bf16 v[72:75],a[208:211],v[240:243],v[72:75]
ds_read_b128 v[236:239],v17 offset:55296
v_min3_u32 v27,v27,v240,v244
v_mfma_f32_16x16x32_bf16 v[64:67],a[84:87],v[244:247],v[64:67]
buffer_load_dwordx4 v16,s[20:23],s65 offen offset:0 sc1 lds
v_mfma_f32_16x16x32_bf16 v[72:75],a[212:215],v[244:247],v[72:75]
ds_read_b128 v[240:243],v17 offset:57344
s_waitcnt lgkmcnt(5)
v_mfma_f32_16x16x32_bf16 v[64:67],a[88:91],v[248:251],v[64:67]
buffer_load_dwordx4 v16,s[20:23],s65 offen offset:2048 sc1 lds
v_mfma_f32_16x16x32_bf16 v[72:75],a[216:219],v[248:251],v[72:75]
ds_read_b128 v[244:247],v17 offset:59392
s_xor_b32 m0,s72,33792
v_mfma_f32_16x16x32_bf16 v[64:67],a[92:95],v[252:255],v[64:67]
s_add_u32 s65,s89,65536
v_min3_u32 v27,v27,v248,v252
v_mfma_f32_16x16x32_bf16 v[72:75],a[220:223],v[252:255],v[72:75]
ds_read_b128 v[248:251],v17 offset:61440
s_waitcnt lgkmcnt(5)
v_mfma_f32_16x16x32_bf16 v[64:67],a[96:99],v[224:227],v[64:67]
buffer_load_dwordx4 v16,s[20:23],s65 offen offset:0 sc1 lds
v_mfma_f32_16x16x32_bf16 v[72:75],a[224:227],v[224:227],v[72:75]
ds_read_b128 v[252:255],v17 offset:63488
v_min3_u32 v27,v27,v224,v228
v_mfma_f32_16x16x32_bf16 v[64:67],a[100:103],v[228:231],v[64:67]
buffer_load_dwordx4 v16,s[20:23],s65 offen offset:2048 sc1 lds
s_waitcnt vmcnt(14)
v_mfma_f32_16x16x32_bf16 v[72:75],a[228:231],v[228:231],v[72:75]
s_barrier
ds_read_b128 v[224:227],v17 offset:1024
s_waitcnt lgkmcnt(5)
v_mfma_f32_16x16x32_bf16 v[64:67],a[104:107],v[232:235],v[64:67]
s_xor_b32 m0,s72,50176
v_min3_u32 v27,v27,v232,v236
v_add_u32 v22,s71,-1
v_mfma_f32_16x16x32_bf16 v[72:75],a[232:235],v[232:235],v[72:75]
ds_read_b128 v[228:231],v17 offset:3072
s_add_u32 s65,s89,98304
ds_read_b128 v[124:127],v19 offset:256
v_mfma_f32_16x16x32_bf16 v[64:67],a[108:111],v[236:239],v[64:67]
buffer_load_dwordx4 v16,s[20:23],s65 offen offset:0 sc1 lds
ds_read_b128 v[120:123],v19 offset:0
v_mfma_f32_16x16x32_bf16 v[72:75],a[236:239],v[236:239],v[72:75]
ds_read_b128 v[232:235],v17 offset:5120
s_waitcnt lgkmcnt(7)
v_mfma_f32_16x16x32_bf16 v[64:67],a[112:115],v[240:243],v[64:67]
buffer_load_dwordx4 v16,s[20:23],s65 offen offset:2048 sc1 lds
v_mfma_f32_16x16x32_bf16 v[72:75],a[240:243],v[240:243],v[72:75]
ds_read_b128 v[236:239],v17 offset:7168
v_min3_u32 v27,v27,v240,v244
v_mfma_f32_16x16x32_bf16 v[64:67],a[116:119],v[244:247],v[64:67]
buffer_store_dword v22,v23,s[20:23],s97 offen sc1
v_mfma_f32_16x16x32_bf16 v[72:75],a[244:247],v[244:247],v[72:75]
ds_read_b128 v[240:243],v17 offset:9216
s_waitcnt lgkmcnt(7)
v_mfma_f32_16x16x32_bf16 v[64:67],a[120:123],v[248:251],v[64:67]
v_min3_u32 v27,v27,v248,v252
s_mov_b32 s97,0x7fff0000
v_mfma_f32_16x16x32_bf16 v[72:75],a[248:251],v[248:251],v[72:75]
ds_read_b128 v[244:247],v17 offset:11264
v_mfma_f32_16x16x32_bf16 v[64:67],a[124:127],v[252:255],v[64:67]
buffer_load_dword v2,v21,s[20:23],s87 offen sc1
v_mfma_f32_16x16x32_bf16 v[72:75],a[252:255],v[252:255],v[72:75]
ds_read_b128 v[248:251],v17 offset:13312
s_waitcnt lgkmcnt(7)
v_mfma_f32_16x16x32_bf16 v[68:71],a[0:3],v[224:227],0
v_cmp_eq_u32 vcc,0,v27
s_cbranch_vccnz retry_308
v_mfma_f32_16x16x32_bf16 v[76:79],a[128:131],v[224:227],0
ds_read_b128 v[252:255],v17 offset:15360
v_min3_u32 v27,v27,v224,v228
v_mfma_f32_16x16x32_bf16 v[68:71],a[4:7],v[228:231],v[68:71]
s_add_u32 s96,s71,2
s_waitcnt lgkmcnt(6)
v_mfma_f32_16x16x32_bf16 v[76:79],a[132:135],v[228:231],v[76:79]
ds_read_b128 v[224:227],v17 offset:17408
s_waitcnt lgkmcnt(5)
v_mfma_f32_16x16x32_bf16 v[68:71],a[8:11],v[232:235],v[68:71]
v_min3_u32 v27,v27,v232,v236
v_fmac_f32 v64,v52,v120
v_fmac_f32 v65,v53,v120
v_mfma_f32_16x16x32_bf16 v[76:79],a[136:139],v[232:235],v[76:79]
ds_read_b128 v[228:231],v17 offset:19456
v_fmac_f32 v66,v54,v120
v_fmac_f32 v67,v55,v120
v_mfma_f32_16x16x32_bf16 v[68:71],a[12:15],v[236:239],v[68:71]
v_mul_f32 v88,v64,v64
v_mul_f32 v89,v65,v65
v_fmac_f32 v72,v56,v120
v_mfma_f32_16x16x32_bf16 v[76:79],a[140:143],v[236:239],v[76:79]
ds_read_b128 v[232:235],v17 offset:21504
v_fmac_f32 v73,v57,v120
s_waitcnt lgkmcnt(5)
v_mfma_f32_16x16x32_bf16 v[68:71],a[16:19],v[240:243],v[68:71]
v_min3_u32 v27,v27,v240,v244
v_mul_f32 v90,v66,v66
v_fmac_f32 v74,v58,v120
v_mfma_f32_16x16x32_bf16 v[76:79],a[144:147],v[240:243],v[76:79]
ds_read_b128 v[236:239],v17 offset:23552
v_mul_f32 v91,v67,v67
v_fmac_f32 v75,v59,v120
v_mfma_f32_16x16x32_bf16 v[68:71],a[20:23],v[244:247],v[68:71]
v_fma_f32 v88,v88,v121,v122
v_fma_f32 v89,v89,v121,v122
v_mul_f32 v92,v72,v72
v_mfma_f32_16x16x32_bf16 v[76:79],a[148:151],v[244:247],v[76:79]
ds_read_b128 v[240:243],v17 offset:25600
v_mul_f32 v93,v73,v73
s_waitcnt lgkmcnt(5)
v_mfma_f32_16x16x32_bf16 v[68:71],a[24:27],v[248:251],v[68:71]
v_min3_u32 v27,v27,v248,v252
v_fma_f32 v90,v90,v121,v122
v_mul_f32 v94,v74,v74
v_mfma_f32_16x16x32_bf16 v[76:79],a[152:155],v[248:251],v[76:79]
ds_read_b128 v[244:247],v17 offset:27648
v_fma_f32 v91,v91,v121,v122
v_mul_f32 v95,v75,v75
v_mfma_f32_16x16x32_bf16 v[68:71],a[28:31],v[252:255],v[68:71]
v_mul_f32 v88,v88,v64
v_mul_f32 v89,v89,v65
v_fma_f32 v92,v92,v121,v122
v_mfma_f32_16x16x32_bf16 v[76:79],a[156:159],v[252:255],v[76:79]
ds_read_b128 v[248:251],v17 offset:29696
v_fma_f32 v93,v93,v121,v122
s_waitcnt lgkmcnt(5)
v_mfma_f32_16x16x32_bf16 v[68:71],a[32:35],v[224:227],v[68:71]
v_min3_u32 v27,v27,v224,v228
v_mul_f32 v90,v90,v66
v_fma_f32 v94,v94,v121,v122
v_mfma_f32_16x16x32_bf16 v[76:79],a[160:163],v[224:227],v[76:79]
ds_read_b128 v[252:255],v17 offset:31744
v_mul_f32 v91,v91,v67
v_fma_f32 v95,v95,v121,v122
v_mfma_f32_16x16x32_bf16 v[68:71],a[36:39],v[228:231],v[68:71]
v_exp_f32 v88,v88
v_mul_f32 v92,v92,v72
v_mfma_f32_16x16x32_bf16 v[76:79],a[164:167],v[228:231],v[76:79]
ds_read_b128 v[224:227],v17 offset:33792
v_mul_f32 v93,v93,v73
s_waitcnt lgkmcnt(5)
v_mfma_f32_16x16x32_bf16 v[68:71],a[40:43],v[232:235],v[68:71]
v_min3_u32 v27,v27,v232,v236
v_mul_f32 v94,v94,v74
v_mul_f32 v95,v95,v75
v_mfma_f32_16x16x32_bf16 v[76:79],a[168:171],v[232:235],v[76:79]
ds_read_b128 v[228:231],v17 offset:35840
v_exp_f32 v92,v92
v_mfma_f32_16x16x32_bf16 v[68:71],a[44:47],v[236:239],v[68:71]
v_exp_f32 v89,v89
v_mfma_f32_16x16x32_bf16 v[76:79],a[172:175],v[236:239],v[76:79]
ds_read_b128 v[232:235],v17 offset:37888
s_waitcnt lgkmcnt(5)
v_mfma_f32_16x16x32_bf16 v[68:71],a[48:51],v[240:243],v[68:71]
v_min3_u32 v27,v27,v240,v244
v_exp_f32 v93,v93
v_mfma_f32_16x16x32_bf16 v[76:79],a[176:179],v[240:243],v[76:79]
ds_read_b128 v[236:239],v17 offset:39936
v_exp_f32 v94,v94
v_mfma_f32_16x16x32_bf16 v[68:71],a[52:55],v[244:247],v[68:71]
v_exp_f32 v90,v90
v_mfma_f32_16x16x32_bf16 v[76:79],a[180:183],v[244:247],v[76:79]
ds_read_b128 v[240:243],v17 offset:41984
s_waitcnt lgkmcnt(5)
v_mfma_f32_16x16x32_bf16 v[68:71],a[56:59],v[248:251],v[68:71]
v_min3_u32 v27,v27,v248,v252
v_exp_f32 v95,v95
v_mfma_f32_16x16x32_bf16 v[76:79],a[184:187],v[248:251],v[76:79]
ds_read_b128 v[244:247],v17 offset:44032
v_fma_f32 v92,v92,v123,v123
v_fma_f32 v93,v93,v123,v123
v_mfma_f32_16x16x32_bf16 v[68:71],a[60:63],v[252:255],v[68:71]
v_exp_f32 v91,v91
v_fma_f32 v94,v94,v123,v123
v_mfma_f32_16x16x32_bf16 v[76:79],a[188:191],v[252:255],v[76:79]
ds_read_b128 v[248:251],v17 offset:46080
v_fma_f32 v95,v95,v123,v123
s_waitcnt lgkmcnt(5)
v_mfma_f32_16x16x32_bf16 v[68:71],a[64:67],v[224:227],v[68:71]
v_min3_u32 v27,v27,v224,v228
v_fma_f32 v88,v88,v123,v123
v_mfma_f32_16x16x32_bf16 v[76:79],a[192:195],v[224:227],v[76:79]
ds_read_b128 v[252:255],v17 offset:48128
v_fma_f32 v89,v89,v123,v123
v_mfma_f32_16x16x32_bf16 v[68:71],a[68:71],v[228:231],v[68:71]
v_fma_f32 v90,v90,v123,v123
v_fma_f32 v91,v91,v123,v123
v_mfma_f32_16x16x32_bf16 v[76:79],a[196:199],v[228:231],v[76:79]
ds_read_b128 v[224:227],v17 offset:50176
s_waitcnt lgkmcnt(5)
v_mfma_f32_16x16x32_bf16 v[68:71],a[72:75],v[232:235],v[68:71]
v_min3_u32 v27,v27,v232,v236
v_rcp_f32 v92,v92
v_mfma_f32_16x16x32_bf16 v[76:79],a[200:203],v[232:235],v[76:79]
ds_read_b128 v[228:231],v17 offset:52224
v_rcp_f32 v93,v93
v_mfma_f32_16x16x32_bf16 v[68:71],a[76:79],v[236:239],v[68:71]
v_rcp_f32 v88,v88
v_mfma_f32_16x16x32_bf16 v[76:79],a[204:207],v[236:239],v[76:79]
ds_read_b128 v[232:235],v17 offset:54272
s_waitcnt lgkmcnt(5)
v_mfma_f32_16x16x32_bf16 v[68:71],a[80:83],v[240:243],v[68:71]
v_min3_u32 v27,v27,v240,v244
v_rcp_f32 v94,v94
v_mfma_f32_16x16x32_bf16 v[76:79],a[208:211],v[240:243],v[76:79]
ds_read_b128 v[236:239],v17 offset:56320
v_rcp_f32 v95,v95
v_mfma_f32_16x16x32_bf16 v[68:71],a[84:87],v[244:247],v[68:71]
v_rcp_f32 v89,v89
v_mfma_f32_16x16x32_bf16 v[76:79],a[212:215],v[244:247],v[76:79]
ds_read_b128 v[240:243],v17 offset:58368
s_waitcnt lgkmcnt(5)
v_mfma_f32_16x16x32_bf16 v[68:71],a[88:91],v[248:251],v[68:71]
v_min3_u32 v27,v27,v248,v252
v_mul_f32 v92,v92,v72
v_mfma_f32_16x16x32_bf16 v[76:79],a[216:219],v[248:251],v[76:79]
ds_read_b128 v[244:247],v17 offset:60416
v_mul_f32 v93,v93,v73
v_mfma_f32_16x16x32_bf16 v[68:71],a[92:95],v[252:255],v[68:71]
v_rcp_f32 v90,v90
v_mfma_f32_16x16x32_bf16 v[76:79],a[220:223],v[252:255],v[76:79]
ds_read_b128 v[248:251],v17 offset:62464
s_waitcnt lgkmcnt(5)
v_mfma_f32_16x16x32_bf16 v[68:71],a[96:99],v[224:227],v[68:71]
v_min3_u32 v27,v27,v224,v228
v_mul_f32 v94,v94,v74
v_mfma_f32_16x16x32_bf16 v[76:79],a[224:227],v[224:227],v[76:79]
ds_read_b128 v[252:255],v17 offset:64512
v_mul_f32 v95,v95,v75
v_mfma_f32_16x16x32_bf16 v[68:71],a[100:103],v[228:231],v[68:71]
v_rcp_f32 v91,v91
v_mfma_f32_16x16x32_bf16 v[76:79],a[228:231],v[228:231],v[76:79]
v_mul_f32 v88,v88,v64
s_waitcnt lgkmcnt(4)
v_mfma_f32_16x16x32_bf16 v[68:71],a[104:107],v[232:235],v[68:71]
v_min3_u32 v27,v27,v232,v236
s_waitcnt vmcnt(0)
v_mfma_f32_16x16x32_bf16 v[76:79],a[232:235],v[232:235],v[76:79]
v_cmp_gt_u32 vcc,s96,v2
s_mov_b32 s96,vcc_lo
v_mfma_f32_16x16x32_bf16 v[68:71],a[108:111],v[236:239],v[68:71]
v_mov_b32 v44,s96
ds_write_b32 v46,v44
v_mfma_f32_16x16x32_bf16 v[76:79],a[236:239],v[236:239],v[76:79]
v_mul_f32 v89,v89,v65
s_waitcnt lgkmcnt(3)
v_mfma_f32_16x16x32_bf16 v[68:71],a[112:115],v[240:243],v[68:71]
v_min3_u32 v27,v27,v240,v244
v_mul_f32 v90,v90,v66
v_mfma_f32_16x16x32_bf16 v[76:79],a[240:243],v[240:243],v[76:79]
v_mul_f32 v91,v91,v67
v_cvt_pk_bf16_f32 v96,v88,v89
v_mfma_f32_16x16x32_bf16 v[68:71],a[116:119],v[244:247],v[68:71]
v_cvt_pk_bf16_f32 v97,v90,v91
v_cvt_pk_bf16_f32 v98,v92,v93
v_mfma_f32_16x16x32_bf16 v[76:79],a[244:247],v[244:247],v[76:79]
v_cvt_pk_bf16_f32 v99,v94,v95
s_waitcnt lgkmcnt(1)
v_mfma_f32_16x16x32_bf16 v[68:71],a[120:123],v[248:251],v[68:71]
v_min3_u32 v27,v27,v248,v252
v_max_u32 v96,1,v96
v_mfma_f32_16x16x32_bf16 v[76:79],a[248:251],v[248:251],v[76:79]
buffer_store_dwordx4 v[96:99],v18,s[20:23],s70 offen offset:0 sc1
v_mfma_f32_16x16x32_bf16 v[68:71],a[124:127],v[252:255],v[68:71]
v_mfma_f32_16x16x32_bf16 v[76:79],a[252:255],v[252:255],v[76:79]
v_cmp_eq_u32 vcc,0,v27
s_cbranch_vccnz retry_308
epi_311:
buffer_load_dword v29,v21,s[20:23],s87 offen sc1
s_nop 3
v_pk_fma_f32 v[68:69],v[52:53],v[124:125],v[68:69] op_sel_hi:[1,0,1]
v_pk_fma_f32 v[70:71],v[54:55],v[124:125],v[70:71] op_sel_hi:[1,0,1]
v_pk_fma_f32 v[76:77],v[56:57],v[124:125],v[76:77] op_sel_hi:[1,0,1]
v_pk_fma_f32 v[78:79],v[58:59],v[124:125],v[78:79] op_sel_hi:[1,0,1]
v_pk_mul_f32 v[88:89],v[68:69],v[68:69]
v_pk_mul_f32 v[90:91],v[70:71],v[70:71]
v_pk_mul_f32 v[92:93],v[76:77],v[76:77]
v_pk_mul_f32 v[94:95],v[78:79],v[78:79]
v_pk_fma_f32 v[88:89],v[88:89],v[124:125],v[126:127] op_sel:[0,1,0] op_sel_hi:[1,1,0]
v_pk_fma_f32 v[90:91],v[90:91],v[124:125],v[126:127] op_sel:[0,1,0] op_sel_hi:[1,1,0]
v_pk_fma_f32 v[92:93],v[92:93],v[124:125],v[126:127] op_sel:[0,1,0] op_sel_hi:[1,1,0]
v_pk_fma_f32 v[94:95],v[94:95],v[124:125],v[126:127] op_sel:[0,1,0] op_sel_hi:[1,1,0]
v_pk_mul_f32 v[88:89],v[88:89],v[68:69]
v_pk_mul_f32 v[90:91],v[90:91],v[70:71]
v_pk_mul_f32 v[92:93],v[92:93],v[76:77]
v_pk_mul_f32 v[94:95],v[94:95],v[78:79]
v_exp_f32 v88,v88
v_exp_f32 v89,v89
v_exp_f32 v90,v90
v_exp_f32 v91,v91
v_exp_f32 v92,v92
v_exp_f32 v93,v93
v_exp_f32 v94,v94
v_exp_f32 v95,v95
v_pk_fma_f32 v[88:89],v[88:89],v[126:127],v[126:127] op_sel:[0,1,1] op_sel_hi:[1,1,1]
v_pk_fma_f32 v[90:91],v[90:91],v[126:127],v[126:127] op_sel:[0,1,1] op_sel_hi:[1,1,1]
v_pk_fma_f32 v[92:93],v[92:93],v[126:127],v[126:127] op_sel:[0,1,1] op_sel_hi:[1,1,1]
v_pk_fma_f32 v[94:95],v[94:95],v[126:127],v[126:127] op_sel:[0,1,1] op_sel_hi:[1,1,1]
v_rcp_f32 v88,v88
v_rcp_f32 v89,v89
v_rcp_f32 v90,v90
v_rcp_f32 v91,v91
v_rcp_f32 v92,v92
v_rcp_f32 v93,v93
v_rcp_f32 v94,v94
v_rcp_f32 v95,v95
v_pk_mul_f32 v[88:89],v[88:89],v[68:69]
v_pk_mul_f32 v[90:91],v[90:91],v[70:71]
v_pk_mul_f32 v[92:93],v[92:93],v[76:77]
v_pk_mul_f32 v[94:95],v[94:95],v[78:79]
v_cvt_pk_bf16_f32 v96,v88,v89
v_cvt_pk_bf16_f32 v97,v90,v91
v_cvt_pk_bf16_f32 v98,v92,v93
v_cvt_pk_bf16_f32 v99,v94,v95
v_max_u32 v96,1,v96
buffer_store_dwordx4 v[96:99],v18,s[20:23],s70 offen offset:1024 sc1
s_cmp_gt_u32 s71,51
s_cselect_b32 s65,s73,0x7fff0000
s_cselect_b32 s97,0x7fff0000,s73
v_mov_b32 v22,s71
buffer_store_dword v22,v23,s[20:23],s65 offen sc1
v_xor_b32 v17,0x10000,v17
v_xor_b32 v45,16,v45
v_xor_b32 v46,16,v46
s_xor_b32 s72,s72,0x10000
s_add_u32 s70,s70,2097152
s_xor_b32 s70,s70,0x2000
s_add_u32 s71,s71,1
s_cmp_le_u32 s71,s57
s_cbranch_scc1 seg_309
s_endpgm
retry_308:
s_sub_u32 s90,s90,64
s_cmp_lt_i32 s90,0
s_cbranch_scc1 giveup_176
s_mov_b32 s83,1
s_waitcnt vmcnt(0) lgkmcnt(0)
s_barrier
s_branch seg_309
w3b_307:
s_add_u32 s64,s79,0
s_lshl_b32 s70,s64,21
s_lshl_b32 s64,s64,13
s_and_b32 s64,s64,0x2000
s_xor_b32 s64,s64,s62
s_add_u32 s70,s70,s64
s_add_u32 s70,s70,29360128
s_mov_b32 s83,1
s_mov_b32 s87,s74
s_cmp_eq_u32 s50,0
s_cselect_b32 s74,s74,0x7fff0000
v_mov_b32 v45,132096
s_lshl_b32 s64,s50,2
s_add_u32 s64,s64,132112
v_mov_b32 v46,s64
v_mov_b32 v2,0
v_mov_b32 v44,1
ds_write_b32 v45,v44
s_mov_b32 s97,0x7fff0000
s_waitcnt lgkmcnt(0)
seg_319:
s_cmp_eq_u32 s83,0
s_cbranch_scc1 ahead_320
s_add_u32 s94,s70,s75
s_xor_b32 s95,s94,1024
s_xor_b32 s91,s72,0x10000
s_waitcnt lgkmcnt(0)
v_cmp_gt_u32 vcc,s71,v2
s_cbranch_vccz nb_323
s_waitcnt vmcnt(2)
v_cmp_gt_u32 vcc,s71,v29
s_cbranch_vccz nb_323
s_waitcnt vmcnt(0)
v_add_u32 v22,s71,-1
buffer_store_dword v22,v23,s[20:23],s97 offen sc1
s_mov_b32 s97,0x7fff0000
s_cmp_lg_u32 s50,0
s_cbranch_scc1 nb_323
buffer_load_dword v32,v21,s[20:23],s74 offen sc1
s_sleep 2
pl_324:
buffer_load_dword v33,v21,s[20:23],s74 offen sc1
s_waitcnt vmcnt(1)
v_cmp_gt_u32 vcc,s71,v32
s_cbranch_vccz pok_325
buffer_load_dword v32,v21,s[20:23],s74 offen sc1
s_waitcnt vmcnt(1)
v_cmp_gt_u32 vcc,s71,v33
s_cbranch_vccz pok_325
s_sub_u32 s90,s90,1
s_cmp_gt_i32 s90,0
s_cbranch_scc1 pl_324
pok_325:
nb_323:
s_barrier
s_xor_b32 m0,s91,0
s_add_u32 s65,s94,0
buffer_load_dwordx4 v16,s[20:23],s65 offen offset:0 sc1 lds
buffer_load_dwordx4 v16,s[20:23],s65 offen offset:2048 sc1 lds
ds_read_b32 v44,v45
s_xor_b32 m0,s91,16384
s_add_u32 s65,s94,32768
buffer_load_dwordx4 v16,s[20:23],s65 offen offset:0 sc1 lds
buffer_load_dwordx4 v16,s[20:23],s65 offen offset:2048 sc1 lds
s_xor_b32 m0,s91,32768
s_add_u32 s65,s94,65536
buffer_load_dwordx4 v16,s[20:23],s65 offen offset:0 sc1 lds
buffer_load_dwordx4 v16,s[20:23],s65 offen offset:2048 sc1 lds
s_xor_b32 m0,s91,49152
s_add_u32 s65,s94,98304
buffer_load_dwordx4 v16,s[20:23],s65 offen offset:0 sc1 lds
buffer_load_dwordx4 v16,s[20:23],s65 offen offset:2048 sc1 lds
s_add_u32 s66,s94,110592
buffer_load_dwordx4 v[128:131],v16,s[20:23],s66 offen offset:0 sc1
buffer_load_dwordx4 v[132:135],v16,s[20:23],s66 offen offset:1024 sc1
buffer_load_dwordx4 v[136:139],v16,s[20:23],s66 offen offset:2048 sc1
buffer_load_dwordx4 v[140:143],v16,s[20:23],s66 offen offset:3072 sc1
s_add_u32 s66,s94,114688
buffer_load_dwordx4 v[144:147],v16,s[20:23],s66 offen offset:0 sc1
buffer_load_dwordx4 v[148:151],v16,s[20:23],s66 offen offset:1024 sc1
buffer_load_dwordx4 v[152:155],v16,s[20:23],s66 offen offset:2048 sc1
buffer_load_dwordx4 v[156:159],v16,s[20:23],s66 offen offset:3072 sc1
s_waitcnt vmcnt(16)
v_add_u32 v22,s71,-1
buffer_store_dword v22,v23,s[20:23],s97 offen sc1
s_mov_b32 s97,0x7fff0000
s_waitcnt lgkmcnt(0)
v_readfirstlane_b32 s83,v44
s_cmp_eq_u32 s83,0
s_cbranch_scc1 both_322
s_waitcnt vmcnt(15)
s_barrier
ds_read_b128 v[224:227],v17 offset:0
ds_read_b128 v[228:231],v17 offset:2048
ds_read_b128 v[232:235],v17 offset:4096
ds_read_b128 v[236:239],v17 offset:6144
ds_read_b128 v[240:243],v17 offset:8192
ds_read_b128 v[244:247],v17 offset:10240
ds_read_b128 v[248:251],v17 offset:12288
s_waitcnt lgkmcnt(5)
v_mfma_f32_16x16x32_bf16 v[64:67],a[0:3],v[224:227],0
ds_read_b128 v[252:255],v17 offset:14336
v_min_u32 v27,v224,v228
s_xor_b32 m0,s91,1024
s_add_u32 s65,s95,0
buffer_load_dwordx4 v16,s[20:23],s65 offen offset:0 sc1 lds
v_mfma_f32_16x16x32_bf16 v[72:75],a[4:7],v[228:231],0
s_waitcnt vmcnt(14)
s_barrier
ds_read_b128 v[224:227],v17 offset:16384
buffer_load_dwordx4 v16,s[20:23],s65 offen offset:2048 sc1 lds
s_xor_b32 m0,s91,17408
s_waitcnt lgkmcnt(5)
v_mfma_f32_16x16x32_bf16 v[64:67],a[8:11],v[232:235],v[64:67]
ds_read_b128 v[228:231],v17 offset:18432
v_min3_u32 v27,v27,v232,v236
s_add_u32 s65,s95,32768
buffer_load_dwordx4 v16,s[20:23],s65 offen offset:0 sc1 lds
buffer_load_dwordx4 v16,s[20:23],s65 offen offset:2048 sc1 lds
v_mfma_f32_16x16x32_bf16 v[72:75],a[12:15],v[236:239],v[72:75]
ds_read_b128 v[232:235],v17 offset:20480
s_xor_b32 m0,s91,33792
s_add_u32 s65,s95,65536
buffer_load_dwordx4 v16,s[20:23],s65 offen offset:0 sc1 lds
s_waitcnt lgkmcnt(5)
v_mfma_f32_16x16x32_bf16 v[64:67],a[16:19],v[240:243],v[64:67]
ds_read_b128 v[236:239],v17 offset:22528
v_min3_u32 v27,v27,v240,v244
buffer_load_dwordx4 v16,s[20:23],s65 offen offset:2048 sc1 lds
s_xor_b32 m0,s91,50176
s_add_u32 s65,s95,98304
v_mfma_f32_16x16x32_bf16 v[72:75],a[20:23],v[244:247],v[72:75]
ds_read_b128 v[240:243],v17 offset:24576
buffer_load_dwordx4 v16,s[20:23],s65 offen offset:0 sc1 lds
buffer_load_dwordx4 v16,s[20:23],s65 offen offset:2048 sc1 lds
s_waitcnt lgkmcnt(5)
v_mfma_f32_16x16x32_bf16 v[64:67],a[24:27],v[248:251],v[64:67]
ds_read_b128 v[244:247],v17 offset:26624
v_min3_u32 v27,v27,v248,v252
v_mfma_f32_16x16x32_bf16 v[72:75],a[28:31],v[252:255],v[72:75]
ds_read_b128 v[248:251],v17 offset:28672
s_waitcnt lgkmcnt(5)
v_mfma_f32_16x16x32_bf16 v[64:67],a[32:35],v[224:227],v[64:67]
ds_read_b128 v[252:255],v17 offset:30720
v_min3_u32 v27,v27,v224,v228
v_mfma_f32_16x16x32_bf16 v[72:75],a[36:39],v[228:231],v[72:75]
s_waitcnt vmcnt(17)
s_barrier
ds_read_b128 v[224:227],v17 offset:32768
s_waitcnt lgkmcnt(5)
v_mfma_f32_16x16x32_bf16 v[64:67],a[40:43],v[232:235],v[64:67]
ds_read_b128 v[228:231],v17 offset:34816
v_min3_u32 v27,v27,v232,v236
v_mfma_f32_16x16x32_bf16 v[72:75],a[44:47],v[236:239],v[72:75]
ds_read_b128 v[232:235],v17 offset:36864
s_waitcnt lgkmcnt(5)
v_mfma_f32_16x16x32_bf16 v[64:67],a[48:51],v[240:243],v[64:67]
ds_read_b128 v[236:239],v17 offset:38912
v_min3_u32 v27,v27,v240,v244
v_mfma_f32_16x16x32_bf16 v[72:75],a[52:55],v[244:247],v[72:75]
ds_read_b128 v[240:243],v17 offset:40960
s_waitcnt lgkmcnt(5)
v_mfma_f32_16x16x32_bf16 v[64:67],a[56:59],v[248:251],v[64:67]
ds_read_b128 v[244:247],v17 offset:43008
v_min3_u32 v27,v27,v248,v252
v_mfma_f32_16x16x32_bf16 v[72:75],a[60:63],v[252:255],v[72:75]
ds_read_b128 v[248:251],v17 offset:45056
s_waitcnt lgkmcnt(5)
v_mfma_f32_16x16x32_bf16 v[64:67],a[64:67],v[224:227],v[64:67]
ds_read_b128 v[252:255],v17 offset:47104
v_min3_u32 v27,v27,v224,v228
v_mfma_f32_16x16x32_bf16 v[72:75],a[68:71],v[228:231],v[72:75]
ds_read_b128 v[224:227],v17 offset:49152
s_waitcnt lgkmcnt(5)
v_mfma_f32_16x16x32_bf16 v[64:67],a[72:75],v[232:235],v[64:67]
ds_read_b128 v[228:231],v17 offset:51200
v_min3_u32 v27,v27,v232,v236
v_mfma_f32_16x16x32_bf16 v[72:75],a[76:79],v[236:239],v[72:75]
ds_read_b128 v[232:235],v17 offset:53248
s_waitcnt lgkmcnt(5)
v_mfma_f32_16x16x32_bf16 v[64:67],a[80:83],v[240:243],v[64:67]
ds_read_b128 v[236:239],v17 offset:55296
v_min3_u32 v27,v27,v240,v244
v_mfma_f32_16x16x32_bf16 v[72:75],a[84:87],v[244:247],v[72:75]
ds_read_b128 v[240:243],v17 offset:57344
s_waitcnt lgkmcnt(5)
v_mfma_f32_16x16x32_bf16 v[64:67],a[88:91],v[248:251],v[64:67]
ds_read_b128 v[244:247],v17 offset:59392
v_min3_u32 v27,v27,v248,v252
v_mfma_f32_16x16x32_bf16 v[72:75],a[92:95],v[252:255],v[72:75]
ds_read_b128 v[248:251],v17 offset:61440
s_waitcnt vmcnt(9)
stk_328:
v_min3_u32 v22,v129,v133,v137
v_min3_u32 v22,v22,v141,v145
v_min3_u32 v22,v22,v149,v153
v_min_u32 v22,v22,v157
v_cmp_eq_u32 vcc,0,v22
s_cmp_lt_i32 s90,0
s_cselect_b64 vcc,0,vcc
s_cbranch_vccnz str_329
v_pk_add_f32 v[88:89],v[128:129],v[144:145]
v_pk_add_f32 v[90:91],v[130:131],v[146:147]
v_pk_add_f32 v[92:93],v[132:133],v[148:149]
v_pk_add_f32 v[94:95],v[134:135],v[150:151]
v_pk_add_f32 v[96:97],v[136:137],v[152:153]
v_pk_add_f32 v[98:99],v[138:139],v[154:155]
v_pk_add_f32 v[100:101],v[140:141],v[156:157]
v_pk_add_f32 v[102:103],v[142:143],v[158:159]
v_pk_add_f32 v[88:89],v[88:89],v[96:97]
v_pk_add_f32 v[90:91],v[90:91],v[98:99]
v_pk_add_f32 v[92:93],v[92:93],v[100:101]
v_pk_add_f32 v[94:95],v[94:95],v[102:103]
v_pk_add_f32 v[88:89],v[88:89],v[92:93]
v_pk_add_f32 v[90:91],v[90:91],v[94:95]
v_mov_b32 v92,v88
v_mov_b32 v93,v89
v_mov_b32 v94,v90
v_mov_b32 v95,v91
v_permlane16_swap_b32 v92,v88
v_permlane16_swap_b32 v93,v89
v_permlane16_swap_b32 v94,v90
v_permlane16_swap_b32 v95,v91
v_pk_add_f32 v[88:89],v[88:89],v[92:93]
v_pk_add_f32 v[90:91],v[90:91],v[94:95]
v_mov_b32 v92,v88
v_mov_b32 v93,v89
s_waitcnt lgkmcnt(5)
v_mfma_f32_16x16x32_bf16 v[64:67],a[96:99],v[224:227],v[64:67]
ds_read_b128 v[252:255],v17 offset:63488
v_min3_u32 v27,v27,v224,v228
v_mov_b32 v94,v90
v_mov_b32 v95,v91
v_permlane32_swap_b32 v92,v88
v_permlane32_swap_b32 v93,v89
v_permlane32_swap_b32 v94,v90
v_permlane32_swap_b32 v95,v91
v_pk_add_f32 v[88:89],v[88:89],v[92:93]
v_pk_add_f32 v[90:91],v[90:91],v[94:95]
v_mul_f32 v120,0xba800000,v88
v_mul_f32 v124,0xba800000,v90
v_mul_f32 v92,v120,v120
v_mul_f32 v93,v124,v124
v_fma_f32 v92,v89,s82,-v92
v_fma_f32 v93,v91,s82,-v93
v_max_f32 v92,0,v92
v_max_f32 v93,0,v93
v_add_f32 v92,0x3727c5ac,v92
v_add_f32 v93,0x3727c5ac,v93
v_rsq_f32 v94,v92
v_rsq_f32 v95,v93
v_mul_f32 v123,v92,v94
v_mul_f32 v127,v93,v95
v_mul_f32 v122,v28,v94
v_mul_f32 v126,v28,v95
v_mul_f32 v92,v94,v94
v_mul_f32 v93,v95,v95
v_mul_f32 v94,s81,v94
v_mul_f32 v95,s81,v95
v_mul_f32 v121,v92,v94
v_mul_f32 v125,v93,v95
ds_write_b128 v19,v[120:123] offset:0
ds_write_b128 v19,v[124:127] offset:256
v_mfma_f32_16x16x32_bf16 v[72:75],a[100:103],v[228:231],v[72:75]
s_waitcnt vmcnt(0) lgkmcnt(0)
s_barrier
ds_read_b128 v[224:227],v17 offset:1024
v_mfma_f32_16x16x32_bf16 v[64:67],a[104:107],v[232:235],v[64:67]
ds_read_b128 v[228:231],v17 offset:3072
v_min3_u32 v27,v27,v232,v236
v_mfma_f32_16x16x32_bf16 v[72:75],a[108:111],v[236:239],v[72:75]
ds_read_b128 v[232:235],v17 offset:5120
v_mfma_f32_16x16x32_bf16 v[64:67],a[112:115],v[240:243],v[64:67]
ds_read_b128 v[236:239],v17 offset:7168
v_min3_u32 v27,v27,v240,v244
v_mfma_f32_16x16x32_bf16 v[72:75],a[116:119],v[244:247],v[72:75]
ds_read_b128 v[240:243],v17 offset:9216
v_mfma_f32_16x16x32_bf16 v[64:67],a[120:123],v[248:251],v[64:67]
ds_read_b128 v[244:247],v17 offset:11264
v_min3_u32 v27,v27,v248,v252
v_mfma_f32_16x16x32_bf16 v[72:75],a[124:127],v[252:255],v[72:75]
ds_read_b128 v[248:251],v17 offset:13312
buffer_load_dword v2,v21,s[20:23],s87 offen sc1
s_add_u32 s96,s71,2
s_waitcnt lgkmcnt(5)
v_mfma_f32_16x16x32_bf16 v[68:71],a[0:3],v[224:227],0
ds_read_b128 v[252:255],v17 offset:15360
v_cmp_eq_u32 vcc,0,v27
s_cbranch_vccnz retry_318
v_min3_u32 v27,v27,v224,v228
v_mfma_f32_16x16x32_bf16 v[76:79],a[4:7],v[228:231],0
ds_read_b128 v[224:227],v17 offset:17408
s_waitcnt lgkmcnt(5)
v_mfma_f32_16x16x32_bf16 v[68:71],a[8:11],v[232:235],v[68:71]
ds_read_b128 v[228:231],v17 offset:19456
v_min3_u32 v27,v27,v232,v236
v_mfma_f32_16x16x32_bf16 v[76:79],a[12:15],v[236:239],v[76:79]
ds_read_b128 v[232:235],v17 offset:21504
s_waitcnt lgkmcnt(5)
v_mfma_f32_16x16x32_bf16 v[68:71],a[16:19],v[240:243],v[68:71]
ds_read_b128 v[236:239],v17 offset:23552
v_min3_u32 v27,v27,v240,v244
v_add_f32 v64,v64,v72
v_add_f32 v65,v65,v73
v_add_f32 v66,v66,v74
v_add_f32 v67,v67,v75
v_mfma_f32_16x16x32_bf16 v[76:79],a[20:23],v[244:247],v[76:79]
ds_read_b128 v[240:243],v17 offset:25600
v_fmac_f32 v64,v52,v120
v_fmac_f32 v65,v53,v120
v_fmac_f32 v66,v54,v120
v_fmac_f32 v67,v55,v120
s_waitcnt lgkmcnt(5)
v_mfma_f32_16x16x32_bf16 v[68:71],a[24:27],v[248:251],v[68:71]
ds_read_b128 v[244:247],v17 offset:27648
v_min3_u32 v27,v27,v248,v252
v_mul_f32 v88,v64,v64
v_mul_f32 v89,v65,v65
v_mul_f32 v90,v66,v66
v_mul_f32 v91,v67,v67
v_mfma_f32_16x16x32_bf16 v[76:79],a[28:31],v[252:255],v[76:79]
ds_read_b128 v[248:251],v17 offset:29696
v_fma_f32 v88,v88,v121,v122
v_fma_f32 v89,v89,v121,v122
v_fma_f32 v90,v90,v121,v122
v_fma_f32 v91,v91,v121,v122
s_waitcnt lgkmcnt(5)
v_mfma_f32_16x16x32_bf16 v[68:71],a[32:35],v[224:227],v[68:71]
ds_read_b128 v[252:255],v17 offset:31744
v_min3_u32 v27,v27,v224,v228
v_mul_f32 v88,v88,v64
v_mul_f32 v89,v89,v65
v_mul_f32 v90,v90,v66
v_mul_f32 v91,v91,v67
v_mfma_f32_16x16x32_bf16 v[76:79],a[36:39],v[228:231],v[76:79]
ds_read_b128 v[224:227],v17 offset:33792
v_exp_f32 v88,v88
v_exp_f32 v89,v89
s_waitcnt lgkmcnt(5)
v_mfma_f32_16x16x32_bf16 v[68:71],a[40:43],v[232:235],v[68:71]
ds_read_b128 v[228:231],v17 offset:35840
v_min3_u32 v27,v27,v232,v236
v_exp_f32 v90,v90
v_exp_f32 v91,v91
v_mfma_f32_16x16x32_bf16 v[76:79],a[44:47],v[236:239],v[76:79]
ds_read_b128 v[232:235],v17 offset:37888
v_fma_f32 v88,v88,v123,v123
v_fma_f32 v89,v89,v123,v123
v_fma_f32 v90,v90,v123,v123
v_fma_f32 v91,v91,v123,v123
s_waitcnt lgkmcnt(5)
v_mfma_f32_16x16x32_bf16 v[68:71],a[48:51],v[240:243],v[68:71]
ds_read_b128 v[236:239],v17 offset:39936
v_min3_u32 v27,v27,v240,v244
v_rcp_f32 v88,v88
v_rcp_f32 v89,v89
v_mfma_f32_16x16x32_bf16 v[76:79],a[52:55],v[244:247],v[76:79]
ds_read_b128 v[240:243],v17 offset:41984
v_rcp_f32 v90,v90
v_rcp_f32 v91,v91
s_waitcnt lgkmcnt(5)
v_mfma_f32_16x16x32_bf16 v[68:71],a[56:59],v[248:251],v[68:71]
ds_read_b128 v[244:247],v17 offset:44032
v_min3_u32 v27,v27,v248,v252
v_mul_f32 v88,v88,v64
v_mul_f32 v89,v89,v65
v_mul_f32 v90,v90,v66
v_mul_f32 v91,v91,v67
v_mfma_f32_16x16x32_bf16 v[76:79],a[60:63],v[252:255],v[76:79]
ds_read_b128 v[248:251],v17 offset:46080
v_cvt_pk_bf16_f32 v96,v88,v89
v_cvt_pk_bf16_f32 v97,v90,v91
v_max_u32 v96,1,v96
s_waitcnt lgkmcnt(5)
v_mfma_f32_16x16x32_bf16 v[68:71],a[64:67],v[224:227],v[68:71]
ds_read_b128 v[252:255],v17 offset:48128
v_min3_u32 v27,v27,v224,v228
buffer_store_dwordx2 v[96:97],v18,s[20:23],s70 offen offset:0 sc1
v_mfma_f32_16x16x32_bf16 v[76:79],a[68:71],v[228:231],v[76:79]
ds_read_b128 v[224:227],v17 offset:50176
s_waitcnt lgkmcnt(5)
v_mfma_f32_16x16x32_bf16 v[68:71],a[72:75],v[232:235],v[68:71]
ds_read_b128 v[228:231],v17 offset:52224
v_min3_u32 v27,v27,v232,v236
v_mfma_f32_16x16x32_bf16 v[76:79],a[76:79],v[236:239],v[76:79]
ds_read_b128 v[232:235],v17 offset:54272
s_waitcnt lgkmcnt(5)
v_mfma_f32_16x16x32_bf16 v[68:71],a[80:83],v[240:243],v[68:71]
ds_read_b128 v[236:239],v17 offset:56320
v_min3_u32 v27,v27,v240,v244
v_mfma_f32_16x16x32_bf16 v[76:79],a[84:87],v[244:247],v[76:79]
ds_read_b128 v[240:243],v17 offset:58368
s_waitcnt lgkmcnt(5)
v_mfma_f32_16x16x32_bf16 v[68:71],a[88:91],v[248:251],v[68:71]
ds_read_b128 v[244:247],v17 offset:60416
v_min3_u32 v27,v27,v248,v252
v_mfma_f32_16x16x32_bf16 v[76:79],a[92:95],v[252:255],v[76:79]
ds_read_b128 v[248:251],v17 offset:62464
s_waitcnt lgkmcnt(5)
v_mfma_f32_16x16x32_bf16 v[68:71],a[96:99],v[224:227],v[68:71]
ds_read_b128 v[252:255],v17 offset:64512
v_min3_u32 v27,v27,v224,v228
v_mfma_f32_16x16x32_bf16 v[76:79],a[100:103],v[228:231],v[76:79]
s_waitcnt lgkmcnt(4)
v_mfma_f32_16x16x32_bf16 v[68:71],a[104:107],v[232:235],v[68:71]
v_min3_u32 v27,v27,v232,v236
s_waitcnt vmcnt(1)
v_cmp_gt_u32 vcc,s96,v2
s_mov_b32 s96,vcc_lo
v_mov_b32 v44,s96
ds_write_b32 v46,v44
v_mfma_f32_16x16x32_bf16 v[76:79],a[108:111],v[236:239],v[76:79]
s_waitcnt lgkmcnt(3)
v_mfma_f32_16x16x32_bf16 v[68:71],a[112:115],v[240:243],v[68:71]
v_min3_u32 v27,v27,v240,v244
v_mfma_f32_16x16x32_bf16 v[76:79],a[116:119],v[244:247],v[76:79]
s_waitcnt lgkmcnt(1)
v_mfma_f32_16x16x32_bf16 v[68:71],a[120:123],v[248:251],v[68:71]
v_min3_u32 v27,v27,v248,v252
v_mfma_f32_16x16x32_bf16 v[76:79],a[124:127],v[252:255],v[76:79]
v_cmp_eq_u32 vcc,0,v27
s_cbranch_vccnz retry_318
s_branch epi_321
both_322:
s_waitcnt vmcnt(15)
s_barrier
ds_read_b128 v[224:227],v17 offset:0
ds_read_b128 v[228:231],v17 offset:2048
ds_read_b128 v[232:235],v17 offset:4096
ds_read_b128 v[236:239],v17 offset:6144
ds_read_b128 v[240:243],v17 offset:8192
ds_read_b128 v[244:247],v17 offset:10240
ds_read_b128 v[248:251],v17 offset:12288
s_waitcnt lgkmcnt(5)
v_mfma_f32_16x16x32_bf16 v[64:67],a[0:3],v[224:227],0
ds_read_b128 v[252:255],v17 offset:14336
s_xor_b32 m0,s91,1024
s_add_u32 s65,s95,0
buffer_load_dwordx4 v16,s[20:23],s65 offen offset:0 sc1 lds
buffer_load_dwordx4 v16,s[20:23],s65 offen offset:2048 sc1 lds
v_min_u32 v27,v224,v228
v_mfma_f32_16x16x32_bf16 v[72:75],a[4:7],v[228:231],0
s_waitcnt vmcnt(15)
s_barrier
ds_read_b128 v[224:227],v17 offset:16384
s_xor_b32 m0,s91,17408
s_add_u32 s65,s95,32768
s_add_u32 s88,s70,s75
s_waitcnt lgkmcnt(5)
v_mfma_f32_16x16x32_bf16 v[64:67],a[8:11],v[232:235],v[64:67]
ds_read_b128 v[228:231],v17 offset:18432
buffer_load_dwordx4 v16,s[20:23],s65 offen offset:0 sc1 lds
buffer_load_dwordx4 v16,s[20:23],s65 offen offset:2048 sc1 lds
s_xor_b32 m0,s91,33792
s_add_u32 s88,s88,2097152
v_min3_u32 v27,v27,v232,v236
v_mfma_f32_16x16x32_bf16 v[72:75],a[12:15],v[236:239],v[72:75]
ds_read_b128 v[232:235],v17 offset:20480
s_add_u32 s65,s95,65536
buffer_load_dwordx4 v16,s[20:23],s65 offen offset:0 sc1 lds
s_xor_b32 s88,s88,0x2000
s_waitcnt lgkmcnt(5)
v_mfma_f32_16x16x32_bf16 v[64:67],a[16:19],v[240:243],v[64:67]
ds_read_b128 v[236:239],v17 offset:22528
buffer_load_dwordx4 v16,s[20:23],s65 offen offset:2048 sc1 lds
s_xor_b32 m0,s91,50176
s_add_u32 s65,s95,98304
s_xor_b32 s89,s88,1024
v_min3_u32 v27,v27,v240,v244
v_mfma_f32_16x16x32_bf16 v[72:75],a[20:23],v[244:247],v[72:75]
ds_read_b128 v[240:243],v17 offset:24576
buffer_load_dwordx4 v16,s[20:23],s65 offen offset:0 sc1 lds
buffer_load_dwordx4 v16,s[20:23],s65 offen offset:2048 sc1 lds
s_waitcnt lgkmcnt(5)
v_mfma_f32_16x16x32_bf16 v[64:67],a[24:27],v[248:251],v[64:67]
ds_read_b128 v[244:247],v17 offset:26624
v_min3_u32 v27,v27,v248,v252
v_mfma_f32_16x16x32_bf16 v[72:75],a[28:31],v[252:255],v[72:75]
ds_read_b128 v[248:251],v17 offset:28672
s_waitcnt lgkmcnt(5)
v_mfma_f32_16x16x32_bf16 v[64:67],a[32:35],v[224:227],v[64:67]
ds_read_b128 v[252:255],v17 offset:30720
v_min3_u32 v27,v27,v224,v228
v_mfma_f32_16x16x32_bf16 v[72:75],a[36:39],v[228:231],v[72:75]
s_waitcnt vmcnt(17)
s_barrier
ds_read_b128 v[224:227],v17 offset:32768
s_waitcnt lgkmcnt(5)
v_mfma_f32_16x16x32_bf16 v[64:67],a[40:43],v[232:235],v[64:67]
ds_read_b128 v[228:231],v17 offset:34816
v_min3_u32 v27,v27,v232,v236
v_mfma_f32_16x16x32_bf16 v[72:75],a[44:47],v[236:239],v[72:75]
ds_read_b128 v[232:235],v17 offset:36864
s_waitcnt lgkmcnt(5)
v_mfma_f32_16x16x32_bf16 v[64:67],a[48:51],v[240:243],v[64:67]
ds_read_b128 v[236:239],v17 offset:38912
v_min3_u32 v27,v27,v240,v244
v_mfma_f32_16x16x32_bf16 v[72:75],a[52:55],v[244:247],v[72:75]
ds_read_b128 v[240:243],v17 offset:40960
s_waitcnt lgkmcnt(5)
v_mfma_f32_16x16x32_bf16 v[64:67],a[56:59],v[248:251],v[64:67]
ds_read_b128 v[244:247],v17 offset:43008
v_min3_u32 v27,v27,v248,v252
v_mfma_f32_16x16x32_bf16 v[72:75],a[60:63],v[252:255],v[72:75]
ds_read_b128 v[248:251],v17 offset:45056
s_waitcnt lgkmcnt(5)
v_mfma_f32_16x16x32_bf16 v[64:67],a[64:67],v[224:227],v[64:67]
ds_read_b128 v[252:255],v17 offset:47104
v_min3_u32 v27,v27,v224,v228
v_mfma_f32_16x16x32_bf16 v[72:75],a[68:71],v[228:231],v[72:75]
ds_read_b128 v[224:227],v17 offset:49152
s_waitcnt lgkmcnt(5)
v_mfma_f32_16x16x32_bf16 v[64:67],a[72:75],v[232:235],v[64:67]
ds_read_b128 v[228:231],v17 offset:51200
v_min3_u32 v27,v27,v232,v236
v_mfma_f32_16x16x32_bf16 v[72:75],a[76:79],v[236:239],v[72:75]
ds_read_b128 v[232:235],v17 offset:53248
s_waitcnt lgkmcnt(5)
v_mfma_f32_16x16x32_bf16 v[64:67],a[80:83],v[240:243],v[64:67]
ds_read_b128 v[236:239],v17 offset:55296
v_min3_u32 v27,v27,v240,v244
v_mfma_f32_16x16x32_bf16 v[72:75],a[84:87],v[244:247],v[72:75]
ds_read_b128 v[240:243],v17 offset:57344
s_waitcnt lgkmcnt(5)
v_mfma_f32_16x16x32_bf16 v[64:67],a[88:91],v[248:251],v[64:67]
ds_read_b128 v[244:247],v17 offset:59392
v_min3_u32 v27,v27,v248,v252
v_mfma_f32_16x16x32_bf16 v[72:75],a[92:95],v[252:255],v[72:75]
ds_read_b128 v[248:251],v17 offset:61440
s_waitcnt vmcnt(9)
stk_330:
v_min3_u32 v22,v129,v133,v137
v_min3_u32 v22,v22,v141,v145
v_min3_u32 v22,v22,v149,v153
v_min_u32 v22,v22,v157
v_cmp_eq_u32 vcc,0,v22
s_cmp_lt_i32 s90,0
s_cselect_b64 vcc,0,vcc
s_cbranch_vccnz str_331
v_pk_add_f32 v[88:89],v[128:129],v[144:145]
v_pk_add_f32 v[90:91],v[130:131],v[146:147]
v_pk_add_f32 v[92:93],v[132:133],v[148:149]
v_pk_add_f32 v[94:95],v[134:135],v[150:151]
v_pk_add_f32 v[96:97],v[136:137],v[152:153]
v_pk_add_f32 v[98:99],v[138:139],v[154:155]
v_pk_add_f32 v[100:101],v[140:141],v[156:157]
v_pk_add_f32 v[102:103],v[142:143],v[158:159]
v_pk_add_f32 v[88:89],v[88:89],v[96:97]
v_pk_add_f32 v[90:91],v[90:91],v[98:99]
v_pk_add_f32 v[92:93],v[92:93],v[100:101]
v_pk_add_f32 v[94:95],v[94:95],v[102:103]
v_pk_add_f32 v[88:89],v[88:89],v[92:93]
v_pk_add_f32 v[90:91],v[90:91],v[94:95]
v_mov_b32 v92,v88
v_mov_b32 v93,v89
v_mov_b32 v94,v90
v_mov_b32 v95,v91
v_permlane16_swap_b32 v92,v88
v_permlane16_swap_b32 v93,v89
v_permlane16_swap_b32 v94,v90
v_permlane16_swap_b32 v95,v91
v_pk_add_f32 v[88:89],v[88:89],v[92:93]
v_pk_add_f32 v[90:91],v[90:91],v[94:95]
v_mov_b32 v92,v88
v_mov_b32 v93,v89
s_waitcnt lgkmcnt(5)
v_mfma_f32_16x16x32_bf16 v[64:67],a[96:99],v[224:227],v[64:67]
ds_read_b128 v[252:255],v17 offset:63488
v_min3_u32 v27,v27,v224,v228
v_mov_b32 v94,v90
v_mov_b32 v95,v91
v_permlane32_swap_b32 v92,v88
v_permlane32_swap_b32 v93,v89
v_permlane32_swap_b32 v94,v90
v_permlane32_swap_b32 v95,v91
v_pk_add_f32 v[88:89],v[88:89],v[92:93]
v_pk_add_f32 v[90:91],v[90:91],v[94:95]
v_mul_f32 v120,0xba800000,v88
v_mul_f32 v124,0xba800000,v90
v_mul_f32 v92,v120,v120
v_mul_f32 v93,v124,v124
v_fma_f32 v92,v89,s82,-v92
v_fma_f32 v93,v91,s82,-v93
v_max_f32 v92,0,v92
v_max_f32 v93,0,v93
v_add_f32 v92,0x3727c5ac,v92
v_add_f32 v93,0x3727c5ac,v93
v_rsq_f32 v94,v92
v_rsq_f32 v95,v93
v_mul_f32 v123,v92,v94
v_mul_f32 v127,v93,v95
v_mul_f32 v122,v28,v94
v_mul_f32 v126,v28,v95
v_mul_f32 v92,v94,v94
v_mul_f32 v93,v95,v95
v_mul_f32 v94,s81,v94
v_mul_f32 v95,s81,v95
v_mul_f32 v121,v92,v94
v_mul_f32 v125,v93,v95
ds_write_b128 v19,v[120:123] offset:0
ds_write_b128 v19,v[124:127] offset:256
v_mfma_f32_16x16x32_bf16 v[72:75],a[100:103],v[228:231],v[72:75]
s_waitcnt vmcnt(0) lgkmcnt(0)
s_barrier
ds_read_b128 v[224:227],v17 offset:1024
v_mfma_f32_16x16x32_bf16 v[64:67],a[104:107],v[232:235],v[64:67]
ds_read_b128 v[228:231],v17 offset:3072
v_min3_u32 v27,v27,v232,v236
s_add_u32 s66,s88,110592
buffer_load_dwordx4 v[128:131],v16,s[20:23],s66 offen offset:0 sc1
v_mfma_f32_16x16x32_bf16 v[72:75],a[108:111],v[236:239],v[72:75]
ds_read_b128 v[232:235],v17 offset:5120
buffer_load_dwordx4 v[132:135],v16,s[20:23],s66 offen offset:1024 sc1
buffer_load_dwordx4 v[136:139],v16,s[20:23],s66 offen offset:2048 sc1
v_mfma_f32_16x16x32_bf16 v[64:67],a[112:115],v[240:243],v[64:67]
ds_read_b128 v[236:239],v17 offset:7168
v_min3_u32 v27,v27,v240,v244
buffer_load_dwordx4 v[140:143],v16,s[20:23],s66 offen offset:3072 sc1
v_mfma_f32_16x16x32_bf16 v[72:75],a[116:119],v[244:247],v[72:75]
ds_read_b128 v[240:243],v17 offset:9216
s_add_u32 s66,s88,114688
buffer_load_dwordx4 v[144:147],v16,s[20:23],s66 offen offset:0 sc1
v_mfma_f32_16x16x32_bf16 v[64:67],a[120:123],v[248:251],v[64:67]
ds_read_b128 v[244:247],v17 offset:11264
v_min3_u32 v27,v27,v248,v252
buffer_load_dwordx4 v[148:151],v16,s[20:23],s66 offen offset:1024 sc1
buffer_load_dwordx4 v[152:155],v16,s[20:23],s66 offen offset:2048 sc1
v_mfma_f32_16x16x32_bf16 v[72:75],a[124:127],v[252:255],v[72:75]
ds_read_b128 v[248:251],v17 offset:13312
buffer_load_dword v2,v21,s[20:23],s87 offen sc1
s_add_u32 s96,s71,2
s_waitcnt lgkmcnt(5)
v_mfma_f32_16x16x32_bf16 v[68:71],a[0:3],v[224:227],0
ds_read_b128 v[252:255],v17 offset:15360
v_cmp_eq_u32 vcc,0,v27
s_cbranch_vccnz retry_318
v_min3_u32 v27,v27,v224,v228
buffer_load_dwordx4 v[156:159],v16,s[20:23],s66 offen offset:3072 sc1
v_mfma_f32_16x16x32_bf16 v[76:79],a[4:7],v[228:231],0
ds_read_b128 v[224:227],v17 offset:17408
s_xor_b32 m0,s72,0
s_add_u32 s65,s88,0
buffer_load_dwordx4 v16,s[20:23],s65 offen offset:0 sc1 lds
s_waitcnt lgkmcnt(5)
v_mfma_f32_16x16x32_bf16 v[68:71],a[8:11],v[232:235],v[68:71]
ds_read_b128 v[228:231],v17 offset:19456
v_min3_u32 v27,v27,v232,v236
buffer_load_dwordx4 v16,s[20:23],s65 offen offset:2048 sc1 lds
s_xor_b32 m0,s72,16384
s_add_u32 s65,s88,32768
v_mfma_f32_16x16x32_bf16 v[76:79],a[12:15],v[236:239],v[76:79]
ds_read_b128 v[232:235],v17 offset:21504
buffer_load_dwordx4 v16,s[20:23],s65 offen offset:0 sc1 lds
buffer_load_dwordx4 v16,s[20:23],s65 offen offset:2048 sc1 lds
s_waitcnt lgkmcnt(5)
v_mfma_f32_16x16x32_bf16 v[68:71],a[16:19],v[240:243],v[68:71]
ds_read_b128 v[236:239],v17 offset:23552
v_min3_u32 v27,v27,v240,v244
v_add_f32 v64,v64,v72
v_add_f32 v65,v65,v73
v_add_f32 v66,v66,v74
v_add_f32 v67,v67,v75
v_mfma_f32_16x16x32_bf16 v[76:79],a[20:23],v[244:247],v[76:79]
ds_read_b128 v[240:243],v17 offset:25600
v_fmac_f32 v64,v52,v120
v_fmac_f32 v65,v53,v120
v_fmac_f32 v66,v54,v120
v_fmac_f32 v67,v55,v120
s_waitcnt lgkmcnt(5)
v_mfma_f32_16x16x32_bf16 v[68:71],a[24:27],v[248:251],v[68:71]
ds_read_b128 v[244:247],v17 offset:27648
v_min3_u32 v27,v27,v248,v252
v_mul_f32 v88,v64,v64
v_mul_f32 v89,v65,v65
v_mul_f32 v90,v66,v66
v_mul_f32 v91,v67,v67
v_mfma_f32_16x16x32_bf16 v[76:79],a[28:31],v[252:255],v[76:79]
ds_read_b128 v[248:251],v17 offset:29696
v_fma_f32 v88,v88,v121,v122
v_fma_f32 v89,v89,v121,v122
v_fma_f32 v90,v90,v121,v122
v_fma_f32 v91,v91,v121,v122
s_waitcnt lgkmcnt(5)
v_mfma_f32_16x16x32_bf16 v[68:71],a[32:35],v[224:227],v[68:71]
ds_read_b128 v[252:255],v17 offset:31744
v_min3_u32 v27,v27,v224,v228
v_mul_f32 v88,v88,v64
v_mul_f32 v89,v89,v65
v_mul_f32 v90,v90,v66
v_mul_f32 v91,v91,v67
v_mfma_f32_16x16x32_bf16 v[76:79],a[36:39],v[228:231],v[76:79]
ds_read_b128 v[224:227],v17 offset:33792
v_exp_f32 v88,v88
v_exp_f32 v89,v89
s_waitcnt lgkmcnt(5)
v_mfma_f32_16x16x32_bf16 v[68:71],a[40:43],v[232:235],v[68:71]
ds_read_b128 v[228:231],v17 offset:35840
v_min3_u32 v27,v27,v232,v236
v_exp_f32 v90,v90
v_exp_f32 v91,v91
v_mfma_f32_16x16x32_bf16 v[76:79],a[44:47],v[236:239],v[76:79]
ds_read_b128 v[232:235],v17 offset:37888
v_fma_f32 v88,v88,v123,v123
v_fma_f32 v89,v89,v123,v123
v_fma_f32 v90,v90,v123,v123
v_fma_f32 v91,v91,v123,v123
s_waitcnt lgkmcnt(5)
v_mfma_f32_16x16x32_bf16 v[68:71],a[48:51],v[240:243],v[68:71]
ds_read_b128 v[236:239],v17 offset:39936
v_min3_u32 v27,v27,v240,v244
v_rcp_f32 v88,v88
v_rcp_f32 v89,v89
v_mfma_f32_16x16x32_bf16 v[76:79],a[52:55],v[244:247],v[76:79]
ds_read_b128 v[240:243],v17 offset:41984
v_rcp_f32 v90,v90
v_rcp_f32 v91,v91
s_waitcnt lgkmcnt(5)
v_mfma_f32_16x16x32_bf16 v[68:71],a[56:59],v[248:251],v[68:71]
ds_read_b128 v[244:247],v17 offset:44032
v_min3_u32 v27,v27,v248,v252
v_mul_f32 v88,v88,v64
v_mul_f32 v89,v89,v65
v_mul_f32 v90,v90,v66
v_mul_f32 v91,v91,v67
v_mfma_f32_16x16x32_bf16 v[76:79],a[60:63],v[252:255],v[76:79]
ds_read_b128 v[248:251],v17 offset:46080
v_cvt_pk_bf16_f32 v96,v88,v89
v_cvt_pk_bf16_f32 v97,v90,v91
v_max_u32 v96,1,v96
s_xor_b32 m0,s72,32768
s_waitcnt lgkmcnt(5)
v_mfma_f32_16x16x32_bf16 v[68:71],a[64:67],v[224:227],v[68:71]
ds_read_b128 v[252:255],v17 offset:48128
v_min3_u32 v27,v27,v224,v228
buffer_store_dwordx2 v[96:97],v18,s[20:23],s70 offen offset:0 sc1
s_add_u32 s65,s88,65536
v_mfma_f32_16x16x32_bf16 v[76:79],a[68:71],v[228:231],v[76:79]
ds_read_b128 v[224:227],v17 offset:50176
buffer_load_dwordx4 v16,s[20:23],s65 offen offset:0 sc1 lds
buffer_load_dwordx4 v16,s[20:23],s65 offen offset:2048 sc1 lds
s_waitcnt lgkmcnt(5)
v_mfma_f32_16x16x32_bf16 v[68:71],a[72:75],v[232:235],v[68:71]
ds_read_b128 v[228:231],v17 offset:52224
v_min3_u32 v27,v27,v232,v236
s_xor_b32 m0,s72,49152
s_add_u32 s65,s88,98304
buffer_load_dwordx4 v16,s[20:23],s65 offen offset:0 sc1 lds
v_mfma_f32_16x16x32_bf16 v[76:79],a[76:79],v[236:239],v[76:79]
ds_read_b128 v[232:235],v17 offset:54272
buffer_load_dwordx4 v16,s[20:23],s65 offen offset:2048 sc1 lds
s_xor_b32 m0,s72,1024
s_add_u32 s65,s89,0
s_waitcnt lgkmcnt(5)
v_mfma_f32_16x16x32_bf16 v[68:71],a[80:83],v[240:243],v[68:71]
ds_read_b128 v[236:239],v17 offset:56320
v_min3_u32 v27,v27,v240,v244
buffer_load_dwordx4 v16,s[20:23],s65 offen offset:0 sc1 lds
buffer_load_dwordx4 v16,s[20:23],s65 offen offset:2048 sc1 lds
v_mfma_f32_16x16x32_bf16 v[76:79],a[84:87],v[244:247],v[76:79]
ds_read_b128 v[240:243],v17 offset:58368
s_xor_b32 m0,s72,17408
s_add_u32 s65,s89,32768
buffer_load_dwordx4 v16,s[20:23],s65 offen offset:0 sc1 lds
s_waitcnt lgkmcnt(5)
v_mfma_f32_16x16x32_bf16 v[68:71],a[88:91],v[248:251],v[68:71]
ds_read_b128 v[244:247],v17 offset:60416
v_min3_u32 v27,v27,v248,v252
buffer_load_dwordx4 v16,s[20:23],s65 offen offset:2048 sc1 lds
s_xor_b32 m0,s72,33792
s_add_u32 s65,s89,65536
v_mfma_f32_16x16x32_bf16 v[76:79],a[92:95],v[252:255],v[76:79]
ds_read_b128 v[248:251],v17 offset:62464
buffer_load_dwordx4 v16,s[20:23],s65 offen offset:0 sc1 lds
buffer_load_dwordx4 v16,s[20:23],s65 offen offset:2048 sc1 lds
s_waitcnt lgkmcnt(5)
v_mfma_f32_16x16x32_bf16 v[68:71],a[96:99],v[224:227],v[68:71]
ds_read_b128 v[252:255],v17 offset:64512
v_min3_u32 v27,v27,v224,v228
s_xor_b32 m0,s72,50176
s_add_u32 s65,s89,98304
buffer_load_dwordx4 v16,s[20:23],s65 offen offset:0 sc1 lds
v_mfma_f32_16x16x32_bf16 v[76:79],a[100:103],v[228:231],v[76:79]
buffer_load_dwordx4 v16,s[20:23],s65 offen offset:2048 sc1 lds
s_waitcnt lgkmcnt(4)
v_mfma_f32_16x16x32_bf16 v[68:71],a[104:107],v[232:235],v[68:71]
v_min3_u32 v27,v27,v232,v236
s_waitcnt vmcnt(18)
v_cmp_gt_u32 vcc,s96,v2
s_mov_b32 s96,vcc_lo
v_mov_b32 v44,s96
ds_write_b32 v46,v44
v_mfma_f32_16x16x32_bf16 v[76:79],a[108:111],v[236:239],v[76:79]
s_waitcnt lgkmcnt(3)
v_mfma_f32_16x16x32_bf16 v[68:71],a[112:115],v[240:243],v[68:71]
v_min3_u32 v27,v27,v240,v244
v_mfma_f32_16x16x32_bf16 v[76:79],a[116:119],v[244:247],v[76:79]
s_waitcnt lgkmcnt(1)
v_mfma_f32_16x16x32_bf16 v[68:71],a[120:123],v[248:251],v[68:71]
v_min3_u32 v27,v27,v248,v252
v_mfma_f32_16x16x32_bf16 v[76:79],a[124:127],v[252:255],v[76:79]
v_cmp_eq_u32 vcc,0,v27
s_cbranch_vccnz retry_318
s_branch epi_321
ahead_320:
s_waitcnt vmcnt(3) lgkmcnt(0)
s_barrier
ds_read_b32 v44,v45
ds_read_b128 v[224:227],v17 offset:0
ds_read_b128 v[228:231],v17 offset:2048
ds_read_b128 v[232:235],v17 offset:4096
ds_read_b128 v[236:239],v17 offset:6144
ds_read_b128 v[240:243],v17 offset:8192
ds_read_b128 v[244:247],v17 offset:10240
ds_read_b128 v[248:251],v17 offset:12288
s_waitcnt lgkmcnt(5)
v_mfma_f32_16x16x32_bf16 v[64:67],a[0:3],v[224:227],0
ds_read_b128 v[252:255],v17 offset:14336
s_add_u32 s88,s70,s75
s_add_u32 s88,s88,2097152
s_xor_b32 s88,s88,0x2000
v_readfirstlane_b32 s83,v44
v_min_u32 v27,v224,v228
v_mfma_f32_16x16x32_bf16 v[72:75],a[4:7],v[228:231],0
ds_read_b128 v[224:227],v17 offset:16384
s_cmp_eq_u32 s83,0
s_cselect_b32 s88,s88,0x7fff0000
s_xor_b32 s89,s88,1024
s_waitcnt lgkmcnt(5)
v_mfma_f32_16x16x32_bf16 v[64:67],a[8:11],v[232:235],v[64:67]
ds_read_b128 v[228:231],v17 offset:18432
v_min3_u32 v27,v27,v232,v236
s_waitcnt vmcnt(4)
stk_332:
v_min3_u32 v22,v129,v133,v137
v_min3_u32 v22,v22,v141,v145
v_min3_u32 v22,v22,v149,v153
v_min_u32 v22,v22,v157
v_cmp_eq_u32 vcc,0,v22
s_cmp_lt_i32 s90,0
s_cselect_b64 vcc,0,vcc
s_cbranch_vccnz str_333
v_mfma_f32_16x16x32_bf16 v[72:75],a[12:15],v[236:239],v[72:75]
ds_read_b128 v[232:235],v17 offset:20480
v_pk_add_f32 v[88:89],v[128:129],v[144:145]
v_pk_add_f32 v[90:91],v[130:131],v[146:147]
v_pk_add_f32 v[92:93],v[132:133],v[148:149]
v_pk_add_f32 v[94:95],v[134:135],v[150:151]
s_waitcnt lgkmcnt(5)
v_mfma_f32_16x16x32_bf16 v[64:67],a[16:19],v[240:243],v[64:67]
ds_read_b128 v[236:239],v17 offset:22528
v_min3_u32 v27,v27,v240,v244
v_pk_add_f32 v[96:97],v[136:137],v[152:153]
v_pk_add_f32 v[98:99],v[138:139],v[154:155]
v_pk_add_f32 v[100:101],v[140:141],v[156:157]
v_pk_add_f32 v[102:103],v[142:143],v[158:159]
v_mfma_f32_16x16x32_bf16 v[72:75],a[20:23],v[244:247],v[72:75]
ds_read_b128 v[240:243],v17 offset:24576
v_pk_add_f32 v[88:89],v[88:89],v[96:97]
v_pk_add_f32 v[90:91],v[90:91],v[98:99]
v_pk_add_f32 v[92:93],v[92:93],v[100:101]
v_pk_add_f32 v[94:95],v[94:95],v[102:103]
s_waitcnt lgkmcnt(5)
v_mfma_f32_16x16x32_bf16 v[64:67],a[24:27],v[248:251],v[64:67]
ds_read_b128 v[244:247],v17 offset:26624
v_min3_u32 v27,v27,v248,v252
v_pk_add_f32 v[88:89],v[88:89],v[92:93]
v_pk_add_f32 v[90:91],v[90:91],v[94:95]
v_mov_b32 v92,v88
v_mov_b32 v93,v89
v_mfma_f32_16x16x32_bf16 v[72:75],a[28:31],v[252:255],v[72:75]
ds_read_b128 v[248:251],v17 offset:28672
v_mov_b32 v94,v90
v_mov_b32 v95,v91
v_permlane16_swap_b32 v92,v88
v_permlane16_swap_b32 v93,v89
s_waitcnt lgkmcnt(5)
v_mfma_f32_16x16x32_bf16 v[64:67],a[32:35],v[224:227],v[64:67]
ds_read_b128 v[252:255],v17 offset:30720
v_min3_u32 v27,v27,v224,v228
v_permlane16_swap_b32 v94,v90
v_permlane16_swap_b32 v95,v91
v_mfma_f32_16x16x32_bf16 v[72:75],a[36:39],v[228:231],v[72:75]
ds_read_b128 v[224:227],v17 offset:32768
v_pk_add_f32 v[88:89],v[88:89],v[92:93]
v_pk_add_f32 v[90:91],v[90:91],v[94:95]
v_mov_b32 v92,v88
s_waitcnt lgkmcnt(5)
v_mfma_f32_16x16x32_bf16 v[64:67],a[40:43],v[232:235],v[64:67]
ds_read_b128 v[228:231],v17 offset:34816
v_min3_u32 v27,v27,v232,v236
v_mov_b32 v93,v89
v_mov_b32 v94,v90
v_mov_b32 v95,v91
v_mfma_f32_16x16x32_bf16 v[72:75],a[44:47],v[236:239],v[72:75]
ds_read_b128 v[232:235],v17 offset:36864
v_permlane32_swap_b32 v92,v88
v_permlane32_swap_b32 v93,v89
v_permlane32_swap_b32 v94,v90
s_waitcnt lgkmcnt(5)
v_mfma_f32_16x16x32_bf16 v[64:67],a[48:51],v[240:243],v[64:67]
ds_read_b128 v[236:239],v17 offset:38912
v_min3_u32 v27,v27,v240,v244
v_permlane32_swap_b32 v95,v91
v_pk_add_f32 v[88:89],v[88:89],v[92:93]
v_mfma_f32_16x16x32_bf16 v[72:75],a[52:55],v[244:247],v[72:75]
ds_read_b128 v[240:243],v17 offset:40960
v_pk_add_f32 v[90:91],v[90:91],v[94:95]
v_mul_f32 v120,0xba800000,v88
v_mul_f32 v124,0xba800000,v90
s_waitcnt lgkmcnt(5)
v_mfma_f32_16x16x32_bf16 v[64:67],a[56:59],v[248:251],v[64:67]
ds_read_b128 v[244:247],v17 offset:43008
v_min3_u32 v27,v27,v248,v252
v_mul_f32 v92,v120,v120
v_mul_f32 v93,v124,v124
v_fma_f32 v92,v89,s82,-v92
v_mfma_f32_16x16x32_bf16 v[72:75],a[60:63],v[252:255],v[72:75]
ds_read_b128 v[248:251],v17 offset:45056
v_fma_f32 v93,v91,s82,-v93
v_max_f32 v92,0,v92
v_max_f32 v93,0,v93
s_waitcnt lgkmcnt(5)
v_mfma_f32_16x16x32_bf16 v[64:67],a[64:67],v[224:227],v[64:67]
ds_read_b128 v[252:255],v17 offset:47104
v_min3_u32 v27,v27,v224,v228
v_add_f32 v92,0x3727c5ac,v92
v_add_f32 v93,0x3727c5ac,v93
v_rsq_f32 v94,v92
v_mfma_f32_16x16x32_bf16 v[72:75],a[68:71],v[228:231],v[72:75]
ds_read_b128 v[224:227],v17 offset:49152
v_rsq_f32 v95,v93
v_mul_f32 v123,v92,v94
s_waitcnt lgkmcnt(5)
v_mfma_f32_16x16x32_bf16 v[64:67],a[72:75],v[232:235],v[64:67]
ds_read_b128 v[228:231],v17 offset:51200
v_min3_u32 v27,v27,v232,v236
v_mul_f32 v127,v93,v95
v_mul_f32 v122,v28,v94
v_mul_f32 v126,v28,v95
v_mfma_f32_16x16x32_bf16 v[72:75],a[76:79],v[236:239],v[72:75]
ds_read_b128 v[232:235],v17 offset:53248
v_mul_f32 v92,v94,v94
v_mul_f32 v93,v95,v95
v_mul_f32 v94,s81,v94
s_waitcnt lgkmcnt(5)
v_mfma_f32_16x16x32_bf16 v[64:67],a[80:83],v[240:243],v[64:67]
ds_read_b128 v[236:239],v17 offset:55296
v_min3_u32 v27,v27,v240,v244
v_mul_f32 v95,s81,v95
v_mul_f32 v121,v92,v94
v_mul_f32 v125,v93,v95
v_mfma_f32_16x16x32_bf16 v[72:75],a[84:87],v[244:247],v[72:75]
ds_read_b128 v[240:243],v17 offset:57344
ds_write_b128 v19,v[120:123] offset:0
ds_write_b128 v19,v[124:127] offset:256
s_waitcnt lgkmcnt(7)
v_mfma_f32_16x16x32_bf16 v[64:67],a[88:91],v[248:251],v[64:67]
ds_read_b128 v[244:247],v17 offset:59392
v_min3_u32 v27,v27,v248,v252
s_add_u32 s66,s88,110592
buffer_load_dwordx4 v[128:131],v16,s[20:23],s66 offen offset:0 sc1
v_mfma_f32_16x16x32_bf16 v[72:75],a[92:95],v[252:255],v[72:75]
ds_read_b128 v[248:251],v17 offset:61440
buffer_load_dwordx4 v[132:135],v16,s[20:23],s66 offen offset:1024 sc1
buffer_load_dwordx4 v[136:139],v16,s[20:23],s66 offen offset:2048 sc1
s_waitcnt lgkmcnt(7)
v_mfma_f32_16x16x32_bf16 v[64:67],a[96:99],v[224:227],v[64:67]
ds_read_b128 v[252:255],v17 offset:63488
v_min3_u32 v27,v27,v224,v228
buffer_load_dwordx4 v[140:143],v16,s[20:23],s66 offen offset:3072 sc1
v_mfma_f32_16x16x32_bf16 v[72:75],a[100:103],v[228:231],v[72:75]
s_waitcnt lgkmcnt(0)
s_barrier
ds_read_b128 v[224:227],v17 offset:1024
s_waitcnt vmcnt(4)
v_add_u32 v22,s71,-1
v_mfma_f32_16x16x32_bf16 v[64:67],a[104:107],v[232:235],v[64:67]
ds_read_b128 v[228:231],v17 offset:3072
v_min3_u32 v27,v27,v232,v236
buffer_store_dword v22,v23,s[20:23],s97 offen sc1
s_mov_b32 s97,0x7fff0000
v_mfma_f32_16x16x32_bf16 v[72:75],a[108:111],v[236:239],v[72:75]
ds_read_b128 v[232:235],v17 offset:5120
s_add_u32 s66,s88,114688
buffer_load_dwordx4 v[144:147],v16,s[20:23],s66 offen offset:0 sc1
v_mfma_f32_16x16x32_bf16 v[64:67],a[112:115],v[240:243],v[64:67]
ds_read_b128 v[236:239],v17 offset:7168
v_min3_u32 v27,v27,v240,v244
buffer_load_dwordx4 v[148:151],v16,s[20:23],s66 offen offset:1024 sc1
buffer_load_dwordx4 v[152:155],v16,s[20:23],s66 offen offset:2048 sc1
v_mfma_f32_16x16x32_bf16 v[72:75],a[116:119],v[244:247],v[72:75]
ds_read_b128 v[240:243],v17 offset:9216
buffer_load_dwordx4 v[156:159],v16,s[20:23],s66 offen offset:3072 sc1
s_xor_b32 m0,s72,0
s_add_u32 s65,s88,0
v_mfma_f32_16x16x32_bf16 v[64:67],a[120:123],v[248:251],v[64:67]
ds_read_b128 v[244:247],v17 offset:11264
v_min3_u32 v27,v27,v248,v252
buffer_load_dwordx4 v16,s[20:23],s65 offen offset:0 sc1 lds
buffer_load_dwordx4 v16,s[20:23],s65 offen offset:2048 sc1 lds
v_mfma_f32_16x16x32_bf16 v[72:75],a[124:127],v[252:255],v[72:75]
ds_read_b128 v[248:251],v17 offset:13312
buffer_load_dword v2,v21,s[20:23],s87 offen sc1
s_add_u32 s96,s71,2
s_xor_b32 m0,s72,16384
s_waitcnt lgkmcnt(5)
v_mfma_f32_16x16x32_bf16 v[68:71],a[0:3],v[224:227],0
ds_read_b128 v[252:255],v17 offset:15360
v_cmp_eq_u32 vcc,0,v27
s_cbranch_vccnz retry_318
v_min3_u32 v27,v27,v224,v228
s_add_u32 s65,s88,32768
v_mfma_f32_16x16x32_bf16 v[76:79],a[4:7],v[228:231],0
ds_read_b128 v[224:227],v17 offset:17408
buffer_load_dwordx4 v16,s[20:23],s65 offen offset:0 sc1 lds
buffer_load_dwordx4 v16,s[20:23],s65 offen offset:2048 sc1 lds
s_waitcnt lgkmcnt(5)
v_mfma_f32_16x16x32_bf16 v[68:71],a[8:11],v[232:235],v[68:71]
ds_read_b128 v[228:231],v17 offset:19456
v_min3_u32 v27,v27,v232,v236
s_xor_b32 m0,s72,32768
s_add_u32 s65,s88,65536
buffer_load_dwordx4 v16,s[20:23],s65 offen offset:0 sc1 lds
v_mfma_f32_16x16x32_bf16 v[76:79],a[12:15],v[236:239],v[76:79]
ds_read_b128 v[232:235],v17 offset:21504
buffer_load_dwordx4 v16,s[20:23],s65 offen offset:2048 sc1 lds
s_xor_b32 m0,s72,49152
s_add_u32 s65,s88,98304
s_waitcnt lgkmcnt(5)
v_mfma_f32_16x16x32_bf16 v[68:71],a[16:19],v[240:243],v[68:71]
ds_read_b128 v[236:239],v17 offset:23552
v_min3_u32 v27,v27,v240,v244
v_add_f32 v64,v64,v72
v_add_f32 v65,v65,v73
v_add_f32 v66,v66,v74
v_add_f32 v67,v67,v75
v_mfma_f32_16x16x32_bf16 v[76:79],a[20:23],v[244:247],v[76:79]
ds_read_b128 v[240:243],v17 offset:25600
v_fmac_f32 v64,v52,v120
v_fmac_f32 v65,v53,v120
v_fmac_f32 v66,v54,v120
v_fmac_f32 v67,v55,v120
s_waitcnt lgkmcnt(5)
v_mfma_f32_16x16x32_bf16 v[68:71],a[24:27],v[248:251],v[68:71]
ds_read_b128 v[244:247],v17 offset:27648
v_min3_u32 v27,v27,v248,v252
v_mul_f32 v88,v64,v64
v_mul_f32 v89,v65,v65
v_mul_f32 v90,v66,v66
v_mul_f32 v91,v67,v67
v_mfma_f32_16x16x32_bf16 v[76:79],a[28:31],v[252:255],v[76:79]
ds_read_b128 v[248:251],v17 offset:29696
v_fma_f32 v88,v88,v121,v122
v_fma_f32 v89,v89,v121,v122
v_fma_f32 v90,v90,v121,v122
v_fma_f32 v91,v91,v121,v122
s_waitcnt lgkmcnt(5)
v_mfma_f32_16x16x32_bf16 v[68:71],a[32:35],v[224:227],v[68:71]
ds_read_b128 v[252:255],v17 offset:31744
v_min3_u32 v27,v27,v224,v228
v_mul_f32 v88,v88,v64
v_mul_f32 v89,v89,v65
v_mul_f32 v90,v90,v66
v_mul_f32 v91,v91,v67
v_mfma_f32_16x16x32_bf16 v[76:79],a[36:39],v[228:231],v[76:79]
ds_read_b128 v[224:227],v17 offset:33792
v_exp_f32 v88,v88
v_exp_f32 v89,v89
s_waitcnt lgkmcnt(5)
v_mfma_f32_16x16x32_bf16 v[68:71],a[40:43],v[232:235],v[68:71]
ds_read_b128 v[228:231],v17 offset:35840
v_min3_u32 v27,v27,v232,v236
v_exp_f32 v90,v90
v_exp_f32 v91,v91
v_mfma_f32_16x16x32_bf16 v[76:79],a[44:47],v[236:239],v[76:79]
ds_read_b128 v[232:235],v17 offset:37888
v_fma_f32 v88,v88,v123,v123
v_fma_f32 v89,v89,v123,v123
v_fma_f32 v90,v90,v123,v123
v_fma_f32 v91,v91,v123,v123
s_waitcnt lgkmcnt(5)
v_mfma_f32_16x16x32_bf16 v[68:71],a[48:51],v[240:243],v[68:71]
ds_read_b128 v[236:239],v17 offset:39936
v_min3_u32 v27,v27,v240,v244
v_rcp_f32 v88,v88
v_rcp_f32 v89,v89
v_mfma_f32_16x16x32_bf16 v[76:79],a[52:55],v[244:247],v[76:79]
ds_read_b128 v[240:243],v17 offset:41984
v_rcp_f32 v90,v90
v_rcp_f32 v91,v91
s_waitcnt lgkmcnt(5)
v_mfma_f32_16x16x32_bf16 v[68:71],a[56:59],v[248:251],v[68:71]
ds_read_b128 v[244:247],v17 offset:44032
v_min3_u32 v27,v27,v248,v252
v_mul_f32 v88,v88,v64
v_mul_f32 v89,v89,v65
v_mul_f32 v90,v90,v66
v_mul_f32 v91,v91,v67
v_mfma_f32_16x16x32_bf16 v[76:79],a[60:63],v[252:255],v[76:79]
ds_read_b128 v[248:251],v17 offset:46080
v_cvt_pk_bf16_f32 v96,v88,v89
v_cvt_pk_bf16_f32 v97,v90,v91
v_max_u32 v96,1,v96
s_waitcnt lgkmcnt(5)
v_mfma_f32_16x16x32_bf16 v[68:71],a[64:67],v[224:227],v[68:71]
ds_read_b128 v[252:255],v17 offset:48128
v_min3_u32 v27,v27,v224,v228
buffer_store_dwordx2 v[96:97],v18,s[20:23],s70 offen offset:0 sc1
buffer_load_dwordx4 v16,s[20:23],s65 offen offset:0 sc1 lds
v_mfma_f32_16x16x32_bf16 v[76:79],a[68:71],v[228:231],v[76:79]
ds_read_b128 v[224:227],v17 offset:50176
buffer_load_dwordx4 v16,s[20:23],s65 offen offset:2048 sc1 lds
s_xor_b32 m0,s72,1024
s_add_u32 s65,s89,0
s_waitcnt lgkmcnt(5)
v_mfma_f32_16x16x32_bf16 v[68:71],a[72:75],v[232:235],v[68:71]
ds_read_b128 v[228:231],v17 offset:52224
v_min3_u32 v27,v27,v232,v236
buffer_load_dwordx4 v16,s[20:23],s65 offen offset:0 sc1 lds
buffer_load_dwordx4 v16,s[20:23],s65 offen offset:2048 sc1 lds
v_mfma_f32_16x16x32_bf16 v[76:79],a[76:79],v[236:239],v[76:79]
ds_read_b128 v[232:235],v17 offset:54272
s_xor_b32 m0,s72,17408
s_add_u32 s65,s89,32768
buffer_load_dwordx4 v16,s[20:23],s65 offen offset:0 sc1 lds
s_waitcnt lgkmcnt(5)
v_mfma_f32_16x16x32_bf16 v[68:71],a[80:83],v[240:243],v[68:71]
ds_read_b128 v[236:239],v17 offset:56320
v_min3_u32 v27,v27,v240,v244
buffer_load_dwordx4 v16,s[20:23],s65 offen offset:2048 sc1 lds
s_xor_b32 m0,s72,33792
s_add_u32 s65,s89,65536
v_mfma_f32_16x16x32_bf16 v[76:79],a[84:87],v[244:247],v[76:79]
ds_read_b128 v[240:243],v17 offset:58368
buffer_load_dwordx4 v16,s[20:23],s65 offen offset:0 sc1 lds
buffer_load_dwordx4 v16,s[20:23],s65 offen offset:2048 sc1 lds
s_waitcnt lgkmcnt(5)
v_mfma_f32_16x16x32_bf16 v[68:71],a[88:91],v[248:251],v[68:71]
ds_read_b128 v[244:247],v17 offset:60416
v_min3_u32 v27,v27,v248,v252
s_xor_b32 m0,s72,50176
s_add_u32 s65,s89,98304
buffer_load_dwordx4 v16,s[20:23],s65 offen offset:0 sc1 lds
v_mfma_f32_16x16x32_bf16 v[76:79],a[92:95],v[252:255],v[76:79]
ds_read_b128 v[248:251],v17 offset:62464
buffer_load_dwordx4 v16,s[20:23],s65 offen offset:2048 sc1 lds
s_waitcnt lgkmcnt(5)
v_mfma_f32_16x16x32_bf16 v[68:71],a[96:99],v[224:227],v[68:71]
ds_read_b128 v[252:255],v17 offset:64512
v_min3_u32 v27,v27,v224,v228
v_mfma_f32_16x16x32_bf16 v[76:79],a[100:103],v[228:231],v[76:79]
s_waitcnt lgkmcnt(4)
v_mfma_f32_16x16x32_bf16 v[68:71],a[104:107],v[232:235],v[68:71]
v_min3_u32 v27,v27,v232,v236
s_waitcnt vmcnt(15)
v_cmp_gt_u32 vcc,s96,v2
s_mov_b32 s96,vcc_lo
v_mov_b32 v44,s96
ds_write_b32 v46,v44
v_mfma_f32_16x16x32_bf16 v[76:79],a[108:111],v[236:239],v[76:79]
s_waitcnt lgkmcnt(3)
v_mfma_f32_16x16x32_bf16 v[68:71],a[112:115],v[240:243],v[68:71]
v_min3_u32 v27,v27,v240,v244
v_mfma_f32_16x16x32_bf16 v[76:79],a[116:119],v[244:247],v[76:79]
s_waitcnt lgkmcnt(1)
v_mfma_f32_16x16x32_bf16 v[68:71],a[120:123],v[248:251],v[68:71]
v_min3_u32 v27,v27,v248,v252
v_mfma_f32_16x16x32_bf16 v[76:79],a[124:127],v[252:255],v[76:79]
v_cmp_eq_u32 vcc,0,v27
s_cbranch_vccnz retry_318
epi_321:
buffer_load_dword v29,v21,s[20:23],s87 offen sc1
s_nop 4
v_pk_add_f32 v[68:69],v[68:69],v[76:77]
v_pk_add_f32 v[70:71],v[70:71],v[78:79]
v_pk_fma_f32 v[68:69],v[52:53],v[124:125],v[68:69] op_sel_hi:[1,0,1]
v_pk_fma_f32 v[70:71],v[54:55],v[124:125],v[70:71] op_sel_hi:[1,0,1]
v_pk_mul_f32 v[88:89],v[68:69],v[68:69]
v_pk_mul_f32 v[90:91],v[70:71],v[70:71]
v_pk_fma_f32 v[88:89],v[88:89],v[124:125],v[126:127] op_sel:[0,1,0] op_sel_hi:[1,1,0]
v_pk_fma_f32 v[90:91],v[90:91],v[124:125],v[126:127] op_sel:[0,1,0] op_sel_hi:[1,1,0]
v_pk_mul_f32 v[88:89],v[88:89],v[68:69]
v_pk_mul_f32 v[90:91],v[90:91],v[70:71]
v_exp_f32 v88,v88
v_exp_f32 v89,v89
v_exp_f32 v90,v90
v_exp_f32 v91,v91
v_pk_fma_f32 v[88:89],v[88:89],v[126:127],v[126:127] op_sel:[0,1,1] op_sel_hi:[1,1,1]
v_pk_fma_f32 v[90:91],v[90:91],v[126:127],v[126:127] op_sel:[0,1,1] op_sel_hi:[1,1,1]
v_rcp_f32 v88,v88
v_rcp_f32 v89,v89
v_rcp_f32 v90,v90
v_rcp_f32 v91,v91
v_pk_mul_f32 v[88:89],v[88:89],v[68:69]
v_pk_mul_f32 v[90:91],v[90:91],v[70:71]
v_cvt_pk_bf16_f32 v96,v88,v89
v_cvt_pk_bf16_f32 v97,v90,v91
v_max_u32 v96,1,v96
buffer_store_dwordx2 v[96:97],v18,s[20:23],s70 offen offset:1024 sc1
s_cmp_gt_u32 s71,51
s_cselect_b32 s65,s73,0x7fff0000
s_cselect_b32 s97,0x7fff0000,s73
v_mov_b32 v22,s71
buffer_store_dword v22,v23,s[20:23],s65 offen sc1
v_xor_b32 v17,0x10000,v17
v_xor_b32 v45,16,v45
v_xor_b32 v46,16,v46
s_xor_b32 s72,s72,0x10000
s_add_u32 s70,s70,2097152
s_xor_b32 s70,s70,0x2000
s_add_u32 s71,s71,1
s_cmp_le_u32 s71,s57
s_cbranch_scc1 seg_319
s_endpgm
retry_318:
s_sub_u32 s90,s90,64
s_cmp_lt_i32 s90,0
s_cbranch_scc1 giveup_176
s_mov_b32 s83,1
s_waitcnt vmcnt(0) lgkmcnt(0)
s_barrier
s_branch seg_319
str_329:
s_add_u32 s94,s70,s75
s_add_u32 s66,s94,110592
buffer_load_dwordx4 v[128:131],v16,s[20:23],s66 offen offset:0 sc1
buffer_load_dwordx4 v[132:135],v16,s[20:23],s66 offen offset:1024 sc1
buffer_load_dwordx4 v[136:139],v16,s[20:23],s66 offen offset:2048 sc1
buffer_load_dwordx4 v[140:143],v16,s[20:23],s66 offen offset:3072 sc1
s_add_u32 s66,s94,114688
buffer_load_dwordx4 v[144:147],v16,s[20:23],s66 offen offset:0 sc1
buffer_load_dwordx4 v[148:151],v16,s[20:23],s66 offen offset:1024 sc1
buffer_load_dwordx4 v[152:155],v16,s[20:23],s66 offen offset:2048 sc1
buffer_load_dwordx4 v[156:159],v16,s[20:23],s66 offen offset:3072 sc1
s_sub_u32 s90,s90,1
s_waitcnt vmcnt(0)
s_branch stk_328
str_331:
s_add_u32 s94,s70,s75
s_add_u32 s66,s94,110592
buffer_load_dwordx4 v[128:131],v16,s[20:23],s66 offen offset:0 sc1
buffer_load_dwordx4 v[132:135],v16,s[20:23],s66 offen offset:1024 sc1
buffer_load_dwordx4 v[136:139],v16,s[20:23],s66 offen offset:2048 sc1
buffer_load_dwordx4 v[140:143],v16,s[20:23],s66 offen offset:3072 sc1
s_add_u32 s66,s94,114688
buffer_load_dwordx4 v[144:147],v16,s[20:23],s66 offen offset:0 sc1
buffer_load_dwordx4 v[148:151],v16,s[20:23],s66 offen offset:1024 sc1
buffer_load_dwordx4 v[152:155],v16,s[20:23],s66 offen offset:2048 sc1
buffer_load_dwordx4 v[156:159],v16,s[20:23],s66 offen offset:3072 sc1
s_sub_u32 s90,s90,1
s_waitcnt vmcnt(0)
s_branch stk_330
str_333:
s_add_u32 s94,s70,s75
s_add_u32 s66,s94,110592
buffer_load_dwordx4 v[128:131],v16,s[20:23],s66 offen offset:0 sc1
buffer_load_dwordx4 v[132:135],v16,s[20:23],s66 offen offset:1024 sc1
buffer_load_dwordx4 v[136:139],v16,s[20:23],s66 offen offset:2048 sc1
buffer_load_dwordx4 v[140:143],v16,s[20:23],s66 offen offset:3072 sc1
s_add_u32 s66,s94,114688
buffer_load_dwordx4 v[144:147],v16,s[20:23],s66 offen offset:0 sc1
buffer_load_dwordx4 v[148:151],v16,s[20:23],s66 offen offset:1024 sc1
buffer_load_dwordx4 v[152:155],v16,s[20:23],s66 offen offset:2048 sc1
buffer_load_dwordx4 v[156:159],v16,s[20:23],s66 offen offset:3072 sc1
s_sub_u32 s90,s90,1
s_waitcnt vmcnt(0)
s_branch stk_332
giveup_176:
s_endpgm
code_end:
.section .rodata,"a"
.p2align 6
.amdhsa_kernel mega_kernel
  .amdhsa_next_free_vgpr 512
  .amdhsa_next_free_sgpr 102
  .amdhsa_accum_offset 256
  .amdhsa_group_segment_fixed_size 0
  .amdhsa_kernarg_size 136
  .amdhsa_user_sgpr_count 2
  .amdhsa_user_sgpr_kernarg_segment_ptr 1
  .amdhsa_system_sgpr_workgroup_id_x 1
.end_amdhsa_kernel
```

```asm
; @launch kernel=mega_kernel grid=(256,1,1) block=(256,1,1) lds=163840
.amdgcn_target "amdgcn-amd-amdhsa--gfx950"
.text
.globl mega_kernel
.p2align 8
.type mega_kernel,@function
mega_kernel:
s_cmp_ge_u32 s2,256
s_cbranch_scc1 done_1
s_load_dwordx4 s[16:19],s[0:1],120
s_load_dword s3,s[0:1],0
s_getpc_b64 s[4:5]
pc_2:
s_sub_u32 s8,s4,pc_2-mega_kernel
s_subb_u32 s9,s5,0
s_and_b32 s9,s9,0xffff
s_mov_b32 s10,code_end-mega_kernel
s_mov_b32 s11,0x20000
v_lshlrev_b32 v180,7,v0
v_cmp_gt_u32 vcc,64,v0
s_cbranch_vccnz nocpf_3
buffer_load_dword v181,v180,s[8:11],0 offen
s_mov_b32 s12,0x8000
buffer_load_dword v182,v180,s[8:11],s12 offen
s_lshr_b32 s12,s2,3
s_and_b32 s12,s12,7
s_add_u32 s12,s12,2
s_lshl_b32 s12,s12,15
buffer_load_dword v183,v180,s[8:11],s12 offen
nocpf_3:
v_and_b32 v1,63,v0
v_lshrrev_b32 v2,6,v0
s_getreg_b32 s51,hwreg(HW_REG_XCC_ID)
v_readfirstlane_b32 s50,v2
s_and_b32 s51,s51,7
s_waitcnt lgkmcnt(0)
s_mov_b32 s20,s18
s_and_b32 s21,s19,0xffff
s_mov_b32 s22,0x10000000
s_mov_b32 s23,0x20000
s_mov_b32 s44,s16
s_and_b32 s45,s17,0xffff
s_mov_b32 s46,0x100
s_mov_b32 s47,0x20000
s_mov_b32 s90,400000
s_mov_b32 s91,s50
v_mov_b32 v187,158976
s_cmp_lg_u32 s50,0
s_cbranch_scc1 norole_4
s_mov_b64 exec,1
v_mov_b32 v184,1
v_mov_b32 v185,0
s_and_b32 s52,s51,3
s_lshl_b32 s52,s52,2
s_lshr_b32 s53,s51,2
s_lshl_b32 s53,s53,7
s_add_u32 s52,s52,s53
buffer_atomic_add v184,v185,s[44:47],s52 offen sc0 sc1
s_mov_b64 exec,-1
buffer_load_dword v181,v180,s[8:11],0 offen
s_mov_b32 s12,0x8000
buffer_load_dword v182,v180,s[8:11],s12 offen
s_lshr_b32 s12,s2,3
s_and_b32 s12,s12,7
s_add_u32 s12,s12,2
s_lshl_b32 s12,s12,15
buffer_load_dword v183,v180,s[8:11],s12 offen
s_mov_b64 exec,1
s_waitcnt vmcnt(3)
ds_write_b32 v187,v184
s_waitcnt lgkmcnt(0)
s_mov_b64 exec,-1
norole_4:
s_barrier
ds_read_b32 v186,v187
s_waitcnt lgkmcnt(0)
v_readfirstlane_b32 s54,v186
s_mov_b32 s56,2
s_lshl_b32 s57,s51,5
s_add_u32 s57,s57,s54
s_cmp_lt_u32 s54,32
s_cselect_b32 s57,s57,999
s_cmp_ge_u32 s57,256
s_cbranch_scc1 verify_6
s_cmp_ge_u32 s57,128
s_cbranch_scc1 pre_8
setup_5:
s_load_dwordx8 s[4:11],s[0:1],8
s_load_dwordx2 s[12:13],s[0:1],40
v_and_b32 v3,15,v1
v_lshrrev_b32 v4,4,v1
v_lshlrev_b32 v16,4,v1
v_lshrrev_b32 v30,2,v1
v_and_b32 v31,3,v1
v_lshlrev_b32 v7,13,v30
v_lshl_add_u32 v7,v31,4,v7
v_lshlrev_b32 v8,11,v30
v_lshl_add_u32 v8,v31,4,v8
s_lshr_b32 s58,s57,5
s_and_b32 s59,s57,31
s_xor_b32 s60,s57,0
s_lshl_b32 s60,s60,6
s_lshl_b32 s61,s50,14
s_lshl_b32 s62,s50,21
s_add_u32 s62,s62,s60
s_lshl_b32 s63,s58,21
s_lshl_b32 s64,s50,19
s_add_u32 s63,s63,s64
s_xor_b32 s64,s59,0
s_lshl_b32 s64,s64,6
s_add_u32 s63,s63,s64
s_waitcnt lgkmcnt(0)
s_mov_b32 s28,s8
s_and_b32 s29,s9,0xffff
s_mov_b32 s30,0x800000
s_mov_b32 s31,0x20000
s_mov_b32 s32,s10
s_and_b32 s33,s11,0xffff
s_mov_b32 s34,0x800000
s_mov_b32 s35,0x20000
s_mov_b32 s36,s6
s_and_b32 s37,s7,0xffff
s_mov_b32 s38,0x800000
s_mov_b32 s39,0x20000
s_mov_b32 s40,s12
s_and_b32 s41,s13,0xffff
s_mov_b32 s42,0x800000
s_mov_b32 s43,0x20000
s_mov_b32 s8,s4
s_and_b32 s9,s5,0xffff
s_mov_b32 s10,0x4000
s_mov_b32 s11,0x20000
v_lshlrev_b32 v9,7,v3
v_lshl_add_u32 v10,v4,11,v9
v_lshl_add_u32 v9,v4,13,v9
s_lshl_b32 s64,s59,2
s_add_u32 s64,s64,s50
s_lshl_b32 s65,s64,16
s_lshl_b32 s66,s58,11
s_add_u32 s65,s65,s66
s_lshl_b32 s66,s64,14
s_lshl_b32 s67,s58,21
s_add_u32 s66,s66,s67
v_and_b32 v9,7,v1
v_lshrrev_b32 v10,3,v1
s_cmp_eq_u32 s58,3
s_cselect_b32 s64,15,3
v_mov_b32 v11,3
v_cmp_eq_u32 vcc,1,v10
s_nop 1
v_cndmask_b32 v11,v11,11,vcc
v_lshlrev_b32 v12,7,v11
v_lshl_add_u32 v12,v9,11,v12
v_mov_b32 v13,s64
v_cmp_eq_u32 vcc,2,v10
s_nop 1
v_cndmask_b32 v11,v11,v13,vcc
v_lshlrev_b32 v11,7,v11
v_lshl_add_u32 v11,v9,13,v11
v_mov_b32 v100,0
v_mov_b32 v101,0
v_mov_b32 v102,0
v_mov_b32 v103,0
s_mov_b32 s53,s65
s_mov_b32 s55,s66
v_and_b32 v22,7,v3
v_lshlrev_b32 v31,11,v22
v_lshl_add_u32 v31,v4,4,v31
s_lshr_b32 s64,s59,3
s_lshl_b32 s64,s64,14
s_and_b32 s65,s59,7
s_lshl_b32 s65,s65,10
s_add_u32 s64,s64,s65
s_lshl_b32 s65,s58,16
s_add_u32 s64,s64,s65
s_add_u32 s64,s64,31195136
s_lshr_b32 s65,s57,3
s_add_u32 s65,s65,96
s_lshl_b32 s65,s65,14
s_and_b32 s66,s57,7
s_lshl_b32 s66,s66,10
s_add_u32 s65,s65,s66
s_add_u32 s65,s65,29360128
v_add_u32 v206,s64,v16
v_add_u32 v207,s65,v16
s_and_b32 s64,s50,1
s_lshl_b32 s64,s64,21
s_lshr_b32 s65,s50,1
s_lshl_b32 s65,s65,13
s_add_u32 s64,s64,s65
buffer_store_dwordx4 v[100:103],v206,s[20:23],s64 offen sc1
buffer_store_dwordx4 v[100:103],v207,s[20:23],s64 offen sc1
s_lshl_b32 s64,s50,20
s_add_u32 s64,s64,23068672
s_cmp_lt_u32 s50,2
s_cselect_b32 s67,s64,0x7fff0000
s_lshl_b32 s65,s57,10
s_add_u32 s65,s65,131072
s_add_u32 s65,s65,s67
buffer_store_dwordx4 v[100:103],v16,s[20:23],s65 offen sc1
s_lshl_b32 s65,s57,9
s_add_u32 s65,s65,s67
s_add_u32 s66,s65,65536
s_mov_b32 exec_hi,0
buffer_store_dwordx4 v[100:103],v16,s[20:23],s65 offen sc1
buffer_store_dwordx4 v[100:103],v16,s[20:23],s66 offen sc1
s_lshl_b32 s65,s57,2
s_add_u32 s65,s65,s64
s_add_u32 s65,s65,524288
s_lshl_b32 s52,s57,7
s_add_u32 s52,s52,21168128
s_mov_b64 exec,1
buffer_store_dword v100,v100,s[20:23],s65 offen sc1
buffer_store_dword v100,v100,s[20:23],s65 offen offset:512 sc1
s_mov_b64 exec,15
buffer_store_dwordx4 v[100:103],v16,s[20:23],s52 offen sc1
s_mov_b64 exec,-1
s_mov_b32 s65,s53
s_mov_b32 s66,s55
v_mov_b32 v37,159008
ds_write_b128 v37,v[100:103]
s_add_u32 s64,s62,0
s_add_u32 m0,s61,0
s_nop 0
buffer_load_dwordx4 v7,s[28:31],s64 offen nt lds
s_add_u32 s64,s62,131072
s_add_u32 m0,s61,1024
s_nop 0
buffer_load_dwordx4 v7,s[28:31],s64 offen nt lds
s_add_u32 s64,s62,262144
s_add_u32 m0,s61,2048
s_nop 0
buffer_load_dwordx4 v7,s[28:31],s64 offen nt lds
s_add_u32 s64,s62,393216
s_add_u32 m0,s61,3072
s_nop 0
buffer_load_dwordx4 v7,s[28:31],s64 offen nt lds
s_add_u32 s64,s62,524288
s_add_u32 m0,s61,4096
s_nop 0
buffer_load_dwordx4 v7,s[28:31],s64 offen nt lds
s_add_u32 s64,s62,655360
s_add_u32 m0,s61,5120
s_nop 0
buffer_load_dwordx4 v7,s[28:31],s64 offen nt lds
s_add_u32 s64,s62,786432
s_add_u32 m0,s61,6144
s_nop 0
buffer_load_dwordx4 v7,s[28:31],s64 offen nt lds
s_add_u32 s64,s62,917504
s_add_u32 m0,s61,7168
s_nop 0
buffer_load_dwordx4 v7,s[28:31],s64 offen nt lds
s_waitcnt vmcnt(8) lgkmcnt(0)
s_barrier
s_cmp_lg_u32 s50,1
s_cbranch_scc1 ws_11
s_and_b32 s64,s56,1
s_lshl_b32 s64,s64,2
s_add_u32 s64,s64,36
s_mov_b64 exec,1
v_mov_b32 v184,1
v_mov_b32 v185,0
buffer_atomic_add v184,v185,s[44:47],s64 offen sc1
s_mov_b64 exec,-1
ws_11:
s_add_u32 s64,s62,1048576
s_add_u32 m0,s61,8192
s_nop 0
buffer_load_dwordx4 v7,s[28:31],s64 offen nt lds
s_add_u32 s64,s62,1179648
s_add_u32 m0,s61,9216
s_nop 0
buffer_load_dwordx4 v7,s[28:31],s64 offen nt lds
s_add_u32 s64,s62,1310720
s_add_u32 m0,s61,10240
s_nop 0
buffer_load_dwordx4 v7,s[28:31],s64 offen nt lds
s_add_u32 s64,s62,1441792
s_add_u32 m0,s61,11264
s_nop 0
buffer_load_dwordx4 v7,s[28:31],s64 offen nt lds
s_add_u32 s64,s62,1572864
s_add_u32 m0,s61,12288
s_nop 0
buffer_load_dwordx4 v7,s[28:31],s64 offen nt lds
s_add_u32 s64,s62,1703936
s_add_u32 m0,s61,13312
s_nop 0
buffer_load_dwordx4 v7,s[28:31],s64 offen nt lds
s_add_u32 s64,s62,1835008
s_add_u32 m0,s61,14336
s_nop 0
buffer_load_dwordx4 v7,s[28:31],s64 offen nt lds
s_add_u32 s64,s62,1966080
s_add_u32 m0,s61,15360
s_nop 0
buffer_load_dwordx4 v7,s[28:31],s64 offen nt lds
s_mov_b64 exec,0xffffff
buffer_load_dword v201,v11,s[32:35],s65 offen
buffer_load_dword v202,v11,s[36:39],s65 offen
s_mov_b64 exec,0xffff
buffer_load_dword v203,v12,s[40:43],s66 offen
s_mov_b64 exec,-1
s_add_u32 s64,s62,0
s_add_u32 m0,s61,65536
s_nop 0
buffer_load_dwordx4 v7,s[32:35],s64 offen nt lds
s_add_u32 s64,s62,131072
s_add_u32 m0,s61,66560
s_nop 0
buffer_load_dwordx4 v7,s[32:35],s64 offen nt lds
s_add_u32 s64,s62,262144
s_add_u32 m0,s61,67584
s_nop 0
buffer_load_dwordx4 v7,s[32:35],s64 offen nt lds
s_add_u32 s64,s62,393216
s_add_u32 m0,s61,68608
s_nop 0
buffer_load_dwordx4 v7,s[32:35],s64 offen nt lds
s_add_u32 s64,s62,524288
s_add_u32 m0,s61,69632
s_nop 0
buffer_load_dwordx4 v7,s[32:35],s64 offen nt lds
s_add_u32 s64,s62,655360
s_add_u32 m0,s61,70656
s_nop 0
buffer_load_dwordx4 v7,s[32:35],s64 offen nt lds
s_add_u32 s64,s62,786432
s_add_u32 m0,s61,71680
s_nop 0
buffer_load_dwordx4 v7,s[32:35],s64 offen nt lds
s_add_u32 s64,s62,917504
s_add_u32 m0,s61,72704
s_nop 0
buffer_load_dwordx4 v7,s[32:35],s64 offen nt lds
s_add_u32 s64,s62,1048576
s_add_u32 m0,s61,73728
s_nop 0
buffer_load_dwordx4 v7,s[32:35],s64 offen nt lds
s_add_u32 s64,s62,1179648
s_add_u32 m0,s61,74752
s_nop 0
buffer_load_dwordx4 v7,s[32:35],s64 offen nt lds
s_add_u32 s64,s62,1310720
s_add_u32 m0,s61,75776
s_nop 0
buffer_load_dwordx4 v7,s[32:35],s64 offen nt lds
s_add_u32 s64,s62,1441792
s_add_u32 m0,s61,76800
s_nop 0
buffer_load_dwordx4 v7,s[32:35],s64 offen nt lds
s_add_u32 s64,s62,1572864
s_add_u32 m0,s61,77824
s_nop 0
buffer_load_dwordx4 v7,s[32:35],s64 offen nt lds
s_add_u32 s64,s62,1703936
s_add_u32 m0,s61,78848
s_nop 0
buffer_load_dwordx4 v7,s[32:35],s64 offen nt lds
s_add_u32 s64,s62,1835008
s_add_u32 m0,s61,79872
s_nop 0
buffer_load_dwordx4 v7,s[32:35],s64 offen nt lds
s_add_u32 s64,s62,1966080
s_add_u32 m0,s61,80896
s_nop 0
buffer_load_dwordx4 v7,s[32:35],s64 offen nt lds
s_lshl_b32 s64,s59,6
buffer_load_dwordx4 v[216:219],v31,s[8:11],s64 offen
v_lshrrev_b32 v184,3,v3
v_bfe_u32 v185,v3,2,1
v_lshrrev_b32 v186,1,v4
v_and_b32 v187,1,v4
v_lshl_add_u32 v188,v184,3,v185
v_lshl_add_u32 v188,v186,4,v188
v_lshl_add_u32 v188,v187,2,v188
v_lshl_add_u32 v189,v184,2,v185
v_lshl_add_u32 v189,v186,3,v189
v_lshl_add_u32 v189,v187,4,v189
v_and_b32 v187,3,v3
v_lshlrev_b32 v187,3,v187
v_lshl_add_u32 v188,v188,6,v187
v_lshl_add_u32 v189,v189,6,v187
s_lshr_b32 s64,s50,1
s_lshl_b32 s64,s64,5
v_add_u32 v190,s64,v188
v_add_u32 v191,0x10000,v190
s_lshl_b32 s64,s64,10
v_add_u32 v192,s64,v189
s_add_u32 s64,s61,0x10000
v_add_u32 v193,s64,v16
s_add_u32 s68,s50,1
s_mov_b32 s69,0
s_waitcnt vmcnt(20)
s_barrier
s_lshl_b32 s64,s57,9
v_mov_b32 v194,s64
s_add_u32 s65,s64,65024
v_mov_b32 v195,s65
v_cmp_lt_u32 vcc,3,v1
s_nop 1
v_cndmask_b32 v194,v194,v195,vcc
s_lshl_b32 s65,s57,10
s_add_u32 s65,s65,130048
v_mov_b32 v195,s65
v_cmp_lt_u32 vcc,7,v1
s_nop 1
v_cndmask_b32 v194,v194,v195,vcc
s_lshl_b32 s65,s57,11
s_add_u32 s65,s65,260096
v_mov_b32 v195,s65
v_cmp_lt_u32 vcc,15,v1
s_nop 1
v_cndmask_b32 v194,v194,v195,vcc
v_lshl_add_u32 v194,v1,7,v194
s_lshl_b32 s65,s58,7
s_add_u32 s65,s65,524288
v_writelane_b32 v194,s65,32
s_add_u32 s65,s65,512
v_writelane_b32 v194,s65,33
s_lshl_b32 s64,s50,20
s_add_u32 s64,s64,23068672
s_mov_b32 exec_hi,3
buffer_load_dword v183,v194,s[20:23],s64 offen sc1
s_mov_b64 exec,-1
s_and_b32 s65,s50,1
s_lshl_b32 s14,s65,19
s_add_u32 s14,s14,s60
s_lshl_b32 s15,s65,19
s_sub_u32 s15,s63,s15
s_lshl_b32 s65,s65,13
s_add_u32 s65,s65,131072
v_mov_b32 v32,v8
v_add_u32 v33,s65,v16
v_add_u32 v34,s65,v189
v_mov_b32 v35,v7
v_add_u32 v36,131072,v190
v_mov_b32 v37,159008
s_bitcmp1_b32 s68,1
s_cbranch_scc0 ws_12
ds_read_b64_tr_b16 a[0:1],v190 offset:0
ds_read_b64_tr_b16 a[2:3],v190 offset:128
ds_read_b64_tr_b16 a[4:5],v190 offset:2048
ds_read_b64_tr_b16 a[6:7],v190 offset:2176
ds_read_b64_tr_b16 a[8:9],v190 offset:4096
ds_read_b64_tr_b16 a[10:11],v190 offset:4224
ds_read_b64_tr_b16 a[12:13],v190 offset:6144
ds_read_b64_tr_b16 a[14:15],v190 offset:6272
s_waitcnt lgkmcnt(0)
ds_read_b64_tr_b16 a[16:17],v190 offset:8192
ds_read_b64_tr_b16 a[18:19],v190 offset:8320
ds_read_b64_tr_b16 a[20:21],v190 offset:10240
ds_read_b64_tr_b16 a[22:23],v190 offset:10368
ds_read_b64_tr_b16 a[24:25],v190 offset:12288
ds_read_b64_tr_b16 a[26:27],v190 offset:12416
ds_read_b64_tr_b16 a[28:29],v190 offset:14336
ds_read_b64_tr_b16 a[30:31],v190 offset:14464
s_waitcnt lgkmcnt(0)
ds_read_b64_tr_b16 a[32:33],v190 offset:16384
ds_read_b64_tr_b16 a[34:35],v190 offset:16512
ds_read_b64_tr_b16 a[36:37],v190 offset:18432
ds_read_b64_tr_b16 a[38:39],v190 offset:18560
ds_read_b64_tr_b16 a[40:41],v190 offset:20480
ds_read_b64_tr_b16 a[42:43],v190 offset:20608
ds_read_b64_tr_b16 a[44:45],v190 offset:22528
ds_read_b64_tr_b16 a[46:47],v190 offset:22656
s_waitcnt lgkmcnt(0)
ds_read_b64_tr_b16 a[48:49],v190 offset:24576
ds_read_b64_tr_b16 a[50:51],v190 offset:24704
ds_read_b64_tr_b16 a[52:53],v190 offset:26624
ds_read_b64_tr_b16 a[54:55],v190 offset:26752
ds_read_b64_tr_b16 a[56:57],v190 offset:28672
ds_read_b64_tr_b16 a[58:59],v190 offset:28800
ds_read_b64_tr_b16 a[60:61],v190 offset:30720
ds_read_b64_tr_b16 a[62:63],v190 offset:30848
s_waitcnt lgkmcnt(0)
ds_read_b64_tr_b16 a[64:65],v190 offset:32768
ds_read_b64_tr_b16 a[66:67],v190 offset:32896
ds_read_b64_tr_b16 a[68:69],v190 offset:34816
ds_read_b64_tr_b16 a[70:71],v190 offset:34944
ds_read_b64_tr_b16 a[72:73],v190 offset:36864
ds_read_b64_tr_b16 a[74:75],v190 offset:36992
ds_read_b64_tr_b16 a[76:77],v190 offset:38912
ds_read_b64_tr_b16 a[78:79],v190 offset:39040
s_waitcnt lgkmcnt(0)
ds_read_b64_tr_b16 a[80:81],v190 offset:40960
ds_read_b64_tr_b16 a[82:83],v190 offset:41088
ds_read_b64_tr_b16 a[84:85],v190 offset:43008
ds_read_b64_tr_b16 a[86:87],v190 offset:43136
ds_read_b64_tr_b16 a[88:89],v190 offset:45056
ds_read_b64_tr_b16 a[90:91],v190 offset:45184
ds_read_b64_tr_b16 a[92:93],v190 offset:47104
ds_read_b64_tr_b16 a[94:95],v190 offset:47232
s_waitcnt lgkmcnt(0)
ds_read_b64_tr_b16 a[96:97],v190 offset:49152
ds_read_b64_tr_b16 a[98:99],v190 offset:49280
ds_read_b64_tr_b16 a[100:101],v190 offset:51200
ds_read_b64_tr_b16 a[102:103],v190 offset:51328
ds_read_b64_tr_b16 a[104:105],v190 offset:53248
ds_read_b64_tr_b16 a[106:107],v190 offset:53376
ds_read_b64_tr_b16 a[108:109],v190 offset:55296
ds_read_b64_tr_b16 a[110:111],v190 offset:55424
s_waitcnt lgkmcnt(0)
ds_read_b64_tr_b16 a[112:113],v190 offset:57344
ds_read_b64_tr_b16 a[114:115],v190 offset:57472
ds_read_b64_tr_b16 a[116:117],v190 offset:59392
ds_read_b64_tr_b16 a[118:119],v190 offset:59520
ds_read_b64_tr_b16 a[120:121],v190 offset:61440
ds_read_b64_tr_b16 a[122:123],v190 offset:61568
ds_read_b64_tr_b16 a[124:125],v190 offset:63488
ds_read_b64_tr_b16 a[126:127],v190 offset:63616
s_waitcnt lgkmcnt(0)
s_waitcnt vmcnt(0)
s_barrier
ds_read_b64_tr_b16 a[128:129],v191 offset:0
ds_read_b64_tr_b16 a[130:131],v191 offset:128
ds_read_b64_tr_b16 a[132:133],v191 offset:2048
ds_read_b64_tr_b16 a[134:135],v191 offset:2176
ds_read_b64_tr_b16 a[136:137],v191 offset:4096
ds_read_b64_tr_b16 a[138:139],v191 offset:4224
ds_read_b64_tr_b16 a[140:141],v191 offset:6144
ds_read_b64_tr_b16 a[142:143],v191 offset:6272
s_waitcnt lgkmcnt(0)
ds_read_b64_tr_b16 a[144:145],v191 offset:8192
ds_read_b64_tr_b16 a[146:147],v191 offset:8320
ds_read_b64_tr_b16 a[148:149],v191 offset:10240
ds_read_b64_tr_b16 a[150:151],v191 offset:10368
ds_read_b64_tr_b16 a[152:153],v191 offset:12288
ds_read_b64_tr_b16 a[154:155],v191 offset:12416
ds_read_b64_tr_b16 a[156:157],v191 offset:14336
ds_read_b64_tr_b16 a[158:159],v191 offset:14464
s_waitcnt lgkmcnt(0)
ds_read_b64_tr_b16 a[160:161],v191 offset:16384
ds_read_b64_tr_b16 a[162:163],v191 offset:16512
ds_read_b64_tr_b16 a[164:165],v191 offset:18432
ds_read_b64_tr_b16 a[166:167],v191 offset:18560
ds_read_b64_tr_b16 a[168:169],v191 offset:20480
ds_read_b64_tr_b16 a[170:171],v191 offset:20608
ds_read_b64_tr_b16 a[172:173],v191 offset:22528
ds_read_b64_tr_b16 a[174:175],v191 offset:22656
s_waitcnt lgkmcnt(0)
ds_read_b64_tr_b16 a[176:177],v191 offset:24576
ds_read_b64_tr_b16 a[178:179],v191 offset:24704
ds_read_b64_tr_b16 a[180:181],v191 offset:26624
ds_read_b64_tr_b16 a[182:183],v191 offset:26752
ds_read_b64_tr_b16 a[184:185],v191 offset:28672
ds_read_b64_tr_b16 a[186:187],v191 offset:28800
ds_read_b64_tr_b16 a[188:189],v191 offset:30720
ds_read_b64_tr_b16 a[190:191],v191 offset:30848
s_waitcnt lgkmcnt(0)
ds_read_b64_tr_b16 a[192:193],v191 offset:32768
ds_read_b64_tr_b16 a[194:195],v191 offset:32896
ds_read_b64_tr_b16 a[196:197],v191 offset:34816
ds_read_b64_tr_b16 a[198:199],v191 offset:34944
ds_read_b64_tr_b16 a[200:201],v191 offset:36864
ds_read_b64_tr_b16 a[202:203],v191 offset:36992
ds_read_b64_tr_b16 a[204:205],v191 offset:38912
ds_read_b64_tr_b16 a[206:207],v191 offset:39040
s_waitcnt lgkmcnt(0)
ds_read_b64_tr_b16 a[208:209],v191 offset:40960
ds_read_b64_tr_b16 a[210:211],v191 offset:41088
ds_read_b64_tr_b16 a[212:213],v191 offset:43008
ds_read_b64_tr_b16 a[214:215],v191 offset:43136
ds_read_b64_tr_b16 a[216:217],v191 offset:45056
ds_read_b64_tr_b16 a[218:219],v191 offset:45184
ds_read_b64_tr_b16 a[220:221],v191 offset:47104
ds_read_b64_tr_b16 a[222:223],v191 offset:47232
s_waitcnt lgkmcnt(0)
ds_read_b64_tr_b16 a[224:225],v191 offset:49152
ds_read_b64_tr_b16 a[226:227],v191 offset:49280
ds_read_b64_tr_b16 a[228:229],v191 offset:51200
ds_read_b64_tr_b16 a[230:231],v191 offset:51328
ds_read_b64_tr_b16 a[232:233],v191 offset:53248
ds_read_b64_tr_b16 a[234:235],v191 offset:53376
ds_read_b64_tr_b16 a[236:237],v191 offset:55296
ds_read_b64_tr_b16 a[238:239],v191 offset:55424
s_waitcnt lgkmcnt(0)
ds_read_b64_tr_b16 a[240:241],v191 offset:57344
ds_read_b64_tr_b16 a[242:243],v191 offset:57472
ds_read_b64_tr_b16 a[244:245],v191 offset:59392
ds_read_b64_tr_b16 a[246:247],v191 offset:59520
ds_read_b64_tr_b16 a[248:249],v191 offset:61440
ds_read_b64_tr_b16 a[250:251],v191 offset:61568
ds_read_b64_tr_b16 a[252:253],v191 offset:63488
ds_read_b64_tr_b16 a[254:255],v191 offset:63616
s_waitcnt lgkmcnt(0)
s_branch ws_14
ws_12:
s_add_u32 s64,s14,0
buffer_load_dwordx4 a[0:3],v35,s[36:39],s64 offen nt
s_add_u32 s64,s14,131072
buffer_load_dwordx4 a[4:7],v35,s[36:39],s64 offen nt
s_add_u32 s64,s14,262144
buffer_load_dwordx4 a[8:11],v35,s[36:39],s64 offen nt
s_add_u32 s64,s14,393216
buffer_load_dwordx4 a[12:15],v35,s[36:39],s64 offen nt
s_add_u32 s64,s14,1048576
buffer_load_dwordx4 a[16:19],v35,s[36:39],s64 offen nt
s_add_u32 s64,s14,1179648
buffer_load_dwordx4 a[20:23],v35,s[36:39],s64 offen nt
s_add_u32 s64,s14,1310720
buffer_load_dwordx4 a[24:27],v35,s[36:39],s64 offen nt
s_add_u32 s64,s14,1441792
buffer_load_dwordx4 a[28:31],v35,s[36:39],s64 offen nt
s_add_u32 s64,s14,2097152
buffer_load_dwordx4 a[32:35],v35,s[36:39],s64 offen nt
s_add_u32 s64,s14,2228224
buffer_load_dwordx4 a[36:39],v35,s[36:39],s64 offen nt
s_add_u32 s64,s14,2359296
buffer_load_dwordx4 a[40:43],v35,s[36:39],s64 offen nt
s_add_u32 s64,s14,2490368
buffer_load_dwordx4 a[44:47],v35,s[36:39],s64 offen nt
s_add_u32 s64,s14,3145728
buffer_load_dwordx4 a[48:51],v35,s[36:39],s64 offen nt
s_add_u32 s64,s14,3276800
buffer_load_dwordx4 a[52:55],v35,s[36:39],s64 offen nt
s_add_u32 s64,s14,3407872
buffer_load_dwordx4 a[56:59],v35,s[36:39],s64 offen nt
s_add_u32 s64,s14,3538944
buffer_load_dwordx4 a[60:63],v35,s[36:39],s64 offen nt
s_add_u32 s64,s14,4194304
buffer_load_dwordx4 a[64:67],v35,s[36:39],s64 offen nt
s_add_u32 s64,s14,4325376
buffer_load_dwordx4 a[68:71],v35,s[36:39],s64 offen nt
s_add_u32 s64,s14,4456448
buffer_load_dwordx4 a[72:75],v35,s[36:39],s64 offen nt
s_add_u32 s64,s14,4587520
buffer_load_dwordx4 a[76:79],v35,s[36:39],s64 offen nt
s_add_u32 s64,s14,5242880
buffer_load_dwordx4 a[80:83],v35,s[36:39],s64 offen nt
s_add_u32 s64,s14,5373952
buffer_load_dwordx4 a[84:87],v35,s[36:39],s64 offen nt
s_add_u32 s64,s14,5505024
buffer_load_dwordx4 a[88:91],v35,s[36:39],s64 offen nt
s_add_u32 s64,s14,5636096
buffer_load_dwordx4 a[92:95],v35,s[36:39],s64 offen nt
s_add_u32 s64,s14,6291456
buffer_load_dwordx4 a[96:99],v35,s[36:39],s64 offen nt
s_add_u32 s64,s14,6422528
buffer_load_dwordx4 a[100:103],v35,s[36:39],s64 offen nt
s_add_u32 s64,s14,6553600
buffer_load_dwordx4 a[104:107],v35,s[36:39],s64 offen nt
s_add_u32 s64,s14,6684672
buffer_load_dwordx4 a[108:111],v35,s[36:39],s64 offen nt
s_add_u32 s64,s14,7340032
buffer_load_dwordx4 a[112:115],v35,s[36:39],s64 offen nt
s_add_u32 s64,s14,7471104
buffer_load_dwordx4 a[116:119],v35,s[36:39],s64 offen nt
s_add_u32 s64,s14,7602176
buffer_load_dwordx4 a[120:123],v35,s[36:39],s64 offen nt
s_add_u32 s64,s14,7733248
buffer_load_dwordx4 a[124:127],v35,s[36:39],s64 offen nt
s_add_u32 s64,s15,0
buffer_load_dwordx4 a[128:131],v32,s[40:43],s64 offen nt
s_add_u32 s64,s15,32768
buffer_load_dwordx4 a[132:135],v32,s[40:43],s64 offen nt
s_add_u32 s64,s15,65536
buffer_load_dwordx4 a[136:139],v32,s[40:43],s64 offen nt
s_add_u32 s64,s15,98304
buffer_load_dwordx4 a[140:143],v32,s[40:43],s64 offen nt
s_add_u32 s64,s15,131072
buffer_load_dwordx4 a[144:147],v32,s[40:43],s64 offen nt
s_add_u32 s64,s15,163840
buffer_load_dwordx4 a[148:151],v32,s[40:43],s64 offen nt
s_add_u32 s64,s15,196608
buffer_load_dwordx4 a[152:155],v32,s[40:43],s64 offen nt
s_add_u32 s64,s15,229376
buffer_load_dwordx4 a[156:159],v32,s[40:43],s64 offen nt
s_add_u32 s64,s15,262144
buffer_load_dwordx4 a[160:163],v32,s[40:43],s64 offen nt
s_add_u32 s64,s15,294912
buffer_load_dwordx4 a[164:167],v32,s[40:43],s64 offen nt
s_add_u32 s64,s15,327680
buffer_load_dwordx4 a[168:171],v32,s[40:43],s64 offen nt
s_add_u32 s64,s15,360448
buffer_load_dwordx4 a[172:175],v32,s[40:43],s64 offen nt
s_waitcnt vmcnt(44)
s_barrier
ws_14:
v_mov_b32 v187,158976
s_cmp_lg_u32 s50,1
s_cbranch_scc1 sh0_17
s_mov_b32 s53,0
stl_18:
s_add_u32 s64,s52,32
s_buffer_load_dwordx8 s[72:79],s[20:23],s52 glc
s_buffer_load_dwordx8 s[80:87],s[20:23],s64 glc
s_waitcnt lgkmcnt(0)
s_min_u32 s72,s72,s80
s_min_u32 s73,s73,s81
s_min_u32 s74,s74,s82
s_min_u32 s75,s75,s83
s_min_u32 s76,s76,s84
s_min_u32 s77,s77,s85
s_min_u32 s78,s78,s86
s_min_u32 s79,s79,s87
s_min_u32 s72,s72,s76
s_min_u32 s73,s73,s77
s_min_u32 s74,s74,s78
s_min_u32 s75,s75,s79
s_min_u32 s72,s72,s74
s_min_u32 s73,s73,s75
s_min_u32 s64,s72,s73
s_mov_b32 s65,0
s_and_b32 s61,s64,1
s_lshl_b32 s61,s61,13
s_cmp_lg_u32 s64,0
s_cbranch_scc1 stok_19
s_sub_u32 s90,s90,1
s_cmp_lt_i32 s90,0
s_cbranch_scc1 stok_19
s_add_u32 s53,s53,1
s_and_b32 s64,s53,31
s_cbranch_scc1 stl_18
s_cmp_eq_u32 s56,1
s_cbranch_scc1 stl_18
v_and_b32 v184,3,v1
v_bfe_u32 v185,v1,2,1
v_lshlrev_b32 v184,2,v184
v_lshl_add_u32 v184,v185,7,v184
v_writelane_b32 v184,32,8
s_mov_b64 exec,0x1ff
vpoll_20:
buffer_load_dword v185,v184,s[44:47],0 offen sc1
s_waitcnt vmcnt(0)
vfirst_23:
v_readlane_b32 s92,v185,0
v_readlane_b32 s93,v185,1
v_readlane_b32 s94,v185,2
v_readlane_b32 s95,v185,3
v_readlane_b32 s96,v185,4
v_readlane_b32 s97,v185,5
v_readlane_b32 s98,v185,6
v_readlane_b32 s99,v185,7
v_readlane_b32 s61,v185,8
s_add_u32 s64,s92,s93
s_add_u32 s64,s64,s94
s_add_u32 s64,s64,s95
s_add_u32 s64,s64,s96
s_add_u32 s64,s64,s97
s_add_u32 s64,s64,s98
s_add_u32 s64,s64,s99
s_min_u32 s65,s92,s93
s_min_u32 s66,s94,s95
s_min_u32 s65,s65,s66
s_min_u32 s66,s96,s97
s_min_u32 s65,s65,s66
s_min_u32 s66,s98,s99
s_min_u32 s65,s65,s66
s_cmp_lt_u32 s65,32
s_cselect_b32 s65,1,0
s_cmp_lt_u32 s64,256
s_cbranch_scc1 vslp_22
s_branch vgot_21
vslp_22:
s_sleep 8
s_sub_u32 s90,s90,1
s_cmp_gt_i32 s90,0
s_cbranch_scc1 vpoll_20
vgot_21:
s_mov_b64 exec,-1
s_and_b32 s61,s61,1
s_lshl_b32 s61,s61,13
s_mov_b32 s66,s54
s_cmp_gt_u32 s51,0
s_cselect_b32 s64,s92,0
s_add_u32 s66,s66,s64
s_cmp_gt_u32 s51,1
s_cselect_b32 s64,s93,0
s_add_u32 s66,s66,s64
s_cmp_gt_u32 s51,2
s_cselect_b32 s64,s94,0
s_add_u32 s66,s66,s64
s_cmp_gt_u32 s51,3
s_cselect_b32 s64,s95,0
s_add_u32 s66,s66,s64
s_cmp_gt_u32 s51,4
s_cselect_b32 s64,s96,0
s_add_u32 s66,s66,s64
s_cmp_gt_u32 s51,5
s_cselect_b32 s64,s97,0
s_add_u32 s66,s66,s64
s_cmp_gt_u32 s51,6
s_cselect_b32 s64,s98,0
s_add_u32 s66,s66,s64
s_cmp_eq_u32 s65,0
s_cbranch_scc1 stl_18
stok_19:
v_mov_b32 v184,s65
v_mov_b32 v185,s66
v_mov_b32 v186,s61
ds_write_b96 v187,v[184:186] offset:16
s_waitcnt lgkmcnt(0)
sh0_17:
s_barrier
ds_read_b96 v[184:186],v187 offset:16
s_waitcnt lgkmcnt(0)
v_readfirstlane_b32 s65,v184
v_readfirstlane_b32 s66,v185
v_readfirstlane_b32 s61,v186
s_cmp_lg_u32 s65,0
s_cbranch_scc1 slowrole_10
s_and_b32 s56,s56,1
s_branch loops_7
pre_8:
s_sub_u32 s55,s57,128
s_load_dwordx4 s[4:7],s[0:1],96
s_load_dwordx2 s[8:9],s[0:1],0
v_and_b32 v1,63,v0
v_lshrrev_b32 v2,6,v0
v_and_b32 v3,7,v0
v_lshrrev_b32 v4,3,v0
v_mul_u32_u24 v5,12288,v4
v_lshl_add_u32 v5,v3,4,v5
v_lshlrev_b32 v6,1,v4
s_and_b32 s24,s55,31
s_lshr_b32 s25,s55,5
s_lshl_b32 s26,s24,7
s_mul_i32 s27,s25,3145728
s_add_u32 s26,s26,s27
s_lshl_b32 s27,s25,9
s_waitcnt lgkmcnt(0)
s_mov_b32 s12,s4
s_and_b32 s13,s5,0xffff
s_mov_b32 s14,0x800
s_mov_b32 s15,0x20000
s_mov_b32 s28,s6
s_and_b32 s29,s7,0xffff
s_mov_b32 s30,0xc00000
s_mov_b32 s31,0x20000
s_mov_b32 s32,s8
s_and_b32 s33,s9,0xffff
s_mov_b32 s34,0x400000
s_mov_b32 s35,0x20000
buffer_load_dwordx4 v[64:67],v5,s[28:31],s26 offen nt
s_add_u32 s26,s26,393216
buffer_load_dwordx4 v[68:71],v5,s[28:31],s26 offen nt
s_add_u32 s26,s26,393216
buffer_load_dwordx4 v[72:75],v5,s[28:31],s26 offen nt
s_add_u32 s26,s26,393216
buffer_load_dwordx4 v[76:79],v5,s[28:31],s26 offen nt
s_add_u32 s26,s26,393216
buffer_load_dwordx4 v[80:83],v5,s[28:31],s26 offen nt
s_add_u32 s26,s26,393216
buffer_load_dwordx4 v[84:87],v5,s[28:31],s26 offen nt
s_add_u32 s26,s26,393216
buffer_load_dwordx4 v[88:91],v5,s[28:31],s26 offen nt
s_add_u32 s26,s26,393216
buffer_load_dwordx4 v[92:95],v5,s[28:31],s26 offen nt
buffer_load_ushort v96,v6,s[12:15],s27 offen offset:0
buffer_load_ushort v97,v6,s[12:15],s27 offen offset:64
buffer_load_ushort v98,v6,s[12:15],s27 offen offset:128
buffer_load_ushort v99,v6,s[12:15],s27 offen offset:192
buffer_load_ushort v100,v6,s[12:15],s27 offen offset:256
buffer_load_ushort v101,v6,s[12:15],s27 offen offset:320
buffer_load_ushort v102,v6,s[12:15],s27 offen offset:384
buffer_load_ushort v103,v6,s[12:15],s27 offen offset:448
v_and_b32 v3,3,v1
v_lshrrev_b32 v4,2,v1
v_lshl_add_u32 v5,v2,2,v3
v_lshlrev_b32 v5,11,v5
v_lshl_add_u32 v5,v4,5,v5
s_lshl_b32 s36,s55,15
s_cmp_lt_u32 s55,16
s_cselect_b32 s42,s36,0x7fff0000
s_cselect_b32 s36,0x7fff0000,s36
buffer_load_dwordx4 v[8:11],v5,s[32:35],s42 offen offset:0
buffer_load_dwordx4 v[12:15],v5,s[32:35],s42 offen offset:16
buffer_load_dwordx4 v[16:19],v5,s[32:35],s42 offen offset:512
buffer_load_dwordx4 v[20:23],v5,s[32:35],s42 offen offset:528
buffer_load_dwordx4 v[24:27],v5,s[32:35],s42 offen offset:1024
buffer_load_dwordx4 v[28:31],v5,s[32:35],s42 offen offset:1040
buffer_load_dwordx4 v[32:35],v5,s[32:35],s42 offen offset:1536
buffer_load_dwordx4 v[36:39],v5,s[32:35],s42 offen offset:1552
v_lshrrev_b32 v6,1,v4
v_lshlrev_b32 v6,11,v6
v_and_b32 v7,1,v4
v_lshl_add_u32 v6,v7,9,v6
v_and_b32 v7,1,v2
v_lshl_add_u32 v6,v7,10,v6
v_lshrrev_b32 v7,1,v2
v_lshl_add_u32 v7,v7,2,v3
v_lshl_add_u32 v6,v7,4,v6
v_lshlrev_b32 v4,6,v4
s_lshr_b32 s37,s55,1
s_lshl_b32 s37,s37,16
s_and_b32 s38,s55,1
s_lshl_b32 s38,s38,7
s_add_u32 s37,s37,s38
s_add_u32 s37,s37,57344
s_mov_b32 s38,0xbfb8aa3b
s_mov_b32 s39,0xffff0000
s_cmp_lg_u32 s50,1
s_cbranch_scc1 nz_24
s_lshl_b32 s40,s55,9
s_add_u32 s40,s40,21037056
v_lshl_add_u32 v104,v1,4,s40
s_lshl_b32 s41,s55,7
s_add_u32 s41,s41,21102592
v_writelane_b32 v104,s41,32
v_mov_b32 v108,0
v_mov_b32 v109,0
v_mov_b32 v110,0
v_mov_b32 v111,0
s_mov_b32 exec_hi,1
buffer_store_dwordx4 v[108:111],v104,s[20:23],0 offen sc1
s_mov_b64 exec,-1
nz_24:
v_mov_b32 v112,0
v_mov_b32 v113,0
v_mov_b32 v114,0
v_mov_b32 v115,0
v_mov_b32 v116,0
v_mov_b32 v117,0
v_mov_b32 v118,0
v_mov_b32 v119,0
s_waitcnt vmcnt(8)
v_lshlrev_b32 v96,16,v96
v_mul_f32 v104,s38,v96
v_exp_f32 v104,v104
s_nop 0
v_add_f32 v104,1.0,v104
v_rcp_f32 v104,v104
s_nop 0
v_mul_f32 v104,v104,v96
v_cvt_pk_bf16_f32 v104,v104,v104
v_and_b32 v96,s39,v104
v_lshlrev_b32 v105,16,v64
v_and_b32 v106,s39,v64
v_fmac_f32 v112,v105,v96
v_fmac_f32 v113,v106,v96
v_lshlrev_b32 v105,16,v65
v_and_b32 v106,s39,v65
v_fmac_f32 v114,v105,v96
v_fmac_f32 v115,v106,v96
v_lshlrev_b32 v105,16,v66
v_and_b32 v106,s39,v66
v_fmac_f32 v116,v105,v96
v_fmac_f32 v117,v106,v96
v_lshlrev_b32 v105,16,v67
v_and_b32 v106,s39,v67
v_fmac_f32 v118,v105,v96
v_fmac_f32 v119,v106,v96
v_lshlrev_b32 v97,16,v97
v_mul_f32 v104,s38,v97
v_exp_f32 v104,v104
s_nop 0
v_add_f32 v104,1.0,v104
v_rcp_f32 v104,v104
s_nop 0
v_mul_f32 v104,v104,v97
v_cvt_pk_bf16_f32 v104,v104,v104
v_and_b32 v97,s39,v104
v_lshlrev_b32 v105,16,v68
v_and_b32 v106,s39,v68
v_fmac_f32 v112,v105,v97
v_fmac_f32 v113,v106,v97
v_lshlrev_b32 v105,16,v69
v_and_b32 v106,s39,v69
v_fmac_f32 v114,v105,v97
v_fmac_f32 v115,v106,v97
v_lshlrev_b32 v105,16,v70
v_and_b32 v106,s39,v70
v_fmac_f32 v116,v105,v97
v_fmac_f32 v117,v106,v97
v_lshlrev_b32 v105,16,v71
v_and_b32 v106,s39,v71
v_fmac_f32 v118,v105,v97
v_fmac_f32 v119,v106,v97
v_lshlrev_b32 v98,16,v98
v_mul_f32 v104,s38,v98
v_exp_f32 v104,v104
s_nop 0
v_add_f32 v104,1.0,v104
v_rcp_f32 v104,v104
s_nop 0
v_mul_f32 v104,v104,v98
v_cvt_pk_bf16_f32 v104,v104,v104
v_and_b32 v98,s39,v104
v_lshlrev_b32 v105,16,v72
v_and_b32 v106,s39,v72
v_fmac_f32 v112,v105,v98
v_fmac_f32 v113,v106,v98
v_lshlrev_b32 v105,16,v73
v_and_b32 v106,s39,v73
v_fmac_f32 v114,v105,v98
v_fmac_f32 v115,v106,v98
v_lshlrev_b32 v105,16,v74
v_and_b32 v106,s39,v74
v_fmac_f32 v116,v105,v98
v_fmac_f32 v117,v106,v98
v_lshlrev_b32 v105,16,v75
v_and_b32 v106,s39,v75
v_fmac_f32 v118,v105,v98
v_fmac_f32 v119,v106,v98
v_lshlrev_b32 v99,16,v99
v_mul_f32 v104,s38,v99
v_exp_f32 v104,v104
s_nop 0
v_add_f32 v104,1.0,v104
v_rcp_f32 v104,v104
s_nop 0
v_mul_f32 v104,v104,v99
v_cvt_pk_bf16_f32 v104,v104,v104
v_and_b32 v99,s39,v104
v_lshlrev_b32 v105,16,v76
v_and_b32 v106,s39,v76
v_fmac_f32 v112,v105,v99
v_fmac_f32 v113,v106,v99
v_lshlrev_b32 v105,16,v77
v_and_b32 v106,s39,v77
v_fmac_f32 v114,v105,v99
v_fmac_f32 v115,v106,v99
v_lshlrev_b32 v105,16,v78
v_and_b32 v106,s39,v78
v_fmac_f32 v116,v105,v99
v_fmac_f32 v117,v106,v99
v_lshlrev_b32 v105,16,v79
v_and_b32 v106,s39,v79
v_fmac_f32 v118,v105,v99
v_fmac_f32 v119,v106,v99
v_lshlrev_b32 v100,16,v100
v_mul_f32 v104,s38,v100
v_exp_f32 v104,v104
s_nop 0
v_add_f32 v104,1.0,v104
v_rcp_f32 v104,v104
s_nop 0
v_mul_f32 v104,v104,v100
v_cvt_pk_bf16_f32 v104,v104,v104
v_and_b32 v100,s39,v104
v_lshlrev_b32 v105,16,v80
v_and_b32 v106,s39,v80
v_fmac_f32 v112,v105,v100
v_fmac_f32 v113,v106,v100
v_lshlrev_b32 v105,16,v81
v_and_b32 v106,s39,v81
v_fmac_f32 v114,v105,v100
v_fmac_f32 v115,v106,v100
v_lshlrev_b32 v105,16,v82
v_and_b32 v106,s39,v82
v_fmac_f32 v116,v105,v100
v_fmac_f32 v117,v106,v100
v_lshlrev_b32 v105,16,v83
v_and_b32 v106,s39,v83
v_fmac_f32 v118,v105,v100
v_fmac_f32 v119,v106,v100
v_lshlrev_b32 v101,16,v101
v_mul_f32 v104,s38,v101
v_exp_f32 v104,v104
s_nop 0
v_add_f32 v104,1.0,v104
v_rcp_f32 v104,v104
s_nop 0
v_mul_f32 v104,v104,v101
v_cvt_pk_bf16_f32 v104,v104,v104
v_and_b32 v101,s39,v104
v_lshlrev_b32 v105,16,v84
v_and_b32 v106,s39,v84
v_fmac_f32 v112,v105,v101
v_fmac_f32 v113,v106,v101
v_lshlrev_b32 v105,16,v85
v_and_b32 v106,s39,v85
v_fmac_f32 v114,v105,v101
v_fmac_f32 v115,v106,v101
v_lshlrev_b32 v105,16,v86
v_and_b32 v106,s39,v86
v_fmac_f32 v116,v105,v101
v_fmac_f32 v117,v106,v101
v_lshlrev_b32 v105,16,v87
v_and_b32 v106,s39,v87
v_fmac_f32 v118,v105,v101
v_fmac_f32 v119,v106,v101
v_lshlrev_b32 v102,16,v102
v_mul_f32 v104,s38,v102
v_exp_f32 v104,v104
s_nop 0
v_add_f32 v104,1.0,v104
v_rcp_f32 v104,v104
s_nop 0
v_mul_f32 v104,v104,v102
v_cvt_pk_bf16_f32 v104,v104,v104
v_and_b32 v102,s39,v104
v_lshlrev_b32 v105,16,v88
v_and_b32 v106,s39,v88
v_fmac_f32 v112,v105,v102
v_fmac_f32 v113,v106,v102
v_lshlrev_b32 v105,16,v89
v_and_b32 v106,s39,v89
v_fmac_f32 v114,v105,v102
v_fmac_f32 v115,v106,v102
v_lshlrev_b32 v105,16,v90
v_and_b32 v106,s39,v90
v_fmac_f32 v116,v105,v102
v_fmac_f32 v117,v106,v102
v_lshlrev_b32 v105,16,v91
v_and_b32 v106,s39,v91
v_fmac_f32 v118,v105,v102
v_fmac_f32 v119,v106,v102
v_lshlrev_b32 v103,16,v103
v_mul_f32 v104,s38,v103
v_exp_f32 v104,v104
s_nop 0
v_add_f32 v104,1.0,v104
v_rcp_f32 v104,v104
s_nop 0
v_mul_f32 v104,v104,v103
v_cvt_pk_bf16_f32 v104,v104,v104
v_and_b32 v103,s39,v104
v_lshlrev_b32 v105,16,v92
v_and_b32 v106,s39,v92
v_fmac_f32 v112,v105,v103
v_fmac_f32 v113,v106,v103
v_lshlrev_b32 v105,16,v93
v_and_b32 v106,s39,v93
v_fmac_f32 v114,v105,v103
v_fmac_f32 v115,v106,v103
v_lshlrev_b32 v105,16,v94
v_and_b32 v106,s39,v94
v_fmac_f32 v116,v105,v103
v_fmac_f32 v117,v106,v103
v_lshlrev_b32 v105,16,v95
v_and_b32 v106,s39,v95
v_fmac_f32 v118,v105,v103
v_fmac_f32 v119,v106,v103
v_permlane32_swap_b32 v112,v116
v_permlane32_swap_b32 v113,v117
v_permlane32_swap_b32 v114,v118
v_permlane32_swap_b32 v115,v119
v_add_f32 v112,v112,v116
v_add_f32 v113,v113,v117
v_add_f32 v114,v114,v118
v_add_f32 v115,v115,v119
s_nop 0
v_permlane16_swap_b32 v112,v114
v_permlane16_swap_b32 v113,v115
v_add_f32 v112,v112,v114
v_add_f32 v113,v113,v115
s_nop 0
v_add_f32_dpp v112,v112,v112 row_ror:8 row_mask:0xf bank_mask:0xf
v_add_f32_dpp v113,v113,v113 row_ror:8 row_mask:0xf bank_mask:0xf
v_and_b32 v104,7,v1
v_lshlrev_b32 v104,5,v104
v_lshrrev_b32 v105,5,v1
v_lshl_add_u32 v104,v105,4,v104
v_bfe_u32 v105,v1,4,1
v_lshl_add_u32 v104,v105,3,v104
v_lshl_add_u32 v104,v2,8,v104
ds_write_b64 v104,v[112:113]
v_lshlrev_b32 v105,2,v1
s_lshl_b32 s40,s25,13
s_lshl_b32 s41,s24,8
s_add_u32 s40,s40,s41
s_add_u32 s40,s40,24576
s_waitcnt lgkmcnt(0)
s_barrier
s_cmp_lg_u32 s50,0
s_cbranch_scc1 m1n0_25
ds_read_b32 v112,v105 offset:0
ds_read_b32 v113,v105 offset:256
ds_read_b32 v114,v105 offset:512
ds_read_b32 v115,v105 offset:768
s_waitcnt lgkmcnt(0)
v_add_f32 v112,v112,v113
v_add_f32 v114,v114,v115
v_add_f32 v112,v112,v114
buffer_store_dword v112,v105,s[20:23],s40 offen sc1
m1n0_25:
s_waitcnt vmcnt(0)
s_barrier
s_cmp_lg_u32 s50,0
s_cbranch_scc1 post_9
s_mov_b64 exec,1
v_mov_b32 v184,1
v_mov_b32 v185,0
s_and_b32 s52,s56,1
s_lshl_b32 s52,s52,2
s_add_u32 s52,s52,160
buffer_atomic_add v184,v185,s[44:47],s52 offen sc0 sc1
s_waitcnt vmcnt(0)
v_readfirstlane_b32 s64,v184
s_mov_b64 exec,-1
s_cmp_eq_u32 s56,1
s_cbranch_scc1 post_9
s_cmp_lg_u32 s64,127
s_cbranch_scc1 post_9
v_and_b32 v184,3,v1
v_bfe_u32 v185,v1,2,1
v_lshlrev_b32 v184,2,v184
v_lshl_add_u32 v184,v185,7,v184
v_writelane_b32 v184,32,8
s_mov_b64 exec,0x1ff
vpoll_27:
buffer_load_dword v185,v184,s[44:47],0 offen sc1
s_waitcnt vmcnt(0)
vfirst_30:
v_readlane_b32 s92,v185,0
v_readlane_b32 s93,v185,1
v_readlane_b32 s94,v185,2
v_readlane_b32 s95,v185,3
v_readlane_b32 s96,v185,4
v_readlane_b32 s97,v185,5
v_readlane_b32 s98,v185,6
v_readlane_b32 s99,v185,7
v_readlane_b32 s61,v185,8
s_add_u32 s64,s92,s93
s_add_u32 s64,s64,s94
s_add_u32 s64,s64,s95
s_add_u32 s64,s64,s96
s_add_u32 s64,s64,s97
s_add_u32 s64,s64,s98
s_add_u32 s64,s64,s99
s_min_u32 s65,s92,s93
s_min_u32 s66,s94,s95
s_min_u32 s65,s65,s66
s_min_u32 s66,s96,s97
s_min_u32 s65,s65,s66
s_min_u32 s66,s98,s99
s_min_u32 s65,s65,s66
s_cmp_lt_u32 s65,32
s_cselect_b32 s65,1,0
s_cmp_lt_u32 s64,256
s_cbranch_scc1 vslp_29
s_branch vgot_28
vslp_29:
s_sleep 8
s_sub_u32 s90,s90,1
s_cmp_gt_i32 s90,0
s_cbranch_scc1 vpoll_27
vgot_28:
s_mov_b64 exec,-1
s_and_b32 s61,s61,1
s_lshl_b32 s61,s61,13
s_cmp_lg_u32 s65,0
s_cbranch_scc1 post_9
v_lshlrev_b32 v184,7,v1
v_mov_b32 v185,1
s_mov_b32 s64,21102592
s_mov_b32 s65,21110784
buffer_store_dword v185,v184,s[20:23],s64 offen sc1
buffer_store_dword v185,v184,s[20:23],s65 offen sc1
s_branch post_9
verify_6:
v_mov_b32 v187,158976
s_cmp_lg_u32 s50,0
s_cbranch_scc1 sh0_31
v_and_b32 v184,3,v1
v_bfe_u32 v185,v1,2,1
v_lshlrev_b32 v184,2,v184
v_lshl_add_u32 v184,v185,7,v184
v_writelane_b32 v184,32,8
s_mov_b64 exec,0x1ff
vpoll_32:
buffer_load_dword v185,v184,s[44:47],0 offen sc1
s_waitcnt vmcnt(0)
vfirst_35:
v_readlane_b32 s92,v185,0
v_readlane_b32 s93,v185,1
v_readlane_b32 s94,v185,2
v_readlane_b32 s95,v185,3
v_readlane_b32 s96,v185,4
v_readlane_b32 s97,v185,5
v_readlane_b32 s98,v185,6
v_readlane_b32 s99,v185,7
v_readlane_b32 s61,v185,8
s_add_u32 s64,s92,s93
s_add_u32 s64,s64,s94
s_add_u32 s64,s64,s95
s_add_u32 s64,s64,s96
s_add_u32 s64,s64,s97
s_add_u32 s64,s64,s98
s_add_u32 s64,s64,s99
s_min_u32 s65,s92,s93
s_min_u32 s66,s94,s95
s_min_u32 s65,s65,s66
s_min_u32 s66,s96,s97
s_min_u32 s65,s65,s66
s_min_u32 s66,s98,s99
s_min_u32 s65,s65,s66
s_cmp_lt_u32 s65,32
s_cselect_b32 s65,1,0
s_cmp_lt_u32 s64,256
s_cbranch_scc1 vslp_34
s_branch vgot_33
vslp_34:
s_sleep 8
s_sub_u32 s90,s90,1
s_cmp_gt_i32 s90,0
s_cbranch_scc1 vpoll_32
vgot_33:
s_mov_b64 exec,-1
s_and_b32 s61,s61,1
s_lshl_b32 s61,s61,13
s_mov_b32 s66,s54
s_cmp_gt_u32 s51,0
s_cselect_b32 s64,s92,0
s_add_u32 s66,s66,s64
s_cmp_gt_u32 s51,1
s_cselect_b32 s64,s93,0
s_add_u32 s66,s66,s64
s_cmp_gt_u32 s51,2
s_cselect_b32 s64,s94,0
s_add_u32 s66,s66,s64
s_cmp_gt_u32 s51,3
s_cselect_b32 s64,s95,0
s_add_u32 s66,s66,s64
s_cmp_gt_u32 s51,4
s_cselect_b32 s64,s96,0
s_add_u32 s66,s66,s64
s_cmp_gt_u32 s51,5
s_cselect_b32 s64,s97,0
s_add_u32 s66,s66,s64
s_cmp_gt_u32 s51,6
s_cselect_b32 s64,s98,0
s_add_u32 s66,s66,s64
v_mov_b32 v184,s65
v_mov_b32 v185,s66
v_mov_b32 v186,s61
ds_write_b96 v187,v[184:186] offset:16
s_waitcnt lgkmcnt(0)
sh0_31:
s_barrier
ds_read_b96 v[184:186],v187 offset:16
s_waitcnt lgkmcnt(0)
v_readfirstlane_b32 s65,v184
v_readfirstlane_b32 s66,v185
v_readfirstlane_b32 s61,v186
s_cmp_lg_u32 s65,0
s_cbranch_scc1 slowrole_10
s_mov_b32 s56,0
s_branch done_1
slowrole_10:
s_mov_b32 s57,s66
s_mov_b32 s56,1
s_waitcnt vmcnt(0)
s_barrier
s_cmp_ge_u32 s57,128
s_cbranch_scc1 pre_8
s_cmp_lg_u32 s50,0
s_cbranch_scc1 nadd_36
s_mov_b64 exec,1
v_mov_b32 v184,1
v_mov_b32 v185,0
s_mov_b32 s52,164
buffer_atomic_add v184,v185,s[44:47],s52 offen sc1
s_mov_b64 exec,-1
nadd_36:
s_branch setup_5
post_9:
s_cmp_lt_u32 s55,16
s_cbranch_scc1 xd_38
s_barrier
buffer_load_dwordx4 v[8:11],v5,s[32:35],s36 offen offset:0
buffer_load_dwordx4 v[12:15],v5,s[32:35],s36 offen offset:16
buffer_load_dwordx4 v[16:19],v5,s[32:35],s36 offen offset:512
buffer_load_dwordx4 v[20:23],v5,s[32:35],s36 offen offset:528
buffer_load_dwordx4 v[24:27],v5,s[32:35],s36 offen offset:1024
buffer_load_dwordx4 v[28:31],v5,s[32:35],s36 offen offset:1040
buffer_load_dwordx4 v[32:35],v5,s[32:35],s36 offen offset:1536
buffer_load_dwordx4 v[36:39],v5,s[32:35],s36 offen offset:1552
xd_38:
s_sub_u32 s65,s57,255
s_and_b32 s66,s56,1
s_or_b32 s65,s65,s66
s_or_b32 s65,s65,s50
s_cmp_lg_u32 s65,0
s_cbranch_scc1 nomeas_37
s_mov_b64 exec,1
v_mov_b32 v184,0
s_mov_b32 s52,20971520
s_mov_b32 s53,20979712
s_mov_b32 s70,0x7fffffff
s_mov_b32 s71,0x7fffffff
s_memtime s[72:73]
s_waitcnt lgkmcnt(0)
buffer_store_dword v184,v184,s[20:23],s52 offen sc1
s_waitcnt vmcnt(0)
s_memtime s[74:75]
s_waitcnt lgkmcnt(0)
s_sub_u32 s74,s74,s72
s_min_u32 s70,s70,s74
s_memtime s[72:73]
s_waitcnt lgkmcnt(0)
buffer_store_dword v184,v184,s[20:23],s53 offen sc1
s_waitcnt vmcnt(0)
s_memtime s[74:75]
s_waitcnt lgkmcnt(0)
s_sub_u32 s74,s74,s72
s_min_u32 s71,s71,s74
s_memtime s[72:73]
s_waitcnt lgkmcnt(0)
buffer_store_dword v184,v184,s[20:23],s52 offen sc1
s_waitcnt vmcnt(0)
s_memtime s[74:75]
s_waitcnt lgkmcnt(0)
s_sub_u32 s74,s74,s72
s_min_u32 s70,s70,s74
s_memtime s[72:73]
s_waitcnt lgkmcnt(0)
buffer_store_dword v184,v184,s[20:23],s53 offen sc1
s_waitcnt vmcnt(0)
s_memtime s[74:75]
s_waitcnt lgkmcnt(0)
s_sub_u32 s74,s74,s72
s_min_u32 s71,s71,s74
s_memtime s[72:73]
s_waitcnt lgkmcnt(0)
buffer_store_dword v184,v184,s[20:23],s52 offen sc1
s_waitcnt vmcnt(0)
s_memtime s[74:75]
s_waitcnt lgkmcnt(0)
s_sub_u32 s74,s74,s72
s_min_u32 s70,s70,s74
s_memtime s[72:73]
s_waitcnt lgkmcnt(0)
buffer_store_dword v184,v184,s[20:23],s53 offen sc1
s_waitcnt vmcnt(0)
s_memtime s[74:75]
s_waitcnt lgkmcnt(0)
s_sub_u32 s74,s74,s72
s_min_u32 s71,s71,s74
s_memtime s[72:73]
s_waitcnt lgkmcnt(0)
buffer_store_dword v184,v184,s[20:23],s52 offen sc1
s_waitcnt vmcnt(0)
s_memtime s[74:75]
s_waitcnt lgkmcnt(0)
s_sub_u32 s74,s74,s72
s_min_u32 s70,s70,s74
s_memtime s[72:73]
s_waitcnt lgkmcnt(0)
buffer_store_dword v184,v184,s[20:23],s53 offen sc1
s_waitcnt vmcnt(0)
s_memtime s[74:75]
s_waitcnt lgkmcnt(0)
s_sub_u32 s74,s74,s72
s_min_u32 s71,s71,s74
s_cmp_gt_u32 s71,s70
s_cselect_b32 s65,3,2
v_mov_b32 v185,s65
buffer_store_dword v185,v184,s[44:47],32 offen sc1
s_mov_b64 exec,-1
nomeas_37:
s_waitcnt vmcnt(0)
v_and_b32 v103,s39,v39
v_lshlrev_b32 v102,16,v39
v_and_b32 v101,s39,v38
v_lshlrev_b32 v100,16,v38
v_and_b32 v99,s39,v37
v_lshlrev_b32 v98,16,v37
v_and_b32 v97,s39,v36
v_lshlrev_b32 v96,16,v36
v_and_b32 v95,s39,v35
v_lshlrev_b32 v94,16,v35
v_and_b32 v93,s39,v34
v_lshlrev_b32 v92,16,v34
v_and_b32 v91,s39,v33
v_lshlrev_b32 v90,16,v33
v_and_b32 v89,s39,v32
v_lshlrev_b32 v88,16,v32
v_and_b32 v87,s39,v31
v_lshlrev_b32 v86,16,v31
v_and_b32 v85,s39,v30
v_lshlrev_b32 v84,16,v30
v_and_b32 v83,s39,v29
v_lshlrev_b32 v82,16,v29
v_and_b32 v81,s39,v28
v_lshlrev_b32 v80,16,v28
v_and_b32 v79,s39,v27
v_lshlrev_b32 v78,16,v27
v_and_b32 v77,s39,v26
v_lshlrev_b32 v76,16,v26
v_and_b32 v75,s39,v25
v_lshlrev_b32 v74,16,v25
v_and_b32 v73,s39,v24
v_lshlrev_b32 v72,16,v24
v_and_b32 v71,s39,v23
v_lshlrev_b32 v70,16,v23
v_and_b32 v69,s39,v22
v_lshlrev_b32 v68,16,v22
v_and_b32 v67,s39,v21
v_lshlrev_b32 v66,16,v21
v_and_b32 v65,s39,v20
v_lshlrev_b32 v64,16,v20
v_and_b32 v63,s39,v19
v_lshlrev_b32 v62,16,v19
v_and_b32 v61,s39,v18
v_lshlrev_b32 v60,16,v18
v_and_b32 v59,s39,v17
v_lshlrev_b32 v58,16,v17
v_and_b32 v57,s39,v16
v_lshlrev_b32 v56,16,v16
v_and_b32 v55,s39,v15
v_lshlrev_b32 v54,16,v15
v_and_b32 v53,s39,v14
v_lshlrev_b32 v52,16,v14
v_and_b32 v51,s39,v13
v_lshlrev_b32 v50,16,v13
v_and_b32 v49,s39,v12
v_lshlrev_b32 v48,16,v12
v_and_b32 v47,s39,v11
v_lshlrev_b32 v46,16,v11
v_and_b32 v45,s39,v10
v_lshlrev_b32 v44,16,v10
v_and_b32 v43,s39,v9
v_lshlrev_b32 v42,16,v9
v_and_b32 v41,s39,v8
v_lshlrev_b32 v40,16,v8
v_pk_add_f32 v[8:9],v[40:41],v[42:43]
v_pk_add_f32 v[10:11],v[44:45],v[46:47]
v_pk_add_f32 v[8:9],v[8:9],v[48:49]
v_pk_add_f32 v[10:11],v[10:11],v[50:51]
v_pk_add_f32 v[8:9],v[8:9],v[52:53]
v_pk_add_f32 v[10:11],v[10:11],v[54:55]
v_pk_add_f32 v[8:9],v[8:9],v[56:57]
v_pk_add_f32 v[10:11],v[10:11],v[58:59]
v_pk_add_f32 v[8:9],v[8:9],v[60:61]
v_pk_add_f32 v[10:11],v[10:11],v[62:63]
v_pk_add_f32 v[8:9],v[8:9],v[64:65]
v_pk_add_f32 v[10:11],v[10:11],v[66:67]
v_pk_add_f32 v[8:9],v[8:9],v[68:69]
v_pk_add_f32 v[10:11],v[10:11],v[70:71]
v_pk_add_f32 v[8:9],v[8:9],v[72:73]
v_pk_add_f32 v[10:11],v[10:11],v[74:75]
v_pk_add_f32 v[8:9],v[8:9],v[76:77]
v_pk_add_f32 v[10:11],v[10:11],v[78:79]
v_pk_add_f32 v[8:9],v[8:9],v[80:81]
v_pk_add_f32 v[10:11],v[10:11],v[82:83]
v_pk_add_f32 v[8:9],v[8:9],v[84:85]
v_pk_add_f32 v[10:11],v[10:11],v[86:87]
v_pk_add_f32 v[8:9],v[8:9],v[88:89]
v_pk_add_f32 v[10:11],v[10:11],v[90:91]
v_pk_add_f32 v[8:9],v[8:9],v[92:93]
v_pk_add_f32 v[10:11],v[10:11],v[94:95]
v_pk_add_f32 v[8:9],v[8:9],v[96:97]
v_pk_add_f32 v[10:11],v[10:11],v[98:99]
v_pk_add_f32 v[8:9],v[8:9],v[100:101]
v_pk_add_f32 v[10:11],v[10:11],v[102:103]
v_pk_add_f32 v[8:9],v[8:9],v[10:11]
v_add_f32 v8,v8,v9
s_nop 1
v_add_f32_dpp v8,v8,v8 row_ror:4 row_mask:0xf bank_mask:0xf
s_nop 1
v_add_f32_dpp v8,v8,v8 row_ror:8 row_mask:0xf bank_mask:0xf
v_mov_b32 v12,v8
s_nop 1
v_permlane16_swap_b32 v12,v8
v_add_f32 v8,v8,v12
v_mov_b32 v12,v8
s_nop 1
v_permlane32_swap_b32 v12,v8
v_add_f32 v8,v8,v12
v_mul_f32 v8,0xba800000,v8
v_pk_add_f32 v[40:41],v[40:41],v[8:9] op_sel_hi:[1,0]
v_pk_add_f32 v[42:43],v[42:43],v[8:9] op_sel_hi:[1,0]
v_pk_add_f32 v[44:45],v[44:45],v[8:9] op_sel_hi:[1,0]
v_pk_add_f32 v[46:47],v[46:47],v[8:9] op_sel_hi:[1,0]
v_pk_add_f32 v[48:49],v[48:49],v[8:9] op_sel_hi:[1,0]
v_pk_add_f32 v[50:51],v[50:51],v[8:9] op_sel_hi:[1,0]
v_pk_add_f32 v[52:53],v[52:53],v[8:9] op_sel_hi:[1,0]
v_pk_add_f32 v[54:55],v[54:55],v[8:9] op_sel_hi:[1,0]
v_pk_add_f32 v[56:57],v[56:57],v[8:9] op_sel_hi:[1,0]
v_pk_add_f32 v[58:59],v[58:59],v[8:9] op_sel_hi:[1,0]
v_pk_add_f32 v[60:61],v[60:61],v[8:9] op_sel_hi:[1,0]
v_pk_add_f32 v[62:63],v[62:63],v[8:9] op_sel_hi:[1,0]
v_pk_add_f32 v[64:65],v[64:65],v[8:9] op_sel_hi:[1,0]
v_pk_add_f32 v[66:67],v[66:67],v[8:9] op_sel_hi:[1,0]
v_pk_add_f32 v[68:69],v[68:69],v[8:9] op_sel_hi:[1,0]
v_pk_add_f32 v[70:71],v[70:71],v[8:9] op_sel_hi:[1,0]
v_pk_add_f32 v[72:73],v[72:73],v[8:9] op_sel_hi:[1,0]
v_pk_add_f32 v[74:75],v[74:75],v[8:9] op_sel_hi:[1,0]
v_pk_add_f32 v[76:77],v[76:77],v[8:9] op_sel_hi:[1,0]
v_pk_add_f32 v[78:79],v[78:79],v[8:9] op_sel_hi:[1,0]
v_pk_add_f32 v[80:81],v[80:81],v[8:9] op_sel_hi:[1,0]
v_pk_add_f32 v[82:83],v[82:83],v[8:9] op_sel_hi:[1,0]
v_pk_add_f32 v[84:85],v[84:85],v[8:9] op_sel_hi:[1,0]
v_pk_add_f32 v[86:87],v[86:87],v[8:9] op_sel_hi:[1,0]
v_pk_add_f32 v[88:89],v[88:89],v[8:9] op_sel_hi:[1,0]
v_pk_add_f32 v[90:91],v[90:91],v[8:9] op_sel_hi:[1,0]
v_pk_add_f32 v[92:93],v[92:93],v[8:9] op_sel_hi:[1,0]
v_pk_add_f32 v[94:95],v[94:95],v[8:9] op_sel_hi:[1,0]
v_pk_add_f32 v[96:97],v[96:97],v[8:9] op_sel_hi:[1,0]
v_pk_add_f32 v[98:99],v[98:99],v[8:9] op_sel_hi:[1,0]
v_pk_add_f32 v[100:101],v[100:101],v[8:9] op_sel_hi:[1,0]
v_pk_add_f32 v[102:103],v[102:103],v[8:9] op_sel_hi:[1,0]
v_pk_mul_f32 v[10:11],v[40:41],v[40:41]
v_pk_mul_f32 v[14:15],v[42:43],v[42:43]
v_pk_fma_f32 v[10:11],v[44:45],v[44:45],v[10:11]
v_pk_fma_f32 v[14:15],v[46:47],v[46:47],v[14:15]
v_pk_fma_f32 v[10:11],v[48:49],v[48:49],v[10:11]
v_pk_fma_f32 v[14:15],v[50:51],v[50:51],v[14:15]
v_pk_fma_f32 v[10:11],v[52:53],v[52:53],v[10:11]
v_pk_fma_f32 v[14:15],v[54:55],v[54:55],v[14:15]
v_pk_fma_f32 v[10:11],v[56:57],v[56:57],v[10:11]
v_pk_fma_f32 v[14:15],v[58:59],v[58:59],v[14:15]
v_pk_fma_f32 v[10:11],v[60:61],v[60:61],v[10:11]
v_pk_fma_f32 v[14:15],v[62:63],v[62:63],v[14:15]
v_pk_fma_f32 v[10:11],v[64:65],v[64:65],v[10:11]
v_pk_fma_f32 v[14:15],v[66:67],v[66:67],v[14:15]
v_pk_fma_f32 v[10:11],v[68:69],v[68:69],v[10:11]
v_pk_fma_f32 v[14:15],v[70:71],v[70:71],v[14:15]
v_pk_fma_f32 v[10:11],v[72:73],v[72:73],v[10:11]
v_pk_fma_f32 v[14:15],v[74:75],v[74:75],v[14:15]
v_pk_fma_f32 v[10:11],v[76:77],v[76:77],v[10:11]
v_pk_fma_f32 v[14:15],v[78:79],v[78:79],v[14:15]
v_pk_fma_f32 v[10:11],v[80:81],v[80:81],v[10:11]
v_pk_fma_f32 v[14:15],v[82:83],v[82:83],v[14:15]
v_pk_fma_f32 v[10:11],v[84:85],v[84:85],v[10:11]
v_pk_fma_f32 v[14:15],v[86:87],v[86:87],v[14:15]
v_pk_fma_f32 v[10:11],v[88:89],v[88:89],v[10:11]
v_pk_fma_f32 v[14:15],v[90:91],v[90:91],v[14:15]
v_pk_fma_f32 v[10:11],v[92:93],v[92:93],v[10:11]
v_pk_fma_f32 v[14:15],v[94:95],v[94:95],v[14:15]
v_pk_fma_f32 v[10:11],v[96:97],v[96:97],v[10:11]
v_pk_fma_f32 v[14:15],v[98:99],v[98:99],v[14:15]
v_pk_fma_f32 v[10:11],v[100:101],v[100:101],v[10:11]
v_pk_fma_f32 v[14:15],v[102:103],v[102:103],v[14:15]
v_pk_add_f32 v[10:11],v[10:11],v[14:15]
v_add_f32 v10,v10,v11
s_nop 1
v_add_f32_dpp v10,v10,v10 row_ror:4 row_mask:0xf bank_mask:0xf
s_nop 1
v_add_f32_dpp v10,v10,v10 row_ror:8 row_mask:0xf bank_mask:0xf
v_mov_b32 v12,v10
s_nop 1
v_permlane16_swap_b32 v12,v10
v_add_f32 v10,v10,v12
v_mov_b32 v12,v10
s_nop 1
v_permlane32_swap_b32 v12,v10
v_add_f32 v10,v10,v12
v_mov_b32 v12,0x3727c5ac
v_fmac_f32 v12,0x3a800000,v10
v_rsq_f32 v10,v12
s_nop 0
v_pk_mul_f32 v[40:41],v[40:41],v[10:11] op_sel_hi:[1,0]
v_pk_mul_f32 v[42:43],v[42:43],v[10:11] op_sel_hi:[1,0]
v_pk_mul_f32 v[44:45],v[44:45],v[10:11] op_sel_hi:[1,0]
v_pk_mul_f32 v[46:47],v[46:47],v[10:11] op_sel_hi:[1,0]
v_pk_mul_f32 v[48:49],v[48:49],v[10:11] op_sel_hi:[1,0]
v_pk_mul_f32 v[50:51],v[50:51],v[10:11] op_sel_hi:[1,0]
v_pk_mul_f32 v[52:53],v[52:53],v[10:11] op_sel_hi:[1,0]
v_pk_mul_f32 v[54:55],v[54:55],v[10:11] op_sel_hi:[1,0]
v_pk_mul_f32 v[56:57],v[56:57],v[10:11] op_sel_hi:[1,0]
v_pk_mul_f32 v[58:59],v[58:59],v[10:11] op_sel_hi:[1,0]
v_pk_mul_f32 v[60:61],v[60:61],v[10:11] op_sel_hi:[1,0]
v_pk_mul_f32 v[62:63],v[62:63],v[10:11] op_sel_hi:[1,0]
v_pk_mul_f32 v[64:65],v[64:65],v[10:11] op_sel_hi:[1,0]
v_pk_mul_f32 v[66:67],v[66:67],v[10:11] op_sel_hi:[1,0]
v_pk_mul_f32 v[68:69],v[68:69],v[10:11] op_sel_hi:[1,0]
v_pk_mul_f32 v[70:71],v[70:71],v[10:11] op_sel_hi:[1,0]
v_pk_mul_f32 v[72:73],v[72:73],v[10:11] op_sel_hi:[1,0]
v_pk_mul_f32 v[74:75],v[74:75],v[10:11] op_sel_hi:[1,0]
v_pk_mul_f32 v[76:77],v[76:77],v[10:11] op_sel_hi:[1,0]
v_pk_mul_f32 v[78:79],v[78:79],v[10:11] op_sel_hi:[1,0]
v_pk_mul_f32 v[80:81],v[80:81],v[10:11] op_sel_hi:[1,0]
v_pk_mul_f32 v[82:83],v[82:83],v[10:11] op_sel_hi:[1,0]
v_pk_mul_f32 v[84:85],v[84:85],v[10:11] op_sel_hi:[1,0]
v_pk_mul_f32 v[86:87],v[86:87],v[10:11] op_sel_hi:[1,0]
v_pk_mul_f32 v[88:89],v[88:89],v[10:11] op_sel_hi:[1,0]
v_pk_mul_f32 v[90:91],v[90:91],v[10:11] op_sel_hi:[1,0]
v_pk_mul_f32 v[92:93],v[92:93],v[10:11] op_sel_hi:[1,0]
v_pk_mul_f32 v[94:95],v[94:95],v[10:11] op_sel_hi:[1,0]
v_pk_mul_f32 v[96:97],v[96:97],v[10:11] op_sel_hi:[1,0]
v_pk_mul_f32 v[98:99],v[98:99],v[10:11] op_sel_hi:[1,0]
v_pk_mul_f32 v[100:101],v[100:101],v[10:11] op_sel_hi:[1,0]
v_pk_mul_f32 v[102:103],v[102:103],v[10:11] op_sel_hi:[1,0]
v_mov_b32 v187,158976
s_cmp_lg_u32 s50,0
s_cbranch_scc1 sh0_39
s_mov_b32 s65,0
s_cmp_eq_u32 s56,1
s_cbranch_scc1 m1s_40
s_lshl_b32 s52,s55,7
s_add_u32 s52,s52,21102592
s_mov_b32 s53,0
m1l_41:
v_mov_b32 v184,0
buffer_load_dword v185,v184,s[20:23],s52 offen sc1
s_waitcnt vmcnt(0)
v_readfirstlane_b32 s64,v185
s_mov_b32 s65,0
s_cmp_eq_u32 s64,1
s_cbranch_scc1 m1ok_42
s_sub_u32 s90,s90,1
s_cmp_lt_i32 s90,0
s_cbranch_scc1 m1ok_42
s_add_u32 s53,s53,1
s_and_b32 s64,s53,31
s_cbranch_scc1 m1l_41
v_and_b32 v184,3,v1
v_bfe_u32 v185,v1,2,1
v_lshlrev_b32 v184,2,v184
v_lshl_add_u32 v184,v185,7,v184
v_writelane_b32 v184,32,8
s_mov_b64 exec,0x1ff
vpoll_43:
buffer_load_dword v185,v184,s[44:47],0 offen sc1
s_waitcnt vmcnt(0)
vfirst_46:
v_readlane_b32 s92,v185,0
v_readlane_b32 s93,v185,1
v_readlane_b32 s94,v185,2
v_readlane_b32 s95,v185,3
v_readlane_b32 s96,v185,4
v_readlane_b32 s97,v185,5
v_readlane_b32 s98,v185,6
v_readlane_b32 s99,v185,7
v_readlane_b32 s61,v185,8
s_add_u32 s64,s92,s93
s_add_u32 s64,s64,s94
s_add_u32 s64,s64,s95
s_add_u32 s64,s64,s96
s_add_u32 s64,s64,s97
s_add_u32 s64,s64,s98
s_add_u32 s64,s64,s99
s_min_u32 s65,s92,s93
s_min_u32 s66,s94,s95
s_min_u32 s65,s65,s66
s_min_u32 s66,s96,s97
s_min_u32 s65,s65,s66
s_min_u32 s66,s98,s99
s_min_u32 s65,s65,s66
s_cmp_lt_u32 s65,32
s_cselect_b32 s65,1,0
s_cmp_lt_u32 s64,256
s_cbranch_scc1 vslp_45
s_branch vgot_44
vslp_45:
s_sleep 8
s_sub_u32 s90,s90,1
s_cmp_gt_i32 s90,0
s_cbranch_scc1 vpoll_43
vgot_44:
s_mov_b64 exec,-1
s_and_b32 s61,s61,1
s_lshl_b32 s61,s61,13
s_mov_b32 s66,s54
s_cmp_gt_u32 s51,0
s_cselect_b32 s64,s92,0
s_add_u32 s66,s66,s64
s_cmp_gt_u32 s51,1
s_cselect_b32 s64,s93,0
s_add_u32 s66,s66,s64
s_cmp_gt_u32 s51,2
s_cselect_b32 s64,s94,0
s_add_u32 s66,s66,s64
s_cmp_gt_u32 s51,3
s_cselect_b32 s64,s95,0
s_add_u32 s66,s66,s64
s_cmp_gt_u32 s51,4
s_cselect_b32 s64,s96,0
s_add_u32 s66,s66,s64
s_cmp_gt_u32 s51,5
s_cselect_b32 s64,s97,0
s_add_u32 s66,s66,s64
s_cmp_gt_u32 s51,6
s_cselect_b32 s64,s98,0
s_add_u32 s66,s66,s64
s_cmp_eq_u32 s65,0
s_cbranch_scc1 m1l_41
s_branch m1ok_42
m1s_40:
s_mov_b32 s53,256
s_mov_b32 s52,164
v_mov_b32 v184,0
dp_47:
buffer_load_dword v185,v184,s[44:47],s52 offen sc1
s_waitcnt vmcnt(0)
v_cmp_ne_u32 vcc,s53,v185
s_cbranch_vccz dpok_48
s_sleep 8
s_sub_u32 s90,s90,1
s_cmp_gt_i32 s90,0
s_cbranch_scc1 dp_47
dpok_48:
m1ok_42:
v_mov_b32 v184,s65
v_mov_b32 v185,s66
v_mov_b32 v186,s61
ds_write_b96 v187,v[184:186] offset:16
s_waitcnt lgkmcnt(0)
sh0_39:
s_barrier
ds_read_b96 v[184:186],v187 offset:16
s_waitcnt lgkmcnt(0)
v_readfirstlane_b32 s65,v184
v_readfirstlane_b32 s66,v185
v_readfirstlane_b32 s61,v186
s_cmp_lg_u32 s65,0
s_cbranch_scc1 slowrole_10
s_and_b32 s56,s56,1
s_lshl_b32 s53,s56,2
s_add_u32 s53,s53,4
v_mul_u32_u24 v241,s53,v1
s_lshr_b32 s53,s55,4
s_or_b32 s53,s53,s50
s_cselect_b32 s53,0x7fff0000,32
s_mov_b64 exec,3
buffer_load_dword v240,v241,s[44:47],s53 offen sc1
s_mov_b64 exec,-1
v_lshlrev_b32 v7,5,v0
s_mov_b32 s40,24576
buffer_load_dwordx4 v[104:107],v7,s[20:23],s40 offen offset:0 sc1
buffer_load_dwordx4 v[108:111],v7,s[20:23],s40 offen offset:16 sc1
s_add_u32 s40,s40,8192
buffer_load_dwordx4 v[112:115],v7,s[20:23],s40 offen offset:0 sc1
buffer_load_dwordx4 v[116:119],v7,s[20:23],s40 offen offset:16 sc1
s_add_u32 s40,s40,8192
buffer_load_dwordx4 v[120:123],v7,s[20:23],s40 offen offset:0 sc1
buffer_load_dwordx4 v[124:127],v7,s[20:23],s40 offen offset:16 sc1
s_add_u32 s40,s40,8192
buffer_load_dwordx4 v[128:131],v7,s[20:23],s40 offen offset:0 sc1
buffer_load_dwordx4 v[132:135],v7,s[20:23],s40 offen offset:16 sc1
v_mov_b32 v14,1.0
v_cmp_lt_u32 vcc,127,v0
s_nop 1
v_cndmask_b32 v14,0,v14,vcc
s_waitcnt vmcnt(0)
v_pk_add_f32 v[104:105],v[104:105],v[112:113]
v_pk_add_f32 v[120:121],v[120:121],v[128:129]
v_pk_add_f32 v[106:107],v[106:107],v[114:115]
v_pk_add_f32 v[122:123],v[122:123],v[130:131]
v_pk_add_f32 v[108:109],v[108:109],v[116:117]
v_pk_add_f32 v[124:125],v[124:125],v[132:133]
v_pk_add_f32 v[110:111],v[110:111],v[118:119]
v_pk_add_f32 v[126:127],v[126:127],v[134:135]
v_pk_add_f32 v[104:105],v[104:105],v[120:121]
v_pk_add_f32 v[106:107],v[106:107],v[122:123]
v_pk_add_f32 v[108:109],v[108:109],v[124:125]
v_pk_add_f32 v[110:111],v[110:111],v[126:127]
v_cvt_pk_bf16_f32 v112,v104,v105
v_cvt_pk_bf16_f32 v113,v106,v107
v_cvt_pk_bf16_f32 v114,v108,v109
v_cvt_pk_bf16_f32 v115,v110,v111
v_lshlrev_b32 v104,16,v112
v_and_b32 v105,s39,v112
v_lshlrev_b32 v106,16,v113
v_and_b32 v107,s39,v113
v_lshlrev_b32 v108,16,v114
v_and_b32 v109,s39,v114
v_lshlrev_b32 v110,16,v115
v_and_b32 v111,s39,v115
v_pk_add_f32 v[104:105],v[104:105],v[14:15] op_sel_hi:[1,0]
v_pk_add_f32 v[106:107],v[106:107],v[14:15] op_sel_hi:[1,0]
v_pk_add_f32 v[108:109],v[108:109],v[14:15] op_sel_hi:[1,0]
v_pk_add_f32 v[110:111],v[110:111],v[14:15] op_sel_hi:[1,0]
ds_write_b128 v7,v[104:107] offset:4096
ds_write_b128 v7,v[108:111] offset:4112
s_waitcnt lgkmcnt(0)
s_barrier
ds_read_b128 v[104:107],v4 offset:8192
ds_read_b128 v[168:171],v4 offset:4096
ds_read_b128 v[108:111],v4 offset:8208
ds_read_b128 v[172:175],v4 offset:4112
ds_read_b128 v[112:115],v4 offset:8224
ds_read_b128 v[176:179],v4 offset:4128
ds_read_b128 v[116:119],v4 offset:8240
ds_read_b128 v[180:183],v4 offset:4144
ds_read_b128 v[120:123],v4 offset:9216
ds_read_b128 v[184:187],v4 offset:5120
ds_read_b128 v[124:127],v4 offset:9232
ds_read_b128 v[188:191],v4 offset:5136
ds_read_b128 v[128:131],v4 offset:9248
ds_read_b128 v[192:195],v4 offset:5152
ds_read_b128 v[132:135],v4 offset:9264
ds_read_b128 v[196:199],v4 offset:5168
ds_read_b128 v[136:139],v4 offset:10240
ds_read_b128 v[200:203],v4 offset:6144
ds_read_b128 v[140:143],v4 offset:10256
ds_read_b128 v[204:207],v4 offset:6160
ds_read_b128 v[144:147],v4 offset:10272
ds_read_b128 v[208:211],v4 offset:6176
ds_read_b128 v[148:151],v4 offset:10288
ds_read_b128 v[212:215],v4 offset:6192
ds_read_b128 v[152:155],v4 offset:11264
ds_read_b128 v[216:219],v4 offset:7168
ds_read_b128 v[156:159],v4 offset:11280
ds_read_b128 v[220:223],v4 offset:7184
ds_read_b128 v[160:163],v4 offset:11296
ds_read_b128 v[224:227],v4 offset:7200
ds_read_b128 v[164:167],v4 offset:11312
ds_read_b128 v[228:231],v4 offset:7216
s_waitcnt lgkmcnt(15)
v_pk_fma_f32 v[40:41],v[40:41],v[104:105],v[168:169]
v_pk_fma_f32 v[42:43],v[42:43],v[106:107],v[170:171]
v_pk_fma_f32 v[44:45],v[44:45],v[108:109],v[172:173]
v_pk_fma_f32 v[46:47],v[46:47],v[110:111],v[174:175]
v_pk_fma_f32 v[48:49],v[48:49],v[112:113],v[176:177]
v_pk_fma_f32 v[50:51],v[50:51],v[114:115],v[178:179]
v_pk_fma_f32 v[52:53],v[52:53],v[116:117],v[180:181]
v_pk_fma_f32 v[54:55],v[54:55],v[118:119],v[182:183]
v_cvt_pk_bf16_f32 v16,v40,v41
v_cvt_pk_bf16_f32 v17,v48,v49
v_cvt_pk_bf16_f32 v18,v42,v43
v_cvt_pk_bf16_f32 v19,v50,v51
buffer_store_dwordx4 v[16:19],v6,s[20:23],s37 offen offset:0 sc1
v_cvt_pk_bf16_f32 v20,v44,v45
v_cvt_pk_bf16_f32 v21,v52,v53
v_cvt_pk_bf16_f32 v22,v46,v47
v_cvt_pk_bf16_f32 v23,v54,v55
buffer_store_dwordx4 v[20:23],v6,s[20:23],s37 offen offset:256 sc1
s_waitcnt lgkmcnt(15)
v_pk_fma_f32 v[56:57],v[56:57],v[120:121],v[184:185]
v_pk_fma_f32 v[58:59],v[58:59],v[122:123],v[186:187]
v_pk_fma_f32 v[60:61],v[60:61],v[124:125],v[188:189]
v_pk_fma_f32 v[62:63],v[62:63],v[126:127],v[190:191]
v_pk_fma_f32 v[64:65],v[64:65],v[128:129],v[192:193]
v_pk_fma_f32 v[66:67],v[66:67],v[130:131],v[194:195]
v_pk_fma_f32 v[68:69],v[68:69],v[132:133],v[196:197]
v_pk_fma_f32 v[70:71],v[70:71],v[134:135],v[198:199]
v_cvt_pk_bf16_f32 v24,v56,v57
v_cvt_pk_bf16_f32 v25,v64,v65
v_cvt_pk_bf16_f32 v26,v58,v59
v_cvt_pk_bf16_f32 v27,v66,v67
s_add_u32 s37,s37,16384
buffer_store_dwordx4 v[24:27],v6,s[20:23],s37 offen offset:0 sc1
v_cvt_pk_bf16_f32 v28,v60,v61
v_cvt_pk_bf16_f32 v29,v68,v69
v_cvt_pk_bf16_f32 v30,v62,v63
v_cvt_pk_bf16_f32 v31,v70,v71
buffer_store_dwordx4 v[28:31],v6,s[20:23],s37 offen offset:256 sc1
s_waitcnt lgkmcnt(8)
v_pk_fma_f32 v[72:73],v[72:73],v[136:137],v[200:201]
v_pk_fma_f32 v[74:75],v[74:75],v[138:139],v[202:203]
v_pk_fma_f32 v[76:77],v[76:77],v[140:141],v[204:205]
v_pk_fma_f32 v[78:79],v[78:79],v[142:143],v[206:207]
v_pk_fma_f32 v[80:81],v[80:81],v[144:145],v[208:209]
v_pk_fma_f32 v[82:83],v[82:83],v[146:147],v[210:211]
v_pk_fma_f32 v[84:85],v[84:85],v[148:149],v[212:213]
v_pk_fma_f32 v[86:87],v[86:87],v[150:151],v[214:215]
v_cvt_pk_bf16_f32 v16,v72,v73
v_cvt_pk_bf16_f32 v17,v80,v81
v_cvt_pk_bf16_f32 v18,v74,v75
v_cvt_pk_bf16_f32 v19,v82,v83
s_add_u32 s37,s37,16384
buffer_store_dwordx4 v[16:19],v6,s[20:23],s37 offen offset:0 sc1
v_cvt_pk_bf16_f32 v20,v76,v77
v_cvt_pk_bf16_f32 v21,v84,v85
v_cvt_pk_bf16_f32 v22,v78,v79
v_cvt_pk_bf16_f32 v23,v86,v87
buffer_store_dwordx4 v[20:23],v6,s[20:23],s37 offen offset:256 sc1
s_waitcnt lgkmcnt(0)
v_pk_fma_f32 v[88:89],v[88:89],v[152:153],v[216:217]
v_pk_fma_f32 v[90:91],v[90:91],v[154:155],v[218:219]
v_pk_fma_f32 v[92:93],v[92:93],v[156:157],v[220:221]
v_pk_fma_f32 v[94:95],v[94:95],v[158:159],v[222:223]
v_pk_fma_f32 v[96:97],v[96:97],v[160:161],v[224:225]
v_pk_fma_f32 v[98:99],v[98:99],v[162:163],v[226:227]
v_pk_fma_f32 v[100:101],v[100:101],v[164:165],v[228:229]
v_pk_fma_f32 v[102:103],v[102:103],v[166:167],v[230:231]
v_cvt_pk_bf16_f32 v24,v88,v89
v_cvt_pk_bf16_f32 v25,v96,v97
v_cvt_pk_bf16_f32 v26,v90,v91
v_cvt_pk_bf16_f32 v27,v98,v99
s_add_u32 s37,s37,16384
buffer_store_dwordx4 v[24:27],v6,s[20:23],s37 offen offset:0 sc1
v_cvt_pk_bf16_f32 v28,v92,v93
v_cvt_pk_bf16_f32 v29,v100,v101
v_cvt_pk_bf16_f32 v30,v94,v95
v_cvt_pk_bf16_f32 v31,v102,v103
buffer_store_dwordx4 v[28:31],v6,s[20:23],s37 offen offset:256 sc1
s_waitcnt vmcnt(0)
s_barrier
v_mov_b32 v187,158976
s_cmp_lg_u32 s50,0
s_cbranch_scc1 sh0_49
s_cmp_ge_u32 s55,16
s_cbranch_scc1 nodln_50
rdl_52:
v_readlane_b32 s64,v240,0
v_readlane_b32 s65,v240,1
s_cmp_eq_u32 s56,1
s_cselect_b32 s64,2,s64
s_cmp_eq_u32 s65,128
s_cselect_b32 s64,s64,0
s_cmp_lg_u32 s64,0
s_cbranch_scc1 rdok_53
s_mov_b64 exec,3
buffer_load_dword v240,v241,s[44:47],s53 offen sc1
s_mov_b64 exec,-1
s_sub_u32 s90,s90,1
s_cmp_gt_i32 s90,0
s_waitcnt vmcnt(0)
s_cbranch_scc1 rdl_52
rdok_53:
s_lshl_b32 s65,s55,2
v_lshl_add_u32 v184,v1,7,s65
v_mov_b32 v185,s64
s_mov_b32 s64,21168128
s_mov_b32 s65,21176320
buffer_store_dword v185,v184,s[20:23],s64 offen sc1
buffer_store_dword v185,v184,s[20:23],s65 offen sc1
nodln_50:
s_mov_b32 s61,0
s_cmp_eq_u32 s56,1
s_cbranch_scc1 nopar_51
v_mov_b32 v184,0
dp_54:
buffer_load_dword v185,v184,s[44:47],32 offen sc1
s_waitcnt vmcnt(0)
v_cmp_eq_u32 vcc,0,v185
s_cbranch_vccz dpok_55
s_sleep 4
s_sub_u32 s90,s90,1
s_cmp_gt_i32 s90,0
s_cbranch_scc1 dp_54
dpok_55:
v_readfirstlane_b32 s65,v185
s_and_b32 s65,s65,1
s_lshl_b32 s61,s65,13
nopar_51:
v_mov_b32 v184,s65
v_mov_b32 v185,s66
v_mov_b32 v186,s61
ds_write_b96 v187,v[184:186] offset:16
s_waitcnt lgkmcnt(0)
sh0_49:
s_barrier
ds_read_b96 v[184:186],v187 offset:16
s_waitcnt lgkmcnt(0)
v_readfirstlane_b32 s65,v184
v_readfirstlane_b32 s66,v185
v_readfirstlane_b32 s61,v186
s_sub_u32 s55,s57,128
s_cmp_lg_u32 s50,0
s_cbranch_scc1 nsig_56
s_lshr_b32 s95,s55,4
s_lshl_b32 s95,s95,6
s_add_u32 s95,s95,21052416
s_mov_b64 exec,1
v_mov_b32 v184,112
v_mov_b32 v185,0
buffer_atomic_add v184,v185,s[20:23],s95 offen sc1
s_mov_b64 exec,-1
nsig_56:
s_branch pipe_worker
loops_7:
s_lshl_b32 s64,s50,14
s_add_u32 m0,s64,0
s_add_u32 s65,s64,57344
buffer_load_dwordx4 v16,s[20:23],s65 offen offset:0 lds
buffer_load_dwordx4 v16,s[20:23],s65 offen offset:1024 lds
buffer_load_dwordx4 v16,s[20:23],s65 offen offset:2048 lds
buffer_load_dwordx4 v16,s[20:23],s65 offen offset:3072 lds
s_add_u32 m0,s64,4096
s_add_u32 s65,s64,61440
buffer_load_dwordx4 v16,s[20:23],s65 offen offset:0 lds
buffer_load_dwordx4 v16,s[20:23],s65 offen offset:1024 lds
buffer_load_dwordx4 v16,s[20:23],s65 offen offset:2048 lds
buffer_load_dwordx4 v16,s[20:23],s65 offen offset:3072 lds
s_add_u32 m0,s64,8192
s_add_u32 s65,s64,65536
buffer_load_dwordx4 v16,s[20:23],s65 offen offset:0 lds
buffer_load_dwordx4 v16,s[20:23],s65 offen offset:1024 lds
buffer_load_dwordx4 v16,s[20:23],s65 offen offset:2048 lds
buffer_load_dwordx4 v16,s[20:23],s65 offen offset:3072 lds
s_add_u32 m0,s64,12288
s_add_u32 s65,s64,69632
buffer_load_dwordx4 v16,s[20:23],s65 offen offset:0 lds
buffer_load_dwordx4 v16,s[20:23],s65 offen offset:1024 lds
buffer_load_dwordx4 v16,s[20:23],s65 offen offset:2048 lds
buffer_load_dwordx4 v16,s[20:23],s65 offen offset:3072 lds
s_add_u32 m0,s64,65536
s_add_u32 s65,s64,122880
buffer_load_dwordx4 v16,s[20:23],s65 offen offset:0 lds
buffer_load_dwordx4 v16,s[20:23],s65 offen offset:1024 lds
buffer_load_dwordx4 v16,s[20:23],s65 offen offset:2048 lds
buffer_load_dwordx4 v16,s[20:23],s65 offen offset:3072 lds
s_add_u32 m0,s64,69632
s_add_u32 s65,s64,126976
buffer_load_dwordx4 v16,s[20:23],s65 offen offset:0 lds
buffer_load_dwordx4 v16,s[20:23],s65 offen offset:1024 lds
buffer_load_dwordx4 v16,s[20:23],s65 offen offset:2048 lds
buffer_load_dwordx4 v16,s[20:23],s65 offen offset:3072 lds
s_add_u32 m0,s64,73728
s_add_u32 s65,s64,131072
buffer_load_dwordx4 v16,s[20:23],s65 offen offset:0 lds
buffer_load_dwordx4 v16,s[20:23],s65 offen offset:1024 lds
buffer_load_dwordx4 v16,s[20:23],s65 offen offset:2048 lds
buffer_load_dwordx4 v16,s[20:23],s65 offen offset:3072 lds
s_add_u32 m0,s64,77824
s_add_u32 s65,s64,135168
buffer_load_dwordx4 v16,s[20:23],s65 offen offset:0 lds
buffer_load_dwordx4 v16,s[20:23],s65 offen offset:1024 lds
buffer_load_dwordx4 v16,s[20:23],s65 offen offset:2048 lds
buffer_load_dwordx4 v16,s[20:23],s65 offen offset:3072 lds
s_mov_b64 s[24:25],s[20:21]
s_mov_b64 s[28:29],s[20:21]
s_mov_b32 s27,0x20000
s_mov_b32 s31,0x20000
s_cmp_eq_u32 s56,0
s_cselect_b32 s26,s22,0
s_cselect_b32 s30,0,s22
s_lshl_b32 s64,s58,14
s_add_u32 s64,s64,23068672
v_add_u32 v26,s64,v16
v_add_u32 v27,4096,v26
v_add_u32 v28,8192,v26
v_add_u32 v29,12288,v26
s_lshl_b32 s65,s59,9
s_add_u32 s66,s64,s65
s_lshl_b32 s64,s58,7
s_add_u32 s64,s64,23592960
v_and_b32 v18,31,v1
v_lshl_add_u32 v18,v18,2,s64
s_lshl_b32 s65,s59,2
s_add_u32 s64,s64,s65
v_mov_b32 v13,s64
v_mov_b32 v14,0x4444
v_mov_b32 v22,0xeeee
v_cmp_lt_u32 vcc,7,v3
s_nop 1
v_cndmask_b32 v14,v14,v22,vcc
v_and_b32 v22,1,v3
v_cmp_eq_u32 vcc,0,v22
v_mov_b32 v15,0x03020706
v_mov_b32 v23,0x05040100
v_cndmask_b32 v15,v15,v23,vcc
v_lshlrev_b32 v19,5,v22
v_lshl_add_u32 v19,v4,6,v19
v_lshrrev_b32 v23,1,v3
v_lshl_add_u32 v19,v23,2,v19
s_lshl_b32 s67,s57,10
s_add_u32 s67,s67,23199744
s_lshl_b32 s64,s50,2
s_lshr_b32 s64,0x1320,s64
s_and_b32 s64,s64,3
s_lshl_b32 s64,s64,8
s_add_u32 s64,s64,s67
v_add_u32 v19,s64,v19
v_add_u32 v24,131072,v16
v_mov_b32 v21,158720
v_mov_b32 v25,0
v_mov_b32 v20,v16
v_and_b32 v22,1,v4
v_lshrrev_b32 v23,1,v4
v_lshl_add_u32 v23,v23,4,v3
v_lshlrev_b32 v23,4,v23
v_lshl_add_u32 v23,v22,10,v23
s_lshr_b32 s64,s50,1
s_lshl_b32 s64,s64,9
v_add_u32 v23,s64,v23
s_lshr_b32 s64,s57,2
s_add_u32 s65,s64,32
s_lshl_b32 s65,s65,14
s_and_b32 s68,s57,3
s_lshl_b32 s68,s68,11
s_add_u32 s65,s65,s68
s_add_u32 s65,s65,29360128
v_add_u32 v17,s65,v23
s_lshl_b32 s69,s57,11
s_add_u32 s69,s69,23330816
v_add_u32 v2,s69,v23
s_mov_b32 s81,0x3e0293ee
s_mov_b32 s84,0xff00ff
s_mov_b32 s85,0xff00ff
s_mov_b32 s86,0x33333333
s_mov_b32 s87,0x33333333
s_mov_b32 s62,0x10000
s_mov_b32 s79,-2
ds_write_b32 v21,v25
ds_write_b32 v21,v25 offset:4
ds_write_b32 v21,v25 offset:8
ds_write_b32 v21,v25 offset:12
ds_write_b32 v21,v25 offset:16
ds_write_b32 v21,v25 offset:24
ds_write_b32 v21,v25 offset:28
v_mov_b32 v100,0
v_mov_b32 v101,0
v_mov_b32 v102,0
v_mov_b32 v103,0
s_lshr_b32 s64,s59,3
s_lshl_b32 s64,s64,14
s_and_b32 s65,s59,7
s_lshl_b32 s65,s65,10
s_add_u32 s64,s64,s65
s_lshl_b32 s65,s58,16
s_add_u32 s64,s64,s65
s_add_u32 s64,s64,31195136
v_add_u32 v8,s64,v16
s_cmp_eq_u32 s50,3
s_cbranch_scc1 w3_61
s_cmp_eq_u32 s50,1
s_cbranch_scc1 w1_59
s_cmp_eq_u32 s50,2
s_cbranch_scc1 w2_60
w0_58:
v_and_b32 v22,7,v3
v_lshrrev_b32 v23,2,v22
v_and_b32 v5,2,v22
v_or_b32 v23,v23,v5
v_and_b32 v5,1,v22
v_lshl_add_u32 v23,v23,1,v5
v_lshlrev_b32 v23,5,v23
v_lshrrev_b32 v5,3,v3
v_lshl_add_u32 v23,v5,9,v23
v_lshrrev_b32 v5,1,v4
v_lshl_add_u32 v23,v5,8,v23
v_and_b32 v5,1,v4
v_lshl_add_u32 v23,v5,4,v23
v_add_u32 v8,s67,v23
v_xor_b32 v9,1024,v8
v_xor_b32 v10,2048,v8
v_xor_b32 v11,3072,v8
v_lshlrev_b32 v31,4,v3
v_lshl_add_u32 v31,v5,3,v31
v_add_u32 v31,155648,v31
v_lshl_add_u32 v23,v4,3,v22
v_lshlrev_b32 v23,4,v23
v_add_u32 v12,155648,v23
v_add_u32 v30,s66,v23
v_cmp_gt_u32 vcc,8,v3
v_cmp_lt_u32 s[52:53],1,v4
s_and_b64 vcc,vcc,s[52:53]
v_mov_b32 v22,0xf149f2ca
v_cndmask_b32 v156,v22,0,vcc
v_mov_b32 v157,v156
v_mov_b32 v158,v156
v_mov_b32 v159,v156
v_add_u32 v2,s69,v16
v_xor_b32 v5,2048,v2
v_xor_b32 v6,4096,v2
v_xor_b32 v7,6144,v2
s_lshr_b32 s64,s57,3
s_add_u32 s64,s64,96
s_lshl_b32 s64,s64,14
s_and_b32 s65,s57,7
s_lshl_b32 s65,s65,10
s_add_u32 s64,s64,s65
s_add_u32 s64,s64,29360128
v_add_u32 v3,s64,v16
v_mov_b32 v136,0
v_mov_b32 v137,0
v_mov_b32 v138,0
v_mov_b32 v139,0
v_mov_b32 v140,0
v_mov_b32 v141,0
v_mov_b32 v142,0
v_mov_b32 v143,0
v_mov_b32 v144,0
v_mov_b32 v145,0
v_mov_b32 v146,0
v_mov_b32 v147,0
v_mov_b32 v152,0x3f803f80
v_mov_b32 v153,0x3f803f80
v_mov_b32 v154,0x3f803f80
v_mov_b32 v155,0x3f803f80
s_branch first_62
loop_63:
s_barrier
buffer_load_dword v248,v18,s[20:23],s70 offen offset:0 sc1
s_nop 15
s_nop 5
hl_65:
buffer_load_dword v249,v18,s[20:23],s70 offen offset:0 sc1
s_waitcnt vmcnt(1)
v_cmp_eq_u32 vcc,v25,v248
s_bcnt1_i32_b32 s64,vcc_lo
s_cmp_ge_u32 s64,8
s_cbranch_scc1 hg_66
buffer_load_dword v248,v18,s[20:23],s70 offen offset:0 sc1
s_waitcnt vmcnt(1)
v_cmp_eq_u32 vcc,v25,v249
s_bcnt1_i32_b32 s64,vcc_lo
s_cmp_ge_u32 s64,8
s_cbranch_scc1 hg_66
s_sub_u32 s90,s90,1
s_cmp_gt_i32 s90,0
s_cbranch_scc1 hl_65
hg_66:
buffer_load_dwordx4 v[32:35],v26,s[20:23],s70 offen offset:0 sc1
buffer_load_dwordx4 v[36:39],v26,s[20:23],s70 offen offset:1024 sc1
buffer_load_dwordx4 v[40:43],v26,s[20:23],s70 offen offset:2048 sc1
buffer_load_dwordx4 v[44:47],v26,s[20:23],s70 offen offset:3072 sc1
s_waitcnt vmcnt(3)
ds_write_b128 v24,v[32:35] offset:0
v_min3_u32 v22,v32,v33,v34
v_min_u32 v22,v22,v35
s_waitcnt vmcnt(2)
ds_write_b128 v24,v[36:39] offset:1024
v_min3_u32 v22,v22,v36,v37
v_min3_u32 v22,v22,v38,v39
s_waitcnt vmcnt(1)
ds_write_b128 v24,v[40:43] offset:2048
v_min3_u32 v22,v22,v40,v41
v_min3_u32 v22,v22,v42,v43
s_waitcnt vmcnt(0)
ds_write_b128 v24,v[44:47] offset:3072
v_min3_u32 v22,v22,v44,v45
v_min3_u32 v22,v22,v46,v47
v_cmp_eq_u32 vcc,0,v22
s_cbranch_vccnz art_67
abk_68:
v_smfmac_f32_16x16x64_bf16 v[176:179],v[32:35],a[0:7],v14
s_waitcnt lgkmcnt(0)
s_barrier
ds_read_b128 v[48:51],v24 offset:4096
ds_read_b128 v[52:55],v24 offset:5120
ds_read_b128 v[56:59],v24 offset:6144
ds_read_b128 v[60:63],v24 offset:7168
v_smfmac_f32_16x16x64_bf16 v[176:179],v[36:39],a[8:15],v14
ds_read_b128 v[64:67],v24 offset:8192
ds_read_b128 v[68:71],v24 offset:9216
v_smfmac_f32_16x16x64_bf16 v[176:179],v[40:43],a[16:23],v14
ds_read_b128 v[72:75],v24 offset:10240
ds_read_b128 v[76:79],v24 offset:11264
v_smfmac_f32_16x16x64_bf16 v[176:179],v[44:47],a[24:31],v14
ds_read_b128 v[80:83],v24 offset:12288
ds_read_b128 v[84:87],v24 offset:13312
s_waitcnt lgkmcnt(9)
v_smfmac_f32_16x16x64_bf16 v[176:179],v[48:51],a[32:39],v14
ds_read_b128 v[88:91],v24 offset:14336
s_waitcnt lgkmcnt(9)
v_smfmac_f32_16x16x64_bf16 v[176:179],v[52:55],a[40:47],v14
ds_read_b128 v[92:95],v24 offset:15360
s_waitcnt lgkmcnt(9)
v_smfmac_f32_16x16x64_bf16 v[176:179],v[56:59],a[48:55],v14
s_waitcnt lgkmcnt(8)
v_smfmac_f32_16x16x64_bf16 v[176:179],v[60:63],a[56:63],v14
s_waitcnt lgkmcnt(7)
v_smfmac_f32_16x16x64_bf16 v[176:179],v[64:67],a[64:71],v14
s_waitcnt lgkmcnt(6)
v_smfmac_f32_16x16x64_bf16 v[176:179],v[68:71],a[72:79],v14
s_waitcnt lgkmcnt(5)
v_smfmac_f32_16x16x64_bf16 v[176:179],v[72:75],a[80:87],v14
s_waitcnt lgkmcnt(4)
v_smfmac_f32_16x16x64_bf16 v[176:179],v[76:79],a[88:95],v14
s_waitcnt lgkmcnt(3)
v_smfmac_f32_16x16x64_bf16 v[176:179],v[80:83],a[96:103],v14
s_waitcnt lgkmcnt(2)
v_smfmac_f32_16x16x64_bf16 v[176:179],v[84:87],a[104:111],v14
s_waitcnt lgkmcnt(1)
v_smfmac_f32_16x16x64_bf16 v[176:179],v[88:91],a[112:119],v14
s_waitcnt lgkmcnt(0)
v_smfmac_f32_16x16x64_bf16 v[176:179],v[92:95],a[120:127],v14
s_nop 7
v_permlane32_swap_b32 v176,v178
v_permlane32_swap_b32 v177,v179
v_add_f32 v176,v176,v178
v_add_f32 v177,v177,v179
v_cvt_pk_bf16_f32 v216,v176,v177
s_nop 1
v_mov_b32_dpp v217,v216 quad_perm:[1,0,3,2] row_mask:0xf bank_mask:0xf
v_perm_b32 v216,v217,v216,v15
v_max_u32 v216,1,v216
buffer_store_dword v216,v19,s[24:27],s70 offen
buffer_store_dword v216,v19,s[28:31],s70 offen sc1
s_lshr_b32 s64,s70,9
v_add_u32 v22,s64,v24
s_cmp_eq_u32 s79,0
ds_read_b128 v[128:131],v22 offset:16384
ds_read_b128 v[132:135],v22 offset:17408
s_cbranch_scc1 kt0_69
kt0b_70:
s_nop 15
s_nop 15
s_nop 11
buffer_load_dwordx4 v[32:35],v8,s[20:23],s70 offen sc1
buffer_load_dwordx4 v[36:39],v9,s[20:23],s70 offen sc1
buffer_load_dwordx4 v[40:43],v10,s[20:23],s70 offen sc1
buffer_load_dwordx4 v[44:47],v11,s[20:23],s70 offen sc1
s_nop 9
scp_71:
buffer_load_dwordx4 v[48:51],v8,s[20:23],s70 offen sc1
buffer_load_dwordx4 v[52:55],v9,s[20:23],s70 offen sc1
buffer_load_dwordx4 v[56:59],v10,s[20:23],s70 offen sc1
buffer_load_dwordx4 v[60:63],v11,s[20:23],s70 offen sc1
s_waitcnt vmcnt(4)
v_mfma_f32_16x16x32_bf16 v[168:171],v[32:35],v[32:35],v[156:159]
v_min3_u32 v22,v32,v33,v34
v_min3_u32 v22,v22,v35,v36
v_mfma_f32_16x16x32_bf16 v[164:167],v[100:103],v[32:35],0
v_min3_u32 v22,v22,v37,v38
v_min3_u32 v22,v22,v39,v40
v_mfma_f32_16x16x32_bf16 v[160:163],v[96:99],v[32:35],0
v_min3_u32 v22,v22,v41,v42
v_min3_u32 v22,v22,v43,v44
v_mfma_f32_16x16x32_bf16 v[168:171],v[36:39],v[36:39],v[168:171]
v_min3_u32 v22,v22,v45,v46
v_min_u32 v22,v22,v47
v_mfma_f32_16x16x32_bf16 v[164:167],v[108:111],v[36:39],v[164:167]
v_cmp_eq_u32 vcc,0,v22
s_cbranch_vccnz nx_73
v_mfma_f32_16x16x32_bf16 v[160:163],v[104:107],v[36:39],v[160:163]
v_mov_b32 v172,v32
v_mfma_f32_16x16x32_bf16 v[168:171],v[40:43],v[40:43],v[168:171]
v_mov_b32 v173,v33
v_mfma_f32_16x16x32_bf16 v[164:167],v[116:119],v[40:43],v[164:167]
v_mov_b32 v174,v34
v_mfma_f32_16x16x32_bf16 v[160:163],v[112:115],v[40:43],v[160:163]
v_mov_b32 v175,v35
v_mfma_f32_16x16x32_bf16 v[168:171],v[44:47],v[44:47],v[168:171]
v_mfma_f32_16x16x32_bf16 v[164:167],v[124:127],v[44:47],v[164:167]
v_mfma_f32_16x16x32_bf16 v[160:163],v[120:123],v[44:47],v[160:163]
s_nop 1
s_branch scok_72
nx_73:
buffer_load_dwordx4 v[32:35],v8,s[20:23],s70 offen sc1
buffer_load_dwordx4 v[36:39],v9,s[20:23],s70 offen sc1
buffer_load_dwordx4 v[40:43],v10,s[20:23],s70 offen sc1
buffer_load_dwordx4 v[44:47],v11,s[20:23],s70 offen sc1
s_waitcnt vmcnt(4)
v_mfma_f32_16x16x32_bf16 v[168:171],v[48:51],v[48:51],v[156:159]
v_min3_u32 v22,v48,v49,v50
v_min3_u32 v22,v22,v51,v52
v_mfma_f32_16x16x32_bf16 v[164:167],v[100:103],v[48:51],0
v_min3_u32 v22,v22,v53,v54
v_min3_u32 v22,v22,v55,v56
v_mfma_f32_16x16x32_bf16 v[160:163],v[96:99],v[48:51],0
v_min3_u32 v22,v22,v57,v58
v_min3_u32 v22,v22,v59,v60
v_mfma_f32_16x16x32_bf16 v[168:171],v[52:55],v[52:55],v[168:171]
v_min3_u32 v22,v22,v61,v62
v_min_u32 v22,v22,v63
v_mfma_f32_16x16x32_bf16 v[164:167],v[108:111],v[52:55],v[164:167]
v_cmp_eq_u32 vcc,0,v22
s_cbranch_vccnz nx_74
v_mfma_f32_16x16x32_bf16 v[160:163],v[104:107],v[52:55],v[160:163]
v_mov_b32 v172,v48
v_mfma_f32_16x16x32_bf16 v[168:171],v[56:59],v[56:59],v[168:171]
v_mov_b32 v173,v49
v_mfma_f32_16x16x32_bf16 v[164:167],v[116:119],v[56:59],v[164:167]
v_mov_b32 v174,v50
v_mfma_f32_16x16x32_bf16 v[160:163],v[112:115],v[56:59],v[160:163]
v_mov_b32 v175,v51
v_mfma_f32_16x16x32_bf16 v[168:171],v[60:63],v[60:63],v[168:171]
v_mfma_f32_16x16x32_bf16 v[164:167],v[124:127],v[60:63],v[164:167]
v_mfma_f32_16x16x32_bf16 v[160:163],v[120:123],v[60:63],v[160:163]
s_nop 1
s_branch scok_72
nx_74:
s_sub_u32 s90,s90,1
s_cmp_gt_i32 s90,0
s_cbranch_scc1 scp_71
s_nop 7
scok_72:
ds_read_b64 v[220:221],v21
ds_read_b64 v[136:137],v31
ds_read_b64 v[140:141],v31 offset:256
s_cmp_eq_u32 s79,63
s_cbranch_scc1 last0_75
v_max3_f32 v216,v168,v169,v170
v_mov_b32_dpp v160,v164 row_ror:8 row_mask:0xf bank_mask:0xc
v_mov_b32_dpp v161,v165 row_ror:8 row_mask:0xf bank_mask:0xc
v_mov_b32_dpp v162,v166 row_ror:8 row_mask:0xf bank_mask:0xc
v_mov_b32_dpp v163,v167 row_ror:8 row_mask:0xf bank_mask:0xc
v_max3_f32 v217,v171,v160,v161
v_max3_f32 v216,v216,v162,v163
v_max_f32 v216,v216,v217
s_nop 1
v_max_f32_dpp v216,v216,v216 row_ror:8 row_mask:0xf bank_mask:0xf
v_mov_b32 v217,v216
s_nop 1
v_permlane16_swap_b32 v217,v216
v_max_f32 v216,v216,v217
v_mov_b32 v217,v216
s_nop 1
v_permlane32_swap_b32 v217,v216
v_max_f32 v216,v216,v217
v_mul_f32 v216,s81,v216
v_fma_f32 v160,v160,s81,-v216
v_fma_f32 v161,v161,s81,-v216
v_fma_f32 v162,v162,s81,-v216
v_fma_f32 v163,v163,s81,-v216
v_fma_f32 v168,v168,s81,-v216
v_fma_f32 v169,v169,s81,-v216
v_fma_f32 v170,v170,s81,-v216
v_fma_f32 v171,v171,s81,-v216
v_exp_f32 v160,v160
v_exp_f32 v161,v161
v_exp_f32 v162,v162
v_exp_f32 v163,v163
v_exp_f32 v168,v168
v_exp_f32 v169,v169
v_exp_f32 v170,v170
v_exp_f32 v171,v171
v_cvt_pk_bf16_f32 v148,v160,v161
v_cvt_pk_bf16_f32 v149,v162,v163
v_cvt_pk_bf16_f32 v144,v168,v169
v_mov_b32_dpp v150,v148 row_ror:8 row_mask:0xf bank_mask:0xf
v_mov_b32_dpp v151,v149 row_ror:8 row_mask:0xf bank_mask:0xf
v_cvt_pk_bf16_f32 v145,v170,v171
s_waitcnt lgkmcnt(0)
v_min_u32 v220,v220,v221
v_mfma_f32_16x16x32_bf16 v[232:235],v[152:155],v[148:151],0
v_cmp_ne_u32 vcc,v220,v25
v_mfma_f32_16x16x32_bf16 v[232:235],v[152:155],v[144:147],v[232:235]
v_mfma_f32_16x16x32_bf16 v[224:227],v[128:131],v[148:151],0
v_mfma_f32_16x16x32_bf16 v[228:231],v[132:135],v[148:151],0
s_cbranch_vccnz vw_76
vb_77:
v_mfma_f32_16x16x32_bf16 v[224:227],v[136:139],v[144:147],v[224:227]
v_mfma_f32_16x16x32_bf16 v[228:231],v[140:143],v[144:147],v[228:231]
s_mov_b64 exec,s[84:85]
s_nop 1
v_rcp_f32 v236,v232
s_nop 2
v_pk_mul_f32 v[224:225],v[224:225],v[236:237] op_sel_hi:[1,0]
v_pk_mul_f32 v[226:227],v[226:227],v[236:237] op_sel_hi:[1,0]
v_pk_mul_f32 v[228:229],v[228:229],v[236:237] op_sel_hi:[1,0]
v_pk_mul_f32 v[230:231],v[230:231],v[236:237] op_sel_hi:[1,0]
v_cvt_pk_bf16_f32 v216,v224,v225
v_cvt_pk_bf16_f32 v217,v226,v227
v_cvt_pk_bf16_f32 v218,v228,v229
v_cvt_pk_bf16_f32 v219,v230,v231
v_max_u32 v216,1,v216
v_max_u32 v217,1,v217
v_max_u32 v218,1,v218
v_max_u32 v219,1,v219
buffer_store_dwordx4 v[216:219],v30,s[24:27],s71 offen
buffer_store_dwordx4 v[216:219],v30,s[28:31],s71 offen sc1
s_mov_b64 exec,1
buffer_store_dword v25,v13,s[24:27],s70 offen offset:512
buffer_store_dword v25,v13,s[28:31],s70 offen offset:512 sc1
s_mov_b64 exec,-1
ds_write_b32 v21,v25 offset:8
hl_78:
buffer_load_dword v248,v18,s[20:23],s70 offen offset:512 sc1
s_waitcnt vmcnt(0)
v_cmp_eq_u32 vcc,v25,v248
s_bcnt1_i32_b32 s64,vcc_lo
s_cmp_ge_u32 s64,16
s_cbranch_scc1 hg_79
s_sub_u32 s90,s90,1
s_cmp_gt_i32 s90,0
s_cbranch_scc1 hl_78
hg_79:
buffer_load_dwordx4 v[32:35],v26,s[20:23],s71 offen offset:0 sc1
buffer_load_dwordx4 v[36:39],v26,s[20:23],s71 offen offset:1024 sc1
buffer_load_dwordx4 v[40:43],v26,s[20:23],s71 offen offset:2048 sc1
buffer_load_dwordx4 v[44:47],v26,s[20:23],s71 offen offset:3072 sc1
buffer_load_dwordx4 v[48:51],v27,s[20:23],s71 offen offset:0 sc1
buffer_load_dwordx4 v[52:55],v27,s[20:23],s71 offen offset:1024 sc1
buffer_load_dwordx4 v[56:59],v27,s[20:23],s71 offen offset:2048 sc1
buffer_load_dwordx4 v[60:63],v27,s[20:23],s71 offen offset:3072 sc1
s_mov_b32 s68,0
s_waitcnt vmcnt(6)
v_smfmac_f32_16x16x64_bf16 v[184:187],v[32:35],a[128:135],v14
v_min3_u32 v22,v32,v33,v34
v_min3_u32 v22,v22,v35,v36
v_smfmac_f32_16x16x64_bf16 v[188:191],v[32:35],a[136:143],v14
v_min3_u32 v22,v22,v37,v38
v_smfmac_f32_16x16x64_bf16 v[184:187],v[36:39],a[144:151],v14
v_min_u32 v22,v22,v39
v_smfmac_f32_16x16x64_bf16 v[188:191],v[36:39],a[152:159],v14
v_cmp_eq_u32 s[52:53],0,v22
s_waitcnt vmcnt(4)
v_smfmac_f32_16x16x64_bf16 v[184:187],v[40:43],a[160:167],v14
v_min3_u32 v22,v40,v41,v42
s_cmp_lg_u64 s[52:53],0
v_smfmac_f32_16x16x64_bf16 v[188:191],v[40:43],a[168:175],v14
s_cbranch_scc1 ms_80
bk_81:
v_min3_u32 v22,v22,v43,v44
v_smfmac_f32_16x16x64_bf16 v[184:187],v[44:47],a[176:183],v14
v_min3_u32 v22,v22,v45,v46
v_min_u32 v22,v22,v47
v_smfmac_f32_16x16x64_bf16 v[188:191],v[44:47],a[184:191],v14
v_cmp_eq_u32 s[54:55],0,v22
s_waitcnt vmcnt(2)
v_smfmac_f32_16x16x64_bf16 v[184:187],v[48:51],a[192:199],v14
v_min3_u32 v22,v48,v49,v50
s_cmp_lg_u64 s[54:55],0
v_smfmac_f32_16x16x64_bf16 v[188:191],v[48:51],a[200:207],v14
s_cbranch_scc1 ms_82
bk_83:
v_min3_u32 v22,v22,v51,v52
v_smfmac_f32_16x16x64_bf16 v[184:187],v[52:55],a[208:215],v14
v_min3_u32 v22,v22,v53,v54
v_min_u32 v22,v22,v55
v_smfmac_f32_16x16x64_bf16 v[188:191],v[52:55],a[216:223],v14
v_cmp_eq_u32 s[52:53],0,v22
s_waitcnt vmcnt(0)
v_smfmac_f32_16x16x64_bf16 v[184:187],v[56:59],a[224:231],v14
v_min3_u32 v22,v56,v57,v58
s_cmp_lg_u64 s[52:53],0
v_smfmac_f32_16x16x64_bf16 v[188:191],v[56:59],a[232:239],v14
s_cbranch_scc1 ms_84
bk_85:
v_min3_u32 v22,v22,v59,v60
v_smfmac_f32_16x16x64_bf16 v[184:187],v[60:63],a[240:247],v14
v_min3_u32 v22,v22,v61,v62
v_min_u32 v22,v22,v63
v_smfmac_f32_16x16x64_bf16 v[188:191],v[60:63],a[248:255],v14
v_cmp_eq_u32 s[54:55],0,v22
s_cmp_lg_u64 s[54:55],0
s_cbranch_scc1 ms_88
bk_89:
s_cmp_lg_u32 s68,0
s_cbranch_scc1 rl2_90
fin_86:
s_nop 2
v_permlane32_swap_b32 v184,v188
v_permlane32_swap_b32 v185,v189
v_permlane32_swap_b32 v186,v190
v_permlane32_swap_b32 v187,v191
v_pk_add_f32 v[184:185],v[184:185],v[188:189]
v_pk_add_f32 v[186:187],v[186:187],v[190:191]
ds_write_b128 v24,v[184:187] offset:25600
ds_write_b32 v21,v25 offset:12
s_mov_b64 exec,s[84:85]
ds_read_b128 v[172:175],v12
s_mov_b64 exec,-1
ds_read_b64 v[220:221],v21 offset:24
buffer_load_dwordx4 v[96:99],v2,s[20:23],s72 offen offset:0 sc1
buffer_load_dwordx4 v[100:103],v2,s[20:23],s72 offen offset:1024 sc1
buffer_load_dwordx4 v[104:107],v5,s[20:23],s72 offen offset:0 sc1
buffer_load_dwordx4 v[108:111],v5,s[20:23],s72 offen offset:1024 sc1
buffer_load_dwordx4 v[112:115],v6,s[20:23],s72 offen offset:0 sc1
buffer_load_dwordx4 v[116:119],v6,s[20:23],s72 offen offset:1024 sc1
buffer_load_dwordx4 v[120:123],v7,s[20:23],s72 offen offset:0 sc1
buffer_load_dwordx4 v[124:127],v7,s[20:23],s72 offen offset:1024 sc1
s_waitcnt lgkmcnt(0)
v_min_u32 v220,v220,v221
v_cmp_ne_u32 vcc,v220,v25
s_cbranch_vccnz v2w_91
v2b_92:
buffer_store_dwordx4 v[172:175],v3,s[20:23],s77 offen sc1
s_xor_b32 s62,s62,0x10000
s_add_u32 s63,s79,1
s_and_b32 s64,s63,3
s_lshl_b32 s70,s64,20
s_add_u32 s65,s63,2
s_and_b32 s65,s65,3
s_lshl_b32 s73,s65,20
s_add_u32 s55,s63,3
s_lshl_b32 s78,s55,16
s_add_u32 s78,s78,57344
s_cmp_lt_u32 s55,64
s_cselect_b32 s78,s78,0x7fff0000
s_add_u32 s71,s70,65536
s_add_u32 s60,s63,1
s_and_b32 s60,s60,3
s_lshl_b32 s72,s60,20
v_mov_b32 v184,0
v_mov_b32 v185,0
v_mov_b32 v186,0
v_mov_b32 v187,0
v_mov_b32 v188,0
v_mov_b32 v189,0
v_mov_b32 v190,0
v_mov_b32 v191,0
s_lshl_b32 s77,s63,21
s_lshl_b32 s55,s63,13
s_and_b32 s55,s55,0x2000
s_xor_b32 s55,s55,s61
s_add_u32 s77,s77,s55
v_mov_b32 v176,0
v_mov_b32 v177,0
v_mov_b32 v178,0
v_mov_b32 v179,0
s_add_u32 s79,s79,1
v_add_u32 v25,1,v25
s_waitcnt vmcnt(0) lgkmcnt(0)
s_branch loop_63
last0_75:
wf_93:
ds_read_b32 v23,v21 offset:0
s_sub_u32 s90,s90,1
s_waitcnt lgkmcnt(0)
v_cmp_ne_u32 vcc,v23,v25
s_cmp_lt_i32 s90,0
s_cselect_b64 vcc,0,vcc
s_cbranch_vccnz wf_93
wf_94:
ds_read_b32 v23,v21 offset:4
s_sub_u32 s90,s90,1
s_waitcnt lgkmcnt(0)
v_cmp_ne_u32 vcc,v23,v25
s_cmp_lt_i32 s90,0
s_cselect_b64 vcc,0,vcc
s_cbranch_vccnz wf_94
s_mov_b64 exec,s[84:85]
ds_read_b128 v[172:175],v12
s_mov_b64 exec,-1
s_waitcnt lgkmcnt(0)
buffer_store_dwordx4 v[172:175],v3,s[20:23],s77 offen sc1
s_branch end_57
art_67:
s_sub_u32 s90,s90,1
s_cmp_lt_i32 s90,0
s_cbranch_scc1 abk_68
buffer_load_dwordx4 v[32:35],v26,s[20:23],s70 offen offset:0 sc1
buffer_load_dwordx4 v[36:39],v26,s[20:23],s70 offen offset:1024 sc1
buffer_load_dwordx4 v[40:43],v26,s[20:23],s70 offen offset:2048 sc1
buffer_load_dwordx4 v[44:47],v26,s[20:23],s70 offen offset:3072 sc1
s_waitcnt vmcnt(3)
ds_write_b128 v24,v[32:35] offset:0
v_min3_u32 v22,v32,v33,v34
v_min_u32 v22,v22,v35
s_waitcnt vmcnt(2)
ds_write_b128 v24,v[36:39] offset:1024
v_min3_u32 v22,v22,v36,v37
v_min3_u32 v22,v22,v38,v39
s_waitcnt vmcnt(1)
ds_write_b128 v24,v[40:43] offset:2048
v_min3_u32 v22,v22,v40,v41
v_min3_u32 v22,v22,v42,v43
s_waitcnt vmcnt(0)
ds_write_b128 v24,v[44:47] offset:3072
v_min3_u32 v22,v22,v44,v45
v_min3_u32 v22,v22,v46,v47
v_cmp_eq_u32 vcc,0,v22
s_cbranch_vccnz art_67
s_branch abk_68
kt0_69:
buffer_load_dwordx4 v[96:99],v2,s[20:23],s70 offen offset:0 sc1
buffer_load_dwordx4 v[100:103],v2,s[20:23],s70 offen offset:1024 sc1
buffer_load_dwordx4 v[104:107],v5,s[20:23],s70 offen offset:0 sc1
buffer_load_dwordx4 v[108:111],v5,s[20:23],s70 offen offset:1024 sc1
buffer_load_dwordx4 v[112:115],v6,s[20:23],s70 offen offset:0 sc1
buffer_load_dwordx4 v[116:119],v6,s[20:23],s70 offen offset:1024 sc1
buffer_load_dwordx4 v[120:123],v7,s[20:23],s70 offen offset:0 sc1
buffer_load_dwordx4 v[124:127],v7,s[20:23],s70 offen offset:1024 sc1
s_branch kt0b_70
vw_76:
wf_95:
ds_read_b32 v23,v21 offset:0
s_sub_u32 s90,s90,1
s_waitcnt lgkmcnt(0)
v_cmp_ne_u32 vcc,v23,v25
s_cmp_lt_i32 s90,0
s_cselect_b64 vcc,0,vcc
s_cbranch_vccnz wf_95
wf_96:
ds_read_b32 v23,v21 offset:4
s_sub_u32 s90,s90,1
s_waitcnt lgkmcnt(0)
v_cmp_ne_u32 vcc,v23,v25
s_cmp_lt_i32 s90,0
s_cselect_b64 vcc,0,vcc
s_cbranch_vccnz wf_96
ds_read_b64 v[220:221],v21
ds_read_b64 v[136:137],v31
ds_read_b64 v[140:141],v31 offset:256
s_waitcnt lgkmcnt(0)
s_branch vb_77
ms_80:
s_waitcnt vmcnt(0)
buffer_load_dwordx4 v[64:67],v26,s[20:23],s71 offen offset:0 sc1
buffer_load_dwordx4 v[68:71],v26,s[20:23],s71 offen offset:1024 sc1
s_bitset1_b32 s68,0
s_branch bk_81
ms_82:
s_waitcnt vmcnt(0)
buffer_load_dwordx4 v[72:75],v26,s[20:23],s71 offen offset:2048 sc1
buffer_load_dwordx4 v[76:79],v26,s[20:23],s71 offen offset:3072 sc1
s_bitset1_b32 s68,1
s_branch bk_83
ms_84:
s_waitcnt vmcnt(0)
buffer_load_dwordx4 v[80:83],v27,s[20:23],s71 offen offset:0 sc1
buffer_load_dwordx4 v[84:87],v27,s[20:23],s71 offen offset:1024 sc1
s_bitset1_b32 s68,2
s_branch bk_85
ms_88:
s_waitcnt vmcnt(0)
buffer_load_dwordx4 v[88:91],v27,s[20:23],s71 offen offset:2048 sc1
buffer_load_dwordx4 v[92:95],v27,s[20:23],s71 offen offset:3072 sc1
s_bitset1_b32 s68,3
s_branch bk_89
rl_87:
s_bitcmp1_b32 s68,0
s_cbranch_scc0 sk_97
buffer_load_dwordx4 v[64:67],v26,s[20:23],s71 offen offset:0 sc1
buffer_load_dwordx4 v[68:71],v26,s[20:23],s71 offen offset:1024 sc1
sk_97:
s_bitcmp1_b32 s68,1
s_cbranch_scc0 sk_98
buffer_load_dwordx4 v[72:75],v26,s[20:23],s71 offen offset:2048 sc1
buffer_load_dwordx4 v[76:79],v26,s[20:23],s71 offen offset:3072 sc1
sk_98:
s_bitcmp1_b32 s68,2
s_cbranch_scc0 sk_99
buffer_load_dwordx4 v[80:83],v27,s[20:23],s71 offen offset:0 sc1
buffer_load_dwordx4 v[84:87],v27,s[20:23],s71 offen offset:1024 sc1
sk_99:
s_bitcmp1_b32 s68,3
s_cbranch_scc0 sk_100
buffer_load_dwordx4 v[88:91],v27,s[20:23],s71 offen offset:2048 sc1
buffer_load_dwordx4 v[92:95],v27,s[20:23],s71 offen offset:3072 sc1
sk_100:
rl2_90:
s_sub_u32 s90,s90,1
s_cmp_lt_i32 s90,0
s_cbranch_scc1 fin_86
s_waitcnt vmcnt(0)
s_bitcmp1_b32 s68,0
s_cbranch_scc0 sk_101
v_min3_u32 v22,v64,v65,v66
v_min3_u32 v22,v22,v67,v68
v_min3_u32 v22,v22,v69,v70
v_min_u32 v22,v22,v71
v_cmp_eq_u32 vcc,0,v22
v_xor_b32 v64,v32,v64
v_xor_b32 v65,v33,v65
v_xor_b32 v66,v34,v66
v_xor_b32 v67,v35,v67
v_xor_b32 v68,v36,v68
v_xor_b32 v69,v37,v69
v_xor_b32 v70,v38,v70
v_xor_b32 v71,v39,v71
s_cbranch_vccnz nb_102
s_bitset0_b32 s68,0
v_smfmac_f32_16x16x64_bf16 v[184:187],v[64:67],a[128:135],v14
v_smfmac_f32_16x16x64_bf16 v[188:191],v[64:67],a[136:143],v14
v_smfmac_f32_16x16x64_bf16 v[184:187],v[68:71],a[144:151],v14
v_smfmac_f32_16x16x64_bf16 v[188:191],v[68:71],a[152:159],v14
nb_102:
sk_101:
s_bitcmp1_b32 s68,1
s_cbranch_scc0 sk_103
v_min3_u32 v22,v72,v73,v74
v_min3_u32 v22,v22,v75,v76
v_min3_u32 v22,v22,v77,v78
v_min_u32 v22,v22,v79
v_cmp_eq_u32 vcc,0,v22
v_xor_b32 v72,v40,v72
v_xor_b32 v73,v41,v73
v_xor_b32 v74,v42,v74
v_xor_b32 v75,v43,v75
v_xor_b32 v76,v44,v76
v_xor_b32 v77,v45,v77
v_xor_b32 v78,v46,v78
v_xor_b32 v79,v47,v79
s_cbranch_vccnz nb_104
s_bitset0_b32 s68,1
v_smfmac_f32_16x16x64_bf16 v[184:187],v[72:75],a[160:167],v14
v_smfmac_f32_16x16x64_bf16 v[188:191],v[72:75],a[168:175],v14
v_smfmac_f32_16x16x64_bf16 v[184:187],v[76:79],a[176:183],v14
v_smfmac_f32_16x16x64_bf16 v[188:191],v[76:79],a[184:191],v14
nb_104:
sk_103:
s_bitcmp1_b32 s68,2
s_cbranch_scc0 sk_105
v_min3_u32 v22,v80,v81,v82
v_min3_u32 v22,v22,v83,v84
v_min3_u32 v22,v22,v85,v86
v_min_u32 v22,v22,v87
v_cmp_eq_u32 vcc,0,v22
v_xor_b32 v80,v48,v80
v_xor_b32 v81,v49,v81
v_xor_b32 v82,v50,v82
v_xor_b32 v83,v51,v83
v_xor_b32 v84,v52,v84
v_xor_b32 v85,v53,v85
v_xor_b32 v86,v54,v86
v_xor_b32 v87,v55,v87
s_cbranch_vccnz nb_106
s_bitset0_b32 s68,2
v_smfmac_f32_16x16x64_bf16 v[184:187],v[80:83],a[192:199],v14
v_smfmac_f32_16x16x64_bf16 v[188:191],v[80:83],a[200:207],v14
v_smfmac_f32_16x16x64_bf16 v[184:187],v[84:87],a[208:215],v14
v_smfmac_f32_16x16x64_bf16 v[188:191],v[84:87],a[216:223],v14
nb_106:
sk_105:
s_bitcmp1_b32 s68,3
s_cbranch_scc0 sk_107
v_min3_u32 v22,v88,v89,v90
v_min3_u32 v22,v22,v91,v92
v_min3_u32 v22,v22,v93,v94
v_min_u32 v22,v22,v95
v_cmp_eq_u32 vcc,0,v22
v_xor_b32 v88,v56,v88
v_xor_b32 v89,v57,v89
v_xor_b32 v90,v58,v90
v_xor_b32 v91,v59,v91
v_xor_b32 v92,v60,v92
v_xor_b32 v93,v61,v93
v_xor_b32 v94,v62,v94
v_xor_b32 v95,v63,v95
s_cbranch_vccnz nb_108
s_bitset0_b32 s68,3
v_smfmac_f32_16x16x64_bf16 v[184:187],v[88:91],a[224:231],v14
v_smfmac_f32_16x16x64_bf16 v[188:191],v[88:91],a[232:239],v14
v_smfmac_f32_16x16x64_bf16 v[184:187],v[92:95],a[240:247],v14
v_smfmac_f32_16x16x64_bf16 v[188:191],v[92:95],a[248:255],v14
nb_108:
sk_107:
s_cmp_lg_u32 s68,0
s_cbranch_scc1 rl_87
s_nop 2
s_branch fin_86
v2w_91:
wf_109:
ds_read_b32 v23,v21 offset:24
s_sub_u32 s90,s90,1
s_waitcnt lgkmcnt(0)
v_cmp_ne_u32 vcc,v23,v25
s_cmp_lt_i32 s90,0
s_cselect_b64 vcc,0,vcc
s_cbranch_vccnz wf_109
wf_110:
ds_read_b32 v23,v21 offset:28
s_sub_u32 s90,s90,1
s_waitcnt lgkmcnt(0)
v_cmp_ne_u32 vcc,v23,v25
s_cmp_lt_i32 s90,0
s_cselect_b64 vcc,0,vcc
s_cbranch_vccnz wf_110
s_branch v2b_92
first_62:
s_waitcnt vmcnt(0) lgkmcnt(0)
s_barrier
s_add_u32 s64,s15,393216
buffer_load_dwordx4 a[176:179],v32,s[40:43],s64 offen nt
s_add_u32 s64,s15,425984
buffer_load_dwordx4 a[180:183],v32,s[40:43],s64 offen nt
s_add_u32 s64,s15,458752
buffer_load_dwordx4 a[184:187],v32,s[40:43],s64 offen nt
s_add_u32 s64,s15,491520
buffer_load_dwordx4 a[188:191],v32,s[40:43],s64 offen nt
s_add_u32 s64,s15,524288
buffer_load_dwordx4 a[192:195],v32,s[40:43],s64 offen nt
s_add_u32 s64,s15,557056
buffer_load_dwordx4 a[196:199],v32,s[40:43],s64 offen nt
s_add_u32 s64,s15,589824
buffer_load_dwordx4 a[200:203],v32,s[40:43],s64 offen nt
s_add_u32 s64,s15,622592
buffer_load_dwordx4 a[204:207],v32,s[40:43],s64 offen nt
s_add_u32 s64,s15,655360
buffer_load_dwordx4 a[208:211],v32,s[40:43],s64 offen nt
s_add_u32 s64,s15,688128
buffer_load_dwordx4 a[212:215],v32,s[40:43],s64 offen nt
s_add_u32 s64,s15,720896
buffer_load_dwordx4 a[216:219],v32,s[40:43],s64 offen nt
s_add_u32 s64,s15,753664
buffer_load_dwordx4 a[220:223],v32,s[40:43],s64 offen nt
s_add_u32 s64,s15,786432
buffer_load_dwordx4 a[224:227],v32,s[40:43],s64 offen nt
s_add_u32 s64,s15,819200
buffer_load_dwordx4 a[228:231],v32,s[40:43],s64 offen nt
s_add_u32 s64,s15,851968
buffer_load_dwordx4 a[232:235],v32,s[40:43],s64 offen nt
s_add_u32 s64,s15,884736
buffer_load_dwordx4 a[236:239],v32,s[40:43],s64 offen nt
s_add_u32 s64,s15,917504
buffer_load_dwordx4 a[240:243],v32,s[40:43],s64 offen nt
s_add_u32 s64,s15,950272
buffer_load_dwordx4 a[244:247],v32,s[40:43],s64 offen nt
s_add_u32 s64,s15,983040
buffer_load_dwordx4 a[248:251],v32,s[40:43],s64 offen nt
s_add_u32 s64,s15,1015808
buffer_load_dwordx4 a[252:255],v32,s[40:43],s64 offen nt
ds_write_b128 v33,a[0:3] offset:0
ds_write_b128 v33,a[4:7] offset:1024
ds_write_b128 v33,a[8:11] offset:2048
ds_write_b128 v33,a[12:15] offset:3072
s_waitcnt lgkmcnt(0)
v_mov_b32 v38,1
ds_write_b32 v37,v38 offset:0
qs_111:
ds_read_b32 v39,v37 offset:4
s_sub_u32 s90,s90,1
s_waitcnt lgkmcnt(0)
v_cmp_gt_u32 vcc,v38,v39
s_cmp_lt_i32 s90,0
s_cselect_b64 vcc,0,vcc
s_cbranch_vccnz qs_111
ds_read_b64_tr_b16 a[0:1],v36 offset:0
ds_read_b64_tr_b16 a[2:3],v36 offset:128
ds_read_b64_tr_b16 a[4:5],v36 offset:2048
ds_read_b64_tr_b16 a[6:7],v36 offset:2176
ds_read_b64_tr_b16 a[8:9],v36 offset:8192
ds_read_b64_tr_b16 a[10:11],v36 offset:8320
ds_read_b64_tr_b16 a[12:13],v36 offset:10240
ds_read_b64_tr_b16 a[14:15],v36 offset:10368
ds_write_b128 v33,a[16:19] offset:4096
ds_write_b128 v33,a[20:23] offset:5120
ds_write_b128 v33,a[24:27] offset:6144
ds_write_b128 v33,a[28:31] offset:7168
s_waitcnt lgkmcnt(0)
v_mov_b32 v38,2
ds_write_b32 v37,v38 offset:0
qs_112:
ds_read_b32 v39,v37 offset:4
s_sub_u32 s90,s90,1
s_waitcnt lgkmcnt(0)
v_cmp_gt_u32 vcc,v38,v39
s_cmp_lt_i32 s90,0
s_cselect_b64 vcc,0,vcc
s_cbranch_vccnz qs_112
ds_read_b64_tr_b16 a[16:17],v36 offset:4096
ds_read_b64_tr_b16 a[18:19],v36 offset:4224
ds_read_b64_tr_b16 a[20:21],v36 offset:6144
ds_read_b64_tr_b16 a[22:23],v36 offset:6272
ds_read_b64_tr_b16 a[24:25],v36 offset:12288
ds_read_b64_tr_b16 a[26:27],v36 offset:12416
ds_read_b64_tr_b16 a[28:29],v36 offset:14336
ds_read_b64_tr_b16 a[30:31],v36 offset:14464
ds_write_b128 v33,a[32:35] offset:0
ds_write_b128 v33,a[36:39] offset:1024
ds_write_b128 v33,a[40:43] offset:2048
ds_write_b128 v33,a[44:47] offset:3072
s_waitcnt lgkmcnt(0)
v_mov_b32 v38,3
ds_write_b32 v37,v38 offset:0
qs_113:
ds_read_b32 v39,v37 offset:4
s_sub_u32 s90,s90,1
s_waitcnt lgkmcnt(0)
v_cmp_gt_u32 vcc,v38,v39
s_cmp_lt_i32 s90,0
s_cselect_b64 vcc,0,vcc
s_cbranch_vccnz qs_113
ds_read_b64_tr_b16 a[32:33],v36 offset:0
ds_read_b64_tr_b16 a[34:35],v36 offset:128
ds_read_b64_tr_b16 a[36:37],v36 offset:2048
ds_read_b64_tr_b16 a[38:39],v36 offset:2176
ds_read_b64_tr_b16 a[40:41],v36 offset:8192
ds_read_b64_tr_b16 a[42:43],v36 offset:8320
ds_read_b64_tr_b16 a[44:45],v36 offset:10240
ds_read_b64_tr_b16 a[46:47],v36 offset:10368
ds_write_b128 v33,a[48:51] offset:4096
ds_write_b128 v33,a[52:55] offset:5120
ds_write_b128 v33,a[56:59] offset:6144
ds_write_b128 v33,a[60:63] offset:7168
s_waitcnt lgkmcnt(0)
v_mov_b32 v38,4
ds_write_b32 v37,v38 offset:0
qs_114:
ds_read_b32 v39,v37 offset:4
s_sub_u32 s90,s90,1
s_waitcnt lgkmcnt(0)
v_cmp_gt_u32 vcc,v38,v39
s_cmp_lt_i32 s90,0
s_cselect_b64 vcc,0,vcc
s_cbranch_vccnz qs_114
ds_read_b64_tr_b16 a[48:49],v36 offset:4096
ds_read_b64_tr_b16 a[50:51],v36 offset:4224
ds_read_b64_tr_b16 a[52:53],v36 offset:6144
ds_read_b64_tr_b16 a[54:55],v36 offset:6272
ds_read_b64_tr_b16 a[56:57],v36 offset:12288
ds_read_b64_tr_b16 a[58:59],v36 offset:12416
ds_read_b64_tr_b16 a[60:61],v36 offset:14336
ds_read_b64_tr_b16 a[62:63],v36 offset:14464
ds_write_b128 v33,a[64:67] offset:0
ds_write_b128 v33,a[68:71] offset:1024
ds_write_b128 v33,a[72:75] offset:2048
ds_write_b128 v33,a[76:79] offset:3072
s_waitcnt lgkmcnt(0)
v_mov_b32 v38,5
ds_write_b32 v37,v38 offset:0
qs_115:
ds_read_b32 v39,v37 offset:4
s_sub_u32 s90,s90,1
s_waitcnt lgkmcnt(0)
v_cmp_gt_u32 vcc,v38,v39
s_cmp_lt_i32 s90,0
s_cselect_b64 vcc,0,vcc
s_cbranch_vccnz qs_115
ds_read_b64_tr_b16 a[64:65],v36 offset:0
ds_read_b64_tr_b16 a[66:67],v36 offset:128
ds_read_b64_tr_b16 a[68:69],v36 offset:2048
ds_read_b64_tr_b16 a[70:71],v36 offset:2176
ds_read_b64_tr_b16 a[72:73],v36 offset:8192
ds_read_b64_tr_b16 a[74:75],v36 offset:8320
ds_read_b64_tr_b16 a[76:77],v36 offset:10240
ds_read_b64_tr_b16 a[78:79],v36 offset:10368
ds_write_b128 v33,a[80:83] offset:4096
ds_write_b128 v33,a[84:87] offset:5120
ds_write_b128 v33,a[88:91] offset:6144
ds_write_b128 v33,a[92:95] offset:7168
s_waitcnt lgkmcnt(0)
v_mov_b32 v38,6
ds_write_b32 v37,v38 offset:0
qs_116:
ds_read_b32 v39,v37 offset:4
s_sub_u32 s90,s90,1
s_waitcnt lgkmcnt(0)
v_cmp_gt_u32 vcc,v38,v39
s_cmp_lt_i32 s90,0
s_cselect_b64 vcc,0,vcc
s_cbranch_vccnz qs_116
ds_read_b64_tr_b16 a[80:81],v36 offset:4096
ds_read_b64_tr_b16 a[82:83],v36 offset:4224
ds_read_b64_tr_b16 a[84:85],v36 offset:6144
ds_read_b64_tr_b16 a[86:87],v36 offset:6272
ds_read_b64_tr_b16 a[88:89],v36 offset:12288
ds_read_b64_tr_b16 a[90:91],v36 offset:12416
ds_read_b64_tr_b16 a[92:93],v36 offset:14336
ds_read_b64_tr_b16 a[94:95],v36 offset:14464
ds_write_b128 v33,a[96:99] offset:0
ds_write_b128 v33,a[100:103] offset:1024
ds_write_b128 v33,a[104:107] offset:2048
ds_write_b128 v33,a[108:111] offset:3072
s_waitcnt lgkmcnt(0)
v_mov_b32 v38,7
ds_write_b32 v37,v38 offset:0
qs_117:
ds_read_b32 v39,v37 offset:4
s_sub_u32 s90,s90,1
s_waitcnt lgkmcnt(0)
v_cmp_gt_u32 vcc,v38,v39
s_cmp_lt_i32 s90,0
s_cselect_b64 vcc,0,vcc
s_cbranch_vccnz qs_117
ds_read_b64_tr_b16 a[96:97],v36 offset:0
ds_read_b64_tr_b16 a[98:99],v36 offset:128
ds_read_b64_tr_b16 a[100:101],v36 offset:2048
ds_read_b64_tr_b16 a[102:103],v36 offset:2176
ds_read_b64_tr_b16 a[104:105],v36 offset:8192
ds_read_b64_tr_b16 a[106:107],v36 offset:8320
ds_read_b64_tr_b16 a[108:109],v36 offset:10240
ds_read_b64_tr_b16 a[110:111],v36 offset:10368
ds_write_b128 v33,a[112:115] offset:4096
ds_write_b128 v33,a[116:119] offset:5120
ds_write_b128 v33,a[120:123] offset:6144
ds_write_b128 v33,a[124:127] offset:7168
s_waitcnt lgkmcnt(0)
v_mov_b32 v38,8
ds_write_b32 v37,v38 offset:0
qs_118:
ds_read_b32 v39,v37 offset:4
s_sub_u32 s90,s90,1
s_waitcnt lgkmcnt(0)
v_cmp_gt_u32 vcc,v38,v39
s_cmp_lt_i32 s90,0
s_cselect_b64 vcc,0,vcc
s_cbranch_vccnz qs_118
ds_read_b64_tr_b16 a[112:113],v36 offset:4096
ds_read_b64_tr_b16 a[114:115],v36 offset:4224
ds_read_b64_tr_b16 a[116:117],v36 offset:6144
ds_read_b64_tr_b16 a[118:119],v36 offset:6272
ds_read_b64_tr_b16 a[120:121],v36 offset:12288
ds_read_b64_tr_b16 a[122:123],v36 offset:12416
ds_read_b64_tr_b16 a[124:125],v36 offset:14336
ds_read_b64_tr_b16 a[126:127],v36 offset:14464
s_waitcnt lgkmcnt(0)
v_mov_b32 v38,9
ds_write_b32 v37,v38 offset:0
qs_119:
ds_read_b32 v39,v37 offset:4
s_sub_u32 s90,s90,1
s_waitcnt lgkmcnt(0)
v_cmp_gt_u32 vcc,v38,v39
s_cmp_lt_i32 s90,0
s_cselect_b64 vcc,0,vcc
s_cbranch_vccnz qs_119
ds_write_b128 v33,a[128:131] offset:0
ds_write_b128 v33,a[132:135] offset:1024
ds_write_b128 v33,a[136:139] offset:2048
ds_write_b128 v33,a[140:143] offset:3072
s_waitcnt lgkmcnt(0)
ds_read_b64_tr_b16 a[128:129],v34 offset:0
ds_read_b64_tr_b16 a[130:131],v34 offset:128
ds_read_b64_tr_b16 a[132:133],v34 offset:2048
ds_read_b64_tr_b16 a[134:135],v34 offset:2176
ds_read_b64_tr_b16 a[136:137],v34 offset:32
ds_read_b64_tr_b16 a[138:139],v34 offset:160
ds_read_b64_tr_b16 a[140:141],v34 offset:2080
ds_read_b64_tr_b16 a[142:143],v34 offset:2208
ds_write_b128 v33,a[144:147] offset:4096
ds_write_b128 v33,a[148:151] offset:5120
ds_write_b128 v33,a[152:155] offset:6144
ds_write_b128 v33,a[156:159] offset:7168
s_waitcnt lgkmcnt(0)
ds_read_b64_tr_b16 a[144:145],v34 offset:4096
ds_read_b64_tr_b16 a[146:147],v34 offset:4224
ds_read_b64_tr_b16 a[148:149],v34 offset:6144
ds_read_b64_tr_b16 a[150:151],v34 offset:6272
ds_read_b64_tr_b16 a[152:153],v34 offset:4128
ds_read_b64_tr_b16 a[154:155],v34 offset:4256
ds_read_b64_tr_b16 a[156:157],v34 offset:6176
ds_read_b64_tr_b16 a[158:159],v34 offset:6304
ds_write_b128 v33,a[160:163] offset:0
ds_write_b128 v33,a[164:167] offset:1024
ds_write_b128 v33,a[168:171] offset:2048
ds_write_b128 v33,a[172:175] offset:3072
s_waitcnt lgkmcnt(0)
ds_read_b64_tr_b16 a[160:161],v34 offset:0
ds_read_b64_tr_b16 a[162:163],v34 offset:128
ds_read_b64_tr_b16 a[164:165],v34 offset:2048
ds_read_b64_tr_b16 a[166:167],v34 offset:2176
ds_read_b64_tr_b16 a[168:169],v34 offset:32
ds_read_b64_tr_b16 a[170:171],v34 offset:160
ds_read_b64_tr_b16 a[172:173],v34 offset:2080
ds_read_b64_tr_b16 a[174:175],v34 offset:2208
free_120:
ds_read_b64 v[38:39],v37 offset:8
s_sub_u32 s90,s90,1
s_waitcnt lgkmcnt(0)
v_and_b32 v38,v38,v39
v_cmp_eq_u32 vcc,0,v38
s_cmp_lt_i32 s90,0
s_cselect_b64 vcc,0,vcc
s_cbranch_vccnz free_120
s_xor_b32 s64,s61,4194304
buffer_store_dwordx4 v[100:103],v206,s[20:23],s64 offen sc1
buffer_store_dwordx4 v[100:103],v207,s[20:23],s64 offen sc1
s_xor_b32 s64,s61,6299648
buffer_store_dwordx4 v[100:103],v206,s[20:23],s64 offen sc1
buffer_store_dwordx4 v[100:103],v207,s[20:23],s64 offen sc1
s_xor_b32 s64,s61,8388608
buffer_store_dwordx4 v[100:103],v206,s[20:23],s64 offen sc1
buffer_store_dwordx4 v[100:103],v207,s[20:23],s64 offen sc1
s_mov_b32 m0,0
s_mov_b32 s65,188416
buffer_load_dwordx4 v16,s[20:23],s65 offen offset:0 lds
buffer_load_dwordx4 v16,s[20:23],s65 offen offset:1024 lds
buffer_load_dwordx4 v16,s[20:23],s65 offen offset:2048 lds
buffer_load_dwordx4 v16,s[20:23],s65 offen offset:3072 lds
s_mov_b32 m0,4096
s_mov_b32 s65,192512
buffer_load_dwordx4 v16,s[20:23],s65 offen offset:0 lds
buffer_load_dwordx4 v16,s[20:23],s65 offen offset:1024 lds
buffer_load_dwordx4 v16,s[20:23],s65 offen offset:2048 lds
buffer_load_dwordx4 v16,s[20:23],s65 offen offset:3072 lds
s_mov_b32 m0,8192
s_mov_b32 s65,196608
buffer_load_dwordx4 v16,s[20:23],s65 offen offset:0 lds
buffer_load_dwordx4 v16,s[20:23],s65 offen offset:1024 lds
buffer_load_dwordx4 v16,s[20:23],s65 offen offset:2048 lds
buffer_load_dwordx4 v16,s[20:23],s65 offen offset:3072 lds
s_mov_b32 m0,12288
s_mov_b32 s65,200704
buffer_load_dwordx4 v16,s[20:23],s65 offen offset:0 lds
buffer_load_dwordx4 v16,s[20:23],s65 offen offset:1024 lds
buffer_load_dwordx4 v16,s[20:23],s65 offen offset:2048 lds
buffer_load_dwordx4 v16,s[20:23],s65 offen offset:3072 lds
s_mov_b32 m0,16384
s_mov_b32 s65,204800
buffer_load_dwordx4 v16,s[20:23],s65 offen offset:0 lds
buffer_load_dwordx4 v16,s[20:23],s65 offen offset:1024 lds
buffer_load_dwordx4 v16,s[20:23],s65 offen offset:2048 lds
buffer_load_dwordx4 v16,s[20:23],s65 offen offset:3072 lds
s_mov_b32 m0,20480
s_mov_b32 s65,208896
buffer_load_dwordx4 v16,s[20:23],s65 offen offset:0 lds
buffer_load_dwordx4 v16,s[20:23],s65 offen offset:1024 lds
buffer_load_dwordx4 v16,s[20:23],s65 offen offset:2048 lds
buffer_load_dwordx4 v16,s[20:23],s65 offen offset:3072 lds
s_mov_b32 m0,24576
s_mov_b32 s65,212992
buffer_load_dwordx4 v16,s[20:23],s65 offen offset:0 lds
buffer_load_dwordx4 v16,s[20:23],s65 offen offset:1024 lds
buffer_load_dwordx4 v16,s[20:23],s65 offen offset:2048 lds
buffer_load_dwordx4 v16,s[20:23],s65 offen offset:3072 lds
s_mov_b32 m0,28672
s_mov_b32 s65,217088
buffer_load_dwordx4 v16,s[20:23],s65 offen offset:0 lds
buffer_load_dwordx4 v16,s[20:23],s65 offen offset:1024 lds
buffer_load_dwordx4 v16,s[20:23],s65 offen offset:2048 lds
buffer_load_dwordx4 v16,s[20:23],s65 offen offset:3072 lds
s_waitcnt vmcnt(54)
ds_write_b128 v33,a[176:179] offset:4096
ds_write_b128 v33,a[180:183] offset:5120
ds_write_b128 v33,a[184:187] offset:6144
ds_write_b128 v33,a[188:191] offset:7168
s_waitcnt lgkmcnt(0)
ds_read_b64_tr_b16 a[176:177],v34 offset:4096
ds_read_b64_tr_b16 a[178:179],v34 offset:4224
ds_read_b64_tr_b16 a[180:181],v34 offset:6144
ds_read_b64_tr_b16 a[182:183],v34 offset:6272
ds_read_b64_tr_b16 a[184:185],v34 offset:4128
ds_read_b64_tr_b16 a[186:187],v34 offset:4256
ds_read_b64_tr_b16 a[188:189],v34 offset:6176
ds_read_b64_tr_b16 a[190:191],v34 offset:6304
s_waitcnt vmcnt(50)
ds_write_b128 v33,a[192:195] offset:0
ds_write_b128 v33,a[196:199] offset:1024
ds_write_b128 v33,a[200:203] offset:2048
ds_write_b128 v33,a[204:207] offset:3072
s_waitcnt lgkmcnt(0)
ds_read_b64_tr_b16 a[192:193],v34 offset:0
ds_read_b64_tr_b16 a[194:195],v34 offset:128
ds_read_b64_tr_b16 a[196:197],v34 offset:2048
ds_read_b64_tr_b16 a[198:199],v34 offset:2176
ds_read_b64_tr_b16 a[200:201],v34 offset:32
ds_read_b64_tr_b16 a[202:203],v34 offset:160
ds_read_b64_tr_b16 a[204:205],v34 offset:2080
ds_read_b64_tr_b16 a[206:207],v34 offset:2208
s_waitcnt vmcnt(46)
ds_write_b128 v33,a[208:211] offset:4096
ds_write_b128 v33,a[212:215] offset:5120
ds_write_b128 v33,a[216:219] offset:6144
ds_write_b128 v33,a[220:223] offset:7168
s_waitcnt lgkmcnt(0)
ds_read_b64_tr_b16 a[208:209],v34 offset:4096
ds_read_b64_tr_b16 a[210:211],v34 offset:4224
ds_read_b64_tr_b16 a[212:213],v34 offset:6144
ds_read_b64_tr_b16 a[214:215],v34 offset:6272
ds_read_b64_tr_b16 a[216:217],v34 offset:4128
ds_read_b64_tr_b16 a[218:219],v34 offset:4256
ds_read_b64_tr_b16 a[220:221],v34 offset:6176
ds_read_b64_tr_b16 a[222:223],v34 offset:6304
s_waitcnt vmcnt(42)
ds_write_b128 v33,a[224:227] offset:0
ds_write_b128 v33,a[228:231] offset:1024
ds_write_b128 v33,a[232:235] offset:2048
ds_write_b128 v33,a[236:239] offset:3072
s_waitcnt lgkmcnt(0)
ds_read_b64_tr_b16 a[224:225],v34 offset:0
ds_read_b64_tr_b16 a[226:227],v34 offset:128
ds_read_b64_tr_b16 a[228:229],v34 offset:2048
ds_read_b64_tr_b16 a[230:231],v34 offset:2176
ds_read_b64_tr_b16 a[232:233],v34 offset:32
ds_read_b64_tr_b16 a[234:235],v34 offset:160
ds_read_b64_tr_b16 a[236:237],v34 offset:2080
ds_read_b64_tr_b16 a[238:239],v34 offset:2208
s_waitcnt vmcnt(38)
ds_write_b128 v33,a[240:243] offset:4096
ds_write_b128 v33,a[244:247] offset:5120
ds_write_b128 v33,a[248:251] offset:6144
ds_write_b128 v33,a[252:255] offset:7168
s_waitcnt lgkmcnt(0)
ds_read_b64_tr_b16 a[240:241],v34 offset:4096
ds_read_b64_tr_b16 a[242:243],v34 offset:4224
ds_read_b64_tr_b16 a[244:245],v34 offset:6144
ds_read_b64_tr_b16 a[246:247],v34 offset:6272
ds_read_b64_tr_b16 a[248:249],v34 offset:4128
ds_read_b64_tr_b16 a[250:251],v34 offset:4256
ds_read_b64_tr_b16 a[252:253],v34 offset:6176
ds_read_b64_tr_b16 a[254:255],v34 offset:6304
s_mov_b32 s79,0
s_add_u32 s63,s79,0
s_and_b32 s64,s63,3
s_lshl_b32 s70,s64,20
s_add_u32 s65,s63,2
s_and_b32 s65,s65,3
s_lshl_b32 s73,s65,20
s_add_u32 s55,s63,3
s_lshl_b32 s78,s55,16
s_add_u32 s78,s78,57344
s_cmp_lt_u32 s55,64
s_cselect_b32 s78,s78,0x7fff0000
s_add_u32 s71,s70,65536
s_add_u32 s60,s63,1
s_and_b32 s60,s60,3
s_lshl_b32 s72,s60,20
v_mov_b32 v184,0
v_mov_b32 v185,0
v_mov_b32 v186,0
v_mov_b32 v187,0
v_mov_b32 v188,0
v_mov_b32 v189,0
v_mov_b32 v190,0
v_mov_b32 v191,0
s_lshl_b32 s77,s63,21
s_lshl_b32 s55,s63,13
s_and_b32 s55,s55,0x2000
s_xor_b32 s55,s55,s61
s_add_u32 s77,s77,s55
v_mov_b32 v176,0
v_mov_b32 v177,0
v_mov_b32 v178,0
v_mov_b32 v179,0
v_mov_b32 v25,1
s_waitcnt vmcnt(0) lgkmcnt(0)
s_barrier
s_branch loop_63
w1_59:
s_lshr_b32 s64,s57,2
s_add_u32 s64,s64,64
s_lshl_b32 s64,s64,14
s_add_u32 s64,s64,s68
s_add_u32 s64,s64,29360128
v_add_u32 v12,s64,v16
v_and_b32 v22,1,v4
v_lshrrev_b32 v23,1,v4
v_lshl_add_u32 v22,v22,1,v23
v_lshlrev_b32 v22,2,v22
v_lshl_add_u32 v22,v3,4,v22
v_add_u32 v31,155648,v22
v_add_u32 v8,s66,v16
v_add_u32 v9,s67,v16
v_mov_b32 v10,1792
v_mov_b32 v11,0
s_branch first_121
loop_122:
s_barrier
buffer_load_dword v248,v18,s[20:23],s70 offen offset:0 sc1
s_nop 15
s_nop 5
hl_124:
buffer_load_dword v249,v18,s[20:23],s70 offen offset:0 sc1
s_waitcnt vmcnt(1)
v_cmp_eq_u32 vcc,v25,v248
s_bcnt1_i32_b32 s64,vcc_lo
s_cmp_ge_u32 s64,8
s_cbranch_scc1 hg_125
buffer_load_dword v248,v18,s[20:23],s70 offen offset:0 sc1
s_waitcnt vmcnt(1)
v_cmp_eq_u32 vcc,v25,v249
s_bcnt1_i32_b32 s64,vcc_lo
s_cmp_ge_u32 s64,8
s_cbranch_scc1 hg_125
s_sub_u32 s90,s90,1
s_cmp_gt_i32 s90,0
s_cbranch_scc1 hl_124
hg_125:
buffer_load_dwordx4 v[48:51],v27,s[20:23],s70 offen offset:0 sc1
buffer_load_dwordx4 v[52:55],v27,s[20:23],s70 offen offset:1024 sc1
buffer_load_dwordx4 v[56:59],v27,s[20:23],s70 offen offset:2048 sc1
buffer_load_dwordx4 v[60:63],v27,s[20:23],s70 offen offset:3072 sc1
s_waitcnt vmcnt(3)
ds_write_b128 v24,v[48:51] offset:4096
v_min3_u32 v22,v48,v49,v50
v_min_u32 v22,v22,v51
s_waitcnt vmcnt(2)
ds_write_b128 v24,v[52:55] offset:5120
v_min3_u32 v22,v22,v52,v53
v_min3_u32 v22,v22,v54,v55
s_waitcnt vmcnt(1)
ds_write_b128 v24,v[56:59] offset:6144
v_min3_u32 v22,v22,v56,v57
v_min3_u32 v22,v22,v58,v59
s_waitcnt vmcnt(0)
ds_write_b128 v24,v[60:63] offset:7168
v_min3_u32 v22,v22,v60,v61
v_min3_u32 v22,v22,v62,v63
v_cmp_eq_u32 vcc,0,v22
s_cbranch_vccnz art_126
abk_127:
v_smfmac_f32_16x16x64_bf16 v[176:179],v[48:51],a[32:39],v14
s_waitcnt lgkmcnt(0)
s_barrier
ds_read_b128 v[64:67],v24 offset:8192
ds_read_b128 v[68:71],v24 offset:9216
ds_read_b128 v[72:75],v24 offset:10240
ds_read_b128 v[76:79],v24 offset:11264
buffer_store_dwordx4 v[212:215],v12,s[20:23],s76 offen sc1
v_smfmac_f32_16x16x64_bf16 v[176:179],v[52:55],a[40:47],v14
ds_read_b128 v[80:83],v24 offset:12288
ds_read_b128 v[84:87],v24 offset:13312
v_smfmac_f32_16x16x64_bf16 v[176:179],v[56:59],a[48:55],v14
ds_read_b128 v[88:91],v24 offset:14336
ds_read_b128 v[92:95],v24 offset:15360
v_smfmac_f32_16x16x64_bf16 v[176:179],v[60:63],a[56:63],v14
ds_read_b128 v[32:35],v24 offset:0
ds_read_b128 v[36:39],v24 offset:1024
s_waitcnt lgkmcnt(9)
v_smfmac_f32_16x16x64_bf16 v[176:179],v[64:67],a[64:71],v14
ds_read_b128 v[40:43],v24 offset:2048
s_waitcnt lgkmcnt(9)
v_smfmac_f32_16x16x64_bf16 v[176:179],v[68:71],a[72:79],v14
ds_read_b128 v[44:47],v24 offset:3072
s_waitcnt lgkmcnt(9)
v_smfmac_f32_16x16x64_bf16 v[176:179],v[72:75],a[80:87],v14
s_waitcnt lgkmcnt(8)
v_smfmac_f32_16x16x64_bf16 v[176:179],v[76:79],a[88:95],v14
s_waitcnt lgkmcnt(7)
v_smfmac_f32_16x16x64_bf16 v[176:179],v[80:83],a[96:103],v14
s_waitcnt lgkmcnt(6)
v_smfmac_f32_16x16x64_bf16 v[176:179],v[84:87],a[104:111],v14
s_waitcnt lgkmcnt(5)
v_smfmac_f32_16x16x64_bf16 v[176:179],v[88:91],a[112:119],v14
s_waitcnt lgkmcnt(4)
v_smfmac_f32_16x16x64_bf16 v[176:179],v[92:95],a[120:127],v14
s_waitcnt lgkmcnt(3)
v_smfmac_f32_16x16x64_bf16 v[176:179],v[32:35],a[0:7],v14
s_waitcnt lgkmcnt(2)
v_smfmac_f32_16x16x64_bf16 v[176:179],v[36:39],a[8:15],v14
s_waitcnt lgkmcnt(1)
v_smfmac_f32_16x16x64_bf16 v[176:179],v[40:43],a[16:23],v14
s_waitcnt lgkmcnt(0)
v_smfmac_f32_16x16x64_bf16 v[176:179],v[44:47],a[24:31],v14
v_smfmac_f32_16x16x64_bf16 v[180:183],v[32:35],a[128:135],v14
v_smfmac_f32_16x16x64_bf16 v[180:183],v[36:39],a[136:143],v14
s_nop 5
v_permlane32_swap_b32 v176,v178
v_permlane32_swap_b32 v177,v179
v_add_f32 v176,v176,v178
v_add_f32 v177,v177,v179
v_cvt_pk_bf16_f32 v216,v176,v177
s_nop 1
v_mov_b32_dpp v217,v216 quad_perm:[1,0,3,2] row_mask:0xf bank_mask:0xf
v_perm_b32 v216,v217,v216,v15
v_max_u32 v216,1,v216
buffer_store_dword v216,v19,s[24:27],s70 offen
buffer_store_dword v216,v19,s[28:31],s70 offen sc1
v_smfmac_f32_16x16x64_bf16 v[180:183],v[40:43],a[144:151],v14
v_smfmac_f32_16x16x64_bf16 v[180:183],v[44:47],a[152:159],v14
v_smfmac_f32_16x16x64_bf16 v[180:183],v[48:51],a[160:167],v14
v_smfmac_f32_16x16x64_bf16 v[180:183],v[52:55],a[168:175],v14
v_smfmac_f32_16x16x64_bf16 v[180:183],v[56:59],a[176:183],v14
v_smfmac_f32_16x16x64_bf16 v[180:183],v[60:63],a[184:191],v14
v_smfmac_f32_16x16x64_bf16 v[180:183],v[64:67],a[192:199],v14
v_smfmac_f32_16x16x64_bf16 v[180:183],v[68:71],a[200:207],v14
v_smfmac_f32_16x16x64_bf16 v[180:183],v[72:75],a[208:215],v14
v_smfmac_f32_16x16x64_bf16 v[180:183],v[76:79],a[216:223],v14
v_smfmac_f32_16x16x64_bf16 v[180:183],v[80:83],a[224:231],v14
v_smfmac_f32_16x16x64_bf16 v[180:183],v[84:87],a[232:239],v14
v_smfmac_f32_16x16x64_bf16 v[180:183],v[88:91],a[240:247],v14
v_smfmac_f32_16x16x64_bf16 v[180:183],v[92:95],a[248:255],v14
s_nop 7
v_permlane32_swap_b32 v180,v182
v_permlane32_swap_b32 v181,v183
v_add_f32 v180,v180,v182
v_add_f32 v181,v181,v183
v_cvt_pk_bf16_f32 v216,v180,v181
v_max_u32 v216,1,v216
ds_write_b32 v31,v216
ds_write_b32 v21,v25 offset:0
s_cmp_eq_u32 s79,63
s_cbranch_scc1 end_57
s_cmp_ge_i32 s79,62
s_cbranch_scc1 bgsk_129
ds_read_b128 v[64:67],v20 offset:0
ds_read_b128 v[68:71],v20 offset:1024
ds_read_b128 v[72:75],v20 offset:2048
s_waitcnt lgkmcnt(2)
v_mfma_f32_16x16x32_bf16 v[192:195],a[0:3],v[64:67],0
ds_read_b128 v[76:79],v20 offset:3072
v_mfma_f32_16x16x32_bf16 v[200:203],v[64:67],a[128:131],0
s_waitcnt lgkmcnt(2)
v_mfma_f32_16x16x32_bf16 v[196:199],a[0:3],v[68:71],0
ds_read_b128 v[64:67],v20 offset:4096
v_mfma_f32_16x16x32_bf16 v[204:207],v[68:71],a[128:131],0
s_waitcnt lgkmcnt(2)
v_mfma_f32_16x16x32_bf16 v[192:195],a[4:7],v[72:75],v[192:195]
ds_read_b128 v[68:71],v20 offset:5120
v_mfma_f32_16x16x32_bf16 v[200:203],v[72:75],a[132:135],v[200:203]
s_waitcnt lgkmcnt(2)
v_mfma_f32_16x16x32_bf16 v[196:199],a[4:7],v[76:79],v[196:199]
ds_read_b128 v[72:75],v20 offset:6144
v_mfma_f32_16x16x32_bf16 v[204:207],v[76:79],a[132:135],v[204:207]
s_waitcnt lgkmcnt(2)
v_mfma_f32_16x16x32_bf16 v[192:195],a[8:11],v[64:67],v[192:195]
ds_read_b128 v[76:79],v20 offset:7168
v_mfma_f32_16x16x32_bf16 v[200:203],v[64:67],a[136:139],v[200:203]
s_waitcnt lgkmcnt(2)
v_mfma_f32_16x16x32_bf16 v[196:199],a[8:11],v[68:71],v[196:199]
ds_read_b128 v[64:67],v20 offset:8192
v_mfma_f32_16x16x32_bf16 v[204:207],v[68:71],a[136:139],v[204:207]
s_waitcnt lgkmcnt(2)
v_mfma_f32_16x16x32_bf16 v[192:195],a[12:15],v[72:75],v[192:195]
ds_read_b128 v[68:71],v20 offset:9216
v_mfma_f32_16x16x32_bf16 v[200:203],v[72:75],a[140:143],v[200:203]
s_waitcnt lgkmcnt(2)
v_mfma_f32_16x16x32_bf16 v[196:199],a[12:15],v[76:79],v[196:199]
ds_read_b128 v[72:75],v20 offset:10240
v_mfma_f32_16x16x32_bf16 v[204:207],v[76:79],a[140:143],v[204:207]
s_add_u32 m0,s62,0
s_add_u32 s69,s78,0
s_waitcnt lgkmcnt(2)
v_mfma_f32_16x16x32_bf16 v[192:195],a[16:19],v[64:67],v[192:195]
ds_read_b128 v[76:79],v20 offset:11264
v_mfma_f32_16x16x32_bf16 v[200:203],v[64:67],a[144:147],v[200:203]
buffer_load_dwordx4 v16,s[20:23],s69 offen offset:0 lds
s_waitcnt lgkmcnt(2)
v_mfma_f32_16x16x32_bf16 v[196:199],a[16:19],v[68:71],v[196:199]
ds_read_b128 v[64:67],v20 offset:12288
v_mfma_f32_16x16x32_bf16 v[204:207],v[68:71],a[144:147],v[204:207]
buffer_load_dwordx4 v16,s[20:23],s69 offen offset:1024 lds
s_waitcnt lgkmcnt(2)
v_mfma_f32_16x16x32_bf16 v[192:195],a[20:23],v[72:75],v[192:195]
ds_read_b128 v[68:71],v20 offset:13312
v_mfma_f32_16x16x32_bf16 v[200:203],v[72:75],a[148:151],v[200:203]
buffer_load_dwordx4 v16,s[20:23],s69 offen offset:2048 lds
s_waitcnt lgkmcnt(2)
v_mfma_f32_16x16x32_bf16 v[196:199],a[20:23],v[76:79],v[196:199]
ds_read_b128 v[72:75],v20 offset:14336
v_mfma_f32_16x16x32_bf16 v[204:207],v[76:79],a[148:151],v[204:207]
buffer_load_dwordx4 v16,s[20:23],s69 offen offset:3072 lds
s_waitcnt lgkmcnt(2)
v_mfma_f32_16x16x32_bf16 v[192:195],a[24:27],v[64:67],v[192:195]
ds_read_b128 v[76:79],v20 offset:15360
v_mfma_f32_16x16x32_bf16 v[200:203],v[64:67],a[152:155],v[200:203]
s_add_u32 m0,s62,4096
s_add_u32 s69,s78,4096
s_waitcnt lgkmcnt(2)
v_mfma_f32_16x16x32_bf16 v[196:199],a[24:27],v[68:71],v[196:199]
ds_read_b128 v[64:67],v20 offset:16384
v_mfma_f32_16x16x32_bf16 v[204:207],v[68:71],a[152:155],v[204:207]
buffer_load_dwordx4 v16,s[20:23],s69 offen offset:0 lds
s_waitcnt lgkmcnt(2)
v_mfma_f32_16x16x32_bf16 v[192:195],a[28:31],v[72:75],v[192:195]
ds_read_b128 v[68:71],v20 offset:17408
v_mfma_f32_16x16x32_bf16 v[200:203],v[72:75],a[156:159],v[200:203]
buffer_load_dwordx4 v16,s[20:23],s69 offen offset:1024 lds
s_waitcnt lgkmcnt(2)
v_mfma_f32_16x16x32_bf16 v[196:199],a[28:31],v[76:79],v[196:199]
ds_read_b128 v[72:75],v20 offset:18432
v_mfma_f32_16x16x32_bf16 v[204:207],v[76:79],a[156:159],v[204:207]
buffer_load_dwordx4 v16,s[20:23],s69 offen offset:2048 lds
s_waitcnt lgkmcnt(2)
v_mfma_f32_16x16x32_bf16 v[192:195],a[32:35],v[64:67],v[192:195]
ds_read_b128 v[76:79],v20 offset:19456
v_mfma_f32_16x16x32_bf16 v[200:203],v[64:67],a[160:163],v[200:203]
buffer_load_dwordx4 v16,s[20:23],s69 offen offset:3072 lds
s_waitcnt lgkmcnt(2)
v_mfma_f32_16x16x32_bf16 v[196:199],a[32:35],v[68:71],v[196:199]
ds_read_b128 v[64:67],v20 offset:20480
v_mfma_f32_16x16x32_bf16 v[204:207],v[68:71],a[160:163],v[204:207]
s_add_u32 m0,s62,8192
s_add_u32 s69,s78,8192
s_waitcnt lgkmcnt(2)
v_mfma_f32_16x16x32_bf16 v[192:195],a[36:39],v[72:75],v[192:195]
ds_read_b128 v[68:71],v20 offset:21504
v_mfma_f32_16x16x32_bf16 v[200:203],v[72:75],a[164:167],v[200:203]
buffer_load_dwordx4 v16,s[20:23],s69 offen offset:0 lds
s_waitcnt lgkmcnt(2)
v_mfma_f32_16x16x32_bf16 v[196:199],a[36:39],v[76:79],v[196:199]
ds_read_b128 v[72:75],v20 offset:22528
v_mfma_f32_16x16x32_bf16 v[204:207],v[76:79],a[164:167],v[204:207]
buffer_load_dwordx4 v16,s[20:23],s69 offen offset:1024 lds
s_waitcnt lgkmcnt(2)
v_mfma_f32_16x16x32_bf16 v[192:195],a[40:43],v[64:67],v[192:195]
ds_read_b128 v[76:79],v20 offset:23552
v_mfma_f32_16x16x32_bf16 v[200:203],v[64:67],a[168:171],v[200:203]
buffer_load_dwordx4 v16,s[20:23],s69 offen offset:2048 lds
s_waitcnt lgkmcnt(2)
v_mfma_f32_16x16x32_bf16 v[196:199],a[40:43],v[68:71],v[196:199]
ds_read_b128 v[64:67],v20 offset:24576
v_mfma_f32_16x16x32_bf16 v[204:207],v[68:71],a[168:171],v[204:207]
buffer_load_dwordx4 v16,s[20:23],s69 offen offset:3072 lds
s_waitcnt lgkmcnt(2)
v_mfma_f32_16x16x32_bf16 v[192:195],a[44:47],v[72:75],v[192:195]
ds_read_b128 v[68:71],v20 offset:25600
v_mfma_f32_16x16x32_bf16 v[200:203],v[72:75],a[172:175],v[200:203]
s_add_u32 m0,s62,12288
s_add_u32 s69,s78,12288
s_waitcnt lgkmcnt(2)
v_mfma_f32_16x16x32_bf16 v[196:199],a[44:47],v[76:79],v[196:199]
ds_read_b128 v[72:75],v20 offset:26624
v_mfma_f32_16x16x32_bf16 v[204:207],v[76:79],a[172:175],v[204:207]
buffer_load_dwordx4 v16,s[20:23],s69 offen offset:0 lds
s_waitcnt lgkmcnt(2)
v_mfma_f32_16x16x32_bf16 v[192:195],a[48:51],v[64:67],v[192:195]
ds_read_b128 v[76:79],v20 offset:27648
v_mfma_f32_16x16x32_bf16 v[200:203],v[64:67],a[176:179],v[200:203]
buffer_load_dwordx4 v16,s[20:23],s69 offen offset:1024 lds
s_waitcnt lgkmcnt(2)
v_mfma_f32_16x16x32_bf16 v[196:199],a[48:51],v[68:71],v[196:199]
ds_read_b128 v[64:67],v20 offset:28672
v_mfma_f32_16x16x32_bf16 v[204:207],v[68:71],a[176:179],v[204:207]
buffer_load_dwordx4 v16,s[20:23],s69 offen offset:2048 lds
s_waitcnt lgkmcnt(2)
v_mfma_f32_16x16x32_bf16 v[192:195],a[52:55],v[72:75],v[192:195]
ds_read_b128 v[68:71],v20 offset:29696
v_mfma_f32_16x16x32_bf16 v[200:203],v[72:75],a[180:183],v[200:203]
buffer_load_dwordx4 v16,s[20:23],s69 offen offset:3072 lds
s_waitcnt lgkmcnt(2)
v_mfma_f32_16x16x32_bf16 v[196:199],a[52:55],v[76:79],v[196:199]
ds_read_b128 v[72:75],v20 offset:30720
v_mfma_f32_16x16x32_bf16 v[204:207],v[76:79],a[180:183],v[204:207]
s_waitcnt lgkmcnt(2)
v_mfma_f32_16x16x32_bf16 v[192:195],a[56:59],v[64:67],v[192:195]
ds_read_b128 v[76:79],v20 offset:31744
v_mfma_f32_16x16x32_bf16 v[200:203],v[64:67],a[184:187],v[200:203]
s_waitcnt lgkmcnt(2)
v_mfma_f32_16x16x32_bf16 v[196:199],a[56:59],v[68:71],v[196:199]
ds_read_b128 v[64:67],v20 offset:32768
v_mfma_f32_16x16x32_bf16 v[204:207],v[68:71],a[184:187],v[204:207]
s_waitcnt lgkmcnt(2)
v_mfma_f32_16x16x32_bf16 v[192:195],a[60:63],v[72:75],v[192:195]
ds_read_b128 v[68:71],v20 offset:33792
v_mfma_f32_16x16x32_bf16 v[200:203],v[72:75],a[188:191],v[200:203]
s_waitcnt lgkmcnt(2)
v_mfma_f32_16x16x32_bf16 v[196:199],a[60:63],v[76:79],v[196:199]
ds_read_b128 v[72:75],v20 offset:34816
v_mfma_f32_16x16x32_bf16 v[204:207],v[76:79],a[188:191],v[204:207]
s_waitcnt lgkmcnt(2)
v_mfma_f32_16x16x32_bf16 v[192:195],a[64:67],v[64:67],v[192:195]
ds_read_b128 v[76:79],v20 offset:35840
v_mfma_f32_16x16x32_bf16 v[200:203],v[64:67],a[192:195],v[200:203]
s_waitcnt lgkmcnt(2)
v_mfma_f32_16x16x32_bf16 v[196:199],a[64:67],v[68:71],v[196:199]
ds_read_b128 v[64:67],v20 offset:36864
v_mfma_f32_16x16x32_bf16 v[204:207],v[68:71],a[192:195],v[204:207]
s_waitcnt lgkmcnt(2)
v_mfma_f32_16x16x32_bf16 v[192:195],a[68:71],v[72:75],v[192:195]
ds_read_b128 v[68:71],v20 offset:37888
v_mfma_f32_16x16x32_bf16 v[200:203],v[72:75],a[196:199],v[200:203]
s_waitcnt lgkmcnt(2)
v_mfma_f32_16x16x32_bf16 v[196:199],a[68:71],v[76:79],v[196:199]
ds_read_b128 v[72:75],v20 offset:38912
v_mfma_f32_16x16x32_bf16 v[204:207],v[76:79],a[196:199],v[204:207]
s_waitcnt lgkmcnt(2)
v_mfma_f32_16x16x32_bf16 v[192:195],a[72:75],v[64:67],v[192:195]
ds_read_b128 v[76:79],v20 offset:39936
v_mfma_f32_16x16x32_bf16 v[200:203],v[64:67],a[200:203],v[200:203]
s_waitcnt lgkmcnt(2)
v_mfma_f32_16x16x32_bf16 v[196:199],a[72:75],v[68:71],v[196:199]
ds_read_b128 v[64:67],v20 offset:40960
v_mfma_f32_16x16x32_bf16 v[204:207],v[68:71],a[200:203],v[204:207]
s_waitcnt lgkmcnt(2)
v_mfma_f32_16x16x32_bf16 v[192:195],a[76:79],v[72:75],v[192:195]
ds_read_b128 v[68:71],v20 offset:41984
v_mfma_f32_16x16x32_bf16 v[200:203],v[72:75],a[204:207],v[200:203]
s_waitcnt lgkmcnt(2)
v_mfma_f32_16x16x32_bf16 v[196:199],a[76:79],v[76:79],v[196:199]
ds_read_b128 v[72:75],v20 offset:43008
v_mfma_f32_16x16x32_bf16 v[204:207],v[76:79],a[204:207],v[204:207]
s_waitcnt lgkmcnt(2)
v_mfma_f32_16x16x32_bf16 v[192:195],a[80:83],v[64:67],v[192:195]
ds_read_b128 v[76:79],v20 offset:44032
v_mfma_f32_16x16x32_bf16 v[200:203],v[64:67],a[208:211],v[200:203]
s_waitcnt lgkmcnt(2)
v_mfma_f32_16x16x32_bf16 v[196:199],a[80:83],v[68:71],v[196:199]
ds_read_b128 v[64:67],v20 offset:45056
v_mfma_f32_16x16x32_bf16 v[204:207],v[68:71],a[208:211],v[204:207]
s_waitcnt lgkmcnt(2)
v_mfma_f32_16x16x32_bf16 v[192:195],a[84:87],v[72:75],v[192:195]
ds_read_b128 v[68:71],v20 offset:46080
v_mfma_f32_16x16x32_bf16 v[200:203],v[72:75],a[212:215],v[200:203]
s_waitcnt lgkmcnt(2)
v_mfma_f32_16x16x32_bf16 v[196:199],a[84:87],v[76:79],v[196:199]
ds_read_b128 v[72:75],v20 offset:47104
v_mfma_f32_16x16x32_bf16 v[204:207],v[76:79],a[212:215],v[204:207]
s_waitcnt lgkmcnt(2)
v_mfma_f32_16x16x32_bf16 v[192:195],a[88:91],v[64:67],v[192:195]
ds_read_b128 v[76:79],v20 offset:48128
v_mfma_f32_16x16x32_bf16 v[200:203],v[64:67],a[216:219],v[200:203]
s_waitcnt lgkmcnt(2)
v_mfma_f32_16x16x32_bf16 v[196:199],a[88:91],v[68:71],v[196:199]
ds_read_b128 v[64:67],v20 offset:49152
v_mfma_f32_16x16x32_bf16 v[204:207],v[68:71],a[216:219],v[204:207]
s_waitcnt lgkmcnt(2)
v_mfma_f32_16x16x32_bf16 v[192:195],a[92:95],v[72:75],v[192:195]
ds_read_b128 v[68:71],v20 offset:50176
v_mfma_f32_16x16x32_bf16 v[200:203],v[72:75],a[220:223],v[200:203]
s_waitcnt lgkmcnt(2)
v_mfma_f32_16x16x32_bf16 v[196:199],a[92:95],v[76:79],v[196:199]
ds_read_b128 v[72:75],v20 offset:51200
v_mfma_f32_16x16x32_bf16 v[204:207],v[76:79],a[220:223],v[204:207]
s_waitcnt lgkmcnt(2)
v_mfma_f32_16x16x32_bf16 v[192:195],a[96:99],v[64:67],v[192:195]
ds_read_b128 v[76:79],v20 offset:52224
v_mfma_f32_16x16x32_bf16 v[200:203],v[64:67],a[224:227],v[200:203]
s_waitcnt lgkmcnt(2)
v_mfma_f32_16x16x32_bf16 v[196:199],a[96:99],v[68:71],v[196:199]
ds_read_b128 v[64:67],v20 offset:53248
v_mfma_f32_16x16x32_bf16 v[204:207],v[68:71],a[224:227],v[204:207]
s_waitcnt lgkmcnt(2)
v_mfma_f32_16x16x32_bf16 v[192:195],a[100:103],v[72:75],v[192:195]
ds_read_b128 v[68:71],v20 offset:54272
s_add_u32 m0,s62,32768
s_add_u32 s69,s78,32768
v_mfma_f32_16x16x32_bf16 v[200:203],v[72:75],a[228:231],v[200:203]
s_waitcnt lgkmcnt(2)
v_mfma_f32_16x16x32_bf16 v[196:199],a[100:103],v[76:79],v[196:199]
ds_read_b128 v[72:75],v20 offset:55296
buffer_load_dwordx4 v16,s[20:23],s69 offen offset:0 lds
v_mfma_f32_16x16x32_bf16 v[204:207],v[76:79],a[228:231],v[204:207]
s_waitcnt lgkmcnt(2)
v_mfma_f32_16x16x32_bf16 v[192:195],a[104:107],v[64:67],v[192:195]
ds_read_b128 v[76:79],v20 offset:56320
buffer_load_dwordx4 v16,s[20:23],s69 offen offset:1024 lds
v_mfma_f32_16x16x32_bf16 v[200:203],v[64:67],a[232:235],v[200:203]
s_waitcnt lgkmcnt(2)
v_mfma_f32_16x16x32_bf16 v[196:199],a[104:107],v[68:71],v[196:199]
ds_read_b128 v[64:67],v20 offset:57344
buffer_load_dwordx4 v16,s[20:23],s69 offen offset:2048 lds
v_mfma_f32_16x16x32_bf16 v[204:207],v[68:71],a[232:235],v[204:207]
s_waitcnt lgkmcnt(2)
v_mfma_f32_16x16x32_bf16 v[192:195],a[108:111],v[72:75],v[192:195]
ds_read_b128 v[68:71],v20 offset:58368
buffer_load_dwordx4 v16,s[20:23],s69 offen offset:3072 lds
v_mfma_f32_16x16x32_bf16 v[200:203],v[72:75],a[236:239],v[200:203]
s_waitcnt lgkmcnt(2)
v_mfma_f32_16x16x32_bf16 v[196:199],a[108:111],v[76:79],v[196:199]
ds_read_b128 v[72:75],v20 offset:59392
s_add_u32 m0,s62,36864
s_add_u32 s69,s78,36864
v_mfma_f32_16x16x32_bf16 v[204:207],v[76:79],a[236:239],v[204:207]
s_waitcnt lgkmcnt(2)
v_mfma_f32_16x16x32_bf16 v[192:195],a[112:115],v[64:67],v[192:195]
ds_read_b128 v[76:79],v20 offset:60416
buffer_load_dwordx4 v16,s[20:23],s69 offen offset:0 lds
v_mfma_f32_16x16x32_bf16 v[200:203],v[64:67],a[240:243],v[200:203]
s_waitcnt lgkmcnt(2)
v_mfma_f32_16x16x32_bf16 v[196:199],a[112:115],v[68:71],v[196:199]
ds_read_b128 v[64:67],v20 offset:61440
v_mfma_f32_16x16x32_bf16 v[204:207],v[68:71],a[240:243],v[204:207]
buffer_load_dwordx4 v16,s[20:23],s69 offen offset:1024 lds
s_waitcnt lgkmcnt(2)
v_mfma_f32_16x16x32_bf16 v[192:195],a[116:119],v[72:75],v[192:195]
ds_read_b128 v[68:71],v20 offset:62464
v_mfma_f32_16x16x32_bf16 v[200:203],v[72:75],a[244:247],v[200:203]
buffer_load_dwordx4 v16,s[20:23],s69 offen offset:2048 lds
s_waitcnt lgkmcnt(2)
v_mfma_f32_16x16x32_bf16 v[196:199],a[116:119],v[76:79],v[196:199]
ds_read_b128 v[72:75],v20 offset:63488
v_mfma_f32_16x16x32_bf16 v[204:207],v[76:79],a[244:247],v[204:207]
buffer_load_dwordx4 v16,s[20:23],s69 offen offset:3072 lds
s_waitcnt lgkmcnt(2)
v_mfma_f32_16x16x32_bf16 v[192:195],a[120:123],v[64:67],v[192:195]
ds_read_b128 v[76:79],v20 offset:64512
v_mfma_f32_16x16x32_bf16 v[200:203],v[64:67],a[248:251],v[200:203]
s_add_u32 m0,s62,40960
s_add_u32 s69,s78,40960
s_waitcnt lgkmcnt(2)
v_mfma_f32_16x16x32_bf16 v[196:199],a[120:123],v[68:71],v[196:199]
v_mfma_f32_16x16x32_bf16 v[204:207],v[68:71],a[248:251],v[204:207]
buffer_load_dwordx4 v16,s[20:23],s69 offen offset:0 lds
s_waitcnt lgkmcnt(1)
v_mfma_f32_16x16x32_bf16 v[192:195],a[124:127],v[72:75],v[192:195]
v_mfma_f32_16x16x32_bf16 v[200:203],v[72:75],a[252:255],v[200:203]
buffer_load_dwordx4 v16,s[20:23],s69 offen offset:1024 lds
s_waitcnt lgkmcnt(0)
v_mfma_f32_16x16x32_bf16 v[196:199],a[124:127],v[76:79],v[196:199]
v_mfma_f32_16x16x32_bf16 v[204:207],v[76:79],a[252:255],v[204:207]
s_waitcnt vmcnt(26)
ds_write_b32 v21,v25 offset:24
v_xor_b32 v20,0x10000,v20
s_xor_b32 s62,s62,0x10000
s_lshr_b32 s64,s73,9
v_add_u32 v22,s64,v24
v_cvt_pk_bf16_f32 v208,v192,v193
v_cvt_pk_bf16_f32 v209,v194,v195
v_cvt_pk_bf16_f32 v210,v196,v197
v_cvt_pk_bf16_f32 v211,v198,v199
v_cvt_pk_bf16_f32 v212,v200,v201
v_cvt_pk_bf16_f32 v213,v202,v203
v_cvt_pk_bf16_f32 v214,v204,v205
v_cvt_pk_bf16_f32 v215,v206,v207
v_permlane16_swap_b32 v208,v210
v_permlane16_swap_b32 v209,v211
buffer_store_dwordx4 v[208:211],v2,s[24:27],s73 offen
buffer_store_dwordx4 v[208:211],v2,s[28:31],s73 offen sc1
ds_write_b128 v22,v[212:215] offset:16384
buffer_store_dwordx4 v[208:211],v17,s[20:23],s12 offen sc1
bgx_128:
buffer_store_dwordx4 v[100:103],v9,s[24:27],s73 offen
buffer_store_dwordx4 v[100:103],v9,s[28:31],s73 offen sc1
s_mov_b32 exec_hi,0
buffer_store_dwordx4 v[100:103],v8,s[24:27],s73 offen
buffer_store_dwordx4 v[100:103],v8,s[24:27],s71 offen
buffer_store_dwordx4 v[100:103],v8,s[28:31],s73 offen sc1
buffer_store_dwordx4 v[100:103],v8,s[28:31],s71 offen sc1
s_mov_b64 exec,-1
s_waitcnt lgkmcnt(0)
s_add_u32 s63,s79,1
s_and_b32 s64,s63,3
s_lshl_b32 s70,s64,20
s_add_u32 s65,s63,2
s_and_b32 s65,s65,3
s_lshl_b32 s73,s65,20
s_add_u32 s55,s63,3
s_lshl_b32 s78,s55,16
s_add_u32 s78,s78,57344
s_cmp_lt_u32 s55,64
s_cselect_b32 s78,s78,0x7fff0000
s_add_u32 s60,s63,1
s_lshl_b32 s76,s60,21
s_lshl_b32 s55,s60,13
s_and_b32 s55,s55,0x2000
s_xor_b32 s55,s55,s61
s_add_u32 s76,s76,s55
s_cmp_lt_u32 s60,64
s_cselect_b32 s76,s76,0x7fff0000
s_add_u32 s60,s63,2
s_lshl_b32 s12,s60,21
s_lshl_b32 s55,s60,13
s_and_b32 s55,s55,0x2000
s_xor_b32 s55,s55,s61
s_add_u32 s12,s12,s55
s_cmp_lt_u32 s60,64
s_cselect_b32 s12,s12,0x7fff0000
s_add_u32 s71,s73,65536
v_mov_b32 v176,0
v_mov_b32 v177,0
v_mov_b32 v178,0
v_mov_b32 v179,0
v_mov_b32 v180,0
v_mov_b32 v181,0
v_mov_b32 v182,0
v_mov_b32 v183,0
s_add_u32 s79,s79,1
v_add_u32 v25,1,v25
s_waitcnt vmcnt(0)
s_branch loop_122
art_126:
s_sub_u32 s90,s90,1
s_cmp_lt_i32 s90,0
s_cbranch_scc1 abk_127
buffer_load_dwordx4 v[48:51],v27,s[20:23],s70 offen offset:0 sc1
buffer_load_dwordx4 v[52:55],v27,s[20:23],s70 offen offset:1024 sc1
buffer_load_dwordx4 v[56:59],v27,s[20:23],s70 offen offset:2048 sc1
buffer_load_dwordx4 v[60:63],v27,s[20:23],s70 offen offset:3072 sc1
s_waitcnt vmcnt(3)
ds_write_b128 v24,v[48:51] offset:4096
v_min3_u32 v22,v48,v49,v50
v_min_u32 v22,v22,v51
s_waitcnt vmcnt(2)
ds_write_b128 v24,v[52:55] offset:5120
v_min3_u32 v22,v22,v52,v53
v_min3_u32 v22,v22,v54,v55
s_waitcnt vmcnt(1)
ds_write_b128 v24,v[56:59] offset:6144
v_min3_u32 v22,v22,v56,v57
v_min3_u32 v22,v22,v58,v59
s_waitcnt vmcnt(0)
ds_write_b128 v24,v[60:63] offset:7168
v_min3_u32 v22,v22,v60,v61
v_min3_u32 v22,v22,v62,v63
v_cmp_eq_u32 vcc,0,v22
s_cbranch_vccnz art_126
s_branch abk_127
bgsk_129:
s_waitcnt vmcnt(0)
ds_write_b32 v21,v25 offset:24
s_branch bgx_128
first_121:
s_add_u32 s63,s79,0
s_and_b32 s64,s63,3
s_lshl_b32 s70,s64,20
s_add_u32 s65,s63,2
s_and_b32 s65,s65,3
s_lshl_b32 s73,s65,20
s_add_u32 s55,s63,3
s_lshl_b32 s78,s55,16
s_add_u32 s78,s78,57344
s_cmp_lt_u32 s55,64
s_cselect_b32 s78,s78,0x7fff0000
s_add_u32 s60,s63,1
s_lshl_b32 s76,s60,21
s_lshl_b32 s55,s60,13
s_and_b32 s55,s55,0x2000
s_xor_b32 s55,s55,s61
s_add_u32 s76,s76,s55
s_cmp_lt_u32 s60,64
s_cselect_b32 s76,s76,0x7fff0000
s_add_u32 s60,s63,2
s_lshl_b32 s12,s60,21
s_lshl_b32 s55,s60,13
s_and_b32 s55,s55,0x2000
s_xor_b32 s55,s55,s61
s_add_u32 s12,s12,s55
s_cmp_lt_u32 s60,64
s_cselect_b32 s12,s12,0x7fff0000
s_add_u32 s71,s73,65536
v_mov_b32 v176,0
v_mov_b32 v177,0
v_mov_b32 v178,0
v_mov_b32 v179,0
v_mov_b32 v180,0
v_mov_b32 v181,0
v_mov_b32 v182,0
v_mov_b32 v183,0
s_waitcnt vmcnt(0) lgkmcnt(0)
s_barrier
pn1_130:
ds_read_b128 v[64:67],v20 offset:0
ds_read_b128 v[68:71],v20 offset:1024
ds_read_b128 v[72:75],v20 offset:2048
s_waitcnt lgkmcnt(2)
v_mfma_f32_16x16x32_bf16 v[192:195],a[0:3],v[64:67],0
ds_read_b128 v[76:79],v20 offset:3072
v_mfma_f32_16x16x32_bf16 v[200:203],v[64:67],a[128:131],0
s_waitcnt lgkmcnt(2)
v_mfma_f32_16x16x32_bf16 v[196:199],a[0:3],v[68:71],0
ds_read_b128 v[64:67],v20 offset:4096
v_mfma_f32_16x16x32_bf16 v[204:207],v[68:71],a[128:131],0
s_waitcnt lgkmcnt(2)
v_mfma_f32_16x16x32_bf16 v[192:195],a[4:7],v[72:75],v[192:195]
ds_read_b128 v[68:71],v20 offset:5120
v_mfma_f32_16x16x32_bf16 v[200:203],v[72:75],a[132:135],v[200:203]
s_waitcnt lgkmcnt(2)
v_mfma_f32_16x16x32_bf16 v[196:199],a[4:7],v[76:79],v[196:199]
ds_read_b128 v[72:75],v20 offset:6144
v_mfma_f32_16x16x32_bf16 v[204:207],v[76:79],a[132:135],v[204:207]
s_waitcnt lgkmcnt(2)
v_mfma_f32_16x16x32_bf16 v[192:195],a[8:11],v[64:67],v[192:195]
ds_read_b128 v[76:79],v20 offset:7168
v_mfma_f32_16x16x32_bf16 v[200:203],v[64:67],a[136:139],v[200:203]
s_waitcnt lgkmcnt(2)
v_mfma_f32_16x16x32_bf16 v[196:199],a[8:11],v[68:71],v[196:199]
ds_read_b128 v[64:67],v20 offset:8192
v_mfma_f32_16x16x32_bf16 v[204:207],v[68:71],a[136:139],v[204:207]
s_waitcnt lgkmcnt(2)
v_mfma_f32_16x16x32_bf16 v[192:195],a[12:15],v[72:75],v[192:195]
ds_read_b128 v[68:71],v20 offset:9216
v_mfma_f32_16x16x32_bf16 v[200:203],v[72:75],a[140:143],v[200:203]
s_waitcnt lgkmcnt(2)
v_mfma_f32_16x16x32_bf16 v[196:199],a[12:15],v[76:79],v[196:199]
ds_read_b128 v[72:75],v20 offset:10240
v_mfma_f32_16x16x32_bf16 v[204:207],v[76:79],a[140:143],v[204:207]
s_waitcnt lgkmcnt(2)
v_mfma_f32_16x16x32_bf16 v[192:195],a[16:19],v[64:67],v[192:195]
ds_read_b128 v[76:79],v20 offset:11264
v_mfma_f32_16x16x32_bf16 v[200:203],v[64:67],a[144:147],v[200:203]
s_waitcnt lgkmcnt(2)
v_mfma_f32_16x16x32_bf16 v[196:199],a[16:19],v[68:71],v[196:199]
ds_read_b128 v[64:67],v20 offset:12288
v_mfma_f32_16x16x32_bf16 v[204:207],v[68:71],a[144:147],v[204:207]
s_waitcnt lgkmcnt(2)
v_mfma_f32_16x16x32_bf16 v[192:195],a[20:23],v[72:75],v[192:195]
ds_read_b128 v[68:71],v20 offset:13312
v_mfma_f32_16x16x32_bf16 v[200:203],v[72:75],a[148:151],v[200:203]
s_waitcnt lgkmcnt(2)
v_mfma_f32_16x16x32_bf16 v[196:199],a[20:23],v[76:79],v[196:199]
ds_read_b128 v[72:75],v20 offset:14336
v_mfma_f32_16x16x32_bf16 v[204:207],v[76:79],a[148:151],v[204:207]
s_waitcnt lgkmcnt(2)
v_mfma_f32_16x16x32_bf16 v[192:195],a[24:27],v[64:67],v[192:195]
ds_read_b128 v[76:79],v20 offset:15360
v_mfma_f32_16x16x32_bf16 v[200:203],v[64:67],a[152:155],v[200:203]
s_waitcnt lgkmcnt(2)
v_mfma_f32_16x16x32_bf16 v[196:199],a[24:27],v[68:71],v[196:199]
ds_read_b128 v[64:67],v20 offset:16384
v_mfma_f32_16x16x32_bf16 v[204:207],v[68:71],a[152:155],v[204:207]
s_waitcnt lgkmcnt(2)
v_mfma_f32_16x16x32_bf16 v[192:195],a[28:31],v[72:75],v[192:195]
ds_read_b128 v[68:71],v20 offset:17408
v_mfma_f32_16x16x32_bf16 v[200:203],v[72:75],a[156:159],v[200:203]
s_waitcnt lgkmcnt(2)
v_mfma_f32_16x16x32_bf16 v[196:199],a[28:31],v[76:79],v[196:199]
ds_read_b128 v[72:75],v20 offset:18432
v_mfma_f32_16x16x32_bf16 v[204:207],v[76:79],a[156:159],v[204:207]
s_waitcnt lgkmcnt(2)
v_mfma_f32_16x16x32_bf16 v[192:195],a[32:35],v[64:67],v[192:195]
ds_read_b128 v[76:79],v20 offset:19456
v_mfma_f32_16x16x32_bf16 v[200:203],v[64:67],a[160:163],v[200:203]
s_waitcnt lgkmcnt(2)
v_mfma_f32_16x16x32_bf16 v[196:199],a[32:35],v[68:71],v[196:199]
ds_read_b128 v[64:67],v20 offset:20480
v_mfma_f32_16x16x32_bf16 v[204:207],v[68:71],a[160:163],v[204:207]
s_waitcnt lgkmcnt(2)
v_mfma_f32_16x16x32_bf16 v[192:195],a[36:39],v[72:75],v[192:195]
ds_read_b128 v[68:71],v20 offset:21504
v_mfma_f32_16x16x32_bf16 v[200:203],v[72:75],a[164:167],v[200:203]
s_waitcnt lgkmcnt(2)
v_mfma_f32_16x16x32_bf16 v[196:199],a[36:39],v[76:79],v[196:199]
ds_read_b128 v[72:75],v20 offset:22528
v_mfma_f32_16x16x32_bf16 v[204:207],v[76:79],a[164:167],v[204:207]
s_waitcnt lgkmcnt(2)
v_mfma_f32_16x16x32_bf16 v[192:195],a[40:43],v[64:67],v[192:195]
ds_read_b128 v[76:79],v20 offset:23552
v_mfma_f32_16x16x32_bf16 v[200:203],v[64:67],a[168:171],v[200:203]
s_waitcnt lgkmcnt(2)
v_mfma_f32_16x16x32_bf16 v[196:199],a[40:43],v[68:71],v[196:199]
ds_read_b128 v[64:67],v20 offset:24576
v_mfma_f32_16x16x32_bf16 v[204:207],v[68:71],a[168:171],v[204:207]
s_waitcnt lgkmcnt(2)
v_mfma_f32_16x16x32_bf16 v[192:195],a[44:47],v[72:75],v[192:195]
ds_read_b128 v[68:71],v20 offset:25600
v_mfma_f32_16x16x32_bf16 v[200:203],v[72:75],a[172:175],v[200:203]
s_waitcnt lgkmcnt(2)
v_mfma_f32_16x16x32_bf16 v[196:199],a[44:47],v[76:79],v[196:199]
ds_read_b128 v[72:75],v20 offset:26624
v_mfma_f32_16x16x32_bf16 v[204:207],v[76:79],a[172:175],v[204:207]
s_waitcnt lgkmcnt(2)
v_mfma_f32_16x16x32_bf16 v[192:195],a[48:51],v[64:67],v[192:195]
ds_read_b128 v[76:79],v20 offset:27648
v_mfma_f32_16x16x32_bf16 v[200:203],v[64:67],a[176:179],v[200:203]
s_waitcnt lgkmcnt(2)
v_mfma_f32_16x16x32_bf16 v[196:199],a[48:51],v[68:71],v[196:199]
ds_read_b128 v[64:67],v20 offset:28672
v_mfma_f32_16x16x32_bf16 v[204:207],v[68:71],a[176:179],v[204:207]
s_waitcnt lgkmcnt(2)
v_mfma_f32_16x16x32_bf16 v[192:195],a[52:55],v[72:75],v[192:195]
ds_read_b128 v[68:71],v20 offset:29696
v_mfma_f32_16x16x32_bf16 v[200:203],v[72:75],a[180:183],v[200:203]
s_waitcnt lgkmcnt(2)
v_mfma_f32_16x16x32_bf16 v[196:199],a[52:55],v[76:79],v[196:199]
ds_read_b128 v[72:75],v20 offset:30720
v_mfma_f32_16x16x32_bf16 v[204:207],v[76:79],a[180:183],v[204:207]
s_waitcnt lgkmcnt(2)
v_mfma_f32_16x16x32_bf16 v[192:195],a[56:59],v[64:67],v[192:195]
ds_read_b128 v[76:79],v20 offset:31744
v_mfma_f32_16x16x32_bf16 v[200:203],v[64:67],a[184:187],v[200:203]
s_waitcnt lgkmcnt(2)
v_mfma_f32_16x16x32_bf16 v[196:199],a[56:59],v[68:71],v[196:199]
ds_read_b128 v[64:67],v20 offset:32768
v_mfma_f32_16x16x32_bf16 v[204:207],v[68:71],a[184:187],v[204:207]
s_waitcnt lgkmcnt(2)
v_mfma_f32_16x16x32_bf16 v[192:195],a[60:63],v[72:75],v[192:195]
ds_read_b128 v[68:71],v20 offset:33792
v_mfma_f32_16x16x32_bf16 v[200:203],v[72:75],a[188:191],v[200:203]
s_waitcnt lgkmcnt(2)
v_mfma_f32_16x16x32_bf16 v[196:199],a[60:63],v[76:79],v[196:199]
ds_read_b128 v[72:75],v20 offset:34816
v_mfma_f32_16x16x32_bf16 v[204:207],v[76:79],a[188:191],v[204:207]
s_waitcnt lgkmcnt(2)
v_mfma_f32_16x16x32_bf16 v[192:195],a[64:67],v[64:67],v[192:195]
ds_read_b128 v[76:79],v20 offset:35840
v_mfma_f32_16x16x32_bf16 v[200:203],v[64:67],a[192:195],v[200:203]
s_waitcnt lgkmcnt(2)
v_mfma_f32_16x16x32_bf16 v[196:199],a[64:67],v[68:71],v[196:199]
ds_read_b128 v[64:67],v20 offset:36864
v_mfma_f32_16x16x32_bf16 v[204:207],v[68:71],a[192:195],v[204:207]
s_waitcnt lgkmcnt(2)
v_mfma_f32_16x16x32_bf16 v[192:195],a[68:71],v[72:75],v[192:195]
ds_read_b128 v[68:71],v20 offset:37888
v_mfma_f32_16x16x32_bf16 v[200:203],v[72:75],a[196:199],v[200:203]
s_waitcnt lgkmcnt(2)
v_mfma_f32_16x16x32_bf16 v[196:199],a[68:71],v[76:79],v[196:199]
ds_read_b128 v[72:75],v20 offset:38912
v_mfma_f32_16x16x32_bf16 v[204:207],v[76:79],a[196:199],v[204:207]
s_waitcnt lgkmcnt(2)
v_mfma_f32_16x16x32_bf16 v[192:195],a[72:75],v[64:67],v[192:195]
ds_read_b128 v[76:79],v20 offset:39936
v_mfma_f32_16x16x32_bf16 v[200:203],v[64:67],a[200:203],v[200:203]
s_waitcnt lgkmcnt(2)
v_mfma_f32_16x16x32_bf16 v[196:199],a[72:75],v[68:71],v[196:199]
ds_read_b128 v[64:67],v20 offset:40960
v_mfma_f32_16x16x32_bf16 v[204:207],v[68:71],a[200:203],v[204:207]
s_waitcnt lgkmcnt(2)
v_mfma_f32_16x16x32_bf16 v[192:195],a[76:79],v[72:75],v[192:195]
ds_read_b128 v[68:71],v20 offset:41984
v_mfma_f32_16x16x32_bf16 v[200:203],v[72:75],a[204:207],v[200:203]
s_waitcnt lgkmcnt(2)
v_mfma_f32_16x16x32_bf16 v[196:199],a[76:79],v[76:79],v[196:199]
ds_read_b128 v[72:75],v20 offset:43008
v_mfma_f32_16x16x32_bf16 v[204:207],v[76:79],a[204:207],v[204:207]
s_waitcnt lgkmcnt(2)
v_mfma_f32_16x16x32_bf16 v[192:195],a[80:83],v[64:67],v[192:195]
ds_read_b128 v[76:79],v20 offset:44032
v_mfma_f32_16x16x32_bf16 v[200:203],v[64:67],a[208:211],v[200:203]
s_waitcnt lgkmcnt(2)
v_mfma_f32_16x16x32_bf16 v[196:199],a[80:83],v[68:71],v[196:199]
ds_read_b128 v[64:67],v20 offset:45056
v_mfma_f32_16x16x32_bf16 v[204:207],v[68:71],a[208:211],v[204:207]
s_waitcnt lgkmcnt(2)
v_mfma_f32_16x16x32_bf16 v[192:195],a[84:87],v[72:75],v[192:195]
ds_read_b128 v[68:71],v20 offset:46080
v_mfma_f32_16x16x32_bf16 v[200:203],v[72:75],a[212:215],v[200:203]
s_waitcnt lgkmcnt(2)
v_mfma_f32_16x16x32_bf16 v[196:199],a[84:87],v[76:79],v[196:199]
ds_read_b128 v[72:75],v20 offset:47104
v_mfma_f32_16x16x32_bf16 v[204:207],v[76:79],a[212:215],v[204:207]
s_waitcnt lgkmcnt(2)
v_mfma_f32_16x16x32_bf16 v[192:195],a[88:91],v[64:67],v[192:195]
ds_read_b128 v[76:79],v20 offset:48128
v_mfma_f32_16x16x32_bf16 v[200:203],v[64:67],a[216:219],v[200:203]
s_waitcnt lgkmcnt(2)
v_mfma_f32_16x16x32_bf16 v[196:199],a[88:91],v[68:71],v[196:199]
ds_read_b128 v[64:67],v20 offset:49152
v_mfma_f32_16x16x32_bf16 v[204:207],v[68:71],a[216:219],v[204:207]
s_waitcnt lgkmcnt(2)
v_mfma_f32_16x16x32_bf16 v[192:195],a[92:95],v[72:75],v[192:195]
ds_read_b128 v[68:71],v20 offset:50176
v_mfma_f32_16x16x32_bf16 v[200:203],v[72:75],a[220:223],v[200:203]
s_waitcnt lgkmcnt(2)
v_mfma_f32_16x16x32_bf16 v[196:199],a[92:95],v[76:79],v[196:199]
ds_read_b128 v[72:75],v20 offset:51200
v_mfma_f32_16x16x32_bf16 v[204:207],v[76:79],a[220:223],v[204:207]
s_waitcnt lgkmcnt(2)
v_mfma_f32_16x16x32_bf16 v[192:195],a[96:99],v[64:67],v[192:195]
ds_read_b128 v[76:79],v20 offset:52224
v_mfma_f32_16x16x32_bf16 v[200:203],v[64:67],a[224:227],v[200:203]
s_waitcnt lgkmcnt(2)
v_mfma_f32_16x16x32_bf16 v[196:199],a[96:99],v[68:71],v[196:199]
ds_read_b128 v[64:67],v20 offset:53248
v_mfma_f32_16x16x32_bf16 v[204:207],v[68:71],a[224:227],v[204:207]
s_waitcnt lgkmcnt(2)
v_mfma_f32_16x16x32_bf16 v[192:195],a[100:103],v[72:75],v[192:195]
ds_read_b128 v[68:71],v20 offset:54272
v_mfma_f32_16x16x32_bf16 v[200:203],v[72:75],a[228:231],v[200:203]
s_waitcnt lgkmcnt(2)
v_mfma_f32_16x16x32_bf16 v[196:199],a[100:103],v[76:79],v[196:199]
ds_read_b128 v[72:75],v20 offset:55296
v_mfma_f32_16x16x32_bf16 v[204:207],v[76:79],a[228:231],v[204:207]
s_waitcnt lgkmcnt(2)
v_mfma_f32_16x16x32_bf16 v[192:195],a[104:107],v[64:67],v[192:195]
ds_read_b128 v[76:79],v20 offset:56320
v_mfma_f32_16x16x32_bf16 v[200:203],v[64:67],a[232:235],v[200:203]
s_waitcnt lgkmcnt(2)
v_mfma_f32_16x16x32_bf16 v[196:199],a[104:107],v[68:71],v[196:199]
ds_read_b128 v[64:67],v20 offset:57344
v_mfma_f32_16x16x32_bf16 v[204:207],v[68:71],a[232:235],v[204:207]
s_waitcnt lgkmcnt(2)
v_mfma_f32_16x16x32_bf16 v[192:195],a[108:111],v[72:75],v[192:195]
ds_read_b128 v[68:71],v20 offset:58368
v_mfma_f32_16x16x32_bf16 v[200:203],v[72:75],a[236:239],v[200:203]
s_waitcnt lgkmcnt(2)
v_mfma_f32_16x16x32_bf16 v[196:199],a[108:111],v[76:79],v[196:199]
ds_read_b128 v[72:75],v20 offset:59392
v_mfma_f32_16x16x32_bf16 v[204:207],v[76:79],a[236:239],v[204:207]
s_waitcnt lgkmcnt(2)
v_mfma_f32_16x16x32_bf16 v[192:195],a[112:115],v[64:67],v[192:195]
ds_read_b128 v[76:79],v20 offset:60416
v_mfma_f32_16x16x32_bf16 v[200:203],v[64:67],a[240:243],v[200:203]
s_waitcnt lgkmcnt(2)
v_mfma_f32_16x16x32_bf16 v[196:199],a[112:115],v[68:71],v[196:199]
ds_read_b128 v[64:67],v20 offset:61440
v_mfma_f32_16x16x32_bf16 v[204:207],v[68:71],a[240:243],v[204:207]
s_waitcnt lgkmcnt(2)
v_mfma_f32_16x16x32_bf16 v[192:195],a[116:119],v[72:75],v[192:195]
ds_read_b128 v[68:71],v20 offset:62464
v_mfma_f32_16x16x32_bf16 v[200:203],v[72:75],a[244:247],v[200:203]
s_waitcnt lgkmcnt(2)
v_mfma_f32_16x16x32_bf16 v[196:199],a[116:119],v[76:79],v[196:199]
ds_read_b128 v[72:75],v20 offset:63488
v_mfma_f32_16x16x32_bf16 v[204:207],v[76:79],a[244:247],v[204:207]
s_waitcnt lgkmcnt(2)
v_mfma_f32_16x16x32_bf16 v[192:195],a[120:123],v[64:67],v[192:195]
ds_read_b128 v[76:79],v20 offset:64512
v_mfma_f32_16x16x32_bf16 v[200:203],v[64:67],a[248:251],v[200:203]
s_waitcnt lgkmcnt(2)
v_mfma_f32_16x16x32_bf16 v[196:199],a[120:123],v[68:71],v[196:199]
v_mfma_f32_16x16x32_bf16 v[204:207],v[68:71],a[248:251],v[204:207]
s_waitcnt lgkmcnt(1)
v_mfma_f32_16x16x32_bf16 v[192:195],a[124:127],v[72:75],v[192:195]
v_mfma_f32_16x16x32_bf16 v[200:203],v[72:75],a[252:255],v[200:203]
s_waitcnt lgkmcnt(0)
v_mfma_f32_16x16x32_bf16 v[196:199],a[124:127],v[76:79],v[196:199]
v_mfma_f32_16x16x32_bf16 v[204:207],v[76:79],a[252:255],v[204:207]
v_xor_b32 v20,0x10000,v20
s_xor_b32 s62,s62,0x10000
s_lshr_b32 s64,s73,9
v_add_u32 v22,s64,v24
v_cvt_pk_bf16_f32 v208,v192,v193
v_cvt_pk_bf16_f32 v209,v194,v195
s_nop 0
v_cvt_pk_bf16_f32 v210,v196,v197
v_cvt_pk_bf16_f32 v211,v198,v199
v_cvt_pk_bf16_f32 v212,v200,v201
v_cvt_pk_bf16_f32 v213,v202,v203
v_cvt_pk_bf16_f32 v214,v204,v205
v_cvt_pk_bf16_f32 v215,v206,v207
v_permlane16_swap_b32 v208,v210
v_permlane16_swap_b32 v209,v211
buffer_store_dwordx4 v[208:211],v2,s[24:27],s73 offen
buffer_store_dwordx4 v[208:211],v2,s[28:31],s73 offen sc1
ds_write_b128 v22,v[212:215] offset:16384
buffer_store_dwordx4 v[208:211],v17,s[20:23],s12 offen sc1
bgx_132:
s_add_u32 s63,s79,1
s_and_b32 s64,s63,3
s_lshl_b32 s70,s64,20
s_add_u32 s65,s63,2
s_and_b32 s65,s65,3
s_lshl_b32 s73,s65,20
s_add_u32 s55,s63,3
s_lshl_b32 s78,s55,16
s_add_u32 s78,s78,57344
s_cmp_lt_u32 s55,64
s_cselect_b32 s78,s78,0x7fff0000
s_add_u32 s60,s63,1
s_lshl_b32 s76,s60,21
s_lshl_b32 s55,s60,13
s_and_b32 s55,s55,0x2000
s_xor_b32 s55,s55,s61
s_add_u32 s76,s76,s55
s_cmp_lt_u32 s60,64
s_cselect_b32 s76,s76,0x7fff0000
s_add_u32 s60,s63,2
s_lshl_b32 s12,s60,21
s_lshl_b32 s55,s60,13
s_and_b32 s55,s55,0x2000
s_xor_b32 s55,s55,s61
s_add_u32 s12,s12,s55
s_cmp_lt_u32 s60,64
s_cselect_b32 s12,s12,0x7fff0000
s_add_u32 s71,s73,65536
v_mov_b32 v176,0
v_mov_b32 v177,0
v_mov_b32 v178,0
v_mov_b32 v179,0
v_mov_b32 v180,0
v_mov_b32 v181,0
v_mov_b32 v182,0
v_mov_b32 v183,0
s_add_u32 s79,s79,1
s_cmp_eq_u32 s79,0
s_cbranch_scc1 pn2_131
v_mov_b32 v38,1
ds_write_b32 v37,v38 offset:8
buffer_store_dwordx4 v[212:215],v12,s[20:23],s76 offen sc1
s_waitcnt lgkmcnt(0)
s_branch pn1_130
pn2_131:
v_mov_b32 v25,1
s_waitcnt vmcnt(1) lgkmcnt(0)
s_barrier
s_branch loop_122
w2_60:
s_lshr_b32 s64,s57,2
s_add_u32 s64,s64,64
s_lshl_b32 s64,s64,14
s_add_u32 s64,s64,s68
s_add_u32 s64,s64,29361152
v_add_u32 v12,s64,v16
v_and_b32 v22,1,v4
v_lshrrev_b32 v23,1,v4
v_lshl_add_u32 v22,v22,1,v23
v_lshlrev_b32 v22,2,v22
v_lshl_add_u32 v22,v3,4,v22
v_add_u32 v31,155904,v22
s_branch first_133
loop_134:
s_barrier
buffer_load_dword v248,v18,s[20:23],s70 offen offset:0 sc1
s_nop 15
s_nop 5
hl_136:
buffer_load_dword v249,v18,s[20:23],s70 offen offset:0 sc1
s_waitcnt vmcnt(1)
v_cmp_eq_u32 vcc,v25,v248
s_bcnt1_i32_b32 s64,vcc_lo
s_cmp_ge_u32 s64,8
s_cbranch_scc1 hg_137
buffer_load_dword v248,v18,s[20:23],s70 offen offset:0 sc1
s_waitcnt vmcnt(1)
v_cmp_eq_u32 vcc,v25,v249
s_bcnt1_i32_b32 s64,vcc_lo
s_cmp_ge_u32 s64,8
s_cbranch_scc1 hg_137
s_sub_u32 s90,s90,1
s_cmp_gt_i32 s90,0
s_cbranch_scc1 hl_136
hg_137:
buffer_load_dwordx4 v[64:67],v28,s[20:23],s70 offen offset:0 sc1
buffer_load_dwordx4 v[68:71],v28,s[20:23],s70 offen offset:1024 sc1
buffer_load_dwordx4 v[72:75],v28,s[20:23],s70 offen offset:2048 sc1
buffer_load_dwordx4 v[76:79],v28,s[20:23],s70 offen offset:3072 sc1
s_waitcnt vmcnt(3)
ds_write_b128 v24,v[64:67] offset:8192
v_min3_u32 v22,v64,v65,v66
v_min_u32 v22,v22,v67
s_waitcnt vmcnt(2)
ds_write_b128 v24,v[68:71] offset:9216
v_min3_u32 v22,v22,v68,v69
v_min3_u32 v22,v22,v70,v71
s_waitcnt vmcnt(1)
ds_write_b128 v24,v[72:75] offset:10240
v_min3_u32 v22,v22,v72,v73
v_min3_u32 v22,v22,v74,v75
s_waitcnt vmcnt(0)
ds_write_b128 v24,v[76:79] offset:11264
v_min3_u32 v22,v22,v76,v77
v_min3_u32 v22,v22,v78,v79
v_cmp_eq_u32 vcc,0,v22
s_cbranch_vccnz art_138
abk_139:
v_smfmac_f32_16x16x64_bf16 v[176:179],v[64:67],a[64:71],v14
s_waitcnt lgkmcnt(0)
s_barrier
ds_read_b128 v[80:83],v24 offset:12288
ds_read_b128 v[84:87],v24 offset:13312
ds_read_b128 v[88:91],v24 offset:14336
ds_read_b128 v[92:95],v24 offset:15360
buffer_store_dwordx4 v[212:215],v12,s[20:23],s76 offen sc1
v_smfmac_f32_16x16x64_bf16 v[176:179],v[68:71],a[72:79],v14
ds_read_b128 v[32:35],v24 offset:0
ds_read_b128 v[36:39],v24 offset:1024
v_smfmac_f32_16x16x64_bf16 v[176:179],v[72:75],a[80:87],v14
ds_read_b128 v[40:43],v24 offset:2048
ds_read_b128 v[44:47],v24 offset:3072
v_smfmac_f32_16x16x64_bf16 v[176:179],v[76:79],a[88:95],v14
ds_read_b128 v[48:51],v24 offset:4096
ds_read_b128 v[52:55],v24 offset:5120
s_waitcnt lgkmcnt(9)
v_smfmac_f32_16x16x64_bf16 v[176:179],v[80:83],a[96:103],v14
ds_read_b128 v[56:59],v24 offset:6144
s_waitcnt lgkmcnt(9)
v_smfmac_f32_16x16x64_bf16 v[176:179],v[84:87],a[104:111],v14
ds_read_b128 v[60:63],v24 offset:7168
s_waitcnt lgkmcnt(9)
v_smfmac_f32_16x16x64_bf16 v[176:179],v[88:91],a[112:119],v14
s_waitcnt lgkmcnt(8)
v_smfmac_f32_16x16x64_bf16 v[176:179],v[92:95],a[120:127],v14
s_waitcnt lgkmcnt(7)
v_smfmac_f32_16x16x64_bf16 v[176:179],v[32:35],a[0:7],v14
s_waitcnt lgkmcnt(6)
v_smfmac_f32_16x16x64_bf16 v[176:179],v[36:39],a[8:15],v14
s_waitcnt lgkmcnt(5)
v_smfmac_f32_16x16x64_bf16 v[176:179],v[40:43],a[16:23],v14
s_waitcnt lgkmcnt(4)
v_smfmac_f32_16x16x64_bf16 v[176:179],v[44:47],a[24:31],v14
s_waitcnt lgkmcnt(3)
v_smfmac_f32_16x16x64_bf16 v[176:179],v[48:51],a[32:39],v14
s_waitcnt lgkmcnt(2)
v_smfmac_f32_16x16x64_bf16 v[176:179],v[52:55],a[40:47],v14
s_waitcnt lgkmcnt(1)
v_smfmac_f32_16x16x64_bf16 v[176:179],v[56:59],a[48:55],v14
s_waitcnt lgkmcnt(0)
v_smfmac_f32_16x16x64_bf16 v[176:179],v[60:63],a[56:63],v14
v_smfmac_f32_16x16x64_bf16 v[180:183],v[32:35],a[128:135],v14
v_smfmac_f32_16x16x64_bf16 v[180:183],v[36:39],a[136:143],v14
s_nop 5
v_permlane32_swap_b32 v176,v178
v_permlane32_swap_b32 v177,v179
v_add_f32 v176,v176,v178
v_add_f32 v177,v177,v179
v_cvt_pk_bf16_f32 v216,v176,v177
s_nop 1
v_mov_b32_dpp v217,v216 quad_perm:[1,0,3,2] row_mask:0xf bank_mask:0xf
v_perm_b32 v216,v217,v216,v15
v_max_u32 v216,1,v216
buffer_store_dword v216,v19,s[24:27],s70 offen
buffer_store_dword v216,v19,s[28:31],s70 offen sc1
v_smfmac_f32_16x16x64_bf16 v[180:183],v[40:43],a[144:151],v14
v_smfmac_f32_16x16x64_bf16 v[180:183],v[44:47],a[152:159],v14
v_smfmac_f32_16x16x64_bf16 v[180:183],v[48:51],a[160:167],v14
v_smfmac_f32_16x16x64_bf16 v[180:183],v[52:55],a[168:175],v14
v_smfmac_f32_16x16x64_bf16 v[180:183],v[56:59],a[176:183],v14
v_smfmac_f32_16x16x64_bf16 v[180:183],v[60:63],a[184:191],v14
v_smfmac_f32_16x16x64_bf16 v[180:183],v[64:67],a[192:199],v14
v_smfmac_f32_16x16x64_bf16 v[180:183],v[68:71],a[200:207],v14
v_smfmac_f32_16x16x64_bf16 v[180:183],v[72:75],a[208:215],v14
v_smfmac_f32_16x16x64_bf16 v[180:183],v[76:79],a[216:223],v14
v_smfmac_f32_16x16x64_bf16 v[180:183],v[80:83],a[224:231],v14
v_smfmac_f32_16x16x64_bf16 v[180:183],v[84:87],a[232:239],v14
v_smfmac_f32_16x16x64_bf16 v[180:183],v[88:91],a[240:247],v14
v_smfmac_f32_16x16x64_bf16 v[180:183],v[92:95],a[248:255],v14
s_nop 7
v_permlane32_swap_b32 v180,v182
v_permlane32_swap_b32 v181,v183
v_add_f32 v180,v180,v182
v_add_f32 v181,v181,v183
v_cvt_pk_bf16_f32 v216,v180,v181
v_max_u32 v216,1,v216
ds_write_b32 v31,v216
ds_write_b32 v21,v25 offset:4
s_cmp_eq_u32 s79,63
s_cbranch_scc1 end_57
s_cmp_ge_i32 s79,62
s_cbranch_scc1 bgsk_141
ds_read_b128 v[64:67],v20 offset:0
ds_read_b128 v[68:71],v20 offset:1024
ds_read_b128 v[72:75],v20 offset:2048
s_waitcnt lgkmcnt(2)
v_mfma_f32_16x16x32_bf16 v[192:195],a[0:3],v[64:67],0
ds_read_b128 v[76:79],v20 offset:3072
v_mfma_f32_16x16x32_bf16 v[200:203],v[64:67],a[128:131],0
s_waitcnt lgkmcnt(2)
v_mfma_f32_16x16x32_bf16 v[196:199],a[0:3],v[68:71],0
ds_read_b128 v[64:67],v20 offset:4096
v_mfma_f32_16x16x32_bf16 v[204:207],v[68:71],a[128:131],0
s_waitcnt lgkmcnt(2)
v_mfma_f32_16x16x32_bf16 v[192:195],a[4:7],v[72:75],v[192:195]
ds_read_b128 v[68:71],v20 offset:5120
v_mfma_f32_16x16x32_bf16 v[200:203],v[72:75],a[132:135],v[200:203]
s_waitcnt lgkmcnt(2)
v_mfma_f32_16x16x32_bf16 v[196:199],a[4:7],v[76:79],v[196:199]
ds_read_b128 v[72:75],v20 offset:6144
v_mfma_f32_16x16x32_bf16 v[204:207],v[76:79],a[132:135],v[204:207]
s_waitcnt lgkmcnt(2)
v_mfma_f32_16x16x32_bf16 v[192:195],a[8:11],v[64:67],v[192:195]
ds_read_b128 v[76:79],v20 offset:7168
v_mfma_f32_16x16x32_bf16 v[200:203],v[64:67],a[136:139],v[200:203]
s_waitcnt lgkmcnt(2)
v_mfma_f32_16x16x32_bf16 v[196:199],a[8:11],v[68:71],v[196:199]
ds_read_b128 v[64:67],v20 offset:8192
v_mfma_f32_16x16x32_bf16 v[204:207],v[68:71],a[136:139],v[204:207]
s_waitcnt lgkmcnt(2)
v_mfma_f32_16x16x32_bf16 v[192:195],a[12:15],v[72:75],v[192:195]
ds_read_b128 v[68:71],v20 offset:9216
v_mfma_f32_16x16x32_bf16 v[200:203],v[72:75],a[140:143],v[200:203]
s_waitcnt lgkmcnt(2)
v_mfma_f32_16x16x32_bf16 v[196:199],a[12:15],v[76:79],v[196:199]
ds_read_b128 v[72:75],v20 offset:10240
v_mfma_f32_16x16x32_bf16 v[204:207],v[76:79],a[140:143],v[204:207]
s_add_u32 m0,s62,16384
s_add_u32 s69,s78,16384
s_waitcnt lgkmcnt(2)
v_mfma_f32_16x16x32_bf16 v[192:195],a[16:19],v[64:67],v[192:195]
ds_read_b128 v[76:79],v20 offset:11264
v_mfma_f32_16x16x32_bf16 v[200:203],v[64:67],a[144:147],v[200:203]
buffer_load_dwordx4 v16,s[20:23],s69 offen offset:0 lds
s_waitcnt lgkmcnt(2)
v_mfma_f32_16x16x32_bf16 v[196:199],a[16:19],v[68:71],v[196:199]
ds_read_b128 v[64:67],v20 offset:12288
v_mfma_f32_16x16x32_bf16 v[204:207],v[68:71],a[144:147],v[204:207]
buffer_load_dwordx4 v16,s[20:23],s69 offen offset:1024 lds
s_waitcnt lgkmcnt(2)
v_mfma_f32_16x16x32_bf16 v[192:195],a[20:23],v[72:75],v[192:195]
ds_read_b128 v[68:71],v20 offset:13312
v_mfma_f32_16x16x32_bf16 v[200:203],v[72:75],a[148:151],v[200:203]
buffer_load_dwordx4 v16,s[20:23],s69 offen offset:2048 lds
s_waitcnt lgkmcnt(2)
v_mfma_f32_16x16x32_bf16 v[196:199],a[20:23],v[76:79],v[196:199]
ds_read_b128 v[72:75],v20 offset:14336
v_mfma_f32_16x16x32_bf16 v[204:207],v[76:79],a[148:151],v[204:207]
buffer_load_dwordx4 v16,s[20:23],s69 offen offset:3072 lds
s_waitcnt lgkmcnt(2)
v_mfma_f32_16x16x32_bf16 v[192:195],a[24:27],v[64:67],v[192:195]
ds_read_b128 v[76:79],v20 offset:15360
v_mfma_f32_16x16x32_bf16 v[200:203],v[64:67],a[152:155],v[200:203]
s_add_u32 m0,s62,20480
s_add_u32 s69,s78,20480
s_waitcnt lgkmcnt(2)
v_mfma_f32_16x16x32_bf16 v[196:199],a[24:27],v[68:71],v[196:199]
ds_read_b128 v[64:67],v20 offset:16384
v_mfma_f32_16x16x32_bf16 v[204:207],v[68:71],a[152:155],v[204:207]
buffer_load_dwordx4 v16,s[20:23],s69 offen offset:0 lds
s_waitcnt lgkmcnt(2)
v_mfma_f32_16x16x32_bf16 v[192:195],a[28:31],v[72:75],v[192:195]
ds_read_b128 v[68:71],v20 offset:17408
v_mfma_f32_16x16x32_bf16 v[200:203],v[72:75],a[156:159],v[200:203]
buffer_load_dwordx4 v16,s[20:23],s69 offen offset:1024 lds
s_waitcnt lgkmcnt(2)
v_mfma_f32_16x16x32_bf16 v[196:199],a[28:31],v[76:79],v[196:199]
ds_read_b128 v[72:75],v20 offset:18432
v_mfma_f32_16x16x32_bf16 v[204:207],v[76:79],a[156:159],v[204:207]
buffer_load_dwordx4 v16,s[20:23],s69 offen offset:2048 lds
s_waitcnt lgkmcnt(2)
v_mfma_f32_16x16x32_bf16 v[192:195],a[32:35],v[64:67],v[192:195]
ds_read_b128 v[76:79],v20 offset:19456
v_mfma_f32_16x16x32_bf16 v[200:203],v[64:67],a[160:163],v[200:203]
buffer_load_dwordx4 v16,s[20:23],s69 offen offset:3072 lds
s_waitcnt lgkmcnt(2)
v_mfma_f32_16x16x32_bf16 v[196:199],a[32:35],v[68:71],v[196:199]
ds_read_b128 v[64:67],v20 offset:20480
v_mfma_f32_16x16x32_bf16 v[204:207],v[68:71],a[160:163],v[204:207]
s_add_u32 m0,s62,24576
s_add_u32 s69,s78,24576
s_waitcnt lgkmcnt(2)
v_mfma_f32_16x16x32_bf16 v[192:195],a[36:39],v[72:75],v[192:195]
ds_read_b128 v[68:71],v20 offset:21504
v_mfma_f32_16x16x32_bf16 v[200:203],v[72:75],a[164:167],v[200:203]
buffer_load_dwordx4 v16,s[20:23],s69 offen offset:0 lds
s_waitcnt lgkmcnt(2)
v_mfma_f32_16x16x32_bf16 v[196:199],a[36:39],v[76:79],v[196:199]
ds_read_b128 v[72:75],v20 offset:22528
v_mfma_f32_16x16x32_bf16 v[204:207],v[76:79],a[164:167],v[204:207]
buffer_load_dwordx4 v16,s[20:23],s69 offen offset:1024 lds
s_waitcnt lgkmcnt(2)
v_mfma_f32_16x16x32_bf16 v[192:195],a[40:43],v[64:67],v[192:195]
ds_read_b128 v[76:79],v20 offset:23552
v_mfma_f32_16x16x32_bf16 v[200:203],v[64:67],a[168:171],v[200:203]
buffer_load_dwordx4 v16,s[20:23],s69 offen offset:2048 lds
s_waitcnt lgkmcnt(2)
v_mfma_f32_16x16x32_bf16 v[196:199],a[40:43],v[68:71],v[196:199]
ds_read_b128 v[64:67],v20 offset:24576
v_mfma_f32_16x16x32_bf16 v[204:207],v[68:71],a[168:171],v[204:207]
buffer_load_dwordx4 v16,s[20:23],s69 offen offset:3072 lds
s_waitcnt lgkmcnt(2)
v_mfma_f32_16x16x32_bf16 v[192:195],a[44:47],v[72:75],v[192:195]
ds_read_b128 v[68:71],v20 offset:25600
v_mfma_f32_16x16x32_bf16 v[200:203],v[72:75],a[172:175],v[200:203]
s_add_u32 m0,s62,28672
s_add_u32 s69,s78,28672
s_waitcnt lgkmcnt(2)
v_mfma_f32_16x16x32_bf16 v[196:199],a[44:47],v[76:79],v[196:199]
ds_read_b128 v[72:75],v20 offset:26624
v_mfma_f32_16x16x32_bf16 v[204:207],v[76:79],a[172:175],v[204:207]
buffer_load_dwordx4 v16,s[20:23],s69 offen offset:0 lds
s_waitcnt lgkmcnt(2)
v_mfma_f32_16x16x32_bf16 v[192:195],a[48:51],v[64:67],v[192:195]
ds_read_b128 v[76:79],v20 offset:27648
v_mfma_f32_16x16x32_bf16 v[200:203],v[64:67],a[176:179],v[200:203]
buffer_load_dwordx4 v16,s[20:23],s69 offen offset:1024 lds
s_waitcnt lgkmcnt(2)
v_mfma_f32_16x16x32_bf16 v[196:199],a[48:51],v[68:71],v[196:199]
ds_read_b128 v[64:67],v20 offset:28672
v_mfma_f32_16x16x32_bf16 v[204:207],v[68:71],a[176:179],v[204:207]
buffer_load_dwordx4 v16,s[20:23],s69 offen offset:2048 lds
s_waitcnt lgkmcnt(2)
v_mfma_f32_16x16x32_bf16 v[192:195],a[52:55],v[72:75],v[192:195]
ds_read_b128 v[68:71],v20 offset:29696
v_mfma_f32_16x16x32_bf16 v[200:203],v[72:75],a[180:183],v[200:203]
buffer_load_dwordx4 v16,s[20:23],s69 offen offset:3072 lds
s_waitcnt lgkmcnt(2)
v_mfma_f32_16x16x32_bf16 v[196:199],a[52:55],v[76:79],v[196:199]
ds_read_b128 v[72:75],v20 offset:30720
v_mfma_f32_16x16x32_bf16 v[204:207],v[76:79],a[180:183],v[204:207]
s_waitcnt lgkmcnt(2)
v_mfma_f32_16x16x32_bf16 v[192:195],a[56:59],v[64:67],v[192:195]
ds_read_b128 v[76:79],v20 offset:31744
v_mfma_f32_16x16x32_bf16 v[200:203],v[64:67],a[184:187],v[200:203]
s_waitcnt lgkmcnt(2)
v_mfma_f32_16x16x32_bf16 v[196:199],a[56:59],v[68:71],v[196:199]
ds_read_b128 v[64:67],v20 offset:32768
v_mfma_f32_16x16x32_bf16 v[204:207],v[68:71],a[184:187],v[204:207]
s_waitcnt lgkmcnt(2)
v_mfma_f32_16x16x32_bf16 v[192:195],a[60:63],v[72:75],v[192:195]
ds_read_b128 v[68:71],v20 offset:33792
v_mfma_f32_16x16x32_bf16 v[200:203],v[72:75],a[188:191],v[200:203]
s_waitcnt lgkmcnt(2)
v_mfma_f32_16x16x32_bf16 v[196:199],a[60:63],v[76:79],v[196:199]
ds_read_b128 v[72:75],v20 offset:34816
v_mfma_f32_16x16x32_bf16 v[204:207],v[76:79],a[188:191],v[204:207]
s_waitcnt lgkmcnt(2)
v_mfma_f32_16x16x32_bf16 v[192:195],a[64:67],v[64:67],v[192:195]
ds_read_b128 v[76:79],v20 offset:35840
v_mfma_f32_16x16x32_bf16 v[200:203],v[64:67],a[192:195],v[200:203]
s_waitcnt lgkmcnt(2)
v_mfma_f32_16x16x32_bf16 v[196:199],a[64:67],v[68:71],v[196:199]
ds_read_b128 v[64:67],v20 offset:36864
v_mfma_f32_16x16x32_bf16 v[204:207],v[68:71],a[192:195],v[204:207]
s_waitcnt lgkmcnt(2)
v_mfma_f32_16x16x32_bf16 v[192:195],a[68:71],v[72:75],v[192:195]
ds_read_b128 v[68:71],v20 offset:37888
v_mfma_f32_16x16x32_bf16 v[200:203],v[72:75],a[196:199],v[200:203]
s_waitcnt lgkmcnt(2)
v_mfma_f32_16x16x32_bf16 v[196:199],a[68:71],v[76:79],v[196:199]
ds_read_b128 v[72:75],v20 offset:38912
v_mfma_f32_16x16x32_bf16 v[204:207],v[76:79],a[196:199],v[204:207]
s_waitcnt lgkmcnt(2)
v_mfma_f32_16x16x32_bf16 v[192:195],a[72:75],v[64:67],v[192:195]
ds_read_b128 v[76:79],v20 offset:39936
v_mfma_f32_16x16x32_bf16 v[200:203],v[64:67],a[200:203],v[200:203]
s_waitcnt lgkmcnt(2)
v_mfma_f32_16x16x32_bf16 v[196:199],a[72:75],v[68:71],v[196:199]
ds_read_b128 v[64:67],v20 offset:40960
v_mfma_f32_16x16x32_bf16 v[204:207],v[68:71],a[200:203],v[204:207]
s_waitcnt lgkmcnt(2)
v_mfma_f32_16x16x32_bf16 v[192:195],a[76:79],v[72:75],v[192:195]
ds_read_b128 v[68:71],v20 offset:41984
v_mfma_f32_16x16x32_bf16 v[200:203],v[72:75],a[204:207],v[200:203]
s_waitcnt lgkmcnt(2)
v_mfma_f32_16x16x32_bf16 v[196:199],a[76:79],v[76:79],v[196:199]
ds_read_b128 v[72:75],v20 offset:43008
v_mfma_f32_16x16x32_bf16 v[204:207],v[76:79],a[204:207],v[204:207]
s_waitcnt lgkmcnt(2)
v_mfma_f32_16x16x32_bf16 v[192:195],a[80:83],v[64:67],v[192:195]
ds_read_b128 v[76:79],v20 offset:44032
v_mfma_f32_16x16x32_bf16 v[200:203],v[64:67],a[208:211],v[200:203]
s_waitcnt lgkmcnt(2)
v_mfma_f32_16x16x32_bf16 v[196:199],a[80:83],v[68:71],v[196:199]
ds_read_b128 v[64:67],v20 offset:45056
v_mfma_f32_16x16x32_bf16 v[204:207],v[68:71],a[208:211],v[204:207]
s_waitcnt lgkmcnt(2)
v_mfma_f32_16x16x32_bf16 v[192:195],a[84:87],v[72:75],v[192:195]
ds_read_b128 v[68:71],v20 offset:46080
v_mfma_f32_16x16x32_bf16 v[200:203],v[72:75],a[212:215],v[200:203]
s_waitcnt lgkmcnt(2)
v_mfma_f32_16x16x32_bf16 v[196:199],a[84:87],v[76:79],v[196:199]
ds_read_b128 v[72:75],v20 offset:47104
v_mfma_f32_16x16x32_bf16 v[204:207],v[76:79],a[212:215],v[204:207]
s_waitcnt lgkmcnt(2)
v_mfma_f32_16x16x32_bf16 v[192:195],a[88:91],v[64:67],v[192:195]
ds_read_b128 v[76:79],v20 offset:48128
v_mfma_f32_16x16x32_bf16 v[200:203],v[64:67],a[216:219],v[200:203]
s_waitcnt lgkmcnt(2)
v_mfma_f32_16x16x32_bf16 v[196:199],a[88:91],v[68:71],v[196:199]
ds_read_b128 v[64:67],v20 offset:49152
v_mfma_f32_16x16x32_bf16 v[204:207],v[68:71],a[216:219],v[204:207]
s_waitcnt lgkmcnt(2)
v_mfma_f32_16x16x32_bf16 v[192:195],a[92:95],v[72:75],v[192:195]
ds_read_b128 v[68:71],v20 offset:50176
v_mfma_f32_16x16x32_bf16 v[200:203],v[72:75],a[220:223],v[200:203]
s_waitcnt lgkmcnt(2)
v_mfma_f32_16x16x32_bf16 v[196:199],a[92:95],v[76:79],v[196:199]
ds_read_b128 v[72:75],v20 offset:51200
v_mfma_f32_16x16x32_bf16 v[204:207],v[76:79],a[220:223],v[204:207]
s_waitcnt lgkmcnt(2)
v_mfma_f32_16x16x32_bf16 v[192:195],a[96:99],v[64:67],v[192:195]
ds_read_b128 v[76:79],v20 offset:52224
v_mfma_f32_16x16x32_bf16 v[200:203],v[64:67],a[224:227],v[200:203]
s_waitcnt lgkmcnt(2)
v_mfma_f32_16x16x32_bf16 v[196:199],a[96:99],v[68:71],v[196:199]
ds_read_b128 v[64:67],v20 offset:53248
v_mfma_f32_16x16x32_bf16 v[204:207],v[68:71],a[224:227],v[204:207]
s_waitcnt lgkmcnt(2)
v_mfma_f32_16x16x32_bf16 v[192:195],a[100:103],v[72:75],v[192:195]
ds_read_b128 v[68:71],v20 offset:54272
s_add_u32 m0,s62,43008
s_add_u32 s69,s78,43008
v_mfma_f32_16x16x32_bf16 v[200:203],v[72:75],a[228:231],v[200:203]
s_waitcnt lgkmcnt(2)
v_mfma_f32_16x16x32_bf16 v[196:199],a[100:103],v[76:79],v[196:199]
ds_read_b128 v[72:75],v20 offset:55296
buffer_load_dwordx4 v16,s[20:23],s69 offen offset:0 lds
v_mfma_f32_16x16x32_bf16 v[204:207],v[76:79],a[228:231],v[204:207]
s_waitcnt lgkmcnt(2)
v_mfma_f32_16x16x32_bf16 v[192:195],a[104:107],v[64:67],v[192:195]
ds_read_b128 v[76:79],v20 offset:56320
buffer_load_dwordx4 v16,s[20:23],s69 offen offset:1024 lds
v_mfma_f32_16x16x32_bf16 v[200:203],v[64:67],a[232:235],v[200:203]
s_waitcnt lgkmcnt(2)
v_mfma_f32_16x16x32_bf16 v[196:199],a[104:107],v[68:71],v[196:199]
ds_read_b128 v[64:67],v20 offset:57344
buffer_load_dwordx4 v16,s[20:23],s69 offen offset:2048 lds
v_mfma_f32_16x16x32_bf16 v[204:207],v[68:71],a[232:235],v[204:207]
s_waitcnt lgkmcnt(2)
v_mfma_f32_16x16x32_bf16 v[192:195],a[108:111],v[72:75],v[192:195]
ds_read_b128 v[68:71],v20 offset:58368
buffer_load_dwordx4 v16,s[20:23],s69 offen offset:3072 lds
v_mfma_f32_16x16x32_bf16 v[200:203],v[72:75],a[236:239],v[200:203]
s_waitcnt lgkmcnt(2)
v_mfma_f32_16x16x32_bf16 v[196:199],a[108:111],v[76:79],v[196:199]
ds_read_b128 v[72:75],v20 offset:59392
s_add_u32 m0,s62,47104
s_add_u32 s69,s78,47104
v_mfma_f32_16x16x32_bf16 v[204:207],v[76:79],a[236:239],v[204:207]
s_waitcnt lgkmcnt(2)
v_mfma_f32_16x16x32_bf16 v[192:195],a[112:115],v[64:67],v[192:195]
ds_read_b128 v[76:79],v20 offset:60416
buffer_load_dwordx4 v16,s[20:23],s69 offen offset:0 lds
v_mfma_f32_16x16x32_bf16 v[200:203],v[64:67],a[240:243],v[200:203]
s_waitcnt lgkmcnt(2)
v_mfma_f32_16x16x32_bf16 v[196:199],a[112:115],v[68:71],v[196:199]
ds_read_b128 v[64:67],v20 offset:61440
v_mfma_f32_16x16x32_bf16 v[204:207],v[68:71],a[240:243],v[204:207]
buffer_load_dwordx4 v16,s[20:23],s69 offen offset:1024 lds
s_waitcnt lgkmcnt(2)
v_mfma_f32_16x16x32_bf16 v[192:195],a[116:119],v[72:75],v[192:195]
ds_read_b128 v[68:71],v20 offset:62464
v_mfma_f32_16x16x32_bf16 v[200:203],v[72:75],a[244:247],v[200:203]
buffer_load_dwordx4 v16,s[20:23],s69 offen offset:2048 lds
s_waitcnt lgkmcnt(2)
v_mfma_f32_16x16x32_bf16 v[196:199],a[116:119],v[76:79],v[196:199]
ds_read_b128 v[72:75],v20 offset:63488
v_mfma_f32_16x16x32_bf16 v[204:207],v[76:79],a[244:247],v[204:207]
buffer_load_dwordx4 v16,s[20:23],s69 offen offset:3072 lds
s_waitcnt lgkmcnt(2)
v_mfma_f32_16x16x32_bf16 v[192:195],a[120:123],v[64:67],v[192:195]
ds_read_b128 v[76:79],v20 offset:64512
v_mfma_f32_16x16x32_bf16 v[200:203],v[64:67],a[248:251],v[200:203]
s_add_u32 m0,s62,51200
s_add_u32 s69,s78,51200
s_waitcnt lgkmcnt(2)
v_mfma_f32_16x16x32_bf16 v[196:199],a[120:123],v[68:71],v[196:199]
v_mfma_f32_16x16x32_bf16 v[204:207],v[68:71],a[248:251],v[204:207]
buffer_load_dwordx4 v16,s[20:23],s69 offen offset:0 lds
s_waitcnt lgkmcnt(1)
v_mfma_f32_16x16x32_bf16 v[192:195],a[124:127],v[72:75],v[192:195]
v_mfma_f32_16x16x32_bf16 v[200:203],v[72:75],a[252:255],v[200:203]
buffer_load_dwordx4 v16,s[20:23],s69 offen offset:1024 lds
s_waitcnt lgkmcnt(0)
v_mfma_f32_16x16x32_bf16 v[196:199],a[124:127],v[76:79],v[196:199]
v_mfma_f32_16x16x32_bf16 v[204:207],v[76:79],a[252:255],v[204:207]
s_waitcnt vmcnt(26)
ds_write_b32 v21,v25 offset:28
v_xor_b32 v20,0x10000,v20
s_xor_b32 s62,s62,0x10000
s_lshr_b32 s64,s73,9
v_add_u32 v22,s64,v24
v_cvt_pk_bf16_f32 v208,v192,v193
v_cvt_pk_bf16_f32 v209,v194,v195
v_cvt_pk_bf16_f32 v210,v196,v197
v_cvt_pk_bf16_f32 v211,v198,v199
v_cvt_pk_bf16_f32 v212,v200,v201
v_cvt_pk_bf16_f32 v213,v202,v203
v_cvt_pk_bf16_f32 v214,v204,v205
v_cvt_pk_bf16_f32 v215,v206,v207
v_permlane16_swap_b32 v208,v210
v_permlane16_swap_b32 v209,v211
buffer_store_dwordx4 v[208:211],v2,s[24:27],s73 offen
buffer_store_dwordx4 v[208:211],v2,s[28:31],s73 offen sc1
ds_write_b128 v22,v[212:215] offset:17408
buffer_store_dwordx4 v[208:211],v17,s[20:23],s12 offen sc1
bgx_140:
s_waitcnt lgkmcnt(0)
s_andn2_b32 s64,s79,0x14
s_cmp_eq_u32 s64,2
s_cbranch_scc1 late_142
lateb_143:
s_buffer_load_dword s48,s[20:23],s80 offset:0
s_buffer_load_dword s48,s[20:23],s80 offset:64
s_buffer_load_dword s48,s[20:23],s80 offset:128
s_buffer_load_dword s48,s[20:23],s80 offset:192
s_buffer_load_dword s48,s[20:23],s80 offset:256
s_buffer_load_dword s48,s[20:23],s80 offset:320
s_buffer_load_dword s48,s[20:23],s80 offset:384
s_buffer_load_dword s48,s[20:23],s80 offset:448
s_buffer_load_dword s48,s[20:23],s80 offset:512
s_buffer_load_dword s48,s[20:23],s80 offset:576
s_buffer_load_dword s48,s[20:23],s80 offset:640
s_buffer_load_dword s48,s[20:23],s80 offset:704
s_buffer_load_dword s48,s[20:23],s80 offset:768
s_buffer_load_dword s48,s[20:23],s80 offset:832
s_buffer_load_dword s48,s[20:23],s80 offset:896
s_buffer_load_dword s48,s[20:23],s80 offset:960
s_buffer_load_dword s48,s[20:23],s80 offset:1024
s_buffer_load_dword s48,s[20:23],s80 offset:1088
s_buffer_load_dword s48,s[20:23],s80 offset:1152
s_buffer_load_dword s48,s[20:23],s80 offset:1216
s_buffer_load_dword s48,s[20:23],s80 offset:1280
s_buffer_load_dword s48,s[20:23],s80 offset:1344
s_buffer_load_dword s48,s[20:23],s80 offset:1408
s_buffer_load_dword s48,s[20:23],s80 offset:1472
s_buffer_load_dword s48,s[20:23],s80 offset:1536
s_buffer_load_dword s48,s[20:23],s80 offset:1600
s_buffer_load_dword s48,s[20:23],s80 offset:1664
s_buffer_load_dword s48,s[20:23],s80 offset:1728
s_buffer_load_dword s48,s[20:23],s80 offset:1792
s_buffer_load_dword s48,s[20:23],s80 offset:1856
s_buffer_load_dword s48,s[20:23],s80 offset:1920
s_buffer_load_dword s48,s[20:23],s80 offset:1984
s_add_u32 s63,s79,1
s_and_b32 s64,s63,3
s_lshl_b32 s70,s64,20
s_add_u32 s65,s63,2
s_and_b32 s65,s65,3
s_lshl_b32 s73,s65,20
s_add_u32 s55,s63,3
s_lshl_b32 s78,s55,16
s_add_u32 s78,s78,57344
s_cmp_lt_u32 s55,64
s_cselect_b32 s78,s78,0x7fff0000
s_add_u32 s60,s63,1
s_lshl_b32 s76,s60,21
s_lshl_b32 s55,s60,13
s_and_b32 s55,s55,0x2000
s_xor_b32 s55,s55,s61
s_add_u32 s76,s76,s55
s_cmp_lt_u32 s60,64
s_cselect_b32 s76,s76,0x7fff0000
s_add_u32 s60,s63,2
s_lshl_b32 s12,s60,21
s_lshl_b32 s55,s60,13
s_and_b32 s55,s55,0x2000
s_xor_b32 s55,s55,s61
s_add_u32 s12,s12,s55
s_cmp_lt_u32 s60,64
s_cselect_b32 s12,s12,0x7fff0000
s_add_u32 s55,s63,5
s_min_u32 s55,s55,63
s_lshl_b32 s55,s55,16
s_lshl_b32 s60,s59,11
s_add_u32 s80,s55,s60
s_add_u32 s80,s80,57344
v_mov_b32 v176,0
v_mov_b32 v177,0
v_mov_b32 v178,0
v_mov_b32 v179,0
v_mov_b32 v180,0
v_mov_b32 v181,0
v_mov_b32 v182,0
v_mov_b32 v183,0
s_add_u32 s79,s79,1
v_add_u32 v25,1,v25
s_waitcnt vmcnt(0)
s_branch loop_134
art_138:
s_sub_u32 s90,s90,1
s_cmp_lt_i32 s90,0
s_cbranch_scc1 abk_139
buffer_load_dwordx4 v[64:67],v28,s[20:23],s70 offen offset:0 sc1
buffer_load_dwordx4 v[68:71],v28,s[20:23],s70 offen offset:1024 sc1
buffer_load_dwordx4 v[72:75],v28,s[20:23],s70 offen offset:2048 sc1
buffer_load_dwordx4 v[76:79],v28,s[20:23],s70 offen offset:3072 sc1
s_waitcnt vmcnt(3)
ds_write_b128 v24,v[64:67] offset:8192
v_min3_u32 v22,v64,v65,v66
v_min_u32 v22,v22,v67
s_waitcnt vmcnt(2)
ds_write_b128 v24,v[68:71] offset:9216
v_min3_u32 v22,v22,v68,v69
v_min3_u32 v22,v22,v70,v71
s_waitcnt vmcnt(1)
ds_write_b128 v24,v[72:75] offset:10240
v_min3_u32 v22,v22,v72,v73
v_min3_u32 v22,v22,v74,v75
s_waitcnt vmcnt(0)
ds_write_b128 v24,v[76:79] offset:11264
v_min3_u32 v22,v22,v76,v77
v_min3_u32 v22,v22,v78,v79
v_cmp_eq_u32 vcc,0,v22
s_cbranch_vccnz art_138
s_branch abk_139
bgsk_141:
s_waitcnt vmcnt(0)
ds_write_b32 v21,v25 offset:28
s_branch bgx_140
late_142:
s_cmp_eq_u32 s79,22
s_cbranch_scc1 lateb_143
v_lshlrev_b32 v184,2,v16
s_mov_b32 s52,21052416
s_mov_b32 s53,1792
s_lshr_b32 s64,s79,4
s_lshl_b32 s64,0x100,s64
s_cmp_eq_u32 s79,2
s_cselect_b32 exec_lo,0xff,s64
s_mov_b32 exec_hi,0
dp_144:
buffer_load_dword v185,v184,s[20:23],s52 offen sc1
s_waitcnt vmcnt(0)
v_cmp_ne_u32 vcc,s53,v185
s_cbranch_vccz dpok_145
s_sleep 2
s_sub_u32 s90,s90,1
s_cmp_gt_i32 s90,0
s_cbranch_scc1 dp_144
dpok_145:
s_mov_b64 exec,-1
s_branch lateb_143
first_133:
s_add_u32 s63,s79,0
s_and_b32 s64,s63,3
s_lshl_b32 s70,s64,20
s_add_u32 s65,s63,2
s_and_b32 s65,s65,3
s_lshl_b32 s73,s65,20
s_add_u32 s55,s63,3
s_lshl_b32 s78,s55,16
s_add_u32 s78,s78,57344
s_cmp_lt_u32 s55,64
s_cselect_b32 s78,s78,0x7fff0000
s_add_u32 s60,s63,1
s_lshl_b32 s76,s60,21
s_lshl_b32 s55,s60,13
s_and_b32 s55,s55,0x2000
s_xor_b32 s55,s55,s61
s_add_u32 s76,s76,s55
s_cmp_lt_u32 s60,64
s_cselect_b32 s76,s76,0x7fff0000
s_add_u32 s60,s63,2
s_lshl_b32 s12,s60,21
s_lshl_b32 s55,s60,13
s_and_b32 s55,s55,0x2000
s_xor_b32 s55,s55,s61
s_add_u32 s12,s12,s55
s_cmp_lt_u32 s60,64
s_cselect_b32 s12,s12,0x7fff0000
s_add_u32 s55,s63,5
s_min_u32 s55,s55,63
s_lshl_b32 s55,s55,16
s_lshl_b32 s60,s59,11
s_add_u32 s80,s55,s60
s_add_u32 s80,s80,57344
v_mov_b32 v176,0
v_mov_b32 v177,0
v_mov_b32 v178,0
v_mov_b32 v179,0
v_mov_b32 v180,0
v_mov_b32 v181,0
v_mov_b32 v182,0
v_mov_b32 v183,0
s_waitcnt vmcnt(0) lgkmcnt(0)
s_barrier
pn1_146:
ds_read_b128 v[64:67],v20 offset:0
ds_read_b128 v[68:71],v20 offset:1024
ds_read_b128 v[72:75],v20 offset:2048
s_waitcnt lgkmcnt(2)
v_mfma_f32_16x16x32_bf16 v[192:195],a[0:3],v[64:67],0
ds_read_b128 v[76:79],v20 offset:3072
v_mfma_f32_16x16x32_bf16 v[200:203],v[64:67],a[128:131],0
s_waitcnt lgkmcnt(2)
v_mfma_f32_16x16x32_bf16 v[196:199],a[0:3],v[68:71],0
ds_read_b128 v[64:67],v20 offset:4096
v_mfma_f32_16x16x32_bf16 v[204:207],v[68:71],a[128:131],0
s_waitcnt lgkmcnt(2)
v_mfma_f32_16x16x32_bf16 v[192:195],a[4:7],v[72:75],v[192:195]
ds_read_b128 v[68:71],v20 offset:5120
v_mfma_f32_16x16x32_bf16 v[200:203],v[72:75],a[132:135],v[200:203]
s_waitcnt lgkmcnt(2)
v_mfma_f32_16x16x32_bf16 v[196:199],a[4:7],v[76:79],v[196:199]
ds_read_b128 v[72:75],v20 offset:6144
v_mfma_f32_16x16x32_bf16 v[204:207],v[76:79],a[132:135],v[204:207]
s_waitcnt lgkmcnt(2)
v_mfma_f32_16x16x32_bf16 v[192:195],a[8:11],v[64:67],v[192:195]
ds_read_b128 v[76:79],v20 offset:7168
v_mfma_f32_16x16x32_bf16 v[200:203],v[64:67],a[136:139],v[200:203]
s_waitcnt lgkmcnt(2)
v_mfma_f32_16x16x32_bf16 v[196:199],a[8:11],v[68:71],v[196:199]
ds_read_b128 v[64:67],v20 offset:8192
v_mfma_f32_16x16x32_bf16 v[204:207],v[68:71],a[136:139],v[204:207]
s_waitcnt lgkmcnt(2)
v_mfma_f32_16x16x32_bf16 v[192:195],a[12:15],v[72:75],v[192:195]
ds_read_b128 v[68:71],v20 offset:9216
v_mfma_f32_16x16x32_bf16 v[200:203],v[72:75],a[140:143],v[200:203]
s_waitcnt lgkmcnt(2)
v_mfma_f32_16x16x32_bf16 v[196:199],a[12:15],v[76:79],v[196:199]
ds_read_b128 v[72:75],v20 offset:10240
v_mfma_f32_16x16x32_bf16 v[204:207],v[76:79],a[140:143],v[204:207]
s_waitcnt lgkmcnt(2)
v_mfma_f32_16x16x32_bf16 v[192:195],a[16:19],v[64:67],v[192:195]
ds_read_b128 v[76:79],v20 offset:11264
v_mfma_f32_16x16x32_bf16 v[200:203],v[64:67],a[144:147],v[200:203]
s_waitcnt lgkmcnt(2)
v_mfma_f32_16x16x32_bf16 v[196:199],a[16:19],v[68:71],v[196:199]
ds_read_b128 v[64:67],v20 offset:12288
v_mfma_f32_16x16x32_bf16 v[204:207],v[68:71],a[144:147],v[204:207]
s_waitcnt lgkmcnt(2)
v_mfma_f32_16x16x32_bf16 v[192:195],a[20:23],v[72:75],v[192:195]
ds_read_b128 v[68:71],v20 offset:13312
v_mfma_f32_16x16x32_bf16 v[200:203],v[72:75],a[148:151],v[200:203]
s_waitcnt lgkmcnt(2)
v_mfma_f32_16x16x32_bf16 v[196:199],a[20:23],v[76:79],v[196:199]
ds_read_b128 v[72:75],v20 offset:14336
v_mfma_f32_16x16x32_bf16 v[204:207],v[76:79],a[148:151],v[204:207]
s_waitcnt lgkmcnt(2)
v_mfma_f32_16x16x32_bf16 v[192:195],a[24:27],v[64:67],v[192:195]
ds_read_b128 v[76:79],v20 offset:15360
v_mfma_f32_16x16x32_bf16 v[200:203],v[64:67],a[152:155],v[200:203]
s_waitcnt lgkmcnt(2)
v_mfma_f32_16x16x32_bf16 v[196:199],a[24:27],v[68:71],v[196:199]
ds_read_b128 v[64:67],v20 offset:16384
v_mfma_f32_16x16x32_bf16 v[204:207],v[68:71],a[152:155],v[204:207]
s_waitcnt lgkmcnt(2)
v_mfma_f32_16x16x32_bf16 v[192:195],a[28:31],v[72:75],v[192:195]
ds_read_b128 v[68:71],v20 offset:17408
v_mfma_f32_16x16x32_bf16 v[200:203],v[72:75],a[156:159],v[200:203]
s_waitcnt lgkmcnt(2)
v_mfma_f32_16x16x32_bf16 v[196:199],a[28:31],v[76:79],v[196:199]
ds_read_b128 v[72:75],v20 offset:18432
v_mfma_f32_16x16x32_bf16 v[204:207],v[76:79],a[156:159],v[204:207]
s_waitcnt lgkmcnt(2)
v_mfma_f32_16x16x32_bf16 v[192:195],a[32:35],v[64:67],v[192:195]
ds_read_b128 v[76:79],v20 offset:19456
v_mfma_f32_16x16x32_bf16 v[200:203],v[64:67],a[160:163],v[200:203]
s_waitcnt lgkmcnt(2)
v_mfma_f32_16x16x32_bf16 v[196:199],a[32:35],v[68:71],v[196:199]
ds_read_b128 v[64:67],v20 offset:20480
v_mfma_f32_16x16x32_bf16 v[204:207],v[68:71],a[160:163],v[204:207]
s_waitcnt lgkmcnt(2)
v_mfma_f32_16x16x32_bf16 v[192:195],a[36:39],v[72:75],v[192:195]
ds_read_b128 v[68:71],v20 offset:21504
v_mfma_f32_16x16x32_bf16 v[200:203],v[72:75],a[164:167],v[200:203]
s_waitcnt lgkmcnt(2)
v_mfma_f32_16x16x32_bf16 v[196:199],a[36:39],v[76:79],v[196:199]
ds_read_b128 v[72:75],v20 offset:22528
v_mfma_f32_16x16x32_bf16 v[204:207],v[76:79],a[164:167],v[204:207]
s_waitcnt lgkmcnt(2)
v_mfma_f32_16x16x32_bf16 v[192:195],a[40:43],v[64:67],v[192:195]
ds_read_b128 v[76:79],v20 offset:23552
v_mfma_f32_16x16x32_bf16 v[200:203],v[64:67],a[168:171],v[200:203]
s_waitcnt lgkmcnt(2)
v_mfma_f32_16x16x32_bf16 v[196:199],a[40:43],v[68:71],v[196:199]
ds_read_b128 v[64:67],v20 offset:24576
v_mfma_f32_16x16x32_bf16 v[204:207],v[68:71],a[168:171],v[204:207]
s_waitcnt lgkmcnt(2)
v_mfma_f32_16x16x32_bf16 v[192:195],a[44:47],v[72:75],v[192:195]
ds_read_b128 v[68:71],v20 offset:25600
v_mfma_f32_16x16x32_bf16 v[200:203],v[72:75],a[172:175],v[200:203]
s_waitcnt lgkmcnt(2)
v_mfma_f32_16x16x32_bf16 v[196:199],a[44:47],v[76:79],v[196:199]
ds_read_b128 v[72:75],v20 offset:26624
v_mfma_f32_16x16x32_bf16 v[204:207],v[76:79],a[172:175],v[204:207]
s_waitcnt lgkmcnt(2)
v_mfma_f32_16x16x32_bf16 v[192:195],a[48:51],v[64:67],v[192:195]
ds_read_b128 v[76:79],v20 offset:27648
v_mfma_f32_16x16x32_bf16 v[200:203],v[64:67],a[176:179],v[200:203]
s_waitcnt lgkmcnt(2)
v_mfma_f32_16x16x32_bf16 v[196:199],a[48:51],v[68:71],v[196:199]
ds_read_b128 v[64:67],v20 offset:28672
v_mfma_f32_16x16x32_bf16 v[204:207],v[68:71],a[176:179],v[204:207]
s_waitcnt lgkmcnt(2)
v_mfma_f32_16x16x32_bf16 v[192:195],a[52:55],v[72:75],v[192:195]
ds_read_b128 v[68:71],v20 offset:29696
v_mfma_f32_16x16x32_bf16 v[200:203],v[72:75],a[180:183],v[200:203]
s_waitcnt lgkmcnt(2)
v_mfma_f32_16x16x32_bf16 v[196:199],a[52:55],v[76:79],v[196:199]
ds_read_b128 v[72:75],v20 offset:30720
v_mfma_f32_16x16x32_bf16 v[204:207],v[76:79],a[180:183],v[204:207]
s_waitcnt lgkmcnt(2)
v_mfma_f32_16x16x32_bf16 v[192:195],a[56:59],v[64:67],v[192:195]
ds_read_b128 v[76:79],v20 offset:31744
v_mfma_f32_16x16x32_bf16 v[200:203],v[64:67],a[184:187],v[200:203]
s_waitcnt lgkmcnt(2)
v_mfma_f32_16x16x32_bf16 v[196:199],a[56:59],v[68:71],v[196:199]
ds_read_b128 v[64:67],v20 offset:32768
v_mfma_f32_16x16x32_bf16 v[204:207],v[68:71],a[184:187],v[204:207]
s_waitcnt lgkmcnt(2)
v_mfma_f32_16x16x32_bf16 v[192:195],a[60:63],v[72:75],v[192:195]
ds_read_b128 v[68:71],v20 offset:33792
v_mfma_f32_16x16x32_bf16 v[200:203],v[72:75],a[188:191],v[200:203]
s_waitcnt lgkmcnt(2)
v_mfma_f32_16x16x32_bf16 v[196:199],a[60:63],v[76:79],v[196:199]
ds_read_b128 v[72:75],v20 offset:34816
v_mfma_f32_16x16x32_bf16 v[204:207],v[76:79],a[188:191],v[204:207]
s_waitcnt lgkmcnt(2)
v_mfma_f32_16x16x32_bf16 v[192:195],a[64:67],v[64:67],v[192:195]
ds_read_b128 v[76:79],v20 offset:35840
v_mfma_f32_16x16x32_bf16 v[200:203],v[64:67],a[192:195],v[200:203]
s_waitcnt lgkmcnt(2)
v_mfma_f32_16x16x32_bf16 v[196:199],a[64:67],v[68:71],v[196:199]
ds_read_b128 v[64:67],v20 offset:36864
v_mfma_f32_16x16x32_bf16 v[204:207],v[68:71],a[192:195],v[204:207]
s_waitcnt lgkmcnt(2)
v_mfma_f32_16x16x32_bf16 v[192:195],a[68:71],v[72:75],v[192:195]
ds_read_b128 v[68:71],v20 offset:37888
v_mfma_f32_16x16x32_bf16 v[200:203],v[72:75],a[196:199],v[200:203]
s_waitcnt lgkmcnt(2)
v_mfma_f32_16x16x32_bf16 v[196:199],a[68:71],v[76:79],v[196:199]
ds_read_b128 v[72:75],v20 offset:38912
v_mfma_f32_16x16x32_bf16 v[204:207],v[76:79],a[196:199],v[204:207]
s_waitcnt lgkmcnt(2)
v_mfma_f32_16x16x32_bf16 v[192:195],a[72:75],v[64:67],v[192:195]
ds_read_b128 v[76:79],v20 offset:39936
v_mfma_f32_16x16x32_bf16 v[200:203],v[64:67],a[200:203],v[200:203]
s_waitcnt lgkmcnt(2)
v_mfma_f32_16x16x32_bf16 v[196:199],a[72:75],v[68:71],v[196:199]
ds_read_b128 v[64:67],v20 offset:40960
v_mfma_f32_16x16x32_bf16 v[204:207],v[68:71],a[200:203],v[204:207]
s_waitcnt lgkmcnt(2)
v_mfma_f32_16x16x32_bf16 v[192:195],a[76:79],v[72:75],v[192:195]
ds_read_b128 v[68:71],v20 offset:41984
v_mfma_f32_16x16x32_bf16 v[200:203],v[72:75],a[204:207],v[200:203]
s_waitcnt lgkmcnt(2)
v_mfma_f32_16x16x32_bf16 v[196:199],a[76:79],v[76:79],v[196:199]
ds_read_b128 v[72:75],v20 offset:43008
v_mfma_f32_16x16x32_bf16 v[204:207],v[76:79],a[204:207],v[204:207]
s_waitcnt lgkmcnt(2)
v_mfma_f32_16x16x32_bf16 v[192:195],a[80:83],v[64:67],v[192:195]
ds_read_b128 v[76:79],v20 offset:44032
v_mfma_f32_16x16x32_bf16 v[200:203],v[64:67],a[208:211],v[200:203]
s_waitcnt lgkmcnt(2)
v_mfma_f32_16x16x32_bf16 v[196:199],a[80:83],v[68:71],v[196:199]
ds_read_b128 v[64:67],v20 offset:45056
v_mfma_f32_16x16x32_bf16 v[204:207],v[68:71],a[208:211],v[204:207]
s_waitcnt lgkmcnt(2)
v_mfma_f32_16x16x32_bf16 v[192:195],a[84:87],v[72:75],v[192:195]
ds_read_b128 v[68:71],v20 offset:46080
v_mfma_f32_16x16x32_bf16 v[200:203],v[72:75],a[212:215],v[200:203]
s_waitcnt lgkmcnt(2)
v_mfma_f32_16x16x32_bf16 v[196:199],a[84:87],v[76:79],v[196:199]
ds_read_b128 v[72:75],v20 offset:47104
v_mfma_f32_16x16x32_bf16 v[204:207],v[76:79],a[212:215],v[204:207]
s_waitcnt lgkmcnt(2)
v_mfma_f32_16x16x32_bf16 v[192:195],a[88:91],v[64:67],v[192:195]
ds_read_b128 v[76:79],v20 offset:48128
v_mfma_f32_16x16x32_bf16 v[200:203],v[64:67],a[216:219],v[200:203]
s_waitcnt lgkmcnt(2)
v_mfma_f32_16x16x32_bf16 v[196:199],a[88:91],v[68:71],v[196:199]
ds_read_b128 v[64:67],v20 offset:49152
v_mfma_f32_16x16x32_bf16 v[204:207],v[68:71],a[216:219],v[204:207]
s_waitcnt lgkmcnt(2)
v_mfma_f32_16x16x32_bf16 v[192:195],a[92:95],v[72:75],v[192:195]
ds_read_b128 v[68:71],v20 offset:50176
v_mfma_f32_16x16x32_bf16 v[200:203],v[72:75],a[220:223],v[200:203]
s_waitcnt lgkmcnt(2)
v_mfma_f32_16x16x32_bf16 v[196:199],a[92:95],v[76:79],v[196:199]
ds_read_b128 v[72:75],v20 offset:51200
v_mfma_f32_16x16x32_bf16 v[204:207],v[76:79],a[220:223],v[204:207]
s_waitcnt lgkmcnt(2)
v_mfma_f32_16x16x32_bf16 v[192:195],a[96:99],v[64:67],v[192:195]
ds_read_b128 v[76:79],v20 offset:52224
v_mfma_f32_16x16x32_bf16 v[200:203],v[64:67],a[224:227],v[200:203]
s_waitcnt lgkmcnt(2)
v_mfma_f32_16x16x32_bf16 v[196:199],a[96:99],v[68:71],v[196:199]
ds_read_b128 v[64:67],v20 offset:53248
v_mfma_f32_16x16x32_bf16 v[204:207],v[68:71],a[224:227],v[204:207]
s_waitcnt lgkmcnt(2)
v_mfma_f32_16x16x32_bf16 v[192:195],a[100:103],v[72:75],v[192:195]
ds_read_b128 v[68:71],v20 offset:54272
v_mfma_f32_16x16x32_bf16 v[200:203],v[72:75],a[228:231],v[200:203]
s_waitcnt lgkmcnt(2)
v_mfma_f32_16x16x32_bf16 v[196:199],a[100:103],v[76:79],v[196:199]
ds_read_b128 v[72:75],v20 offset:55296
v_mfma_f32_16x16x32_bf16 v[204:207],v[76:79],a[228:231],v[204:207]
s_waitcnt lgkmcnt(2)
v_mfma_f32_16x16x32_bf16 v[192:195],a[104:107],v[64:67],v[192:195]
ds_read_b128 v[76:79],v20 offset:56320
v_mfma_f32_16x16x32_bf16 v[200:203],v[64:67],a[232:235],v[200:203]
s_waitcnt lgkmcnt(2)
v_mfma_f32_16x16x32_bf16 v[196:199],a[104:107],v[68:71],v[196:199]
ds_read_b128 v[64:67],v20 offset:57344
v_mfma_f32_16x16x32_bf16 v[204:207],v[68:71],a[232:235],v[204:207]
s_waitcnt lgkmcnt(2)
v_mfma_f32_16x16x32_bf16 v[192:195],a[108:111],v[72:75],v[192:195]
ds_read_b128 v[68:71],v20 offset:58368
v_mfma_f32_16x16x32_bf16 v[200:203],v[72:75],a[236:239],v[200:203]
s_waitcnt lgkmcnt(2)
v_mfma_f32_16x16x32_bf16 v[196:199],a[108:111],v[76:79],v[196:199]
ds_read_b128 v[72:75],v20 offset:59392
v_mfma_f32_16x16x32_bf16 v[204:207],v[76:79],a[236:239],v[204:207]
s_waitcnt lgkmcnt(2)
v_mfma_f32_16x16x32_bf16 v[192:195],a[112:115],v[64:67],v[192:195]
ds_read_b128 v[76:79],v20 offset:60416
v_mfma_f32_16x16x32_bf16 v[200:203],v[64:67],a[240:243],v[200:203]
s_waitcnt lgkmcnt(2)
v_mfma_f32_16x16x32_bf16 v[196:199],a[112:115],v[68:71],v[196:199]
ds_read_b128 v[64:67],v20 offset:61440
v_mfma_f32_16x16x32_bf16 v[204:207],v[68:71],a[240:243],v[204:207]
s_waitcnt lgkmcnt(2)
v_mfma_f32_16x16x32_bf16 v[192:195],a[116:119],v[72:75],v[192:195]
ds_read_b128 v[68:71],v20 offset:62464
v_mfma_f32_16x16x32_bf16 v[200:203],v[72:75],a[244:247],v[200:203]
s_waitcnt lgkmcnt(2)
v_mfma_f32_16x16x32_bf16 v[196:199],a[116:119],v[76:79],v[196:199]
ds_read_b128 v[72:75],v20 offset:63488
v_mfma_f32_16x16x32_bf16 v[204:207],v[76:79],a[244:247],v[204:207]
s_waitcnt lgkmcnt(2)
v_mfma_f32_16x16x32_bf16 v[192:195],a[120:123],v[64:67],v[192:195]
ds_read_b128 v[76:79],v20 offset:64512
v_mfma_f32_16x16x32_bf16 v[200:203],v[64:67],a[248:251],v[200:203]
s_waitcnt lgkmcnt(2)
v_mfma_f32_16x16x32_bf16 v[196:199],a[120:123],v[68:71],v[196:199]
v_mfma_f32_16x16x32_bf16 v[204:207],v[68:71],a[248:251],v[204:207]
s_waitcnt lgkmcnt(1)
v_mfma_f32_16x16x32_bf16 v[192:195],a[124:127],v[72:75],v[192:195]
v_mfma_f32_16x16x32_bf16 v[200:203],v[72:75],a[252:255],v[200:203]
s_waitcnt lgkmcnt(0)
v_mfma_f32_16x16x32_bf16 v[196:199],a[124:127],v[76:79],v[196:199]
v_mfma_f32_16x16x32_bf16 v[204:207],v[76:79],a[252:255],v[204:207]
v_xor_b32 v20,0x10000,v20
s_xor_b32 s62,s62,0x10000
s_lshr_b32 s64,s73,9
v_add_u32 v22,s64,v24
v_cvt_pk_bf16_f32 v208,v192,v193
v_cvt_pk_bf16_f32 v209,v194,v195
s_nop 0
v_cvt_pk_bf16_f32 v210,v196,v197
v_cvt_pk_bf16_f32 v211,v198,v199
v_cvt_pk_bf16_f32 v212,v200,v201
v_cvt_pk_bf16_f32 v213,v202,v203
v_cvt_pk_bf16_f32 v214,v204,v205
v_cvt_pk_bf16_f32 v215,v206,v207
v_permlane16_swap_b32 v208,v210
v_permlane16_swap_b32 v209,v211
buffer_store_dwordx4 v[208:211],v2,s[24:27],s73 offen
buffer_store_dwordx4 v[208:211],v2,s[28:31],s73 offen sc1
ds_write_b128 v22,v[212:215] offset:17408
buffer_store_dwordx4 v[208:211],v17,s[20:23],s12 offen sc1
bgx_148:
s_add_u32 s63,s79,1
s_and_b32 s64,s63,3
s_lshl_b32 s70,s64,20
s_add_u32 s65,s63,2
s_and_b32 s65,s65,3
s_lshl_b32 s73,s65,20
s_add_u32 s55,s63,3
s_lshl_b32 s78,s55,16
s_add_u32 s78,s78,57344
s_cmp_lt_u32 s55,64
s_cselect_b32 s78,s78,0x7fff0000
s_add_u32 s60,s63,1
s_lshl_b32 s76,s60,21
s_lshl_b32 s55,s60,13
s_and_b32 s55,s55,0x2000
s_xor_b32 s55,s55,s61
s_add_u32 s76,s76,s55
s_cmp_lt_u32 s60,64
s_cselect_b32 s76,s76,0x7fff0000
s_add_u32 s60,s63,2
s_lshl_b32 s12,s60,21
s_lshl_b32 s55,s60,13
s_and_b32 s55,s55,0x2000
s_xor_b32 s55,s55,s61
s_add_u32 s12,s12,s55
s_cmp_lt_u32 s60,64
s_cselect_b32 s12,s12,0x7fff0000
s_add_u32 s55,s63,5
s_min_u32 s55,s55,63
s_lshl_b32 s55,s55,16
s_lshl_b32 s60,s59,11
s_add_u32 s80,s55,s60
s_add_u32 s80,s80,57344
v_mov_b32 v176,0
v_mov_b32 v177,0
v_mov_b32 v178,0
v_mov_b32 v179,0
v_mov_b32 v180,0
v_mov_b32 v181,0
v_mov_b32 v182,0
v_mov_b32 v183,0
s_add_u32 s79,s79,1
s_cmp_eq_u32 s79,0
s_cbranch_scc1 pn2_147
v_mov_b32 v38,1
ds_write_b32 v37,v38 offset:12
buffer_store_dwordx4 v[212:215],v12,s[20:23],s76 offen sc1
s_waitcnt lgkmcnt(0)
s_branch pn1_146
pn2_147:
v_mov_b32 v25,1
s_waitcnt vmcnt(1) lgkmcnt(0)
s_barrier
s_branch loop_134
w3_61:
v_xor_b32 v9,0x10000,v8
v_xor_b32 v10,0x20000,v8
v_xor_b32 v11,0x30000,v8
v_and_b32 v22,2,v4
v_lshrrev_b32 v23,3,v3
v_add_u32 v22,v22,v23
v_lshlrev_b32 v22,3,v22
v_and_b32 v23,1,v4
v_lshl_add_u32 v22,v23,2,v22
v_and_b32 v23,3,v3
v_add_u32 v22,v22,v23
v_lshlrev_b32 v22,4,v22
v_bfe_u32 v23,v3,2,1
v_lshl_add_u32 v22,v23,3,v22
v_add_u32 v30,s66,v22
v_and_b32 v22,7,v3
v_lshl_add_u32 v12,v4,3,v22
v_lshlrev_b32 v12,4,v12
v_add_u32 v12,s66,v12
s_branch first_149
loop_150:
s_barrier
buffer_load_dword v248,v18,s[20:23],s70 offen offset:0 sc1
s_nop 15
s_nop 5
hl_152:
buffer_load_dword v249,v18,s[20:23],s70 offen offset:0 sc1
s_waitcnt vmcnt(1)
v_cmp_eq_u32 vcc,v25,v248
s_bcnt1_i32_b32 s64,vcc_lo
s_cmp_ge_u32 s64,8
s_cbranch_scc1 hg_153
buffer_load_dword v248,v18,s[20:23],s70 offen offset:0 sc1
s_waitcnt vmcnt(1)
v_cmp_eq_u32 vcc,v25,v249
s_bcnt1_i32_b32 s64,vcc_lo
s_cmp_ge_u32 s64,8
s_cbranch_scc1 hg_153
s_sub_u32 s90,s90,1
s_cmp_gt_i32 s90,0
s_cbranch_scc1 hl_152
hg_153:
buffer_load_dwordx4 v[80:83],v29,s[20:23],s70 offen offset:0 sc1
buffer_load_dwordx4 v[84:87],v29,s[20:23],s70 offen offset:1024 sc1
buffer_load_dwordx4 v[88:91],v29,s[20:23],s70 offen offset:2048 sc1
buffer_load_dwordx4 v[92:95],v29,s[20:23],s70 offen offset:3072 sc1
s_waitcnt vmcnt(3)
ds_write_b128 v24,v[80:83] offset:12288
v_min3_u32 v22,v80,v81,v82
v_min_u32 v22,v22,v83
s_waitcnt vmcnt(2)
ds_write_b128 v24,v[84:87] offset:13312
v_min3_u32 v22,v22,v84,v85
v_min3_u32 v22,v22,v86,v87
s_waitcnt vmcnt(1)
ds_write_b128 v24,v[88:91] offset:14336
v_min3_u32 v22,v22,v88,v89
v_min3_u32 v22,v22,v90,v91
s_waitcnt vmcnt(0)
ds_write_b128 v24,v[92:95] offset:15360
v_min3_u32 v22,v22,v92,v93
v_min3_u32 v22,v22,v94,v95
v_cmp_eq_u32 vcc,0,v22
s_cbranch_vccnz art_154
abk_155:
v_smfmac_f32_16x16x64_bf16 v[176:179],v[80:83],a[96:103],v14
s_waitcnt lgkmcnt(0)
s_barrier
ds_read_b128 v[32:35],v24 offset:0
ds_read_b128 v[36:39],v24 offset:1024
ds_read_b128 v[40:43],v24 offset:2048
ds_read_b128 v[44:47],v24 offset:3072
v_smfmac_f32_16x16x64_bf16 v[176:179],v[84:87],a[104:111],v14
ds_read_b128 v[48:51],v24 offset:4096
ds_read_b128 v[52:55],v24 offset:5120
v_smfmac_f32_16x16x64_bf16 v[176:179],v[88:91],a[112:119],v14
ds_read_b128 v[56:59],v24 offset:6144
ds_read_b128 v[60:63],v24 offset:7168
v_smfmac_f32_16x16x64_bf16 v[176:179],v[92:95],a[120:127],v14
ds_read_b128 v[64:67],v24 offset:8192
ds_read_b128 v[68:71],v24 offset:9216
s_waitcnt lgkmcnt(9)
v_smfmac_f32_16x16x64_bf16 v[176:179],v[32:35],a[0:7],v14
ds_read_b128 v[72:75],v24 offset:10240
s_waitcnt lgkmcnt(9)
v_smfmac_f32_16x16x64_bf16 v[176:179],v[36:39],a[8:15],v14
ds_read_b128 v[76:79],v24 offset:11264
s_waitcnt lgkmcnt(9)
v_smfmac_f32_16x16x64_bf16 v[176:179],v[40:43],a[16:23],v14
s_waitcnt lgkmcnt(8)
v_smfmac_f32_16x16x64_bf16 v[176:179],v[44:47],a[24:31],v14
s_waitcnt lgkmcnt(7)
v_smfmac_f32_16x16x64_bf16 v[176:179],v[48:51],a[32:39],v14
s_waitcnt lgkmcnt(6)
v_smfmac_f32_16x16x64_bf16 v[176:179],v[52:55],a[40:47],v14
s_waitcnt lgkmcnt(5)
v_smfmac_f32_16x16x64_bf16 v[176:179],v[56:59],a[48:55],v14
s_waitcnt lgkmcnt(4)
v_smfmac_f32_16x16x64_bf16 v[176:179],v[60:63],a[56:63],v14
s_waitcnt lgkmcnt(3)
v_smfmac_f32_16x16x64_bf16 v[176:179],v[64:67],a[64:71],v14
s_waitcnt lgkmcnt(2)
v_smfmac_f32_16x16x64_bf16 v[176:179],v[68:71],a[72:79],v14
s_waitcnt lgkmcnt(1)
v_smfmac_f32_16x16x64_bf16 v[176:179],v[72:75],a[80:87],v14
s_waitcnt lgkmcnt(0)
v_smfmac_f32_16x16x64_bf16 v[176:179],v[76:79],a[88:95],v14
s_nop 7
v_permlane32_swap_b32 v176,v178
v_permlane32_swap_b32 v177,v179
v_add_f32 v176,v176,v178
v_add_f32 v177,v177,v179
v_cvt_pk_bf16_f32 v216,v176,v177
s_nop 1
v_mov_b32_dpp v217,v216 quad_perm:[1,0,3,2] row_mask:0xf bank_mask:0xf
v_perm_b32 v216,v217,v216,v15
v_max_u32 v216,1,v216
buffer_store_dword v216,v19,s[24:27],s70 offen
buffer_store_dword v216,v19,s[28:31],s70 offen sc1
s_cmp_eq_u32 s79,63
s_cbranch_scc1 end_57
s_nop 15
s_nop 15
s_nop 15
s_nop 15
s_nop 10
s_add_u32 m0,s62,53248
s_add_u32 s69,s78,53248
buffer_load_dwordx4 v16,s[20:23],s69 offen offset:0 lds
s_nop 3
buffer_load_dwordx4 v16,s[20:23],s69 offen offset:1024 lds
s_nop 3
buffer_load_dwordx4 v16,s[20:23],s69 offen offset:2048 lds
s_nop 3
buffer_load_dwordx4 v16,s[20:23],s69 offen offset:3072 lds
s_nop 3
s_add_u32 m0,s62,57344
s_add_u32 s69,s78,57344
buffer_load_dwordx4 v16,s[20:23],s69 offen offset:0 lds
s_nop 3
buffer_load_dwordx4 v16,s[20:23],s69 offen offset:1024 lds
s_nop 3
buffer_load_dwordx4 v16,s[20:23],s69 offen offset:2048 lds
s_nop 3
buffer_load_dwordx4 v16,s[20:23],s69 offen offset:3072 lds
s_nop 3
s_add_u32 m0,s62,61440
s_add_u32 s69,s78,61440
buffer_load_dwordx4 v16,s[20:23],s69 offen offset:0 lds
s_nop 3
buffer_load_dwordx4 v16,s[20:23],s69 offen offset:1024 lds
s_nop 3
buffer_load_dwordx4 v16,s[20:23],s69 offen offset:2048 lds
s_nop 3
buffer_load_dwordx4 v16,s[20:23],s69 offen offset:3072 lds
s_nop 3
s_xor_b32 s62,s62,0x10000
wf_156:
ds_read_b32 v23,v21 offset:8
s_sub_u32 s90,s90,1
s_waitcnt lgkmcnt(0)
v_cmp_ne_u32 vcc,v23,v25
s_cmp_lt_i32 s90,0
s_cselect_b64 vcc,0,vcc
s_cbranch_vccnz wf_156
hl_157:
buffer_load_dword v248,v18,s[20:23],s70 offen offset:512 sc1
s_waitcnt vmcnt(0)
v_cmp_eq_u32 vcc,v25,v248
s_bcnt1_i32_b32 s64,vcc_lo
s_cmp_ge_u32 s64,16
s_cbranch_scc1 hg_158
s_sub_u32 s90,s90,1
s_cmp_gt_i32 s90,0
s_cbranch_scc1 hl_157
hg_158:
buffer_load_dwordx4 v[32:35],v28,s[20:23],s71 offen offset:0 sc1
buffer_load_dwordx4 v[36:39],v28,s[20:23],s71 offen offset:1024 sc1
buffer_load_dwordx4 v[40:43],v28,s[20:23],s71 offen offset:2048 sc1
buffer_load_dwordx4 v[44:47],v28,s[20:23],s71 offen offset:3072 sc1
buffer_load_dwordx4 v[48:51],v29,s[20:23],s71 offen offset:0 sc1
buffer_load_dwordx4 v[52:55],v29,s[20:23],s71 offen offset:1024 sc1
buffer_load_dwordx4 v[56:59],v29,s[20:23],s71 offen offset:2048 sc1
buffer_load_dwordx4 v[60:63],v29,s[20:23],s71 offen offset:3072 sc1
s_mov_b32 s68,0
s_waitcnt vmcnt(6)
v_smfmac_f32_16x16x64_bf16 v[184:187],v[32:35],a[128:135],v14
v_min3_u32 v22,v32,v33,v34
v_min3_u32 v22,v22,v35,v36
v_smfmac_f32_16x16x64_bf16 v[188:191],v[32:35],a[136:143],v14
v_min3_u32 v22,v22,v37,v38
v_smfmac_f32_16x16x64_bf16 v[184:187],v[36:39],a[144:151],v14
v_min_u32 v22,v22,v39
v_smfmac_f32_16x16x64_bf16 v[188:191],v[36:39],a[152:159],v14
v_cmp_eq_u32 s[52:53],0,v22
s_waitcnt vmcnt(4)
v_smfmac_f32_16x16x64_bf16 v[184:187],v[40:43],a[160:167],v14
v_min3_u32 v22,v40,v41,v42
s_cmp_lg_u64 s[52:53],0
v_smfmac_f32_16x16x64_bf16 v[188:191],v[40:43],a[168:175],v14
s_cbranch_scc1 ms_159
bk_160:
v_min3_u32 v22,v22,v43,v44
v_smfmac_f32_16x16x64_bf16 v[184:187],v[44:47],a[176:183],v14
v_min3_u32 v22,v22,v45,v46
v_min_u32 v22,v22,v47
v_smfmac_f32_16x16x64_bf16 v[188:191],v[44:47],a[184:191],v14
v_cmp_eq_u32 s[54:55],0,v22
s_waitcnt vmcnt(2)
v_smfmac_f32_16x16x64_bf16 v[184:187],v[48:51],a[192:199],v14
v_min3_u32 v22,v48,v49,v50
s_cmp_lg_u64 s[54:55],0
v_smfmac_f32_16x16x64_bf16 v[188:191],v[48:51],a[200:207],v14
s_cbranch_scc1 ms_161
bk_162:
v_min3_u32 v22,v22,v51,v52
v_smfmac_f32_16x16x64_bf16 v[184:187],v[52:55],a[208:215],v14
v_min3_u32 v22,v22,v53,v54
v_min_u32 v22,v22,v55
v_smfmac_f32_16x16x64_bf16 v[188:191],v[52:55],a[216:223],v14
v_cmp_eq_u32 s[52:53],0,v22
s_waitcnt vmcnt(0)
v_smfmac_f32_16x16x64_bf16 v[184:187],v[56:59],a[224:231],v14
v_min3_u32 v22,v56,v57,v58
s_cmp_lg_u64 s[52:53],0
v_smfmac_f32_16x16x64_bf16 v[188:191],v[56:59],a[232:239],v14
s_cbranch_scc1 ms_163
bk_164:
v_min3_u32 v22,v22,v59,v60
v_smfmac_f32_16x16x64_bf16 v[184:187],v[60:63],a[240:247],v14
v_min3_u32 v22,v22,v61,v62
v_min_u32 v22,v22,v63
v_smfmac_f32_16x16x64_bf16 v[188:191],v[60:63],a[248:255],v14
v_cmp_eq_u32 s[54:55],0,v22
s_cmp_lg_u64 s[54:55],0
s_cbranch_scc1 ms_167
bk_168:
s_cmp_lg_u32 s68,0
s_cbranch_scc1 rl2_169
fin_165:
s_nop 2
v_permlane32_swap_b32 v184,v188
v_permlane32_swap_b32 v185,v189
v_permlane32_swap_b32 v186,v190
v_permlane32_swap_b32 v187,v191
v_pk_add_f32 v[184:185],v[184:185],v[188:189]
v_pk_add_f32 v[186:187],v[186:187],v[190:191]
wf_170:
ds_read_b32 v23,v21 offset:12
ds_read_b128 v[216:219],v24 offset:25600
s_sub_u32 s90,s90,1
s_waitcnt lgkmcnt(0)
v_cmp_ne_u32 vcc,v23,v25
s_cmp_lt_i32 s90,0
s_cselect_b64 vcc,0,vcc
v_pk_add_f32 v[216:217],v[216:217],v[184:185]
v_pk_add_f32 v[218:219],v[218:219],v[186:187]
s_cbranch_vccnz wf_170
v_max_u32 v216,1,v216
v_max_u32 v217,1,v217
v_max_u32 v218,1,v218
v_max_u32 v219,1,v219
buffer_store_dwordx4 v[216:219],v8,s[20:23],s74 offen sc1
s_mov_b32 s88,s74
s_mov_b32 s89,s72
v_add_u32 v25,1,v25
s_add_u32 s63,s79,1
s_and_b32 s64,s63,3
s_lshl_b32 s70,s64,20
s_add_u32 s65,s63,2
s_and_b32 s65,s65,3
s_lshl_b32 s73,s65,20
s_add_u32 s55,s63,3
s_lshl_b32 s78,s55,16
s_add_u32 s78,s78,57344
s_cmp_lt_u32 s55,64
s_cselect_b32 s78,s78,0x7fff0000
s_add_u32 s71,s70,65536
s_add_u32 s60,s63,1
s_and_b32 s60,s60,3
s_lshl_b32 s72,s60,20
v_mov_b32 v184,0
v_mov_b32 v185,0
v_mov_b32 v186,0
v_mov_b32 v187,0
v_mov_b32 v188,0
v_mov_b32 v189,0
v_mov_b32 v190,0
v_mov_b32 v191,0
s_lshl_b32 s74,s63,21
s_lshl_b32 s55,s63,13
s_and_b32 s55,s55,0x2000
s_xor_b32 s55,s55,s61
s_add_u32 s74,s74,s55
v_mov_b32 v176,0
v_mov_b32 v177,0
v_mov_b32 v178,0
v_mov_b32 v179,0
s_nop 15
s_nop 15
s_nop 15
s_nop 15
s_nop 5
pp_171:
buffer_load_dwordx4 v[32:35],v9,s[20:23],s88 offen sc1
buffer_load_dwordx4 v[36:39],v10,s[20:23],s88 offen sc1
buffer_load_dwordx4 v[40:43],v11,s[20:23],s88 offen sc1
s_waitcnt vmcnt(2)
v_min3_u32 v22,v32,v33,v34
v_pk_add_f32 v[220:221],v[216:217],v[32:33]
v_pk_add_f32 v[222:223],v[218:219],v[34:35]
s_waitcnt vmcnt(0)
v_min3_u32 v22,v22,v35,v36
v_min3_u32 v22,v22,v37,v38
v_min3_u32 v22,v22,v39,v40
v_min3_u32 v22,v22,v41,v42
v_min_u32 v22,v22,v43
v_pk_add_f32 v[36:37],v[36:37],v[40:41]
v_cmp_eq_u32 vcc,0,v22
v_pk_add_f32 v[38:39],v[38:39],v[42:43]
s_cbranch_vccz pok_172
s_sub_u32 s90,s90,1
s_cmp_gt_i32 s90,0
s_cbranch_scc1 pp_171
pok_172:
v_pk_add_f32 v[220:221],v[220:221],v[36:37]
v_pk_add_f32 v[222:223],v[222:223],v[38:39]
s_mov_b64 vcc,s[86:87]
v_cvt_pk_bf16_f32 v216,v220,v221
v_cvt_pk_bf16_f32 v217,v222,v223
s_nop 0
v_mov_b32_dpp v218,v216 quad_perm:[1,0,3,2] row_mask:0xf bank_mask:0xf
v_mov_b32_dpp v219,v217 quad_perm:[1,0,3,2] row_mask:0xf bank_mask:0xf
v_perm_b32 v216,v218,v216,v15
v_perm_b32 v217,v219,v217,v15
s_nop 1
v_cndmask_b32_dpp v220,v217,v216,vcc quad_perm:[2,3,0,1] row_mask:0xf bank_mask:0xf
s_not_b64 vcc,vcc
v_cndmask_b32_dpp v221,v216,v217,vcc quad_perm:[2,3,0,1] row_mask:0xf bank_mask:0xf
v_max_u32 v220,1,v220
v_max_u32 v221,1,v221
buffer_store_dwordx2 v[220:221],v30,s[24:27],s89 offen
buffer_store_dwordx2 v[220:221],v30,s[28:31],s89 offen sc1
s_mov_b64 exec,1
buffer_store_dword v25,v13,s[24:27],s89 offen
buffer_store_dword v25,v13,s[28:31],s89 offen sc1
s_mov_b64 exec,-1
s_add_u32 s79,s79,1
s_branch loop_150
art_154:
s_sub_u32 s90,s90,1
s_cmp_lt_i32 s90,0
s_cbranch_scc1 abk_155
buffer_load_dwordx4 v[80:83],v29,s[20:23],s70 offen offset:0 sc1
buffer_load_dwordx4 v[84:87],v29,s[20:23],s70 offen offset:1024 sc1
buffer_load_dwordx4 v[88:91],v29,s[20:23],s70 offen offset:2048 sc1
buffer_load_dwordx4 v[92:95],v29,s[20:23],s70 offen offset:3072 sc1
s_waitcnt vmcnt(3)
ds_write_b128 v24,v[80:83] offset:12288
v_min3_u32 v22,v80,v81,v82
v_min_u32 v22,v22,v83
s_waitcnt vmcnt(2)
ds_write_b128 v24,v[84:87] offset:13312
v_min3_u32 v22,v22,v84,v85
v_min3_u32 v22,v22,v86,v87
s_waitcnt vmcnt(1)
ds_write_b128 v24,v[88:91] offset:14336
v_min3_u32 v22,v22,v88,v89
v_min3_u32 v22,v22,v90,v91
s_waitcnt vmcnt(0)
ds_write_b128 v24,v[92:95] offset:15360
v_min3_u32 v22,v22,v92,v93
v_min3_u32 v22,v22,v94,v95
v_cmp_eq_u32 vcc,0,v22
s_cbranch_vccnz art_154
s_branch abk_155
ms_159:
s_waitcnt vmcnt(0)
buffer_load_dwordx4 v[64:67],v28,s[20:23],s71 offen offset:0 sc1
buffer_load_dwordx4 v[68:71],v28,s[20:23],s71 offen offset:1024 sc1
s_bitset1_b32 s68,0
s_branch bk_160
ms_161:
s_waitcnt vmcnt(0)
buffer_load_dwordx4 v[72:75],v28,s[20:23],s71 offen offset:2048 sc1
buffer_load_dwordx4 v[76:79],v28,s[20:23],s71 offen offset:3072 sc1
s_bitset1_b32 s68,1
s_branch bk_162
ms_163:
s_waitcnt vmcnt(0)
buffer_load_dwordx4 v[80:83],v29,s[20:23],s71 offen offset:0 sc1
buffer_load_dwordx4 v[84:87],v29,s[20:23],s71 offen offset:1024 sc1
s_bitset1_b32 s68,2
s_branch bk_164
ms_167:
s_waitcnt vmcnt(0)
buffer_load_dwordx4 v[88:91],v29,s[20:23],s71 offen offset:2048 sc1
buffer_load_dwordx4 v[92:95],v29,s[20:23],s71 offen offset:3072 sc1
s_bitset1_b32 s68,3
s_branch bk_168
rl_166:
s_bitcmp1_b32 s68,0
s_cbranch_scc0 sk_173
buffer_load_dwordx4 v[64:67],v28,s[20:23],s71 offen offset:0 sc1
buffer_load_dwordx4 v[68:71],v28,s[20:23],s71 offen offset:1024 sc1
sk_173:
s_bitcmp1_b32 s68,1
s_cbranch_scc0 sk_174
buffer_load_dwordx4 v[72:75],v28,s[20:23],s71 offen offset:2048 sc1
buffer_load_dwordx4 v[76:79],v28,s[20:23],s71 offen offset:3072 sc1
sk_174:
s_bitcmp1_b32 s68,2
s_cbranch_scc0 sk_175
buffer_load_dwordx4 v[80:83],v29,s[20:23],s71 offen offset:0 sc1
buffer_load_dwordx4 v[84:87],v29,s[20:23],s71 offen offset:1024 sc1
sk_175:
s_bitcmp1_b32 s68,3
s_cbranch_scc0 sk_176
buffer_load_dwordx4 v[88:91],v29,s[20:23],s71 offen offset:2048 sc1
buffer_load_dwordx4 v[92:95],v29,s[20:23],s71 offen offset:3072 sc1
sk_176:
rl2_169:
s_sub_u32 s90,s90,1
s_cmp_lt_i32 s90,0
s_cbranch_scc1 fin_165
s_waitcnt vmcnt(0)
s_bitcmp1_b32 s68,0
s_cbranch_scc0 sk_177
v_min3_u32 v22,v64,v65,v66
v_min3_u32 v22,v22,v67,v68
v_min3_u32 v22,v22,v69,v70
v_min_u32 v22,v22,v71
v_cmp_eq_u32 vcc,0,v22
v_xor_b32 v64,v32,v64
v_xor_b32 v65,v33,v65
v_xor_b32 v66,v34,v66
v_xor_b32 v67,v35,v67
v_xor_b32 v68,v36,v68
v_xor_b32 v69,v37,v69
v_xor_b32 v70,v38,v70
v_xor_b32 v71,v39,v71
s_cbranch_vccnz nb_178
s_bitset0_b32 s68,0
v_smfmac_f32_16x16x64_bf16 v[184:187],v[64:67],a[128:135],v14
v_smfmac_f32_16x16x64_bf16 v[188:191],v[64:67],a[136:143],v14
v_smfmac_f32_16x16x64_bf16 v[184:187],v[68:71],a[144:151],v14
v_smfmac_f32_16x16x64_bf16 v[188:191],v[68:71],a[152:159],v14
nb_178:
sk_177:
s_bitcmp1_b32 s68,1
s_cbranch_scc0 sk_179
v_min3_u32 v22,v72,v73,v74
v_min3_u32 v22,v22,v75,v76
v_min3_u32 v22,v22,v77,v78
v_min_u32 v22,v22,v79
v_cmp_eq_u32 vcc,0,v22
v_xor_b32 v72,v40,v72
v_xor_b32 v73,v41,v73
v_xor_b32 v74,v42,v74
v_xor_b32 v75,v43,v75
v_xor_b32 v76,v44,v76
v_xor_b32 v77,v45,v77
v_xor_b32 v78,v46,v78
v_xor_b32 v79,v47,v79
s_cbranch_vccnz nb_180
s_bitset0_b32 s68,1
v_smfmac_f32_16x16x64_bf16 v[184:187],v[72:75],a[160:167],v14
v_smfmac_f32_16x16x64_bf16 v[188:191],v[72:75],a[168:175],v14
v_smfmac_f32_16x16x64_bf16 v[184:187],v[76:79],a[176:183],v14
v_smfmac_f32_16x16x64_bf16 v[188:191],v[76:79],a[184:191],v14
nb_180:
sk_179:
s_bitcmp1_b32 s68,2
s_cbranch_scc0 sk_181
v_min3_u32 v22,v80,v81,v82
v_min3_u32 v22,v22,v83,v84
v_min3_u32 v22,v22,v85,v86
v_min_u32 v22,v22,v87
v_cmp_eq_u32 vcc,0,v22
v_xor_b32 v80,v48,v80
v_xor_b32 v81,v49,v81
v_xor_b32 v82,v50,v82
v_xor_b32 v83,v51,v83
v_xor_b32 v84,v52,v84
v_xor_b32 v85,v53,v85
v_xor_b32 v86,v54,v86
v_xor_b32 v87,v55,v87
s_cbranch_vccnz nb_182
s_bitset0_b32 s68,2
v_smfmac_f32_16x16x64_bf16 v[184:187],v[80:83],a[192:199],v14
v_smfmac_f32_16x16x64_bf16 v[188:191],v[80:83],a[200:207],v14
v_smfmac_f32_16x16x64_bf16 v[184:187],v[84:87],a[208:215],v14
v_smfmac_f32_16x16x64_bf16 v[188:191],v[84:87],a[216:223],v14
nb_182:
sk_181:
s_bitcmp1_b32 s68,3
s_cbranch_scc0 sk_183
v_min3_u32 v22,v88,v89,v90
v_min3_u32 v22,v22,v91,v92
v_min3_u32 v22,v22,v93,v94
v_min_u32 v22,v22,v95
v_cmp_eq_u32 vcc,0,v22
v_xor_b32 v88,v56,v88
v_xor_b32 v89,v57,v89
v_xor_b32 v90,v58,v90
v_xor_b32 v91,v59,v91
v_xor_b32 v92,v60,v92
v_xor_b32 v93,v61,v93
v_xor_b32 v94,v62,v94
v_xor_b32 v95,v63,v95
s_cbranch_vccnz nb_184
s_bitset0_b32 s68,3
v_smfmac_f32_16x16x64_bf16 v[184:187],v[88:91],a[224:231],v14
v_smfmac_f32_16x16x64_bf16 v[188:191],v[88:91],a[232:239],v14
v_smfmac_f32_16x16x64_bf16 v[184:187],v[92:95],a[240:247],v14
v_smfmac_f32_16x16x64_bf16 v[188:191],v[92:95],a[248:255],v14
nb_184:
sk_183:
s_cmp_lg_u32 s68,0
s_cbranch_scc1 rl_166
s_nop 2
s_branch fin_165
first_149:
s_waitcnt vmcnt(0) lgkmcnt(0)
s_barrier
s_add_u32 s64,s15,393216
buffer_load_dwordx4 a[176:179],v32,s[40:43],s64 offen nt
s_add_u32 s64,s15,425984
buffer_load_dwordx4 a[180:183],v32,s[40:43],s64 offen nt
s_add_u32 s64,s15,458752
buffer_load_dwordx4 a[184:187],v32,s[40:43],s64 offen nt
s_add_u32 s64,s15,491520
buffer_load_dwordx4 a[188:191],v32,s[40:43],s64 offen nt
s_add_u32 s64,s15,524288
buffer_load_dwordx4 a[192:195],v32,s[40:43],s64 offen nt
s_add_u32 s64,s15,557056
buffer_load_dwordx4 a[196:199],v32,s[40:43],s64 offen nt
s_add_u32 s64,s15,589824
buffer_load_dwordx4 a[200:203],v32,s[40:43],s64 offen nt
s_add_u32 s64,s15,622592
buffer_load_dwordx4 a[204:207],v32,s[40:43],s64 offen nt
s_add_u32 s64,s15,655360
buffer_load_dwordx4 a[208:211],v32,s[40:43],s64 offen nt
s_add_u32 s64,s15,688128
buffer_load_dwordx4 a[212:215],v32,s[40:43],s64 offen nt
s_add_u32 s64,s15,720896
buffer_load_dwordx4 a[216:219],v32,s[40:43],s64 offen nt
s_add_u32 s64,s15,753664
buffer_load_dwordx4 a[220:223],v32,s[40:43],s64 offen nt
s_add_u32 s64,s15,786432
buffer_load_dwordx4 a[224:227],v32,s[40:43],s64 offen nt
s_add_u32 s64,s15,819200
buffer_load_dwordx4 a[228:231],v32,s[40:43],s64 offen nt
s_add_u32 s64,s15,851968
buffer_load_dwordx4 a[232:235],v32,s[40:43],s64 offen nt
s_add_u32 s64,s15,884736
buffer_load_dwordx4 a[236:239],v32,s[40:43],s64 offen nt
s_add_u32 s64,s15,917504
buffer_load_dwordx4 a[240:243],v32,s[40:43],s64 offen nt
s_add_u32 s64,s15,950272
buffer_load_dwordx4 a[244:247],v32,s[40:43],s64 offen nt
s_add_u32 s64,s15,983040
buffer_load_dwordx4 a[248:251],v32,s[40:43],s64 offen nt
s_add_u32 s64,s15,1015808
buffer_load_dwordx4 a[252:255],v32,s[40:43],s64 offen nt
ds_write_b128 v33,a[0:3] offset:0
ds_write_b128 v33,a[4:7] offset:1024
ds_write_b128 v33,a[8:11] offset:2048
ds_write_b128 v33,a[12:15] offset:3072
s_waitcnt lgkmcnt(0)
v_mov_b32 v38,1
ds_write_b32 v37,v38 offset:4
qs_185:
ds_read_b32 v39,v37 offset:0
s_sub_u32 s90,s90,1
s_waitcnt lgkmcnt(0)
v_cmp_gt_u32 vcc,v38,v39
s_cmp_lt_i32 s90,0
s_cselect_b64 vcc,0,vcc
s_cbranch_vccnz qs_185
ds_read_b64_tr_b16 a[0:1],v36 offset:0
ds_read_b64_tr_b16 a[2:3],v36 offset:128
ds_read_b64_tr_b16 a[4:5],v36 offset:2048
ds_read_b64_tr_b16 a[6:7],v36 offset:2176
ds_read_b64_tr_b16 a[8:9],v36 offset:8192
ds_read_b64_tr_b16 a[10:11],v36 offset:8320
ds_read_b64_tr_b16 a[12:13],v36 offset:10240
ds_read_b64_tr_b16 a[14:15],v36 offset:10368
ds_write_b128 v33,a[16:19] offset:4096
ds_write_b128 v33,a[20:23] offset:5120
ds_write_b128 v33,a[24:27] offset:6144
ds_write_b128 v33,a[28:31] offset:7168
s_waitcnt lgkmcnt(0)
v_mov_b32 v38,2
ds_write_b32 v37,v38 offset:4
qs_186:
ds_read_b32 v39,v37 offset:0
s_sub_u32 s90,s90,1
s_waitcnt lgkmcnt(0)
v_cmp_gt_u32 vcc,v38,v39
s_cmp_lt_i32 s90,0
s_cselect_b64 vcc,0,vcc
s_cbranch_vccnz qs_186
ds_read_b64_tr_b16 a[16:17],v36 offset:4096
ds_read_b64_tr_b16 a[18:19],v36 offset:4224
ds_read_b64_tr_b16 a[20:21],v36 offset:6144
ds_read_b64_tr_b16 a[22:23],v36 offset:6272
ds_read_b64_tr_b16 a[24:25],v36 offset:12288
ds_read_b64_tr_b16 a[26:27],v36 offset:12416
ds_read_b64_tr_b16 a[28:29],v36 offset:14336
ds_read_b64_tr_b16 a[30:31],v36 offset:14464
ds_write_b128 v33,a[32:35] offset:0
ds_write_b128 v33,a[36:39] offset:1024
ds_write_b128 v33,a[40:43] offset:2048
ds_write_b128 v33,a[44:47] offset:3072
s_waitcnt lgkmcnt(0)
v_mov_b32 v38,3
ds_write_b32 v37,v38 offset:4
qs_187:
ds_read_b32 v39,v37 offset:0
s_sub_u32 s90,s90,1
s_waitcnt lgkmcnt(0)
v_cmp_gt_u32 vcc,v38,v39
s_cmp_lt_i32 s90,0
s_cselect_b64 vcc,0,vcc
s_cbranch_vccnz qs_187
ds_read_b64_tr_b16 a[32:33],v36 offset:0
ds_read_b64_tr_b16 a[34:35],v36 offset:128
ds_read_b64_tr_b16 a[36:37],v36 offset:2048
ds_read_b64_tr_b16 a[38:39],v36 offset:2176
ds_read_b64_tr_b16 a[40:41],v36 offset:8192
ds_read_b64_tr_b16 a[42:43],v36 offset:8320
ds_read_b64_tr_b16 a[44:45],v36 offset:10240
ds_read_b64_tr_b16 a[46:47],v36 offset:10368
ds_write_b128 v33,a[48:51] offset:4096
ds_write_b128 v33,a[52:55] offset:5120
ds_write_b128 v33,a[56:59] offset:6144
ds_write_b128 v33,a[60:63] offset:7168
s_waitcnt lgkmcnt(0)
v_mov_b32 v38,4
ds_write_b32 v37,v38 offset:4
qs_188:
ds_read_b32 v39,v37 offset:0
s_sub_u32 s90,s90,1
s_waitcnt lgkmcnt(0)
v_cmp_gt_u32 vcc,v38,v39
s_cmp_lt_i32 s90,0
s_cselect_b64 vcc,0,vcc
s_cbranch_vccnz qs_188
ds_read_b64_tr_b16 a[48:49],v36 offset:4096
ds_read_b64_tr_b16 a[50:51],v36 offset:4224
ds_read_b64_tr_b16 a[52:53],v36 offset:6144
ds_read_b64_tr_b16 a[54:55],v36 offset:6272
ds_read_b64_tr_b16 a[56:57],v36 offset:12288
ds_read_b64_tr_b16 a[58:59],v36 offset:12416
ds_read_b64_tr_b16 a[60:61],v36 offset:14336
ds_read_b64_tr_b16 a[62:63],v36 offset:14464
ds_write_b128 v33,a[64:67] offset:0
ds_write_b128 v33,a[68:71] offset:1024
ds_write_b128 v33,a[72:75] offset:2048
ds_write_b128 v33,a[76:79] offset:3072
s_waitcnt lgkmcnt(0)
v_mov_b32 v38,5
ds_write_b32 v37,v38 offset:4
qs_189:
ds_read_b32 v39,v37 offset:0
s_sub_u32 s90,s90,1
s_waitcnt lgkmcnt(0)
v_cmp_gt_u32 vcc,v38,v39
s_cmp_lt_i32 s90,0
s_cselect_b64 vcc,0,vcc
s_cbranch_vccnz qs_189
ds_read_b64_tr_b16 a[64:65],v36 offset:0
ds_read_b64_tr_b16 a[66:67],v36 offset:128
ds_read_b64_tr_b16 a[68:69],v36 offset:2048
ds_read_b64_tr_b16 a[70:71],v36 offset:2176
ds_read_b64_tr_b16 a[72:73],v36 offset:8192
ds_read_b64_tr_b16 a[74:75],v36 offset:8320
ds_read_b64_tr_b16 a[76:77],v36 offset:10240
ds_read_b64_tr_b16 a[78:79],v36 offset:10368
ds_write_b128 v33,a[80:83] offset:4096
ds_write_b128 v33,a[84:87] offset:5120
ds_write_b128 v33,a[88:91] offset:6144
ds_write_b128 v33,a[92:95] offset:7168
s_waitcnt lgkmcnt(0)
v_mov_b32 v38,6
ds_write_b32 v37,v38 offset:4
qs_190:
ds_read_b32 v39,v37 offset:0
s_sub_u32 s90,s90,1
s_waitcnt lgkmcnt(0)
v_cmp_gt_u32 vcc,v38,v39
s_cmp_lt_i32 s90,0
s_cselect_b64 vcc,0,vcc
s_cbranch_vccnz qs_190
ds_read_b64_tr_b16 a[80:81],v36 offset:4096
ds_read_b64_tr_b16 a[82:83],v36 offset:4224
ds_read_b64_tr_b16 a[84:85],v36 offset:6144
ds_read_b64_tr_b16 a[86:87],v36 offset:6272
ds_read_b64_tr_b16 a[88:89],v36 offset:12288
ds_read_b64_tr_b16 a[90:91],v36 offset:12416
ds_read_b64_tr_b16 a[92:93],v36 offset:14336
ds_read_b64_tr_b16 a[94:95],v36 offset:14464
ds_write_b128 v33,a[96:99] offset:0
ds_write_b128 v33,a[100:103] offset:1024
ds_write_b128 v33,a[104:107] offset:2048
ds_write_b128 v33,a[108:111] offset:3072
s_waitcnt lgkmcnt(0)
v_mov_b32 v38,7
ds_write_b32 v37,v38 offset:4
qs_191:
ds_read_b32 v39,v37 offset:0
s_sub_u32 s90,s90,1
s_waitcnt lgkmcnt(0)
v_cmp_gt_u32 vcc,v38,v39
s_cmp_lt_i32 s90,0
s_cselect_b64 vcc,0,vcc
s_cbranch_vccnz qs_191
ds_read_b64_tr_b16 a[96:97],v36 offset:0
ds_read_b64_tr_b16 a[98:99],v36 offset:128
ds_read_b64_tr_b16 a[100:101],v36 offset:2048
ds_read_b64_tr_b16 a[102:103],v36 offset:2176
ds_read_b64_tr_b16 a[104:105],v36 offset:8192
ds_read_b64_tr_b16 a[106:107],v36 offset:8320
ds_read_b64_tr_b16 a[108:109],v36 offset:10240
ds_read_b64_tr_b16 a[110:111],v36 offset:10368
ds_write_b128 v33,a[112:115] offset:4096
ds_write_b128 v33,a[116:119] offset:5120
ds_write_b128 v33,a[120:123] offset:6144
ds_write_b128 v33,a[124:127] offset:7168
s_waitcnt lgkmcnt(0)
v_mov_b32 v38,8
ds_write_b32 v37,v38 offset:4
qs_192:
ds_read_b32 v39,v37 offset:0
s_sub_u32 s90,s90,1
s_waitcnt lgkmcnt(0)
v_cmp_gt_u32 vcc,v38,v39
s_cmp_lt_i32 s90,0
s_cselect_b64 vcc,0,vcc
s_cbranch_vccnz qs_192
ds_read_b64_tr_b16 a[112:113],v36 offset:4096
ds_read_b64_tr_b16 a[114:115],v36 offset:4224
ds_read_b64_tr_b16 a[116:117],v36 offset:6144
ds_read_b64_tr_b16 a[118:119],v36 offset:6272
ds_read_b64_tr_b16 a[120:121],v36 offset:12288
ds_read_b64_tr_b16 a[122:123],v36 offset:12416
ds_read_b64_tr_b16 a[124:125],v36 offset:14336
ds_read_b64_tr_b16 a[126:127],v36 offset:14464
s_waitcnt lgkmcnt(0)
v_mov_b32 v38,9
ds_write_b32 v37,v38 offset:4
qs_193:
ds_read_b32 v39,v37 offset:0
s_sub_u32 s90,s90,1
s_waitcnt lgkmcnt(0)
v_cmp_gt_u32 vcc,v38,v39
s_cmp_lt_i32 s90,0
s_cselect_b64 vcc,0,vcc
s_cbranch_vccnz qs_193
ds_write_b128 v33,a[128:131] offset:0
ds_write_b128 v33,a[132:135] offset:1024
ds_write_b128 v33,a[136:139] offset:2048
ds_write_b128 v33,a[140:143] offset:3072
s_waitcnt lgkmcnt(0)
ds_read_b64_tr_b16 a[128:129],v34 offset:0
ds_read_b64_tr_b16 a[130:131],v34 offset:128
ds_read_b64_tr_b16 a[132:133],v34 offset:2048
ds_read_b64_tr_b16 a[134:135],v34 offset:2176
ds_read_b64_tr_b16 a[136:137],v34 offset:32
ds_read_b64_tr_b16 a[138:139],v34 offset:160
ds_read_b64_tr_b16 a[140:141],v34 offset:2080
ds_read_b64_tr_b16 a[142:143],v34 offset:2208
ds_write_b128 v33,a[144:147] offset:4096
ds_write_b128 v33,a[148:151] offset:5120
ds_write_b128 v33,a[152:155] offset:6144
ds_write_b128 v33,a[156:159] offset:7168
s_waitcnt lgkmcnt(0)
ds_read_b64_tr_b16 a[144:145],v34 offset:4096
ds_read_b64_tr_b16 a[146:147],v34 offset:4224
ds_read_b64_tr_b16 a[148:149],v34 offset:6144
ds_read_b64_tr_b16 a[150:151],v34 offset:6272
ds_read_b64_tr_b16 a[152:153],v34 offset:4128
ds_read_b64_tr_b16 a[154:155],v34 offset:4256
ds_read_b64_tr_b16 a[156:157],v34 offset:6176
ds_read_b64_tr_b16 a[158:159],v34 offset:6304
ds_write_b128 v33,a[160:163] offset:0
ds_write_b128 v33,a[164:167] offset:1024
ds_write_b128 v33,a[168:171] offset:2048
ds_write_b128 v33,a[172:175] offset:3072
s_waitcnt lgkmcnt(0)
ds_read_b64_tr_b16 a[160:161],v34 offset:0
ds_read_b64_tr_b16 a[162:163],v34 offset:128
ds_read_b64_tr_b16 a[164:165],v34 offset:2048
ds_read_b64_tr_b16 a[166:167],v34 offset:2176
ds_read_b64_tr_b16 a[168:169],v34 offset:32
ds_read_b64_tr_b16 a[170:171],v34 offset:160
ds_read_b64_tr_b16 a[172:173],v34 offset:2080
ds_read_b64_tr_b16 a[174:175],v34 offset:2208
free_194:
ds_read_b64 v[38:39],v37 offset:8
s_sub_u32 s90,s90,1
s_waitcnt lgkmcnt(0)
v_and_b32 v38,v38,v39
v_cmp_eq_u32 vcc,0,v38
s_cmp_lt_i32 s90,0
s_cselect_b64 vcc,0,vcc
s_cbranch_vccnz free_194
s_xor_b32 s64,s61,10493952
buffer_store_dwordx4 v[100:103],v206,s[20:23],s64 offen sc1
buffer_store_dwordx4 v[100:103],v207,s[20:23],s64 offen sc1
s_xor_b32 s64,s61,12582912
buffer_store_dwordx4 v[100:103],v206,s[20:23],s64 offen sc1
buffer_store_dwordx4 v[100:103],v207,s[20:23],s64 offen sc1
s_xor_b32 s64,s61,14688256
buffer_store_dwordx4 v[100:103],v206,s[20:23],s64 offen sc1
buffer_store_dwordx4 v[100:103],v207,s[20:23],s64 offen sc1
s_mov_b32 m0,32768
s_mov_b32 s65,221184
buffer_load_dwordx4 v16,s[20:23],s65 offen offset:0 lds
buffer_load_dwordx4 v16,s[20:23],s65 offen offset:1024 lds
buffer_load_dwordx4 v16,s[20:23],s65 offen offset:2048 lds
buffer_load_dwordx4 v16,s[20:23],s65 offen offset:3072 lds
s_mov_b32 m0,36864
s_mov_b32 s65,225280
buffer_load_dwordx4 v16,s[20:23],s65 offen offset:0 lds
buffer_load_dwordx4 v16,s[20:23],s65 offen offset:1024 lds
buffer_load_dwordx4 v16,s[20:23],s65 offen offset:2048 lds
buffer_load_dwordx4 v16,s[20:23],s65 offen offset:3072 lds
s_mov_b32 m0,40960
s_mov_b32 s65,229376
buffer_load_dwordx4 v16,s[20:23],s65 offen offset:0 lds
buffer_load_dwordx4 v16,s[20:23],s65 offen offset:1024 lds
buffer_load_dwordx4 v16,s[20:23],s65 offen offset:2048 lds
buffer_load_dwordx4 v16,s[20:23],s65 offen offset:3072 lds
s_mov_b32 m0,45056
s_mov_b32 s65,233472
buffer_load_dwordx4 v16,s[20:23],s65 offen offset:0 lds
buffer_load_dwordx4 v16,s[20:23],s65 offen offset:1024 lds
buffer_load_dwordx4 v16,s[20:23],s65 offen offset:2048 lds
buffer_load_dwordx4 v16,s[20:23],s65 offen offset:3072 lds
s_mov_b32 m0,49152
s_mov_b32 s65,237568
buffer_load_dwordx4 v16,s[20:23],s65 offen offset:0 lds
buffer_load_dwordx4 v16,s[20:23],s65 offen offset:1024 lds
buffer_load_dwordx4 v16,s[20:23],s65 offen offset:2048 lds
buffer_load_dwordx4 v16,s[20:23],s65 offen offset:3072 lds
s_mov_b32 m0,53248
s_mov_b32 s65,241664
buffer_load_dwordx4 v16,s[20:23],s65 offen offset:0 lds
buffer_load_dwordx4 v16,s[20:23],s65 offen offset:1024 lds
buffer_load_dwordx4 v16,s[20:23],s65 offen offset:2048 lds
buffer_load_dwordx4 v16,s[20:23],s65 offen offset:3072 lds
s_mov_b32 m0,57344
s_mov_b32 s65,245760
buffer_load_dwordx4 v16,s[20:23],s65 offen offset:0 lds
buffer_load_dwordx4 v16,s[20:23],s65 offen offset:1024 lds
buffer_load_dwordx4 v16,s[20:23],s65 offen offset:2048 lds
buffer_load_dwordx4 v16,s[20:23],s65 offen offset:3072 lds
s_mov_b32 m0,61440
s_mov_b32 s65,249856
buffer_load_dwordx4 v16,s[20:23],s65 offen offset:0 lds
buffer_load_dwordx4 v16,s[20:23],s65 offen offset:1024 lds
buffer_load_dwordx4 v16,s[20:23],s65 offen offset:2048 lds
buffer_load_dwordx4 v16,s[20:23],s65 offen offset:3072 lds
s_waitcnt vmcnt(54)
ds_write_b128 v33,a[176:179] offset:4096
ds_write_b128 v33,a[180:183] offset:5120
ds_write_b128 v33,a[184:187] offset:6144
ds_write_b128 v33,a[188:191] offset:7168
s_waitcnt lgkmcnt(0)
ds_read_b64_tr_b16 a[176:177],v34 offset:4096
ds_read_b64_tr_b16 a[178:179],v34 offset:4224
ds_read_b64_tr_b16 a[180:181],v34 offset:6144
ds_read_b64_tr_b16 a[182:183],v34 offset:6272
ds_read_b64_tr_b16 a[184:185],v34 offset:4128
ds_read_b64_tr_b16 a[186:187],v34 offset:4256
ds_read_b64_tr_b16 a[188:189],v34 offset:6176
ds_read_b64_tr_b16 a[190:191],v34 offset:6304
s_waitcnt vmcnt(50)
ds_write_b128 v33,a[192:195] offset:0
ds_write_b128 v33,a[196:199] offset:1024
ds_write_b128 v33,a[200:203] offset:2048
ds_write_b128 v33,a[204:207] offset:3072
s_waitcnt lgkmcnt(0)
ds_read_b64_tr_b16 a[192:193],v34 offset:0
ds_read_b64_tr_b16 a[194:195],v34 offset:128
ds_read_b64_tr_b16 a[196:197],v34 offset:2048
ds_read_b64_tr_b16 a[198:199],v34 offset:2176
ds_read_b64_tr_b16 a[200:201],v34 offset:32
ds_read_b64_tr_b16 a[202:203],v34 offset:160
ds_read_b64_tr_b16 a[204:205],v34 offset:2080
ds_read_b64_tr_b16 a[206:207],v34 offset:2208
s_waitcnt vmcnt(46)
ds_write_b128 v33,a[208:211] offset:4096
ds_write_b128 v33,a[212:215] offset:5120
ds_write_b128 v33,a[216:219] offset:6144
ds_write_b128 v33,a[220:223] offset:7168
s_waitcnt lgkmcnt(0)
ds_read_b64_tr_b16 a[208:209],v34 offset:4096
ds_read_b64_tr_b16 a[210:211],v34 offset:4224
ds_read_b64_tr_b16 a[212:213],v34 offset:6144
ds_read_b64_tr_b16 a[214:215],v34 offset:6272
ds_read_b64_tr_b16 a[216:217],v34 offset:4128
ds_read_b64_tr_b16 a[218:219],v34 offset:4256
ds_read_b64_tr_b16 a[220:221],v34 offset:6176
ds_read_b64_tr_b16 a[222:223],v34 offset:6304
s_waitcnt vmcnt(42)
ds_write_b128 v33,a[224:227] offset:0
ds_write_b128 v33,a[228:231] offset:1024
ds_write_b128 v33,a[232:235] offset:2048
ds_write_b128 v33,a[236:239] offset:3072
s_waitcnt lgkmcnt(0)
ds_read_b64_tr_b16 a[224:225],v34 offset:0
ds_read_b64_tr_b16 a[226:227],v34 offset:128
ds_read_b64_tr_b16 a[228:229],v34 offset:2048
ds_read_b64_tr_b16 a[230:231],v34 offset:2176
ds_read_b64_tr_b16 a[232:233],v34 offset:32
ds_read_b64_tr_b16 a[234:235],v34 offset:160
ds_read_b64_tr_b16 a[236:237],v34 offset:2080
ds_read_b64_tr_b16 a[238:239],v34 offset:2208
s_waitcnt vmcnt(38)
ds_write_b128 v33,a[240:243] offset:4096
ds_write_b128 v33,a[244:247] offset:5120
ds_write_b128 v33,a[248:251] offset:6144
ds_write_b128 v33,a[252:255] offset:7168
s_waitcnt lgkmcnt(0)
ds_read_b64_tr_b16 a[240:241],v34 offset:4096
ds_read_b64_tr_b16 a[242:243],v34 offset:4224
ds_read_b64_tr_b16 a[244:245],v34 offset:6144
ds_read_b64_tr_b16 a[246:247],v34 offset:6272
ds_read_b64_tr_b16 a[248:249],v34 offset:4128
ds_read_b64_tr_b16 a[250:251],v34 offset:4256
ds_read_b64_tr_b16 a[252:253],v34 offset:6176
ds_read_b64_tr_b16 a[254:255],v34 offset:6304
s_mov_b32 s79,0
s_add_u32 s63,s79,0
s_and_b32 s64,s63,3
s_lshl_b32 s70,s64,20
s_add_u32 s65,s63,2
s_and_b32 s65,s65,3
s_lshl_b32 s73,s65,20
s_add_u32 s55,s63,3
s_lshl_b32 s78,s55,16
s_add_u32 s78,s78,57344
s_cmp_lt_u32 s55,64
s_cselect_b32 s78,s78,0x7fff0000
s_add_u32 s71,s70,65536
s_add_u32 s60,s63,1
s_and_b32 s60,s60,3
s_lshl_b32 s72,s60,20
v_mov_b32 v184,0
v_mov_b32 v185,0
v_mov_b32 v186,0
v_mov_b32 v187,0
v_mov_b32 v188,0
v_mov_b32 v189,0
v_mov_b32 v190,0
v_mov_b32 v191,0
s_lshl_b32 s74,s63,21
s_lshl_b32 s55,s63,13
s_and_b32 s55,s55,0x2000
s_xor_b32 s55,s55,s61
s_add_u32 s74,s74,s55
v_mov_b32 v176,0
v_mov_b32 v177,0
v_mov_b32 v178,0
v_mov_b32 v179,0
v_mov_b32 v25,1
s_waitcnt vmcnt(0) lgkmcnt(0)
s_barrier
v_max_u32 v216,1,v216
v_max_u32 v217,1,v217
v_max_u32 v218,1,v218
v_max_u32 v219,1,v219
s_mov_b64 exec,s[84:85]
buffer_store_dwordx4 v[216:219],v12,s[24:27],s70 offen
buffer_store_dwordx4 v[216:219],v12,s[28:31],s70 offen sc1
s_mov_b64 exec,1
buffer_store_dword v25,v13,s[24:27],s70 offen
buffer_store_dword v25,v13,s[28:31],s70 offen sc1
s_mov_b64 exec,-1
s_branch loop_150
end_57:
s_waitcnt vmcnt(0)
s_barrier
s_mov_b32 s50,s91
done_1:
s_endpgm
pipe_worker:
v_and_b32 v1,63,v0
v_and_b32 v3,15,v1
v_lshrrev_b32 v4,4,v1
v_lshlrev_b32 v16,4,v1
v_mov_b32 v48,0
v_mov_b32 v49,0
v_mov_b32 v50,0
v_mov_b32 v51,0
s_lshr_b32 s58,s55,5
s_and_b32 s59,s55,31
s_xor_b32 s62,s61,0x2000
s_add_u32 s63,s62,21053440
s_lshr_b32 s64,s59,4
s_and_b32 s59,s59,15
s_lshr_b32 s65,s58,1
s_lshl_b32 s65,s65,4
s_add_u32 s59,s59,s65
s_mul_i32 s65,s64,3
s_add_u32 s64,s64,1
s_sub_u32 s58,s58,1
s_cmp_lt_u32 s58,2
s_cselect_b32 s58,s64,s65
s_load_dwordx2 s[4:5],s[0:1],16
v_lshlrev_b32 v5,4,v0
s_lshl_b32 s64,s55,14
s_add_u32 s64,s64,17825792
buffer_store_dwordx4 v[48:51],v5,s[20:23],s64 offen sc1
s_add_u32 s64,s64,4096
buffer_store_dwordx4 v[48:51],v5,s[20:23],s64 offen sc1
s_add_u32 s64,s64,4096
buffer_store_dwordx4 v[48:51],v5,s[20:23],s64 offen sc1
s_add_u32 s64,s64,4096
buffer_store_dwordx4 v[48:51],v5,s[20:23],s64 offen sc1
s_add_u32 s64,s64,4096
s_lshl_b32 s64,s55,12
s_add_u32 s64,s64,8577024
buffer_store_dwordx4 v[48:51],v5,s[20:23],s64 offen sc1
s_lshr_b32 s79,s55,5
s_add_u32 s64,s79,8
s_lshl_b32 s93,s64,21
s_lshl_b32 s64,s64,13
s_and_b32 s64,s64,0x2000
s_xor_b32 s64,s64,s61
s_add_u32 s93,s93,s64
s_add_u32 s93,s93,29360128
s_and_b32 s64,s55,31
s_add_u32 s64,s64,96
s_lshl_b32 s64,s64,14
s_add_u32 s93,s93,s64
s_waitcnt lgkmcnt(0)
s_mov_b32 s32,s4
s_and_b32 s33,s5,0xffff
s_mov_b32 s34,0x800000
s_mov_b32 s35,0x20000
v_lshrrev_b32 v5,3,v3
v_bfe_u32 v6,v3,2,1
v_lshl_add_u32 v7,v5,3,v6
v_lshl_add_u32 v6,v5,2,v6
v_lshrrev_b32 v5,1,v4
v_lshl_add_u32 v7,v5,4,v7
v_and_b32 v5,1,v4
v_lshl_add_u32 v7,v5,2,v7
v_lshl_add_u32 v6,v5,1,v6
v_bfe_u32 v5,v3,1,1
s_lshl_b32 s64,s50,1
v_add_u32 v5,s64,v5
v_xor_b32 v5,v5,v6
v_lshlrev_b32 v5,5,v5
v_lshl_add_u32 v5,v7,8,v5
v_and_b32 v6,1,v3
v_lshl_add_u32 v12,v6,4,v5
s_lshl_b32 s66,s59,8
v_and_b32 v5,15,v1
v_and_b32 v6,1,v4
v_lshlrev_b32 v6,1,v6
v_xor_b32 v5,v5,v6
v_mul_u32_u24 v6,8192,v4
v_xor_b32 v7,0,v5
v_lshl_add_u32 v8,v7,4,v6
v_xor_b32 v7,4,v5
v_lshl_add_u32 v9,v7,4,v6
v_xor_b32 v7,8,v5
v_lshl_add_u32 v10,v7,4,v6
v_xor_b32 v7,12,v5
v_lshl_add_u32 v11,v7,4,v6
s_mul_i32 s74,s50,524288
s_add_u32 s74,s74,s66
s_lshl_b32 s75,s50,14
s_mul_i32 s76,s50,262144
s_add_u32 s76,s76,s66
s_lshl_b32 s77,s50,13
s_add_u32 s64,s74,0
s_add_u32 m0,s75,0
s_nop 0
buffer_load_dwordx4 v8,s[32:35],s64 offen nt lds
s_add_u32 s64,s74,32768
s_add_u32 m0,s75,1024
s_nop 0
buffer_load_dwordx4 v9,s[32:35],s64 offen nt lds
s_add_u32 s64,s74,65536
s_add_u32 m0,s75,2048
s_nop 0
buffer_load_dwordx4 v10,s[32:35],s64 offen nt lds
s_add_u32 s64,s74,98304
s_add_u32 m0,s75,3072
s_nop 0
buffer_load_dwordx4 v11,s[32:35],s64 offen nt lds
s_add_u32 s64,s74,131072
s_add_u32 m0,s75,4096
s_nop 0
buffer_load_dwordx4 v8,s[32:35],s64 offen nt lds
s_add_u32 s64,s74,163840
s_add_u32 m0,s75,5120
s_nop 0
buffer_load_dwordx4 v9,s[32:35],s64 offen nt lds
s_add_u32 s64,s74,196608
s_add_u32 m0,s75,6144
s_nop 0
buffer_load_dwordx4 v10,s[32:35],s64 offen nt lds
s_add_u32 s64,s74,229376
s_add_u32 m0,s75,7168
s_nop 0
buffer_load_dwordx4 v11,s[32:35],s64 offen nt lds
s_add_u32 s64,s74,262144
s_add_u32 m0,s75,8192
s_nop 0
buffer_load_dwordx4 v8,s[32:35],s64 offen nt lds
s_add_u32 s64,s74,294912
s_add_u32 m0,s75,9216
s_nop 0
buffer_load_dwordx4 v9,s[32:35],s64 offen nt lds
s_add_u32 s64,s74,327680
s_add_u32 m0,s75,10240
s_nop 0
buffer_load_dwordx4 v10,s[32:35],s64 offen nt lds
s_add_u32 s64,s74,360448
s_add_u32 m0,s75,11264
s_nop 0
buffer_load_dwordx4 v11,s[32:35],s64 offen nt lds
s_add_u32 s64,s74,393216
s_add_u32 m0,s75,12288
s_nop 0
buffer_load_dwordx4 v8,s[32:35],s64 offen nt lds
s_add_u32 s64,s74,425984
s_add_u32 m0,s75,13312
s_nop 0
buffer_load_dwordx4 v9,s[32:35],s64 offen nt lds
s_add_u32 s64,s74,458752
s_add_u32 m0,s75,14336
s_nop 0
buffer_load_dwordx4 v10,s[32:35],s64 offen nt lds
s_add_u32 s64,s74,491520
s_add_u32 m0,s75,15360
s_nop 0
buffer_load_dwordx4 v11,s[32:35],s64 offen nt lds
s_add_u32 s64,s74,2097152
s_add_u32 m0,s75,65536
s_nop 0
buffer_load_dwordx4 v8,s[32:35],s64 offen nt lds
s_add_u32 s64,s74,2129920
s_add_u32 m0,s75,66560
s_nop 0
buffer_load_dwordx4 v9,s[32:35],s64 offen nt lds
s_add_u32 s64,s74,2162688
s_add_u32 m0,s75,67584
s_nop 0
buffer_load_dwordx4 v10,s[32:35],s64 offen nt lds
s_add_u32 s64,s74,2195456
s_add_u32 m0,s75,68608
s_nop 0
buffer_load_dwordx4 v11,s[32:35],s64 offen nt lds
s_add_u32 s64,s74,2228224
s_add_u32 m0,s75,69632
s_nop 0
buffer_load_dwordx4 v8,s[32:35],s64 offen nt lds
s_add_u32 s64,s74,2260992
s_add_u32 m0,s75,70656
s_nop 0
buffer_load_dwordx4 v9,s[32:35],s64 offen nt lds
s_add_u32 s64,s74,2293760
s_add_u32 m0,s75,71680
s_nop 0
buffer_load_dwordx4 v10,s[32:35],s64 offen nt lds
s_add_u32 s64,s74,2326528
s_add_u32 m0,s75,72704
s_nop 0
buffer_load_dwordx4 v11,s[32:35],s64 offen nt lds
s_add_u32 s64,s74,2359296
s_add_u32 m0,s75,73728
s_nop 0
buffer_load_dwordx4 v8,s[32:35],s64 offen nt lds
s_add_u32 s64,s74,2392064
s_add_u32 m0,s75,74752
s_nop 0
buffer_load_dwordx4 v9,s[32:35],s64 offen nt lds
s_add_u32 s64,s74,2424832
s_add_u32 m0,s75,75776
s_nop 0
buffer_load_dwordx4 v10,s[32:35],s64 offen nt lds
s_add_u32 s64,s74,2457600
s_add_u32 m0,s75,76800
s_nop 0
buffer_load_dwordx4 v11,s[32:35],s64 offen nt lds
s_add_u32 s64,s74,2490368
s_add_u32 m0,s75,77824
s_nop 0
buffer_load_dwordx4 v8,s[32:35],s64 offen nt lds
s_add_u32 s64,s74,2523136
s_add_u32 m0,s75,78848
s_nop 0
buffer_load_dwordx4 v9,s[32:35],s64 offen nt lds
s_add_u32 s64,s74,2555904
s_add_u32 m0,s75,79872
s_nop 0
buffer_load_dwordx4 v10,s[32:35],s64 offen nt lds
s_add_u32 s64,s74,2588672
s_add_u32 m0,s75,80896
s_nop 0
buffer_load_dwordx4 v11,s[32:35],s64 offen nt lds
s_waitcnt vmcnt(16)
s_barrier
ds_read_b64_tr_b16 a[0:1],v12 offset:0
ds_read_b64_tr_b16 a[2:3],v12 offset:512
ds_read_b64_tr_b16 a[128:129],v12 offset:8
ds_read_b64_tr_b16 a[130:131],v12 offset:520
ds_read_b64_tr_b16 a[4:5],v12 offset:8192
ds_read_b64_tr_b16 a[6:7],v12 offset:8704
ds_read_b64_tr_b16 a[132:133],v12 offset:8200
ds_read_b64_tr_b16 a[134:135],v12 offset:8712
s_waitcnt lgkmcnt(4)
ds_read_b64_tr_b16 a[8:9],v12 offset:16384
ds_read_b64_tr_b16 a[10:11],v12 offset:16896
ds_read_b64_tr_b16 a[136:137],v12 offset:16392
ds_read_b64_tr_b16 a[138:139],v12 offset:16904
ds_read_b64_tr_b16 a[12:13],v12 offset:24576
ds_read_b64_tr_b16 a[14:15],v12 offset:25088
ds_read_b64_tr_b16 a[140:141],v12 offset:24584
ds_read_b64_tr_b16 a[142:143],v12 offset:25096
s_waitcnt lgkmcnt(4)
ds_read_b64_tr_b16 a[16:17],v12 offset:32768
ds_read_b64_tr_b16 a[18:19],v12 offset:33280
ds_read_b64_tr_b16 a[144:145],v12 offset:32776
ds_read_b64_tr_b16 a[146:147],v12 offset:33288
ds_read_b64_tr_b16 a[20:21],v12 offset:40960
ds_read_b64_tr_b16 a[22:23],v12 offset:41472
ds_read_b64_tr_b16 a[148:149],v12 offset:40968
ds_read_b64_tr_b16 a[150:151],v12 offset:41480
s_waitcnt lgkmcnt(4)
ds_read_b64_tr_b16 a[24:25],v12 offset:49152
ds_read_b64_tr_b16 a[26:27],v12 offset:49664
ds_read_b64_tr_b16 a[152:153],v12 offset:49160
ds_read_b64_tr_b16 a[154:155],v12 offset:49672
ds_read_b64_tr_b16 a[28:29],v12 offset:57344
ds_read_b64_tr_b16 a[30:31],v12 offset:57856
ds_read_b64_tr_b16 a[156:157],v12 offset:57352
ds_read_b64_tr_b16 a[158:159],v12 offset:57864
s_waitcnt lgkmcnt(4)
v_xor_b32 v12,0x10000,v12
s_waitcnt lgkmcnt(0)
s_barrier
s_add_u32 s64,s74,4194304
s_add_u32 m0,s75,0
s_nop 0
buffer_load_dwordx4 v8,s[32:35],s64 offen nt lds
s_add_u32 s64,s74,4227072
s_add_u32 m0,s75,1024
s_nop 0
buffer_load_dwordx4 v9,s[32:35],s64 offen nt lds
s_add_u32 s64,s74,4259840
s_add_u32 m0,s75,2048
s_nop 0
buffer_load_dwordx4 v10,s[32:35],s64 offen nt lds
s_add_u32 s64,s74,4292608
s_add_u32 m0,s75,3072
s_nop 0
buffer_load_dwordx4 v11,s[32:35],s64 offen nt lds
s_add_u32 s64,s74,4325376
s_add_u32 m0,s75,4096
s_nop 0
buffer_load_dwordx4 v8,s[32:35],s64 offen nt lds
s_add_u32 s64,s74,4358144
s_add_u32 m0,s75,5120
s_nop 0
buffer_load_dwordx4 v9,s[32:35],s64 offen nt lds
s_add_u32 s64,s74,4390912
s_add_u32 m0,s75,6144
s_nop 0
buffer_load_dwordx4 v10,s[32:35],s64 offen nt lds
s_add_u32 s64,s74,4423680
s_add_u32 m0,s75,7168
s_nop 0
buffer_load_dwordx4 v11,s[32:35],s64 offen nt lds
s_add_u32 s64,s74,4456448
s_add_u32 m0,s75,8192
s_nop 0
buffer_load_dwordx4 v8,s[32:35],s64 offen nt lds
s_add_u32 s64,s74,4489216
s_add_u32 m0,s75,9216
s_nop 0
buffer_load_dwordx4 v9,s[32:35],s64 offen nt lds
s_add_u32 s64,s74,4521984
s_add_u32 m0,s75,10240
s_nop 0
buffer_load_dwordx4 v10,s[32:35],s64 offen nt lds
s_add_u32 s64,s74,4554752
s_add_u32 m0,s75,11264
s_nop 0
buffer_load_dwordx4 v11,s[32:35],s64 offen nt lds
s_add_u32 s64,s74,4587520
s_add_u32 m0,s75,12288
s_nop 0
buffer_load_dwordx4 v8,s[32:35],s64 offen nt lds
s_add_u32 s64,s74,4620288
s_add_u32 m0,s75,13312
s_nop 0
buffer_load_dwordx4 v9,s[32:35],s64 offen nt lds
s_add_u32 s64,s74,4653056
s_add_u32 m0,s75,14336
s_nop 0
buffer_load_dwordx4 v10,s[32:35],s64 offen nt lds
s_add_u32 s64,s74,4685824
s_add_u32 m0,s75,15360
s_nop 0
buffer_load_dwordx4 v11,s[32:35],s64 offen nt lds
s_waitcnt vmcnt(16)
s_barrier
ds_read_b64_tr_b16 a[32:33],v12 offset:0
ds_read_b64_tr_b16 a[34:35],v12 offset:512
ds_read_b64_tr_b16 a[160:161],v12 offset:8
ds_read_b64_tr_b16 a[162:163],v12 offset:520
ds_read_b64_tr_b16 a[36:37],v12 offset:8192
ds_read_b64_tr_b16 a[38:39],v12 offset:8704
ds_read_b64_tr_b16 a[164:165],v12 offset:8200
ds_read_b64_tr_b16 a[166:167],v12 offset:8712
s_waitcnt lgkmcnt(4)
ds_read_b64_tr_b16 a[40:41],v12 offset:16384
ds_read_b64_tr_b16 a[42:43],v12 offset:16896
ds_read_b64_tr_b16 a[168:169],v12 offset:16392
ds_read_b64_tr_b16 a[170:171],v12 offset:16904
ds_read_b64_tr_b16 a[44:45],v12 offset:24576
ds_read_b64_tr_b16 a[46:47],v12 offset:25088
ds_read_b64_tr_b16 a[172:173],v12 offset:24584
ds_read_b64_tr_b16 a[174:175],v12 offset:25096
s_waitcnt lgkmcnt(4)
ds_read_b64_tr_b16 a[48:49],v12 offset:32768
ds_read_b64_tr_b16 a[50:51],v12 offset:33280
ds_read_b64_tr_b16 a[176:177],v12 offset:32776
ds_read_b64_tr_b16 a[178:179],v12 offset:33288
ds_read_b64_tr_b16 a[52:53],v12 offset:40960
ds_read_b64_tr_b16 a[54:55],v12 offset:41472
ds_read_b64_tr_b16 a[180:181],v12 offset:40968
ds_read_b64_tr_b16 a[182:183],v12 offset:41480
s_waitcnt lgkmcnt(4)
ds_read_b64_tr_b16 a[56:57],v12 offset:49152
ds_read_b64_tr_b16 a[58:59],v12 offset:49664
ds_read_b64_tr_b16 a[184:185],v12 offset:49160
ds_read_b64_tr_b16 a[186:187],v12 offset:49672
ds_read_b64_tr_b16 a[60:61],v12 offset:57344
ds_read_b64_tr_b16 a[62:63],v12 offset:57856
ds_read_b64_tr_b16 a[188:189],v12 offset:57352
ds_read_b64_tr_b16 a[190:191],v12 offset:57864
s_waitcnt lgkmcnt(4)
v_xor_b32 v12,0x10000,v12
s_waitcnt lgkmcnt(0)
s_barrier
s_add_u32 s64,s74,6291456
s_add_u32 m0,s75,65536
s_nop 0
buffer_load_dwordx4 v8,s[32:35],s64 offen nt lds
s_add_u32 s64,s74,6324224
s_add_u32 m0,s75,66560
s_nop 0
buffer_load_dwordx4 v9,s[32:35],s64 offen nt lds
s_add_u32 s64,s74,6356992
s_add_u32 m0,s75,67584
s_nop 0
buffer_load_dwordx4 v10,s[32:35],s64 offen nt lds
s_add_u32 s64,s74,6389760
s_add_u32 m0,s75,68608
s_nop 0
buffer_load_dwordx4 v11,s[32:35],s64 offen nt lds
s_add_u32 s64,s74,6422528
s_add_u32 m0,s75,69632
s_nop 0
buffer_load_dwordx4 v8,s[32:35],s64 offen nt lds
s_add_u32 s64,s74,6455296
s_add_u32 m0,s75,70656
s_nop 0
buffer_load_dwordx4 v9,s[32:35],s64 offen nt lds
s_add_u32 s64,s74,6488064
s_add_u32 m0,s75,71680
s_nop 0
buffer_load_dwordx4 v10,s[32:35],s64 offen nt lds
s_add_u32 s64,s74,6520832
s_add_u32 m0,s75,72704
s_nop 0
buffer_load_dwordx4 v11,s[32:35],s64 offen nt lds
s_add_u32 s64,s74,6553600
s_add_u32 m0,s75,73728
s_nop 0
buffer_load_dwordx4 v8,s[32:35],s64 offen nt lds
s_add_u32 s64,s74,6586368
s_add_u32 m0,s75,74752
s_nop 0
buffer_load_dwordx4 v9,s[32:35],s64 offen nt lds
s_add_u32 s64,s74,6619136
s_add_u32 m0,s75,75776
s_nop 0
buffer_load_dwordx4 v10,s[32:35],s64 offen nt lds
s_add_u32 s64,s74,6651904
s_add_u32 m0,s75,76800
s_nop 0
buffer_load_dwordx4 v11,s[32:35],s64 offen nt lds
s_add_u32 s64,s74,6684672
s_add_u32 m0,s75,77824
s_nop 0
buffer_load_dwordx4 v8,s[32:35],s64 offen nt lds
s_add_u32 s64,s74,6717440
s_add_u32 m0,s75,78848
s_nop 0
buffer_load_dwordx4 v9,s[32:35],s64 offen nt lds
s_add_u32 s64,s74,6750208
s_add_u32 m0,s75,79872
s_nop 0
buffer_load_dwordx4 v10,s[32:35],s64 offen nt lds
s_add_u32 s64,s74,6782976
s_add_u32 m0,s75,80896
s_nop 0
buffer_load_dwordx4 v11,s[32:35],s64 offen nt lds
s_waitcnt vmcnt(16)
s_barrier
ds_read_b64_tr_b16 a[64:65],v12 offset:0
ds_read_b64_tr_b16 a[66:67],v12 offset:512
ds_read_b64_tr_b16 a[192:193],v12 offset:8
ds_read_b64_tr_b16 a[194:195],v12 offset:520
ds_read_b64_tr_b16 a[68:69],v12 offset:8192
ds_read_b64_tr_b16 a[70:71],v12 offset:8704
ds_read_b64_tr_b16 a[196:197],v12 offset:8200
ds_read_b64_tr_b16 a[198:199],v12 offset:8712
s_waitcnt lgkmcnt(4)
ds_read_b64_tr_b16 a[72:73],v12 offset:16384
ds_read_b64_tr_b16 a[74:75],v12 offset:16896
ds_read_b64_tr_b16 a[200:201],v12 offset:16392
ds_read_b64_tr_b16 a[202:203],v12 offset:16904
ds_read_b64_tr_b16 a[76:77],v12 offset:24576
ds_read_b64_tr_b16 a[78:79],v12 offset:25088
ds_read_b64_tr_b16 a[204:205],v12 offset:24584
ds_read_b64_tr_b16 a[206:207],v12 offset:25096
s_waitcnt lgkmcnt(4)
ds_read_b64_tr_b16 a[80:81],v12 offset:32768
ds_read_b64_tr_b16 a[82:83],v12 offset:33280
ds_read_b64_tr_b16 a[208:209],v12 offset:32776
ds_read_b64_tr_b16 a[210:211],v12 offset:33288
ds_read_b64_tr_b16 a[84:85],v12 offset:40960
ds_read_b64_tr_b16 a[86:87],v12 offset:41472
ds_read_b64_tr_b16 a[212:213],v12 offset:40968
ds_read_b64_tr_b16 a[214:215],v12 offset:41480
s_waitcnt lgkmcnt(4)
ds_read_b64_tr_b16 a[88:89],v12 offset:49152
ds_read_b64_tr_b16 a[90:91],v12 offset:49664
ds_read_b64_tr_b16 a[216:217],v12 offset:49160
ds_read_b64_tr_b16 a[218:219],v12 offset:49672
ds_read_b64_tr_b16 a[92:93],v12 offset:57344
ds_read_b64_tr_b16 a[94:95],v12 offset:57856
ds_read_b64_tr_b16 a[220:221],v12 offset:57352
ds_read_b64_tr_b16 a[222:223],v12 offset:57864
s_waitcnt lgkmcnt(4)
v_xor_b32 v12,0x10000,v12
s_waitcnt lgkmcnt(0)
s_barrier
s_waitcnt vmcnt(0)
s_barrier
ds_read_b64_tr_b16 a[96:97],v12 offset:0
ds_read_b64_tr_b16 a[98:99],v12 offset:512
ds_read_b64_tr_b16 a[224:225],v12 offset:8
ds_read_b64_tr_b16 a[226:227],v12 offset:520
ds_read_b64_tr_b16 a[100:101],v12 offset:8192
ds_read_b64_tr_b16 a[102:103],v12 offset:8704
ds_read_b64_tr_b16 a[228:229],v12 offset:8200
ds_read_b64_tr_b16 a[230:231],v12 offset:8712
s_waitcnt lgkmcnt(4)
ds_read_b64_tr_b16 a[104:105],v12 offset:16384
ds_read_b64_tr_b16 a[106:107],v12 offset:16896
ds_read_b64_tr_b16 a[232:233],v12 offset:16392
ds_read_b64_tr_b16 a[234:235],v12 offset:16904
ds_read_b64_tr_b16 a[108:109],v12 offset:24576
ds_read_b64_tr_b16 a[110:111],v12 offset:25088
ds_read_b64_tr_b16 a[236:237],v12 offset:24584
ds_read_b64_tr_b16 a[238:239],v12 offset:25096
s_waitcnt lgkmcnt(4)
ds_read_b64_tr_b16 a[112:113],v12 offset:32768
ds_read_b64_tr_b16 a[114:115],v12 offset:33280
ds_read_b64_tr_b16 a[240:241],v12 offset:32776
ds_read_b64_tr_b16 a[242:243],v12 offset:33288
ds_read_b64_tr_b16 a[116:117],v12 offset:40960
ds_read_b64_tr_b16 a[118:119],v12 offset:41472
ds_read_b64_tr_b16 a[244:245],v12 offset:40968
ds_read_b64_tr_b16 a[246:247],v12 offset:41480
s_waitcnt lgkmcnt(4)
ds_read_b64_tr_b16 a[120:121],v12 offset:49152
ds_read_b64_tr_b16 a[122:123],v12 offset:49664
ds_read_b64_tr_b16 a[248:249],v12 offset:49160
ds_read_b64_tr_b16 a[250:251],v12 offset:49672
ds_read_b64_tr_b16 a[124:125],v12 offset:57344
ds_read_b64_tr_b16 a[126:127],v12 offset:57856
ds_read_b64_tr_b16 a[252:253],v12 offset:57352
ds_read_b64_tr_b16 a[254:255],v12 offset:57864
s_waitcnt lgkmcnt(4)
v_xor_b32 v12,0x10000,v12
s_waitcnt lgkmcnt(0)
s_barrier
v_and_b32 v21,7,v1
v_lshlrev_b32 v21,6,v21
s_mov_b32 s65,21052416
s_mov_b32 s66,1792
pl_198:
buffer_load_dword v22,v21,s[20:23],s65 offen sc1
s_waitcnt vmcnt(0)
v_cmp_gt_u32 vcc,s66,v22
s_cbranch_vccz pok_199
s_sleep 1
s_sub_u32 s90,s90,1
s_cmp_gt_i32 s90,0
s_cbranch_scc1 pl_198
pok_199:
s_lshl_b32 s72,s50,14
s_lshl_b32 s74,s58,16
s_add_u32 s74,s74,s72
s_add_u32 s74,s74,57344
v_mov_b32 v17,v16
s_lshl_b32 s64,s59,14
s_lshl_b32 s65,s50,11
s_add_u32 s64,s64,s65
v_add_u32 v18,s64,v16
s_lshl_b32 s73,s58,5
s_add_u32 s73,s73,s59
s_lshl_b32 s73,s73,2
s_add_u32 s73,s73,s63
v_lshlrev_b32 v24,4,v0
s_mov_b32 s79,s58
s_add_u32 m0,s72,0
s_add_u32 s65,s74,0
buffer_load_dwordx4 v16,s[20:23],s65 offen offset:0  lds
buffer_load_dwordx4 v16,s[20:23],s65 offen offset:1024  lds
buffer_load_dwordx4 v16,s[20:23],s65 offen offset:2048  lds
buffer_load_dwordx4 v16,s[20:23],s65 offen offset:3072  lds
s_add_u32 m0,s72,4096
s_add_u32 s65,s74,4096
buffer_load_dwordx4 v16,s[20:23],s65 offen offset:0  lds
buffer_load_dwordx4 v16,s[20:23],s65 offen offset:1024  lds
buffer_load_dwordx4 v16,s[20:23],s65 offen offset:2048  lds
buffer_load_dwordx4 v16,s[20:23],s65 offen offset:3072  lds
s_add_u32 m0,s72,8192
s_add_u32 s65,s74,8192
buffer_load_dwordx4 v16,s[20:23],s65 offen offset:0  lds
buffer_load_dwordx4 v16,s[20:23],s65 offen offset:1024  lds
buffer_load_dwordx4 v16,s[20:23],s65 offen offset:2048  lds
buffer_load_dwordx4 v16,s[20:23],s65 offen offset:3072  lds
s_add_u32 m0,s72,12288
s_add_u32 s65,s74,12288
buffer_load_dwordx4 v16,s[20:23],s65 offen offset:0  lds
buffer_load_dwordx4 v16,s[20:23],s65 offen offset:1024  lds
buffer_load_dwordx4 v16,s[20:23],s65 offen offset:2048  lds
buffer_load_dwordx4 v16,s[20:23],s65 offen offset:3072  lds
s_waitcnt vmcnt(0)
s_add_u32 s41,s58,55
s_sub_u32 s64,s58,1
s_cmp_lt_u32 s64,2
s_cselect_b32 s41,s41,64
s_lshl_b32 s76,s50,14
s_add_u32 s76,s76,57344
s_add_u32 s42,s55,32
s_lshl_b32 s42,s42,14
s_add_u32 s42,s42,136314880
s_xor_b32 s64,s62,8192
s_add_u32 s42,s42,s64
s_cmp_lt_u32 s55,96
s_cselect_b32 s42,s42,0x7fff0000
v_add_u32 v25,4096,v24
s_load_dwordx2 s[4:5],s[0:1],96
s_load_dwordx2 s[6:7],s[0:1],104
v_and_b32 v5,3,v0
v_lshrrev_b32 v6,2,v0
v_mul_u32_u24 v112,12288,v6
v_lshl_add_u32 v112,v5,4,v112
v_lshlrev_b32 v113,1,v6
s_add_u32 s43,s55,64
s_lshl_b32 s43,s43,6
s_mov_b32 s48,0
s_mov_b32 s80,0xffff0000
s_mov_b32 s81,0xbfb8aa3b
s_waitcnt lgkmcnt(0)
s_mov_b32 s12,s4
s_and_b32 s13,s5,0xffff
s_mov_b32 s14,0x800
s_mov_b32 s15,0x20000
s_mov_b32 s16,s6
s_and_b32 s17,s7,0xffff
s_mov_b32 s18,0xc00000
s_mov_b32 s19,0x20000
buffer_load_dwordx4 v[104:107],v112,s[16:19],s43 offen nt
buffer_load_ushort v108,v113,s[12:15],s48 offen
s_add_u32 s43,s43,786432
s_add_u32 s48,s48,128
buffer_load_dwordx4 v[116:119],v112,s[16:19],s43 offen nt
buffer_load_ushort v120,v113,s[12:15],s48 offen
s_add_u32 s43,s43,786432
s_add_u32 s48,s48,128
v_mov_b32 v96,0
v_mov_b32 v97,0
v_mov_b32 v98,0
v_mov_b32 v99,0
v_mov_b32 v100,0
v_mov_b32 v101,0
v_mov_b32 v102,0
v_mov_b32 v103,0
s_waitcnt vmcnt(0)
qloop_200:
s_lshr_b32 s64,s79,2
s_cmp_lg_u32 s64,4
s_cbranch_scc1 np2_202
s_waitcnt vmcnt(0)
s_barrier
s_cmp_lg_u32 s50,0
s_cbranch_scc1 ow_203
s_mov_b64 exec,1
v_mov_b32 v22,14
v_mov_b32 v23,0
s_mov_b32 s64,21052928
buffer_atomic_add v22,v23,s[20:23],s64 offen sc1
s_mov_b64 exec,-1
ow_203:
np2_202:
s_cmp_lg_u32 s79,s41
s_cbranch_scc1 npz_201
s_waitcnt vmcnt(0)
s_barrier
s_cmp_lg_u32 s50,0
s_cbranch_scc1 ow_204
s_mov_b64 exec,1
v_mov_b32 v22,14
v_mov_b32 v23,0
s_mov_b32 s64,21052992
buffer_atomic_add v22,v23,s[20:23],s64 offen sc1
s_mov_b64 exec,-1
ow_204:
s_cmp_lg_u32 s50,0
s_cbranch_scc1 ow_205
s_mov_b64 exec,1
v_mov_b32 v22,14
v_mov_b32 v23,0
buffer_store_dword v22,v23,s[20:23],s73 offen sc1
s_mov_b64 exec,-1
ow_205:
npz_201:
s_waitcnt vmcnt(8)
s_barrier
ds_read_b128 v[224:227],v17 offset:0
ds_read_b128 v[228:231],v17 offset:2048
ds_read_b128 v[232:235],v17 offset:4096
ds_read_b128 v[236:239],v17 offset:6144
ds_read_b128 v[240:243],v17 offset:8192
ds_read_b128 v[244:247],v17 offset:10240
ds_read_b128 v[248:251],v17 offset:12288
s_waitcnt lgkmcnt(5)
v_mfma_f32_16x16x32_bf16 v[64:67],a[0:3],v[224:227],0
s_xor_b32 s72,s72,0x10000
s_add_u32 s77,s79,2
v_mfma_f32_16x16x32_bf16 v[72:75],a[128:131],v[224:227],0
ds_read_b128 v[252:255],v17 offset:14336
s_cmp_lt_u32 s79,56
s_cselect_b32 s77,s41,s77
v_mfma_f32_16x16x32_bf16 v[64:67],a[4:7],v[228:231],v[64:67]
s_add_u32 s74,s79,4
s_cmp_lt_u32 s79,52
s_cselect_b32 s77,s74,s77
v_mfma_f32_16x16x32_bf16 v[72:75],a[132:135],v[228:231],v[72:75]
ds_read_b128 v[224:227],v17 offset:16384
s_waitcnt lgkmcnt(5)
v_mfma_f32_16x16x32_bf16 v[64:67],a[8:11],v[232:235],v[64:67]
s_lshl_b32 s74,s77,16
s_add_u32 s74,s74,s76
v_mfma_f32_16x16x32_bf16 v[72:75],a[136:139],v[232:235],v[72:75]
ds_read_b128 v[228:231],v17 offset:18432
s_add_u32 s64,s79,0
v_mfma_f32_16x16x32_bf16 v[64:67],a[12:15],v[236:239],v[64:67]
s_cmp_lt_u32 s77,64
s_cselect_b32 s74,s74,0x7fff0000
v_mfma_f32_16x16x32_bf16 v[72:75],a[140:143],v[236:239],v[72:75]
ds_read_b128 v[232:235],v17 offset:20480
s_waitcnt lgkmcnt(5)
v_mfma_f32_16x16x32_bf16 v[64:67],a[16:19],v[240:243],v[64:67]
s_add_u32 m0,s72,0
v_lshlrev_b32 v108,16,v108
v_mfma_f32_16x16x32_bf16 v[72:75],a[144:147],v[240:243],v[72:75]
ds_read_b128 v[236:239],v17 offset:22528
v_mul_f32 v109,s81,v108
v_mfma_f32_16x16x32_bf16 v[64:67],a[20:23],v[244:247],v[64:67]
s_lshl_b32 s70,s64,21
v_mfma_f32_16x16x32_bf16 v[72:75],a[148:151],v[244:247],v[72:75]
ds_read_b128 v[240:243],v17 offset:24576
s_waitcnt lgkmcnt(5)
v_mfma_f32_16x16x32_bf16 v[64:67],a[24:27],v[248:251],v[64:67]
s_add_u32 s65,s74,0
v_mfma_f32_16x16x32_bf16 v[72:75],a[152:155],v[248:251],v[72:75]
ds_read_b128 v[244:247],v17 offset:26624
v_mfma_f32_16x16x32_bf16 v[64:67],a[28:31],v[252:255],v[64:67]
buffer_load_dwordx4 v16,s[20:23],s65 offen offset:0  lds
v_mfma_f32_16x16x32_bf16 v[72:75],a[156:159],v[252:255],v[72:75]
ds_read_b128 v[248:251],v17 offset:28672
s_waitcnt lgkmcnt(5)
v_mfma_f32_16x16x32_bf16 v[64:67],a[32:35],v[224:227],v[64:67]
s_lshl_b32 s64,s64,13
v_mfma_f32_16x16x32_bf16 v[72:75],a[160:163],v[224:227],v[72:75]
ds_read_b128 v[252:255],v17 offset:30720
v_mfma_f32_16x16x32_bf16 v[64:67],a[36:39],v[228:231],v[64:67]
buffer_load_dwordx4 v16,s[20:23],s65 offen offset:1024  lds
v_mfma_f32_16x16x32_bf16 v[72:75],a[164:167],v[228:231],v[72:75]
ds_read_b128 v[224:227],v17 offset:32768
s_waitcnt lgkmcnt(5)
v_mfma_f32_16x16x32_bf16 v[64:67],a[40:43],v[232:235],v[64:67]
buffer_load_dwordx4 v16,s[20:23],s65 offen offset:2048  lds
v_mfma_f32_16x16x32_bf16 v[72:75],a[168:171],v[232:235],v[72:75]
ds_read_b128 v[228:231],v17 offset:34816
s_and_b32 s64,s64,0x2000
v_mfma_f32_16x16x32_bf16 v[64:67],a[44:47],v[236:239],v[64:67]
v_exp_f32 v109,v109
v_mfma_f32_16x16x32_bf16 v[72:75],a[172:175],v[236:239],v[72:75]
ds_read_b128 v[232:235],v17 offset:36864
s_waitcnt lgkmcnt(5)
v_mfma_f32_16x16x32_bf16 v[64:67],a[48:51],v[240:243],v[64:67]
buffer_load_dwordx4 v16,s[20:23],s65 offen offset:3072  lds
v_mfma_f32_16x16x32_bf16 v[72:75],a[176:179],v[240:243],v[72:75]
ds_read_b128 v[236:239],v17 offset:38912
s_xor_b32 s64,s64,s62
v_mfma_f32_16x16x32_bf16 v[64:67],a[52:55],v[244:247],v[64:67]
s_add_u32 m0,s72,4096
v_add_f32 v109,1.0,v109
v_mfma_f32_16x16x32_bf16 v[72:75],a[180:183],v[244:247],v[72:75]
ds_read_b128 v[240:243],v17 offset:40960
s_waitcnt lgkmcnt(5)
v_mfma_f32_16x16x32_bf16 v[64:67],a[56:59],v[248:251],v[64:67]
v_rcp_f32 v109,v109
v_mfma_f32_16x16x32_bf16 v[72:75],a[184:187],v[248:251],v[72:75]
ds_read_b128 v[244:247],v17 offset:43008
s_add_u32 s65,s74,4096
v_mfma_f32_16x16x32_bf16 v[64:67],a[60:63],v[252:255],v[64:67]
s_add_u32 s70,s70,s64
v_mul_f32 v109,v109,v108
v_mfma_f32_16x16x32_bf16 v[72:75],a[188:191],v[252:255],v[72:75]
ds_read_b128 v[248:251],v17 offset:45056
s_waitcnt lgkmcnt(5)
v_mfma_f32_16x16x32_bf16 v[64:67],a[64:67],v[224:227],v[64:67]
buffer_load_dwordx4 v16,s[20:23],s65 offen offset:0  lds
v_mfma_f32_16x16x32_bf16 v[72:75],a[192:195],v[224:227],v[72:75]
ds_read_b128 v[252:255],v17 offset:47104
v_cvt_pk_bf16_f32 v109,v109,v109
v_mfma_f32_16x16x32_bf16 v[64:67],a[68:71],v[228:231],v[64:67]
v_and_b32 v108,s80,v109
v_lshlrev_b32 v110,16,v104
v_mfma_f32_16x16x32_bf16 v[72:75],a[196:199],v[228:231],v[72:75]
ds_read_b128 v[224:227],v17 offset:49152
s_waitcnt lgkmcnt(5)
v_mfma_f32_16x16x32_bf16 v[64:67],a[72:75],v[232:235],v[64:67]
buffer_load_dwordx4 v16,s[20:23],s65 offen offset:1024  lds
v_mfma_f32_16x16x32_bf16 v[72:75],a[200:203],v[232:235],v[72:75]
ds_read_b128 v[228:231],v17 offset:51200
s_add_u32 s70,s70,29360128
v_mfma_f32_16x16x32_bf16 v[64:67],a[76:79],v[236:239],v[64:67]
buffer_load_dwordx4 v16,s[20:23],s65 offen offset:2048  lds
v_mfma_f32_16x16x32_bf16 v[72:75],a[204:207],v[236:239],v[72:75]
ds_read_b128 v[232:235],v17 offset:53248
s_waitcnt lgkmcnt(5)
v_mfma_f32_16x16x32_bf16 v[64:67],a[80:83],v[240:243],v[64:67]
v_and_b32 v111,s80,v104
v_fmac_f32 v96,v110,v108
v_mfma_f32_16x16x32_bf16 v[72:75],a[208:211],v[240:243],v[72:75]
ds_read_b128 v[236:239],v17 offset:55296
v_fmac_f32 v97,v111,v108
v_mfma_f32_16x16x32_bf16 v[64:67],a[84:87],v[244:247],v[64:67]
buffer_load_dwordx4 v16,s[20:23],s65 offen offset:3072  lds
v_mfma_f32_16x16x32_bf16 v[72:75],a[212:215],v[244:247],v[72:75]
ds_read_b128 v[240:243],v17 offset:57344
s_waitcnt lgkmcnt(5)
v_mfma_f32_16x16x32_bf16 v[64:67],a[88:91],v[248:251],v[64:67]
s_add_u32 m0,s72,8192
v_lshlrev_b32 v110,16,v105
v_mfma_f32_16x16x32_bf16 v[72:75],a[216:219],v[248:251],v[72:75]
ds_read_b128 v[244:247],v17 offset:59392
v_and_b32 v111,s80,v105
v_mfma_f32_16x16x32_bf16 v[64:67],a[92:95],v[252:255],v[64:67]
v_fmac_f32 v98,v110,v108
v_fmac_f32 v99,v111,v108
v_mfma_f32_16x16x32_bf16 v[72:75],a[220:223],v[252:255],v[72:75]
ds_read_b128 v[248:251],v17 offset:61440
s_waitcnt lgkmcnt(5)
v_mfma_f32_16x16x32_bf16 v[64:67],a[96:99],v[224:227],v[64:67]
s_add_u32 s65,s74,8192
v_lshlrev_b32 v110,16,v106
v_mfma_f32_16x16x32_bf16 v[72:75],a[224:227],v[224:227],v[72:75]
ds_read_b128 v[252:255],v17 offset:63488
v_and_b32 v111,s80,v106
v_mfma_f32_16x16x32_bf16 v[64:67],a[100:103],v[228:231],v[64:67]
buffer_load_dwordx4 v16,s[20:23],s65 offen offset:0  lds
v_mfma_f32_16x16x32_bf16 v[72:75],a[228:231],v[228:231],v[72:75]
ds_read_b128 v[224:227],v17 offset:1024
s_waitcnt lgkmcnt(5)
v_mfma_f32_16x16x32_bf16 v[64:67],a[104:107],v[232:235],v[64:67]
v_fmac_f32 v100,v110,v108
v_fmac_f32 v101,v111,v108
v_mfma_f32_16x16x32_bf16 v[72:75],a[232:235],v[232:235],v[72:75]
ds_read_b128 v[228:231],v17 offset:3072
v_lshlrev_b32 v110,16,v107
v_mfma_f32_16x16x32_bf16 v[64:67],a[108:111],v[236:239],v[64:67]
buffer_load_dwordx4 v16,s[20:23],s65 offen offset:1024  lds
v_mfma_f32_16x16x32_bf16 v[72:75],a[236:239],v[236:239],v[72:75]
ds_read_b128 v[232:235],v17 offset:5120
s_waitcnt lgkmcnt(5)
v_mfma_f32_16x16x32_bf16 v[64:67],a[112:115],v[240:243],v[64:67]
buffer_load_dwordx4 v16,s[20:23],s65 offen offset:2048  lds
v_mfma_f32_16x16x32_bf16 v[72:75],a[240:243],v[240:243],v[72:75]
ds_read_b128 v[236:239],v17 offset:7168
v_and_b32 v111,s80,v107
v_mfma_f32_16x16x32_bf16 v[64:67],a[116:119],v[244:247],v[64:67]
v_fmac_f32 v102,v110,v108
v_fmac_f32 v103,v111,v108
v_mfma_f32_16x16x32_bf16 v[72:75],a[244:247],v[244:247],v[72:75]
ds_read_b128 v[240:243],v17 offset:9216
s_waitcnt lgkmcnt(5)
v_mfma_f32_16x16x32_bf16 v[64:67],a[120:123],v[248:251],v[64:67]
buffer_load_dwordx4 v16,s[20:23],s65 offen offset:3072  lds
v_mfma_f32_16x16x32_bf16 v[72:75],a[248:251],v[248:251],v[72:75]
ds_read_b128 v[244:247],v17 offset:11264
v_mfma_f32_16x16x32_bf16 v[64:67],a[124:127],v[252:255],v[64:67]
s_add_u32 m0,s72,12288
v_mfma_f32_16x16x32_bf16 v[72:75],a[252:255],v[252:255],v[72:75]
ds_read_b128 v[248:251],v17 offset:13312
s_waitcnt lgkmcnt(5)
v_mfma_f32_16x16x32_bf16 v[68:71],a[0:3],v[224:227],0
v_mfma_f32_16x16x32_bf16 v[76:79],a[128:131],v[224:227],0
ds_read_b128 v[252:255],v17 offset:15360
s_add_u32 s65,s74,12288
v_mfma_f32_16x16x32_bf16 v[68:71],a[4:7],v[228:231],v[68:71]
v_mfma_f32_16x16x32_bf16 v[76:79],a[132:135],v[228:231],v[76:79]
ds_read_b128 v[224:227],v17 offset:17408
s_waitcnt lgkmcnt(5)
v_mfma_f32_16x16x32_bf16 v[68:71],a[8:11],v[232:235],v[68:71]
buffer_load_dwordx4 v16,s[20:23],s65 offen offset:0  lds
v_mfma_f32_16x16x32_bf16 v[76:79],a[136:139],v[232:235],v[76:79]
ds_read_b128 v[228:231],v17 offset:19456
v_cvt_pk_bf16_f32 v88,v64,v65
v_mfma_f32_16x16x32_bf16 v[68:71],a[12:15],v[236:239],v[68:71]
v_cvt_pk_bf16_f32 v89,v66,v67
v_cvt_pk_bf16_f32 v90,v72,v73
v_mfma_f32_16x16x32_bf16 v[76:79],a[140:143],v[236:239],v[76:79]
ds_read_b128 v[232:235],v17 offset:21504
s_waitcnt lgkmcnt(5)
v_mfma_f32_16x16x32_bf16 v[68:71],a[16:19],v[240:243],v[68:71]
buffer_load_dwordx4 v16,s[20:23],s65 offen offset:1024  lds
v_mfma_f32_16x16x32_bf16 v[76:79],a[144:147],v[240:243],v[76:79]
ds_read_b128 v[236:239],v17 offset:23552
v_cvt_pk_bf16_f32 v91,v74,v75
v_mfma_f32_16x16x32_bf16 v[68:71],a[20:23],v[244:247],v[68:71]
buffer_load_dwordx4 v16,s[20:23],s65 offen offset:2048  lds
v_mfma_f32_16x16x32_bf16 v[76:79],a[148:151],v[244:247],v[76:79]
ds_read_b128 v[240:243],v17 offset:25600
s_waitcnt lgkmcnt(5)
v_mfma_f32_16x16x32_bf16 v[68:71],a[24:27],v[248:251],v[68:71]
v_mfma_f32_16x16x32_bf16 v[76:79],a[152:155],v[248:251],v[76:79]
ds_read_b128 v[244:247],v17 offset:27648
v_mfma_f32_16x16x32_bf16 v[68:71],a[28:31],v[252:255],v[68:71]
buffer_load_dwordx4 v16,s[20:23],s65 offen offset:3072  lds
v_mfma_f32_16x16x32_bf16 v[76:79],a[156:159],v[252:255],v[76:79]
ds_read_b128 v[248:251],v17 offset:29696
s_waitcnt lgkmcnt(5)
v_mfma_f32_16x16x32_bf16 v[68:71],a[32:35],v[224:227],v[68:71]
v_mfma_f32_16x16x32_bf16 v[76:79],a[160:163],v[224:227],v[76:79]
ds_read_b128 v[252:255],v17 offset:31744
v_mfma_f32_16x16x32_bf16 v[68:71],a[36:39],v[228:231],v[68:71]
v_mfma_f32_16x16x32_bf16 v[76:79],a[164:167],v[228:231],v[76:79]
ds_read_b128 v[224:227],v17 offset:33792
s_waitcnt lgkmcnt(5)
v_mfma_f32_16x16x32_bf16 v[68:71],a[40:43],v[232:235],v[68:71]
buffer_store_dwordx4 v[88:91],v18,s[20:23],s70 offen offset:0 sc1
v_mfma_f32_16x16x32_bf16 v[76:79],a[168:171],v[232:235],v[76:79]
ds_read_b128 v[228:231],v17 offset:35840
v_mfma_f32_16x16x32_bf16 v[68:71],a[44:47],v[236:239],v[68:71]
buffer_load_dwordx4 v[104:107],v112,s[16:19],s43 offen nt
v_mfma_f32_16x16x32_bf16 v[76:79],a[172:175],v[236:239],v[76:79]
ds_read_b128 v[232:235],v17 offset:37888
s_waitcnt lgkmcnt(5)
v_mfma_f32_16x16x32_bf16 v[68:71],a[48:51],v[240:243],v[68:71]
v_mfma_f32_16x16x32_bf16 v[76:79],a[176:179],v[240:243],v[76:79]
ds_read_b128 v[236:239],v17 offset:39936
v_mfma_f32_16x16x32_bf16 v[68:71],a[52:55],v[244:247],v[68:71]
buffer_load_ushort v108,v113,s[12:15],s48 offen
v_mfma_f32_16x16x32_bf16 v[76:79],a[180:183],v[244:247],v[76:79]
ds_read_b128 v[240:243],v17 offset:41984
s_waitcnt lgkmcnt(5)
v_mfma_f32_16x16x32_bf16 v[68:71],a[56:59],v[248:251],v[68:71]
s_add_u32 s43,s43,786432
v_mfma_f32_16x16x32_bf16 v[76:79],a[184:187],v[248:251],v[76:79]
ds_read_b128 v[244:247],v17 offset:44032
v_mfma_f32_16x16x32_bf16 v[68:71],a[60:63],v[252:255],v[68:71]
v_mfma_f32_16x16x32_bf16 v[76:79],a[188:191],v[252:255],v[76:79]
ds_read_b128 v[248:251],v17 offset:46080
s_waitcnt lgkmcnt(5)
v_mfma_f32_16x16x32_bf16 v[68:71],a[64:67],v[224:227],v[68:71]
s_add_u32 s48,s48,128
v_mfma_f32_16x16x32_bf16 v[76:79],a[192:195],v[224:227],v[76:79]
ds_read_b128 v[252:255],v17 offset:48128
v_mfma_f32_16x16x32_bf16 v[68:71],a[68:71],v[228:231],v[68:71]
buffer_store_dwordx4 v[48:51],v24,s[20:23],s93 offen sc1
v_mfma_f32_16x16x32_bf16 v[76:79],a[196:199],v[228:231],v[76:79]
ds_read_b128 v[224:227],v17 offset:50176
s_waitcnt lgkmcnt(5)
v_mfma_f32_16x16x32_bf16 v[68:71],a[72:75],v[232:235],v[68:71]
v_mfma_f32_16x16x32_bf16 v[76:79],a[200:203],v[232:235],v[76:79]
ds_read_b128 v[228:231],v17 offset:52224
v_mfma_f32_16x16x32_bf16 v[68:71],a[76:79],v[236:239],v[68:71]
buffer_store_dwordx4 v[48:51],v25,s[20:23],s93 offen sc1
v_mfma_f32_16x16x32_bf16 v[76:79],a[204:207],v[236:239],v[76:79]
ds_read_b128 v[232:235],v17 offset:54272
s_waitcnt lgkmcnt(5)
v_mfma_f32_16x16x32_bf16 v[68:71],a[80:83],v[240:243],v[68:71]
s_add_u32 s93,s93,8388608
v_mfma_f32_16x16x32_bf16 v[76:79],a[208:211],v[240:243],v[76:79]
ds_read_b128 v[236:239],v17 offset:56320
v_mfma_f32_16x16x32_bf16 v[68:71],a[84:87],v[244:247],v[68:71]
v_mfma_f32_16x16x32_bf16 v[76:79],a[212:215],v[244:247],v[76:79]
ds_read_b128 v[240:243],v17 offset:58368
s_waitcnt lgkmcnt(5)
v_mfma_f32_16x16x32_bf16 v[68:71],a[88:91],v[248:251],v[68:71]
s_cmp_lt_u32 s93,163577856
s_cselect_b32 s93,s93,0x7fff0000
v_mfma_f32_16x16x32_bf16 v[76:79],a[216:219],v[248:251],v[76:79]
ds_read_b128 v[244:247],v17 offset:60416
v_mfma_f32_16x16x32_bf16 v[68:71],a[92:95],v[252:255],v[68:71]
buffer_store_dwordx4 v[48:51],v24,s[20:23],s42 offen sc1
v_mfma_f32_16x16x32_bf16 v[76:79],a[220:223],v[252:255],v[76:79]
ds_read_b128 v[248:251],v17 offset:62464
s_waitcnt lgkmcnt(5)
v_mfma_f32_16x16x32_bf16 v[68:71],a[96:99],v[224:227],v[68:71]
v_mfma_f32_16x16x32_bf16 v[76:79],a[224:227],v[224:227],v[76:79]
ds_read_b128 v[252:255],v17 offset:64512
v_mfma_f32_16x16x32_bf16 v[68:71],a[100:103],v[228:231],v[68:71]
buffer_store_dwordx4 v[48:51],v25,s[20:23],s42 offen sc1
v_mfma_f32_16x16x32_bf16 v[76:79],a[228:231],v[228:231],v[76:79]
s_waitcnt lgkmcnt(4)
v_mfma_f32_16x16x32_bf16 v[68:71],a[104:107],v[232:235],v[68:71]
s_add_u32 s42,s42,2097152
v_mfma_f32_16x16x32_bf16 v[76:79],a[232:235],v[232:235],v[76:79]
v_mfma_f32_16x16x32_bf16 v[68:71],a[108:111],v[236:239],v[68:71]
v_mfma_f32_16x16x32_bf16 v[76:79],a[236:239],v[236:239],v[76:79]
s_xor_b32 s42,s42,0x2000
s_waitcnt lgkmcnt(2)
v_mfma_f32_16x16x32_bf16 v[68:71],a[112:115],v[240:243],v[68:71]
v_mfma_f32_16x16x32_bf16 v[76:79],a[240:243],v[240:243],v[76:79]
v_mfma_f32_16x16x32_bf16 v[68:71],a[116:119],v[244:247],v[68:71]
s_cmp_lt_u32 s42,165675008
s_cselect_b32 s42,s42,0x7fff0000
v_mfma_f32_16x16x32_bf16 v[76:79],a[244:247],v[244:247],v[76:79]
s_waitcnt lgkmcnt(0)
v_mfma_f32_16x16x32_bf16 v[68:71],a[120:123],v[248:251],v[68:71]
v_mfma_f32_16x16x32_bf16 v[76:79],a[248:251],v[248:251],v[76:79]
v_mfma_f32_16x16x32_bf16 v[68:71],a[124:127],v[252:255],v[68:71]
v_mfma_f32_16x16x32_bf16 v[76:79],a[252:255],v[252:255],v[76:79]
v_xor_b32 v17,0x10000,v17
s_mov_b32 s79,s77
s_nop 4
v_cvt_pk_bf16_f32 v92,v68,v69
v_cvt_pk_bf16_f32 v93,v70,v71
v_cvt_pk_bf16_f32 v94,v76,v77
v_cvt_pk_bf16_f32 v95,v78,v79
buffer_store_dwordx4 v[92:95],v18,s[20:23],s70 offen offset:1024 sc1
s_waitcnt vmcnt(8)
s_barrier
ds_read_b128 v[224:227],v17 offset:0
ds_read_b128 v[228:231],v17 offset:2048
ds_read_b128 v[232:235],v17 offset:4096
ds_read_b128 v[236:239],v17 offset:6144
ds_read_b128 v[240:243],v17 offset:8192
ds_read_b128 v[244:247],v17 offset:10240
ds_read_b128 v[248:251],v17 offset:12288
s_waitcnt lgkmcnt(5)
v_mfma_f32_16x16x32_bf16 v[64:67],a[0:3],v[224:227],0
s_xor_b32 s72,s72,0x10000
s_add_u32 s77,s79,2
v_mfma_f32_16x16x32_bf16 v[72:75],a[128:131],v[224:227],0
ds_read_b128 v[252:255],v17 offset:14336
s_cmp_lt_u32 s79,56
s_cselect_b32 s77,s41,s77
v_mfma_f32_16x16x32_bf16 v[64:67],a[4:7],v[228:231],v[64:67]
s_add_u32 s74,s79,4
s_cmp_lt_u32 s79,52
s_cselect_b32 s77,s74,s77
v_mfma_f32_16x16x32_bf16 v[72:75],a[132:135],v[228:231],v[72:75]
ds_read_b128 v[224:227],v17 offset:16384
s_waitcnt lgkmcnt(5)
v_mfma_f32_16x16x32_bf16 v[64:67],a[8:11],v[232:235],v[64:67]
s_lshl_b32 s74,s77,16
s_add_u32 s74,s74,s76
v_mfma_f32_16x16x32_bf16 v[72:75],a[136:139],v[232:235],v[72:75]
ds_read_b128 v[228:231],v17 offset:18432
s_add_u32 s64,s79,0
v_mfma_f32_16x16x32_bf16 v[64:67],a[12:15],v[236:239],v[64:67]
s_cmp_lt_u32 s77,64
s_cselect_b32 s74,s74,0x7fff0000
v_mfma_f32_16x16x32_bf16 v[72:75],a[140:143],v[236:239],v[72:75]
ds_read_b128 v[232:235],v17 offset:20480
s_waitcnt lgkmcnt(5)
v_mfma_f32_16x16x32_bf16 v[64:67],a[16:19],v[240:243],v[64:67]
s_add_u32 m0,s72,0
v_lshlrev_b32 v120,16,v120
v_mfma_f32_16x16x32_bf16 v[72:75],a[144:147],v[240:243],v[72:75]
ds_read_b128 v[236:239],v17 offset:22528
v_mul_f32 v109,s81,v120
v_mfma_f32_16x16x32_bf16 v[64:67],a[20:23],v[244:247],v[64:67]
s_lshl_b32 s70,s64,21
v_mfma_f32_16x16x32_bf16 v[72:75],a[148:151],v[244:247],v[72:75]
ds_read_b128 v[240:243],v17 offset:24576
s_waitcnt lgkmcnt(5)
v_mfma_f32_16x16x32_bf16 v[64:67],a[24:27],v[248:251],v[64:67]
s_add_u32 s65,s74,0
v_mfma_f32_16x16x32_bf16 v[72:75],a[152:155],v[248:251],v[72:75]
ds_read_b128 v[244:247],v17 offset:26624
v_mfma_f32_16x16x32_bf16 v[64:67],a[28:31],v[252:255],v[64:67]
buffer_load_dwordx4 v16,s[20:23],s65 offen offset:0  lds
v_mfma_f32_16x16x32_bf16 v[72:75],a[156:159],v[252:255],v[72:75]
ds_read_b128 v[248:251],v17 offset:28672
s_waitcnt lgkmcnt(5)
v_mfma_f32_16x16x32_bf16 v[64:67],a[32:35],v[224:227],v[64:67]
s_lshl_b32 s64,s64,13
v_mfma_f32_16x16x32_bf16 v[72:75],a[160:163],v[224:227],v[72:75]
ds_read_b128 v[252:255],v17 offset:30720
v_mfma_f32_16x16x32_bf16 v[64:67],a[36:39],v[228:231],v[64:67]
buffer_load_dwordx4 v16,s[20:23],s65 offen offset:1024  lds
v_mfma_f32_16x16x32_bf16 v[72:75],a[164:167],v[228:231],v[72:75]
ds_read_b128 v[224:227],v17 offset:32768
s_waitcnt lgkmcnt(5)
v_mfma_f32_16x16x32_bf16 v[64:67],a[40:43],v[232:235],v[64:67]
buffer_load_dwordx4 v16,s[20:23],s65 offen offset:2048  lds
v_mfma_f32_16x16x32_bf16 v[72:75],a[168:171],v[232:235],v[72:75]
ds_read_b128 v[228:231],v17 offset:34816
s_and_b32 s64,s64,0x2000
v_mfma_f32_16x16x32_bf16 v[64:67],a[44:47],v[236:239],v[64:67]
v_exp_f32 v109,v109
v_mfma_f32_16x16x32_bf16 v[72:75],a[172:175],v[236:239],v[72:75]
ds_read_b128 v[232:235],v17 offset:36864
s_waitcnt lgkmcnt(5)
v_mfma_f32_16x16x32_bf16 v[64:67],a[48:51],v[240:243],v[64:67]
buffer_load_dwordx4 v16,s[20:23],s65 offen offset:3072  lds
v_mfma_f32_16x16x32_bf16 v[72:75],a[176:179],v[240:243],v[72:75]
ds_read_b128 v[236:239],v17 offset:38912
s_xor_b32 s64,s64,s62
v_mfma_f32_16x16x32_bf16 v[64:67],a[52:55],v[244:247],v[64:67]
s_add_u32 m0,s72,4096
v_add_f32 v109,1.0,v109
v_mfma_f32_16x16x32_bf16 v[72:75],a[180:183],v[244:247],v[72:75]
ds_read_b128 v[240:243],v17 offset:40960
s_waitcnt lgkmcnt(5)
v_mfma_f32_16x16x32_bf16 v[64:67],a[56:59],v[248:251],v[64:67]
v_rcp_f32 v109,v109
v_mfma_f32_16x16x32_bf16 v[72:75],a[184:187],v[248:251],v[72:75]
ds_read_b128 v[244:247],v17 offset:43008
s_add_u32 s65,s74,4096
v_mfma_f32_16x16x32_bf16 v[64:67],a[60:63],v[252:255],v[64:67]
s_add_u32 s70,s70,s64
v_mul_f32 v109,v109,v120
v_mfma_f32_16x16x32_bf16 v[72:75],a[188:191],v[252:255],v[72:75]
ds_read_b128 v[248:251],v17 offset:45056
s_waitcnt lgkmcnt(5)
v_mfma_f32_16x16x32_bf16 v[64:67],a[64:67],v[224:227],v[64:67]
buffer_load_dwordx4 v16,s[20:23],s65 offen offset:0  lds
v_mfma_f32_16x16x32_bf16 v[72:75],a[192:195],v[224:227],v[72:75]
ds_read_b128 v[252:255],v17 offset:47104
v_cvt_pk_bf16_f32 v109,v109,v109
v_mfma_f32_16x16x32_bf16 v[64:67],a[68:71],v[228:231],v[64:67]
v_and_b32 v120,s80,v109
v_lshlrev_b32 v110,16,v116
v_mfma_f32_16x16x32_bf16 v[72:75],a[196:199],v[228:231],v[72:75]
ds_read_b128 v[224:227],v17 offset:49152
s_waitcnt lgkmcnt(5)
v_mfma_f32_16x16x32_bf16 v[64:67],a[72:75],v[232:235],v[64:67]
buffer_load_dwordx4 v16,s[20:23],s65 offen offset:1024  lds
v_mfma_f32_16x16x32_bf16 v[72:75],a[200:203],v[232:235],v[72:75]
ds_read_b128 v[228:231],v17 offset:51200
s_add_u32 s70,s70,29360128
v_mfma_f32_16x16x32_bf16 v[64:67],a[76:79],v[236:239],v[64:67]
buffer_load_dwordx4 v16,s[20:23],s65 offen offset:2048  lds
v_mfma_f32_16x16x32_bf16 v[72:75],a[204:207],v[236:239],v[72:75]
ds_read_b128 v[232:235],v17 offset:53248
s_waitcnt lgkmcnt(5)
v_mfma_f32_16x16x32_bf16 v[64:67],a[80:83],v[240:243],v[64:67]
v_and_b32 v111,s80,v116
v_fmac_f32 v96,v110,v120
v_mfma_f32_16x16x32_bf16 v[72:75],a[208:211],v[240:243],v[72:75]
ds_read_b128 v[236:239],v17 offset:55296
v_fmac_f32 v97,v111,v120
v_mfma_f32_16x16x32_bf16 v[64:67],a[84:87],v[244:247],v[64:67]
buffer_load_dwordx4 v16,s[20:23],s65 offen offset:3072  lds
v_mfma_f32_16x16x32_bf16 v[72:75],a[212:215],v[244:247],v[72:75]
ds_read_b128 v[240:243],v17 offset:57344
s_waitcnt lgkmcnt(5)
v_mfma_f32_16x16x32_bf16 v[64:67],a[88:91],v[248:251],v[64:67]
s_add_u32 m0,s72,8192
v_lshlrev_b32 v110,16,v117
v_mfma_f32_16x16x32_bf16 v[72:75],a[216:219],v[248:251],v[72:75]
ds_read_b128 v[244:247],v17 offset:59392
v_and_b32 v111,s80,v117
v_mfma_f32_16x16x32_bf16 v[64:67],a[92:95],v[252:255],v[64:67]
v_fmac_f32 v98,v110,v120
v_fmac_f32 v99,v111,v120
v_mfma_f32_16x16x32_bf16 v[72:75],a[220:223],v[252:255],v[72:75]
ds_read_b128 v[248:251],v17 offset:61440
s_waitcnt lgkmcnt(5)
v_mfma_f32_16x16x32_bf16 v[64:67],a[96:99],v[224:227],v[64:67]
s_add_u32 s65,s74,8192
v_lshlrev_b32 v110,16,v118
v_mfma_f32_16x16x32_bf16 v[72:75],a[224:227],v[224:227],v[72:75]
ds_read_b128 v[252:255],v17 offset:63488
v_and_b32 v111,s80,v118
v_mfma_f32_16x16x32_bf16 v[64:67],a[100:103],v[228:231],v[64:67]
buffer_load_dwordx4 v16,s[20:23],s65 offen offset:0  lds
v_mfma_f32_16x16x32_bf16 v[72:75],a[228:231],v[228:231],v[72:75]
ds_read_b128 v[224:227],v17 offset:1024
s_waitcnt lgkmcnt(5)
v_mfma_f32_16x16x32_bf16 v[64:67],a[104:107],v[232:235],v[64:67]
v_fmac_f32 v100,v110,v120
v_fmac_f32 v101,v111,v120
v_mfma_f32_16x16x32_bf16 v[72:75],a[232:235],v[232:235],v[72:75]
ds_read_b128 v[228:231],v17 offset:3072
v_lshlrev_b32 v110,16,v119
v_mfma_f32_16x16x32_bf16 v[64:67],a[108:111],v[236:239],v[64:67]
buffer_load_dwordx4 v16,s[20:23],s65 offen offset:1024  lds
v_mfma_f32_16x16x32_bf16 v[72:75],a[236:239],v[236:239],v[72:75]
ds_read_b128 v[232:235],v17 offset:5120
s_waitcnt lgkmcnt(5)
v_mfma_f32_16x16x32_bf16 v[64:67],a[112:115],v[240:243],v[64:67]
buffer_load_dwordx4 v16,s[20:23],s65 offen offset:2048  lds
v_mfma_f32_16x16x32_bf16 v[72:75],a[240:243],v[240:243],v[72:75]
ds_read_b128 v[236:239],v17 offset:7168
v_and_b32 v111,s80,v119
v_mfma_f32_16x16x32_bf16 v[64:67],a[116:119],v[244:247],v[64:67]
v_fmac_f32 v102,v110,v120
v_fmac_f32 v103,v111,v120
v_mfma_f32_16x16x32_bf16 v[72:75],a[244:247],v[244:247],v[72:75]
ds_read_b128 v[240:243],v17 offset:9216
s_waitcnt lgkmcnt(5)
v_mfma_f32_16x16x32_bf16 v[64:67],a[120:123],v[248:251],v[64:67]
buffer_load_dwordx4 v16,s[20:23],s65 offen offset:3072  lds
v_mfma_f32_16x16x32_bf16 v[72:75],a[248:251],v[248:251],v[72:75]
ds_read_b128 v[244:247],v17 offset:11264
v_mfma_f32_16x16x32_bf16 v[64:67],a[124:127],v[252:255],v[64:67]
s_add_u32 m0,s72,12288
v_mfma_f32_16x16x32_bf16 v[72:75],a[252:255],v[252:255],v[72:75]
ds_read_b128 v[248:251],v17 offset:13312
s_waitcnt lgkmcnt(5)
v_mfma_f32_16x16x32_bf16 v[68:71],a[0:3],v[224:227],0
v_mfma_f32_16x16x32_bf16 v[76:79],a[128:131],v[224:227],0
ds_read_b128 v[252:255],v17 offset:15360
s_add_u32 s65,s74,12288
v_mfma_f32_16x16x32_bf16 v[68:71],a[4:7],v[228:231],v[68:71]
v_mfma_f32_16x16x32_bf16 v[76:79],a[132:135],v[228:231],v[76:79]
ds_read_b128 v[224:227],v17 offset:17408
s_waitcnt lgkmcnt(5)
v_mfma_f32_16x16x32_bf16 v[68:71],a[8:11],v[232:235],v[68:71]
buffer_load_dwordx4 v16,s[20:23],s65 offen offset:0  lds
v_mfma_f32_16x16x32_bf16 v[76:79],a[136:139],v[232:235],v[76:79]
ds_read_b128 v[228:231],v17 offset:19456
v_cvt_pk_bf16_f32 v88,v64,v65
v_mfma_f32_16x16x32_bf16 v[68:71],a[12:15],v[236:239],v[68:71]
v_cvt_pk_bf16_f32 v89,v66,v67
v_cvt_pk_bf16_f32 v90,v72,v73
v_mfma_f32_16x16x32_bf16 v[76:79],a[140:143],v[236:239],v[76:79]
ds_read_b128 v[232:235],v17 offset:21504
s_waitcnt lgkmcnt(5)
v_mfma_f32_16x16x32_bf16 v[68:71],a[16:19],v[240:243],v[68:71]
buffer_load_dwordx4 v16,s[20:23],s65 offen offset:1024  lds
v_mfma_f32_16x16x32_bf16 v[76:79],a[144:147],v[240:243],v[76:79]
ds_read_b128 v[236:239],v17 offset:23552
v_cvt_pk_bf16_f32 v91,v74,v75
v_mfma_f32_16x16x32_bf16 v[68:71],a[20:23],v[244:247],v[68:71]
buffer_load_dwordx4 v16,s[20:23],s65 offen offset:2048  lds
v_mfma_f32_16x16x32_bf16 v[76:79],a[148:151],v[244:247],v[76:79]
ds_read_b128 v[240:243],v17 offset:25600
s_waitcnt lgkmcnt(5)
v_mfma_f32_16x16x32_bf16 v[68:71],a[24:27],v[248:251],v[68:71]
v_mfma_f32_16x16x32_bf16 v[76:79],a[152:155],v[248:251],v[76:79]
ds_read_b128 v[244:247],v17 offset:27648
v_mfma_f32_16x16x32_bf16 v[68:71],a[28:31],v[252:255],v[68:71]
buffer_load_dwordx4 v16,s[20:23],s65 offen offset:3072  lds
v_mfma_f32_16x16x32_bf16 v[76:79],a[156:159],v[252:255],v[76:79]
ds_read_b128 v[248:251],v17 offset:29696
s_waitcnt lgkmcnt(5)
v_mfma_f32_16x16x32_bf16 v[68:71],a[32:35],v[224:227],v[68:71]
v_mfma_f32_16x16x32_bf16 v[76:79],a[160:163],v[224:227],v[76:79]
ds_read_b128 v[252:255],v17 offset:31744
v_mfma_f32_16x16x32_bf16 v[68:71],a[36:39],v[228:231],v[68:71]
v_mfma_f32_16x16x32_bf16 v[76:79],a[164:167],v[228:231],v[76:79]
ds_read_b128 v[224:227],v17 offset:33792
s_waitcnt lgkmcnt(5)
v_mfma_f32_16x16x32_bf16 v[68:71],a[40:43],v[232:235],v[68:71]
buffer_store_dwordx4 v[88:91],v18,s[20:23],s70 offen offset:0 sc1
v_mfma_f32_16x16x32_bf16 v[76:79],a[168:171],v[232:235],v[76:79]
ds_read_b128 v[228:231],v17 offset:35840
v_mfma_f32_16x16x32_bf16 v[68:71],a[44:47],v[236:239],v[68:71]
buffer_load_dwordx4 v[116:119],v112,s[16:19],s43 offen nt
v_mfma_f32_16x16x32_bf16 v[76:79],a[172:175],v[236:239],v[76:79]
ds_read_b128 v[232:235],v17 offset:37888
s_waitcnt lgkmcnt(5)
v_mfma_f32_16x16x32_bf16 v[68:71],a[48:51],v[240:243],v[68:71]
v_mfma_f32_16x16x32_bf16 v[76:79],a[176:179],v[240:243],v[76:79]
ds_read_b128 v[236:239],v17 offset:39936
v_mfma_f32_16x16x32_bf16 v[68:71],a[52:55],v[244:247],v[68:71]
buffer_load_ushort v120,v113,s[12:15],s48 offen
v_mfma_f32_16x16x32_bf16 v[76:79],a[180:183],v[244:247],v[76:79]
ds_read_b128 v[240:243],v17 offset:41984
s_waitcnt lgkmcnt(5)
v_mfma_f32_16x16x32_bf16 v[68:71],a[56:59],v[248:251],v[68:71]
s_add_u32 s43,s43,786432
v_mfma_f32_16x16x32_bf16 v[76:79],a[184:187],v[248:251],v[76:79]
ds_read_b128 v[244:247],v17 offset:44032
v_mfma_f32_16x16x32_bf16 v[68:71],a[60:63],v[252:255],v[68:71]
v_mfma_f32_16x16x32_bf16 v[76:79],a[188:191],v[252:255],v[76:79]
ds_read_b128 v[248:251],v17 offset:46080
s_waitcnt lgkmcnt(5)
v_mfma_f32_16x16x32_bf16 v[68:71],a[64:67],v[224:227],v[68:71]
s_add_u32 s48,s48,128
v_mfma_f32_16x16x32_bf16 v[76:79],a[192:195],v[224:227],v[76:79]
ds_read_b128 v[252:255],v17 offset:48128
v_mfma_f32_16x16x32_bf16 v[68:71],a[68:71],v[228:231],v[68:71]
buffer_store_dwordx4 v[48:51],v24,s[20:23],s93 offen sc1
v_mfma_f32_16x16x32_bf16 v[76:79],a[196:199],v[228:231],v[76:79]
ds_read_b128 v[224:227],v17 offset:50176
s_waitcnt lgkmcnt(5)
v_mfma_f32_16x16x32_bf16 v[68:71],a[72:75],v[232:235],v[68:71]
v_mfma_f32_16x16x32_bf16 v[76:79],a[200:203],v[232:235],v[76:79]
ds_read_b128 v[228:231],v17 offset:52224
v_mfma_f32_16x16x32_bf16 v[68:71],a[76:79],v[236:239],v[68:71]
buffer_store_dwordx4 v[48:51],v25,s[20:23],s93 offen sc1
v_mfma_f32_16x16x32_bf16 v[76:79],a[204:207],v[236:239],v[76:79]
ds_read_b128 v[232:235],v17 offset:54272
s_waitcnt lgkmcnt(5)
v_mfma_f32_16x16x32_bf16 v[68:71],a[80:83],v[240:243],v[68:71]
s_add_u32 s93,s93,8388608
v_mfma_f32_16x16x32_bf16 v[76:79],a[208:211],v[240:243],v[76:79]
ds_read_b128 v[236:239],v17 offset:56320
v_mfma_f32_16x16x32_bf16 v[68:71],a[84:87],v[244:247],v[68:71]
v_mfma_f32_16x16x32_bf16 v[76:79],a[212:215],v[244:247],v[76:79]
ds_read_b128 v[240:243],v17 offset:58368
s_waitcnt lgkmcnt(5)
v_mfma_f32_16x16x32_bf16 v[68:71],a[88:91],v[248:251],v[68:71]
s_cmp_lt_u32 s93,163577856
s_cselect_b32 s93,s93,0x7fff0000
v_mfma_f32_16x16x32_bf16 v[76:79],a[216:219],v[248:251],v[76:79]
ds_read_b128 v[244:247],v17 offset:60416
v_mfma_f32_16x16x32_bf16 v[68:71],a[92:95],v[252:255],v[68:71]
buffer_store_dwordx4 v[48:51],v24,s[20:23],s42 offen sc1
v_mfma_f32_16x16x32_bf16 v[76:79],a[220:223],v[252:255],v[76:79]
ds_read_b128 v[248:251],v17 offset:62464
s_waitcnt lgkmcnt(5)
v_mfma_f32_16x16x32_bf16 v[68:71],a[96:99],v[224:227],v[68:71]
v_mfma_f32_16x16x32_bf16 v[76:79],a[224:227],v[224:227],v[76:79]
ds_read_b128 v[252:255],v17 offset:64512
v_mfma_f32_16x16x32_bf16 v[68:71],a[100:103],v[228:231],v[68:71]
buffer_store_dwordx4 v[48:51],v25,s[20:23],s42 offen sc1
v_mfma_f32_16x16x32_bf16 v[76:79],a[228:231],v[228:231],v[76:79]
s_waitcnt lgkmcnt(4)
v_mfma_f32_16x16x32_bf16 v[68:71],a[104:107],v[232:235],v[68:71]
s_add_u32 s42,s42,2097152
v_mfma_f32_16x16x32_bf16 v[76:79],a[232:235],v[232:235],v[76:79]
v_mfma_f32_16x16x32_bf16 v[68:71],a[108:111],v[236:239],v[68:71]
v_mfma_f32_16x16x32_bf16 v[76:79],a[236:239],v[236:239],v[76:79]
s_xor_b32 s42,s42,0x2000
s_waitcnt lgkmcnt(2)
v_mfma_f32_16x16x32_bf16 v[68:71],a[112:115],v[240:243],v[68:71]
v_mfma_f32_16x16x32_bf16 v[76:79],a[240:243],v[240:243],v[76:79]
v_mfma_f32_16x16x32_bf16 v[68:71],a[116:119],v[244:247],v[68:71]
s_cmp_lt_u32 s42,165675008
s_cselect_b32 s42,s42,0x7fff0000
v_mfma_f32_16x16x32_bf16 v[76:79],a[244:247],v[244:247],v[76:79]
s_waitcnt lgkmcnt(0)
v_mfma_f32_16x16x32_bf16 v[68:71],a[120:123],v[248:251],v[68:71]
v_mfma_f32_16x16x32_bf16 v[76:79],a[248:251],v[248:251],v[76:79]
v_mfma_f32_16x16x32_bf16 v[68:71],a[124:127],v[252:255],v[68:71]
v_mfma_f32_16x16x32_bf16 v[76:79],a[252:255],v[252:255],v[76:79]
v_xor_b32 v17,0x10000,v17
s_mov_b32 s79,s77
s_nop 4
v_cvt_pk_bf16_f32 v92,v68,v69
v_cvt_pk_bf16_f32 v93,v70,v71
v_cvt_pk_bf16_f32 v94,v76,v77
v_cvt_pk_bf16_f32 v95,v78,v79
buffer_store_dwordx4 v[92:95],v18,s[20:23],s70 offen offset:1024 sc1
s_cmp_lt_u32 s79,64
s_cbranch_scc1 qloop_200
s_waitcnt vmcnt(0)
s_barrier
s_cmp_lg_u32 s41,64
s_cbranch_scc1 np3_206
s_cmp_lg_u32 s50,0
s_cbranch_scc1 ow_207
s_mov_b64 exec,1
v_mov_b32 v22,14
v_mov_b32 v23,0
s_mov_b32 s64,21052992
buffer_atomic_add v22,v23,s[20:23],s64 offen sc1
s_mov_b64 exec,-1
ow_207:
np3_206:
s_cmp_lg_u32 s50,0
s_cbranch_scc1 ow_208
s_mov_b64 exec,1
v_mov_b32 v22,18
v_mov_b32 v23,0
buffer_store_dword v22,v23,s[20:23],s73 offen sc1
s_mov_b64 exec,-1
ow_208:
v_lshlrev_b32 v108,16,v108
v_mul_f32 v109,s81,v108
v_exp_f32 v109,v109
s_nop 0
v_add_f32 v109,1.0,v109
v_rcp_f32 v109,v109
s_nop 0
v_mul_f32 v109,v109,v108
v_cvt_pk_bf16_f32 v109,v109,v109
v_and_b32 v108,s80,v109
v_lshlrev_b32 v110,16,v104
v_and_b32 v111,s80,v104
v_fmac_f32 v96,v110,v108
v_fmac_f32 v97,v111,v108
v_lshlrev_b32 v110,16,v105
v_and_b32 v111,s80,v105
v_fmac_f32 v98,v110,v108
v_fmac_f32 v99,v111,v108
v_lshlrev_b32 v110,16,v106
v_and_b32 v111,s80,v106
v_fmac_f32 v100,v110,v108
v_fmac_f32 v101,v111,v108
v_lshlrev_b32 v110,16,v107
v_and_b32 v111,s80,v107
v_fmac_f32 v102,v110,v108
v_fmac_f32 v103,v111,v108
v_lshlrev_b32 v120,16,v120
v_mul_f32 v109,s81,v120
v_exp_f32 v109,v109
s_nop 0
v_add_f32 v109,1.0,v109
v_rcp_f32 v109,v109
s_nop 0
v_mul_f32 v109,v109,v120
v_cvt_pk_bf16_f32 v109,v109,v109
v_and_b32 v120,s80,v109
v_lshlrev_b32 v110,16,v116
v_and_b32 v111,s80,v116
v_fmac_f32 v96,v110,v120
v_fmac_f32 v97,v111,v120
v_lshlrev_b32 v110,16,v117
v_and_b32 v111,s80,v117
v_fmac_f32 v98,v110,v120
v_fmac_f32 v99,v111,v120
v_lshlrev_b32 v110,16,v118
v_and_b32 v111,s80,v118
v_fmac_f32 v100,v110,v120
v_fmac_f32 v101,v111,v120
v_lshlrev_b32 v110,16,v119
v_and_b32 v111,s80,v119
v_fmac_f32 v102,v110,v120
v_fmac_f32 v103,v111,v120
v_lshlrev_b32 v5,5,v0
ds_write_b128 v5,v[96:99]
ds_write_b128 v5,v[100:103] offset:16
v_and_b32 v6,31,v0
v_lshrrev_b32 v7,5,v0
v_lshlrev_b32 v7,10,v7
v_lshl_add_u32 v7,v6,2,v7
s_waitcnt lgkmcnt(0)
s_barrier
ds_read_b32 v8,v7 offset:0
ds_read_b32 v9,v7 offset:128
ds_read_b32 v10,v7 offset:256
ds_read_b32 v11,v7 offset:384
ds_read_b32 v12,v7 offset:512
ds_read_b32 v13,v7 offset:640
ds_read_b32 v14,v7 offset:768
ds_read_b32 v15,v7 offset:896
s_waitcnt lgkmcnt(0)
v_add_f32 v8,v8,v9
v_add_f32 v8,v8,v10
v_add_f32 v8,v8,v11
v_add_f32 v8,v8,v12
v_add_f32 v8,v8,v13
v_add_f32 v8,v8,v14
v_add_f32 v8,v8,v15
v_lshlrev_b32 v5,2,v0
ds_write_b32 v5,v8 offset:8192
v_lshlrev_b32 v7,2,v6
s_waitcnt lgkmcnt(0)
s_barrier
ds_read_b32 v8,v7 offset:8192
ds_read_b32 v9,v7 offset:8320
ds_read_b32 v10,v7 offset:8448
ds_read_b32 v11,v7 offset:8576
ds_read_b32 v12,v7 offset:8704
ds_read_b32 v13,v7 offset:8832
ds_read_b32 v14,v7 offset:8960
ds_read_b32 v15,v7 offset:9088
s_waitcnt lgkmcnt(0)
v_add_f32 v8,v8,v9
v_add_f32 v8,v8,v10
v_add_f32 v8,v8,v11
v_add_f32 v8,v8,v12
v_add_f32 v8,v8,v13
v_add_f32 v8,v8,v14
v_add_f32 v8,v8,v15
v_cvt_pk_bf16_f32 v8,v8,v8
v_and_b32 v8,s80,v8
s_lshl_b32 s64,s55,7
s_add_u32 s64,s64,8192
s_cmp_lg_u32 s50,0
s_cbranch_scc1 ow_209
buffer_store_dword v8,v7,s[20:23],s64 offen sc1
ow_209:
s_waitcnt vmcnt(0)
s_barrier
s_cmp_lg_u32 s50,0
s_cbranch_scc1 ow_210
s_mov_b64 exec,1
v_mov_b32 v22,14
v_mov_b32 v23,0
s_mov_b32 s64,21052032
buffer_atomic_add v22,v23,s[20:23],s64 offen sc1
s_mov_b64 exec,-1
ow_210:
s_lshr_b32 s58,s55,5
s_and_b32 s59,s55,31
s_mov_b32 s57,65
s_mov_b32 s79,0
s_branch common_211
pipe_second:
s_cmp_ge_u32 s59,18
s_cbranch_scc1 giveup_195
s_getpc_b64 s[4:5]
pc2nd:
s_sub_u32 s8,s4,pc2nd-mega_kernel
s_subb_u32 s9,s5,0
s_and_b32 s9,s9,0xffff
s_mov_b32 s10,code_end-mega_kernel
s_mov_b32 s11,0x20000
s_lshl_b32 s12,s59,15
v_lshlrev_b32 v2,7,v0
buffer_load_dword v2,v2,s[8:11],s12 offen
s_add_u32 s55,s57,128
s_and_b32 s64,s59,1
s_lshl_b32 s65,s58,1
s_add_u32 s64,s64,s65
s_lshl_b32 s65,s59,2
s_and_b32 s65,s65,24
s_add_u32 s65,s65,s64
s_add_u32 s64,s64,24
s_cmp_ge_u32 s59,16
s_cselect_b32 s64,s64,s65
s_lshl_b32 s65,s58,3
s_add_u32 s65,s65,s59
s_lshr_b32 s58,s59,3
s_add_u32 s58,s58,1
s_cmp_lt_u32 s59,8
s_cselect_b32 s59,s65,s64
s_xor_b32 s62,s61,0x2000
s_add_u32 s63,s62,21053440
s_mov_b32 s57,65
s_mov_b32 s79,64
s_mov_b32 s90,400000
common_211:
v_and_b32 v1,63,v0
v_and_b32 v3,15,v1
v_lshrrev_b32 v4,4,v1
v_lshlrev_b32 v16,4,v1
v_mov_b32 v48,0
v_mov_b32 v49,0
v_mov_b32 v50,0
v_mov_b32 v51,0
s_mov_b64 s[24:25],s[20:21]
s_mov_b64 s[28:29],s[20:21]
s_mov_b32 s27,0x20000
s_mov_b32 s31,0x20000
s_cmp_eq_u32 s56,0
s_cselect_b32 s26,s22,0
s_cselect_b32 s30,0,s22
s_add_u32 s71,s79,1
s_lshl_b32 s60,s79,4
s_mov_b32 s98,0
s_mov_b32 s99,0
v_mov_b32 v29,0
v_cmp_eq_u32 vcc,0,v1
v_mov_b32 v23,0x40000000
s_nop 0
v_cndmask_b32 v23,v23,v48,vcc
s_mov_b32 s80,0xffff0000
s_cmp_eq_u32 s58,0
s_cbranch_scc1 r_wo_212
s_cmp_eq_u32 s58,1
s_cbranch_scc1 r_w3_213
s_cmp_eq_u32 s58,2
s_cbranch_scc1 r_w4_214
s_and_b32 s41,s59,15
s_cmp_lt_u32 s59,16
s_cbranch_scc1 r_at_217
s_cmp_ge_u32 s59,24
s_cbranch_scc1 r_w2_215
s_load_dwordx2 s[4:5],s[0:1],64
s_and_b32 s41,s59,7
s_lshl_b32 s66,s41,8
s_lshl_b32 s67,s50,1
s_waitcnt lgkmcnt(0)
s_mov_b32 s32,s4
s_and_b32 s33,s5,0xffff
s_mov_b32 s34,0x200000
s_mov_b32 s35,0x20000
v_lshrrev_b32 v5,2,v3
v_lshl_add_u32 v7,v4,3,v5
v_and_b32 v6,3,v3
v_lshlrev_b32 v6,3,v6
v_lshl_add_u32 v6,v7,8,v6
v_and_b32 v7,1,v4
v_lshl_add_u32 v5,v7,2,v5
v_xor_b32 v5,s67,v5
v_lshl_add_u32 v12,v5,5,v6
v_xor_b32 v13,32,v12
v_and_b32 v5,15,v1
v_and_b32 v6,3,v4
v_lshlrev_b32 v6,1,v6
v_xor_b32 v5,v5,v6
v_mul_u32_u24 v6,2048,v4
v_xor_b32 v7,0,v5
v_lshl_add_u32 v8,v7,4,v6
v_xor_b32 v7,8,v5
v_lshl_add_u32 v9,v7,4,v6
s_mul_i32 s74,s50,131072
s_add_u32 s74,s74,s66
s_lshl_b32 s75,s50,14
s_mul_i32 s76,s50,65536
s_add_u32 s76,s76,s66
s_lshl_b32 s77,s50,13
s_add_u32 s64,s74,0
s_add_u32 m0,s75,0
s_nop 0
buffer_load_dwordx4 v8,s[32:35],s64 offen nt lds
s_add_u32 s64,s74,8192
s_add_u32 m0,s75,1024
s_nop 0
buffer_load_dwordx4 v8,s[32:35],s64 offen nt lds
s_add_u32 s64,s74,16384
s_add_u32 m0,s75,2048
s_nop 0
buffer_load_dwordx4 v9,s[32:35],s64 offen nt lds
s_add_u32 s64,s74,24576
s_add_u32 m0,s75,3072
s_nop 0
buffer_load_dwordx4 v9,s[32:35],s64 offen nt lds
s_add_u32 s64,s74,32768
s_add_u32 m0,s75,4096
s_nop 0
buffer_load_dwordx4 v8,s[32:35],s64 offen nt lds
s_add_u32 s64,s74,40960
s_add_u32 m0,s75,5120
s_nop 0
buffer_load_dwordx4 v8,s[32:35],s64 offen nt lds
s_add_u32 s64,s74,49152
s_add_u32 m0,s75,6144
s_nop 0
buffer_load_dwordx4 v9,s[32:35],s64 offen nt lds
s_add_u32 s64,s74,57344
s_add_u32 m0,s75,7168
s_nop 0
buffer_load_dwordx4 v9,s[32:35],s64 offen nt lds
s_add_u32 s64,s74,65536
s_add_u32 m0,s75,8192
s_nop 0
buffer_load_dwordx4 v8,s[32:35],s64 offen nt lds
s_add_u32 s64,s74,73728
s_add_u32 m0,s75,9216
s_nop 0
buffer_load_dwordx4 v8,s[32:35],s64 offen nt lds
s_add_u32 s64,s74,81920
s_add_u32 m0,s75,10240
s_nop 0
buffer_load_dwordx4 v9,s[32:35],s64 offen nt lds
s_add_u32 s64,s74,90112
s_add_u32 m0,s75,11264
s_nop 0
buffer_load_dwordx4 v9,s[32:35],s64 offen nt lds
s_add_u32 s64,s74,98304
s_add_u32 m0,s75,12288
s_nop 0
buffer_load_dwordx4 v8,s[32:35],s64 offen nt lds
s_add_u32 s64,s74,106496
s_add_u32 m0,s75,13312
s_nop 0
buffer_load_dwordx4 v8,s[32:35],s64 offen nt lds
s_add_u32 s64,s74,114688
s_add_u32 m0,s75,14336
s_nop 0
buffer_load_dwordx4 v9,s[32:35],s64 offen nt lds
s_add_u32 s64,s74,122880
s_add_u32 m0,s75,15360
s_nop 0
buffer_load_dwordx4 v9,s[32:35],s64 offen nt lds
s_add_u32 s64,s74,524288
s_add_u32 m0,s75,65536
s_nop 0
buffer_load_dwordx4 v8,s[32:35],s64 offen nt lds
s_add_u32 s64,s74,532480
s_add_u32 m0,s75,66560
s_nop 0
buffer_load_dwordx4 v8,s[32:35],s64 offen nt lds
s_add_u32 s64,s74,540672
s_add_u32 m0,s75,67584
s_nop 0
buffer_load_dwordx4 v9,s[32:35],s64 offen nt lds
s_add_u32 s64,s74,548864
s_add_u32 m0,s75,68608
s_nop 0
buffer_load_dwordx4 v9,s[32:35],s64 offen nt lds
s_add_u32 s64,s74,557056
s_add_u32 m0,s75,69632
s_nop 0
buffer_load_dwordx4 v8,s[32:35],s64 offen nt lds
s_add_u32 s64,s74,565248
s_add_u32 m0,s75,70656
s_nop 0
buffer_load_dwordx4 v8,s[32:35],s64 offen nt lds
s_add_u32 s64,s74,573440
s_add_u32 m0,s75,71680
s_nop 0
buffer_load_dwordx4 v9,s[32:35],s64 offen nt lds
s_add_u32 s64,s74,581632
s_add_u32 m0,s75,72704
s_nop 0
buffer_load_dwordx4 v9,s[32:35],s64 offen nt lds
s_add_u32 s64,s74,589824
s_add_u32 m0,s75,73728
s_nop 0
buffer_load_dwordx4 v8,s[32:35],s64 offen nt lds
s_add_u32 s64,s74,598016
s_add_u32 m0,s75,74752
s_nop 0
buffer_load_dwordx4 v8,s[32:35],s64 offen nt lds
s_add_u32 s64,s74,606208
s_add_u32 m0,s75,75776
s_nop 0
buffer_load_dwordx4 v9,s[32:35],s64 offen nt lds
s_add_u32 s64,s74,614400
s_add_u32 m0,s75,76800
s_nop 0
buffer_load_dwordx4 v9,s[32:35],s64 offen nt lds
s_add_u32 s64,s74,622592
s_add_u32 m0,s75,77824
s_nop 0
buffer_load_dwordx4 v8,s[32:35],s64 offen nt lds
s_add_u32 s64,s74,630784
s_add_u32 m0,s75,78848
s_nop 0
buffer_load_dwordx4 v8,s[32:35],s64 offen nt lds
s_add_u32 s64,s74,638976
s_add_u32 m0,s75,79872
s_nop 0
buffer_load_dwordx4 v9,s[32:35],s64 offen nt lds
s_add_u32 s64,s74,647168
s_add_u32 m0,s75,80896
s_nop 0
buffer_load_dwordx4 v9,s[32:35],s64 offen nt lds
s_waitcnt vmcnt(16)
s_barrier
ds_read_b64_tr_b16 a[0:1],v12 offset:0
ds_read_b64_tr_b16 a[128:129],v13 offset:0
ds_read_b64_tr_b16 a[2:3],v12 offset:1024
ds_read_b64_tr_b16 a[130:131],v13 offset:1024
ds_read_b64_tr_b16 a[4:5],v12 offset:8192
ds_read_b64_tr_b16 a[132:133],v13 offset:8192
ds_read_b64_tr_b16 a[6:7],v12 offset:9216
ds_read_b64_tr_b16 a[134:135],v13 offset:9216
s_waitcnt lgkmcnt(4)
ds_read_b64_tr_b16 a[8:9],v12 offset:16384
ds_read_b64_tr_b16 a[136:137],v13 offset:16384
ds_read_b64_tr_b16 a[10:11],v12 offset:17408
ds_read_b64_tr_b16 a[138:139],v13 offset:17408
ds_read_b64_tr_b16 a[12:13],v12 offset:24576
ds_read_b64_tr_b16 a[140:141],v13 offset:24576
ds_read_b64_tr_b16 a[14:15],v12 offset:25600
ds_read_b64_tr_b16 a[142:143],v13 offset:25600
s_waitcnt lgkmcnt(4)
ds_read_b64_tr_b16 a[16:17],v12 offset:32768
ds_read_b64_tr_b16 a[144:145],v13 offset:32768
ds_read_b64_tr_b16 a[18:19],v12 offset:33792
ds_read_b64_tr_b16 a[146:147],v13 offset:33792
ds_read_b64_tr_b16 a[20:21],v12 offset:40960
ds_read_b64_tr_b16 a[148:149],v13 offset:40960
ds_read_b64_tr_b16 a[22:23],v12 offset:41984
ds_read_b64_tr_b16 a[150:151],v13 offset:41984
s_waitcnt lgkmcnt(4)
ds_read_b64_tr_b16 a[24:25],v12 offset:49152
ds_read_b64_tr_b16 a[152:153],v13 offset:49152
ds_read_b64_tr_b16 a[26:27],v12 offset:50176
ds_read_b64_tr_b16 a[154:155],v13 offset:50176
ds_read_b64_tr_b16 a[28:29],v12 offset:57344
ds_read_b64_tr_b16 a[156:157],v13 offset:57344
ds_read_b64_tr_b16 a[30:31],v12 offset:58368
ds_read_b64_tr_b16 a[158:159],v13 offset:58368
s_waitcnt lgkmcnt(4)
v_xor_b32 v12,0x10000,v12
v_xor_b32 v13,0x10000,v13
s_waitcnt lgkmcnt(0)
s_barrier
s_add_u32 s64,s74,1048576
s_add_u32 m0,s75,0
s_nop 0
buffer_load_dwordx4 v8,s[32:35],s64 offen nt lds
s_add_u32 s64,s74,1056768
s_add_u32 m0,s75,1024
s_nop 0
buffer_load_dwordx4 v8,s[32:35],s64 offen nt lds
s_add_u32 s64,s74,1064960
s_add_u32 m0,s75,2048
s_nop 0
buffer_load_dwordx4 v9,s[32:35],s64 offen nt lds
s_add_u32 s64,s74,1073152
s_add_u32 m0,s75,3072
s_nop 0
buffer_load_dwordx4 v9,s[32:35],s64 offen nt lds
s_add_u32 s64,s74,1081344
s_add_u32 m0,s75,4096
s_nop 0
buffer_load_dwordx4 v8,s[32:35],s64 offen nt lds
s_add_u32 s64,s74,1089536
s_add_u32 m0,s75,5120
s_nop 0
buffer_load_dwordx4 v8,s[32:35],s64 offen nt lds
s_add_u32 s64,s74,1097728
s_add_u32 m0,s75,6144
s_nop 0
buffer_load_dwordx4 v9,s[32:35],s64 offen nt lds
s_add_u32 s64,s74,1105920
s_add_u32 m0,s75,7168
s_nop 0
buffer_load_dwordx4 v9,s[32:35],s64 offen nt lds
s_add_u32 s64,s74,1114112
s_add_u32 m0,s75,8192
s_nop 0
buffer_load_dwordx4 v8,s[32:35],s64 offen nt lds
s_add_u32 s64,s74,1122304
s_add_u32 m0,s75,9216
s_nop 0
buffer_load_dwordx4 v8,s[32:35],s64 offen nt lds
s_add_u32 s64,s74,1130496
s_add_u32 m0,s75,10240
s_nop 0
buffer_load_dwordx4 v9,s[32:35],s64 offen nt lds
s_add_u32 s64,s74,1138688
s_add_u32 m0,s75,11264
s_nop 0
buffer_load_dwordx4 v9,s[32:35],s64 offen nt lds
s_add_u32 s64,s74,1146880
s_add_u32 m0,s75,12288
s_nop 0
buffer_load_dwordx4 v8,s[32:35],s64 offen nt lds
s_add_u32 s64,s74,1155072
s_add_u32 m0,s75,13312
s_nop 0
buffer_load_dwordx4 v8,s[32:35],s64 offen nt lds
s_add_u32 s64,s74,1163264
s_add_u32 m0,s75,14336
s_nop 0
buffer_load_dwordx4 v9,s[32:35],s64 offen nt lds
s_add_u32 s64,s74,1171456
s_add_u32 m0,s75,15360
s_nop 0
buffer_load_dwordx4 v9,s[32:35],s64 offen nt lds
s_waitcnt vmcnt(16)
s_barrier
ds_read_b64_tr_b16 a[32:33],v12 offset:0
ds_read_b64_tr_b16 a[160:161],v13 offset:0
ds_read_b64_tr_b16 a[34:35],v12 offset:1024
ds_read_b64_tr_b16 a[162:163],v13 offset:1024
ds_read_b64_tr_b16 a[36:37],v12 offset:8192
ds_read_b64_tr_b16 a[164:165],v13 offset:8192
ds_read_b64_tr_b16 a[38:39],v12 offset:9216
ds_read_b64_tr_b16 a[166:167],v13 offset:9216
s_waitcnt lgkmcnt(4)
ds_read_b64_tr_b16 a[40:41],v12 offset:16384
ds_read_b64_tr_b16 a[168:169],v13 offset:16384
ds_read_b64_tr_b16 a[42:43],v12 offset:17408
ds_read_b64_tr_b16 a[170:171],v13 offset:17408
ds_read_b64_tr_b16 a[44:45],v12 offset:24576
ds_read_b64_tr_b16 a[172:173],v13 offset:24576
ds_read_b64_tr_b16 a[46:47],v12 offset:25600
ds_read_b64_tr_b16 a[174:175],v13 offset:25600
s_waitcnt lgkmcnt(4)
ds_read_b64_tr_b16 a[48:49],v12 offset:32768
ds_read_b64_tr_b16 a[176:177],v13 offset:32768
ds_read_b64_tr_b16 a[50:51],v12 offset:33792
ds_read_b64_tr_b16 a[178:179],v13 offset:33792
ds_read_b64_tr_b16 a[52:53],v12 offset:40960
ds_read_b64_tr_b16 a[180:181],v13 offset:40960
ds_read_b64_tr_b16 a[54:55],v12 offset:41984
ds_read_b64_tr_b16 a[182:183],v13 offset:41984
s_waitcnt lgkmcnt(4)
ds_read_b64_tr_b16 a[56:57],v12 offset:49152
ds_read_b64_tr_b16 a[184:185],v13 offset:49152
ds_read_b64_tr_b16 a[58:59],v12 offset:50176
ds_read_b64_tr_b16 a[186:187],v13 offset:50176
ds_read_b64_tr_b16 a[60:61],v12 offset:57344
ds_read_b64_tr_b16 a[188:189],v13 offset:57344
ds_read_b64_tr_b16 a[62:63],v12 offset:58368
ds_read_b64_tr_b16 a[190:191],v13 offset:58368
s_waitcnt lgkmcnt(4)
v_xor_b32 v12,0x10000,v12
v_xor_b32 v13,0x10000,v13
s_waitcnt lgkmcnt(0)
s_barrier
s_add_u32 s64,s74,1572864
s_add_u32 m0,s75,65536
s_nop 0
buffer_load_dwordx4 v8,s[32:35],s64 offen nt lds
s_add_u32 s64,s74,1581056
s_add_u32 m0,s75,66560
s_nop 0
buffer_load_dwordx4 v8,s[32:35],s64 offen nt lds
s_add_u32 s64,s74,1589248
s_add_u32 m0,s75,67584
s_nop 0
buffer_load_dwordx4 v9,s[32:35],s64 offen nt lds
s_add_u32 s64,s74,1597440
s_add_u32 m0,s75,68608
s_nop 0
buffer_load_dwordx4 v9,s[32:35],s64 offen nt lds
s_add_u32 s64,s74,1605632
s_add_u32 m0,s75,69632
s_nop 0
buffer_load_dwordx4 v8,s[32:35],s64 offen nt lds
s_add_u32 s64,s74,1613824
s_add_u32 m0,s75,70656
s_nop 0
buffer_load_dwordx4 v8,s[32:35],s64 offen nt lds
s_add_u32 s64,s74,1622016
s_add_u32 m0,s75,71680
s_nop 0
buffer_load_dwordx4 v9,s[32:35],s64 offen nt lds
s_add_u32 s64,s74,1630208
s_add_u32 m0,s75,72704
s_nop 0
buffer_load_dwordx4 v9,s[32:35],s64 offen nt lds
s_add_u32 s64,s74,1638400
s_add_u32 m0,s75,73728
s_nop 0
buffer_load_dwordx4 v8,s[32:35],s64 offen nt lds
s_add_u32 s64,s74,1646592
s_add_u32 m0,s75,74752
s_nop 0
buffer_load_dwordx4 v8,s[32:35],s64 offen nt lds
s_add_u32 s64,s74,1654784
s_add_u32 m0,s75,75776
s_nop 0
buffer_load_dwordx4 v9,s[32:35],s64 offen nt lds
s_add_u32 s64,s74,1662976
s_add_u32 m0,s75,76800
s_nop 0
buffer_load_dwordx4 v9,s[32:35],s64 offen nt lds
s_add_u32 s64,s74,1671168
s_add_u32 m0,s75,77824
s_nop 0
buffer_load_dwordx4 v8,s[32:35],s64 offen nt lds
s_add_u32 s64,s74,1679360
s_add_u32 m0,s75,78848
s_nop 0
buffer_load_dwordx4 v8,s[32:35],s64 offen nt lds
s_add_u32 s64,s74,1687552
s_add_u32 m0,s75,79872
s_nop 0
buffer_load_dwordx4 v9,s[32:35],s64 offen nt lds
s_add_u32 s64,s74,1695744
s_add_u32 m0,s75,80896
s_nop 0
buffer_load_dwordx4 v9,s[32:35],s64 offen nt lds
s_waitcnt vmcnt(16)
s_barrier
ds_read_b64_tr_b16 a[64:65],v12 offset:0
ds_read_b64_tr_b16 a[192:193],v13 offset:0
ds_read_b64_tr_b16 a[66:67],v12 offset:1024
ds_read_b64_tr_b16 a[194:195],v13 offset:1024
ds_read_b64_tr_b16 a[68:69],v12 offset:8192
ds_read_b64_tr_b16 a[196:197],v13 offset:8192
ds_read_b64_tr_b16 a[70:71],v12 offset:9216
ds_read_b64_tr_b16 a[198:199],v13 offset:9216
s_waitcnt lgkmcnt(4)
ds_read_b64_tr_b16 a[72:73],v12 offset:16384
ds_read_b64_tr_b16 a[200:201],v13 offset:16384
ds_read_b64_tr_b16 a[74:75],v12 offset:17408
ds_read_b64_tr_b16 a[202:203],v13 offset:17408
ds_read_b64_tr_b16 a[76:77],v12 offset:24576
ds_read_b64_tr_b16 a[204:205],v13 offset:24576
ds_read_b64_tr_b16 a[78:79],v12 offset:25600
ds_read_b64_tr_b16 a[206:207],v13 offset:25600
s_waitcnt lgkmcnt(4)
ds_read_b64_tr_b16 a[80:81],v12 offset:32768
ds_read_b64_tr_b16 a[208:209],v13 offset:32768
ds_read_b64_tr_b16 a[82:83],v12 offset:33792
ds_read_b64_tr_b16 a[210:211],v13 offset:33792
ds_read_b64_tr_b16 a[84:85],v12 offset:40960
ds_read_b64_tr_b16 a[212:213],v13 offset:40960
ds_read_b64_tr_b16 a[86:87],v12 offset:41984
ds_read_b64_tr_b16 a[214:215],v13 offset:41984
s_waitcnt lgkmcnt(4)
ds_read_b64_tr_b16 a[88:89],v12 offset:49152
ds_read_b64_tr_b16 a[216:217],v13 offset:49152
ds_read_b64_tr_b16 a[90:91],v12 offset:50176
ds_read_b64_tr_b16 a[218:219],v13 offset:50176
ds_read_b64_tr_b16 a[92:93],v12 offset:57344
ds_read_b64_tr_b16 a[220:221],v13 offset:57344
ds_read_b64_tr_b16 a[94:95],v12 offset:58368
ds_read_b64_tr_b16 a[222:223],v13 offset:58368
s_waitcnt lgkmcnt(4)
v_xor_b32 v12,0x10000,v12
v_xor_b32 v13,0x10000,v13
s_waitcnt lgkmcnt(0)
s_barrier
s_waitcnt vmcnt(0)
s_barrier
ds_read_b64_tr_b16 a[96:97],v12 offset:0
ds_read_b64_tr_b16 a[224:225],v13 offset:0
ds_read_b64_tr_b16 a[98:99],v12 offset:1024
ds_read_b64_tr_b16 a[226:227],v13 offset:1024
ds_read_b64_tr_b16 a[100:101],v12 offset:8192
ds_read_b64_tr_b16 a[228:229],v13 offset:8192
ds_read_b64_tr_b16 a[102:103],v12 offset:9216
ds_read_b64_tr_b16 a[230:231],v13 offset:9216
s_waitcnt lgkmcnt(4)
ds_read_b64_tr_b16 a[104:105],v12 offset:16384
ds_read_b64_tr_b16 a[232:233],v13 offset:16384
ds_read_b64_tr_b16 a[106:107],v12 offset:17408
ds_read_b64_tr_b16 a[234:235],v13 offset:17408
ds_read_b64_tr_b16 a[108:109],v12 offset:24576
ds_read_b64_tr_b16 a[236:237],v13 offset:24576
ds_read_b64_tr_b16 a[110:111],v12 offset:25600
ds_read_b64_tr_b16 a[238:239],v13 offset:25600
s_waitcnt lgkmcnt(4)
ds_read_b64_tr_b16 a[112:113],v12 offset:32768
ds_read_b64_tr_b16 a[240:241],v13 offset:32768
ds_read_b64_tr_b16 a[114:115],v12 offset:33792
ds_read_b64_tr_b16 a[242:243],v13 offset:33792
ds_read_b64_tr_b16 a[116:117],v12 offset:40960
ds_read_b64_tr_b16 a[244:245],v13 offset:40960
ds_read_b64_tr_b16 a[118:119],v12 offset:41984
ds_read_b64_tr_b16 a[246:247],v13 offset:41984
s_waitcnt lgkmcnt(4)
ds_read_b64_tr_b16 a[120:121],v12 offset:49152
ds_read_b64_tr_b16 a[248:249],v13 offset:49152
ds_read_b64_tr_b16 a[122:123],v12 offset:50176
ds_read_b64_tr_b16 a[250:251],v13 offset:50176
ds_read_b64_tr_b16 a[124:125],v12 offset:57344
ds_read_b64_tr_b16 a[252:253],v13 offset:57344
ds_read_b64_tr_b16 a[126:127],v12 offset:58368
ds_read_b64_tr_b16 a[254:255],v13 offset:58368
s_waitcnt lgkmcnt(4)
v_xor_b32 v12,0x10000,v12
v_xor_b32 v13,0x10000,v13
s_waitcnt lgkmcnt(0)
s_barrier
v_and_b32 v21,1,v1
v_mul_u32_u24 v21,960,v21
s_mov_b32 s65,21052032
s_mov_b32 s66,1792
pl_218:
buffer_load_dword v22,v21,s[20:23],s65 offen sc1
s_waitcnt vmcnt(0)
v_cmp_gt_u32 vcc,s66,v22
s_cbranch_vccz pok_219
s_sleep 1
s_sub_u32 s90,s90,1
s_cmp_gt_i32 s90,0
s_cbranch_scc1 pl_218
pok_219:
s_mov_b32 s81,0xbdd2d3e8
v_mov_b32 v28,0xc0135761
v_mov_b32 v17,v16
v_and_b32 v21,31,v1
v_lshlrev_b32 v21,2,v21
s_mul_i32 s74,s79,40
s_add_u32 s74,s74,s63
s_add_u32 s74,s74,2560
s_lshl_b32 s42,s41,2
s_add_u32 s42,s42,s50
s_lshl_b32 s73,s41,4
s_lshl_b32 s64,s50,2
s_add_u32 s73,s73,s64
s_add_u32 s73,s73,s63
s_add_u32 s73,s73,3072
s_add_u32 s73,s73,s60
s_lshl_b32 s43,s50,11
s_lshl_b32 s78,s79,21
s_add_u32 s78,s78,29360128
s_mov_b32 s64,0
s_lshr_b32 s65,s50,1
s_and_b32 s66,s50,1
s_lshl_b32 s72,s65,13
s_lshl_b32 s64,s66,11
s_add_u32 s72,s72,s64
s_add_u32 s72,s72,0x10000
s_lshl_b32 s75,s66,15
s_lshl_b32 s64,s65,7
s_add_u32 s75,s75,s64
s_add_u32 s75,s75,1835008
s_lshl_b32 s64,s66,2
v_add_u32 v5,s64,v4
v_and_b32 v6,7,v1
v_xor_b32 v5,v5,v6
v_lshlrev_b32 v5,4,v5
v_bfe_u32 v6,v1,3,2
v_lshl_add_u32 v5,v6,11,v5
v_lshrrev_b32 v6,5,v1
v_lshl_add_u32 v42,v6,14,v5
v_lshrrev_b32 v5,1,v3
v_xor_b32 v5,v5,v4
v_lshlrev_b32 v5,4,v5
v_and_b32 v6,7,v3
v_lshl_add_u32 v5,v6,7,v5
v_lshrrev_b32 v6,3,v3
v_lshl_add_u32 v17,v6,11,v5
v_xor_b32 v43,64,v17
s_lshr_b32 s64,s41,1
s_lshl_b32 s64,s64,2
s_lshr_b32 s64,0x0413,s64
s_and_b32 s64,s64,7
s_add_u32 s65,s41,120
s_lshl_b32 s65,s65,14
s_add_u32 s65,s65,s43
v_lshl_add_u32 v7,v4,8,s65
v_mov_b32 v9,2105344
v_add_u32 v6,s64,v3
v_and_b32 v5,15,v6
v_lshl_add_u32 v5,v5,4,v7
v_bfe_u32 v8,v6,4,1
v_lshl_add_u32 v5,v8,10,v5
v_cmp_lt_u32 vcc,31,v6
s_nop 1
v_cndmask_b32 v8,0,v9,vcc
v_add_u32 v5,v5,v8
v_xor_b32 v18,s62,v5
s_add_u32 s64,s64,16
v_add_u32 v6,s64,v3
v_and_b32 v5,15,v6
v_lshl_add_u32 v5,v5,4,v7
v_bfe_u32 v8,v6,4,1
v_lshl_add_u32 v5,v8,10,v5
v_cmp_lt_u32 vcc,31,v6
s_nop 1
v_cndmask_b32 v8,0,v9,vcc
v_add_u32 v5,v5,v8
v_xor_b32 v19,s62,v5
s_add_u32 s64,s64,16
s_mov_b64 s[84:85],vcc
v_mov_b32 v88,1
v_mov_b32 v89,0
v_mov_b32 v90,0
v_mov_b32 v91,0
v_xor_b32 v5,0x2000,v19
s_mov_b32 s64,163577856
buffer_store_dwordx4 v[88:91],v18,s[20:23],s64 offen sc1
s_andn2_b64 exec,exec,s[84:85]
buffer_store_dwordx4 v[88:91],v19,s[20:23],s64 offen sc1
s_mov_b64 exec,-1
v_mov_b32 v6,0x7fff0000
v_cndmask_b32 v5,v6,v5,s[84:85]
s_mov_b32 s64,27262976
buffer_store_dwordx4 v[88:91],v5,s[20:23],s64 offen sc1
s_waitcnt vmcnt(0)
s_add_u32 s64,s79,0
s_lshl_b32 s70,s64,21
s_lshl_b32 s64,s64,13
s_and_b32 s64,s64,0x2000
s_xor_b32 s64,s64,s62
s_add_u32 s70,s70,s64
s_add_u32 s70,s70,29360128
s_mov_b32 s83,1
s_mov_b32 s87,s74
s_cmp_eq_u32 s50,0
s_cselect_b32 s74,s74,0x7fff0000
v_mov_b32 v47,132096
s_lshl_b32 s64,s50,3
s_add_u32 s64,s64,132096
v_mov_b32 v46,s64
v_mov_b32 v29,0
s_mov_b32 s97,0x7fff0000
seg_221:
s_cmp_eq_u32 s83,0
s_cbranch_scc1 ahead_222
s_add_u32 s94,s70,s75
s_add_u32 s95,s94,65536
s_xor_b32 s91,s72,0x10000
s_waitcnt vmcnt(3)
v_cmp_gt_u32 vcc,s71,v29
s_cbranch_vccz nb_225
s_waitcnt vmcnt(0)
v_add_u32 v22,s71,-1
buffer_store_dword v22,v23,s[24:27],s97 offen
buffer_store_dword v22,v23,s[28:31],s97 offen sc1
s_mov_b32 s97,0x7fff0000
s_cmp_lg_u32 s50,0
s_cbranch_scc1 nb_225
buffer_load_dword v32,v21,s[20:23],s74 offen sc1
s_sleep 2
pl_226:
buffer_load_dword v33,v21,s[20:23],s74 offen sc1
s_waitcnt vmcnt(1)
v_cmp_gt_u32 vcc,s71,v32
v_mov_b32 v29,v32
s_cbranch_vccz pok_227
buffer_load_dword v32,v21,s[20:23],s74 offen sc1
s_waitcnt vmcnt(1)
v_cmp_gt_u32 vcc,s71,v33
v_mov_b32 v29,v33
s_cbranch_vccz pok_227
s_sub_u32 s90,s90,1
s_cmp_gt_i32 s90,0
s_cbranch_scc1 pl_226
pok_227:
nb_225:
s_barrier
s_xor_b32 m0,s91,0
s_add_u32 s65,s94,0
buffer_load_dwordx4 v42,s[20:23],s65 offen offset:0 sc1 lds
buffer_load_dwordx4 v42,s[20:23],s65 offen offset:1024 sc1 lds
s_xor_b32 m0,s91,16384
s_add_u32 s65,s94,256
buffer_load_dwordx4 v42,s[20:23],s65 offen offset:0 sc1 lds
buffer_load_dwordx4 v42,s[20:23],s65 offen offset:1024 sc1 lds
s_xor_b32 m0,s91,32768
s_add_u32 s65,s94,512
buffer_load_dwordx4 v42,s[20:23],s65 offen offset:0 sc1 lds
buffer_load_dwordx4 v42,s[20:23],s65 offen offset:1024 sc1 lds
s_xor_b32 m0,s91,49152
s_add_u32 s65,s94,768
buffer_load_dwordx4 v42,s[20:23],s65 offen offset:0 sc1 lds
buffer_load_dwordx4 v42,s[20:23],s65 offen offset:1024 sc1 lds
s_waitcnt vmcnt(8)
v_add_u32 v22,s71,-1
buffer_store_dword v22,v23,s[24:27],s97 offen
buffer_store_dword v22,v23,s[28:31],s97 offen sc1
s_mov_b32 s97,0x7fff0000
s_waitcnt vmcnt(8)
s_barrier
ds_read_b128 v[224:227],v17 offset:0
ds_read_b128 v[228:231],v43 offset:0
ds_read_b128 v[232:235],v17 offset:8192
ds_read_b128 v[236:239],v43 offset:8192
ds_read_b128 v[240:243],v17 offset:1024
ds_read_b128 v[244:247],v43 offset:1024
ds_read_b128 v[248:251],v17 offset:9216
s_waitcnt lgkmcnt(5)
v_mfma_f32_16x16x32_bf16 v[64:67],a[0:3],v[224:227],0
s_xor_b32 m0,s91,4096
s_add_u32 s96,s71,1
v_mfma_f32_16x16x32_bf16 v[72:75],a[128:131],v[224:227],0
ds_read_b128 v[252:255],v43 offset:9216
s_add_u32 s92,s71,2
v_mfma_f32_16x16x32_bf16 v[64:67],a[4:7],v[228:231],v[64:67]
s_add_u32 s65,s95,0
v_min_u32 v27,v224,v228
v_mfma_f32_16x16x32_bf16 v[72:75],a[132:135],v[228:231],v[72:75]
s_waitcnt vmcnt(6)
s_barrier
ds_read_b128 v[224:227],v17 offset:16384
s_waitcnt lgkmcnt(5)
v_mfma_f32_16x16x32_bf16 v[64:67],a[8:11],v[232:235],v[64:67]
buffer_load_dwordx4 v42,s[20:23],s65 offen offset:0 sc1 lds
v_mfma_f32_16x16x32_bf16 v[72:75],a[136:139],v[232:235],v[72:75]
ds_read_b128 v[228:231],v43 offset:16384
v_min3_u32 v27,v27,v232,v236
v_mfma_f32_16x16x32_bf16 v[64:67],a[12:15],v[236:239],v[64:67]
buffer_load_dwordx4 v42,s[20:23],s65 offen offset:1024 sc1 lds
v_mfma_f32_16x16x32_bf16 v[72:75],a[140:143],v[236:239],v[72:75]
ds_read_b128 v[232:235],v17 offset:24576
s_waitcnt lgkmcnt(5)
v_mfma_f32_16x16x32_bf16 v[64:67],a[64:67],v[240:243],v[64:67]
s_xor_b32 m0,s91,20480
v_min3_u32 v27,v27,v240,v244
v_mfma_f32_16x16x32_bf16 v[72:75],a[192:195],v[240:243],v[72:75]
ds_read_b128 v[236:239],v43 offset:24576
v_mfma_f32_16x16x32_bf16 v[64:67],a[68:71],v[244:247],v[64:67]
s_add_u32 s65,s95,256
v_mfma_f32_16x16x32_bf16 v[72:75],a[196:199],v[244:247],v[72:75]
ds_read_b128 v[240:243],v17 offset:17408
s_waitcnt lgkmcnt(5)
v_mfma_f32_16x16x32_bf16 v[64:67],a[72:75],v[248:251],v[64:67]
buffer_load_dwordx4 v42,s[20:23],s65 offen offset:0 sc1 lds
v_mfma_f32_16x16x32_bf16 v[72:75],a[200:203],v[248:251],v[72:75]
ds_read_b128 v[244:247],v43 offset:17408
v_min3_u32 v27,v27,v248,v252
v_mfma_f32_16x16x32_bf16 v[64:67],a[76:79],v[252:255],v[64:67]
buffer_load_dwordx4 v42,s[20:23],s65 offen offset:1024 sc1 lds
v_mfma_f32_16x16x32_bf16 v[72:75],a[204:207],v[252:255],v[72:75]
ds_read_b128 v[248:251],v17 offset:25600
s_waitcnt lgkmcnt(5)
v_mfma_f32_16x16x32_bf16 v[64:67],a[16:19],v[224:227],v[64:67]
s_xor_b32 m0,s91,36864
v_min3_u32 v27,v27,v224,v228
v_mfma_f32_16x16x32_bf16 v[72:75],a[144:147],v[224:227],v[72:75]
ds_read_b128 v[252:255],v43 offset:25600
v_mfma_f32_16x16x32_bf16 v[64:67],a[20:23],v[228:231],v[64:67]
s_add_u32 s65,s95,512
v_mfma_f32_16x16x32_bf16 v[72:75],a[148:151],v[228:231],v[72:75]
s_waitcnt vmcnt(6)
s_barrier
ds_read_b128 v[224:227],v17 offset:32768
s_waitcnt lgkmcnt(5)
v_mfma_f32_16x16x32_bf16 v[64:67],a[24:27],v[232:235],v[64:67]
buffer_load_dwordx4 v42,s[20:23],s65 offen offset:0 sc1 lds
v_mfma_f32_16x16x32_bf16 v[72:75],a[152:155],v[232:235],v[72:75]
ds_read_b128 v[228:231],v43 offset:32768
v_min3_u32 v27,v27,v232,v236
v_mfma_f32_16x16x32_bf16 v[64:67],a[28:31],v[236:239],v[64:67]
buffer_load_dwordx4 v42,s[20:23],s65 offen offset:1024 sc1 lds
v_mfma_f32_16x16x32_bf16 v[72:75],a[156:159],v[236:239],v[72:75]
ds_read_b128 v[232:235],v17 offset:40960
s_waitcnt lgkmcnt(5)
v_mfma_f32_16x16x32_bf16 v[64:67],a[80:83],v[240:243],v[64:67]
s_xor_b32 m0,s91,53248
v_min3_u32 v27,v27,v240,v244
v_mfma_f32_16x16x32_bf16 v[72:75],a[208:211],v[240:243],v[72:75]
ds_read_b128 v[236:239],v43 offset:40960
v_mfma_f32_16x16x32_bf16 v[64:67],a[84:87],v[244:247],v[64:67]
s_add_u32 s65,s95,768
v_mfma_f32_16x16x32_bf16 v[72:75],a[212:215],v[244:247],v[72:75]
ds_read_b128 v[240:243],v17 offset:33792
s_waitcnt lgkmcnt(5)
v_mfma_f32_16x16x32_bf16 v[64:67],a[88:91],v[248:251],v[64:67]
buffer_load_dwordx4 v42,s[20:23],s65 offen offset:0 sc1 lds
v_min3_u32 v27,v27,v248,v252
v_mfma_f32_16x16x32_bf16 v[72:75],a[216:219],v[248:251],v[72:75]
ds_read_b128 v[244:247],v43 offset:33792
s_waitcnt vmcnt(63)
v_mfma_f32_16x16x32_bf16 v[64:67],a[92:95],v[252:255],v[64:67]
buffer_load_dwordx4 v42,s[20:23],s65 offen offset:1024 sc1 lds
v_mfma_f32_16x16x32_bf16 v[72:75],a[220:223],v[252:255],v[72:75]
ds_read_b128 v[248:251],v17 offset:41984
s_waitcnt lgkmcnt(5)
v_mfma_f32_16x16x32_bf16 v[64:67],a[32:35],v[224:227],v[64:67]
v_cmp_gt_u32 vcc,s96,v29
v_cmp_gt_u32 s[92:93],s92,v29
v_mfma_f32_16x16x32_bf16 v[72:75],a[160:163],v[224:227],v[72:75]
ds_read_b128 v[252:255],v43 offset:41984
v_min3_u32 v27,v27,v224,v228
v_mfma_f32_16x16x32_bf16 v[64:67],a[36:39],v[228:231],v[64:67]
v_mov_b32 v44,vcc_lo
v_mov_b32 v45,s92
v_mfma_f32_16x16x32_bf16 v[72:75],a[164:167],v[228:231],v[72:75]
ds_read_b128 v[224:227],v17 offset:49152
s_waitcnt lgkmcnt(5)
v_mfma_f32_16x16x32_bf16 v[64:67],a[40:43],v[232:235],v[64:67]
ds_write_b64 v46,v[44:45]
v_min3_u32 v27,v27,v232,v236
v_mfma_f32_16x16x32_bf16 v[72:75],a[168:171],v[232:235],v[72:75]
ds_read_b128 v[228:231],v43 offset:49152
v_mfma_f32_16x16x32_bf16 v[64:67],a[44:47],v[236:239],v[64:67]
v_mfma_f32_16x16x32_bf16 v[72:75],a[172:175],v[236:239],v[72:75]
ds_read_b128 v[232:235],v17 offset:57344
s_waitcnt lgkmcnt(6)
v_mfma_f32_16x16x32_bf16 v[64:67],a[96:99],v[240:243],v[64:67]
v_min3_u32 v27,v27,v240,v244
s_add_u32 s88,s70,s75
v_mfma_f32_16x16x32_bf16 v[72:75],a[224:227],v[240:243],v[72:75]
ds_read_b128 v[236:239],v43 offset:57344
s_add_u32 s88,s88,2097152
v_mfma_f32_16x16x32_bf16 v[64:67],a[100:103],v[244:247],v[64:67]
s_xor_b32 s88,s88,0x2000
s_add_u32 s89,s88,65536
v_mfma_f32_16x16x32_bf16 v[72:75],a[228:231],v[244:247],v[72:75]
ds_read_b128 v[240:243],v17 offset:50176
s_waitcnt lgkmcnt(6)
v_mfma_f32_16x16x32_bf16 v[64:67],a[104:107],v[248:251],v[64:67]
v_min3_u32 v27,v27,v248,v252
v_mfma_f32_16x16x32_bf16 v[72:75],a[232:235],v[248:251],v[72:75]
ds_read_b128 v[244:247],v43 offset:50176
v_mfma_f32_16x16x32_bf16 v[64:67],a[108:111],v[252:255],v[64:67]
v_mfma_f32_16x16x32_bf16 v[72:75],a[236:239],v[252:255],v[72:75]
ds_read_b128 v[248:251],v17 offset:58368
s_waitcnt lgkmcnt(5)
v_mfma_f32_16x16x32_bf16 v[64:67],a[48:51],v[224:227],v[64:67]
v_min3_u32 v27,v27,v224,v228
v_mfma_f32_16x16x32_bf16 v[72:75],a[176:179],v[224:227],v[72:75]
ds_read_b128 v[252:255],v43 offset:58368
v_mfma_f32_16x16x32_bf16 v[64:67],a[52:55],v[228:231],v[64:67]
v_mfma_f32_16x16x32_bf16 v[72:75],a[180:183],v[228:231],v[72:75]
s_waitcnt vmcnt(4)
s_barrier
ds_read_b64 v[44:45],v47
ds_read_b128 v[224:227],v17 offset:4096
s_waitcnt lgkmcnt(6)
v_mfma_f32_16x16x32_bf16 v[64:67],a[56:59],v[232:235],v[64:67]
v_min3_u32 v27,v27,v232,v236
v_mfma_f32_16x16x32_bf16 v[72:75],a[184:187],v[232:235],v[72:75]
ds_read_b128 v[228:231],v43 offset:4096
v_mfma_f32_16x16x32_bf16 v[64:67],a[60:63],v[236:239],v[64:67]
v_mfma_f32_16x16x32_bf16 v[72:75],a[188:191],v[236:239],v[72:75]
ds_read_b128 v[232:235],v17 offset:12288
s_waitcnt lgkmcnt(6)
v_mfma_f32_16x16x32_bf16 v[64:67],a[112:115],v[240:243],v[64:67]
v_min3_u32 v27,v27,v240,v244
v_mfma_f32_16x16x32_bf16 v[72:75],a[240:243],v[240:243],v[72:75]
ds_read_b128 v[236:239],v43 offset:12288
v_mfma_f32_16x16x32_bf16 v[64:67],a[116:119],v[244:247],v[64:67]
v_mfma_f32_16x16x32_bf16 v[72:75],a[244:247],v[244:247],v[72:75]
ds_read_b128 v[240:243],v17 offset:5120
s_waitcnt lgkmcnt(6)
v_mfma_f32_16x16x32_bf16 v[64:67],a[120:123],v[248:251],v[64:67]
s_waitcnt lgkmcnt(5)
v_readfirstlane_b32 s93,v45
v_mfma_f32_16x16x32_bf16 v[72:75],a[248:251],v[248:251],v[72:75]
ds_read_b128 v[244:247],v43 offset:5120
v_readfirstlane_b32 s83,v44
s_cmp_lg_u32 s83,0
s_cbranch_scc0 keep_228
v_mfma_f32_16x16x32_bf16 v[64:67],a[124:127],v[252:255],v[64:67]
v_min3_u32 v27,v27,v248,v252
v_mfma_f32_16x16x32_bf16 v[72:75],a[252:255],v[252:255],v[72:75]
ds_read_b128 v[248:251],v17 offset:13312
s_waitcnt lgkmcnt(5)
v_mfma_f32_16x16x32_bf16 v[68:71],a[0:3],v[224:227],0
v_cmp_eq_u32 vcc,0,v27
s_cbranch_vccnz retry_220
v_mfma_f32_16x16x32_bf16 v[76:79],a[128:131],v[224:227],0
ds_read_b128 v[252:255],v43 offset:13312
v_min3_u32 v27,v27,v224,v228
v_mfma_f32_16x16x32_bf16 v[68:71],a[4:7],v[228:231],v[68:71]
v_mfma_f32_16x16x32_bf16 v[76:79],a[132:135],v[228:231],v[76:79]
ds_read_b128 v[224:227],v17 offset:20480
s_waitcnt lgkmcnt(5)
v_mfma_f32_16x16x32_bf16 v[68:71],a[8:11],v[232:235],v[68:71]
v_min3_u32 v27,v27,v232,v236
v_mul_f32 v88,v64,v64
v_mul_f32 v92,v72,v72
v_mfma_f32_16x16x32_bf16 v[76:79],a[136:139],v[232:235],v[76:79]
ds_read_b128 v[228:231],v43 offset:20480
v_mul_f32 v89,v65,v65
v_mul_f32 v93,v73,v73
v_mfma_f32_16x16x32_bf16 v[68:71],a[12:15],v[236:239],v[68:71]
v_mul_f32 v90,v66,v66
v_mul_f32 v91,v67,v67
v_mul_f32 v94,v74,v74
v_mfma_f32_16x16x32_bf16 v[76:79],a[140:143],v[236:239],v[76:79]
ds_read_b128 v[232:235],v17 offset:28672
v_mul_f32 v95,v75,v75
s_waitcnt lgkmcnt(5)
v_mfma_f32_16x16x32_bf16 v[68:71],a[64:67],v[240:243],v[68:71]
v_min3_u32 v27,v27,v240,v244
v_fma_f32 v88,v88,s81,v28
v_fma_f32 v92,v92,s81,v28
v_mfma_f32_16x16x32_bf16 v[76:79],a[192:195],v[240:243],v[76:79]
ds_read_b128 v[236:239],v43 offset:28672
v_fma_f32 v89,v89,s81,v28
v_fma_f32 v93,v93,s81,v28
v_mfma_f32_16x16x32_bf16 v[68:71],a[68:71],v[244:247],v[68:71]
v_fma_f32 v90,v90,s81,v28
v_fma_f32 v91,v91,s81,v28
v_fma_f32 v94,v94,s81,v28
v_mfma_f32_16x16x32_bf16 v[76:79],a[196:199],v[244:247],v[76:79]
ds_read_b128 v[240:243],v17 offset:21504
v_fma_f32 v95,v95,s81,v28
s_waitcnt lgkmcnt(5)
v_mfma_f32_16x16x32_bf16 v[68:71],a[72:75],v[248:251],v[68:71]
v_min3_u32 v27,v27,v248,v252
v_mul_f32 v88,v88,v64
v_mul_f32 v92,v92,v72
v_mfma_f32_16x16x32_bf16 v[76:79],a[200:203],v[248:251],v[76:79]
ds_read_b128 v[244:247],v43 offset:21504
v_mul_f32 v89,v89,v65
v_mul_f32 v93,v93,v73
v_mfma_f32_16x16x32_bf16 v[68:71],a[76:79],v[252:255],v[68:71]
v_mul_f32 v90,v90,v66
v_mul_f32 v91,v91,v67
v_mul_f32 v94,v94,v74
v_mfma_f32_16x16x32_bf16 v[76:79],a[204:207],v[252:255],v[76:79]
ds_read_b128 v[248:251],v17 offset:29696
v_mul_f32 v95,v95,v75
s_waitcnt lgkmcnt(5)
v_mfma_f32_16x16x32_bf16 v[68:71],a[16:19],v[224:227],v[68:71]
v_min3_u32 v27,v27,v224,v228
v_exp_f32 v92,v92
v_mfma_f32_16x16x32_bf16 v[76:79],a[144:147],v[224:227],v[76:79]
ds_read_b128 v[252:255],v43 offset:29696
v_exp_f32 v93,v93
v_mfma_f32_16x16x32_bf16 v[68:71],a[20:23],v[228:231],v[68:71]
v_exp_f32 v88,v88
v_mfma_f32_16x16x32_bf16 v[76:79],a[148:151],v[228:231],v[76:79]
s_waitcnt vmcnt(0)
s_barrier
ds_read_b128 v[224:227],v17 offset:36864
s_waitcnt lgkmcnt(5)
v_mfma_f32_16x16x32_bf16 v[68:71],a[24:27],v[232:235],v[68:71]
v_min3_u32 v27,v27,v232,v236
v_exp_f32 v94,v94
v_mfma_f32_16x16x32_bf16 v[76:79],a[152:155],v[232:235],v[76:79]
ds_read_b128 v[228:231],v43 offset:36864
v_exp_f32 v95,v95
v_mfma_f32_16x16x32_bf16 v[68:71],a[28:31],v[236:239],v[68:71]
v_exp_f32 v89,v89
v_add_f32 v92,1.0,v92
v_mfma_f32_16x16x32_bf16 v[76:79],a[156:159],v[236:239],v[76:79]
ds_read_b128 v[232:235],v17 offset:45056
v_add_f32 v93,1.0,v93
s_waitcnt lgkmcnt(5)
v_mfma_f32_16x16x32_bf16 v[68:71],a[80:83],v[240:243],v[68:71]
v_min3_u32 v27,v27,v240,v244
v_add_f32 v94,1.0,v94
v_add_f32 v95,1.0,v95
v_mfma_f32_16x16x32_bf16 v[76:79],a[208:211],v[240:243],v[76:79]
ds_read_b128 v[236:239],v43 offset:45056
v_rcp_f32 v92,v92
v_mfma_f32_16x16x32_bf16 v[68:71],a[84:87],v[244:247],v[68:71]
v_exp_f32 v90,v90
v_mfma_f32_16x16x32_bf16 v[76:79],a[212:215],v[244:247],v[76:79]
ds_read_b128 v[240:243],v17 offset:37888
s_waitcnt lgkmcnt(5)
v_mfma_f32_16x16x32_bf16 v[68:71],a[88:91],v[248:251],v[68:71]
v_min3_u32 v27,v27,v248,v252
v_rcp_f32 v93,v93
v_mfma_f32_16x16x32_bf16 v[76:79],a[216:219],v[248:251],v[76:79]
ds_read_b128 v[244:247],v43 offset:37888
v_rcp_f32 v94,v94
v_mfma_f32_16x16x32_bf16 v[68:71],a[92:95],v[252:255],v[68:71]
v_exp_f32 v91,v91
v_mfma_f32_16x16x32_bf16 v[76:79],a[220:223],v[252:255],v[76:79]
ds_read_b128 v[248:251],v17 offset:46080
s_waitcnt lgkmcnt(5)
v_mfma_f32_16x16x32_bf16 v[68:71],a[32:35],v[224:227],v[68:71]
v_min3_u32 v27,v27,v224,v228
v_add_f32 v88,1.0,v88
v_mfma_f32_16x16x32_bf16 v[76:79],a[160:163],v[224:227],v[76:79]
ds_read_b128 v[252:255],v43 offset:46080
v_add_f32 v89,1.0,v89
v_mfma_f32_16x16x32_bf16 v[68:71],a[36:39],v[228:231],v[68:71]
v_add_f32 v90,1.0,v90
v_add_f32 v91,1.0,v91
v_mfma_f32_16x16x32_bf16 v[76:79],a[164:167],v[228:231],v[76:79]
ds_read_b128 v[224:227],v17 offset:53248
s_waitcnt lgkmcnt(5)
v_mfma_f32_16x16x32_bf16 v[68:71],a[40:43],v[232:235],v[68:71]
v_min3_u32 v27,v27,v232,v236
v_mfma_f32_16x16x32_bf16 v[76:79],a[168:171],v[232:235],v[76:79]
ds_read_b128 v[228:231],v43 offset:53248
v_mfma_f32_16x16x32_bf16 v[68:71],a[44:47],v[236:239],v[68:71]
v_rcp_f32 v88,v88
v_mfma_f32_16x16x32_bf16 v[76:79],a[172:175],v[236:239],v[76:79]
ds_read_b128 v[232:235],v17 offset:61440
s_waitcnt lgkmcnt(5)
v_mfma_f32_16x16x32_bf16 v[68:71],a[96:99],v[240:243],v[68:71]
v_min3_u32 v27,v27,v240,v244
v_mfma_f32_16x16x32_bf16 v[76:79],a[224:227],v[240:243],v[76:79]
ds_read_b128 v[236:239],v43 offset:61440
v_mfma_f32_16x16x32_bf16 v[68:71],a[100:103],v[244:247],v[68:71]
v_rcp_f32 v89,v89
v_mfma_f32_16x16x32_bf16 v[76:79],a[228:231],v[244:247],v[76:79]
ds_read_b128 v[240:243],v17 offset:54272
s_waitcnt lgkmcnt(5)
v_mfma_f32_16x16x32_bf16 v[68:71],a[104:107],v[248:251],v[68:71]
v_min3_u32 v27,v27,v248,v252
v_mfma_f32_16x16x32_bf16 v[76:79],a[232:235],v[248:251],v[76:79]
ds_read_b128 v[244:247],v43 offset:54272
v_mfma_f32_16x16x32_bf16 v[68:71],a[108:111],v[252:255],v[68:71]
v_rcp_f32 v90,v90
v_mfma_f32_16x16x32_bf16 v[76:79],a[236:239],v[252:255],v[76:79]
ds_read_b128 v[248:251],v17 offset:62464
s_waitcnt lgkmcnt(5)
v_mfma_f32_16x16x32_bf16 v[68:71],a[48:51],v[224:227],v[68:71]
v_min3_u32 v27,v27,v224,v228
v_mfma_f32_16x16x32_bf16 v[76:79],a[176:179],v[224:227],v[76:79]
ds_read_b128 v[252:255],v43 offset:62464
v_mfma_f32_16x16x32_bf16 v[68:71],a[52:55],v[228:231],v[68:71]
v_rcp_f32 v91,v91
v_mfma_f32_16x16x32_bf16 v[76:79],a[180:183],v[228:231],v[76:79]
v_mul_f32 v88,v88,v64
s_waitcnt lgkmcnt(4)
v_mfma_f32_16x16x32_bf16 v[68:71],a[56:59],v[232:235],v[68:71]
v_min3_u32 v27,v27,v232,v236
v_mul_f32 v89,v89,v65
v_mfma_f32_16x16x32_bf16 v[76:79],a[184:187],v[232:235],v[76:79]
v_mul_f32 v90,v90,v66
v_mul_f32 v91,v91,v67
v_mfma_f32_16x16x32_bf16 v[68:71],a[60:63],v[236:239],v[68:71]
v_rcp_f32 v95,v95
v_mfma_f32_16x16x32_bf16 v[76:79],a[188:191],v[236:239],v[76:79]
v_mul_f32 v92,v92,v72
s_waitcnt lgkmcnt(2)
v_mfma_f32_16x16x32_bf16 v[68:71],a[112:115],v[240:243],v[68:71]
v_min3_u32 v27,v27,v240,v244
v_mul_f32 v93,v93,v73
v_mfma_f32_16x16x32_bf16 v[76:79],a[240:243],v[240:243],v[76:79]
v_mul_f32 v94,v94,v74
v_mul_f32 v95,v95,v75
v_mfma_f32_16x16x32_bf16 v[68:71],a[116:119],v[244:247],v[68:71]
v_cvt_pk_bf16_f32 v96,v88,v89
v_cvt_pk_bf16_f32 v97,v90,v91
v_mfma_f32_16x16x32_bf16 v[76:79],a[244:247],v[244:247],v[76:79]
v_cvt_pk_bf16_f32 v98,v92,v93
s_waitcnt lgkmcnt(0)
v_mfma_f32_16x16x32_bf16 v[68:71],a[120:123],v[248:251],v[68:71]
v_min3_u32 v27,v27,v248,v252
v_cvt_pk_bf16_f32 v99,v94,v95
v_mfma_f32_16x16x32_bf16 v[76:79],a[248:251],v[248:251],v[76:79]
v_max_u32 v96,1,v96
v_mfma_f32_16x16x32_bf16 v[68:71],a[124:127],v[252:255],v[68:71]
buffer_store_dwordx4 v[96:99],v18,s[20:23],s78 offen sc1
v_mfma_f32_16x16x32_bf16 v[76:79],a[252:255],v[252:255],v[76:79]
v_cmp_eq_u32 vcc,0,v27
s_cbranch_vccnz retry_220
s_branch epi_223
keep_228:
v_mfma_f32_16x16x32_bf16 v[64:67],a[124:127],v[252:255],v[64:67]
v_min3_u32 v27,v27,v248,v252
s_xor_b32 m0,s72,0
v_mfma_f32_16x16x32_bf16 v[72:75],a[252:255],v[252:255],v[72:75]
ds_read_b128 v[248:251],v17 offset:13312
s_waitcnt lgkmcnt(5)
v_mfma_f32_16x16x32_bf16 v[68:71],a[0:3],v[224:227],0
s_add_u32 s65,s88,0
v_cmp_eq_u32 vcc,0,v27
s_cbranch_vccnz retry_220
v_mfma_f32_16x16x32_bf16 v[76:79],a[128:131],v[224:227],0
ds_read_b128 v[252:255],v43 offset:13312
v_min3_u32 v27,v27,v224,v228
v_mfma_f32_16x16x32_bf16 v[68:71],a[4:7],v[228:231],v[68:71]
buffer_load_dwordx4 v42,s[20:23],s65 offen offset:0 sc1 lds
v_mfma_f32_16x16x32_bf16 v[76:79],a[132:135],v[228:231],v[76:79]
ds_read_b128 v[224:227],v17 offset:20480
s_waitcnt lgkmcnt(5)
v_mfma_f32_16x16x32_bf16 v[68:71],a[8:11],v[232:235],v[68:71]
buffer_load_dwordx4 v42,s[20:23],s65 offen offset:1024 sc1 lds
v_mul_f32 v88,v64,v64
v_mul_f32 v89,v65,v65
v_mfma_f32_16x16x32_bf16 v[76:79],a[136:139],v[232:235],v[76:79]
ds_read_b128 v[228:231],v43 offset:20480
s_xor_b32 m0,s72,16384
v_mul_f32 v90,v66,v66
v_mul_f32 v91,v67,v67
v_mfma_f32_16x16x32_bf16 v[68:71],a[12:15],v[236:239],v[68:71]
s_add_u32 s65,s88,256
v_min3_u32 v27,v27,v232,v236
v_fma_f32 v88,v88,s81,v28
v_fma_f32 v89,v89,s81,v28
v_mfma_f32_16x16x32_bf16 v[76:79],a[140:143],v[236:239],v[76:79]
ds_read_b128 v[232:235],v17 offset:28672
v_fma_f32 v90,v90,s81,v28
v_fma_f32 v91,v91,s81,v28
s_waitcnt lgkmcnt(5)
v_mfma_f32_16x16x32_bf16 v[68:71],a[64:67],v[240:243],v[68:71]
buffer_load_dwordx4 v42,s[20:23],s65 offen offset:0 sc1 lds
v_mul_f32 v88,v88,v64
v_mul_f32 v89,v89,v65
v_mfma_f32_16x16x32_bf16 v[76:79],a[192:195],v[240:243],v[76:79]
ds_read_b128 v[236:239],v43 offset:28672
v_min3_u32 v27,v27,v240,v244
v_mul_f32 v90,v90,v66
v_mul_f32 v91,v91,v67
v_mfma_f32_16x16x32_bf16 v[68:71],a[68:71],v[244:247],v[68:71]
buffer_load_dwordx4 v42,s[20:23],s65 offen offset:1024 sc1 lds
v_exp_f32 v88,v88
v_mfma_f32_16x16x32_bf16 v[76:79],a[196:199],v[244:247],v[76:79]
ds_read_b128 v[240:243],v17 offset:21504
v_exp_f32 v89,v89
s_waitcnt lgkmcnt(5)
v_mfma_f32_16x16x32_bf16 v[68:71],a[72:75],v[248:251],v[68:71]
s_xor_b32 m0,s72,32768
s_add_u32 s65,s88,512
v_exp_f32 v90,v90
v_mfma_f32_16x16x32_bf16 v[76:79],a[200:203],v[248:251],v[76:79]
ds_read_b128 v[244:247],v43 offset:21504
v_min3_u32 v27,v27,v248,v252
v_exp_f32 v91,v91
v_mfma_f32_16x16x32_bf16 v[68:71],a[76:79],v[252:255],v[68:71]
buffer_load_dwordx4 v42,s[20:23],s65 offen offset:0 sc1 lds
v_add_f32 v88,1.0,v88
v_add_f32 v89,1.0,v89
v_mfma_f32_16x16x32_bf16 v[76:79],a[204:207],v[252:255],v[76:79]
ds_read_b128 v[248:251],v17 offset:29696
v_add_f32 v90,1.0,v90
v_add_f32 v91,1.0,v91
s_waitcnt lgkmcnt(5)
v_mfma_f32_16x16x32_bf16 v[68:71],a[16:19],v[224:227],v[68:71]
buffer_load_dwordx4 v42,s[20:23],s65 offen offset:1024 sc1 lds
v_rcp_f32 v88,v88
v_mfma_f32_16x16x32_bf16 v[76:79],a[144:147],v[224:227],v[76:79]
ds_read_b128 v[252:255],v43 offset:29696
s_xor_b32 m0,s72,49152
v_mul_f32 v92,v72,v72
v_mul_f32 v93,v73,v73
v_mfma_f32_16x16x32_bf16 v[68:71],a[20:23],v[228:231],v[68:71]
v_min3_u32 v27,v27,v224,v228
v_mul_f32 v94,v74,v74
v_mul_f32 v95,v75,v75
v_fma_f32 v92,v92,s81,v28
v_mfma_f32_16x16x32_bf16 v[76:79],a[148:151],v[228:231],v[76:79]
s_waitcnt vmcnt(6)
s_barrier
ds_read_b128 v[224:227],v17 offset:36864
s_waitcnt lgkmcnt(5)
v_mfma_f32_16x16x32_bf16 v[68:71],a[24:27],v[232:235],v[68:71]
s_add_u32 s65,s88,768
v_min3_u32 v27,v27,v232,v236
v_fma_f32 v93,v93,s81,v28
v_fma_f32 v94,v94,s81,v28
v_mfma_f32_16x16x32_bf16 v[76:79],a[152:155],v[232:235],v[76:79]
ds_read_b128 v[228:231],v43 offset:36864
v_fma_f32 v95,v95,s81,v28
v_mul_f32 v92,v92,v72
v_mul_f32 v93,v93,v73
v_mfma_f32_16x16x32_bf16 v[68:71],a[28:31],v[236:239],v[68:71]
buffer_load_dwordx4 v42,s[20:23],s65 offen offset:0 sc1 lds
v_mul_f32 v94,v94,v74
v_mul_f32 v95,v95,v75
v_mfma_f32_16x16x32_bf16 v[76:79],a[156:159],v[236:239],v[76:79]
ds_read_b128 v[232:235],v17 offset:45056
v_exp_f32 v92,v92
s_waitcnt lgkmcnt(5)
v_mfma_f32_16x16x32_bf16 v[68:71],a[80:83],v[240:243],v[68:71]
buffer_load_dwordx4 v42,s[20:23],s65 offen offset:1024 sc1 lds
v_exp_f32 v93,v93
v_mfma_f32_16x16x32_bf16 v[76:79],a[208:211],v[240:243],v[76:79]
ds_read_b128 v[236:239],v43 offset:45056
s_xor_b32 m0,s72,4096
v_exp_f32 v94,v94
v_mfma_f32_16x16x32_bf16 v[68:71],a[84:87],v[244:247],v[68:71]
s_add_u32 s65,s89,0
v_min3_u32 v27,v27,v240,v244
v_exp_f32 v95,v95
v_mfma_f32_16x16x32_bf16 v[76:79],a[212:215],v[244:247],v[76:79]
ds_read_b128 v[240:243],v17 offset:37888
v_add_f32 v92,1.0,v92
v_add_f32 v93,1.0,v93
s_waitcnt lgkmcnt(5)
v_mfma_f32_16x16x32_bf16 v[68:71],a[88:91],v[248:251],v[68:71]
buffer_load_dwordx4 v42,s[20:23],s65 offen offset:0 sc1 lds
v_add_f32 v94,1.0,v94
v_add_f32 v95,1.0,v95
v_mfma_f32_16x16x32_bf16 v[76:79],a[216:219],v[248:251],v[76:79]
ds_read_b128 v[244:247],v43 offset:37888
v_min3_u32 v27,v27,v248,v252
v_rcp_f32 v92,v92
v_mfma_f32_16x16x32_bf16 v[68:71],a[92:95],v[252:255],v[68:71]
buffer_load_dwordx4 v42,s[20:23],s65 offen offset:1024 sc1 lds
v_rcp_f32 v93,v93
v_mfma_f32_16x16x32_bf16 v[76:79],a[220:223],v[252:255],v[76:79]
ds_read_b128 v[248:251],v17 offset:46080
v_rcp_f32 v94,v94
s_waitcnt lgkmcnt(5)
v_mfma_f32_16x16x32_bf16 v[68:71],a[32:35],v[224:227],v[68:71]
s_xor_b32 m0,s72,20480
s_add_u32 s65,s89,256
v_rcp_f32 v95,v95
v_mfma_f32_16x16x32_bf16 v[76:79],a[160:163],v[224:227],v[76:79]
ds_read_b128 v[252:255],v43 offset:46080
v_min3_u32 v27,v27,v224,v228
v_mfma_f32_16x16x32_bf16 v[68:71],a[36:39],v[228:231],v[68:71]
buffer_load_dwordx4 v42,s[20:23],s65 offen offset:0 sc1 lds
v_mfma_f32_16x16x32_bf16 v[76:79],a[164:167],v[228:231],v[76:79]
ds_read_b128 v[224:227],v17 offset:53248
s_waitcnt lgkmcnt(5)
v_mfma_f32_16x16x32_bf16 v[68:71],a[40:43],v[232:235],v[68:71]
buffer_load_dwordx4 v42,s[20:23],s65 offen offset:1024 sc1 lds
v_mfma_f32_16x16x32_bf16 v[76:79],a[168:171],v[232:235],v[76:79]
ds_read_b128 v[228:231],v43 offset:53248
s_xor_b32 m0,s72,36864
v_mfma_f32_16x16x32_bf16 v[68:71],a[44:47],v[236:239],v[68:71]
s_add_u32 s65,s89,512
v_min3_u32 v27,v27,v232,v236
v_mfma_f32_16x16x32_bf16 v[76:79],a[172:175],v[236:239],v[76:79]
ds_read_b128 v[232:235],v17 offset:61440
s_waitcnt lgkmcnt(5)
v_mfma_f32_16x16x32_bf16 v[68:71],a[96:99],v[240:243],v[68:71]
buffer_load_dwordx4 v42,s[20:23],s65 offen offset:0 sc1 lds
v_mfma_f32_16x16x32_bf16 v[76:79],a[224:227],v[240:243],v[76:79]
ds_read_b128 v[236:239],v43 offset:61440
v_min3_u32 v27,v27,v240,v244
v_mfma_f32_16x16x32_bf16 v[68:71],a[100:103],v[244:247],v[68:71]
buffer_load_dwordx4 v42,s[20:23],s65 offen offset:1024 sc1 lds
v_mfma_f32_16x16x32_bf16 v[76:79],a[228:231],v[244:247],v[76:79]
ds_read_b128 v[240:243],v17 offset:54272
s_waitcnt lgkmcnt(5)
v_mfma_f32_16x16x32_bf16 v[68:71],a[104:107],v[248:251],v[68:71]
s_xor_b32 m0,s72,53248
v_min3_u32 v27,v27,v248,v252
v_mfma_f32_16x16x32_bf16 v[76:79],a[232:235],v[248:251],v[76:79]
ds_read_b128 v[244:247],v43 offset:54272
s_add_u32 s65,s89,768
v_mfma_f32_16x16x32_bf16 v[68:71],a[108:111],v[252:255],v[68:71]
buffer_load_dwordx4 v42,s[20:23],s65 offen offset:0 sc1 lds
v_mfma_f32_16x16x32_bf16 v[76:79],a[236:239],v[252:255],v[76:79]
ds_read_b128 v[248:251],v17 offset:62464
s_waitcnt lgkmcnt(5)
v_mfma_f32_16x16x32_bf16 v[68:71],a[48:51],v[224:227],v[68:71]
buffer_load_dwordx4 v42,s[20:23],s65 offen offset:1024 sc1 lds
v_mfma_f32_16x16x32_bf16 v[76:79],a[176:179],v[224:227],v[76:79]
ds_read_b128 v[252:255],v43 offset:62464
v_min3_u32 v27,v27,v224,v228
v_mfma_f32_16x16x32_bf16 v[68:71],a[52:55],v[228:231],v[68:71]
v_rcp_f32 v89,v89
v_mfma_f32_16x16x32_bf16 v[76:79],a[180:183],v[228:231],v[76:79]
v_mul_f32 v92,v92,v72
s_waitcnt lgkmcnt(4)
v_mfma_f32_16x16x32_bf16 v[68:71],a[56:59],v[232:235],v[68:71]
v_min3_u32 v27,v27,v232,v236
v_mul_f32 v93,v93,v73
v_mfma_f32_16x16x32_bf16 v[76:79],a[184:187],v[232:235],v[76:79]
v_rcp_f32 v90,v90
v_mfma_f32_16x16x32_bf16 v[68:71],a[60:63],v[236:239],v[68:71]
v_rcp_f32 v91,v91
v_mfma_f32_16x16x32_bf16 v[76:79],a[188:191],v[236:239],v[76:79]
v_mul_f32 v88,v88,v64
s_waitcnt lgkmcnt(2)
v_mfma_f32_16x16x32_bf16 v[68:71],a[112:115],v[240:243],v[68:71]
v_min3_u32 v27,v27,v240,v244
v_mul_f32 v89,v89,v65
v_mfma_f32_16x16x32_bf16 v[76:79],a[240:243],v[240:243],v[76:79]
v_mul_f32 v90,v90,v66
v_mul_f32 v91,v91,v67
v_mfma_f32_16x16x32_bf16 v[68:71],a[116:119],v[244:247],v[68:71]
v_mul_f32 v94,v94,v74
v_mul_f32 v95,v95,v75
v_mfma_f32_16x16x32_bf16 v[76:79],a[244:247],v[244:247],v[76:79]
v_cvt_pk_bf16_f32 v96,v88,v89
s_waitcnt lgkmcnt(0)
v_mfma_f32_16x16x32_bf16 v[68:71],a[120:123],v[248:251],v[68:71]
v_min3_u32 v27,v27,v248,v252
v_cvt_pk_bf16_f32 v97,v90,v91
v_mfma_f32_16x16x32_bf16 v[76:79],a[248:251],v[248:251],v[76:79]
v_cvt_pk_bf16_f32 v98,v92,v93
v_cvt_pk_bf16_f32 v99,v94,v95
v_mfma_f32_16x16x32_bf16 v[68:71],a[124:127],v[252:255],v[68:71]
v_max_u32 v96,1,v96
v_mfma_f32_16x16x32_bf16 v[76:79],a[252:255],v[252:255],v[76:79]
buffer_store_dwordx4 v[96:99],v18,s[20:23],s78 offen sc1
v_cmp_eq_u32 vcc,0,v27
s_cbranch_vccnz retry_220
s_branch epi_223
ahead_222:
s_cmp_eq_u32 s93,0
s_cbranch_scc1 both_224
s_waitcnt vmcnt(13) lgkmcnt(0)
s_barrier
ds_read_b128 v[224:227],v17 offset:0
ds_read_b128 v[228:231],v43 offset:0
ds_read_b128 v[232:235],v17 offset:8192
ds_read_b128 v[236:239],v43 offset:8192
ds_read_b128 v[240:243],v17 offset:1024
ds_read_b128 v[244:247],v43 offset:1024
ds_read_b128 v[248:251],v17 offset:9216
s_waitcnt lgkmcnt(5)
v_mfma_f32_16x16x32_bf16 v[64:67],a[0:3],v[224:227],0
s_add_u32 s96,s71,1
s_add_u32 s92,s71,2
v_mfma_f32_16x16x32_bf16 v[72:75],a[128:131],v[224:227],0
ds_read_b128 v[252:255],v43 offset:9216
v_min_u32 v27,v224,v228
v_mfma_f32_16x16x32_bf16 v[64:67],a[4:7],v[228:231],v[64:67]
v_mfma_f32_16x16x32_bf16 v[72:75],a[132:135],v[228:231],v[72:75]
ds_read_b128 v[224:227],v17 offset:16384
s_waitcnt lgkmcnt(5)
v_mfma_f32_16x16x32_bf16 v[64:67],a[8:11],v[232:235],v[64:67]
v_min3_u32 v27,v27,v232,v236
v_mfma_f32_16x16x32_bf16 v[72:75],a[136:139],v[232:235],v[72:75]
ds_read_b128 v[228:231],v43 offset:16384
v_mfma_f32_16x16x32_bf16 v[64:67],a[12:15],v[236:239],v[64:67]
v_mfma_f32_16x16x32_bf16 v[72:75],a[140:143],v[236:239],v[72:75]
ds_read_b128 v[232:235],v17 offset:24576
s_waitcnt lgkmcnt(5)
v_mfma_f32_16x16x32_bf16 v[64:67],a[64:67],v[240:243],v[64:67]
v_min3_u32 v27,v27,v240,v244
v_mfma_f32_16x16x32_bf16 v[72:75],a[192:195],v[240:243],v[72:75]
ds_read_b128 v[236:239],v43 offset:24576
v_mfma_f32_16x16x32_bf16 v[64:67],a[68:71],v[244:247],v[64:67]
v_mfma_f32_16x16x32_bf16 v[72:75],a[196:199],v[244:247],v[72:75]
ds_read_b128 v[240:243],v17 offset:17408
s_waitcnt lgkmcnt(5)
v_mfma_f32_16x16x32_bf16 v[64:67],a[72:75],v[248:251],v[64:67]
v_min3_u32 v27,v27,v248,v252
v_mfma_f32_16x16x32_bf16 v[72:75],a[200:203],v[248:251],v[72:75]
ds_read_b128 v[244:247],v43 offset:17408
v_mfma_f32_16x16x32_bf16 v[64:67],a[76:79],v[252:255],v[64:67]
v_mfma_f32_16x16x32_bf16 v[72:75],a[204:207],v[252:255],v[72:75]
ds_read_b128 v[248:251],v17 offset:25600
s_waitcnt lgkmcnt(5)
v_mfma_f32_16x16x32_bf16 v[64:67],a[16:19],v[224:227],v[64:67]
v_min3_u32 v27,v27,v224,v228
v_mfma_f32_16x16x32_bf16 v[72:75],a[144:147],v[224:227],v[72:75]
ds_read_b128 v[252:255],v43 offset:25600
v_mfma_f32_16x16x32_bf16 v[64:67],a[20:23],v[228:231],v[64:67]
v_mfma_f32_16x16x32_bf16 v[72:75],a[148:151],v[228:231],v[72:75]
ds_read_b128 v[224:227],v17 offset:32768
s_waitcnt lgkmcnt(5)
v_mfma_f32_16x16x32_bf16 v[64:67],a[24:27],v[232:235],v[64:67]
v_min3_u32 v27,v27,v232,v236
v_mfma_f32_16x16x32_bf16 v[72:75],a[152:155],v[232:235],v[72:75]
ds_read_b128 v[228:231],v43 offset:32768
v_mfma_f32_16x16x32_bf16 v[64:67],a[28:31],v[236:239],v[64:67]
v_mfma_f32_16x16x32_bf16 v[72:75],a[156:159],v[236:239],v[72:75]
ds_read_b128 v[232:235],v17 offset:40960
s_waitcnt lgkmcnt(5)
v_mfma_f32_16x16x32_bf16 v[64:67],a[80:83],v[240:243],v[64:67]
v_min3_u32 v27,v27,v240,v244
v_mfma_f32_16x16x32_bf16 v[72:75],a[208:211],v[240:243],v[72:75]
ds_read_b128 v[236:239],v43 offset:40960
v_mfma_f32_16x16x32_bf16 v[64:67],a[84:87],v[244:247],v[64:67]
v_mfma_f32_16x16x32_bf16 v[72:75],a[212:215],v[244:247],v[72:75]
ds_read_b128 v[240:243],v17 offset:33792
s_waitcnt lgkmcnt(5)
v_mfma_f32_16x16x32_bf16 v[64:67],a[88:91],v[248:251],v[64:67]
v_min3_u32 v27,v27,v248,v252
v_mfma_f32_16x16x32_bf16 v[72:75],a[216:219],v[248:251],v[72:75]
ds_read_b128 v[244:247],v43 offset:33792
s_waitcnt vmcnt(3)
v_mfma_f32_16x16x32_bf16 v[64:67],a[92:95],v[252:255],v[64:67]
v_cmp_gt_u32 vcc,s96,v29
v_cmp_gt_u32 s[92:93],s92,v29
v_mfma_f32_16x16x32_bf16 v[72:75],a[220:223],v[252:255],v[72:75]
ds_read_b128 v[248:251],v17 offset:41984
s_waitcnt lgkmcnt(5)
v_mfma_f32_16x16x32_bf16 v[64:67],a[32:35],v[224:227],v[64:67]
v_mov_b32 v44,vcc_lo
v_mov_b32 v45,s92
v_mfma_f32_16x16x32_bf16 v[72:75],a[160:163],v[224:227],v[72:75]
ds_read_b128 v[252:255],v43 offset:41984
ds_write_b64 v46,v[44:45]
v_mfma_f32_16x16x32_bf16 v[64:67],a[36:39],v[228:231],v[64:67]
v_min3_u32 v27,v27,v224,v228
v_mfma_f32_16x16x32_bf16 v[72:75],a[164:167],v[228:231],v[72:75]
ds_read_b128 v[224:227],v17 offset:49152
s_waitcnt lgkmcnt(6)
v_mfma_f32_16x16x32_bf16 v[64:67],a[40:43],v[232:235],v[64:67]
v_min3_u32 v27,v27,v232,v236
v_mfma_f32_16x16x32_bf16 v[72:75],a[168:171],v[232:235],v[72:75]
ds_read_b128 v[228:231],v43 offset:49152
v_mfma_f32_16x16x32_bf16 v[64:67],a[44:47],v[236:239],v[64:67]
v_mfma_f32_16x16x32_bf16 v[72:75],a[172:175],v[236:239],v[72:75]
ds_read_b128 v[232:235],v17 offset:57344
s_waitcnt lgkmcnt(6)
v_mfma_f32_16x16x32_bf16 v[64:67],a[96:99],v[240:243],v[64:67]
v_min3_u32 v27,v27,v240,v244
s_add_u32 s88,s70,s75
v_mfma_f32_16x16x32_bf16 v[72:75],a[224:227],v[240:243],v[72:75]
ds_read_b128 v[236:239],v43 offset:57344
s_add_u32 s88,s88,2097152
v_mfma_f32_16x16x32_bf16 v[64:67],a[100:103],v[244:247],v[64:67]
s_xor_b32 s88,s88,0x2000
s_add_u32 s89,s88,65536
v_mfma_f32_16x16x32_bf16 v[72:75],a[228:231],v[244:247],v[72:75]
ds_read_b128 v[240:243],v17 offset:50176
s_waitcnt lgkmcnt(6)
v_mfma_f32_16x16x32_bf16 v[64:67],a[104:107],v[248:251],v[64:67]
v_min3_u32 v27,v27,v248,v252
v_mfma_f32_16x16x32_bf16 v[72:75],a[232:235],v[248:251],v[72:75]
ds_read_b128 v[244:247],v43 offset:50176
v_mfma_f32_16x16x32_bf16 v[64:67],a[108:111],v[252:255],v[64:67]
v_mfma_f32_16x16x32_bf16 v[72:75],a[236:239],v[252:255],v[72:75]
ds_read_b128 v[248:251],v17 offset:58368
s_waitcnt lgkmcnt(5)
v_mfma_f32_16x16x32_bf16 v[64:67],a[48:51],v[224:227],v[64:67]
v_min3_u32 v27,v27,v224,v228
v_mfma_f32_16x16x32_bf16 v[72:75],a[176:179],v[224:227],v[72:75]
ds_read_b128 v[252:255],v43 offset:58368
v_mfma_f32_16x16x32_bf16 v[64:67],a[52:55],v[228:231],v[64:67]
s_waitcnt vmcnt(0)
v_add_u32 v22,s71,-1
v_mfma_f32_16x16x32_bf16 v[72:75],a[180:183],v[228:231],v[72:75]
s_waitcnt vmcnt(5)
s_barrier
ds_read_b64 v[44:45],v47
ds_read_b128 v[224:227],v17 offset:4096
s_waitcnt lgkmcnt(6)
v_mfma_f32_16x16x32_bf16 v[64:67],a[56:59],v[232:235],v[64:67]
v_min3_u32 v27,v27,v232,v236
buffer_store_dword v22,v23,s[24:27],s97 offen
v_mfma_f32_16x16x32_bf16 v[72:75],a[184:187],v[232:235],v[72:75]
ds_read_b128 v[228:231],v43 offset:4096
v_mfma_f32_16x16x32_bf16 v[64:67],a[60:63],v[236:239],v[64:67]
buffer_store_dword v22,v23,s[28:31],s97 offen sc1
v_mfma_f32_16x16x32_bf16 v[72:75],a[188:191],v[236:239],v[72:75]
ds_read_b128 v[232:235],v17 offset:12288
s_waitcnt lgkmcnt(6)
v_mfma_f32_16x16x32_bf16 v[64:67],a[112:115],v[240:243],v[64:67]
v_min3_u32 v27,v27,v240,v244
s_mov_b32 s97,0x7fff0000
v_mfma_f32_16x16x32_bf16 v[72:75],a[240:243],v[240:243],v[72:75]
ds_read_b128 v[236:239],v43 offset:12288
v_mfma_f32_16x16x32_bf16 v[64:67],a[116:119],v[244:247],v[64:67]
v_mfma_f32_16x16x32_bf16 v[72:75],a[244:247],v[244:247],v[72:75]
ds_read_b128 v[240:243],v17 offset:5120
s_waitcnt lgkmcnt(6)
v_mfma_f32_16x16x32_bf16 v[64:67],a[120:123],v[248:251],v[64:67]
s_waitcnt lgkmcnt(5)
v_readfirstlane_b32 s93,v45
v_mfma_f32_16x16x32_bf16 v[72:75],a[248:251],v[248:251],v[72:75]
ds_read_b128 v[244:247],v43 offset:5120
v_readfirstlane_b32 s83,v44
s_cmp_lg_u32 s83,0
s_cbranch_scc1 keep_229
v_mfma_f32_16x16x32_bf16 v[64:67],a[124:127],v[252:255],v[64:67]
v_min3_u32 v27,v27,v248,v252
s_xor_b32 m0,s72,0
v_mfma_f32_16x16x32_bf16 v[72:75],a[252:255],v[252:255],v[72:75]
ds_read_b128 v[248:251],v17 offset:13312
s_waitcnt lgkmcnt(5)
v_mfma_f32_16x16x32_bf16 v[68:71],a[0:3],v[224:227],0
s_add_u32 s65,s88,0
v_cmp_eq_u32 vcc,0,v27
s_cbranch_vccnz retry_220
v_mfma_f32_16x16x32_bf16 v[76:79],a[128:131],v[224:227],0
ds_read_b128 v[252:255],v43 offset:13312
v_min3_u32 v27,v27,v224,v228
v_mfma_f32_16x16x32_bf16 v[68:71],a[4:7],v[228:231],v[68:71]
buffer_load_dwordx4 v42,s[20:23],s65 offen offset:0 sc1 lds
v_mfma_f32_16x16x32_bf16 v[76:79],a[132:135],v[228:231],v[76:79]
ds_read_b128 v[224:227],v17 offset:20480
s_waitcnt lgkmcnt(5)
v_mfma_f32_16x16x32_bf16 v[68:71],a[8:11],v[232:235],v[68:71]
buffer_load_dwordx4 v42,s[20:23],s65 offen offset:1024 sc1 lds
v_mul_f32 v88,v64,v64
v_mul_f32 v89,v65,v65
v_mfma_f32_16x16x32_bf16 v[76:79],a[136:139],v[232:235],v[76:79]
ds_read_b128 v[228:231],v43 offset:20480
s_xor_b32 m0,s72,16384
v_mul_f32 v90,v66,v66
v_mul_f32 v91,v67,v67
v_mfma_f32_16x16x32_bf16 v[68:71],a[12:15],v[236:239],v[68:71]
s_add_u32 s65,s88,256
v_min3_u32 v27,v27,v232,v236
v_fma_f32 v88,v88,s81,v28
v_fma_f32 v89,v89,s81,v28
v_mfma_f32_16x16x32_bf16 v[76:79],a[140:143],v[236:239],v[76:79]
ds_read_b128 v[232:235],v17 offset:28672
v_fma_f32 v90,v90,s81,v28
v_fma_f32 v91,v91,s81,v28
s_waitcnt lgkmcnt(5)
v_mfma_f32_16x16x32_bf16 v[68:71],a[64:67],v[240:243],v[68:71]
buffer_load_dwordx4 v42,s[20:23],s65 offen offset:0 sc1 lds
v_mul_f32 v88,v88,v64
v_mul_f32 v89,v89,v65
v_mfma_f32_16x16x32_bf16 v[76:79],a[192:195],v[240:243],v[76:79]
ds_read_b128 v[236:239],v43 offset:28672
v_min3_u32 v27,v27,v240,v244
v_mul_f32 v90,v90,v66
v_mul_f32 v91,v91,v67
v_mfma_f32_16x16x32_bf16 v[68:71],a[68:71],v[244:247],v[68:71]
buffer_load_dwordx4 v42,s[20:23],s65 offen offset:1024 sc1 lds
v_exp_f32 v88,v88
v_mfma_f32_16x16x32_bf16 v[76:79],a[196:199],v[244:247],v[76:79]
ds_read_b128 v[240:243],v17 offset:21504
v_exp_f32 v89,v89
s_waitcnt lgkmcnt(5)
v_mfma_f32_16x16x32_bf16 v[68:71],a[72:75],v[248:251],v[68:71]
s_xor_b32 m0,s72,32768
s_add_u32 s65,s88,512
v_exp_f32 v90,v90
v_mfma_f32_16x16x32_bf16 v[76:79],a[200:203],v[248:251],v[76:79]
ds_read_b128 v[244:247],v43 offset:21504
v_min3_u32 v27,v27,v248,v252
v_exp_f32 v91,v91
v_mfma_f32_16x16x32_bf16 v[68:71],a[76:79],v[252:255],v[68:71]
buffer_load_dwordx4 v42,s[20:23],s65 offen offset:0 sc1 lds
v_add_f32 v88,1.0,v88
v_add_f32 v89,1.0,v89
v_mfma_f32_16x16x32_bf16 v[76:79],a[204:207],v[252:255],v[76:79]
ds_read_b128 v[248:251],v17 offset:29696
v_add_f32 v90,1.0,v90
v_add_f32 v91,1.0,v91
s_waitcnt lgkmcnt(5)
v_mfma_f32_16x16x32_bf16 v[68:71],a[16:19],v[224:227],v[68:71]
buffer_load_dwordx4 v42,s[20:23],s65 offen offset:1024 sc1 lds
v_rcp_f32 v88,v88
v_mfma_f32_16x16x32_bf16 v[76:79],a[144:147],v[224:227],v[76:79]
ds_read_b128 v[252:255],v43 offset:29696
s_xor_b32 m0,s72,49152
v_mul_f32 v92,v72,v72
v_mul_f32 v93,v73,v73
v_mfma_f32_16x16x32_bf16 v[68:71],a[20:23],v[228:231],v[68:71]
v_min3_u32 v27,v27,v224,v228
v_mul_f32 v94,v74,v74
v_mul_f32 v95,v75,v75
v_fma_f32 v92,v92,s81,v28
v_mfma_f32_16x16x32_bf16 v[76:79],a[148:151],v[228:231],v[76:79]
ds_read_b128 v[224:227],v17 offset:36864
v_fma_f32 v93,v93,s81,v28
v_fma_f32 v94,v94,s81,v28
s_waitcnt lgkmcnt(5)
v_mfma_f32_16x16x32_bf16 v[68:71],a[24:27],v[232:235],v[68:71]
s_add_u32 s65,s88,768
v_min3_u32 v27,v27,v232,v236
v_fma_f32 v95,v95,s81,v28
v_mul_f32 v92,v92,v72
v_mfma_f32_16x16x32_bf16 v[76:79],a[152:155],v[232:235],v[76:79]
ds_read_b128 v[228:231],v43 offset:36864
v_mul_f32 v93,v93,v73
v_mul_f32 v94,v94,v74
v_mul_f32 v95,v95,v75
v_mfma_f32_16x16x32_bf16 v[68:71],a[28:31],v[236:239],v[68:71]
buffer_load_dwordx4 v42,s[20:23],s65 offen offset:0 sc1 lds
v_exp_f32 v92,v92
v_mfma_f32_16x16x32_bf16 v[76:79],a[156:159],v[236:239],v[76:79]
ds_read_b128 v[232:235],v17 offset:45056
v_exp_f32 v93,v93
s_waitcnt lgkmcnt(5)
v_mfma_f32_16x16x32_bf16 v[68:71],a[80:83],v[240:243],v[68:71]
buffer_load_dwordx4 v42,s[20:23],s65 offen offset:1024 sc1 lds
v_exp_f32 v94,v94
v_mfma_f32_16x16x32_bf16 v[76:79],a[208:211],v[240:243],v[76:79]
ds_read_b128 v[236:239],v43 offset:45056
s_xor_b32 m0,s72,4096
v_exp_f32 v95,v95
v_mfma_f32_16x16x32_bf16 v[68:71],a[84:87],v[244:247],v[68:71]
s_add_u32 s65,s89,0
v_min3_u32 v27,v27,v240,v244
v_add_f32 v92,1.0,v92
v_add_f32 v93,1.0,v93
v_mfma_f32_16x16x32_bf16 v[76:79],a[212:215],v[244:247],v[76:79]
ds_read_b128 v[240:243],v17 offset:37888
v_add_f32 v94,1.0,v94
v_add_f32 v95,1.0,v95
s_waitcnt lgkmcnt(5)
v_mfma_f32_16x16x32_bf16 v[68:71],a[88:91],v[248:251],v[68:71]
buffer_load_dwordx4 v42,s[20:23],s65 offen offset:0 sc1 lds
v_rcp_f32 v92,v92
v_mfma_f32_16x16x32_bf16 v[76:79],a[216:219],v[248:251],v[76:79]
ds_read_b128 v[244:247],v43 offset:37888
v_min3_u32 v27,v27,v248,v252
v_rcp_f32 v93,v93
v_mfma_f32_16x16x32_bf16 v[68:71],a[92:95],v[252:255],v[68:71]
buffer_load_dwordx4 v42,s[20:23],s65 offen offset:1024 sc1 lds
v_rcp_f32 v94,v94
v_mfma_f32_16x16x32_bf16 v[76:79],a[220:223],v[252:255],v[76:79]
ds_read_b128 v[248:251],v17 offset:46080
v_rcp_f32 v95,v95
s_waitcnt lgkmcnt(5)
v_mfma_f32_16x16x32_bf16 v[68:71],a[32:35],v[224:227],v[68:71]
s_xor_b32 m0,s72,20480
s_add_u32 s65,s89,256
v_mfma_f32_16x16x32_bf16 v[76:79],a[160:163],v[224:227],v[76:79]
ds_read_b128 v[252:255],v43 offset:46080
v_min3_u32 v27,v27,v224,v228
v_mfma_f32_16x16x32_bf16 v[68:71],a[36:39],v[228:231],v[68:71]
buffer_load_dwordx4 v42,s[20:23],s65 offen offset:0 sc1 lds
v_mfma_f32_16x16x32_bf16 v[76:79],a[164:167],v[228:231],v[76:79]
ds_read_b128 v[224:227],v17 offset:53248
s_waitcnt lgkmcnt(5)
v_mfma_f32_16x16x32_bf16 v[68:71],a[40:43],v[232:235],v[68:71]
buffer_load_dwordx4 v42,s[20:23],s65 offen offset:1024 sc1 lds
v_mfma_f32_16x16x32_bf16 v[76:79],a[168:171],v[232:235],v[76:79]
ds_read_b128 v[228:231],v43 offset:53248
s_xor_b32 m0,s72,36864
v_mfma_f32_16x16x32_bf16 v[68:71],a[44:47],v[236:239],v[68:71]
s_add_u32 s65,s89,512
v_min3_u32 v27,v27,v232,v236
v_mfma_f32_16x16x32_bf16 v[76:79],a[172:175],v[236:239],v[76:79]
ds_read_b128 v[232:235],v17 offset:61440
s_waitcnt lgkmcnt(5)
v_mfma_f32_16x16x32_bf16 v[68:71],a[96:99],v[240:243],v[68:71]
buffer_load_dwordx4 v42,s[20:23],s65 offen offset:0 sc1 lds
v_mfma_f32_16x16x32_bf16 v[76:79],a[224:227],v[240:243],v[76:79]
ds_read_b128 v[236:239],v43 offset:61440
v_min3_u32 v27,v27,v240,v244
v_mfma_f32_16x16x32_bf16 v[68:71],a[100:103],v[244:247],v[68:71]
buffer_load_dwordx4 v42,s[20:23],s65 offen offset:1024 sc1 lds
v_mfma_f32_16x16x32_bf16 v[76:79],a[228:231],v[244:247],v[76:79]
ds_read_b128 v[240:243],v17 offset:54272
s_waitcnt lgkmcnt(5)
v_mfma_f32_16x16x32_bf16 v[68:71],a[104:107],v[248:251],v[68:71]
s_xor_b32 m0,s72,53248
v_min3_u32 v27,v27,v248,v252
v_mfma_f32_16x16x32_bf16 v[76:79],a[232:235],v[248:251],v[76:79]
ds_read_b128 v[244:247],v43 offset:54272
s_add_u32 s65,s89,768
v_mfma_f32_16x16x32_bf16 v[68:71],a[108:111],v[252:255],v[68:71]
buffer_load_dwordx4 v42,s[20:23],s65 offen offset:0 sc1 lds
v_mfma_f32_16x16x32_bf16 v[76:79],a[236:239],v[252:255],v[76:79]
ds_read_b128 v[248:251],v17 offset:62464
s_waitcnt lgkmcnt(5)
v_mfma_f32_16x16x32_bf16 v[68:71],a[48:51],v[224:227],v[68:71]
buffer_load_dwordx4 v42,s[20:23],s65 offen offset:1024 sc1 lds
v_mfma_f32_16x16x32_bf16 v[76:79],a[176:179],v[224:227],v[76:79]
ds_read_b128 v[252:255],v43 offset:62464
v_min3_u32 v27,v27,v224,v228
v_mfma_f32_16x16x32_bf16 v[68:71],a[52:55],v[228:231],v[68:71]
v_rcp_f32 v89,v89
v_mfma_f32_16x16x32_bf16 v[76:79],a[180:183],v[228:231],v[76:79]
v_mul_f32 v92,v92,v72
s_waitcnt lgkmcnt(4)
v_mfma_f32_16x16x32_bf16 v[68:71],a[56:59],v[232:235],v[68:71]
v_min3_u32 v27,v27,v232,v236
v_mul_f32 v93,v93,v73
v_mfma_f32_16x16x32_bf16 v[76:79],a[184:187],v[232:235],v[76:79]
v_rcp_f32 v90,v90
v_mfma_f32_16x16x32_bf16 v[68:71],a[60:63],v[236:239],v[68:71]
v_rcp_f32 v91,v91
v_mfma_f32_16x16x32_bf16 v[76:79],a[188:191],v[236:239],v[76:79]
v_mul_f32 v88,v88,v64
s_waitcnt lgkmcnt(2)
v_mfma_f32_16x16x32_bf16 v[68:71],a[112:115],v[240:243],v[68:71]
v_min3_u32 v27,v27,v240,v244
v_mul_f32 v89,v89,v65
v_mfma_f32_16x16x32_bf16 v[76:79],a[240:243],v[240:243],v[76:79]
v_mul_f32 v90,v90,v66
v_mul_f32 v91,v91,v67
v_mfma_f32_16x16x32_bf16 v[68:71],a[116:119],v[244:247],v[68:71]
v_mul_f32 v94,v94,v74
v_mul_f32 v95,v95,v75
v_mfma_f32_16x16x32_bf16 v[76:79],a[244:247],v[244:247],v[76:79]
v_cvt_pk_bf16_f32 v96,v88,v89
s_waitcnt lgkmcnt(0)
v_mfma_f32_16x16x32_bf16 v[68:71],a[120:123],v[248:251],v[68:71]
v_min3_u32 v27,v27,v248,v252
v_cvt_pk_bf16_f32 v97,v90,v91
v_mfma_f32_16x16x32_bf16 v[76:79],a[248:251],v[248:251],v[76:79]
v_cvt_pk_bf16_f32 v98,v92,v93
v_cvt_pk_bf16_f32 v99,v94,v95
v_mfma_f32_16x16x32_bf16 v[68:71],a[124:127],v[252:255],v[68:71]
v_max_u32 v96,1,v96
v_mfma_f32_16x16x32_bf16 v[76:79],a[252:255],v[252:255],v[76:79]
buffer_store_dwordx4 v[96:99],v18,s[20:23],s78 offen sc1
v_cmp_eq_u32 vcc,0,v27
s_cbranch_vccnz retry_220
s_branch epi_223
keep_229:
v_mfma_f32_16x16x32_bf16 v[64:67],a[124:127],v[252:255],v[64:67]
v_min3_u32 v27,v27,v248,v252
v_mfma_f32_16x16x32_bf16 v[72:75],a[252:255],v[252:255],v[72:75]
ds_read_b128 v[248:251],v17 offset:13312
s_waitcnt lgkmcnt(5)
v_mfma_f32_16x16x32_bf16 v[68:71],a[0:3],v[224:227],0
v_cmp_eq_u32 vcc,0,v27
s_cbranch_vccnz retry_220
v_mfma_f32_16x16x32_bf16 v[76:79],a[128:131],v[224:227],0
ds_read_b128 v[252:255],v43 offset:13312
v_min3_u32 v27,v27,v224,v228
v_mfma_f32_16x16x32_bf16 v[68:71],a[4:7],v[228:231],v[68:71]
v_mfma_f32_16x16x32_bf16 v[76:79],a[132:135],v[228:231],v[76:79]
ds_read_b128 v[224:227],v17 offset:20480
s_waitcnt lgkmcnt(5)
v_mfma_f32_16x16x32_bf16 v[68:71],a[8:11],v[232:235],v[68:71]
v_min3_u32 v27,v27,v232,v236
v_mul_f32 v88,v64,v64
v_mul_f32 v92,v72,v72
v_mfma_f32_16x16x32_bf16 v[76:79],a[136:139],v[232:235],v[76:79]
ds_read_b128 v[228:231],v43 offset:20480
v_mul_f32 v89,v65,v65
v_mul_f32 v93,v73,v73
v_mfma_f32_16x16x32_bf16 v[68:71],a[12:15],v[236:239],v[68:71]
v_mul_f32 v90,v66,v66
v_mul_f32 v91,v67,v67
v_mul_f32 v94,v74,v74
v_mfma_f32_16x16x32_bf16 v[76:79],a[140:143],v[236:239],v[76:79]
ds_read_b128 v[232:235],v17 offset:28672
v_mul_f32 v95,v75,v75
s_waitcnt lgkmcnt(5)
v_mfma_f32_16x16x32_bf16 v[68:71],a[64:67],v[240:243],v[68:71]
v_min3_u32 v27,v27,v240,v244
v_fma_f32 v88,v88,s81,v28
v_fma_f32 v92,v92,s81,v28
v_mfma_f32_16x16x32_bf16 v[76:79],a[192:195],v[240:243],v[76:79]
ds_read_b128 v[236:239],v43 offset:28672
v_fma_f32 v89,v89,s81,v28
v_fma_f32 v93,v93,s81,v28
v_mfma_f32_16x16x32_bf16 v[68:71],a[68:71],v[244:247],v[68:71]
v_fma_f32 v90,v90,s81,v28
v_fma_f32 v91,v91,s81,v28
v_fma_f32 v94,v94,s81,v28
v_mfma_f32_16x16x32_bf16 v[76:79],a[196:199],v[244:247],v[76:79]
ds_read_b128 v[240:243],v17 offset:21504
v_fma_f32 v95,v95,s81,v28
s_waitcnt lgkmcnt(5)
v_mfma_f32_16x16x32_bf16 v[68:71],a[72:75],v[248:251],v[68:71]
v_min3_u32 v27,v27,v248,v252
v_mul_f32 v88,v88,v64
v_mul_f32 v92,v92,v72
v_mfma_f32_16x16x32_bf16 v[76:79],a[200:203],v[248:251],v[76:79]
ds_read_b128 v[244:247],v43 offset:21504
v_mul_f32 v89,v89,v65
v_mul_f32 v93,v93,v73
v_mfma_f32_16x16x32_bf16 v[68:71],a[76:79],v[252:255],v[68:71]
v_mul_f32 v90,v90,v66
v_mul_f32 v91,v91,v67
v_mul_f32 v94,v94,v74
v_mfma_f32_16x16x32_bf16 v[76:79],a[204:207],v[252:255],v[76:79]
ds_read_b128 v[248:251],v17 offset:29696
v_mul_f32 v95,v95,v75
s_waitcnt lgkmcnt(5)
v_mfma_f32_16x16x32_bf16 v[68:71],a[16:19],v[224:227],v[68:71]
v_min3_u32 v27,v27,v224,v228
v_exp_f32 v92,v92
v_mfma_f32_16x16x32_bf16 v[76:79],a[144:147],v[224:227],v[76:79]
ds_read_b128 v[252:255],v43 offset:29696
v_exp_f32 v93,v93
v_mfma_f32_16x16x32_bf16 v[68:71],a[20:23],v[228:231],v[68:71]
v_exp_f32 v88,v88
v_mfma_f32_16x16x32_bf16 v[76:79],a[148:151],v[228:231],v[76:79]
ds_read_b128 v[224:227],v17 offset:36864
s_waitcnt lgkmcnt(5)
v_mfma_f32_16x16x32_bf16 v[68:71],a[24:27],v[232:235],v[68:71]
v_min3_u32 v27,v27,v232,v236
v_exp_f32 v94,v94
v_mfma_f32_16x16x32_bf16 v[76:79],a[152:155],v[232:235],v[76:79]
ds_read_b128 v[228:231],v43 offset:36864
v_exp_f32 v95,v95
v_mfma_f32_16x16x32_bf16 v[68:71],a[28:31],v[236:239],v[68:71]
v_exp_f32 v89,v89
v_add_f32 v92,1.0,v92
v_mfma_f32_16x16x32_bf16 v[76:79],a[156:159],v[236:239],v[76:79]
ds_read_b128 v[232:235],v17 offset:45056
v_add_f32 v93,1.0,v93
s_waitcnt lgkmcnt(5)
v_mfma_f32_16x16x32_bf16 v[68:71],a[80:83],v[240:243],v[68:71]
v_min3_u32 v27,v27,v240,v244
v_add_f32 v94,1.0,v94
v_add_f32 v95,1.0,v95
v_mfma_f32_16x16x32_bf16 v[76:79],a[208:211],v[240:243],v[76:79]
ds_read_b128 v[236:239],v43 offset:45056
v_rcp_f32 v92,v92
v_mfma_f32_16x16x32_bf16 v[68:71],a[84:87],v[244:247],v[68:71]
v_exp_f32 v90,v90
v_mfma_f32_16x16x32_bf16 v[76:79],a[212:215],v[244:247],v[76:79]
ds_read_b128 v[240:243],v17 offset:37888
s_waitcnt lgkmcnt(5)
v_mfma_f32_16x16x32_bf16 v[68:71],a[88:91],v[248:251],v[68:71]
v_min3_u32 v27,v27,v248,v252
v_rcp_f32 v93,v93
v_mfma_f32_16x16x32_bf16 v[76:79],a[216:219],v[248:251],v[76:79]
ds_read_b128 v[244:247],v43 offset:37888
v_rcp_f32 v94,v94
v_mfma_f32_16x16x32_bf16 v[68:71],a[92:95],v[252:255],v[68:71]
v_exp_f32 v91,v91
v_mfma_f32_16x16x32_bf16 v[76:79],a[220:223],v[252:255],v[76:79]
ds_read_b128 v[248:251],v17 offset:46080
s_waitcnt lgkmcnt(5)
v_mfma_f32_16x16x32_bf16 v[68:71],a[32:35],v[224:227],v[68:71]
v_min3_u32 v27,v27,v224,v228
v_add_f32 v88,1.0,v88
v_mfma_f32_16x16x32_bf16 v[76:79],a[160:163],v[224:227],v[76:79]
ds_read_b128 v[252:255],v43 offset:46080
v_add_f32 v89,1.0,v89
v_mfma_f32_16x16x32_bf16 v[68:71],a[36:39],v[228:231],v[68:71]
v_add_f32 v90,1.0,v90
v_add_f32 v91,1.0,v91
v_mfma_f32_16x16x32_bf16 v[76:79],a[164:167],v[228:231],v[76:79]
ds_read_b128 v[224:227],v17 offset:53248
s_waitcnt lgkmcnt(5)
v_mfma_f32_16x16x32_bf16 v[68:71],a[40:43],v[232:235],v[68:71]
v_min3_u32 v27,v27,v232,v236
v_mfma_f32_16x16x32_bf16 v[76:79],a[168:171],v[232:235],v[76:79]
ds_read_b128 v[228:231],v43 offset:53248
v_mfma_f32_16x16x32_bf16 v[68:71],a[44:47],v[236:239],v[68:71]
v_rcp_f32 v88,v88
v_mfma_f32_16x16x32_bf16 v[76:79],a[172:175],v[236:239],v[76:79]
ds_read_b128 v[232:235],v17 offset:61440
s_waitcnt lgkmcnt(5)
v_mfma_f32_16x16x32_bf16 v[68:71],a[96:99],v[240:243],v[68:71]
v_min3_u32 v27,v27,v240,v244
v_mfma_f32_16x16x32_bf16 v[76:79],a[224:227],v[240:243],v[76:79]
ds_read_b128 v[236:239],v43 offset:61440
v_mfma_f32_16x16x32_bf16 v[68:71],a[100:103],v[244:247],v[68:71]
v_rcp_f32 v89,v89
v_mfma_f32_16x16x32_bf16 v[76:79],a[228:231],v[244:247],v[76:79]
ds_read_b128 v[240:243],v17 offset:54272
s_waitcnt lgkmcnt(5)
v_mfma_f32_16x16x32_bf16 v[68:71],a[104:107],v[248:251],v[68:71]
v_min3_u32 v27,v27,v248,v252
v_mfma_f32_16x16x32_bf16 v[76:79],a[232:235],v[248:251],v[76:79]
ds_read_b128 v[244:247],v43 offset:54272
v_mfma_f32_16x16x32_bf16 v[68:71],a[108:111],v[252:255],v[68:71]
v_rcp_f32 v90,v90
v_mfma_f32_16x16x32_bf16 v[76:79],a[236:239],v[252:255],v[76:79]
ds_read_b128 v[248:251],v17 offset:62464
s_waitcnt lgkmcnt(5)
v_mfma_f32_16x16x32_bf16 v[68:71],a[48:51],v[224:227],v[68:71]
v_min3_u32 v27,v27,v224,v228
v_mfma_f32_16x16x32_bf16 v[76:79],a[176:179],v[224:227],v[76:79]
ds_read_b128 v[252:255],v43 offset:62464
v_mfma_f32_16x16x32_bf16 v[68:71],a[52:55],v[228:231],v[68:71]
v_rcp_f32 v91,v91
v_mfma_f32_16x16x32_bf16 v[76:79],a[180:183],v[228:231],v[76:79]
v_mul_f32 v88,v88,v64
s_waitcnt lgkmcnt(4)
v_mfma_f32_16x16x32_bf16 v[68:71],a[56:59],v[232:235],v[68:71]
v_min3_u32 v27,v27,v232,v236
v_mul_f32 v89,v89,v65
v_mfma_f32_16x16x32_bf16 v[76:79],a[184:187],v[232:235],v[76:79]
v_mul_f32 v90,v90,v66
v_mul_f32 v91,v91,v67
v_mfma_f32_16x16x32_bf16 v[68:71],a[60:63],v[236:239],v[68:71]
v_rcp_f32 v95,v95
v_mfma_f32_16x16x32_bf16 v[76:79],a[188:191],v[236:239],v[76:79]
v_mul_f32 v92,v92,v72
s_waitcnt lgkmcnt(2)
v_mfma_f32_16x16x32_bf16 v[68:71],a[112:115],v[240:243],v[68:71]
v_min3_u32 v27,v27,v240,v244
v_mul_f32 v93,v93,v73
v_mfma_f32_16x16x32_bf16 v[76:79],a[240:243],v[240:243],v[76:79]
v_mul_f32 v94,v94,v74
v_mul_f32 v95,v95,v75
v_mfma_f32_16x16x32_bf16 v[68:71],a[116:119],v[244:247],v[68:71]
v_cvt_pk_bf16_f32 v96,v88,v89
v_cvt_pk_bf16_f32 v97,v90,v91
v_mfma_f32_16x16x32_bf16 v[76:79],a[244:247],v[244:247],v[76:79]
v_cvt_pk_bf16_f32 v98,v92,v93
s_waitcnt lgkmcnt(0)
v_mfma_f32_16x16x32_bf16 v[68:71],a[120:123],v[248:251],v[68:71]
v_min3_u32 v27,v27,v248,v252
v_cvt_pk_bf16_f32 v99,v94,v95
v_mfma_f32_16x16x32_bf16 v[76:79],a[248:251],v[248:251],v[76:79]
v_max_u32 v96,1,v96
v_mfma_f32_16x16x32_bf16 v[68:71],a[124:127],v[252:255],v[68:71]
buffer_store_dwordx4 v[96:99],v18,s[20:23],s78 offen sc1
v_mfma_f32_16x16x32_bf16 v[76:79],a[252:255],v[252:255],v[76:79]
v_cmp_eq_u32 vcc,0,v27
s_cbranch_vccnz retry_220
s_branch epi_223
both_224:
s_waitcnt vmcnt(13) lgkmcnt(0)
s_barrier
ds_read_b128 v[224:227],v17 offset:0
ds_read_b128 v[228:231],v43 offset:0
ds_read_b128 v[232:235],v17 offset:8192
ds_read_b128 v[236:239],v43 offset:8192
ds_read_b128 v[240:243],v17 offset:1024
ds_read_b128 v[244:247],v43 offset:1024
ds_read_b128 v[248:251],v17 offset:9216
s_waitcnt lgkmcnt(5)
v_mfma_f32_16x16x32_bf16 v[64:67],a[0:3],v[224:227],0
s_add_u32 s96,s71,1
s_add_u32 s92,s71,2
v_min_u32 v27,v224,v228
v_mfma_f32_16x16x32_bf16 v[72:75],a[128:131],v[224:227],0
ds_read_b128 v[252:255],v43 offset:9216
s_add_u32 s88,s70,s75
v_mfma_f32_16x16x32_bf16 v[64:67],a[4:7],v[228:231],v[64:67]
s_add_u32 s88,s88,2097152
s_xor_b32 s88,s88,0x2000
v_mfma_f32_16x16x32_bf16 v[72:75],a[132:135],v[228:231],v[72:75]
ds_read_b128 v[224:227],v17 offset:16384
s_waitcnt lgkmcnt(5)
v_mfma_f32_16x16x32_bf16 v[64:67],a[8:11],v[232:235],v[64:67]
s_add_u32 s89,s88,65536
v_min3_u32 v27,v27,v232,v236
v_mfma_f32_16x16x32_bf16 v[72:75],a[136:139],v[232:235],v[72:75]
ds_read_b128 v[228:231],v43 offset:16384
v_mfma_f32_16x16x32_bf16 v[64:67],a[12:15],v[236:239],v[64:67]
s_xor_b32 m0,s72,0
v_mfma_f32_16x16x32_bf16 v[72:75],a[140:143],v[236:239],v[72:75]
ds_read_b128 v[232:235],v17 offset:24576
s_add_u32 s65,s88,0
s_waitcnt lgkmcnt(5)
v_mfma_f32_16x16x32_bf16 v[64:67],a[64:67],v[240:243],v[64:67]
v_min3_u32 v27,v27,v240,v244
v_mfma_f32_16x16x32_bf16 v[72:75],a[192:195],v[240:243],v[72:75]
ds_read_b128 v[236:239],v43 offset:24576
buffer_load_dwordx4 v42,s[20:23],s65 offen offset:0 sc1 lds
v_mfma_f32_16x16x32_bf16 v[64:67],a[68:71],v[244:247],v[64:67]
buffer_load_dwordx4 v42,s[20:23],s65 offen offset:1024 sc1 lds
v_mfma_f32_16x16x32_bf16 v[72:75],a[196:199],v[244:247],v[72:75]
ds_read_b128 v[240:243],v17 offset:17408
s_waitcnt lgkmcnt(5)
v_mfma_f32_16x16x32_bf16 v[64:67],a[72:75],v[248:251],v[64:67]
s_xor_b32 m0,s72,16384
v_min3_u32 v27,v27,v248,v252
v_mfma_f32_16x16x32_bf16 v[72:75],a[200:203],v[248:251],v[72:75]
ds_read_b128 v[244:247],v43 offset:17408
v_mfma_f32_16x16x32_bf16 v[64:67],a[76:79],v[252:255],v[64:67]
s_add_u32 s65,s88,256
v_mfma_f32_16x16x32_bf16 v[72:75],a[204:207],v[252:255],v[72:75]
ds_read_b128 v[248:251],v17 offset:25600
s_waitcnt lgkmcnt(5)
v_mfma_f32_16x16x32_bf16 v[64:67],a[16:19],v[224:227],v[64:67]
buffer_load_dwordx4 v42,s[20:23],s65 offen offset:0 sc1 lds
v_mfma_f32_16x16x32_bf16 v[72:75],a[144:147],v[224:227],v[72:75]
ds_read_b128 v[252:255],v43 offset:25600
buffer_load_dwordx4 v42,s[20:23],s65 offen offset:1024 sc1 lds
v_mfma_f32_16x16x32_bf16 v[64:67],a[20:23],v[228:231],v[64:67]
v_min3_u32 v27,v27,v224,v228
v_mfma_f32_16x16x32_bf16 v[72:75],a[148:151],v[228:231],v[72:75]
ds_read_b128 v[224:227],v17 offset:32768
s_xor_b32 m0,s72,32768
s_waitcnt lgkmcnt(5)
v_mfma_f32_16x16x32_bf16 v[64:67],a[24:27],v[232:235],v[64:67]
s_add_u32 s65,s88,512
v_min3_u32 v27,v27,v232,v236
v_mfma_f32_16x16x32_bf16 v[72:75],a[152:155],v[232:235],v[72:75]
ds_read_b128 v[228:231],v43 offset:32768
v_mfma_f32_16x16x32_bf16 v[64:67],a[28:31],v[236:239],v[64:67]
buffer_load_dwordx4 v42,s[20:23],s65 offen offset:0 sc1 lds
v_mfma_f32_16x16x32_bf16 v[72:75],a[156:159],v[236:239],v[72:75]
ds_read_b128 v[232:235],v17 offset:40960
s_waitcnt lgkmcnt(5)
v_mfma_f32_16x16x32_bf16 v[64:67],a[80:83],v[240:243],v[64:67]
buffer_load_dwordx4 v42,s[20:23],s65 offen offset:1024 sc1 lds
v_mfma_f32_16x16x32_bf16 v[72:75],a[208:211],v[240:243],v[72:75]
ds_read_b128 v[236:239],v43 offset:40960
s_xor_b32 m0,s72,49152
v_mfma_f32_16x16x32_bf16 v[64:67],a[84:87],v[244:247],v[64:67]
v_min3_u32 v27,v27,v240,v244
v_mfma_f32_16x16x32_bf16 v[72:75],a[212:215],v[244:247],v[72:75]
ds_read_b128 v[240:243],v17 offset:33792
s_add_u32 s65,s88,768
s_waitcnt lgkmcnt(5)
v_mfma_f32_16x16x32_bf16 v[64:67],a[88:91],v[248:251],v[64:67]
buffer_load_dwordx4 v42,s[20:23],s65 offen offset:0 sc1 lds
v_min3_u32 v27,v27,v248,v252
v_mfma_f32_16x16x32_bf16 v[72:75],a[216:219],v[248:251],v[72:75]
ds_read_b128 v[244:247],v43 offset:33792
s_waitcnt vmcnt(10)
v_mfma_f32_16x16x32_bf16 v[64:67],a[92:95],v[252:255],v[64:67]
v_cmp_gt_u32 vcc,s96,v29
v_cmp_gt_u32 s[92:93],s92,v29
v_mfma_f32_16x16x32_bf16 v[72:75],a[220:223],v[252:255],v[72:75]
ds_read_b128 v[248:251],v17 offset:41984
s_waitcnt lgkmcnt(5)
v_mfma_f32_16x16x32_bf16 v[64:67],a[32:35],v[224:227],v[64:67]
v_mov_b32 v44,vcc_lo
v_mov_b32 v45,s92
v_min3_u32 v27,v27,v224,v228
v_mfma_f32_16x16x32_bf16 v[72:75],a[160:163],v[224:227],v[72:75]
ds_read_b128 v[252:255],v43 offset:41984
ds_write_b64 v46,v[44:45]
v_mfma_f32_16x16x32_bf16 v[64:67],a[36:39],v[228:231],v[64:67]
buffer_load_dwordx4 v42,s[20:23],s65 offen offset:1024 sc1 lds
v_mfma_f32_16x16x32_bf16 v[72:75],a[164:167],v[228:231],v[72:75]
ds_read_b128 v[224:227],v17 offset:49152
s_waitcnt lgkmcnt(6)
v_mfma_f32_16x16x32_bf16 v[64:67],a[40:43],v[232:235],v[64:67]
s_xor_b32 m0,s72,4096
s_add_u32 s65,s89,0
v_mfma_f32_16x16x32_bf16 v[72:75],a[168:171],v[232:235],v[72:75]
ds_read_b128 v[228:231],v43 offset:49152
v_min3_u32 v27,v27,v232,v236
v_mfma_f32_16x16x32_bf16 v[64:67],a[44:47],v[236:239],v[64:67]
buffer_load_dwordx4 v42,s[20:23],s65 offen offset:0 sc1 lds
v_mfma_f32_16x16x32_bf16 v[72:75],a[172:175],v[236:239],v[72:75]
ds_read_b128 v[232:235],v17 offset:57344
s_waitcnt lgkmcnt(6)
v_mfma_f32_16x16x32_bf16 v[64:67],a[96:99],v[240:243],v[64:67]
buffer_load_dwordx4 v42,s[20:23],s65 offen offset:1024 sc1 lds
v_mfma_f32_16x16x32_bf16 v[72:75],a[224:227],v[240:243],v[72:75]
ds_read_b128 v[236:239],v43 offset:57344
s_xor_b32 m0,s72,20480
v_mfma_f32_16x16x32_bf16 v[64:67],a[100:103],v[244:247],v[64:67]
s_add_u32 s65,s89,256
v_min3_u32 v27,v27,v240,v244
v_mfma_f32_16x16x32_bf16 v[72:75],a[228:231],v[244:247],v[72:75]
ds_read_b128 v[240:243],v17 offset:50176
s_waitcnt lgkmcnt(6)
v_mfma_f32_16x16x32_bf16 v[64:67],a[104:107],v[248:251],v[64:67]
buffer_load_dwordx4 v42,s[20:23],s65 offen offset:0 sc1 lds
v_mfma_f32_16x16x32_bf16 v[72:75],a[232:235],v[248:251],v[72:75]
ds_read_b128 v[244:247],v43 offset:50176
v_min3_u32 v27,v27,v248,v252
v_mfma_f32_16x16x32_bf16 v[64:67],a[108:111],v[252:255],v[64:67]
buffer_load_dwordx4 v42,s[20:23],s65 offen offset:1024 sc1 lds
v_mfma_f32_16x16x32_bf16 v[72:75],a[236:239],v[252:255],v[72:75]
ds_read_b128 v[248:251],v17 offset:58368
s_waitcnt lgkmcnt(5)
v_mfma_f32_16x16x32_bf16 v[64:67],a[48:51],v[224:227],v[64:67]
s_xor_b32 m0,s72,36864
s_add_u32 s65,s89,512
v_mfma_f32_16x16x32_bf16 v[72:75],a[176:179],v[224:227],v[72:75]
ds_read_b128 v[252:255],v43 offset:58368
v_min3_u32 v27,v27,v224,v228
v_mfma_f32_16x16x32_bf16 v[64:67],a[52:55],v[228:231],v[64:67]
buffer_load_dwordx4 v42,s[20:23],s65 offen offset:0 sc1 lds
s_waitcnt vmcnt(13)
v_add_u32 v22,s71,-1
v_mfma_f32_16x16x32_bf16 v[72:75],a[180:183],v[228:231],v[72:75]
s_waitcnt vmcnt(18)
s_barrier
ds_read_b64 v[44:45],v47
ds_read_b128 v[224:227],v17 offset:4096
s_waitcnt lgkmcnt(6)
v_mfma_f32_16x16x32_bf16 v[64:67],a[56:59],v[232:235],v[64:67]
buffer_load_dwordx4 v42,s[20:23],s65 offen offset:1024 sc1 lds
buffer_store_dword v22,v23,s[24:27],s97 offen
v_mfma_f32_16x16x32_bf16 v[72:75],a[184:187],v[232:235],v[72:75]
ds_read_b128 v[228:231],v43 offset:4096
s_xor_b32 m0,s72,53248
buffer_store_dword v22,v23,s[28:31],s97 offen sc1
v_mfma_f32_16x16x32_bf16 v[64:67],a[60:63],v[236:239],v[64:67]
s_add_u32 s65,s89,768
v_min3_u32 v27,v27,v232,v236
s_mov_b32 s97,0x7fff0000
v_mfma_f32_16x16x32_bf16 v[72:75],a[188:191],v[236:239],v[72:75]
ds_read_b128 v[232:235],v17 offset:12288
s_waitcnt lgkmcnt(6)
v_mfma_f32_16x16x32_bf16 v[64:67],a[112:115],v[240:243],v[64:67]
buffer_load_dwordx4 v42,s[20:23],s65 offen offset:0 sc1 lds
v_mfma_f32_16x16x32_bf16 v[72:75],a[240:243],v[240:243],v[72:75]
ds_read_b128 v[236:239],v43 offset:12288
v_min3_u32 v27,v27,v240,v244
v_mfma_f32_16x16x32_bf16 v[64:67],a[116:119],v[244:247],v[64:67]
buffer_load_dwordx4 v42,s[20:23],s65 offen offset:1024 sc1 lds
v_mfma_f32_16x16x32_bf16 v[72:75],a[244:247],v[244:247],v[72:75]
ds_read_b128 v[240:243],v17 offset:5120
s_waitcnt lgkmcnt(6)
v_mfma_f32_16x16x32_bf16 v[64:67],a[120:123],v[248:251],v[64:67]
s_waitcnt lgkmcnt(5)
v_readfirstlane_b32 s93,v45
v_mfma_f32_16x16x32_bf16 v[72:75],a[248:251],v[248:251],v[72:75]
ds_read_b128 v[244:247],v43 offset:5120
v_min3_u32 v27,v27,v248,v252
v_mfma_f32_16x16x32_bf16 v[64:67],a[124:127],v[252:255],v[64:67]
v_mfma_f32_16x16x32_bf16 v[72:75],a[252:255],v[252:255],v[72:75]
ds_read_b128 v[248:251],v17 offset:13312
s_waitcnt lgkmcnt(5)
v_mfma_f32_16x16x32_bf16 v[68:71],a[0:3],v[224:227],0
v_cmp_eq_u32 vcc,0,v27
s_cbranch_vccnz retry_220
v_mfma_f32_16x16x32_bf16 v[76:79],a[128:131],v[224:227],0
ds_read_b128 v[252:255],v43 offset:13312
v_min3_u32 v27,v27,v224,v228
v_mfma_f32_16x16x32_bf16 v[68:71],a[4:7],v[228:231],v[68:71]
v_mfma_f32_16x16x32_bf16 v[76:79],a[132:135],v[228:231],v[76:79]
ds_read_b128 v[224:227],v17 offset:20480
s_waitcnt lgkmcnt(5)
v_mfma_f32_16x16x32_bf16 v[68:71],a[8:11],v[232:235],v[68:71]
v_min3_u32 v27,v27,v232,v236
v_mul_f32 v88,v64,v64
v_mul_f32 v92,v72,v72
v_mfma_f32_16x16x32_bf16 v[76:79],a[136:139],v[232:235],v[76:79]
ds_read_b128 v[228:231],v43 offset:20480
v_mul_f32 v89,v65,v65
v_mul_f32 v93,v73,v73
v_mfma_f32_16x16x32_bf16 v[68:71],a[12:15],v[236:239],v[68:71]
v_mul_f32 v90,v66,v66
v_mul_f32 v91,v67,v67
v_mul_f32 v94,v74,v74
v_mfma_f32_16x16x32_bf16 v[76:79],a[140:143],v[236:239],v[76:79]
ds_read_b128 v[232:235],v17 offset:28672
v_mul_f32 v95,v75,v75
s_waitcnt lgkmcnt(5)
v_mfma_f32_16x16x32_bf16 v[68:71],a[64:67],v[240:243],v[68:71]
v_min3_u32 v27,v27,v240,v244
v_fma_f32 v88,v88,s81,v28
v_fma_f32 v92,v92,s81,v28
v_mfma_f32_16x16x32_bf16 v[76:79],a[192:195],v[240:243],v[76:79]
ds_read_b128 v[236:239],v43 offset:28672
v_fma_f32 v89,v89,s81,v28
v_fma_f32 v93,v93,s81,v28
v_mfma_f32_16x16x32_bf16 v[68:71],a[68:71],v[244:247],v[68:71]
v_fma_f32 v90,v90,s81,v28
v_fma_f32 v91,v91,s81,v28
v_fma_f32 v94,v94,s81,v28
v_mfma_f32_16x16x32_bf16 v[76:79],a[196:199],v[244:247],v[76:79]
ds_read_b128 v[240:243],v17 offset:21504
v_fma_f32 v95,v95,s81,v28
s_waitcnt lgkmcnt(5)
v_mfma_f32_16x16x32_bf16 v[68:71],a[72:75],v[248:251],v[68:71]
v_min3_u32 v27,v27,v248,v252
v_mul_f32 v88,v88,v64
v_mul_f32 v92,v92,v72
v_mfma_f32_16x16x32_bf16 v[76:79],a[200:203],v[248:251],v[76:79]
ds_read_b128 v[244:247],v43 offset:21504
v_mul_f32 v89,v89,v65
v_mul_f32 v93,v93,v73
v_mfma_f32_16x16x32_bf16 v[68:71],a[76:79],v[252:255],v[68:71]
v_mul_f32 v90,v90,v66
v_mul_f32 v91,v91,v67
v_mul_f32 v94,v94,v74
v_mfma_f32_16x16x32_bf16 v[76:79],a[204:207],v[252:255],v[76:79]
ds_read_b128 v[248:251],v17 offset:29696
v_mul_f32 v95,v95,v75
s_waitcnt lgkmcnt(5)
v_mfma_f32_16x16x32_bf16 v[68:71],a[16:19],v[224:227],v[68:71]
v_min3_u32 v27,v27,v224,v228
v_exp_f32 v92,v92
v_mfma_f32_16x16x32_bf16 v[76:79],a[144:147],v[224:227],v[76:79]
ds_read_b128 v[252:255],v43 offset:29696
v_exp_f32 v93,v93
v_mfma_f32_16x16x32_bf16 v[68:71],a[20:23],v[228:231],v[68:71]
v_exp_f32 v88,v88
v_mfma_f32_16x16x32_bf16 v[76:79],a[148:151],v[228:231],v[76:79]
ds_read_b128 v[224:227],v17 offset:36864
s_waitcnt lgkmcnt(5)
v_mfma_f32_16x16x32_bf16 v[68:71],a[24:27],v[232:235],v[68:71]
v_min3_u32 v27,v27,v232,v236
v_exp_f32 v94,v94
v_mfma_f32_16x16x32_bf16 v[76:79],a[152:155],v[232:235],v[76:79]
ds_read_b128 v[228:231],v43 offset:36864
v_exp_f32 v95,v95
v_mfma_f32_16x16x32_bf16 v[68:71],a[28:31],v[236:239],v[68:71]
v_exp_f32 v89,v89
v_add_f32 v92,1.0,v92
v_mfma_f32_16x16x32_bf16 v[76:79],a[156:159],v[236:239],v[76:79]
ds_read_b128 v[232:235],v17 offset:45056
v_add_f32 v93,1.0,v93
s_waitcnt lgkmcnt(5)
v_mfma_f32_16x16x32_bf16 v[68:71],a[80:83],v[240:243],v[68:71]
v_min3_u32 v27,v27,v240,v244
v_add_f32 v94,1.0,v94
v_add_f32 v95,1.0,v95
v_mfma_f32_16x16x32_bf16 v[76:79],a[208:211],v[240:243],v[76:79]
ds_read_b128 v[236:239],v43 offset:45056
v_rcp_f32 v92,v92
v_mfma_f32_16x16x32_bf16 v[68:71],a[84:87],v[244:247],v[68:71]
v_exp_f32 v90,v90
v_mfma_f32_16x16x32_bf16 v[76:79],a[212:215],v[244:247],v[76:79]
ds_read_b128 v[240:243],v17 offset:37888
s_waitcnt lgkmcnt(5)
v_mfma_f32_16x16x32_bf16 v[68:71],a[88:91],v[248:251],v[68:71]
v_min3_u32 v27,v27,v248,v252
v_rcp_f32 v93,v93
v_mfma_f32_16x16x32_bf16 v[76:79],a[216:219],v[248:251],v[76:79]
ds_read_b128 v[244:247],v43 offset:37888
v_rcp_f32 v94,v94
v_mfma_f32_16x16x32_bf16 v[68:71],a[92:95],v[252:255],v[68:71]
v_exp_f32 v91,v91
v_mfma_f32_16x16x32_bf16 v[76:79],a[220:223],v[252:255],v[76:79]
ds_read_b128 v[248:251],v17 offset:46080
s_waitcnt lgkmcnt(5)
v_mfma_f32_16x16x32_bf16 v[68:71],a[32:35],v[224:227],v[68:71]
v_min3_u32 v27,v27,v224,v228
v_add_f32 v88,1.0,v88
v_mfma_f32_16x16x32_bf16 v[76:79],a[160:163],v[224:227],v[76:79]
ds_read_b128 v[252:255],v43 offset:46080
v_add_f32 v89,1.0,v89
v_mfma_f32_16x16x32_bf16 v[68:71],a[36:39],v[228:231],v[68:71]
v_add_f32 v90,1.0,v90
v_add_f32 v91,1.0,v91
v_mfma_f32_16x16x32_bf16 v[76:79],a[164:167],v[228:231],v[76:79]
ds_read_b128 v[224:227],v17 offset:53248
s_waitcnt lgkmcnt(5)
v_mfma_f32_16x16x32_bf16 v[68:71],a[40:43],v[232:235],v[68:71]
v_min3_u32 v27,v27,v232,v236
v_mfma_f32_16x16x32_bf16 v[76:79],a[168:171],v[232:235],v[76:79]
ds_read_b128 v[228:231],v43 offset:53248
v_mfma_f32_16x16x32_bf16 v[68:71],a[44:47],v[236:239],v[68:71]
v_rcp_f32 v88,v88
v_mfma_f32_16x16x32_bf16 v[76:79],a[172:175],v[236:239],v[76:79]
ds_read_b128 v[232:235],v17 offset:61440
s_waitcnt lgkmcnt(5)
v_mfma_f32_16x16x32_bf16 v[68:71],a[96:99],v[240:243],v[68:71]
v_min3_u32 v27,v27,v240,v244
v_mfma_f32_16x16x32_bf16 v[76:79],a[224:227],v[240:243],v[76:79]
ds_read_b128 v[236:239],v43 offset:61440
v_mfma_f32_16x16x32_bf16 v[68:71],a[100:103],v[244:247],v[68:71]
v_rcp_f32 v89,v89
v_mfma_f32_16x16x32_bf16 v[76:79],a[228:231],v[244:247],v[76:79]
ds_read_b128 v[240:243],v17 offset:54272
s_waitcnt lgkmcnt(5)
v_mfma_f32_16x16x32_bf16 v[68:71],a[104:107],v[248:251],v[68:71]
v_min3_u32 v27,v27,v248,v252
v_mfma_f32_16x16x32_bf16 v[76:79],a[232:235],v[248:251],v[76:79]
ds_read_b128 v[244:247],v43 offset:54272
v_mfma_f32_16x16x32_bf16 v[68:71],a[108:111],v[252:255],v[68:71]
v_rcp_f32 v90,v90
v_mfma_f32_16x16x32_bf16 v[76:79],a[236:239],v[252:255],v[76:79]
ds_read_b128 v[248:251],v17 offset:62464
s_waitcnt lgkmcnt(5)
v_mfma_f32_16x16x32_bf16 v[68:71],a[48:51],v[224:227],v[68:71]
v_min3_u32 v27,v27,v224,v228
v_mfma_f32_16x16x32_bf16 v[76:79],a[176:179],v[224:227],v[76:79]
ds_read_b128 v[252:255],v43 offset:62464
v_mfma_f32_16x16x32_bf16 v[68:71],a[52:55],v[228:231],v[68:71]
v_rcp_f32 v91,v91
v_mfma_f32_16x16x32_bf16 v[76:79],a[180:183],v[228:231],v[76:79]
v_mul_f32 v88,v88,v64
s_waitcnt lgkmcnt(4)
v_mfma_f32_16x16x32_bf16 v[68:71],a[56:59],v[232:235],v[68:71]
v_min3_u32 v27,v27,v232,v236
v_mul_f32 v89,v89,v65
v_mfma_f32_16x16x32_bf16 v[76:79],a[184:187],v[232:235],v[76:79]
v_mul_f32 v90,v90,v66
v_mul_f32 v91,v91,v67
v_mfma_f32_16x16x32_bf16 v[68:71],a[60:63],v[236:239],v[68:71]
v_rcp_f32 v95,v95
v_mfma_f32_16x16x32_bf16 v[76:79],a[188:191],v[236:239],v[76:79]
v_mul_f32 v92,v92,v72
s_waitcnt lgkmcnt(2)
v_mfma_f32_16x16x32_bf16 v[68:71],a[112:115],v[240:243],v[68:71]
v_min3_u32 v27,v27,v240,v244
v_mul_f32 v93,v93,v73
v_mfma_f32_16x16x32_bf16 v[76:79],a[240:243],v[240:243],v[76:79]
v_mul_f32 v94,v94,v74
v_mul_f32 v95,v95,v75
v_mfma_f32_16x16x32_bf16 v[68:71],a[116:119],v[244:247],v[68:71]
v_cvt_pk_bf16_f32 v96,v88,v89
v_cvt_pk_bf16_f32 v97,v90,v91
v_mfma_f32_16x16x32_bf16 v[76:79],a[244:247],v[244:247],v[76:79]
v_cvt_pk_bf16_f32 v98,v92,v93
s_waitcnt lgkmcnt(0)
v_mfma_f32_16x16x32_bf16 v[68:71],a[120:123],v[248:251],v[68:71]
v_min3_u32 v27,v27,v248,v252
v_cvt_pk_bf16_f32 v99,v94,v95
v_mfma_f32_16x16x32_bf16 v[76:79],a[248:251],v[248:251],v[76:79]
v_max_u32 v96,1,v96
v_mfma_f32_16x16x32_bf16 v[68:71],a[124:127],v[252:255],v[68:71]
buffer_store_dwordx4 v[96:99],v18,s[20:23],s78 offen sc1
v_mfma_f32_16x16x32_bf16 v[76:79],a[252:255],v[252:255],v[76:79]
v_cmp_eq_u32 vcc,0,v27
s_cbranch_vccnz retry_220
epi_223:
buffer_load_dword v29,v21,s[20:23],s87 offen sc1
s_cmp_gt_u32 s71,51
s_cselect_b32 s65,s73,0x7fff0000
s_cselect_b32 s97,0x7fff0000,s73
v_mov_b32 v22,s71
buffer_store_dword v22,v23,s[24:27],s65 offen
buffer_store_dword v22,v23,s[28:31],s65 offen sc1
v_pk_mul_f32 v[88:89],v[68:69],v[68:69]
v_pk_mul_f32 v[90:91],v[70:71],v[70:71]
v_pk_mul_f32 v[92:93],v[76:77],v[76:77]
v_pk_mul_f32 v[94:95],v[78:79],v[78:79]
v_pk_fma_f32 v[88:89],v[88:89],s[80:81],v[28:29] op_sel:[0,1,0] op_sel_hi:[1,1,0]
v_pk_fma_f32 v[90:91],v[90:91],s[80:81],v[28:29] op_sel:[0,1,0] op_sel_hi:[1,1,0]
v_pk_fma_f32 v[92:93],v[92:93],s[80:81],v[28:29] op_sel:[0,1,0] op_sel_hi:[1,1,0]
v_pk_fma_f32 v[94:95],v[94:95],s[80:81],v[28:29] op_sel:[0,1,0] op_sel_hi:[1,1,0]
v_pk_mul_f32 v[88:89],v[88:89],v[68:69]
v_pk_mul_f32 v[90:91],v[90:91],v[70:71]
v_pk_mul_f32 v[92:93],v[92:93],v[76:77]
v_pk_mul_f32 v[94:95],v[94:95],v[78:79]
v_exp_f32 v88,v88
v_exp_f32 v89,v89
v_exp_f32 v90,v90
v_exp_f32 v91,v91
v_exp_f32 v92,v92
v_exp_f32 v93,v93
v_exp_f32 v94,v94
v_exp_f32 v95,v95
v_pk_add_f32 v[88:89],v[88:89],1.0 op_sel_hi:[1,0]
v_pk_add_f32 v[90:91],v[90:91],1.0 op_sel_hi:[1,0]
v_pk_add_f32 v[92:93],v[92:93],1.0 op_sel_hi:[1,0]
v_pk_add_f32 v[94:95],v[94:95],1.0 op_sel_hi:[1,0]
v_rcp_f32 v88,v88
v_rcp_f32 v89,v89
v_rcp_f32 v90,v90
v_rcp_f32 v91,v91
v_rcp_f32 v92,v92
v_rcp_f32 v93,v93
v_rcp_f32 v94,v94
v_rcp_f32 v95,v95
v_pk_mul_f32 v[88:89],v[88:89],v[68:69]
v_pk_mul_f32 v[90:91],v[90:91],v[70:71]
v_pk_mul_f32 v[92:93],v[92:93],v[76:77]
v_pk_mul_f32 v[94:95],v[94:95],v[78:79]
v_cvt_pk_bf16_f32 v96,v88,v89
v_cvt_pk_bf16_f32 v97,v90,v91
v_cvt_pk_bf16_f32 v98,v92,v93
v_cvt_pk_bf16_f32 v99,v94,v95
v_max_u32 v96,1,v96
buffer_store_dwordx4 v[96:99],v19,s[20:23],s78 offen sc1
v_xor_b32 v18,0x2000,v18
v_xor_b32 v19,0x2000,v19
s_add_u32 s78,s78,2097152
v_xor_b32 v43,0x10000,v43
v_xor_b32 v17,0x10000,v17
s_xor_b32 s72,s72,0x10000
s_add_u32 s70,s70,2097152
s_xor_b32 s70,s70,0x2000
s_add_u32 s71,s71,1
s_cmp_le_u32 s71,64
s_cbranch_scc1 seg_221
s_add_u32 s65,s73,2560
v_add_u32 v22,s71,-1
buffer_store_dword v22,v23,s[20:23],s65 offen sc1
s_endpgm
retry_220:
s_sub_u32 s90,s90,64
s_cmp_lt_i32 s90,0
s_cbranch_scc1 giveup_195
s_mov_b32 s83,1
s_waitcnt vmcnt(0) lgkmcnt(0)
s_barrier
s_branch seg_221
r_w2_215:
s_load_dwordx2 s[4:5],s[0:1],72
s_and_b32 s41,s59,7
s_lshl_b32 s66,s41,8
s_lshl_b32 s67,s50,1
s_waitcnt lgkmcnt(0)
s_mov_b32 s32,s4
s_and_b32 s33,s5,0xffff
s_mov_b32 s34,0x200000
s_mov_b32 s35,0x20000
v_lshrrev_b32 v5,2,v3
v_lshl_add_u32 v5,v4,2,v5
v_and_b32 v6,3,v3
v_lshlrev_b32 v6,3,v6
v_lshl_add_u32 v6,v5,8,v6
v_and_b32 v5,7,v5
v_xor_b32 v5,s67,v5
v_lshl_add_u32 v12,v5,5,v6
v_xor_b32 v13,32,v12
v_and_b32 v5,15,v1
v_and_b32 v6,3,v4
v_lshlrev_b32 v6,1,v6
v_xor_b32 v5,v5,v6
v_mul_u32_u24 v6,2048,v4
v_xor_b32 v7,0,v5
v_lshl_add_u32 v8,v7,4,v6
v_xor_b32 v7,8,v5
v_lshl_add_u32 v9,v7,4,v6
s_mul_i32 s74,s50,131072
s_add_u32 s74,s74,s66
s_lshl_b32 s75,s50,14
s_mul_i32 s76,s50,65536
s_add_u32 s76,s76,s66
s_lshl_b32 s77,s50,13
s_add_u32 s64,s74,0
s_add_u32 m0,s75,0
s_nop 0
buffer_load_dwordx4 v8,s[32:35],s64 offen nt lds
s_add_u32 s64,s74,8192
s_add_u32 m0,s75,1024
s_nop 0
buffer_load_dwordx4 v9,s[32:35],s64 offen nt lds
s_add_u32 s64,s74,16384
s_add_u32 m0,s75,2048
s_nop 0
buffer_load_dwordx4 v8,s[32:35],s64 offen nt lds
s_add_u32 s64,s74,24576
s_add_u32 m0,s75,3072
s_nop 0
buffer_load_dwordx4 v9,s[32:35],s64 offen nt lds
s_add_u32 s64,s74,32768
s_add_u32 m0,s75,4096
s_nop 0
buffer_load_dwordx4 v8,s[32:35],s64 offen nt lds
s_add_u32 s64,s74,40960
s_add_u32 m0,s75,5120
s_nop 0
buffer_load_dwordx4 v9,s[32:35],s64 offen nt lds
s_add_u32 s64,s74,49152
s_add_u32 m0,s75,6144
s_nop 0
buffer_load_dwordx4 v8,s[32:35],s64 offen nt lds
s_add_u32 s64,s74,57344
s_add_u32 m0,s75,7168
s_nop 0
buffer_load_dwordx4 v9,s[32:35],s64 offen nt lds
s_add_u32 s64,s74,65536
s_add_u32 m0,s75,8192
s_nop 0
buffer_load_dwordx4 v8,s[32:35],s64 offen nt lds
s_add_u32 s64,s74,73728
s_add_u32 m0,s75,9216
s_nop 0
buffer_load_dwordx4 v9,s[32:35],s64 offen nt lds
s_add_u32 s64,s74,81920
s_add_u32 m0,s75,10240
s_nop 0
buffer_load_dwordx4 v8,s[32:35],s64 offen nt lds
s_add_u32 s64,s74,90112
s_add_u32 m0,s75,11264
s_nop 0
buffer_load_dwordx4 v9,s[32:35],s64 offen nt lds
s_add_u32 s64,s74,98304
s_add_u32 m0,s75,12288
s_nop 0
buffer_load_dwordx4 v8,s[32:35],s64 offen nt lds
s_add_u32 s64,s74,106496
s_add_u32 m0,s75,13312
s_nop 0
buffer_load_dwordx4 v9,s[32:35],s64 offen nt lds
s_add_u32 s64,s74,114688
s_add_u32 m0,s75,14336
s_nop 0
buffer_load_dwordx4 v8,s[32:35],s64 offen nt lds
s_add_u32 s64,s74,122880
s_add_u32 m0,s75,15360
s_nop 0
buffer_load_dwordx4 v9,s[32:35],s64 offen nt lds
s_add_u32 s64,s74,524288
s_add_u32 m0,s75,65536
s_nop 0
buffer_load_dwordx4 v8,s[32:35],s64 offen nt lds
s_add_u32 s64,s74,532480
s_add_u32 m0,s75,66560
s_nop 0
buffer_load_dwordx4 v9,s[32:35],s64 offen nt lds
s_add_u32 s64,s74,540672
s_add_u32 m0,s75,67584
s_nop 0
buffer_load_dwordx4 v8,s[32:35],s64 offen nt lds
s_add_u32 s64,s74,548864
s_add_u32 m0,s75,68608
s_nop 0
buffer_load_dwordx4 v9,s[32:35],s64 offen nt lds
s_add_u32 s64,s74,557056
s_add_u32 m0,s75,69632
s_nop 0
buffer_load_dwordx4 v8,s[32:35],s64 offen nt lds
s_add_u32 s64,s74,565248
s_add_u32 m0,s75,70656
s_nop 0
buffer_load_dwordx4 v9,s[32:35],s64 offen nt lds
s_add_u32 s64,s74,573440
s_add_u32 m0,s75,71680
s_nop 0
buffer_load_dwordx4 v8,s[32:35],s64 offen nt lds
s_add_u32 s64,s74,581632
s_add_u32 m0,s75,72704
s_nop 0
buffer_load_dwordx4 v9,s[32:35],s64 offen nt lds
s_add_u32 s64,s74,589824
s_add_u32 m0,s75,73728
s_nop 0
buffer_load_dwordx4 v8,s[32:35],s64 offen nt lds
s_add_u32 s64,s74,598016
s_add_u32 m0,s75,74752
s_nop 0
buffer_load_dwordx4 v9,s[32:35],s64 offen nt lds
s_add_u32 s64,s74,606208
s_add_u32 m0,s75,75776
s_nop 0
buffer_load_dwordx4 v8,s[32:35],s64 offen nt lds
s_add_u32 s64,s74,614400
s_add_u32 m0,s75,76800
s_nop 0
buffer_load_dwordx4 v9,s[32:35],s64 offen nt lds
s_add_u32 s64,s74,622592
s_add_u32 m0,s75,77824
s_nop 0
buffer_load_dwordx4 v8,s[32:35],s64 offen nt lds
s_add_u32 s64,s74,630784
s_add_u32 m0,s75,78848
s_nop 0
buffer_load_dwordx4 v9,s[32:35],s64 offen nt lds
s_add_u32 s64,s74,638976
s_add_u32 m0,s75,79872
s_nop 0
buffer_load_dwordx4 v8,s[32:35],s64 offen nt lds
s_add_u32 s64,s74,647168
s_add_u32 m0,s75,80896
s_nop 0
buffer_load_dwordx4 v9,s[32:35],s64 offen nt lds
s_waitcnt vmcnt(16)
s_barrier
ds_read_b64_tr_b16 a[0:1],v12 offset:0
ds_read_b64_tr_b16 a[128:129],v13 offset:0
ds_read_b64_tr_b16 a[2:3],v12 offset:4096
ds_read_b64_tr_b16 a[130:131],v13 offset:4096
ds_read_b64_tr_b16 a[4:5],v12 offset:8192
ds_read_b64_tr_b16 a[132:133],v13 offset:8192
ds_read_b64_tr_b16 a[6:7],v12 offset:12288
ds_read_b64_tr_b16 a[134:135],v13 offset:12288
s_waitcnt lgkmcnt(4)
ds_read_b64_tr_b16 a[8:9],v12 offset:16384
ds_read_b64_tr_b16 a[136:137],v13 offset:16384
ds_read_b64_tr_b16 a[10:11],v12 offset:20480
ds_read_b64_tr_b16 a[138:139],v13 offset:20480
ds_read_b64_tr_b16 a[12:13],v12 offset:24576
ds_read_b64_tr_b16 a[140:141],v13 offset:24576
ds_read_b64_tr_b16 a[14:15],v12 offset:28672
ds_read_b64_tr_b16 a[142:143],v13 offset:28672
s_waitcnt lgkmcnt(4)
ds_read_b64_tr_b16 a[16:17],v12 offset:32768
ds_read_b64_tr_b16 a[144:145],v13 offset:32768
ds_read_b64_tr_b16 a[18:19],v12 offset:36864
ds_read_b64_tr_b16 a[146:147],v13 offset:36864
ds_read_b64_tr_b16 a[20:21],v12 offset:40960
ds_read_b64_tr_b16 a[148:149],v13 offset:40960
ds_read_b64_tr_b16 a[22:23],v12 offset:45056
ds_read_b64_tr_b16 a[150:151],v13 offset:45056
s_waitcnt lgkmcnt(4)
ds_read_b64_tr_b16 a[24:25],v12 offset:49152
ds_read_b64_tr_b16 a[152:153],v13 offset:49152
ds_read_b64_tr_b16 a[26:27],v12 offset:53248
ds_read_b64_tr_b16 a[154:155],v13 offset:53248
ds_read_b64_tr_b16 a[28:29],v12 offset:57344
ds_read_b64_tr_b16 a[156:157],v13 offset:57344
ds_read_b64_tr_b16 a[30:31],v12 offset:61440
ds_read_b64_tr_b16 a[158:159],v13 offset:61440
s_waitcnt lgkmcnt(4)
v_xor_b32 v12,0x10000,v12
v_xor_b32 v13,0x10000,v13
s_waitcnt lgkmcnt(0)
s_barrier
s_add_u32 s64,s74,1048576
s_add_u32 m0,s75,0
s_nop 0
buffer_load_dwordx4 v8,s[32:35],s64 offen nt lds
s_add_u32 s64,s74,1056768
s_add_u32 m0,s75,1024
s_nop 0
buffer_load_dwordx4 v9,s[32:35],s64 offen nt lds
s_add_u32 s64,s74,1064960
s_add_u32 m0,s75,2048
s_nop 0
buffer_load_dwordx4 v8,s[32:35],s64 offen nt lds
s_add_u32 s64,s74,1073152
s_add_u32 m0,s75,3072
s_nop 0
buffer_load_dwordx4 v9,s[32:35],s64 offen nt lds
s_add_u32 s64,s74,1081344
s_add_u32 m0,s75,4096
s_nop 0
buffer_load_dwordx4 v8,s[32:35],s64 offen nt lds
s_add_u32 s64,s74,1089536
s_add_u32 m0,s75,5120
s_nop 0
buffer_load_dwordx4 v9,s[32:35],s64 offen nt lds
s_add_u32 s64,s74,1097728
s_add_u32 m0,s75,6144
s_nop 0
buffer_load_dwordx4 v8,s[32:35],s64 offen nt lds
s_add_u32 s64,s74,1105920
s_add_u32 m0,s75,7168
s_nop 0
buffer_load_dwordx4 v9,s[32:35],s64 offen nt lds
s_add_u32 s64,s74,1114112
s_add_u32 m0,s75,8192
s_nop 0
buffer_load_dwordx4 v8,s[32:35],s64 offen nt lds
s_add_u32 s64,s74,1122304
s_add_u32 m0,s75,9216
s_nop 0
buffer_load_dwordx4 v9,s[32:35],s64 offen nt lds
s_add_u32 s64,s74,1130496
s_add_u32 m0,s75,10240
s_nop 0
buffer_load_dwordx4 v8,s[32:35],s64 offen nt lds
s_add_u32 s64,s74,1138688
s_add_u32 m0,s75,11264
s_nop 0
buffer_load_dwordx4 v9,s[32:35],s64 offen nt lds
s_add_u32 s64,s74,1146880
s_add_u32 m0,s75,12288
s_nop 0
buffer_load_dwordx4 v8,s[32:35],s64 offen nt lds
s_add_u32 s64,s74,1155072
s_add_u32 m0,s75,13312
s_nop 0
buffer_load_dwordx4 v9,s[32:35],s64 offen nt lds
s_add_u32 s64,s74,1163264
s_add_u32 m0,s75,14336
s_nop 0
buffer_load_dwordx4 v8,s[32:35],s64 offen nt lds
s_add_u32 s64,s74,1171456
s_add_u32 m0,s75,15360
s_nop 0
buffer_load_dwordx4 v9,s[32:35],s64 offen nt lds
s_waitcnt vmcnt(16)
s_barrier
ds_read_b64_tr_b16 a[32:33],v12 offset:0
ds_read_b64_tr_b16 a[160:161],v13 offset:0
ds_read_b64_tr_b16 a[34:35],v12 offset:4096
ds_read_b64_tr_b16 a[162:163],v13 offset:4096
ds_read_b64_tr_b16 a[36:37],v12 offset:8192
ds_read_b64_tr_b16 a[164:165],v13 offset:8192
ds_read_b64_tr_b16 a[38:39],v12 offset:12288
ds_read_b64_tr_b16 a[166:167],v13 offset:12288
s_waitcnt lgkmcnt(4)
ds_read_b64_tr_b16 a[40:41],v12 offset:16384
ds_read_b64_tr_b16 a[168:169],v13 offset:16384
ds_read_b64_tr_b16 a[42:43],v12 offset:20480
ds_read_b64_tr_b16 a[170:171],v13 offset:20480
ds_read_b64_tr_b16 a[44:45],v12 offset:24576
ds_read_b64_tr_b16 a[172:173],v13 offset:24576
ds_read_b64_tr_b16 a[46:47],v12 offset:28672
ds_read_b64_tr_b16 a[174:175],v13 offset:28672
s_waitcnt lgkmcnt(4)
ds_read_b64_tr_b16 a[48:49],v12 offset:32768
ds_read_b64_tr_b16 a[176:177],v13 offset:32768
ds_read_b64_tr_b16 a[50:51],v12 offset:36864
ds_read_b64_tr_b16 a[178:179],v13 offset:36864
ds_read_b64_tr_b16 a[52:53],v12 offset:40960
ds_read_b64_tr_b16 a[180:181],v13 offset:40960
ds_read_b64_tr_b16 a[54:55],v12 offset:45056
ds_read_b64_tr_b16 a[182:183],v13 offset:45056
s_waitcnt lgkmcnt(4)
ds_read_b64_tr_b16 a[56:57],v12 offset:49152
ds_read_b64_tr_b16 a[184:185],v13 offset:49152
ds_read_b64_tr_b16 a[58:59],v12 offset:53248
ds_read_b64_tr_b16 a[186:187],v13 offset:53248
ds_read_b64_tr_b16 a[60:61],v12 offset:57344
ds_read_b64_tr_b16 a[188:189],v13 offset:57344
ds_read_b64_tr_b16 a[62:63],v12 offset:61440
ds_read_b64_tr_b16 a[190:191],v13 offset:61440
s_waitcnt lgkmcnt(4)
v_xor_b32 v12,0x10000,v12
v_xor_b32 v13,0x10000,v13
s_waitcnt lgkmcnt(0)
s_barrier
s_add_u32 s64,s74,1572864
s_add_u32 m0,s75,65536
s_nop 0
buffer_load_dwordx4 v8,s[32:35],s64 offen nt lds
s_add_u32 s64,s74,1581056
s_add_u32 m0,s75,66560
s_nop 0
buffer_load_dwordx4 v9,s[32:35],s64 offen nt lds
s_add_u32 s64,s74,1589248
s_add_u32 m0,s75,67584
s_nop 0
buffer_load_dwordx4 v8,s[32:35],s64 offen nt lds
s_add_u32 s64,s74,1597440
s_add_u32 m0,s75,68608
s_nop 0
buffer_load_dwordx4 v9,s[32:35],s64 offen nt lds
s_add_u32 s64,s74,1605632
s_add_u32 m0,s75,69632
s_nop 0
buffer_load_dwordx4 v8,s[32:35],s64 offen nt lds
s_add_u32 s64,s74,1613824
s_add_u32 m0,s75,70656
s_nop 0
buffer_load_dwordx4 v9,s[32:35],s64 offen nt lds
s_add_u32 s64,s74,1622016
s_add_u32 m0,s75,71680
s_nop 0
buffer_load_dwordx4 v8,s[32:35],s64 offen nt lds
s_add_u32 s64,s74,1630208
s_add_u32 m0,s75,72704
s_nop 0
buffer_load_dwordx4 v9,s[32:35],s64 offen nt lds
s_add_u32 s64,s74,1638400
s_add_u32 m0,s75,73728
s_nop 0
buffer_load_dwordx4 v8,s[32:35],s64 offen nt lds
s_add_u32 s64,s74,1646592
s_add_u32 m0,s75,74752
s_nop 0
buffer_load_dwordx4 v9,s[32:35],s64 offen nt lds
s_add_u32 s64,s74,1654784
s_add_u32 m0,s75,75776
s_nop 0
buffer_load_dwordx4 v8,s[32:35],s64 offen nt lds
s_add_u32 s64,s74,1662976
s_add_u32 m0,s75,76800
s_nop 0
buffer_load_dwordx4 v9,s[32:35],s64 offen nt lds
s_add_u32 s64,s74,1671168
s_add_u32 m0,s75,77824
s_nop 0
buffer_load_dwordx4 v8,s[32:35],s64 offen nt lds
s_add_u32 s64,s74,1679360
s_add_u32 m0,s75,78848
s_nop 0
buffer_load_dwordx4 v9,s[32:35],s64 offen nt lds
s_add_u32 s64,s74,1687552
s_add_u32 m0,s75,79872
s_nop 0
buffer_load_dwordx4 v8,s[32:35],s64 offen nt lds
s_add_u32 s64,s74,1695744
s_add_u32 m0,s75,80896
s_nop 0
buffer_load_dwordx4 v9,s[32:35],s64 offen nt lds
s_waitcnt vmcnt(16)
s_barrier
ds_read_b64_tr_b16 a[64:65],v12 offset:0
ds_read_b64_tr_b16 a[192:193],v13 offset:0
ds_read_b64_tr_b16 a[66:67],v12 offset:4096
ds_read_b64_tr_b16 a[194:195],v13 offset:4096
ds_read_b64_tr_b16 a[68:69],v12 offset:8192
ds_read_b64_tr_b16 a[196:197],v13 offset:8192
ds_read_b64_tr_b16 a[70:71],v12 offset:12288
ds_read_b64_tr_b16 a[198:199],v13 offset:12288
s_waitcnt lgkmcnt(4)
ds_read_b64_tr_b16 a[72:73],v12 offset:16384
ds_read_b64_tr_b16 a[200:201],v13 offset:16384
ds_read_b64_tr_b16 a[74:75],v12 offset:20480
ds_read_b64_tr_b16 a[202:203],v13 offset:20480
ds_read_b64_tr_b16 a[76:77],v12 offset:24576
ds_read_b64_tr_b16 a[204:205],v13 offset:24576
ds_read_b64_tr_b16 a[78:79],v12 offset:28672
ds_read_b64_tr_b16 a[206:207],v13 offset:28672
s_waitcnt lgkmcnt(4)
ds_read_b64_tr_b16 a[80:81],v12 offset:32768
ds_read_b64_tr_b16 a[208:209],v13 offset:32768
ds_read_b64_tr_b16 a[82:83],v12 offset:36864
ds_read_b64_tr_b16 a[210:211],v13 offset:36864
ds_read_b64_tr_b16 a[84:85],v12 offset:40960
ds_read_b64_tr_b16 a[212:213],v13 offset:40960
ds_read_b64_tr_b16 a[86:87],v12 offset:45056
ds_read_b64_tr_b16 a[214:215],v13 offset:45056
s_waitcnt lgkmcnt(4)
ds_read_b64_tr_b16 a[88:89],v12 offset:49152
ds_read_b64_tr_b16 a[216:217],v13 offset:49152
ds_read_b64_tr_b16 a[90:91],v12 offset:53248
ds_read_b64_tr_b16 a[218:219],v13 offset:53248
ds_read_b64_tr_b16 a[92:93],v12 offset:57344
ds_read_b64_tr_b16 a[220:221],v13 offset:57344
ds_read_b64_tr_b16 a[94:95],v12 offset:61440
ds_read_b64_tr_b16 a[222:223],v13 offset:61440
s_waitcnt lgkmcnt(4)
v_xor_b32 v12,0x10000,v12
v_xor_b32 v13,0x10000,v13
s_waitcnt lgkmcnt(0)
s_barrier
s_waitcnt vmcnt(0)
s_barrier
ds_read_b64_tr_b16 a[96:97],v12 offset:0
ds_read_b64_tr_b16 a[224:225],v13 offset:0
ds_read_b64_tr_b16 a[98:99],v12 offset:4096
ds_read_b64_tr_b16 a[226:227],v13 offset:4096
ds_read_b64_tr_b16 a[100:101],v12 offset:8192
ds_read_b64_tr_b16 a[228:229],v13 offset:8192
ds_read_b64_tr_b16 a[102:103],v12 offset:12288
ds_read_b64_tr_b16 a[230:231],v13 offset:12288
s_waitcnt lgkmcnt(4)
ds_read_b64_tr_b16 a[104:105],v12 offset:16384
ds_read_b64_tr_b16 a[232:233],v13 offset:16384
ds_read_b64_tr_b16 a[106:107],v12 offset:20480
ds_read_b64_tr_b16 a[234:235],v13 offset:20480
ds_read_b64_tr_b16 a[108:109],v12 offset:24576
ds_read_b64_tr_b16 a[236:237],v13 offset:24576
ds_read_b64_tr_b16 a[110:111],v12 offset:28672
ds_read_b64_tr_b16 a[238:239],v13 offset:28672
s_waitcnt lgkmcnt(4)
ds_read_b64_tr_b16 a[112:113],v12 offset:32768
ds_read_b64_tr_b16 a[240:241],v13 offset:32768
ds_read_b64_tr_b16 a[114:115],v12 offset:36864
ds_read_b64_tr_b16 a[242:243],v13 offset:36864
ds_read_b64_tr_b16 a[116:117],v12 offset:40960
ds_read_b64_tr_b16 a[244:245],v13 offset:40960
ds_read_b64_tr_b16 a[118:119],v12 offset:45056
ds_read_b64_tr_b16 a[246:247],v13 offset:45056
s_waitcnt lgkmcnt(4)
ds_read_b64_tr_b16 a[120:121],v12 offset:49152
ds_read_b64_tr_b16 a[248:249],v13 offset:49152
ds_read_b64_tr_b16 a[122:123],v12 offset:53248
ds_read_b64_tr_b16 a[250:251],v13 offset:53248
ds_read_b64_tr_b16 a[124:125],v12 offset:57344
ds_read_b64_tr_b16 a[252:253],v13 offset:57344
ds_read_b64_tr_b16 a[126:127],v12 offset:61440
ds_read_b64_tr_b16 a[254:255],v13 offset:61440
s_waitcnt lgkmcnt(4)
v_xor_b32 v12,0x10000,v12
v_xor_b32 v13,0x10000,v13
s_waitcnt lgkmcnt(0)
s_barrier
v_and_b32 v21,1,v1
v_mul_u32_u24 v21,960,v21
s_mov_b32 s65,21052032
s_mov_b32 s66,1792
pl_232:
buffer_load_dword v22,v21,s[20:23],s65 offen sc1
s_waitcnt vmcnt(0)
v_cmp_gt_u32 vcc,s66,v22
s_cbranch_vccz pok_233
s_sleep 1
s_sub_u32 s90,s90,1
s_cmp_gt_i32 s90,0
s_cbranch_scc1 pl_232
pok_233:
s_mov_b32 s81,0xbdd2d3e8
v_mov_b32 v28,0xc0135761
v_mov_b32 v17,v16
v_and_b32 v21,31,v1
v_lshlrev_b32 v21,2,v21
s_mul_i32 s74,s79,40
s_add_u32 s74,s74,s63
s_add_u32 s74,s74,3072
s_lshl_b32 s42,s41,2
s_add_u32 s42,s42,s50
s_lshl_b32 s73,s41,7
s_lshl_b32 s64,s50,2
s_add_u32 s73,s73,s64
s_add_u32 s73,s73,s63
s_add_u32 s73,s73,6144
s_add_u32 s73,s73,s60
s_lshl_b32 s43,s50,11
s_lshl_b32 s78,s79,21
s_add_u32 s78,s78,27262976
s_mov_b32 s64,0
s_lshr_b32 s65,s50,1
s_and_b32 s66,s50,1
s_lshl_b32 s66,s66,12
s_add_u32 s66,s66,s64
s_lshl_b32 s72,s65,13
s_add_u32 s72,s72,s66
s_add_u32 s72,s72,0x10000
s_lshl_b32 s65,s65,14
s_add_u32 s75,s65,s66
s_add_u32 s75,s75,1966080
s_add_u32 s64,s41,72
s_lshl_b32 s64,s64,14
s_add_u32 s64,s64,s43
v_add_u32 v18,s64,v16
s_lshl_b32 s64,s42,8
s_add_u32 s64,s64,1310720
v_lshl_add_u32 v24,v3,4,s64
v_mov_b32 v5,0x40000000
v_cmp_gt_u32 vcc,16,v1
s_nop 1
v_cndmask_b32 v24,v5,v24,vcc
s_lshl_b32 s64,s42,6
v_and_b32 v5,3,v1
v_xor_b32 v5,v5,v4
v_lshl_add_u32 v5,v5,4,s64
v_lshrrev_b32 v11,2,v1
s_add_u32 s43,s43,133120
v_lshrrev_b32 v6,2,v3
v_lshrrev_b32 v7,1,v4
v_xor_b32 v6,v6,v7
v_lshlrev_b32 v6,4,v6
v_lshl_add_u32 v6,v3,6,v6
v_and_b32 v7,1,v4
v_lshl_add_u32 v6,v7,3,v6
v_add_u32 v40,s43,v6
v_xor_b32 v41,32,v40
v_add_u32 v6,30,v11
v_lshl_add_u32 v9,v6,7,v5
v_and_b32 v9,2047,v9
v_and_b32 v7,3,v6
v_lshl_add_u32 v7,v7,11,v9
v_bfe_u32 v8,v6,2,3
v_lshl_add_u32 v7,v8,14,v7
v_mov_b32 v8,0x2000
v_mov_b32 v9,2097152
v_cmp_gt_u32 vcc,32,v6
s_nop 1
v_cndmask_b32 v8,v9,v8,vcc
v_add_u32 v7,v7,v8
v_add_u32 v7,0,v7
v_xor_b32 v19,s62,v7
v_add_u32 v6,46,v11
v_lshl_add_u32 v9,v6,7,v5
v_and_b32 v9,2047,v9
v_and_b32 v7,3,v6
v_lshl_add_u32 v7,v7,11,v9
v_bfe_u32 v8,v6,2,3
v_lshl_add_u32 v7,v8,14,v7
v_mov_b32 v8,0x2000
v_mov_b32 v9,2097152
v_cmp_gt_u32 vcc,32,v6
s_nop 1
v_cndmask_b32 v8,v9,v8,vcc
v_add_u32 v7,v7,v8
v_add_u32 v7,0,v7
v_xor_b32 v20,s62,v7
s_add_u32 s64,s79,0
s_lshl_b32 s70,s64,21
s_lshl_b32 s64,s64,13
s_and_b32 s64,s64,0x2000
s_xor_b32 s64,s64,s62
s_add_u32 s70,s70,s64
s_add_u32 s70,s70,29360128
s_mov_b32 s83,1
s_mov_b32 s87,s74
s_cmp_eq_u32 s50,0
s_cselect_b32 s74,s74,0x7fff0000
v_mov_b32 v47,132096
s_lshl_b32 s64,s50,3
s_add_u32 s64,s64,132096
v_mov_b32 v46,s64
v_mov_b32 v29,0
s_mov_b32 s97,0x7fff0000
seg_235:
s_cmp_eq_u32 s83,0
s_cbranch_scc1 ahead_236
s_add_u32 s94,s70,s75
s_xor_b32 s95,s94,1024
s_xor_b32 s91,s72,0x10000
s_min_u32 s66,s71,64
s_waitcnt vmcnt(3)
v_cmp_gt_u32 vcc,s66,v29
s_cbranch_vccz nb_239
s_waitcnt vmcnt(0)
v_add_u32 v22,s71,-1
buffer_store_dword v22,v23,s[20:23],s97 offen sc1
s_mov_b32 s97,0x7fff0000
s_cmp_lg_u32 s50,0
s_cbranch_scc1 nb_239
buffer_load_dword v32,v21,s[20:23],s74 offen sc1
s_sleep 2
pl_240:
buffer_load_dword v33,v21,s[20:23],s74 offen sc1
s_waitcnt vmcnt(1)
v_cmp_gt_u32 vcc,s66,v32
v_mov_b32 v29,v32
s_cbranch_vccz pok_241
buffer_load_dword v32,v21,s[20:23],s74 offen sc1
s_waitcnt vmcnt(1)
v_cmp_gt_u32 vcc,s66,v33
v_mov_b32 v29,v33
s_cbranch_vccz pok_241
s_sub_u32 s90,s90,1
s_cmp_gt_i32 s90,0
s_cbranch_scc1 pl_240
pok_241:
nb_239:
s_barrier
s_xor_b32 m0,s91,0
s_add_u32 s65,s94,0
buffer_load_dwordx4 v16,s[20:23],s65 offen offset:0 sc1 lds
buffer_load_dwordx4 v16,s[20:23],s65 offen offset:2048 sc1 lds
s_xor_b32 m0,s91,16384
s_add_u32 s65,s94,32768
buffer_load_dwordx4 v16,s[20:23],s65 offen offset:0 sc1 lds
buffer_load_dwordx4 v16,s[20:23],s65 offen offset:2048 sc1 lds
s_xor_b32 m0,s91,32768
s_add_u32 s65,s94,65536
buffer_load_dwordx4 v16,s[20:23],s65 offen offset:0 sc1 lds
buffer_load_dwordx4 v16,s[20:23],s65 offen offset:2048 sc1 lds
s_xor_b32 m0,s91,49152
s_add_u32 s65,s94,98304
buffer_load_dwordx4 v16,s[20:23],s65 offen offset:0 sc1 lds
buffer_load_dwordx4 v16,s[20:23],s65 offen offset:2048 sc1 lds
s_waitcnt vmcnt(8)
v_add_u32 v22,s71,-1
buffer_store_dword v22,v23,s[20:23],s97 offen sc1
s_mov_b32 s97,0x7fff0000
s_waitcnt vmcnt(7)
s_barrier
ds_read_b128 v[224:227],v17 offset:0
ds_read_b128 v[228:231],v17 offset:2048
ds_read_b128 v[232:235],v17 offset:4096
ds_read_b128 v[236:239],v17 offset:6144
ds_read_b128 v[240:243],v17 offset:8192
ds_read_b128 v[244:247],v17 offset:10240
ds_read_b128 v[248:251],v17 offset:12288
s_waitcnt lgkmcnt(5)
v_mfma_f32_16x16x32_bf16 v[64:67],a[0:3],v[224:227],0
s_xor_b32 m0,s91,1024
s_add_u32 s96,s71,1
s_add_u32 s92,s71,2
v_mfma_f32_16x16x32_bf16 v[72:75],a[128:131],v[224:227],0
ds_read_b128 v[252:255],v17 offset:14336
s_cmp_eq_u32 s96,65
s_cselect_b32 s96,64,s96
v_mfma_f32_16x16x32_bf16 v[64:67],a[4:7],v[228:231],v[64:67]
s_add_u32 s65,s95,0
v_min_u32 v27,v224,v228
v_mfma_f32_16x16x32_bf16 v[72:75],a[132:135],v[228:231],v[72:75]
s_waitcnt vmcnt(5)
s_barrier
ds_read_b128 v[224:227],v17 offset:16384
s_waitcnt lgkmcnt(5)
v_mfma_f32_16x16x32_bf16 v[64:67],a[8:11],v[232:235],v[64:67]
buffer_load_dwordx4 v16,s[20:23],s65 offen offset:0 sc1 lds
v_mfma_f32_16x16x32_bf16 v[72:75],a[136:139],v[232:235],v[72:75]
ds_read_b128 v[228:231],v17 offset:18432
v_min3_u32 v27,v27,v232,v236
v_mfma_f32_16x16x32_bf16 v[64:67],a[12:15],v[236:239],v[64:67]
buffer_load_dwordx4 v16,s[20:23],s65 offen offset:2048 sc1 lds
v_mfma_f32_16x16x32_bf16 v[72:75],a[140:143],v[236:239],v[72:75]
ds_read_b128 v[232:235],v17 offset:20480
s_waitcnt lgkmcnt(5)
v_mfma_f32_16x16x32_bf16 v[64:67],a[16:19],v[240:243],v[64:67]
s_xor_b32 m0,s91,17408
v_min3_u32 v27,v27,v240,v244
v_mfma_f32_16x16x32_bf16 v[72:75],a[144:147],v[240:243],v[72:75]
ds_read_b128 v[236:239],v17 offset:22528
v_mfma_f32_16x16x32_bf16 v[64:67],a[20:23],v[244:247],v[64:67]
s_add_u32 s65,s95,32768
v_mfma_f32_16x16x32_bf16 v[72:75],a[148:151],v[244:247],v[72:75]
ds_read_b128 v[240:243],v17 offset:24576
s_waitcnt lgkmcnt(5)
v_mfma_f32_16x16x32_bf16 v[64:67],a[24:27],v[248:251],v[64:67]
buffer_load_dwordx4 v16,s[20:23],s65 offen offset:0 sc1 lds
v_mfma_f32_16x16x32_bf16 v[72:75],a[152:155],v[248:251],v[72:75]
ds_read_b128 v[244:247],v17 offset:26624
v_min3_u32 v27,v27,v248,v252
v_mfma_f32_16x16x32_bf16 v[64:67],a[28:31],v[252:255],v[64:67]
buffer_load_dwordx4 v16,s[20:23],s65 offen offset:2048 sc1 lds
v_mfma_f32_16x16x32_bf16 v[72:75],a[156:159],v[252:255],v[72:75]
ds_read_b128 v[248:251],v17 offset:28672
s_waitcnt lgkmcnt(5)
v_mfma_f32_16x16x32_bf16 v[64:67],a[32:35],v[224:227],v[64:67]
s_xor_b32 m0,s91,33792
v_min3_u32 v27,v27,v224,v228
v_mfma_f32_16x16x32_bf16 v[72:75],a[160:163],v[224:227],v[72:75]
ds_read_b128 v[252:255],v17 offset:30720
v_mfma_f32_16x16x32_bf16 v[64:67],a[36:39],v[228:231],v[64:67]
s_add_u32 s65,s95,65536
v_mfma_f32_16x16x32_bf16 v[72:75],a[164:167],v[228:231],v[72:75]
s_waitcnt vmcnt(5)
s_barrier
ds_read_b128 v[224:227],v17 offset:32768
s_waitcnt lgkmcnt(5)
v_mfma_f32_16x16x32_bf16 v[64:67],a[40:43],v[232:235],v[64:67]
buffer_load_dwordx4 v16,s[20:23],s65 offen offset:0 sc1 lds
v_mfma_f32_16x16x32_bf16 v[72:75],a[168:171],v[232:235],v[72:75]
ds_read_b128 v[228:231],v17 offset:34816
v_min3_u32 v27,v27,v232,v236
v_mfma_f32_16x16x32_bf16 v[64:67],a[44:47],v[236:239],v[64:67]
buffer_load_dwordx4 v16,s[20:23],s65 offen offset:2048 sc1 lds
v_mfma_f32_16x16x32_bf16 v[72:75],a[172:175],v[236:239],v[72:75]
ds_read_b128 v[232:235],v17 offset:36864
s_waitcnt lgkmcnt(5)
v_mfma_f32_16x16x32_bf16 v[64:67],a[48:51],v[240:243],v[64:67]
s_xor_b32 m0,s91,50176
v_min3_u32 v27,v27,v240,v244
v_mfma_f32_16x16x32_bf16 v[72:75],a[176:179],v[240:243],v[72:75]
ds_read_b128 v[236:239],v17 offset:38912
v_mfma_f32_16x16x32_bf16 v[64:67],a[52:55],v[244:247],v[64:67]
s_add_u32 s65,s95,98304
v_mfma_f32_16x16x32_bf16 v[72:75],a[180:183],v[244:247],v[72:75]
ds_read_b128 v[240:243],v17 offset:40960
s_waitcnt lgkmcnt(5)
v_mfma_f32_16x16x32_bf16 v[64:67],a[56:59],v[248:251],v[64:67]
buffer_load_dwordx4 v16,s[20:23],s65 offen offset:0 sc1 lds
v_min3_u32 v27,v27,v248,v252
v_mfma_f32_16x16x32_bf16 v[72:75],a[184:187],v[248:251],v[72:75]
ds_read_b128 v[244:247],v17 offset:43008
s_waitcnt vmcnt(63)
v_mfma_f32_16x16x32_bf16 v[64:67],a[60:63],v[252:255],v[64:67]
buffer_load_dwordx4 v16,s[20:23],s65 offen offset:2048 sc1 lds
v_mfma_f32_16x16x32_bf16 v[72:75],a[188:191],v[252:255],v[72:75]
ds_read_b128 v[248:251],v17 offset:45056
s_waitcnt lgkmcnt(5)
v_mfma_f32_16x16x32_bf16 v[64:67],a[64:67],v[224:227],v[64:67]
v_cmp_gt_u32 vcc,s96,v29
v_cmp_gt_u32 s[92:93],s92,v29
v_mfma_f32_16x16x32_bf16 v[72:75],a[192:195],v[224:227],v[72:75]
ds_read_b128 v[252:255],v17 offset:47104
v_min3_u32 v27,v27,v224,v228
v_mfma_f32_16x16x32_bf16 v[64:67],a[68:71],v[228:231],v[64:67]
v_mov_b32 v44,vcc_lo
v_mov_b32 v45,s92
s_add_u32 m0,s43,0
v_mfma_f32_16x16x32_bf16 v[72:75],a[196:199],v[228:231],v[72:75]
ds_read_b128 v[224:227],v17 offset:49152
s_waitcnt lgkmcnt(5)
v_mfma_f32_16x16x32_bf16 v[64:67],a[72:75],v[232:235],v[64:67]
ds_write_b64 v46,v[44:45]
v_min3_u32 v27,v27,v232,v236
v_mfma_f32_16x16x32_bf16 v[72:75],a[200:203],v[232:235],v[72:75]
ds_read_b128 v[228:231],v17 offset:51200
buffer_load_dwordx4 v19,s[20:23],s78 offen sc1 lds
v_mfma_f32_16x16x32_bf16 v[64:67],a[76:79],v[236:239],v[64:67]
s_add_u32 m0,s43,1024
s_nop 0
buffer_load_dwordx4 v20,s[20:23],s78 offen sc1 lds
v_mfma_f32_16x16x32_bf16 v[72:75],a[204:207],v[236:239],v[72:75]
ds_read_b128 v[232:235],v17 offset:53248
s_waitcnt lgkmcnt(6)
v_mfma_f32_16x16x32_bf16 v[64:67],a[80:83],v[240:243],v[64:67]
v_min3_u32 v27,v27,v240,v244
s_add_u32 s88,s70,s75
v_mfma_f32_16x16x32_bf16 v[72:75],a[208:211],v[240:243],v[72:75]
ds_read_b128 v[236:239],v17 offset:55296
s_add_u32 s88,s88,2097152
v_mfma_f32_16x16x32_bf16 v[64:67],a[84:87],v[244:247],v[64:67]
s_xor_b32 s88,s88,0x2000
s_xor_b32 s89,s88,1024
v_mfma_f32_16x16x32_bf16 v[72:75],a[212:215],v[244:247],v[72:75]
ds_read_b128 v[240:243],v17 offset:57344
s_waitcnt lgkmcnt(6)
v_mfma_f32_16x16x32_bf16 v[64:67],a[88:91],v[248:251],v[64:67]
v_min3_u32 v27,v27,v248,v252
v_mfma_f32_16x16x32_bf16 v[72:75],a[216:219],v[248:251],v[72:75]
ds_read_b128 v[244:247],v17 offset:59392
v_mfma_f32_16x16x32_bf16 v[64:67],a[92:95],v[252:255],v[64:67]
v_mfma_f32_16x16x32_bf16 v[72:75],a[220:223],v[252:255],v[72:75]
ds_read_b128 v[248:251],v17 offset:61440
s_waitcnt lgkmcnt(5)
v_mfma_f32_16x16x32_bf16 v[64:67],a[96:99],v[224:227],v[64:67]
v_min3_u32 v27,v27,v224,v228
v_mfma_f32_16x16x32_bf16 v[72:75],a[224:227],v[224:227],v[72:75]
ds_read_b128 v[252:255],v17 offset:63488
v_mfma_f32_16x16x32_bf16 v[64:67],a[100:103],v[228:231],v[64:67]
v_mfma_f32_16x16x32_bf16 v[72:75],a[228:231],v[228:231],v[72:75]
s_waitcnt vmcnt(6)
s_barrier
ds_read_b64 v[44:45],v47
ds_read_b128 v[224:227],v17 offset:1024
s_waitcnt lgkmcnt(6)
v_mfma_f32_16x16x32_bf16 v[64:67],a[104:107],v[232:235],v[64:67]
v_min3_u32 v27,v27,v232,v236
v_mfma_f32_16x16x32_bf16 v[72:75],a[232:235],v[232:235],v[72:75]
ds_read_b128 v[228:231],v17 offset:3072
v_mfma_f32_16x16x32_bf16 v[64:67],a[108:111],v[236:239],v[64:67]
s_waitcnt vmcnt(0)
ds_read_b64 v[120:121],v40 offset:0
v_mfma_f32_16x16x32_bf16 v[72:75],a[236:239],v[236:239],v[72:75]
ds_read_b128 v[232:235],v17 offset:5120
s_waitcnt lgkmcnt(7)
v_mfma_f32_16x16x32_bf16 v[64:67],a[112:115],v[240:243],v[64:67]
v_min3_u32 v27,v27,v240,v244
ds_read_b64 v[122:123],v41 offset:0
v_mfma_f32_16x16x32_bf16 v[72:75],a[240:243],v[240:243],v[72:75]
ds_read_b128 v[236:239],v17 offset:7168
ds_read_b64 v[124:125],v40 offset:1024
v_mfma_f32_16x16x32_bf16 v[64:67],a[116:119],v[244:247],v[64:67]
ds_read_b64 v[126:127],v41 offset:1024
v_mfma_f32_16x16x32_bf16 v[72:75],a[244:247],v[244:247],v[72:75]
ds_read_b128 v[240:243],v17 offset:9216
s_waitcnt lgkmcnt(10)
v_mfma_f32_16x16x32_bf16 v[64:67],a[120:123],v[248:251],v[64:67]
s_waitcnt lgkmcnt(9)
v_readfirstlane_b32 s93,v45
v_mfma_f32_16x16x32_bf16 v[72:75],a[248:251],v[248:251],v[72:75]
ds_read_b128 v[244:247],v17 offset:11264
v_readfirstlane_b32 s83,v44
s_cmp_lg_u32 s83,0
s_cbranch_scc0 keep_242
v_mfma_f32_16x16x32_bf16 v[64:67],a[124:127],v[252:255],v[64:67]
v_min3_u32 v27,v27,v248,v252
v_mfma_f32_16x16x32_bf16 v[72:75],a[252:255],v[252:255],v[72:75]
ds_read_b128 v[248:251],v17 offset:13312
s_waitcnt lgkmcnt(9)
v_mfma_f32_16x16x32_bf16 v[68:71],a[0:3],v[224:227],0
v_cmp_eq_u32 vcc,0,v27
s_cbranch_vccnz retry_234
v_mfma_f32_16x16x32_bf16 v[76:79],a[128:131],v[224:227],0
ds_read_b128 v[252:255],v17 offset:15360
v_min3_u32 v27,v27,v224,v228
v_mfma_f32_16x16x32_bf16 v[68:71],a[4:7],v[228:231],v[68:71]
v_mfma_f32_16x16x32_bf16 v[76:79],a[132:135],v[228:231],v[76:79]
ds_read_b128 v[224:227],v17 offset:17408
s_waitcnt lgkmcnt(7)
v_mfma_f32_16x16x32_bf16 v[68:71],a[8:11],v[232:235],v[68:71]
v_min3_u32 v27,v27,v232,v236
s_waitcnt lgkmcnt(5)
v_mfma_f32_16x16x32_bf16 v[76:79],a[136:139],v[232:235],v[76:79]
ds_read_b128 v[228:231],v17 offset:19456
v_lshlrev_b32 v88,16,v120
v_mfma_f32_16x16x32_bf16 v[68:71],a[12:15],v[236:239],v[68:71]
v_and_b32 v89,s80,v120
v_lshlrev_b32 v90,16,v121
v_mfma_f32_16x16x32_bf16 v[76:79],a[140:143],v[236:239],v[76:79]
ds_read_b128 v[232:235],v17 offset:21504
s_waitcnt lgkmcnt(5)
v_mfma_f32_16x16x32_bf16 v[68:71],a[16:19],v[240:243],v[68:71]
v_min3_u32 v27,v27,v240,v244
v_and_b32 v91,s80,v121
v_mfma_f32_16x16x32_bf16 v[76:79],a[144:147],v[240:243],v[76:79]
ds_read_b128 v[236:239],v17 offset:23552
v_lshlrev_b32 v92,16,v122
v_mfma_f32_16x16x32_bf16 v[68:71],a[20:23],v[244:247],v[68:71]
v_and_b32 v93,s80,v122
v_lshlrev_b32 v94,16,v123
v_mfma_f32_16x16x32_bf16 v[76:79],a[148:151],v[244:247],v[76:79]
ds_read_b128 v[240:243],v17 offset:25600
s_waitcnt lgkmcnt(5)
v_mfma_f32_16x16x32_bf16 v[68:71],a[24:27],v[248:251],v[68:71]
v_min3_u32 v27,v27,v248,v252
v_and_b32 v95,s80,v123
v_mfma_f32_16x16x32_bf16 v[76:79],a[152:155],v[248:251],v[76:79]
ds_read_b128 v[244:247],v17 offset:27648
v_add_f32 v88,v64,v88
v_mfma_f32_16x16x32_bf16 v[68:71],a[28:31],v[252:255],v[68:71]
v_add_f32 v89,v65,v89
v_add_f32 v90,v66,v90
v_mfma_f32_16x16x32_bf16 v[76:79],a[156:159],v[252:255],v[76:79]
ds_read_b128 v[248:251],v17 offset:29696
s_waitcnt lgkmcnt(5)
v_mfma_f32_16x16x32_bf16 v[68:71],a[32:35],v[224:227],v[68:71]
v_min3_u32 v27,v27,v224,v228
v_add_f32 v91,v67,v91
v_mfma_f32_16x16x32_bf16 v[76:79],a[160:163],v[224:227],v[76:79]
ds_read_b128 v[252:255],v17 offset:31744
v_add_f32 v92,v72,v92
v_mfma_f32_16x16x32_bf16 v[68:71],a[36:39],v[228:231],v[68:71]
v_add_f32 v93,v73,v93
v_add_f32 v94,v74,v94
v_mfma_f32_16x16x32_bf16 v[76:79],a[164:167],v[228:231],v[76:79]
s_waitcnt vmcnt(2)
s_barrier
ds_read_b128 v[224:227],v17 offset:33792
s_waitcnt lgkmcnt(5)
v_mfma_f32_16x16x32_bf16 v[68:71],a[40:43],v[232:235],v[68:71]
v_min3_u32 v27,v27,v232,v236
v_add_f32 v95,v75,v95
v_mfma_f32_16x16x32_bf16 v[76:79],a[168:171],v[232:235],v[76:79]
ds_read_b128 v[228:231],v17 offset:35840
v_cvt_pk_bf16_f32 v96,v88,v89
v_mfma_f32_16x16x32_bf16 v[68:71],a[44:47],v[236:239],v[68:71]
v_cvt_pk_bf16_f32 v97,v90,v91
v_cvt_pk_bf16_f32 v98,v92,v93
v_mfma_f32_16x16x32_bf16 v[76:79],a[172:175],v[236:239],v[76:79]
ds_read_b128 v[232:235],v17 offset:37888
s_waitcnt lgkmcnt(5)
v_mfma_f32_16x16x32_bf16 v[68:71],a[48:51],v[240:243],v[68:71]
v_min3_u32 v27,v27,v240,v244
v_cvt_pk_bf16_f32 v99,v94,v95
v_mfma_f32_16x16x32_bf16 v[76:79],a[176:179],v[240:243],v[76:79]
ds_read_b128 v[236:239],v17 offset:39936
v_max_u32 v96,1,v96
v_mfma_f32_16x16x32_bf16 v[68:71],a[52:55],v[244:247],v[68:71]
buffer_store_dwordx4 v[96:99],v18,s[20:23],s70 offen offset:0 sc1
v_mfma_f32_16x16x32_bf16 v[76:79],a[180:183],v[244:247],v[76:79]
ds_read_b128 v[240:243],v17 offset:41984
s_waitcnt lgkmcnt(5)
v_mfma_f32_16x16x32_bf16 v[68:71],a[56:59],v[248:251],v[68:71]
v_min3_u32 v27,v27,v248,v252
v_lshlrev_b32 v88,16,v96
v_mfma_f32_16x16x32_bf16 v[76:79],a[184:187],v[248:251],v[76:79]
ds_read_b128 v[244:247],v17 offset:44032
v_and_b32 v89,s80,v96
v_mfma_f32_16x16x32_bf16 v[68:71],a[60:63],v[252:255],v[68:71]
v_lshlrev_b32 v90,16,v97
v_and_b32 v91,s80,v97
v_mfma_f32_16x16x32_bf16 v[76:79],a[188:191],v[252:255],v[76:79]
ds_read_b128 v[248:251],v17 offset:46080
s_waitcnt lgkmcnt(5)
v_mfma_f32_16x16x32_bf16 v[68:71],a[64:67],v[224:227],v[68:71]
v_min3_u32 v27,v27,v224,v228
v_lshlrev_b32 v92,16,v98
v_mfma_f32_16x16x32_bf16 v[76:79],a[192:195],v[224:227],v[76:79]
ds_read_b128 v[252:255],v17 offset:48128
v_and_b32 v93,s80,v98
v_mfma_f32_16x16x32_bf16 v[68:71],a[68:71],v[228:231],v[68:71]
v_lshlrev_b32 v94,16,v99
v_and_b32 v95,s80,v99
v_mfma_f32_16x16x32_bf16 v[76:79],a[196:199],v[228:231],v[76:79]
ds_read_b128 v[224:227],v17 offset:50176
s_waitcnt lgkmcnt(5)
v_mfma_f32_16x16x32_bf16 v[68:71],a[72:75],v[232:235],v[68:71]
v_min3_u32 v27,v27,v232,v236
v_add_f32 v108,v88,v89
v_mfma_f32_16x16x32_bf16 v[76:79],a[200:203],v[232:235],v[76:79]
ds_read_b128 v[228:231],v17 offset:52224
v_mul_f32 v109,v88,v88
v_mfma_f32_16x16x32_bf16 v[68:71],a[76:79],v[236:239],v[68:71]
v_add_f32 v100,v90,v91
v_mul_f32 v101,v89,v89
v_mfma_f32_16x16x32_bf16 v[76:79],a[204:207],v[236:239],v[76:79]
ds_read_b128 v[232:235],v17 offset:54272
s_waitcnt lgkmcnt(5)
v_mfma_f32_16x16x32_bf16 v[68:71],a[80:83],v[240:243],v[68:71]
v_min3_u32 v27,v27,v240,v244
v_fmac_f32 v109,v90,v90
v_mfma_f32_16x16x32_bf16 v[76:79],a[208:211],v[240:243],v[76:79]
ds_read_b128 v[236:239],v17 offset:56320
v_fmac_f32 v101,v91,v91
v_mfma_f32_16x16x32_bf16 v[68:71],a[84:87],v[244:247],v[68:71]
v_fmac_f32 v109,v92,v92
v_fmac_f32 v101,v93,v93
v_mfma_f32_16x16x32_bf16 v[76:79],a[212:215],v[244:247],v[76:79]
ds_read_b128 v[240:243],v17 offset:58368
s_waitcnt lgkmcnt(5)
v_mfma_f32_16x16x32_bf16 v[68:71],a[88:91],v[248:251],v[68:71]
v_min3_u32 v27,v27,v248,v252
v_add_f32 v108,v108,v92
v_mfma_f32_16x16x32_bf16 v[76:79],a[216:219],v[248:251],v[76:79]
ds_read_b128 v[244:247],v17 offset:60416
v_add_f32 v100,v100,v93
v_mfma_f32_16x16x32_bf16 v[68:71],a[92:95],v[252:255],v[68:71]
v_fmac_f32 v109,v94,v94
v_fmac_f32 v101,v95,v95
v_mfma_f32_16x16x32_bf16 v[76:79],a[220:223],v[252:255],v[76:79]
ds_read_b128 v[248:251],v17 offset:62464
s_waitcnt lgkmcnt(5)
v_mfma_f32_16x16x32_bf16 v[68:71],a[96:99],v[224:227],v[68:71]
v_min3_u32 v27,v27,v224,v228
v_add_f32 v108,v108,v94
v_mfma_f32_16x16x32_bf16 v[76:79],a[224:227],v[224:227],v[76:79]
ds_read_b128 v[252:255],v17 offset:64512
v_add_f32 v100,v100,v95
v_mfma_f32_16x16x32_bf16 v[68:71],a[100:103],v[228:231],v[68:71]
v_add_f32 v108,v108,v100
v_add_f32 v109,v109,v101
v_mfma_f32_16x16x32_bf16 v[76:79],a[228:231],v[228:231],v[76:79]
v_mov_b32 v100,v108
s_waitcnt lgkmcnt(4)
v_mfma_f32_16x16x32_bf16 v[68:71],a[104:107],v[232:235],v[68:71]
v_min3_u32 v27,v27,v232,v236
v_mov_b32 v101,v109
v_mfma_f32_16x16x32_bf16 v[76:79],a[232:235],v[232:235],v[76:79]
v_permlane16_swap_b32 v100,v108
v_permlane16_swap_b32 v101,v109
v_mfma_f32_16x16x32_bf16 v[68:71],a[108:111],v[236:239],v[68:71]
v_add_f32 v108,v108,v100
v_add_f32 v109,v109,v101
v_mfma_f32_16x16x32_bf16 v[76:79],a[236:239],v[236:239],v[76:79]
v_mov_b32 v100,v108
s_waitcnt lgkmcnt(2)
v_mfma_f32_16x16x32_bf16 v[68:71],a[112:115],v[240:243],v[68:71]
v_min3_u32 v27,v27,v240,v244
v_mov_b32 v101,v109
v_mfma_f32_16x16x32_bf16 v[76:79],a[240:243],v[240:243],v[76:79]
v_permlane32_swap_b32 v100,v108
v_permlane32_swap_b32 v101,v109
v_mfma_f32_16x16x32_bf16 v[68:71],a[116:119],v[244:247],v[68:71]
v_add_f32 v108,v108,v100
v_add_f32 v109,v109,v101
v_mfma_f32_16x16x32_bf16 v[76:79],a[244:247],v[244:247],v[76:79]
v_lshlrev_b32 v32,16,v124
s_waitcnt lgkmcnt(0)
v_mfma_f32_16x16x32_bf16 v[68:71],a[120:123],v[248:251],v[68:71]
v_min3_u32 v27,v27,v248,v252
v_and_b32 v33,s80,v124
v_mfma_f32_16x16x32_bf16 v[76:79],a[248:251],v[248:251],v[76:79]
v_lshlrev_b32 v34,16,v125
v_and_b32 v35,s80,v125
v_mfma_f32_16x16x32_bf16 v[68:71],a[124:127],v[252:255],v[68:71]
v_lshlrev_b32 v36,16,v126
v_and_b32 v37,s80,v126
v_mfma_f32_16x16x32_bf16 v[76:79],a[252:255],v[252:255],v[76:79]
v_lshlrev_b32 v38,16,v127
v_and_b32 v39,s80,v127
v_cmp_eq_u32 vcc,0,v27
s_cbranch_vccnz retry_234
s_branch epi_237
keep_242:
v_mfma_f32_16x16x32_bf16 v[64:67],a[124:127],v[252:255],v[64:67]
v_min3_u32 v27,v27,v248,v252
s_xor_b32 m0,s72,0
v_mfma_f32_16x16x32_bf16 v[72:75],a[252:255],v[252:255],v[72:75]
ds_read_b128 v[248:251],v17 offset:13312
s_waitcnt lgkmcnt(9)
v_mfma_f32_16x16x32_bf16 v[68:71],a[0:3],v[224:227],0
s_add_u32 s65,s88,0
v_cmp_eq_u32 vcc,0,v27
s_cbranch_vccnz retry_234
v_mfma_f32_16x16x32_bf16 v[76:79],a[128:131],v[224:227],0
ds_read_b128 v[252:255],v17 offset:15360
v_min3_u32 v27,v27,v224,v228
v_mfma_f32_16x16x32_bf16 v[68:71],a[4:7],v[228:231],v[68:71]
buffer_load_dwordx4 v16,s[20:23],s65 offen offset:0 sc1 lds
v_mfma_f32_16x16x32_bf16 v[76:79],a[132:135],v[228:231],v[76:79]
ds_read_b128 v[224:227],v17 offset:17408
s_waitcnt lgkmcnt(7)
v_mfma_f32_16x16x32_bf16 v[68:71],a[8:11],v[232:235],v[68:71]
buffer_load_dwordx4 v16,s[20:23],s65 offen offset:2048 sc1 lds
s_waitcnt lgkmcnt(5)
v_lshlrev_b32 v88,16,v120
v_mfma_f32_16x16x32_bf16 v[76:79],a[136:139],v[232:235],v[76:79]
ds_read_b128 v[228:231],v17 offset:19456
s_xor_b32 m0,s72,16384
v_and_b32 v89,s80,v120
v_lshlrev_b32 v90,16,v121
v_mfma_f32_16x16x32_bf16 v[68:71],a[12:15],v[236:239],v[68:71]
s_add_u32 s65,s88,32768
v_min3_u32 v27,v27,v232,v236
v_and_b32 v91,s80,v121
v_lshlrev_b32 v92,16,v122
v_mfma_f32_16x16x32_bf16 v[76:79],a[140:143],v[236:239],v[76:79]
ds_read_b128 v[232:235],v17 offset:21504
v_and_b32 v93,s80,v122
v_lshlrev_b32 v94,16,v123
s_waitcnt lgkmcnt(5)
v_mfma_f32_16x16x32_bf16 v[68:71],a[16:19],v[240:243],v[68:71]
buffer_load_dwordx4 v16,s[20:23],s65 offen offset:0 sc1 lds
v_and_b32 v95,s80,v123
v_add_f32 v88,v64,v88
v_mfma_f32_16x16x32_bf16 v[76:79],a[144:147],v[240:243],v[76:79]
ds_read_b128 v[236:239],v17 offset:23552
v_min3_u32 v27,v27,v240,v244
v_add_f32 v89,v65,v89
v_add_f32 v90,v66,v90
v_mfma_f32_16x16x32_bf16 v[68:71],a[20:23],v[244:247],v[68:71]
buffer_load_dwordx4 v16,s[20:23],s65 offen offset:2048 sc1 lds
v_add_f32 v91,v67,v91
v_add_f32 v92,v72,v92
v_mfma_f32_16x16x32_bf16 v[76:79],a[148:151],v[244:247],v[76:79]
ds_read_b128 v[240:243],v17 offset:25600
v_add_f32 v93,v73,v93
v_add_f32 v94,v74,v94
s_waitcnt lgkmcnt(5)
v_mfma_f32_16x16x32_bf16 v[68:71],a[24:27],v[248:251],v[68:71]
s_xor_b32 m0,s72,32768
s_add_u32 s65,s88,65536
v_add_f32 v95,v75,v95
v_cvt_pk_bf16_f32 v96,v88,v89
v_mfma_f32_16x16x32_bf16 v[76:79],a[152:155],v[248:251],v[76:79]
ds_read_b128 v[244:247],v17 offset:27648
v_min3_u32 v27,v27,v248,v252
v_cvt_pk_bf16_f32 v97,v90,v91
v_cvt_pk_bf16_f32 v98,v92,v93
v_mfma_f32_16x16x32_bf16 v[68:71],a[28:31],v[252:255],v[68:71]
buffer_load_dwordx4 v16,s[20:23],s65 offen offset:0 sc1 lds
v_cvt_pk_bf16_f32 v99,v94,v95
v_max_u32 v96,1,v96
v_mfma_f32_16x16x32_bf16 v[76:79],a[156:159],v[252:255],v[76:79]
ds_read_b128 v[248:251],v17 offset:29696
buffer_store_dwordx4 v[96:99],v18,s[20:23],s70 offen offset:0 sc1
s_waitcnt lgkmcnt(5)
v_mfma_f32_16x16x32_bf16 v[68:71],a[32:35],v[224:227],v[68:71]
buffer_load_dwordx4 v16,s[20:23],s65 offen offset:2048 sc1 lds
v_lshlrev_b32 v88,16,v96
v_and_b32 v89,s80,v96
v_mfma_f32_16x16x32_bf16 v[76:79],a[160:163],v[224:227],v[76:79]
ds_read_b128 v[252:255],v17 offset:31744
s_xor_b32 m0,s72,49152
v_lshlrev_b32 v90,16,v97
v_and_b32 v91,s80,v97
v_mfma_f32_16x16x32_bf16 v[68:71],a[36:39],v[228:231],v[68:71]
v_min3_u32 v27,v27,v224,v228
v_lshlrev_b32 v92,16,v98
v_and_b32 v93,s80,v98
v_lshlrev_b32 v94,16,v99
v_mfma_f32_16x16x32_bf16 v[76:79],a[164:167],v[228:231],v[76:79]
s_waitcnt vmcnt(9)
s_barrier
ds_read_b128 v[224:227],v17 offset:33792
s_waitcnt lgkmcnt(5)
v_mfma_f32_16x16x32_bf16 v[68:71],a[40:43],v[232:235],v[68:71]
s_add_u32 s65,s88,98304
v_min3_u32 v27,v27,v232,v236
v_and_b32 v95,s80,v99
v_add_f32 v108,v88,v89
v_mfma_f32_16x16x32_bf16 v[76:79],a[168:171],v[232:235],v[76:79]
ds_read_b128 v[228:231],v17 offset:35840
v_mul_f32 v109,v88,v88
v_add_f32 v100,v90,v91
v_mul_f32 v101,v89,v89
v_mfma_f32_16x16x32_bf16 v[68:71],a[44:47],v[236:239],v[68:71]
buffer_load_dwordx4 v16,s[20:23],s65 offen offset:0 sc1 lds
v_fmac_f32 v109,v90,v90
v_fmac_f32 v101,v91,v91
v_mfma_f32_16x16x32_bf16 v[76:79],a[172:175],v[236:239],v[76:79]
ds_read_b128 v[232:235],v17 offset:37888
v_fmac_f32 v109,v92,v92
v_fmac_f32 v101,v93,v93
s_waitcnt lgkmcnt(5)
v_mfma_f32_16x16x32_bf16 v[68:71],a[48:51],v[240:243],v[68:71]
buffer_load_dwordx4 v16,s[20:23],s65 offen offset:2048 sc1 lds
v_add_f32 v108,v108,v92
v_add_f32 v100,v100,v93
v_mfma_f32_16x16x32_bf16 v[76:79],a[176:179],v[240:243],v[76:79]
ds_read_b128 v[236:239],v17 offset:39936
s_xor_b32 m0,s72,1024
v_fmac_f32 v109,v94,v94
v_fmac_f32 v101,v95,v95
v_mfma_f32_16x16x32_bf16 v[68:71],a[52:55],v[244:247],v[68:71]
s_add_u32 s65,s89,0
v_min3_u32 v27,v27,v240,v244
v_add_f32 v108,v108,v94
v_add_f32 v100,v100,v95
v_mfma_f32_16x16x32_bf16 v[76:79],a[180:183],v[244:247],v[76:79]
ds_read_b128 v[240:243],v17 offset:41984
s_waitcnt lgkmcnt(5)
v_mfma_f32_16x16x32_bf16 v[68:71],a[56:59],v[248:251],v[68:71]
buffer_load_dwordx4 v16,s[20:23],s65 offen offset:0 sc1 lds
v_mfma_f32_16x16x32_bf16 v[76:79],a[184:187],v[248:251],v[76:79]
ds_read_b128 v[244:247],v17 offset:44032
v_min3_u32 v27,v27,v248,v252
v_mfma_f32_16x16x32_bf16 v[68:71],a[60:63],v[252:255],v[68:71]
buffer_load_dwordx4 v16,s[20:23],s65 offen offset:2048 sc1 lds
v_mfma_f32_16x16x32_bf16 v[76:79],a[188:191],v[252:255],v[76:79]
ds_read_b128 v[248:251],v17 offset:46080
s_waitcnt lgkmcnt(5)
v_mfma_f32_16x16x32_bf16 v[68:71],a[64:67],v[224:227],v[68:71]
s_xor_b32 m0,s72,17408
s_add_u32 s65,s89,32768
v_mfma_f32_16x16x32_bf16 v[76:79],a[192:195],v[224:227],v[76:79]
ds_read_b128 v[252:255],v17 offset:48128
v_min3_u32 v27,v27,v224,v228
v_mfma_f32_16x16x32_bf16 v[68:71],a[68:71],v[228:231],v[68:71]
buffer_load_dwordx4 v16,s[20:23],s65 offen offset:0 sc1 lds
v_mfma_f32_16x16x32_bf16 v[76:79],a[196:199],v[228:231],v[76:79]
ds_read_b128 v[224:227],v17 offset:50176
s_waitcnt lgkmcnt(5)
v_mfma_f32_16x16x32_bf16 v[68:71],a[72:75],v[232:235],v[68:71]
buffer_load_dwordx4 v16,s[20:23],s65 offen offset:2048 sc1 lds
v_mfma_f32_16x16x32_bf16 v[76:79],a[200:203],v[232:235],v[76:79]
ds_read_b128 v[228:231],v17 offset:52224
s_xor_b32 m0,s72,33792
v_mfma_f32_16x16x32_bf16 v[68:71],a[76:79],v[236:239],v[68:71]
s_add_u32 s65,s89,65536
v_min3_u32 v27,v27,v232,v236
v_mfma_f32_16x16x32_bf16 v[76:79],a[204:207],v[236:239],v[76:79]
ds_read_b128 v[232:235],v17 offset:54272
s_waitcnt lgkmcnt(5)
v_mfma_f32_16x16x32_bf16 v[68:71],a[80:83],v[240:243],v[68:71]
buffer_load_dwordx4 v16,s[20:23],s65 offen offset:0 sc1 lds
v_mfma_f32_16x16x32_bf16 v[76:79],a[208:211],v[240:243],v[76:79]
ds_read_b128 v[236:239],v17 offset:56320
v_min3_u32 v27,v27,v240,v244
v_mfma_f32_16x16x32_bf16 v[68:71],a[84:87],v[244:247],v[68:71]
buffer_load_dwordx4 v16,s[20:23],s65 offen offset:2048 sc1 lds
v_mfma_f32_16x16x32_bf16 v[76:79],a[212:215],v[244:247],v[76:79]
ds_read_b128 v[240:243],v17 offset:58368
s_waitcnt lgkmcnt(5)
v_mfma_f32_16x16x32_bf16 v[68:71],a[88:91],v[248:251],v[68:71]
s_xor_b32 m0,s72,50176
v_min3_u32 v27,v27,v248,v252
v_mfma_f32_16x16x32_bf16 v[76:79],a[216:219],v[248:251],v[76:79]
ds_read_b128 v[244:247],v17 offset:60416
s_add_u32 s65,s89,98304
v_mfma_f32_16x16x32_bf16 v[68:71],a[92:95],v[252:255],v[68:71]
buffer_load_dwordx4 v16,s[20:23],s65 offen offset:0 sc1 lds
v_mfma_f32_16x16x32_bf16 v[76:79],a[220:223],v[252:255],v[76:79]
ds_read_b128 v[248:251],v17 offset:62464
s_waitcnt lgkmcnt(5)
v_mfma_f32_16x16x32_bf16 v[68:71],a[96:99],v[224:227],v[68:71]
buffer_load_dwordx4 v16,s[20:23],s65 offen offset:2048 sc1 lds
v_mfma_f32_16x16x32_bf16 v[76:79],a[224:227],v[224:227],v[76:79]
ds_read_b128 v[252:255],v17 offset:64512
v_min3_u32 v27,v27,v224,v228
v_mfma_f32_16x16x32_bf16 v[68:71],a[100:103],v[228:231],v[68:71]
v_add_f32 v108,v108,v100
v_add_f32 v109,v109,v101
v_mfma_f32_16x16x32_bf16 v[76:79],a[228:231],v[228:231],v[76:79]
v_mov_b32 v100,v108
s_waitcnt lgkmcnt(4)
v_mfma_f32_16x16x32_bf16 v[68:71],a[104:107],v[232:235],v[68:71]
v_min3_u32 v27,v27,v232,v236
v_mov_b32 v101,v109
v_mfma_f32_16x16x32_bf16 v[76:79],a[232:235],v[232:235],v[76:79]
v_permlane16_swap_b32 v100,v108
v_permlane16_swap_b32 v101,v109
v_mfma_f32_16x16x32_bf16 v[68:71],a[108:111],v[236:239],v[68:71]
v_add_f32 v108,v108,v100
v_add_f32 v109,v109,v101
v_mfma_f32_16x16x32_bf16 v[76:79],a[236:239],v[236:239],v[76:79]
v_mov_b32 v100,v108
s_waitcnt lgkmcnt(2)
v_mfma_f32_16x16x32_bf16 v[68:71],a[112:115],v[240:243],v[68:71]
v_min3_u32 v27,v27,v240,v244
v_mov_b32 v101,v109
v_mfma_f32_16x16x32_bf16 v[76:79],a[240:243],v[240:243],v[76:79]
v_permlane32_swap_b32 v100,v108
v_permlane32_swap_b32 v101,v109
v_mfma_f32_16x16x32_bf16 v[68:71],a[116:119],v[244:247],v[68:71]
v_add_f32 v108,v108,v100
v_add_f32 v109,v109,v101
v_mfma_f32_16x16x32_bf16 v[76:79],a[244:247],v[244:247],v[76:79]
v_lshlrev_b32 v32,16,v124
s_waitcnt lgkmcnt(0)
v_mfma_f32_16x16x32_bf16 v[68:71],a[120:123],v[248:251],v[68:71]
v_min3_u32 v27,v27,v248,v252
v_and_b32 v33,s80,v124
v_mfma_f32_16x16x32_bf16 v[76:79],a[248:251],v[248:251],v[76:79]
v_lshlrev_b32 v34,16,v125
v_and_b32 v35,s80,v125
v_mfma_f32_16x16x32_bf16 v[68:71],a[124:127],v[252:255],v[68:71]
v_lshlrev_b32 v36,16,v126
v_and_b32 v37,s80,v126
v_mfma_f32_16x16x32_bf16 v[76:79],a[252:255],v[252:255],v[76:79]
v_lshlrev_b32 v38,16,v127
v_and_b32 v39,s80,v127
v_cmp_eq_u32 vcc,0,v27
s_cbranch_vccnz retry_234
s_branch epi_237
ahead_236:
s_cmp_eq_u32 s93,0
s_cbranch_scc1 both_238
s_waitcnt vmcnt(12) lgkmcnt(0)
s_barrier
ds_read_b128 v[224:227],v17 offset:0
ds_read_b128 v[228:231],v17 offset:2048
ds_read_b128 v[232:235],v17 offset:4096
ds_read_b128 v[236:239],v17 offset:6144
ds_read_b128 v[240:243],v17 offset:8192
ds_read_b128 v[244:247],v17 offset:10240
ds_read_b128 v[248:251],v17 offset:12288
s_waitcnt lgkmcnt(5)
v_mfma_f32_16x16x32_bf16 v[64:67],a[0:3],v[224:227],0
s_add_u32 s96,s71,1
s_add_u32 s92,s71,2
s_add_u32 m0,s43,0
v_mfma_f32_16x16x32_bf16 v[72:75],a[128:131],v[224:227],0
ds_read_b128 v[252:255],v17 offset:14336
v_min_u32 v27,v224,v228
buffer_load_dwordx4 v19,s[20:23],s78 offen sc1 lds
v_mfma_f32_16x16x32_bf16 v[64:67],a[4:7],v[228:231],v[64:67]
s_cmp_eq_u32 s96,65
s_cselect_b32 s96,64,s96
s_add_u32 m0,s43,1024
v_mfma_f32_16x16x32_bf16 v[72:75],a[132:135],v[228:231],v[72:75]
ds_read_b128 v[224:227],v17 offset:16384
buffer_load_dwordx4 v20,s[20:23],s78 offen sc1 lds
s_waitcnt lgkmcnt(5)
v_mfma_f32_16x16x32_bf16 v[64:67],a[8:11],v[232:235],v[64:67]
v_min3_u32 v27,v27,v232,v236
v_mfma_f32_16x16x32_bf16 v[72:75],a[136:139],v[232:235],v[72:75]
ds_read_b128 v[228:231],v17 offset:18432
v_mfma_f32_16x16x32_bf16 v[64:67],a[12:15],v[236:239],v[64:67]
v_mfma_f32_16x16x32_bf16 v[72:75],a[140:143],v[236:239],v[72:75]
ds_read_b128 v[232:235],v17 offset:20480
s_waitcnt lgkmcnt(5)
v_mfma_f32_16x16x32_bf16 v[64:67],a[16:19],v[240:243],v[64:67]
v_min3_u32 v27,v27,v240,v244
v_mfma_f32_16x16x32_bf16 v[72:75],a[144:147],v[240:243],v[72:75]
ds_read_b128 v[236:239],v17 offset:22528
v_mfma_f32_16x16x32_bf16 v[64:67],a[20:23],v[244:247],v[64:67]
v_mfma_f32_16x16x32_bf16 v[72:75],a[148:151],v[244:247],v[72:75]
ds_read_b128 v[240:243],v17 offset:24576
s_waitcnt lgkmcnt(5)
v_mfma_f32_16x16x32_bf16 v[64:67],a[24:27],v[248:251],v[64:67]
v_min3_u32 v27,v27,v248,v252
v_mfma_f32_16x16x32_bf16 v[72:75],a[152:155],v[248:251],v[72:75]
ds_read_b128 v[244:247],v17 offset:26624
v_mfma_f32_16x16x32_bf16 v[64:67],a[28:31],v[252:255],v[64:67]
v_mfma_f32_16x16x32_bf16 v[72:75],a[156:159],v[252:255],v[72:75]
ds_read_b128 v[248:251],v17 offset:28672
s_waitcnt lgkmcnt(5)
v_mfma_f32_16x16x32_bf16 v[64:67],a[32:35],v[224:227],v[64:67]
v_min3_u32 v27,v27,v224,v228
v_mfma_f32_16x16x32_bf16 v[72:75],a[160:163],v[224:227],v[72:75]
ds_read_b128 v[252:255],v17 offset:30720
v_mfma_f32_16x16x32_bf16 v[64:67],a[36:39],v[228:231],v[64:67]
v_mfma_f32_16x16x32_bf16 v[72:75],a[164:167],v[228:231],v[72:75]
ds_read_b128 v[224:227],v17 offset:32768
s_waitcnt lgkmcnt(5)
v_mfma_f32_16x16x32_bf16 v[64:67],a[40:43],v[232:235],v[64:67]
v_min3_u32 v27,v27,v232,v236
v_mfma_f32_16x16x32_bf16 v[72:75],a[168:171],v[232:235],v[72:75]
ds_read_b128 v[228:231],v17 offset:34816
v_mfma_f32_16x16x32_bf16 v[64:67],a[44:47],v[236:239],v[64:67]
v_mfma_f32_16x16x32_bf16 v[72:75],a[172:175],v[236:239],v[72:75]
ds_read_b128 v[232:235],v17 offset:36864
s_waitcnt lgkmcnt(5)
v_mfma_f32_16x16x32_bf16 v[64:67],a[48:51],v[240:243],v[64:67]
v_min3_u32 v27,v27,v240,v244
v_mfma_f32_16x16x32_bf16 v[72:75],a[176:179],v[240:243],v[72:75]
ds_read_b128 v[236:239],v17 offset:38912
v_mfma_f32_16x16x32_bf16 v[64:67],a[52:55],v[244:247],v[64:67]
v_mfma_f32_16x16x32_bf16 v[72:75],a[180:183],v[244:247],v[72:75]
ds_read_b128 v[240:243],v17 offset:40960
s_waitcnt lgkmcnt(5)
v_mfma_f32_16x16x32_bf16 v[64:67],a[56:59],v[248:251],v[64:67]
v_min3_u32 v27,v27,v248,v252
v_mfma_f32_16x16x32_bf16 v[72:75],a[184:187],v[248:251],v[72:75]
ds_read_b128 v[244:247],v17 offset:43008
s_waitcnt vmcnt(5)
v_mfma_f32_16x16x32_bf16 v[64:67],a[60:63],v[252:255],v[64:67]
v_cmp_gt_u32 vcc,s96,v29
v_cmp_gt_u32 s[92:93],s92,v29
v_mfma_f32_16x16x32_bf16 v[72:75],a[188:191],v[252:255],v[72:75]
ds_read_b128 v[248:251],v17 offset:45056
s_waitcnt lgkmcnt(5)
v_mfma_f32_16x16x32_bf16 v[64:67],a[64:67],v[224:227],v[64:67]
v_mov_b32 v44,vcc_lo
v_mov_b32 v45,s92
v_mfma_f32_16x16x32_bf16 v[72:75],a[192:195],v[224:227],v[72:75]
ds_read_b128 v[252:255],v17 offset:47104
ds_write_b64 v46,v[44:45]
v_mfma_f32_16x16x32_bf16 v[64:67],a[68:71],v[228:231],v[64:67]
v_min3_u32 v27,v27,v224,v228
v_mfma_f32_16x16x32_bf16 v[72:75],a[196:199],v[228:231],v[72:75]
ds_read_b128 v[224:227],v17 offset:49152
s_waitcnt lgkmcnt(6)
v_mfma_f32_16x16x32_bf16 v[64:67],a[72:75],v[232:235],v[64:67]
v_min3_u32 v27,v27,v232,v236
v_mfma_f32_16x16x32_bf16 v[72:75],a[200:203],v[232:235],v[72:75]
ds_read_b128 v[228:231],v17 offset:51200
v_mfma_f32_16x16x32_bf16 v[64:67],a[76:79],v[236:239],v[64:67]
v_mfma_f32_16x16x32_bf16 v[72:75],a[204:207],v[236:239],v[72:75]
ds_read_b128 v[232:235],v17 offset:53248
s_waitcnt lgkmcnt(6)
v_mfma_f32_16x16x32_bf16 v[64:67],a[80:83],v[240:243],v[64:67]
v_min3_u32 v27,v27,v240,v244
s_add_u32 s88,s70,s75
v_mfma_f32_16x16x32_bf16 v[72:75],a[208:211],v[240:243],v[72:75]
ds_read_b128 v[236:239],v17 offset:55296
s_add_u32 s88,s88,2097152
v_mfma_f32_16x16x32_bf16 v[64:67],a[84:87],v[244:247],v[64:67]
s_xor_b32 s88,s88,0x2000
s_xor_b32 s89,s88,1024
v_mfma_f32_16x16x32_bf16 v[72:75],a[212:215],v[244:247],v[72:75]
ds_read_b128 v[240:243],v17 offset:57344
s_waitcnt lgkmcnt(6)
v_mfma_f32_16x16x32_bf16 v[64:67],a[88:91],v[248:251],v[64:67]
v_min3_u32 v27,v27,v248,v252
v_mfma_f32_16x16x32_bf16 v[72:75],a[216:219],v[248:251],v[72:75]
ds_read_b128 v[244:247],v17 offset:59392
v_mfma_f32_16x16x32_bf16 v[64:67],a[92:95],v[252:255],v[64:67]
v_mfma_f32_16x16x32_bf16 v[72:75],a[220:223],v[252:255],v[72:75]
ds_read_b128 v[248:251],v17 offset:61440
s_waitcnt lgkmcnt(5)
v_mfma_f32_16x16x32_bf16 v[64:67],a[96:99],v[224:227],v[64:67]
v_min3_u32 v27,v27,v224,v228
v_mfma_f32_16x16x32_bf16 v[72:75],a[224:227],v[224:227],v[72:75]
ds_read_b128 v[252:255],v17 offset:63488
v_mfma_f32_16x16x32_bf16 v[64:67],a[100:103],v[228:231],v[64:67]
s_waitcnt vmcnt(2)
v_add_u32 v22,s71,-1
v_mfma_f32_16x16x32_bf16 v[72:75],a[228:231],v[228:231],v[72:75]
s_waitcnt vmcnt(6)
s_barrier
ds_read_b64 v[44:45],v47
ds_read_b128 v[224:227],v17 offset:1024
s_waitcnt lgkmcnt(6)
v_mfma_f32_16x16x32_bf16 v[64:67],a[104:107],v[232:235],v[64:67]
v_min3_u32 v27,v27,v232,v236
v_mfma_f32_16x16x32_bf16 v[72:75],a[232:235],v[232:235],v[72:75]
ds_read_b128 v[228:231],v17 offset:3072
v_mfma_f32_16x16x32_bf16 v[64:67],a[108:111],v[236:239],v[64:67]
buffer_store_dword v22,v23,s[20:23],s97 offen sc1
s_waitcnt vmcnt(1)
v_mfma_f32_16x16x32_bf16 v[72:75],a[236:239],v[236:239],v[72:75]
ds_read_b128 v[232:235],v17 offset:5120
s_waitcnt lgkmcnt(6)
v_mfma_f32_16x16x32_bf16 v[64:67],a[112:115],v[240:243],v[64:67]
v_min3_u32 v27,v27,v240,v244
s_mov_b32 s97,0x7fff0000
v_mfma_f32_16x16x32_bf16 v[72:75],a[240:243],v[240:243],v[72:75]
ds_read_b128 v[236:239],v17 offset:7168
ds_read_b64 v[120:121],v40 offset:0
v_mfma_f32_16x16x32_bf16 v[64:67],a[116:119],v[244:247],v[64:67]
ds_read_b64 v[122:123],v41 offset:0
ds_read_b64 v[124:125],v40 offset:1024
v_mfma_f32_16x16x32_bf16 v[72:75],a[244:247],v[244:247],v[72:75]
ds_read_b128 v[240:243],v17 offset:9216
s_waitcnt lgkmcnt(9)
v_mfma_f32_16x16x32_bf16 v[64:67],a[120:123],v[248:251],v[64:67]
s_waitcnt lgkmcnt(8)
v_readfirstlane_b32 s93,v45
v_mfma_f32_16x16x32_bf16 v[72:75],a[248:251],v[248:251],v[72:75]
ds_read_b128 v[244:247],v17 offset:11264
v_readfirstlane_b32 s83,v44
s_cmp_lg_u32 s83,0
s_cbranch_scc1 keep_243
v_mfma_f32_16x16x32_bf16 v[64:67],a[124:127],v[252:255],v[64:67]
v_min3_u32 v27,v27,v248,v252
ds_read_b64 v[126:127],v41 offset:1024
v_mfma_f32_16x16x32_bf16 v[72:75],a[252:255],v[252:255],v[72:75]
ds_read_b128 v[248:251],v17 offset:13312
s_waitcnt lgkmcnt(9)
v_mfma_f32_16x16x32_bf16 v[68:71],a[0:3],v[224:227],0
s_xor_b32 m0,s72,0
s_add_u32 s65,s88,0
v_min3_u32 v27,v27,v224,v228
v_mfma_f32_16x16x32_bf16 v[76:79],a[128:131],v[224:227],0
ds_read_b128 v[252:255],v17 offset:15360
v_cmp_eq_u32 vcc,0,v27
s_cbranch_vccnz retry_234
v_mfma_f32_16x16x32_bf16 v[68:71],a[4:7],v[228:231],v[68:71]
buffer_load_dwordx4 v16,s[20:23],s65 offen offset:0 sc1 lds
v_mfma_f32_16x16x32_bf16 v[76:79],a[132:135],v[228:231],v[76:79]
ds_read_b128 v[224:227],v17 offset:17408
s_waitcnt lgkmcnt(9)
v_mfma_f32_16x16x32_bf16 v[68:71],a[8:11],v[232:235],v[68:71]
buffer_load_dwordx4 v16,s[20:23],s65 offen offset:2048 sc1 lds
s_waitcnt lgkmcnt(3)
v_lshlrev_b32 v88,16,v120
v_mfma_f32_16x16x32_bf16 v[76:79],a[136:139],v[232:235],v[76:79]
ds_read_b128 v[228:231],v17 offset:19456
s_xor_b32 m0,s72,16384
v_and_b32 v89,s80,v120
v_lshlrev_b32 v90,16,v121
v_mfma_f32_16x16x32_bf16 v[68:71],a[12:15],v[236:239],v[68:71]
s_add_u32 s65,s88,32768
v_min3_u32 v27,v27,v232,v236
v_and_b32 v91,s80,v121
v_lshlrev_b32 v92,16,v122
v_mfma_f32_16x16x32_bf16 v[76:79],a[140:143],v[236:239],v[76:79]
ds_read_b128 v[232:235],v17 offset:21504
v_and_b32 v93,s80,v122
v_lshlrev_b32 v94,16,v123
v_mfma_f32_16x16x32_bf16 v[68:71],a[16:19],v[240:243],v[68:71]
buffer_load_dwordx4 v16,s[20:23],s65 offen offset:0 sc1 lds
v_and_b32 v95,s80,v123
v_add_f32 v88,v64,v88
v_mfma_f32_16x16x32_bf16 v[76:79],a[144:147],v[240:243],v[76:79]
ds_read_b128 v[236:239],v17 offset:23552
v_min3_u32 v27,v27,v240,v244
v_add_f32 v89,v65,v89
v_add_f32 v90,v66,v90
v_mfma_f32_16x16x32_bf16 v[68:71],a[20:23],v[244:247],v[68:71]
buffer_load_dwordx4 v16,s[20:23],s65 offen offset:2048 sc1 lds
v_add_f32 v91,v67,v91
v_add_f32 v92,v72,v92
v_mfma_f32_16x16x32_bf16 v[76:79],a[148:151],v[244:247],v[76:79]
ds_read_b128 v[240:243],v17 offset:25600
v_add_f32 v93,v73,v93
v_add_f32 v94,v74,v94
s_waitcnt lgkmcnt(5)
v_mfma_f32_16x16x32_bf16 v[68:71],a[24:27],v[248:251],v[68:71]
s_xor_b32 m0,s72,32768
s_add_u32 s65,s88,65536
v_add_f32 v95,v75,v95
v_cvt_pk_bf16_f32 v96,v88,v89
v_mfma_f32_16x16x32_bf16 v[76:79],a[152:155],v[248:251],v[76:79]
ds_read_b128 v[244:247],v17 offset:27648
v_min3_u32 v27,v27,v248,v252
v_cvt_pk_bf16_f32 v97,v90,v91
v_cvt_pk_bf16_f32 v98,v92,v93
v_mfma_f32_16x16x32_bf16 v[68:71],a[28:31],v[252:255],v[68:71]
buffer_load_dwordx4 v16,s[20:23],s65 offen offset:0 sc1 lds
v_cvt_pk_bf16_f32 v99,v94,v95
v_max_u32 v96,1,v96
v_mfma_f32_16x16x32_bf16 v[76:79],a[156:159],v[252:255],v[76:79]
ds_read_b128 v[248:251],v17 offset:29696
buffer_store_dwordx4 v[96:99],v18,s[20:23],s70 offen offset:0 sc1
s_waitcnt lgkmcnt(5)
v_mfma_f32_16x16x32_bf16 v[68:71],a[32:35],v[224:227],v[68:71]
buffer_load_dwordx4 v16,s[20:23],s65 offen offset:2048 sc1 lds
v_lshlrev_b32 v88,16,v96
v_and_b32 v89,s80,v96
v_mfma_f32_16x16x32_bf16 v[76:79],a[160:163],v[224:227],v[76:79]
ds_read_b128 v[252:255],v17 offset:31744
s_xor_b32 m0,s72,49152
v_lshlrev_b32 v90,16,v97
v_and_b32 v91,s80,v97
v_mfma_f32_16x16x32_bf16 v[68:71],a[36:39],v[228:231],v[68:71]
v_min3_u32 v27,v27,v224,v228
v_lshlrev_b32 v92,16,v98
v_and_b32 v93,s80,v98
v_lshlrev_b32 v94,16,v99
v_mfma_f32_16x16x32_bf16 v[76:79],a[164:167],v[228:231],v[76:79]
ds_read_b128 v[224:227],v17 offset:33792
v_and_b32 v95,s80,v99
v_add_f32 v108,v88,v89
s_waitcnt lgkmcnt(5)
v_mfma_f32_16x16x32_bf16 v[68:71],a[40:43],v[232:235],v[68:71]
s_add_u32 s65,s88,98304
v_min3_u32 v27,v27,v232,v236
v_mul_f32 v109,v88,v88
v_add_f32 v100,v90,v91
v_mfma_f32_16x16x32_bf16 v[76:79],a[168:171],v[232:235],v[76:79]
ds_read_b128 v[228:231],v17 offset:35840
v_mul_f32 v101,v89,v89
v_fmac_f32 v109,v90,v90
v_fmac_f32 v101,v91,v91
v_mfma_f32_16x16x32_bf16 v[68:71],a[44:47],v[236:239],v[68:71]
buffer_load_dwordx4 v16,s[20:23],s65 offen offset:0 sc1 lds
v_fmac_f32 v109,v92,v92
v_fmac_f32 v101,v93,v93
v_mfma_f32_16x16x32_bf16 v[76:79],a[172:175],v[236:239],v[76:79]
ds_read_b128 v[232:235],v17 offset:37888
v_add_f32 v108,v108,v92
v_add_f32 v100,v100,v93
s_waitcnt lgkmcnt(5)
v_mfma_f32_16x16x32_bf16 v[68:71],a[48:51],v[240:243],v[68:71]
buffer_load_dwordx4 v16,s[20:23],s65 offen offset:2048 sc1 lds
v_fmac_f32 v109,v94,v94
v_fmac_f32 v101,v95,v95
v_mfma_f32_16x16x32_bf16 v[76:79],a[176:179],v[240:243],v[76:79]
ds_read_b128 v[236:239],v17 offset:39936
s_xor_b32 m0,s72,1024
v_add_f32 v108,v108,v94
v_add_f32 v100,v100,v95
v_mfma_f32_16x16x32_bf16 v[68:71],a[52:55],v[244:247],v[68:71]
s_add_u32 s65,s89,0
v_min3_u32 v27,v27,v240,v244
v_mfma_f32_16x16x32_bf16 v[76:79],a[180:183],v[244:247],v[76:79]
ds_read_b128 v[240:243],v17 offset:41984
s_waitcnt lgkmcnt(5)
v_mfma_f32_16x16x32_bf16 v[68:71],a[56:59],v[248:251],v[68:71]
buffer_load_dwordx4 v16,s[20:23],s65 offen offset:0 sc1 lds
v_mfma_f32_16x16x32_bf16 v[76:79],a[184:187],v[248:251],v[76:79]
ds_read_b128 v[244:247],v17 offset:44032
v_min3_u32 v27,v27,v248,v252
v_mfma_f32_16x16x32_bf16 v[68:71],a[60:63],v[252:255],v[68:71]
buffer_load_dwordx4 v16,s[20:23],s65 offen offset:2048 sc1 lds
v_mfma_f32_16x16x32_bf16 v[76:79],a[188:191],v[252:255],v[76:79]
ds_read_b128 v[248:251],v17 offset:46080
s_waitcnt lgkmcnt(5)
v_mfma_f32_16x16x32_bf16 v[68:71],a[64:67],v[224:227],v[68:71]
s_xor_b32 m0,s72,17408
s_add_u32 s65,s89,32768
v_mfma_f32_16x16x32_bf16 v[76:79],a[192:195],v[224:227],v[76:79]
ds_read_b128 v[252:255],v17 offset:48128
v_min3_u32 v27,v27,v224,v228
v_mfma_f32_16x16x32_bf16 v[68:71],a[68:71],v[228:231],v[68:71]
buffer_load_dwordx4 v16,s[20:23],s65 offen offset:0 sc1 lds
v_mfma_f32_16x16x32_bf16 v[76:79],a[196:199],v[228:231],v[76:79]
ds_read_b128 v[224:227],v17 offset:50176
s_waitcnt lgkmcnt(5)
v_mfma_f32_16x16x32_bf16 v[68:71],a[72:75],v[232:235],v[68:71]
buffer_load_dwordx4 v16,s[20:23],s65 offen offset:2048 sc1 lds
v_mfma_f32_16x16x32_bf16 v[76:79],a[200:203],v[232:235],v[76:79]
ds_read_b128 v[228:231],v17 offset:52224
s_xor_b32 m0,s72,33792
v_mfma_f32_16x16x32_bf16 v[68:71],a[76:79],v[236:239],v[68:71]
s_add_u32 s65,s89,65536
v_min3_u32 v27,v27,v232,v236
v_mfma_f32_16x16x32_bf16 v[76:79],a[204:207],v[236:239],v[76:79]
ds_read_b128 v[232:235],v17 offset:54272
s_waitcnt lgkmcnt(5)
v_mfma_f32_16x16x32_bf16 v[68:71],a[80:83],v[240:243],v[68:71]
buffer_load_dwordx4 v16,s[20:23],s65 offen offset:0 sc1 lds
v_mfma_f32_16x16x32_bf16 v[76:79],a[208:211],v[240:243],v[76:79]
ds_read_b128 v[236:239],v17 offset:56320
v_min3_u32 v27,v27,v240,v244
v_mfma_f32_16x16x32_bf16 v[68:71],a[84:87],v[244:247],v[68:71]
buffer_load_dwordx4 v16,s[20:23],s65 offen offset:2048 sc1 lds
v_mfma_f32_16x16x32_bf16 v[76:79],a[212:215],v[244:247],v[76:79]
ds_read_b128 v[240:243],v17 offset:58368
s_waitcnt lgkmcnt(5)
v_mfma_f32_16x16x32_bf16 v[68:71],a[88:91],v[248:251],v[68:71]
s_xor_b32 m0,s72,50176
v_min3_u32 v27,v27,v248,v252
v_mfma_f32_16x16x32_bf16 v[76:79],a[216:219],v[248:251],v[76:79]
ds_read_b128 v[244:247],v17 offset:60416
s_add_u32 s65,s89,98304
v_mfma_f32_16x16x32_bf16 v[68:71],a[92:95],v[252:255],v[68:71]
buffer_load_dwordx4 v16,s[20:23],s65 offen offset:0 sc1 lds
v_mfma_f32_16x16x32_bf16 v[76:79],a[220:223],v[252:255],v[76:79]
ds_read_b128 v[248:251],v17 offset:62464
s_waitcnt lgkmcnt(5)
v_mfma_f32_16x16x32_bf16 v[68:71],a[96:99],v[224:227],v[68:71]
buffer_load_dwordx4 v16,s[20:23],s65 offen offset:2048 sc1 lds
v_mfma_f32_16x16x32_bf16 v[76:79],a[224:227],v[224:227],v[76:79]
ds_read_b128 v[252:255],v17 offset:64512
v_min3_u32 v27,v27,v224,v228
v_mfma_f32_16x16x32_bf16 v[68:71],a[100:103],v[228:231],v[68:71]
v_add_f32 v108,v108,v100
v_add_f32 v109,v109,v101
v_mfma_f32_16x16x32_bf16 v[76:79],a[228:231],v[228:231],v[76:79]
v_mov_b32 v100,v108
s_waitcnt lgkmcnt(4)
v_mfma_f32_16x16x32_bf16 v[68:71],a[104:107],v[232:235],v[68:71]
v_min3_u32 v27,v27,v232,v236
v_mov_b32 v101,v109
v_mfma_f32_16x16x32_bf16 v[76:79],a[232:235],v[232:235],v[76:79]
v_permlane16_swap_b32 v100,v108
v_permlane16_swap_b32 v101,v109
v_mfma_f32_16x16x32_bf16 v[68:71],a[108:111],v[236:239],v[68:71]
v_add_f32 v108,v108,v100
v_add_f32 v109,v109,v101
v_mfma_f32_16x16x32_bf16 v[76:79],a[236:239],v[236:239],v[76:79]
v_mov_b32 v100,v108
s_waitcnt lgkmcnt(2)
v_mfma_f32_16x16x32_bf16 v[68:71],a[112:115],v[240:243],v[68:71]
v_min3_u32 v27,v27,v240,v244
v_mov_b32 v101,v109
v_mfma_f32_16x16x32_bf16 v[76:79],a[240:243],v[240:243],v[76:79]
v_permlane32_swap_b32 v100,v108
v_permlane32_swap_b32 v101,v109
v_mfma_f32_16x16x32_bf16 v[68:71],a[116:119],v[244:247],v[68:71]
v_add_f32 v108,v108,v100
v_add_f32 v109,v109,v101
v_mfma_f32_16x16x32_bf16 v[76:79],a[244:247],v[244:247],v[76:79]
v_lshlrev_b32 v32,16,v124
s_waitcnt lgkmcnt(0)
v_mfma_f32_16x16x32_bf16 v[68:71],a[120:123],v[248:251],v[68:71]
v_min3_u32 v27,v27,v248,v252
v_and_b32 v33,s80,v124
v_mfma_f32_16x16x32_bf16 v[76:79],a[248:251],v[248:251],v[76:79]
v_lshlrev_b32 v34,16,v125
v_and_b32 v35,s80,v125
v_mfma_f32_16x16x32_bf16 v[68:71],a[124:127],v[252:255],v[68:71]
v_lshlrev_b32 v36,16,v126
v_and_b32 v37,s80,v126
v_mfma_f32_16x16x32_bf16 v[76:79],a[252:255],v[252:255],v[76:79]
v_lshlrev_b32 v38,16,v127
v_and_b32 v39,s80,v127
v_cmp_eq_u32 vcc,0,v27
s_cbranch_vccnz retry_234
s_branch epi_237
keep_243:
v_mfma_f32_16x16x32_bf16 v[64:67],a[124:127],v[252:255],v[64:67]
v_min3_u32 v27,v27,v248,v252
ds_read_b64 v[126:127],v41 offset:1024
v_mfma_f32_16x16x32_bf16 v[72:75],a[252:255],v[252:255],v[72:75]
ds_read_b128 v[248:251],v17 offset:13312
s_waitcnt lgkmcnt(9)
v_mfma_f32_16x16x32_bf16 v[68:71],a[0:3],v[224:227],0
v_cmp_eq_u32 vcc,0,v27
s_cbranch_vccnz retry_234
v_mfma_f32_16x16x32_bf16 v[76:79],a[128:131],v[224:227],0
ds_read_b128 v[252:255],v17 offset:15360
v_min3_u32 v27,v27,v224,v228
v_mfma_f32_16x16x32_bf16 v[68:71],a[4:7],v[228:231],v[68:71]
v_mfma_f32_16x16x32_bf16 v[76:79],a[132:135],v[228:231],v[76:79]
ds_read_b128 v[224:227],v17 offset:17408
s_waitcnt lgkmcnt(9)
v_mfma_f32_16x16x32_bf16 v[68:71],a[8:11],v[232:235],v[68:71]
v_min3_u32 v27,v27,v232,v236
s_waitcnt lgkmcnt(3)
v_mfma_f32_16x16x32_bf16 v[76:79],a[136:139],v[232:235],v[76:79]
ds_read_b128 v[228:231],v17 offset:19456
v_lshlrev_b32 v88,16,v120
v_mfma_f32_16x16x32_bf16 v[68:71],a[12:15],v[236:239],v[68:71]
v_and_b32 v89,s80,v120
v_lshlrev_b32 v90,16,v121
v_mfma_f32_16x16x32_bf16 v[76:79],a[140:143],v[236:239],v[76:79]
ds_read_b128 v[232:235],v17 offset:21504
v_mfma_f32_16x16x32_bf16 v[68:71],a[16:19],v[240:243],v[68:71]
v_min3_u32 v27,v27,v240,v244
v_and_b32 v91,s80,v121
v_mfma_f32_16x16x32_bf16 v[76:79],a[144:147],v[240:243],v[76:79]
ds_read_b128 v[236:239],v17 offset:23552
v_lshlrev_b32 v92,16,v122
v_mfma_f32_16x16x32_bf16 v[68:71],a[20:23],v[244:247],v[68:71]
v_and_b32 v93,s80,v122
v_lshlrev_b32 v94,16,v123
v_mfma_f32_16x16x32_bf16 v[76:79],a[148:151],v[244:247],v[76:79]
ds_read_b128 v[240:243],v17 offset:25600
s_waitcnt lgkmcnt(5)
v_mfma_f32_16x16x32_bf16 v[68:71],a[24:27],v[248:251],v[68:71]
v_min3_u32 v27,v27,v248,v252
v_and_b32 v95,s80,v123
v_mfma_f32_16x16x32_bf16 v[76:79],a[152:155],v[248:251],v[76:79]
ds_read_b128 v[244:247],v17 offset:27648
v_add_f32 v88,v64,v88
v_mfma_f32_16x16x32_bf16 v[68:71],a[28:31],v[252:255],v[68:71]
v_add_f32 v89,v65,v89
v_add_f32 v90,v66,v90
v_mfma_f32_16x16x32_bf16 v[76:79],a[156:159],v[252:255],v[76:79]
ds_read_b128 v[248:251],v17 offset:29696
s_waitcnt lgkmcnt(5)
v_mfma_f32_16x16x32_bf16 v[68:71],a[32:35],v[224:227],v[68:71]
v_min3_u32 v27,v27,v224,v228
v_add_f32 v91,v67,v91
v_mfma_f32_16x16x32_bf16 v[76:79],a[160:163],v[224:227],v[76:79]
ds_read_b128 v[252:255],v17 offset:31744
v_add_f32 v92,v72,v92
v_mfma_f32_16x16x32_bf16 v[68:71],a[36:39],v[228:231],v[68:71]
v_add_f32 v93,v73,v93
v_add_f32 v94,v74,v94
v_mfma_f32_16x16x32_bf16 v[76:79],a[164:167],v[228:231],v[76:79]
ds_read_b128 v[224:227],v17 offset:33792
s_waitcnt lgkmcnt(5)
v_mfma_f32_16x16x32_bf16 v[68:71],a[40:43],v[232:235],v[68:71]
v_min3_u32 v27,v27,v232,v236
v_add_f32 v95,v75,v95
v_mfma_f32_16x16x32_bf16 v[76:79],a[168:171],v[232:235],v[76:79]
ds_read_b128 v[228:231],v17 offset:35840
v_cvt_pk_bf16_f32 v96,v88,v89
v_mfma_f32_16x16x32_bf16 v[68:71],a[44:47],v[236:239],v[68:71]
v_cvt_pk_bf16_f32 v97,v90,v91
v_cvt_pk_bf16_f32 v98,v92,v93
v_mfma_f32_16x16x32_bf16 v[76:79],a[172:175],v[236:239],v[76:79]
ds_read_b128 v[232:235],v17 offset:37888
s_waitcnt lgkmcnt(5)
v_mfma_f32_16x16x32_bf16 v[68:71],a[48:51],v[240:243],v[68:71]
v_min3_u32 v27,v27,v240,v244
v_cvt_pk_bf16_f32 v99,v94,v95
v_mfma_f32_16x16x32_bf16 v[76:79],a[176:179],v[240:243],v[76:79]
ds_read_b128 v[236:239],v17 offset:39936
v_max_u32 v96,1,v96
v_mfma_f32_16x16x32_bf16 v[68:71],a[52:55],v[244:247],v[68:71]
buffer_store_dwordx4 v[96:99],v18,s[20:23],s70 offen offset:0 sc1
v_mfma_f32_16x16x32_bf16 v[76:79],a[180:183],v[244:247],v[76:79]
ds_read_b128 v[240:243],v17 offset:41984
s_waitcnt lgkmcnt(5)
v_mfma_f32_16x16x32_bf16 v[68:71],a[56:59],v[248:251],v[68:71]
v_min3_u32 v27,v27,v248,v252
v_lshlrev_b32 v88,16,v96
v_mfma_f32_16x16x32_bf16 v[76:79],a[184:187],v[248:251],v[76:79]
ds_read_b128 v[244:247],v17 offset:44032
v_and_b32 v89,s80,v96
v_mfma_f32_16x16x32_bf16 v[68:71],a[60:63],v[252:255],v[68:71]
v_lshlrev_b32 v90,16,v97
v_and_b32 v91,s80,v97
v_mfma_f32_16x16x32_bf16 v[76:79],a[188:191],v[252:255],v[76:79]
ds_read_b128 v[248:251],v17 offset:46080
s_waitcnt lgkmcnt(5)
v_mfma_f32_16x16x32_bf16 v[68:71],a[64:67],v[224:227],v[68:71]
v_min3_u32 v27,v27,v224,v228
v_lshlrev_b32 v92,16,v98
v_mfma_f32_16x16x32_bf16 v[76:79],a[192:195],v[224:227],v[76:79]
ds_read_b128 v[252:255],v17 offset:48128
v_and_b32 v93,s80,v98
v_mfma_f32_16x16x32_bf16 v[68:71],a[68:71],v[228:231],v[68:71]
v_lshlrev_b32 v94,16,v99
v_and_b32 v95,s80,v99
v_mfma_f32_16x16x32_bf16 v[76:79],a[196:199],v[228:231],v[76:79]
ds_read_b128 v[224:227],v17 offset:50176
s_waitcnt lgkmcnt(5)
v_mfma_f32_16x16x32_bf16 v[68:71],a[72:75],v[232:235],v[68:71]
v_min3_u32 v27,v27,v232,v236
v_add_f32 v108,v88,v89
v_mfma_f32_16x16x32_bf16 v[76:79],a[200:203],v[232:235],v[76:79]
ds_read_b128 v[228:231],v17 offset:52224
v_mul_f32 v109,v88,v88
v_mfma_f32_16x16x32_bf16 v[68:71],a[76:79],v[236:239],v[68:71]
v_add_f32 v100,v90,v91
v_mul_f32 v101,v89,v89
v_mfma_f32_16x16x32_bf16 v[76:79],a[204:207],v[236:239],v[76:79]
ds_read_b128 v[232:235],v17 offset:54272
s_waitcnt lgkmcnt(5)
v_mfma_f32_16x16x32_bf16 v[68:71],a[80:83],v[240:243],v[68:71]
v_min3_u32 v27,v27,v240,v244
v_fmac_f32 v109,v90,v90
v_mfma_f32_16x16x32_bf16 v[76:79],a[208:211],v[240:243],v[76:79]
ds_read_b128 v[236:239],v17 offset:56320
v_fmac_f32 v101,v91,v91
v_mfma_f32_16x16x32_bf16 v[68:71],a[84:87],v[244:247],v[68:71]
v_fmac_f32 v109,v92,v92
v_fmac_f32 v101,v93,v93
v_mfma_f32_16x16x32_bf16 v[76:79],a[212:215],v[244:247],v[76:79]
ds_read_b128 v[240:243],v17 offset:58368
s_waitcnt lgkmcnt(5)
v_mfma_f32_16x16x32_bf16 v[68:71],a[88:91],v[248:251],v[68:71]
v_min3_u32 v27,v27,v248,v252
v_add_f32 v108,v108,v92
v_mfma_f32_16x16x32_bf16 v[76:79],a[216:219],v[248:251],v[76:79]
ds_read_b128 v[244:247],v17 offset:60416
v_add_f32 v100,v100,v93
v_mfma_f32_16x16x32_bf16 v[68:71],a[92:95],v[252:255],v[68:71]
v_fmac_f32 v109,v94,v94
v_fmac_f32 v101,v95,v95
v_mfma_f32_16x16x32_bf16 v[76:79],a[220:223],v[252:255],v[76:79]
ds_read_b128 v[248:251],v17 offset:62464
s_waitcnt lgkmcnt(5)
v_mfma_f32_16x16x32_bf16 v[68:71],a[96:99],v[224:227],v[68:71]
v_min3_u32 v27,v27,v224,v228
v_add_f32 v108,v108,v94
v_mfma_f32_16x16x32_bf16 v[76:79],a[224:227],v[224:227],v[76:79]
ds_read_b128 v[252:255],v17 offset:64512
v_add_f32 v100,v100,v95
v_mfma_f32_16x16x32_bf16 v[68:71],a[100:103],v[228:231],v[68:71]
v_add_f32 v108,v108,v100
v_add_f32 v109,v109,v101
v_mfma_f32_16x16x32_bf16 v[76:79],a[228:231],v[228:231],v[76:79]
v_mov_b32 v100,v108
s_waitcnt lgkmcnt(4)
v_mfma_f32_16x16x32_bf16 v[68:71],a[104:107],v[232:235],v[68:71]
v_min3_u32 v27,v27,v232,v236
v_mov_b32 v101,v109
v_mfma_f32_16x16x32_bf16 v[76:79],a[232:235],v[232:235],v[76:79]
v_permlane16_swap_b32 v100,v108
v_permlane16_swap_b32 v101,v109
v_mfma_f32_16x16x32_bf16 v[68:71],a[108:111],v[236:239],v[68:71]
v_add_f32 v108,v108,v100
v_add_f32 v109,v109,v101
v_mfma_f32_16x16x32_bf16 v[76:79],a[236:239],v[236:239],v[76:79]
v_mov_b32 v100,v108
s_waitcnt lgkmcnt(2)
v_mfma_f32_16x16x32_bf16 v[68:71],a[112:115],v[240:243],v[68:71]
v_min3_u32 v27,v27,v240,v244
v_mov_b32 v101,v109
v_mfma_f32_16x16x32_bf16 v[76:79],a[240:243],v[240:243],v[76:79]
v_permlane32_swap_b32 v100,v108
v_permlane32_swap_b32 v101,v109
v_mfma_f32_16x16x32_bf16 v[68:71],a[116:119],v[244:247],v[68:71]
v_add_f32 v108,v108,v100
v_add_f32 v109,v109,v101
v_mfma_f32_16x16x32_bf16 v[76:79],a[244:247],v[244:247],v[76:79]
v_lshlrev_b32 v32,16,v124
s_waitcnt lgkmcnt(0)
v_mfma_f32_16x16x32_bf16 v[68:71],a[120:123],v[248:251],v[68:71]
v_min3_u32 v27,v27,v248,v252
v_and_b32 v33,s80,v124
v_mfma_f32_16x16x32_bf16 v[76:79],a[248:251],v[248:251],v[76:79]
v_lshlrev_b32 v34,16,v125
v_and_b32 v35,s80,v125
v_mfma_f32_16x16x32_bf16 v[68:71],a[124:127],v[252:255],v[68:71]
v_lshlrev_b32 v36,16,v126
v_and_b32 v37,s80,v126
v_mfma_f32_16x16x32_bf16 v[76:79],a[252:255],v[252:255],v[76:79]
v_lshlrev_b32 v38,16,v127
v_and_b32 v39,s80,v127
v_cmp_eq_u32 vcc,0,v27
s_cbranch_vccnz retry_234
s_branch epi_237
both_238:
s_waitcnt vmcnt(12) lgkmcnt(0)
s_barrier
ds_read_b128 v[224:227],v17 offset:0
ds_read_b128 v[228:231],v17 offset:2048
ds_read_b128 v[232:235],v17 offset:4096
ds_read_b128 v[236:239],v17 offset:6144
ds_read_b128 v[240:243],v17 offset:8192
ds_read_b128 v[244:247],v17 offset:10240
ds_read_b128 v[248:251],v17 offset:12288
s_waitcnt lgkmcnt(5)
v_mfma_f32_16x16x32_bf16 v[64:67],a[0:3],v[224:227],0
s_add_u32 s96,s71,1
s_add_u32 s92,s71,2
v_min_u32 v27,v224,v228
s_add_u32 m0,s43,0
v_mfma_f32_16x16x32_bf16 v[72:75],a[128:131],v[224:227],0
ds_read_b128 v[252:255],v17 offset:14336
s_add_u32 s88,s70,s75
buffer_load_dwordx4 v19,s[20:23],s78 offen sc1 lds
v_mfma_f32_16x16x32_bf16 v[64:67],a[4:7],v[228:231],v[64:67]
s_cmp_eq_u32 s96,65
s_cselect_b32 s96,64,s96
s_add_u32 m0,s43,1024
v_mfma_f32_16x16x32_bf16 v[72:75],a[132:135],v[228:231],v[72:75]
ds_read_b128 v[224:227],v17 offset:16384
buffer_load_dwordx4 v20,s[20:23],s78 offen sc1 lds
s_waitcnt lgkmcnt(5)
v_mfma_f32_16x16x32_bf16 v[64:67],a[8:11],v[232:235],v[64:67]
s_add_u32 s88,s88,2097152
s_xor_b32 s88,s88,0x2000
v_mfma_f32_16x16x32_bf16 v[72:75],a[136:139],v[232:235],v[72:75]
ds_read_b128 v[228:231],v17 offset:18432
s_xor_b32 s89,s88,1024
v_mfma_f32_16x16x32_bf16 v[64:67],a[12:15],v[236:239],v[64:67]
s_xor_b32 m0,s72,0
v_min3_u32 v27,v27,v232,v236
v_mfma_f32_16x16x32_bf16 v[72:75],a[140:143],v[236:239],v[72:75]
ds_read_b128 v[232:235],v17 offset:20480
s_add_u32 s65,s88,0
s_waitcnt lgkmcnt(5)
v_mfma_f32_16x16x32_bf16 v[64:67],a[16:19],v[240:243],v[64:67]
v_min3_u32 v27,v27,v240,v244
v_mfma_f32_16x16x32_bf16 v[72:75],a[144:147],v[240:243],v[72:75]
ds_read_b128 v[236:239],v17 offset:22528
buffer_load_dwordx4 v16,s[20:23],s65 offen offset:0 sc1 lds
v_mfma_f32_16x16x32_bf16 v[64:67],a[20:23],v[244:247],v[64:67]
buffer_load_dwordx4 v16,s[20:23],s65 offen offset:2048 sc1 lds
v_mfma_f32_16x16x32_bf16 v[72:75],a[148:151],v[244:247],v[72:75]
ds_read_b128 v[240:243],v17 offset:24576
s_waitcnt lgkmcnt(5)
v_mfma_f32_16x16x32_bf16 v[64:67],a[24:27],v[248:251],v[64:67]
s_xor_b32 m0,s72,16384
v_min3_u32 v27,v27,v248,v252
v_mfma_f32_16x16x32_bf16 v[72:75],a[152:155],v[248:251],v[72:75]
ds_read_b128 v[244:247],v17 offset:26624
v_mfma_f32_16x16x32_bf16 v[64:67],a[28:31],v[252:255],v[64:67]
s_add_u32 s65,s88,32768
v_mfma_f32_16x16x32_bf16 v[72:75],a[156:159],v[252:255],v[72:75]
ds_read_b128 v[248:251],v17 offset:28672
s_waitcnt lgkmcnt(5)
v_mfma_f32_16x16x32_bf16 v[64:67],a[32:35],v[224:227],v[64:67]
buffer_load_dwordx4 v16,s[20:23],s65 offen offset:0 sc1 lds
v_mfma_f32_16x16x32_bf16 v[72:75],a[160:163],v[224:227],v[72:75]
ds_read_b128 v[252:255],v17 offset:30720
buffer_load_dwordx4 v16,s[20:23],s65 offen offset:2048 sc1 lds
v_mfma_f32_16x16x32_bf16 v[64:67],a[36:39],v[228:231],v[64:67]
v_min3_u32 v27,v27,v224,v228
v_mfma_f32_16x16x32_bf16 v[72:75],a[164:167],v[228:231],v[72:75]
ds_read_b128 v[224:227],v17 offset:32768
s_xor_b32 m0,s72,32768
s_waitcnt lgkmcnt(5)
v_mfma_f32_16x16x32_bf16 v[64:67],a[40:43],v[232:235],v[64:67]
s_add_u32 s65,s88,65536
v_min3_u32 v27,v27,v232,v236
v_mfma_f32_16x16x32_bf16 v[72:75],a[168:171],v[232:235],v[72:75]
ds_read_b128 v[228:231],v17 offset:34816
v_mfma_f32_16x16x32_bf16 v[64:67],a[44:47],v[236:239],v[64:67]
buffer_load_dwordx4 v16,s[20:23],s65 offen offset:0 sc1 lds
v_mfma_f32_16x16x32_bf16 v[72:75],a[172:175],v[236:239],v[72:75]
ds_read_b128 v[232:235],v17 offset:36864
s_waitcnt lgkmcnt(5)
v_mfma_f32_16x16x32_bf16 v[64:67],a[48:51],v[240:243],v[64:67]
buffer_load_dwordx4 v16,s[20:23],s65 offen offset:2048 sc1 lds
v_mfma_f32_16x16x32_bf16 v[72:75],a[176:179],v[240:243],v[72:75]
ds_read_b128 v[236:239],v17 offset:38912
s_xor_b32 m0,s72,49152
v_mfma_f32_16x16x32_bf16 v[64:67],a[52:55],v[244:247],v[64:67]
v_min3_u32 v27,v27,v240,v244
v_mfma_f32_16x16x32_bf16 v[72:75],a[180:183],v[244:247],v[72:75]
ds_read_b128 v[240:243],v17 offset:40960
s_add_u32 s65,s88,98304
s_waitcnt lgkmcnt(5)
v_mfma_f32_16x16x32_bf16 v[64:67],a[56:59],v[248:251],v[64:67]
buffer_load_dwordx4 v16,s[20:23],s65 offen offset:0 sc1 lds
v_min3_u32 v27,v27,v248,v252
v_mfma_f32_16x16x32_bf16 v[72:75],a[184:187],v[248:251],v[72:75]
ds_read_b128 v[244:247],v17 offset:43008
s_waitcnt vmcnt(12)
v_mfma_f32_16x16x32_bf16 v[64:67],a[60:63],v[252:255],v[64:67]
v_cmp_gt_u32 vcc,s96,v29
v_cmp_gt_u32 s[92:93],s92,v29
v_mfma_f32_16x16x32_bf16 v[72:75],a[188:191],v[252:255],v[72:75]
ds_read_b128 v[248:251],v17 offset:45056
s_waitcnt lgkmcnt(5)
v_mfma_f32_16x16x32_bf16 v[64:67],a[64:67],v[224:227],v[64:67]
v_mov_b32 v44,vcc_lo
v_mov_b32 v45,s92
v_min3_u32 v27,v27,v224,v228
v_mfma_f32_16x16x32_bf16 v[72:75],a[192:195],v[224:227],v[72:75]
ds_read_b128 v[252:255],v17 offset:47104
ds_write_b64 v46,v[44:45]
v_mfma_f32_16x16x32_bf16 v[64:67],a[68:71],v[228:231],v[64:67]
buffer_load_dwordx4 v16,s[20:23],s65 offen offset:2048 sc1 lds
v_mfma_f32_16x16x32_bf16 v[72:75],a[196:199],v[228:231],v[72:75]
ds_read_b128 v[224:227],v17 offset:49152
s_waitcnt lgkmcnt(6)
v_mfma_f32_16x16x32_bf16 v[64:67],a[72:75],v[232:235],v[64:67]
s_xor_b32 m0,s72,1024
s_add_u32 s65,s89,0
v_mfma_f32_16x16x32_bf16 v[72:75],a[200:203],v[232:235],v[72:75]
ds_read_b128 v[228:231],v17 offset:51200
v_min3_u32 v27,v27,v232,v236
v_mfma_f32_16x16x32_bf16 v[64:67],a[76:79],v[236:239],v[64:67]
buffer_load_dwordx4 v16,s[20:23],s65 offen offset:0 sc1 lds
v_mfma_f32_16x16x32_bf16 v[72:75],a[204:207],v[236:239],v[72:75]
ds_read_b128 v[232:235],v17 offset:53248
s_waitcnt lgkmcnt(6)
v_mfma_f32_16x16x32_bf16 v[64:67],a[80:83],v[240:243],v[64:67]
buffer_load_dwordx4 v16,s[20:23],s65 offen offset:2048 sc1 lds
v_mfma_f32_16x16x32_bf16 v[72:75],a[208:211],v[240:243],v[72:75]
ds_read_b128 v[236:239],v17 offset:55296
s_xor_b32 m0,s72,17408
v_mfma_f32_16x16x32_bf16 v[64:67],a[84:87],v[244:247],v[64:67]
s_add_u32 s65,s89,32768
v_min3_u32 v27,v27,v240,v244
v_mfma_f32_16x16x32_bf16 v[72:75],a[212:215],v[244:247],v[72:75]
ds_read_b128 v[240:243],v17 offset:57344
s_waitcnt lgkmcnt(6)
v_mfma_f32_16x16x32_bf16 v[64:67],a[88:91],v[248:251],v[64:67]
buffer_load_dwordx4 v16,s[20:23],s65 offen offset:0 sc1 lds
v_mfma_f32_16x16x32_bf16 v[72:75],a[216:219],v[248:251],v[72:75]
ds_read_b128 v[244:247],v17 offset:59392
v_min3_u32 v27,v27,v248,v252
v_mfma_f32_16x16x32_bf16 v[64:67],a[92:95],v[252:255],v[64:67]
buffer_load_dwordx4 v16,s[20:23],s65 offen offset:2048 sc1 lds
v_mfma_f32_16x16x32_bf16 v[72:75],a[220:223],v[252:255],v[72:75]
ds_read_b128 v[248:251],v17 offset:61440
s_waitcnt lgkmcnt(5)
v_mfma_f32_16x16x32_bf16 v[64:67],a[96:99],v[224:227],v[64:67]
s_xor_b32 m0,s72,33792
s_add_u32 s65,s89,65536
v_mfma_f32_16x16x32_bf16 v[72:75],a[224:227],v[224:227],v[72:75]
ds_read_b128 v[252:255],v17 offset:63488
v_min3_u32 v27,v27,v224,v228
v_mfma_f32_16x16x32_bf16 v[64:67],a[100:103],v[228:231],v[64:67]
buffer_load_dwordx4 v16,s[20:23],s65 offen offset:0 sc1 lds
s_waitcnt vmcnt(15)
v_add_u32 v22,s71,-1
v_mfma_f32_16x16x32_bf16 v[72:75],a[228:231],v[228:231],v[72:75]
s_waitcnt vmcnt(19)
s_barrier
ds_read_b64 v[44:45],v47
ds_read_b128 v[224:227],v17 offset:1024
s_waitcnt lgkmcnt(6)
v_mfma_f32_16x16x32_bf16 v[64:67],a[104:107],v[232:235],v[64:67]
buffer_load_dwordx4 v16,s[20:23],s65 offen offset:2048 sc1 lds
buffer_store_dword v22,v23,s[20:23],s97 offen sc1
v_mfma_f32_16x16x32_bf16 v[72:75],a[232:235],v[232:235],v[72:75]
ds_read_b128 v[228:231],v17 offset:3072
s_xor_b32 m0,s72,50176
s_mov_b32 s97,0x7fff0000
v_mfma_f32_16x16x32_bf16 v[64:67],a[108:111],v[236:239],v[64:67]
s_add_u32 s65,s89,98304
v_min3_u32 v27,v27,v232,v236
s_waitcnt vmcnt(15)
v_mfma_f32_16x16x32_bf16 v[72:75],a[236:239],v[236:239],v[72:75]
ds_read_b128 v[232:235],v17 offset:5120
ds_read_b64 v[120:121],v40 offset:0
s_waitcnt lgkmcnt(7)
v_mfma_f32_16x16x32_bf16 v[64:67],a[112:115],v[240:243],v[64:67]
buffer_load_dwordx4 v16,s[20:23],s65 offen offset:0 sc1 lds
ds_read_b64 v[122:123],v41 offset:0
v_mfma_f32_16x16x32_bf16 v[72:75],a[240:243],v[240:243],v[72:75]
ds_read_b128 v[236:239],v17 offset:7168
v_min3_u32 v27,v27,v240,v244
v_mfma_f32_16x16x32_bf16 v[64:67],a[116:119],v[244:247],v[64:67]
buffer_load_dwordx4 v16,s[20:23],s65 offen offset:2048 sc1 lds
v_mfma_f32_16x16x32_bf16 v[72:75],a[244:247],v[244:247],v[72:75]
ds_read_b128 v[240:243],v17 offset:9216
s_waitcnt lgkmcnt(8)
v_mfma_f32_16x16x32_bf16 v[64:67],a[120:123],v[248:251],v[64:67]
s_waitcnt lgkmcnt(7)
v_readfirstlane_b32 s93,v45
v_mfma_f32_16x16x32_bf16 v[72:75],a[248:251],v[248:251],v[72:75]
ds_read_b128 v[244:247],v17 offset:11264
v_min3_u32 v27,v27,v248,v252
v_mfma_f32_16x16x32_bf16 v[64:67],a[124:127],v[252:255],v[64:67]
ds_read_b64 v[124:125],v40 offset:1024
ds_read_b64 v[126:127],v41 offset:1024
v_mfma_f32_16x16x32_bf16 v[72:75],a[252:255],v[252:255],v[72:75]
ds_read_b128 v[248:251],v17 offset:13312
s_waitcnt lgkmcnt(9)
v_mfma_f32_16x16x32_bf16 v[68:71],a[0:3],v[224:227],0
v_cmp_eq_u32 vcc,0,v27
s_cbranch_vccnz retry_234
v_mfma_f32_16x16x32_bf16 v[76:79],a[128:131],v[224:227],0
ds_read_b128 v[252:255],v17 offset:15360
v_min3_u32 v27,v27,v224,v228
v_mfma_f32_16x16x32_bf16 v[68:71],a[4:7],v[228:231],v[68:71]
v_mfma_f32_16x16x32_bf16 v[76:79],a[132:135],v[228:231],v[76:79]
ds_read_b128 v[224:227],v17 offset:17408
s_waitcnt lgkmcnt(7)
v_mfma_f32_16x16x32_bf16 v[68:71],a[8:11],v[232:235],v[68:71]
v_min3_u32 v27,v27,v232,v236
s_waitcnt lgkmcnt(3)
v_mfma_f32_16x16x32_bf16 v[76:79],a[136:139],v[232:235],v[76:79]
ds_read_b128 v[228:231],v17 offset:19456
v_lshlrev_b32 v88,16,v120
v_mfma_f32_16x16x32_bf16 v[68:71],a[12:15],v[236:239],v[68:71]
v_and_b32 v89,s80,v120
v_lshlrev_b32 v90,16,v121
v_mfma_f32_16x16x32_bf16 v[76:79],a[140:143],v[236:239],v[76:79]
ds_read_b128 v[232:235],v17 offset:21504
v_mfma_f32_16x16x32_bf16 v[68:71],a[16:19],v[240:243],v[68:71]
v_min3_u32 v27,v27,v240,v244
v_and_b32 v91,s80,v121
v_mfma_f32_16x16x32_bf16 v[76:79],a[144:147],v[240:243],v[76:79]
ds_read_b128 v[236:239],v17 offset:23552
v_lshlrev_b32 v92,16,v122
v_mfma_f32_16x16x32_bf16 v[68:71],a[20:23],v[244:247],v[68:71]
v_and_b32 v93,s80,v122
v_lshlrev_b32 v94,16,v123
v_mfma_f32_16x16x32_bf16 v[76:79],a[148:151],v[244:247],v[76:79]
ds_read_b128 v[240:243],v17 offset:25600
s_waitcnt lgkmcnt(5)
v_mfma_f32_16x16x32_bf16 v[68:71],a[24:27],v[248:251],v[68:71]
v_min3_u32 v27,v27,v248,v252
v_and_b32 v95,s80,v123
v_mfma_f32_16x16x32_bf16 v[76:79],a[152:155],v[248:251],v[76:79]
ds_read_b128 v[244:247],v17 offset:27648
v_add_f32 v88,v64,v88
v_mfma_f32_16x16x32_bf16 v[68:71],a[28:31],v[252:255],v[68:71]
v_add_f32 v89,v65,v89
v_add_f32 v90,v66,v90
v_mfma_f32_16x16x32_bf16 v[76:79],a[156:159],v[252:255],v[76:79]
ds_read_b128 v[248:251],v17 offset:29696
s_waitcnt lgkmcnt(5)
v_mfma_f32_16x16x32_bf16 v[68:71],a[32:35],v[224:227],v[68:71]
v_min3_u32 v27,v27,v224,v228
v_add_f32 v91,v67,v91
v_mfma_f32_16x16x32_bf16 v[76:79],a[160:163],v[224:227],v[76:79]
ds_read_b128 v[252:255],v17 offset:31744
v_add_f32 v92,v72,v92
v_mfma_f32_16x16x32_bf16 v[68:71],a[36:39],v[228:231],v[68:71]
v_add_f32 v93,v73,v93
v_add_f32 v94,v74,v94
v_mfma_f32_16x16x32_bf16 v[76:79],a[164:167],v[228:231],v[76:79]
ds_read_b128 v[224:227],v17 offset:33792
s_waitcnt lgkmcnt(5)
v_mfma_f32_16x16x32_bf16 v[68:71],a[40:43],v[232:235],v[68:71]
v_min3_u32 v27,v27,v232,v236
v_add_f32 v95,v75,v95
v_mfma_f32_16x16x32_bf16 v[76:79],a[168:171],v[232:235],v[76:79]
ds_read_b128 v[228:231],v17 offset:35840
v_cvt_pk_bf16_f32 v96,v88,v89
v_mfma_f32_16x16x32_bf16 v[68:71],a[44:47],v[236:239],v[68:71]
v_cvt_pk_bf16_f32 v97,v90,v91
v_cvt_pk_bf16_f32 v98,v92,v93
v_mfma_f32_16x16x32_bf16 v[76:79],a[172:175],v[236:239],v[76:79]
ds_read_b128 v[232:235],v17 offset:37888
s_waitcnt lgkmcnt(5)
v_mfma_f32_16x16x32_bf16 v[68:71],a[48:51],v[240:243],v[68:71]
v_min3_u32 v27,v27,v240,v244
v_cvt_pk_bf16_f32 v99,v94,v95
v_mfma_f32_16x16x32_bf16 v[76:79],a[176:179],v[240:243],v[76:79]
ds_read_b128 v[236:239],v17 offset:39936
v_max_u32 v96,1,v96
v_mfma_f32_16x16x32_bf16 v[68:71],a[52:55],v[244:247],v[68:71]
buffer_store_dwordx4 v[96:99],v18,s[20:23],s70 offen offset:0 sc1
v_mfma_f32_16x16x32_bf16 v[76:79],a[180:183],v[244:247],v[76:79]
ds_read_b128 v[240:243],v17 offset:41984
s_waitcnt lgkmcnt(5)
v_mfma_f32_16x16x32_bf16 v[68:71],a[56:59],v[248:251],v[68:71]
v_min3_u32 v27,v27,v248,v252
v_lshlrev_b32 v88,16,v96
v_mfma_f32_16x16x32_bf16 v[76:79],a[184:187],v[248:251],v[76:79]
ds_read_b128 v[244:247],v17 offset:44032
v_and_b32 v89,s80,v96
v_mfma_f32_16x16x32_bf16 v[68:71],a[60:63],v[252:255],v[68:71]
v_lshlrev_b32 v90,16,v97
v_and_b32 v91,s80,v97
v_mfma_f32_16x16x32_bf16 v[76:79],a[188:191],v[252:255],v[76:79]
ds_read_b128 v[248:251],v17 offset:46080
s_waitcnt lgkmcnt(5)
v_mfma_f32_16x16x32_bf16 v[68:71],a[64:67],v[224:227],v[68:71]
v_min3_u32 v27,v27,v224,v228
v_lshlrev_b32 v92,16,v98
v_mfma_f32_16x16x32_bf16 v[76:79],a[192:195],v[224:227],v[76:79]
ds_read_b128 v[252:255],v17 offset:48128
v_and_b32 v93,s80,v98
v_mfma_f32_16x16x32_bf16 v[68:71],a[68:71],v[228:231],v[68:71]
v_lshlrev_b32 v94,16,v99
v_and_b32 v95,s80,v99
v_mfma_f32_16x16x32_bf16 v[76:79],a[196:199],v[228:231],v[76:79]
ds_read_b128 v[224:227],v17 offset:50176
s_waitcnt lgkmcnt(5)
v_mfma_f32_16x16x32_bf16 v[68:71],a[72:75],v[232:235],v[68:71]
v_min3_u32 v27,v27,v232,v236
v_add_f32 v108,v88,v89
v_mfma_f32_16x16x32_bf16 v[76:79],a[200:203],v[232:235],v[76:79]
ds_read_b128 v[228:231],v17 offset:52224
v_mul_f32 v109,v88,v88
v_mfma_f32_16x16x32_bf16 v[68:71],a[76:79],v[236:239],v[68:71]
v_add_f32 v100,v90,v91
v_mul_f32 v101,v89,v89
v_mfma_f32_16x16x32_bf16 v[76:79],a[204:207],v[236:239],v[76:79]
ds_read_b128 v[232:235],v17 offset:54272
s_waitcnt lgkmcnt(5)
v_mfma_f32_16x16x32_bf16 v[68:71],a[80:83],v[240:243],v[68:71]
v_min3_u32 v27,v27,v240,v244
v_fmac_f32 v109,v90,v90
v_mfma_f32_16x16x32_bf16 v[76:79],a[208:211],v[240:243],v[76:79]
ds_read_b128 v[236:239],v17 offset:56320
v_fmac_f32 v101,v91,v91
v_mfma_f32_16x16x32_bf16 v[68:71],a[84:87],v[244:247],v[68:71]
v_fmac_f32 v109,v92,v92
v_fmac_f32 v101,v93,v93
v_mfma_f32_16x16x32_bf16 v[76:79],a[212:215],v[244:247],v[76:79]
ds_read_b128 v[240:243],v17 offset:58368
s_waitcnt lgkmcnt(5)
v_mfma_f32_16x16x32_bf16 v[68:71],a[88:91],v[248:251],v[68:71]
v_min3_u32 v27,v27,v248,v252
v_add_f32 v108,v108,v92
v_mfma_f32_16x16x32_bf16 v[76:79],a[216:219],v[248:251],v[76:79]
ds_read_b128 v[244:247],v17 offset:60416
v_add_f32 v100,v100,v93
v_mfma_f32_16x16x32_bf16 v[68:71],a[92:95],v[252:255],v[68:71]
v_fmac_f32 v109,v94,v94
v_fmac_f32 v101,v95,v95
v_mfma_f32_16x16x32_bf16 v[76:79],a[220:223],v[252:255],v[76:79]
ds_read_b128 v[248:251],v17 offset:62464
s_waitcnt lgkmcnt(5)
v_mfma_f32_16x16x32_bf16 v[68:71],a[96:99],v[224:227],v[68:71]
v_min3_u32 v27,v27,v224,v228
v_add_f32 v108,v108,v94
v_mfma_f32_16x16x32_bf16 v[76:79],a[224:227],v[224:227],v[76:79]
ds_read_b128 v[252:255],v17 offset:64512
v_add_f32 v100,v100,v95
v_mfma_f32_16x16x32_bf16 v[68:71],a[100:103],v[228:231],v[68:71]
v_add_f32 v108,v108,v100
v_add_f32 v109,v109,v101
v_mfma_f32_16x16x32_bf16 v[76:79],a[228:231],v[228:231],v[76:79]
v_mov_b32 v100,v108
s_waitcnt lgkmcnt(4)
v_mfma_f32_16x16x32_bf16 v[68:71],a[104:107],v[232:235],v[68:71]
v_min3_u32 v27,v27,v232,v236
v_mov_b32 v101,v109
v_mfma_f32_16x16x32_bf16 v[76:79],a[232:235],v[232:235],v[76:79]
v_permlane16_swap_b32 v100,v108
v_permlane16_swap_b32 v101,v109
v_mfma_f32_16x16x32_bf16 v[68:71],a[108:111],v[236:239],v[68:71]
v_add_f32 v108,v108,v100
v_add_f32 v109,v109,v101
v_mfma_f32_16x16x32_bf16 v[76:79],a[236:239],v[236:239],v[76:79]
v_mov_b32 v100,v108
s_waitcnt lgkmcnt(2)
v_mfma_f32_16x16x32_bf16 v[68:71],a[112:115],v[240:243],v[68:71]
v_min3_u32 v27,v27,v240,v244
v_mov_b32 v101,v109
v_mfma_f32_16x16x32_bf16 v[76:79],a[240:243],v[240:243],v[76:79]
v_permlane32_swap_b32 v100,v108
v_permlane32_swap_b32 v101,v109
v_mfma_f32_16x16x32_bf16 v[68:71],a[116:119],v[244:247],v[68:71]
v_add_f32 v108,v108,v100
v_add_f32 v109,v109,v101
v_mfma_f32_16x16x32_bf16 v[76:79],a[244:247],v[244:247],v[76:79]
v_lshlrev_b32 v32,16,v124
s_waitcnt lgkmcnt(0)
v_mfma_f32_16x16x32_bf16 v[68:71],a[120:123],v[248:251],v[68:71]
v_min3_u32 v27,v27,v248,v252
v_and_b32 v33,s80,v124
v_mfma_f32_16x16x32_bf16 v[76:79],a[248:251],v[248:251],v[76:79]
v_lshlrev_b32 v34,16,v125
v_and_b32 v35,s80,v125
v_mfma_f32_16x16x32_bf16 v[68:71],a[124:127],v[252:255],v[68:71]
v_lshlrev_b32 v36,16,v126
v_and_b32 v37,s80,v126
v_mfma_f32_16x16x32_bf16 v[76:79],a[252:255],v[252:255],v[76:79]
v_lshlrev_b32 v38,16,v127
v_and_b32 v39,s80,v127
v_cmp_eq_u32 vcc,0,v27
s_cbranch_vccnz retry_234
epi_237:
buffer_load_dword v29,v21,s[20:23],s87 offen sc1
s_cmp_gt_u32 s71,51
s_cselect_b32 s65,s73,0x7fff0000
s_cselect_b32 s97,0x7fff0000,s73
v_mov_b32 v22,s71
buffer_store_dword v22,v23,s[20:23],s65 offen sc1
v_pk_add_f32 v[88:89],v[68:69],v[32:33]
v_pk_add_f32 v[90:91],v[70:71],v[34:35]
v_pk_add_f32 v[92:93],v[76:77],v[36:37]
v_pk_add_f32 v[94:95],v[78:79],v[38:39]
v_cvt_pk_bf16_f32 v96,v88,v89
v_cvt_pk_bf16_f32 v97,v90,v91
v_cvt_pk_bf16_f32 v98,v92,v93
v_cvt_pk_bf16_f32 v99,v94,v95
v_max_u32 v96,1,v96
buffer_store_dwordx4 v[96:99],v18,s[20:23],s70 offen offset:1024 sc1
v_lshlrev_b32 v88,16,v96
v_and_b32 v89,s80,v96
v_lshlrev_b32 v90,16,v97
v_and_b32 v91,s80,v97
v_lshlrev_b32 v92,16,v98
v_and_b32 v93,s80,v98
v_lshlrev_b32 v94,16,v99
v_and_b32 v95,s80,v99
v_pk_mul_f32 v[102:103],v[88:89],v[88:89]
v_pk_add_f32 v[100:101],v[88:89],v[90:91]
v_pk_mul_f32 v[106:107],v[90:91],v[90:91]
v_pk_add_f32 v[104:105],v[92:93],v[94:95]
v_pk_fma_f32 v[102:103],v[92:93],v[92:93],v[102:103]
v_pk_fma_f32 v[106:107],v[94:95],v[94:95],v[106:107]
v_pk_add_f32 v[100:101],v[100:101],v[104:105]
v_pk_add_f32 v[102:103],v[102:103],v[106:107]
v_add_f32 v110,v100,v101
v_add_f32 v111,v102,v103
v_mov_b32 v100,v110
v_mov_b32 v101,v111
s_nop 0
v_permlane16_swap_b32 v100,v110
v_permlane16_swap_b32 v101,v111
v_add_f32 v110,v110,v100
v_add_f32 v111,v111,v101
v_mov_b32 v100,v110
v_mov_b32 v101,v111
s_nop 0
v_permlane32_swap_b32 v100,v110
v_permlane32_swap_b32 v101,v111
v_add_f32 v110,v110,v100
v_add_f32 v111,v111,v101
v_max_u32 v109,1,v109
buffer_store_dwordx4 v[108:111],v24,s[20:23],s70 offen sc1
v_xor_b32 v19,0x2000,v19
v_xor_b32 v20,0x2000,v20
s_add_u32 s78,s78,2097152
v_xor_b32 v17,0x10000,v17
s_xor_b32 s72,s72,0x10000
s_add_u32 s70,s70,2097152
s_xor_b32 s70,s70,0x2000
s_add_u32 s71,s71,1
s_cmp_le_u32 s71,s57
s_cbranch_scc1 seg_235
s_endpgm
retry_234:
s_sub_u32 s90,s90,64
s_cmp_lt_i32 s90,0
s_cbranch_scc1 giveup_195
s_mov_b32 s83,1
s_waitcnt vmcnt(0) lgkmcnt(0)
s_barrier
s_branch seg_235
r_at_217:
v_mov_b32 v128,0
v_mov_b32 v129,0
v_mov_b32 v130,0
v_mov_b32 v131,0
s_cmp_ge_u32 s50,2
s_cbranch_scc1 r_ln_216
v_and_b32 v21,1,v1
v_mul_u32_u24 v21,64,v21
s_mov_b32 s65,21052928
s_mov_b32 s66,1792
pl_246:
buffer_load_dword v22,v21,s[20:23],s65 offen sc1
s_waitcnt vmcnt(0)
v_cmp_gt_u32 vcc,s66,v22
s_cbranch_vccz pok_247
s_sleep 1
s_sub_u32 s90,s90,1
s_cmp_gt_i32 s90,0
s_cbranch_scc1 pl_246
pok_247:
s_lshl_b32 s41,s41,1
s_add_u32 s41,s41,s50
v_and_b32 v21,3,v1
v_lshlrev_b32 v21,7,v21
s_lshl_b32 s65,s41,2
s_add_u32 s87,s65,s63
v_mov_b32 v99,v21
pl_248:
buffer_load_dword v22,v21,s[20:23],s87 offen sc1
s_waitcnt vmcnt(0)
v_cmp_gt_u32 vcc,14,v22
s_cbranch_vccz pok_249
s_sleep 1
s_sub_u32 s90,s90,1
s_cmp_gt_i32 s90,0
s_cbranch_scc1 pl_248
pok_249:
v_mov_b32 v21,s56
v_lshlrev_b32 v21,2,v21
s_mov_b32 s66,128
pl_250:
buffer_load_dword v22,v21,s[44:47],36 offen sc1
s_waitcnt vmcnt(0)
v_cmp_gt_u32 vcc,s66,v22
s_cbranch_vccz pok_251
s_sleep 1
s_sub_u32 s90,s90,1
s_cmp_gt_i32 s90,0
s_cbranch_scc1 pl_250
pok_251:
s_lshl_b32 s42,s41,14
s_lshr_b32 s43,s41,1
s_lshl_b32 s43,s43,14
s_and_b32 s64,s41,1
s_lshl_b32 s64,s64,12
s_add_u32 s43,s43,s64
s_add_u32 s43,s43,1572864
s_lshl_b32 s73,s41,7
s_add_u32 s73,s73,s63
s_add_u32 s73,s73,16384
v_lshrrev_b32 v6,3,v3
v_and_b32 v7,7,v3
v_lshl_add_u32 v6,v6,4,v7
v_lshlrev_b32 v6,4,v6
v_and_b32 v7,1,v4
v_lshl_add_u32 v6,v7,3,v6
v_lshrrev_b32 v8,2,v3
v_and_b32 v9,3,v3
v_lshl_add_u32 v8,v8,3,v9
s_mov_b32 s80,0x3e0293ee
v_mov_b32 v97,0xff800000
v_lshlrev_b32 v98,3,v4
v_sub_u32 v98,v98,v8
v_cmp_lt_u32 s[48:49],1,v4
v_cmp_ge_i32 s[4:5],-7,v98
v_cmp_ge_i32 s[6:7],-6,v98
v_cmp_ge_i32 s[8:9],-5,v98
v_cmp_ge_i32 s[10:11],-4,v98
v_cmp_ge_i32 s[12:13],-3,v98
v_cmp_ge_i32 s[14:15],-2,v98
v_cmp_ge_i32 s[16:17],-1,v98
v_cmp_ge_i32 s[18:19],0,v98
v_cmp_ge_i32 s[32:33],1,v98
v_cmp_ge_i32 s[34:35],2,v98
v_cmp_ge_i32 s[36:37],3,v98
v_cmp_ge_i32 s[38:39],4,v98
s_add_u32 s64,s79,0
s_lshl_b32 s74,s64,21
s_lshl_b32 s64,s64,13
s_and_b32 s64,s64,0x2000
s_xor_b32 s64,s64,s61
s_add_u32 s74,s74,s64
s_add_u32 s74,s74,29360128
s_add_u32 s66,s74,s43
kp_252:
buffer_load_dwordx4 v[136:139],v16,s[20:23],s66 offen offset:0 sc1
buffer_load_dwordx4 v[140:143],v16,s[20:23],s66 offen offset:1024 sc1
buffer_load_dwordx4 v[144:147],v16,s[20:23],s66 offen offset:2048 sc1
buffer_load_dwordx4 v[148:151],v16,s[20:23],s66 offen offset:3072 sc1
s_waitcnt vmcnt(0)
kck_254:
v_min3_u32 v22,v136,v140,v144
v_min_u32 v22,v22,v148
v_cmp_eq_u32 vcc,0,v22
s_cbranch_vccz kok_253
s_sleep 1
s_sub_u32 s90,s90,1
s_cmp_gt_i32 s90,0
s_cbranch_scc1 kp_252
kok_253:
s_add_u32 s64,s79,0
s_lshl_b32 s75,s64,21
s_lshl_b32 s64,s64,13
s_and_b32 s64,s64,0x2000
s_xor_b32 s64,s64,s61
s_add_u32 s75,s75,s64
s_add_u32 s75,s75,29360128
s_add_u32 s64,s79,0
s_lshl_b32 s76,s64,21
s_lshl_b32 s64,s64,13
s_and_b32 s64,s64,0x2000
s_xor_b32 s64,s64,s62
s_add_u32 s76,s76,s64
s_add_u32 s76,s76,29360128
s_add_u32 s66,s75,s43
s_add_u32 s75,s75,s42
s_add_u32 s76,s76,s42
s_add_u32 s65,s75,524288
buffer_load_dwordx4 a[32:35],v16,s[20:23],s65 offen offset:0 sc1
buffer_load_dwordx4 a[36:39],v16,s[20:23],s65 offen offset:1024 sc1
buffer_load_dwordx4 a[40:43],v16,s[20:23],s65 offen offset:2048 sc1
buffer_load_dwordx4 a[44:47],v16,s[20:23],s65 offen offset:3072 sc1
s_add_u32 s65,s75,528384
buffer_load_dwordx4 a[48:51],v16,s[20:23],s65 offen offset:0 sc1
buffer_load_dwordx4 a[52:55],v16,s[20:23],s65 offen offset:1024 sc1
buffer_load_dwordx4 a[56:59],v16,s[20:23],s65 offen offset:2048 sc1
buffer_load_dwordx4 a[60:63],v16,s[20:23],s65 offen offset:3072 sc1
s_add_u32 s65,s76,0
buffer_load_dwordx4 a[0:3],v16,s[20:23],s65 offen offset:0 sc1
buffer_load_dwordx4 a[4:7],v16,s[20:23],s65 offen offset:1024 sc1
buffer_load_dwordx4 a[8:11],v16,s[20:23],s65 offen offset:2048 sc1
buffer_load_dwordx4 a[12:15],v16,s[20:23],s65 offen offset:3072 sc1
s_add_u32 s65,s76,4096
buffer_load_dwordx4 a[16:19],v16,s[20:23],s65 offen offset:0 sc1
buffer_load_dwordx4 a[20:23],v16,s[20:23],s65 offen offset:1024 sc1
buffer_load_dwordx4 a[24:27],v16,s[20:23],s65 offen offset:2048 sc1
buffer_load_dwordx4 a[28:31],v16,s[20:23],s65 offen offset:3072 sc1
buffer_load_dwordx4 v[136:139],v16,s[20:23],s66 offen offset:0 sc1
buffer_load_dwordx4 v[140:143],v16,s[20:23],s66 offen offset:1024 sc1
buffer_load_dwordx4 v[144:147],v16,s[20:23],s66 offen offset:2048 sc1
buffer_load_dwordx4 v[148:151],v16,s[20:23],s66 offen offset:3072 sc1
s_add_u32 s65,s75,1048576
buffer_load_dwordx4 a[64:67],v16,s[20:23],s65 offen offset:0 sc1
buffer_load_dwordx4 a[68:71],v16,s[20:23],s65 offen offset:1024 sc1
buffer_load_dwordx4 a[72:75],v16,s[20:23],s65 offen offset:2048 sc1
buffer_load_dwordx4 a[76:79],v16,s[20:23],s65 offen offset:3072 sc1
s_add_u32 s65,s75,1052672
buffer_load_dwordx4 a[80:83],v16,s[20:23],s65 offen offset:0 sc1
buffer_load_dwordx4 a[84:87],v16,s[20:23],s65 offen offset:1024 sc1
buffer_load_dwordx4 a[88:91],v16,s[20:23],s65 offen offset:2048 sc1
buffer_load_dwordx4 a[92:95],v16,s[20:23],s65 offen offset:3072 sc1
s_waitcnt vmcnt(0)
aloop_255:
s_add_u32 s64,s79,0
s_lshl_b32 s74,s64,21
s_lshl_b32 s64,s64,13
s_and_b32 s64,s64,0x2000
s_xor_b32 s64,s64,s61
s_add_u32 s74,s74,s64
s_add_u32 s74,s74,29360128
s_add_u32 s64,s79,0
s_lshl_b32 s70,s64,21
s_lshl_b32 s64,s64,13
s_and_b32 s64,s64,0x2000
s_xor_b32 s64,s64,s62
s_add_u32 s70,s70,s64
s_add_u32 s70,s70,29360128
s_cmp_gt_u32 s71,52
s_cselect_b32 s65,0x7fff0000,s73
s_waitcnt vmcnt(28)
v_add_u32 v22,s71,-1
buffer_store_dword v22,v23,s[20:23],s65 offen sc1
s_waitcnt vmcnt(13)
v_mfma_f32_16x16x32_bf16 v[168:171],a[32:35],a[0:3],0
v_mfma_f32_16x16x32_bf16 v[172:175],a[36:39],a[0:3],0
v_mfma_f32_16x16x32_bf16 v[180:183],a[32:35],a[4:7],0
v_mfma_f32_16x16x32_bf16 v[184:187],a[36:39],a[4:7],0
v_mfma_f32_16x16x32_bf16 v[168:171],a[40:43],a[8:11],v[168:171]
v_mfma_f32_16x16x32_bf16 v[172:175],a[44:47],a[8:11],v[172:175]
v_mfma_f32_16x16x32_bf16 v[180:183],a[40:43],a[12:15],v[180:183]
v_mfma_f32_16x16x32_bf16 v[184:187],a[44:47],a[12:15],v[184:187]
v_mfma_f32_16x16x32_bf16 v[168:171],a[48:51],a[16:19],v[168:171]
v_mfma_f32_16x16x32_bf16 v[172:175],a[52:55],a[16:19],v[172:175]
v_mfma_f32_16x16x32_bf16 v[180:183],a[48:51],a[20:23],v[180:183]
v_mfma_f32_16x16x32_bf16 v[184:187],a[52:55],a[20:23],v[184:187]
v_mfma_f32_16x16x32_bf16 v[168:171],a[56:59],a[24:27],v[168:171]
v_mfma_f32_16x16x32_bf16 v[172:175],a[60:63],a[24:27],v[172:175]
v_mfma_f32_16x16x32_bf16 v[180:183],a[56:59],a[28:31],v[180:183]
v_mfma_f32_16x16x32_bf16 v[184:187],a[60:63],a[28:31],v[184:187]
s_nop 4
v_cndmask_b32 v168,v97,v168,s[18:19]
s_nop 0
v_cndmask_b32 v180,v97,v180,s[38:39]
v_cndmask_b32 v169,v97,v169,s[16:17]
v_cndmask_b32 v181,v97,v181,s[36:37]
v_cndmask_b32 v170,v97,v170,s[14:15]
v_cndmask_b32 v182,v97,v182,s[34:35]
v_cndmask_b32 v171,v97,v171,s[12:13]
v_cndmask_b32 v183,v97,v183,s[32:33]
v_cndmask_b32 v172,v97,v172,s[10:11]
v_cndmask_b32 v184,v97,v184,s[18:19]
v_cndmask_b32 v173,v97,v173,s[8:9]
v_cndmask_b32 v185,v97,v185,s[16:17]
v_cndmask_b32 v174,v97,v174,s[6:7]
v_cndmask_b32 v186,v97,v186,s[14:15]
v_cndmask_b32 v175,v97,v175,s[4:5]
v_cndmask_b32 v187,v97,v187,s[12:13]
v_max3_f32 v116,v168,v169,v170
v_max3_f32 v122,v180,v181,v182
v_max3_f32 v118,v171,v172,v173
v_max3_f32 v124,v183,v184,v185
v_max3_f32 v116,v116,v174,v175
v_max3_f32 v122,v122,v186,v187
v_max_f32 v116,v116,v118
v_max_f32 v122,v122,v124
v_mov_b32 v118,v116
v_mov_b32 v124,v122
s_nop 0
v_permlane16_swap_b32 v118,v116
v_permlane16_swap_b32 v124,v122
v_max_f32 v116,v116,v118
v_max_f32 v122,v122,v124
v_mov_b32 v118,v116
v_mov_b32 v124,v122
s_nop 0
v_permlane32_swap_b32 v118,v116
v_permlane32_swap_b32 v124,v122
v_max_f32 v116,v116,v118
v_max_f32 v122,v122,v124
v_mul_f32 v116,s80,v116
v_mul_f32 v122,s80,v122
v_fma_f32 v168,v168,s80,-v116
v_fma_f32 v180,v180,s80,-v122
v_fma_f32 v169,v169,s80,-v116
v_fma_f32 v181,v181,s80,-v122
v_fma_f32 v170,v170,s80,-v116
v_fma_f32 v182,v182,s80,-v122
v_fma_f32 v171,v171,s80,-v116
v_fma_f32 v183,v183,s80,-v122
v_fma_f32 v172,v172,s80,-v116
v_fma_f32 v184,v184,s80,-v122
v_fma_f32 v173,v173,s80,-v116
v_fma_f32 v185,v185,s80,-v122
v_fma_f32 v174,v174,s80,-v116
v_fma_f32 v186,v186,s80,-v122
v_fma_f32 v175,v175,s80,-v116
v_fma_f32 v187,v187,s80,-v122
v_exp_f32 v168,v168
v_exp_f32 v180,v180
v_exp_f32 v169,v169
v_exp_f32 v181,v181
v_exp_f32 v170,v170
v_exp_f32 v182,v182
v_exp_f32 v171,v171
v_exp_f32 v183,v183
v_exp_f32 v172,v172
v_exp_f32 v184,v184
v_exp_f32 v173,v173
v_exp_f32 v185,v185
v_exp_f32 v174,v174
v_exp_f32 v186,v186
v_exp_f32 v175,v175
v_exp_f32 v187,v187
v_add_f32 v117,v168,v169
v_add_f32 v123,v180,v181
v_add_f32 v119,v170,v171
v_add_f32 v125,v182,v183
v_add_f32 v117,v117,v172
v_add_f32 v123,v123,v184
v_add_f32 v119,v119,v173
v_add_f32 v125,v125,v185
v_add_f32 v117,v117,v174
v_add_f32 v123,v123,v186
v_add_f32 v119,v119,v175
v_add_f32 v125,v125,v187
v_add_f32 v117,v117,v119
v_add_f32 v123,v123,v125
v_mov_b32 v118,v117
v_mov_b32 v124,v123
s_nop 0
v_permlane16_swap_b32 v118,v117
v_permlane16_swap_b32 v124,v123
v_add_f32 v117,v117,v118
v_add_f32 v123,v123,v124
v_mov_b32 v118,v117
v_mov_b32 v124,v123
s_nop 0
v_permlane32_swap_b32 v118,v117
v_permlane32_swap_b32 v124,v123
v_add_f32 v117,v117,v118
v_add_f32 v123,v123,v124
s_add_u32 s66,s74,s43
s_waitcnt vmcnt(9)
s_branch kck_258
kp_256:
buffer_load_dwordx4 v[136:139],v16,s[20:23],s66 offen offset:0 sc1
buffer_load_dwordx4 v[140:143],v16,s[20:23],s66 offen offset:1024 sc1
buffer_load_dwordx4 v[144:147],v16,s[20:23],s66 offen offset:2048 sc1
buffer_load_dwordx4 v[148:151],v16,s[20:23],s66 offen offset:3072 sc1
s_waitcnt vmcnt(0)
kck_258:
v_min3_u32 v22,v136,v140,v144
v_min_u32 v22,v22,v148
v_cmp_eq_u32 vcc,0,v22
s_cbranch_vccz kok_257
s_sleep 1
s_sub_u32 s90,s90,1
s_cmp_gt_i32 s90,0
s_cbranch_scc1 kp_256
kok_257:
buffer_load_dwordx2 v[100:101],v6,s[20:23],s66 offen offset:0 sc1
buffer_load_dwordx2 v[102:103],v6,s[20:23],s66 offen offset:512 sc1
buffer_load_dwordx2 v[104:105],v6,s[20:23],s66 offen offset:1024 sc1
buffer_load_dwordx2 v[106:107],v6,s[20:23],s66 offen offset:1536 sc1
buffer_load_dwordx2 v[108:109],v6,s[20:23],s66 offen offset:2048 sc1
buffer_load_dwordx2 v[110:111],v6,s[20:23],s66 offen offset:2560 sc1
buffer_load_dwordx2 v[112:113],v6,s[20:23],s66 offen offset:3072 sc1
buffer_load_dwordx2 v[114:115],v6,s[20:23],s66 offen offset:3584 sc1
v_mfma_f32_16x16x32_bf16 v[176:179],v[136:139],a[0:3],0
v_mfma_f32_16x16x32_bf16 v[188:191],v[136:139],a[4:7],0
v_mfma_f32_16x16x32_bf16 v[176:179],v[140:143],a[8:11],v[176:179]
v_mfma_f32_16x16x32_bf16 v[188:191],v[140:143],a[12:15],v[188:191]
v_mfma_f32_16x16x32_bf16 v[176:179],v[144:147],a[16:19],v[176:179]
v_mfma_f32_16x16x32_bf16 v[188:191],v[144:147],a[20:23],v[188:191]
v_mfma_f32_16x16x32_bf16 v[176:179],v[148:151],a[24:27],v[176:179]
v_mfma_f32_16x16x32_bf16 v[188:191],v[148:151],a[28:31],v[188:191]
s_nop 6
v_cndmask_b32 v176,v97,v176,s[48:49]
v_cndmask_b32 v188,v97,v188,s[48:49]
v_cndmask_b32 v177,v97,v177,s[48:49]
v_cndmask_b32 v189,v97,v189,s[48:49]
v_cndmask_b32 v178,v97,v178,s[48:49]
v_cndmask_b32 v190,v97,v190,s[48:49]
v_cndmask_b32 v179,v97,v179,s[48:49]
v_cndmask_b32 v191,v97,v191,s[48:49]
v_max3_f32 v119,v176,v177,v178
v_max3_f32 v125,v188,v189,v190
v_max_f32 v119,v119,v179
v_max_f32 v125,v125,v191
v_mov_b32 v118,v119
v_mov_b32 v124,v125
s_nop 0
v_permlane16_swap_b32 v118,v119
v_permlane16_swap_b32 v124,v125
v_max_f32 v119,v119,v118
v_max_f32 v125,v125,v124
v_mov_b32 v118,v119
v_mov_b32 v124,v125
s_nop 0
v_permlane32_swap_b32 v118,v119
v_permlane32_swap_b32 v124,v125
v_max_f32 v119,v119,v118
v_max_f32 v125,v125,v124
v_mul_f32 v119,s80,v119
v_mul_f32 v125,s80,v125
v_max_f32 v119,v119,v116
v_max_f32 v125,v125,v122
v_fma_f32 v176,v176,s80,-v119
v_fma_f32 v188,v188,s80,-v125
v_fma_f32 v177,v177,s80,-v119
v_fma_f32 v189,v189,s80,-v125
v_fma_f32 v178,v178,s80,-v119
v_fma_f32 v190,v190,s80,-v125
v_fma_f32 v179,v179,s80,-v119
v_fma_f32 v191,v191,s80,-v125
v_sub_f32 v116,v116,v119
v_sub_f32 v122,v122,v125
v_exp_f32 v176,v176
v_exp_f32 v188,v188
v_exp_f32 v177,v177
v_exp_f32 v189,v189
v_exp_f32 v178,v178
v_exp_f32 v190,v190
v_exp_f32 v179,v179
v_exp_f32 v191,v191
v_exp_f32 v116,v116
v_exp_f32 v122,v122
v_add_f32 v120,v176,v177
v_add_f32 v126,v188,v189
v_add_f32 v121,v178,v179
v_add_f32 v127,v190,v191
v_add_f32 v120,v120,v121
v_add_f32 v126,v126,v127
v_mov_b32 v118,v120
v_mov_b32 v124,v126
s_nop 0
v_permlane16_swap_b32 v118,v120
v_permlane16_swap_b32 v124,v126
v_add_f32 v120,v120,v118
v_add_f32 v126,v126,v124
v_mov_b32 v118,v120
v_mov_b32 v124,v126
s_nop 0
v_permlane32_swap_b32 v118,v120
v_permlane32_swap_b32 v124,v126
v_add_f32 v120,v120,v118
v_add_f32 v126,v126,v124
v_fmac_f32 v120,v117,v116
v_fmac_f32 v126,v123,v122
v_rcp_f32 v121,v120
v_rcp_f32 v127,v126
v_mul_f32 v119,v116,v121
v_mul_f32 v125,v122,v127
v_pk_mul_f32 v[168:169],v[168:169],v[118:119] op_sel:[0,1] op_sel_hi:[1,1]
v_pk_mul_f32 v[180:181],v[180:181],v[124:125] op_sel:[0,1] op_sel_hi:[1,1]
v_pk_mul_f32 v[170:171],v[170:171],v[118:119] op_sel:[0,1] op_sel_hi:[1,1]
v_pk_mul_f32 v[182:183],v[182:183],v[124:125] op_sel:[0,1] op_sel_hi:[1,1]
v_pk_mul_f32 v[172:173],v[172:173],v[118:119] op_sel:[0,1] op_sel_hi:[1,1]
v_pk_mul_f32 v[184:185],v[184:185],v[124:125] op_sel:[0,1] op_sel_hi:[1,1]
v_pk_mul_f32 v[174:175],v[174:175],v[118:119] op_sel:[0,1] op_sel_hi:[1,1]
v_pk_mul_f32 v[186:187],v[186:187],v[124:125] op_sel:[0,1] op_sel_hi:[1,1]
v_cvt_pk_bf16_f32 v48,v168,v169
v_cvt_pk_bf16_f32 v56,v180,v181
v_cvt_pk_bf16_f32 v49,v170,v171
v_cvt_pk_bf16_f32 v57,v182,v183
v_cvt_pk_bf16_f32 v50,v172,v173
v_cvt_pk_bf16_f32 v58,v184,v185
v_cvt_pk_bf16_f32 v51,v174,v175
v_cvt_pk_bf16_f32 v59,v186,v187
v_pk_mul_f32 v[176:177],v[176:177],v[120:121] op_sel:[0,1] op_sel_hi:[1,1]
v_pk_mul_f32 v[188:189],v[188:189],v[126:127] op_sel:[0,1] op_sel_hi:[1,1]
v_pk_mul_f32 v[178:179],v[178:179],v[120:121] op_sel:[0,1] op_sel_hi:[1,1]
v_pk_mul_f32 v[190:191],v[190:191],v[126:127] op_sel:[0,1] op_sel_hi:[1,1]
v_cvt_pk_bf16_f32 v52,v176,v177
v_cvt_pk_bf16_f32 v60,v188,v189
v_cvt_pk_bf16_f32 v53,v178,v179
v_cvt_pk_bf16_f32 v61,v190,v191
s_add_u32 s70,s70,s42
s_waitcnt vmcnt(8)
v_mfma_f32_16x16x32_bf16 v[192:195],a[64:67],v[48:51],0
v_mfma_f32_16x16x32_bf16 v[196:199],a[64:67],v[56:59],0
v_mfma_f32_16x16x32_bf16 v[200:203],a[68:71],v[48:51],0
v_mfma_f32_16x16x32_bf16 v[204:207],a[68:71],v[56:59],0
v_mfma_f32_16x16x32_bf16 v[208:211],a[72:75],v[48:51],0
v_mfma_f32_16x16x32_bf16 v[212:215],a[72:75],v[56:59],0
v_mfma_f32_16x16x32_bf16 v[216:219],a[76:79],v[48:51],0
v_mfma_f32_16x16x32_bf16 v[220:223],a[76:79],v[56:59],0
s_waitcnt vmcnt(0)
v_mfma_f32_16x16x16_bf16 v[192:195],v[100:101],v[52:53],v[192:195]
v_mfma_f32_16x16x16_bf16 v[196:199],v[100:101],v[60:61],v[196:199]
v_mfma_f32_16x16x16_bf16 v[200:203],v[102:103],v[52:53],v[200:203]
v_mfma_f32_16x16x16_bf16 v[204:207],v[102:103],v[60:61],v[204:207]
v_mfma_f32_16x16x32_bf16 v[224:227],a[80:83],v[48:51],0
v_mfma_f32_16x16x32_bf16 v[228:231],a[80:83],v[56:59],0
v_mfma_f32_16x16x32_bf16 v[232:235],a[84:87],v[48:51],0
v_mfma_f32_16x16x32_bf16 v[236:239],a[84:87],v[56:59],0
v_mfma_f32_16x16x16_bf16 v[208:211],v[104:105],v[52:53],v[208:211]
s_add_u32 s65,s70,524288
v_mfma_f32_16x16x16_bf16 v[212:215],v[104:105],v[60:61],v[212:215]
v_cvt_pk_bf16_f32 v64,v192,v193
v_cvt_pk_bf16_f32 v65,v194,v195
v_mfma_f32_16x16x16_bf16 v[216:219],v[106:107],v[52:53],v[216:219]
v_cvt_pk_bf16_f32 v66,v200,v201
v_mfma_f32_16x16x16_bf16 v[220:223],v[106:107],v[60:61],v[220:223]
v_cvt_pk_bf16_f32 v67,v202,v203
v_max_u32 v64,1,v64
v_mfma_f32_16x16x32_bf16 v[240:243],a[88:91],v[48:51],0
buffer_store_dwordx4 v[64:67],v16,s[20:23],s65 offen offset:0 sc1
v_cvt_pk_bf16_f32 v68,v196,v197
v_mfma_f32_16x16x32_bf16 v[244:247],a[88:91],v[56:59],0
v_cvt_pk_bf16_f32 v69,v198,v199
v_mfma_f32_16x16x32_bf16 v[248:251],a[92:95],v[48:51],0
v_cvt_pk_bf16_f32 v70,v204,v205
v_cvt_pk_bf16_f32 v71,v206,v207
v_mfma_f32_16x16x32_bf16 v[252:255],a[92:95],v[56:59],0
v_max_u32 v68,1,v68
buffer_store_dwordx4 v[68:71],v16,s[20:23],s65 offen offset:1024 sc1
v_mfma_f32_16x16x16_bf16 v[224:227],v[108:109],v[52:53],v[224:227]
v_cvt_pk_bf16_f32 v72,v208,v209
v_mfma_f32_16x16x16_bf16 v[228:231],v[108:109],v[60:61],v[228:231]
v_cvt_pk_bf16_f32 v73,v210,v211
v_cvt_pk_bf16_f32 v74,v216,v217
v_mfma_f32_16x16x16_bf16 v[232:235],v[110:111],v[52:53],v[232:235]
v_cvt_pk_bf16_f32 v75,v218,v219
v_mfma_f32_16x16x16_bf16 v[236:239],v[110:111],v[60:61],v[236:239]
v_max_u32 v72,1,v72
buffer_store_dwordx4 v[72:75],v16,s[20:23],s65 offen offset:2048 sc1
v_mfma_f32_16x16x16_bf16 v[240:243],v[112:113],v[52:53],v[240:243]
v_cvt_pk_bf16_f32 v76,v212,v213
v_mfma_f32_16x16x16_bf16 v[244:247],v[112:113],v[60:61],v[244:247]
v_cvt_pk_bf16_f32 v77,v214,v215
v_cvt_pk_bf16_f32 v78,v220,v221
v_mfma_f32_16x16x16_bf16 v[248:251],v[114:115],v[52:53],v[248:251]
v_cvt_pk_bf16_f32 v79,v222,v223
v_mfma_f32_16x16x16_bf16 v[252:255],v[114:115],v[60:61],v[252:255]
v_max_u32 v76,1,v76
buffer_store_dwordx4 v[76:79],v16,s[20:23],s65 offen offset:3072 sc1
s_cmp_gt_u32 s71,51
s_cselect_b32 s64,s73,0x7fff0000
v_mov_b32 v22,s71
buffer_store_dword v22,v23,s[20:23],s64 offen sc1
s_add_u32 s65,s70,528384
v_cvt_pk_bf16_f32 v64,v224,v225
v_cvt_pk_bf16_f32 v65,v226,v227
v_cvt_pk_bf16_f32 v66,v232,v233
v_cvt_pk_bf16_f32 v67,v234,v235
v_max_u32 v64,1,v64
buffer_store_dwordx4 v[64:67],v16,s[20:23],s65 offen offset:0 sc1
v_cvt_pk_bf16_f32 v68,v228,v229
v_cvt_pk_bf16_f32 v69,v230,v231
v_cvt_pk_bf16_f32 v70,v236,v237
v_cvt_pk_bf16_f32 v71,v238,v239
v_max_u32 v68,1,v68
buffer_store_dwordx4 v[68:71],v16,s[20:23],s65 offen offset:1024 sc1
v_cvt_pk_bf16_f32 v72,v240,v241
v_cvt_pk_bf16_f32 v73,v242,v243
v_cvt_pk_bf16_f32 v74,v248,v249
v_cvt_pk_bf16_f32 v75,v250,v251
v_max_u32 v72,1,v72
buffer_store_dwordx4 v[72:75],v16,s[20:23],s65 offen offset:2048 sc1
v_cvt_pk_bf16_f32 v76,v244,v245
v_cvt_pk_bf16_f32 v77,v246,v247
v_cvt_pk_bf16_f32 v78,v252,v253
v_cvt_pk_bf16_f32 v79,v254,v255
v_max_u32 v76,1,v76
buffer_store_dwordx4 v[76:79],v16,s[20:23],s65 offen offset:3072 sc1
s_cmp_lg_u32 s79,55
s_cbranch_scc1 q2nd_259
pl_260:
buffer_load_dword v98,v99,s[20:23],s87 offen sc1
s_waitcnt vmcnt(0)
v_cmp_gt_u32 vcc,18,v98
s_cbranch_vccz pok_261
s_sleep 1
s_sub_u32 s90,s90,1
s_cmp_gt_i32 s90,0
s_cbranch_scc1 pl_260
pok_261:
q2nd_259:
s_add_u32 s64,s79,1
s_lshl_b32 s75,s64,21
s_lshl_b32 s64,s64,13
s_and_b32 s64,s64,0x2000
s_xor_b32 s64,s64,s61
s_add_u32 s75,s75,s64
s_add_u32 s75,s75,29360128
s_add_u32 s64,s79,1
s_lshl_b32 s76,s64,21
s_lshl_b32 s64,s64,13
s_and_b32 s64,s64,0x2000
s_xor_b32 s64,s64,s62
s_add_u32 s76,s76,s64
s_add_u32 s76,s76,29360128
s_add_u32 s66,s75,s43
s_add_u32 s75,s75,s42
s_add_u32 s76,s76,s42
s_cmp_lt_u32 s79,63
s_cselect_b32 s75,s75,0x7fff0000
s_cselect_b32 s76,s76,0x7fff0000
s_cselect_b32 s66,s66,0x7fff0000
s_add_u32 s65,s75,524288
buffer_load_dwordx4 a[32:35],v16,s[20:23],s65 offen offset:0 sc1
buffer_load_dwordx4 a[36:39],v16,s[20:23],s65 offen offset:1024 sc1
buffer_load_dwordx4 a[40:43],v16,s[20:23],s65 offen offset:2048 sc1
buffer_load_dwordx4 a[44:47],v16,s[20:23],s65 offen offset:3072 sc1
s_add_u32 s65,s75,528384
buffer_load_dwordx4 a[48:51],v16,s[20:23],s65 offen offset:0 sc1
buffer_load_dwordx4 a[52:55],v16,s[20:23],s65 offen offset:1024 sc1
buffer_load_dwordx4 a[56:59],v16,s[20:23],s65 offen offset:2048 sc1
buffer_load_dwordx4 a[60:63],v16,s[20:23],s65 offen offset:3072 sc1
s_add_u32 s65,s76,0
buffer_load_dwordx4 a[0:3],v16,s[20:23],s65 offen offset:0 sc1
buffer_load_dwordx4 a[4:7],v16,s[20:23],s65 offen offset:1024 sc1
buffer_load_dwordx4 a[8:11],v16,s[20:23],s65 offen offset:2048 sc1
buffer_load_dwordx4 a[12:15],v16,s[20:23],s65 offen offset:3072 sc1
s_add_u32 s65,s76,4096
buffer_load_dwordx4 a[16:19],v16,s[20:23],s65 offen offset:0 sc1
buffer_load_dwordx4 a[20:23],v16,s[20:23],s65 offen offset:1024 sc1
buffer_load_dwordx4 a[24:27],v16,s[20:23],s65 offen offset:2048 sc1
buffer_load_dwordx4 a[28:31],v16,s[20:23],s65 offen offset:3072 sc1
buffer_load_dwordx4 v[136:139],v16,s[20:23],s66 offen offset:0 sc1
buffer_load_dwordx4 v[140:143],v16,s[20:23],s66 offen offset:1024 sc1
buffer_load_dwordx4 v[144:147],v16,s[20:23],s66 offen offset:2048 sc1
buffer_load_dwordx4 v[148:151],v16,s[20:23],s66 offen offset:3072 sc1
s_add_u32 s65,s75,1048576
buffer_load_dwordx4 a[64:67],v16,s[20:23],s65 offen offset:0 sc1
buffer_load_dwordx4 a[68:71],v16,s[20:23],s65 offen offset:1024 sc1
buffer_load_dwordx4 a[72:75],v16,s[20:23],s65 offen offset:2048 sc1
buffer_load_dwordx4 a[76:79],v16,s[20:23],s65 offen offset:3072 sc1
s_add_u32 s65,s75,1052672
buffer_load_dwordx4 a[80:83],v16,s[20:23],s65 offen offset:0 sc1
buffer_load_dwordx4 a[84:87],v16,s[20:23],s65 offen offset:1024 sc1
buffer_load_dwordx4 a[88:91],v16,s[20:23],s65 offen offset:2048 sc1
buffer_load_dwordx4 a[92:95],v16,s[20:23],s65 offen offset:3072 sc1
s_add_u32 s79,s79,1
s_add_u32 s71,s71,1
s_cmp_lt_u32 s79,64
s_cbranch_scc1 aloop_255
s_endpgm
r_ln_216:
v_and_b32 v21,1,v1
v_mul_u32_u24 v21,960,v21
s_mov_b32 s65,21052032
s_mov_b32 s66,1792
pl_262:
buffer_load_dword v22,v21,s[20:23],s65 offen sc1
s_waitcnt vmcnt(0)
v_cmp_gt_u32 vcc,s66,v22
s_cbranch_vccz pok_263
s_sleep 1
s_sub_u32 s90,s90,1
s_cmp_gt_i32 s90,0
s_cbranch_scc1 pl_262
pok_263:
s_lshl_b32 s41,s59,1
s_add_u32 s41,s41,s50
s_sub_u32 s41,s41,2
v_lshlrev_b32 v5,5,v1
s_mov_b32 s64,16384
buffer_load_dwordx4 v[40:43],v5,s[20:23],s64 offen offset:0 sc1
buffer_load_dwordx4 v[44:47],v5,s[20:23],s64 offen offset:16 sc1
buffer_load_dwordx4 v[48:51],v5,s[20:23],s64 offen offset:2048 sc1
buffer_load_dwordx4 v[52:55],v5,s[20:23],s64 offen offset:2064 sc1
s_mov_b32 s64,12288
buffer_load_dwordx4 v[56:59],v5,s[20:23],s64 offen offset:0 sc1
buffer_load_dwordx4 v[60:63],v5,s[20:23],s64 offen offset:16 sc1
buffer_load_dwordx4 v[64:67],v5,s[20:23],s64 offen offset:2048 sc1
buffer_load_dwordx4 v[68:71],v5,s[20:23],s64 offen offset:2064 sc1
s_lshr_b32 s64,s41,2
s_add_u32 s64,s64,64
s_lshl_b32 s64,s64,14
s_and_b32 s65,s41,3
s_lshl_b32 s65,s65,11
s_add_u32 s64,s64,s65
v_add_u32 v19,s64,v16
v_add_u32 v19,786432,v19
s_lshl_b32 s65,s41,7
v_add_u32 v5,s65,v16
v_and_b32 v5,2047,v5
v_add_u32 v17,s64,v5
v_xor_b32 v18,1024,v17
v_add_u32 v24,0xfff00000,v17
v_xor_b32 v25,1024,v24
v_lshlrev_b32 v21,2,v1
s_and_b32 s64,s41,4
s_lshl_b32 s64,s64,6
s_add_u32 s74,s63,s64
s_add_u32 s74,s74,2048
s_mov_b32 s83,1
s_lshl_b32 s73,s41,2
s_add_u32 s73,s73,s63
s_add_u32 s73,s73,2560
s_waitcnt vmcnt(0)
v_add_f32 v40,1.0,v40
v_add_f32 v41,1.0,v41
v_add_f32 v42,1.0,v42
v_add_f32 v43,1.0,v43
v_add_f32 v44,1.0,v44
v_add_f32 v45,1.0,v45
v_add_f32 v46,1.0,v46
v_add_f32 v47,1.0,v47
v_add_f32 v48,1.0,v48
v_add_f32 v49,1.0,v49
v_add_f32 v50,1.0,v50
v_add_f32 v51,1.0,v51
v_add_f32 v52,1.0,v52
v_add_f32 v53,1.0,v53
v_add_f32 v54,1.0,v54
v_add_f32 v55,1.0,v55
s_add_u32 s64,s79,0
s_lshl_b32 s70,s64,21
s_lshl_b32 s64,s64,13
s_and_b32 s64,s64,0x2000
s_xor_b32 s64,s64,s62
s_add_u32 s70,s70,s64
s_add_u32 s70,s70,29360128
lloop_264:
s_add_u32 s75,s70,2097152
s_xor_b32 s75,s75,0x2000
s_add_u32 s96,s71,1
s_cmp_eq_u32 s83,0
s_cbranch_scc1 lahead_267
s_cmp_gt_u32 s71,51
s_cbranch_scc1 xp_265
pl_269:
buffer_load_dword v29,v21,s[20:23],s74 offen sc1
s_waitcnt vmcnt(0)
v_cmp_gt_u32 vcc,s71,v29
s_cbranch_vccz pok_270
s_sleep 1
s_sub_u32 s90,s90,1
s_cmp_gt_i32 s90,0
s_cbranch_scc1 pl_269
pok_270:
xp_265:
buffer_load_dwordx4 v[8:11],v17,s[20:23],s70 offen sc1
buffer_load_dwordx4 v[12:15],v18,s[20:23],s70 offen sc1
s_waitcnt vmcnt(0)
v_min3_u32 v22,v8,v10,v12
v_min_u32 v22,v22,v14
v_cmp_eq_u32 vcc,0,v22
s_cbranch_vccz xk_266
s_sleep 1
s_sub_u32 s90,s90,1
s_cmp_gt_i32 s90,0
s_cbranch_scc1 xp_265
s_branch xk_266
lahead_267:
s_waitcnt vmcnt(6)
v_mov_b32 v8,v104
v_mov_b32 v9,v105
v_mov_b32 v10,v106
v_mov_b32 v11,v107
v_mov_b32 v12,v108
v_mov_b32 v13,v109
v_mov_b32 v14,v110
v_mov_b32 v15,v111
v_min3_u32 v22,v8,v10,v12
v_min_u32 v22,v22,v14
v_cmp_eq_u32 vcc,0,v22
s_cbranch_vccnz xp_265
xk_266:
v_cmp_gt_u32 vcc,s96,v29
s_or_b32 s83,vcc_lo,vcc_hi
s_cselect_b32 s76,0x7fff0000,s75
buffer_load_dwordx4 v[104:107],v17,s[20:23],s76 offen sc1
buffer_load_dwordx4 v[108:111],v18,s[20:23],s76 offen sc1
buffer_load_dword v29,v21,s[20:23],s74 offen sc1
v_lshlrev_b32 v80,16,v8
v_and_b32 v81,s80,v8
v_lshlrev_b32 v82,16,v9
v_and_b32 v83,s80,v9
v_lshlrev_b32 v84,16,v10
v_and_b32 v85,s80,v10
v_lshlrev_b32 v86,16,v11
v_and_b32 v87,s80,v11
v_lshlrev_b32 v88,16,v12
v_and_b32 v89,s80,v12
v_lshlrev_b32 v90,16,v13
v_and_b32 v91,s80,v13
v_lshlrev_b32 v92,16,v14
v_and_b32 v93,s80,v14
v_lshlrev_b32 v94,16,v15
v_and_b32 v95,s80,v15
v_add_f32 v5,v80,v81
v_add_f32 v5,v5,v82
v_add_f32 v5,v5,v83
v_add_f32 v5,v5,v84
v_add_f32 v5,v5,v85
v_add_f32 v5,v5,v86
v_add_f32 v5,v5,v87
v_add_f32 v5,v5,v88
v_add_f32 v5,v5,v89
v_add_f32 v5,v5,v90
v_add_f32 v5,v5,v91
v_add_f32 v5,v5,v92
v_add_f32 v5,v5,v93
v_add_f32 v5,v5,v94
v_add_f32 v5,v5,v95
s_nop 1
v_add_f32_dpp v5,v5,v5 quad_perm:[1,0,3,2] row_mask:0xf bank_mask:0xf
s_nop 1
v_add_f32_dpp v5,v5,v5 quad_perm:[2,3,0,1] row_mask:0xf bank_mask:0xf
s_nop 1
v_add_f32_dpp v5,v5,v5 row_half_mirror row_mask:0xf bank_mask:0xf
s_nop 1
v_add_f32_dpp v5,v5,v5 row_mirror row_mask:0xf bank_mask:0xf
v_mov_b32 v7,v5
s_nop 1
v_permlane16_swap_b32 v7,v5
v_add_f32 v5,v5,v7
v_mov_b32 v7,v5
s_nop 1
v_permlane32_swap_b32 v7,v5
v_add_f32 v5,v5,v7
v_mul_f32 v5,0x3a800000,v5
v_sub_f32 v80,v80,v5
v_sub_f32 v81,v81,v5
v_sub_f32 v82,v82,v5
v_sub_f32 v83,v83,v5
v_sub_f32 v84,v84,v5
v_sub_f32 v85,v85,v5
v_sub_f32 v86,v86,v5
v_sub_f32 v87,v87,v5
v_sub_f32 v88,v88,v5
v_sub_f32 v89,v89,v5
v_sub_f32 v90,v90,v5
v_sub_f32 v91,v91,v5
v_sub_f32 v92,v92,v5
v_sub_f32 v93,v93,v5
v_sub_f32 v94,v94,v5
v_sub_f32 v95,v95,v5
v_mul_f32 v6,v80,v80
v_fmac_f32 v6,v81,v81
v_fmac_f32 v6,v82,v82
v_fmac_f32 v6,v83,v83
v_fmac_f32 v6,v84,v84
v_fmac_f32 v6,v85,v85
v_fmac_f32 v6,v86,v86
v_fmac_f32 v6,v87,v87
v_fmac_f32 v6,v88,v88
v_fmac_f32 v6,v89,v89
v_fmac_f32 v6,v90,v90
v_fmac_f32 v6,v91,v91
v_fmac_f32 v6,v92,v92
v_fmac_f32 v6,v93,v93
v_fmac_f32 v6,v94,v94
v_fmac_f32 v6,v95,v95
s_nop 1
v_add_f32_dpp v6,v6,v6 quad_perm:[1,0,3,2] row_mask:0xf bank_mask:0xf
s_nop 1
v_add_f32_dpp v6,v6,v6 quad_perm:[2,3,0,1] row_mask:0xf bank_mask:0xf
s_nop 1
v_add_f32_dpp v6,v6,v6 row_half_mirror row_mask:0xf bank_mask:0xf
s_nop 1
v_add_f32_dpp v6,v6,v6 row_mirror row_mask:0xf bank_mask:0xf
v_mov_b32 v7,v6
s_nop 1
v_permlane16_swap_b32 v7,v6
v_add_f32 v6,v6,v7
v_mov_b32 v7,v6
s_nop 1
v_permlane32_swap_b32 v7,v6
v_add_f32 v6,v6,v7
v_mov_b32 v7,0x3727c5ac
v_fmac_f32 v7,0x3a800000,v6
v_rsq_f32 v6,v7
s_nop 0
v_mul_f32 v80,v80,v6
v_mul_f32 v81,v81,v6
v_mul_f32 v82,v82,v6
v_mul_f32 v83,v83,v6
v_mul_f32 v84,v84,v6
v_mul_f32 v85,v85,v6
v_mul_f32 v86,v86,v6
v_mul_f32 v87,v87,v6
v_mul_f32 v88,v88,v6
v_mul_f32 v89,v89,v6
v_mul_f32 v90,v90,v6
v_mul_f32 v91,v91,v6
v_mul_f32 v92,v92,v6
v_mul_f32 v93,v93,v6
v_mul_f32 v94,v94,v6
v_mul_f32 v95,v95,v6
v_fma_f32 v80,v80,v40,v56
v_fma_f32 v81,v81,v41,v57
v_fma_f32 v82,v82,v42,v58
v_fma_f32 v83,v83,v43,v59
v_fma_f32 v84,v84,v44,v60
v_fma_f32 v85,v85,v45,v61
v_fma_f32 v86,v86,v46,v62
v_fma_f32 v87,v87,v47,v63
v_fma_f32 v88,v88,v48,v64
v_fma_f32 v89,v89,v49,v65
v_fma_f32 v90,v90,v50,v66
v_fma_f32 v91,v91,v51,v67
v_fma_f32 v92,v92,v52,v68
v_fma_f32 v93,v93,v53,v69
v_fma_f32 v94,v94,v54,v70
v_fma_f32 v95,v95,v55,v71
v_cvt_pk_bf16_f32 v8,v80,v81
v_cvt_pk_bf16_f32 v9,v82,v83
v_cvt_pk_bf16_f32 v10,v84,v85
v_cvt_pk_bf16_f32 v11,v86,v87
v_cvt_pk_bf16_f32 v12,v88,v89
v_cvt_pk_bf16_f32 v13,v90,v91
v_cvt_pk_bf16_f32 v14,v92,v93
v_cvt_pk_bf16_f32 v15,v94,v95
s_waitcnt vmcnt(3)
v_add_u32 v22,s71,-1
buffer_store_dword v22,v23,s[24:27],s73 offen
buffer_store_dword v22,v23,s[28:31],s73 offen sc1
buffer_store_dwordx4 v[8:11],v24,s[20:23],s70 offen sc1
buffer_store_dwordx4 v[12:15],v25,s[20:23],s70 offen sc1
v_lshlrev_b32 v80,16,v8
v_and_b32 v81,s80,v8
v_lshlrev_b32 v82,16,v9
v_and_b32 v83,s80,v9
v_lshlrev_b32 v84,16,v10
v_and_b32 v85,s80,v10
v_lshlrev_b32 v86,16,v11
v_and_b32 v87,s80,v11
v_lshlrev_b32 v88,16,v12
v_and_b32 v89,s80,v12
v_lshlrev_b32 v90,16,v13
v_and_b32 v91,s80,v13
v_lshlrev_b32 v92,16,v14
v_and_b32 v93,s80,v14
v_lshlrev_b32 v94,16,v15
v_and_b32 v95,s80,v15
v_add_f32 v5,v80,v81
v_add_f32 v5,v5,v82
v_add_f32 v5,v5,v83
v_add_f32 v5,v5,v84
v_add_f32 v5,v5,v85
v_add_f32 v5,v5,v86
v_add_f32 v5,v5,v87
v_add_f32 v5,v5,v88
v_add_f32 v5,v5,v89
v_add_f32 v5,v5,v90
v_add_f32 v5,v5,v91
v_add_f32 v5,v5,v92
v_add_f32 v5,v5,v93
v_add_f32 v5,v5,v94
v_add_f32 v5,v5,v95
s_nop 1
v_add_f32_dpp v5,v5,v5 quad_perm:[1,0,3,2] row_mask:0xf bank_mask:0xf
s_nop 1
v_add_f32_dpp v5,v5,v5 quad_perm:[2,3,0,1] row_mask:0xf bank_mask:0xf
s_nop 1
v_add_f32_dpp v5,v5,v5 row_half_mirror row_mask:0xf bank_mask:0xf
s_nop 1
v_add_f32_dpp v5,v5,v5 row_mirror row_mask:0xf bank_mask:0xf
v_mov_b32 v7,v5
s_nop 1
v_permlane16_swap_b32 v7,v5
v_add_f32 v5,v5,v7
v_mov_b32 v7,v5
s_nop 1
v_permlane32_swap_b32 v7,v5
v_add_f32 v5,v5,v7
v_mul_f32 v5,0x3a800000,v5
v_sub_f32 v80,v80,v5
v_sub_f32 v81,v81,v5
v_sub_f32 v82,v82,v5
v_sub_f32 v83,v83,v5
v_sub_f32 v84,v84,v5
v_sub_f32 v85,v85,v5
v_sub_f32 v86,v86,v5
v_sub_f32 v87,v87,v5
v_sub_f32 v88,v88,v5
v_sub_f32 v89,v89,v5
v_sub_f32 v90,v90,v5
v_sub_f32 v91,v91,v5
v_sub_f32 v92,v92,v5
v_sub_f32 v93,v93,v5
v_sub_f32 v94,v94,v5
v_sub_f32 v95,v95,v5
v_mul_f32 v6,v80,v80
v_fmac_f32 v6,v81,v81
v_fmac_f32 v6,v82,v82
v_fmac_f32 v6,v83,v83
v_fmac_f32 v6,v84,v84
v_fmac_f32 v6,v85,v85
v_fmac_f32 v6,v86,v86
v_fmac_f32 v6,v87,v87
v_fmac_f32 v6,v88,v88
v_fmac_f32 v6,v89,v89
v_fmac_f32 v6,v90,v90
v_fmac_f32 v6,v91,v91
v_fmac_f32 v6,v92,v92
v_fmac_f32 v6,v93,v93
v_fmac_f32 v6,v94,v94
v_fmac_f32 v6,v95,v95
s_nop 1
v_add_f32_dpp v6,v6,v6 quad_perm:[1,0,3,2] row_mask:0xf bank_mask:0xf
s_nop 1
v_add_f32_dpp v6,v6,v6 quad_perm:[2,3,0,1] row_mask:0xf bank_mask:0xf
s_nop 1
v_add_f32_dpp v6,v6,v6 row_half_mirror row_mask:0xf bank_mask:0xf
s_nop 1
v_add_f32_dpp v6,v6,v6 row_mirror row_mask:0xf bank_mask:0xf
v_mov_b32 v7,v6
s_nop 1
v_permlane16_swap_b32 v7,v6
v_add_f32 v6,v6,v7
v_mov_b32 v7,v6
s_nop 1
v_permlane32_swap_b32 v7,v6
v_add_f32 v6,v6,v7
v_mov_b32 v7,0x3727c5ac
v_fmac_f32 v7,0x3a800000,v6
v_rsq_f32 v6,v7
s_nop 0
v_mul_f32 v80,v80,v6
v_mul_f32 v81,v81,v6
v_mul_f32 v82,v82,v6
v_mul_f32 v83,v83,v6
v_mul_f32 v84,v84,v6
v_mul_f32 v85,v85,v6
v_mul_f32 v86,v86,v6
v_mul_f32 v87,v87,v6
v_mul_f32 v88,v88,v6
v_mul_f32 v89,v89,v6
v_mul_f32 v90,v90,v6
v_mul_f32 v91,v91,v6
v_mul_f32 v92,v92,v6
v_mul_f32 v93,v93,v6
v_mul_f32 v94,v94,v6
v_mul_f32 v95,v95,v6
v_cvt_pk_bf16_f32 v72,v80,v81
v_cvt_pk_bf16_f32 v73,v82,v83
v_cvt_pk_bf16_f32 v74,v84,v85
v_cvt_pk_bf16_f32 v75,v86,v87
v_cvt_pk_bf16_f32 v76,v88,v89
v_cvt_pk_bf16_f32 v77,v90,v91
v_cvt_pk_bf16_f32 v78,v92,v93
v_cvt_pk_bf16_f32 v79,v94,v95
v_max_u32 v72,1,v72
v_max_u32 v76,1,v76
s_cmp_le_u32 s71,51
s_cbranch_scc1 lw_268
s_waitcnt vmcnt(0)
lw_268:
buffer_store_dwordx4 v[72:75],v19,s[20:23],s70 offen sc1
buffer_store_dwordx4 v[76:79],v19,s[20:23],s70 offen offset:1024 sc1
s_cmp_gt_u32 s71,51
s_cbranch_scc1 fnow_271
s_cmp_eq_u32 s83,0
s_cbranch_scc1 flater_272
s_waitcnt vmcnt(0)
fnow_271:
v_mov_b32 v22,s71
buffer_store_dword v22,v23,s[24:27],s73 offen
buffer_store_dword v22,v23,s[28:31],s73 offen sc1
flater_272:
s_mov_b32 s70,s75
s_add_u32 s79,s79,1
s_add_u32 s71,s71,1
s_cmp_lt_u32 s79,64
s_cbranch_scc1 lloop_264
s_endpgm
r_wo_212:
s_load_dwordx2 s[4:5],s[0:1],40
s_load_dwordx2 s[6:7],s[0:1],0
s_lshr_b32 s41,s59,3
s_and_b32 s42,s59,7
s_mul_i32 s66,s41,2097152
s_lshl_b32 s64,s42,8
s_add_u32 s66,s66,s64
s_lshl_b32 s67,s50,1
s_and_b32 s64,s41,1
s_add_u32 s67,s67,s64
s_waitcnt lgkmcnt(0)
s_mov_b32 s32,s4
s_and_b32 s33,s5,0xffff
s_mov_b32 s34,0x800000
s_mov_b32 s35,0x20000
s_mov_b32 s36,s6
s_and_b32 s37,s7,0xffff
s_mov_b32 s38,0x400000
s_mov_b32 s39,0x20000
v_lshrrev_b32 v5,2,v3
v_lshl_add_u32 v5,v4,2,v5
v_and_b32 v6,3,v3
v_lshlrev_b32 v6,3,v6
v_lshl_add_u32 v6,v5,8,v6
v_and_b32 v5,7,v5
v_xor_b32 v5,s67,v5
v_lshl_add_u32 v12,v5,5,v6
v_xor_b32 v13,32,v12
v_and_b32 v5,15,v1
v_and_b32 v6,3,v4
v_lshlrev_b32 v6,1,v6
v_xor_b32 v5,v5,v6
v_mul_u32_u24 v6,2048,v4
v_xor_b32 v7,0,v5
v_lshl_add_u32 v8,v7,4,v6
v_xor_b32 v7,8,v5
v_lshl_add_u32 v9,v7,4,v6
s_mul_i32 s74,s50,131072
s_add_u32 s74,s74,s66
s_lshl_b32 s75,s50,14
s_mul_i32 s76,s50,65536
s_add_u32 s76,s76,s66
s_lshl_b32 s77,s50,13
s_add_u32 s64,s74,0
s_add_u32 m0,s75,0
s_nop 0
buffer_load_dwordx4 v8,s[32:35],s64 offen nt lds
s_add_u32 s64,s74,8192
s_add_u32 m0,s75,1024
s_nop 0
buffer_load_dwordx4 v9,s[32:35],s64 offen nt lds
s_add_u32 s64,s74,16384
s_add_u32 m0,s75,2048
s_nop 0
buffer_load_dwordx4 v8,s[32:35],s64 offen nt lds
s_add_u32 s64,s74,24576
s_add_u32 m0,s75,3072
s_nop 0
buffer_load_dwordx4 v9,s[32:35],s64 offen nt lds
s_add_u32 s64,s74,32768
s_add_u32 m0,s75,4096
s_nop 0
buffer_load_dwordx4 v8,s[32:35],s64 offen nt lds
s_add_u32 s64,s74,40960
s_add_u32 m0,s75,5120
s_nop 0
buffer_load_dwordx4 v9,s[32:35],s64 offen nt lds
s_add_u32 s64,s74,49152
s_add_u32 m0,s75,6144
s_nop 0
buffer_load_dwordx4 v8,s[32:35],s64 offen nt lds
s_add_u32 s64,s74,57344
s_add_u32 m0,s75,7168
s_nop 0
buffer_load_dwordx4 v9,s[32:35],s64 offen nt lds
s_add_u32 s64,s74,65536
s_add_u32 m0,s75,8192
s_nop 0
buffer_load_dwordx4 v8,s[32:35],s64 offen nt lds
s_add_u32 s64,s74,73728
s_add_u32 m0,s75,9216
s_nop 0
buffer_load_dwordx4 v9,s[32:35],s64 offen nt lds
s_add_u32 s64,s74,81920
s_add_u32 m0,s75,10240
s_nop 0
buffer_load_dwordx4 v8,s[32:35],s64 offen nt lds
s_add_u32 s64,s74,90112
s_add_u32 m0,s75,11264
s_nop 0
buffer_load_dwordx4 v9,s[32:35],s64 offen nt lds
s_add_u32 s64,s74,98304
s_add_u32 m0,s75,12288
s_nop 0
buffer_load_dwordx4 v8,s[32:35],s64 offen nt lds
s_add_u32 s64,s74,106496
s_add_u32 m0,s75,13312
s_nop 0
buffer_load_dwordx4 v9,s[32:35],s64 offen nt lds
s_add_u32 s64,s74,114688
s_add_u32 m0,s75,14336
s_nop 0
buffer_load_dwordx4 v8,s[32:35],s64 offen nt lds
s_add_u32 s64,s74,122880
s_add_u32 m0,s75,15360
s_nop 0
buffer_load_dwordx4 v9,s[32:35],s64 offen nt lds
s_add_u32 s64,s74,524288
s_add_u32 m0,s75,65536
s_nop 0
buffer_load_dwordx4 v8,s[32:35],s64 offen nt lds
s_add_u32 s64,s74,532480
s_add_u32 m0,s75,66560
s_nop 0
buffer_load_dwordx4 v9,s[32:35],s64 offen nt lds
s_add_u32 s64,s74,540672
s_add_u32 m0,s75,67584
s_nop 0
buffer_load_dwordx4 v8,s[32:35],s64 offen nt lds
s_add_u32 s64,s74,548864
s_add_u32 m0,s75,68608
s_nop 0
buffer_load_dwordx4 v9,s[32:35],s64 offen nt lds
s_add_u32 s64,s74,557056
s_add_u32 m0,s75,69632
s_nop 0
buffer_load_dwordx4 v8,s[32:35],s64 offen nt lds
s_add_u32 s64,s74,565248
s_add_u32 m0,s75,70656
s_nop 0
buffer_load_dwordx4 v9,s[32:35],s64 offen nt lds
s_add_u32 s64,s74,573440
s_add_u32 m0,s75,71680
s_nop 0
buffer_load_dwordx4 v8,s[32:35],s64 offen nt lds
s_add_u32 s64,s74,581632
s_add_u32 m0,s75,72704
s_nop 0
buffer_load_dwordx4 v9,s[32:35],s64 offen nt lds
s_add_u32 s64,s74,589824
s_add_u32 m0,s75,73728
s_nop 0
buffer_load_dwordx4 v8,s[32:35],s64 offen nt lds
s_add_u32 s64,s74,598016
s_add_u32 m0,s75,74752
s_nop 0
buffer_load_dwordx4 v9,s[32:35],s64 offen nt lds
s_add_u32 s64,s74,606208
s_add_u32 m0,s75,75776
s_nop 0
buffer_load_dwordx4 v8,s[32:35],s64 offen nt lds
s_add_u32 s64,s74,614400
s_add_u32 m0,s75,76800
s_nop 0
buffer_load_dwordx4 v9,s[32:35],s64 offen nt lds
s_add_u32 s64,s74,622592
s_add_u32 m0,s75,77824
s_nop 0
buffer_load_dwordx4 v8,s[32:35],s64 offen nt lds
s_add_u32 s64,s74,630784
s_add_u32 m0,s75,78848
s_nop 0
buffer_load_dwordx4 v9,s[32:35],s64 offen nt lds
s_add_u32 s64,s74,638976
s_add_u32 m0,s75,79872
s_nop 0
buffer_load_dwordx4 v8,s[32:35],s64 offen nt lds
s_add_u32 s64,s74,647168
s_add_u32 m0,s75,80896
s_nop 0
buffer_load_dwordx4 v9,s[32:35],s64 offen nt lds
s_waitcnt vmcnt(16)
s_barrier
ds_read_b64_tr_b16 a[0:1],v12 offset:0
ds_read_b64_tr_b16 a[128:129],v13 offset:0
ds_read_b64_tr_b16 a[2:3],v12 offset:4096
ds_read_b64_tr_b16 a[130:131],v13 offset:4096
ds_read_b64_tr_b16 a[4:5],v12 offset:8192
ds_read_b64_tr_b16 a[132:133],v13 offset:8192
ds_read_b64_tr_b16 a[6:7],v12 offset:12288
ds_read_b64_tr_b16 a[134:135],v13 offset:12288
s_waitcnt lgkmcnt(4)
ds_read_b64_tr_b16 a[8:9],v12 offset:16384
ds_read_b64_tr_b16 a[136:137],v13 offset:16384
ds_read_b64_tr_b16 a[10:11],v12 offset:20480
ds_read_b64_tr_b16 a[138:139],v13 offset:20480
ds_read_b64_tr_b16 a[12:13],v12 offset:24576
ds_read_b64_tr_b16 a[140:141],v13 offset:24576
ds_read_b64_tr_b16 a[14:15],v12 offset:28672
ds_read_b64_tr_b16 a[142:143],v13 offset:28672
s_waitcnt lgkmcnt(4)
ds_read_b64_tr_b16 a[16:17],v12 offset:32768
ds_read_b64_tr_b16 a[144:145],v13 offset:32768
ds_read_b64_tr_b16 a[18:19],v12 offset:36864
ds_read_b64_tr_b16 a[146:147],v13 offset:36864
ds_read_b64_tr_b16 a[20:21],v12 offset:40960
ds_read_b64_tr_b16 a[148:149],v13 offset:40960
ds_read_b64_tr_b16 a[22:23],v12 offset:45056
ds_read_b64_tr_b16 a[150:151],v13 offset:45056
s_waitcnt lgkmcnt(4)
ds_read_b64_tr_b16 a[24:25],v12 offset:49152
ds_read_b64_tr_b16 a[152:153],v13 offset:49152
ds_read_b64_tr_b16 a[26:27],v12 offset:53248
ds_read_b64_tr_b16 a[154:155],v13 offset:53248
ds_read_b64_tr_b16 a[28:29],v12 offset:57344
ds_read_b64_tr_b16 a[156:157],v13 offset:57344
ds_read_b64_tr_b16 a[30:31],v12 offset:61440
ds_read_b64_tr_b16 a[158:159],v13 offset:61440
s_waitcnt lgkmcnt(4)
v_xor_b32 v12,0x10000,v12
v_xor_b32 v13,0x10000,v13
s_waitcnt lgkmcnt(0)
s_barrier
s_add_u32 s64,s74,1048576
s_add_u32 m0,s75,0
s_nop 0
buffer_load_dwordx4 v8,s[32:35],s64 offen nt lds
s_add_u32 s64,s74,1056768
s_add_u32 m0,s75,1024
s_nop 0
buffer_load_dwordx4 v9,s[32:35],s64 offen nt lds
s_add_u32 s64,s74,1064960
s_add_u32 m0,s75,2048
s_nop 0
buffer_load_dwordx4 v8,s[32:35],s64 offen nt lds
s_add_u32 s64,s74,1073152
s_add_u32 m0,s75,3072
s_nop 0
buffer_load_dwordx4 v9,s[32:35],s64 offen nt lds
s_add_u32 s64,s74,1081344
s_add_u32 m0,s75,4096
s_nop 0
buffer_load_dwordx4 v8,s[32:35],s64 offen nt lds
s_add_u32 s64,s74,1089536
s_add_u32 m0,s75,5120
s_nop 0
buffer_load_dwordx4 v9,s[32:35],s64 offen nt lds
s_add_u32 s64,s74,1097728
s_add_u32 m0,s75,6144
s_nop 0
buffer_load_dwordx4 v8,s[32:35],s64 offen nt lds
s_add_u32 s64,s74,1105920
s_add_u32 m0,s75,7168
s_nop 0
buffer_load_dwordx4 v9,s[32:35],s64 offen nt lds
s_add_u32 s64,s74,1114112
s_add_u32 m0,s75,8192
s_nop 0
buffer_load_dwordx4 v8,s[32:35],s64 offen nt lds
s_add_u32 s64,s74,1122304
s_add_u32 m0,s75,9216
s_nop 0
buffer_load_dwordx4 v9,s[32:35],s64 offen nt lds
s_add_u32 s64,s74,1130496
s_add_u32 m0,s75,10240
s_nop 0
buffer_load_dwordx4 v8,s[32:35],s64 offen nt lds
s_add_u32 s64,s74,1138688
s_add_u32 m0,s75,11264
s_nop 0
buffer_load_dwordx4 v9,s[32:35],s64 offen nt lds
s_add_u32 s64,s74,1146880
s_add_u32 m0,s75,12288
s_nop 0
buffer_load_dwordx4 v8,s[32:35],s64 offen nt lds
s_add_u32 s64,s74,1155072
s_add_u32 m0,s75,13312
s_nop 0
buffer_load_dwordx4 v9,s[32:35],s64 offen nt lds
s_add_u32 s64,s74,1163264
s_add_u32 m0,s75,14336
s_nop 0
buffer_load_dwordx4 v8,s[32:35],s64 offen nt lds
s_add_u32 s64,s74,1171456
s_add_u32 m0,s75,15360
s_nop 0
buffer_load_dwordx4 v9,s[32:35],s64 offen nt lds
s_waitcnt vmcnt(16)
s_barrier
ds_read_b64_tr_b16 a[32:33],v12 offset:0
ds_read_b64_tr_b16 a[160:161],v13 offset:0
ds_read_b64_tr_b16 a[34:35],v12 offset:4096
ds_read_b64_tr_b16 a[162:163],v13 offset:4096
ds_read_b64_tr_b16 a[36:37],v12 offset:8192
ds_read_b64_tr_b16 a[164:165],v13 offset:8192
ds_read_b64_tr_b16 a[38:39],v12 offset:12288
ds_read_b64_tr_b16 a[166:167],v13 offset:12288
s_waitcnt lgkmcnt(4)
ds_read_b64_tr_b16 a[40:41],v12 offset:16384
ds_read_b64_tr_b16 a[168:169],v13 offset:16384
ds_read_b64_tr_b16 a[42:43],v12 offset:20480
ds_read_b64_tr_b16 a[170:171],v13 offset:20480
ds_read_b64_tr_b16 a[44:45],v12 offset:24576
ds_read_b64_tr_b16 a[172:173],v13 offset:24576
ds_read_b64_tr_b16 a[46:47],v12 offset:28672
ds_read_b64_tr_b16 a[174:175],v13 offset:28672
s_waitcnt lgkmcnt(4)
ds_read_b64_tr_b16 a[48:49],v12 offset:32768
ds_read_b64_tr_b16 a[176:177],v13 offset:32768
ds_read_b64_tr_b16 a[50:51],v12 offset:36864
ds_read_b64_tr_b16 a[178:179],v13 offset:36864
ds_read_b64_tr_b16 a[52:53],v12 offset:40960
ds_read_b64_tr_b16 a[180:181],v13 offset:40960
ds_read_b64_tr_b16 a[54:55],v12 offset:45056
ds_read_b64_tr_b16 a[182:183],v13 offset:45056
s_waitcnt lgkmcnt(4)
ds_read_b64_tr_b16 a[56:57],v12 offset:49152
ds_read_b64_tr_b16 a[184:185],v13 offset:49152
ds_read_b64_tr_b16 a[58:59],v12 offset:53248
ds_read_b64_tr_b16 a[186:187],v13 offset:53248
ds_read_b64_tr_b16 a[60:61],v12 offset:57344
ds_read_b64_tr_b16 a[188:189],v13 offset:57344
ds_read_b64_tr_b16 a[62:63],v12 offset:61440
ds_read_b64_tr_b16 a[190:191],v13 offset:61440
s_waitcnt lgkmcnt(4)
v_xor_b32 v12,0x10000,v12
v_xor_b32 v13,0x10000,v13
s_waitcnt lgkmcnt(0)
s_barrier
s_add_u32 s64,s74,1572864
s_add_u32 m0,s75,65536
s_nop 0
buffer_load_dwordx4 v8,s[32:35],s64 offen nt lds
s_add_u32 s64,s74,1581056
s_add_u32 m0,s75,66560
s_nop 0
buffer_load_dwordx4 v9,s[32:35],s64 offen nt lds
s_add_u32 s64,s74,1589248
s_add_u32 m0,s75,67584
s_nop 0
buffer_load_dwordx4 v8,s[32:35],s64 offen nt lds
s_add_u32 s64,s74,1597440
s_add_u32 m0,s75,68608
s_nop 0
buffer_load_dwordx4 v9,s[32:35],s64 offen nt lds
s_add_u32 s64,s74,1605632
s_add_u32 m0,s75,69632
s_nop 0
buffer_load_dwordx4 v8,s[32:35],s64 offen nt lds
s_add_u32 s64,s74,1613824
s_add_u32 m0,s75,70656
s_nop 0
buffer_load_dwordx4 v9,s[32:35],s64 offen nt lds
s_add_u32 s64,s74,1622016
s_add_u32 m0,s75,71680
s_nop 0
buffer_load_dwordx4 v8,s[32:35],s64 offen nt lds
s_add_u32 s64,s74,1630208
s_add_u32 m0,s75,72704
s_nop 0
buffer_load_dwordx4 v9,s[32:35],s64 offen nt lds
s_add_u32 s64,s74,1638400
s_add_u32 m0,s75,73728
s_nop 0
buffer_load_dwordx4 v8,s[32:35],s64 offen nt lds
s_add_u32 s64,s74,1646592
s_add_u32 m0,s75,74752
s_nop 0
buffer_load_dwordx4 v9,s[32:35],s64 offen nt lds
s_add_u32 s64,s74,1654784
s_add_u32 m0,s75,75776
s_nop 0
buffer_load_dwordx4 v8,s[32:35],s64 offen nt lds
s_add_u32 s64,s74,1662976
s_add_u32 m0,s75,76800
s_nop 0
buffer_load_dwordx4 v9,s[32:35],s64 offen nt lds
s_add_u32 s64,s74,1671168
s_add_u32 m0,s75,77824
s_nop 0
buffer_load_dwordx4 v8,s[32:35],s64 offen nt lds
s_add_u32 s64,s74,1679360
s_add_u32 m0,s75,78848
s_nop 0
buffer_load_dwordx4 v9,s[32:35],s64 offen nt lds
s_add_u32 s64,s74,1687552
s_add_u32 m0,s75,79872
s_nop 0
buffer_load_dwordx4 v8,s[32:35],s64 offen nt lds
s_add_u32 s64,s74,1695744
s_add_u32 m0,s75,80896
s_nop 0
buffer_load_dwordx4 v9,s[32:35],s64 offen nt lds
s_waitcnt vmcnt(16)
s_barrier
ds_read_b64_tr_b16 a[64:65],v12 offset:0
ds_read_b64_tr_b16 a[192:193],v13 offset:0
ds_read_b64_tr_b16 a[66:67],v12 offset:4096
ds_read_b64_tr_b16 a[194:195],v13 offset:4096
ds_read_b64_tr_b16 a[68:69],v12 offset:8192
ds_read_b64_tr_b16 a[196:197],v13 offset:8192
ds_read_b64_tr_b16 a[70:71],v12 offset:12288
ds_read_b64_tr_b16 a[198:199],v13 offset:12288
s_waitcnt lgkmcnt(4)
ds_read_b64_tr_b16 a[72:73],v12 offset:16384
ds_read_b64_tr_b16 a[200:201],v13 offset:16384
ds_read_b64_tr_b16 a[74:75],v12 offset:20480
ds_read_b64_tr_b16 a[202:203],v13 offset:20480
ds_read_b64_tr_b16 a[76:77],v12 offset:24576
ds_read_b64_tr_b16 a[204:205],v13 offset:24576
ds_read_b64_tr_b16 a[78:79],v12 offset:28672
ds_read_b64_tr_b16 a[206:207],v13 offset:28672
s_waitcnt lgkmcnt(4)
ds_read_b64_tr_b16 a[80:81],v12 offset:32768
ds_read_b64_tr_b16 a[208:209],v13 offset:32768
ds_read_b64_tr_b16 a[82:83],v12 offset:36864
ds_read_b64_tr_b16 a[210:211],v13 offset:36864
ds_read_b64_tr_b16 a[84:85],v12 offset:40960
ds_read_b64_tr_b16 a[212:213],v13 offset:40960
ds_read_b64_tr_b16 a[86:87],v12 offset:45056
ds_read_b64_tr_b16 a[214:215],v13 offset:45056
s_waitcnt lgkmcnt(4)
ds_read_b64_tr_b16 a[88:89],v12 offset:49152
ds_read_b64_tr_b16 a[216:217],v13 offset:49152
ds_read_b64_tr_b16 a[90:91],v12 offset:53248
ds_read_b64_tr_b16 a[218:219],v13 offset:53248
ds_read_b64_tr_b16 a[92:93],v12 offset:57344
ds_read_b64_tr_b16 a[220:221],v13 offset:57344
ds_read_b64_tr_b16 a[94:95],v12 offset:61440
ds_read_b64_tr_b16 a[222:223],v13 offset:61440
s_waitcnt lgkmcnt(4)
v_xor_b32 v12,0x10000,v12
v_xor_b32 v13,0x10000,v13
s_waitcnt lgkmcnt(0)
s_barrier
s_waitcnt vmcnt(0)
s_barrier
ds_read_b64_tr_b16 a[96:97],v12 offset:0
ds_read_b64_tr_b16 a[224:225],v13 offset:0
ds_read_b64_tr_b16 a[98:99],v12 offset:4096
ds_read_b64_tr_b16 a[226:227],v13 offset:4096
ds_read_b64_tr_b16 a[100:101],v12 offset:8192
ds_read_b64_tr_b16 a[228:229],v13 offset:8192
ds_read_b64_tr_b16 a[102:103],v12 offset:12288
ds_read_b64_tr_b16 a[230:231],v13 offset:12288
s_waitcnt lgkmcnt(4)
ds_read_b64_tr_b16 a[104:105],v12 offset:16384
ds_read_b64_tr_b16 a[232:233],v13 offset:16384
ds_read_b64_tr_b16 a[106:107],v12 offset:20480
ds_read_b64_tr_b16 a[234:235],v13 offset:20480
ds_read_b64_tr_b16 a[108:109],v12 offset:24576
ds_read_b64_tr_b16 a[236:237],v13 offset:24576
ds_read_b64_tr_b16 a[110:111],v12 offset:28672
ds_read_b64_tr_b16 a[238:239],v13 offset:28672
s_waitcnt lgkmcnt(4)
ds_read_b64_tr_b16 a[112:113],v12 offset:32768
ds_read_b64_tr_b16 a[240:241],v13 offset:32768
ds_read_b64_tr_b16 a[114:115],v12 offset:36864
ds_read_b64_tr_b16 a[242:243],v13 offset:36864
ds_read_b64_tr_b16 a[116:117],v12 offset:40960
ds_read_b64_tr_b16 a[244:245],v13 offset:40960
ds_read_b64_tr_b16 a[118:119],v12 offset:45056
ds_read_b64_tr_b16 a[246:247],v13 offset:45056
s_waitcnt lgkmcnt(4)
ds_read_b64_tr_b16 a[120:121],v12 offset:49152
ds_read_b64_tr_b16 a[248:249],v13 offset:49152
ds_read_b64_tr_b16 a[122:123],v12 offset:53248
ds_read_b64_tr_b16 a[250:251],v13 offset:53248
ds_read_b64_tr_b16 a[124:125],v12 offset:57344
ds_read_b64_tr_b16 a[252:253],v13 offset:57344
ds_read_b64_tr_b16 a[126:127],v12 offset:61440
ds_read_b64_tr_b16 a[254:255],v13 offset:61440
s_waitcnt lgkmcnt(4)
v_xor_b32 v12,0x10000,v12
v_xor_b32 v13,0x10000,v13
s_waitcnt lgkmcnt(0)
s_barrier
v_and_b32 v21,1,v1
v_mul_u32_u24 v21,960,v21
s_mov_b32 s65,21052032
s_mov_b32 s66,1792
pl_273:
buffer_load_dword v22,v21,s[20:23],s65 offen sc1
s_waitcnt vmcnt(0)
v_cmp_gt_u32 vcc,s66,v22
s_cbranch_vccz pok_274
s_sleep 1
s_sub_u32 s90,s90,1
s_cmp_gt_i32 s90,0
s_cbranch_scc1 pl_273
pok_274:
s_lshr_b32 s43,s41,1
s_and_b32 s48,s41,1
s_lshl_b32 s64,s42,7
s_lshl_b32 s65,s50,5
s_add_u32 s64,s64,s65
s_lshl_b32 s65,s48,4
s_add_u32 s64,s64,s65
v_lshl_add_u32 v5,v4,2,s64
v_lshlrev_b32 v6,2,v5
s_mov_b32 s64,8192
buffer_load_dwordx4 v[52:55],v6,s[20:23],s64 offen sc1
v_lshlrev_b32 v10,1,v5
v_and_b32 v6,3,v1
v_sub_u32 v5,v6,v4
v_lshl_add_u32 v5,v5,3,v10
v_lshrrev_b32 v11,2,v1
v_lshl_add_u32 v40,v6,4,v11
v_lshlrev_b32 v40,2,v40
v_lshl_add_u32 v41,v3,2,v4
v_lshlrev_b32 v41,2,v41
s_lshl_b32 s64,s43,10
v_add_u32 v17,s64,v16
v_xor_b32 v18,1024,v17
s_xor_b32 s64,s64,1024
s_lshr_b32 s65,s50,1
s_and_b32 s66,s50,1
s_lshl_b32 s66,s66,12
s_add_u32 s66,s66,s64
s_lshl_b32 s72,s65,13
s_add_u32 s72,s72,s66
s_add_u32 s72,s72,0x10000
s_lshl_b32 s65,s65,14
s_add_u32 s75,s65,s66
s_add_u32 s75,s75,524288
s_mul_i32 s64,s41,131072
s_add_u32 s75,s75,s64
s_cmp_lt_u32 s50,2
s_cselect_b32 s86,98304,0x40000000
s_lshl_b32 s76,s79,21
s_add_u32 s76,s76,27262976
s_mov_b32 s77,0
s_lshl_b32 s78,s79,16
s_mov_b32 s49,0
s_cmp_eq_u32 s79,0
s_mov_b32 s66,8577024
s_cselect_b32 s66,17825792,s66
s_lshl_b32 s64,s59,14
s_lshl_b32 s65,s50,12
s_add_u32 s65,s65,s66
s_add_u32 s64,s64,s65
v_add_u32 v26,s64,v16
s_lshl_b32 s64,s42,14
s_add_u32 s64,s64,s65
v_add_u32 v25,s64,v16
s_xor_b32 s33,s41,1
s_xor_b32 s34,s41,2
s_xor_b32 s35,s41,3
s_lshl_b32 s33,s33,17
s_lshl_b32 s34,s34,17
s_lshl_b32 s35,s35,17
v_and_b32 v21,7,v1
v_lshlrev_b32 v21,7,v21
v_bfe_u32 v6,v1,3,0
v_lshl_add_u32 v21,v6,2,v21
s_lshl_b32 s74,s41,10
s_add_u32 s74,s74,s63
s_lshl_b32 s64,s60,4
s_add_u32 s74,s74,s64
s_add_u32 s74,s74,16384
v_lshrrev_b32 v6,2,v11
v_and_b32 v7,3,v11
v_lshl_add_u32 v6,v6,1,s43
v_lshl_add_u32 v8,v6,2,v7
v_lshl_add_u32 v8,v8,7,v5
v_and_b32 v8,2047,v8
v_lshl_add_u32 v8,v7,11,v8
v_lshl_add_u32 v7,v7,11,v5
v_lshl_add_u32 v20,v6,13,v7
v_lshl_add_u32 v19,v6,14,v8
v_add_u32 v19,1048576,v19
s_lshl_b32 s73,s59,2
s_add_u32 s73,s73,s50
s_lshl_b32 s73,s73,2
s_add_u32 s73,s73,s63
s_add_u32 s73,s73,2048
s_mov_b32 s48,1
s_waitcnt vmcnt(0)
s_cmp_lg_u32 s56,0
s_cbranch_scc1 kslow_275
s_add_u32 s64,s79,0
s_lshl_b32 s70,s64,21
s_lshl_b32 s64,s64,13
s_and_b32 s64,s64,0x2000
s_xor_b32 s64,s64,s62
s_add_u32 s70,s70,s64
s_add_u32 s70,s70,29360128
s_mov_b32 s83,1
s_mov_b32 s87,s74
s_cmp_eq_u32 s50,0
s_cselect_b32 s74,s74,0x7fff0000
v_mov_b32 v47,132096
s_lshl_b32 s64,s50,3
s_add_u32 s64,s64,132096
v_mov_b32 v46,s64
v_mov_b32 v29,0
s_mov_b32 s97,0x7fff0000
seg_277:
s_cmp_eq_u32 s83,0
s_cbranch_scc1 ahead_278
s_add_u32 s94,s70,s75
s_xor_b32 s95,s94,1024
s_xor_b32 s91,s72,0x10000
s_waitcnt vmcnt(2)
v_cmp_gt_u32 vcc,s71,v29
s_cbranch_vccz nb_281
s_waitcnt vmcnt(0)
v_add_u32 v22,s71,-1
buffer_store_dword v22,v23,s[20:23],s97 offen sc1
s_mov_b32 s97,0x7fff0000
s_cmp_lg_u32 s50,0
s_cbranch_scc1 nb_281
buffer_load_dword v32,v21,s[20:23],s74 offen sc1
s_sleep 2
pl_282:
buffer_load_dword v33,v21,s[20:23],s74 offen sc1
s_waitcnt vmcnt(1)
v_cmp_gt_u32 vcc,s71,v32
v_mov_b32 v29,v32
s_cbranch_vccz pok_283
buffer_load_dword v32,v21,s[20:23],s74 offen sc1
s_waitcnt vmcnt(1)
v_cmp_gt_u32 vcc,s71,v33
v_mov_b32 v29,v33
s_cbranch_vccz pok_283
s_sub_u32 s90,s90,1
s_cmp_gt_i32 s90,0
s_cbranch_scc1 pl_282
pok_283:
nb_281:
s_barrier
s_xor_b32 m0,s91,0
s_add_u32 s65,s94,0
buffer_load_dwordx4 v16,s[20:23],s65 offen offset:0 sc1 lds
buffer_load_dwordx4 v16,s[20:23],s65 offen offset:2048 sc1 lds
s_xor_b32 m0,s91,16384
s_add_u32 s65,s94,32768
buffer_load_dwordx4 v16,s[20:23],s65 offen offset:0 sc1 lds
buffer_load_dwordx4 v16,s[20:23],s65 offen offset:2048 sc1 lds
s_xor_b32 m0,s91,32768
s_add_u32 s65,s94,65536
buffer_load_dwordx4 v16,s[20:23],s65 offen offset:0 sc1 lds
buffer_load_dwordx4 v16,s[20:23],s65 offen offset:2048 sc1 lds
s_xor_b32 m0,s91,49152
s_add_u32 s65,s94,98304
buffer_load_dwordx4 v16,s[20:23],s65 offen offset:0 sc1 lds
buffer_load_dwordx4 v16,s[20:23],s65 offen offset:2048 sc1 lds
s_waitcnt vmcnt(8)
v_add_u32 v22,s71,-1
buffer_store_dword v22,v23,s[20:23],s97 offen sc1
s_mov_b32 s97,0x7fff0000
s_waitcnt vmcnt(7)
s_barrier
ds_read_b128 v[224:227],v18 offset:0
ds_read_b128 v[228:231],v18 offset:2048
ds_read_b128 v[232:235],v18 offset:4096
ds_read_b128 v[236:239],v18 offset:6144
ds_read_b128 v[240:243],v18 offset:8192
ds_read_b128 v[244:247],v18 offset:10240
ds_read_b128 v[248:251],v18 offset:12288
s_waitcnt lgkmcnt(5)
v_mfma_f32_16x16x32_bf16 v[64:67],a[0:3],v[224:227],0
s_xor_b32 m0,s91,1024
s_add_u32 s96,s71,1
v_mfma_f32_16x16x32_bf16 v[68:71],a[128:131],v[224:227],0
ds_read_b128 v[252:255],v18 offset:14336
s_add_u32 s92,s71,2
v_mfma_f32_16x16x32_bf16 v[64:67],a[4:7],v[228:231],v[64:67]
s_add_u32 s65,s95,0
v_min_u32 v27,v224,v228
v_mfma_f32_16x16x32_bf16 v[68:71],a[132:135],v[228:231],v[68:71]
s_waitcnt vmcnt(5)
s_barrier
ds_read_b128 v[224:227],v18 offset:16384
s_waitcnt lgkmcnt(5)
v_mfma_f32_16x16x32_bf16 v[64:67],a[8:11],v[232:235],v[64:67]
buffer_load_dwordx4 v16,s[20:23],s65 offen offset:0 sc1 lds
v_mfma_f32_16x16x32_bf16 v[68:71],a[136:139],v[232:235],v[68:71]
ds_read_b128 v[228:231],v18 offset:18432
v_min3_u32 v27,v27,v232,v236
v_mfma_f32_16x16x32_bf16 v[64:67],a[12:15],v[236:239],v[64:67]
buffer_load_dwordx4 v16,s[20:23],s65 offen offset:2048 sc1 lds
v_mfma_f32_16x16x32_bf16 v[68:71],a[140:143],v[236:239],v[68:71]
ds_read_b128 v[232:235],v18 offset:20480
s_waitcnt lgkmcnt(5)
v_mfma_f32_16x16x32_bf16 v[64:67],a[16:19],v[240:243],v[64:67]
s_xor_b32 m0,s91,17408
v_min3_u32 v27,v27,v240,v244
v_mfma_f32_16x16x32_bf16 v[68:71],a[144:147],v[240:243],v[68:71]
ds_read_b128 v[236:239],v18 offset:22528
v_mfma_f32_16x16x32_bf16 v[64:67],a[20:23],v[244:247],v[64:67]
s_add_u32 s65,s95,32768
v_mfma_f32_16x16x32_bf16 v[68:71],a[148:151],v[244:247],v[68:71]
ds_read_b128 v[240:243],v18 offset:24576
s_waitcnt lgkmcnt(5)
v_mfma_f32_16x16x32_bf16 v[64:67],a[24:27],v[248:251],v[64:67]
buffer_load_dwordx4 v16,s[20:23],s65 offen offset:0 sc1 lds
v_mfma_f32_16x16x32_bf16 v[68:71],a[152:155],v[248:251],v[68:71]
ds_read_b128 v[244:247],v18 offset:26624
v_min3_u32 v27,v27,v248,v252
v_mfma_f32_16x16x32_bf16 v[64:67],a[28:31],v[252:255],v[64:67]
buffer_load_dwordx4 v16,s[20:23],s65 offen offset:2048 sc1 lds
v_mfma_f32_16x16x32_bf16 v[68:71],a[156:159],v[252:255],v[68:71]
ds_read_b128 v[248:251],v18 offset:28672
s_waitcnt lgkmcnt(5)
v_mfma_f32_16x16x32_bf16 v[64:67],a[32:35],v[224:227],v[64:67]
s_xor_b32 m0,s91,33792
v_min3_u32 v27,v27,v224,v228
v_mfma_f32_16x16x32_bf16 v[68:71],a[160:163],v[224:227],v[68:71]
ds_read_b128 v[252:255],v18 offset:30720
v_mfma_f32_16x16x32_bf16 v[64:67],a[36:39],v[228:231],v[64:67]
s_add_u32 s65,s95,65536
s_waitcnt vmcnt(63)
v_mfma_f32_16x16x32_bf16 v[68:71],a[164:167],v[228:231],v[68:71]
s_waitcnt vmcnt(5)
s_barrier
ds_read_b128 v[224:227],v18 offset:32768
s_waitcnt lgkmcnt(5)
v_mfma_f32_16x16x32_bf16 v[64:67],a[40:43],v[232:235],v[64:67]
buffer_load_dwordx4 v16,s[20:23],s65 offen offset:0 sc1 lds
v_min3_u32 v27,v27,v232,v236
v_mfma_f32_16x16x32_bf16 v[68:71],a[168:171],v[232:235],v[68:71]
ds_read_b128 v[228:231],v18 offset:34816
v_cmp_gt_u32 vcc,s96,v29
v_cmp_gt_u32 s[92:93],s92,v29
v_mfma_f32_16x16x32_bf16 v[64:67],a[44:47],v[236:239],v[64:67]
buffer_load_dwordx4 v16,s[20:23],s65 offen offset:2048 sc1 lds
v_mfma_f32_16x16x32_bf16 v[68:71],a[172:175],v[236:239],v[68:71]
ds_read_b128 v[232:235],v18 offset:36864
s_waitcnt lgkmcnt(5)
v_mfma_f32_16x16x32_bf16 v[64:67],a[48:51],v[240:243],v[64:67]
s_xor_b32 m0,s91,50176
v_mov_b32 v44,vcc_lo
v_mov_b32 v45,s92
v_mfma_f32_16x16x32_bf16 v[68:71],a[176:179],v[240:243],v[68:71]
ds_read_b128 v[236:239],v18 offset:38912
ds_write_b64 v46,v[44:45]
v_mfma_f32_16x16x32_bf16 v[64:67],a[52:55],v[244:247],v[64:67]
s_add_u32 s65,s95,98304
v_min3_u32 v27,v27,v240,v244
v_mfma_f32_16x16x32_bf16 v[68:71],a[180:183],v[244:247],v[68:71]
ds_read_b128 v[240:243],v18 offset:40960
s_waitcnt lgkmcnt(6)
v_mfma_f32_16x16x32_bf16 v[64:67],a[56:59],v[248:251],v[64:67]
buffer_load_dwordx4 v16,s[20:23],s65 offen offset:0 sc1 lds
v_mfma_f32_16x16x32_bf16 v[68:71],a[184:187],v[248:251],v[68:71]
ds_read_b128 v[244:247],v18 offset:43008
v_min3_u32 v27,v27,v248,v252
v_mfma_f32_16x16x32_bf16 v[64:67],a[60:63],v[252:255],v[64:67]
buffer_load_dwordx4 v16,s[20:23],s65 offen offset:2048 sc1 lds
v_mfma_f32_16x16x32_bf16 v[68:71],a[188:191],v[252:255],v[68:71]
ds_read_b128 v[248:251],v18 offset:45056
s_waitcnt lgkmcnt(6)
v_mfma_f32_16x16x32_bf16 v[64:67],a[64:67],v[224:227],v[64:67]
v_min3_u32 v27,v27,v224,v228
s_add_u32 s88,s70,s75
v_mfma_f32_16x16x32_bf16 v[68:71],a[192:195],v[224:227],v[68:71]
ds_read_b128 v[252:255],v18 offset:47104
s_add_u32 s88,s88,2097152
v_mfma_f32_16x16x32_bf16 v[64:67],a[68:71],v[228:231],v[64:67]
buffer_load_dwordx2 v[120:121],v20,s[36:39],s78 offen
v_mfma_f32_16x16x32_bf16 v[68:71],a[196:199],v[228:231],v[68:71]
ds_read_b128 v[224:227],v18 offset:49152
s_waitcnt lgkmcnt(6)
v_mfma_f32_16x16x32_bf16 v[64:67],a[72:75],v[232:235],v[64:67]
v_min3_u32 v27,v27,v232,v236
s_xor_b32 s88,s88,0x2000
v_mfma_f32_16x16x32_bf16 v[68:71],a[200:203],v[232:235],v[68:71]
ds_read_b128 v[228:231],v18 offset:51200
s_xor_b32 s89,s88,1024
v_mfma_f32_16x16x32_bf16 v[64:67],a[76:79],v[236:239],v[64:67]
v_mfma_f32_16x16x32_bf16 v[68:71],a[204:207],v[236:239],v[68:71]
ds_read_b128 v[232:235],v18 offset:53248
s_waitcnt lgkmcnt(5)
v_mfma_f32_16x16x32_bf16 v[64:67],a[80:83],v[240:243],v[64:67]
s_waitcnt vmcnt(5)
s_barrier
ds_read_b64 v[44:45],v47
ds_read_b128 v[128:131],v17 offset:0
ds_read_b128 v[132:135],v17 offset:2048
v_mfma_f32_16x16x32_bf16 v[68:71],a[208:211],v[240:243],v[68:71]
ds_read_b128 v[236:239],v18 offset:55296
v_min3_u32 v27,v27,v240,v244
v_mfma_f32_16x16x32_bf16 v[64:67],a[84:87],v[244:247],v[64:67]
ds_read_b128 v[136:139],v17 offset:4096
v_mfma_f32_16x16x32_bf16 v[68:71],a[212:215],v[244:247],v[68:71]
ds_read_b128 v[240:243],v18 offset:57344
s_waitcnt lgkmcnt(9)
v_mfma_f32_16x16x32_bf16 v[64:67],a[88:91],v[248:251],v[64:67]
ds_read_b128 v[140:143],v17 offset:6144
v_min3_u32 v27,v27,v248,v252
v_mfma_f32_16x16x32_bf16 v[68:71],a[216:219],v[248:251],v[68:71]
ds_read_b128 v[244:247],v18 offset:59392
v_mfma_f32_16x16x32_bf16 v[64:67],a[92:95],v[252:255],v[64:67]
ds_read_b128 v[144:147],v17 offset:8192
ds_read_b128 v[148:151],v17 offset:10240
v_mfma_f32_16x16x32_bf16 v[68:71],a[220:223],v[252:255],v[68:71]
ds_read_b128 v[248:251],v18 offset:61440
s_waitcnt lgkmcnt(12)
v_mfma_f32_16x16x32_bf16 v[64:67],a[96:99],v[224:227],v[64:67]
ds_read_b128 v[152:155],v17 offset:12288
s_waitcnt lgkmcnt(11)
v_min3_u32 v27,v27,v224,v228
v_mfma_f32_16x16x32_bf16 v[68:71],a[224:227],v[224:227],v[68:71]
ds_read_b128 v[252:255],v18 offset:63488
v_readfirstlane_b32 s93,v45
v_mfma_f32_16x16x32_bf16 v[64:67],a[100:103],v[228:231],v[64:67]
ds_read_b128 v[156:159],v17 offset:14336
v_readfirstlane_b32 s83,v44
s_cmp_lg_u32 s83,0
s_cbranch_scc0 keep_284
v_mfma_f32_16x16x32_bf16 v[68:71],a[228:231],v[228:231],v[68:71]
s_waitcnt lgkmcnt(10)
v_mfma_f32_16x16x32_bf16 v[64:67],a[104:107],v[232:235],v[64:67]
ds_read_b128 v[160:163],v17 offset:16384
ds_read_b128 v[164:167],v17 offset:18432
v_mfma_f32_16x16x32_bf16 v[68:71],a[232:235],v[232:235],v[68:71]
v_min3_u32 v27,v27,v232,v236
v_mfma_f32_16x16x32_bf16 v[64:67],a[108:111],v[236:239],v[64:67]
ds_read_b128 v[168:171],v17 offset:20480
v_mfma_f32_16x16x32_bf16 v[68:71],a[236:239],v[236:239],v[68:71]
s_waitcnt lgkmcnt(9)
v_mfma_f32_16x16x32_bf16 v[64:67],a[112:115],v[240:243],v[64:67]
ds_read_b128 v[172:175],v17 offset:22528
v_min3_u32 v27,v27,v240,v244
v_mfma_f32_16x16x32_bf16 v[68:71],a[240:243],v[240:243],v[68:71]
v_mfma_f32_16x16x32_bf16 v[64:67],a[116:119],v[244:247],v[64:67]
ds_read_b128 v[176:179],v17 offset:24576
ds_read_b128 v[180:183],v17 offset:26624
v_mfma_f32_16x16x32_bf16 v[68:71],a[244:247],v[244:247],v[68:71]
s_waitcnt lgkmcnt(7)
v_mfma_f32_16x16x32_bf16 v[64:67],a[120:123],v[248:251],v[64:67]
ds_read_b128 v[184:187],v17 offset:28672
v_min3_u32 v27,v27,v248,v252
v_mfma_f32_16x16x32_bf16 v[68:71],a[248:251],v[248:251],v[68:71]
v_mfma_f32_16x16x32_bf16 v[64:67],a[124:127],v[252:255],v[64:67]
ds_read_b128 v[188:191],v17 offset:30720
v_mfma_f32_16x16x32_bf16 v[68:71],a[252:255],v[252:255],v[68:71]
v_mfma_f32_16x16x32_bf16 v[72:75],a[128:131],v[128:131],0
v_cmp_eq_u32 vcc,0,v27
s_cbranch_vccnz retry_276
v_mfma_f32_16x16x32_bf16 v[76:79],a[132:135],v[132:135],0
v_min3_u32 v27,v27,v128,v132
v_mfma_f32_16x16x32_bf16 v[72:75],a[136:139],v[136:139],v[72:75]
s_waitcnt vmcnt(1)
s_barrier
ds_read_b128 v[192:195],v17 offset:32768
v_mfma_f32_16x16x32_bf16 v[76:79],a[140:143],v[140:143],v[76:79]
ds_read_b128 v[196:199],v17 offset:34816
s_waitcnt lgkmcnt(10)
v_mfma_f32_16x16x32_bf16 v[72:75],a[144:147],v[144:147],v[72:75]
ds_read_b128 v[200:203],v17 offset:36864
v_min3_u32 v27,v27,v136,v140
s_waitcnt vmcnt(0)
v_mfma_f32_16x16x32_bf16 v[76:79],a[148:151],v[148:151],v[76:79]
ds_read_b128 v[204:207],v17 offset:38912
v_min3_u32 v27,v27,v144,v148
v_and_or_b32 v64,v64,-4,s48
v_mfma_f32_16x16x32_bf16 v[72:75],a[152:155],v[152:155],v[72:75]
ds_read_b128 v[208:211],v17 offset:40960
s_add_u32 s64,s49,s34
v_mfma_f32_16x16x32_bf16 v[76:79],a[156:159],v[156:159],v[76:79]
v_min3_u32 v27,v27,v152,v156
s_waitcnt lgkmcnt(9)
v_mfma_f32_16x16x32_bf16 v[72:75],a[160:163],v[160:163],v[72:75]
ds_read_b128 v[212:215],v17 offset:43008
buffer_store_dwordx4 v[64:67],v25,s[20:23],s64 offen offset:2048
v_mfma_f32_16x16x32_bf16 v[76:79],a[164:167],v[164:167],v[76:79]
ds_read_b128 v[216:219],v17 offset:45056
v_min3_u32 v27,v27,v160,v164
v_and_or_b32 v68,v68,-4,s48
v_mfma_f32_16x16x32_bf16 v[72:75],a[168:171],v[168:171],v[72:75]
ds_read_b128 v[220:223],v17 offset:47104
s_add_u32 s64,s49,s35
v_mfma_f32_16x16x32_bf16 v[76:79],a[172:175],v[172:175],v[76:79]
ds_read_b128 v[224:227],v17 offset:49152
s_waitcnt lgkmcnt(9)
v_mfma_f32_16x16x32_bf16 v[72:75],a[176:179],v[176:179],v[72:75]
ds_read_b128 v[228:231],v17 offset:51200
v_min3_u32 v27,v27,v168,v172
v_mfma_f32_16x16x32_bf16 v[76:79],a[180:183],v[180:183],v[76:79]
v_min3_u32 v27,v27,v176,v180
buffer_store_dwordx4 v[68:71],v25,s[20:23],s64 offen offset:3072
v_mfma_f32_16x16x32_bf16 v[72:75],a[184:187],v[184:187],v[72:75]
ds_read_b128 v[232:235],v17 offset:53248
s_mov_b32 s49,0x7fff0000
v_mfma_f32_16x16x32_bf16 v[76:79],a[188:191],v[188:191],v[76:79]
ds_read_b128 v[236:239],v17 offset:55296
s_waitcnt lgkmcnt(8)
v_mfma_f32_16x16x32_bf16 v[72:75],a[192:195],v[192:195],v[72:75]
ds_read_b128 v[240:243],v17 offset:57344
v_min3_u32 v27,v27,v184,v188
v_mfma_f32_16x16x32_bf16 v[76:79],a[196:199],v[196:199],v[76:79]
ds_read_b128 v[244:247],v17 offset:59392
v_min3_u32 v27,v27,v192,v196
v_mfma_f32_16x16x32_bf16 v[72:75],a[200:203],v[200:203],v[72:75]
ds_read_b128 v[248:251],v17 offset:61440
ds_bpermute_b32 v124,v41,v120
v_mfma_f32_16x16x32_bf16 v[76:79],a[204:207],v[204:207],v[76:79]
v_min3_u32 v27,v27,v200,v204
s_waitcnt lgkmcnt(8)
v_mfma_f32_16x16x32_bf16 v[72:75],a[208:211],v[208:211],v[72:75]
ds_read_b128 v[252:255],v17 offset:63488
ds_bpermute_b32 v125,v41,v121
v_mfma_f32_16x16x32_bf16 v[76:79],a[212:215],v[212:215],v[76:79]
v_min3_u32 v27,v27,v208,v212
v_mfma_f32_16x16x32_bf16 v[72:75],a[216:219],v[216:219],v[72:75]
v_mfma_f32_16x16x32_bf16 v[76:79],a[220:223],v[220:223],v[76:79]
v_min3_u32 v27,v27,v216,v220
s_waitcnt lgkmcnt(6)
v_mfma_f32_16x16x32_bf16 v[72:75],a[224:227],v[224:227],v[72:75]
s_waitcnt lgkmcnt(0)
v_mfma_f32_16x16x32_bf16 v[76:79],a[228:231],v[228:231],v[76:79]
v_min3_u32 v27,v27,v224,v228
v_mfma_f32_16x16x32_bf16 v[72:75],a[232:235],v[232:235],v[72:75]
v_lshlrev_b32 v104,16,v124
v_mfma_f32_16x16x32_bf16 v[76:79],a[236:239],v[236:239],v[76:79]
v_min3_u32 v27,v27,v232,v236
v_mfma_f32_16x16x32_bf16 v[72:75],a[240:243],v[240:243],v[72:75]
v_mfma_f32_16x16x32_bf16 v[76:79],a[244:247],v[244:247],v[76:79]
v_min3_u32 v27,v27,v240,v244
v_mfma_f32_16x16x32_bf16 v[72:75],a[248:251],v[248:251],v[72:75]
v_and_b32 v105,s80,v124
v_mfma_f32_16x16x32_bf16 v[76:79],a[252:255],v[252:255],v[76:79]
v_min3_u32 v27,v27,v248,v252
v_mfma_f32_16x16x32_bf16 v[80:83],a[0:3],v[128:131],0
v_cmp_eq_u32 vcc,0,v27
s_cbranch_vccnz retry_276
v_mfma_f32_16x16x32_bf16 v[84:87],a[4:7],v[132:135],0
v_lshlrev_b32 v106,16,v125
v_mfma_f32_16x16x32_bf16 v[80:83],a[8:11],v[136:139],v[80:83]
v_mfma_f32_16x16x32_bf16 v[84:87],a[12:15],v[140:143],v[84:87]
v_mfma_f32_16x16x32_bf16 v[80:83],a[16:19],v[144:147],v[80:83]
v_and_b32 v107,s80,v125
v_add_f32 v72,v72,v76
v_mfma_f32_16x16x32_bf16 v[84:87],a[20:23],v[148:151],v[84:87]
v_add_f32 v73,v73,v77
v_add_f32 v74,v74,v78
v_mfma_f32_16x16x32_bf16 v[80:83],a[24:27],v[152:155],v[80:83]
v_add_f32 v75,v75,v79
v_and_or_b32 v72,v72,-4,s48
v_mfma_f32_16x16x32_bf16 v[84:87],a[28:31],v[156:159],v[84:87]
s_add_u32 s64,s77,s33
v_mfma_f32_16x16x32_bf16 v[80:83],a[32:35],v[160:163],v[80:83]
buffer_store_dwordx4 v[72:75],v25,s[20:23],s64 offen offset:1024
v_mfma_f32_16x16x32_bf16 v[84:87],a[36:39],v[164:167],v[84:87]
v_mfma_f32_16x16x32_bf16 v[80:83],a[40:43],v[168:171],v[80:83]
v_mfma_f32_16x16x32_bf16 v[84:87],a[44:47],v[172:175],v[84:87]
v_mfma_f32_16x16x32_bf16 v[80:83],a[48:51],v[176:179],v[80:83]
v_mfma_f32_16x16x32_bf16 v[84:87],a[52:55],v[180:183],v[84:87]
v_mfma_f32_16x16x32_bf16 v[80:83],a[56:59],v[184:187],v[80:83]
v_mfma_f32_16x16x32_bf16 v[84:87],a[60:63],v[188:191],v[84:87]
v_mfma_f32_16x16x32_bf16 v[80:83],a[64:67],v[192:195],v[80:83]
buffer_load_dwordx4 v[96:99],v26,s[20:23],s77 offen offset:2048 sc1
v_mfma_f32_16x16x32_bf16 v[84:87],a[68:71],v[196:199],v[84:87]
buffer_load_dwordx4 v[100:103],v26,s[20:23],s77 offen offset:3072 sc1
v_mfma_f32_16x16x32_bf16 v[80:83],a[72:75],v[200:203],v[80:83]
v_mfma_f32_16x16x32_bf16 v[84:87],a[76:79],v[204:207],v[84:87]
v_mfma_f32_16x16x32_bf16 v[80:83],a[80:83],v[208:211],v[80:83]
v_mfma_f32_16x16x32_bf16 v[84:87],a[84:87],v[212:215],v[84:87]
v_mfma_f32_16x16x32_bf16 v[80:83],a[88:91],v[216:219],v[80:83]
v_mfma_f32_16x16x32_bf16 v[84:87],a[92:95],v[220:223],v[84:87]
v_mfma_f32_16x16x32_bf16 v[80:83],a[96:99],v[224:227],v[80:83]
v_mfma_f32_16x16x32_bf16 v[84:87],a[100:103],v[228:231],v[84:87]
v_mfma_f32_16x16x32_bf16 v[80:83],a[104:107],v[232:235],v[80:83]
buffer_load_dwordx4 v[92:95],v26,s[20:23],s77 offen offset:1024 sc1
v_mfma_f32_16x16x32_bf16 v[84:87],a[108:111],v[236:239],v[84:87]
v_mfma_f32_16x16x32_bf16 v[80:83],a[112:115],v[240:243],v[80:83]
v_mfma_f32_16x16x32_bf16 v[84:87],a[116:119],v[244:247],v[84:87]
v_mfma_f32_16x16x32_bf16 v[80:83],a[120:123],v[248:251],v[80:83]
v_mfma_f32_16x16x32_bf16 v[84:87],a[124:127],v[252:255],v[84:87]
s_branch epi_279
keep_284:
v_mfma_f32_16x16x32_bf16 v[68:71],a[228:231],v[228:231],v[68:71]
s_xor_b32 m0,s72,0
s_waitcnt lgkmcnt(10)
v_mfma_f32_16x16x32_bf16 v[64:67],a[104:107],v[232:235],v[64:67]
ds_read_b128 v[160:163],v17 offset:16384
ds_read_b128 v[164:167],v17 offset:18432
v_mfma_f32_16x16x32_bf16 v[68:71],a[232:235],v[232:235],v[68:71]
s_add_u32 s65,s88,0
v_min3_u32 v27,v27,v232,v236
v_mfma_f32_16x16x32_bf16 v[64:67],a[108:111],v[236:239],v[64:67]
ds_read_b128 v[168:171],v17 offset:20480
v_mfma_f32_16x16x32_bf16 v[68:71],a[236:239],v[236:239],v[68:71]
s_waitcnt lgkmcnt(9)
v_mfma_f32_16x16x32_bf16 v[64:67],a[112:115],v[240:243],v[64:67]
ds_read_b128 v[172:175],v17 offset:22528
v_min3_u32 v27,v27,v240,v244
v_mfma_f32_16x16x32_bf16 v[68:71],a[240:243],v[240:243],v[68:71]
buffer_load_dwordx4 v16,s[20:23],s65 offen offset:0 sc1 lds
v_mfma_f32_16x16x32_bf16 v[64:67],a[116:119],v[244:247],v[64:67]
ds_read_b128 v[176:179],v17 offset:24576
ds_read_b128 v[180:183],v17 offset:26624
v_mfma_f32_16x16x32_bf16 v[68:71],a[244:247],v[244:247],v[68:71]
s_waitcnt lgkmcnt(7)
v_mfma_f32_16x16x32_bf16 v[64:67],a[120:123],v[248:251],v[64:67]
ds_read_b128 v[184:187],v17 offset:28672
v_min3_u32 v27,v27,v248,v252
v_mfma_f32_16x16x32_bf16 v[68:71],a[248:251],v[248:251],v[68:71]
buffer_load_dwordx4 v16,s[20:23],s65 offen offset:2048 sc1 lds
v_mfma_f32_16x16x32_bf16 v[64:67],a[124:127],v[252:255],v[64:67]
ds_read_b128 v[188:191],v17 offset:30720
s_xor_b32 m0,s72,16384
v_mfma_f32_16x16x32_bf16 v[68:71],a[252:255],v[252:255],v[68:71]
s_add_u32 s65,s88,32768
v_mfma_f32_16x16x32_bf16 v[72:75],a[128:131],v[128:131],0
buffer_load_dwordx4 v16,s[20:23],s65 offen offset:0 sc1 lds
v_cmp_eq_u32 vcc,0,v27
s_cbranch_vccnz retry_276
v_mfma_f32_16x16x32_bf16 v[76:79],a[132:135],v[132:135],0
buffer_load_dwordx4 v16,s[20:23],s65 offen offset:2048 sc1 lds
v_mfma_f32_16x16x32_bf16 v[72:75],a[136:139],v[136:139],v[72:75]
s_waitcnt vmcnt(5)
s_barrier
ds_read_b128 v[192:195],v17 offset:32768
v_mfma_f32_16x16x32_bf16 v[76:79],a[140:143],v[140:143],v[76:79]
ds_read_b128 v[196:199],v17 offset:34816
s_waitcnt lgkmcnt(10)
v_mfma_f32_16x16x32_bf16 v[72:75],a[144:147],v[144:147],v[72:75]
ds_read_b128 v[200:203],v17 offset:36864
s_xor_b32 m0,s72,32768
s_waitcnt vmcnt(4)
v_and_or_b32 v64,v64,-4,s48
v_mfma_f32_16x16x32_bf16 v[76:79],a[148:151],v[148:151],v[76:79]
ds_read_b128 v[204:207],v17 offset:38912
s_add_u32 s65,s88,65536
s_add_u32 s64,s49,s34
v_mfma_f32_16x16x32_bf16 v[72:75],a[152:155],v[152:155],v[72:75]
ds_read_b128 v[208:211],v17 offset:40960
v_min3_u32 v27,v27,v128,v132
buffer_store_dwordx4 v[64:67],v25,s[20:23],s64 offen offset:2048
v_mfma_f32_16x16x32_bf16 v[76:79],a[156:159],v[156:159],v[76:79]
v_min3_u32 v27,v27,v136,v140
v_and_or_b32 v68,v68,-4,s48
s_add_u32 s64,s49,s35
s_waitcnt lgkmcnt(9)
v_mfma_f32_16x16x32_bf16 v[72:75],a[160:163],v[160:163],v[72:75]
ds_read_b128 v[212:215],v17 offset:43008
v_min3_u32 v27,v27,v144,v148
buffer_store_dwordx4 v[68:71],v25,s[20:23],s64 offen offset:3072
v_mfma_f32_16x16x32_bf16 v[76:79],a[164:167],v[164:167],v[76:79]
ds_read_b128 v[216:219],v17 offset:45056
v_min3_u32 v27,v27,v152,v156
s_mov_b32 s49,0x7fff0000
v_mfma_f32_16x16x32_bf16 v[72:75],a[168:171],v[168:171],v[72:75]
ds_read_b128 v[220:223],v17 offset:47104
v_min3_u32 v27,v27,v160,v164
v_mfma_f32_16x16x32_bf16 v[76:79],a[172:175],v[172:175],v[76:79]
ds_read_b128 v[224:227],v17 offset:49152
s_waitcnt lgkmcnt(9)
v_mfma_f32_16x16x32_bf16 v[72:75],a[176:179],v[176:179],v[72:75]
ds_read_b128 v[228:231],v17 offset:51200
v_min3_u32 v27,v27,v168,v172
v_mfma_f32_16x16x32_bf16 v[76:79],a[180:183],v[180:183],v[76:79]
buffer_load_dwordx4 v16,s[20:23],s65 offen offset:0 sc1 lds
v_mfma_f32_16x16x32_bf16 v[72:75],a[184:187],v[184:187],v[72:75]
ds_read_b128 v[232:235],v17 offset:53248
v_min3_u32 v27,v27,v176,v180
v_mfma_f32_16x16x32_bf16 v[76:79],a[188:191],v[188:191],v[76:79]
ds_read_b128 v[236:239],v17 offset:55296
s_waitcnt lgkmcnt(8)
v_mfma_f32_16x16x32_bf16 v[72:75],a[192:195],v[192:195],v[72:75]
ds_read_b128 v[240:243],v17 offset:57344
v_min3_u32 v27,v27,v184,v188
v_mfma_f32_16x16x32_bf16 v[76:79],a[196:199],v[196:199],v[76:79]
ds_read_b128 v[244:247],v17 offset:59392
v_min3_u32 v27,v27,v192,v196
v_mfma_f32_16x16x32_bf16 v[72:75],a[200:203],v[200:203],v[72:75]
ds_read_b128 v[248:251],v17 offset:61440
ds_bpermute_b32 v124,v41,v120
v_mfma_f32_16x16x32_bf16 v[76:79],a[204:207],v[204:207],v[76:79]
v_min3_u32 v27,v27,v200,v204
s_waitcnt lgkmcnt(8)
v_mfma_f32_16x16x32_bf16 v[72:75],a[208:211],v[208:211],v[72:75]
ds_read_b128 v[252:255],v17 offset:63488
ds_bpermute_b32 v125,v41,v121
v_mfma_f32_16x16x32_bf16 v[76:79],a[212:215],v[212:215],v[76:79]
buffer_load_dwordx4 v16,s[20:23],s65 offen offset:2048 sc1 lds
v_mfma_f32_16x16x32_bf16 v[72:75],a[216:219],v[216:219],v[72:75]
s_xor_b32 m0,s72,49152
s_add_u32 s65,s88,98304
v_mfma_f32_16x16x32_bf16 v[76:79],a[220:223],v[220:223],v[76:79]
v_min3_u32 v27,v27,v208,v212
s_waitcnt lgkmcnt(6)
v_mfma_f32_16x16x32_bf16 v[72:75],a[224:227],v[224:227],v[72:75]
buffer_load_dwordx4 v16,s[20:23],s65 offen offset:0 sc1 lds
v_mfma_f32_16x16x32_bf16 v[76:79],a[228:231],v[228:231],v[76:79]
buffer_load_dwordx4 v16,s[20:23],s65 offen offset:2048 sc1 lds
v_min3_u32 v27,v27,v224,v228
v_mfma_f32_16x16x32_bf16 v[72:75],a[232:235],v[232:235],v[72:75]
s_xor_b32 m0,s72,1024
s_add_u32 s65,s89,0
v_mfma_f32_16x16x32_bf16 v[76:79],a[236:239],v[236:239],v[76:79]
v_min3_u32 v27,v27,v216,v220
v_min3_u32 v27,v27,v232,v236
s_waitcnt lgkmcnt(1)
v_mfma_f32_16x16x32_bf16 v[72:75],a[240:243],v[240:243],v[72:75]
buffer_load_dwordx4 v16,s[20:23],s65 offen offset:0 sc1 lds
v_mfma_f32_16x16x32_bf16 v[76:79],a[244:247],v[244:247],v[76:79]
buffer_load_dwordx4 v16,s[20:23],s65 offen offset:2048 sc1 lds
v_min3_u32 v27,v27,v240,v244
v_mfma_f32_16x16x32_bf16 v[72:75],a[248:251],v[248:251],v[72:75]
s_xor_b32 m0,s72,17408
s_add_u32 s65,s89,32768
v_mfma_f32_16x16x32_bf16 v[76:79],a[252:255],v[252:255],v[76:79]
buffer_load_dwordx4 v16,s[20:23],s65 offen offset:0 sc1 lds
v_min3_u32 v27,v27,v248,v252
v_mfma_f32_16x16x32_bf16 v[80:83],a[0:3],v[128:131],0
buffer_load_dwordx4 v16,s[20:23],s65 offen offset:2048 sc1 lds
v_cmp_eq_u32 vcc,0,v27
s_cbranch_vccnz retry_276
v_mfma_f32_16x16x32_bf16 v[84:87],a[4:7],v[132:135],0
s_xor_b32 m0,s72,33792
s_add_u32 s65,s89,65536
v_mfma_f32_16x16x32_bf16 v[80:83],a[8:11],v[136:139],v[80:83]
buffer_load_dwordx4 v16,s[20:23],s65 offen offset:0 sc1 lds
v_mfma_f32_16x16x32_bf16 v[84:87],a[12:15],v[140:143],v[84:87]
buffer_load_dwordx4 v16,s[20:23],s65 offen offset:2048 sc1 lds
v_mfma_f32_16x16x32_bf16 v[80:83],a[16:19],v[144:147],v[80:83]
s_xor_b32 m0,s72,50176
s_add_u32 s65,s89,98304
v_add_f32 v72,v72,v76
v_mfma_f32_16x16x32_bf16 v[84:87],a[20:23],v[148:151],v[84:87]
buffer_load_dwordx4 v16,s[20:23],s65 offen offset:0 sc1 lds
v_add_f32 v73,v73,v77
v_mfma_f32_16x16x32_bf16 v[80:83],a[24:27],v[152:155],v[80:83]
buffer_load_dwordx4 v16,s[20:23],s65 offen offset:2048 sc1 lds
v_add_f32 v74,v74,v78
v_mfma_f32_16x16x32_bf16 v[84:87],a[28:31],v[156:159],v[84:87]
s_waitcnt lgkmcnt(0)
v_lshlrev_b32 v104,16,v124
v_add_f32 v75,v75,v79
v_mfma_f32_16x16x32_bf16 v[80:83],a[32:35],v[160:163],v[80:83]
v_and_b32 v105,s80,v124
v_lshlrev_b32 v106,16,v125
v_and_or_b32 v72,v72,-4,s48
v_mfma_f32_16x16x32_bf16 v[84:87],a[36:39],v[164:167],v[84:87]
v_and_b32 v107,s80,v125
s_add_u32 s64,s77,s33
v_mfma_f32_16x16x32_bf16 v[80:83],a[40:43],v[168:171],v[80:83]
buffer_store_dwordx4 v[72:75],v25,s[20:23],s64 offen offset:1024
v_mfma_f32_16x16x32_bf16 v[84:87],a[44:47],v[172:175],v[84:87]
v_mfma_f32_16x16x32_bf16 v[80:83],a[48:51],v[176:179],v[80:83]
v_mfma_f32_16x16x32_bf16 v[84:87],a[52:55],v[180:183],v[84:87]
v_mfma_f32_16x16x32_bf16 v[80:83],a[56:59],v[184:187],v[80:83]
v_mfma_f32_16x16x32_bf16 v[84:87],a[60:63],v[188:191],v[84:87]
v_mfma_f32_16x16x32_bf16 v[80:83],a[64:67],v[192:195],v[80:83]
buffer_load_dwordx4 v[96:99],v26,s[20:23],s77 offen offset:2048 sc1
v_mfma_f32_16x16x32_bf16 v[84:87],a[68:71],v[196:199],v[84:87]
buffer_load_dwordx4 v[100:103],v26,s[20:23],s77 offen offset:3072 sc1
v_mfma_f32_16x16x32_bf16 v[80:83],a[72:75],v[200:203],v[80:83]
v_mfma_f32_16x16x32_bf16 v[84:87],a[76:79],v[204:207],v[84:87]
v_mfma_f32_16x16x32_bf16 v[80:83],a[80:83],v[208:211],v[80:83]
v_mfma_f32_16x16x32_bf16 v[84:87],a[84:87],v[212:215],v[84:87]
v_mfma_f32_16x16x32_bf16 v[80:83],a[88:91],v[216:219],v[80:83]
v_mfma_f32_16x16x32_bf16 v[84:87],a[92:95],v[220:223],v[84:87]
v_mfma_f32_16x16x32_bf16 v[80:83],a[96:99],v[224:227],v[80:83]
v_mfma_f32_16x16x32_bf16 v[84:87],a[100:103],v[228:231],v[84:87]
v_mfma_f32_16x16x32_bf16 v[80:83],a[104:107],v[232:235],v[80:83]
buffer_load_dwordx4 v[92:95],v26,s[20:23],s77 offen offset:1024 sc1
v_mfma_f32_16x16x32_bf16 v[84:87],a[108:111],v[236:239],v[84:87]
v_mfma_f32_16x16x32_bf16 v[80:83],a[112:115],v[240:243],v[80:83]
v_mfma_f32_16x16x32_bf16 v[84:87],a[116:119],v[244:247],v[84:87]
v_mfma_f32_16x16x32_bf16 v[80:83],a[120:123],v[248:251],v[80:83]
v_mfma_f32_16x16x32_bf16 v[84:87],a[124:127],v[252:255],v[84:87]
s_branch epi_279
ahead_278:
s_cmp_eq_u32 s93,0
s_cbranch_scc1 both_280
s_waitcnt vmcnt(15) lgkmcnt(0)
s_barrier
ds_read_b128 v[224:227],v18 offset:0
ds_read_b128 v[228:231],v18 offset:2048
ds_read_b128 v[232:235],v18 offset:4096
ds_read_b128 v[236:239],v18 offset:6144
ds_read_b128 v[240:243],v18 offset:8192
ds_read_b128 v[244:247],v18 offset:10240
ds_read_b128 v[248:251],v18 offset:12288
s_waitcnt lgkmcnt(5)
v_mfma_f32_16x16x32_bf16 v[64:67],a[0:3],v[224:227],0
s_add_u32 s96,s71,1
s_add_u32 s92,s71,2
v_mfma_f32_16x16x32_bf16 v[68:71],a[128:131],v[224:227],0
ds_read_b128 v[252:255],v18 offset:14336
v_min_u32 v27,v224,v228
v_mfma_f32_16x16x32_bf16 v[64:67],a[4:7],v[228:231],v[64:67]
buffer_load_dwordx2 v[120:121],v20,s[36:39],s78 offen
v_mfma_f32_16x16x32_bf16 v[68:71],a[132:135],v[228:231],v[68:71]
ds_read_b128 v[224:227],v18 offset:16384
s_waitcnt lgkmcnt(5)
v_mfma_f32_16x16x32_bf16 v[64:67],a[8:11],v[232:235],v[64:67]
v_min3_u32 v27,v27,v232,v236
v_mfma_f32_16x16x32_bf16 v[68:71],a[136:139],v[232:235],v[68:71]
ds_read_b128 v[228:231],v18 offset:18432
v_mfma_f32_16x16x32_bf16 v[64:67],a[12:15],v[236:239],v[64:67]
v_mfma_f32_16x16x32_bf16 v[68:71],a[140:143],v[236:239],v[68:71]
ds_read_b128 v[232:235],v18 offset:20480
s_waitcnt lgkmcnt(5)
v_mfma_f32_16x16x32_bf16 v[64:67],a[16:19],v[240:243],v[64:67]
v_min3_u32 v27,v27,v240,v244
v_mfma_f32_16x16x32_bf16 v[68:71],a[144:147],v[240:243],v[68:71]
ds_read_b128 v[236:239],v18 offset:22528
v_mfma_f32_16x16x32_bf16 v[64:67],a[20:23],v[244:247],v[64:67]
v_mfma_f32_16x16x32_bf16 v[68:71],a[148:151],v[244:247],v[68:71]
ds_read_b128 v[240:243],v18 offset:24576
s_waitcnt lgkmcnt(5)
v_mfma_f32_16x16x32_bf16 v[64:67],a[24:27],v[248:251],v[64:67]
v_min3_u32 v27,v27,v248,v252
v_mfma_f32_16x16x32_bf16 v[68:71],a[152:155],v[248:251],v[68:71]
ds_read_b128 v[244:247],v18 offset:26624
v_mfma_f32_16x16x32_bf16 v[64:67],a[28:31],v[252:255],v[64:67]
v_mfma_f32_16x16x32_bf16 v[68:71],a[156:159],v[252:255],v[68:71]
ds_read_b128 v[248:251],v18 offset:28672
s_waitcnt lgkmcnt(5)
v_mfma_f32_16x16x32_bf16 v[64:67],a[32:35],v[224:227],v[64:67]
v_min3_u32 v27,v27,v224,v228
v_mfma_f32_16x16x32_bf16 v[68:71],a[160:163],v[224:227],v[68:71]
ds_read_b128 v[252:255],v18 offset:30720
v_mfma_f32_16x16x32_bf16 v[64:67],a[36:39],v[228:231],v[64:67]
s_waitcnt vmcnt(3)
v_mfma_f32_16x16x32_bf16 v[68:71],a[164:167],v[228:231],v[68:71]
ds_read_b128 v[224:227],v18 offset:32768
s_waitcnt lgkmcnt(5)
v_mfma_f32_16x16x32_bf16 v[64:67],a[40:43],v[232:235],v[64:67]
v_cmp_gt_u32 vcc,s96,v29
v_cmp_gt_u32 s[92:93],s92,v29
v_mfma_f32_16x16x32_bf16 v[68:71],a[168:171],v[232:235],v[68:71]
ds_read_b128 v[228:231],v18 offset:34816
v_min3_u32 v27,v27,v232,v236
v_mfma_f32_16x16x32_bf16 v[64:67],a[44:47],v[236:239],v[64:67]
v_mov_b32 v44,vcc_lo
v_mov_b32 v45,s92
v_mfma_f32_16x16x32_bf16 v[68:71],a[172:175],v[236:239],v[68:71]
ds_read_b128 v[232:235],v18 offset:36864
s_waitcnt lgkmcnt(5)
v_mfma_f32_16x16x32_bf16 v[64:67],a[48:51],v[240:243],v[64:67]
ds_write_b64 v46,v[44:45]
v_min3_u32 v27,v27,v240,v244
v_mfma_f32_16x16x32_bf16 v[68:71],a[176:179],v[240:243],v[68:71]
ds_read_b128 v[236:239],v18 offset:38912
v_mfma_f32_16x16x32_bf16 v[64:67],a[52:55],v[244:247],v[64:67]
v_mfma_f32_16x16x32_bf16 v[68:71],a[180:183],v[244:247],v[68:71]
ds_read_b128 v[240:243],v18 offset:40960
s_waitcnt lgkmcnt(6)
v_mfma_f32_16x16x32_bf16 v[64:67],a[56:59],v[248:251],v[64:67]
v_min3_u32 v27,v27,v248,v252
s_add_u32 s88,s70,s75
v_mfma_f32_16x16x32_bf16 v[68:71],a[184:187],v[248:251],v[68:71]
ds_read_b128 v[244:247],v18 offset:43008
s_add_u32 s88,s88,2097152
v_mfma_f32_16x16x32_bf16 v[64:67],a[60:63],v[252:255],v[64:67]
s_xor_b32 s88,s88,0x2000
s_xor_b32 s89,s88,1024
v_mfma_f32_16x16x32_bf16 v[68:71],a[188:191],v[252:255],v[68:71]
ds_read_b128 v[248:251],v18 offset:45056
s_waitcnt lgkmcnt(6)
v_mfma_f32_16x16x32_bf16 v[64:67],a[64:67],v[224:227],v[64:67]
v_min3_u32 v27,v27,v224,v228
v_mfma_f32_16x16x32_bf16 v[68:71],a[192:195],v[224:227],v[68:71]
ds_read_b128 v[252:255],v18 offset:47104
v_mfma_f32_16x16x32_bf16 v[64:67],a[68:71],v[228:231],v[64:67]
v_mfma_f32_16x16x32_bf16 v[68:71],a[196:199],v[228:231],v[68:71]
ds_read_b128 v[224:227],v18 offset:49152
s_waitcnt lgkmcnt(5)
v_mfma_f32_16x16x32_bf16 v[64:67],a[72:75],v[232:235],v[64:67]
v_min3_u32 v27,v27,v232,v236
v_mfma_f32_16x16x32_bf16 v[68:71],a[200:203],v[232:235],v[68:71]
ds_read_b128 v[228:231],v18 offset:51200
v_mfma_f32_16x16x32_bf16 v[64:67],a[76:79],v[236:239],v[64:67]
v_mfma_f32_16x16x32_bf16 v[68:71],a[204:207],v[236:239],v[68:71]
ds_read_b128 v[232:235],v18 offset:53248
s_waitcnt lgkmcnt(5)
v_mfma_f32_16x16x32_bf16 v[64:67],a[80:83],v[240:243],v[64:67]
s_waitcnt vmcnt(8)
s_barrier
ds_read_b64 v[44:45],v47
ds_read_b128 v[128:131],v17 offset:0
ds_read_b128 v[132:135],v17 offset:2048
v_mfma_f32_16x16x32_bf16 v[68:71],a[208:211],v[240:243],v[68:71]
ds_read_b128 v[236:239],v18 offset:55296
v_min3_u32 v27,v27,v240,v244
v_mfma_f32_16x16x32_bf16 v[64:67],a[84:87],v[244:247],v[64:67]
ds_read_b128 v[136:139],v17 offset:4096
v_mfma_f32_16x16x32_bf16 v[68:71],a[212:215],v[244:247],v[68:71]
ds_read_b128 v[240:243],v18 offset:57344
s_waitcnt lgkmcnt(9)
v_mfma_f32_16x16x32_bf16 v[64:67],a[88:91],v[248:251],v[64:67]
ds_read_b128 v[140:143],v17 offset:6144
v_min3_u32 v27,v27,v248,v252
v_mfma_f32_16x16x32_bf16 v[68:71],a[216:219],v[248:251],v[68:71]
ds_read_b128 v[244:247],v18 offset:59392
v_mfma_f32_16x16x32_bf16 v[64:67],a[92:95],v[252:255],v[64:67]
ds_read_b128 v[144:147],v17 offset:8192
ds_read_b128 v[148:151],v17 offset:10240
v_mfma_f32_16x16x32_bf16 v[68:71],a[220:223],v[252:255],v[68:71]
ds_read_b128 v[248:251],v18 offset:61440
s_waitcnt lgkmcnt(12)
v_mfma_f32_16x16x32_bf16 v[64:67],a[96:99],v[224:227],v[64:67]
ds_read_b128 v[152:155],v17 offset:12288
s_waitcnt lgkmcnt(11)
v_min3_u32 v27,v27,v224,v228
v_mfma_f32_16x16x32_bf16 v[68:71],a[224:227],v[224:227],v[68:71]
ds_read_b128 v[252:255],v18 offset:63488
v_readfirstlane_b32 s93,v45
v_mfma_f32_16x16x32_bf16 v[64:67],a[100:103],v[228:231],v[64:67]
ds_read_b128 v[156:159],v17 offset:14336
v_readfirstlane_b32 s83,v44
s_cmp_lg_u32 s83,0
s_cbranch_scc1 keep_285
v_mfma_f32_16x16x32_bf16 v[68:71],a[228:231],v[228:231],v[68:71]
s_waitcnt vmcnt(1)
s_xor_b32 m0,s72,0
s_waitcnt lgkmcnt(10)
v_mfma_f32_16x16x32_bf16 v[64:67],a[104:107],v[232:235],v[64:67]
ds_read_b128 v[160:163],v17 offset:16384
ds_read_b128 v[164:167],v17 offset:18432
s_add_u32 s65,s88,0
v_mfma_f32_16x16x32_bf16 v[68:71],a[232:235],v[232:235],v[68:71]
v_add_u32 v22,s71,-1
v_min3_u32 v27,v27,v232,v236
v_mfma_f32_16x16x32_bf16 v[64:67],a[108:111],v[236:239],v[64:67]
ds_read_b128 v[168:171],v17 offset:20480
buffer_load_dwordx4 v16,s[20:23],s65 offen offset:0 sc1 lds
v_mfma_f32_16x16x32_bf16 v[68:71],a[236:239],v[236:239],v[68:71]
s_waitcnt lgkmcnt(9)
v_mfma_f32_16x16x32_bf16 v[64:67],a[112:115],v[240:243],v[64:67]
ds_read_b128 v[172:175],v17 offset:22528
v_min3_u32 v27,v27,v240,v244
v_mfma_f32_16x16x32_bf16 v[68:71],a[240:243],v[240:243],v[68:71]
buffer_store_dword v22,v23,s[20:23],s97 offen sc1
v_mfma_f32_16x16x32_bf16 v[64:67],a[116:119],v[244:247],v[64:67]
ds_read_b128 v[176:179],v17 offset:24576
ds_read_b128 v[180:183],v17 offset:26624
v_mfma_f32_16x16x32_bf16 v[68:71],a[244:247],v[244:247],v[68:71]
s_mov_b32 s97,0x7fff0000
s_waitcnt lgkmcnt(7)
v_mfma_f32_16x16x32_bf16 v[64:67],a[120:123],v[248:251],v[64:67]
ds_read_b128 v[184:187],v17 offset:28672
v_min3_u32 v27,v27,v248,v252
v_mfma_f32_16x16x32_bf16 v[68:71],a[248:251],v[248:251],v[68:71]
buffer_load_dwordx4 v16,s[20:23],s65 offen offset:2048 sc1 lds
v_mfma_f32_16x16x32_bf16 v[64:67],a[124:127],v[252:255],v[64:67]
ds_read_b128 v[188:191],v17 offset:30720
s_xor_b32 m0,s72,16384
v_mfma_f32_16x16x32_bf16 v[68:71],a[252:255],v[252:255],v[68:71]
s_add_u32 s65,s88,32768
v_mfma_f32_16x16x32_bf16 v[72:75],a[128:131],v[128:131],0
buffer_load_dwordx4 v16,s[20:23],s65 offen offset:0 sc1 lds
v_cmp_eq_u32 vcc,0,v27
s_cbranch_vccnz retry_276
v_mfma_f32_16x16x32_bf16 v[76:79],a[132:135],v[132:135],0
buffer_load_dwordx4 v16,s[20:23],s65 offen offset:2048 sc1 lds
v_mfma_f32_16x16x32_bf16 v[72:75],a[136:139],v[136:139],v[72:75]
ds_read_b128 v[192:195],v17 offset:32768
s_xor_b32 m0,s72,32768
v_mfma_f32_16x16x32_bf16 v[76:79],a[140:143],v[140:143],v[76:79]
ds_read_b128 v[196:199],v17 offset:34816
s_waitcnt lgkmcnt(10)
v_mfma_f32_16x16x32_bf16 v[72:75],a[144:147],v[144:147],v[72:75]
ds_read_b128 v[200:203],v17 offset:36864
s_add_u32 s65,s88,65536
s_waitcnt vmcnt(5)
v_and_or_b32 v64,v64,-4,s48
v_mfma_f32_16x16x32_bf16 v[76:79],a[148:151],v[148:151],v[76:79]
ds_read_b128 v[204:207],v17 offset:38912
v_min3_u32 v27,v27,v128,v132
s_add_u32 s64,s49,s34
v_mfma_f32_16x16x32_bf16 v[72:75],a[152:155],v[152:155],v[72:75]
ds_read_b128 v[208:211],v17 offset:40960
v_min3_u32 v27,v27,v136,v140
buffer_store_dwordx4 v[64:67],v25,s[20:23],s64 offen offset:2048
v_mfma_f32_16x16x32_bf16 v[76:79],a[156:159],v[156:159],v[76:79]
v_min3_u32 v27,v27,v144,v148
v_and_or_b32 v68,v68,-4,s48
s_add_u32 s64,s49,s35
s_waitcnt lgkmcnt(9)
v_mfma_f32_16x16x32_bf16 v[72:75],a[160:163],v[160:163],v[72:75]
ds_read_b128 v[212:215],v17 offset:43008
v_min3_u32 v27,v27,v152,v156
buffer_store_dwordx4 v[68:71],v25,s[20:23],s64 offen offset:3072
v_mfma_f32_16x16x32_bf16 v[76:79],a[164:167],v[164:167],v[76:79]
ds_read_b128 v[216:219],v17 offset:45056
v_min3_u32 v27,v27,v160,v164
v_mfma_f32_16x16x32_bf16 v[72:75],a[168:171],v[168:171],v[72:75]
ds_read_b128 v[220:223],v17 offset:47104
s_mov_b32 s49,0x7fff0000
v_mfma_f32_16x16x32_bf16 v[76:79],a[172:175],v[172:175],v[76:79]
ds_read_b128 v[224:227],v17 offset:49152
s_waitcnt lgkmcnt(9)
v_mfma_f32_16x16x32_bf16 v[72:75],a[176:179],v[176:179],v[72:75]
ds_read_b128 v[228:231],v17 offset:51200
v_min3_u32 v27,v27,v168,v172
v_mfma_f32_16x16x32_bf16 v[76:79],a[180:183],v[180:183],v[76:79]
buffer_load_dwordx4 v16,s[20:23],s65 offen offset:0 sc1 lds
v_mfma_f32_16x16x32_bf16 v[72:75],a[184:187],v[184:187],v[72:75]
ds_read_b128 v[232:235],v17 offset:53248
v_min3_u32 v27,v27,v176,v180
v_mfma_f32_16x16x32_bf16 v[76:79],a[188:191],v[188:191],v[76:79]
ds_read_b128 v[236:239],v17 offset:55296
s_waitcnt lgkmcnt(8)
v_mfma_f32_16x16x32_bf16 v[72:75],a[192:195],v[192:195],v[72:75]
ds_read_b128 v[240:243],v17 offset:57344
v_min3_u32 v27,v27,v184,v188
v_mfma_f32_16x16x32_bf16 v[76:79],a[196:199],v[196:199],v[76:79]
ds_read_b128 v[244:247],v17 offset:59392
v_min3_u32 v27,v27,v192,v196
v_mfma_f32_16x16x32_bf16 v[72:75],a[200:203],v[200:203],v[72:75]
ds_read_b128 v[248:251],v17 offset:61440
ds_bpermute_b32 v124,v41,v120
v_mfma_f32_16x16x32_bf16 v[76:79],a[204:207],v[204:207],v[76:79]
v_min3_u32 v27,v27,v200,v204
s_waitcnt lgkmcnt(8)
v_mfma_f32_16x16x32_bf16 v[72:75],a[208:211],v[208:211],v[72:75]
ds_read_b128 v[252:255],v17 offset:63488
ds_bpermute_b32 v125,v41,v121
v_mfma_f32_16x16x32_bf16 v[76:79],a[212:215],v[212:215],v[76:79]
buffer_load_dwordx4 v16,s[20:23],s65 offen offset:2048 sc1 lds
v_mfma_f32_16x16x32_bf16 v[72:75],a[216:219],v[216:219],v[72:75]
s_xor_b32 m0,s72,49152
s_add_u32 s65,s88,98304
v_mfma_f32_16x16x32_bf16 v[76:79],a[220:223],v[220:223],v[76:79]
v_min3_u32 v27,v27,v208,v212
s_waitcnt lgkmcnt(6)
v_mfma_f32_16x16x32_bf16 v[72:75],a[224:227],v[224:227],v[72:75]
buffer_load_dwordx4 v16,s[20:23],s65 offen offset:0 sc1 lds
v_mfma_f32_16x16x32_bf16 v[76:79],a[228:231],v[228:231],v[76:79]
buffer_load_dwordx4 v16,s[20:23],s65 offen offset:2048 sc1 lds
v_min3_u32 v27,v27,v224,v228
v_mfma_f32_16x16x32_bf16 v[72:75],a[232:235],v[232:235],v[72:75]
s_xor_b32 m0,s72,1024
s_add_u32 s65,s89,0
v_mfma_f32_16x16x32_bf16 v[76:79],a[236:239],v[236:239],v[76:79]
v_min3_u32 v27,v27,v216,v220
v_min3_u32 v27,v27,v232,v236
s_waitcnt lgkmcnt(1)
v_mfma_f32_16x16x32_bf16 v[72:75],a[240:243],v[240:243],v[72:75]
buffer_load_dwordx4 v16,s[20:23],s65 offen offset:0 sc1 lds
v_mfma_f32_16x16x32_bf16 v[76:79],a[244:247],v[244:247],v[76:79]
buffer_load_dwordx4 v16,s[20:23],s65 offen offset:2048 sc1 lds
v_min3_u32 v27,v27,v240,v244
v_mfma_f32_16x16x32_bf16 v[72:75],a[248:251],v[248:251],v[72:75]
s_xor_b32 m0,s72,17408
s_add_u32 s65,s89,32768
v_mfma_f32_16x16x32_bf16 v[76:79],a[252:255],v[252:255],v[76:79]
buffer_load_dwordx4 v16,s[20:23],s65 offen offset:0 sc1 lds
v_min3_u32 v27,v27,v248,v252
v_mfma_f32_16x16x32_bf16 v[80:83],a[0:3],v[128:131],0
buffer_load_dwordx4 v16,s[20:23],s65 offen offset:2048 sc1 lds
v_cmp_eq_u32 vcc,0,v27
s_cbranch_vccnz retry_276
v_mfma_f32_16x16x32_bf16 v[84:87],a[4:7],v[132:135],0
s_xor_b32 m0,s72,33792
s_add_u32 s65,s89,65536
v_mfma_f32_16x16x32_bf16 v[80:83],a[8:11],v[136:139],v[80:83]
buffer_load_dwordx4 v16,s[20:23],s65 offen offset:0 sc1 lds
v_mfma_f32_16x16x32_bf16 v[84:87],a[12:15],v[140:143],v[84:87]
buffer_load_dwordx4 v16,s[20:23],s65 offen offset:2048 sc1 lds
v_mfma_f32_16x16x32_bf16 v[80:83],a[16:19],v[144:147],v[80:83]
s_xor_b32 m0,s72,50176
s_add_u32 s65,s89,98304
v_add_f32 v72,v72,v76
v_mfma_f32_16x16x32_bf16 v[84:87],a[20:23],v[148:151],v[84:87]
buffer_load_dwordx4 v16,s[20:23],s65 offen offset:0 sc1 lds
v_add_f32 v73,v73,v77
v_mfma_f32_16x16x32_bf16 v[80:83],a[24:27],v[152:155],v[80:83]
buffer_load_dwordx4 v16,s[20:23],s65 offen offset:2048 sc1 lds
v_add_f32 v74,v74,v78
v_mfma_f32_16x16x32_bf16 v[84:87],a[28:31],v[156:159],v[84:87]
s_waitcnt lgkmcnt(0)
v_lshlrev_b32 v104,16,v124
v_add_f32 v75,v75,v79
v_mfma_f32_16x16x32_bf16 v[80:83],a[32:35],v[160:163],v[80:83]
v_and_b32 v105,s80,v124
v_lshlrev_b32 v106,16,v125
v_and_or_b32 v72,v72,-4,s48
v_mfma_f32_16x16x32_bf16 v[84:87],a[36:39],v[164:167],v[84:87]
v_and_b32 v107,s80,v125
s_add_u32 s64,s77,s33
v_mfma_f32_16x16x32_bf16 v[80:83],a[40:43],v[168:171],v[80:83]
buffer_store_dwordx4 v[72:75],v25,s[20:23],s64 offen offset:1024
v_mfma_f32_16x16x32_bf16 v[84:87],a[44:47],v[172:175],v[84:87]
v_mfma_f32_16x16x32_bf16 v[80:83],a[48:51],v[176:179],v[80:83]
v_mfma_f32_16x16x32_bf16 v[84:87],a[52:55],v[180:183],v[84:87]
v_mfma_f32_16x16x32_bf16 v[80:83],a[56:59],v[184:187],v[80:83]
v_mfma_f32_16x16x32_bf16 v[84:87],a[60:63],v[188:191],v[84:87]
v_mfma_f32_16x16x32_bf16 v[80:83],a[64:67],v[192:195],v[80:83]
buffer_load_dwordx4 v[96:99],v26,s[20:23],s77 offen offset:2048 sc1
v_mfma_f32_16x16x32_bf16 v[84:87],a[68:71],v[196:199],v[84:87]
buffer_load_dwordx4 v[100:103],v26,s[20:23],s77 offen offset:3072 sc1
v_mfma_f32_16x16x32_bf16 v[80:83],a[72:75],v[200:203],v[80:83]
v_mfma_f32_16x16x32_bf16 v[84:87],a[76:79],v[204:207],v[84:87]
v_mfma_f32_16x16x32_bf16 v[80:83],a[80:83],v[208:211],v[80:83]
v_mfma_f32_16x16x32_bf16 v[84:87],a[84:87],v[212:215],v[84:87]
v_mfma_f32_16x16x32_bf16 v[80:83],a[88:91],v[216:219],v[80:83]
v_mfma_f32_16x16x32_bf16 v[84:87],a[92:95],v[220:223],v[84:87]
v_mfma_f32_16x16x32_bf16 v[80:83],a[96:99],v[224:227],v[80:83]
v_mfma_f32_16x16x32_bf16 v[84:87],a[100:103],v[228:231],v[84:87]
v_mfma_f32_16x16x32_bf16 v[80:83],a[104:107],v[232:235],v[80:83]
buffer_load_dwordx4 v[92:95],v26,s[20:23],s77 offen offset:1024 sc1
v_mfma_f32_16x16x32_bf16 v[84:87],a[108:111],v[236:239],v[84:87]
v_mfma_f32_16x16x32_bf16 v[80:83],a[112:115],v[240:243],v[80:83]
v_mfma_f32_16x16x32_bf16 v[84:87],a[116:119],v[244:247],v[84:87]
v_mfma_f32_16x16x32_bf16 v[80:83],a[120:123],v[248:251],v[80:83]
v_mfma_f32_16x16x32_bf16 v[84:87],a[124:127],v[252:255],v[84:87]
s_branch epi_279
keep_285:
v_mfma_f32_16x16x32_bf16 v[68:71],a[228:231],v[228:231],v[68:71]
s_waitcnt vmcnt(1)
s_waitcnt lgkmcnt(10)
v_mfma_f32_16x16x32_bf16 v[64:67],a[104:107],v[232:235],v[64:67]
ds_read_b128 v[160:163],v17 offset:16384
ds_read_b128 v[164:167],v17 offset:18432
v_mfma_f32_16x16x32_bf16 v[68:71],a[232:235],v[232:235],v[68:71]
v_add_u32 v22,s71,-1
v_min3_u32 v27,v27,v232,v236
v_mfma_f32_16x16x32_bf16 v[64:67],a[108:111],v[236:239],v[64:67]
ds_read_b128 v[168:171],v17 offset:20480
v_mfma_f32_16x16x32_bf16 v[68:71],a[236:239],v[236:239],v[68:71]
s_waitcnt lgkmcnt(9)
v_mfma_f32_16x16x32_bf16 v[64:67],a[112:115],v[240:243],v[64:67]
ds_read_b128 v[172:175],v17 offset:22528
v_min3_u32 v27,v27,v240,v244
v_mfma_f32_16x16x32_bf16 v[68:71],a[240:243],v[240:243],v[68:71]
buffer_store_dword v22,v23,s[20:23],s97 offen sc1
v_mfma_f32_16x16x32_bf16 v[64:67],a[116:119],v[244:247],v[64:67]
ds_read_b128 v[176:179],v17 offset:24576
ds_read_b128 v[180:183],v17 offset:26624
v_mfma_f32_16x16x32_bf16 v[68:71],a[244:247],v[244:247],v[68:71]
s_mov_b32 s97,0x7fff0000
s_waitcnt lgkmcnt(7)
v_mfma_f32_16x16x32_bf16 v[64:67],a[120:123],v[248:251],v[64:67]
ds_read_b128 v[184:187],v17 offset:28672
v_min3_u32 v27,v27,v248,v252
v_mfma_f32_16x16x32_bf16 v[68:71],a[248:251],v[248:251],v[68:71]
v_mfma_f32_16x16x32_bf16 v[64:67],a[124:127],v[252:255],v[64:67]
ds_read_b128 v[188:191],v17 offset:30720
v_mfma_f32_16x16x32_bf16 v[68:71],a[252:255],v[252:255],v[68:71]
v_mfma_f32_16x16x32_bf16 v[72:75],a[128:131],v[128:131],0
v_cmp_eq_u32 vcc,0,v27
s_cbranch_vccnz retry_276
v_mfma_f32_16x16x32_bf16 v[76:79],a[132:135],v[132:135],0
v_min3_u32 v27,v27,v128,v132
v_mfma_f32_16x16x32_bf16 v[72:75],a[136:139],v[136:139],v[72:75]
ds_read_b128 v[192:195],v17 offset:32768
v_mfma_f32_16x16x32_bf16 v[76:79],a[140:143],v[140:143],v[76:79]
ds_read_b128 v[196:199],v17 offset:34816
s_waitcnt lgkmcnt(10)
v_mfma_f32_16x16x32_bf16 v[72:75],a[144:147],v[144:147],v[72:75]
ds_read_b128 v[200:203],v17 offset:36864
v_min3_u32 v27,v27,v136,v140
s_waitcnt vmcnt(1)
v_mfma_f32_16x16x32_bf16 v[76:79],a[148:151],v[148:151],v[76:79]
ds_read_b128 v[204:207],v17 offset:38912
v_min3_u32 v27,v27,v144,v148
v_and_or_b32 v64,v64,-4,s48
v_mfma_f32_16x16x32_bf16 v[72:75],a[152:155],v[152:155],v[72:75]
ds_read_b128 v[208:211],v17 offset:40960
s_add_u32 s64,s49,s34
v_mfma_f32_16x16x32_bf16 v[76:79],a[156:159],v[156:159],v[76:79]
v_min3_u32 v27,v27,v152,v156
s_waitcnt lgkmcnt(9)
v_mfma_f32_16x16x32_bf16 v[72:75],a[160:163],v[160:163],v[72:75]
ds_read_b128 v[212:215],v17 offset:43008
buffer_store_dwordx4 v[64:67],v25,s[20:23],s64 offen offset:2048
v_mfma_f32_16x16x32_bf16 v[76:79],a[164:167],v[164:167],v[76:79]
ds_read_b128 v[216:219],v17 offset:45056
v_min3_u32 v27,v27,v160,v164
v_and_or_b32 v68,v68,-4,s48
v_mfma_f32_16x16x32_bf16 v[72:75],a[168:171],v[168:171],v[72:75]
ds_read_b128 v[220:223],v17 offset:47104
s_add_u32 s64,s49,s35
v_mfma_f32_16x16x32_bf16 v[76:79],a[172:175],v[172:175],v[76:79]
ds_read_b128 v[224:227],v17 offset:49152
s_waitcnt lgkmcnt(9)
v_mfma_f32_16x16x32_bf16 v[72:75],a[176:179],v[176:179],v[72:75]
ds_read_b128 v[228:231],v17 offset:51200
v_min3_u32 v27,v27,v168,v172
v_mfma_f32_16x16x32_bf16 v[76:79],a[180:183],v[180:183],v[76:79]
v_min3_u32 v27,v27,v176,v180
buffer_store_dwordx4 v[68:71],v25,s[20:23],s64 offen offset:3072
v_mfma_f32_16x16x32_bf16 v[72:75],a[184:187],v[184:187],v[72:75]
ds_read_b128 v[232:235],v17 offset:53248
s_mov_b32 s49,0x7fff0000
v_mfma_f32_16x16x32_bf16 v[76:79],a[188:191],v[188:191],v[76:79]
ds_read_b128 v[236:239],v17 offset:55296
s_waitcnt lgkmcnt(8)
v_mfma_f32_16x16x32_bf16 v[72:75],a[192:195],v[192:195],v[72:75]
ds_read_b128 v[240:243],v17 offset:57344
v_min3_u32 v27,v27,v184,v188
v_mfma_f32_16x16x32_bf16 v[76:79],a[196:199],v[196:199],v[76:79]
ds_read_b128 v[244:247],v17 offset:59392
v_min3_u32 v27,v27,v192,v196
v_mfma_f32_16x16x32_bf16 v[72:75],a[200:203],v[200:203],v[72:75]
ds_read_b128 v[248:251],v17 offset:61440
ds_bpermute_b32 v124,v41,v120
v_mfma_f32_16x16x32_bf16 v[76:79],a[204:207],v[204:207],v[76:79]
v_min3_u32 v27,v27,v200,v204
s_waitcnt lgkmcnt(8)
v_mfma_f32_16x16x32_bf16 v[72:75],a[208:211],v[208:211],v[72:75]
ds_read_b128 v[252:255],v17 offset:63488
ds_bpermute_b32 v125,v41,v121
v_mfma_f32_16x16x32_bf16 v[76:79],a[212:215],v[212:215],v[76:79]
v_min3_u32 v27,v27,v208,v212
v_mfma_f32_16x16x32_bf16 v[72:75],a[216:219],v[216:219],v[72:75]
v_mfma_f32_16x16x32_bf16 v[76:79],a[220:223],v[220:223],v[76:79]
v_min3_u32 v27,v27,v216,v220
s_waitcnt lgkmcnt(6)
v_mfma_f32_16x16x32_bf16 v[72:75],a[224:227],v[224:227],v[72:75]
s_waitcnt lgkmcnt(0)
v_mfma_f32_16x16x32_bf16 v[76:79],a[228:231],v[228:231],v[76:79]
v_min3_u32 v27,v27,v224,v228
v_mfma_f32_16x16x32_bf16 v[72:75],a[232:235],v[232:235],v[72:75]
v_lshlrev_b32 v104,16,v124
v_mfma_f32_16x16x32_bf16 v[76:79],a[236:239],v[236:239],v[76:79]
v_min3_u32 v27,v27,v232,v236
v_mfma_f32_16x16x32_bf16 v[72:75],a[240:243],v[240:243],v[72:75]
v_mfma_f32_16x16x32_bf16 v[76:79],a[244:247],v[244:247],v[76:79]
v_min3_u32 v27,v27,v240,v244
v_mfma_f32_16x16x32_bf16 v[72:75],a[248:251],v[248:251],v[72:75]
v_and_b32 v105,s80,v124
v_mfma_f32_16x16x32_bf16 v[76:79],a[252:255],v[252:255],v[76:79]
v_min3_u32 v27,v27,v248,v252
v_mfma_f32_16x16x32_bf16 v[80:83],a[0:3],v[128:131],0
v_cmp_eq_u32 vcc,0,v27
s_cbranch_vccnz retry_276
v_mfma_f32_16x16x32_bf16 v[84:87],a[4:7],v[132:135],0
v_lshlrev_b32 v106,16,v125
v_mfma_f32_16x16x32_bf16 v[80:83],a[8:11],v[136:139],v[80:83]
v_mfma_f32_16x16x32_bf16 v[84:87],a[12:15],v[140:143],v[84:87]
v_mfma_f32_16x16x32_bf16 v[80:83],a[16:19],v[144:147],v[80:83]
v_and_b32 v107,s80,v125
v_add_f32 v72,v72,v76
v_mfma_f32_16x16x32_bf16 v[84:87],a[20:23],v[148:151],v[84:87]
v_add_f32 v73,v73,v77
v_add_f32 v74,v74,v78
v_mfma_f32_16x16x32_bf16 v[80:83],a[24:27],v[152:155],v[80:83]
v_add_f32 v75,v75,v79
v_and_or_b32 v72,v72,-4,s48
v_mfma_f32_16x16x32_bf16 v[84:87],a[28:31],v[156:159],v[84:87]
s_add_u32 s64,s77,s33
v_mfma_f32_16x16x32_bf16 v[80:83],a[32:35],v[160:163],v[80:83]
buffer_store_dwordx4 v[72:75],v25,s[20:23],s64 offen offset:1024
v_mfma_f32_16x16x32_bf16 v[84:87],a[36:39],v[164:167],v[84:87]
v_mfma_f32_16x16x32_bf16 v[80:83],a[40:43],v[168:171],v[80:83]
v_mfma_f32_16x16x32_bf16 v[84:87],a[44:47],v[172:175],v[84:87]
v_mfma_f32_16x16x32_bf16 v[80:83],a[48:51],v[176:179],v[80:83]
v_mfma_f32_16x16x32_bf16 v[84:87],a[52:55],v[180:183],v[84:87]
v_mfma_f32_16x16x32_bf16 v[80:83],a[56:59],v[184:187],v[80:83]
v_mfma_f32_16x16x32_bf16 v[84:87],a[60:63],v[188:191],v[84:87]
v_mfma_f32_16x16x32_bf16 v[80:83],a[64:67],v[192:195],v[80:83]
buffer_load_dwordx4 v[96:99],v26,s[20:23],s77 offen offset:2048 sc1
v_mfma_f32_16x16x32_bf16 v[84:87],a[68:71],v[196:199],v[84:87]
buffer_load_dwordx4 v[100:103],v26,s[20:23],s77 offen offset:3072 sc1
v_mfma_f32_16x16x32_bf16 v[80:83],a[72:75],v[200:203],v[80:83]
v_mfma_f32_16x16x32_bf16 v[84:87],a[76:79],v[204:207],v[84:87]
v_mfma_f32_16x16x32_bf16 v[80:83],a[80:83],v[208:211],v[80:83]
v_mfma_f32_16x16x32_bf16 v[84:87],a[84:87],v[212:215],v[84:87]
v_mfma_f32_16x16x32_bf16 v[80:83],a[88:91],v[216:219],v[80:83]
v_mfma_f32_16x16x32_bf16 v[84:87],a[92:95],v[220:223],v[84:87]
v_mfma_f32_16x16x32_bf16 v[80:83],a[96:99],v[224:227],v[80:83]
v_mfma_f32_16x16x32_bf16 v[84:87],a[100:103],v[228:231],v[84:87]
v_mfma_f32_16x16x32_bf16 v[80:83],a[104:107],v[232:235],v[80:83]
buffer_load_dwordx4 v[92:95],v26,s[20:23],s77 offen offset:1024 sc1
v_mfma_f32_16x16x32_bf16 v[84:87],a[108:111],v[236:239],v[84:87]
v_mfma_f32_16x16x32_bf16 v[80:83],a[112:115],v[240:243],v[80:83]
v_mfma_f32_16x16x32_bf16 v[84:87],a[116:119],v[244:247],v[84:87]
v_mfma_f32_16x16x32_bf16 v[80:83],a[120:123],v[248:251],v[80:83]
v_mfma_f32_16x16x32_bf16 v[84:87],a[124:127],v[252:255],v[84:87]
s_branch epi_279
both_280:
s_waitcnt vmcnt(15) lgkmcnt(0)
s_barrier
ds_read_b128 v[224:227],v18 offset:0
ds_read_b128 v[228:231],v18 offset:2048
ds_read_b128 v[232:235],v18 offset:4096
ds_read_b128 v[236:239],v18 offset:6144
ds_read_b128 v[240:243],v18 offset:8192
ds_read_b128 v[244:247],v18 offset:10240
ds_read_b128 v[248:251],v18 offset:12288
s_waitcnt lgkmcnt(5)
v_mfma_f32_16x16x32_bf16 v[64:67],a[0:3],v[224:227],0
s_add_u32 s96,s71,1
s_add_u32 s92,s71,2
v_min_u32 v27,v224,v228
v_mfma_f32_16x16x32_bf16 v[68:71],a[128:131],v[224:227],0
ds_read_b128 v[252:255],v18 offset:14336
s_add_u32 s88,s70,s75
v_mfma_f32_16x16x32_bf16 v[64:67],a[4:7],v[228:231],v[64:67]
s_add_u32 s88,s88,2097152
s_xor_b32 s88,s88,0x2000
v_mfma_f32_16x16x32_bf16 v[68:71],a[132:135],v[228:231],v[68:71]
ds_read_b128 v[224:227],v18 offset:16384
s_waitcnt lgkmcnt(5)
v_mfma_f32_16x16x32_bf16 v[64:67],a[8:11],v[232:235],v[64:67]
s_xor_b32 s89,s88,1024
v_min3_u32 v27,v27,v232,v236
v_mfma_f32_16x16x32_bf16 v[68:71],a[136:139],v[232:235],v[68:71]
ds_read_b128 v[228:231],v18 offset:18432
v_mfma_f32_16x16x32_bf16 v[64:67],a[12:15],v[236:239],v[64:67]
s_xor_b32 m0,s72,0
v_mfma_f32_16x16x32_bf16 v[68:71],a[140:143],v[236:239],v[68:71]
ds_read_b128 v[232:235],v18 offset:20480
s_waitcnt lgkmcnt(5)
v_mfma_f32_16x16x32_bf16 v[64:67],a[16:19],v[240:243],v[64:67]
s_add_u32 s65,s88,0
v_min3_u32 v27,v27,v240,v244
v_mfma_f32_16x16x32_bf16 v[68:71],a[144:147],v[240:243],v[68:71]
ds_read_b128 v[236:239],v18 offset:22528
v_mfma_f32_16x16x32_bf16 v[64:67],a[20:23],v[244:247],v[64:67]
buffer_load_dwordx4 v16,s[20:23],s65 offen offset:0 sc1 lds
v_mfma_f32_16x16x32_bf16 v[68:71],a[148:151],v[244:247],v[68:71]
ds_read_b128 v[240:243],v18 offset:24576
s_waitcnt lgkmcnt(5)
v_mfma_f32_16x16x32_bf16 v[64:67],a[24:27],v[248:251],v[64:67]
buffer_load_dwordx4 v16,s[20:23],s65 offen offset:2048 sc1 lds
v_mfma_f32_16x16x32_bf16 v[68:71],a[152:155],v[248:251],v[68:71]
ds_read_b128 v[244:247],v18 offset:26624
v_min3_u32 v27,v27,v248,v252
v_mfma_f32_16x16x32_bf16 v[64:67],a[28:31],v[252:255],v[64:67]
s_xor_b32 m0,s72,16384
v_mfma_f32_16x16x32_bf16 v[68:71],a[156:159],v[252:255],v[68:71]
ds_read_b128 v[248:251],v18 offset:28672
s_waitcnt lgkmcnt(5)
v_mfma_f32_16x16x32_bf16 v[64:67],a[32:35],v[224:227],v[64:67]
s_add_u32 s65,s88,32768
v_min3_u32 v27,v27,v224,v228
v_mfma_f32_16x16x32_bf16 v[68:71],a[160:163],v[224:227],v[68:71]
ds_read_b128 v[252:255],v18 offset:30720
v_mfma_f32_16x16x32_bf16 v[64:67],a[36:39],v[228:231],v[64:67]
s_waitcnt vmcnt(4)
buffer_load_dwordx4 v16,s[20:23],s65 offen offset:0 sc1 lds
v_mfma_f32_16x16x32_bf16 v[68:71],a[164:167],v[228:231],v[68:71]
ds_read_b128 v[224:227],v18 offset:32768
s_waitcnt lgkmcnt(5)
v_mfma_f32_16x16x32_bf16 v[64:67],a[40:43],v[232:235],v[64:67]
v_cmp_gt_u32 vcc,s96,v29
v_cmp_gt_u32 s[92:93],s92,v29
v_min3_u32 v27,v27,v232,v236
v_mfma_f32_16x16x32_bf16 v[68:71],a[168:171],v[232:235],v[68:71]
ds_read_b128 v[228:231],v18 offset:34816
buffer_load_dwordx4 v16,s[20:23],s65 offen offset:2048 sc1 lds
v_mfma_f32_16x16x32_bf16 v[64:67],a[44:47],v[236:239],v[64:67]
v_mov_b32 v44,vcc_lo
v_mov_b32 v45,s92
v_mfma_f32_16x16x32_bf16 v[68:71],a[172:175],v[236:239],v[68:71]
ds_read_b128 v[232:235],v18 offset:36864
s_xor_b32 m0,s72,32768
s_waitcnt lgkmcnt(5)
v_mfma_f32_16x16x32_bf16 v[64:67],a[48:51],v[240:243],v[64:67]
ds_write_b64 v46,v[44:45]
v_min3_u32 v27,v27,v240,v244
v_mfma_f32_16x16x32_bf16 v[68:71],a[176:179],v[240:243],v[68:71]
ds_read_b128 v[236:239],v18 offset:38912
s_add_u32 s65,s88,65536
v_mfma_f32_16x16x32_bf16 v[64:67],a[52:55],v[244:247],v[64:67]
buffer_load_dwordx2 v[120:121],v20,s[36:39],s78 offen
v_mfma_f32_16x16x32_bf16 v[68:71],a[180:183],v[244:247],v[68:71]
ds_read_b128 v[240:243],v18 offset:40960
s_waitcnt lgkmcnt(6)
v_mfma_f32_16x16x32_bf16 v[64:67],a[56:59],v[248:251],v[64:67]
buffer_load_dwordx4 v16,s[20:23],s65 offen offset:0 sc1 lds
v_mfma_f32_16x16x32_bf16 v[68:71],a[184:187],v[248:251],v[68:71]
ds_read_b128 v[244:247],v18 offset:43008
buffer_load_dwordx4 v16,s[20:23],s65 offen offset:2048 sc1 lds
v_mfma_f32_16x16x32_bf16 v[64:67],a[60:63],v[252:255],v[64:67]
v_min3_u32 v27,v27,v248,v252
v_mfma_f32_16x16x32_bf16 v[68:71],a[188:191],v[252:255],v[68:71]
ds_read_b128 v[248:251],v18 offset:45056
s_xor_b32 m0,s72,49152
s_waitcnt lgkmcnt(6)
v_mfma_f32_16x16x32_bf16 v[64:67],a[64:67],v[224:227],v[64:67]
v_min3_u32 v27,v27,v224,v228
v_mfma_f32_16x16x32_bf16 v[68:71],a[192:195],v[224:227],v[68:71]
ds_read_b128 v[252:255],v18 offset:47104
s_add_u32 s65,s88,98304
v_mfma_f32_16x16x32_bf16 v[64:67],a[68:71],v[228:231],v[64:67]
v_mfma_f32_16x16x32_bf16 v[68:71],a[196:199],v[228:231],v[68:71]
ds_read_b128 v[224:227],v18 offset:49152
s_waitcnt lgkmcnt(5)
v_mfma_f32_16x16x32_bf16 v[64:67],a[72:75],v[232:235],v[64:67]
buffer_load_dwordx4 v16,s[20:23],s65 offen offset:0 sc1 lds
v_mfma_f32_16x16x32_bf16 v[68:71],a[200:203],v[232:235],v[68:71]
ds_read_b128 v[228:231],v18 offset:51200
buffer_load_dwordx4 v16,s[20:23],s65 offen offset:2048 sc1 lds
v_mfma_f32_16x16x32_bf16 v[64:67],a[76:79],v[236:239],v[64:67]
v_min3_u32 v27,v27,v232,v236
v_mfma_f32_16x16x32_bf16 v[68:71],a[204:207],v[236:239],v[68:71]
ds_read_b128 v[232:235],v18 offset:53248
s_waitcnt lgkmcnt(5)
v_mfma_f32_16x16x32_bf16 v[64:67],a[80:83],v[240:243],v[64:67]
s_waitcnt vmcnt(16)
s_barrier
ds_read_b64 v[44:45],v47
ds_read_b128 v[128:131],v17 offset:0
ds_read_b128 v[132:135],v17 offset:2048
v_mfma_f32_16x16x32_bf16 v[68:71],a[208:211],v[240:243],v[68:71]
ds_read_b128 v[236:239],v18 offset:55296
s_xor_b32 m0,s72,1024
v_min3_u32 v27,v27,v240,v244
v_mfma_f32_16x16x32_bf16 v[64:67],a[84:87],v[244:247],v[64:67]
ds_read_b128 v[136:139],v17 offset:4096
s_add_u32 s65,s89,0
v_mfma_f32_16x16x32_bf16 v[68:71],a[212:215],v[244:247],v[68:71]
ds_read_b128 v[240:243],v18 offset:57344
s_waitcnt lgkmcnt(9)
v_mfma_f32_16x16x32_bf16 v[64:67],a[88:91],v[248:251],v[64:67]
ds_read_b128 v[140:143],v17 offset:6144
buffer_load_dwordx4 v16,s[20:23],s65 offen offset:0 sc1 lds
v_mfma_f32_16x16x32_bf16 v[68:71],a[216:219],v[248:251],v[68:71]
ds_read_b128 v[244:247],v18 offset:59392
v_min3_u32 v27,v27,v248,v252
v_mfma_f32_16x16x32_bf16 v[64:67],a[92:95],v[252:255],v[64:67]
ds_read_b128 v[144:147],v17 offset:8192
ds_read_b128 v[148:151],v17 offset:10240
v_mfma_f32_16x16x32_bf16 v[68:71],a[220:223],v[252:255],v[68:71]
ds_read_b128 v[248:251],v18 offset:61440
s_waitcnt lgkmcnt(12)
v_mfma_f32_16x16x32_bf16 v[64:67],a[96:99],v[224:227],v[64:67]
ds_read_b128 v[152:155],v17 offset:12288
s_waitcnt lgkmcnt(11)
v_min3_u32 v27,v27,v224,v228
v_mfma_f32_16x16x32_bf16 v[68:71],a[224:227],v[224:227],v[68:71]
ds_read_b128 v[252:255],v18 offset:63488
v_readfirstlane_b32 s93,v45
v_mfma_f32_16x16x32_bf16 v[64:67],a[100:103],v[228:231],v[64:67]
ds_read_b128 v[156:159],v17 offset:14336
buffer_load_dwordx4 v16,s[20:23],s65 offen offset:2048 sc1 lds
v_mfma_f32_16x16x32_bf16 v[68:71],a[228:231],v[228:231],v[68:71]
s_xor_b32 m0,s72,17408
s_add_u32 s65,s89,32768
s_waitcnt lgkmcnt(10)
v_mfma_f32_16x16x32_bf16 v[64:67],a[104:107],v[232:235],v[64:67]
ds_read_b128 v[160:163],v17 offset:16384
ds_read_b128 v[164:167],v17 offset:18432
v_min3_u32 v27,v27,v232,v236
v_mfma_f32_16x16x32_bf16 v[68:71],a[232:235],v[232:235],v[68:71]
buffer_load_dwordx4 v16,s[20:23],s65 offen offset:0 sc1 lds
s_waitcnt vmcnt(12)
v_mfma_f32_16x16x32_bf16 v[64:67],a[108:111],v[236:239],v[64:67]
ds_read_b128 v[168:171],v17 offset:20480
buffer_load_dwordx4 v16,s[20:23],s65 offen offset:2048 sc1 lds
v_mfma_f32_16x16x32_bf16 v[68:71],a[236:239],v[236:239],v[68:71]
v_add_u32 v22,s71,-1
s_waitcnt lgkmcnt(9)
v_mfma_f32_16x16x32_bf16 v[64:67],a[112:115],v[240:243],v[64:67]
ds_read_b128 v[172:175],v17 offset:22528
v_min3_u32 v27,v27,v240,v244
v_mfma_f32_16x16x32_bf16 v[68:71],a[240:243],v[240:243],v[68:71]
s_xor_b32 m0,s72,33792
buffer_store_dword v22,v23,s[20:23],s97 offen sc1
v_mfma_f32_16x16x32_bf16 v[64:67],a[116:119],v[244:247],v[64:67]
ds_read_b128 v[176:179],v17 offset:24576
ds_read_b128 v[180:183],v17 offset:26624
s_mov_b32 s97,0x7fff0000
v_mfma_f32_16x16x32_bf16 v[68:71],a[244:247],v[244:247],v[68:71]
s_add_u32 s65,s89,65536
s_waitcnt lgkmcnt(7)
v_mfma_f32_16x16x32_bf16 v[64:67],a[120:123],v[248:251],v[64:67]
ds_read_b128 v[184:187],v17 offset:28672
v_min3_u32 v27,v27,v248,v252
v_mfma_f32_16x16x32_bf16 v[68:71],a[248:251],v[248:251],v[68:71]
buffer_load_dwordx4 v16,s[20:23],s65 offen offset:0 sc1 lds
v_mfma_f32_16x16x32_bf16 v[64:67],a[124:127],v[252:255],v[64:67]
ds_read_b128 v[188:191],v17 offset:30720
v_mfma_f32_16x16x32_bf16 v[68:71],a[252:255],v[252:255],v[68:71]
buffer_load_dwordx4 v16,s[20:23],s65 offen offset:2048 sc1 lds
v_mfma_f32_16x16x32_bf16 v[72:75],a[128:131],v[128:131],0
v_cmp_eq_u32 vcc,0,v27
s_cbranch_vccnz retry_276
v_mfma_f32_16x16x32_bf16 v[76:79],a[132:135],v[132:135],0
s_xor_b32 m0,s72,50176
v_min3_u32 v27,v27,v128,v132
v_mfma_f32_16x16x32_bf16 v[72:75],a[136:139],v[136:139],v[72:75]
ds_read_b128 v[192:195],v17 offset:32768
v_mfma_f32_16x16x32_bf16 v[76:79],a[140:143],v[140:143],v[76:79]
ds_read_b128 v[196:199],v17 offset:34816
s_add_u32 s65,s89,98304
s_waitcnt lgkmcnt(10)
v_mfma_f32_16x16x32_bf16 v[72:75],a[144:147],v[144:147],v[72:75]
ds_read_b128 v[200:203],v17 offset:36864
v_min3_u32 v27,v27,v136,v140
s_waitcnt vmcnt(11)
v_mfma_f32_16x16x32_bf16 v[76:79],a[148:151],v[148:151],v[76:79]
ds_read_b128 v[204:207],v17 offset:38912
buffer_load_dwordx4 v16,s[20:23],s65 offen offset:0 sc1 lds
v_mfma_f32_16x16x32_bf16 v[72:75],a[152:155],v[152:155],v[72:75]
ds_read_b128 v[208:211],v17 offset:40960
v_min3_u32 v27,v27,v144,v148
v_and_or_b32 v64,v64,-4,s48
v_mfma_f32_16x16x32_bf16 v[76:79],a[156:159],v[156:159],v[76:79]
buffer_load_dwordx4 v16,s[20:23],s65 offen offset:2048 sc1 lds
s_waitcnt lgkmcnt(9)
v_mfma_f32_16x16x32_bf16 v[72:75],a[160:163],v[160:163],v[72:75]
ds_read_b128 v[212:215],v17 offset:43008
v_min3_u32 v27,v27,v152,v156
s_add_u32 s64,s49,s34
v_mfma_f32_16x16x32_bf16 v[76:79],a[164:167],v[164:167],v[76:79]
ds_read_b128 v[216:219],v17 offset:45056
v_min3_u32 v27,v27,v160,v164
v_mfma_f32_16x16x32_bf16 v[72:75],a[168:171],v[168:171],v[72:75]
ds_read_b128 v[220:223],v17 offset:47104
buffer_store_dwordx4 v[64:67],v25,s[20:23],s64 offen offset:2048
v_mfma_f32_16x16x32_bf16 v[76:79],a[172:175],v[172:175],v[76:79]
ds_read_b128 v[224:227],v17 offset:49152
v_and_or_b32 v68,v68,-4,s48
s_waitcnt lgkmcnt(9)
v_mfma_f32_16x16x32_bf16 v[72:75],a[176:179],v[176:179],v[72:75]
ds_read_b128 v[228:231],v17 offset:51200
v_min3_u32 v27,v27,v168,v172
s_add_u32 s64,s49,s35
v_mfma_f32_16x16x32_bf16 v[76:79],a[180:183],v[180:183],v[76:79]
v_min3_u32 v27,v27,v176,v180
buffer_store_dwordx4 v[68:71],v25,s[20:23],s64 offen offset:3072
v_mfma_f32_16x16x32_bf16 v[72:75],a[184:187],v[184:187],v[72:75]
ds_read_b128 v[232:235],v17 offset:53248
s_mov_b32 s49,0x7fff0000
v_mfma_f32_16x16x32_bf16 v[76:79],a[188:191],v[188:191],v[76:79]
ds_read_b128 v[236:239],v17 offset:55296
s_waitcnt lgkmcnt(8)
v_mfma_f32_16x16x32_bf16 v[72:75],a[192:195],v[192:195],v[72:75]
ds_read_b128 v[240:243],v17 offset:57344
v_min3_u32 v27,v27,v184,v188
v_mfma_f32_16x16x32_bf16 v[76:79],a[196:199],v[196:199],v[76:79]
ds_read_b128 v[244:247],v17 offset:59392
v_min3_u32 v27,v27,v192,v196
v_mfma_f32_16x16x32_bf16 v[72:75],a[200:203],v[200:203],v[72:75]
ds_read_b128 v[248:251],v17 offset:61440
ds_bpermute_b32 v124,v41,v120
v_mfma_f32_16x16x32_bf16 v[76:79],a[204:207],v[204:207],v[76:79]
v_min3_u32 v27,v27,v200,v204
s_waitcnt lgkmcnt(8)
v_mfma_f32_16x16x32_bf16 v[72:75],a[208:211],v[208:211],v[72:75]
ds_read_b128 v[252:255],v17 offset:63488
ds_bpermute_b32 v125,v41,v121
v_mfma_f32_16x16x32_bf16 v[76:79],a[212:215],v[212:215],v[76:79]
v_min3_u32 v27,v27,v208,v212
v_mfma_f32_16x16x32_bf16 v[72:75],a[216:219],v[216:219],v[72:75]
v_mfma_f32_16x16x32_bf16 v[76:79],a[220:223],v[220:223],v[76:79]
v_min3_u32 v27,v27,v216,v220
s_waitcnt lgkmcnt(6)
v_mfma_f32_16x16x32_bf16 v[72:75],a[224:227],v[224:227],v[72:75]
s_waitcnt lgkmcnt(0)
v_mfma_f32_16x16x32_bf16 v[76:79],a[228:231],v[228:231],v[76:79]
v_min3_u32 v27,v27,v224,v228
v_mfma_f32_16x16x32_bf16 v[72:75],a[232:235],v[232:235],v[72:75]
v_lshlrev_b32 v104,16,v124
v_mfma_f32_16x16x32_bf16 v[76:79],a[236:239],v[236:239],v[76:79]
v_min3_u32 v27,v27,v232,v236
v_mfma_f32_16x16x32_bf16 v[72:75],a[240:243],v[240:243],v[72:75]
v_mfma_f32_16x16x32_bf16 v[76:79],a[244:247],v[244:247],v[76:79]
v_min3_u32 v27,v27,v240,v244
v_mfma_f32_16x16x32_bf16 v[72:75],a[248:251],v[248:251],v[72:75]
v_and_b32 v105,s80,v124
v_mfma_f32_16x16x32_bf16 v[76:79],a[252:255],v[252:255],v[76:79]
v_min3_u32 v27,v27,v248,v252
v_mfma_f32_16x16x32_bf16 v[80:83],a[0:3],v[128:131],0
v_cmp_eq_u32 vcc,0,v27
s_cbranch_vccnz retry_276
v_mfma_f32_16x16x32_bf16 v[84:87],a[4:7],v[132:135],0
v_lshlrev_b32 v106,16,v125
v_mfma_f32_16x16x32_bf16 v[80:83],a[8:11],v[136:139],v[80:83]
v_mfma_f32_16x16x32_bf16 v[84:87],a[12:15],v[140:143],v[84:87]
v_mfma_f32_16x16x32_bf16 v[80:83],a[16:19],v[144:147],v[80:83]
v_and_b32 v107,s80,v125
v_add_f32 v72,v72,v76
v_mfma_f32_16x16x32_bf16 v[84:87],a[20:23],v[148:151],v[84:87]
v_add_f32 v73,v73,v77
v_add_f32 v74,v74,v78
v_mfma_f32_16x16x32_bf16 v[80:83],a[24:27],v[152:155],v[80:83]
v_add_f32 v75,v75,v79
v_and_or_b32 v72,v72,-4,s48
v_mfma_f32_16x16x32_bf16 v[84:87],a[28:31],v[156:159],v[84:87]
s_add_u32 s64,s77,s33
v_mfma_f32_16x16x32_bf16 v[80:83],a[32:35],v[160:163],v[80:83]
buffer_store_dwordx4 v[72:75],v25,s[20:23],s64 offen offset:1024
v_mfma_f32_16x16x32_bf16 v[84:87],a[36:39],v[164:167],v[84:87]
v_mfma_f32_16x16x32_bf16 v[80:83],a[40:43],v[168:171],v[80:83]
v_mfma_f32_16x16x32_bf16 v[84:87],a[44:47],v[172:175],v[84:87]
v_mfma_f32_16x16x32_bf16 v[80:83],a[48:51],v[176:179],v[80:83]
v_mfma_f32_16x16x32_bf16 v[84:87],a[52:55],v[180:183],v[84:87]
v_mfma_f32_16x16x32_bf16 v[80:83],a[56:59],v[184:187],v[80:83]
v_mfma_f32_16x16x32_bf16 v[84:87],a[60:63],v[188:191],v[84:87]
v_mfma_f32_16x16x32_bf16 v[80:83],a[64:67],v[192:195],v[80:83]
buffer_load_dwordx4 v[96:99],v26,s[20:23],s77 offen offset:2048 sc1
v_mfma_f32_16x16x32_bf16 v[84:87],a[68:71],v[196:199],v[84:87]
buffer_load_dwordx4 v[100:103],v26,s[20:23],s77 offen offset:3072 sc1
v_mfma_f32_16x16x32_bf16 v[80:83],a[72:75],v[200:203],v[80:83]
v_mfma_f32_16x16x32_bf16 v[84:87],a[76:79],v[204:207],v[84:87]
v_mfma_f32_16x16x32_bf16 v[80:83],a[80:83],v[208:211],v[80:83]
v_mfma_f32_16x16x32_bf16 v[84:87],a[84:87],v[212:215],v[84:87]
v_mfma_f32_16x16x32_bf16 v[80:83],a[88:91],v[216:219],v[80:83]
v_mfma_f32_16x16x32_bf16 v[84:87],a[92:95],v[220:223],v[84:87]
v_mfma_f32_16x16x32_bf16 v[80:83],a[96:99],v[224:227],v[80:83]
v_mfma_f32_16x16x32_bf16 v[84:87],a[100:103],v[228:231],v[84:87]
v_mfma_f32_16x16x32_bf16 v[80:83],a[104:107],v[232:235],v[80:83]
buffer_load_dwordx4 v[92:95],v26,s[20:23],s77 offen offset:1024 sc1
v_mfma_f32_16x16x32_bf16 v[84:87],a[108:111],v[236:239],v[84:87]
v_mfma_f32_16x16x32_bf16 v[80:83],a[112:115],v[240:243],v[80:83]
v_mfma_f32_16x16x32_bf16 v[84:87],a[116:119],v[244:247],v[84:87]
v_mfma_f32_16x16x32_bf16 v[80:83],a[120:123],v[248:251],v[80:83]
v_mfma_f32_16x16x32_bf16 v[84:87],a[124:127],v[252:255],v[84:87]
epi_279:
buffer_load_dword v29,v21,s[20:23],s87 offen sc1
s_nop 6
v_pk_add_f32 v[88:89],v[80:81],v[84:85]
v_pk_add_f32 v[90:91],v[82:83],v[86:87]
s_waitcnt vmcnt(1)
s_branch ic_288
ip_286:
buffer_load_dwordx4 v[92:95],v26,s[20:23],s77 offen offset:1024 sc1
buffer_load_dwordx4 v[96:99],v26,s[20:23],s77 offen offset:2048 sc1
buffer_load_dwordx4 v[100:103],v26,s[20:23],s77 offen offset:3072 sc1
s_waitcnt vmcnt(0)
ic_288:
v_bitop3_b32 v22,v92,v96,v100 bitop3:0x80
v_and_b32 v22,s48,v22
v_cmp_eq_u32 vcc,0,v22
s_cbranch_vccz ik_287
s_sub_u32 s90,s90,1
s_cmp_gt_i32 s90,0
s_cbranch_scc1 ip_286
ik_287:
v_pk_add_f32 v[88:89],v[88:89],v[92:93]
v_pk_add_f32 v[96:97],v[96:97],v[100:101]
v_pk_add_f32 v[90:91],v[90:91],v[94:95]
v_pk_add_f32 v[98:99],v[98:99],v[102:103]
v_pk_add_f32 v[88:89],v[88:89],v[96:97]
v_pk_add_f32 v[90:91],v[90:91],v[98:99]
v_pk_fma_f32 v[88:89],v[88:89],v[52:53],v[104:105]
v_pk_fma_f32 v[90:91],v[90:91],v[54:55],v[106:107]
v_cvt_pk_bf16_f32 v88,v88,v89
v_cvt_pk_bf16_f32 v89,v90,v91
v_max_u32 v88,1,v88
ds_bpermute_b32 v88,v40,v88
ds_bpermute_b32 v89,v40,v89
v_xor_b32 v18,0x10000,v18
s_xor_b32 s49,s77,524288
s_cselect_b32 s64,0,3
s_xor_b32 s48,s48,s64
s_waitcnt lgkmcnt(0)
buffer_store_dwordx2 v[88:89],v19,s[20:23],s70 offen sc1
s_mov_b32 s77,s49
s_add_u32 s78,s78,65536
s_cmp_gt_u32 s71,51
s_cselect_b32 s65,s73,0x7fff0000
s_cselect_b32 s97,0x7fff0000,s73
v_mov_b32 v22,s71
buffer_store_dword v22,v23,s[20:23],s65 offen sc1
v_xor_b32 v17,0x10000,v17
s_xor_b32 s72,s72,0x10000
s_add_u32 s70,s70,2097152
s_xor_b32 s70,s70,0x2000
s_add_u32 s71,s71,1
s_cmp_le_u32 s71,64
s_cbranch_scc1 seg_277
s_endpgm
retry_276:
s_sub_u32 s90,s90,64
s_cmp_lt_i32 s90,0
s_cbranch_scc1 giveup_195
s_mov_b32 s83,1
s_waitcnt vmcnt(0) lgkmcnt(0)
s_barrier
s_branch seg_277
kslow_275:
s_add_u32 s64,s79,0
s_lshl_b32 s70,s64,21
s_lshl_b32 s64,s64,13
s_and_b32 s64,s64,0x2000
s_xor_b32 s64,s64,s62
s_add_u32 s70,s70,s64
s_add_u32 s70,s70,29360128
s_mov_b32 s83,1
s_mov_b32 s87,s74
s_cmp_eq_u32 s50,0
s_cselect_b32 s74,s74,0x7fff0000
v_mov_b32 v47,132096
s_lshl_b32 s64,s50,3
s_add_u32 s64,s64,132096
v_mov_b32 v46,s64
v_mov_b32 v29,0
s_mov_b32 s97,0x7fff0000
seg_292:
s_add_u32 s94,s70,s75
s_xor_b32 s95,s94,1024
s_xor_b32 s91,s72,0x10000
s_waitcnt vmcnt(2)
v_cmp_gt_u32 vcc,s71,v29
s_cbranch_vccz nb_296
s_waitcnt vmcnt(0)
v_add_u32 v22,s71,-1
buffer_store_dword v22,v23,s[20:23],s97 offen sc1
s_mov_b32 s97,0x7fff0000
s_cmp_lg_u32 s50,0
s_cbranch_scc1 nb_296
buffer_load_dword v32,v21,s[20:23],s74 offen sc1
s_sleep 2
pl_297:
buffer_load_dword v33,v21,s[20:23],s74 offen sc1
s_waitcnt vmcnt(1)
v_cmp_gt_u32 vcc,s71,v32
v_mov_b32 v29,v32
s_cbranch_vccz pok_298
buffer_load_dword v32,v21,s[20:23],s74 offen sc1
s_waitcnt vmcnt(1)
v_cmp_gt_u32 vcc,s71,v33
v_mov_b32 v29,v33
s_cbranch_vccz pok_298
s_sub_u32 s90,s90,1
s_cmp_gt_i32 s90,0
s_cbranch_scc1 pl_297
pok_298:
nb_296:
s_barrier
s_xor_b32 m0,s91,0
s_add_u32 s65,s94,0
buffer_load_dwordx4 v16,s[20:23],s65 offen offset:0 sc1 lds
buffer_load_dwordx4 v16,s[20:23],s65 offen offset:2048 sc1 lds
s_xor_b32 m0,s91,16384
s_add_u32 s65,s94,32768
buffer_load_dwordx4 v16,s[20:23],s65 offen offset:0 sc1 lds
buffer_load_dwordx4 v16,s[20:23],s65 offen offset:2048 sc1 lds
s_xor_b32 m0,s91,32768
s_add_u32 s65,s94,65536
buffer_load_dwordx4 v16,s[20:23],s65 offen offset:0 sc1 lds
buffer_load_dwordx4 v16,s[20:23],s65 offen offset:2048 sc1 lds
s_xor_b32 m0,s91,49152
s_add_u32 s65,s94,98304
buffer_load_dwordx4 v16,s[20:23],s65 offen offset:0 sc1 lds
buffer_load_dwordx4 v16,s[20:23],s65 offen offset:2048 sc1 lds
s_waitcnt vmcnt(8)
v_add_u32 v22,s71,-1
buffer_store_dword v22,v23,s[20:23],s97 offen sc1
s_mov_b32 s97,0x7fff0000
s_waitcnt vmcnt(7)
s_barrier
ds_read_b128 v[224:227],v18 offset:0
ds_read_b128 v[228:231],v18 offset:2048
ds_read_b128 v[232:235],v18 offset:4096
ds_read_b128 v[236:239],v18 offset:6144
ds_read_b128 v[240:243],v18 offset:8192
ds_read_b128 v[244:247],v18 offset:10240
ds_read_b128 v[248:251],v18 offset:12288
s_waitcnt lgkmcnt(5)
v_mfma_f32_16x16x32_bf16 v[64:67],a[0:3],v[224:227],0
s_xor_b32 m0,s91,1024
v_min_u32 v27,v224,v228
v_mfma_f32_16x16x32_bf16 v[68:71],a[128:131],v[224:227],0
ds_read_b128 v[252:255],v18 offset:14336
v_mfma_f32_16x16x32_bf16 v[64:67],a[4:7],v[228:231],v[64:67]
s_add_u32 s65,s95,0
v_mfma_f32_16x16x32_bf16 v[68:71],a[132:135],v[228:231],v[68:71]
s_waitcnt vmcnt(5)
s_barrier
ds_read_b128 v[224:227],v18 offset:16384
s_waitcnt lgkmcnt(5)
v_mfma_f32_16x16x32_bf16 v[64:67],a[8:11],v[232:235],v[64:67]
buffer_load_dwordx4 v16,s[20:23],s65 offen offset:0 sc1 lds
v_mfma_f32_16x16x32_bf16 v[68:71],a[136:139],v[232:235],v[68:71]
ds_read_b128 v[228:231],v18 offset:18432
v_min3_u32 v27,v27,v232,v236
v_mfma_f32_16x16x32_bf16 v[64:67],a[12:15],v[236:239],v[64:67]
buffer_load_dwordx4 v16,s[20:23],s65 offen offset:2048 sc1 lds
v_mfma_f32_16x16x32_bf16 v[68:71],a[140:143],v[236:239],v[68:71]
ds_read_b128 v[232:235],v18 offset:20480
s_waitcnt lgkmcnt(5)
v_mfma_f32_16x16x32_bf16 v[64:67],a[16:19],v[240:243],v[64:67]
s_xor_b32 m0,s91,17408
v_min3_u32 v27,v27,v240,v244
v_mfma_f32_16x16x32_bf16 v[68:71],a[144:147],v[240:243],v[68:71]
ds_read_b128 v[236:239],v18 offset:22528
v_mfma_f32_16x16x32_bf16 v[64:67],a[20:23],v[244:247],v[64:67]
s_add_u32 s65,s95,32768
v_mfma_f32_16x16x32_bf16 v[68:71],a[148:151],v[244:247],v[68:71]
ds_read_b128 v[240:243],v18 offset:24576
s_waitcnt lgkmcnt(5)
v_mfma_f32_16x16x32_bf16 v[64:67],a[24:27],v[248:251],v[64:67]
buffer_load_dwordx4 v16,s[20:23],s65 offen offset:0 sc1 lds
v_mfma_f32_16x16x32_bf16 v[68:71],a[152:155],v[248:251],v[68:71]
ds_read_b128 v[244:247],v18 offset:26624
v_min3_u32 v27,v27,v248,v252
v_mfma_f32_16x16x32_bf16 v[64:67],a[28:31],v[252:255],v[64:67]
buffer_load_dwordx4 v16,s[20:23],s65 offen offset:2048 sc1 lds
v_mfma_f32_16x16x32_bf16 v[68:71],a[156:159],v[252:255],v[68:71]
ds_read_b128 v[248:251],v18 offset:28672
s_waitcnt lgkmcnt(5)
v_mfma_f32_16x16x32_bf16 v[64:67],a[32:35],v[224:227],v[64:67]
s_xor_b32 m0,s91,33792
v_min3_u32 v27,v27,v224,v228
v_mfma_f32_16x16x32_bf16 v[68:71],a[160:163],v[224:227],v[68:71]
ds_read_b128 v[252:255],v18 offset:30720
v_mfma_f32_16x16x32_bf16 v[64:67],a[36:39],v[228:231],v[64:67]
s_add_u32 s65,s95,65536
v_mfma_f32_16x16x32_bf16 v[68:71],a[164:167],v[228:231],v[68:71]
s_waitcnt vmcnt(5)
s_barrier
ds_read_b128 v[224:227],v18 offset:32768
s_waitcnt lgkmcnt(5)
v_mfma_f32_16x16x32_bf16 v[64:67],a[40:43],v[232:235],v[64:67]
buffer_load_dwordx4 v16,s[20:23],s65 offen offset:0 sc1 lds
v_mfma_f32_16x16x32_bf16 v[68:71],a[168:171],v[232:235],v[68:71]
ds_read_b128 v[228:231],v18 offset:34816
v_min3_u32 v27,v27,v232,v236
v_mfma_f32_16x16x32_bf16 v[64:67],a[44:47],v[236:239],v[64:67]
buffer_load_dwordx4 v16,s[20:23],s65 offen offset:2048 sc1 lds
v_mfma_f32_16x16x32_bf16 v[68:71],a[172:175],v[236:239],v[68:71]
ds_read_b128 v[232:235],v18 offset:36864
s_waitcnt lgkmcnt(5)
v_mfma_f32_16x16x32_bf16 v[64:67],a[48:51],v[240:243],v[64:67]
s_xor_b32 m0,s91,50176
v_min3_u32 v27,v27,v240,v244
v_mfma_f32_16x16x32_bf16 v[68:71],a[176:179],v[240:243],v[68:71]
ds_read_b128 v[236:239],v18 offset:38912
v_mfma_f32_16x16x32_bf16 v[64:67],a[52:55],v[244:247],v[64:67]
s_add_u32 s65,s95,98304
v_mfma_f32_16x16x32_bf16 v[68:71],a[180:183],v[244:247],v[68:71]
ds_read_b128 v[240:243],v18 offset:40960
s_waitcnt lgkmcnt(5)
v_mfma_f32_16x16x32_bf16 v[64:67],a[56:59],v[248:251],v[64:67]
buffer_load_dwordx4 v16,s[20:23],s65 offen offset:0 sc1 lds
v_mfma_f32_16x16x32_bf16 v[68:71],a[184:187],v[248:251],v[68:71]
ds_read_b128 v[244:247],v18 offset:43008
v_min3_u32 v27,v27,v248,v252
v_mfma_f32_16x16x32_bf16 v[64:67],a[60:63],v[252:255],v[64:67]
buffer_load_dwordx4 v16,s[20:23],s65 offen offset:2048 sc1 lds
v_mfma_f32_16x16x32_bf16 v[68:71],a[188:191],v[252:255],v[68:71]
ds_read_b128 v[248:251],v18 offset:45056
s_waitcnt lgkmcnt(5)
v_mfma_f32_16x16x32_bf16 v[64:67],a[64:67],v[224:227],v[64:67]
v_min3_u32 v27,v27,v224,v228
s_add_u32 s88,s70,s75
v_mfma_f32_16x16x32_bf16 v[68:71],a[192:195],v[224:227],v[68:71]
ds_read_b128 v[252:255],v18 offset:47104
s_add_u32 s88,s88,2097152
v_mfma_f32_16x16x32_bf16 v[64:67],a[68:71],v[228:231],v[64:67]
buffer_load_dwordx2 v[120:121],v20,s[36:39],s78 offen
v_mfma_f32_16x16x32_bf16 v[68:71],a[196:199],v[228:231],v[68:71]
ds_read_b128 v[224:227],v18 offset:49152
s_waitcnt lgkmcnt(5)
v_mfma_f32_16x16x32_bf16 v[64:67],a[72:75],v[232:235],v[64:67]
v_min3_u32 v27,v27,v232,v236
s_xor_b32 s88,s88,0x2000
v_mfma_f32_16x16x32_bf16 v[68:71],a[200:203],v[232:235],v[68:71]
ds_read_b128 v[228:231],v18 offset:51200
s_xor_b32 s89,s88,1024
v_mfma_f32_16x16x32_bf16 v[64:67],a[76:79],v[236:239],v[64:67]
v_mfma_f32_16x16x32_bf16 v[68:71],a[204:207],v[236:239],v[68:71]
ds_read_b128 v[232:235],v18 offset:53248
s_waitcnt lgkmcnt(5)
v_mfma_f32_16x16x32_bf16 v[64:67],a[80:83],v[240:243],v[64:67]
s_waitcnt vmcnt(5)
s_barrier
ds_read_b128 v[128:131],v17 offset:0
ds_read_b128 v[132:135],v17 offset:2048
v_mfma_f32_16x16x32_bf16 v[68:71],a[208:211],v[240:243],v[68:71]
ds_read_b128 v[236:239],v18 offset:55296
v_min3_u32 v27,v27,v240,v244
v_mfma_f32_16x16x32_bf16 v[64:67],a[84:87],v[244:247],v[64:67]
ds_read_b128 v[136:139],v17 offset:4096
v_mfma_f32_16x16x32_bf16 v[68:71],a[212:215],v[244:247],v[68:71]
ds_read_b128 v[240:243],v18 offset:57344
s_waitcnt lgkmcnt(8)
v_mfma_f32_16x16x32_bf16 v[64:67],a[88:91],v[248:251],v[64:67]
ds_read_b128 v[140:143],v17 offset:6144
v_min3_u32 v27,v27,v248,v252
v_mfma_f32_16x16x32_bf16 v[68:71],a[216:219],v[248:251],v[68:71]
ds_read_b128 v[244:247],v18 offset:59392
v_mfma_f32_16x16x32_bf16 v[64:67],a[92:95],v[252:255],v[64:67]
ds_read_b128 v[144:147],v17 offset:8192
ds_read_b128 v[148:151],v17 offset:10240
v_mfma_f32_16x16x32_bf16 v[68:71],a[220:223],v[252:255],v[68:71]
ds_read_b128 v[248:251],v18 offset:61440
s_waitcnt lgkmcnt(11)
v_mfma_f32_16x16x32_bf16 v[64:67],a[96:99],v[224:227],v[64:67]
ds_read_b128 v[152:155],v17 offset:12288
v_min3_u32 v27,v27,v224,v228
v_mfma_f32_16x16x32_bf16 v[68:71],a[224:227],v[224:227],v[68:71]
ds_read_b128 v[252:255],v18 offset:63488
v_mfma_f32_16x16x32_bf16 v[64:67],a[100:103],v[228:231],v[64:67]
ds_read_b128 v[156:159],v17 offset:14336
v_mfma_f32_16x16x32_bf16 v[68:71],a[228:231],v[228:231],v[68:71]
s_waitcnt lgkmcnt(10)
v_mfma_f32_16x16x32_bf16 v[64:67],a[104:107],v[232:235],v[64:67]
ds_read_b128 v[160:163],v17 offset:16384
ds_read_b128 v[164:167],v17 offset:18432
v_mfma_f32_16x16x32_bf16 v[68:71],a[232:235],v[232:235],v[68:71]
v_min3_u32 v27,v27,v232,v236
v_mfma_f32_16x16x32_bf16 v[64:67],a[108:111],v[236:239],v[64:67]
ds_read_b128 v[168:171],v17 offset:20480
v_mfma_f32_16x16x32_bf16 v[68:71],a[236:239],v[236:239],v[68:71]
s_waitcnt lgkmcnt(9)
v_mfma_f32_16x16x32_bf16 v[64:67],a[112:115],v[240:243],v[64:67]
ds_read_b128 v[172:175],v17 offset:22528
v_min3_u32 v27,v27,v240,v244
v_mfma_f32_16x16x32_bf16 v[68:71],a[240:243],v[240:243],v[68:71]
v_mfma_f32_16x16x32_bf16 v[64:67],a[116:119],v[244:247],v[64:67]
ds_read_b128 v[176:179],v17 offset:24576
ds_read_b128 v[180:183],v17 offset:26624
v_mfma_f32_16x16x32_bf16 v[68:71],a[244:247],v[244:247],v[68:71]
s_waitcnt lgkmcnt(7)
v_mfma_f32_16x16x32_bf16 v[64:67],a[120:123],v[248:251],v[64:67]
ds_read_b128 v[184:187],v17 offset:28672
v_min3_u32 v27,v27,v248,v252
v_mfma_f32_16x16x32_bf16 v[68:71],a[248:251],v[248:251],v[68:71]
v_mfma_f32_16x16x32_bf16 v[64:67],a[124:127],v[252:255],v[64:67]
ds_read_b128 v[188:191],v17 offset:30720
v_mfma_f32_16x16x32_bf16 v[68:71],a[252:255],v[252:255],v[68:71]
v_mfma_f32_16x16x32_bf16 v[72:75],a[128:131],v[128:131],0
v_cmp_eq_u32 vcc,0,v27
s_cbranch_vccnz retry_291
v_mfma_f32_16x16x32_bf16 v[76:79],a[132:135],v[132:135],0
v_min3_u32 v27,v27,v128,v132
v_mfma_f32_16x16x32_bf16 v[72:75],a[136:139],v[136:139],v[72:75]
s_waitcnt vmcnt(1)
s_barrier
ds_read_b128 v[192:195],v17 offset:32768
v_mfma_f32_16x16x32_bf16 v[76:79],a[140:143],v[140:143],v[76:79]
ds_read_b128 v[196:199],v17 offset:34816
s_waitcnt lgkmcnt(10)
v_mfma_f32_16x16x32_bf16 v[72:75],a[144:147],v[144:147],v[72:75]
ds_read_b128 v[200:203],v17 offset:36864
v_min3_u32 v27,v27,v136,v140
s_waitcnt vmcnt(0)
v_mfma_f32_16x16x32_bf16 v[76:79],a[148:151],v[148:151],v[76:79]
ds_read_b128 v[204:207],v17 offset:38912
v_min3_u32 v27,v27,v144,v148
v_and_or_b32 v64,v64,-4,s48
v_mfma_f32_16x16x32_bf16 v[72:75],a[152:155],v[152:155],v[72:75]
ds_read_b128 v[208:211],v17 offset:40960
s_add_u32 s64,s49,s34
v_mfma_f32_16x16x32_bf16 v[76:79],a[156:159],v[156:159],v[76:79]
v_min3_u32 v27,v27,v152,v156
s_waitcnt lgkmcnt(9)
v_mfma_f32_16x16x32_bf16 v[72:75],a[160:163],v[160:163],v[72:75]
ds_read_b128 v[212:215],v17 offset:43008
buffer_store_dwordx4 v[64:67],v25,s[20:23],s64 offen offset:2048 sc1
v_mfma_f32_16x16x32_bf16 v[76:79],a[164:167],v[164:167],v[76:79]
ds_read_b128 v[216:219],v17 offset:45056
v_min3_u32 v27,v27,v160,v164
v_and_or_b32 v68,v68,-4,s48
v_mfma_f32_16x16x32_bf16 v[72:75],a[168:171],v[168:171],v[72:75]
ds_read_b128 v[220:223],v17 offset:47104
s_add_u32 s64,s49,s35
v_mfma_f32_16x16x32_bf16 v[76:79],a[172:175],v[172:175],v[76:79]
ds_read_b128 v[224:227],v17 offset:49152
s_waitcnt lgkmcnt(9)
v_mfma_f32_16x16x32_bf16 v[72:75],a[176:179],v[176:179],v[72:75]
ds_read_b128 v[228:231],v17 offset:51200
v_min3_u32 v27,v27,v168,v172
v_mfma_f32_16x16x32_bf16 v[76:79],a[180:183],v[180:183],v[76:79]
v_min3_u32 v27,v27,v176,v180
buffer_store_dwordx4 v[68:71],v25,s[20:23],s64 offen offset:3072 sc1
v_mfma_f32_16x16x32_bf16 v[72:75],a[184:187],v[184:187],v[72:75]
ds_read_b128 v[232:235],v17 offset:53248
s_mov_b32 s49,0x7fff0000
v_mfma_f32_16x16x32_bf16 v[76:79],a[188:191],v[188:191],v[76:79]
ds_read_b128 v[236:239],v17 offset:55296
s_waitcnt lgkmcnt(8)
v_mfma_f32_16x16x32_bf16 v[72:75],a[192:195],v[192:195],v[72:75]
ds_read_b128 v[240:243],v17 offset:57344
v_min3_u32 v27,v27,v184,v188
v_mfma_f32_16x16x32_bf16 v[76:79],a[196:199],v[196:199],v[76:79]
ds_read_b128 v[244:247],v17 offset:59392
v_min3_u32 v27,v27,v192,v196
v_mfma_f32_16x16x32_bf16 v[72:75],a[200:203],v[200:203],v[72:75]
ds_read_b128 v[248:251],v17 offset:61440
ds_bpermute_b32 v124,v41,v120
v_mfma_f32_16x16x32_bf16 v[76:79],a[204:207],v[204:207],v[76:79]
v_min3_u32 v27,v27,v200,v204
s_waitcnt lgkmcnt(8)
v_mfma_f32_16x16x32_bf16 v[72:75],a[208:211],v[208:211],v[72:75]
ds_read_b128 v[252:255],v17 offset:63488
ds_bpermute_b32 v125,v41,v121
v_mfma_f32_16x16x32_bf16 v[76:79],a[212:215],v[212:215],v[76:79]
v_min3_u32 v27,v27,v208,v212
v_mfma_f32_16x16x32_bf16 v[72:75],a[216:219],v[216:219],v[72:75]
v_mfma_f32_16x16x32_bf16 v[76:79],a[220:223],v[220:223],v[76:79]
v_min3_u32 v27,v27,v216,v220
s_waitcnt lgkmcnt(6)
v_mfma_f32_16x16x32_bf16 v[72:75],a[224:227],v[224:227],v[72:75]
s_waitcnt lgkmcnt(0)
v_mfma_f32_16x16x32_bf16 v[76:79],a[228:231],v[228:231],v[76:79]
v_min3_u32 v27,v27,v224,v228
v_mfma_f32_16x16x32_bf16 v[72:75],a[232:235],v[232:235],v[72:75]
v_lshlrev_b32 v104,16,v124
v_mfma_f32_16x16x32_bf16 v[76:79],a[236:239],v[236:239],v[76:79]
v_min3_u32 v27,v27,v232,v236
v_mfma_f32_16x16x32_bf16 v[72:75],a[240:243],v[240:243],v[72:75]
v_mfma_f32_16x16x32_bf16 v[76:79],a[244:247],v[244:247],v[76:79]
v_min3_u32 v27,v27,v240,v244
v_mfma_f32_16x16x32_bf16 v[72:75],a[248:251],v[248:251],v[72:75]
v_and_b32 v105,s80,v124
v_mfma_f32_16x16x32_bf16 v[76:79],a[252:255],v[252:255],v[76:79]
v_min3_u32 v27,v27,v248,v252
v_mfma_f32_16x16x32_bf16 v[80:83],a[0:3],v[128:131],0
v_cmp_eq_u32 vcc,0,v27
s_cbranch_vccnz retry_291
v_mfma_f32_16x16x32_bf16 v[84:87],a[4:7],v[132:135],0
v_lshlrev_b32 v106,16,v125
v_mfma_f32_16x16x32_bf16 v[80:83],a[8:11],v[136:139],v[80:83]
v_mfma_f32_16x16x32_bf16 v[84:87],a[12:15],v[140:143],v[84:87]
v_mfma_f32_16x16x32_bf16 v[80:83],a[16:19],v[144:147],v[80:83]
v_and_b32 v107,s80,v125
v_add_f32 v72,v72,v76
v_mfma_f32_16x16x32_bf16 v[84:87],a[20:23],v[148:151],v[84:87]
v_add_f32 v73,v73,v77
v_add_f32 v74,v74,v78
v_mfma_f32_16x16x32_bf16 v[80:83],a[24:27],v[152:155],v[80:83]
v_add_f32 v75,v75,v79
v_and_or_b32 v72,v72,-4,s48
v_mfma_f32_16x16x32_bf16 v[84:87],a[28:31],v[156:159],v[84:87]
s_add_u32 s64,s77,s33
v_mfma_f32_16x16x32_bf16 v[80:83],a[32:35],v[160:163],v[80:83]
buffer_store_dwordx4 v[72:75],v25,s[20:23],s64 offen offset:1024 sc1
v_mfma_f32_16x16x32_bf16 v[84:87],a[36:39],v[164:167],v[84:87]
v_mfma_f32_16x16x32_bf16 v[80:83],a[40:43],v[168:171],v[80:83]
v_mfma_f32_16x16x32_bf16 v[84:87],a[44:47],v[172:175],v[84:87]
v_mfma_f32_16x16x32_bf16 v[80:83],a[48:51],v[176:179],v[80:83]
v_mfma_f32_16x16x32_bf16 v[84:87],a[52:55],v[180:183],v[84:87]
v_mfma_f32_16x16x32_bf16 v[80:83],a[56:59],v[184:187],v[80:83]
v_mfma_f32_16x16x32_bf16 v[84:87],a[60:63],v[188:191],v[84:87]
v_mfma_f32_16x16x32_bf16 v[80:83],a[64:67],v[192:195],v[80:83]
buffer_load_dwordx4 v[96:99],v26,s[20:23],s77 offen offset:2048 sc1
v_mfma_f32_16x16x32_bf16 v[84:87],a[68:71],v[196:199],v[84:87]
buffer_load_dwordx4 v[100:103],v26,s[20:23],s77 offen offset:3072 sc1
v_mfma_f32_16x16x32_bf16 v[80:83],a[72:75],v[200:203],v[80:83]
v_mfma_f32_16x16x32_bf16 v[84:87],a[76:79],v[204:207],v[84:87]
v_mfma_f32_16x16x32_bf16 v[80:83],a[80:83],v[208:211],v[80:83]
v_mfma_f32_16x16x32_bf16 v[84:87],a[84:87],v[212:215],v[84:87]
v_mfma_f32_16x16x32_bf16 v[80:83],a[88:91],v[216:219],v[80:83]
v_mfma_f32_16x16x32_bf16 v[84:87],a[92:95],v[220:223],v[84:87]
v_mfma_f32_16x16x32_bf16 v[80:83],a[96:99],v[224:227],v[80:83]
v_mfma_f32_16x16x32_bf16 v[84:87],a[100:103],v[228:231],v[84:87]
v_mfma_f32_16x16x32_bf16 v[80:83],a[104:107],v[232:235],v[80:83]
buffer_load_dwordx4 v[92:95],v26,s[20:23],s77 offen offset:1024 sc1
v_mfma_f32_16x16x32_bf16 v[84:87],a[108:111],v[236:239],v[84:87]
v_mfma_f32_16x16x32_bf16 v[80:83],a[112:115],v[240:243],v[80:83]
v_mfma_f32_16x16x32_bf16 v[84:87],a[116:119],v[244:247],v[84:87]
v_mfma_f32_16x16x32_bf16 v[80:83],a[120:123],v[248:251],v[80:83]
v_mfma_f32_16x16x32_bf16 v[84:87],a[124:127],v[252:255],v[84:87]
epi_294:
buffer_load_dword v29,v21,s[20:23],s87 offen sc1
s_nop 6
v_pk_add_f32 v[88:89],v[80:81],v[84:85]
v_pk_add_f32 v[90:91],v[82:83],v[86:87]
s_waitcnt vmcnt(1)
s_branch ic_301
ip_299:
buffer_load_dwordx4 v[92:95],v26,s[20:23],s77 offen offset:1024 sc1
buffer_load_dwordx4 v[96:99],v26,s[20:23],s77 offen offset:2048 sc1
buffer_load_dwordx4 v[100:103],v26,s[20:23],s77 offen offset:3072 sc1
s_waitcnt vmcnt(0)
ic_301:
v_bitop3_b32 v22,v92,v96,v100 bitop3:0x80
v_and_b32 v22,s48,v22
v_cmp_eq_u32 vcc,0,v22
s_cbranch_vccz ik_300
s_sub_u32 s90,s90,1
s_cmp_gt_i32 s90,0
s_cbranch_scc1 ip_299
ik_300:
v_pk_add_f32 v[88:89],v[88:89],v[92:93]
v_pk_add_f32 v[96:97],v[96:97],v[100:101]
v_pk_add_f32 v[90:91],v[90:91],v[94:95]
v_pk_add_f32 v[98:99],v[98:99],v[102:103]
v_pk_add_f32 v[88:89],v[88:89],v[96:97]
v_pk_add_f32 v[90:91],v[90:91],v[98:99]
v_pk_fma_f32 v[88:89],v[88:89],v[52:53],v[104:105]
v_pk_fma_f32 v[90:91],v[90:91],v[54:55],v[106:107]
v_cvt_pk_bf16_f32 v88,v88,v89
v_cvt_pk_bf16_f32 v89,v90,v91
v_max_u32 v88,1,v88
ds_bpermute_b32 v88,v40,v88
ds_bpermute_b32 v89,v40,v89
v_xor_b32 v18,0x10000,v18
s_xor_b32 s49,s77,524288
s_cselect_b32 s64,0,3
s_xor_b32 s48,s48,s64
s_waitcnt lgkmcnt(0)
buffer_store_dwordx2 v[88:89],v19,s[20:23],s70 offen sc1
s_mov_b32 s77,s49
s_add_u32 s78,s78,65536
s_cmp_gt_u32 s71,51
s_cselect_b32 s65,s73,0x7fff0000
s_cselect_b32 s97,0x7fff0000,s73
v_mov_b32 v22,s71
buffer_store_dword v22,v23,s[20:23],s65 offen sc1
v_xor_b32 v17,0x10000,v17
s_xor_b32 s72,s72,0x10000
s_add_u32 s70,s70,2097152
s_xor_b32 s70,s70,0x2000
s_add_u32 s71,s71,1
s_cmp_le_u32 s71,64
s_cbranch_scc1 seg_292
s_endpgm
retry_291:
s_sub_u32 s90,s90,64
s_cmp_lt_i32 s90,0
s_cbranch_scc1 giveup_195
s_mov_b32 s83,1
s_waitcnt vmcnt(0) lgkmcnt(0)
s_barrier
s_branch seg_292
r_w4_214:
s_load_dwordx2 s[4:5],s[0:1],88
s_load_dwordx2 s[6:7],s[0:1],112
s_lshr_b32 s41,s59,3
s_and_b32 s42,s59,7
s_mul_i32 s66,s41,1835008
s_lshl_b32 s64,s42,8
s_add_u32 s66,s66,s64
s_lshl_b32 s67,s50,1
s_and_b32 s64,s41,1
s_add_u32 s67,s67,s64
s_waitcnt lgkmcnt(0)
s_mov_b32 s32,s4
s_and_b32 s33,s5,0xffff
s_mov_b32 s34,0x700000
s_mov_b32 s35,0x20000
s_sub_u32 s36,s6,0x1000
s_subb_u32 s37,s7,0
s_and_b32 s37,s37,0xffff
s_mov_b32 s38,0x401000
s_mov_b32 s39,0x20000
v_lshrrev_b32 v5,2,v3
v_lshl_add_u32 v5,v4,2,v5
v_and_b32 v6,3,v3
v_lshlrev_b32 v6,3,v6
v_lshl_add_u32 v6,v5,8,v6
v_and_b32 v5,7,v5
v_xor_b32 v5,s67,v5
v_lshl_add_u32 v12,v5,5,v6
v_xor_b32 v13,32,v12
v_and_b32 v5,15,v1
v_and_b32 v6,3,v4
v_lshlrev_b32 v6,1,v6
v_xor_b32 v5,v5,v6
v_mul_u32_u24 v6,2048,v4
v_xor_b32 v7,0,v5
v_lshl_add_u32 v8,v7,4,v6
v_xor_b32 v7,8,v5
v_lshl_add_u32 v9,v7,4,v6
s_mul_i32 s74,s50,131072
s_add_u32 s74,s74,s66
s_lshl_b32 s75,s50,14
s_mul_i32 s76,s50,65536
s_add_u32 s76,s76,s66
s_lshl_b32 s77,s50,13
s_add_u32 s64,s74,0
s_add_u32 m0,s75,0
s_nop 0
buffer_load_dwordx4 v8,s[32:35],s64 offen nt lds
s_add_u32 s64,s74,8192
s_add_u32 m0,s75,1024
s_nop 0
buffer_load_dwordx4 v9,s[32:35],s64 offen nt lds
s_add_u32 s64,s74,16384
s_add_u32 m0,s75,2048
s_nop 0
buffer_load_dwordx4 v8,s[32:35],s64 offen nt lds
s_add_u32 s64,s74,24576
s_add_u32 m0,s75,3072
s_nop 0
buffer_load_dwordx4 v9,s[32:35],s64 offen nt lds
s_add_u32 s64,s74,32768
s_add_u32 m0,s75,4096
s_nop 0
buffer_load_dwordx4 v8,s[32:35],s64 offen nt lds
s_add_u32 s64,s74,40960
s_add_u32 m0,s75,5120
s_nop 0
buffer_load_dwordx4 v9,s[32:35],s64 offen nt lds
s_add_u32 s64,s74,49152
s_add_u32 m0,s75,6144
s_nop 0
buffer_load_dwordx4 v8,s[32:35],s64 offen nt lds
s_add_u32 s64,s74,57344
s_add_u32 m0,s75,7168
s_nop 0
buffer_load_dwordx4 v9,s[32:35],s64 offen nt lds
s_add_u32 s64,s74,65536
s_add_u32 m0,s75,8192
s_nop 0
buffer_load_dwordx4 v8,s[32:35],s64 offen nt lds
s_add_u32 s64,s74,73728
s_add_u32 m0,s75,9216
s_nop 0
buffer_load_dwordx4 v9,s[32:35],s64 offen nt lds
s_add_u32 s64,s74,81920
s_add_u32 m0,s75,10240
s_nop 0
buffer_load_dwordx4 v8,s[32:35],s64 offen nt lds
s_add_u32 s64,s74,90112
s_add_u32 m0,s75,11264
s_nop 0
buffer_load_dwordx4 v9,s[32:35],s64 offen nt lds
s_add_u32 s64,s74,98304
s_add_u32 m0,s75,12288
s_nop 0
buffer_load_dwordx4 v8,s[32:35],s64 offen nt lds
s_add_u32 s64,s74,106496
s_add_u32 m0,s75,13312
s_nop 0
buffer_load_dwordx4 v9,s[32:35],s64 offen nt lds
s_add_u32 s64,s74,114688
s_add_u32 m0,s75,14336
s_nop 0
buffer_load_dwordx4 v8,s[32:35],s64 offen nt lds
s_add_u32 s64,s74,122880
s_add_u32 m0,s75,15360
s_nop 0
buffer_load_dwordx4 v9,s[32:35],s64 offen nt lds
s_add_u32 s64,s74,524288
s_add_u32 m0,s75,65536
s_nop 0
buffer_load_dwordx4 v8,s[32:35],s64 offen nt lds
s_add_u32 s64,s74,532480
s_add_u32 m0,s75,66560
s_nop 0
buffer_load_dwordx4 v9,s[32:35],s64 offen nt lds
s_add_u32 s64,s74,540672
s_add_u32 m0,s75,67584
s_nop 0
buffer_load_dwordx4 v8,s[32:35],s64 offen nt lds
s_add_u32 s64,s74,548864
s_add_u32 m0,s75,68608
s_nop 0
buffer_load_dwordx4 v9,s[32:35],s64 offen nt lds
s_add_u32 s64,s74,557056
s_add_u32 m0,s75,69632
s_nop 0
buffer_load_dwordx4 v8,s[32:35],s64 offen nt lds
s_add_u32 s64,s74,565248
s_add_u32 m0,s75,70656
s_nop 0
buffer_load_dwordx4 v9,s[32:35],s64 offen nt lds
s_add_u32 s64,s74,573440
s_add_u32 m0,s75,71680
s_nop 0
buffer_load_dwordx4 v8,s[32:35],s64 offen nt lds
s_add_u32 s64,s74,581632
s_add_u32 m0,s75,72704
s_nop 0
buffer_load_dwordx4 v9,s[32:35],s64 offen nt lds
s_add_u32 s64,s74,589824
s_add_u32 m0,s75,73728
s_nop 0
buffer_load_dwordx4 v8,s[32:35],s64 offen nt lds
s_add_u32 s64,s74,598016
s_add_u32 m0,s75,74752
s_nop 0
buffer_load_dwordx4 v9,s[32:35],s64 offen nt lds
s_add_u32 s64,s74,606208
s_add_u32 m0,s75,75776
s_nop 0
buffer_load_dwordx4 v8,s[32:35],s64 offen nt lds
s_add_u32 s64,s74,614400
s_add_u32 m0,s75,76800
s_nop 0
buffer_load_dwordx4 v9,s[32:35],s64 offen nt lds
s_add_u32 s64,s74,622592
s_add_u32 m0,s75,77824
s_nop 0
buffer_load_dwordx4 v8,s[32:35],s64 offen nt lds
s_add_u32 s64,s74,630784
s_add_u32 m0,s75,78848
s_nop 0
buffer_load_dwordx4 v9,s[32:35],s64 offen nt lds
s_add_u32 s64,s74,638976
s_add_u32 m0,s75,79872
s_nop 0
buffer_load_dwordx4 v8,s[32:35],s64 offen nt lds
s_add_u32 s64,s74,647168
s_add_u32 m0,s75,80896
s_nop 0
buffer_load_dwordx4 v9,s[32:35],s64 offen nt lds
s_waitcnt vmcnt(16)
s_barrier
ds_read_b64_tr_b16 a[0:1],v12 offset:0
ds_read_b64_tr_b16 a[112:113],v13 offset:0
ds_read_b64_tr_b16 a[2:3],v12 offset:4096
ds_read_b64_tr_b16 a[114:115],v13 offset:4096
ds_read_b64_tr_b16 a[4:5],v12 offset:8192
ds_read_b64_tr_b16 a[116:117],v13 offset:8192
ds_read_b64_tr_b16 a[6:7],v12 offset:12288
ds_read_b64_tr_b16 a[118:119],v13 offset:12288
s_waitcnt lgkmcnt(4)
ds_read_b64_tr_b16 a[8:9],v12 offset:16384
ds_read_b64_tr_b16 a[120:121],v13 offset:16384
ds_read_b64_tr_b16 a[10:11],v12 offset:20480
ds_read_b64_tr_b16 a[122:123],v13 offset:20480
ds_read_b64_tr_b16 a[12:13],v12 offset:28672
ds_read_b64_tr_b16 a[124:125],v13 offset:28672
ds_read_b64_tr_b16 a[14:15],v12 offset:32768
ds_read_b64_tr_b16 a[126:127],v13 offset:32768
s_waitcnt lgkmcnt(4)
ds_read_b64_tr_b16 a[16:17],v12 offset:36864
ds_read_b64_tr_b16 a[128:129],v13 offset:36864
ds_read_b64_tr_b16 a[18:19],v12 offset:40960
ds_read_b64_tr_b16 a[130:131],v13 offset:40960
ds_read_b64_tr_b16 a[20:21],v12 offset:45056
ds_read_b64_tr_b16 a[132:133],v13 offset:45056
ds_read_b64_tr_b16 a[22:23],v12 offset:49152
ds_read_b64_tr_b16 a[134:135],v13 offset:49152
s_waitcnt lgkmcnt(4)
ds_read_b64_tr_b16 a[24:25],v12 offset:57344
ds_read_b64_tr_b16 a[136:137],v13 offset:57344
ds_read_b64_tr_b16 a[26:27],v12 offset:61440
ds_read_b64_tr_b16 a[138:139],v13 offset:61440
ds_read_b64_tr_b16 a[96:97],v12 offset:24576
ds_read_b64_tr_b16 a[208:209],v13 offset:24576
ds_read_b64_tr_b16 a[98:99],v12 offset:53248
ds_read_b64_tr_b16 a[210:211],v13 offset:53248
s_waitcnt lgkmcnt(4)
v_xor_b32 v12,0x10000,v12
v_xor_b32 v13,0x10000,v13
s_waitcnt lgkmcnt(0)
s_barrier
s_add_u32 s64,s74,1048576
s_add_u32 m0,s75,0
s_nop 0
buffer_load_dwordx4 v8,s[32:35],s64 offen nt lds
s_add_u32 s64,s74,1056768
s_add_u32 m0,s75,1024
s_nop 0
buffer_load_dwordx4 v9,s[32:35],s64 offen nt lds
s_add_u32 s64,s74,1064960
s_add_u32 m0,s75,2048
s_nop 0
buffer_load_dwordx4 v8,s[32:35],s64 offen nt lds
s_add_u32 s64,s74,1073152
s_add_u32 m0,s75,3072
s_nop 0
buffer_load_dwordx4 v9,s[32:35],s64 offen nt lds
s_add_u32 s64,s74,1081344
s_add_u32 m0,s75,4096
s_nop 0
buffer_load_dwordx4 v8,s[32:35],s64 offen nt lds
s_add_u32 s64,s74,1089536
s_add_u32 m0,s75,5120
s_nop 0
buffer_load_dwordx4 v9,s[32:35],s64 offen nt lds
s_add_u32 s64,s74,1097728
s_add_u32 m0,s75,6144
s_nop 0
buffer_load_dwordx4 v8,s[32:35],s64 offen nt lds
s_add_u32 s64,s74,1105920
s_add_u32 m0,s75,7168
s_nop 0
buffer_load_dwordx4 v9,s[32:35],s64 offen nt lds
s_add_u32 s64,s74,1114112
s_add_u32 m0,s75,8192
s_nop 0
buffer_load_dwordx4 v8,s[32:35],s64 offen nt lds
s_add_u32 s64,s74,1122304
s_add_u32 m0,s75,9216
s_nop 0
buffer_load_dwordx4 v9,s[32:35],s64 offen nt lds
s_add_u32 s64,s74,1130496
s_add_u32 m0,s75,10240
s_nop 0
buffer_load_dwordx4 v8,s[32:35],s64 offen nt lds
s_add_u32 s64,s74,1138688
s_add_u32 m0,s75,11264
s_nop 0
buffer_load_dwordx4 v9,s[32:35],s64 offen nt lds
s_add_u32 s64,s74,1146880
s_add_u32 m0,s75,12288
s_nop 0
buffer_load_dwordx4 v8,s[32:35],s64 offen nt lds
s_add_u32 s64,s74,1155072
s_add_u32 m0,s75,13312
s_nop 0
buffer_load_dwordx4 v9,s[32:35],s64 offen nt lds
s_add_u32 s64,s74,1163264
s_add_u32 m0,s75,14336
s_nop 0
buffer_load_dwordx4 v8,s[32:35],s64 offen nt lds
s_add_u32 s64,s74,1171456
s_add_u32 m0,s75,15360
s_nop 0
buffer_load_dwordx4 v9,s[32:35],s64 offen nt lds
s_waitcnt vmcnt(16)
s_barrier
ds_read_b64_tr_b16 a[28:29],v12 offset:0
ds_read_b64_tr_b16 a[140:141],v13 offset:0
ds_read_b64_tr_b16 a[30:31],v12 offset:4096
ds_read_b64_tr_b16 a[142:143],v13 offset:4096
ds_read_b64_tr_b16 a[32:33],v12 offset:8192
ds_read_b64_tr_b16 a[144:145],v13 offset:8192
ds_read_b64_tr_b16 a[34:35],v12 offset:12288
ds_read_b64_tr_b16 a[146:147],v13 offset:12288
s_waitcnt lgkmcnt(4)
ds_read_b64_tr_b16 a[36:37],v12 offset:20480
ds_read_b64_tr_b16 a[148:149],v13 offset:20480
ds_read_b64_tr_b16 a[38:39],v12 offset:24576
ds_read_b64_tr_b16 a[150:151],v13 offset:24576
ds_read_b64_tr_b16 a[40:41],v12 offset:28672
ds_read_b64_tr_b16 a[152:153],v13 offset:28672
ds_read_b64_tr_b16 a[42:43],v12 offset:32768
ds_read_b64_tr_b16 a[154:155],v13 offset:32768
s_waitcnt lgkmcnt(4)
ds_read_b64_tr_b16 a[44:45],v12 offset:36864
ds_read_b64_tr_b16 a[156:157],v13 offset:36864
ds_read_b64_tr_b16 a[46:47],v12 offset:40960
ds_read_b64_tr_b16 a[158:159],v13 offset:40960
ds_read_b64_tr_b16 a[48:49],v12 offset:49152
ds_read_b64_tr_b16 a[160:161],v13 offset:49152
ds_read_b64_tr_b16 a[50:51],v12 offset:53248
ds_read_b64_tr_b16 a[162:163],v13 offset:53248
s_waitcnt lgkmcnt(4)
ds_read_b64_tr_b16 a[52:53],v12 offset:57344
ds_read_b64_tr_b16 a[164:165],v13 offset:57344
ds_read_b64_tr_b16 a[54:55],v12 offset:61440
ds_read_b64_tr_b16 a[166:167],v13 offset:61440
ds_read_b64_tr_b16 a[100:101],v12 offset:16384
ds_read_b64_tr_b16 a[212:213],v13 offset:16384
ds_read_b64_tr_b16 a[102:103],v12 offset:45056
ds_read_b64_tr_b16 a[214:215],v13 offset:45056
s_waitcnt lgkmcnt(4)
v_xor_b32 v12,0x10000,v12
v_xor_b32 v13,0x10000,v13
s_waitcnt lgkmcnt(0)
s_barrier
s_add_u32 s64,s76,1572864
s_add_u32 m0,s77,65536
s_nop 0
buffer_load_dwordx4 v8,s[32:35],s64 offen nt lds
s_add_u32 s64,s76,1581056
s_add_u32 m0,s77,66560
s_nop 0
buffer_load_dwordx4 v9,s[32:35],s64 offen nt lds
s_add_u32 s64,s76,1589248
s_add_u32 m0,s77,67584
s_nop 0
buffer_load_dwordx4 v8,s[32:35],s64 offen nt lds
s_add_u32 s64,s76,1597440
s_add_u32 m0,s77,68608
s_nop 0
buffer_load_dwordx4 v9,s[32:35],s64 offen nt lds
s_add_u32 s64,s76,1605632
s_add_u32 m0,s77,69632
s_nop 0
buffer_load_dwordx4 v8,s[32:35],s64 offen nt lds
s_add_u32 s64,s76,1613824
s_add_u32 m0,s77,70656
s_nop 0
buffer_load_dwordx4 v9,s[32:35],s64 offen nt lds
s_add_u32 s64,s76,1622016
s_add_u32 m0,s77,71680
s_nop 0
buffer_load_dwordx4 v8,s[32:35],s64 offen nt lds
s_add_u32 s64,s76,1630208
s_add_u32 m0,s77,72704
s_nop 0
buffer_load_dwordx4 v9,s[32:35],s64 offen nt lds
s_waitcnt vmcnt(8)
s_barrier
ds_read_b64_tr_b16 a[56:57],v12 offset:0
ds_read_b64_tr_b16 a[168:169],v13 offset:0
ds_read_b64_tr_b16 a[58:59],v12 offset:4096
ds_read_b64_tr_b16 a[170:171],v13 offset:4096
ds_read_b64_tr_b16 a[60:61],v12 offset:12288
ds_read_b64_tr_b16 a[172:173],v13 offset:12288
ds_read_b64_tr_b16 a[62:63],v12 offset:16384
ds_read_b64_tr_b16 a[174:175],v13 offset:16384
s_waitcnt lgkmcnt(4)
ds_read_b64_tr_b16 a[64:65],v12 offset:20480
ds_read_b64_tr_b16 a[176:177],v13 offset:20480
ds_read_b64_tr_b16 a[66:67],v12 offset:24576
ds_read_b64_tr_b16 a[178:179],v13 offset:24576
ds_read_b64_tr_b16 a[68:69],v12 offset:28672
ds_read_b64_tr_b16 a[180:181],v13 offset:28672
ds_read_b64_tr_b16 a[70:71],v12 offset:32768
ds_read_b64_tr_b16 a[182:183],v13 offset:32768
s_waitcnt lgkmcnt(4)
ds_read_b64_tr_b16 a[72:73],v12 offset:40960
ds_read_b64_tr_b16 a[184:185],v13 offset:40960
ds_read_b64_tr_b16 a[74:75],v12 offset:45056
ds_read_b64_tr_b16 a[186:187],v13 offset:45056
ds_read_b64_tr_b16 a[76:77],v12 offset:49152
ds_read_b64_tr_b16 a[188:189],v13 offset:49152
ds_read_b64_tr_b16 a[78:79],v12 offset:53248
ds_read_b64_tr_b16 a[190:191],v13 offset:53248
s_waitcnt lgkmcnt(4)
ds_read_b64_tr_b16 a[80:81],v12 offset:57344
ds_read_b64_tr_b16 a[192:193],v13 offset:57344
ds_read_b64_tr_b16 a[82:83],v12 offset:61440
ds_read_b64_tr_b16 a[194:195],v13 offset:61440
ds_read_b64_tr_b16 a[104:105],v12 offset:8192
ds_read_b64_tr_b16 a[216:217],v13 offset:8192
ds_read_b64_tr_b16 a[106:107],v12 offset:36864
ds_read_b64_tr_b16 a[218:219],v13 offset:36864
s_waitcnt lgkmcnt(4)
v_xor_b32 v12,0x10000,v12
v_xor_b32 v13,0x10000,v13
s_waitcnt lgkmcnt(0)
s_barrier
s_waitcnt vmcnt(0)
s_barrier
ds_read_b64_tr_b16 a[84:85],v12 offset:4096
ds_read_b64_tr_b16 a[196:197],v13 offset:4096
ds_read_b64_tr_b16 a[86:87],v12 offset:8192
ds_read_b64_tr_b16 a[198:199],v13 offset:8192
ds_read_b64_tr_b16 a[88:89],v12 offset:12288
ds_read_b64_tr_b16 a[200:201],v13 offset:12288
ds_read_b64_tr_b16 a[90:91],v12 offset:16384
ds_read_b64_tr_b16 a[202:203],v13 offset:16384
s_waitcnt lgkmcnt(4)
ds_read_b64_tr_b16 a[92:93],v12 offset:20480
ds_read_b64_tr_b16 a[204:205],v13 offset:20480
ds_read_b64_tr_b16 a[94:95],v12 offset:24576
ds_read_b64_tr_b16 a[206:207],v13 offset:24576
ds_read_b64_tr_b16 a[108:109],v12 offset:0
ds_read_b64_tr_b16 a[220:221],v13 offset:0
ds_read_b64_tr_b16 a[110:111],v12 offset:28672
ds_read_b64_tr_b16 a[222:223],v13 offset:28672
s_waitcnt lgkmcnt(4)
v_xor_b32 v12,0x10000,v12
v_xor_b32 v13,0x10000,v13
s_waitcnt lgkmcnt(0)
s_barrier
v_and_b32 v21,1,v1
v_mul_u32_u24 v21,960,v21
s_mov_b32 s65,21052032
s_mov_b32 s66,1792
pl_304:
buffer_load_dword v22,v21,s[20:23],s65 offen sc1
s_waitcnt vmcnt(0)
v_cmp_gt_u32 vcc,s66,v22
s_cbranch_vccz pok_305
s_sleep 1
s_sub_u32 s90,s90,1
s_cmp_gt_i32 s90,0
s_cbranch_scc1 pl_304
pok_305:
s_lshr_b32 s43,s41,1
s_and_b32 s48,s41,1
s_lshl_b32 s64,s42,7
s_lshl_b32 s65,s50,5
s_add_u32 s64,s64,s65
s_lshl_b32 s65,s48,4
s_add_u32 s64,s64,s65
v_lshl_add_u32 v5,v4,2,s64
v_lshlrev_b32 v6,2,v5
s_mov_b32 s64,20480
buffer_load_dwordx4 v[52:55],v6,s[20:23],s64 offen sc1
v_lshlrev_b32 v10,1,v5
v_and_b32 v6,3,v1
v_sub_u32 v5,v6,v4
v_lshl_add_u32 v5,v5,3,v10
v_lshrrev_b32 v11,2,v1
v_lshl_add_u32 v40,v6,4,v11
v_lshlrev_b32 v40,2,v40
v_lshl_add_u32 v41,v3,2,v4
v_lshlrev_b32 v41,2,v41
s_lshl_b32 s64,s43,10
v_add_u32 v17,s64,v16
v_xor_b32 v18,1024,v17
s_xor_b32 s64,s64,1024
s_lshr_b32 s65,s50,1
s_and_b32 s66,s50,1
s_lshl_b32 s66,s66,12
s_add_u32 s66,s66,s64
s_lshl_b32 s72,s65,13
s_add_u32 s72,s72,s66
s_add_u32 s72,s72,0x10000
s_lshl_b32 s65,s65,14
s_add_u32 s75,s65,s66
s_add_u32 s75,s75,1327104
s_mul_i32 s64,s41,114688
s_add_u32 s75,s75,s64
s_cmp_lt_u32 s50,2
s_cselect_b32 s86,98304,0x40000000
s_lshl_b32 s76,s79,21
s_add_u32 s76,s76,27262976
s_mov_b32 s77,0
s_lshl_b32 s78,s79,16
s_mov_b32 s49,0
s_cmp_eq_u32 s79,0
s_mov_b32 s66,8577024
s_cselect_b32 s66,18874368,s66
s_lshl_b32 s64,s59,14
s_lshl_b32 s65,s50,12
s_add_u32 s65,s65,s66
s_add_u32 s64,s64,s65
v_add_u32 v26,s64,v16
s_lshl_b32 s64,s42,14
s_add_u32 s64,s64,s65
v_add_u32 v25,s64,v16
s_xor_b32 s33,s41,1
s_xor_b32 s34,s41,2
s_xor_b32 s35,s41,3
s_lshl_b32 s33,s33,17
s_lshl_b32 s34,s34,17
s_lshl_b32 s35,s35,17
v_and_b32 v21,7,v1
v_lshlrev_b32 v21,7,v21
v_bfe_u32 v6,v1,3,2
v_lshl_add_u32 v21,v6,2,v21
s_lshl_b32 s74,s41,10
s_add_u32 s74,s74,s63
s_lshl_b32 s64,s60,4
s_add_u32 s74,s74,s64
s_add_u32 s74,s74,20480
s_lshl_b32 s64,s43,4
v_add_u32 v6,s64,v11
v_lshl_add_u32 v19,v6,11,v5
v_add_u32 v6,s64,v11
v_add_u32 v6,30,v6
v_lshl_add_u32 v9,v6,7,v5
v_and_b32 v9,2047,v9
v_and_b32 v7,3,v6
v_lshl_add_u32 v7,v7,11,v9
v_bfe_u32 v8,v6,2,3
v_lshl_add_u32 v7,v8,14,v7
v_mov_b32 v8,0x2000
v_mov_b32 v9,2097152
v_cmp_gt_u32 vcc,32,v6
s_nop 1
v_cndmask_b32 v8,v9,v8,vcc
v_add_u32 v7,v7,v8
v_add_u32 v7,1048576,v7
v_xor_b32 v20,s62,v7
s_lshl_b32 s64,s42,14
s_lshl_b32 s65,s50,11
s_add_u32 s64,s64,s65
s_lshl_b32 s65,s43,10
s_add_u32 s64,s64,s65
s_lshl_b32 s65,s48,3
s_add_u32 s64,s64,s65
s_add_u32 s64,s64,1179648
v_add_u32 v24,s64,v16
s_mov_b32 s84,0xffffff00
s_or_b32 s64,s43,s79
s_cselect_b32 s84,-1,s84
s_mov_b32 s85,-1
s_mov_b32 s48,1
s_waitcnt vmcnt(0)
s_cmp_lg_u32 s56,0
s_cbranch_scc1 kslow_306
s_add_u32 s64,s79,0
s_lshl_b32 s70,s64,21
s_lshl_b32 s64,s64,13
s_and_b32 s64,s64,0x2000
s_xor_b32 s64,s64,s62
s_add_u32 s70,s70,s64
s_add_u32 s70,s70,29360128
s_mov_b32 s83,1
s_mov_b32 s87,s74
s_cmp_eq_u32 s50,0
s_cselect_b32 s74,s74,0x7fff0000
v_mov_b32 v47,132096
s_lshl_b32 s64,s50,3
s_add_u32 s64,s64,132096
v_mov_b32 v46,s64
v_mov_b32 v29,0
s_mov_b32 s97,0x7fff0000
seg_308:
s_cmp_eq_u32 s83,0
s_cbranch_scc1 ahead_309
s_add_u32 s94,s70,s75
s_xor_b32 s95,s94,1024
s_xor_b32 s91,s72,0x10000
s_waitcnt vmcnt(1)
v_cmp_gt_u32 vcc,s71,v29
s_cbranch_vccz nb_312
s_cmp_lg_u32 s50,0
s_cbranch_scc1 nb_312
buffer_load_dword v32,v21,s[20:23],s74 offen sc1
s_sleep 2
pl_313:
buffer_load_dword v33,v21,s[20:23],s74 offen sc1
s_waitcnt vmcnt(1)
v_cmp_gt_u32 vcc,s71,v32
v_mov_b32 v29,v32
s_cbranch_vccz pok_314
buffer_load_dword v32,v21,s[20:23],s74 offen sc1
s_waitcnt vmcnt(1)
v_cmp_gt_u32 vcc,s71,v33
v_mov_b32 v29,v33
s_cbranch_vccz pok_314
s_sub_u32 s90,s90,1
s_cmp_gt_i32 s90,0
s_cbranch_scc1 pl_313
pok_314:
nb_312:
s_barrier
s_xor_b32 m0,s91,0
s_add_u32 s65,s94,0
buffer_load_dwordx4 v16,s[20:23],s65 offen offset:0 sc1 lds
buffer_load_dwordx4 v16,s[20:23],s65 offen offset:2048 sc1 lds
s_xor_b32 m0,s91,16384
s_add_u32 s65,s94,32768
buffer_load_dwordx4 v16,s[20:23],s65 offen offset:0 sc1 lds
buffer_load_dwordx4 v16,s[20:23],s65 offen offset:2048 sc1 lds
s_xor_b32 m0,s91,32768
s_add_u32 s65,s94,65536
buffer_load_dwordx4 v16,s[20:23],s65 offen offset:0 sc1 lds
buffer_load_dwordx4 v16,s[20:23],s65 offen offset:2048 sc1 lds
s_xor_b32 m0,s91,49152
s_add_u32 s65,s94,s86
buffer_load_dwordx4 v16,s[20:23],s65 offen offset:0 sc1 lds
buffer_load_dwordx4 v16,s[20:23],s65 offen offset:2048 sc1 lds
s_waitcnt vmcnt(6)
s_barrier
ds_read_b128 v[224:227],v18 offset:0
ds_read_b128 v[228:231],v18 offset:2048
ds_read_b128 v[232:235],v18 offset:4096
ds_read_b128 v[236:239],v18 offset:6144
ds_read_b128 v[240:243],v18 offset:8192
ds_read_b128 v[244:247],v18 offset:10240
ds_read_b128 v[248:251],v18 offset:12288
s_waitcnt lgkmcnt(5)
v_mfma_f32_16x16x32_bf16 v[64:67],a[0:3],v[224:227],0
s_xor_b32 m0,s91,1024
s_add_u32 s96,s71,1
v_mfma_f32_16x16x32_bf16 v[68:71],a[112:115],v[224:227],0
ds_read_b128 v[252:255],v18 offset:14336
s_add_u32 s92,s71,2
v_mfma_f32_16x16x32_bf16 v[64:67],a[4:7],v[228:231],v[64:67]
s_add_u32 s65,s95,0
v_min_u32 v27,v224,v228
v_mfma_f32_16x16x32_bf16 v[68:71],a[116:119],v[228:231],v[68:71]
s_waitcnt vmcnt(4)
s_barrier
ds_read_b128 v[224:227],v18 offset:16384
s_waitcnt lgkmcnt(5)
v_mfma_f32_16x16x32_bf16 v[64:67],a[8:11],v[232:235],v[64:67]
buffer_load_dwordx4 v16,s[20:23],s65 offen offset:0 sc1 lds
v_mfma_f32_16x16x32_bf16 v[68:71],a[120:123],v[232:235],v[68:71]
ds_read_b128 v[228:231],v18 offset:18432
v_min3_u32 v27,v27,v232,v236
v_mfma_f32_16x16x32_bf16 v[64:67],a[12:15],v[236:239],v[64:67]
buffer_load_dwordx4 v16,s[20:23],s65 offen offset:2048 sc1 lds
v_mfma_f32_16x16x32_bf16 v[68:71],a[124:127],v[236:239],v[68:71]
ds_read_b128 v[232:235],v18 offset:20480
s_waitcnt lgkmcnt(5)
v_mfma_f32_16x16x32_bf16 v[64:67],a[16:19],v[240:243],v[64:67]
s_xor_b32 m0,s91,17408
v_min3_u32 v27,v27,v240,v244
v_mfma_f32_16x16x32_bf16 v[68:71],a[128:131],v[240:243],v[68:71]
ds_read_b128 v[236:239],v18 offset:22528
v_mfma_f32_16x16x32_bf16 v[64:67],a[20:23],v[244:247],v[64:67]
s_add_u32 s65,s95,32768
s_waitcnt vmcnt(63)
v_mfma_f32_16x16x32_bf16 v[68:71],a[132:135],v[244:247],v[68:71]
ds_read_b128 v[240:243],v18 offset:24576
s_waitcnt lgkmcnt(5)
v_mfma_f32_16x16x32_bf16 v[64:67],a[24:27],v[248:251],v[64:67]
buffer_load_dwordx4 v16,s[20:23],s65 offen offset:0 sc1 lds
v_min3_u32 v27,v27,v248,v252
v_mfma_f32_16x16x32_bf16 v[68:71],a[136:139],v[248:251],v[68:71]
ds_read_b128 v[244:247],v18 offset:26624
v_cmp_gt_u32 vcc,s96,v29
v_cmp_gt_u32 s[92:93],s92,v29
v_mfma_f32_16x16x32_bf16 v[64:67],a[28:31],v[252:255],v[64:67]
buffer_load_dwordx4 v16,s[20:23],s65 offen offset:2048 sc1 lds
v_mfma_f32_16x16x32_bf16 v[68:71],a[140:143],v[252:255],v[68:71]
ds_read_b128 v[248:251],v18 offset:28672
s_waitcnt lgkmcnt(5)
v_mfma_f32_16x16x32_bf16 v[64:67],a[32:35],v[224:227],v[64:67]
s_xor_b32 m0,s91,33792
v_mov_b32 v44,vcc_lo
v_mov_b32 v45,s92
v_mfma_f32_16x16x32_bf16 v[68:71],a[144:147],v[224:227],v[68:71]
ds_read_b128 v[252:255],v18 offset:30720
ds_write_b64 v46,v[44:45]
v_mfma_f32_16x16x32_bf16 v[64:67],a[36:39],v[228:231],v[64:67]
s_add_u32 s65,s95,65536
v_min3_u32 v27,v27,v224,v228
v_mfma_f32_16x16x32_bf16 v[68:71],a[148:151],v[228:231],v[68:71]
s_waitcnt vmcnt(4)
s_barrier
ds_read_b128 v[224:227],v18 offset:32768
s_waitcnt lgkmcnt(6)
v_mfma_f32_16x16x32_bf16 v[64:67],a[40:43],v[232:235],v[64:67]
buffer_load_dwordx4 v16,s[20:23],s65 offen offset:0 sc1 lds
s_add_u32 s88,s70,s75
v_mfma_f32_16x16x32_bf16 v[68:71],a[152:155],v[232:235],v[68:71]
ds_read_b128 v[228:231],v18 offset:34816
v_min3_u32 v27,v27,v232,v236
s_add_u32 s88,s88,2097152
v_mfma_f32_16x16x32_bf16 v[64:67],a[44:47],v[236:239],v[64:67]
buffer_load_dwordx4 v16,s[20:23],s65 offen offset:2048 sc1 lds
v_mfma_f32_16x16x32_bf16 v[68:71],a[156:159],v[236:239],v[68:71]
ds_read_b128 v[232:235],v18 offset:36864
s_waitcnt lgkmcnt(6)
v_mfma_f32_16x16x32_bf16 v[64:67],a[48:51],v[240:243],v[64:67]
s_xor_b32 m0,s91,50176
v_min3_u32 v27,v27,v240,v244
v_mfma_f32_16x16x32_bf16 v[68:71],a[160:163],v[240:243],v[68:71]
ds_read_b128 v[236:239],v18 offset:38912
s_xor_b32 s88,s88,0x2000
v_mfma_f32_16x16x32_bf16 v[64:67],a[52:55],v[244:247],v[64:67]
s_add_u32 s65,s95,s86
s_xor_b32 s89,s88,1024
v_mfma_f32_16x16x32_bf16 v[68:71],a[164:167],v[244:247],v[68:71]
ds_read_b128 v[240:243],v18 offset:40960
s_waitcnt lgkmcnt(6)
v_mfma_f32_16x16x32_bf16 v[64:67],a[56:59],v[248:251],v[64:67]
buffer_load_dwordx4 v16,s[20:23],s65 offen offset:0 sc1 lds
v_mfma_f32_16x16x32_bf16 v[68:71],a[168:171],v[248:251],v[68:71]
ds_read_b128 v[244:247],v18 offset:43008
v_min3_u32 v27,v27,v248,v252
v_mfma_f32_16x16x32_bf16 v[64:67],a[60:63],v[252:255],v[64:67]
buffer_load_dwordx4 v16,s[20:23],s65 offen offset:2048 sc1 lds
v_mfma_f32_16x16x32_bf16 v[68:71],a[172:175],v[252:255],v[68:71]
ds_read_b128 v[248:251],v18 offset:45056
s_waitcnt lgkmcnt(5)
v_mfma_f32_16x16x32_bf16 v[64:67],a[64:67],v[224:227],v[64:67]
s_waitcnt vmcnt(4)
s_barrier
ds_read_b64 v[44:45],v47
ds_read_b128 v[128:131],v17 offset:0
ds_read_b128 v[132:135],v17 offset:2048
v_mfma_f32_16x16x32_bf16 v[68:71],a[176:179],v[224:227],v[68:71]
ds_read_b128 v[252:255],v18 offset:47104
v_min3_u32 v27,v27,v224,v228
v_mfma_f32_16x16x32_bf16 v[64:67],a[68:71],v[228:231],v[64:67]
ds_read_b128 v[136:139],v17 offset:4096
buffer_load_dwordx2 v[120:121],v20,s[20:23],s76 offen sc1
v_mfma_f32_16x16x32_bf16 v[68:71],a[180:183],v[228:231],v[68:71]
ds_read_b128 v[224:227],v18 offset:49152
s_waitcnt lgkmcnt(9)
v_mfma_f32_16x16x32_bf16 v[64:67],a[72:75],v[232:235],v[64:67]
ds_read_b128 v[140:143],v17 offset:6144
v_min3_u32 v27,v27,v232,v236
v_mfma_f32_16x16x32_bf16 v[68:71],a[184:187],v[232:235],v[68:71]
ds_read_b128 v[228:231],v18 offset:51200
buffer_load_dwordx2 v[122:123],v24,s[20:23],s70 offen sc1
v_mfma_f32_16x16x32_bf16 v[64:67],a[76:79],v[236:239],v[64:67]
ds_read_b128 v[144:147],v17 offset:8192
ds_read_b128 v[148:151],v17 offset:10240
v_mfma_f32_16x16x32_bf16 v[68:71],a[188:191],v[236:239],v[68:71]
ds_read_b128 v[232:235],v18 offset:53248
s_waitcnt lgkmcnt(12)
v_mfma_f32_16x16x32_bf16 v[64:67],a[80:83],v[240:243],v[64:67]
ds_read_b128 v[152:155],v17 offset:12288
s_waitcnt lgkmcnt(11)
v_min3_u32 v27,v27,v240,v244
v_mfma_f32_16x16x32_bf16 v[68:71],a[192:195],v[240:243],v[68:71]
ds_read_b128 v[236:239],v18 offset:55296
v_readfirstlane_b32 s93,v45
v_mfma_f32_16x16x32_bf16 v[64:67],a[84:87],v[244:247],v[64:67]
ds_read_b128 v[156:159],v17 offset:14336
v_readfirstlane_b32 s83,v44
s_cmp_lg_u32 s83,0
s_cbranch_scc0 keep_315
v_mfma_f32_16x16x32_bf16 v[68:71],a[196:199],v[244:247],v[68:71]
s_waitcnt lgkmcnt(10)
v_mfma_f32_16x16x32_bf16 v[64:67],a[88:91],v[248:251],v[64:67]
ds_read_b128 v[160:163],v17 offset:16384
ds_read_b128 v[164:167],v17 offset:18432
v_mfma_f32_16x16x32_bf16 v[68:71],a[200:203],v[248:251],v[68:71]
v_min3_u32 v27,v27,v248,v252
v_mfma_f32_16x16x32_bf16 v[64:67],a[92:95],v[252:255],v[64:67]
ds_read_b128 v[168:171],v17 offset:20480
v_mfma_f32_16x16x32_bf16 v[68:71],a[204:207],v[252:255],v[68:71]
s_waitcnt lgkmcnt(9)
v_mfma_f32_16x16x32_bf16 v[64:67],a[96:99],v[224:227],v[64:67]
ds_read_b128 v[172:175],v17 offset:22528
v_min3_u32 v27,v27,v224,v228
v_mfma_f32_16x16x32_bf16 v[68:71],a[208:211],v[224:227],v[68:71]
v_min3_u32 v27,v27,v226,v230
v_mfma_f32_16x16x32_bf16 v[64:67],a[100:103],v[228:231],v[64:67]
ds_read_b128 v[176:179],v17 offset:24576
ds_read_b128 v[180:183],v17 offset:26624
v_mfma_f32_16x16x32_bf16 v[68:71],a[212:215],v[228:231],v[68:71]
s_waitcnt lgkmcnt(7)
v_mfma_f32_16x16x32_bf16 v[64:67],a[104:107],v[232:235],v[64:67]
ds_read_b128 v[184:187],v17 offset:28672
v_min3_u32 v27,v27,v232,v236
v_mfma_f32_16x16x32_bf16 v[68:71],a[216:219],v[232:235],v[68:71]
v_min3_u32 v27,v27,v234,v238
v_mfma_f32_16x16x32_bf16 v[64:67],a[108:111],v[236:239],v[64:67]
ds_read_b128 v[188:191],v17 offset:30720
v_mfma_f32_16x16x32_bf16 v[68:71],a[220:223],v[236:239],v[68:71]
v_mfma_f32_16x16x32_bf16 v[72:75],a[112:115],v[128:131],0
v_cmp_eq_u32 vcc,0,v27
s_cbranch_vccnz retry_307
v_mfma_f32_16x16x32_bf16 v[76:79],a[116:119],v[132:135],0
v_min3_u32 v27,v27,v128,v132
v_mfma_f32_16x16x32_bf16 v[72:75],a[120:123],v[136:139],v[72:75]
s_waitcnt vmcnt(2)
s_barrier
ds_read_b128 v[192:195],v17 offset:32768
v_mfma_f32_16x16x32_bf16 v[76:79],a[124:127],v[140:143],v[76:79]
ds_read_b128 v[196:199],v17 offset:34816
s_waitcnt lgkmcnt(10)
v_mfma_f32_16x16x32_bf16 v[72:75],a[128:131],v[144:147],v[72:75]
ds_read_b128 v[200:203],v17 offset:36864
v_min3_u32 v27,v27,v136,v140
s_waitcnt vmcnt(0)
v_mfma_f32_16x16x32_bf16 v[76:79],a[132:135],v[148:151],v[76:79]
ds_read_b128 v[204:207],v17 offset:38912
v_min3_u32 v27,v27,v144,v148
v_and_or_b32 v64,v64,-4,s48
v_mfma_f32_16x16x32_bf16 v[72:75],a[136:139],v[152:155],v[72:75]
ds_read_b128 v[208:211],v17 offset:40960
s_add_u32 s64,s49,s34
v_mfma_f32_16x16x32_bf16 v[76:79],a[140:143],v[156:159],v[76:79]
v_min3_u32 v27,v27,v152,v156
s_waitcnt lgkmcnt(9)
v_mfma_f32_16x16x32_bf16 v[72:75],a[144:147],v[160:163],v[72:75]
ds_read_b128 v[212:215],v17 offset:43008
buffer_store_dwordx4 v[64:67],v25,s[20:23],s64 offen offset:2048
v_mfma_f32_16x16x32_bf16 v[76:79],a[148:151],v[164:167],v[76:79]
ds_read_b128 v[216:219],v17 offset:45056
v_min3_u32 v27,v27,v160,v164
v_and_or_b32 v68,v68,-4,s48
v_mfma_f32_16x16x32_bf16 v[72:75],a[152:155],v[168:171],v[72:75]
ds_read_b128 v[220:223],v17 offset:47104
s_add_u32 s64,s49,s35
v_mfma_f32_16x16x32_bf16 v[76:79],a[156:159],v[172:175],v[76:79]
ds_read_b128 v[224:227],v17 offset:49152
s_waitcnt lgkmcnt(9)
v_mfma_f32_16x16x32_bf16 v[72:75],a[160:163],v[176:179],v[72:75]
ds_read_b128 v[228:231],v17 offset:51200
v_min3_u32 v27,v27,v168,v172
v_mfma_f32_16x16x32_bf16 v[76:79],a[164:167],v[180:183],v[76:79]
v_min3_u32 v27,v27,v176,v180
buffer_store_dwordx4 v[68:71],v25,s[20:23],s64 offen offset:3072
v_mfma_f32_16x16x32_bf16 v[72:75],a[168:171],v[184:187],v[72:75]
ds_read_b128 v[232:235],v17 offset:53248
s_mov_b32 s49,0x7fff0000
v_mfma_f32_16x16x32_bf16 v[76:79],a[172:175],v[188:191],v[76:79]
ds_read_b128 v[236:239],v17 offset:55296
s_waitcnt lgkmcnt(8)
v_mfma_f32_16x16x32_bf16 v[72:75],a[176:179],v[192:195],v[72:75]
v_min3_u32 v27,v27,v184,v188
v_mfma_f32_16x16x32_bf16 v[76:79],a[180:183],v[196:199],v[76:79]
v_min3_u32 v27,v27,v192,v196
ds_bpermute_b32 v124,v41,v120
v_mfma_f32_16x16x32_bf16 v[72:75],a[184:187],v[200:203],v[72:75]
v_mfma_f32_16x16x32_bf16 v[76:79],a[188:191],v[204:207],v[76:79]
v_min3_u32 v27,v27,v200,v204
s_waitcnt lgkmcnt(5)
v_mfma_f32_16x16x32_bf16 v[72:75],a[192:195],v[208:211],v[72:75]
ds_bpermute_b32 v125,v41,v121
v_mfma_f32_16x16x32_bf16 v[76:79],a[196:199],v[212:215],v[76:79]
v_min3_u32 v27,v27,v208,v212
v_lshlrev_b32 v108,16,v122
v_mfma_f32_16x16x32_bf16 v[72:75],a[200:203],v[216:219],v[72:75]
v_mfma_f32_16x16x32_bf16 v[76:79],a[204:207],v[220:223],v[76:79]
v_min3_u32 v27,v27,v216,v220
s_waitcnt lgkmcnt(2)
v_mfma_f32_16x16x32_bf16 v[72:75],a[208:211],v[224:227],v[72:75]
v_and_b32 v109,s80,v122
v_mfma_f32_16x16x32_bf16 v[76:79],a[212:215],v[228:231],v[76:79]
v_min3_u32 v27,v27,v224,v228
v_min3_u32 v27,v27,v226,v230
v_mfma_f32_16x16x32_bf16 v[72:75],a[216:219],v[232:235],v[72:75]
v_lshlrev_b32 v110,16,v123
v_mfma_f32_16x16x32_bf16 v[76:79],a[220:223],v[236:239],v[76:79]
v_min3_u32 v27,v27,v232,v236
v_min3_u32 v27,v27,v234,v238
v_mfma_f32_16x16x32_bf16 v[80:83],a[0:3],v[128:131],0
v_cmp_eq_u32 vcc,0,v27
s_cbranch_vccnz retry_307
v_mfma_f32_16x16x32_bf16 v[84:87],a[4:7],v[132:135],0
v_and_b32 v111,s80,v123
s_waitcnt lgkmcnt(0)
v_mfma_f32_16x16x32_bf16 v[80:83],a[8:11],v[136:139],v[80:83]
v_mfma_f32_16x16x32_bf16 v[84:87],a[12:15],v[140:143],v[84:87]
v_lshlrev_b32 v104,16,v124
v_mfma_f32_16x16x32_bf16 v[80:83],a[16:19],v[144:147],v[80:83]
v_add_f32 v72,v72,v76
v_add_f32 v73,v73,v77
v_mfma_f32_16x16x32_bf16 v[84:87],a[20:23],v[148:151],v[84:87]
v_and_b32 v105,s80,v124
v_add_f32 v74,v74,v78
v_mfma_f32_16x16x32_bf16 v[80:83],a[24:27],v[152:155],v[80:83]
v_add_f32 v75,v75,v79
v_and_or_b32 v72,v72,-4,s48
v_mfma_f32_16x16x32_bf16 v[84:87],a[28:31],v[156:159],v[84:87]
v_lshlrev_b32 v106,16,v125
s_add_u32 s64,s77,s33
v_mfma_f32_16x16x32_bf16 v[80:83],a[32:35],v[160:163],v[80:83]
buffer_store_dwordx4 v[72:75],v25,s[20:23],s64 offen offset:1024
v_mfma_f32_16x16x32_bf16 v[84:87],a[36:39],v[164:167],v[84:87]
v_and_b32 v107,s80,v125
v_mfma_f32_16x16x32_bf16 v[80:83],a[40:43],v[168:171],v[80:83]
v_mfma_f32_16x16x32_bf16 v[84:87],a[44:47],v[172:175],v[84:87]
v_mfma_f32_16x16x32_bf16 v[80:83],a[48:51],v[176:179],v[80:83]
buffer_load_dwordx4 v[96:99],v26,s[20:23],s77 offen offset:2048 sc1
v_mfma_f32_16x16x32_bf16 v[84:87],a[52:55],v[180:183],v[84:87]
buffer_load_dwordx4 v[100:103],v26,s[20:23],s77 offen offset:3072 sc1
v_mfma_f32_16x16x32_bf16 v[80:83],a[56:59],v[184:187],v[80:83]
v_mfma_f32_16x16x32_bf16 v[84:87],a[60:63],v[188:191],v[84:87]
v_mfma_f32_16x16x32_bf16 v[80:83],a[64:67],v[192:195],v[80:83]
v_mfma_f32_16x16x32_bf16 v[84:87],a[68:71],v[196:199],v[84:87]
v_mfma_f32_16x16x32_bf16 v[80:83],a[72:75],v[200:203],v[80:83]
v_mfma_f32_16x16x32_bf16 v[84:87],a[76:79],v[204:207],v[84:87]
v_mfma_f32_16x16x32_bf16 v[80:83],a[80:83],v[208:211],v[80:83]
v_mfma_f32_16x16x32_bf16 v[84:87],a[84:87],v[212:215],v[84:87]
v_mfma_f32_16x16x32_bf16 v[80:83],a[88:91],v[216:219],v[80:83]
buffer_load_dwordx4 v[92:95],v26,s[20:23],s77 offen offset:1024 sc1
v_mfma_f32_16x16x32_bf16 v[84:87],a[92:95],v[220:223],v[84:87]
v_mfma_f32_16x16x32_bf16 v[80:83],a[96:99],v[224:227],v[80:83]
v_mfma_f32_16x16x32_bf16 v[84:87],a[100:103],v[228:231],v[84:87]
v_mfma_f32_16x16x32_bf16 v[80:83],a[104:107],v[232:235],v[80:83]
v_mfma_f32_16x16x32_bf16 v[84:87],a[108:111],v[236:239],v[84:87]
s_branch epi_310
keep_315:
v_mfma_f32_16x16x32_bf16 v[68:71],a[196:199],v[244:247],v[68:71]
s_xor_b32 m0,s72,0
s_waitcnt lgkmcnt(10)
v_mfma_f32_16x16x32_bf16 v[64:67],a[88:91],v[248:251],v[64:67]
ds_read_b128 v[160:163],v17 offset:16384
ds_read_b128 v[164:167],v17 offset:18432
s_add_u32 s65,s88,0
v_mfma_f32_16x16x32_bf16 v[68:71],a[200:203],v[248:251],v[68:71]
buffer_load_dwordx4 v16,s[20:23],s65 offen offset:0 sc1 lds
v_mfma_f32_16x16x32_bf16 v[64:67],a[92:95],v[252:255],v[64:67]
ds_read_b128 v[168:171],v17 offset:20480
v_min3_u32 v27,v27,v248,v252
v_mfma_f32_16x16x32_bf16 v[68:71],a[204:207],v[252:255],v[68:71]
buffer_load_dwordx4 v16,s[20:23],s65 offen offset:2048 sc1 lds
s_waitcnt lgkmcnt(9)
v_mfma_f32_16x16x32_bf16 v[64:67],a[96:99],v[224:227],v[64:67]
ds_read_b128 v[172:175],v17 offset:22528
s_xor_b32 m0,s72,16384
v_min3_u32 v27,v27,v224,v228
v_mfma_f32_16x16x32_bf16 v[68:71],a[208:211],v[224:227],v[68:71]
s_add_u32 s65,s88,32768
v_min3_u32 v27,v27,v226,v230
v_mfma_f32_16x16x32_bf16 v[64:67],a[100:103],v[228:231],v[64:67]
ds_read_b128 v[176:179],v17 offset:24576
ds_read_b128 v[180:183],v17 offset:26624
v_mfma_f32_16x16x32_bf16 v[68:71],a[212:215],v[228:231],v[68:71]
buffer_load_dwordx4 v16,s[20:23],s65 offen offset:0 sc1 lds
s_waitcnt lgkmcnt(7)
v_mfma_f32_16x16x32_bf16 v[64:67],a[104:107],v[232:235],v[64:67]
ds_read_b128 v[184:187],v17 offset:28672
v_min3_u32 v27,v27,v232,v236
v_min3_u32 v27,v27,v234,v238
v_mfma_f32_16x16x32_bf16 v[68:71],a[216:219],v[232:235],v[68:71]
buffer_load_dwordx4 v16,s[20:23],s65 offen offset:2048 sc1 lds
v_mfma_f32_16x16x32_bf16 v[64:67],a[108:111],v[236:239],v[64:67]
ds_read_b128 v[188:191],v17 offset:30720
s_xor_b32 m0,s72,32768
v_mfma_f32_16x16x32_bf16 v[68:71],a[220:223],v[236:239],v[68:71]
s_add_u32 s65,s88,65536
v_mfma_f32_16x16x32_bf16 v[72:75],a[112:115],v[128:131],0
buffer_load_dwordx4 v16,s[20:23],s65 offen offset:0 sc1 lds
v_cmp_eq_u32 vcc,0,v27
s_cbranch_vccnz retry_307
v_mfma_f32_16x16x32_bf16 v[76:79],a[116:119],v[132:135],0
buffer_load_dwordx4 v16,s[20:23],s65 offen offset:2048 sc1 lds
v_mfma_f32_16x16x32_bf16 v[72:75],a[120:123],v[136:139],v[72:75]
s_waitcnt vmcnt(8)
s_barrier
ds_read_b128 v[192:195],v17 offset:32768
v_mfma_f32_16x16x32_bf16 v[76:79],a[124:127],v[140:143],v[76:79]
ds_read_b128 v[196:199],v17 offset:34816
s_waitcnt lgkmcnt(10)
v_mfma_f32_16x16x32_bf16 v[72:75],a[128:131],v[144:147],v[72:75]
ds_read_b128 v[200:203],v17 offset:36864
s_xor_b32 m0,s72,49152
s_waitcnt vmcnt(6)
v_and_or_b32 v64,v64,-4,s48
v_mfma_f32_16x16x32_bf16 v[76:79],a[132:135],v[148:151],v[76:79]
ds_read_b128 v[204:207],v17 offset:38912
s_add_u32 s65,s88,s86
s_add_u32 s64,s49,s34
v_mfma_f32_16x16x32_bf16 v[72:75],a[136:139],v[152:155],v[72:75]
ds_read_b128 v[208:211],v17 offset:40960
v_min3_u32 v27,v27,v128,v132
buffer_store_dwordx4 v[64:67],v25,s[20:23],s64 offen offset:2048
v_mfma_f32_16x16x32_bf16 v[76:79],a[140:143],v[156:159],v[76:79]
v_min3_u32 v27,v27,v136,v140
v_and_or_b32 v68,v68,-4,s48
s_add_u32 s64,s49,s35
s_waitcnt lgkmcnt(9)
v_mfma_f32_16x16x32_bf16 v[72:75],a[144:147],v[160:163],v[72:75]
ds_read_b128 v[212:215],v17 offset:43008
v_min3_u32 v27,v27,v144,v148
buffer_store_dwordx4 v[68:71],v25,s[20:23],s64 offen offset:3072
v_mfma_f32_16x16x32_bf16 v[76:79],a[148:151],v[164:167],v[76:79]
ds_read_b128 v[216:219],v17 offset:45056
v_min3_u32 v27,v27,v152,v156
s_mov_b32 s49,0x7fff0000
v_mfma_f32_16x16x32_bf16 v[72:75],a[152:155],v[168:171],v[72:75]
ds_read_b128 v[220:223],v17 offset:47104
v_min3_u32 v27,v27,v160,v164
v_mfma_f32_16x16x32_bf16 v[76:79],a[156:159],v[172:175],v[76:79]
ds_read_b128 v[224:227],v17 offset:49152
s_waitcnt lgkmcnt(9)
v_mfma_f32_16x16x32_bf16 v[72:75],a[160:163],v[176:179],v[72:75]
ds_read_b128 v[228:231],v17 offset:51200
v_min3_u32 v27,v27,v168,v172
v_mfma_f32_16x16x32_bf16 v[76:79],a[164:167],v[180:183],v[76:79]
buffer_load_dwordx4 v16,s[20:23],s65 offen offset:0 sc1 lds
v_mfma_f32_16x16x32_bf16 v[72:75],a[168:171],v[184:187],v[72:75]
ds_read_b128 v[232:235],v17 offset:53248
v_min3_u32 v27,v27,v176,v180
v_mfma_f32_16x16x32_bf16 v[76:79],a[172:175],v[188:191],v[76:79]
ds_read_b128 v[236:239],v17 offset:55296
s_waitcnt lgkmcnt(8)
v_mfma_f32_16x16x32_bf16 v[72:75],a[176:179],v[192:195],v[72:75]
buffer_load_dwordx4 v16,s[20:23],s65 offen offset:2048 sc1 lds
v_mfma_f32_16x16x32_bf16 v[76:79],a[180:183],v[196:199],v[76:79]
s_xor_b32 m0,s72,1024
s_add_u32 s65,s89,0
v_mfma_f32_16x16x32_bf16 v[72:75],a[184:187],v[200:203],v[72:75]
buffer_load_dwordx4 v16,s[20:23],s65 offen offset:0 sc1 lds
v_mfma_f32_16x16x32_bf16 v[76:79],a[188:191],v[204:207],v[76:79]
v_min3_u32 v27,v27,v184,v188
v_min3_u32 v27,v27,v200,v204
s_waitcnt lgkmcnt(4)
v_mfma_f32_16x16x32_bf16 v[72:75],a[192:195],v[208:211],v[72:75]
buffer_load_dwordx4 v16,s[20:23],s65 offen offset:2048 sc1 lds
v_mfma_f32_16x16x32_bf16 v[76:79],a[196:199],v[212:215],v[76:79]
s_xor_b32 m0,s72,17408
s_add_u32 s65,s89,32768
v_min3_u32 v27,v27,v208,v212
v_mfma_f32_16x16x32_bf16 v[72:75],a[200:203],v[216:219],v[72:75]
buffer_load_dwordx4 v16,s[20:23],s65 offen offset:0 sc1 lds
v_mfma_f32_16x16x32_bf16 v[76:79],a[204:207],v[220:223],v[76:79]
v_min3_u32 v27,v27,v192,v196
v_min3_u32 v27,v27,v216,v220
s_waitcnt lgkmcnt(0)
v_mfma_f32_16x16x32_bf16 v[72:75],a[208:211],v[224:227],v[72:75]
buffer_load_dwordx4 v16,s[20:23],s65 offen offset:2048 sc1 lds
v_mfma_f32_16x16x32_bf16 v[76:79],a[212:215],v[228:231],v[76:79]
s_xor_b32 m0,s72,33792
s_add_u32 s65,s89,65536
v_min3_u32 v27,v27,v224,v228
v_mfma_f32_16x16x32_bf16 v[72:75],a[216:219],v[232:235],v[72:75]
buffer_load_dwordx4 v16,s[20:23],s65 offen offset:0 sc1 lds
v_min3_u32 v27,v27,v226,v230
v_mfma_f32_16x16x32_bf16 v[76:79],a[220:223],v[236:239],v[76:79]
buffer_load_dwordx4 v16,s[20:23],s65 offen offset:2048 sc1 lds
v_min3_u32 v27,v27,v232,v236
v_min3_u32 v27,v27,v234,v238
v_mfma_f32_16x16x32_bf16 v[80:83],a[0:3],v[128:131],0
s_xor_b32 m0,s72,50176
s_add_u32 s65,s89,s86
v_cmp_eq_u32 vcc,0,v27
s_cbranch_vccnz retry_307
v_mfma_f32_16x16x32_bf16 v[84:87],a[4:7],v[132:135],0
buffer_load_dwordx4 v16,s[20:23],s65 offen offset:0 sc1 lds
v_mfma_f32_16x16x32_bf16 v[80:83],a[8:11],v[136:139],v[80:83]
buffer_load_dwordx4 v16,s[20:23],s65 offen offset:2048 sc1 lds
v_mfma_f32_16x16x32_bf16 v[84:87],a[12:15],v[140:143],v[84:87]
ds_bpermute_b32 v124,v41,v120
ds_bpermute_b32 v125,v41,v121
v_mfma_f32_16x16x32_bf16 v[80:83],a[16:19],v[144:147],v[80:83]
v_lshlrev_b32 v108,16,v122
v_and_b32 v109,s80,v122
v_add_f32 v72,v72,v76
v_mfma_f32_16x16x32_bf16 v[84:87],a[20:23],v[148:151],v[84:87]
v_lshlrev_b32 v110,16,v123
v_and_b32 v111,s80,v123
v_add_f32 v73,v73,v77
v_mfma_f32_16x16x32_bf16 v[80:83],a[24:27],v[152:155],v[80:83]
s_waitcnt lgkmcnt(0)
v_lshlrev_b32 v104,16,v124
v_add_f32 v74,v74,v78
v_mfma_f32_16x16x32_bf16 v[84:87],a[28:31],v[156:159],v[84:87]
v_and_b32 v105,s80,v124
v_lshlrev_b32 v106,16,v125
v_mfma_f32_16x16x32_bf16 v[80:83],a[32:35],v[160:163],v[80:83]
v_add_f32 v75,v75,v79
v_and_or_b32 v72,v72,-4,s48
v_mfma_f32_16x16x32_bf16 v[84:87],a[36:39],v[164:167],v[84:87]
v_and_b32 v107,s80,v125
s_add_u32 s64,s77,s33
v_mfma_f32_16x16x32_bf16 v[80:83],a[40:43],v[168:171],v[80:83]
buffer_store_dwordx4 v[72:75],v25,s[20:23],s64 offen offset:1024
v_mfma_f32_16x16x32_bf16 v[84:87],a[44:47],v[172:175],v[84:87]
v_mfma_f32_16x16x32_bf16 v[80:83],a[48:51],v[176:179],v[80:83]
buffer_load_dwordx4 v[96:99],v26,s[20:23],s77 offen offset:2048 sc1
v_mfma_f32_16x16x32_bf16 v[84:87],a[52:55],v[180:183],v[84:87]
buffer_load_dwordx4 v[100:103],v26,s[20:23],s77 offen offset:3072 sc1
v_mfma_f32_16x16x32_bf16 v[80:83],a[56:59],v[184:187],v[80:83]
v_mfma_f32_16x16x32_bf16 v[84:87],a[60:63],v[188:191],v[84:87]
v_mfma_f32_16x16x32_bf16 v[80:83],a[64:67],v[192:195],v[80:83]
v_mfma_f32_16x16x32_bf16 v[84:87],a[68:71],v[196:199],v[84:87]
v_mfma_f32_16x16x32_bf16 v[80:83],a[72:75],v[200:203],v[80:83]
v_mfma_f32_16x16x32_bf16 v[84:87],a[76:79],v[204:207],v[84:87]
v_mfma_f32_16x16x32_bf16 v[80:83],a[80:83],v[208:211],v[80:83]
v_mfma_f32_16x16x32_bf16 v[84:87],a[84:87],v[212:215],v[84:87]
v_mfma_f32_16x16x32_bf16 v[80:83],a[88:91],v[216:219],v[80:83]
buffer_load_dwordx4 v[92:95],v26,s[20:23],s77 offen offset:1024 sc1
v_mfma_f32_16x16x32_bf16 v[84:87],a[92:95],v[220:223],v[84:87]
v_mfma_f32_16x16x32_bf16 v[80:83],a[96:99],v[224:227],v[80:83]
v_mfma_f32_16x16x32_bf16 v[84:87],a[100:103],v[228:231],v[84:87]
v_mfma_f32_16x16x32_bf16 v[80:83],a[104:107],v[232:235],v[80:83]
v_mfma_f32_16x16x32_bf16 v[84:87],a[108:111],v[236:239],v[84:87]
s_branch epi_310
ahead_309:
s_cmp_eq_u32 s93,0
s_cbranch_scc1 both_311
s_waitcnt vmcnt(14) lgkmcnt(0)
s_barrier
ds_read_b128 v[224:227],v18 offset:0
ds_read_b128 v[228:231],v18 offset:2048
ds_read_b128 v[232:235],v18 offset:4096
ds_read_b128 v[236:239],v18 offset:6144
ds_read_b128 v[240:243],v18 offset:8192
ds_read_b128 v[244:247],v18 offset:10240
ds_read_b128 v[248:251],v18 offset:12288
s_waitcnt lgkmcnt(5)
v_mfma_f32_16x16x32_bf16 v[64:67],a[0:3],v[224:227],0
s_add_u32 s96,s71,1
s_add_u32 s92,s71,2
v_mfma_f32_16x16x32_bf16 v[68:71],a[112:115],v[224:227],0
ds_read_b128 v[252:255],v18 offset:14336
v_min_u32 v27,v224,v228
v_mfma_f32_16x16x32_bf16 v[64:67],a[4:7],v[228:231],v[64:67]
buffer_load_dwordx2 v[120:121],v20,s[20:23],s76 offen sc1
v_mfma_f32_16x16x32_bf16 v[68:71],a[116:119],v[228:231],v[68:71]
ds_read_b128 v[224:227],v18 offset:16384
s_waitcnt lgkmcnt(5)
v_mfma_f32_16x16x32_bf16 v[64:67],a[8:11],v[232:235],v[64:67]
v_min3_u32 v27,v27,v232,v236
v_mfma_f32_16x16x32_bf16 v[68:71],a[120:123],v[232:235],v[68:71]
ds_read_b128 v[228:231],v18 offset:18432
v_mfma_f32_16x16x32_bf16 v[64:67],a[12:15],v[236:239],v[64:67]
buffer_load_dwordx2 v[122:123],v24,s[20:23],s70 offen sc1
v_mfma_f32_16x16x32_bf16 v[68:71],a[124:127],v[236:239],v[68:71]
ds_read_b128 v[232:235],v18 offset:20480
s_waitcnt lgkmcnt(5)
v_mfma_f32_16x16x32_bf16 v[64:67],a[16:19],v[240:243],v[64:67]
v_min3_u32 v27,v27,v240,v244
v_mfma_f32_16x16x32_bf16 v[68:71],a[128:131],v[240:243],v[68:71]
ds_read_b128 v[236:239],v18 offset:22528
v_mfma_f32_16x16x32_bf16 v[64:67],a[20:23],v[244:247],v[64:67]
s_waitcnt vmcnt(3)
v_mfma_f32_16x16x32_bf16 v[68:71],a[132:135],v[244:247],v[68:71]
ds_read_b128 v[240:243],v18 offset:24576
s_waitcnt lgkmcnt(5)
v_mfma_f32_16x16x32_bf16 v[64:67],a[24:27],v[248:251],v[64:67]
v_cmp_gt_u32 vcc,s96,v29
v_cmp_gt_u32 s[92:93],s92,v29
v_mfma_f32_16x16x32_bf16 v[68:71],a[136:139],v[248:251],v[68:71]
ds_read_b128 v[244:247],v18 offset:26624
v_min3_u32 v27,v27,v248,v252
v_mfma_f32_16x16x32_bf16 v[64:67],a[28:31],v[252:255],v[64:67]
v_mov_b32 v44,vcc_lo
v_mov_b32 v45,s92
v_mfma_f32_16x16x32_bf16 v[68:71],a[140:143],v[252:255],v[68:71]
ds_read_b128 v[248:251],v18 offset:28672
s_waitcnt lgkmcnt(5)
v_mfma_f32_16x16x32_bf16 v[64:67],a[32:35],v[224:227],v[64:67]
ds_write_b64 v46,v[44:45]
v_min3_u32 v27,v27,v224,v228
v_mfma_f32_16x16x32_bf16 v[68:71],a[144:147],v[224:227],v[68:71]
ds_read_b128 v[252:255],v18 offset:30720
v_mfma_f32_16x16x32_bf16 v[64:67],a[36:39],v[228:231],v[64:67]
v_mfma_f32_16x16x32_bf16 v[68:71],a[148:151],v[228:231],v[68:71]
ds_read_b128 v[224:227],v18 offset:32768
s_waitcnt lgkmcnt(6)
v_mfma_f32_16x16x32_bf16 v[64:67],a[40:43],v[232:235],v[64:67]
v_min3_u32 v27,v27,v232,v236
s_add_u32 s88,s70,s75
v_mfma_f32_16x16x32_bf16 v[68:71],a[152:155],v[232:235],v[68:71]
ds_read_b128 v[228:231],v18 offset:34816
s_add_u32 s88,s88,2097152
v_mfma_f32_16x16x32_bf16 v[64:67],a[44:47],v[236:239],v[64:67]
s_xor_b32 s88,s88,0x2000
s_xor_b32 s89,s88,1024
v_mfma_f32_16x16x32_bf16 v[68:71],a[156:159],v[236:239],v[68:71]
ds_read_b128 v[232:235],v18 offset:36864
s_waitcnt lgkmcnt(6)
v_mfma_f32_16x16x32_bf16 v[64:67],a[48:51],v[240:243],v[64:67]
v_min3_u32 v27,v27,v240,v244
v_mfma_f32_16x16x32_bf16 v[68:71],a[160:163],v[240:243],v[68:71]
ds_read_b128 v[236:239],v18 offset:38912
v_mfma_f32_16x16x32_bf16 v[64:67],a[52:55],v[244:247],v[64:67]
v_mfma_f32_16x16x32_bf16 v[68:71],a[164:167],v[244:247],v[68:71]
ds_read_b128 v[240:243],v18 offset:40960
s_waitcnt lgkmcnt(5)
v_mfma_f32_16x16x32_bf16 v[64:67],a[56:59],v[248:251],v[64:67]
v_min3_u32 v27,v27,v248,v252
v_mfma_f32_16x16x32_bf16 v[68:71],a[168:171],v[248:251],v[68:71]
ds_read_b128 v[244:247],v18 offset:43008
v_mfma_f32_16x16x32_bf16 v[64:67],a[60:63],v[252:255],v[64:67]
v_mfma_f32_16x16x32_bf16 v[68:71],a[172:175],v[252:255],v[68:71]
ds_read_b128 v[248:251],v18 offset:45056
s_waitcnt lgkmcnt(5)
v_mfma_f32_16x16x32_bf16 v[64:67],a[64:67],v[224:227],v[64:67]
s_waitcnt vmcnt(8)
s_barrier
ds_read_b64 v[44:45],v47
ds_read_b128 v[128:131],v17 offset:0
ds_read_b128 v[132:135],v17 offset:2048
v_mfma_f32_16x16x32_bf16 v[68:71],a[176:179],v[224:227],v[68:71]
ds_read_b128 v[252:255],v18 offset:47104
v_min3_u32 v27,v27,v224,v228
v_mfma_f32_16x16x32_bf16 v[64:67],a[68:71],v[228:231],v[64:67]
ds_read_b128 v[136:139],v17 offset:4096
v_mfma_f32_16x16x32_bf16 v[68:71],a[180:183],v[228:231],v[68:71]
ds_read_b128 v[224:227],v18 offset:49152
s_waitcnt lgkmcnt(9)
v_mfma_f32_16x16x32_bf16 v[64:67],a[72:75],v[232:235],v[64:67]
ds_read_b128 v[140:143],v17 offset:6144
v_min3_u32 v27,v27,v232,v236
v_mfma_f32_16x16x32_bf16 v[68:71],a[184:187],v[232:235],v[68:71]
ds_read_b128 v[228:231],v18 offset:51200
v_mfma_f32_16x16x32_bf16 v[64:67],a[76:79],v[236:239],v[64:67]
ds_read_b128 v[144:147],v17 offset:8192
ds_read_b128 v[148:151],v17 offset:10240
v_mfma_f32_16x16x32_bf16 v[68:71],a[188:191],v[236:239],v[68:71]
ds_read_b128 v[232:235],v18 offset:53248
s_waitcnt lgkmcnt(12)
v_mfma_f32_16x16x32_bf16 v[64:67],a[80:83],v[240:243],v[64:67]
ds_read_b128 v[152:155],v17 offset:12288
s_waitcnt lgkmcnt(11)
v_min3_u32 v27,v27,v240,v244
v_mfma_f32_16x16x32_bf16 v[68:71],a[192:195],v[240:243],v[68:71]
ds_read_b128 v[236:239],v18 offset:55296
v_readfirstlane_b32 s93,v45
v_mfma_f32_16x16x32_bf16 v[64:67],a[84:87],v[244:247],v[64:67]
ds_read_b128 v[156:159],v17 offset:14336
v_readfirstlane_b32 s83,v44
s_cmp_lg_u32 s83,0
s_cbranch_scc1 keep_316
v_mfma_f32_16x16x32_bf16 v[68:71],a[196:199],v[244:247],v[68:71]
s_xor_b32 m0,s72,0
s_waitcnt lgkmcnt(10)
v_mfma_f32_16x16x32_bf16 v[64:67],a[88:91],v[248:251],v[64:67]
ds_read_b128 v[160:163],v17 offset:16384
ds_read_b128 v[164:167],v17 offset:18432
s_add_u32 s65,s88,0
v_mfma_f32_16x16x32_bf16 v[68:71],a[200:203],v[248:251],v[68:71]
buffer_load_dwordx4 v16,s[20:23],s65 offen offset:0 sc1 lds
v_mfma_f32_16x16x32_bf16 v[64:67],a[92:95],v[252:255],v[64:67]
ds_read_b128 v[168:171],v17 offset:20480
v_min3_u32 v27,v27,v248,v252
v_mfma_f32_16x16x32_bf16 v[68:71],a[204:207],v[252:255],v[68:71]
buffer_load_dwordx4 v16,s[20:23],s65 offen offset:2048 sc1 lds
s_waitcnt lgkmcnt(9)
v_mfma_f32_16x16x32_bf16 v[64:67],a[96:99],v[224:227],v[64:67]
ds_read_b128 v[172:175],v17 offset:22528
s_xor_b32 m0,s72,16384
v_min3_u32 v27,v27,v224,v228
v_mfma_f32_16x16x32_bf16 v[68:71],a[208:211],v[224:227],v[68:71]
s_add_u32 s65,s88,32768
v_min3_u32 v27,v27,v226,v230
v_mfma_f32_16x16x32_bf16 v[64:67],a[100:103],v[228:231],v[64:67]
ds_read_b128 v[176:179],v17 offset:24576
ds_read_b128 v[180:183],v17 offset:26624
v_mfma_f32_16x16x32_bf16 v[68:71],a[212:215],v[228:231],v[68:71]
buffer_load_dwordx4 v16,s[20:23],s65 offen offset:0 sc1 lds
s_waitcnt lgkmcnt(7)
v_mfma_f32_16x16x32_bf16 v[64:67],a[104:107],v[232:235],v[64:67]
ds_read_b128 v[184:187],v17 offset:28672
v_min3_u32 v27,v27,v232,v236
v_min3_u32 v27,v27,v234,v238
v_mfma_f32_16x16x32_bf16 v[68:71],a[216:219],v[232:235],v[68:71]
buffer_load_dwordx4 v16,s[20:23],s65 offen offset:2048 sc1 lds
v_mfma_f32_16x16x32_bf16 v[64:67],a[108:111],v[236:239],v[64:67]
ds_read_b128 v[188:191],v17 offset:30720
s_xor_b32 m0,s72,32768
v_mfma_f32_16x16x32_bf16 v[68:71],a[220:223],v[236:239],v[68:71]
s_add_u32 s65,s88,65536
v_mfma_f32_16x16x32_bf16 v[72:75],a[112:115],v[128:131],0
buffer_load_dwordx4 v16,s[20:23],s65 offen offset:0 sc1 lds
v_mfma_f32_16x16x32_bf16 v[76:79],a[116:119],v[132:135],0
buffer_load_dwordx4 v16,s[20:23],s65 offen offset:2048 sc1 lds
v_mfma_f32_16x16x32_bf16 v[72:75],a[120:123],v[136:139],v[72:75]
ds_read_b128 v[192:195],v17 offset:32768
v_cmp_eq_u32 vcc,0,v27
s_cbranch_vccnz retry_307
v_mfma_f32_16x16x32_bf16 v[76:79],a[124:127],v[140:143],v[76:79]
ds_read_b128 v[196:199],v17 offset:34816
s_waitcnt lgkmcnt(10)
v_mfma_f32_16x16x32_bf16 v[72:75],a[128:131],v[144:147],v[72:75]
ds_read_b128 v[200:203],v17 offset:36864
s_xor_b32 m0,s72,49152
s_waitcnt vmcnt(6)
v_and_or_b32 v64,v64,-4,s48
v_mfma_f32_16x16x32_bf16 v[76:79],a[132:135],v[148:151],v[76:79]
ds_read_b128 v[204:207],v17 offset:38912
s_add_u32 s65,s88,s86
s_add_u32 s64,s49,s34
v_mfma_f32_16x16x32_bf16 v[72:75],a[136:139],v[152:155],v[72:75]
ds_read_b128 v[208:211],v17 offset:40960
v_min3_u32 v27,v27,v128,v132
buffer_store_dwordx4 v[64:67],v25,s[20:23],s64 offen offset:2048
v_mfma_f32_16x16x32_bf16 v[76:79],a[140:143],v[156:159],v[76:79]
v_min3_u32 v27,v27,v136,v140
v_and_or_b32 v68,v68,-4,s48
s_add_u32 s64,s49,s35
s_waitcnt lgkmcnt(9)
v_mfma_f32_16x16x32_bf16 v[72:75],a[144:147],v[160:163],v[72:75]
ds_read_b128 v[212:215],v17 offset:43008
v_min3_u32 v27,v27,v144,v148
buffer_store_dwordx4 v[68:71],v25,s[20:23],s64 offen offset:3072
v_mfma_f32_16x16x32_bf16 v[76:79],a[148:151],v[164:167],v[76:79]
ds_read_b128 v[216:219],v17 offset:45056
v_min3_u32 v27,v27,v152,v156
s_mov_b32 s49,0x7fff0000
v_mfma_f32_16x16x32_bf16 v[72:75],a[152:155],v[168:171],v[72:75]
ds_read_b128 v[220:223],v17 offset:47104
v_min3_u32 v27,v27,v160,v164
v_mfma_f32_16x16x32_bf16 v[76:79],a[156:159],v[172:175],v[76:79]
ds_read_b128 v[224:227],v17 offset:49152
s_waitcnt lgkmcnt(9)
v_mfma_f32_16x16x32_bf16 v[72:75],a[160:163],v[176:179],v[72:75]
ds_read_b128 v[228:231],v17 offset:51200
v_min3_u32 v27,v27,v168,v172
v_mfma_f32_16x16x32_bf16 v[76:79],a[164:167],v[180:183],v[76:79]
buffer_load_dwordx4 v16,s[20:23],s65 offen offset:0 sc1 lds
v_mfma_f32_16x16x32_bf16 v[72:75],a[168:171],v[184:187],v[72:75]
ds_read_b128 v[232:235],v17 offset:53248
v_min3_u32 v27,v27,v176,v180
v_mfma_f32_16x16x32_bf16 v[76:79],a[172:175],v[188:191],v[76:79]
ds_read_b128 v[236:239],v17 offset:55296
s_waitcnt lgkmcnt(8)
v_mfma_f32_16x16x32_bf16 v[72:75],a[176:179],v[192:195],v[72:75]
buffer_load_dwordx4 v16,s[20:23],s65 offen offset:2048 sc1 lds
v_mfma_f32_16x16x32_bf16 v[76:79],a[180:183],v[196:199],v[76:79]
s_xor_b32 m0,s72,1024
s_add_u32 s65,s89,0
v_mfma_f32_16x16x32_bf16 v[72:75],a[184:187],v[200:203],v[72:75]
buffer_load_dwordx4 v16,s[20:23],s65 offen offset:0 sc1 lds
v_mfma_f32_16x16x32_bf16 v[76:79],a[188:191],v[204:207],v[76:79]
v_min3_u32 v27,v27,v184,v188
v_min3_u32 v27,v27,v200,v204
s_waitcnt lgkmcnt(4)
v_mfma_f32_16x16x32_bf16 v[72:75],a[192:195],v[208:211],v[72:75]
buffer_load_dwordx4 v16,s[20:23],s65 offen offset:2048 sc1 lds
v_mfma_f32_16x16x32_bf16 v[76:79],a[196:199],v[212:215],v[76:79]
s_xor_b32 m0,s72,17408
s_add_u32 s65,s89,32768
v_min3_u32 v27,v27,v208,v212
v_mfma_f32_16x16x32_bf16 v[72:75],a[200:203],v[216:219],v[72:75]
buffer_load_dwordx4 v16,s[20:23],s65 offen offset:0 sc1 lds
v_mfma_f32_16x16x32_bf16 v[76:79],a[204:207],v[220:223],v[76:79]
v_min3_u32 v27,v27,v192,v196
v_min3_u32 v27,v27,v216,v220
s_waitcnt lgkmcnt(0)
v_mfma_f32_16x16x32_bf16 v[72:75],a[208:211],v[224:227],v[72:75]
buffer_load_dwordx4 v16,s[20:23],s65 offen offset:2048 sc1 lds
v_mfma_f32_16x16x32_bf16 v[76:79],a[212:215],v[228:231],v[76:79]
s_xor_b32 m0,s72,33792
s_add_u32 s65,s89,65536
v_min3_u32 v27,v27,v224,v228
v_mfma_f32_16x16x32_bf16 v[72:75],a[216:219],v[232:235],v[72:75]
buffer_load_dwordx4 v16,s[20:23],s65 offen offset:0 sc1 lds
v_min3_u32 v27,v27,v226,v230
v_mfma_f32_16x16x32_bf16 v[76:79],a[220:223],v[236:239],v[76:79]
buffer_load_dwordx4 v16,s[20:23],s65 offen offset:2048 sc1 lds
v_min3_u32 v27,v27,v232,v236
v_min3_u32 v27,v27,v234,v238
v_mfma_f32_16x16x32_bf16 v[80:83],a[0:3],v[128:131],0
s_xor_b32 m0,s72,50176
s_add_u32 s65,s89,s86
v_cmp_eq_u32 vcc,0,v27
s_cbranch_vccnz retry_307
v_mfma_f32_16x16x32_bf16 v[84:87],a[4:7],v[132:135],0
buffer_load_dwordx4 v16,s[20:23],s65 offen offset:0 sc1 lds
v_mfma_f32_16x16x32_bf16 v[80:83],a[8:11],v[136:139],v[80:83]
buffer_load_dwordx4 v16,s[20:23],s65 offen offset:2048 sc1 lds
v_mfma_f32_16x16x32_bf16 v[84:87],a[12:15],v[140:143],v[84:87]
ds_bpermute_b32 v124,v41,v120
ds_bpermute_b32 v125,v41,v121
v_mfma_f32_16x16x32_bf16 v[80:83],a[16:19],v[144:147],v[80:83]
v_lshlrev_b32 v108,16,v122
v_and_b32 v109,s80,v122
v_add_f32 v72,v72,v76
v_mfma_f32_16x16x32_bf16 v[84:87],a[20:23],v[148:151],v[84:87]
v_lshlrev_b32 v110,16,v123
v_and_b32 v111,s80,v123
v_add_f32 v73,v73,v77
v_mfma_f32_16x16x32_bf16 v[80:83],a[24:27],v[152:155],v[80:83]
s_waitcnt lgkmcnt(0)
v_lshlrev_b32 v104,16,v124
v_add_f32 v74,v74,v78
v_mfma_f32_16x16x32_bf16 v[84:87],a[28:31],v[156:159],v[84:87]
v_and_b32 v105,s80,v124
v_lshlrev_b32 v106,16,v125
v_mfma_f32_16x16x32_bf16 v[80:83],a[32:35],v[160:163],v[80:83]
v_add_f32 v75,v75,v79
v_and_or_b32 v72,v72,-4,s48
v_mfma_f32_16x16x32_bf16 v[84:87],a[36:39],v[164:167],v[84:87]
v_and_b32 v107,s80,v125
s_add_u32 s64,s77,s33
v_mfma_f32_16x16x32_bf16 v[80:83],a[40:43],v[168:171],v[80:83]
buffer_store_dwordx4 v[72:75],v25,s[20:23],s64 offen offset:1024
v_mfma_f32_16x16x32_bf16 v[84:87],a[44:47],v[172:175],v[84:87]
v_mfma_f32_16x16x32_bf16 v[80:83],a[48:51],v[176:179],v[80:83]
buffer_load_dwordx4 v[96:99],v26,s[20:23],s77 offen offset:2048 sc1
v_mfma_f32_16x16x32_bf16 v[84:87],a[52:55],v[180:183],v[84:87]
buffer_load_dwordx4 v[100:103],v26,s[20:23],s77 offen offset:3072 sc1
v_mfma_f32_16x16x32_bf16 v[80:83],a[56:59],v[184:187],v[80:83]
v_mfma_f32_16x16x32_bf16 v[84:87],a[60:63],v[188:191],v[84:87]
v_mfma_f32_16x16x32_bf16 v[80:83],a[64:67],v[192:195],v[80:83]
v_mfma_f32_16x16x32_bf16 v[84:87],a[68:71],v[196:199],v[84:87]
v_mfma_f32_16x16x32_bf16 v[80:83],a[72:75],v[200:203],v[80:83]
v_mfma_f32_16x16x32_bf16 v[84:87],a[76:79],v[204:207],v[84:87]
v_mfma_f32_16x16x32_bf16 v[80:83],a[80:83],v[208:211],v[80:83]
v_mfma_f32_16x16x32_bf16 v[84:87],a[84:87],v[212:215],v[84:87]
v_mfma_f32_16x16x32_bf16 v[80:83],a[88:91],v[216:219],v[80:83]
buffer_load_dwordx4 v[92:95],v26,s[20:23],s77 offen offset:1024 sc1
v_mfma_f32_16x16x32_bf16 v[84:87],a[92:95],v[220:223],v[84:87]
v_mfma_f32_16x16x32_bf16 v[80:83],a[96:99],v[224:227],v[80:83]
v_mfma_f32_16x16x32_bf16 v[84:87],a[100:103],v[228:231],v[84:87]
v_mfma_f32_16x16x32_bf16 v[80:83],a[104:107],v[232:235],v[80:83]
v_mfma_f32_16x16x32_bf16 v[84:87],a[108:111],v[236:239],v[84:87]
s_branch epi_310
keep_316:
v_mfma_f32_16x16x32_bf16 v[68:71],a[196:199],v[244:247],v[68:71]
s_waitcnt lgkmcnt(10)
v_mfma_f32_16x16x32_bf16 v[64:67],a[88:91],v[248:251],v[64:67]
ds_read_b128 v[160:163],v17 offset:16384
ds_read_b128 v[164:167],v17 offset:18432
v_mfma_f32_16x16x32_bf16 v[68:71],a[200:203],v[248:251],v[68:71]
v_min3_u32 v27,v27,v248,v252
v_mfma_f32_16x16x32_bf16 v[64:67],a[92:95],v[252:255],v[64:67]
ds_read_b128 v[168:171],v17 offset:20480
v_mfma_f32_16x16x32_bf16 v[68:71],a[204:207],v[252:255],v[68:71]
s_waitcnt lgkmcnt(9)
v_mfma_f32_16x16x32_bf16 v[64:67],a[96:99],v[224:227],v[64:67]
ds_read_b128 v[172:175],v17 offset:22528
v_min3_u32 v27,v27,v224,v228
v_mfma_f32_16x16x32_bf16 v[68:71],a[208:211],v[224:227],v[68:71]
v_min3_u32 v27,v27,v226,v230
v_mfma_f32_16x16x32_bf16 v[64:67],a[100:103],v[228:231],v[64:67]
ds_read_b128 v[176:179],v17 offset:24576
ds_read_b128 v[180:183],v17 offset:26624
v_mfma_f32_16x16x32_bf16 v[68:71],a[212:215],v[228:231],v[68:71]
s_waitcnt lgkmcnt(7)
v_mfma_f32_16x16x32_bf16 v[64:67],a[104:107],v[232:235],v[64:67]
ds_read_b128 v[184:187],v17 offset:28672
v_min3_u32 v27,v27,v232,v236
v_mfma_f32_16x16x32_bf16 v[68:71],a[216:219],v[232:235],v[68:71]
v_min3_u32 v27,v27,v234,v238
v_mfma_f32_16x16x32_bf16 v[64:67],a[108:111],v[236:239],v[64:67]
ds_read_b128 v[188:191],v17 offset:30720
v_mfma_f32_16x16x32_bf16 v[68:71],a[220:223],v[236:239],v[68:71]
v_mfma_f32_16x16x32_bf16 v[72:75],a[112:115],v[128:131],0
v_cmp_eq_u32 vcc,0,v27
s_cbranch_vccnz retry_307
v_mfma_f32_16x16x32_bf16 v[76:79],a[116:119],v[132:135],0
v_min3_u32 v27,v27,v128,v132
v_mfma_f32_16x16x32_bf16 v[72:75],a[120:123],v[136:139],v[72:75]
ds_read_b128 v[192:195],v17 offset:32768
v_mfma_f32_16x16x32_bf16 v[76:79],a[124:127],v[140:143],v[76:79]
ds_read_b128 v[196:199],v17 offset:34816
s_waitcnt lgkmcnt(10)
v_mfma_f32_16x16x32_bf16 v[72:75],a[128:131],v[144:147],v[72:75]
ds_read_b128 v[200:203],v17 offset:36864
v_min3_u32 v27,v27,v136,v140
s_waitcnt vmcnt(0)
v_mfma_f32_16x16x32_bf16 v[76:79],a[132:135],v[148:151],v[76:79]
ds_read_b128 v[204:207],v17 offset:38912
v_min3_u32 v27,v27,v144,v148
v_and_or_b32 v64,v64,-4,s48
v_mfma_f32_16x16x32_bf16 v[72:75],a[136:139],v[152:155],v[72:75]
ds_read_b128 v[208:211],v17 offset:40960
s_add_u32 s64,s49,s34
v_mfma_f32_16x16x32_bf16 v[76:79],a[140:143],v[156:159],v[76:79]
v_min3_u32 v27,v27,v152,v156
s_waitcnt lgkmcnt(9)
v_mfma_f32_16x16x32_bf16 v[72:75],a[144:147],v[160:163],v[72:75]
ds_read_b128 v[212:215],v17 offset:43008
buffer_store_dwordx4 v[64:67],v25,s[20:23],s64 offen offset:2048
v_mfma_f32_16x16x32_bf16 v[76:79],a[148:151],v[164:167],v[76:79]
ds_read_b128 v[216:219],v17 offset:45056
v_min3_u32 v27,v27,v160,v164
v_and_or_b32 v68,v68,-4,s48
v_mfma_f32_16x16x32_bf16 v[72:75],a[152:155],v[168:171],v[72:75]
ds_read_b128 v[220:223],v17 offset:47104
s_add_u32 s64,s49,s35
v_mfma_f32_16x16x32_bf16 v[76:79],a[156:159],v[172:175],v[76:79]
ds_read_b128 v[224:227],v17 offset:49152
s_waitcnt lgkmcnt(9)
v_mfma_f32_16x16x32_bf16 v[72:75],a[160:163],v[176:179],v[72:75]
ds_read_b128 v[228:231],v17 offset:51200
v_min3_u32 v27,v27,v168,v172
v_mfma_f32_16x16x32_bf16 v[76:79],a[164:167],v[180:183],v[76:79]
v_min3_u32 v27,v27,v176,v180
buffer_store_dwordx4 v[68:71],v25,s[20:23],s64 offen offset:3072
v_mfma_f32_16x16x32_bf16 v[72:75],a[168:171],v[184:187],v[72:75]
ds_read_b128 v[232:235],v17 offset:53248
s_mov_b32 s49,0x7fff0000
v_mfma_f32_16x16x32_bf16 v[76:79],a[172:175],v[188:191],v[76:79]
ds_read_b128 v[236:239],v17 offset:55296
s_waitcnt lgkmcnt(8)
v_mfma_f32_16x16x32_bf16 v[72:75],a[176:179],v[192:195],v[72:75]
v_min3_u32 v27,v27,v184,v188
v_mfma_f32_16x16x32_bf16 v[76:79],a[180:183],v[196:199],v[76:79]
v_min3_u32 v27,v27,v192,v196
ds_bpermute_b32 v124,v41,v120
v_mfma_f32_16x16x32_bf16 v[72:75],a[184:187],v[200:203],v[72:75]
v_mfma_f32_16x16x32_bf16 v[76:79],a[188:191],v[204:207],v[76:79]
v_min3_u32 v27,v27,v200,v204
s_waitcnt lgkmcnt(5)
v_mfma_f32_16x16x32_bf16 v[72:75],a[192:195],v[208:211],v[72:75]
ds_bpermute_b32 v125,v41,v121
v_mfma_f32_16x16x32_bf16 v[76:79],a[196:199],v[212:215],v[76:79]
v_min3_u32 v27,v27,v208,v212
v_lshlrev_b32 v108,16,v122
v_mfma_f32_16x16x32_bf16 v[72:75],a[200:203],v[216:219],v[72:75]
v_mfma_f32_16x16x32_bf16 v[76:79],a[204:207],v[220:223],v[76:79]
v_min3_u32 v27,v27,v216,v220
s_waitcnt lgkmcnt(2)
v_mfma_f32_16x16x32_bf16 v[72:75],a[208:211],v[224:227],v[72:75]
v_and_b32 v109,s80,v122
v_mfma_f32_16x16x32_bf16 v[76:79],a[212:215],v[228:231],v[76:79]
v_min3_u32 v27,v27,v224,v228
v_min3_u32 v27,v27,v226,v230
v_mfma_f32_16x16x32_bf16 v[72:75],a[216:219],v[232:235],v[72:75]
v_lshlrev_b32 v110,16,v123
v_mfma_f32_16x16x32_bf16 v[76:79],a[220:223],v[236:239],v[76:79]
v_min3_u32 v27,v27,v232,v236
v_min3_u32 v27,v27,v234,v238
v_mfma_f32_16x16x32_bf16 v[80:83],a[0:3],v[128:131],0
v_cmp_eq_u32 vcc,0,v27
s_cbranch_vccnz retry_307
v_mfma_f32_16x16x32_bf16 v[84:87],a[4:7],v[132:135],0
v_and_b32 v111,s80,v123
s_waitcnt lgkmcnt(0)
v_mfma_f32_16x16x32_bf16 v[80:83],a[8:11],v[136:139],v[80:83]
v_mfma_f32_16x16x32_bf16 v[84:87],a[12:15],v[140:143],v[84:87]
v_lshlrev_b32 v104,16,v124
v_mfma_f32_16x16x32_bf16 v[80:83],a[16:19],v[144:147],v[80:83]
v_add_f32 v72,v72,v76
v_add_f32 v73,v73,v77
v_mfma_f32_16x16x32_bf16 v[84:87],a[20:23],v[148:151],v[84:87]
v_and_b32 v105,s80,v124
v_add_f32 v74,v74,v78
v_mfma_f32_16x16x32_bf16 v[80:83],a[24:27],v[152:155],v[80:83]
v_add_f32 v75,v75,v79
v_and_or_b32 v72,v72,-4,s48
v_mfma_f32_16x16x32_bf16 v[84:87],a[28:31],v[156:159],v[84:87]
v_lshlrev_b32 v106,16,v125
s_add_u32 s64,s77,s33
v_mfma_f32_16x16x32_bf16 v[80:83],a[32:35],v[160:163],v[80:83]
buffer_store_dwordx4 v[72:75],v25,s[20:23],s64 offen offset:1024
v_mfma_f32_16x16x32_bf16 v[84:87],a[36:39],v[164:167],v[84:87]
v_and_b32 v107,s80,v125
v_mfma_f32_16x16x32_bf16 v[80:83],a[40:43],v[168:171],v[80:83]
v_mfma_f32_16x16x32_bf16 v[84:87],a[44:47],v[172:175],v[84:87]
v_mfma_f32_16x16x32_bf16 v[80:83],a[48:51],v[176:179],v[80:83]
buffer_load_dwordx4 v[96:99],v26,s[20:23],s77 offen offset:2048 sc1
v_mfma_f32_16x16x32_bf16 v[84:87],a[52:55],v[180:183],v[84:87]
buffer_load_dwordx4 v[100:103],v26,s[20:23],s77 offen offset:3072 sc1
v_mfma_f32_16x16x32_bf16 v[80:83],a[56:59],v[184:187],v[80:83]
v_mfma_f32_16x16x32_bf16 v[84:87],a[60:63],v[188:191],v[84:87]
v_mfma_f32_16x16x32_bf16 v[80:83],a[64:67],v[192:195],v[80:83]
v_mfma_f32_16x16x32_bf16 v[84:87],a[68:71],v[196:199],v[84:87]
v_mfma_f32_16x16x32_bf16 v[80:83],a[72:75],v[200:203],v[80:83]
v_mfma_f32_16x16x32_bf16 v[84:87],a[76:79],v[204:207],v[84:87]
v_mfma_f32_16x16x32_bf16 v[80:83],a[80:83],v[208:211],v[80:83]
v_mfma_f32_16x16x32_bf16 v[84:87],a[84:87],v[212:215],v[84:87]
v_mfma_f32_16x16x32_bf16 v[80:83],a[88:91],v[216:219],v[80:83]
buffer_load_dwordx4 v[92:95],v26,s[20:23],s77 offen offset:1024 sc1
v_mfma_f32_16x16x32_bf16 v[84:87],a[92:95],v[220:223],v[84:87]
v_mfma_f32_16x16x32_bf16 v[80:83],a[96:99],v[224:227],v[80:83]
v_mfma_f32_16x16x32_bf16 v[84:87],a[100:103],v[228:231],v[84:87]
v_mfma_f32_16x16x32_bf16 v[80:83],a[104:107],v[232:235],v[80:83]
v_mfma_f32_16x16x32_bf16 v[84:87],a[108:111],v[236:239],v[84:87]
s_branch epi_310
both_311:
s_waitcnt vmcnt(14) lgkmcnt(0)
s_barrier
ds_read_b128 v[224:227],v18 offset:0
ds_read_b128 v[228:231],v18 offset:2048
ds_read_b128 v[232:235],v18 offset:4096
ds_read_b128 v[236:239],v18 offset:6144
ds_read_b128 v[240:243],v18 offset:8192
ds_read_b128 v[244:247],v18 offset:10240
ds_read_b128 v[248:251],v18 offset:12288
s_waitcnt lgkmcnt(5)
v_mfma_f32_16x16x32_bf16 v[64:67],a[0:3],v[224:227],0
s_add_u32 s96,s71,1
s_add_u32 s92,s71,2
v_min_u32 v27,v224,v228
v_mfma_f32_16x16x32_bf16 v[68:71],a[112:115],v[224:227],0
ds_read_b128 v[252:255],v18 offset:14336
s_add_u32 s88,s70,s75
v_mfma_f32_16x16x32_bf16 v[64:67],a[4:7],v[228:231],v[64:67]
s_add_u32 s88,s88,2097152
s_xor_b32 s88,s88,0x2000
v_mfma_f32_16x16x32_bf16 v[68:71],a[116:119],v[228:231],v[68:71]
ds_read_b128 v[224:227],v18 offset:16384
s_waitcnt lgkmcnt(5)
v_mfma_f32_16x16x32_bf16 v[64:67],a[8:11],v[232:235],v[64:67]
s_xor_b32 s89,s88,1024
v_min3_u32 v27,v27,v232,v236
v_mfma_f32_16x16x32_bf16 v[68:71],a[120:123],v[232:235],v[68:71]
ds_read_b128 v[228:231],v18 offset:18432
buffer_load_dwordx2 v[120:121],v20,s[20:23],s76 offen sc1
v_mfma_f32_16x16x32_bf16 v[64:67],a[12:15],v[236:239],v[64:67]
s_xor_b32 m0,s72,0
v_mfma_f32_16x16x32_bf16 v[68:71],a[124:127],v[236:239],v[68:71]
ds_read_b128 v[232:235],v18 offset:20480
s_add_u32 s65,s88,0
s_waitcnt lgkmcnt(5)
v_mfma_f32_16x16x32_bf16 v[64:67],a[16:19],v[240:243],v[64:67]
v_min3_u32 v27,v27,v240,v244
v_mfma_f32_16x16x32_bf16 v[68:71],a[128:131],v[240:243],v[68:71]
ds_read_b128 v[236:239],v18 offset:22528
buffer_load_dwordx4 v16,s[20:23],s65 offen offset:0 sc1 lds
v_mfma_f32_16x16x32_bf16 v[64:67],a[20:23],v[244:247],v[64:67]
s_waitcnt vmcnt(3)
v_mfma_f32_16x16x32_bf16 v[68:71],a[132:135],v[244:247],v[68:71]
ds_read_b128 v[240:243],v18 offset:24576
s_waitcnt lgkmcnt(5)
v_mfma_f32_16x16x32_bf16 v[64:67],a[24:27],v[248:251],v[64:67]
v_cmp_gt_u32 vcc,s96,v29
v_cmp_gt_u32 s[92:93],s92,v29
v_min3_u32 v27,v27,v248,v252
v_mfma_f32_16x16x32_bf16 v[68:71],a[136:139],v[248:251],v[68:71]
ds_read_b128 v[244:247],v18 offset:26624
buffer_load_dwordx4 v16,s[20:23],s65 offen offset:2048 sc1 lds
v_mfma_f32_16x16x32_bf16 v[64:67],a[28:31],v[252:255],v[64:67]
v_mov_b32 v44,vcc_lo
v_mov_b32 v45,s92
s_xor_b32 m0,s72,16384
v_mfma_f32_16x16x32_bf16 v[68:71],a[140:143],v[252:255],v[68:71]
ds_read_b128 v[248:251],v18 offset:28672
s_add_u32 s65,s88,32768
s_waitcnt lgkmcnt(5)
v_mfma_f32_16x16x32_bf16 v[64:67],a[32:35],v[224:227],v[64:67]
ds_write_b64 v46,v[44:45]
v_min3_u32 v27,v27,v224,v228
v_mfma_f32_16x16x32_bf16 v[68:71],a[144:147],v[224:227],v[68:71]
ds_read_b128 v[252:255],v18 offset:30720
buffer_load_dwordx4 v16,s[20:23],s65 offen offset:0 sc1 lds
v_mfma_f32_16x16x32_bf16 v[64:67],a[36:39],v[228:231],v[64:67]
buffer_load_dwordx4 v16,s[20:23],s65 offen offset:2048 sc1 lds
v_mfma_f32_16x16x32_bf16 v[68:71],a[148:151],v[228:231],v[68:71]
ds_read_b128 v[224:227],v18 offset:32768
s_waitcnt lgkmcnt(6)
v_mfma_f32_16x16x32_bf16 v[64:67],a[40:43],v[232:235],v[64:67]
s_xor_b32 m0,s72,32768
v_min3_u32 v27,v27,v232,v236
v_mfma_f32_16x16x32_bf16 v[68:71],a[152:155],v[232:235],v[68:71]
ds_read_b128 v[228:231],v18 offset:34816
v_mfma_f32_16x16x32_bf16 v[64:67],a[44:47],v[236:239],v[64:67]
s_add_u32 s65,s88,65536
v_mfma_f32_16x16x32_bf16 v[68:71],a[156:159],v[236:239],v[68:71]
ds_read_b128 v[232:235],v18 offset:36864
s_waitcnt lgkmcnt(6)
v_mfma_f32_16x16x32_bf16 v[64:67],a[48:51],v[240:243],v[64:67]
buffer_load_dwordx4 v16,s[20:23],s65 offen offset:0 sc1 lds
v_mfma_f32_16x16x32_bf16 v[68:71],a[160:163],v[240:243],v[68:71]
ds_read_b128 v[236:239],v18 offset:38912
v_min3_u32 v27,v27,v240,v244
v_mfma_f32_16x16x32_bf16 v[64:67],a[52:55],v[244:247],v[64:67]
buffer_load_dwordx4 v16,s[20:23],s65 offen offset:2048 sc1 lds
v_mfma_f32_16x16x32_bf16 v[68:71],a[164:167],v[244:247],v[68:71]
ds_read_b128 v[240:243],v18 offset:40960
s_waitcnt lgkmcnt(5)
v_mfma_f32_16x16x32_bf16 v[64:67],a[56:59],v[248:251],v[64:67]
s_xor_b32 m0,s72,49152
v_min3_u32 v27,v27,v248,v252
v_mfma_f32_16x16x32_bf16 v[68:71],a[168:171],v[248:251],v[68:71]
ds_read_b128 v[244:247],v18 offset:43008
s_add_u32 s65,s88,s86
v_mfma_f32_16x16x32_bf16 v[64:67],a[60:63],v[252:255],v[64:67]
buffer_load_dwordx2 v[122:123],v24,s[20:23],s70 offen sc1
v_mfma_f32_16x16x32_bf16 v[68:71],a[172:175],v[252:255],v[68:71]
ds_read_b128 v[248:251],v18 offset:45056
s_waitcnt lgkmcnt(5)
v_mfma_f32_16x16x32_bf16 v[64:67],a[64:67],v[224:227],v[64:67]
s_waitcnt vmcnt(14)
s_barrier
ds_read_b64 v[44:45],v47
ds_read_b128 v[128:131],v17 offset:0
ds_read_b128 v[132:135],v17 offset:2048
v_mfma_f32_16x16x32_bf16 v[68:71],a[176:179],v[224:227],v[68:71]
ds_read_b128 v[252:255],v18 offset:47104
buffer_load_dwordx4 v16,s[20:23],s65 offen offset:0 sc1 lds
v_min3_u32 v27,v27,v224,v228
v_mfma_f32_16x16x32_bf16 v[64:67],a[68:71],v[228:231],v[64:67]
ds_read_b128 v[136:139],v17 offset:4096
buffer_load_dwordx4 v16,s[20:23],s65 offen offset:2048 sc1 lds
v_mfma_f32_16x16x32_bf16 v[68:71],a[180:183],v[228:231],v[68:71]
ds_read_b128 v[224:227],v18 offset:49152
s_xor_b32 m0,s72,1024
s_waitcnt lgkmcnt(9)
v_mfma_f32_16x16x32_bf16 v[64:67],a[72:75],v[232:235],v[64:67]
ds_read_b128 v[140:143],v17 offset:6144
v_min3_u32 v27,v27,v232,v236
v_mfma_f32_16x16x32_bf16 v[68:71],a[184:187],v[232:235],v[68:71]
ds_read_b128 v[228:231],v18 offset:51200
s_add_u32 s65,s89,0
v_mfma_f32_16x16x32_bf16 v[64:67],a[76:79],v[236:239],v[64:67]
ds_read_b128 v[144:147],v17 offset:8192
ds_read_b128 v[148:151],v17 offset:10240
v_mfma_f32_16x16x32_bf16 v[68:71],a[188:191],v[236:239],v[68:71]
ds_read_b128 v[232:235],v18 offset:53248
s_waitcnt lgkmcnt(12)
v_mfma_f32_16x16x32_bf16 v[64:67],a[80:83],v[240:243],v[64:67]
ds_read_b128 v[152:155],v17 offset:12288
s_waitcnt lgkmcnt(11)
v_min3_u32 v27,v27,v240,v244
v_mfma_f32_16x16x32_bf16 v[68:71],a[192:195],v[240:243],v[68:71]
ds_read_b128 v[236:239],v18 offset:55296
v_readfirstlane_b32 s93,v45
v_mfma_f32_16x16x32_bf16 v[64:67],a[84:87],v[244:247],v[64:67]
ds_read_b128 v[156:159],v17 offset:14336
buffer_load_dwordx4 v16,s[20:23],s65 offen offset:0 sc1 lds
v_mfma_f32_16x16x32_bf16 v[68:71],a[196:199],v[244:247],v[68:71]
buffer_load_dwordx4 v16,s[20:23],s65 offen offset:2048 sc1 lds
s_waitcnt lgkmcnt(10)
v_mfma_f32_16x16x32_bf16 v[64:67],a[88:91],v[248:251],v[64:67]
ds_read_b128 v[160:163],v17 offset:16384
ds_read_b128 v[164:167],v17 offset:18432
s_xor_b32 m0,s72,17408
v_mfma_f32_16x16x32_bf16 v[68:71],a[200:203],v[248:251],v[68:71]
s_add_u32 s65,s89,32768
v_min3_u32 v27,v27,v248,v252
v_mfma_f32_16x16x32_bf16 v[64:67],a[92:95],v[252:255],v[64:67]
ds_read_b128 v[168:171],v17 offset:20480
buffer_load_dwordx4 v16,s[20:23],s65 offen offset:0 sc1 lds
v_mfma_f32_16x16x32_bf16 v[68:71],a[204:207],v[252:255],v[68:71]
s_waitcnt lgkmcnt(9)
v_mfma_f32_16x16x32_bf16 v[64:67],a[96:99],v[224:227],v[64:67]
ds_read_b128 v[172:175],v17 offset:22528
buffer_load_dwordx4 v16,s[20:23],s65 offen offset:2048 sc1 lds
v_mfma_f32_16x16x32_bf16 v[68:71],a[208:211],v[224:227],v[68:71]
v_min3_u32 v27,v27,v224,v228
v_min3_u32 v27,v27,v226,v230
v_mfma_f32_16x16x32_bf16 v[64:67],a[100:103],v[228:231],v[64:67]
ds_read_b128 v[176:179],v17 offset:24576
ds_read_b128 v[180:183],v17 offset:26624
s_xor_b32 m0,s72,33792
v_mfma_f32_16x16x32_bf16 v[68:71],a[212:215],v[228:231],v[68:71]
s_waitcnt lgkmcnt(7)
v_mfma_f32_16x16x32_bf16 v[64:67],a[104:107],v[232:235],v[64:67]
ds_read_b128 v[184:187],v17 offset:28672
s_add_u32 s65,s89,65536
v_min3_u32 v27,v27,v232,v236
v_mfma_f32_16x16x32_bf16 v[68:71],a[216:219],v[232:235],v[68:71]
buffer_load_dwordx4 v16,s[20:23],s65 offen offset:0 sc1 lds
v_mfma_f32_16x16x32_bf16 v[64:67],a[108:111],v[236:239],v[64:67]
ds_read_b128 v[188:191],v17 offset:30720
v_min3_u32 v27,v27,v234,v238
v_mfma_f32_16x16x32_bf16 v[68:71],a[220:223],v[236:239],v[68:71]
buffer_load_dwordx4 v16,s[20:23],s65 offen offset:2048 sc1 lds
v_mfma_f32_16x16x32_bf16 v[72:75],a[112:115],v[128:131],0
v_cmp_eq_u32 vcc,0,v27
s_cbranch_vccnz retry_307
v_mfma_f32_16x16x32_bf16 v[76:79],a[116:119],v[132:135],0
s_xor_b32 m0,s72,50176
v_min3_u32 v27,v27,v128,v132
v_mfma_f32_16x16x32_bf16 v[72:75],a[120:123],v[136:139],v[72:75]
ds_read_b128 v[192:195],v17 offset:32768
v_mfma_f32_16x16x32_bf16 v[76:79],a[124:127],v[140:143],v[76:79]
ds_read_b128 v[196:199],v17 offset:34816
s_add_u32 s65,s89,s86
s_waitcnt lgkmcnt(10)
v_mfma_f32_16x16x32_bf16 v[72:75],a[128:131],v[144:147],v[72:75]
ds_read_b128 v[200:203],v17 offset:36864
v_min3_u32 v27,v27,v136,v140
s_waitcnt vmcnt(8)
v_mfma_f32_16x16x32_bf16 v[76:79],a[132:135],v[148:151],v[76:79]
ds_read_b128 v[204:207],v17 offset:38912
buffer_load_dwordx4 v16,s[20:23],s65 offen offset:0 sc1 lds
v_mfma_f32_16x16x32_bf16 v[72:75],a[136:139],v[152:155],v[72:75]
ds_read_b128 v[208:211],v17 offset:40960
v_min3_u32 v27,v27,v144,v148
v_and_or_b32 v64,v64,-4,s48
v_mfma_f32_16x16x32_bf16 v[76:79],a[140:143],v[156:159],v[76:79]
buffer_load_dwordx4 v16,s[20:23],s65 offen offset:2048 sc1 lds
s_waitcnt lgkmcnt(9)
v_mfma_f32_16x16x32_bf16 v[72:75],a[144:147],v[160:163],v[72:75]
ds_read_b128 v[212:215],v17 offset:43008
v_min3_u32 v27,v27,v152,v156
s_add_u32 s64,s49,s34
v_mfma_f32_16x16x32_bf16 v[76:79],a[148:151],v[164:167],v[76:79]
ds_read_b128 v[216:219],v17 offset:45056
v_min3_u32 v27,v27,v160,v164
v_mfma_f32_16x16x32_bf16 v[72:75],a[152:155],v[168:171],v[72:75]
ds_read_b128 v[220:223],v17 offset:47104
buffer_store_dwordx4 v[64:67],v25,s[20:23],s64 offen offset:2048
v_mfma_f32_16x16x32_bf16 v[76:79],a[156:159],v[172:175],v[76:79]
ds_read_b128 v[224:227],v17 offset:49152
v_and_or_b32 v68,v68,-4,s48
s_waitcnt lgkmcnt(9)
v_mfma_f32_16x16x32_bf16 v[72:75],a[160:163],v[176:179],v[72:75]
ds_read_b128 v[228:231],v17 offset:51200
v_min3_u32 v27,v27,v168,v172
s_add_u32 s64,s49,s35
v_mfma_f32_16x16x32_bf16 v[76:79],a[164:167],v[180:183],v[76:79]
v_min3_u32 v27,v27,v176,v180
buffer_store_dwordx4 v[68:71],v25,s[20:23],s64 offen offset:3072
v_mfma_f32_16x16x32_bf16 v[72:75],a[168:171],v[184:187],v[72:75]
ds_read_b128 v[232:235],v17 offset:53248
s_mov_b32 s49,0x7fff0000
v_mfma_f32_16x16x32_bf16 v[76:79],a[172:175],v[188:191],v[76:79]
ds_read_b128 v[236:239],v17 offset:55296
s_waitcnt lgkmcnt(8)
v_mfma_f32_16x16x32_bf16 v[72:75],a[176:179],v[192:195],v[72:75]
v_min3_u32 v27,v27,v184,v188
v_mfma_f32_16x16x32_bf16 v[76:79],a[180:183],v[196:199],v[76:79]
v_min3_u32 v27,v27,v192,v196
ds_bpermute_b32 v124,v41,v120
v_mfma_f32_16x16x32_bf16 v[72:75],a[184:187],v[200:203],v[72:75]
v_mfma_f32_16x16x32_bf16 v[76:79],a[188:191],v[204:207],v[76:79]
v_min3_u32 v27,v27,v200,v204
s_waitcnt lgkmcnt(5)
v_mfma_f32_16x16x32_bf16 v[72:75],a[192:195],v[208:211],v[72:75]
ds_bpermute_b32 v125,v41,v121
v_mfma_f32_16x16x32_bf16 v[76:79],a[196:199],v[212:215],v[76:79]
v_min3_u32 v27,v27,v208,v212
v_lshlrev_b32 v108,16,v122
v_mfma_f32_16x16x32_bf16 v[72:75],a[200:203],v[216:219],v[72:75]
v_mfma_f32_16x16x32_bf16 v[76:79],a[204:207],v[220:223],v[76:79]
v_min3_u32 v27,v27,v216,v220
s_waitcnt lgkmcnt(2)
v_mfma_f32_16x16x32_bf16 v[72:75],a[208:211],v[224:227],v[72:75]
v_and_b32 v109,s80,v122
v_mfma_f32_16x16x32_bf16 v[76:79],a[212:215],v[228:231],v[76:79]
v_min3_u32 v27,v27,v224,v228
v_min3_u32 v27,v27,v226,v230
v_mfma_f32_16x16x32_bf16 v[72:75],a[216:219],v[232:235],v[72:75]
v_lshlrev_b32 v110,16,v123
v_mfma_f32_16x16x32_bf16 v[76:79],a[220:223],v[236:239],v[76:79]
v_min3_u32 v27,v27,v232,v236
v_min3_u32 v27,v27,v234,v238
v_mfma_f32_16x16x32_bf16 v[80:83],a[0:3],v[128:131],0
v_cmp_eq_u32 vcc,0,v27
s_cbranch_vccnz retry_307
v_mfma_f32_16x16x32_bf16 v[84:87],a[4:7],v[132:135],0
v_and_b32 v111,s80,v123
s_waitcnt lgkmcnt(0)
v_mfma_f32_16x16x32_bf16 v[80:83],a[8:11],v[136:139],v[80:83]
v_mfma_f32_16x16x32_bf16 v[84:87],a[12:15],v[140:143],v[84:87]
v_lshlrev_b32 v104,16,v124
v_mfma_f32_16x16x32_bf16 v[80:83],a[16:19],v[144:147],v[80:83]
v_add_f32 v72,v72,v76
v_add_f32 v73,v73,v77
v_mfma_f32_16x16x32_bf16 v[84:87],a[20:23],v[148:151],v[84:87]
v_and_b32 v105,s80,v124
v_add_f32 v74,v74,v78
v_mfma_f32_16x16x32_bf16 v[80:83],a[24:27],v[152:155],v[80:83]
v_add_f32 v75,v75,v79
v_and_or_b32 v72,v72,-4,s48
v_mfma_f32_16x16x32_bf16 v[84:87],a[28:31],v[156:159],v[84:87]
v_lshlrev_b32 v106,16,v125
s_add_u32 s64,s77,s33
v_mfma_f32_16x16x32_bf16 v[80:83],a[32:35],v[160:163],v[80:83]
buffer_store_dwordx4 v[72:75],v25,s[20:23],s64 offen offset:1024
v_mfma_f32_16x16x32_bf16 v[84:87],a[36:39],v[164:167],v[84:87]
v_and_b32 v107,s80,v125
v_mfma_f32_16x16x32_bf16 v[80:83],a[40:43],v[168:171],v[80:83]
v_mfma_f32_16x16x32_bf16 v[84:87],a[44:47],v[172:175],v[84:87]
v_mfma_f32_16x16x32_bf16 v[80:83],a[48:51],v[176:179],v[80:83]
buffer_load_dwordx4 v[96:99],v26,s[20:23],s77 offen offset:2048 sc1
v_mfma_f32_16x16x32_bf16 v[84:87],a[52:55],v[180:183],v[84:87]
buffer_load_dwordx4 v[100:103],v26,s[20:23],s77 offen offset:3072 sc1
v_mfma_f32_16x16x32_bf16 v[80:83],a[56:59],v[184:187],v[80:83]
v_mfma_f32_16x16x32_bf16 v[84:87],a[60:63],v[188:191],v[84:87]
v_mfma_f32_16x16x32_bf16 v[80:83],a[64:67],v[192:195],v[80:83]
v_mfma_f32_16x16x32_bf16 v[84:87],a[68:71],v[196:199],v[84:87]
v_mfma_f32_16x16x32_bf16 v[80:83],a[72:75],v[200:203],v[80:83]
v_mfma_f32_16x16x32_bf16 v[84:87],a[76:79],v[204:207],v[84:87]
v_mfma_f32_16x16x32_bf16 v[80:83],a[80:83],v[208:211],v[80:83]
v_mfma_f32_16x16x32_bf16 v[84:87],a[84:87],v[212:215],v[84:87]
v_mfma_f32_16x16x32_bf16 v[80:83],a[88:91],v[216:219],v[80:83]
buffer_load_dwordx4 v[92:95],v26,s[20:23],s77 offen offset:1024 sc1
v_mfma_f32_16x16x32_bf16 v[84:87],a[92:95],v[220:223],v[84:87]
v_mfma_f32_16x16x32_bf16 v[80:83],a[96:99],v[224:227],v[80:83]
v_mfma_f32_16x16x32_bf16 v[84:87],a[100:103],v[228:231],v[84:87]
v_mfma_f32_16x16x32_bf16 v[80:83],a[104:107],v[232:235],v[80:83]
v_mfma_f32_16x16x32_bf16 v[84:87],a[108:111],v[236:239],v[84:87]
epi_310:
buffer_load_dword v29,v21,s[20:23],s87 offen sc1
s_nop 6
v_pk_add_f32 v[88:89],v[80:81],v[84:85]
v_pk_add_f32 v[90:91],v[82:83],v[86:87]
v_pk_add_f32 v[88:89],v[88:89],v[108:109]
v_pk_add_f32 v[90:91],v[90:91],v[110:111]
s_waitcnt vmcnt(1)
s_branch ic_319
ip_317:
buffer_load_dwordx4 v[92:95],v26,s[20:23],s77 offen offset:1024 sc1
buffer_load_dwordx4 v[96:99],v26,s[20:23],s77 offen offset:2048 sc1
buffer_load_dwordx4 v[100:103],v26,s[20:23],s77 offen offset:3072 sc1
s_waitcnt vmcnt(0)
ic_319:
v_bitop3_b32 v22,v92,v96,v100 bitop3:0x80
v_and_b32 v22,s48,v22
v_cmp_eq_u32 vcc,0,v22
s_cbranch_vccz ik_318
s_sub_u32 s90,s90,1
s_cmp_gt_i32 s90,0
s_cbranch_scc1 ip_317
ik_318:
v_pk_add_f32 v[88:89],v[88:89],v[92:93]
v_pk_add_f32 v[96:97],v[96:97],v[100:101]
v_pk_add_f32 v[90:91],v[90:91],v[94:95]
v_pk_add_f32 v[98:99],v[98:99],v[102:103]
v_pk_add_f32 v[88:89],v[88:89],v[96:97]
v_pk_add_f32 v[90:91],v[90:91],v[98:99]
v_pk_fma_f32 v[88:89],v[88:89],v[52:53],v[104:105]
v_pk_fma_f32 v[90:91],v[90:91],v[54:55],v[106:107]
v_cvt_pk_bf16_f32 v88,v88,v89
v_cvt_pk_bf16_f32 v89,v90,v91
ds_bpermute_b32 v88,v40,v88
ds_bpermute_b32 v89,v40,v89
v_xor_b32 v18,0x10000,v18
s_xor_b32 s49,s77,524288
s_cselect_b32 s64,0,3
s_xor_b32 s48,s48,s64
v_xor_b32 v20,0x2000,v20
s_add_u32 s76,s76,2097152
s_waitcnt lgkmcnt(0)
s_mov_b64 exec,s[84:85]
buffer_store_dwordx2 v[88:89],v19,s[36:39],s78 offen
s_mov_b64 exec,-1
s_mov_b64 s[84:85],-1
s_mov_b32 s77,s49
s_add_u32 s78,s78,65536
v_xor_b32 v17,0x10000,v17
s_xor_b32 s72,s72,0x10000
s_add_u32 s70,s70,2097152
s_xor_b32 s70,s70,0x2000
s_add_u32 s71,s71,1
s_cmp_le_u32 s71,s57
s_cbranch_scc1 seg_308
s_endpgm
retry_307:
s_sub_u32 s90,s90,64
s_cmp_lt_i32 s90,0
s_cbranch_scc1 giveup_195
s_mov_b32 s83,1
s_waitcnt vmcnt(0) lgkmcnt(0)
s_barrier
s_branch seg_308
kslow_306:
s_add_u32 s64,s79,0
s_lshl_b32 s70,s64,21
s_lshl_b32 s64,s64,13
s_and_b32 s64,s64,0x2000
s_xor_b32 s64,s64,s62
s_add_u32 s70,s70,s64
s_add_u32 s70,s70,29360128
s_mov_b32 s83,1
s_mov_b32 s87,s74
s_cmp_eq_u32 s50,0
s_cselect_b32 s74,s74,0x7fff0000
v_mov_b32 v47,132096
s_lshl_b32 s64,s50,3
s_add_u32 s64,s64,132096
v_mov_b32 v46,s64
v_mov_b32 v29,0
s_mov_b32 s97,0x7fff0000
seg_321:
s_add_u32 s94,s70,s75
s_xor_b32 s95,s94,1024
s_xor_b32 s91,s72,0x10000
s_waitcnt vmcnt(1)
v_cmp_gt_u32 vcc,s71,v29
s_cbranch_vccz nb_325
s_cmp_lg_u32 s50,0
s_cbranch_scc1 nb_325
buffer_load_dword v32,v21,s[20:23],s74 offen sc1
s_sleep 2
pl_326:
buffer_load_dword v33,v21,s[20:23],s74 offen sc1
s_waitcnt vmcnt(1)
v_cmp_gt_u32 vcc,s71,v32
v_mov_b32 v29,v32
s_cbranch_vccz pok_327
buffer_load_dword v32,v21,s[20:23],s74 offen sc1
s_waitcnt vmcnt(1)
v_cmp_gt_u32 vcc,s71,v33
v_mov_b32 v29,v33
s_cbranch_vccz pok_327
s_sub_u32 s90,s90,1
s_cmp_gt_i32 s90,0
s_cbranch_scc1 pl_326
pok_327:
nb_325:
s_barrier
s_xor_b32 m0,s91,0
s_add_u32 s65,s94,0
buffer_load_dwordx4 v16,s[20:23],s65 offen offset:0 sc1 lds
buffer_load_dwordx4 v16,s[20:23],s65 offen offset:2048 sc1 lds
s_xor_b32 m0,s91,16384
s_add_u32 s65,s94,32768
buffer_load_dwordx4 v16,s[20:23],s65 offen offset:0 sc1 lds
buffer_load_dwordx4 v16,s[20:23],s65 offen offset:2048 sc1 lds
s_xor_b32 m0,s91,32768
s_add_u32 s65,s94,65536
buffer_load_dwordx4 v16,s[20:23],s65 offen offset:0 sc1 lds
buffer_load_dwordx4 v16,s[20:23],s65 offen offset:2048 sc1 lds
s_xor_b32 m0,s91,49152
s_add_u32 s65,s94,s86
buffer_load_dwordx4 v16,s[20:23],s65 offen offset:0 sc1 lds
buffer_load_dwordx4 v16,s[20:23],s65 offen offset:2048 sc1 lds
s_waitcnt vmcnt(6)
s_barrier
ds_read_b128 v[224:227],v18 offset:0
ds_read_b128 v[228:231],v18 offset:2048
ds_read_b128 v[232:235],v18 offset:4096
ds_read_b128 v[236:239],v18 offset:6144
ds_read_b128 v[240:243],v18 offset:8192
ds_read_b128 v[244:247],v18 offset:10240
ds_read_b128 v[248:251],v18 offset:12288
s_waitcnt lgkmcnt(5)
v_mfma_f32_16x16x32_bf16 v[64:67],a[0:3],v[224:227],0
s_xor_b32 m0,s91,1024
v_min_u32 v27,v224,v228
v_mfma_f32_16x16x32_bf16 v[68:71],a[112:115],v[224:227],0
ds_read_b128 v[252:255],v18 offset:14336
v_mfma_f32_16x16x32_bf16 v[64:67],a[4:7],v[228:231],v[64:67]
s_add_u32 s65,s95,0
v_mfma_f32_16x16x32_bf16 v[68:71],a[116:119],v[228:231],v[68:71]
s_waitcnt vmcnt(4)
s_barrier
ds_read_b128 v[224:227],v18 offset:16384
s_waitcnt lgkmcnt(5)
v_mfma_f32_16x16x32_bf16 v[64:67],a[8:11],v[232:235],v[64:67]
buffer_load_dwordx4 v16,s[20:23],s65 offen offset:0 sc1 lds
v_mfma_f32_16x16x32_bf16 v[68:71],a[120:123],v[232:235],v[68:71]
ds_read_b128 v[228:231],v18 offset:18432
v_min3_u32 v27,v27,v232,v236
v_mfma_f32_16x16x32_bf16 v[64:67],a[12:15],v[236:239],v[64:67]
buffer_load_dwordx4 v16,s[20:23],s65 offen offset:2048 sc1 lds
v_mfma_f32_16x16x32_bf16 v[68:71],a[124:127],v[236:239],v[68:71]
ds_read_b128 v[232:235],v18 offset:20480
s_waitcnt lgkmcnt(5)
v_mfma_f32_16x16x32_bf16 v[64:67],a[16:19],v[240:243],v[64:67]
s_xor_b32 m0,s91,17408
v_min3_u32 v27,v27,v240,v244
v_mfma_f32_16x16x32_bf16 v[68:71],a[128:131],v[240:243],v[68:71]
ds_read_b128 v[236:239],v18 offset:22528
v_mfma_f32_16x16x32_bf16 v[64:67],a[20:23],v[244:247],v[64:67]
s_add_u32 s65,s95,32768
v_mfma_f32_16x16x32_bf16 v[68:71],a[132:135],v[244:247],v[68:71]
ds_read_b128 v[240:243],v18 offset:24576
s_waitcnt lgkmcnt(5)
v_mfma_f32_16x16x32_bf16 v[64:67],a[24:27],v[248:251],v[64:67]
buffer_load_dwordx4 v16,s[20:23],s65 offen offset:0 sc1 lds
v_mfma_f32_16x16x32_bf16 v[68:71],a[136:139],v[248:251],v[68:71]
ds_read_b128 v[244:247],v18 offset:26624
v_min3_u32 v27,v27,v248,v252
v_mfma_f32_16x16x32_bf16 v[64:67],a[28:31],v[252:255],v[64:67]
buffer_load_dwordx4 v16,s[20:23],s65 offen offset:2048 sc1 lds
v_mfma_f32_16x16x32_bf16 v[68:71],a[140:143],v[252:255],v[68:71]
ds_read_b128 v[248:251],v18 offset:28672
s_waitcnt lgkmcnt(5)
v_mfma_f32_16x16x32_bf16 v[64:67],a[32:35],v[224:227],v[64:67]
s_xor_b32 m0,s91,33792
v_min3_u32 v27,v27,v224,v228
v_mfma_f32_16x16x32_bf16 v[68:71],a[144:147],v[224:227],v[68:71]
ds_read_b128 v[252:255],v18 offset:30720
v_mfma_f32_16x16x32_bf16 v[64:67],a[36:39],v[228:231],v[64:67]
s_add_u32 s65,s95,65536
v_mfma_f32_16x16x32_bf16 v[68:71],a[148:151],v[228:231],v[68:71]
s_waitcnt vmcnt(4)
s_barrier
ds_read_b128 v[224:227],v18 offset:32768
s_waitcnt lgkmcnt(5)
v_mfma_f32_16x16x32_bf16 v[64:67],a[40:43],v[232:235],v[64:67]
buffer_load_dwordx4 v16,s[20:23],s65 offen offset:0 sc1 lds
s_add_u32 s88,s70,s75
v_mfma_f32_16x16x32_bf16 v[68:71],a[152:155],v[232:235],v[68:71]
ds_read_b128 v[228:231],v18 offset:34816
v_min3_u32 v27,v27,v232,v236
s_add_u32 s88,s88,2097152
v_mfma_f32_16x16x32_bf16 v[64:67],a[44:47],v[236:239],v[64:67]
buffer_load_dwordx4 v16,s[20:23],s65 offen offset:2048 sc1 lds
v_mfma_f32_16x16x32_bf16 v[68:71],a[156:159],v[236:239],v[68:71]
ds_read_b128 v[232:235],v18 offset:36864
s_waitcnt lgkmcnt(5)
v_mfma_f32_16x16x32_bf16 v[64:67],a[48:51],v[240:243],v[64:67]
s_xor_b32 m0,s91,50176
v_min3_u32 v27,v27,v240,v244
v_mfma_f32_16x16x32_bf16 v[68:71],a[160:163],v[240:243],v[68:71]
ds_read_b128 v[236:239],v18 offset:38912
s_xor_b32 s88,s88,0x2000
v_mfma_f32_16x16x32_bf16 v[64:67],a[52:55],v[244:247],v[64:67]
s_add_u32 s65,s95,s86
s_xor_b32 s89,s88,1024
v_mfma_f32_16x16x32_bf16 v[68:71],a[164:167],v[244:247],v[68:71]
ds_read_b128 v[240:243],v18 offset:40960
s_waitcnt lgkmcnt(5)
v_mfma_f32_16x16x32_bf16 v[64:67],a[56:59],v[248:251],v[64:67]
buffer_load_dwordx4 v16,s[20:23],s65 offen offset:0 sc1 lds
v_mfma_f32_16x16x32_bf16 v[68:71],a[168:171],v[248:251],v[68:71]
ds_read_b128 v[244:247],v18 offset:43008
v_min3_u32 v27,v27,v248,v252
v_mfma_f32_16x16x32_bf16 v[64:67],a[60:63],v[252:255],v[64:67]
buffer_load_dwordx4 v16,s[20:23],s65 offen offset:2048 sc1 lds
v_mfma_f32_16x16x32_bf16 v[68:71],a[172:175],v[252:255],v[68:71]
ds_read_b128 v[248:251],v18 offset:45056
s_waitcnt lgkmcnt(5)
v_mfma_f32_16x16x32_bf16 v[64:67],a[64:67],v[224:227],v[64:67]
s_waitcnt vmcnt(4)
s_barrier
ds_read_b128 v[128:131],v17 offset:0
ds_read_b128 v[132:135],v17 offset:2048
v_mfma_f32_16x16x32_bf16 v[68:71],a[176:179],v[224:227],v[68:71]
ds_read_b128 v[252:255],v18 offset:47104
v_min3_u32 v27,v27,v224,v228
v_mfma_f32_16x16x32_bf16 v[64:67],a[68:71],v[228:231],v[64:67]
ds_read_b128 v[136:139],v17 offset:4096
buffer_load_dwordx2 v[120:121],v20,s[20:23],s76 offen sc1
v_mfma_f32_16x16x32_bf16 v[68:71],a[180:183],v[228:231],v[68:71]
ds_read_b128 v[224:227],v18 offset:49152
s_waitcnt lgkmcnt(8)
v_mfma_f32_16x16x32_bf16 v[64:67],a[72:75],v[232:235],v[64:67]
ds_read_b128 v[140:143],v17 offset:6144
v_min3_u32 v27,v27,v232,v236
v_mfma_f32_16x16x32_bf16 v[68:71],a[184:187],v[232:235],v[68:71]
ds_read_b128 v[228:231],v18 offset:51200
buffer_load_dwordx2 v[122:123],v24,s[20:23],s70 offen sc1
v_mfma_f32_16x16x32_bf16 v[64:67],a[76:79],v[236:239],v[64:67]
ds_read_b128 v[144:147],v17 offset:8192
ds_read_b128 v[148:151],v17 offset:10240
v_mfma_f32_16x16x32_bf16 v[68:71],a[188:191],v[236:239],v[68:71]
ds_read_b128 v[232:235],v18 offset:53248
s_waitcnt lgkmcnt(11)
v_mfma_f32_16x16x32_bf16 v[64:67],a[80:83],v[240:243],v[64:67]
ds_read_b128 v[152:155],v17 offset:12288
v_min3_u32 v27,v27,v240,v244
v_mfma_f32_16x16x32_bf16 v[68:71],a[192:195],v[240:243],v[68:71]
ds_read_b128 v[236:239],v18 offset:55296
v_mfma_f32_16x16x32_bf16 v[64:67],a[84:87],v[244:247],v[64:67]
ds_read_b128 v[156:159],v17 offset:14336
v_mfma_f32_16x16x32_bf16 v[68:71],a[196:199],v[244:247],v[68:71]
s_waitcnt lgkmcnt(10)
v_mfma_f32_16x16x32_bf16 v[64:67],a[88:91],v[248:251],v[64:67]
ds_read_b128 v[160:163],v17 offset:16384
ds_read_b128 v[164:167],v17 offset:18432
v_mfma_f32_16x16x32_bf16 v[68:71],a[200:203],v[248:251],v[68:71]
v_min3_u32 v27,v27,v248,v252
v_mfma_f32_16x16x32_bf16 v[64:67],a[92:95],v[252:255],v[64:67]
ds_read_b128 v[168:171],v17 offset:20480
v_mfma_f32_16x16x32_bf16 v[68:71],a[204:207],v[252:255],v[68:71]
s_waitcnt lgkmcnt(9)
v_mfma_f32_16x16x32_bf16 v[64:67],a[96:99],v[224:227],v[64:67]
ds_read_b128 v[172:175],v17 offset:22528
v_min3_u32 v27,v27,v224,v228
v_mfma_f32_16x16x32_bf16 v[68:71],a[208:211],v[224:227],v[68:71]
v_min3_u32 v27,v27,v226,v230
v_mfma_f32_16x16x32_bf16 v[64:67],a[100:103],v[228:231],v[64:67]
ds_read_b128 v[176:179],v17 offset:24576
ds_read_b128 v[180:183],v17 offset:26624
v_mfma_f32_16x16x32_bf16 v[68:71],a[212:215],v[228:231],v[68:71]
s_waitcnt lgkmcnt(7)
v_mfma_f32_16x16x32_bf16 v[64:67],a[104:107],v[232:235],v[64:67]
ds_read_b128 v[184:187],v17 offset:28672
v_min3_u32 v27,v27,v232,v236
v_mfma_f32_16x16x32_bf16 v[68:71],a[216:219],v[232:235],v[68:71]
v_min3_u32 v27,v27,v234,v238
v_mfma_f32_16x16x32_bf16 v[64:67],a[108:111],v[236:239],v[64:67]
ds_read_b128 v[188:191],v17 offset:30720
v_mfma_f32_16x16x32_bf16 v[68:71],a[220:223],v[236:239],v[68:71]
v_mfma_f32_16x16x32_bf16 v[72:75],a[112:115],v[128:131],0
v_cmp_eq_u32 vcc,0,v27
s_cbranch_vccnz retry_320
v_mfma_f32_16x16x32_bf16 v[76:79],a[116:119],v[132:135],0
v_min3_u32 v27,v27,v128,v132
v_mfma_f32_16x16x32_bf16 v[72:75],a[120:123],v[136:139],v[72:75]
s_waitcnt vmcnt(2)
s_barrier
ds_read_b128 v[192:195],v17 offset:32768
v_mfma_f32_16x16x32_bf16 v[76:79],a[124:127],v[140:143],v[76:79]
ds_read_b128 v[196:199],v17 offset:34816
s_waitcnt lgkmcnt(10)
v_mfma_f32_16x16x32_bf16 v[72:75],a[128:131],v[144:147],v[72:75]
ds_read_b128 v[200:203],v17 offset:36864
v_min3_u32 v27,v27,v136,v140
s_waitcnt vmcnt(0)
v_mfma_f32_16x16x32_bf16 v[76:79],a[132:135],v[148:151],v[76:79]
ds_read_b128 v[204:207],v17 offset:38912
v_min3_u32 v27,v27,v144,v148
v_and_or_b32 v64,v64,-4,s48
v_mfma_f32_16x16x32_bf16 v[72:75],a[136:139],v[152:155],v[72:75]
ds_read_b128 v[208:211],v17 offset:40960
s_add_u32 s64,s49,s34
v_mfma_f32_16x16x32_bf16 v[76:79],a[140:143],v[156:159],v[76:79]
v_min3_u32 v27,v27,v152,v156
s_waitcnt lgkmcnt(9)
v_mfma_f32_16x16x32_bf16 v[72:75],a[144:147],v[160:163],v[72:75]
ds_read_b128 v[212:215],v17 offset:43008
buffer_store_dwordx4 v[64:67],v25,s[20:23],s64 offen offset:2048 sc1
v_mfma_f32_16x16x32_bf16 v[76:79],a[148:151],v[164:167],v[76:79]
ds_read_b128 v[216:219],v17 offset:45056
v_min3_u32 v27,v27,v160,v164
v_and_or_b32 v68,v68,-4,s48
v_mfma_f32_16x16x32_bf16 v[72:75],a[152:155],v[168:171],v[72:75]
ds_read_b128 v[220:223],v17 offset:47104
s_add_u32 s64,s49,s35
v_mfma_f32_16x16x32_bf16 v[76:79],a[156:159],v[172:175],v[76:79]
ds_read_b128 v[224:227],v17 offset:49152
s_waitcnt lgkmcnt(9)
v_mfma_f32_16x16x32_bf16 v[72:75],a[160:163],v[176:179],v[72:75]
ds_read_b128 v[228:231],v17 offset:51200
v_min3_u32 v27,v27,v168,v172
v_mfma_f32_16x16x32_bf16 v[76:79],a[164:167],v[180:183],v[76:79]
v_min3_u32 v27,v27,v176,v180
buffer_store_dwordx4 v[68:71],v25,s[20:23],s64 offen offset:3072 sc1
v_mfma_f32_16x16x32_bf16 v[72:75],a[168:171],v[184:187],v[72:75]
ds_read_b128 v[232:235],v17 offset:53248
s_mov_b32 s49,0x7fff0000
v_mfma_f32_16x16x32_bf16 v[76:79],a[172:175],v[188:191],v[76:79]
ds_read_b128 v[236:239],v17 offset:55296
s_waitcnt lgkmcnt(8)
v_mfma_f32_16x16x32_bf16 v[72:75],a[176:179],v[192:195],v[72:75]
v_min3_u32 v27,v27,v184,v188
v_mfma_f32_16x16x32_bf16 v[76:79],a[180:183],v[196:199],v[76:79]
v_min3_u32 v27,v27,v192,v196
ds_bpermute_b32 v124,v41,v120
v_mfma_f32_16x16x32_bf16 v[72:75],a[184:187],v[200:203],v[72:75]
v_mfma_f32_16x16x32_bf16 v[76:79],a[188:191],v[204:207],v[76:79]
v_min3_u32 v27,v27,v200,v204
s_waitcnt lgkmcnt(5)
v_mfma_f32_16x16x32_bf16 v[72:75],a[192:195],v[208:211],v[72:75]
ds_bpermute_b32 v125,v41,v121
v_mfma_f32_16x16x32_bf16 v[76:79],a[196:199],v[212:215],v[76:79]
v_min3_u32 v27,v27,v208,v212
v_lshlrev_b32 v108,16,v122
v_mfma_f32_16x16x32_bf16 v[72:75],a[200:203],v[216:219],v[72:75]
v_mfma_f32_16x16x32_bf16 v[76:79],a[204:207],v[220:223],v[76:79]
v_min3_u32 v27,v27,v216,v220
s_waitcnt lgkmcnt(2)
v_mfma_f32_16x16x32_bf16 v[72:75],a[208:211],v[224:227],v[72:75]
v_and_b32 v109,s80,v122
v_mfma_f32_16x16x32_bf16 v[76:79],a[212:215],v[228:231],v[76:79]
v_min3_u32 v27,v27,v224,v228
v_min3_u32 v27,v27,v226,v230
v_mfma_f32_16x16x32_bf16 v[72:75],a[216:219],v[232:235],v[72:75]
v_lshlrev_b32 v110,16,v123
v_mfma_f32_16x16x32_bf16 v[76:79],a[220:223],v[236:239],v[76:79]
v_min3_u32 v27,v27,v232,v236
v_min3_u32 v27,v27,v234,v238
v_mfma_f32_16x16x32_bf16 v[80:83],a[0:3],v[128:131],0
v_cmp_eq_u32 vcc,0,v27
s_cbranch_vccnz retry_320
v_mfma_f32_16x16x32_bf16 v[84:87],a[4:7],v[132:135],0
v_and_b32 v111,s80,v123
s_waitcnt lgkmcnt(0)
v_mfma_f32_16x16x32_bf16 v[80:83],a[8:11],v[136:139],v[80:83]
v_mfma_f32_16x16x32_bf16 v[84:87],a[12:15],v[140:143],v[84:87]
v_lshlrev_b32 v104,16,v124
v_mfma_f32_16x16x32_bf16 v[80:83],a[16:19],v[144:147],v[80:83]
v_add_f32 v72,v72,v76
v_add_f32 v73,v73,v77
v_mfma_f32_16x16x32_bf16 v[84:87],a[20:23],v[148:151],v[84:87]
v_and_b32 v105,s80,v124
v_add_f32 v74,v74,v78
v_mfma_f32_16x16x32_bf16 v[80:83],a[24:27],v[152:155],v[80:83]
v_add_f32 v75,v75,v79
v_and_or_b32 v72,v72,-4,s48
v_mfma_f32_16x16x32_bf16 v[84:87],a[28:31],v[156:159],v[84:87]
v_lshlrev_b32 v106,16,v125
s_add_u32 s64,s77,s33
v_mfma_f32_16x16x32_bf16 v[80:83],a[32:35],v[160:163],v[80:83]
buffer_store_dwordx4 v[72:75],v25,s[20:23],s64 offen offset:1024 sc1
v_mfma_f32_16x16x32_bf16 v[84:87],a[36:39],v[164:167],v[84:87]
v_and_b32 v107,s80,v125
v_mfma_f32_16x16x32_bf16 v[80:83],a[40:43],v[168:171],v[80:83]
v_mfma_f32_16x16x32_bf16 v[84:87],a[44:47],v[172:175],v[84:87]
v_mfma_f32_16x16x32_bf16 v[80:83],a[48:51],v[176:179],v[80:83]
buffer_load_dwordx4 v[96:99],v26,s[20:23],s77 offen offset:2048 sc1
v_mfma_f32_16x16x32_bf16 v[84:87],a[52:55],v[180:183],v[84:87]
buffer_load_dwordx4 v[100:103],v26,s[20:23],s77 offen offset:3072 sc1
v_mfma_f32_16x16x32_bf16 v[80:83],a[56:59],v[184:187],v[80:83]
v_mfma_f32_16x16x32_bf16 v[84:87],a[60:63],v[188:191],v[84:87]
v_mfma_f32_16x16x32_bf16 v[80:83],a[64:67],v[192:195],v[80:83]
v_mfma_f32_16x16x32_bf16 v[84:87],a[68:71],v[196:199],v[84:87]
v_mfma_f32_16x16x32_bf16 v[80:83],a[72:75],v[200:203],v[80:83]
v_mfma_f32_16x16x32_bf16 v[84:87],a[76:79],v[204:207],v[84:87]
v_mfma_f32_16x16x32_bf16 v[80:83],a[80:83],v[208:211],v[80:83]
v_mfma_f32_16x16x32_bf16 v[84:87],a[84:87],v[212:215],v[84:87]
v_mfma_f32_16x16x32_bf16 v[80:83],a[88:91],v[216:219],v[80:83]
buffer_load_dwordx4 v[92:95],v26,s[20:23],s77 offen offset:1024 sc1
v_mfma_f32_16x16x32_bf16 v[84:87],a[92:95],v[220:223],v[84:87]
v_mfma_f32_16x16x32_bf16 v[80:83],a[96:99],v[224:227],v[80:83]
v_mfma_f32_16x16x32_bf16 v[84:87],a[100:103],v[228:231],v[84:87]
v_mfma_f32_16x16x32_bf16 v[80:83],a[104:107],v[232:235],v[80:83]
v_mfma_f32_16x16x32_bf16 v[84:87],a[108:111],v[236:239],v[84:87]
epi_323:
buffer_load_dword v29,v21,s[20:23],s87 offen sc1
s_nop 6
v_pk_add_f32 v[88:89],v[80:81],v[84:85]
v_pk_add_f32 v[90:91],v[82:83],v[86:87]
v_pk_add_f32 v[88:89],v[88:89],v[108:109]
v_pk_add_f32 v[90:91],v[90:91],v[110:111]
s_waitcnt vmcnt(1)
s_branch ic_330
ip_328:
buffer_load_dwordx4 v[92:95],v26,s[20:23],s77 offen offset:1024 sc1
buffer_load_dwordx4 v[96:99],v26,s[20:23],s77 offen offset:2048 sc1
buffer_load_dwordx4 v[100:103],v26,s[20:23],s77 offen offset:3072 sc1
s_waitcnt vmcnt(0)
ic_330:
v_bitop3_b32 v22,v92,v96,v100 bitop3:0x80
v_and_b32 v22,s48,v22
v_cmp_eq_u32 vcc,0,v22
s_cbranch_vccz ik_329
s_sub_u32 s90,s90,1
s_cmp_gt_i32 s90,0
s_cbranch_scc1 ip_328
ik_329:
v_pk_add_f32 v[88:89],v[88:89],v[92:93]
v_pk_add_f32 v[96:97],v[96:97],v[100:101]
v_pk_add_f32 v[90:91],v[90:91],v[94:95]
v_pk_add_f32 v[98:99],v[98:99],v[102:103]
v_pk_add_f32 v[88:89],v[88:89],v[96:97]
v_pk_add_f32 v[90:91],v[90:91],v[98:99]
v_pk_fma_f32 v[88:89],v[88:89],v[52:53],v[104:105]
v_pk_fma_f32 v[90:91],v[90:91],v[54:55],v[106:107]
v_cvt_pk_bf16_f32 v88,v88,v89
v_cvt_pk_bf16_f32 v89,v90,v91
ds_bpermute_b32 v88,v40,v88
ds_bpermute_b32 v89,v40,v89
v_xor_b32 v18,0x10000,v18
s_xor_b32 s49,s77,524288
s_cselect_b32 s64,0,3
s_xor_b32 s48,s48,s64
v_xor_b32 v20,0x2000,v20
s_add_u32 s76,s76,2097152
s_waitcnt lgkmcnt(0)
s_mov_b64 exec,s[84:85]
buffer_store_dwordx2 v[88:89],v19,s[36:39],s78 offen
s_mov_b64 exec,-1
s_mov_b64 s[84:85],-1
s_mov_b32 s77,s49
s_add_u32 s78,s78,65536
v_xor_b32 v17,0x10000,v17
s_xor_b32 s72,s72,0x10000
s_add_u32 s70,s70,2097152
s_xor_b32 s70,s70,0x2000
s_add_u32 s71,s71,1
s_cmp_le_u32 s71,s57
s_cbranch_scc1 seg_321
s_endpgm
retry_320:
s_sub_u32 s90,s90,64
s_cmp_lt_i32 s90,0
s_cbranch_scc1 giveup_195
s_mov_b32 s83,1
s_waitcnt vmcnt(0) lgkmcnt(0)
s_barrier
s_branch seg_321
r_w3_213:
s_load_dwordx2 s[4:5],s[0:1],80
s_mul_i32 s66,s59,224
s_lshl_b32 s67,s50,1
s_waitcnt lgkmcnt(0)
s_mov_b32 s32,s4
s_and_b32 s33,s5,0xffff
s_mov_b32 s34,0x700000
s_mov_b32 s35,0x20000
v_lshrrev_b32 v5,2,v3
v_lshl_add_u32 v5,v4,2,v5
v_and_b32 v6,3,v3
v_lshlrev_b32 v6,3,v6
v_lshl_add_u32 v6,v5,8,v6
v_and_b32 v5,7,v5
v_xor_b32 v5,s67,v5
v_lshl_add_u32 v12,v5,5,v6
v_xor_b32 v13,32,v12
v_and_b32 v5,15,v1
v_and_b32 v6,3,v4
v_lshlrev_b32 v6,1,v6
v_xor_b32 v5,v5,v6
v_mul_u32_u24 v6,7168,v4
v_xor_b32 v7,0,v5
v_lshl_add_u32 v8,v7,4,v6
v_xor_b32 v7,8,v5
v_lshl_add_u32 v9,v7,4,v6
s_mul_i32 s74,s50,458752
s_add_u32 s74,s74,s66
s_lshl_b32 s75,s50,14
s_mul_i32 s76,s50,229376
s_add_u32 s76,s76,s66
s_lshl_b32 s77,s50,13
s_add_u32 s64,s74,0
s_add_u32 m0,s75,0
s_nop 0
buffer_load_dwordx4 v8,s[32:35],s64 offen nt lds
s_add_u32 s64,s74,28672
s_add_u32 m0,s75,1024
s_nop 0
buffer_load_dwordx4 v9,s[32:35],s64 offen nt lds
s_add_u32 s64,s74,57344
s_add_u32 m0,s75,2048
s_nop 0
buffer_load_dwordx4 v8,s[32:35],s64 offen nt lds
s_add_u32 s64,s74,86016
s_add_u32 m0,s75,3072
s_nop 0
buffer_load_dwordx4 v9,s[32:35],s64 offen nt lds
s_add_u32 s64,s74,114688
s_add_u32 m0,s75,4096
s_nop 0
buffer_load_dwordx4 v8,s[32:35],s64 offen nt lds
s_add_u32 s64,s74,143360
s_add_u32 m0,s75,5120
s_nop 0
buffer_load_dwordx4 v9,s[32:35],s64 offen nt lds
s_add_u32 s64,s74,172032
s_add_u32 m0,s75,6144
s_nop 0
buffer_load_dwordx4 v8,s[32:35],s64 offen nt lds
s_add_u32 s64,s74,200704
s_add_u32 m0,s75,7168
s_nop 0
buffer_load_dwordx4 v9,s[32:35],s64 offen nt lds
s_add_u32 s64,s74,229376
s_add_u32 m0,s75,8192
s_nop 0
buffer_load_dwordx4 v8,s[32:35],s64 offen nt lds
s_add_u32 s64,s74,258048
s_add_u32 m0,s75,9216
s_nop 0
buffer_load_dwordx4 v9,s[32:35],s64 offen nt lds
s_add_u32 s64,s74,286720
s_add_u32 m0,s75,10240
s_nop 0
buffer_load_dwordx4 v8,s[32:35],s64 offen nt lds
s_add_u32 s64,s74,315392
s_add_u32 m0,s75,11264
s_nop 0
buffer_load_dwordx4 v9,s[32:35],s64 offen nt lds
s_add_u32 s64,s74,344064
s_add_u32 m0,s75,12288
s_nop 0
buffer_load_dwordx4 v8,s[32:35],s64 offen nt lds
s_add_u32 s64,s74,372736
s_add_u32 m0,s75,13312
s_nop 0
buffer_load_dwordx4 v9,s[32:35],s64 offen nt lds
s_add_u32 s64,s74,401408
s_add_u32 m0,s75,14336
s_nop 0
buffer_load_dwordx4 v8,s[32:35],s64 offen nt lds
s_add_u32 s64,s74,430080
s_add_u32 m0,s75,15360
s_nop 0
buffer_load_dwordx4 v9,s[32:35],s64 offen nt lds
s_add_u32 s64,s74,1835008
s_add_u32 m0,s75,65536
s_nop 0
buffer_load_dwordx4 v8,s[32:35],s64 offen nt lds
s_add_u32 s64,s74,1863680
s_add_u32 m0,s75,66560
s_nop 0
buffer_load_dwordx4 v9,s[32:35],s64 offen nt lds
s_add_u32 s64,s74,1892352
s_add_u32 m0,s75,67584
s_nop 0
buffer_load_dwordx4 v8,s[32:35],s64 offen nt lds
s_add_u32 s64,s74,1921024
s_add_u32 m0,s75,68608
s_nop 0
buffer_load_dwordx4 v9,s[32:35],s64 offen nt lds
s_add_u32 s64,s74,1949696
s_add_u32 m0,s75,69632
s_nop 0
buffer_load_dwordx4 v8,s[32:35],s64 offen nt lds
s_add_u32 s64,s74,1978368
s_add_u32 m0,s75,70656
s_nop 0
buffer_load_dwordx4 v9,s[32:35],s64 offen nt lds
s_add_u32 s64,s74,2007040
s_add_u32 m0,s75,71680
s_nop 0
buffer_load_dwordx4 v8,s[32:35],s64 offen nt lds
s_add_u32 s64,s74,2035712
s_add_u32 m0,s75,72704
s_nop 0
buffer_load_dwordx4 v9,s[32:35],s64 offen nt lds
s_add_u32 s64,s74,2064384
s_add_u32 m0,s75,73728
s_nop 0
buffer_load_dwordx4 v8,s[32:35],s64 offen nt lds
s_add_u32 s64,s74,2093056
s_add_u32 m0,s75,74752
s_nop 0
buffer_load_dwordx4 v9,s[32:35],s64 offen nt lds
s_add_u32 s64,s74,2121728
s_add_u32 m0,s75,75776
s_nop 0
buffer_load_dwordx4 v8,s[32:35],s64 offen nt lds
s_add_u32 s64,s74,2150400
s_add_u32 m0,s75,76800
s_nop 0
buffer_load_dwordx4 v9,s[32:35],s64 offen nt lds
s_add_u32 s64,s74,2179072
s_add_u32 m0,s75,77824
s_nop 0
buffer_load_dwordx4 v8,s[32:35],s64 offen nt lds
s_add_u32 s64,s74,2207744
s_add_u32 m0,s75,78848
s_nop 0
buffer_load_dwordx4 v9,s[32:35],s64 offen nt lds
s_add_u32 s64,s74,2236416
s_add_u32 m0,s75,79872
s_nop 0
buffer_load_dwordx4 v8,s[32:35],s64 offen nt lds
s_add_u32 s64,s74,2265088
s_add_u32 m0,s75,80896
s_nop 0
buffer_load_dwordx4 v9,s[32:35],s64 offen nt lds
s_waitcnt vmcnt(16)
s_barrier
ds_read_b64_tr_b16 a[0:1],v12 offset:0
ds_read_b64_tr_b16 a[128:129],v13 offset:0
ds_read_b64_tr_b16 a[2:3],v12 offset:4096
ds_read_b64_tr_b16 a[130:131],v13 offset:4096
ds_read_b64_tr_b16 a[4:5],v12 offset:8192
ds_read_b64_tr_b16 a[132:133],v13 offset:8192
ds_read_b64_tr_b16 a[6:7],v12 offset:12288
ds_read_b64_tr_b16 a[134:135],v13 offset:12288
s_waitcnt lgkmcnt(4)
ds_read_b64_tr_b16 a[8:9],v12 offset:16384
ds_read_b64_tr_b16 a[136:137],v13 offset:16384
ds_read_b64_tr_b16 a[10:11],v12 offset:20480
ds_read_b64_tr_b16 a[138:139],v13 offset:20480
ds_read_b64_tr_b16 a[12:13],v12 offset:24576
ds_read_b64_tr_b16 a[140:141],v13 offset:24576
ds_read_b64_tr_b16 a[14:15],v12 offset:28672
ds_read_b64_tr_b16 a[142:143],v13 offset:28672
s_waitcnt lgkmcnt(4)
ds_read_b64_tr_b16 a[16:17],v12 offset:32768
ds_read_b64_tr_b16 a[144:145],v13 offset:32768
ds_read_b64_tr_b16 a[18:19],v12 offset:36864
ds_read_b64_tr_b16 a[146:147],v13 offset:36864
ds_read_b64_tr_b16 a[20:21],v12 offset:40960
ds_read_b64_tr_b16 a[148:149],v13 offset:40960
ds_read_b64_tr_b16 a[22:23],v12 offset:45056
ds_read_b64_tr_b16 a[150:151],v13 offset:45056
s_waitcnt lgkmcnt(4)
ds_read_b64_tr_b16 a[24:25],v12 offset:49152
ds_read_b64_tr_b16 a[152:153],v13 offset:49152
ds_read_b64_tr_b16 a[26:27],v12 offset:53248
ds_read_b64_tr_b16 a[154:155],v13 offset:53248
ds_read_b64_tr_b16 a[28:29],v12 offset:57344
ds_read_b64_tr_b16 a[156:157],v13 offset:57344
ds_read_b64_tr_b16 a[30:31],v12 offset:61440
ds_read_b64_tr_b16 a[158:159],v13 offset:61440
s_waitcnt lgkmcnt(4)
v_xor_b32 v12,0x10000,v12
v_xor_b32 v13,0x10000,v13
s_waitcnt lgkmcnt(0)
s_barrier
s_add_u32 s64,s74,3670016
s_add_u32 m0,s75,0
s_nop 0
buffer_load_dwordx4 v8,s[32:35],s64 offen nt lds
s_add_u32 s64,s74,3698688
s_add_u32 m0,s75,1024
s_nop 0
buffer_load_dwordx4 v9,s[32:35],s64 offen nt lds
s_add_u32 s64,s74,3727360
s_add_u32 m0,s75,2048
s_nop 0
buffer_load_dwordx4 v8,s[32:35],s64 offen nt lds
s_add_u32 s64,s74,3756032
s_add_u32 m0,s75,3072
s_nop 0
buffer_load_dwordx4 v9,s[32:35],s64 offen nt lds
s_add_u32 s64,s74,3784704
s_add_u32 m0,s75,4096
s_nop 0
buffer_load_dwordx4 v8,s[32:35],s64 offen nt lds
s_add_u32 s64,s74,3813376
s_add_u32 m0,s75,5120
s_nop 0
buffer_load_dwordx4 v9,s[32:35],s64 offen nt lds
s_add_u32 s64,s74,3842048
s_add_u32 m0,s75,6144
s_nop 0
buffer_load_dwordx4 v8,s[32:35],s64 offen nt lds
s_add_u32 s64,s74,3870720
s_add_u32 m0,s75,7168
s_nop 0
buffer_load_dwordx4 v9,s[32:35],s64 offen nt lds
s_add_u32 s64,s74,3899392
s_add_u32 m0,s75,8192
s_nop 0
buffer_load_dwordx4 v8,s[32:35],s64 offen nt lds
s_add_u32 s64,s74,3928064
s_add_u32 m0,s75,9216
s_nop 0
buffer_load_dwordx4 v9,s[32:35],s64 offen nt lds
s_add_u32 s64,s74,3956736
s_add_u32 m0,s75,10240
s_nop 0
buffer_load_dwordx4 v8,s[32:35],s64 offen nt lds
s_add_u32 s64,s74,3985408
s_add_u32 m0,s75,11264
s_nop 0
buffer_load_dwordx4 v9,s[32:35],s64 offen nt lds
s_add_u32 s64,s74,4014080
s_add_u32 m0,s75,12288
s_nop 0
buffer_load_dwordx4 v8,s[32:35],s64 offen nt lds
s_add_u32 s64,s74,4042752
s_add_u32 m0,s75,13312
s_nop 0
buffer_load_dwordx4 v9,s[32:35],s64 offen nt lds
s_add_u32 s64,s74,4071424
s_add_u32 m0,s75,14336
s_nop 0
buffer_load_dwordx4 v8,s[32:35],s64 offen nt lds
s_add_u32 s64,s74,4100096
s_add_u32 m0,s75,15360
s_nop 0
buffer_load_dwordx4 v9,s[32:35],s64 offen nt lds
s_waitcnt vmcnt(16)
s_barrier
ds_read_b64_tr_b16 a[32:33],v12 offset:0
ds_read_b64_tr_b16 a[160:161],v13 offset:0
ds_read_b64_tr_b16 a[34:35],v12 offset:4096
ds_read_b64_tr_b16 a[162:163],v13 offset:4096
ds_read_b64_tr_b16 a[36:37],v12 offset:8192
ds_read_b64_tr_b16 a[164:165],v13 offset:8192
ds_read_b64_tr_b16 a[38:39],v12 offset:12288
ds_read_b64_tr_b16 a[166:167],v13 offset:12288
s_waitcnt lgkmcnt(4)
ds_read_b64_tr_b16 a[40:41],v12 offset:16384
ds_read_b64_tr_b16 a[168:169],v13 offset:16384
ds_read_b64_tr_b16 a[42:43],v12 offset:20480
ds_read_b64_tr_b16 a[170:171],v13 offset:20480
ds_read_b64_tr_b16 a[44:45],v12 offset:24576
ds_read_b64_tr_b16 a[172:173],v13 offset:24576
ds_read_b64_tr_b16 a[46:47],v12 offset:28672
ds_read_b64_tr_b16 a[174:175],v13 offset:28672
s_waitcnt lgkmcnt(4)
ds_read_b64_tr_b16 a[48:49],v12 offset:32768
ds_read_b64_tr_b16 a[176:177],v13 offset:32768
ds_read_b64_tr_b16 a[50:51],v12 offset:36864
ds_read_b64_tr_b16 a[178:179],v13 offset:36864
ds_read_b64_tr_b16 a[52:53],v12 offset:40960
ds_read_b64_tr_b16 a[180:181],v13 offset:40960
ds_read_b64_tr_b16 a[54:55],v12 offset:45056
ds_read_b64_tr_b16 a[182:183],v13 offset:45056
s_waitcnt lgkmcnt(4)
ds_read_b64_tr_b16 a[56:57],v12 offset:49152
ds_read_b64_tr_b16 a[184:185],v13 offset:49152
ds_read_b64_tr_b16 a[58:59],v12 offset:53248
ds_read_b64_tr_b16 a[186:187],v13 offset:53248
ds_read_b64_tr_b16 a[60:61],v12 offset:57344
ds_read_b64_tr_b16 a[188:189],v13 offset:57344
ds_read_b64_tr_b16 a[62:63],v12 offset:61440
ds_read_b64_tr_b16 a[190:191],v13 offset:61440
s_waitcnt lgkmcnt(4)
v_xor_b32 v12,0x10000,v12
v_xor_b32 v13,0x10000,v13
s_waitcnt lgkmcnt(0)
s_barrier
s_add_u32 s64,s74,5505024
s_add_u32 m0,s75,65536
s_nop 0
buffer_load_dwordx4 v8,s[32:35],s64 offen nt lds
s_add_u32 s64,s74,5533696
s_add_u32 m0,s75,66560
s_nop 0
buffer_load_dwordx4 v9,s[32:35],s64 offen nt lds
s_add_u32 s64,s74,5562368
s_add_u32 m0,s75,67584
s_nop 0
buffer_load_dwordx4 v8,s[32:35],s64 offen nt lds
s_add_u32 s64,s74,5591040
s_add_u32 m0,s75,68608
s_nop 0
buffer_load_dwordx4 v9,s[32:35],s64 offen nt lds
s_add_u32 s64,s74,5619712
s_add_u32 m0,s75,69632
s_nop 0
buffer_load_dwordx4 v8,s[32:35],s64 offen nt lds
s_add_u32 s64,s74,5648384
s_add_u32 m0,s75,70656
s_nop 0
buffer_load_dwordx4 v9,s[32:35],s64 offen nt lds
s_add_u32 s64,s74,5677056
s_add_u32 m0,s75,71680
s_nop 0
buffer_load_dwordx4 v8,s[32:35],s64 offen nt lds
s_add_u32 s64,s74,5705728
s_add_u32 m0,s75,72704
s_nop 0
buffer_load_dwordx4 v9,s[32:35],s64 offen nt lds
s_add_u32 s64,s74,5734400
s_add_u32 m0,s75,73728
s_nop 0
buffer_load_dwordx4 v8,s[32:35],s64 offen nt lds
s_add_u32 s64,s74,5763072
s_add_u32 m0,s75,74752
s_nop 0
buffer_load_dwordx4 v9,s[32:35],s64 offen nt lds
s_add_u32 s64,s74,5791744
s_add_u32 m0,s75,75776
s_nop 0
buffer_load_dwordx4 v8,s[32:35],s64 offen nt lds
s_add_u32 s64,s74,5820416
s_add_u32 m0,s75,76800
s_nop 0
buffer_load_dwordx4 v9,s[32:35],s64 offen nt lds
s_add_u32 s64,s74,5849088
s_add_u32 m0,s75,77824
s_nop 0
buffer_load_dwordx4 v8,s[32:35],s64 offen nt lds
s_add_u32 s64,s74,5877760
s_add_u32 m0,s75,78848
s_nop 0
buffer_load_dwordx4 v9,s[32:35],s64 offen nt lds
s_add_u32 s64,s74,5906432
s_add_u32 m0,s75,79872
s_nop 0
buffer_load_dwordx4 v8,s[32:35],s64 offen nt lds
s_add_u32 s64,s74,5935104
s_add_u32 m0,s75,80896
s_nop 0
buffer_load_dwordx4 v9,s[32:35],s64 offen nt lds
s_waitcnt vmcnt(16)
s_barrier
ds_read_b64_tr_b16 a[64:65],v12 offset:0
ds_read_b64_tr_b16 a[192:193],v13 offset:0
ds_read_b64_tr_b16 a[66:67],v12 offset:4096
ds_read_b64_tr_b16 a[194:195],v13 offset:4096
ds_read_b64_tr_b16 a[68:69],v12 offset:8192
ds_read_b64_tr_b16 a[196:197],v13 offset:8192
ds_read_b64_tr_b16 a[70:71],v12 offset:12288
ds_read_b64_tr_b16 a[198:199],v13 offset:12288
s_waitcnt lgkmcnt(4)
ds_read_b64_tr_b16 a[72:73],v12 offset:16384
ds_read_b64_tr_b16 a[200:201],v13 offset:16384
ds_read_b64_tr_b16 a[74:75],v12 offset:20480
ds_read_b64_tr_b16 a[202:203],v13 offset:20480
ds_read_b64_tr_b16 a[76:77],v12 offset:24576
ds_read_b64_tr_b16 a[204:205],v13 offset:24576
ds_read_b64_tr_b16 a[78:79],v12 offset:28672
ds_read_b64_tr_b16 a[206:207],v13 offset:28672
s_waitcnt lgkmcnt(4)
ds_read_b64_tr_b16 a[80:81],v12 offset:32768
ds_read_b64_tr_b16 a[208:209],v13 offset:32768
ds_read_b64_tr_b16 a[82:83],v12 offset:36864
ds_read_b64_tr_b16 a[210:211],v13 offset:36864
ds_read_b64_tr_b16 a[84:85],v12 offset:40960
ds_read_b64_tr_b16 a[212:213],v13 offset:40960
ds_read_b64_tr_b16 a[86:87],v12 offset:45056
ds_read_b64_tr_b16 a[214:215],v13 offset:45056
s_waitcnt lgkmcnt(4)
ds_read_b64_tr_b16 a[88:89],v12 offset:49152
ds_read_b64_tr_b16 a[216:217],v13 offset:49152
ds_read_b64_tr_b16 a[90:91],v12 offset:53248
ds_read_b64_tr_b16 a[218:219],v13 offset:53248
ds_read_b64_tr_b16 a[92:93],v12 offset:57344
ds_read_b64_tr_b16 a[220:221],v13 offset:57344
ds_read_b64_tr_b16 a[94:95],v12 offset:61440
ds_read_b64_tr_b16 a[222:223],v13 offset:61440
s_waitcnt lgkmcnt(4)
v_xor_b32 v12,0x10000,v12
v_xor_b32 v13,0x10000,v13
s_waitcnt lgkmcnt(0)
s_barrier
s_waitcnt vmcnt(0)
s_barrier
ds_read_b64_tr_b16 a[96:97],v12 offset:0
ds_read_b64_tr_b16 a[224:225],v13 offset:0
ds_read_b64_tr_b16 a[98:99],v12 offset:4096
ds_read_b64_tr_b16 a[226:227],v13 offset:4096
ds_read_b64_tr_b16 a[100:101],v12 offset:8192
ds_read_b64_tr_b16 a[228:229],v13 offset:8192
ds_read_b64_tr_b16 a[102:103],v12 offset:12288
ds_read_b64_tr_b16 a[230:231],v13 offset:12288
s_waitcnt lgkmcnt(4)
ds_read_b64_tr_b16 a[104:105],v12 offset:16384
ds_read_b64_tr_b16 a[232:233],v13 offset:16384
ds_read_b64_tr_b16 a[106:107],v12 offset:20480
ds_read_b64_tr_b16 a[234:235],v13 offset:20480
ds_read_b64_tr_b16 a[108:109],v12 offset:24576
ds_read_b64_tr_b16 a[236:237],v13 offset:24576
ds_read_b64_tr_b16 a[110:111],v12 offset:28672
ds_read_b64_tr_b16 a[238:239],v13 offset:28672
s_waitcnt lgkmcnt(4)
ds_read_b64_tr_b16 a[112:113],v12 offset:32768
ds_read_b64_tr_b16 a[240:241],v13 offset:32768
ds_read_b64_tr_b16 a[114:115],v12 offset:36864
ds_read_b64_tr_b16 a[242:243],v13 offset:36864
ds_read_b64_tr_b16 a[116:117],v12 offset:40960
ds_read_b64_tr_b16 a[244:245],v13 offset:40960
ds_read_b64_tr_b16 a[118:119],v12 offset:45056
ds_read_b64_tr_b16 a[246:247],v13 offset:45056
s_waitcnt lgkmcnt(4)
ds_read_b64_tr_b16 a[120:121],v12 offset:49152
ds_read_b64_tr_b16 a[248:249],v13 offset:49152
ds_read_b64_tr_b16 a[122:123],v12 offset:53248
ds_read_b64_tr_b16 a[250:251],v13 offset:53248
ds_read_b64_tr_b16 a[124:125],v12 offset:57344
ds_read_b64_tr_b16 a[252:253],v13 offset:57344
ds_read_b64_tr_b16 a[126:127],v12 offset:61440
ds_read_b64_tr_b16 a[254:255],v13 offset:61440
s_waitcnt lgkmcnt(4)
v_xor_b32 v12,0x10000,v12
v_xor_b32 v13,0x10000,v13
s_waitcnt lgkmcnt(0)
s_barrier
v_mov_b32 v88,0x3f803f80
v_mov_b32 v89,0x3f803f80
v_mov_b32 v90,0x3f803f80
v_mov_b32 v91,0x3f803f80
s_nop 1
v_mfma_f32_16x16x32_bf16 v[52:55],a[0:3],v[88:91],0
v_mfma_f32_16x16x32_bf16 v[56:59],a[128:131],v[88:91],0
v_mfma_f32_16x16x32_bf16 v[52:55],a[4:7],v[88:91],v[52:55]
v_mfma_f32_16x16x32_bf16 v[56:59],a[132:135],v[88:91],v[56:59]
v_mfma_f32_16x16x32_bf16 v[52:55],a[8:11],v[88:91],v[52:55]
v_mfma_f32_16x16x32_bf16 v[56:59],a[136:139],v[88:91],v[56:59]
v_mfma_f32_16x16x32_bf16 v[52:55],a[12:15],v[88:91],v[52:55]
v_mfma_f32_16x16x32_bf16 v[56:59],a[140:143],v[88:91],v[56:59]
v_mfma_f32_16x16x32_bf16 v[52:55],a[16:19],v[88:91],v[52:55]
v_mfma_f32_16x16x32_bf16 v[56:59],a[144:147],v[88:91],v[56:59]
v_mfma_f32_16x16x32_bf16 v[52:55],a[20:23],v[88:91],v[52:55]
v_mfma_f32_16x16x32_bf16 v[56:59],a[148:151],v[88:91],v[56:59]
v_mfma_f32_16x16x32_bf16 v[52:55],a[24:27],v[88:91],v[52:55]
v_mfma_f32_16x16x32_bf16 v[56:59],a[152:155],v[88:91],v[56:59]
v_mfma_f32_16x16x32_bf16 v[52:55],a[28:31],v[88:91],v[52:55]
v_mfma_f32_16x16x32_bf16 v[56:59],a[156:159],v[88:91],v[56:59]
v_mfma_f32_16x16x32_bf16 v[52:55],a[32:35],v[88:91],v[52:55]
v_mfma_f32_16x16x32_bf16 v[56:59],a[160:163],v[88:91],v[56:59]
v_mfma_f32_16x16x32_bf16 v[52:55],a[36:39],v[88:91],v[52:55]
v_mfma_f32_16x16x32_bf16 v[56:59],a[164:167],v[88:91],v[56:59]
v_mfma_f32_16x16x32_bf16 v[52:55],a[40:43],v[88:91],v[52:55]
v_mfma_f32_16x16x32_bf16 v[56:59],a[168:171],v[88:91],v[56:59]
v_mfma_f32_16x16x32_bf16 v[52:55],a[44:47],v[88:91],v[52:55]
v_mfma_f32_16x16x32_bf16 v[56:59],a[172:175],v[88:91],v[56:59]
v_mfma_f32_16x16x32_bf16 v[52:55],a[48:51],v[88:91],v[52:55]
v_mfma_f32_16x16x32_bf16 v[56:59],a[176:179],v[88:91],v[56:59]
v_mfma_f32_16x16x32_bf16 v[52:55],a[52:55],v[88:91],v[52:55]
v_mfma_f32_16x16x32_bf16 v[56:59],a[180:183],v[88:91],v[56:59]
v_mfma_f32_16x16x32_bf16 v[52:55],a[56:59],v[88:91],v[52:55]
v_mfma_f32_16x16x32_bf16 v[56:59],a[184:187],v[88:91],v[56:59]
v_mfma_f32_16x16x32_bf16 v[52:55],a[60:63],v[88:91],v[52:55]
v_mfma_f32_16x16x32_bf16 v[56:59],a[188:191],v[88:91],v[56:59]
v_mfma_f32_16x16x32_bf16 v[52:55],a[64:67],v[88:91],v[52:55]
v_mfma_f32_16x16x32_bf16 v[56:59],a[192:195],v[88:91],v[56:59]
v_mfma_f32_16x16x32_bf16 v[52:55],a[68:71],v[88:91],v[52:55]
v_mfma_f32_16x16x32_bf16 v[56:59],a[196:199],v[88:91],v[56:59]
v_mfma_f32_16x16x32_bf16 v[52:55],a[72:75],v[88:91],v[52:55]
v_mfma_f32_16x16x32_bf16 v[56:59],a[200:203],v[88:91],v[56:59]
v_mfma_f32_16x16x32_bf16 v[52:55],a[76:79],v[88:91],v[52:55]
v_mfma_f32_16x16x32_bf16 v[56:59],a[204:207],v[88:91],v[56:59]
v_mfma_f32_16x16x32_bf16 v[52:55],a[80:83],v[88:91],v[52:55]
v_mfma_f32_16x16x32_bf16 v[56:59],a[208:211],v[88:91],v[56:59]
v_mfma_f32_16x16x32_bf16 v[52:55],a[84:87],v[88:91],v[52:55]
v_mfma_f32_16x16x32_bf16 v[56:59],a[212:215],v[88:91],v[56:59]
v_mfma_f32_16x16x32_bf16 v[52:55],a[88:91],v[88:91],v[52:55]
v_mfma_f32_16x16x32_bf16 v[56:59],a[216:219],v[88:91],v[56:59]
v_mfma_f32_16x16x32_bf16 v[52:55],a[92:95],v[88:91],v[52:55]
v_mfma_f32_16x16x32_bf16 v[56:59],a[220:223],v[88:91],v[56:59]
v_mfma_f32_16x16x32_bf16 v[52:55],a[96:99],v[88:91],v[52:55]
v_mfma_f32_16x16x32_bf16 v[56:59],a[224:227],v[88:91],v[56:59]
v_mfma_f32_16x16x32_bf16 v[52:55],a[100:103],v[88:91],v[52:55]
v_mfma_f32_16x16x32_bf16 v[56:59],a[228:231],v[88:91],v[56:59]
v_mfma_f32_16x16x32_bf16 v[52:55],a[104:107],v[88:91],v[52:55]
v_mfma_f32_16x16x32_bf16 v[56:59],a[232:235],v[88:91],v[56:59]
v_mfma_f32_16x16x32_bf16 v[52:55],a[108:111],v[88:91],v[52:55]
v_mfma_f32_16x16x32_bf16 v[56:59],a[236:239],v[88:91],v[56:59]
v_mfma_f32_16x16x32_bf16 v[52:55],a[112:115],v[88:91],v[52:55]
v_mfma_f32_16x16x32_bf16 v[56:59],a[240:243],v[88:91],v[56:59]
v_mfma_f32_16x16x32_bf16 v[52:55],a[116:119],v[88:91],v[52:55]
v_mfma_f32_16x16x32_bf16 v[56:59],a[244:247],v[88:91],v[56:59]
v_mfma_f32_16x16x32_bf16 v[52:55],a[120:123],v[88:91],v[52:55]
v_mfma_f32_16x16x32_bf16 v[56:59],a[248:251],v[88:91],v[56:59]
v_mfma_f32_16x16x32_bf16 v[52:55],a[124:127],v[88:91],v[52:55]
v_mfma_f32_16x16x32_bf16 v[56:59],a[252:255],v[88:91],v[56:59]
v_and_b32 v21,1,v1
v_mul_u32_u24 v21,960,v21
s_mov_b32 s65,21052032
s_mov_b32 s66,1792
pl_331:
buffer_load_dword v22,v21,s[20:23],s65 offen sc1
s_waitcnt vmcnt(0)
v_cmp_gt_u32 vcc,s66,v22
s_cbranch_vccz pok_332
s_sleep 1
s_sub_u32 s90,s90,1
s_cmp_gt_i32 s90,0
s_cbranch_scc1 pl_331
pok_332:
s_mov_b32 s81,0xbdd2d3e8
v_mov_b32 v28,0xc0135761
s_lshr_b32 s41,s59,3
s_and_b32 s42,s59,7
s_mul_i32 s64,s42,3
s_add_u32 s64,s64,s50
s_lshr_b32 s65,s42,1
s_add_u32 s65,s65,24
s_cmp_eq_u32 s50,3
s_cselect_b32 s64,s65,s64
s_and_b32 s65,s42,1
s_lshl_b32 s65,s65,3
s_cmp_eq_u32 s50,3
s_cselect_b32 s65,s65,0
s_and_b32 s66,s64,3
s_lshl_b32 s66,s66,11
s_add_u32 s65,s65,s66
s_lshr_b32 s64,s64,2
s_mul_i32 s66,s41,7
s_add_u32 s64,s64,s66
s_add_u32 s64,s64,81
s_lshl_b32 s64,s64,14
s_add_u32 s64,s64,s65
v_add_u32 v18,s64,v16
v_mov_b32 v17,v16
v_lshlrev_b32 v19,4,v3
v_add_u32 v19,131072,v19
v_and_b32 v21,7,v1
v_lshlrev_b32 v21,7,v21
v_bfe_u32 v6,v1,3,2
v_lshl_add_u32 v21,v6,2,v21
s_add_u32 s74,s63,6144
s_add_u32 s74,s74,s60
s_lshl_b32 s73,s59,7
s_lshl_b32 s64,s50,2
s_add_u32 s73,s73,s64
s_add_u32 s73,s73,s63
s_add_u32 s73,s73,20480
s_lshl_b32 s64,s60,4
s_add_u32 s73,s73,s64
s_mov_b32 s82,0x3a800000
s_mov_b32 s64,0
s_lshr_b32 s65,s50,1
s_and_b32 s66,s50,1
s_lshl_b32 s66,s66,12
s_add_u32 s66,s66,s64
s_lshl_b32 s72,s65,13
s_add_u32 s72,s72,s66
s_add_u32 s72,s72,0x10000
s_lshl_b32 s65,s65,14
s_add_u32 s75,s65,s66
s_add_u32 s75,s75,1179648
s_cmp_eq_u32 s50,3
s_cbranch_scc1 w3b_333
s_add_u32 s64,s79,0
s_lshl_b32 s70,s64,21
s_lshl_b32 s64,s64,13
s_and_b32 s64,s64,0x2000
s_xor_b32 s64,s64,s62
s_add_u32 s70,s70,s64
s_add_u32 s70,s70,29360128
s_mov_b32 s83,1
s_mov_b32 s87,s74
s_cmp_eq_u32 s50,0
s_cselect_b32 s74,s74,0x7fff0000
v_mov_b32 v47,132096
s_lshl_b32 s64,s50,3
s_add_u32 s64,s64,132096
v_mov_b32 v46,s64
v_mov_b32 v29,0
s_mov_b32 s97,0x7fff0000
seg_335:
s_cmp_eq_u32 s83,0
s_cbranch_scc1 ahead_336
s_add_u32 s94,s70,s75
s_xor_b32 s95,s94,1024
s_xor_b32 s91,s72,0x10000
s_waitcnt vmcnt(2)
v_cmp_gt_u32 vcc,s71,v29
s_cbranch_vccz nb_339
s_waitcnt vmcnt(0)
v_add_u32 v22,s71,-1
buffer_store_dword v22,v23,s[20:23],s97 offen sc1
s_mov_b32 s97,0x7fff0000
s_cmp_lg_u32 s50,0
s_cbranch_scc1 nb_339
buffer_load_dword v32,v21,s[20:23],s74 offen sc1
s_sleep 2
pl_340:
buffer_load_dword v33,v21,s[20:23],s74 offen sc1
s_waitcnt vmcnt(1)
v_cmp_gt_u32 vcc,s71,v32
v_mov_b32 v29,v32
s_cbranch_vccz pok_341
buffer_load_dword v32,v21,s[20:23],s74 offen sc1
s_waitcnt vmcnt(1)
v_cmp_gt_u32 vcc,s71,v33
v_mov_b32 v29,v33
s_cbranch_vccz pok_341
s_sub_u32 s90,s90,1
s_cmp_gt_i32 s90,0
s_cbranch_scc1 pl_340
pok_341:
nb_339:
s_barrier
s_xor_b32 m0,s91,0
s_add_u32 s65,s94,0
buffer_load_dwordx4 v16,s[20:23],s65 offen offset:0 sc1 lds
buffer_load_dwordx4 v16,s[20:23],s65 offen offset:2048 sc1 lds
s_xor_b32 m0,s91,16384
s_add_u32 s65,s94,32768
buffer_load_dwordx4 v16,s[20:23],s65 offen offset:0 sc1 lds
buffer_load_dwordx4 v16,s[20:23],s65 offen offset:2048 sc1 lds
s_xor_b32 m0,s91,32768
s_add_u32 s65,s94,65536
buffer_load_dwordx4 v16,s[20:23],s65 offen offset:0 sc1 lds
buffer_load_dwordx4 v16,s[20:23],s65 offen offset:2048 sc1 lds
s_xor_b32 m0,s91,49152
s_add_u32 s65,s94,98304
buffer_load_dwordx4 v16,s[20:23],s65 offen offset:0 sc1 lds
buffer_load_dwordx4 v16,s[20:23],s65 offen offset:2048 sc1 lds
s_waitcnt vmcnt(8)
v_add_u32 v22,s71,-1
buffer_store_dword v22,v23,s[20:23],s97 offen sc1
s_mov_b32 s97,0x7fff0000
s_waitcnt vmcnt(7)
s_barrier
ds_read_b128 v[224:227],v17 offset:0
ds_read_b128 v[228:231],v17 offset:2048
ds_read_b128 v[232:235],v17 offset:4096
ds_read_b128 v[236:239],v17 offset:6144
ds_read_b128 v[240:243],v17 offset:8192
ds_read_b128 v[244:247],v17 offset:10240
ds_read_b128 v[248:251],v17 offset:12288
s_waitcnt lgkmcnt(5)
v_mfma_f32_16x16x32_bf16 v[64:67],a[0:3],v[224:227],0
s_xor_b32 m0,s91,1024
s_add_u32 s96,s71,1
v_mfma_f32_16x16x32_bf16 v[72:75],a[128:131],v[224:227],0
ds_read_b128 v[252:255],v17 offset:14336
s_add_u32 s92,s71,2
v_mfma_f32_16x16x32_bf16 v[64:67],a[4:7],v[228:231],v[64:67]
s_add_u32 s65,s95,0
v_min_u32 v27,v224,v228
v_mfma_f32_16x16x32_bf16 v[72:75],a[132:135],v[228:231],v[72:75]
s_waitcnt vmcnt(5)
s_barrier
ds_read_b128 v[224:227],v17 offset:16384
s_waitcnt lgkmcnt(5)
v_mfma_f32_16x16x32_bf16 v[64:67],a[8:11],v[232:235],v[64:67]
buffer_load_dwordx4 v16,s[20:23],s65 offen offset:0 sc1 lds
v_mfma_f32_16x16x32_bf16 v[72:75],a[136:139],v[232:235],v[72:75]
ds_read_b128 v[228:231],v17 offset:18432
v_min3_u32 v27,v27,v232,v236
v_mfma_f32_16x16x32_bf16 v[64:67],a[12:15],v[236:239],v[64:67]
buffer_load_dwordx4 v16,s[20:23],s65 offen offset:2048 sc1 lds
v_mfma_f32_16x16x32_bf16 v[72:75],a[140:143],v[236:239],v[72:75]
ds_read_b128 v[232:235],v17 offset:20480
s_waitcnt lgkmcnt(5)
v_mfma_f32_16x16x32_bf16 v[64:67],a[16:19],v[240:243],v[64:67]
s_xor_b32 m0,s91,17408
v_min3_u32 v27,v27,v240,v244
v_mfma_f32_16x16x32_bf16 v[72:75],a[144:147],v[240:243],v[72:75]
ds_read_b128 v[236:239],v17 offset:22528
v_mfma_f32_16x16x32_bf16 v[64:67],a[20:23],v[244:247],v[64:67]
s_add_u32 s65,s95,32768
v_mfma_f32_16x16x32_bf16 v[72:75],a[148:151],v[244:247],v[72:75]
ds_read_b128 v[240:243],v17 offset:24576
s_waitcnt lgkmcnt(5)
v_mfma_f32_16x16x32_bf16 v[64:67],a[24:27],v[248:251],v[64:67]
buffer_load_dwordx4 v16,s[20:23],s65 offen offset:0 sc1 lds
v_mfma_f32_16x16x32_bf16 v[72:75],a[152:155],v[248:251],v[72:75]
ds_read_b128 v[244:247],v17 offset:26624
v_min3_u32 v27,v27,v248,v252
v_mfma_f32_16x16x32_bf16 v[64:67],a[28:31],v[252:255],v[64:67]
buffer_load_dwordx4 v16,s[20:23],s65 offen offset:2048 sc1 lds
v_mfma_f32_16x16x32_bf16 v[72:75],a[156:159],v[252:255],v[72:75]
ds_read_b128 v[248:251],v17 offset:28672
s_waitcnt lgkmcnt(5)
v_mfma_f32_16x16x32_bf16 v[64:67],a[32:35],v[224:227],v[64:67]
s_xor_b32 m0,s91,33792
v_min3_u32 v27,v27,v224,v228
v_mfma_f32_16x16x32_bf16 v[72:75],a[160:163],v[224:227],v[72:75]
ds_read_b128 v[252:255],v17 offset:30720
v_mfma_f32_16x16x32_bf16 v[64:67],a[36:39],v[228:231],v[64:67]
s_add_u32 s65,s95,65536
v_mfma_f32_16x16x32_bf16 v[72:75],a[164:167],v[228:231],v[72:75]
s_waitcnt vmcnt(5)
s_barrier
ds_read_b128 v[224:227],v17 offset:32768
s_waitcnt lgkmcnt(5)
v_mfma_f32_16x16x32_bf16 v[64:67],a[40:43],v[232:235],v[64:67]
buffer_load_dwordx4 v16,s[20:23],s65 offen offset:0 sc1 lds
v_mfma_f32_16x16x32_bf16 v[72:75],a[168:171],v[232:235],v[72:75]
ds_read_b128 v[228:231],v17 offset:34816
v_min3_u32 v27,v27,v232,v236
v_mfma_f32_16x16x32_bf16 v[64:67],a[44:47],v[236:239],v[64:67]
buffer_load_dwordx4 v16,s[20:23],s65 offen offset:2048 sc1 lds
v_mfma_f32_16x16x32_bf16 v[72:75],a[172:175],v[236:239],v[72:75]
ds_read_b128 v[232:235],v17 offset:36864
s_waitcnt lgkmcnt(5)
v_mfma_f32_16x16x32_bf16 v[64:67],a[48:51],v[240:243],v[64:67]
s_xor_b32 m0,s91,50176
v_min3_u32 v27,v27,v240,v244
v_mfma_f32_16x16x32_bf16 v[72:75],a[176:179],v[240:243],v[72:75]
ds_read_b128 v[236:239],v17 offset:38912
v_mfma_f32_16x16x32_bf16 v[64:67],a[52:55],v[244:247],v[64:67]
s_add_u32 s65,s95,98304
v_mfma_f32_16x16x32_bf16 v[72:75],a[180:183],v[244:247],v[72:75]
ds_read_b128 v[240:243],v17 offset:40960
s_waitcnt lgkmcnt(5)
v_mfma_f32_16x16x32_bf16 v[64:67],a[56:59],v[248:251],v[64:67]
buffer_load_dwordx4 v16,s[20:23],s65 offen offset:0 sc1 lds
v_min3_u32 v27,v27,v248,v252
v_mfma_f32_16x16x32_bf16 v[72:75],a[184:187],v[248:251],v[72:75]
ds_read_b128 v[244:247],v17 offset:43008
s_waitcnt vmcnt(63)
v_mfma_f32_16x16x32_bf16 v[64:67],a[60:63],v[252:255],v[64:67]
buffer_load_dwordx4 v16,s[20:23],s65 offen offset:2048 sc1 lds
v_mfma_f32_16x16x32_bf16 v[72:75],a[188:191],v[252:255],v[72:75]
ds_read_b128 v[248:251],v17 offset:45056
s_waitcnt lgkmcnt(5)
v_mfma_f32_16x16x32_bf16 v[64:67],a[64:67],v[224:227],v[64:67]
v_cmp_gt_u32 vcc,s96,v29
v_cmp_gt_u32 s[92:93],s92,v29
v_mfma_f32_16x16x32_bf16 v[72:75],a[192:195],v[224:227],v[72:75]
ds_read_b128 v[252:255],v17 offset:47104
v_min3_u32 v27,v27,v224,v228
v_mfma_f32_16x16x32_bf16 v[64:67],a[68:71],v[228:231],v[64:67]
v_mov_b32 v44,vcc_lo
v_mov_b32 v45,s92
v_mfma_f32_16x16x32_bf16 v[72:75],a[196:199],v[228:231],v[72:75]
ds_read_b128 v[224:227],v17 offset:49152
s_waitcnt lgkmcnt(5)
v_mfma_f32_16x16x32_bf16 v[64:67],a[72:75],v[232:235],v[64:67]
ds_write_b64 v46,v[44:45]
v_min3_u32 v27,v27,v232,v236
v_mfma_f32_16x16x32_bf16 v[72:75],a[200:203],v[232:235],v[72:75]
ds_read_b128 v[228:231],v17 offset:51200
v_mfma_f32_16x16x32_bf16 v[64:67],a[76:79],v[236:239],v[64:67]
v_mfma_f32_16x16x32_bf16 v[72:75],a[204:207],v[236:239],v[72:75]
ds_read_b128 v[232:235],v17 offset:53248
s_waitcnt lgkmcnt(6)
v_mfma_f32_16x16x32_bf16 v[64:67],a[80:83],v[240:243],v[64:67]
v_min3_u32 v27,v27,v240,v244
s_add_u32 s88,s70,s75
v_mfma_f32_16x16x32_bf16 v[72:75],a[208:211],v[240:243],v[72:75]
ds_read_b128 v[236:239],v17 offset:55296
s_add_u32 s88,s88,2097152
v_mfma_f32_16x16x32_bf16 v[64:67],a[84:87],v[244:247],v[64:67]
s_xor_b32 s88,s88,0x2000
s_xor_b32 s89,s88,1024
v_mfma_f32_16x16x32_bf16 v[72:75],a[212:215],v[244:247],v[72:75]
ds_read_b128 v[240:243],v17 offset:57344
s_waitcnt lgkmcnt(6)
v_mfma_f32_16x16x32_bf16 v[64:67],a[88:91],v[248:251],v[64:67]
v_min3_u32 v27,v27,v248,v252
v_mfma_f32_16x16x32_bf16 v[72:75],a[216:219],v[248:251],v[72:75]
ds_read_b128 v[244:247],v17 offset:59392
v_mfma_f32_16x16x32_bf16 v[64:67],a[92:95],v[252:255],v[64:67]
v_mfma_f32_16x16x32_bf16 v[72:75],a[220:223],v[252:255],v[72:75]
ds_read_b128 v[248:251],v17 offset:61440
s_waitcnt lgkmcnt(5)
v_mfma_f32_16x16x32_bf16 v[64:67],a[96:99],v[224:227],v[64:67]
v_min3_u32 v27,v27,v224,v228
v_mfma_f32_16x16x32_bf16 v[72:75],a[224:227],v[224:227],v[72:75]
ds_read_b128 v[252:255],v17 offset:63488
v_mfma_f32_16x16x32_bf16 v[64:67],a[100:103],v[228:231],v[64:67]
v_mfma_f32_16x16x32_bf16 v[72:75],a[228:231],v[228:231],v[72:75]
s_waitcnt vmcnt(4)
s_barrier
ds_read_b64 v[44:45],v47
ds_read_b128 v[224:227],v17 offset:1024
s_waitcnt lgkmcnt(6)
v_mfma_f32_16x16x32_bf16 v[64:67],a[104:107],v[232:235],v[64:67]
v_min3_u32 v27,v27,v232,v236
ds_read_b128 v[124:127],v19 offset:256
v_mfma_f32_16x16x32_bf16 v[72:75],a[232:235],v[232:235],v[72:75]
ds_read_b128 v[228:231],v17 offset:3072
ds_read_b128 v[120:123],v19 offset:0
v_mfma_f32_16x16x32_bf16 v[64:67],a[108:111],v[236:239],v[64:67]
v_mfma_f32_16x16x32_bf16 v[72:75],a[236:239],v[236:239],v[72:75]
ds_read_b128 v[232:235],v17 offset:5120
s_waitcnt lgkmcnt(8)
v_mfma_f32_16x16x32_bf16 v[64:67],a[112:115],v[240:243],v[64:67]
v_min3_u32 v27,v27,v240,v244
v_mfma_f32_16x16x32_bf16 v[72:75],a[240:243],v[240:243],v[72:75]
ds_read_b128 v[236:239],v17 offset:7168
v_mfma_f32_16x16x32_bf16 v[64:67],a[116:119],v[244:247],v[64:67]
v_mfma_f32_16x16x32_bf16 v[72:75],a[244:247],v[244:247],v[72:75]
ds_read_b128 v[240:243],v17 offset:9216
s_waitcnt lgkmcnt(8)
v_mfma_f32_16x16x32_bf16 v[64:67],a[120:123],v[248:251],v[64:67]
s_waitcnt lgkmcnt(7)
v_readfirstlane_b32 s93,v45
v_mfma_f32_16x16x32_bf16 v[72:75],a[248:251],v[248:251],v[72:75]
ds_read_b128 v[244:247],v17 offset:11264
v_readfirstlane_b32 s83,v44
s_cmp_lg_u32 s83,0
s_cbranch_scc0 keep_342
v_mfma_f32_16x16x32_bf16 v[64:67],a[124:127],v[252:255],v[64:67]
v_min3_u32 v27,v27,v248,v252
v_mfma_f32_16x16x32_bf16 v[72:75],a[252:255],v[252:255],v[72:75]
ds_read_b128 v[248:251],v17 offset:13312
s_waitcnt lgkmcnt(6)
v_mfma_f32_16x16x32_bf16 v[68:71],a[0:3],v[224:227],0
v_cmp_eq_u32 vcc,0,v27
s_cbranch_vccnz retry_334
v_mfma_f32_16x16x32_bf16 v[76:79],a[128:131],v[224:227],0
ds_read_b128 v[252:255],v17 offset:15360
v_min3_u32 v27,v27,v224,v228
v_mfma_f32_16x16x32_bf16 v[68:71],a[4:7],v[228:231],v[68:71]
s_waitcnt lgkmcnt(6)
v_mfma_f32_16x16x32_bf16 v[76:79],a[132:135],v[228:231],v[76:79]
ds_read_b128 v[224:227],v17 offset:17408
s_waitcnt lgkmcnt(5)
v_mfma_f32_16x16x32_bf16 v[68:71],a[8:11],v[232:235],v[68:71]
v_min3_u32 v27,v27,v232,v236
v_fmac_f32 v64,v52,v120
v_fmac_f32 v72,v56,v120
v_mfma_f32_16x16x32_bf16 v[76:79],a[136:139],v[232:235],v[76:79]
ds_read_b128 v[228:231],v17 offset:19456
v_fmac_f32 v65,v53,v120
v_fmac_f32 v73,v57,v120
v_mfma_f32_16x16x32_bf16 v[68:71],a[12:15],v[236:239],v[68:71]
v_fmac_f32 v66,v54,v120
v_fmac_f32 v67,v55,v120
v_fmac_f32 v74,v58,v120
v_mfma_f32_16x16x32_bf16 v[76:79],a[140:143],v[236:239],v[76:79]
ds_read_b128 v[232:235],v17 offset:21504
v_fmac_f32 v75,v59,v120
s_waitcnt lgkmcnt(5)
v_mfma_f32_16x16x32_bf16 v[68:71],a[16:19],v[240:243],v[68:71]
v_min3_u32 v27,v27,v240,v244
v_mul_f32 v88,v64,v64
v_mul_f32 v92,v72,v72
v_mfma_f32_16x16x32_bf16 v[76:79],a[144:147],v[240:243],v[76:79]
ds_read_b128 v[236:239],v17 offset:23552
v_mul_f32 v89,v65,v65
v_mul_f32 v93,v73,v73
v_mfma_f32_16x16x32_bf16 v[68:71],a[20:23],v[244:247],v[68:71]
v_mul_f32 v90,v66,v66
v_mul_f32 v91,v67,v67
v_mul_f32 v94,v74,v74
v_mfma_f32_16x16x32_bf16 v[76:79],a[148:151],v[244:247],v[76:79]
ds_read_b128 v[240:243],v17 offset:25600
v_mul_f32 v95,v75,v75
s_waitcnt lgkmcnt(5)
v_mfma_f32_16x16x32_bf16 v[68:71],a[24:27],v[248:251],v[68:71]
v_min3_u32 v27,v27,v248,v252
v_fma_f32 v88,v88,v121,v122
v_fma_f32 v92,v92,v121,v122
v_mfma_f32_16x16x32_bf16 v[76:79],a[152:155],v[248:251],v[76:79]
ds_read_b128 v[244:247],v17 offset:27648
v_fma_f32 v89,v89,v121,v122
v_fma_f32 v93,v93,v121,v122
v_mfma_f32_16x16x32_bf16 v[68:71],a[28:31],v[252:255],v[68:71]
v_fma_f32 v90,v90,v121,v122
v_fma_f32 v91,v91,v121,v122
v_fma_f32 v94,v94,v121,v122
v_mfma_f32_16x16x32_bf16 v[76:79],a[156:159],v[252:255],v[76:79]
ds_read_b128 v[248:251],v17 offset:29696
v_fma_f32 v95,v95,v121,v122
s_waitcnt lgkmcnt(5)
v_mfma_f32_16x16x32_bf16 v[68:71],a[32:35],v[224:227],v[68:71]
v_min3_u32 v27,v27,v224,v228
v_mul_f32 v88,v88,v64
v_mul_f32 v92,v92,v72
v_mfma_f32_16x16x32_bf16 v[76:79],a[160:163],v[224:227],v[76:79]
ds_read_b128 v[252:255],v17 offset:31744
v_mul_f32 v89,v89,v65
v_mul_f32 v93,v93,v73
v_mfma_f32_16x16x32_bf16 v[68:71],a[36:39],v[228:231],v[68:71]
v_mul_f32 v90,v90,v66
v_mul_f32 v91,v91,v67
v_mul_f32 v94,v94,v74
v_mfma_f32_16x16x32_bf16 v[76:79],a[164:167],v[228:231],v[76:79]
s_waitcnt vmcnt(0)
s_barrier
ds_read_b128 v[224:227],v17 offset:33792
s_waitcnt lgkmcnt(5)
v_mfma_f32_16x16x32_bf16 v[68:71],a[40:43],v[232:235],v[68:71]
v_min3_u32 v27,v27,v232,v236
v_mul_f32 v95,v95,v75
v_mfma_f32_16x16x32_bf16 v[76:79],a[168:171],v[232:235],v[76:79]
ds_read_b128 v[228:231],v17 offset:35840
v_exp_f32 v92,v92
v_mfma_f32_16x16x32_bf16 v[68:71],a[44:47],v[236:239],v[68:71]
v_exp_f32 v88,v88
v_mfma_f32_16x16x32_bf16 v[76:79],a[172:175],v[236:239],v[76:79]
ds_read_b128 v[232:235],v17 offset:37888
s_waitcnt lgkmcnt(5)
v_mfma_f32_16x16x32_bf16 v[68:71],a[48:51],v[240:243],v[68:71]
v_min3_u32 v27,v27,v240,v244
v_exp_f32 v93,v93
v_mfma_f32_16x16x32_bf16 v[76:79],a[176:179],v[240:243],v[76:79]
ds_read_b128 v[236:239],v17 offset:39936
v_exp_f32 v94,v94
v_mfma_f32_16x16x32_bf16 v[68:71],a[52:55],v[244:247],v[68:71]
v_exp_f32 v89,v89
v_mfma_f32_16x16x32_bf16 v[76:79],a[180:183],v[244:247],v[76:79]
ds_read_b128 v[240:243],v17 offset:41984
s_waitcnt lgkmcnt(5)
v_mfma_f32_16x16x32_bf16 v[68:71],a[56:59],v[248:251],v[68:71]
v_min3_u32 v27,v27,v248,v252
v_exp_f32 v95,v95
v_mfma_f32_16x16x32_bf16 v[76:79],a[184:187],v[248:251],v[76:79]
ds_read_b128 v[244:247],v17 offset:44032
v_fma_f32 v92,v92,v123,v123
v_fma_f32 v93,v93,v123,v123
v_mfma_f32_16x16x32_bf16 v[68:71],a[60:63],v[252:255],v[68:71]
v_exp_f32 v90,v90
v_fma_f32 v94,v94,v123,v123
v_mfma_f32_16x16x32_bf16 v[76:79],a[188:191],v[252:255],v[76:79]
ds_read_b128 v[248:251],v17 offset:46080
v_fma_f32 v95,v95,v123,v123
s_waitcnt lgkmcnt(5)
v_mfma_f32_16x16x32_bf16 v[68:71],a[64:67],v[224:227],v[68:71]
v_min3_u32 v27,v27,v224,v228
v_rcp_f32 v92,v92
v_mfma_f32_16x16x32_bf16 v[76:79],a[192:195],v[224:227],v[76:79]
ds_read_b128 v[252:255],v17 offset:48128
v_rcp_f32 v93,v93
v_mfma_f32_16x16x32_bf16 v[68:71],a[68:71],v[228:231],v[68:71]
v_exp_f32 v91,v91
v_mfma_f32_16x16x32_bf16 v[76:79],a[196:199],v[228:231],v[76:79]
ds_read_b128 v[224:227],v17 offset:50176
s_waitcnt lgkmcnt(5)
v_mfma_f32_16x16x32_bf16 v[68:71],a[72:75],v[232:235],v[68:71]
v_min3_u32 v27,v27,v232,v236
v_fma_f32 v88,v88,v123,v123
v_mfma_f32_16x16x32_bf16 v[76:79],a[200:203],v[232:235],v[76:79]
ds_read_b128 v[228:231],v17 offset:52224
v_fma_f32 v89,v89,v123,v123
v_mfma_f32_16x16x32_bf16 v[68:71],a[76:79],v[236:239],v[68:71]
v_fma_f32 v90,v90,v123,v123
v_fma_f32 v91,v91,v123,v123
v_mfma_f32_16x16x32_bf16 v[76:79],a[204:207],v[236:239],v[76:79]
ds_read_b128 v[232:235],v17 offset:54272
s_waitcnt lgkmcnt(5)
v_mfma_f32_16x16x32_bf16 v[68:71],a[80:83],v[240:243],v[68:71]
v_min3_u32 v27,v27,v240,v244
v_rcp_f32 v94,v94
v_mfma_f32_16x16x32_bf16 v[76:79],a[208:211],v[240:243],v[76:79]
ds_read_b128 v[236:239],v17 offset:56320
v_rcp_f32 v95,v95
v_mfma_f32_16x16x32_bf16 v[68:71],a[84:87],v[244:247],v[68:71]
v_rcp_f32 v88,v88
v_mfma_f32_16x16x32_bf16 v[76:79],a[212:215],v[244:247],v[76:79]
ds_read_b128 v[240:243],v17 offset:58368
s_waitcnt lgkmcnt(5)
v_mfma_f32_16x16x32_bf16 v[68:71],a[88:91],v[248:251],v[68:71]
v_min3_u32 v27,v27,v248,v252
v_mul_f32 v92,v92,v72
v_mfma_f32_16x16x32_bf16 v[76:79],a[216:219],v[248:251],v[76:79]
ds_read_b128 v[244:247],v17 offset:60416
v_mul_f32 v93,v93,v73
v_mfma_f32_16x16x32_bf16 v[68:71],a[92:95],v[252:255],v[68:71]
v_rcp_f32 v89,v89
v_mfma_f32_16x16x32_bf16 v[76:79],a[220:223],v[252:255],v[76:79]
ds_read_b128 v[248:251],v17 offset:62464
s_waitcnt lgkmcnt(5)
v_mfma_f32_16x16x32_bf16 v[68:71],a[96:99],v[224:227],v[68:71]
v_min3_u32 v27,v27,v224,v228
v_mul_f32 v94,v94,v74
v_mfma_f32_16x16x32_bf16 v[76:79],a[224:227],v[224:227],v[76:79]
ds_read_b128 v[252:255],v17 offset:64512
v_mul_f32 v95,v95,v75
v_mfma_f32_16x16x32_bf16 v[68:71],a[100:103],v[228:231],v[68:71]
v_rcp_f32 v90,v90
v_mfma_f32_16x16x32_bf16 v[76:79],a[228:231],v[228:231],v[76:79]
s_waitcnt lgkmcnt(4)
v_mfma_f32_16x16x32_bf16 v[68:71],a[104:107],v[232:235],v[68:71]
v_min3_u32 v27,v27,v232,v236
v_mfma_f32_16x16x32_bf16 v[76:79],a[232:235],v[232:235],v[76:79]
v_rcp_f32 v91,v91
v_mfma_f32_16x16x32_bf16 v[68:71],a[108:111],v[236:239],v[68:71]
v_mul_f32 v88,v88,v64
v_mul_f32 v89,v89,v65
v_mfma_f32_16x16x32_bf16 v[76:79],a[236:239],v[236:239],v[76:79]
v_mul_f32 v90,v90,v66
s_waitcnt lgkmcnt(2)
v_mfma_f32_16x16x32_bf16 v[68:71],a[112:115],v[240:243],v[68:71]
v_min3_u32 v27,v27,v240,v244
v_mul_f32 v91,v91,v67
v_mfma_f32_16x16x32_bf16 v[76:79],a[240:243],v[240:243],v[76:79]
v_cvt_pk_bf16_f32 v96,v88,v89
v_cvt_pk_bf16_f32 v97,v90,v91
v_mfma_f32_16x16x32_bf16 v[68:71],a[116:119],v[244:247],v[68:71]
v_cvt_pk_bf16_f32 v98,v92,v93
v_cvt_pk_bf16_f32 v99,v94,v95
v_mfma_f32_16x16x32_bf16 v[76:79],a[244:247],v[244:247],v[76:79]
v_max_u32 v96,1,v96
s_waitcnt lgkmcnt(0)
v_mfma_f32_16x16x32_bf16 v[68:71],a[120:123],v[248:251],v[68:71]
v_min3_u32 v27,v27,v248,v252
v_mfma_f32_16x16x32_bf16 v[76:79],a[248:251],v[248:251],v[76:79]
buffer_store_dwordx4 v[96:99],v18,s[20:23],s70 offen offset:0 sc1
v_mfma_f32_16x16x32_bf16 v[68:71],a[124:127],v[252:255],v[68:71]
v_mfma_f32_16x16x32_bf16 v[76:79],a[252:255],v[252:255],v[76:79]
v_cmp_eq_u32 vcc,0,v27
s_cbranch_vccnz retry_334
s_branch epi_337
keep_342:
v_mfma_f32_16x16x32_bf16 v[64:67],a[124:127],v[252:255],v[64:67]
v_min3_u32 v27,v27,v248,v252
s_xor_b32 m0,s72,0
v_mfma_f32_16x16x32_bf16 v[72:75],a[252:255],v[252:255],v[72:75]
ds_read_b128 v[248:251],v17 offset:13312
s_waitcnt lgkmcnt(6)
v_mfma_f32_16x16x32_bf16 v[68:71],a[0:3],v[224:227],0
s_add_u32 s65,s88,0
v_cmp_eq_u32 vcc,0,v27
s_cbranch_vccnz retry_334
v_mfma_f32_16x16x32_bf16 v[76:79],a[128:131],v[224:227],0
ds_read_b128 v[252:255],v17 offset:15360
v_min3_u32 v27,v27,v224,v228
s_waitcnt lgkmcnt(6)
v_mfma_f32_16x16x32_bf16 v[68:71],a[4:7],v[228:231],v[68:71]
buffer_load_dwordx4 v16,s[20:23],s65 offen offset:0 sc1 lds
v_mfma_f32_16x16x32_bf16 v[76:79],a[132:135],v[228:231],v[76:79]
ds_read_b128 v[224:227],v17 offset:17408
s_waitcnt lgkmcnt(5)
v_mfma_f32_16x16x32_bf16 v[68:71],a[8:11],v[232:235],v[68:71]
buffer_load_dwordx4 v16,s[20:23],s65 offen offset:2048 sc1 lds
v_fmac_f32 v64,v52,v120
v_fmac_f32 v65,v53,v120
v_mfma_f32_16x16x32_bf16 v[76:79],a[136:139],v[232:235],v[76:79]
ds_read_b128 v[228:231],v17 offset:19456
s_xor_b32 m0,s72,16384
v_fmac_f32 v66,v54,v120
v_fmac_f32 v67,v55,v120
v_mfma_f32_16x16x32_bf16 v[68:71],a[12:15],v[236:239],v[68:71]
s_add_u32 s65,s88,32768
v_min3_u32 v27,v27,v232,v236
v_mul_f32 v88,v64,v64
v_mul_f32 v89,v65,v65
v_mfma_f32_16x16x32_bf16 v[76:79],a[140:143],v[236:239],v[76:79]
ds_read_b128 v[232:235],v17 offset:21504
v_mul_f32 v90,v66,v66
v_mul_f32 v91,v67,v67
s_waitcnt lgkmcnt(5)
v_mfma_f32_16x16x32_bf16 v[68:71],a[16:19],v[240:243],v[68:71]
buffer_load_dwordx4 v16,s[20:23],s65 offen offset:0 sc1 lds
v_fma_f32 v88,v88,v121,v122
v_fma_f32 v89,v89,v121,v122
v_mfma_f32_16x16x32_bf16 v[76:79],a[144:147],v[240:243],v[76:79]
ds_read_b128 v[236:239],v17 offset:23552
v_min3_u32 v27,v27,v240,v244
v_fma_f32 v90,v90,v121,v122
v_fma_f32 v91,v91,v121,v122
v_mfma_f32_16x16x32_bf16 v[68:71],a[20:23],v[244:247],v[68:71]
buffer_load_dwordx4 v16,s[20:23],s65 offen offset:2048 sc1 lds
v_mul_f32 v88,v88,v64
v_mul_f32 v89,v89,v65
v_mfma_f32_16x16x32_bf16 v[76:79],a[148:151],v[244:247],v[76:79]
ds_read_b128 v[240:243],v17 offset:25600
v_mul_f32 v90,v90,v66
v_mul_f32 v91,v91,v67
s_waitcnt lgkmcnt(5)
v_mfma_f32_16x16x32_bf16 v[68:71],a[24:27],v[248:251],v[68:71]
s_xor_b32 m0,s72,32768
s_add_u32 s65,s88,65536
v_exp_f32 v88,v88
v_mfma_f32_16x16x32_bf16 v[76:79],a[152:155],v[248:251],v[76:79]
ds_read_b128 v[244:247],v17 offset:27648
v_min3_u32 v27,v27,v248,v252
v_exp_f32 v89,v89
v_mfma_f32_16x16x32_bf16 v[68:71],a[28:31],v[252:255],v[68:71]
buffer_load_dwordx4 v16,s[20:23],s65 offen offset:0 sc1 lds
v_exp_f32 v90,v90
v_mfma_f32_16x16x32_bf16 v[76:79],a[156:159],v[252:255],v[76:79]
ds_read_b128 v[248:251],v17 offset:29696
v_exp_f32 v91,v91
s_waitcnt lgkmcnt(5)
v_mfma_f32_16x16x32_bf16 v[68:71],a[32:35],v[224:227],v[68:71]
buffer_load_dwordx4 v16,s[20:23],s65 offen offset:2048 sc1 lds
v_fma_f32 v88,v88,v123,v123
v_fma_f32 v89,v89,v123,v123
v_mfma_f32_16x16x32_bf16 v[76:79],a[160:163],v[224:227],v[76:79]
ds_read_b128 v[252:255],v17 offset:31744
s_xor_b32 m0,s72,49152
v_fma_f32 v90,v90,v123,v123
v_fma_f32 v91,v91,v123,v123
v_mfma_f32_16x16x32_bf16 v[68:71],a[36:39],v[228:231],v[68:71]
v_min3_u32 v27,v27,v224,v228
v_rcp_f32 v88,v88
v_fmac_f32 v72,v56,v120
v_mfma_f32_16x16x32_bf16 v[76:79],a[164:167],v[228:231],v[76:79]
s_waitcnt vmcnt(6)
s_barrier
ds_read_b128 v[224:227],v17 offset:33792
s_waitcnt lgkmcnt(5)
v_mfma_f32_16x16x32_bf16 v[68:71],a[40:43],v[232:235],v[68:71]
s_add_u32 s65,s88,98304
v_min3_u32 v27,v27,v232,v236
v_fmac_f32 v73,v57,v120
v_fmac_f32 v74,v58,v120
v_mfma_f32_16x16x32_bf16 v[76:79],a[168:171],v[232:235],v[76:79]
ds_read_b128 v[228:231],v17 offset:35840
v_fmac_f32 v75,v59,v120
v_mul_f32 v92,v72,v72
v_mul_f32 v93,v73,v73
v_mfma_f32_16x16x32_bf16 v[68:71],a[44:47],v[236:239],v[68:71]
buffer_load_dwordx4 v16,s[20:23],s65 offen offset:0 sc1 lds
v_mul_f32 v94,v74,v74
v_mul_f32 v95,v75,v75
v_mfma_f32_16x16x32_bf16 v[76:79],a[172:175],v[236:239],v[76:79]
ds_read_b128 v[232:235],v17 offset:37888
v_fma_f32 v92,v92,v121,v122
v_fma_f32 v93,v93,v121,v122
s_waitcnt lgkmcnt(5)
v_mfma_f32_16x16x32_bf16 v[68:71],a[48:51],v[240:243],v[68:71]
buffer_load_dwordx4 v16,s[20:23],s65 offen offset:2048 sc1 lds
v_fma_f32 v94,v94,v121,v122
v_fma_f32 v95,v95,v121,v122
v_mfma_f32_16x16x32_bf16 v[76:79],a[176:179],v[240:243],v[76:79]
ds_read_b128 v[236:239],v17 offset:39936
s_xor_b32 m0,s72,1024
v_mul_f32 v92,v92,v72
v_mul_f32 v93,v93,v73
v_mfma_f32_16x16x32_bf16 v[68:71],a[52:55],v[244:247],v[68:71]
s_add_u32 s65,s89,0
v_min3_u32 v27,v27,v240,v244
v_mul_f32 v94,v94,v74
v_mul_f32 v95,v95,v75
v_mfma_f32_16x16x32_bf16 v[76:79],a[180:183],v[244:247],v[76:79]
ds_read_b128 v[240:243],v17 offset:41984
v_exp_f32 v92,v92
s_waitcnt lgkmcnt(5)
v_mfma_f32_16x16x32_bf16 v[68:71],a[56:59],v[248:251],v[68:71]
buffer_load_dwordx4 v16,s[20:23],s65 offen offset:0 sc1 lds
v_exp_f32 v93,v93
v_mfma_f32_16x16x32_bf16 v[76:79],a[184:187],v[248:251],v[76:79]
ds_read_b128 v[244:247],v17 offset:44032
v_min3_u32 v27,v27,v248,v252
v_exp_f32 v94,v94
v_mfma_f32_16x16x32_bf16 v[68:71],a[60:63],v[252:255],v[68:71]
buffer_load_dwordx4 v16,s[20:23],s65 offen offset:2048 sc1 lds
v_exp_f32 v95,v95
v_mfma_f32_16x16x32_bf16 v[76:79],a[188:191],v[252:255],v[76:79]
ds_read_b128 v[248:251],v17 offset:46080
v_fma_f32 v92,v92,v123,v123
v_fma_f32 v93,v93,v123,v123
s_waitcnt lgkmcnt(5)
v_mfma_f32_16x16x32_bf16 v[68:71],a[64:67],v[224:227],v[68:71]
s_xor_b32 m0,s72,17408
s_add_u32 s65,s89,32768
v_fma_f32 v94,v94,v123,v123
v_fma_f32 v95,v95,v123,v123
v_mfma_f32_16x16x32_bf16 v[76:79],a[192:195],v[224:227],v[76:79]
ds_read_b128 v[252:255],v17 offset:48128
v_min3_u32 v27,v27,v224,v228
v_rcp_f32 v92,v92
v_mfma_f32_16x16x32_bf16 v[68:71],a[68:71],v[228:231],v[68:71]
buffer_load_dwordx4 v16,s[20:23],s65 offen offset:0 sc1 lds
v_rcp_f32 v93,v93
v_mfma_f32_16x16x32_bf16 v[76:79],a[196:199],v[228:231],v[76:79]
ds_read_b128 v[224:227],v17 offset:50176
v_rcp_f32 v94,v94
s_waitcnt lgkmcnt(5)
v_mfma_f32_16x16x32_bf16 v[68:71],a[72:75],v[232:235],v[68:71]
buffer_load_dwordx4 v16,s[20:23],s65 offen offset:2048 sc1 lds
v_rcp_f32 v95,v95
v_mfma_f32_16x16x32_bf16 v[76:79],a[200:203],v[232:235],v[76:79]
ds_read_b128 v[228:231],v17 offset:52224
s_xor_b32 m0,s72,33792
v_mfma_f32_16x16x32_bf16 v[68:71],a[76:79],v[236:239],v[68:71]
s_add_u32 s65,s89,65536
v_min3_u32 v27,v27,v232,v236
v_mfma_f32_16x16x32_bf16 v[76:79],a[204:207],v[236:239],v[76:79]
ds_read_b128 v[232:235],v17 offset:54272
s_waitcnt lgkmcnt(5)
v_mfma_f32_16x16x32_bf16 v[68:71],a[80:83],v[240:243],v[68:71]
buffer_load_dwordx4 v16,s[20:23],s65 offen offset:0 sc1 lds
v_mfma_f32_16x16x32_bf16 v[76:79],a[208:211],v[240:243],v[76:79]
ds_read_b128 v[236:239],v17 offset:56320
v_min3_u32 v27,v27,v240,v244
v_mfma_f32_16x16x32_bf16 v[68:71],a[84:87],v[244:247],v[68:71]
buffer_load_dwordx4 v16,s[20:23],s65 offen offset:2048 sc1 lds
v_mfma_f32_16x16x32_bf16 v[76:79],a[212:215],v[244:247],v[76:79]
ds_read_b128 v[240:243],v17 offset:58368
s_waitcnt lgkmcnt(5)
v_mfma_f32_16x16x32_bf16 v[68:71],a[88:91],v[248:251],v[68:71]
s_xor_b32 m0,s72,50176
v_min3_u32 v27,v27,v248,v252
v_mfma_f32_16x16x32_bf16 v[76:79],a[216:219],v[248:251],v[76:79]
ds_read_b128 v[244:247],v17 offset:60416
s_add_u32 s65,s89,98304
v_mfma_f32_16x16x32_bf16 v[68:71],a[92:95],v[252:255],v[68:71]
buffer_load_dwordx4 v16,s[20:23],s65 offen offset:0 sc1 lds
v_mfma_f32_16x16x32_bf16 v[76:79],a[220:223],v[252:255],v[76:79]
ds_read_b128 v[248:251],v17 offset:62464
s_waitcnt lgkmcnt(5)
v_mfma_f32_16x16x32_bf16 v[68:71],a[96:99],v[224:227],v[68:71]
buffer_load_dwordx4 v16,s[20:23],s65 offen offset:2048 sc1 lds
v_mfma_f32_16x16x32_bf16 v[76:79],a[224:227],v[224:227],v[76:79]
ds_read_b128 v[252:255],v17 offset:64512
v_min3_u32 v27,v27,v224,v228
v_mfma_f32_16x16x32_bf16 v[68:71],a[100:103],v[228:231],v[68:71]
v_rcp_f32 v89,v89
v_mfma_f32_16x16x32_bf16 v[76:79],a[228:231],v[228:231],v[76:79]
v_mul_f32 v92,v92,v72
s_waitcnt lgkmcnt(4)
v_mfma_f32_16x16x32_bf16 v[68:71],a[104:107],v[232:235],v[68:71]
v_min3_u32 v27,v27,v232,v236
v_mul_f32 v93,v93,v73
v_mfma_f32_16x16x32_bf16 v[76:79],a[232:235],v[232:235],v[76:79]
v_rcp_f32 v90,v90
v_mfma_f32_16x16x32_bf16 v[68:71],a[108:111],v[236:239],v[68:71]
v_rcp_f32 v91,v91
v_mfma_f32_16x16x32_bf16 v[76:79],a[236:239],v[236:239],v[76:79]
v_mul_f32 v88,v88,v64
s_waitcnt lgkmcnt(2)
v_mfma_f32_16x16x32_bf16 v[68:71],a[112:115],v[240:243],v[68:71]
v_min3_u32 v27,v27,v240,v244
v_mul_f32 v89,v89,v65
v_mfma_f32_16x16x32_bf16 v[76:79],a[240:243],v[240:243],v[76:79]
v_mul_f32 v90,v90,v66
v_mul_f32 v91,v91,v67
v_mfma_f32_16x16x32_bf16 v[68:71],a[116:119],v[244:247],v[68:71]
v_mul_f32 v94,v94,v74
v_mul_f32 v95,v95,v75
v_mfma_f32_16x16x32_bf16 v[76:79],a[244:247],v[244:247],v[76:79]
v_cvt_pk_bf16_f32 v96,v88,v89
s_waitcnt lgkmcnt(0)
v_mfma_f32_16x16x32_bf16 v[68:71],a[120:123],v[248:251],v[68:71]
v_min3_u32 v27,v27,v248,v252
v_cvt_pk_bf16_f32 v97,v90,v91
v_mfma_f32_16x16x32_bf16 v[76:79],a[248:251],v[248:251],v[76:79]
v_cvt_pk_bf16_f32 v98,v92,v93
v_cvt_pk_bf16_f32 v99,v94,v95
v_mfma_f32_16x16x32_bf16 v[68:71],a[124:127],v[252:255],v[68:71]
v_max_u32 v96,1,v96
v_mfma_f32_16x16x32_bf16 v[76:79],a[252:255],v[252:255],v[76:79]
buffer_store_dwordx4 v[96:99],v18,s[20:23],s70 offen offset:0 sc1
v_cmp_eq_u32 vcc,0,v27
s_cbranch_vccnz retry_334
s_branch epi_337
ahead_336:
s_cmp_eq_u32 s93,0
s_cbranch_scc1 both_338
s_waitcnt vmcnt(12) lgkmcnt(0)
s_barrier
ds_read_b128 v[224:227],v17 offset:0
ds_read_b128 v[228:231],v17 offset:2048
ds_read_b128 v[232:235],v17 offset:4096
ds_read_b128 v[236:239],v17 offset:6144
ds_read_b128 v[240:243],v17 offset:8192
ds_read_b128 v[244:247],v17 offset:10240
ds_read_b128 v[248:251],v17 offset:12288
s_waitcnt lgkmcnt(5)
v_mfma_f32_16x16x32_bf16 v[64:67],a[0:3],v[224:227],0
s_add_u32 s96,s71,1
s_add_u32 s92,s71,2
v_mfma_f32_16x16x32_bf16 v[72:75],a[128:131],v[224:227],0
ds_read_b128 v[252:255],v17 offset:14336
v_min_u32 v27,v224,v228
v_mfma_f32_16x16x32_bf16 v[64:67],a[4:7],v[228:231],v[64:67]
v_mfma_f32_16x16x32_bf16 v[72:75],a[132:135],v[228:231],v[72:75]
ds_read_b128 v[224:227],v17 offset:16384
s_waitcnt lgkmcnt(5)
v_mfma_f32_16x16x32_bf16 v[64:67],a[8:11],v[232:235],v[64:67]
v_min3_u32 v27,v27,v232,v236
v_mfma_f32_16x16x32_bf16 v[72:75],a[136:139],v[232:235],v[72:75]
ds_read_b128 v[228:231],v17 offset:18432
v_mfma_f32_16x16x32_bf16 v[64:67],a[12:15],v[236:239],v[64:67]
v_mfma_f32_16x16x32_bf16 v[72:75],a[140:143],v[236:239],v[72:75]
ds_read_b128 v[232:235],v17 offset:20480
s_waitcnt lgkmcnt(5)
v_mfma_f32_16x16x32_bf16 v[64:67],a[16:19],v[240:243],v[64:67]
v_min3_u32 v27,v27,v240,v244
v_mfma_f32_16x16x32_bf16 v[72:75],a[144:147],v[240:243],v[72:75]
ds_read_b128 v[236:239],v17 offset:22528
v_mfma_f32_16x16x32_bf16 v[64:67],a[20:23],v[244:247],v[64:67]
v_mfma_f32_16x16x32_bf16 v[72:75],a[148:151],v[244:247],v[72:75]
ds_read_b128 v[240:243],v17 offset:24576
s_waitcnt lgkmcnt(5)
v_mfma_f32_16x16x32_bf16 v[64:67],a[24:27],v[248:251],v[64:67]
v_min3_u32 v27,v27,v248,v252
v_mfma_f32_16x16x32_bf16 v[72:75],a[152:155],v[248:251],v[72:75]
ds_read_b128 v[244:247],v17 offset:26624
v_mfma_f32_16x16x32_bf16 v[64:67],a[28:31],v[252:255],v[64:67]
v_mfma_f32_16x16x32_bf16 v[72:75],a[156:159],v[252:255],v[72:75]
ds_read_b128 v[248:251],v17 offset:28672
s_waitcnt lgkmcnt(5)
v_mfma_f32_16x16x32_bf16 v[64:67],a[32:35],v[224:227],v[64:67]
v_min3_u32 v27,v27,v224,v228
v_mfma_f32_16x16x32_bf16 v[72:75],a[160:163],v[224:227],v[72:75]
ds_read_b128 v[252:255],v17 offset:30720
v_mfma_f32_16x16x32_bf16 v[64:67],a[36:39],v[228:231],v[64:67]
v_mfma_f32_16x16x32_bf16 v[72:75],a[164:167],v[228:231],v[72:75]
ds_read_b128 v[224:227],v17 offset:32768
s_waitcnt lgkmcnt(5)
v_mfma_f32_16x16x32_bf16 v[64:67],a[40:43],v[232:235],v[64:67]
v_min3_u32 v27,v27,v232,v236
v_mfma_f32_16x16x32_bf16 v[72:75],a[168:171],v[232:235],v[72:75]
ds_read_b128 v[228:231],v17 offset:34816
v_mfma_f32_16x16x32_bf16 v[64:67],a[44:47],v[236:239],v[64:67]
v_mfma_f32_16x16x32_bf16 v[72:75],a[172:175],v[236:239],v[72:75]
ds_read_b128 v[232:235],v17 offset:36864
s_waitcnt lgkmcnt(5)
v_mfma_f32_16x16x32_bf16 v[64:67],a[48:51],v[240:243],v[64:67]
v_min3_u32 v27,v27,v240,v244
v_mfma_f32_16x16x32_bf16 v[72:75],a[176:179],v[240:243],v[72:75]
ds_read_b128 v[236:239],v17 offset:38912
v_mfma_f32_16x16x32_bf16 v[64:67],a[52:55],v[244:247],v[64:67]
v_mfma_f32_16x16x32_bf16 v[72:75],a[180:183],v[244:247],v[72:75]
ds_read_b128 v[240:243],v17 offset:40960
s_waitcnt lgkmcnt(5)
v_mfma_f32_16x16x32_bf16 v[64:67],a[56:59],v[248:251],v[64:67]
v_min3_u32 v27,v27,v248,v252
v_mfma_f32_16x16x32_bf16 v[72:75],a[184:187],v[248:251],v[72:75]
ds_read_b128 v[244:247],v17 offset:43008
s_waitcnt vmcnt(2)
v_mfma_f32_16x16x32_bf16 v[64:67],a[60:63],v[252:255],v[64:67]
v_cmp_gt_u32 vcc,s96,v29
v_cmp_gt_u32 s[92:93],s92,v29
v_mfma_f32_16x16x32_bf16 v[72:75],a[188:191],v[252:255],v[72:75]
ds_read_b128 v[248:251],v17 offset:45056
s_waitcnt lgkmcnt(5)
v_mfma_f32_16x16x32_bf16 v[64:67],a[64:67],v[224:227],v[64:67]
v_mov_b32 v44,vcc_lo
v_mov_b32 v45,s92
v_mfma_f32_16x16x32_bf16 v[72:75],a[192:195],v[224:227],v[72:75]
ds_read_b128 v[252:255],v17 offset:47104
ds_write_b64 v46,v[44:45]
v_mfma_f32_16x16x32_bf16 v[64:67],a[68:71],v[228:231],v[64:67]
v_min3_u32 v27,v27,v224,v228
v_mfma_f32_16x16x32_bf16 v[72:75],a[196:199],v[228:231],v[72:75]
ds_read_b128 v[224:227],v17 offset:49152
s_waitcnt lgkmcnt(6)
v_mfma_f32_16x16x32_bf16 v[64:67],a[72:75],v[232:235],v[64:67]
v_min3_u32 v27,v27,v232,v236
v_mfma_f32_16x16x32_bf16 v[72:75],a[200:203],v[232:235],v[72:75]
ds_read_b128 v[228:231],v17 offset:51200
v_mfma_f32_16x16x32_bf16 v[64:67],a[76:79],v[236:239],v[64:67]
v_mfma_f32_16x16x32_bf16 v[72:75],a[204:207],v[236:239],v[72:75]
ds_read_b128 v[232:235],v17 offset:53248
s_waitcnt lgkmcnt(6)
v_mfma_f32_16x16x32_bf16 v[64:67],a[80:83],v[240:243],v[64:67]
v_min3_u32 v27,v27,v240,v244
s_add_u32 s88,s70,s75
v_mfma_f32_16x16x32_bf16 v[72:75],a[208:211],v[240:243],v[72:75]
ds_read_b128 v[236:239],v17 offset:55296
s_add_u32 s88,s88,2097152
v_mfma_f32_16x16x32_bf16 v[64:67],a[84:87],v[244:247],v[64:67]
s_xor_b32 s88,s88,0x2000
s_xor_b32 s89,s88,1024
v_mfma_f32_16x16x32_bf16 v[72:75],a[212:215],v[244:247],v[72:75]
ds_read_b128 v[240:243],v17 offset:57344
s_waitcnt lgkmcnt(6)
v_mfma_f32_16x16x32_bf16 v[64:67],a[88:91],v[248:251],v[64:67]
v_min3_u32 v27,v27,v248,v252
v_mfma_f32_16x16x32_bf16 v[72:75],a[216:219],v[248:251],v[72:75]
ds_read_b128 v[244:247],v17 offset:59392
v_mfma_f32_16x16x32_bf16 v[64:67],a[92:95],v[252:255],v[64:67]
v_mfma_f32_16x16x32_bf16 v[72:75],a[220:223],v[252:255],v[72:75]
ds_read_b128 v[248:251],v17 offset:61440
s_waitcnt lgkmcnt(5)
v_mfma_f32_16x16x32_bf16 v[64:67],a[96:99],v[224:227],v[64:67]
v_min3_u32 v27,v27,v224,v228
v_mfma_f32_16x16x32_bf16 v[72:75],a[224:227],v[224:227],v[72:75]
ds_read_b128 v[252:255],v17 offset:63488
v_mfma_f32_16x16x32_bf16 v[64:67],a[100:103],v[228:231],v[64:67]
s_waitcnt vmcnt(0)
v_add_u32 v22,s71,-1
v_mfma_f32_16x16x32_bf16 v[72:75],a[228:231],v[228:231],v[72:75]
s_waitcnt vmcnt(4)
s_barrier
ds_read_b64 v[44:45],v47
ds_read_b128 v[224:227],v17 offset:1024
s_waitcnt lgkmcnt(6)
v_mfma_f32_16x16x32_bf16 v[64:67],a[104:107],v[232:235],v[64:67]
v_min3_u32 v27,v27,v232,v236
ds_read_b128 v[124:127],v19 offset:256
v_mfma_f32_16x16x32_bf16 v[72:75],a[232:235],v[232:235],v[72:75]
ds_read_b128 v[228:231],v17 offset:3072
ds_read_b128 v[120:123],v19 offset:0
v_mfma_f32_16x16x32_bf16 v[64:67],a[108:111],v[236:239],v[64:67]
buffer_store_dword v22,v23,s[20:23],s97 offen sc1
v_mfma_f32_16x16x32_bf16 v[72:75],a[236:239],v[236:239],v[72:75]
ds_read_b128 v[232:235],v17 offset:5120
s_waitcnt lgkmcnt(8)
v_mfma_f32_16x16x32_bf16 v[64:67],a[112:115],v[240:243],v[64:67]
v_min3_u32 v27,v27,v240,v244
s_mov_b32 s97,0x7fff0000
v_mfma_f32_16x16x32_bf16 v[72:75],a[240:243],v[240:243],v[72:75]
ds_read_b128 v[236:239],v17 offset:7168
v_mfma_f32_16x16x32_bf16 v[64:67],a[116:119],v[244:247],v[64:67]
v_mfma_f32_16x16x32_bf16 v[72:75],a[244:247],v[244:247],v[72:75]
ds_read_b128 v[240:243],v17 offset:9216
s_waitcnt lgkmcnt(8)
v_mfma_f32_16x16x32_bf16 v[64:67],a[120:123],v[248:251],v[64:67]
s_waitcnt lgkmcnt(7)
v_readfirstlane_b32 s93,v45
v_mfma_f32_16x16x32_bf16 v[72:75],a[248:251],v[248:251],v[72:75]
ds_read_b128 v[244:247],v17 offset:11264
v_readfirstlane_b32 s83,v44
s_cmp_lg_u32 s83,0
s_cbranch_scc1 keep_343
v_mfma_f32_16x16x32_bf16 v[64:67],a[124:127],v[252:255],v[64:67]
v_min3_u32 v27,v27,v248,v252
s_xor_b32 m0,s72,0
v_mfma_f32_16x16x32_bf16 v[72:75],a[252:255],v[252:255],v[72:75]
ds_read_b128 v[248:251],v17 offset:13312
s_waitcnt lgkmcnt(6)
v_mfma_f32_16x16x32_bf16 v[68:71],a[0:3],v[224:227],0
s_add_u32 s65,s88,0
v_cmp_eq_u32 vcc,0,v27
s_cbranch_vccnz retry_334
v_mfma_f32_16x16x32_bf16 v[76:79],a[128:131],v[224:227],0
ds_read_b128 v[252:255],v17 offset:15360
v_min3_u32 v27,v27,v224,v228
s_waitcnt lgkmcnt(6)
v_mfma_f32_16x16x32_bf16 v[68:71],a[4:7],v[228:231],v[68:71]
buffer_load_dwordx4 v16,s[20:23],s65 offen offset:0 sc1 lds
v_mfma_f32_16x16x32_bf16 v[76:79],a[132:135],v[228:231],v[76:79]
ds_read_b128 v[224:227],v17 offset:17408
s_waitcnt lgkmcnt(5)
v_mfma_f32_16x16x32_bf16 v[68:71],a[8:11],v[232:235],v[68:71]
buffer_load_dwordx4 v16,s[20:23],s65 offen offset:2048 sc1 lds
v_fmac_f32 v64,v52,v120
v_fmac_f32 v65,v53,v120
v_mfma_f32_16x16x32_bf16 v[76:79],a[136:139],v[232:235],v[76:79]
ds_read_b128 v[228:231],v17 offset:19456
s_xor_b32 m0,s72,16384
v_fmac_f32 v66,v54,v120
v_fmac_f32 v67,v55,v120
v_mfma_f32_16x16x32_bf16 v[68:71],a[12:15],v[236:239],v[68:71]
s_add_u32 s65,s88,32768
v_min3_u32 v27,v27,v232,v236
v_mul_f32 v88,v64,v64
v_mul_f32 v89,v65,v65
v_mfma_f32_16x16x32_bf16 v[76:79],a[140:143],v[236:239],v[76:79]
ds_read_b128 v[232:235],v17 offset:21504
v_mul_f32 v90,v66,v66
v_mul_f32 v91,v67,v67
s_waitcnt lgkmcnt(5)
v_mfma_f32_16x16x32_bf16 v[68:71],a[16:19],v[240:243],v[68:71]
buffer_load_dwordx4 v16,s[20:23],s65 offen offset:0 sc1 lds
v_fma_f32 v88,v88,v121,v122
v_fma_f32 v89,v89,v121,v122
v_mfma_f32_16x16x32_bf16 v[76:79],a[144:147],v[240:243],v[76:79]
ds_read_b128 v[236:239],v17 offset:23552
v_min3_u32 v27,v27,v240,v244
v_fma_f32 v90,v90,v121,v122
v_fma_f32 v91,v91,v121,v122
v_mfma_f32_16x16x32_bf16 v[68:71],a[20:23],v[244:247],v[68:71]
buffer_load_dwordx4 v16,s[20:23],s65 offen offset:2048 sc1 lds
v_mul_f32 v88,v88,v64
v_mul_f32 v89,v89,v65
v_mfma_f32_16x16x32_bf16 v[76:79],a[148:151],v[244:247],v[76:79]
ds_read_b128 v[240:243],v17 offset:25600
v_mul_f32 v90,v90,v66
v_mul_f32 v91,v91,v67
s_waitcnt lgkmcnt(5)
v_mfma_f32_16x16x32_bf16 v[68:71],a[24:27],v[248:251],v[68:71]
s_xor_b32 m0,s72,32768
s_add_u32 s65,s88,65536
v_exp_f32 v88,v88
v_mfma_f32_16x16x32_bf16 v[76:79],a[152:155],v[248:251],v[76:79]
ds_read_b128 v[244:247],v17 offset:27648
v_min3_u32 v27,v27,v248,v252
v_exp_f32 v89,v89
v_mfma_f32_16x16x32_bf16 v[68:71],a[28:31],v[252:255],v[68:71]
buffer_load_dwordx4 v16,s[20:23],s65 offen offset:0 sc1 lds
v_exp_f32 v90,v90
v_mfma_f32_16x16x32_bf16 v[76:79],a[156:159],v[252:255],v[76:79]
ds_read_b128 v[248:251],v17 offset:29696
v_exp_f32 v91,v91
s_waitcnt lgkmcnt(5)
v_mfma_f32_16x16x32_bf16 v[68:71],a[32:35],v[224:227],v[68:71]
buffer_load_dwordx4 v16,s[20:23],s65 offen offset:2048 sc1 lds
v_fma_f32 v88,v88,v123,v123
v_fma_f32 v89,v89,v123,v123
v_mfma_f32_16x16x32_bf16 v[76:79],a[160:163],v[224:227],v[76:79]
ds_read_b128 v[252:255],v17 offset:31744
s_xor_b32 m0,s72,49152
v_fma_f32 v90,v90,v123,v123
v_fma_f32 v91,v91,v123,v123
v_mfma_f32_16x16x32_bf16 v[68:71],a[36:39],v[228:231],v[68:71]
v_min3_u32 v27,v27,v224,v228
v_rcp_f32 v88,v88
v_fmac_f32 v72,v56,v120
v_mfma_f32_16x16x32_bf16 v[76:79],a[164:167],v[228:231],v[76:79]
ds_read_b128 v[224:227],v17 offset:33792
v_fmac_f32 v73,v57,v120
v_fmac_f32 v74,v58,v120
s_waitcnt lgkmcnt(5)
v_mfma_f32_16x16x32_bf16 v[68:71],a[40:43],v[232:235],v[68:71]
s_add_u32 s65,s88,98304
v_min3_u32 v27,v27,v232,v236
v_fmac_f32 v75,v59,v120
v_mul_f32 v92,v72,v72
v_mfma_f32_16x16x32_bf16 v[76:79],a[168:171],v[232:235],v[76:79]
ds_read_b128 v[228:231],v17 offset:35840
v_mul_f32 v93,v73,v73
v_mul_f32 v94,v74,v74
v_mul_f32 v95,v75,v75
v_mfma_f32_16x16x32_bf16 v[68:71],a[44:47],v[236:239],v[68:71]
buffer_load_dwordx4 v16,s[20:23],s65 offen offset:0 sc1 lds
v_fma_f32 v92,v92,v121,v122
v_fma_f32 v93,v93,v121,v122
v_mfma_f32_16x16x32_bf16 v[76:79],a[172:175],v[236:239],v[76:79]
ds_read_b128 v[232:235],v17 offset:37888
v_fma_f32 v94,v94,v121,v122
v_fma_f32 v95,v95,v121,v122
s_waitcnt lgkmcnt(5)
v_mfma_f32_16x16x32_bf16 v[68:71],a[48:51],v[240:243],v[68:71]
buffer_load_dwordx4 v16,s[20:23],s65 offen offset:2048 sc1 lds
v_mul_f32 v92,v92,v72
v_mul_f32 v93,v93,v73
v_mfma_f32_16x16x32_bf16 v[76:79],a[176:179],v[240:243],v[76:79]
ds_read_b128 v[236:239],v17 offset:39936
s_xor_b32 m0,s72,1024
v_mul_f32 v94,v94,v74
v_mul_f32 v95,v95,v75
v_mfma_f32_16x16x32_bf16 v[68:71],a[52:55],v[244:247],v[68:71]
s_add_u32 s65,s89,0
v_min3_u32 v27,v27,v240,v244
v_exp_f32 v92,v92
v_mfma_f32_16x16x32_bf16 v[76:79],a[180:183],v[244:247],v[76:79]
ds_read_b128 v[240:243],v17 offset:41984
v_exp_f32 v93,v93
s_waitcnt lgkmcnt(5)
v_mfma_f32_16x16x32_bf16 v[68:71],a[56:59],v[248:251],v[68:71]
buffer_load_dwordx4 v16,s[20:23],s65 offen offset:0 sc1 lds
v_exp_f32 v94,v94
v_mfma_f32_16x16x32_bf16 v[76:79],a[184:187],v[248:251],v[76:79]
ds_read_b128 v[244:247],v17 offset:44032
v_min3_u32 v27,v27,v248,v252
v_exp_f32 v95,v95
v_mfma_f32_16x16x32_bf16 v[68:71],a[60:63],v[252:255],v[68:71]
buffer_load_dwordx4 v16,s[20:23],s65 offen offset:2048 sc1 lds
v_fma_f32 v92,v92,v123,v123
v_fma_f32 v93,v93,v123,v123
v_mfma_f32_16x16x32_bf16 v[76:79],a[188:191],v[252:255],v[76:79]
ds_read_b128 v[248:251],v17 offset:46080
v_fma_f32 v94,v94,v123,v123
v_fma_f32 v95,v95,v123,v123
s_waitcnt lgkmcnt(5)
v_mfma_f32_16x16x32_bf16 v[68:71],a[64:67],v[224:227],v[68:71]
s_xor_b32 m0,s72,17408
s_add_u32 s65,s89,32768
v_rcp_f32 v92,v92
v_mfma_f32_16x16x32_bf16 v[76:79],a[192:195],v[224:227],v[76:79]
ds_read_b128 v[252:255],v17 offset:48128
v_min3_u32 v27,v27,v224,v228
v_rcp_f32 v93,v93
v_mfma_f32_16x16x32_bf16 v[68:71],a[68:71],v[228:231],v[68:71]
buffer_load_dwordx4 v16,s[20:23],s65 offen offset:0 sc1 lds
v_rcp_f32 v94,v94
v_mfma_f32_16x16x32_bf16 v[76:79],a[196:199],v[228:231],v[76:79]
ds_read_b128 v[224:227],v17 offset:50176
v_rcp_f32 v95,v95
s_waitcnt lgkmcnt(5)
v_mfma_f32_16x16x32_bf16 v[68:71],a[72:75],v[232:235],v[68:71]
buffer_load_dwordx4 v16,s[20:23],s65 offen offset:2048 sc1 lds
v_mfma_f32_16x16x32_bf16 v[76:79],a[200:203],v[232:235],v[76:79]
ds_read_b128 v[228:231],v17 offset:52224
s_xor_b32 m0,s72,33792
v_mfma_f32_16x16x32_bf16 v[68:71],a[76:79],v[236:239],v[68:71]
s_add_u32 s65,s89,65536
v_min3_u32 v27,v27,v232,v236
v_mfma_f32_16x16x32_bf16 v[76:79],a[204:207],v[236:239],v[76:79]
ds_read_b128 v[232:235],v17 offset:54272
s_waitcnt lgkmcnt(5)
v_mfma_f32_16x16x32_bf16 v[68:71],a[80:83],v[240:243],v[68:71]
buffer_load_dwordx4 v16,s[20:23],s65 offen offset:0 sc1 lds
v_mfma_f32_16x16x32_bf16 v[76:79],a[208:211],v[240:243],v[76:79]
ds_read_b128 v[236:239],v17 offset:56320
v_min3_u32 v27,v27,v240,v244
v_mfma_f32_16x16x32_bf16 v[68:71],a[84:87],v[244:247],v[68:71]
buffer_load_dwordx4 v16,s[20:23],s65 offen offset:2048 sc1 lds
v_mfma_f32_16x16x32_bf16 v[76:79],a[212:215],v[244:247],v[76:79]
ds_read_b128 v[240:243],v17 offset:58368
s_waitcnt lgkmcnt(5)
v_mfma_f32_16x16x32_bf16 v[68:71],a[88:91],v[248:251],v[68:71]
s_xor_b32 m0,s72,50176
v_min3_u32 v27,v27,v248,v252
v_mfma_f32_16x16x32_bf16 v[76:79],a[216:219],v[248:251],v[76:79]
ds_read_b128 v[244:247],v17 offset:60416
s_add_u32 s65,s89,98304
v_mfma_f32_16x16x32_bf16 v[68:71],a[92:95],v[252:255],v[68:71]
buffer_load_dwordx4 v16,s[20:23],s65 offen offset:0 sc1 lds
v_mfma_f32_16x16x32_bf16 v[76:79],a[220:223],v[252:255],v[76:79]
ds_read_b128 v[248:251],v17 offset:62464
s_waitcnt lgkmcnt(5)
v_mfma_f32_16x16x32_bf16 v[68:71],a[96:99],v[224:227],v[68:71]
buffer_load_dwordx4 v16,s[20:23],s65 offen offset:2048 sc1 lds
v_mfma_f32_16x16x32_bf16 v[76:79],a[224:227],v[224:227],v[76:79]
ds_read_b128 v[252:255],v17 offset:64512
v_min3_u32 v27,v27,v224,v228
v_mfma_f32_16x16x32_bf16 v[68:71],a[100:103],v[228:231],v[68:71]
v_rcp_f32 v89,v89
v_mfma_f32_16x16x32_bf16 v[76:79],a[228:231],v[228:231],v[76:79]
v_mul_f32 v92,v92,v72
s_waitcnt lgkmcnt(4)
v_mfma_f32_16x16x32_bf16 v[68:71],a[104:107],v[232:235],v[68:71]
v_min3_u32 v27,v27,v232,v236
v_mul_f32 v93,v93,v73
v_mfma_f32_16x16x32_bf16 v[76:79],a[232:235],v[232:235],v[76:79]
v_rcp_f32 v90,v90
v_mfma_f32_16x16x32_bf16 v[68:71],a[108:111],v[236:239],v[68:71]
v_rcp_f32 v91,v91
v_mfma_f32_16x16x32_bf16 v[76:79],a[236:239],v[236:239],v[76:79]
v_mul_f32 v88,v88,v64
s_waitcnt lgkmcnt(2)
v_mfma_f32_16x16x32_bf16 v[68:71],a[112:115],v[240:243],v[68:71]
v_min3_u32 v27,v27,v240,v244
v_mul_f32 v89,v89,v65
v_mfma_f32_16x16x32_bf16 v[76:79],a[240:243],v[240:243],v[76:79]
v_mul_f32 v90,v90,v66
v_mul_f32 v91,v91,v67
v_mfma_f32_16x16x32_bf16 v[68:71],a[116:119],v[244:247],v[68:71]
v_mul_f32 v94,v94,v74
v_mul_f32 v95,v95,v75
v_mfma_f32_16x16x32_bf16 v[76:79],a[244:247],v[244:247],v[76:79]
v_cvt_pk_bf16_f32 v96,v88,v89
s_waitcnt lgkmcnt(0)
v_mfma_f32_16x16x32_bf16 v[68:71],a[120:123],v[248:251],v[68:71]
v_min3_u32 v27,v27,v248,v252
v_cvt_pk_bf16_f32 v97,v90,v91
v_mfma_f32_16x16x32_bf16 v[76:79],a[248:251],v[248:251],v[76:79]
v_cvt_pk_bf16_f32 v98,v92,v93
v_cvt_pk_bf16_f32 v99,v94,v95
v_mfma_f32_16x16x32_bf16 v[68:71],a[124:127],v[252:255],v[68:71]
v_max_u32 v96,1,v96
v_mfma_f32_16x16x32_bf16 v[76:79],a[252:255],v[252:255],v[76:79]
buffer_store_dwordx4 v[96:99],v18,s[20:23],s70 offen offset:0 sc1
v_cmp_eq_u32 vcc,0,v27
s_cbranch_vccnz retry_334
s_branch epi_337
keep_343:
v_mfma_f32_16x16x32_bf16 v[64:67],a[124:127],v[252:255],v[64:67]
v_min3_u32 v27,v27,v248,v252
v_mfma_f32_16x16x32_bf16 v[72:75],a[252:255],v[252:255],v[72:75]
ds_read_b128 v[248:251],v17 offset:13312
s_waitcnt lgkmcnt(6)
v_mfma_f32_16x16x32_bf16 v[68:71],a[0:3],v[224:227],0
v_cmp_eq_u32 vcc,0,v27
s_cbranch_vccnz retry_334
v_mfma_f32_16x16x32_bf16 v[76:79],a[128:131],v[224:227],0
ds_read_b128 v[252:255],v17 offset:15360
v_min3_u32 v27,v27,v224,v228
v_mfma_f32_16x16x32_bf16 v[68:71],a[4:7],v[228:231],v[68:71]
s_waitcnt lgkmcnt(6)
v_mfma_f32_16x16x32_bf16 v[76:79],a[132:135],v[228:231],v[76:79]
ds_read_b128 v[224:227],v17 offset:17408
s_waitcnt lgkmcnt(5)
v_mfma_f32_16x16x32_bf16 v[68:71],a[8:11],v[232:235],v[68:71]
v_min3_u32 v27,v27,v232,v236
v_fmac_f32 v64,v52,v120
v_fmac_f32 v72,v56,v120
v_mfma_f32_16x16x32_bf16 v[76:79],a[136:139],v[232:235],v[76:79]
ds_read_b128 v[228:231],v17 offset:19456
v_fmac_f32 v65,v53,v120
v_fmac_f32 v73,v57,v120
v_mfma_f32_16x16x32_bf16 v[68:71],a[12:15],v[236:239],v[68:71]
v_fmac_f32 v66,v54,v120
v_fmac_f32 v67,v55,v120
v_fmac_f32 v74,v58,v120
v_mfma_f32_16x16x32_bf16 v[76:79],a[140:143],v[236:239],v[76:79]
ds_read_b128 v[232:235],v17 offset:21504
v_fmac_f32 v75,v59,v120
s_waitcnt lgkmcnt(5)
v_mfma_f32_16x16x32_bf16 v[68:71],a[16:19],v[240:243],v[68:71]
v_min3_u32 v27,v27,v240,v244
v_mul_f32 v88,v64,v64
v_mul_f32 v92,v72,v72
v_mfma_f32_16x16x32_bf16 v[76:79],a[144:147],v[240:243],v[76:79]
ds_read_b128 v[236:239],v17 offset:23552
v_mul_f32 v89,v65,v65
v_mul_f32 v93,v73,v73
v_mfma_f32_16x16x32_bf16 v[68:71],a[20:23],v[244:247],v[68:71]
v_mul_f32 v90,v66,v66
v_mul_f32 v91,v67,v67
v_mul_f32 v94,v74,v74
v_mfma_f32_16x16x32_bf16 v[76:79],a[148:151],v[244:247],v[76:79]
ds_read_b128 v[240:243],v17 offset:25600
v_mul_f32 v95,v75,v75
s_waitcnt lgkmcnt(5)
v_mfma_f32_16x16x32_bf16 v[68:71],a[24:27],v[248:251],v[68:71]
v_min3_u32 v27,v27,v248,v252
v_fma_f32 v88,v88,v121,v122
v_fma_f32 v92,v92,v121,v122
v_mfma_f32_16x16x32_bf16 v[76:79],a[152:155],v[248:251],v[76:79]
ds_read_b128 v[244:247],v17 offset:27648
v_fma_f32 v89,v89,v121,v122
v_fma_f32 v93,v93,v121,v122
v_mfma_f32_16x16x32_bf16 v[68:71],a[28:31],v[252:255],v[68:71]
v_fma_f32 v90,v90,v121,v122
v_fma_f32 v91,v91,v121,v122
v_fma_f32 v94,v94,v121,v122
v_mfma_f32_16x16x32_bf16 v[76:79],a[156:159],v[252:255],v[76:79]
ds_read_b128 v[248:251],v17 offset:29696
v_fma_f32 v95,v95,v121,v122
s_waitcnt lgkmcnt(5)
v_mfma_f32_16x16x32_bf16 v[68:71],a[32:35],v[224:227],v[68:71]
v_min3_u32 v27,v27,v224,v228
v_mul_f32 v88,v88,v64
v_mul_f32 v92,v92,v72
v_mfma_f32_16x16x32_bf16 v[76:79],a[160:163],v[224:227],v[76:79]
ds_read_b128 v[252:255],v17 offset:31744
v_mul_f32 v89,v89,v65
v_mul_f32 v93,v93,v73
v_mfma_f32_16x16x32_bf16 v[68:71],a[36:39],v[228:231],v[68:71]
v_mul_f32 v90,v90,v66
v_mul_f32 v91,v91,v67
v_mul_f32 v94,v94,v74
v_mfma_f32_16x16x32_bf16 v[76:79],a[164:167],v[228:231],v[76:79]
ds_read_b128 v[224:227],v17 offset:33792
v_mul_f32 v95,v95,v75
s_waitcnt lgkmcnt(5)
v_mfma_f32_16x16x32_bf16 v[68:71],a[40:43],v[232:235],v[68:71]
v_min3_u32 v27,v27,v232,v236
v_exp_f32 v92,v92
v_mfma_f32_16x16x32_bf16 v[76:79],a[168:171],v[232:235],v[76:79]
ds_read_b128 v[228:231],v17 offset:35840
v_exp_f32 v93,v93
v_mfma_f32_16x16x32_bf16 v[68:71],a[44:47],v[236:239],v[68:71]
v_exp_f32 v88,v88
v_mfma_f32_16x16x32_bf16 v[76:79],a[172:175],v[236:239],v[76:79]
ds_read_b128 v[232:235],v17 offset:37888
s_waitcnt lgkmcnt(5)
v_mfma_f32_16x16x32_bf16 v[68:71],a[48:51],v[240:243],v[68:71]
v_min3_u32 v27,v27,v240,v244
v_exp_f32 v94,v94
v_mfma_f32_16x16x32_bf16 v[76:79],a[176:179],v[240:243],v[76:79]
ds_read_b128 v[236:239],v17 offset:39936
v_exp_f32 v95,v95
v_mfma_f32_16x16x32_bf16 v[68:71],a[52:55],v[244:247],v[68:71]
v_exp_f32 v89,v89
v_fma_f32 v92,v92,v123,v123
v_mfma_f32_16x16x32_bf16 v[76:79],a[180:183],v[244:247],v[76:79]
ds_read_b128 v[240:243],v17 offset:41984
v_fma_f32 v93,v93,v123,v123
s_waitcnt lgkmcnt(5)
v_mfma_f32_16x16x32_bf16 v[68:71],a[56:59],v[248:251],v[68:71]
v_min3_u32 v27,v27,v248,v252
v_fma_f32 v94,v94,v123,v123
v_fma_f32 v95,v95,v123,v123
v_mfma_f32_16x16x32_bf16 v[76:79],a[184:187],v[248:251],v[76:79]
ds_read_b128 v[244:247],v17 offset:44032
v_rcp_f32 v92,v92
v_mfma_f32_16x16x32_bf16 v[68:71],a[60:63],v[252:255],v[68:71]
v_exp_f32 v90,v90
v_mfma_f32_16x16x32_bf16 v[76:79],a[188:191],v[252:255],v[76:79]
ds_read_b128 v[248:251],v17 offset:46080
s_waitcnt lgkmcnt(5)
v_mfma_f32_16x16x32_bf16 v[68:71],a[64:67],v[224:227],v[68:71]
v_min3_u32 v27,v27,v224,v228
v_rcp_f32 v93,v93
v_mfma_f32_16x16x32_bf16 v[76:79],a[192:195],v[224:227],v[76:79]
ds_read_b128 v[252:255],v17 offset:48128
v_rcp_f32 v94,v94
v_mfma_f32_16x16x32_bf16 v[68:71],a[68:71],v[228:231],v[68:71]
v_exp_f32 v91,v91
v_mfma_f32_16x16x32_bf16 v[76:79],a[196:199],v[228:231],v[76:79]
ds_read_b128 v[224:227],v17 offset:50176
s_waitcnt lgkmcnt(5)
v_mfma_f32_16x16x32_bf16 v[68:71],a[72:75],v[232:235],v[68:71]
v_min3_u32 v27,v27,v232,v236
v_fma_f32 v88,v88,v123,v123
v_mfma_f32_16x16x32_bf16 v[76:79],a[200:203],v[232:235],v[76:79]
ds_read_b128 v[228:231],v17 offset:52224
v_fma_f32 v89,v89,v123,v123
v_mfma_f32_16x16x32_bf16 v[68:71],a[76:79],v[236:239],v[68:71]
v_fma_f32 v90,v90,v123,v123
v_fma_f32 v91,v91,v123,v123
v_mfma_f32_16x16x32_bf16 v[76:79],a[204:207],v[236:239],v[76:79]
ds_read_b128 v[232:235],v17 offset:54272
s_waitcnt lgkmcnt(5)
v_mfma_f32_16x16x32_bf16 v[68:71],a[80:83],v[240:243],v[68:71]
v_min3_u32 v27,v27,v240,v244
v_rcp_f32 v95,v95
v_mfma_f32_16x16x32_bf16 v[76:79],a[208:211],v[240:243],v[76:79]
ds_read_b128 v[236:239],v17 offset:56320
v_mul_f32 v92,v92,v72
v_mfma_f32_16x16x32_bf16 v[68:71],a[84:87],v[244:247],v[68:71]
v_rcp_f32 v88,v88
v_mfma_f32_16x16x32_bf16 v[76:79],a[212:215],v[244:247],v[76:79]
ds_read_b128 v[240:243],v17 offset:58368
s_waitcnt lgkmcnt(5)
v_mfma_f32_16x16x32_bf16 v[68:71],a[88:91],v[248:251],v[68:71]
v_min3_u32 v27,v27,v248,v252
v_mul_f32 v93,v93,v73
v_mfma_f32_16x16x32_bf16 v[76:79],a[216:219],v[248:251],v[76:79]
ds_read_b128 v[244:247],v17 offset:60416
v_mul_f32 v94,v94,v74
v_mfma_f32_16x16x32_bf16 v[68:71],a[92:95],v[252:255],v[68:71]
v_rcp_f32 v89,v89
v_mfma_f32_16x16x32_bf16 v[76:79],a[220:223],v[252:255],v[76:79]
ds_read_b128 v[248:251],v17 offset:62464
s_waitcnt lgkmcnt(5)
v_mfma_f32_16x16x32_bf16 v[68:71],a[96:99],v[224:227],v[68:71]
v_min3_u32 v27,v27,v224,v228
v_mul_f32 v95,v95,v75
v_mfma_f32_16x16x32_bf16 v[76:79],a[224:227],v[224:227],v[76:79]
ds_read_b128 v[252:255],v17 offset:64512
v_mfma_f32_16x16x32_bf16 v[68:71],a[100:103],v[228:231],v[68:71]
v_rcp_f32 v90,v90
v_mfma_f32_16x16x32_bf16 v[76:79],a[228:231],v[228:231],v[76:79]
s_waitcnt lgkmcnt(4)
v_mfma_f32_16x16x32_bf16 v[68:71],a[104:107],v[232:235],v[68:71]
v_min3_u32 v27,v27,v232,v236
v_mfma_f32_16x16x32_bf16 v[76:79],a[232:235],v[232:235],v[76:79]
v_rcp_f32 v91,v91
v_mfma_f32_16x16x32_bf16 v[68:71],a[108:111],v[236:239],v[68:71]
v_mul_f32 v88,v88,v64
v_mul_f32 v89,v89,v65
v_mfma_f32_16x16x32_bf16 v[76:79],a[236:239],v[236:239],v[76:79]
v_mul_f32 v90,v90,v66
s_waitcnt lgkmcnt(2)
v_mfma_f32_16x16x32_bf16 v[68:71],a[112:115],v[240:243],v[68:71]
v_min3_u32 v27,v27,v240,v244
v_mul_f32 v91,v91,v67
v_mfma_f32_16x16x32_bf16 v[76:79],a[240:243],v[240:243],v[76:79]
v_cvt_pk_bf16_f32 v96,v88,v89
v_cvt_pk_bf16_f32 v97,v90,v91
v_mfma_f32_16x16x32_bf16 v[68:71],a[116:119],v[244:247],v[68:71]
v_cvt_pk_bf16_f32 v98,v92,v93
v_cvt_pk_bf16_f32 v99,v94,v95
v_mfma_f32_16x16x32_bf16 v[76:79],a[244:247],v[244:247],v[76:79]
v_max_u32 v96,1,v96
s_waitcnt lgkmcnt(0)
v_mfma_f32_16x16x32_bf16 v[68:71],a[120:123],v[248:251],v[68:71]
v_min3_u32 v27,v27,v248,v252
v_mfma_f32_16x16x32_bf16 v[76:79],a[248:251],v[248:251],v[76:79]
buffer_store_dwordx4 v[96:99],v18,s[20:23],s70 offen offset:0 sc1
v_mfma_f32_16x16x32_bf16 v[68:71],a[124:127],v[252:255],v[68:71]
v_mfma_f32_16x16x32_bf16 v[76:79],a[252:255],v[252:255],v[76:79]
v_cmp_eq_u32 vcc,0,v27
s_cbranch_vccnz retry_334
s_branch epi_337
both_338:
s_waitcnt vmcnt(12) lgkmcnt(0)
s_barrier
ds_read_b128 v[224:227],v17 offset:0
ds_read_b128 v[228:231],v17 offset:2048
ds_read_b128 v[232:235],v17 offset:4096
ds_read_b128 v[236:239],v17 offset:6144
ds_read_b128 v[240:243],v17 offset:8192
ds_read_b128 v[244:247],v17 offset:10240
ds_read_b128 v[248:251],v17 offset:12288
s_waitcnt lgkmcnt(5)
v_mfma_f32_16x16x32_bf16 v[64:67],a[0:3],v[224:227],0
s_add_u32 s96,s71,1
s_add_u32 s92,s71,2
v_min_u32 v27,v224,v228
v_mfma_f32_16x16x32_bf16 v[72:75],a[128:131],v[224:227],0
ds_read_b128 v[252:255],v17 offset:14336
s_add_u32 s88,s70,s75
v_mfma_f32_16x16x32_bf16 v[64:67],a[4:7],v[228:231],v[64:67]
s_add_u32 s88,s88,2097152
s_xor_b32 s88,s88,0x2000
v_mfma_f32_16x16x32_bf16 v[72:75],a[132:135],v[228:231],v[72:75]
ds_read_b128 v[224:227],v17 offset:16384
s_waitcnt lgkmcnt(5)
v_mfma_f32_16x16x32_bf16 v[64:67],a[8:11],v[232:235],v[64:67]
s_xor_b32 s89,s88,1024
v_min3_u32 v27,v27,v232,v236
v_mfma_f32_16x16x32_bf16 v[72:75],a[136:139],v[232:235],v[72:75]
ds_read_b128 v[228:231],v17 offset:18432
v_mfma_f32_16x16x32_bf16 v[64:67],a[12:15],v[236:239],v[64:67]
s_xor_b32 m0,s72,0
v_mfma_f32_16x16x32_bf16 v[72:75],a[140:143],v[236:239],v[72:75]
ds_read_b128 v[232:235],v17 offset:20480
s_add_u32 s65,s88,0
s_waitcnt lgkmcnt(5)
v_mfma_f32_16x16x32_bf16 v[64:67],a[16:19],v[240:243],v[64:67]
v_min3_u32 v27,v27,v240,v244
v_mfma_f32_16x16x32_bf16 v[72:75],a[144:147],v[240:243],v[72:75]
ds_read_b128 v[236:239],v17 offset:22528
buffer_load_dwordx4 v16,s[20:23],s65 offen offset:0 sc1 lds
v_mfma_f32_16x16x32_bf16 v[64:67],a[20:23],v[244:247],v[64:67]
buffer_load_dwordx4 v16,s[20:23],s65 offen offset:2048 sc1 lds
v_mfma_f32_16x16x32_bf16 v[72:75],a[148:151],v[244:247],v[72:75]
ds_read_b128 v[240:243],v17 offset:24576
s_waitcnt lgkmcnt(5)
v_mfma_f32_16x16x32_bf16 v[64:67],a[24:27],v[248:251],v[64:67]
s_xor_b32 m0,s72,16384
v_min3_u32 v27,v27,v248,v252
v_mfma_f32_16x16x32_bf16 v[72:75],a[152:155],v[248:251],v[72:75]
ds_read_b128 v[244:247],v17 offset:26624
v_mfma_f32_16x16x32_bf16 v[64:67],a[28:31],v[252:255],v[64:67]
s_add_u32 s65,s88,32768
v_mfma_f32_16x16x32_bf16 v[72:75],a[156:159],v[252:255],v[72:75]
ds_read_b128 v[248:251],v17 offset:28672
s_waitcnt lgkmcnt(5)
v_mfma_f32_16x16x32_bf16 v[64:67],a[32:35],v[224:227],v[64:67]
buffer_load_dwordx4 v16,s[20:23],s65 offen offset:0 sc1 lds
v_mfma_f32_16x16x32_bf16 v[72:75],a[160:163],v[224:227],v[72:75]
ds_read_b128 v[252:255],v17 offset:30720
buffer_load_dwordx4 v16,s[20:23],s65 offen offset:2048 sc1 lds
v_mfma_f32_16x16x32_bf16 v[64:67],a[36:39],v[228:231],v[64:67]
v_min3_u32 v27,v27,v224,v228
v_mfma_f32_16x16x32_bf16 v[72:75],a[164:167],v[228:231],v[72:75]
ds_read_b128 v[224:227],v17 offset:32768
s_xor_b32 m0,s72,32768
s_waitcnt lgkmcnt(5)
v_mfma_f32_16x16x32_bf16 v[64:67],a[40:43],v[232:235],v[64:67]
s_add_u32 s65,s88,65536
v_min3_u32 v27,v27,v232,v236
v_mfma_f32_16x16x32_bf16 v[72:75],a[168:171],v[232:235],v[72:75]
ds_read_b128 v[228:231],v17 offset:34816
v_mfma_f32_16x16x32_bf16 v[64:67],a[44:47],v[236:239],v[64:67]
buffer_load_dwordx4 v16,s[20:23],s65 offen offset:0 sc1 lds
v_mfma_f32_16x16x32_bf16 v[72:75],a[172:175],v[236:239],v[72:75]
ds_read_b128 v[232:235],v17 offset:36864
s_waitcnt lgkmcnt(5)
v_mfma_f32_16x16x32_bf16 v[64:67],a[48:51],v[240:243],v[64:67]
buffer_load_dwordx4 v16,s[20:23],s65 offen offset:2048 sc1 lds
v_mfma_f32_16x16x32_bf16 v[72:75],a[176:179],v[240:243],v[72:75]
ds_read_b128 v[236:239],v17 offset:38912
s_xor_b32 m0,s72,49152
v_mfma_f32_16x16x32_bf16 v[64:67],a[52:55],v[244:247],v[64:67]
v_min3_u32 v27,v27,v240,v244
v_mfma_f32_16x16x32_bf16 v[72:75],a[180:183],v[244:247],v[72:75]
ds_read_b128 v[240:243],v17 offset:40960
s_add_u32 s65,s88,98304
s_waitcnt lgkmcnt(5)
v_mfma_f32_16x16x32_bf16 v[64:67],a[56:59],v[248:251],v[64:67]
buffer_load_dwordx4 v16,s[20:23],s65 offen offset:0 sc1 lds
v_min3_u32 v27,v27,v248,v252
v_mfma_f32_16x16x32_bf16 v[72:75],a[184:187],v[248:251],v[72:75]
ds_read_b128 v[244:247],v17 offset:43008
s_waitcnt vmcnt(9)
v_mfma_f32_16x16x32_bf16 v[64:67],a[60:63],v[252:255],v[64:67]
v_cmp_gt_u32 vcc,s96,v29
v_cmp_gt_u32 s[92:93],s92,v29
v_mfma_f32_16x16x32_bf16 v[72:75],a[188:191],v[252:255],v[72:75]
ds_read_b128 v[248:251],v17 offset:45056
s_waitcnt lgkmcnt(5)
v_mfma_f32_16x16x32_bf16 v[64:67],a[64:67],v[224:227],v[64:67]
v_mov_b32 v44,vcc_lo
v_mov_b32 v45,s92
v_min3_u32 v27,v27,v224,v228
v_mfma_f32_16x16x32_bf16 v[72:75],a[192:195],v[224:227],v[72:75]
ds_read_b128 v[252:255],v17 offset:47104
ds_write_b64 v46,v[44:45]
v_mfma_f32_16x16x32_bf16 v[64:67],a[68:71],v[228:231],v[64:67]
buffer_load_dwordx4 v16,s[20:23],s65 offen offset:2048 sc1 lds
v_mfma_f32_16x16x32_bf16 v[72:75],a[196:199],v[228:231],v[72:75]
ds_read_b128 v[224:227],v17 offset:49152
s_waitcnt lgkmcnt(6)
v_mfma_f32_16x16x32_bf16 v[64:67],a[72:75],v[232:235],v[64:67]
s_xor_b32 m0,s72,1024
s_add_u32 s65,s89,0
v_mfma_f32_16x16x32_bf16 v[72:75],a[200:203],v[232:235],v[72:75]
ds_read_b128 v[228:231],v17 offset:51200
v_min3_u32 v27,v27,v232,v236
v_mfma_f32_16x16x32_bf16 v[64:67],a[76:79],v[236:239],v[64:67]
buffer_load_dwordx4 v16,s[20:23],s65 offen offset:0 sc1 lds
v_mfma_f32_16x16x32_bf16 v[72:75],a[204:207],v[236:239],v[72:75]
ds_read_b128 v[232:235],v17 offset:53248
s_waitcnt lgkmcnt(6)
v_mfma_f32_16x16x32_bf16 v[64:67],a[80:83],v[240:243],v[64:67]
buffer_load_dwordx4 v16,s[20:23],s65 offen offset:2048 sc1 lds
v_mfma_f32_16x16x32_bf16 v[72:75],a[208:211],v[240:243],v[72:75]
ds_read_b128 v[236:239],v17 offset:55296
s_xor_b32 m0,s72,17408
v_mfma_f32_16x16x32_bf16 v[64:67],a[84:87],v[244:247],v[64:67]
s_add_u32 s65,s89,32768
v_min3_u32 v27,v27,v240,v244
v_mfma_f32_16x16x32_bf16 v[72:75],a[212:215],v[244:247],v[72:75]
ds_read_b128 v[240:243],v17 offset:57344
s_waitcnt lgkmcnt(6)
v_mfma_f32_16x16x32_bf16 v[64:67],a[88:91],v[248:251],v[64:67]
buffer_load_dwordx4 v16,s[20:23],s65 offen offset:0 sc1 lds
v_mfma_f32_16x16x32_bf16 v[72:75],a[216:219],v[248:251],v[72:75]
ds_read_b128 v[244:247],v17 offset:59392
v_min3_u32 v27,v27,v248,v252
v_mfma_f32_16x16x32_bf16 v[64:67],a[92:95],v[252:255],v[64:67]
buffer_load_dwordx4 v16,s[20:23],s65 offen offset:2048 sc1 lds
v_mfma_f32_16x16x32_bf16 v[72:75],a[220:223],v[252:255],v[72:75]
ds_read_b128 v[248:251],v17 offset:61440
s_waitcnt lgkmcnt(5)
v_mfma_f32_16x16x32_bf16 v[64:67],a[96:99],v[224:227],v[64:67]
s_xor_b32 m0,s72,33792
s_add_u32 s65,s89,65536
v_mfma_f32_16x16x32_bf16 v[72:75],a[224:227],v[224:227],v[72:75]
ds_read_b128 v[252:255],v17 offset:63488
v_min3_u32 v27,v27,v224,v228
v_mfma_f32_16x16x32_bf16 v[64:67],a[100:103],v[228:231],v[64:67]
buffer_load_dwordx4 v16,s[20:23],s65 offen offset:0 sc1 lds
s_waitcnt vmcnt(13)
v_add_u32 v22,s71,-1
v_mfma_f32_16x16x32_bf16 v[72:75],a[228:231],v[228:231],v[72:75]
s_waitcnt vmcnt(17)
s_barrier
ds_read_b64 v[44:45],v47
ds_read_b128 v[224:227],v17 offset:1024
s_waitcnt lgkmcnt(6)
v_mfma_f32_16x16x32_bf16 v[64:67],a[104:107],v[232:235],v[64:67]
buffer_load_dwordx4 v16,s[20:23],s65 offen offset:2048 sc1 lds
buffer_store_dword v22,v23,s[20:23],s97 offen sc1
v_mfma_f32_16x16x32_bf16 v[72:75],a[232:235],v[232:235],v[72:75]
ds_read_b128 v[228:231],v17 offset:3072
s_xor_b32 m0,s72,50176
s_mov_b32 s97,0x7fff0000
v_mfma_f32_16x16x32_bf16 v[64:67],a[108:111],v[236:239],v[64:67]
s_add_u32 s65,s89,98304
v_min3_u32 v27,v27,v232,v236
ds_read_b128 v[124:127],v19 offset:256
v_mfma_f32_16x16x32_bf16 v[72:75],a[236:239],v[236:239],v[72:75]
ds_read_b128 v[232:235],v17 offset:5120
ds_read_b128 v[120:123],v19 offset:0
s_waitcnt lgkmcnt(8)
v_mfma_f32_16x16x32_bf16 v[64:67],a[112:115],v[240:243],v[64:67]
buffer_load_dwordx4 v16,s[20:23],s65 offen offset:0 sc1 lds
v_mfma_f32_16x16x32_bf16 v[72:75],a[240:243],v[240:243],v[72:75]
ds_read_b128 v[236:239],v17 offset:7168
v_min3_u32 v27,v27,v240,v244
v_mfma_f32_16x16x32_bf16 v[64:67],a[116:119],v[244:247],v[64:67]
buffer_load_dwordx4 v16,s[20:23],s65 offen offset:2048 sc1 lds
v_mfma_f32_16x16x32_bf16 v[72:75],a[244:247],v[244:247],v[72:75]
ds_read_b128 v[240:243],v17 offset:9216
s_waitcnt lgkmcnt(8)
v_mfma_f32_16x16x32_bf16 v[64:67],a[120:123],v[248:251],v[64:67]
s_waitcnt lgkmcnt(7)
v_readfirstlane_b32 s93,v45
v_mfma_f32_16x16x32_bf16 v[72:75],a[248:251],v[248:251],v[72:75]
ds_read_b128 v[244:247],v17 offset:11264
v_min3_u32 v27,v27,v248,v252
v_mfma_f32_16x16x32_bf16 v[64:67],a[124:127],v[252:255],v[64:67]
v_mfma_f32_16x16x32_bf16 v[72:75],a[252:255],v[252:255],v[72:75]
ds_read_b128 v[248:251],v17 offset:13312
s_waitcnt lgkmcnt(7)
v_mfma_f32_16x16x32_bf16 v[68:71],a[0:3],v[224:227],0
v_cmp_eq_u32 vcc,0,v27
s_cbranch_vccnz retry_334
v_mfma_f32_16x16x32_bf16 v[76:79],a[128:131],v[224:227],0
ds_read_b128 v[252:255],v17 offset:15360
v_min3_u32 v27,v27,v224,v228
v_mfma_f32_16x16x32_bf16 v[68:71],a[4:7],v[228:231],v[68:71]
s_waitcnt lgkmcnt(5)
v_mfma_f32_16x16x32_bf16 v[76:79],a[132:135],v[228:231],v[76:79]
ds_read_b128 v[224:227],v17 offset:17408
s_waitcnt lgkmcnt(5)
v_mfma_f32_16x16x32_bf16 v[68:71],a[8:11],v[232:235],v[68:71]
v_min3_u32 v27,v27,v232,v236
v_fmac_f32 v64,v52,v120
v_fmac_f32 v72,v56,v120
v_mfma_f32_16x16x32_bf16 v[76:79],a[136:139],v[232:235],v[76:79]
ds_read_b128 v[228:231],v17 offset:19456
v_fmac_f32 v65,v53,v120
v_fmac_f32 v73,v57,v120
v_mfma_f32_16x16x32_bf16 v[68:71],a[12:15],v[236:239],v[68:71]
v_fmac_f32 v66,v54,v120
v_fmac_f32 v67,v55,v120
v_fmac_f32 v74,v58,v120
v_mfma_f32_16x16x32_bf16 v[76:79],a[140:143],v[236:239],v[76:79]
ds_read_b128 v[232:235],v17 offset:21504
v_fmac_f32 v75,v59,v120
s_waitcnt lgkmcnt(5)
v_mfma_f32_16x16x32_bf16 v[68:71],a[16:19],v[240:243],v[68:71]
v_min3_u32 v27,v27,v240,v244
v_mul_f32 v88,v64,v64
v_mul_f32 v92,v72,v72
v_mfma_f32_16x16x32_bf16 v[76:79],a[144:147],v[240:243],v[76:79]
ds_read_b128 v[236:239],v17 offset:23552
v_mul_f32 v89,v65,v65
v_mul_f32 v93,v73,v73
v_mfma_f32_16x16x32_bf16 v[68:71],a[20:23],v[244:247],v[68:71]
v_mul_f32 v90,v66,v66
v_mul_f32 v91,v67,v67
v_mul_f32 v94,v74,v74
v_mfma_f32_16x16x32_bf16 v[76:79],a[148:151],v[244:247],v[76:79]
ds_read_b128 v[240:243],v17 offset:25600
v_mul_f32 v95,v75,v75
s_waitcnt lgkmcnt(5)
v_mfma_f32_16x16x32_bf16 v[68:71],a[24:27],v[248:251],v[68:71]
v_min3_u32 v27,v27,v248,v252
v_fma_f32 v88,v88,v121,v122
v_fma_f32 v92,v92,v121,v122
v_mfma_f32_16x16x32_bf16 v[76:79],a[152:155],v[248:251],v[76:79]
ds_read_b128 v[244:247],v17 offset:27648
v_fma_f32 v89,v89,v121,v122
v_fma_f32 v93,v93,v121,v122
v_mfma_f32_16x16x32_bf16 v[68:71],a[28:31],v[252:255],v[68:71]
v_fma_f32 v90,v90,v121,v122
v_fma_f32 v91,v91,v121,v122
v_fma_f32 v94,v94,v121,v122
v_mfma_f32_16x16x32_bf16 v[76:79],a[156:159],v[252:255],v[76:79]
ds_read_b128 v[248:251],v17 offset:29696
v_fma_f32 v95,v95,v121,v122
s_waitcnt lgkmcnt(5)
v_mfma_f32_16x16x32_bf16 v[68:71],a[32:35],v[224:227],v[68:71]
v_min3_u32 v27,v27,v224,v228
v_mul_f32 v88,v88,v64
v_mul_f32 v92,v92,v72
v_mfma_f32_16x16x32_bf16 v[76:79],a[160:163],v[224:227],v[76:79]
ds_read_b128 v[252:255],v17 offset:31744
v_mul_f32 v89,v89,v65
v_mul_f32 v93,v93,v73
v_mfma_f32_16x16x32_bf16 v[68:71],a[36:39],v[228:231],v[68:71]
v_mul_f32 v90,v90,v66
v_mul_f32 v91,v91,v67
v_mul_f32 v94,v94,v74
v_mfma_f32_16x16x32_bf16 v[76:79],a[164:167],v[228:231],v[76:79]
ds_read_b128 v[224:227],v17 offset:33792
v_mul_f32 v95,v95,v75
s_waitcnt lgkmcnt(5)
v_mfma_f32_16x16x32_bf16 v[68:71],a[40:43],v[232:235],v[68:71]
v_min3_u32 v27,v27,v232,v236
v_exp_f32 v92,v92
v_mfma_f32_16x16x32_bf16 v[76:79],a[168:171],v[232:235],v[76:79]
ds_read_b128 v[228:231],v17 offset:35840
v_exp_f32 v93,v93
v_mfma_f32_16x16x32_bf16 v[68:71],a[44:47],v[236:239],v[68:71]
v_exp_f32 v88,v88
v_mfma_f32_16x16x32_bf16 v[76:79],a[172:175],v[236:239],v[76:79]
ds_read_b128 v[232:235],v17 offset:37888
s_waitcnt lgkmcnt(5)
v_mfma_f32_16x16x32_bf16 v[68:71],a[48:51],v[240:243],v[68:71]
v_min3_u32 v27,v27,v240,v244
v_exp_f32 v94,v94
v_mfma_f32_16x16x32_bf16 v[76:79],a[176:179],v[240:243],v[76:79]
ds_read_b128 v[236:239],v17 offset:39936
v_exp_f32 v95,v95
v_mfma_f32_16x16x32_bf16 v[68:71],a[52:55],v[244:247],v[68:71]
v_exp_f32 v89,v89
v_fma_f32 v92,v92,v123,v123
v_mfma_f32_16x16x32_bf16 v[76:79],a[180:183],v[244:247],v[76:79]
ds_read_b128 v[240:243],v17 offset:41984
v_fma_f32 v93,v93,v123,v123
s_waitcnt lgkmcnt(5)
v_mfma_f32_16x16x32_bf16 v[68:71],a[56:59],v[248:251],v[68:71]
v_min3_u32 v27,v27,v248,v252
v_fma_f32 v94,v94,v123,v123
v_fma_f32 v95,v95,v123,v123
v_mfma_f32_16x16x32_bf16 v[76:79],a[184:187],v[248:251],v[76:79]
ds_read_b128 v[244:247],v17 offset:44032
v_rcp_f32 v92,v92
v_mfma_f32_16x16x32_bf16 v[68:71],a[60:63],v[252:255],v[68:71]
v_exp_f32 v90,v90
v_mfma_f32_16x16x32_bf16 v[76:79],a[188:191],v[252:255],v[76:79]
ds_read_b128 v[248:251],v17 offset:46080
s_waitcnt lgkmcnt(5)
v_mfma_f32_16x16x32_bf16 v[68:71],a[64:67],v[224:227],v[68:71]
v_min3_u32 v27,v27,v224,v228
v_rcp_f32 v93,v93
v_mfma_f32_16x16x32_bf16 v[76:79],a[192:195],v[224:227],v[76:79]
ds_read_b128 v[252:255],v17 offset:48128
v_rcp_f32 v94,v94
v_mfma_f32_16x16x32_bf16 v[68:71],a[68:71],v[228:231],v[68:71]
v_exp_f32 v91,v91
v_mfma_f32_16x16x32_bf16 v[76:79],a[196:199],v[228:231],v[76:79]
ds_read_b128 v[224:227],v17 offset:50176
s_waitcnt lgkmcnt(5)
v_mfma_f32_16x16x32_bf16 v[68:71],a[72:75],v[232:235],v[68:71]
v_min3_u32 v27,v27,v232,v236
v_fma_f32 v88,v88,v123,v123
v_mfma_f32_16x16x32_bf16 v[76:79],a[200:203],v[232:235],v[76:79]
ds_read_b128 v[228:231],v17 offset:52224
v_fma_f32 v89,v89,v123,v123
v_mfma_f32_16x16x32_bf16 v[68:71],a[76:79],v[236:239],v[68:71]
v_fma_f32 v90,v90,v123,v123
v_fma_f32 v91,v91,v123,v123
v_mfma_f32_16x16x32_bf16 v[76:79],a[204:207],v[236:239],v[76:79]
ds_read_b128 v[232:235],v17 offset:54272
s_waitcnt lgkmcnt(5)
v_mfma_f32_16x16x32_bf16 v[68:71],a[80:83],v[240:243],v[68:71]
v_min3_u32 v27,v27,v240,v244
v_rcp_f32 v95,v95
v_mfma_f32_16x16x32_bf16 v[76:79],a[208:211],v[240:243],v[76:79]
ds_read_b128 v[236:239],v17 offset:56320
v_mul_f32 v92,v92,v72
v_mfma_f32_16x16x32_bf16 v[68:71],a[84:87],v[244:247],v[68:71]
v_rcp_f32 v88,v88
v_mfma_f32_16x16x32_bf16 v[76:79],a[212:215],v[244:247],v[76:79]
ds_read_b128 v[240:243],v17 offset:58368
s_waitcnt lgkmcnt(5)
v_mfma_f32_16x16x32_bf16 v[68:71],a[88:91],v[248:251],v[68:71]
v_min3_u32 v27,v27,v248,v252
v_mul_f32 v93,v93,v73
v_mfma_f32_16x16x32_bf16 v[76:79],a[216:219],v[248:251],v[76:79]
ds_read_b128 v[244:247],v17 offset:60416
v_mul_f32 v94,v94,v74
v_mfma_f32_16x16x32_bf16 v[68:71],a[92:95],v[252:255],v[68:71]
v_rcp_f32 v89,v89
v_mfma_f32_16x16x32_bf16 v[76:79],a[220:223],v[252:255],v[76:79]
ds_read_b128 v[248:251],v17 offset:62464
s_waitcnt lgkmcnt(5)
v_mfma_f32_16x16x32_bf16 v[68:71],a[96:99],v[224:227],v[68:71]
v_min3_u32 v27,v27,v224,v228
v_mul_f32 v95,v95,v75
v_mfma_f32_16x16x32_bf16 v[76:79],a[224:227],v[224:227],v[76:79]
ds_read_b128 v[252:255],v17 offset:64512
v_mfma_f32_16x16x32_bf16 v[68:71],a[100:103],v[228:231],v[68:71]
v_rcp_f32 v90,v90
v_mfma_f32_16x16x32_bf16 v[76:79],a[228:231],v[228:231],v[76:79]
s_waitcnt lgkmcnt(4)
v_mfma_f32_16x16x32_bf16 v[68:71],a[104:107],v[232:235],v[68:71]
v_min3_u32 v27,v27,v232,v236
v_mfma_f32_16x16x32_bf16 v[76:79],a[232:235],v[232:235],v[76:79]
v_rcp_f32 v91,v91
v_mfma_f32_16x16x32_bf16 v[68:71],a[108:111],v[236:239],v[68:71]
v_mul_f32 v88,v88,v64
v_mul_f32 v89,v89,v65
v_mfma_f32_16x16x32_bf16 v[76:79],a[236:239],v[236:239],v[76:79]
v_mul_f32 v90,v90,v66
s_waitcnt lgkmcnt(2)
v_mfma_f32_16x16x32_bf16 v[68:71],a[112:115],v[240:243],v[68:71]
v_min3_u32 v27,v27,v240,v244
v_mul_f32 v91,v91,v67
v_mfma_f32_16x16x32_bf16 v[76:79],a[240:243],v[240:243],v[76:79]
v_cvt_pk_bf16_f32 v96,v88,v89
v_cvt_pk_bf16_f32 v97,v90,v91
v_mfma_f32_16x16x32_bf16 v[68:71],a[116:119],v[244:247],v[68:71]
v_cvt_pk_bf16_f32 v98,v92,v93
v_cvt_pk_bf16_f32 v99,v94,v95
v_mfma_f32_16x16x32_bf16 v[76:79],a[244:247],v[244:247],v[76:79]
v_max_u32 v96,1,v96
s_waitcnt lgkmcnt(0)
v_mfma_f32_16x16x32_bf16 v[68:71],a[120:123],v[248:251],v[68:71]
v_min3_u32 v27,v27,v248,v252
v_mfma_f32_16x16x32_bf16 v[76:79],a[248:251],v[248:251],v[76:79]
buffer_store_dwordx4 v[96:99],v18,s[20:23],s70 offen offset:0 sc1
v_mfma_f32_16x16x32_bf16 v[68:71],a[124:127],v[252:255],v[68:71]
v_mfma_f32_16x16x32_bf16 v[76:79],a[252:255],v[252:255],v[76:79]
v_cmp_eq_u32 vcc,0,v27
s_cbranch_vccnz retry_334
epi_337:
buffer_load_dword v29,v21,s[20:23],s87 offen sc1
s_nop 3
v_pk_fma_f32 v[68:69],v[52:53],v[124:125],v[68:69] op_sel_hi:[1,0,1]
v_pk_fma_f32 v[70:71],v[54:55],v[124:125],v[70:71] op_sel_hi:[1,0,1]
v_pk_fma_f32 v[76:77],v[56:57],v[124:125],v[76:77] op_sel_hi:[1,0,1]
v_pk_fma_f32 v[78:79],v[58:59],v[124:125],v[78:79] op_sel_hi:[1,0,1]
v_pk_mul_f32 v[88:89],v[68:69],v[68:69]
v_pk_mul_f32 v[90:91],v[70:71],v[70:71]
v_pk_mul_f32 v[92:93],v[76:77],v[76:77]
v_pk_mul_f32 v[94:95],v[78:79],v[78:79]
v_pk_fma_f32 v[88:89],v[88:89],v[124:125],v[126:127] op_sel:[0,1,0] op_sel_hi:[1,1,0]
v_pk_fma_f32 v[90:91],v[90:91],v[124:125],v[126:127] op_sel:[0,1,0] op_sel_hi:[1,1,0]
v_pk_fma_f32 v[92:93],v[92:93],v[124:125],v[126:127] op_sel:[0,1,0] op_sel_hi:[1,1,0]
v_pk_fma_f32 v[94:95],v[94:95],v[124:125],v[126:127] op_sel:[0,1,0] op_sel_hi:[1,1,0]
v_pk_mul_f32 v[88:89],v[88:89],v[68:69]
v_pk_mul_f32 v[90:91],v[90:91],v[70:71]
v_pk_mul_f32 v[92:93],v[92:93],v[76:77]
v_pk_mul_f32 v[94:95],v[94:95],v[78:79]
v_exp_f32 v88,v88
v_exp_f32 v89,v89
v_exp_f32 v90,v90
v_exp_f32 v91,v91
v_exp_f32 v92,v92
v_exp_f32 v93,v93
v_exp_f32 v94,v94
s_cmp_gt_u32 s71,51
s_cselect_b32 s65,s73,0x7fff0000
s_cselect_b32 s97,0x7fff0000,s73
v_mov_b32 v22,s71
buffer_store_dword v22,v23,s[20:23],s65 offen sc1
v_exp_f32 v95,v95
v_pk_fma_f32 v[88:89],v[88:89],v[126:127],v[126:127] op_sel:[0,1,1] op_sel_hi:[1,1,1]
v_pk_fma_f32 v[90:91],v[90:91],v[126:127],v[126:127] op_sel:[0,1,1] op_sel_hi:[1,1,1]
v_pk_fma_f32 v[92:93],v[92:93],v[126:127],v[126:127] op_sel:[0,1,1] op_sel_hi:[1,1,1]
v_pk_fma_f32 v[94:95],v[94:95],v[126:127],v[126:127] op_sel:[0,1,1] op_sel_hi:[1,1,1]
v_rcp_f32 v88,v88
v_rcp_f32 v89,v89
v_rcp_f32 v90,v90
v_rcp_f32 v91,v91
v_rcp_f32 v92,v92
v_rcp_f32 v93,v93
v_rcp_f32 v94,v94
v_rcp_f32 v95,v95
v_pk_mul_f32 v[88:89],v[88:89],v[68:69]
v_pk_mul_f32 v[90:91],v[90:91],v[70:71]
v_pk_mul_f32 v[92:93],v[92:93],v[76:77]
v_pk_mul_f32 v[94:95],v[94:95],v[78:79]
v_cvt_pk_bf16_f32 v96,v88,v89
v_cvt_pk_bf16_f32 v97,v90,v91
v_cvt_pk_bf16_f32 v98,v92,v93
v_cvt_pk_bf16_f32 v99,v94,v95
v_max_u32 v96,1,v96
buffer_store_dwordx4 v[96:99],v18,s[20:23],s70 offen offset:1024 sc1
v_xor_b32 v17,0x10000,v17
s_xor_b32 s72,s72,0x10000
s_add_u32 s70,s70,2097152
s_xor_b32 s70,s70,0x2000
s_add_u32 s71,s71,1
s_cmp_le_u32 s71,s57
s_cbranch_scc1 seg_335
s_endpgm
retry_334:
s_sub_u32 s90,s90,64
s_cmp_lt_i32 s90,0
s_cbranch_scc1 giveup_195
s_mov_b32 s83,1
s_waitcnt vmcnt(0) lgkmcnt(0)
s_barrier
s_branch seg_335
w3b_333:
s_add_u32 s64,s79,0
s_lshl_b32 s70,s64,21
s_lshl_b32 s64,s64,13
s_and_b32 s64,s64,0x2000
s_xor_b32 s64,s64,s62
s_add_u32 s70,s70,s64
s_add_u32 s70,s70,29360128
s_mov_b32 s83,1
s_mov_b32 s87,s74
s_cmp_eq_u32 s50,0
s_cselect_b32 s74,s74,0x7fff0000
v_mov_b32 v47,132096
s_lshl_b32 s64,s50,3
s_add_u32 s64,s64,132096
v_mov_b32 v46,s64
v_mov_b32 v29,0
s_mov_b32 s97,0x7fff0000
seg_347:
s_cmp_eq_u32 s83,0
s_cbranch_scc1 ahead_348
s_add_u32 s94,s70,s75
s_xor_b32 s95,s94,1024
s_xor_b32 s91,s72,0x10000
s_waitcnt vmcnt(2)
v_cmp_gt_u32 vcc,s71,v29
s_cbranch_vccz nb_351
s_waitcnt vmcnt(0)
v_add_u32 v22,s71,-1
buffer_store_dword v22,v23,s[20:23],s97 offen sc1
s_mov_b32 s97,0x7fff0000
s_cmp_lg_u32 s50,0
s_cbranch_scc1 nb_351
buffer_load_dword v32,v21,s[20:23],s74 offen sc1
s_sleep 2
pl_352:
buffer_load_dword v33,v21,s[20:23],s74 offen sc1
s_waitcnt vmcnt(1)
v_cmp_gt_u32 vcc,s71,v32
v_mov_b32 v29,v32
s_cbranch_vccz pok_353
buffer_load_dword v32,v21,s[20:23],s74 offen sc1
s_waitcnt vmcnt(1)
v_cmp_gt_u32 vcc,s71,v33
v_mov_b32 v29,v33
s_cbranch_vccz pok_353
s_sub_u32 s90,s90,1
s_cmp_gt_i32 s90,0
s_cbranch_scc1 pl_352
pok_353:
nb_351:
s_barrier
s_xor_b32 m0,s91,0
s_add_u32 s65,s94,0
buffer_load_dwordx4 v16,s[20:23],s65 offen offset:0 sc1 lds
buffer_load_dwordx4 v16,s[20:23],s65 offen offset:2048 sc1 lds
s_xor_b32 m0,s91,16384
s_add_u32 s65,s94,32768
buffer_load_dwordx4 v16,s[20:23],s65 offen offset:0 sc1 lds
buffer_load_dwordx4 v16,s[20:23],s65 offen offset:2048 sc1 lds
s_xor_b32 m0,s91,32768
s_add_u32 s65,s94,65536
buffer_load_dwordx4 v16,s[20:23],s65 offen offset:0 sc1 lds
buffer_load_dwordx4 v16,s[20:23],s65 offen offset:2048 sc1 lds
s_xor_b32 m0,s91,49152
s_add_u32 s65,s94,98304
buffer_load_dwordx4 v16,s[20:23],s65 offen offset:0 sc1 lds
buffer_load_dwordx4 v16,s[20:23],s65 offen offset:2048 sc1 lds
s_add_u32 s66,s94,110592
buffer_load_dwordx4 v[128:131],v16,s[20:23],s66 offen offset:0 sc1
buffer_load_dwordx4 v[132:135],v16,s[20:23],s66 offen offset:1024 sc1
buffer_load_dwordx4 v[136:139],v16,s[20:23],s66 offen offset:2048 sc1
buffer_load_dwordx4 v[140:143],v16,s[20:23],s66 offen offset:3072 sc1
s_add_u32 s66,s94,114688
buffer_load_dwordx4 v[144:147],v16,s[20:23],s66 offen offset:0 sc1
buffer_load_dwordx4 v[148:151],v16,s[20:23],s66 offen offset:1024 sc1
buffer_load_dwordx4 v[152:155],v16,s[20:23],s66 offen offset:2048 sc1
buffer_load_dwordx4 v[156:159],v16,s[20:23],s66 offen offset:3072 sc1
s_waitcnt vmcnt(16)
v_add_u32 v22,s71,-1
buffer_store_dword v22,v23,s[20:23],s97 offen sc1
s_mov_b32 s97,0x7fff0000
s_waitcnt vmcnt(15)
s_barrier
ds_read_b128 v[224:227],v17 offset:0
ds_read_b128 v[228:231],v17 offset:2048
ds_read_b128 v[232:235],v17 offset:4096
ds_read_b128 v[236:239],v17 offset:6144
ds_read_b128 v[240:243],v17 offset:8192
ds_read_b128 v[244:247],v17 offset:10240
ds_read_b128 v[248:251],v17 offset:12288
s_waitcnt lgkmcnt(5)
v_mfma_f32_16x16x32_bf16 v[64:67],a[0:3],v[224:227],0
ds_read_b128 v[252:255],v17 offset:14336
s_xor_b32 m0,s91,1024
s_add_u32 s65,s95,0
buffer_load_dwordx4 v16,s[20:23],s65 offen offset:0 sc1 lds
buffer_load_dwordx4 v16,s[20:23],s65 offen offset:2048 sc1 lds
v_min_u32 v27,v224,v228
v_mfma_f32_16x16x32_bf16 v[72:75],a[4:7],v[228:231],0
s_waitcnt vmcnt(15)
s_barrier
ds_read_b128 v[224:227],v17 offset:16384
s_xor_b32 m0,s91,17408
s_add_u32 s65,s95,32768
s_waitcnt lgkmcnt(5)
v_mfma_f32_16x16x32_bf16 v[64:67],a[8:11],v[232:235],v[64:67]
ds_read_b128 v[228:231],v17 offset:18432
buffer_load_dwordx4 v16,s[20:23],s65 offen offset:0 sc1 lds
buffer_load_dwordx4 v16,s[20:23],s65 offen offset:2048 sc1 lds
s_xor_b32 m0,s91,33792
v_min3_u32 v27,v27,v232,v236
v_mfma_f32_16x16x32_bf16 v[72:75],a[12:15],v[236:239],v[72:75]
ds_read_b128 v[232:235],v17 offset:20480
s_add_u32 s65,s95,65536
buffer_load_dwordx4 v16,s[20:23],s65 offen offset:0 sc1 lds
s_waitcnt lgkmcnt(5)
v_mfma_f32_16x16x32_bf16 v[64:67],a[16:19],v[240:243],v[64:67]
ds_read_b128 v[236:239],v17 offset:22528
buffer_load_dwordx4 v16,s[20:23],s65 offen offset:2048 sc1 lds
s_xor_b32 m0,s91,50176
s_add_u32 s65,s95,98304
v_min3_u32 v27,v27,v240,v244
v_mfma_f32_16x16x32_bf16 v[72:75],a[20:23],v[244:247],v[72:75]
ds_read_b128 v[240:243],v17 offset:24576
buffer_load_dwordx4 v16,s[20:23],s65 offen offset:0 sc1 lds
buffer_load_dwordx4 v16,s[20:23],s65 offen offset:2048 sc1 lds
s_waitcnt lgkmcnt(5)
v_mfma_f32_16x16x32_bf16 v[64:67],a[24:27],v[248:251],v[64:67]
ds_read_b128 v[244:247],v17 offset:26624
v_min3_u32 v27,v27,v248,v252
v_mfma_f32_16x16x32_bf16 v[72:75],a[28:31],v[252:255],v[72:75]
ds_read_b128 v[248:251],v17 offset:28672
s_waitcnt lgkmcnt(5)
v_mfma_f32_16x16x32_bf16 v[64:67],a[32:35],v[224:227],v[64:67]
ds_read_b128 v[252:255],v17 offset:30720
v_min3_u32 v27,v27,v224,v228
v_mfma_f32_16x16x32_bf16 v[72:75],a[36:39],v[228:231],v[72:75]
s_waitcnt vmcnt(17)
s_barrier
ds_read_b128 v[224:227],v17 offset:32768
s_waitcnt lgkmcnt(5)
v_mfma_f32_16x16x32_bf16 v[64:67],a[40:43],v[232:235],v[64:67]
ds_read_b128 v[228:231],v17 offset:34816
v_min3_u32 v27,v27,v232,v236
v_mfma_f32_16x16x32_bf16 v[72:75],a[44:47],v[236:239],v[72:75]
ds_read_b128 v[232:235],v17 offset:36864
s_waitcnt lgkmcnt(5)
v_mfma_f32_16x16x32_bf16 v[64:67],a[48:51],v[240:243],v[64:67]
ds_read_b128 v[236:239],v17 offset:38912
v_min3_u32 v27,v27,v240,v244
v_mfma_f32_16x16x32_bf16 v[72:75],a[52:55],v[244:247],v[72:75]
ds_read_b128 v[240:243],v17 offset:40960
s_add_u32 s88,s70,s75
s_add_u32 s88,s88,2097152
s_xor_b32 s88,s88,0x2000
s_xor_b32 s89,s88,1024
s_waitcnt lgkmcnt(5)
v_mfma_f32_16x16x32_bf16 v[64:67],a[56:59],v[248:251],v[64:67]
ds_read_b128 v[244:247],v17 offset:43008
v_min3_u32 v27,v27,v248,v252
v_mfma_f32_16x16x32_bf16 v[72:75],a[60:63],v[252:255],v[72:75]
ds_read_b128 v[248:251],v17 offset:45056
s_waitcnt lgkmcnt(5)
v_mfma_f32_16x16x32_bf16 v[64:67],a[64:67],v[224:227],v[64:67]
ds_read_b128 v[252:255],v17 offset:47104
v_min3_u32 v27,v27,v224,v228
v_mfma_f32_16x16x32_bf16 v[72:75],a[68:71],v[228:231],v[72:75]
ds_read_b128 v[224:227],v17 offset:49152
s_waitcnt lgkmcnt(5)
v_mfma_f32_16x16x32_bf16 v[64:67],a[72:75],v[232:235],v[64:67]
ds_read_b128 v[228:231],v17 offset:51200
v_min3_u32 v27,v27,v232,v236
v_mfma_f32_16x16x32_bf16 v[72:75],a[76:79],v[236:239],v[72:75]
ds_read_b128 v[232:235],v17 offset:53248
s_waitcnt lgkmcnt(5)
v_mfma_f32_16x16x32_bf16 v[64:67],a[80:83],v[240:243],v[64:67]
ds_read_b128 v[236:239],v17 offset:55296
v_min3_u32 v27,v27,v240,v244
v_mfma_f32_16x16x32_bf16 v[72:75],a[84:87],v[244:247],v[72:75]
ds_read_b128 v[240:243],v17 offset:57344
s_waitcnt lgkmcnt(5)
v_mfma_f32_16x16x32_bf16 v[64:67],a[88:91],v[248:251],v[64:67]
ds_read_b128 v[244:247],v17 offset:59392
v_min3_u32 v27,v27,v248,v252
v_mfma_f32_16x16x32_bf16 v[72:75],a[92:95],v[252:255],v[72:75]
ds_read_b128 v[248:251],v17 offset:61440
s_waitcnt vmcnt(9)
stk_358:
v_min3_u32 v22,v129,v133,v137
v_min3_u32 v22,v22,v141,v145
v_min3_u32 v22,v22,v149,v153
v_min_u32 v22,v22,v157
v_cmp_eq_u32 vcc,0,v22
s_cmp_lt_i32 s90,0
s_cselect_b64 vcc,0,vcc
s_cbranch_vccnz str_359
v_pk_add_f32 v[88:89],v[128:129],v[144:145]
v_pk_add_f32 v[90:91],v[130:131],v[146:147]
v_pk_add_f32 v[92:93],v[132:133],v[148:149]
v_pk_add_f32 v[94:95],v[134:135],v[150:151]
v_pk_add_f32 v[96:97],v[136:137],v[152:153]
v_pk_add_f32 v[98:99],v[138:139],v[154:155]
v_pk_add_f32 v[100:101],v[140:141],v[156:157]
v_pk_add_f32 v[102:103],v[142:143],v[158:159]
v_pk_add_f32 v[88:89],v[88:89],v[96:97]
v_pk_add_f32 v[90:91],v[90:91],v[98:99]
v_pk_add_f32 v[92:93],v[92:93],v[100:101]
v_pk_add_f32 v[94:95],v[94:95],v[102:103]
v_pk_add_f32 v[88:89],v[88:89],v[92:93]
v_pk_add_f32 v[90:91],v[90:91],v[94:95]
v_mov_b32 v92,v88
v_mov_b32 v93,v89
v_mov_b32 v94,v90
v_mov_b32 v95,v91
v_permlane16_swap_b32 v92,v88
v_permlane16_swap_b32 v93,v89
v_permlane16_swap_b32 v94,v90
v_permlane16_swap_b32 v95,v91
v_pk_add_f32 v[88:89],v[88:89],v[92:93]
v_pk_add_f32 v[90:91],v[90:91],v[94:95]
v_mov_b32 v92,v88
v_mov_b32 v93,v89
s_waitcnt lgkmcnt(5)
v_mfma_f32_16x16x32_bf16 v[64:67],a[96:99],v[224:227],v[64:67]
ds_read_b128 v[252:255],v17 offset:63488
v_min3_u32 v27,v27,v224,v228
v_mov_b32 v94,v90
v_mov_b32 v95,v91
v_permlane32_swap_b32 v92,v88
v_permlane32_swap_b32 v93,v89
v_permlane32_swap_b32 v94,v90
v_permlane32_swap_b32 v95,v91
v_pk_add_f32 v[88:89],v[88:89],v[92:93]
v_pk_add_f32 v[90:91],v[90:91],v[94:95]
v_mul_f32 v120,0xba800000,v88
v_mul_f32 v124,0xba800000,v90
v_mul_f32 v92,v120,v120
v_mul_f32 v93,v124,v124
v_fma_f32 v92,v89,s82,-v92
v_fma_f32 v93,v91,s82,-v93
v_max_f32 v92,0,v92
v_max_f32 v93,0,v93
v_add_f32 v92,0x3727c5ac,v92
v_add_f32 v93,0x3727c5ac,v93
v_rsq_f32 v94,v92
v_rsq_f32 v95,v93
v_mul_f32 v123,v92,v94
v_mul_f32 v127,v93,v95
v_mul_f32 v122,v28,v94
v_mul_f32 v126,v28,v95
v_mul_f32 v92,v94,v94
v_mul_f32 v93,v95,v95
v_mul_f32 v94,s81,v94
v_mul_f32 v95,s81,v95
v_mul_f32 v121,v92,v94
v_mul_f32 v125,v93,v95
ds_write_b128 v19,v[120:123] offset:0
ds_write_b128 v19,v[124:127] offset:256
v_mfma_f32_16x16x32_bf16 v[72:75],a[100:103],v[228:231],v[72:75]
s_waitcnt vmcnt(4) lgkmcnt(0)
s_barrier
ds_read_b64 v[44:45],v47
ds_read_b128 v[224:227],v17 offset:1024
v_mfma_f32_16x16x32_bf16 v[64:67],a[104:107],v[232:235],v[64:67]
ds_read_b128 v[228:231],v17 offset:3072
v_min3_u32 v27,v27,v232,v236
v_mfma_f32_16x16x32_bf16 v[72:75],a[108:111],v[236:239],v[72:75]
ds_read_b128 v[232:235],v17 offset:5120
v_mfma_f32_16x16x32_bf16 v[64:67],a[112:115],v[240:243],v[64:67]
ds_read_b128 v[236:239],v17 offset:7168
v_min3_u32 v27,v27,v240,v244
v_mfma_f32_16x16x32_bf16 v[72:75],a[116:119],v[244:247],v[72:75]
ds_read_b128 v[240:243],v17 offset:9216
s_waitcnt lgkmcnt(5)
v_readfirstlane_b32 s93,v45
v_mfma_f32_16x16x32_bf16 v[64:67],a[120:123],v[248:251],v[64:67]
ds_read_b128 v[244:247],v17 offset:11264
v_readfirstlane_b32 s83,v44
s_cmp_lg_u32 s83,0
s_cbranch_scc0 keep_354
v_min3_u32 v27,v27,v248,v252
v_mfma_f32_16x16x32_bf16 v[72:75],a[124:127],v[252:255],v[72:75]
ds_read_b128 v[248:251],v17 offset:13312
s_waitcnt lgkmcnt(5)
v_mfma_f32_16x16x32_bf16 v[68:71],a[0:3],v[224:227],0
ds_read_b128 v[252:255],v17 offset:15360
v_cmp_eq_u32 vcc,0,v27
s_cbranch_vccnz retry_346
v_min3_u32 v27,v27,v224,v228
v_mfma_f32_16x16x32_bf16 v[76:79],a[4:7],v[228:231],0
ds_read_b128 v[224:227],v17 offset:17408
s_waitcnt lgkmcnt(5)
v_mfma_f32_16x16x32_bf16 v[68:71],a[8:11],v[232:235],v[68:71]
ds_read_b128 v[228:231],v17 offset:19456
v_min3_u32 v27,v27,v232,v236
v_mfma_f32_16x16x32_bf16 v[76:79],a[12:15],v[236:239],v[76:79]
ds_read_b128 v[232:235],v17 offset:21504
s_waitcnt lgkmcnt(5)
v_mfma_f32_16x16x32_bf16 v[68:71],a[16:19],v[240:243],v[68:71]
ds_read_b128 v[236:239],v17 offset:23552
v_min3_u32 v27,v27,v240,v244
v_add_f32 v64,v64,v72
v_add_f32 v65,v65,v73
v_add_f32 v66,v66,v74
v_add_f32 v67,v67,v75
v_mfma_f32_16x16x32_bf16 v[76:79],a[20:23],v[244:247],v[76:79]
ds_read_b128 v[240:243],v17 offset:25600
v_fmac_f32 v64,v52,v120
v_fmac_f32 v65,v53,v120
v_fmac_f32 v66,v54,v120
v_fmac_f32 v67,v55,v120
s_waitcnt lgkmcnt(5)
v_mfma_f32_16x16x32_bf16 v[68:71],a[24:27],v[248:251],v[68:71]
ds_read_b128 v[244:247],v17 offset:27648
v_min3_u32 v27,v27,v248,v252
v_mul_f32 v88,v64,v64
v_mul_f32 v89,v65,v65
v_mul_f32 v90,v66,v66
v_mul_f32 v91,v67,v67
v_mfma_f32_16x16x32_bf16 v[76:79],a[28:31],v[252:255],v[76:79]
ds_read_b128 v[248:251],v17 offset:29696
v_fma_f32 v88,v88,v121,v122
v_fma_f32 v89,v89,v121,v122
v_fma_f32 v90,v90,v121,v122
v_fma_f32 v91,v91,v121,v122
s_waitcnt lgkmcnt(5)
v_mfma_f32_16x16x32_bf16 v[68:71],a[32:35],v[224:227],v[68:71]
ds_read_b128 v[252:255],v17 offset:31744
v_min3_u32 v27,v27,v224,v228
v_mul_f32 v88,v88,v64
v_mul_f32 v89,v89,v65
v_mul_f32 v90,v90,v66
v_mul_f32 v91,v91,v67
v_mfma_f32_16x16x32_bf16 v[76:79],a[36:39],v[228:231],v[76:79]
s_waitcnt vmcnt(0)
s_barrier
ds_read_b128 v[224:227],v17 offset:33792
v_exp_f32 v88,v88
s_waitcnt lgkmcnt(5)
v_mfma_f32_16x16x32_bf16 v[68:71],a[40:43],v[232:235],v[68:71]
ds_read_b128 v[228:231],v17 offset:35840
v_min3_u32 v27,v27,v232,v236
v_exp_f32 v89,v89
v_exp_f32 v90,v90
v_mfma_f32_16x16x32_bf16 v[76:79],a[44:47],v[236:239],v[76:79]
ds_read_b128 v[232:235],v17 offset:37888
v_exp_f32 v91,v91
v_fma_f32 v88,v88,v123,v123
v_fma_f32 v89,v89,v123,v123
s_waitcnt lgkmcnt(5)
v_mfma_f32_16x16x32_bf16 v[68:71],a[48:51],v[240:243],v[68:71]
ds_read_b128 v[236:239],v17 offset:39936
v_min3_u32 v27,v27,v240,v244
v_fma_f32 v90,v90,v123,v123
v_fma_f32 v91,v91,v123,v123
v_rcp_f32 v88,v88
v_mfma_f32_16x16x32_bf16 v[76:79],a[52:55],v[244:247],v[76:79]
ds_read_b128 v[240:243],v17 offset:41984
v_rcp_f32 v89,v89
v_rcp_f32 v90,v90
s_waitcnt lgkmcnt(5)
v_mfma_f32_16x16x32_bf16 v[68:71],a[56:59],v[248:251],v[68:71]
ds_read_b128 v[244:247],v17 offset:44032
v_min3_u32 v27,v27,v248,v252
v_rcp_f32 v91,v91
v_mul_f32 v88,v88,v64
v_mul_f32 v89,v89,v65
v_mfma_f32_16x16x32_bf16 v[76:79],a[60:63],v[252:255],v[76:79]
ds_read_b128 v[248:251],v17 offset:46080
v_mul_f32 v90,v90,v66
v_mul_f32 v91,v91,v67
v_cvt_pk_bf16_f32 v96,v88,v89
v_cvt_pk_bf16_f32 v97,v90,v91
s_waitcnt lgkmcnt(5)
v_mfma_f32_16x16x32_bf16 v[68:71],a[64:67],v[224:227],v[68:71]
ds_read_b128 v[252:255],v17 offset:48128
v_min3_u32 v27,v27,v224,v228
v_max_u32 v96,1,v96
buffer_store_dwordx2 v[96:97],v18,s[20:23],s70 offen offset:0 sc1
v_mfma_f32_16x16x32_bf16 v[76:79],a[68:71],v[228:231],v[76:79]
ds_read_b128 v[224:227],v17 offset:50176
s_waitcnt lgkmcnt(5)
v_mfma_f32_16x16x32_bf16 v[68:71],a[72:75],v[232:235],v[68:71]
ds_read_b128 v[228:231],v17 offset:52224
v_min3_u32 v27,v27,v232,v236
v_mfma_f32_16x16x32_bf16 v[76:79],a[76:79],v[236:239],v[76:79]
ds_read_b128 v[232:235],v17 offset:54272
s_waitcnt lgkmcnt(5)
v_mfma_f32_16x16x32_bf16 v[68:71],a[80:83],v[240:243],v[68:71]
ds_read_b128 v[236:239],v17 offset:56320
v_min3_u32 v27,v27,v240,v244
v_mfma_f32_16x16x32_bf16 v[76:79],a[84:87],v[244:247],v[76:79]
ds_read_b128 v[240:243],v17 offset:58368
s_waitcnt lgkmcnt(5)
v_mfma_f32_16x16x32_bf16 v[68:71],a[88:91],v[248:251],v[68:71]
ds_read_b128 v[244:247],v17 offset:60416
v_min3_u32 v27,v27,v248,v252
v_mfma_f32_16x16x32_bf16 v[76:79],a[92:95],v[252:255],v[76:79]
ds_read_b128 v[248:251],v17 offset:62464
s_waitcnt lgkmcnt(5)
v_mfma_f32_16x16x32_bf16 v[68:71],a[96:99],v[224:227],v[68:71]
ds_read_b128 v[252:255],v17 offset:64512
v_min3_u32 v27,v27,v224,v228
v_mfma_f32_16x16x32_bf16 v[76:79],a[100:103],v[228:231],v[76:79]
s_waitcnt lgkmcnt(4)
v_mfma_f32_16x16x32_bf16 v[68:71],a[104:107],v[232:235],v[68:71]
v_min3_u32 v27,v27,v232,v236
v_mfma_f32_16x16x32_bf16 v[76:79],a[108:111],v[236:239],v[76:79]
s_waitcnt lgkmcnt(2)
v_mfma_f32_16x16x32_bf16 v[68:71],a[112:115],v[240:243],v[68:71]
v_min3_u32 v27,v27,v240,v244
v_mfma_f32_16x16x32_bf16 v[76:79],a[116:119],v[244:247],v[76:79]
s_waitcnt lgkmcnt(0)
v_mfma_f32_16x16x32_bf16 v[68:71],a[120:123],v[248:251],v[68:71]
v_min3_u32 v27,v27,v248,v252
v_mfma_f32_16x16x32_bf16 v[76:79],a[124:127],v[252:255],v[76:79]
v_cmp_eq_u32 vcc,0,v27
s_cbranch_vccnz retry_346
s_branch epi_349
keep_354:
v_min3_u32 v27,v27,v248,v252
v_mfma_f32_16x16x32_bf16 v[72:75],a[124:127],v[252:255],v[72:75]
ds_read_b128 v[248:251],v17 offset:13312
s_add_u32 s66,s88,110592
buffer_load_dwordx4 v[128:131],v16,s[20:23],s66 offen offset:0 sc1
buffer_load_dwordx4 v[132:135],v16,s[20:23],s66 offen offset:1024 sc1
s_waitcnt lgkmcnt(5)
v_mfma_f32_16x16x32_bf16 v[68:71],a[0:3],v[224:227],0
ds_read_b128 v[252:255],v17 offset:15360
v_cmp_eq_u32 vcc,0,v27
s_cbranch_vccnz retry_346
v_min3_u32 v27,v27,v224,v228
buffer_load_dwordx4 v[136:139],v16,s[20:23],s66 offen offset:2048 sc1
v_mfma_f32_16x16x32_bf16 v[76:79],a[4:7],v[228:231],0
ds_read_b128 v[224:227],v17 offset:17408
buffer_load_dwordx4 v[140:143],v16,s[20:23],s66 offen offset:3072 sc1
s_add_u32 s66,s88,114688
buffer_load_dwordx4 v[144:147],v16,s[20:23],s66 offen offset:0 sc1
s_waitcnt lgkmcnt(5)
v_mfma_f32_16x16x32_bf16 v[68:71],a[8:11],v[232:235],v[68:71]
ds_read_b128 v[228:231],v17 offset:19456
v_min3_u32 v27,v27,v232,v236
buffer_load_dwordx4 v[148:151],v16,s[20:23],s66 offen offset:1024 sc1
buffer_load_dwordx4 v[152:155],v16,s[20:23],s66 offen offset:2048 sc1
v_mfma_f32_16x16x32_bf16 v[76:79],a[12:15],v[236:239],v[76:79]
ds_read_b128 v[232:235],v17 offset:21504
buffer_load_dwordx4 v[156:159],v16,s[20:23],s66 offen offset:3072 sc1
s_waitcnt lgkmcnt(5)
v_mfma_f32_16x16x32_bf16 v[68:71],a[16:19],v[240:243],v[68:71]
ds_read_b128 v[236:239],v17 offset:23552
v_min3_u32 v27,v27,v240,v244
v_add_f32 v64,v64,v72
v_add_f32 v65,v65,v73
v_add_f32 v66,v66,v74
v_add_f32 v67,v67,v75
s_xor_b32 m0,s72,0
v_mfma_f32_16x16x32_bf16 v[76:79],a[20:23],v[244:247],v[76:79]
ds_read_b128 v[240:243],v17 offset:25600
v_fmac_f32 v64,v52,v120
v_fmac_f32 v65,v53,v120
v_fmac_f32 v66,v54,v120
v_fmac_f32 v67,v55,v120
s_add_u32 s65,s88,0
s_waitcnt lgkmcnt(5)
v_mfma_f32_16x16x32_bf16 v[68:71],a[24:27],v[248:251],v[68:71]
ds_read_b128 v[244:247],v17 offset:27648
v_min3_u32 v27,v27,v248,v252
v_mul_f32 v88,v64,v64
v_mul_f32 v89,v65,v65
v_mul_f32 v90,v66,v66
v_mul_f32 v91,v67,v67
v_mfma_f32_16x16x32_bf16 v[76:79],a[28:31],v[252:255],v[76:79]
ds_read_b128 v[248:251],v17 offset:29696
v_fma_f32 v88,v88,v121,v122
v_fma_f32 v89,v89,v121,v122
v_fma_f32 v90,v90,v121,v122
v_fma_f32 v91,v91,v121,v122
s_waitcnt lgkmcnt(5)
v_mfma_f32_16x16x32_bf16 v[68:71],a[32:35],v[224:227],v[68:71]
ds_read_b128 v[252:255],v17 offset:31744
v_min3_u32 v27,v27,v224,v228
v_mul_f32 v88,v88,v64
v_mul_f32 v89,v89,v65
v_mul_f32 v90,v90,v66
v_mul_f32 v91,v91,v67
v_mfma_f32_16x16x32_bf16 v[76:79],a[36:39],v[228:231],v[76:79]
s_waitcnt vmcnt(8)
s_barrier
ds_read_b128 v[224:227],v17 offset:33792
v_exp_f32 v88,v88
s_waitcnt lgkmcnt(5)
v_mfma_f32_16x16x32_bf16 v[68:71],a[40:43],v[232:235],v[68:71]
ds_read_b128 v[228:231],v17 offset:35840
v_min3_u32 v27,v27,v232,v236
v_exp_f32 v89,v89
v_exp_f32 v90,v90
v_mfma_f32_16x16x32_bf16 v[76:79],a[44:47],v[236:239],v[76:79]
ds_read_b128 v[232:235],v17 offset:37888
v_exp_f32 v91,v91
v_fma_f32 v88,v88,v123,v123
v_fma_f32 v89,v89,v123,v123
s_waitcnt lgkmcnt(5)
v_mfma_f32_16x16x32_bf16 v[68:71],a[48:51],v[240:243],v[68:71]
ds_read_b128 v[236:239],v17 offset:39936
v_min3_u32 v27,v27,v240,v244
v_fma_f32 v90,v90,v123,v123
v_fma_f32 v91,v91,v123,v123
v_rcp_f32 v88,v88
v_mfma_f32_16x16x32_bf16 v[76:79],a[52:55],v[244:247],v[76:79]
ds_read_b128 v[240:243],v17 offset:41984
v_rcp_f32 v89,v89
v_rcp_f32 v90,v90
s_waitcnt lgkmcnt(5)
v_mfma_f32_16x16x32_bf16 v[68:71],a[56:59],v[248:251],v[68:71]
ds_read_b128 v[244:247],v17 offset:44032
v_min3_u32 v27,v27,v248,v252
v_rcp_f32 v91,v91
v_mul_f32 v88,v88,v64
v_mul_f32 v89,v89,v65
v_mfma_f32_16x16x32_bf16 v[76:79],a[60:63],v[252:255],v[76:79]
ds_read_b128 v[248:251],v17 offset:46080
v_mul_f32 v90,v90,v66
v_mul_f32 v91,v91,v67
v_cvt_pk_bf16_f32 v96,v88,v89
v_cvt_pk_bf16_f32 v97,v90,v91
s_waitcnt lgkmcnt(5)
v_mfma_f32_16x16x32_bf16 v[68:71],a[64:67],v[224:227],v[68:71]
ds_read_b128 v[252:255],v17 offset:48128
v_min3_u32 v27,v27,v224,v228
v_max_u32 v96,1,v96
buffer_store_dwordx2 v[96:97],v18,s[20:23],s70 offen offset:0 sc1
buffer_load_dwordx4 v16,s[20:23],s65 offen offset:0 sc1 lds
v_mfma_f32_16x16x32_bf16 v[76:79],a[68:71],v[228:231],v[76:79]
ds_read_b128 v[224:227],v17 offset:50176
buffer_load_dwordx4 v16,s[20:23],s65 offen offset:2048 sc1 lds
s_xor_b32 m0,s72,16384
s_add_u32 s65,s88,32768
s_waitcnt lgkmcnt(5)
v_mfma_f32_16x16x32_bf16 v[68:71],a[72:75],v[232:235],v[68:71]
ds_read_b128 v[228:231],v17 offset:52224
v_min3_u32 v27,v27,v232,v236
buffer_load_dwordx4 v16,s[20:23],s65 offen offset:0 sc1 lds
buffer_load_dwordx4 v16,s[20:23],s65 offen offset:2048 sc1 lds
s_xor_b32 m0,s72,32768
v_mfma_f32_16x16x32_bf16 v[76:79],a[76:79],v[236:239],v[76:79]
ds_read_b128 v[232:235],v17 offset:54272
s_add_u32 s65,s88,65536
buffer_load_dwordx4 v16,s[20:23],s65 offen offset:0 sc1 lds
buffer_load_dwordx4 v16,s[20:23],s65 offen offset:2048 sc1 lds
s_waitcnt lgkmcnt(5)
v_mfma_f32_16x16x32_bf16 v[68:71],a[80:83],v[240:243],v[68:71]
ds_read_b128 v[236:239],v17 offset:56320
v_min3_u32 v27,v27,v240,v244
s_xor_b32 m0,s72,49152
s_add_u32 s65,s88,98304
buffer_load_dwordx4 v16,s[20:23],s65 offen offset:0 sc1 lds
v_mfma_f32_16x16x32_bf16 v[76:79],a[84:87],v[244:247],v[76:79]
ds_read_b128 v[240:243],v17 offset:58368
buffer_load_dwordx4 v16,s[20:23],s65 offen offset:2048 sc1 lds
s_xor_b32 m0,s72,1024
s_add_u32 s65,s89,0
s_waitcnt lgkmcnt(5)
v_mfma_f32_16x16x32_bf16 v[68:71],a[88:91],v[248:251],v[68:71]
ds_read_b128 v[244:247],v17 offset:60416
v_min3_u32 v27,v27,v248,v252
buffer_load_dwordx4 v16,s[20:23],s65 offen offset:0 sc1 lds
buffer_load_dwordx4 v16,s[20:23],s65 offen offset:2048 sc1 lds
v_mfma_f32_16x16x32_bf16 v[76:79],a[92:95],v[252:255],v[76:79]
ds_read_b128 v[248:251],v17 offset:62464
s_xor_b32 m0,s72,17408
s_add_u32 s65,s89,32768
buffer_load_dwordx4 v16,s[20:23],s65 offen offset:0 sc1 lds
s_waitcnt lgkmcnt(5)
v_mfma_f32_16x16x32_bf16 v[68:71],a[96:99],v[224:227],v[68:71]
ds_read_b128 v[252:255],v17 offset:64512
v_min3_u32 v27,v27,v224,v228
buffer_load_dwordx4 v16,s[20:23],s65 offen offset:2048 sc1 lds
s_xor_b32 m0,s72,33792
s_add_u32 s65,s89,65536
v_mfma_f32_16x16x32_bf16 v[76:79],a[100:103],v[228:231],v[76:79]
buffer_load_dwordx4 v16,s[20:23],s65 offen offset:0 sc1 lds
buffer_load_dwordx4 v16,s[20:23],s65 offen offset:2048 sc1 lds
s_xor_b32 m0,s72,50176
s_waitcnt lgkmcnt(4)
v_mfma_f32_16x16x32_bf16 v[68:71],a[104:107],v[232:235],v[68:71]
v_min3_u32 v27,v27,v232,v236
s_add_u32 s65,s89,98304
buffer_load_dwordx4 v16,s[20:23],s65 offen offset:0 sc1 lds
buffer_load_dwordx4 v16,s[20:23],s65 offen offset:2048 sc1 lds
v_mfma_f32_16x16x32_bf16 v[76:79],a[108:111],v[236:239],v[76:79]
s_waitcnt lgkmcnt(2)
v_mfma_f32_16x16x32_bf16 v[68:71],a[112:115],v[240:243],v[68:71]
v_min3_u32 v27,v27,v240,v244
v_mfma_f32_16x16x32_bf16 v[76:79],a[116:119],v[244:247],v[76:79]
s_waitcnt lgkmcnt(0)
v_mfma_f32_16x16x32_bf16 v[68:71],a[120:123],v[248:251],v[68:71]
v_min3_u32 v27,v27,v248,v252
v_mfma_f32_16x16x32_bf16 v[76:79],a[124:127],v[252:255],v[76:79]
v_cmp_eq_u32 vcc,0,v27
s_cbranch_vccnz retry_346
s_branch epi_349
ahead_348:
s_cmp_eq_u32 s93,0
s_cbranch_scc1 both_350
s_waitcnt vmcnt(11) lgkmcnt(0)
s_barrier
ds_read_b128 v[224:227],v17 offset:0
ds_read_b128 v[228:231],v17 offset:2048
ds_read_b128 v[232:235],v17 offset:4096
ds_read_b128 v[236:239],v17 offset:6144
ds_read_b128 v[240:243],v17 offset:8192
ds_read_b128 v[244:247],v17 offset:10240
ds_read_b128 v[248:251],v17 offset:12288
s_waitcnt lgkmcnt(5)
v_mfma_f32_16x16x32_bf16 v[64:67],a[0:3],v[224:227],0
ds_read_b128 v[252:255],v17 offset:14336
v_min_u32 v27,v224,v228
s_waitcnt vmcnt(12)
stk_360:
v_min3_u32 v22,v129,v133,v137
v_min3_u32 v22,v22,v141,v145
v_min3_u32 v22,v22,v149,v153
v_min_u32 v22,v22,v157
v_cmp_eq_u32 vcc,0,v22
s_cmp_lt_i32 s90,0
s_cselect_b64 vcc,0,vcc
s_cbranch_vccnz str_361
v_mfma_f32_16x16x32_bf16 v[72:75],a[4:7],v[228:231],0
ds_read_b128 v[224:227],v17 offset:16384
v_pk_add_f32 v[88:89],v[128:129],v[144:145]
v_pk_add_f32 v[90:91],v[130:131],v[146:147]
v_pk_add_f32 v[92:93],v[132:133],v[148:149]
v_pk_add_f32 v[94:95],v[134:135],v[150:151]
s_waitcnt lgkmcnt(5)
v_mfma_f32_16x16x32_bf16 v[64:67],a[8:11],v[232:235],v[64:67]
ds_read_b128 v[228:231],v17 offset:18432
v_min3_u32 v27,v27,v232,v236
v_pk_add_f32 v[96:97],v[136:137],v[152:153]
v_pk_add_f32 v[98:99],v[138:139],v[154:155]
v_pk_add_f32 v[100:101],v[140:141],v[156:157]
v_pk_add_f32 v[102:103],v[142:143],v[158:159]
v_mfma_f32_16x16x32_bf16 v[72:75],a[12:15],v[236:239],v[72:75]
ds_read_b128 v[232:235],v17 offset:20480
s_waitcnt lgkmcnt(5)
v_mfma_f32_16x16x32_bf16 v[64:67],a[16:19],v[240:243],v[64:67]
ds_read_b128 v[236:239],v17 offset:22528
v_min3_u32 v27,v27,v240,v244
v_pk_add_f32 v[88:89],v[88:89],v[96:97]
v_pk_add_f32 v[90:91],v[90:91],v[98:99]
v_pk_add_f32 v[92:93],v[92:93],v[100:101]
v_mfma_f32_16x16x32_bf16 v[72:75],a[20:23],v[244:247],v[72:75]
ds_read_b128 v[240:243],v17 offset:24576
v_pk_add_f32 v[94:95],v[94:95],v[102:103]
v_pk_add_f32 v[88:89],v[88:89],v[92:93]
v_pk_add_f32 v[90:91],v[90:91],v[94:95]
s_waitcnt lgkmcnt(5)
v_mfma_f32_16x16x32_bf16 v[64:67],a[24:27],v[248:251],v[64:67]
ds_read_b128 v[244:247],v17 offset:26624
v_min3_u32 v27,v27,v248,v252
v_mov_b32 v92,v88
v_mov_b32 v93,v89
v_mov_b32 v94,v90
v_mfma_f32_16x16x32_bf16 v[72:75],a[28:31],v[252:255],v[72:75]
ds_read_b128 v[248:251],v17 offset:28672
v_mov_b32 v95,v91
v_permlane16_swap_b32 v92,v88
v_permlane16_swap_b32 v93,v89
s_waitcnt lgkmcnt(5)
v_mfma_f32_16x16x32_bf16 v[64:67],a[32:35],v[224:227],v[64:67]
ds_read_b128 v[252:255],v17 offset:30720
v_min3_u32 v27,v27,v224,v228
v_permlane16_swap_b32 v94,v90
v_permlane16_swap_b32 v95,v91
v_mfma_f32_16x16x32_bf16 v[72:75],a[36:39],v[228:231],v[72:75]
ds_read_b128 v[224:227],v17 offset:32768
v_pk_add_f32 v[88:89],v[88:89],v[92:93]
v_pk_add_f32 v[90:91],v[90:91],v[94:95]
v_mov_b32 v92,v88
s_waitcnt lgkmcnt(5)
v_mfma_f32_16x16x32_bf16 v[64:67],a[40:43],v[232:235],v[64:67]
ds_read_b128 v[228:231],v17 offset:34816
v_min3_u32 v27,v27,v232,v236
v_mov_b32 v93,v89
v_mov_b32 v94,v90
v_mov_b32 v95,v91
v_mfma_f32_16x16x32_bf16 v[72:75],a[44:47],v[236:239],v[72:75]
ds_read_b128 v[232:235],v17 offset:36864
v_permlane32_swap_b32 v92,v88
v_permlane32_swap_b32 v93,v89
v_permlane32_swap_b32 v94,v90
s_waitcnt lgkmcnt(5)
v_mfma_f32_16x16x32_bf16 v[64:67],a[48:51],v[240:243],v[64:67]
ds_read_b128 v[236:239],v17 offset:38912
v_min3_u32 v27,v27,v240,v244
v_permlane32_swap_b32 v95,v91
v_pk_add_f32 v[88:89],v[88:89],v[92:93]
v_mfma_f32_16x16x32_bf16 v[72:75],a[52:55],v[244:247],v[72:75]
ds_read_b128 v[240:243],v17 offset:40960
v_pk_add_f32 v[90:91],v[90:91],v[94:95]
v_mul_f32 v120,0xba800000,v88
v_mul_f32 v124,0xba800000,v90
s_add_u32 s88,s70,s75
s_waitcnt lgkmcnt(5)
v_mfma_f32_16x16x32_bf16 v[64:67],a[56:59],v[248:251],v[64:67]
ds_read_b128 v[244:247],v17 offset:43008
v_min3_u32 v27,v27,v248,v252
v_mul_f32 v92,v120,v120
v_mul_f32 v93,v124,v124
v_fma_f32 v92,v89,s82,-v92
s_add_u32 s88,s88,2097152
v_mfma_f32_16x16x32_bf16 v[72:75],a[60:63],v[252:255],v[72:75]
ds_read_b128 v[248:251],v17 offset:45056
v_fma_f32 v93,v91,s82,-v93
v_max_f32 v92,0,v92
v_max_f32 v93,0,v93
s_xor_b32 s88,s88,0x2000
s_waitcnt lgkmcnt(5)
v_mfma_f32_16x16x32_bf16 v[64:67],a[64:67],v[224:227],v[64:67]
ds_read_b128 v[252:255],v17 offset:47104
v_min3_u32 v27,v27,v224,v228
v_add_f32 v92,0x3727c5ac,v92
v_add_f32 v93,0x3727c5ac,v93
v_rsq_f32 v94,v92
v_mfma_f32_16x16x32_bf16 v[72:75],a[68:71],v[228:231],v[72:75]
ds_read_b128 v[224:227],v17 offset:49152
v_rsq_f32 v95,v93
v_mul_f32 v123,v92,v94
s_xor_b32 s89,s88,1024
s_waitcnt lgkmcnt(5)
v_mfma_f32_16x16x32_bf16 v[64:67],a[72:75],v[232:235],v[64:67]
ds_read_b128 v[228:231],v17 offset:51200
v_min3_u32 v27,v27,v232,v236
v_mul_f32 v127,v93,v95
v_mul_f32 v122,v28,v94
v_mul_f32 v126,v28,v95
v_mfma_f32_16x16x32_bf16 v[72:75],a[76:79],v[236:239],v[72:75]
ds_read_b128 v[232:235],v17 offset:53248
v_mul_f32 v92,v94,v94
v_mul_f32 v93,v95,v95
v_mul_f32 v94,s81,v94
s_waitcnt lgkmcnt(5)
v_mfma_f32_16x16x32_bf16 v[64:67],a[80:83],v[240:243],v[64:67]
ds_read_b128 v[236:239],v17 offset:55296
v_min3_u32 v27,v27,v240,v244
v_mul_f32 v95,s81,v95
v_mul_f32 v121,v92,v94
v_mul_f32 v125,v93,v95
v_mfma_f32_16x16x32_bf16 v[72:75],a[84:87],v[244:247],v[72:75]
ds_read_b128 v[240:243],v17 offset:57344
ds_write_b128 v19,v[120:123] offset:0
ds_write_b128 v19,v[124:127] offset:256
s_waitcnt lgkmcnt(7)
v_mfma_f32_16x16x32_bf16 v[64:67],a[88:91],v[248:251],v[64:67]
ds_read_b128 v[244:247],v17 offset:59392
v_min3_u32 v27,v27,v248,v252
v_mfma_f32_16x16x32_bf16 v[72:75],a[92:95],v[252:255],v[72:75]
ds_read_b128 v[248:251],v17 offset:61440
s_waitcnt lgkmcnt(7)
v_mfma_f32_16x16x32_bf16 v[64:67],a[96:99],v[224:227],v[64:67]
ds_read_b128 v[252:255],v17 offset:63488
v_min3_u32 v27,v27,v224,v228
v_mfma_f32_16x16x32_bf16 v[72:75],a[100:103],v[228:231],v[72:75]
s_waitcnt vmcnt(3) lgkmcnt(0)
s_barrier
ds_read_b64 v[44:45],v47
ds_read_b128 v[224:227],v17 offset:1024
s_waitcnt vmcnt(0)
v_add_u32 v22,s71,-1
v_mfma_f32_16x16x32_bf16 v[64:67],a[104:107],v[232:235],v[64:67]
ds_read_b128 v[228:231],v17 offset:3072
v_min3_u32 v27,v27,v232,v236
buffer_store_dword v22,v23,s[20:23],s97 offen sc1
s_mov_b32 s97,0x7fff0000
v_mfma_f32_16x16x32_bf16 v[72:75],a[108:111],v[236:239],v[72:75]
ds_read_b128 v[232:235],v17 offset:5120
v_mfma_f32_16x16x32_bf16 v[64:67],a[112:115],v[240:243],v[64:67]
ds_read_b128 v[236:239],v17 offset:7168
v_min3_u32 v27,v27,v240,v244
v_mfma_f32_16x16x32_bf16 v[72:75],a[116:119],v[244:247],v[72:75]
ds_read_b128 v[240:243],v17 offset:9216
s_waitcnt lgkmcnt(5)
v_readfirstlane_b32 s93,v45
v_mfma_f32_16x16x32_bf16 v[64:67],a[120:123],v[248:251],v[64:67]
ds_read_b128 v[244:247],v17 offset:11264
v_readfirstlane_b32 s83,v44
s_cmp_lg_u32 s83,0
s_cbranch_scc1 keep_355
v_min3_u32 v27,v27,v248,v252
v_mfma_f32_16x16x32_bf16 v[72:75],a[124:127],v[252:255],v[72:75]
ds_read_b128 v[248:251],v17 offset:13312
s_add_u32 s66,s88,110592
buffer_load_dwordx4 v[128:131],v16,s[20:23],s66 offen offset:0 sc1
buffer_load_dwordx4 v[132:135],v16,s[20:23],s66 offen offset:1024 sc1
s_waitcnt lgkmcnt(5)
v_mfma_f32_16x16x32_bf16 v[68:71],a[0:3],v[224:227],0
ds_read_b128 v[252:255],v17 offset:15360
v_cmp_eq_u32 vcc,0,v27
s_cbranch_vccnz retry_346
v_min3_u32 v27,v27,v224,v228
buffer_load_dwordx4 v[136:139],v16,s[20:23],s66 offen offset:2048 sc1
v_mfma_f32_16x16x32_bf16 v[76:79],a[4:7],v[228:231],0
ds_read_b128 v[224:227],v17 offset:17408
buffer_load_dwordx4 v[140:143],v16,s[20:23],s66 offen offset:3072 sc1
s_add_u32 s66,s88,114688
buffer_load_dwordx4 v[144:147],v16,s[20:23],s66 offen offset:0 sc1
s_waitcnt lgkmcnt(5)
v_mfma_f32_16x16x32_bf16 v[68:71],a[8:11],v[232:235],v[68:71]
ds_read_b128 v[228:231],v17 offset:19456
v_min3_u32 v27,v27,v232,v236
buffer_load_dwordx4 v[148:151],v16,s[20:23],s66 offen offset:1024 sc1
buffer_load_dwordx4 v[152:155],v16,s[20:23],s66 offen offset:2048 sc1
v_mfma_f32_16x16x32_bf16 v[76:79],a[12:15],v[236:239],v[76:79]
ds_read_b128 v[232:235],v17 offset:21504
buffer_load_dwordx4 v[156:159],v16,s[20:23],s66 offen offset:3072 sc1
s_waitcnt lgkmcnt(5)
v_mfma_f32_16x16x32_bf16 v[68:71],a[16:19],v[240:243],v[68:71]
ds_read_b128 v[236:239],v17 offset:23552
v_min3_u32 v27,v27,v240,v244
v_add_f32 v64,v64,v72
v_add_f32 v65,v65,v73
v_add_f32 v66,v66,v74
v_add_f32 v67,v67,v75
s_xor_b32 m0,s72,0
v_mfma_f32_16x16x32_bf16 v[76:79],a[20:23],v[244:247],v[76:79]
ds_read_b128 v[240:243],v17 offset:25600
v_fmac_f32 v64,v52,v120
v_fmac_f32 v65,v53,v120
v_fmac_f32 v66,v54,v120
v_fmac_f32 v67,v55,v120
s_add_u32 s65,s88,0
s_waitcnt lgkmcnt(5)
v_mfma_f32_16x16x32_bf16 v[68:71],a[24:27],v[248:251],v[68:71]
ds_read_b128 v[244:247],v17 offset:27648
v_min3_u32 v27,v27,v248,v252
v_mul_f32 v88,v64,v64
v_mul_f32 v89,v65,v65
v_mul_f32 v90,v66,v66
v_mul_f32 v91,v67,v67
v_mfma_f32_16x16x32_bf16 v[76:79],a[28:31],v[252:255],v[76:79]
ds_read_b128 v[248:251],v17 offset:29696
v_fma_f32 v88,v88,v121,v122
v_fma_f32 v89,v89,v121,v122
v_fma_f32 v90,v90,v121,v122
v_fma_f32 v91,v91,v121,v122
s_waitcnt lgkmcnt(5)
v_mfma_f32_16x16x32_bf16 v[68:71],a[32:35],v[224:227],v[68:71]
ds_read_b128 v[252:255],v17 offset:31744
v_min3_u32 v27,v27,v224,v228
v_mul_f32 v88,v88,v64
v_mul_f32 v89,v89,v65
v_mul_f32 v90,v90,v66
v_mul_f32 v91,v91,v67
v_mfma_f32_16x16x32_bf16 v[76:79],a[36:39],v[228:231],v[76:79]
ds_read_b128 v[224:227],v17 offset:33792
v_exp_f32 v88,v88
v_exp_f32 v89,v89
s_waitcnt lgkmcnt(5)
v_mfma_f32_16x16x32_bf16 v[68:71],a[40:43],v[232:235],v[68:71]
ds_read_b128 v[228:231],v17 offset:35840
v_min3_u32 v27,v27,v232,v236
v_exp_f32 v90,v90
v_exp_f32 v91,v91
v_mfma_f32_16x16x32_bf16 v[76:79],a[44:47],v[236:239],v[76:79]
ds_read_b128 v[232:235],v17 offset:37888
v_fma_f32 v88,v88,v123,v123
v_fma_f32 v89,v89,v123,v123
v_fma_f32 v90,v90,v123,v123
v_fma_f32 v91,v91,v123,v123
s_waitcnt lgkmcnt(5)
v_mfma_f32_16x16x32_bf16 v[68:71],a[48:51],v[240:243],v[68:71]
ds_read_b128 v[236:239],v17 offset:39936
v_min3_u32 v27,v27,v240,v244
v_rcp_f32 v88,v88
v_rcp_f32 v89,v89
v_mfma_f32_16x16x32_bf16 v[76:79],a[52:55],v[244:247],v[76:79]
ds_read_b128 v[240:243],v17 offset:41984
v_rcp_f32 v90,v90
v_rcp_f32 v91,v91
s_waitcnt lgkmcnt(5)
v_mfma_f32_16x16x32_bf16 v[68:71],a[56:59],v[248:251],v[68:71]
ds_read_b128 v[244:247],v17 offset:44032
v_min3_u32 v27,v27,v248,v252
v_mul_f32 v88,v88,v64
v_mul_f32 v89,v89,v65
v_mul_f32 v90,v90,v66
v_mul_f32 v91,v91,v67
v_mfma_f32_16x16x32_bf16 v[76:79],a[60:63],v[252:255],v[76:79]
ds_read_b128 v[248:251],v17 offset:46080
v_cvt_pk_bf16_f32 v96,v88,v89
v_cvt_pk_bf16_f32 v97,v90,v91
v_max_u32 v96,1,v96
buffer_load_dwordx4 v16,s[20:23],s65 offen offset:0 sc1 lds
s_waitcnt lgkmcnt(5)
v_mfma_f32_16x16x32_bf16 v[68:71],a[64:67],v[224:227],v[68:71]
ds_read_b128 v[252:255],v17 offset:48128
v_min3_u32 v27,v27,v224,v228
buffer_store_dwordx2 v[96:97],v18,s[20:23],s70 offen offset:0 sc1
buffer_load_dwordx4 v16,s[20:23],s65 offen offset:2048 sc1 lds
v_mfma_f32_16x16x32_bf16 v[76:79],a[68:71],v[228:231],v[76:79]
ds_read_b128 v[224:227],v17 offset:50176
s_xor_b32 m0,s72,16384
s_add_u32 s65,s88,32768
buffer_load_dwordx4 v16,s[20:23],s65 offen offset:0 sc1 lds
s_waitcnt lgkmcnt(5)
v_mfma_f32_16x16x32_bf16 v[68:71],a[72:75],v[232:235],v[68:71]
ds_read_b128 v[228:231],v17 offset:52224
v_min3_u32 v27,v27,v232,v236
buffer_load_dwordx4 v16,s[20:23],s65 offen offset:2048 sc1 lds
s_xor_b32 m0,s72,32768
s_add_u32 s65,s88,65536
v_mfma_f32_16x16x32_bf16 v[76:79],a[76:79],v[236:239],v[76:79]
ds_read_b128 v[232:235],v17 offset:54272
buffer_load_dwordx4 v16,s[20:23],s65 offen offset:0 sc1 lds
buffer_load_dwordx4 v16,s[20:23],s65 offen offset:2048 sc1 lds
s_waitcnt lgkmcnt(5)
v_mfma_f32_16x16x32_bf16 v[68:71],a[80:83],v[240:243],v[68:71]
ds_read_b128 v[236:239],v17 offset:56320
v_min3_u32 v27,v27,v240,v244
s_xor_b32 m0,s72,49152
s_add_u32 s65,s88,98304
buffer_load_dwordx4 v16,s[20:23],s65 offen offset:0 sc1 lds
v_mfma_f32_16x16x32_bf16 v[76:79],a[84:87],v[244:247],v[76:79]
ds_read_b128 v[240:243],v17 offset:58368
buffer_load_dwordx4 v16,s[20:23],s65 offen offset:2048 sc1 lds
s_xor_b32 m0,s72,1024
s_add_u32 s65,s89,0
s_waitcnt lgkmcnt(5)
v_mfma_f32_16x16x32_bf16 v[68:71],a[88:91],v[248:251],v[68:71]
ds_read_b128 v[244:247],v17 offset:60416
v_min3_u32 v27,v27,v248,v252
buffer_load_dwordx4 v16,s[20:23],s65 offen offset:0 sc1 lds
buffer_load_dwordx4 v16,s[20:23],s65 offen offset:2048 sc1 lds
v_mfma_f32_16x16x32_bf16 v[76:79],a[92:95],v[252:255],v[76:79]
ds_read_b128 v[248:251],v17 offset:62464
s_xor_b32 m0,s72,17408
s_add_u32 s65,s89,32768
buffer_load_dwordx4 v16,s[20:23],s65 offen offset:0 sc1 lds
s_waitcnt lgkmcnt(5)
v_mfma_f32_16x16x32_bf16 v[68:71],a[96:99],v[224:227],v[68:71]
ds_read_b128 v[252:255],v17 offset:64512
v_min3_u32 v27,v27,v224,v228
buffer_load_dwordx4 v16,s[20:23],s65 offen offset:2048 sc1 lds
s_xor_b32 m0,s72,33792
s_add_u32 s65,s89,65536
v_mfma_f32_16x16x32_bf16 v[76:79],a[100:103],v[228:231],v[76:79]
buffer_load_dwordx4 v16,s[20:23],s65 offen offset:0 sc1 lds
buffer_load_dwordx4 v16,s[20:23],s65 offen offset:2048 sc1 lds
s_xor_b32 m0,s72,50176
s_waitcnt lgkmcnt(4)
v_mfma_f32_16x16x32_bf16 v[68:71],a[104:107],v[232:235],v[68:71]
v_min3_u32 v27,v27,v232,v236
s_add_u32 s65,s89,98304
buffer_load_dwordx4 v16,s[20:23],s65 offen offset:0 sc1 lds
buffer_load_dwordx4 v16,s[20:23],s65 offen offset:2048 sc1 lds
v_mfma_f32_16x16x32_bf16 v[76:79],a[108:111],v[236:239],v[76:79]
s_waitcnt lgkmcnt(2)
v_mfma_f32_16x16x32_bf16 v[68:71],a[112:115],v[240:243],v[68:71]
v_min3_u32 v27,v27,v240,v244
v_mfma_f32_16x16x32_bf16 v[76:79],a[116:119],v[244:247],v[76:79]
s_waitcnt lgkmcnt(0)
v_mfma_f32_16x16x32_bf16 v[68:71],a[120:123],v[248:251],v[68:71]
v_min3_u32 v27,v27,v248,v252
v_mfma_f32_16x16x32_bf16 v[76:79],a[124:127],v[252:255],v[76:79]
v_cmp_eq_u32 vcc,0,v27
s_cbranch_vccnz retry_346
s_branch epi_349
keep_355:
v_min3_u32 v27,v27,v248,v252
v_mfma_f32_16x16x32_bf16 v[72:75],a[124:127],v[252:255],v[72:75]
ds_read_b128 v[248:251],v17 offset:13312
s_waitcnt lgkmcnt(5)
v_mfma_f32_16x16x32_bf16 v[68:71],a[0:3],v[224:227],0
ds_read_b128 v[252:255],v17 offset:15360
v_cmp_eq_u32 vcc,0,v27
s_cbranch_vccnz retry_346
v_min3_u32 v27,v27,v224,v228
v_mfma_f32_16x16x32_bf16 v[76:79],a[4:7],v[228:231],0
ds_read_b128 v[224:227],v17 offset:17408
s_waitcnt lgkmcnt(5)
v_mfma_f32_16x16x32_bf16 v[68:71],a[8:11],v[232:235],v[68:71]
ds_read_b128 v[228:231],v17 offset:19456
v_min3_u32 v27,v27,v232,v236
v_mfma_f32_16x16x32_bf16 v[76:79],a[12:15],v[236:239],v[76:79]
ds_read_b128 v[232:235],v17 offset:21504
s_waitcnt lgkmcnt(5)
v_mfma_f32_16x16x32_bf16 v[68:71],a[16:19],v[240:243],v[68:71]
ds_read_b128 v[236:239],v17 offset:23552
v_min3_u32 v27,v27,v240,v244
v_add_f32 v64,v64,v72
v_add_f32 v65,v65,v73
v_add_f32 v66,v66,v74
v_add_f32 v67,v67,v75
v_mfma_f32_16x16x32_bf16 v[76:79],a[20:23],v[244:247],v[76:79]
ds_read_b128 v[240:243],v17 offset:25600
v_fmac_f32 v64,v52,v120
v_fmac_f32 v65,v53,v120
v_fmac_f32 v66,v54,v120
v_fmac_f32 v67,v55,v120
s_waitcnt lgkmcnt(5)
v_mfma_f32_16x16x32_bf16 v[68:71],a[24:27],v[248:251],v[68:71]
ds_read_b128 v[244:247],v17 offset:27648
v_min3_u32 v27,v27,v248,v252
v_mul_f32 v88,v64,v64
v_mul_f32 v89,v65,v65
v_mul_f32 v90,v66,v66
v_mul_f32 v91,v67,v67
v_mfma_f32_16x16x32_bf16 v[76:79],a[28:31],v[252:255],v[76:79]
ds_read_b128 v[248:251],v17 offset:29696
v_fma_f32 v88,v88,v121,v122
v_fma_f32 v89,v89,v121,v122
v_fma_f32 v90,v90,v121,v122
v_fma_f32 v91,v91,v121,v122
s_waitcnt lgkmcnt(5)
v_mfma_f32_16x16x32_bf16 v[68:71],a[32:35],v[224:227],v[68:71]
ds_read_b128 v[252:255],v17 offset:31744
v_min3_u32 v27,v27,v224,v228
v_mul_f32 v88,v88,v64
v_mul_f32 v89,v89,v65
v_mul_f32 v90,v90,v66
v_mul_f32 v91,v91,v67
v_mfma_f32_16x16x32_bf16 v[76:79],a[36:39],v[228:231],v[76:79]
ds_read_b128 v[224:227],v17 offset:33792
v_exp_f32 v88,v88
v_exp_f32 v89,v89
s_waitcnt lgkmcnt(5)
v_mfma_f32_16x16x32_bf16 v[68:71],a[40:43],v[232:235],v[68:71]
ds_read_b128 v[228:231],v17 offset:35840
v_min3_u32 v27,v27,v232,v236
v_exp_f32 v90,v90
v_exp_f32 v91,v91
v_mfma_f32_16x16x32_bf16 v[76:79],a[44:47],v[236:239],v[76:79]
ds_read_b128 v[232:235],v17 offset:37888
v_fma_f32 v88,v88,v123,v123
v_fma_f32 v89,v89,v123,v123
v_fma_f32 v90,v90,v123,v123
v_fma_f32 v91,v91,v123,v123
s_waitcnt lgkmcnt(5)
v_mfma_f32_16x16x32_bf16 v[68:71],a[48:51],v[240:243],v[68:71]
ds_read_b128 v[236:239],v17 offset:39936
v_min3_u32 v27,v27,v240,v244
v_rcp_f32 v88,v88
v_rcp_f32 v89,v89
v_mfma_f32_16x16x32_bf16 v[76:79],a[52:55],v[244:247],v[76:79]
ds_read_b128 v[240:243],v17 offset:41984
v_rcp_f32 v90,v90
v_rcp_f32 v91,v91
s_waitcnt lgkmcnt(5)
v_mfma_f32_16x16x32_bf16 v[68:71],a[56:59],v[248:251],v[68:71]
ds_read_b128 v[244:247],v17 offset:44032
v_min3_u32 v27,v27,v248,v252
v_mul_f32 v88,v88,v64
v_mul_f32 v89,v89,v65
v_mul_f32 v90,v90,v66
v_mul_f32 v91,v91,v67
v_mfma_f32_16x16x32_bf16 v[76:79],a[60:63],v[252:255],v[76:79]
ds_read_b128 v[248:251],v17 offset:46080
v_cvt_pk_bf16_f32 v96,v88,v89
v_cvt_pk_bf16_f32 v97,v90,v91
v_max_u32 v96,1,v96
s_waitcnt lgkmcnt(5)
v_mfma_f32_16x16x32_bf16 v[68:71],a[64:67],v[224:227],v[68:71]
ds_read_b128 v[252:255],v17 offset:48128
v_min3_u32 v27,v27,v224,v228
buffer_store_dwordx2 v[96:97],v18,s[20:23],s70 offen offset:0 sc1
v_mfma_f32_16x16x32_bf16 v[76:79],a[68:71],v[228:231],v[76:79]
ds_read_b128 v[224:227],v17 offset:50176
s_waitcnt lgkmcnt(5)
v_mfma_f32_16x16x32_bf16 v[68:71],a[72:75],v[232:235],v[68:71]
ds_read_b128 v[228:231],v17 offset:52224
v_min3_u32 v27,v27,v232,v236
v_mfma_f32_16x16x32_bf16 v[76:79],a[76:79],v[236:239],v[76:79]
ds_read_b128 v[232:235],v17 offset:54272
s_waitcnt lgkmcnt(5)
v_mfma_f32_16x16x32_bf16 v[68:71],a[80:83],v[240:243],v[68:71]
ds_read_b128 v[236:239],v17 offset:56320
v_min3_u32 v27,v27,v240,v244
v_mfma_f32_16x16x32_bf16 v[76:79],a[84:87],v[244:247],v[76:79]
ds_read_b128 v[240:243],v17 offset:58368
s_waitcnt lgkmcnt(5)
v_mfma_f32_16x16x32_bf16 v[68:71],a[88:91],v[248:251],v[68:71]
ds_read_b128 v[244:247],v17 offset:60416
v_min3_u32 v27,v27,v248,v252
v_mfma_f32_16x16x32_bf16 v[76:79],a[92:95],v[252:255],v[76:79]
ds_read_b128 v[248:251],v17 offset:62464
s_waitcnt lgkmcnt(5)
v_mfma_f32_16x16x32_bf16 v[68:71],a[96:99],v[224:227],v[68:71]
ds_read_b128 v[252:255],v17 offset:64512
v_min3_u32 v27,v27,v224,v228
v_mfma_f32_16x16x32_bf16 v[76:79],a[100:103],v[228:231],v[76:79]
s_waitcnt lgkmcnt(4)
v_mfma_f32_16x16x32_bf16 v[68:71],a[104:107],v[232:235],v[68:71]
v_min3_u32 v27,v27,v232,v236
v_mfma_f32_16x16x32_bf16 v[76:79],a[108:111],v[236:239],v[76:79]
s_waitcnt lgkmcnt(2)
v_mfma_f32_16x16x32_bf16 v[68:71],a[112:115],v[240:243],v[68:71]
v_min3_u32 v27,v27,v240,v244
v_mfma_f32_16x16x32_bf16 v[76:79],a[116:119],v[244:247],v[76:79]
s_waitcnt lgkmcnt(0)
v_mfma_f32_16x16x32_bf16 v[68:71],a[120:123],v[248:251],v[68:71]
v_min3_u32 v27,v27,v248,v252
v_mfma_f32_16x16x32_bf16 v[76:79],a[124:127],v[252:255],v[76:79]
v_cmp_eq_u32 vcc,0,v27
s_cbranch_vccnz retry_346
s_branch epi_349
both_350:
s_waitcnt vmcnt(11) lgkmcnt(0)
s_barrier
ds_read_b128 v[224:227],v17 offset:0
ds_read_b128 v[228:231],v17 offset:2048
ds_read_b128 v[232:235],v17 offset:4096
ds_read_b128 v[236:239],v17 offset:6144
ds_read_b128 v[240:243],v17 offset:8192
ds_read_b128 v[244:247],v17 offset:10240
ds_read_b128 v[248:251],v17 offset:12288
s_waitcnt lgkmcnt(5)
v_mfma_f32_16x16x32_bf16 v[64:67],a[0:3],v[224:227],0
ds_read_b128 v[252:255],v17 offset:14336
v_min_u32 v27,v224,v228
s_waitcnt vmcnt(12)
stk_362:
v_min3_u32 v22,v129,v133,v137
v_min3_u32 v22,v22,v141,v145
v_min3_u32 v22,v22,v149,v153
v_min_u32 v22,v22,v157
v_cmp_eq_u32 vcc,0,v22
s_cmp_lt_i32 s90,0
s_cselect_b64 vcc,0,vcc
s_cbranch_vccnz str_363
v_mfma_f32_16x16x32_bf16 v[72:75],a[4:7],v[228:231],0
ds_read_b128 v[224:227],v17 offset:16384
v_pk_add_f32 v[88:89],v[128:129],v[144:145]
v_pk_add_f32 v[90:91],v[130:131],v[146:147]
v_pk_add_f32 v[92:93],v[132:133],v[148:149]
v_pk_add_f32 v[94:95],v[134:135],v[150:151]
s_waitcnt lgkmcnt(5)
v_mfma_f32_16x16x32_bf16 v[64:67],a[8:11],v[232:235],v[64:67]
ds_read_b128 v[228:231],v17 offset:18432
v_min3_u32 v27,v27,v232,v236
v_pk_add_f32 v[96:97],v[136:137],v[152:153]
v_pk_add_f32 v[98:99],v[138:139],v[154:155]
v_pk_add_f32 v[100:101],v[140:141],v[156:157]
v_pk_add_f32 v[102:103],v[142:143],v[158:159]
v_mfma_f32_16x16x32_bf16 v[72:75],a[12:15],v[236:239],v[72:75]
ds_read_b128 v[232:235],v17 offset:20480
s_add_u32 s88,s70,s75
s_add_u32 s88,s88,2097152
s_xor_b32 s88,s88,0x2000
s_xor_b32 s89,s88,1024
s_waitcnt lgkmcnt(5)
v_mfma_f32_16x16x32_bf16 v[64:67],a[16:19],v[240:243],v[64:67]
ds_read_b128 v[236:239],v17 offset:22528
v_min3_u32 v27,v27,v240,v244
v_pk_add_f32 v[88:89],v[88:89],v[96:97]
v_pk_add_f32 v[90:91],v[90:91],v[98:99]
v_pk_add_f32 v[92:93],v[92:93],v[100:101]
v_mfma_f32_16x16x32_bf16 v[72:75],a[20:23],v[244:247],v[72:75]
ds_read_b128 v[240:243],v17 offset:24576
v_pk_add_f32 v[94:95],v[94:95],v[102:103]
v_pk_add_f32 v[88:89],v[88:89],v[92:93]
v_pk_add_f32 v[90:91],v[90:91],v[94:95]
s_waitcnt lgkmcnt(5)
v_mfma_f32_16x16x32_bf16 v[64:67],a[24:27],v[248:251],v[64:67]
ds_read_b128 v[244:247],v17 offset:26624
v_min3_u32 v27,v27,v248,v252
v_mov_b32 v92,v88
v_mov_b32 v93,v89
v_mov_b32 v94,v90
v_mfma_f32_16x16x32_bf16 v[72:75],a[28:31],v[252:255],v[72:75]
ds_read_b128 v[248:251],v17 offset:28672
v_mov_b32 v95,v91
v_permlane16_swap_b32 v92,v88
v_permlane16_swap_b32 v93,v89
s_waitcnt lgkmcnt(5)
v_mfma_f32_16x16x32_bf16 v[64:67],a[32:35],v[224:227],v[64:67]
ds_read_b128 v[252:255],v17 offset:30720
v_min3_u32 v27,v27,v224,v228
v_permlane16_swap_b32 v94,v90
v_permlane16_swap_b32 v95,v91
s_add_u32 s66,s88,110592
buffer_load_dwordx4 v[128:131],v16,s[20:23],s66 offen offset:0 sc1
v_mfma_f32_16x16x32_bf16 v[72:75],a[36:39],v[228:231],v[72:75]
ds_read_b128 v[224:227],v17 offset:32768
v_pk_add_f32 v[88:89],v[88:89],v[92:93]
v_pk_add_f32 v[90:91],v[90:91],v[94:95]
v_mov_b32 v92,v88
buffer_load_dwordx4 v[132:135],v16,s[20:23],s66 offen offset:1024 sc1
s_waitcnt lgkmcnt(5)
v_mfma_f32_16x16x32_bf16 v[64:67],a[40:43],v[232:235],v[64:67]
ds_read_b128 v[228:231],v17 offset:34816
v_min3_u32 v27,v27,v232,v236
v_mov_b32 v93,v89
v_mov_b32 v94,v90
v_mov_b32 v95,v91
buffer_load_dwordx4 v[136:139],v16,s[20:23],s66 offen offset:2048 sc1
v_mfma_f32_16x16x32_bf16 v[72:75],a[44:47],v[236:239],v[72:75]
ds_read_b128 v[232:235],v17 offset:36864
v_permlane32_swap_b32 v92,v88
v_permlane32_swap_b32 v93,v89
v_permlane32_swap_b32 v94,v90
buffer_load_dwordx4 v[140:143],v16,s[20:23],s66 offen offset:3072 sc1
s_waitcnt lgkmcnt(5)
v_mfma_f32_16x16x32_bf16 v[64:67],a[48:51],v[240:243],v[64:67]
ds_read_b128 v[236:239],v17 offset:38912
v_min3_u32 v27,v27,v240,v244
v_permlane32_swap_b32 v95,v91
v_pk_add_f32 v[88:89],v[88:89],v[92:93]
s_add_u32 s66,s88,114688
buffer_load_dwordx4 v[144:147],v16,s[20:23],s66 offen offset:0 sc1
v_mfma_f32_16x16x32_bf16 v[72:75],a[52:55],v[244:247],v[72:75]
ds_read_b128 v[240:243],v17 offset:40960
v_pk_add_f32 v[90:91],v[90:91],v[94:95]
v_mul_f32 v120,0xba800000,v88
v_mul_f32 v124,0xba800000,v90
buffer_load_dwordx4 v[148:151],v16,s[20:23],s66 offen offset:1024 sc1
s_waitcnt lgkmcnt(5)
v_mfma_f32_16x16x32_bf16 v[64:67],a[56:59],v[248:251],v[64:67]
ds_read_b128 v[244:247],v17 offset:43008
v_min3_u32 v27,v27,v248,v252
v_mul_f32 v92,v120,v120
v_mul_f32 v93,v124,v124
v_fma_f32 v92,v89,s82,-v92
buffer_load_dwordx4 v[152:155],v16,s[20:23],s66 offen offset:2048 sc1
v_mfma_f32_16x16x32_bf16 v[72:75],a[60:63],v[252:255],v[72:75]
ds_read_b128 v[248:251],v17 offset:45056
v_fma_f32 v93,v91,s82,-v93
v_max_f32 v92,0,v92
v_max_f32 v93,0,v93
buffer_load_dwordx4 v[156:159],v16,s[20:23],s66 offen offset:3072 sc1
s_waitcnt lgkmcnt(5)
v_mfma_f32_16x16x32_bf16 v[64:67],a[64:67],v[224:227],v[64:67]
ds_read_b128 v[252:255],v17 offset:47104
v_min3_u32 v27,v27,v224,v228
v_add_f32 v92,0x3727c5ac,v92
v_add_f32 v93,0x3727c5ac,v93
v_rsq_f32 v94,v92
s_xor_b32 m0,s72,0
v_mfma_f32_16x16x32_bf16 v[72:75],a[68:71],v[228:231],v[72:75]
ds_read_b128 v[224:227],v17 offset:49152
v_rsq_f32 v95,v93
v_mul_f32 v123,v92,v94
s_add_u32 s65,s88,0
s_waitcnt lgkmcnt(5)
v_mfma_f32_16x16x32_bf16 v[64:67],a[72:75],v[232:235],v[64:67]
ds_read_b128 v[228:231],v17 offset:51200
v_min3_u32 v27,v27,v232,v236
v_mul_f32 v127,v93,v95
v_mul_f32 v122,v28,v94
v_mul_f32 v126,v28,v95
buffer_load_dwordx4 v16,s[20:23],s65 offen offset:0 sc1 lds
v_mfma_f32_16x16x32_bf16 v[72:75],a[76:79],v[236:239],v[72:75]
ds_read_b128 v[232:235],v17 offset:53248
v_mul_f32 v92,v94,v94
v_mul_f32 v93,v95,v95
v_mul_f32 v94,s81,v94
buffer_load_dwordx4 v16,s[20:23],s65 offen offset:2048 sc1 lds
s_waitcnt lgkmcnt(5)
v_mfma_f32_16x16x32_bf16 v[64:67],a[80:83],v[240:243],v[64:67]
ds_read_b128 v[236:239],v17 offset:55296
v_min3_u32 v27,v27,v240,v244
v_mul_f32 v95,s81,v95
v_mul_f32 v121,v92,v94
v_mul_f32 v125,v93,v95
s_xor_b32 m0,s72,16384
v_mfma_f32_16x16x32_bf16 v[72:75],a[84:87],v[244:247],v[72:75]
ds_read_b128 v[240:243],v17 offset:57344
ds_write_b128 v19,v[120:123] offset:0
ds_write_b128 v19,v[124:127] offset:256
s_add_u32 s65,s88,32768
s_waitcnt lgkmcnt(7)
v_mfma_f32_16x16x32_bf16 v[64:67],a[88:91],v[248:251],v[64:67]
ds_read_b128 v[244:247],v17 offset:59392
v_min3_u32 v27,v27,v248,v252
buffer_load_dwordx4 v16,s[20:23],s65 offen offset:0 sc1 lds
buffer_load_dwordx4 v16,s[20:23],s65 offen offset:2048 sc1 lds
v_mfma_f32_16x16x32_bf16 v[72:75],a[92:95],v[252:255],v[72:75]
ds_read_b128 v[248:251],v17 offset:61440
s_xor_b32 m0,s72,32768
s_add_u32 s65,s88,65536
buffer_load_dwordx4 v16,s[20:23],s65 offen offset:0 sc1 lds
s_waitcnt lgkmcnt(7)
v_mfma_f32_16x16x32_bf16 v[64:67],a[96:99],v[224:227],v[64:67]
ds_read_b128 v[252:255],v17 offset:63488
v_min3_u32 v27,v27,v224,v228
buffer_load_dwordx4 v16,s[20:23],s65 offen offset:2048 sc1 lds
s_xor_b32 m0,s72,49152
s_add_u32 s65,s88,98304
v_mfma_f32_16x16x32_bf16 v[72:75],a[100:103],v[228:231],v[72:75]
s_waitcnt vmcnt(17) lgkmcnt(0)
s_barrier
ds_read_b64 v[44:45],v47
ds_read_b128 v[224:227],v17 offset:1024
s_waitcnt vmcnt(14)
v_add_u32 v22,s71,-1
v_mfma_f32_16x16x32_bf16 v[64:67],a[104:107],v[232:235],v[64:67]
ds_read_b128 v[228:231],v17 offset:3072
v_min3_u32 v27,v27,v232,v236
buffer_store_dword v22,v23,s[20:23],s97 offen sc1
s_mov_b32 s97,0x7fff0000
v_mfma_f32_16x16x32_bf16 v[72:75],a[108:111],v[236:239],v[72:75]
ds_read_b128 v[232:235],v17 offset:5120
buffer_load_dwordx4 v16,s[20:23],s65 offen offset:0 sc1 lds
buffer_load_dwordx4 v16,s[20:23],s65 offen offset:2048 sc1 lds
v_mfma_f32_16x16x32_bf16 v[64:67],a[112:115],v[240:243],v[64:67]
ds_read_b128 v[236:239],v17 offset:7168
v_min3_u32 v27,v27,v240,v244
s_xor_b32 m0,s72,1024
s_add_u32 s65,s89,0
buffer_load_dwordx4 v16,s[20:23],s65 offen offset:0 sc1 lds
v_mfma_f32_16x16x32_bf16 v[72:75],a[116:119],v[244:247],v[72:75]
ds_read_b128 v[240:243],v17 offset:9216
s_waitcnt lgkmcnt(5)
v_readfirstlane_b32 s93,v45
buffer_load_dwordx4 v16,s[20:23],s65 offen offset:2048 sc1 lds
v_mfma_f32_16x16x32_bf16 v[64:67],a[120:123],v[248:251],v[64:67]
ds_read_b128 v[244:247],v17 offset:11264
v_min3_u32 v27,v27,v248,v252
s_xor_b32 m0,s72,17408
s_add_u32 s65,s89,32768
buffer_load_dwordx4 v16,s[20:23],s65 offen offset:0 sc1 lds
v_mfma_f32_16x16x32_bf16 v[72:75],a[124:127],v[252:255],v[72:75]
ds_read_b128 v[248:251],v17 offset:13312
buffer_load_dwordx4 v16,s[20:23],s65 offen offset:2048 sc1 lds
s_xor_b32 m0,s72,33792
s_add_u32 s65,s89,65536
s_waitcnt lgkmcnt(5)
v_mfma_f32_16x16x32_bf16 v[68:71],a[0:3],v[224:227],0
ds_read_b128 v[252:255],v17 offset:15360
v_cmp_eq_u32 vcc,0,v27
s_cbranch_vccnz retry_346
v_min3_u32 v27,v27,v224,v228
buffer_load_dwordx4 v16,s[20:23],s65 offen offset:0 sc1 lds
v_mfma_f32_16x16x32_bf16 v[76:79],a[4:7],v[228:231],0
ds_read_b128 v[224:227],v17 offset:17408
buffer_load_dwordx4 v16,s[20:23],s65 offen offset:2048 sc1 lds
s_xor_b32 m0,s72,50176
s_add_u32 s65,s89,98304
s_waitcnt lgkmcnt(5)
v_mfma_f32_16x16x32_bf16 v[68:71],a[8:11],v[232:235],v[68:71]
ds_read_b128 v[228:231],v17 offset:19456
v_min3_u32 v27,v27,v232,v236
buffer_load_dwordx4 v16,s[20:23],s65 offen offset:0 sc1 lds
buffer_load_dwordx4 v16,s[20:23],s65 offen offset:2048 sc1 lds
v_mfma_f32_16x16x32_bf16 v[76:79],a[12:15],v[236:239],v[76:79]
ds_read_b128 v[232:235],v17 offset:21504
s_waitcnt lgkmcnt(5)
v_mfma_f32_16x16x32_bf16 v[68:71],a[16:19],v[240:243],v[68:71]
ds_read_b128 v[236:239],v17 offset:23552
v_min3_u32 v27,v27,v240,v244
v_add_f32 v64,v64,v72
v_add_f32 v65,v65,v73
v_add_f32 v66,v66,v74
v_add_f32 v67,v67,v75
v_mfma_f32_16x16x32_bf16 v[76:79],a[20:23],v[244:247],v[76:79]
ds_read_b128 v[240:243],v17 offset:25600
v_fmac_f32 v64,v52,v120
v_fmac_f32 v65,v53,v120
v_fmac_f32 v66,v54,v120
v_fmac_f32 v67,v55,v120
s_waitcnt lgkmcnt(5)
v_mfma_f32_16x16x32_bf16 v[68:71],a[24:27],v[248:251],v[68:71]
ds_read_b128 v[244:247],v17 offset:27648
v_min3_u32 v27,v27,v248,v252
v_mul_f32 v88,v64,v64
v_mul_f32 v89,v65,v65
v_mul_f32 v90,v66,v66
v_mul_f32 v91,v67,v67
v_mfma_f32_16x16x32_bf16 v[76:79],a[28:31],v[252:255],v[76:79]
ds_read_b128 v[248:251],v17 offset:29696
v_fma_f32 v88,v88,v121,v122
v_fma_f32 v89,v89,v121,v122
v_fma_f32 v90,v90,v121,v122
v_fma_f32 v91,v91,v121,v122
s_waitcnt lgkmcnt(5)
v_mfma_f32_16x16x32_bf16 v[68:71],a[32:35],v[224:227],v[68:71]
ds_read_b128 v[252:255],v17 offset:31744
v_min3_u32 v27,v27,v224,v228
v_mul_f32 v88,v88,v64
v_mul_f32 v89,v89,v65
v_mul_f32 v90,v90,v66
v_mul_f32 v91,v91,v67
v_mfma_f32_16x16x32_bf16 v[76:79],a[36:39],v[228:231],v[76:79]
ds_read_b128 v[224:227],v17 offset:33792
v_exp_f32 v88,v88
v_exp_f32 v89,v89
s_waitcnt lgkmcnt(5)
v_mfma_f32_16x16x32_bf16 v[68:71],a[40:43],v[232:235],v[68:71]
ds_read_b128 v[228:231],v17 offset:35840
v_min3_u32 v27,v27,v232,v236
v_exp_f32 v90,v90
v_exp_f32 v91,v91
v_mfma_f32_16x16x32_bf16 v[76:79],a[44:47],v[236:239],v[76:79]
ds_read_b128 v[232:235],v17 offset:37888
v_fma_f32 v88,v88,v123,v123
v_fma_f32 v89,v89,v123,v123
v_fma_f32 v90,v90,v123,v123
v_fma_f32 v91,v91,v123,v123
s_waitcnt lgkmcnt(5)
v_mfma_f32_16x16x32_bf16 v[68:71],a[48:51],v[240:243],v[68:71]
ds_read_b128 v[236:239],v17 offset:39936
v_min3_u32 v27,v27,v240,v244
v_rcp_f32 v88,v88
v_rcp_f32 v89,v89
v_mfma_f32_16x16x32_bf16 v[76:79],a[52:55],v[244:247],v[76:79]
ds_read_b128 v[240:243],v17 offset:41984
v_rcp_f32 v90,v90
v_rcp_f32 v91,v91
s_waitcnt lgkmcnt(5)
v_mfma_f32_16x16x32_bf16 v[68:71],a[56:59],v[248:251],v[68:71]
ds_read_b128 v[244:247],v17 offset:44032
v_min3_u32 v27,v27,v248,v252
v_mul_f32 v88,v88,v64
v_mul_f32 v89,v89,v65
v_mul_f32 v90,v90,v66
v_mul_f32 v91,v91,v67
v_mfma_f32_16x16x32_bf16 v[76:79],a[60:63],v[252:255],v[76:79]
ds_read_b128 v[248:251],v17 offset:46080
v_cvt_pk_bf16_f32 v96,v88,v89
v_cvt_pk_bf16_f32 v97,v90,v91
v_max_u32 v96,1,v96
s_waitcnt lgkmcnt(5)
v_mfma_f32_16x16x32_bf16 v[68:71],a[64:67],v[224:227],v[68:71]
ds_read_b128 v[252:255],v17 offset:48128
v_min3_u32 v27,v27,v224,v228
buffer_store_dwordx2 v[96:97],v18,s[20:23],s70 offen offset:0 sc1
v_mfma_f32_16x16x32_bf16 v[76:79],a[68:71],v[228:231],v[76:79]
ds_read_b128 v[224:227],v17 offset:50176
s_waitcnt lgkmcnt(5)
v_mfma_f32_16x16x32_bf16 v[68:71],a[72:75],v[232:235],v[68:71]
ds_read_b128 v[228:231],v17 offset:52224
v_min3_u32 v27,v27,v232,v236
v_mfma_f32_16x16x32_bf16 v[76:79],a[76:79],v[236:239],v[76:79]
ds_read_b128 v[232:235],v17 offset:54272
s_waitcnt lgkmcnt(5)
v_mfma_f32_16x16x32_bf16 v[68:71],a[80:83],v[240:243],v[68:71]
ds_read_b128 v[236:239],v17 offset:56320
v_min3_u32 v27,v27,v240,v244
v_mfma_f32_16x16x32_bf16 v[76:79],a[84:87],v[244:247],v[76:79]
ds_read_b128 v[240:243],v17 offset:58368
s_waitcnt lgkmcnt(5)
v_mfma_f32_16x16x32_bf16 v[68:71],a[88:91],v[248:251],v[68:71]
ds_read_b128 v[244:247],v17 offset:60416
v_min3_u32 v27,v27,v248,v252
v_mfma_f32_16x16x32_bf16 v[76:79],a[92:95],v[252:255],v[76:79]
ds_read_b128 v[248:251],v17 offset:62464
s_waitcnt lgkmcnt(5)
v_mfma_f32_16x16x32_bf16 v[68:71],a[96:99],v[224:227],v[68:71]
ds_read_b128 v[252:255],v17 offset:64512
v_min3_u32 v27,v27,v224,v228
v_mfma_f32_16x16x32_bf16 v[76:79],a[100:103],v[228:231],v[76:79]
s_waitcnt lgkmcnt(4)
v_mfma_f32_16x16x32_bf16 v[68:71],a[104:107],v[232:235],v[68:71]
v_min3_u32 v27,v27,v232,v236
v_mfma_f32_16x16x32_bf16 v[76:79],a[108:111],v[236:239],v[76:79]
s_waitcnt lgkmcnt(2)
v_mfma_f32_16x16x32_bf16 v[68:71],a[112:115],v[240:243],v[68:71]
v_min3_u32 v27,v27,v240,v244
v_mfma_f32_16x16x32_bf16 v[76:79],a[116:119],v[244:247],v[76:79]
s_waitcnt lgkmcnt(0)
v_mfma_f32_16x16x32_bf16 v[68:71],a[120:123],v[248:251],v[68:71]
v_min3_u32 v27,v27,v248,v252
v_mfma_f32_16x16x32_bf16 v[76:79],a[124:127],v[252:255],v[76:79]
v_cmp_eq_u32 vcc,0,v27
s_cbranch_vccnz retry_346
epi_349:
buffer_load_dword v29,v21,s[20:23],s87 offen sc1
s_nop 4
v_pk_add_f32 v[68:69],v[68:69],v[76:77]
v_pk_add_f32 v[70:71],v[70:71],v[78:79]
v_pk_fma_f32 v[68:69],v[52:53],v[124:125],v[68:69] op_sel_hi:[1,0,1]
v_pk_fma_f32 v[70:71],v[54:55],v[124:125],v[70:71] op_sel_hi:[1,0,1]
v_pk_mul_f32 v[88:89],v[68:69],v[68:69]
v_pk_mul_f32 v[90:91],v[70:71],v[70:71]
v_pk_fma_f32 v[88:89],v[88:89],v[124:125],v[126:127] op_sel:[0,1,0] op_sel_hi:[1,1,0]
v_pk_fma_f32 v[90:91],v[90:91],v[124:125],v[126:127] op_sel:[0,1,0] op_sel_hi:[1,1,0]
v_pk_mul_f32 v[88:89],v[88:89],v[68:69]
v_pk_mul_f32 v[90:91],v[90:91],v[70:71]
v_exp_f32 v88,v88
v_exp_f32 v89,v89
v_exp_f32 v90,v90
s_cmp_gt_u32 s71,51
s_cselect_b32 s65,s73,0x7fff0000
s_cselect_b32 s97,0x7fff0000,s73
v_mov_b32 v22,s71
buffer_store_dword v22,v23,s[20:23],s65 offen sc1
v_exp_f32 v91,v91
v_pk_fma_f32 v[88:89],v[88:89],v[126:127],v[126:127] op_sel:[0,1,1] op_sel_hi:[1,1,1]
v_pk_fma_f32 v[90:91],v[90:91],v[126:127],v[126:127] op_sel:[0,1,1] op_sel_hi:[1,1,1]
v_rcp_f32 v88,v88
v_rcp_f32 v89,v89
v_rcp_f32 v90,v90
v_rcp_f32 v91,v91
v_pk_mul_f32 v[88:89],v[88:89],v[68:69]
v_pk_mul_f32 v[90:91],v[90:91],v[70:71]
v_cvt_pk_bf16_f32 v96,v88,v89
v_cvt_pk_bf16_f32 v97,v90,v91
v_max_u32 v96,1,v96
buffer_store_dwordx2 v[96:97],v18,s[20:23],s70 offen offset:1024 sc1
v_xor_b32 v17,0x10000,v17
s_xor_b32 s72,s72,0x10000
s_add_u32 s70,s70,2097152
s_xor_b32 s70,s70,0x2000
s_add_u32 s71,s71,1
s_cmp_le_u32 s71,s57
s_cbranch_scc1 seg_347
s_endpgm
retry_346:
s_sub_u32 s90,s90,64
s_cmp_lt_i32 s90,0
s_cbranch_scc1 giveup_195
s_mov_b32 s83,1
s_waitcnt vmcnt(0) lgkmcnt(0)
s_barrier
s_branch seg_347
str_359:
s_add_u32 s94,s70,s75
s_add_u32 s66,s94,110592
buffer_load_dwordx4 v[128:131],v16,s[20:23],s66 offen offset:0 sc1
buffer_load_dwordx4 v[132:135],v16,s[20:23],s66 offen offset:1024 sc1
buffer_load_dwordx4 v[136:139],v16,s[20:23],s66 offen offset:2048 sc1
buffer_load_dwordx4 v[140:143],v16,s[20:23],s66 offen offset:3072 sc1
s_add_u32 s66,s94,114688
buffer_load_dwordx4 v[144:147],v16,s[20:23],s66 offen offset:0 sc1
buffer_load_dwordx4 v[148:151],v16,s[20:23],s66 offen offset:1024 sc1
buffer_load_dwordx4 v[152:155],v16,s[20:23],s66 offen offset:2048 sc1
buffer_load_dwordx4 v[156:159],v16,s[20:23],s66 offen offset:3072 sc1
s_sub_u32 s90,s90,1
s_waitcnt vmcnt(0)
s_branch stk_358
str_361:
s_add_u32 s94,s70,s75
s_add_u32 s66,s94,110592
buffer_load_dwordx4 v[128:131],v16,s[20:23],s66 offen offset:0 sc1
buffer_load_dwordx4 v[132:135],v16,s[20:23],s66 offen offset:1024 sc1
buffer_load_dwordx4 v[136:139],v16,s[20:23],s66 offen offset:2048 sc1
buffer_load_dwordx4 v[140:143],v16,s[20:23],s66 offen offset:3072 sc1
s_add_u32 s66,s94,114688
buffer_load_dwordx4 v[144:147],v16,s[20:23],s66 offen offset:0 sc1
buffer_load_dwordx4 v[148:151],v16,s[20:23],s66 offen offset:1024 sc1
buffer_load_dwordx4 v[152:155],v16,s[20:23],s66 offen offset:2048 sc1
buffer_load_dwordx4 v[156:159],v16,s[20:23],s66 offen offset:3072 sc1
s_sub_u32 s90,s90,1
s_waitcnt vmcnt(0)
s_branch stk_360
str_363:
s_add_u32 s94,s70,s75
s_add_u32 s66,s94,110592
buffer_load_dwordx4 v[128:131],v16,s[20:23],s66 offen offset:0 sc1
buffer_load_dwordx4 v[132:135],v16,s[20:23],s66 offen offset:1024 sc1
buffer_load_dwordx4 v[136:139],v16,s[20:23],s66 offen offset:2048 sc1
buffer_load_dwordx4 v[140:143],v16,s[20:23],s66 offen offset:3072 sc1
s_add_u32 s66,s94,114688
buffer_load_dwordx4 v[144:147],v16,s[20:23],s66 offen offset:0 sc1
buffer_load_dwordx4 v[148:151],v16,s[20:23],s66 offen offset:1024 sc1
buffer_load_dwordx4 v[152:155],v16,s[20:23],s66 offen offset:2048 sc1
buffer_load_dwordx4 v[156:159],v16,s[20:23],s66 offen offset:3072 sc1
s_sub_u32 s90,s90,1
s_waitcnt vmcnt(0)
s_branch stk_362
giveup_195:
s_endpgm
code_end:
.section .rodata,"a"
.p2align 6
.amdhsa_kernel mega_kernel
  .amdhsa_next_free_vgpr 512
  .amdhsa_next_free_sgpr 102
  .amdhsa_accum_offset 256
  .amdhsa_group_segment_fixed_size 0
  .amdhsa_kernarg_size 136
  .amdhsa_user_sgpr_count 2
  .amdhsa_user_sgpr_kernarg_segment_ptr 1
  .amdhsa_system_sgpr_workgroup_id_x 1
.end_amdhsa_kernel
```

```asm
; @launch kernel=mega_kernel grid=(256,1,1) block=(256,1,1) lds=163840
.amdgcn_target "amdgcn-amd-amdhsa--gfx950"
.text
.globl mega_kernel
.p2align 8
.type mega_kernel,@function
mega_kernel:
s_cmp_ge_u32 s2,256
s_cbranch_scc1 done_1
s_load_dwordx4 s[16:19],s[0:1],120
s_load_dword s3,s[0:1],0
s_getpc_b64 s[4:5]
pc_2:
s_sub_u32 s8,s4,pc_2-mega_kernel
s_subb_u32 s9,s5,0
s_and_b32 s9,s9,0xffff
s_mov_b32 s10,code_end-mega_kernel
s_mov_b32 s11,0x20000
v_lshlrev_b32 v180,7,v0
v_cmp_gt_u32 vcc,64,v0
s_cbranch_vccnz nocpf_3
buffer_load_dword v181,v180,s[8:11],0 offen
s_mov_b32 s12,0x8000
buffer_load_dword v182,v180,s[8:11],s12 offen
s_lshr_b32 s12,s2,3
s_and_b32 s12,s12,7
s_add_u32 s12,s12,2
s_lshl_b32 s12,s12,15
buffer_load_dword v183,v180,s[8:11],s12 offen
nocpf_3:
v_and_b32 v1,63,v0
v_lshrrev_b32 v2,6,v0
s_getreg_b32 s51,hwreg(HW_REG_XCC_ID)
v_readfirstlane_b32 s50,v2
s_and_b32 s51,s51,7
s_waitcnt lgkmcnt(0)
s_mov_b32 s20,s18
s_and_b32 s21,s19,0xffff
s_mov_b32 s22,0x10000000
s_mov_b32 s23,0x20000
s_mov_b32 s44,s16
s_and_b32 s45,s17,0xffff
s_mov_b32 s46,0x100
s_mov_b32 s47,0x20000
s_mov_b32 s90,400000
s_mov_b32 s91,s50
v_mov_b32 v187,158976
s_cmp_lg_u32 s50,0
s_cbranch_scc1 norole_4
s_mov_b64 exec,1
v_mov_b32 v184,1
v_mov_b32 v185,0
s_and_b32 s52,s51,3
s_lshl_b32 s52,s52,2
s_lshr_b32 s53,s51,2
s_lshl_b32 s53,s53,7
s_add_u32 s52,s52,s53
buffer_atomic_add v184,v185,s[44:47],s52 offen sc0 sc1
s_mov_b64 exec,-1
buffer_load_dword v181,v180,s[8:11],0 offen
s_mov_b32 s12,0x8000
buffer_load_dword v182,v180,s[8:11],s12 offen
s_lshr_b32 s12,s2,3
s_and_b32 s12,s12,7
s_add_u32 s12,s12,2
s_lshl_b32 s12,s12,15
buffer_load_dword v183,v180,s[8:11],s12 offen
s_mov_b64 exec,1
s_waitcnt vmcnt(3)
ds_write_b32 v187,v184
s_waitcnt lgkmcnt(0)
s_mov_b64 exec,-1
norole_4:
s_barrier
ds_read_b32 v186,v187
s_waitcnt lgkmcnt(0)
v_readfirstlane_b32 s54,v186
s_mov_b32 s56,2
s_lshl_b32 s57,s51,5
s_add_u32 s57,s57,s54
s_cmp_lt_u32 s54,32
s_cselect_b32 s57,s57,999
s_cmp_ge_u32 s57,256
s_cbranch_scc1 verify_6
s_cmp_ge_u32 s57,128
s_cbranch_scc1 pre_8
setup_5:
s_load_dwordx8 s[4:11],s[0:1],8
s_load_dwordx2 s[12:13],s[0:1],40
v_and_b32 v3,15,v1
v_lshrrev_b32 v4,4,v1
v_lshlrev_b32 v16,4,v1
v_lshrrev_b32 v30,2,v1
v_and_b32 v31,3,v1
v_lshlrev_b32 v7,13,v30
v_lshl_add_u32 v7,v31,4,v7
v_lshlrev_b32 v8,11,v30
v_lshl_add_u32 v8,v31,4,v8
s_lshr_b32 s58,s57,5
s_and_b32 s59,s57,31
s_xor_b32 s60,s57,0
s_lshl_b32 s60,s60,6
s_lshl_b32 s61,s50,14
s_lshl_b32 s62,s50,21
s_add_u32 s62,s62,s60
s_lshl_b32 s63,s58,21
s_lshl_b32 s64,s50,19
s_add_u32 s63,s63,s64
s_xor_b32 s64,s59,0
s_lshl_b32 s64,s64,6
s_add_u32 s63,s63,s64
s_waitcnt lgkmcnt(0)
s_mov_b32 s28,s8
s_and_b32 s29,s9,0xffff
s_mov_b32 s30,0x800000
s_mov_b32 s31,0x20000
s_mov_b32 s32,s10
s_and_b32 s33,s11,0xffff
s_mov_b32 s34,0x800000
s_mov_b32 s35,0x20000
s_mov_b32 s36,s6
s_and_b32 s37,s7,0xffff
s_mov_b32 s38,0x800000
s_mov_b32 s39,0x20000
s_mov_b32 s40,s12
s_and_b32 s41,s13,0xffff
s_mov_b32 s42,0x800000
s_mov_b32 s43,0x20000
s_mov_b32 s8,s4
s_and_b32 s9,s5,0xffff
s_mov_b32 s10,0x4000
s_mov_b32 s11,0x20000
v_lshlrev_b32 v9,7,v3
v_lshl_add_u32 v10,v4,11,v9
v_lshl_add_u32 v9,v4,13,v9
s_lshl_b32 s64,s59,2
s_add_u32 s64,s64,s50
s_lshl_b32 s65,s64,16
s_lshl_b32 s66,s58,11
s_add_u32 s65,s65,s66
s_lshl_b32 s66,s64,14
s_lshl_b32 s67,s58,21
s_add_u32 s66,s66,s67
v_and_b32 v9,7,v1
v_lshrrev_b32 v10,3,v1
s_cmp_eq_u32 s58,3
s_cselect_b32 s64,15,3
v_mov_b32 v11,3
v_cmp_eq_u32 vcc,1,v10
s_nop 1
v_cndmask_b32 v11,v11,11,vcc
v_lshlrev_b32 v12,7,v11
v_lshl_add_u32 v12,v9,11,v12
v_mov_b32 v13,s64
v_cmp_eq_u32 vcc,2,v10
s_nop 1
v_cndmask_b32 v11,v11,v13,vcc
v_lshlrev_b32 v11,7,v11
v_lshl_add_u32 v11,v9,13,v11
v_mov_b32 v100,0
v_mov_b32 v101,0
v_mov_b32 v102,0
v_mov_b32 v103,0
s_mov_b32 s53,s65
s_mov_b32 s55,s66
v_and_b32 v22,7,v3
v_lshlrev_b32 v31,11,v22
v_lshl_add_u32 v31,v4,4,v31
s_lshr_b32 s64,s59,3
s_lshl_b32 s64,s64,14
s_and_b32 s65,s59,7
s_lshl_b32 s65,s65,10
s_add_u32 s64,s64,s65
s_lshl_b32 s65,s58,16
s_add_u32 s64,s64,s65
s_add_u32 s64,s64,31195136
s_lshr_b32 s65,s57,3
s_add_u32 s65,s65,96
s_lshl_b32 s65,s65,14
s_and_b32 s66,s57,7
s_lshl_b32 s66,s66,10
s_add_u32 s65,s65,s66
s_add_u32 s65,s65,29360128
v_add_u32 v206,s64,v16
v_add_u32 v207,s65,v16
s_and_b32 s64,s50,1
s_lshl_b32 s64,s64,21
s_lshr_b32 s65,s50,1
s_lshl_b32 s65,s65,13
s_add_u32 s64,s64,s65
buffer_store_dwordx4 v[100:103],v206,s[20:23],s64 offen sc1
buffer_store_dwordx4 v[100:103],v207,s[20:23],s64 offen sc1
s_lshl_b32 s64,s50,20
s_add_u32 s64,s64,23068672
s_cmp_lt_u32 s50,2
s_cselect_b32 s67,s64,0x7fff0000
s_lshl_b32 s65,s57,10
s_add_u32 s65,s65,131072
s_add_u32 s65,s65,s67
buffer_store_dwordx4 v[100:103],v16,s[20:23],s65 offen sc1
s_lshl_b32 s65,s57,9
s_add_u32 s65,s65,s67
s_add_u32 s66,s65,65536
s_mov_b32 exec_hi,0
buffer_store_dwordx4 v[100:103],v16,s[20:23],s65 offen sc1
buffer_store_dwordx4 v[100:103],v16,s[20:23],s66 offen sc1
s_lshl_b32 s65,s57,2
s_add_u32 s65,s65,s64
s_add_u32 s65,s65,524288
s_lshl_b32 s52,s57,7
s_add_u32 s52,s52,21168128
s_mov_b64 exec,1
buffer_store_dword v100,v100,s[20:23],s65 offen sc1
buffer_store_dword v100,v100,s[20:23],s65 offen offset:512 sc1
s_mov_b64 exec,15
buffer_store_dwordx4 v[100:103],v16,s[20:23],s52 offen sc1
s_mov_b64 exec,-1
s_mov_b32 s65,s53
s_mov_b32 s66,s55
v_mov_b32 v37,159008
ds_write_b128 v37,v[100:103]
s_add_u32 s64,s62,0
s_add_u32 m0,s61,0
s_nop 0
buffer_load_dwordx4 v7,s[28:31],s64 offen nt lds
s_add_u32 s64,s62,131072
s_add_u32 m0,s61,1024
s_nop 0
buffer_load_dwordx4 v7,s[28:31],s64 offen nt lds
s_add_u32 s64,s62,262144
s_add_u32 m0,s61,2048
s_nop 0
buffer_load_dwordx4 v7,s[28:31],s64 offen nt lds
s_add_u32 s64,s62,393216
s_add_u32 m0,s61,3072
s_nop 0
buffer_load_dwordx4 v7,s[28:31],s64 offen nt lds
s_add_u32 s64,s62,524288
s_add_u32 m0,s61,4096
s_nop 0
buffer_load_dwordx4 v7,s[28:31],s64 offen nt lds
s_add_u32 s64,s62,655360
s_add_u32 m0,s61,5120
s_nop 0
buffer_load_dwordx4 v7,s[28:31],s64 offen nt lds
s_add_u32 s64,s62,786432
s_add_u32 m0,s61,6144
s_nop 0
buffer_load_dwordx4 v7,s[28:31],s64 offen nt lds
s_add_u32 s64,s62,917504
s_add_u32 m0,s61,7168
s_nop 0
buffer_load_dwordx4 v7,s[28:31],s64 offen nt lds
s_waitcnt vmcnt(8) lgkmcnt(0)
s_barrier
s_cmp_lg_u32 s50,1
s_cbranch_scc1 ws_11
s_and_b32 s64,s56,1
s_lshl_b32 s64,s64,2
s_add_u32 s64,s64,36
s_mov_b64 exec,1
v_mov_b32 v184,1
v_mov_b32 v185,0
buffer_atomic_add v184,v185,s[44:47],s64 offen sc1
s_mov_b64 exec,-1
ws_11:
s_add_u32 s64,s62,1048576
s_add_u32 m0,s61,8192
s_nop 0
buffer_load_dwordx4 v7,s[28:31],s64 offen nt lds
s_add_u32 s64,s62,1179648
s_add_u32 m0,s61,9216
s_nop 0
buffer_load_dwordx4 v7,s[28:31],s64 offen nt lds
s_add_u32 s64,s62,1310720
s_add_u32 m0,s61,10240
s_nop 0
buffer_load_dwordx4 v7,s[28:31],s64 offen nt lds
s_add_u32 s64,s62,1441792
s_add_u32 m0,s61,11264
s_nop 0
buffer_load_dwordx4 v7,s[28:31],s64 offen nt lds
s_add_u32 s64,s62,1572864
s_add_u32 m0,s61,12288
s_nop 0
buffer_load_dwordx4 v7,s[28:31],s64 offen nt lds
s_add_u32 s64,s62,1703936
s_add_u32 m0,s61,13312
s_nop 0
buffer_load_dwordx4 v7,s[28:31],s64 offen nt lds
s_add_u32 s64,s62,1835008
s_add_u32 m0,s61,14336
s_nop 0
buffer_load_dwordx4 v7,s[28:31],s64 offen nt lds
s_add_u32 s64,s62,1966080
s_add_u32 m0,s61,15360
s_nop 0
buffer_load_dwordx4 v7,s[28:31],s64 offen nt lds
s_mov_b64 exec,0xffffff
buffer_load_dword v201,v11,s[32:35],s65 offen
buffer_load_dword v202,v11,s[36:39],s65 offen
s_mov_b64 exec,0xffff
buffer_load_dword v203,v12,s[40:43],s66 offen
s_mov_b64 exec,-1
s_add_u32 s64,s62,0
s_add_u32 m0,s61,65536
s_nop 0
buffer_load_dwordx4 v7,s[32:35],s64 offen nt lds
s_add_u32 s64,s62,131072
s_add_u32 m0,s61,66560
s_nop 0
buffer_load_dwordx4 v7,s[32:35],s64 offen nt lds
s_add_u32 s64,s62,262144
s_add_u32 m0,s61,67584
s_nop 0
buffer_load_dwordx4 v7,s[32:35],s64 offen nt lds
s_add_u32 s64,s62,393216
s_add_u32 m0,s61,68608
s_nop 0
buffer_load_dwordx4 v7,s[32:35],s64 offen nt lds
s_add_u32 s64,s62,524288
s_add_u32 m0,s61,69632
s_nop 0
buffer_load_dwordx4 v7,s[32:35],s64 offen nt lds
s_add_u32 s64,s62,655360
s_add_u32 m0,s61,70656
s_nop 0
buffer_load_dwordx4 v7,s[32:35],s64 offen nt lds
s_add_u32 s64,s62,786432
s_add_u32 m0,s61,71680
s_nop 0
buffer_load_dwordx4 v7,s[32:35],s64 offen nt lds
s_add_u32 s64,s62,917504
s_add_u32 m0,s61,72704
s_nop 0
buffer_load_dwordx4 v7,s[32:35],s64 offen nt lds
s_add_u32 s64,s62,1048576
s_add_u32 m0,s61,73728
s_nop 0
buffer_load_dwordx4 v7,s[32:35],s64 offen nt lds
s_add_u32 s64,s62,1179648
s_add_u32 m0,s61,74752
s_nop 0
buffer_load_dwordx4 v7,s[32:35],s64 offen nt lds
s_add_u32 s64,s62,1310720
s_add_u32 m0,s61,75776
s_nop 0
buffer_load_dwordx4 v7,s[32:35],s64 offen nt lds
s_add_u32 s64,s62,1441792
s_add_u32 m0,s61,76800
s_nop 0
buffer_load_dwordx4 v7,s[32:35],s64 offen nt lds
s_add_u32 s64,s62,1572864
s_add_u32 m0,s61,77824
s_nop 0
buffer_load_dwordx4 v7,s[32:35],s64 offen nt lds
s_add_u32 s64,s62,1703936
s_add_u32 m0,s61,78848
s_nop 0
buffer_load_dwordx4 v7,s[32:35],s64 offen nt lds
s_add_u32 s64,s62,1835008
s_add_u32 m0,s61,79872
s_nop 0
buffer_load_dwordx4 v7,s[32:35],s64 offen nt lds
s_add_u32 s64,s62,1966080
s_add_u32 m0,s61,80896
s_nop 0
buffer_load_dwordx4 v7,s[32:35],s64 offen nt lds
s_lshl_b32 s64,s59,6
buffer_load_dwordx4 v[216:219],v31,s[8:11],s64 offen
v_lshrrev_b32 v184,3,v3
v_bfe_u32 v185,v3,2,1
v_lshrrev_b32 v186,1,v4
v_and_b32 v187,1,v4
v_lshl_add_u32 v188,v184,3,v185
v_lshl_add_u32 v188,v186,4,v188
v_lshl_add_u32 v188,v187,2,v188
v_lshl_add_u32 v189,v184,2,v185
v_lshl_add_u32 v189,v186,3,v189
v_lshl_add_u32 v189,v187,4,v189
v_and_b32 v187,3,v3
v_lshlrev_b32 v187,3,v187
v_lshl_add_u32 v188,v188,6,v187
v_lshl_add_u32 v189,v189,6,v187
s_lshr_b32 s64,s50,1
s_lshl_b32 s64,s64,5
v_add_u32 v190,s64,v188
v_add_u32 v191,0x10000,v190
s_lshl_b32 s64,s64,10
v_add_u32 v192,s64,v189
s_add_u32 s64,s61,0x10000
v_add_u32 v193,s64,v16
s_add_u32 s68,s50,1
s_mov_b32 s69,0
s_waitcnt vmcnt(20)
s_barrier
s_lshl_b32 s64,s57,9
v_mov_b32 v194,s64
s_add_u32 s65,s64,65024
v_mov_b32 v195,s65
v_cmp_lt_u32 vcc,3,v1
s_nop 1
v_cndmask_b32 v194,v194,v195,vcc
s_lshl_b32 s65,s57,10
s_add_u32 s65,s65,130048
v_mov_b32 v195,s65
v_cmp_lt_u32 vcc,7,v1
s_nop 1
v_cndmask_b32 v194,v194,v195,vcc
s_lshl_b32 s65,s57,11
s_add_u32 s65,s65,260096
v_mov_b32 v195,s65
v_cmp_lt_u32 vcc,15,v1
s_nop 1
v_cndmask_b32 v194,v194,v195,vcc
v_lshl_add_u32 v194,v1,7,v194
s_lshl_b32 s65,s58,7
s_add_u32 s65,s65,524288
v_writelane_b32 v194,s65,32
s_add_u32 s65,s65,512
v_writelane_b32 v194,s65,33
s_lshl_b32 s64,s50,20
s_add_u32 s64,s64,23068672
s_mov_b32 exec_hi,3
buffer_load_dword v183,v194,s[20:23],s64 offen sc1
s_mov_b64 exec,-1
s_and_b32 s65,s50,1
s_lshl_b32 s14,s65,19
s_add_u32 s14,s14,s60
s_lshl_b32 s15,s65,19
s_sub_u32 s15,s63,s15
s_lshl_b32 s65,s65,13
s_add_u32 s65,s65,131072
v_mov_b32 v32,v8
v_add_u32 v33,s65,v16
v_add_u32 v34,s65,v189
v_mov_b32 v35,v7
v_add_u32 v36,131072,v190
v_mov_b32 v37,159008
s_bitcmp1_b32 s68,1
s_cbranch_scc0 ws_12
ds_read_b64_tr_b16 a[0:1],v190 offset:0
ds_read_b64_tr_b16 a[2:3],v190 offset:128
ds_read_b64_tr_b16 a[4:5],v190 offset:2048
ds_read_b64_tr_b16 a[6:7],v190 offset:2176
ds_read_b64_tr_b16 a[8:9],v190 offset:4096
ds_read_b64_tr_b16 a[10:11],v190 offset:4224
ds_read_b64_tr_b16 a[12:13],v190 offset:6144
ds_read_b64_tr_b16 a[14:15],v190 offset:6272
s_waitcnt lgkmcnt(0)
ds_read_b64_tr_b16 a[16:17],v190 offset:8192
ds_read_b64_tr_b16 a[18:19],v190 offset:8320
ds_read_b64_tr_b16 a[20:21],v190 offset:10240
ds_read_b64_tr_b16 a[22:23],v190 offset:10368
ds_read_b64_tr_b16 a[24:25],v190 offset:12288
ds_read_b64_tr_b16 a[26:27],v190 offset:12416
ds_read_b64_tr_b16 a[28:29],v190 offset:14336
ds_read_b64_tr_b16 a[30:31],v190 offset:14464
s_waitcnt lgkmcnt(0)
ds_read_b64_tr_b16 a[32:33],v190 offset:16384
ds_read_b64_tr_b16 a[34:35],v190 offset:16512
ds_read_b64_tr_b16 a[36:37],v190 offset:18432
ds_read_b64_tr_b16 a[38:39],v190 offset:18560
ds_read_b64_tr_b16 a[40:41],v190 offset:20480
ds_read_b64_tr_b16 a[42:43],v190 offset:20608
ds_read_b64_tr_b16 a[44:45],v190 offset:22528
ds_read_b64_tr_b16 a[46:47],v190 offset:22656
s_waitcnt lgkmcnt(0)
ds_read_b64_tr_b16 a[48:49],v190 offset:24576
ds_read_b64_tr_b16 a[50:51],v190 offset:24704
ds_read_b64_tr_b16 a[52:53],v190 offset:26624
ds_read_b64_tr_b16 a[54:55],v190 offset:26752
ds_read_b64_tr_b16 a[56:57],v190 offset:28672
ds_read_b64_tr_b16 a[58:59],v190 offset:28800
ds_read_b64_tr_b16 a[60:61],v190 offset:30720
ds_read_b64_tr_b16 a[62:63],v190 offset:30848
s_waitcnt lgkmcnt(0)
ds_read_b64_tr_b16 a[64:65],v190 offset:32768
ds_read_b64_tr_b16 a[66:67],v190 offset:32896
ds_read_b64_tr_b16 a[68:69],v190 offset:34816
ds_read_b64_tr_b16 a[70:71],v190 offset:34944
ds_read_b64_tr_b16 a[72:73],v190 offset:36864
ds_read_b64_tr_b16 a[74:75],v190 offset:36992
ds_read_b64_tr_b16 a[76:77],v190 offset:38912
ds_read_b64_tr_b16 a[78:79],v190 offset:39040
s_waitcnt lgkmcnt(0)
ds_read_b64_tr_b16 a[80:81],v190 offset:40960
ds_read_b64_tr_b16 a[82:83],v190 offset:41088
ds_read_b64_tr_b16 a[84:85],v190 offset:43008
ds_read_b64_tr_b16 a[86:87],v190 offset:43136
ds_read_b64_tr_b16 a[88:89],v190 offset:45056
ds_read_b64_tr_b16 a[90:91],v190 offset:45184
ds_read_b64_tr_b16 a[92:93],v190 offset:47104
ds_read_b64_tr_b16 a[94:95],v190 offset:47232
s_waitcnt lgkmcnt(0)
ds_read_b64_tr_b16 a[96:97],v190 offset:49152
ds_read_b64_tr_b16 a[98:99],v190 offset:49280
ds_read_b64_tr_b16 a[100:101],v190 offset:51200
ds_read_b64_tr_b16 a[102:103],v190 offset:51328
ds_read_b64_tr_b16 a[104:105],v190 offset:53248
ds_read_b64_tr_b16 a[106:107],v190 offset:53376
ds_read_b64_tr_b16 a[108:109],v190 offset:55296
ds_read_b64_tr_b16 a[110:111],v190 offset:55424
s_waitcnt lgkmcnt(0)
ds_read_b64_tr_b16 a[112:113],v190 offset:57344
ds_read_b64_tr_b16 a[114:115],v190 offset:57472
ds_read_b64_tr_b16 a[116:117],v190 offset:59392
ds_read_b64_tr_b16 a[118:119],v190 offset:59520
ds_read_b64_tr_b16 a[120:121],v190 offset:61440
ds_read_b64_tr_b16 a[122:123],v190 offset:61568
ds_read_b64_tr_b16 a[124:125],v190 offset:63488
ds_read_b64_tr_b16 a[126:127],v190 offset:63616
s_waitcnt lgkmcnt(0)
s_waitcnt vmcnt(0)
s_barrier
ds_read_b64_tr_b16 a[128:129],v191 offset:0
ds_read_b64_tr_b16 a[130:131],v191 offset:128
ds_read_b64_tr_b16 a[132:133],v191 offset:2048
ds_read_b64_tr_b16 a[134:135],v191 offset:2176
ds_read_b64_tr_b16 a[136:137],v191 offset:4096
ds_read_b64_tr_b16 a[138:139],v191 offset:4224
ds_read_b64_tr_b16 a[140:141],v191 offset:6144
ds_read_b64_tr_b16 a[142:143],v191 offset:6272
s_waitcnt lgkmcnt(0)
ds_read_b64_tr_b16 a[144:145],v191 offset:8192
ds_read_b64_tr_b16 a[146:147],v191 offset:8320
ds_read_b64_tr_b16 a[148:149],v191 offset:10240
ds_read_b64_tr_b16 a[150:151],v191 offset:10368
ds_read_b64_tr_b16 a[152:153],v191 offset:12288
ds_read_b64_tr_b16 a[154:155],v191 offset:12416
ds_read_b64_tr_b16 a[156:157],v191 offset:14336
ds_read_b64_tr_b16 a[158:159],v191 offset:14464
s_waitcnt lgkmcnt(0)
ds_read_b64_tr_b16 a[160:161],v191 offset:16384
ds_read_b64_tr_b16 a[162:163],v191 offset:16512
ds_read_b64_tr_b16 a[164:165],v191 offset:18432
ds_read_b64_tr_b16 a[166:167],v191 offset:18560
ds_read_b64_tr_b16 a[168:169],v191 offset:20480
ds_read_b64_tr_b16 a[170:171],v191 offset:20608
ds_read_b64_tr_b16 a[172:173],v191 offset:22528
ds_read_b64_tr_b16 a[174:175],v191 offset:22656
s_waitcnt lgkmcnt(0)
ds_read_b64_tr_b16 a[176:177],v191 offset:24576
ds_read_b64_tr_b16 a[178:179],v191 offset:24704
ds_read_b64_tr_b16 a[180:181],v191 offset:26624
ds_read_b64_tr_b16 a[182:183],v191 offset:26752
ds_read_b64_tr_b16 a[184:185],v191 offset:28672
ds_read_b64_tr_b16 a[186:187],v191 offset:28800
ds_read_b64_tr_b16 a[188:189],v191 offset:30720
ds_read_b64_tr_b16 a[190:191],v191 offset:30848
s_waitcnt lgkmcnt(0)
ds_read_b64_tr_b16 a[192:193],v191 offset:32768
ds_read_b64_tr_b16 a[194:195],v191 offset:32896
ds_read_b64_tr_b16 a[196:197],v191 offset:34816
ds_read_b64_tr_b16 a[198:199],v191 offset:34944
ds_read_b64_tr_b16 a[200:201],v191 offset:36864
ds_read_b64_tr_b16 a[202:203],v191 offset:36992
ds_read_b64_tr_b16 a[204:205],v191 offset:38912
ds_read_b64_tr_b16 a[206:207],v191 offset:39040
s_waitcnt lgkmcnt(0)
ds_read_b64_tr_b16 a[208:209],v191 offset:40960
ds_read_b64_tr_b16 a[210:211],v191 offset:41088
ds_read_b64_tr_b16 a[212:213],v191 offset:43008
ds_read_b64_tr_b16 a[214:215],v191 offset:43136
ds_read_b64_tr_b16 a[216:217],v191 offset:45056
ds_read_b64_tr_b16 a[218:219],v191 offset:45184
ds_read_b64_tr_b16 a[220:221],v191 offset:47104
ds_read_b64_tr_b16 a[222:223],v191 offset:47232
s_waitcnt lgkmcnt(0)
ds_read_b64_tr_b16 a[224:225],v191 offset:49152
ds_read_b64_tr_b16 a[226:227],v191 offset:49280
ds_read_b64_tr_b16 a[228:229],v191 offset:51200
ds_read_b64_tr_b16 a[230:231],v191 offset:51328
ds_read_b64_tr_b16 a[232:233],v191 offset:53248
ds_read_b64_tr_b16 a[234:235],v191 offset:53376
ds_read_b64_tr_b16 a[236:237],v191 offset:55296
ds_read_b64_tr_b16 a[238:239],v191 offset:55424
s_waitcnt lgkmcnt(0)
ds_read_b64_tr_b16 a[240:241],v191 offset:57344
ds_read_b64_tr_b16 a[242:243],v191 offset:57472
ds_read_b64_tr_b16 a[244:245],v191 offset:59392
ds_read_b64_tr_b16 a[246:247],v191 offset:59520
ds_read_b64_tr_b16 a[248:249],v191 offset:61440
ds_read_b64_tr_b16 a[250:251],v191 offset:61568
ds_read_b64_tr_b16 a[252:253],v191 offset:63488
ds_read_b64_tr_b16 a[254:255],v191 offset:63616
s_waitcnt lgkmcnt(0)
s_branch ws_14
ws_12:
s_add_u32 s64,s14,0
buffer_load_dwordx4 a[0:3],v35,s[36:39],s64 offen nt
s_add_u32 s64,s14,131072
buffer_load_dwordx4 a[4:7],v35,s[36:39],s64 offen nt
s_add_u32 s64,s14,262144
buffer_load_dwordx4 a[8:11],v35,s[36:39],s64 offen nt
s_add_u32 s64,s14,393216
buffer_load_dwordx4 a[12:15],v35,s[36:39],s64 offen nt
s_add_u32 s64,s14,1048576
buffer_load_dwordx4 a[16:19],v35,s[36:39],s64 offen nt
s_add_u32 s64,s14,1179648
buffer_load_dwordx4 a[20:23],v35,s[36:39],s64 offen nt
s_add_u32 s64,s14,1310720
buffer_load_dwordx4 a[24:27],v35,s[36:39],s64 offen nt
s_add_u32 s64,s14,1441792
buffer_load_dwordx4 a[28:31],v35,s[36:39],s64 offen nt
s_add_u32 s64,s14,2097152
buffer_load_dwordx4 a[32:35],v35,s[36:39],s64 offen nt
s_add_u32 s64,s14,2228224
buffer_load_dwordx4 a[36:39],v35,s[36:39],s64 offen nt
s_add_u32 s64,s14,2359296
buffer_load_dwordx4 a[40:43],v35,s[36:39],s64 offen nt
s_add_u32 s64,s14,2490368
buffer_load_dwordx4 a[44:47],v35,s[36:39],s64 offen nt
s_add_u32 s64,s14,3145728
buffer_load_dwordx4 a[48:51],v35,s[36:39],s64 offen nt
s_add_u32 s64,s14,3276800
buffer_load_dwordx4 a[52:55],v35,s[36:39],s64 offen nt
s_add_u32 s64,s14,3407872
buffer_load_dwordx4 a[56:59],v35,s[36:39],s64 offen nt
s_add_u32 s64,s14,3538944
buffer_load_dwordx4 a[60:63],v35,s[36:39],s64 offen nt
s_add_u32 s64,s14,4194304
buffer_load_dwordx4 a[64:67],v35,s[36:39],s64 offen nt
s_add_u32 s64,s14,4325376
buffer_load_dwordx4 a[68:71],v35,s[36:39],s64 offen nt
s_add_u32 s64,s14,4456448
buffer_load_dwordx4 a[72:75],v35,s[36:39],s64 offen nt
s_add_u32 s64,s14,4587520
buffer_load_dwordx4 a[76:79],v35,s[36:39],s64 offen nt
s_add_u32 s64,s14,5242880
buffer_load_dwordx4 a[80:83],v35,s[36:39],s64 offen nt
s_add_u32 s64,s14,5373952
buffer_load_dwordx4 a[84:87],v35,s[36:39],s64 offen nt
s_add_u32 s64,s14,5505024
buffer_load_dwordx4 a[88:91],v35,s[36:39],s64 offen nt
s_add_u32 s64,s14,5636096
buffer_load_dwordx4 a[92:95],v35,s[36:39],s64 offen nt
s_add_u32 s64,s14,6291456
buffer_load_dwordx4 a[96:99],v35,s[36:39],s64 offen nt
s_add_u32 s64,s14,6422528
buffer_load_dwordx4 a[100:103],v35,s[36:39],s64 offen nt
s_add_u32 s64,s14,6553600
buffer_load_dwordx4 a[104:107],v35,s[36:39],s64 offen nt
s_add_u32 s64,s14,6684672
buffer_load_dwordx4 a[108:111],v35,s[36:39],s64 offen nt
s_add_u32 s64,s14,7340032
buffer_load_dwordx4 a[112:115],v35,s[36:39],s64 offen nt
s_add_u32 s64,s14,7471104
buffer_load_dwordx4 a[116:119],v35,s[36:39],s64 offen nt
s_add_u32 s64,s14,7602176
buffer_load_dwordx4 a[120:123],v35,s[36:39],s64 offen nt
s_add_u32 s64,s14,7733248
buffer_load_dwordx4 a[124:127],v35,s[36:39],s64 offen nt
s_add_u32 s64,s15,0
buffer_load_dwordx4 a[128:131],v32,s[40:43],s64 offen nt
s_add_u32 s64,s15,32768
buffer_load_dwordx4 a[132:135],v32,s[40:43],s64 offen nt
s_add_u32 s64,s15,65536
buffer_load_dwordx4 a[136:139],v32,s[40:43],s64 offen nt
s_add_u32 s64,s15,98304
buffer_load_dwordx4 a[140:143],v32,s[40:43],s64 offen nt
s_add_u32 s64,s15,131072
buffer_load_dwordx4 a[144:147],v32,s[40:43],s64 offen nt
s_add_u32 s64,s15,163840
buffer_load_dwordx4 a[148:151],v32,s[40:43],s64 offen nt
s_add_u32 s64,s15,196608
buffer_load_dwordx4 a[152:155],v32,s[40:43],s64 offen nt
s_add_u32 s64,s15,229376
buffer_load_dwordx4 a[156:159],v32,s[40:43],s64 offen nt
s_add_u32 s64,s15,262144
buffer_load_dwordx4 a[160:163],v32,s[40:43],s64 offen nt
s_add_u32 s64,s15,294912
buffer_load_dwordx4 a[164:167],v32,s[40:43],s64 offen nt
s_add_u32 s64,s15,327680
buffer_load_dwordx4 a[168:171],v32,s[40:43],s64 offen nt
s_add_u32 s64,s15,360448
buffer_load_dwordx4 a[172:175],v32,s[40:43],s64 offen nt
s_waitcnt vmcnt(44)
s_barrier
ws_14:
v_mov_b32 v187,158976
s_cmp_lg_u32 s50,1
s_cbranch_scc1 sh0_17
s_mov_b32 s53,0
stl_18:
s_add_u32 s64,s52,32
s_buffer_load_dwordx8 s[72:79],s[20:23],s52 glc
s_buffer_load_dwordx8 s[80:87],s[20:23],s64 glc
s_waitcnt lgkmcnt(0)
s_min_u32 s72,s72,s80
s_min_u32 s73,s73,s81
s_min_u32 s74,s74,s82
s_min_u32 s75,s75,s83
s_min_u32 s76,s76,s84
s_min_u32 s77,s77,s85
s_min_u32 s78,s78,s86
s_min_u32 s79,s79,s87
s_min_u32 s72,s72,s76
s_min_u32 s73,s73,s77
s_min_u32 s74,s74,s78
s_min_u32 s75,s75,s79
s_min_u32 s72,s72,s74
s_min_u32 s73,s73,s75
s_min_u32 s64,s72,s73
s_mov_b32 s65,0
s_and_b32 s61,s64,1
s_lshl_b32 s61,s61,13
s_cmp_lg_u32 s64,0
s_cbranch_scc1 stok_19
s_sub_u32 s90,s90,1
s_cmp_lt_i32 s90,0
s_cbranch_scc1 stok_19
s_add_u32 s53,s53,1
s_and_b32 s64,s53,31
s_cbranch_scc1 stl_18
s_cmp_eq_u32 s56,1
s_cbranch_scc1 stl_18
v_and_b32 v184,3,v1
v_bfe_u32 v185,v1,2,1
v_lshlrev_b32 v184,2,v184
v_lshl_add_u32 v184,v185,7,v184
v_writelane_b32 v184,32,8
s_mov_b64 exec,0x1ff
vpoll_20:
buffer_load_dword v185,v184,s[44:47],0 offen sc1
s_waitcnt vmcnt(0)
vfirst_23:
v_readlane_b32 s92,v185,0
v_readlane_b32 s93,v185,1
v_readlane_b32 s94,v185,2
v_readlane_b32 s95,v185,3
v_readlane_b32 s96,v185,4
v_readlane_b32 s97,v185,5
v_readlane_b32 s98,v185,6
v_readlane_b32 s99,v185,7
v_readlane_b32 s61,v185,8
s_add_u32 s64,s92,s93
s_add_u32 s64,s64,s94
s_add_u32 s64,s64,s95
s_add_u32 s64,s64,s96
s_add_u32 s64,s64,s97
s_add_u32 s64,s64,s98
s_add_u32 s64,s64,s99
s_min_u32 s65,s92,s93
s_min_u32 s66,s94,s95
s_min_u32 s65,s65,s66
s_min_u32 s66,s96,s97
s_min_u32 s65,s65,s66
s_min_u32 s66,s98,s99
s_min_u32 s65,s65,s66
s_cmp_lt_u32 s65,32
s_cselect_b32 s65,1,0
s_cmp_lt_u32 s64,256
s_cbranch_scc1 vslp_22
s_branch vgot_21
vslp_22:
s_sleep 8
s_sub_u32 s90,s90,1
s_cmp_gt_i32 s90,0
s_cbranch_scc1 vpoll_20
vgot_21:
s_mov_b64 exec,-1
s_and_b32 s61,s61,1
s_lshl_b32 s61,s61,13
s_mov_b32 s66,s54
s_cmp_gt_u32 s51,0
s_cselect_b32 s64,s92,0
s_add_u32 s66,s66,s64
s_cmp_gt_u32 s51,1
s_cselect_b32 s64,s93,0
s_add_u32 s66,s66,s64
s_cmp_gt_u32 s51,2
s_cselect_b32 s64,s94,0
s_add_u32 s66,s66,s64
s_cmp_gt_u32 s51,3
s_cselect_b32 s64,s95,0
s_add_u32 s66,s66,s64
s_cmp_gt_u32 s51,4
s_cselect_b32 s64,s96,0
s_add_u32 s66,s66,s64
s_cmp_gt_u32 s51,5
s_cselect_b32 s64,s97,0
s_add_u32 s66,s66,s64
s_cmp_gt_u32 s51,6
s_cselect_b32 s64,s98,0
s_add_u32 s66,s66,s64
s_cmp_eq_u32 s65,0
s_cbranch_scc1 stl_18
stok_19:
v_mov_b32 v184,s65
v_mov_b32 v185,s66
v_mov_b32 v186,s61
ds_write_b96 v187,v[184:186] offset:16
s_waitcnt lgkmcnt(0)
sh0_17:
s_barrier
ds_read_b96 v[184:186],v187 offset:16
s_waitcnt lgkmcnt(0)
v_readfirstlane_b32 s65,v184
v_readfirstlane_b32 s66,v185
v_readfirstlane_b32 s61,v186
s_cmp_lg_u32 s65,0
s_cbranch_scc1 slowrole_10
s_and_b32 s56,s56,1
s_branch loops_7
pre_8:
s_sub_u32 s55,s57,128
s_load_dwordx4 s[4:7],s[0:1],96
s_load_dwordx2 s[8:9],s[0:1],0
v_and_b32 v1,63,v0
v_lshrrev_b32 v2,6,v0
v_and_b32 v3,7,v0
v_lshrrev_b32 v4,3,v0
v_mul_u32_u24 v5,12288,v4
v_lshl_add_u32 v5,v3,4,v5
v_lshlrev_b32 v6,1,v4
s_and_b32 s24,s55,31
s_lshr_b32 s25,s55,5
s_lshl_b32 s26,s24,7
s_mul_i32 s27,s25,3145728
s_add_u32 s26,s26,s27
s_lshl_b32 s27,s25,9
s_waitcnt lgkmcnt(0)
s_mov_b32 s12,s4
s_and_b32 s13,s5,0xffff
s_mov_b32 s14,0x800
s_mov_b32 s15,0x20000
s_mov_b32 s28,s6
s_and_b32 s29,s7,0xffff
s_mov_b32 s30,0xc00000
s_mov_b32 s31,0x20000
s_mov_b32 s32,s8
s_and_b32 s33,s9,0xffff
s_mov_b32 s34,0x400000
s_mov_b32 s35,0x20000
buffer_load_dwordx4 v[64:67],v5,s[28:31],s26 offen nt
s_add_u32 s26,s26,393216
buffer_load_dwordx4 v[68:71],v5,s[28:31],s26 offen nt
s_add_u32 s26,s26,393216
buffer_load_dwordx4 v[72:75],v5,s[28:31],s26 offen nt
s_add_u32 s26,s26,393216
buffer_load_dwordx4 v[76:79],v5,s[28:31],s26 offen nt
s_add_u32 s26,s26,393216
buffer_load_dwordx4 v[80:83],v5,s[28:31],s26 offen nt
s_add_u32 s26,s26,393216
buffer_load_dwordx4 v[84:87],v5,s[28:31],s26 offen nt
s_add_u32 s26,s26,393216
buffer_load_dwordx4 v[88:91],v5,s[28:31],s26 offen nt
s_add_u32 s26,s26,393216
buffer_load_dwordx4 v[92:95],v5,s[28:31],s26 offen nt
buffer_load_ushort v96,v6,s[12:15],s27 offen offset:0
buffer_load_ushort v97,v6,s[12:15],s27 offen offset:64
buffer_load_ushort v98,v6,s[12:15],s27 offen offset:128
buffer_load_ushort v99,v6,s[12:15],s27 offen offset:192
buffer_load_ushort v100,v6,s[12:15],s27 offen offset:256
buffer_load_ushort v101,v6,s[12:15],s27 offen offset:320
buffer_load_ushort v102,v6,s[12:15],s27 offen offset:384
buffer_load_ushort v103,v6,s[12:15],s27 offen offset:448
v_and_b32 v3,3,v1
v_lshrrev_b32 v4,2,v1
v_lshl_add_u32 v5,v2,2,v3
v_lshlrev_b32 v5,11,v5
v_lshl_add_u32 v5,v4,5,v5
s_lshl_b32 s36,s55,15
s_cmp_lt_u32 s55,16
s_cselect_b32 s42,s36,0x7fff0000
s_cselect_b32 s36,0x7fff0000,s36
buffer_load_dwordx4 v[8:11],v5,s[32:35],s42 offen offset:0
buffer_load_dwordx4 v[12:15],v5,s[32:35],s42 offen offset:16
buffer_load_dwordx4 v[16:19],v5,s[32:35],s42 offen offset:512
buffer_load_dwordx4 v[20:23],v5,s[32:35],s42 offen offset:528
buffer_load_dwordx4 v[24:27],v5,s[32:35],s42 offen offset:1024
buffer_load_dwordx4 v[28:31],v5,s[32:35],s42 offen offset:1040
buffer_load_dwordx4 v[32:35],v5,s[32:35],s42 offen offset:1536
buffer_load_dwordx4 v[36:39],v5,s[32:35],s42 offen offset:1552
v_lshrrev_b32 v6,1,v4
v_lshlrev_b32 v6,11,v6
v_and_b32 v7,1,v4
v_lshl_add_u32 v6,v7,9,v6
v_and_b32 v7,1,v2
v_lshl_add_u32 v6,v7,10,v6
v_lshrrev_b32 v7,1,v2
v_lshl_add_u32 v7,v7,2,v3
v_lshl_add_u32 v6,v7,4,v6
v_lshlrev_b32 v4,6,v4
s_lshr_b32 s37,s55,1
s_lshl_b32 s37,s37,16
s_and_b32 s38,s55,1
s_lshl_b32 s38,s38,7
s_add_u32 s37,s37,s38
s_add_u32 s37,s37,57344
s_mov_b32 s38,0xbfb8aa3b
s_mov_b32 s39,0xffff0000
s_cmp_lg_u32 s50,1
s_cbranch_scc1 nz_24
s_lshl_b32 s40,s55,9
s_add_u32 s40,s40,21037056
v_lshl_add_u32 v104,v1,4,s40
s_lshl_b32 s41,s55,7
s_add_u32 s41,s41,21102592
v_writelane_b32 v104,s41,32
v_mov_b32 v108,0
v_mov_b32 v109,0
v_mov_b32 v110,0
v_mov_b32 v111,0
s_mov_b32 exec_hi,1
buffer_store_dwordx4 v[108:111],v104,s[20:23],0 offen sc1
s_mov_b64 exec,-1
nz_24:
v_mov_b32 v112,0
v_mov_b32 v113,0
v_mov_b32 v114,0
v_mov_b32 v115,0
v_mov_b32 v116,0
v_mov_b32 v117,0
v_mov_b32 v118,0
v_mov_b32 v119,0
s_waitcnt vmcnt(8)
v_lshlrev_b32 v96,16,v96
v_mul_f32 v104,s38,v96
v_exp_f32 v104,v104
s_nop 0
v_add_f32 v104,1.0,v104
v_rcp_f32 v104,v104
s_nop 0
v_mul_f32 v104,v104,v96
v_cvt_pk_bf16_f32 v104,v104,v104
v_and_b32 v96,s39,v104
v_lshlrev_b32 v105,16,v64
v_and_b32 v106,s39,v64
v_fmac_f32 v112,v105,v96
v_fmac_f32 v113,v106,v96
v_lshlrev_b32 v105,16,v65
v_and_b32 v106,s39,v65
v_fmac_f32 v114,v105,v96
v_fmac_f32 v115,v106,v96
v_lshlrev_b32 v105,16,v66
v_and_b32 v106,s39,v66
v_fmac_f32 v116,v105,v96
v_fmac_f32 v117,v106,v96
v_lshlrev_b32 v105,16,v67
v_and_b32 v106,s39,v67
v_fmac_f32 v118,v105,v96
v_fmac_f32 v119,v106,v96
v_lshlrev_b32 v97,16,v97
v_mul_f32 v104,s38,v97
v_exp_f32 v104,v104
s_nop 0
v_add_f32 v104,1.0,v104
v_rcp_f32 v104,v104
s_nop 0
v_mul_f32 v104,v104,v97
v_cvt_pk_bf16_f32 v104,v104,v104
v_and_b32 v97,s39,v104
v_lshlrev_b32 v105,16,v68
v_and_b32 v106,s39,v68
v_fmac_f32 v112,v105,v97
v_fmac_f32 v113,v106,v97
v_lshlrev_b32 v105,16,v69
v_and_b32 v106,s39,v69
v_fmac_f32 v114,v105,v97
v_fmac_f32 v115,v106,v97
v_lshlrev_b32 v105,16,v70
v_and_b32 v106,s39,v70
v_fmac_f32 v116,v105,v97
v_fmac_f32 v117,v106,v97
v_lshlrev_b32 v105,16,v71
v_and_b32 v106,s39,v71
v_fmac_f32 v118,v105,v97
v_fmac_f32 v119,v106,v97
v_lshlrev_b32 v98,16,v98
v_mul_f32 v104,s38,v98
v_exp_f32 v104,v104
s_nop 0
v_add_f32 v104,1.0,v104
v_rcp_f32 v104,v104
s_nop 0
v_mul_f32 v104,v104,v98
v_cvt_pk_bf16_f32 v104,v104,v104
v_and_b32 v98,s39,v104
v_lshlrev_b32 v105,16,v72
v_and_b32 v106,s39,v72
v_fmac_f32 v112,v105,v98
v_fmac_f32 v113,v106,v98
v_lshlrev_b32 v105,16,v73
v_and_b32 v106,s39,v73
v_fmac_f32 v114,v105,v98
v_fmac_f32 v115,v106,v98
v_lshlrev_b32 v105,16,v74
v_and_b32 v106,s39,v74
v_fmac_f32 v116,v105,v98
v_fmac_f32 v117,v106,v98
v_lshlrev_b32 v105,16,v75
v_and_b32 v106,s39,v75
v_fmac_f32 v118,v105,v98
v_fmac_f32 v119,v106,v98
v_lshlrev_b32 v99,16,v99
v_mul_f32 v104,s38,v99
v_exp_f32 v104,v104
s_nop 0
v_add_f32 v104,1.0,v104
v_rcp_f32 v104,v104
s_nop 0
v_mul_f32 v104,v104,v99
v_cvt_pk_bf16_f32 v104,v104,v104
v_and_b32 v99,s39,v104
v_lshlrev_b32 v105,16,v76
v_and_b32 v106,s39,v76
v_fmac_f32 v112,v105,v99
v_fmac_f32 v113,v106,v99
v_lshlrev_b32 v105,16,v77
v_and_b32 v106,s39,v77
v_fmac_f32 v114,v105,v99
v_fmac_f32 v115,v106,v99
v_lshlrev_b32 v105,16,v78
v_and_b32 v106,s39,v78
v_fmac_f32 v116,v105,v99
v_fmac_f32 v117,v106,v99
v_lshlrev_b32 v105,16,v79
v_and_b32 v106,s39,v79
v_fmac_f32 v118,v105,v99
v_fmac_f32 v119,v106,v99
v_lshlrev_b32 v100,16,v100
v_mul_f32 v104,s38,v100
v_exp_f32 v104,v104
s_nop 0
v_add_f32 v104,1.0,v104
v_rcp_f32 v104,v104
s_nop 0
v_mul_f32 v104,v104,v100
v_cvt_pk_bf16_f32 v104,v104,v104
v_and_b32 v100,s39,v104
v_lshlrev_b32 v105,16,v80
v_and_b32 v106,s39,v80
v_fmac_f32 v112,v105,v100
v_fmac_f32 v113,v106,v100
v_lshlrev_b32 v105,16,v81
v_and_b32 v106,s39,v81
v_fmac_f32 v114,v105,v100
v_fmac_f32 v115,v106,v100
v_lshlrev_b32 v105,16,v82
v_and_b32 v106,s39,v82
v_fmac_f32 v116,v105,v100
v_fmac_f32 v117,v106,v100
v_lshlrev_b32 v105,16,v83
v_and_b32 v106,s39,v83
v_fmac_f32 v118,v105,v100
v_fmac_f32 v119,v106,v100
v_lshlrev_b32 v101,16,v101
v_mul_f32 v104,s38,v101
v_exp_f32 v104,v104
s_nop 0
v_add_f32 v104,1.0,v104
v_rcp_f32 v104,v104
s_nop 0
v_mul_f32 v104,v104,v101
v_cvt_pk_bf16_f32 v104,v104,v104
v_and_b32 v101,s39,v104
v_lshlrev_b32 v105,16,v84
v_and_b32 v106,s39,v84
v_fmac_f32 v112,v105,v101
v_fmac_f32 v113,v106,v101
v_lshlrev_b32 v105,16,v85
v_and_b32 v106,s39,v85
v_fmac_f32 v114,v105,v101
v_fmac_f32 v115,v106,v101
v_lshlrev_b32 v105,16,v86
v_and_b32 v106,s39,v86
v_fmac_f32 v116,v105,v101
v_fmac_f32 v117,v106,v101
v_lshlrev_b32 v105,16,v87
v_and_b32 v106,s39,v87
v_fmac_f32 v118,v105,v101
v_fmac_f32 v119,v106,v101
v_lshlrev_b32 v102,16,v102
v_mul_f32 v104,s38,v102
v_exp_f32 v104,v104
s_nop 0
v_add_f32 v104,1.0,v104
v_rcp_f32 v104,v104
s_nop 0
v_mul_f32 v104,v104,v102
v_cvt_pk_bf16_f32 v104,v104,v104
v_and_b32 v102,s39,v104
v_lshlrev_b32 v105,16,v88
v_and_b32 v106,s39,v88
v_fmac_f32 v112,v105,v102
v_fmac_f32 v113,v106,v102
v_lshlrev_b32 v105,16,v89
v_and_b32 v106,s39,v89
v_fmac_f32 v114,v105,v102
v_fmac_f32 v115,v106,v102
v_lshlrev_b32 v105,16,v90
v_and_b32 v106,s39,v90
v_fmac_f32 v116,v105,v102
v_fmac_f32 v117,v106,v102
v_lshlrev_b32 v105,16,v91
v_and_b32 v106,s39,v91
v_fmac_f32 v118,v105,v102
v_fmac_f32 v119,v106,v102
v_lshlrev_b32 v103,16,v103
v_mul_f32 v104,s38,v103
v_exp_f32 v104,v104
s_nop 0
v_add_f32 v104,1.0,v104
v_rcp_f32 v104,v104
s_nop 0
v_mul_f32 v104,v104,v103
v_cvt_pk_bf16_f32 v104,v104,v104
v_and_b32 v103,s39,v104
v_lshlrev_b32 v105,16,v92
v_and_b32 v106,s39,v92
v_fmac_f32 v112,v105,v103
v_fmac_f32 v113,v106,v103
v_lshlrev_b32 v105,16,v93
v_and_b32 v106,s39,v93
v_fmac_f32 v114,v105,v103
v_fmac_f32 v115,v106,v103
v_lshlrev_b32 v105,16,v94
v_and_b32 v106,s39,v94
v_fmac_f32 v116,v105,v103
v_fmac_f32 v117,v106,v103
v_lshlrev_b32 v105,16,v95
v_and_b32 v106,s39,v95
v_fmac_f32 v118,v105,v103
v_fmac_f32 v119,v106,v103
v_permlane32_swap_b32 v112,v116
v_permlane32_swap_b32 v113,v117
v_permlane32_swap_b32 v114,v118
v_permlane32_swap_b32 v115,v119
v_add_f32 v112,v112,v116
v_add_f32 v113,v113,v117
v_add_f32 v114,v114,v118
v_add_f32 v115,v115,v119
s_nop 0
v_permlane16_swap_b32 v112,v114
v_permlane16_swap_b32 v113,v115
v_add_f32 v112,v112,v114
v_add_f32 v113,v113,v115
s_nop 0
v_add_f32_dpp v112,v112,v112 row_ror:8 row_mask:0xf bank_mask:0xf
v_add_f32_dpp v113,v113,v113 row_ror:8 row_mask:0xf bank_mask:0xf
v_and_b32 v104,7,v1
v_lshlrev_b32 v104,5,v104
v_lshrrev_b32 v105,5,v1
v_lshl_add_u32 v104,v105,4,v104
v_bfe_u32 v105,v1,4,1
v_lshl_add_u32 v104,v105,3,v104
v_lshl_add_u32 v104,v2,8,v104
ds_write_b64 v104,v[112:113]
v_lshlrev_b32 v105,2,v1
s_lshl_b32 s40,s25,13
s_lshl_b32 s41,s24,8
s_add_u32 s40,s40,s41
s_add_u32 s40,s40,24576
s_waitcnt lgkmcnt(0)
s_barrier
s_cmp_lg_u32 s50,0
s_cbranch_scc1 m1n0_25
ds_read_b32 v112,v105 offset:0
ds_read_b32 v113,v105 offset:256
ds_read_b32 v114,v105 offset:512
ds_read_b32 v115,v105 offset:768
s_waitcnt lgkmcnt(0)
v_add_f32 v112,v112,v113
v_add_f32 v114,v114,v115
v_add_f32 v112,v112,v114
buffer_store_dword v112,v105,s[20:23],s40 offen sc1
m1n0_25:
s_waitcnt vmcnt(0)
s_barrier
s_cmp_lg_u32 s50,0
s_cbranch_scc1 post_9
s_mov_b64 exec,1
v_mov_b32 v184,1
v_mov_b32 v185,0
s_and_b32 s52,s56,1
s_lshl_b32 s52,s52,2
s_add_u32 s52,s52,160
buffer_atomic_add v184,v185,s[44:47],s52 offen sc0 sc1
s_waitcnt vmcnt(0)
v_readfirstlane_b32 s64,v184
s_mov_b64 exec,-1
s_cmp_eq_u32 s56,1
s_cbranch_scc1 post_9
s_cmp_lg_u32 s64,127
s_cbranch_scc1 post_9
v_and_b32 v184,3,v1
v_bfe_u32 v185,v1,2,1
v_lshlrev_b32 v184,2,v184
v_lshl_add_u32 v184,v185,7,v184
v_writelane_b32 v184,32,8
s_mov_b64 exec,0x1ff
vpoll_27:
buffer_load_dword v185,v184,s[44:47],0 offen sc1
s_waitcnt vmcnt(0)
vfirst_30:
v_readlane_b32 s92,v185,0
v_readlane_b32 s93,v185,1
v_readlane_b32 s94,v185,2
v_readlane_b32 s95,v185,3
v_readlane_b32 s96,v185,4
v_readlane_b32 s97,v185,5
v_readlane_b32 s98,v185,6
v_readlane_b32 s99,v185,7
v_readlane_b32 s61,v185,8
s_add_u32 s64,s92,s93
s_add_u32 s64,s64,s94
s_add_u32 s64,s64,s95
s_add_u32 s64,s64,s96
s_add_u32 s64,s64,s97
s_add_u32 s64,s64,s98
s_add_u32 s64,s64,s99
s_min_u32 s65,s92,s93
s_min_u32 s66,s94,s95
s_min_u32 s65,s65,s66
s_min_u32 s66,s96,s97
s_min_u32 s65,s65,s66
s_min_u32 s66,s98,s99
s_min_u32 s65,s65,s66
s_cmp_lt_u32 s65,32
s_cselect_b32 s65,1,0
s_cmp_lt_u32 s64,256
s_cbranch_scc1 vslp_29
s_branch vgot_28
vslp_29:
s_sleep 8
s_sub_u32 s90,s90,1
s_cmp_gt_i32 s90,0
s_cbranch_scc1 vpoll_27
vgot_28:
s_mov_b64 exec,-1
s_and_b32 s61,s61,1
s_lshl_b32 s61,s61,13
s_cmp_lg_u32 s65,0
s_cbranch_scc1 post_9
v_lshlrev_b32 v184,7,v1
v_mov_b32 v185,1
s_mov_b32 s64,21102592
s_mov_b32 s65,21110784
buffer_store_dword v185,v184,s[20:23],s64 offen sc1
buffer_store_dword v185,v184,s[20:23],s65 offen sc1
s_branch post_9
verify_6:
v_mov_b32 v187,158976
s_cmp_lg_u32 s50,0
s_cbranch_scc1 sh0_31
v_and_b32 v184,3,v1
v_bfe_u32 v185,v1,2,1
v_lshlrev_b32 v184,2,v184
v_lshl_add_u32 v184,v185,7,v184
v_writelane_b32 v184,32,8
s_mov_b64 exec,0x1ff
vpoll_32:
buffer_load_dword v185,v184,s[44:47],0 offen sc1
s_waitcnt vmcnt(0)
vfirst_35:
v_readlane_b32 s92,v185,0
v_readlane_b32 s93,v185,1
v_readlane_b32 s94,v185,2
v_readlane_b32 s95,v185,3
v_readlane_b32 s96,v185,4
v_readlane_b32 s97,v185,5
v_readlane_b32 s98,v185,6
v_readlane_b32 s99,v185,7
v_readlane_b32 s61,v185,8
s_add_u32 s64,s92,s93
s_add_u32 s64,s64,s94
s_add_u32 s64,s64,s95
s_add_u32 s64,s64,s96
s_add_u32 s64,s64,s97
s_add_u32 s64,s64,s98
s_add_u32 s64,s64,s99
s_min_u32 s65,s92,s93
s_min_u32 s66,s94,s95
s_min_u32 s65,s65,s66
s_min_u32 s66,s96,s97
s_min_u32 s65,s65,s66
s_min_u32 s66,s98,s99
s_min_u32 s65,s65,s66
s_cmp_lt_u32 s65,32
s_cselect_b32 s65,1,0
s_cmp_lt_u32 s64,256
s_cbranch_scc1 vslp_34
s_branch vgot_33
vslp_34:
s_sleep 8
s_sub_u32 s90,s90,1
s_cmp_gt_i32 s90,0
s_cbranch_scc1 vpoll_32
vgot_33:
s_mov_b64 exec,-1
s_and_b32 s61,s61,1
s_lshl_b32 s61,s61,13
s_mov_b32 s66,s54
s_cmp_gt_u32 s51,0
s_cselect_b32 s64,s92,0
s_add_u32 s66,s66,s64
s_cmp_gt_u32 s51,1
s_cselect_b32 s64,s93,0
s_add_u32 s66,s66,s64
s_cmp_gt_u32 s51,2
s_cselect_b32 s64,s94,0
s_add_u32 s66,s66,s64
s_cmp_gt_u32 s51,3
s_cselect_b32 s64,s95,0
s_add_u32 s66,s66,s64
s_cmp_gt_u32 s51,4
s_cselect_b32 s64,s96,0
s_add_u32 s66,s66,s64
s_cmp_gt_u32 s51,5
s_cselect_b32 s64,s97,0
s_add_u32 s66,s66,s64
s_cmp_gt_u32 s51,6
s_cselect_b32 s64,s98,0
s_add_u32 s66,s66,s64
v_mov_b32 v184,s65
v_mov_b32 v185,s66
v_mov_b32 v186,s61
ds_write_b96 v187,v[184:186] offset:16
s_waitcnt lgkmcnt(0)
sh0_31:
s_barrier
ds_read_b96 v[184:186],v187 offset:16
s_waitcnt lgkmcnt(0)
v_readfirstlane_b32 s65,v184
v_readfirstlane_b32 s66,v185
v_readfirstlane_b32 s61,v186
s_cmp_lg_u32 s65,0
s_cbranch_scc1 slowrole_10
s_mov_b32 s56,0
s_branch done_1
slowrole_10:
s_mov_b32 s57,s66
s_mov_b32 s56,1
s_waitcnt vmcnt(0)
s_barrier
s_cmp_ge_u32 s57,128
s_cbranch_scc1 pre_8
s_cmp_lg_u32 s50,0
s_cbranch_scc1 nadd_36
s_mov_b64 exec,1
v_mov_b32 v184,1
v_mov_b32 v185,0
s_mov_b32 s52,164
buffer_atomic_add v184,v185,s[44:47],s52 offen sc1
s_mov_b64 exec,-1
nadd_36:
s_branch setup_5
post_9:
s_cmp_lt_u32 s55,16
s_cbranch_scc1 xd_38
s_barrier
buffer_load_dwordx4 v[8:11],v5,s[32:35],s36 offen offset:0
buffer_load_dwordx4 v[12:15],v5,s[32:35],s36 offen offset:16
buffer_load_dwordx4 v[16:19],v5,s[32:35],s36 offen offset:512
buffer_load_dwordx4 v[20:23],v5,s[32:35],s36 offen offset:528
buffer_load_dwordx4 v[24:27],v5,s[32:35],s36 offen offset:1024
buffer_load_dwordx4 v[28:31],v5,s[32:35],s36 offen offset:1040
buffer_load_dwordx4 v[32:35],v5,s[32:35],s36 offen offset:1536
buffer_load_dwordx4 v[36:39],v5,s[32:35],s36 offen offset:1552
xd_38:
s_sub_u32 s65,s57,255
s_and_b32 s66,s56,1
s_or_b32 s65,s65,s66
s_or_b32 s65,s65,s50
s_cmp_lg_u32 s65,0
s_cbranch_scc1 nomeas_37
s_mov_b64 exec,1
v_mov_b32 v184,0
s_mov_b32 s52,20971520
s_mov_b32 s53,20979712
s_mov_b32 s70,0x7fffffff
s_mov_b32 s71,0x7fffffff
s_memtime s[72:73]
s_waitcnt lgkmcnt(0)
buffer_store_dword v184,v184,s[20:23],s52 offen sc1
s_waitcnt vmcnt(0)
s_memtime s[74:75]
s_waitcnt lgkmcnt(0)
s_sub_u32 s74,s74,s72
s_min_u32 s70,s70,s74
s_memtime s[72:73]
s_waitcnt lgkmcnt(0)
buffer_store_dword v184,v184,s[20:23],s53 offen sc1
s_waitcnt vmcnt(0)
s_memtime s[74:75]
s_waitcnt lgkmcnt(0)
s_sub_u32 s74,s74,s72
s_min_u32 s71,s71,s74
s_memtime s[72:73]
s_waitcnt lgkmcnt(0)
buffer_store_dword v184,v184,s[20:23],s52 offen sc1
s_waitcnt vmcnt(0)
s_memtime s[74:75]
s_waitcnt lgkmcnt(0)
s_sub_u32 s74,s74,s72
s_min_u32 s70,s70,s74
s_memtime s[72:73]
s_waitcnt lgkmcnt(0)
buffer_store_dword v184,v184,s[20:23],s53 offen sc1
s_waitcnt vmcnt(0)
s_memtime s[74:75]
s_waitcnt lgkmcnt(0)
s_sub_u32 s74,s74,s72
s_min_u32 s71,s71,s74
s_memtime s[72:73]
s_waitcnt lgkmcnt(0)
buffer_store_dword v184,v184,s[20:23],s52 offen sc1
s_waitcnt vmcnt(0)
s_memtime s[74:75]
s_waitcnt lgkmcnt(0)
s_sub_u32 s74,s74,s72
s_min_u32 s70,s70,s74
s_memtime s[72:73]
s_waitcnt lgkmcnt(0)
buffer_store_dword v184,v184,s[20:23],s53 offen sc1
s_waitcnt vmcnt(0)
s_memtime s[74:75]
s_waitcnt lgkmcnt(0)
s_sub_u32 s74,s74,s72
s_min_u32 s71,s71,s74
s_memtime s[72:73]
s_waitcnt lgkmcnt(0)
buffer_store_dword v184,v184,s[20:23],s52 offen sc1
s_waitcnt vmcnt(0)
s_memtime s[74:75]
s_waitcnt lgkmcnt(0)
s_sub_u32 s74,s74,s72
s_min_u32 s70,s70,s74
s_memtime s[72:73]
s_waitcnt lgkmcnt(0)
buffer_store_dword v184,v184,s[20:23],s53 offen sc1
s_waitcnt vmcnt(0)
s_memtime s[74:75]
s_waitcnt lgkmcnt(0)
s_sub_u32 s74,s74,s72
s_min_u32 s71,s71,s74
s_cmp_gt_u32 s71,s70
s_cselect_b32 s65,3,2
v_mov_b32 v185,s65
buffer_store_dword v185,v184,s[44:47],32 offen sc1
s_mov_b64 exec,-1
nomeas_37:
s_waitcnt vmcnt(0)
v_and_b32 v103,s39,v39
v_lshlrev_b32 v102,16,v39
v_and_b32 v101,s39,v38
v_lshlrev_b32 v100,16,v38
v_and_b32 v99,s39,v37
v_lshlrev_b32 v98,16,v37
v_and_b32 v97,s39,v36
v_lshlrev_b32 v96,16,v36
v_and_b32 v95,s39,v35
v_lshlrev_b32 v94,16,v35
v_and_b32 v93,s39,v34
v_lshlrev_b32 v92,16,v34
v_and_b32 v91,s39,v33
v_lshlrev_b32 v90,16,v33
v_and_b32 v89,s39,v32
v_lshlrev_b32 v88,16,v32
v_and_b32 v87,s39,v31
v_lshlrev_b32 v86,16,v31
v_and_b32 v85,s39,v30
v_lshlrev_b32 v84,16,v30
v_and_b32 v83,s39,v29
v_lshlrev_b32 v82,16,v29
v_and_b32 v81,s39,v28
v_lshlrev_b32 v80,16,v28
v_and_b32 v79,s39,v27
v_lshlrev_b32 v78,16,v27
v_and_b32 v77,s39,v26
v_lshlrev_b32 v76,16,v26
v_and_b32 v75,s39,v25
v_lshlrev_b32 v74,16,v25
v_and_b32 v73,s39,v24
v_lshlrev_b32 v72,16,v24
v_and_b32 v71,s39,v23
v_lshlrev_b32 v70,16,v23
v_and_b32 v69,s39,v22
v_lshlrev_b32 v68,16,v22
v_and_b32 v67,s39,v21
v_lshlrev_b32 v66,16,v21
v_and_b32 v65,s39,v20
v_lshlrev_b32 v64,16,v20
v_and_b32 v63,s39,v19
v_lshlrev_b32 v62,16,v19
v_and_b32 v61,s39,v18
v_lshlrev_b32 v60,16,v18
v_and_b32 v59,s39,v17
v_lshlrev_b32 v58,16,v17
v_and_b32 v57,s39,v16
v_lshlrev_b32 v56,16,v16
v_and_b32 v55,s39,v15
v_lshlrev_b32 v54,16,v15
v_and_b32 v53,s39,v14
v_lshlrev_b32 v52,16,v14
v_and_b32 v51,s39,v13
v_lshlrev_b32 v50,16,v13
v_and_b32 v49,s39,v12
v_lshlrev_b32 v48,16,v12
v_and_b32 v47,s39,v11
v_lshlrev_b32 v46,16,v11
v_and_b32 v45,s39,v10
v_lshlrev_b32 v44,16,v10
v_and_b32 v43,s39,v9
v_lshlrev_b32 v42,16,v9
v_and_b32 v41,s39,v8
v_lshlrev_b32 v40,16,v8
v_pk_add_f32 v[8:9],v[40:41],v[42:43]
v_pk_add_f32 v[10:11],v[44:45],v[46:47]
v_pk_add_f32 v[8:9],v[8:9],v[48:49]
v_pk_add_f32 v[10:11],v[10:11],v[50:51]
v_pk_add_f32 v[8:9],v[8:9],v[52:53]
v_pk_add_f32 v[10:11],v[10:11],v[54:55]
v_pk_add_f32 v[8:9],v[8:9],v[56:57]
v_pk_add_f32 v[10:11],v[10:11],v[58:59]
v_pk_add_f32 v[8:9],v[8:9],v[60:61]
v_pk_add_f32 v[10:11],v[10:11],v[62:63]
v_pk_add_f32 v[8:9],v[8:9],v[64:65]
v_pk_add_f32 v[10:11],v[10:11],v[66:67]
v_pk_add_f32 v[8:9],v[8:9],v[68:69]
v_pk_add_f32 v[10:11],v[10:11],v[70:71]
v_pk_add_f32 v[8:9],v[8:9],v[72:73]
v_pk_add_f32 v[10:11],v[10:11],v[74:75]
v_pk_add_f32 v[8:9],v[8:9],v[76:77]
v_pk_add_f32 v[10:11],v[10:11],v[78:79]
v_pk_add_f32 v[8:9],v[8:9],v[80:81]
v_pk_add_f32 v[10:11],v[10:11],v[82:83]
v_pk_add_f32 v[8:9],v[8:9],v[84:85]
v_pk_add_f32 v[10:11],v[10:11],v[86:87]
v_pk_add_f32 v[8:9],v[8:9],v[88:89]
v_pk_add_f32 v[10:11],v[10:11],v[90:91]
v_pk_add_f32 v[8:9],v[8:9],v[92:93]
v_pk_add_f32 v[10:11],v[10:11],v[94:95]
v_pk_add_f32 v[8:9],v[8:9],v[96:97]
v_pk_add_f32 v[10:11],v[10:11],v[98:99]
v_pk_add_f32 v[8:9],v[8:9],v[100:101]
v_pk_add_f32 v[10:11],v[10:11],v[102:103]
v_pk_add_f32 v[8:9],v[8:9],v[10:11]
v_add_f32 v8,v8,v9
s_nop 1
v_add_f32_dpp v8,v8,v8 row_ror:4 row_mask:0xf bank_mask:0xf
s_nop 1
v_add_f32_dpp v8,v8,v8 row_ror:8 row_mask:0xf bank_mask:0xf
v_mov_b32 v12,v8
s_nop 1
v_permlane16_swap_b32 v12,v8
v_add_f32 v8,v8,v12
v_mov_b32 v12,v8
s_nop 1
v_permlane32_swap_b32 v12,v8
v_add_f32 v8,v8,v12
v_mul_f32 v8,0xba800000,v8
v_pk_add_f32 v[40:41],v[40:41],v[8:9] op_sel_hi:[1,0]
v_pk_add_f32 v[42:43],v[42:43],v[8:9] op_sel_hi:[1,0]
v_pk_add_f32 v[44:45],v[44:45],v[8:9] op_sel_hi:[1,0]
v_pk_add_f32 v[46:47],v[46:47],v[8:9] op_sel_hi:[1,0]
v_pk_add_f32 v[48:49],v[48:49],v[8:9] op_sel_hi:[1,0]
v_pk_add_f32 v[50:51],v[50:51],v[8:9] op_sel_hi:[1,0]
v_pk_add_f32 v[52:53],v[52:53],v[8:9] op_sel_hi:[1,0]
v_pk_add_f32 v[54:55],v[54:55],v[8:9] op_sel_hi:[1,0]
v_pk_add_f32 v[56:57],v[56:57],v[8:9] op_sel_hi:[1,0]
v_pk_add_f32 v[58:59],v[58:59],v[8:9] op_sel_hi:[1,0]
v_pk_add_f32 v[60:61],v[60:61],v[8:9] op_sel_hi:[1,0]
v_pk_add_f32 v[62:63],v[62:63],v[8:9] op_sel_hi:[1,0]
v_pk_add_f32 v[64:65],v[64:65],v[8:9] op_sel_hi:[1,0]
v_pk_add_f32 v[66:67],v[66:67],v[8:9] op_sel_hi:[1,0]
v_pk_add_f32 v[68:69],v[68:69],v[8:9] op_sel_hi:[1,0]
v_pk_add_f32 v[70:71],v[70:71],v[8:9] op_sel_hi:[1,0]
v_pk_add_f32 v[72:73],v[72:73],v[8:9] op_sel_hi:[1,0]
v_pk_add_f32 v[74:75],v[74:75],v[8:9] op_sel_hi:[1,0]
v_pk_add_f32 v[76:77],v[76:77],v[8:9] op_sel_hi:[1,0]
v_pk_add_f32 v[78:79],v[78:79],v[8:9] op_sel_hi:[1,0]
v_pk_add_f32 v[80:81],v[80:81],v[8:9] op_sel_hi:[1,0]
v_pk_add_f32 v[82:83],v[82:83],v[8:9] op_sel_hi:[1,0]
v_pk_add_f32 v[84:85],v[84:85],v[8:9] op_sel_hi:[1,0]
v_pk_add_f32 v[86:87],v[86:87],v[8:9] op_sel_hi:[1,0]
v_pk_add_f32 v[88:89],v[88:89],v[8:9] op_sel_hi:[1,0]
v_pk_add_f32 v[90:91],v[90:91],v[8:9] op_sel_hi:[1,0]
v_pk_add_f32 v[92:93],v[92:93],v[8:9] op_sel_hi:[1,0]
v_pk_add_f32 v[94:95],v[94:95],v[8:9] op_sel_hi:[1,0]
v_pk_add_f32 v[96:97],v[96:97],v[8:9] op_sel_hi:[1,0]
v_pk_add_f32 v[98:99],v[98:99],v[8:9] op_sel_hi:[1,0]
v_pk_add_f32 v[100:101],v[100:101],v[8:9] op_sel_hi:[1,0]
v_pk_add_f32 v[102:103],v[102:103],v[8:9] op_sel_hi:[1,0]
v_pk_mul_f32 v[10:11],v[40:41],v[40:41]
v_pk_mul_f32 v[14:15],v[42:43],v[42:43]
v_pk_fma_f32 v[10:11],v[44:45],v[44:45],v[10:11]
v_pk_fma_f32 v[14:15],v[46:47],v[46:47],v[14:15]
v_pk_fma_f32 v[10:11],v[48:49],v[48:49],v[10:11]
v_pk_fma_f32 v[14:15],v[50:51],v[50:51],v[14:15]
v_pk_fma_f32 v[10:11],v[52:53],v[52:53],v[10:11]
v_pk_fma_f32 v[14:15],v[54:55],v[54:55],v[14:15]
v_pk_fma_f32 v[10:11],v[56:57],v[56:57],v[10:11]
v_pk_fma_f32 v[14:15],v[58:59],v[58:59],v[14:15]
v_pk_fma_f32 v[10:11],v[60:61],v[60:61],v[10:11]
v_pk_fma_f32 v[14:15],v[62:63],v[62:63],v[14:15]
v_pk_fma_f32 v[10:11],v[64:65],v[64:65],v[10:11]
v_pk_fma_f32 v[14:15],v[66:67],v[66:67],v[14:15]
v_pk_fma_f32 v[10:11],v[68:69],v[68:69],v[10:11]
v_pk_fma_f32 v[14:15],v[70:71],v[70:71],v[14:15]
v_pk_fma_f32 v[10:11],v[72:73],v[72:73],v[10:11]
v_pk_fma_f32 v[14:15],v[74:75],v[74:75],v[14:15]
v_pk_fma_f32 v[10:11],v[76:77],v[76:77],v[10:11]
v_pk_fma_f32 v[14:15],v[78:79],v[78:79],v[14:15]
v_pk_fma_f32 v[10:11],v[80:81],v[80:81],v[10:11]
v_pk_fma_f32 v[14:15],v[82:83],v[82:83],v[14:15]
v_pk_fma_f32 v[10:11],v[84:85],v[84:85],v[10:11]
v_pk_fma_f32 v[14:15],v[86:87],v[86:87],v[14:15]
v_pk_fma_f32 v[10:11],v[88:89],v[88:89],v[10:11]
v_pk_fma_f32 v[14:15],v[90:91],v[90:91],v[14:15]
v_pk_fma_f32 v[10:11],v[92:93],v[92:93],v[10:11]
v_pk_fma_f32 v[14:15],v[94:95],v[94:95],v[14:15]
v_pk_fma_f32 v[10:11],v[96:97],v[96:97],v[10:11]
v_pk_fma_f32 v[14:15],v[98:99],v[98:99],v[14:15]
v_pk_fma_f32 v[10:11],v[100:101],v[100:101],v[10:11]
v_pk_fma_f32 v[14:15],v[102:103],v[102:103],v[14:15]
v_pk_add_f32 v[10:11],v[10:11],v[14:15]
v_add_f32 v10,v10,v11
s_nop 1
v_add_f32_dpp v10,v10,v10 row_ror:4 row_mask:0xf bank_mask:0xf
s_nop 1
v_add_f32_dpp v10,v10,v10 row_ror:8 row_mask:0xf bank_mask:0xf
v_mov_b32 v12,v10
s_nop 1
v_permlane16_swap_b32 v12,v10
v_add_f32 v10,v10,v12
v_mov_b32 v12,v10
s_nop 1
v_permlane32_swap_b32 v12,v10
v_add_f32 v10,v10,v12
v_mov_b32 v12,0x3727c5ac
v_fmac_f32 v12,0x3a800000,v10
v_rsq_f32 v10,v12
s_nop 0
v_pk_mul_f32 v[40:41],v[40:41],v[10:11] op_sel_hi:[1,0]
v_pk_mul_f32 v[42:43],v[42:43],v[10:11] op_sel_hi:[1,0]
v_pk_mul_f32 v[44:45],v[44:45],v[10:11] op_sel_hi:[1,0]
v_pk_mul_f32 v[46:47],v[46:47],v[10:11] op_sel_hi:[1,0]
v_pk_mul_f32 v[48:49],v[48:49],v[10:11] op_sel_hi:[1,0]
v_pk_mul_f32 v[50:51],v[50:51],v[10:11] op_sel_hi:[1,0]
v_pk_mul_f32 v[52:53],v[52:53],v[10:11] op_sel_hi:[1,0]
v_pk_mul_f32 v[54:55],v[54:55],v[10:11] op_sel_hi:[1,0]
v_pk_mul_f32 v[56:57],v[56:57],v[10:11] op_sel_hi:[1,0]
v_pk_mul_f32 v[58:59],v[58:59],v[10:11] op_sel_hi:[1,0]
v_pk_mul_f32 v[60:61],v[60:61],v[10:11] op_sel_hi:[1,0]
v_pk_mul_f32 v[62:63],v[62:63],v[10:11] op_sel_hi:[1,0]
v_pk_mul_f32 v[64:65],v[64:65],v[10:11] op_sel_hi:[1,0]
v_pk_mul_f32 v[66:67],v[66:67],v[10:11] op_sel_hi:[1,0]
v_pk_mul_f32 v[68:69],v[68:69],v[10:11] op_sel_hi:[1,0]
v_pk_mul_f32 v[70:71],v[70:71],v[10:11] op_sel_hi:[1,0]
v_pk_mul_f32 v[72:73],v[72:73],v[10:11] op_sel_hi:[1,0]
v_pk_mul_f32 v[74:75],v[74:75],v[10:11] op_sel_hi:[1,0]
v_pk_mul_f32 v[76:77],v[76:77],v[10:11] op_sel_hi:[1,0]
v_pk_mul_f32 v[78:79],v[78:79],v[10:11] op_sel_hi:[1,0]
v_pk_mul_f32 v[80:81],v[80:81],v[10:11] op_sel_hi:[1,0]
v_pk_mul_f32 v[82:83],v[82:83],v[10:11] op_sel_hi:[1,0]
v_pk_mul_f32 v[84:85],v[84:85],v[10:11] op_sel_hi:[1,0]
v_pk_mul_f32 v[86:87],v[86:87],v[10:11] op_sel_hi:[1,0]
v_pk_mul_f32 v[88:89],v[88:89],v[10:11] op_sel_hi:[1,0]
v_pk_mul_f32 v[90:91],v[90:91],v[10:11] op_sel_hi:[1,0]
v_pk_mul_f32 v[92:93],v[92:93],v[10:11] op_sel_hi:[1,0]
v_pk_mul_f32 v[94:95],v[94:95],v[10:11] op_sel_hi:[1,0]
v_pk_mul_f32 v[96:97],v[96:97],v[10:11] op_sel_hi:[1,0]
v_pk_mul_f32 v[98:99],v[98:99],v[10:11] op_sel_hi:[1,0]
v_pk_mul_f32 v[100:101],v[100:101],v[10:11] op_sel_hi:[1,0]
v_pk_mul_f32 v[102:103],v[102:103],v[10:11] op_sel_hi:[1,0]
v_mov_b32 v187,158976
s_cmp_lg_u32 s50,0
s_cbranch_scc1 sh0_39
s_mov_b32 s65,0
s_cmp_eq_u32 s56,1
s_cbranch_scc1 m1s_40
s_lshl_b32 s52,s55,7
s_add_u32 s52,s52,21102592
s_mov_b32 s53,0
m1l_41:
v_mov_b32 v184,0
buffer_load_dword v185,v184,s[20:23],s52 offen sc1
s_waitcnt vmcnt(0)
v_readfirstlane_b32 s64,v185
s_mov_b32 s65,0
s_cmp_eq_u32 s64,1
s_cbranch_scc1 m1ok_42
s_sub_u32 s90,s90,1
s_cmp_lt_i32 s90,0
s_cbranch_scc1 m1ok_42
s_add_u32 s53,s53,1
s_and_b32 s64,s53,31
s_cbranch_scc1 m1l_41
v_and_b32 v184,3,v1
v_bfe_u32 v185,v1,2,1
v_lshlrev_b32 v184,2,v184
v_lshl_add_u32 v184,v185,7,v184
v_writelane_b32 v184,32,8
s_mov_b64 exec,0x1ff
vpoll_43:
buffer_load_dword v185,v184,s[44:47],0 offen sc1
s_waitcnt vmcnt(0)
vfirst_46:
v_readlane_b32 s92,v185,0
v_readlane_b32 s93,v185,1
v_readlane_b32 s94,v185,2
v_readlane_b32 s95,v185,3
v_readlane_b32 s96,v185,4
v_readlane_b32 s97,v185,5
v_readlane_b32 s98,v185,6
v_readlane_b32 s99,v185,7
v_readlane_b32 s61,v185,8
s_add_u32 s64,s92,s93
s_add_u32 s64,s64,s94
s_add_u32 s64,s64,s95
s_add_u32 s64,s64,s96
s_add_u32 s64,s64,s97
s_add_u32 s64,s64,s98
s_add_u32 s64,s64,s99
s_min_u32 s65,s92,s93
s_min_u32 s66,s94,s95
s_min_u32 s65,s65,s66
s_min_u32 s66,s96,s97
s_min_u32 s65,s65,s66
s_min_u32 s66,s98,s99
s_min_u32 s65,s65,s66
s_cmp_lt_u32 s65,32
s_cselect_b32 s65,1,0
s_cmp_lt_u32 s64,256
s_cbranch_scc1 vslp_45
s_branch vgot_44
vslp_45:
s_sleep 8
s_sub_u32 s90,s90,1
s_cmp_gt_i32 s90,0
s_cbranch_scc1 vpoll_43
vgot_44:
s_mov_b64 exec,-1
s_and_b32 s61,s61,1
s_lshl_b32 s61,s61,13
s_mov_b32 s66,s54
s_cmp_gt_u32 s51,0
s_cselect_b32 s64,s92,0
s_add_u32 s66,s66,s64
s_cmp_gt_u32 s51,1
s_cselect_b32 s64,s93,0
s_add_u32 s66,s66,s64
s_cmp_gt_u32 s51,2
s_cselect_b32 s64,s94,0
s_add_u32 s66,s66,s64
s_cmp_gt_u32 s51,3
s_cselect_b32 s64,s95,0
s_add_u32 s66,s66,s64
s_cmp_gt_u32 s51,4
s_cselect_b32 s64,s96,0
s_add_u32 s66,s66,s64
s_cmp_gt_u32 s51,5
s_cselect_b32 s64,s97,0
s_add_u32 s66,s66,s64
s_cmp_gt_u32 s51,6
s_cselect_b32 s64,s98,0
s_add_u32 s66,s66,s64
s_cmp_eq_u32 s65,0
s_cbranch_scc1 m1l_41
s_branch m1ok_42
m1s_40:
s_mov_b32 s53,256
s_mov_b32 s52,164
v_mov_b32 v184,0
dp_47:
buffer_load_dword v185,v184,s[44:47],s52 offen sc1
s_waitcnt vmcnt(0)
v_cmp_ne_u32 vcc,s53,v185
s_cbranch_vccz dpok_48
s_sleep 8
s_sub_u32 s90,s90,1
s_cmp_gt_i32 s90,0
s_cbranch_scc1 dp_47
dpok_48:
m1ok_42:
v_mov_b32 v184,s65
v_mov_b32 v185,s66
v_mov_b32 v186,s61
ds_write_b96 v187,v[184:186] offset:16
s_waitcnt lgkmcnt(0)
sh0_39:
s_barrier
ds_read_b96 v[184:186],v187 offset:16
s_waitcnt lgkmcnt(0)
v_readfirstlane_b32 s65,v184
v_readfirstlane_b32 s66,v185
v_readfirstlane_b32 s61,v186
s_cmp_lg_u32 s65,0
s_cbranch_scc1 slowrole_10
s_and_b32 s56,s56,1
s_lshl_b32 s53,s56,2
s_add_u32 s53,s53,4
v_mul_u32_u24 v241,s53,v1
s_lshr_b32 s53,s55,4
s_or_b32 s53,s53,s50
s_cselect_b32 s53,0x7fff0000,32
s_mov_b64 exec,3
buffer_load_dword v240,v241,s[44:47],s53 offen sc1
s_mov_b64 exec,-1
v_lshlrev_b32 v7,5,v0
s_mov_b32 s40,24576
buffer_load_dwordx4 v[104:107],v7,s[20:23],s40 offen offset:0 sc1
buffer_load_dwordx4 v[108:111],v7,s[20:23],s40 offen offset:16 sc1
s_add_u32 s40,s40,8192
buffer_load_dwordx4 v[112:115],v7,s[20:23],s40 offen offset:0 sc1
buffer_load_dwordx4 v[116:119],v7,s[20:23],s40 offen offset:16 sc1
s_add_u32 s40,s40,8192
buffer_load_dwordx4 v[120:123],v7,s[20:23],s40 offen offset:0 sc1
buffer_load_dwordx4 v[124:127],v7,s[20:23],s40 offen offset:16 sc1
s_add_u32 s40,s40,8192
buffer_load_dwordx4 v[128:131],v7,s[20:23],s40 offen offset:0 sc1
buffer_load_dwordx4 v[132:135],v7,s[20:23],s40 offen offset:16 sc1
v_mov_b32 v14,1.0
v_cmp_lt_u32 vcc,127,v0
s_nop 1
v_cndmask_b32 v14,0,v14,vcc
s_waitcnt vmcnt(0)
v_pk_add_f32 v[104:105],v[104:105],v[112:113]
v_pk_add_f32 v[120:121],v[120:121],v[128:129]
v_pk_add_f32 v[106:107],v[106:107],v[114:115]
v_pk_add_f32 v[122:123],v[122:123],v[130:131]
v_pk_add_f32 v[108:109],v[108:109],v[116:117]
v_pk_add_f32 v[124:125],v[124:125],v[132:133]
v_pk_add_f32 v[110:111],v[110:111],v[118:119]
v_pk_add_f32 v[126:127],v[126:127],v[134:135]
v_pk_add_f32 v[104:105],v[104:105],v[120:121]
v_pk_add_f32 v[106:107],v[106:107],v[122:123]
v_pk_add_f32 v[108:109],v[108:109],v[124:125]
v_pk_add_f32 v[110:111],v[110:111],v[126:127]
v_cvt_pk_bf16_f32 v112,v104,v105
v_cvt_pk_bf16_f32 v113,v106,v107
v_cvt_pk_bf16_f32 v114,v108,v109
v_cvt_pk_bf16_f32 v115,v110,v111
v_lshlrev_b32 v104,16,v112
v_and_b32 v105,s39,v112
v_lshlrev_b32 v106,16,v113
v_and_b32 v107,s39,v113
v_lshlrev_b32 v108,16,v114
v_and_b32 v109,s39,v114
v_lshlrev_b32 v110,16,v115
v_and_b32 v111,s39,v115
v_pk_add_f32 v[104:105],v[104:105],v[14:15] op_sel_hi:[1,0]
v_pk_add_f32 v[106:107],v[106:107],v[14:15] op_sel_hi:[1,0]
v_pk_add_f32 v[108:109],v[108:109],v[14:15] op_sel_hi:[1,0]
v_pk_add_f32 v[110:111],v[110:111],v[14:15] op_sel_hi:[1,0]
ds_write_b128 v7,v[104:107] offset:4096
ds_write_b128 v7,v[108:111] offset:4112
s_waitcnt lgkmcnt(0)
s_barrier
ds_read_b128 v[104:107],v4 offset:8192
ds_read_b128 v[168:171],v4 offset:4096
ds_read_b128 v[108:111],v4 offset:8208
ds_read_b128 v[172:175],v4 offset:4112
ds_read_b128 v[112:115],v4 offset:8224
ds_read_b128 v[176:179],v4 offset:4128
ds_read_b128 v[116:119],v4 offset:8240
ds_read_b128 v[180:183],v4 offset:4144
ds_read_b128 v[120:123],v4 offset:9216
ds_read_b128 v[184:187],v4 offset:5120
ds_read_b128 v[124:127],v4 offset:9232
ds_read_b128 v[188:191],v4 offset:5136
ds_read_b128 v[128:131],v4 offset:9248
ds_read_b128 v[192:195],v4 offset:5152
ds_read_b128 v[132:135],v4 offset:9264
ds_read_b128 v[196:199],v4 offset:5168
ds_read_b128 v[136:139],v4 offset:10240
ds_read_b128 v[200:203],v4 offset:6144
ds_read_b128 v[140:143],v4 offset:10256
ds_read_b128 v[204:207],v4 offset:6160
ds_read_b128 v[144:147],v4 offset:10272
ds_read_b128 v[208:211],v4 offset:6176
ds_read_b128 v[148:151],v4 offset:10288
ds_read_b128 v[212:215],v4 offset:6192
ds_read_b128 v[152:155],v4 offset:11264
ds_read_b128 v[216:219],v4 offset:7168
ds_read_b128 v[156:159],v4 offset:11280
ds_read_b128 v[220:223],v4 offset:7184
ds_read_b128 v[160:163],v4 offset:11296
ds_read_b128 v[224:227],v4 offset:7200
ds_read_b128 v[164:167],v4 offset:11312
ds_read_b128 v[228:231],v4 offset:7216
s_waitcnt lgkmcnt(15)
v_pk_fma_f32 v[40:41],v[40:41],v[104:105],v[168:169]
v_pk_fma_f32 v[42:43],v[42:43],v[106:107],v[170:171]
v_pk_fma_f32 v[44:45],v[44:45],v[108:109],v[172:173]
v_pk_fma_f32 v[46:47],v[46:47],v[110:111],v[174:175]
v_pk_fma_f32 v[48:49],v[48:49],v[112:113],v[176:177]
v_pk_fma_f32 v[50:51],v[50:51],v[114:115],v[178:179]
v_pk_fma_f32 v[52:53],v[52:53],v[116:117],v[180:181]
v_pk_fma_f32 v[54:55],v[54:55],v[118:119],v[182:183]
v_cvt_pk_bf16_f32 v16,v40,v41
v_cvt_pk_bf16_f32 v17,v48,v49
v_cvt_pk_bf16_f32 v18,v42,v43
v_cvt_pk_bf16_f32 v19,v50,v51
buffer_store_dwordx4 v[16:19],v6,s[20:23],s37 offen offset:0 sc1
v_cvt_pk_bf16_f32 v20,v44,v45
v_cvt_pk_bf16_f32 v21,v52,v53
v_cvt_pk_bf16_f32 v22,v46,v47
v_cvt_pk_bf16_f32 v23,v54,v55
buffer_store_dwordx4 v[20:23],v6,s[20:23],s37 offen offset:256 sc1
s_waitcnt lgkmcnt(15)
v_pk_fma_f32 v[56:57],v[56:57],v[120:121],v[184:185]
v_pk_fma_f32 v[58:59],v[58:59],v[122:123],v[186:187]
v_pk_fma_f32 v[60:61],v[60:61],v[124:125],v[188:189]
v_pk_fma_f32 v[62:63],v[62:63],v[126:127],v[190:191]
v_pk_fma_f32 v[64:65],v[64:65],v[128:129],v[192:193]
v_pk_fma_f32 v[66:67],v[66:67],v[130:131],v[194:195]
v_pk_fma_f32 v[68:69],v[68:69],v[132:133],v[196:197]
v_pk_fma_f32 v[70:71],v[70:71],v[134:135],v[198:199]
v_cvt_pk_bf16_f32 v24,v56,v57
v_cvt_pk_bf16_f32 v25,v64,v65
v_cvt_pk_bf16_f32 v26,v58,v59
v_cvt_pk_bf16_f32 v27,v66,v67
s_add_u32 s37,s37,16384
buffer_store_dwordx4 v[24:27],v6,s[20:23],s37 offen offset:0 sc1
v_cvt_pk_bf16_f32 v28,v60,v61
v_cvt_pk_bf16_f32 v29,v68,v69
v_cvt_pk_bf16_f32 v30,v62,v63
v_cvt_pk_bf16_f32 v31,v70,v71
buffer_store_dwordx4 v[28:31],v6,s[20:23],s37 offen offset:256 sc1
s_waitcnt lgkmcnt(8)
v_pk_fma_f32 v[72:73],v[72:73],v[136:137],v[200:201]
v_pk_fma_f32 v[74:75],v[74:75],v[138:139],v[202:203]
v_pk_fma_f32 v[76:77],v[76:77],v[140:141],v[204:205]
v_pk_fma_f32 v[78:79],v[78:79],v[142:143],v[206:207]
v_pk_fma_f32 v[80:81],v[80:81],v[144:145],v[208:209]
v_pk_fma_f32 v[82:83],v[82:83],v[146:147],v[210:211]
v_pk_fma_f32 v[84:85],v[84:85],v[148:149],v[212:213]
v_pk_fma_f32 v[86:87],v[86:87],v[150:151],v[214:215]
v_cvt_pk_bf16_f32 v16,v72,v73
v_cvt_pk_bf16_f32 v17,v80,v81
v_cvt_pk_bf16_f32 v18,v74,v75
v_cvt_pk_bf16_f32 v19,v82,v83
s_add_u32 s37,s37,16384
buffer_store_dwordx4 v[16:19],v6,s[20:23],s37 offen offset:0 sc1
v_cvt_pk_bf16_f32 v20,v76,v77
v_cvt_pk_bf16_f32 v21,v84,v85
v_cvt_pk_bf16_f32 v22,v78,v79
v_cvt_pk_bf16_f32 v23,v86,v87
buffer_store_dwordx4 v[20:23],v6,s[20:23],s37 offen offset:256 sc1
s_waitcnt lgkmcnt(0)
v_pk_fma_f32 v[88:89],v[88:89],v[152:153],v[216:217]
v_pk_fma_f32 v[90:91],v[90:91],v[154:155],v[218:219]
v_pk_fma_f32 v[92:93],v[92:93],v[156:157],v[220:221]
v_pk_fma_f32 v[94:95],v[94:95],v[158:159],v[222:223]
v_pk_fma_f32 v[96:97],v[96:97],v[160:161],v[224:225]
v_pk_fma_f32 v[98:99],v[98:99],v[162:163],v[226:227]
v_pk_fma_f32 v[100:101],v[100:101],v[164:165],v[228:229]
v_pk_fma_f32 v[102:103],v[102:103],v[166:167],v[230:231]
v_cvt_pk_bf16_f32 v24,v88,v89
v_cvt_pk_bf16_f32 v25,v96,v97
v_cvt_pk_bf16_f32 v26,v90,v91
v_cvt_pk_bf16_f32 v27,v98,v99
s_add_u32 s37,s37,16384
buffer_store_dwordx4 v[24:27],v6,s[20:23],s37 offen offset:0 sc1
v_cvt_pk_bf16_f32 v28,v92,v93
v_cvt_pk_bf16_f32 v29,v100,v101
v_cvt_pk_bf16_f32 v30,v94,v95
v_cvt_pk_bf16_f32 v31,v102,v103
buffer_store_dwordx4 v[28:31],v6,s[20:23],s37 offen offset:256 sc1
s_waitcnt vmcnt(0)
s_barrier
v_mov_b32 v187,158976
s_cmp_lg_u32 s50,0
s_cbranch_scc1 sh0_49
s_cmp_ge_u32 s55,16
s_cbranch_scc1 nodln_50
rdl_52:
v_readlane_b32 s64,v240,0
v_readlane_b32 s65,v240,1
s_cmp_eq_u32 s56,1
s_cselect_b32 s64,2,s64
s_cmp_eq_u32 s65,128
s_cselect_b32 s64,s64,0
s_cmp_lg_u32 s64,0
s_cbranch_scc1 rdok_53
s_mov_b64 exec,3
buffer_load_dword v240,v241,s[44:47],s53 offen sc1
s_mov_b64 exec,-1
s_sub_u32 s90,s90,1
s_cmp_gt_i32 s90,0
s_waitcnt vmcnt(0)
s_cbranch_scc1 rdl_52
rdok_53:
s_lshl_b32 s65,s55,2
v_lshl_add_u32 v184,v1,7,s65
v_mov_b32 v185,s64
s_mov_b32 s64,21168128
s_mov_b32 s65,21176320
buffer_store_dword v185,v184,s[20:23],s64 offen sc1
buffer_store_dword v185,v184,s[20:23],s65 offen sc1
nodln_50:
s_mov_b32 s61,0
s_cmp_eq_u32 s56,1
s_cbranch_scc1 nopar_51
v_mov_b32 v184,0
dp_54:
buffer_load_dword v185,v184,s[44:47],32 offen sc1
s_waitcnt vmcnt(0)
v_cmp_eq_u32 vcc,0,v185
s_cbranch_vccz dpok_55
s_sleep 4
s_sub_u32 s90,s90,1
s_cmp_gt_i32 s90,0
s_cbranch_scc1 dp_54
dpok_55:
v_readfirstlane_b32 s65,v185
s_and_b32 s65,s65,1
s_lshl_b32 s61,s65,13
nopar_51:
v_mov_b32 v184,s65
v_mov_b32 v185,s66
v_mov_b32 v186,s61
ds_write_b96 v187,v[184:186] offset:16
s_waitcnt lgkmcnt(0)
sh0_49:
s_barrier
ds_read_b96 v[184:186],v187 offset:16
s_waitcnt lgkmcnt(0)
v_readfirstlane_b32 s65,v184
v_readfirstlane_b32 s66,v185
v_readfirstlane_b32 s61,v186
s_sub_u32 s55,s57,128
s_cmp_lg_u32 s50,0
s_cbranch_scc1 nsig_56
s_lshr_b32 s95,s55,4
s_lshl_b32 s95,s95,6
s_add_u32 s95,s95,21052416
s_mov_b64 exec,1
v_mov_b32 v184,112
v_mov_b32 v185,0
buffer_atomic_add v184,v185,s[20:23],s95 offen sc1
s_mov_b64 exec,-1
nsig_56:
s_branch pipe_worker
loops_7:
s_lshl_b32 s64,s50,14
s_add_u32 m0,s64,0
s_add_u32 s65,s64,57344
buffer_load_dwordx4 v16,s[20:23],s65 offen offset:0 lds
buffer_load_dwordx4 v16,s[20:23],s65 offen offset:1024 lds
buffer_load_dwordx4 v16,s[20:23],s65 offen offset:2048 lds
buffer_load_dwordx4 v16,s[20:23],s65 offen offset:3072 lds
s_add_u32 m0,s64,4096
s_add_u32 s65,s64,61440
buffer_load_dwordx4 v16,s[20:23],s65 offen offset:0 lds
buffer_load_dwordx4 v16,s[20:23],s65 offen offset:1024 lds
buffer_load_dwordx4 v16,s[20:23],s65 offen offset:2048 lds
buffer_load_dwordx4 v16,s[20:23],s65 offen offset:3072 lds
s_add_u32 m0,s64,8192
s_add_u32 s65,s64,65536
buffer_load_dwordx4 v16,s[20:23],s65 offen offset:0 lds
buffer_load_dwordx4 v16,s[20:23],s65 offen offset:1024 lds
buffer_load_dwordx4 v16,s[20:23],s65 offen offset:2048 lds
buffer_load_dwordx4 v16,s[20:23],s65 offen offset:3072 lds
s_add_u32 m0,s64,12288
s_add_u32 s65,s64,69632
buffer_load_dwordx4 v16,s[20:23],s65 offen offset:0 lds
buffer_load_dwordx4 v16,s[20:23],s65 offen offset:1024 lds
buffer_load_dwordx4 v16,s[20:23],s65 offen offset:2048 lds
buffer_load_dwordx4 v16,s[20:23],s65 offen offset:3072 lds
s_add_u32 m0,s64,65536
s_add_u32 s65,s64,122880
buffer_load_dwordx4 v16,s[20:23],s65 offen offset:0 lds
buffer_load_dwordx4 v16,s[20:23],s65 offen offset:1024 lds
buffer_load_dwordx4 v16,s[20:23],s65 offen offset:2048 lds
buffer_load_dwordx4 v16,s[20:23],s65 offen offset:3072 lds
s_add_u32 m0,s64,69632
s_add_u32 s65,s64,126976
buffer_load_dwordx4 v16,s[20:23],s65 offen offset:0 lds
buffer_load_dwordx4 v16,s[20:23],s65 offen offset:1024 lds
buffer_load_dwordx4 v16,s[20:23],s65 offen offset:2048 lds
buffer_load_dwordx4 v16,s[20:23],s65 offen offset:3072 lds
s_add_u32 m0,s64,73728
s_add_u32 s65,s64,131072
buffer_load_dwordx4 v16,s[20:23],s65 offen offset:0 lds
buffer_load_dwordx4 v16,s[20:23],s65 offen offset:1024 lds
buffer_load_dwordx4 v16,s[20:23],s65 offen offset:2048 lds
buffer_load_dwordx4 v16,s[20:23],s65 offen offset:3072 lds
s_add_u32 m0,s64,77824
s_add_u32 s65,s64,135168
buffer_load_dwordx4 v16,s[20:23],s65 offen offset:0 lds
buffer_load_dwordx4 v16,s[20:23],s65 offen offset:1024 lds
buffer_load_dwordx4 v16,s[20:23],s65 offen offset:2048 lds
buffer_load_dwordx4 v16,s[20:23],s65 offen offset:3072 lds
s_mov_b64 s[24:25],s[20:21]
s_mov_b64 s[28:29],s[20:21]
s_mov_b32 s27,0x20000
s_mov_b32 s31,0x20000
s_cmp_eq_u32 s56,0
s_cselect_b32 s26,s22,0
s_cselect_b32 s30,0,s22
s_lshl_b32 s64,s58,14
s_add_u32 s64,s64,23068672
v_add_u32 v26,s64,v16
v_add_u32 v27,4096,v26
v_add_u32 v28,8192,v26
v_add_u32 v29,12288,v26
s_lshl_b32 s65,s59,9
s_add_u32 s66,s64,s65
s_lshl_b32 s64,s58,7
s_add_u32 s64,s64,23592960
v_and_b32 v18,31,v1
v_lshl_add_u32 v18,v18,2,s64
s_lshl_b32 s65,s59,2
s_add_u32 s64,s64,s65
v_mov_b32 v13,s64
v_mov_b32 v14,0x4444
v_mov_b32 v22,0xeeee
v_cmp_lt_u32 vcc,7,v3
s_nop 1
v_cndmask_b32 v14,v14,v22,vcc
v_and_b32 v22,1,v3
v_cmp_eq_u32 vcc,0,v22
v_mov_b32 v15,0x03020706
v_mov_b32 v23,0x05040100
v_cndmask_b32 v15,v15,v23,vcc
v_lshlrev_b32 v19,5,v22
v_lshl_add_u32 v19,v4,6,v19
v_lshrrev_b32 v23,1,v3
v_lshl_add_u32 v19,v23,2,v19
s_lshl_b32 s67,s57,10
s_add_u32 s67,s67,23199744
s_lshl_b32 s64,s50,2
s_lshr_b32 s64,0x1320,s64
s_and_b32 s64,s64,3
s_lshl_b32 s64,s64,8
s_add_u32 s64,s64,s67
v_add_u32 v19,s64,v19
v_add_u32 v24,131072,v16
v_mov_b32 v21,158720
v_mov_b32 v25,0
v_mov_b32 v20,v16
v_and_b32 v22,1,v4
v_lshrrev_b32 v23,1,v4
v_lshl_add_u32 v23,v23,4,v3
v_lshlrev_b32 v23,4,v23
v_lshl_add_u32 v23,v22,10,v23
s_lshr_b32 s64,s50,1
s_lshl_b32 s64,s64,9
v_add_u32 v23,s64,v23
s_lshr_b32 s64,s57,2
s_add_u32 s65,s64,32
s_lshl_b32 s65,s65,14
s_and_b32 s68,s57,3
s_lshl_b32 s68,s68,11
s_add_u32 s65,s65,s68
s_add_u32 s65,s65,29360128
v_add_u32 v17,s65,v23
s_lshl_b32 s69,s57,11
s_add_u32 s69,s69,23330816
v_add_u32 v2,s69,v23
s_mov_b32 s81,0x3e0293ee
s_mov_b32 s84,0xff00ff
s_mov_b32 s85,0xff00ff
s_mov_b32 s86,0x33333333
s_mov_b32 s87,0x33333333
s_mov_b32 s62,0x10000
s_mov_b32 s79,-2
ds_write_b32 v21,v25
ds_write_b32 v21,v25 offset:4
ds_write_b32 v21,v25 offset:8
ds_write_b32 v21,v25 offset:12
ds_write_b32 v21,v25 offset:16
ds_write_b32 v21,v25 offset:24
ds_write_b32 v21,v25 offset:28
v_mov_b32 v100,0
v_mov_b32 v101,0
v_mov_b32 v102,0
v_mov_b32 v103,0
s_lshr_b32 s64,s59,3
s_lshl_b32 s64,s64,14
s_and_b32 s65,s59,7
s_lshl_b32 s65,s65,10
s_add_u32 s64,s64,s65
s_lshl_b32 s65,s58,16
s_add_u32 s64,s64,s65
s_add_u32 s64,s64,31195136
v_add_u32 v8,s64,v16
s_cmp_eq_u32 s50,3
s_cbranch_scc1 w3_61
s_cmp_eq_u32 s50,1
s_cbranch_scc1 w1_59
s_cmp_eq_u32 s50,2
s_cbranch_scc1 w2_60
w0_58:
v_and_b32 v22,7,v3
v_lshrrev_b32 v23,2,v22
v_and_b32 v5,2,v22
v_or_b32 v23,v23,v5
v_and_b32 v5,1,v22
v_lshl_add_u32 v23,v23,1,v5
v_lshlrev_b32 v23,5,v23
v_lshrrev_b32 v5,3,v3
v_lshl_add_u32 v23,v5,9,v23
v_lshrrev_b32 v5,1,v4
v_lshl_add_u32 v23,v5,8,v23
v_and_b32 v5,1,v4
v_lshl_add_u32 v23,v5,4,v23
v_add_u32 v8,s67,v23
v_xor_b32 v9,1024,v8
v_xor_b32 v10,2048,v8
v_xor_b32 v11,3072,v8
v_lshlrev_b32 v31,4,v3
v_lshl_add_u32 v31,v5,3,v31
v_add_u32 v31,155648,v31
v_lshl_add_u32 v23,v4,3,v22
v_lshlrev_b32 v23,4,v23
v_add_u32 v12,155648,v23
v_add_u32 v30,s66,v23
v_cmp_gt_u32 vcc,8,v3
v_cmp_lt_u32 s[52:53],1,v4
s_and_b64 vcc,vcc,s[52:53]
v_mov_b32 v22,0xf149f2ca
v_cndmask_b32 v156,v22,0,vcc
v_mov_b32 v157,v156
v_mov_b32 v158,v156
v_mov_b32 v159,v156
v_add_u32 v2,s69,v16
v_xor_b32 v5,2048,v2
v_xor_b32 v6,4096,v2
v_xor_b32 v7,6144,v2
s_lshr_b32 s64,s57,3
s_add_u32 s64,s64,96
s_lshl_b32 s64,s64,14
s_and_b32 s65,s57,7
s_lshl_b32 s65,s65,10
s_add_u32 s64,s64,s65
s_add_u32 s64,s64,29360128
v_add_u32 v3,s64,v16
v_mov_b32 v136,0
v_mov_b32 v137,0
v_mov_b32 v138,0
v_mov_b32 v139,0
v_mov_b32 v140,0
v_mov_b32 v141,0
v_mov_b32 v142,0
v_mov_b32 v143,0
v_mov_b32 v144,0
v_mov_b32 v145,0
v_mov_b32 v146,0
v_mov_b32 v147,0
v_mov_b32 v152,0x3f803f80
v_mov_b32 v153,0x3f803f80
v_mov_b32 v154,0x3f803f80
v_mov_b32 v155,0x3f803f80
s_branch first_62
loop_63:
s_barrier
buffer_load_dword v248,v18,s[20:23],s70 offen offset:0 sc1
s_nop 15
s_nop 5
hl_65:
buffer_load_dword v249,v18,s[20:23],s70 offen offset:0 sc1
s_waitcnt vmcnt(1)
v_cmp_eq_u32 vcc,v25,v248
s_bcnt1_i32_b32 s64,vcc_lo
s_cmp_ge_u32 s64,8
s_cbranch_scc1 hg_66
buffer_load_dword v248,v18,s[20:23],s70 offen offset:0 sc1
s_waitcnt vmcnt(1)
v_cmp_eq_u32 vcc,v25,v249
s_bcnt1_i32_b32 s64,vcc_lo
s_cmp_ge_u32 s64,8
s_cbranch_scc1 hg_66
s_sub_u32 s90,s90,1
s_cmp_gt_i32 s90,0
s_cbranch_scc1 hl_65
hg_66:
buffer_load_dwordx4 v[32:35],v26,s[20:23],s70 offen offset:0 sc1
buffer_load_dwordx4 v[36:39],v26,s[20:23],s70 offen offset:1024 sc1
buffer_load_dwordx4 v[40:43],v26,s[20:23],s70 offen offset:2048 sc1
buffer_load_dwordx4 v[44:47],v26,s[20:23],s70 offen offset:3072 sc1
s_waitcnt vmcnt(3)
ds_write_b128 v24,v[32:35] offset:0
v_min3_u32 v22,v32,v33,v34
v_min_u32 v22,v22,v35
s_waitcnt vmcnt(2)
ds_write_b128 v24,v[36:39] offset:1024
v_min3_u32 v22,v22,v36,v37
v_min3_u32 v22,v22,v38,v39
s_waitcnt vmcnt(1)
ds_write_b128 v24,v[40:43] offset:2048
v_min3_u32 v22,v22,v40,v41
v_min3_u32 v22,v22,v42,v43
s_waitcnt vmcnt(0)
ds_write_b128 v24,v[44:47] offset:3072
v_min3_u32 v22,v22,v44,v45
v_min3_u32 v22,v22,v46,v47
v_cmp_eq_u32 vcc,0,v22
s_cbranch_vccnz art_67
abk_68:
v_smfmac_f32_16x16x64_bf16 v[176:179],v[32:35],a[0:7],v14
s_waitcnt lgkmcnt(0)
s_barrier
ds_read_b128 v[48:51],v24 offset:4096
ds_read_b128 v[52:55],v24 offset:5120
ds_read_b128 v[56:59],v24 offset:6144
ds_read_b128 v[60:63],v24 offset:7168
v_smfmac_f32_16x16x64_bf16 v[176:179],v[36:39],a[8:15],v14
ds_read_b128 v[64:67],v24 offset:8192
ds_read_b128 v[68:71],v24 offset:9216
v_smfmac_f32_16x16x64_bf16 v[176:179],v[40:43],a[16:23],v14
ds_read_b128 v[72:75],v24 offset:10240
ds_read_b128 v[76:79],v24 offset:11264
v_smfmac_f32_16x16x64_bf16 v[176:179],v[44:47],a[24:31],v14
ds_read_b128 v[80:83],v24 offset:12288
ds_read_b128 v[84:87],v24 offset:13312
s_waitcnt lgkmcnt(9)
v_smfmac_f32_16x16x64_bf16 v[176:179],v[48:51],a[32:39],v14
ds_read_b128 v[88:91],v24 offset:14336
s_waitcnt lgkmcnt(9)
v_smfmac_f32_16x16x64_bf16 v[176:179],v[52:55],a[40:47],v14
ds_read_b128 v[92:95],v24 offset:15360
s_waitcnt lgkmcnt(9)
v_smfmac_f32_16x16x64_bf16 v[176:179],v[56:59],a[48:55],v14
s_waitcnt lgkmcnt(8)
v_smfmac_f32_16x16x64_bf16 v[176:179],v[60:63],a[56:63],v14
s_waitcnt lgkmcnt(7)
v_smfmac_f32_16x16x64_bf16 v[176:179],v[64:67],a[64:71],v14
s_waitcnt lgkmcnt(6)
v_smfmac_f32_16x16x64_bf16 v[176:179],v[68:71],a[72:79],v14
s_waitcnt lgkmcnt(5)
v_smfmac_f32_16x16x64_bf16 v[176:179],v[72:75],a[80:87],v14
s_waitcnt lgkmcnt(4)
v_smfmac_f32_16x16x64_bf16 v[176:179],v[76:79],a[88:95],v14
s_waitcnt lgkmcnt(3)
v_smfmac_f32_16x16x64_bf16 v[176:179],v[80:83],a[96:103],v14
s_waitcnt lgkmcnt(2)
v_smfmac_f32_16x16x64_bf16 v[176:179],v[84:87],a[104:111],v14
s_waitcnt lgkmcnt(1)
v_smfmac_f32_16x16x64_bf16 v[176:179],v[88:91],a[112:119],v14
s_waitcnt lgkmcnt(0)
v_smfmac_f32_16x16x64_bf16 v[176:179],v[92:95],a[120:127],v14
s_nop 7
v_permlane32_swap_b32 v176,v178
v_permlane32_swap_b32 v177,v179
v_add_f32 v176,v176,v178
v_add_f32 v177,v177,v179
v_cvt_pk_bf16_f32 v216,v176,v177
s_nop 1
v_mov_b32_dpp v217,v216 quad_perm:[1,0,3,2] row_mask:0xf bank_mask:0xf
v_perm_b32 v216,v217,v216,v15
v_max_u32 v216,1,v216
buffer_store_dword v216,v19,s[24:27],s70 offen
buffer_store_dword v216,v19,s[28:31],s70 offen sc1
s_lshr_b32 s64,s70,9
v_add_u32 v22,s64,v24
s_cmp_eq_u32 s79,0
ds_read_b128 v[128:131],v22 offset:16384
ds_read_b128 v[132:135],v22 offset:17408
s_cbranch_scc1 kt0_69
kt0b_70:
s_nop 15
s_nop 15
s_nop 11
buffer_load_dwordx4 v[32:35],v8,s[20:23],s70 offen sc1
buffer_load_dwordx4 v[36:39],v9,s[20:23],s70 offen sc1
buffer_load_dwordx4 v[40:43],v10,s[20:23],s70 offen sc1
buffer_load_dwordx4 v[44:47],v11,s[20:23],s70 offen sc1
s_nop 9
scp_71:
buffer_load_dwordx4 v[48:51],v8,s[20:23],s70 offen sc1
buffer_load_dwordx4 v[52:55],v9,s[20:23],s70 offen sc1
buffer_load_dwordx4 v[56:59],v10,s[20:23],s70 offen sc1
buffer_load_dwordx4 v[60:63],v11,s[20:23],s70 offen sc1
s_waitcnt vmcnt(4)
v_mfma_f32_16x16x32_bf16 v[168:171],v[32:35],v[32:35],v[156:159]
v_min3_u32 v22,v32,v33,v34
v_min3_u32 v22,v22,v35,v36
v_mfma_f32_16x16x32_bf16 v[164:167],v[100:103],v[32:35],0
v_min3_u32 v22,v22,v37,v38
v_min3_u32 v22,v22,v39,v40
v_mfma_f32_16x16x32_bf16 v[160:163],v[96:99],v[32:35],0
v_min3_u32 v22,v22,v41,v42
v_min3_u32 v22,v22,v43,v44
v_mfma_f32_16x16x32_bf16 v[168:171],v[36:39],v[36:39],v[168:171]
v_min3_u32 v22,v22,v45,v46
v_min_u32 v22,v22,v47
v_mfma_f32_16x16x32_bf16 v[164:167],v[108:111],v[36:39],v[164:167]
v_cmp_eq_u32 vcc,0,v22
s_cbranch_vccnz nx_73
v_mfma_f32_16x16x32_bf16 v[160:163],v[104:107],v[36:39],v[160:163]
v_mov_b32 v172,v32
v_mfma_f32_16x16x32_bf16 v[168:171],v[40:43],v[40:43],v[168:171]
v_mov_b32 v173,v33
v_mfma_f32_16x16x32_bf16 v[164:167],v[116:119],v[40:43],v[164:167]
v_mov_b32 v174,v34
v_mfma_f32_16x16x32_bf16 v[160:163],v[112:115],v[40:43],v[160:163]
v_mov_b32 v175,v35
v_mfma_f32_16x16x32_bf16 v[168:171],v[44:47],v[44:47],v[168:171]
v_mfma_f32_16x16x32_bf16 v[164:167],v[124:127],v[44:47],v[164:167]
v_mfma_f32_16x16x32_bf16 v[160:163],v[120:123],v[44:47],v[160:163]
s_nop 1
s_branch scok_72
nx_73:
buffer_load_dwordx4 v[32:35],v8,s[20:23],s70 offen sc1
buffer_load_dwordx4 v[36:39],v9,s[20:23],s70 offen sc1
buffer_load_dwordx4 v[40:43],v10,s[20:23],s70 offen sc1
buffer_load_dwordx4 v[44:47],v11,s[20:23],s70 offen sc1
s_waitcnt vmcnt(4)
v_mfma_f32_16x16x32_bf16 v[168:171],v[48:51],v[48:51],v[156:159]
v_min3_u32 v22,v48,v49,v50
v_min3_u32 v22,v22,v51,v52
v_mfma_f32_16x16x32_bf16 v[164:167],v[100:103],v[48:51],0
v_min3_u32 v22,v22,v53,v54
v_min3_u32 v22,v22,v55,v56
v_mfma_f32_16x16x32_bf16 v[160:163],v[96:99],v[48:51],0
v_min3_u32 v22,v22,v57,v58
v_min3_u32 v22,v22,v59,v60
v_mfma_f32_16x16x32_bf16 v[168:171],v[52:55],v[52:55],v[168:171]
v_min3_u32 v22,v22,v61,v62
v_min_u32 v22,v22,v63
v_mfma_f32_16x16x32_bf16 v[164:167],v[108:111],v[52:55],v[164:167]
v_cmp_eq_u32 vcc,0,v22
s_cbranch_vccnz nx_74
v_mfma_f32_16x16x32_bf16 v[160:163],v[104:107],v[52:55],v[160:163]
v_mov_b32 v172,v48
v_mfma_f32_16x16x32_bf16 v[168:171],v[56:59],v[56:59],v[168:171]
v_mov_b32 v173,v49
v_mfma_f32_16x16x32_bf16 v[164:167],v[116:119],v[56:59],v[164:167]
v_mov_b32 v174,v50
v_mfma_f32_16x16x32_bf16 v[160:163],v[112:115],v[56:59],v[160:163]
v_mov_b32 v175,v51
v_mfma_f32_16x16x32_bf16 v[168:171],v[60:63],v[60:63],v[168:171]
v_mfma_f32_16x16x32_bf16 v[164:167],v[124:127],v[60:63],v[164:167]
v_mfma_f32_16x16x32_bf16 v[160:163],v[120:123],v[60:63],v[160:163]
s_nop 1
s_branch scok_72
nx_74:
s_sub_u32 s90,s90,1
s_cmp_gt_i32 s90,0
s_cbranch_scc1 scp_71
s_nop 7
scok_72:
ds_read_b64 v[220:221],v21
ds_read_b64 v[136:137],v31
ds_read_b64 v[140:141],v31 offset:256
s_cmp_ge_u32 s79,62
s_cbranch_scc1 ke_76
keb_77:
v_max3_f32 v216,v168,v169,v170
v_mov_b32_dpp v160,v164 row_ror:8 row_mask:0xf bank_mask:0xc
v_mov_b32_dpp v161,v165 row_ror:8 row_mask:0xf bank_mask:0xc
v_mov_b32_dpp v162,v166 row_ror:8 row_mask:0xf bank_mask:0xc
v_mov_b32_dpp v163,v167 row_ror:8 row_mask:0xf bank_mask:0xc
v_max3_f32 v217,v171,v160,v161
v_max3_f32 v216,v216,v162,v163
v_max_f32 v216,v216,v217
s_nop 1
v_max_f32_dpp v216,v216,v216 row_ror:8 row_mask:0xf bank_mask:0xf
v_mov_b32 v217,v216
s_nop 1
v_permlane16_swap_b32 v217,v216
v_max_f32 v216,v216,v217
v_mov_b32 v217,v216
s_nop 1
v_permlane32_swap_b32 v217,v216
v_max_f32 v216,v216,v217
v_mul_f32 v216,s81,v216
v_fma_f32 v160,v160,s81,-v216
v_fma_f32 v161,v161,s81,-v216
v_fma_f32 v162,v162,s81,-v216
v_fma_f32 v163,v163,s81,-v216
v_fma_f32 v168,v168,s81,-v216
v_fma_f32 v169,v169,s81,-v216
v_fma_f32 v170,v170,s81,-v216
v_fma_f32 v171,v171,s81,-v216
v_exp_f32 v160,v160
v_exp_f32 v161,v161
v_exp_f32 v162,v162
v_exp_f32 v163,v163
v_exp_f32 v168,v168
v_exp_f32 v169,v169
v_exp_f32 v170,v170
v_exp_f32 v171,v171
v_cvt_pk_bf16_f32 v148,v160,v161
v_cvt_pk_bf16_f32 v149,v162,v163
v_cvt_pk_bf16_f32 v144,v168,v169
v_mov_b32_dpp v150,v148 row_ror:8 row_mask:0xf bank_mask:0xf
v_mov_b32_dpp v151,v149 row_ror:8 row_mask:0xf bank_mask:0xf
v_cvt_pk_bf16_f32 v145,v170,v171
s_waitcnt lgkmcnt(0)
v_min_u32 v220,v220,v221
v_mfma_f32_16x16x32_bf16 v[232:235],v[152:155],v[148:151],0
v_cmp_ne_u32 vcc,v220,v25
v_mfma_f32_16x16x32_bf16 v[232:235],v[152:155],v[144:147],v[232:235]
v_mfma_f32_16x16x32_bf16 v[224:227],v[128:131],v[148:151],0
v_mfma_f32_16x16x32_bf16 v[228:231],v[132:135],v[148:151],0
s_cbranch_vccnz vw_78
vb_79:
v_mfma_f32_16x16x32_bf16 v[224:227],v[136:139],v[144:147],v[224:227]
v_mfma_f32_16x16x32_bf16 v[228:231],v[140:143],v[144:147],v[228:231]
s_mov_b64 exec,s[84:85]
s_nop 1
v_rcp_f32 v236,v232
s_nop 2
v_pk_mul_f32 v[224:225],v[224:225],v[236:237] op_sel_hi:[1,0]
v_pk_mul_f32 v[226:227],v[226:227],v[236:237] op_sel_hi:[1,0]
v_pk_mul_f32 v[228:229],v[228:229],v[236:237] op_sel_hi:[1,0]
v_pk_mul_f32 v[230:231],v[230:231],v[236:237] op_sel_hi:[1,0]
v_cvt_pk_bf16_f32 v216,v224,v225
v_cvt_pk_bf16_f32 v217,v226,v227
v_cvt_pk_bf16_f32 v218,v228,v229
v_cvt_pk_bf16_f32 v219,v230,v231
v_max_u32 v216,1,v216
v_max_u32 v217,1,v217
v_max_u32 v218,1,v218
v_max_u32 v219,1,v219
buffer_store_dwordx4 v[216:219],v30,s[24:27],s71 offen
buffer_store_dwordx4 v[216:219],v30,s[28:31],s71 offen sc1
s_mov_b64 exec,1
buffer_store_dword v25,v13,s[24:27],s70 offen offset:512
buffer_store_dword v25,v13,s[28:31],s70 offen offset:512 sc1
s_mov_b64 exec,-1
ds_write_b32 v21,v25 offset:8
hl_80:
buffer_load_dword v248,v18,s[20:23],s70 offen offset:512 sc1
s_waitcnt vmcnt(0)
v_cmp_eq_u32 vcc,v25,v248
s_bcnt1_i32_b32 s64,vcc_lo
s_cmp_ge_u32 s64,16
s_cbranch_scc1 hg_81
s_sub_u32 s90,s90,1
s_cmp_gt_i32 s90,0
s_cbranch_scc1 hl_80
hg_81:
buffer_load_dwordx4 v[32:35],v26,s[20:23],s71 offen offset:0 sc1
buffer_load_dwordx4 v[36:39],v26,s[20:23],s71 offen offset:1024 sc1
buffer_load_dwordx4 v[40:43],v26,s[20:23],s71 offen offset:2048 sc1
buffer_load_dwordx4 v[44:47],v26,s[20:23],s71 offen offset:3072 sc1
buffer_load_dwordx4 v[48:51],v27,s[20:23],s71 offen offset:0 sc1
buffer_load_dwordx4 v[52:55],v27,s[20:23],s71 offen offset:1024 sc1
buffer_load_dwordx4 v[56:59],v27,s[20:23],s71 offen offset:2048 sc1
buffer_load_dwordx4 v[60:63],v27,s[20:23],s71 offen offset:3072 sc1
s_mov_b32 s68,0
s_waitcnt vmcnt(6)
v_smfmac_f32_16x16x64_bf16 v[184:187],v[32:35],a[128:135],v14
v_min3_u32 v22,v32,v33,v34
v_min3_u32 v22,v22,v35,v36
v_smfmac_f32_16x16x64_bf16 v[188:191],v[32:35],a[136:143],v14
v_min3_u32 v22,v22,v37,v38
v_smfmac_f32_16x16x64_bf16 v[184:187],v[36:39],a[144:151],v14
v_min_u32 v22,v22,v39
v_smfmac_f32_16x16x64_bf16 v[188:191],v[36:39],a[152:159],v14
v_cmp_eq_u32 s[52:53],0,v22
s_waitcnt vmcnt(4)
v_smfmac_f32_16x16x64_bf16 v[184:187],v[40:43],a[160:167],v14
v_min3_u32 v22,v40,v41,v42
s_cmp_lg_u64 s[52:53],0
v_smfmac_f32_16x16x64_bf16 v[188:191],v[40:43],a[168:175],v14
s_cbranch_scc1 ms_82
bk_83:
v_min3_u32 v22,v22,v43,v44
v_smfmac_f32_16x16x64_bf16 v[184:187],v[44:47],a[176:183],v14
v_min3_u32 v22,v22,v45,v46
v_min_u32 v22,v22,v47
v_smfmac_f32_16x16x64_bf16 v[188:191],v[44:47],a[184:191],v14
v_cmp_eq_u32 s[54:55],0,v22
s_waitcnt vmcnt(2)
v_smfmac_f32_16x16x64_bf16 v[184:187],v[48:51],a[192:199],v14
v_min3_u32 v22,v48,v49,v50
s_cmp_lg_u64 s[54:55],0
v_smfmac_f32_16x16x64_bf16 v[188:191],v[48:51],a[200:207],v14
s_cbranch_scc1 ms_84
bk_85:
v_min3_u32 v22,v22,v51,v52
v_smfmac_f32_16x16x64_bf16 v[184:187],v[52:55],a[208:215],v14
v_min3_u32 v22,v22,v53,v54
v_min_u32 v22,v22,v55
v_smfmac_f32_16x16x64_bf16 v[188:191],v[52:55],a[216:223],v14
v_cmp_eq_u32 s[52:53],0,v22
s_waitcnt vmcnt(0)
v_smfmac_f32_16x16x64_bf16 v[184:187],v[56:59],a[224:231],v14
v_min3_u32 v22,v56,v57,v58
s_cmp_lg_u64 s[52:53],0
v_smfmac_f32_16x16x64_bf16 v[188:191],v[56:59],a[232:239],v14
s_cbranch_scc1 ms_86
bk_87:
v_min3_u32 v22,v22,v59,v60
v_smfmac_f32_16x16x64_bf16 v[184:187],v[60:63],a[240:247],v14
v_min3_u32 v22,v22,v61,v62
v_min_u32 v22,v22,v63
v_smfmac_f32_16x16x64_bf16 v[188:191],v[60:63],a[248:255],v14
v_cmp_eq_u32 s[54:55],0,v22
s_cmp_lg_u64 s[54:55],0
s_cbranch_scc1 ms_90
bk_91:
s_cmp_lg_u32 s68,0
s_cbranch_scc1 rl2_92
fin_88:
s_nop 2
v_permlane32_swap_b32 v184,v188
v_permlane32_swap_b32 v185,v189
v_permlane32_swap_b32 v186,v190
v_permlane32_swap_b32 v187,v191
v_pk_add_f32 v[184:185],v[184:185],v[188:189]
v_pk_add_f32 v[186:187],v[186:187],v[190:191]
ds_write_b128 v24,v[184:187] offset:25600
ds_write_b32 v21,v25 offset:12
s_mov_b64 exec,s[84:85]
ds_read_b128 v[172:175],v12
s_mov_b64 exec,-1
ds_read_b64 v[220:221],v21 offset:24
buffer_load_dwordx4 v[96:99],v2,s[20:23],s72 offen offset:0 sc1
buffer_load_dwordx4 v[100:103],v2,s[20:23],s72 offen offset:1024 sc1
buffer_load_dwordx4 v[104:107],v5,s[20:23],s72 offen offset:0 sc1
buffer_load_dwordx4 v[108:111],v5,s[20:23],s72 offen offset:1024 sc1
buffer_load_dwordx4 v[112:115],v6,s[20:23],s72 offen offset:0 sc1
buffer_load_dwordx4 v[116:119],v6,s[20:23],s72 offen offset:1024 sc1
buffer_load_dwordx4 v[120:123],v7,s[20:23],s72 offen offset:0 sc1
buffer_load_dwordx4 v[124:127],v7,s[20:23],s72 offen offset:1024 sc1
s_waitcnt lgkmcnt(0)
v_min_u32 v220,v220,v221
v_cmp_ne_u32 vcc,v220,v25
s_cbranch_vccnz v2w_93
v2b_94:
buffer_store_dwordx4 v[172:175],v3,s[20:23],s77 offen sc1
s_xor_b32 s62,s62,0x10000
s_add_u32 s63,s79,1
s_and_b32 s64,s63,3
s_lshl_b32 s70,s64,20
s_add_u32 s65,s63,2
s_and_b32 s65,s65,3
s_lshl_b32 s73,s65,20
s_add_u32 s55,s63,3
s_lshl_b32 s78,s55,16
s_add_u32 s78,s78,57344
s_cmp_lt_u32 s55,64
s_cselect_b32 s78,s78,0x7fff0000
s_add_u32 s71,s70,65536
s_add_u32 s60,s63,1
s_and_b32 s60,s60,3
s_lshl_b32 s72,s60,20
v_mov_b32 v184,0
v_mov_b32 v185,0
v_mov_b32 v186,0
v_mov_b32 v187,0
v_mov_b32 v188,0
v_mov_b32 v189,0
v_mov_b32 v190,0
v_mov_b32 v191,0
s_lshl_b32 s77,s63,21
s_lshl_b32 s55,s63,13
s_and_b32 s55,s55,0x2000
s_xor_b32 s55,s55,s61
s_add_u32 s77,s77,s55
v_mov_b32 v176,0
v_mov_b32 v177,0
v_mov_b32 v178,0
v_mov_b32 v179,0
s_add_u32 s79,s79,1
v_add_u32 v25,1,v25
s_waitcnt vmcnt(0) lgkmcnt(0)
s_branch loop_63
last0_75:
wf_95:
ds_read_b32 v23,v21 offset:0
s_sub_u32 s90,s90,1
s_waitcnt lgkmcnt(0)
v_cmp_ne_u32 vcc,v23,v25
s_cmp_lt_i32 s90,0
s_cselect_b64 vcc,0,vcc
s_cbranch_vccnz wf_95
wf_96:
ds_read_b32 v23,v21 offset:4
s_sub_u32 s90,s90,1
s_waitcnt lgkmcnt(0)
v_cmp_ne_u32 vcc,v23,v25
s_cmp_lt_i32 s90,0
s_cselect_b64 vcc,0,vcc
s_cbranch_vccnz wf_96
s_mov_b64 exec,s[84:85]
ds_read_b128 v[172:175],v12
s_mov_b64 exec,-1
s_waitcnt lgkmcnt(0)
buffer_store_dwordx4 v[172:175],v3,s[20:23],s77 offen sc1
s_branch end_57
art_67:
s_sub_u32 s90,s90,1
s_cmp_lt_i32 s90,0
s_cbranch_scc1 abk_68
buffer_load_dwordx4 v[32:35],v26,s[20:23],s70 offen offset:0 sc1
buffer_load_dwordx4 v[36:39],v26,s[20:23],s70 offen offset:1024 sc1
buffer_load_dwordx4 v[40:43],v26,s[20:23],s70 offen offset:2048 sc1
buffer_load_dwordx4 v[44:47],v26,s[20:23],s70 offen offset:3072 sc1
s_waitcnt vmcnt(3)
ds_write_b128 v24,v[32:35] offset:0
v_min3_u32 v22,v32,v33,v34
v_min_u32 v22,v22,v35
s_waitcnt vmcnt(2)
ds_write_b128 v24,v[36:39] offset:1024
v_min3_u32 v22,v22,v36,v37
v_min3_u32 v22,v22,v38,v39
s_waitcnt vmcnt(1)
ds_write_b128 v24,v[40:43] offset:2048
v_min3_u32 v22,v22,v40,v41
v_min3_u32 v22,v22,v42,v43
s_waitcnt vmcnt(0)
ds_write_b128 v24,v[44:47] offset:3072
v_min3_u32 v22,v22,v44,v45
v_min3_u32 v22,v22,v46,v47
v_cmp_eq_u32 vcc,0,v22
s_cbranch_vccnz art_67
s_branch abk_68
kt0_69:
buffer_load_dwordx4 v[96:99],v2,s[20:23],s70 offen offset:0 sc1
buffer_load_dwordx4 v[100:103],v2,s[20:23],s70 offen offset:1024 sc1
buffer_load_dwordx4 v[104:107],v5,s[20:23],s70 offen offset:0 sc1
buffer_load_dwordx4 v[108:111],v5,s[20:23],s70 offen offset:1024 sc1
buffer_load_dwordx4 v[112:115],v6,s[20:23],s70 offen offset:0 sc1
buffer_load_dwordx4 v[116:119],v6,s[20:23],s70 offen offset:1024 sc1
buffer_load_dwordx4 v[120:123],v7,s[20:23],s70 offen offset:0 sc1
buffer_load_dwordx4 v[124:127],v7,s[20:23],s70 offen offset:1024 sc1
s_branch kt0b_70
ke_76:
s_cmp_eq_u32 s79,63
s_cbranch_scc1 last0_75
ds_read_b64 v[222:223],v21 offset:24
s_mov_b64 exec,s[84:85]
ds_read_b128 v[172:175],v12
s_mov_b64 exec,-1
s_waitcnt lgkmcnt(0)
v_min3_u32 v222,v222,v223,v220
v_min_u32 v222,v222,v221
v_cmp_ne_u32 vcc,v222,v25
s_cbranch_vccnz keb_77
buffer_store_dwordx4 v[172:175],v3,s[20:23],s77 offen sc1
s_mov_b32 s77,0x7fff0000
s_branch keb_77
vw_78:
wf_97:
ds_read_b32 v23,v21 offset:0
s_sub_u32 s90,s90,1
s_waitcnt lgkmcnt(0)
v_cmp_ne_u32 vcc,v23,v25
s_cmp_lt_i32 s90,0
s_cselect_b64 vcc,0,vcc
s_cbranch_vccnz wf_97
wf_98:
ds_read_b32 v23,v21 offset:4
s_sub_u32 s90,s90,1
s_waitcnt lgkmcnt(0)
v_cmp_ne_u32 vcc,v23,v25
s_cmp_lt_i32 s90,0
s_cselect_b64 vcc,0,vcc
s_cbranch_vccnz wf_98
ds_read_b64 v[220:221],v21
ds_read_b64 v[136:137],v31
ds_read_b64 v[140:141],v31 offset:256
s_waitcnt lgkmcnt(0)
s_branch vb_79
ms_82:
s_waitcnt vmcnt(0)
buffer_load_dwordx4 v[64:67],v26,s[20:23],s71 offen offset:0 sc1
buffer_load_dwordx4 v[68:71],v26,s[20:23],s71 offen offset:1024 sc1
s_bitset1_b32 s68,0
s_branch bk_83
ms_84:
s_waitcnt vmcnt(0)
buffer_load_dwordx4 v[72:75],v26,s[20:23],s71 offen offset:2048 sc1
buffer_load_dwordx4 v[76:79],v26,s[20:23],s71 offen offset:3072 sc1
s_bitset1_b32 s68,1
s_branch bk_85
ms_86:
s_waitcnt vmcnt(0)
buffer_load_dwordx4 v[80:83],v27,s[20:23],s71 offen offset:0 sc1
buffer_load_dwordx4 v[84:87],v27,s[20:23],s71 offen offset:1024 sc1
s_bitset1_b32 s68,2
s_branch bk_87
ms_90:
s_waitcnt vmcnt(0)
buffer_load_dwordx4 v[88:91],v27,s[20:23],s71 offen offset:2048 sc1
buffer_load_dwordx4 v[92:95],v27,s[20:23],s71 offen offset:3072 sc1
s_bitset1_b32 s68,3
s_branch bk_91
rl_89:
s_bitcmp1_b32 s68,0
s_cbranch_scc0 sk_99
buffer_load_dwordx4 v[64:67],v26,s[20:23],s71 offen offset:0 sc1
buffer_load_dwordx4 v[68:71],v26,s[20:23],s71 offen offset:1024 sc1
sk_99:
s_bitcmp1_b32 s68,1
s_cbranch_scc0 sk_100
buffer_load_dwordx4 v[72:75],v26,s[20:23],s71 offen offset:2048 sc1
buffer_load_dwordx4 v[76:79],v26,s[20:23],s71 offen offset:3072 sc1
sk_100:
s_bitcmp1_b32 s68,2
s_cbranch_scc0 sk_101
buffer_load_dwordx4 v[80:83],v27,s[20:23],s71 offen offset:0 sc1
buffer_load_dwordx4 v[84:87],v27,s[20:23],s71 offen offset:1024 sc1
sk_101:
s_bitcmp1_b32 s68,3
s_cbranch_scc0 sk_102
buffer_load_dwordx4 v[88:91],v27,s[20:23],s71 offen offset:2048 sc1
buffer_load_dwordx4 v[92:95],v27,s[20:23],s71 offen offset:3072 sc1
sk_102:
rl2_92:
s_sub_u32 s90,s90,1
s_cmp_lt_i32 s90,0
s_cbranch_scc1 fin_88
s_waitcnt vmcnt(0)
s_bitcmp1_b32 s68,0
s_cbranch_scc0 sk_103
v_min3_u32 v22,v64,v65,v66
v_min3_u32 v22,v22,v67,v68
v_min3_u32 v22,v22,v69,v70
v_min_u32 v22,v22,v71
v_cmp_eq_u32 vcc,0,v22
v_xor_b32 v64,v32,v64
v_xor_b32 v65,v33,v65
v_xor_b32 v66,v34,v66
v_xor_b32 v67,v35,v67
v_xor_b32 v68,v36,v68
v_xor_b32 v69,v37,v69
v_xor_b32 v70,v38,v70
v_xor_b32 v71,v39,v71
s_cbranch_vccnz nb_104
s_bitset0_b32 s68,0
v_smfmac_f32_16x16x64_bf16 v[184:187],v[64:67],a[128:135],v14
v_smfmac_f32_16x16x64_bf16 v[188:191],v[64:67],a[136:143],v14
v_smfmac_f32_16x16x64_bf16 v[184:187],v[68:71],a[144:151],v14
v_smfmac_f32_16x16x64_bf16 v[188:191],v[68:71],a[152:159],v14
nb_104:
sk_103:
s_bitcmp1_b32 s68,1
s_cbranch_scc0 sk_105
v_min3_u32 v22,v72,v73,v74
v_min3_u32 v22,v22,v75,v76
v_min3_u32 v22,v22,v77,v78
v_min_u32 v22,v22,v79
v_cmp_eq_u32 vcc,0,v22
v_xor_b32 v72,v40,v72
v_xor_b32 v73,v41,v73
v_xor_b32 v74,v42,v74
v_xor_b32 v75,v43,v75
v_xor_b32 v76,v44,v76
v_xor_b32 v77,v45,v77
v_xor_b32 v78,v46,v78
v_xor_b32 v79,v47,v79
s_cbranch_vccnz nb_106
s_bitset0_b32 s68,1
v_smfmac_f32_16x16x64_bf16 v[184:187],v[72:75],a[160:167],v14
v_smfmac_f32_16x16x64_bf16 v[188:191],v[72:75],a[168:175],v14
v_smfmac_f32_16x16x64_bf16 v[184:187],v[76:79],a[176:183],v14
v_smfmac_f32_16x16x64_bf16 v[188:191],v[76:79],a[184:191],v14
nb_106:
sk_105:
s_bitcmp1_b32 s68,2
s_cbranch_scc0 sk_107
v_min3_u32 v22,v80,v81,v82
v_min3_u32 v22,v22,v83,v84
v_min3_u32 v22,v22,v85,v86
v_min_u32 v22,v22,v87
v_cmp_eq_u32 vcc,0,v22
v_xor_b32 v80,v48,v80
v_xor_b32 v81,v49,v81
v_xor_b32 v82,v50,v82
v_xor_b32 v83,v51,v83
v_xor_b32 v84,v52,v84
v_xor_b32 v85,v53,v85
v_xor_b32 v86,v54,v86
v_xor_b32 v87,v55,v87
s_cbranch_vccnz nb_108
s_bitset0_b32 s68,2
v_smfmac_f32_16x16x64_bf16 v[184:187],v[80:83],a[192:199],v14
v_smfmac_f32_16x16x64_bf16 v[188:191],v[80:83],a[200:207],v14
v_smfmac_f32_16x16x64_bf16 v[184:187],v[84:87],a[208:215],v14
v_smfmac_f32_16x16x64_bf16 v[188:191],v[84:87],a[216:223],v14
nb_108:
sk_107:
s_bitcmp1_b32 s68,3
s_cbranch_scc0 sk_109
v_min3_u32 v22,v88,v89,v90
v_min3_u32 v22,v22,v91,v92
v_min3_u32 v22,v22,v93,v94
v_min_u32 v22,v22,v95
v_cmp_eq_u32 vcc,0,v22
v_xor_b32 v88,v56,v88
v_xor_b32 v89,v57,v89
v_xor_b32 v90,v58,v90
v_xor_b32 v91,v59,v91
v_xor_b32 v92,v60,v92
v_xor_b32 v93,v61,v93
v_xor_b32 v94,v62,v94
v_xor_b32 v95,v63,v95
s_cbranch_vccnz nb_110
s_bitset0_b32 s68,3
v_smfmac_f32_16x16x64_bf16 v[184:187],v[88:91],a[224:231],v14
v_smfmac_f32_16x16x64_bf16 v[188:191],v[88:91],a[232:239],v14
v_smfmac_f32_16x16x64_bf16 v[184:187],v[92:95],a[240:247],v14
v_smfmac_f32_16x16x64_bf16 v[188:191],v[92:95],a[248:255],v14
nb_110:
sk_109:
s_cmp_lg_u32 s68,0
s_cbranch_scc1 rl_89
s_nop 2
s_branch fin_88
v2w_93:
wf_111:
ds_read_b32 v23,v21 offset:24
s_sub_u32 s90,s90,1
s_waitcnt lgkmcnt(0)
v_cmp_ne_u32 vcc,v23,v25
s_cmp_lt_i32 s90,0
s_cselect_b64 vcc,0,vcc
s_cbranch_vccnz wf_111
wf_112:
ds_read_b32 v23,v21 offset:28
s_sub_u32 s90,s90,1
s_waitcnt lgkmcnt(0)
v_cmp_ne_u32 vcc,v23,v25
s_cmp_lt_i32 s90,0
s_cselect_b64 vcc,0,vcc
s_cbranch_vccnz wf_112
s_branch v2b_94
first_62:
s_waitcnt vmcnt(0) lgkmcnt(0)
s_barrier
s_add_u32 s64,s15,393216
buffer_load_dwordx4 a[176:179],v32,s[40:43],s64 offen nt
s_add_u32 s64,s15,425984
buffer_load_dwordx4 a[180:183],v32,s[40:43],s64 offen nt
s_add_u32 s64,s15,458752
buffer_load_dwordx4 a[184:187],v32,s[40:43],s64 offen nt
s_add_u32 s64,s15,491520
buffer_load_dwordx4 a[188:191],v32,s[40:43],s64 offen nt
s_add_u32 s64,s15,524288
buffer_load_dwordx4 a[192:195],v32,s[40:43],s64 offen nt
s_add_u32 s64,s15,557056
buffer_load_dwordx4 a[196:199],v32,s[40:43],s64 offen nt
s_add_u32 s64,s15,589824
buffer_load_dwordx4 a[200:203],v32,s[40:43],s64 offen nt
s_add_u32 s64,s15,622592
buffer_load_dwordx4 a[204:207],v32,s[40:43],s64 offen nt
s_add_u32 s64,s15,655360
buffer_load_dwordx4 a[208:211],v32,s[40:43],s64 offen nt
s_add_u32 s64,s15,688128
buffer_load_dwordx4 a[212:215],v32,s[40:43],s64 offen nt
s_add_u32 s64,s15,720896
buffer_load_dwordx4 a[216:219],v32,s[40:43],s64 offen nt
s_add_u32 s64,s15,753664
buffer_load_dwordx4 a[220:223],v32,s[40:43],s64 offen nt
s_add_u32 s64,s15,786432
buffer_load_dwordx4 a[224:227],v32,s[40:43],s64 offen nt
s_add_u32 s64,s15,819200
buffer_load_dwordx4 a[228:231],v32,s[40:43],s64 offen nt
s_add_u32 s64,s15,851968
buffer_load_dwordx4 a[232:235],v32,s[40:43],s64 offen nt
s_add_u32 s64,s15,884736
buffer_load_dwordx4 a[236:239],v32,s[40:43],s64 offen nt
s_add_u32 s64,s15,917504
buffer_load_dwordx4 a[240:243],v32,s[40:43],s64 offen nt
s_add_u32 s64,s15,950272
buffer_load_dwordx4 a[244:247],v32,s[40:43],s64 offen nt
s_add_u32 s64,s15,983040
buffer_load_dwordx4 a[248:251],v32,s[40:43],s64 offen nt
s_add_u32 s64,s15,1015808
buffer_load_dwordx4 a[252:255],v32,s[40:43],s64 offen nt
ds_write_b128 v33,a[0:3] offset:0
ds_write_b128 v33,a[4:7] offset:1024
ds_write_b128 v33,a[8:11] offset:2048
ds_write_b128 v33,a[12:15] offset:3072
s_waitcnt lgkmcnt(0)
v_mov_b32 v38,1
ds_write_b32 v37,v38 offset:0
qs_113:
ds_read_b32 v39,v37 offset:4
s_sub_u32 s90,s90,1
s_waitcnt lgkmcnt(0)
v_cmp_gt_u32 vcc,v38,v39
s_cmp_lt_i32 s90,0
s_cselect_b64 vcc,0,vcc
s_cbranch_vccnz qs_113
ds_read_b64_tr_b16 a[0:1],v36 offset:0
ds_read_b64_tr_b16 a[2:3],v36 offset:128
ds_read_b64_tr_b16 a[4:5],v36 offset:2048
ds_read_b64_tr_b16 a[6:7],v36 offset:2176
ds_read_b64_tr_b16 a[8:9],v36 offset:8192
ds_read_b64_tr_b16 a[10:11],v36 offset:8320
ds_read_b64_tr_b16 a[12:13],v36 offset:10240
ds_read_b64_tr_b16 a[14:15],v36 offset:10368
ds_write_b128 v33,a[16:19] offset:4096
ds_write_b128 v33,a[20:23] offset:5120
ds_write_b128 v33,a[24:27] offset:6144
ds_write_b128 v33,a[28:31] offset:7168
s_waitcnt lgkmcnt(0)
v_mov_b32 v38,2
ds_write_b32 v37,v38 offset:0
qs_114:
ds_read_b32 v39,v37 offset:4
s_sub_u32 s90,s90,1
s_waitcnt lgkmcnt(0)
v_cmp_gt_u32 vcc,v38,v39
s_cmp_lt_i32 s90,0
s_cselect_b64 vcc,0,vcc
s_cbranch_vccnz qs_114
ds_read_b64_tr_b16 a[16:17],v36 offset:4096
ds_read_b64_tr_b16 a[18:19],v36 offset:4224
ds_read_b64_tr_b16 a[20:21],v36 offset:6144
ds_read_b64_tr_b16 a[22:23],v36 offset:6272
ds_read_b64_tr_b16 a[24:25],v36 offset:12288
ds_read_b64_tr_b16 a[26:27],v36 offset:12416
ds_read_b64_tr_b16 a[28:29],v36 offset:14336
ds_read_b64_tr_b16 a[30:31],v36 offset:14464
ds_write_b128 v33,a[32:35] offset:0
ds_write_b128 v33,a[36:39] offset:1024
ds_write_b128 v33,a[40:43] offset:2048
ds_write_b128 v33,a[44:47] offset:3072
s_waitcnt lgkmcnt(0)
v_mov_b32 v38,3
ds_write_b32 v37,v38 offset:0
qs_115:
ds_read_b32 v39,v37 offset:4
s_sub_u32 s90,s90,1
s_waitcnt lgkmcnt(0)
v_cmp_gt_u32 vcc,v38,v39
s_cmp_lt_i32 s90,0
s_cselect_b64 vcc,0,vcc
s_cbranch_vccnz qs_115
ds_read_b64_tr_b16 a[32:33],v36 offset:0
ds_read_b64_tr_b16 a[34:35],v36 offset:128
ds_read_b64_tr_b16 a[36:37],v36 offset:2048
ds_read_b64_tr_b16 a[38:39],v36 offset:2176
ds_read_b64_tr_b16 a[40:41],v36 offset:8192
ds_read_b64_tr_b16 a[42:43],v36 offset:8320
ds_read_b64_tr_b16 a[44:45],v36 offset:10240
ds_read_b64_tr_b16 a[46:47],v36 offset:10368
ds_write_b128 v33,a[48:51] offset:4096
ds_write_b128 v33,a[52:55] offset:5120
ds_write_b128 v33,a[56:59] offset:6144
ds_write_b128 v33,a[60:63] offset:7168
s_waitcnt lgkmcnt(0)
v_mov_b32 v38,4
ds_write_b32 v37,v38 offset:0
qs_116:
ds_read_b32 v39,v37 offset:4
s_sub_u32 s90,s90,1
s_waitcnt lgkmcnt(0)
v_cmp_gt_u32 vcc,v38,v39
s_cmp_lt_i32 s90,0
s_cselect_b64 vcc,0,vcc
s_cbranch_vccnz qs_116
ds_read_b64_tr_b16 a[48:49],v36 offset:4096
ds_read_b64_tr_b16 a[50:51],v36 offset:4224
ds_read_b64_tr_b16 a[52:53],v36 offset:6144
ds_read_b64_tr_b16 a[54:55],v36 offset:6272
ds_read_b64_tr_b16 a[56:57],v36 offset:12288
ds_read_b64_tr_b16 a[58:59],v36 offset:12416
ds_read_b64_tr_b16 a[60:61],v36 offset:14336
ds_read_b64_tr_b16 a[62:63],v36 offset:14464
ds_write_b128 v33,a[64:67] offset:0
ds_write_b128 v33,a[68:71] offset:1024
ds_write_b128 v33,a[72:75] offset:2048
ds_write_b128 v33,a[76:79] offset:3072
s_waitcnt lgkmcnt(0)
v_mov_b32 v38,5
ds_write_b32 v37,v38 offset:0
qs_117:
ds_read_b32 v39,v37 offset:4
s_sub_u32 s90,s90,1
s_waitcnt lgkmcnt(0)
v_cmp_gt_u32 vcc,v38,v39
s_cmp_lt_i32 s90,0
s_cselect_b64 vcc,0,vcc
s_cbranch_vccnz qs_117
ds_read_b64_tr_b16 a[64:65],v36 offset:0
ds_read_b64_tr_b16 a[66:67],v36 offset:128
ds_read_b64_tr_b16 a[68:69],v36 offset:2048
ds_read_b64_tr_b16 a[70:71],v36 offset:2176
ds_read_b64_tr_b16 a[72:73],v36 offset:8192
ds_read_b64_tr_b16 a[74:75],v36 offset:8320
ds_read_b64_tr_b16 a[76:77],v36 offset:10240
ds_read_b64_tr_b16 a[78:79],v36 offset:10368
ds_write_b128 v33,a[80:83] offset:4096
ds_write_b128 v33,a[84:87] offset:5120
ds_write_b128 v33,a[88:91] offset:6144
ds_write_b128 v33,a[92:95] offset:7168
s_waitcnt lgkmcnt(0)
v_mov_b32 v38,6
ds_write_b32 v37,v38 offset:0
qs_118:
ds_read_b32 v39,v37 offset:4
s_sub_u32 s90,s90,1
s_waitcnt lgkmcnt(0)
v_cmp_gt_u32 vcc,v38,v39
s_cmp_lt_i32 s90,0
s_cselect_b64 vcc,0,vcc
s_cbranch_vccnz qs_118
ds_read_b64_tr_b16 a[80:81],v36 offset:4096
ds_read_b64_tr_b16 a[82:83],v36 offset:4224
ds_read_b64_tr_b16 a[84:85],v36 offset:6144
ds_read_b64_tr_b16 a[86:87],v36 offset:6272
ds_read_b64_tr_b16 a[88:89],v36 offset:12288
ds_read_b64_tr_b16 a[90:91],v36 offset:12416
ds_read_b64_tr_b16 a[92:93],v36 offset:14336
ds_read_b64_tr_b16 a[94:95],v36 offset:14464
ds_write_b128 v33,a[96:99] offset:0
ds_write_b128 v33,a[100:103] offset:1024
ds_write_b128 v33,a[104:107] offset:2048
ds_write_b128 v33,a[108:111] offset:3072
s_waitcnt lgkmcnt(0)
v_mov_b32 v38,7
ds_write_b32 v37,v38 offset:0
qs_119:
ds_read_b32 v39,v37 offset:4
s_sub_u32 s90,s90,1
s_waitcnt lgkmcnt(0)
v_cmp_gt_u32 vcc,v38,v39
s_cmp_lt_i32 s90,0
s_cselect_b64 vcc,0,vcc
s_cbranch_vccnz qs_119
ds_read_b64_tr_b16 a[96:97],v36 offset:0
ds_read_b64_tr_b16 a[98:99],v36 offset:128
ds_read_b64_tr_b16 a[100:101],v36 offset:2048
ds_read_b64_tr_b16 a[102:103],v36 offset:2176
ds_read_b64_tr_b16 a[104:105],v36 offset:8192
ds_read_b64_tr_b16 a[106:107],v36 offset:8320
ds_read_b64_tr_b16 a[108:109],v36 offset:10240
ds_read_b64_tr_b16 a[110:111],v36 offset:10368
ds_write_b128 v33,a[112:115] offset:4096
ds_write_b128 v33,a[116:119] offset:5120
ds_write_b128 v33,a[120:123] offset:6144
ds_write_b128 v33,a[124:127] offset:7168
s_waitcnt lgkmcnt(0)
v_mov_b32 v38,8
ds_write_b32 v37,v38 offset:0
qs_120:
ds_read_b32 v39,v37 offset:4
s_sub_u32 s90,s90,1
s_waitcnt lgkmcnt(0)
v_cmp_gt_u32 vcc,v38,v39
s_cmp_lt_i32 s90,0
s_cselect_b64 vcc,0,vcc
s_cbranch_vccnz qs_120
ds_read_b64_tr_b16 a[112:113],v36 offset:4096
ds_read_b64_tr_b16 a[114:115],v36 offset:4224
ds_read_b64_tr_b16 a[116:117],v36 offset:6144
ds_read_b64_tr_b16 a[118:119],v36 offset:6272
ds_read_b64_tr_b16 a[120:121],v36 offset:12288
ds_read_b64_tr_b16 a[122:123],v36 offset:12416
ds_read_b64_tr_b16 a[124:125],v36 offset:14336
ds_read_b64_tr_b16 a[126:127],v36 offset:14464
s_waitcnt lgkmcnt(0)
v_mov_b32 v38,9
ds_write_b32 v37,v38 offset:0
qs_121:
ds_read_b32 v39,v37 offset:4
s_sub_u32 s90,s90,1
s_waitcnt lgkmcnt(0)
v_cmp_gt_u32 vcc,v38,v39
s_cmp_lt_i32 s90,0
s_cselect_b64 vcc,0,vcc
s_cbranch_vccnz qs_121
ds_write_b128 v33,a[128:131] offset:0
ds_write_b128 v33,a[132:135] offset:1024
ds_write_b128 v33,a[136:139] offset:2048
ds_write_b128 v33,a[140:143] offset:3072
s_waitcnt lgkmcnt(0)
ds_read_b64_tr_b16 a[128:129],v34 offset:0
ds_read_b64_tr_b16 a[130:131],v34 offset:128
ds_read_b64_tr_b16 a[132:133],v34 offset:2048
ds_read_b64_tr_b16 a[134:135],v34 offset:2176
ds_read_b64_tr_b16 a[136:137],v34 offset:32
ds_read_b64_tr_b16 a[138:139],v34 offset:160
ds_read_b64_tr_b16 a[140:141],v34 offset:2080
ds_read_b64_tr_b16 a[142:143],v34 offset:2208
ds_write_b128 v33,a[144:147] offset:4096
ds_write_b128 v33,a[148:151] offset:5120
ds_write_b128 v33,a[152:155] offset:6144
ds_write_b128 v33,a[156:159] offset:7168
s_waitcnt lgkmcnt(0)
ds_read_b64_tr_b16 a[144:145],v34 offset:4096
ds_read_b64_tr_b16 a[146:147],v34 offset:4224
ds_read_b64_tr_b16 a[148:149],v34 offset:6144
ds_read_b64_tr_b16 a[150:151],v34 offset:6272
ds_read_b64_tr_b16 a[152:153],v34 offset:4128
ds_read_b64_tr_b16 a[154:155],v34 offset:4256
ds_read_b64_tr_b16 a[156:157],v34 offset:6176
ds_read_b64_tr_b16 a[158:159],v34 offset:6304
ds_write_b128 v33,a[160:163] offset:0
ds_write_b128 v33,a[164:167] offset:1024
ds_write_b128 v33,a[168:171] offset:2048
ds_write_b128 v33,a[172:175] offset:3072
s_waitcnt lgkmcnt(0)
ds_read_b64_tr_b16 a[160:161],v34 offset:0
ds_read_b64_tr_b16 a[162:163],v34 offset:128
ds_read_b64_tr_b16 a[164:165],v34 offset:2048
ds_read_b64_tr_b16 a[166:167],v34 offset:2176
ds_read_b64_tr_b16 a[168:169],v34 offset:32
ds_read_b64_tr_b16 a[170:171],v34 offset:160
ds_read_b64_tr_b16 a[172:173],v34 offset:2080
ds_read_b64_tr_b16 a[174:175],v34 offset:2208
free_122:
ds_read_b64 v[38:39],v37 offset:8
s_sub_u32 s90,s90,1
s_waitcnt lgkmcnt(0)
v_and_b32 v38,v38,v39
v_cmp_eq_u32 vcc,0,v38
s_cmp_lt_i32 s90,0
s_cselect_b64 vcc,0,vcc
s_cbranch_vccnz free_122
s_xor_b32 s64,s61,4194304
buffer_store_dwordx4 v[100:103],v206,s[20:23],s64 offen sc1
buffer_store_dwordx4 v[100:103],v207,s[20:23],s64 offen sc1
s_xor_b32 s64,s61,6299648
buffer_store_dwordx4 v[100:103],v206,s[20:23],s64 offen sc1
buffer_store_dwordx4 v[100:103],v207,s[20:23],s64 offen sc1
s_xor_b32 s64,s61,8388608
buffer_store_dwordx4 v[100:103],v206,s[20:23],s64 offen sc1
buffer_store_dwordx4 v[100:103],v207,s[20:23],s64 offen sc1
s_mov_b32 m0,0
s_mov_b32 s65,188416
buffer_load_dwordx4 v16,s[20:23],s65 offen offset:0 lds
buffer_load_dwordx4 v16,s[20:23],s65 offen offset:1024 lds
buffer_load_dwordx4 v16,s[20:23],s65 offen offset:2048 lds
buffer_load_dwordx4 v16,s[20:23],s65 offen offset:3072 lds
s_mov_b32 m0,4096
s_mov_b32 s65,192512
buffer_load_dwordx4 v16,s[20:23],s65 offen offset:0 lds
buffer_load_dwordx4 v16,s[20:23],s65 offen offset:1024 lds
buffer_load_dwordx4 v16,s[20:23],s65 offen offset:2048 lds
buffer_load_dwordx4 v16,s[20:23],s65 offen offset:3072 lds
s_mov_b32 m0,8192
s_mov_b32 s65,196608
buffer_load_dwordx4 v16,s[20:23],s65 offen offset:0 lds
buffer_load_dwordx4 v16,s[20:23],s65 offen offset:1024 lds
buffer_load_dwordx4 v16,s[20:23],s65 offen offset:2048 lds
buffer_load_dwordx4 v16,s[20:23],s65 offen offset:3072 lds
s_mov_b32 m0,12288
s_mov_b32 s65,200704
buffer_load_dwordx4 v16,s[20:23],s65 offen offset:0 lds
buffer_load_dwordx4 v16,s[20:23],s65 offen offset:1024 lds
buffer_load_dwordx4 v16,s[20:23],s65 offen offset:2048 lds
buffer_load_dwordx4 v16,s[20:23],s65 offen offset:3072 lds
s_mov_b32 m0,16384
s_mov_b32 s65,204800
buffer_load_dwordx4 v16,s[20:23],s65 offen offset:0 lds
buffer_load_dwordx4 v16,s[20:23],s65 offen offset:1024 lds
buffer_load_dwordx4 v16,s[20:23],s65 offen offset:2048 lds
buffer_load_dwordx4 v16,s[20:23],s65 offen offset:3072 lds
s_mov_b32 m0,20480
s_mov_b32 s65,208896
buffer_load_dwordx4 v16,s[20:23],s65 offen offset:0 lds
buffer_load_dwordx4 v16,s[20:23],s65 offen offset:1024 lds
buffer_load_dwordx4 v16,s[20:23],s65 offen offset:2048 lds
buffer_load_dwordx4 v16,s[20:23],s65 offen offset:3072 lds
s_mov_b32 m0,24576
s_mov_b32 s65,212992
buffer_load_dwordx4 v16,s[20:23],s65 offen offset:0 lds
buffer_load_dwordx4 v16,s[20:23],s65 offen offset:1024 lds
buffer_load_dwordx4 v16,s[20:23],s65 offen offset:2048 lds
buffer_load_dwordx4 v16,s[20:23],s65 offen offset:3072 lds
s_mov_b32 m0,28672
s_mov_b32 s65,217088
buffer_load_dwordx4 v16,s[20:23],s65 offen offset:0 lds
buffer_load_dwordx4 v16,s[20:23],s65 offen offset:1024 lds
buffer_load_dwordx4 v16,s[20:23],s65 offen offset:2048 lds
buffer_load_dwordx4 v16,s[20:23],s65 offen offset:3072 lds
s_waitcnt vmcnt(54)
ds_write_b128 v33,a[176:179] offset:4096
ds_write_b128 v33,a[180:183] offset:5120
ds_write_b128 v33,a[184:187] offset:6144
ds_write_b128 v33,a[188:191] offset:7168
s_waitcnt lgkmcnt(0)
ds_read_b64_tr_b16 a[176:177],v34 offset:4096
ds_read_b64_tr_b16 a[178:179],v34 offset:4224
ds_read_b64_tr_b16 a[180:181],v34 offset:6144
ds_read_b64_tr_b16 a[182:183],v34 offset:6272
ds_read_b64_tr_b16 a[184:185],v34 offset:4128
ds_read_b64_tr_b16 a[186:187],v34 offset:4256
ds_read_b64_tr_b16 a[188:189],v34 offset:6176
ds_read_b64_tr_b16 a[190:191],v34 offset:6304
s_waitcnt vmcnt(50)
ds_write_b128 v33,a[192:195] offset:0
ds_write_b128 v33,a[196:199] offset:1024
ds_write_b128 v33,a[200:203] offset:2048
ds_write_b128 v33,a[204:207] offset:3072
s_waitcnt lgkmcnt(0)
ds_read_b64_tr_b16 a[192:193],v34 offset:0
ds_read_b64_tr_b16 a[194:195],v34 offset:128
ds_read_b64_tr_b16 a[196:197],v34 offset:2048
ds_read_b64_tr_b16 a[198:199],v34 offset:2176
ds_read_b64_tr_b16 a[200:201],v34 offset:32
ds_read_b64_tr_b16 a[202:203],v34 offset:160
ds_read_b64_tr_b16 a[204:205],v34 offset:2080
ds_read_b64_tr_b16 a[206:207],v34 offset:2208
s_waitcnt vmcnt(46)
ds_write_b128 v33,a[208:211] offset:4096
ds_write_b128 v33,a[212:215] offset:5120
ds_write_b128 v33,a[216:219] offset:6144
ds_write_b128 v33,a[220:223] offset:7168
s_waitcnt lgkmcnt(0)
ds_read_b64_tr_b16 a[208:209],v34 offset:4096
ds_read_b64_tr_b16 a[210:211],v34 offset:4224
ds_read_b64_tr_b16 a[212:213],v34 offset:6144
ds_read_b64_tr_b16 a[214:215],v34 offset:6272
ds_read_b64_tr_b16 a[216:217],v34 offset:4128
ds_read_b64_tr_b16 a[218:219],v34 offset:4256
ds_read_b64_tr_b16 a[220:221],v34 offset:6176
ds_read_b64_tr_b16 a[222:223],v34 offset:6304
s_waitcnt vmcnt(42)
ds_write_b128 v33,a[224:227] offset:0
ds_write_b128 v33,a[228:231] offset:1024
ds_write_b128 v33,a[232:235] offset:2048
ds_write_b128 v33,a[236:239] offset:3072
s_waitcnt lgkmcnt(0)
ds_read_b64_tr_b16 a[224:225],v34 offset:0
ds_read_b64_tr_b16 a[226:227],v34 offset:128
ds_read_b64_tr_b16 a[228:229],v34 offset:2048
ds_read_b64_tr_b16 a[230:231],v34 offset:2176
ds_read_b64_tr_b16 a[232:233],v34 offset:32
ds_read_b64_tr_b16 a[234:235],v34 offset:160
ds_read_b64_tr_b16 a[236:237],v34 offset:2080
ds_read_b64_tr_b16 a[238:239],v34 offset:2208
s_waitcnt vmcnt(38)
ds_write_b128 v33,a[240:243] offset:4096
ds_write_b128 v33,a[244:247] offset:5120
ds_write_b128 v33,a[248:251] offset:6144
ds_write_b128 v33,a[252:255] offset:7168
s_waitcnt lgkmcnt(0)
ds_read_b64_tr_b16 a[240:241],v34 offset:4096
ds_read_b64_tr_b16 a[242:243],v34 offset:4224
ds_read_b64_tr_b16 a[244:245],v34 offset:6144
ds_read_b64_tr_b16 a[246:247],v34 offset:6272
ds_read_b64_tr_b16 a[248:249],v34 offset:4128
ds_read_b64_tr_b16 a[250:251],v34 offset:4256
ds_read_b64_tr_b16 a[252:253],v34 offset:6176
ds_read_b64_tr_b16 a[254:255],v34 offset:6304
s_mov_b32 s79,0
s_add_u32 s63,s79,0
s_and_b32 s64,s63,3
s_lshl_b32 s70,s64,20
s_add_u32 s65,s63,2
s_and_b32 s65,s65,3
s_lshl_b32 s73,s65,20
s_add_u32 s55,s63,3
s_lshl_b32 s78,s55,16
s_add_u32 s78,s78,57344
s_cmp_lt_u32 s55,64
s_cselect_b32 s78,s78,0x7fff0000
s_add_u32 s71,s70,65536
s_add_u32 s60,s63,1
s_and_b32 s60,s60,3
s_lshl_b32 s72,s60,20
v_mov_b32 v184,0
v_mov_b32 v185,0
v_mov_b32 v186,0
v_mov_b32 v187,0
v_mov_b32 v188,0
v_mov_b32 v189,0
v_mov_b32 v190,0
v_mov_b32 v191,0
s_lshl_b32 s77,s63,21
s_lshl_b32 s55,s63,13
s_and_b32 s55,s55,0x2000
s_xor_b32 s55,s55,s61
s_add_u32 s77,s77,s55
v_mov_b32 v176,0
v_mov_b32 v177,0
v_mov_b32 v178,0
v_mov_b32 v179,0
v_mov_b32 v25,1
s_waitcnt vmcnt(0) lgkmcnt(0)
s_barrier
s_branch loop_63
w1_59:
s_lshr_b32 s64,s57,2
s_add_u32 s64,s64,64
s_lshl_b32 s64,s64,14
s_add_u32 s64,s64,s68
s_add_u32 s64,s64,29360128
v_add_u32 v12,s64,v16
v_and_b32 v22,1,v4
v_lshrrev_b32 v23,1,v4
v_lshl_add_u32 v22,v22,1,v23
v_lshlrev_b32 v22,2,v22
v_lshl_add_u32 v22,v3,4,v22
v_add_u32 v31,155648,v22
v_add_u32 v8,s66,v16
v_add_u32 v9,s67,v16
v_mov_b32 v10,1792
v_mov_b32 v11,0
s_branch first_123
loop_124:
s_barrier
buffer_load_dword v248,v18,s[20:23],s70 offen offset:0 sc1
s_nop 15
s_nop 5
hl_126:
buffer_load_dword v249,v18,s[20:23],s70 offen offset:0 sc1
s_waitcnt vmcnt(1)
v_cmp_eq_u32 vcc,v25,v248
s_bcnt1_i32_b32 s64,vcc_lo
s_cmp_ge_u32 s64,8
s_cbranch_scc1 hg_127
buffer_load_dword v248,v18,s[20:23],s70 offen offset:0 sc1
s_waitcnt vmcnt(1)
v_cmp_eq_u32 vcc,v25,v249
s_bcnt1_i32_b32 s64,vcc_lo
s_cmp_ge_u32 s64,8
s_cbranch_scc1 hg_127
s_sub_u32 s90,s90,1
s_cmp_gt_i32 s90,0
s_cbranch_scc1 hl_126
hg_127:
buffer_load_dwordx4 v[48:51],v27,s[20:23],s70 offen offset:0 sc1
buffer_load_dwordx4 v[52:55],v27,s[20:23],s70 offen offset:1024 sc1
buffer_load_dwordx4 v[56:59],v27,s[20:23],s70 offen offset:2048 sc1
buffer_load_dwordx4 v[60:63],v27,s[20:23],s70 offen offset:3072 sc1
s_waitcnt vmcnt(3)
ds_write_b128 v24,v[48:51] offset:4096
v_min3_u32 v22,v48,v49,v50
v_min_u32 v22,v22,v51
s_waitcnt vmcnt(2)
ds_write_b128 v24,v[52:55] offset:5120
v_min3_u32 v22,v22,v52,v53
v_min3_u32 v22,v22,v54,v55
s_waitcnt vmcnt(1)
ds_write_b128 v24,v[56:59] offset:6144
v_min3_u32 v22,v22,v56,v57
v_min3_u32 v22,v22,v58,v59
s_waitcnt vmcnt(0)
ds_write_b128 v24,v[60:63] offset:7168
v_min3_u32 v22,v22,v60,v61
v_min3_u32 v22,v22,v62,v63
v_cmp_eq_u32 vcc,0,v22
s_cbranch_vccnz art_128
abk_129:
v_smfmac_f32_16x16x64_bf16 v[176:179],v[48:51],a[32:39],v14
s_waitcnt lgkmcnt(0)
s_barrier
ds_read_b128 v[64:67],v24 offset:8192
ds_read_b128 v[68:71],v24 offset:9216
ds_read_b128 v[72:75],v24 offset:10240
ds_read_b128 v[76:79],v24 offset:11264
buffer_store_dwordx4 v[212:215],v12,s[20:23],s76 offen sc1
v_smfmac_f32_16x16x64_bf16 v[176:179],v[52:55],a[40:47],v14
ds_read_b128 v[80:83],v24 offset:12288
ds_read_b128 v[84:87],v24 offset:13312
v_smfmac_f32_16x16x64_bf16 v[176:179],v[56:59],a[48:55],v14
ds_read_b128 v[88:91],v24 offset:14336
ds_read_b128 v[92:95],v24 offset:15360
v_smfmac_f32_16x16x64_bf16 v[176:179],v[60:63],a[56:63],v14
ds_read_b128 v[32:35],v24 offset:0
ds_read_b128 v[36:39],v24 offset:1024
s_waitcnt lgkmcnt(9)
v_smfmac_f32_16x16x64_bf16 v[176:179],v[64:67],a[64:71],v14
ds_read_b128 v[40:43],v24 offset:2048
s_waitcnt lgkmcnt(9)
v_smfmac_f32_16x16x64_bf16 v[176:179],v[68:71],a[72:79],v14
ds_read_b128 v[44:47],v24 offset:3072
s_waitcnt lgkmcnt(9)
v_smfmac_f32_16x16x64_bf16 v[176:179],v[72:75],a[80:87],v14
s_waitcnt lgkmcnt(8)
v_smfmac_f32_16x16x64_bf16 v[176:179],v[76:79],a[88:95],v14
s_waitcnt lgkmcnt(7)
v_smfmac_f32_16x16x64_bf16 v[176:179],v[80:83],a[96:103],v14
s_waitcnt lgkmcnt(6)
v_smfmac_f32_16x16x64_bf16 v[176:179],v[84:87],a[104:111],v14
s_waitcnt lgkmcnt(5)
v_smfmac_f32_16x16x64_bf16 v[176:179],v[88:91],a[112:119],v14
s_waitcnt lgkmcnt(4)
v_smfmac_f32_16x16x64_bf16 v[176:179],v[92:95],a[120:127],v14
s_waitcnt lgkmcnt(3)
v_smfmac_f32_16x16x64_bf16 v[176:179],v[32:35],a[0:7],v14
s_waitcnt lgkmcnt(2)
v_smfmac_f32_16x16x64_bf16 v[176:179],v[36:39],a[8:15],v14
s_waitcnt lgkmcnt(1)
v_smfmac_f32_16x16x64_bf16 v[176:179],v[40:43],a[16:23],v14
s_waitcnt lgkmcnt(0)
v_smfmac_f32_16x16x64_bf16 v[176:179],v[44:47],a[24:31],v14
v_smfmac_f32_16x16x64_bf16 v[180:183],v[32:35],a[128:135],v14
v_smfmac_f32_16x16x64_bf16 v[180:183],v[36:39],a[136:143],v14
s_nop 5
v_permlane32_swap_b32 v176,v178
v_permlane32_swap_b32 v177,v179
v_add_f32 v176,v176,v178
v_add_f32 v177,v177,v179
v_cvt_pk_bf16_f32 v216,v176,v177
s_nop 1
v_mov_b32_dpp v217,v216 quad_perm:[1,0,3,2] row_mask:0xf bank_mask:0xf
v_perm_b32 v216,v217,v216,v15
v_max_u32 v216,1,v216
buffer_store_dword v216,v19,s[24:27],s70 offen
buffer_store_dword v216,v19,s[28:31],s70 offen sc1
v_smfmac_f32_16x16x64_bf16 v[180:183],v[40:43],a[144:151],v14
v_smfmac_f32_16x16x64_bf16 v[180:183],v[44:47],a[152:159],v14
v_smfmac_f32_16x16x64_bf16 v[180:183],v[48:51],a[160:167],v14
v_smfmac_f32_16x16x64_bf16 v[180:183],v[52:55],a[168:175],v14
v_smfmac_f32_16x16x64_bf16 v[180:183],v[56:59],a[176:183],v14
v_smfmac_f32_16x16x64_bf16 v[180:183],v[60:63],a[184:191],v14
v_smfmac_f32_16x16x64_bf16 v[180:183],v[64:67],a[192:199],v14
v_smfmac_f32_16x16x64_bf16 v[180:183],v[68:71],a[200:207],v14
v_smfmac_f32_16x16x64_bf16 v[180:183],v[72:75],a[208:215],v14
v_smfmac_f32_16x16x64_bf16 v[180:183],v[76:79],a[216:223],v14
v_smfmac_f32_16x16x64_bf16 v[180:183],v[80:83],a[224:231],v14
v_smfmac_f32_16x16x64_bf16 v[180:183],v[84:87],a[232:239],v14
v_smfmac_f32_16x16x64_bf16 v[180:183],v[88:91],a[240:247],v14
v_smfmac_f32_16x16x64_bf16 v[180:183],v[92:95],a[248:255],v14
s_nop 7
v_permlane32_swap_b32 v180,v182
v_permlane32_swap_b32 v181,v183
v_add_f32 v180,v180,v182
v_add_f32 v181,v181,v183
v_cvt_pk_bf16_f32 v216,v180,v181
v_max_u32 v216,1,v216
ds_write_b32 v31,v216
ds_write_b32 v21,v25 offset:0
s_cmp_eq_u32 s79,63
s_cbranch_scc1 end_57
s_cmp_ge_i32 s79,62
s_cbranch_scc1 bgsk_131
ds_read_b128 v[64:67],v20 offset:0
ds_read_b128 v[68:71],v20 offset:1024
ds_read_b128 v[72:75],v20 offset:2048
s_waitcnt lgkmcnt(2)
v_mfma_f32_16x16x32_bf16 v[192:195],a[0:3],v[64:67],0
ds_read_b128 v[76:79],v20 offset:3072
v_mfma_f32_16x16x32_bf16 v[200:203],v[64:67],a[128:131],0
s_waitcnt lgkmcnt(2)
v_mfma_f32_16x16x32_bf16 v[196:199],a[0:3],v[68:71],0
ds_read_b128 v[64:67],v20 offset:4096
v_mfma_f32_16x16x32_bf16 v[204:207],v[68:71],a[128:131],0
s_waitcnt lgkmcnt(2)
v_mfma_f32_16x16x32_bf16 v[192:195],a[4:7],v[72:75],v[192:195]
ds_read_b128 v[68:71],v20 offset:5120
v_mfma_f32_16x16x32_bf16 v[200:203],v[72:75],a[132:135],v[200:203]
s_waitcnt lgkmcnt(2)
v_mfma_f32_16x16x32_bf16 v[196:199],a[4:7],v[76:79],v[196:199]
ds_read_b128 v[72:75],v20 offset:6144
v_mfma_f32_16x16x32_bf16 v[204:207],v[76:79],a[132:135],v[204:207]
s_waitcnt lgkmcnt(2)
v_mfma_f32_16x16x32_bf16 v[192:195],a[8:11],v[64:67],v[192:195]
ds_read_b128 v[76:79],v20 offset:7168
v_mfma_f32_16x16x32_bf16 v[200:203],v[64:67],a[136:139],v[200:203]
s_waitcnt lgkmcnt(2)
v_mfma_f32_16x16x32_bf16 v[196:199],a[8:11],v[68:71],v[196:199]
ds_read_b128 v[64:67],v20 offset:8192
v_mfma_f32_16x16x32_bf16 v[204:207],v[68:71],a[136:139],v[204:207]
s_waitcnt lgkmcnt(2)
v_mfma_f32_16x16x32_bf16 v[192:195],a[12:15],v[72:75],v[192:195]
ds_read_b128 v[68:71],v20 offset:9216
v_mfma_f32_16x16x32_bf16 v[200:203],v[72:75],a[140:143],v[200:203]
s_waitcnt lgkmcnt(2)
v_mfma_f32_16x16x32_bf16 v[196:199],a[12:15],v[76:79],v[196:199]
ds_read_b128 v[72:75],v20 offset:10240
v_mfma_f32_16x16x32_bf16 v[204:207],v[76:79],a[140:143],v[204:207]
s_add_u32 m0,s62,0
s_add_u32 s69,s78,0
s_waitcnt lgkmcnt(2)
v_mfma_f32_16x16x32_bf16 v[192:195],a[16:19],v[64:67],v[192:195]
ds_read_b128 v[76:79],v20 offset:11264
v_mfma_f32_16x16x32_bf16 v[200:203],v[64:67],a[144:147],v[200:203]
buffer_load_dwordx4 v16,s[20:23],s69 offen offset:0 lds
s_waitcnt lgkmcnt(2)
v_mfma_f32_16x16x32_bf16 v[196:199],a[16:19],v[68:71],v[196:199]
ds_read_b128 v[64:67],v20 offset:12288
v_mfma_f32_16x16x32_bf16 v[204:207],v[68:71],a[144:147],v[204:207]
buffer_load_dwordx4 v16,s[20:23],s69 offen offset:1024 lds
s_waitcnt lgkmcnt(2)
v_mfma_f32_16x16x32_bf16 v[192:195],a[20:23],v[72:75],v[192:195]
ds_read_b128 v[68:71],v20 offset:13312
v_mfma_f32_16x16x32_bf16 v[200:203],v[72:75],a[148:151],v[200:203]
buffer_load_dwordx4 v16,s[20:23],s69 offen offset:2048 lds
s_waitcnt lgkmcnt(2)
v_mfma_f32_16x16x32_bf16 v[196:199],a[20:23],v[76:79],v[196:199]
ds_read_b128 v[72:75],v20 offset:14336
v_mfma_f32_16x16x32_bf16 v[204:207],v[76:79],a[148:151],v[204:207]
buffer_load_dwordx4 v16,s[20:23],s69 offen offset:3072 lds
s_waitcnt lgkmcnt(2)
v_mfma_f32_16x16x32_bf16 v[192:195],a[24:27],v[64:67],v[192:195]
ds_read_b128 v[76:79],v20 offset:15360
v_mfma_f32_16x16x32_bf16 v[200:203],v[64:67],a[152:155],v[200:203]
s_add_u32 m0,s62,4096
s_add_u32 s69,s78,4096
s_waitcnt lgkmcnt(2)
v_mfma_f32_16x16x32_bf16 v[196:199],a[24:27],v[68:71],v[196:199]
ds_read_b128 v[64:67],v20 offset:16384
v_mfma_f32_16x16x32_bf16 v[204:207],v[68:71],a[152:155],v[204:207]
buffer_load_dwordx4 v16,s[20:23],s69 offen offset:0 lds
s_waitcnt lgkmcnt(2)
v_mfma_f32_16x16x32_bf16 v[192:195],a[28:31],v[72:75],v[192:195]
ds_read_b128 v[68:71],v20 offset:17408
v_mfma_f32_16x16x32_bf16 v[200:203],v[72:75],a[156:159],v[200:203]
buffer_load_dwordx4 v16,s[20:23],s69 offen offset:1024 lds
s_waitcnt lgkmcnt(2)
v_mfma_f32_16x16x32_bf16 v[196:199],a[28:31],v[76:79],v[196:199]
ds_read_b128 v[72:75],v20 offset:18432
v_mfma_f32_16x16x32_bf16 v[204:207],v[76:79],a[156:159],v[204:207]
buffer_load_dwordx4 v16,s[20:23],s69 offen offset:2048 lds
s_waitcnt lgkmcnt(2)
v_mfma_f32_16x16x32_bf16 v[192:195],a[32:35],v[64:67],v[192:195]
ds_read_b128 v[76:79],v20 offset:19456
v_mfma_f32_16x16x32_bf16 v[200:203],v[64:67],a[160:163],v[200:203]
buffer_load_dwordx4 v16,s[20:23],s69 offen offset:3072 lds
s_waitcnt lgkmcnt(2)
v_mfma_f32_16x16x32_bf16 v[196:199],a[32:35],v[68:71],v[196:199]
ds_read_b128 v[64:67],v20 offset:20480
v_mfma_f32_16x16x32_bf16 v[204:207],v[68:71],a[160:163],v[204:207]
s_add_u32 m0,s62,8192
s_add_u32 s69,s78,8192
s_waitcnt lgkmcnt(2)
v_mfma_f32_16x16x32_bf16 v[192:195],a[36:39],v[72:75],v[192:195]
ds_read_b128 v[68:71],v20 offset:21504
v_mfma_f32_16x16x32_bf16 v[200:203],v[72:75],a[164:167],v[200:203]
buffer_load_dwordx4 v16,s[20:23],s69 offen offset:0 lds
s_waitcnt lgkmcnt(2)
v_mfma_f32_16x16x32_bf16 v[196:199],a[36:39],v[76:79],v[196:199]
ds_read_b128 v[72:75],v20 offset:22528
v_mfma_f32_16x16x32_bf16 v[204:207],v[76:79],a[164:167],v[204:207]
buffer_load_dwordx4 v16,s[20:23],s69 offen offset:1024 lds
s_waitcnt lgkmcnt(2)
v_mfma_f32_16x16x32_bf16 v[192:195],a[40:43],v[64:67],v[192:195]
ds_read_b128 v[76:79],v20 offset:23552
v_mfma_f32_16x16x32_bf16 v[200:203],v[64:67],a[168:171],v[200:203]
buffer_load_dwordx4 v16,s[20:23],s69 offen offset:2048 lds
s_waitcnt lgkmcnt(2)
v_mfma_f32_16x16x32_bf16 v[196:199],a[40:43],v[68:71],v[196:199]
ds_read_b128 v[64:67],v20 offset:24576
v_mfma_f32_16x16x32_bf16 v[204:207],v[68:71],a[168:171],v[204:207]
buffer_load_dwordx4 v16,s[20:23],s69 offen offset:3072 lds
s_waitcnt lgkmcnt(2)
v_mfma_f32_16x16x32_bf16 v[192:195],a[44:47],v[72:75],v[192:195]
ds_read_b128 v[68:71],v20 offset:25600
v_mfma_f32_16x16x32_bf16 v[200:203],v[72:75],a[172:175],v[200:203]
s_add_u32 m0,s62,12288
s_add_u32 s69,s78,12288
s_waitcnt lgkmcnt(2)
v_mfma_f32_16x16x32_bf16 v[196:199],a[44:47],v[76:79],v[196:199]
ds_read_b128 v[72:75],v20 offset:26624
v_mfma_f32_16x16x32_bf16 v[204:207],v[76:79],a[172:175],v[204:207]
buffer_load_dwordx4 v16,s[20:23],s69 offen offset:0 lds
s_waitcnt lgkmcnt(2)
v_mfma_f32_16x16x32_bf16 v[192:195],a[48:51],v[64:67],v[192:195]
ds_read_b128 v[76:79],v20 offset:27648
v_mfma_f32_16x16x32_bf16 v[200:203],v[64:67],a[176:179],v[200:203]
buffer_load_dwordx4 v16,s[20:23],s69 offen offset:1024 lds
s_waitcnt lgkmcnt(2)
v_mfma_f32_16x16x32_bf16 v[196:199],a[48:51],v[68:71],v[196:199]
ds_read_b128 v[64:67],v20 offset:28672
v_mfma_f32_16x16x32_bf16 v[204:207],v[68:71],a[176:179],v[204:207]
buffer_load_dwordx4 v16,s[20:23],s69 offen offset:2048 lds
s_waitcnt lgkmcnt(2)
v_mfma_f32_16x16x32_bf16 v[192:195],a[52:55],v[72:75],v[192:195]
ds_read_b128 v[68:71],v20 offset:29696
v_mfma_f32_16x16x32_bf16 v[200:203],v[72:75],a[180:183],v[200:203]
buffer_load_dwordx4 v16,s[20:23],s69 offen offset:3072 lds
s_waitcnt lgkmcnt(2)
v_mfma_f32_16x16x32_bf16 v[196:199],a[52:55],v[76:79],v[196:199]
ds_read_b128 v[72:75],v20 offset:30720
v_mfma_f32_16x16x32_bf16 v[204:207],v[76:79],a[180:183],v[204:207]
s_waitcnt lgkmcnt(2)
v_mfma_f32_16x16x32_bf16 v[192:195],a[56:59],v[64:67],v[192:195]
ds_read_b128 v[76:79],v20 offset:31744
v_mfma_f32_16x16x32_bf16 v[200:203],v[64:67],a[184:187],v[200:203]
s_waitcnt lgkmcnt(2)
v_mfma_f32_16x16x32_bf16 v[196:199],a[56:59],v[68:71],v[196:199]
ds_read_b128 v[64:67],v20 offset:32768
v_mfma_f32_16x16x32_bf16 v[204:207],v[68:71],a[184:187],v[204:207]
s_waitcnt lgkmcnt(2)
v_mfma_f32_16x16x32_bf16 v[192:195],a[60:63],v[72:75],v[192:195]
ds_read_b128 v[68:71],v20 offset:33792
v_mfma_f32_16x16x32_bf16 v[200:203],v[72:75],a[188:191],v[200:203]
s_waitcnt lgkmcnt(2)
v_mfma_f32_16x16x32_bf16 v[196:199],a[60:63],v[76:79],v[196:199]
ds_read_b128 v[72:75],v20 offset:34816
v_mfma_f32_16x16x32_bf16 v[204:207],v[76:79],a[188:191],v[204:207]
s_waitcnt lgkmcnt(2)
v_mfma_f32_16x16x32_bf16 v[192:195],a[64:67],v[64:67],v[192:195]
ds_read_b128 v[76:79],v20 offset:35840
v_mfma_f32_16x16x32_bf16 v[200:203],v[64:67],a[192:195],v[200:203]
s_waitcnt lgkmcnt(2)
v_mfma_f32_16x16x32_bf16 v[196:199],a[64:67],v[68:71],v[196:199]
ds_read_b128 v[64:67],v20 offset:36864
v_mfma_f32_16x16x32_bf16 v[204:207],v[68:71],a[192:195],v[204:207]
s_waitcnt lgkmcnt(2)
v_mfma_f32_16x16x32_bf16 v[192:195],a[68:71],v[72:75],v[192:195]
ds_read_b128 v[68:71],v20 offset:37888
v_mfma_f32_16x16x32_bf16 v[200:203],v[72:75],a[196:199],v[200:203]
s_waitcnt lgkmcnt(2)
v_mfma_f32_16x16x32_bf16 v[196:199],a[68:71],v[76:79],v[196:199]
ds_read_b128 v[72:75],v20 offset:38912
v_mfma_f32_16x16x32_bf16 v[204:207],v[76:79],a[196:199],v[204:207]
s_waitcnt lgkmcnt(2)
v_mfma_f32_16x16x32_bf16 v[192:195],a[72:75],v[64:67],v[192:195]
ds_read_b128 v[76:79],v20 offset:39936
v_mfma_f32_16x16x32_bf16 v[200:203],v[64:67],a[200:203],v[200:203]
s_waitcnt lgkmcnt(2)
v_mfma_f32_16x16x32_bf16 v[196:199],a[72:75],v[68:71],v[196:199]
ds_read_b128 v[64:67],v20 offset:40960
v_mfma_f32_16x16x32_bf16 v[204:207],v[68:71],a[200:203],v[204:207]
s_waitcnt lgkmcnt(2)
v_mfma_f32_16x16x32_bf16 v[192:195],a[76:79],v[72:75],v[192:195]
ds_read_b128 v[68:71],v20 offset:41984
v_mfma_f32_16x16x32_bf16 v[200:203],v[72:75],a[204:207],v[200:203]
s_waitcnt lgkmcnt(2)
v_mfma_f32_16x16x32_bf16 v[196:199],a[76:79],v[76:79],v[196:199]
ds_read_b128 v[72:75],v20 offset:43008
v_mfma_f32_16x16x32_bf16 v[204:207],v[76:79],a[204:207],v[204:207]
s_waitcnt lgkmcnt(2)
v_mfma_f32_16x16x32_bf16 v[192:195],a[80:83],v[64:67],v[192:195]
ds_read_b128 v[76:79],v20 offset:44032
v_mfma_f32_16x16x32_bf16 v[200:203],v[64:67],a[208:211],v[200:203]
s_waitcnt lgkmcnt(2)
v_mfma_f32_16x16x32_bf16 v[196:199],a[80:83],v[68:71],v[196:199]
ds_read_b128 v[64:67],v20 offset:45056
v_mfma_f32_16x16x32_bf16 v[204:207],v[68:71],a[208:211],v[204:207]
s_waitcnt lgkmcnt(2)
v_mfma_f32_16x16x32_bf16 v[192:195],a[84:87],v[72:75],v[192:195]
ds_read_b128 v[68:71],v20 offset:46080
v_mfma_f32_16x16x32_bf16 v[200:203],v[72:75],a[212:215],v[200:203]
s_waitcnt lgkmcnt(2)
v_mfma_f32_16x16x32_bf16 v[196:199],a[84:87],v[76:79],v[196:199]
ds_read_b128 v[72:75],v20 offset:47104
v_mfma_f32_16x16x32_bf16 v[204:207],v[76:79],a[212:215],v[204:207]
s_waitcnt lgkmcnt(2)
v_mfma_f32_16x16x32_bf16 v[192:195],a[88:91],v[64:67],v[192:195]
ds_read_b128 v[76:79],v20 offset:48128
v_mfma_f32_16x16x32_bf16 v[200:203],v[64:67],a[216:219],v[200:203]
s_waitcnt lgkmcnt(2)
v_mfma_f32_16x16x32_bf16 v[196:199],a[88:91],v[68:71],v[196:199]
ds_read_b128 v[64:67],v20 offset:49152
v_mfma_f32_16x16x32_bf16 v[204:207],v[68:71],a[216:219],v[204:207]
s_waitcnt lgkmcnt(2)
v_mfma_f32_16x16x32_bf16 v[192:195],a[92:95],v[72:75],v[192:195]
ds_read_b128 v[68:71],v20 offset:50176
v_mfma_f32_16x16x32_bf16 v[200:203],v[72:75],a[220:223],v[200:203]
s_waitcnt lgkmcnt(2)
v_mfma_f32_16x16x32_bf16 v[196:199],a[92:95],v[76:79],v[196:199]
ds_read_b128 v[72:75],v20 offset:51200
v_mfma_f32_16x16x32_bf16 v[204:207],v[76:79],a[220:223],v[204:207]
s_waitcnt lgkmcnt(2)
v_mfma_f32_16x16x32_bf16 v[192:195],a[96:99],v[64:67],v[192:195]
ds_read_b128 v[76:79],v20 offset:52224
v_mfma_f32_16x16x32_bf16 v[200:203],v[64:67],a[224:227],v[200:203]
s_waitcnt lgkmcnt(2)
v_mfma_f32_16x16x32_bf16 v[196:199],a[96:99],v[68:71],v[196:199]
ds_read_b128 v[64:67],v20 offset:53248
v_mfma_f32_16x16x32_bf16 v[204:207],v[68:71],a[224:227],v[204:207]
s_waitcnt lgkmcnt(2)
v_mfma_f32_16x16x32_bf16 v[192:195],a[100:103],v[72:75],v[192:195]
ds_read_b128 v[68:71],v20 offset:54272
s_add_u32 m0,s62,32768
s_add_u32 s69,s78,32768
v_mfma_f32_16x16x32_bf16 v[200:203],v[72:75],a[228:231],v[200:203]
s_waitcnt lgkmcnt(2)
v_mfma_f32_16x16x32_bf16 v[196:199],a[100:103],v[76:79],v[196:199]
ds_read_b128 v[72:75],v20 offset:55296
buffer_load_dwordx4 v16,s[20:23],s69 offen offset:0 lds
v_mfma_f32_16x16x32_bf16 v[204:207],v[76:79],a[228:231],v[204:207]
s_waitcnt lgkmcnt(2)
v_mfma_f32_16x16x32_bf16 v[192:195],a[104:107],v[64:67],v[192:195]
ds_read_b128 v[76:79],v20 offset:56320
buffer_load_dwordx4 v16,s[20:23],s69 offen offset:1024 lds
v_mfma_f32_16x16x32_bf16 v[200:203],v[64:67],a[232:235],v[200:203]
s_waitcnt lgkmcnt(2)
v_mfma_f32_16x16x32_bf16 v[196:199],a[104:107],v[68:71],v[196:199]
ds_read_b128 v[64:67],v20 offset:57344
buffer_load_dwordx4 v16,s[20:23],s69 offen offset:2048 lds
v_mfma_f32_16x16x32_bf16 v[204:207],v[68:71],a[232:235],v[204:207]
s_waitcnt lgkmcnt(2)
v_mfma_f32_16x16x32_bf16 v[192:195],a[108:111],v[72:75],v[192:195]
ds_read_b128 v[68:71],v20 offset:58368
buffer_load_dwordx4 v16,s[20:23],s69 offen offset:3072 lds
v_mfma_f32_16x16x32_bf16 v[200:203],v[72:75],a[236:239],v[200:203]
s_waitcnt lgkmcnt(2)
v_mfma_f32_16x16x32_bf16 v[196:199],a[108:111],v[76:79],v[196:199]
ds_read_b128 v[72:75],v20 offset:59392
s_add_u32 m0,s62,36864
s_add_u32 s69,s78,36864
v_mfma_f32_16x16x32_bf16 v[204:207],v[76:79],a[236:239],v[204:207]
s_waitcnt lgkmcnt(2)
v_mfma_f32_16x16x32_bf16 v[192:195],a[112:115],v[64:67],v[192:195]
ds_read_b128 v[76:79],v20 offset:60416
buffer_load_dwordx4 v16,s[20:23],s69 offen offset:0 lds
v_mfma_f32_16x16x32_bf16 v[200:203],v[64:67],a[240:243],v[200:203]
s_waitcnt lgkmcnt(2)
v_mfma_f32_16x16x32_bf16 v[196:199],a[112:115],v[68:71],v[196:199]
ds_read_b128 v[64:67],v20 offset:61440
v_mfma_f32_16x16x32_bf16 v[204:207],v[68:71],a[240:243],v[204:207]
buffer_load_dwordx4 v16,s[20:23],s69 offen offset:1024 lds
s_waitcnt lgkmcnt(2)
v_mfma_f32_16x16x32_bf16 v[192:195],a[116:119],v[72:75],v[192:195]
ds_read_b128 v[68:71],v20 offset:62464
v_mfma_f32_16x16x32_bf16 v[200:203],v[72:75],a[244:247],v[200:203]
buffer_load_dwordx4 v16,s[20:23],s69 offen offset:2048 lds
s_waitcnt lgkmcnt(2)
v_mfma_f32_16x16x32_bf16 v[196:199],a[116:119],v[76:79],v[196:199]
ds_read_b128 v[72:75],v20 offset:63488
v_mfma_f32_16x16x32_bf16 v[204:207],v[76:79],a[244:247],v[204:207]
buffer_load_dwordx4 v16,s[20:23],s69 offen offset:3072 lds
s_waitcnt lgkmcnt(2)
v_mfma_f32_16x16x32_bf16 v[192:195],a[120:123],v[64:67],v[192:195]
ds_read_b128 v[76:79],v20 offset:64512
v_mfma_f32_16x16x32_bf16 v[200:203],v[64:67],a[248:251],v[200:203]
s_add_u32 m0,s62,40960
s_add_u32 s69,s78,40960
s_waitcnt lgkmcnt(2)
v_mfma_f32_16x16x32_bf16 v[196:199],a[120:123],v[68:71],v[196:199]
v_mfma_f32_16x16x32_bf16 v[204:207],v[68:71],a[248:251],v[204:207]
buffer_load_dwordx4 v16,s[20:23],s69 offen offset:0 lds
s_waitcnt lgkmcnt(1)
v_mfma_f32_16x16x32_bf16 v[192:195],a[124:127],v[72:75],v[192:195]
v_mfma_f32_16x16x32_bf16 v[200:203],v[72:75],a[252:255],v[200:203]
buffer_load_dwordx4 v16,s[20:23],s69 offen offset:1024 lds
s_waitcnt lgkmcnt(0)
v_mfma_f32_16x16x32_bf16 v[196:199],a[124:127],v[76:79],v[196:199]
v_mfma_f32_16x16x32_bf16 v[204:207],v[76:79],a[252:255],v[204:207]
s_waitcnt vmcnt(26)
ds_write_b32 v21,v25 offset:24
v_xor_b32 v20,0x10000,v20
s_xor_b32 s62,s62,0x10000
s_lshr_b32 s64,s73,9
v_add_u32 v22,s64,v24
v_cvt_pk_bf16_f32 v208,v192,v193
v_cvt_pk_bf16_f32 v209,v194,v195
v_cvt_pk_bf16_f32 v210,v196,v197
v_cvt_pk_bf16_f32 v211,v198,v199
v_cvt_pk_bf16_f32 v212,v200,v201
v_cvt_pk_bf16_f32 v213,v202,v203
v_cvt_pk_bf16_f32 v214,v204,v205
v_cvt_pk_bf16_f32 v215,v206,v207
v_permlane16_swap_b32 v208,v210
v_permlane16_swap_b32 v209,v211
buffer_store_dwordx4 v[208:211],v2,s[24:27],s73 offen
buffer_store_dwordx4 v[208:211],v2,s[28:31],s73 offen sc1
ds_write_b128 v22,v[212:215] offset:16384
buffer_store_dwordx4 v[208:211],v17,s[20:23],s12 offen sc1
bgx_130:
buffer_store_dwordx4 v[100:103],v9,s[24:27],s73 offen
buffer_store_dwordx4 v[100:103],v9,s[28:31],s73 offen sc1
s_mov_b32 exec_hi,0
buffer_store_dwordx4 v[100:103],v8,s[24:27],s73 offen
buffer_store_dwordx4 v[100:103],v8,s[24:27],s71 offen
buffer_store_dwordx4 v[100:103],v8,s[28:31],s73 offen sc1
buffer_store_dwordx4 v[100:103],v8,s[28:31],s71 offen sc1
s_mov_b64 exec,-1
s_waitcnt lgkmcnt(0)
s_add_u32 s63,s79,1
s_and_b32 s64,s63,3
s_lshl_b32 s70,s64,20
s_add_u32 s65,s63,2
s_and_b32 s65,s65,3
s_lshl_b32 s73,s65,20
s_add_u32 s55,s63,3
s_lshl_b32 s78,s55,16
s_add_u32 s78,s78,57344
s_cmp_lt_u32 s55,64
s_cselect_b32 s78,s78,0x7fff0000
s_add_u32 s60,s63,1
s_lshl_b32 s76,s60,21
s_lshl_b32 s55,s60,13
s_and_b32 s55,s55,0x2000
s_xor_b32 s55,s55,s61
s_add_u32 s76,s76,s55
s_cmp_lt_u32 s60,64
s_cselect_b32 s76,s76,0x7fff0000
s_add_u32 s60,s63,2
s_lshl_b32 s12,s60,21
s_lshl_b32 s55,s60,13
s_and_b32 s55,s55,0x2000
s_xor_b32 s55,s55,s61
s_add_u32 s12,s12,s55
s_cmp_lt_u32 s60,64
s_cselect_b32 s12,s12,0x7fff0000
s_add_u32 s71,s73,65536
v_mov_b32 v176,0
v_mov_b32 v177,0
v_mov_b32 v178,0
v_mov_b32 v179,0
v_mov_b32 v180,0
v_mov_b32 v181,0
v_mov_b32 v182,0
v_mov_b32 v183,0
s_add_u32 s79,s79,1
v_add_u32 v25,1,v25
s_waitcnt vmcnt(0)
s_branch loop_124
art_128:
s_sub_u32 s90,s90,1
s_cmp_lt_i32 s90,0
s_cbranch_scc1 abk_129
buffer_load_dwordx4 v[48:51],v27,s[20:23],s70 offen offset:0 sc1
buffer_load_dwordx4 v[52:55],v27,s[20:23],s70 offen offset:1024 sc1
buffer_load_dwordx4 v[56:59],v27,s[20:23],s70 offen offset:2048 sc1
buffer_load_dwordx4 v[60:63],v27,s[20:23],s70 offen offset:3072 sc1
s_waitcnt vmcnt(3)
ds_write_b128 v24,v[48:51] offset:4096
v_min3_u32 v22,v48,v49,v50
v_min_u32 v22,v22,v51
s_waitcnt vmcnt(2)
ds_write_b128 v24,v[52:55] offset:5120
v_min3_u32 v22,v22,v52,v53
v_min3_u32 v22,v22,v54,v55
s_waitcnt vmcnt(1)
ds_write_b128 v24,v[56:59] offset:6144
v_min3_u32 v22,v22,v56,v57
v_min3_u32 v22,v22,v58,v59
s_waitcnt vmcnt(0)
ds_write_b128 v24,v[60:63] offset:7168
v_min3_u32 v22,v22,v60,v61
v_min3_u32 v22,v22,v62,v63
v_cmp_eq_u32 vcc,0,v22
s_cbranch_vccnz art_128
s_branch abk_129
bgsk_131:
s_waitcnt vmcnt(0)
ds_write_b32 v21,v25 offset:24
s_branch bgx_130
first_123:
s_add_u32 s63,s79,0
s_and_b32 s64,s63,3
s_lshl_b32 s70,s64,20
s_add_u32 s65,s63,2
s_and_b32 s65,s65,3
s_lshl_b32 s73,s65,20
s_add_u32 s55,s63,3
s_lshl_b32 s78,s55,16
s_add_u32 s78,s78,57344
s_cmp_lt_u32 s55,64
s_cselect_b32 s78,s78,0x7fff0000
s_add_u32 s60,s63,1
s_lshl_b32 s76,s60,21
s_lshl_b32 s55,s60,13
s_and_b32 s55,s55,0x2000
s_xor_b32 s55,s55,s61
s_add_u32 s76,s76,s55
s_cmp_lt_u32 s60,64
s_cselect_b32 s76,s76,0x7fff0000
s_add_u32 s60,s63,2
s_lshl_b32 s12,s60,21
s_lshl_b32 s55,s60,13
s_and_b32 s55,s55,0x2000
s_xor_b32 s55,s55,s61
s_add_u32 s12,s12,s55
s_cmp_lt_u32 s60,64
s_cselect_b32 s12,s12,0x7fff0000
s_add_u32 s71,s73,65536
v_mov_b32 v176,0
v_mov_b32 v177,0
v_mov_b32 v178,0
v_mov_b32 v179,0
v_mov_b32 v180,0
v_mov_b32 v181,0
v_mov_b32 v182,0
v_mov_b32 v183,0
s_waitcnt vmcnt(0) lgkmcnt(0)
s_barrier
pn1_132:
ds_read_b128 v[64:67],v20 offset:0
ds_read_b128 v[68:71],v20 offset:1024
ds_read_b128 v[72:75],v20 offset:2048
s_waitcnt lgkmcnt(2)
v_mfma_f32_16x16x32_bf16 v[192:195],a[0:3],v[64:67],0
ds_read_b128 v[76:79],v20 offset:3072
v_mfma_f32_16x16x32_bf16 v[200:203],v[64:67],a[128:131],0
s_waitcnt lgkmcnt(2)
v_mfma_f32_16x16x32_bf16 v[196:199],a[0:3],v[68:71],0
ds_read_b128 v[64:67],v20 offset:4096
v_mfma_f32_16x16x32_bf16 v[204:207],v[68:71],a[128:131],0
s_waitcnt lgkmcnt(2)
v_mfma_f32_16x16x32_bf16 v[192:195],a[4:7],v[72:75],v[192:195]
ds_read_b128 v[68:71],v20 offset:5120
v_mfma_f32_16x16x32_bf16 v[200:203],v[72:75],a[132:135],v[200:203]
s_waitcnt lgkmcnt(2)
v_mfma_f32_16x16x32_bf16 v[196:199],a[4:7],v[76:79],v[196:199]
ds_read_b128 v[72:75],v20 offset:6144
v_mfma_f32_16x16x32_bf16 v[204:207],v[76:79],a[132:135],v[204:207]
s_waitcnt lgkmcnt(2)
v_mfma_f32_16x16x32_bf16 v[192:195],a[8:11],v[64:67],v[192:195]
ds_read_b128 v[76:79],v20 offset:7168
v_mfma_f32_16x16x32_bf16 v[200:203],v[64:67],a[136:139],v[200:203]
s_waitcnt lgkmcnt(2)
v_mfma_f32_16x16x32_bf16 v[196:199],a[8:11],v[68:71],v[196:199]
ds_read_b128 v[64:67],v20 offset:8192
v_mfma_f32_16x16x32_bf16 v[204:207],v[68:71],a[136:139],v[204:207]
s_waitcnt lgkmcnt(2)
v_mfma_f32_16x16x32_bf16 v[192:195],a[12:15],v[72:75],v[192:195]
ds_read_b128 v[68:71],v20 offset:9216
v_mfma_f32_16x16x32_bf16 v[200:203],v[72:75],a[140:143],v[200:203]
s_waitcnt lgkmcnt(2)
v_mfma_f32_16x16x32_bf16 v[196:199],a[12:15],v[76:79],v[196:199]
ds_read_b128 v[72:75],v20 offset:10240
v_mfma_f32_16x16x32_bf16 v[204:207],v[76:79],a[140:143],v[204:207]
s_waitcnt lgkmcnt(2)
v_mfma_f32_16x16x32_bf16 v[192:195],a[16:19],v[64:67],v[192:195]
ds_read_b128 v[76:79],v20 offset:11264
v_mfma_f32_16x16x32_bf16 v[200:203],v[64:67],a[144:147],v[200:203]
s_waitcnt lgkmcnt(2)
v_mfma_f32_16x16x32_bf16 v[196:199],a[16:19],v[68:71],v[196:199]
ds_read_b128 v[64:67],v20 offset:12288
v_mfma_f32_16x16x32_bf16 v[204:207],v[68:71],a[144:147],v[204:207]
s_waitcnt lgkmcnt(2)
v_mfma_f32_16x16x32_bf16 v[192:195],a[20:23],v[72:75],v[192:195]
ds_read_b128 v[68:71],v20 offset:13312
v_mfma_f32_16x16x32_bf16 v[200:203],v[72:75],a[148:151],v[200:203]
s_waitcnt lgkmcnt(2)
v_mfma_f32_16x16x32_bf16 v[196:199],a[20:23],v[76:79],v[196:199]
ds_read_b128 v[72:75],v20 offset:14336
v_mfma_f32_16x16x32_bf16 v[204:207],v[76:79],a[148:151],v[204:207]
s_waitcnt lgkmcnt(2)
v_mfma_f32_16x16x32_bf16 v[192:195],a[24:27],v[64:67],v[192:195]
ds_read_b128 v[76:79],v20 offset:15360
v_mfma_f32_16x16x32_bf16 v[200:203],v[64:67],a[152:155],v[200:203]
s_waitcnt lgkmcnt(2)
v_mfma_f32_16x16x32_bf16 v[196:199],a[24:27],v[68:71],v[196:199]
ds_read_b128 v[64:67],v20 offset:16384
v_mfma_f32_16x16x32_bf16 v[204:207],v[68:71],a[152:155],v[204:207]
s_waitcnt lgkmcnt(2)
v_mfma_f32_16x16x32_bf16 v[192:195],a[28:31],v[72:75],v[192:195]
ds_read_b128 v[68:71],v20 offset:17408
v_mfma_f32_16x16x32_bf16 v[200:203],v[72:75],a[156:159],v[200:203]
s_waitcnt lgkmcnt(2)
v_mfma_f32_16x16x32_bf16 v[196:199],a[28:31],v[76:79],v[196:199]
ds_read_b128 v[72:75],v20 offset:18432
v_mfma_f32_16x16x32_bf16 v[204:207],v[76:79],a[156:159],v[204:207]
s_waitcnt lgkmcnt(2)
v_mfma_f32_16x16x32_bf16 v[192:195],a[32:35],v[64:67],v[192:195]
ds_read_b128 v[76:79],v20 offset:19456
v_mfma_f32_16x16x32_bf16 v[200:203],v[64:67],a[160:163],v[200:203]
s_waitcnt lgkmcnt(2)
v_mfma_f32_16x16x32_bf16 v[196:199],a[32:35],v[68:71],v[196:199]
ds_read_b128 v[64:67],v20 offset:20480
v_mfma_f32_16x16x32_bf16 v[204:207],v[68:71],a[160:163],v[204:207]
s_waitcnt lgkmcnt(2)
v_mfma_f32_16x16x32_bf16 v[192:195],a[36:39],v[72:75],v[192:195]
ds_read_b128 v[68:71],v20 offset:21504
v_mfma_f32_16x16x32_bf16 v[200:203],v[72:75],a[164:167],v[200:203]
s_waitcnt lgkmcnt(2)
v_mfma_f32_16x16x32_bf16 v[196:199],a[36:39],v[76:79],v[196:199]
ds_read_b128 v[72:75],v20 offset:22528
v_mfma_f32_16x16x32_bf16 v[204:207],v[76:79],a[164:167],v[204:207]
s_waitcnt lgkmcnt(2)
v_mfma_f32_16x16x32_bf16 v[192:195],a[40:43],v[64:67],v[192:195]
ds_read_b128 v[76:79],v20 offset:23552
v_mfma_f32_16x16x32_bf16 v[200:203],v[64:67],a[168:171],v[200:203]
s_waitcnt lgkmcnt(2)
v_mfma_f32_16x16x32_bf16 v[196:199],a[40:43],v[68:71],v[196:199]
ds_read_b128 v[64:67],v20 offset:24576
v_mfma_f32_16x16x32_bf16 v[204:207],v[68:71],a[168:171],v[204:207]
s_waitcnt lgkmcnt(2)
v_mfma_f32_16x16x32_bf16 v[192:195],a[44:47],v[72:75],v[192:195]
ds_read_b128 v[68:71],v20 offset:25600
v_mfma_f32_16x16x32_bf16 v[200:203],v[72:75],a[172:175],v[200:203]
s_waitcnt lgkmcnt(2)
v_mfma_f32_16x16x32_bf16 v[196:199],a[44:47],v[76:79],v[196:199]
ds_read_b128 v[72:75],v20 offset:26624
v_mfma_f32_16x16x32_bf16 v[204:207],v[76:79],a[172:175],v[204:207]
s_waitcnt lgkmcnt(2)
v_mfma_f32_16x16x32_bf16 v[192:195],a[48:51],v[64:67],v[192:195]
ds_read_b128 v[76:79],v20 offset:27648
v_mfma_f32_16x16x32_bf16 v[200:203],v[64:67],a[176:179],v[200:203]
s_waitcnt lgkmcnt(2)
v_mfma_f32_16x16x32_bf16 v[196:199],a[48:51],v[68:71],v[196:199]
ds_read_b128 v[64:67],v20 offset:28672
v_mfma_f32_16x16x32_bf16 v[204:207],v[68:71],a[176:179],v[204:207]
s_waitcnt lgkmcnt(2)
v_mfma_f32_16x16x32_bf16 v[192:195],a[52:55],v[72:75],v[192:195]
ds_read_b128 v[68:71],v20 offset:29696
v_mfma_f32_16x16x32_bf16 v[200:203],v[72:75],a[180:183],v[200:203]
s_waitcnt lgkmcnt(2)
v_mfma_f32_16x16x32_bf16 v[196:199],a[52:55],v[76:79],v[196:199]
ds_read_b128 v[72:75],v20 offset:30720
v_mfma_f32_16x16x32_bf16 v[204:207],v[76:79],a[180:183],v[204:207]
s_waitcnt lgkmcnt(2)
v_mfma_f32_16x16x32_bf16 v[192:195],a[56:59],v[64:67],v[192:195]
ds_read_b128 v[76:79],v20 offset:31744
v_mfma_f32_16x16x32_bf16 v[200:203],v[64:67],a[184:187],v[200:203]
s_waitcnt lgkmcnt(2)
v_mfma_f32_16x16x32_bf16 v[196:199],a[56:59],v[68:71],v[196:199]
ds_read_b128 v[64:67],v20 offset:32768
v_mfma_f32_16x16x32_bf16 v[204:207],v[68:71],a[184:187],v[204:207]
s_waitcnt lgkmcnt(2)
v_mfma_f32_16x16x32_bf16 v[192:195],a[60:63],v[72:75],v[192:195]
ds_read_b128 v[68:71],v20 offset:33792
v_mfma_f32_16x16x32_bf16 v[200:203],v[72:75],a[188:191],v[200:203]
s_waitcnt lgkmcnt(2)
v_mfma_f32_16x16x32_bf16 v[196:199],a[60:63],v[76:79],v[196:199]
ds_read_b128 v[72:75],v20 offset:34816
v_mfma_f32_16x16x32_bf16 v[204:207],v[76:79],a[188:191],v[204:207]
s_waitcnt lgkmcnt(2)
v_mfma_f32_16x16x32_bf16 v[192:195],a[64:67],v[64:67],v[192:195]
ds_read_b128 v[76:79],v20 offset:35840
v_mfma_f32_16x16x32_bf16 v[200:203],v[64:67],a[192:195],v[200:203]
s_waitcnt lgkmcnt(2)
v_mfma_f32_16x16x32_bf16 v[196:199],a[64:67],v[68:71],v[196:199]
ds_read_b128 v[64:67],v20 offset:36864
v_mfma_f32_16x16x32_bf16 v[204:207],v[68:71],a[192:195],v[204:207]
s_waitcnt lgkmcnt(2)
v_mfma_f32_16x16x32_bf16 v[192:195],a[68:71],v[72:75],v[192:195]
ds_read_b128 v[68:71],v20 offset:37888
v_mfma_f32_16x16x32_bf16 v[200:203],v[72:75],a[196:199],v[200:203]
s_waitcnt lgkmcnt(2)
v_mfma_f32_16x16x32_bf16 v[196:199],a[68:71],v[76:79],v[196:199]
ds_read_b128 v[72:75],v20 offset:38912
v_mfma_f32_16x16x32_bf16 v[204:207],v[76:79],a[196:199],v[204:207]
s_waitcnt lgkmcnt(2)
v_mfma_f32_16x16x32_bf16 v[192:195],a[72:75],v[64:67],v[192:195]
ds_read_b128 v[76:79],v20 offset:39936
v_mfma_f32_16x16x32_bf16 v[200:203],v[64:67],a[200:203],v[200:203]
s_waitcnt lgkmcnt(2)
v_mfma_f32_16x16x32_bf16 v[196:199],a[72:75],v[68:71],v[196:199]
ds_read_b128 v[64:67],v20 offset:40960
v_mfma_f32_16x16x32_bf16 v[204:207],v[68:71],a[200:203],v[204:207]
s_waitcnt lgkmcnt(2)
v_mfma_f32_16x16x32_bf16 v[192:195],a[76:79],v[72:75],v[192:195]
ds_read_b128 v[68:71],v20 offset:41984
v_mfma_f32_16x16x32_bf16 v[200:203],v[72:75],a[204:207],v[200:203]
s_waitcnt lgkmcnt(2)
v_mfma_f32_16x16x32_bf16 v[196:199],a[76:79],v[76:79],v[196:199]
ds_read_b128 v[72:75],v20 offset:43008
v_mfma_f32_16x16x32_bf16 v[204:207],v[76:79],a[204:207],v[204:207]
s_waitcnt lgkmcnt(2)
v_mfma_f32_16x16x32_bf16 v[192:195],a[80:83],v[64:67],v[192:195]
ds_read_b128 v[76:79],v20 offset:44032
v_mfma_f32_16x16x32_bf16 v[200:203],v[64:67],a[208:211],v[200:203]
s_waitcnt lgkmcnt(2)
v_mfma_f32_16x16x32_bf16 v[196:199],a[80:83],v[68:71],v[196:199]
ds_read_b128 v[64:67],v20 offset:45056
v_mfma_f32_16x16x32_bf16 v[204:207],v[68:71],a[208:211],v[204:207]
s_waitcnt lgkmcnt(2)
v_mfma_f32_16x16x32_bf16 v[192:195],a[84:87],v[72:75],v[192:195]
ds_read_b128 v[68:71],v20 offset:46080
v_mfma_f32_16x16x32_bf16 v[200:203],v[72:75],a[212:215],v[200:203]
s_waitcnt lgkmcnt(2)
v_mfma_f32_16x16x32_bf16 v[196:199],a[84:87],v[76:79],v[196:199]
ds_read_b128 v[72:75],v20 offset:47104
v_mfma_f32_16x16x32_bf16 v[204:207],v[76:79],a[212:215],v[204:207]
s_waitcnt lgkmcnt(2)
v_mfma_f32_16x16x32_bf16 v[192:195],a[88:91],v[64:67],v[192:195]
ds_read_b128 v[76:79],v20 offset:48128
v_mfma_f32_16x16x32_bf16 v[200:203],v[64:67],a[216:219],v[200:203]
s_waitcnt lgkmcnt(2)
v_mfma_f32_16x16x32_bf16 v[196:199],a[88:91],v[68:71],v[196:199]
ds_read_b128 v[64:67],v20 offset:49152
v_mfma_f32_16x16x32_bf16 v[204:207],v[68:71],a[216:219],v[204:207]
s_waitcnt lgkmcnt(2)
v_mfma_f32_16x16x32_bf16 v[192:195],a[92:95],v[72:75],v[192:195]
ds_read_b128 v[68:71],v20 offset:50176
v_mfma_f32_16x16x32_bf16 v[200:203],v[72:75],a[220:223],v[200:203]
s_waitcnt lgkmcnt(2)
v_mfma_f32_16x16x32_bf16 v[196:199],a[92:95],v[76:79],v[196:199]
ds_read_b128 v[72:75],v20 offset:51200
v_mfma_f32_16x16x32_bf16 v[204:207],v[76:79],a[220:223],v[204:207]
s_waitcnt lgkmcnt(2)
v_mfma_f32_16x16x32_bf16 v[192:195],a[96:99],v[64:67],v[192:195]
ds_read_b128 v[76:79],v20 offset:52224
v_mfma_f32_16x16x32_bf16 v[200:203],v[64:67],a[224:227],v[200:203]
s_waitcnt lgkmcnt(2)
v_mfma_f32_16x16x32_bf16 v[196:199],a[96:99],v[68:71],v[196:199]
ds_read_b128 v[64:67],v20 offset:53248
v_mfma_f32_16x16x32_bf16 v[204:207],v[68:71],a[224:227],v[204:207]
s_waitcnt lgkmcnt(2)
v_mfma_f32_16x16x32_bf16 v[192:195],a[100:103],v[72:75],v[192:195]
ds_read_b128 v[68:71],v20 offset:54272
v_mfma_f32_16x16x32_bf16 v[200:203],v[72:75],a[228:231],v[200:203]
s_waitcnt lgkmcnt(2)
v_mfma_f32_16x16x32_bf16 v[196:199],a[100:103],v[76:79],v[196:199]
ds_read_b128 v[72:75],v20 offset:55296
v_mfma_f32_16x16x32_bf16 v[204:207],v[76:79],a[228:231],v[204:207]
s_waitcnt lgkmcnt(2)
v_mfma_f32_16x16x32_bf16 v[192:195],a[104:107],v[64:67],v[192:195]
ds_read_b128 v[76:79],v20 offset:56320
v_mfma_f32_16x16x32_bf16 v[200:203],v[64:67],a[232:235],v[200:203]
s_waitcnt lgkmcnt(2)
v_mfma_f32_16x16x32_bf16 v[196:199],a[104:107],v[68:71],v[196:199]
ds_read_b128 v[64:67],v20 offset:57344
v_mfma_f32_16x16x32_bf16 v[204:207],v[68:71],a[232:235],v[204:207]
s_waitcnt lgkmcnt(2)
v_mfma_f32_16x16x32_bf16 v[192:195],a[108:111],v[72:75],v[192:195]
ds_read_b128 v[68:71],v20 offset:58368
v_mfma_f32_16x16x32_bf16 v[200:203],v[72:75],a[236:239],v[200:203]
s_waitcnt lgkmcnt(2)
v_mfma_f32_16x16x32_bf16 v[196:199],a[108:111],v[76:79],v[196:199]
ds_read_b128 v[72:75],v20 offset:59392
v_mfma_f32_16x16x32_bf16 v[204:207],v[76:79],a[236:239],v[204:207]
s_waitcnt lgkmcnt(2)
v_mfma_f32_16x16x32_bf16 v[192:195],a[112:115],v[64:67],v[192:195]
ds_read_b128 v[76:79],v20 offset:60416
v_mfma_f32_16x16x32_bf16 v[200:203],v[64:67],a[240:243],v[200:203]
s_waitcnt lgkmcnt(2)
v_mfma_f32_16x16x32_bf16 v[196:199],a[112:115],v[68:71],v[196:199]
ds_read_b128 v[64:67],v20 offset:61440
v_mfma_f32_16x16x32_bf16 v[204:207],v[68:71],a[240:243],v[204:207]
s_waitcnt lgkmcnt(2)
v_mfma_f32_16x16x32_bf16 v[192:195],a[116:119],v[72:75],v[192:195]
ds_read_b128 v[68:71],v20 offset:62464
v_mfma_f32_16x16x32_bf16 v[200:203],v[72:75],a[244:247],v[200:203]
s_waitcnt lgkmcnt(2)
v_mfma_f32_16x16x32_bf16 v[196:199],a[116:119],v[76:79],v[196:199]
ds_read_b128 v[72:75],v20 offset:63488
v_mfma_f32_16x16x32_bf16 v[204:207],v[76:79],a[244:247],v[204:207]
s_waitcnt lgkmcnt(2)
v_mfma_f32_16x16x32_bf16 v[192:195],a[120:123],v[64:67],v[192:195]
ds_read_b128 v[76:79],v20 offset:64512
v_mfma_f32_16x16x32_bf16 v[200:203],v[64:67],a[248:251],v[200:203]
s_waitcnt lgkmcnt(2)
v_mfma_f32_16x16x32_bf16 v[196:199],a[120:123],v[68:71],v[196:199]
v_mfma_f32_16x16x32_bf16 v[204:207],v[68:71],a[248:251],v[204:207]
s_waitcnt lgkmcnt(1)
v_mfma_f32_16x16x32_bf16 v[192:195],a[124:127],v[72:75],v[192:195]
v_mfma_f32_16x16x32_bf16 v[200:203],v[72:75],a[252:255],v[200:203]
s_waitcnt lgkmcnt(0)
v_mfma_f32_16x16x32_bf16 v[196:199],a[124:127],v[76:79],v[196:199]
v_mfma_f32_16x16x32_bf16 v[204:207],v[76:79],a[252:255],v[204:207]
v_xor_b32 v20,0x10000,v20
s_xor_b32 s62,s62,0x10000
s_lshr_b32 s64,s73,9
v_add_u32 v22,s64,v24
v_cvt_pk_bf16_f32 v208,v192,v193
v_cvt_pk_bf16_f32 v209,v194,v195
s_nop 0
v_cvt_pk_bf16_f32 v210,v196,v197
v_cvt_pk_bf16_f32 v211,v198,v199
v_cvt_pk_bf16_f32 v212,v200,v201
v_cvt_pk_bf16_f32 v213,v202,v203
v_cvt_pk_bf16_f32 v214,v204,v205
v_cvt_pk_bf16_f32 v215,v206,v207
v_permlane16_swap_b32 v208,v210
v_permlane16_swap_b32 v209,v211
buffer_store_dwordx4 v[208:211],v2,s[24:27],s73 offen
buffer_store_dwordx4 v[208:211],v2,s[28:31],s73 offen sc1
ds_write_b128 v22,v[212:215] offset:16384
buffer_store_dwordx4 v[208:211],v17,s[20:23],s12 offen sc1
bgx_134:
s_add_u32 s63,s79,1
s_and_b32 s64,s63,3
s_lshl_b32 s70,s64,20
s_add_u32 s65,s63,2
s_and_b32 s65,s65,3
s_lshl_b32 s73,s65,20
s_add_u32 s55,s63,3
s_lshl_b32 s78,s55,16
s_add_u32 s78,s78,57344
s_cmp_lt_u32 s55,64
s_cselect_b32 s78,s78,0x7fff0000
s_add_u32 s60,s63,1
s_lshl_b32 s76,s60,21
s_lshl_b32 s55,s60,13
s_and_b32 s55,s55,0x2000
s_xor_b32 s55,s55,s61
s_add_u32 s76,s76,s55
s_cmp_lt_u32 s60,64
s_cselect_b32 s76,s76,0x7fff0000
s_add_u32 s60,s63,2
s_lshl_b32 s12,s60,21
s_lshl_b32 s55,s60,13
s_and_b32 s55,s55,0x2000
s_xor_b32 s55,s55,s61
s_add_u32 s12,s12,s55
s_cmp_lt_u32 s60,64
s_cselect_b32 s12,s12,0x7fff0000
s_add_u32 s71,s73,65536
v_mov_b32 v176,0
v_mov_b32 v177,0
v_mov_b32 v178,0
v_mov_b32 v179,0
v_mov_b32 v180,0
v_mov_b32 v181,0
v_mov_b32 v182,0
v_mov_b32 v183,0
s_add_u32 s79,s79,1
s_cmp_eq_u32 s79,0
s_cbranch_scc1 pn2_133
v_mov_b32 v38,1
ds_write_b32 v37,v38 offset:8
buffer_store_dwordx4 v[212:215],v12,s[20:23],s76 offen sc1
s_waitcnt lgkmcnt(0)
s_branch pn1_132
pn2_133:
v_mov_b32 v25,1
s_waitcnt vmcnt(1) lgkmcnt(0)
s_barrier
s_branch loop_124
w2_60:
s_lshr_b32 s64,s57,2
s_add_u32 s64,s64,64
s_lshl_b32 s64,s64,14
s_add_u32 s64,s64,s68
s_add_u32 s64,s64,29361152
v_add_u32 v12,s64,v16
v_and_b32 v22,1,v4
v_lshrrev_b32 v23,1,v4
v_lshl_add_u32 v22,v22,1,v23
v_lshlrev_b32 v22,2,v22
v_lshl_add_u32 v22,v3,4,v22
v_add_u32 v31,155904,v22
s_branch first_135
loop_136:
s_barrier
buffer_load_dword v248,v18,s[20:23],s70 offen offset:0 sc1
s_nop 15
s_nop 5
hl_138:
buffer_load_dword v249,v18,s[20:23],s70 offen offset:0 sc1
s_waitcnt vmcnt(1)
v_cmp_eq_u32 vcc,v25,v248
s_bcnt1_i32_b32 s64,vcc_lo
s_cmp_ge_u32 s64,8
s_cbranch_scc1 hg_139
buffer_load_dword v248,v18,s[20:23],s70 offen offset:0 sc1
s_waitcnt vmcnt(1)
v_cmp_eq_u32 vcc,v25,v249
s_bcnt1_i32_b32 s64,vcc_lo
s_cmp_ge_u32 s64,8
s_cbranch_scc1 hg_139
s_sub_u32 s90,s90,1
s_cmp_gt_i32 s90,0
s_cbranch_scc1 hl_138
hg_139:
buffer_load_dwordx4 v[64:67],v28,s[20:23],s70 offen offset:0 sc1
buffer_load_dwordx4 v[68:71],v28,s[20:23],s70 offen offset:1024 sc1
buffer_load_dwordx4 v[72:75],v28,s[20:23],s70 offen offset:2048 sc1
buffer_load_dwordx4 v[76:79],v28,s[20:23],s70 offen offset:3072 sc1
s_waitcnt vmcnt(3)
ds_write_b128 v24,v[64:67] offset:8192
v_min3_u32 v22,v64,v65,v66
v_min_u32 v22,v22,v67
s_waitcnt vmcnt(2)
ds_write_b128 v24,v[68:71] offset:9216
v_min3_u32 v22,v22,v68,v69
v_min3_u32 v22,v22,v70,v71
s_waitcnt vmcnt(1)
ds_write_b128 v24,v[72:75] offset:10240
v_min3_u32 v22,v22,v72,v73
v_min3_u32 v22,v22,v74,v75
s_waitcnt vmcnt(0)
ds_write_b128 v24,v[76:79] offset:11264
v_min3_u32 v22,v22,v76,v77
v_min3_u32 v22,v22,v78,v79
v_cmp_eq_u32 vcc,0,v22
s_cbranch_vccnz art_140
abk_141:
v_smfmac_f32_16x16x64_bf16 v[176:179],v[64:67],a[64:71],v14
s_waitcnt lgkmcnt(0)
s_barrier
ds_read_b128 v[80:83],v24 offset:12288
ds_read_b128 v[84:87],v24 offset:13312
ds_read_b128 v[88:91],v24 offset:14336
ds_read_b128 v[92:95],v24 offset:15360
buffer_store_dwordx4 v[212:215],v12,s[20:23],s76 offen sc1
v_smfmac_f32_16x16x64_bf16 v[176:179],v[68:71],a[72:79],v14
ds_read_b128 v[32:35],v24 offset:0
ds_read_b128 v[36:39],v24 offset:1024
v_smfmac_f32_16x16x64_bf16 v[176:179],v[72:75],a[80:87],v14
ds_read_b128 v[40:43],v24 offset:2048
ds_read_b128 v[44:47],v24 offset:3072
v_smfmac_f32_16x16x64_bf16 v[176:179],v[76:79],a[88:95],v14
ds_read_b128 v[48:51],v24 offset:4096
ds_read_b128 v[52:55],v24 offset:5120
s_waitcnt lgkmcnt(9)
v_smfmac_f32_16x16x64_bf16 v[176:179],v[80:83],a[96:103],v14
ds_read_b128 v[56:59],v24 offset:6144
s_waitcnt lgkmcnt(9)
v_smfmac_f32_16x16x64_bf16 v[176:179],v[84:87],a[104:111],v14
ds_read_b128 v[60:63],v24 offset:7168
s_waitcnt lgkmcnt(9)
v_smfmac_f32_16x16x64_bf16 v[176:179],v[88:91],a[112:119],v14
s_waitcnt lgkmcnt(8)
v_smfmac_f32_16x16x64_bf16 v[176:179],v[92:95],a[120:127],v14
s_waitcnt lgkmcnt(7)
v_smfmac_f32_16x16x64_bf16 v[176:179],v[32:35],a[0:7],v14
s_waitcnt lgkmcnt(6)
v_smfmac_f32_16x16x64_bf16 v[176:179],v[36:39],a[8:15],v14
s_waitcnt lgkmcnt(5)
v_smfmac_f32_16x16x64_bf16 v[176:179],v[40:43],a[16:23],v14
s_waitcnt lgkmcnt(4)
v_smfmac_f32_16x16x64_bf16 v[176:179],v[44:47],a[24:31],v14
s_waitcnt lgkmcnt(3)
v_smfmac_f32_16x16x64_bf16 v[176:179],v[48:51],a[32:39],v14
s_waitcnt lgkmcnt(2)
v_smfmac_f32_16x16x64_bf16 v[176:179],v[52:55],a[40:47],v14
s_waitcnt lgkmcnt(1)
v_smfmac_f32_16x16x64_bf16 v[176:179],v[56:59],a[48:55],v14
s_waitcnt lgkmcnt(0)
v_smfmac_f32_16x16x64_bf16 v[176:179],v[60:63],a[56:63],v14
v_smfmac_f32_16x16x64_bf16 v[180:183],v[32:35],a[128:135],v14
v_smfmac_f32_16x16x64_bf16 v[180:183],v[36:39],a[136:143],v14
s_nop 5
v_permlane32_swap_b32 v176,v178
v_permlane32_swap_b32 v177,v179
v_add_f32 v176,v176,v178
v_add_f32 v177,v177,v179
v_cvt_pk_bf16_f32 v216,v176,v177
s_nop 1
v_mov_b32_dpp v217,v216 quad_perm:[1,0,3,2] row_mask:0xf bank_mask:0xf
v_perm_b32 v216,v217,v216,v15
v_max_u32 v216,1,v216
buffer_store_dword v216,v19,s[24:27],s70 offen
buffer_store_dword v216,v19,s[28:31],s70 offen sc1
v_smfmac_f32_16x16x64_bf16 v[180:183],v[40:43],a[144:151],v14
v_smfmac_f32_16x16x64_bf16 v[180:183],v[44:47],a[152:159],v14
v_smfmac_f32_16x16x64_bf16 v[180:183],v[48:51],a[160:167],v14
v_smfmac_f32_16x16x64_bf16 v[180:183],v[52:55],a[168:175],v14
v_smfmac_f32_16x16x64_bf16 v[180:183],v[56:59],a[176:183],v14
v_smfmac_f32_16x16x64_bf16 v[180:183],v[60:63],a[184:191],v14
v_smfmac_f32_16x16x64_bf16 v[180:183],v[64:67],a[192:199],v14
v_smfmac_f32_16x16x64_bf16 v[180:183],v[68:71],a[200:207],v14
v_smfmac_f32_16x16x64_bf16 v[180:183],v[72:75],a[208:215],v14
v_smfmac_f32_16x16x64_bf16 v[180:183],v[76:79],a[216:223],v14
v_smfmac_f32_16x16x64_bf16 v[180:183],v[80:83],a[224:231],v14
v_smfmac_f32_16x16x64_bf16 v[180:183],v[84:87],a[232:239],v14
v_smfmac_f32_16x16x64_bf16 v[180:183],v[88:91],a[240:247],v14
v_smfmac_f32_16x16x64_bf16 v[180:183],v[92:95],a[248:255],v14
s_nop 7
v_permlane32_swap_b32 v180,v182
v_permlane32_swap_b32 v181,v183
v_add_f32 v180,v180,v182
v_add_f32 v181,v181,v183
v_cvt_pk_bf16_f32 v216,v180,v181
v_max_u32 v216,1,v216
ds_write_b32 v31,v216
ds_write_b32 v21,v25 offset:4
s_cmp_eq_u32 s79,63
s_cbranch_scc1 end_57
s_cmp_ge_i32 s79,62
s_cbranch_scc1 bgsk_143
ds_read_b128 v[64:67],v20 offset:0
ds_read_b128 v[68:71],v20 offset:1024
ds_read_b128 v[72:75],v20 offset:2048
s_waitcnt lgkmcnt(2)
v_mfma_f32_16x16x32_bf16 v[192:195],a[0:3],v[64:67],0
ds_read_b128 v[76:79],v20 offset:3072
v_mfma_f32_16x16x32_bf16 v[200:203],v[64:67],a[128:131],0
s_waitcnt lgkmcnt(2)
v_mfma_f32_16x16x32_bf16 v[196:199],a[0:3],v[68:71],0
ds_read_b128 v[64:67],v20 offset:4096
v_mfma_f32_16x16x32_bf16 v[204:207],v[68:71],a[128:131],0
s_waitcnt lgkmcnt(2)
v_mfma_f32_16x16x32_bf16 v[192:195],a[4:7],v[72:75],v[192:195]
ds_read_b128 v[68:71],v20 offset:5120
v_mfma_f32_16x16x32_bf16 v[200:203],v[72:75],a[132:135],v[200:203]
s_waitcnt lgkmcnt(2)
v_mfma_f32_16x16x32_bf16 v[196:199],a[4:7],v[76:79],v[196:199]
ds_read_b128 v[72:75],v20 offset:6144
v_mfma_f32_16x16x32_bf16 v[204:207],v[76:79],a[132:135],v[204:207]
s_waitcnt lgkmcnt(2)
v_mfma_f32_16x16x32_bf16 v[192:195],a[8:11],v[64:67],v[192:195]
ds_read_b128 v[76:79],v20 offset:7168
v_mfma_f32_16x16x32_bf16 v[200:203],v[64:67],a[136:139],v[200:203]
s_waitcnt lgkmcnt(2)
v_mfma_f32_16x16x32_bf16 v[196:199],a[8:11],v[68:71],v[196:199]
ds_read_b128 v[64:67],v20 offset:8192
v_mfma_f32_16x16x32_bf16 v[204:207],v[68:71],a[136:139],v[204:207]
s_waitcnt lgkmcnt(2)
v_mfma_f32_16x16x32_bf16 v[192:195],a[12:15],v[72:75],v[192:195]
ds_read_b128 v[68:71],v20 offset:9216
v_mfma_f32_16x16x32_bf16 v[200:203],v[72:75],a[140:143],v[200:203]
s_waitcnt lgkmcnt(2)
v_mfma_f32_16x16x32_bf16 v[196:199],a[12:15],v[76:79],v[196:199]
ds_read_b128 v[72:75],v20 offset:10240
v_mfma_f32_16x16x32_bf16 v[204:207],v[76:79],a[140:143],v[204:207]
s_add_u32 m0,s62,16384
s_add_u32 s69,s78,16384
s_waitcnt lgkmcnt(2)
v_mfma_f32_16x16x32_bf16 v[192:195],a[16:19],v[64:67],v[192:195]
ds_read_b128 v[76:79],v20 offset:11264
v_mfma_f32_16x16x32_bf16 v[200:203],v[64:67],a[144:147],v[200:203]
buffer_load_dwordx4 v16,s[20:23],s69 offen offset:0 lds
s_waitcnt lgkmcnt(2)
v_mfma_f32_16x16x32_bf16 v[196:199],a[16:19],v[68:71],v[196:199]
ds_read_b128 v[64:67],v20 offset:12288
v_mfma_f32_16x16x32_bf16 v[204:207],v[68:71],a[144:147],v[204:207]
buffer_load_dwordx4 v16,s[20:23],s69 offen offset:1024 lds
s_waitcnt lgkmcnt(2)
v_mfma_f32_16x16x32_bf16 v[192:195],a[20:23],v[72:75],v[192:195]
ds_read_b128 v[68:71],v20 offset:13312
v_mfma_f32_16x16x32_bf16 v[200:203],v[72:75],a[148:151],v[200:203]
buffer_load_dwordx4 v16,s[20:23],s69 offen offset:2048 lds
s_waitcnt lgkmcnt(2)
v_mfma_f32_16x16x32_bf16 v[196:199],a[20:23],v[76:79],v[196:199]
ds_read_b128 v[72:75],v20 offset:14336
v_mfma_f32_16x16x32_bf16 v[204:207],v[76:79],a[148:151],v[204:207]
buffer_load_dwordx4 v16,s[20:23],s69 offen offset:3072 lds
s_waitcnt lgkmcnt(2)
v_mfma_f32_16x16x32_bf16 v[192:195],a[24:27],v[64:67],v[192:195]
ds_read_b128 v[76:79],v20 offset:15360
v_mfma_f32_16x16x32_bf16 v[200:203],v[64:67],a[152:155],v[200:203]
s_add_u32 m0,s62,20480
s_add_u32 s69,s78,20480
s_waitcnt lgkmcnt(2)
v_mfma_f32_16x16x32_bf16 v[196:199],a[24:27],v[68:71],v[196:199]
ds_read_b128 v[64:67],v20 offset:16384
v_mfma_f32_16x16x32_bf16 v[204:207],v[68:71],a[152:155],v[204:207]
buffer_load_dwordx4 v16,s[20:23],s69 offen offset:0 lds
s_waitcnt lgkmcnt(2)
v_mfma_f32_16x16x32_bf16 v[192:195],a[28:31],v[72:75],v[192:195]
ds_read_b128 v[68:71],v20 offset:17408
v_mfma_f32_16x16x32_bf16 v[200:203],v[72:75],a[156:159],v[200:203]
buffer_load_dwordx4 v16,s[20:23],s69 offen offset:1024 lds
s_waitcnt lgkmcnt(2)
v_mfma_f32_16x16x32_bf16 v[196:199],a[28:31],v[76:79],v[196:199]
ds_read_b128 v[72:75],v20 offset:18432
v_mfma_f32_16x16x32_bf16 v[204:207],v[76:79],a[156:159],v[204:207]
buffer_load_dwordx4 v16,s[20:23],s69 offen offset:2048 lds
s_waitcnt lgkmcnt(2)
v_mfma_f32_16x16x32_bf16 v[192:195],a[32:35],v[64:67],v[192:195]
ds_read_b128 v[76:79],v20 offset:19456
v_mfma_f32_16x16x32_bf16 v[200:203],v[64:67],a[160:163],v[200:203]
buffer_load_dwordx4 v16,s[20:23],s69 offen offset:3072 lds
s_waitcnt lgkmcnt(2)
v_mfma_f32_16x16x32_bf16 v[196:199],a[32:35],v[68:71],v[196:199]
ds_read_b128 v[64:67],v20 offset:20480
v_mfma_f32_16x16x32_bf16 v[204:207],v[68:71],a[160:163],v[204:207]
s_add_u32 m0,s62,24576
s_add_u32 s69,s78,24576
s_waitcnt lgkmcnt(2)
v_mfma_f32_16x16x32_bf16 v[192:195],a[36:39],v[72:75],v[192:195]
ds_read_b128 v[68:71],v20 offset:21504
v_mfma_f32_16x16x32_bf16 v[200:203],v[72:75],a[164:167],v[200:203]
buffer_load_dwordx4 v16,s[20:23],s69 offen offset:0 lds
s_waitcnt lgkmcnt(2)
v_mfma_f32_16x16x32_bf16 v[196:199],a[36:39],v[76:79],v[196:199]
ds_read_b128 v[72:75],v20 offset:22528
v_mfma_f32_16x16x32_bf16 v[204:207],v[76:79],a[164:167],v[204:207]
buffer_load_dwordx4 v16,s[20:23],s69 offen offset:1024 lds
s_waitcnt lgkmcnt(2)
v_mfma_f32_16x16x32_bf16 v[192:195],a[40:43],v[64:67],v[192:195]
ds_read_b128 v[76:79],v20 offset:23552
v_mfma_f32_16x16x32_bf16 v[200:203],v[64:67],a[168:171],v[200:203]
buffer_load_dwordx4 v16,s[20:23],s69 offen offset:2048 lds
s_waitcnt lgkmcnt(2)
v_mfma_f32_16x16x32_bf16 v[196:199],a[40:43],v[68:71],v[196:199]
ds_read_b128 v[64:67],v20 offset:24576
v_mfma_f32_16x16x32_bf16 v[204:207],v[68:71],a[168:171],v[204:207]
buffer_load_dwordx4 v16,s[20:23],s69 offen offset:3072 lds
s_waitcnt lgkmcnt(2)
v_mfma_f32_16x16x32_bf16 v[192:195],a[44:47],v[72:75],v[192:195]
ds_read_b128 v[68:71],v20 offset:25600
v_mfma_f32_16x16x32_bf16 v[200:203],v[72:75],a[172:175],v[200:203]
s_add_u32 m0,s62,28672
s_add_u32 s69,s78,28672
s_waitcnt lgkmcnt(2)
v_mfma_f32_16x16x32_bf16 v[196:199],a[44:47],v[76:79],v[196:199]
ds_read_b128 v[72:75],v20 offset:26624
v_mfma_f32_16x16x32_bf16 v[204:207],v[76:79],a[172:175],v[204:207]
buffer_load_dwordx4 v16,s[20:23],s69 offen offset:0 lds
s_waitcnt lgkmcnt(2)
v_mfma_f32_16x16x32_bf16 v[192:195],a[48:51],v[64:67],v[192:195]
ds_read_b128 v[76:79],v20 offset:27648
v_mfma_f32_16x16x32_bf16 v[200:203],v[64:67],a[176:179],v[200:203]
buffer_load_dwordx4 v16,s[20:23],s69 offen offset:1024 lds
s_waitcnt lgkmcnt(2)
v_mfma_f32_16x16x32_bf16 v[196:199],a[48:51],v[68:71],v[196:199]
ds_read_b128 v[64:67],v20 offset:28672
v_mfma_f32_16x16x32_bf16 v[204:207],v[68:71],a[176:179],v[204:207]
buffer_load_dwordx4 v16,s[20:23],s69 offen offset:2048 lds
s_waitcnt lgkmcnt(2)
v_mfma_f32_16x16x32_bf16 v[192:195],a[52:55],v[72:75],v[192:195]
ds_read_b128 v[68:71],v20 offset:29696
v_mfma_f32_16x16x32_bf16 v[200:203],v[72:75],a[180:183],v[200:203]
buffer_load_dwordx4 v16,s[20:23],s69 offen offset:3072 lds
s_waitcnt lgkmcnt(2)
v_mfma_f32_16x16x32_bf16 v[196:199],a[52:55],v[76:79],v[196:199]
ds_read_b128 v[72:75],v20 offset:30720
v_mfma_f32_16x16x32_bf16 v[204:207],v[76:79],a[180:183],v[204:207]
s_waitcnt lgkmcnt(2)
v_mfma_f32_16x16x32_bf16 v[192:195],a[56:59],v[64:67],v[192:195]
ds_read_b128 v[76:79],v20 offset:31744
v_mfma_f32_16x16x32_bf16 v[200:203],v[64:67],a[184:187],v[200:203]
s_waitcnt lgkmcnt(2)
v_mfma_f32_16x16x32_bf16 v[196:199],a[56:59],v[68:71],v[196:199]
ds_read_b128 v[64:67],v20 offset:32768
v_mfma_f32_16x16x32_bf16 v[204:207],v[68:71],a[184:187],v[204:207]
s_waitcnt lgkmcnt(2)
v_mfma_f32_16x16x32_bf16 v[192:195],a[60:63],v[72:75],v[192:195]
ds_read_b128 v[68:71],v20 offset:33792
v_mfma_f32_16x16x32_bf16 v[200:203],v[72:75],a[188:191],v[200:203]
s_waitcnt lgkmcnt(2)
v_mfma_f32_16x16x32_bf16 v[196:199],a[60:63],v[76:79],v[196:199]
ds_read_b128 v[72:75],v20 offset:34816
v_mfma_f32_16x16x32_bf16 v[204:207],v[76:79],a[188:191],v[204:207]
s_waitcnt lgkmcnt(2)
v_mfma_f32_16x16x32_bf16 v[192:195],a[64:67],v[64:67],v[192:195]
ds_read_b128 v[76:79],v20 offset:35840
v_mfma_f32_16x16x32_bf16 v[200:203],v[64:67],a[192:195],v[200:203]
s_waitcnt lgkmcnt(2)
v_mfma_f32_16x16x32_bf16 v[196:199],a[64:67],v[68:71],v[196:199]
ds_read_b128 v[64:67],v20 offset:36864
v_mfma_f32_16x16x32_bf16 v[204:207],v[68:71],a[192:195],v[204:207]
s_waitcnt lgkmcnt(2)
v_mfma_f32_16x16x32_bf16 v[192:195],a[68:71],v[72:75],v[192:195]
ds_read_b128 v[68:71],v20 offset:37888
v_mfma_f32_16x16x32_bf16 v[200:203],v[72:75],a[196:199],v[200:203]
s_waitcnt lgkmcnt(2)
v_mfma_f32_16x16x32_bf16 v[196:199],a[68:71],v[76:79],v[196:199]
ds_read_b128 v[72:75],v20 offset:38912
v_mfma_f32_16x16x32_bf16 v[204:207],v[76:79],a[196:199],v[204:207]
s_waitcnt lgkmcnt(2)
v_mfma_f32_16x16x32_bf16 v[192:195],a[72:75],v[64:67],v[192:195]
ds_read_b128 v[76:79],v20 offset:39936
v_mfma_f32_16x16x32_bf16 v[200:203],v[64:67],a[200:203],v[200:203]
s_waitcnt lgkmcnt(2)
v_mfma_f32_16x16x32_bf16 v[196:199],a[72:75],v[68:71],v[196:199]
ds_read_b128 v[64:67],v20 offset:40960
v_mfma_f32_16x16x32_bf16 v[204:207],v[68:71],a[200:203],v[204:207]
s_waitcnt lgkmcnt(2)
v_mfma_f32_16x16x32_bf16 v[192:195],a[76:79],v[72:75],v[192:195]
ds_read_b128 v[68:71],v20 offset:41984
v_mfma_f32_16x16x32_bf16 v[200:203],v[72:75],a[204:207],v[200:203]
s_waitcnt lgkmcnt(2)
v_mfma_f32_16x16x32_bf16 v[196:199],a[76:79],v[76:79],v[196:199]
ds_read_b128 v[72:75],v20 offset:43008
v_mfma_f32_16x16x32_bf16 v[204:207],v[76:79],a[204:207],v[204:207]
s_waitcnt lgkmcnt(2)
v_mfma_f32_16x16x32_bf16 v[192:195],a[80:83],v[64:67],v[192:195]
ds_read_b128 v[76:79],v20 offset:44032
v_mfma_f32_16x16x32_bf16 v[200:203],v[64:67],a[208:211],v[200:203]
s_waitcnt lgkmcnt(2)
v_mfma_f32_16x16x32_bf16 v[196:199],a[80:83],v[68:71],v[196:199]
ds_read_b128 v[64:67],v20 offset:45056
v_mfma_f32_16x16x32_bf16 v[204:207],v[68:71],a[208:211],v[204:207]
s_waitcnt lgkmcnt(2)
v_mfma_f32_16x16x32_bf16 v[192:195],a[84:87],v[72:75],v[192:195]
ds_read_b128 v[68:71],v20 offset:46080
v_mfma_f32_16x16x32_bf16 v[200:203],v[72:75],a[212:215],v[200:203]
s_waitcnt lgkmcnt(2)
v_mfma_f32_16x16x32_bf16 v[196:199],a[84:87],v[76:79],v[196:199]
ds_read_b128 v[72:75],v20 offset:47104
v_mfma_f32_16x16x32_bf16 v[204:207],v[76:79],a[212:215],v[204:207]
s_waitcnt lgkmcnt(2)
v_mfma_f32_16x16x32_bf16 v[192:195],a[88:91],v[64:67],v[192:195]
ds_read_b128 v[76:79],v20 offset:48128
v_mfma_f32_16x16x32_bf16 v[200:203],v[64:67],a[216:219],v[200:203]
s_waitcnt lgkmcnt(2)
v_mfma_f32_16x16x32_bf16 v[196:199],a[88:91],v[68:71],v[196:199]
ds_read_b128 v[64:67],v20 offset:49152
v_mfma_f32_16x16x32_bf16 v[204:207],v[68:71],a[216:219],v[204:207]
s_waitcnt lgkmcnt(2)
v_mfma_f32_16x16x32_bf16 v[192:195],a[92:95],v[72:75],v[192:195]
ds_read_b128 v[68:71],v20 offset:50176
v_mfma_f32_16x16x32_bf16 v[200:203],v[72:75],a[220:223],v[200:203]
s_waitcnt lgkmcnt(2)
v_mfma_f32_16x16x32_bf16 v[196:199],a[92:95],v[76:79],v[196:199]
ds_read_b128 v[72:75],v20 offset:51200
v_mfma_f32_16x16x32_bf16 v[204:207],v[76:79],a[220:223],v[204:207]
s_waitcnt lgkmcnt(2)
v_mfma_f32_16x16x32_bf16 v[192:195],a[96:99],v[64:67],v[192:195]
ds_read_b128 v[76:79],v20 offset:52224
v_mfma_f32_16x16x32_bf16 v[200:203],v[64:67],a[224:227],v[200:203]
s_waitcnt lgkmcnt(2)
v_mfma_f32_16x16x32_bf16 v[196:199],a[96:99],v[68:71],v[196:199]
ds_read_b128 v[64:67],v20 offset:53248
v_mfma_f32_16x16x32_bf16 v[204:207],v[68:71],a[224:227],v[204:207]
s_waitcnt lgkmcnt(2)
v_mfma_f32_16x16x32_bf16 v[192:195],a[100:103],v[72:75],v[192:195]
ds_read_b128 v[68:71],v20 offset:54272
s_add_u32 m0,s62,43008
s_add_u32 s69,s78,43008
v_mfma_f32_16x16x32_bf16 v[200:203],v[72:75],a[228:231],v[200:203]
s_waitcnt lgkmcnt(2)
v_mfma_f32_16x16x32_bf16 v[196:199],a[100:103],v[76:79],v[196:199]
ds_read_b128 v[72:75],v20 offset:55296
buffer_load_dwordx4 v16,s[20:23],s69 offen offset:0 lds
v_mfma_f32_16x16x32_bf16 v[204:207],v[76:79],a[228:231],v[204:207]
s_waitcnt lgkmcnt(2)
v_mfma_f32_16x16x32_bf16 v[192:195],a[104:107],v[64:67],v[192:195]
ds_read_b128 v[76:79],v20 offset:56320
buffer_load_dwordx4 v16,s[20:23],s69 offen offset:1024 lds
v_mfma_f32_16x16x32_bf16 v[200:203],v[64:67],a[232:235],v[200:203]
s_waitcnt lgkmcnt(2)
v_mfma_f32_16x16x32_bf16 v[196:199],a[104:107],v[68:71],v[196:199]
ds_read_b128 v[64:67],v20 offset:57344
buffer_load_dwordx4 v16,s[20:23],s69 offen offset:2048 lds
v_mfma_f32_16x16x32_bf16 v[204:207],v[68:71],a[232:235],v[204:207]
s_waitcnt lgkmcnt(2)
v_mfma_f32_16x16x32_bf16 v[192:195],a[108:111],v[72:75],v[192:195]
ds_read_b128 v[68:71],v20 offset:58368
buffer_load_dwordx4 v16,s[20:23],s69 offen offset:3072 lds
v_mfma_f32_16x16x32_bf16 v[200:203],v[72:75],a[236:239],v[200:203]
s_waitcnt lgkmcnt(2)
v_mfma_f32_16x16x32_bf16 v[196:199],a[108:111],v[76:79],v[196:199]
ds_read_b128 v[72:75],v20 offset:59392
s_add_u32 m0,s62,47104
s_add_u32 s69,s78,47104
v_mfma_f32_16x16x32_bf16 v[204:207],v[76:79],a[236:239],v[204:207]
s_waitcnt lgkmcnt(2)
v_mfma_f32_16x16x32_bf16 v[192:195],a[112:115],v[64:67],v[192:195]
ds_read_b128 v[76:79],v20 offset:60416
buffer_load_dwordx4 v16,s[20:23],s69 offen offset:0 lds
v_mfma_f32_16x16x32_bf16 v[200:203],v[64:67],a[240:243],v[200:203]
s_waitcnt lgkmcnt(2)
v_mfma_f32_16x16x32_bf16 v[196:199],a[112:115],v[68:71],v[196:199]
ds_read_b128 v[64:67],v20 offset:61440
v_mfma_f32_16x16x32_bf16 v[204:207],v[68:71],a[240:243],v[204:207]
buffer_load_dwordx4 v16,s[20:23],s69 offen offset:1024 lds
s_waitcnt lgkmcnt(2)
v_mfma_f32_16x16x32_bf16 v[192:195],a[116:119],v[72:75],v[192:195]
ds_read_b128 v[68:71],v20 offset:62464
v_mfma_f32_16x16x32_bf16 v[200:203],v[72:75],a[244:247],v[200:203]
buffer_load_dwordx4 v16,s[20:23],s69 offen offset:2048 lds
s_waitcnt lgkmcnt(2)
v_mfma_f32_16x16x32_bf16 v[196:199],a[116:119],v[76:79],v[196:199]
ds_read_b128 v[72:75],v20 offset:63488
v_mfma_f32_16x16x32_bf16 v[204:207],v[76:79],a[244:247],v[204:207]
buffer_load_dwordx4 v16,s[20:23],s69 offen offset:3072 lds
s_waitcnt lgkmcnt(2)
v_mfma_f32_16x16x32_bf16 v[192:195],a[120:123],v[64:67],v[192:195]
ds_read_b128 v[76:79],v20 offset:64512
v_mfma_f32_16x16x32_bf16 v[200:203],v[64:67],a[248:251],v[200:203]
s_add_u32 m0,s62,51200
s_add_u32 s69,s78,51200
s_waitcnt lgkmcnt(2)
v_mfma_f32_16x16x32_bf16 v[196:199],a[120:123],v[68:71],v[196:199]
v_mfma_f32_16x16x32_bf16 v[204:207],v[68:71],a[248:251],v[204:207]
buffer_load_dwordx4 v16,s[20:23],s69 offen offset:0 lds
s_waitcnt lgkmcnt(1)
v_mfma_f32_16x16x32_bf16 v[192:195],a[124:127],v[72:75],v[192:195]
v_mfma_f32_16x16x32_bf16 v[200:203],v[72:75],a[252:255],v[200:203]
buffer_load_dwordx4 v16,s[20:23],s69 offen offset:1024 lds
s_waitcnt lgkmcnt(0)
v_mfma_f32_16x16x32_bf16 v[196:199],a[124:127],v[76:79],v[196:199]
v_mfma_f32_16x16x32_bf16 v[204:207],v[76:79],a[252:255],v[204:207]
s_waitcnt vmcnt(26)
ds_write_b32 v21,v25 offset:28
v_xor_b32 v20,0x10000,v20
s_xor_b32 s62,s62,0x10000
s_lshr_b32 s64,s73,9
v_add_u32 v22,s64,v24
v_cvt_pk_bf16_f32 v208,v192,v193
v_cvt_pk_bf16_f32 v209,v194,v195
v_cvt_pk_bf16_f32 v210,v196,v197
v_cvt_pk_bf16_f32 v211,v198,v199
v_cvt_pk_bf16_f32 v212,v200,v201
v_cvt_pk_bf16_f32 v213,v202,v203
v_cvt_pk_bf16_f32 v214,v204,v205
v_cvt_pk_bf16_f32 v215,v206,v207
v_permlane16_swap_b32 v208,v210
v_permlane16_swap_b32 v209,v211
buffer_store_dwordx4 v[208:211],v2,s[24:27],s73 offen
buffer_store_dwordx4 v[208:211],v2,s[28:31],s73 offen sc1
ds_write_b128 v22,v[212:215] offset:17408
buffer_store_dwordx4 v[208:211],v17,s[20:23],s12 offen sc1
bgx_142:
s_waitcnt lgkmcnt(0)
s_andn2_b32 s64,s79,0x14
s_cmp_eq_u32 s64,2
s_cbranch_scc1 late_144
lateb_145:
s_buffer_load_dword s48,s[20:23],s80 offset:0
s_buffer_load_dword s48,s[20:23],s80 offset:64
s_buffer_load_dword s48,s[20:23],s80 offset:128
s_buffer_load_dword s48,s[20:23],s80 offset:192
s_buffer_load_dword s48,s[20:23],s80 offset:256
s_buffer_load_dword s48,s[20:23],s80 offset:320
s_buffer_load_dword s48,s[20:23],s80 offset:384
s_buffer_load_dword s48,s[20:23],s80 offset:448
s_buffer_load_dword s48,s[20:23],s80 offset:512
s_buffer_load_dword s48,s[20:23],s80 offset:576
s_buffer_load_dword s48,s[20:23],s80 offset:640
s_buffer_load_dword s48,s[20:23],s80 offset:704
s_buffer_load_dword s48,s[20:23],s80 offset:768
s_buffer_load_dword s48,s[20:23],s80 offset:832
s_buffer_load_dword s48,s[20:23],s80 offset:896
s_buffer_load_dword s48,s[20:23],s80 offset:960
s_buffer_load_dword s48,s[20:23],s80 offset:1024
s_buffer_load_dword s48,s[20:23],s80 offset:1088
s_buffer_load_dword s48,s[20:23],s80 offset:1152
s_buffer_load_dword s48,s[20:23],s80 offset:1216
s_buffer_load_dword s48,s[20:23],s80 offset:1280
s_buffer_load_dword s48,s[20:23],s80 offset:1344
s_buffer_load_dword s48,s[20:23],s80 offset:1408
s_buffer_load_dword s48,s[20:23],s80 offset:1472
s_buffer_load_dword s48,s[20:23],s80 offset:1536
s_buffer_load_dword s48,s[20:23],s80 offset:1600
s_buffer_load_dword s48,s[20:23],s80 offset:1664
s_buffer_load_dword s48,s[20:23],s80 offset:1728
s_buffer_load_dword s48,s[20:23],s80 offset:1792
s_buffer_load_dword s48,s[20:23],s80 offset:1856
s_buffer_load_dword s48,s[20:23],s80 offset:1920
s_buffer_load_dword s48,s[20:23],s80 offset:1984
s_add_u32 s63,s79,1
s_and_b32 s64,s63,3
s_lshl_b32 s70,s64,20
s_add_u32 s65,s63,2
s_and_b32 s65,s65,3
s_lshl_b32 s73,s65,20
s_add_u32 s55,s63,3
s_lshl_b32 s78,s55,16
s_add_u32 s78,s78,57344
s_cmp_lt_u32 s55,64
s_cselect_b32 s78,s78,0x7fff0000
s_add_u32 s60,s63,1
s_lshl_b32 s76,s60,21
s_lshl_b32 s55,s60,13
s_and_b32 s55,s55,0x2000
s_xor_b32 s55,s55,s61
s_add_u32 s76,s76,s55
s_cmp_lt_u32 s60,64
s_cselect_b32 s76,s76,0x7fff0000
s_add_u32 s60,s63,2
s_lshl_b32 s12,s60,21
s_lshl_b32 s55,s60,13
s_and_b32 s55,s55,0x2000
s_xor_b32 s55,s55,s61
s_add_u32 s12,s12,s55
s_cmp_lt_u32 s60,64
s_cselect_b32 s12,s12,0x7fff0000
s_add_u32 s55,s63,5
s_min_u32 s55,s55,63
s_lshl_b32 s55,s55,16
s_lshl_b32 s60,s59,11
s_add_u32 s80,s55,s60
s_add_u32 s80,s80,57344
v_mov_b32 v176,0
v_mov_b32 v177,0
v_mov_b32 v178,0
v_mov_b32 v179,0
v_mov_b32 v180,0
v_mov_b32 v181,0
v_mov_b32 v182,0
v_mov_b32 v183,0
s_add_u32 s79,s79,1
v_add_u32 v25,1,v25
s_waitcnt vmcnt(0)
s_branch loop_136
art_140:
s_sub_u32 s90,s90,1
s_cmp_lt_i32 s90,0
s_cbranch_scc1 abk_141
buffer_load_dwordx4 v[64:67],v28,s[20:23],s70 offen offset:0 sc1
buffer_load_dwordx4 v[68:71],v28,s[20:23],s70 offen offset:1024 sc1
buffer_load_dwordx4 v[72:75],v28,s[20:23],s70 offen offset:2048 sc1
buffer_load_dwordx4 v[76:79],v28,s[20:23],s70 offen offset:3072 sc1
s_waitcnt vmcnt(3)
ds_write_b128 v24,v[64:67] offset:8192
v_min3_u32 v22,v64,v65,v66
v_min_u32 v22,v22,v67
s_waitcnt vmcnt(2)
ds_write_b128 v24,v[68:71] offset:9216
v_min3_u32 v22,v22,v68,v69
v_min3_u32 v22,v22,v70,v71
s_waitcnt vmcnt(1)
ds_write_b128 v24,v[72:75] offset:10240
v_min3_u32 v22,v22,v72,v73
v_min3_u32 v22,v22,v74,v75
s_waitcnt vmcnt(0)
ds_write_b128 v24,v[76:79] offset:11264
v_min3_u32 v22,v22,v76,v77
v_min3_u32 v22,v22,v78,v79
v_cmp_eq_u32 vcc,0,v22
s_cbranch_vccnz art_140
s_branch abk_141
bgsk_143:
s_waitcnt vmcnt(0)
ds_write_b32 v21,v25 offset:28
s_branch bgx_142
late_144:
s_cmp_eq_u32 s79,22
s_cbranch_scc1 lateb_145
v_lshlrev_b32 v184,2,v16
s_mov_b32 s52,21052416
s_mov_b32 s53,1792
s_lshr_b32 s64,s79,4
s_lshl_b32 s64,0x100,s64
s_cmp_eq_u32 s79,2
s_cselect_b32 exec_lo,0xff,s64
s_mov_b32 exec_hi,0
dp_146:
buffer_load_dword v185,v184,s[20:23],s52 offen sc1
s_waitcnt vmcnt(0)
v_cmp_ne_u32 vcc,s53,v185
s_cbranch_vccz dpok_147
s_sleep 2
s_sub_u32 s90,s90,1
s_cmp_gt_i32 s90,0
s_cbranch_scc1 dp_146
dpok_147:
s_mov_b64 exec,-1
s_branch lateb_145
first_135:
s_add_u32 s63,s79,0
s_and_b32 s64,s63,3
s_lshl_b32 s70,s64,20
s_add_u32 s65,s63,2
s_and_b32 s65,s65,3
s_lshl_b32 s73,s65,20
s_add_u32 s55,s63,3
s_lshl_b32 s78,s55,16
s_add_u32 s78,s78,57344
s_cmp_lt_u32 s55,64
s_cselect_b32 s78,s78,0x7fff0000
s_add_u32 s60,s63,1
s_lshl_b32 s76,s60,21
s_lshl_b32 s55,s60,13
s_and_b32 s55,s55,0x2000
s_xor_b32 s55,s55,s61
s_add_u32 s76,s76,s55
s_cmp_lt_u32 s60,64
s_cselect_b32 s76,s76,0x7fff0000
s_add_u32 s60,s63,2
s_lshl_b32 s12,s60,21
s_lshl_b32 s55,s60,13
s_and_b32 s55,s55,0x2000
s_xor_b32 s55,s55,s61
s_add_u32 s12,s12,s55
s_cmp_lt_u32 s60,64
s_cselect_b32 s12,s12,0x7fff0000
s_add_u32 s55,s63,5
s_min_u32 s55,s55,63
s_lshl_b32 s55,s55,16
s_lshl_b32 s60,s59,11
s_add_u32 s80,s55,s60
s_add_u32 s80,s80,57344
v_mov_b32 v176,0
v_mov_b32 v177,0
v_mov_b32 v178,0
v_mov_b32 v179,0
v_mov_b32 v180,0
v_mov_b32 v181,0
v_mov_b32 v182,0
v_mov_b32 v183,0
s_waitcnt vmcnt(0) lgkmcnt(0)
s_barrier
pn1_148:
ds_read_b128 v[64:67],v20 offset:0
ds_read_b128 v[68:71],v20 offset:1024
ds_read_b128 v[72:75],v20 offset:2048
s_waitcnt lgkmcnt(2)
v_mfma_f32_16x16x32_bf16 v[192:195],a[0:3],v[64:67],0
ds_read_b128 v[76:79],v20 offset:3072
v_mfma_f32_16x16x32_bf16 v[200:203],v[64:67],a[128:131],0
s_waitcnt lgkmcnt(2)
v_mfma_f32_16x16x32_bf16 v[196:199],a[0:3],v[68:71],0
ds_read_b128 v[64:67],v20 offset:4096
v_mfma_f32_16x16x32_bf16 v[204:207],v[68:71],a[128:131],0
s_waitcnt lgkmcnt(2)
v_mfma_f32_16x16x32_bf16 v[192:195],a[4:7],v[72:75],v[192:195]
ds_read_b128 v[68:71],v20 offset:5120
v_mfma_f32_16x16x32_bf16 v[200:203],v[72:75],a[132:135],v[200:203]
s_waitcnt lgkmcnt(2)
v_mfma_f32_16x16x32_bf16 v[196:199],a[4:7],v[76:79],v[196:199]
ds_read_b128 v[72:75],v20 offset:6144
v_mfma_f32_16x16x32_bf16 v[204:207],v[76:79],a[132:135],v[204:207]
s_waitcnt lgkmcnt(2)
v_mfma_f32_16x16x32_bf16 v[192:195],a[8:11],v[64:67],v[192:195]
ds_read_b128 v[76:79],v20 offset:7168
v_mfma_f32_16x16x32_bf16 v[200:203],v[64:67],a[136:139],v[200:203]
s_waitcnt lgkmcnt(2)
v_mfma_f32_16x16x32_bf16 v[196:199],a[8:11],v[68:71],v[196:199]
ds_read_b128 v[64:67],v20 offset:8192
v_mfma_f32_16x16x32_bf16 v[204:207],v[68:71],a[136:139],v[204:207]
s_waitcnt lgkmcnt(2)
v_mfma_f32_16x16x32_bf16 v[192:195],a[12:15],v[72:75],v[192:195]
ds_read_b128 v[68:71],v20 offset:9216
v_mfma_f32_16x16x32_bf16 v[200:203],v[72:75],a[140:143],v[200:203]
s_waitcnt lgkmcnt(2)
v_mfma_f32_16x16x32_bf16 v[196:199],a[12:15],v[76:79],v[196:199]
ds_read_b128 v[72:75],v20 offset:10240
v_mfma_f32_16x16x32_bf16 v[204:207],v[76:79],a[140:143],v[204:207]
s_waitcnt lgkmcnt(2)
v_mfma_f32_16x16x32_bf16 v[192:195],a[16:19],v[64:67],v[192:195]
ds_read_b128 v[76:79],v20 offset:11264
v_mfma_f32_16x16x32_bf16 v[200:203],v[64:67],a[144:147],v[200:203]
s_waitcnt lgkmcnt(2)
v_mfma_f32_16x16x32_bf16 v[196:199],a[16:19],v[68:71],v[196:199]
ds_read_b128 v[64:67],v20 offset:12288
v_mfma_f32_16x16x32_bf16 v[204:207],v[68:71],a[144:147],v[204:207]
s_waitcnt lgkmcnt(2)
v_mfma_f32_16x16x32_bf16 v[192:195],a[20:23],v[72:75],v[192:195]
ds_read_b128 v[68:71],v20 offset:13312
v_mfma_f32_16x16x32_bf16 v[200:203],v[72:75],a[148:151],v[200:203]
s_waitcnt lgkmcnt(2)
v_mfma_f32_16x16x32_bf16 v[196:199],a[20:23],v[76:79],v[196:199]
ds_read_b128 v[72:75],v20 offset:14336
v_mfma_f32_16x16x32_bf16 v[204:207],v[76:79],a[148:151],v[204:207]
s_waitcnt lgkmcnt(2)
v_mfma_f32_16x16x32_bf16 v[192:195],a[24:27],v[64:67],v[192:195]
ds_read_b128 v[76:79],v20 offset:15360
v_mfma_f32_16x16x32_bf16 v[200:203],v[64:67],a[152:155],v[200:203]
s_waitcnt lgkmcnt(2)
v_mfma_f32_16x16x32_bf16 v[196:199],a[24:27],v[68:71],v[196:199]
ds_read_b128 v[64:67],v20 offset:16384
v_mfma_f32_16x16x32_bf16 v[204:207],v[68:71],a[152:155],v[204:207]
s_waitcnt lgkmcnt(2)
v_mfma_f32_16x16x32_bf16 v[192:195],a[28:31],v[72:75],v[192:195]
ds_read_b128 v[68:71],v20 offset:17408
v_mfma_f32_16x16x32_bf16 v[200:203],v[72:75],a[156:159],v[200:203]
s_waitcnt lgkmcnt(2)
v_mfma_f32_16x16x32_bf16 v[196:199],a[28:31],v[76:79],v[196:199]
ds_read_b128 v[72:75],v20 offset:18432
v_mfma_f32_16x16x32_bf16 v[204:207],v[76:79],a[156:159],v[204:207]
s_waitcnt lgkmcnt(2)
v_mfma_f32_16x16x32_bf16 v[192:195],a[32:35],v[64:67],v[192:195]
ds_read_b128 v[76:79],v20 offset:19456
v_mfma_f32_16x16x32_bf16 v[200:203],v[64:67],a[160:163],v[200:203]
s_waitcnt lgkmcnt(2)
v_mfma_f32_16x16x32_bf16 v[196:199],a[32:35],v[68:71],v[196:199]
ds_read_b128 v[64:67],v20 offset:20480
v_mfma_f32_16x16x32_bf16 v[204:207],v[68:71],a[160:163],v[204:207]
s_waitcnt lgkmcnt(2)
v_mfma_f32_16x16x32_bf16 v[192:195],a[36:39],v[72:75],v[192:195]
ds_read_b128 v[68:71],v20 offset:21504
v_mfma_f32_16x16x32_bf16 v[200:203],v[72:75],a[164:167],v[200:203]
s_waitcnt lgkmcnt(2)
v_mfma_f32_16x16x32_bf16 v[196:199],a[36:39],v[76:79],v[196:199]
ds_read_b128 v[72:75],v20 offset:22528
v_mfma_f32_16x16x32_bf16 v[204:207],v[76:79],a[164:167],v[204:207]
s_waitcnt lgkmcnt(2)
v_mfma_f32_16x16x32_bf16 v[192:195],a[40:43],v[64:67],v[192:195]
ds_read_b128 v[76:79],v20 offset:23552
v_mfma_f32_16x16x32_bf16 v[200:203],v[64:67],a[168:171],v[200:203]
s_waitcnt lgkmcnt(2)
v_mfma_f32_16x16x32_bf16 v[196:199],a[40:43],v[68:71],v[196:199]
ds_read_b128 v[64:67],v20 offset:24576
v_mfma_f32_16x16x32_bf16 v[204:207],v[68:71],a[168:171],v[204:207]
s_waitcnt lgkmcnt(2)
v_mfma_f32_16x16x32_bf16 v[192:195],a[44:47],v[72:75],v[192:195]
ds_read_b128 v[68:71],v20 offset:25600
v_mfma_f32_16x16x32_bf16 v[200:203],v[72:75],a[172:175],v[200:203]
s_waitcnt lgkmcnt(2)
v_mfma_f32_16x16x32_bf16 v[196:199],a[44:47],v[76:79],v[196:199]
ds_read_b128 v[72:75],v20 offset:26624
v_mfma_f32_16x16x32_bf16 v[204:207],v[76:79],a[172:175],v[204:207]
s_waitcnt lgkmcnt(2)
v_mfma_f32_16x16x32_bf16 v[192:195],a[48:51],v[64:67],v[192:195]
ds_read_b128 v[76:79],v20 offset:27648
v_mfma_f32_16x16x32_bf16 v[200:203],v[64:67],a[176:179],v[200:203]
s_waitcnt lgkmcnt(2)
v_mfma_f32_16x16x32_bf16 v[196:199],a[48:51],v[68:71],v[196:199]
ds_read_b128 v[64:67],v20 offset:28672
v_mfma_f32_16x16x32_bf16 v[204:207],v[68:71],a[176:179],v[204:207]
s_waitcnt lgkmcnt(2)
v_mfma_f32_16x16x32_bf16 v[192:195],a[52:55],v[72:75],v[192:195]
ds_read_b128 v[68:71],v20 offset:29696
v_mfma_f32_16x16x32_bf16 v[200:203],v[72:75],a[180:183],v[200:203]
s_waitcnt lgkmcnt(2)
v_mfma_f32_16x16x32_bf16 v[196:199],a[52:55],v[76:79],v[196:199]
ds_read_b128 v[72:75],v20 offset:30720
v_mfma_f32_16x16x32_bf16 v[204:207],v[76:79],a[180:183],v[204:207]
s_waitcnt lgkmcnt(2)
v_mfma_f32_16x16x32_bf16 v[192:195],a[56:59],v[64:67],v[192:195]
ds_read_b128 v[76:79],v20 offset:31744
v_mfma_f32_16x16x32_bf16 v[200:203],v[64:67],a[184:187],v[200:203]
s_waitcnt lgkmcnt(2)
v_mfma_f32_16x16x32_bf16 v[196:199],a[56:59],v[68:71],v[196:199]
ds_read_b128 v[64:67],v20 offset:32768
v_mfma_f32_16x16x32_bf16 v[204:207],v[68:71],a[184:187],v[204:207]
s_waitcnt lgkmcnt(2)
v_mfma_f32_16x16x32_bf16 v[192:195],a[60:63],v[72:75],v[192:195]
ds_read_b128 v[68:71],v20 offset:33792
v_mfma_f32_16x16x32_bf16 v[200:203],v[72:75],a[188:191],v[200:203]
s_waitcnt lgkmcnt(2)
v_mfma_f32_16x16x32_bf16 v[196:199],a[60:63],v[76:79],v[196:199]
ds_read_b128 v[72:75],v20 offset:34816
v_mfma_f32_16x16x32_bf16 v[204:207],v[76:79],a[188:191],v[204:207]
s_waitcnt lgkmcnt(2)
v_mfma_f32_16x16x32_bf16 v[192:195],a[64:67],v[64:67],v[192:195]
ds_read_b128 v[76:79],v20 offset:35840
v_mfma_f32_16x16x32_bf16 v[200:203],v[64:67],a[192:195],v[200:203]
s_waitcnt lgkmcnt(2)
v_mfma_f32_16x16x32_bf16 v[196:199],a[64:67],v[68:71],v[196:199]
ds_read_b128 v[64:67],v20 offset:36864
v_mfma_f32_16x16x32_bf16 v[204:207],v[68:71],a[192:195],v[204:207]
s_waitcnt lgkmcnt(2)
v_mfma_f32_16x16x32_bf16 v[192:195],a[68:71],v[72:75],v[192:195]
ds_read_b128 v[68:71],v20 offset:37888
v_mfma_f32_16x16x32_bf16 v[200:203],v[72:75],a[196:199],v[200:203]
s_waitcnt lgkmcnt(2)
v_mfma_f32_16x16x32_bf16 v[196:199],a[68:71],v[76:79],v[196:199]
ds_read_b128 v[72:75],v20 offset:38912
v_mfma_f32_16x16x32_bf16 v[204:207],v[76:79],a[196:199],v[204:207]
s_waitcnt lgkmcnt(2)
v_mfma_f32_16x16x32_bf16 v[192:195],a[72:75],v[64:67],v[192:195]
ds_read_b128 v[76:79],v20 offset:39936
v_mfma_f32_16x16x32_bf16 v[200:203],v[64:67],a[200:203],v[200:203]
s_waitcnt lgkmcnt(2)
v_mfma_f32_16x16x32_bf16 v[196:199],a[72:75],v[68:71],v[196:199]
ds_read_b128 v[64:67],v20 offset:40960
v_mfma_f32_16x16x32_bf16 v[204:207],v[68:71],a[200:203],v[204:207]
s_waitcnt lgkmcnt(2)
v_mfma_f32_16x16x32_bf16 v[192:195],a[76:79],v[72:75],v[192:195]
ds_read_b128 v[68:71],v20 offset:41984
v_mfma_f32_16x16x32_bf16 v[200:203],v[72:75],a[204:207],v[200:203]
s_waitcnt lgkmcnt(2)
v_mfma_f32_16x16x32_bf16 v[196:199],a[76:79],v[76:79],v[196:199]
ds_read_b128 v[72:75],v20 offset:43008
v_mfma_f32_16x16x32_bf16 v[204:207],v[76:79],a[204:207],v[204:207]
s_waitcnt lgkmcnt(2)
v_mfma_f32_16x16x32_bf16 v[192:195],a[80:83],v[64:67],v[192:195]
ds_read_b128 v[76:79],v20 offset:44032
v_mfma_f32_16x16x32_bf16 v[200:203],v[64:67],a[208:211],v[200:203]
s_waitcnt lgkmcnt(2)
v_mfma_f32_16x16x32_bf16 v[196:199],a[80:83],v[68:71],v[196:199]
ds_read_b128 v[64:67],v20 offset:45056
v_mfma_f32_16x16x32_bf16 v[204:207],v[68:71],a[208:211],v[204:207]
s_waitcnt lgkmcnt(2)
v_mfma_f32_16x16x32_bf16 v[192:195],a[84:87],v[72:75],v[192:195]
ds_read_b128 v[68:71],v20 offset:46080
v_mfma_f32_16x16x32_bf16 v[200:203],v[72:75],a[212:215],v[200:203]
s_waitcnt lgkmcnt(2)
v_mfma_f32_16x16x32_bf16 v[196:199],a[84:87],v[76:79],v[196:199]
ds_read_b128 v[72:75],v20 offset:47104
v_mfma_f32_16x16x32_bf16 v[204:207],v[76:79],a[212:215],v[204:207]
s_waitcnt lgkmcnt(2)
v_mfma_f32_16x16x32_bf16 v[192:195],a[88:91],v[64:67],v[192:195]
ds_read_b128 v[76:79],v20 offset:48128
v_mfma_f32_16x16x32_bf16 v[200:203],v[64:67],a[216:219],v[200:203]
s_waitcnt lgkmcnt(2)
v_mfma_f32_16x16x32_bf16 v[196:199],a[88:91],v[68:71],v[196:199]
ds_read_b128 v[64:67],v20 offset:49152
v_mfma_f32_16x16x32_bf16 v[204:207],v[68:71],a[216:219],v[204:207]
s_waitcnt lgkmcnt(2)
v_mfma_f32_16x16x32_bf16 v[192:195],a[92:95],v[72:75],v[192:195]
ds_read_b128 v[68:71],v20 offset:50176
v_mfma_f32_16x16x32_bf16 v[200:203],v[72:75],a[220:223],v[200:203]
s_waitcnt lgkmcnt(2)
v_mfma_f32_16x16x32_bf16 v[196:199],a[92:95],v[76:79],v[196:199]
ds_read_b128 v[72:75],v20 offset:51200
v_mfma_f32_16x16x32_bf16 v[204:207],v[76:79],a[220:223],v[204:207]
s_waitcnt lgkmcnt(2)
v_mfma_f32_16x16x32_bf16 v[192:195],a[96:99],v[64:67],v[192:195]
ds_read_b128 v[76:79],v20 offset:52224
v_mfma_f32_16x16x32_bf16 v[200:203],v[64:67],a[224:227],v[200:203]
s_waitcnt lgkmcnt(2)
v_mfma_f32_16x16x32_bf16 v[196:199],a[96:99],v[68:71],v[196:199]
ds_read_b128 v[64:67],v20 offset:53248
v_mfma_f32_16x16x32_bf16 v[204:207],v[68:71],a[224:227],v[204:207]
s_waitcnt lgkmcnt(2)
v_mfma_f32_16x16x32_bf16 v[192:195],a[100:103],v[72:75],v[192:195]
ds_read_b128 v[68:71],v20 offset:54272
v_mfma_f32_16x16x32_bf16 v[200:203],v[72:75],a[228:231],v[200:203]
s_waitcnt lgkmcnt(2)
v_mfma_f32_16x16x32_bf16 v[196:199],a[100:103],v[76:79],v[196:199]
ds_read_b128 v[72:75],v20 offset:55296
v_mfma_f32_16x16x32_bf16 v[204:207],v[76:79],a[228:231],v[204:207]
s_waitcnt lgkmcnt(2)
v_mfma_f32_16x16x32_bf16 v[192:195],a[104:107],v[64:67],v[192:195]
ds_read_b128 v[76:79],v20 offset:56320
v_mfma_f32_16x16x32_bf16 v[200:203],v[64:67],a[232:235],v[200:203]
s_waitcnt lgkmcnt(2)
v_mfma_f32_16x16x32_bf16 v[196:199],a[104:107],v[68:71],v[196:199]
ds_read_b128 v[64:67],v20 offset:57344
v_mfma_f32_16x16x32_bf16 v[204:207],v[68:71],a[232:235],v[204:207]
s_waitcnt lgkmcnt(2)
v_mfma_f32_16x16x32_bf16 v[192:195],a[108:111],v[72:75],v[192:195]
ds_read_b128 v[68:71],v20 offset:58368
v_mfma_f32_16x16x32_bf16 v[200:203],v[72:75],a[236:239],v[200:203]
s_waitcnt lgkmcnt(2)
v_mfma_f32_16x16x32_bf16 v[196:199],a[108:111],v[76:79],v[196:199]
ds_read_b128 v[72:75],v20 offset:59392
v_mfma_f32_16x16x32_bf16 v[204:207],v[76:79],a[236:239],v[204:207]
s_waitcnt lgkmcnt(2)
v_mfma_f32_16x16x32_bf16 v[192:195],a[112:115],v[64:67],v[192:195]
ds_read_b128 v[76:79],v20 offset:60416
v_mfma_f32_16x16x32_bf16 v[200:203],v[64:67],a[240:243],v[200:203]
s_waitcnt lgkmcnt(2)
v_mfma_f32_16x16x32_bf16 v[196:199],a[112:115],v[68:71],v[196:199]
ds_read_b128 v[64:67],v20 offset:61440
v_mfma_f32_16x16x32_bf16 v[204:207],v[68:71],a[240:243],v[204:207]
s_waitcnt lgkmcnt(2)
v_mfma_f32_16x16x32_bf16 v[192:195],a[116:119],v[72:75],v[192:195]
ds_read_b128 v[68:71],v20 offset:62464
v_mfma_f32_16x16x32_bf16 v[200:203],v[72:75],a[244:247],v[200:203]
s_waitcnt lgkmcnt(2)
v_mfma_f32_16x16x32_bf16 v[196:199],a[116:119],v[76:79],v[196:199]
ds_read_b128 v[72:75],v20 offset:63488
v_mfma_f32_16x16x32_bf16 v[204:207],v[76:79],a[244:247],v[204:207]
s_waitcnt lgkmcnt(2)
v_mfma_f32_16x16x32_bf16 v[192:195],a[120:123],v[64:67],v[192:195]
ds_read_b128 v[76:79],v20 offset:64512
v_mfma_f32_16x16x32_bf16 v[200:203],v[64:67],a[248:251],v[200:203]
s_waitcnt lgkmcnt(2)
v_mfma_f32_16x16x32_bf16 v[196:199],a[120:123],v[68:71],v[196:199]
v_mfma_f32_16x16x32_bf16 v[204:207],v[68:71],a[248:251],v[204:207]
s_waitcnt lgkmcnt(1)
v_mfma_f32_16x16x32_bf16 v[192:195],a[124:127],v[72:75],v[192:195]
v_mfma_f32_16x16x32_bf16 v[200:203],v[72:75],a[252:255],v[200:203]
s_waitcnt lgkmcnt(0)
v_mfma_f32_16x16x32_bf16 v[196:199],a[124:127],v[76:79],v[196:199]
v_mfma_f32_16x16x32_bf16 v[204:207],v[76:79],a[252:255],v[204:207]
v_xor_b32 v20,0x10000,v20
s_xor_b32 s62,s62,0x10000
s_lshr_b32 s64,s73,9
v_add_u32 v22,s64,v24
v_cvt_pk_bf16_f32 v208,v192,v193
v_cvt_pk_bf16_f32 v209,v194,v195
s_nop 0
v_cvt_pk_bf16_f32 v210,v196,v197
v_cvt_pk_bf16_f32 v211,v198,v199
v_cvt_pk_bf16_f32 v212,v200,v201
v_cvt_pk_bf16_f32 v213,v202,v203
v_cvt_pk_bf16_f32 v214,v204,v205
v_cvt_pk_bf16_f32 v215,v206,v207
v_permlane16_swap_b32 v208,v210
v_permlane16_swap_b32 v209,v211
buffer_store_dwordx4 v[208:211],v2,s[24:27],s73 offen
buffer_store_dwordx4 v[208:211],v2,s[28:31],s73 offen sc1
ds_write_b128 v22,v[212:215] offset:17408
buffer_store_dwordx4 v[208:211],v17,s[20:23],s12 offen sc1
bgx_150:
s_add_u32 s63,s79,1
s_and_b32 s64,s63,3
s_lshl_b32 s70,s64,20
s_add_u32 s65,s63,2
s_and_b32 s65,s65,3
s_lshl_b32 s73,s65,20
s_add_u32 s55,s63,3
s_lshl_b32 s78,s55,16
s_add_u32 s78,s78,57344
s_cmp_lt_u32 s55,64
s_cselect_b32 s78,s78,0x7fff0000
s_add_u32 s60,s63,1
s_lshl_b32 s76,s60,21
s_lshl_b32 s55,s60,13
s_and_b32 s55,s55,0x2000
s_xor_b32 s55,s55,s61
s_add_u32 s76,s76,s55
s_cmp_lt_u32 s60,64
s_cselect_b32 s76,s76,0x7fff0000
s_add_u32 s60,s63,2
s_lshl_b32 s12,s60,21
s_lshl_b32 s55,s60,13
s_and_b32 s55,s55,0x2000
s_xor_b32 s55,s55,s61
s_add_u32 s12,s12,s55
s_cmp_lt_u32 s60,64
s_cselect_b32 s12,s12,0x7fff0000
s_add_u32 s55,s63,5
s_min_u32 s55,s55,63
s_lshl_b32 s55,s55,16
s_lshl_b32 s60,s59,11
s_add_u32 s80,s55,s60
s_add_u32 s80,s80,57344
v_mov_b32 v176,0
v_mov_b32 v177,0
v_mov_b32 v178,0
v_mov_b32 v179,0
v_mov_b32 v180,0
v_mov_b32 v181,0
v_mov_b32 v182,0
v_mov_b32 v183,0
s_add_u32 s79,s79,1
s_cmp_eq_u32 s79,0
s_cbranch_scc1 pn2_149
v_mov_b32 v38,1
ds_write_b32 v37,v38 offset:12
buffer_store_dwordx4 v[212:215],v12,s[20:23],s76 offen sc1
s_waitcnt lgkmcnt(0)
s_branch pn1_148
pn2_149:
v_mov_b32 v25,1
s_waitcnt vmcnt(1) lgkmcnt(0)
s_barrier
s_branch loop_136
w3_61:
v_xor_b32 v9,0x10000,v8
v_xor_b32 v10,0x20000,v8
v_xor_b32 v11,0x30000,v8
v_and_b32 v22,2,v4
v_lshrrev_b32 v23,3,v3
v_add_u32 v22,v22,v23
v_lshlrev_b32 v22,3,v22
v_and_b32 v23,1,v4
v_lshl_add_u32 v22,v23,2,v22
v_and_b32 v23,3,v3
v_add_u32 v22,v22,v23
v_lshlrev_b32 v22,4,v22
v_bfe_u32 v23,v3,2,1
v_lshl_add_u32 v22,v23,3,v22
v_add_u32 v30,s66,v22
v_and_b32 v22,7,v3
v_lshl_add_u32 v12,v4,3,v22
v_lshlrev_b32 v12,4,v12
v_add_u32 v12,s66,v12
s_branch first_151
loop_152:
s_barrier
buffer_load_dword v248,v18,s[20:23],s70 offen offset:0 sc1
s_nop 15
s_nop 5
hl_154:
buffer_load_dword v249,v18,s[20:23],s70 offen offset:0 sc1
s_waitcnt vmcnt(1)
v_cmp_eq_u32 vcc,v25,v248
s_bcnt1_i32_b32 s64,vcc_lo
s_cmp_ge_u32 s64,8
s_cbranch_scc1 hg_155
buffer_load_dword v248,v18,s[20:23],s70 offen offset:0 sc1
s_waitcnt vmcnt(1)
v_cmp_eq_u32 vcc,v25,v249
s_bcnt1_i32_b32 s64,vcc_lo
s_cmp_ge_u32 s64,8
s_cbranch_scc1 hg_155
s_sub_u32 s90,s90,1
s_cmp_gt_i32 s90,0
s_cbranch_scc1 hl_154
hg_155:
buffer_load_dwordx4 v[80:83],v29,s[20:23],s70 offen offset:0 sc1
buffer_load_dwordx4 v[84:87],v29,s[20:23],s70 offen offset:1024 sc1
buffer_load_dwordx4 v[88:91],v29,s[20:23],s70 offen offset:2048 sc1
buffer_load_dwordx4 v[92:95],v29,s[20:23],s70 offen offset:3072 sc1
s_waitcnt vmcnt(3)
ds_write_b128 v24,v[80:83] offset:12288
v_min3_u32 v22,v80,v81,v82
v_min_u32 v22,v22,v83
s_waitcnt vmcnt(2)
ds_write_b128 v24,v[84:87] offset:13312
v_min3_u32 v22,v22,v84,v85
v_min3_u32 v22,v22,v86,v87
s_waitcnt vmcnt(1)
ds_write_b128 v24,v[88:91] offset:14336
v_min3_u32 v22,v22,v88,v89
v_min3_u32 v22,v22,v90,v91
s_waitcnt vmcnt(0)
ds_write_b128 v24,v[92:95] offset:15360
v_min3_u32 v22,v22,v92,v93
v_min3_u32 v22,v22,v94,v95
v_cmp_eq_u32 vcc,0,v22
s_cbranch_vccnz art_156
abk_157:
v_smfmac_f32_16x16x64_bf16 v[176:179],v[80:83],a[96:103],v14
s_waitcnt lgkmcnt(0)
s_barrier
ds_read_b128 v[32:35],v24 offset:0
ds_read_b128 v[36:39],v24 offset:1024
ds_read_b128 v[40:43],v24 offset:2048
ds_read_b128 v[44:47],v24 offset:3072
v_smfmac_f32_16x16x64_bf16 v[176:179],v[84:87],a[104:111],v14
ds_read_b128 v[48:51],v24 offset:4096
ds_read_b128 v[52:55],v24 offset:5120
v_smfmac_f32_16x16x64_bf16 v[176:179],v[88:91],a[112:119],v14
ds_read_b128 v[56:59],v24 offset:6144
ds_read_b128 v[60:63],v24 offset:7168
v_smfmac_f32_16x16x64_bf16 v[176:179],v[92:95],a[120:127],v14
ds_read_b128 v[64:67],v24 offset:8192
ds_read_b128 v[68:71],v24 offset:9216
s_waitcnt lgkmcnt(9)
v_smfmac_f32_16x16x64_bf16 v[176:179],v[32:35],a[0:7],v14
ds_read_b128 v[72:75],v24 offset:10240
s_waitcnt lgkmcnt(9)
v_smfmac_f32_16x16x64_bf16 v[176:179],v[36:39],a[8:15],v14
ds_read_b128 v[76:79],v24 offset:11264
s_waitcnt lgkmcnt(9)
v_smfmac_f32_16x16x64_bf16 v[176:179],v[40:43],a[16:23],v14
s_waitcnt lgkmcnt(8)
v_smfmac_f32_16x16x64_bf16 v[176:179],v[44:47],a[24:31],v14
s_waitcnt lgkmcnt(7)
v_smfmac_f32_16x16x64_bf16 v[176:179],v[48:51],a[32:39],v14
s_waitcnt lgkmcnt(6)
v_smfmac_f32_16x16x64_bf16 v[176:179],v[52:55],a[40:47],v14
s_waitcnt lgkmcnt(5)
v_smfmac_f32_16x16x64_bf16 v[176:179],v[56:59],a[48:55],v14
s_waitcnt lgkmcnt(4)
v_smfmac_f32_16x16x64_bf16 v[176:179],v[60:63],a[56:63],v14
s_waitcnt lgkmcnt(3)
v_smfmac_f32_16x16x64_bf16 v[176:179],v[64:67],a[64:71],v14
s_waitcnt lgkmcnt(2)
v_smfmac_f32_16x16x64_bf16 v[176:179],v[68:71],a[72:79],v14
s_waitcnt lgkmcnt(1)
v_smfmac_f32_16x16x64_bf16 v[176:179],v[72:75],a[80:87],v14
s_waitcnt lgkmcnt(0)
v_smfmac_f32_16x16x64_bf16 v[176:179],v[76:79],a[88:95],v14
s_nop 7
v_permlane32_swap_b32 v176,v178
v_permlane32_swap_b32 v177,v179
v_add_f32 v176,v176,v178
v_add_f32 v177,v177,v179
v_cvt_pk_bf16_f32 v216,v176,v177
s_nop 1
v_mov_b32_dpp v217,v216 quad_perm:[1,0,3,2] row_mask:0xf bank_mask:0xf
v_perm_b32 v216,v217,v216,v15
v_max_u32 v216,1,v216
buffer_store_dword v216,v19,s[24:27],s70 offen
buffer_store_dword v216,v19,s[28:31],s70 offen sc1
s_cmp_eq_u32 s79,63
s_cbranch_scc1 end_57
s_nop 15
s_nop 15
s_nop 15
s_nop 15
s_nop 10
s_add_u32 m0,s62,53248
s_add_u32 s69,s78,53248
buffer_load_dwordx4 v16,s[20:23],s69 offen offset:0 lds
s_nop 3
buffer_load_dwordx4 v16,s[20:23],s69 offen offset:1024 lds
s_nop 3
buffer_load_dwordx4 v16,s[20:23],s69 offen offset:2048 lds
s_nop 3
buffer_load_dwordx4 v16,s[20:23],s69 offen offset:3072 lds
s_nop 3
s_add_u32 m0,s62,57344
s_add_u32 s69,s78,57344
buffer_load_dwordx4 v16,s[20:23],s69 offen offset:0 lds
s_nop 3
buffer_load_dwordx4 v16,s[20:23],s69 offen offset:1024 lds
s_nop 3
buffer_load_dwordx4 v16,s[20:23],s69 offen offset:2048 lds
s_nop 3
buffer_load_dwordx4 v16,s[20:23],s69 offen offset:3072 lds
s_nop 3
s_add_u32 m0,s62,61440
s_add_u32 s69,s78,61440
buffer_load_dwordx4 v16,s[20:23],s69 offen offset:0 lds
s_nop 3
buffer_load_dwordx4 v16,s[20:23],s69 offen offset:1024 lds
s_nop 3
buffer_load_dwordx4 v16,s[20:23],s69 offen offset:2048 lds
s_nop 3
buffer_load_dwordx4 v16,s[20:23],s69 offen offset:3072 lds
s_nop 3
s_xor_b32 s62,s62,0x10000
wf_158:
ds_read_b32 v23,v21 offset:8
s_sub_u32 s90,s90,1
s_waitcnt lgkmcnt(0)
v_cmp_ne_u32 vcc,v23,v25
s_cmp_lt_i32 s90,0
s_cselect_b64 vcc,0,vcc
s_cbranch_vccnz wf_158
hl_159:
buffer_load_dword v248,v18,s[20:23],s70 offen offset:512 sc1
s_waitcnt vmcnt(0)
v_cmp_eq_u32 vcc,v25,v248
s_bcnt1_i32_b32 s64,vcc_lo
s_cmp_ge_u32 s64,16
s_cbranch_scc1 hg_160
s_sub_u32 s90,s90,1
s_cmp_gt_i32 s90,0
s_cbranch_scc1 hl_159
hg_160:
buffer_load_dwordx4 v[32:35],v28,s[20:23],s71 offen offset:0 sc1
buffer_load_dwordx4 v[36:39],v28,s[20:23],s71 offen offset:1024 sc1
buffer_load_dwordx4 v[40:43],v28,s[20:23],s71 offen offset:2048 sc1
buffer_load_dwordx4 v[44:47],v28,s[20:23],s71 offen offset:3072 sc1
buffer_load_dwordx4 v[48:51],v29,s[20:23],s71 offen offset:0 sc1
buffer_load_dwordx4 v[52:55],v29,s[20:23],s71 offen offset:1024 sc1
buffer_load_dwordx4 v[56:59],v29,s[20:23],s71 offen offset:2048 sc1
buffer_load_dwordx4 v[60:63],v29,s[20:23],s71 offen offset:3072 sc1
s_mov_b32 s68,0
s_waitcnt vmcnt(6)
v_smfmac_f32_16x16x64_bf16 v[184:187],v[32:35],a[128:135],v14
v_min3_u32 v22,v32,v33,v34
v_min3_u32 v22,v22,v35,v36
v_smfmac_f32_16x16x64_bf16 v[188:191],v[32:35],a[136:143],v14
v_min3_u32 v22,v22,v37,v38
v_smfmac_f32_16x16x64_bf16 v[184:187],v[36:39],a[144:151],v14
v_min_u32 v22,v22,v39
v_smfmac_f32_16x16x64_bf16 v[188:191],v[36:39],a[152:159],v14
v_cmp_eq_u32 s[52:53],0,v22
s_waitcnt vmcnt(4)
v_smfmac_f32_16x16x64_bf16 v[184:187],v[40:43],a[160:167],v14
v_min3_u32 v22,v40,v41,v42
s_cmp_lg_u64 s[52:53],0
v_smfmac_f32_16x16x64_bf16 v[188:191],v[40:43],a[168:175],v14
s_cbranch_scc1 ms_161
bk_162:
v_min3_u32 v22,v22,v43,v44
v_smfmac_f32_16x16x64_bf16 v[184:187],v[44:47],a[176:183],v14
v_min3_u32 v22,v22,v45,v46
v_min_u32 v22,v22,v47
v_smfmac_f32_16x16x64_bf16 v[188:191],v[44:47],a[184:191],v14
v_cmp_eq_u32 s[54:55],0,v22
s_waitcnt vmcnt(2)
v_smfmac_f32_16x16x64_bf16 v[184:187],v[48:51],a[192:199],v14
v_min3_u32 v22,v48,v49,v50
s_cmp_lg_u64 s[54:55],0
v_smfmac_f32_16x16x64_bf16 v[188:191],v[48:51],a[200:207],v14
s_cbranch_scc1 ms_163
bk_164:
v_min3_u32 v22,v22,v51,v52
v_smfmac_f32_16x16x64_bf16 v[184:187],v[52:55],a[208:215],v14
v_min3_u32 v22,v22,v53,v54
v_min_u32 v22,v22,v55
v_smfmac_f32_16x16x64_bf16 v[188:191],v[52:55],a[216:223],v14
v_cmp_eq_u32 s[52:53],0,v22
s_waitcnt vmcnt(0)
v_smfmac_f32_16x16x64_bf16 v[184:187],v[56:59],a[224:231],v14
v_min3_u32 v22,v56,v57,v58
s_cmp_lg_u64 s[52:53],0
v_smfmac_f32_16x16x64_bf16 v[188:191],v[56:59],a[232:239],v14
s_cbranch_scc1 ms_165
bk_166:
v_min3_u32 v22,v22,v59,v60
v_smfmac_f32_16x16x64_bf16 v[184:187],v[60:63],a[240:247],v14
v_min3_u32 v22,v22,v61,v62
v_min_u32 v22,v22,v63
v_smfmac_f32_16x16x64_bf16 v[188:191],v[60:63],a[248:255],v14
v_cmp_eq_u32 s[54:55],0,v22
s_cmp_lg_u64 s[54:55],0
s_cbranch_scc1 ms_169
bk_170:
s_cmp_lg_u32 s68,0
s_cbranch_scc1 rl2_171
fin_167:
s_nop 2
v_permlane32_swap_b32 v184,v188
v_permlane32_swap_b32 v185,v189
v_permlane32_swap_b32 v186,v190
v_permlane32_swap_b32 v187,v191
v_pk_add_f32 v[184:185],v[184:185],v[188:189]
v_pk_add_f32 v[186:187],v[186:187],v[190:191]
wf_172:
ds_read_b32 v23,v21 offset:12
ds_read_b128 v[216:219],v24 offset:25600
s_sub_u32 s90,s90,1
s_waitcnt lgkmcnt(0)
v_cmp_ne_u32 vcc,v23,v25
s_cmp_lt_i32 s90,0
s_cselect_b64 vcc,0,vcc
v_pk_add_f32 v[216:217],v[216:217],v[184:185]
v_pk_add_f32 v[218:219],v[218:219],v[186:187]
s_cbranch_vccnz wf_172
v_max_u32 v216,1,v216
v_max_u32 v217,1,v217
v_max_u32 v218,1,v218
v_max_u32 v219,1,v219
buffer_store_dwordx4 v[216:219],v8,s[20:23],s74 offen sc1
s_mov_b32 s88,s74
s_mov_b32 s89,s72
v_add_u32 v25,1,v25
s_add_u32 s63,s79,1
s_and_b32 s64,s63,3
s_lshl_b32 s70,s64,20
s_add_u32 s65,s63,2
s_and_b32 s65,s65,3
s_lshl_b32 s73,s65,20
s_add_u32 s55,s63,3
s_lshl_b32 s78,s55,16
s_add_u32 s78,s78,57344
s_cmp_lt_u32 s55,64
s_cselect_b32 s78,s78,0x7fff0000
s_add_u32 s71,s70,65536
s_add_u32 s60,s63,1
s_and_b32 s60,s60,3
s_lshl_b32 s72,s60,20
v_mov_b32 v184,0
v_mov_b32 v185,0
v_mov_b32 v186,0
v_mov_b32 v187,0
v_mov_b32 v188,0
v_mov_b32 v189,0
v_mov_b32 v190,0
v_mov_b32 v191,0
s_lshl_b32 s74,s63,21
s_lshl_b32 s55,s63,13
s_and_b32 s55,s55,0x2000
s_xor_b32 s55,s55,s61
s_add_u32 s74,s74,s55
v_mov_b32 v176,0
v_mov_b32 v177,0
v_mov_b32 v178,0
v_mov_b32 v179,0
s_nop 15
s_nop 15
s_nop 15
s_nop 15
s_nop 5
pp_173:
buffer_load_dwordx4 v[32:35],v9,s[20:23],s88 offen sc1
buffer_load_dwordx4 v[36:39],v10,s[20:23],s88 offen sc1
buffer_load_dwordx4 v[40:43],v11,s[20:23],s88 offen sc1
s_waitcnt vmcnt(2)
v_min3_u32 v22,v32,v33,v34
v_pk_add_f32 v[220:221],v[216:217],v[32:33]
v_pk_add_f32 v[222:223],v[218:219],v[34:35]
s_waitcnt vmcnt(0)
v_min3_u32 v22,v22,v35,v36
v_min3_u32 v22,v22,v37,v38
v_min3_u32 v22,v22,v39,v40
v_min3_u32 v22,v22,v41,v42
v_min_u32 v22,v22,v43
v_pk_add_f32 v[36:37],v[36:37],v[40:41]
v_cmp_eq_u32 vcc,0,v22
v_pk_add_f32 v[38:39],v[38:39],v[42:43]
s_cbranch_vccz pok_174
s_sub_u32 s90,s90,1
s_cmp_gt_i32 s90,0
s_cbranch_scc1 pp_173
pok_174:
v_pk_add_f32 v[220:221],v[220:221],v[36:37]
v_pk_add_f32 v[222:223],v[222:223],v[38:39]
s_mov_b64 vcc,s[86:87]
v_cvt_pk_bf16_f32 v216,v220,v221
v_cvt_pk_bf16_f32 v217,v222,v223
s_nop 0
v_mov_b32_dpp v218,v216 quad_perm:[1,0,3,2] row_mask:0xf bank_mask:0xf
v_mov_b32_dpp v219,v217 quad_perm:[1,0,3,2] row_mask:0xf bank_mask:0xf
v_perm_b32 v216,v218,v216,v15
v_perm_b32 v217,v219,v217,v15
s_nop 1
v_cndmask_b32_dpp v220,v217,v216,vcc quad_perm:[2,3,0,1] row_mask:0xf bank_mask:0xf
s_not_b64 vcc,vcc
v_cndmask_b32_dpp v221,v216,v217,vcc quad_perm:[2,3,0,1] row_mask:0xf bank_mask:0xf
v_max_u32 v220,1,v220
v_max_u32 v221,1,v221
buffer_store_dwordx2 v[220:221],v30,s[24:27],s89 offen
buffer_store_dwordx2 v[220:221],v30,s[28:31],s89 offen sc1
s_mov_b64 exec,1
buffer_store_dword v25,v13,s[24:27],s89 offen
buffer_store_dword v25,v13,s[28:31],s89 offen sc1
s_mov_b64 exec,-1
s_add_u32 s79,s79,1
s_branch loop_152
art_156:
s_sub_u32 s90,s90,1
s_cmp_lt_i32 s90,0
s_cbranch_scc1 abk_157
buffer_load_dwordx4 v[80:83],v29,s[20:23],s70 offen offset:0 sc1
buffer_load_dwordx4 v[84:87],v29,s[20:23],s70 offen offset:1024 sc1
buffer_load_dwordx4 v[88:91],v29,s[20:23],s70 offen offset:2048 sc1
buffer_load_dwordx4 v[92:95],v29,s[20:23],s70 offen offset:3072 sc1
s_waitcnt vmcnt(3)
ds_write_b128 v24,v[80:83] offset:12288
v_min3_u32 v22,v80,v81,v82
v_min_u32 v22,v22,v83
s_waitcnt vmcnt(2)
ds_write_b128 v24,v[84:87] offset:13312
v_min3_u32 v22,v22,v84,v85
v_min3_u32 v22,v22,v86,v87
s_waitcnt vmcnt(1)
ds_write_b128 v24,v[88:91] offset:14336
v_min3_u32 v22,v22,v88,v89
v_min3_u32 v22,v22,v90,v91
s_waitcnt vmcnt(0)
ds_write_b128 v24,v[92:95] offset:15360
v_min3_u32 v22,v22,v92,v93
v_min3_u32 v22,v22,v94,v95
v_cmp_eq_u32 vcc,0,v22
s_cbranch_vccnz art_156
s_branch abk_157
ms_161:
s_waitcnt vmcnt(0)
buffer_load_dwordx4 v[64:67],v28,s[20:23],s71 offen offset:0 sc1
buffer_load_dwordx4 v[68:71],v28,s[20:23],s71 offen offset:1024 sc1
s_bitset1_b32 s68,0
s_branch bk_162
ms_163:
s_waitcnt vmcnt(0)
buffer_load_dwordx4 v[72:75],v28,s[20:23],s71 offen offset:2048 sc1
buffer_load_dwordx4 v[76:79],v28,s[20:23],s71 offen offset:3072 sc1
s_bitset1_b32 s68,1
s_branch bk_164
ms_165:
s_waitcnt vmcnt(0)
buffer_load_dwordx4 v[80:83],v29,s[20:23],s71 offen offset:0 sc1
buffer_load_dwordx4 v[84:87],v29,s[20:23],s71 offen offset:1024 sc1
s_bitset1_b32 s68,2
s_branch bk_166
ms_169:
s_waitcnt vmcnt(0)
buffer_load_dwordx4 v[88:91],v29,s[20:23],s71 offen offset:2048 sc1
buffer_load_dwordx4 v[92:95],v29,s[20:23],s71 offen offset:3072 sc1
s_bitset1_b32 s68,3
s_branch bk_170
rl_168:
s_bitcmp1_b32 s68,0
s_cbranch_scc0 sk_175
buffer_load_dwordx4 v[64:67],v28,s[20:23],s71 offen offset:0 sc1
buffer_load_dwordx4 v[68:71],v28,s[20:23],s71 offen offset:1024 sc1
sk_175:
s_bitcmp1_b32 s68,1
s_cbranch_scc0 sk_176
buffer_load_dwordx4 v[72:75],v28,s[20:23],s71 offen offset:2048 sc1
buffer_load_dwordx4 v[76:79],v28,s[20:23],s71 offen offset:3072 sc1
sk_176:
s_bitcmp1_b32 s68,2
s_cbranch_scc0 sk_177
buffer_load_dwordx4 v[80:83],v29,s[20:23],s71 offen offset:0 sc1
buffer_load_dwordx4 v[84:87],v29,s[20:23],s71 offen offset:1024 sc1
sk_177:
s_bitcmp1_b32 s68,3
s_cbranch_scc0 sk_178
buffer_load_dwordx4 v[88:91],v29,s[20:23],s71 offen offset:2048 sc1
buffer_load_dwordx4 v[92:95],v29,s[20:23],s71 offen offset:3072 sc1
sk_178:
rl2_171:
s_sub_u32 s90,s90,1
s_cmp_lt_i32 s90,0
s_cbranch_scc1 fin_167
s_waitcnt vmcnt(0)
s_bitcmp1_b32 s68,0
s_cbranch_scc0 sk_179
v_min3_u32 v22,v64,v65,v66
v_min3_u32 v22,v22,v67,v68
v_min3_u32 v22,v22,v69,v70
v_min_u32 v22,v22,v71
v_cmp_eq_u32 vcc,0,v22
v_xor_b32 v64,v32,v64
v_xor_b32 v65,v33,v65
v_xor_b32 v66,v34,v66
v_xor_b32 v67,v35,v67
v_xor_b32 v68,v36,v68
v_xor_b32 v69,v37,v69
v_xor_b32 v70,v38,v70
v_xor_b32 v71,v39,v71
s_cbranch_vccnz nb_180
s_bitset0_b32 s68,0
v_smfmac_f32_16x16x64_bf16 v[184:187],v[64:67],a[128:135],v14
v_smfmac_f32_16x16x64_bf16 v[188:191],v[64:67],a[136:143],v14
v_smfmac_f32_16x16x64_bf16 v[184:187],v[68:71],a[144:151],v14
v_smfmac_f32_16x16x64_bf16 v[188:191],v[68:71],a[152:159],v14
nb_180:
sk_179:
s_bitcmp1_b32 s68,1
s_cbranch_scc0 sk_181
v_min3_u32 v22,v72,v73,v74
v_min3_u32 v22,v22,v75,v76
v_min3_u32 v22,v22,v77,v78
v_min_u32 v22,v22,v79
v_cmp_eq_u32 vcc,0,v22
v_xor_b32 v72,v40,v72
v_xor_b32 v73,v41,v73
v_xor_b32 v74,v42,v74
v_xor_b32 v75,v43,v75
v_xor_b32 v76,v44,v76
v_xor_b32 v77,v45,v77
v_xor_b32 v78,v46,v78
v_xor_b32 v79,v47,v79
s_cbranch_vccnz nb_182
s_bitset0_b32 s68,1
v_smfmac_f32_16x16x64_bf16 v[184:187],v[72:75],a[160:167],v14
v_smfmac_f32_16x16x64_bf16 v[188:191],v[72:75],a[168:175],v14
v_smfmac_f32_16x16x64_bf16 v[184:187],v[76:79],a[176:183],v14
v_smfmac_f32_16x16x64_bf16 v[188:191],v[76:79],a[184:191],v14
nb_182:
sk_181:
s_bitcmp1_b32 s68,2
s_cbranch_scc0 sk_183
v_min3_u32 v22,v80,v81,v82
v_min3_u32 v22,v22,v83,v84
v_min3_u32 v22,v22,v85,v86
v_min_u32 v22,v22,v87
v_cmp_eq_u32 vcc,0,v22
v_xor_b32 v80,v48,v80
v_xor_b32 v81,v49,v81
v_xor_b32 v82,v50,v82
v_xor_b32 v83,v51,v83
v_xor_b32 v84,v52,v84
v_xor_b32 v85,v53,v85
v_xor_b32 v86,v54,v86
v_xor_b32 v87,v55,v87
s_cbranch_vccnz nb_184
s_bitset0_b32 s68,2
v_smfmac_f32_16x16x64_bf16 v[184:187],v[80:83],a[192:199],v14
v_smfmac_f32_16x16x64_bf16 v[188:191],v[80:83],a[200:207],v14
v_smfmac_f32_16x16x64_bf16 v[184:187],v[84:87],a[208:215],v14
v_smfmac_f32_16x16x64_bf16 v[188:191],v[84:87],a[216:223],v14
nb_184:
sk_183:
s_bitcmp1_b32 s68,3
s_cbranch_scc0 sk_185
v_min3_u32 v22,v88,v89,v90
v_min3_u32 v22,v22,v91,v92
v_min3_u32 v22,v22,v93,v94
v_min_u32 v22,v22,v95
v_cmp_eq_u32 vcc,0,v22
v_xor_b32 v88,v56,v88
v_xor_b32 v89,v57,v89
v_xor_b32 v90,v58,v90
v_xor_b32 v91,v59,v91
v_xor_b32 v92,v60,v92
v_xor_b32 v93,v61,v93
v_xor_b32 v94,v62,v94
v_xor_b32 v95,v63,v95
s_cbranch_vccnz nb_186
s_bitset0_b32 s68,3
v_smfmac_f32_16x16x64_bf16 v[184:187],v[88:91],a[224:231],v14
v_smfmac_f32_16x16x64_bf16 v[188:191],v[88:91],a[232:239],v14
v_smfmac_f32_16x16x64_bf16 v[184:187],v[92:95],a[240:247],v14
v_smfmac_f32_16x16x64_bf16 v[188:191],v[92:95],a[248:255],v14
nb_186:
sk_185:
s_cmp_lg_u32 s68,0
s_cbranch_scc1 rl_168
s_nop 2
s_branch fin_167
first_151:
s_waitcnt vmcnt(0) lgkmcnt(0)
s_barrier
s_add_u32 s64,s15,393216
buffer_load_dwordx4 a[176:179],v32,s[40:43],s64 offen nt
s_add_u32 s64,s15,425984
buffer_load_dwordx4 a[180:183],v32,s[40:43],s64 offen nt
s_add_u32 s64,s15,458752
buffer_load_dwordx4 a[184:187],v32,s[40:43],s64 offen nt
s_add_u32 s64,s15,491520
buffer_load_dwordx4 a[188:191],v32,s[40:43],s64 offen nt
s_add_u32 s64,s15,524288
buffer_load_dwordx4 a[192:195],v32,s[40:43],s64 offen nt
s_add_u32 s64,s15,557056
buffer_load_dwordx4 a[196:199],v32,s[40:43],s64 offen nt
s_add_u32 s64,s15,589824
buffer_load_dwordx4 a[200:203],v32,s[40:43],s64 offen nt
s_add_u32 s64,s15,622592
buffer_load_dwordx4 a[204:207],v32,s[40:43],s64 offen nt
s_add_u32 s64,s15,655360
buffer_load_dwordx4 a[208:211],v32,s[40:43],s64 offen nt
s_add_u32 s64,s15,688128
buffer_load_dwordx4 a[212:215],v32,s[40:43],s64 offen nt
s_add_u32 s64,s15,720896
buffer_load_dwordx4 a[216:219],v32,s[40:43],s64 offen nt
s_add_u32 s64,s15,753664
buffer_load_dwordx4 a[220:223],v32,s[40:43],s64 offen nt
s_add_u32 s64,s15,786432
buffer_load_dwordx4 a[224:227],v32,s[40:43],s64 offen nt
s_add_u32 s64,s15,819200
buffer_load_dwordx4 a[228:231],v32,s[40:43],s64 offen nt
s_add_u32 s64,s15,851968
buffer_load_dwordx4 a[232:235],v32,s[40:43],s64 offen nt
s_add_u32 s64,s15,884736
buffer_load_dwordx4 a[236:239],v32,s[40:43],s64 offen nt
s_add_u32 s64,s15,917504
buffer_load_dwordx4 a[240:243],v32,s[40:43],s64 offen nt
s_add_u32 s64,s15,950272
buffer_load_dwordx4 a[244:247],v32,s[40:43],s64 offen nt
s_add_u32 s64,s15,983040
buffer_load_dwordx4 a[248:251],v32,s[40:43],s64 offen nt
s_add_u32 s64,s15,1015808
buffer_load_dwordx4 a[252:255],v32,s[40:43],s64 offen nt
ds_write_b128 v33,a[0:3] offset:0
ds_write_b128 v33,a[4:7] offset:1024
ds_write_b128 v33,a[8:11] offset:2048
ds_write_b128 v33,a[12:15] offset:3072
s_waitcnt lgkmcnt(0)
v_mov_b32 v38,1
ds_write_b32 v37,v38 offset:4
qs_187:
ds_read_b32 v39,v37 offset:0
s_sub_u32 s90,s90,1
s_waitcnt lgkmcnt(0)
v_cmp_gt_u32 vcc,v38,v39
s_cmp_lt_i32 s90,0
s_cselect_b64 vcc,0,vcc
s_cbranch_vccnz qs_187
ds_read_b64_tr_b16 a[0:1],v36 offset:0
ds_read_b64_tr_b16 a[2:3],v36 offset:128
ds_read_b64_tr_b16 a[4:5],v36 offset:2048
ds_read_b64_tr_b16 a[6:7],v36 offset:2176
ds_read_b64_tr_b16 a[8:9],v36 offset:8192
ds_read_b64_tr_b16 a[10:11],v36 offset:8320
ds_read_b64_tr_b16 a[12:13],v36 offset:10240
ds_read_b64_tr_b16 a[14:15],v36 offset:10368
ds_write_b128 v33,a[16:19] offset:4096
ds_write_b128 v33,a[20:23] offset:5120
ds_write_b128 v33,a[24:27] offset:6144
ds_write_b128 v33,a[28:31] offset:7168
s_waitcnt lgkmcnt(0)
v_mov_b32 v38,2
ds_write_b32 v37,v38 offset:4
qs_188:
ds_read_b32 v39,v37 offset:0
s_sub_u32 s90,s90,1
s_waitcnt lgkmcnt(0)
v_cmp_gt_u32 vcc,v38,v39
s_cmp_lt_i32 s90,0
s_cselect_b64 vcc,0,vcc
s_cbranch_vccnz qs_188
ds_read_b64_tr_b16 a[16:17],v36 offset:4096
ds_read_b64_tr_b16 a[18:19],v36 offset:4224
ds_read_b64_tr_b16 a[20:21],v36 offset:6144
ds_read_b64_tr_b16 a[22:23],v36 offset:6272
ds_read_b64_tr_b16 a[24:25],v36 offset:12288
ds_read_b64_tr_b16 a[26:27],v36 offset:12416
ds_read_b64_tr_b16 a[28:29],v36 offset:14336
ds_read_b64_tr_b16 a[30:31],v36 offset:14464
ds_write_b128 v33,a[32:35] offset:0
ds_write_b128 v33,a[36:39] offset:1024
ds_write_b128 v33,a[40:43] offset:2048
ds_write_b128 v33,a[44:47] offset:3072
s_waitcnt lgkmcnt(0)
v_mov_b32 v38,3
ds_write_b32 v37,v38 offset:4
qs_189:
ds_read_b32 v39,v37 offset:0
s_sub_u32 s90,s90,1
s_waitcnt lgkmcnt(0)
v_cmp_gt_u32 vcc,v38,v39
s_cmp_lt_i32 s90,0
s_cselect_b64 vcc,0,vcc
s_cbranch_vccnz qs_189
ds_read_b64_tr_b16 a[32:33],v36 offset:0
ds_read_b64_tr_b16 a[34:35],v36 offset:128
ds_read_b64_tr_b16 a[36:37],v36 offset:2048
ds_read_b64_tr_b16 a[38:39],v36 offset:2176
ds_read_b64_tr_b16 a[40:41],v36 offset:8192
ds_read_b64_tr_b16 a[42:43],v36 offset:8320
ds_read_b64_tr_b16 a[44:45],v36 offset:10240
ds_read_b64_tr_b16 a[46:47],v36 offset:10368
ds_write_b128 v33,a[48:51] offset:4096
ds_write_b128 v33,a[52:55] offset:5120
ds_write_b128 v33,a[56:59] offset:6144
ds_write_b128 v33,a[60:63] offset:7168
s_waitcnt lgkmcnt(0)
v_mov_b32 v38,4
ds_write_b32 v37,v38 offset:4
qs_190:
ds_read_b32 v39,v37 offset:0
s_sub_u32 s90,s90,1
s_waitcnt lgkmcnt(0)
v_cmp_gt_u32 vcc,v38,v39
s_cmp_lt_i32 s90,0
s_cselect_b64 vcc,0,vcc
s_cbranch_vccnz qs_190
ds_read_b64_tr_b16 a[48:49],v36 offset:4096
ds_read_b64_tr_b16 a[50:51],v36 offset:4224
ds_read_b64_tr_b16 a[52:53],v36 offset:6144
ds_read_b64_tr_b16 a[54:55],v36 offset:6272
ds_read_b64_tr_b16 a[56:57],v36 offset:12288
ds_read_b64_tr_b16 a[58:59],v36 offset:12416
ds_read_b64_tr_b16 a[60:61],v36 offset:14336
ds_read_b64_tr_b16 a[62:63],v36 offset:14464
ds_write_b128 v33,a[64:67] offset:0
ds_write_b128 v33,a[68:71] offset:1024
ds_write_b128 v33,a[72:75] offset:2048
ds_write_b128 v33,a[76:79] offset:3072
s_waitcnt lgkmcnt(0)
v_mov_b32 v38,5
ds_write_b32 v37,v38 offset:4
qs_191:
ds_read_b32 v39,v37 offset:0
s_sub_u32 s90,s90,1
s_waitcnt lgkmcnt(0)
v_cmp_gt_u32 vcc,v38,v39
s_cmp_lt_i32 s90,0
s_cselect_b64 vcc,0,vcc
s_cbranch_vccnz qs_191
ds_read_b64_tr_b16 a[64:65],v36 offset:0
ds_read_b64_tr_b16 a[66:67],v36 offset:128
ds_read_b64_tr_b16 a[68:69],v36 offset:2048
ds_read_b64_tr_b16 a[70:71],v36 offset:2176
ds_read_b64_tr_b16 a[72:73],v36 offset:8192
ds_read_b64_tr_b16 a[74:75],v36 offset:8320
ds_read_b64_tr_b16 a[76:77],v36 offset:10240
ds_read_b64_tr_b16 a[78:79],v36 offset:10368
ds_write_b128 v33,a[80:83] offset:4096
ds_write_b128 v33,a[84:87] offset:5120
ds_write_b128 v33,a[88:91] offset:6144
ds_write_b128 v33,a[92:95] offset:7168
s_waitcnt lgkmcnt(0)
v_mov_b32 v38,6
ds_write_b32 v37,v38 offset:4
qs_192:
ds_read_b32 v39,v37 offset:0
s_sub_u32 s90,s90,1
s_waitcnt lgkmcnt(0)
v_cmp_gt_u32 vcc,v38,v39
s_cmp_lt_i32 s90,0
s_cselect_b64 vcc,0,vcc
s_cbranch_vccnz qs_192
ds_read_b64_tr_b16 a[80:81],v36 offset:4096
ds_read_b64_tr_b16 a[82:83],v36 offset:4224
ds_read_b64_tr_b16 a[84:85],v36 offset:6144
ds_read_b64_tr_b16 a[86:87],v36 offset:6272
ds_read_b64_tr_b16 a[88:89],v36 offset:12288
ds_read_b64_tr_b16 a[90:91],v36 offset:12416
ds_read_b64_tr_b16 a[92:93],v36 offset:14336
ds_read_b64_tr_b16 a[94:95],v36 offset:14464
ds_write_b128 v33,a[96:99] offset:0
ds_write_b128 v33,a[100:103] offset:1024
ds_write_b128 v33,a[104:107] offset:2048
ds_write_b128 v33,a[108:111] offset:3072
s_waitcnt lgkmcnt(0)
v_mov_b32 v38,7
ds_write_b32 v37,v38 offset:4
qs_193:
ds_read_b32 v39,v37 offset:0
s_sub_u32 s90,s90,1
s_waitcnt lgkmcnt(0)
v_cmp_gt_u32 vcc,v38,v39
s_cmp_lt_i32 s90,0
s_cselect_b64 vcc,0,vcc
s_cbranch_vccnz qs_193
ds_read_b64_tr_b16 a[96:97],v36 offset:0
ds_read_b64_tr_b16 a[98:99],v36 offset:128
ds_read_b64_tr_b16 a[100:101],v36 offset:2048
ds_read_b64_tr_b16 a[102:103],v36 offset:2176
ds_read_b64_tr_b16 a[104:105],v36 offset:8192
ds_read_b64_tr_b16 a[106:107],v36 offset:8320
ds_read_b64_tr_b16 a[108:109],v36 offset:10240
ds_read_b64_tr_b16 a[110:111],v36 offset:10368
ds_write_b128 v33,a[112:115] offset:4096
ds_write_b128 v33,a[116:119] offset:5120
ds_write_b128 v33,a[120:123] offset:6144
ds_write_b128 v33,a[124:127] offset:7168
s_waitcnt lgkmcnt(0)
v_mov_b32 v38,8
ds_write_b32 v37,v38 offset:4
qs_194:
ds_read_b32 v39,v37 offset:0
s_sub_u32 s90,s90,1
s_waitcnt lgkmcnt(0)
v_cmp_gt_u32 vcc,v38,v39
s_cmp_lt_i32 s90,0
s_cselect_b64 vcc,0,vcc
s_cbranch_vccnz qs_194
ds_read_b64_tr_b16 a[112:113],v36 offset:4096
ds_read_b64_tr_b16 a[114:115],v36 offset:4224
ds_read_b64_tr_b16 a[116:117],v36 offset:6144
ds_read_b64_tr_b16 a[118:119],v36 offset:6272
ds_read_b64_tr_b16 a[120:121],v36 offset:12288
ds_read_b64_tr_b16 a[122:123],v36 offset:12416
ds_read_b64_tr_b16 a[124:125],v36 offset:14336
ds_read_b64_tr_b16 a[126:127],v36 offset:14464
s_waitcnt lgkmcnt(0)
v_mov_b32 v38,9
ds_write_b32 v37,v38 offset:4
qs_195:
ds_read_b32 v39,v37 offset:0
s_sub_u32 s90,s90,1
s_waitcnt lgkmcnt(0)
v_cmp_gt_u32 vcc,v38,v39
s_cmp_lt_i32 s90,0
s_cselect_b64 vcc,0,vcc
s_cbranch_vccnz qs_195
ds_write_b128 v33,a[128:131] offset:0
ds_write_b128 v33,a[132:135] offset:1024
ds_write_b128 v33,a[136:139] offset:2048
ds_write_b128 v33,a[140:143] offset:3072
s_waitcnt lgkmcnt(0)
ds_read_b64_tr_b16 a[128:129],v34 offset:0
ds_read_b64_tr_b16 a[130:131],v34 offset:128
ds_read_b64_tr_b16 a[132:133],v34 offset:2048
ds_read_b64_tr_b16 a[134:135],v34 offset:2176
ds_read_b64_tr_b16 a[136:137],v34 offset:32
ds_read_b64_tr_b16 a[138:139],v34 offset:160
ds_read_b64_tr_b16 a[140:141],v34 offset:2080
ds_read_b64_tr_b16 a[142:143],v34 offset:2208
ds_write_b128 v33,a[144:147] offset:4096
ds_write_b128 v33,a[148:151] offset:5120
ds_write_b128 v33,a[152:155] offset:6144
ds_write_b128 v33,a[156:159] offset:7168
s_waitcnt lgkmcnt(0)
ds_read_b64_tr_b16 a[144:145],v34 offset:4096
ds_read_b64_tr_b16 a[146:147],v34 offset:4224
ds_read_b64_tr_b16 a[148:149],v34 offset:6144
ds_read_b64_tr_b16 a[150:151],v34 offset:6272
ds_read_b64_tr_b16 a[152:153],v34 offset:4128
ds_read_b64_tr_b16 a[154:155],v34 offset:4256
ds_read_b64_tr_b16 a[156:157],v34 offset:6176
ds_read_b64_tr_b16 a[158:159],v34 offset:6304
ds_write_b128 v33,a[160:163] offset:0
ds_write_b128 v33,a[164:167] offset:1024
ds_write_b128 v33,a[168:171] offset:2048
ds_write_b128 v33,a[172:175] offset:3072
s_waitcnt lgkmcnt(0)
ds_read_b64_tr_b16 a[160:161],v34 offset:0
ds_read_b64_tr_b16 a[162:163],v34 offset:128
ds_read_b64_tr_b16 a[164:165],v34 offset:2048
ds_read_b64_tr_b16 a[166:167],v34 offset:2176
ds_read_b64_tr_b16 a[168:169],v34 offset:32
ds_read_b64_tr_b16 a[170:171],v34 offset:160
ds_read_b64_tr_b16 a[172:173],v34 offset:2080
ds_read_b64_tr_b16 a[174:175],v34 offset:2208
free_196:
ds_read_b64 v[38:39],v37 offset:8
s_sub_u32 s90,s90,1
s_waitcnt lgkmcnt(0)
v_and_b32 v38,v38,v39
v_cmp_eq_u32 vcc,0,v38
s_cmp_lt_i32 s90,0
s_cselect_b64 vcc,0,vcc
s_cbranch_vccnz free_196
s_xor_b32 s64,s61,10493952
buffer_store_dwordx4 v[100:103],v206,s[20:23],s64 offen sc1
buffer_store_dwordx4 v[100:103],v207,s[20:23],s64 offen sc1
s_xor_b32 s64,s61,12582912
buffer_store_dwordx4 v[100:103],v206,s[20:23],s64 offen sc1
buffer_store_dwordx4 v[100:103],v207,s[20:23],s64 offen sc1
s_xor_b32 s64,s61,14688256
buffer_store_dwordx4 v[100:103],v206,s[20:23],s64 offen sc1
buffer_store_dwordx4 v[100:103],v207,s[20:23],s64 offen sc1
s_mov_b32 m0,32768
s_mov_b32 s65,221184
buffer_load_dwordx4 v16,s[20:23],s65 offen offset:0 lds
buffer_load_dwordx4 v16,s[20:23],s65 offen offset:1024 lds
buffer_load_dwordx4 v16,s[20:23],s65 offen offset:2048 lds
buffer_load_dwordx4 v16,s[20:23],s65 offen offset:3072 lds
s_mov_b32 m0,36864
s_mov_b32 s65,225280
buffer_load_dwordx4 v16,s[20:23],s65 offen offset:0 lds
buffer_load_dwordx4 v16,s[20:23],s65 offen offset:1024 lds
buffer_load_dwordx4 v16,s[20:23],s65 offen offset:2048 lds
buffer_load_dwordx4 v16,s[20:23],s65 offen offset:3072 lds
s_mov_b32 m0,40960
s_mov_b32 s65,229376
buffer_load_dwordx4 v16,s[20:23],s65 offen offset:0 lds
buffer_load_dwordx4 v16,s[20:23],s65 offen offset:1024 lds
buffer_load_dwordx4 v16,s[20:23],s65 offen offset:2048 lds
buffer_load_dwordx4 v16,s[20:23],s65 offen offset:3072 lds
s_mov_b32 m0,45056
s_mov_b32 s65,233472
buffer_load_dwordx4 v16,s[20:23],s65 offen offset:0 lds
buffer_load_dwordx4 v16,s[20:23],s65 offen offset:1024 lds
buffer_load_dwordx4 v16,s[20:23],s65 offen offset:2048 lds
buffer_load_dwordx4 v16,s[20:23],s65 offen offset:3072 lds
s_mov_b32 m0,49152
s_mov_b32 s65,237568
buffer_load_dwordx4 v16,s[20:23],s65 offen offset:0 lds
buffer_load_dwordx4 v16,s[20:23],s65 offen offset:1024 lds
buffer_load_dwordx4 v16,s[20:23],s65 offen offset:2048 lds
buffer_load_dwordx4 v16,s[20:23],s65 offen offset:3072 lds
s_mov_b32 m0,53248
s_mov_b32 s65,241664
buffer_load_dwordx4 v16,s[20:23],s65 offen offset:0 lds
buffer_load_dwordx4 v16,s[20:23],s65 offen offset:1024 lds
buffer_load_dwordx4 v16,s[20:23],s65 offen offset:2048 lds
buffer_load_dwordx4 v16,s[20:23],s65 offen offset:3072 lds
s_mov_b32 m0,57344
s_mov_b32 s65,245760
buffer_load_dwordx4 v16,s[20:23],s65 offen offset:0 lds
buffer_load_dwordx4 v16,s[20:23],s65 offen offset:1024 lds
buffer_load_dwordx4 v16,s[20:23],s65 offen offset:2048 lds
buffer_load_dwordx4 v16,s[20:23],s65 offen offset:3072 lds
s_mov_b32 m0,61440
s_mov_b32 s65,249856
buffer_load_dwordx4 v16,s[20:23],s65 offen offset:0 lds
buffer_load_dwordx4 v16,s[20:23],s65 offen offset:1024 lds
buffer_load_dwordx4 v16,s[20:23],s65 offen offset:2048 lds
buffer_load_dwordx4 v16,s[20:23],s65 offen offset:3072 lds
s_waitcnt vmcnt(54)
ds_write_b128 v33,a[176:179] offset:4096
ds_write_b128 v33,a[180:183] offset:5120
ds_write_b128 v33,a[184:187] offset:6144
ds_write_b128 v33,a[188:191] offset:7168
s_waitcnt lgkmcnt(0)
ds_read_b64_tr_b16 a[176:177],v34 offset:4096
ds_read_b64_tr_b16 a[178:179],v34 offset:4224
ds_read_b64_tr_b16 a[180:181],v34 offset:6144
ds_read_b64_tr_b16 a[182:183],v34 offset:6272
ds_read_b64_tr_b16 a[184:185],v34 offset:4128
ds_read_b64_tr_b16 a[186:187],v34 offset:4256
ds_read_b64_tr_b16 a[188:189],v34 offset:6176
ds_read_b64_tr_b16 a[190:191],v34 offset:6304
s_waitcnt vmcnt(50)
ds_write_b128 v33,a[192:195] offset:0
ds_write_b128 v33,a[196:199] offset:1024
ds_write_b128 v33,a[200:203] offset:2048
ds_write_b128 v33,a[204:207] offset:3072
s_waitcnt lgkmcnt(0)
ds_read_b64_tr_b16 a[192:193],v34 offset:0
ds_read_b64_tr_b16 a[194:195],v34 offset:128
ds_read_b64_tr_b16 a[196:197],v34 offset:2048
ds_read_b64_tr_b16 a[198:199],v34 offset:2176
ds_read_b64_tr_b16 a[200:201],v34 offset:32
ds_read_b64_tr_b16 a[202:203],v34 offset:160
ds_read_b64_tr_b16 a[204:205],v34 offset:2080
ds_read_b64_tr_b16 a[206:207],v34 offset:2208
s_waitcnt vmcnt(46)
ds_write_b128 v33,a[208:211] offset:4096
ds_write_b128 v33,a[212:215] offset:5120
ds_write_b128 v33,a[216:219] offset:6144
ds_write_b128 v33,a[220:223] offset:7168
s_waitcnt lgkmcnt(0)
ds_read_b64_tr_b16 a[208:209],v34 offset:4096
ds_read_b64_tr_b16 a[210:211],v34 offset:4224
ds_read_b64_tr_b16 a[212:213],v34 offset:6144
ds_read_b64_tr_b16 a[214:215],v34 offset:6272
ds_read_b64_tr_b16 a[216:217],v34 offset:4128
ds_read_b64_tr_b16 a[218:219],v34 offset:4256
ds_read_b64_tr_b16 a[220:221],v34 offset:6176
ds_read_b64_tr_b16 a[222:223],v34 offset:6304
s_waitcnt vmcnt(42)
ds_write_b128 v33,a[224:227] offset:0
ds_write_b128 v33,a[228:231] offset:1024
ds_write_b128 v33,a[232:235] offset:2048
ds_write_b128 v33,a[236:239] offset:3072
s_waitcnt lgkmcnt(0)
ds_read_b64_tr_b16 a[224:225],v34 offset:0
ds_read_b64_tr_b16 a[226:227],v34 offset:128
ds_read_b64_tr_b16 a[228:229],v34 offset:2048
ds_read_b64_tr_b16 a[230:231],v34 offset:2176
ds_read_b64_tr_b16 a[232:233],v34 offset:32
ds_read_b64_tr_b16 a[234:235],v34 offset:160
ds_read_b64_tr_b16 a[236:237],v34 offset:2080
ds_read_b64_tr_b16 a[238:239],v34 offset:2208
s_waitcnt vmcnt(38)
ds_write_b128 v33,a[240:243] offset:4096
ds_write_b128 v33,a[244:247] offset:5120
ds_write_b128 v33,a[248:251] offset:6144
ds_write_b128 v33,a[252:255] offset:7168
s_waitcnt lgkmcnt(0)
ds_read_b64_tr_b16 a[240:241],v34 offset:4096
ds_read_b64_tr_b16 a[242:243],v34 offset:4224
ds_read_b64_tr_b16 a[244:245],v34 offset:6144
ds_read_b64_tr_b16 a[246:247],v34 offset:6272
ds_read_b64_tr_b16 a[248:249],v34 offset:4128
ds_read_b64_tr_b16 a[250:251],v34 offset:4256
ds_read_b64_tr_b16 a[252:253],v34 offset:6176
ds_read_b64_tr_b16 a[254:255],v34 offset:6304
s_mov_b32 s79,0
s_add_u32 s63,s79,0
s_and_b32 s64,s63,3
s_lshl_b32 s70,s64,20
s_add_u32 s65,s63,2
s_and_b32 s65,s65,3
s_lshl_b32 s73,s65,20
s_add_u32 s55,s63,3
s_lshl_b32 s78,s55,16
s_add_u32 s78,s78,57344
s_cmp_lt_u32 s55,64
s_cselect_b32 s78,s78,0x7fff0000
s_add_u32 s71,s70,65536
s_add_u32 s60,s63,1
s_and_b32 s60,s60,3
s_lshl_b32 s72,s60,20
v_mov_b32 v184,0
v_mov_b32 v185,0
v_mov_b32 v186,0
v_mov_b32 v187,0
v_mov_b32 v188,0
v_mov_b32 v189,0
v_mov_b32 v190,0
v_mov_b32 v191,0
s_lshl_b32 s74,s63,21
s_lshl_b32 s55,s63,13
s_and_b32 s55,s55,0x2000
s_xor_b32 s55,s55,s61
s_add_u32 s74,s74,s55
v_mov_b32 v176,0
v_mov_b32 v177,0
v_mov_b32 v178,0
v_mov_b32 v179,0
v_mov_b32 v25,1
s_waitcnt vmcnt(0) lgkmcnt(0)
s_barrier
v_max_u32 v216,1,v216
v_max_u32 v217,1,v217
v_max_u32 v218,1,v218
v_max_u32 v219,1,v219
s_mov_b64 exec,s[84:85]
buffer_store_dwordx4 v[216:219],v12,s[24:27],s70 offen
buffer_store_dwordx4 v[216:219],v12,s[28:31],s70 offen sc1
s_mov_b64 exec,1
buffer_store_dword v25,v13,s[24:27],s70 offen
buffer_store_dword v25,v13,s[28:31],s70 offen sc1
s_mov_b64 exec,-1
s_branch loop_152
end_57:
s_waitcnt vmcnt(0)
s_barrier
s_mov_b32 s50,s91
done_1:
s_endpgm
pipe_worker:
v_and_b32 v1,63,v0
v_and_b32 v3,15,v1
v_lshrrev_b32 v4,4,v1
v_lshlrev_b32 v16,4,v1
v_mov_b32 v48,0
v_mov_b32 v49,0
v_mov_b32 v50,0
v_mov_b32 v51,0
s_lshr_b32 s58,s55,5
s_and_b32 s59,s55,31
s_xor_b32 s62,s61,0x2000
s_add_u32 s63,s62,21053440
s_lshr_b32 s64,s59,4
s_and_b32 s59,s59,15
s_lshr_b32 s65,s58,1
s_lshl_b32 s65,s65,4
s_add_u32 s59,s59,s65
s_mul_i32 s65,s64,3
s_add_u32 s64,s64,1
s_sub_u32 s58,s58,1
s_cmp_lt_u32 s58,2
s_cselect_b32 s58,s64,s65
s_load_dwordx2 s[4:5],s[0:1],16
v_lshlrev_b32 v5,4,v0
s_lshl_b32 s64,s55,14
s_add_u32 s64,s64,17825792
buffer_store_dwordx4 v[48:51],v5,s[20:23],s64 offen sc1
s_add_u32 s64,s64,4096
buffer_store_dwordx4 v[48:51],v5,s[20:23],s64 offen sc1
s_add_u32 s64,s64,4096
buffer_store_dwordx4 v[48:51],v5,s[20:23],s64 offen sc1
s_add_u32 s64,s64,4096
buffer_store_dwordx4 v[48:51],v5,s[20:23],s64 offen sc1
s_add_u32 s64,s64,4096
s_lshl_b32 s64,s55,12
s_add_u32 s64,s64,8577024
buffer_store_dwordx4 v[48:51],v5,s[20:23],s64 offen sc1
s_lshr_b32 s79,s55,5
s_add_u32 s64,s79,8
s_lshl_b32 s93,s64,21
s_lshl_b32 s64,s64,13
s_and_b32 s64,s64,0x2000
s_xor_b32 s64,s64,s61
s_add_u32 s93,s93,s64
s_add_u32 s93,s93,29360128
s_and_b32 s64,s55,31
s_add_u32 s64,s64,96
s_lshl_b32 s64,s64,14
s_add_u32 s93,s93,s64
s_waitcnt lgkmcnt(0)
s_mov_b32 s32,s4
s_and_b32 s33,s5,0xffff
s_mov_b32 s34,0x800000
s_mov_b32 s35,0x20000
v_lshrrev_b32 v5,3,v3
v_bfe_u32 v6,v3,2,1
v_lshl_add_u32 v7,v5,3,v6
v_lshl_add_u32 v6,v5,2,v6
v_lshrrev_b32 v5,1,v4
v_lshl_add_u32 v7,v5,4,v7
v_and_b32 v5,1,v4
v_lshl_add_u32 v7,v5,2,v7
v_lshl_add_u32 v6,v5,1,v6
v_bfe_u32 v5,v3,1,1
s_lshl_b32 s64,s50,1
v_add_u32 v5,s64,v5
v_xor_b32 v5,v5,v6
v_lshlrev_b32 v5,5,v5
v_lshl_add_u32 v5,v7,8,v5
v_and_b32 v6,1,v3
v_lshl_add_u32 v12,v6,4,v5
s_lshl_b32 s66,s59,8
v_and_b32 v5,15,v1
v_and_b32 v6,1,v4
v_lshlrev_b32 v6,1,v6
v_xor_b32 v5,v5,v6
v_mul_u32_u24 v6,8192,v4
v_xor_b32 v7,0,v5
v_lshl_add_u32 v8,v7,4,v6
v_xor_b32 v7,4,v5
v_lshl_add_u32 v9,v7,4,v6
v_xor_b32 v7,8,v5
v_lshl_add_u32 v10,v7,4,v6
v_xor_b32 v7,12,v5
v_lshl_add_u32 v11,v7,4,v6
s_mul_i32 s74,s50,524288
s_add_u32 s74,s74,s66
s_lshl_b32 s75,s50,14
s_mul_i32 s76,s50,262144
s_add_u32 s76,s76,s66
s_lshl_b32 s77,s50,13
s_add_u32 s64,s74,0
s_add_u32 m0,s75,0
s_nop 0
buffer_load_dwordx4 v8,s[32:35],s64 offen nt lds
s_add_u32 s64,s74,32768
s_add_u32 m0,s75,1024
s_nop 0
buffer_load_dwordx4 v9,s[32:35],s64 offen nt lds
s_add_u32 s64,s74,65536
s_add_u32 m0,s75,2048
s_nop 0
buffer_load_dwordx4 v10,s[32:35],s64 offen nt lds
s_add_u32 s64,s74,98304
s_add_u32 m0,s75,3072
s_nop 0
buffer_load_dwordx4 v11,s[32:35],s64 offen nt lds
s_add_u32 s64,s74,131072
s_add_u32 m0,s75,4096
s_nop 0
buffer_load_dwordx4 v8,s[32:35],s64 offen nt lds
s_add_u32 s64,s74,163840
s_add_u32 m0,s75,5120
s_nop 0
buffer_load_dwordx4 v9,s[32:35],s64 offen nt lds
s_add_u32 s64,s74,196608
s_add_u32 m0,s75,6144
s_nop 0
buffer_load_dwordx4 v10,s[32:35],s64 offen nt lds
s_add_u32 s64,s74,229376
s_add_u32 m0,s75,7168
s_nop 0
buffer_load_dwordx4 v11,s[32:35],s64 offen nt lds
s_add_u32 s64,s74,262144
s_add_u32 m0,s75,8192
s_nop 0
buffer_load_dwordx4 v8,s[32:35],s64 offen nt lds
s_add_u32 s64,s74,294912
s_add_u32 m0,s75,9216
s_nop 0
buffer_load_dwordx4 v9,s[32:35],s64 offen nt lds
s_add_u32 s64,s74,327680
s_add_u32 m0,s75,10240
s_nop 0
buffer_load_dwordx4 v10,s[32:35],s64 offen nt lds
s_add_u32 s64,s74,360448
s_add_u32 m0,s75,11264
s_nop 0
buffer_load_dwordx4 v11,s[32:35],s64 offen nt lds
s_add_u32 s64,s74,393216
s_add_u32 m0,s75,12288
s_nop 0
buffer_load_dwordx4 v8,s[32:35],s64 offen nt lds
s_add_u32 s64,s74,425984
s_add_u32 m0,s75,13312
s_nop 0
buffer_load_dwordx4 v9,s[32:35],s64 offen nt lds
s_add_u32 s64,s74,458752
s_add_u32 m0,s75,14336
s_nop 0
buffer_load_dwordx4 v10,s[32:35],s64 offen nt lds
s_add_u32 s64,s74,491520
s_add_u32 m0,s75,15360
s_nop 0
buffer_load_dwordx4 v11,s[32:35],s64 offen nt lds
s_add_u32 s64,s74,2097152
s_add_u32 m0,s75,65536
s_nop 0
buffer_load_dwordx4 v8,s[32:35],s64 offen nt lds
s_add_u32 s64,s74,2129920
s_add_u32 m0,s75,66560
s_nop 0
buffer_load_dwordx4 v9,s[32:35],s64 offen nt lds
s_add_u32 s64,s74,2162688
s_add_u32 m0,s75,67584
s_nop 0
buffer_load_dwordx4 v10,s[32:35],s64 offen nt lds
s_add_u32 s64,s74,2195456
s_add_u32 m0,s75,68608
s_nop 0
buffer_load_dwordx4 v11,s[32:35],s64 offen nt lds
s_add_u32 s64,s74,2228224
s_add_u32 m0,s75,69632
s_nop 0
buffer_load_dwordx4 v8,s[32:35],s64 offen nt lds
s_add_u32 s64,s74,2260992
s_add_u32 m0,s75,70656
s_nop 0
buffer_load_dwordx4 v9,s[32:35],s64 offen nt lds
s_add_u32 s64,s74,2293760
s_add_u32 m0,s75,71680
s_nop 0
buffer_load_dwordx4 v10,s[32:35],s64 offen nt lds
s_add_u32 s64,s74,2326528
s_add_u32 m0,s75,72704
s_nop 0
buffer_load_dwordx4 v11,s[32:35],s64 offen nt lds
s_add_u32 s64,s74,2359296
s_add_u32 m0,s75,73728
s_nop 0
buffer_load_dwordx4 v8,s[32:35],s64 offen nt lds
s_add_u32 s64,s74,2392064
s_add_u32 m0,s75,74752
s_nop 0
buffer_load_dwordx4 v9,s[32:35],s64 offen nt lds
s_add_u32 s64,s74,2424832
s_add_u32 m0,s75,75776
s_nop 0
buffer_load_dwordx4 v10,s[32:35],s64 offen nt lds
s_add_u32 s64,s74,2457600
s_add_u32 m0,s75,76800
s_nop 0
buffer_load_dwordx4 v11,s[32:35],s64 offen nt lds
s_add_u32 s64,s74,2490368
s_add_u32 m0,s75,77824
s_nop 0
buffer_load_dwordx4 v8,s[32:35],s64 offen nt lds
s_add_u32 s64,s74,2523136
s_add_u32 m0,s75,78848
s_nop 0
buffer_load_dwordx4 v9,s[32:35],s64 offen nt lds
s_add_u32 s64,s74,2555904
s_add_u32 m0,s75,79872
s_nop 0
buffer_load_dwordx4 v10,s[32:35],s64 offen nt lds
s_add_u32 s64,s74,2588672
s_add_u32 m0,s75,80896
s_nop 0
buffer_load_dwordx4 v11,s[32:35],s64 offen nt lds
s_waitcnt vmcnt(16)
s_barrier
ds_read_b64_tr_b16 a[0:1],v12 offset:0
ds_read_b64_tr_b16 a[2:3],v12 offset:512
ds_read_b64_tr_b16 a[128:129],v12 offset:8
ds_read_b64_tr_b16 a[130:131],v12 offset:520
ds_read_b64_tr_b16 a[4:5],v12 offset:8192
ds_read_b64_tr_b16 a[6:7],v12 offset:8704
ds_read_b64_tr_b16 a[132:133],v12 offset:8200
ds_read_b64_tr_b16 a[134:135],v12 offset:8712
s_waitcnt lgkmcnt(4)
ds_read_b64_tr_b16 a[8:9],v12 offset:16384
ds_read_b64_tr_b16 a[10:11],v12 offset:16896
ds_read_b64_tr_b16 a[136:137],v12 offset:16392
ds_read_b64_tr_b16 a[138:139],v12 offset:16904
ds_read_b64_tr_b16 a[12:13],v12 offset:24576
ds_read_b64_tr_b16 a[14:15],v12 offset:25088
ds_read_b64_tr_b16 a[140:141],v12 offset:24584
ds_read_b64_tr_b16 a[142:143],v12 offset:25096
s_waitcnt lgkmcnt(4)
ds_read_b64_tr_b16 a[16:17],v12 offset:32768
ds_read_b64_tr_b16 a[18:19],v12 offset:33280
ds_read_b64_tr_b16 a[144:145],v12 offset:32776
ds_read_b64_tr_b16 a[146:147],v12 offset:33288
ds_read_b64_tr_b16 a[20:21],v12 offset:40960
ds_read_b64_tr_b16 a[22:23],v12 offset:41472
ds_read_b64_tr_b16 a[148:149],v12 offset:40968
ds_read_b64_tr_b16 a[150:151],v12 offset:41480
s_waitcnt lgkmcnt(4)
ds_read_b64_tr_b16 a[24:25],v12 offset:49152
ds_read_b64_tr_b16 a[26:27],v12 offset:49664
ds_read_b64_tr_b16 a[152:153],v12 offset:49160
ds_read_b64_tr_b16 a[154:155],v12 offset:49672
ds_read_b64_tr_b16 a[28:29],v12 offset:57344
ds_read_b64_tr_b16 a[30:31],v12 offset:57856
ds_read_b64_tr_b16 a[156:157],v12 offset:57352
ds_read_b64_tr_b16 a[158:159],v12 offset:57864
s_waitcnt lgkmcnt(4)
v_xor_b32 v12,0x10000,v12
s_waitcnt lgkmcnt(0)
s_barrier
s_add_u32 s64,s74,4194304
s_add_u32 m0,s75,0
s_nop 0
buffer_load_dwordx4 v8,s[32:35],s64 offen nt lds
s_add_u32 s64,s74,4227072
s_add_u32 m0,s75,1024
s_nop 0
buffer_load_dwordx4 v9,s[32:35],s64 offen nt lds
s_add_u32 s64,s74,4259840
s_add_u32 m0,s75,2048
s_nop 0
buffer_load_dwordx4 v10,s[32:35],s64 offen nt lds
s_add_u32 s64,s74,4292608
s_add_u32 m0,s75,3072
s_nop 0
buffer_load_dwordx4 v11,s[32:35],s64 offen nt lds
s_add_u32 s64,s74,4325376
s_add_u32 m0,s75,4096
s_nop 0
buffer_load_dwordx4 v8,s[32:35],s64 offen nt lds
s_add_u32 s64,s74,4358144
s_add_u32 m0,s75,5120
s_nop 0
buffer_load_dwordx4 v9,s[32:35],s64 offen nt lds
s_add_u32 s64,s74,4390912
s_add_u32 m0,s75,6144
s_nop 0
buffer_load_dwordx4 v10,s[32:35],s64 offen nt lds
s_add_u32 s64,s74,4423680
s_add_u32 m0,s75,7168
s_nop 0
buffer_load_dwordx4 v11,s[32:35],s64 offen nt lds
s_add_u32 s64,s74,4456448
s_add_u32 m0,s75,8192
s_nop 0
buffer_load_dwordx4 v8,s[32:35],s64 offen nt lds
s_add_u32 s64,s74,4489216
s_add_u32 m0,s75,9216
s_nop 0
buffer_load_dwordx4 v9,s[32:35],s64 offen nt lds
s_add_u32 s64,s74,4521984
s_add_u32 m0,s75,10240
s_nop 0
buffer_load_dwordx4 v10,s[32:35],s64 offen nt lds
s_add_u32 s64,s74,4554752
s_add_u32 m0,s75,11264
s_nop 0
buffer_load_dwordx4 v11,s[32:35],s64 offen nt lds
s_add_u32 s64,s74,4587520
s_add_u32 m0,s75,12288
s_nop 0
buffer_load_dwordx4 v8,s[32:35],s64 offen nt lds
s_add_u32 s64,s74,4620288
s_add_u32 m0,s75,13312
s_nop 0
buffer_load_dwordx4 v9,s[32:35],s64 offen nt lds
s_add_u32 s64,s74,4653056
s_add_u32 m0,s75,14336
s_nop 0
buffer_load_dwordx4 v10,s[32:35],s64 offen nt lds
s_add_u32 s64,s74,4685824
s_add_u32 m0,s75,15360
s_nop 0
buffer_load_dwordx4 v11,s[32:35],s64 offen nt lds
s_waitcnt vmcnt(16)
s_barrier
ds_read_b64_tr_b16 a[32:33],v12 offset:0
ds_read_b64_tr_b16 a[34:35],v12 offset:512
ds_read_b64_tr_b16 a[160:161],v12 offset:8
ds_read_b64_tr_b16 a[162:163],v12 offset:520
ds_read_b64_tr_b16 a[36:37],v12 offset:8192
ds_read_b64_tr_b16 a[38:39],v12 offset:8704
ds_read_b64_tr_b16 a[164:165],v12 offset:8200
ds_read_b64_tr_b16 a[166:167],v12 offset:8712
s_waitcnt lgkmcnt(4)
ds_read_b64_tr_b16 a[40:41],v12 offset:16384
ds_read_b64_tr_b16 a[42:43],v12 offset:16896
ds_read_b64_tr_b16 a[168:169],v12 offset:16392
ds_read_b64_tr_b16 a[170:171],v12 offset:16904
ds_read_b64_tr_b16 a[44:45],v12 offset:24576
ds_read_b64_tr_b16 a[46:47],v12 offset:25088
ds_read_b64_tr_b16 a[172:173],v12 offset:24584
ds_read_b64_tr_b16 a[174:175],v12 offset:25096
s_waitcnt lgkmcnt(4)
ds_read_b64_tr_b16 a[48:49],v12 offset:32768
ds_read_b64_tr_b16 a[50:51],v12 offset:33280
ds_read_b64_tr_b16 a[176:177],v12 offset:32776
ds_read_b64_tr_b16 a[178:179],v12 offset:33288
ds_read_b64_tr_b16 a[52:53],v12 offset:40960
ds_read_b64_tr_b16 a[54:55],v12 offset:41472
ds_read_b64_tr_b16 a[180:181],v12 offset:40968
ds_read_b64_tr_b16 a[182:183],v12 offset:41480
s_waitcnt lgkmcnt(4)
ds_read_b64_tr_b16 a[56:57],v12 offset:49152
ds_read_b64_tr_b16 a[58:59],v12 offset:49664
ds_read_b64_tr_b16 a[184:185],v12 offset:49160
ds_read_b64_tr_b16 a[186:187],v12 offset:49672
ds_read_b64_tr_b16 a[60:61],v12 offset:57344
ds_read_b64_tr_b16 a[62:63],v12 offset:57856
ds_read_b64_tr_b16 a[188:189],v12 offset:57352
ds_read_b64_tr_b16 a[190:191],v12 offset:57864
s_waitcnt lgkmcnt(4)
v_xor_b32 v12,0x10000,v12
s_waitcnt lgkmcnt(0)
s_barrier
s_add_u32 s64,s74,6291456
s_add_u32 m0,s75,65536
s_nop 0
buffer_load_dwordx4 v8,s[32:35],s64 offen nt lds
s_add_u32 s64,s74,6324224
s_add_u32 m0,s75,66560
s_nop 0
buffer_load_dwordx4 v9,s[32:35],s64 offen nt lds
s_add_u32 s64,s74,6356992
s_add_u32 m0,s75,67584
s_nop 0
buffer_load_dwordx4 v10,s[32:35],s64 offen nt lds
s_add_u32 s64,s74,6389760
s_add_u32 m0,s75,68608
s_nop 0
buffer_load_dwordx4 v11,s[32:35],s64 offen nt lds
s_add_u32 s64,s74,6422528
s_add_u32 m0,s75,69632
s_nop 0
buffer_load_dwordx4 v8,s[32:35],s64 offen nt lds
s_add_u32 s64,s74,6455296
s_add_u32 m0,s75,70656
s_nop 0
buffer_load_dwordx4 v9,s[32:35],s64 offen nt lds
s_add_u32 s64,s74,6488064
s_add_u32 m0,s75,71680
s_nop 0
buffer_load_dwordx4 v10,s[32:35],s64 offen nt lds
s_add_u32 s64,s74,6520832
s_add_u32 m0,s75,72704
s_nop 0
buffer_load_dwordx4 v11,s[32:35],s64 offen nt lds
s_add_u32 s64,s74,6553600
s_add_u32 m0,s75,73728
s_nop 0
buffer_load_dwordx4 v8,s[32:35],s64 offen nt lds
s_add_u32 s64,s74,6586368
s_add_u32 m0,s75,74752
s_nop 0
buffer_load_dwordx4 v9,s[32:35],s64 offen nt lds
s_add_u32 s64,s74,6619136
s_add_u32 m0,s75,75776
s_nop 0
buffer_load_dwordx4 v10,s[32:35],s64 offen nt lds
s_add_u32 s64,s74,6651904
s_add_u32 m0,s75,76800
s_nop 0
buffer_load_dwordx4 v11,s[32:35],s64 offen nt lds
s_add_u32 s64,s74,6684672
s_add_u32 m0,s75,77824
s_nop 0
buffer_load_dwordx4 v8,s[32:35],s64 offen nt lds
s_add_u32 s64,s74,6717440
s_add_u32 m0,s75,78848
s_nop 0
buffer_load_dwordx4 v9,s[32:35],s64 offen nt lds
s_add_u32 s64,s74,6750208
s_add_u32 m0,s75,79872
s_nop 0
buffer_load_dwordx4 v10,s[32:35],s64 offen nt lds
s_add_u32 s64,s74,6782976
s_add_u32 m0,s75,80896
s_nop 0
buffer_load_dwordx4 v11,s[32:35],s64 offen nt lds
s_waitcnt vmcnt(16)
s_barrier
ds_read_b64_tr_b16 a[64:65],v12 offset:0
ds_read_b64_tr_b16 a[66:67],v12 offset:512
ds_read_b64_tr_b16 a[192:193],v12 offset:8
ds_read_b64_tr_b16 a[194:195],v12 offset:520
ds_read_b64_tr_b16 a[68:69],v12 offset:8192
ds_read_b64_tr_b16 a[70:71],v12 offset:8704
ds_read_b64_tr_b16 a[196:197],v12 offset:8200
ds_read_b64_tr_b16 a[198:199],v12 offset:8712
s_waitcnt lgkmcnt(4)
ds_read_b64_tr_b16 a[72:73],v12 offset:16384
ds_read_b64_tr_b16 a[74:75],v12 offset:16896
ds_read_b64_tr_b16 a[200:201],v12 offset:16392
ds_read_b64_tr_b16 a[202:203],v12 offset:16904
ds_read_b64_tr_b16 a[76:77],v12 offset:24576
ds_read_b64_tr_b16 a[78:79],v12 offset:25088
ds_read_b64_tr_b16 a[204:205],v12 offset:24584
ds_read_b64_tr_b16 a[206:207],v12 offset:25096
s_waitcnt lgkmcnt(4)
ds_read_b64_tr_b16 a[80:81],v12 offset:32768
ds_read_b64_tr_b16 a[82:83],v12 offset:33280
ds_read_b64_tr_b16 a[208:209],v12 offset:32776
ds_read_b64_tr_b16 a[210:211],v12 offset:33288
ds_read_b64_tr_b16 a[84:85],v12 offset:40960
ds_read_b64_tr_b16 a[86:87],v12 offset:41472
ds_read_b64_tr_b16 a[212:213],v12 offset:40968
ds_read_b64_tr_b16 a[214:215],v12 offset:41480
s_waitcnt lgkmcnt(4)
ds_read_b64_tr_b16 a[88:89],v12 offset:49152
ds_read_b64_tr_b16 a[90:91],v12 offset:49664
ds_read_b64_tr_b16 a[216:217],v12 offset:49160
ds_read_b64_tr_b16 a[218:219],v12 offset:49672
ds_read_b64_tr_b16 a[92:93],v12 offset:57344
ds_read_b64_tr_b16 a[94:95],v12 offset:57856
ds_read_b64_tr_b16 a[220:221],v12 offset:57352
ds_read_b64_tr_b16 a[222:223],v12 offset:57864
s_waitcnt lgkmcnt(4)
v_xor_b32 v12,0x10000,v12
s_waitcnt lgkmcnt(0)
s_barrier
s_waitcnt vmcnt(0)
s_barrier
ds_read_b64_tr_b16 a[96:97],v12 offset:0
ds_read_b64_tr_b16 a[98:99],v12 offset:512
ds_read_b64_tr_b16 a[224:225],v12 offset:8
ds_read_b64_tr_b16 a[226:227],v12 offset:520
ds_read_b64_tr_b16 a[100:101],v12 offset:8192
ds_read_b64_tr_b16 a[102:103],v12 offset:8704
ds_read_b64_tr_b16 a[228:229],v12 offset:8200
ds_read_b64_tr_b16 a[230:231],v12 offset:8712
s_waitcnt lgkmcnt(4)
ds_read_b64_tr_b16 a[104:105],v12 offset:16384
ds_read_b64_tr_b16 a[106:107],v12 offset:16896
ds_read_b64_tr_b16 a[232:233],v12 offset:16392
ds_read_b64_tr_b16 a[234:235],v12 offset:16904
ds_read_b64_tr_b16 a[108:109],v12 offset:24576
ds_read_b64_tr_b16 a[110:111],v12 offset:25088
ds_read_b64_tr_b16 a[236:237],v12 offset:24584
ds_read_b64_tr_b16 a[238:239],v12 offset:25096
s_waitcnt lgkmcnt(4)
ds_read_b64_tr_b16 a[112:113],v12 offset:32768
ds_read_b64_tr_b16 a[114:115],v12 offset:33280
ds_read_b64_tr_b16 a[240:241],v12 offset:32776
ds_read_b64_tr_b16 a[242:243],v12 offset:33288
ds_read_b64_tr_b16 a[116:117],v12 offset:40960
ds_read_b64_tr_b16 a[118:119],v12 offset:41472
ds_read_b64_tr_b16 a[244:245],v12 offset:40968
ds_read_b64_tr_b16 a[246:247],v12 offset:41480
s_waitcnt lgkmcnt(4)
ds_read_b64_tr_b16 a[120:121],v12 offset:49152
ds_read_b64_tr_b16 a[122:123],v12 offset:49664
ds_read_b64_tr_b16 a[248:249],v12 offset:49160
ds_read_b64_tr_b16 a[250:251],v12 offset:49672
ds_read_b64_tr_b16 a[124:125],v12 offset:57344
ds_read_b64_tr_b16 a[126:127],v12 offset:57856
ds_read_b64_tr_b16 a[252:253],v12 offset:57352
ds_read_b64_tr_b16 a[254:255],v12 offset:57864
s_waitcnt lgkmcnt(4)
v_xor_b32 v12,0x10000,v12
s_waitcnt lgkmcnt(0)
s_barrier
v_and_b32 v21,7,v1
v_lshlrev_b32 v21,6,v21
s_mov_b32 s65,21052416
s_mov_b32 s66,1792
pl_200:
buffer_load_dword v22,v21,s[20:23],s65 offen sc1
s_waitcnt vmcnt(0)
v_cmp_gt_u32 vcc,s66,v22
s_cbranch_vccz pok_201
s_sleep 1
s_sub_u32 s90,s90,1
s_cmp_gt_i32 s90,0
s_cbranch_scc1 pl_200
pok_201:
s_lshl_b32 s72,s50,14
s_lshl_b32 s74,s58,16
s_add_u32 s74,s74,s72
s_add_u32 s74,s74,57344
v_mov_b32 v17,v16
s_lshl_b32 s64,s59,14
s_lshl_b32 s65,s50,11
s_add_u32 s64,s64,s65
v_add_u32 v18,s64,v16
s_lshl_b32 s73,s58,5
s_add_u32 s73,s73,s59
s_lshl_b32 s73,s73,2
s_add_u32 s73,s73,s63
v_lshlrev_b32 v24,4,v0
s_mov_b32 s79,s58
s_add_u32 m0,s72,0
s_add_u32 s65,s74,0
buffer_load_dwordx4 v16,s[20:23],s65 offen offset:0  lds
buffer_load_dwordx4 v16,s[20:23],s65 offen offset:1024  lds
buffer_load_dwordx4 v16,s[20:23],s65 offen offset:2048  lds
buffer_load_dwordx4 v16,s[20:23],s65 offen offset:3072  lds
s_add_u32 m0,s72,4096
s_add_u32 s65,s74,4096
buffer_load_dwordx4 v16,s[20:23],s65 offen offset:0  lds
buffer_load_dwordx4 v16,s[20:23],s65 offen offset:1024  lds
buffer_load_dwordx4 v16,s[20:23],s65 offen offset:2048  lds
buffer_load_dwordx4 v16,s[20:23],s65 offen offset:3072  lds
s_add_u32 m0,s72,8192
s_add_u32 s65,s74,8192
buffer_load_dwordx4 v16,s[20:23],s65 offen offset:0  lds
buffer_load_dwordx4 v16,s[20:23],s65 offen offset:1024  lds
buffer_load_dwordx4 v16,s[20:23],s65 offen offset:2048  lds
buffer_load_dwordx4 v16,s[20:23],s65 offen offset:3072  lds
s_add_u32 m0,s72,12288
s_add_u32 s65,s74,12288
buffer_load_dwordx4 v16,s[20:23],s65 offen offset:0  lds
buffer_load_dwordx4 v16,s[20:23],s65 offen offset:1024  lds
buffer_load_dwordx4 v16,s[20:23],s65 offen offset:2048  lds
buffer_load_dwordx4 v16,s[20:23],s65 offen offset:3072  lds
s_waitcnt vmcnt(0)
s_add_u32 s41,s58,55
s_sub_u32 s64,s58,1
s_cmp_lt_u32 s64,2
s_cselect_b32 s41,s41,64
s_lshl_b32 s76,s50,14
s_add_u32 s76,s76,57344
s_add_u32 s42,s55,32
s_lshl_b32 s42,s42,14
s_add_u32 s42,s42,136314880
s_xor_b32 s64,s62,8192
s_add_u32 s42,s42,s64
s_sub_u32 s64,s42,2097152
s_xor_b32 s64,s64,0x2000
s_cmp_lt_u32 s55,104
s_cselect_b32 s64,s64,0x7fff0000
s_cmp_lt_u32 s55,96
s_cselect_b32 s42,s42,s64
v_add_u32 v25,4096,v24
s_load_dwordx2 s[4:5],s[0:1],96
s_load_dwordx2 s[6:7],s[0:1],104
v_and_b32 v5,3,v0
v_lshrrev_b32 v6,2,v0
v_mul_u32_u24 v112,12288,v6
v_lshl_add_u32 v112,v5,4,v112
v_lshlrev_b32 v113,1,v6
s_add_u32 s43,s55,64
s_lshl_b32 s43,s43,6
s_mov_b32 s48,0
s_mov_b32 s80,0xffff0000
s_mov_b32 s81,0xbfb8aa3b
s_waitcnt lgkmcnt(0)
s_mov_b32 s12,s4
s_and_b32 s13,s5,0xffff
s_mov_b32 s14,0x800
s_mov_b32 s15,0x20000
s_mov_b32 s16,s6
s_and_b32 s17,s7,0xffff
s_mov_b32 s18,0xc00000
s_mov_b32 s19,0x20000
buffer_load_dwordx4 v[104:107],v112,s[16:19],s43 offen nt
buffer_load_ushort v108,v113,s[12:15],s48 offen
s_add_u32 s43,s43,786432
s_add_u32 s48,s48,128
buffer_load_dwordx4 v[116:119],v112,s[16:19],s43 offen nt
buffer_load_ushort v120,v113,s[12:15],s48 offen
s_add_u32 s43,s43,786432
s_add_u32 s48,s48,128
v_mov_b32 v96,0
v_mov_b32 v97,0
v_mov_b32 v98,0
v_mov_b32 v99,0
v_mov_b32 v100,0
v_mov_b32 v101,0
v_mov_b32 v102,0
v_mov_b32 v103,0
s_waitcnt vmcnt(0)
qloop_202:
s_lshr_b32 s64,s79,2
s_cmp_lg_u32 s64,4
s_cbranch_scc1 np2_204
s_waitcnt vmcnt(0)
s_barrier
s_cmp_lg_u32 s50,0
s_cbranch_scc1 ow_205
s_mov_b64 exec,1
v_mov_b32 v22,14
v_mov_b32 v23,0
s_mov_b32 s64,21052928
buffer_atomic_add v22,v23,s[20:23],s64 offen sc1
s_mov_b64 exec,-1
ow_205:
np2_204:
s_cmp_lg_u32 s79,s41
s_cbranch_scc1 npz_203
s_waitcnt vmcnt(0)
s_barrier
s_cmp_lg_u32 s50,0
s_cbranch_scc1 ow_206
s_mov_b64 exec,1
v_mov_b32 v22,14
v_mov_b32 v23,0
s_mov_b32 s64,21052992
buffer_atomic_add v22,v23,s[20:23],s64 offen sc1
s_mov_b64 exec,-1
ow_206:
s_cmp_lg_u32 s50,0
s_cbranch_scc1 ow_207
s_mov_b64 exec,1
v_mov_b32 v22,14
v_mov_b32 v23,0
buffer_store_dword v22,v23,s[20:23],s73 offen sc1
s_mov_b64 exec,-1
ow_207:
npz_203:
s_waitcnt vmcnt(8)
s_barrier
ds_read_b128 v[224:227],v17 offset:0
ds_read_b128 v[228:231],v17 offset:2048
ds_read_b128 v[232:235],v17 offset:4096
ds_read_b128 v[236:239],v17 offset:6144
ds_read_b128 v[240:243],v17 offset:8192
ds_read_b128 v[244:247],v17 offset:10240
ds_read_b128 v[248:251],v17 offset:12288
s_waitcnt lgkmcnt(5)
v_mfma_f32_16x16x32_bf16 v[64:67],a[0:3],v[224:227],0
s_xor_b32 s72,s72,0x10000
s_add_u32 s77,s79,2
v_mfma_f32_16x16x32_bf16 v[72:75],a[128:131],v[224:227],0
ds_read_b128 v[252:255],v17 offset:14336
s_cmp_lt_u32 s79,56
s_cselect_b32 s77,s41,s77
v_mfma_f32_16x16x32_bf16 v[64:67],a[4:7],v[228:231],v[64:67]
s_add_u32 s74,s79,4
s_cmp_lt_u32 s79,52
s_cselect_b32 s77,s74,s77
v_mfma_f32_16x16x32_bf16 v[72:75],a[132:135],v[228:231],v[72:75]
ds_read_b128 v[224:227],v17 offset:16384
s_waitcnt lgkmcnt(5)
v_mfma_f32_16x16x32_bf16 v[64:67],a[8:11],v[232:235],v[64:67]
s_lshl_b32 s74,s77,16
s_add_u32 s74,s74,s76
v_mfma_f32_16x16x32_bf16 v[72:75],a[136:139],v[232:235],v[72:75]
ds_read_b128 v[228:231],v17 offset:18432
s_add_u32 s64,s79,0
v_mfma_f32_16x16x32_bf16 v[64:67],a[12:15],v[236:239],v[64:67]
s_cmp_lt_u32 s77,64
s_cselect_b32 s74,s74,0x7fff0000
v_mfma_f32_16x16x32_bf16 v[72:75],a[140:143],v[236:239],v[72:75]
ds_read_b128 v[232:235],v17 offset:20480
s_waitcnt lgkmcnt(5)
v_mfma_f32_16x16x32_bf16 v[64:67],a[16:19],v[240:243],v[64:67]
s_add_u32 m0,s72,0
v_lshlrev_b32 v108,16,v108
v_mfma_f32_16x16x32_bf16 v[72:75],a[144:147],v[240:243],v[72:75]
ds_read_b128 v[236:239],v17 offset:22528
v_mul_f32 v109,s81,v108
v_mfma_f32_16x16x32_bf16 v[64:67],a[20:23],v[244:247],v[64:67]
s_lshl_b32 s70,s64,21
v_mfma_f32_16x16x32_bf16 v[72:75],a[148:151],v[244:247],v[72:75]
ds_read_b128 v[240:243],v17 offset:24576
s_waitcnt lgkmcnt(5)
v_mfma_f32_16x16x32_bf16 v[64:67],a[24:27],v[248:251],v[64:67]
s_add_u32 s65,s74,0
v_mfma_f32_16x16x32_bf16 v[72:75],a[152:155],v[248:251],v[72:75]
ds_read_b128 v[244:247],v17 offset:26624
v_mfma_f32_16x16x32_bf16 v[64:67],a[28:31],v[252:255],v[64:67]
buffer_load_dwordx4 v16,s[20:23],s65 offen offset:0  lds
v_mfma_f32_16x16x32_bf16 v[72:75],a[156:159],v[252:255],v[72:75]
ds_read_b128 v[248:251],v17 offset:28672
s_waitcnt lgkmcnt(5)
v_mfma_f32_16x16x32_bf16 v[64:67],a[32:35],v[224:227],v[64:67]
s_lshl_b32 s64,s64,13
v_mfma_f32_16x16x32_bf16 v[72:75],a[160:163],v[224:227],v[72:75]
ds_read_b128 v[252:255],v17 offset:30720
v_mfma_f32_16x16x32_bf16 v[64:67],a[36:39],v[228:231],v[64:67]
buffer_load_dwordx4 v16,s[20:23],s65 offen offset:1024  lds
v_mfma_f32_16x16x32_bf16 v[72:75],a[164:167],v[228:231],v[72:75]
ds_read_b128 v[224:227],v17 offset:32768
s_waitcnt lgkmcnt(5)
v_mfma_f32_16x16x32_bf16 v[64:67],a[40:43],v[232:235],v[64:67]
buffer_load_dwordx4 v16,s[20:23],s65 offen offset:2048  lds
v_mfma_f32_16x16x32_bf16 v[72:75],a[168:171],v[232:235],v[72:75]
ds_read_b128 v[228:231],v17 offset:34816
s_and_b32 s64,s64,0x2000
v_mfma_f32_16x16x32_bf16 v[64:67],a[44:47],v[236:239],v[64:67]
v_exp_f32 v109,v109
v_mfma_f32_16x16x32_bf16 v[72:75],a[172:175],v[236:239],v[72:75]
ds_read_b128 v[232:235],v17 offset:36864
s_waitcnt lgkmcnt(5)
v_mfma_f32_16x16x32_bf16 v[64:67],a[48:51],v[240:243],v[64:67]
buffer_load_dwordx4 v16,s[20:23],s65 offen offset:3072  lds
v_mfma_f32_16x16x32_bf16 v[72:75],a[176:179],v[240:243],v[72:75]
ds_read_b128 v[236:239],v17 offset:38912
s_xor_b32 s64,s64,s62
v_mfma_f32_16x16x32_bf16 v[64:67],a[52:55],v[244:247],v[64:67]
s_add_u32 m0,s72,4096
v_add_f32 v109,1.0,v109
v_mfma_f32_16x16x32_bf16 v[72:75],a[180:183],v[244:247],v[72:75]
ds_read_b128 v[240:243],v17 offset:40960
s_waitcnt lgkmcnt(5)
v_mfma_f32_16x16x32_bf16 v[64:67],a[56:59],v[248:251],v[64:67]
v_rcp_f32 v109,v109
v_mfma_f32_16x16x32_bf16 v[72:75],a[184:187],v[248:251],v[72:75]
ds_read_b128 v[244:247],v17 offset:43008
s_add_u32 s65,s74,4096
v_mfma_f32_16x16x32_bf16 v[64:67],a[60:63],v[252:255],v[64:67]
s_add_u32 s70,s70,s64
v_mul_f32 v109,v109,v108
v_mfma_f32_16x16x32_bf16 v[72:75],a[188:191],v[252:255],v[72:75]
ds_read_b128 v[248:251],v17 offset:45056
s_waitcnt lgkmcnt(5)
v_mfma_f32_16x16x32_bf16 v[64:67],a[64:67],v[224:227],v[64:67]
buffer_load_dwordx4 v16,s[20:23],s65 offen offset:0  lds
v_mfma_f32_16x16x32_bf16 v[72:75],a[192:195],v[224:227],v[72:75]
ds_read_b128 v[252:255],v17 offset:47104
v_cvt_pk_bf16_f32 v109,v109,v109
v_mfma_f32_16x16x32_bf16 v[64:67],a[68:71],v[228:231],v[64:67]
v_and_b32 v108,s80,v109
v_lshlrev_b32 v110,16,v104
v_mfma_f32_16x16x32_bf16 v[72:75],a[196:199],v[228:231],v[72:75]
ds_read_b128 v[224:227],v17 offset:49152
s_waitcnt lgkmcnt(5)
v_mfma_f32_16x16x32_bf16 v[64:67],a[72:75],v[232:235],v[64:67]
buffer_load_dwordx4 v16,s[20:23],s65 offen offset:1024  lds
v_mfma_f32_16x16x32_bf16 v[72:75],a[200:203],v[232:235],v[72:75]
ds_read_b128 v[228:231],v17 offset:51200
s_add_u32 s70,s70,29360128
v_mfma_f32_16x16x32_bf16 v[64:67],a[76:79],v[236:239],v[64:67]
buffer_load_dwordx4 v16,s[20:23],s65 offen offset:2048  lds
v_mfma_f32_16x16x32_bf16 v[72:75],a[204:207],v[236:239],v[72:75]
ds_read_b128 v[232:235],v17 offset:53248
s_waitcnt lgkmcnt(5)
v_mfma_f32_16x16x32_bf16 v[64:67],a[80:83],v[240:243],v[64:67]
v_and_b32 v111,s80,v104
v_fmac_f32 v96,v110,v108
v_mfma_f32_16x16x32_bf16 v[72:75],a[208:211],v[240:243],v[72:75]
ds_read_b128 v[236:239],v17 offset:55296
v_fmac_f32 v97,v111,v108
v_mfma_f32_16x16x32_bf16 v[64:67],a[84:87],v[244:247],v[64:67]
buffer_load_dwordx4 v16,s[20:23],s65 offen offset:3072  lds
v_mfma_f32_16x16x32_bf16 v[72:75],a[212:215],v[244:247],v[72:75]
ds_read_b128 v[240:243],v17 offset:57344
s_waitcnt lgkmcnt(5)
v_mfma_f32_16x16x32_bf16 v[64:67],a[88:91],v[248:251],v[64:67]
s_add_u32 m0,s72,8192
v_lshlrev_b32 v110,16,v105
v_mfma_f32_16x16x32_bf16 v[72:75],a[216:219],v[248:251],v[72:75]
ds_read_b128 v[244:247],v17 offset:59392
v_and_b32 v111,s80,v105
v_mfma_f32_16x16x32_bf16 v[64:67],a[92:95],v[252:255],v[64:67]
v_fmac_f32 v98,v110,v108
v_fmac_f32 v99,v111,v108
v_mfma_f32_16x16x32_bf16 v[72:75],a[220:223],v[252:255],v[72:75]
ds_read_b128 v[248:251],v17 offset:61440
s_waitcnt lgkmcnt(5)
v_mfma_f32_16x16x32_bf16 v[64:67],a[96:99],v[224:227],v[64:67]
s_add_u32 s65,s74,8192
v_lshlrev_b32 v110,16,v106
v_mfma_f32_16x16x32_bf16 v[72:75],a[224:227],v[224:227],v[72:75]
ds_read_b128 v[252:255],v17 offset:63488
v_and_b32 v111,s80,v106
v_mfma_f32_16x16x32_bf16 v[64:67],a[100:103],v[228:231],v[64:67]
buffer_load_dwordx4 v16,s[20:23],s65 offen offset:0  lds
v_mfma_f32_16x16x32_bf16 v[72:75],a[228:231],v[228:231],v[72:75]
ds_read_b128 v[224:227],v17 offset:1024
s_waitcnt lgkmcnt(5)
v_mfma_f32_16x16x32_bf16 v[64:67],a[104:107],v[232:235],v[64:67]
v_fmac_f32 v100,v110,v108
v_fmac_f32 v101,v111,v108
v_mfma_f32_16x16x32_bf16 v[72:75],a[232:235],v[232:235],v[72:75]
ds_read_b128 v[228:231],v17 offset:3072
v_lshlrev_b32 v110,16,v107
v_mfma_f32_16x16x32_bf16 v[64:67],a[108:111],v[236:239],v[64:67]
buffer_load_dwordx4 v16,s[20:23],s65 offen offset:1024  lds
v_mfma_f32_16x16x32_bf16 v[72:75],a[236:239],v[236:239],v[72:75]
ds_read_b128 v[232:235],v17 offset:5120
s_waitcnt lgkmcnt(5)
v_mfma_f32_16x16x32_bf16 v[64:67],a[112:115],v[240:243],v[64:67]
buffer_load_dwordx4 v16,s[20:23],s65 offen offset:2048  lds
v_mfma_f32_16x16x32_bf16 v[72:75],a[240:243],v[240:243],v[72:75]
ds_read_b128 v[236:239],v17 offset:7168
v_and_b32 v111,s80,v107
v_mfma_f32_16x16x32_bf16 v[64:67],a[116:119],v[244:247],v[64:67]
v_fmac_f32 v102,v110,v108
v_fmac_f32 v103,v111,v108
v_mfma_f32_16x16x32_bf16 v[72:75],a[244:247],v[244:247],v[72:75]
ds_read_b128 v[240:243],v17 offset:9216
s_waitcnt lgkmcnt(5)
v_mfma_f32_16x16x32_bf16 v[64:67],a[120:123],v[248:251],v[64:67]
buffer_load_dwordx4 v16,s[20:23],s65 offen offset:3072  lds
v_mfma_f32_16x16x32_bf16 v[72:75],a[248:251],v[248:251],v[72:75]
ds_read_b128 v[244:247],v17 offset:11264
v_mfma_f32_16x16x32_bf16 v[64:67],a[124:127],v[252:255],v[64:67]
s_add_u32 m0,s72,12288
v_mfma_f32_16x16x32_bf16 v[72:75],a[252:255],v[252:255],v[72:75]
ds_read_b128 v[248:251],v17 offset:13312
s_waitcnt lgkmcnt(5)
v_mfma_f32_16x16x32_bf16 v[68:71],a[0:3],v[224:227],0
v_mfma_f32_16x16x32_bf16 v[76:79],a[128:131],v[224:227],0
ds_read_b128 v[252:255],v17 offset:15360
s_add_u32 s65,s74,12288
v_mfma_f32_16x16x32_bf16 v[68:71],a[4:7],v[228:231],v[68:71]
v_mfma_f32_16x16x32_bf16 v[76:79],a[132:135],v[228:231],v[76:79]
ds_read_b128 v[224:227],v17 offset:17408
s_waitcnt lgkmcnt(5)
v_mfma_f32_16x16x32_bf16 v[68:71],a[8:11],v[232:235],v[68:71]
buffer_load_dwordx4 v16,s[20:23],s65 offen offset:0  lds
v_mfma_f32_16x16x32_bf16 v[76:79],a[136:139],v[232:235],v[76:79]
ds_read_b128 v[228:231],v17 offset:19456
v_cvt_pk_bf16_f32 v88,v64,v65
v_mfma_f32_16x16x32_bf16 v[68:71],a[12:15],v[236:239],v[68:71]
v_cvt_pk_bf16_f32 v89,v66,v67
v_cvt_pk_bf16_f32 v90,v72,v73
v_mfma_f32_16x16x32_bf16 v[76:79],a[140:143],v[236:239],v[76:79]
ds_read_b128 v[232:235],v17 offset:21504
s_waitcnt lgkmcnt(5)
v_mfma_f32_16x16x32_bf16 v[68:71],a[16:19],v[240:243],v[68:71]
buffer_load_dwordx4 v16,s[20:23],s65 offen offset:1024  lds
v_mfma_f32_16x16x32_bf16 v[76:79],a[144:147],v[240:243],v[76:79]
ds_read_b128 v[236:239],v17 offset:23552
v_cvt_pk_bf16_f32 v91,v74,v75
v_mfma_f32_16x16x32_bf16 v[68:71],a[20:23],v[244:247],v[68:71]
buffer_load_dwordx4 v16,s[20:23],s65 offen offset:2048  lds
v_mfma_f32_16x16x32_bf16 v[76:79],a[148:151],v[244:247],v[76:79]
ds_read_b128 v[240:243],v17 offset:25600
s_waitcnt lgkmcnt(5)
v_mfma_f32_16x16x32_bf16 v[68:71],a[24:27],v[248:251],v[68:71]
v_mfma_f32_16x16x32_bf16 v[76:79],a[152:155],v[248:251],v[76:79]
ds_read_b128 v[244:247],v17 offset:27648
v_mfma_f32_16x16x32_bf16 v[68:71],a[28:31],v[252:255],v[68:71]
buffer_load_dwordx4 v16,s[20:23],s65 offen offset:3072  lds
v_mfma_f32_16x16x32_bf16 v[76:79],a[156:159],v[252:255],v[76:79]
ds_read_b128 v[248:251],v17 offset:29696
s_waitcnt lgkmcnt(5)
v_mfma_f32_16x16x32_bf16 v[68:71],a[32:35],v[224:227],v[68:71]
v_mfma_f32_16x16x32_bf16 v[76:79],a[160:163],v[224:227],v[76:79]
ds_read_b128 v[252:255],v17 offset:31744
v_mfma_f32_16x16x32_bf16 v[68:71],a[36:39],v[228:231],v[68:71]
v_mfma_f32_16x16x32_bf16 v[76:79],a[164:167],v[228:231],v[76:79]
ds_read_b128 v[224:227],v17 offset:33792
s_waitcnt lgkmcnt(5)
v_mfma_f32_16x16x32_bf16 v[68:71],a[40:43],v[232:235],v[68:71]
buffer_store_dwordx4 v[88:91],v18,s[20:23],s70 offen offset:0 sc1
v_mfma_f32_16x16x32_bf16 v[76:79],a[168:171],v[232:235],v[76:79]
ds_read_b128 v[228:231],v17 offset:35840
v_mfma_f32_16x16x32_bf16 v[68:71],a[44:47],v[236:239],v[68:71]
buffer_load_dwordx4 v[104:107],v112,s[16:19],s43 offen nt
v_mfma_f32_16x16x32_bf16 v[76:79],a[172:175],v[236:239],v[76:79]
ds_read_b128 v[232:235],v17 offset:37888
s_waitcnt lgkmcnt(5)
v_mfma_f32_16x16x32_bf16 v[68:71],a[48:51],v[240:243],v[68:71]
v_mfma_f32_16x16x32_bf16 v[76:79],a[176:179],v[240:243],v[76:79]
ds_read_b128 v[236:239],v17 offset:39936
v_mfma_f32_16x16x32_bf16 v[68:71],a[52:55],v[244:247],v[68:71]
buffer_load_ushort v108,v113,s[12:15],s48 offen
v_mfma_f32_16x16x32_bf16 v[76:79],a[180:183],v[244:247],v[76:79]
ds_read_b128 v[240:243],v17 offset:41984
s_waitcnt lgkmcnt(5)
v_mfma_f32_16x16x32_bf16 v[68:71],a[56:59],v[248:251],v[68:71]
s_add_u32 s43,s43,786432
v_mfma_f32_16x16x32_bf16 v[76:79],a[184:187],v[248:251],v[76:79]
ds_read_b128 v[244:247],v17 offset:44032
v_mfma_f32_16x16x32_bf16 v[68:71],a[60:63],v[252:255],v[68:71]
v_mfma_f32_16x16x32_bf16 v[76:79],a[188:191],v[252:255],v[76:79]
ds_read_b128 v[248:251],v17 offset:46080
s_waitcnt lgkmcnt(5)
v_mfma_f32_16x16x32_bf16 v[68:71],a[64:67],v[224:227],v[68:71]
s_add_u32 s48,s48,128
v_mfma_f32_16x16x32_bf16 v[76:79],a[192:195],v[224:227],v[76:79]
ds_read_b128 v[252:255],v17 offset:48128
v_mfma_f32_16x16x32_bf16 v[68:71],a[68:71],v[228:231],v[68:71]
buffer_store_dwordx4 v[48:51],v24,s[20:23],s93 offen sc1
v_mfma_f32_16x16x32_bf16 v[76:79],a[196:199],v[228:231],v[76:79]
ds_read_b128 v[224:227],v17 offset:50176
s_waitcnt lgkmcnt(5)
v_mfma_f32_16x16x32_bf16 v[68:71],a[72:75],v[232:235],v[68:71]
v_mfma_f32_16x16x32_bf16 v[76:79],a[200:203],v[232:235],v[76:79]
ds_read_b128 v[228:231],v17 offset:52224
v_mfma_f32_16x16x32_bf16 v[68:71],a[76:79],v[236:239],v[68:71]
buffer_store_dwordx4 v[48:51],v25,s[20:23],s93 offen sc1
v_mfma_f32_16x16x32_bf16 v[76:79],a[204:207],v[236:239],v[76:79]
ds_read_b128 v[232:235],v17 offset:54272
s_waitcnt lgkmcnt(5)
v_mfma_f32_16x16x32_bf16 v[68:71],a[80:83],v[240:243],v[68:71]
s_add_u32 s93,s93,8388608
v_mfma_f32_16x16x32_bf16 v[76:79],a[208:211],v[240:243],v[76:79]
ds_read_b128 v[236:239],v17 offset:56320
v_mfma_f32_16x16x32_bf16 v[68:71],a[84:87],v[244:247],v[68:71]
v_mfma_f32_16x16x32_bf16 v[76:79],a[212:215],v[244:247],v[76:79]
ds_read_b128 v[240:243],v17 offset:58368
s_waitcnt lgkmcnt(5)
v_mfma_f32_16x16x32_bf16 v[68:71],a[88:91],v[248:251],v[68:71]
s_cmp_lt_u32 s93,163577856
s_cselect_b32 s93,s93,0x7fff0000
v_mfma_f32_16x16x32_bf16 v[76:79],a[216:219],v[248:251],v[76:79]
ds_read_b128 v[244:247],v17 offset:60416
v_mfma_f32_16x16x32_bf16 v[68:71],a[92:95],v[252:255],v[68:71]
buffer_store_dwordx4 v[48:51],v24,s[20:23],s42 offen sc1
v_mfma_f32_16x16x32_bf16 v[76:79],a[220:223],v[252:255],v[76:79]
ds_read_b128 v[248:251],v17 offset:62464
s_waitcnt lgkmcnt(5)
v_mfma_f32_16x16x32_bf16 v[68:71],a[96:99],v[224:227],v[68:71]
v_mfma_f32_16x16x32_bf16 v[76:79],a[224:227],v[224:227],v[76:79]
ds_read_b128 v[252:255],v17 offset:64512
v_mfma_f32_16x16x32_bf16 v[68:71],a[100:103],v[228:231],v[68:71]
buffer_store_dwordx4 v[48:51],v25,s[20:23],s42 offen sc1
v_mfma_f32_16x16x32_bf16 v[76:79],a[228:231],v[228:231],v[76:79]
s_waitcnt lgkmcnt(4)
v_mfma_f32_16x16x32_bf16 v[68:71],a[104:107],v[232:235],v[68:71]
s_add_u32 s42,s42,2097152
v_mfma_f32_16x16x32_bf16 v[76:79],a[232:235],v[232:235],v[76:79]
v_mfma_f32_16x16x32_bf16 v[68:71],a[108:111],v[236:239],v[68:71]
v_mfma_f32_16x16x32_bf16 v[76:79],a[236:239],v[236:239],v[76:79]
s_xor_b32 s42,s42,0x2000
s_waitcnt lgkmcnt(2)
v_mfma_f32_16x16x32_bf16 v[68:71],a[112:115],v[240:243],v[68:71]
v_mfma_f32_16x16x32_bf16 v[76:79],a[240:243],v[240:243],v[76:79]
v_mfma_f32_16x16x32_bf16 v[68:71],a[116:119],v[244:247],v[68:71]
s_cmp_lt_u32 s42,165675008
s_cselect_b32 s42,s42,0x7fff0000
v_mfma_f32_16x16x32_bf16 v[76:79],a[244:247],v[244:247],v[76:79]
s_waitcnt lgkmcnt(0)
v_mfma_f32_16x16x32_bf16 v[68:71],a[120:123],v[248:251],v[68:71]
v_mfma_f32_16x16x32_bf16 v[76:79],a[248:251],v[248:251],v[76:79]
v_mfma_f32_16x16x32_bf16 v[68:71],a[124:127],v[252:255],v[68:71]
v_mfma_f32_16x16x32_bf16 v[76:79],a[252:255],v[252:255],v[76:79]
v_xor_b32 v17,0x10000,v17
s_mov_b32 s79,s77
s_nop 4
v_cvt_pk_bf16_f32 v92,v68,v69
v_cvt_pk_bf16_f32 v93,v70,v71
v_cvt_pk_bf16_f32 v94,v76,v77
v_cvt_pk_bf16_f32 v95,v78,v79
buffer_store_dwordx4 v[92:95],v18,s[20:23],s70 offen offset:1024 sc1
s_waitcnt vmcnt(8)
s_barrier
ds_read_b128 v[224:227],v17 offset:0
ds_read_b128 v[228:231],v17 offset:2048
ds_read_b128 v[232:235],v17 offset:4096
ds_read_b128 v[236:239],v17 offset:6144
ds_read_b128 v[240:243],v17 offset:8192
ds_read_b128 v[244:247],v17 offset:10240
ds_read_b128 v[248:251],v17 offset:12288
s_waitcnt lgkmcnt(5)
v_mfma_f32_16x16x32_bf16 v[64:67],a[0:3],v[224:227],0
s_xor_b32 s72,s72,0x10000
s_add_u32 s77,s79,2
v_mfma_f32_16x16x32_bf16 v[72:75],a[128:131],v[224:227],0
ds_read_b128 v[252:255],v17 offset:14336
s_cmp_lt_u32 s79,56
s_cselect_b32 s77,s41,s77
v_mfma_f32_16x16x32_bf16 v[64:67],a[4:7],v[228:231],v[64:67]
s_add_u32 s74,s79,4
s_cmp_lt_u32 s79,52
s_cselect_b32 s77,s74,s77
v_mfma_f32_16x16x32_bf16 v[72:75],a[132:135],v[228:231],v[72:75]
ds_read_b128 v[224:227],v17 offset:16384
s_waitcnt lgkmcnt(5)
v_mfma_f32_16x16x32_bf16 v[64:67],a[8:11],v[232:235],v[64:67]
s_lshl_b32 s74,s77,16
s_add_u32 s74,s74,s76
v_mfma_f32_16x16x32_bf16 v[72:75],a[136:139],v[232:235],v[72:75]
ds_read_b128 v[228:231],v17 offset:18432
s_add_u32 s64,s79,0
v_mfma_f32_16x16x32_bf16 v[64:67],a[12:15],v[236:239],v[64:67]
s_cmp_lt_u32 s77,64
s_cselect_b32 s74,s74,0x7fff0000
v_mfma_f32_16x16x32_bf16 v[72:75],a[140:143],v[236:239],v[72:75]
ds_read_b128 v[232:235],v17 offset:20480
s_waitcnt lgkmcnt(5)
v_mfma_f32_16x16x32_bf16 v[64:67],a[16:19],v[240:243],v[64:67]
s_add_u32 m0,s72,0
v_lshlrev_b32 v120,16,v120
v_mfma_f32_16x16x32_bf16 v[72:75],a[144:147],v[240:243],v[72:75]
ds_read_b128 v[236:239],v17 offset:22528
v_mul_f32 v109,s81,v120
v_mfma_f32_16x16x32_bf16 v[64:67],a[20:23],v[244:247],v[64:67]
s_lshl_b32 s70,s64,21
v_mfma_f32_16x16x32_bf16 v[72:75],a[148:151],v[244:247],v[72:75]
ds_read_b128 v[240:243],v17 offset:24576
s_waitcnt lgkmcnt(5)
v_mfma_f32_16x16x32_bf16 v[64:67],a[24:27],v[248:251],v[64:67]
s_add_u32 s65,s74,0
v_mfma_f32_16x16x32_bf16 v[72:75],a[152:155],v[248:251],v[72:75]
ds_read_b128 v[244:247],v17 offset:26624
v_mfma_f32_16x16x32_bf16 v[64:67],a[28:31],v[252:255],v[64:67]
buffer_load_dwordx4 v16,s[20:23],s65 offen offset:0  lds
v_mfma_f32_16x16x32_bf16 v[72:75],a[156:159],v[252:255],v[72:75]
ds_read_b128 v[248:251],v17 offset:28672
s_waitcnt lgkmcnt(5)
v_mfma_f32_16x16x32_bf16 v[64:67],a[32:35],v[224:227],v[64:67]
s_lshl_b32 s64,s64,13
v_mfma_f32_16x16x32_bf16 v[72:75],a[160:163],v[224:227],v[72:75]
ds_read_b128 v[252:255],v17 offset:30720
v_mfma_f32_16x16x32_bf16 v[64:67],a[36:39],v[228:231],v[64:67]
buffer_load_dwordx4 v16,s[20:23],s65 offen offset:1024  lds
v_mfma_f32_16x16x32_bf16 v[72:75],a[164:167],v[228:231],v[72:75]
ds_read_b128 v[224:227],v17 offset:32768
s_waitcnt lgkmcnt(5)
v_mfma_f32_16x16x32_bf16 v[64:67],a[40:43],v[232:235],v[64:67]
buffer_load_dwordx4 v16,s[20:23],s65 offen offset:2048  lds
v_mfma_f32_16x16x32_bf16 v[72:75],a[168:171],v[232:235],v[72:75]
ds_read_b128 v[228:231],v17 offset:34816
s_and_b32 s64,s64,0x2000
v_mfma_f32_16x16x32_bf16 v[64:67],a[44:47],v[236:239],v[64:67]
v_exp_f32 v109,v109
v_mfma_f32_16x16x32_bf16 v[72:75],a[172:175],v[236:239],v[72:75]
ds_read_b128 v[232:235],v17 offset:36864
s_waitcnt lgkmcnt(5)
v_mfma_f32_16x16x32_bf16 v[64:67],a[48:51],v[240:243],v[64:67]
buffer_load_dwordx4 v16,s[20:23],s65 offen offset:3072  lds
v_mfma_f32_16x16x32_bf16 v[72:75],a[176:179],v[240:243],v[72:75]
ds_read_b128 v[236:239],v17 offset:38912
s_xor_b32 s64,s64,s62
v_mfma_f32_16x16x32_bf16 v[64:67],a[52:55],v[244:247],v[64:67]
s_add_u32 m0,s72,4096
v_add_f32 v109,1.0,v109
v_mfma_f32_16x16x32_bf16 v[72:75],a[180:183],v[244:247],v[72:75]
ds_read_b128 v[240:243],v17 offset:40960
s_waitcnt lgkmcnt(5)
v_mfma_f32_16x16x32_bf16 v[64:67],a[56:59],v[248:251],v[64:67]
v_rcp_f32 v109,v109
v_mfma_f32_16x16x32_bf16 v[72:75],a[184:187],v[248:251],v[72:75]
ds_read_b128 v[244:247],v17 offset:43008
s_add_u32 s65,s74,4096
v_mfma_f32_16x16x32_bf16 v[64:67],a[60:63],v[252:255],v[64:67]
s_add_u32 s70,s70,s64
v_mul_f32 v109,v109,v120
v_mfma_f32_16x16x32_bf16 v[72:75],a[188:191],v[252:255],v[72:75]
ds_read_b128 v[248:251],v17 offset:45056
s_waitcnt lgkmcnt(5)
v_mfma_f32_16x16x32_bf16 v[64:67],a[64:67],v[224:227],v[64:67]
buffer_load_dwordx4 v16,s[20:23],s65 offen offset:0  lds
v_mfma_f32_16x16x32_bf16 v[72:75],a[192:195],v[224:227],v[72:75]
ds_read_b128 v[252:255],v17 offset:47104
v_cvt_pk_bf16_f32 v109,v109,v109
v_mfma_f32_16x16x32_bf16 v[64:67],a[68:71],v[228:231],v[64:67]
v_and_b32 v120,s80,v109
v_lshlrev_b32 v110,16,v116
v_mfma_f32_16x16x32_bf16 v[72:75],a[196:199],v[228:231],v[72:75]
ds_read_b128 v[224:227],v17 offset:49152
s_waitcnt lgkmcnt(5)
v_mfma_f32_16x16x32_bf16 v[64:67],a[72:75],v[232:235],v[64:67]
buffer_load_dwordx4 v16,s[20:23],s65 offen offset:1024  lds
v_mfma_f32_16x16x32_bf16 v[72:75],a[200:203],v[232:235],v[72:75]
ds_read_b128 v[228:231],v17 offset:51200
s_add_u32 s70,s70,29360128
v_mfma_f32_16x16x32_bf16 v[64:67],a[76:79],v[236:239],v[64:67]
buffer_load_dwordx4 v16,s[20:23],s65 offen offset:2048  lds
v_mfma_f32_16x16x32_bf16 v[72:75],a[204:207],v[236:239],v[72:75]
ds_read_b128 v[232:235],v17 offset:53248
s_waitcnt lgkmcnt(5)
v_mfma_f32_16x16x32_bf16 v[64:67],a[80:83],v[240:243],v[64:67]
v_and_b32 v111,s80,v116
v_fmac_f32 v96,v110,v120
v_mfma_f32_16x16x32_bf16 v[72:75],a[208:211],v[240:243],v[72:75]
ds_read_b128 v[236:239],v17 offset:55296
v_fmac_f32 v97,v111,v120
v_mfma_f32_16x16x32_bf16 v[64:67],a[84:87],v[244:247],v[64:67]
buffer_load_dwordx4 v16,s[20:23],s65 offen offset:3072  lds
v_mfma_f32_16x16x32_bf16 v[72:75],a[212:215],v[244:247],v[72:75]
ds_read_b128 v[240:243],v17 offset:57344
s_waitcnt lgkmcnt(5)
v_mfma_f32_16x16x32_bf16 v[64:67],a[88:91],v[248:251],v[64:67]
s_add_u32 m0,s72,8192
v_lshlrev_b32 v110,16,v117
v_mfma_f32_16x16x32_bf16 v[72:75],a[216:219],v[248:251],v[72:75]
ds_read_b128 v[244:247],v17 offset:59392
v_and_b32 v111,s80,v117
v_mfma_f32_16x16x32_bf16 v[64:67],a[92:95],v[252:255],v[64:67]
v_fmac_f32 v98,v110,v120
v_fmac_f32 v99,v111,v120
v_mfma_f32_16x16x32_bf16 v[72:75],a[220:223],v[252:255],v[72:75]
ds_read_b128 v[248:251],v17 offset:61440
s_waitcnt lgkmcnt(5)
v_mfma_f32_16x16x32_bf16 v[64:67],a[96:99],v[224:227],v[64:67]
s_add_u32 s65,s74,8192
v_lshlrev_b32 v110,16,v118
v_mfma_f32_16x16x32_bf16 v[72:75],a[224:227],v[224:227],v[72:75]
ds_read_b128 v[252:255],v17 offset:63488
v_and_b32 v111,s80,v118
v_mfma_f32_16x16x32_bf16 v[64:67],a[100:103],v[228:231],v[64:67]
buffer_load_dwordx4 v16,s[20:23],s65 offen offset:0  lds
v_mfma_f32_16x16x32_bf16 v[72:75],a[228:231],v[228:231],v[72:75]
ds_read_b128 v[224:227],v17 offset:1024
s_waitcnt lgkmcnt(5)
v_mfma_f32_16x16x32_bf16 v[64:67],a[104:107],v[232:235],v[64:67]
v_fmac_f32 v100,v110,v120
v_fmac_f32 v101,v111,v120
v_mfma_f32_16x16x32_bf16 v[72:75],a[232:235],v[232:235],v[72:75]
ds_read_b128 v[228:231],v17 offset:3072
v_lshlrev_b32 v110,16,v119
v_mfma_f32_16x16x32_bf16 v[64:67],a[108:111],v[236:239],v[64:67]
buffer_load_dwordx4 v16,s[20:23],s65 offen offset:1024  lds
v_mfma_f32_16x16x32_bf16 v[72:75],a[236:239],v[236:239],v[72:75]
ds_read_b128 v[232:235],v17 offset:5120
s_waitcnt lgkmcnt(5)
v_mfma_f32_16x16x32_bf16 v[64:67],a[112:115],v[240:243],v[64:67]
buffer_load_dwordx4 v16,s[20:23],s65 offen offset:2048  lds
v_mfma_f32_16x16x32_bf16 v[72:75],a[240:243],v[240:243],v[72:75]
ds_read_b128 v[236:239],v17 offset:7168
v_and_b32 v111,s80,v119
v_mfma_f32_16x16x32_bf16 v[64:67],a[116:119],v[244:247],v[64:67]
v_fmac_f32 v102,v110,v120
v_fmac_f32 v103,v111,v120
v_mfma_f32_16x16x32_bf16 v[72:75],a[244:247],v[244:247],v[72:75]
ds_read_b128 v[240:243],v17 offset:9216
s_waitcnt lgkmcnt(5)
v_mfma_f32_16x16x32_bf16 v[64:67],a[120:123],v[248:251],v[64:67]
buffer_load_dwordx4 v16,s[20:23],s65 offen offset:3072  lds
v_mfma_f32_16x16x32_bf16 v[72:75],a[248:251],v[248:251],v[72:75]
ds_read_b128 v[244:247],v17 offset:11264
v_mfma_f32_16x16x32_bf16 v[64:67],a[124:127],v[252:255],v[64:67]
s_add_u32 m0,s72,12288
v_mfma_f32_16x16x32_bf16 v[72:75],a[252:255],v[252:255],v[72:75]
ds_read_b128 v[248:251],v17 offset:13312
s_waitcnt lgkmcnt(5)
v_mfma_f32_16x16x32_bf16 v[68:71],a[0:3],v[224:227],0
v_mfma_f32_16x16x32_bf16 v[76:79],a[128:131],v[224:227],0
ds_read_b128 v[252:255],v17 offset:15360
s_add_u32 s65,s74,12288
v_mfma_f32_16x16x32_bf16 v[68:71],a[4:7],v[228:231],v[68:71]
v_mfma_f32_16x16x32_bf16 v[76:79],a[132:135],v[228:231],v[76:79]
ds_read_b128 v[224:227],v17 offset:17408
s_waitcnt lgkmcnt(5)
v_mfma_f32_16x16x32_bf16 v[68:71],a[8:11],v[232:235],v[68:71]
buffer_load_dwordx4 v16,s[20:23],s65 offen offset:0  lds
v_mfma_f32_16x16x32_bf16 v[76:79],a[136:139],v[232:235],v[76:79]
ds_read_b128 v[228:231],v17 offset:19456
v_cvt_pk_bf16_f32 v88,v64,v65
v_mfma_f32_16x16x32_bf16 v[68:71],a[12:15],v[236:239],v[68:71]
v_cvt_pk_bf16_f32 v89,v66,v67
v_cvt_pk_bf16_f32 v90,v72,v73
v_mfma_f32_16x16x32_bf16 v[76:79],a[140:143],v[236:239],v[76:79]
ds_read_b128 v[232:235],v17 offset:21504
s_waitcnt lgkmcnt(5)
v_mfma_f32_16x16x32_bf16 v[68:71],a[16:19],v[240:243],v[68:71]
buffer_load_dwordx4 v16,s[20:23],s65 offen offset:1024  lds
v_mfma_f32_16x16x32_bf16 v[76:79],a[144:147],v[240:243],v[76:79]
ds_read_b128 v[236:239],v17 offset:23552
v_cvt_pk_bf16_f32 v91,v74,v75
v_mfma_f32_16x16x32_bf16 v[68:71],a[20:23],v[244:247],v[68:71]
buffer_load_dwordx4 v16,s[20:23],s65 offen offset:2048  lds
v_mfma_f32_16x16x32_bf16 v[76:79],a[148:151],v[244:247],v[76:79]
ds_read_b128 v[240:243],v17 offset:25600
s_waitcnt lgkmcnt(5)
v_mfma_f32_16x16x32_bf16 v[68:71],a[24:27],v[248:251],v[68:71]
v_mfma_f32_16x16x32_bf16 v[76:79],a[152:155],v[248:251],v[76:79]
ds_read_b128 v[244:247],v17 offset:27648
v_mfma_f32_16x16x32_bf16 v[68:71],a[28:31],v[252:255],v[68:71]
buffer_load_dwordx4 v16,s[20:23],s65 offen offset:3072  lds
v_mfma_f32_16x16x32_bf16 v[76:79],a[156:159],v[252:255],v[76:79]
ds_read_b128 v[248:251],v17 offset:29696
s_waitcnt lgkmcnt(5)
v_mfma_f32_16x16x32_bf16 v[68:71],a[32:35],v[224:227],v[68:71]
v_mfma_f32_16x16x32_bf16 v[76:79],a[160:163],v[224:227],v[76:79]
ds_read_b128 v[252:255],v17 offset:31744
v_mfma_f32_16x16x32_bf16 v[68:71],a[36:39],v[228:231],v[68:71]
v_mfma_f32_16x16x32_bf16 v[76:79],a[164:167],v[228:231],v[76:79]
ds_read_b128 v[224:227],v17 offset:33792
s_waitcnt lgkmcnt(5)
v_mfma_f32_16x16x32_bf16 v[68:71],a[40:43],v[232:235],v[68:71]
buffer_store_dwordx4 v[88:91],v18,s[20:23],s70 offen offset:0 sc1
v_mfma_f32_16x16x32_bf16 v[76:79],a[168:171],v[232:235],v[76:79]
ds_read_b128 v[228:231],v17 offset:35840
v_mfma_f32_16x16x32_bf16 v[68:71],a[44:47],v[236:239],v[68:71]
buffer_load_dwordx4 v[116:119],v112,s[16:19],s43 offen nt
v_mfma_f32_16x16x32_bf16 v[76:79],a[172:175],v[236:239],v[76:79]
ds_read_b128 v[232:235],v17 offset:37888
s_waitcnt lgkmcnt(5)
v_mfma_f32_16x16x32_bf16 v[68:71],a[48:51],v[240:243],v[68:71]
v_mfma_f32_16x16x32_bf16 v[76:79],a[176:179],v[240:243],v[76:79]
ds_read_b128 v[236:239],v17 offset:39936
v_mfma_f32_16x16x32_bf16 v[68:71],a[52:55],v[244:247],v[68:71]
buffer_load_ushort v120,v113,s[12:15],s48 offen
v_mfma_f32_16x16x32_bf16 v[76:79],a[180:183],v[244:247],v[76:79]
ds_read_b128 v[240:243],v17 offset:41984
s_waitcnt lgkmcnt(5)
v_mfma_f32_16x16x32_bf16 v[68:71],a[56:59],v[248:251],v[68:71]
s_add_u32 s43,s43,786432
v_mfma_f32_16x16x32_bf16 v[76:79],a[184:187],v[248:251],v[76:79]
ds_read_b128 v[244:247],v17 offset:44032
v_mfma_f32_16x16x32_bf16 v[68:71],a[60:63],v[252:255],v[68:71]
v_mfma_f32_16x16x32_bf16 v[76:79],a[188:191],v[252:255],v[76:79]
ds_read_b128 v[248:251],v17 offset:46080
s_waitcnt lgkmcnt(5)
v_mfma_f32_16x16x32_bf16 v[68:71],a[64:67],v[224:227],v[68:71]
s_add_u32 s48,s48,128
v_mfma_f32_16x16x32_bf16 v[76:79],a[192:195],v[224:227],v[76:79]
ds_read_b128 v[252:255],v17 offset:48128
v_mfma_f32_16x16x32_bf16 v[68:71],a[68:71],v[228:231],v[68:71]
buffer_store_dwordx4 v[48:51],v24,s[20:23],s93 offen sc1
v_mfma_f32_16x16x32_bf16 v[76:79],a[196:199],v[228:231],v[76:79]
ds_read_b128 v[224:227],v17 offset:50176
s_waitcnt lgkmcnt(5)
v_mfma_f32_16x16x32_bf16 v[68:71],a[72:75],v[232:235],v[68:71]
v_mfma_f32_16x16x32_bf16 v[76:79],a[200:203],v[232:235],v[76:79]
ds_read_b128 v[228:231],v17 offset:52224
v_mfma_f32_16x16x32_bf16 v[68:71],a[76:79],v[236:239],v[68:71]
buffer_store_dwordx4 v[48:51],v25,s[20:23],s93 offen sc1
v_mfma_f32_16x16x32_bf16 v[76:79],a[204:207],v[236:239],v[76:79]
ds_read_b128 v[232:235],v17 offset:54272
s_waitcnt lgkmcnt(5)
v_mfma_f32_16x16x32_bf16 v[68:71],a[80:83],v[240:243],v[68:71]
s_add_u32 s93,s93,8388608
v_mfma_f32_16x16x32_bf16 v[76:79],a[208:211],v[240:243],v[76:79]
ds_read_b128 v[236:239],v17 offset:56320
v_mfma_f32_16x16x32_bf16 v[68:71],a[84:87],v[244:247],v[68:71]
v_mfma_f32_16x16x32_bf16 v[76:79],a[212:215],v[244:247],v[76:79]
ds_read_b128 v[240:243],v17 offset:58368
s_waitcnt lgkmcnt(5)
v_mfma_f32_16x16x32_bf16 v[68:71],a[88:91],v[248:251],v[68:71]
s_cmp_lt_u32 s93,163577856
s_cselect_b32 s93,s93,0x7fff0000
v_mfma_f32_16x16x32_bf16 v[76:79],a[216:219],v[248:251],v[76:79]
ds_read_b128 v[244:247],v17 offset:60416
v_mfma_f32_16x16x32_bf16 v[68:71],a[92:95],v[252:255],v[68:71]
buffer_store_dwordx4 v[48:51],v24,s[20:23],s42 offen sc1
v_mfma_f32_16x16x32_bf16 v[76:79],a[220:223],v[252:255],v[76:79]
ds_read_b128 v[248:251],v17 offset:62464
s_waitcnt lgkmcnt(5)
v_mfma_f32_16x16x32_bf16 v[68:71],a[96:99],v[224:227],v[68:71]
v_mfma_f32_16x16x32_bf16 v[76:79],a[224:227],v[224:227],v[76:79]
ds_read_b128 v[252:255],v17 offset:64512
v_mfma_f32_16x16x32_bf16 v[68:71],a[100:103],v[228:231],v[68:71]
buffer_store_dwordx4 v[48:51],v25,s[20:23],s42 offen sc1
v_mfma_f32_16x16x32_bf16 v[76:79],a[228:231],v[228:231],v[76:79]
s_waitcnt lgkmcnt(4)
v_mfma_f32_16x16x32_bf16 v[68:71],a[104:107],v[232:235],v[68:71]
s_add_u32 s42,s42,2097152
v_mfma_f32_16x16x32_bf16 v[76:79],a[232:235],v[232:235],v[76:79]
v_mfma_f32_16x16x32_bf16 v[68:71],a[108:111],v[236:239],v[68:71]
v_mfma_f32_16x16x32_bf16 v[76:79],a[236:239],v[236:239],v[76:79]
s_xor_b32 s42,s42,0x2000
s_waitcnt lgkmcnt(2)
v_mfma_f32_16x16x32_bf16 v[68:71],a[112:115],v[240:243],v[68:71]
v_mfma_f32_16x16x32_bf16 v[76:79],a[240:243],v[240:243],v[76:79]
v_mfma_f32_16x16x32_bf16 v[68:71],a[116:119],v[244:247],v[68:71]
s_cmp_lt_u32 s42,165675008
s_cselect_b32 s42,s42,0x7fff0000
v_mfma_f32_16x16x32_bf16 v[76:79],a[244:247],v[244:247],v[76:79]
s_waitcnt lgkmcnt(0)
v_mfma_f32_16x16x32_bf16 v[68:71],a[120:123],v[248:251],v[68:71]
v_mfma_f32_16x16x32_bf16 v[76:79],a[248:251],v[248:251],v[76:79]
v_mfma_f32_16x16x32_bf16 v[68:71],a[124:127],v[252:255],v[68:71]
v_mfma_f32_16x16x32_bf16 v[76:79],a[252:255],v[252:255],v[76:79]
v_xor_b32 v17,0x10000,v17
s_mov_b32 s79,s77
s_nop 4
v_cvt_pk_bf16_f32 v92,v68,v69
v_cvt_pk_bf16_f32 v93,v70,v71
v_cvt_pk_bf16_f32 v94,v76,v77
v_cvt_pk_bf16_f32 v95,v78,v79
buffer_store_dwordx4 v[92:95],v18,s[20:23],s70 offen offset:1024 sc1
s_cmp_lt_u32 s79,64
s_cbranch_scc1 qloop_202
s_waitcnt vmcnt(0)
s_barrier
s_cmp_lg_u32 s41,64
s_cbranch_scc1 np3_208
s_cmp_lg_u32 s50,0
s_cbranch_scc1 ow_209
s_mov_b64 exec,1
v_mov_b32 v22,14
v_mov_b32 v23,0
s_mov_b32 s64,21052992
buffer_atomic_add v22,v23,s[20:23],s64 offen sc1
s_mov_b64 exec,-1
ow_209:
np3_208:
s_cmp_lg_u32 s50,0
s_cbranch_scc1 ow_210
s_mov_b64 exec,1
v_mov_b32 v22,18
v_mov_b32 v23,0
buffer_store_dword v22,v23,s[20:23],s73 offen sc1
s_mov_b64 exec,-1
ow_210:
v_lshlrev_b32 v108,16,v108
v_mul_f32 v109,s81,v108
v_exp_f32 v109,v109
s_nop 0
v_add_f32 v109,1.0,v109
v_rcp_f32 v109,v109
s_nop 0
v_mul_f32 v109,v109,v108
v_cvt_pk_bf16_f32 v109,v109,v109
v_and_b32 v108,s80,v109
v_lshlrev_b32 v110,16,v104
v_and_b32 v111,s80,v104
v_fmac_f32 v96,v110,v108
v_fmac_f32 v97,v111,v108
v_lshlrev_b32 v110,16,v105
v_and_b32 v111,s80,v105
v_fmac_f32 v98,v110,v108
v_fmac_f32 v99,v111,v108
v_lshlrev_b32 v110,16,v106
v_and_b32 v111,s80,v106
v_fmac_f32 v100,v110,v108
v_fmac_f32 v101,v111,v108
v_lshlrev_b32 v110,16,v107
v_and_b32 v111,s80,v107
v_fmac_f32 v102,v110,v108
v_fmac_f32 v103,v111,v108
v_lshlrev_b32 v120,16,v120
v_mul_f32 v109,s81,v120
v_exp_f32 v109,v109
s_nop 0
v_add_f32 v109,1.0,v109
v_rcp_f32 v109,v109
s_nop 0
v_mul_f32 v109,v109,v120
v_cvt_pk_bf16_f32 v109,v109,v109
v_and_b32 v120,s80,v109
v_lshlrev_b32 v110,16,v116
v_and_b32 v111,s80,v116
v_fmac_f32 v96,v110,v120
v_fmac_f32 v97,v111,v120
v_lshlrev_b32 v110,16,v117
v_and_b32 v111,s80,v117
v_fmac_f32 v98,v110,v120
v_fmac_f32 v99,v111,v120
v_lshlrev_b32 v110,16,v118
v_and_b32 v111,s80,v118
v_fmac_f32 v100,v110,v120
v_fmac_f32 v101,v111,v120
v_lshlrev_b32 v110,16,v119
v_and_b32 v111,s80,v119
v_fmac_f32 v102,v110,v120
v_fmac_f32 v103,v111,v120
v_lshlrev_b32 v5,5,v0
ds_write_b128 v5,v[96:99]
ds_write_b128 v5,v[100:103] offset:16
v_and_b32 v6,31,v0
v_lshrrev_b32 v7,5,v0
v_lshlrev_b32 v7,10,v7
v_lshl_add_u32 v7,v6,2,v7
s_waitcnt lgkmcnt(0)
s_barrier
ds_read_b32 v8,v7 offset:0
ds_read_b32 v9,v7 offset:128
ds_read_b32 v10,v7 offset:256
ds_read_b32 v11,v7 offset:384
ds_read_b32 v12,v7 offset:512
ds_read_b32 v13,v7 offset:640
ds_read_b32 v14,v7 offset:768
ds_read_b32 v15,v7 offset:896
s_waitcnt lgkmcnt(0)
v_add_f32 v8,v8,v9
v_add_f32 v8,v8,v10
v_add_f32 v8,v8,v11
v_add_f32 v8,v8,v12
v_add_f32 v8,v8,v13
v_add_f32 v8,v8,v14
v_add_f32 v8,v8,v15
v_lshlrev_b32 v5,2,v0
ds_write_b32 v5,v8 offset:8192
v_lshlrev_b32 v7,2,v6
s_waitcnt lgkmcnt(0)
s_barrier
ds_read_b32 v8,v7 offset:8192
ds_read_b32 v9,v7 offset:8320
ds_read_b32 v10,v7 offset:8448
ds_read_b32 v11,v7 offset:8576
ds_read_b32 v12,v7 offset:8704
ds_read_b32 v13,v7 offset:8832
ds_read_b32 v14,v7 offset:8960
ds_read_b32 v15,v7 offset:9088
s_waitcnt lgkmcnt(0)
v_add_f32 v8,v8,v9
v_add_f32 v8,v8,v10
v_add_f32 v8,v8,v11
v_add_f32 v8,v8,v12
v_add_f32 v8,v8,v13
v_add_f32 v8,v8,v14
v_add_f32 v8,v8,v15
v_cvt_pk_bf16_f32 v8,v8,v8
v_and_b32 v8,s80,v8
s_lshl_b32 s64,s55,7
s_add_u32 s64,s64,8192
s_cmp_lg_u32 s50,0
s_cbranch_scc1 ow_211
buffer_store_dword v8,v7,s[20:23],s64 offen sc1
ow_211:
s_waitcnt vmcnt(0)
s_barrier
s_cmp_lg_u32 s50,0
s_cbranch_scc1 ow_212
s_mov_b64 exec,1
v_mov_b32 v22,14
v_mov_b32 v23,0
s_mov_b32 s64,21052032
buffer_atomic_add v22,v23,s[20:23],s64 offen sc1
s_mov_b64 exec,-1
ow_212:
s_lshr_b32 s58,s55,5
s_and_b32 s59,s55,31
s_mov_b32 s57,65
s_mov_b32 s79,0
s_branch common_213
pipe_second:
s_cmp_ge_u32 s59,18
s_cbranch_scc1 giveup_197
s_getpc_b64 s[4:5]
pc2nd:
s_sub_u32 s8,s4,pc2nd-mega_kernel
s_subb_u32 s9,s5,0
s_and_b32 s9,s9,0xffff
s_mov_b32 s10,code_end-mega_kernel
s_mov_b32 s11,0x20000
s_lshl_b32 s12,s59,15
v_lshlrev_b32 v2,7,v0
buffer_load_dword v2,v2,s[8:11],s12 offen
s_add_u32 s55,s57,128
s_and_b32 s64,s59,1
s_lshl_b32 s65,s58,1
s_add_u32 s64,s64,s65
s_lshl_b32 s65,s59,2
s_and_b32 s65,s65,24
s_add_u32 s65,s65,s64
s_add_u32 s64,s64,24
s_cmp_ge_u32 s59,16
s_cselect_b32 s64,s64,s65
s_lshl_b32 s65,s58,3
s_add_u32 s65,s65,s59
s_lshr_b32 s58,s59,3
s_add_u32 s58,s58,1
s_cmp_lt_u32 s59,8
s_cselect_b32 s59,s65,s64
s_xor_b32 s62,s61,0x2000
s_add_u32 s63,s62,21053440
s_mov_b32 s57,65
s_mov_b32 s79,64
s_mov_b32 s90,400000
common_213:
v_and_b32 v1,63,v0
v_and_b32 v3,15,v1
v_lshrrev_b32 v4,4,v1
v_lshlrev_b32 v16,4,v1
v_mov_b32 v48,0
v_mov_b32 v49,0
v_mov_b32 v50,0
v_mov_b32 v51,0
s_mov_b64 s[24:25],s[20:21]
s_mov_b64 s[28:29],s[20:21]
s_mov_b32 s27,0x20000
s_mov_b32 s31,0x20000
s_cmp_eq_u32 s56,0
s_cselect_b32 s26,s22,0
s_cselect_b32 s30,0,s22
s_add_u32 s71,s79,1
s_lshl_b32 s60,s79,4
s_mov_b32 s98,0
s_mov_b32 s99,0
v_mov_b32 v29,0
v_cmp_eq_u32 vcc,0,v1
v_mov_b32 v23,0x40000000
s_nop 0
v_cndmask_b32 v23,v23,v48,vcc
s_mov_b32 s80,0xffff0000
s_cmp_eq_u32 s58,0
s_cbranch_scc1 r_wo_214
s_cmp_eq_u32 s58,1
s_cbranch_scc1 r_w3_215
s_cmp_eq_u32 s58,2
s_cbranch_scc1 r_w4_216
s_and_b32 s41,s59,15
s_cmp_lt_u32 s59,16
s_cbranch_scc1 r_at_219
s_cmp_ge_u32 s59,24
s_cbranch_scc1 r_w2_217
s_load_dwordx2 s[4:5],s[0:1],64
s_and_b32 s41,s59,7
s_lshl_b32 s66,s41,8
s_lshl_b32 s67,s50,1
s_waitcnt lgkmcnt(0)
s_mov_b32 s32,s4
s_and_b32 s33,s5,0xffff
s_mov_b32 s34,0x200000
s_mov_b32 s35,0x20000
v_lshrrev_b32 v5,2,v3
v_lshl_add_u32 v7,v4,3,v5
v_and_b32 v6,3,v3
v_lshlrev_b32 v6,3,v6
v_lshl_add_u32 v6,v7,8,v6
v_and_b32 v7,1,v4
v_lshl_add_u32 v5,v7,2,v5
v_xor_b32 v5,s67,v5
v_lshl_add_u32 v12,v5,5,v6
v_xor_b32 v13,32,v12
v_and_b32 v5,15,v1
v_and_b32 v6,3,v4
v_lshlrev_b32 v6,1,v6
v_xor_b32 v5,v5,v6
v_mul_u32_u24 v6,2048,v4
v_xor_b32 v7,0,v5
v_lshl_add_u32 v8,v7,4,v6
v_xor_b32 v7,8,v5
v_lshl_add_u32 v9,v7,4,v6
s_mul_i32 s74,s50,131072
s_add_u32 s74,s74,s66
s_lshl_b32 s75,s50,14
s_mul_i32 s76,s50,65536
s_add_u32 s76,s76,s66
s_lshl_b32 s77,s50,13
s_add_u32 s64,s74,0
s_add_u32 m0,s75,0
s_nop 0
buffer_load_dwordx4 v8,s[32:35],s64 offen nt lds
s_add_u32 s64,s74,8192
s_add_u32 m0,s75,1024
s_nop 0
buffer_load_dwordx4 v8,s[32:35],s64 offen nt lds
s_add_u32 s64,s74,16384
s_add_u32 m0,s75,2048
s_nop 0
buffer_load_dwordx4 v9,s[32:35],s64 offen nt lds
s_add_u32 s64,s74,24576
s_add_u32 m0,s75,3072
s_nop 0
buffer_load_dwordx4 v9,s[32:35],s64 offen nt lds
s_add_u32 s64,s74,32768
s_add_u32 m0,s75,4096
s_nop 0
buffer_load_dwordx4 v8,s[32:35],s64 offen nt lds
s_add_u32 s64,s74,40960
s_add_u32 m0,s75,5120
s_nop 0
buffer_load_dwordx4 v8,s[32:35],s64 offen nt lds
s_add_u32 s64,s74,49152
s_add_u32 m0,s75,6144
s_nop 0
buffer_load_dwordx4 v9,s[32:35],s64 offen nt lds
s_add_u32 s64,s74,57344
s_add_u32 m0,s75,7168
s_nop 0
buffer_load_dwordx4 v9,s[32:35],s64 offen nt lds
s_add_u32 s64,s74,65536
s_add_u32 m0,s75,8192
s_nop 0
buffer_load_dwordx4 v8,s[32:35],s64 offen nt lds
s_add_u32 s64,s74,73728
s_add_u32 m0,s75,9216
s_nop 0
buffer_load_dwordx4 v8,s[32:35],s64 offen nt lds
s_add_u32 s64,s74,81920
s_add_u32 m0,s75,10240
s_nop 0
buffer_load_dwordx4 v9,s[32:35],s64 offen nt lds
s_add_u32 s64,s74,90112
s_add_u32 m0,s75,11264
s_nop 0
buffer_load_dwordx4 v9,s[32:35],s64 offen nt lds
s_add_u32 s64,s74,98304
s_add_u32 m0,s75,12288
s_nop 0
buffer_load_dwordx4 v8,s[32:35],s64 offen nt lds
s_add_u32 s64,s74,106496
s_add_u32 m0,s75,13312
s_nop 0
buffer_load_dwordx4 v8,s[32:35],s64 offen nt lds
s_add_u32 s64,s74,114688
s_add_u32 m0,s75,14336
s_nop 0
buffer_load_dwordx4 v9,s[32:35],s64 offen nt lds
s_add_u32 s64,s74,122880
s_add_u32 m0,s75,15360
s_nop 0
buffer_load_dwordx4 v9,s[32:35],s64 offen nt lds
s_add_u32 s64,s74,524288
s_add_u32 m0,s75,65536
s_nop 0
buffer_load_dwordx4 v8,s[32:35],s64 offen nt lds
s_add_u32 s64,s74,532480
s_add_u32 m0,s75,66560
s_nop 0
buffer_load_dwordx4 v8,s[32:35],s64 offen nt lds
s_add_u32 s64,s74,540672
s_add_u32 m0,s75,67584
s_nop 0
buffer_load_dwordx4 v9,s[32:35],s64 offen nt lds
s_add_u32 s64,s74,548864
s_add_u32 m0,s75,68608
s_nop 0
buffer_load_dwordx4 v9,s[32:35],s64 offen nt lds
s_add_u32 s64,s74,557056
s_add_u32 m0,s75,69632
s_nop 0
buffer_load_dwordx4 v8,s[32:35],s64 offen nt lds
s_add_u32 s64,s74,565248
s_add_u32 m0,s75,70656
s_nop 0
buffer_load_dwordx4 v8,s[32:35],s64 offen nt lds
s_add_u32 s64,s74,573440
s_add_u32 m0,s75,71680
s_nop 0
buffer_load_dwordx4 v9,s[32:35],s64 offen nt lds
s_add_u32 s64,s74,581632
s_add_u32 m0,s75,72704
s_nop 0
buffer_load_dwordx4 v9,s[32:35],s64 offen nt lds
s_add_u32 s64,s74,589824
s_add_u32 m0,s75,73728
s_nop 0
buffer_load_dwordx4 v8,s[32:35],s64 offen nt lds
s_add_u32 s64,s74,598016
s_add_u32 m0,s75,74752
s_nop 0
buffer_load_dwordx4 v8,s[32:35],s64 offen nt lds
s_add_u32 s64,s74,606208
s_add_u32 m0,s75,75776
s_nop 0
buffer_load_dwordx4 v9,s[32:35],s64 offen nt lds
s_add_u32 s64,s74,614400
s_add_u32 m0,s75,76800
s_nop 0
buffer_load_dwordx4 v9,s[32:35],s64 offen nt lds
s_add_u32 s64,s74,622592
s_add_u32 m0,s75,77824
s_nop 0
buffer_load_dwordx4 v8,s[32:35],s64 offen nt lds
s_add_u32 s64,s74,630784
s_add_u32 m0,s75,78848
s_nop 0
buffer_load_dwordx4 v8,s[32:35],s64 offen nt lds
s_add_u32 s64,s74,638976
s_add_u32 m0,s75,79872
s_nop 0
buffer_load_dwordx4 v9,s[32:35],s64 offen nt lds
s_add_u32 s64,s74,647168
s_add_u32 m0,s75,80896
s_nop 0
buffer_load_dwordx4 v9,s[32:35],s64 offen nt lds
s_waitcnt vmcnt(16)
s_barrier
ds_read_b64_tr_b16 a[0:1],v12 offset:0
ds_read_b64_tr_b16 a[128:129],v13 offset:0
ds_read_b64_tr_b16 a[2:3],v12 offset:1024
ds_read_b64_tr_b16 a[130:131],v13 offset:1024
ds_read_b64_tr_b16 a[4:5],v12 offset:8192
ds_read_b64_tr_b16 a[132:133],v13 offset:8192
ds_read_b64_tr_b16 a[6:7],v12 offset:9216
ds_read_b64_tr_b16 a[134:135],v13 offset:9216
s_waitcnt lgkmcnt(4)
ds_read_b64_tr_b16 a[8:9],v12 offset:16384
ds_read_b64_tr_b16 a[136:137],v13 offset:16384
ds_read_b64_tr_b16 a[10:11],v12 offset:17408
ds_read_b64_tr_b16 a[138:139],v13 offset:17408
ds_read_b64_tr_b16 a[12:13],v12 offset:24576
ds_read_b64_tr_b16 a[140:141],v13 offset:24576
ds_read_b64_tr_b16 a[14:15],v12 offset:25600
ds_read_b64_tr_b16 a[142:143],v13 offset:25600
s_waitcnt lgkmcnt(4)
ds_read_b64_tr_b16 a[16:17],v12 offset:32768
ds_read_b64_tr_b16 a[144:145],v13 offset:32768
ds_read_b64_tr_b16 a[18:19],v12 offset:33792
ds_read_b64_tr_b16 a[146:147],v13 offset:33792
ds_read_b64_tr_b16 a[20:21],v12 offset:40960
ds_read_b64_tr_b16 a[148:149],v13 offset:40960
ds_read_b64_tr_b16 a[22:23],v12 offset:41984
ds_read_b64_tr_b16 a[150:151],v13 offset:41984
s_waitcnt lgkmcnt(4)
ds_read_b64_tr_b16 a[24:25],v12 offset:49152
ds_read_b64_tr_b16 a[152:153],v13 offset:49152
ds_read_b64_tr_b16 a[26:27],v12 offset:50176
ds_read_b64_tr_b16 a[154:155],v13 offset:50176
ds_read_b64_tr_b16 a[28:29],v12 offset:57344
ds_read_b64_tr_b16 a[156:157],v13 offset:57344
ds_read_b64_tr_b16 a[30:31],v12 offset:58368
ds_read_b64_tr_b16 a[158:159],v13 offset:58368
s_waitcnt lgkmcnt(4)
v_xor_b32 v12,0x10000,v12
v_xor_b32 v13,0x10000,v13
s_waitcnt lgkmcnt(0)
s_barrier
s_add_u32 s64,s74,1048576
s_add_u32 m0,s75,0
s_nop 0
buffer_load_dwordx4 v8,s[32:35],s64 offen nt lds
s_add_u32 s64,s74,1056768
s_add_u32 m0,s75,1024
s_nop 0
buffer_load_dwordx4 v8,s[32:35],s64 offen nt lds
s_add_u32 s64,s74,1064960
s_add_u32 m0,s75,2048
s_nop 0
buffer_load_dwordx4 v9,s[32:35],s64 offen nt lds
s_add_u32 s64,s74,1073152
s_add_u32 m0,s75,3072
s_nop 0
buffer_load_dwordx4 v9,s[32:35],s64 offen nt lds
s_add_u32 s64,s74,1081344
s_add_u32 m0,s75,4096
s_nop 0
buffer_load_dwordx4 v8,s[32:35],s64 offen nt lds
s_add_u32 s64,s74,1089536
s_add_u32 m0,s75,5120
s_nop 0
buffer_load_dwordx4 v8,s[32:35],s64 offen nt lds
s_add_u32 s64,s74,1097728
s_add_u32 m0,s75,6144
s_nop 0
buffer_load_dwordx4 v9,s[32:35],s64 offen nt lds
s_add_u32 s64,s74,1105920
s_add_u32 m0,s75,7168
s_nop 0
buffer_load_dwordx4 v9,s[32:35],s64 offen nt lds
s_add_u32 s64,s74,1114112
s_add_u32 m0,s75,8192
s_nop 0
buffer_load_dwordx4 v8,s[32:35],s64 offen nt lds
s_add_u32 s64,s74,1122304
s_add_u32 m0,s75,9216
s_nop 0
buffer_load_dwordx4 v8,s[32:35],s64 offen nt lds
s_add_u32 s64,s74,1130496
s_add_u32 m0,s75,10240
s_nop 0
buffer_load_dwordx4 v9,s[32:35],s64 offen nt lds
s_add_u32 s64,s74,1138688
s_add_u32 m0,s75,11264
s_nop 0
buffer_load_dwordx4 v9,s[32:35],s64 offen nt lds
s_add_u32 s64,s74,1146880
s_add_u32 m0,s75,12288
s_nop 0
buffer_load_dwordx4 v8,s[32:35],s64 offen nt lds
s_add_u32 s64,s74,1155072
s_add_u32 m0,s75,13312
s_nop 0
buffer_load_dwordx4 v8,s[32:35],s64 offen nt lds
s_add_u32 s64,s74,1163264
s_add_u32 m0,s75,14336
s_nop 0
buffer_load_dwordx4 v9,s[32:35],s64 offen nt lds
s_add_u32 s64,s74,1171456
s_add_u32 m0,s75,15360
s_nop 0
buffer_load_dwordx4 v9,s[32:35],s64 offen nt lds
s_waitcnt vmcnt(16)
s_barrier
ds_read_b64_tr_b16 a[32:33],v12 offset:0
ds_read_b64_tr_b16 a[160:161],v13 offset:0
ds_read_b64_tr_b16 a[34:35],v12 offset:1024
ds_read_b64_tr_b16 a[162:163],v13 offset:1024
ds_read_b64_tr_b16 a[36:37],v12 offset:8192
ds_read_b64_tr_b16 a[164:165],v13 offset:8192
ds_read_b64_tr_b16 a[38:39],v12 offset:9216
ds_read_b64_tr_b16 a[166:167],v13 offset:9216
s_waitcnt lgkmcnt(4)
ds_read_b64_tr_b16 a[40:41],v12 offset:16384
ds_read_b64_tr_b16 a[168:169],v13 offset:16384
ds_read_b64_tr_b16 a[42:43],v12 offset:17408
ds_read_b64_tr_b16 a[170:171],v13 offset:17408
ds_read_b64_tr_b16 a[44:45],v12 offset:24576
ds_read_b64_tr_b16 a[172:173],v13 offset:24576
ds_read_b64_tr_b16 a[46:47],v12 offset:25600
ds_read_b64_tr_b16 a[174:175],v13 offset:25600
s_waitcnt lgkmcnt(4)
ds_read_b64_tr_b16 a[48:49],v12 offset:32768
ds_read_b64_tr_b16 a[176:177],v13 offset:32768
ds_read_b64_tr_b16 a[50:51],v12 offset:33792
ds_read_b64_tr_b16 a[178:179],v13 offset:33792
ds_read_b64_tr_b16 a[52:53],v12 offset:40960
ds_read_b64_tr_b16 a[180:181],v13 offset:40960
ds_read_b64_tr_b16 a[54:55],v12 offset:41984
ds_read_b64_tr_b16 a[182:183],v13 offset:41984
s_waitcnt lgkmcnt(4)
ds_read_b64_tr_b16 a[56:57],v12 offset:49152
ds_read_b64_tr_b16 a[184:185],v13 offset:49152
ds_read_b64_tr_b16 a[58:59],v12 offset:50176
ds_read_b64_tr_b16 a[186:187],v13 offset:50176
ds_read_b64_tr_b16 a[60:61],v12 offset:57344
ds_read_b64_tr_b16 a[188:189],v13 offset:57344
ds_read_b64_tr_b16 a[62:63],v12 offset:58368
ds_read_b64_tr_b16 a[190:191],v13 offset:58368
s_waitcnt lgkmcnt(4)
v_xor_b32 v12,0x10000,v12
v_xor_b32 v13,0x10000,v13
s_waitcnt lgkmcnt(0)
s_barrier
s_add_u32 s64,s74,1572864
s_add_u32 m0,s75,65536
s_nop 0
buffer_load_dwordx4 v8,s[32:35],s64 offen nt lds
s_add_u32 s64,s74,1581056
s_add_u32 m0,s75,66560
s_nop 0
buffer_load_dwordx4 v8,s[32:35],s64 offen nt lds
s_add_u32 s64,s74,1589248
s_add_u32 m0,s75,67584
s_nop 0
buffer_load_dwordx4 v9,s[32:35],s64 offen nt lds
s_add_u32 s64,s74,1597440
s_add_u32 m0,s75,68608
s_nop 0
buffer_load_dwordx4 v9,s[32:35],s64 offen nt lds
s_add_u32 s64,s74,1605632
s_add_u32 m0,s75,69632
s_nop 0
buffer_load_dwordx4 v8,s[32:35],s64 offen nt lds
s_add_u32 s64,s74,1613824
s_add_u32 m0,s75,70656
s_nop 0
buffer_load_dwordx4 v8,s[32:35],s64 offen nt lds
s_add_u32 s64,s74,1622016
s_add_u32 m0,s75,71680
s_nop 0
buffer_load_dwordx4 v9,s[32:35],s64 offen nt lds
s_add_u32 s64,s74,1630208
s_add_u32 m0,s75,72704
s_nop 0
buffer_load_dwordx4 v9,s[32:35],s64 offen nt lds
s_add_u32 s64,s74,1638400
s_add_u32 m0,s75,73728
s_nop 0
buffer_load_dwordx4 v8,s[32:35],s64 offen nt lds
s_add_u32 s64,s74,1646592
s_add_u32 m0,s75,74752
s_nop 0
buffer_load_dwordx4 v8,s[32:35],s64 offen nt lds
s_add_u32 s64,s74,1654784
s_add_u32 m0,s75,75776
s_nop 0
buffer_load_dwordx4 v9,s[32:35],s64 offen nt lds
s_add_u32 s64,s74,1662976
s_add_u32 m0,s75,76800
s_nop 0
buffer_load_dwordx4 v9,s[32:35],s64 offen nt lds
s_add_u32 s64,s74,1671168
s_add_u32 m0,s75,77824
s_nop 0
buffer_load_dwordx4 v8,s[32:35],s64 offen nt lds
s_add_u32 s64,s74,1679360
s_add_u32 m0,s75,78848
s_nop 0
buffer_load_dwordx4 v8,s[32:35],s64 offen nt lds
s_add_u32 s64,s74,1687552
s_add_u32 m0,s75,79872
s_nop 0
buffer_load_dwordx4 v9,s[32:35],s64 offen nt lds
s_add_u32 s64,s74,1695744
s_add_u32 m0,s75,80896
s_nop 0
buffer_load_dwordx4 v9,s[32:35],s64 offen nt lds
s_waitcnt vmcnt(16)
s_barrier
ds_read_b64_tr_b16 a[64:65],v12 offset:0
ds_read_b64_tr_b16 a[192:193],v13 offset:0
ds_read_b64_tr_b16 a[66:67],v12 offset:1024
ds_read_b64_tr_b16 a[194:195],v13 offset:1024
ds_read_b64_tr_b16 a[68:69],v12 offset:8192
ds_read_b64_tr_b16 a[196:197],v13 offset:8192
ds_read_b64_tr_b16 a[70:71],v12 offset:9216
ds_read_b64_tr_b16 a[198:199],v13 offset:9216
s_waitcnt lgkmcnt(4)
ds_read_b64_tr_b16 a[72:73],v12 offset:16384
ds_read_b64_tr_b16 a[200:201],v13 offset:16384
ds_read_b64_tr_b16 a[74:75],v12 offset:17408
ds_read_b64_tr_b16 a[202:203],v13 offset:17408
ds_read_b64_tr_b16 a[76:77],v12 offset:24576
ds_read_b64_tr_b16 a[204:205],v13 offset:24576
ds_read_b64_tr_b16 a[78:79],v12 offset:25600
ds_read_b64_tr_b16 a[206:207],v13 offset:25600
s_waitcnt lgkmcnt(4)
ds_read_b64_tr_b16 a[80:81],v12 offset:32768
ds_read_b64_tr_b16 a[208:209],v13 offset:32768
ds_read_b64_tr_b16 a[82:83],v12 offset:33792
ds_read_b64_tr_b16 a[210:211],v13 offset:33792
ds_read_b64_tr_b16 a[84:85],v12 offset:40960
ds_read_b64_tr_b16 a[212:213],v13 offset:40960
ds_read_b64_tr_b16 a[86:87],v12 offset:41984
ds_read_b64_tr_b16 a[214:215],v13 offset:41984
s_waitcnt lgkmcnt(4)
ds_read_b64_tr_b16 a[88:89],v12 offset:49152
ds_read_b64_tr_b16 a[216:217],v13 offset:49152
ds_read_b64_tr_b16 a[90:91],v12 offset:50176
ds_read_b64_tr_b16 a[218:219],v13 offset:50176
ds_read_b64_tr_b16 a[92:93],v12 offset:57344
ds_read_b64_tr_b16 a[220:221],v13 offset:57344
ds_read_b64_tr_b16 a[94:95],v12 offset:58368
ds_read_b64_tr_b16 a[222:223],v13 offset:58368
s_waitcnt lgkmcnt(4)
v_xor_b32 v12,0x10000,v12
v_xor_b32 v13,0x10000,v13
s_waitcnt lgkmcnt(0)
s_barrier
s_waitcnt vmcnt(0)
s_barrier
ds_read_b64_tr_b16 a[96:97],v12 offset:0
ds_read_b64_tr_b16 a[224:225],v13 offset:0
ds_read_b64_tr_b16 a[98:99],v12 offset:1024
ds_read_b64_tr_b16 a[226:227],v13 offset:1024
ds_read_b64_tr_b16 a[100:101],v12 offset:8192
ds_read_b64_tr_b16 a[228:229],v13 offset:8192
ds_read_b64_tr_b16 a[102:103],v12 offset:9216
ds_read_b64_tr_b16 a[230:231],v13 offset:9216
s_waitcnt lgkmcnt(4)
ds_read_b64_tr_b16 a[104:105],v12 offset:16384
ds_read_b64_tr_b16 a[232:233],v13 offset:16384
ds_read_b64_tr_b16 a[106:107],v12 offset:17408
ds_read_b64_tr_b16 a[234:235],v13 offset:17408
ds_read_b64_tr_b16 a[108:109],v12 offset:24576
ds_read_b64_tr_b16 a[236:237],v13 offset:24576
ds_read_b64_tr_b16 a[110:111],v12 offset:25600
ds_read_b64_tr_b16 a[238:239],v13 offset:25600
s_waitcnt lgkmcnt(4)
ds_read_b64_tr_b16 a[112:113],v12 offset:32768
ds_read_b64_tr_b16 a[240:241],v13 offset:32768
ds_read_b64_tr_b16 a[114:115],v12 offset:33792
ds_read_b64_tr_b16 a[242:243],v13 offset:33792
ds_read_b64_tr_b16 a[116:117],v12 offset:40960
ds_read_b64_tr_b16 a[244:245],v13 offset:40960
ds_read_b64_tr_b16 a[118:119],v12 offset:41984
ds_read_b64_tr_b16 a[246:247],v13 offset:41984
s_waitcnt lgkmcnt(4)
ds_read_b64_tr_b16 a[120:121],v12 offset:49152
ds_read_b64_tr_b16 a[248:249],v13 offset:49152
ds_read_b64_tr_b16 a[122:123],v12 offset:50176
ds_read_b64_tr_b16 a[250:251],v13 offset:50176
ds_read_b64_tr_b16 a[124:125],v12 offset:57344
ds_read_b64_tr_b16 a[252:253],v13 offset:57344
ds_read_b64_tr_b16 a[126:127],v12 offset:58368
ds_read_b64_tr_b16 a[254:255],v13 offset:58368
s_waitcnt lgkmcnt(4)
v_xor_b32 v12,0x10000,v12
v_xor_b32 v13,0x10000,v13
s_waitcnt lgkmcnt(0)
s_barrier
v_and_b32 v21,1,v1
v_mul_u32_u24 v21,960,v21
s_mov_b32 s65,21052032
s_mov_b32 s66,1792
pl_220:
buffer_load_dword v22,v21,s[20:23],s65 offen sc1
s_waitcnt vmcnt(0)
v_cmp_gt_u32 vcc,s66,v22
s_cbranch_vccz pok_221
s_sleep 1
s_sub_u32 s90,s90,1
s_cmp_gt_i32 s90,0
s_cbranch_scc1 pl_220
pok_221:
s_mov_b32 s81,0xbdd2d3e8
v_mov_b32 v28,0xc0135761
v_mov_b32 v17,v16
v_and_b32 v21,31,v1
v_lshlrev_b32 v21,2,v21
s_mul_i32 s74,s79,40
s_add_u32 s74,s74,s63
s_add_u32 s74,s74,2560
s_lshl_b32 s42,s41,2
s_add_u32 s42,s42,s50
s_lshl_b32 s73,s41,4
s_lshl_b32 s64,s50,2
s_add_u32 s73,s73,s64
s_add_u32 s73,s73,s63
s_add_u32 s73,s73,3072
s_add_u32 s73,s73,s60
s_lshl_b32 s43,s50,11
s_lshl_b32 s78,s79,21
s_add_u32 s78,s78,29360128
s_mov_b32 s64,0
s_lshr_b32 s65,s50,1
s_and_b32 s66,s50,1
s_lshl_b32 s72,s65,13
s_lshl_b32 s64,s66,11
s_add_u32 s72,s72,s64
s_add_u32 s72,s72,0x10000
s_lshl_b32 s75,s66,15
s_lshl_b32 s64,s65,7
s_add_u32 s75,s75,s64
s_add_u32 s75,s75,1835008
s_lshl_b32 s64,s66,2
v_add_u32 v5,s64,v4
v_and_b32 v6,7,v1
v_xor_b32 v5,v5,v6
v_lshlrev_b32 v5,4,v5
v_bfe_u32 v6,v1,3,2
v_lshl_add_u32 v5,v6,11,v5
v_lshrrev_b32 v6,5,v1
v_lshl_add_u32 v42,v6,14,v5
v_lshrrev_b32 v5,1,v3
v_xor_b32 v5,v5,v4
v_lshlrev_b32 v5,4,v5
v_and_b32 v6,7,v3
v_lshl_add_u32 v5,v6,7,v5
v_lshrrev_b32 v6,3,v3
v_lshl_add_u32 v17,v6,11,v5
v_xor_b32 v43,64,v17
s_lshr_b32 s64,s41,1
s_lshl_b32 s64,s64,2
s_lshr_b32 s64,0x0413,s64
s_and_b32 s64,s64,7
s_add_u32 s65,s41,120
s_lshl_b32 s65,s65,14
s_add_u32 s65,s65,s43
v_lshl_add_u32 v7,v4,8,s65
v_mov_b32 v9,2105344
v_add_u32 v6,s64,v3
v_and_b32 v5,15,v6
v_lshl_add_u32 v5,v5,4,v7
v_bfe_u32 v8,v6,4,1
v_lshl_add_u32 v5,v8,10,v5
v_cmp_lt_u32 vcc,31,v6
s_nop 1
v_cndmask_b32 v8,0,v9,vcc
v_add_u32 v5,v5,v8
v_xor_b32 v18,s62,v5
s_add_u32 s64,s64,16
v_add_u32 v6,s64,v3
v_and_b32 v5,15,v6
v_lshl_add_u32 v5,v5,4,v7
v_bfe_u32 v8,v6,4,1
v_lshl_add_u32 v5,v8,10,v5
v_cmp_lt_u32 vcc,31,v6
s_nop 1
v_cndmask_b32 v8,0,v9,vcc
v_add_u32 v5,v5,v8
v_xor_b32 v19,s62,v5
s_add_u32 s64,s64,16
s_mov_b64 s[84:85],vcc
v_mov_b32 v88,1
v_mov_b32 v89,0
v_mov_b32 v90,0
v_mov_b32 v91,0
v_xor_b32 v5,0x2000,v19
s_mov_b32 s64,163577856
buffer_store_dwordx4 v[88:91],v18,s[20:23],s64 offen sc1
s_andn2_b64 exec,exec,s[84:85]
buffer_store_dwordx4 v[88:91],v19,s[20:23],s64 offen sc1
s_mov_b64 exec,-1
v_mov_b32 v6,0x7fff0000
v_cndmask_b32 v5,v6,v5,s[84:85]
s_mov_b32 s64,27262976
buffer_store_dwordx4 v[88:91],v5,s[20:23],s64 offen sc1
s_waitcnt vmcnt(0)
s_add_u32 s64,s79,0
s_lshl_b32 s70,s64,21
s_lshl_b32 s64,s64,13
s_and_b32 s64,s64,0x2000
s_xor_b32 s64,s64,s62
s_add_u32 s70,s70,s64
s_add_u32 s70,s70,29360128
s_mov_b32 s83,1
s_mov_b32 s87,s74
s_cmp_eq_u32 s50,0
s_cselect_b32 s74,s74,0x7fff0000
v_mov_b32 v47,132096
s_lshl_b32 s64,s50,3
s_add_u32 s64,s64,132096
v_mov_b32 v46,s64
v_mov_b32 v29,0
s_mov_b32 s97,0x7fff0000
seg_223:
s_cmp_eq_u32 s83,0
s_cbranch_scc1 ahead_224
s_add_u32 s94,s70,s75
s_add_u32 s95,s94,65536
s_xor_b32 s91,s72,0x10000
s_waitcnt vmcnt(3)
v_cmp_gt_u32 vcc,s71,v29
s_cbranch_vccz nb_227
s_waitcnt vmcnt(0)
v_add_u32 v22,s71,-1
buffer_store_dword v22,v23,s[24:27],s97 offen
buffer_store_dword v22,v23,s[28:31],s97 offen sc1
s_mov_b32 s97,0x7fff0000
s_cmp_lg_u32 s50,0
s_cbranch_scc1 nb_227
buffer_load_dword v32,v21,s[20:23],s74 offen sc1
s_sleep 2
pl_228:
buffer_load_dword v33,v21,s[20:23],s74 offen sc1
s_waitcnt vmcnt(1)
v_cmp_gt_u32 vcc,s71,v32
v_mov_b32 v29,v32
s_cbranch_vccz pok_229
buffer_load_dword v32,v21,s[20:23],s74 offen sc1
s_waitcnt vmcnt(1)
v_cmp_gt_u32 vcc,s71,v33
v_mov_b32 v29,v33
s_cbranch_vccz pok_229
s_sub_u32 s90,s90,1
s_cmp_gt_i32 s90,0
s_cbranch_scc1 pl_228
pok_229:
nb_227:
s_barrier
s_xor_b32 m0,s91,0
s_add_u32 s65,s94,0
buffer_load_dwordx4 v42,s[20:23],s65 offen offset:0 sc1 lds
buffer_load_dwordx4 v42,s[20:23],s65 offen offset:1024 sc1 lds
s_xor_b32 m0,s91,16384
s_add_u32 s65,s94,256
buffer_load_dwordx4 v42,s[20:23],s65 offen offset:0 sc1 lds
buffer_load_dwordx4 v42,s[20:23],s65 offen offset:1024 sc1 lds
s_xor_b32 m0,s91,32768
s_add_u32 s65,s94,512
buffer_load_dwordx4 v42,s[20:23],s65 offen offset:0 sc1 lds
buffer_load_dwordx4 v42,s[20:23],s65 offen offset:1024 sc1 lds
s_xor_b32 m0,s91,49152
s_add_u32 s65,s94,768
buffer_load_dwordx4 v42,s[20:23],s65 offen offset:0 sc1 lds
buffer_load_dwordx4 v42,s[20:23],s65 offen offset:1024 sc1 lds
s_waitcnt vmcnt(8)
v_add_u32 v22,s71,-1
buffer_store_dword v22,v23,s[24:27],s97 offen
buffer_store_dword v22,v23,s[28:31],s97 offen sc1
s_mov_b32 s97,0x7fff0000
s_waitcnt vmcnt(8)
s_barrier
ds_read_b128 v[224:227],v17 offset:0
ds_read_b128 v[228:231],v43 offset:0
ds_read_b128 v[232:235],v17 offset:8192
ds_read_b128 v[236:239],v43 offset:8192
ds_read_b128 v[240:243],v17 offset:1024
ds_read_b128 v[244:247],v43 offset:1024
ds_read_b128 v[248:251],v17 offset:9216
s_waitcnt lgkmcnt(5)
v_mfma_f32_16x16x32_bf16 v[64:67],a[0:3],v[224:227],0
s_xor_b32 m0,s91,4096
s_add_u32 s96,s71,1
v_mfma_f32_16x16x32_bf16 v[72:75],a[128:131],v[224:227],0
ds_read_b128 v[252:255],v43 offset:9216
s_add_u32 s92,s71,2
v_mfma_f32_16x16x32_bf16 v[64:67],a[4:7],v[228:231],v[64:67]
s_add_u32 s65,s95,0
v_min_u32 v27,v224,v228
v_mfma_f32_16x16x32_bf16 v[72:75],a[132:135],v[228:231],v[72:75]
s_waitcnt vmcnt(6)
s_barrier
ds_read_b128 v[224:227],v17 offset:16384
s_waitcnt lgkmcnt(5)
v_mfma_f32_16x16x32_bf16 v[64:67],a[8:11],v[232:235],v[64:67]
buffer_load_dwordx4 v42,s[20:23],s65 offen offset:0 sc1 lds
v_mfma_f32_16x16x32_bf16 v[72:75],a[136:139],v[232:235],v[72:75]
ds_read_b128 v[228:231],v43 offset:16384
v_min3_u32 v27,v27,v232,v236
v_mfma_f32_16x16x32_bf16 v[64:67],a[12:15],v[236:239],v[64:67]
buffer_load_dwordx4 v42,s[20:23],s65 offen offset:1024 sc1 lds
v_mfma_f32_16x16x32_bf16 v[72:75],a[140:143],v[236:239],v[72:75]
ds_read_b128 v[232:235],v17 offset:24576
s_waitcnt lgkmcnt(5)
v_mfma_f32_16x16x32_bf16 v[64:67],a[64:67],v[240:243],v[64:67]
s_xor_b32 m0,s91,20480
v_min3_u32 v27,v27,v240,v244
v_mfma_f32_16x16x32_bf16 v[72:75],a[192:195],v[240:243],v[72:75]
ds_read_b128 v[236:239],v43 offset:24576
v_mfma_f32_16x16x32_bf16 v[64:67],a[68:71],v[244:247],v[64:67]
s_add_u32 s65,s95,256
v_mfma_f32_16x16x32_bf16 v[72:75],a[196:199],v[244:247],v[72:75]
ds_read_b128 v[240:243],v17 offset:17408
s_waitcnt lgkmcnt(5)
v_mfma_f32_16x16x32_bf16 v[64:67],a[72:75],v[248:251],v[64:67]
buffer_load_dwordx4 v42,s[20:23],s65 offen offset:0 sc1 lds
v_mfma_f32_16x16x32_bf16 v[72:75],a[200:203],v[248:251],v[72:75]
ds_read_b128 v[244:247],v43 offset:17408
v_min3_u32 v27,v27,v248,v252
v_mfma_f32_16x16x32_bf16 v[64:67],a[76:79],v[252:255],v[64:67]
buffer_load_dwordx4 v42,s[20:23],s65 offen offset:1024 sc1 lds
v_mfma_f32_16x16x32_bf16 v[72:75],a[204:207],v[252:255],v[72:75]
ds_read_b128 v[248:251],v17 offset:25600
s_waitcnt lgkmcnt(5)
v_mfma_f32_16x16x32_bf16 v[64:67],a[16:19],v[224:227],v[64:67]
s_xor_b32 m0,s91,36864
v_min3_u32 v27,v27,v224,v228
v_mfma_f32_16x16x32_bf16 v[72:75],a[144:147],v[224:227],v[72:75]
ds_read_b128 v[252:255],v43 offset:25600
v_mfma_f32_16x16x32_bf16 v[64:67],a[20:23],v[228:231],v[64:67]
s_add_u32 s65,s95,512
v_mfma_f32_16x16x32_bf16 v[72:75],a[148:151],v[228:231],v[72:75]
s_waitcnt vmcnt(6)
s_barrier
ds_read_b128 v[224:227],v17 offset:32768
s_waitcnt lgkmcnt(5)
v_mfma_f32_16x16x32_bf16 v[64:67],a[24:27],v[232:235],v[64:67]
buffer_load_dwordx4 v42,s[20:23],s65 offen offset:0 sc1 lds
v_mfma_f32_16x16x32_bf16 v[72:75],a[152:155],v[232:235],v[72:75]
ds_read_b128 v[228:231],v43 offset:32768
v_min3_u32 v27,v27,v232,v236
v_mfma_f32_16x16x32_bf16 v[64:67],a[28:31],v[236:239],v[64:67]
buffer_load_dwordx4 v42,s[20:23],s65 offen offset:1024 sc1 lds
v_mfma_f32_16x16x32_bf16 v[72:75],a[156:159],v[236:239],v[72:75]
ds_read_b128 v[232:235],v17 offset:40960
s_waitcnt lgkmcnt(5)
v_mfma_f32_16x16x32_bf16 v[64:67],a[80:83],v[240:243],v[64:67]
s_xor_b32 m0,s91,53248
v_min3_u32 v27,v27,v240,v244
v_mfma_f32_16x16x32_bf16 v[72:75],a[208:211],v[240:243],v[72:75]
ds_read_b128 v[236:239],v43 offset:40960
v_mfma_f32_16x16x32_bf16 v[64:67],a[84:87],v[244:247],v[64:67]
s_add_u32 s65,s95,768
v_mfma_f32_16x16x32_bf16 v[72:75],a[212:215],v[244:247],v[72:75]
ds_read_b128 v[240:243],v17 offset:33792
s_waitcnt lgkmcnt(5)
v_mfma_f32_16x16x32_bf16 v[64:67],a[88:91],v[248:251],v[64:67]
buffer_load_dwordx4 v42,s[20:23],s65 offen offset:0 sc1 lds
v_min3_u32 v27,v27,v248,v252
v_mfma_f32_16x16x32_bf16 v[72:75],a[216:219],v[248:251],v[72:75]
ds_read_b128 v[244:247],v43 offset:33792
s_waitcnt vmcnt(63)
v_mfma_f32_16x16x32_bf16 v[64:67],a[92:95],v[252:255],v[64:67]
buffer_load_dwordx4 v42,s[20:23],s65 offen offset:1024 sc1 lds
v_mfma_f32_16x16x32_bf16 v[72:75],a[220:223],v[252:255],v[72:75]
ds_read_b128 v[248:251],v17 offset:41984
s_waitcnt lgkmcnt(5)
v_mfma_f32_16x16x32_bf16 v[64:67],a[32:35],v[224:227],v[64:67]
v_cmp_gt_u32 vcc,s96,v29
v_cmp_gt_u32 s[92:93],s92,v29
v_mfma_f32_16x16x32_bf16 v[72:75],a[160:163],v[224:227],v[72:75]
ds_read_b128 v[252:255],v43 offset:41984
v_min3_u32 v27,v27,v224,v228
v_mfma_f32_16x16x32_bf16 v[64:67],a[36:39],v[228:231],v[64:67]
v_mov_b32 v44,vcc_lo
v_mov_b32 v45,s92
v_mfma_f32_16x16x32_bf16 v[72:75],a[164:167],v[228:231],v[72:75]
ds_read_b128 v[224:227],v17 offset:49152
s_waitcnt lgkmcnt(5)
v_mfma_f32_16x16x32_bf16 v[64:67],a[40:43],v[232:235],v[64:67]
ds_write_b64 v46,v[44:45]
v_min3_u32 v27,v27,v232,v236
v_mfma_f32_16x16x32_bf16 v[72:75],a[168:171],v[232:235],v[72:75]
ds_read_b128 v[228:231],v43 offset:49152
v_mfma_f32_16x16x32_bf16 v[64:67],a[44:47],v[236:239],v[64:67]
v_mfma_f32_16x16x32_bf16 v[72:75],a[172:175],v[236:239],v[72:75]
ds_read_b128 v[232:235],v17 offset:57344
s_waitcnt lgkmcnt(6)
v_mfma_f32_16x16x32_bf16 v[64:67],a[96:99],v[240:243],v[64:67]
v_min3_u32 v27,v27,v240,v244
s_add_u32 s88,s70,s75
v_mfma_f32_16x16x32_bf16 v[72:75],a[224:227],v[240:243],v[72:75]
ds_read_b128 v[236:239],v43 offset:57344
s_add_u32 s88,s88,2097152
v_mfma_f32_16x16x32_bf16 v[64:67],a[100:103],v[244:247],v[64:67]
s_xor_b32 s88,s88,0x2000
s_add_u32 s89,s88,65536
v_mfma_f32_16x16x32_bf16 v[72:75],a[228:231],v[244:247],v[72:75]
ds_read_b128 v[240:243],v17 offset:50176
s_waitcnt lgkmcnt(6)
v_mfma_f32_16x16x32_bf16 v[64:67],a[104:107],v[248:251],v[64:67]
v_min3_u32 v27,v27,v248,v252
v_mfma_f32_16x16x32_bf16 v[72:75],a[232:235],v[248:251],v[72:75]
ds_read_b128 v[244:247],v43 offset:50176
v_mfma_f32_16x16x32_bf16 v[64:67],a[108:111],v[252:255],v[64:67]
v_mfma_f32_16x16x32_bf16 v[72:75],a[236:239],v[252:255],v[72:75]
ds_read_b128 v[248:251],v17 offset:58368
s_waitcnt lgkmcnt(5)
v_mfma_f32_16x16x32_bf16 v[64:67],a[48:51],v[224:227],v[64:67]
v_min3_u32 v27,v27,v224,v228
v_mfma_f32_16x16x32_bf16 v[72:75],a[176:179],v[224:227],v[72:75]
ds_read_b128 v[252:255],v43 offset:58368
v_mfma_f32_16x16x32_bf16 v[64:67],a[52:55],v[228:231],v[64:67]
v_mfma_f32_16x16x32_bf16 v[72:75],a[180:183],v[228:231],v[72:75]
s_waitcnt vmcnt(4)
s_barrier
ds_read_b64 v[44:45],v47
ds_read_b128 v[224:227],v17 offset:4096
s_waitcnt lgkmcnt(6)
v_mfma_f32_16x16x32_bf16 v[64:67],a[56:59],v[232:235],v[64:67]
v_min3_u32 v27,v27,v232,v236
v_mfma_f32_16x16x32_bf16 v[72:75],a[184:187],v[232:235],v[72:75]
ds_read_b128 v[228:231],v43 offset:4096
v_mfma_f32_16x16x32_bf16 v[64:67],a[60:63],v[236:239],v[64:67]
v_mfma_f32_16x16x32_bf16 v[72:75],a[188:191],v[236:239],v[72:75]
ds_read_b128 v[232:235],v17 offset:12288
s_waitcnt lgkmcnt(6)
v_mfma_f32_16x16x32_bf16 v[64:67],a[112:115],v[240:243],v[64:67]
v_min3_u32 v27,v27,v240,v244
v_mfma_f32_16x16x32_bf16 v[72:75],a[240:243],v[240:243],v[72:75]
ds_read_b128 v[236:239],v43 offset:12288
v_mfma_f32_16x16x32_bf16 v[64:67],a[116:119],v[244:247],v[64:67]
v_mfma_f32_16x16x32_bf16 v[72:75],a[244:247],v[244:247],v[72:75]
ds_read_b128 v[240:243],v17 offset:5120
s_waitcnt lgkmcnt(6)
v_mfma_f32_16x16x32_bf16 v[64:67],a[120:123],v[248:251],v[64:67]
s_waitcnt lgkmcnt(5)
v_readfirstlane_b32 s93,v45
v_mfma_f32_16x16x32_bf16 v[72:75],a[248:251],v[248:251],v[72:75]
ds_read_b128 v[244:247],v43 offset:5120
v_readfirstlane_b32 s83,v44
s_cmp_lg_u32 s83,0
s_cbranch_scc0 keep_230
v_mfma_f32_16x16x32_bf16 v[64:67],a[124:127],v[252:255],v[64:67]
v_min3_u32 v27,v27,v248,v252
v_mfma_f32_16x16x32_bf16 v[72:75],a[252:255],v[252:255],v[72:75]
ds_read_b128 v[248:251],v17 offset:13312
s_waitcnt lgkmcnt(5)
v_mfma_f32_16x16x32_bf16 v[68:71],a[0:3],v[224:227],0
v_cmp_eq_u32 vcc,0,v27
s_cbranch_vccnz retry_222
v_mfma_f32_16x16x32_bf16 v[76:79],a[128:131],v[224:227],0
ds_read_b128 v[252:255],v43 offset:13312
v_min3_u32 v27,v27,v224,v228
v_mfma_f32_16x16x32_bf16 v[68:71],a[4:7],v[228:231],v[68:71]
v_mfma_f32_16x16x32_bf16 v[76:79],a[132:135],v[228:231],v[76:79]
ds_read_b128 v[224:227],v17 offset:20480
s_waitcnt lgkmcnt(5)
v_mfma_f32_16x16x32_bf16 v[68:71],a[8:11],v[232:235],v[68:71]
v_min3_u32 v27,v27,v232,v236
v_mul_f32 v88,v64,v64
v_mul_f32 v92,v72,v72
v_mfma_f32_16x16x32_bf16 v[76:79],a[136:139],v[232:235],v[76:79]
ds_read_b128 v[228:231],v43 offset:20480
v_mul_f32 v89,v65,v65
v_mul_f32 v93,v73,v73
v_mfma_f32_16x16x32_bf16 v[68:71],a[12:15],v[236:239],v[68:71]
v_mul_f32 v90,v66,v66
v_mul_f32 v91,v67,v67
v_mul_f32 v94,v74,v74
v_mfma_f32_16x16x32_bf16 v[76:79],a[140:143],v[236:239],v[76:79]
ds_read_b128 v[232:235],v17 offset:28672
v_mul_f32 v95,v75,v75
s_waitcnt lgkmcnt(5)
v_mfma_f32_16x16x32_bf16 v[68:71],a[64:67],v[240:243],v[68:71]
v_min3_u32 v27,v27,v240,v244
v_fma_f32 v88,v88,s81,v28
v_fma_f32 v92,v92,s81,v28
v_mfma_f32_16x16x32_bf16 v[76:79],a[192:195],v[240:243],v[76:79]
ds_read_b128 v[236:239],v43 offset:28672
v_fma_f32 v89,v89,s81,v28
v_fma_f32 v93,v93,s81,v28
v_mfma_f32_16x16x32_bf16 v[68:71],a[68:71],v[244:247],v[68:71]
v_fma_f32 v90,v90,s81,v28
v_fma_f32 v91,v91,s81,v28
v_fma_f32 v94,v94,s81,v28
v_mfma_f32_16x16x32_bf16 v[76:79],a[196:199],v[244:247],v[76:79]
ds_read_b128 v[240:243],v17 offset:21504
v_fma_f32 v95,v95,s81,v28
s_waitcnt lgkmcnt(5)
v_mfma_f32_16x16x32_bf16 v[68:71],a[72:75],v[248:251],v[68:71]
v_min3_u32 v27,v27,v248,v252
v_mul_f32 v88,v88,v64
v_mul_f32 v92,v92,v72
v_mfma_f32_16x16x32_bf16 v[76:79],a[200:203],v[248:251],v[76:79]
ds_read_b128 v[244:247],v43 offset:21504
v_mul_f32 v89,v89,v65
v_mul_f32 v93,v93,v73
v_mfma_f32_16x16x32_bf16 v[68:71],a[76:79],v[252:255],v[68:71]
v_mul_f32 v90,v90,v66
v_mul_f32 v91,v91,v67
v_mul_f32 v94,v94,v74
v_mfma_f32_16x16x32_bf16 v[76:79],a[204:207],v[252:255],v[76:79]
ds_read_b128 v[248:251],v17 offset:29696
v_mul_f32 v95,v95,v75
s_waitcnt lgkmcnt(5)
v_mfma_f32_16x16x32_bf16 v[68:71],a[16:19],v[224:227],v[68:71]
v_min3_u32 v27,v27,v224,v228
v_exp_f32 v92,v92
v_mfma_f32_16x16x32_bf16 v[76:79],a[144:147],v[224:227],v[76:79]
ds_read_b128 v[252:255],v43 offset:29696
v_exp_f32 v93,v93
v_mfma_f32_16x16x32_bf16 v[68:71],a[20:23],v[228:231],v[68:71]
v_exp_f32 v88,v88
v_mfma_f32_16x16x32_bf16 v[76:79],a[148:151],v[228:231],v[76:79]
s_waitcnt vmcnt(0)
s_barrier
ds_read_b128 v[224:227],v17 offset:36864
s_waitcnt lgkmcnt(5)
v_mfma_f32_16x16x32_bf16 v[68:71],a[24:27],v[232:235],v[68:71]
v_min3_u32 v27,v27,v232,v236
v_exp_f32 v94,v94
v_mfma_f32_16x16x32_bf16 v[76:79],a[152:155],v[232:235],v[76:79]
ds_read_b128 v[228:231],v43 offset:36864
v_exp_f32 v95,v95
v_mfma_f32_16x16x32_bf16 v[68:71],a[28:31],v[236:239],v[68:71]
v_exp_f32 v89,v89
v_add_f32 v92,1.0,v92
v_mfma_f32_16x16x32_bf16 v[76:79],a[156:159],v[236:239],v[76:79]
ds_read_b128 v[232:235],v17 offset:45056
v_add_f32 v93,1.0,v93
s_waitcnt lgkmcnt(5)
v_mfma_f32_16x16x32_bf16 v[68:71],a[80:83],v[240:243],v[68:71]
v_min3_u32 v27,v27,v240,v244
v_add_f32 v94,1.0,v94
v_add_f32 v95,1.0,v95
v_mfma_f32_16x16x32_bf16 v[76:79],a[208:211],v[240:243],v[76:79]
ds_read_b128 v[236:239],v43 offset:45056
v_rcp_f32 v92,v92
v_mfma_f32_16x16x32_bf16 v[68:71],a[84:87],v[244:247],v[68:71]
v_exp_f32 v90,v90
v_mfma_f32_16x16x32_bf16 v[76:79],a[212:215],v[244:247],v[76:79]
ds_read_b128 v[240:243],v17 offset:37888
s_waitcnt lgkmcnt(5)
v_mfma_f32_16x16x32_bf16 v[68:71],a[88:91],v[248:251],v[68:71]
v_min3_u32 v27,v27,v248,v252
v_rcp_f32 v93,v93
v_mfma_f32_16x16x32_bf16 v[76:79],a[216:219],v[248:251],v[76:79]
ds_read_b128 v[244:247],v43 offset:37888
v_rcp_f32 v94,v94
v_mfma_f32_16x16x32_bf16 v[68:71],a[92:95],v[252:255],v[68:71]
v_exp_f32 v91,v91
v_mfma_f32_16x16x32_bf16 v[76:79],a[220:223],v[252:255],v[76:79]
ds_read_b128 v[248:251],v17 offset:46080
s_waitcnt lgkmcnt(5)
v_mfma_f32_16x16x32_bf16 v[68:71],a[32:35],v[224:227],v[68:71]
v_min3_u32 v27,v27,v224,v228
v_add_f32 v88,1.0,v88
v_mfma_f32_16x16x32_bf16 v[76:79],a[160:163],v[224:227],v[76:79]
ds_read_b128 v[252:255],v43 offset:46080
v_add_f32 v89,1.0,v89
v_mfma_f32_16x16x32_bf16 v[68:71],a[36:39],v[228:231],v[68:71]
v_add_f32 v90,1.0,v90
v_add_f32 v91,1.0,v91
v_mfma_f32_16x16x32_bf16 v[76:79],a[164:167],v[228:231],v[76:79]
ds_read_b128 v[224:227],v17 offset:53248
s_waitcnt lgkmcnt(5)
v_mfma_f32_16x16x32_bf16 v[68:71],a[40:43],v[232:235],v[68:71]
v_min3_u32 v27,v27,v232,v236
v_mfma_f32_16x16x32_bf16 v[76:79],a[168:171],v[232:235],v[76:79]
ds_read_b128 v[228:231],v43 offset:53248
v_mfma_f32_16x16x32_bf16 v[68:71],a[44:47],v[236:239],v[68:71]
v_rcp_f32 v88,v88
v_mfma_f32_16x16x32_bf16 v[76:79],a[172:175],v[236:239],v[76:79]
ds_read_b128 v[232:235],v17 offset:61440
s_waitcnt lgkmcnt(5)
v_mfma_f32_16x16x32_bf16 v[68:71],a[96:99],v[240:243],v[68:71]
v_min3_u32 v27,v27,v240,v244
v_mfma_f32_16x16x32_bf16 v[76:79],a[224:227],v[240:243],v[76:79]
ds_read_b128 v[236:239],v43 offset:61440
v_mfma_f32_16x16x32_bf16 v[68:71],a[100:103],v[244:247],v[68:71]
v_rcp_f32 v89,v89
v_mfma_f32_16x16x32_bf16 v[76:79],a[228:231],v[244:247],v[76:79]
ds_read_b128 v[240:243],v17 offset:54272
s_waitcnt lgkmcnt(5)
v_mfma_f32_16x16x32_bf16 v[68:71],a[104:107],v[248:251],v[68:71]
v_min3_u32 v27,v27,v248,v252
v_mfma_f32_16x16x32_bf16 v[76:79],a[232:235],v[248:251],v[76:79]
ds_read_b128 v[244:247],v43 offset:54272
v_mfma_f32_16x16x32_bf16 v[68:71],a[108:111],v[252:255],v[68:71]
v_rcp_f32 v90,v90
v_mfma_f32_16x16x32_bf16 v[76:79],a[236:239],v[252:255],v[76:79]
ds_read_b128 v[248:251],v17 offset:62464
s_waitcnt lgkmcnt(5)
v_mfma_f32_16x16x32_bf16 v[68:71],a[48:51],v[224:227],v[68:71]
v_min3_u32 v27,v27,v224,v228
v_mfma_f32_16x16x32_bf16 v[76:79],a[176:179],v[224:227],v[76:79]
ds_read_b128 v[252:255],v43 offset:62464
v_mfma_f32_16x16x32_bf16 v[68:71],a[52:55],v[228:231],v[68:71]
v_rcp_f32 v91,v91
v_mfma_f32_16x16x32_bf16 v[76:79],a[180:183],v[228:231],v[76:79]
v_mul_f32 v88,v88,v64
s_waitcnt lgkmcnt(4)
v_mfma_f32_16x16x32_bf16 v[68:71],a[56:59],v[232:235],v[68:71]
v_min3_u32 v27,v27,v232,v236
v_mul_f32 v89,v89,v65
v_mfma_f32_16x16x32_bf16 v[76:79],a[184:187],v[232:235],v[76:79]
v_mul_f32 v90,v90,v66
v_mul_f32 v91,v91,v67
v_mfma_f32_16x16x32_bf16 v[68:71],a[60:63],v[236:239],v[68:71]
v_rcp_f32 v95,v95
v_mfma_f32_16x16x32_bf16 v[76:79],a[188:191],v[236:239],v[76:79]
v_mul_f32 v92,v92,v72
s_waitcnt lgkmcnt(2)
v_mfma_f32_16x16x32_bf16 v[68:71],a[112:115],v[240:243],v[68:71]
v_min3_u32 v27,v27,v240,v244
v_mul_f32 v93,v93,v73
v_mfma_f32_16x16x32_bf16 v[76:79],a[240:243],v[240:243],v[76:79]
v_mul_f32 v94,v94,v74
v_mul_f32 v95,v95,v75
v_mfma_f32_16x16x32_bf16 v[68:71],a[116:119],v[244:247],v[68:71]
v_cvt_pk_bf16_f32 v96,v88,v89
v_cvt_pk_bf16_f32 v97,v90,v91
v_mfma_f32_16x16x32_bf16 v[76:79],a[244:247],v[244:247],v[76:79]
v_cvt_pk_bf16_f32 v98,v92,v93
s_waitcnt lgkmcnt(0)
v_mfma_f32_16x16x32_bf16 v[68:71],a[120:123],v[248:251],v[68:71]
v_min3_u32 v27,v27,v248,v252
v_cvt_pk_bf16_f32 v99,v94,v95
v_mfma_f32_16x16x32_bf16 v[76:79],a[248:251],v[248:251],v[76:79]
v_max_u32 v96,1,v96
v_mfma_f32_16x16x32_bf16 v[68:71],a[124:127],v[252:255],v[68:71]
buffer_store_dwordx4 v[96:99],v18,s[20:23],s78 offen sc1
v_mfma_f32_16x16x32_bf16 v[76:79],a[252:255],v[252:255],v[76:79]
v_cmp_eq_u32 vcc,0,v27
s_cbranch_vccnz retry_222
s_branch epi_225
keep_230:
v_mfma_f32_16x16x32_bf16 v[64:67],a[124:127],v[252:255],v[64:67]
v_min3_u32 v27,v27,v248,v252
s_xor_b32 m0,s72,0
v_mfma_f32_16x16x32_bf16 v[72:75],a[252:255],v[252:255],v[72:75]
ds_read_b128 v[248:251],v17 offset:13312
s_waitcnt lgkmcnt(5)
v_mfma_f32_16x16x32_bf16 v[68:71],a[0:3],v[224:227],0
s_add_u32 s65,s88,0
v_cmp_eq_u32 vcc,0,v27
s_cbranch_vccnz retry_222
v_mfma_f32_16x16x32_bf16 v[76:79],a[128:131],v[224:227],0
ds_read_b128 v[252:255],v43 offset:13312
v_min3_u32 v27,v27,v224,v228
v_mfma_f32_16x16x32_bf16 v[68:71],a[4:7],v[228:231],v[68:71]
buffer_load_dwordx4 v42,s[20:23],s65 offen offset:0 sc1 lds
v_mfma_f32_16x16x32_bf16 v[76:79],a[132:135],v[228:231],v[76:79]
ds_read_b128 v[224:227],v17 offset:20480
s_waitcnt lgkmcnt(5)
v_mfma_f32_16x16x32_bf16 v[68:71],a[8:11],v[232:235],v[68:71]
buffer_load_dwordx4 v42,s[20:23],s65 offen offset:1024 sc1 lds
v_mul_f32 v88,v64,v64
v_mul_f32 v89,v65,v65
v_mfma_f32_16x16x32_bf16 v[76:79],a[136:139],v[232:235],v[76:79]
ds_read_b128 v[228:231],v43 offset:20480
s_xor_b32 m0,s72,16384
v_mul_f32 v90,v66,v66
v_mul_f32 v91,v67,v67
v_mfma_f32_16x16x32_bf16 v[68:71],a[12:15],v[236:239],v[68:71]
s_add_u32 s65,s88,256
v_min3_u32 v27,v27,v232,v236
v_fma_f32 v88,v88,s81,v28
v_fma_f32 v89,v89,s81,v28
v_mfma_f32_16x16x32_bf16 v[76:79],a[140:143],v[236:239],v[76:79]
ds_read_b128 v[232:235],v17 offset:28672
v_fma_f32 v90,v90,s81,v28
v_fma_f32 v91,v91,s81,v28
s_waitcnt lgkmcnt(5)
v_mfma_f32_16x16x32_bf16 v[68:71],a[64:67],v[240:243],v[68:71]
buffer_load_dwordx4 v42,s[20:23],s65 offen offset:0 sc1 lds
v_mul_f32 v88,v88,v64
v_mul_f32 v89,v89,v65
v_mfma_f32_16x16x32_bf16 v[76:79],a[192:195],v[240:243],v[76:79]
ds_read_b128 v[236:239],v43 offset:28672
v_min3_u32 v27,v27,v240,v244
v_mul_f32 v90,v90,v66
v_mul_f32 v91,v91,v67
v_mfma_f32_16x16x32_bf16 v[68:71],a[68:71],v[244:247],v[68:71]
buffer_load_dwordx4 v42,s[20:23],s65 offen offset:1024 sc1 lds
v_exp_f32 v88,v88
v_mfma_f32_16x16x32_bf16 v[76:79],a[196:199],v[244:247],v[76:79]
ds_read_b128 v[240:243],v17 offset:21504
v_exp_f32 v89,v89
s_waitcnt lgkmcnt(5)
v_mfma_f32_16x16x32_bf16 v[68:71],a[72:75],v[248:251],v[68:71]
s_xor_b32 m0,s72,32768
s_add_u32 s65,s88,512
v_exp_f32 v90,v90
v_mfma_f32_16x16x32_bf16 v[76:79],a[200:203],v[248:251],v[76:79]
ds_read_b128 v[244:247],v43 offset:21504
v_min3_u32 v27,v27,v248,v252
v_exp_f32 v91,v91
v_mfma_f32_16x16x32_bf16 v[68:71],a[76:79],v[252:255],v[68:71]
buffer_load_dwordx4 v42,s[20:23],s65 offen offset:0 sc1 lds
v_add_f32 v88,1.0,v88
v_add_f32 v89,1.0,v89
v_mfma_f32_16x16x32_bf16 v[76:79],a[204:207],v[252:255],v[76:79]
ds_read_b128 v[248:251],v17 offset:29696
v_add_f32 v90,1.0,v90
v_add_f32 v91,1.0,v91
s_waitcnt lgkmcnt(5)
v_mfma_f32_16x16x32_bf16 v[68:71],a[16:19],v[224:227],v[68:71]
buffer_load_dwordx4 v42,s[20:23],s65 offen offset:1024 sc1 lds
v_rcp_f32 v88,v88
v_mfma_f32_16x16x32_bf16 v[76:79],a[144:147],v[224:227],v[76:79]
ds_read_b128 v[252:255],v43 offset:29696
s_xor_b32 m0,s72,49152
v_mul_f32 v92,v72,v72
v_mul_f32 v93,v73,v73
v_mfma_f32_16x16x32_bf16 v[68:71],a[20:23],v[228:231],v[68:71]
v_min3_u32 v27,v27,v224,v228
v_mul_f32 v94,v74,v74
v_mul_f32 v95,v75,v75
v_fma_f32 v92,v92,s81,v28
v_mfma_f32_16x16x32_bf16 v[76:79],a[148:151],v[228:231],v[76:79]
s_waitcnt vmcnt(6)
s_barrier
ds_read_b128 v[224:227],v17 offset:36864
s_waitcnt lgkmcnt(5)
v_mfma_f32_16x16x32_bf16 v[68:71],a[24:27],v[232:235],v[68:71]
s_add_u32 s65,s88,768
v_min3_u32 v27,v27,v232,v236
v_fma_f32 v93,v93,s81,v28
v_fma_f32 v94,v94,s81,v28
v_mfma_f32_16x16x32_bf16 v[76:79],a[152:155],v[232:235],v[76:79]
ds_read_b128 v[228:231],v43 offset:36864
v_fma_f32 v95,v95,s81,v28
v_mul_f32 v92,v92,v72
v_mul_f32 v93,v93,v73
v_mfma_f32_16x16x32_bf16 v[68:71],a[28:31],v[236:239],v[68:71]
buffer_load_dwordx4 v42,s[20:23],s65 offen offset:0 sc1 lds
v_mul_f32 v94,v94,v74
v_mul_f32 v95,v95,v75
v_mfma_f32_16x16x32_bf16 v[76:79],a[156:159],v[236:239],v[76:79]
ds_read_b128 v[232:235],v17 offset:45056
v_exp_f32 v92,v92
s_waitcnt lgkmcnt(5)
v_mfma_f32_16x16x32_bf16 v[68:71],a[80:83],v[240:243],v[68:71]
buffer_load_dwordx4 v42,s[20:23],s65 offen offset:1024 sc1 lds
v_exp_f32 v93,v93
v_mfma_f32_16x16x32_bf16 v[76:79],a[208:211],v[240:243],v[76:79]
ds_read_b128 v[236:239],v43 offset:45056
s_xor_b32 m0,s72,4096
v_exp_f32 v94,v94
v_mfma_f32_16x16x32_bf16 v[68:71],a[84:87],v[244:247],v[68:71]
s_add_u32 s65,s89,0
v_min3_u32 v27,v27,v240,v244
v_exp_f32 v95,v95
v_mfma_f32_16x16x32_bf16 v[76:79],a[212:215],v[244:247],v[76:79]
ds_read_b128 v[240:243],v17 offset:37888
v_add_f32 v92,1.0,v92
v_add_f32 v93,1.0,v93
s_waitcnt lgkmcnt(5)
v_mfma_f32_16x16x32_bf16 v[68:71],a[88:91],v[248:251],v[68:71]
buffer_load_dwordx4 v42,s[20:23],s65 offen offset:0 sc1 lds
v_add_f32 v94,1.0,v94
v_add_f32 v95,1.0,v95
v_mfma_f32_16x16x32_bf16 v[76:79],a[216:219],v[248:251],v[76:79]
ds_read_b128 v[244:247],v43 offset:37888
v_min3_u32 v27,v27,v248,v252
v_rcp_f32 v92,v92
v_mfma_f32_16x16x32_bf16 v[68:71],a[92:95],v[252:255],v[68:71]
buffer_load_dwordx4 v42,s[20:23],s65 offen offset:1024 sc1 lds
v_rcp_f32 v93,v93
v_mfma_f32_16x16x32_bf16 v[76:79],a[220:223],v[252:255],v[76:79]
ds_read_b128 v[248:251],v17 offset:46080
v_rcp_f32 v94,v94
s_waitcnt lgkmcnt(5)
v_mfma_f32_16x16x32_bf16 v[68:71],a[32:35],v[224:227],v[68:71]
s_xor_b32 m0,s72,20480
s_add_u32 s65,s89,256
v_rcp_f32 v95,v95
v_mfma_f32_16x16x32_bf16 v[76:79],a[160:163],v[224:227],v[76:79]
ds_read_b128 v[252:255],v43 offset:46080
v_min3_u32 v27,v27,v224,v228
v_mfma_f32_16x16x32_bf16 v[68:71],a[36:39],v[228:231],v[68:71]
buffer_load_dwordx4 v42,s[20:23],s65 offen offset:0 sc1 lds
v_mfma_f32_16x16x32_bf16 v[76:79],a[164:167],v[228:231],v[76:79]
ds_read_b128 v[224:227],v17 offset:53248
s_waitcnt lgkmcnt(5)
v_mfma_f32_16x16x32_bf16 v[68:71],a[40:43],v[232:235],v[68:71]
buffer_load_dwordx4 v42,s[20:23],s65 offen offset:1024 sc1 lds
v_mfma_f32_16x16x32_bf16 v[76:79],a[168:171],v[232:235],v[76:79]
ds_read_b128 v[228:231],v43 offset:53248
s_xor_b32 m0,s72,36864
v_mfma_f32_16x16x32_bf16 v[68:71],a[44:47],v[236:239],v[68:71]
s_add_u32 s65,s89,512
v_min3_u32 v27,v27,v232,v236
v_mfma_f32_16x16x32_bf16 v[76:79],a[172:175],v[236:239],v[76:79]
ds_read_b128 v[232:235],v17 offset:61440
s_waitcnt lgkmcnt(5)
v_mfma_f32_16x16x32_bf16 v[68:71],a[96:99],v[240:243],v[68:71]
buffer_load_dwordx4 v42,s[20:23],s65 offen offset:0 sc1 lds
v_mfma_f32_16x16x32_bf16 v[76:79],a[224:227],v[240:243],v[76:79]
ds_read_b128 v[236:239],v43 offset:61440
v_min3_u32 v27,v27,v240,v244
v_mfma_f32_16x16x32_bf16 v[68:71],a[100:103],v[244:247],v[68:71]
buffer_load_dwordx4 v42,s[20:23],s65 offen offset:1024 sc1 lds
v_mfma_f32_16x16x32_bf16 v[76:79],a[228:231],v[244:247],v[76:79]
ds_read_b128 v[240:243],v17 offset:54272
s_waitcnt lgkmcnt(5)
v_mfma_f32_16x16x32_bf16 v[68:71],a[104:107],v[248:251],v[68:71]
s_xor_b32 m0,s72,53248
v_min3_u32 v27,v27,v248,v252
v_mfma_f32_16x16x32_bf16 v[76:79],a[232:235],v[248:251],v[76:79]
ds_read_b128 v[244:247],v43 offset:54272
s_add_u32 s65,s89,768
v_mfma_f32_16x16x32_bf16 v[68:71],a[108:111],v[252:255],v[68:71]
buffer_load_dwordx4 v42,s[20:23],s65 offen offset:0 sc1 lds
v_mfma_f32_16x16x32_bf16 v[76:79],a[236:239],v[252:255],v[76:79]
ds_read_b128 v[248:251],v17 offset:62464
s_waitcnt lgkmcnt(5)
v_mfma_f32_16x16x32_bf16 v[68:71],a[48:51],v[224:227],v[68:71]
buffer_load_dwordx4 v42,s[20:23],s65 offen offset:1024 sc1 lds
v_mfma_f32_16x16x32_bf16 v[76:79],a[176:179],v[224:227],v[76:79]
ds_read_b128 v[252:255],v43 offset:62464
v_min3_u32 v27,v27,v224,v228
v_mfma_f32_16x16x32_bf16 v[68:71],a[52:55],v[228:231],v[68:71]
v_rcp_f32 v89,v89
v_mfma_f32_16x16x32_bf16 v[76:79],a[180:183],v[228:231],v[76:79]
v_mul_f32 v92,v92,v72
s_waitcnt lgkmcnt(4)
v_mfma_f32_16x16x32_bf16 v[68:71],a[56:59],v[232:235],v[68:71]
v_min3_u32 v27,v27,v232,v236
v_mul_f32 v93,v93,v73
v_mfma_f32_16x16x32_bf16 v[76:79],a[184:187],v[232:235],v[76:79]
v_rcp_f32 v90,v90
v_mfma_f32_16x16x32_bf16 v[68:71],a[60:63],v[236:239],v[68:71]
v_rcp_f32 v91,v91
v_mfma_f32_16x16x32_bf16 v[76:79],a[188:191],v[236:239],v[76:79]
v_mul_f32 v88,v88,v64
s_waitcnt lgkmcnt(2)
v_mfma_f32_16x16x32_bf16 v[68:71],a[112:115],v[240:243],v[68:71]
v_min3_u32 v27,v27,v240,v244
v_mul_f32 v89,v89,v65
v_mfma_f32_16x16x32_bf16 v[76:79],a[240:243],v[240:243],v[76:79]
v_mul_f32 v90,v90,v66
v_mul_f32 v91,v91,v67
v_mfma_f32_16x16x32_bf16 v[68:71],a[116:119],v[244:247],v[68:71]
v_mul_f32 v94,v94,v74
v_mul_f32 v95,v95,v75
v_mfma_f32_16x16x32_bf16 v[76:79],a[244:247],v[244:247],v[76:79]
v_cvt_pk_bf16_f32 v96,v88,v89
s_waitcnt lgkmcnt(0)
v_mfma_f32_16x16x32_bf16 v[68:71],a[120:123],v[248:251],v[68:71]
v_min3_u32 v27,v27,v248,v252
v_cvt_pk_bf16_f32 v97,v90,v91
v_mfma_f32_16x16x32_bf16 v[76:79],a[248:251],v[248:251],v[76:79]
v_cvt_pk_bf16_f32 v98,v92,v93
v_cvt_pk_bf16_f32 v99,v94,v95
v_mfma_f32_16x16x32_bf16 v[68:71],a[124:127],v[252:255],v[68:71]
v_max_u32 v96,1,v96
v_mfma_f32_16x16x32_bf16 v[76:79],a[252:255],v[252:255],v[76:79]
buffer_store_dwordx4 v[96:99],v18,s[20:23],s78 offen sc1
v_cmp_eq_u32 vcc,0,v27
s_cbranch_vccnz retry_222
s_branch epi_225
ahead_224:
s_cmp_eq_u32 s93,0
s_cbranch_scc1 both_226
s_waitcnt vmcnt(13) lgkmcnt(0)
s_barrier
ds_read_b128 v[224:227],v17 offset:0
ds_read_b128 v[228:231],v43 offset:0
ds_read_b128 v[232:235],v17 offset:8192
ds_read_b128 v[236:239],v43 offset:8192
ds_read_b128 v[240:243],v17 offset:1024
ds_read_b128 v[244:247],v43 offset:1024
ds_read_b128 v[248:251],v17 offset:9216
s_waitcnt lgkmcnt(5)
v_mfma_f32_16x16x32_bf16 v[64:67],a[0:3],v[224:227],0
s_add_u32 s96,s71,1
s_add_u32 s92,s71,2
v_mfma_f32_16x16x32_bf16 v[72:75],a[128:131],v[224:227],0
ds_read_b128 v[252:255],v43 offset:9216
v_min_u32 v27,v224,v228
v_mfma_f32_16x16x32_bf16 v[64:67],a[4:7],v[228:231],v[64:67]
v_mfma_f32_16x16x32_bf16 v[72:75],a[132:135],v[228:231],v[72:75]
ds_read_b128 v[224:227],v17 offset:16384
s_waitcnt lgkmcnt(5)
v_mfma_f32_16x16x32_bf16 v[64:67],a[8:11],v[232:235],v[64:67]
v_min3_u32 v27,v27,v232,v236
v_mfma_f32_16x16x32_bf16 v[72:75],a[136:139],v[232:235],v[72:75]
ds_read_b128 v[228:231],v43 offset:16384
v_mfma_f32_16x16x32_bf16 v[64:67],a[12:15],v[236:239],v[64:67]
v_mfma_f32_16x16x32_bf16 v[72:75],a[140:143],v[236:239],v[72:75]
ds_read_b128 v[232:235],v17 offset:24576
s_waitcnt lgkmcnt(5)
v_mfma_f32_16x16x32_bf16 v[64:67],a[64:67],v[240:243],v[64:67]
v_min3_u32 v27,v27,v240,v244
v_mfma_f32_16x16x32_bf16 v[72:75],a[192:195],v[240:243],v[72:75]
ds_read_b128 v[236:239],v43 offset:24576
v_mfma_f32_16x16x32_bf16 v[64:67],a[68:71],v[244:247],v[64:67]
v_mfma_f32_16x16x32_bf16 v[72:75],a[196:199],v[244:247],v[72:75]
ds_read_b128 v[240:243],v17 offset:17408
s_waitcnt lgkmcnt(5)
v_mfma_f32_16x16x32_bf16 v[64:67],a[72:75],v[248:251],v[64:67]
v_min3_u32 v27,v27,v248,v252
v_mfma_f32_16x16x32_bf16 v[72:75],a[200:203],v[248:251],v[72:75]
ds_read_b128 v[244:247],v43 offset:17408
v_mfma_f32_16x16x32_bf16 v[64:67],a[76:79],v[252:255],v[64:67]
v_mfma_f32_16x16x32_bf16 v[72:75],a[204:207],v[252:255],v[72:75]
ds_read_b128 v[248:251],v17 offset:25600
s_waitcnt lgkmcnt(5)
v_mfma_f32_16x16x32_bf16 v[64:67],a[16:19],v[224:227],v[64:67]
v_min3_u32 v27,v27,v224,v228
v_mfma_f32_16x16x32_bf16 v[72:75],a[144:147],v[224:227],v[72:75]
ds_read_b128 v[252:255],v43 offset:25600
v_mfma_f32_16x16x32_bf16 v[64:67],a[20:23],v[228:231],v[64:67]
v_mfma_f32_16x16x32_bf16 v[72:75],a[148:151],v[228:231],v[72:75]
ds_read_b128 v[224:227],v17 offset:32768
s_waitcnt lgkmcnt(5)
v_mfma_f32_16x16x32_bf16 v[64:67],a[24:27],v[232:235],v[64:67]
v_min3_u32 v27,v27,v232,v236
v_mfma_f32_16x16x32_bf16 v[72:75],a[152:155],v[232:235],v[72:75]
ds_read_b128 v[228:231],v43 offset:32768
v_mfma_f32_16x16x32_bf16 v[64:67],a[28:31],v[236:239],v[64:67]
v_mfma_f32_16x16x32_bf16 v[72:75],a[156:159],v[236:239],v[72:75]
ds_read_b128 v[232:235],v17 offset:40960
s_waitcnt lgkmcnt(5)
v_mfma_f32_16x16x32_bf16 v[64:67],a[80:83],v[240:243],v[64:67]
v_min3_u32 v27,v27,v240,v244
v_mfma_f32_16x16x32_bf16 v[72:75],a[208:211],v[240:243],v[72:75]
ds_read_b128 v[236:239],v43 offset:40960
v_mfma_f32_16x16x32_bf16 v[64:67],a[84:87],v[244:247],v[64:67]
v_mfma_f32_16x16x32_bf16 v[72:75],a[212:215],v[244:247],v[72:75]
ds_read_b128 v[240:243],v17 offset:33792
s_waitcnt lgkmcnt(5)
v_mfma_f32_16x16x32_bf16 v[64:67],a[88:91],v[248:251],v[64:67]
v_min3_u32 v27,v27,v248,v252
v_mfma_f32_16x16x32_bf16 v[72:75],a[216:219],v[248:251],v[72:75]
ds_read_b128 v[244:247],v43 offset:33792
s_waitcnt vmcnt(3)
v_mfma_f32_16x16x32_bf16 v[64:67],a[92:95],v[252:255],v[64:67]
v_cmp_gt_u32 vcc,s96,v29
v_cmp_gt_u32 s[92:93],s92,v29
v_mfma_f32_16x16x32_bf16 v[72:75],a[220:223],v[252:255],v[72:75]
ds_read_b128 v[248:251],v17 offset:41984
s_waitcnt lgkmcnt(5)
v_mfma_f32_16x16x32_bf16 v[64:67],a[32:35],v[224:227],v[64:67]
v_mov_b32 v44,vcc_lo
v_mov_b32 v45,s92
v_mfma_f32_16x16x32_bf16 v[72:75],a[160:163],v[224:227],v[72:75]
ds_read_b128 v[252:255],v43 offset:41984
ds_write_b64 v46,v[44:45]
v_mfma_f32_16x16x32_bf16 v[64:67],a[36:39],v[228:231],v[64:67]
v_min3_u32 v27,v27,v224,v228
v_mfma_f32_16x16x32_bf16 v[72:75],a[164:167],v[228:231],v[72:75]
ds_read_b128 v[224:227],v17 offset:49152
s_waitcnt lgkmcnt(6)
v_mfma_f32_16x16x32_bf16 v[64:67],a[40:43],v[232:235],v[64:67]
v_min3_u32 v27,v27,v232,v236
v_mfma_f32_16x16x32_bf16 v[72:75],a[168:171],v[232:235],v[72:75]
ds_read_b128 v[228:231],v43 offset:49152
v_mfma_f32_16x16x32_bf16 v[64:67],a[44:47],v[236:239],v[64:67]
v_mfma_f32_16x16x32_bf16 v[72:75],a[172:175],v[236:239],v[72:75]
ds_read_b128 v[232:235],v17 offset:57344
s_waitcnt lgkmcnt(6)
v_mfma_f32_16x16x32_bf16 v[64:67],a[96:99],v[240:243],v[64:67]
v_min3_u32 v27,v27,v240,v244
s_add_u32 s88,s70,s75
v_mfma_f32_16x16x32_bf16 v[72:75],a[224:227],v[240:243],v[72:75]
ds_read_b128 v[236:239],v43 offset:57344
s_add_u32 s88,s88,2097152
v_mfma_f32_16x16x32_bf16 v[64:67],a[100:103],v[244:247],v[64:67]
s_xor_b32 s88,s88,0x2000
s_add_u32 s89,s88,65536
v_mfma_f32_16x16x32_bf16 v[72:75],a[228:231],v[244:247],v[72:75]
ds_read_b128 v[240:243],v17 offset:50176
s_waitcnt lgkmcnt(6)
v_mfma_f32_16x16x32_bf16 v[64:67],a[104:107],v[248:251],v[64:67]
v_min3_u32 v27,v27,v248,v252
v_mfma_f32_16x16x32_bf16 v[72:75],a[232:235],v[248:251],v[72:75]
ds_read_b128 v[244:247],v43 offset:50176
v_mfma_f32_16x16x32_bf16 v[64:67],a[108:111],v[252:255],v[64:67]
v_mfma_f32_16x16x32_bf16 v[72:75],a[236:239],v[252:255],v[72:75]
ds_read_b128 v[248:251],v17 offset:58368
s_waitcnt lgkmcnt(5)
v_mfma_f32_16x16x32_bf16 v[64:67],a[48:51],v[224:227],v[64:67]
v_min3_u32 v27,v27,v224,v228
v_mfma_f32_16x16x32_bf16 v[72:75],a[176:179],v[224:227],v[72:75]
ds_read_b128 v[252:255],v43 offset:58368
v_mfma_f32_16x16x32_bf16 v[64:67],a[52:55],v[228:231],v[64:67]
s_waitcnt vmcnt(0)
v_add_u32 v22,s71,-1
v_mfma_f32_16x16x32_bf16 v[72:75],a[180:183],v[228:231],v[72:75]
s_waitcnt vmcnt(5)
s_barrier
ds_read_b64 v[44:45],v47
ds_read_b128 v[224:227],v17 offset:4096
s_waitcnt lgkmcnt(6)
v_mfma_f32_16x16x32_bf16 v[64:67],a[56:59],v[232:235],v[64:67]
v_min3_u32 v27,v27,v232,v236
buffer_store_dword v22,v23,s[24:27],s97 offen
v_mfma_f32_16x16x32_bf16 v[72:75],a[184:187],v[232:235],v[72:75]
ds_read_b128 v[228:231],v43 offset:4096
v_mfma_f32_16x16x32_bf16 v[64:67],a[60:63],v[236:239],v[64:67]
buffer_store_dword v22,v23,s[28:31],s97 offen sc1
v_mfma_f32_16x16x32_bf16 v[72:75],a[188:191],v[236:239],v[72:75]
ds_read_b128 v[232:235],v17 offset:12288
s_waitcnt lgkmcnt(6)
v_mfma_f32_16x16x32_bf16 v[64:67],a[112:115],v[240:243],v[64:67]
v_min3_u32 v27,v27,v240,v244
s_mov_b32 s97,0x7fff0000
v_mfma_f32_16x16x32_bf16 v[72:75],a[240:243],v[240:243],v[72:75]
ds_read_b128 v[236:239],v43 offset:12288
v_mfma_f32_16x16x32_bf16 v[64:67],a[116:119],v[244:247],v[64:67]
v_mfma_f32_16x16x32_bf16 v[72:75],a[244:247],v[244:247],v[72:75]
ds_read_b128 v[240:243],v17 offset:5120
s_waitcnt lgkmcnt(6)
v_mfma_f32_16x16x32_bf16 v[64:67],a[120:123],v[248:251],v[64:67]
s_waitcnt lgkmcnt(5)
v_readfirstlane_b32 s93,v45
v_mfma_f32_16x16x32_bf16 v[72:75],a[248:251],v[248:251],v[72:75]
ds_read_b128 v[244:247],v43 offset:5120
v_readfirstlane_b32 s83,v44
s_cmp_lg_u32 s83,0
s_cbranch_scc1 keep_231
v_mfma_f32_16x16x32_bf16 v[64:67],a[124:127],v[252:255],v[64:67]
v_min3_u32 v27,v27,v248,v252
s_xor_b32 m0,s72,0
v_mfma_f32_16x16x32_bf16 v[72:75],a[252:255],v[252:255],v[72:75]
ds_read_b128 v[248:251],v17 offset:13312
s_waitcnt lgkmcnt(5)
v_mfma_f32_16x16x32_bf16 v[68:71],a[0:3],v[224:227],0
s_add_u32 s65,s88,0
v_cmp_eq_u32 vcc,0,v27
s_cbranch_vccnz retry_222
v_mfma_f32_16x16x32_bf16 v[76:79],a[128:131],v[224:227],0
ds_read_b128 v[252:255],v43 offset:13312
v_min3_u32 v27,v27,v224,v228
v_mfma_f32_16x16x32_bf16 v[68:71],a[4:7],v[228:231],v[68:71]
buffer_load_dwordx4 v42,s[20:23],s65 offen offset:0 sc1 lds
v_mfma_f32_16x16x32_bf16 v[76:79],a[132:135],v[228:231],v[76:79]
ds_read_b128 v[224:227],v17 offset:20480
s_waitcnt lgkmcnt(5)
v_mfma_f32_16x16x32_bf16 v[68:71],a[8:11],v[232:235],v[68:71]
buffer_load_dwordx4 v42,s[20:23],s65 offen offset:1024 sc1 lds
v_mul_f32 v88,v64,v64
v_mul_f32 v89,v65,v65
v_mfma_f32_16x16x32_bf16 v[76:79],a[136:139],v[232:235],v[76:79]
ds_read_b128 v[228:231],v43 offset:20480
s_xor_b32 m0,s72,16384
v_mul_f32 v90,v66,v66
v_mul_f32 v91,v67,v67
v_mfma_f32_16x16x32_bf16 v[68:71],a[12:15],v[236:239],v[68:71]
s_add_u32 s65,s88,256
v_min3_u32 v27,v27,v232,v236
v_fma_f32 v88,v88,s81,v28
v_fma_f32 v89,v89,s81,v28
v_mfma_f32_16x16x32_bf16 v[76:79],a[140:143],v[236:239],v[76:79]
ds_read_b128 v[232:235],v17 offset:28672
v_fma_f32 v90,v90,s81,v28
v_fma_f32 v91,v91,s81,v28
s_waitcnt lgkmcnt(5)
v_mfma_f32_16x16x32_bf16 v[68:71],a[64:67],v[240:243],v[68:71]
buffer_load_dwordx4 v42,s[20:23],s65 offen offset:0 sc1 lds
v_mul_f32 v88,v88,v64
v_mul_f32 v89,v89,v65
v_mfma_f32_16x16x32_bf16 v[76:79],a[192:195],v[240:243],v[76:79]
ds_read_b128 v[236:239],v43 offset:28672
v_min3_u32 v27,v27,v240,v244
v_mul_f32 v90,v90,v66
v_mul_f32 v91,v91,v67
v_mfma_f32_16x16x32_bf16 v[68:71],a[68:71],v[244:247],v[68:71]
buffer_load_dwordx4 v42,s[20:23],s65 offen offset:1024 sc1 lds
v_exp_f32 v88,v88
v_mfma_f32_16x16x32_bf16 v[76:79],a[196:199],v[244:247],v[76:79]
ds_read_b128 v[240:243],v17 offset:21504
v_exp_f32 v89,v89
s_waitcnt lgkmcnt(5)
v_mfma_f32_16x16x32_bf16 v[68:71],a[72:75],v[248:251],v[68:71]
s_xor_b32 m0,s72,32768
s_add_u32 s65,s88,512
v_exp_f32 v90,v90
v_mfma_f32_16x16x32_bf16 v[76:79],a[200:203],v[248:251],v[76:79]
ds_read_b128 v[244:247],v43 offset:21504
v_min3_u32 v27,v27,v248,v252
v_exp_f32 v91,v91
v_mfma_f32_16x16x32_bf16 v[68:71],a[76:79],v[252:255],v[68:71]
buffer_load_dwordx4 v42,s[20:23],s65 offen offset:0 sc1 lds
v_add_f32 v88,1.0,v88
v_add_f32 v89,1.0,v89
v_mfma_f32_16x16x32_bf16 v[76:79],a[204:207],v[252:255],v[76:79]
ds_read_b128 v[248:251],v17 offset:29696
v_add_f32 v90,1.0,v90
v_add_f32 v91,1.0,v91
s_waitcnt lgkmcnt(5)
v_mfma_f32_16x16x32_bf16 v[68:71],a[16:19],v[224:227],v[68:71]
buffer_load_dwordx4 v42,s[20:23],s65 offen offset:1024 sc1 lds
v_rcp_f32 v88,v88
v_mfma_f32_16x16x32_bf16 v[76:79],a[144:147],v[224:227],v[76:79]
ds_read_b128 v[252:255],v43 offset:29696
s_xor_b32 m0,s72,49152
v_mul_f32 v92,v72,v72
v_mul_f32 v93,v73,v73
v_mfma_f32_16x16x32_bf16 v[68:71],a[20:23],v[228:231],v[68:71]
v_min3_u32 v27,v27,v224,v228
v_mul_f32 v94,v74,v74
v_mul_f32 v95,v75,v75
v_fma_f32 v92,v92,s81,v28
v_mfma_f32_16x16x32_bf16 v[76:79],a[148:151],v[228:231],v[76:79]
ds_read_b128 v[224:227],v17 offset:36864
v_fma_f32 v93,v93,s81,v28
v_fma_f32 v94,v94,s81,v28
s_waitcnt lgkmcnt(5)
v_mfma_f32_16x16x32_bf16 v[68:71],a[24:27],v[232:235],v[68:71]
s_add_u32 s65,s88,768
v_min3_u32 v27,v27,v232,v236
v_fma_f32 v95,v95,s81,v28
v_mul_f32 v92,v92,v72
v_mfma_f32_16x16x32_bf16 v[76:79],a[152:155],v[232:235],v[76:79]
ds_read_b128 v[228:231],v43 offset:36864
v_mul_f32 v93,v93,v73
v_mul_f32 v94,v94,v74
v_mul_f32 v95,v95,v75
v_mfma_f32_16x16x32_bf16 v[68:71],a[28:31],v[236:239],v[68:71]
buffer_load_dwordx4 v42,s[20:23],s65 offen offset:0 sc1 lds
v_exp_f32 v92,v92
v_mfma_f32_16x16x32_bf16 v[76:79],a[156:159],v[236:239],v[76:79]
ds_read_b128 v[232:235],v17 offset:45056
v_exp_f32 v93,v93
s_waitcnt lgkmcnt(5)
v_mfma_f32_16x16x32_bf16 v[68:71],a[80:83],v[240:243],v[68:71]
buffer_load_dwordx4 v42,s[20:23],s65 offen offset:1024 sc1 lds
v_exp_f32 v94,v94
v_mfma_f32_16x16x32_bf16 v[76:79],a[208:211],v[240:243],v[76:79]
ds_read_b128 v[236:239],v43 offset:45056
s_xor_b32 m0,s72,4096
v_exp_f32 v95,v95
v_mfma_f32_16x16x32_bf16 v[68:71],a[84:87],v[244:247],v[68:71]
s_add_u32 s65,s89,0
v_min3_u32 v27,v27,v240,v244
v_add_f32 v92,1.0,v92
v_add_f32 v93,1.0,v93
v_mfma_f32_16x16x32_bf16 v[76:79],a[212:215],v[244:247],v[76:79]
ds_read_b128 v[240:243],v17 offset:37888
v_add_f32 v94,1.0,v94
v_add_f32 v95,1.0,v95
s_waitcnt lgkmcnt(5)
v_mfma_f32_16x16x32_bf16 v[68:71],a[88:91],v[248:251],v[68:71]
buffer_load_dwordx4 v42,s[20:23],s65 offen offset:0 sc1 lds
v_rcp_f32 v92,v92
v_mfma_f32_16x16x32_bf16 v[76:79],a[216:219],v[248:251],v[76:79]
ds_read_b128 v[244:247],v43 offset:37888
v_min3_u32 v27,v27,v248,v252
v_rcp_f32 v93,v93
v_mfma_f32_16x16x32_bf16 v[68:71],a[92:95],v[252:255],v[68:71]
buffer_load_dwordx4 v42,s[20:23],s65 offen offset:1024 sc1 lds
v_rcp_f32 v94,v94
v_mfma_f32_16x16x32_bf16 v[76:79],a[220:223],v[252:255],v[76:79]
ds_read_b128 v[248:251],v17 offset:46080
v_rcp_f32 v95,v95
s_waitcnt lgkmcnt(5)
v_mfma_f32_16x16x32_bf16 v[68:71],a[32:35],v[224:227],v[68:71]
s_xor_b32 m0,s72,20480
s_add_u32 s65,s89,256
v_mfma_f32_16x16x32_bf16 v[76:79],a[160:163],v[224:227],v[76:79]
ds_read_b128 v[252:255],v43 offset:46080
v_min3_u32 v27,v27,v224,v228
v_mfma_f32_16x16x32_bf16 v[68:71],a[36:39],v[228:231],v[68:71]
buffer_load_dwordx4 v42,s[20:23],s65 offen offset:0 sc1 lds
v_mfma_f32_16x16x32_bf16 v[76:79],a[164:167],v[228:231],v[76:79]
ds_read_b128 v[224:227],v17 offset:53248
s_waitcnt lgkmcnt(5)
v_mfma_f32_16x16x32_bf16 v[68:71],a[40:43],v[232:235],v[68:71]
buffer_load_dwordx4 v42,s[20:23],s65 offen offset:1024 sc1 lds
v_mfma_f32_16x16x32_bf16 v[76:79],a[168:171],v[232:235],v[76:79]
ds_read_b128 v[228:231],v43 offset:53248
s_xor_b32 m0,s72,36864
v_mfma_f32_16x16x32_bf16 v[68:71],a[44:47],v[236:239],v[68:71]
s_add_u32 s65,s89,512
v_min3_u32 v27,v27,v232,v236
v_mfma_f32_16x16x32_bf16 v[76:79],a[172:175],v[236:239],v[76:79]
ds_read_b128 v[232:235],v17 offset:61440
s_waitcnt lgkmcnt(5)
v_mfma_f32_16x16x32_bf16 v[68:71],a[96:99],v[240:243],v[68:71]
buffer_load_dwordx4 v42,s[20:23],s65 offen offset:0 sc1 lds
v_mfma_f32_16x16x32_bf16 v[76:79],a[224:227],v[240:243],v[76:79]
ds_read_b128 v[236:239],v43 offset:61440
v_min3_u32 v27,v27,v240,v244
v_mfma_f32_16x16x32_bf16 v[68:71],a[100:103],v[244:247],v[68:71]
buffer_load_dwordx4 v42,s[20:23],s65 offen offset:1024 sc1 lds
v_mfma_f32_16x16x32_bf16 v[76:79],a[228:231],v[244:247],v[76:79]
ds_read_b128 v[240:243],v17 offset:54272
s_waitcnt lgkmcnt(5)
v_mfma_f32_16x16x32_bf16 v[68:71],a[104:107],v[248:251],v[68:71]
s_xor_b32 m0,s72,53248
v_min3_u32 v27,v27,v248,v252
v_mfma_f32_16x16x32_bf16 v[76:79],a[232:235],v[248:251],v[76:79]
ds_read_b128 v[244:247],v43 offset:54272
s_add_u32 s65,s89,768
v_mfma_f32_16x16x32_bf16 v[68:71],a[108:111],v[252:255],v[68:71]
buffer_load_dwordx4 v42,s[20:23],s65 offen offset:0 sc1 lds
v_mfma_f32_16x16x32_bf16 v[76:79],a[236:239],v[252:255],v[76:79]
ds_read_b128 v[248:251],v17 offset:62464
s_waitcnt lgkmcnt(5)
v_mfma_f32_16x16x32_bf16 v[68:71],a[48:51],v[224:227],v[68:71]
buffer_load_dwordx4 v42,s[20:23],s65 offen offset:1024 sc1 lds
v_mfma_f32_16x16x32_bf16 v[76:79],a[176:179],v[224:227],v[76:79]
ds_read_b128 v[252:255],v43 offset:62464
v_min3_u32 v27,v27,v224,v228
v_mfma_f32_16x16x32_bf16 v[68:71],a[52:55],v[228:231],v[68:71]
v_rcp_f32 v89,v89
v_mfma_f32_16x16x32_bf16 v[76:79],a[180:183],v[228:231],v[76:79]
v_mul_f32 v92,v92,v72
s_waitcnt lgkmcnt(4)
v_mfma_f32_16x16x32_bf16 v[68:71],a[56:59],v[232:235],v[68:71]
v_min3_u32 v27,v27,v232,v236
v_mul_f32 v93,v93,v73
v_mfma_f32_16x16x32_bf16 v[76:79],a[184:187],v[232:235],v[76:79]
v_rcp_f32 v90,v90
v_mfma_f32_16x16x32_bf16 v[68:71],a[60:63],v[236:239],v[68:71]
v_rcp_f32 v91,v91
v_mfma_f32_16x16x32_bf16 v[76:79],a[188:191],v[236:239],v[76:79]
v_mul_f32 v88,v88,v64
s_waitcnt lgkmcnt(2)
v_mfma_f32_16x16x32_bf16 v[68:71],a[112:115],v[240:243],v[68:71]
v_min3_u32 v27,v27,v240,v244
v_mul_f32 v89,v89,v65
v_mfma_f32_16x16x32_bf16 v[76:79],a[240:243],v[240:243],v[76:79]
v_mul_f32 v90,v90,v66
v_mul_f32 v91,v91,v67
v_mfma_f32_16x16x32_bf16 v[68:71],a[116:119],v[244:247],v[68:71]
v_mul_f32 v94,v94,v74
v_mul_f32 v95,v95,v75
v_mfma_f32_16x16x32_bf16 v[76:79],a[244:247],v[244:247],v[76:79]
v_cvt_pk_bf16_f32 v96,v88,v89
s_waitcnt lgkmcnt(0)
v_mfma_f32_16x16x32_bf16 v[68:71],a[120:123],v[248:251],v[68:71]
v_min3_u32 v27,v27,v248,v252
v_cvt_pk_bf16_f32 v97,v90,v91
v_mfma_f32_16x16x32_bf16 v[76:79],a[248:251],v[248:251],v[76:79]
v_cvt_pk_bf16_f32 v98,v92,v93
v_cvt_pk_bf16_f32 v99,v94,v95
v_mfma_f32_16x16x32_bf16 v[68:71],a[124:127],v[252:255],v[68:71]
v_max_u32 v96,1,v96
v_mfma_f32_16x16x32_bf16 v[76:79],a[252:255],v[252:255],v[76:79]
buffer_store_dwordx4 v[96:99],v18,s[20:23],s78 offen sc1
v_cmp_eq_u32 vcc,0,v27
s_cbranch_vccnz retry_222
s_branch epi_225
keep_231:
v_mfma_f32_16x16x32_bf16 v[64:67],a[124:127],v[252:255],v[64:67]
v_min3_u32 v27,v27,v248,v252
v_mfma_f32_16x16x32_bf16 v[72:75],a[252:255],v[252:255],v[72:75]
ds_read_b128 v[248:251],v17 offset:13312
s_waitcnt lgkmcnt(5)
v_mfma_f32_16x16x32_bf16 v[68:71],a[0:3],v[224:227],0
v_cmp_eq_u32 vcc,0,v27
s_cbranch_vccnz retry_222
v_mfma_f32_16x16x32_bf16 v[76:79],a[128:131],v[224:227],0
ds_read_b128 v[252:255],v43 offset:13312
v_min3_u32 v27,v27,v224,v228
v_mfma_f32_16x16x32_bf16 v[68:71],a[4:7],v[228:231],v[68:71]
v_mfma_f32_16x16x32_bf16 v[76:79],a[132:135],v[228:231],v[76:79]
ds_read_b128 v[224:227],v17 offset:20480
s_waitcnt lgkmcnt(5)
v_mfma_f32_16x16x32_bf16 v[68:71],a[8:11],v[232:235],v[68:71]
v_min3_u32 v27,v27,v232,v236
v_mul_f32 v88,v64,v64
v_mul_f32 v92,v72,v72
v_mfma_f32_16x16x32_bf16 v[76:79],a[136:139],v[232:235],v[76:79]
ds_read_b128 v[228:231],v43 offset:20480
v_mul_f32 v89,v65,v65
v_mul_f32 v93,v73,v73
v_mfma_f32_16x16x32_bf16 v[68:71],a[12:15],v[236:239],v[68:71]
v_mul_f32 v90,v66,v66
v_mul_f32 v91,v67,v67
v_mul_f32 v94,v74,v74
v_mfma_f32_16x16x32_bf16 v[76:79],a[140:143],v[236:239],v[76:79]
ds_read_b128 v[232:235],v17 offset:28672
v_mul_f32 v95,v75,v75
s_waitcnt lgkmcnt(5)
v_mfma_f32_16x16x32_bf16 v[68:71],a[64:67],v[240:243],v[68:71]
v_min3_u32 v27,v27,v240,v244
v_fma_f32 v88,v88,s81,v28
v_fma_f32 v92,v92,s81,v28
v_mfma_f32_16x16x32_bf16 v[76:79],a[192:195],v[240:243],v[76:79]
ds_read_b128 v[236:239],v43 offset:28672
v_fma_f32 v89,v89,s81,v28
v_fma_f32 v93,v93,s81,v28
v_mfma_f32_16x16x32_bf16 v[68:71],a[68:71],v[244:247],v[68:71]
v_fma_f32 v90,v90,s81,v28
v_fma_f32 v91,v91,s81,v28
v_fma_f32 v94,v94,s81,v28
v_mfma_f32_16x16x32_bf16 v[76:79],a[196:199],v[244:247],v[76:79]
ds_read_b128 v[240:243],v17 offset:21504
v_fma_f32 v95,v95,s81,v28
s_waitcnt lgkmcnt(5)
v_mfma_f32_16x16x32_bf16 v[68:71],a[72:75],v[248:251],v[68:71]
v_min3_u32 v27,v27,v248,v252
v_mul_f32 v88,v88,v64
v_mul_f32 v92,v92,v72
v_mfma_f32_16x16x32_bf16 v[76:79],a[200:203],v[248:251],v[76:79]
ds_read_b128 v[244:247],v43 offset:21504
v_mul_f32 v89,v89,v65
v_mul_f32 v93,v93,v73
v_mfma_f32_16x16x32_bf16 v[68:71],a[76:79],v[252:255],v[68:71]
v_mul_f32 v90,v90,v66
v_mul_f32 v91,v91,v67
v_mul_f32 v94,v94,v74
v_mfma_f32_16x16x32_bf16 v[76:79],a[204:207],v[252:255],v[76:79]
ds_read_b128 v[248:251],v17 offset:29696
v_mul_f32 v95,v95,v75
s_waitcnt lgkmcnt(5)
v_mfma_f32_16x16x32_bf16 v[68:71],a[16:19],v[224:227],v[68:71]
v_min3_u32 v27,v27,v224,v228
v_exp_f32 v92,v92
v_mfma_f32_16x16x32_bf16 v[76:79],a[144:147],v[224:227],v[76:79]
ds_read_b128 v[252:255],v43 offset:29696
v_exp_f32 v93,v93
v_mfma_f32_16x16x32_bf16 v[68:71],a[20:23],v[228:231],v[68:71]
v_exp_f32 v88,v88
v_mfma_f32_16x16x32_bf16 v[76:79],a[148:151],v[228:231],v[76:79]
ds_read_b128 v[224:227],v17 offset:36864
s_waitcnt lgkmcnt(5)
v_mfma_f32_16x16x32_bf16 v[68:71],a[24:27],v[232:235],v[68:71]
v_min3_u32 v27,v27,v232,v236
v_exp_f32 v94,v94
v_mfma_f32_16x16x32_bf16 v[76:79],a[152:155],v[232:235],v[76:79]
ds_read_b128 v[228:231],v43 offset:36864
v_exp_f32 v95,v95
v_mfma_f32_16x16x32_bf16 v[68:71],a[28:31],v[236:239],v[68:71]
v_exp_f32 v89,v89
v_add_f32 v92,1.0,v92
v_mfma_f32_16x16x32_bf16 v[76:79],a[156:159],v[236:239],v[76:79]
ds_read_b128 v[232:235],v17 offset:45056
v_add_f32 v93,1.0,v93
s_waitcnt lgkmcnt(5)
v_mfma_f32_16x16x32_bf16 v[68:71],a[80:83],v[240:243],v[68:71]
v_min3_u32 v27,v27,v240,v244
v_add_f32 v94,1.0,v94
v_add_f32 v95,1.0,v95
v_mfma_f32_16x16x32_bf16 v[76:79],a[208:211],v[240:243],v[76:79]
ds_read_b128 v[236:239],v43 offset:45056
v_rcp_f32 v92,v92
v_mfma_f32_16x16x32_bf16 v[68:71],a[84:87],v[244:247],v[68:71]
v_exp_f32 v90,v90
v_mfma_f32_16x16x32_bf16 v[76:79],a[212:215],v[244:247],v[76:79]
ds_read_b128 v[240:243],v17 offset:37888
s_waitcnt lgkmcnt(5)
v_mfma_f32_16x16x32_bf16 v[68:71],a[88:91],v[248:251],v[68:71]
v_min3_u32 v27,v27,v248,v252
v_rcp_f32 v93,v93
v_mfma_f32_16x16x32_bf16 v[76:79],a[216:219],v[248:251],v[76:79]
ds_read_b128 v[244:247],v43 offset:37888
v_rcp_f32 v94,v94
v_mfma_f32_16x16x32_bf16 v[68:71],a[92:95],v[252:255],v[68:71]
v_exp_f32 v91,v91
v_mfma_f32_16x16x32_bf16 v[76:79],a[220:223],v[252:255],v[76:79]
ds_read_b128 v[248:251],v17 offset:46080
s_waitcnt lgkmcnt(5)
v_mfma_f32_16x16x32_bf16 v[68:71],a[32:35],v[224:227],v[68:71]
v_min3_u32 v27,v27,v224,v228
v_add_f32 v88,1.0,v88
v_mfma_f32_16x16x32_bf16 v[76:79],a[160:163],v[224:227],v[76:79]
ds_read_b128 v[252:255],v43 offset:46080
v_add_f32 v89,1.0,v89
v_mfma_f32_16x16x32_bf16 v[68:71],a[36:39],v[228:231],v[68:71]
v_add_f32 v90,1.0,v90
v_add_f32 v91,1.0,v91
v_mfma_f32_16x16x32_bf16 v[76:79],a[164:167],v[228:231],v[76:79]
ds_read_b128 v[224:227],v17 offset:53248
s_waitcnt lgkmcnt(5)
v_mfma_f32_16x16x32_bf16 v[68:71],a[40:43],v[232:235],v[68:71]
v_min3_u32 v27,v27,v232,v236
v_mfma_f32_16x16x32_bf16 v[76:79],a[168:171],v[232:235],v[76:79]
ds_read_b128 v[228:231],v43 offset:53248
v_mfma_f32_16x16x32_bf16 v[68:71],a[44:47],v[236:239],v[68:71]
v_rcp_f32 v88,v88
v_mfma_f32_16x16x32_bf16 v[76:79],a[172:175],v[236:239],v[76:79]
ds_read_b128 v[232:235],v17 offset:61440
s_waitcnt lgkmcnt(5)
v_mfma_f32_16x16x32_bf16 v[68:71],a[96:99],v[240:243],v[68:71]
v_min3_u32 v27,v27,v240,v244
v_mfma_f32_16x16x32_bf16 v[76:79],a[224:227],v[240:243],v[76:79]
ds_read_b128 v[236:239],v43 offset:61440
v_mfma_f32_16x16x32_bf16 v[68:71],a[100:103],v[244:247],v[68:71]
v_rcp_f32 v89,v89
v_mfma_f32_16x16x32_bf16 v[76:79],a[228:231],v[244:247],v[76:79]
ds_read_b128 v[240:243],v17 offset:54272
s_waitcnt lgkmcnt(5)
v_mfma_f32_16x16x32_bf16 v[68:71],a[104:107],v[248:251],v[68:71]
v_min3_u32 v27,v27,v248,v252
v_mfma_f32_16x16x32_bf16 v[76:79],a[232:235],v[248:251],v[76:79]
ds_read_b128 v[244:247],v43 offset:54272
v_mfma_f32_16x16x32_bf16 v[68:71],a[108:111],v[252:255],v[68:71]
v_rcp_f32 v90,v90
v_mfma_f32_16x16x32_bf16 v[76:79],a[236:239],v[252:255],v[76:79]
ds_read_b128 v[248:251],v17 offset:62464
s_waitcnt lgkmcnt(5)
v_mfma_f32_16x16x32_bf16 v[68:71],a[48:51],v[224:227],v[68:71]
v_min3_u32 v27,v27,v224,v228
v_mfma_f32_16x16x32_bf16 v[76:79],a[176:179],v[224:227],v[76:79]
ds_read_b128 v[252:255],v43 offset:62464
v_mfma_f32_16x16x32_bf16 v[68:71],a[52:55],v[228:231],v[68:71]
v_rcp_f32 v91,v91
v_mfma_f32_16x16x32_bf16 v[76:79],a[180:183],v[228:231],v[76:79]
v_mul_f32 v88,v88,v64
s_waitcnt lgkmcnt(4)
v_mfma_f32_16x16x32_bf16 v[68:71],a[56:59],v[232:235],v[68:71]
v_min3_u32 v27,v27,v232,v236
v_mul_f32 v89,v89,v65
v_mfma_f32_16x16x32_bf16 v[76:79],a[184:187],v[232:235],v[76:79]
v_mul_f32 v90,v90,v66
v_mul_f32 v91,v91,v67
v_mfma_f32_16x16x32_bf16 v[68:71],a[60:63],v[236:239],v[68:71]
v_rcp_f32 v95,v95
v_mfma_f32_16x16x32_bf16 v[76:79],a[188:191],v[236:239],v[76:79]
v_mul_f32 v92,v92,v72
s_waitcnt lgkmcnt(2)
v_mfma_f32_16x16x32_bf16 v[68:71],a[112:115],v[240:243],v[68:71]
v_min3_u32 v27,v27,v240,v244
v_mul_f32 v93,v93,v73
v_mfma_f32_16x16x32_bf16 v[76:79],a[240:243],v[240:243],v[76:79]
v_mul_f32 v94,v94,v74
v_mul_f32 v95,v95,v75
v_mfma_f32_16x16x32_bf16 v[68:71],a[116:119],v[244:247],v[68:71]
v_cvt_pk_bf16_f32 v96,v88,v89
v_cvt_pk_bf16_f32 v97,v90,v91
v_mfma_f32_16x16x32_bf16 v[76:79],a[244:247],v[244:247],v[76:79]
v_cvt_pk_bf16_f32 v98,v92,v93
s_waitcnt lgkmcnt(0)
v_mfma_f32_16x16x32_bf16 v[68:71],a[120:123],v[248:251],v[68:71]
v_min3_u32 v27,v27,v248,v252
v_cvt_pk_bf16_f32 v99,v94,v95
v_mfma_f32_16x16x32_bf16 v[76:79],a[248:251],v[248:251],v[76:79]
v_max_u32 v96,1,v96
v_mfma_f32_16x16x32_bf16 v[68:71],a[124:127],v[252:255],v[68:71]
buffer_store_dwordx4 v[96:99],v18,s[20:23],s78 offen sc1
v_mfma_f32_16x16x32_bf16 v[76:79],a[252:255],v[252:255],v[76:79]
v_cmp_eq_u32 vcc,0,v27
s_cbranch_vccnz retry_222
s_branch epi_225
both_226:
s_waitcnt vmcnt(13) lgkmcnt(0)
s_barrier
ds_read_b128 v[224:227],v17 offset:0
ds_read_b128 v[228:231],v43 offset:0
ds_read_b128 v[232:235],v17 offset:8192
ds_read_b128 v[236:239],v43 offset:8192
ds_read_b128 v[240:243],v17 offset:1024
ds_read_b128 v[244:247],v43 offset:1024
ds_read_b128 v[248:251],v17 offset:9216
s_waitcnt lgkmcnt(5)
v_mfma_f32_16x16x32_bf16 v[64:67],a[0:3],v[224:227],0
s_add_u32 s96,s71,1
s_add_u32 s92,s71,2
v_min_u32 v27,v224,v228
v_mfma_f32_16x16x32_bf16 v[72:75],a[128:131],v[224:227],0
ds_read_b128 v[252:255],v43 offset:9216
s_add_u32 s88,s70,s75
v_mfma_f32_16x16x32_bf16 v[64:67],a[4:7],v[228:231],v[64:67]
s_add_u32 s88,s88,2097152
s_xor_b32 s88,s88,0x2000
v_mfma_f32_16x16x32_bf16 v[72:75],a[132:135],v[228:231],v[72:75]
ds_read_b128 v[224:227],v17 offset:16384
s_waitcnt lgkmcnt(5)
v_mfma_f32_16x16x32_bf16 v[64:67],a[8:11],v[232:235],v[64:67]
s_add_u32 s89,s88,65536
v_min3_u32 v27,v27,v232,v236
v_mfma_f32_16x16x32_bf16 v[72:75],a[136:139],v[232:235],v[72:75]
ds_read_b128 v[228:231],v43 offset:16384
v_mfma_f32_16x16x32_bf16 v[64:67],a[12:15],v[236:239],v[64:67]
s_xor_b32 m0,s72,0
v_mfma_f32_16x16x32_bf16 v[72:75],a[140:143],v[236:239],v[72:75]
ds_read_b128 v[232:235],v17 offset:24576
s_add_u32 s65,s88,0
s_waitcnt lgkmcnt(5)
v_mfma_f32_16x16x32_bf16 v[64:67],a[64:67],v[240:243],v[64:67]
v_min3_u32 v27,v27,v240,v244
v_mfma_f32_16x16x32_bf16 v[72:75],a[192:195],v[240:243],v[72:75]
ds_read_b128 v[236:239],v43 offset:24576
buffer_load_dwordx4 v42,s[20:23],s65 offen offset:0 sc1 lds
v_mfma_f32_16x16x32_bf16 v[64:67],a[68:71],v[244:247],v[64:67]
buffer_load_dwordx4 v42,s[20:23],s65 offen offset:1024 sc1 lds
v_mfma_f32_16x16x32_bf16 v[72:75],a[196:199],v[244:247],v[72:75]
ds_read_b128 v[240:243],v17 offset:17408
s_waitcnt lgkmcnt(5)
v_mfma_f32_16x16x32_bf16 v[64:67],a[72:75],v[248:251],v[64:67]
s_xor_b32 m0,s72,16384
v_min3_u32 v27,v27,v248,v252
v_mfma_f32_16x16x32_bf16 v[72:75],a[200:203],v[248:251],v[72:75]
ds_read_b128 v[244:247],v43 offset:17408
v_mfma_f32_16x16x32_bf16 v[64:67],a[76:79],v[252:255],v[64:67]
s_add_u32 s65,s88,256
v_mfma_f32_16x16x32_bf16 v[72:75],a[204:207],v[252:255],v[72:75]
ds_read_b128 v[248:251],v17 offset:25600
s_waitcnt lgkmcnt(5)
v_mfma_f32_16x16x32_bf16 v[64:67],a[16:19],v[224:227],v[64:67]
buffer_load_dwordx4 v42,s[20:23],s65 offen offset:0 sc1 lds
v_mfma_f32_16x16x32_bf16 v[72:75],a[144:147],v[224:227],v[72:75]
ds_read_b128 v[252:255],v43 offset:25600
buffer_load_dwordx4 v42,s[20:23],s65 offen offset:1024 sc1 lds
v_mfma_f32_16x16x32_bf16 v[64:67],a[20:23],v[228:231],v[64:67]
v_min3_u32 v27,v27,v224,v228
v_mfma_f32_16x16x32_bf16 v[72:75],a[148:151],v[228:231],v[72:75]
ds_read_b128 v[224:227],v17 offset:32768
s_xor_b32 m0,s72,32768
s_waitcnt lgkmcnt(5)
v_mfma_f32_16x16x32_bf16 v[64:67],a[24:27],v[232:235],v[64:67]
s_add_u32 s65,s88,512
v_min3_u32 v27,v27,v232,v236
v_mfma_f32_16x16x32_bf16 v[72:75],a[152:155],v[232:235],v[72:75]
ds_read_b128 v[228:231],v43 offset:32768
v_mfma_f32_16x16x32_bf16 v[64:67],a[28:31],v[236:239],v[64:67]
buffer_load_dwordx4 v42,s[20:23],s65 offen offset:0 sc1 lds
v_mfma_f32_16x16x32_bf16 v[72:75],a[156:159],v[236:239],v[72:75]
ds_read_b128 v[232:235],v17 offset:40960
s_waitcnt lgkmcnt(5)
v_mfma_f32_16x16x32_bf16 v[64:67],a[80:83],v[240:243],v[64:67]
buffer_load_dwordx4 v42,s[20:23],s65 offen offset:1024 sc1 lds
v_mfma_f32_16x16x32_bf16 v[72:75],a[208:211],v[240:243],v[72:75]
ds_read_b128 v[236:239],v43 offset:40960
s_xor_b32 m0,s72,49152
v_mfma_f32_16x16x32_bf16 v[64:67],a[84:87],v[244:247],v[64:67]
v_min3_u32 v27,v27,v240,v244
v_mfma_f32_16x16x32_bf16 v[72:75],a[212:215],v[244:247],v[72:75]
ds_read_b128 v[240:243],v17 offset:33792
s_add_u32 s65,s88,768
s_waitcnt lgkmcnt(5)
v_mfma_f32_16x16x32_bf16 v[64:67],a[88:91],v[248:251],v[64:67]
buffer_load_dwordx4 v42,s[20:23],s65 offen offset:0 sc1 lds
v_min3_u32 v27,v27,v248,v252
v_mfma_f32_16x16x32_bf16 v[72:75],a[216:219],v[248:251],v[72:75]
ds_read_b128 v[244:247],v43 offset:33792
s_waitcnt vmcnt(10)
v_mfma_f32_16x16x32_bf16 v[64:67],a[92:95],v[252:255],v[64:67]
v_cmp_gt_u32 vcc,s96,v29
v_cmp_gt_u32 s[92:93],s92,v29
v_mfma_f32_16x16x32_bf16 v[72:75],a[220:223],v[252:255],v[72:75]
ds_read_b128 v[248:251],v17 offset:41984
s_waitcnt lgkmcnt(5)
v_mfma_f32_16x16x32_bf16 v[64:67],a[32:35],v[224:227],v[64:67]
v_mov_b32 v44,vcc_lo
v_mov_b32 v45,s92
v_min3_u32 v27,v27,v224,v228
v_mfma_f32_16x16x32_bf16 v[72:75],a[160:163],v[224:227],v[72:75]
ds_read_b128 v[252:255],v43 offset:41984
ds_write_b64 v46,v[44:45]
v_mfma_f32_16x16x32_bf16 v[64:67],a[36:39],v[228:231],v[64:67]
buffer_load_dwordx4 v42,s[20:23],s65 offen offset:1024 sc1 lds
v_mfma_f32_16x16x32_bf16 v[72:75],a[164:167],v[228:231],v[72:75]
ds_read_b128 v[224:227],v17 offset:49152
s_waitcnt lgkmcnt(6)
v_mfma_f32_16x16x32_bf16 v[64:67],a[40:43],v[232:235],v[64:67]
s_xor_b32 m0,s72,4096
s_add_u32 s65,s89,0
v_mfma_f32_16x16x32_bf16 v[72:75],a[168:171],v[232:235],v[72:75]
ds_read_b128 v[228:231],v43 offset:49152
v_min3_u32 v27,v27,v232,v236
v_mfma_f32_16x16x32_bf16 v[64:67],a[44:47],v[236:239],v[64:67]
buffer_load_dwordx4 v42,s[20:23],s65 offen offset:0 sc1 lds
v_mfma_f32_16x16x32_bf16 v[72:75],a[172:175],v[236:239],v[72:75]
ds_read_b128 v[232:235],v17 offset:57344
s_waitcnt lgkmcnt(6)
v_mfma_f32_16x16x32_bf16 v[64:67],a[96:99],v[240:243],v[64:67]
buffer_load_dwordx4 v42,s[20:23],s65 offen offset:1024 sc1 lds
v_mfma_f32_16x16x32_bf16 v[72:75],a[224:227],v[240:243],v[72:75]
ds_read_b128 v[236:239],v43 offset:57344
s_xor_b32 m0,s72,20480
v_mfma_f32_16x16x32_bf16 v[64:67],a[100:103],v[244:247],v[64:67]
s_add_u32 s65,s89,256
v_min3_u32 v27,v27,v240,v244
v_mfma_f32_16x16x32_bf16 v[72:75],a[228:231],v[244:247],v[72:75]
ds_read_b128 v[240:243],v17 offset:50176
s_waitcnt lgkmcnt(6)
v_mfma_f32_16x16x32_bf16 v[64:67],a[104:107],v[248:251],v[64:67]
buffer_load_dwordx4 v42,s[20:23],s65 offen offset:0 sc1 lds
v_mfma_f32_16x16x32_bf16 v[72:75],a[232:235],v[248:251],v[72:75]
ds_read_b128 v[244:247],v43 offset:50176
v_min3_u32 v27,v27,v248,v252
v_mfma_f32_16x16x32_bf16 v[64:67],a[108:111],v[252:255],v[64:67]
buffer_load_dwordx4 v42,s[20:23],s65 offen offset:1024 sc1 lds
v_mfma_f32_16x16x32_bf16 v[72:75],a[236:239],v[252:255],v[72:75]
ds_read_b128 v[248:251],v17 offset:58368
s_waitcnt lgkmcnt(5)
v_mfma_f32_16x16x32_bf16 v[64:67],a[48:51],v[224:227],v[64:67]
s_xor_b32 m0,s72,36864
s_add_u32 s65,s89,512
v_mfma_f32_16x16x32_bf16 v[72:75],a[176:179],v[224:227],v[72:75]
ds_read_b128 v[252:255],v43 offset:58368
v_min3_u32 v27,v27,v224,v228
v_mfma_f32_16x16x32_bf16 v[64:67],a[52:55],v[228:231],v[64:67]
buffer_load_dwordx4 v42,s[20:23],s65 offen offset:0 sc1 lds
s_waitcnt vmcnt(13)
v_add_u32 v22,s71,-1
v_mfma_f32_16x16x32_bf16 v[72:75],a[180:183],v[228:231],v[72:75]
s_waitcnt vmcnt(18)
s_barrier
ds_read_b64 v[44:45],v47
ds_read_b128 v[224:227],v17 offset:4096
s_waitcnt lgkmcnt(6)
v_mfma_f32_16x16x32_bf16 v[64:67],a[56:59],v[232:235],v[64:67]
buffer_load_dwordx4 v42,s[20:23],s65 offen offset:1024 sc1 lds
buffer_store_dword v22,v23,s[24:27],s97 offen
v_mfma_f32_16x16x32_bf16 v[72:75],a[184:187],v[232:235],v[72:75]
ds_read_b128 v[228:231],v43 offset:4096
s_xor_b32 m0,s72,53248
buffer_store_dword v22,v23,s[28:31],s97 offen sc1
v_mfma_f32_16x16x32_bf16 v[64:67],a[60:63],v[236:239],v[64:67]
s_add_u32 s65,s89,768
v_min3_u32 v27,v27,v232,v236
s_mov_b32 s97,0x7fff0000
v_mfma_f32_16x16x32_bf16 v[72:75],a[188:191],v[236:239],v[72:75]
ds_read_b128 v[232:235],v17 offset:12288
s_waitcnt lgkmcnt(6)
v_mfma_f32_16x16x32_bf16 v[64:67],a[112:115],v[240:243],v[64:67]
buffer_load_dwordx4 v42,s[20:23],s65 offen offset:0 sc1 lds
v_mfma_f32_16x16x32_bf16 v[72:75],a[240:243],v[240:243],v[72:75]
ds_read_b128 v[236:239],v43 offset:12288
v_min3_u32 v27,v27,v240,v244
v_mfma_f32_16x16x32_bf16 v[64:67],a[116:119],v[244:247],v[64:67]
buffer_load_dwordx4 v42,s[20:23],s65 offen offset:1024 sc1 lds
v_mfma_f32_16x16x32_bf16 v[72:75],a[244:247],v[244:247],v[72:75]
ds_read_b128 v[240:243],v17 offset:5120
s_waitcnt lgkmcnt(6)
v_mfma_f32_16x16x32_bf16 v[64:67],a[120:123],v[248:251],v[64:67]
s_waitcnt lgkmcnt(5)
v_readfirstlane_b32 s93,v45
v_mfma_f32_16x16x32_bf16 v[72:75],a[248:251],v[248:251],v[72:75]
ds_read_b128 v[244:247],v43 offset:5120
v_min3_u32 v27,v27,v248,v252
v_mfma_f32_16x16x32_bf16 v[64:67],a[124:127],v[252:255],v[64:67]
v_mfma_f32_16x16x32_bf16 v[72:75],a[252:255],v[252:255],v[72:75]
ds_read_b128 v[248:251],v17 offset:13312
s_waitcnt lgkmcnt(5)
v_mfma_f32_16x16x32_bf16 v[68:71],a[0:3],v[224:227],0
v_cmp_eq_u32 vcc,0,v27
s_cbranch_vccnz retry_222
v_mfma_f32_16x16x32_bf16 v[76:79],a[128:131],v[224:227],0
ds_read_b128 v[252:255],v43 offset:13312
v_min3_u32 v27,v27,v224,v228
v_mfma_f32_16x16x32_bf16 v[68:71],a[4:7],v[228:231],v[68:71]
v_mfma_f32_16x16x32_bf16 v[76:79],a[132:135],v[228:231],v[76:79]
ds_read_b128 v[224:227],v17 offset:20480
s_waitcnt lgkmcnt(5)
v_mfma_f32_16x16x32_bf16 v[68:71],a[8:11],v[232:235],v[68:71]
v_min3_u32 v27,v27,v232,v236
v_mul_f32 v88,v64,v64
v_mul_f32 v92,v72,v72
v_mfma_f32_16x16x32_bf16 v[76:79],a[136:139],v[232:235],v[76:79]
ds_read_b128 v[228:231],v43 offset:20480
v_mul_f32 v89,v65,v65
v_mul_f32 v93,v73,v73
v_mfma_f32_16x16x32_bf16 v[68:71],a[12:15],v[236:239],v[68:71]
v_mul_f32 v90,v66,v66
v_mul_f32 v91,v67,v67
v_mul_f32 v94,v74,v74
v_mfma_f32_16x16x32_bf16 v[76:79],a[140:143],v[236:239],v[76:79]
ds_read_b128 v[232:235],v17 offset:28672
v_mul_f32 v95,v75,v75
s_waitcnt lgkmcnt(5)
v_mfma_f32_16x16x32_bf16 v[68:71],a[64:67],v[240:243],v[68:71]
v_min3_u32 v27,v27,v240,v244
v_fma_f32 v88,v88,s81,v28
v_fma_f32 v92,v92,s81,v28
v_mfma_f32_16x16x32_bf16 v[76:79],a[192:195],v[240:243],v[76:79]
ds_read_b128 v[236:239],v43 offset:28672
v_fma_f32 v89,v89,s81,v28
v_fma_f32 v93,v93,s81,v28
v_mfma_f32_16x16x32_bf16 v[68:71],a[68:71],v[244:247],v[68:71]
v_fma_f32 v90,v90,s81,v28
v_fma_f32 v91,v91,s81,v28
v_fma_f32 v94,v94,s81,v28
v_mfma_f32_16x16x32_bf16 v[76:79],a[196:199],v[244:247],v[76:79]
ds_read_b128 v[240:243],v17 offset:21504
v_fma_f32 v95,v95,s81,v28
s_waitcnt lgkmcnt(5)
v_mfma_f32_16x16x32_bf16 v[68:71],a[72:75],v[248:251],v[68:71]
v_min3_u32 v27,v27,v248,v252
v_mul_f32 v88,v88,v64
v_mul_f32 v92,v92,v72
v_mfma_f32_16x16x32_bf16 v[76:79],a[200:203],v[248:251],v[76:79]
ds_read_b128 v[244:247],v43 offset:21504
v_mul_f32 v89,v89,v65
v_mul_f32 v93,v93,v73
v_mfma_f32_16x16x32_bf16 v[68:71],a[76:79],v[252:255],v[68:71]
v_mul_f32 v90,v90,v66
v_mul_f32 v91,v91,v67
v_mul_f32 v94,v94,v74
v_mfma_f32_16x16x32_bf16 v[76:79],a[204:207],v[252:255],v[76:79]
ds_read_b128 v[248:251],v17 offset:29696
v_mul_f32 v95,v95,v75
s_waitcnt lgkmcnt(5)
v_mfma_f32_16x16x32_bf16 v[68:71],a[16:19],v[224:227],v[68:71]
v_min3_u32 v27,v27,v224,v228
v_exp_f32 v92,v92
v_mfma_f32_16x16x32_bf16 v[76:79],a[144:147],v[224:227],v[76:79]
ds_read_b128 v[252:255],v43 offset:29696
v_exp_f32 v93,v93
v_mfma_f32_16x16x32_bf16 v[68:71],a[20:23],v[228:231],v[68:71]
v_exp_f32 v88,v88
v_mfma_f32_16x16x32_bf16 v[76:79],a[148:151],v[228:231],v[76:79]
ds_read_b128 v[224:227],v17 offset:36864
s_waitcnt lgkmcnt(5)
v_mfma_f32_16x16x32_bf16 v[68:71],a[24:27],v[232:235],v[68:71]
v_min3_u32 v27,v27,v232,v236
v_exp_f32 v94,v94
v_mfma_f32_16x16x32_bf16 v[76:79],a[152:155],v[232:235],v[76:79]
ds_read_b128 v[228:231],v43 offset:36864
v_exp_f32 v95,v95
v_mfma_f32_16x16x32_bf16 v[68:71],a[28:31],v[236:239],v[68:71]
v_exp_f32 v89,v89
v_add_f32 v92,1.0,v92
v_mfma_f32_16x16x32_bf16 v[76:79],a[156:159],v[236:239],v[76:79]
ds_read_b128 v[232:235],v17 offset:45056
v_add_f32 v93,1.0,v93
s_waitcnt lgkmcnt(5)
v_mfma_f32_16x16x32_bf16 v[68:71],a[80:83],v[240:243],v[68:71]
v_min3_u32 v27,v27,v240,v244
v_add_f32 v94,1.0,v94
v_add_f32 v95,1.0,v95
v_mfma_f32_16x16x32_bf16 v[76:79],a[208:211],v[240:243],v[76:79]
ds_read_b128 v[236:239],v43 offset:45056
v_rcp_f32 v92,v92
v_mfma_f32_16x16x32_bf16 v[68:71],a[84:87],v[244:247],v[68:71]
v_exp_f32 v90,v90
v_mfma_f32_16x16x32_bf16 v[76:79],a[212:215],v[244:247],v[76:79]
ds_read_b128 v[240:243],v17 offset:37888
s_waitcnt lgkmcnt(5)
v_mfma_f32_16x16x32_bf16 v[68:71],a[88:91],v[248:251],v[68:71]
v_min3_u32 v27,v27,v248,v252
v_rcp_f32 v93,v93
v_mfma_f32_16x16x32_bf16 v[76:79],a[216:219],v[248:251],v[76:79]
ds_read_b128 v[244:247],v43 offset:37888
v_rcp_f32 v94,v94
v_mfma_f32_16x16x32_bf16 v[68:71],a[92:95],v[252:255],v[68:71]
v_exp_f32 v91,v91
v_mfma_f32_16x16x32_bf16 v[76:79],a[220:223],v[252:255],v[76:79]
ds_read_b128 v[248:251],v17 offset:46080
s_waitcnt lgkmcnt(5)
v_mfma_f32_16x16x32_bf16 v[68:71],a[32:35],v[224:227],v[68:71]
v_min3_u32 v27,v27,v224,v228
v_add_f32 v88,1.0,v88
v_mfma_f32_16x16x32_bf16 v[76:79],a[160:163],v[224:227],v[76:79]
ds_read_b128 v[252:255],v43 offset:46080
v_add_f32 v89,1.0,v89
v_mfma_f32_16x16x32_bf16 v[68:71],a[36:39],v[228:231],v[68:71]
v_add_f32 v90,1.0,v90
v_add_f32 v91,1.0,v91
v_mfma_f32_16x16x32_bf16 v[76:79],a[164:167],v[228:231],v[76:79]
ds_read_b128 v[224:227],v17 offset:53248
s_waitcnt lgkmcnt(5)
v_mfma_f32_16x16x32_bf16 v[68:71],a[40:43],v[232:235],v[68:71]
v_min3_u32 v27,v27,v232,v236
v_mfma_f32_16x16x32_bf16 v[76:79],a[168:171],v[232:235],v[76:79]
ds_read_b128 v[228:231],v43 offset:53248
v_mfma_f32_16x16x32_bf16 v[68:71],a[44:47],v[236:239],v[68:71]
v_rcp_f32 v88,v88
v_mfma_f32_16x16x32_bf16 v[76:79],a[172:175],v[236:239],v[76:79]
ds_read_b128 v[232:235],v17 offset:61440
s_waitcnt lgkmcnt(5)
v_mfma_f32_16x16x32_bf16 v[68:71],a[96:99],v[240:243],v[68:71]
v_min3_u32 v27,v27,v240,v244
v_mfma_f32_16x16x32_bf16 v[76:79],a[224:227],v[240:243],v[76:79]
ds_read_b128 v[236:239],v43 offset:61440
v_mfma_f32_16x16x32_bf16 v[68:71],a[100:103],v[244:247],v[68:71]
v_rcp_f32 v89,v89
v_mfma_f32_16x16x32_bf16 v[76:79],a[228:231],v[244:247],v[76:79]
ds_read_b128 v[240:243],v17 offset:54272
s_waitcnt lgkmcnt(5)
v_mfma_f32_16x16x32_bf16 v[68:71],a[104:107],v[248:251],v[68:71]
v_min3_u32 v27,v27,v248,v252
v_mfma_f32_16x16x32_bf16 v[76:79],a[232:235],v[248:251],v[76:79]
ds_read_b128 v[244:247],v43 offset:54272
v_mfma_f32_16x16x32_bf16 v[68:71],a[108:111],v[252:255],v[68:71]
v_rcp_f32 v90,v90
v_mfma_f32_16x16x32_bf16 v[76:79],a[236:239],v[252:255],v[76:79]
ds_read_b128 v[248:251],v17 offset:62464
s_waitcnt lgkmcnt(5)
v_mfma_f32_16x16x32_bf16 v[68:71],a[48:51],v[224:227],v[68:71]
v_min3_u32 v27,v27,v224,v228
v_mfma_f32_16x16x32_bf16 v[76:79],a[176:179],v[224:227],v[76:79]
ds_read_b128 v[252:255],v43 offset:62464
v_mfma_f32_16x16x32_bf16 v[68:71],a[52:55],v[228:231],v[68:71]
v_rcp_f32 v91,v91
v_mfma_f32_16x16x32_bf16 v[76:79],a[180:183],v[228:231],v[76:79]
v_mul_f32 v88,v88,v64
s_waitcnt lgkmcnt(4)
v_mfma_f32_16x16x32_bf16 v[68:71],a[56:59],v[232:235],v[68:71]
v_min3_u32 v27,v27,v232,v236
v_mul_f32 v89,v89,v65
v_mfma_f32_16x16x32_bf16 v[76:79],a[184:187],v[232:235],v[76:79]
v_mul_f32 v90,v90,v66
v_mul_f32 v91,v91,v67
v_mfma_f32_16x16x32_bf16 v[68:71],a[60:63],v[236:239],v[68:71]
v_rcp_f32 v95,v95
v_mfma_f32_16x16x32_bf16 v[76:79],a[188:191],v[236:239],v[76:79]
v_mul_f32 v92,v92,v72
s_waitcnt lgkmcnt(2)
v_mfma_f32_16x16x32_bf16 v[68:71],a[112:115],v[240:243],v[68:71]
v_min3_u32 v27,v27,v240,v244
v_mul_f32 v93,v93,v73
v_mfma_f32_16x16x32_bf16 v[76:79],a[240:243],v[240:243],v[76:79]
v_mul_f32 v94,v94,v74
v_mul_f32 v95,v95,v75
v_mfma_f32_16x16x32_bf16 v[68:71],a[116:119],v[244:247],v[68:71]
v_cvt_pk_bf16_f32 v96,v88,v89
v_cvt_pk_bf16_f32 v97,v90,v91
v_mfma_f32_16x16x32_bf16 v[76:79],a[244:247],v[244:247],v[76:79]
v_cvt_pk_bf16_f32 v98,v92,v93
s_waitcnt lgkmcnt(0)
v_mfma_f32_16x16x32_bf16 v[68:71],a[120:123],v[248:251],v[68:71]
v_min3_u32 v27,v27,v248,v252
v_cvt_pk_bf16_f32 v99,v94,v95
v_mfma_f32_16x16x32_bf16 v[76:79],a[248:251],v[248:251],v[76:79]
v_max_u32 v96,1,v96
v_mfma_f32_16x16x32_bf16 v[68:71],a[124:127],v[252:255],v[68:71]
buffer_store_dwordx4 v[96:99],v18,s[20:23],s78 offen sc1
v_mfma_f32_16x16x32_bf16 v[76:79],a[252:255],v[252:255],v[76:79]
v_cmp_eq_u32 vcc,0,v27
s_cbranch_vccnz retry_222
epi_225:
buffer_load_dword v29,v21,s[20:23],s87 offen sc1
s_cmp_gt_u32 s71,51
s_cselect_b32 s65,s73,0x7fff0000
s_cselect_b32 s97,0x7fff0000,s73
v_mov_b32 v22,s71
buffer_store_dword v22,v23,s[24:27],s65 offen
buffer_store_dword v22,v23,s[28:31],s65 offen sc1
v_pk_mul_f32 v[88:89],v[68:69],v[68:69]
v_pk_mul_f32 v[90:91],v[70:71],v[70:71]
v_pk_mul_f32 v[92:93],v[76:77],v[76:77]
v_pk_mul_f32 v[94:95],v[78:79],v[78:79]
v_pk_fma_f32 v[88:89],v[88:89],s[80:81],v[28:29] op_sel:[0,1,0] op_sel_hi:[1,1,0]
v_pk_fma_f32 v[90:91],v[90:91],s[80:81],v[28:29] op_sel:[0,1,0] op_sel_hi:[1,1,0]
v_pk_fma_f32 v[92:93],v[92:93],s[80:81],v[28:29] op_sel:[0,1,0] op_sel_hi:[1,1,0]
v_pk_fma_f32 v[94:95],v[94:95],s[80:81],v[28:29] op_sel:[0,1,0] op_sel_hi:[1,1,0]
v_pk_mul_f32 v[88:89],v[88:89],v[68:69]
v_pk_mul_f32 v[90:91],v[90:91],v[70:71]
v_pk_mul_f32 v[92:93],v[92:93],v[76:77]
v_pk_mul_f32 v[94:95],v[94:95],v[78:79]
v_exp_f32 v88,v88
v_exp_f32 v89,v89
v_exp_f32 v90,v90
v_exp_f32 v91,v91
v_exp_f32 v92,v92
v_exp_f32 v93,v93
v_exp_f32 v94,v94
v_exp_f32 v95,v95
v_pk_add_f32 v[88:89],v[88:89],1.0 op_sel_hi:[1,0]
v_pk_add_f32 v[90:91],v[90:91],1.0 op_sel_hi:[1,0]
v_pk_add_f32 v[92:93],v[92:93],1.0 op_sel_hi:[1,0]
v_pk_add_f32 v[94:95],v[94:95],1.0 op_sel_hi:[1,0]
v_rcp_f32 v88,v88
v_rcp_f32 v89,v89
v_rcp_f32 v90,v90
v_rcp_f32 v91,v91
v_rcp_f32 v92,v92
v_rcp_f32 v93,v93
v_rcp_f32 v94,v94
v_rcp_f32 v95,v95
v_pk_mul_f32 v[88:89],v[88:89],v[68:69]
v_pk_mul_f32 v[90:91],v[90:91],v[70:71]
v_pk_mul_f32 v[92:93],v[92:93],v[76:77]
v_pk_mul_f32 v[94:95],v[94:95],v[78:79]
v_cvt_pk_bf16_f32 v96,v88,v89
v_cvt_pk_bf16_f32 v97,v90,v91
v_cvt_pk_bf16_f32 v98,v92,v93
v_cvt_pk_bf16_f32 v99,v94,v95
v_max_u32 v96,1,v96
buffer_store_dwordx4 v[96:99],v19,s[20:23],s78 offen sc1
v_xor_b32 v18,0x2000,v18
v_xor_b32 v19,0x2000,v19
s_add_u32 s78,s78,2097152
v_xor_b32 v43,0x10000,v43
v_xor_b32 v17,0x10000,v17
s_xor_b32 s72,s72,0x10000
s_add_u32 s70,s70,2097152
s_xor_b32 s70,s70,0x2000
s_add_u32 s71,s71,1
s_cmp_le_u32 s71,64
s_cbranch_scc1 seg_223
s_add_u32 s65,s73,2560
v_add_u32 v22,s71,-1
buffer_store_dword v22,v23,s[20:23],s65 offen sc1
s_endpgm
retry_222:
s_sub_u32 s90,s90,64
s_cmp_lt_i32 s90,0
s_cbranch_scc1 giveup_197
s_mov_b32 s83,1
s_waitcnt vmcnt(0) lgkmcnt(0)
s_barrier
s_branch seg_223
r_w2_217:
s_load_dwordx2 s[4:5],s[0:1],72
s_and_b32 s41,s59,7
s_lshl_b32 s66,s41,8
s_lshl_b32 s67,s50,1
s_waitcnt lgkmcnt(0)
s_mov_b32 s32,s4
s_and_b32 s33,s5,0xffff
s_mov_b32 s34,0x200000
s_mov_b32 s35,0x20000
v_lshrrev_b32 v5,2,v3
v_lshl_add_u32 v5,v4,2,v5
v_and_b32 v6,3,v3
v_lshlrev_b32 v6,3,v6
v_lshl_add_u32 v6,v5,8,v6
v_and_b32 v5,7,v5
v_xor_b32 v5,s67,v5
v_lshl_add_u32 v12,v5,5,v6
v_xor_b32 v13,32,v12
v_and_b32 v5,15,v1
v_and_b32 v6,3,v4
v_lshlrev_b32 v6,1,v6
v_xor_b32 v5,v5,v6
v_mul_u32_u24 v6,2048,v4
v_xor_b32 v7,0,v5
v_lshl_add_u32 v8,v7,4,v6
v_xor_b32 v7,8,v5
v_lshl_add_u32 v9,v7,4,v6
s_mul_i32 s74,s50,131072
s_add_u32 s74,s74,s66
s_lshl_b32 s75,s50,14
s_mul_i32 s76,s50,65536
s_add_u32 s76,s76,s66
s_lshl_b32 s77,s50,13
s_add_u32 s64,s74,0
s_add_u32 m0,s75,0
s_nop 0
buffer_load_dwordx4 v8,s[32:35],s64 offen nt lds
s_add_u32 s64,s74,8192
s_add_u32 m0,s75,1024
s_nop 0
buffer_load_dwordx4 v9,s[32:35],s64 offen nt lds
s_add_u32 s64,s74,16384
s_add_u32 m0,s75,2048
s_nop 0
buffer_load_dwordx4 v8,s[32:35],s64 offen nt lds
s_add_u32 s64,s74,24576
s_add_u32 m0,s75,3072
s_nop 0
buffer_load_dwordx4 v9,s[32:35],s64 offen nt lds
s_add_u32 s64,s74,32768
s_add_u32 m0,s75,4096
s_nop 0
buffer_load_dwordx4 v8,s[32:35],s64 offen nt lds
s_add_u32 s64,s74,40960
s_add_u32 m0,s75,5120
s_nop 0
buffer_load_dwordx4 v9,s[32:35],s64 offen nt lds
s_add_u32 s64,s74,49152
s_add_u32 m0,s75,6144
s_nop 0
buffer_load_dwordx4 v8,s[32:35],s64 offen nt lds
s_add_u32 s64,s74,57344
s_add_u32 m0,s75,7168
s_nop 0
buffer_load_dwordx4 v9,s[32:35],s64 offen nt lds
s_add_u32 s64,s74,65536
s_add_u32 m0,s75,8192
s_nop 0
buffer_load_dwordx4 v8,s[32:35],s64 offen nt lds
s_add_u32 s64,s74,73728
s_add_u32 m0,s75,9216
s_nop 0
buffer_load_dwordx4 v9,s[32:35],s64 offen nt lds
s_add_u32 s64,s74,81920
s_add_u32 m0,s75,10240
s_nop 0
buffer_load_dwordx4 v8,s[32:35],s64 offen nt lds
s_add_u32 s64,s74,90112
s_add_u32 m0,s75,11264
s_nop 0
buffer_load_dwordx4 v9,s[32:35],s64 offen nt lds
s_add_u32 s64,s74,98304
s_add_u32 m0,s75,12288
s_nop 0
buffer_load_dwordx4 v8,s[32:35],s64 offen nt lds
s_add_u32 s64,s74,106496
s_add_u32 m0,s75,13312
s_nop 0
buffer_load_dwordx4 v9,s[32:35],s64 offen nt lds
s_add_u32 s64,s74,114688
s_add_u32 m0,s75,14336
s_nop 0
buffer_load_dwordx4 v8,s[32:35],s64 offen nt lds
s_add_u32 s64,s74,122880
s_add_u32 m0,s75,15360
s_nop 0
buffer_load_dwordx4 v9,s[32:35],s64 offen nt lds
s_add_u32 s64,s74,524288
s_add_u32 m0,s75,65536
s_nop 0
buffer_load_dwordx4 v8,s[32:35],s64 offen nt lds
s_add_u32 s64,s74,532480
s_add_u32 m0,s75,66560
s_nop 0
buffer_load_dwordx4 v9,s[32:35],s64 offen nt lds
s_add_u32 s64,s74,540672
s_add_u32 m0,s75,67584
s_nop 0
buffer_load_dwordx4 v8,s[32:35],s64 offen nt lds
s_add_u32 s64,s74,548864
s_add_u32 m0,s75,68608
s_nop 0
buffer_load_dwordx4 v9,s[32:35],s64 offen nt lds
s_add_u32 s64,s74,557056
s_add_u32 m0,s75,69632
s_nop 0
buffer_load_dwordx4 v8,s[32:35],s64 offen nt lds
s_add_u32 s64,s74,565248
s_add_u32 m0,s75,70656
s_nop 0
buffer_load_dwordx4 v9,s[32:35],s64 offen nt lds
s_add_u32 s64,s74,573440
s_add_u32 m0,s75,71680
s_nop 0
buffer_load_dwordx4 v8,s[32:35],s64 offen nt lds
s_add_u32 s64,s74,581632
s_add_u32 m0,s75,72704
s_nop 0
buffer_load_dwordx4 v9,s[32:35],s64 offen nt lds
s_add_u32 s64,s74,589824
s_add_u32 m0,s75,73728
s_nop 0
buffer_load_dwordx4 v8,s[32:35],s64 offen nt lds
s_add_u32 s64,s74,598016
s_add_u32 m0,s75,74752
s_nop 0
buffer_load_dwordx4 v9,s[32:35],s64 offen nt lds
s_add_u32 s64,s74,606208
s_add_u32 m0,s75,75776
s_nop 0
buffer_load_dwordx4 v8,s[32:35],s64 offen nt lds
s_add_u32 s64,s74,614400
s_add_u32 m0,s75,76800
s_nop 0
buffer_load_dwordx4 v9,s[32:35],s64 offen nt lds
s_add_u32 s64,s74,622592
s_add_u32 m0,s75,77824
s_nop 0
buffer_load_dwordx4 v8,s[32:35],s64 offen nt lds
s_add_u32 s64,s74,630784
s_add_u32 m0,s75,78848
s_nop 0
buffer_load_dwordx4 v9,s[32:35],s64 offen nt lds
s_add_u32 s64,s74,638976
s_add_u32 m0,s75,79872
s_nop 0
buffer_load_dwordx4 v8,s[32:35],s64 offen nt lds
s_add_u32 s64,s74,647168
s_add_u32 m0,s75,80896
s_nop 0
buffer_load_dwordx4 v9,s[32:35],s64 offen nt lds
s_waitcnt vmcnt(16)
s_barrier
ds_read_b64_tr_b16 a[0:1],v12 offset:0
ds_read_b64_tr_b16 a[128:129],v13 offset:0
ds_read_b64_tr_b16 a[2:3],v12 offset:4096
ds_read_b64_tr_b16 a[130:131],v13 offset:4096
ds_read_b64_tr_b16 a[4:5],v12 offset:8192
ds_read_b64_tr_b16 a[132:133],v13 offset:8192
ds_read_b64_tr_b16 a[6:7],v12 offset:12288
ds_read_b64_tr_b16 a[134:135],v13 offset:12288
s_waitcnt lgkmcnt(4)
ds_read_b64_tr_b16 a[8:9],v12 offset:16384
ds_read_b64_tr_b16 a[136:137],v13 offset:16384
ds_read_b64_tr_b16 a[10:11],v12 offset:20480
ds_read_b64_tr_b16 a[138:139],v13 offset:20480
ds_read_b64_tr_b16 a[12:13],v12 offset:24576
ds_read_b64_tr_b16 a[140:141],v13 offset:24576
ds_read_b64_tr_b16 a[14:15],v12 offset:28672
ds_read_b64_tr_b16 a[142:143],v13 offset:28672
s_waitcnt lgkmcnt(4)
ds_read_b64_tr_b16 a[16:17],v12 offset:32768
ds_read_b64_tr_b16 a[144:145],v13 offset:32768
ds_read_b64_tr_b16 a[18:19],v12 offset:36864
ds_read_b64_tr_b16 a[146:147],v13 offset:36864
ds_read_b64_tr_b16 a[20:21],v12 offset:40960
ds_read_b64_tr_b16 a[148:149],v13 offset:40960
ds_read_b64_tr_b16 a[22:23],v12 offset:45056
ds_read_b64_tr_b16 a[150:151],v13 offset:45056
s_waitcnt lgkmcnt(4)
ds_read_b64_tr_b16 a[24:25],v12 offset:49152
ds_read_b64_tr_b16 a[152:153],v13 offset:49152
ds_read_b64_tr_b16 a[26:27],v12 offset:53248
ds_read_b64_tr_b16 a[154:155],v13 offset:53248
ds_read_b64_tr_b16 a[28:29],v12 offset:57344
ds_read_b64_tr_b16 a[156:157],v13 offset:57344
ds_read_b64_tr_b16 a[30:31],v12 offset:61440
ds_read_b64_tr_b16 a[158:159],v13 offset:61440
s_waitcnt lgkmcnt(4)
v_xor_b32 v12,0x10000,v12
v_xor_b32 v13,0x10000,v13
s_waitcnt lgkmcnt(0)
s_barrier
s_add_u32 s64,s74,1048576
s_add_u32 m0,s75,0
s_nop 0
buffer_load_dwordx4 v8,s[32:35],s64 offen nt lds
s_add_u32 s64,s74,1056768
s_add_u32 m0,s75,1024
s_nop 0
buffer_load_dwordx4 v9,s[32:35],s64 offen nt lds
s_add_u32 s64,s74,1064960
s_add_u32 m0,s75,2048
s_nop 0
buffer_load_dwordx4 v8,s[32:35],s64 offen nt lds
s_add_u32 s64,s74,1073152
s_add_u32 m0,s75,3072
s_nop 0
buffer_load_dwordx4 v9,s[32:35],s64 offen nt lds
s_add_u32 s64,s74,1081344
s_add_u32 m0,s75,4096
s_nop 0
buffer_load_dwordx4 v8,s[32:35],s64 offen nt lds
s_add_u32 s64,s74,1089536
s_add_u32 m0,s75,5120
s_nop 0
buffer_load_dwordx4 v9,s[32:35],s64 offen nt lds
s_add_u32 s64,s74,1097728
s_add_u32 m0,s75,6144
s_nop 0
buffer_load_dwordx4 v8,s[32:35],s64 offen nt lds
s_add_u32 s64,s74,1105920
s_add_u32 m0,s75,7168
s_nop 0
buffer_load_dwordx4 v9,s[32:35],s64 offen nt lds
s_add_u32 s64,s74,1114112
s_add_u32 m0,s75,8192
s_nop 0
buffer_load_dwordx4 v8,s[32:35],s64 offen nt lds
s_add_u32 s64,s74,1122304
s_add_u32 m0,s75,9216
s_nop 0
buffer_load_dwordx4 v9,s[32:35],s64 offen nt lds
s_add_u32 s64,s74,1130496
s_add_u32 m0,s75,10240
s_nop 0
buffer_load_dwordx4 v8,s[32:35],s64 offen nt lds
s_add_u32 s64,s74,1138688
s_add_u32 m0,s75,11264
s_nop 0
buffer_load_dwordx4 v9,s[32:35],s64 offen nt lds
s_add_u32 s64,s74,1146880
s_add_u32 m0,s75,12288
s_nop 0
buffer_load_dwordx4 v8,s[32:35],s64 offen nt lds
s_add_u32 s64,s74,1155072
s_add_u32 m0,s75,13312
s_nop 0
buffer_load_dwordx4 v9,s[32:35],s64 offen nt lds
s_add_u32 s64,s74,1163264
s_add_u32 m0,s75,14336
s_nop 0
buffer_load_dwordx4 v8,s[32:35],s64 offen nt lds
s_add_u32 s64,s74,1171456
s_add_u32 m0,s75,15360
s_nop 0
buffer_load_dwordx4 v9,s[32:35],s64 offen nt lds
s_waitcnt vmcnt(16)
s_barrier
ds_read_b64_tr_b16 a[32:33],v12 offset:0
ds_read_b64_tr_b16 a[160:161],v13 offset:0
ds_read_b64_tr_b16 a[34:35],v12 offset:4096
ds_read_b64_tr_b16 a[162:163],v13 offset:4096
ds_read_b64_tr_b16 a[36:37],v12 offset:8192
ds_read_b64_tr_b16 a[164:165],v13 offset:8192
ds_read_b64_tr_b16 a[38:39],v12 offset:12288
ds_read_b64_tr_b16 a[166:167],v13 offset:12288
s_waitcnt lgkmcnt(4)
ds_read_b64_tr_b16 a[40:41],v12 offset:16384
ds_read_b64_tr_b16 a[168:169],v13 offset:16384
ds_read_b64_tr_b16 a[42:43],v12 offset:20480
ds_read_b64_tr_b16 a[170:171],v13 offset:20480
ds_read_b64_tr_b16 a[44:45],v12 offset:24576
ds_read_b64_tr_b16 a[172:173],v13 offset:24576
ds_read_b64_tr_b16 a[46:47],v12 offset:28672
ds_read_b64_tr_b16 a[174:175],v13 offset:28672
s_waitcnt lgkmcnt(4)
ds_read_b64_tr_b16 a[48:49],v12 offset:32768
ds_read_b64_tr_b16 a[176:177],v13 offset:32768
ds_read_b64_tr_b16 a[50:51],v12 offset:36864
ds_read_b64_tr_b16 a[178:179],v13 offset:36864
ds_read_b64_tr_b16 a[52:53],v12 offset:40960
ds_read_b64_tr_b16 a[180:181],v13 offset:40960
ds_read_b64_tr_b16 a[54:55],v12 offset:45056
ds_read_b64_tr_b16 a[182:183],v13 offset:45056
s_waitcnt lgkmcnt(4)
ds_read_b64_tr_b16 a[56:57],v12 offset:49152
ds_read_b64_tr_b16 a[184:185],v13 offset:49152
ds_read_b64_tr_b16 a[58:59],v12 offset:53248
ds_read_b64_tr_b16 a[186:187],v13 offset:53248
ds_read_b64_tr_b16 a[60:61],v12 offset:57344
ds_read_b64_tr_b16 a[188:189],v13 offset:57344
ds_read_b64_tr_b16 a[62:63],v12 offset:61440
ds_read_b64_tr_b16 a[190:191],v13 offset:61440
s_waitcnt lgkmcnt(4)
v_xor_b32 v12,0x10000,v12
v_xor_b32 v13,0x10000,v13
s_waitcnt lgkmcnt(0)
s_barrier
s_add_u32 s64,s74,1572864
s_add_u32 m0,s75,65536
s_nop 0
buffer_load_dwordx4 v8,s[32:35],s64 offen nt lds
s_add_u32 s64,s74,1581056
s_add_u32 m0,s75,66560
s_nop 0
buffer_load_dwordx4 v9,s[32:35],s64 offen nt lds
s_add_u32 s64,s74,1589248
s_add_u32 m0,s75,67584
s_nop 0
buffer_load_dwordx4 v8,s[32:35],s64 offen nt lds
s_add_u32 s64,s74,1597440
s_add_u32 m0,s75,68608
s_nop 0
buffer_load_dwordx4 v9,s[32:35],s64 offen nt lds
s_add_u32 s64,s74,1605632
s_add_u32 m0,s75,69632
s_nop 0
buffer_load_dwordx4 v8,s[32:35],s64 offen nt lds
s_add_u32 s64,s74,1613824
s_add_u32 m0,s75,70656
s_nop 0
buffer_load_dwordx4 v9,s[32:35],s64 offen nt lds
s_add_u32 s64,s74,1622016
s_add_u32 m0,s75,71680
s_nop 0
buffer_load_dwordx4 v8,s[32:35],s64 offen nt lds
s_add_u32 s64,s74,1630208
s_add_u32 m0,s75,72704
s_nop 0
buffer_load_dwordx4 v9,s[32:35],s64 offen nt lds
s_add_u32 s64,s74,1638400
s_add_u32 m0,s75,73728
s_nop 0
buffer_load_dwordx4 v8,s[32:35],s64 offen nt lds
s_add_u32 s64,s74,1646592
s_add_u32 m0,s75,74752
s_nop 0
buffer_load_dwordx4 v9,s[32:35],s64 offen nt lds
s_add_u32 s64,s74,1654784
s_add_u32 m0,s75,75776
s_nop 0
buffer_load_dwordx4 v8,s[32:35],s64 offen nt lds
s_add_u32 s64,s74,1662976
s_add_u32 m0,s75,76800
s_nop 0
buffer_load_dwordx4 v9,s[32:35],s64 offen nt lds
s_add_u32 s64,s74,1671168
s_add_u32 m0,s75,77824
s_nop 0
buffer_load_dwordx4 v8,s[32:35],s64 offen nt lds
s_add_u32 s64,s74,1679360
s_add_u32 m0,s75,78848
s_nop 0
buffer_load_dwordx4 v9,s[32:35],s64 offen nt lds
s_add_u32 s64,s74,1687552
s_add_u32 m0,s75,79872
s_nop 0
buffer_load_dwordx4 v8,s[32:35],s64 offen nt lds
s_add_u32 s64,s74,1695744
s_add_u32 m0,s75,80896
s_nop 0
buffer_load_dwordx4 v9,s[32:35],s64 offen nt lds
s_waitcnt vmcnt(16)
s_barrier
ds_read_b64_tr_b16 a[64:65],v12 offset:0
ds_read_b64_tr_b16 a[192:193],v13 offset:0
ds_read_b64_tr_b16 a[66:67],v12 offset:4096
ds_read_b64_tr_b16 a[194:195],v13 offset:4096
ds_read_b64_tr_b16 a[68:69],v12 offset:8192
ds_read_b64_tr_b16 a[196:197],v13 offset:8192
ds_read_b64_tr_b16 a[70:71],v12 offset:12288
ds_read_b64_tr_b16 a[198:199],v13 offset:12288
s_waitcnt lgkmcnt(4)
ds_read_b64_tr_b16 a[72:73],v12 offset:16384
ds_read_b64_tr_b16 a[200:201],v13 offset:16384
ds_read_b64_tr_b16 a[74:75],v12 offset:20480
ds_read_b64_tr_b16 a[202:203],v13 offset:20480
ds_read_b64_tr_b16 a[76:77],v12 offset:24576
ds_read_b64_tr_b16 a[204:205],v13 offset:24576
ds_read_b64_tr_b16 a[78:79],v12 offset:28672
ds_read_b64_tr_b16 a[206:207],v13 offset:28672
s_waitcnt lgkmcnt(4)
ds_read_b64_tr_b16 a[80:81],v12 offset:32768
ds_read_b64_tr_b16 a[208:209],v13 offset:32768
ds_read_b64_tr_b16 a[82:83],v12 offset:36864
ds_read_b64_tr_b16 a[210:211],v13 offset:36864
ds_read_b64_tr_b16 a[84:85],v12 offset:40960
ds_read_b64_tr_b16 a[212:213],v13 offset:40960
ds_read_b64_tr_b16 a[86:87],v12 offset:45056
ds_read_b64_tr_b16 a[214:215],v13 offset:45056
s_waitcnt lgkmcnt(4)
ds_read_b64_tr_b16 a[88:89],v12 offset:49152
ds_read_b64_tr_b16 a[216:217],v13 offset:49152
ds_read_b64_tr_b16 a[90:91],v12 offset:53248
ds_read_b64_tr_b16 a[218:219],v13 offset:53248
ds_read_b64_tr_b16 a[92:93],v12 offset:57344
ds_read_b64_tr_b16 a[220:221],v13 offset:57344
ds_read_b64_tr_b16 a[94:95],v12 offset:61440
ds_read_b64_tr_b16 a[222:223],v13 offset:61440
s_waitcnt lgkmcnt(4)
v_xor_b32 v12,0x10000,v12
v_xor_b32 v13,0x10000,v13
s_waitcnt lgkmcnt(0)
s_barrier
s_waitcnt vmcnt(0)
s_barrier
ds_read_b64_tr_b16 a[96:97],v12 offset:0
ds_read_b64_tr_b16 a[224:225],v13 offset:0
ds_read_b64_tr_b16 a[98:99],v12 offset:4096
ds_read_b64_tr_b16 a[226:227],v13 offset:4096
ds_read_b64_tr_b16 a[100:101],v12 offset:8192
ds_read_b64_tr_b16 a[228:229],v13 offset:8192
ds_read_b64_tr_b16 a[102:103],v12 offset:12288
ds_read_b64_tr_b16 a[230:231],v13 offset:12288
s_waitcnt lgkmcnt(4)
ds_read_b64_tr_b16 a[104:105],v12 offset:16384
ds_read_b64_tr_b16 a[232:233],v13 offset:16384
ds_read_b64_tr_b16 a[106:107],v12 offset:20480
ds_read_b64_tr_b16 a[234:235],v13 offset:20480
ds_read_b64_tr_b16 a[108:109],v12 offset:24576
ds_read_b64_tr_b16 a[236:237],v13 offset:24576
ds_read_b64_tr_b16 a[110:111],v12 offset:28672
ds_read_b64_tr_b16 a[238:239],v13 offset:28672
s_waitcnt lgkmcnt(4)
ds_read_b64_tr_b16 a[112:113],v12 offset:32768
ds_read_b64_tr_b16 a[240:241],v13 offset:32768
ds_read_b64_tr_b16 a[114:115],v12 offset:36864
ds_read_b64_tr_b16 a[242:243],v13 offset:36864
ds_read_b64_tr_b16 a[116:117],v12 offset:40960
ds_read_b64_tr_b16 a[244:245],v13 offset:40960
ds_read_b64_tr_b16 a[118:119],v12 offset:45056
ds_read_b64_tr_b16 a[246:247],v13 offset:45056
s_waitcnt lgkmcnt(4)
ds_read_b64_tr_b16 a[120:121],v12 offset:49152
ds_read_b64_tr_b16 a[248:249],v13 offset:49152
ds_read_b64_tr_b16 a[122:123],v12 offset:53248
ds_read_b64_tr_b16 a[250:251],v13 offset:53248
ds_read_b64_tr_b16 a[124:125],v12 offset:57344
ds_read_b64_tr_b16 a[252:253],v13 offset:57344
ds_read_b64_tr_b16 a[126:127],v12 offset:61440
ds_read_b64_tr_b16 a[254:255],v13 offset:61440
s_waitcnt lgkmcnt(4)
v_xor_b32 v12,0x10000,v12
v_xor_b32 v13,0x10000,v13
s_waitcnt lgkmcnt(0)
s_barrier
v_and_b32 v21,1,v1
v_mul_u32_u24 v21,960,v21
s_mov_b32 s65,21052032
s_mov_b32 s66,1792
pl_234:
buffer_load_dword v22,v21,s[20:23],s65 offen sc1
s_waitcnt vmcnt(0)
v_cmp_gt_u32 vcc,s66,v22
s_cbranch_vccz pok_235
s_sleep 1
s_sub_u32 s90,s90,1
s_cmp_gt_i32 s90,0
s_cbranch_scc1 pl_234
pok_235:
s_mov_b32 s81,0xbdd2d3e8
v_mov_b32 v28,0xc0135761
v_mov_b32 v17,v16
v_and_b32 v21,31,v1
v_lshlrev_b32 v21,2,v21
s_mul_i32 s74,s79,40
s_add_u32 s74,s74,s63
s_add_u32 s74,s74,3072
s_lshl_b32 s42,s41,2
s_add_u32 s42,s42,s50
s_lshl_b32 s73,s41,7
s_lshl_b32 s64,s50,2
s_add_u32 s73,s73,s64
s_add_u32 s73,s73,s63
s_add_u32 s73,s73,6144
s_add_u32 s73,s73,s60
s_lshl_b32 s43,s50,11
s_lshl_b32 s78,s79,21
s_add_u32 s78,s78,27262976
s_mov_b32 s64,0
s_lshr_b32 s65,s50,1
s_and_b32 s66,s50,1
s_lshl_b32 s66,s66,12
s_add_u32 s66,s66,s64
s_lshl_b32 s72,s65,13
s_add_u32 s72,s72,s66
s_add_u32 s72,s72,0x10000
s_lshl_b32 s65,s65,14
s_add_u32 s75,s65,s66
s_add_u32 s75,s75,1966080
s_add_u32 s64,s41,72
s_lshl_b32 s64,s64,14
s_add_u32 s64,s64,s43
v_add_u32 v18,s64,v16
s_lshl_b32 s64,s42,8
s_add_u32 s64,s64,1310720
v_lshl_add_u32 v24,v3,4,s64
v_mov_b32 v5,0x40000000
v_cmp_gt_u32 vcc,16,v1
s_nop 1
v_cndmask_b32 v24,v5,v24,vcc
s_lshl_b32 s64,s42,6
v_and_b32 v5,3,v1
v_xor_b32 v5,v5,v4
v_lshl_add_u32 v5,v5,4,s64
v_lshrrev_b32 v11,2,v1
s_add_u32 s43,s43,133120
v_lshrrev_b32 v6,2,v3
v_lshrrev_b32 v7,1,v4
v_xor_b32 v6,v6,v7
v_lshlrev_b32 v6,4,v6
v_lshl_add_u32 v6,v3,6,v6
v_and_b32 v7,1,v4
v_lshl_add_u32 v6,v7,3,v6
v_add_u32 v40,s43,v6
v_xor_b32 v41,32,v40
v_add_u32 v6,30,v11
v_lshl_add_u32 v9,v6,7,v5
v_and_b32 v9,2047,v9
v_and_b32 v7,3,v6
v_lshl_add_u32 v7,v7,11,v9
v_bfe_u32 v8,v6,2,3
v_lshl_add_u32 v7,v8,14,v7
v_mov_b32 v8,0x2000
v_mov_b32 v9,2097152
v_cmp_gt_u32 vcc,32,v6
s_nop 1
v_cndmask_b32 v8,v9,v8,vcc
v_add_u32 v7,v7,v8
v_add_u32 v7,0,v7
v_xor_b32 v19,s62,v7
v_xor_b32 v19,0x2000,v19
v_add_u32 v6,46,v11
v_lshl_add_u32 v9,v6,7,v5
v_and_b32 v9,2047,v9
v_and_b32 v7,3,v6
v_lshl_add_u32 v7,v7,11,v9
v_bfe_u32 v8,v6,2,3
v_lshl_add_u32 v7,v8,14,v7
v_mov_b32 v8,0x2000
v_mov_b32 v9,2097152
v_cmp_gt_u32 vcc,32,v6
s_nop 1
v_cndmask_b32 v8,v9,v8,vcc
v_add_u32 v7,v7,v8
v_add_u32 v7,0,v7
v_xor_b32 v20,s62,v7
v_xor_b32 v20,0x2000,v20
s_add_u32 s64,s79,0
s_lshl_b32 s70,s64,21
s_lshl_b32 s64,s64,13
s_and_b32 s64,s64,0x2000
s_xor_b32 s64,s64,s62
s_add_u32 s70,s70,s64
s_add_u32 s70,s70,29360128
s_mov_b32 s83,1
s_mov_b32 s87,s74
s_cmp_eq_u32 s50,0
s_cselect_b32 s74,s74,0x7fff0000
v_mov_b32 v47,132096
s_lshl_b32 s64,s50,3
s_add_u32 s64,s64,132096
v_mov_b32 v46,s64
v_mov_b32 v29,0
s_mov_b32 s97,0x7fff0000
seg_237:
s_cmp_eq_u32 s83,0
s_cbranch_scc1 ahead_238
s_add_u32 s94,s70,s75
s_xor_b32 s95,s94,1024
s_xor_b32 s91,s72,0x10000
s_min_u32 s66,s71,64
s_waitcnt vmcnt(3)
v_cmp_gt_u32 vcc,s66,v29
s_cbranch_vccz nb_241
s_waitcnt vmcnt(0)
v_add_u32 v22,s71,-1
buffer_store_dword v22,v23,s[20:23],s97 offen sc1
s_mov_b32 s97,0x7fff0000
s_cmp_lg_u32 s50,0
s_cbranch_scc1 nb_241
buffer_load_dword v32,v21,s[20:23],s74 offen sc1
s_sleep 2
pl_242:
buffer_load_dword v33,v21,s[20:23],s74 offen sc1
s_waitcnt vmcnt(1)
v_cmp_gt_u32 vcc,s66,v32
v_mov_b32 v29,v32
s_cbranch_vccz pok_243
buffer_load_dword v32,v21,s[20:23],s74 offen sc1
s_waitcnt vmcnt(1)
v_cmp_gt_u32 vcc,s66,v33
v_mov_b32 v29,v33
s_cbranch_vccz pok_243
s_sub_u32 s90,s90,1
s_cmp_gt_i32 s90,0
s_cbranch_scc1 pl_242
pok_243:
nb_241:
s_barrier
s_xor_b32 m0,s91,0
s_add_u32 s65,s94,0
buffer_load_dwordx4 v16,s[20:23],s65 offen offset:0 sc1 lds
buffer_load_dwordx4 v16,s[20:23],s65 offen offset:2048 sc1 lds
s_xor_b32 m0,s91,16384
s_add_u32 s65,s94,32768
buffer_load_dwordx4 v16,s[20:23],s65 offen offset:0 sc1 lds
buffer_load_dwordx4 v16,s[20:23],s65 offen offset:2048 sc1 lds
s_xor_b32 m0,s91,32768
s_add_u32 s65,s94,65536
buffer_load_dwordx4 v16,s[20:23],s65 offen offset:0 sc1 lds
buffer_load_dwordx4 v16,s[20:23],s65 offen offset:2048 sc1 lds
s_xor_b32 m0,s91,49152
s_add_u32 s65,s94,98304
buffer_load_dwordx4 v16,s[20:23],s65 offen offset:0 sc1 lds
buffer_load_dwordx4 v16,s[20:23],s65 offen offset:2048 sc1 lds
s_waitcnt vmcnt(8)
v_add_u32 v22,s71,-1
buffer_store_dword v22,v23,s[20:23],s97 offen sc1
s_mov_b32 s97,0x7fff0000
s_waitcnt vmcnt(7)
s_barrier
ds_read_b128 v[224:227],v17 offset:0
ds_read_b128 v[228:231],v17 offset:2048
ds_read_b128 v[232:235],v17 offset:4096
ds_read_b128 v[236:239],v17 offset:6144
ds_read_b128 v[240:243],v17 offset:8192
ds_read_b128 v[244:247],v17 offset:10240
ds_read_b128 v[248:251],v17 offset:12288
s_waitcnt lgkmcnt(5)
v_mfma_f32_16x16x32_bf16 v[64:67],a[0:3],v[224:227],0
s_xor_b32 m0,s91,1024
s_add_u32 s96,s71,1
s_add_u32 s92,s71,2
v_mfma_f32_16x16x32_bf16 v[72:75],a[128:131],v[224:227],0
ds_read_b128 v[252:255],v17 offset:14336
s_cmp_eq_u32 s96,65
s_cselect_b32 s96,64,s96
v_mfma_f32_16x16x32_bf16 v[64:67],a[4:7],v[228:231],v[64:67]
s_add_u32 s65,s95,0
v_min_u32 v27,v224,v228
v_mfma_f32_16x16x32_bf16 v[72:75],a[132:135],v[228:231],v[72:75]
s_waitcnt vmcnt(5)
s_barrier
ds_read_b128 v[224:227],v17 offset:16384
s_waitcnt lgkmcnt(5)
v_mfma_f32_16x16x32_bf16 v[64:67],a[8:11],v[232:235],v[64:67]
buffer_load_dwordx4 v16,s[20:23],s65 offen offset:0 sc1 lds
v_mfma_f32_16x16x32_bf16 v[72:75],a[136:139],v[232:235],v[72:75]
ds_read_b128 v[228:231],v17 offset:18432
v_min3_u32 v27,v27,v232,v236
v_mfma_f32_16x16x32_bf16 v[64:67],a[12:15],v[236:239],v[64:67]
buffer_load_dwordx4 v16,s[20:23],s65 offen offset:2048 sc1 lds
v_mfma_f32_16x16x32_bf16 v[72:75],a[140:143],v[236:239],v[72:75]
ds_read_b128 v[232:235],v17 offset:20480
s_waitcnt lgkmcnt(5)
v_mfma_f32_16x16x32_bf16 v[64:67],a[16:19],v[240:243],v[64:67]
s_xor_b32 m0,s91,17408
v_min3_u32 v27,v27,v240,v244
v_mfma_f32_16x16x32_bf16 v[72:75],a[144:147],v[240:243],v[72:75]
ds_read_b128 v[236:239],v17 offset:22528
v_mfma_f32_16x16x32_bf16 v[64:67],a[20:23],v[244:247],v[64:67]
s_add_u32 s65,s95,32768
v_mfma_f32_16x16x32_bf16 v[72:75],a[148:151],v[244:247],v[72:75]
ds_read_b128 v[240:243],v17 offset:24576
s_waitcnt lgkmcnt(5)
v_mfma_f32_16x16x32_bf16 v[64:67],a[24:27],v[248:251],v[64:67]
buffer_load_dwordx4 v16,s[20:23],s65 offen offset:0 sc1 lds
v_mfma_f32_16x16x32_bf16 v[72:75],a[152:155],v[248:251],v[72:75]
ds_read_b128 v[244:247],v17 offset:26624
v_min3_u32 v27,v27,v248,v252
v_mfma_f32_16x16x32_bf16 v[64:67],a[28:31],v[252:255],v[64:67]
buffer_load_dwordx4 v16,s[20:23],s65 offen offset:2048 sc1 lds
v_mfma_f32_16x16x32_bf16 v[72:75],a[156:159],v[252:255],v[72:75]
ds_read_b128 v[248:251],v17 offset:28672
s_waitcnt lgkmcnt(5)
v_mfma_f32_16x16x32_bf16 v[64:67],a[32:35],v[224:227],v[64:67]
s_xor_b32 m0,s91,33792
v_min3_u32 v27,v27,v224,v228
v_mfma_f32_16x16x32_bf16 v[72:75],a[160:163],v[224:227],v[72:75]
ds_read_b128 v[252:255],v17 offset:30720
v_mfma_f32_16x16x32_bf16 v[64:67],a[36:39],v[228:231],v[64:67]
s_add_u32 s65,s95,65536
v_mfma_f32_16x16x32_bf16 v[72:75],a[164:167],v[228:231],v[72:75]
s_waitcnt vmcnt(5)
s_barrier
ds_read_b128 v[224:227],v17 offset:32768
s_waitcnt lgkmcnt(5)
v_mfma_f32_16x16x32_bf16 v[64:67],a[40:43],v[232:235],v[64:67]
buffer_load_dwordx4 v16,s[20:23],s65 offen offset:0 sc1 lds
v_mfma_f32_16x16x32_bf16 v[72:75],a[168:171],v[232:235],v[72:75]
ds_read_b128 v[228:231],v17 offset:34816
v_min3_u32 v27,v27,v232,v236
v_mfma_f32_16x16x32_bf16 v[64:67],a[44:47],v[236:239],v[64:67]
buffer_load_dwordx4 v16,s[20:23],s65 offen offset:2048 sc1 lds
v_mfma_f32_16x16x32_bf16 v[72:75],a[172:175],v[236:239],v[72:75]
ds_read_b128 v[232:235],v17 offset:36864
s_waitcnt lgkmcnt(5)
v_mfma_f32_16x16x32_bf16 v[64:67],a[48:51],v[240:243],v[64:67]
s_xor_b32 m0,s91,50176
v_min3_u32 v27,v27,v240,v244
v_mfma_f32_16x16x32_bf16 v[72:75],a[176:179],v[240:243],v[72:75]
ds_read_b128 v[236:239],v17 offset:38912
v_mfma_f32_16x16x32_bf16 v[64:67],a[52:55],v[244:247],v[64:67]
s_add_u32 s65,s95,98304
v_mfma_f32_16x16x32_bf16 v[72:75],a[180:183],v[244:247],v[72:75]
ds_read_b128 v[240:243],v17 offset:40960
s_waitcnt lgkmcnt(5)
v_mfma_f32_16x16x32_bf16 v[64:67],a[56:59],v[248:251],v[64:67]
buffer_load_dwordx4 v16,s[20:23],s65 offen offset:0 sc1 lds
v_min3_u32 v27,v27,v248,v252
v_mfma_f32_16x16x32_bf16 v[72:75],a[184:187],v[248:251],v[72:75]
ds_read_b128 v[244:247],v17 offset:43008
s_waitcnt vmcnt(63)
v_mfma_f32_16x16x32_bf16 v[64:67],a[60:63],v[252:255],v[64:67]
buffer_load_dwordx4 v16,s[20:23],s65 offen offset:2048 sc1 lds
v_mfma_f32_16x16x32_bf16 v[72:75],a[188:191],v[252:255],v[72:75]
ds_read_b128 v[248:251],v17 offset:45056
s_waitcnt lgkmcnt(5)
v_mfma_f32_16x16x32_bf16 v[64:67],a[64:67],v[224:227],v[64:67]
v_cmp_gt_u32 vcc,s96,v29
v_cmp_gt_u32 s[92:93],s92,v29
v_mfma_f32_16x16x32_bf16 v[72:75],a[192:195],v[224:227],v[72:75]
ds_read_b128 v[252:255],v17 offset:47104
v_min3_u32 v27,v27,v224,v228
v_mfma_f32_16x16x32_bf16 v[64:67],a[68:71],v[228:231],v[64:67]
v_mov_b32 v44,vcc_lo
v_mov_b32 v45,s92
s_add_u32 m0,s43,0
v_mfma_f32_16x16x32_bf16 v[72:75],a[196:199],v[228:231],v[72:75]
ds_read_b128 v[224:227],v17 offset:49152
s_waitcnt lgkmcnt(5)
v_mfma_f32_16x16x32_bf16 v[64:67],a[72:75],v[232:235],v[64:67]
ds_write_b64 v46,v[44:45]
v_min3_u32 v27,v27,v232,v236
v_mfma_f32_16x16x32_bf16 v[72:75],a[200:203],v[232:235],v[72:75]
ds_read_b128 v[228:231],v17 offset:51200
buffer_load_dwordx4 v19,s[20:23],s78 offen sc1 lds
v_mfma_f32_16x16x32_bf16 v[64:67],a[76:79],v[236:239],v[64:67]
s_add_u32 m0,s43,1024
s_nop 0
buffer_load_dwordx4 v20,s[20:23],s78 offen sc1 lds
v_mfma_f32_16x16x32_bf16 v[72:75],a[204:207],v[236:239],v[72:75]
ds_read_b128 v[232:235],v17 offset:53248
s_waitcnt lgkmcnt(6)
v_mfma_f32_16x16x32_bf16 v[64:67],a[80:83],v[240:243],v[64:67]
v_min3_u32 v27,v27,v240,v244
s_add_u32 s88,s70,s75
v_mfma_f32_16x16x32_bf16 v[72:75],a[208:211],v[240:243],v[72:75]
ds_read_b128 v[236:239],v17 offset:55296
s_add_u32 s88,s88,2097152
v_mfma_f32_16x16x32_bf16 v[64:67],a[84:87],v[244:247],v[64:67]
s_xor_b32 s88,s88,0x2000
s_xor_b32 s89,s88,1024
v_mfma_f32_16x16x32_bf16 v[72:75],a[212:215],v[244:247],v[72:75]
ds_read_b128 v[240:243],v17 offset:57344
s_waitcnt lgkmcnt(6)
v_mfma_f32_16x16x32_bf16 v[64:67],a[88:91],v[248:251],v[64:67]
v_min3_u32 v27,v27,v248,v252
v_mfma_f32_16x16x32_bf16 v[72:75],a[216:219],v[248:251],v[72:75]
ds_read_b128 v[244:247],v17 offset:59392
v_mfma_f32_16x16x32_bf16 v[64:67],a[92:95],v[252:255],v[64:67]
v_mfma_f32_16x16x32_bf16 v[72:75],a[220:223],v[252:255],v[72:75]
ds_read_b128 v[248:251],v17 offset:61440
s_waitcnt lgkmcnt(5)
v_mfma_f32_16x16x32_bf16 v[64:67],a[96:99],v[224:227],v[64:67]
v_min3_u32 v27,v27,v224,v228
v_mfma_f32_16x16x32_bf16 v[72:75],a[224:227],v[224:227],v[72:75]
ds_read_b128 v[252:255],v17 offset:63488
v_mfma_f32_16x16x32_bf16 v[64:67],a[100:103],v[228:231],v[64:67]
v_mfma_f32_16x16x32_bf16 v[72:75],a[228:231],v[228:231],v[72:75]
s_waitcnt vmcnt(6)
s_barrier
ds_read_b64 v[44:45],v47
ds_read_b128 v[224:227],v17 offset:1024
s_waitcnt lgkmcnt(6)
v_mfma_f32_16x16x32_bf16 v[64:67],a[104:107],v[232:235],v[64:67]
v_min3_u32 v27,v27,v232,v236
v_mfma_f32_16x16x32_bf16 v[72:75],a[232:235],v[232:235],v[72:75]
ds_read_b128 v[228:231],v17 offset:3072
v_mfma_f32_16x16x32_bf16 v[64:67],a[108:111],v[236:239],v[64:67]
s_waitcnt vmcnt(0)
ds_read_b64 v[120:121],v40 offset:0
v_mfma_f32_16x16x32_bf16 v[72:75],a[236:239],v[236:239],v[72:75]
ds_read_b128 v[232:235],v17 offset:5120
s_waitcnt lgkmcnt(7)
v_mfma_f32_16x16x32_bf16 v[64:67],a[112:115],v[240:243],v[64:67]
v_min3_u32 v27,v27,v240,v244
ds_read_b64 v[122:123],v41 offset:0
v_mfma_f32_16x16x32_bf16 v[72:75],a[240:243],v[240:243],v[72:75]
ds_read_b128 v[236:239],v17 offset:7168
ds_read_b64 v[124:125],v40 offset:1024
v_mfma_f32_16x16x32_bf16 v[64:67],a[116:119],v[244:247],v[64:67]
ds_read_b64 v[126:127],v41 offset:1024
v_mfma_f32_16x16x32_bf16 v[72:75],a[244:247],v[244:247],v[72:75]
ds_read_b128 v[240:243],v17 offset:9216
s_waitcnt lgkmcnt(10)
v_mfma_f32_16x16x32_bf16 v[64:67],a[120:123],v[248:251],v[64:67]
s_waitcnt lgkmcnt(9)
v_readfirstlane_b32 s93,v45
v_mfma_f32_16x16x32_bf16 v[72:75],a[248:251],v[248:251],v[72:75]
ds_read_b128 v[244:247],v17 offset:11264
v_readfirstlane_b32 s83,v44
s_cmp_lg_u32 s83,0
s_cbranch_scc0 keep_244
v_mfma_f32_16x16x32_bf16 v[64:67],a[124:127],v[252:255],v[64:67]
v_min3_u32 v27,v27,v248,v252
v_mfma_f32_16x16x32_bf16 v[72:75],a[252:255],v[252:255],v[72:75]
ds_read_b128 v[248:251],v17 offset:13312
s_waitcnt lgkmcnt(9)
v_mfma_f32_16x16x32_bf16 v[68:71],a[0:3],v[224:227],0
v_cmp_eq_u32 vcc,0,v27
s_cbranch_vccnz retry_236
v_mfma_f32_16x16x32_bf16 v[76:79],a[128:131],v[224:227],0
ds_read_b128 v[252:255],v17 offset:15360
v_min3_u32 v27,v27,v224,v228
v_mfma_f32_16x16x32_bf16 v[68:71],a[4:7],v[228:231],v[68:71]
v_mfma_f32_16x16x32_bf16 v[76:79],a[132:135],v[228:231],v[76:79]
ds_read_b128 v[224:227],v17 offset:17408
s_waitcnt lgkmcnt(7)
v_mfma_f32_16x16x32_bf16 v[68:71],a[8:11],v[232:235],v[68:71]
v_min3_u32 v27,v27,v232,v236
s_waitcnt lgkmcnt(5)
v_lshlrev_b32 v88,16,v120
v_mfma_f32_16x16x32_bf16 v[76:79],a[136:139],v[232:235],v[76:79]
ds_read_b128 v[228:231],v17 offset:19456
v_and_b32 v89,s80,v120
v_lshlrev_b32 v90,16,v121
v_mfma_f32_16x16x32_bf16 v[68:71],a[12:15],v[236:239],v[68:71]
v_and_b32 v91,s80,v121
v_lshlrev_b32 v92,16,v122
v_and_b32 v93,s80,v122
v_mfma_f32_16x16x32_bf16 v[76:79],a[140:143],v[236:239],v[76:79]
ds_read_b128 v[232:235],v17 offset:21504
v_lshlrev_b32 v94,16,v123
s_waitcnt lgkmcnt(5)
v_mfma_f32_16x16x32_bf16 v[68:71],a[16:19],v[240:243],v[68:71]
v_min3_u32 v27,v27,v240,v244
v_and_b32 v95,s80,v123
v_mfma_f32_16x16x32_bf16 v[76:79],a[144:147],v[240:243],v[76:79]
ds_read_b128 v[236:239],v17 offset:23552
v_add_f32 v88,v64,v88
v_mfma_f32_16x16x32_bf16 v[68:71],a[20:23],v[244:247],v[68:71]
v_add_f32 v89,v65,v89
v_add_f32 v90,v66,v90
v_mfma_f32_16x16x32_bf16 v[76:79],a[148:151],v[244:247],v[76:79]
ds_read_b128 v[240:243],v17 offset:25600
s_waitcnt lgkmcnt(5)
v_mfma_f32_16x16x32_bf16 v[68:71],a[24:27],v[248:251],v[68:71]
v_min3_u32 v27,v27,v248,v252
v_add_f32 v91,v67,v91
v_mfma_f32_16x16x32_bf16 v[76:79],a[152:155],v[248:251],v[76:79]
ds_read_b128 v[244:247],v17 offset:27648
v_add_f32 v92,v72,v92
v_mfma_f32_16x16x32_bf16 v[68:71],a[28:31],v[252:255],v[68:71]
v_add_f32 v93,v73,v93
v_add_f32 v94,v74,v94
v_mfma_f32_16x16x32_bf16 v[76:79],a[156:159],v[252:255],v[76:79]
ds_read_b128 v[248:251],v17 offset:29696
s_waitcnt lgkmcnt(5)
v_mfma_f32_16x16x32_bf16 v[68:71],a[32:35],v[224:227],v[68:71]
v_min3_u32 v27,v27,v224,v228
v_add_f32 v95,v75,v95
v_mfma_f32_16x16x32_bf16 v[76:79],a[160:163],v[224:227],v[76:79]
ds_read_b128 v[252:255],v17 offset:31744
v_cvt_pk_bf16_f32 v96,v88,v89
v_mfma_f32_16x16x32_bf16 v[68:71],a[36:39],v[228:231],v[68:71]
v_cvt_pk_bf16_f32 v97,v90,v91
v_cvt_pk_bf16_f32 v98,v92,v93
v_mfma_f32_16x16x32_bf16 v[76:79],a[164:167],v[228:231],v[76:79]
s_waitcnt vmcnt(2)
s_barrier
ds_read_b128 v[224:227],v17 offset:33792
s_waitcnt lgkmcnt(5)
v_mfma_f32_16x16x32_bf16 v[68:71],a[40:43],v[232:235],v[68:71]
v_min3_u32 v27,v27,v232,v236
v_cvt_pk_bf16_f32 v99,v94,v95
v_mfma_f32_16x16x32_bf16 v[76:79],a[168:171],v[232:235],v[76:79]
ds_read_b128 v[228:231],v17 offset:35840
v_max_u32 v96,1,v96
v_mfma_f32_16x16x32_bf16 v[68:71],a[44:47],v[236:239],v[68:71]
buffer_store_dwordx4 v[96:99],v18,s[20:23],s70 offen offset:0 sc1
v_mfma_f32_16x16x32_bf16 v[76:79],a[172:175],v[236:239],v[76:79]
ds_read_b128 v[232:235],v17 offset:37888
s_waitcnt lgkmcnt(5)
v_mfma_f32_16x16x32_bf16 v[68:71],a[48:51],v[240:243],v[68:71]
v_min3_u32 v27,v27,v240,v244
v_lshlrev_b32 v88,16,v96
v_mfma_f32_16x16x32_bf16 v[76:79],a[176:179],v[240:243],v[76:79]
ds_read_b128 v[236:239],v17 offset:39936
v_and_b32 v89,s80,v96
v_mfma_f32_16x16x32_bf16 v[68:71],a[52:55],v[244:247],v[68:71]
v_lshlrev_b32 v90,16,v97
v_and_b32 v91,s80,v97
v_mfma_f32_16x16x32_bf16 v[76:79],a[180:183],v[244:247],v[76:79]
ds_read_b128 v[240:243],v17 offset:41984
s_waitcnt lgkmcnt(5)
v_mfma_f32_16x16x32_bf16 v[68:71],a[56:59],v[248:251],v[68:71]
v_min3_u32 v27,v27,v248,v252
v_lshlrev_b32 v92,16,v98
v_mfma_f32_16x16x32_bf16 v[76:79],a[184:187],v[248:251],v[76:79]
ds_read_b128 v[244:247],v17 offset:44032
v_and_b32 v93,s80,v98
v_mfma_f32_16x16x32_bf16 v[68:71],a[60:63],v[252:255],v[68:71]
v_lshlrev_b32 v94,16,v99
v_and_b32 v95,s80,v99
v_mfma_f32_16x16x32_bf16 v[76:79],a[188:191],v[252:255],v[76:79]
ds_read_b128 v[248:251],v17 offset:46080
s_waitcnt lgkmcnt(5)
v_mfma_f32_16x16x32_bf16 v[68:71],a[64:67],v[224:227],v[68:71]
v_min3_u32 v27,v27,v224,v228
v_add_f32 v108,v88,v89
v_mfma_f32_16x16x32_bf16 v[76:79],a[192:195],v[224:227],v[76:79]
ds_read_b128 v[252:255],v17 offset:48128
v_mul_f32 v109,v88,v88
v_mfma_f32_16x16x32_bf16 v[68:71],a[68:71],v[228:231],v[68:71]
v_add_f32 v100,v90,v91
v_mul_f32 v101,v89,v89
v_mfma_f32_16x16x32_bf16 v[76:79],a[196:199],v[228:231],v[76:79]
ds_read_b128 v[224:227],v17 offset:50176
s_waitcnt lgkmcnt(5)
v_mfma_f32_16x16x32_bf16 v[68:71],a[72:75],v[232:235],v[68:71]
v_min3_u32 v27,v27,v232,v236
v_fmac_f32 v109,v90,v90
v_mfma_f32_16x16x32_bf16 v[76:79],a[200:203],v[232:235],v[76:79]
ds_read_b128 v[228:231],v17 offset:52224
v_fmac_f32 v101,v91,v91
v_mfma_f32_16x16x32_bf16 v[68:71],a[76:79],v[236:239],v[68:71]
v_fmac_f32 v109,v92,v92
v_fmac_f32 v101,v93,v93
v_mfma_f32_16x16x32_bf16 v[76:79],a[204:207],v[236:239],v[76:79]
ds_read_b128 v[232:235],v17 offset:54272
s_waitcnt lgkmcnt(5)
v_mfma_f32_16x16x32_bf16 v[68:71],a[80:83],v[240:243],v[68:71]
v_min3_u32 v27,v27,v240,v244
v_add_f32 v108,v108,v92
v_mfma_f32_16x16x32_bf16 v[76:79],a[208:211],v[240:243],v[76:79]
ds_read_b128 v[236:239],v17 offset:56320
v_add_f32 v100,v100,v93
v_mfma_f32_16x16x32_bf16 v[68:71],a[84:87],v[244:247],v[68:71]
v_fmac_f32 v109,v94,v94
v_fmac_f32 v101,v95,v95
v_mfma_f32_16x16x32_bf16 v[76:79],a[212:215],v[244:247],v[76:79]
ds_read_b128 v[240:243],v17 offset:58368
s_waitcnt lgkmcnt(5)
v_mfma_f32_16x16x32_bf16 v[68:71],a[88:91],v[248:251],v[68:71]
v_min3_u32 v27,v27,v248,v252
v_add_f32 v108,v108,v94
v_mfma_f32_16x16x32_bf16 v[76:79],a[216:219],v[248:251],v[76:79]
ds_read_b128 v[244:247],v17 offset:60416
v_add_f32 v100,v100,v95
v_mfma_f32_16x16x32_bf16 v[68:71],a[92:95],v[252:255],v[68:71]
v_add_f32 v108,v108,v100
v_add_f32 v109,v109,v101
v_mfma_f32_16x16x32_bf16 v[76:79],a[220:223],v[252:255],v[76:79]
ds_read_b128 v[248:251],v17 offset:62464
s_waitcnt lgkmcnt(5)
v_mfma_f32_16x16x32_bf16 v[68:71],a[96:99],v[224:227],v[68:71]
v_min3_u32 v27,v27,v224,v228
v_mov_b32 v100,v108
v_mfma_f32_16x16x32_bf16 v[76:79],a[224:227],v[224:227],v[76:79]
ds_read_b128 v[252:255],v17 offset:64512
v_mov_b32 v101,v109
v_mfma_f32_16x16x32_bf16 v[68:71],a[100:103],v[228:231],v[68:71]
v_permlane16_swap_b32 v100,v108
v_permlane16_swap_b32 v101,v109
v_mfma_f32_16x16x32_bf16 v[76:79],a[228:231],v[228:231],v[76:79]
v_add_f32 v108,v108,v100
s_waitcnt lgkmcnt(4)
v_mfma_f32_16x16x32_bf16 v[68:71],a[104:107],v[232:235],v[68:71]
v_min3_u32 v27,v27,v232,v236
v_add_f32 v109,v109,v101
v_mfma_f32_16x16x32_bf16 v[76:79],a[232:235],v[232:235],v[76:79]
v_mov_b32 v100,v108
v_mov_b32 v101,v109
v_mfma_f32_16x16x32_bf16 v[68:71],a[108:111],v[236:239],v[68:71]
v_permlane32_swap_b32 v100,v108
v_permlane32_swap_b32 v101,v109
v_mfma_f32_16x16x32_bf16 v[76:79],a[236:239],v[236:239],v[76:79]
v_add_f32 v108,v108,v100
s_waitcnt lgkmcnt(2)
v_mfma_f32_16x16x32_bf16 v[68:71],a[112:115],v[240:243],v[68:71]
v_min3_u32 v27,v27,v240,v244
v_add_f32 v109,v109,v101
v_mfma_f32_16x16x32_bf16 v[76:79],a[240:243],v[240:243],v[76:79]
v_min3_u32 v27,v27,v120,v122
v_min3_u32 v27,v27,v124,v126
v_mfma_f32_16x16x32_bf16 v[68:71],a[116:119],v[244:247],v[68:71]
v_lshlrev_b32 v32,16,v124
v_and_b32 v33,s80,v124
v_mfma_f32_16x16x32_bf16 v[76:79],a[244:247],v[244:247],v[76:79]
v_lshlrev_b32 v34,16,v125
s_waitcnt lgkmcnt(0)
v_mfma_f32_16x16x32_bf16 v[68:71],a[120:123],v[248:251],v[68:71]
v_min3_u32 v27,v27,v248,v252
v_and_b32 v35,s80,v125
v_mfma_f32_16x16x32_bf16 v[76:79],a[248:251],v[248:251],v[76:79]
v_lshlrev_b32 v36,16,v126
v_and_b32 v37,s80,v126
v_mfma_f32_16x16x32_bf16 v[68:71],a[124:127],v[252:255],v[68:71]
v_lshlrev_b32 v38,16,v127
v_and_b32 v39,s80,v127
v_mfma_f32_16x16x32_bf16 v[76:79],a[252:255],v[252:255],v[76:79]
v_cmp_eq_u32 vcc,0,v27
s_cbranch_vccnz retry_236
s_branch epi_239
keep_244:
v_mfma_f32_16x16x32_bf16 v[64:67],a[124:127],v[252:255],v[64:67]
v_min3_u32 v27,v27,v248,v252
s_xor_b32 m0,s72,0
v_mfma_f32_16x16x32_bf16 v[72:75],a[252:255],v[252:255],v[72:75]
ds_read_b128 v[248:251],v17 offset:13312
s_waitcnt lgkmcnt(9)
v_mfma_f32_16x16x32_bf16 v[68:71],a[0:3],v[224:227],0
s_add_u32 s65,s88,0
v_cmp_eq_u32 vcc,0,v27
s_cbranch_vccnz retry_236
v_mfma_f32_16x16x32_bf16 v[76:79],a[128:131],v[224:227],0
ds_read_b128 v[252:255],v17 offset:15360
v_min3_u32 v27,v27,v224,v228
v_mfma_f32_16x16x32_bf16 v[68:71],a[4:7],v[228:231],v[68:71]
buffer_load_dwordx4 v16,s[20:23],s65 offen offset:0 sc1 lds
v_mfma_f32_16x16x32_bf16 v[76:79],a[132:135],v[228:231],v[76:79]
ds_read_b128 v[224:227],v17 offset:17408
s_waitcnt lgkmcnt(7)
v_mfma_f32_16x16x32_bf16 v[68:71],a[8:11],v[232:235],v[68:71]
buffer_load_dwordx4 v16,s[20:23],s65 offen offset:2048 sc1 lds
s_waitcnt lgkmcnt(5)
v_lshlrev_b32 v88,16,v120
v_mfma_f32_16x16x32_bf16 v[76:79],a[136:139],v[232:235],v[76:79]
ds_read_b128 v[228:231],v17 offset:19456
s_xor_b32 m0,s72,16384
v_and_b32 v89,s80,v120
v_lshlrev_b32 v90,16,v121
v_mfma_f32_16x16x32_bf16 v[68:71],a[12:15],v[236:239],v[68:71]
s_add_u32 s65,s88,32768
v_min3_u32 v27,v27,v232,v236
v_and_b32 v91,s80,v121
v_lshlrev_b32 v92,16,v122
v_mfma_f32_16x16x32_bf16 v[76:79],a[140:143],v[236:239],v[76:79]
ds_read_b128 v[232:235],v17 offset:21504
v_and_b32 v93,s80,v122
v_lshlrev_b32 v94,16,v123
s_waitcnt lgkmcnt(5)
v_mfma_f32_16x16x32_bf16 v[68:71],a[16:19],v[240:243],v[68:71]
buffer_load_dwordx4 v16,s[20:23],s65 offen offset:0 sc1 lds
v_and_b32 v95,s80,v123
v_add_f32 v88,v64,v88
v_mfma_f32_16x16x32_bf16 v[76:79],a[144:147],v[240:243],v[76:79]
ds_read_b128 v[236:239],v17 offset:23552
v_min3_u32 v27,v27,v240,v244
v_add_f32 v89,v65,v89
v_add_f32 v90,v66,v90
v_mfma_f32_16x16x32_bf16 v[68:71],a[20:23],v[244:247],v[68:71]
buffer_load_dwordx4 v16,s[20:23],s65 offen offset:2048 sc1 lds
v_add_f32 v91,v67,v91
v_add_f32 v92,v72,v92
v_mfma_f32_16x16x32_bf16 v[76:79],a[148:151],v[244:247],v[76:79]
ds_read_b128 v[240:243],v17 offset:25600
v_add_f32 v93,v73,v93
v_add_f32 v94,v74,v94
s_waitcnt lgkmcnt(5)
v_mfma_f32_16x16x32_bf16 v[68:71],a[24:27],v[248:251],v[68:71]
s_xor_b32 m0,s72,32768
s_add_u32 s65,s88,65536
v_add_f32 v95,v75,v95
v_cvt_pk_bf16_f32 v96,v88,v89
v_mfma_f32_16x16x32_bf16 v[76:79],a[152:155],v[248:251],v[76:79]
ds_read_b128 v[244:247],v17 offset:27648
v_min3_u32 v27,v27,v248,v252
v_cvt_pk_bf16_f32 v97,v90,v91
v_cvt_pk_bf16_f32 v98,v92,v93
v_mfma_f32_16x16x32_bf16 v[68:71],a[28:31],v[252:255],v[68:71]
buffer_load_dwordx4 v16,s[20:23],s65 offen offset:0 sc1 lds
v_cvt_pk_bf16_f32 v99,v94,v95
v_max_u32 v96,1,v96
v_mfma_f32_16x16x32_bf16 v[76:79],a[156:159],v[252:255],v[76:79]
ds_read_b128 v[248:251],v17 offset:29696
buffer_store_dwordx4 v[96:99],v18,s[20:23],s70 offen offset:0 sc1
s_waitcnt lgkmcnt(5)
v_mfma_f32_16x16x32_bf16 v[68:71],a[32:35],v[224:227],v[68:71]
buffer_load_dwordx4 v16,s[20:23],s65 offen offset:2048 sc1 lds
v_lshlrev_b32 v88,16,v96
v_and_b32 v89,s80,v96
v_mfma_f32_16x16x32_bf16 v[76:79],a[160:163],v[224:227],v[76:79]
ds_read_b128 v[252:255],v17 offset:31744
s_xor_b32 m0,s72,49152
v_lshlrev_b32 v90,16,v97
v_and_b32 v91,s80,v97
v_mfma_f32_16x16x32_bf16 v[68:71],a[36:39],v[228:231],v[68:71]
v_min3_u32 v27,v27,v224,v228
v_lshlrev_b32 v92,16,v98
v_and_b32 v93,s80,v98
v_lshlrev_b32 v94,16,v99
v_mfma_f32_16x16x32_bf16 v[76:79],a[164:167],v[228:231],v[76:79]
s_waitcnt vmcnt(9)
s_barrier
ds_read_b128 v[224:227],v17 offset:33792
s_waitcnt lgkmcnt(5)
v_mfma_f32_16x16x32_bf16 v[68:71],a[40:43],v[232:235],v[68:71]
s_add_u32 s65,s88,98304
v_min3_u32 v27,v27,v232,v236
v_and_b32 v95,s80,v99
v_add_f32 v108,v88,v89
v_mfma_f32_16x16x32_bf16 v[76:79],a[168:171],v[232:235],v[76:79]
ds_read_b128 v[228:231],v17 offset:35840
v_mul_f32 v109,v88,v88
v_add_f32 v100,v90,v91
v_mul_f32 v101,v89,v89
v_mfma_f32_16x16x32_bf16 v[68:71],a[44:47],v[236:239],v[68:71]
buffer_load_dwordx4 v16,s[20:23],s65 offen offset:0 sc1 lds
v_fmac_f32 v109,v90,v90
v_fmac_f32 v101,v91,v91
v_mfma_f32_16x16x32_bf16 v[76:79],a[172:175],v[236:239],v[76:79]
ds_read_b128 v[232:235],v17 offset:37888
v_fmac_f32 v109,v92,v92
v_fmac_f32 v101,v93,v93
s_waitcnt lgkmcnt(5)
v_mfma_f32_16x16x32_bf16 v[68:71],a[48:51],v[240:243],v[68:71]
buffer_load_dwordx4 v16,s[20:23],s65 offen offset:2048 sc1 lds
v_add_f32 v108,v108,v92
v_add_f32 v100,v100,v93
v_mfma_f32_16x16x32_bf16 v[76:79],a[176:179],v[240:243],v[76:79]
ds_read_b128 v[236:239],v17 offset:39936
s_xor_b32 m0,s72,1024
v_fmac_f32 v109,v94,v94
v_fmac_f32 v101,v95,v95
v_mfma_f32_16x16x32_bf16 v[68:71],a[52:55],v[244:247],v[68:71]
s_add_u32 s65,s89,0
v_min3_u32 v27,v27,v240,v244
v_add_f32 v108,v108,v94
v_add_f32 v100,v100,v95
v_mfma_f32_16x16x32_bf16 v[76:79],a[180:183],v[244:247],v[76:79]
ds_read_b128 v[240:243],v17 offset:41984
v_add_f32 v108,v108,v100
v_add_f32 v109,v109,v101
s_waitcnt lgkmcnt(5)
v_mfma_f32_16x16x32_bf16 v[68:71],a[56:59],v[248:251],v[68:71]
buffer_load_dwordx4 v16,s[20:23],s65 offen offset:0 sc1 lds
v_mfma_f32_16x16x32_bf16 v[76:79],a[184:187],v[248:251],v[76:79]
ds_read_b128 v[244:247],v17 offset:44032
v_min3_u32 v27,v27,v248,v252
v_mfma_f32_16x16x32_bf16 v[68:71],a[60:63],v[252:255],v[68:71]
buffer_load_dwordx4 v16,s[20:23],s65 offen offset:2048 sc1 lds
v_mfma_f32_16x16x32_bf16 v[76:79],a[188:191],v[252:255],v[76:79]
ds_read_b128 v[248:251],v17 offset:46080
s_waitcnt lgkmcnt(5)
v_mfma_f32_16x16x32_bf16 v[68:71],a[64:67],v[224:227],v[68:71]
s_xor_b32 m0,s72,17408
s_add_u32 s65,s89,32768
v_mfma_f32_16x16x32_bf16 v[76:79],a[192:195],v[224:227],v[76:79]
ds_read_b128 v[252:255],v17 offset:48128
v_min3_u32 v27,v27,v224,v228
v_mfma_f32_16x16x32_bf16 v[68:71],a[68:71],v[228:231],v[68:71]
buffer_load_dwordx4 v16,s[20:23],s65 offen offset:0 sc1 lds
v_mfma_f32_16x16x32_bf16 v[76:79],a[196:199],v[228:231],v[76:79]
ds_read_b128 v[224:227],v17 offset:50176
s_waitcnt lgkmcnt(5)
v_mfma_f32_16x16x32_bf16 v[68:71],a[72:75],v[232:235],v[68:71]
buffer_load_dwordx4 v16,s[20:23],s65 offen offset:2048 sc1 lds
v_mfma_f32_16x16x32_bf16 v[76:79],a[200:203],v[232:235],v[76:79]
ds_read_b128 v[228:231],v17 offset:52224
s_xor_b32 m0,s72,33792
v_mfma_f32_16x16x32_bf16 v[68:71],a[76:79],v[236:239],v[68:71]
s_add_u32 s65,s89,65536
v_min3_u32 v27,v27,v232,v236
v_mfma_f32_16x16x32_bf16 v[76:79],a[204:207],v[236:239],v[76:79]
ds_read_b128 v[232:235],v17 offset:54272
s_waitcnt lgkmcnt(5)
v_mfma_f32_16x16x32_bf16 v[68:71],a[80:83],v[240:243],v[68:71]
buffer_load_dwordx4 v16,s[20:23],s65 offen offset:0 sc1 lds
v_mfma_f32_16x16x32_bf16 v[76:79],a[208:211],v[240:243],v[76:79]
ds_read_b128 v[236:239],v17 offset:56320
v_min3_u32 v27,v27,v240,v244
v_mfma_f32_16x16x32_bf16 v[68:71],a[84:87],v[244:247],v[68:71]
buffer_load_dwordx4 v16,s[20:23],s65 offen offset:2048 sc1 lds
v_mfma_f32_16x16x32_bf16 v[76:79],a[212:215],v[244:247],v[76:79]
ds_read_b128 v[240:243],v17 offset:58368
s_waitcnt lgkmcnt(5)
v_mfma_f32_16x16x32_bf16 v[68:71],a[88:91],v[248:251],v[68:71]
s_xor_b32 m0,s72,50176
v_min3_u32 v27,v27,v248,v252
v_mfma_f32_16x16x32_bf16 v[76:79],a[216:219],v[248:251],v[76:79]
ds_read_b128 v[244:247],v17 offset:60416
s_add_u32 s65,s89,98304
v_mfma_f32_16x16x32_bf16 v[68:71],a[92:95],v[252:255],v[68:71]
buffer_load_dwordx4 v16,s[20:23],s65 offen offset:0 sc1 lds
v_mfma_f32_16x16x32_bf16 v[76:79],a[220:223],v[252:255],v[76:79]
ds_read_b128 v[248:251],v17 offset:62464
s_waitcnt lgkmcnt(5)
v_mfma_f32_16x16x32_bf16 v[68:71],a[96:99],v[224:227],v[68:71]
buffer_load_dwordx4 v16,s[20:23],s65 offen offset:2048 sc1 lds
v_mfma_f32_16x16x32_bf16 v[76:79],a[224:227],v[224:227],v[76:79]
ds_read_b128 v[252:255],v17 offset:64512
v_min3_u32 v27,v27,v224,v228
v_mfma_f32_16x16x32_bf16 v[68:71],a[100:103],v[228:231],v[68:71]
v_mov_b32 v100,v108
v_mov_b32 v101,v109
v_mfma_f32_16x16x32_bf16 v[76:79],a[228:231],v[228:231],v[76:79]
v_permlane16_swap_b32 v100,v108
s_waitcnt lgkmcnt(4)
v_mfma_f32_16x16x32_bf16 v[68:71],a[104:107],v[232:235],v[68:71]
v_min3_u32 v27,v27,v232,v236
v_permlane16_swap_b32 v101,v109
v_mfma_f32_16x16x32_bf16 v[76:79],a[232:235],v[232:235],v[76:79]
v_add_f32 v108,v108,v100
v_add_f32 v109,v109,v101
v_mfma_f32_16x16x32_bf16 v[68:71],a[108:111],v[236:239],v[68:71]
v_mov_b32 v100,v108
v_mov_b32 v101,v109
v_mfma_f32_16x16x32_bf16 v[76:79],a[236:239],v[236:239],v[76:79]
v_permlane32_swap_b32 v100,v108
s_waitcnt lgkmcnt(2)
v_mfma_f32_16x16x32_bf16 v[68:71],a[112:115],v[240:243],v[68:71]
v_min3_u32 v27,v27,v240,v244
v_permlane32_swap_b32 v101,v109
v_mfma_f32_16x16x32_bf16 v[76:79],a[240:243],v[240:243],v[76:79]
v_add_f32 v108,v108,v100
v_add_f32 v109,v109,v101
v_mfma_f32_16x16x32_bf16 v[68:71],a[116:119],v[244:247],v[68:71]
v_min3_u32 v27,v27,v120,v122
v_min3_u32 v27,v27,v124,v126
v_mfma_f32_16x16x32_bf16 v[76:79],a[244:247],v[244:247],v[76:79]
v_lshlrev_b32 v32,16,v124
s_waitcnt lgkmcnt(0)
v_mfma_f32_16x16x32_bf16 v[68:71],a[120:123],v[248:251],v[68:71]
v_min3_u32 v27,v27,v248,v252
v_and_b32 v33,s80,v124
v_mfma_f32_16x16x32_bf16 v[76:79],a[248:251],v[248:251],v[76:79]
v_lshlrev_b32 v34,16,v125
v_and_b32 v35,s80,v125
v_mfma_f32_16x16x32_bf16 v[68:71],a[124:127],v[252:255],v[68:71]
v_lshlrev_b32 v36,16,v126
v_and_b32 v37,s80,v126
v_mfma_f32_16x16x32_bf16 v[76:79],a[252:255],v[252:255],v[76:79]
v_lshlrev_b32 v38,16,v127
v_and_b32 v39,s80,v127
v_cmp_eq_u32 vcc,0,v27
s_cbranch_vccnz retry_236
s_branch epi_239
ahead_238:
s_cmp_eq_u32 s93,0
s_cbranch_scc1 both_240
s_waitcnt vmcnt(12) lgkmcnt(0)
s_barrier
ds_read_b128 v[224:227],v17 offset:0
ds_read_b128 v[228:231],v17 offset:2048
ds_read_b128 v[232:235],v17 offset:4096
ds_read_b128 v[236:239],v17 offset:6144
ds_read_b128 v[240:243],v17 offset:8192
ds_read_b128 v[244:247],v17 offset:10240
ds_read_b128 v[248:251],v17 offset:12288
s_waitcnt lgkmcnt(5)
v_mfma_f32_16x16x32_bf16 v[64:67],a[0:3],v[224:227],0
s_add_u32 s96,s71,1
s_add_u32 s92,s71,2
s_add_u32 m0,s43,0
v_mfma_f32_16x16x32_bf16 v[72:75],a[128:131],v[224:227],0
ds_read_b128 v[252:255],v17 offset:14336
v_min_u32 v27,v224,v228
buffer_load_dwordx4 v19,s[20:23],s78 offen sc1 lds
v_mfma_f32_16x16x32_bf16 v[64:67],a[4:7],v[228:231],v[64:67]
s_cmp_eq_u32 s96,65
s_cselect_b32 s96,64,s96
s_add_u32 m0,s43,1024
v_mfma_f32_16x16x32_bf16 v[72:75],a[132:135],v[228:231],v[72:75]
ds_read_b128 v[224:227],v17 offset:16384
buffer_load_dwordx4 v20,s[20:23],s78 offen sc1 lds
s_waitcnt lgkmcnt(5)
v_mfma_f32_16x16x32_bf16 v[64:67],a[8:11],v[232:235],v[64:67]
v_min3_u32 v27,v27,v232,v236
v_mfma_f32_16x16x32_bf16 v[72:75],a[136:139],v[232:235],v[72:75]
ds_read_b128 v[228:231],v17 offset:18432
v_mfma_f32_16x16x32_bf16 v[64:67],a[12:15],v[236:239],v[64:67]
v_mfma_f32_16x16x32_bf16 v[72:75],a[140:143],v[236:239],v[72:75]
ds_read_b128 v[232:235],v17 offset:20480
s_waitcnt lgkmcnt(5)
v_mfma_f32_16x16x32_bf16 v[64:67],a[16:19],v[240:243],v[64:67]
v_min3_u32 v27,v27,v240,v244
v_mfma_f32_16x16x32_bf16 v[72:75],a[144:147],v[240:243],v[72:75]
ds_read_b128 v[236:239],v17 offset:22528
v_mfma_f32_16x16x32_bf16 v[64:67],a[20:23],v[244:247],v[64:67]
v_mfma_f32_16x16x32_bf16 v[72:75],a[148:151],v[244:247],v[72:75]
ds_read_b128 v[240:243],v17 offset:24576
s_waitcnt lgkmcnt(5)
v_mfma_f32_16x16x32_bf16 v[64:67],a[24:27],v[248:251],v[64:67]
v_min3_u32 v27,v27,v248,v252
v_mfma_f32_16x16x32_bf16 v[72:75],a[152:155],v[248:251],v[72:75]
ds_read_b128 v[244:247],v17 offset:26624
v_mfma_f32_16x16x32_bf16 v[64:67],a[28:31],v[252:255],v[64:67]
v_mfma_f32_16x16x32_bf16 v[72:75],a[156:159],v[252:255],v[72:75]
ds_read_b128 v[248:251],v17 offset:28672
s_waitcnt lgkmcnt(5)
v_mfma_f32_16x16x32_bf16 v[64:67],a[32:35],v[224:227],v[64:67]
v_min3_u32 v27,v27,v224,v228
v_mfma_f32_16x16x32_bf16 v[72:75],a[160:163],v[224:227],v[72:75]
ds_read_b128 v[252:255],v17 offset:30720
v_mfma_f32_16x16x32_bf16 v[64:67],a[36:39],v[228:231],v[64:67]
v_mfma_f32_16x16x32_bf16 v[72:75],a[164:167],v[228:231],v[72:75]
ds_read_b128 v[224:227],v17 offset:32768
s_waitcnt lgkmcnt(5)
v_mfma_f32_16x16x32_bf16 v[64:67],a[40:43],v[232:235],v[64:67]
v_min3_u32 v27,v27,v232,v236
v_mfma_f32_16x16x32_bf16 v[72:75],a[168:171],v[232:235],v[72:75]
ds_read_b128 v[228:231],v17 offset:34816
v_mfma_f32_16x16x32_bf16 v[64:67],a[44:47],v[236:239],v[64:67]
v_mfma_f32_16x16x32_bf16 v[72:75],a[172:175],v[236:239],v[72:75]
ds_read_b128 v[232:235],v17 offset:36864
s_waitcnt lgkmcnt(5)
v_mfma_f32_16x16x32_bf16 v[64:67],a[48:51],v[240:243],v[64:67]
v_min3_u32 v27,v27,v240,v244
v_mfma_f32_16x16x32_bf16 v[72:75],a[176:179],v[240:243],v[72:75]
ds_read_b128 v[236:239],v17 offset:38912
v_mfma_f32_16x16x32_bf16 v[64:67],a[52:55],v[244:247],v[64:67]
v_mfma_f32_16x16x32_bf16 v[72:75],a[180:183],v[244:247],v[72:75]
ds_read_b128 v[240:243],v17 offset:40960
s_waitcnt lgkmcnt(5)
v_mfma_f32_16x16x32_bf16 v[64:67],a[56:59],v[248:251],v[64:67]
v_min3_u32 v27,v27,v248,v252
v_mfma_f32_16x16x32_bf16 v[72:75],a[184:187],v[248:251],v[72:75]
ds_read_b128 v[244:247],v17 offset:43008
s_waitcnt vmcnt(5)
v_mfma_f32_16x16x32_bf16 v[64:67],a[60:63],v[252:255],v[64:67]
v_cmp_gt_u32 vcc,s96,v29
v_cmp_gt_u32 s[92:93],s92,v29
v_mfma_f32_16x16x32_bf16 v[72:75],a[188:191],v[252:255],v[72:75]
ds_read_b128 v[248:251],v17 offset:45056
s_waitcnt lgkmcnt(5)
v_mfma_f32_16x16x32_bf16 v[64:67],a[64:67],v[224:227],v[64:67]
v_mov_b32 v44,vcc_lo
v_mov_b32 v45,s92
v_mfma_f32_16x16x32_bf16 v[72:75],a[192:195],v[224:227],v[72:75]
ds_read_b128 v[252:255],v17 offset:47104
ds_write_b64 v46,v[44:45]
v_mfma_f32_16x16x32_bf16 v[64:67],a[68:71],v[228:231],v[64:67]
v_min3_u32 v27,v27,v224,v228
v_mfma_f32_16x16x32_bf16 v[72:75],a[196:199],v[228:231],v[72:75]
ds_read_b128 v[224:227],v17 offset:49152
s_waitcnt lgkmcnt(6)
v_mfma_f32_16x16x32_bf16 v[64:67],a[72:75],v[232:235],v[64:67]
v_min3_u32 v27,v27,v232,v236
v_mfma_f32_16x16x32_bf16 v[72:75],a[200:203],v[232:235],v[72:75]
ds_read_b128 v[228:231],v17 offset:51200
v_mfma_f32_16x16x32_bf16 v[64:67],a[76:79],v[236:239],v[64:67]
v_mfma_f32_16x16x32_bf16 v[72:75],a[204:207],v[236:239],v[72:75]
ds_read_b128 v[232:235],v17 offset:53248
s_waitcnt lgkmcnt(6)
v_mfma_f32_16x16x32_bf16 v[64:67],a[80:83],v[240:243],v[64:67]
v_min3_u32 v27,v27,v240,v244
s_add_u32 s88,s70,s75
v_mfma_f32_16x16x32_bf16 v[72:75],a[208:211],v[240:243],v[72:75]
ds_read_b128 v[236:239],v17 offset:55296
s_add_u32 s88,s88,2097152
v_mfma_f32_16x16x32_bf16 v[64:67],a[84:87],v[244:247],v[64:67]
s_xor_b32 s88,s88,0x2000
s_xor_b32 s89,s88,1024
v_mfma_f32_16x16x32_bf16 v[72:75],a[212:215],v[244:247],v[72:75]
ds_read_b128 v[240:243],v17 offset:57344
s_waitcnt lgkmcnt(6)
v_mfma_f32_16x16x32_bf16 v[64:67],a[88:91],v[248:251],v[64:67]
v_min3_u32 v27,v27,v248,v252
v_mfma_f32_16x16x32_bf16 v[72:75],a[216:219],v[248:251],v[72:75]
ds_read_b128 v[244:247],v17 offset:59392
v_mfma_f32_16x16x32_bf16 v[64:67],a[92:95],v[252:255],v[64:67]
v_mfma_f32_16x16x32_bf16 v[72:75],a[220:223],v[252:255],v[72:75]
ds_read_b128 v[248:251],v17 offset:61440
s_waitcnt lgkmcnt(5)
v_mfma_f32_16x16x32_bf16 v[64:67],a[96:99],v[224:227],v[64:67]
v_min3_u32 v27,v27,v224,v228
v_mfma_f32_16x16x32_bf16 v[72:75],a[224:227],v[224:227],v[72:75]
ds_read_b128 v[252:255],v17 offset:63488
v_mfma_f32_16x16x32_bf16 v[64:67],a[100:103],v[228:231],v[64:67]
s_waitcnt vmcnt(2)
v_add_u32 v22,s71,-1
v_mfma_f32_16x16x32_bf16 v[72:75],a[228:231],v[228:231],v[72:75]
s_waitcnt vmcnt(6)
s_barrier
ds_read_b64 v[44:45],v47
ds_read_b128 v[224:227],v17 offset:1024
s_waitcnt lgkmcnt(6)
v_mfma_f32_16x16x32_bf16 v[64:67],a[104:107],v[232:235],v[64:67]
v_min3_u32 v27,v27,v232,v236
v_mfma_f32_16x16x32_bf16 v[72:75],a[232:235],v[232:235],v[72:75]
ds_read_b128 v[228:231],v17 offset:3072
v_mfma_f32_16x16x32_bf16 v[64:67],a[108:111],v[236:239],v[64:67]
buffer_store_dword v22,v23,s[20:23],s97 offen sc1
s_waitcnt vmcnt(1)
v_mfma_f32_16x16x32_bf16 v[72:75],a[236:239],v[236:239],v[72:75]
ds_read_b128 v[232:235],v17 offset:5120
s_waitcnt lgkmcnt(6)
v_mfma_f32_16x16x32_bf16 v[64:67],a[112:115],v[240:243],v[64:67]
v_min3_u32 v27,v27,v240,v244
s_mov_b32 s97,0x7fff0000
v_mfma_f32_16x16x32_bf16 v[72:75],a[240:243],v[240:243],v[72:75]
ds_read_b128 v[236:239],v17 offset:7168
ds_read_b64 v[120:121],v40 offset:0
v_mfma_f32_16x16x32_bf16 v[64:67],a[116:119],v[244:247],v[64:67]
ds_read_b64 v[122:123],v41 offset:0
ds_read_b64 v[124:125],v40 offset:1024
v_mfma_f32_16x16x32_bf16 v[72:75],a[244:247],v[244:247],v[72:75]
ds_read_b128 v[240:243],v17 offset:9216
s_waitcnt lgkmcnt(9)
v_mfma_f32_16x16x32_bf16 v[64:67],a[120:123],v[248:251],v[64:67]
s_waitcnt lgkmcnt(8)
v_readfirstlane_b32 s93,v45
v_mfma_f32_16x16x32_bf16 v[72:75],a[248:251],v[248:251],v[72:75]
ds_read_b128 v[244:247],v17 offset:11264
v_readfirstlane_b32 s83,v44
s_cmp_lg_u32 s83,0
s_cbranch_scc1 keep_245
v_mfma_f32_16x16x32_bf16 v[64:67],a[124:127],v[252:255],v[64:67]
v_min3_u32 v27,v27,v248,v252
ds_read_b64 v[126:127],v41 offset:1024
v_mfma_f32_16x16x32_bf16 v[72:75],a[252:255],v[252:255],v[72:75]
ds_read_b128 v[248:251],v17 offset:13312
s_waitcnt lgkmcnt(9)
v_mfma_f32_16x16x32_bf16 v[68:71],a[0:3],v[224:227],0
s_xor_b32 m0,s72,0
s_add_u32 s65,s88,0
v_min3_u32 v27,v27,v224,v228
v_mfma_f32_16x16x32_bf16 v[76:79],a[128:131],v[224:227],0
ds_read_b128 v[252:255],v17 offset:15360
v_cmp_eq_u32 vcc,0,v27
s_cbranch_vccnz retry_236
v_mfma_f32_16x16x32_bf16 v[68:71],a[4:7],v[228:231],v[68:71]
buffer_load_dwordx4 v16,s[20:23],s65 offen offset:0 sc1 lds
v_mfma_f32_16x16x32_bf16 v[76:79],a[132:135],v[228:231],v[76:79]
ds_read_b128 v[224:227],v17 offset:17408
s_waitcnt lgkmcnt(9)
v_mfma_f32_16x16x32_bf16 v[68:71],a[8:11],v[232:235],v[68:71]
buffer_load_dwordx4 v16,s[20:23],s65 offen offset:2048 sc1 lds
s_waitcnt lgkmcnt(3)
v_lshlrev_b32 v88,16,v120
v_mfma_f32_16x16x32_bf16 v[76:79],a[136:139],v[232:235],v[76:79]
ds_read_b128 v[228:231],v17 offset:19456
s_xor_b32 m0,s72,16384
v_and_b32 v89,s80,v120
v_lshlrev_b32 v90,16,v121
v_mfma_f32_16x16x32_bf16 v[68:71],a[12:15],v[236:239],v[68:71]
s_add_u32 s65,s88,32768
v_min3_u32 v27,v27,v232,v236
v_and_b32 v91,s80,v121
v_lshlrev_b32 v92,16,v122
v_mfma_f32_16x16x32_bf16 v[76:79],a[140:143],v[236:239],v[76:79]
ds_read_b128 v[232:235],v17 offset:21504
v_and_b32 v93,s80,v122
v_lshlrev_b32 v94,16,v123
v_mfma_f32_16x16x32_bf16 v[68:71],a[16:19],v[240:243],v[68:71]
buffer_load_dwordx4 v16,s[20:23],s65 offen offset:0 sc1 lds
v_and_b32 v95,s80,v123
v_add_f32 v88,v64,v88
v_mfma_f32_16x16x32_bf16 v[76:79],a[144:147],v[240:243],v[76:79]
ds_read_b128 v[236:239],v17 offset:23552
v_min3_u32 v27,v27,v240,v244
v_add_f32 v89,v65,v89
v_add_f32 v90,v66,v90
v_mfma_f32_16x16x32_bf16 v[68:71],a[20:23],v[244:247],v[68:71]
buffer_load_dwordx4 v16,s[20:23],s65 offen offset:2048 sc1 lds
v_add_f32 v91,v67,v91
v_add_f32 v92,v72,v92
v_mfma_f32_16x16x32_bf16 v[76:79],a[148:151],v[244:247],v[76:79]
ds_read_b128 v[240:243],v17 offset:25600
v_add_f32 v93,v73,v93
v_add_f32 v94,v74,v94
s_waitcnt lgkmcnt(5)
v_mfma_f32_16x16x32_bf16 v[68:71],a[24:27],v[248:251],v[68:71]
s_xor_b32 m0,s72,32768
s_add_u32 s65,s88,65536
v_add_f32 v95,v75,v95
v_cvt_pk_bf16_f32 v96,v88,v89
v_mfma_f32_16x16x32_bf16 v[76:79],a[152:155],v[248:251],v[76:79]
ds_read_b128 v[244:247],v17 offset:27648
v_min3_u32 v27,v27,v248,v252
v_cvt_pk_bf16_f32 v97,v90,v91
v_cvt_pk_bf16_f32 v98,v92,v93
v_mfma_f32_16x16x32_bf16 v[68:71],a[28:31],v[252:255],v[68:71]
buffer_load_dwordx4 v16,s[20:23],s65 offen offset:0 sc1 lds
v_cvt_pk_bf16_f32 v99,v94,v95
v_max_u32 v96,1,v96
v_mfma_f32_16x16x32_bf16 v[76:79],a[156:159],v[252:255],v[76:79]
ds_read_b128 v[248:251],v17 offset:29696
buffer_store_dwordx4 v[96:99],v18,s[20:23],s70 offen offset:0 sc1
s_waitcnt lgkmcnt(5)
v_mfma_f32_16x16x32_bf16 v[68:71],a[32:35],v[224:227],v[68:71]
buffer_load_dwordx4 v16,s[20:23],s65 offen offset:2048 sc1 lds
v_lshlrev_b32 v88,16,v96
v_and_b32 v89,s80,v96
v_mfma_f32_16x16x32_bf16 v[76:79],a[160:163],v[224:227],v[76:79]
ds_read_b128 v[252:255],v17 offset:31744
s_xor_b32 m0,s72,49152
v_lshlrev_b32 v90,16,v97
v_and_b32 v91,s80,v97
v_mfma_f32_16x16x32_bf16 v[68:71],a[36:39],v[228:231],v[68:71]
v_min3_u32 v27,v27,v224,v228
v_lshlrev_b32 v92,16,v98
v_and_b32 v93,s80,v98
v_lshlrev_b32 v94,16,v99
v_mfma_f32_16x16x32_bf16 v[76:79],a[164:167],v[228:231],v[76:79]
ds_read_b128 v[224:227],v17 offset:33792
v_and_b32 v95,s80,v99
v_add_f32 v108,v88,v89
s_waitcnt lgkmcnt(5)
v_mfma_f32_16x16x32_bf16 v[68:71],a[40:43],v[232:235],v[68:71]
s_add_u32 s65,s88,98304
v_min3_u32 v27,v27,v232,v236
v_mul_f32 v109,v88,v88
v_add_f32 v100,v90,v91
v_mfma_f32_16x16x32_bf16 v[76:79],a[168:171],v[232:235],v[76:79]
ds_read_b128 v[228:231],v17 offset:35840
v_mul_f32 v101,v89,v89
v_fmac_f32 v109,v90,v90
v_fmac_f32 v101,v91,v91
v_mfma_f32_16x16x32_bf16 v[68:71],a[44:47],v[236:239],v[68:71]
buffer_load_dwordx4 v16,s[20:23],s65 offen offset:0 sc1 lds
v_fmac_f32 v109,v92,v92
v_fmac_f32 v101,v93,v93
v_mfma_f32_16x16x32_bf16 v[76:79],a[172:175],v[236:239],v[76:79]
ds_read_b128 v[232:235],v17 offset:37888
v_add_f32 v108,v108,v92
v_add_f32 v100,v100,v93
s_waitcnt lgkmcnt(5)
v_mfma_f32_16x16x32_bf16 v[68:71],a[48:51],v[240:243],v[68:71]
buffer_load_dwordx4 v16,s[20:23],s65 offen offset:2048 sc1 lds
v_fmac_f32 v109,v94,v94
v_fmac_f32 v101,v95,v95
v_mfma_f32_16x16x32_bf16 v[76:79],a[176:179],v[240:243],v[76:79]
ds_read_b128 v[236:239],v17 offset:39936
s_xor_b32 m0,s72,1024
v_add_f32 v108,v108,v94
v_add_f32 v100,v100,v95
v_mfma_f32_16x16x32_bf16 v[68:71],a[52:55],v[244:247],v[68:71]
s_add_u32 s65,s89,0
v_min3_u32 v27,v27,v240,v244
v_add_f32 v108,v108,v100
v_add_f32 v109,v109,v101
v_mfma_f32_16x16x32_bf16 v[76:79],a[180:183],v[244:247],v[76:79]
ds_read_b128 v[240:243],v17 offset:41984
s_waitcnt lgkmcnt(5)
v_mfma_f32_16x16x32_bf16 v[68:71],a[56:59],v[248:251],v[68:71]
buffer_load_dwordx4 v16,s[20:23],s65 offen offset:0 sc1 lds
v_mfma_f32_16x16x32_bf16 v[76:79],a[184:187],v[248:251],v[76:79]
ds_read_b128 v[244:247],v17 offset:44032
v_min3_u32 v27,v27,v248,v252
v_mfma_f32_16x16x32_bf16 v[68:71],a[60:63],v[252:255],v[68:71]
buffer_load_dwordx4 v16,s[20:23],s65 offen offset:2048 sc1 lds
v_mfma_f32_16x16x32_bf16 v[76:79],a[188:191],v[252:255],v[76:79]
ds_read_b128 v[248:251],v17 offset:46080
s_waitcnt lgkmcnt(5)
v_mfma_f32_16x16x32_bf16 v[68:71],a[64:67],v[224:227],v[68:71]
s_xor_b32 m0,s72,17408
s_add_u32 s65,s89,32768
v_mfma_f32_16x16x32_bf16 v[76:79],a[192:195],v[224:227],v[76:79]
ds_read_b128 v[252:255],v17 offset:48128
v_min3_u32 v27,v27,v224,v228
v_mfma_f32_16x16x32_bf16 v[68:71],a[68:71],v[228:231],v[68:71]
buffer_load_dwordx4 v16,s[20:23],s65 offen offset:0 sc1 lds
v_mfma_f32_16x16x32_bf16 v[76:79],a[196:199],v[228:231],v[76:79]
ds_read_b128 v[224:227],v17 offset:50176
s_waitcnt lgkmcnt(5)
v_mfma_f32_16x16x32_bf16 v[68:71],a[72:75],v[232:235],v[68:71]
buffer_load_dwordx4 v16,s[20:23],s65 offen offset:2048 sc1 lds
v_mfma_f32_16x16x32_bf16 v[76:79],a[200:203],v[232:235],v[76:79]
ds_read_b128 v[228:231],v17 offset:52224
s_xor_b32 m0,s72,33792
v_mfma_f32_16x16x32_bf16 v[68:71],a[76:79],v[236:239],v[68:71]
s_add_u32 s65,s89,65536
v_min3_u32 v27,v27,v232,v236
v_mfma_f32_16x16x32_bf16 v[76:79],a[204:207],v[236:239],v[76:79]
ds_read_b128 v[232:235],v17 offset:54272
s_waitcnt lgkmcnt(5)
v_mfma_f32_16x16x32_bf16 v[68:71],a[80:83],v[240:243],v[68:71]
buffer_load_dwordx4 v16,s[20:23],s65 offen offset:0 sc1 lds
v_mfma_f32_16x16x32_bf16 v[76:79],a[208:211],v[240:243],v[76:79]
ds_read_b128 v[236:239],v17 offset:56320
v_min3_u32 v27,v27,v240,v244
v_mfma_f32_16x16x32_bf16 v[68:71],a[84:87],v[244:247],v[68:71]
buffer_load_dwordx4 v16,s[20:23],s65 offen offset:2048 sc1 lds
v_mfma_f32_16x16x32_bf16 v[76:79],a[212:215],v[244:247],v[76:79]
ds_read_b128 v[240:243],v17 offset:58368
s_waitcnt lgkmcnt(5)
v_mfma_f32_16x16x32_bf16 v[68:71],a[88:91],v[248:251],v[68:71]
s_xor_b32 m0,s72,50176
v_min3_u32 v27,v27,v248,v252
v_mfma_f32_16x16x32_bf16 v[76:79],a[216:219],v[248:251],v[76:79]
ds_read_b128 v[244:247],v17 offset:60416
s_add_u32 s65,s89,98304
v_mfma_f32_16x16x32_bf16 v[68:71],a[92:95],v[252:255],v[68:71]
buffer_load_dwordx4 v16,s[20:23],s65 offen offset:0 sc1 lds
v_mfma_f32_16x16x32_bf16 v[76:79],a[220:223],v[252:255],v[76:79]
ds_read_b128 v[248:251],v17 offset:62464
s_waitcnt lgkmcnt(5)
v_mfma_f32_16x16x32_bf16 v[68:71],a[96:99],v[224:227],v[68:71]
buffer_load_dwordx4 v16,s[20:23],s65 offen offset:2048 sc1 lds
v_mfma_f32_16x16x32_bf16 v[76:79],a[224:227],v[224:227],v[76:79]
ds_read_b128 v[252:255],v17 offset:64512
v_min3_u32 v27,v27,v224,v228
v_mfma_f32_16x16x32_bf16 v[68:71],a[100:103],v[228:231],v[68:71]
v_mov_b32 v100,v108
v_mov_b32 v101,v109
v_mfma_f32_16x16x32_bf16 v[76:79],a[228:231],v[228:231],v[76:79]
v_permlane16_swap_b32 v100,v108
s_waitcnt lgkmcnt(4)
v_mfma_f32_16x16x32_bf16 v[68:71],a[104:107],v[232:235],v[68:71]
v_min3_u32 v27,v27,v232,v236
v_permlane16_swap_b32 v101,v109
v_mfma_f32_16x16x32_bf16 v[76:79],a[232:235],v[232:235],v[76:79]
v_add_f32 v108,v108,v100
v_add_f32 v109,v109,v101
v_mfma_f32_16x16x32_bf16 v[68:71],a[108:111],v[236:239],v[68:71]
v_mov_b32 v100,v108
v_mov_b32 v101,v109
v_mfma_f32_16x16x32_bf16 v[76:79],a[236:239],v[236:239],v[76:79]
v_permlane32_swap_b32 v100,v108
s_waitcnt lgkmcnt(2)
v_mfma_f32_16x16x32_bf16 v[68:71],a[112:115],v[240:243],v[68:71]
v_min3_u32 v27,v27,v240,v244
v_permlane32_swap_b32 v101,v109
v_mfma_f32_16x16x32_bf16 v[76:79],a[240:243],v[240:243],v[76:79]
v_add_f32 v108,v108,v100
v_add_f32 v109,v109,v101
v_mfma_f32_16x16x32_bf16 v[68:71],a[116:119],v[244:247],v[68:71]
v_min3_u32 v27,v27,v120,v122
v_min3_u32 v27,v27,v124,v126
v_mfma_f32_16x16x32_bf16 v[76:79],a[244:247],v[244:247],v[76:79]
v_lshlrev_b32 v32,16,v124
s_waitcnt lgkmcnt(0)
v_mfma_f32_16x16x32_bf16 v[68:71],a[120:123],v[248:251],v[68:71]
v_min3_u32 v27,v27,v248,v252
v_and_b32 v33,s80,v124
v_mfma_f32_16x16x32_bf16 v[76:79],a[248:251],v[248:251],v[76:79]
v_lshlrev_b32 v34,16,v125
v_and_b32 v35,s80,v125
v_mfma_f32_16x16x32_bf16 v[68:71],a[124:127],v[252:255],v[68:71]
v_lshlrev_b32 v36,16,v126
v_and_b32 v37,s80,v126
v_mfma_f32_16x16x32_bf16 v[76:79],a[252:255],v[252:255],v[76:79]
v_lshlrev_b32 v38,16,v127
v_and_b32 v39,s80,v127
v_cmp_eq_u32 vcc,0,v27
s_cbranch_vccnz retry_236
s_branch epi_239
keep_245:
v_mfma_f32_16x16x32_bf16 v[64:67],a[124:127],v[252:255],v[64:67]
v_min3_u32 v27,v27,v248,v252
ds_read_b64 v[126:127],v41 offset:1024
v_mfma_f32_16x16x32_bf16 v[72:75],a[252:255],v[252:255],v[72:75]
ds_read_b128 v[248:251],v17 offset:13312
s_waitcnt lgkmcnt(9)
v_mfma_f32_16x16x32_bf16 v[68:71],a[0:3],v[224:227],0
v_cmp_eq_u32 vcc,0,v27
s_cbranch_vccnz retry_236
v_mfma_f32_16x16x32_bf16 v[76:79],a[128:131],v[224:227],0
ds_read_b128 v[252:255],v17 offset:15360
v_min3_u32 v27,v27,v224,v228
v_mfma_f32_16x16x32_bf16 v[68:71],a[4:7],v[228:231],v[68:71]
v_mfma_f32_16x16x32_bf16 v[76:79],a[132:135],v[228:231],v[76:79]
ds_read_b128 v[224:227],v17 offset:17408
s_waitcnt lgkmcnt(9)
v_mfma_f32_16x16x32_bf16 v[68:71],a[8:11],v[232:235],v[68:71]
v_min3_u32 v27,v27,v232,v236
s_waitcnt lgkmcnt(3)
v_lshlrev_b32 v88,16,v120
v_mfma_f32_16x16x32_bf16 v[76:79],a[136:139],v[232:235],v[76:79]
ds_read_b128 v[228:231],v17 offset:19456
v_and_b32 v89,s80,v120
v_lshlrev_b32 v90,16,v121
v_mfma_f32_16x16x32_bf16 v[68:71],a[12:15],v[236:239],v[68:71]
v_and_b32 v91,s80,v121
v_lshlrev_b32 v92,16,v122
v_and_b32 v93,s80,v122
v_mfma_f32_16x16x32_bf16 v[76:79],a[140:143],v[236:239],v[76:79]
ds_read_b128 v[232:235],v17 offset:21504
v_lshlrev_b32 v94,16,v123
v_mfma_f32_16x16x32_bf16 v[68:71],a[16:19],v[240:243],v[68:71]
v_min3_u32 v27,v27,v240,v244
v_and_b32 v95,s80,v123
v_mfma_f32_16x16x32_bf16 v[76:79],a[144:147],v[240:243],v[76:79]
ds_read_b128 v[236:239],v17 offset:23552
v_add_f32 v88,v64,v88
v_mfma_f32_16x16x32_bf16 v[68:71],a[20:23],v[244:247],v[68:71]
v_add_f32 v89,v65,v89
v_add_f32 v90,v66,v90
v_mfma_f32_16x16x32_bf16 v[76:79],a[148:151],v[244:247],v[76:79]
ds_read_b128 v[240:243],v17 offset:25600
s_waitcnt lgkmcnt(5)
v_mfma_f32_16x16x32_bf16 v[68:71],a[24:27],v[248:251],v[68:71]
v_min3_u32 v27,v27,v248,v252
v_add_f32 v91,v67,v91
v_mfma_f32_16x16x32_bf16 v[76:79],a[152:155],v[248:251],v[76:79]
ds_read_b128 v[244:247],v17 offset:27648
v_add_f32 v92,v72,v92
v_mfma_f32_16x16x32_bf16 v[68:71],a[28:31],v[252:255],v[68:71]
v_add_f32 v93,v73,v93
v_add_f32 v94,v74,v94
v_mfma_f32_16x16x32_bf16 v[76:79],a[156:159],v[252:255],v[76:79]
ds_read_b128 v[248:251],v17 offset:29696
s_waitcnt lgkmcnt(5)
v_mfma_f32_16x16x32_bf16 v[68:71],a[32:35],v[224:227],v[68:71]
v_min3_u32 v27,v27,v224,v228
v_add_f32 v95,v75,v95
v_mfma_f32_16x16x32_bf16 v[76:79],a[160:163],v[224:227],v[76:79]
ds_read_b128 v[252:255],v17 offset:31744
v_cvt_pk_bf16_f32 v96,v88,v89
v_mfma_f32_16x16x32_bf16 v[68:71],a[36:39],v[228:231],v[68:71]
v_cvt_pk_bf16_f32 v97,v90,v91
v_cvt_pk_bf16_f32 v98,v92,v93
v_mfma_f32_16x16x32_bf16 v[76:79],a[164:167],v[228:231],v[76:79]
ds_read_b128 v[224:227],v17 offset:33792
s_waitcnt lgkmcnt(5)
v_mfma_f32_16x16x32_bf16 v[68:71],a[40:43],v[232:235],v[68:71]
v_min3_u32 v27,v27,v232,v236
v_cvt_pk_bf16_f32 v99,v94,v95
v_mfma_f32_16x16x32_bf16 v[76:79],a[168:171],v[232:235],v[76:79]
ds_read_b128 v[228:231],v17 offset:35840
v_max_u32 v96,1,v96
v_mfma_f32_16x16x32_bf16 v[68:71],a[44:47],v[236:239],v[68:71]
buffer_store_dwordx4 v[96:99],v18,s[20:23],s70 offen offset:0 sc1
v_mfma_f32_16x16x32_bf16 v[76:79],a[172:175],v[236:239],v[76:79]
ds_read_b128 v[232:235],v17 offset:37888
s_waitcnt lgkmcnt(5)
v_mfma_f32_16x16x32_bf16 v[68:71],a[48:51],v[240:243],v[68:71]
v_min3_u32 v27,v27,v240,v244
v_lshlrev_b32 v88,16,v96
v_mfma_f32_16x16x32_bf16 v[76:79],a[176:179],v[240:243],v[76:79]
ds_read_b128 v[236:239],v17 offset:39936
v_and_b32 v89,s80,v96
v_mfma_f32_16x16x32_bf16 v[68:71],a[52:55],v[244:247],v[68:71]
v_lshlrev_b32 v90,16,v97
v_and_b32 v91,s80,v97
v_mfma_f32_16x16x32_bf16 v[76:79],a[180:183],v[244:247],v[76:79]
ds_read_b128 v[240:243],v17 offset:41984
s_waitcnt lgkmcnt(5)
v_mfma_f32_16x16x32_bf16 v[68:71],a[56:59],v[248:251],v[68:71]
v_min3_u32 v27,v27,v248,v252
v_lshlrev_b32 v92,16,v98
v_mfma_f32_16x16x32_bf16 v[76:79],a[184:187],v[248:251],v[76:79]
ds_read_b128 v[244:247],v17 offset:44032
v_and_b32 v93,s80,v98
v_mfma_f32_16x16x32_bf16 v[68:71],a[60:63],v[252:255],v[68:71]
v_lshlrev_b32 v94,16,v99
v_and_b32 v95,s80,v99
v_mfma_f32_16x16x32_bf16 v[76:79],a[188:191],v[252:255],v[76:79]
ds_read_b128 v[248:251],v17 offset:46080
s_waitcnt lgkmcnt(5)
v_mfma_f32_16x16x32_bf16 v[68:71],a[64:67],v[224:227],v[68:71]
v_min3_u32 v27,v27,v224,v228
v_add_f32 v108,v88,v89
v_mfma_f32_16x16x32_bf16 v[76:79],a[192:195],v[224:227],v[76:79]
ds_read_b128 v[252:255],v17 offset:48128
v_mul_f32 v109,v88,v88
v_mfma_f32_16x16x32_bf16 v[68:71],a[68:71],v[228:231],v[68:71]
v_add_f32 v100,v90,v91
v_mul_f32 v101,v89,v89
v_mfma_f32_16x16x32_bf16 v[76:79],a[196:199],v[228:231],v[76:79]
ds_read_b128 v[224:227],v17 offset:50176
s_waitcnt lgkmcnt(5)
v_mfma_f32_16x16x32_bf16 v[68:71],a[72:75],v[232:235],v[68:71]
v_min3_u32 v27,v27,v232,v236
v_fmac_f32 v109,v90,v90
v_mfma_f32_16x16x32_bf16 v[76:79],a[200:203],v[232:235],v[76:79]
ds_read_b128 v[228:231],v17 offset:52224
v_fmac_f32 v101,v91,v91
v_mfma_f32_16x16x32_bf16 v[68:71],a[76:79],v[236:239],v[68:71]
v_fmac_f32 v109,v92,v92
v_fmac_f32 v101,v93,v93
v_mfma_f32_16x16x32_bf16 v[76:79],a[204:207],v[236:239],v[76:79]
ds_read_b128 v[232:235],v17 offset:54272
s_waitcnt lgkmcnt(5)
v_mfma_f32_16x16x32_bf16 v[68:71],a[80:83],v[240:243],v[68:71]
v_min3_u32 v27,v27,v240,v244
v_add_f32 v108,v108,v92
v_mfma_f32_16x16x32_bf16 v[76:79],a[208:211],v[240:243],v[76:79]
ds_read_b128 v[236:239],v17 offset:56320
v_add_f32 v100,v100,v93
v_mfma_f32_16x16x32_bf16 v[68:71],a[84:87],v[244:247],v[68:71]
v_fmac_f32 v109,v94,v94
v_fmac_f32 v101,v95,v95
v_mfma_f32_16x16x32_bf16 v[76:79],a[212:215],v[244:247],v[76:79]
ds_read_b128 v[240:243],v17 offset:58368
s_waitcnt lgkmcnt(5)
v_mfma_f32_16x16x32_bf16 v[68:71],a[88:91],v[248:251],v[68:71]
v_min3_u32 v27,v27,v248,v252
v_add_f32 v108,v108,v94
v_mfma_f32_16x16x32_bf16 v[76:79],a[216:219],v[248:251],v[76:79]
ds_read_b128 v[244:247],v17 offset:60416
v_add_f32 v100,v100,v95
v_mfma_f32_16x16x32_bf16 v[68:71],a[92:95],v[252:255],v[68:71]
v_add_f32 v108,v108,v100
v_add_f32 v109,v109,v101
v_mfma_f32_16x16x32_bf16 v[76:79],a[220:223],v[252:255],v[76:79]
ds_read_b128 v[248:251],v17 offset:62464
s_waitcnt lgkmcnt(5)
v_mfma_f32_16x16x32_bf16 v[68:71],a[96:99],v[224:227],v[68:71]
v_min3_u32 v27,v27,v224,v228
v_mov_b32 v100,v108
v_mfma_f32_16x16x32_bf16 v[76:79],a[224:227],v[224:227],v[76:79]
ds_read_b128 v[252:255],v17 offset:64512
v_mov_b32 v101,v109
v_mfma_f32_16x16x32_bf16 v[68:71],a[100:103],v[228:231],v[68:71]
v_permlane16_swap_b32 v100,v108
v_permlane16_swap_b32 v101,v109
v_mfma_f32_16x16x32_bf16 v[76:79],a[228:231],v[228:231],v[76:79]
v_add_f32 v108,v108,v100
s_waitcnt lgkmcnt(4)
v_mfma_f32_16x16x32_bf16 v[68:71],a[104:107],v[232:235],v[68:71]
v_min3_u32 v27,v27,v232,v236
v_add_f32 v109,v109,v101
v_mfma_f32_16x16x32_bf16 v[76:79],a[232:235],v[232:235],v[76:79]
v_mov_b32 v100,v108
v_mov_b32 v101,v109
v_mfma_f32_16x16x32_bf16 v[68:71],a[108:111],v[236:239],v[68:71]
v_permlane32_swap_b32 v100,v108
v_permlane32_swap_b32 v101,v109
v_mfma_f32_16x16x32_bf16 v[76:79],a[236:239],v[236:239],v[76:79]
v_add_f32 v108,v108,v100
s_waitcnt lgkmcnt(2)
v_mfma_f32_16x16x32_bf16 v[68:71],a[112:115],v[240:243],v[68:71]
v_min3_u32 v27,v27,v240,v244
v_add_f32 v109,v109,v101
v_mfma_f32_16x16x32_bf16 v[76:79],a[240:243],v[240:243],v[76:79]
v_min3_u32 v27,v27,v120,v122
v_min3_u32 v27,v27,v124,v126
v_mfma_f32_16x16x32_bf16 v[68:71],a[116:119],v[244:247],v[68:71]
v_lshlrev_b32 v32,16,v124
v_and_b32 v33,s80,v124
v_mfma_f32_16x16x32_bf16 v[76:79],a[244:247],v[244:247],v[76:79]
v_lshlrev_b32 v34,16,v125
s_waitcnt lgkmcnt(0)
v_mfma_f32_16x16x32_bf16 v[68:71],a[120:123],v[248:251],v[68:71]
v_min3_u32 v27,v27,v248,v252
v_and_b32 v35,s80,v125
v_mfma_f32_16x16x32_bf16 v[76:79],a[248:251],v[248:251],v[76:79]
v_lshlrev_b32 v36,16,v126
v_and_b32 v37,s80,v126
v_mfma_f32_16x16x32_bf16 v[68:71],a[124:127],v[252:255],v[68:71]
v_lshlrev_b32 v38,16,v127
v_and_b32 v39,s80,v127
v_mfma_f32_16x16x32_bf16 v[76:79],a[252:255],v[252:255],v[76:79]
v_cmp_eq_u32 vcc,0,v27
s_cbranch_vccnz retry_236
s_branch epi_239
both_240:
s_waitcnt vmcnt(12) lgkmcnt(0)
s_barrier
ds_read_b128 v[224:227],v17 offset:0
ds_read_b128 v[228:231],v17 offset:2048
ds_read_b128 v[232:235],v17 offset:4096
ds_read_b128 v[236:239],v17 offset:6144
ds_read_b128 v[240:243],v17 offset:8192
ds_read_b128 v[244:247],v17 offset:10240
ds_read_b128 v[248:251],v17 offset:12288
s_waitcnt lgkmcnt(5)
v_mfma_f32_16x16x32_bf16 v[64:67],a[0:3],v[224:227],0
s_add_u32 s96,s71,1
s_add_u32 s92,s71,2
v_min_u32 v27,v224,v228
s_add_u32 m0,s43,0
v_mfma_f32_16x16x32_bf16 v[72:75],a[128:131],v[224:227],0
ds_read_b128 v[252:255],v17 offset:14336
s_add_u32 s88,s70,s75
buffer_load_dwordx4 v19,s[20:23],s78 offen sc1 lds
v_mfma_f32_16x16x32_bf16 v[64:67],a[4:7],v[228:231],v[64:67]
s_cmp_eq_u32 s96,65
s_cselect_b32 s96,64,s96
s_add_u32 m0,s43,1024
v_mfma_f32_16x16x32_bf16 v[72:75],a[132:135],v[228:231],v[72:75]
ds_read_b128 v[224:227],v17 offset:16384
buffer_load_dwordx4 v20,s[20:23],s78 offen sc1 lds
s_waitcnt lgkmcnt(5)
v_mfma_f32_16x16x32_bf16 v[64:67],a[8:11],v[232:235],v[64:67]
s_add_u32 s88,s88,2097152
s_xor_b32 s88,s88,0x2000
v_mfma_f32_16x16x32_bf16 v[72:75],a[136:139],v[232:235],v[72:75]
ds_read_b128 v[228:231],v17 offset:18432
s_xor_b32 s89,s88,1024
v_mfma_f32_16x16x32_bf16 v[64:67],a[12:15],v[236:239],v[64:67]
s_xor_b32 m0,s72,0
v_min3_u32 v27,v27,v232,v236
v_mfma_f32_16x16x32_bf16 v[72:75],a[140:143],v[236:239],v[72:75]
ds_read_b128 v[232:235],v17 offset:20480
s_add_u32 s65,s88,0
s_waitcnt lgkmcnt(5)
v_mfma_f32_16x16x32_bf16 v[64:67],a[16:19],v[240:243],v[64:67]
v_min3_u32 v27,v27,v240,v244
v_mfma_f32_16x16x32_bf16 v[72:75],a[144:147],v[240:243],v[72:75]
ds_read_b128 v[236:239],v17 offset:22528
buffer_load_dwordx4 v16,s[20:23],s65 offen offset:0 sc1 lds
v_mfma_f32_16x16x32_bf16 v[64:67],a[20:23],v[244:247],v[64:67]
buffer_load_dwordx4 v16,s[20:23],s65 offen offset:2048 sc1 lds
v_mfma_f32_16x16x32_bf16 v[72:75],a[148:151],v[244:247],v[72:75]
ds_read_b128 v[240:243],v17 offset:24576
s_waitcnt lgkmcnt(5)
v_mfma_f32_16x16x32_bf16 v[64:67],a[24:27],v[248:251],v[64:67]
s_xor_b32 m0,s72,16384
v_min3_u32 v27,v27,v248,v252
v_mfma_f32_16x16x32_bf16 v[72:75],a[152:155],v[248:251],v[72:75]
ds_read_b128 v[244:247],v17 offset:26624
v_mfma_f32_16x16x32_bf16 v[64:67],a[28:31],v[252:255],v[64:67]
s_add_u32 s65,s88,32768
v_mfma_f32_16x16x32_bf16 v[72:75],a[156:159],v[252:255],v[72:75]
ds_read_b128 v[248:251],v17 offset:28672
s_waitcnt lgkmcnt(5)
v_mfma_f32_16x16x32_bf16 v[64:67],a[32:35],v[224:227],v[64:67]
buffer_load_dwordx4 v16,s[20:23],s65 offen offset:0 sc1 lds
v_mfma_f32_16x16x32_bf16 v[72:75],a[160:163],v[224:227],v[72:75]
ds_read_b128 v[252:255],v17 offset:30720
buffer_load_dwordx4 v16,s[20:23],s65 offen offset:2048 sc1 lds
v_mfma_f32_16x16x32_bf16 v[64:67],a[36:39],v[228:231],v[64:67]
v_min3_u32 v27,v27,v224,v228
v_mfma_f32_16x16x32_bf16 v[72:75],a[164:167],v[228:231],v[72:75]
ds_read_b128 v[224:227],v17 offset:32768
s_xor_b32 m0,s72,32768
s_waitcnt lgkmcnt(5)
v_mfma_f32_16x16x32_bf16 v[64:67],a[40:43],v[232:235],v[64:67]
s_add_u32 s65,s88,65536
v_min3_u32 v27,v27,v232,v236
v_mfma_f32_16x16x32_bf16 v[72:75],a[168:171],v[232:235],v[72:75]
ds_read_b128 v[228:231],v17 offset:34816
v_mfma_f32_16x16x32_bf16 v[64:67],a[44:47],v[236:239],v[64:67]
buffer_load_dwordx4 v16,s[20:23],s65 offen offset:0 sc1 lds
v_mfma_f32_16x16x32_bf16 v[72:75],a[172:175],v[236:239],v[72:75]
ds_read_b128 v[232:235],v17 offset:36864
s_waitcnt lgkmcnt(5)
v_mfma_f32_16x16x32_bf16 v[64:67],a[48:51],v[240:243],v[64:67]
buffer_load_dwordx4 v16,s[20:23],s65 offen offset:2048 sc1 lds
v_mfma_f32_16x16x32_bf16 v[72:75],a[176:179],v[240:243],v[72:75]
ds_read_b128 v[236:239],v17 offset:38912
s_xor_b32 m0,s72,49152
v_mfma_f32_16x16x32_bf16 v[64:67],a[52:55],v[244:247],v[64:67]
v_min3_u32 v27,v27,v240,v244
v_mfma_f32_16x16x32_bf16 v[72:75],a[180:183],v[244:247],v[72:75]
ds_read_b128 v[240:243],v17 offset:40960
s_add_u32 s65,s88,98304
s_waitcnt lgkmcnt(5)
v_mfma_f32_16x16x32_bf16 v[64:67],a[56:59],v[248:251],v[64:67]
buffer_load_dwordx4 v16,s[20:23],s65 offen offset:0 sc1 lds
v_min3_u32 v27,v27,v248,v252
v_mfma_f32_16x16x32_bf16 v[72:75],a[184:187],v[248:251],v[72:75]
ds_read_b128 v[244:247],v17 offset:43008
s_waitcnt vmcnt(12)
v_mfma_f32_16x16x32_bf16 v[64:67],a[60:63],v[252:255],v[64:67]
v_cmp_gt_u32 vcc,s96,v29
v_cmp_gt_u32 s[92:93],s92,v29
v_mfma_f32_16x16x32_bf16 v[72:75],a[188:191],v[252:255],v[72:75]
ds_read_b128 v[248:251],v17 offset:45056
s_waitcnt lgkmcnt(5)
v_mfma_f32_16x16x32_bf16 v[64:67],a[64:67],v[224:227],v[64:67]
v_mov_b32 v44,vcc_lo
v_mov_b32 v45,s92
v_min3_u32 v27,v27,v224,v228
v_mfma_f32_16x16x32_bf16 v[72:75],a[192:195],v[224:227],v[72:75]
ds_read_b128 v[252:255],v17 offset:47104
ds_write_b64 v46,v[44:45]
v_mfma_f32_16x16x32_bf16 v[64:67],a[68:71],v[228:231],v[64:67]
buffer_load_dwordx4 v16,s[20:23],s65 offen offset:2048 sc1 lds
v_mfma_f32_16x16x32_bf16 v[72:75],a[196:199],v[228:231],v[72:75]
ds_read_b128 v[224:227],v17 offset:49152
s_waitcnt lgkmcnt(6)
v_mfma_f32_16x16x32_bf16 v[64:67],a[72:75],v[232:235],v[64:67]
s_xor_b32 m0,s72,1024
s_add_u32 s65,s89,0
v_mfma_f32_16x16x32_bf16 v[72:75],a[200:203],v[232:235],v[72:75]
ds_read_b128 v[228:231],v17 offset:51200
v_min3_u32 v27,v27,v232,v236
v_mfma_f32_16x16x32_bf16 v[64:67],a[76:79],v[236:239],v[64:67]
buffer_load_dwordx4 v16,s[20:23],s65 offen offset:0 sc1 lds
v_mfma_f32_16x16x32_bf16 v[72:75],a[204:207],v[236:239],v[72:75]
ds_read_b128 v[232:235],v17 offset:53248
s_waitcnt lgkmcnt(6)
v_mfma_f32_16x16x32_bf16 v[64:67],a[80:83],v[240:243],v[64:67]
buffer_load_dwordx4 v16,s[20:23],s65 offen offset:2048 sc1 lds
v_mfma_f32_16x16x32_bf16 v[72:75],a[208:211],v[240:243],v[72:75]
ds_read_b128 v[236:239],v17 offset:55296
s_xor_b32 m0,s72,17408
v_mfma_f32_16x16x32_bf16 v[64:67],a[84:87],v[244:247],v[64:67]
s_add_u32 s65,s89,32768
v_min3_u32 v27,v27,v240,v244
v_mfma_f32_16x16x32_bf16 v[72:75],a[212:215],v[244:247],v[72:75]
ds_read_b128 v[240:243],v17 offset:57344
s_waitcnt lgkmcnt(6)
v_mfma_f32_16x16x32_bf16 v[64:67],a[88:91],v[248:251],v[64:67]
buffer_load_dwordx4 v16,s[20:23],s65 offen offset:0 sc1 lds
v_mfma_f32_16x16x32_bf16 v[72:75],a[216:219],v[248:251],v[72:75]
ds_read_b128 v[244:247],v17 offset:59392
v_min3_u32 v27,v27,v248,v252
v_mfma_f32_16x16x32_bf16 v[64:67],a[92:95],v[252:255],v[64:67]
buffer_load_dwordx4 v16,s[20:23],s65 offen offset:2048 sc1 lds
v_mfma_f32_16x16x32_bf16 v[72:75],a[220:223],v[252:255],v[72:75]
ds_read_b128 v[248:251],v17 offset:61440
s_waitcnt lgkmcnt(5)
v_mfma_f32_16x16x32_bf16 v[64:67],a[96:99],v[224:227],v[64:67]
s_xor_b32 m0,s72,33792
s_add_u32 s65,s89,65536
v_mfma_f32_16x16x32_bf16 v[72:75],a[224:227],v[224:227],v[72:75]
ds_read_b128 v[252:255],v17 offset:63488
v_min3_u32 v27,v27,v224,v228
v_mfma_f32_16x16x32_bf16 v[64:67],a[100:103],v[228:231],v[64:67]
buffer_load_dwordx4 v16,s[20:23],s65 offen offset:0 sc1 lds
s_waitcnt vmcnt(15)
v_add_u32 v22,s71,-1
v_mfma_f32_16x16x32_bf16 v[72:75],a[228:231],v[228:231],v[72:75]
s_waitcnt vmcnt(19)
s_barrier
ds_read_b64 v[44:45],v47
ds_read_b128 v[224:227],v17 offset:1024
s_waitcnt lgkmcnt(6)
v_mfma_f32_16x16x32_bf16 v[64:67],a[104:107],v[232:235],v[64:67]
buffer_load_dwordx4 v16,s[20:23],s65 offen offset:2048 sc1 lds
buffer_store_dword v22,v23,s[20:23],s97 offen sc1
v_mfma_f32_16x16x32_bf16 v[72:75],a[232:235],v[232:235],v[72:75]
ds_read_b128 v[228:231],v17 offset:3072
s_xor_b32 m0,s72,50176
s_mov_b32 s97,0x7fff0000
v_mfma_f32_16x16x32_bf16 v[64:67],a[108:111],v[236:239],v[64:67]
s_add_u32 s65,s89,98304
v_min3_u32 v27,v27,v232,v236
s_waitcnt vmcnt(15)
v_mfma_f32_16x16x32_bf16 v[72:75],a[236:239],v[236:239],v[72:75]
ds_read_b128 v[232:235],v17 offset:5120
ds_read_b64 v[120:121],v40 offset:0
s_waitcnt lgkmcnt(7)
v_mfma_f32_16x16x32_bf16 v[64:67],a[112:115],v[240:243],v[64:67]
buffer_load_dwordx4 v16,s[20:23],s65 offen offset:0 sc1 lds
ds_read_b64 v[122:123],v41 offset:0
v_mfma_f32_16x16x32_bf16 v[72:75],a[240:243],v[240:243],v[72:75]
ds_read_b128 v[236:239],v17 offset:7168
v_min3_u32 v27,v27,v240,v244
v_mfma_f32_16x16x32_bf16 v[64:67],a[116:119],v[244:247],v[64:67]
buffer_load_dwordx4 v16,s[20:23],s65 offen offset:2048 sc1 lds
v_mfma_f32_16x16x32_bf16 v[72:75],a[244:247],v[244:247],v[72:75]
ds_read_b128 v[240:243],v17 offset:9216
s_waitcnt lgkmcnt(8)
v_mfma_f32_16x16x32_bf16 v[64:67],a[120:123],v[248:251],v[64:67]
s_waitcnt lgkmcnt(7)
v_readfirstlane_b32 s93,v45
v_mfma_f32_16x16x32_bf16 v[72:75],a[248:251],v[248:251],v[72:75]
ds_read_b128 v[244:247],v17 offset:11264
v_min3_u32 v27,v27,v248,v252
v_mfma_f32_16x16x32_bf16 v[64:67],a[124:127],v[252:255],v[64:67]
ds_read_b64 v[124:125],v40 offset:1024
ds_read_b64 v[126:127],v41 offset:1024
v_mfma_f32_16x16x32_bf16 v[72:75],a[252:255],v[252:255],v[72:75]
ds_read_b128 v[248:251],v17 offset:13312
s_waitcnt lgkmcnt(9)
v_mfma_f32_16x16x32_bf16 v[68:71],a[0:3],v[224:227],0
v_cmp_eq_u32 vcc,0,v27
s_cbranch_vccnz retry_236
v_mfma_f32_16x16x32_bf16 v[76:79],a[128:131],v[224:227],0
ds_read_b128 v[252:255],v17 offset:15360
v_min3_u32 v27,v27,v224,v228
v_mfma_f32_16x16x32_bf16 v[68:71],a[4:7],v[228:231],v[68:71]
v_mfma_f32_16x16x32_bf16 v[76:79],a[132:135],v[228:231],v[76:79]
ds_read_b128 v[224:227],v17 offset:17408
s_waitcnt lgkmcnt(7)
v_mfma_f32_16x16x32_bf16 v[68:71],a[8:11],v[232:235],v[68:71]
v_min3_u32 v27,v27,v232,v236
s_waitcnt lgkmcnt(3)
v_lshlrev_b32 v88,16,v120
v_mfma_f32_16x16x32_bf16 v[76:79],a[136:139],v[232:235],v[76:79]
ds_read_b128 v[228:231],v17 offset:19456
v_and_b32 v89,s80,v120
v_lshlrev_b32 v90,16,v121
v_mfma_f32_16x16x32_bf16 v[68:71],a[12:15],v[236:239],v[68:71]
v_and_b32 v91,s80,v121
v_lshlrev_b32 v92,16,v122
v_and_b32 v93,s80,v122
v_mfma_f32_16x16x32_bf16 v[76:79],a[140:143],v[236:239],v[76:79]
ds_read_b128 v[232:235],v17 offset:21504
v_lshlrev_b32 v94,16,v123
v_mfma_f32_16x16x32_bf16 v[68:71],a[16:19],v[240:243],v[68:71]
v_min3_u32 v27,v27,v240,v244
v_and_b32 v95,s80,v123
v_mfma_f32_16x16x32_bf16 v[76:79],a[144:147],v[240:243],v[76:79]
ds_read_b128 v[236:239],v17 offset:23552
v_add_f32 v88,v64,v88
v_mfma_f32_16x16x32_bf16 v[68:71],a[20:23],v[244:247],v[68:71]
v_add_f32 v89,v65,v89
v_add_f32 v90,v66,v90
v_mfma_f32_16x16x32_bf16 v[76:79],a[148:151],v[244:247],v[76:79]
ds_read_b128 v[240:243],v17 offset:25600
s_waitcnt lgkmcnt(5)
v_mfma_f32_16x16x32_bf16 v[68:71],a[24:27],v[248:251],v[68:71]
v_min3_u32 v27,v27,v248,v252
v_add_f32 v91,v67,v91
v_mfma_f32_16x16x32_bf16 v[76:79],a[152:155],v[248:251],v[76:79]
ds_read_b128 v[244:247],v17 offset:27648
v_add_f32 v92,v72,v92
v_mfma_f32_16x16x32_bf16 v[68:71],a[28:31],v[252:255],v[68:71]
v_add_f32 v93,v73,v93
v_add_f32 v94,v74,v94
v_mfma_f32_16x16x32_bf16 v[76:79],a[156:159],v[252:255],v[76:79]
ds_read_b128 v[248:251],v17 offset:29696
s_waitcnt lgkmcnt(5)
v_mfma_f32_16x16x32_bf16 v[68:71],a[32:35],v[224:227],v[68:71]
v_min3_u32 v27,v27,v224,v228
v_add_f32 v95,v75,v95
v_mfma_f32_16x16x32_bf16 v[76:79],a[160:163],v[224:227],v[76:79]
ds_read_b128 v[252:255],v17 offset:31744
v_cvt_pk_bf16_f32 v96,v88,v89
v_mfma_f32_16x16x32_bf16 v[68:71],a[36:39],v[228:231],v[68:71]
v_cvt_pk_bf16_f32 v97,v90,v91
v_cvt_pk_bf16_f32 v98,v92,v93
v_mfma_f32_16x16x32_bf16 v[76:79],a[164:167],v[228:231],v[76:79]
ds_read_b128 v[224:227],v17 offset:33792
s_waitcnt lgkmcnt(5)
v_mfma_f32_16x16x32_bf16 v[68:71],a[40:43],v[232:235],v[68:71]
v_min3_u32 v27,v27,v232,v236
v_cvt_pk_bf16_f32 v99,v94,v95
v_mfma_f32_16x16x32_bf16 v[76:79],a[168:171],v[232:235],v[76:79]
ds_read_b128 v[228:231],v17 offset:35840
v_max_u32 v96,1,v96
v_mfma_f32_16x16x32_bf16 v[68:71],a[44:47],v[236:239],v[68:71]
buffer_store_dwordx4 v[96:99],v18,s[20:23],s70 offen offset:0 sc1
v_mfma_f32_16x16x32_bf16 v[76:79],a[172:175],v[236:239],v[76:79]
ds_read_b128 v[232:235],v17 offset:37888
s_waitcnt lgkmcnt(5)
v_mfma_f32_16x16x32_bf16 v[68:71],a[48:51],v[240:243],v[68:71]
v_min3_u32 v27,v27,v240,v244
v_lshlrev_b32 v88,16,v96
v_mfma_f32_16x16x32_bf16 v[76:79],a[176:179],v[240:243],v[76:79]
ds_read_b128 v[236:239],v17 offset:39936
v_and_b32 v89,s80,v96
v_mfma_f32_16x16x32_bf16 v[68:71],a[52:55],v[244:247],v[68:71]
v_lshlrev_b32 v90,16,v97
v_and_b32 v91,s80,v97
v_mfma_f32_16x16x32_bf16 v[76:79],a[180:183],v[244:247],v[76:79]
ds_read_b128 v[240:243],v17 offset:41984
s_waitcnt lgkmcnt(5)
v_mfma_f32_16x16x32_bf16 v[68:71],a[56:59],v[248:251],v[68:71]
v_min3_u32 v27,v27,v248,v252
v_lshlrev_b32 v92,16,v98
v_mfma_f32_16x16x32_bf16 v[76:79],a[184:187],v[248:251],v[76:79]
ds_read_b128 v[244:247],v17 offset:44032
v_and_b32 v93,s80,v98
v_mfma_f32_16x16x32_bf16 v[68:71],a[60:63],v[252:255],v[68:71]
v_lshlrev_b32 v94,16,v99
v_and_b32 v95,s80,v99
v_mfma_f32_16x16x32_bf16 v[76:79],a[188:191],v[252:255],v[76:79]
ds_read_b128 v[248:251],v17 offset:46080
s_waitcnt lgkmcnt(5)
v_mfma_f32_16x16x32_bf16 v[68:71],a[64:67],v[224:227],v[68:71]
v_min3_u32 v27,v27,v224,v228
v_add_f32 v108,v88,v89
v_mfma_f32_16x16x32_bf16 v[76:79],a[192:195],v[224:227],v[76:79]
ds_read_b128 v[252:255],v17 offset:48128
v_mul_f32 v109,v88,v88
v_mfma_f32_16x16x32_bf16 v[68:71],a[68:71],v[228:231],v[68:71]
v_add_f32 v100,v90,v91
v_mul_f32 v101,v89,v89
v_mfma_f32_16x16x32_bf16 v[76:79],a[196:199],v[228:231],v[76:79]
ds_read_b128 v[224:227],v17 offset:50176
s_waitcnt lgkmcnt(5)
v_mfma_f32_16x16x32_bf16 v[68:71],a[72:75],v[232:235],v[68:71]
v_min3_u32 v27,v27,v232,v236
v_fmac_f32 v109,v90,v90
v_mfma_f32_16x16x32_bf16 v[76:79],a[200:203],v[232:235],v[76:79]
ds_read_b128 v[228:231],v17 offset:52224
v_fmac_f32 v101,v91,v91
v_mfma_f32_16x16x32_bf16 v[68:71],a[76:79],v[236:239],v[68:71]
v_fmac_f32 v109,v92,v92
v_fmac_f32 v101,v93,v93
v_mfma_f32_16x16x32_bf16 v[76:79],a[204:207],v[236:239],v[76:79]
ds_read_b128 v[232:235],v17 offset:54272
s_waitcnt lgkmcnt(5)
v_mfma_f32_16x16x32_bf16 v[68:71],a[80:83],v[240:243],v[68:71]
v_min3_u32 v27,v27,v240,v244
v_add_f32 v108,v108,v92
v_mfma_f32_16x16x32_bf16 v[76:79],a[208:211],v[240:243],v[76:79]
ds_read_b128 v[236:239],v17 offset:56320
v_add_f32 v100,v100,v93
v_mfma_f32_16x16x32_bf16 v[68:71],a[84:87],v[244:247],v[68:71]
v_fmac_f32 v109,v94,v94
v_fmac_f32 v101,v95,v95
v_mfma_f32_16x16x32_bf16 v[76:79],a[212:215],v[244:247],v[76:79]
ds_read_b128 v[240:243],v17 offset:58368
s_waitcnt lgkmcnt(5)
v_mfma_f32_16x16x32_bf16 v[68:71],a[88:91],v[248:251],v[68:71]
v_min3_u32 v27,v27,v248,v252
v_add_f32 v108,v108,v94
v_mfma_f32_16x16x32_bf16 v[76:79],a[216:219],v[248:251],v[76:79]
ds_read_b128 v[244:247],v17 offset:60416
v_add_f32 v100,v100,v95
v_mfma_f32_16x16x32_bf16 v[68:71],a[92:95],v[252:255],v[68:71]
v_add_f32 v108,v108,v100
v_add_f32 v109,v109,v101
v_mfma_f32_16x16x32_bf16 v[76:79],a[220:223],v[252:255],v[76:79]
ds_read_b128 v[248:251],v17 offset:62464
s_waitcnt lgkmcnt(5)
v_mfma_f32_16x16x32_bf16 v[68:71],a[96:99],v[224:227],v[68:71]
v_min3_u32 v27,v27,v224,v228
v_mov_b32 v100,v108
v_mfma_f32_16x16x32_bf16 v[76:79],a[224:227],v[224:227],v[76:79]
ds_read_b128 v[252:255],v17 offset:64512
v_mov_b32 v101,v109
v_mfma_f32_16x16x32_bf16 v[68:71],a[100:103],v[228:231],v[68:71]
v_permlane16_swap_b32 v100,v108
v_permlane16_swap_b32 v101,v109
v_mfma_f32_16x16x32_bf16 v[76:79],a[228:231],v[228:231],v[76:79]
v_add_f32 v108,v108,v100
s_waitcnt lgkmcnt(4)
v_mfma_f32_16x16x32_bf16 v[68:71],a[104:107],v[232:235],v[68:71]
v_min3_u32 v27,v27,v232,v236
v_add_f32 v109,v109,v101
v_mfma_f32_16x16x32_bf16 v[76:79],a[232:235],v[232:235],v[76:79]
v_mov_b32 v100,v108
v_mov_b32 v101,v109
v_mfma_f32_16x16x32_bf16 v[68:71],a[108:111],v[236:239],v[68:71]
v_permlane32_swap_b32 v100,v108
v_permlane32_swap_b32 v101,v109
v_mfma_f32_16x16x32_bf16 v[76:79],a[236:239],v[236:239],v[76:79]
v_add_f32 v108,v108,v100
s_waitcnt lgkmcnt(2)
v_mfma_f32_16x16x32_bf16 v[68:71],a[112:115],v[240:243],v[68:71]
v_min3_u32 v27,v27,v240,v244
v_add_f32 v109,v109,v101
v_mfma_f32_16x16x32_bf16 v[76:79],a[240:243],v[240:243],v[76:79]
v_min3_u32 v27,v27,v120,v122
v_min3_u32 v27,v27,v124,v126
v_mfma_f32_16x16x32_bf16 v[68:71],a[116:119],v[244:247],v[68:71]
v_lshlrev_b32 v32,16,v124
v_and_b32 v33,s80,v124
v_mfma_f32_16x16x32_bf16 v[76:79],a[244:247],v[244:247],v[76:79]
v_lshlrev_b32 v34,16,v125
s_waitcnt lgkmcnt(0)
v_mfma_f32_16x16x32_bf16 v[68:71],a[120:123],v[248:251],v[68:71]
v_min3_u32 v27,v27,v248,v252
v_and_b32 v35,s80,v125
v_mfma_f32_16x16x32_bf16 v[76:79],a[248:251],v[248:251],v[76:79]
v_lshlrev_b32 v36,16,v126
v_and_b32 v37,s80,v126
v_mfma_f32_16x16x32_bf16 v[68:71],a[124:127],v[252:255],v[68:71]
v_lshlrev_b32 v38,16,v127
v_and_b32 v39,s80,v127
v_mfma_f32_16x16x32_bf16 v[76:79],a[252:255],v[252:255],v[76:79]
v_cmp_eq_u32 vcc,0,v27
s_cbranch_vccnz retry_236
epi_239:
buffer_load_dword v29,v21,s[20:23],s87 offen sc1
s_cmp_gt_u32 s71,51
s_cselect_b32 s65,s73,0x7fff0000
s_cselect_b32 s97,0x7fff0000,s73
v_mov_b32 v22,s71
buffer_store_dword v22,v23,s[20:23],s65 offen sc1
v_pk_add_f32 v[88:89],v[68:69],v[32:33]
v_pk_add_f32 v[90:91],v[70:71],v[34:35]
v_pk_add_f32 v[92:93],v[76:77],v[36:37]
v_pk_add_f32 v[94:95],v[78:79],v[38:39]
v_cvt_pk_bf16_f32 v96,v88,v89
v_cvt_pk_bf16_f32 v97,v90,v91
v_cvt_pk_bf16_f32 v98,v92,v93
v_cvt_pk_bf16_f32 v99,v94,v95
v_max_u32 v96,1,v96
buffer_store_dwordx4 v[96:99],v18,s[20:23],s70 offen offset:1024 sc1
v_lshlrev_b32 v88,16,v96
v_and_b32 v89,s80,v96
v_lshlrev_b32 v90,16,v97
v_and_b32 v91,s80,v97
v_lshlrev_b32 v92,16,v98
v_and_b32 v93,s80,v98
v_lshlrev_b32 v94,16,v99
v_and_b32 v95,s80,v99
v_pk_mul_f32 v[102:103],v[88:89],v[88:89]
v_pk_add_f32 v[100:101],v[88:89],v[90:91]
v_pk_mul_f32 v[106:107],v[90:91],v[90:91]
v_pk_add_f32 v[104:105],v[92:93],v[94:95]
v_pk_fma_f32 v[102:103],v[92:93],v[92:93],v[102:103]
v_pk_fma_f32 v[106:107],v[94:95],v[94:95],v[106:107]
v_pk_add_f32 v[100:101],v[100:101],v[104:105]
v_pk_add_f32 v[102:103],v[102:103],v[106:107]
v_add_f32 v110,v100,v101
v_add_f32 v111,v102,v103
v_mov_b32 v100,v110
v_mov_b32 v101,v111
s_nop 0
v_permlane16_swap_b32 v100,v110
v_permlane16_swap_b32 v101,v111
v_add_f32 v110,v110,v100
v_add_f32 v111,v111,v101
v_mov_b32 v100,v110
v_mov_b32 v101,v111
s_nop 0
v_permlane32_swap_b32 v100,v110
v_permlane32_swap_b32 v101,v111
v_add_f32 v110,v110,v100
v_add_f32 v111,v111,v101
v_max_u32 v109,1,v109
buffer_store_dwordx4 v[108:111],v24,s[20:23],s70 offen sc1
v_xor_b32 v19,0x2000,v19
v_xor_b32 v20,0x2000,v20
s_add_u32 s78,s78,2097152
v_xor_b32 v17,0x10000,v17
s_xor_b32 s72,s72,0x10000
s_add_u32 s70,s70,2097152
s_xor_b32 s70,s70,0x2000
s_add_u32 s71,s71,1
s_cmp_le_u32 s71,s57
s_cbranch_scc1 seg_237
s_endpgm
retry_236:
s_sub_u32 s90,s90,64
s_cmp_lt_i32 s90,0
s_cbranch_scc1 giveup_197
s_mov_b32 s83,1
s_waitcnt vmcnt(0) lgkmcnt(0)
s_barrier
s_branch seg_237
r_at_219:
v_mov_b32 v128,0
v_mov_b32 v129,0
v_mov_b32 v130,0
v_mov_b32 v131,0
s_cmp_ge_u32 s50,2
s_cbranch_scc1 r_ln_218
v_and_b32 v21,1,v1
v_mul_u32_u24 v21,64,v21
s_mov_b32 s65,21052928
s_mov_b32 s66,1792
pl_248:
buffer_load_dword v22,v21,s[20:23],s65 offen sc1
s_waitcnt vmcnt(0)
v_cmp_gt_u32 vcc,s66,v22
s_cbranch_vccz pok_249
s_sleep 1
s_sub_u32 s90,s90,1
s_cmp_gt_i32 s90,0
s_cbranch_scc1 pl_248
pok_249:
s_lshl_b32 s41,s41,1
s_add_u32 s41,s41,s50
v_and_b32 v21,3,v1
v_lshlrev_b32 v21,7,v21
s_lshl_b32 s65,s41,2
s_add_u32 s87,s65,s63
v_mov_b32 v99,v21
pl_250:
buffer_load_dword v22,v21,s[20:23],s87 offen sc1
s_waitcnt vmcnt(0)
v_cmp_gt_u32 vcc,14,v22
s_cbranch_vccz pok_251
s_sleep 1
s_sub_u32 s90,s90,1
s_cmp_gt_i32 s90,0
s_cbranch_scc1 pl_250
pok_251:
v_mov_b32 v21,s56
v_lshlrev_b32 v21,2,v21
s_mov_b32 s66,128
pl_252:
buffer_load_dword v22,v21,s[44:47],36 offen sc1
s_waitcnt vmcnt(0)
v_cmp_gt_u32 vcc,s66,v22
s_cbranch_vccz pok_253
s_sleep 1
s_sub_u32 s90,s90,1
s_cmp_gt_i32 s90,0
s_cbranch_scc1 pl_252
pok_253:
s_lshl_b32 s42,s41,14
s_lshr_b32 s43,s41,1
s_lshl_b32 s43,s43,14
s_and_b32 s64,s41,1
s_lshl_b32 s64,s64,12
s_add_u32 s43,s43,s64
s_add_u32 s43,s43,1572864
s_lshl_b32 s73,s41,7
s_add_u32 s73,s73,s63
s_add_u32 s73,s73,16384
v_lshrrev_b32 v6,3,v3
v_and_b32 v7,7,v3
v_lshl_add_u32 v6,v6,4,v7
v_lshlrev_b32 v6,4,v6
v_and_b32 v7,1,v4
v_lshl_add_u32 v6,v7,3,v6
v_lshrrev_b32 v8,2,v3
v_and_b32 v9,3,v3
v_lshl_add_u32 v8,v8,3,v9
s_mov_b32 s80,0x3e0293ee
v_mov_b32 v97,0xff800000
v_lshlrev_b32 v96,10,v1
v_lshlrev_b32 v98,3,v4
v_sub_u32 v98,v98,v8
v_cmp_lt_u32 s[48:49],1,v4
v_cmp_ge_i32 s[4:5],-7,v98
v_cmp_ge_i32 s[6:7],-6,v98
v_cmp_ge_i32 s[8:9],-5,v98
v_cmp_ge_i32 s[10:11],-4,v98
v_cmp_ge_i32 s[12:13],-3,v98
v_cmp_ge_i32 s[14:15],-2,v98
v_cmp_ge_i32 s[16:17],-1,v98
v_cmp_ge_i32 s[18:19],0,v98
v_cmp_ge_i32 s[32:33],1,v98
v_cmp_ge_i32 s[34:35],2,v98
v_cmp_ge_i32 s[36:37],3,v98
v_cmp_ge_i32 s[38:39],4,v98
s_add_u32 s64,s79,0
s_lshl_b32 s74,s64,21
s_lshl_b32 s64,s64,13
s_and_b32 s64,s64,0x2000
s_xor_b32 s64,s64,s61
s_add_u32 s74,s74,s64
s_add_u32 s74,s74,29360128
s_add_u32 s66,s74,s43
kp_254:
s_add_u32 s78,s78,2
buffer_load_dwordx4 v[136:139],v16,s[20:23],s66 offen offset:0 sc1
buffer_load_dwordx4 v[140:143],v16,s[20:23],s66 offen offset:1024 sc1
buffer_load_dwordx4 v[144:147],v16,s[20:23],s66 offen offset:2048 sc1
buffer_load_dwordx4 v[148:151],v16,s[20:23],s66 offen offset:3072 sc1
s_waitcnt vmcnt(0)
kck_256:
v_min3_u32 v22,v136,v140,v144
v_min_u32 v22,v22,v148
v_cmp_eq_u32 vcc,0,v22
s_cbranch_vccz kok_255
s_sleep 1
s_sub_u32 s90,s90,1
s_cmp_gt_i32 s90,0
s_cbranch_scc1 kp_254
kok_255:
s_mov_b32 s78,0
s_add_u32 s64,s79,0
s_lshl_b32 s75,s64,21
s_lshl_b32 s64,s64,13
s_and_b32 s64,s64,0x2000
s_xor_b32 s64,s64,s61
s_add_u32 s75,s75,s64
s_add_u32 s75,s75,29360128
s_add_u32 s64,s79,0
s_lshl_b32 s76,s64,21
s_lshl_b32 s64,s64,13
s_and_b32 s64,s64,0x2000
s_xor_b32 s64,s64,s62
s_add_u32 s76,s76,s64
s_add_u32 s76,s76,29360128
s_add_u32 s77,s75,s43
s_add_u32 s75,s75,s42
s_add_u32 s76,s76,s42
s_add_u32 s65,s75,524288
buffer_load_dwordx4 a[32:35],v16,s[20:23],s65 offen offset:0 sc1
buffer_load_dwordx4 a[36:39],v16,s[20:23],s65 offen offset:1024 sc1
buffer_load_dwordx4 a[40:43],v16,s[20:23],s65 offen offset:2048 sc1
buffer_load_dwordx4 a[44:47],v16,s[20:23],s65 offen offset:3072 sc1
s_add_u32 s65,s75,528384
buffer_load_dwordx4 a[48:51],v16,s[20:23],s65 offen offset:0 sc1
buffer_load_dwordx4 a[52:55],v16,s[20:23],s65 offen offset:1024 sc1
buffer_load_dwordx4 a[56:59],v16,s[20:23],s65 offen offset:2048 sc1
buffer_load_dwordx4 a[60:63],v16,s[20:23],s65 offen offset:3072 sc1
s_add_u32 s65,s76,0
buffer_load_dwordx4 a[0:3],v16,s[20:23],s65 offen offset:0 sc1
buffer_load_dwordx4 a[4:7],v16,s[20:23],s65 offen offset:1024 sc1
buffer_load_dwordx4 a[8:11],v16,s[20:23],s65 offen offset:2048 sc1
buffer_load_dwordx4 a[12:15],v16,s[20:23],s65 offen offset:3072 sc1
s_add_u32 s65,s76,4096
buffer_load_dwordx4 a[16:19],v16,s[20:23],s65 offen offset:0 sc1
buffer_load_dwordx4 a[20:23],v16,s[20:23],s65 offen offset:1024 sc1
buffer_load_dwordx4 a[24:27],v16,s[20:23],s65 offen offset:2048 sc1
buffer_load_dwordx4 a[28:31],v16,s[20:23],s65 offen offset:3072 sc1
s_cmp_lt_u32 s79,60
s_cselect_b32 s78,s78,0
s_cmp_lg_u32 s78,0
s_cselect_b32 s66,0x7fff0000,s77
buffer_load_dwordx4 v[136:139],v16,s[20:23],s66 offen offset:0 sc1
buffer_load_dwordx4 v[140:143],v16,s[20:23],s66 offen offset:1024 sc1
buffer_load_dwordx4 v[144:147],v16,s[20:23],s66 offen offset:2048 sc1
buffer_load_dwordx4 v[148:151],v16,s[20:23],s66 offen offset:3072 sc1
s_add_u32 s65,s75,1048576
buffer_load_dwordx4 a[64:67],v16,s[20:23],s65 offen offset:0 sc1
buffer_load_dwordx4 a[68:71],v16,s[20:23],s65 offen offset:1024 sc1
buffer_load_dwordx4 a[72:75],v16,s[20:23],s65 offen offset:2048 sc1
buffer_load_dwordx4 a[76:79],v16,s[20:23],s65 offen offset:3072 sc1
s_add_u32 s65,s75,1052672
buffer_load_dwordx4 a[80:83],v16,s[20:23],s65 offen offset:0 sc1
buffer_load_dwordx4 a[84:87],v16,s[20:23],s65 offen offset:1024 sc1
buffer_load_dwordx4 a[88:91],v16,s[20:23],s65 offen offset:2048 sc1
buffer_load_dwordx4 a[92:95],v16,s[20:23],s65 offen offset:3072 sc1
s_waitcnt vmcnt(0)
aloop_257:
s_add_u32 s64,s79,0
s_lshl_b32 s74,s64,21
s_lshl_b32 s64,s64,13
s_and_b32 s64,s64,0x2000
s_xor_b32 s64,s64,s61
s_add_u32 s74,s74,s64
s_add_u32 s74,s74,29360128
s_add_u32 s64,s79,0
s_lshl_b32 s70,s64,21
s_lshl_b32 s64,s64,13
s_and_b32 s64,s64,0x2000
s_xor_b32 s64,s64,s62
s_add_u32 s70,s70,s64
s_add_u32 s70,s70,29360128
s_waitcnt vmcnt(21)
v_mfma_f32_16x16x32_bf16 v[168:171],a[32:35],a[0:3],0
v_mfma_f32_16x16x32_bf16 v[172:175],a[36:39],a[0:3],0
v_mfma_f32_16x16x32_bf16 v[180:183],a[32:35],a[4:7],0
v_mfma_f32_16x16x32_bf16 v[184:187],a[36:39],a[4:7],0
v_mfma_f32_16x16x32_bf16 v[168:171],a[40:43],a[8:11],v[168:171]
v_mfma_f32_16x16x32_bf16 v[172:175],a[44:47],a[8:11],v[172:175]
v_mfma_f32_16x16x32_bf16 v[180:183],a[40:43],a[12:15],v[180:183]
v_mfma_f32_16x16x32_bf16 v[184:187],a[44:47],a[12:15],v[184:187]
v_mfma_f32_16x16x32_bf16 v[168:171],a[48:51],a[16:19],v[168:171]
v_mfma_f32_16x16x32_bf16 v[172:175],a[52:55],a[16:19],v[172:175]
v_mfma_f32_16x16x32_bf16 v[180:183],a[48:51],a[20:23],v[180:183]
v_mfma_f32_16x16x32_bf16 v[184:187],a[52:55],a[20:23],v[184:187]
v_mfma_f32_16x16x32_bf16 v[168:171],a[56:59],a[24:27],v[168:171]
v_mfma_f32_16x16x32_bf16 v[172:175],a[60:63],a[24:27],v[172:175]
v_mfma_f32_16x16x32_bf16 v[180:183],a[56:59],a[28:31],v[180:183]
v_mfma_f32_16x16x32_bf16 v[184:187],a[60:63],a[28:31],v[184:187]
s_nop 4
v_cndmask_b32 v168,v97,v168,s[18:19]
s_nop 0
v_cndmask_b32 v180,v97,v180,s[38:39]
v_cndmask_b32 v169,v97,v169,s[16:17]
v_cndmask_b32 v181,v97,v181,s[36:37]
v_cndmask_b32 v170,v97,v170,s[14:15]
v_cndmask_b32 v182,v97,v182,s[34:35]
v_cndmask_b32 v171,v97,v171,s[12:13]
v_cndmask_b32 v183,v97,v183,s[32:33]
v_cndmask_b32 v172,v97,v172,s[10:11]
v_cndmask_b32 v184,v97,v184,s[18:19]
v_cndmask_b32 v173,v97,v173,s[8:9]
v_cndmask_b32 v185,v97,v185,s[16:17]
v_cndmask_b32 v174,v97,v174,s[6:7]
v_cndmask_b32 v186,v97,v186,s[14:15]
v_cndmask_b32 v175,v97,v175,s[4:5]
v_cndmask_b32 v187,v97,v187,s[12:13]
v_max3_f32 v116,v168,v169,v170
v_max3_f32 v122,v180,v181,v182
v_max3_f32 v118,v171,v172,v173
v_max3_f32 v124,v183,v184,v185
v_max3_f32 v116,v116,v174,v175
v_max3_f32 v122,v122,v186,v187
v_max_f32 v116,v116,v118
v_max_f32 v122,v122,v124
v_mov_b32 v118,v116
v_mov_b32 v124,v122
s_nop 0
v_permlane16_swap_b32 v118,v116
v_permlane16_swap_b32 v124,v122
v_max_f32 v116,v116,v118
v_max_f32 v122,v122,v124
v_mov_b32 v118,v116
v_mov_b32 v124,v122
s_nop 0
v_permlane32_swap_b32 v118,v116
v_permlane32_swap_b32 v124,v122
v_max_f32 v116,v116,v118
v_max_f32 v122,v122,v124
v_mul_f32 v116,s80,v116
v_mul_f32 v122,s80,v122
v_fma_f32 v168,v168,s80,-v116
v_fma_f32 v180,v180,s80,-v122
v_fma_f32 v169,v169,s80,-v116
v_fma_f32 v181,v181,s80,-v122
v_fma_f32 v170,v170,s80,-v116
v_fma_f32 v182,v182,s80,-v122
v_fma_f32 v171,v171,s80,-v116
v_fma_f32 v183,v183,s80,-v122
v_fma_f32 v172,v172,s80,-v116
v_fma_f32 v184,v184,s80,-v122
v_fma_f32 v173,v173,s80,-v116
v_fma_f32 v185,v185,s80,-v122
v_fma_f32 v174,v174,s80,-v116
v_fma_f32 v186,v186,s80,-v122
v_fma_f32 v175,v175,s80,-v116
v_fma_f32 v187,v187,s80,-v122
v_exp_f32 v168,v168
v_exp_f32 v180,v180
v_exp_f32 v169,v169
v_exp_f32 v181,v181
v_exp_f32 v170,v170
v_exp_f32 v182,v182
v_exp_f32 v171,v171
v_exp_f32 v183,v183
v_exp_f32 v172,v172
v_exp_f32 v184,v184
v_exp_f32 v173,v173
v_exp_f32 v185,v185
v_exp_f32 v174,v174
v_exp_f32 v186,v186
v_exp_f32 v175,v175
v_exp_f32 v187,v187
v_add_f32 v117,v168,v169
v_add_f32 v123,v180,v181
v_add_f32 v119,v170,v171
v_add_f32 v125,v182,v183
v_add_f32 v117,v117,v172
v_add_f32 v123,v123,v184
v_add_f32 v119,v119,v173
v_add_f32 v125,v125,v185
v_add_f32 v117,v117,v174
v_add_f32 v123,v123,v186
v_add_f32 v119,v119,v175
v_add_f32 v125,v125,v187
v_add_f32 v117,v117,v119
v_add_f32 v123,v123,v125
v_mov_b32 v118,v117
v_mov_b32 v124,v123
s_nop 0
v_permlane16_swap_b32 v118,v117
v_permlane16_swap_b32 v124,v123
v_add_f32 v117,v117,v118
v_add_f32 v123,v123,v124
v_mov_b32 v118,v117
v_mov_b32 v124,v123
s_nop 0
v_permlane32_swap_b32 v118,v117
v_permlane32_swap_b32 v124,v123
v_add_f32 v117,v117,v118
v_add_f32 v123,v123,v124
s_cmp_gt_u32 s71,52
s_cselect_b32 s65,0x7fff0000,s73
s_waitcnt vmcnt(12)
v_add_u32 v22,s71,-1
buffer_store_dword v22,v23,s[20:23],s65 offen sc1
s_add_u32 s66,s74,s43
s_cmp_eq_u32 s78,0
s_cbranch_scc1 kx_261
s_cmp_eq_u32 s84,0
s_cselect_b32 s64,3,0
s_add_u32 s64,s64,s78
kbo_263:
s_sleep 2
s_sub_u32 s64,s64,1
s_cmp_gt_i32 s64,0
s_cbranch_scc1 kbo_263
s_cmp_lt_u32 s84,3
s_cselect_b32 s64,1,0
s_cmp_ge_u32 s84,4
s_subb_u32 s78,s78,2
s_add_u32 s84,s84,1
kpr_262:
s_mov_b64 exec,15
buffer_load_dword v22,v96,s[20:23],s66 offen sc1
s_waitcnt vmcnt(0)
v_cmp_eq_u32 vcc,0,v22
s_mov_b64 exec,-1
s_cbranch_vccz kp_258
s_add_u32 s78,s78,s64
s_mov_b32 s64,1
s_mov_b32 s84,0
s_sleep 1
s_sub_u32 s90,s90,1
s_cmp_gt_i32 s90,0
s_cbranch_scc1 kpr_262
s_branch kp_258
kx_261:
s_mov_b32 s84,0
s_waitcnt vmcnt(9)
s_branch kck_260
kp_258:
s_add_u32 s78,s78,2
buffer_load_dwordx4 v[136:139],v16,s[20:23],s66 offen offset:0 sc1
buffer_load_dwordx4 v[140:143],v16,s[20:23],s66 offen offset:1024 sc1
buffer_load_dwordx4 v[144:147],v16,s[20:23],s66 offen offset:2048 sc1
buffer_load_dwordx4 v[148:151],v16,s[20:23],s66 offen offset:3072 sc1
s_waitcnt vmcnt(0)
kck_260:
v_min3_u32 v22,v136,v140,v144
v_min_u32 v22,v22,v148
v_cmp_eq_u32 vcc,0,v22
s_cbranch_vccz kok_259
s_sleep 1
s_sub_u32 s90,s90,1
s_cmp_gt_i32 s90,0
s_cbranch_scc1 kp_258
kok_259:
s_min_u32 s78,s78,40
buffer_load_dwordx2 v[100:101],v6,s[20:23],s66 offen offset:0 sc1
buffer_load_dwordx2 v[102:103],v6,s[20:23],s66 offen offset:512 sc1
buffer_load_dwordx2 v[104:105],v6,s[20:23],s66 offen offset:1024 sc1
buffer_load_dwordx2 v[106:107],v6,s[20:23],s66 offen offset:1536 sc1
buffer_load_dwordx2 v[108:109],v6,s[20:23],s66 offen offset:2048 sc1
buffer_load_dwordx2 v[110:111],v6,s[20:23],s66 offen offset:2560 sc1
buffer_load_dwordx2 v[112:113],v6,s[20:23],s66 offen offset:3072 sc1
buffer_load_dwordx2 v[114:115],v6,s[20:23],s66 offen offset:3584 sc1
v_mfma_f32_16x16x32_bf16 v[176:179],v[136:139],a[0:3],0
v_mfma_f32_16x16x32_bf16 v[188:191],v[136:139],a[4:7],0
v_mfma_f32_16x16x32_bf16 v[176:179],v[140:143],a[8:11],v[176:179]
v_mfma_f32_16x16x32_bf16 v[188:191],v[140:143],a[12:15],v[188:191]
v_mfma_f32_16x16x32_bf16 v[176:179],v[144:147],a[16:19],v[176:179]
v_mfma_f32_16x16x32_bf16 v[188:191],v[144:147],a[20:23],v[188:191]
v_mfma_f32_16x16x32_bf16 v[176:179],v[148:151],a[24:27],v[176:179]
v_mfma_f32_16x16x32_bf16 v[188:191],v[148:151],a[28:31],v[188:191]
s_cmp_lg_u32 s79,55
s_cbranch_scc1 q2nd_264
pl_265:
buffer_load_dword v98,v99,s[20:23],s87 offen sc1
s_waitcnt vmcnt(0)
v_cmp_gt_u32 vcc,18,v98
s_cbranch_vccz pok_266
s_sleep 1
s_sub_u32 s90,s90,1
s_cmp_gt_i32 s90,0
s_cbranch_scc1 pl_265
pok_266:
q2nd_264:
s_add_u32 s64,s79,1
s_lshl_b32 s75,s64,21
s_lshl_b32 s64,s64,13
s_and_b32 s64,s64,0x2000
s_xor_b32 s64,s64,s61
s_add_u32 s75,s75,s64
s_add_u32 s75,s75,29360128
s_add_u32 s64,s79,1
s_lshl_b32 s76,s64,21
s_lshl_b32 s64,s64,13
s_and_b32 s64,s64,0x2000
s_xor_b32 s64,s64,s62
s_add_u32 s76,s76,s64
s_add_u32 s76,s76,29360128
s_add_u32 s77,s75,s43
s_add_u32 s75,s75,s42
s_add_u32 s76,s76,s42
s_cmp_lt_u32 s79,63
s_cselect_b32 s75,s75,0x7fff0000
s_cselect_b32 s76,s76,0x7fff0000
s_cselect_b32 s77,s77,0x7fff0000
s_add_u32 s65,s75,524288
buffer_load_dwordx4 a[32:35],v16,s[20:23],s65 offen offset:0 sc1
buffer_load_dwordx4 a[36:39],v16,s[20:23],s65 offen offset:1024 sc1
buffer_load_dwordx4 a[40:43],v16,s[20:23],s65 offen offset:2048 sc1
buffer_load_dwordx4 a[44:47],v16,s[20:23],s65 offen offset:3072 sc1
s_add_u32 s65,s75,528384
buffer_load_dwordx4 a[48:51],v16,s[20:23],s65 offen offset:0 sc1
buffer_load_dwordx4 a[52:55],v16,s[20:23],s65 offen offset:1024 sc1
buffer_load_dwordx4 a[56:59],v16,s[20:23],s65 offen offset:2048 sc1
buffer_load_dwordx4 a[60:63],v16,s[20:23],s65 offen offset:3072 sc1
s_add_u32 s65,s76,0
buffer_load_dwordx4 a[0:3],v16,s[20:23],s65 offen offset:0 sc1
buffer_load_dwordx4 a[4:7],v16,s[20:23],s65 offen offset:1024 sc1
buffer_load_dwordx4 a[8:11],v16,s[20:23],s65 offen offset:2048 sc1
buffer_load_dwordx4 a[12:15],v16,s[20:23],s65 offen offset:3072 sc1
s_add_u32 s65,s76,4096
buffer_load_dwordx4 a[16:19],v16,s[20:23],s65 offen offset:0 sc1
buffer_load_dwordx4 a[20:23],v16,s[20:23],s65 offen offset:1024 sc1
buffer_load_dwordx4 a[24:27],v16,s[20:23],s65 offen offset:2048 sc1
buffer_load_dwordx4 a[28:31],v16,s[20:23],s65 offen offset:3072 sc1
v_cndmask_b32 v176,v97,v176,s[48:49]
v_cndmask_b32 v188,v97,v188,s[48:49]
v_cndmask_b32 v177,v97,v177,s[48:49]
v_cndmask_b32 v189,v97,v189,s[48:49]
v_cndmask_b32 v178,v97,v178,s[48:49]
v_cndmask_b32 v190,v97,v190,s[48:49]
v_cndmask_b32 v179,v97,v179,s[48:49]
v_cndmask_b32 v191,v97,v191,s[48:49]
v_max3_f32 v119,v176,v177,v178
v_max3_f32 v125,v188,v189,v190
v_max_f32 v119,v119,v179
v_max_f32 v125,v125,v191
v_mov_b32 v118,v119
v_mov_b32 v124,v125
s_nop 0
v_permlane16_swap_b32 v118,v119
v_permlane16_swap_b32 v124,v125
v_max_f32 v119,v119,v118
v_max_f32 v125,v125,v124
v_mov_b32 v118,v119
v_mov_b32 v124,v125
s_nop 0
v_permlane32_swap_b32 v118,v119
v_permlane32_swap_b32 v124,v125
v_max_f32 v119,v119,v118
v_max_f32 v125,v125,v124
v_mul_f32 v119,s80,v119
v_mul_f32 v125,s80,v125
v_max_f32 v119,v119,v116
v_max_f32 v125,v125,v122
v_fma_f32 v176,v176,s80,-v119
v_fma_f32 v188,v188,s80,-v125
v_fma_f32 v177,v177,s80,-v119
v_fma_f32 v189,v189,s80,-v125
v_fma_f32 v178,v178,s80,-v119
v_fma_f32 v190,v190,s80,-v125
v_fma_f32 v179,v179,s80,-v119
v_fma_f32 v191,v191,s80,-v125
v_sub_f32 v116,v116,v119
v_sub_f32 v122,v122,v125
v_exp_f32 v176,v176
v_exp_f32 v188,v188
v_exp_f32 v177,v177
v_exp_f32 v189,v189
v_exp_f32 v178,v178
v_exp_f32 v190,v190
v_exp_f32 v179,v179
v_exp_f32 v191,v191
v_exp_f32 v116,v116
v_exp_f32 v122,v122
v_add_f32 v120,v176,v177
v_add_f32 v126,v188,v189
v_add_f32 v121,v178,v179
v_add_f32 v127,v190,v191
v_add_f32 v120,v120,v121
v_add_f32 v126,v126,v127
v_mov_b32 v118,v120
v_mov_b32 v124,v126
s_nop 0
v_permlane16_swap_b32 v118,v120
v_permlane16_swap_b32 v124,v126
v_add_f32 v120,v120,v118
v_add_f32 v126,v126,v124
v_mov_b32 v118,v120
v_mov_b32 v124,v126
s_nop 0
v_permlane32_swap_b32 v118,v120
v_permlane32_swap_b32 v124,v126
v_add_f32 v120,v120,v118
v_add_f32 v126,v126,v124
v_fmac_f32 v120,v117,v116
v_fmac_f32 v126,v123,v122
v_rcp_f32 v121,v120
v_rcp_f32 v127,v126
v_mul_f32 v119,v116,v121
v_mul_f32 v125,v122,v127
v_pk_mul_f32 v[168:169],v[168:169],v[118:119] op_sel:[0,1] op_sel_hi:[1,1]
v_pk_mul_f32 v[180:181],v[180:181],v[124:125] op_sel:[0,1] op_sel_hi:[1,1]
v_pk_mul_f32 v[170:171],v[170:171],v[118:119] op_sel:[0,1] op_sel_hi:[1,1]
v_pk_mul_f32 v[182:183],v[182:183],v[124:125] op_sel:[0,1] op_sel_hi:[1,1]
v_pk_mul_f32 v[172:173],v[172:173],v[118:119] op_sel:[0,1] op_sel_hi:[1,1]
v_pk_mul_f32 v[184:185],v[184:185],v[124:125] op_sel:[0,1] op_sel_hi:[1,1]
v_pk_mul_f32 v[174:175],v[174:175],v[118:119] op_sel:[0,1] op_sel_hi:[1,1]
v_pk_mul_f32 v[186:187],v[186:187],v[124:125] op_sel:[0,1] op_sel_hi:[1,1]
v_cvt_pk_bf16_f32 v48,v168,v169
v_cvt_pk_bf16_f32 v56,v180,v181
v_cvt_pk_bf16_f32 v49,v170,v171
v_cvt_pk_bf16_f32 v57,v182,v183
v_cvt_pk_bf16_f32 v50,v172,v173
v_cvt_pk_bf16_f32 v58,v184,v185
v_cvt_pk_bf16_f32 v51,v174,v175
v_cvt_pk_bf16_f32 v59,v186,v187
v_pk_mul_f32 v[176:177],v[176:177],v[120:121] op_sel:[0,1] op_sel_hi:[1,1]
v_pk_mul_f32 v[188:189],v[188:189],v[126:127] op_sel:[0,1] op_sel_hi:[1,1]
v_pk_mul_f32 v[178:179],v[178:179],v[120:121] op_sel:[0,1] op_sel_hi:[1,1]
v_pk_mul_f32 v[190:191],v[190:191],v[126:127] op_sel:[0,1] op_sel_hi:[1,1]
v_cvt_pk_bf16_f32 v52,v176,v177
v_cvt_pk_bf16_f32 v60,v188,v189
v_cvt_pk_bf16_f32 v53,v178,v179
v_cvt_pk_bf16_f32 v61,v190,v191
s_add_u32 s70,s70,s42
s_waitcnt vmcnt(24)
v_mfma_f32_16x16x32_bf16 v[192:195],a[64:67],v[48:51],0
v_mfma_f32_16x16x32_bf16 v[196:199],a[64:67],v[56:59],0
v_mfma_f32_16x16x32_bf16 v[200:203],a[68:71],v[48:51],0
v_mfma_f32_16x16x32_bf16 v[204:207],a[68:71],v[56:59],0
v_mfma_f32_16x16x32_bf16 v[208:211],a[72:75],v[48:51],0
v_mfma_f32_16x16x32_bf16 v[212:215],a[72:75],v[56:59],0
v_mfma_f32_16x16x32_bf16 v[216:219],a[76:79],v[48:51],0
v_mfma_f32_16x16x32_bf16 v[220:223],a[76:79],v[56:59],0
s_waitcnt vmcnt(16)
v_mfma_f32_16x16x16_bf16 v[192:195],v[100:101],v[52:53],v[192:195]
v_mfma_f32_16x16x16_bf16 v[196:199],v[100:101],v[60:61],v[196:199]
v_mfma_f32_16x16x16_bf16 v[200:203],v[102:103],v[52:53],v[200:203]
v_mfma_f32_16x16x16_bf16 v[204:207],v[102:103],v[60:61],v[204:207]
v_mfma_f32_16x16x32_bf16 v[224:227],a[80:83],v[48:51],0
v_mfma_f32_16x16x32_bf16 v[228:231],a[80:83],v[56:59],0
v_mfma_f32_16x16x32_bf16 v[232:235],a[84:87],v[48:51],0
v_mfma_f32_16x16x32_bf16 v[236:239],a[84:87],v[56:59],0
v_mfma_f32_16x16x16_bf16 v[208:211],v[104:105],v[52:53],v[208:211]
s_add_u32 s65,s70,524288
v_mfma_f32_16x16x16_bf16 v[212:215],v[104:105],v[60:61],v[212:215]
v_cvt_pk_bf16_f32 v64,v192,v193
v_cvt_pk_bf16_f32 v65,v194,v195
v_mfma_f32_16x16x16_bf16 v[216:219],v[106:107],v[52:53],v[216:219]
v_cvt_pk_bf16_f32 v66,v200,v201
v_mfma_f32_16x16x16_bf16 v[220:223],v[106:107],v[60:61],v[220:223]
v_cvt_pk_bf16_f32 v67,v202,v203
v_max_u32 v64,1,v64
v_mfma_f32_16x16x32_bf16 v[240:243],a[88:91],v[48:51],0
buffer_store_dwordx4 v[64:67],v16,s[20:23],s65 offen offset:0 sc1
v_cvt_pk_bf16_f32 v68,v196,v197
v_mfma_f32_16x16x32_bf16 v[244:247],a[88:91],v[56:59],0
v_cvt_pk_bf16_f32 v69,v198,v199
v_mfma_f32_16x16x32_bf16 v[248:251],a[92:95],v[48:51],0
v_cvt_pk_bf16_f32 v70,v204,v205
v_cvt_pk_bf16_f32 v71,v206,v207
v_mfma_f32_16x16x32_bf16 v[252:255],a[92:95],v[56:59],0
v_max_u32 v68,1,v68
buffer_store_dwordx4 v[68:71],v16,s[20:23],s65 offen offset:1024 sc1
v_mfma_f32_16x16x16_bf16 v[224:227],v[108:109],v[52:53],v[224:227]
v_cvt_pk_bf16_f32 v72,v208,v209
v_mfma_f32_16x16x16_bf16 v[228:231],v[108:109],v[60:61],v[228:231]
v_cvt_pk_bf16_f32 v73,v210,v211
v_cvt_pk_bf16_f32 v74,v216,v217
v_mfma_f32_16x16x16_bf16 v[232:235],v[110:111],v[52:53],v[232:235]
v_cvt_pk_bf16_f32 v75,v218,v219
v_mfma_f32_16x16x16_bf16 v[236:239],v[110:111],v[60:61],v[236:239]
v_max_u32 v72,1,v72
buffer_store_dwordx4 v[72:75],v16,s[20:23],s65 offen offset:2048 sc1
v_mfma_f32_16x16x16_bf16 v[240:243],v[112:113],v[52:53],v[240:243]
v_cvt_pk_bf16_f32 v76,v212,v213
v_mfma_f32_16x16x16_bf16 v[244:247],v[112:113],v[60:61],v[244:247]
v_cvt_pk_bf16_f32 v77,v214,v215
v_cvt_pk_bf16_f32 v78,v220,v221
v_mfma_f32_16x16x16_bf16 v[248:251],v[114:115],v[52:53],v[248:251]
v_cvt_pk_bf16_f32 v79,v222,v223
v_mfma_f32_16x16x16_bf16 v[252:255],v[114:115],v[60:61],v[252:255]
v_max_u32 v76,1,v76
buffer_store_dwordx4 v[76:79],v16,s[20:23],s65 offen offset:3072 sc1
s_cmp_gt_u32 s71,51
s_cselect_b32 s64,s73,0x7fff0000
v_mov_b32 v22,s71
buffer_store_dword v22,v23,s[20:23],s64 offen sc1
s_add_u32 s65,s70,528384
v_cvt_pk_bf16_f32 v64,v224,v225
v_cvt_pk_bf16_f32 v65,v226,v227
v_cvt_pk_bf16_f32 v66,v232,v233
v_cvt_pk_bf16_f32 v67,v234,v235
v_max_u32 v64,1,v64
buffer_store_dwordx4 v[64:67],v16,s[20:23],s65 offen offset:0 sc1
v_cvt_pk_bf16_f32 v68,v228,v229
v_cvt_pk_bf16_f32 v69,v230,v231
v_cvt_pk_bf16_f32 v70,v236,v237
v_cvt_pk_bf16_f32 v71,v238,v239
v_max_u32 v68,1,v68
buffer_store_dwordx4 v[68:71],v16,s[20:23],s65 offen offset:1024 sc1
v_cvt_pk_bf16_f32 v72,v240,v241
v_cvt_pk_bf16_f32 v73,v242,v243
v_cvt_pk_bf16_f32 v74,v248,v249
v_cvt_pk_bf16_f32 v75,v250,v251
v_max_u32 v72,1,v72
buffer_store_dwordx4 v[72:75],v16,s[20:23],s65 offen offset:2048 sc1
v_cvt_pk_bf16_f32 v76,v244,v245
v_cvt_pk_bf16_f32 v77,v246,v247
v_cvt_pk_bf16_f32 v78,v252,v253
v_cvt_pk_bf16_f32 v79,v254,v255
v_max_u32 v76,1,v76
buffer_store_dwordx4 v[76:79],v16,s[20:23],s65 offen offset:3072 sc1
s_cmp_lt_u32 s79,60
s_cselect_b32 s78,s78,0
s_cmp_lg_u32 s78,0
s_cselect_b32 s66,0x7fff0000,s77
buffer_load_dwordx4 v[136:139],v16,s[20:23],s66 offen offset:0 sc1
buffer_load_dwordx4 v[140:143],v16,s[20:23],s66 offen offset:1024 sc1
buffer_load_dwordx4 v[144:147],v16,s[20:23],s66 offen offset:2048 sc1
buffer_load_dwordx4 v[148:151],v16,s[20:23],s66 offen offset:3072 sc1
s_add_u32 s65,s75,1048576
buffer_load_dwordx4 a[64:67],v16,s[20:23],s65 offen offset:0 sc1
buffer_load_dwordx4 a[68:71],v16,s[20:23],s65 offen offset:1024 sc1
buffer_load_dwordx4 a[72:75],v16,s[20:23],s65 offen offset:2048 sc1
buffer_load_dwordx4 a[76:79],v16,s[20:23],s65 offen offset:3072 sc1
s_add_u32 s65,s75,1052672
buffer_load_dwordx4 a[80:83],v16,s[20:23],s65 offen offset:0 sc1
buffer_load_dwordx4 a[84:87],v16,s[20:23],s65 offen offset:1024 sc1
buffer_load_dwordx4 a[88:91],v16,s[20:23],s65 offen offset:2048 sc1
buffer_load_dwordx4 a[92:95],v16,s[20:23],s65 offen offset:3072 sc1
s_add_u32 s79,s79,1
s_add_u32 s71,s71,1
s_cmp_lt_u32 s79,64
s_cbranch_scc1 aloop_257
s_endpgm
r_ln_218:
v_and_b32 v21,1,v1
v_mul_u32_u24 v21,960,v21
s_mov_b32 s65,21052032
s_mov_b32 s66,1792
pl_267:
buffer_load_dword v22,v21,s[20:23],s65 offen sc1
s_waitcnt vmcnt(0)
v_cmp_gt_u32 vcc,s66,v22
s_cbranch_vccz pok_268
s_sleep 1
s_sub_u32 s90,s90,1
s_cmp_gt_i32 s90,0
s_cbranch_scc1 pl_267
pok_268:
s_lshl_b32 s41,s59,1
s_add_u32 s41,s41,s50
s_sub_u32 s41,s41,2
v_lshlrev_b32 v5,5,v1
s_mov_b32 s64,16384
buffer_load_dwordx4 v[40:43],v5,s[20:23],s64 offen offset:0 sc1
buffer_load_dwordx4 v[44:47],v5,s[20:23],s64 offen offset:16 sc1
buffer_load_dwordx4 v[48:51],v5,s[20:23],s64 offen offset:2048 sc1
buffer_load_dwordx4 v[52:55],v5,s[20:23],s64 offen offset:2064 sc1
s_mov_b32 s64,12288
buffer_load_dwordx4 v[56:59],v5,s[20:23],s64 offen offset:0 sc1
buffer_load_dwordx4 v[60:63],v5,s[20:23],s64 offen offset:16 sc1
buffer_load_dwordx4 v[64:67],v5,s[20:23],s64 offen offset:2048 sc1
buffer_load_dwordx4 v[68:71],v5,s[20:23],s64 offen offset:2064 sc1
s_lshr_b32 s64,s41,2
s_add_u32 s64,s64,64
s_lshl_b32 s64,s64,14
s_and_b32 s65,s41,3
s_lshl_b32 s65,s65,11
s_add_u32 s64,s64,s65
v_add_u32 v19,s64,v16
v_add_u32 v19,786432,v19
s_lshl_b32 s65,s41,7
v_add_u32 v5,s65,v16
v_and_b32 v5,2047,v5
v_add_u32 v17,s64,v5
v_xor_b32 v18,1024,v17
v_add_u32 v24,0xfff00000,v17
v_xor_b32 v25,1024,v24
v_lshlrev_b32 v21,2,v1
s_and_b32 s64,s41,4
s_lshl_b32 s64,s64,6
s_add_u32 s74,s63,s64
s_add_u32 s74,s74,2048
s_mov_b32 s83,1
s_lshl_b32 s73,s41,2
s_add_u32 s73,s73,s63
s_add_u32 s73,s73,2560
v_mov_b32 v8,1
v_mov_b32 v9,1
v_mov_b32 v10,1
v_mov_b32 v11,1
s_add_u32 s64,s62,27262976
s_xor_b32 s65,s62,0x2000
s_add_u32 s65,s65,163577856
buffer_store_dwordx4 v[8:11],v24,s[20:23],s64 offen sc1
buffer_store_dwordx4 v[8:11],v25,s[20:23],s64 offen sc1
buffer_store_dwordx4 v[8:11],v24,s[20:23],s65 offen sc1
buffer_store_dwordx4 v[8:11],v25,s[20:23],s65 offen sc1
s_mov_b32 s82,0x3a800000
s_waitcnt vmcnt(0)
v_add_f32 v40,1.0,v40
v_add_f32 v41,1.0,v41
v_add_f32 v42,1.0,v42
v_add_f32 v43,1.0,v43
v_add_f32 v44,1.0,v44
v_add_f32 v45,1.0,v45
v_add_f32 v46,1.0,v46
v_add_f32 v47,1.0,v47
v_add_f32 v48,1.0,v48
v_add_f32 v49,1.0,v49
v_add_f32 v50,1.0,v50
v_add_f32 v51,1.0,v51
v_add_f32 v52,1.0,v52
v_add_f32 v53,1.0,v53
v_add_f32 v54,1.0,v54
v_add_f32 v55,1.0,v55
s_add_u32 s64,s79,0
s_lshl_b32 s70,s64,21
s_lshl_b32 s64,s64,13
s_and_b32 s64,s64,0x2000
s_xor_b32 s64,s64,s62
s_add_u32 s70,s70,s64
s_add_u32 s70,s70,29360128
lloop_269:
s_add_u32 s75,s70,2097152
s_xor_b32 s75,s75,0x2000
s_add_u32 s96,s71,1
s_cmp_eq_u32 s83,0
s_cbranch_scc1 lahead_272
s_cmp_gt_u32 s71,51
s_cbranch_scc1 xp_270
pl_274:
buffer_load_dword v29,v21,s[20:23],s74 offen sc1
s_waitcnt vmcnt(0)
v_cmp_gt_u32 vcc,s71,v29
s_cbranch_vccz pok_275
s_sleep 1
s_sub_u32 s90,s90,1
s_cmp_gt_i32 s90,0
s_cbranch_scc1 pl_274
pok_275:
xp_270:
buffer_load_dwordx4 v[8:11],v17,s[20:23],s70 offen sc1
buffer_load_dwordx4 v[12:15],v18,s[20:23],s70 offen sc1
s_waitcnt vmcnt(0)
v_min3_u32 v22,v8,v10,v12
v_min_u32 v22,v22,v14
v_cmp_eq_u32 vcc,0,v22
s_cbranch_vccz xk_271
s_sleep 1
s_sub_u32 s90,s90,1
s_cmp_gt_i32 s90,0
s_cbranch_scc1 xp_270
s_branch xk_271
lahead_272:
s_waitcnt vmcnt(6)
v_mov_b32 v8,v104
v_mov_b32 v9,v105
v_mov_b32 v10,v106
v_mov_b32 v11,v107
v_mov_b32 v12,v108
v_mov_b32 v13,v109
v_mov_b32 v14,v110
v_mov_b32 v15,v111
v_min3_u32 v22,v8,v10,v12
v_min_u32 v22,v22,v14
v_cmp_eq_u32 vcc,0,v22
s_cbranch_vccnz xp_270
xk_271:
v_cmp_gt_u32 vcc,s96,v29
s_or_b32 s83,vcc_lo,vcc_hi
s_cselect_b32 s76,0x7fff0000,s75
buffer_load_dwordx4 v[104:107],v17,s[20:23],s76 offen sc1
buffer_load_dwordx4 v[108:111],v18,s[20:23],s76 offen sc1
buffer_load_dword v29,v21,s[20:23],s74 offen sc1
v_lshlrev_b32 v80,16,v8
v_and_b32 v81,s80,v8
v_lshlrev_b32 v82,16,v9
v_and_b32 v83,s80,v9
v_lshlrev_b32 v84,16,v10
v_and_b32 v85,s80,v10
v_lshlrev_b32 v86,16,v11
v_and_b32 v87,s80,v11
v_lshlrev_b32 v88,16,v12
v_and_b32 v89,s80,v12
v_lshlrev_b32 v90,16,v13
v_and_b32 v91,s80,v13
v_lshlrev_b32 v92,16,v14
v_and_b32 v93,s80,v14
v_lshlrev_b32 v94,16,v15
v_and_b32 v95,s80,v15
v_pk_add_f32 v[96:97],v[80:81],v[82:83]
v_pk_mul_f32 v[100:101],v[80:81],v[80:81]
v_pk_add_f32 v[98:99],v[88:89],v[90:91]
v_pk_mul_f32 v[102:103],v[88:89],v[88:89]
v_pk_fma_f32 v[100:101],v[82:83],v[82:83],v[100:101]
v_pk_fma_f32 v[102:103],v[90:91],v[90:91],v[102:103]
v_pk_add_f32 v[96:97],v[96:97],v[84:85]
v_pk_fma_f32 v[100:101],v[84:85],v[84:85],v[100:101]
v_pk_add_f32 v[98:99],v[98:99],v[92:93]
v_pk_fma_f32 v[102:103],v[92:93],v[92:93],v[102:103]
v_pk_add_f32 v[96:97],v[96:97],v[86:87]
v_pk_fma_f32 v[100:101],v[86:87],v[86:87],v[100:101]
v_pk_add_f32 v[98:99],v[98:99],v[94:95]
v_pk_fma_f32 v[102:103],v[94:95],v[94:95],v[102:103]
v_pk_add_f32 v[96:97],v[96:97],v[98:99]
v_pk_add_f32 v[100:101],v[100:101],v[102:103]
v_add_f32 v96,v96,v97
v_add_f32 v97,v100,v101
s_nop 0
v_add_f32_dpp v96,v96,v96 quad_perm:[1,0,3,2] row_mask:0xf bank_mask:0xf
v_add_f32_dpp v97,v97,v97 quad_perm:[1,0,3,2] row_mask:0xf bank_mask:0xf
s_nop 0
v_add_f32_dpp v96,v96,v96 quad_perm:[2,3,0,1] row_mask:0xf bank_mask:0xf
v_add_f32_dpp v97,v97,v97 quad_perm:[2,3,0,1] row_mask:0xf bank_mask:0xf
s_nop 0
v_add_f32_dpp v96,v96,v96 row_half_mirror row_mask:0xf bank_mask:0xf
v_add_f32_dpp v97,v97,v97 row_half_mirror row_mask:0xf bank_mask:0xf
s_nop 0
v_add_f32_dpp v96,v96,v96 row_mirror row_mask:0xf bank_mask:0xf
v_add_f32_dpp v97,v97,v97 row_mirror row_mask:0xf bank_mask:0xf
v_mov_b32 v98,v96
v_mov_b32 v99,v97
s_nop 0
v_permlane16_swap_b32 v98,v96
v_permlane16_swap_b32 v99,v97
v_pk_add_f32 v[96:97],v[96:97],v[98:99]
v_mov_b32 v98,v96
v_mov_b32 v99,v97
s_nop 0
v_permlane32_swap_b32 v98,v96
v_permlane32_swap_b32 v99,v97
v_pk_add_f32 v[96:97],v[96:97],v[98:99]
v_mul_f32 v96,0xba800000,v96
v_mul_f32 v98,v96,v96
v_fma_f32 v98,v97,s82,-v98
v_max_f32 v98,0,v98
v_add_f32 v98,0x3727c5ac,v98
v_rsq_f32 v98,v98
s_nop 0
v_mul_f32 v96,v96,v98
v_pk_fma_f32 v[80:81],v[80:81],v[98:99],v[96:97] op_sel_hi:[1,0,0]
v_pk_fma_f32 v[82:83],v[82:83],v[98:99],v[96:97] op_sel_hi:[1,0,0]
v_pk_fma_f32 v[84:85],v[84:85],v[98:99],v[96:97] op_sel_hi:[1,0,0]
v_pk_fma_f32 v[86:87],v[86:87],v[98:99],v[96:97] op_sel_hi:[1,0,0]
v_pk_fma_f32 v[88:89],v[88:89],v[98:99],v[96:97] op_sel_hi:[1,0,0]
v_pk_fma_f32 v[90:91],v[90:91],v[98:99],v[96:97] op_sel_hi:[1,0,0]
v_pk_fma_f32 v[92:93],v[92:93],v[98:99],v[96:97] op_sel_hi:[1,0,0]
v_pk_fma_f32 v[94:95],v[94:95],v[98:99],v[96:97] op_sel_hi:[1,0,0]
v_pk_fma_f32 v[80:81],v[80:81],v[40:41],v[56:57]
v_pk_fma_f32 v[82:83],v[82:83],v[42:43],v[58:59]
v_pk_fma_f32 v[84:85],v[84:85],v[44:45],v[60:61]
v_pk_fma_f32 v[86:87],v[86:87],v[46:47],v[62:63]
v_pk_fma_f32 v[88:89],v[88:89],v[48:49],v[64:65]
v_pk_fma_f32 v[90:91],v[90:91],v[50:51],v[66:67]
v_pk_fma_f32 v[92:93],v[92:93],v[52:53],v[68:69]
v_pk_fma_f32 v[94:95],v[94:95],v[54:55],v[70:71]
v_cvt_pk_bf16_f32 v8,v80,v81
v_cvt_pk_bf16_f32 v9,v82,v83
v_cvt_pk_bf16_f32 v10,v84,v85
v_cvt_pk_bf16_f32 v11,v86,v87
v_cvt_pk_bf16_f32 v12,v88,v89
v_cvt_pk_bf16_f32 v13,v90,v91
v_cvt_pk_bf16_f32 v14,v92,v93
v_cvt_pk_bf16_f32 v15,v94,v95
v_max_u32 v8,1,v8
v_max_u32 v10,1,v10
v_max_u32 v12,1,v12
v_max_u32 v14,1,v14
s_xor_b32 s78,s70,0x2000
s_waitcnt vmcnt(3)
v_add_u32 v22,s71,-1
buffer_store_dword v22,v23,s[24:27],s73 offen
buffer_store_dword v22,v23,s[28:31],s73 offen sc1
buffer_store_dwordx4 v[8:11],v24,s[20:23],s78 offen sc1
buffer_store_dwordx4 v[12:15],v25,s[20:23],s78 offen sc1
v_lshlrev_b32 v80,16,v8
v_and_b32 v81,s80,v8
v_lshlrev_b32 v82,16,v9
v_and_b32 v83,s80,v9
v_lshlrev_b32 v84,16,v10
v_and_b32 v85,s80,v10
v_lshlrev_b32 v86,16,v11
v_and_b32 v87,s80,v11
v_lshlrev_b32 v88,16,v12
v_and_b32 v89,s80,v12
v_lshlrev_b32 v90,16,v13
v_and_b32 v91,s80,v13
v_lshlrev_b32 v92,16,v14
v_and_b32 v93,s80,v14
v_lshlrev_b32 v94,16,v15
v_and_b32 v95,s80,v15
v_pk_add_f32 v[96:97],v[80:81],v[82:83]
v_pk_mul_f32 v[100:101],v[80:81],v[80:81]
v_pk_add_f32 v[98:99],v[88:89],v[90:91]
v_pk_mul_f32 v[102:103],v[88:89],v[88:89]
v_pk_fma_f32 v[100:101],v[82:83],v[82:83],v[100:101]
v_pk_fma_f32 v[102:103],v[90:91],v[90:91],v[102:103]
v_pk_add_f32 v[96:97],v[96:97],v[84:85]
v_pk_fma_f32 v[100:101],v[84:85],v[84:85],v[100:101]
v_pk_add_f32 v[98:99],v[98:99],v[92:93]
v_pk_fma_f32 v[102:103],v[92:93],v[92:93],v[102:103]
v_pk_add_f32 v[96:97],v[96:97],v[86:87]
v_pk_fma_f32 v[100:101],v[86:87],v[86:87],v[100:101]
v_pk_add_f32 v[98:99],v[98:99],v[94:95]
v_pk_fma_f32 v[102:103],v[94:95],v[94:95],v[102:103]
v_pk_add_f32 v[96:97],v[96:97],v[98:99]
v_pk_add_f32 v[100:101],v[100:101],v[102:103]
v_add_f32 v96,v96,v97
v_add_f32 v97,v100,v101
s_nop 0
v_add_f32_dpp v96,v96,v96 quad_perm:[1,0,3,2] row_mask:0xf bank_mask:0xf
v_add_f32_dpp v97,v97,v97 quad_perm:[1,0,3,2] row_mask:0xf bank_mask:0xf
s_nop 0
v_add_f32_dpp v96,v96,v96 quad_perm:[2,3,0,1] row_mask:0xf bank_mask:0xf
v_add_f32_dpp v97,v97,v97 quad_perm:[2,3,0,1] row_mask:0xf bank_mask:0xf
s_nop 0
v_add_f32_dpp v96,v96,v96 row_half_mirror row_mask:0xf bank_mask:0xf
v_add_f32_dpp v97,v97,v97 row_half_mirror row_mask:0xf bank_mask:0xf
s_nop 0
v_add_f32_dpp v96,v96,v96 row_mirror row_mask:0xf bank_mask:0xf
v_add_f32_dpp v97,v97,v97 row_mirror row_mask:0xf bank_mask:0xf
v_mov_b32 v98,v96
v_mov_b32 v99,v97
s_nop 0
v_permlane16_swap_b32 v98,v96
v_permlane16_swap_b32 v99,v97
v_pk_add_f32 v[96:97],v[96:97],v[98:99]
v_mov_b32 v98,v96
v_mov_b32 v99,v97
s_nop 0
v_permlane32_swap_b32 v98,v96
v_permlane32_swap_b32 v99,v97
v_pk_add_f32 v[96:97],v[96:97],v[98:99]
v_mul_f32 v96,0xba800000,v96
v_mul_f32 v98,v96,v96
v_fma_f32 v98,v97,s82,-v98
v_max_f32 v98,0,v98
v_add_f32 v98,0x3727c5ac,v98
v_rsq_f32 v98,v98
s_nop 0
v_mul_f32 v96,v96,v98
v_pk_fma_f32 v[80:81],v[80:81],v[98:99],v[96:97] op_sel_hi:[1,0,0]
v_pk_fma_f32 v[82:83],v[82:83],v[98:99],v[96:97] op_sel_hi:[1,0,0]
v_pk_fma_f32 v[84:85],v[84:85],v[98:99],v[96:97] op_sel_hi:[1,0,0]
v_pk_fma_f32 v[86:87],v[86:87],v[98:99],v[96:97] op_sel_hi:[1,0,0]
v_pk_fma_f32 v[88:89],v[88:89],v[98:99],v[96:97] op_sel_hi:[1,0,0]
v_pk_fma_f32 v[90:91],v[90:91],v[98:99],v[96:97] op_sel_hi:[1,0,0]
v_pk_fma_f32 v[92:93],v[92:93],v[98:99],v[96:97] op_sel_hi:[1,0,0]
v_pk_fma_f32 v[94:95],v[94:95],v[98:99],v[96:97] op_sel_hi:[1,0,0]
v_cvt_pk_bf16_f32 v72,v80,v81
v_cvt_pk_bf16_f32 v73,v82,v83
v_cvt_pk_bf16_f32 v74,v84,v85
v_cvt_pk_bf16_f32 v75,v86,v87
v_cvt_pk_bf16_f32 v76,v88,v89
v_cvt_pk_bf16_f32 v77,v90,v91
v_cvt_pk_bf16_f32 v78,v92,v93
v_cvt_pk_bf16_f32 v79,v94,v95
v_max_u32 v72,1,v72
v_max_u32 v76,1,v76
buffer_store_dwordx4 v[72:75],v19,s[20:23],s70 offen sc1
buffer_store_dwordx4 v[76:79],v19,s[20:23],s70 offen offset:1024 sc1
s_cmp_gt_u32 s71,51
s_cbranch_scc1 fnow_276
s_cmp_eq_u32 s83,0
s_cbranch_scc1 flater_277
s_waitcnt vmcnt(0)
fnow_276:
v_mov_b32 v22,s71
buffer_store_dword v22,v23,s[24:27],s73 offen
buffer_store_dword v22,v23,s[28:31],s73 offen sc1
flater_277:
s_mov_b32 s70,s75
s_add_u32 s79,s79,1
s_add_u32 s71,s71,1
s_cmp_lt_u32 s79,64
s_cbranch_scc1 lloop_269
s_endpgm
r_wo_214:
s_load_dwordx2 s[4:5],s[0:1],40
s_load_dwordx2 s[6:7],s[0:1],0
s_lshr_b32 s41,s59,3
s_and_b32 s42,s59,7
s_mul_i32 s66,s41,2097152
s_lshl_b32 s64,s42,8
s_add_u32 s66,s66,s64
s_lshl_b32 s67,s50,1
s_and_b32 s64,s41,1
s_add_u32 s67,s67,s64
s_waitcnt lgkmcnt(0)
s_mov_b32 s32,s4
s_and_b32 s33,s5,0xffff
s_mov_b32 s34,0x800000
s_mov_b32 s35,0x20000
s_mov_b32 s36,s6
s_and_b32 s37,s7,0xffff
s_mov_b32 s38,0x400000
s_mov_b32 s39,0x20000
v_lshrrev_b32 v5,2,v3
v_lshl_add_u32 v5,v4,2,v5
v_and_b32 v6,3,v3
v_lshlrev_b32 v6,3,v6
v_lshl_add_u32 v6,v5,8,v6
v_and_b32 v5,7,v5
v_xor_b32 v5,s67,v5
v_lshl_add_u32 v12,v5,5,v6
v_xor_b32 v13,32,v12
v_and_b32 v5,15,v1
v_and_b32 v6,3,v4
v_lshlrev_b32 v6,1,v6
v_xor_b32 v5,v5,v6
v_mul_u32_u24 v6,2048,v4
v_xor_b32 v7,0,v5
v_lshl_add_u32 v8,v7,4,v6
v_xor_b32 v7,8,v5
v_lshl_add_u32 v9,v7,4,v6
s_mul_i32 s74,s50,131072
s_add_u32 s74,s74,s66
s_lshl_b32 s75,s50,14
s_mul_i32 s76,s50,65536
s_add_u32 s76,s76,s66
s_lshl_b32 s77,s50,13
s_add_u32 s64,s74,0
s_add_u32 m0,s75,0
s_nop 0
buffer_load_dwordx4 v8,s[32:35],s64 offen nt lds
s_add_u32 s64,s74,8192
s_add_u32 m0,s75,1024
s_nop 0
buffer_load_dwordx4 v9,s[32:35],s64 offen nt lds
s_add_u32 s64,s74,16384
s_add_u32 m0,s75,2048
s_nop 0
buffer_load_dwordx4 v8,s[32:35],s64 offen nt lds
s_add_u32 s64,s74,24576
s_add_u32 m0,s75,3072
s_nop 0
buffer_load_dwordx4 v9,s[32:35],s64 offen nt lds
s_add_u32 s64,s74,32768
s_add_u32 m0,s75,4096
s_nop 0
buffer_load_dwordx4 v8,s[32:35],s64 offen nt lds
s_add_u32 s64,s74,40960
s_add_u32 m0,s75,5120
s_nop 0
buffer_load_dwordx4 v9,s[32:35],s64 offen nt lds
s_add_u32 s64,s74,49152
s_add_u32 m0,s75,6144
s_nop 0
buffer_load_dwordx4 v8,s[32:35],s64 offen nt lds
s_add_u32 s64,s74,57344
s_add_u32 m0,s75,7168
s_nop 0
buffer_load_dwordx4 v9,s[32:35],s64 offen nt lds
s_add_u32 s64,s74,65536
s_add_u32 m0,s75,8192
s_nop 0
buffer_load_dwordx4 v8,s[32:35],s64 offen nt lds
s_add_u32 s64,s74,73728
s_add_u32 m0,s75,9216
s_nop 0
buffer_load_dwordx4 v9,s[32:35],s64 offen nt lds
s_add_u32 s64,s74,81920
s_add_u32 m0,s75,10240
s_nop 0
buffer_load_dwordx4 v8,s[32:35],s64 offen nt lds
s_add_u32 s64,s74,90112
s_add_u32 m0,s75,11264
s_nop 0
buffer_load_dwordx4 v9,s[32:35],s64 offen nt lds
s_add_u32 s64,s74,98304
s_add_u32 m0,s75,12288
s_nop 0
buffer_load_dwordx4 v8,s[32:35],s64 offen nt lds
s_add_u32 s64,s74,106496
s_add_u32 m0,s75,13312
s_nop 0
buffer_load_dwordx4 v9,s[32:35],s64 offen nt lds
s_add_u32 s64,s74,114688
s_add_u32 m0,s75,14336
s_nop 0
buffer_load_dwordx4 v8,s[32:35],s64 offen nt lds
s_add_u32 s64,s74,122880
s_add_u32 m0,s75,15360
s_nop 0
buffer_load_dwordx4 v9,s[32:35],s64 offen nt lds
s_add_u32 s64,s74,524288
s_add_u32 m0,s75,65536
s_nop 0
buffer_load_dwordx4 v8,s[32:35],s64 offen nt lds
s_add_u32 s64,s74,532480
s_add_u32 m0,s75,66560
s_nop 0
buffer_load_dwordx4 v9,s[32:35],s64 offen nt lds
s_add_u32 s64,s74,540672
s_add_u32 m0,s75,67584
s_nop 0
buffer_load_dwordx4 v8,s[32:35],s64 offen nt lds
s_add_u32 s64,s74,548864
s_add_u32 m0,s75,68608
s_nop 0
buffer_load_dwordx4 v9,s[32:35],s64 offen nt lds
s_add_u32 s64,s74,557056
s_add_u32 m0,s75,69632
s_nop 0
buffer_load_dwordx4 v8,s[32:35],s64 offen nt lds
s_add_u32 s64,s74,565248
s_add_u32 m0,s75,70656
s_nop 0
buffer_load_dwordx4 v9,s[32:35],s64 offen nt lds
s_add_u32 s64,s74,573440
s_add_u32 m0,s75,71680
s_nop 0
buffer_load_dwordx4 v8,s[32:35],s64 offen nt lds
s_add_u32 s64,s74,581632
s_add_u32 m0,s75,72704
s_nop 0
buffer_load_dwordx4 v9,s[32:35],s64 offen nt lds
s_add_u32 s64,s74,589824
s_add_u32 m0,s75,73728
s_nop 0
buffer_load_dwordx4 v8,s[32:35],s64 offen nt lds
s_add_u32 s64,s74,598016
s_add_u32 m0,s75,74752
s_nop 0
buffer_load_dwordx4 v9,s[32:35],s64 offen nt lds
s_add_u32 s64,s74,606208
s_add_u32 m0,s75,75776
s_nop 0
buffer_load_dwordx4 v8,s[32:35],s64 offen nt lds
s_add_u32 s64,s74,614400
s_add_u32 m0,s75,76800
s_nop 0
buffer_load_dwordx4 v9,s[32:35],s64 offen nt lds
s_add_u32 s64,s74,622592
s_add_u32 m0,s75,77824
s_nop 0
buffer_load_dwordx4 v8,s[32:35],s64 offen nt lds
s_add_u32 s64,s74,630784
s_add_u32 m0,s75,78848
s_nop 0
buffer_load_dwordx4 v9,s[32:35],s64 offen nt lds
s_add_u32 s64,s74,638976
s_add_u32 m0,s75,79872
s_nop 0
buffer_load_dwordx4 v8,s[32:35],s64 offen nt lds
s_add_u32 s64,s74,647168
s_add_u32 m0,s75,80896
s_nop 0
buffer_load_dwordx4 v9,s[32:35],s64 offen nt lds
s_waitcnt vmcnt(16)
s_barrier
ds_read_b64_tr_b16 a[0:1],v12 offset:0
ds_read_b64_tr_b16 a[128:129],v13 offset:0
ds_read_b64_tr_b16 a[2:3],v12 offset:4096
ds_read_b64_tr_b16 a[130:131],v13 offset:4096
ds_read_b64_tr_b16 a[4:5],v12 offset:8192
ds_read_b64_tr_b16 a[132:133],v13 offset:8192
ds_read_b64_tr_b16 a[6:7],v12 offset:12288
ds_read_b64_tr_b16 a[134:135],v13 offset:12288
s_waitcnt lgkmcnt(4)
ds_read_b64_tr_b16 a[8:9],v12 offset:16384
ds_read_b64_tr_b16 a[136:137],v13 offset:16384
ds_read_b64_tr_b16 a[10:11],v12 offset:20480
ds_read_b64_tr_b16 a[138:139],v13 offset:20480
ds_read_b64_tr_b16 a[12:13],v12 offset:24576
ds_read_b64_tr_b16 a[140:141],v13 offset:24576
ds_read_b64_tr_b16 a[14:15],v12 offset:28672
ds_read_b64_tr_b16 a[142:143],v13 offset:28672
s_waitcnt lgkmcnt(4)
ds_read_b64_tr_b16 a[16:17],v12 offset:32768
ds_read_b64_tr_b16 a[144:145],v13 offset:32768
ds_read_b64_tr_b16 a[18:19],v12 offset:36864
ds_read_b64_tr_b16 a[146:147],v13 offset:36864
ds_read_b64_tr_b16 a[20:21],v12 offset:40960
ds_read_b64_tr_b16 a[148:149],v13 offset:40960
ds_read_b64_tr_b16 a[22:23],v12 offset:45056
ds_read_b64_tr_b16 a[150:151],v13 offset:45056
s_waitcnt lgkmcnt(4)
ds_read_b64_tr_b16 a[24:25],v12 offset:49152
ds_read_b64_tr_b16 a[152:153],v13 offset:49152
ds_read_b64_tr_b16 a[26:27],v12 offset:53248
ds_read_b64_tr_b16 a[154:155],v13 offset:53248
ds_read_b64_tr_b16 a[28:29],v12 offset:57344
ds_read_b64_tr_b16 a[156:157],v13 offset:57344
ds_read_b64_tr_b16 a[30:31],v12 offset:61440
ds_read_b64_tr_b16 a[158:159],v13 offset:61440
s_waitcnt lgkmcnt(4)
v_xor_b32 v12,0x10000,v12
v_xor_b32 v13,0x10000,v13
s_waitcnt lgkmcnt(0)
s_barrier
s_add_u32 s64,s74,1048576
s_add_u32 m0,s75,0
s_nop 0
buffer_load_dwordx4 v8,s[32:35],s64 offen nt lds
s_add_u32 s64,s74,1056768
s_add_u32 m0,s75,1024
s_nop 0
buffer_load_dwordx4 v9,s[32:35],s64 offen nt lds
s_add_u32 s64,s74,1064960
s_add_u32 m0,s75,2048
s_nop 0
buffer_load_dwordx4 v8,s[32:35],s64 offen nt lds
s_add_u32 s64,s74,1073152
s_add_u32 m0,s75,3072
s_nop 0
buffer_load_dwordx4 v9,s[32:35],s64 offen nt lds
s_add_u32 s64,s74,1081344
s_add_u32 m0,s75,4096
s_nop 0
buffer_load_dwordx4 v8,s[32:35],s64 offen nt lds
s_add_u32 s64,s74,1089536
s_add_u32 m0,s75,5120
s_nop 0
buffer_load_dwordx4 v9,s[32:35],s64 offen nt lds
s_add_u32 s64,s74,1097728
s_add_u32 m0,s75,6144
s_nop 0
buffer_load_dwordx4 v8,s[32:35],s64 offen nt lds
s_add_u32 s64,s74,1105920
s_add_u32 m0,s75,7168
s_nop 0
buffer_load_dwordx4 v9,s[32:35],s64 offen nt lds
s_add_u32 s64,s74,1114112
s_add_u32 m0,s75,8192
s_nop 0
buffer_load_dwordx4 v8,s[32:35],s64 offen nt lds
s_add_u32 s64,s74,1122304
s_add_u32 m0,s75,9216
s_nop 0
buffer_load_dwordx4 v9,s[32:35],s64 offen nt lds
s_add_u32 s64,s74,1130496
s_add_u32 m0,s75,10240
s_nop 0
buffer_load_dwordx4 v8,s[32:35],s64 offen nt lds
s_add_u32 s64,s74,1138688
s_add_u32 m0,s75,11264
s_nop 0
buffer_load_dwordx4 v9,s[32:35],s64 offen nt lds
s_add_u32 s64,s74,1146880
s_add_u32 m0,s75,12288
s_nop 0
buffer_load_dwordx4 v8,s[32:35],s64 offen nt lds
s_add_u32 s64,s74,1155072
s_add_u32 m0,s75,13312
s_nop 0
buffer_load_dwordx4 v9,s[32:35],s64 offen nt lds
s_add_u32 s64,s74,1163264
s_add_u32 m0,s75,14336
s_nop 0
buffer_load_dwordx4 v8,s[32:35],s64 offen nt lds
s_add_u32 s64,s74,1171456
s_add_u32 m0,s75,15360
s_nop 0
buffer_load_dwordx4 v9,s[32:35],s64 offen nt lds
s_waitcnt vmcnt(16)
s_barrier
ds_read_b64_tr_b16 a[32:33],v12 offset:0
ds_read_b64_tr_b16 a[160:161],v13 offset:0
ds_read_b64_tr_b16 a[34:35],v12 offset:4096
ds_read_b64_tr_b16 a[162:163],v13 offset:4096
ds_read_b64_tr_b16 a[36:37],v12 offset:8192
ds_read_b64_tr_b16 a[164:165],v13 offset:8192
ds_read_b64_tr_b16 a[38:39],v12 offset:12288
ds_read_b64_tr_b16 a[166:167],v13 offset:12288
s_waitcnt lgkmcnt(4)
ds_read_b64_tr_b16 a[40:41],v12 offset:16384
ds_read_b64_tr_b16 a[168:169],v13 offset:16384
ds_read_b64_tr_b16 a[42:43],v12 offset:20480
ds_read_b64_tr_b16 a[170:171],v13 offset:20480
ds_read_b64_tr_b16 a[44:45],v12 offset:24576
ds_read_b64_tr_b16 a[172:173],v13 offset:24576
ds_read_b64_tr_b16 a[46:47],v12 offset:28672
ds_read_b64_tr_b16 a[174:175],v13 offset:28672
s_waitcnt lgkmcnt(4)
ds_read_b64_tr_b16 a[48:49],v12 offset:32768
ds_read_b64_tr_b16 a[176:177],v13 offset:32768
ds_read_b64_tr_b16 a[50:51],v12 offset:36864
ds_read_b64_tr_b16 a[178:179],v13 offset:36864
ds_read_b64_tr_b16 a[52:53],v12 offset:40960
ds_read_b64_tr_b16 a[180:181],v13 offset:40960
ds_read_b64_tr_b16 a[54:55],v12 offset:45056
ds_read_b64_tr_b16 a[182:183],v13 offset:45056
s_waitcnt lgkmcnt(4)
ds_read_b64_tr_b16 a[56:57],v12 offset:49152
ds_read_b64_tr_b16 a[184:185],v13 offset:49152
ds_read_b64_tr_b16 a[58:59],v12 offset:53248
ds_read_b64_tr_b16 a[186:187],v13 offset:53248
ds_read_b64_tr_b16 a[60:61],v12 offset:57344
ds_read_b64_tr_b16 a[188:189],v13 offset:57344
ds_read_b64_tr_b16 a[62:63],v12 offset:61440
ds_read_b64_tr_b16 a[190:191],v13 offset:61440
s_waitcnt lgkmcnt(4)
v_xor_b32 v12,0x10000,v12
v_xor_b32 v13,0x10000,v13
s_waitcnt lgkmcnt(0)
s_barrier
s_add_u32 s64,s74,1572864
s_add_u32 m0,s75,65536
s_nop 0
buffer_load_dwordx4 v8,s[32:35],s64 offen nt lds
s_add_u32 s64,s74,1581056
s_add_u32 m0,s75,66560
s_nop 0
buffer_load_dwordx4 v9,s[32:35],s64 offen nt lds
s_add_u32 s64,s74,1589248
s_add_u32 m0,s75,67584
s_nop 0
buffer_load_dwordx4 v8,s[32:35],s64 offen nt lds
s_add_u32 s64,s74,1597440
s_add_u32 m0,s75,68608
s_nop 0
buffer_load_dwordx4 v9,s[32:35],s64 offen nt lds
s_add_u32 s64,s74,1605632
s_add_u32 m0,s75,69632
s_nop 0
buffer_load_dwordx4 v8,s[32:35],s64 offen nt lds
s_add_u32 s64,s74,1613824
s_add_u32 m0,s75,70656
s_nop 0
buffer_load_dwordx4 v9,s[32:35],s64 offen nt lds
s_add_u32 s64,s74,1622016
s_add_u32 m0,s75,71680
s_nop 0
buffer_load_dwordx4 v8,s[32:35],s64 offen nt lds
s_add_u32 s64,s74,1630208
s_add_u32 m0,s75,72704
s_nop 0
buffer_load_dwordx4 v9,s[32:35],s64 offen nt lds
s_add_u32 s64,s74,1638400
s_add_u32 m0,s75,73728
s_nop 0
buffer_load_dwordx4 v8,s[32:35],s64 offen nt lds
s_add_u32 s64,s74,1646592
s_add_u32 m0,s75,74752
s_nop 0
buffer_load_dwordx4 v9,s[32:35],s64 offen nt lds
s_add_u32 s64,s74,1654784
s_add_u32 m0,s75,75776
s_nop 0
buffer_load_dwordx4 v8,s[32:35],s64 offen nt lds
s_add_u32 s64,s74,1662976
s_add_u32 m0,s75,76800
s_nop 0
buffer_load_dwordx4 v9,s[32:35],s64 offen nt lds
s_add_u32 s64,s74,1671168
s_add_u32 m0,s75,77824
s_nop 0
buffer_load_dwordx4 v8,s[32:35],s64 offen nt lds
s_add_u32 s64,s74,1679360
s_add_u32 m0,s75,78848
s_nop 0
buffer_load_dwordx4 v9,s[32:35],s64 offen nt lds
s_add_u32 s64,s74,1687552
s_add_u32 m0,s75,79872
s_nop 0
buffer_load_dwordx4 v8,s[32:35],s64 offen nt lds
s_add_u32 s64,s74,1695744
s_add_u32 m0,s75,80896
s_nop 0
buffer_load_dwordx4 v9,s[32:35],s64 offen nt lds
s_waitcnt vmcnt(16)
s_barrier
ds_read_b64_tr_b16 a[64:65],v12 offset:0
ds_read_b64_tr_b16 a[192:193],v13 offset:0
ds_read_b64_tr_b16 a[66:67],v12 offset:4096
ds_read_b64_tr_b16 a[194:195],v13 offset:4096
ds_read_b64_tr_b16 a[68:69],v12 offset:8192
ds_read_b64_tr_b16 a[196:197],v13 offset:8192
ds_read_b64_tr_b16 a[70:71],v12 offset:12288
ds_read_b64_tr_b16 a[198:199],v13 offset:12288
s_waitcnt lgkmcnt(4)
ds_read_b64_tr_b16 a[72:73],v12 offset:16384
ds_read_b64_tr_b16 a[200:201],v13 offset:16384
ds_read_b64_tr_b16 a[74:75],v12 offset:20480
ds_read_b64_tr_b16 a[202:203],v13 offset:20480
ds_read_b64_tr_b16 a[76:77],v12 offset:24576
ds_read_b64_tr_b16 a[204:205],v13 offset:24576
ds_read_b64_tr_b16 a[78:79],v12 offset:28672
ds_read_b64_tr_b16 a[206:207],v13 offset:28672
s_waitcnt lgkmcnt(4)
ds_read_b64_tr_b16 a[80:81],v12 offset:32768
ds_read_b64_tr_b16 a[208:209],v13 offset:32768
ds_read_b64_tr_b16 a[82:83],v12 offset:36864
ds_read_b64_tr_b16 a[210:211],v13 offset:36864
ds_read_b64_tr_b16 a[84:85],v12 offset:40960
ds_read_b64_tr_b16 a[212:213],v13 offset:40960
ds_read_b64_tr_b16 a[86:87],v12 offset:45056
ds_read_b64_tr_b16 a[214:215],v13 offset:45056
s_waitcnt lgkmcnt(4)
ds_read_b64_tr_b16 a[88:89],v12 offset:49152
ds_read_b64_tr_b16 a[216:217],v13 offset:49152
ds_read_b64_tr_b16 a[90:91],v12 offset:53248
ds_read_b64_tr_b16 a[218:219],v13 offset:53248
ds_read_b64_tr_b16 a[92:93],v12 offset:57344
ds_read_b64_tr_b16 a[220:221],v13 offset:57344
ds_read_b64_tr_b16 a[94:95],v12 offset:61440
ds_read_b64_tr_b16 a[222:223],v13 offset:61440
s_waitcnt lgkmcnt(4)
v_xor_b32 v12,0x10000,v12
v_xor_b32 v13,0x10000,v13
s_waitcnt lgkmcnt(0)
s_barrier
s_waitcnt vmcnt(0)
s_barrier
ds_read_b64_tr_b16 a[96:97],v12 offset:0
ds_read_b64_tr_b16 a[224:225],v13 offset:0
ds_read_b64_tr_b16 a[98:99],v12 offset:4096
ds_read_b64_tr_b16 a[226:227],v13 offset:4096
ds_read_b64_tr_b16 a[100:101],v12 offset:8192
ds_read_b64_tr_b16 a[228:229],v13 offset:8192
ds_read_b64_tr_b16 a[102:103],v12 offset:12288
ds_read_b64_tr_b16 a[230:231],v13 offset:12288
s_waitcnt lgkmcnt(4)
ds_read_b64_tr_b16 a[104:105],v12 offset:16384
ds_read_b64_tr_b16 a[232:233],v13 offset:16384
ds_read_b64_tr_b16 a[106:107],v12 offset:20480
ds_read_b64_tr_b16 a[234:235],v13 offset:20480
ds_read_b64_tr_b16 a[108:109],v12 offset:24576
ds_read_b64_tr_b16 a[236:237],v13 offset:24576
ds_read_b64_tr_b16 a[110:111],v12 offset:28672
ds_read_b64_tr_b16 a[238:239],v13 offset:28672
s_waitcnt lgkmcnt(4)
ds_read_b64_tr_b16 a[112:113],v12 offset:32768
ds_read_b64_tr_b16 a[240:241],v13 offset:32768
ds_read_b64_tr_b16 a[114:115],v12 offset:36864
ds_read_b64_tr_b16 a[242:243],v13 offset:36864
ds_read_b64_tr_b16 a[116:117],v12 offset:40960
ds_read_b64_tr_b16 a[244:245],v13 offset:40960
ds_read_b64_tr_b16 a[118:119],v12 offset:45056
ds_read_b64_tr_b16 a[246:247],v13 offset:45056
s_waitcnt lgkmcnt(4)
ds_read_b64_tr_b16 a[120:121],v12 offset:49152
ds_read_b64_tr_b16 a[248:249],v13 offset:49152
ds_read_b64_tr_b16 a[122:123],v12 offset:53248
ds_read_b64_tr_b16 a[250:251],v13 offset:53248
ds_read_b64_tr_b16 a[124:125],v12 offset:57344
ds_read_b64_tr_b16 a[252:253],v13 offset:57344
ds_read_b64_tr_b16 a[126:127],v12 offset:61440
ds_read_b64_tr_b16 a[254:255],v13 offset:61440
s_waitcnt lgkmcnt(4)
v_xor_b32 v12,0x10000,v12
v_xor_b32 v13,0x10000,v13
s_waitcnt lgkmcnt(0)
s_barrier
v_and_b32 v21,1,v1
v_mul_u32_u24 v21,960,v21
s_mov_b32 s65,21052032
s_mov_b32 s66,1792
pl_278:
buffer_load_dword v22,v21,s[20:23],s65 offen sc1
s_waitcnt vmcnt(0)
v_cmp_gt_u32 vcc,s66,v22
s_cbranch_vccz pok_279
s_sleep 1
s_sub_u32 s90,s90,1
s_cmp_gt_i32 s90,0
s_cbranch_scc1 pl_278
pok_279:
s_lshr_b32 s43,s41,1
s_and_b32 s48,s41,1
s_lshl_b32 s64,s42,7
s_lshl_b32 s65,s50,5
s_add_u32 s64,s64,s65
s_lshl_b32 s65,s48,4
s_add_u32 s64,s64,s65
v_lshl_add_u32 v5,v4,2,s64
v_lshlrev_b32 v6,2,v5
s_mov_b32 s64,8192
buffer_load_dwordx4 v[52:55],v6,s[20:23],s64 offen sc1
v_lshlrev_b32 v10,1,v5
v_and_b32 v6,3,v1
v_sub_u32 v5,v6,v4
v_lshl_add_u32 v5,v5,3,v10
v_lshrrev_b32 v11,2,v1
v_lshl_add_u32 v40,v6,4,v11
v_lshlrev_b32 v40,2,v40
v_lshl_add_u32 v41,v3,2,v4
v_lshlrev_b32 v41,2,v41
s_lshl_b32 s64,s43,10
v_add_u32 v17,s64,v16
v_xor_b32 v18,1024,v17
s_xor_b32 s64,s64,1024
s_lshr_b32 s65,s50,1
s_and_b32 s66,s50,1
s_lshl_b32 s66,s66,12
s_add_u32 s66,s66,s64
s_lshl_b32 s72,s65,13
s_add_u32 s72,s72,s66
s_add_u32 s72,s72,0x10000
s_lshl_b32 s65,s65,14
s_add_u32 s75,s65,s66
s_add_u32 s75,s75,524288
s_mul_i32 s64,s41,131072
s_add_u32 s75,s75,s64
s_cmp_lt_u32 s50,2
s_cselect_b32 s86,98304,0x40000000
s_lshl_b32 s76,s79,21
s_add_u32 s76,s76,27262976
s_mov_b32 s77,0
s_lshl_b32 s78,s79,16
s_mov_b32 s49,0
s_cmp_eq_u32 s79,0
s_mov_b32 s66,8577024
s_cselect_b32 s66,17825792,s66
s_lshl_b32 s64,s59,14
s_lshl_b32 s65,s50,12
s_add_u32 s65,s65,s66
s_add_u32 s64,s64,s65
v_add_u32 v26,s64,v16
s_lshl_b32 s64,s42,14
s_add_u32 s64,s64,s65
v_add_u32 v25,s64,v16
s_xor_b32 s33,s41,1
s_xor_b32 s34,s41,2
s_xor_b32 s35,s41,3
s_lshl_b32 s33,s33,17
s_lshl_b32 s34,s34,17
s_lshl_b32 s35,s35,17
v_and_b32 v21,7,v1
v_lshlrev_b32 v21,7,v21
v_bfe_u32 v6,v1,3,0
v_lshl_add_u32 v21,v6,2,v21
s_lshl_b32 s74,s41,10
s_add_u32 s74,s74,s63
s_lshl_b32 s64,s60,4
s_add_u32 s74,s74,s64
s_add_u32 s74,s74,16384
v_lshrrev_b32 v6,2,v11
v_and_b32 v7,3,v11
v_lshl_add_u32 v6,v6,1,s43
v_lshl_add_u32 v8,v6,2,v7
v_lshl_add_u32 v8,v8,7,v5
v_and_b32 v8,2047,v8
v_lshl_add_u32 v8,v7,11,v8
v_lshl_add_u32 v7,v7,11,v5
v_lshl_add_u32 v20,v6,13,v7
v_lshl_add_u32 v19,v6,14,v8
v_add_u32 v19,1048576,v19
s_lshl_b32 s73,s59,2
s_add_u32 s73,s73,s50
s_lshl_b32 s73,s73,2
s_add_u32 s73,s73,s63
s_add_u32 s73,s73,2048
s_mov_b32 s48,1
s_waitcnt vmcnt(0)
s_cmp_lg_u32 s56,0
s_cbranch_scc1 kslow_280
s_add_u32 s64,s79,0
s_lshl_b32 s70,s64,21
s_lshl_b32 s64,s64,13
s_and_b32 s64,s64,0x2000
s_xor_b32 s64,s64,s62
s_add_u32 s70,s70,s64
s_add_u32 s70,s70,29360128
s_mov_b32 s83,1
s_mov_b32 s87,s74
s_cmp_eq_u32 s50,0
s_cselect_b32 s74,s74,0x7fff0000
v_mov_b32 v47,132096
s_lshl_b32 s64,s50,3
s_add_u32 s64,s64,132096
v_mov_b32 v46,s64
v_mov_b32 v29,0
s_mov_b32 s97,0x7fff0000
seg_282:
s_cmp_eq_u32 s83,0
s_cbranch_scc1 ahead_283
s_add_u32 s94,s70,s75
s_xor_b32 s95,s94,1024
s_xor_b32 s91,s72,0x10000
s_waitcnt vmcnt(2)
v_cmp_gt_u32 vcc,s71,v29
s_cbranch_vccz nb_286
s_waitcnt vmcnt(0)
v_add_u32 v22,s71,-1
buffer_store_dword v22,v23,s[20:23],s97 offen sc1
s_mov_b32 s97,0x7fff0000
s_cmp_lg_u32 s50,0
s_cbranch_scc1 nb_286
buffer_load_dword v32,v21,s[20:23],s74 offen sc1
s_sleep 2
pl_287:
buffer_load_dword v33,v21,s[20:23],s74 offen sc1
s_waitcnt vmcnt(1)
v_cmp_gt_u32 vcc,s71,v32
v_mov_b32 v29,v32
s_cbranch_vccz pok_288
buffer_load_dword v32,v21,s[20:23],s74 offen sc1
s_waitcnt vmcnt(1)
v_cmp_gt_u32 vcc,s71,v33
v_mov_b32 v29,v33
s_cbranch_vccz pok_288
s_sub_u32 s90,s90,1
s_cmp_gt_i32 s90,0
s_cbranch_scc1 pl_287
pok_288:
nb_286:
s_barrier
s_xor_b32 m0,s91,0
s_add_u32 s65,s94,0
buffer_load_dwordx4 v16,s[20:23],s65 offen offset:0 sc1 lds
buffer_load_dwordx4 v16,s[20:23],s65 offen offset:2048 sc1 lds
s_xor_b32 m0,s91,16384
s_add_u32 s65,s94,32768
buffer_load_dwordx4 v16,s[20:23],s65 offen offset:0 sc1 lds
buffer_load_dwordx4 v16,s[20:23],s65 offen offset:2048 sc1 lds
s_xor_b32 m0,s91,32768
s_add_u32 s65,s94,65536
buffer_load_dwordx4 v16,s[20:23],s65 offen offset:0 sc1 lds
buffer_load_dwordx4 v16,s[20:23],s65 offen offset:2048 sc1 lds
s_xor_b32 m0,s91,49152
s_add_u32 s65,s94,98304
buffer_load_dwordx4 v16,s[20:23],s65 offen offset:0 sc1 lds
buffer_load_dwordx4 v16,s[20:23],s65 offen offset:2048 sc1 lds
s_waitcnt vmcnt(8)
v_add_u32 v22,s71,-1
buffer_store_dword v22,v23,s[20:23],s97 offen sc1
s_mov_b32 s97,0x7fff0000
s_waitcnt vmcnt(7)
s_barrier
ds_read_b128 v[224:227],v18 offset:0
ds_read_b128 v[228:231],v18 offset:2048
ds_read_b128 v[232:235],v18 offset:4096
ds_read_b128 v[236:239],v18 offset:6144
ds_read_b128 v[240:243],v18 offset:8192
ds_read_b128 v[244:247],v18 offset:10240
ds_read_b128 v[248:251],v18 offset:12288
s_waitcnt lgkmcnt(5)
v_mfma_f32_16x16x32_bf16 v[64:67],a[0:3],v[224:227],0
s_xor_b32 m0,s91,1024
s_add_u32 s96,s71,1
v_mfma_f32_16x16x32_bf16 v[68:71],a[128:131],v[224:227],0
ds_read_b128 v[252:255],v18 offset:14336
s_add_u32 s92,s71,2
v_mfma_f32_16x16x32_bf16 v[64:67],a[4:7],v[228:231],v[64:67]
s_add_u32 s65,s95,0
v_min_u32 v27,v224,v228
v_mfma_f32_16x16x32_bf16 v[68:71],a[132:135],v[228:231],v[68:71]
s_waitcnt vmcnt(5)
s_barrier
ds_read_b128 v[224:227],v18 offset:16384
s_waitcnt lgkmcnt(5)
v_mfma_f32_16x16x32_bf16 v[64:67],a[8:11],v[232:235],v[64:67]
buffer_load_dwordx4 v16,s[20:23],s65 offen offset:0 sc1 lds
v_mfma_f32_16x16x32_bf16 v[68:71],a[136:139],v[232:235],v[68:71]
ds_read_b128 v[228:231],v18 offset:18432
v_min3_u32 v27,v27,v232,v236
v_mfma_f32_16x16x32_bf16 v[64:67],a[12:15],v[236:239],v[64:67]
buffer_load_dwordx4 v16,s[20:23],s65 offen offset:2048 sc1 lds
v_mfma_f32_16x16x32_bf16 v[68:71],a[140:143],v[236:239],v[68:71]
ds_read_b128 v[232:235],v18 offset:20480
s_waitcnt lgkmcnt(5)
v_mfma_f32_16x16x32_bf16 v[64:67],a[16:19],v[240:243],v[64:67]
s_xor_b32 m0,s91,17408
v_min3_u32 v27,v27,v240,v244
v_mfma_f32_16x16x32_bf16 v[68:71],a[144:147],v[240:243],v[68:71]
ds_read_b128 v[236:239],v18 offset:22528
v_mfma_f32_16x16x32_bf16 v[64:67],a[20:23],v[244:247],v[64:67]
s_add_u32 s65,s95,32768
v_mfma_f32_16x16x32_bf16 v[68:71],a[148:151],v[244:247],v[68:71]
ds_read_b128 v[240:243],v18 offset:24576
s_waitcnt lgkmcnt(5)
v_mfma_f32_16x16x32_bf16 v[64:67],a[24:27],v[248:251],v[64:67]
buffer_load_dwordx4 v16,s[20:23],s65 offen offset:0 sc1 lds
v_mfma_f32_16x16x32_bf16 v[68:71],a[152:155],v[248:251],v[68:71]
ds_read_b128 v[244:247],v18 offset:26624
v_min3_u32 v27,v27,v248,v252
v_mfma_f32_16x16x32_bf16 v[64:67],a[28:31],v[252:255],v[64:67]
buffer_load_dwordx4 v16,s[20:23],s65 offen offset:2048 sc1 lds
v_mfma_f32_16x16x32_bf16 v[68:71],a[156:159],v[252:255],v[68:71]
ds_read_b128 v[248:251],v18 offset:28672
s_waitcnt lgkmcnt(5)
v_mfma_f32_16x16x32_bf16 v[64:67],a[32:35],v[224:227],v[64:67]
s_xor_b32 m0,s91,33792
v_min3_u32 v27,v27,v224,v228
v_mfma_f32_16x16x32_bf16 v[68:71],a[160:163],v[224:227],v[68:71]
ds_read_b128 v[252:255],v18 offset:30720
v_mfma_f32_16x16x32_bf16 v[64:67],a[36:39],v[228:231],v[64:67]
s_add_u32 s65,s95,65536
s_waitcnt vmcnt(63)
v_mfma_f32_16x16x32_bf16 v[68:71],a[164:167],v[228:231],v[68:71]
s_waitcnt vmcnt(5)
s_barrier
ds_read_b128 v[224:227],v18 offset:32768
s_waitcnt lgkmcnt(5)
v_mfma_f32_16x16x32_bf16 v[64:67],a[40:43],v[232:235],v[64:67]
buffer_load_dwordx4 v16,s[20:23],s65 offen offset:0 sc1 lds
v_min3_u32 v27,v27,v232,v236
v_mfma_f32_16x16x32_bf16 v[68:71],a[168:171],v[232:235],v[68:71]
ds_read_b128 v[228:231],v18 offset:34816
v_cmp_gt_u32 vcc,s96,v29
v_cmp_gt_u32 s[92:93],s92,v29
v_mfma_f32_16x16x32_bf16 v[64:67],a[44:47],v[236:239],v[64:67]
buffer_load_dwordx4 v16,s[20:23],s65 offen offset:2048 sc1 lds
v_mfma_f32_16x16x32_bf16 v[68:71],a[172:175],v[236:239],v[68:71]
ds_read_b128 v[232:235],v18 offset:36864
s_waitcnt lgkmcnt(5)
v_mfma_f32_16x16x32_bf16 v[64:67],a[48:51],v[240:243],v[64:67]
s_xor_b32 m0,s91,50176
v_mov_b32 v44,vcc_lo
v_mov_b32 v45,s92
v_mfma_f32_16x16x32_bf16 v[68:71],a[176:179],v[240:243],v[68:71]
ds_read_b128 v[236:239],v18 offset:38912
ds_write_b64 v46,v[44:45]
v_mfma_f32_16x16x32_bf16 v[64:67],a[52:55],v[244:247],v[64:67]
s_add_u32 s65,s95,98304
v_min3_u32 v27,v27,v240,v244
v_mfma_f32_16x16x32_bf16 v[68:71],a[180:183],v[244:247],v[68:71]
ds_read_b128 v[240:243],v18 offset:40960
s_waitcnt lgkmcnt(6)
v_mfma_f32_16x16x32_bf16 v[64:67],a[56:59],v[248:251],v[64:67]
buffer_load_dwordx4 v16,s[20:23],s65 offen offset:0 sc1 lds
v_mfma_f32_16x16x32_bf16 v[68:71],a[184:187],v[248:251],v[68:71]
ds_read_b128 v[244:247],v18 offset:43008
v_min3_u32 v27,v27,v248,v252
v_mfma_f32_16x16x32_bf16 v[64:67],a[60:63],v[252:255],v[64:67]
buffer_load_dwordx4 v16,s[20:23],s65 offen offset:2048 sc1 lds
v_mfma_f32_16x16x32_bf16 v[68:71],a[188:191],v[252:255],v[68:71]
ds_read_b128 v[248:251],v18 offset:45056
s_waitcnt lgkmcnt(6)
v_mfma_f32_16x16x32_bf16 v[64:67],a[64:67],v[224:227],v[64:67]
v_min3_u32 v27,v27,v224,v228
s_add_u32 s88,s70,s75
v_mfma_f32_16x16x32_bf16 v[68:71],a[192:195],v[224:227],v[68:71]
ds_read_b128 v[252:255],v18 offset:47104
s_add_u32 s88,s88,2097152
v_mfma_f32_16x16x32_bf16 v[64:67],a[68:71],v[228:231],v[64:67]
buffer_load_dwordx2 v[120:121],v20,s[36:39],s78 offen
v_mfma_f32_16x16x32_bf16 v[68:71],a[196:199],v[228:231],v[68:71]
ds_read_b128 v[224:227],v18 offset:49152
s_waitcnt lgkmcnt(6)
v_mfma_f32_16x16x32_bf16 v[64:67],a[72:75],v[232:235],v[64:67]
v_min3_u32 v27,v27,v232,v236
s_xor_b32 s88,s88,0x2000
v_mfma_f32_16x16x32_bf16 v[68:71],a[200:203],v[232:235],v[68:71]
ds_read_b128 v[228:231],v18 offset:51200
s_xor_b32 s89,s88,1024
v_mfma_f32_16x16x32_bf16 v[64:67],a[76:79],v[236:239],v[64:67]
v_mfma_f32_16x16x32_bf16 v[68:71],a[204:207],v[236:239],v[68:71]
ds_read_b128 v[232:235],v18 offset:53248
s_waitcnt lgkmcnt(5)
v_mfma_f32_16x16x32_bf16 v[64:67],a[80:83],v[240:243],v[64:67]
s_waitcnt vmcnt(5)
s_barrier
ds_read_b64 v[44:45],v47
ds_read_b128 v[128:131],v17 offset:0
ds_read_b128 v[132:135],v17 offset:2048
v_mfma_f32_16x16x32_bf16 v[68:71],a[208:211],v[240:243],v[68:71]
ds_read_b128 v[236:239],v18 offset:55296
v_min3_u32 v27,v27,v240,v244
v_mfma_f32_16x16x32_bf16 v[64:67],a[84:87],v[244:247],v[64:67]
ds_read_b128 v[136:139],v17 offset:4096
v_mfma_f32_16x16x32_bf16 v[68:71],a[212:215],v[244:247],v[68:71]
ds_read_b128 v[240:243],v18 offset:57344
s_waitcnt lgkmcnt(9)
v_mfma_f32_16x16x32_bf16 v[64:67],a[88:91],v[248:251],v[64:67]
ds_read_b128 v[140:143],v17 offset:6144
v_min3_u32 v27,v27,v248,v252
v_mfma_f32_16x16x32_bf16 v[68:71],a[216:219],v[248:251],v[68:71]
ds_read_b128 v[244:247],v18 offset:59392
v_mfma_f32_16x16x32_bf16 v[64:67],a[92:95],v[252:255],v[64:67]
ds_read_b128 v[144:147],v17 offset:8192
ds_read_b128 v[148:151],v17 offset:10240
v_mfma_f32_16x16x32_bf16 v[68:71],a[220:223],v[252:255],v[68:71]
ds_read_b128 v[248:251],v18 offset:61440
s_waitcnt lgkmcnt(12)
v_mfma_f32_16x16x32_bf16 v[64:67],a[96:99],v[224:227],v[64:67]
ds_read_b128 v[152:155],v17 offset:12288
s_waitcnt lgkmcnt(11)
v_min3_u32 v27,v27,v224,v228
v_mfma_f32_16x16x32_bf16 v[68:71],a[224:227],v[224:227],v[68:71]
ds_read_b128 v[252:255],v18 offset:63488
v_readfirstlane_b32 s93,v45
v_mfma_f32_16x16x32_bf16 v[64:67],a[100:103],v[228:231],v[64:67]
ds_read_b128 v[156:159],v17 offset:14336
v_readfirstlane_b32 s83,v44
s_cmp_lg_u32 s83,0
s_cbranch_scc0 keep_289
v_mfma_f32_16x16x32_bf16 v[68:71],a[228:231],v[228:231],v[68:71]
s_waitcnt lgkmcnt(10)
v_mfma_f32_16x16x32_bf16 v[64:67],a[104:107],v[232:235],v[64:67]
ds_read_b128 v[160:163],v17 offset:16384
ds_read_b128 v[164:167],v17 offset:18432
v_mfma_f32_16x16x32_bf16 v[68:71],a[232:235],v[232:235],v[68:71]
v_min3_u32 v27,v27,v232,v236
v_mfma_f32_16x16x32_bf16 v[64:67],a[108:111],v[236:239],v[64:67]
ds_read_b128 v[168:171],v17 offset:20480
v_mfma_f32_16x16x32_bf16 v[68:71],a[236:239],v[236:239],v[68:71]
s_waitcnt lgkmcnt(9)
v_mfma_f32_16x16x32_bf16 v[64:67],a[112:115],v[240:243],v[64:67]
ds_read_b128 v[172:175],v17 offset:22528
v_min3_u32 v27,v27,v240,v244
v_mfma_f32_16x16x32_bf16 v[68:71],a[240:243],v[240:243],v[68:71]
v_mfma_f32_16x16x32_bf16 v[64:67],a[116:119],v[244:247],v[64:67]
ds_read_b128 v[176:179],v17 offset:24576
ds_read_b128 v[180:183],v17 offset:26624
v_mfma_f32_16x16x32_bf16 v[68:71],a[244:247],v[244:247],v[68:71]
s_waitcnt lgkmcnt(7)
v_mfma_f32_16x16x32_bf16 v[64:67],a[120:123],v[248:251],v[64:67]
ds_read_b128 v[184:187],v17 offset:28672
v_min3_u32 v27,v27,v248,v252
v_mfma_f32_16x16x32_bf16 v[68:71],a[248:251],v[248:251],v[68:71]
v_mfma_f32_16x16x32_bf16 v[64:67],a[124:127],v[252:255],v[64:67]
ds_read_b128 v[188:191],v17 offset:30720
v_mfma_f32_16x16x32_bf16 v[68:71],a[252:255],v[252:255],v[68:71]
v_mfma_f32_16x16x32_bf16 v[72:75],a[128:131],v[128:131],0
v_cmp_eq_u32 vcc,0,v27
s_cbranch_vccnz retry_281
v_mfma_f32_16x16x32_bf16 v[76:79],a[132:135],v[132:135],0
v_min3_u32 v27,v27,v128,v132
v_mfma_f32_16x16x32_bf16 v[72:75],a[136:139],v[136:139],v[72:75]
s_waitcnt vmcnt(1)
s_barrier
ds_read_b128 v[192:195],v17 offset:32768
v_mfma_f32_16x16x32_bf16 v[76:79],a[140:143],v[140:143],v[76:79]
ds_read_b128 v[196:199],v17 offset:34816
s_waitcnt lgkmcnt(10)
v_mfma_f32_16x16x32_bf16 v[72:75],a[144:147],v[144:147],v[72:75]
ds_read_b128 v[200:203],v17 offset:36864
v_min3_u32 v27,v27,v136,v140
s_waitcnt vmcnt(0)
v_mfma_f32_16x16x32_bf16 v[76:79],a[148:151],v[148:151],v[76:79]
ds_read_b128 v[204:207],v17 offset:38912
v_min3_u32 v27,v27,v144,v148
v_and_or_b32 v64,v64,-4,s48
v_mfma_f32_16x16x32_bf16 v[72:75],a[152:155],v[152:155],v[72:75]
ds_read_b128 v[208:211],v17 offset:40960
s_add_u32 s64,s49,s34
v_mfma_f32_16x16x32_bf16 v[76:79],a[156:159],v[156:159],v[76:79]
v_min3_u32 v27,v27,v152,v156
s_waitcnt lgkmcnt(9)
v_mfma_f32_16x16x32_bf16 v[72:75],a[160:163],v[160:163],v[72:75]
ds_read_b128 v[212:215],v17 offset:43008
buffer_store_dwordx4 v[64:67],v25,s[20:23],s64 offen offset:2048
v_mfma_f32_16x16x32_bf16 v[76:79],a[164:167],v[164:167],v[76:79]
ds_read_b128 v[216:219],v17 offset:45056
v_min3_u32 v27,v27,v160,v164
v_and_or_b32 v68,v68,-4,s48
v_mfma_f32_16x16x32_bf16 v[72:75],a[168:171],v[168:171],v[72:75]
ds_read_b128 v[220:223],v17 offset:47104
s_add_u32 s64,s49,s35
v_mfma_f32_16x16x32_bf16 v[76:79],a[172:175],v[172:175],v[76:79]
ds_read_b128 v[224:227],v17 offset:49152
s_waitcnt lgkmcnt(9)
v_mfma_f32_16x16x32_bf16 v[72:75],a[176:179],v[176:179],v[72:75]
ds_read_b128 v[228:231],v17 offset:51200
v_min3_u32 v27,v27,v168,v172
v_mfma_f32_16x16x32_bf16 v[76:79],a[180:183],v[180:183],v[76:79]
v_min3_u32 v27,v27,v176,v180
buffer_store_dwordx4 v[68:71],v25,s[20:23],s64 offen offset:3072
v_mfma_f32_16x16x32_bf16 v[72:75],a[184:187],v[184:187],v[72:75]
ds_read_b128 v[232:235],v17 offset:53248
s_mov_b32 s49,0x7fff0000
v_mfma_f32_16x16x32_bf16 v[76:79],a[188:191],v[188:191],v[76:79]
ds_read_b128 v[236:239],v17 offset:55296
s_waitcnt lgkmcnt(8)
v_mfma_f32_16x16x32_bf16 v[72:75],a[192:195],v[192:195],v[72:75]
ds_read_b128 v[240:243],v17 offset:57344
v_min3_u32 v27,v27,v184,v188
v_mfma_f32_16x16x32_bf16 v[76:79],a[196:199],v[196:199],v[76:79]
ds_read_b128 v[244:247],v17 offset:59392
v_min3_u32 v27,v27,v192,v196
v_mfma_f32_16x16x32_bf16 v[72:75],a[200:203],v[200:203],v[72:75]
ds_read_b128 v[248:251],v17 offset:61440
ds_bpermute_b32 v124,v41,v120
v_mfma_f32_16x16x32_bf16 v[76:79],a[204:207],v[204:207],v[76:79]
v_min3_u32 v27,v27,v200,v204
s_waitcnt lgkmcnt(8)
v_mfma_f32_16x16x32_bf16 v[72:75],a[208:211],v[208:211],v[72:75]
ds_read_b128 v[252:255],v17 offset:63488
ds_bpermute_b32 v125,v41,v121
v_mfma_f32_16x16x32_bf16 v[76:79],a[212:215],v[212:215],v[76:79]
v_min3_u32 v27,v27,v208,v212
v_mfma_f32_16x16x32_bf16 v[72:75],a[216:219],v[216:219],v[72:75]
v_mfma_f32_16x16x32_bf16 v[76:79],a[220:223],v[220:223],v[76:79]
v_min3_u32 v27,v27,v216,v220
s_waitcnt lgkmcnt(6)
v_mfma_f32_16x16x32_bf16 v[72:75],a[224:227],v[224:227],v[72:75]
s_waitcnt lgkmcnt(0)
v_mfma_f32_16x16x32_bf16 v[76:79],a[228:231],v[228:231],v[76:79]
v_min3_u32 v27,v27,v224,v228
v_mfma_f32_16x16x32_bf16 v[72:75],a[232:235],v[232:235],v[72:75]
v_lshlrev_b32 v104,16,v124
v_mfma_f32_16x16x32_bf16 v[76:79],a[236:239],v[236:239],v[76:79]
v_min3_u32 v27,v27,v232,v236
v_mfma_f32_16x16x32_bf16 v[72:75],a[240:243],v[240:243],v[72:75]
v_mfma_f32_16x16x32_bf16 v[76:79],a[244:247],v[244:247],v[76:79]
v_min3_u32 v27,v27,v240,v244
v_mfma_f32_16x16x32_bf16 v[72:75],a[248:251],v[248:251],v[72:75]
v_and_b32 v105,s80,v124
v_mfma_f32_16x16x32_bf16 v[76:79],a[252:255],v[252:255],v[76:79]
v_min3_u32 v27,v27,v248,v252
v_mfma_f32_16x16x32_bf16 v[80:83],a[0:3],v[128:131],0
v_cmp_eq_u32 vcc,0,v27
s_cbranch_vccnz retry_281
v_mfma_f32_16x16x32_bf16 v[84:87],a[4:7],v[132:135],0
v_lshlrev_b32 v106,16,v125
v_mfma_f32_16x16x32_bf16 v[80:83],a[8:11],v[136:139],v[80:83]
v_mfma_f32_16x16x32_bf16 v[84:87],a[12:15],v[140:143],v[84:87]
v_mfma_f32_16x16x32_bf16 v[80:83],a[16:19],v[144:147],v[80:83]
v_and_b32 v107,s80,v125
v_add_f32 v72,v72,v76
v_mfma_f32_16x16x32_bf16 v[84:87],a[20:23],v[148:151],v[84:87]
v_add_f32 v73,v73,v77
v_add_f32 v74,v74,v78
v_mfma_f32_16x16x32_bf16 v[80:83],a[24:27],v[152:155],v[80:83]
v_add_f32 v75,v75,v79
v_and_or_b32 v72,v72,-4,s48
v_mfma_f32_16x16x32_bf16 v[84:87],a[28:31],v[156:159],v[84:87]
s_add_u32 s64,s77,s33
v_mfma_f32_16x16x32_bf16 v[80:83],a[32:35],v[160:163],v[80:83]
buffer_store_dwordx4 v[72:75],v25,s[20:23],s64 offen offset:1024
v_mfma_f32_16x16x32_bf16 v[84:87],a[36:39],v[164:167],v[84:87]
v_mfma_f32_16x16x32_bf16 v[80:83],a[40:43],v[168:171],v[80:83]
v_mfma_f32_16x16x32_bf16 v[84:87],a[44:47],v[172:175],v[84:87]
v_mfma_f32_16x16x32_bf16 v[80:83],a[48:51],v[176:179],v[80:83]
v_mfma_f32_16x16x32_bf16 v[84:87],a[52:55],v[180:183],v[84:87]
v_mfma_f32_16x16x32_bf16 v[80:83],a[56:59],v[184:187],v[80:83]
v_mfma_f32_16x16x32_bf16 v[84:87],a[60:63],v[188:191],v[84:87]
v_mfma_f32_16x16x32_bf16 v[80:83],a[64:67],v[192:195],v[80:83]
buffer_load_dwordx4 v[96:99],v26,s[20:23],s77 offen offset:2048 sc1
v_mfma_f32_16x16x32_bf16 v[84:87],a[68:71],v[196:199],v[84:87]
buffer_load_dwordx4 v[100:103],v26,s[20:23],s77 offen offset:3072 sc1
v_mfma_f32_16x16x32_bf16 v[80:83],a[72:75],v[200:203],v[80:83]
v_mfma_f32_16x16x32_bf16 v[84:87],a[76:79],v[204:207],v[84:87]
v_mfma_f32_16x16x32_bf16 v[80:83],a[80:83],v[208:211],v[80:83]
v_mfma_f32_16x16x32_bf16 v[84:87],a[84:87],v[212:215],v[84:87]
v_mfma_f32_16x16x32_bf16 v[80:83],a[88:91],v[216:219],v[80:83]
v_mfma_f32_16x16x32_bf16 v[84:87],a[92:95],v[220:223],v[84:87]
v_mfma_f32_16x16x32_bf16 v[80:83],a[96:99],v[224:227],v[80:83]
v_mfma_f32_16x16x32_bf16 v[84:87],a[100:103],v[228:231],v[84:87]
v_mfma_f32_16x16x32_bf16 v[80:83],a[104:107],v[232:235],v[80:83]
buffer_load_dwordx4 v[92:95],v26,s[20:23],s77 offen offset:1024 sc1
v_mfma_f32_16x16x32_bf16 v[84:87],a[108:111],v[236:239],v[84:87]
v_mfma_f32_16x16x32_bf16 v[80:83],a[112:115],v[240:243],v[80:83]
v_mfma_f32_16x16x32_bf16 v[84:87],a[116:119],v[244:247],v[84:87]
v_mfma_f32_16x16x32_bf16 v[80:83],a[120:123],v[248:251],v[80:83]
v_mfma_f32_16x16x32_bf16 v[84:87],a[124:127],v[252:255],v[84:87]
s_branch epi_284
keep_289:
v_mfma_f32_16x16x32_bf16 v[68:71],a[228:231],v[228:231],v[68:71]
s_xor_b32 m0,s72,0
s_waitcnt lgkmcnt(10)
v_mfma_f32_16x16x32_bf16 v[64:67],a[104:107],v[232:235],v[64:67]
ds_read_b128 v[160:163],v17 offset:16384
ds_read_b128 v[164:167],v17 offset:18432
v_mfma_f32_16x16x32_bf16 v[68:71],a[232:235],v[232:235],v[68:71]
s_add_u32 s65,s88,0
v_min3_u32 v27,v27,v232,v236
v_mfma_f32_16x16x32_bf16 v[64:67],a[108:111],v[236:239],v[64:67]
ds_read_b128 v[168:171],v17 offset:20480
v_mfma_f32_16x16x32_bf16 v[68:71],a[236:239],v[236:239],v[68:71]
s_waitcnt lgkmcnt(9)
v_mfma_f32_16x16x32_bf16 v[64:67],a[112:115],v[240:243],v[64:67]
ds_read_b128 v[172:175],v17 offset:22528
v_min3_u32 v27,v27,v240,v244
v_mfma_f32_16x16x32_bf16 v[68:71],a[240:243],v[240:243],v[68:71]
buffer_load_dwordx4 v16,s[20:23],s65 offen offset:0 sc1 lds
v_mfma_f32_16x16x32_bf16 v[64:67],a[116:119],v[244:247],v[64:67]
ds_read_b128 v[176:179],v17 offset:24576
ds_read_b128 v[180:183],v17 offset:26624
v_mfma_f32_16x16x32_bf16 v[68:71],a[244:247],v[244:247],v[68:71]
s_waitcnt lgkmcnt(7)
v_mfma_f32_16x16x32_bf16 v[64:67],a[120:123],v[248:251],v[64:67]
ds_read_b128 v[184:187],v17 offset:28672
v_min3_u32 v27,v27,v248,v252
v_mfma_f32_16x16x32_bf16 v[68:71],a[248:251],v[248:251],v[68:71]
buffer_load_dwordx4 v16,s[20:23],s65 offen offset:2048 sc1 lds
v_mfma_f32_16x16x32_bf16 v[64:67],a[124:127],v[252:255],v[64:67]
ds_read_b128 v[188:191],v17 offset:30720
s_xor_b32 m0,s72,16384
v_mfma_f32_16x16x32_bf16 v[68:71],a[252:255],v[252:255],v[68:71]
s_add_u32 s65,s88,32768
v_mfma_f32_16x16x32_bf16 v[72:75],a[128:131],v[128:131],0
buffer_load_dwordx4 v16,s[20:23],s65 offen offset:0 sc1 lds
v_cmp_eq_u32 vcc,0,v27
s_cbranch_vccnz retry_281
v_mfma_f32_16x16x32_bf16 v[76:79],a[132:135],v[132:135],0
buffer_load_dwordx4 v16,s[20:23],s65 offen offset:2048 sc1 lds
v_mfma_f32_16x16x32_bf16 v[72:75],a[136:139],v[136:139],v[72:75]
s_waitcnt vmcnt(5)
s_barrier
ds_read_b128 v[192:195],v17 offset:32768
v_mfma_f32_16x16x32_bf16 v[76:79],a[140:143],v[140:143],v[76:79]
ds_read_b128 v[196:199],v17 offset:34816
s_waitcnt lgkmcnt(10)
v_mfma_f32_16x16x32_bf16 v[72:75],a[144:147],v[144:147],v[72:75]
ds_read_b128 v[200:203],v17 offset:36864
s_xor_b32 m0,s72,32768
s_waitcnt vmcnt(4)
v_and_or_b32 v64,v64,-4,s48
v_mfma_f32_16x16x32_bf16 v[76:79],a[148:151],v[148:151],v[76:79]
ds_read_b128 v[204:207],v17 offset:38912
s_add_u32 s65,s88,65536
s_add_u32 s64,s49,s34
v_mfma_f32_16x16x32_bf16 v[72:75],a[152:155],v[152:155],v[72:75]
ds_read_b128 v[208:211],v17 offset:40960
v_min3_u32 v27,v27,v128,v132
buffer_store_dwordx4 v[64:67],v25,s[20:23],s64 offen offset:2048
v_mfma_f32_16x16x32_bf16 v[76:79],a[156:159],v[156:159],v[76:79]
v_min3_u32 v27,v27,v136,v140
v_and_or_b32 v68,v68,-4,s48
s_add_u32 s64,s49,s35
s_waitcnt lgkmcnt(9)
v_mfma_f32_16x16x32_bf16 v[72:75],a[160:163],v[160:163],v[72:75]
ds_read_b128 v[212:215],v17 offset:43008
v_min3_u32 v27,v27,v144,v148
buffer_store_dwordx4 v[68:71],v25,s[20:23],s64 offen offset:3072
v_mfma_f32_16x16x32_bf16 v[76:79],a[164:167],v[164:167],v[76:79]
ds_read_b128 v[216:219],v17 offset:45056
v_min3_u32 v27,v27,v152,v156
s_mov_b32 s49,0x7fff0000
v_mfma_f32_16x16x32_bf16 v[72:75],a[168:171],v[168:171],v[72:75]
ds_read_b128 v[220:223],v17 offset:47104
v_min3_u32 v27,v27,v160,v164
v_mfma_f32_16x16x32_bf16 v[76:79],a[172:175],v[172:175],v[76:79]
ds_read_b128 v[224:227],v17 offset:49152
s_waitcnt lgkmcnt(9)
v_mfma_f32_16x16x32_bf16 v[72:75],a[176:179],v[176:179],v[72:75]
ds_read_b128 v[228:231],v17 offset:51200
v_min3_u32 v27,v27,v168,v172
v_mfma_f32_16x16x32_bf16 v[76:79],a[180:183],v[180:183],v[76:79]
buffer_load_dwordx4 v16,s[20:23],s65 offen offset:0 sc1 lds
v_mfma_f32_16x16x32_bf16 v[72:75],a[184:187],v[184:187],v[72:75]
ds_read_b128 v[232:235],v17 offset:53248
v_min3_u32 v27,v27,v176,v180
v_mfma_f32_16x16x32_bf16 v[76:79],a[188:191],v[188:191],v[76:79]
ds_read_b128 v[236:239],v17 offset:55296
s_waitcnt lgkmcnt(8)
v_mfma_f32_16x16x32_bf16 v[72:75],a[192:195],v[192:195],v[72:75]
ds_read_b128 v[240:243],v17 offset:57344
v_min3_u32 v27,v27,v184,v188
v_mfma_f32_16x16x32_bf16 v[76:79],a[196:199],v[196:199],v[76:79]
ds_read_b128 v[244:247],v17 offset:59392
v_min3_u32 v27,v27,v192,v196
v_mfma_f32_16x16x32_bf16 v[72:75],a[200:203],v[200:203],v[72:75]
ds_read_b128 v[248:251],v17 offset:61440
ds_bpermute_b32 v124,v41,v120
v_mfma_f32_16x16x32_bf16 v[76:79],a[204:207],v[204:207],v[76:79]
v_min3_u32 v27,v27,v200,v204
s_waitcnt lgkmcnt(8)
v_mfma_f32_16x16x32_bf16 v[72:75],a[208:211],v[208:211],v[72:75]
ds_read_b128 v[252:255],v17 offset:63488
ds_bpermute_b32 v125,v41,v121
v_mfma_f32_16x16x32_bf16 v[76:79],a[212:215],v[212:215],v[76:79]
buffer_load_dwordx4 v16,s[20:23],s65 offen offset:2048 sc1 lds
v_mfma_f32_16x16x32_bf16 v[72:75],a[216:219],v[216:219],v[72:75]
s_xor_b32 m0,s72,49152
s_add_u32 s65,s88,98304
v_mfma_f32_16x16x32_bf16 v[76:79],a[220:223],v[220:223],v[76:79]
v_min3_u32 v27,v27,v208,v212
s_waitcnt lgkmcnt(6)
v_mfma_f32_16x16x32_bf16 v[72:75],a[224:227],v[224:227],v[72:75]
buffer_load_dwordx4 v16,s[20:23],s65 offen offset:0 sc1 lds
v_mfma_f32_16x16x32_bf16 v[76:79],a[228:231],v[228:231],v[76:79]
buffer_load_dwordx4 v16,s[20:23],s65 offen offset:2048 sc1 lds
v_min3_u32 v27,v27,v224,v228
v_mfma_f32_16x16x32_bf16 v[72:75],a[232:235],v[232:235],v[72:75]
s_xor_b32 m0,s72,1024
s_add_u32 s65,s89,0
v_mfma_f32_16x16x32_bf16 v[76:79],a[236:239],v[236:239],v[76:79]
v_min3_u32 v27,v27,v216,v220
v_min3_u32 v27,v27,v232,v236
s_waitcnt lgkmcnt(1)
v_mfma_f32_16x16x32_bf16 v[72:75],a[240:243],v[240:243],v[72:75]
buffer_load_dwordx4 v16,s[20:23],s65 offen offset:0 sc1 lds
v_mfma_f32_16x16x32_bf16 v[76:79],a[244:247],v[244:247],v[76:79]
buffer_load_dwordx4 v16,s[20:23],s65 offen offset:2048 sc1 lds
v_min3_u32 v27,v27,v240,v244
v_mfma_f32_16x16x32_bf16 v[72:75],a[248:251],v[248:251],v[72:75]
s_xor_b32 m0,s72,17408
s_add_u32 s65,s89,32768
v_mfma_f32_16x16x32_bf16 v[76:79],a[252:255],v[252:255],v[76:79]
buffer_load_dwordx4 v16,s[20:23],s65 offen offset:0 sc1 lds
v_min3_u32 v27,v27,v248,v252
v_mfma_f32_16x16x32_bf16 v[80:83],a[0:3],v[128:131],0
buffer_load_dwordx4 v16,s[20:23],s65 offen offset:2048 sc1 lds
v_cmp_eq_u32 vcc,0,v27
s_cbranch_vccnz retry_281
v_mfma_f32_16x16x32_bf16 v[84:87],a[4:7],v[132:135],0
s_xor_b32 m0,s72,33792
s_add_u32 s65,s89,65536
v_mfma_f32_16x16x32_bf16 v[80:83],a[8:11],v[136:139],v[80:83]
buffer_load_dwordx4 v16,s[20:23],s65 offen offset:0 sc1 lds
v_mfma_f32_16x16x32_bf16 v[84:87],a[12:15],v[140:143],v[84:87]
buffer_load_dwordx4 v16,s[20:23],s65 offen offset:2048 sc1 lds
v_mfma_f32_16x16x32_bf16 v[80:83],a[16:19],v[144:147],v[80:83]
s_xor_b32 m0,s72,50176
s_add_u32 s65,s89,98304
v_add_f32 v72,v72,v76
v_mfma_f32_16x16x32_bf16 v[84:87],a[20:23],v[148:151],v[84:87]
buffer_load_dwordx4 v16,s[20:23],s65 offen offset:0 sc1 lds
v_add_f32 v73,v73,v77
v_mfma_f32_16x16x32_bf16 v[80:83],a[24:27],v[152:155],v[80:83]
buffer_load_dwordx4 v16,s[20:23],s65 offen offset:2048 sc1 lds
v_add_f32 v74,v74,v78
v_mfma_f32_16x16x32_bf16 v[84:87],a[28:31],v[156:159],v[84:87]
s_waitcnt lgkmcnt(0)
v_lshlrev_b32 v104,16,v124
v_add_f32 v75,v75,v79
v_mfma_f32_16x16x32_bf16 v[80:83],a[32:35],v[160:163],v[80:83]
v_and_b32 v105,s80,v124
v_lshlrev_b32 v106,16,v125
v_and_or_b32 v72,v72,-4,s48
v_mfma_f32_16x16x32_bf16 v[84:87],a[36:39],v[164:167],v[84:87]
v_and_b32 v107,s80,v125
s_add_u32 s64,s77,s33
v_mfma_f32_16x16x32_bf16 v[80:83],a[40:43],v[168:171],v[80:83]
buffer_store_dwordx4 v[72:75],v25,s[20:23],s64 offen offset:1024
v_mfma_f32_16x16x32_bf16 v[84:87],a[44:47],v[172:175],v[84:87]
v_mfma_f32_16x16x32_bf16 v[80:83],a[48:51],v[176:179],v[80:83]
v_mfma_f32_16x16x32_bf16 v[84:87],a[52:55],v[180:183],v[84:87]
v_mfma_f32_16x16x32_bf16 v[80:83],a[56:59],v[184:187],v[80:83]
v_mfma_f32_16x16x32_bf16 v[84:87],a[60:63],v[188:191],v[84:87]
v_mfma_f32_16x16x32_bf16 v[80:83],a[64:67],v[192:195],v[80:83]
buffer_load_dwordx4 v[96:99],v26,s[20:23],s77 offen offset:2048 sc1
v_mfma_f32_16x16x32_bf16 v[84:87],a[68:71],v[196:199],v[84:87]
buffer_load_dwordx4 v[100:103],v26,s[20:23],s77 offen offset:3072 sc1
v_mfma_f32_16x16x32_bf16 v[80:83],a[72:75],v[200:203],v[80:83]
v_mfma_f32_16x16x32_bf16 v[84:87],a[76:79],v[204:207],v[84:87]
v_mfma_f32_16x16x32_bf16 v[80:83],a[80:83],v[208:211],v[80:83]
v_mfma_f32_16x16x32_bf16 v[84:87],a[84:87],v[212:215],v[84:87]
v_mfma_f32_16x16x32_bf16 v[80:83],a[88:91],v[216:219],v[80:83]
v_mfma_f32_16x16x32_bf16 v[84:87],a[92:95],v[220:223],v[84:87]
v_mfma_f32_16x16x32_bf16 v[80:83],a[96:99],v[224:227],v[80:83]
v_mfma_f32_16x16x32_bf16 v[84:87],a[100:103],v[228:231],v[84:87]
v_mfma_f32_16x16x32_bf16 v[80:83],a[104:107],v[232:235],v[80:83]
buffer_load_dwordx4 v[92:95],v26,s[20:23],s77 offen offset:1024 sc1
v_mfma_f32_16x16x32_bf16 v[84:87],a[108:111],v[236:239],v[84:87]
v_mfma_f32_16x16x32_bf16 v[80:83],a[112:115],v[240:243],v[80:83]
v_mfma_f32_16x16x32_bf16 v[84:87],a[116:119],v[244:247],v[84:87]
v_mfma_f32_16x16x32_bf16 v[80:83],a[120:123],v[248:251],v[80:83]
v_mfma_f32_16x16x32_bf16 v[84:87],a[124:127],v[252:255],v[84:87]
s_branch epi_284
ahead_283:
s_cmp_eq_u32 s93,0
s_cbranch_scc1 both_285
s_waitcnt vmcnt(15) lgkmcnt(0)
s_barrier
ds_read_b128 v[224:227],v18 offset:0
ds_read_b128 v[228:231],v18 offset:2048
ds_read_b128 v[232:235],v18 offset:4096
ds_read_b128 v[236:239],v18 offset:6144
ds_read_b128 v[240:243],v18 offset:8192
ds_read_b128 v[244:247],v18 offset:10240
ds_read_b128 v[248:251],v18 offset:12288
s_waitcnt lgkmcnt(5)
v_mfma_f32_16x16x32_bf16 v[64:67],a[0:3],v[224:227],0
s_add_u32 s96,s71,1
s_add_u32 s92,s71,2
v_mfma_f32_16x16x32_bf16 v[68:71],a[128:131],v[224:227],0
ds_read_b128 v[252:255],v18 offset:14336
v_min_u32 v27,v224,v228
v_mfma_f32_16x16x32_bf16 v[64:67],a[4:7],v[228:231],v[64:67]
buffer_load_dwordx2 v[120:121],v20,s[36:39],s78 offen
v_mfma_f32_16x16x32_bf16 v[68:71],a[132:135],v[228:231],v[68:71]
ds_read_b128 v[224:227],v18 offset:16384
s_waitcnt lgkmcnt(5)
v_mfma_f32_16x16x32_bf16 v[64:67],a[8:11],v[232:235],v[64:67]
v_min3_u32 v27,v27,v232,v236
v_mfma_f32_16x16x32_bf16 v[68:71],a[136:139],v[232:235],v[68:71]
ds_read_b128 v[228:231],v18 offset:18432
v_mfma_f32_16x16x32_bf16 v[64:67],a[12:15],v[236:239],v[64:67]
v_mfma_f32_16x16x32_bf16 v[68:71],a[140:143],v[236:239],v[68:71]
ds_read_b128 v[232:235],v18 offset:20480
s_waitcnt lgkmcnt(5)
v_mfma_f32_16x16x32_bf16 v[64:67],a[16:19],v[240:243],v[64:67]
v_min3_u32 v27,v27,v240,v244
v_mfma_f32_16x16x32_bf16 v[68:71],a[144:147],v[240:243],v[68:71]
ds_read_b128 v[236:239],v18 offset:22528
v_mfma_f32_16x16x32_bf16 v[64:67],a[20:23],v[244:247],v[64:67]
v_mfma_f32_16x16x32_bf16 v[68:71],a[148:151],v[244:247],v[68:71]
ds_read_b128 v[240:243],v18 offset:24576
s_waitcnt lgkmcnt(5)
v_mfma_f32_16x16x32_bf16 v[64:67],a[24:27],v[248:251],v[64:67]
v_min3_u32 v27,v27,v248,v252
v_mfma_f32_16x16x32_bf16 v[68:71],a[152:155],v[248:251],v[68:71]
ds_read_b128 v[244:247],v18 offset:26624
v_mfma_f32_16x16x32_bf16 v[64:67],a[28:31],v[252:255],v[64:67]
v_mfma_f32_16x16x32_bf16 v[68:71],a[156:159],v[252:255],v[68:71]
ds_read_b128 v[248:251],v18 offset:28672
s_waitcnt lgkmcnt(5)
v_mfma_f32_16x16x32_bf16 v[64:67],a[32:35],v[224:227],v[64:67]
v_min3_u32 v27,v27,v224,v228
v_mfma_f32_16x16x32_bf16 v[68:71],a[160:163],v[224:227],v[68:71]
ds_read_b128 v[252:255],v18 offset:30720
v_mfma_f32_16x16x32_bf16 v[64:67],a[36:39],v[228:231],v[64:67]
s_waitcnt vmcnt(3)
v_mfma_f32_16x16x32_bf16 v[68:71],a[164:167],v[228:231],v[68:71]
ds_read_b128 v[224:227],v18 offset:32768
s_waitcnt lgkmcnt(5)
v_mfma_f32_16x16x32_bf16 v[64:67],a[40:43],v[232:235],v[64:67]
v_cmp_gt_u32 vcc,s96,v29
v_cmp_gt_u32 s[92:93],s92,v29
v_mfma_f32_16x16x32_bf16 v[68:71],a[168:171],v[232:235],v[68:71]
ds_read_b128 v[228:231],v18 offset:34816
v_min3_u32 v27,v27,v232,v236
v_mfma_f32_16x16x32_bf16 v[64:67],a[44:47],v[236:239],v[64:67]
v_mov_b32 v44,vcc_lo
v_mov_b32 v45,s92
v_mfma_f32_16x16x32_bf16 v[68:71],a[172:175],v[236:239],v[68:71]
ds_read_b128 v[232:235],v18 offset:36864
s_waitcnt lgkmcnt(5)
v_mfma_f32_16x16x32_bf16 v[64:67],a[48:51],v[240:243],v[64:67]
ds_write_b64 v46,v[44:45]
v_min3_u32 v27,v27,v240,v244
v_mfma_f32_16x16x32_bf16 v[68:71],a[176:179],v[240:243],v[68:71]
ds_read_b128 v[236:239],v18 offset:38912
v_mfma_f32_16x16x32_bf16 v[64:67],a[52:55],v[244:247],v[64:67]
v_mfma_f32_16x16x32_bf16 v[68:71],a[180:183],v[244:247],v[68:71]
ds_read_b128 v[240:243],v18 offset:40960
s_waitcnt lgkmcnt(6)
v_mfma_f32_16x16x32_bf16 v[64:67],a[56:59],v[248:251],v[64:67]
v_min3_u32 v27,v27,v248,v252
s_add_u32 s88,s70,s75
v_mfma_f32_16x16x32_bf16 v[68:71],a[184:187],v[248:251],v[68:71]
ds_read_b128 v[244:247],v18 offset:43008
s_add_u32 s88,s88,2097152
v_mfma_f32_16x16x32_bf16 v[64:67],a[60:63],v[252:255],v[64:67]
s_xor_b32 s88,s88,0x2000
s_xor_b32 s89,s88,1024
v_mfma_f32_16x16x32_bf16 v[68:71],a[188:191],v[252:255],v[68:71]
ds_read_b128 v[248:251],v18 offset:45056
s_waitcnt lgkmcnt(6)
v_mfma_f32_16x16x32_bf16 v[64:67],a[64:67],v[224:227],v[64:67]
v_min3_u32 v27,v27,v224,v228
v_mfma_f32_16x16x32_bf16 v[68:71],a[192:195],v[224:227],v[68:71]
ds_read_b128 v[252:255],v18 offset:47104
v_mfma_f32_16x16x32_bf16 v[64:67],a[68:71],v[228:231],v[64:67]
v_mfma_f32_16x16x32_bf16 v[68:71],a[196:199],v[228:231],v[68:71]
ds_read_b128 v[224:227],v18 offset:49152
s_waitcnt lgkmcnt(5)
v_mfma_f32_16x16x32_bf16 v[64:67],a[72:75],v[232:235],v[64:67]
v_min3_u32 v27,v27,v232,v236
v_mfma_f32_16x16x32_bf16 v[68:71],a[200:203],v[232:235],v[68:71]
ds_read_b128 v[228:231],v18 offset:51200
v_mfma_f32_16x16x32_bf16 v[64:67],a[76:79],v[236:239],v[64:67]
v_mfma_f32_16x16x32_bf16 v[68:71],a[204:207],v[236:239],v[68:71]
ds_read_b128 v[232:235],v18 offset:53248
s_waitcnt lgkmcnt(5)
v_mfma_f32_16x16x32_bf16 v[64:67],a[80:83],v[240:243],v[64:67]
s_waitcnt vmcnt(8)
s_barrier
ds_read_b64 v[44:45],v47
ds_read_b128 v[128:131],v17 offset:0
ds_read_b128 v[132:135],v17 offset:2048
v_mfma_f32_16x16x32_bf16 v[68:71],a[208:211],v[240:243],v[68:71]
ds_read_b128 v[236:239],v18 offset:55296
v_min3_u32 v27,v27,v240,v244
v_mfma_f32_16x16x32_bf16 v[64:67],a[84:87],v[244:247],v[64:67]
ds_read_b128 v[136:139],v17 offset:4096
v_mfma_f32_16x16x32_bf16 v[68:71],a[212:215],v[244:247],v[68:71]
ds_read_b128 v[240:243],v18 offset:57344
s_waitcnt lgkmcnt(9)
v_mfma_f32_16x16x32_bf16 v[64:67],a[88:91],v[248:251],v[64:67]
ds_read_b128 v[140:143],v17 offset:6144
v_min3_u32 v27,v27,v248,v252
v_mfma_f32_16x16x32_bf16 v[68:71],a[216:219],v[248:251],v[68:71]
ds_read_b128 v[244:247],v18 offset:59392
v_mfma_f32_16x16x32_bf16 v[64:67],a[92:95],v[252:255],v[64:67]
ds_read_b128 v[144:147],v17 offset:8192
ds_read_b128 v[148:151],v17 offset:10240
v_mfma_f32_16x16x32_bf16 v[68:71],a[220:223],v[252:255],v[68:71]
ds_read_b128 v[248:251],v18 offset:61440
s_waitcnt lgkmcnt(12)
v_mfma_f32_16x16x32_bf16 v[64:67],a[96:99],v[224:227],v[64:67]
ds_read_b128 v[152:155],v17 offset:12288
s_waitcnt lgkmcnt(11)
v_min3_u32 v27,v27,v224,v228
v_mfma_f32_16x16x32_bf16 v[68:71],a[224:227],v[224:227],v[68:71]
ds_read_b128 v[252:255],v18 offset:63488
v_readfirstlane_b32 s93,v45
v_mfma_f32_16x16x32_bf16 v[64:67],a[100:103],v[228:231],v[64:67]
ds_read_b128 v[156:159],v17 offset:14336
v_readfirstlane_b32 s83,v44
s_cmp_lg_u32 s83,0
s_cbranch_scc1 keep_290
v_mfma_f32_16x16x32_bf16 v[68:71],a[228:231],v[228:231],v[68:71]
s_waitcnt vmcnt(1)
s_xor_b32 m0,s72,0
s_waitcnt lgkmcnt(10)
v_mfma_f32_16x16x32_bf16 v[64:67],a[104:107],v[232:235],v[64:67]
ds_read_b128 v[160:163],v17 offset:16384
ds_read_b128 v[164:167],v17 offset:18432
s_add_u32 s65,s88,0
v_mfma_f32_16x16x32_bf16 v[68:71],a[232:235],v[232:235],v[68:71]
v_add_u32 v22,s71,-1
v_min3_u32 v27,v27,v232,v236
v_mfma_f32_16x16x32_bf16 v[64:67],a[108:111],v[236:239],v[64:67]
ds_read_b128 v[168:171],v17 offset:20480
buffer_load_dwordx4 v16,s[20:23],s65 offen offset:0 sc1 lds
v_mfma_f32_16x16x32_bf16 v[68:71],a[236:239],v[236:239],v[68:71]
s_waitcnt lgkmcnt(9)
v_mfma_f32_16x16x32_bf16 v[64:67],a[112:115],v[240:243],v[64:67]
ds_read_b128 v[172:175],v17 offset:22528
v_min3_u32 v27,v27,v240,v244
v_mfma_f32_16x16x32_bf16 v[68:71],a[240:243],v[240:243],v[68:71]
buffer_store_dword v22,v23,s[20:23],s97 offen sc1
v_mfma_f32_16x16x32_bf16 v[64:67],a[116:119],v[244:247],v[64:67]
ds_read_b128 v[176:179],v17 offset:24576
ds_read_b128 v[180:183],v17 offset:26624
v_mfma_f32_16x16x32_bf16 v[68:71],a[244:247],v[244:247],v[68:71]
s_mov_b32 s97,0x7fff0000
s_waitcnt lgkmcnt(7)
v_mfma_f32_16x16x32_bf16 v[64:67],a[120:123],v[248:251],v[64:67]
ds_read_b128 v[184:187],v17 offset:28672
v_min3_u32 v27,v27,v248,v252
v_mfma_f32_16x16x32_bf16 v[68:71],a[248:251],v[248:251],v[68:71]
buffer_load_dwordx4 v16,s[20:23],s65 offen offset:2048 sc1 lds
v_mfma_f32_16x16x32_bf16 v[64:67],a[124:127],v[252:255],v[64:67]
ds_read_b128 v[188:191],v17 offset:30720
s_xor_b32 m0,s72,16384
v_mfma_f32_16x16x32_bf16 v[68:71],a[252:255],v[252:255],v[68:71]
s_add_u32 s65,s88,32768
v_mfma_f32_16x16x32_bf16 v[72:75],a[128:131],v[128:131],0
buffer_load_dwordx4 v16,s[20:23],s65 offen offset:0 sc1 lds
v_cmp_eq_u32 vcc,0,v27
s_cbranch_vccnz retry_281
v_mfma_f32_16x16x32_bf16 v[76:79],a[132:135],v[132:135],0
buffer_load_dwordx4 v16,s[20:23],s65 offen offset:2048 sc1 lds
v_mfma_f32_16x16x32_bf16 v[72:75],a[136:139],v[136:139],v[72:75]
ds_read_b128 v[192:195],v17 offset:32768
s_xor_b32 m0,s72,32768
v_mfma_f32_16x16x32_bf16 v[76:79],a[140:143],v[140:143],v[76:79]
ds_read_b128 v[196:199],v17 offset:34816
s_waitcnt lgkmcnt(10)
v_mfma_f32_16x16x32_bf16 v[72:75],a[144:147],v[144:147],v[72:75]
ds_read_b128 v[200:203],v17 offset:36864
s_add_u32 s65,s88,65536
s_waitcnt vmcnt(5)
v_and_or_b32 v64,v64,-4,s48
v_mfma_f32_16x16x32_bf16 v[76:79],a[148:151],v[148:151],v[76:79]
ds_read_b128 v[204:207],v17 offset:38912
v_min3_u32 v27,v27,v128,v132
s_add_u32 s64,s49,s34
v_mfma_f32_16x16x32_bf16 v[72:75],a[152:155],v[152:155],v[72:75]
ds_read_b128 v[208:211],v17 offset:40960
v_min3_u32 v27,v27,v136,v140
buffer_store_dwordx4 v[64:67],v25,s[20:23],s64 offen offset:2048
v_mfma_f32_16x16x32_bf16 v[76:79],a[156:159],v[156:159],v[76:79]
v_min3_u32 v27,v27,v144,v148
v_and_or_b32 v68,v68,-4,s48
s_add_u32 s64,s49,s35
s_waitcnt lgkmcnt(9)
v_mfma_f32_16x16x32_bf16 v[72:75],a[160:163],v[160:163],v[72:75]
ds_read_b128 v[212:215],v17 offset:43008
v_min3_u32 v27,v27,v152,v156
buffer_store_dwordx4 v[68:71],v25,s[20:23],s64 offen offset:3072
v_mfma_f32_16x16x32_bf16 v[76:79],a[164:167],v[164:167],v[76:79]
ds_read_b128 v[216:219],v17 offset:45056
v_min3_u32 v27,v27,v160,v164
v_mfma_f32_16x16x32_bf16 v[72:75],a[168:171],v[168:171],v[72:75]
ds_read_b128 v[220:223],v17 offset:47104
s_mov_b32 s49,0x7fff0000
v_mfma_f32_16x16x32_bf16 v[76:79],a[172:175],v[172:175],v[76:79]
ds_read_b128 v[224:227],v17 offset:49152
s_waitcnt lgkmcnt(9)
v_mfma_f32_16x16x32_bf16 v[72:75],a[176:179],v[176:179],v[72:75]
ds_read_b128 v[228:231],v17 offset:51200
v_min3_u32 v27,v27,v168,v172
v_mfma_f32_16x16x32_bf16 v[76:79],a[180:183],v[180:183],v[76:79]
buffer_load_dwordx4 v16,s[20:23],s65 offen offset:0 sc1 lds
v_mfma_f32_16x16x32_bf16 v[72:75],a[184:187],v[184:187],v[72:75]
ds_read_b128 v[232:235],v17 offset:53248
v_min3_u32 v27,v27,v176,v180
v_mfma_f32_16x16x32_bf16 v[76:79],a[188:191],v[188:191],v[76:79]
ds_read_b128 v[236:239],v17 offset:55296
s_waitcnt lgkmcnt(8)
v_mfma_f32_16x16x32_bf16 v[72:75],a[192:195],v[192:195],v[72:75]
ds_read_b128 v[240:243],v17 offset:57344
v_min3_u32 v27,v27,v184,v188
v_mfma_f32_16x16x32_bf16 v[76:79],a[196:199],v[196:199],v[76:79]
ds_read_b128 v[244:247],v17 offset:59392
v_min3_u32 v27,v27,v192,v196
v_mfma_f32_16x16x32_bf16 v[72:75],a[200:203],v[200:203],v[72:75]
ds_read_b128 v[248:251],v17 offset:61440
ds_bpermute_b32 v124,v41,v120
v_mfma_f32_16x16x32_bf16 v[76:79],a[204:207],v[204:207],v[76:79]
v_min3_u32 v27,v27,v200,v204
s_waitcnt lgkmcnt(8)
v_mfma_f32_16x16x32_bf16 v[72:75],a[208:211],v[208:211],v[72:75]
ds_read_b128 v[252:255],v17 offset:63488
ds_bpermute_b32 v125,v41,v121
v_mfma_f32_16x16x32_bf16 v[76:79],a[212:215],v[212:215],v[76:79]
buffer_load_dwordx4 v16,s[20:23],s65 offen offset:2048 sc1 lds
v_mfma_f32_16x16x32_bf16 v[72:75],a[216:219],v[216:219],v[72:75]
s_xor_b32 m0,s72,49152
s_add_u32 s65,s88,98304
v_mfma_f32_16x16x32_bf16 v[76:79],a[220:223],v[220:223],v[76:79]
v_min3_u32 v27,v27,v208,v212
s_waitcnt lgkmcnt(6)
v_mfma_f32_16x16x32_bf16 v[72:75],a[224:227],v[224:227],v[72:75]
buffer_load_dwordx4 v16,s[20:23],s65 offen offset:0 sc1 lds
v_mfma_f32_16x16x32_bf16 v[76:79],a[228:231],v[228:231],v[76:79]
buffer_load_dwordx4 v16,s[20:23],s65 offen offset:2048 sc1 lds
v_min3_u32 v27,v27,v224,v228
v_mfma_f32_16x16x32_bf16 v[72:75],a[232:235],v[232:235],v[72:75]
s_xor_b32 m0,s72,1024
s_add_u32 s65,s89,0
v_mfma_f32_16x16x32_bf16 v[76:79],a[236:239],v[236:239],v[76:79]
v_min3_u32 v27,v27,v216,v220
v_min3_u32 v27,v27,v232,v236
s_waitcnt lgkmcnt(1)
v_mfma_f32_16x16x32_bf16 v[72:75],a[240:243],v[240:243],v[72:75]
buffer_load_dwordx4 v16,s[20:23],s65 offen offset:0 sc1 lds
v_mfma_f32_16x16x32_bf16 v[76:79],a[244:247],v[244:247],v[76:79]
buffer_load_dwordx4 v16,s[20:23],s65 offen offset:2048 sc1 lds
v_min3_u32 v27,v27,v240,v244
v_mfma_f32_16x16x32_bf16 v[72:75],a[248:251],v[248:251],v[72:75]
s_xor_b32 m0,s72,17408
s_add_u32 s65,s89,32768
v_mfma_f32_16x16x32_bf16 v[76:79],a[252:255],v[252:255],v[76:79]
buffer_load_dwordx4 v16,s[20:23],s65 offen offset:0 sc1 lds
v_min3_u32 v27,v27,v248,v252
v_mfma_f32_16x16x32_bf16 v[80:83],a[0:3],v[128:131],0
buffer_load_dwordx4 v16,s[20:23],s65 offen offset:2048 sc1 lds
v_cmp_eq_u32 vcc,0,v27
s_cbranch_vccnz retry_281
v_mfma_f32_16x16x32_bf16 v[84:87],a[4:7],v[132:135],0
s_xor_b32 m0,s72,33792
s_add_u32 s65,s89,65536
v_mfma_f32_16x16x32_bf16 v[80:83],a[8:11],v[136:139],v[80:83]
buffer_load_dwordx4 v16,s[20:23],s65 offen offset:0 sc1 lds
v_mfma_f32_16x16x32_bf16 v[84:87],a[12:15],v[140:143],v[84:87]
buffer_load_dwordx4 v16,s[20:23],s65 offen offset:2048 sc1 lds
v_mfma_f32_16x16x32_bf16 v[80:83],a[16:19],v[144:147],v[80:83]
s_xor_b32 m0,s72,50176
s_add_u32 s65,s89,98304
v_add_f32 v72,v72,v76
v_mfma_f32_16x16x32_bf16 v[84:87],a[20:23],v[148:151],v[84:87]
buffer_load_dwordx4 v16,s[20:23],s65 offen offset:0 sc1 lds
v_add_f32 v73,v73,v77
v_mfma_f32_16x16x32_bf16 v[80:83],a[24:27],v[152:155],v[80:83]
buffer_load_dwordx4 v16,s[20:23],s65 offen offset:2048 sc1 lds
v_add_f32 v74,v74,v78
v_mfma_f32_16x16x32_bf16 v[84:87],a[28:31],v[156:159],v[84:87]
s_waitcnt lgkmcnt(0)
v_lshlrev_b32 v104,16,v124
v_add_f32 v75,v75,v79
v_mfma_f32_16x16x32_bf16 v[80:83],a[32:35],v[160:163],v[80:83]
v_and_b32 v105,s80,v124
v_lshlrev_b32 v106,16,v125
v_and_or_b32 v72,v72,-4,s48
v_mfma_f32_16x16x32_bf16 v[84:87],a[36:39],v[164:167],v[84:87]
v_and_b32 v107,s80,v125
s_add_u32 s64,s77,s33
v_mfma_f32_16x16x32_bf16 v[80:83],a[40:43],v[168:171],v[80:83]
buffer_store_dwordx4 v[72:75],v25,s[20:23],s64 offen offset:1024
v_mfma_f32_16x16x32_bf16 v[84:87],a[44:47],v[172:175],v[84:87]
v_mfma_f32_16x16x32_bf16 v[80:83],a[48:51],v[176:179],v[80:83]
v_mfma_f32_16x16x32_bf16 v[84:87],a[52:55],v[180:183],v[84:87]
v_mfma_f32_16x16x32_bf16 v[80:83],a[56:59],v[184:187],v[80:83]
v_mfma_f32_16x16x32_bf16 v[84:87],a[60:63],v[188:191],v[84:87]
v_mfma_f32_16x16x32_bf16 v[80:83],a[64:67],v[192:195],v[80:83]
buffer_load_dwordx4 v[96:99],v26,s[20:23],s77 offen offset:2048 sc1
v_mfma_f32_16x16x32_bf16 v[84:87],a[68:71],v[196:199],v[84:87]
buffer_load_dwordx4 v[100:103],v26,s[20:23],s77 offen offset:3072 sc1
v_mfma_f32_16x16x32_bf16 v[80:83],a[72:75],v[200:203],v[80:83]
v_mfma_f32_16x16x32_bf16 v[84:87],a[76:79],v[204:207],v[84:87]
v_mfma_f32_16x16x32_bf16 v[80:83],a[80:83],v[208:211],v[80:83]
v_mfma_f32_16x16x32_bf16 v[84:87],a[84:87],v[212:215],v[84:87]
v_mfma_f32_16x16x32_bf16 v[80:83],a[88:91],v[216:219],v[80:83]
v_mfma_f32_16x16x32_bf16 v[84:87],a[92:95],v[220:223],v[84:87]
v_mfma_f32_16x16x32_bf16 v[80:83],a[96:99],v[224:227],v[80:83]
v_mfma_f32_16x16x32_bf16 v[84:87],a[100:103],v[228:231],v[84:87]
v_mfma_f32_16x16x32_bf16 v[80:83],a[104:107],v[232:235],v[80:83]
buffer_load_dwordx4 v[92:95],v26,s[20:23],s77 offen offset:1024 sc1
v_mfma_f32_16x16x32_bf16 v[84:87],a[108:111],v[236:239],v[84:87]
v_mfma_f32_16x16x32_bf16 v[80:83],a[112:115],v[240:243],v[80:83]
v_mfma_f32_16x16x32_bf16 v[84:87],a[116:119],v[244:247],v[84:87]
v_mfma_f32_16x16x32_bf16 v[80:83],a[120:123],v[248:251],v[80:83]
v_mfma_f32_16x16x32_bf16 v[84:87],a[124:127],v[252:255],v[84:87]
s_branch epi_284
keep_290:
v_mfma_f32_16x16x32_bf16 v[68:71],a[228:231],v[228:231],v[68:71]
s_waitcnt vmcnt(1)
s_waitcnt lgkmcnt(10)
v_mfma_f32_16x16x32_bf16 v[64:67],a[104:107],v[232:235],v[64:67]
ds_read_b128 v[160:163],v17 offset:16384
ds_read_b128 v[164:167],v17 offset:18432
v_mfma_f32_16x16x32_bf16 v[68:71],a[232:235],v[232:235],v[68:71]
v_add_u32 v22,s71,-1
v_min3_u32 v27,v27,v232,v236
v_mfma_f32_16x16x32_bf16 v[64:67],a[108:111],v[236:239],v[64:67]
ds_read_b128 v[168:171],v17 offset:20480
v_mfma_f32_16x16x32_bf16 v[68:71],a[236:239],v[236:239],v[68:71]
s_waitcnt lgkmcnt(9)
v_mfma_f32_16x16x32_bf16 v[64:67],a[112:115],v[240:243],v[64:67]
ds_read_b128 v[172:175],v17 offset:22528
v_min3_u32 v27,v27,v240,v244
v_mfma_f32_16x16x32_bf16 v[68:71],a[240:243],v[240:243],v[68:71]
buffer_store_dword v22,v23,s[20:23],s97 offen sc1
v_mfma_f32_16x16x32_bf16 v[64:67],a[116:119],v[244:247],v[64:67]
ds_read_b128 v[176:179],v17 offset:24576
ds_read_b128 v[180:183],v17 offset:26624
v_mfma_f32_16x16x32_bf16 v[68:71],a[244:247],v[244:247],v[68:71]
s_mov_b32 s97,0x7fff0000
s_waitcnt lgkmcnt(7)
v_mfma_f32_16x16x32_bf16 v[64:67],a[120:123],v[248:251],v[64:67]
ds_read_b128 v[184:187],v17 offset:28672
v_min3_u32 v27,v27,v248,v252
v_mfma_f32_16x16x32_bf16 v[68:71],a[248:251],v[248:251],v[68:71]
v_mfma_f32_16x16x32_bf16 v[64:67],a[124:127],v[252:255],v[64:67]
ds_read_b128 v[188:191],v17 offset:30720
v_mfma_f32_16x16x32_bf16 v[68:71],a[252:255],v[252:255],v[68:71]
v_mfma_f32_16x16x32_bf16 v[72:75],a[128:131],v[128:131],0
v_cmp_eq_u32 vcc,0,v27
s_cbranch_vccnz retry_281
v_mfma_f32_16x16x32_bf16 v[76:79],a[132:135],v[132:135],0
v_min3_u32 v27,v27,v128,v132
v_mfma_f32_16x16x32_bf16 v[72:75],a[136:139],v[136:139],v[72:75]
ds_read_b128 v[192:195],v17 offset:32768
v_mfma_f32_16x16x32_bf16 v[76:79],a[140:143],v[140:143],v[76:79]
ds_read_b128 v[196:199],v17 offset:34816
s_waitcnt lgkmcnt(10)
v_mfma_f32_16x16x32_bf16 v[72:75],a[144:147],v[144:147],v[72:75]
ds_read_b128 v[200:203],v17 offset:36864
v_min3_u32 v27,v27,v136,v140
s_waitcnt vmcnt(1)
v_mfma_f32_16x16x32_bf16 v[76:79],a[148:151],v[148:151],v[76:79]
ds_read_b128 v[204:207],v17 offset:38912
v_min3_u32 v27,v27,v144,v148
v_and_or_b32 v64,v64,-4,s48
v_mfma_f32_16x16x32_bf16 v[72:75],a[152:155],v[152:155],v[72:75]
ds_read_b128 v[208:211],v17 offset:40960
s_add_u32 s64,s49,s34
v_mfma_f32_16x16x32_bf16 v[76:79],a[156:159],v[156:159],v[76:79]
v_min3_u32 v27,v27,v152,v156
s_waitcnt lgkmcnt(9)
v_mfma_f32_16x16x32_bf16 v[72:75],a[160:163],v[160:163],v[72:75]
ds_read_b128 v[212:215],v17 offset:43008
buffer_store_dwordx4 v[64:67],v25,s[20:23],s64 offen offset:2048
v_mfma_f32_16x16x32_bf16 v[76:79],a[164:167],v[164:167],v[76:79]
ds_read_b128 v[216:219],v17 offset:45056
v_min3_u32 v27,v27,v160,v164
v_and_or_b32 v68,v68,-4,s48
v_mfma_f32_16x16x32_bf16 v[72:75],a[168:171],v[168:171],v[72:75]
ds_read_b128 v[220:223],v17 offset:47104
s_add_u32 s64,s49,s35
v_mfma_f32_16x16x32_bf16 v[76:79],a[172:175],v[172:175],v[76:79]
ds_read_b128 v[224:227],v17 offset:49152
s_waitcnt lgkmcnt(9)
v_mfma_f32_16x16x32_bf16 v[72:75],a[176:179],v[176:179],v[72:75]
ds_read_b128 v[228:231],v17 offset:51200
v_min3_u32 v27,v27,v168,v172
v_mfma_f32_16x16x32_bf16 v[76:79],a[180:183],v[180:183],v[76:79]
v_min3_u32 v27,v27,v176,v180
buffer_store_dwordx4 v[68:71],v25,s[20:23],s64 offen offset:3072
v_mfma_f32_16x16x32_bf16 v[72:75],a[184:187],v[184:187],v[72:75]
ds_read_b128 v[232:235],v17 offset:53248
s_mov_b32 s49,0x7fff0000
v_mfma_f32_16x16x32_bf16 v[76:79],a[188:191],v[188:191],v[76:79]
ds_read_b128 v[236:239],v17 offset:55296
s_waitcnt lgkmcnt(8)
v_mfma_f32_16x16x32_bf16 v[72:75],a[192:195],v[192:195],v[72:75]
ds_read_b128 v[240:243],v17 offset:57344
v_min3_u32 v27,v27,v184,v188
v_mfma_f32_16x16x32_bf16 v[76:79],a[196:199],v[196:199],v[76:79]
ds_read_b128 v[244:247],v17 offset:59392
v_min3_u32 v27,v27,v192,v196
v_mfma_f32_16x16x32_bf16 v[72:75],a[200:203],v[200:203],v[72:75]
ds_read_b128 v[248:251],v17 offset:61440
ds_bpermute_b32 v124,v41,v120
v_mfma_f32_16x16x32_bf16 v[76:79],a[204:207],v[204:207],v[76:79]
v_min3_u32 v27,v27,v200,v204
s_waitcnt lgkmcnt(8)
v_mfma_f32_16x16x32_bf16 v[72:75],a[208:211],v[208:211],v[72:75]
ds_read_b128 v[252:255],v17 offset:63488
ds_bpermute_b32 v125,v41,v121
v_mfma_f32_16x16x32_bf16 v[76:79],a[212:215],v[212:215],v[76:79]
v_min3_u32 v27,v27,v208,v212
v_mfma_f32_16x16x32_bf16 v[72:75],a[216:219],v[216:219],v[72:75]
v_mfma_f32_16x16x32_bf16 v[76:79],a[220:223],v[220:223],v[76:79]
v_min3_u32 v27,v27,v216,v220
s_waitcnt lgkmcnt(6)
v_mfma_f32_16x16x32_bf16 v[72:75],a[224:227],v[224:227],v[72:75]
s_waitcnt lgkmcnt(0)
v_mfma_f32_16x16x32_bf16 v[76:79],a[228:231],v[228:231],v[76:79]
v_min3_u32 v27,v27,v224,v228
v_mfma_f32_16x16x32_bf16 v[72:75],a[232:235],v[232:235],v[72:75]
v_lshlrev_b32 v104,16,v124
v_mfma_f32_16x16x32_bf16 v[76:79],a[236:239],v[236:239],v[76:79]
v_min3_u32 v27,v27,v232,v236
v_mfma_f32_16x16x32_bf16 v[72:75],a[240:243],v[240:243],v[72:75]
v_mfma_f32_16x16x32_bf16 v[76:79],a[244:247],v[244:247],v[76:79]
v_min3_u32 v27,v27,v240,v244
v_mfma_f32_16x16x32_bf16 v[72:75],a[248:251],v[248:251],v[72:75]
v_and_b32 v105,s80,v124
v_mfma_f32_16x16x32_bf16 v[76:79],a[252:255],v[252:255],v[76:79]
v_min3_u32 v27,v27,v248,v252
v_mfma_f32_16x16x32_bf16 v[80:83],a[0:3],v[128:131],0
v_cmp_eq_u32 vcc,0,v27
s_cbranch_vccnz retry_281
v_mfma_f32_16x16x32_bf16 v[84:87],a[4:7],v[132:135],0
v_lshlrev_b32 v106,16,v125
v_mfma_f32_16x16x32_bf16 v[80:83],a[8:11],v[136:139],v[80:83]
v_mfma_f32_16x16x32_bf16 v[84:87],a[12:15],v[140:143],v[84:87]
v_mfma_f32_16x16x32_bf16 v[80:83],a[16:19],v[144:147],v[80:83]
v_and_b32 v107,s80,v125
v_add_f32 v72,v72,v76
v_mfma_f32_16x16x32_bf16 v[84:87],a[20:23],v[148:151],v[84:87]
v_add_f32 v73,v73,v77
v_add_f32 v74,v74,v78
v_mfma_f32_16x16x32_bf16 v[80:83],a[24:27],v[152:155],v[80:83]
v_add_f32 v75,v75,v79
v_and_or_b32 v72,v72,-4,s48
v_mfma_f32_16x16x32_bf16 v[84:87],a[28:31],v[156:159],v[84:87]
s_add_u32 s64,s77,s33
v_mfma_f32_16x16x32_bf16 v[80:83],a[32:35],v[160:163],v[80:83]
buffer_store_dwordx4 v[72:75],v25,s[20:23],s64 offen offset:1024
v_mfma_f32_16x16x32_bf16 v[84:87],a[36:39],v[164:167],v[84:87]
v_mfma_f32_16x16x32_bf16 v[80:83],a[40:43],v[168:171],v[80:83]
v_mfma_f32_16x16x32_bf16 v[84:87],a[44:47],v[172:175],v[84:87]
v_mfma_f32_16x16x32_bf16 v[80:83],a[48:51],v[176:179],v[80:83]
v_mfma_f32_16x16x32_bf16 v[84:87],a[52:55],v[180:183],v[84:87]
v_mfma_f32_16x16x32_bf16 v[80:83],a[56:59],v[184:187],v[80:83]
v_mfma_f32_16x16x32_bf16 v[84:87],a[60:63],v[188:191],v[84:87]
v_mfma_f32_16x16x32_bf16 v[80:83],a[64:67],v[192:195],v[80:83]
buffer_load_dwordx4 v[96:99],v26,s[20:23],s77 offen offset:2048 sc1
v_mfma_f32_16x16x32_bf16 v[84:87],a[68:71],v[196:199],v[84:87]
buffer_load_dwordx4 v[100:103],v26,s[20:23],s77 offen offset:3072 sc1
v_mfma_f32_16x16x32_bf16 v[80:83],a[72:75],v[200:203],v[80:83]
v_mfma_f32_16x16x32_bf16 v[84:87],a[76:79],v[204:207],v[84:87]
v_mfma_f32_16x16x32_bf16 v[80:83],a[80:83],v[208:211],v[80:83]
v_mfma_f32_16x16x32_bf16 v[84:87],a[84:87],v[212:215],v[84:87]
v_mfma_f32_16x16x32_bf16 v[80:83],a[88:91],v[216:219],v[80:83]
v_mfma_f32_16x16x32_bf16 v[84:87],a[92:95],v[220:223],v[84:87]
v_mfma_f32_16x16x32_bf16 v[80:83],a[96:99],v[224:227],v[80:83]
v_mfma_f32_16x16x32_bf16 v[84:87],a[100:103],v[228:231],v[84:87]
v_mfma_f32_16x16x32_bf16 v[80:83],a[104:107],v[232:235],v[80:83]
buffer_load_dwordx4 v[92:95],v26,s[20:23],s77 offen offset:1024 sc1
v_mfma_f32_16x16x32_bf16 v[84:87],a[108:111],v[236:239],v[84:87]
v_mfma_f32_16x16x32_bf16 v[80:83],a[112:115],v[240:243],v[80:83]
v_mfma_f32_16x16x32_bf16 v[84:87],a[116:119],v[244:247],v[84:87]
v_mfma_f32_16x16x32_bf16 v[80:83],a[120:123],v[248:251],v[80:83]
v_mfma_f32_16x16x32_bf16 v[84:87],a[124:127],v[252:255],v[84:87]
s_branch epi_284
both_285:
s_waitcnt vmcnt(15) lgkmcnt(0)
s_barrier
ds_read_b128 v[224:227],v18 offset:0
ds_read_b128 v[228:231],v18 offset:2048
ds_read_b128 v[232:235],v18 offset:4096
ds_read_b128 v[236:239],v18 offset:6144
ds_read_b128 v[240:243],v18 offset:8192
ds_read_b128 v[244:247],v18 offset:10240
ds_read_b128 v[248:251],v18 offset:12288
s_waitcnt lgkmcnt(5)
v_mfma_f32_16x16x32_bf16 v[64:67],a[0:3],v[224:227],0
s_add_u32 s96,s71,1
s_add_u32 s92,s71,2
v_min_u32 v27,v224,v228
v_mfma_f32_16x16x32_bf16 v[68:71],a[128:131],v[224:227],0
ds_read_b128 v[252:255],v18 offset:14336
s_add_u32 s88,s70,s75
v_mfma_f32_16x16x32_bf16 v[64:67],a[4:7],v[228:231],v[64:67]
s_add_u32 s88,s88,2097152
s_xor_b32 s88,s88,0x2000
v_mfma_f32_16x16x32_bf16 v[68:71],a[132:135],v[228:231],v[68:71]
ds_read_b128 v[224:227],v18 offset:16384
s_waitcnt lgkmcnt(5)
v_mfma_f32_16x16x32_bf16 v[64:67],a[8:11],v[232:235],v[64:67]
s_xor_b32 s89,s88,1024
v_min3_u32 v27,v27,v232,v236
v_mfma_f32_16x16x32_bf16 v[68:71],a[136:139],v[232:235],v[68:71]
ds_read_b128 v[228:231],v18 offset:18432
v_mfma_f32_16x16x32_bf16 v[64:67],a[12:15],v[236:239],v[64:67]
s_xor_b32 m0,s72,0
v_mfma_f32_16x16x32_bf16 v[68:71],a[140:143],v[236:239],v[68:71]
ds_read_b128 v[232:235],v18 offset:20480
s_waitcnt lgkmcnt(5)
v_mfma_f32_16x16x32_bf16 v[64:67],a[16:19],v[240:243],v[64:67]
s_add_u32 s65,s88,0
v_min3_u32 v27,v27,v240,v244
v_mfma_f32_16x16x32_bf16 v[68:71],a[144:147],v[240:243],v[68:71]
ds_read_b128 v[236:239],v18 offset:22528
v_mfma_f32_16x16x32_bf16 v[64:67],a[20:23],v[244:247],v[64:67]
buffer_load_dwordx4 v16,s[20:23],s65 offen offset:0 sc1 lds
v_mfma_f32_16x16x32_bf16 v[68:71],a[148:151],v[244:247],v[68:71]
ds_read_b128 v[240:243],v18 offset:24576
s_waitcnt lgkmcnt(5)
v_mfma_f32_16x16x32_bf16 v[64:67],a[24:27],v[248:251],v[64:67]
buffer_load_dwordx4 v16,s[20:23],s65 offen offset:2048 sc1 lds
v_mfma_f32_16x16x32_bf16 v[68:71],a[152:155],v[248:251],v[68:71]
ds_read_b128 v[244:247],v18 offset:26624
v_min3_u32 v27,v27,v248,v252
v_mfma_f32_16x16x32_bf16 v[64:67],a[28:31],v[252:255],v[64:67]
s_xor_b32 m0,s72,16384
v_mfma_f32_16x16x32_bf16 v[68:71],a[156:159],v[252:255],v[68:71]
ds_read_b128 v[248:251],v18 offset:28672
s_waitcnt lgkmcnt(5)
v_mfma_f32_16x16x32_bf16 v[64:67],a[32:35],v[224:227],v[64:67]
s_add_u32 s65,s88,32768
v_min3_u32 v27,v27,v224,v228
v_mfma_f32_16x16x32_bf16 v[68:71],a[160:163],v[224:227],v[68:71]
ds_read_b128 v[252:255],v18 offset:30720
v_mfma_f32_16x16x32_bf16 v[64:67],a[36:39],v[228:231],v[64:67]
s_waitcnt vmcnt(4)
buffer_load_dwordx4 v16,s[20:23],s65 offen offset:0 sc1 lds
v_mfma_f32_16x16x32_bf16 v[68:71],a[164:167],v[228:231],v[68:71]
ds_read_b128 v[224:227],v18 offset:32768
s_waitcnt lgkmcnt(5)
v_mfma_f32_16x16x32_bf16 v[64:67],a[40:43],v[232:235],v[64:67]
v_cmp_gt_u32 vcc,s96,v29
v_cmp_gt_u32 s[92:93],s92,v29
v_min3_u32 v27,v27,v232,v236
v_mfma_f32_16x16x32_bf16 v[68:71],a[168:171],v[232:235],v[68:71]
ds_read_b128 v[228:231],v18 offset:34816
buffer_load_dwordx4 v16,s[20:23],s65 offen offset:2048 sc1 lds
v_mfma_f32_16x16x32_bf16 v[64:67],a[44:47],v[236:239],v[64:67]
v_mov_b32 v44,vcc_lo
v_mov_b32 v45,s92
v_mfma_f32_16x16x32_bf16 v[68:71],a[172:175],v[236:239],v[68:71]
ds_read_b128 v[232:235],v18 offset:36864
s_xor_b32 m0,s72,32768
s_waitcnt lgkmcnt(5)
v_mfma_f32_16x16x32_bf16 v[64:67],a[48:51],v[240:243],v[64:67]
ds_write_b64 v46,v[44:45]
v_min3_u32 v27,v27,v240,v244
v_mfma_f32_16x16x32_bf16 v[68:71],a[176:179],v[240:243],v[68:71]
ds_read_b128 v[236:239],v18 offset:38912
s_add_u32 s65,s88,65536
v_mfma_f32_16x16x32_bf16 v[64:67],a[52:55],v[244:247],v[64:67]
buffer_load_dwordx2 v[120:121],v20,s[36:39],s78 offen
v_mfma_f32_16x16x32_bf16 v[68:71],a[180:183],v[244:247],v[68:71]
ds_read_b128 v[240:243],v18 offset:40960
s_waitcnt lgkmcnt(6)
v_mfma_f32_16x16x32_bf16 v[64:67],a[56:59],v[248:251],v[64:67]
buffer_load_dwordx4 v16,s[20:23],s65 offen offset:0 sc1 lds
v_mfma_f32_16x16x32_bf16 v[68:71],a[184:187],v[248:251],v[68:71]
ds_read_b128 v[244:247],v18 offset:43008
buffer_load_dwordx4 v16,s[20:23],s65 offen offset:2048 sc1 lds
v_mfma_f32_16x16x32_bf16 v[64:67],a[60:63],v[252:255],v[64:67]
v_min3_u32 v27,v27,v248,v252
v_mfma_f32_16x16x32_bf16 v[68:71],a[188:191],v[252:255],v[68:71]
ds_read_b128 v[248:251],v18 offset:45056
s_xor_b32 m0,s72,49152
s_waitcnt lgkmcnt(6)
v_mfma_f32_16x16x32_bf16 v[64:67],a[64:67],v[224:227],v[64:67]
v_min3_u32 v27,v27,v224,v228
v_mfma_f32_16x16x32_bf16 v[68:71],a[192:195],v[224:227],v[68:71]
ds_read_b128 v[252:255],v18 offset:47104
s_add_u32 s65,s88,98304
v_mfma_f32_16x16x32_bf16 v[64:67],a[68:71],v[228:231],v[64:67]
v_mfma_f32_16x16x32_bf16 v[68:71],a[196:199],v[228:231],v[68:71]
ds_read_b128 v[224:227],v18 offset:49152
s_waitcnt lgkmcnt(5)
v_mfma_f32_16x16x32_bf16 v[64:67],a[72:75],v[232:235],v[64:67]
buffer_load_dwordx4 v16,s[20:23],s65 offen offset:0 sc1 lds
v_mfma_f32_16x16x32_bf16 v[68:71],a[200:203],v[232:235],v[68:71]
ds_read_b128 v[228:231],v18 offset:51200
buffer_load_dwordx4 v16,s[20:23],s65 offen offset:2048 sc1 lds
v_mfma_f32_16x16x32_bf16 v[64:67],a[76:79],v[236:239],v[64:67]
v_min3_u32 v27,v27,v232,v236
v_mfma_f32_16x16x32_bf16 v[68:71],a[204:207],v[236:239],v[68:71]
ds_read_b128 v[232:235],v18 offset:53248
s_waitcnt lgkmcnt(5)
v_mfma_f32_16x16x32_bf16 v[64:67],a[80:83],v[240:243],v[64:67]
s_waitcnt vmcnt(16)
s_barrier
ds_read_b64 v[44:45],v47
ds_read_b128 v[128:131],v17 offset:0
ds_read_b128 v[132:135],v17 offset:2048
v_mfma_f32_16x16x32_bf16 v[68:71],a[208:211],v[240:243],v[68:71]
ds_read_b128 v[236:239],v18 offset:55296
s_xor_b32 m0,s72,1024
v_min3_u32 v27,v27,v240,v244
v_mfma_f32_16x16x32_bf16 v[64:67],a[84:87],v[244:247],v[64:67]
ds_read_b128 v[136:139],v17 offset:4096
s_add_u32 s65,s89,0
v_mfma_f32_16x16x32_bf16 v[68:71],a[212:215],v[244:247],v[68:71]
ds_read_b128 v[240:243],v18 offset:57344
s_waitcnt lgkmcnt(9)
v_mfma_f32_16x16x32_bf16 v[64:67],a[88:91],v[248:251],v[64:67]
ds_read_b128 v[140:143],v17 offset:6144
buffer_load_dwordx4 v16,s[20:23],s65 offen offset:0 sc1 lds
v_mfma_f32_16x16x32_bf16 v[68:71],a[216:219],v[248:251],v[68:71]
ds_read_b128 v[244:247],v18 offset:59392
v_min3_u32 v27,v27,v248,v252
v_mfma_f32_16x16x32_bf16 v[64:67],a[92:95],v[252:255],v[64:67]
ds_read_b128 v[144:147],v17 offset:8192
ds_read_b128 v[148:151],v17 offset:10240
v_mfma_f32_16x16x32_bf16 v[68:71],a[220:223],v[252:255],v[68:71]
ds_read_b128 v[248:251],v18 offset:61440
s_waitcnt lgkmcnt(12)
v_mfma_f32_16x16x32_bf16 v[64:67],a[96:99],v[224:227],v[64:67]
ds_read_b128 v[152:155],v17 offset:12288
s_waitcnt lgkmcnt(11)
v_min3_u32 v27,v27,v224,v228
v_mfma_f32_16x16x32_bf16 v[68:71],a[224:227],v[224:227],v[68:71]
ds_read_b128 v[252:255],v18 offset:63488
v_readfirstlane_b32 s93,v45
v_mfma_f32_16x16x32_bf16 v[64:67],a[100:103],v[228:231],v[64:67]
ds_read_b128 v[156:159],v17 offset:14336
buffer_load_dwordx4 v16,s[20:23],s65 offen offset:2048 sc1 lds
v_mfma_f32_16x16x32_bf16 v[68:71],a[228:231],v[228:231],v[68:71]
s_xor_b32 m0,s72,17408
s_add_u32 s65,s89,32768
s_waitcnt lgkmcnt(10)
v_mfma_f32_16x16x32_bf16 v[64:67],a[104:107],v[232:235],v[64:67]
ds_read_b128 v[160:163],v17 offset:16384
ds_read_b128 v[164:167],v17 offset:18432
v_min3_u32 v27,v27,v232,v236
v_mfma_f32_16x16x32_bf16 v[68:71],a[232:235],v[232:235],v[68:71]
buffer_load_dwordx4 v16,s[20:23],s65 offen offset:0 sc1 lds
s_waitcnt vmcnt(12)
v_mfma_f32_16x16x32_bf16 v[64:67],a[108:111],v[236:239],v[64:67]
ds_read_b128 v[168:171],v17 offset:20480
buffer_load_dwordx4 v16,s[20:23],s65 offen offset:2048 sc1 lds
v_mfma_f32_16x16x32_bf16 v[68:71],a[236:239],v[236:239],v[68:71]
v_add_u32 v22,s71,-1
s_waitcnt lgkmcnt(9)
v_mfma_f32_16x16x32_bf16 v[64:67],a[112:115],v[240:243],v[64:67]
ds_read_b128 v[172:175],v17 offset:22528
v_min3_u32 v27,v27,v240,v244
v_mfma_f32_16x16x32_bf16 v[68:71],a[240:243],v[240:243],v[68:71]
s_xor_b32 m0,s72,33792
buffer_store_dword v22,v23,s[20:23],s97 offen sc1
v_mfma_f32_16x16x32_bf16 v[64:67],a[116:119],v[244:247],v[64:67]
ds_read_b128 v[176:179],v17 offset:24576
ds_read_b128 v[180:183],v17 offset:26624
s_mov_b32 s97,0x7fff0000
v_mfma_f32_16x16x32_bf16 v[68:71],a[244:247],v[244:247],v[68:71]
s_add_u32 s65,s89,65536
s_waitcnt lgkmcnt(7)
v_mfma_f32_16x16x32_bf16 v[64:67],a[120:123],v[248:251],v[64:67]
ds_read_b128 v[184:187],v17 offset:28672
v_min3_u32 v27,v27,v248,v252
v_mfma_f32_16x16x32_bf16 v[68:71],a[248:251],v[248:251],v[68:71]
buffer_load_dwordx4 v16,s[20:23],s65 offen offset:0 sc1 lds
v_mfma_f32_16x16x32_bf16 v[64:67],a[124:127],v[252:255],v[64:67]
ds_read_b128 v[188:191],v17 offset:30720
v_mfma_f32_16x16x32_bf16 v[68:71],a[252:255],v[252:255],v[68:71]
buffer_load_dwordx4 v16,s[20:23],s65 offen offset:2048 sc1 lds
v_mfma_f32_16x16x32_bf16 v[72:75],a[128:131],v[128:131],0
v_cmp_eq_u32 vcc,0,v27
s_cbranch_vccnz retry_281
v_mfma_f32_16x16x32_bf16 v[76:79],a[132:135],v[132:135],0
s_xor_b32 m0,s72,50176
v_min3_u32 v27,v27,v128,v132
v_mfma_f32_16x16x32_bf16 v[72:75],a[136:139],v[136:139],v[72:75]
ds_read_b128 v[192:195],v17 offset:32768
v_mfma_f32_16x16x32_bf16 v[76:79],a[140:143],v[140:143],v[76:79]
ds_read_b128 v[196:199],v17 offset:34816
s_add_u32 s65,s89,98304
s_waitcnt lgkmcnt(10)
v_mfma_f32_16x16x32_bf16 v[72:75],a[144:147],v[144:147],v[72:75]
ds_read_b128 v[200:203],v17 offset:36864
v_min3_u32 v27,v27,v136,v140
s_waitcnt vmcnt(11)
v_mfma_f32_16x16x32_bf16 v[76:79],a[148:151],v[148:151],v[76:79]
ds_read_b128 v[204:207],v17 offset:38912
buffer_load_dwordx4 v16,s[20:23],s65 offen offset:0 sc1 lds
v_mfma_f32_16x16x32_bf16 v[72:75],a[152:155],v[152:155],v[72:75]
ds_read_b128 v[208:211],v17 offset:40960
v_min3_u32 v27,v27,v144,v148
v_and_or_b32 v64,v64,-4,s48
v_mfma_f32_16x16x32_bf16 v[76:79],a[156:159],v[156:159],v[76:79]
buffer_load_dwordx4 v16,s[20:23],s65 offen offset:2048 sc1 lds
s_waitcnt lgkmcnt(9)
v_mfma_f32_16x16x32_bf16 v[72:75],a[160:163],v[160:163],v[72:75]
ds_read_b128 v[212:215],v17 offset:43008
v_min3_u32 v27,v27,v152,v156
s_add_u32 s64,s49,s34
v_mfma_f32_16x16x32_bf16 v[76:79],a[164:167],v[164:167],v[76:79]
ds_read_b128 v[216:219],v17 offset:45056
v_min3_u32 v27,v27,v160,v164
v_mfma_f32_16x16x32_bf16 v[72:75],a[168:171],v[168:171],v[72:75]
ds_read_b128 v[220:223],v17 offset:47104
buffer_store_dwordx4 v[64:67],v25,s[20:23],s64 offen offset:2048
v_mfma_f32_16x16x32_bf16 v[76:79],a[172:175],v[172:175],v[76:79]
ds_read_b128 v[224:227],v17 offset:49152
v_and_or_b32 v68,v68,-4,s48
s_waitcnt lgkmcnt(9)
v_mfma_f32_16x16x32_bf16 v[72:75],a[176:179],v[176:179],v[72:75]
ds_read_b128 v[228:231],v17 offset:51200
v_min3_u32 v27,v27,v168,v172
s_add_u32 s64,s49,s35
v_mfma_f32_16x16x32_bf16 v[76:79],a[180:183],v[180:183],v[76:79]
v_min3_u32 v27,v27,v176,v180
buffer_store_dwordx4 v[68:71],v25,s[20:23],s64 offen offset:3072
v_mfma_f32_16x16x32_bf16 v[72:75],a[184:187],v[184:187],v[72:75]
ds_read_b128 v[232:235],v17 offset:53248
s_mov_b32 s49,0x7fff0000
v_mfma_f32_16x16x32_bf16 v[76:79],a[188:191],v[188:191],v[76:79]
ds_read_b128 v[236:239],v17 offset:55296
s_waitcnt lgkmcnt(8)
v_mfma_f32_16x16x32_bf16 v[72:75],a[192:195],v[192:195],v[72:75]
ds_read_b128 v[240:243],v17 offset:57344
v_min3_u32 v27,v27,v184,v188
v_mfma_f32_16x16x32_bf16 v[76:79],a[196:199],v[196:199],v[76:79]
ds_read_b128 v[244:247],v17 offset:59392
v_min3_u32 v27,v27,v192,v196
v_mfma_f32_16x16x32_bf16 v[72:75],a[200:203],v[200:203],v[72:75]
ds_read_b128 v[248:251],v17 offset:61440
ds_bpermute_b32 v124,v41,v120
v_mfma_f32_16x16x32_bf16 v[76:79],a[204:207],v[204:207],v[76:79]
v_min3_u32 v27,v27,v200,v204
s_waitcnt lgkmcnt(8)
v_mfma_f32_16x16x32_bf16 v[72:75],a[208:211],v[208:211],v[72:75]
ds_read_b128 v[252:255],v17 offset:63488
ds_bpermute_b32 v125,v41,v121
v_mfma_f32_16x16x32_bf16 v[76:79],a[212:215],v[212:215],v[76:79]
v_min3_u32 v27,v27,v208,v212
v_mfma_f32_16x16x32_bf16 v[72:75],a[216:219],v[216:219],v[72:75]
v_mfma_f32_16x16x32_bf16 v[76:79],a[220:223],v[220:223],v[76:79]
v_min3_u32 v27,v27,v216,v220
s_waitcnt lgkmcnt(6)
v_mfma_f32_16x16x32_bf16 v[72:75],a[224:227],v[224:227],v[72:75]
s_waitcnt lgkmcnt(0)
v_mfma_f32_16x16x32_bf16 v[76:79],a[228:231],v[228:231],v[76:79]
v_min3_u32 v27,v27,v224,v228
v_mfma_f32_16x16x32_bf16 v[72:75],a[232:235],v[232:235],v[72:75]
v_lshlrev_b32 v104,16,v124
v_mfma_f32_16x16x32_bf16 v[76:79],a[236:239],v[236:239],v[76:79]
v_min3_u32 v27,v27,v232,v236
v_mfma_f32_16x16x32_bf16 v[72:75],a[240:243],v[240:243],v[72:75]
v_mfma_f32_16x16x32_bf16 v[76:79],a[244:247],v[244:247],v[76:79]
v_min3_u32 v27,v27,v240,v244
v_mfma_f32_16x16x32_bf16 v[72:75],a[248:251],v[248:251],v[72:75]
v_and_b32 v105,s80,v124
v_mfma_f32_16x16x32_bf16 v[76:79],a[252:255],v[252:255],v[76:79]
v_min3_u32 v27,v27,v248,v252
v_mfma_f32_16x16x32_bf16 v[80:83],a[0:3],v[128:131],0
v_cmp_eq_u32 vcc,0,v27
s_cbranch_vccnz retry_281
v_mfma_f32_16x16x32_bf16 v[84:87],a[4:7],v[132:135],0
v_lshlrev_b32 v106,16,v125
v_mfma_f32_16x16x32_bf16 v[80:83],a[8:11],v[136:139],v[80:83]
v_mfma_f32_16x16x32_bf16 v[84:87],a[12:15],v[140:143],v[84:87]
v_mfma_f32_16x16x32_bf16 v[80:83],a[16:19],v[144:147],v[80:83]
v_and_b32 v107,s80,v125
v_add_f32 v72,v72,v76
v_mfma_f32_16x16x32_bf16 v[84:87],a[20:23],v[148:151],v[84:87]
v_add_f32 v73,v73,v77
v_add_f32 v74,v74,v78
v_mfma_f32_16x16x32_bf16 v[80:83],a[24:27],v[152:155],v[80:83]
v_add_f32 v75,v75,v79
v_and_or_b32 v72,v72,-4,s48
v_mfma_f32_16x16x32_bf16 v[84:87],a[28:31],v[156:159],v[84:87]
s_add_u32 s64,s77,s33
v_mfma_f32_16x16x32_bf16 v[80:83],a[32:35],v[160:163],v[80:83]
buffer_store_dwordx4 v[72:75],v25,s[20:23],s64 offen offset:1024
v_mfma_f32_16x16x32_bf16 v[84:87],a[36:39],v[164:167],v[84:87]
v_mfma_f32_16x16x32_bf16 v[80:83],a[40:43],v[168:171],v[80:83]
v_mfma_f32_16x16x32_bf16 v[84:87],a[44:47],v[172:175],v[84:87]
v_mfma_f32_16x16x32_bf16 v[80:83],a[48:51],v[176:179],v[80:83]
v_mfma_f32_16x16x32_bf16 v[84:87],a[52:55],v[180:183],v[84:87]
v_mfma_f32_16x16x32_bf16 v[80:83],a[56:59],v[184:187],v[80:83]
v_mfma_f32_16x16x32_bf16 v[84:87],a[60:63],v[188:191],v[84:87]
v_mfma_f32_16x16x32_bf16 v[80:83],a[64:67],v[192:195],v[80:83]
buffer_load_dwordx4 v[96:99],v26,s[20:23],s77 offen offset:2048 sc1
v_mfma_f32_16x16x32_bf16 v[84:87],a[68:71],v[196:199],v[84:87]
buffer_load_dwordx4 v[100:103],v26,s[20:23],s77 offen offset:3072 sc1
v_mfma_f32_16x16x32_bf16 v[80:83],a[72:75],v[200:203],v[80:83]
v_mfma_f32_16x16x32_bf16 v[84:87],a[76:79],v[204:207],v[84:87]
v_mfma_f32_16x16x32_bf16 v[80:83],a[80:83],v[208:211],v[80:83]
v_mfma_f32_16x16x32_bf16 v[84:87],a[84:87],v[212:215],v[84:87]
v_mfma_f32_16x16x32_bf16 v[80:83],a[88:91],v[216:219],v[80:83]
v_mfma_f32_16x16x32_bf16 v[84:87],a[92:95],v[220:223],v[84:87]
v_mfma_f32_16x16x32_bf16 v[80:83],a[96:99],v[224:227],v[80:83]
v_mfma_f32_16x16x32_bf16 v[84:87],a[100:103],v[228:231],v[84:87]
v_mfma_f32_16x16x32_bf16 v[80:83],a[104:107],v[232:235],v[80:83]
buffer_load_dwordx4 v[92:95],v26,s[20:23],s77 offen offset:1024 sc1
v_mfma_f32_16x16x32_bf16 v[84:87],a[108:111],v[236:239],v[84:87]
v_mfma_f32_16x16x32_bf16 v[80:83],a[112:115],v[240:243],v[80:83]
v_mfma_f32_16x16x32_bf16 v[84:87],a[116:119],v[244:247],v[84:87]
v_mfma_f32_16x16x32_bf16 v[80:83],a[120:123],v[248:251],v[80:83]
v_mfma_f32_16x16x32_bf16 v[84:87],a[124:127],v[252:255],v[84:87]
epi_284:
buffer_load_dword v29,v21,s[20:23],s87 offen sc1
s_nop 6
v_pk_add_f32 v[88:89],v[80:81],v[84:85]
v_pk_add_f32 v[90:91],v[82:83],v[86:87]
s_waitcnt vmcnt(1)
s_branch ic_293
ip_291:
buffer_load_dwordx4 v[92:95],v26,s[20:23],s77 offen offset:1024 sc1
buffer_load_dwordx4 v[96:99],v26,s[20:23],s77 offen offset:2048 sc1
buffer_load_dwordx4 v[100:103],v26,s[20:23],s77 offen offset:3072 sc1
s_waitcnt vmcnt(0)
ic_293:
v_bitop3_b32 v22,v92,v96,v100 bitop3:0x80
v_and_b32 v22,s48,v22
v_cmp_eq_u32 vcc,0,v22
s_cbranch_vccz ik_292
s_sub_u32 s90,s90,1
s_cmp_gt_i32 s90,0
s_cbranch_scc1 ip_291
ik_292:
v_pk_add_f32 v[88:89],v[88:89],v[92:93]
v_pk_add_f32 v[96:97],v[96:97],v[100:101]
v_pk_add_f32 v[90:91],v[90:91],v[94:95]
v_pk_add_f32 v[98:99],v[98:99],v[102:103]
v_pk_add_f32 v[88:89],v[88:89],v[96:97]
v_pk_add_f32 v[90:91],v[90:91],v[98:99]
v_pk_fma_f32 v[88:89],v[88:89],v[52:53],v[104:105]
v_pk_fma_f32 v[90:91],v[90:91],v[54:55],v[106:107]
v_cvt_pk_bf16_f32 v88,v88,v89
v_cvt_pk_bf16_f32 v89,v90,v91
v_max_u32 v88,1,v88
ds_bpermute_b32 v88,v40,v88
ds_bpermute_b32 v89,v40,v89
v_xor_b32 v18,0x10000,v18
s_xor_b32 s49,s77,524288
s_cselect_b32 s64,0,3
s_xor_b32 s48,s48,s64
s_waitcnt lgkmcnt(0)
buffer_store_dwordx2 v[88:89],v19,s[20:23],s70 offen sc1
s_mov_b32 s77,s49
s_add_u32 s78,s78,65536
s_cmp_gt_u32 s71,51
s_cselect_b32 s65,s73,0x7fff0000
s_cselect_b32 s97,0x7fff0000,s73
v_mov_b32 v22,s71
buffer_store_dword v22,v23,s[20:23],s65 offen sc1
v_xor_b32 v17,0x10000,v17
s_xor_b32 s72,s72,0x10000
s_add_u32 s70,s70,2097152
s_xor_b32 s70,s70,0x2000
s_add_u32 s71,s71,1
s_cmp_le_u32 s71,64
s_cbranch_scc1 seg_282
s_endpgm
retry_281:
s_sub_u32 s90,s90,64
s_cmp_lt_i32 s90,0
s_cbranch_scc1 giveup_197
s_mov_b32 s83,1
s_waitcnt vmcnt(0) lgkmcnt(0)
s_barrier
s_branch seg_282
kslow_280:
s_add_u32 s64,s79,0
s_lshl_b32 s70,s64,21
s_lshl_b32 s64,s64,13
s_and_b32 s64,s64,0x2000
s_xor_b32 s64,s64,s62
s_add_u32 s70,s70,s64
s_add_u32 s70,s70,29360128
s_mov_b32 s83,1
s_mov_b32 s87,s74
s_cmp_eq_u32 s50,0
s_cselect_b32 s74,s74,0x7fff0000
v_mov_b32 v47,132096
s_lshl_b32 s64,s50,3
s_add_u32 s64,s64,132096
v_mov_b32 v46,s64
v_mov_b32 v29,0
s_mov_b32 s97,0x7fff0000
seg_297:
s_add_u32 s94,s70,s75
s_xor_b32 s95,s94,1024
s_xor_b32 s91,s72,0x10000
s_waitcnt vmcnt(2)
v_cmp_gt_u32 vcc,s71,v29
s_cbranch_vccz nb_301
s_waitcnt vmcnt(0)
v_add_u32 v22,s71,-1
buffer_store_dword v22,v23,s[20:23],s97 offen sc1
s_mov_b32 s97,0x7fff0000
s_cmp_lg_u32 s50,0
s_cbranch_scc1 nb_301
buffer_load_dword v32,v21,s[20:23],s74 offen sc1
s_sleep 2
pl_302:
buffer_load_dword v33,v21,s[20:23],s74 offen sc1
s_waitcnt vmcnt(1)
v_cmp_gt_u32 vcc,s71,v32
v_mov_b32 v29,v32
s_cbranch_vccz pok_303
buffer_load_dword v32,v21,s[20:23],s74 offen sc1
s_waitcnt vmcnt(1)
v_cmp_gt_u32 vcc,s71,v33
v_mov_b32 v29,v33
s_cbranch_vccz pok_303
s_sub_u32 s90,s90,1
s_cmp_gt_i32 s90,0
s_cbranch_scc1 pl_302
pok_303:
nb_301:
s_barrier
s_xor_b32 m0,s91,0
s_add_u32 s65,s94,0
buffer_load_dwordx4 v16,s[20:23],s65 offen offset:0 sc1 lds
buffer_load_dwordx4 v16,s[20:23],s65 offen offset:2048 sc1 lds
s_xor_b32 m0,s91,16384
s_add_u32 s65,s94,32768
buffer_load_dwordx4 v16,s[20:23],s65 offen offset:0 sc1 lds
buffer_load_dwordx4 v16,s[20:23],s65 offen offset:2048 sc1 lds
s_xor_b32 m0,s91,32768
s_add_u32 s65,s94,65536
buffer_load_dwordx4 v16,s[20:23],s65 offen offset:0 sc1 lds
buffer_load_dwordx4 v16,s[20:23],s65 offen offset:2048 sc1 lds
s_xor_b32 m0,s91,49152
s_add_u32 s65,s94,98304
buffer_load_dwordx4 v16,s[20:23],s65 offen offset:0 sc1 lds
buffer_load_dwordx4 v16,s[20:23],s65 offen offset:2048 sc1 lds
s_waitcnt vmcnt(8)
v_add_u32 v22,s71,-1
buffer_store_dword v22,v23,s[20:23],s97 offen sc1
s_mov_b32 s97,0x7fff0000
s_waitcnt vmcnt(7)
s_barrier
ds_read_b128 v[224:227],v18 offset:0
ds_read_b128 v[228:231],v18 offset:2048
ds_read_b128 v[232:235],v18 offset:4096
ds_read_b128 v[236:239],v18 offset:6144
ds_read_b128 v[240:243],v18 offset:8192
ds_read_b128 v[244:247],v18 offset:10240
ds_read_b128 v[248:251],v18 offset:12288
s_waitcnt lgkmcnt(5)
v_mfma_f32_16x16x32_bf16 v[64:67],a[0:3],v[224:227],0
s_xor_b32 m0,s91,1024
v_min_u32 v27,v224,v228
v_mfma_f32_16x16x32_bf16 v[68:71],a[128:131],v[224:227],0
ds_read_b128 v[252:255],v18 offset:14336
v_mfma_f32_16x16x32_bf16 v[64:67],a[4:7],v[228:231],v[64:67]
s_add_u32 s65,s95,0
v_mfma_f32_16x16x32_bf16 v[68:71],a[132:135],v[228:231],v[68:71]
s_waitcnt vmcnt(5)
s_barrier
ds_read_b128 v[224:227],v18 offset:16384
s_waitcnt lgkmcnt(5)
v_mfma_f32_16x16x32_bf16 v[64:67],a[8:11],v[232:235],v[64:67]
buffer_load_dwordx4 v16,s[20:23],s65 offen offset:0 sc1 lds
v_mfma_f32_16x16x32_bf16 v[68:71],a[136:139],v[232:235],v[68:71]
ds_read_b128 v[228:231],v18 offset:18432
v_min3_u32 v27,v27,v232,v236
v_mfma_f32_16x16x32_bf16 v[64:67],a[12:15],v[236:239],v[64:67]
buffer_load_dwordx4 v16,s[20:23],s65 offen offset:2048 sc1 lds
v_mfma_f32_16x16x32_bf16 v[68:71],a[140:143],v[236:239],v[68:71]
ds_read_b128 v[232:235],v18 offset:20480
s_waitcnt lgkmcnt(5)
v_mfma_f32_16x16x32_bf16 v[64:67],a[16:19],v[240:243],v[64:67]
s_xor_b32 m0,s91,17408
v_min3_u32 v27,v27,v240,v244
v_mfma_f32_16x16x32_bf16 v[68:71],a[144:147],v[240:243],v[68:71]
ds_read_b128 v[236:239],v18 offset:22528
v_mfma_f32_16x16x32_bf16 v[64:67],a[20:23],v[244:247],v[64:67]
s_add_u32 s65,s95,32768
v_mfma_f32_16x16x32_bf16 v[68:71],a[148:151],v[244:247],v[68:71]
ds_read_b128 v[240:243],v18 offset:24576
s_waitcnt lgkmcnt(5)
v_mfma_f32_16x16x32_bf16 v[64:67],a[24:27],v[248:251],v[64:67]
buffer_load_dwordx4 v16,s[20:23],s65 offen offset:0 sc1 lds
v_mfma_f32_16x16x32_bf16 v[68:71],a[152:155],v[248:251],v[68:71]
ds_read_b128 v[244:247],v18 offset:26624
v_min3_u32 v27,v27,v248,v252
v_mfma_f32_16x16x32_bf16 v[64:67],a[28:31],v[252:255],v[64:67]
buffer_load_dwordx4 v16,s[20:23],s65 offen offset:2048 sc1 lds
v_mfma_f32_16x16x32_bf16 v[68:71],a[156:159],v[252:255],v[68:71]
ds_read_b128 v[248:251],v18 offset:28672
s_waitcnt lgkmcnt(5)
v_mfma_f32_16x16x32_bf16 v[64:67],a[32:35],v[224:227],v[64:67]
s_xor_b32 m0,s91,33792
v_min3_u32 v27,v27,v224,v228
v_mfma_f32_16x16x32_bf16 v[68:71],a[160:163],v[224:227],v[68:71]
ds_read_b128 v[252:255],v18 offset:30720
v_mfma_f32_16x16x32_bf16 v[64:67],a[36:39],v[228:231],v[64:67]
s_add_u32 s65,s95,65536
v_mfma_f32_16x16x32_bf16 v[68:71],a[164:167],v[228:231],v[68:71]
s_waitcnt vmcnt(5)
s_barrier
ds_read_b128 v[224:227],v18 offset:32768
s_waitcnt lgkmcnt(5)
v_mfma_f32_16x16x32_bf16 v[64:67],a[40:43],v[232:235],v[64:67]
buffer_load_dwordx4 v16,s[20:23],s65 offen offset:0 sc1 lds
v_mfma_f32_16x16x32_bf16 v[68:71],a[168:171],v[232:235],v[68:71]
ds_read_b128 v[228:231],v18 offset:34816
v_min3_u32 v27,v27,v232,v236
v_mfma_f32_16x16x32_bf16 v[64:67],a[44:47],v[236:239],v[64:67]
buffer_load_dwordx4 v16,s[20:23],s65 offen offset:2048 sc1 lds
v_mfma_f32_16x16x32_bf16 v[68:71],a[172:175],v[236:239],v[68:71]
ds_read_b128 v[232:235],v18 offset:36864
s_waitcnt lgkmcnt(5)
v_mfma_f32_16x16x32_bf16 v[64:67],a[48:51],v[240:243],v[64:67]
s_xor_b32 m0,s91,50176
v_min3_u32 v27,v27,v240,v244
v_mfma_f32_16x16x32_bf16 v[68:71],a[176:179],v[240:243],v[68:71]
ds_read_b128 v[236:239],v18 offset:38912
v_mfma_f32_16x16x32_bf16 v[64:67],a[52:55],v[244:247],v[64:67]
s_add_u32 s65,s95,98304
v_mfma_f32_16x16x32_bf16 v[68:71],a[180:183],v[244:247],v[68:71]
ds_read_b128 v[240:243],v18 offset:40960
s_waitcnt lgkmcnt(5)
v_mfma_f32_16x16x32_bf16 v[64:67],a[56:59],v[248:251],v[64:67]
buffer_load_dwordx4 v16,s[20:23],s65 offen offset:0 sc1 lds
v_mfma_f32_16x16x32_bf16 v[68:71],a[184:187],v[248:251],v[68:71]
ds_read_b128 v[244:247],v18 offset:43008
v_min3_u32 v27,v27,v248,v252
v_mfma_f32_16x16x32_bf16 v[64:67],a[60:63],v[252:255],v[64:67]
buffer_load_dwordx4 v16,s[20:23],s65 offen offset:2048 sc1 lds
v_mfma_f32_16x16x32_bf16 v[68:71],a[188:191],v[252:255],v[68:71]
ds_read_b128 v[248:251],v18 offset:45056
s_waitcnt lgkmcnt(5)
v_mfma_f32_16x16x32_bf16 v[64:67],a[64:67],v[224:227],v[64:67]
v_min3_u32 v27,v27,v224,v228
s_add_u32 s88,s70,s75
v_mfma_f32_16x16x32_bf16 v[68:71],a[192:195],v[224:227],v[68:71]
ds_read_b128 v[252:255],v18 offset:47104
s_add_u32 s88,s88,2097152
v_mfma_f32_16x16x32_bf16 v[64:67],a[68:71],v[228:231],v[64:67]
buffer_load_dwordx2 v[120:121],v20,s[36:39],s78 offen
v_mfma_f32_16x16x32_bf16 v[68:71],a[196:199],v[228:231],v[68:71]
ds_read_b128 v[224:227],v18 offset:49152
s_waitcnt lgkmcnt(5)
v_mfma_f32_16x16x32_bf16 v[64:67],a[72:75],v[232:235],v[64:67]
v_min3_u32 v27,v27,v232,v236
s_xor_b32 s88,s88,0x2000
v_mfma_f32_16x16x32_bf16 v[68:71],a[200:203],v[232:235],v[68:71]
ds_read_b128 v[228:231],v18 offset:51200
s_xor_b32 s89,s88,1024
v_mfma_f32_16x16x32_bf16 v[64:67],a[76:79],v[236:239],v[64:67]
v_mfma_f32_16x16x32_bf16 v[68:71],a[204:207],v[236:239],v[68:71]
ds_read_b128 v[232:235],v18 offset:53248
s_waitcnt lgkmcnt(5)
v_mfma_f32_16x16x32_bf16 v[64:67],a[80:83],v[240:243],v[64:67]
s_waitcnt vmcnt(5)
s_barrier
ds_read_b128 v[128:131],v17 offset:0
ds_read_b128 v[132:135],v17 offset:2048
v_mfma_f32_16x16x32_bf16 v[68:71],a[208:211],v[240:243],v[68:71]
ds_read_b128 v[236:239],v18 offset:55296
v_min3_u32 v27,v27,v240,v244
v_mfma_f32_16x16x32_bf16 v[64:67],a[84:87],v[244:247],v[64:67]
ds_read_b128 v[136:139],v17 offset:4096
v_mfma_f32_16x16x32_bf16 v[68:71],a[212:215],v[244:247],v[68:71]
ds_read_b128 v[240:243],v18 offset:57344
s_waitcnt lgkmcnt(8)
v_mfma_f32_16x16x32_bf16 v[64:67],a[88:91],v[248:251],v[64:67]
ds_read_b128 v[140:143],v17 offset:6144
v_min3_u32 v27,v27,v248,v252
v_mfma_f32_16x16x32_bf16 v[68:71],a[216:219],v[248:251],v[68:71]
ds_read_b128 v[244:247],v18 offset:59392
v_mfma_f32_16x16x32_bf16 v[64:67],a[92:95],v[252:255],v[64:67]
ds_read_b128 v[144:147],v17 offset:8192
ds_read_b128 v[148:151],v17 offset:10240
v_mfma_f32_16x16x32_bf16 v[68:71],a[220:223],v[252:255],v[68:71]
ds_read_b128 v[248:251],v18 offset:61440
s_waitcnt lgkmcnt(11)
v_mfma_f32_16x16x32_bf16 v[64:67],a[96:99],v[224:227],v[64:67]
ds_read_b128 v[152:155],v17 offset:12288
v_min3_u32 v27,v27,v224,v228
v_mfma_f32_16x16x32_bf16 v[68:71],a[224:227],v[224:227],v[68:71]
ds_read_b128 v[252:255],v18 offset:63488
v_mfma_f32_16x16x32_bf16 v[64:67],a[100:103],v[228:231],v[64:67]
ds_read_b128 v[156:159],v17 offset:14336
v_mfma_f32_16x16x32_bf16 v[68:71],a[228:231],v[228:231],v[68:71]
s_waitcnt lgkmcnt(10)
v_mfma_f32_16x16x32_bf16 v[64:67],a[104:107],v[232:235],v[64:67]
ds_read_b128 v[160:163],v17 offset:16384
ds_read_b128 v[164:167],v17 offset:18432
v_mfma_f32_16x16x32_bf16 v[68:71],a[232:235],v[232:235],v[68:71]
v_min3_u32 v27,v27,v232,v236
v_mfma_f32_16x16x32_bf16 v[64:67],a[108:111],v[236:239],v[64:67]
ds_read_b128 v[168:171],v17 offset:20480
v_mfma_f32_16x16x32_bf16 v[68:71],a[236:239],v[236:239],v[68:71]
s_waitcnt lgkmcnt(9)
v_mfma_f32_16x16x32_bf16 v[64:67],a[112:115],v[240:243],v[64:67]
ds_read_b128 v[172:175],v17 offset:22528
v_min3_u32 v27,v27,v240,v244
v_mfma_f32_16x16x32_bf16 v[68:71],a[240:243],v[240:243],v[68:71]
v_mfma_f32_16x16x32_bf16 v[64:67],a[116:119],v[244:247],v[64:67]
ds_read_b128 v[176:179],v17 offset:24576
ds_read_b128 v[180:183],v17 offset:26624
v_mfma_f32_16x16x32_bf16 v[68:71],a[244:247],v[244:247],v[68:71]
s_waitcnt lgkmcnt(7)
v_mfma_f32_16x16x32_bf16 v[64:67],a[120:123],v[248:251],v[64:67]
ds_read_b128 v[184:187],v17 offset:28672
v_min3_u32 v27,v27,v248,v252
v_mfma_f32_16x16x32_bf16 v[68:71],a[248:251],v[248:251],v[68:71]
v_mfma_f32_16x16x32_bf16 v[64:67],a[124:127],v[252:255],v[64:67]
ds_read_b128 v[188:191],v17 offset:30720
v_mfma_f32_16x16x32_bf16 v[68:71],a[252:255],v[252:255],v[68:71]
v_mfma_f32_16x16x32_bf16 v[72:75],a[128:131],v[128:131],0
v_cmp_eq_u32 vcc,0,v27
s_cbranch_vccnz retry_296
v_mfma_f32_16x16x32_bf16 v[76:79],a[132:135],v[132:135],0
v_min3_u32 v27,v27,v128,v132
v_mfma_f32_16x16x32_bf16 v[72:75],a[136:139],v[136:139],v[72:75]
s_waitcnt vmcnt(1)
s_barrier
ds_read_b128 v[192:195],v17 offset:32768
v_mfma_f32_16x16x32_bf16 v[76:79],a[140:143],v[140:143],v[76:79]
ds_read_b128 v[196:199],v17 offset:34816
s_waitcnt lgkmcnt(10)
v_mfma_f32_16x16x32_bf16 v[72:75],a[144:147],v[144:147],v[72:75]
ds_read_b128 v[200:203],v17 offset:36864
v_min3_u32 v27,v27,v136,v140
s_waitcnt vmcnt(0)
v_mfma_f32_16x16x32_bf16 v[76:79],a[148:151],v[148:151],v[76:79]
ds_read_b128 v[204:207],v17 offset:38912
v_min3_u32 v27,v27,v144,v148
v_and_or_b32 v64,v64,-4,s48
v_mfma_f32_16x16x32_bf16 v[72:75],a[152:155],v[152:155],v[72:75]
ds_read_b128 v[208:211],v17 offset:40960
s_add_u32 s64,s49,s34
v_mfma_f32_16x16x32_bf16 v[76:79],a[156:159],v[156:159],v[76:79]
v_min3_u32 v27,v27,v152,v156
s_waitcnt lgkmcnt(9)
v_mfma_f32_16x16x32_bf16 v[72:75],a[160:163],v[160:163],v[72:75]
ds_read_b128 v[212:215],v17 offset:43008
buffer_store_dwordx4 v[64:67],v25,s[20:23],s64 offen offset:2048 sc1
v_mfma_f32_16x16x32_bf16 v[76:79],a[164:167],v[164:167],v[76:79]
ds_read_b128 v[216:219],v17 offset:45056
v_min3_u32 v27,v27,v160,v164
v_and_or_b32 v68,v68,-4,s48
v_mfma_f32_16x16x32_bf16 v[72:75],a[168:171],v[168:171],v[72:75]
ds_read_b128 v[220:223],v17 offset:47104
s_add_u32 s64,s49,s35
v_mfma_f32_16x16x32_bf16 v[76:79],a[172:175],v[172:175],v[76:79]
ds_read_b128 v[224:227],v17 offset:49152
s_waitcnt lgkmcnt(9)
v_mfma_f32_16x16x32_bf16 v[72:75],a[176:179],v[176:179],v[72:75]
ds_read_b128 v[228:231],v17 offset:51200
v_min3_u32 v27,v27,v168,v172
v_mfma_f32_16x16x32_bf16 v[76:79],a[180:183],v[180:183],v[76:79]
v_min3_u32 v27,v27,v176,v180
buffer_store_dwordx4 v[68:71],v25,s[20:23],s64 offen offset:3072 sc1
v_mfma_f32_16x16x32_bf16 v[72:75],a[184:187],v[184:187],v[72:75]
ds_read_b128 v[232:235],v17 offset:53248
s_mov_b32 s49,0x7fff0000
v_mfma_f32_16x16x32_bf16 v[76:79],a[188:191],v[188:191],v[76:79]
ds_read_b128 v[236:239],v17 offset:55296
s_waitcnt lgkmcnt(8)
v_mfma_f32_16x16x32_bf16 v[72:75],a[192:195],v[192:195],v[72:75]
ds_read_b128 v[240:243],v17 offset:57344
v_min3_u32 v27,v27,v184,v188
v_mfma_f32_16x16x32_bf16 v[76:79],a[196:199],v[196:199],v[76:79]
ds_read_b128 v[244:247],v17 offset:59392
v_min3_u32 v27,v27,v192,v196
v_mfma_f32_16x16x32_bf16 v[72:75],a[200:203],v[200:203],v[72:75]
ds_read_b128 v[248:251],v17 offset:61440
ds_bpermute_b32 v124,v41,v120
v_mfma_f32_16x16x32_bf16 v[76:79],a[204:207],v[204:207],v[76:79]
v_min3_u32 v27,v27,v200,v204
s_waitcnt lgkmcnt(8)
v_mfma_f32_16x16x32_bf16 v[72:75],a[208:211],v[208:211],v[72:75]
ds_read_b128 v[252:255],v17 offset:63488
ds_bpermute_b32 v125,v41,v121
v_mfma_f32_16x16x32_bf16 v[76:79],a[212:215],v[212:215],v[76:79]
v_min3_u32 v27,v27,v208,v212
v_mfma_f32_16x16x32_bf16 v[72:75],a[216:219],v[216:219],v[72:75]
v_mfma_f32_16x16x32_bf16 v[76:79],a[220:223],v[220:223],v[76:79]
v_min3_u32 v27,v27,v216,v220
s_waitcnt lgkmcnt(6)
v_mfma_f32_16x16x32_bf16 v[72:75],a[224:227],v[224:227],v[72:75]
s_waitcnt lgkmcnt(0)
v_mfma_f32_16x16x32_bf16 v[76:79],a[228:231],v[228:231],v[76:79]
v_min3_u32 v27,v27,v224,v228
v_mfma_f32_16x16x32_bf16 v[72:75],a[232:235],v[232:235],v[72:75]
v_lshlrev_b32 v104,16,v124
v_mfma_f32_16x16x32_bf16 v[76:79],a[236:239],v[236:239],v[76:79]
v_min3_u32 v27,v27,v232,v236
v_mfma_f32_16x16x32_bf16 v[72:75],a[240:243],v[240:243],v[72:75]
v_mfma_f32_16x16x32_bf16 v[76:79],a[244:247],v[244:247],v[76:79]
v_min3_u32 v27,v27,v240,v244
v_mfma_f32_16x16x32_bf16 v[72:75],a[248:251],v[248:251],v[72:75]
v_and_b32 v105,s80,v124
v_mfma_f32_16x16x32_bf16 v[76:79],a[252:255],v[252:255],v[76:79]
v_min3_u32 v27,v27,v248,v252
v_mfma_f32_16x16x32_bf16 v[80:83],a[0:3],v[128:131],0
v_cmp_eq_u32 vcc,0,v27
s_cbranch_vccnz retry_296
v_mfma_f32_16x16x32_bf16 v[84:87],a[4:7],v[132:135],0
v_lshlrev_b32 v106,16,v125
v_mfma_f32_16x16x32_bf16 v[80:83],a[8:11],v[136:139],v[80:83]
v_mfma_f32_16x16x32_bf16 v[84:87],a[12:15],v[140:143],v[84:87]
v_mfma_f32_16x16x32_bf16 v[80:83],a[16:19],v[144:147],v[80:83]
v_and_b32 v107,s80,v125
v_add_f32 v72,v72,v76
v_mfma_f32_16x16x32_bf16 v[84:87],a[20:23],v[148:151],v[84:87]
v_add_f32 v73,v73,v77
v_add_f32 v74,v74,v78
v_mfma_f32_16x16x32_bf16 v[80:83],a[24:27],v[152:155],v[80:83]
v_add_f32 v75,v75,v79
v_and_or_b32 v72,v72,-4,s48
v_mfma_f32_16x16x32_bf16 v[84:87],a[28:31],v[156:159],v[84:87]
s_add_u32 s64,s77,s33
v_mfma_f32_16x16x32_bf16 v[80:83],a[32:35],v[160:163],v[80:83]
buffer_store_dwordx4 v[72:75],v25,s[20:23],s64 offen offset:1024 sc1
v_mfma_f32_16x16x32_bf16 v[84:87],a[36:39],v[164:167],v[84:87]
v_mfma_f32_16x16x32_bf16 v[80:83],a[40:43],v[168:171],v[80:83]
v_mfma_f32_16x16x32_bf16 v[84:87],a[44:47],v[172:175],v[84:87]
v_mfma_f32_16x16x32_bf16 v[80:83],a[48:51],v[176:179],v[80:83]
v_mfma_f32_16x16x32_bf16 v[84:87],a[52:55],v[180:183],v[84:87]
v_mfma_f32_16x16x32_bf16 v[80:83],a[56:59],v[184:187],v[80:83]
v_mfma_f32_16x16x32_bf16 v[84:87],a[60:63],v[188:191],v[84:87]
v_mfma_f32_16x16x32_bf16 v[80:83],a[64:67],v[192:195],v[80:83]
buffer_load_dwordx4 v[96:99],v26,s[20:23],s77 offen offset:2048 sc1
v_mfma_f32_16x16x32_bf16 v[84:87],a[68:71],v[196:199],v[84:87]
buffer_load_dwordx4 v[100:103],v26,s[20:23],s77 offen offset:3072 sc1
v_mfma_f32_16x16x32_bf16 v[80:83],a[72:75],v[200:203],v[80:83]
v_mfma_f32_16x16x32_bf16 v[84:87],a[76:79],v[204:207],v[84:87]
v_mfma_f32_16x16x32_bf16 v[80:83],a[80:83],v[208:211],v[80:83]
v_mfma_f32_16x16x32_bf16 v[84:87],a[84:87],v[212:215],v[84:87]
v_mfma_f32_16x16x32_bf16 v[80:83],a[88:91],v[216:219],v[80:83]
v_mfma_f32_16x16x32_bf16 v[84:87],a[92:95],v[220:223],v[84:87]
v_mfma_f32_16x16x32_bf16 v[80:83],a[96:99],v[224:227],v[80:83]
v_mfma_f32_16x16x32_bf16 v[84:87],a[100:103],v[228:231],v[84:87]
v_mfma_f32_16x16x32_bf16 v[80:83],a[104:107],v[232:235],v[80:83]
buffer_load_dwordx4 v[92:95],v26,s[20:23],s77 offen offset:1024 sc1
v_mfma_f32_16x16x32_bf16 v[84:87],a[108:111],v[236:239],v[84:87]
v_mfma_f32_16x16x32_bf16 v[80:83],a[112:115],v[240:243],v[80:83]
v_mfma_f32_16x16x32_bf16 v[84:87],a[116:119],v[244:247],v[84:87]
v_mfma_f32_16x16x32_bf16 v[80:83],a[120:123],v[248:251],v[80:83]
v_mfma_f32_16x16x32_bf16 v[84:87],a[124:127],v[252:255],v[84:87]
epi_299:
buffer_load_dword v29,v21,s[20:23],s87 offen sc1
s_nop 6
v_pk_add_f32 v[88:89],v[80:81],v[84:85]
v_pk_add_f32 v[90:91],v[82:83],v[86:87]
s_waitcnt vmcnt(1)
s_branch ic_306
ip_304:
buffer_load_dwordx4 v[92:95],v26,s[20:23],s77 offen offset:1024 sc1
buffer_load_dwordx4 v[96:99],v26,s[20:23],s77 offen offset:2048 sc1
buffer_load_dwordx4 v[100:103],v26,s[20:23],s77 offen offset:3072 sc1
s_waitcnt vmcnt(0)
ic_306:
v_bitop3_b32 v22,v92,v96,v100 bitop3:0x80
v_and_b32 v22,s48,v22
v_cmp_eq_u32 vcc,0,v22
s_cbranch_vccz ik_305
s_sub_u32 s90,s90,1
s_cmp_gt_i32 s90,0
s_cbranch_scc1 ip_304
ik_305:
v_pk_add_f32 v[88:89],v[88:89],v[92:93]
v_pk_add_f32 v[96:97],v[96:97],v[100:101]
v_pk_add_f32 v[90:91],v[90:91],v[94:95]
v_pk_add_f32 v[98:99],v[98:99],v[102:103]
v_pk_add_f32 v[88:89],v[88:89],v[96:97]
v_pk_add_f32 v[90:91],v[90:91],v[98:99]
v_pk_fma_f32 v[88:89],v[88:89],v[52:53],v[104:105]
v_pk_fma_f32 v[90:91],v[90:91],v[54:55],v[106:107]
v_cvt_pk_bf16_f32 v88,v88,v89
v_cvt_pk_bf16_f32 v89,v90,v91
v_max_u32 v88,1,v88
ds_bpermute_b32 v88,v40,v88
ds_bpermute_b32 v89,v40,v89
v_xor_b32 v18,0x10000,v18
s_xor_b32 s49,s77,524288
s_cselect_b32 s64,0,3
s_xor_b32 s48,s48,s64
s_waitcnt lgkmcnt(0)
buffer_store_dwordx2 v[88:89],v19,s[20:23],s70 offen sc1
s_mov_b32 s77,s49
s_add_u32 s78,s78,65536
s_cmp_gt_u32 s71,51
s_cselect_b32 s65,s73,0x7fff0000
s_cselect_b32 s97,0x7fff0000,s73
v_mov_b32 v22,s71
buffer_store_dword v22,v23,s[20:23],s65 offen sc1
v_xor_b32 v17,0x10000,v17
s_xor_b32 s72,s72,0x10000
s_add_u32 s70,s70,2097152
s_xor_b32 s70,s70,0x2000
s_add_u32 s71,s71,1
s_cmp_le_u32 s71,64
s_cbranch_scc1 seg_297
s_endpgm
retry_296:
s_sub_u32 s90,s90,64
s_cmp_lt_i32 s90,0
s_cbranch_scc1 giveup_197
s_mov_b32 s83,1
s_waitcnt vmcnt(0) lgkmcnt(0)
s_barrier
s_branch seg_297
r_w4_216:
s_load_dwordx2 s[4:5],s[0:1],88
s_load_dwordx2 s[6:7],s[0:1],112
s_lshr_b32 s41,s59,3
s_and_b32 s42,s59,7
s_mul_i32 s66,s41,1835008
s_lshl_b32 s64,s42,8
s_add_u32 s66,s66,s64
s_lshl_b32 s67,s50,1
s_and_b32 s64,s41,1
s_add_u32 s67,s67,s64
s_waitcnt lgkmcnt(0)
s_mov_b32 s32,s4
s_and_b32 s33,s5,0xffff
s_mov_b32 s34,0x700000
s_mov_b32 s35,0x20000
s_sub_u32 s36,s6,0x1000
s_subb_u32 s37,s7,0
s_and_b32 s37,s37,0xffff
s_mov_b32 s38,0x401000
s_mov_b32 s39,0x20000
v_lshrrev_b32 v5,2,v3
v_lshl_add_u32 v5,v4,2,v5
v_and_b32 v6,3,v3
v_lshlrev_b32 v6,3,v6
v_lshl_add_u32 v6,v5,8,v6
v_and_b32 v5,7,v5
v_xor_b32 v5,s67,v5
v_lshl_add_u32 v12,v5,5,v6
v_xor_b32 v13,32,v12
v_and_b32 v5,15,v1
v_and_b32 v6,3,v4
v_lshlrev_b32 v6,1,v6
v_xor_b32 v5,v5,v6
v_mul_u32_u24 v6,2048,v4
v_xor_b32 v7,0,v5
v_lshl_add_u32 v8,v7,4,v6
v_xor_b32 v7,8,v5
v_lshl_add_u32 v9,v7,4,v6
s_mul_i32 s74,s50,131072
s_add_u32 s74,s74,s66
s_lshl_b32 s75,s50,14
s_mul_i32 s76,s50,65536
s_add_u32 s76,s76,s66
s_lshl_b32 s77,s50,13
s_add_u32 s64,s74,0
s_add_u32 m0,s75,0
s_nop 0
buffer_load_dwordx4 v8,s[32:35],s64 offen nt lds
s_add_u32 s64,s74,8192
s_add_u32 m0,s75,1024
s_nop 0
buffer_load_dwordx4 v9,s[32:35],s64 offen nt lds
s_add_u32 s64,s74,16384
s_add_u32 m0,s75,2048
s_nop 0
buffer_load_dwordx4 v8,s[32:35],s64 offen nt lds
s_add_u32 s64,s74,24576
s_add_u32 m0,s75,3072
s_nop 0
buffer_load_dwordx4 v9,s[32:35],s64 offen nt lds
s_add_u32 s64,s74,32768
s_add_u32 m0,s75,4096
s_nop 0
buffer_load_dwordx4 v8,s[32:35],s64 offen nt lds
s_add_u32 s64,s74,40960
s_add_u32 m0,s75,5120
s_nop 0
buffer_load_dwordx4 v9,s[32:35],s64 offen nt lds
s_add_u32 s64,s74,49152
s_add_u32 m0,s75,6144
s_nop 0
buffer_load_dwordx4 v8,s[32:35],s64 offen nt lds
s_add_u32 s64,s74,57344
s_add_u32 m0,s75,7168
s_nop 0
buffer_load_dwordx4 v9,s[32:35],s64 offen nt lds
s_add_u32 s64,s74,65536
s_add_u32 m0,s75,8192
s_nop 0
buffer_load_dwordx4 v8,s[32:35],s64 offen nt lds
s_add_u32 s64,s74,73728
s_add_u32 m0,s75,9216
s_nop 0
buffer_load_dwordx4 v9,s[32:35],s64 offen nt lds
s_add_u32 s64,s74,81920
s_add_u32 m0,s75,10240
s_nop 0
buffer_load_dwordx4 v8,s[32:35],s64 offen nt lds
s_add_u32 s64,s74,90112
s_add_u32 m0,s75,11264
s_nop 0
buffer_load_dwordx4 v9,s[32:35],s64 offen nt lds
s_add_u32 s64,s74,98304
s_add_u32 m0,s75,12288
s_nop 0
buffer_load_dwordx4 v8,s[32:35],s64 offen nt lds
s_add_u32 s64,s74,106496
s_add_u32 m0,s75,13312
s_nop 0
buffer_load_dwordx4 v9,s[32:35],s64 offen nt lds
s_add_u32 s64,s74,114688
s_add_u32 m0,s75,14336
s_nop 0
buffer_load_dwordx4 v8,s[32:35],s64 offen nt lds
s_add_u32 s64,s74,122880
s_add_u32 m0,s75,15360
s_nop 0
buffer_load_dwordx4 v9,s[32:35],s64 offen nt lds
s_add_u32 s64,s74,524288
s_add_u32 m0,s75,65536
s_nop 0
buffer_load_dwordx4 v8,s[32:35],s64 offen nt lds
s_add_u32 s64,s74,532480
s_add_u32 m0,s75,66560
s_nop 0
buffer_load_dwordx4 v9,s[32:35],s64 offen nt lds
s_add_u32 s64,s74,540672
s_add_u32 m0,s75,67584
s_nop 0
buffer_load_dwordx4 v8,s[32:35],s64 offen nt lds
s_add_u32 s64,s74,548864
s_add_u32 m0,s75,68608
s_nop 0
buffer_load_dwordx4 v9,s[32:35],s64 offen nt lds
s_add_u32 s64,s74,557056
s_add_u32 m0,s75,69632
s_nop 0
buffer_load_dwordx4 v8,s[32:35],s64 offen nt lds
s_add_u32 s64,s74,565248
s_add_u32 m0,s75,70656
s_nop 0
buffer_load_dwordx4 v9,s[32:35],s64 offen nt lds
s_add_u32 s64,s74,573440
s_add_u32 m0,s75,71680
s_nop 0
buffer_load_dwordx4 v8,s[32:35],s64 offen nt lds
s_add_u32 s64,s74,581632
s_add_u32 m0,s75,72704
s_nop 0
buffer_load_dwordx4 v9,s[32:35],s64 offen nt lds
s_add_u32 s64,s74,589824
s_add_u32 m0,s75,73728
s_nop 0
buffer_load_dwordx4 v8,s[32:35],s64 offen nt lds
s_add_u32 s64,s74,598016
s_add_u32 m0,s75,74752
s_nop 0
buffer_load_dwordx4 v9,s[32:35],s64 offen nt lds
s_add_u32 s64,s74,606208
s_add_u32 m0,s75,75776
s_nop 0
buffer_load_dwordx4 v8,s[32:35],s64 offen nt lds
s_add_u32 s64,s74,614400
s_add_u32 m0,s75,76800
s_nop 0
buffer_load_dwordx4 v9,s[32:35],s64 offen nt lds
s_add_u32 s64,s74,622592
s_add_u32 m0,s75,77824
s_nop 0
buffer_load_dwordx4 v8,s[32:35],s64 offen nt lds
s_add_u32 s64,s74,630784
s_add_u32 m0,s75,78848
s_nop 0
buffer_load_dwordx4 v9,s[32:35],s64 offen nt lds
s_add_u32 s64,s74,638976
s_add_u32 m0,s75,79872
s_nop 0
buffer_load_dwordx4 v8,s[32:35],s64 offen nt lds
s_add_u32 s64,s74,647168
s_add_u32 m0,s75,80896
s_nop 0
buffer_load_dwordx4 v9,s[32:35],s64 offen nt lds
s_waitcnt vmcnt(16)
s_barrier
ds_read_b64_tr_b16 a[0:1],v12 offset:0
ds_read_b64_tr_b16 a[112:113],v13 offset:0
ds_read_b64_tr_b16 a[2:3],v12 offset:4096
ds_read_b64_tr_b16 a[114:115],v13 offset:4096
ds_read_b64_tr_b16 a[4:5],v12 offset:8192
ds_read_b64_tr_b16 a[116:117],v13 offset:8192
ds_read_b64_tr_b16 a[6:7],v12 offset:12288
ds_read_b64_tr_b16 a[118:119],v13 offset:12288
s_waitcnt lgkmcnt(4)
ds_read_b64_tr_b16 a[8:9],v12 offset:16384
ds_read_b64_tr_b16 a[120:121],v13 offset:16384
ds_read_b64_tr_b16 a[10:11],v12 offset:20480
ds_read_b64_tr_b16 a[122:123],v13 offset:20480
ds_read_b64_tr_b16 a[12:13],v12 offset:28672
ds_read_b64_tr_b16 a[124:125],v13 offset:28672
ds_read_b64_tr_b16 a[14:15],v12 offset:32768
ds_read_b64_tr_b16 a[126:127],v13 offset:32768
s_waitcnt lgkmcnt(4)
ds_read_b64_tr_b16 a[16:17],v12 offset:36864
ds_read_b64_tr_b16 a[128:129],v13 offset:36864
ds_read_b64_tr_b16 a[18:19],v12 offset:40960
ds_read_b64_tr_b16 a[130:131],v13 offset:40960
ds_read_b64_tr_b16 a[20:21],v12 offset:45056
ds_read_b64_tr_b16 a[132:133],v13 offset:45056
ds_read_b64_tr_b16 a[22:23],v12 offset:49152
ds_read_b64_tr_b16 a[134:135],v13 offset:49152
s_waitcnt lgkmcnt(4)
ds_read_b64_tr_b16 a[24:25],v12 offset:57344
ds_read_b64_tr_b16 a[136:137],v13 offset:57344
ds_read_b64_tr_b16 a[26:27],v12 offset:61440
ds_read_b64_tr_b16 a[138:139],v13 offset:61440
ds_read_b64_tr_b16 a[96:97],v12 offset:24576
ds_read_b64_tr_b16 a[208:209],v13 offset:24576
ds_read_b64_tr_b16 a[98:99],v12 offset:53248
ds_read_b64_tr_b16 a[210:211],v13 offset:53248
s_waitcnt lgkmcnt(4)
v_xor_b32 v12,0x10000,v12
v_xor_b32 v13,0x10000,v13
s_waitcnt lgkmcnt(0)
s_barrier
s_add_u32 s64,s74,1048576
s_add_u32 m0,s75,0
s_nop 0
buffer_load_dwordx4 v8,s[32:35],s64 offen nt lds
s_add_u32 s64,s74,1056768
s_add_u32 m0,s75,1024
s_nop 0
buffer_load_dwordx4 v9,s[32:35],s64 offen nt lds
s_add_u32 s64,s74,1064960
s_add_u32 m0,s75,2048
s_nop 0
buffer_load_dwordx4 v8,s[32:35],s64 offen nt lds
s_add_u32 s64,s74,1073152
s_add_u32 m0,s75,3072
s_nop 0
buffer_load_dwordx4 v9,s[32:35],s64 offen nt lds
s_add_u32 s64,s74,1081344
s_add_u32 m0,s75,4096
s_nop 0
buffer_load_dwordx4 v8,s[32:35],s64 offen nt lds
s_add_u32 s64,s74,1089536
s_add_u32 m0,s75,5120
s_nop 0
buffer_load_dwordx4 v9,s[32:35],s64 offen nt lds
s_add_u32 s64,s74,1097728
s_add_u32 m0,s75,6144
s_nop 0
buffer_load_dwordx4 v8,s[32:35],s64 offen nt lds
s_add_u32 s64,s74,1105920
s_add_u32 m0,s75,7168
s_nop 0
buffer_load_dwordx4 v9,s[32:35],s64 offen nt lds
s_add_u32 s64,s74,1114112
s_add_u32 m0,s75,8192
s_nop 0
buffer_load_dwordx4 v8,s[32:35],s64 offen nt lds
s_add_u32 s64,s74,1122304
s_add_u32 m0,s75,9216
s_nop 0
buffer_load_dwordx4 v9,s[32:35],s64 offen nt lds
s_add_u32 s64,s74,1130496
s_add_u32 m0,s75,10240
s_nop 0
buffer_load_dwordx4 v8,s[32:35],s64 offen nt lds
s_add_u32 s64,s74,1138688
s_add_u32 m0,s75,11264
s_nop 0
buffer_load_dwordx4 v9,s[32:35],s64 offen nt lds
s_add_u32 s64,s74,1146880
s_add_u32 m0,s75,12288
s_nop 0
buffer_load_dwordx4 v8,s[32:35],s64 offen nt lds
s_add_u32 s64,s74,1155072
s_add_u32 m0,s75,13312
s_nop 0
buffer_load_dwordx4 v9,s[32:35],s64 offen nt lds
s_add_u32 s64,s74,1163264
s_add_u32 m0,s75,14336
s_nop 0
buffer_load_dwordx4 v8,s[32:35],s64 offen nt lds
s_add_u32 s64,s74,1171456
s_add_u32 m0,s75,15360
s_nop 0
buffer_load_dwordx4 v9,s[32:35],s64 offen nt lds
s_waitcnt vmcnt(16)
s_barrier
ds_read_b64_tr_b16 a[28:29],v12 offset:0
ds_read_b64_tr_b16 a[140:141],v13 offset:0
ds_read_b64_tr_b16 a[30:31],v12 offset:4096
ds_read_b64_tr_b16 a[142:143],v13 offset:4096
ds_read_b64_tr_b16 a[32:33],v12 offset:8192
ds_read_b64_tr_b16 a[144:145],v13 offset:8192
ds_read_b64_tr_b16 a[34:35],v12 offset:12288
ds_read_b64_tr_b16 a[146:147],v13 offset:12288
s_waitcnt lgkmcnt(4)
ds_read_b64_tr_b16 a[36:37],v12 offset:20480
ds_read_b64_tr_b16 a[148:149],v13 offset:20480
ds_read_b64_tr_b16 a[38:39],v12 offset:24576
ds_read_b64_tr_b16 a[150:151],v13 offset:24576
ds_read_b64_tr_b16 a[40:41],v12 offset:28672
ds_read_b64_tr_b16 a[152:153],v13 offset:28672
ds_read_b64_tr_b16 a[42:43],v12 offset:32768
ds_read_b64_tr_b16 a[154:155],v13 offset:32768
s_waitcnt lgkmcnt(4)
ds_read_b64_tr_b16 a[44:45],v12 offset:36864
ds_read_b64_tr_b16 a[156:157],v13 offset:36864
ds_read_b64_tr_b16 a[46:47],v12 offset:40960
ds_read_b64_tr_b16 a[158:159],v13 offset:40960
ds_read_b64_tr_b16 a[48:49],v12 offset:49152
ds_read_b64_tr_b16 a[160:161],v13 offset:49152
ds_read_b64_tr_b16 a[50:51],v12 offset:53248
ds_read_b64_tr_b16 a[162:163],v13 offset:53248
s_waitcnt lgkmcnt(4)
ds_read_b64_tr_b16 a[52:53],v12 offset:57344
ds_read_b64_tr_b16 a[164:165],v13 offset:57344
ds_read_b64_tr_b16 a[54:55],v12 offset:61440
ds_read_b64_tr_b16 a[166:167],v13 offset:61440
ds_read_b64_tr_b16 a[100:101],v12 offset:16384
ds_read_b64_tr_b16 a[212:213],v13 offset:16384
ds_read_b64_tr_b16 a[102:103],v12 offset:45056
ds_read_b64_tr_b16 a[214:215],v13 offset:45056
s_waitcnt lgkmcnt(4)
v_xor_b32 v12,0x10000,v12
v_xor_b32 v13,0x10000,v13
s_waitcnt lgkmcnt(0)
s_barrier
s_add_u32 s64,s76,1572864
s_add_u32 m0,s77,65536
s_nop 0
buffer_load_dwordx4 v8,s[32:35],s64 offen nt lds
s_add_u32 s64,s76,1581056
s_add_u32 m0,s77,66560
s_nop 0
buffer_load_dwordx4 v9,s[32:35],s64 offen nt lds
s_add_u32 s64,s76,1589248
s_add_u32 m0,s77,67584
s_nop 0
buffer_load_dwordx4 v8,s[32:35],s64 offen nt lds
s_add_u32 s64,s76,1597440
s_add_u32 m0,s77,68608
s_nop 0
buffer_load_dwordx4 v9,s[32:35],s64 offen nt lds
s_add_u32 s64,s76,1605632
s_add_u32 m0,s77,69632
s_nop 0
buffer_load_dwordx4 v8,s[32:35],s64 offen nt lds
s_add_u32 s64,s76,1613824
s_add_u32 m0,s77,70656
s_nop 0
buffer_load_dwordx4 v9,s[32:35],s64 offen nt lds
s_add_u32 s64,s76,1622016
s_add_u32 m0,s77,71680
s_nop 0
buffer_load_dwordx4 v8,s[32:35],s64 offen nt lds
s_add_u32 s64,s76,1630208
s_add_u32 m0,s77,72704
s_nop 0
buffer_load_dwordx4 v9,s[32:35],s64 offen nt lds
s_waitcnt vmcnt(8)
s_barrier
ds_read_b64_tr_b16 a[56:57],v12 offset:0
ds_read_b64_tr_b16 a[168:169],v13 offset:0
ds_read_b64_tr_b16 a[58:59],v12 offset:4096
ds_read_b64_tr_b16 a[170:171],v13 offset:4096
ds_read_b64_tr_b16 a[60:61],v12 offset:12288
ds_read_b64_tr_b16 a[172:173],v13 offset:12288
ds_read_b64_tr_b16 a[62:63],v12 offset:16384
ds_read_b64_tr_b16 a[174:175],v13 offset:16384
s_waitcnt lgkmcnt(4)
ds_read_b64_tr_b16 a[64:65],v12 offset:20480
ds_read_b64_tr_b16 a[176:177],v13 offset:20480
ds_read_b64_tr_b16 a[66:67],v12 offset:24576
ds_read_b64_tr_b16 a[178:179],v13 offset:24576
ds_read_b64_tr_b16 a[68:69],v12 offset:28672
ds_read_b64_tr_b16 a[180:181],v13 offset:28672
ds_read_b64_tr_b16 a[70:71],v12 offset:32768
ds_read_b64_tr_b16 a[182:183],v13 offset:32768
s_waitcnt lgkmcnt(4)
ds_read_b64_tr_b16 a[72:73],v12 offset:40960
ds_read_b64_tr_b16 a[184:185],v13 offset:40960
ds_read_b64_tr_b16 a[74:75],v12 offset:45056
ds_read_b64_tr_b16 a[186:187],v13 offset:45056
ds_read_b64_tr_b16 a[76:77],v12 offset:49152
ds_read_b64_tr_b16 a[188:189],v13 offset:49152
ds_read_b64_tr_b16 a[78:79],v12 offset:53248
ds_read_b64_tr_b16 a[190:191],v13 offset:53248
s_waitcnt lgkmcnt(4)
ds_read_b64_tr_b16 a[80:81],v12 offset:57344
ds_read_b64_tr_b16 a[192:193],v13 offset:57344
ds_read_b64_tr_b16 a[82:83],v12 offset:61440
ds_read_b64_tr_b16 a[194:195],v13 offset:61440
ds_read_b64_tr_b16 a[104:105],v12 offset:8192
ds_read_b64_tr_b16 a[216:217],v13 offset:8192
ds_read_b64_tr_b16 a[106:107],v12 offset:36864
ds_read_b64_tr_b16 a[218:219],v13 offset:36864
s_waitcnt lgkmcnt(4)
v_xor_b32 v12,0x10000,v12
v_xor_b32 v13,0x10000,v13
s_waitcnt lgkmcnt(0)
s_barrier
s_waitcnt vmcnt(0)
s_barrier
ds_read_b64_tr_b16 a[84:85],v12 offset:4096
ds_read_b64_tr_b16 a[196:197],v13 offset:4096
ds_read_b64_tr_b16 a[86:87],v12 offset:8192
ds_read_b64_tr_b16 a[198:199],v13 offset:8192
ds_read_b64_tr_b16 a[88:89],v12 offset:12288
ds_read_b64_tr_b16 a[200:201],v13 offset:12288
ds_read_b64_tr_b16 a[90:91],v12 offset:16384
ds_read_b64_tr_b16 a[202:203],v13 offset:16384
s_waitcnt lgkmcnt(4)
ds_read_b64_tr_b16 a[92:93],v12 offset:20480
ds_read_b64_tr_b16 a[204:205],v13 offset:20480
ds_read_b64_tr_b16 a[94:95],v12 offset:24576
ds_read_b64_tr_b16 a[206:207],v13 offset:24576
ds_read_b64_tr_b16 a[108:109],v12 offset:0
ds_read_b64_tr_b16 a[220:221],v13 offset:0
ds_read_b64_tr_b16 a[110:111],v12 offset:28672
ds_read_b64_tr_b16 a[222:223],v13 offset:28672
s_waitcnt lgkmcnt(4)
v_xor_b32 v12,0x10000,v12
v_xor_b32 v13,0x10000,v13
s_waitcnt lgkmcnt(0)
s_barrier
v_and_b32 v21,1,v1
v_mul_u32_u24 v21,960,v21
s_mov_b32 s65,21052032
s_mov_b32 s66,1792
pl_309:
buffer_load_dword v22,v21,s[20:23],s65 offen sc1
s_waitcnt vmcnt(0)
v_cmp_gt_u32 vcc,s66,v22
s_cbranch_vccz pok_310
s_sleep 1
s_sub_u32 s90,s90,1
s_cmp_gt_i32 s90,0
s_cbranch_scc1 pl_309
pok_310:
s_lshr_b32 s43,s41,1
s_and_b32 s48,s41,1
s_lshl_b32 s64,s42,7
s_lshl_b32 s65,s50,5
s_add_u32 s64,s64,s65
s_lshl_b32 s65,s48,4
s_add_u32 s64,s64,s65
v_lshl_add_u32 v5,v4,2,s64
v_lshlrev_b32 v6,2,v5
s_mov_b32 s64,20480
buffer_load_dwordx4 v[52:55],v6,s[20:23],s64 offen sc1
v_lshlrev_b32 v10,1,v5
v_and_b32 v6,3,v1
v_sub_u32 v5,v6,v4
v_lshl_add_u32 v5,v5,3,v10
v_lshrrev_b32 v11,2,v1
v_lshl_add_u32 v40,v6,4,v11
v_lshlrev_b32 v40,2,v40
v_lshl_add_u32 v41,v3,2,v4
v_lshlrev_b32 v41,2,v41
s_lshl_b32 s64,s43,10
v_add_u32 v17,s64,v16
v_xor_b32 v18,1024,v17
s_xor_b32 s64,s64,1024
s_lshr_b32 s65,s50,1
s_and_b32 s66,s50,1
s_lshl_b32 s66,s66,12
s_add_u32 s66,s66,s64
s_lshl_b32 s72,s65,13
s_add_u32 s72,s72,s66
s_add_u32 s72,s72,0x10000
s_lshl_b32 s65,s65,14
s_add_u32 s75,s65,s66
s_add_u32 s75,s75,1327104
s_mul_i32 s64,s41,114688
s_add_u32 s75,s75,s64
s_cmp_lt_u32 s50,2
s_cselect_b32 s86,98304,0x40000000
s_lshl_b32 s76,s79,21
s_add_u32 s76,s76,27262976
s_mov_b32 s77,0
s_lshl_b32 s78,s79,16
s_mov_b32 s49,0
s_cmp_eq_u32 s79,0
s_mov_b32 s66,8577024
s_cselect_b32 s66,18874368,s66
s_lshl_b32 s64,s59,14
s_lshl_b32 s65,s50,12
s_add_u32 s65,s65,s66
s_add_u32 s64,s64,s65
v_add_u32 v26,s64,v16
s_lshl_b32 s64,s42,14
s_add_u32 s64,s64,s65
v_add_u32 v25,s64,v16
s_xor_b32 s33,s41,1
s_xor_b32 s34,s41,2
s_xor_b32 s35,s41,3
s_lshl_b32 s33,s33,17
s_lshl_b32 s34,s34,17
s_lshl_b32 s35,s35,17
v_and_b32 v21,7,v1
v_lshlrev_b32 v21,7,v21
v_bfe_u32 v6,v1,3,2
v_lshl_add_u32 v21,v6,2,v21
s_lshl_b32 s74,s41,10
s_add_u32 s74,s74,s63
s_lshl_b32 s64,s60,4
s_add_u32 s74,s74,s64
s_add_u32 s74,s74,20480
s_lshl_b32 s64,s43,4
v_add_u32 v6,s64,v11
v_lshl_add_u32 v19,v6,11,v5
v_add_u32 v6,s64,v11
v_add_u32 v6,30,v6
v_lshl_add_u32 v9,v6,7,v5
v_and_b32 v9,2047,v9
v_and_b32 v7,3,v6
v_lshl_add_u32 v7,v7,11,v9
v_bfe_u32 v8,v6,2,3
v_lshl_add_u32 v7,v8,14,v7
v_mov_b32 v8,0x2000
v_mov_b32 v9,2097152
v_cmp_gt_u32 vcc,32,v6
s_nop 1
v_cndmask_b32 v8,v9,v8,vcc
v_add_u32 v7,v7,v8
v_add_u32 v7,1048576,v7
v_xor_b32 v20,s62,v7
s_lshl_b32 s64,s42,14
s_lshl_b32 s65,s50,11
s_add_u32 s64,s64,s65
s_lshl_b32 s65,s43,10
s_add_u32 s64,s64,s65
s_lshl_b32 s65,s48,3
s_add_u32 s64,s64,s65
s_add_u32 s64,s64,1179648
v_add_u32 v24,s64,v16
s_mov_b32 s84,0xffffff00
s_or_b32 s64,s43,s79
s_cselect_b32 s84,-1,s84
s_mov_b32 s85,-1
s_mov_b32 s48,1
s_waitcnt vmcnt(0)
s_cmp_lg_u32 s56,0
s_cbranch_scc1 kslow_311
s_add_u32 s64,s79,0
s_lshl_b32 s70,s64,21
s_lshl_b32 s64,s64,13
s_and_b32 s64,s64,0x2000
s_xor_b32 s64,s64,s62
s_add_u32 s70,s70,s64
s_add_u32 s70,s70,29360128
s_mov_b32 s83,1
s_mov_b32 s87,s74
s_cmp_eq_u32 s50,0
s_cselect_b32 s74,s74,0x7fff0000
v_mov_b32 v47,132096
s_lshl_b32 s64,s50,3
s_add_u32 s64,s64,132096
v_mov_b32 v46,s64
v_mov_b32 v29,0
s_mov_b32 s97,0x7fff0000
seg_313:
s_cmp_eq_u32 s83,0
s_cbranch_scc1 ahead_314
s_add_u32 s94,s70,s75
s_xor_b32 s95,s94,1024
s_xor_b32 s91,s72,0x10000
s_waitcnt vmcnt(1)
v_cmp_gt_u32 vcc,s71,v29
s_cbranch_vccz nb_317
s_cmp_lg_u32 s50,0
s_cbranch_scc1 nb_317
buffer_load_dword v32,v21,s[20:23],s74 offen sc1
s_sleep 2
pl_318:
buffer_load_dword v33,v21,s[20:23],s74 offen sc1
s_waitcnt vmcnt(1)
v_cmp_gt_u32 vcc,s71,v32
v_mov_b32 v29,v32
s_cbranch_vccz pok_319
buffer_load_dword v32,v21,s[20:23],s74 offen sc1
s_waitcnt vmcnt(1)
v_cmp_gt_u32 vcc,s71,v33
v_mov_b32 v29,v33
s_cbranch_vccz pok_319
s_sub_u32 s90,s90,1
s_cmp_gt_i32 s90,0
s_cbranch_scc1 pl_318
pok_319:
nb_317:
s_barrier
s_xor_b32 m0,s91,0
s_add_u32 s65,s94,0
buffer_load_dwordx4 v16,s[20:23],s65 offen offset:0 sc1 lds
buffer_load_dwordx4 v16,s[20:23],s65 offen offset:2048 sc1 lds
s_xor_b32 m0,s91,16384
s_add_u32 s65,s94,32768
buffer_load_dwordx4 v16,s[20:23],s65 offen offset:0 sc1 lds
buffer_load_dwordx4 v16,s[20:23],s65 offen offset:2048 sc1 lds
s_xor_b32 m0,s91,32768
s_add_u32 s65,s94,65536
buffer_load_dwordx4 v16,s[20:23],s65 offen offset:0 sc1 lds
buffer_load_dwordx4 v16,s[20:23],s65 offen offset:2048 sc1 lds
s_xor_b32 m0,s91,49152
s_add_u32 s65,s94,s86
buffer_load_dwordx4 v16,s[20:23],s65 offen offset:0 sc1 lds
buffer_load_dwordx4 v16,s[20:23],s65 offen offset:2048 sc1 lds
s_waitcnt vmcnt(6)
s_barrier
ds_read_b128 v[224:227],v18 offset:0
ds_read_b128 v[228:231],v18 offset:2048
ds_read_b128 v[232:235],v18 offset:4096
ds_read_b128 v[236:239],v18 offset:6144
ds_read_b128 v[240:243],v18 offset:8192
ds_read_b128 v[244:247],v18 offset:10240
ds_read_b128 v[248:251],v18 offset:12288
s_waitcnt lgkmcnt(5)
v_mfma_f32_16x16x32_bf16 v[64:67],a[0:3],v[224:227],0
s_xor_b32 m0,s91,1024
s_add_u32 s96,s71,1
v_mfma_f32_16x16x32_bf16 v[68:71],a[112:115],v[224:227],0
ds_read_b128 v[252:255],v18 offset:14336
s_add_u32 s92,s71,2
v_mfma_f32_16x16x32_bf16 v[64:67],a[4:7],v[228:231],v[64:67]
s_add_u32 s65,s95,0
v_min_u32 v27,v224,v228
v_mfma_f32_16x16x32_bf16 v[68:71],a[116:119],v[228:231],v[68:71]
s_waitcnt vmcnt(4)
s_barrier
ds_read_b128 v[224:227],v18 offset:16384
s_waitcnt lgkmcnt(5)
v_mfma_f32_16x16x32_bf16 v[64:67],a[8:11],v[232:235],v[64:67]
buffer_load_dwordx4 v16,s[20:23],s65 offen offset:0 sc1 lds
v_mfma_f32_16x16x32_bf16 v[68:71],a[120:123],v[232:235],v[68:71]
ds_read_b128 v[228:231],v18 offset:18432
v_min3_u32 v27,v27,v232,v236
v_mfma_f32_16x16x32_bf16 v[64:67],a[12:15],v[236:239],v[64:67]
buffer_load_dwordx4 v16,s[20:23],s65 offen offset:2048 sc1 lds
v_mfma_f32_16x16x32_bf16 v[68:71],a[124:127],v[236:239],v[68:71]
ds_read_b128 v[232:235],v18 offset:20480
s_waitcnt lgkmcnt(5)
v_mfma_f32_16x16x32_bf16 v[64:67],a[16:19],v[240:243],v[64:67]
s_xor_b32 m0,s91,17408
v_min3_u32 v27,v27,v240,v244
v_mfma_f32_16x16x32_bf16 v[68:71],a[128:131],v[240:243],v[68:71]
ds_read_b128 v[236:239],v18 offset:22528
v_mfma_f32_16x16x32_bf16 v[64:67],a[20:23],v[244:247],v[64:67]
s_add_u32 s65,s95,32768
s_waitcnt vmcnt(63)
v_mfma_f32_16x16x32_bf16 v[68:71],a[132:135],v[244:247],v[68:71]
ds_read_b128 v[240:243],v18 offset:24576
s_waitcnt lgkmcnt(5)
v_mfma_f32_16x16x32_bf16 v[64:67],a[24:27],v[248:251],v[64:67]
buffer_load_dwordx4 v16,s[20:23],s65 offen offset:0 sc1 lds
v_min3_u32 v27,v27,v248,v252
v_mfma_f32_16x16x32_bf16 v[68:71],a[136:139],v[248:251],v[68:71]
ds_read_b128 v[244:247],v18 offset:26624
v_cmp_gt_u32 vcc,s96,v29
v_cmp_gt_u32 s[92:93],s92,v29
v_mfma_f32_16x16x32_bf16 v[64:67],a[28:31],v[252:255],v[64:67]
buffer_load_dwordx4 v16,s[20:23],s65 offen offset:2048 sc1 lds
v_mfma_f32_16x16x32_bf16 v[68:71],a[140:143],v[252:255],v[68:71]
ds_read_b128 v[248:251],v18 offset:28672
s_waitcnt lgkmcnt(5)
v_mfma_f32_16x16x32_bf16 v[64:67],a[32:35],v[224:227],v[64:67]
s_xor_b32 m0,s91,33792
v_mov_b32 v44,vcc_lo
v_mov_b32 v45,s92
v_mfma_f32_16x16x32_bf16 v[68:71],a[144:147],v[224:227],v[68:71]
ds_read_b128 v[252:255],v18 offset:30720
ds_write_b64 v46,v[44:45]
v_mfma_f32_16x16x32_bf16 v[64:67],a[36:39],v[228:231],v[64:67]
s_add_u32 s65,s95,65536
v_min3_u32 v27,v27,v224,v228
v_mfma_f32_16x16x32_bf16 v[68:71],a[148:151],v[228:231],v[68:71]
s_waitcnt vmcnt(4)
s_barrier
ds_read_b128 v[224:227],v18 offset:32768
s_waitcnt lgkmcnt(6)
v_mfma_f32_16x16x32_bf16 v[64:67],a[40:43],v[232:235],v[64:67]
buffer_load_dwordx4 v16,s[20:23],s65 offen offset:0 sc1 lds
s_add_u32 s88,s70,s75
v_mfma_f32_16x16x32_bf16 v[68:71],a[152:155],v[232:235],v[68:71]
ds_read_b128 v[228:231],v18 offset:34816
v_min3_u32 v27,v27,v232,v236
s_add_u32 s88,s88,2097152
v_mfma_f32_16x16x32_bf16 v[64:67],a[44:47],v[236:239],v[64:67]
buffer_load_dwordx4 v16,s[20:23],s65 offen offset:2048 sc1 lds
v_mfma_f32_16x16x32_bf16 v[68:71],a[156:159],v[236:239],v[68:71]
ds_read_b128 v[232:235],v18 offset:36864
s_waitcnt lgkmcnt(6)
v_mfma_f32_16x16x32_bf16 v[64:67],a[48:51],v[240:243],v[64:67]
s_xor_b32 m0,s91,50176
v_min3_u32 v27,v27,v240,v244
v_mfma_f32_16x16x32_bf16 v[68:71],a[160:163],v[240:243],v[68:71]
ds_read_b128 v[236:239],v18 offset:38912
s_xor_b32 s88,s88,0x2000
v_mfma_f32_16x16x32_bf16 v[64:67],a[52:55],v[244:247],v[64:67]
s_add_u32 s65,s95,s86
s_xor_b32 s89,s88,1024
v_mfma_f32_16x16x32_bf16 v[68:71],a[164:167],v[244:247],v[68:71]
ds_read_b128 v[240:243],v18 offset:40960
s_waitcnt lgkmcnt(6)
v_mfma_f32_16x16x32_bf16 v[64:67],a[56:59],v[248:251],v[64:67]
buffer_load_dwordx4 v16,s[20:23],s65 offen offset:0 sc1 lds
v_mfma_f32_16x16x32_bf16 v[68:71],a[168:171],v[248:251],v[68:71]
ds_read_b128 v[244:247],v18 offset:43008
v_min3_u32 v27,v27,v248,v252
v_mfma_f32_16x16x32_bf16 v[64:67],a[60:63],v[252:255],v[64:67]
buffer_load_dwordx4 v16,s[20:23],s65 offen offset:2048 sc1 lds
v_mfma_f32_16x16x32_bf16 v[68:71],a[172:175],v[252:255],v[68:71]
ds_read_b128 v[248:251],v18 offset:45056
s_waitcnt lgkmcnt(5)
v_mfma_f32_16x16x32_bf16 v[64:67],a[64:67],v[224:227],v[64:67]
s_waitcnt vmcnt(4)
s_barrier
ds_read_b64 v[44:45],v47
ds_read_b128 v[128:131],v17 offset:0
ds_read_b128 v[132:135],v17 offset:2048
v_mfma_f32_16x16x32_bf16 v[68:71],a[176:179],v[224:227],v[68:71]
ds_read_b128 v[252:255],v18 offset:47104
v_min3_u32 v27,v27,v224,v228
v_mfma_f32_16x16x32_bf16 v[64:67],a[68:71],v[228:231],v[64:67]
ds_read_b128 v[136:139],v17 offset:4096
buffer_load_dwordx2 v[120:121],v20,s[20:23],s76 offen sc1
v_mfma_f32_16x16x32_bf16 v[68:71],a[180:183],v[228:231],v[68:71]
ds_read_b128 v[224:227],v18 offset:49152
s_waitcnt lgkmcnt(9)
v_mfma_f32_16x16x32_bf16 v[64:67],a[72:75],v[232:235],v[64:67]
ds_read_b128 v[140:143],v17 offset:6144
v_min3_u32 v27,v27,v232,v236
v_mfma_f32_16x16x32_bf16 v[68:71],a[184:187],v[232:235],v[68:71]
ds_read_b128 v[228:231],v18 offset:51200
buffer_load_dwordx2 v[122:123],v24,s[20:23],s70 offen sc1
v_mfma_f32_16x16x32_bf16 v[64:67],a[76:79],v[236:239],v[64:67]
ds_read_b128 v[144:147],v17 offset:8192
ds_read_b128 v[148:151],v17 offset:10240
v_mfma_f32_16x16x32_bf16 v[68:71],a[188:191],v[236:239],v[68:71]
ds_read_b128 v[232:235],v18 offset:53248
s_waitcnt lgkmcnt(12)
v_mfma_f32_16x16x32_bf16 v[64:67],a[80:83],v[240:243],v[64:67]
ds_read_b128 v[152:155],v17 offset:12288
s_waitcnt lgkmcnt(11)
v_min3_u32 v27,v27,v240,v244
v_mfma_f32_16x16x32_bf16 v[68:71],a[192:195],v[240:243],v[68:71]
ds_read_b128 v[236:239],v18 offset:55296
v_readfirstlane_b32 s93,v45
v_mfma_f32_16x16x32_bf16 v[64:67],a[84:87],v[244:247],v[64:67]
ds_read_b128 v[156:159],v17 offset:14336
v_readfirstlane_b32 s83,v44
s_cmp_lg_u32 s83,0
s_cbranch_scc0 keep_320
v_mfma_f32_16x16x32_bf16 v[68:71],a[196:199],v[244:247],v[68:71]
s_waitcnt lgkmcnt(10)
v_mfma_f32_16x16x32_bf16 v[64:67],a[88:91],v[248:251],v[64:67]
ds_read_b128 v[160:163],v17 offset:16384
ds_read_b128 v[164:167],v17 offset:18432
v_mfma_f32_16x16x32_bf16 v[68:71],a[200:203],v[248:251],v[68:71]
v_min3_u32 v27,v27,v248,v252
v_mfma_f32_16x16x32_bf16 v[64:67],a[92:95],v[252:255],v[64:67]
ds_read_b128 v[168:171],v17 offset:20480
v_mfma_f32_16x16x32_bf16 v[68:71],a[204:207],v[252:255],v[68:71]
s_waitcnt lgkmcnt(9)
v_mfma_f32_16x16x32_bf16 v[64:67],a[96:99],v[224:227],v[64:67]
ds_read_b128 v[172:175],v17 offset:22528
v_min3_u32 v27,v27,v224,v228
v_mfma_f32_16x16x32_bf16 v[68:71],a[208:211],v[224:227],v[68:71]
v_min3_u32 v27,v27,v226,v230
v_mfma_f32_16x16x32_bf16 v[64:67],a[100:103],v[228:231],v[64:67]
ds_read_b128 v[176:179],v17 offset:24576
ds_read_b128 v[180:183],v17 offset:26624
v_mfma_f32_16x16x32_bf16 v[68:71],a[212:215],v[228:231],v[68:71]
s_waitcnt lgkmcnt(7)
v_mfma_f32_16x16x32_bf16 v[64:67],a[104:107],v[232:235],v[64:67]
ds_read_b128 v[184:187],v17 offset:28672
v_min3_u32 v27,v27,v232,v236
v_mfma_f32_16x16x32_bf16 v[68:71],a[216:219],v[232:235],v[68:71]
v_min3_u32 v27,v27,v234,v238
v_mfma_f32_16x16x32_bf16 v[64:67],a[108:111],v[236:239],v[64:67]
ds_read_b128 v[188:191],v17 offset:30720
v_mfma_f32_16x16x32_bf16 v[68:71],a[220:223],v[236:239],v[68:71]
v_mfma_f32_16x16x32_bf16 v[72:75],a[112:115],v[128:131],0
v_cmp_eq_u32 vcc,0,v27
s_cbranch_vccnz retry_312
v_mfma_f32_16x16x32_bf16 v[76:79],a[116:119],v[132:135],0
v_min3_u32 v27,v27,v128,v132
v_mfma_f32_16x16x32_bf16 v[72:75],a[120:123],v[136:139],v[72:75]
s_waitcnt vmcnt(2)
s_barrier
ds_read_b128 v[192:195],v17 offset:32768
v_mfma_f32_16x16x32_bf16 v[76:79],a[124:127],v[140:143],v[76:79]
ds_read_b128 v[196:199],v17 offset:34816
s_waitcnt lgkmcnt(10)
v_mfma_f32_16x16x32_bf16 v[72:75],a[128:131],v[144:147],v[72:75]
ds_read_b128 v[200:203],v17 offset:36864
v_min3_u32 v27,v27,v136,v140
s_waitcnt vmcnt(0)
v_mfma_f32_16x16x32_bf16 v[76:79],a[132:135],v[148:151],v[76:79]
ds_read_b128 v[204:207],v17 offset:38912
v_min3_u32 v27,v27,v144,v148
v_and_or_b32 v64,v64,-4,s48
v_mfma_f32_16x16x32_bf16 v[72:75],a[136:139],v[152:155],v[72:75]
ds_read_b128 v[208:211],v17 offset:40960
s_add_u32 s64,s49,s34
v_mfma_f32_16x16x32_bf16 v[76:79],a[140:143],v[156:159],v[76:79]
v_min3_u32 v27,v27,v152,v156
s_waitcnt lgkmcnt(9)
v_mfma_f32_16x16x32_bf16 v[72:75],a[144:147],v[160:163],v[72:75]
ds_read_b128 v[212:215],v17 offset:43008
buffer_store_dwordx4 v[64:67],v25,s[20:23],s64 offen offset:2048
v_mfma_f32_16x16x32_bf16 v[76:79],a[148:151],v[164:167],v[76:79]
ds_read_b128 v[216:219],v17 offset:45056
v_min3_u32 v27,v27,v160,v164
v_and_or_b32 v68,v68,-4,s48
v_mfma_f32_16x16x32_bf16 v[72:75],a[152:155],v[168:171],v[72:75]
ds_read_b128 v[220:223],v17 offset:47104
s_add_u32 s64,s49,s35
v_mfma_f32_16x16x32_bf16 v[76:79],a[156:159],v[172:175],v[76:79]
ds_read_b128 v[224:227],v17 offset:49152
s_waitcnt lgkmcnt(9)
v_mfma_f32_16x16x32_bf16 v[72:75],a[160:163],v[176:179],v[72:75]
ds_read_b128 v[228:231],v17 offset:51200
v_min3_u32 v27,v27,v168,v172
v_mfma_f32_16x16x32_bf16 v[76:79],a[164:167],v[180:183],v[76:79]
v_min3_u32 v27,v27,v176,v180
buffer_store_dwordx4 v[68:71],v25,s[20:23],s64 offen offset:3072
v_mfma_f32_16x16x32_bf16 v[72:75],a[168:171],v[184:187],v[72:75]
ds_read_b128 v[232:235],v17 offset:53248
s_mov_b32 s49,0x7fff0000
v_mfma_f32_16x16x32_bf16 v[76:79],a[172:175],v[188:191],v[76:79]
ds_read_b128 v[236:239],v17 offset:55296
s_waitcnt lgkmcnt(8)
v_mfma_f32_16x16x32_bf16 v[72:75],a[176:179],v[192:195],v[72:75]
v_min3_u32 v27,v27,v184,v188
v_mfma_f32_16x16x32_bf16 v[76:79],a[180:183],v[196:199],v[76:79]
v_min3_u32 v27,v27,v192,v196
ds_bpermute_b32 v124,v41,v120
v_mfma_f32_16x16x32_bf16 v[72:75],a[184:187],v[200:203],v[72:75]
v_mfma_f32_16x16x32_bf16 v[76:79],a[188:191],v[204:207],v[76:79]
v_min3_u32 v27,v27,v200,v204
s_waitcnt lgkmcnt(5)
v_mfma_f32_16x16x32_bf16 v[72:75],a[192:195],v[208:211],v[72:75]
ds_bpermute_b32 v125,v41,v121
v_mfma_f32_16x16x32_bf16 v[76:79],a[196:199],v[212:215],v[76:79]
v_min3_u32 v27,v27,v208,v212
v_lshlrev_b32 v108,16,v122
v_mfma_f32_16x16x32_bf16 v[72:75],a[200:203],v[216:219],v[72:75]
v_mfma_f32_16x16x32_bf16 v[76:79],a[204:207],v[220:223],v[76:79]
v_min3_u32 v27,v27,v216,v220
s_waitcnt lgkmcnt(2)
v_mfma_f32_16x16x32_bf16 v[72:75],a[208:211],v[224:227],v[72:75]
v_and_b32 v109,s80,v122
v_mfma_f32_16x16x32_bf16 v[76:79],a[212:215],v[228:231],v[76:79]
v_min3_u32 v27,v27,v224,v228
v_min3_u32 v27,v27,v226,v230
v_mfma_f32_16x16x32_bf16 v[72:75],a[216:219],v[232:235],v[72:75]
v_lshlrev_b32 v110,16,v123
v_mfma_f32_16x16x32_bf16 v[76:79],a[220:223],v[236:239],v[76:79]
v_min3_u32 v27,v27,v232,v236
v_min3_u32 v27,v27,v234,v238
v_mfma_f32_16x16x32_bf16 v[80:83],a[0:3],v[128:131],0
v_cmp_eq_u32 vcc,0,v27
s_cbranch_vccnz retry_312
v_mfma_f32_16x16x32_bf16 v[84:87],a[4:7],v[132:135],0
v_and_b32 v111,s80,v123
s_waitcnt lgkmcnt(0)
v_mfma_f32_16x16x32_bf16 v[80:83],a[8:11],v[136:139],v[80:83]
v_mfma_f32_16x16x32_bf16 v[84:87],a[12:15],v[140:143],v[84:87]
v_lshlrev_b32 v104,16,v124
v_mfma_f32_16x16x32_bf16 v[80:83],a[16:19],v[144:147],v[80:83]
v_add_f32 v72,v72,v76
v_add_f32 v73,v73,v77
v_mfma_f32_16x16x32_bf16 v[84:87],a[20:23],v[148:151],v[84:87]
v_and_b32 v105,s80,v124
v_add_f32 v74,v74,v78
v_mfma_f32_16x16x32_bf16 v[80:83],a[24:27],v[152:155],v[80:83]
v_add_f32 v75,v75,v79
v_and_or_b32 v72,v72,-4,s48
v_mfma_f32_16x16x32_bf16 v[84:87],a[28:31],v[156:159],v[84:87]
v_lshlrev_b32 v106,16,v125
s_add_u32 s64,s77,s33
v_mfma_f32_16x16x32_bf16 v[80:83],a[32:35],v[160:163],v[80:83]
buffer_store_dwordx4 v[72:75],v25,s[20:23],s64 offen offset:1024
v_mfma_f32_16x16x32_bf16 v[84:87],a[36:39],v[164:167],v[84:87]
v_and_b32 v107,s80,v125
v_mfma_f32_16x16x32_bf16 v[80:83],a[40:43],v[168:171],v[80:83]
v_mfma_f32_16x16x32_bf16 v[84:87],a[44:47],v[172:175],v[84:87]
v_mfma_f32_16x16x32_bf16 v[80:83],a[48:51],v[176:179],v[80:83]
buffer_load_dwordx4 v[96:99],v26,s[20:23],s77 offen offset:2048 sc1
v_mfma_f32_16x16x32_bf16 v[84:87],a[52:55],v[180:183],v[84:87]
buffer_load_dwordx4 v[100:103],v26,s[20:23],s77 offen offset:3072 sc1
v_mfma_f32_16x16x32_bf16 v[80:83],a[56:59],v[184:187],v[80:83]
v_mfma_f32_16x16x32_bf16 v[84:87],a[60:63],v[188:191],v[84:87]
v_mfma_f32_16x16x32_bf16 v[80:83],a[64:67],v[192:195],v[80:83]
v_mfma_f32_16x16x32_bf16 v[84:87],a[68:71],v[196:199],v[84:87]
v_mfma_f32_16x16x32_bf16 v[80:83],a[72:75],v[200:203],v[80:83]
v_mfma_f32_16x16x32_bf16 v[84:87],a[76:79],v[204:207],v[84:87]
v_mfma_f32_16x16x32_bf16 v[80:83],a[80:83],v[208:211],v[80:83]
v_mfma_f32_16x16x32_bf16 v[84:87],a[84:87],v[212:215],v[84:87]
v_mfma_f32_16x16x32_bf16 v[80:83],a[88:91],v[216:219],v[80:83]
buffer_load_dwordx4 v[92:95],v26,s[20:23],s77 offen offset:1024 sc1
v_mfma_f32_16x16x32_bf16 v[84:87],a[92:95],v[220:223],v[84:87]
v_mfma_f32_16x16x32_bf16 v[80:83],a[96:99],v[224:227],v[80:83]
v_mfma_f32_16x16x32_bf16 v[84:87],a[100:103],v[228:231],v[84:87]
v_mfma_f32_16x16x32_bf16 v[80:83],a[104:107],v[232:235],v[80:83]
v_mfma_f32_16x16x32_bf16 v[84:87],a[108:111],v[236:239],v[84:87]
s_branch epi_315
keep_320:
v_mfma_f32_16x16x32_bf16 v[68:71],a[196:199],v[244:247],v[68:71]
s_xor_b32 m0,s72,0
s_waitcnt lgkmcnt(10)
v_mfma_f32_16x16x32_bf16 v[64:67],a[88:91],v[248:251],v[64:67]
ds_read_b128 v[160:163],v17 offset:16384
ds_read_b128 v[164:167],v17 offset:18432
s_add_u32 s65,s88,0
v_mfma_f32_16x16x32_bf16 v[68:71],a[200:203],v[248:251],v[68:71]
buffer_load_dwordx4 v16,s[20:23],s65 offen offset:0 sc1 lds
v_mfma_f32_16x16x32_bf16 v[64:67],a[92:95],v[252:255],v[64:67]
ds_read_b128 v[168:171],v17 offset:20480
v_min3_u32 v27,v27,v248,v252
v_mfma_f32_16x16x32_bf16 v[68:71],a[204:207],v[252:255],v[68:71]
buffer_load_dwordx4 v16,s[20:23],s65 offen offset:2048 sc1 lds
s_waitcnt lgkmcnt(9)
v_mfma_f32_16x16x32_bf16 v[64:67],a[96:99],v[224:227],v[64:67]
ds_read_b128 v[172:175],v17 offset:22528
s_xor_b32 m0,s72,16384
v_min3_u32 v27,v27,v224,v228
v_mfma_f32_16x16x32_bf16 v[68:71],a[208:211],v[224:227],v[68:71]
s_add_u32 s65,s88,32768
v_min3_u32 v27,v27,v226,v230
v_mfma_f32_16x16x32_bf16 v[64:67],a[100:103],v[228:231],v[64:67]
ds_read_b128 v[176:179],v17 offset:24576
ds_read_b128 v[180:183],v17 offset:26624
v_mfma_f32_16x16x32_bf16 v[68:71],a[212:215],v[228:231],v[68:71]
buffer_load_dwordx4 v16,s[20:23],s65 offen offset:0 sc1 lds
s_waitcnt lgkmcnt(7)
v_mfma_f32_16x16x32_bf16 v[64:67],a[104:107],v[232:235],v[64:67]
ds_read_b128 v[184:187],v17 offset:28672
v_min3_u32 v27,v27,v232,v236
v_min3_u32 v27,v27,v234,v238
v_mfma_f32_16x16x32_bf16 v[68:71],a[216:219],v[232:235],v[68:71]
buffer_load_dwordx4 v16,s[20:23],s65 offen offset:2048 sc1 lds
v_mfma_f32_16x16x32_bf16 v[64:67],a[108:111],v[236:239],v[64:67]
ds_read_b128 v[188:191],v17 offset:30720
s_xor_b32 m0,s72,32768
v_mfma_f32_16x16x32_bf16 v[68:71],a[220:223],v[236:239],v[68:71]
s_add_u32 s65,s88,65536
v_mfma_f32_16x16x32_bf16 v[72:75],a[112:115],v[128:131],0
buffer_load_dwordx4 v16,s[20:23],s65 offen offset:0 sc1 lds
v_cmp_eq_u32 vcc,0,v27
s_cbranch_vccnz retry_312
v_mfma_f32_16x16x32_bf16 v[76:79],a[116:119],v[132:135],0
buffer_load_dwordx4 v16,s[20:23],s65 offen offset:2048 sc1 lds
v_mfma_f32_16x16x32_bf16 v[72:75],a[120:123],v[136:139],v[72:75]
s_waitcnt vmcnt(8)
s_barrier
ds_read_b128 v[192:195],v17 offset:32768
v_mfma_f32_16x16x32_bf16 v[76:79],a[124:127],v[140:143],v[76:79]
ds_read_b128 v[196:199],v17 offset:34816
s_waitcnt lgkmcnt(10)
v_mfma_f32_16x16x32_bf16 v[72:75],a[128:131],v[144:147],v[72:75]
ds_read_b128 v[200:203],v17 offset:36864
s_xor_b32 m0,s72,49152
s_waitcnt vmcnt(6)
v_and_or_b32 v64,v64,-4,s48
v_mfma_f32_16x16x32_bf16 v[76:79],a[132:135],v[148:151],v[76:79]
ds_read_b128 v[204:207],v17 offset:38912
s_add_u32 s65,s88,s86
s_add_u32 s64,s49,s34
v_mfma_f32_16x16x32_bf16 v[72:75],a[136:139],v[152:155],v[72:75]
ds_read_b128 v[208:211],v17 offset:40960
v_min3_u32 v27,v27,v128,v132
buffer_store_dwordx4 v[64:67],v25,s[20:23],s64 offen offset:2048
v_mfma_f32_16x16x32_bf16 v[76:79],a[140:143],v[156:159],v[76:79]
v_min3_u32 v27,v27,v136,v140
v_and_or_b32 v68,v68,-4,s48
s_add_u32 s64,s49,s35
s_waitcnt lgkmcnt(9)
v_mfma_f32_16x16x32_bf16 v[72:75],a[144:147],v[160:163],v[72:75]
ds_read_b128 v[212:215],v17 offset:43008
v_min3_u32 v27,v27,v144,v148
buffer_store_dwordx4 v[68:71],v25,s[20:23],s64 offen offset:3072
v_mfma_f32_16x16x32_bf16 v[76:79],a[148:151],v[164:167],v[76:79]
ds_read_b128 v[216:219],v17 offset:45056
v_min3_u32 v27,v27,v152,v156
s_mov_b32 s49,0x7fff0000
v_mfma_f32_16x16x32_bf16 v[72:75],a[152:155],v[168:171],v[72:75]
ds_read_b128 v[220:223],v17 offset:47104
v_min3_u32 v27,v27,v160,v164
v_mfma_f32_16x16x32_bf16 v[76:79],a[156:159],v[172:175],v[76:79]
ds_read_b128 v[224:227],v17 offset:49152
s_waitcnt lgkmcnt(9)
v_mfma_f32_16x16x32_bf16 v[72:75],a[160:163],v[176:179],v[72:75]
ds_read_b128 v[228:231],v17 offset:51200
v_min3_u32 v27,v27,v168,v172
v_mfma_f32_16x16x32_bf16 v[76:79],a[164:167],v[180:183],v[76:79]
buffer_load_dwordx4 v16,s[20:23],s65 offen offset:0 sc1 lds
v_mfma_f32_16x16x32_bf16 v[72:75],a[168:171],v[184:187],v[72:75]
ds_read_b128 v[232:235],v17 offset:53248
v_min3_u32 v27,v27,v176,v180
v_mfma_f32_16x16x32_bf16 v[76:79],a[172:175],v[188:191],v[76:79]
ds_read_b128 v[236:239],v17 offset:55296
s_waitcnt lgkmcnt(8)
v_mfma_f32_16x16x32_bf16 v[72:75],a[176:179],v[192:195],v[72:75]
buffer_load_dwordx4 v16,s[20:23],s65 offen offset:2048 sc1 lds
v_mfma_f32_16x16x32_bf16 v[76:79],a[180:183],v[196:199],v[76:79]
s_xor_b32 m0,s72,1024
s_add_u32 s65,s89,0
v_mfma_f32_16x16x32_bf16 v[72:75],a[184:187],v[200:203],v[72:75]
buffer_load_dwordx4 v16,s[20:23],s65 offen offset:0 sc1 lds
v_mfma_f32_16x16x32_bf16 v[76:79],a[188:191],v[204:207],v[76:79]
v_min3_u32 v27,v27,v184,v188
v_min3_u32 v27,v27,v200,v204
s_waitcnt lgkmcnt(4)
v_mfma_f32_16x16x32_bf16 v[72:75],a[192:195],v[208:211],v[72:75]
buffer_load_dwordx4 v16,s[20:23],s65 offen offset:2048 sc1 lds
v_mfma_f32_16x16x32_bf16 v[76:79],a[196:199],v[212:215],v[76:79]
s_xor_b32 m0,s72,17408
s_add_u32 s65,s89,32768
v_min3_u32 v27,v27,v208,v212
v_mfma_f32_16x16x32_bf16 v[72:75],a[200:203],v[216:219],v[72:75]
buffer_load_dwordx4 v16,s[20:23],s65 offen offset:0 sc1 lds
v_mfma_f32_16x16x32_bf16 v[76:79],a[204:207],v[220:223],v[76:79]
v_min3_u32 v27,v27,v192,v196
v_min3_u32 v27,v27,v216,v220
s_waitcnt lgkmcnt(0)
v_mfma_f32_16x16x32_bf16 v[72:75],a[208:211],v[224:227],v[72:75]
buffer_load_dwordx4 v16,s[20:23],s65 offen offset:2048 sc1 lds
v_mfma_f32_16x16x32_bf16 v[76:79],a[212:215],v[228:231],v[76:79]
s_xor_b32 m0,s72,33792
s_add_u32 s65,s89,65536
v_min3_u32 v27,v27,v224,v228
v_mfma_f32_16x16x32_bf16 v[72:75],a[216:219],v[232:235],v[72:75]
buffer_load_dwordx4 v16,s[20:23],s65 offen offset:0 sc1 lds
v_min3_u32 v27,v27,v226,v230
v_mfma_f32_16x16x32_bf16 v[76:79],a[220:223],v[236:239],v[76:79]
buffer_load_dwordx4 v16,s[20:23],s65 offen offset:2048 sc1 lds
v_min3_u32 v27,v27,v232,v236
v_min3_u32 v27,v27,v234,v238
v_mfma_f32_16x16x32_bf16 v[80:83],a[0:3],v[128:131],0
s_xor_b32 m0,s72,50176
s_add_u32 s65,s89,s86
v_cmp_eq_u32 vcc,0,v27
s_cbranch_vccnz retry_312
v_mfma_f32_16x16x32_bf16 v[84:87],a[4:7],v[132:135],0
buffer_load_dwordx4 v16,s[20:23],s65 offen offset:0 sc1 lds
v_mfma_f32_16x16x32_bf16 v[80:83],a[8:11],v[136:139],v[80:83]
buffer_load_dwordx4 v16,s[20:23],s65 offen offset:2048 sc1 lds
v_mfma_f32_16x16x32_bf16 v[84:87],a[12:15],v[140:143],v[84:87]
ds_bpermute_b32 v124,v41,v120
ds_bpermute_b32 v125,v41,v121
v_mfma_f32_16x16x32_bf16 v[80:83],a[16:19],v[144:147],v[80:83]
v_lshlrev_b32 v108,16,v122
v_and_b32 v109,s80,v122
v_add_f32 v72,v72,v76
v_mfma_f32_16x16x32_bf16 v[84:87],a[20:23],v[148:151],v[84:87]
v_lshlrev_b32 v110,16,v123
v_and_b32 v111,s80,v123
v_add_f32 v73,v73,v77
v_mfma_f32_16x16x32_bf16 v[80:83],a[24:27],v[152:155],v[80:83]
s_waitcnt lgkmcnt(0)
v_lshlrev_b32 v104,16,v124
v_add_f32 v74,v74,v78
v_mfma_f32_16x16x32_bf16 v[84:87],a[28:31],v[156:159],v[84:87]
v_and_b32 v105,s80,v124
v_lshlrev_b32 v106,16,v125
v_mfma_f32_16x16x32_bf16 v[80:83],a[32:35],v[160:163],v[80:83]
v_add_f32 v75,v75,v79
v_and_or_b32 v72,v72,-4,s48
v_mfma_f32_16x16x32_bf16 v[84:87],a[36:39],v[164:167],v[84:87]
v_and_b32 v107,s80,v125
s_add_u32 s64,s77,s33
v_mfma_f32_16x16x32_bf16 v[80:83],a[40:43],v[168:171],v[80:83]
buffer_store_dwordx4 v[72:75],v25,s[20:23],s64 offen offset:1024
v_mfma_f32_16x16x32_bf16 v[84:87],a[44:47],v[172:175],v[84:87]
v_mfma_f32_16x16x32_bf16 v[80:83],a[48:51],v[176:179],v[80:83]
buffer_load_dwordx4 v[96:99],v26,s[20:23],s77 offen offset:2048 sc1
v_mfma_f32_16x16x32_bf16 v[84:87],a[52:55],v[180:183],v[84:87]
buffer_load_dwordx4 v[100:103],v26,s[20:23],s77 offen offset:3072 sc1
v_mfma_f32_16x16x32_bf16 v[80:83],a[56:59],v[184:187],v[80:83]
v_mfma_f32_16x16x32_bf16 v[84:87],a[60:63],v[188:191],v[84:87]
v_mfma_f32_16x16x32_bf16 v[80:83],a[64:67],v[192:195],v[80:83]
v_mfma_f32_16x16x32_bf16 v[84:87],a[68:71],v[196:199],v[84:87]
v_mfma_f32_16x16x32_bf16 v[80:83],a[72:75],v[200:203],v[80:83]
v_mfma_f32_16x16x32_bf16 v[84:87],a[76:79],v[204:207],v[84:87]
v_mfma_f32_16x16x32_bf16 v[80:83],a[80:83],v[208:211],v[80:83]
v_mfma_f32_16x16x32_bf16 v[84:87],a[84:87],v[212:215],v[84:87]
v_mfma_f32_16x16x32_bf16 v[80:83],a[88:91],v[216:219],v[80:83]
buffer_load_dwordx4 v[92:95],v26,s[20:23],s77 offen offset:1024 sc1
v_mfma_f32_16x16x32_bf16 v[84:87],a[92:95],v[220:223],v[84:87]
v_mfma_f32_16x16x32_bf16 v[80:83],a[96:99],v[224:227],v[80:83]
v_mfma_f32_16x16x32_bf16 v[84:87],a[100:103],v[228:231],v[84:87]
v_mfma_f32_16x16x32_bf16 v[80:83],a[104:107],v[232:235],v[80:83]
v_mfma_f32_16x16x32_bf16 v[84:87],a[108:111],v[236:239],v[84:87]
s_branch epi_315
ahead_314:
s_cmp_eq_u32 s93,0
s_cbranch_scc1 both_316
s_waitcnt vmcnt(14) lgkmcnt(0)
s_barrier
ds_read_b128 v[224:227],v18 offset:0
ds_read_b128 v[228:231],v18 offset:2048
ds_read_b128 v[232:235],v18 offset:4096
ds_read_b128 v[236:239],v18 offset:6144
ds_read_b128 v[240:243],v18 offset:8192
ds_read_b128 v[244:247],v18 offset:10240
ds_read_b128 v[248:251],v18 offset:12288
s_waitcnt lgkmcnt(5)
v_mfma_f32_16x16x32_bf16 v[64:67],a[0:3],v[224:227],0
s_add_u32 s96,s71,1
s_add_u32 s92,s71,2
v_mfma_f32_16x16x32_bf16 v[68:71],a[112:115],v[224:227],0
ds_read_b128 v[252:255],v18 offset:14336
v_min_u32 v27,v224,v228
v_mfma_f32_16x16x32_bf16 v[64:67],a[4:7],v[228:231],v[64:67]
buffer_load_dwordx2 v[120:121],v20,s[20:23],s76 offen sc1
v_mfma_f32_16x16x32_bf16 v[68:71],a[116:119],v[228:231],v[68:71]
ds_read_b128 v[224:227],v18 offset:16384
s_waitcnt lgkmcnt(5)
v_mfma_f32_16x16x32_bf16 v[64:67],a[8:11],v[232:235],v[64:67]
v_min3_u32 v27,v27,v232,v236
v_mfma_f32_16x16x32_bf16 v[68:71],a[120:123],v[232:235],v[68:71]
ds_read_b128 v[228:231],v18 offset:18432
v_mfma_f32_16x16x32_bf16 v[64:67],a[12:15],v[236:239],v[64:67]
buffer_load_dwordx2 v[122:123],v24,s[20:23],s70 offen sc1
v_mfma_f32_16x16x32_bf16 v[68:71],a[124:127],v[236:239],v[68:71]
ds_read_b128 v[232:235],v18 offset:20480
s_waitcnt lgkmcnt(5)
v_mfma_f32_16x16x32_bf16 v[64:67],a[16:19],v[240:243],v[64:67]
v_min3_u32 v27,v27,v240,v244
v_mfma_f32_16x16x32_bf16 v[68:71],a[128:131],v[240:243],v[68:71]
ds_read_b128 v[236:239],v18 offset:22528
v_mfma_f32_16x16x32_bf16 v[64:67],a[20:23],v[244:247],v[64:67]
s_waitcnt vmcnt(3)
v_mfma_f32_16x16x32_bf16 v[68:71],a[132:135],v[244:247],v[68:71]
ds_read_b128 v[240:243],v18 offset:24576
s_waitcnt lgkmcnt(5)
v_mfma_f32_16x16x32_bf16 v[64:67],a[24:27],v[248:251],v[64:67]
v_cmp_gt_u32 vcc,s96,v29
v_cmp_gt_u32 s[92:93],s92,v29
v_mfma_f32_16x16x32_bf16 v[68:71],a[136:139],v[248:251],v[68:71]
ds_read_b128 v[244:247],v18 offset:26624
v_min3_u32 v27,v27,v248,v252
v_mfma_f32_16x16x32_bf16 v[64:67],a[28:31],v[252:255],v[64:67]
v_mov_b32 v44,vcc_lo
v_mov_b32 v45,s92
v_mfma_f32_16x16x32_bf16 v[68:71],a[140:143],v[252:255],v[68:71]
ds_read_b128 v[248:251],v18 offset:28672
s_waitcnt lgkmcnt(5)
v_mfma_f32_16x16x32_bf16 v[64:67],a[32:35],v[224:227],v[64:67]
ds_write_b64 v46,v[44:45]
v_min3_u32 v27,v27,v224,v228
v_mfma_f32_16x16x32_bf16 v[68:71],a[144:147],v[224:227],v[68:71]
ds_read_b128 v[252:255],v18 offset:30720
v_mfma_f32_16x16x32_bf16 v[64:67],a[36:39],v[228:231],v[64:67]
v_mfma_f32_16x16x32_bf16 v[68:71],a[148:151],v[228:231],v[68:71]
ds_read_b128 v[224:227],v18 offset:32768
s_waitcnt lgkmcnt(6)
v_mfma_f32_16x16x32_bf16 v[64:67],a[40:43],v[232:235],v[64:67]
v_min3_u32 v27,v27,v232,v236
s_add_u32 s88,s70,s75
v_mfma_f32_16x16x32_bf16 v[68:71],a[152:155],v[232:235],v[68:71]
ds_read_b128 v[228:231],v18 offset:34816
s_add_u32 s88,s88,2097152
v_mfma_f32_16x16x32_bf16 v[64:67],a[44:47],v[236:239],v[64:67]
s_xor_b32 s88,s88,0x2000
s_xor_b32 s89,s88,1024
v_mfma_f32_16x16x32_bf16 v[68:71],a[156:159],v[236:239],v[68:71]
ds_read_b128 v[232:235],v18 offset:36864
s_waitcnt lgkmcnt(6)
v_mfma_f32_16x16x32_bf16 v[64:67],a[48:51],v[240:243],v[64:67]
v_min3_u32 v27,v27,v240,v244
v_mfma_f32_16x16x32_bf16 v[68:71],a[160:163],v[240:243],v[68:71]
ds_read_b128 v[236:239],v18 offset:38912
v_mfma_f32_16x16x32_bf16 v[64:67],a[52:55],v[244:247],v[64:67]
v_mfma_f32_16x16x32_bf16 v[68:71],a[164:167],v[244:247],v[68:71]
ds_read_b128 v[240:243],v18 offset:40960
s_waitcnt lgkmcnt(5)
v_mfma_f32_16x16x32_bf16 v[64:67],a[56:59],v[248:251],v[64:67]
v_min3_u32 v27,v27,v248,v252
v_mfma_f32_16x16x32_bf16 v[68:71],a[168:171],v[248:251],v[68:71]
ds_read_b128 v[244:247],v18 offset:43008
v_mfma_f32_16x16x32_bf16 v[64:67],a[60:63],v[252:255],v[64:67]
v_mfma_f32_16x16x32_bf16 v[68:71],a[172:175],v[252:255],v[68:71]
ds_read_b128 v[248:251],v18 offset:45056
s_waitcnt lgkmcnt(5)
v_mfma_f32_16x16x32_bf16 v[64:67],a[64:67],v[224:227],v[64:67]
s_waitcnt vmcnt(8)
s_barrier
ds_read_b64 v[44:45],v47
ds_read_b128 v[128:131],v17 offset:0
ds_read_b128 v[132:135],v17 offset:2048
v_mfma_f32_16x16x32_bf16 v[68:71],a[176:179],v[224:227],v[68:71]
ds_read_b128 v[252:255],v18 offset:47104
v_min3_u32 v27,v27,v224,v228
v_mfma_f32_16x16x32_bf16 v[64:67],a[68:71],v[228:231],v[64:67]
ds_read_b128 v[136:139],v17 offset:4096
v_mfma_f32_16x16x32_bf16 v[68:71],a[180:183],v[228:231],v[68:71]
ds_read_b128 v[224:227],v18 offset:49152
s_waitcnt lgkmcnt(9)
v_mfma_f32_16x16x32_bf16 v[64:67],a[72:75],v[232:235],v[64:67]
ds_read_b128 v[140:143],v17 offset:6144
v_min3_u32 v27,v27,v232,v236
v_mfma_f32_16x16x32_bf16 v[68:71],a[184:187],v[232:235],v[68:71]
ds_read_b128 v[228:231],v18 offset:51200
v_mfma_f32_16x16x32_bf16 v[64:67],a[76:79],v[236:239],v[64:67]
ds_read_b128 v[144:147],v17 offset:8192
ds_read_b128 v[148:151],v17 offset:10240
v_mfma_f32_16x16x32_bf16 v[68:71],a[188:191],v[236:239],v[68:71]
ds_read_b128 v[232:235],v18 offset:53248
s_waitcnt lgkmcnt(12)
v_mfma_f32_16x16x32_bf16 v[64:67],a[80:83],v[240:243],v[64:67]
ds_read_b128 v[152:155],v17 offset:12288
s_waitcnt lgkmcnt(11)
v_min3_u32 v27,v27,v240,v244
v_mfma_f32_16x16x32_bf16 v[68:71],a[192:195],v[240:243],v[68:71]
ds_read_b128 v[236:239],v18 offset:55296
v_readfirstlane_b32 s93,v45
v_mfma_f32_16x16x32_bf16 v[64:67],a[84:87],v[244:247],v[64:67]
ds_read_b128 v[156:159],v17 offset:14336
v_readfirstlane_b32 s83,v44
s_cmp_lg_u32 s83,0
s_cbranch_scc1 keep_321
v_mfma_f32_16x16x32_bf16 v[68:71],a[196:199],v[244:247],v[68:71]
s_xor_b32 m0,s72,0
s_waitcnt lgkmcnt(10)
v_mfma_f32_16x16x32_bf16 v[64:67],a[88:91],v[248:251],v[64:67]
ds_read_b128 v[160:163],v17 offset:16384
ds_read_b128 v[164:167],v17 offset:18432
s_add_u32 s65,s88,0
v_mfma_f32_16x16x32_bf16 v[68:71],a[200:203],v[248:251],v[68:71]
buffer_load_dwordx4 v16,s[20:23],s65 offen offset:0 sc1 lds
v_mfma_f32_16x16x32_bf16 v[64:67],a[92:95],v[252:255],v[64:67]
ds_read_b128 v[168:171],v17 offset:20480
v_min3_u32 v27,v27,v248,v252
v_mfma_f32_16x16x32_bf16 v[68:71],a[204:207],v[252:255],v[68:71]
buffer_load_dwordx4 v16,s[20:23],s65 offen offset:2048 sc1 lds
s_waitcnt lgkmcnt(9)
v_mfma_f32_16x16x32_bf16 v[64:67],a[96:99],v[224:227],v[64:67]
ds_read_b128 v[172:175],v17 offset:22528
s_xor_b32 m0,s72,16384
v_min3_u32 v27,v27,v224,v228
v_mfma_f32_16x16x32_bf16 v[68:71],a[208:211],v[224:227],v[68:71]
s_add_u32 s65,s88,32768
v_min3_u32 v27,v27,v226,v230
v_mfma_f32_16x16x32_bf16 v[64:67],a[100:103],v[228:231],v[64:67]
ds_read_b128 v[176:179],v17 offset:24576
ds_read_b128 v[180:183],v17 offset:26624
v_mfma_f32_16x16x32_bf16 v[68:71],a[212:215],v[228:231],v[68:71]
buffer_load_dwordx4 v16,s[20:23],s65 offen offset:0 sc1 lds
s_waitcnt lgkmcnt(7)
v_mfma_f32_16x16x32_bf16 v[64:67],a[104:107],v[232:235],v[64:67]
ds_read_b128 v[184:187],v17 offset:28672
v_min3_u32 v27,v27,v232,v236
v_min3_u32 v27,v27,v234,v238
v_mfma_f32_16x16x32_bf16 v[68:71],a[216:219],v[232:235],v[68:71]
buffer_load_dwordx4 v16,s[20:23],s65 offen offset:2048 sc1 lds
v_mfma_f32_16x16x32_bf16 v[64:67],a[108:111],v[236:239],v[64:67]
ds_read_b128 v[188:191],v17 offset:30720
s_xor_b32 m0,s72,32768
v_mfma_f32_16x16x32_bf16 v[68:71],a[220:223],v[236:239],v[68:71]
s_add_u32 s65,s88,65536
v_mfma_f32_16x16x32_bf16 v[72:75],a[112:115],v[128:131],0
buffer_load_dwordx4 v16,s[20:23],s65 offen offset:0 sc1 lds
v_mfma_f32_16x16x32_bf16 v[76:79],a[116:119],v[132:135],0
buffer_load_dwordx4 v16,s[20:23],s65 offen offset:2048 sc1 lds
v_mfma_f32_16x16x32_bf16 v[72:75],a[120:123],v[136:139],v[72:75]
ds_read_b128 v[192:195],v17 offset:32768
v_cmp_eq_u32 vcc,0,v27
s_cbranch_vccnz retry_312
v_mfma_f32_16x16x32_bf16 v[76:79],a[124:127],v[140:143],v[76:79]
ds_read_b128 v[196:199],v17 offset:34816
s_waitcnt lgkmcnt(10)
v_mfma_f32_16x16x32_bf16 v[72:75],a[128:131],v[144:147],v[72:75]
ds_read_b128 v[200:203],v17 offset:36864
s_xor_b32 m0,s72,49152
s_waitcnt vmcnt(6)
v_and_or_b32 v64,v64,-4,s48
v_mfma_f32_16x16x32_bf16 v[76:79],a[132:135],v[148:151],v[76:79]
ds_read_b128 v[204:207],v17 offset:38912
s_add_u32 s65,s88,s86
s_add_u32 s64,s49,s34
v_mfma_f32_16x16x32_bf16 v[72:75],a[136:139],v[152:155],v[72:75]
ds_read_b128 v[208:211],v17 offset:40960
v_min3_u32 v27,v27,v128,v132
buffer_store_dwordx4 v[64:67],v25,s[20:23],s64 offen offset:2048
v_mfma_f32_16x16x32_bf16 v[76:79],a[140:143],v[156:159],v[76:79]
v_min3_u32 v27,v27,v136,v140
v_and_or_b32 v68,v68,-4,s48
s_add_u32 s64,s49,s35
s_waitcnt lgkmcnt(9)
v_mfma_f32_16x16x32_bf16 v[72:75],a[144:147],v[160:163],v[72:75]
ds_read_b128 v[212:215],v17 offset:43008
v_min3_u32 v27,v27,v144,v148
buffer_store_dwordx4 v[68:71],v25,s[20:23],s64 offen offset:3072
v_mfma_f32_16x16x32_bf16 v[76:79],a[148:151],v[164:167],v[76:79]
ds_read_b128 v[216:219],v17 offset:45056
v_min3_u32 v27,v27,v152,v156
s_mov_b32 s49,0x7fff0000
v_mfma_f32_16x16x32_bf16 v[72:75],a[152:155],v[168:171],v[72:75]
ds_read_b128 v[220:223],v17 offset:47104
v_min3_u32 v27,v27,v160,v164
v_mfma_f32_16x16x32_bf16 v[76:79],a[156:159],v[172:175],v[76:79]
ds_read_b128 v[224:227],v17 offset:49152
s_waitcnt lgkmcnt(9)
v_mfma_f32_16x16x32_bf16 v[72:75],a[160:163],v[176:179],v[72:75]
ds_read_b128 v[228:231],v17 offset:51200
v_min3_u32 v27,v27,v168,v172
v_mfma_f32_16x16x32_bf16 v[76:79],a[164:167],v[180:183],v[76:79]
buffer_load_dwordx4 v16,s[20:23],s65 offen offset:0 sc1 lds
v_mfma_f32_16x16x32_bf16 v[72:75],a[168:171],v[184:187],v[72:75]
ds_read_b128 v[232:235],v17 offset:53248
v_min3_u32 v27,v27,v176,v180
v_mfma_f32_16x16x32_bf16 v[76:79],a[172:175],v[188:191],v[76:79]
ds_read_b128 v[236:239],v17 offset:55296
s_waitcnt lgkmcnt(8)
v_mfma_f32_16x16x32_bf16 v[72:75],a[176:179],v[192:195],v[72:75]
buffer_load_dwordx4 v16,s[20:23],s65 offen offset:2048 sc1 lds
v_mfma_f32_16x16x32_bf16 v[76:79],a[180:183],v[196:199],v[76:79]
s_xor_b32 m0,s72,1024
s_add_u32 s65,s89,0
v_mfma_f32_16x16x32_bf16 v[72:75],a[184:187],v[200:203],v[72:75]
buffer_load_dwordx4 v16,s[20:23],s65 offen offset:0 sc1 lds
v_mfma_f32_16x16x32_bf16 v[76:79],a[188:191],v[204:207],v[76:79]
v_min3_u32 v27,v27,v184,v188
v_min3_u32 v27,v27,v200,v204
s_waitcnt lgkmcnt(4)
v_mfma_f32_16x16x32_bf16 v[72:75],a[192:195],v[208:211],v[72:75]
buffer_load_dwordx4 v16,s[20:23],s65 offen offset:2048 sc1 lds
v_mfma_f32_16x16x32_bf16 v[76:79],a[196:199],v[212:215],v[76:79]
s_xor_b32 m0,s72,17408
s_add_u32 s65,s89,32768
v_min3_u32 v27,v27,v208,v212
v_mfma_f32_16x16x32_bf16 v[72:75],a[200:203],v[216:219],v[72:75]
buffer_load_dwordx4 v16,s[20:23],s65 offen offset:0 sc1 lds
v_mfma_f32_16x16x32_bf16 v[76:79],a[204:207],v[220:223],v[76:79]
v_min3_u32 v27,v27,v192,v196
v_min3_u32 v27,v27,v216,v220
s_waitcnt lgkmcnt(0)
v_mfma_f32_16x16x32_bf16 v[72:75],a[208:211],v[224:227],v[72:75]
buffer_load_dwordx4 v16,s[20:23],s65 offen offset:2048 sc1 lds
v_mfma_f32_16x16x32_bf16 v[76:79],a[212:215],v[228:231],v[76:79]
s_xor_b32 m0,s72,33792
s_add_u32 s65,s89,65536
v_min3_u32 v27,v27,v224,v228
v_mfma_f32_16x16x32_bf16 v[72:75],a[216:219],v[232:235],v[72:75]
buffer_load_dwordx4 v16,s[20:23],s65 offen offset:0 sc1 lds
v_min3_u32 v27,v27,v226,v230
v_mfma_f32_16x16x32_bf16 v[76:79],a[220:223],v[236:239],v[76:79]
buffer_load_dwordx4 v16,s[20:23],s65 offen offset:2048 sc1 lds
v_min3_u32 v27,v27,v232,v236
v_min3_u32 v27,v27,v234,v238
v_mfma_f32_16x16x32_bf16 v[80:83],a[0:3],v[128:131],0
s_xor_b32 m0,s72,50176
s_add_u32 s65,s89,s86
v_cmp_eq_u32 vcc,0,v27
s_cbranch_vccnz retry_312
v_mfma_f32_16x16x32_bf16 v[84:87],a[4:7],v[132:135],0
buffer_load_dwordx4 v16,s[20:23],s65 offen offset:0 sc1 lds
v_mfma_f32_16x16x32_bf16 v[80:83],a[8:11],v[136:139],v[80:83]
buffer_load_dwordx4 v16,s[20:23],s65 offen offset:2048 sc1 lds
v_mfma_f32_16x16x32_bf16 v[84:87],a[12:15],v[140:143],v[84:87]
ds_bpermute_b32 v124,v41,v120
ds_bpermute_b32 v125,v41,v121
v_mfma_f32_16x16x32_bf16 v[80:83],a[16:19],v[144:147],v[80:83]
v_lshlrev_b32 v108,16,v122
v_and_b32 v109,s80,v122
v_add_f32 v72,v72,v76
v_mfma_f32_16x16x32_bf16 v[84:87],a[20:23],v[148:151],v[84:87]
v_lshlrev_b32 v110,16,v123
v_and_b32 v111,s80,v123
v_add_f32 v73,v73,v77
v_mfma_f32_16x16x32_bf16 v[80:83],a[24:27],v[152:155],v[80:83]
s_waitcnt lgkmcnt(0)
v_lshlrev_b32 v104,16,v124
v_add_f32 v74,v74,v78
v_mfma_f32_16x16x32_bf16 v[84:87],a[28:31],v[156:159],v[84:87]
v_and_b32 v105,s80,v124
v_lshlrev_b32 v106,16,v125
v_mfma_f32_16x16x32_bf16 v[80:83],a[32:35],v[160:163],v[80:83]
v_add_f32 v75,v75,v79
v_and_or_b32 v72,v72,-4,s48
v_mfma_f32_16x16x32_bf16 v[84:87],a[36:39],v[164:167],v[84:87]
v_and_b32 v107,s80,v125
s_add_u32 s64,s77,s33
v_mfma_f32_16x16x32_bf16 v[80:83],a[40:43],v[168:171],v[80:83]
buffer_store_dwordx4 v[72:75],v25,s[20:23],s64 offen offset:1024
v_mfma_f32_16x16x32_bf16 v[84:87],a[44:47],v[172:175],v[84:87]
v_mfma_f32_16x16x32_bf16 v[80:83],a[48:51],v[176:179],v[80:83]
buffer_load_dwordx4 v[96:99],v26,s[20:23],s77 offen offset:2048 sc1
v_mfma_f32_16x16x32_bf16 v[84:87],a[52:55],v[180:183],v[84:87]
buffer_load_dwordx4 v[100:103],v26,s[20:23],s77 offen offset:3072 sc1
v_mfma_f32_16x16x32_bf16 v[80:83],a[56:59],v[184:187],v[80:83]
v_mfma_f32_16x16x32_bf16 v[84:87],a[60:63],v[188:191],v[84:87]
v_mfma_f32_16x16x32_bf16 v[80:83],a[64:67],v[192:195],v[80:83]
v_mfma_f32_16x16x32_bf16 v[84:87],a[68:71],v[196:199],v[84:87]
v_mfma_f32_16x16x32_bf16 v[80:83],a[72:75],v[200:203],v[80:83]
v_mfma_f32_16x16x32_bf16 v[84:87],a[76:79],v[204:207],v[84:87]
v_mfma_f32_16x16x32_bf16 v[80:83],a[80:83],v[208:211],v[80:83]
v_mfma_f32_16x16x32_bf16 v[84:87],a[84:87],v[212:215],v[84:87]
v_mfma_f32_16x16x32_bf16 v[80:83],a[88:91],v[216:219],v[80:83]
buffer_load_dwordx4 v[92:95],v26,s[20:23],s77 offen offset:1024 sc1
v_mfma_f32_16x16x32_bf16 v[84:87],a[92:95],v[220:223],v[84:87]
v_mfma_f32_16x16x32_bf16 v[80:83],a[96:99],v[224:227],v[80:83]
v_mfma_f32_16x16x32_bf16 v[84:87],a[100:103],v[228:231],v[84:87]
v_mfma_f32_16x16x32_bf16 v[80:83],a[104:107],v[232:235],v[80:83]
v_mfma_f32_16x16x32_bf16 v[84:87],a[108:111],v[236:239],v[84:87]
s_branch epi_315
keep_321:
v_mfma_f32_16x16x32_bf16 v[68:71],a[196:199],v[244:247],v[68:71]
s_waitcnt lgkmcnt(10)
v_mfma_f32_16x16x32_bf16 v[64:67],a[88:91],v[248:251],v[64:67]
ds_read_b128 v[160:163],v17 offset:16384
ds_read_b128 v[164:167],v17 offset:18432
v_mfma_f32_16x16x32_bf16 v[68:71],a[200:203],v[248:251],v[68:71]
v_min3_u32 v27,v27,v248,v252
v_mfma_f32_16x16x32_bf16 v[64:67],a[92:95],v[252:255],v[64:67]
ds_read_b128 v[168:171],v17 offset:20480
v_mfma_f32_16x16x32_bf16 v[68:71],a[204:207],v[252:255],v[68:71]
s_waitcnt lgkmcnt(9)
v_mfma_f32_16x16x32_bf16 v[64:67],a[96:99],v[224:227],v[64:67]
ds_read_b128 v[172:175],v17 offset:22528
v_min3_u32 v27,v27,v224,v228
v_mfma_f32_16x16x32_bf16 v[68:71],a[208:211],v[224:227],v[68:71]
v_min3_u32 v27,v27,v226,v230
v_mfma_f32_16x16x32_bf16 v[64:67],a[100:103],v[228:231],v[64:67]
ds_read_b128 v[176:179],v17 offset:24576
ds_read_b128 v[180:183],v17 offset:26624
v_mfma_f32_16x16x32_bf16 v[68:71],a[212:215],v[228:231],v[68:71]
s_waitcnt lgkmcnt(7)
v_mfma_f32_16x16x32_bf16 v[64:67],a[104:107],v[232:235],v[64:67]
ds_read_b128 v[184:187],v17 offset:28672
v_min3_u32 v27,v27,v232,v236
v_mfma_f32_16x16x32_bf16 v[68:71],a[216:219],v[232:235],v[68:71]
v_min3_u32 v27,v27,v234,v238
v_mfma_f32_16x16x32_bf16 v[64:67],a[108:111],v[236:239],v[64:67]
ds_read_b128 v[188:191],v17 offset:30720
v_mfma_f32_16x16x32_bf16 v[68:71],a[220:223],v[236:239],v[68:71]
v_mfma_f32_16x16x32_bf16 v[72:75],a[112:115],v[128:131],0
v_cmp_eq_u32 vcc,0,v27
s_cbranch_vccnz retry_312
v_mfma_f32_16x16x32_bf16 v[76:79],a[116:119],v[132:135],0
v_min3_u32 v27,v27,v128,v132
v_mfma_f32_16x16x32_bf16 v[72:75],a[120:123],v[136:139],v[72:75]
ds_read_b128 v[192:195],v17 offset:32768
v_mfma_f32_16x16x32_bf16 v[76:79],a[124:127],v[140:143],v[76:79]
ds_read_b128 v[196:199],v17 offset:34816
s_waitcnt lgkmcnt(10)
v_mfma_f32_16x16x32_bf16 v[72:75],a[128:131],v[144:147],v[72:75]
ds_read_b128 v[200:203],v17 offset:36864
v_min3_u32 v27,v27,v136,v140
s_waitcnt vmcnt(0)
v_mfma_f32_16x16x32_bf16 v[76:79],a[132:135],v[148:151],v[76:79]
ds_read_b128 v[204:207],v17 offset:38912
v_min3_u32 v27,v27,v144,v148
v_and_or_b32 v64,v64,-4,s48
v_mfma_f32_16x16x32_bf16 v[72:75],a[136:139],v[152:155],v[72:75]
ds_read_b128 v[208:211],v17 offset:40960
s_add_u32 s64,s49,s34
v_mfma_f32_16x16x32_bf16 v[76:79],a[140:143],v[156:159],v[76:79]
v_min3_u32 v27,v27,v152,v156
s_waitcnt lgkmcnt(9)
v_mfma_f32_16x16x32_bf16 v[72:75],a[144:147],v[160:163],v[72:75]
ds_read_b128 v[212:215],v17 offset:43008
buffer_store_dwordx4 v[64:67],v25,s[20:23],s64 offen offset:2048
v_mfma_f32_16x16x32_bf16 v[76:79],a[148:151],v[164:167],v[76:79]
ds_read_b128 v[216:219],v17 offset:45056
v_min3_u32 v27,v27,v160,v164
v_and_or_b32 v68,v68,-4,s48
v_mfma_f32_16x16x32_bf16 v[72:75],a[152:155],v[168:171],v[72:75]
ds_read_b128 v[220:223],v17 offset:47104
s_add_u32 s64,s49,s35
v_mfma_f32_16x16x32_bf16 v[76:79],a[156:159],v[172:175],v[76:79]
ds_read_b128 v[224:227],v17 offset:49152
s_waitcnt lgkmcnt(9)
v_mfma_f32_16x16x32_bf16 v[72:75],a[160:163],v[176:179],v[72:75]
ds_read_b128 v[228:231],v17 offset:51200
v_min3_u32 v27,v27,v168,v172
v_mfma_f32_16x16x32_bf16 v[76:79],a[164:167],v[180:183],v[76:79]
v_min3_u32 v27,v27,v176,v180
buffer_store_dwordx4 v[68:71],v25,s[20:23],s64 offen offset:3072
v_mfma_f32_16x16x32_bf16 v[72:75],a[168:171],v[184:187],v[72:75]
ds_read_b128 v[232:235],v17 offset:53248
s_mov_b32 s49,0x7fff0000
v_mfma_f32_16x16x32_bf16 v[76:79],a[172:175],v[188:191],v[76:79]
ds_read_b128 v[236:239],v17 offset:55296
s_waitcnt lgkmcnt(8)
v_mfma_f32_16x16x32_bf16 v[72:75],a[176:179],v[192:195],v[72:75]
v_min3_u32 v27,v27,v184,v188
v_mfma_f32_16x16x32_bf16 v[76:79],a[180:183],v[196:199],v[76:79]
v_min3_u32 v27,v27,v192,v196
ds_bpermute_b32 v124,v41,v120
v_mfma_f32_16x16x32_bf16 v[72:75],a[184:187],v[200:203],v[72:75]
v_mfma_f32_16x16x32_bf16 v[76:79],a[188:191],v[204:207],v[76:79]
v_min3_u32 v27,v27,v200,v204
s_waitcnt lgkmcnt(5)
v_mfma_f32_16x16x32_bf16 v[72:75],a[192:195],v[208:211],v[72:75]
ds_bpermute_b32 v125,v41,v121
v_mfma_f32_16x16x32_bf16 v[76:79],a[196:199],v[212:215],v[76:79]
v_min3_u32 v27,v27,v208,v212
v_lshlrev_b32 v108,16,v122
v_mfma_f32_16x16x32_bf16 v[72:75],a[200:203],v[216:219],v[72:75]
v_mfma_f32_16x16x32_bf16 v[76:79],a[204:207],v[220:223],v[76:79]
v_min3_u32 v27,v27,v216,v220
s_waitcnt lgkmcnt(2)
v_mfma_f32_16x16x32_bf16 v[72:75],a[208:211],v[224:227],v[72:75]
v_and_b32 v109,s80,v122
v_mfma_f32_16x16x32_bf16 v[76:79],a[212:215],v[228:231],v[76:79]
v_min3_u32 v27,v27,v224,v228
v_min3_u32 v27,v27,v226,v230
v_mfma_f32_16x16x32_bf16 v[72:75],a[216:219],v[232:235],v[72:75]
v_lshlrev_b32 v110,16,v123
v_mfma_f32_16x16x32_bf16 v[76:79],a[220:223],v[236:239],v[76:79]
v_min3_u32 v27,v27,v232,v236
v_min3_u32 v27,v27,v234,v238
v_mfma_f32_16x16x32_bf16 v[80:83],a[0:3],v[128:131],0
v_cmp_eq_u32 vcc,0,v27
s_cbranch_vccnz retry_312
v_mfma_f32_16x16x32_bf16 v[84:87],a[4:7],v[132:135],0
v_and_b32 v111,s80,v123
s_waitcnt lgkmcnt(0)
v_mfma_f32_16x16x32_bf16 v[80:83],a[8:11],v[136:139],v[80:83]
v_mfma_f32_16x16x32_bf16 v[84:87],a[12:15],v[140:143],v[84:87]
v_lshlrev_b32 v104,16,v124
v_mfma_f32_16x16x32_bf16 v[80:83],a[16:19],v[144:147],v[80:83]
v_add_f32 v72,v72,v76
v_add_f32 v73,v73,v77
v_mfma_f32_16x16x32_bf16 v[84:87],a[20:23],v[148:151],v[84:87]
v_and_b32 v105,s80,v124
v_add_f32 v74,v74,v78
v_mfma_f32_16x16x32_bf16 v[80:83],a[24:27],v[152:155],v[80:83]
v_add_f32 v75,v75,v79
v_and_or_b32 v72,v72,-4,s48
v_mfma_f32_16x16x32_bf16 v[84:87],a[28:31],v[156:159],v[84:87]
v_lshlrev_b32 v106,16,v125
s_add_u32 s64,s77,s33
v_mfma_f32_16x16x32_bf16 v[80:83],a[32:35],v[160:163],v[80:83]
buffer_store_dwordx4 v[72:75],v25,s[20:23],s64 offen offset:1024
v_mfma_f32_16x16x32_bf16 v[84:87],a[36:39],v[164:167],v[84:87]
v_and_b32 v107,s80,v125
v_mfma_f32_16x16x32_bf16 v[80:83],a[40:43],v[168:171],v[80:83]
v_mfma_f32_16x16x32_bf16 v[84:87],a[44:47],v[172:175],v[84:87]
v_mfma_f32_16x16x32_bf16 v[80:83],a[48:51],v[176:179],v[80:83]
buffer_load_dwordx4 v[96:99],v26,s[20:23],s77 offen offset:2048 sc1
v_mfma_f32_16x16x32_bf16 v[84:87],a[52:55],v[180:183],v[84:87]
buffer_load_dwordx4 v[100:103],v26,s[20:23],s77 offen offset:3072 sc1
v_mfma_f32_16x16x32_bf16 v[80:83],a[56:59],v[184:187],v[80:83]
v_mfma_f32_16x16x32_bf16 v[84:87],a[60:63],v[188:191],v[84:87]
v_mfma_f32_16x16x32_bf16 v[80:83],a[64:67],v[192:195],v[80:83]
v_mfma_f32_16x16x32_bf16 v[84:87],a[68:71],v[196:199],v[84:87]
v_mfma_f32_16x16x32_bf16 v[80:83],a[72:75],v[200:203],v[80:83]
v_mfma_f32_16x16x32_bf16 v[84:87],a[76:79],v[204:207],v[84:87]
v_mfma_f32_16x16x32_bf16 v[80:83],a[80:83],v[208:211],v[80:83]
v_mfma_f32_16x16x32_bf16 v[84:87],a[84:87],v[212:215],v[84:87]
v_mfma_f32_16x16x32_bf16 v[80:83],a[88:91],v[216:219],v[80:83]
buffer_load_dwordx4 v[92:95],v26,s[20:23],s77 offen offset:1024 sc1
v_mfma_f32_16x16x32_bf16 v[84:87],a[92:95],v[220:223],v[84:87]
v_mfma_f32_16x16x32_bf16 v[80:83],a[96:99],v[224:227],v[80:83]
v_mfma_f32_16x16x32_bf16 v[84:87],a[100:103],v[228:231],v[84:87]
v_mfma_f32_16x16x32_bf16 v[80:83],a[104:107],v[232:235],v[80:83]
v_mfma_f32_16x16x32_bf16 v[84:87],a[108:111],v[236:239],v[84:87]
s_branch epi_315
both_316:
s_waitcnt vmcnt(14) lgkmcnt(0)
s_barrier
ds_read_b128 v[224:227],v18 offset:0
ds_read_b128 v[228:231],v18 offset:2048
ds_read_b128 v[232:235],v18 offset:4096
ds_read_b128 v[236:239],v18 offset:6144
ds_read_b128 v[240:243],v18 offset:8192
ds_read_b128 v[244:247],v18 offset:10240
ds_read_b128 v[248:251],v18 offset:12288
s_waitcnt lgkmcnt(5)
v_mfma_f32_16x16x32_bf16 v[64:67],a[0:3],v[224:227],0
s_add_u32 s96,s71,1
s_add_u32 s92,s71,2
v_min_u32 v27,v224,v228
v_mfma_f32_16x16x32_bf16 v[68:71],a[112:115],v[224:227],0
ds_read_b128 v[252:255],v18 offset:14336
s_add_u32 s88,s70,s75
v_mfma_f32_16x16x32_bf16 v[64:67],a[4:7],v[228:231],v[64:67]
s_add_u32 s88,s88,2097152
s_xor_b32 s88,s88,0x2000
v_mfma_f32_16x16x32_bf16 v[68:71],a[116:119],v[228:231],v[68:71]
ds_read_b128 v[224:227],v18 offset:16384
s_waitcnt lgkmcnt(5)
v_mfma_f32_16x16x32_bf16 v[64:67],a[8:11],v[232:235],v[64:67]
s_xor_b32 s89,s88,1024
v_min3_u32 v27,v27,v232,v236
v_mfma_f32_16x16x32_bf16 v[68:71],a[120:123],v[232:235],v[68:71]
ds_read_b128 v[228:231],v18 offset:18432
buffer_load_dwordx2 v[120:121],v20,s[20:23],s76 offen sc1
v_mfma_f32_16x16x32_bf16 v[64:67],a[12:15],v[236:239],v[64:67]
s_xor_b32 m0,s72,0
v_mfma_f32_16x16x32_bf16 v[68:71],a[124:127],v[236:239],v[68:71]
ds_read_b128 v[232:235],v18 offset:20480
s_add_u32 s65,s88,0
s_waitcnt lgkmcnt(5)
v_mfma_f32_16x16x32_bf16 v[64:67],a[16:19],v[240:243],v[64:67]
v_min3_u32 v27,v27,v240,v244
v_mfma_f32_16x16x32_bf16 v[68:71],a[128:131],v[240:243],v[68:71]
ds_read_b128 v[236:239],v18 offset:22528
buffer_load_dwordx4 v16,s[20:23],s65 offen offset:0 sc1 lds
v_mfma_f32_16x16x32_bf16 v[64:67],a[20:23],v[244:247],v[64:67]
s_waitcnt vmcnt(3)
v_mfma_f32_16x16x32_bf16 v[68:71],a[132:135],v[244:247],v[68:71]
ds_read_b128 v[240:243],v18 offset:24576
s_waitcnt lgkmcnt(5)
v_mfma_f32_16x16x32_bf16 v[64:67],a[24:27],v[248:251],v[64:67]
v_cmp_gt_u32 vcc,s96,v29
v_cmp_gt_u32 s[92:93],s92,v29
v_min3_u32 v27,v27,v248,v252
v_mfma_f32_16x16x32_bf16 v[68:71],a[136:139],v[248:251],v[68:71]
ds_read_b128 v[244:247],v18 offset:26624
buffer_load_dwordx4 v16,s[20:23],s65 offen offset:2048 sc1 lds
v_mfma_f32_16x16x32_bf16 v[64:67],a[28:31],v[252:255],v[64:67]
v_mov_b32 v44,vcc_lo
v_mov_b32 v45,s92
s_xor_b32 m0,s72,16384
v_mfma_f32_16x16x32_bf16 v[68:71],a[140:143],v[252:255],v[68:71]
ds_read_b128 v[248:251],v18 offset:28672
s_add_u32 s65,s88,32768
s_waitcnt lgkmcnt(5)
v_mfma_f32_16x16x32_bf16 v[64:67],a[32:35],v[224:227],v[64:67]
ds_write_b64 v46,v[44:45]
v_min3_u32 v27,v27,v224,v228
v_mfma_f32_16x16x32_bf16 v[68:71],a[144:147],v[224:227],v[68:71]
ds_read_b128 v[252:255],v18 offset:30720
buffer_load_dwordx4 v16,s[20:23],s65 offen offset:0 sc1 lds
v_mfma_f32_16x16x32_bf16 v[64:67],a[36:39],v[228:231],v[64:67]
buffer_load_dwordx4 v16,s[20:23],s65 offen offset:2048 sc1 lds
v_mfma_f32_16x16x32_bf16 v[68:71],a[148:151],v[228:231],v[68:71]
ds_read_b128 v[224:227],v18 offset:32768
s_waitcnt lgkmcnt(6)
v_mfma_f32_16x16x32_bf16 v[64:67],a[40:43],v[232:235],v[64:67]
s_xor_b32 m0,s72,32768
v_min3_u32 v27,v27,v232,v236
v_mfma_f32_16x16x32_bf16 v[68:71],a[152:155],v[232:235],v[68:71]
ds_read_b128 v[228:231],v18 offset:34816
v_mfma_f32_16x16x32_bf16 v[64:67],a[44:47],v[236:239],v[64:67]
s_add_u32 s65,s88,65536
v_mfma_f32_16x16x32_bf16 v[68:71],a[156:159],v[236:239],v[68:71]
ds_read_b128 v[232:235],v18 offset:36864
s_waitcnt lgkmcnt(6)
v_mfma_f32_16x16x32_bf16 v[64:67],a[48:51],v[240:243],v[64:67]
buffer_load_dwordx4 v16,s[20:23],s65 offen offset:0 sc1 lds
v_mfma_f32_16x16x32_bf16 v[68:71],a[160:163],v[240:243],v[68:71]
ds_read_b128 v[236:239],v18 offset:38912
v_min3_u32 v27,v27,v240,v244
v_mfma_f32_16x16x32_bf16 v[64:67],a[52:55],v[244:247],v[64:67]
buffer_load_dwordx4 v16,s[20:23],s65 offen offset:2048 sc1 lds
v_mfma_f32_16x16x32_bf16 v[68:71],a[164:167],v[244:247],v[68:71]
ds_read_b128 v[240:243],v18 offset:40960
s_waitcnt lgkmcnt(5)
v_mfma_f32_16x16x32_bf16 v[64:67],a[56:59],v[248:251],v[64:67]
s_xor_b32 m0,s72,49152
v_min3_u32 v27,v27,v248,v252
v_mfma_f32_16x16x32_bf16 v[68:71],a[168:171],v[248:251],v[68:71]
ds_read_b128 v[244:247],v18 offset:43008
s_add_u32 s65,s88,s86
v_mfma_f32_16x16x32_bf16 v[64:67],a[60:63],v[252:255],v[64:67]
buffer_load_dwordx2 v[122:123],v24,s[20:23],s70 offen sc1
v_mfma_f32_16x16x32_bf16 v[68:71],a[172:175],v[252:255],v[68:71]
ds_read_b128 v[248:251],v18 offset:45056
s_waitcnt lgkmcnt(5)
v_mfma_f32_16x16x32_bf16 v[64:67],a[64:67],v[224:227],v[64:67]
s_waitcnt vmcnt(14)
s_barrier
ds_read_b64 v[44:45],v47
ds_read_b128 v[128:131],v17 offset:0
ds_read_b128 v[132:135],v17 offset:2048
v_mfma_f32_16x16x32_bf16 v[68:71],a[176:179],v[224:227],v[68:71]
ds_read_b128 v[252:255],v18 offset:47104
buffer_load_dwordx4 v16,s[20:23],s65 offen offset:0 sc1 lds
v_min3_u32 v27,v27,v224,v228
v_mfma_f32_16x16x32_bf16 v[64:67],a[68:71],v[228:231],v[64:67]
ds_read_b128 v[136:139],v17 offset:4096
buffer_load_dwordx4 v16,s[20:23],s65 offen offset:2048 sc1 lds
v_mfma_f32_16x16x32_bf16 v[68:71],a[180:183],v[228:231],v[68:71]
ds_read_b128 v[224:227],v18 offset:49152
s_xor_b32 m0,s72,1024
s_waitcnt lgkmcnt(9)
v_mfma_f32_16x16x32_bf16 v[64:67],a[72:75],v[232:235],v[64:67]
ds_read_b128 v[140:143],v17 offset:6144
v_min3_u32 v27,v27,v232,v236
v_mfma_f32_16x16x32_bf16 v[68:71],a[184:187],v[232:235],v[68:71]
ds_read_b128 v[228:231],v18 offset:51200
s_add_u32 s65,s89,0
v_mfma_f32_16x16x32_bf16 v[64:67],a[76:79],v[236:239],v[64:67]
ds_read_b128 v[144:147],v17 offset:8192
ds_read_b128 v[148:151],v17 offset:10240
v_mfma_f32_16x16x32_bf16 v[68:71],a[188:191],v[236:239],v[68:71]
ds_read_b128 v[232:235],v18 offset:53248
s_waitcnt lgkmcnt(12)
v_mfma_f32_16x16x32_bf16 v[64:67],a[80:83],v[240:243],v[64:67]
ds_read_b128 v[152:155],v17 offset:12288
s_waitcnt lgkmcnt(11)
v_min3_u32 v27,v27,v240,v244
v_mfma_f32_16x16x32_bf16 v[68:71],a[192:195],v[240:243],v[68:71]
ds_read_b128 v[236:239],v18 offset:55296
v_readfirstlane_b32 s93,v45
v_mfma_f32_16x16x32_bf16 v[64:67],a[84:87],v[244:247],v[64:67]
ds_read_b128 v[156:159],v17 offset:14336
buffer_load_dwordx4 v16,s[20:23],s65 offen offset:0 sc1 lds
v_mfma_f32_16x16x32_bf16 v[68:71],a[196:199],v[244:247],v[68:71]
buffer_load_dwordx4 v16,s[20:23],s65 offen offset:2048 sc1 lds
s_waitcnt lgkmcnt(10)
v_mfma_f32_16x16x32_bf16 v[64:67],a[88:91],v[248:251],v[64:67]
ds_read_b128 v[160:163],v17 offset:16384
ds_read_b128 v[164:167],v17 offset:18432
s_xor_b32 m0,s72,17408
v_mfma_f32_16x16x32_bf16 v[68:71],a[200:203],v[248:251],v[68:71]
s_add_u32 s65,s89,32768
v_min3_u32 v27,v27,v248,v252
v_mfma_f32_16x16x32_bf16 v[64:67],a[92:95],v[252:255],v[64:67]
ds_read_b128 v[168:171],v17 offset:20480
buffer_load_dwordx4 v16,s[20:23],s65 offen offset:0 sc1 lds
v_mfma_f32_16x16x32_bf16 v[68:71],a[204:207],v[252:255],v[68:71]
s_waitcnt lgkmcnt(9)
v_mfma_f32_16x16x32_bf16 v[64:67],a[96:99],v[224:227],v[64:67]
ds_read_b128 v[172:175],v17 offset:22528
buffer_load_dwordx4 v16,s[20:23],s65 offen offset:2048 sc1 lds
v_mfma_f32_16x16x32_bf16 v[68:71],a[208:211],v[224:227],v[68:71]
v_min3_u32 v27,v27,v224,v228
v_min3_u32 v27,v27,v226,v230
v_mfma_f32_16x16x32_bf16 v[64:67],a[100:103],v[228:231],v[64:67]
ds_read_b128 v[176:179],v17 offset:24576
ds_read_b128 v[180:183],v17 offset:26624
s_xor_b32 m0,s72,33792
v_mfma_f32_16x16x32_bf16 v[68:71],a[212:215],v[228:231],v[68:71]
s_waitcnt lgkmcnt(7)
v_mfma_f32_16x16x32_bf16 v[64:67],a[104:107],v[232:235],v[64:67]
ds_read_b128 v[184:187],v17 offset:28672
s_add_u32 s65,s89,65536
v_min3_u32 v27,v27,v232,v236
v_mfma_f32_16x16x32_bf16 v[68:71],a[216:219],v[232:235],v[68:71]
buffer_load_dwordx4 v16,s[20:23],s65 offen offset:0 sc1 lds
v_mfma_f32_16x16x32_bf16 v[64:67],a[108:111],v[236:239],v[64:67]
ds_read_b128 v[188:191],v17 offset:30720
v_min3_u32 v27,v27,v234,v238
v_mfma_f32_16x16x32_bf16 v[68:71],a[220:223],v[236:239],v[68:71]
buffer_load_dwordx4 v16,s[20:23],s65 offen offset:2048 sc1 lds
v_mfma_f32_16x16x32_bf16 v[72:75],a[112:115],v[128:131],0
v_cmp_eq_u32 vcc,0,v27
s_cbranch_vccnz retry_312
v_mfma_f32_16x16x32_bf16 v[76:79],a[116:119],v[132:135],0
s_xor_b32 m0,s72,50176
v_min3_u32 v27,v27,v128,v132
v_mfma_f32_16x16x32_bf16 v[72:75],a[120:123],v[136:139],v[72:75]
ds_read_b128 v[192:195],v17 offset:32768
v_mfma_f32_16x16x32_bf16 v[76:79],a[124:127],v[140:143],v[76:79]
ds_read_b128 v[196:199],v17 offset:34816
s_add_u32 s65,s89,s86
s_waitcnt lgkmcnt(10)
v_mfma_f32_16x16x32_bf16 v[72:75],a[128:131],v[144:147],v[72:75]
ds_read_b128 v[200:203],v17 offset:36864
v_min3_u32 v27,v27,v136,v140
s_waitcnt vmcnt(8)
v_mfma_f32_16x16x32_bf16 v[76:79],a[132:135],v[148:151],v[76:79]
ds_read_b128 v[204:207],v17 offset:38912
buffer_load_dwordx4 v16,s[20:23],s65 offen offset:0 sc1 lds
v_mfma_f32_16x16x32_bf16 v[72:75],a[136:139],v[152:155],v[72:75]
ds_read_b128 v[208:211],v17 offset:40960
v_min3_u32 v27,v27,v144,v148
v_and_or_b32 v64,v64,-4,s48
v_mfma_f32_16x16x32_bf16 v[76:79],a[140:143],v[156:159],v[76:79]
buffer_load_dwordx4 v16,s[20:23],s65 offen offset:2048 sc1 lds
s_waitcnt lgkmcnt(9)
v_mfma_f32_16x16x32_bf16 v[72:75],a[144:147],v[160:163],v[72:75]
ds_read_b128 v[212:215],v17 offset:43008
v_min3_u32 v27,v27,v152,v156
s_add_u32 s64,s49,s34
v_mfma_f32_16x16x32_bf16 v[76:79],a[148:151],v[164:167],v[76:79]
ds_read_b128 v[216:219],v17 offset:45056
v_min3_u32 v27,v27,v160,v164
v_mfma_f32_16x16x32_bf16 v[72:75],a[152:155],v[168:171],v[72:75]
ds_read_b128 v[220:223],v17 offset:47104
buffer_store_dwordx4 v[64:67],v25,s[20:23],s64 offen offset:2048
v_mfma_f32_16x16x32_bf16 v[76:79],a[156:159],v[172:175],v[76:79]
ds_read_b128 v[224:227],v17 offset:49152
v_and_or_b32 v68,v68,-4,s48
s_waitcnt lgkmcnt(9)
v_mfma_f32_16x16x32_bf16 v[72:75],a[160:163],v[176:179],v[72:75]
ds_read_b128 v[228:231],v17 offset:51200
v_min3_u32 v27,v27,v168,v172
s_add_u32 s64,s49,s35
v_mfma_f32_16x16x32_bf16 v[76:79],a[164:167],v[180:183],v[76:79]
v_min3_u32 v27,v27,v176,v180
buffer_store_dwordx4 v[68:71],v25,s[20:23],s64 offen offset:3072
v_mfma_f32_16x16x32_bf16 v[72:75],a[168:171],v[184:187],v[72:75]
ds_read_b128 v[232:235],v17 offset:53248
s_mov_b32 s49,0x7fff0000
v_mfma_f32_16x16x32_bf16 v[76:79],a[172:175],v[188:191],v[76:79]
ds_read_b128 v[236:239],v17 offset:55296
s_waitcnt lgkmcnt(8)
v_mfma_f32_16x16x32_bf16 v[72:75],a[176:179],v[192:195],v[72:75]
v_min3_u32 v27,v27,v184,v188
v_mfma_f32_16x16x32_bf16 v[76:79],a[180:183],v[196:199],v[76:79]
v_min3_u32 v27,v27,v192,v196
ds_bpermute_b32 v124,v41,v120
v_mfma_f32_16x16x32_bf16 v[72:75],a[184:187],v[200:203],v[72:75]
v_mfma_f32_16x16x32_bf16 v[76:79],a[188:191],v[204:207],v[76:79]
v_min3_u32 v27,v27,v200,v204
s_waitcnt lgkmcnt(5)
v_mfma_f32_16x16x32_bf16 v[72:75],a[192:195],v[208:211],v[72:75]
ds_bpermute_b32 v125,v41,v121
v_mfma_f32_16x16x32_bf16 v[76:79],a[196:199],v[212:215],v[76:79]
v_min3_u32 v27,v27,v208,v212
v_lshlrev_b32 v108,16,v122
v_mfma_f32_16x16x32_bf16 v[72:75],a[200:203],v[216:219],v[72:75]
v_mfma_f32_16x16x32_bf16 v[76:79],a[204:207],v[220:223],v[76:79]
v_min3_u32 v27,v27,v216,v220
s_waitcnt lgkmcnt(2)
v_mfma_f32_16x16x32_bf16 v[72:75],a[208:211],v[224:227],v[72:75]
v_and_b32 v109,s80,v122
v_mfma_f32_16x16x32_bf16 v[76:79],a[212:215],v[228:231],v[76:79]
v_min3_u32 v27,v27,v224,v228
v_min3_u32 v27,v27,v226,v230
v_mfma_f32_16x16x32_bf16 v[72:75],a[216:219],v[232:235],v[72:75]
v_lshlrev_b32 v110,16,v123
v_mfma_f32_16x16x32_bf16 v[76:79],a[220:223],v[236:239],v[76:79]
v_min3_u32 v27,v27,v232,v236
v_min3_u32 v27,v27,v234,v238
v_mfma_f32_16x16x32_bf16 v[80:83],a[0:3],v[128:131],0
v_cmp_eq_u32 vcc,0,v27
s_cbranch_vccnz retry_312
v_mfma_f32_16x16x32_bf16 v[84:87],a[4:7],v[132:135],0
v_and_b32 v111,s80,v123
s_waitcnt lgkmcnt(0)
v_mfma_f32_16x16x32_bf16 v[80:83],a[8:11],v[136:139],v[80:83]
v_mfma_f32_16x16x32_bf16 v[84:87],a[12:15],v[140:143],v[84:87]
v_lshlrev_b32 v104,16,v124
v_mfma_f32_16x16x32_bf16 v[80:83],a[16:19],v[144:147],v[80:83]
v_add_f32 v72,v72,v76
v_add_f32 v73,v73,v77
v_mfma_f32_16x16x32_bf16 v[84:87],a[20:23],v[148:151],v[84:87]
v_and_b32 v105,s80,v124
v_add_f32 v74,v74,v78
v_mfma_f32_16x16x32_bf16 v[80:83],a[24:27],v[152:155],v[80:83]
v_add_f32 v75,v75,v79
v_and_or_b32 v72,v72,-4,s48
v_mfma_f32_16x16x32_bf16 v[84:87],a[28:31],v[156:159],v[84:87]
v_lshlrev_b32 v106,16,v125
s_add_u32 s64,s77,s33
v_mfma_f32_16x16x32_bf16 v[80:83],a[32:35],v[160:163],v[80:83]
buffer_store_dwordx4 v[72:75],v25,s[20:23],s64 offen offset:1024
v_mfma_f32_16x16x32_bf16 v[84:87],a[36:39],v[164:167],v[84:87]
v_and_b32 v107,s80,v125
v_mfma_f32_16x16x32_bf16 v[80:83],a[40:43],v[168:171],v[80:83]
v_mfma_f32_16x16x32_bf16 v[84:87],a[44:47],v[172:175],v[84:87]
v_mfma_f32_16x16x32_bf16 v[80:83],a[48:51],v[176:179],v[80:83]
buffer_load_dwordx4 v[96:99],v26,s[20:23],s77 offen offset:2048 sc1
v_mfma_f32_16x16x32_bf16 v[84:87],a[52:55],v[180:183],v[84:87]
buffer_load_dwordx4 v[100:103],v26,s[20:23],s77 offen offset:3072 sc1
v_mfma_f32_16x16x32_bf16 v[80:83],a[56:59],v[184:187],v[80:83]
v_mfma_f32_16x16x32_bf16 v[84:87],a[60:63],v[188:191],v[84:87]
v_mfma_f32_16x16x32_bf16 v[80:83],a[64:67],v[192:195],v[80:83]
v_mfma_f32_16x16x32_bf16 v[84:87],a[68:71],v[196:199],v[84:87]
v_mfma_f32_16x16x32_bf16 v[80:83],a[72:75],v[200:203],v[80:83]
v_mfma_f32_16x16x32_bf16 v[84:87],a[76:79],v[204:207],v[84:87]
v_mfma_f32_16x16x32_bf16 v[80:83],a[80:83],v[208:211],v[80:83]
v_mfma_f32_16x16x32_bf16 v[84:87],a[84:87],v[212:215],v[84:87]
v_mfma_f32_16x16x32_bf16 v[80:83],a[88:91],v[216:219],v[80:83]
buffer_load_dwordx4 v[92:95],v26,s[20:23],s77 offen offset:1024 sc1
v_mfma_f32_16x16x32_bf16 v[84:87],a[92:95],v[220:223],v[84:87]
v_mfma_f32_16x16x32_bf16 v[80:83],a[96:99],v[224:227],v[80:83]
v_mfma_f32_16x16x32_bf16 v[84:87],a[100:103],v[228:231],v[84:87]
v_mfma_f32_16x16x32_bf16 v[80:83],a[104:107],v[232:235],v[80:83]
v_mfma_f32_16x16x32_bf16 v[84:87],a[108:111],v[236:239],v[84:87]
epi_315:
buffer_load_dword v29,v21,s[20:23],s87 offen sc1
s_nop 6
v_pk_add_f32 v[88:89],v[80:81],v[84:85]
v_pk_add_f32 v[90:91],v[82:83],v[86:87]
v_pk_add_f32 v[88:89],v[88:89],v[108:109]
v_pk_add_f32 v[90:91],v[90:91],v[110:111]
s_waitcnt vmcnt(1)
s_branch ic_324
ip_322:
buffer_load_dwordx4 v[92:95],v26,s[20:23],s77 offen offset:1024 sc1
buffer_load_dwordx4 v[96:99],v26,s[20:23],s77 offen offset:2048 sc1
buffer_load_dwordx4 v[100:103],v26,s[20:23],s77 offen offset:3072 sc1
s_waitcnt vmcnt(0)
ic_324:
v_bitop3_b32 v22,v92,v96,v100 bitop3:0x80
v_and_b32 v22,s48,v22
v_cmp_eq_u32 vcc,0,v22
s_cbranch_vccz ik_323
s_sub_u32 s90,s90,1
s_cmp_gt_i32 s90,0
s_cbranch_scc1 ip_322
ik_323:
v_pk_add_f32 v[88:89],v[88:89],v[92:93]
v_pk_add_f32 v[96:97],v[96:97],v[100:101]
v_pk_add_f32 v[90:91],v[90:91],v[94:95]
v_pk_add_f32 v[98:99],v[98:99],v[102:103]
v_pk_add_f32 v[88:89],v[88:89],v[96:97]
v_pk_add_f32 v[90:91],v[90:91],v[98:99]
v_pk_fma_f32 v[88:89],v[88:89],v[52:53],v[104:105]
v_pk_fma_f32 v[90:91],v[90:91],v[54:55],v[106:107]
v_cvt_pk_bf16_f32 v88,v88,v89
v_cvt_pk_bf16_f32 v89,v90,v91
ds_bpermute_b32 v88,v40,v88
ds_bpermute_b32 v89,v40,v89
v_xor_b32 v18,0x10000,v18
s_xor_b32 s49,s77,524288
s_cselect_b32 s64,0,3
s_xor_b32 s48,s48,s64
v_xor_b32 v20,0x2000,v20
s_add_u32 s76,s76,2097152
s_waitcnt lgkmcnt(0)
s_mov_b64 exec,s[84:85]
buffer_store_dwordx2 v[88:89],v19,s[36:39],s78 offen
s_mov_b64 exec,-1
s_mov_b64 s[84:85],-1
s_mov_b32 s77,s49
s_add_u32 s78,s78,65536
v_xor_b32 v17,0x10000,v17
s_xor_b32 s72,s72,0x10000
s_add_u32 s70,s70,2097152
s_xor_b32 s70,s70,0x2000
s_add_u32 s71,s71,1
s_cmp_le_u32 s71,s57
s_cbranch_scc1 seg_313
s_endpgm
retry_312:
s_sub_u32 s90,s90,64
s_cmp_lt_i32 s90,0
s_cbranch_scc1 giveup_197
s_mov_b32 s83,1
s_waitcnt vmcnt(0) lgkmcnt(0)
s_barrier
s_branch seg_313
kslow_311:
s_add_u32 s64,s79,0
s_lshl_b32 s70,s64,21
s_lshl_b32 s64,s64,13
s_and_b32 s64,s64,0x2000
s_xor_b32 s64,s64,s62
s_add_u32 s70,s70,s64
s_add_u32 s70,s70,29360128
s_mov_b32 s83,1
s_mov_b32 s87,s74
s_cmp_eq_u32 s50,0
s_cselect_b32 s74,s74,0x7fff0000
v_mov_b32 v47,132096
s_lshl_b32 s64,s50,3
s_add_u32 s64,s64,132096
v_mov_b32 v46,s64
v_mov_b32 v29,0
s_mov_b32 s97,0x7fff0000
seg_326:
s_add_u32 s94,s70,s75
s_xor_b32 s95,s94,1024
s_xor_b32 s91,s72,0x10000
s_waitcnt vmcnt(1)
v_cmp_gt_u32 vcc,s71,v29
s_cbranch_vccz nb_330
s_cmp_lg_u32 s50,0
s_cbranch_scc1 nb_330
buffer_load_dword v32,v21,s[20:23],s74 offen sc1
s_sleep 2
pl_331:
buffer_load_dword v33,v21,s[20:23],s74 offen sc1
s_waitcnt vmcnt(1)
v_cmp_gt_u32 vcc,s71,v32
v_mov_b32 v29,v32
s_cbranch_vccz pok_332
buffer_load_dword v32,v21,s[20:23],s74 offen sc1
s_waitcnt vmcnt(1)
v_cmp_gt_u32 vcc,s71,v33
v_mov_b32 v29,v33
s_cbranch_vccz pok_332
s_sub_u32 s90,s90,1
s_cmp_gt_i32 s90,0
s_cbranch_scc1 pl_331
pok_332:
nb_330:
s_barrier
s_xor_b32 m0,s91,0
s_add_u32 s65,s94,0
buffer_load_dwordx4 v16,s[20:23],s65 offen offset:0 sc1 lds
buffer_load_dwordx4 v16,s[20:23],s65 offen offset:2048 sc1 lds
s_xor_b32 m0,s91,16384
s_add_u32 s65,s94,32768
buffer_load_dwordx4 v16,s[20:23],s65 offen offset:0 sc1 lds
buffer_load_dwordx4 v16,s[20:23],s65 offen offset:2048 sc1 lds
s_xor_b32 m0,s91,32768
s_add_u32 s65,s94,65536
buffer_load_dwordx4 v16,s[20:23],s65 offen offset:0 sc1 lds
buffer_load_dwordx4 v16,s[20:23],s65 offen offset:2048 sc1 lds
s_xor_b32 m0,s91,49152
s_add_u32 s65,s94,s86
buffer_load_dwordx4 v16,s[20:23],s65 offen offset:0 sc1 lds
buffer_load_dwordx4 v16,s[20:23],s65 offen offset:2048 sc1 lds
s_waitcnt vmcnt(6)
s_barrier
ds_read_b128 v[224:227],v18 offset:0
ds_read_b128 v[228:231],v18 offset:2048
ds_read_b128 v[232:235],v18 offset:4096
ds_read_b128 v[236:239],v18 offset:6144
ds_read_b128 v[240:243],v18 offset:8192
ds_read_b128 v[244:247],v18 offset:10240
ds_read_b128 v[248:251],v18 offset:12288
s_waitcnt lgkmcnt(5)
v_mfma_f32_16x16x32_bf16 v[64:67],a[0:3],v[224:227],0
s_xor_b32 m0,s91,1024
v_min_u32 v27,v224,v228
v_mfma_f32_16x16x32_bf16 v[68:71],a[112:115],v[224:227],0
ds_read_b128 v[252:255],v18 offset:14336
v_mfma_f32_16x16x32_bf16 v[64:67],a[4:7],v[228:231],v[64:67]
s_add_u32 s65,s95,0
v_mfma_f32_16x16x32_bf16 v[68:71],a[116:119],v[228:231],v[68:71]
s_waitcnt vmcnt(4)
s_barrier
ds_read_b128 v[224:227],v18 offset:16384
s_waitcnt lgkmcnt(5)
v_mfma_f32_16x16x32_bf16 v[64:67],a[8:11],v[232:235],v[64:67]
buffer_load_dwordx4 v16,s[20:23],s65 offen offset:0 sc1 lds
v_mfma_f32_16x16x32_bf16 v[68:71],a[120:123],v[232:235],v[68:71]
ds_read_b128 v[228:231],v18 offset:18432
v_min3_u32 v27,v27,v232,v236
v_mfma_f32_16x16x32_bf16 v[64:67],a[12:15],v[236:239],v[64:67]
buffer_load_dwordx4 v16,s[20:23],s65 offen offset:2048 sc1 lds
v_mfma_f32_16x16x32_bf16 v[68:71],a[124:127],v[236:239],v[68:71]
ds_read_b128 v[232:235],v18 offset:20480
s_waitcnt lgkmcnt(5)
v_mfma_f32_16x16x32_bf16 v[64:67],a[16:19],v[240:243],v[64:67]
s_xor_b32 m0,s91,17408
v_min3_u32 v27,v27,v240,v244
v_mfma_f32_16x16x32_bf16 v[68:71],a[128:131],v[240:243],v[68:71]
ds_read_b128 v[236:239],v18 offset:22528
v_mfma_f32_16x16x32_bf16 v[64:67],a[20:23],v[244:247],v[64:67]
s_add_u32 s65,s95,32768
v_mfma_f32_16x16x32_bf16 v[68:71],a[132:135],v[244:247],v[68:71]
ds_read_b128 v[240:243],v18 offset:24576
s_waitcnt lgkmcnt(5)
v_mfma_f32_16x16x32_bf16 v[64:67],a[24:27],v[248:251],v[64:67]
buffer_load_dwordx4 v16,s[20:23],s65 offen offset:0 sc1 lds
v_mfma_f32_16x16x32_bf16 v[68:71],a[136:139],v[248:251],v[68:71]
ds_read_b128 v[244:247],v18 offset:26624
v_min3_u32 v27,v27,v248,v252
v_mfma_f32_16x16x32_bf16 v[64:67],a[28:31],v[252:255],v[64:67]
buffer_load_dwordx4 v16,s[20:23],s65 offen offset:2048 sc1 lds
v_mfma_f32_16x16x32_bf16 v[68:71],a[140:143],v[252:255],v[68:71]
ds_read_b128 v[248:251],v18 offset:28672
s_waitcnt lgkmcnt(5)
v_mfma_f32_16x16x32_bf16 v[64:67],a[32:35],v[224:227],v[64:67]
s_xor_b32 m0,s91,33792
v_min3_u32 v27,v27,v224,v228
v_mfma_f32_16x16x32_bf16 v[68:71],a[144:147],v[224:227],v[68:71]
ds_read_b128 v[252:255],v18 offset:30720
v_mfma_f32_16x16x32_bf16 v[64:67],a[36:39],v[228:231],v[64:67]
s_add_u32 s65,s95,65536
v_mfma_f32_16x16x32_bf16 v[68:71],a[148:151],v[228:231],v[68:71]
s_waitcnt vmcnt(4)
s_barrier
ds_read_b128 v[224:227],v18 offset:32768
s_waitcnt lgkmcnt(5)
v_mfma_f32_16x16x32_bf16 v[64:67],a[40:43],v[232:235],v[64:67]
buffer_load_dwordx4 v16,s[20:23],s65 offen offset:0 sc1 lds
s_add_u32 s88,s70,s75
v_mfma_f32_16x16x32_bf16 v[68:71],a[152:155],v[232:235],v[68:71]
ds_read_b128 v[228:231],v18 offset:34816
v_min3_u32 v27,v27,v232,v236
s_add_u32 s88,s88,2097152
v_mfma_f32_16x16x32_bf16 v[64:67],a[44:47],v[236:239],v[64:67]
buffer_load_dwordx4 v16,s[20:23],s65 offen offset:2048 sc1 lds
v_mfma_f32_16x16x32_bf16 v[68:71],a[156:159],v[236:239],v[68:71]
ds_read_b128 v[232:235],v18 offset:36864
s_waitcnt lgkmcnt(5)
v_mfma_f32_16x16x32_bf16 v[64:67],a[48:51],v[240:243],v[64:67]
s_xor_b32 m0,s91,50176
v_min3_u32 v27,v27,v240,v244
v_mfma_f32_16x16x32_bf16 v[68:71],a[160:163],v[240:243],v[68:71]
ds_read_b128 v[236:239],v18 offset:38912
s_xor_b32 s88,s88,0x2000
v_mfma_f32_16x16x32_bf16 v[64:67],a[52:55],v[244:247],v[64:67]
s_add_u32 s65,s95,s86
s_xor_b32 s89,s88,1024
v_mfma_f32_16x16x32_bf16 v[68:71],a[164:167],v[244:247],v[68:71]
ds_read_b128 v[240:243],v18 offset:40960
s_waitcnt lgkmcnt(5)
v_mfma_f32_16x16x32_bf16 v[64:67],a[56:59],v[248:251],v[64:67]
buffer_load_dwordx4 v16,s[20:23],s65 offen offset:0 sc1 lds
v_mfma_f32_16x16x32_bf16 v[68:71],a[168:171],v[248:251],v[68:71]
ds_read_b128 v[244:247],v18 offset:43008
v_min3_u32 v27,v27,v248,v252
v_mfma_f32_16x16x32_bf16 v[64:67],a[60:63],v[252:255],v[64:67]
buffer_load_dwordx4 v16,s[20:23],s65 offen offset:2048 sc1 lds
v_mfma_f32_16x16x32_bf16 v[68:71],a[172:175],v[252:255],v[68:71]
ds_read_b128 v[248:251],v18 offset:45056
s_waitcnt lgkmcnt(5)
v_mfma_f32_16x16x32_bf16 v[64:67],a[64:67],v[224:227],v[64:67]
s_waitcnt vmcnt(4)
s_barrier
ds_read_b128 v[128:131],v17 offset:0
ds_read_b128 v[132:135],v17 offset:2048
v_mfma_f32_16x16x32_bf16 v[68:71],a[176:179],v[224:227],v[68:71]
ds_read_b128 v[252:255],v18 offset:47104
v_min3_u32 v27,v27,v224,v228
v_mfma_f32_16x16x32_bf16 v[64:67],a[68:71],v[228:231],v[64:67]
ds_read_b128 v[136:139],v17 offset:4096
buffer_load_dwordx2 v[120:121],v20,s[20:23],s76 offen sc1
v_mfma_f32_16x16x32_bf16 v[68:71],a[180:183],v[228:231],v[68:71]
ds_read_b128 v[224:227],v18 offset:49152
s_waitcnt lgkmcnt(8)
v_mfma_f32_16x16x32_bf16 v[64:67],a[72:75],v[232:235],v[64:67]
ds_read_b128 v[140:143],v17 offset:6144
v_min3_u32 v27,v27,v232,v236
v_mfma_f32_16x16x32_bf16 v[68:71],a[184:187],v[232:235],v[68:71]
ds_read_b128 v[228:231],v18 offset:51200
buffer_load_dwordx2 v[122:123],v24,s[20:23],s70 offen sc1
v_mfma_f32_16x16x32_bf16 v[64:67],a[76:79],v[236:239],v[64:67]
ds_read_b128 v[144:147],v17 offset:8192
ds_read_b128 v[148:151],v17 offset:10240
v_mfma_f32_16x16x32_bf16 v[68:71],a[188:191],v[236:239],v[68:71]
ds_read_b128 v[232:235],v18 offset:53248
s_waitcnt lgkmcnt(11)
v_mfma_f32_16x16x32_bf16 v[64:67],a[80:83],v[240:243],v[64:67]
ds_read_b128 v[152:155],v17 offset:12288
v_min3_u32 v27,v27,v240,v244
v_mfma_f32_16x16x32_bf16 v[68:71],a[192:195],v[240:243],v[68:71]
ds_read_b128 v[236:239],v18 offset:55296
v_mfma_f32_16x16x32_bf16 v[64:67],a[84:87],v[244:247],v[64:67]
ds_read_b128 v[156:159],v17 offset:14336
v_mfma_f32_16x16x32_bf16 v[68:71],a[196:199],v[244:247],v[68:71]
s_waitcnt lgkmcnt(10)
v_mfma_f32_16x16x32_bf16 v[64:67],a[88:91],v[248:251],v[64:67]
ds_read_b128 v[160:163],v17 offset:16384
ds_read_b128 v[164:167],v17 offset:18432
v_mfma_f32_16x16x32_bf16 v[68:71],a[200:203],v[248:251],v[68:71]
v_min3_u32 v27,v27,v248,v252
v_mfma_f32_16x16x32_bf16 v[64:67],a[92:95],v[252:255],v[64:67]
ds_read_b128 v[168:171],v17 offset:20480
v_mfma_f32_16x16x32_bf16 v[68:71],a[204:207],v[252:255],v[68:71]
s_waitcnt lgkmcnt(9)
v_mfma_f32_16x16x32_bf16 v[64:67],a[96:99],v[224:227],v[64:67]
ds_read_b128 v[172:175],v17 offset:22528
v_min3_u32 v27,v27,v224,v228
v_mfma_f32_16x16x32_bf16 v[68:71],a[208:211],v[224:227],v[68:71]
v_min3_u32 v27,v27,v226,v230
v_mfma_f32_16x16x32_bf16 v[64:67],a[100:103],v[228:231],v[64:67]
ds_read_b128 v[176:179],v17 offset:24576
ds_read_b128 v[180:183],v17 offset:26624
v_mfma_f32_16x16x32_bf16 v[68:71],a[212:215],v[228:231],v[68:71]
s_waitcnt lgkmcnt(7)
v_mfma_f32_16x16x32_bf16 v[64:67],a[104:107],v[232:235],v[64:67]
ds_read_b128 v[184:187],v17 offset:28672
v_min3_u32 v27,v27,v232,v236
v_mfma_f32_16x16x32_bf16 v[68:71],a[216:219],v[232:235],v[68:71]
v_min3_u32 v27,v27,v234,v238
v_mfma_f32_16x16x32_bf16 v[64:67],a[108:111],v[236:239],v[64:67]
ds_read_b128 v[188:191],v17 offset:30720
v_mfma_f32_16x16x32_bf16 v[68:71],a[220:223],v[236:239],v[68:71]
v_mfma_f32_16x16x32_bf16 v[72:75],a[112:115],v[128:131],0
v_cmp_eq_u32 vcc,0,v27
s_cbranch_vccnz retry_325
v_mfma_f32_16x16x32_bf16 v[76:79],a[116:119],v[132:135],0
v_min3_u32 v27,v27,v128,v132
v_mfma_f32_16x16x32_bf16 v[72:75],a[120:123],v[136:139],v[72:75]
s_waitcnt vmcnt(2)
s_barrier
ds_read_b128 v[192:195],v17 offset:32768
v_mfma_f32_16x16x32_bf16 v[76:79],a[124:127],v[140:143],v[76:79]
ds_read_b128 v[196:199],v17 offset:34816
s_waitcnt lgkmcnt(10)
v_mfma_f32_16x16x32_bf16 v[72:75],a[128:131],v[144:147],v[72:75]
ds_read_b128 v[200:203],v17 offset:36864
v_min3_u32 v27,v27,v136,v140
s_waitcnt vmcnt(0)
v_mfma_f32_16x16x32_bf16 v[76:79],a[132:135],v[148:151],v[76:79]
ds_read_b128 v[204:207],v17 offset:38912
v_min3_u32 v27,v27,v144,v148
v_and_or_b32 v64,v64,-4,s48
v_mfma_f32_16x16x32_bf16 v[72:75],a[136:139],v[152:155],v[72:75]
ds_read_b128 v[208:211],v17 offset:40960
s_add_u32 s64,s49,s34
v_mfma_f32_16x16x32_bf16 v[76:79],a[140:143],v[156:159],v[76:79]
v_min3_u32 v27,v27,v152,v156
s_waitcnt lgkmcnt(9)
v_mfma_f32_16x16x32_bf16 v[72:75],a[144:147],v[160:163],v[72:75]
ds_read_b128 v[212:215],v17 offset:43008
buffer_store_dwordx4 v[64:67],v25,s[20:23],s64 offen offset:2048 sc1
v_mfma_f32_16x16x32_bf16 v[76:79],a[148:151],v[164:167],v[76:79]
ds_read_b128 v[216:219],v17 offset:45056
v_min3_u32 v27,v27,v160,v164
v_and_or_b32 v68,v68,-4,s48
v_mfma_f32_16x16x32_bf16 v[72:75],a[152:155],v[168:171],v[72:75]
ds_read_b128 v[220:223],v17 offset:47104
s_add_u32 s64,s49,s35
v_mfma_f32_16x16x32_bf16 v[76:79],a[156:159],v[172:175],v[76:79]
ds_read_b128 v[224:227],v17 offset:49152
s_waitcnt lgkmcnt(9)
v_mfma_f32_16x16x32_bf16 v[72:75],a[160:163],v[176:179],v[72:75]
ds_read_b128 v[228:231],v17 offset:51200
v_min3_u32 v27,v27,v168,v172
v_mfma_f32_16x16x32_bf16 v[76:79],a[164:167],v[180:183],v[76:79]
v_min3_u32 v27,v27,v176,v180
buffer_store_dwordx4 v[68:71],v25,s[20:23],s64 offen offset:3072 sc1
v_mfma_f32_16x16x32_bf16 v[72:75],a[168:171],v[184:187],v[72:75]
ds_read_b128 v[232:235],v17 offset:53248
s_mov_b32 s49,0x7fff0000
v_mfma_f32_16x16x32_bf16 v[76:79],a[172:175],v[188:191],v[76:79]
ds_read_b128 v[236:239],v17 offset:55296
s_waitcnt lgkmcnt(8)
v_mfma_f32_16x16x32_bf16 v[72:75],a[176:179],v[192:195],v[72:75]
v_min3_u32 v27,v27,v184,v188
v_mfma_f32_16x16x32_bf16 v[76:79],a[180:183],v[196:199],v[76:79]
v_min3_u32 v27,v27,v192,v196
ds_bpermute_b32 v124,v41,v120
v_mfma_f32_16x16x32_bf16 v[72:75],a[184:187],v[200:203],v[72:75]
v_mfma_f32_16x16x32_bf16 v[76:79],a[188:191],v[204:207],v[76:79]
v_min3_u32 v27,v27,v200,v204
s_waitcnt lgkmcnt(5)
v_mfma_f32_16x16x32_bf16 v[72:75],a[192:195],v[208:211],v[72:75]
ds_bpermute_b32 v125,v41,v121
v_mfma_f32_16x16x32_bf16 v[76:79],a[196:199],v[212:215],v[76:79]
v_min3_u32 v27,v27,v208,v212
v_lshlrev_b32 v108,16,v122
v_mfma_f32_16x16x32_bf16 v[72:75],a[200:203],v[216:219],v[72:75]
v_mfma_f32_16x16x32_bf16 v[76:79],a[204:207],v[220:223],v[76:79]
v_min3_u32 v27,v27,v216,v220
s_waitcnt lgkmcnt(2)
v_mfma_f32_16x16x32_bf16 v[72:75],a[208:211],v[224:227],v[72:75]
v_and_b32 v109,s80,v122
v_mfma_f32_16x16x32_bf16 v[76:79],a[212:215],v[228:231],v[76:79]
v_min3_u32 v27,v27,v224,v228
v_min3_u32 v27,v27,v226,v230
v_mfma_f32_16x16x32_bf16 v[72:75],a[216:219],v[232:235],v[72:75]
v_lshlrev_b32 v110,16,v123
v_mfma_f32_16x16x32_bf16 v[76:79],a[220:223],v[236:239],v[76:79]
v_min3_u32 v27,v27,v232,v236
v_min3_u32 v27,v27,v234,v238
v_mfma_f32_16x16x32_bf16 v[80:83],a[0:3],v[128:131],0
v_cmp_eq_u32 vcc,0,v27
s_cbranch_vccnz retry_325
v_mfma_f32_16x16x32_bf16 v[84:87],a[4:7],v[132:135],0
v_and_b32 v111,s80,v123
s_waitcnt lgkmcnt(0)
v_mfma_f32_16x16x32_bf16 v[80:83],a[8:11],v[136:139],v[80:83]
v_mfma_f32_16x16x32_bf16 v[84:87],a[12:15],v[140:143],v[84:87]
v_lshlrev_b32 v104,16,v124
v_mfma_f32_16x16x32_bf16 v[80:83],a[16:19],v[144:147],v[80:83]
v_add_f32 v72,v72,v76
v_add_f32 v73,v73,v77
v_mfma_f32_16x16x32_bf16 v[84:87],a[20:23],v[148:151],v[84:87]
v_and_b32 v105,s80,v124
v_add_f32 v74,v74,v78
v_mfma_f32_16x16x32_bf16 v[80:83],a[24:27],v[152:155],v[80:83]
v_add_f32 v75,v75,v79
v_and_or_b32 v72,v72,-4,s48
v_mfma_f32_16x16x32_bf16 v[84:87],a[28:31],v[156:159],v[84:87]
v_lshlrev_b32 v106,16,v125
s_add_u32 s64,s77,s33
v_mfma_f32_16x16x32_bf16 v[80:83],a[32:35],v[160:163],v[80:83]
buffer_store_dwordx4 v[72:75],v25,s[20:23],s64 offen offset:1024 sc1
v_mfma_f32_16x16x32_bf16 v[84:87],a[36:39],v[164:167],v[84:87]
v_and_b32 v107,s80,v125
v_mfma_f32_16x16x32_bf16 v[80:83],a[40:43],v[168:171],v[80:83]
v_mfma_f32_16x16x32_bf16 v[84:87],a[44:47],v[172:175],v[84:87]
v_mfma_f32_16x16x32_bf16 v[80:83],a[48:51],v[176:179],v[80:83]
buffer_load_dwordx4 v[96:99],v26,s[20:23],s77 offen offset:2048 sc1
v_mfma_f32_16x16x32_bf16 v[84:87],a[52:55],v[180:183],v[84:87]
buffer_load_dwordx4 v[100:103],v26,s[20:23],s77 offen offset:3072 sc1
v_mfma_f32_16x16x32_bf16 v[80:83],a[56:59],v[184:187],v[80:83]
v_mfma_f32_16x16x32_bf16 v[84:87],a[60:63],v[188:191],v[84:87]
v_mfma_f32_16x16x32_bf16 v[80:83],a[64:67],v[192:195],v[80:83]
v_mfma_f32_16x16x32_bf16 v[84:87],a[68:71],v[196:199],v[84:87]
v_mfma_f32_16x16x32_bf16 v[80:83],a[72:75],v[200:203],v[80:83]
v_mfma_f32_16x16x32_bf16 v[84:87],a[76:79],v[204:207],v[84:87]
v_mfma_f32_16x16x32_bf16 v[80:83],a[80:83],v[208:211],v[80:83]
v_mfma_f32_16x16x32_bf16 v[84:87],a[84:87],v[212:215],v[84:87]
v_mfma_f32_16x16x32_bf16 v[80:83],a[88:91],v[216:219],v[80:83]
buffer_load_dwordx4 v[92:95],v26,s[20:23],s77 offen offset:1024 sc1
v_mfma_f32_16x16x32_bf16 v[84:87],a[92:95],v[220:223],v[84:87]
v_mfma_f32_16x16x32_bf16 v[80:83],a[96:99],v[224:227],v[80:83]
v_mfma_f32_16x16x32_bf16 v[84:87],a[100:103],v[228:231],v[84:87]
v_mfma_f32_16x16x32_bf16 v[80:83],a[104:107],v[232:235],v[80:83]
v_mfma_f32_16x16x32_bf16 v[84:87],a[108:111],v[236:239],v[84:87]
epi_328:
buffer_load_dword v29,v21,s[20:23],s87 offen sc1
s_nop 6
v_pk_add_f32 v[88:89],v[80:81],v[84:85]
v_pk_add_f32 v[90:91],v[82:83],v[86:87]
v_pk_add_f32 v[88:89],v[88:89],v[108:109]
v_pk_add_f32 v[90:91],v[90:91],v[110:111]
s_waitcnt vmcnt(1)
s_branch ic_335
ip_333:
buffer_load_dwordx4 v[92:95],v26,s[20:23],s77 offen offset:1024 sc1
buffer_load_dwordx4 v[96:99],v26,s[20:23],s77 offen offset:2048 sc1
buffer_load_dwordx4 v[100:103],v26,s[20:23],s77 offen offset:3072 sc1
s_waitcnt vmcnt(0)
ic_335:
v_bitop3_b32 v22,v92,v96,v100 bitop3:0x80
v_and_b32 v22,s48,v22
v_cmp_eq_u32 vcc,0,v22
s_cbranch_vccz ik_334
s_sub_u32 s90,s90,1
s_cmp_gt_i32 s90,0
s_cbranch_scc1 ip_333
ik_334:
v_pk_add_f32 v[88:89],v[88:89],v[92:93]
v_pk_add_f32 v[96:97],v[96:97],v[100:101]
v_pk_add_f32 v[90:91],v[90:91],v[94:95]
v_pk_add_f32 v[98:99],v[98:99],v[102:103]
v_pk_add_f32 v[88:89],v[88:89],v[96:97]
v_pk_add_f32 v[90:91],v[90:91],v[98:99]
v_pk_fma_f32 v[88:89],v[88:89],v[52:53],v[104:105]
v_pk_fma_f32 v[90:91],v[90:91],v[54:55],v[106:107]
v_cvt_pk_bf16_f32 v88,v88,v89
v_cvt_pk_bf16_f32 v89,v90,v91
ds_bpermute_b32 v88,v40,v88
ds_bpermute_b32 v89,v40,v89
v_xor_b32 v18,0x10000,v18
s_xor_b32 s49,s77,524288
s_cselect_b32 s64,0,3
s_xor_b32 s48,s48,s64
v_xor_b32 v20,0x2000,v20
s_add_u32 s76,s76,2097152
s_waitcnt lgkmcnt(0)
s_mov_b64 exec,s[84:85]
buffer_store_dwordx2 v[88:89],v19,s[36:39],s78 offen
s_mov_b64 exec,-1
s_mov_b64 s[84:85],-1
s_mov_b32 s77,s49
s_add_u32 s78,s78,65536
v_xor_b32 v17,0x10000,v17
s_xor_b32 s72,s72,0x10000
s_add_u32 s70,s70,2097152
s_xor_b32 s70,s70,0x2000
s_add_u32 s71,s71,1
s_cmp_le_u32 s71,s57
s_cbranch_scc1 seg_326
s_endpgm
retry_325:
s_sub_u32 s90,s90,64
s_cmp_lt_i32 s90,0
s_cbranch_scc1 giveup_197
s_mov_b32 s83,1
s_waitcnt vmcnt(0) lgkmcnt(0)
s_barrier
s_branch seg_326
r_w3_215:
s_load_dwordx2 s[4:5],s[0:1],80
s_mul_i32 s66,s59,224
s_lshl_b32 s67,s50,1
s_waitcnt lgkmcnt(0)
s_mov_b32 s32,s4
s_and_b32 s33,s5,0xffff
s_mov_b32 s34,0x700000
s_mov_b32 s35,0x20000
v_lshrrev_b32 v5,2,v3
v_lshl_add_u32 v5,v4,2,v5
v_and_b32 v6,3,v3
v_lshlrev_b32 v6,3,v6
v_lshl_add_u32 v6,v5,8,v6
v_and_b32 v5,7,v5
v_xor_b32 v5,s67,v5
v_lshl_add_u32 v12,v5,5,v6
v_xor_b32 v13,32,v12
v_and_b32 v5,15,v1
v_and_b32 v6,3,v4
v_lshlrev_b32 v6,1,v6
v_xor_b32 v5,v5,v6
v_mul_u32_u24 v6,7168,v4
v_xor_b32 v7,0,v5
v_lshl_add_u32 v8,v7,4,v6
v_xor_b32 v7,8,v5
v_lshl_add_u32 v9,v7,4,v6
s_mul_i32 s74,s50,458752
s_add_u32 s74,s74,s66
s_lshl_b32 s75,s50,14
s_mul_i32 s76,s50,229376
s_add_u32 s76,s76,s66
s_lshl_b32 s77,s50,13
s_add_u32 s64,s74,0
s_add_u32 m0,s75,0
s_nop 0
buffer_load_dwordx4 v8,s[32:35],s64 offen nt lds
s_add_u32 s64,s74,28672
s_add_u32 m0,s75,1024
s_nop 0
buffer_load_dwordx4 v9,s[32:35],s64 offen nt lds
s_add_u32 s64,s74,57344
s_add_u32 m0,s75,2048
s_nop 0
buffer_load_dwordx4 v8,s[32:35],s64 offen nt lds
s_add_u32 s64,s74,86016
s_add_u32 m0,s75,3072
s_nop 0
buffer_load_dwordx4 v9,s[32:35],s64 offen nt lds
s_add_u32 s64,s74,114688
s_add_u32 m0,s75,4096
s_nop 0
buffer_load_dwordx4 v8,s[32:35],s64 offen nt lds
s_add_u32 s64,s74,143360
s_add_u32 m0,s75,5120
s_nop 0
buffer_load_dwordx4 v9,s[32:35],s64 offen nt lds
s_add_u32 s64,s74,172032
s_add_u32 m0,s75,6144
s_nop 0
buffer_load_dwordx4 v8,s[32:35],s64 offen nt lds
s_add_u32 s64,s74,200704
s_add_u32 m0,s75,7168
s_nop 0
buffer_load_dwordx4 v9,s[32:35],s64 offen nt lds
s_add_u32 s64,s74,229376
s_add_u32 m0,s75,8192
s_nop 0
buffer_load_dwordx4 v8,s[32:35],s64 offen nt lds
s_add_u32 s64,s74,258048
s_add_u32 m0,s75,9216
s_nop 0
buffer_load_dwordx4 v9,s[32:35],s64 offen nt lds
s_add_u32 s64,s74,286720
s_add_u32 m0,s75,10240
s_nop 0
buffer_load_dwordx4 v8,s[32:35],s64 offen nt lds
s_add_u32 s64,s74,315392
s_add_u32 m0,s75,11264
s_nop 0
buffer_load_dwordx4 v9,s[32:35],s64 offen nt lds
s_add_u32 s64,s74,344064
s_add_u32 m0,s75,12288
s_nop 0
buffer_load_dwordx4 v8,s[32:35],s64 offen nt lds
s_add_u32 s64,s74,372736
s_add_u32 m0,s75,13312
s_nop 0
buffer_load_dwordx4 v9,s[32:35],s64 offen nt lds
s_add_u32 s64,s74,401408
s_add_u32 m0,s75,14336
s_nop 0
buffer_load_dwordx4 v8,s[32:35],s64 offen nt lds
s_add_u32 s64,s74,430080
s_add_u32 m0,s75,15360
s_nop 0
buffer_load_dwordx4 v9,s[32:35],s64 offen nt lds
s_add_u32 s64,s74,1835008
s_add_u32 m0,s75,65536
s_nop 0
buffer_load_dwordx4 v8,s[32:35],s64 offen nt lds
s_add_u32 s64,s74,1863680
s_add_u32 m0,s75,66560
s_nop 0
buffer_load_dwordx4 v9,s[32:35],s64 offen nt lds
s_add_u32 s64,s74,1892352
s_add_u32 m0,s75,67584
s_nop 0
buffer_load_dwordx4 v8,s[32:35],s64 offen nt lds
s_add_u32 s64,s74,1921024
s_add_u32 m0,s75,68608
s_nop 0
buffer_load_dwordx4 v9,s[32:35],s64 offen nt lds
s_add_u32 s64,s74,1949696
s_add_u32 m0,s75,69632
s_nop 0
buffer_load_dwordx4 v8,s[32:35],s64 offen nt lds
s_add_u32 s64,s74,1978368
s_add_u32 m0,s75,70656
s_nop 0
buffer_load_dwordx4 v9,s[32:35],s64 offen nt lds
s_add_u32 s64,s74,2007040
s_add_u32 m0,s75,71680
s_nop 0
buffer_load_dwordx4 v8,s[32:35],s64 offen nt lds
s_add_u32 s64,s74,2035712
s_add_u32 m0,s75,72704
s_nop 0
buffer_load_dwordx4 v9,s[32:35],s64 offen nt lds
s_add_u32 s64,s74,2064384
s_add_u32 m0,s75,73728
s_nop 0
buffer_load_dwordx4 v8,s[32:35],s64 offen nt lds
s_add_u32 s64,s74,2093056
s_add_u32 m0,s75,74752
s_nop 0
buffer_load_dwordx4 v9,s[32:35],s64 offen nt lds
s_add_u32 s64,s74,2121728
s_add_u32 m0,s75,75776
s_nop 0
buffer_load_dwordx4 v8,s[32:35],s64 offen nt lds
s_add_u32 s64,s74,2150400
s_add_u32 m0,s75,76800
s_nop 0
buffer_load_dwordx4 v9,s[32:35],s64 offen nt lds
s_add_u32 s64,s74,2179072
s_add_u32 m0,s75,77824
s_nop 0
buffer_load_dwordx4 v8,s[32:35],s64 offen nt lds
s_add_u32 s64,s74,2207744
s_add_u32 m0,s75,78848
s_nop 0
buffer_load_dwordx4 v9,s[32:35],s64 offen nt lds
s_add_u32 s64,s74,2236416
s_add_u32 m0,s75,79872
s_nop 0
buffer_load_dwordx4 v8,s[32:35],s64 offen nt lds
s_add_u32 s64,s74,2265088
s_add_u32 m0,s75,80896
s_nop 0
buffer_load_dwordx4 v9,s[32:35],s64 offen nt lds
s_waitcnt vmcnt(16)
s_barrier
ds_read_b64_tr_b16 a[0:1],v12 offset:0
ds_read_b64_tr_b16 a[128:129],v13 offset:0
ds_read_b64_tr_b16 a[2:3],v12 offset:4096
ds_read_b64_tr_b16 a[130:131],v13 offset:4096
ds_read_b64_tr_b16 a[4:5],v12 offset:8192
ds_read_b64_tr_b16 a[132:133],v13 offset:8192
ds_read_b64_tr_b16 a[6:7],v12 offset:12288
ds_read_b64_tr_b16 a[134:135],v13 offset:12288
s_waitcnt lgkmcnt(4)
ds_read_b64_tr_b16 a[8:9],v12 offset:16384
ds_read_b64_tr_b16 a[136:137],v13 offset:16384
ds_read_b64_tr_b16 a[10:11],v12 offset:20480
ds_read_b64_tr_b16 a[138:139],v13 offset:20480
ds_read_b64_tr_b16 a[12:13],v12 offset:24576
ds_read_b64_tr_b16 a[140:141],v13 offset:24576
ds_read_b64_tr_b16 a[14:15],v12 offset:28672
ds_read_b64_tr_b16 a[142:143],v13 offset:28672
s_waitcnt lgkmcnt(4)
ds_read_b64_tr_b16 a[16:17],v12 offset:32768
ds_read_b64_tr_b16 a[144:145],v13 offset:32768
ds_read_b64_tr_b16 a[18:19],v12 offset:36864
ds_read_b64_tr_b16 a[146:147],v13 offset:36864
ds_read_b64_tr_b16 a[20:21],v12 offset:40960
ds_read_b64_tr_b16 a[148:149],v13 offset:40960
ds_read_b64_tr_b16 a[22:23],v12 offset:45056
ds_read_b64_tr_b16 a[150:151],v13 offset:45056
s_waitcnt lgkmcnt(4)
ds_read_b64_tr_b16 a[24:25],v12 offset:49152
ds_read_b64_tr_b16 a[152:153],v13 offset:49152
ds_read_b64_tr_b16 a[26:27],v12 offset:53248
ds_read_b64_tr_b16 a[154:155],v13 offset:53248
ds_read_b64_tr_b16 a[28:29],v12 offset:57344
ds_read_b64_tr_b16 a[156:157],v13 offset:57344
ds_read_b64_tr_b16 a[30:31],v12 offset:61440
ds_read_b64_tr_b16 a[158:159],v13 offset:61440
s_waitcnt lgkmcnt(4)
v_xor_b32 v12,0x10000,v12
v_xor_b32 v13,0x10000,v13
s_waitcnt lgkmcnt(0)
s_barrier
s_add_u32 s64,s74,3670016
s_add_u32 m0,s75,0
s_nop 0
buffer_load_dwordx4 v8,s[32:35],s64 offen nt lds
s_add_u32 s64,s74,3698688
s_add_u32 m0,s75,1024
s_nop 0
buffer_load_dwordx4 v9,s[32:35],s64 offen nt lds
s_add_u32 s64,s74,3727360
s_add_u32 m0,s75,2048
s_nop 0
buffer_load_dwordx4 v8,s[32:35],s64 offen nt lds
s_add_u32 s64,s74,3756032
s_add_u32 m0,s75,3072
s_nop 0
buffer_load_dwordx4 v9,s[32:35],s64 offen nt lds
s_add_u32 s64,s74,3784704
s_add_u32 m0,s75,4096
s_nop 0
buffer_load_dwordx4 v8,s[32:35],s64 offen nt lds
s_add_u32 s64,s74,3813376
s_add_u32 m0,s75,5120
s_nop 0
buffer_load_dwordx4 v9,s[32:35],s64 offen nt lds
s_add_u32 s64,s74,3842048
s_add_u32 m0,s75,6144
s_nop 0
buffer_load_dwordx4 v8,s[32:35],s64 offen nt lds
s_add_u32 s64,s74,3870720
s_add_u32 m0,s75,7168
s_nop 0
buffer_load_dwordx4 v9,s[32:35],s64 offen nt lds
s_add_u32 s64,s74,3899392
s_add_u32 m0,s75,8192
s_nop 0
buffer_load_dwordx4 v8,s[32:35],s64 offen nt lds
s_add_u32 s64,s74,3928064
s_add_u32 m0,s75,9216
s_nop 0
buffer_load_dwordx4 v9,s[32:35],s64 offen nt lds
s_add_u32 s64,s74,3956736
s_add_u32 m0,s75,10240
s_nop 0
buffer_load_dwordx4 v8,s[32:35],s64 offen nt lds
s_add_u32 s64,s74,3985408
s_add_u32 m0,s75,11264
s_nop 0
buffer_load_dwordx4 v9,s[32:35],s64 offen nt lds
s_add_u32 s64,s74,4014080
s_add_u32 m0,s75,12288
s_nop 0
buffer_load_dwordx4 v8,s[32:35],s64 offen nt lds
s_add_u32 s64,s74,4042752
s_add_u32 m0,s75,13312
s_nop 0
buffer_load_dwordx4 v9,s[32:35],s64 offen nt lds
s_add_u32 s64,s74,4071424
s_add_u32 m0,s75,14336
s_nop 0
buffer_load_dwordx4 v8,s[32:35],s64 offen nt lds
s_add_u32 s64,s74,4100096
s_add_u32 m0,s75,15360
s_nop 0
buffer_load_dwordx4 v9,s[32:35],s64 offen nt lds
s_waitcnt vmcnt(16)
s_barrier
ds_read_b64_tr_b16 a[32:33],v12 offset:0
ds_read_b64_tr_b16 a[160:161],v13 offset:0
ds_read_b64_tr_b16 a[34:35],v12 offset:4096
ds_read_b64_tr_b16 a[162:163],v13 offset:4096
ds_read_b64_tr_b16 a[36:37],v12 offset:8192
ds_read_b64_tr_b16 a[164:165],v13 offset:8192
ds_read_b64_tr_b16 a[38:39],v12 offset:12288
ds_read_b64_tr_b16 a[166:167],v13 offset:12288
s_waitcnt lgkmcnt(4)
ds_read_b64_tr_b16 a[40:41],v12 offset:16384
ds_read_b64_tr_b16 a[168:169],v13 offset:16384
ds_read_b64_tr_b16 a[42:43],v12 offset:20480
ds_read_b64_tr_b16 a[170:171],v13 offset:20480
ds_read_b64_tr_b16 a[44:45],v12 offset:24576
ds_read_b64_tr_b16 a[172:173],v13 offset:24576
ds_read_b64_tr_b16 a[46:47],v12 offset:28672
ds_read_b64_tr_b16 a[174:175],v13 offset:28672
s_waitcnt lgkmcnt(4)
ds_read_b64_tr_b16 a[48:49],v12 offset:32768
ds_read_b64_tr_b16 a[176:177],v13 offset:32768
ds_read_b64_tr_b16 a[50:51],v12 offset:36864
ds_read_b64_tr_b16 a[178:179],v13 offset:36864
ds_read_b64_tr_b16 a[52:53],v12 offset:40960
ds_read_b64_tr_b16 a[180:181],v13 offset:40960
ds_read_b64_tr_b16 a[54:55],v12 offset:45056
ds_read_b64_tr_b16 a[182:183],v13 offset:45056
s_waitcnt lgkmcnt(4)
ds_read_b64_tr_b16 a[56:57],v12 offset:49152
ds_read_b64_tr_b16 a[184:185],v13 offset:49152
ds_read_b64_tr_b16 a[58:59],v12 offset:53248
ds_read_b64_tr_b16 a[186:187],v13 offset:53248
ds_read_b64_tr_b16 a[60:61],v12 offset:57344
ds_read_b64_tr_b16 a[188:189],v13 offset:57344
ds_read_b64_tr_b16 a[62:63],v12 offset:61440
ds_read_b64_tr_b16 a[190:191],v13 offset:61440
s_waitcnt lgkmcnt(4)
v_xor_b32 v12,0x10000,v12
v_xor_b32 v13,0x10000,v13
s_waitcnt lgkmcnt(0)
s_barrier
s_add_u32 s64,s74,5505024
s_add_u32 m0,s75,65536
s_nop 0
buffer_load_dwordx4 v8,s[32:35],s64 offen nt lds
s_add_u32 s64,s74,5533696
s_add_u32 m0,s75,66560
s_nop 0
buffer_load_dwordx4 v9,s[32:35],s64 offen nt lds
s_add_u32 s64,s74,5562368
s_add_u32 m0,s75,67584
s_nop 0
buffer_load_dwordx4 v8,s[32:35],s64 offen nt lds
s_add_u32 s64,s74,5591040
s_add_u32 m0,s75,68608
s_nop 0
buffer_load_dwordx4 v9,s[32:35],s64 offen nt lds
s_add_u32 s64,s74,5619712
s_add_u32 m0,s75,69632
s_nop 0
buffer_load_dwordx4 v8,s[32:35],s64 offen nt lds
s_add_u32 s64,s74,5648384
s_add_u32 m0,s75,70656
s_nop 0
buffer_load_dwordx4 v9,s[32:35],s64 offen nt lds
s_add_u32 s64,s74,5677056
s_add_u32 m0,s75,71680
s_nop 0
buffer_load_dwordx4 v8,s[32:35],s64 offen nt lds
s_add_u32 s64,s74,5705728
s_add_u32 m0,s75,72704
s_nop 0
buffer_load_dwordx4 v9,s[32:35],s64 offen nt lds
s_add_u32 s64,s74,5734400
s_add_u32 m0,s75,73728
s_nop 0
buffer_load_dwordx4 v8,s[32:35],s64 offen nt lds
s_add_u32 s64,s74,5763072
s_add_u32 m0,s75,74752
s_nop 0
buffer_load_dwordx4 v9,s[32:35],s64 offen nt lds
s_add_u32 s64,s74,5791744
s_add_u32 m0,s75,75776
s_nop 0
buffer_load_dwordx4 v8,s[32:35],s64 offen nt lds
s_add_u32 s64,s74,5820416
s_add_u32 m0,s75,76800
s_nop 0
buffer_load_dwordx4 v9,s[32:35],s64 offen nt lds
s_add_u32 s64,s74,5849088
s_add_u32 m0,s75,77824
s_nop 0
buffer_load_dwordx4 v8,s[32:35],s64 offen nt lds
s_add_u32 s64,s74,5877760
s_add_u32 m0,s75,78848
s_nop 0
buffer_load_dwordx4 v9,s[32:35],s64 offen nt lds
s_add_u32 s64,s74,5906432
s_add_u32 m0,s75,79872
s_nop 0
buffer_load_dwordx4 v8,s[32:35],s64 offen nt lds
s_add_u32 s64,s74,5935104
s_add_u32 m0,s75,80896
s_nop 0
buffer_load_dwordx4 v9,s[32:35],s64 offen nt lds
s_waitcnt vmcnt(16)
s_barrier
ds_read_b64_tr_b16 a[64:65],v12 offset:0
ds_read_b64_tr_b16 a[192:193],v13 offset:0
ds_read_b64_tr_b16 a[66:67],v12 offset:4096
ds_read_b64_tr_b16 a[194:195],v13 offset:4096
ds_read_b64_tr_b16 a[68:69],v12 offset:8192
ds_read_b64_tr_b16 a[196:197],v13 offset:8192
ds_read_b64_tr_b16 a[70:71],v12 offset:12288
ds_read_b64_tr_b16 a[198:199],v13 offset:12288
s_waitcnt lgkmcnt(4)
ds_read_b64_tr_b16 a[72:73],v12 offset:16384
ds_read_b64_tr_b16 a[200:201],v13 offset:16384
ds_read_b64_tr_b16 a[74:75],v12 offset:20480
ds_read_b64_tr_b16 a[202:203],v13 offset:20480
ds_read_b64_tr_b16 a[76:77],v12 offset:24576
ds_read_b64_tr_b16 a[204:205],v13 offset:24576
ds_read_b64_tr_b16 a[78:79],v12 offset:28672
ds_read_b64_tr_b16 a[206:207],v13 offset:28672
s_waitcnt lgkmcnt(4)
ds_read_b64_tr_b16 a[80:81],v12 offset:32768
ds_read_b64_tr_b16 a[208:209],v13 offset:32768
ds_read_b64_tr_b16 a[82:83],v12 offset:36864
ds_read_b64_tr_b16 a[210:211],v13 offset:36864
ds_read_b64_tr_b16 a[84:85],v12 offset:40960
ds_read_b64_tr_b16 a[212:213],v13 offset:40960
ds_read_b64_tr_b16 a[86:87],v12 offset:45056
ds_read_b64_tr_b16 a[214:215],v13 offset:45056
s_waitcnt lgkmcnt(4)
ds_read_b64_tr_b16 a[88:89],v12 offset:49152
ds_read_b64_tr_b16 a[216:217],v13 offset:49152
ds_read_b64_tr_b16 a[90:91],v12 offset:53248
ds_read_b64_tr_b16 a[218:219],v13 offset:53248
ds_read_b64_tr_b16 a[92:93],v12 offset:57344
ds_read_b64_tr_b16 a[220:221],v13 offset:57344
ds_read_b64_tr_b16 a[94:95],v12 offset:61440
ds_read_b64_tr_b16 a[222:223],v13 offset:61440
s_waitcnt lgkmcnt(4)
v_xor_b32 v12,0x10000,v12
v_xor_b32 v13,0x10000,v13
s_waitcnt lgkmcnt(0)
s_barrier
s_waitcnt vmcnt(0)
s_barrier
ds_read_b64_tr_b16 a[96:97],v12 offset:0
ds_read_b64_tr_b16 a[224:225],v13 offset:0
ds_read_b64_tr_b16 a[98:99],v12 offset:4096
ds_read_b64_tr_b16 a[226:227],v13 offset:4096
ds_read_b64_tr_b16 a[100:101],v12 offset:8192
ds_read_b64_tr_b16 a[228:229],v13 offset:8192
ds_read_b64_tr_b16 a[102:103],v12 offset:12288
ds_read_b64_tr_b16 a[230:231],v13 offset:12288
s_waitcnt lgkmcnt(4)
ds_read_b64_tr_b16 a[104:105],v12 offset:16384
ds_read_b64_tr_b16 a[232:233],v13 offset:16384
ds_read_b64_tr_b16 a[106:107],v12 offset:20480
ds_read_b64_tr_b16 a[234:235],v13 offset:20480
ds_read_b64_tr_b16 a[108:109],v12 offset:24576
ds_read_b64_tr_b16 a[236:237],v13 offset:24576
ds_read_b64_tr_b16 a[110:111],v12 offset:28672
ds_read_b64_tr_b16 a[238:239],v13 offset:28672
s_waitcnt lgkmcnt(4)
ds_read_b64_tr_b16 a[112:113],v12 offset:32768
ds_read_b64_tr_b16 a[240:241],v13 offset:32768
ds_read_b64_tr_b16 a[114:115],v12 offset:36864
ds_read_b64_tr_b16 a[242:243],v13 offset:36864
ds_read_b64_tr_b16 a[116:117],v12 offset:40960
ds_read_b64_tr_b16 a[244:245],v13 offset:40960
ds_read_b64_tr_b16 a[118:119],v12 offset:45056
ds_read_b64_tr_b16 a[246:247],v13 offset:45056
s_waitcnt lgkmcnt(4)
ds_read_b64_tr_b16 a[120:121],v12 offset:49152
ds_read_b64_tr_b16 a[248:249],v13 offset:49152
ds_read_b64_tr_b16 a[122:123],v12 offset:53248
ds_read_b64_tr_b16 a[250:251],v13 offset:53248
ds_read_b64_tr_b16 a[124:125],v12 offset:57344
ds_read_b64_tr_b16 a[252:253],v13 offset:57344
ds_read_b64_tr_b16 a[126:127],v12 offset:61440
ds_read_b64_tr_b16 a[254:255],v13 offset:61440
s_waitcnt lgkmcnt(4)
v_xor_b32 v12,0x10000,v12
v_xor_b32 v13,0x10000,v13
s_waitcnt lgkmcnt(0)
s_barrier
v_mov_b32 v88,0x3f803f80
v_mov_b32 v89,0x3f803f80
v_mov_b32 v90,0x3f803f80
v_mov_b32 v91,0x3f803f80
s_nop 1
v_mfma_f32_16x16x32_bf16 v[52:55],a[0:3],v[88:91],0
v_mfma_f32_16x16x32_bf16 v[56:59],a[128:131],v[88:91],0
v_mfma_f32_16x16x32_bf16 v[52:55],a[4:7],v[88:91],v[52:55]
v_mfma_f32_16x16x32_bf16 v[56:59],a[132:135],v[88:91],v[56:59]
v_mfma_f32_16x16x32_bf16 v[52:55],a[8:11],v[88:91],v[52:55]
v_mfma_f32_16x16x32_bf16 v[56:59],a[136:139],v[88:91],v[56:59]
v_mfma_f32_16x16x32_bf16 v[52:55],a[12:15],v[88:91],v[52:55]
v_mfma_f32_16x16x32_bf16 v[56:59],a[140:143],v[88:91],v[56:59]
v_mfma_f32_16x16x32_bf16 v[52:55],a[16:19],v[88:91],v[52:55]
v_mfma_f32_16x16x32_bf16 v[56:59],a[144:147],v[88:91],v[56:59]
v_mfma_f32_16x16x32_bf16 v[52:55],a[20:23],v[88:91],v[52:55]
v_mfma_f32_16x16x32_bf16 v[56:59],a[148:151],v[88:91],v[56:59]
v_mfma_f32_16x16x32_bf16 v[52:55],a[24:27],v[88:91],v[52:55]
v_mfma_f32_16x16x32_bf16 v[56:59],a[152:155],v[88:91],v[56:59]
v_mfma_f32_16x16x32_bf16 v[52:55],a[28:31],v[88:91],v[52:55]
v_mfma_f32_16x16x32_bf16 v[56:59],a[156:159],v[88:91],v[56:59]
v_mfma_f32_16x16x32_bf16 v[52:55],a[32:35],v[88:91],v[52:55]
v_mfma_f32_16x16x32_bf16 v[56:59],a[160:163],v[88:91],v[56:59]
v_mfma_f32_16x16x32_bf16 v[52:55],a[36:39],v[88:91],v[52:55]
v_mfma_f32_16x16x32_bf16 v[56:59],a[164:167],v[88:91],v[56:59]
v_mfma_f32_16x16x32_bf16 v[52:55],a[40:43],v[88:91],v[52:55]
v_mfma_f32_16x16x32_bf16 v[56:59],a[168:171],v[88:91],v[56:59]
v_mfma_f32_16x16x32_bf16 v[52:55],a[44:47],v[88:91],v[52:55]
v_mfma_f32_16x16x32_bf16 v[56:59],a[172:175],v[88:91],v[56:59]
v_mfma_f32_16x16x32_bf16 v[52:55],a[48:51],v[88:91],v[52:55]
v_mfma_f32_16x16x32_bf16 v[56:59],a[176:179],v[88:91],v[56:59]
v_mfma_f32_16x16x32_bf16 v[52:55],a[52:55],v[88:91],v[52:55]
v_mfma_f32_16x16x32_bf16 v[56:59],a[180:183],v[88:91],v[56:59]
v_mfma_f32_16x16x32_bf16 v[52:55],a[56:59],v[88:91],v[52:55]
v_mfma_f32_16x16x32_bf16 v[56:59],a[184:187],v[88:91],v[56:59]
v_mfma_f32_16x16x32_bf16 v[52:55],a[60:63],v[88:91],v[52:55]
v_mfma_f32_16x16x32_bf16 v[56:59],a[188:191],v[88:91],v[56:59]
v_mfma_f32_16x16x32_bf16 v[52:55],a[64:67],v[88:91],v[52:55]
v_mfma_f32_16x16x32_bf16 v[56:59],a[192:195],v[88:91],v[56:59]
v_mfma_f32_16x16x32_bf16 v[52:55],a[68:71],v[88:91],v[52:55]
v_mfma_f32_16x16x32_bf16 v[56:59],a[196:199],v[88:91],v[56:59]
v_mfma_f32_16x16x32_bf16 v[52:55],a[72:75],v[88:91],v[52:55]
v_mfma_f32_16x16x32_bf16 v[56:59],a[200:203],v[88:91],v[56:59]
v_mfma_f32_16x16x32_bf16 v[52:55],a[76:79],v[88:91],v[52:55]
v_mfma_f32_16x16x32_bf16 v[56:59],a[204:207],v[88:91],v[56:59]
v_mfma_f32_16x16x32_bf16 v[52:55],a[80:83],v[88:91],v[52:55]
v_mfma_f32_16x16x32_bf16 v[56:59],a[208:211],v[88:91],v[56:59]
v_mfma_f32_16x16x32_bf16 v[52:55],a[84:87],v[88:91],v[52:55]
v_mfma_f32_16x16x32_bf16 v[56:59],a[212:215],v[88:91],v[56:59]
v_mfma_f32_16x16x32_bf16 v[52:55],a[88:91],v[88:91],v[52:55]
v_mfma_f32_16x16x32_bf16 v[56:59],a[216:219],v[88:91],v[56:59]
v_mfma_f32_16x16x32_bf16 v[52:55],a[92:95],v[88:91],v[52:55]
v_mfma_f32_16x16x32_bf16 v[56:59],a[220:223],v[88:91],v[56:59]
v_mfma_f32_16x16x32_bf16 v[52:55],a[96:99],v[88:91],v[52:55]
v_mfma_f32_16x16x32_bf16 v[56:59],a[224:227],v[88:91],v[56:59]
v_mfma_f32_16x16x32_bf16 v[52:55],a[100:103],v[88:91],v[52:55]
v_mfma_f32_16x16x32_bf16 v[56:59],a[228:231],v[88:91],v[56:59]
v_mfma_f32_16x16x32_bf16 v[52:55],a[104:107],v[88:91],v[52:55]
v_mfma_f32_16x16x32_bf16 v[56:59],a[232:235],v[88:91],v[56:59]
v_mfma_f32_16x16x32_bf16 v[52:55],a[108:111],v[88:91],v[52:55]
v_mfma_f32_16x16x32_bf16 v[56:59],a[236:239],v[88:91],v[56:59]
v_mfma_f32_16x16x32_bf16 v[52:55],a[112:115],v[88:91],v[52:55]
v_mfma_f32_16x16x32_bf16 v[56:59],a[240:243],v[88:91],v[56:59]
v_mfma_f32_16x16x32_bf16 v[52:55],a[116:119],v[88:91],v[52:55]
v_mfma_f32_16x16x32_bf16 v[56:59],a[244:247],v[88:91],v[56:59]
v_mfma_f32_16x16x32_bf16 v[52:55],a[120:123],v[88:91],v[52:55]
v_mfma_f32_16x16x32_bf16 v[56:59],a[248:251],v[88:91],v[56:59]
v_mfma_f32_16x16x32_bf16 v[52:55],a[124:127],v[88:91],v[52:55]
v_mfma_f32_16x16x32_bf16 v[56:59],a[252:255],v[88:91],v[56:59]
v_and_b32 v21,1,v1
v_mul_u32_u24 v21,960,v21
s_mov_b32 s65,21052032
s_mov_b32 s66,1792
pl_336:
buffer_load_dword v22,v21,s[20:23],s65 offen sc1
s_waitcnt vmcnt(0)
v_cmp_gt_u32 vcc,s66,v22
s_cbranch_vccz pok_337
s_sleep 1
s_sub_u32 s90,s90,1
s_cmp_gt_i32 s90,0
s_cbranch_scc1 pl_336
pok_337:
s_mov_b32 s81,0xbdd2d3e8
v_mov_b32 v28,0xc0135761
s_lshr_b32 s41,s59,3
s_and_b32 s42,s59,7
s_mul_i32 s64,s42,3
s_add_u32 s64,s64,s50
s_lshr_b32 s65,s42,1
s_add_u32 s65,s65,24
s_cmp_eq_u32 s50,3
s_cselect_b32 s64,s65,s64
s_and_b32 s65,s42,1
s_lshl_b32 s65,s65,3
s_cmp_eq_u32 s50,3
s_cselect_b32 s65,s65,0
s_and_b32 s66,s64,3
s_lshl_b32 s66,s66,11
s_add_u32 s65,s65,s66
s_lshr_b32 s64,s64,2
s_mul_i32 s66,s41,7
s_add_u32 s64,s64,s66
s_add_u32 s64,s64,81
s_lshl_b32 s64,s64,14
s_add_u32 s64,s64,s65
v_add_u32 v18,s64,v16
v_mov_b32 v17,v16
v_lshlrev_b32 v19,4,v3
v_add_u32 v19,131072,v19
v_and_b32 v21,7,v1
v_lshlrev_b32 v21,7,v21
v_bfe_u32 v6,v1,3,2
v_lshl_add_u32 v21,v6,2,v21
s_add_u32 s74,s63,6144
s_add_u32 s74,s74,s60
s_lshl_b32 s73,s59,7
s_lshl_b32 s64,s50,2
s_add_u32 s73,s73,s64
s_add_u32 s73,s73,s63
s_add_u32 s73,s73,20480
s_lshl_b32 s64,s60,4
s_add_u32 s73,s73,s64
s_mov_b32 s82,0x3a800000
s_mov_b32 s64,0
s_lshr_b32 s65,s50,1
s_and_b32 s66,s50,1
s_lshl_b32 s66,s66,12
s_add_u32 s66,s66,s64
s_lshl_b32 s72,s65,13
s_add_u32 s72,s72,s66
s_add_u32 s72,s72,0x10000
s_lshl_b32 s65,s65,14
s_add_u32 s75,s65,s66
s_add_u32 s75,s75,1179648
s_cmp_eq_u32 s50,3
s_cbranch_scc1 w3b_338
s_add_u32 s64,s79,0
s_lshl_b32 s70,s64,21
s_lshl_b32 s64,s64,13
s_and_b32 s64,s64,0x2000
s_xor_b32 s64,s64,s62
s_add_u32 s70,s70,s64
s_add_u32 s70,s70,29360128
s_mov_b32 s83,1
s_mov_b32 s87,s74
s_cmp_eq_u32 s50,0
s_cselect_b32 s74,s74,0x7fff0000
v_mov_b32 v47,132096
s_lshl_b32 s64,s50,3
s_add_u32 s64,s64,132096
v_mov_b32 v46,s64
v_mov_b32 v29,0
s_mov_b32 s97,0x7fff0000
seg_340:
s_cmp_eq_u32 s83,0
s_cbranch_scc1 ahead_341
s_add_u32 s94,s70,s75
s_xor_b32 s95,s94,1024
s_xor_b32 s91,s72,0x10000
s_waitcnt vmcnt(2)
v_cmp_gt_u32 vcc,s71,v29
s_cbranch_vccz nb_344
s_waitcnt vmcnt(0)
v_add_u32 v22,s71,-1
buffer_store_dword v22,v23,s[20:23],s97 offen sc1
s_mov_b32 s97,0x7fff0000
s_cmp_lg_u32 s50,0
s_cbranch_scc1 nb_344
buffer_load_dword v32,v21,s[20:23],s74 offen sc1
s_sleep 2
pl_345:
buffer_load_dword v33,v21,s[20:23],s74 offen sc1
s_waitcnt vmcnt(1)
v_cmp_gt_u32 vcc,s71,v32
v_mov_b32 v29,v32
s_cbranch_vccz pok_346
buffer_load_dword v32,v21,s[20:23],s74 offen sc1
s_waitcnt vmcnt(1)
v_cmp_gt_u32 vcc,s71,v33
v_mov_b32 v29,v33
s_cbranch_vccz pok_346
s_sub_u32 s90,s90,1
s_cmp_gt_i32 s90,0
s_cbranch_scc1 pl_345
pok_346:
nb_344:
s_barrier
s_xor_b32 m0,s91,0
s_add_u32 s65,s94,0
buffer_load_dwordx4 v16,s[20:23],s65 offen offset:0 sc1 lds
buffer_load_dwordx4 v16,s[20:23],s65 offen offset:2048 sc1 lds
s_xor_b32 m0,s91,16384
s_add_u32 s65,s94,32768
buffer_load_dwordx4 v16,s[20:23],s65 offen offset:0 sc1 lds
buffer_load_dwordx4 v16,s[20:23],s65 offen offset:2048 sc1 lds
s_xor_b32 m0,s91,32768
s_add_u32 s65,s94,65536
buffer_load_dwordx4 v16,s[20:23],s65 offen offset:0 sc1 lds
buffer_load_dwordx4 v16,s[20:23],s65 offen offset:2048 sc1 lds
s_xor_b32 m0,s91,49152
s_add_u32 s65,s94,98304
buffer_load_dwordx4 v16,s[20:23],s65 offen offset:0 sc1 lds
buffer_load_dwordx4 v16,s[20:23],s65 offen offset:2048 sc1 lds
s_waitcnt vmcnt(8)
v_add_u32 v22,s71,-1
buffer_store_dword v22,v23,s[20:23],s97 offen sc1
s_mov_b32 s97,0x7fff0000
s_waitcnt vmcnt(7)
s_barrier
ds_read_b128 v[224:227],v17 offset:0
ds_read_b128 v[228:231],v17 offset:2048
ds_read_b128 v[232:235],v17 offset:4096
ds_read_b128 v[236:239],v17 offset:6144
ds_read_b128 v[240:243],v17 offset:8192
ds_read_b128 v[244:247],v17 offset:10240
ds_read_b128 v[248:251],v17 offset:12288
s_waitcnt lgkmcnt(5)
v_mfma_f32_16x16x32_bf16 v[64:67],a[0:3],v[224:227],0
s_xor_b32 m0,s91,1024
s_add_u32 s96,s71,1
v_mfma_f32_16x16x32_bf16 v[72:75],a[128:131],v[224:227],0
ds_read_b128 v[252:255],v17 offset:14336
s_add_u32 s92,s71,2
v_mfma_f32_16x16x32_bf16 v[64:67],a[4:7],v[228:231],v[64:67]
s_add_u32 s65,s95,0
v_min_u32 v27,v224,v228
v_mfma_f32_16x16x32_bf16 v[72:75],a[132:135],v[228:231],v[72:75]
s_waitcnt vmcnt(5)
s_barrier
ds_read_b128 v[224:227],v17 offset:16384
s_waitcnt lgkmcnt(5)
v_mfma_f32_16x16x32_bf16 v[64:67],a[8:11],v[232:235],v[64:67]
buffer_load_dwordx4 v16,s[20:23],s65 offen offset:0 sc1 lds
v_mfma_f32_16x16x32_bf16 v[72:75],a[136:139],v[232:235],v[72:75]
ds_read_b128 v[228:231],v17 offset:18432
v_min3_u32 v27,v27,v232,v236
v_mfma_f32_16x16x32_bf16 v[64:67],a[12:15],v[236:239],v[64:67]
buffer_load_dwordx4 v16,s[20:23],s65 offen offset:2048 sc1 lds
v_mfma_f32_16x16x32_bf16 v[72:75],a[140:143],v[236:239],v[72:75]
ds_read_b128 v[232:235],v17 offset:20480
s_waitcnt lgkmcnt(5)
v_mfma_f32_16x16x32_bf16 v[64:67],a[16:19],v[240:243],v[64:67]
s_xor_b32 m0,s91,17408
v_min3_u32 v27,v27,v240,v244
v_mfma_f32_16x16x32_bf16 v[72:75],a[144:147],v[240:243],v[72:75]
ds_read_b128 v[236:239],v17 offset:22528
v_mfma_f32_16x16x32_bf16 v[64:67],a[20:23],v[244:247],v[64:67]
s_add_u32 s65,s95,32768
v_mfma_f32_16x16x32_bf16 v[72:75],a[148:151],v[244:247],v[72:75]
ds_read_b128 v[240:243],v17 offset:24576
s_waitcnt lgkmcnt(5)
v_mfma_f32_16x16x32_bf16 v[64:67],a[24:27],v[248:251],v[64:67]
buffer_load_dwordx4 v16,s[20:23],s65 offen offset:0 sc1 lds
v_mfma_f32_16x16x32_bf16 v[72:75],a[152:155],v[248:251],v[72:75]
ds_read_b128 v[244:247],v17 offset:26624
v_min3_u32 v27,v27,v248,v252
v_mfma_f32_16x16x32_bf16 v[64:67],a[28:31],v[252:255],v[64:67]
buffer_load_dwordx4 v16,s[20:23],s65 offen offset:2048 sc1 lds
v_mfma_f32_16x16x32_bf16 v[72:75],a[156:159],v[252:255],v[72:75]
ds_read_b128 v[248:251],v17 offset:28672
s_waitcnt lgkmcnt(5)
v_mfma_f32_16x16x32_bf16 v[64:67],a[32:35],v[224:227],v[64:67]
s_xor_b32 m0,s91,33792
v_min3_u32 v27,v27,v224,v228
v_mfma_f32_16x16x32_bf16 v[72:75],a[160:163],v[224:227],v[72:75]
ds_read_b128 v[252:255],v17 offset:30720
v_mfma_f32_16x16x32_bf16 v[64:67],a[36:39],v[228:231],v[64:67]
s_add_u32 s65,s95,65536
v_mfma_f32_16x16x32_bf16 v[72:75],a[164:167],v[228:231],v[72:75]
s_waitcnt vmcnt(5)
s_barrier
ds_read_b128 v[224:227],v17 offset:32768
s_waitcnt lgkmcnt(5)
v_mfma_f32_16x16x32_bf16 v[64:67],a[40:43],v[232:235],v[64:67]
buffer_load_dwordx4 v16,s[20:23],s65 offen offset:0 sc1 lds
v_mfma_f32_16x16x32_bf16 v[72:75],a[168:171],v[232:235],v[72:75]
ds_read_b128 v[228:231],v17 offset:34816
v_min3_u32 v27,v27,v232,v236
v_mfma_f32_16x16x32_bf16 v[64:67],a[44:47],v[236:239],v[64:67]
buffer_load_dwordx4 v16,s[20:23],s65 offen offset:2048 sc1 lds
v_mfma_f32_16x16x32_bf16 v[72:75],a[172:175],v[236:239],v[72:75]
ds_read_b128 v[232:235],v17 offset:36864
s_waitcnt lgkmcnt(5)
v_mfma_f32_16x16x32_bf16 v[64:67],a[48:51],v[240:243],v[64:67]
s_xor_b32 m0,s91,50176
v_min3_u32 v27,v27,v240,v244
v_mfma_f32_16x16x32_bf16 v[72:75],a[176:179],v[240:243],v[72:75]
ds_read_b128 v[236:239],v17 offset:38912
v_mfma_f32_16x16x32_bf16 v[64:67],a[52:55],v[244:247],v[64:67]
s_add_u32 s65,s95,98304
v_mfma_f32_16x16x32_bf16 v[72:75],a[180:183],v[244:247],v[72:75]
ds_read_b128 v[240:243],v17 offset:40960
s_waitcnt lgkmcnt(5)
v_mfma_f32_16x16x32_bf16 v[64:67],a[56:59],v[248:251],v[64:67]
buffer_load_dwordx4 v16,s[20:23],s65 offen offset:0 sc1 lds
v_min3_u32 v27,v27,v248,v252
v_mfma_f32_16x16x32_bf16 v[72:75],a[184:187],v[248:251],v[72:75]
ds_read_b128 v[244:247],v17 offset:43008
s_waitcnt vmcnt(63)
v_mfma_f32_16x16x32_bf16 v[64:67],a[60:63],v[252:255],v[64:67]
buffer_load_dwordx4 v16,s[20:23],s65 offen offset:2048 sc1 lds
v_mfma_f32_16x16x32_bf16 v[72:75],a[188:191],v[252:255],v[72:75]
ds_read_b128 v[248:251],v17 offset:45056
s_waitcnt lgkmcnt(5)
v_mfma_f32_16x16x32_bf16 v[64:67],a[64:67],v[224:227],v[64:67]
v_cmp_gt_u32 vcc,s96,v29
v_cmp_gt_u32 s[92:93],s92,v29
v_mfma_f32_16x16x32_bf16 v[72:75],a[192:195],v[224:227],v[72:75]
ds_read_b128 v[252:255],v17 offset:47104
v_min3_u32 v27,v27,v224,v228
v_mfma_f32_16x16x32_bf16 v[64:67],a[68:71],v[228:231],v[64:67]
v_mov_b32 v44,vcc_lo
v_mov_b32 v45,s92
v_mfma_f32_16x16x32_bf16 v[72:75],a[196:199],v[228:231],v[72:75]
ds_read_b128 v[224:227],v17 offset:49152
s_waitcnt lgkmcnt(5)
v_mfma_f32_16x16x32_bf16 v[64:67],a[72:75],v[232:235],v[64:67]
ds_write_b64 v46,v[44:45]
v_min3_u32 v27,v27,v232,v236
v_mfma_f32_16x16x32_bf16 v[72:75],a[200:203],v[232:235],v[72:75]
ds_read_b128 v[228:231],v17 offset:51200
v_mfma_f32_16x16x32_bf16 v[64:67],a[76:79],v[236:239],v[64:67]
v_mfma_f32_16x16x32_bf16 v[72:75],a[204:207],v[236:239],v[72:75]
ds_read_b128 v[232:235],v17 offset:53248
s_waitcnt lgkmcnt(6)
v_mfma_f32_16x16x32_bf16 v[64:67],a[80:83],v[240:243],v[64:67]
v_min3_u32 v27,v27,v240,v244
s_add_u32 s88,s70,s75
v_mfma_f32_16x16x32_bf16 v[72:75],a[208:211],v[240:243],v[72:75]
ds_read_b128 v[236:239],v17 offset:55296
s_add_u32 s88,s88,2097152
v_mfma_f32_16x16x32_bf16 v[64:67],a[84:87],v[244:247],v[64:67]
s_xor_b32 s88,s88,0x2000
s_xor_b32 s89,s88,1024
v_mfma_f32_16x16x32_bf16 v[72:75],a[212:215],v[244:247],v[72:75]
ds_read_b128 v[240:243],v17 offset:57344
s_waitcnt lgkmcnt(6)
v_mfma_f32_16x16x32_bf16 v[64:67],a[88:91],v[248:251],v[64:67]
v_min3_u32 v27,v27,v248,v252
v_mfma_f32_16x16x32_bf16 v[72:75],a[216:219],v[248:251],v[72:75]
ds_read_b128 v[244:247],v17 offset:59392
v_mfma_f32_16x16x32_bf16 v[64:67],a[92:95],v[252:255],v[64:67]
v_mfma_f32_16x16x32_bf16 v[72:75],a[220:223],v[252:255],v[72:75]
ds_read_b128 v[248:251],v17 offset:61440
s_waitcnt lgkmcnt(5)
v_mfma_f32_16x16x32_bf16 v[64:67],a[96:99],v[224:227],v[64:67]
v_min3_u32 v27,v27,v224,v228
v_mfma_f32_16x16x32_bf16 v[72:75],a[224:227],v[224:227],v[72:75]
ds_read_b128 v[252:255],v17 offset:63488
v_mfma_f32_16x16x32_bf16 v[64:67],a[100:103],v[228:231],v[64:67]
v_mfma_f32_16x16x32_bf16 v[72:75],a[228:231],v[228:231],v[72:75]
s_waitcnt vmcnt(4)
s_barrier
ds_read_b64 v[44:45],v47
ds_read_b128 v[224:227],v17 offset:1024
s_waitcnt lgkmcnt(6)
v_mfma_f32_16x16x32_bf16 v[64:67],a[104:107],v[232:235],v[64:67]
v_min3_u32 v27,v27,v232,v236
ds_read_b128 v[124:127],v19 offset:256
v_mfma_f32_16x16x32_bf16 v[72:75],a[232:235],v[232:235],v[72:75]
ds_read_b128 v[228:231],v17 offset:3072
ds_read_b128 v[120:123],v19 offset:0
v_mfma_f32_16x16x32_bf16 v[64:67],a[108:111],v[236:239],v[64:67]
v_mfma_f32_16x16x32_bf16 v[72:75],a[236:239],v[236:239],v[72:75]
ds_read_b128 v[232:235],v17 offset:5120
s_waitcnt lgkmcnt(8)
v_mfma_f32_16x16x32_bf16 v[64:67],a[112:115],v[240:243],v[64:67]
v_min3_u32 v27,v27,v240,v244
v_mfma_f32_16x16x32_bf16 v[72:75],a[240:243],v[240:243],v[72:75]
ds_read_b128 v[236:239],v17 offset:7168
v_mfma_f32_16x16x32_bf16 v[64:67],a[116:119],v[244:247],v[64:67]
v_mfma_f32_16x16x32_bf16 v[72:75],a[244:247],v[244:247],v[72:75]
ds_read_b128 v[240:243],v17 offset:9216
s_waitcnt lgkmcnt(8)
v_mfma_f32_16x16x32_bf16 v[64:67],a[120:123],v[248:251],v[64:67]
s_waitcnt lgkmcnt(7)
v_readfirstlane_b32 s93,v45
v_mfma_f32_16x16x32_bf16 v[72:75],a[248:251],v[248:251],v[72:75]
ds_read_b128 v[244:247],v17 offset:11264
v_readfirstlane_b32 s83,v44
s_cmp_lg_u32 s83,0
s_cbranch_scc0 keep_347
v_mfma_f32_16x16x32_bf16 v[64:67],a[124:127],v[252:255],v[64:67]
v_min3_u32 v27,v27,v248,v252
v_mfma_f32_16x16x32_bf16 v[72:75],a[252:255],v[252:255],v[72:75]
ds_read_b128 v[248:251],v17 offset:13312
s_waitcnt lgkmcnt(6)
v_mfma_f32_16x16x32_bf16 v[68:71],a[0:3],v[224:227],0
v_cmp_eq_u32 vcc,0,v27
s_cbranch_vccnz retry_339
v_mfma_f32_16x16x32_bf16 v[76:79],a[128:131],v[224:227],0
ds_read_b128 v[252:255],v17 offset:15360
v_min3_u32 v27,v27,v224,v228
v_mfma_f32_16x16x32_bf16 v[68:71],a[4:7],v[228:231],v[68:71]
s_waitcnt lgkmcnt(6)
v_mfma_f32_16x16x32_bf16 v[76:79],a[132:135],v[228:231],v[76:79]
ds_read_b128 v[224:227],v17 offset:17408
s_waitcnt lgkmcnt(5)
v_mfma_f32_16x16x32_bf16 v[68:71],a[8:11],v[232:235],v[68:71]
v_min3_u32 v27,v27,v232,v236
v_fmac_f32 v64,v52,v120
v_fmac_f32 v72,v56,v120
v_mfma_f32_16x16x32_bf16 v[76:79],a[136:139],v[232:235],v[76:79]
ds_read_b128 v[228:231],v17 offset:19456
v_fmac_f32 v65,v53,v120
v_fmac_f32 v73,v57,v120
v_mfma_f32_16x16x32_bf16 v[68:71],a[12:15],v[236:239],v[68:71]
v_fmac_f32 v66,v54,v120
v_fmac_f32 v67,v55,v120
v_fmac_f32 v74,v58,v120
v_mfma_f32_16x16x32_bf16 v[76:79],a[140:143],v[236:239],v[76:79]
ds_read_b128 v[232:235],v17 offset:21504
v_fmac_f32 v75,v59,v120
s_waitcnt lgkmcnt(5)
v_mfma_f32_16x16x32_bf16 v[68:71],a[16:19],v[240:243],v[68:71]
v_min3_u32 v27,v27,v240,v244
v_mul_f32 v88,v64,v64
v_mul_f32 v92,v72,v72
v_mfma_f32_16x16x32_bf16 v[76:79],a[144:147],v[240:243],v[76:79]
ds_read_b128 v[236:239],v17 offset:23552
v_mul_f32 v89,v65,v65
v_mul_f32 v93,v73,v73
v_mfma_f32_16x16x32_bf16 v[68:71],a[20:23],v[244:247],v[68:71]
v_mul_f32 v90,v66,v66
v_mul_f32 v91,v67,v67
v_mul_f32 v94,v74,v74
v_mfma_f32_16x16x32_bf16 v[76:79],a[148:151],v[244:247],v[76:79]
ds_read_b128 v[240:243],v17 offset:25600
v_mul_f32 v95,v75,v75
s_waitcnt lgkmcnt(5)
v_mfma_f32_16x16x32_bf16 v[68:71],a[24:27],v[248:251],v[68:71]
v_min3_u32 v27,v27,v248,v252
v_fma_f32 v88,v88,v121,v122
v_fma_f32 v92,v92,v121,v122
v_mfma_f32_16x16x32_bf16 v[76:79],a[152:155],v[248:251],v[76:79]
ds_read_b128 v[244:247],v17 offset:27648
v_fma_f32 v89,v89,v121,v122
v_fma_f32 v93,v93,v121,v122
v_mfma_f32_16x16x32_bf16 v[68:71],a[28:31],v[252:255],v[68:71]
v_fma_f32 v90,v90,v121,v122
v_fma_f32 v91,v91,v121,v122
v_fma_f32 v94,v94,v121,v122
v_mfma_f32_16x16x32_bf16 v[76:79],a[156:159],v[252:255],v[76:79]
ds_read_b128 v[248:251],v17 offset:29696
v_fma_f32 v95,v95,v121,v122
s_waitcnt lgkmcnt(5)
v_mfma_f32_16x16x32_bf16 v[68:71],a[32:35],v[224:227],v[68:71]
v_min3_u32 v27,v27,v224,v228
v_mul_f32 v88,v88,v64
v_mul_f32 v92,v92,v72
v_mfma_f32_16x16x32_bf16 v[76:79],a[160:163],v[224:227],v[76:79]
ds_read_b128 v[252:255],v17 offset:31744
v_mul_f32 v89,v89,v65
v_mul_f32 v93,v93,v73
v_mfma_f32_16x16x32_bf16 v[68:71],a[36:39],v[228:231],v[68:71]
v_mul_f32 v90,v90,v66
v_mul_f32 v91,v91,v67
v_mul_f32 v94,v94,v74
v_mfma_f32_16x16x32_bf16 v[76:79],a[164:167],v[228:231],v[76:79]
s_waitcnt vmcnt(0)
s_barrier
ds_read_b128 v[224:227],v17 offset:33792
s_waitcnt lgkmcnt(5)
v_mfma_f32_16x16x32_bf16 v[68:71],a[40:43],v[232:235],v[68:71]
v_min3_u32 v27,v27,v232,v236
v_mul_f32 v95,v95,v75
v_mfma_f32_16x16x32_bf16 v[76:79],a[168:171],v[232:235],v[76:79]
ds_read_b128 v[228:231],v17 offset:35840
v_exp_f32 v92,v92
v_mfma_f32_16x16x32_bf16 v[68:71],a[44:47],v[236:239],v[68:71]
v_exp_f32 v88,v88
v_mfma_f32_16x16x32_bf16 v[76:79],a[172:175],v[236:239],v[76:79]
ds_read_b128 v[232:235],v17 offset:37888
s_waitcnt lgkmcnt(5)
v_mfma_f32_16x16x32_bf16 v[68:71],a[48:51],v[240:243],v[68:71]
v_min3_u32 v27,v27,v240,v244
v_exp_f32 v93,v93
v_mfma_f32_16x16x32_bf16 v[76:79],a[176:179],v[240:243],v[76:79]
ds_read_b128 v[236:239],v17 offset:39936
v_exp_f32 v94,v94
v_mfma_f32_16x16x32_bf16 v[68:71],a[52:55],v[244:247],v[68:71]
v_exp_f32 v89,v89
v_mfma_f32_16x16x32_bf16 v[76:79],a[180:183],v[244:247],v[76:79]
ds_read_b128 v[240:243],v17 offset:41984
s_waitcnt lgkmcnt(5)
v_mfma_f32_16x16x32_bf16 v[68:71],a[56:59],v[248:251],v[68:71]
v_min3_u32 v27,v27,v248,v252
v_exp_f32 v95,v95
v_mfma_f32_16x16x32_bf16 v[76:79],a[184:187],v[248:251],v[76:79]
ds_read_b128 v[244:247],v17 offset:44032
v_fma_f32 v92,v92,v123,v123
v_fma_f32 v93,v93,v123,v123
v_mfma_f32_16x16x32_bf16 v[68:71],a[60:63],v[252:255],v[68:71]
v_exp_f32 v90,v90
v_fma_f32 v94,v94,v123,v123
v_mfma_f32_16x16x32_bf16 v[76:79],a[188:191],v[252:255],v[76:79]
ds_read_b128 v[248:251],v17 offset:46080
v_fma_f32 v95,v95,v123,v123
s_waitcnt lgkmcnt(5)
v_mfma_f32_16x16x32_bf16 v[68:71],a[64:67],v[224:227],v[68:71]
v_min3_u32 v27,v27,v224,v228
v_rcp_f32 v92,v92
v_mfma_f32_16x16x32_bf16 v[76:79],a[192:195],v[224:227],v[76:79]
ds_read_b128 v[252:255],v17 offset:48128
v_rcp_f32 v93,v93
v_mfma_f32_16x16x32_bf16 v[68:71],a[68:71],v[228:231],v[68:71]
v_exp_f32 v91,v91
v_mfma_f32_16x16x32_bf16 v[76:79],a[196:199],v[228:231],v[76:79]
ds_read_b128 v[224:227],v17 offset:50176
s_waitcnt lgkmcnt(5)
v_mfma_f32_16x16x32_bf16 v[68:71],a[72:75],v[232:235],v[68:71]
v_min3_u32 v27,v27,v232,v236
v_fma_f32 v88,v88,v123,v123
v_mfma_f32_16x16x32_bf16 v[76:79],a[200:203],v[232:235],v[76:79]
ds_read_b128 v[228:231],v17 offset:52224
v_fma_f32 v89,v89,v123,v123
v_mfma_f32_16x16x32_bf16 v[68:71],a[76:79],v[236:239],v[68:71]
v_fma_f32 v90,v90,v123,v123
v_fma_f32 v91,v91,v123,v123
v_mfma_f32_16x16x32_bf16 v[76:79],a[204:207],v[236:239],v[76:79]
ds_read_b128 v[232:235],v17 offset:54272
s_waitcnt lgkmcnt(5)
v_mfma_f32_16x16x32_bf16 v[68:71],a[80:83],v[240:243],v[68:71]
v_min3_u32 v27,v27,v240,v244
v_rcp_f32 v94,v94
v_mfma_f32_16x16x32_bf16 v[76:79],a[208:211],v[240:243],v[76:79]
ds_read_b128 v[236:239],v17 offset:56320
v_rcp_f32 v95,v95
v_mfma_f32_16x16x32_bf16 v[68:71],a[84:87],v[244:247],v[68:71]
v_rcp_f32 v88,v88
v_mfma_f32_16x16x32_bf16 v[76:79],a[212:215],v[244:247],v[76:79]
ds_read_b128 v[240:243],v17 offset:58368
s_waitcnt lgkmcnt(5)
v_mfma_f32_16x16x32_bf16 v[68:71],a[88:91],v[248:251],v[68:71]
v_min3_u32 v27,v27,v248,v252
v_mul_f32 v92,v92,v72
v_mfma_f32_16x16x32_bf16 v[76:79],a[216:219],v[248:251],v[76:79]
ds_read_b128 v[244:247],v17 offset:60416
v_mul_f32 v93,v93,v73
v_mfma_f32_16x16x32_bf16 v[68:71],a[92:95],v[252:255],v[68:71]
v_rcp_f32 v89,v89
v_mfma_f32_16x16x32_bf16 v[76:79],a[220:223],v[252:255],v[76:79]
ds_read_b128 v[248:251],v17 offset:62464
s_waitcnt lgkmcnt(5)
v_mfma_f32_16x16x32_bf16 v[68:71],a[96:99],v[224:227],v[68:71]
v_min3_u32 v27,v27,v224,v228
v_mul_f32 v94,v94,v74
v_mfma_f32_16x16x32_bf16 v[76:79],a[224:227],v[224:227],v[76:79]
ds_read_b128 v[252:255],v17 offset:64512
v_mul_f32 v95,v95,v75
v_mfma_f32_16x16x32_bf16 v[68:71],a[100:103],v[228:231],v[68:71]
v_rcp_f32 v90,v90
v_mfma_f32_16x16x32_bf16 v[76:79],a[228:231],v[228:231],v[76:79]
s_waitcnt lgkmcnt(4)
v_mfma_f32_16x16x32_bf16 v[68:71],a[104:107],v[232:235],v[68:71]
v_min3_u32 v27,v27,v232,v236
v_mfma_f32_16x16x32_bf16 v[76:79],a[232:235],v[232:235],v[76:79]
v_rcp_f32 v91,v91
v_mfma_f32_16x16x32_bf16 v[68:71],a[108:111],v[236:239],v[68:71]
v_mul_f32 v88,v88,v64
v_mul_f32 v89,v89,v65
v_mfma_f32_16x16x32_bf16 v[76:79],a[236:239],v[236:239],v[76:79]
v_mul_f32 v90,v90,v66
s_waitcnt lgkmcnt(2)
v_mfma_f32_16x16x32_bf16 v[68:71],a[112:115],v[240:243],v[68:71]
v_min3_u32 v27,v27,v240,v244
v_mul_f32 v91,v91,v67
v_mfma_f32_16x16x32_bf16 v[76:79],a[240:243],v[240:243],v[76:79]
v_cvt_pk_bf16_f32 v96,v88,v89
v_cvt_pk_bf16_f32 v97,v90,v91
v_mfma_f32_16x16x32_bf16 v[68:71],a[116:119],v[244:247],v[68:71]
v_cvt_pk_bf16_f32 v98,v92,v93
v_cvt_pk_bf16_f32 v99,v94,v95
v_mfma_f32_16x16x32_bf16 v[76:79],a[244:247],v[244:247],v[76:79]
v_max_u32 v96,1,v96
s_waitcnt lgkmcnt(0)
v_mfma_f32_16x16x32_bf16 v[68:71],a[120:123],v[248:251],v[68:71]
v_min3_u32 v27,v27,v248,v252
v_mfma_f32_16x16x32_bf16 v[76:79],a[248:251],v[248:251],v[76:79]
buffer_store_dwordx4 v[96:99],v18,s[20:23],s70 offen offset:0 sc1
v_mfma_f32_16x16x32_bf16 v[68:71],a[124:127],v[252:255],v[68:71]
v_mfma_f32_16x16x32_bf16 v[76:79],a[252:255],v[252:255],v[76:79]
v_cmp_eq_u32 vcc,0,v27
s_cbranch_vccnz retry_339
s_branch epi_342
keep_347:
v_mfma_f32_16x16x32_bf16 v[64:67],a[124:127],v[252:255],v[64:67]
v_min3_u32 v27,v27,v248,v252
s_xor_b32 m0,s72,0
v_mfma_f32_16x16x32_bf16 v[72:75],a[252:255],v[252:255],v[72:75]
ds_read_b128 v[248:251],v17 offset:13312
s_waitcnt lgkmcnt(6)
v_mfma_f32_16x16x32_bf16 v[68:71],a[0:3],v[224:227],0
s_add_u32 s65,s88,0
v_cmp_eq_u32 vcc,0,v27
s_cbranch_vccnz retry_339
v_mfma_f32_16x16x32_bf16 v[76:79],a[128:131],v[224:227],0
ds_read_b128 v[252:255],v17 offset:15360
v_min3_u32 v27,v27,v224,v228
s_waitcnt lgkmcnt(6)
v_mfma_f32_16x16x32_bf16 v[68:71],a[4:7],v[228:231],v[68:71]
buffer_load_dwordx4 v16,s[20:23],s65 offen offset:0 sc1 lds
v_mfma_f32_16x16x32_bf16 v[76:79],a[132:135],v[228:231],v[76:79]
ds_read_b128 v[224:227],v17 offset:17408
s_waitcnt lgkmcnt(5)
v_mfma_f32_16x16x32_bf16 v[68:71],a[8:11],v[232:235],v[68:71]
buffer_load_dwordx4 v16,s[20:23],s65 offen offset:2048 sc1 lds
v_fmac_f32 v64,v52,v120
v_fmac_f32 v65,v53,v120
v_mfma_f32_16x16x32_bf16 v[76:79],a[136:139],v[232:235],v[76:79]
ds_read_b128 v[228:231],v17 offset:19456
s_xor_b32 m0,s72,16384
v_fmac_f32 v66,v54,v120
v_fmac_f32 v67,v55,v120
v_mfma_f32_16x16x32_bf16 v[68:71],a[12:15],v[236:239],v[68:71]
s_add_u32 s65,s88,32768
v_min3_u32 v27,v27,v232,v236
v_mul_f32 v88,v64,v64
v_mul_f32 v89,v65,v65
v_mfma_f32_16x16x32_bf16 v[76:79],a[140:143],v[236:239],v[76:79]
ds_read_b128 v[232:235],v17 offset:21504
v_mul_f32 v90,v66,v66
v_mul_f32 v91,v67,v67
s_waitcnt lgkmcnt(5)
v_mfma_f32_16x16x32_bf16 v[68:71],a[16:19],v[240:243],v[68:71]
buffer_load_dwordx4 v16,s[20:23],s65 offen offset:0 sc1 lds
v_fma_f32 v88,v88,v121,v122
v_fma_f32 v89,v89,v121,v122
v_mfma_f32_16x16x32_bf16 v[76:79],a[144:147],v[240:243],v[76:79]
ds_read_b128 v[236:239],v17 offset:23552
v_min3_u32 v27,v27,v240,v244
v_fma_f32 v90,v90,v121,v122
v_fma_f32 v91,v91,v121,v122
v_mfma_f32_16x16x32_bf16 v[68:71],a[20:23],v[244:247],v[68:71]
buffer_load_dwordx4 v16,s[20:23],s65 offen offset:2048 sc1 lds
v_mul_f32 v88,v88,v64
v_mul_f32 v89,v89,v65
v_mfma_f32_16x16x32_bf16 v[76:79],a[148:151],v[244:247],v[76:79]
ds_read_b128 v[240:243],v17 offset:25600
v_mul_f32 v90,v90,v66
v_mul_f32 v91,v91,v67
s_waitcnt lgkmcnt(5)
v_mfma_f32_16x16x32_bf16 v[68:71],a[24:27],v[248:251],v[68:71]
s_xor_b32 m0,s72,32768
s_add_u32 s65,s88,65536
v_exp_f32 v88,v88
v_mfma_f32_16x16x32_bf16 v[76:79],a[152:155],v[248:251],v[76:79]
ds_read_b128 v[244:247],v17 offset:27648
v_min3_u32 v27,v27,v248,v252
v_exp_f32 v89,v89
v_mfma_f32_16x16x32_bf16 v[68:71],a[28:31],v[252:255],v[68:71]
buffer_load_dwordx4 v16,s[20:23],s65 offen offset:0 sc1 lds
v_exp_f32 v90,v90
v_mfma_f32_16x16x32_bf16 v[76:79],a[156:159],v[252:255],v[76:79]
ds_read_b128 v[248:251],v17 offset:29696
v_exp_f32 v91,v91
s_waitcnt lgkmcnt(5)
v_mfma_f32_16x16x32_bf16 v[68:71],a[32:35],v[224:227],v[68:71]
buffer_load_dwordx4 v16,s[20:23],s65 offen offset:2048 sc1 lds
v_fma_f32 v88,v88,v123,v123
v_fma_f32 v89,v89,v123,v123
v_mfma_f32_16x16x32_bf16 v[76:79],a[160:163],v[224:227],v[76:79]
ds_read_b128 v[252:255],v17 offset:31744
s_xor_b32 m0,s72,49152
v_fma_f32 v90,v90,v123,v123
v_fma_f32 v91,v91,v123,v123
v_mfma_f32_16x16x32_bf16 v[68:71],a[36:39],v[228:231],v[68:71]
v_min3_u32 v27,v27,v224,v228
v_rcp_f32 v88,v88
v_fmac_f32 v72,v56,v120
v_mfma_f32_16x16x32_bf16 v[76:79],a[164:167],v[228:231],v[76:79]
s_waitcnt vmcnt(6)
s_barrier
ds_read_b128 v[224:227],v17 offset:33792
s_waitcnt lgkmcnt(5)
v_mfma_f32_16x16x32_bf16 v[68:71],a[40:43],v[232:235],v[68:71]
s_add_u32 s65,s88,98304
v_min3_u32 v27,v27,v232,v236
v_fmac_f32 v73,v57,v120
v_fmac_f32 v74,v58,v120
v_mfma_f32_16x16x32_bf16 v[76:79],a[168:171],v[232:235],v[76:79]
ds_read_b128 v[228:231],v17 offset:35840
v_fmac_f32 v75,v59,v120
v_mul_f32 v92,v72,v72
v_mul_f32 v93,v73,v73
v_mfma_f32_16x16x32_bf16 v[68:71],a[44:47],v[236:239],v[68:71]
buffer_load_dwordx4 v16,s[20:23],s65 offen offset:0 sc1 lds
v_mul_f32 v94,v74,v74
v_mul_f32 v95,v75,v75
v_mfma_f32_16x16x32_bf16 v[76:79],a[172:175],v[236:239],v[76:79]
ds_read_b128 v[232:235],v17 offset:37888
v_fma_f32 v92,v92,v121,v122
v_fma_f32 v93,v93,v121,v122
s_waitcnt lgkmcnt(5)
v_mfma_f32_16x16x32_bf16 v[68:71],a[48:51],v[240:243],v[68:71]
buffer_load_dwordx4 v16,s[20:23],s65 offen offset:2048 sc1 lds
v_fma_f32 v94,v94,v121,v122
v_fma_f32 v95,v95,v121,v122
v_mfma_f32_16x16x32_bf16 v[76:79],a[176:179],v[240:243],v[76:79]
ds_read_b128 v[236:239],v17 offset:39936
s_xor_b32 m0,s72,1024
v_mul_f32 v92,v92,v72
v_mul_f32 v93,v93,v73
v_mfma_f32_16x16x32_bf16 v[68:71],a[52:55],v[244:247],v[68:71]
s_add_u32 s65,s89,0
v_min3_u32 v27,v27,v240,v244
v_mul_f32 v94,v94,v74
v_mul_f32 v95,v95,v75
v_mfma_f32_16x16x32_bf16 v[76:79],a[180:183],v[244:247],v[76:79]
ds_read_b128 v[240:243],v17 offset:41984
v_exp_f32 v92,v92
s_waitcnt lgkmcnt(5)
v_mfma_f32_16x16x32_bf16 v[68:71],a[56:59],v[248:251],v[68:71]
buffer_load_dwordx4 v16,s[20:23],s65 offen offset:0 sc1 lds
v_exp_f32 v93,v93
v_mfma_f32_16x16x32_bf16 v[76:79],a[184:187],v[248:251],v[76:79]
ds_read_b128 v[244:247],v17 offset:44032
v_min3_u32 v27,v27,v248,v252
v_exp_f32 v94,v94
v_mfma_f32_16x16x32_bf16 v[68:71],a[60:63],v[252:255],v[68:71]
buffer_load_dwordx4 v16,s[20:23],s65 offen offset:2048 sc1 lds
v_exp_f32 v95,v95
v_mfma_f32_16x16x32_bf16 v[76:79],a[188:191],v[252:255],v[76:79]
ds_read_b128 v[248:251],v17 offset:46080
v_fma_f32 v92,v92,v123,v123
v_fma_f32 v93,v93,v123,v123
s_waitcnt lgkmcnt(5)
v_mfma_f32_16x16x32_bf16 v[68:71],a[64:67],v[224:227],v[68:71]
s_xor_b32 m0,s72,17408
s_add_u32 s65,s89,32768
v_fma_f32 v94,v94,v123,v123
v_fma_f32 v95,v95,v123,v123
v_mfma_f32_16x16x32_bf16 v[76:79],a[192:195],v[224:227],v[76:79]
ds_read_b128 v[252:255],v17 offset:48128
v_min3_u32 v27,v27,v224,v228
v_rcp_f32 v92,v92
v_mfma_f32_16x16x32_bf16 v[68:71],a[68:71],v[228:231],v[68:71]
buffer_load_dwordx4 v16,s[20:23],s65 offen offset:0 sc1 lds
v_rcp_f32 v93,v93
v_mfma_f32_16x16x32_bf16 v[76:79],a[196:199],v[228:231],v[76:79]
ds_read_b128 v[224:227],v17 offset:50176
v_rcp_f32 v94,v94
s_waitcnt lgkmcnt(5)
v_mfma_f32_16x16x32_bf16 v[68:71],a[72:75],v[232:235],v[68:71]
buffer_load_dwordx4 v16,s[20:23],s65 offen offset:2048 sc1 lds
v_rcp_f32 v95,v95
v_mfma_f32_16x16x32_bf16 v[76:79],a[200:203],v[232:235],v[76:79]
ds_read_b128 v[228:231],v17 offset:52224
s_xor_b32 m0,s72,33792
v_mfma_f32_16x16x32_bf16 v[68:71],a[76:79],v[236:239],v[68:71]
s_add_u32 s65,s89,65536
v_min3_u32 v27,v27,v232,v236
v_mfma_f32_16x16x32_bf16 v[76:79],a[204:207],v[236:239],v[76:79]
ds_read_b128 v[232:235],v17 offset:54272
s_waitcnt lgkmcnt(5)
v_mfma_f32_16x16x32_bf16 v[68:71],a[80:83],v[240:243],v[68:71]
buffer_load_dwordx4 v16,s[20:23],s65 offen offset:0 sc1 lds
v_mfma_f32_16x16x32_bf16 v[76:79],a[208:211],v[240:243],v[76:79]
ds_read_b128 v[236:239],v17 offset:56320
v_min3_u32 v27,v27,v240,v244
v_mfma_f32_16x16x32_bf16 v[68:71],a[84:87],v[244:247],v[68:71]
buffer_load_dwordx4 v16,s[20:23],s65 offen offset:2048 sc1 lds
v_mfma_f32_16x16x32_bf16 v[76:79],a[212:215],v[244:247],v[76:79]
ds_read_b128 v[240:243],v17 offset:58368
s_waitcnt lgkmcnt(5)
v_mfma_f32_16x16x32_bf16 v[68:71],a[88:91],v[248:251],v[68:71]
s_xor_b32 m0,s72,50176
v_min3_u32 v27,v27,v248,v252
v_mfma_f32_16x16x32_bf16 v[76:79],a[216:219],v[248:251],v[76:79]
ds_read_b128 v[244:247],v17 offset:60416
s_add_u32 s65,s89,98304
v_mfma_f32_16x16x32_bf16 v[68:71],a[92:95],v[252:255],v[68:71]
buffer_load_dwordx4 v16,s[20:23],s65 offen offset:0 sc1 lds
v_mfma_f32_16x16x32_bf16 v[76:79],a[220:223],v[252:255],v[76:79]
ds_read_b128 v[248:251],v17 offset:62464
s_waitcnt lgkmcnt(5)
v_mfma_f32_16x16x32_bf16 v[68:71],a[96:99],v[224:227],v[68:71]
buffer_load_dwordx4 v16,s[20:23],s65 offen offset:2048 sc1 lds
v_mfma_f32_16x16x32_bf16 v[76:79],a[224:227],v[224:227],v[76:79]
ds_read_b128 v[252:255],v17 offset:64512
v_min3_u32 v27,v27,v224,v228
v_mfma_f32_16x16x32_bf16 v[68:71],a[100:103],v[228:231],v[68:71]
v_rcp_f32 v89,v89
v_mfma_f32_16x16x32_bf16 v[76:79],a[228:231],v[228:231],v[76:79]
v_mul_f32 v92,v92,v72
s_waitcnt lgkmcnt(4)
v_mfma_f32_16x16x32_bf16 v[68:71],a[104:107],v[232:235],v[68:71]
v_min3_u32 v27,v27,v232,v236
v_mul_f32 v93,v93,v73
v_mfma_f32_16x16x32_bf16 v[76:79],a[232:235],v[232:235],v[76:79]
v_rcp_f32 v90,v90
v_mfma_f32_16x16x32_bf16 v[68:71],a[108:111],v[236:239],v[68:71]
v_rcp_f32 v91,v91
v_mfma_f32_16x16x32_bf16 v[76:79],a[236:239],v[236:239],v[76:79]
v_mul_f32 v88,v88,v64
s_waitcnt lgkmcnt(2)
v_mfma_f32_16x16x32_bf16 v[68:71],a[112:115],v[240:243],v[68:71]
v_min3_u32 v27,v27,v240,v244
v_mul_f32 v89,v89,v65
v_mfma_f32_16x16x32_bf16 v[76:79],a[240:243],v[240:243],v[76:79]
v_mul_f32 v90,v90,v66
v_mul_f32 v91,v91,v67
v_mfma_f32_16x16x32_bf16 v[68:71],a[116:119],v[244:247],v[68:71]
v_mul_f32 v94,v94,v74
v_mul_f32 v95,v95,v75
v_mfma_f32_16x16x32_bf16 v[76:79],a[244:247],v[244:247],v[76:79]
v_cvt_pk_bf16_f32 v96,v88,v89
s_waitcnt lgkmcnt(0)
v_mfma_f32_16x16x32_bf16 v[68:71],a[120:123],v[248:251],v[68:71]
v_min3_u32 v27,v27,v248,v252
v_cvt_pk_bf16_f32 v97,v90,v91
v_mfma_f32_16x16x32_bf16 v[76:79],a[248:251],v[248:251],v[76:79]
v_cvt_pk_bf16_f32 v98,v92,v93
v_cvt_pk_bf16_f32 v99,v94,v95
v_mfma_f32_16x16x32_bf16 v[68:71],a[124:127],v[252:255],v[68:71]
v_max_u32 v96,1,v96
v_mfma_f32_16x16x32_bf16 v[76:79],a[252:255],v[252:255],v[76:79]
buffer_store_dwordx4 v[96:99],v18,s[20:23],s70 offen offset:0 sc1
v_cmp_eq_u32 vcc,0,v27
s_cbranch_vccnz retry_339
s_branch epi_342
ahead_341:
s_cmp_eq_u32 s93,0
s_cbranch_scc1 both_343
s_waitcnt vmcnt(12) lgkmcnt(0)
s_barrier
ds_read_b128 v[224:227],v17 offset:0
ds_read_b128 v[228:231],v17 offset:2048
ds_read_b128 v[232:235],v17 offset:4096
ds_read_b128 v[236:239],v17 offset:6144
ds_read_b128 v[240:243],v17 offset:8192
ds_read_b128 v[244:247],v17 offset:10240
ds_read_b128 v[248:251],v17 offset:12288
s_waitcnt lgkmcnt(5)
v_mfma_f32_16x16x32_bf16 v[64:67],a[0:3],v[224:227],0
s_add_u32 s96,s71,1
s_add_u32 s92,s71,2
v_mfma_f32_16x16x32_bf16 v[72:75],a[128:131],v[224:227],0
ds_read_b128 v[252:255],v17 offset:14336
v_min_u32 v27,v224,v228
v_mfma_f32_16x16x32_bf16 v[64:67],a[4:7],v[228:231],v[64:67]
v_mfma_f32_16x16x32_bf16 v[72:75],a[132:135],v[228:231],v[72:75]
ds_read_b128 v[224:227],v17 offset:16384
s_waitcnt lgkmcnt(5)
v_mfma_f32_16x16x32_bf16 v[64:67],a[8:11],v[232:235],v[64:67]
v_min3_u32 v27,v27,v232,v236
v_mfma_f32_16x16x32_bf16 v[72:75],a[136:139],v[232:235],v[72:75]
ds_read_b128 v[228:231],v17 offset:18432
v_mfma_f32_16x16x32_bf16 v[64:67],a[12:15],v[236:239],v[64:67]
v_mfma_f32_16x16x32_bf16 v[72:75],a[140:143],v[236:239],v[72:75]
ds_read_b128 v[232:235],v17 offset:20480
s_waitcnt lgkmcnt(5)
v_mfma_f32_16x16x32_bf16 v[64:67],a[16:19],v[240:243],v[64:67]
v_min3_u32 v27,v27,v240,v244
v_mfma_f32_16x16x32_bf16 v[72:75],a[144:147],v[240:243],v[72:75]
ds_read_b128 v[236:239],v17 offset:22528
v_mfma_f32_16x16x32_bf16 v[64:67],a[20:23],v[244:247],v[64:67]
v_mfma_f32_16x16x32_bf16 v[72:75],a[148:151],v[244:247],v[72:75]
ds_read_b128 v[240:243],v17 offset:24576
s_waitcnt lgkmcnt(5)
v_mfma_f32_16x16x32_bf16 v[64:67],a[24:27],v[248:251],v[64:67]
v_min3_u32 v27,v27,v248,v252
v_mfma_f32_16x16x32_bf16 v[72:75],a[152:155],v[248:251],v[72:75]
ds_read_b128 v[244:247],v17 offset:26624
v_mfma_f32_16x16x32_bf16 v[64:67],a[28:31],v[252:255],v[64:67]
v_mfma_f32_16x16x32_bf16 v[72:75],a[156:159],v[252:255],v[72:75]
ds_read_b128 v[248:251],v17 offset:28672
s_waitcnt lgkmcnt(5)
v_mfma_f32_16x16x32_bf16 v[64:67],a[32:35],v[224:227],v[64:67]
v_min3_u32 v27,v27,v224,v228
v_mfma_f32_16x16x32_bf16 v[72:75],a[160:163],v[224:227],v[72:75]
ds_read_b128 v[252:255],v17 offset:30720
v_mfma_f32_16x16x32_bf16 v[64:67],a[36:39],v[228:231],v[64:67]
v_mfma_f32_16x16x32_bf16 v[72:75],a[164:167],v[228:231],v[72:75]
ds_read_b128 v[224:227],v17 offset:32768
s_waitcnt lgkmcnt(5)
v_mfma_f32_16x16x32_bf16 v[64:67],a[40:43],v[232:235],v[64:67]
v_min3_u32 v27,v27,v232,v236
v_mfma_f32_16x16x32_bf16 v[72:75],a[168:171],v[232:235],v[72:75]
ds_read_b128 v[228:231],v17 offset:34816
v_mfma_f32_16x16x32_bf16 v[64:67],a[44:47],v[236:239],v[64:67]
v_mfma_f32_16x16x32_bf16 v[72:75],a[172:175],v[236:239],v[72:75]
ds_read_b128 v[232:235],v17 offset:36864
s_waitcnt lgkmcnt(5)
v_mfma_f32_16x16x32_bf16 v[64:67],a[48:51],v[240:243],v[64:67]
v_min3_u32 v27,v27,v240,v244
v_mfma_f32_16x16x32_bf16 v[72:75],a[176:179],v[240:243],v[72:75]
ds_read_b128 v[236:239],v17 offset:38912
v_mfma_f32_16x16x32_bf16 v[64:67],a[52:55],v[244:247],v[64:67]
v_mfma_f32_16x16x32_bf16 v[72:75],a[180:183],v[244:247],v[72:75]
ds_read_b128 v[240:243],v17 offset:40960
s_waitcnt lgkmcnt(5)
v_mfma_f32_16x16x32_bf16 v[64:67],a[56:59],v[248:251],v[64:67]
v_min3_u32 v27,v27,v248,v252
v_mfma_f32_16x16x32_bf16 v[72:75],a[184:187],v[248:251],v[72:75]
ds_read_b128 v[244:247],v17 offset:43008
s_waitcnt vmcnt(2)
v_mfma_f32_16x16x32_bf16 v[64:67],a[60:63],v[252:255],v[64:67]
v_cmp_gt_u32 vcc,s96,v29
v_cmp_gt_u32 s[92:93],s92,v29
v_mfma_f32_16x16x32_bf16 v[72:75],a[188:191],v[252:255],v[72:75]
ds_read_b128 v[248:251],v17 offset:45056
s_waitcnt lgkmcnt(5)
v_mfma_f32_16x16x32_bf16 v[64:67],a[64:67],v[224:227],v[64:67]
v_mov_b32 v44,vcc_lo
v_mov_b32 v45,s92
v_mfma_f32_16x16x32_bf16 v[72:75],a[192:195],v[224:227],v[72:75]
ds_read_b128 v[252:255],v17 offset:47104
ds_write_b64 v46,v[44:45]
v_mfma_f32_16x16x32_bf16 v[64:67],a[68:71],v[228:231],v[64:67]
v_min3_u32 v27,v27,v224,v228
v_mfma_f32_16x16x32_bf16 v[72:75],a[196:199],v[228:231],v[72:75]
ds_read_b128 v[224:227],v17 offset:49152
s_waitcnt lgkmcnt(6)
v_mfma_f32_16x16x32_bf16 v[64:67],a[72:75],v[232:235],v[64:67]
v_min3_u32 v27,v27,v232,v236
v_mfma_f32_16x16x32_bf16 v[72:75],a[200:203],v[232:235],v[72:75]
ds_read_b128 v[228:231],v17 offset:51200
v_mfma_f32_16x16x32_bf16 v[64:67],a[76:79],v[236:239],v[64:67]
v_mfma_f32_16x16x32_bf16 v[72:75],a[204:207],v[236:239],v[72:75]
ds_read_b128 v[232:235],v17 offset:53248
s_waitcnt lgkmcnt(6)
v_mfma_f32_16x16x32_bf16 v[64:67],a[80:83],v[240:243],v[64:67]
v_min3_u32 v27,v27,v240,v244
s_add_u32 s88,s70,s75
v_mfma_f32_16x16x32_bf16 v[72:75],a[208:211],v[240:243],v[72:75]
ds_read_b128 v[236:239],v17 offset:55296
s_add_u32 s88,s88,2097152
v_mfma_f32_16x16x32_bf16 v[64:67],a[84:87],v[244:247],v[64:67]
s_xor_b32 s88,s88,0x2000
s_xor_b32 s89,s88,1024
v_mfma_f32_16x16x32_bf16 v[72:75],a[212:215],v[244:247],v[72:75]
ds_read_b128 v[240:243],v17 offset:57344
s_waitcnt lgkmcnt(6)
v_mfma_f32_16x16x32_bf16 v[64:67],a[88:91],v[248:251],v[64:67]
v_min3_u32 v27,v27,v248,v252
v_mfma_f32_16x16x32_bf16 v[72:75],a[216:219],v[248:251],v[72:75]
ds_read_b128 v[244:247],v17 offset:59392
v_mfma_f32_16x16x32_bf16 v[64:67],a[92:95],v[252:255],v[64:67]
v_mfma_f32_16x16x32_bf16 v[72:75],a[220:223],v[252:255],v[72:75]
ds_read_b128 v[248:251],v17 offset:61440
s_waitcnt lgkmcnt(5)
v_mfma_f32_16x16x32_bf16 v[64:67],a[96:99],v[224:227],v[64:67]
v_min3_u32 v27,v27,v224,v228
v_mfma_f32_16x16x32_bf16 v[72:75],a[224:227],v[224:227],v[72:75]
ds_read_b128 v[252:255],v17 offset:63488
v_mfma_f32_16x16x32_bf16 v[64:67],a[100:103],v[228:231],v[64:67]
s_waitcnt vmcnt(0)
v_add_u32 v22,s71,-1
v_mfma_f32_16x16x32_bf16 v[72:75],a[228:231],v[228:231],v[72:75]
s_waitcnt vmcnt(4)
s_barrier
ds_read_b64 v[44:45],v47
ds_read_b128 v[224:227],v17 offset:1024
s_waitcnt lgkmcnt(6)
v_mfma_f32_16x16x32_bf16 v[64:67],a[104:107],v[232:235],v[64:67]
v_min3_u32 v27,v27,v232,v236
ds_read_b128 v[124:127],v19 offset:256
v_mfma_f32_16x16x32_bf16 v[72:75],a[232:235],v[232:235],v[72:75]
ds_read_b128 v[228:231],v17 offset:3072
ds_read_b128 v[120:123],v19 offset:0
v_mfma_f32_16x16x32_bf16 v[64:67],a[108:111],v[236:239],v[64:67]
buffer_store_dword v22,v23,s[20:23],s97 offen sc1
v_mfma_f32_16x16x32_bf16 v[72:75],a[236:239],v[236:239],v[72:75]
ds_read_b128 v[232:235],v17 offset:5120
s_waitcnt lgkmcnt(8)
v_mfma_f32_16x16x32_bf16 v[64:67],a[112:115],v[240:243],v[64:67]
v_min3_u32 v27,v27,v240,v244
s_mov_b32 s97,0x7fff0000
v_mfma_f32_16x16x32_bf16 v[72:75],a[240:243],v[240:243],v[72:75]
ds_read_b128 v[236:239],v17 offset:7168
v_mfma_f32_16x16x32_bf16 v[64:67],a[116:119],v[244:247],v[64:67]
v_mfma_f32_16x16x32_bf16 v[72:75],a[244:247],v[244:247],v[72:75]
ds_read_b128 v[240:243],v17 offset:9216
s_waitcnt lgkmcnt(8)
v_mfma_f32_16x16x32_bf16 v[64:67],a[120:123],v[248:251],v[64:67]
s_waitcnt lgkmcnt(7)
v_readfirstlane_b32 s93,v45
v_mfma_f32_16x16x32_bf16 v[72:75],a[248:251],v[248:251],v[72:75]
ds_read_b128 v[244:247],v17 offset:11264
v_readfirstlane_b32 s83,v44
s_cmp_lg_u32 s83,0
s_cbranch_scc1 keep_348
v_mfma_f32_16x16x32_bf16 v[64:67],a[124:127],v[252:255],v[64:67]
v_min3_u32 v27,v27,v248,v252
s_xor_b32 m0,s72,0
v_mfma_f32_16x16x32_bf16 v[72:75],a[252:255],v[252:255],v[72:75]
ds_read_b128 v[248:251],v17 offset:13312
s_waitcnt lgkmcnt(6)
v_mfma_f32_16x16x32_bf16 v[68:71],a[0:3],v[224:227],0
s_add_u32 s65,s88,0
v_cmp_eq_u32 vcc,0,v27
s_cbranch_vccnz retry_339
v_mfma_f32_16x16x32_bf16 v[76:79],a[128:131],v[224:227],0
ds_read_b128 v[252:255],v17 offset:15360
v_min3_u32 v27,v27,v224,v228
s_waitcnt lgkmcnt(6)
v_mfma_f32_16x16x32_bf16 v[68:71],a[4:7],v[228:231],v[68:71]
buffer_load_dwordx4 v16,s[20:23],s65 offen offset:0 sc1 lds
v_mfma_f32_16x16x32_bf16 v[76:79],a[132:135],v[228:231],v[76:79]
ds_read_b128 v[224:227],v17 offset:17408
s_waitcnt lgkmcnt(5)
v_mfma_f32_16x16x32_bf16 v[68:71],a[8:11],v[232:235],v[68:71]
buffer_load_dwordx4 v16,s[20:23],s65 offen offset:2048 sc1 lds
v_fmac_f32 v64,v52,v120
v_fmac_f32 v65,v53,v120
v_mfma_f32_16x16x32_bf16 v[76:79],a[136:139],v[232:235],v[76:79]
ds_read_b128 v[228:231],v17 offset:19456
s_xor_b32 m0,s72,16384
v_fmac_f32 v66,v54,v120
v_fmac_f32 v67,v55,v120
v_mfma_f32_16x16x32_bf16 v[68:71],a[12:15],v[236:239],v[68:71]
s_add_u32 s65,s88,32768
v_min3_u32 v27,v27,v232,v236
v_mul_f32 v88,v64,v64
v_mul_f32 v89,v65,v65
v_mfma_f32_16x16x32_bf16 v[76:79],a[140:143],v[236:239],v[76:79]
ds_read_b128 v[232:235],v17 offset:21504
v_mul_f32 v90,v66,v66
v_mul_f32 v91,v67,v67
s_waitcnt lgkmcnt(5)
v_mfma_f32_16x16x32_bf16 v[68:71],a[16:19],v[240:243],v[68:71]
buffer_load_dwordx4 v16,s[20:23],s65 offen offset:0 sc1 lds
v_fma_f32 v88,v88,v121,v122
v_fma_f32 v89,v89,v121,v122
v_mfma_f32_16x16x32_bf16 v[76:79],a[144:147],v[240:243],v[76:79]
ds_read_b128 v[236:239],v17 offset:23552
v_min3_u32 v27,v27,v240,v244
v_fma_f32 v90,v90,v121,v122
v_fma_f32 v91,v91,v121,v122
v_mfma_f32_16x16x32_bf16 v[68:71],a[20:23],v[244:247],v[68:71]
buffer_load_dwordx4 v16,s[20:23],s65 offen offset:2048 sc1 lds
v_mul_f32 v88,v88,v64
v_mul_f32 v89,v89,v65
v_mfma_f32_16x16x32_bf16 v[76:79],a[148:151],v[244:247],v[76:79]
ds_read_b128 v[240:243],v17 offset:25600
v_mul_f32 v90,v90,v66
v_mul_f32 v91,v91,v67
s_waitcnt lgkmcnt(5)
v_mfma_f32_16x16x32_bf16 v[68:71],a[24:27],v[248:251],v[68:71]
s_xor_b32 m0,s72,32768
s_add_u32 s65,s88,65536
v_exp_f32 v88,v88
v_mfma_f32_16x16x32_bf16 v[76:79],a[152:155],v[248:251],v[76:79]
ds_read_b128 v[244:247],v17 offset:27648
v_min3_u32 v27,v27,v248,v252
v_exp_f32 v89,v89
v_mfma_f32_16x16x32_bf16 v[68:71],a[28:31],v[252:255],v[68:71]
buffer_load_dwordx4 v16,s[20:23],s65 offen offset:0 sc1 lds
v_exp_f32 v90,v90
v_mfma_f32_16x16x32_bf16 v[76:79],a[156:159],v[252:255],v[76:79]
ds_read_b128 v[248:251],v17 offset:29696
v_exp_f32 v91,v91
s_waitcnt lgkmcnt(5)
v_mfma_f32_16x16x32_bf16 v[68:71],a[32:35],v[224:227],v[68:71]
buffer_load_dwordx4 v16,s[20:23],s65 offen offset:2048 sc1 lds
v_fma_f32 v88,v88,v123,v123
v_fma_f32 v89,v89,v123,v123
v_mfma_f32_16x16x32_bf16 v[76:79],a[160:163],v[224:227],v[76:79]
ds_read_b128 v[252:255],v17 offset:31744
s_xor_b32 m0,s72,49152
v_fma_f32 v90,v90,v123,v123
v_fma_f32 v91,v91,v123,v123
v_mfma_f32_16x16x32_bf16 v[68:71],a[36:39],v[228:231],v[68:71]
v_min3_u32 v27,v27,v224,v228
v_rcp_f32 v88,v88
v_fmac_f32 v72,v56,v120
v_mfma_f32_16x16x32_bf16 v[76:79],a[164:167],v[228:231],v[76:79]
ds_read_b128 v[224:227],v17 offset:33792
v_fmac_f32 v73,v57,v120
v_fmac_f32 v74,v58,v120
s_waitcnt lgkmcnt(5)
v_mfma_f32_16x16x32_bf16 v[68:71],a[40:43],v[232:235],v[68:71]
s_add_u32 s65,s88,98304
v_min3_u32 v27,v27,v232,v236
v_fmac_f32 v75,v59,v120
v_mul_f32 v92,v72,v72
v_mfma_f32_16x16x32_bf16 v[76:79],a[168:171],v[232:235],v[76:79]
ds_read_b128 v[228:231],v17 offset:35840
v_mul_f32 v93,v73,v73
v_mul_f32 v94,v74,v74
v_mul_f32 v95,v75,v75
v_mfma_f32_16x16x32_bf16 v[68:71],a[44:47],v[236:239],v[68:71]
buffer_load_dwordx4 v16,s[20:23],s65 offen offset:0 sc1 lds
v_fma_f32 v92,v92,v121,v122
v_fma_f32 v93,v93,v121,v122
v_mfma_f32_16x16x32_bf16 v[76:79],a[172:175],v[236:239],v[76:79]
ds_read_b128 v[232:235],v17 offset:37888
v_fma_f32 v94,v94,v121,v122
v_fma_f32 v95,v95,v121,v122
s_waitcnt lgkmcnt(5)
v_mfma_f32_16x16x32_bf16 v[68:71],a[48:51],v[240:243],v[68:71]
buffer_load_dwordx4 v16,s[20:23],s65 offen offset:2048 sc1 lds
v_mul_f32 v92,v92,v72
v_mul_f32 v93,v93,v73
v_mfma_f32_16x16x32_bf16 v[76:79],a[176:179],v[240:243],v[76:79]
ds_read_b128 v[236:239],v17 offset:39936
s_xor_b32 m0,s72,1024
v_mul_f32 v94,v94,v74
v_mul_f32 v95,v95,v75
v_mfma_f32_16x16x32_bf16 v[68:71],a[52:55],v[244:247],v[68:71]
s_add_u32 s65,s89,0
v_min3_u32 v27,v27,v240,v244
v_exp_f32 v92,v92
v_mfma_f32_16x16x32_bf16 v[76:79],a[180:183],v[244:247],v[76:79]
ds_read_b128 v[240:243],v17 offset:41984
v_exp_f32 v93,v93
s_waitcnt lgkmcnt(5)
v_mfma_f32_16x16x32_bf16 v[68:71],a[56:59],v[248:251],v[68:71]
buffer_load_dwordx4 v16,s[20:23],s65 offen offset:0 sc1 lds
v_exp_f32 v94,v94
v_mfma_f32_16x16x32_bf16 v[76:79],a[184:187],v[248:251],v[76:79]
ds_read_b128 v[244:247],v17 offset:44032
v_min3_u32 v27,v27,v248,v252
v_exp_f32 v95,v95
v_mfma_f32_16x16x32_bf16 v[68:71],a[60:63],v[252:255],v[68:71]
buffer_load_dwordx4 v16,s[20:23],s65 offen offset:2048 sc1 lds
v_fma_f32 v92,v92,v123,v123
v_fma_f32 v93,v93,v123,v123
v_mfma_f32_16x16x32_bf16 v[76:79],a[188:191],v[252:255],v[76:79]
ds_read_b128 v[248:251],v17 offset:46080
v_fma_f32 v94,v94,v123,v123
v_fma_f32 v95,v95,v123,v123
s_waitcnt lgkmcnt(5)
v_mfma_f32_16x16x32_bf16 v[68:71],a[64:67],v[224:227],v[68:71]
s_xor_b32 m0,s72,17408
s_add_u32 s65,s89,32768
v_rcp_f32 v92,v92
v_mfma_f32_16x16x32_bf16 v[76:79],a[192:195],v[224:227],v[76:79]
ds_read_b128 v[252:255],v17 offset:48128
v_min3_u32 v27,v27,v224,v228
v_rcp_f32 v93,v93
v_mfma_f32_16x16x32_bf16 v[68:71],a[68:71],v[228:231],v[68:71]
buffer_load_dwordx4 v16,s[20:23],s65 offen offset:0 sc1 lds
v_rcp_f32 v94,v94
v_mfma_f32_16x16x32_bf16 v[76:79],a[196:199],v[228:231],v[76:79]
ds_read_b128 v[224:227],v17 offset:50176
v_rcp_f32 v95,v95
s_waitcnt lgkmcnt(5)
v_mfma_f32_16x16x32_bf16 v[68:71],a[72:75],v[232:235],v[68:71]
buffer_load_dwordx4 v16,s[20:23],s65 offen offset:2048 sc1 lds
v_mfma_f32_16x16x32_bf16 v[76:79],a[200:203],v[232:235],v[76:79]
ds_read_b128 v[228:231],v17 offset:52224
s_xor_b32 m0,s72,33792
v_mfma_f32_16x16x32_bf16 v[68:71],a[76:79],v[236:239],v[68:71]
s_add_u32 s65,s89,65536
v_min3_u32 v27,v27,v232,v236
v_mfma_f32_16x16x32_bf16 v[76:79],a[204:207],v[236:239],v[76:79]
ds_read_b128 v[232:235],v17 offset:54272
s_waitcnt lgkmcnt(5)
v_mfma_f32_16x16x32_bf16 v[68:71],a[80:83],v[240:243],v[68:71]
buffer_load_dwordx4 v16,s[20:23],s65 offen offset:0 sc1 lds
v_mfma_f32_16x16x32_bf16 v[76:79],a[208:211],v[240:243],v[76:79]
ds_read_b128 v[236:239],v17 offset:56320
v_min3_u32 v27,v27,v240,v244
v_mfma_f32_16x16x32_bf16 v[68:71],a[84:87],v[244:247],v[68:71]
buffer_load_dwordx4 v16,s[20:23],s65 offen offset:2048 sc1 lds
v_mfma_f32_16x16x32_bf16 v[76:79],a[212:215],v[244:247],v[76:79]
ds_read_b128 v[240:243],v17 offset:58368
s_waitcnt lgkmcnt(5)
v_mfma_f32_16x16x32_bf16 v[68:71],a[88:91],v[248:251],v[68:71]
s_xor_b32 m0,s72,50176
v_min3_u32 v27,v27,v248,v252
v_mfma_f32_16x16x32_bf16 v[76:79],a[216:219],v[248:251],v[76:79]
ds_read_b128 v[244:247],v17 offset:60416
s_add_u32 s65,s89,98304
v_mfma_f32_16x16x32_bf16 v[68:71],a[92:95],v[252:255],v[68:71]
buffer_load_dwordx4 v16,s[20:23],s65 offen offset:0 sc1 lds
v_mfma_f32_16x16x32_bf16 v[76:79],a[220:223],v[252:255],v[76:79]
ds_read_b128 v[248:251],v17 offset:62464
s_waitcnt lgkmcnt(5)
v_mfma_f32_16x16x32_bf16 v[68:71],a[96:99],v[224:227],v[68:71]
buffer_load_dwordx4 v16,s[20:23],s65 offen offset:2048 sc1 lds
v_mfma_f32_16x16x32_bf16 v[76:79],a[224:227],v[224:227],v[76:79]
ds_read_b128 v[252:255],v17 offset:64512
v_min3_u32 v27,v27,v224,v228
v_mfma_f32_16x16x32_bf16 v[68:71],a[100:103],v[228:231],v[68:71]
v_rcp_f32 v89,v89
v_mfma_f32_16x16x32_bf16 v[76:79],a[228:231],v[228:231],v[76:79]
v_mul_f32 v92,v92,v72
s_waitcnt lgkmcnt(4)
v_mfma_f32_16x16x32_bf16 v[68:71],a[104:107],v[232:235],v[68:71]
v_min3_u32 v27,v27,v232,v236
v_mul_f32 v93,v93,v73
v_mfma_f32_16x16x32_bf16 v[76:79],a[232:235],v[232:235],v[76:79]
v_rcp_f32 v90,v90
v_mfma_f32_16x16x32_bf16 v[68:71],a[108:111],v[236:239],v[68:71]
v_rcp_f32 v91,v91
v_mfma_f32_16x16x32_bf16 v[76:79],a[236:239],v[236:239],v[76:79]
v_mul_f32 v88,v88,v64
s_waitcnt lgkmcnt(2)
v_mfma_f32_16x16x32_bf16 v[68:71],a[112:115],v[240:243],v[68:71]
v_min3_u32 v27,v27,v240,v244
v_mul_f32 v89,v89,v65
v_mfma_f32_16x16x32_bf16 v[76:79],a[240:243],v[240:243],v[76:79]
v_mul_f32 v90,v90,v66
v_mul_f32 v91,v91,v67
v_mfma_f32_16x16x32_bf16 v[68:71],a[116:119],v[244:247],v[68:71]
v_mul_f32 v94,v94,v74
v_mul_f32 v95,v95,v75
v_mfma_f32_16x16x32_bf16 v[76:79],a[244:247],v[244:247],v[76:79]
v_cvt_pk_bf16_f32 v96,v88,v89
s_waitcnt lgkmcnt(0)
v_mfma_f32_16x16x32_bf16 v[68:71],a[120:123],v[248:251],v[68:71]
v_min3_u32 v27,v27,v248,v252
v_cvt_pk_bf16_f32 v97,v90,v91
v_mfma_f32_16x16x32_bf16 v[76:79],a[248:251],v[248:251],v[76:79]
v_cvt_pk_bf16_f32 v98,v92,v93
v_cvt_pk_bf16_f32 v99,v94,v95
v_mfma_f32_16x16x32_bf16 v[68:71],a[124:127],v[252:255],v[68:71]
v_max_u32 v96,1,v96
v_mfma_f32_16x16x32_bf16 v[76:79],a[252:255],v[252:255],v[76:79]
buffer_store_dwordx4 v[96:99],v18,s[20:23],s70 offen offset:0 sc1
v_cmp_eq_u32 vcc,0,v27
s_cbranch_vccnz retry_339
s_branch epi_342
keep_348:
v_mfma_f32_16x16x32_bf16 v[64:67],a[124:127],v[252:255],v[64:67]
v_min3_u32 v27,v27,v248,v252
v_mfma_f32_16x16x32_bf16 v[72:75],a[252:255],v[252:255],v[72:75]
ds_read_b128 v[248:251],v17 offset:13312
s_waitcnt lgkmcnt(6)
v_mfma_f32_16x16x32_bf16 v[68:71],a[0:3],v[224:227],0
v_cmp_eq_u32 vcc,0,v27
s_cbranch_vccnz retry_339
v_mfma_f32_16x16x32_bf16 v[76:79],a[128:131],v[224:227],0
ds_read_b128 v[252:255],v17 offset:15360
v_min3_u32 v27,v27,v224,v228
v_mfma_f32_16x16x32_bf16 v[68:71],a[4:7],v[228:231],v[68:71]
s_waitcnt lgkmcnt(6)
v_mfma_f32_16x16x32_bf16 v[76:79],a[132:135],v[228:231],v[76:79]
ds_read_b128 v[224:227],v17 offset:17408
s_waitcnt lgkmcnt(5)
v_mfma_f32_16x16x32_bf16 v[68:71],a[8:11],v[232:235],v[68:71]
v_min3_u32 v27,v27,v232,v236
v_fmac_f32 v64,v52,v120
v_fmac_f32 v72,v56,v120
v_mfma_f32_16x16x32_bf16 v[76:79],a[136:139],v[232:235],v[76:79]
ds_read_b128 v[228:231],v17 offset:19456
v_fmac_f32 v65,v53,v120
v_fmac_f32 v73,v57,v120
v_mfma_f32_16x16x32_bf16 v[68:71],a[12:15],v[236:239],v[68:71]
v_fmac_f32 v66,v54,v120
v_fmac_f32 v67,v55,v120
v_fmac_f32 v74,v58,v120
v_mfma_f32_16x16x32_bf16 v[76:79],a[140:143],v[236:239],v[76:79]
ds_read_b128 v[232:235],v17 offset:21504
v_fmac_f32 v75,v59,v120
s_waitcnt lgkmcnt(5)
v_mfma_f32_16x16x32_bf16 v[68:71],a[16:19],v[240:243],v[68:71]
v_min3_u32 v27,v27,v240,v244
v_mul_f32 v88,v64,v64
v_mul_f32 v92,v72,v72
v_mfma_f32_16x16x32_bf16 v[76:79],a[144:147],v[240:243],v[76:79]
ds_read_b128 v[236:239],v17 offset:23552
v_mul_f32 v89,v65,v65
v_mul_f32 v93,v73,v73
v_mfma_f32_16x16x32_bf16 v[68:71],a[20:23],v[244:247],v[68:71]
v_mul_f32 v90,v66,v66
v_mul_f32 v91,v67,v67
v_mul_f32 v94,v74,v74
v_mfma_f32_16x16x32_bf16 v[76:79],a[148:151],v[244:247],v[76:79]
ds_read_b128 v[240:243],v17 offset:25600
v_mul_f32 v95,v75,v75
s_waitcnt lgkmcnt(5)
v_mfma_f32_16x16x32_bf16 v[68:71],a[24:27],v[248:251],v[68:71]
v_min3_u32 v27,v27,v248,v252
v_fma_f32 v88,v88,v121,v122
v_fma_f32 v92,v92,v121,v122
v_mfma_f32_16x16x32_bf16 v[76:79],a[152:155],v[248:251],v[76:79]
ds_read_b128 v[244:247],v17 offset:27648
v_fma_f32 v89,v89,v121,v122
v_fma_f32 v93,v93,v121,v122
v_mfma_f32_16x16x32_bf16 v[68:71],a[28:31],v[252:255],v[68:71]
v_fma_f32 v90,v90,v121,v122
v_fma_f32 v91,v91,v121,v122
v_fma_f32 v94,v94,v121,v122
v_mfma_f32_16x16x32_bf16 v[76:79],a[156:159],v[252:255],v[76:79]
ds_read_b128 v[248:251],v17 offset:29696
v_fma_f32 v95,v95,v121,v122
s_waitcnt lgkmcnt(5)
v_mfma_f32_16x16x32_bf16 v[68:71],a[32:35],v[224:227],v[68:71]
v_min3_u32 v27,v27,v224,v228
v_mul_f32 v88,v88,v64
v_mul_f32 v92,v92,v72
v_mfma_f32_16x16x32_bf16 v[76:79],a[160:163],v[224:227],v[76:79]
ds_read_b128 v[252:255],v17 offset:31744
v_mul_f32 v89,v89,v65
v_mul_f32 v93,v93,v73
v_mfma_f32_16x16x32_bf16 v[68:71],a[36:39],v[228:231],v[68:71]
v_mul_f32 v90,v90,v66
v_mul_f32 v91,v91,v67
v_mul_f32 v94,v94,v74
v_mfma_f32_16x16x32_bf16 v[76:79],a[164:167],v[228:231],v[76:79]
ds_read_b128 v[224:227],v17 offset:33792
v_mul_f32 v95,v95,v75
s_waitcnt lgkmcnt(5)
v_mfma_f32_16x16x32_bf16 v[68:71],a[40:43],v[232:235],v[68:71]
v_min3_u32 v27,v27,v232,v236
v_exp_f32 v92,v92
v_mfma_f32_16x16x32_bf16 v[76:79],a[168:171],v[232:235],v[76:79]
ds_read_b128 v[228:231],v17 offset:35840
v_exp_f32 v93,v93
v_mfma_f32_16x16x32_bf16 v[68:71],a[44:47],v[236:239],v[68:71]
v_exp_f32 v88,v88
v_mfma_f32_16x16x32_bf16 v[76:79],a[172:175],v[236:239],v[76:79]
ds_read_b128 v[232:235],v17 offset:37888
s_waitcnt lgkmcnt(5)
v_mfma_f32_16x16x32_bf16 v[68:71],a[48:51],v[240:243],v[68:71]
v_min3_u32 v27,v27,v240,v244
v_exp_f32 v94,v94
v_mfma_f32_16x16x32_bf16 v[76:79],a[176:179],v[240:243],v[76:79]
ds_read_b128 v[236:239],v17 offset:39936
v_exp_f32 v95,v95
v_mfma_f32_16x16x32_bf16 v[68:71],a[52:55],v[244:247],v[68:71]
v_exp_f32 v89,v89
v_fma_f32 v92,v92,v123,v123
v_mfma_f32_16x16x32_bf16 v[76:79],a[180:183],v[244:247],v[76:79]
ds_read_b128 v[240:243],v17 offset:41984
v_fma_f32 v93,v93,v123,v123
s_waitcnt lgkmcnt(5)
v_mfma_f32_16x16x32_bf16 v[68:71],a[56:59],v[248:251],v[68:71]
v_min3_u32 v27,v27,v248,v252
v_fma_f32 v94,v94,v123,v123
v_fma_f32 v95,v95,v123,v123
v_mfma_f32_16x16x32_bf16 v[76:79],a[184:187],v[248:251],v[76:79]
ds_read_b128 v[244:247],v17 offset:44032
v_rcp_f32 v92,v92
v_mfma_f32_16x16x32_bf16 v[68:71],a[60:63],v[252:255],v[68:71]
v_exp_f32 v90,v90
v_mfma_f32_16x16x32_bf16 v[76:79],a[188:191],v[252:255],v[76:79]
ds_read_b128 v[248:251],v17 offset:46080
s_waitcnt lgkmcnt(5)
v_mfma_f32_16x16x32_bf16 v[68:71],a[64:67],v[224:227],v[68:71]
v_min3_u32 v27,v27,v224,v228
v_rcp_f32 v93,v93
v_mfma_f32_16x16x32_bf16 v[76:79],a[192:195],v[224:227],v[76:79]
ds_read_b128 v[252:255],v17 offset:48128
v_rcp_f32 v94,v94
v_mfma_f32_16x16x32_bf16 v[68:71],a[68:71],v[228:231],v[68:71]
v_exp_f32 v91,v91
v_mfma_f32_16x16x32_bf16 v[76:79],a[196:199],v[228:231],v[76:79]
ds_read_b128 v[224:227],v17 offset:50176
s_waitcnt lgkmcnt(5)
v_mfma_f32_16x16x32_bf16 v[68:71],a[72:75],v[232:235],v[68:71]
v_min3_u32 v27,v27,v232,v236
v_fma_f32 v88,v88,v123,v123
v_mfma_f32_16x16x32_bf16 v[76:79],a[200:203],v[232:235],v[76:79]
ds_read_b128 v[228:231],v17 offset:52224
v_fma_f32 v89,v89,v123,v123
v_mfma_f32_16x16x32_bf16 v[68:71],a[76:79],v[236:239],v[68:71]
v_fma_f32 v90,v90,v123,v123
v_fma_f32 v91,v91,v123,v123
v_mfma_f32_16x16x32_bf16 v[76:79],a[204:207],v[236:239],v[76:79]
ds_read_b128 v[232:235],v17 offset:54272
s_waitcnt lgkmcnt(5)
v_mfma_f32_16x16x32_bf16 v[68:71],a[80:83],v[240:243],v[68:71]
v_min3_u32 v27,v27,v240,v244
v_rcp_f32 v95,v95
v_mfma_f32_16x16x32_bf16 v[76:79],a[208:211],v[240:243],v[76:79]
ds_read_b128 v[236:239],v17 offset:56320
v_mul_f32 v92,v92,v72
v_mfma_f32_16x16x32_bf16 v[68:71],a[84:87],v[244:247],v[68:71]
v_rcp_f32 v88,v88
v_mfma_f32_16x16x32_bf16 v[76:79],a[212:215],v[244:247],v[76:79]
ds_read_b128 v[240:243],v17 offset:58368
s_waitcnt lgkmcnt(5)
v_mfma_f32_16x16x32_bf16 v[68:71],a[88:91],v[248:251],v[68:71]
v_min3_u32 v27,v27,v248,v252
v_mul_f32 v93,v93,v73
v_mfma_f32_16x16x32_bf16 v[76:79],a[216:219],v[248:251],v[76:79]
ds_read_b128 v[244:247],v17 offset:60416
v_mul_f32 v94,v94,v74
v_mfma_f32_16x16x32_bf16 v[68:71],a[92:95],v[252:255],v[68:71]
v_rcp_f32 v89,v89
v_mfma_f32_16x16x32_bf16 v[76:79],a[220:223],v[252:255],v[76:79]
ds_read_b128 v[248:251],v17 offset:62464
s_waitcnt lgkmcnt(5)
v_mfma_f32_16x16x32_bf16 v[68:71],a[96:99],v[224:227],v[68:71]
v_min3_u32 v27,v27,v224,v228
v_mul_f32 v95,v95,v75
v_mfma_f32_16x16x32_bf16 v[76:79],a[224:227],v[224:227],v[76:79]
ds_read_b128 v[252:255],v17 offset:64512
v_mfma_f32_16x16x32_bf16 v[68:71],a[100:103],v[228:231],v[68:71]
v_rcp_f32 v90,v90
v_mfma_f32_16x16x32_bf16 v[76:79],a[228:231],v[228:231],v[76:79]
s_waitcnt lgkmcnt(4)
v_mfma_f32_16x16x32_bf16 v[68:71],a[104:107],v[232:235],v[68:71]
v_min3_u32 v27,v27,v232,v236
v_mfma_f32_16x16x32_bf16 v[76:79],a[232:235],v[232:235],v[76:79]
v_rcp_f32 v91,v91
v_mfma_f32_16x16x32_bf16 v[68:71],a[108:111],v[236:239],v[68:71]
v_mul_f32 v88,v88,v64
v_mul_f32 v89,v89,v65
v_mfma_f32_16x16x32_bf16 v[76:79],a[236:239],v[236:239],v[76:79]
v_mul_f32 v90,v90,v66
s_waitcnt lgkmcnt(2)
v_mfma_f32_16x16x32_bf16 v[68:71],a[112:115],v[240:243],v[68:71]
v_min3_u32 v27,v27,v240,v244
v_mul_f32 v91,v91,v67
v_mfma_f32_16x16x32_bf16 v[76:79],a[240:243],v[240:243],v[76:79]
v_cvt_pk_bf16_f32 v96,v88,v89
v_cvt_pk_bf16_f32 v97,v90,v91
v_mfma_f32_16x16x32_bf16 v[68:71],a[116:119],v[244:247],v[68:71]
v_cvt_pk_bf16_f32 v98,v92,v93
v_cvt_pk_bf16_f32 v99,v94,v95
v_mfma_f32_16x16x32_bf16 v[76:79],a[244:247],v[244:247],v[76:79]
v_max_u32 v96,1,v96
s_waitcnt lgkmcnt(0)
v_mfma_f32_16x16x32_bf16 v[68:71],a[120:123],v[248:251],v[68:71]
v_min3_u32 v27,v27,v248,v252
v_mfma_f32_16x16x32_bf16 v[76:79],a[248:251],v[248:251],v[76:79]
buffer_store_dwordx4 v[96:99],v18,s[20:23],s70 offen offset:0 sc1
v_mfma_f32_16x16x32_bf16 v[68:71],a[124:127],v[252:255],v[68:71]
v_mfma_f32_16x16x32_bf16 v[76:79],a[252:255],v[252:255],v[76:79]
v_cmp_eq_u32 vcc,0,v27
s_cbranch_vccnz retry_339
s_branch epi_342
both_343:
s_waitcnt vmcnt(12) lgkmcnt(0)
s_barrier
ds_read_b128 v[224:227],v17 offset:0
ds_read_b128 v[228:231],v17 offset:2048
ds_read_b128 v[232:235],v17 offset:4096
ds_read_b128 v[236:239],v17 offset:6144
ds_read_b128 v[240:243],v17 offset:8192
ds_read_b128 v[244:247],v17 offset:10240
ds_read_b128 v[248:251],v17 offset:12288
s_waitcnt lgkmcnt(5)
v_mfma_f32_16x16x32_bf16 v[64:67],a[0:3],v[224:227],0
s_add_u32 s96,s71,1
s_add_u32 s92,s71,2
v_min_u32 v27,v224,v228
v_mfma_f32_16x16x32_bf16 v[72:75],a[128:131],v[224:227],0
ds_read_b128 v[252:255],v17 offset:14336
s_add_u32 s88,s70,s75
v_mfma_f32_16x16x32_bf16 v[64:67],a[4:7],v[228:231],v[64:67]
s_add_u32 s88,s88,2097152
s_xor_b32 s88,s88,0x2000
v_mfma_f32_16x16x32_bf16 v[72:75],a[132:135],v[228:231],v[72:75]
ds_read_b128 v[224:227],v17 offset:16384
s_waitcnt lgkmcnt(5)
v_mfma_f32_16x16x32_bf16 v[64:67],a[8:11],v[232:235],v[64:67]
s_xor_b32 s89,s88,1024
v_min3_u32 v27,v27,v232,v236
v_mfma_f32_16x16x32_bf16 v[72:75],a[136:139],v[232:235],v[72:75]
ds_read_b128 v[228:231],v17 offset:18432
v_mfma_f32_16x16x32_bf16 v[64:67],a[12:15],v[236:239],v[64:67]
s_xor_b32 m0,s72,0
v_mfma_f32_16x16x32_bf16 v[72:75],a[140:143],v[236:239],v[72:75]
ds_read_b128 v[232:235],v17 offset:20480
s_add_u32 s65,s88,0
s_waitcnt lgkmcnt(5)
v_mfma_f32_16x16x32_bf16 v[64:67],a[16:19],v[240:243],v[64:67]
v_min3_u32 v27,v27,v240,v244
v_mfma_f32_16x16x32_bf16 v[72:75],a[144:147],v[240:243],v[72:75]
ds_read_b128 v[236:239],v17 offset:22528
buffer_load_dwordx4 v16,s[20:23],s65 offen offset:0 sc1 lds
v_mfma_f32_16x16x32_bf16 v[64:67],a[20:23],v[244:247],v[64:67]
buffer_load_dwordx4 v16,s[20:23],s65 offen offset:2048 sc1 lds
v_mfma_f32_16x16x32_bf16 v[72:75],a[148:151],v[244:247],v[72:75]
ds_read_b128 v[240:243],v17 offset:24576
s_waitcnt lgkmcnt(5)
v_mfma_f32_16x16x32_bf16 v[64:67],a[24:27],v[248:251],v[64:67]
s_xor_b32 m0,s72,16384
v_min3_u32 v27,v27,v248,v252
v_mfma_f32_16x16x32_bf16 v[72:75],a[152:155],v[248:251],v[72:75]
ds_read_b128 v[244:247],v17 offset:26624
v_mfma_f32_16x16x32_bf16 v[64:67],a[28:31],v[252:255],v[64:67]
s_add_u32 s65,s88,32768
v_mfma_f32_16x16x32_bf16 v[72:75],a[156:159],v[252:255],v[72:75]
ds_read_b128 v[248:251],v17 offset:28672
s_waitcnt lgkmcnt(5)
v_mfma_f32_16x16x32_bf16 v[64:67],a[32:35],v[224:227],v[64:67]
buffer_load_dwordx4 v16,s[20:23],s65 offen offset:0 sc1 lds
v_mfma_f32_16x16x32_bf16 v[72:75],a[160:163],v[224:227],v[72:75]
ds_read_b128 v[252:255],v17 offset:30720
buffer_load_dwordx4 v16,s[20:23],s65 offen offset:2048 sc1 lds
v_mfma_f32_16x16x32_bf16 v[64:67],a[36:39],v[228:231],v[64:67]
v_min3_u32 v27,v27,v224,v228
v_mfma_f32_16x16x32_bf16 v[72:75],a[164:167],v[228:231],v[72:75]
ds_read_b128 v[224:227],v17 offset:32768
s_xor_b32 m0,s72,32768
s_waitcnt lgkmcnt(5)
v_mfma_f32_16x16x32_bf16 v[64:67],a[40:43],v[232:235],v[64:67]
s_add_u32 s65,s88,65536
v_min3_u32 v27,v27,v232,v236
v_mfma_f32_16x16x32_bf16 v[72:75],a[168:171],v[232:235],v[72:75]
ds_read_b128 v[228:231],v17 offset:34816
v_mfma_f32_16x16x32_bf16 v[64:67],a[44:47],v[236:239],v[64:67]
buffer_load_dwordx4 v16,s[20:23],s65 offen offset:0 sc1 lds
v_mfma_f32_16x16x32_bf16 v[72:75],a[172:175],v[236:239],v[72:75]
ds_read_b128 v[232:235],v17 offset:36864
s_waitcnt lgkmcnt(5)
v_mfma_f32_16x16x32_bf16 v[64:67],a[48:51],v[240:243],v[64:67]
buffer_load_dwordx4 v16,s[20:23],s65 offen offset:2048 sc1 lds
v_mfma_f32_16x16x32_bf16 v[72:75],a[176:179],v[240:243],v[72:75]
ds_read_b128 v[236:239],v17 offset:38912
s_xor_b32 m0,s72,49152
v_mfma_f32_16x16x32_bf16 v[64:67],a[52:55],v[244:247],v[64:67]
v_min3_u32 v27,v27,v240,v244
v_mfma_f32_16x16x32_bf16 v[72:75],a[180:183],v[244:247],v[72:75]
ds_read_b128 v[240:243],v17 offset:40960
s_add_u32 s65,s88,98304
s_waitcnt lgkmcnt(5)
v_mfma_f32_16x16x32_bf16 v[64:67],a[56:59],v[248:251],v[64:67]
buffer_load_dwordx4 v16,s[20:23],s65 offen offset:0 sc1 lds
v_min3_u32 v27,v27,v248,v252
v_mfma_f32_16x16x32_bf16 v[72:75],a[184:187],v[248:251],v[72:75]
ds_read_b128 v[244:247],v17 offset:43008
s_waitcnt vmcnt(9)
v_mfma_f32_16x16x32_bf16 v[64:67],a[60:63],v[252:255],v[64:67]
v_cmp_gt_u32 vcc,s96,v29
v_cmp_gt_u32 s[92:93],s92,v29
v_mfma_f32_16x16x32_bf16 v[72:75],a[188:191],v[252:255],v[72:75]
ds_read_b128 v[248:251],v17 offset:45056
s_waitcnt lgkmcnt(5)
v_mfma_f32_16x16x32_bf16 v[64:67],a[64:67],v[224:227],v[64:67]
v_mov_b32 v44,vcc_lo
v_mov_b32 v45,s92
v_min3_u32 v27,v27,v224,v228
v_mfma_f32_16x16x32_bf16 v[72:75],a[192:195],v[224:227],v[72:75]
ds_read_b128 v[252:255],v17 offset:47104
ds_write_b64 v46,v[44:45]
v_mfma_f32_16x16x32_bf16 v[64:67],a[68:71],v[228:231],v[64:67]
buffer_load_dwordx4 v16,s[20:23],s65 offen offset:2048 sc1 lds
v_mfma_f32_16x16x32_bf16 v[72:75],a[196:199],v[228:231],v[72:75]
ds_read_b128 v[224:227],v17 offset:49152
s_waitcnt lgkmcnt(6)
v_mfma_f32_16x16x32_bf16 v[64:67],a[72:75],v[232:235],v[64:67]
s_xor_b32 m0,s72,1024
s_add_u32 s65,s89,0
v_mfma_f32_16x16x32_bf16 v[72:75],a[200:203],v[232:235],v[72:75]
ds_read_b128 v[228:231],v17 offset:51200
v_min3_u32 v27,v27,v232,v236
v_mfma_f32_16x16x32_bf16 v[64:67],a[76:79],v[236:239],v[64:67]
buffer_load_dwordx4 v16,s[20:23],s65 offen offset:0 sc1 lds
v_mfma_f32_16x16x32_bf16 v[72:75],a[204:207],v[236:239],v[72:75]
ds_read_b128 v[232:235],v17 offset:53248
s_waitcnt lgkmcnt(6)
v_mfma_f32_16x16x32_bf16 v[64:67],a[80:83],v[240:243],v[64:67]
buffer_load_dwordx4 v16,s[20:23],s65 offen offset:2048 sc1 lds
v_mfma_f32_16x16x32_bf16 v[72:75],a[208:211],v[240:243],v[72:75]
ds_read_b128 v[236:239],v17 offset:55296
s_xor_b32 m0,s72,17408
v_mfma_f32_16x16x32_bf16 v[64:67],a[84:87],v[244:247],v[64:67]
s_add_u32 s65,s89,32768
v_min3_u32 v27,v27,v240,v244
v_mfma_f32_16x16x32_bf16 v[72:75],a[212:215],v[244:247],v[72:75]
ds_read_b128 v[240:243],v17 offset:57344
s_waitcnt lgkmcnt(6)
v_mfma_f32_16x16x32_bf16 v[64:67],a[88:91],v[248:251],v[64:67]
buffer_load_dwordx4 v16,s[20:23],s65 offen offset:0 sc1 lds
v_mfma_f32_16x16x32_bf16 v[72:75],a[216:219],v[248:251],v[72:75]
ds_read_b128 v[244:247],v17 offset:59392
v_min3_u32 v27,v27,v248,v252
v_mfma_f32_16x16x32_bf16 v[64:67],a[92:95],v[252:255],v[64:67]
buffer_load_dwordx4 v16,s[20:23],s65 offen offset:2048 sc1 lds
v_mfma_f32_16x16x32_bf16 v[72:75],a[220:223],v[252:255],v[72:75]
ds_read_b128 v[248:251],v17 offset:61440
s_waitcnt lgkmcnt(5)
v_mfma_f32_16x16x32_bf16 v[64:67],a[96:99],v[224:227],v[64:67]
s_xor_b32 m0,s72,33792
s_add_u32 s65,s89,65536
v_mfma_f32_16x16x32_bf16 v[72:75],a[224:227],v[224:227],v[72:75]
ds_read_b128 v[252:255],v17 offset:63488
v_min3_u32 v27,v27,v224,v228
v_mfma_f32_16x16x32_bf16 v[64:67],a[100:103],v[228:231],v[64:67]
buffer_load_dwordx4 v16,s[20:23],s65 offen offset:0 sc1 lds
s_waitcnt vmcnt(13)
v_add_u32 v22,s71,-1
v_mfma_f32_16x16x32_bf16 v[72:75],a[228:231],v[228:231],v[72:75]
s_waitcnt vmcnt(17)
s_barrier
ds_read_b64 v[44:45],v47
ds_read_b128 v[224:227],v17 offset:1024
s_waitcnt lgkmcnt(6)
v_mfma_f32_16x16x32_bf16 v[64:67],a[104:107],v[232:235],v[64:67]
buffer_load_dwordx4 v16,s[20:23],s65 offen offset:2048 sc1 lds
buffer_store_dword v22,v23,s[20:23],s97 offen sc1
v_mfma_f32_16x16x32_bf16 v[72:75],a[232:235],v[232:235],v[72:75]
ds_read_b128 v[228:231],v17 offset:3072
s_xor_b32 m0,s72,50176
s_mov_b32 s97,0x7fff0000
v_mfma_f32_16x16x32_bf16 v[64:67],a[108:111],v[236:239],v[64:67]
s_add_u32 s65,s89,98304
v_min3_u32 v27,v27,v232,v236
ds_read_b128 v[124:127],v19 offset:256
v_mfma_f32_16x16x32_bf16 v[72:75],a[236:239],v[236:239],v[72:75]
ds_read_b128 v[232:235],v17 offset:5120
ds_read_b128 v[120:123],v19 offset:0
s_waitcnt lgkmcnt(8)
v_mfma_f32_16x16x32_bf16 v[64:67],a[112:115],v[240:243],v[64:67]
buffer_load_dwordx4 v16,s[20:23],s65 offen offset:0 sc1 lds
v_mfma_f32_16x16x32_bf16 v[72:75],a[240:243],v[240:243],v[72:75]
ds_read_b128 v[236:239],v17 offset:7168
v_min3_u32 v27,v27,v240,v244
v_mfma_f32_16x16x32_bf16 v[64:67],a[116:119],v[244:247],v[64:67]
buffer_load_dwordx4 v16,s[20:23],s65 offen offset:2048 sc1 lds
v_mfma_f32_16x16x32_bf16 v[72:75],a[244:247],v[244:247],v[72:75]
ds_read_b128 v[240:243],v17 offset:9216
s_waitcnt lgkmcnt(8)
v_mfma_f32_16x16x32_bf16 v[64:67],a[120:123],v[248:251],v[64:67]
s_waitcnt lgkmcnt(7)
v_readfirstlane_b32 s93,v45
v_mfma_f32_16x16x32_bf16 v[72:75],a[248:251],v[248:251],v[72:75]
ds_read_b128 v[244:247],v17 offset:11264
v_min3_u32 v27,v27,v248,v252
v_mfma_f32_16x16x32_bf16 v[64:67],a[124:127],v[252:255],v[64:67]
v_mfma_f32_16x16x32_bf16 v[72:75],a[252:255],v[252:255],v[72:75]
ds_read_b128 v[248:251],v17 offset:13312
s_waitcnt lgkmcnt(7)
v_mfma_f32_16x16x32_bf16 v[68:71],a[0:3],v[224:227],0
v_cmp_eq_u32 vcc,0,v27
s_cbranch_vccnz retry_339
v_mfma_f32_16x16x32_bf16 v[76:79],a[128:131],v[224:227],0
ds_read_b128 v[252:255],v17 offset:15360
v_min3_u32 v27,v27,v224,v228
v_mfma_f32_16x16x32_bf16 v[68:71],a[4:7],v[228:231],v[68:71]
s_waitcnt lgkmcnt(5)
v_mfma_f32_16x16x32_bf16 v[76:79],a[132:135],v[228:231],v[76:79]
ds_read_b128 v[224:227],v17 offset:17408
s_waitcnt lgkmcnt(5)
v_mfma_f32_16x16x32_bf16 v[68:71],a[8:11],v[232:235],v[68:71]
v_min3_u32 v27,v27,v232,v236
v_fmac_f32 v64,v52,v120
v_fmac_f32 v72,v56,v120
v_mfma_f32_16x16x32_bf16 v[76:79],a[136:139],v[232:235],v[76:79]
ds_read_b128 v[228:231],v17 offset:19456
v_fmac_f32 v65,v53,v120
v_fmac_f32 v73,v57,v120
v_mfma_f32_16x16x32_bf16 v[68:71],a[12:15],v[236:239],v[68:71]
v_fmac_f32 v66,v54,v120
v_fmac_f32 v67,v55,v120
v_fmac_f32 v74,v58,v120
v_mfma_f32_16x16x32_bf16 v[76:79],a[140:143],v[236:239],v[76:79]
ds_read_b128 v[232:235],v17 offset:21504
v_fmac_f32 v75,v59,v120
s_waitcnt lgkmcnt(5)
v_mfma_f32_16x16x32_bf16 v[68:71],a[16:19],v[240:243],v[68:71]
v_min3_u32 v27,v27,v240,v244
v_mul_f32 v88,v64,v64
v_mul_f32 v92,v72,v72
v_mfma_f32_16x16x32_bf16 v[76:79],a[144:147],v[240:243],v[76:79]
ds_read_b128 v[236:239],v17 offset:23552
v_mul_f32 v89,v65,v65
v_mul_f32 v93,v73,v73
v_mfma_f32_16x16x32_bf16 v[68:71],a[20:23],v[244:247],v[68:71]
v_mul_f32 v90,v66,v66
v_mul_f32 v91,v67,v67
v_mul_f32 v94,v74,v74
v_mfma_f32_16x16x32_bf16 v[76:79],a[148:151],v[244:247],v[76:79]
ds_read_b128 v[240:243],v17 offset:25600
v_mul_f32 v95,v75,v75
s_waitcnt lgkmcnt(5)
v_mfma_f32_16x16x32_bf16 v[68:71],a[24:27],v[248:251],v[68:71]
v_min3_u32 v27,v27,v248,v252
v_fma_f32 v88,v88,v121,v122
v_fma_f32 v92,v92,v121,v122
v_mfma_f32_16x16x32_bf16 v[76:79],a[152:155],v[248:251],v[76:79]
ds_read_b128 v[244:247],v17 offset:27648
v_fma_f32 v89,v89,v121,v122
v_fma_f32 v93,v93,v121,v122
v_mfma_f32_16x16x32_bf16 v[68:71],a[28:31],v[252:255],v[68:71]
v_fma_f32 v90,v90,v121,v122
v_fma_f32 v91,v91,v121,v122
v_fma_f32 v94,v94,v121,v122
v_mfma_f32_16x16x32_bf16 v[76:79],a[156:159],v[252:255],v[76:79]
ds_read_b128 v[248:251],v17 offset:29696
v_fma_f32 v95,v95,v121,v122
s_waitcnt lgkmcnt(5)
v_mfma_f32_16x16x32_bf16 v[68:71],a[32:35],v[224:227],v[68:71]
v_min3_u32 v27,v27,v224,v228
v_mul_f32 v88,v88,v64
v_mul_f32 v92,v92,v72
v_mfma_f32_16x16x32_bf16 v[76:79],a[160:163],v[224:227],v[76:79]
ds_read_b128 v[252:255],v17 offset:31744
v_mul_f32 v89,v89,v65
v_mul_f32 v93,v93,v73
v_mfma_f32_16x16x32_bf16 v[68:71],a[36:39],v[228:231],v[68:71]
v_mul_f32 v90,v90,v66
v_mul_f32 v91,v91,v67
v_mul_f32 v94,v94,v74
v_mfma_f32_16x16x32_bf16 v[76:79],a[164:167],v[228:231],v[76:79]
ds_read_b128 v[224:227],v17 offset:33792
v_mul_f32 v95,v95,v75
s_waitcnt lgkmcnt(5)
v_mfma_f32_16x16x32_bf16 v[68:71],a[40:43],v[232:235],v[68:71]
v_min3_u32 v27,v27,v232,v236
v_exp_f32 v92,v92
v_mfma_f32_16x16x32_bf16 v[76:79],a[168:171],v[232:235],v[76:79]
ds_read_b128 v[228:231],v17 offset:35840
v_exp_f32 v93,v93
v_mfma_f32_16x16x32_bf16 v[68:71],a[44:47],v[236:239],v[68:71]
v_exp_f32 v88,v88
v_mfma_f32_16x16x32_bf16 v[76:79],a[172:175],v[236:239],v[76:79]
ds_read_b128 v[232:235],v17 offset:37888
s_waitcnt lgkmcnt(5)
v_mfma_f32_16x16x32_bf16 v[68:71],a[48:51],v[240:243],v[68:71]
v_min3_u32 v27,v27,v240,v244
v_exp_f32 v94,v94
v_mfma_f32_16x16x32_bf16 v[76:79],a[176:179],v[240:243],v[76:79]
ds_read_b128 v[236:239],v17 offset:39936
v_exp_f32 v95,v95
v_mfma_f32_16x16x32_bf16 v[68:71],a[52:55],v[244:247],v[68:71]
v_exp_f32 v89,v89
v_fma_f32 v92,v92,v123,v123
v_mfma_f32_16x16x32_bf16 v[76:79],a[180:183],v[244:247],v[76:79]
ds_read_b128 v[240:243],v17 offset:41984
v_fma_f32 v93,v93,v123,v123
s_waitcnt lgkmcnt(5)
v_mfma_f32_16x16x32_bf16 v[68:71],a[56:59],v[248:251],v[68:71]
v_min3_u32 v27,v27,v248,v252
v_fma_f32 v94,v94,v123,v123
v_fma_f32 v95,v95,v123,v123
v_mfma_f32_16x16x32_bf16 v[76:79],a[184:187],v[248:251],v[76:79]
ds_read_b128 v[244:247],v17 offset:44032
v_rcp_f32 v92,v92
v_mfma_f32_16x16x32_bf16 v[68:71],a[60:63],v[252:255],v[68:71]
v_exp_f32 v90,v90
v_mfma_f32_16x16x32_bf16 v[76:79],a[188:191],v[252:255],v[76:79]
ds_read_b128 v[248:251],v17 offset:46080
s_waitcnt lgkmcnt(5)
v_mfma_f32_16x16x32_bf16 v[68:71],a[64:67],v[224:227],v[68:71]
v_min3_u32 v27,v27,v224,v228
v_rcp_f32 v93,v93
v_mfma_f32_16x16x32_bf16 v[76:79],a[192:195],v[224:227],v[76:79]
ds_read_b128 v[252:255],v17 offset:48128
v_rcp_f32 v94,v94
v_mfma_f32_16x16x32_bf16 v[68:71],a[68:71],v[228:231],v[68:71]
v_exp_f32 v91,v91
v_mfma_f32_16x16x32_bf16 v[76:79],a[196:199],v[228:231],v[76:79]
ds_read_b128 v[224:227],v17 offset:50176
s_waitcnt lgkmcnt(5)
v_mfma_f32_16x16x32_bf16 v[68:71],a[72:75],v[232:235],v[68:71]
v_min3_u32 v27,v27,v232,v236
v_fma_f32 v88,v88,v123,v123
v_mfma_f32_16x16x32_bf16 v[76:79],a[200:203],v[232:235],v[76:79]
ds_read_b128 v[228:231],v17 offset:52224
v_fma_f32 v89,v89,v123,v123
v_mfma_f32_16x16x32_bf16 v[68:71],a[76:79],v[236:239],v[68:71]
v_fma_f32 v90,v90,v123,v123
v_fma_f32 v91,v91,v123,v123
v_mfma_f32_16x16x32_bf16 v[76:79],a[204:207],v[236:239],v[76:79]
ds_read_b128 v[232:235],v17 offset:54272
s_waitcnt lgkmcnt(5)
v_mfma_f32_16x16x32_bf16 v[68:71],a[80:83],v[240:243],v[68:71]
v_min3_u32 v27,v27,v240,v244
v_rcp_f32 v95,v95
v_mfma_f32_16x16x32_bf16 v[76:79],a[208:211],v[240:243],v[76:79]
ds_read_b128 v[236:239],v17 offset:56320
v_mul_f32 v92,v92,v72
v_mfma_f32_16x16x32_bf16 v[68:71],a[84:87],v[244:247],v[68:71]
v_rcp_f32 v88,v88
v_mfma_f32_16x16x32_bf16 v[76:79],a[212:215],v[244:247],v[76:79]
ds_read_b128 v[240:243],v17 offset:58368
s_waitcnt lgkmcnt(5)
v_mfma_f32_16x16x32_bf16 v[68:71],a[88:91],v[248:251],v[68:71]
v_min3_u32 v27,v27,v248,v252
v_mul_f32 v93,v93,v73
v_mfma_f32_16x16x32_bf16 v[76:79],a[216:219],v[248:251],v[76:79]
ds_read_b128 v[244:247],v17 offset:60416
v_mul_f32 v94,v94,v74
v_mfma_f32_16x16x32_bf16 v[68:71],a[92:95],v[252:255],v[68:71]
v_rcp_f32 v89,v89
v_mfma_f32_16x16x32_bf16 v[76:79],a[220:223],v[252:255],v[76:79]
ds_read_b128 v[248:251],v17 offset:62464
s_waitcnt lgkmcnt(5)
v_mfma_f32_16x16x32_bf16 v[68:71],a[96:99],v[224:227],v[68:71]
v_min3_u32 v27,v27,v224,v228
v_mul_f32 v95,v95,v75
v_mfma_f32_16x16x32_bf16 v[76:79],a[224:227],v[224:227],v[76:79]
ds_read_b128 v[252:255],v17 offset:64512
v_mfma_f32_16x16x32_bf16 v[68:71],a[100:103],v[228:231],v[68:71]
v_rcp_f32 v90,v90
v_mfma_f32_16x16x32_bf16 v[76:79],a[228:231],v[228:231],v[76:79]
s_waitcnt lgkmcnt(4)
v_mfma_f32_16x16x32_bf16 v[68:71],a[104:107],v[232:235],v[68:71]
v_min3_u32 v27,v27,v232,v236
v_mfma_f32_16x16x32_bf16 v[76:79],a[232:235],v[232:235],v[76:79]
v_rcp_f32 v91,v91
v_mfma_f32_16x16x32_bf16 v[68:71],a[108:111],v[236:239],v[68:71]
v_mul_f32 v88,v88,v64
v_mul_f32 v89,v89,v65
v_mfma_f32_16x16x32_bf16 v[76:79],a[236:239],v[236:239],v[76:79]
v_mul_f32 v90,v90,v66
s_waitcnt lgkmcnt(2)
v_mfma_f32_16x16x32_bf16 v[68:71],a[112:115],v[240:243],v[68:71]
v_min3_u32 v27,v27,v240,v244
v_mul_f32 v91,v91,v67
v_mfma_f32_16x16x32_bf16 v[76:79],a[240:243],v[240:243],v[76:79]
v_cvt_pk_bf16_f32 v96,v88,v89
v_cvt_pk_bf16_f32 v97,v90,v91
v_mfma_f32_16x16x32_bf16 v[68:71],a[116:119],v[244:247],v[68:71]
v_cvt_pk_bf16_f32 v98,v92,v93
v_cvt_pk_bf16_f32 v99,v94,v95
v_mfma_f32_16x16x32_bf16 v[76:79],a[244:247],v[244:247],v[76:79]
v_max_u32 v96,1,v96
s_waitcnt lgkmcnt(0)
v_mfma_f32_16x16x32_bf16 v[68:71],a[120:123],v[248:251],v[68:71]
v_min3_u32 v27,v27,v248,v252
v_mfma_f32_16x16x32_bf16 v[76:79],a[248:251],v[248:251],v[76:79]
buffer_store_dwordx4 v[96:99],v18,s[20:23],s70 offen offset:0 sc1
v_mfma_f32_16x16x32_bf16 v[68:71],a[124:127],v[252:255],v[68:71]
v_mfma_f32_16x16x32_bf16 v[76:79],a[252:255],v[252:255],v[76:79]
v_cmp_eq_u32 vcc,0,v27
s_cbranch_vccnz retry_339
epi_342:
buffer_load_dword v29,v21,s[20:23],s87 offen sc1
s_nop 3
v_pk_fma_f32 v[68:69],v[52:53],v[124:125],v[68:69] op_sel_hi:[1,0,1]
v_pk_fma_f32 v[70:71],v[54:55],v[124:125],v[70:71] op_sel_hi:[1,0,1]
v_pk_fma_f32 v[76:77],v[56:57],v[124:125],v[76:77] op_sel_hi:[1,0,1]
v_pk_fma_f32 v[78:79],v[58:59],v[124:125],v[78:79] op_sel_hi:[1,0,1]
v_pk_mul_f32 v[88:89],v[68:69],v[68:69]
v_pk_mul_f32 v[90:91],v[70:71],v[70:71]
v_pk_mul_f32 v[92:93],v[76:77],v[76:77]
v_pk_mul_f32 v[94:95],v[78:79],v[78:79]
v_pk_fma_f32 v[88:89],v[88:89],v[124:125],v[126:127] op_sel:[0,1,0] op_sel_hi:[1,1,0]
v_pk_fma_f32 v[90:91],v[90:91],v[124:125],v[126:127] op_sel:[0,1,0] op_sel_hi:[1,1,0]
v_pk_fma_f32 v[92:93],v[92:93],v[124:125],v[126:127] op_sel:[0,1,0] op_sel_hi:[1,1,0]
v_pk_fma_f32 v[94:95],v[94:95],v[124:125],v[126:127] op_sel:[0,1,0] op_sel_hi:[1,1,0]
v_pk_mul_f32 v[88:89],v[88:89],v[68:69]
v_pk_mul_f32 v[90:91],v[90:91],v[70:71]
v_pk_mul_f32 v[92:93],v[92:93],v[76:77]
v_pk_mul_f32 v[94:95],v[94:95],v[78:79]
v_exp_f32 v88,v88
v_exp_f32 v89,v89
v_exp_f32 v90,v90
v_exp_f32 v91,v91
v_exp_f32 v92,v92
v_exp_f32 v93,v93
v_exp_f32 v94,v94
s_cmp_gt_u32 s71,51
s_cselect_b32 s65,s73,0x7fff0000
s_cselect_b32 s97,0x7fff0000,s73
v_mov_b32 v22,s71
buffer_store_dword v22,v23,s[20:23],s65 offen sc1
v_exp_f32 v95,v95
v_pk_fma_f32 v[88:89],v[88:89],v[126:127],v[126:127] op_sel:[0,1,1] op_sel_hi:[1,1,1]
v_pk_fma_f32 v[90:91],v[90:91],v[126:127],v[126:127] op_sel:[0,1,1] op_sel_hi:[1,1,1]
v_pk_fma_f32 v[92:93],v[92:93],v[126:127],v[126:127] op_sel:[0,1,1] op_sel_hi:[1,1,1]
v_pk_fma_f32 v[94:95],v[94:95],v[126:127],v[126:127] op_sel:[0,1,1] op_sel_hi:[1,1,1]
v_rcp_f32 v88,v88
v_rcp_f32 v89,v89
v_rcp_f32 v90,v90
v_rcp_f32 v91,v91
v_rcp_f32 v92,v92
v_rcp_f32 v93,v93
v_rcp_f32 v94,v94
v_rcp_f32 v95,v95
v_pk_mul_f32 v[88:89],v[88:89],v[68:69]
v_pk_mul_f32 v[90:91],v[90:91],v[70:71]
v_pk_mul_f32 v[92:93],v[92:93],v[76:77]
v_pk_mul_f32 v[94:95],v[94:95],v[78:79]
v_cvt_pk_bf16_f32 v96,v88,v89
v_cvt_pk_bf16_f32 v97,v90,v91
v_cvt_pk_bf16_f32 v98,v92,v93
v_cvt_pk_bf16_f32 v99,v94,v95
v_max_u32 v96,1,v96
buffer_store_dwordx4 v[96:99],v18,s[20:23],s70 offen offset:1024 sc1
v_xor_b32 v17,0x10000,v17
s_xor_b32 s72,s72,0x10000
s_add_u32 s70,s70,2097152
s_xor_b32 s70,s70,0x2000
s_add_u32 s71,s71,1
s_cmp_le_u32 s71,s57
s_cbranch_scc1 seg_340
s_endpgm
retry_339:
s_sub_u32 s90,s90,64
s_cmp_lt_i32 s90,0
s_cbranch_scc1 giveup_197
s_mov_b32 s83,1
s_waitcnt vmcnt(0) lgkmcnt(0)
s_barrier
s_branch seg_340
w3b_338:
s_add_u32 s64,s79,0
s_lshl_b32 s70,s64,21
s_lshl_b32 s64,s64,13
s_and_b32 s64,s64,0x2000
s_xor_b32 s64,s64,s62
s_add_u32 s70,s70,s64
s_add_u32 s70,s70,29360128
s_mov_b32 s83,1
s_mov_b32 s87,s74
s_cmp_eq_u32 s50,0
s_cselect_b32 s74,s74,0x7fff0000
v_mov_b32 v47,132096
s_lshl_b32 s64,s50,3
s_add_u32 s64,s64,132096
v_mov_b32 v46,s64
v_mov_b32 v29,0
s_mov_b32 s97,0x7fff0000
seg_352:
s_cmp_eq_u32 s83,0
s_cbranch_scc1 ahead_353
s_add_u32 s94,s70,s75
s_xor_b32 s95,s94,1024
s_xor_b32 s91,s72,0x10000
s_waitcnt vmcnt(2)
v_cmp_gt_u32 vcc,s71,v29
s_cbranch_vccz nb_356
s_waitcnt vmcnt(0)
v_add_u32 v22,s71,-1
buffer_store_dword v22,v23,s[20:23],s97 offen sc1
s_mov_b32 s97,0x7fff0000
s_cmp_lg_u32 s50,0
s_cbranch_scc1 nb_356
buffer_load_dword v32,v21,s[20:23],s74 offen sc1
s_sleep 2
pl_357:
buffer_load_dword v33,v21,s[20:23],s74 offen sc1
s_waitcnt vmcnt(1)
v_cmp_gt_u32 vcc,s71,v32
v_mov_b32 v29,v32
s_cbranch_vccz pok_358
buffer_load_dword v32,v21,s[20:23],s74 offen sc1
s_waitcnt vmcnt(1)
v_cmp_gt_u32 vcc,s71,v33
v_mov_b32 v29,v33
s_cbranch_vccz pok_358
s_sub_u32 s90,s90,1
s_cmp_gt_i32 s90,0
s_cbranch_scc1 pl_357
pok_358:
nb_356:
s_barrier
s_xor_b32 m0,s91,0
s_add_u32 s65,s94,0
buffer_load_dwordx4 v16,s[20:23],s65 offen offset:0 sc1 lds
buffer_load_dwordx4 v16,s[20:23],s65 offen offset:2048 sc1 lds
s_xor_b32 m0,s91,16384
s_add_u32 s65,s94,32768
buffer_load_dwordx4 v16,s[20:23],s65 offen offset:0 sc1 lds
buffer_load_dwordx4 v16,s[20:23],s65 offen offset:2048 sc1 lds
s_xor_b32 m0,s91,32768
s_add_u32 s65,s94,65536
buffer_load_dwordx4 v16,s[20:23],s65 offen offset:0 sc1 lds
buffer_load_dwordx4 v16,s[20:23],s65 offen offset:2048 sc1 lds
s_xor_b32 m0,s91,49152
s_add_u32 s65,s94,98304
buffer_load_dwordx4 v16,s[20:23],s65 offen offset:0 sc1 lds
buffer_load_dwordx4 v16,s[20:23],s65 offen offset:2048 sc1 lds
s_add_u32 s66,s94,110592
buffer_load_dwordx4 v[128:131],v16,s[20:23],s66 offen offset:0 sc1
buffer_load_dwordx4 v[132:135],v16,s[20:23],s66 offen offset:1024 sc1
buffer_load_dwordx4 v[136:139],v16,s[20:23],s66 offen offset:2048 sc1
buffer_load_dwordx4 v[140:143],v16,s[20:23],s66 offen offset:3072 sc1
s_add_u32 s66,s94,114688
buffer_load_dwordx4 v[144:147],v16,s[20:23],s66 offen offset:0 sc1
buffer_load_dwordx4 v[148:151],v16,s[20:23],s66 offen offset:1024 sc1
buffer_load_dwordx4 v[152:155],v16,s[20:23],s66 offen offset:2048 sc1
buffer_load_dwordx4 v[156:159],v16,s[20:23],s66 offen offset:3072 sc1
s_waitcnt vmcnt(16)
v_add_u32 v22,s71,-1
buffer_store_dword v22,v23,s[20:23],s97 offen sc1
s_mov_b32 s97,0x7fff0000
s_waitcnt vmcnt(15)
s_barrier
ds_read_b128 v[224:227],v17 offset:0
ds_read_b128 v[228:231],v17 offset:2048
ds_read_b128 v[232:235],v17 offset:4096
ds_read_b128 v[236:239],v17 offset:6144
ds_read_b128 v[240:243],v17 offset:8192
ds_read_b128 v[244:247],v17 offset:10240
ds_read_b128 v[248:251],v17 offset:12288
s_waitcnt lgkmcnt(5)
v_mfma_f32_16x16x32_bf16 v[64:67],a[0:3],v[224:227],0
ds_read_b128 v[252:255],v17 offset:14336
s_xor_b32 m0,s91,1024
s_add_u32 s65,s95,0
buffer_load_dwordx4 v16,s[20:23],s65 offen offset:0 sc1 lds
buffer_load_dwordx4 v16,s[20:23],s65 offen offset:2048 sc1 lds
v_min_u32 v27,v224,v228
v_mfma_f32_16x16x32_bf16 v[72:75],a[4:7],v[228:231],0
s_waitcnt vmcnt(15)
s_barrier
ds_read_b128 v[224:227],v17 offset:16384
s_xor_b32 m0,s91,17408
s_add_u32 s65,s95,32768
s_waitcnt lgkmcnt(5)
v_mfma_f32_16x16x32_bf16 v[64:67],a[8:11],v[232:235],v[64:67]
ds_read_b128 v[228:231],v17 offset:18432
buffer_load_dwordx4 v16,s[20:23],s65 offen offset:0 sc1 lds
buffer_load_dwordx4 v16,s[20:23],s65 offen offset:2048 sc1 lds
s_xor_b32 m0,s91,33792
v_min3_u32 v27,v27,v232,v236
v_mfma_f32_16x16x32_bf16 v[72:75],a[12:15],v[236:239],v[72:75]
ds_read_b128 v[232:235],v17 offset:20480
s_add_u32 s65,s95,65536
buffer_load_dwordx4 v16,s[20:23],s65 offen offset:0 sc1 lds
s_waitcnt lgkmcnt(5)
v_mfma_f32_16x16x32_bf16 v[64:67],a[16:19],v[240:243],v[64:67]
ds_read_b128 v[236:239],v17 offset:22528
buffer_load_dwordx4 v16,s[20:23],s65 offen offset:2048 sc1 lds
s_xor_b32 m0,s91,50176
s_add_u32 s65,s95,98304
v_min3_u32 v27,v27,v240,v244
v_mfma_f32_16x16x32_bf16 v[72:75],a[20:23],v[244:247],v[72:75]
ds_read_b128 v[240:243],v17 offset:24576
buffer_load_dwordx4 v16,s[20:23],s65 offen offset:0 sc1 lds
buffer_load_dwordx4 v16,s[20:23],s65 offen offset:2048 sc1 lds
s_waitcnt lgkmcnt(5)
v_mfma_f32_16x16x32_bf16 v[64:67],a[24:27],v[248:251],v[64:67]
ds_read_b128 v[244:247],v17 offset:26624
v_min3_u32 v27,v27,v248,v252
v_mfma_f32_16x16x32_bf16 v[72:75],a[28:31],v[252:255],v[72:75]
ds_read_b128 v[248:251],v17 offset:28672
s_waitcnt lgkmcnt(5)
v_mfma_f32_16x16x32_bf16 v[64:67],a[32:35],v[224:227],v[64:67]
ds_read_b128 v[252:255],v17 offset:30720
v_min3_u32 v27,v27,v224,v228
v_mfma_f32_16x16x32_bf16 v[72:75],a[36:39],v[228:231],v[72:75]
s_waitcnt vmcnt(17)
s_barrier
ds_read_b128 v[224:227],v17 offset:32768
s_waitcnt lgkmcnt(5)
v_mfma_f32_16x16x32_bf16 v[64:67],a[40:43],v[232:235],v[64:67]
ds_read_b128 v[228:231],v17 offset:34816
v_min3_u32 v27,v27,v232,v236
v_mfma_f32_16x16x32_bf16 v[72:75],a[44:47],v[236:239],v[72:75]
ds_read_b128 v[232:235],v17 offset:36864
s_waitcnt lgkmcnt(5)
v_mfma_f32_16x16x32_bf16 v[64:67],a[48:51],v[240:243],v[64:67]
ds_read_b128 v[236:239],v17 offset:38912
v_min3_u32 v27,v27,v240,v244
v_mfma_f32_16x16x32_bf16 v[72:75],a[52:55],v[244:247],v[72:75]
ds_read_b128 v[240:243],v17 offset:40960
s_add_u32 s88,s70,s75
s_add_u32 s88,s88,2097152
s_xor_b32 s88,s88,0x2000
s_xor_b32 s89,s88,1024
s_waitcnt lgkmcnt(5)
v_mfma_f32_16x16x32_bf16 v[64:67],a[56:59],v[248:251],v[64:67]
ds_read_b128 v[244:247],v17 offset:43008
v_min3_u32 v27,v27,v248,v252
v_mfma_f32_16x16x32_bf16 v[72:75],a[60:63],v[252:255],v[72:75]
ds_read_b128 v[248:251],v17 offset:45056
s_waitcnt lgkmcnt(5)
v_mfma_f32_16x16x32_bf16 v[64:67],a[64:67],v[224:227],v[64:67]
ds_read_b128 v[252:255],v17 offset:47104
v_min3_u32 v27,v27,v224,v228
v_mfma_f32_16x16x32_bf16 v[72:75],a[68:71],v[228:231],v[72:75]
ds_read_b128 v[224:227],v17 offset:49152
s_waitcnt lgkmcnt(5)
v_mfma_f32_16x16x32_bf16 v[64:67],a[72:75],v[232:235],v[64:67]
ds_read_b128 v[228:231],v17 offset:51200
v_min3_u32 v27,v27,v232,v236
v_mfma_f32_16x16x32_bf16 v[72:75],a[76:79],v[236:239],v[72:75]
ds_read_b128 v[232:235],v17 offset:53248
s_waitcnt lgkmcnt(5)
v_mfma_f32_16x16x32_bf16 v[64:67],a[80:83],v[240:243],v[64:67]
ds_read_b128 v[236:239],v17 offset:55296
v_min3_u32 v27,v27,v240,v244
v_mfma_f32_16x16x32_bf16 v[72:75],a[84:87],v[244:247],v[72:75]
ds_read_b128 v[240:243],v17 offset:57344
s_waitcnt lgkmcnt(5)
v_mfma_f32_16x16x32_bf16 v[64:67],a[88:91],v[248:251],v[64:67]
ds_read_b128 v[244:247],v17 offset:59392
v_min3_u32 v27,v27,v248,v252
v_mfma_f32_16x16x32_bf16 v[72:75],a[92:95],v[252:255],v[72:75]
ds_read_b128 v[248:251],v17 offset:61440
s_waitcnt vmcnt(9)
stk_363:
v_min3_u32 v22,v129,v133,v137
v_min3_u32 v22,v22,v141,v145
v_min3_u32 v22,v22,v149,v153
v_min_u32 v22,v22,v157
v_cmp_eq_u32 vcc,0,v22
s_cmp_lt_i32 s90,0
s_cselect_b64 vcc,0,vcc
s_cbranch_vccnz str_364
v_pk_add_f32 v[88:89],v[128:129],v[144:145]
v_pk_add_f32 v[90:91],v[130:131],v[146:147]
v_pk_add_f32 v[92:93],v[132:133],v[148:149]
v_pk_add_f32 v[94:95],v[134:135],v[150:151]
v_pk_add_f32 v[96:97],v[136:137],v[152:153]
v_pk_add_f32 v[98:99],v[138:139],v[154:155]
v_pk_add_f32 v[100:101],v[140:141],v[156:157]
v_pk_add_f32 v[102:103],v[142:143],v[158:159]
v_pk_add_f32 v[88:89],v[88:89],v[96:97]
v_pk_add_f32 v[90:91],v[90:91],v[98:99]
v_pk_add_f32 v[92:93],v[92:93],v[100:101]
v_pk_add_f32 v[94:95],v[94:95],v[102:103]
v_pk_add_f32 v[88:89],v[88:89],v[92:93]
v_pk_add_f32 v[90:91],v[90:91],v[94:95]
v_mov_b32 v92,v88
v_mov_b32 v93,v89
v_mov_b32 v94,v90
v_mov_b32 v95,v91
v_permlane16_swap_b32 v92,v88
v_permlane16_swap_b32 v93,v89
v_permlane16_swap_b32 v94,v90
v_permlane16_swap_b32 v95,v91
v_pk_add_f32 v[88:89],v[88:89],v[92:93]
v_pk_add_f32 v[90:91],v[90:91],v[94:95]
v_mov_b32 v92,v88
v_mov_b32 v93,v89
s_waitcnt lgkmcnt(5)
v_mfma_f32_16x16x32_bf16 v[64:67],a[96:99],v[224:227],v[64:67]
ds_read_b128 v[252:255],v17 offset:63488
v_min3_u32 v27,v27,v224,v228
v_mov_b32 v94,v90
v_mov_b32 v95,v91
v_permlane32_swap_b32 v92,v88
v_permlane32_swap_b32 v93,v89
v_permlane32_swap_b32 v94,v90
v_permlane32_swap_b32 v95,v91
v_pk_add_f32 v[88:89],v[88:89],v[92:93]
v_pk_add_f32 v[90:91],v[90:91],v[94:95]
v_mul_f32 v120,0xba800000,v88
v_mul_f32 v124,0xba800000,v90
v_mul_f32 v92,v120,v120
v_mul_f32 v93,v124,v124
v_fma_f32 v92,v89,s82,-v92
v_fma_f32 v93,v91,s82,-v93
v_max_f32 v92,0,v92
v_max_f32 v93,0,v93
v_add_f32 v92,0x3727c5ac,v92
v_add_f32 v93,0x3727c5ac,v93
v_rsq_f32 v94,v92
v_rsq_f32 v95,v93
v_mul_f32 v123,v92,v94
v_mul_f32 v127,v93,v95
v_mul_f32 v122,v28,v94
v_mul_f32 v126,v28,v95
v_mul_f32 v92,v94,v94
v_mul_f32 v93,v95,v95
v_mul_f32 v94,s81,v94
v_mul_f32 v95,s81,v95
v_mul_f32 v121,v92,v94
v_mul_f32 v125,v93,v95
ds_write_b128 v19,v[120:123] offset:0
ds_write_b128 v19,v[124:127] offset:256
v_mfma_f32_16x16x32_bf16 v[72:75],a[100:103],v[228:231],v[72:75]
s_waitcnt vmcnt(4) lgkmcnt(0)
s_barrier
ds_read_b64 v[44:45],v47
ds_read_b128 v[224:227],v17 offset:1024
v_mfma_f32_16x16x32_bf16 v[64:67],a[104:107],v[232:235],v[64:67]
ds_read_b128 v[228:231],v17 offset:3072
v_min3_u32 v27,v27,v232,v236
v_mfma_f32_16x16x32_bf16 v[72:75],a[108:111],v[236:239],v[72:75]
ds_read_b128 v[232:235],v17 offset:5120
v_mfma_f32_16x16x32_bf16 v[64:67],a[112:115],v[240:243],v[64:67]
ds_read_b128 v[236:239],v17 offset:7168
v_min3_u32 v27,v27,v240,v244
v_mfma_f32_16x16x32_bf16 v[72:75],a[116:119],v[244:247],v[72:75]
ds_read_b128 v[240:243],v17 offset:9216
s_waitcnt lgkmcnt(5)
v_readfirstlane_b32 s93,v45
v_mfma_f32_16x16x32_bf16 v[64:67],a[120:123],v[248:251],v[64:67]
ds_read_b128 v[244:247],v17 offset:11264
v_readfirstlane_b32 s83,v44
s_cmp_lg_u32 s83,0
s_cbranch_scc0 keep_359
v_min3_u32 v27,v27,v248,v252
v_mfma_f32_16x16x32_bf16 v[72:75],a[124:127],v[252:255],v[72:75]
ds_read_b128 v[248:251],v17 offset:13312
s_waitcnt lgkmcnt(5)
v_mfma_f32_16x16x32_bf16 v[68:71],a[0:3],v[224:227],0
ds_read_b128 v[252:255],v17 offset:15360
v_cmp_eq_u32 vcc,0,v27
s_cbranch_vccnz retry_351
v_min3_u32 v27,v27,v224,v228
v_mfma_f32_16x16x32_bf16 v[76:79],a[4:7],v[228:231],0
ds_read_b128 v[224:227],v17 offset:17408
s_waitcnt lgkmcnt(5)
v_mfma_f32_16x16x32_bf16 v[68:71],a[8:11],v[232:235],v[68:71]
ds_read_b128 v[228:231],v17 offset:19456
v_min3_u32 v27,v27,v232,v236
v_mfma_f32_16x16x32_bf16 v[76:79],a[12:15],v[236:239],v[76:79]
ds_read_b128 v[232:235],v17 offset:21504
s_waitcnt lgkmcnt(5)
v_mfma_f32_16x16x32_bf16 v[68:71],a[16:19],v[240:243],v[68:71]
ds_read_b128 v[236:239],v17 offset:23552
v_min3_u32 v27,v27,v240,v244
v_add_f32 v64,v64,v72
v_add_f32 v65,v65,v73
v_add_f32 v66,v66,v74
v_add_f32 v67,v67,v75
v_mfma_f32_16x16x32_bf16 v[76:79],a[20:23],v[244:247],v[76:79]
ds_read_b128 v[240:243],v17 offset:25600
v_fmac_f32 v64,v52,v120
v_fmac_f32 v65,v53,v120
v_fmac_f32 v66,v54,v120
v_fmac_f32 v67,v55,v120
s_waitcnt lgkmcnt(5)
v_mfma_f32_16x16x32_bf16 v[68:71],a[24:27],v[248:251],v[68:71]
ds_read_b128 v[244:247],v17 offset:27648
v_min3_u32 v27,v27,v248,v252
v_mul_f32 v88,v64,v64
v_mul_f32 v89,v65,v65
v_mul_f32 v90,v66,v66
v_mul_f32 v91,v67,v67
v_mfma_f32_16x16x32_bf16 v[76:79],a[28:31],v[252:255],v[76:79]
ds_read_b128 v[248:251],v17 offset:29696
v_fma_f32 v88,v88,v121,v122
v_fma_f32 v89,v89,v121,v122
v_fma_f32 v90,v90,v121,v122
v_fma_f32 v91,v91,v121,v122
s_waitcnt lgkmcnt(5)
v_mfma_f32_16x16x32_bf16 v[68:71],a[32:35],v[224:227],v[68:71]
ds_read_b128 v[252:255],v17 offset:31744
v_min3_u32 v27,v27,v224,v228
v_mul_f32 v88,v88,v64
v_mul_f32 v89,v89,v65
v_mul_f32 v90,v90,v66
v_mul_f32 v91,v91,v67
v_mfma_f32_16x16x32_bf16 v[76:79],a[36:39],v[228:231],v[76:79]
s_waitcnt vmcnt(0)
s_barrier
ds_read_b128 v[224:227],v17 offset:33792
v_exp_f32 v88,v88
s_waitcnt lgkmcnt(5)
v_mfma_f32_16x16x32_bf16 v[68:71],a[40:43],v[232:235],v[68:71]
ds_read_b128 v[228:231],v17 offset:35840
v_min3_u32 v27,v27,v232,v236
v_exp_f32 v89,v89
v_exp_f32 v90,v90
v_mfma_f32_16x16x32_bf16 v[76:79],a[44:47],v[236:239],v[76:79]
ds_read_b128 v[232:235],v17 offset:37888
v_exp_f32 v91,v91
v_fma_f32 v88,v88,v123,v123
v_fma_f32 v89,v89,v123,v123
s_waitcnt lgkmcnt(5)
v_mfma_f32_16x16x32_bf16 v[68:71],a[48:51],v[240:243],v[68:71]
ds_read_b128 v[236:239],v17 offset:39936
v_min3_u32 v27,v27,v240,v244
v_fma_f32 v90,v90,v123,v123
v_fma_f32 v91,v91,v123,v123
v_rcp_f32 v88,v88
v_mfma_f32_16x16x32_bf16 v[76:79],a[52:55],v[244:247],v[76:79]
ds_read_b128 v[240:243],v17 offset:41984
v_rcp_f32 v89,v89
v_rcp_f32 v90,v90
s_waitcnt lgkmcnt(5)
v_mfma_f32_16x16x32_bf16 v[68:71],a[56:59],v[248:251],v[68:71]
ds_read_b128 v[244:247],v17 offset:44032
v_min3_u32 v27,v27,v248,v252
v_rcp_f32 v91,v91
v_mul_f32 v88,v88,v64
v_mul_f32 v89,v89,v65
v_mfma_f32_16x16x32_bf16 v[76:79],a[60:63],v[252:255],v[76:79]
ds_read_b128 v[248:251],v17 offset:46080
v_mul_f32 v90,v90,v66
v_mul_f32 v91,v91,v67
v_cvt_pk_bf16_f32 v96,v88,v89
v_cvt_pk_bf16_f32 v97,v90,v91
s_waitcnt lgkmcnt(5)
v_mfma_f32_16x16x32_bf16 v[68:71],a[64:67],v[224:227],v[68:71]
ds_read_b128 v[252:255],v17 offset:48128
v_min3_u32 v27,v27,v224,v228
v_max_u32 v96,1,v96
buffer_store_dwordx2 v[96:97],v18,s[20:23],s70 offen offset:0 sc1
v_mfma_f32_16x16x32_bf16 v[76:79],a[68:71],v[228:231],v[76:79]
ds_read_b128 v[224:227],v17 offset:50176
s_waitcnt lgkmcnt(5)
v_mfma_f32_16x16x32_bf16 v[68:71],a[72:75],v[232:235],v[68:71]
ds_read_b128 v[228:231],v17 offset:52224
v_min3_u32 v27,v27,v232,v236
v_mfma_f32_16x16x32_bf16 v[76:79],a[76:79],v[236:239],v[76:79]
ds_read_b128 v[232:235],v17 offset:54272
s_waitcnt lgkmcnt(5)
v_mfma_f32_16x16x32_bf16 v[68:71],a[80:83],v[240:243],v[68:71]
ds_read_b128 v[236:239],v17 offset:56320
v_min3_u32 v27,v27,v240,v244
v_mfma_f32_16x16x32_bf16 v[76:79],a[84:87],v[244:247],v[76:79]
ds_read_b128 v[240:243],v17 offset:58368
s_waitcnt lgkmcnt(5)
v_mfma_f32_16x16x32_bf16 v[68:71],a[88:91],v[248:251],v[68:71]
ds_read_b128 v[244:247],v17 offset:60416
v_min3_u32 v27,v27,v248,v252
v_mfma_f32_16x16x32_bf16 v[76:79],a[92:95],v[252:255],v[76:79]
ds_read_b128 v[248:251],v17 offset:62464
s_waitcnt lgkmcnt(5)
v_mfma_f32_16x16x32_bf16 v[68:71],a[96:99],v[224:227],v[68:71]
ds_read_b128 v[252:255],v17 offset:64512
v_min3_u32 v27,v27,v224,v228
v_mfma_f32_16x16x32_bf16 v[76:79],a[100:103],v[228:231],v[76:79]
s_waitcnt lgkmcnt(4)
v_mfma_f32_16x16x32_bf16 v[68:71],a[104:107],v[232:235],v[68:71]
v_min3_u32 v27,v27,v232,v236
v_mfma_f32_16x16x32_bf16 v[76:79],a[108:111],v[236:239],v[76:79]
s_waitcnt lgkmcnt(2)
v_mfma_f32_16x16x32_bf16 v[68:71],a[112:115],v[240:243],v[68:71]
v_min3_u32 v27,v27,v240,v244
v_mfma_f32_16x16x32_bf16 v[76:79],a[116:119],v[244:247],v[76:79]
s_waitcnt lgkmcnt(0)
v_mfma_f32_16x16x32_bf16 v[68:71],a[120:123],v[248:251],v[68:71]
v_min3_u32 v27,v27,v248,v252
v_mfma_f32_16x16x32_bf16 v[76:79],a[124:127],v[252:255],v[76:79]
v_cmp_eq_u32 vcc,0,v27
s_cbranch_vccnz retry_351
s_branch epi_354
keep_359:
v_min3_u32 v27,v27,v248,v252
v_mfma_f32_16x16x32_bf16 v[72:75],a[124:127],v[252:255],v[72:75]
ds_read_b128 v[248:251],v17 offset:13312
s_add_u32 s66,s88,110592
buffer_load_dwordx4 v[128:131],v16,s[20:23],s66 offen offset:0 sc1
buffer_load_dwordx4 v[132:135],v16,s[20:23],s66 offen offset:1024 sc1
s_waitcnt lgkmcnt(5)
v_mfma_f32_16x16x32_bf16 v[68:71],a[0:3],v[224:227],0
ds_read_b128 v[252:255],v17 offset:15360
v_cmp_eq_u32 vcc,0,v27
s_cbranch_vccnz retry_351
v_min3_u32 v27,v27,v224,v228
buffer_load_dwordx4 v[136:139],v16,s[20:23],s66 offen offset:2048 sc1
v_mfma_f32_16x16x32_bf16 v[76:79],a[4:7],v[228:231],0
ds_read_b128 v[224:227],v17 offset:17408
buffer_load_dwordx4 v[140:143],v16,s[20:23],s66 offen offset:3072 sc1
s_add_u32 s66,s88,114688
buffer_load_dwordx4 v[144:147],v16,s[20:23],s66 offen offset:0 sc1
s_waitcnt lgkmcnt(5)
v_mfma_f32_16x16x32_bf16 v[68:71],a[8:11],v[232:235],v[68:71]
ds_read_b128 v[228:231],v17 offset:19456
v_min3_u32 v27,v27,v232,v236
buffer_load_dwordx4 v[148:151],v16,s[20:23],s66 offen offset:1024 sc1
buffer_load_dwordx4 v[152:155],v16,s[20:23],s66 offen offset:2048 sc1
v_mfma_f32_16x16x32_bf16 v[76:79],a[12:15],v[236:239],v[76:79]
ds_read_b128 v[232:235],v17 offset:21504
buffer_load_dwordx4 v[156:159],v16,s[20:23],s66 offen offset:3072 sc1
s_waitcnt lgkmcnt(5)
v_mfma_f32_16x16x32_bf16 v[68:71],a[16:19],v[240:243],v[68:71]
ds_read_b128 v[236:239],v17 offset:23552
v_min3_u32 v27,v27,v240,v244
v_add_f32 v64,v64,v72
v_add_f32 v65,v65,v73
v_add_f32 v66,v66,v74
v_add_f32 v67,v67,v75
s_xor_b32 m0,s72,0
v_mfma_f32_16x16x32_bf16 v[76:79],a[20:23],v[244:247],v[76:79]
ds_read_b128 v[240:243],v17 offset:25600
v_fmac_f32 v64,v52,v120
v_fmac_f32 v65,v53,v120
v_fmac_f32 v66,v54,v120
v_fmac_f32 v67,v55,v120
s_add_u32 s65,s88,0
s_waitcnt lgkmcnt(5)
v_mfma_f32_16x16x32_bf16 v[68:71],a[24:27],v[248:251],v[68:71]
ds_read_b128 v[244:247],v17 offset:27648
v_min3_u32 v27,v27,v248,v252
v_mul_f32 v88,v64,v64
v_mul_f32 v89,v65,v65
v_mul_f32 v90,v66,v66
v_mul_f32 v91,v67,v67
v_mfma_f32_16x16x32_bf16 v[76:79],a[28:31],v[252:255],v[76:79]
ds_read_b128 v[248:251],v17 offset:29696
v_fma_f32 v88,v88,v121,v122
v_fma_f32 v89,v89,v121,v122
v_fma_f32 v90,v90,v121,v122
v_fma_f32 v91,v91,v121,v122
s_waitcnt lgkmcnt(5)
v_mfma_f32_16x16x32_bf16 v[68:71],a[32:35],v[224:227],v[68:71]
ds_read_b128 v[252:255],v17 offset:31744
v_min3_u32 v27,v27,v224,v228
v_mul_f32 v88,v88,v64
v_mul_f32 v89,v89,v65
v_mul_f32 v90,v90,v66
v_mul_f32 v91,v91,v67
v_mfma_f32_16x16x32_bf16 v[76:79],a[36:39],v[228:231],v[76:79]
s_waitcnt vmcnt(8)
s_barrier
ds_read_b128 v[224:227],v17 offset:33792
v_exp_f32 v88,v88
s_waitcnt lgkmcnt(5)
v_mfma_f32_16x16x32_bf16 v[68:71],a[40:43],v[232:235],v[68:71]
ds_read_b128 v[228:231],v17 offset:35840
v_min3_u32 v27,v27,v232,v236
v_exp_f32 v89,v89
v_exp_f32 v90,v90
v_mfma_f32_16x16x32_bf16 v[76:79],a[44:47],v[236:239],v[76:79]
ds_read_b128 v[232:235],v17 offset:37888
v_exp_f32 v91,v91
v_fma_f32 v88,v88,v123,v123
v_fma_f32 v89,v89,v123,v123
s_waitcnt lgkmcnt(5)
v_mfma_f32_16x16x32_bf16 v[68:71],a[48:51],v[240:243],v[68:71]
ds_read_b128 v[236:239],v17 offset:39936
v_min3_u32 v27,v27,v240,v244
v_fma_f32 v90,v90,v123,v123
v_fma_f32 v91,v91,v123,v123
v_rcp_f32 v88,v88
v_mfma_f32_16x16x32_bf16 v[76:79],a[52:55],v[244:247],v[76:79]
ds_read_b128 v[240:243],v17 offset:41984
v_rcp_f32 v89,v89
v_rcp_f32 v90,v90
s_waitcnt lgkmcnt(5)
v_mfma_f32_16x16x32_bf16 v[68:71],a[56:59],v[248:251],v[68:71]
ds_read_b128 v[244:247],v17 offset:44032
v_min3_u32 v27,v27,v248,v252
v_rcp_f32 v91,v91
v_mul_f32 v88,v88,v64
v_mul_f32 v89,v89,v65
v_mfma_f32_16x16x32_bf16 v[76:79],a[60:63],v[252:255],v[76:79]
ds_read_b128 v[248:251],v17 offset:46080
v_mul_f32 v90,v90,v66
v_mul_f32 v91,v91,v67
v_cvt_pk_bf16_f32 v96,v88,v89
v_cvt_pk_bf16_f32 v97,v90,v91
s_waitcnt lgkmcnt(5)
v_mfma_f32_16x16x32_bf16 v[68:71],a[64:67],v[224:227],v[68:71]
ds_read_b128 v[252:255],v17 offset:48128
v_min3_u32 v27,v27,v224,v228
v_max_u32 v96,1,v96
buffer_store_dwordx2 v[96:97],v18,s[20:23],s70 offen offset:0 sc1
buffer_load_dwordx4 v16,s[20:23],s65 offen offset:0 sc1 lds
v_mfma_f32_16x16x32_bf16 v[76:79],a[68:71],v[228:231],v[76:79]
ds_read_b128 v[224:227],v17 offset:50176
buffer_load_dwordx4 v16,s[20:23],s65 offen offset:2048 sc1 lds
s_xor_b32 m0,s72,16384
s_add_u32 s65,s88,32768
s_waitcnt lgkmcnt(5)
v_mfma_f32_16x16x32_bf16 v[68:71],a[72:75],v[232:235],v[68:71]
ds_read_b128 v[228:231],v17 offset:52224
v_min3_u32 v27,v27,v232,v236
buffer_load_dwordx4 v16,s[20:23],s65 offen offset:0 sc1 lds
buffer_load_dwordx4 v16,s[20:23],s65 offen offset:2048 sc1 lds
s_xor_b32 m0,s72,32768
v_mfma_f32_16x16x32_bf16 v[76:79],a[76:79],v[236:239],v[76:79]
ds_read_b128 v[232:235],v17 offset:54272
s_add_u32 s65,s88,65536
buffer_load_dwordx4 v16,s[20:23],s65 offen offset:0 sc1 lds
buffer_load_dwordx4 v16,s[20:23],s65 offen offset:2048 sc1 lds
s_waitcnt lgkmcnt(5)
v_mfma_f32_16x16x32_bf16 v[68:71],a[80:83],v[240:243],v[68:71]
ds_read_b128 v[236:239],v17 offset:56320
v_min3_u32 v27,v27,v240,v244
s_xor_b32 m0,s72,49152
s_add_u32 s65,s88,98304
buffer_load_dwordx4 v16,s[20:23],s65 offen offset:0 sc1 lds
v_mfma_f32_16x16x32_bf16 v[76:79],a[84:87],v[244:247],v[76:79]
ds_read_b128 v[240:243],v17 offset:58368
buffer_load_dwordx4 v16,s[20:23],s65 offen offset:2048 sc1 lds
s_xor_b32 m0,s72,1024
s_add_u32 s65,s89,0
s_waitcnt lgkmcnt(5)
v_mfma_f32_16x16x32_bf16 v[68:71],a[88:91],v[248:251],v[68:71]
ds_read_b128 v[244:247],v17 offset:60416
v_min3_u32 v27,v27,v248,v252
buffer_load_dwordx4 v16,s[20:23],s65 offen offset:0 sc1 lds
buffer_load_dwordx4 v16,s[20:23],s65 offen offset:2048 sc1 lds
v_mfma_f32_16x16x32_bf16 v[76:79],a[92:95],v[252:255],v[76:79]
ds_read_b128 v[248:251],v17 offset:62464
s_xor_b32 m0,s72,17408
s_add_u32 s65,s89,32768
buffer_load_dwordx4 v16,s[20:23],s65 offen offset:0 sc1 lds
s_waitcnt lgkmcnt(5)
v_mfma_f32_16x16x32_bf16 v[68:71],a[96:99],v[224:227],v[68:71]
ds_read_b128 v[252:255],v17 offset:64512
v_min3_u32 v27,v27,v224,v228
buffer_load_dwordx4 v16,s[20:23],s65 offen offset:2048 sc1 lds
s_xor_b32 m0,s72,33792
s_add_u32 s65,s89,65536
v_mfma_f32_16x16x32_bf16 v[76:79],a[100:103],v[228:231],v[76:79]
buffer_load_dwordx4 v16,s[20:23],s65 offen offset:0 sc1 lds
buffer_load_dwordx4 v16,s[20:23],s65 offen offset:2048 sc1 lds
s_xor_b32 m0,s72,50176
s_waitcnt lgkmcnt(4)
v_mfma_f32_16x16x32_bf16 v[68:71],a[104:107],v[232:235],v[68:71]
v_min3_u32 v27,v27,v232,v236
s_add_u32 s65,s89,98304
buffer_load_dwordx4 v16,s[20:23],s65 offen offset:0 sc1 lds
buffer_load_dwordx4 v16,s[20:23],s65 offen offset:2048 sc1 lds
v_mfma_f32_16x16x32_bf16 v[76:79],a[108:111],v[236:239],v[76:79]
s_waitcnt lgkmcnt(2)
v_mfma_f32_16x16x32_bf16 v[68:71],a[112:115],v[240:243],v[68:71]
v_min3_u32 v27,v27,v240,v244
v_mfma_f32_16x16x32_bf16 v[76:79],a[116:119],v[244:247],v[76:79]
s_waitcnt lgkmcnt(0)
v_mfma_f32_16x16x32_bf16 v[68:71],a[120:123],v[248:251],v[68:71]
v_min3_u32 v27,v27,v248,v252
v_mfma_f32_16x16x32_bf16 v[76:79],a[124:127],v[252:255],v[76:79]
v_cmp_eq_u32 vcc,0,v27
s_cbranch_vccnz retry_351
s_branch epi_354
ahead_353:
s_cmp_eq_u32 s93,0
s_cbranch_scc1 both_355
s_waitcnt vmcnt(11) lgkmcnt(0)
s_barrier
ds_read_b128 v[224:227],v17 offset:0
ds_read_b128 v[228:231],v17 offset:2048
ds_read_b128 v[232:235],v17 offset:4096
ds_read_b128 v[236:239],v17 offset:6144
ds_read_b128 v[240:243],v17 offset:8192
ds_read_b128 v[244:247],v17 offset:10240
ds_read_b128 v[248:251],v17 offset:12288
s_waitcnt lgkmcnt(5)
v_mfma_f32_16x16x32_bf16 v[64:67],a[0:3],v[224:227],0
ds_read_b128 v[252:255],v17 offset:14336
v_min_u32 v27,v224,v228
s_waitcnt vmcnt(12)
stk_365:
v_min3_u32 v22,v129,v133,v137
v_min3_u32 v22,v22,v141,v145
v_min3_u32 v22,v22,v149,v153
v_min_u32 v22,v22,v157
v_cmp_eq_u32 vcc,0,v22
s_cmp_lt_i32 s90,0
s_cselect_b64 vcc,0,vcc
s_cbranch_vccnz str_366
v_mfma_f32_16x16x32_bf16 v[72:75],a[4:7],v[228:231],0
ds_read_b128 v[224:227],v17 offset:16384
v_pk_add_f32 v[88:89],v[128:129],v[144:145]
v_pk_add_f32 v[90:91],v[130:131],v[146:147]
v_pk_add_f32 v[92:93],v[132:133],v[148:149]
v_pk_add_f32 v[94:95],v[134:135],v[150:151]
s_waitcnt lgkmcnt(5)
v_mfma_f32_16x16x32_bf16 v[64:67],a[8:11],v[232:235],v[64:67]
ds_read_b128 v[228:231],v17 offset:18432
v_min3_u32 v27,v27,v232,v236
v_pk_add_f32 v[96:97],v[136:137],v[152:153]
v_pk_add_f32 v[98:99],v[138:139],v[154:155]
v_pk_add_f32 v[100:101],v[140:141],v[156:157]
v_pk_add_f32 v[102:103],v[142:143],v[158:159]
v_mfma_f32_16x16x32_bf16 v[72:75],a[12:15],v[236:239],v[72:75]
ds_read_b128 v[232:235],v17 offset:20480
s_waitcnt lgkmcnt(5)
v_mfma_f32_16x16x32_bf16 v[64:67],a[16:19],v[240:243],v[64:67]
ds_read_b128 v[236:239],v17 offset:22528
v_min3_u32 v27,v27,v240,v244
v_pk_add_f32 v[88:89],v[88:89],v[96:97]
v_pk_add_f32 v[90:91],v[90:91],v[98:99]
v_pk_add_f32 v[92:93],v[92:93],v[100:101]
v_mfma_f32_16x16x32_bf16 v[72:75],a[20:23],v[244:247],v[72:75]
ds_read_b128 v[240:243],v17 offset:24576
v_pk_add_f32 v[94:95],v[94:95],v[102:103]
v_pk_add_f32 v[88:89],v[88:89],v[92:93]
v_pk_add_f32 v[90:91],v[90:91],v[94:95]
s_waitcnt lgkmcnt(5)
v_mfma_f32_16x16x32_bf16 v[64:67],a[24:27],v[248:251],v[64:67]
ds_read_b128 v[244:247],v17 offset:26624
v_min3_u32 v27,v27,v248,v252
v_mov_b32 v92,v88
v_mov_b32 v93,v89
v_mov_b32 v94,v90
v_mfma_f32_16x16x32_bf16 v[72:75],a[28:31],v[252:255],v[72:75]
ds_read_b128 v[248:251],v17 offset:28672
v_mov_b32 v95,v91
v_permlane16_swap_b32 v92,v88
v_permlane16_swap_b32 v93,v89
s_waitcnt lgkmcnt(5)
v_mfma_f32_16x16x32_bf16 v[64:67],a[32:35],v[224:227],v[64:67]
ds_read_b128 v[252:255],v17 offset:30720
v_min3_u32 v27,v27,v224,v228
v_permlane16_swap_b32 v94,v90
v_permlane16_swap_b32 v95,v91
v_mfma_f32_16x16x32_bf16 v[72:75],a[36:39],v[228:231],v[72:75]
ds_read_b128 v[224:227],v17 offset:32768
v_pk_add_f32 v[88:89],v[88:89],v[92:93]
v_pk_add_f32 v[90:91],v[90:91],v[94:95]
v_mov_b32 v92,v88
s_waitcnt lgkmcnt(5)
v_mfma_f32_16x16x32_bf16 v[64:67],a[40:43],v[232:235],v[64:67]
ds_read_b128 v[228:231],v17 offset:34816
v_min3_u32 v27,v27,v232,v236
v_mov_b32 v93,v89
v_mov_b32 v94,v90
v_mov_b32 v95,v91
v_mfma_f32_16x16x32_bf16 v[72:75],a[44:47],v[236:239],v[72:75]
ds_read_b128 v[232:235],v17 offset:36864
v_permlane32_swap_b32 v92,v88
v_permlane32_swap_b32 v93,v89
v_permlane32_swap_b32 v94,v90
s_waitcnt lgkmcnt(5)
v_mfma_f32_16x16x32_bf16 v[64:67],a[48:51],v[240:243],v[64:67]
ds_read_b128 v[236:239],v17 offset:38912
v_min3_u32 v27,v27,v240,v244
v_permlane32_swap_b32 v95,v91
v_pk_add_f32 v[88:89],v[88:89],v[92:93]
v_mfma_f32_16x16x32_bf16 v[72:75],a[52:55],v[244:247],v[72:75]
ds_read_b128 v[240:243],v17 offset:40960
v_pk_add_f32 v[90:91],v[90:91],v[94:95]
v_mul_f32 v120,0xba800000,v88
v_mul_f32 v124,0xba800000,v90
s_add_u32 s88,s70,s75
s_waitcnt lgkmcnt(5)
v_mfma_f32_16x16x32_bf16 v[64:67],a[56:59],v[248:251],v[64:67]
ds_read_b128 v[244:247],v17 offset:43008
v_min3_u32 v27,v27,v248,v252
v_mul_f32 v92,v120,v120
v_mul_f32 v93,v124,v124
v_fma_f32 v92,v89,s82,-v92
s_add_u32 s88,s88,2097152
v_mfma_f32_16x16x32_bf16 v[72:75],a[60:63],v[252:255],v[72:75]
ds_read_b128 v[248:251],v17 offset:45056
v_fma_f32 v93,v91,s82,-v93
v_max_f32 v92,0,v92
v_max_f32 v93,0,v93
s_xor_b32 s88,s88,0x2000
s_waitcnt lgkmcnt(5)
v_mfma_f32_16x16x32_bf16 v[64:67],a[64:67],v[224:227],v[64:67]
ds_read_b128 v[252:255],v17 offset:47104
v_min3_u32 v27,v27,v224,v228
v_add_f32 v92,0x3727c5ac,v92
v_add_f32 v93,0x3727c5ac,v93
v_rsq_f32 v94,v92
v_mfma_f32_16x16x32_bf16 v[72:75],a[68:71],v[228:231],v[72:75]
ds_read_b128 v[224:227],v17 offset:49152
v_rsq_f32 v95,v93
v_mul_f32 v123,v92,v94
s_xor_b32 s89,s88,1024
s_waitcnt lgkmcnt(5)
v_mfma_f32_16x16x32_bf16 v[64:67],a[72:75],v[232:235],v[64:67]
ds_read_b128 v[228:231],v17 offset:51200
v_min3_u32 v27,v27,v232,v236
v_mul_f32 v127,v93,v95
v_mul_f32 v122,v28,v94
v_mul_f32 v126,v28,v95
v_mfma_f32_16x16x32_bf16 v[72:75],a[76:79],v[236:239],v[72:75]
ds_read_b128 v[232:235],v17 offset:53248
v_mul_f32 v92,v94,v94
v_mul_f32 v93,v95,v95
v_mul_f32 v94,s81,v94
s_waitcnt lgkmcnt(5)
v_mfma_f32_16x16x32_bf16 v[64:67],a[80:83],v[240:243],v[64:67]
ds_read_b128 v[236:239],v17 offset:55296
v_min3_u32 v27,v27,v240,v244
v_mul_f32 v95,s81,v95
v_mul_f32 v121,v92,v94
v_mul_f32 v125,v93,v95
v_mfma_f32_16x16x32_bf16 v[72:75],a[84:87],v[244:247],v[72:75]
ds_read_b128 v[240:243],v17 offset:57344
ds_write_b128 v19,v[120:123] offset:0
ds_write_b128 v19,v[124:127] offset:256
s_waitcnt lgkmcnt(7)
v_mfma_f32_16x16x32_bf16 v[64:67],a[88:91],v[248:251],v[64:67]
ds_read_b128 v[244:247],v17 offset:59392
v_min3_u32 v27,v27,v248,v252
v_mfma_f32_16x16x32_bf16 v[72:75],a[92:95],v[252:255],v[72:75]
ds_read_b128 v[248:251],v17 offset:61440
s_waitcnt lgkmcnt(7)
v_mfma_f32_16x16x32_bf16 v[64:67],a[96:99],v[224:227],v[64:67]
ds_read_b128 v[252:255],v17 offset:63488
v_min3_u32 v27,v27,v224,v228
v_mfma_f32_16x16x32_bf16 v[72:75],a[100:103],v[228:231],v[72:75]
s_waitcnt vmcnt(3) lgkmcnt(0)
s_barrier
ds_read_b64 v[44:45],v47
ds_read_b128 v[224:227],v17 offset:1024
s_waitcnt vmcnt(0)
v_add_u32 v22,s71,-1
v_mfma_f32_16x16x32_bf16 v[64:67],a[104:107],v[232:235],v[64:67]
ds_read_b128 v[228:231],v17 offset:3072
v_min3_u32 v27,v27,v232,v236
buffer_store_dword v22,v23,s[20:23],s97 offen sc1
s_mov_b32 s97,0x7fff0000
v_mfma_f32_16x16x32_bf16 v[72:75],a[108:111],v[236:239],v[72:75]
ds_read_b128 v[232:235],v17 offset:5120
v_mfma_f32_16x16x32_bf16 v[64:67],a[112:115],v[240:243],v[64:67]
ds_read_b128 v[236:239],v17 offset:7168
v_min3_u32 v27,v27,v240,v244
v_mfma_f32_16x16x32_bf16 v[72:75],a[116:119],v[244:247],v[72:75]
ds_read_b128 v[240:243],v17 offset:9216
s_waitcnt lgkmcnt(5)
v_readfirstlane_b32 s93,v45
v_mfma_f32_16x16x32_bf16 v[64:67],a[120:123],v[248:251],v[64:67]
ds_read_b128 v[244:247],v17 offset:11264
v_readfirstlane_b32 s83,v44
s_cmp_lg_u32 s83,0
s_cbranch_scc1 keep_360
v_min3_u32 v27,v27,v248,v252
v_mfma_f32_16x16x32_bf16 v[72:75],a[124:127],v[252:255],v[72:75]
ds_read_b128 v[248:251],v17 offset:13312
s_add_u32 s66,s88,110592
buffer_load_dwordx4 v[128:131],v16,s[20:23],s66 offen offset:0 sc1
buffer_load_dwordx4 v[132:135],v16,s[20:23],s66 offen offset:1024 sc1
s_waitcnt lgkmcnt(5)
v_mfma_f32_16x16x32_bf16 v[68:71],a[0:3],v[224:227],0
ds_read_b128 v[252:255],v17 offset:15360
v_cmp_eq_u32 vcc,0,v27
s_cbranch_vccnz retry_351
v_min3_u32 v27,v27,v224,v228
buffer_load_dwordx4 v[136:139],v16,s[20:23],s66 offen offset:2048 sc1
v_mfma_f32_16x16x32_bf16 v[76:79],a[4:7],v[228:231],0
ds_read_b128 v[224:227],v17 offset:17408
buffer_load_dwordx4 v[140:143],v16,s[20:23],s66 offen offset:3072 sc1
s_add_u32 s66,s88,114688
buffer_load_dwordx4 v[144:147],v16,s[20:23],s66 offen offset:0 sc1
s_waitcnt lgkmcnt(5)
v_mfma_f32_16x16x32_bf16 v[68:71],a[8:11],v[232:235],v[68:71]
ds_read_b128 v[228:231],v17 offset:19456
v_min3_u32 v27,v27,v232,v236
buffer_load_dwordx4 v[148:151],v16,s[20:23],s66 offen offset:1024 sc1
buffer_load_dwordx4 v[152:155],v16,s[20:23],s66 offen offset:2048 sc1
v_mfma_f32_16x16x32_bf16 v[76:79],a[12:15],v[236:239],v[76:79]
ds_read_b128 v[232:235],v17 offset:21504
buffer_load_dwordx4 v[156:159],v16,s[20:23],s66 offen offset:3072 sc1
s_waitcnt lgkmcnt(5)
v_mfma_f32_16x16x32_bf16 v[68:71],a[16:19],v[240:243],v[68:71]
ds_read_b128 v[236:239],v17 offset:23552
v_min3_u32 v27,v27,v240,v244
v_add_f32 v64,v64,v72
v_add_f32 v65,v65,v73
v_add_f32 v66,v66,v74
v_add_f32 v67,v67,v75
s_xor_b32 m0,s72,0
v_mfma_f32_16x16x32_bf16 v[76:79],a[20:23],v[244:247],v[76:79]
ds_read_b128 v[240:243],v17 offset:25600
v_fmac_f32 v64,v52,v120
v_fmac_f32 v65,v53,v120
v_fmac_f32 v66,v54,v120
v_fmac_f32 v67,v55,v120
s_add_u32 s65,s88,0
s_waitcnt lgkmcnt(5)
v_mfma_f32_16x16x32_bf16 v[68:71],a[24:27],v[248:251],v[68:71]
ds_read_b128 v[244:247],v17 offset:27648
v_min3_u32 v27,v27,v248,v252
v_mul_f32 v88,v64,v64
v_mul_f32 v89,v65,v65
v_mul_f32 v90,v66,v66
v_mul_f32 v91,v67,v67
v_mfma_f32_16x16x32_bf16 v[76:79],a[28:31],v[252:255],v[76:79]
ds_read_b128 v[248:251],v17 offset:29696
v_fma_f32 v88,v88,v121,v122
v_fma_f32 v89,v89,v121,v122
v_fma_f32 v90,v90,v121,v122
v_fma_f32 v91,v91,v121,v122
s_waitcnt lgkmcnt(5)
v_mfma_f32_16x16x32_bf16 v[68:71],a[32:35],v[224:227],v[68:71]
ds_read_b128 v[252:255],v17 offset:31744
v_min3_u32 v27,v27,v224,v228
v_mul_f32 v88,v88,v64
v_mul_f32 v89,v89,v65
v_mul_f32 v90,v90,v66
v_mul_f32 v91,v91,v67
v_mfma_f32_16x16x32_bf16 v[76:79],a[36:39],v[228:231],v[76:79]
ds_read_b128 v[224:227],v17 offset:33792
v_exp_f32 v88,v88
v_exp_f32 v89,v89
s_waitcnt lgkmcnt(5)
v_mfma_f32_16x16x32_bf16 v[68:71],a[40:43],v[232:235],v[68:71]
ds_read_b128 v[228:231],v17 offset:35840
v_min3_u32 v27,v27,v232,v236
v_exp_f32 v90,v90
v_exp_f32 v91,v91
v_mfma_f32_16x16x32_bf16 v[76:79],a[44:47],v[236:239],v[76:79]
ds_read_b128 v[232:235],v17 offset:37888
v_fma_f32 v88,v88,v123,v123
v_fma_f32 v89,v89,v123,v123
v_fma_f32 v90,v90,v123,v123
v_fma_f32 v91,v91,v123,v123
s_waitcnt lgkmcnt(5)
v_mfma_f32_16x16x32_bf16 v[68:71],a[48:51],v[240:243],v[68:71]
ds_read_b128 v[236:239],v17 offset:39936
v_min3_u32 v27,v27,v240,v244
v_rcp_f32 v88,v88
v_rcp_f32 v89,v89
v_mfma_f32_16x16x32_bf16 v[76:79],a[52:55],v[244:247],v[76:79]
ds_read_b128 v[240:243],v17 offset:41984
v_rcp_f32 v90,v90
v_rcp_f32 v91,v91
s_waitcnt lgkmcnt(5)
v_mfma_f32_16x16x32_bf16 v[68:71],a[56:59],v[248:251],v[68:71]
ds_read_b128 v[244:247],v17 offset:44032
v_min3_u32 v27,v27,v248,v252
v_mul_f32 v88,v88,v64
v_mul_f32 v89,v89,v65
v_mul_f32 v90,v90,v66
v_mul_f32 v91,v91,v67
v_mfma_f32_16x16x32_bf16 v[76:79],a[60:63],v[252:255],v[76:79]
ds_read_b128 v[248:251],v17 offset:46080
v_cvt_pk_bf16_f32 v96,v88,v89
v_cvt_pk_bf16_f32 v97,v90,v91
v_max_u32 v96,1,v96
buffer_load_dwordx4 v16,s[20:23],s65 offen offset:0 sc1 lds
s_waitcnt lgkmcnt(5)
v_mfma_f32_16x16x32_bf16 v[68:71],a[64:67],v[224:227],v[68:71]
ds_read_b128 v[252:255],v17 offset:48128
v_min3_u32 v27,v27,v224,v228
buffer_store_dwordx2 v[96:97],v18,s[20:23],s70 offen offset:0 sc1
buffer_load_dwordx4 v16,s[20:23],s65 offen offset:2048 sc1 lds
v_mfma_f32_16x16x32_bf16 v[76:79],a[68:71],v[228:231],v[76:79]
ds_read_b128 v[224:227],v17 offset:50176
s_xor_b32 m0,s72,16384
s_add_u32 s65,s88,32768
buffer_load_dwordx4 v16,s[20:23],s65 offen offset:0 sc1 lds
s_waitcnt lgkmcnt(5)
v_mfma_f32_16x16x32_bf16 v[68:71],a[72:75],v[232:235],v[68:71]
ds_read_b128 v[228:231],v17 offset:52224
v_min3_u32 v27,v27,v232,v236
buffer_load_dwordx4 v16,s[20:23],s65 offen offset:2048 sc1 lds
s_xor_b32 m0,s72,32768
s_add_u32 s65,s88,65536
v_mfma_f32_16x16x32_bf16 v[76:79],a[76:79],v[236:239],v[76:79]
ds_read_b128 v[232:235],v17 offset:54272
buffer_load_dwordx4 v16,s[20:23],s65 offen offset:0 sc1 lds
buffer_load_dwordx4 v16,s[20:23],s65 offen offset:2048 sc1 lds
s_waitcnt lgkmcnt(5)
v_mfma_f32_16x16x32_bf16 v[68:71],a[80:83],v[240:243],v[68:71]
ds_read_b128 v[236:239],v17 offset:56320
v_min3_u32 v27,v27,v240,v244
s_xor_b32 m0,s72,49152
s_add_u32 s65,s88,98304
buffer_load_dwordx4 v16,s[20:23],s65 offen offset:0 sc1 lds
v_mfma_f32_16x16x32_bf16 v[76:79],a[84:87],v[244:247],v[76:79]
ds_read_b128 v[240:243],v17 offset:58368
buffer_load_dwordx4 v16,s[20:23],s65 offen offset:2048 sc1 lds
s_xor_b32 m0,s72,1024
s_add_u32 s65,s89,0
s_waitcnt lgkmcnt(5)
v_mfma_f32_16x16x32_bf16 v[68:71],a[88:91],v[248:251],v[68:71]
ds_read_b128 v[244:247],v17 offset:60416
v_min3_u32 v27,v27,v248,v252
buffer_load_dwordx4 v16,s[20:23],s65 offen offset:0 sc1 lds
buffer_load_dwordx4 v16,s[20:23],s65 offen offset:2048 sc1 lds
v_mfma_f32_16x16x32_bf16 v[76:79],a[92:95],v[252:255],v[76:79]
ds_read_b128 v[248:251],v17 offset:62464
s_xor_b32 m0,s72,17408
s_add_u32 s65,s89,32768
buffer_load_dwordx4 v16,s[20:23],s65 offen offset:0 sc1 lds
s_waitcnt lgkmcnt(5)
v_mfma_f32_16x16x32_bf16 v[68:71],a[96:99],v[224:227],v[68:71]
ds_read_b128 v[252:255],v17 offset:64512
v_min3_u32 v27,v27,v224,v228
buffer_load_dwordx4 v16,s[20:23],s65 offen offset:2048 sc1 lds
s_xor_b32 m0,s72,33792
s_add_u32 s65,s89,65536
v_mfma_f32_16x16x32_bf16 v[76:79],a[100:103],v[228:231],v[76:79]
buffer_load_dwordx4 v16,s[20:23],s65 offen offset:0 sc1 lds
buffer_load_dwordx4 v16,s[20:23],s65 offen offset:2048 sc1 lds
s_xor_b32 m0,s72,50176
s_waitcnt lgkmcnt(4)
v_mfma_f32_16x16x32_bf16 v[68:71],a[104:107],v[232:235],v[68:71]
v_min3_u32 v27,v27,v232,v236
s_add_u32 s65,s89,98304
buffer_load_dwordx4 v16,s[20:23],s65 offen offset:0 sc1 lds
buffer_load_dwordx4 v16,s[20:23],s65 offen offset:2048 sc1 lds
v_mfma_f32_16x16x32_bf16 v[76:79],a[108:111],v[236:239],v[76:79]
s_waitcnt lgkmcnt(2)
v_mfma_f32_16x16x32_bf16 v[68:71],a[112:115],v[240:243],v[68:71]
v_min3_u32 v27,v27,v240,v244
v_mfma_f32_16x16x32_bf16 v[76:79],a[116:119],v[244:247],v[76:79]
s_waitcnt lgkmcnt(0)
v_mfma_f32_16x16x32_bf16 v[68:71],a[120:123],v[248:251],v[68:71]
v_min3_u32 v27,v27,v248,v252
v_mfma_f32_16x16x32_bf16 v[76:79],a[124:127],v[252:255],v[76:79]
v_cmp_eq_u32 vcc,0,v27
s_cbranch_vccnz retry_351
s_branch epi_354
keep_360:
v_min3_u32 v27,v27,v248,v252
v_mfma_f32_16x16x32_bf16 v[72:75],a[124:127],v[252:255],v[72:75]
ds_read_b128 v[248:251],v17 offset:13312
s_waitcnt lgkmcnt(5)
v_mfma_f32_16x16x32_bf16 v[68:71],a[0:3],v[224:227],0
ds_read_b128 v[252:255],v17 offset:15360
v_cmp_eq_u32 vcc,0,v27
s_cbranch_vccnz retry_351
v_min3_u32 v27,v27,v224,v228
v_mfma_f32_16x16x32_bf16 v[76:79],a[4:7],v[228:231],0
ds_read_b128 v[224:227],v17 offset:17408
s_waitcnt lgkmcnt(5)
v_mfma_f32_16x16x32_bf16 v[68:71],a[8:11],v[232:235],v[68:71]
ds_read_b128 v[228:231],v17 offset:19456
v_min3_u32 v27,v27,v232,v236
v_mfma_f32_16x16x32_bf16 v[76:79],a[12:15],v[236:239],v[76:79]
ds_read_b128 v[232:235],v17 offset:21504
s_waitcnt lgkmcnt(5)
v_mfma_f32_16x16x32_bf16 v[68:71],a[16:19],v[240:243],v[68:71]
ds_read_b128 v[236:239],v17 offset:23552
v_min3_u32 v27,v27,v240,v244
v_add_f32 v64,v64,v72
v_add_f32 v65,v65,v73
v_add_f32 v66,v66,v74
v_add_f32 v67,v67,v75
v_mfma_f32_16x16x32_bf16 v[76:79],a[20:23],v[244:247],v[76:79]
ds_read_b128 v[240:243],v17 offset:25600
v_fmac_f32 v64,v52,v120
v_fmac_f32 v65,v53,v120
v_fmac_f32 v66,v54,v120
v_fmac_f32 v67,v55,v120
s_waitcnt lgkmcnt(5)
v_mfma_f32_16x16x32_bf16 v[68:71],a[24:27],v[248:251],v[68:71]
ds_read_b128 v[244:247],v17 offset:27648
v_min3_u32 v27,v27,v248,v252
v_mul_f32 v88,v64,v64
v_mul_f32 v89,v65,v65
v_mul_f32 v90,v66,v66
v_mul_f32 v91,v67,v67
v_mfma_f32_16x16x32_bf16 v[76:79],a[28:31],v[252:255],v[76:79]
ds_read_b128 v[248:251],v17 offset:29696
v_fma_f32 v88,v88,v121,v122
v_fma_f32 v89,v89,v121,v122
v_fma_f32 v90,v90,v121,v122
v_fma_f32 v91,v91,v121,v122
s_waitcnt lgkmcnt(5)
v_mfma_f32_16x16x32_bf16 v[68:71],a[32:35],v[224:227],v[68:71]
ds_read_b128 v[252:255],v17 offset:31744
v_min3_u32 v27,v27,v224,v228
v_mul_f32 v88,v88,v64
v_mul_f32 v89,v89,v65
v_mul_f32 v90,v90,v66
v_mul_f32 v91,v91,v67
v_mfma_f32_16x16x32_bf16 v[76:79],a[36:39],v[228:231],v[76:79]
ds_read_b128 v[224:227],v17 offset:33792
v_exp_f32 v88,v88
v_exp_f32 v89,v89
s_waitcnt lgkmcnt(5)
v_mfma_f32_16x16x32_bf16 v[68:71],a[40:43],v[232:235],v[68:71]
ds_read_b128 v[228:231],v17 offset:35840
v_min3_u32 v27,v27,v232,v236
v_exp_f32 v90,v90
v_exp_f32 v91,v91
v_mfma_f32_16x16x32_bf16 v[76:79],a[44:47],v[236:239],v[76:79]
ds_read_b128 v[232:235],v17 offset:37888
v_fma_f32 v88,v88,v123,v123
v_fma_f32 v89,v89,v123,v123
v_fma_f32 v90,v90,v123,v123
v_fma_f32 v91,v91,v123,v123
s_waitcnt lgkmcnt(5)
v_mfma_f32_16x16x32_bf16 v[68:71],a[48:51],v[240:243],v[68:71]
ds_read_b128 v[236:239],v17 offset:39936
v_min3_u32 v27,v27,v240,v244
v_rcp_f32 v88,v88
v_rcp_f32 v89,v89
v_mfma_f32_16x16x32_bf16 v[76:79],a[52:55],v[244:247],v[76:79]
ds_read_b128 v[240:243],v17 offset:41984
v_rcp_f32 v90,v90
v_rcp_f32 v91,v91
s_waitcnt lgkmcnt(5)
v_mfma_f32_16x16x32_bf16 v[68:71],a[56:59],v[248:251],v[68:71]
ds_read_b128 v[244:247],v17 offset:44032
v_min3_u32 v27,v27,v248,v252
v_mul_f32 v88,v88,v64
v_mul_f32 v89,v89,v65
v_mul_f32 v90,v90,v66
v_mul_f32 v91,v91,v67
v_mfma_f32_16x16x32_bf16 v[76:79],a[60:63],v[252:255],v[76:79]
ds_read_b128 v[248:251],v17 offset:46080
v_cvt_pk_bf16_f32 v96,v88,v89
v_cvt_pk_bf16_f32 v97,v90,v91
v_max_u32 v96,1,v96
s_waitcnt lgkmcnt(5)
v_mfma_f32_16x16x32_bf16 v[68:71],a[64:67],v[224:227],v[68:71]
ds_read_b128 v[252:255],v17 offset:48128
v_min3_u32 v27,v27,v224,v228
buffer_store_dwordx2 v[96:97],v18,s[20:23],s70 offen offset:0 sc1
v_mfma_f32_16x16x32_bf16 v[76:79],a[68:71],v[228:231],v[76:79]
ds_read_b128 v[224:227],v17 offset:50176
s_waitcnt lgkmcnt(5)
v_mfma_f32_16x16x32_bf16 v[68:71],a[72:75],v[232:235],v[68:71]
ds_read_b128 v[228:231],v17 offset:52224
v_min3_u32 v27,v27,v232,v236
v_mfma_f32_16x16x32_bf16 v[76:79],a[76:79],v[236:239],v[76:79]
ds_read_b128 v[232:235],v17 offset:54272
s_waitcnt lgkmcnt(5)
v_mfma_f32_16x16x32_bf16 v[68:71],a[80:83],v[240:243],v[68:71]
ds_read_b128 v[236:239],v17 offset:56320
v_min3_u32 v27,v27,v240,v244
v_mfma_f32_16x16x32_bf16 v[76:79],a[84:87],v[244:247],v[76:79]
ds_read_b128 v[240:243],v17 offset:58368
s_waitcnt lgkmcnt(5)
v_mfma_f32_16x16x32_bf16 v[68:71],a[88:91],v[248:251],v[68:71]
ds_read_b128 v[244:247],v17 offset:60416
v_min3_u32 v27,v27,v248,v252
v_mfma_f32_16x16x32_bf16 v[76:79],a[92:95],v[252:255],v[76:79]
ds_read_b128 v[248:251],v17 offset:62464
s_waitcnt lgkmcnt(5)
v_mfma_f32_16x16x32_bf16 v[68:71],a[96:99],v[224:227],v[68:71]
ds_read_b128 v[252:255],v17 offset:64512
v_min3_u32 v27,v27,v224,v228
v_mfma_f32_16x16x32_bf16 v[76:79],a[100:103],v[228:231],v[76:79]
s_waitcnt lgkmcnt(4)
v_mfma_f32_16x16x32_bf16 v[68:71],a[104:107],v[232:235],v[68:71]
v_min3_u32 v27,v27,v232,v236
v_mfma_f32_16x16x32_bf16 v[76:79],a[108:111],v[236:239],v[76:79]
s_waitcnt lgkmcnt(2)
v_mfma_f32_16x16x32_bf16 v[68:71],a[112:115],v[240:243],v[68:71]
v_min3_u32 v27,v27,v240,v244
v_mfma_f32_16x16x32_bf16 v[76:79],a[116:119],v[244:247],v[76:79]
s_waitcnt lgkmcnt(0)
v_mfma_f32_16x16x32_bf16 v[68:71],a[120:123],v[248:251],v[68:71]
v_min3_u32 v27,v27,v248,v252
v_mfma_f32_16x16x32_bf16 v[76:79],a[124:127],v[252:255],v[76:79]
v_cmp_eq_u32 vcc,0,v27
s_cbranch_vccnz retry_351
s_branch epi_354
both_355:
s_waitcnt vmcnt(11) lgkmcnt(0)
s_barrier
ds_read_b128 v[224:227],v17 offset:0
ds_read_b128 v[228:231],v17 offset:2048
ds_read_b128 v[232:235],v17 offset:4096
ds_read_b128 v[236:239],v17 offset:6144
ds_read_b128 v[240:243],v17 offset:8192
ds_read_b128 v[244:247],v17 offset:10240
ds_read_b128 v[248:251],v17 offset:12288
s_waitcnt lgkmcnt(5)
v_mfma_f32_16x16x32_bf16 v[64:67],a[0:3],v[224:227],0
ds_read_b128 v[252:255],v17 offset:14336
v_min_u32 v27,v224,v228
s_waitcnt vmcnt(12)
stk_367:
v_min3_u32 v22,v129,v133,v137
v_min3_u32 v22,v22,v141,v145
v_min3_u32 v22,v22,v149,v153
v_min_u32 v22,v22,v157
v_cmp_eq_u32 vcc,0,v22
s_cmp_lt_i32 s90,0
s_cselect_b64 vcc,0,vcc
s_cbranch_vccnz str_368
v_mfma_f32_16x16x32_bf16 v[72:75],a[4:7],v[228:231],0
ds_read_b128 v[224:227],v17 offset:16384
v_pk_add_f32 v[88:89],v[128:129],v[144:145]
v_pk_add_f32 v[90:91],v[130:131],v[146:147]
v_pk_add_f32 v[92:93],v[132:133],v[148:149]
v_pk_add_f32 v[94:95],v[134:135],v[150:151]
s_waitcnt lgkmcnt(5)
v_mfma_f32_16x16x32_bf16 v[64:67],a[8:11],v[232:235],v[64:67]
ds_read_b128 v[228:231],v17 offset:18432
v_min3_u32 v27,v27,v232,v236
v_pk_add_f32 v[96:97],v[136:137],v[152:153]
v_pk_add_f32 v[98:99],v[138:139],v[154:155]
v_pk_add_f32 v[100:101],v[140:141],v[156:157]
v_pk_add_f32 v[102:103],v[142:143],v[158:159]
v_mfma_f32_16x16x32_bf16 v[72:75],a[12:15],v[236:239],v[72:75]
ds_read_b128 v[232:235],v17 offset:20480
s_add_u32 s88,s70,s75
s_add_u32 s88,s88,2097152
s_xor_b32 s88,s88,0x2000
s_xor_b32 s89,s88,1024
s_waitcnt lgkmcnt(5)
v_mfma_f32_16x16x32_bf16 v[64:67],a[16:19],v[240:243],v[64:67]
ds_read_b128 v[236:239],v17 offset:22528
v_min3_u32 v27,v27,v240,v244
v_pk_add_f32 v[88:89],v[88:89],v[96:97]
v_pk_add_f32 v[90:91],v[90:91],v[98:99]
v_pk_add_f32 v[92:93],v[92:93],v[100:101]
v_mfma_f32_16x16x32_bf16 v[72:75],a[20:23],v[244:247],v[72:75]
ds_read_b128 v[240:243],v17 offset:24576
v_pk_add_f32 v[94:95],v[94:95],v[102:103]
v_pk_add_f32 v[88:89],v[88:89],v[92:93]
v_pk_add_f32 v[90:91],v[90:91],v[94:95]
s_waitcnt lgkmcnt(5)
v_mfma_f32_16x16x32_bf16 v[64:67],a[24:27],v[248:251],v[64:67]
ds_read_b128 v[244:247],v17 offset:26624
v_min3_u32 v27,v27,v248,v252
v_mov_b32 v92,v88
v_mov_b32 v93,v89
v_mov_b32 v94,v90
v_mfma_f32_16x16x32_bf16 v[72:75],a[28:31],v[252:255],v[72:75]
ds_read_b128 v[248:251],v17 offset:28672
v_mov_b32 v95,v91
v_permlane16_swap_b32 v92,v88
v_permlane16_swap_b32 v93,v89
s_waitcnt lgkmcnt(5)
v_mfma_f32_16x16x32_bf16 v[64:67],a[32:35],v[224:227],v[64:67]
ds_read_b128 v[252:255],v17 offset:30720
v_min3_u32 v27,v27,v224,v228
v_permlane16_swap_b32 v94,v90
v_permlane16_swap_b32 v95,v91
s_add_u32 s66,s88,110592
buffer_load_dwordx4 v[128:131],v16,s[20:23],s66 offen offset:0 sc1
v_mfma_f32_16x16x32_bf16 v[72:75],a[36:39],v[228:231],v[72:75]
ds_read_b128 v[224:227],v17 offset:32768
v_pk_add_f32 v[88:89],v[88:89],v[92:93]
v_pk_add_f32 v[90:91],v[90:91],v[94:95]
v_mov_b32 v92,v88
buffer_load_dwordx4 v[132:135],v16,s[20:23],s66 offen offset:1024 sc1
s_waitcnt lgkmcnt(5)
v_mfma_f32_16x16x32_bf16 v[64:67],a[40:43],v[232:235],v[64:67]
ds_read_b128 v[228:231],v17 offset:34816
v_min3_u32 v27,v27,v232,v236
v_mov_b32 v93,v89
v_mov_b32 v94,v90
v_mov_b32 v95,v91
buffer_load_dwordx4 v[136:139],v16,s[20:23],s66 offen offset:2048 sc1
v_mfma_f32_16x16x32_bf16 v[72:75],a[44:47],v[236:239],v[72:75]
ds_read_b128 v[232:235],v17 offset:36864
v_permlane32_swap_b32 v92,v88
v_permlane32_swap_b32 v93,v89
v_permlane32_swap_b32 v94,v90
buffer_load_dwordx4 v[140:143],v16,s[20:23],s66 offen offset:3072 sc1
s_waitcnt lgkmcnt(5)
v_mfma_f32_16x16x32_bf16 v[64:67],a[48:51],v[240:243],v[64:67]
ds_read_b128 v[236:239],v17 offset:38912
v_min3_u32 v27,v27,v240,v244
v_permlane32_swap_b32 v95,v91
v_pk_add_f32 v[88:89],v[88:89],v[92:93]
s_add_u32 s66,s88,114688
buffer_load_dwordx4 v[144:147],v16,s[20:23],s66 offen offset:0 sc1
v_mfma_f32_16x16x32_bf16 v[72:75],a[52:55],v[244:247],v[72:75]
ds_read_b128 v[240:243],v17 offset:40960
v_pk_add_f32 v[90:91],v[90:91],v[94:95]
v_mul_f32 v120,0xba800000,v88
v_mul_f32 v124,0xba800000,v90
buffer_load_dwordx4 v[148:151],v16,s[20:23],s66 offen offset:1024 sc1
s_waitcnt lgkmcnt(5)
v_mfma_f32_16x16x32_bf16 v[64:67],a[56:59],v[248:251],v[64:67]
ds_read_b128 v[244:247],v17 offset:43008
v_min3_u32 v27,v27,v248,v252
v_mul_f32 v92,v120,v120
v_mul_f32 v93,v124,v124
v_fma_f32 v92,v89,s82,-v92
buffer_load_dwordx4 v[152:155],v16,s[20:23],s66 offen offset:2048 sc1
v_mfma_f32_16x16x32_bf16 v[72:75],a[60:63],v[252:255],v[72:75]
ds_read_b128 v[248:251],v17 offset:45056
v_fma_f32 v93,v91,s82,-v93
v_max_f32 v92,0,v92
v_max_f32 v93,0,v93
buffer_load_dwordx4 v[156:159],v16,s[20:23],s66 offen offset:3072 sc1
s_waitcnt lgkmcnt(5)
v_mfma_f32_16x16x32_bf16 v[64:67],a[64:67],v[224:227],v[64:67]
ds_read_b128 v[252:255],v17 offset:47104
v_min3_u32 v27,v27,v224,v228
v_add_f32 v92,0x3727c5ac,v92
v_add_f32 v93,0x3727c5ac,v93
v_rsq_f32 v94,v92
s_xor_b32 m0,s72,0
v_mfma_f32_16x16x32_bf16 v[72:75],a[68:71],v[228:231],v[72:75]
ds_read_b128 v[224:227],v17 offset:49152
v_rsq_f32 v95,v93
v_mul_f32 v123,v92,v94
s_add_u32 s65,s88,0
s_waitcnt lgkmcnt(5)
v_mfma_f32_16x16x32_bf16 v[64:67],a[72:75],v[232:235],v[64:67]
ds_read_b128 v[228:231],v17 offset:51200
v_min3_u32 v27,v27,v232,v236
v_mul_f32 v127,v93,v95
v_mul_f32 v122,v28,v94
v_mul_f32 v126,v28,v95
buffer_load_dwordx4 v16,s[20:23],s65 offen offset:0 sc1 lds
v_mfma_f32_16x16x32_bf16 v[72:75],a[76:79],v[236:239],v[72:75]
ds_read_b128 v[232:235],v17 offset:53248
v_mul_f32 v92,v94,v94
v_mul_f32 v93,v95,v95
v_mul_f32 v94,s81,v94
buffer_load_dwordx4 v16,s[20:23],s65 offen offset:2048 sc1 lds
s_waitcnt lgkmcnt(5)
v_mfma_f32_16x16x32_bf16 v[64:67],a[80:83],v[240:243],v[64:67]
ds_read_b128 v[236:239],v17 offset:55296
v_min3_u32 v27,v27,v240,v244
v_mul_f32 v95,s81,v95
v_mul_f32 v121,v92,v94
v_mul_f32 v125,v93,v95
s_xor_b32 m0,s72,16384
v_mfma_f32_16x16x32_bf16 v[72:75],a[84:87],v[244:247],v[72:75]
ds_read_b128 v[240:243],v17 offset:57344
ds_write_b128 v19,v[120:123] offset:0
ds_write_b128 v19,v[124:127] offset:256
s_add_u32 s65,s88,32768
s_waitcnt lgkmcnt(7)
v_mfma_f32_16x16x32_bf16 v[64:67],a[88:91],v[248:251],v[64:67]
ds_read_b128 v[244:247],v17 offset:59392
v_min3_u32 v27,v27,v248,v252
buffer_load_dwordx4 v16,s[20:23],s65 offen offset:0 sc1 lds
buffer_load_dwordx4 v16,s[20:23],s65 offen offset:2048 sc1 lds
v_mfma_f32_16x16x32_bf16 v[72:75],a[92:95],v[252:255],v[72:75]
ds_read_b128 v[248:251],v17 offset:61440
s_xor_b32 m0,s72,32768
s_add_u32 s65,s88,65536
buffer_load_dwordx4 v16,s[20:23],s65 offen offset:0 sc1 lds
s_waitcnt lgkmcnt(7)
v_mfma_f32_16x16x32_bf16 v[64:67],a[96:99],v[224:227],v[64:67]
ds_read_b128 v[252:255],v17 offset:63488
v_min3_u32 v27,v27,v224,v228
buffer_load_dwordx4 v16,s[20:23],s65 offen offset:2048 sc1 lds
s_xor_b32 m0,s72,49152
s_add_u32 s65,s88,98304
v_mfma_f32_16x16x32_bf16 v[72:75],a[100:103],v[228:231],v[72:75]
s_waitcnt vmcnt(17) lgkmcnt(0)
s_barrier
ds_read_b64 v[44:45],v47
ds_read_b128 v[224:227],v17 offset:1024
s_waitcnt vmcnt(14)
v_add_u32 v22,s71,-1
v_mfma_f32_16x16x32_bf16 v[64:67],a[104:107],v[232:235],v[64:67]
ds_read_b128 v[228:231],v17 offset:3072
v_min3_u32 v27,v27,v232,v236
buffer_store_dword v22,v23,s[20:23],s97 offen sc1
s_mov_b32 s97,0x7fff0000
v_mfma_f32_16x16x32_bf16 v[72:75],a[108:111],v[236:239],v[72:75]
ds_read_b128 v[232:235],v17 offset:5120
buffer_load_dwordx4 v16,s[20:23],s65 offen offset:0 sc1 lds
buffer_load_dwordx4 v16,s[20:23],s65 offen offset:2048 sc1 lds
v_mfma_f32_16x16x32_bf16 v[64:67],a[112:115],v[240:243],v[64:67]
ds_read_b128 v[236:239],v17 offset:7168
v_min3_u32 v27,v27,v240,v244
s_xor_b32 m0,s72,1024
s_add_u32 s65,s89,0
buffer_load_dwordx4 v16,s[20:23],s65 offen offset:0 sc1 lds
v_mfma_f32_16x16x32_bf16 v[72:75],a[116:119],v[244:247],v[72:75]
ds_read_b128 v[240:243],v17 offset:9216
s_waitcnt lgkmcnt(5)
v_readfirstlane_b32 s93,v45
buffer_load_dwordx4 v16,s[20:23],s65 offen offset:2048 sc1 lds
v_mfma_f32_16x16x32_bf16 v[64:67],a[120:123],v[248:251],v[64:67]
ds_read_b128 v[244:247],v17 offset:11264
v_min3_u32 v27,v27,v248,v252
s_xor_b32 m0,s72,17408
s_add_u32 s65,s89,32768
buffer_load_dwordx4 v16,s[20:23],s65 offen offset:0 sc1 lds
v_mfma_f32_16x16x32_bf16 v[72:75],a[124:127],v[252:255],v[72:75]
ds_read_b128 v[248:251],v17 offset:13312
buffer_load_dwordx4 v16,s[20:23],s65 offen offset:2048 sc1 lds
s_xor_b32 m0,s72,33792
s_add_u32 s65,s89,65536
s_waitcnt lgkmcnt(5)
v_mfma_f32_16x16x32_bf16 v[68:71],a[0:3],v[224:227],0
ds_read_b128 v[252:255],v17 offset:15360
v_cmp_eq_u32 vcc,0,v27
s_cbranch_vccnz retry_351
v_min3_u32 v27,v27,v224,v228
buffer_load_dwordx4 v16,s[20:23],s65 offen offset:0 sc1 lds
v_mfma_f32_16x16x32_bf16 v[76:79],a[4:7],v[228:231],0
ds_read_b128 v[224:227],v17 offset:17408
buffer_load_dwordx4 v16,s[20:23],s65 offen offset:2048 sc1 lds
s_xor_b32 m0,s72,50176
s_add_u32 s65,s89,98304
s_waitcnt lgkmcnt(5)
v_mfma_f32_16x16x32_bf16 v[68:71],a[8:11],v[232:235],v[68:71]
ds_read_b128 v[228:231],v17 offset:19456
v_min3_u32 v27,v27,v232,v236
buffer_load_dwordx4 v16,s[20:23],s65 offen offset:0 sc1 lds
buffer_load_dwordx4 v16,s[20:23],s65 offen offset:2048 sc1 lds
v_mfma_f32_16x16x32_bf16 v[76:79],a[12:15],v[236:239],v[76:79]
ds_read_b128 v[232:235],v17 offset:21504
s_waitcnt lgkmcnt(5)
v_mfma_f32_16x16x32_bf16 v[68:71],a[16:19],v[240:243],v[68:71]
ds_read_b128 v[236:239],v17 offset:23552
v_min3_u32 v27,v27,v240,v244
v_add_f32 v64,v64,v72
v_add_f32 v65,v65,v73
v_add_f32 v66,v66,v74
v_add_f32 v67,v67,v75
v_mfma_f32_16x16x32_bf16 v[76:79],a[20:23],v[244:247],v[76:79]
ds_read_b128 v[240:243],v17 offset:25600
v_fmac_f32 v64,v52,v120
v_fmac_f32 v65,v53,v120
v_fmac_f32 v66,v54,v120
v_fmac_f32 v67,v55,v120
s_waitcnt lgkmcnt(5)
v_mfma_f32_16x16x32_bf16 v[68:71],a[24:27],v[248:251],v[68:71]
ds_read_b128 v[244:247],v17 offset:27648
v_min3_u32 v27,v27,v248,v252
v_mul_f32 v88,v64,v64
v_mul_f32 v89,v65,v65
v_mul_f32 v90,v66,v66
v_mul_f32 v91,v67,v67
v_mfma_f32_16x16x32_bf16 v[76:79],a[28:31],v[252:255],v[76:79]
ds_read_b128 v[248:251],v17 offset:29696
v_fma_f32 v88,v88,v121,v122
v_fma_f32 v89,v89,v121,v122
v_fma_f32 v90,v90,v121,v122
v_fma_f32 v91,v91,v121,v122
s_waitcnt lgkmcnt(5)
v_mfma_f32_16x16x32_bf16 v[68:71],a[32:35],v[224:227],v[68:71]
ds_read_b128 v[252:255],v17 offset:31744
v_min3_u32 v27,v27,v224,v228
v_mul_f32 v88,v88,v64
v_mul_f32 v89,v89,v65
v_mul_f32 v90,v90,v66
v_mul_f32 v91,v91,v67
v_mfma_f32_16x16x32_bf16 v[76:79],a[36:39],v[228:231],v[76:79]
ds_read_b128 v[224:227],v17 offset:33792
v_exp_f32 v88,v88
v_exp_f32 v89,v89
s_waitcnt lgkmcnt(5)
v_mfma_f32_16x16x32_bf16 v[68:71],a[40:43],v[232:235],v[68:71]
ds_read_b128 v[228:231],v17 offset:35840
v_min3_u32 v27,v27,v232,v236
v_exp_f32 v90,v90
v_exp_f32 v91,v91
v_mfma_f32_16x16x32_bf16 v[76:79],a[44:47],v[236:239],v[76:79]
ds_read_b128 v[232:235],v17 offset:37888
v_fma_f32 v88,v88,v123,v123
v_fma_f32 v89,v89,v123,v123
v_fma_f32 v90,v90,v123,v123
v_fma_f32 v91,v91,v123,v123
s_waitcnt lgkmcnt(5)
v_mfma_f32_16x16x32_bf16 v[68:71],a[48:51],v[240:243],v[68:71]
ds_read_b128 v[236:239],v17 offset:39936
v_min3_u32 v27,v27,v240,v244
v_rcp_f32 v88,v88
v_rcp_f32 v89,v89
v_mfma_f32_16x16x32_bf16 v[76:79],a[52:55],v[244:247],v[76:79]
ds_read_b128 v[240:243],v17 offset:41984
v_rcp_f32 v90,v90
v_rcp_f32 v91,v91
s_waitcnt lgkmcnt(5)
v_mfma_f32_16x16x32_bf16 v[68:71],a[56:59],v[248:251],v[68:71]
ds_read_b128 v[244:247],v17 offset:44032
v_min3_u32 v27,v27,v248,v252
v_mul_f32 v88,v88,v64
v_mul_f32 v89,v89,v65
v_mul_f32 v90,v90,v66
v_mul_f32 v91,v91,v67
v_mfma_f32_16x16x32_bf16 v[76:79],a[60:63],v[252:255],v[76:79]
ds_read_b128 v[248:251],v17 offset:46080
v_cvt_pk_bf16_f32 v96,v88,v89
v_cvt_pk_bf16_f32 v97,v90,v91
v_max_u32 v96,1,v96
s_waitcnt lgkmcnt(5)
v_mfma_f32_16x16x32_bf16 v[68:71],a[64:67],v[224:227],v[68:71]
ds_read_b128 v[252:255],v17 offset:48128
v_min3_u32 v27,v27,v224,v228
buffer_store_dwordx2 v[96:97],v18,s[20:23],s70 offen offset:0 sc1
v_mfma_f32_16x16x32_bf16 v[76:79],a[68:71],v[228:231],v[76:79]
ds_read_b128 v[224:227],v17 offset:50176
s_waitcnt lgkmcnt(5)
v_mfma_f32_16x16x32_bf16 v[68:71],a[72:75],v[232:235],v[68:71]
ds_read_b128 v[228:231],v17 offset:52224
v_min3_u32 v27,v27,v232,v236
v_mfma_f32_16x16x32_bf16 v[76:79],a[76:79],v[236:239],v[76:79]
ds_read_b128 v[232:235],v17 offset:54272
s_waitcnt lgkmcnt(5)
v_mfma_f32_16x16x32_bf16 v[68:71],a[80:83],v[240:243],v[68:71]
ds_read_b128 v[236:239],v17 offset:56320
v_min3_u32 v27,v27,v240,v244
v_mfma_f32_16x16x32_bf16 v[76:79],a[84:87],v[244:247],v[76:79]
ds_read_b128 v[240:243],v17 offset:58368
s_waitcnt lgkmcnt(5)
v_mfma_f32_16x16x32_bf16 v[68:71],a[88:91],v[248:251],v[68:71]
ds_read_b128 v[244:247],v17 offset:60416
v_min3_u32 v27,v27,v248,v252
v_mfma_f32_16x16x32_bf16 v[76:79],a[92:95],v[252:255],v[76:79]
ds_read_b128 v[248:251],v17 offset:62464
s_waitcnt lgkmcnt(5)
v_mfma_f32_16x16x32_bf16 v[68:71],a[96:99],v[224:227],v[68:71]
ds_read_b128 v[252:255],v17 offset:64512
v_min3_u32 v27,v27,v224,v228
v_mfma_f32_16x16x32_bf16 v[76:79],a[100:103],v[228:231],v[76:79]
s_waitcnt lgkmcnt(4)
v_mfma_f32_16x16x32_bf16 v[68:71],a[104:107],v[232:235],v[68:71]
v_min3_u32 v27,v27,v232,v236
v_mfma_f32_16x16x32_bf16 v[76:79],a[108:111],v[236:239],v[76:79]
s_waitcnt lgkmcnt(2)
v_mfma_f32_16x16x32_bf16 v[68:71],a[112:115],v[240:243],v[68:71]
v_min3_u32 v27,v27,v240,v244
v_mfma_f32_16x16x32_bf16 v[76:79],a[116:119],v[244:247],v[76:79]
s_waitcnt lgkmcnt(0)
v_mfma_f32_16x16x32_bf16 v[68:71],a[120:123],v[248:251],v[68:71]
v_min3_u32 v27,v27,v248,v252
v_mfma_f32_16x16x32_bf16 v[76:79],a[124:127],v[252:255],v[76:79]
v_cmp_eq_u32 vcc,0,v27
s_cbranch_vccnz retry_351
epi_354:
buffer_load_dword v29,v21,s[20:23],s87 offen sc1
s_nop 4
v_pk_add_f32 v[68:69],v[68:69],v[76:77]
v_pk_add_f32 v[70:71],v[70:71],v[78:79]
v_pk_fma_f32 v[68:69],v[52:53],v[124:125],v[68:69] op_sel_hi:[1,0,1]
v_pk_fma_f32 v[70:71],v[54:55],v[124:125],v[70:71] op_sel_hi:[1,0,1]
v_pk_mul_f32 v[88:89],v[68:69],v[68:69]
v_pk_mul_f32 v[90:91],v[70:71],v[70:71]
v_pk_fma_f32 v[88:89],v[88:89],v[124:125],v[126:127] op_sel:[0,1,0] op_sel_hi:[1,1,0]
v_pk_fma_f32 v[90:91],v[90:91],v[124:125],v[126:127] op_sel:[0,1,0] op_sel_hi:[1,1,0]
v_pk_mul_f32 v[88:89],v[88:89],v[68:69]
v_pk_mul_f32 v[90:91],v[90:91],v[70:71]
v_exp_f32 v88,v88
v_exp_f32 v89,v89
v_exp_f32 v90,v90
s_cmp_gt_u32 s71,51
s_cselect_b32 s65,s73,0x7fff0000
s_cselect_b32 s97,0x7fff0000,s73
v_mov_b32 v22,s71
buffer_store_dword v22,v23,s[20:23],s65 offen sc1
v_exp_f32 v91,v91
v_pk_fma_f32 v[88:89],v[88:89],v[126:127],v[126:127] op_sel:[0,1,1] op_sel_hi:[1,1,1]
v_pk_fma_f32 v[90:91],v[90:91],v[126:127],v[126:127] op_sel:[0,1,1] op_sel_hi:[1,1,1]
v_rcp_f32 v88,v88
v_rcp_f32 v89,v89
v_rcp_f32 v90,v90
v_rcp_f32 v91,v91
v_pk_mul_f32 v[88:89],v[88:89],v[68:69]
v_pk_mul_f32 v[90:91],v[90:91],v[70:71]
v_cvt_pk_bf16_f32 v96,v88,v89
v_cvt_pk_bf16_f32 v97,v90,v91
v_max_u32 v96,1,v96
buffer_store_dwordx2 v[96:97],v18,s[20:23],s70 offen offset:1024 sc1
v_xor_b32 v17,0x10000,v17
s_xor_b32 s72,s72,0x10000
s_add_u32 s70,s70,2097152
s_xor_b32 s70,s70,0x2000
s_add_u32 s71,s71,1
s_cmp_le_u32 s71,s57
s_cbranch_scc1 seg_352
s_endpgm
retry_351:
s_sub_u32 s90,s90,64
s_cmp_lt_i32 s90,0
s_cbranch_scc1 giveup_197
s_mov_b32 s83,1
s_waitcnt vmcnt(0) lgkmcnt(0)
s_barrier
s_branch seg_352
str_364:
s_add_u32 s94,s70,s75
s_add_u32 s66,s94,110592
buffer_load_dwordx4 v[128:131],v16,s[20:23],s66 offen offset:0 sc1
buffer_load_dwordx4 v[132:135],v16,s[20:23],s66 offen offset:1024 sc1
buffer_load_dwordx4 v[136:139],v16,s[20:23],s66 offen offset:2048 sc1
buffer_load_dwordx4 v[140:143],v16,s[20:23],s66 offen offset:3072 sc1
s_add_u32 s66,s94,114688
buffer_load_dwordx4 v[144:147],v16,s[20:23],s66 offen offset:0 sc1
buffer_load_dwordx4 v[148:151],v16,s[20:23],s66 offen offset:1024 sc1
buffer_load_dwordx4 v[152:155],v16,s[20:23],s66 offen offset:2048 sc1
buffer_load_dwordx4 v[156:159],v16,s[20:23],s66 offen offset:3072 sc1
s_sub_u32 s90,s90,1
s_waitcnt vmcnt(0)
s_branch stk_363
str_366:
s_add_u32 s94,s70,s75
s_add_u32 s66,s94,110592
buffer_load_dwordx4 v[128:131],v16,s[20:23],s66 offen offset:0 sc1
buffer_load_dwordx4 v[132:135],v16,s[20:23],s66 offen offset:1024 sc1
buffer_load_dwordx4 v[136:139],v16,s[20:23],s66 offen offset:2048 sc1
buffer_load_dwordx4 v[140:143],v16,s[20:23],s66 offen offset:3072 sc1
s_add_u32 s66,s94,114688
buffer_load_dwordx4 v[144:147],v16,s[20:23],s66 offen offset:0 sc1
buffer_load_dwordx4 v[148:151],v16,s[20:23],s66 offen offset:1024 sc1
buffer_load_dwordx4 v[152:155],v16,s[20:23],s66 offen offset:2048 sc1
buffer_load_dwordx4 v[156:159],v16,s[20:23],s66 offen offset:3072 sc1
s_sub_u32 s90,s90,1
s_waitcnt vmcnt(0)
s_branch stk_365
str_368:
s_add_u32 s94,s70,s75
s_add_u32 s66,s94,110592
buffer_load_dwordx4 v[128:131],v16,s[20:23],s66 offen offset:0 sc1
buffer_load_dwordx4 v[132:135],v16,s[20:23],s66 offen offset:1024 sc1
buffer_load_dwordx4 v[136:139],v16,s[20:23],s66 offen offset:2048 sc1
buffer_load_dwordx4 v[140:143],v16,s[20:23],s66 offen offset:3072 sc1
s_add_u32 s66,s94,114688
buffer_load_dwordx4 v[144:147],v16,s[20:23],s66 offen offset:0 sc1
buffer_load_dwordx4 v[148:151],v16,s[20:23],s66 offen offset:1024 sc1
buffer_load_dwordx4 v[152:155],v16,s[20:23],s66 offen offset:2048 sc1
buffer_load_dwordx4 v[156:159],v16,s[20:23],s66 offen offset:3072 sc1
s_sub_u32 s90,s90,1
s_waitcnt vmcnt(0)
s_branch stk_367
giveup_197:
s_endpgm
code_end:
.section .rodata,"a"
.p2align 6
.amdhsa_kernel mega_kernel
  .amdhsa_next_free_vgpr 512
  .amdhsa_next_free_sgpr 102
  .amdhsa_accum_offset 256
  .amdhsa_group_segment_fixed_size 0
  .amdhsa_kernarg_size 136
  .amdhsa_user_sgpr_count 2
  .amdhsa_user_sgpr_kernarg_segment_ptr 1
  .amdhsa_system_sgpr_workgroup_id_x 1
.end_amdhsa_kernel
```

```asm
; @launch kernel=mega_kernel grid=(256,1,1) block=(256,1,1) lds=163840
.amdgcn_target "amdgcn-amd-amdhsa--gfx950"
.text
.globl mega_kernel
.p2align 8
.type mega_kernel,@function
mega_kernel:
s_cmp_ge_u32 s2,256
s_cbranch_scc1 done_1
s_load_dwordx4 s[16:19],s[0:1],120
s_load_dword s3,s[0:1],0
s_getpc_b64 s[4:5]
pc_2:
s_sub_u32 s8,s4,pc_2-mega_kernel
s_subb_u32 s9,s5,0
s_and_b32 s9,s9,0xffff
s_mov_b32 s10,code_end-mega_kernel
s_mov_b32 s11,0x20000
v_lshlrev_b32 v180,7,v0
v_cmp_gt_u32 vcc,64,v0
s_cbranch_vccnz nocpf_3
buffer_load_dword v181,v180,s[8:11],0 offen
s_mov_b32 s12,0x8000
buffer_load_dword v182,v180,s[8:11],s12 offen
s_lshr_b32 s12,s2,3
s_and_b32 s12,s12,7
s_add_u32 s12,s12,2
s_lshl_b32 s12,s12,15
buffer_load_dword v183,v180,s[8:11],s12 offen
nocpf_3:
v_and_b32 v1,63,v0
v_lshrrev_b32 v2,6,v0
s_getreg_b32 s51,hwreg(HW_REG_XCC_ID)
v_readfirstlane_b32 s50,v2
s_and_b32 s51,s51,7
s_waitcnt lgkmcnt(0)
s_mov_b32 s20,s18
s_and_b32 s21,s19,0xffff
s_mov_b32 s22,0x10000000
s_mov_b32 s23,0x20000
s_mov_b32 s44,s16
s_and_b32 s45,s17,0xffff
s_mov_b32 s46,0x100
s_mov_b32 s47,0x20000
s_mov_b32 s90,400000
s_mov_b32 s91,s50
v_mov_b32 v187,158976
s_cmp_lg_u32 s50,0
s_cbranch_scc1 norole_4
s_mov_b64 exec,1
v_mov_b32 v184,1
v_mov_b32 v185,0
s_and_b32 s52,s51,3
s_lshl_b32 s52,s52,2
s_lshr_b32 s53,s51,2
s_lshl_b32 s53,s53,7
s_add_u32 s52,s52,s53
buffer_atomic_add v184,v185,s[44:47],s52 offen sc0 sc1
s_mov_b64 exec,-1
buffer_load_dword v181,v180,s[8:11],0 offen
s_mov_b32 s12,0x8000
buffer_load_dword v182,v180,s[8:11],s12 offen
s_lshr_b32 s12,s2,3
s_and_b32 s12,s12,7
s_add_u32 s12,s12,2
s_lshl_b32 s12,s12,15
buffer_load_dword v183,v180,s[8:11],s12 offen
s_mov_b64 exec,1
s_waitcnt vmcnt(3)
ds_write_b32 v187,v184
s_waitcnt lgkmcnt(0)
s_mov_b64 exec,-1
norole_4:
s_barrier
ds_read_b32 v186,v187
s_waitcnt lgkmcnt(0)
v_readfirstlane_b32 s54,v186
s_mov_b32 s56,2
s_lshl_b32 s57,s51,5
s_add_u32 s57,s57,s54
s_cmp_lt_u32 s54,32
s_cselect_b32 s57,s57,999
s_cmp_ge_u32 s57,256
s_cbranch_scc1 verify_6
s_cmp_ge_u32 s57,128
s_cbranch_scc1 pre_8
setup_5:
s_load_dwordx8 s[4:11],s[0:1],8
s_load_dwordx2 s[12:13],s[0:1],40
v_and_b32 v3,15,v1
v_lshrrev_b32 v4,4,v1
v_lshlrev_b32 v16,4,v1
v_lshrrev_b32 v30,2,v1
v_and_b32 v31,3,v1
v_lshlrev_b32 v7,13,v30
v_lshl_add_u32 v7,v31,4,v7
v_lshlrev_b32 v8,11,v30
v_lshl_add_u32 v8,v31,4,v8
s_lshr_b32 s58,s57,5
s_and_b32 s59,s57,31
s_xor_b32 s60,s57,0
s_lshl_b32 s60,s60,6
s_lshl_b32 s61,s50,14
s_lshl_b32 s62,s50,21
s_add_u32 s62,s62,s60
s_lshl_b32 s63,s58,21
s_lshl_b32 s64,s50,19
s_add_u32 s63,s63,s64
s_xor_b32 s64,s59,0
s_lshl_b32 s64,s64,6
s_add_u32 s63,s63,s64
s_waitcnt lgkmcnt(0)
s_mov_b32 s28,s8
s_and_b32 s29,s9,0xffff
s_mov_b32 s30,0x800000
s_mov_b32 s31,0x20000
s_mov_b32 s32,s10
s_and_b32 s33,s11,0xffff
s_mov_b32 s34,0x800000
s_mov_b32 s35,0x20000
s_mov_b32 s36,s6
s_and_b32 s37,s7,0xffff
s_mov_b32 s38,0x800000
s_mov_b32 s39,0x20000
s_mov_b32 s40,s12
s_and_b32 s41,s13,0xffff
s_mov_b32 s42,0x800000
s_mov_b32 s43,0x20000
s_mov_b32 s8,s4
s_and_b32 s9,s5,0xffff
s_mov_b32 s10,0x4000
s_mov_b32 s11,0x20000
v_lshlrev_b32 v9,7,v3
v_lshl_add_u32 v10,v4,11,v9
v_lshl_add_u32 v9,v4,13,v9
s_lshl_b32 s64,s59,2
s_add_u32 s64,s64,s50
s_lshl_b32 s65,s64,16
s_lshl_b32 s66,s58,11
s_add_u32 s65,s65,s66
s_lshl_b32 s66,s64,14
s_lshl_b32 s67,s58,21
s_add_u32 s66,s66,s67
v_and_b32 v9,7,v1
v_lshrrev_b32 v10,3,v1
s_cmp_eq_u32 s58,3
s_cselect_b32 s64,15,3
v_mov_b32 v11,3
v_cmp_eq_u32 vcc,1,v10
s_nop 1
v_cndmask_b32 v11,v11,11,vcc
v_lshlrev_b32 v12,7,v11
v_lshl_add_u32 v12,v9,11,v12
v_mov_b32 v13,s64
v_cmp_eq_u32 vcc,2,v10
s_nop 1
v_cndmask_b32 v11,v11,v13,vcc
v_lshlrev_b32 v11,7,v11
v_lshl_add_u32 v11,v9,13,v11
v_mov_b32 v100,0
v_mov_b32 v101,0
v_mov_b32 v102,0
v_mov_b32 v103,0
s_mov_b32 s53,s65
s_mov_b32 s55,s66
v_and_b32 v22,7,v3
v_lshlrev_b32 v31,11,v22
v_lshl_add_u32 v31,v4,4,v31
s_lshr_b32 s64,s59,3
s_lshl_b32 s64,s64,14
s_and_b32 s65,s59,7
s_lshl_b32 s65,s65,10
s_add_u32 s64,s64,s65
s_lshl_b32 s65,s58,16
s_add_u32 s64,s64,s65
s_add_u32 s64,s64,31195136
s_lshr_b32 s65,s57,3
s_add_u32 s65,s65,96
s_lshl_b32 s65,s65,14
s_and_b32 s66,s57,7
s_lshl_b32 s66,s66,10
s_add_u32 s65,s65,s66
s_add_u32 s65,s65,29360128
v_add_u32 v206,s64,v16
v_add_u32 v207,s65,v16
s_and_b32 s64,s50,1
s_lshl_b32 s64,s64,21
s_lshr_b32 s65,s50,1
s_lshl_b32 s65,s65,13
s_add_u32 s64,s64,s65
buffer_store_dwordx4 v[100:103],v206,s[20:23],s64 offen sc1
buffer_store_dwordx4 v[100:103],v207,s[20:23],s64 offen sc1
s_lshl_b32 s64,s50,20
s_add_u32 s64,s64,23068672
s_cmp_lt_u32 s50,2
s_cselect_b32 s67,s64,0x7fff0000
s_lshl_b32 s65,s57,10
s_add_u32 s65,s65,131072
s_add_u32 s65,s65,s67
buffer_store_dwordx4 v[100:103],v16,s[20:23],s65 offen sc1
s_lshl_b32 s65,s57,9
s_add_u32 s65,s65,s67
s_add_u32 s66,s65,65536
s_mov_b32 exec_hi,0
buffer_store_dwordx4 v[100:103],v16,s[20:23],s65 offen sc1
buffer_store_dwordx4 v[100:103],v16,s[20:23],s66 offen sc1
s_lshl_b32 s65,s57,2
s_add_u32 s65,s65,s64
s_add_u32 s65,s65,524288
s_lshl_b32 s52,s57,7
s_add_u32 s52,s52,21168128
s_mov_b64 exec,1
buffer_store_dword v100,v100,s[20:23],s65 offen sc1
buffer_store_dword v100,v100,s[20:23],s65 offen offset:512 sc1
s_mov_b64 exec,15
buffer_store_dwordx4 v[100:103],v16,s[20:23],s52 offen sc1
s_mov_b64 exec,-1
s_mov_b32 s65,s53
s_mov_b32 s66,s55
v_mov_b32 v37,159008
ds_write_b128 v37,v[100:103]
s_add_u32 s64,s62,0
s_add_u32 m0,s61,0
s_nop 0
buffer_load_dwordx4 v7,s[28:31],s64 offen nt lds
s_add_u32 s64,s62,131072
s_add_u32 m0,s61,1024
s_nop 0
buffer_load_dwordx4 v7,s[28:31],s64 offen nt lds
s_add_u32 s64,s62,262144
s_add_u32 m0,s61,2048
s_nop 0
buffer_load_dwordx4 v7,s[28:31],s64 offen nt lds
s_add_u32 s64,s62,393216
s_add_u32 m0,s61,3072
s_nop 0
buffer_load_dwordx4 v7,s[28:31],s64 offen nt lds
s_add_u32 s64,s62,524288
s_add_u32 m0,s61,4096
s_nop 0
buffer_load_dwordx4 v7,s[28:31],s64 offen nt lds
s_add_u32 s64,s62,655360
s_add_u32 m0,s61,5120
s_nop 0
buffer_load_dwordx4 v7,s[28:31],s64 offen nt lds
s_add_u32 s64,s62,786432
s_add_u32 m0,s61,6144
s_nop 0
buffer_load_dwordx4 v7,s[28:31],s64 offen nt lds
s_add_u32 s64,s62,917504
s_add_u32 m0,s61,7168
s_nop 0
buffer_load_dwordx4 v7,s[28:31],s64 offen nt lds
s_waitcnt vmcnt(8) lgkmcnt(0)
s_barrier
s_cmp_lg_u32 s50,1
s_cbranch_scc1 ws_11
s_and_b32 s64,s56,1
s_lshl_b32 s64,s64,2
s_add_u32 s64,s64,36
s_mov_b64 exec,1
v_mov_b32 v184,1
v_mov_b32 v185,0
buffer_atomic_add v184,v185,s[44:47],s64 offen sc1
s_mov_b64 exec,-1
ws_11:
s_add_u32 s64,s62,1048576
s_add_u32 m0,s61,8192
s_nop 0
buffer_load_dwordx4 v7,s[28:31],s64 offen nt lds
s_add_u32 s64,s62,1179648
s_add_u32 m0,s61,9216
s_nop 0
buffer_load_dwordx4 v7,s[28:31],s64 offen nt lds
s_add_u32 s64,s62,1310720
s_add_u32 m0,s61,10240
s_nop 0
buffer_load_dwordx4 v7,s[28:31],s64 offen nt lds
s_add_u32 s64,s62,1441792
s_add_u32 m0,s61,11264
s_nop 0
buffer_load_dwordx4 v7,s[28:31],s64 offen nt lds
s_add_u32 s64,s62,1572864
s_add_u32 m0,s61,12288
s_nop 0
buffer_load_dwordx4 v7,s[28:31],s64 offen nt lds
s_add_u32 s64,s62,1703936
s_add_u32 m0,s61,13312
s_nop 0
buffer_load_dwordx4 v7,s[28:31],s64 offen nt lds
s_add_u32 s64,s62,1835008
s_add_u32 m0,s61,14336
s_nop 0
buffer_load_dwordx4 v7,s[28:31],s64 offen nt lds
s_add_u32 s64,s62,1966080
s_add_u32 m0,s61,15360
s_nop 0
buffer_load_dwordx4 v7,s[28:31],s64 offen nt lds
s_mov_b64 exec,0xffffff
buffer_load_dword v201,v11,s[32:35],s65 offen
buffer_load_dword v202,v11,s[36:39],s65 offen
s_mov_b64 exec,0xffff
buffer_load_dword v203,v12,s[40:43],s66 offen
s_mov_b64 exec,-1
s_add_u32 s64,s62,0
s_add_u32 m0,s61,65536
s_nop 0
buffer_load_dwordx4 v7,s[32:35],s64 offen nt lds
s_add_u32 s64,s62,131072
s_add_u32 m0,s61,66560
s_nop 0
buffer_load_dwordx4 v7,s[32:35],s64 offen nt lds
s_add_u32 s64,s62,262144
s_add_u32 m0,s61,67584
s_nop 0
buffer_load_dwordx4 v7,s[32:35],s64 offen nt lds
s_add_u32 s64,s62,393216
s_add_u32 m0,s61,68608
s_nop 0
buffer_load_dwordx4 v7,s[32:35],s64 offen nt lds
s_add_u32 s64,s62,524288
s_add_u32 m0,s61,69632
s_nop 0
buffer_load_dwordx4 v7,s[32:35],s64 offen nt lds
s_add_u32 s64,s62,655360
s_add_u32 m0,s61,70656
s_nop 0
buffer_load_dwordx4 v7,s[32:35],s64 offen nt lds
s_add_u32 s64,s62,786432
s_add_u32 m0,s61,71680
s_nop 0
buffer_load_dwordx4 v7,s[32:35],s64 offen nt lds
s_add_u32 s64,s62,917504
s_add_u32 m0,s61,72704
s_nop 0
buffer_load_dwordx4 v7,s[32:35],s64 offen nt lds
s_add_u32 s64,s62,1048576
s_add_u32 m0,s61,73728
s_nop 0
buffer_load_dwordx4 v7,s[32:35],s64 offen nt lds
s_add_u32 s64,s62,1179648
s_add_u32 m0,s61,74752
s_nop 0
buffer_load_dwordx4 v7,s[32:35],s64 offen nt lds
s_add_u32 s64,s62,1310720
s_add_u32 m0,s61,75776
s_nop 0
buffer_load_dwordx4 v7,s[32:35],s64 offen nt lds
s_add_u32 s64,s62,1441792
s_add_u32 m0,s61,76800
s_nop 0
buffer_load_dwordx4 v7,s[32:35],s64 offen nt lds
s_add_u32 s64,s62,1572864
s_add_u32 m0,s61,77824
s_nop 0
buffer_load_dwordx4 v7,s[32:35],s64 offen nt lds
s_add_u32 s64,s62,1703936
s_add_u32 m0,s61,78848
s_nop 0
buffer_load_dwordx4 v7,s[32:35],s64 offen nt lds
s_add_u32 s64,s62,1835008
s_add_u32 m0,s61,79872
s_nop 0
buffer_load_dwordx4 v7,s[32:35],s64 offen nt lds
s_add_u32 s64,s62,1966080
s_add_u32 m0,s61,80896
s_nop 0
buffer_load_dwordx4 v7,s[32:35],s64 offen nt lds
s_lshl_b32 s64,s59,6
buffer_load_dwordx4 v[216:219],v31,s[8:11],s64 offen
v_lshrrev_b32 v184,3,v3
v_bfe_u32 v185,v3,2,1
v_lshrrev_b32 v186,1,v4
v_and_b32 v187,1,v4
v_lshl_add_u32 v188,v184,3,v185
v_lshl_add_u32 v188,v186,4,v188
v_lshl_add_u32 v188,v187,2,v188
v_lshl_add_u32 v189,v184,2,v185
v_lshl_add_u32 v189,v186,3,v189
v_lshl_add_u32 v189,v187,4,v189
v_and_b32 v187,3,v3
v_lshlrev_b32 v187,3,v187
v_lshl_add_u32 v188,v188,6,v187
v_lshl_add_u32 v189,v189,6,v187
s_lshr_b32 s64,s50,1
s_lshl_b32 s64,s64,5
v_add_u32 v190,s64,v188
v_add_u32 v191,0x10000,v190
s_lshl_b32 s64,s64,10
v_add_u32 v192,s64,v189
s_add_u32 s64,s61,0x10000
v_add_u32 v193,s64,v16
s_add_u32 s68,s50,1
s_mov_b32 s69,0
s_waitcnt vmcnt(20)
s_barrier
s_lshl_b32 s64,s57,9
v_mov_b32 v194,s64
s_add_u32 s65,s64,65024
v_mov_b32 v195,s65
v_cmp_lt_u32 vcc,3,v1
s_nop 1
v_cndmask_b32 v194,v194,v195,vcc
s_lshl_b32 s65,s57,10
s_add_u32 s65,s65,130048
v_mov_b32 v195,s65
v_cmp_lt_u32 vcc,7,v1
s_nop 1
v_cndmask_b32 v194,v194,v195,vcc
s_lshl_b32 s65,s57,11
s_add_u32 s65,s65,260096
v_mov_b32 v195,s65
v_cmp_lt_u32 vcc,15,v1
s_nop 1
v_cndmask_b32 v194,v194,v195,vcc
v_lshl_add_u32 v194,v1,7,v194
s_lshl_b32 s65,s58,7
s_add_u32 s65,s65,524288
v_writelane_b32 v194,s65,32
s_add_u32 s65,s65,512
v_writelane_b32 v194,s65,33
s_lshl_b32 s64,s50,20
s_add_u32 s64,s64,23068672
s_mov_b32 exec_hi,3
buffer_load_dword v183,v194,s[20:23],s64 offen sc1
s_mov_b64 exec,-1
s_and_b32 s65,s50,1
s_lshl_b32 s14,s65,19
s_add_u32 s14,s14,s60
s_lshl_b32 s15,s65,19
s_sub_u32 s15,s63,s15
s_lshl_b32 s65,s65,13
s_add_u32 s65,s65,131072
v_mov_b32 v32,v8
v_add_u32 v33,s65,v16
v_add_u32 v34,s65,v189
v_mov_b32 v35,v7
v_add_u32 v36,131072,v190
v_mov_b32 v37,159008
s_bitcmp1_b32 s68,1
s_cbranch_scc0 ws_12
ds_read_b64_tr_b16 a[0:1],v190 offset:0
ds_read_b64_tr_b16 a[2:3],v190 offset:128
ds_read_b64_tr_b16 a[4:5],v190 offset:2048
ds_read_b64_tr_b16 a[6:7],v190 offset:2176
ds_read_b64_tr_b16 a[8:9],v190 offset:4096
ds_read_b64_tr_b16 a[10:11],v190 offset:4224
ds_read_b64_tr_b16 a[12:13],v190 offset:6144
ds_read_b64_tr_b16 a[14:15],v190 offset:6272
s_waitcnt lgkmcnt(0)
ds_read_b64_tr_b16 a[16:17],v190 offset:8192
ds_read_b64_tr_b16 a[18:19],v190 offset:8320
ds_read_b64_tr_b16 a[20:21],v190 offset:10240
ds_read_b64_tr_b16 a[22:23],v190 offset:10368
ds_read_b64_tr_b16 a[24:25],v190 offset:12288
ds_read_b64_tr_b16 a[26:27],v190 offset:12416
ds_read_b64_tr_b16 a[28:29],v190 offset:14336
ds_read_b64_tr_b16 a[30:31],v190 offset:14464
s_waitcnt lgkmcnt(0)
ds_read_b64_tr_b16 a[32:33],v190 offset:16384
ds_read_b64_tr_b16 a[34:35],v190 offset:16512
ds_read_b64_tr_b16 a[36:37],v190 offset:18432
ds_read_b64_tr_b16 a[38:39],v190 offset:18560
ds_read_b64_tr_b16 a[40:41],v190 offset:20480
ds_read_b64_tr_b16 a[42:43],v190 offset:20608
ds_read_b64_tr_b16 a[44:45],v190 offset:22528
ds_read_b64_tr_b16 a[46:47],v190 offset:22656
s_waitcnt lgkmcnt(0)
ds_read_b64_tr_b16 a[48:49],v190 offset:24576
ds_read_b64_tr_b16 a[50:51],v190 offset:24704
ds_read_b64_tr_b16 a[52:53],v190 offset:26624
ds_read_b64_tr_b16 a[54:55],v190 offset:26752
ds_read_b64_tr_b16 a[56:57],v190 offset:28672
ds_read_b64_tr_b16 a[58:59],v190 offset:28800
ds_read_b64_tr_b16 a[60:61],v190 offset:30720
ds_read_b64_tr_b16 a[62:63],v190 offset:30848
s_waitcnt lgkmcnt(0)
ds_read_b64_tr_b16 a[64:65],v190 offset:32768
ds_read_b64_tr_b16 a[66:67],v190 offset:32896
ds_read_b64_tr_b16 a[68:69],v190 offset:34816
ds_read_b64_tr_b16 a[70:71],v190 offset:34944
ds_read_b64_tr_b16 a[72:73],v190 offset:36864
ds_read_b64_tr_b16 a[74:75],v190 offset:36992
ds_read_b64_tr_b16 a[76:77],v190 offset:38912
ds_read_b64_tr_b16 a[78:79],v190 offset:39040
s_waitcnt lgkmcnt(0)
ds_read_b64_tr_b16 a[80:81],v190 offset:40960
ds_read_b64_tr_b16 a[82:83],v190 offset:41088
ds_read_b64_tr_b16 a[84:85],v190 offset:43008
ds_read_b64_tr_b16 a[86:87],v190 offset:43136
ds_read_b64_tr_b16 a[88:89],v190 offset:45056
ds_read_b64_tr_b16 a[90:91],v190 offset:45184
ds_read_b64_tr_b16 a[92:93],v190 offset:47104
ds_read_b64_tr_b16 a[94:95],v190 offset:47232
s_waitcnt lgkmcnt(0)
ds_read_b64_tr_b16 a[96:97],v190 offset:49152
ds_read_b64_tr_b16 a[98:99],v190 offset:49280
ds_read_b64_tr_b16 a[100:101],v190 offset:51200
ds_read_b64_tr_b16 a[102:103],v190 offset:51328
ds_read_b64_tr_b16 a[104:105],v190 offset:53248
ds_read_b64_tr_b16 a[106:107],v190 offset:53376
ds_read_b64_tr_b16 a[108:109],v190 offset:55296
ds_read_b64_tr_b16 a[110:111],v190 offset:55424
s_waitcnt lgkmcnt(0)
ds_read_b64_tr_b16 a[112:113],v190 offset:57344
ds_read_b64_tr_b16 a[114:115],v190 offset:57472
ds_read_b64_tr_b16 a[116:117],v190 offset:59392
ds_read_b64_tr_b16 a[118:119],v190 offset:59520
ds_read_b64_tr_b16 a[120:121],v190 offset:61440
ds_read_b64_tr_b16 a[122:123],v190 offset:61568
ds_read_b64_tr_b16 a[124:125],v190 offset:63488
ds_read_b64_tr_b16 a[126:127],v190 offset:63616
s_waitcnt lgkmcnt(0)
s_waitcnt vmcnt(0)
s_barrier
ds_read_b64_tr_b16 a[128:129],v191 offset:0
ds_read_b64_tr_b16 a[130:131],v191 offset:128
ds_read_b64_tr_b16 a[132:133],v191 offset:2048
ds_read_b64_tr_b16 a[134:135],v191 offset:2176
ds_read_b64_tr_b16 a[136:137],v191 offset:4096
ds_read_b64_tr_b16 a[138:139],v191 offset:4224
ds_read_b64_tr_b16 a[140:141],v191 offset:6144
ds_read_b64_tr_b16 a[142:143],v191 offset:6272
s_waitcnt lgkmcnt(0)
ds_read_b64_tr_b16 a[144:145],v191 offset:8192
ds_read_b64_tr_b16 a[146:147],v191 offset:8320
ds_read_b64_tr_b16 a[148:149],v191 offset:10240
ds_read_b64_tr_b16 a[150:151],v191 offset:10368
ds_read_b64_tr_b16 a[152:153],v191 offset:12288
ds_read_b64_tr_b16 a[154:155],v191 offset:12416
ds_read_b64_tr_b16 a[156:157],v191 offset:14336
ds_read_b64_tr_b16 a[158:159],v191 offset:14464
s_waitcnt lgkmcnt(0)
ds_read_b64_tr_b16 a[160:161],v191 offset:16384
ds_read_b64_tr_b16 a[162:163],v191 offset:16512
ds_read_b64_tr_b16 a[164:165],v191 offset:18432
ds_read_b64_tr_b16 a[166:167],v191 offset:18560
ds_read_b64_tr_b16 a[168:169],v191 offset:20480
ds_read_b64_tr_b16 a[170:171],v191 offset:20608
ds_read_b64_tr_b16 a[172:173],v191 offset:22528
ds_read_b64_tr_b16 a[174:175],v191 offset:22656
s_waitcnt lgkmcnt(0)
ds_read_b64_tr_b16 a[176:177],v191 offset:24576
ds_read_b64_tr_b16 a[178:179],v191 offset:24704
ds_read_b64_tr_b16 a[180:181],v191 offset:26624
ds_read_b64_tr_b16 a[182:183],v191 offset:26752
ds_read_b64_tr_b16 a[184:185],v191 offset:28672
ds_read_b64_tr_b16 a[186:187],v191 offset:28800
ds_read_b64_tr_b16 a[188:189],v191 offset:30720
ds_read_b64_tr_b16 a[190:191],v191 offset:30848
s_waitcnt lgkmcnt(0)
ds_read_b64_tr_b16 a[192:193],v191 offset:32768
ds_read_b64_tr_b16 a[194:195],v191 offset:32896
ds_read_b64_tr_b16 a[196:197],v191 offset:34816
ds_read_b64_tr_b16 a[198:199],v191 offset:34944
ds_read_b64_tr_b16 a[200:201],v191 offset:36864
ds_read_b64_tr_b16 a[202:203],v191 offset:36992
ds_read_b64_tr_b16 a[204:205],v191 offset:38912
ds_read_b64_tr_b16 a[206:207],v191 offset:39040
s_waitcnt lgkmcnt(0)
ds_read_b64_tr_b16 a[208:209],v191 offset:40960
ds_read_b64_tr_b16 a[210:211],v191 offset:41088
ds_read_b64_tr_b16 a[212:213],v191 offset:43008
ds_read_b64_tr_b16 a[214:215],v191 offset:43136
ds_read_b64_tr_b16 a[216:217],v191 offset:45056
ds_read_b64_tr_b16 a[218:219],v191 offset:45184
ds_read_b64_tr_b16 a[220:221],v191 offset:47104
ds_read_b64_tr_b16 a[222:223],v191 offset:47232
s_waitcnt lgkmcnt(0)
ds_read_b64_tr_b16 a[224:225],v191 offset:49152
ds_read_b64_tr_b16 a[226:227],v191 offset:49280
ds_read_b64_tr_b16 a[228:229],v191 offset:51200
ds_read_b64_tr_b16 a[230:231],v191 offset:51328
ds_read_b64_tr_b16 a[232:233],v191 offset:53248
ds_read_b64_tr_b16 a[234:235],v191 offset:53376
ds_read_b64_tr_b16 a[236:237],v191 offset:55296
ds_read_b64_tr_b16 a[238:239],v191 offset:55424
s_waitcnt lgkmcnt(0)
ds_read_b64_tr_b16 a[240:241],v191 offset:57344
ds_read_b64_tr_b16 a[242:243],v191 offset:57472
ds_read_b64_tr_b16 a[244:245],v191 offset:59392
ds_read_b64_tr_b16 a[246:247],v191 offset:59520
ds_read_b64_tr_b16 a[248:249],v191 offset:61440
ds_read_b64_tr_b16 a[250:251],v191 offset:61568
ds_read_b64_tr_b16 a[252:253],v191 offset:63488
ds_read_b64_tr_b16 a[254:255],v191 offset:63616
s_waitcnt lgkmcnt(0)
s_branch ws_14
ws_12:
s_add_u32 s64,s14,0
buffer_load_dwordx4 a[0:3],v35,s[36:39],s64 offen nt
s_add_u32 s64,s14,131072
buffer_load_dwordx4 a[4:7],v35,s[36:39],s64 offen nt
s_add_u32 s64,s14,262144
buffer_load_dwordx4 a[8:11],v35,s[36:39],s64 offen nt
s_add_u32 s64,s14,393216
buffer_load_dwordx4 a[12:15],v35,s[36:39],s64 offen nt
s_add_u32 s64,s14,1048576
buffer_load_dwordx4 a[16:19],v35,s[36:39],s64 offen nt
s_add_u32 s64,s14,1179648
buffer_load_dwordx4 a[20:23],v35,s[36:39],s64 offen nt
s_add_u32 s64,s14,1310720
buffer_load_dwordx4 a[24:27],v35,s[36:39],s64 offen nt
s_add_u32 s64,s14,1441792
buffer_load_dwordx4 a[28:31],v35,s[36:39],s64 offen nt
s_add_u32 s64,s14,2097152
buffer_load_dwordx4 a[32:35],v35,s[36:39],s64 offen nt
s_add_u32 s64,s14,2228224
buffer_load_dwordx4 a[36:39],v35,s[36:39],s64 offen nt
s_add_u32 s64,s14,2359296
buffer_load_dwordx4 a[40:43],v35,s[36:39],s64 offen nt
s_add_u32 s64,s14,2490368
buffer_load_dwordx4 a[44:47],v35,s[36:39],s64 offen nt
s_add_u32 s64,s14,3145728
buffer_load_dwordx4 a[48:51],v35,s[36:39],s64 offen nt
s_add_u32 s64,s14,3276800
buffer_load_dwordx4 a[52:55],v35,s[36:39],s64 offen nt
s_add_u32 s64,s14,3407872
buffer_load_dwordx4 a[56:59],v35,s[36:39],s64 offen nt
s_add_u32 s64,s14,3538944
buffer_load_dwordx4 a[60:63],v35,s[36:39],s64 offen nt
s_add_u32 s64,s14,4194304
buffer_load_dwordx4 a[64:67],v35,s[36:39],s64 offen nt
s_add_u32 s64,s14,4325376
buffer_load_dwordx4 a[68:71],v35,s[36:39],s64 offen nt
s_add_u32 s64,s14,4456448
buffer_load_dwordx4 a[72:75],v35,s[36:39],s64 offen nt
s_add_u32 s64,s14,4587520
buffer_load_dwordx4 a[76:79],v35,s[36:39],s64 offen nt
s_add_u32 s64,s14,5242880
buffer_load_dwordx4 a[80:83],v35,s[36:39],s64 offen nt
s_add_u32 s64,s14,5373952
buffer_load_dwordx4 a[84:87],v35,s[36:39],s64 offen nt
s_add_u32 s64,s14,5505024
buffer_load_dwordx4 a[88:91],v35,s[36:39],s64 offen nt
s_add_u32 s64,s14,5636096
buffer_load_dwordx4 a[92:95],v35,s[36:39],s64 offen nt
s_add_u32 s64,s14,6291456
buffer_load_dwordx4 a[96:99],v35,s[36:39],s64 offen nt
s_add_u32 s64,s14,6422528
buffer_load_dwordx4 a[100:103],v35,s[36:39],s64 offen nt
s_add_u32 s64,s14,6553600
buffer_load_dwordx4 a[104:107],v35,s[36:39],s64 offen nt
s_add_u32 s64,s14,6684672
buffer_load_dwordx4 a[108:111],v35,s[36:39],s64 offen nt
s_add_u32 s64,s14,7340032
buffer_load_dwordx4 a[112:115],v35,s[36:39],s64 offen nt
s_add_u32 s64,s14,7471104
buffer_load_dwordx4 a[116:119],v35,s[36:39],s64 offen nt
s_add_u32 s64,s14,7602176
buffer_load_dwordx4 a[120:123],v35,s[36:39],s64 offen nt
s_add_u32 s64,s14,7733248
buffer_load_dwordx4 a[124:127],v35,s[36:39],s64 offen nt
s_add_u32 s64,s15,0
buffer_load_dwordx4 a[128:131],v32,s[40:43],s64 offen nt
s_add_u32 s64,s15,32768
buffer_load_dwordx4 a[132:135],v32,s[40:43],s64 offen nt
s_add_u32 s64,s15,65536
buffer_load_dwordx4 a[136:139],v32,s[40:43],s64 offen nt
s_add_u32 s64,s15,98304
buffer_load_dwordx4 a[140:143],v32,s[40:43],s64 offen nt
s_add_u32 s64,s15,131072
buffer_load_dwordx4 a[144:147],v32,s[40:43],s64 offen nt
s_add_u32 s64,s15,163840
buffer_load_dwordx4 a[148:151],v32,s[40:43],s64 offen nt
s_add_u32 s64,s15,196608
buffer_load_dwordx4 a[152:155],v32,s[40:43],s64 offen nt
s_add_u32 s64,s15,229376
buffer_load_dwordx4 a[156:159],v32,s[40:43],s64 offen nt
s_add_u32 s64,s15,262144
buffer_load_dwordx4 a[160:163],v32,s[40:43],s64 offen nt
s_add_u32 s64,s15,294912
buffer_load_dwordx4 a[164:167],v32,s[40:43],s64 offen nt
s_add_u32 s64,s15,327680
buffer_load_dwordx4 a[168:171],v32,s[40:43],s64 offen nt
s_add_u32 s64,s15,360448
buffer_load_dwordx4 a[172:175],v32,s[40:43],s64 offen nt
s_waitcnt vmcnt(44)
s_barrier
ws_14:
v_mov_b32 v187,158976
s_cmp_lg_u32 s50,1
s_cbranch_scc1 sh0_17
s_mov_b32 s53,0
stl_18:
s_add_u32 s64,s52,32
s_buffer_load_dwordx8 s[72:79],s[20:23],s52 glc
s_buffer_load_dwordx8 s[80:87],s[20:23],s64 glc
s_waitcnt lgkmcnt(0)
s_min_u32 s72,s72,s80
s_min_u32 s73,s73,s81
s_min_u32 s74,s74,s82
s_min_u32 s75,s75,s83
s_min_u32 s76,s76,s84
s_min_u32 s77,s77,s85
s_min_u32 s78,s78,s86
s_min_u32 s79,s79,s87
s_min_u32 s72,s72,s76
s_min_u32 s73,s73,s77
s_min_u32 s74,s74,s78
s_min_u32 s75,s75,s79
s_min_u32 s72,s72,s74
s_min_u32 s73,s73,s75
s_min_u32 s64,s72,s73
s_mov_b32 s65,0
s_and_b32 s61,s64,1
s_lshl_b32 s61,s61,13
s_cmp_lg_u32 s64,0
s_cbranch_scc1 stok_19
s_sub_u32 s90,s90,1
s_cmp_lt_i32 s90,0
s_cbranch_scc1 stok_19
s_add_u32 s53,s53,1
s_and_b32 s64,s53,31
s_cbranch_scc1 stl_18
s_cmp_eq_u32 s56,1
s_cbranch_scc1 stl_18
v_and_b32 v184,3,v1
v_bfe_u32 v185,v1,2,1
v_lshlrev_b32 v184,2,v184
v_lshl_add_u32 v184,v185,7,v184
v_writelane_b32 v184,32,8
s_mov_b64 exec,0x1ff
vpoll_20:
buffer_load_dword v185,v184,s[44:47],0 offen sc1
s_waitcnt vmcnt(0)
vfirst_23:
v_readlane_b32 s92,v185,0
v_readlane_b32 s93,v185,1
v_readlane_b32 s94,v185,2
v_readlane_b32 s95,v185,3
v_readlane_b32 s96,v185,4
v_readlane_b32 s97,v185,5
v_readlane_b32 s98,v185,6
v_readlane_b32 s99,v185,7
v_readlane_b32 s61,v185,8
s_add_u32 s64,s92,s93
s_add_u32 s64,s64,s94
s_add_u32 s64,s64,s95
s_add_u32 s64,s64,s96
s_add_u32 s64,s64,s97
s_add_u32 s64,s64,s98
s_add_u32 s64,s64,s99
s_min_u32 s65,s92,s93
s_min_u32 s66,s94,s95
s_min_u32 s65,s65,s66
s_min_u32 s66,s96,s97
s_min_u32 s65,s65,s66
s_min_u32 s66,s98,s99
s_min_u32 s65,s65,s66
s_cmp_lt_u32 s65,32
s_cselect_b32 s65,1,0
s_cmp_lt_u32 s64,256
s_cbranch_scc1 vslp_22
s_branch vgot_21
vslp_22:
s_sleep 8
s_sub_u32 s90,s90,1
s_cmp_gt_i32 s90,0
s_cbranch_scc1 vpoll_20
vgot_21:
s_mov_b64 exec,-1
s_and_b32 s61,s61,1
s_lshl_b32 s61,s61,13
s_mov_b32 s66,s54
s_cmp_gt_u32 s51,0
s_cselect_b32 s64,s92,0
s_add_u32 s66,s66,s64
s_cmp_gt_u32 s51,1
s_cselect_b32 s64,s93,0
s_add_u32 s66,s66,s64
s_cmp_gt_u32 s51,2
s_cselect_b32 s64,s94,0
s_add_u32 s66,s66,s64
s_cmp_gt_u32 s51,3
s_cselect_b32 s64,s95,0
s_add_u32 s66,s66,s64
s_cmp_gt_u32 s51,4
s_cselect_b32 s64,s96,0
s_add_u32 s66,s66,s64
s_cmp_gt_u32 s51,5
s_cselect_b32 s64,s97,0
s_add_u32 s66,s66,s64
s_cmp_gt_u32 s51,6
s_cselect_b32 s64,s98,0
s_add_u32 s66,s66,s64
s_cmp_eq_u32 s65,0
s_cbranch_scc1 stl_18
stok_19:
v_mov_b32 v184,s65
v_mov_b32 v185,s66
v_mov_b32 v186,s61
ds_write_b96 v187,v[184:186] offset:16
s_waitcnt lgkmcnt(0)
sh0_17:
s_barrier
ds_read_b96 v[184:186],v187 offset:16
s_waitcnt lgkmcnt(0)
v_readfirstlane_b32 s65,v184
v_readfirstlane_b32 s66,v185
v_readfirstlane_b32 s61,v186
s_cmp_lg_u32 s65,0
s_cbranch_scc1 slowrole_10
s_and_b32 s56,s56,1
s_branch loops_7
pre_8:
s_sub_u32 s55,s57,128
s_load_dwordx4 s[4:7],s[0:1],96
s_load_dwordx2 s[8:9],s[0:1],0
v_and_b32 v1,63,v0
v_lshrrev_b32 v2,6,v0
v_and_b32 v3,7,v0
v_lshrrev_b32 v4,3,v0
v_mul_u32_u24 v5,12288,v4
v_lshl_add_u32 v5,v3,4,v5
v_lshlrev_b32 v6,1,v4
s_and_b32 s24,s55,31
s_lshr_b32 s25,s55,5
s_lshl_b32 s26,s24,7
s_mul_i32 s27,s25,3145728
s_add_u32 s26,s26,s27
s_lshl_b32 s27,s25,9
s_waitcnt lgkmcnt(0)
s_mov_b32 s12,s4
s_and_b32 s13,s5,0xffff
s_mov_b32 s14,0x800
s_mov_b32 s15,0x20000
s_mov_b32 s28,s6
s_and_b32 s29,s7,0xffff
s_mov_b32 s30,0xc00000
s_mov_b32 s31,0x20000
s_mov_b32 s32,s8
s_and_b32 s33,s9,0xffff
s_mov_b32 s34,0x400000
s_mov_b32 s35,0x20000
buffer_load_dwordx4 v[64:67],v5,s[28:31],s26 offen nt
s_add_u32 s26,s26,393216
buffer_load_dwordx4 v[68:71],v5,s[28:31],s26 offen nt
s_add_u32 s26,s26,393216
buffer_load_dwordx4 v[72:75],v5,s[28:31],s26 offen nt
s_add_u32 s26,s26,393216
buffer_load_dwordx4 v[76:79],v5,s[28:31],s26 offen nt
s_add_u32 s26,s26,393216
buffer_load_dwordx4 v[80:83],v5,s[28:31],s26 offen nt
s_add_u32 s26,s26,393216
buffer_load_dwordx4 v[84:87],v5,s[28:31],s26 offen nt
s_add_u32 s26,s26,393216
buffer_load_dwordx4 v[88:91],v5,s[28:31],s26 offen nt
s_add_u32 s26,s26,393216
buffer_load_dwordx4 v[92:95],v5,s[28:31],s26 offen nt
buffer_load_ushort v96,v6,s[12:15],s27 offen offset:0
buffer_load_ushort v97,v6,s[12:15],s27 offen offset:64
buffer_load_ushort v98,v6,s[12:15],s27 offen offset:128
buffer_load_ushort v99,v6,s[12:15],s27 offen offset:192
buffer_load_ushort v100,v6,s[12:15],s27 offen offset:256
buffer_load_ushort v101,v6,s[12:15],s27 offen offset:320
buffer_load_ushort v102,v6,s[12:15],s27 offen offset:384
buffer_load_ushort v103,v6,s[12:15],s27 offen offset:448
v_and_b32 v3,3,v1
v_lshrrev_b32 v4,2,v1
v_lshl_add_u32 v5,v2,2,v3
v_lshlrev_b32 v5,11,v5
v_lshl_add_u32 v5,v4,5,v5
s_lshl_b32 s36,s55,15
s_cmp_lt_u32 s55,16
s_cselect_b32 s42,s36,0x7fff0000
s_cselect_b32 s36,0x7fff0000,s36
buffer_load_dwordx4 v[8:11],v5,s[32:35],s42 offen offset:0
buffer_load_dwordx4 v[12:15],v5,s[32:35],s42 offen offset:16
buffer_load_dwordx4 v[16:19],v5,s[32:35],s42 offen offset:512
buffer_load_dwordx4 v[20:23],v5,s[32:35],s42 offen offset:528
buffer_load_dwordx4 v[24:27],v5,s[32:35],s42 offen offset:1024
buffer_load_dwordx4 v[28:31],v5,s[32:35],s42 offen offset:1040
buffer_load_dwordx4 v[32:35],v5,s[32:35],s42 offen offset:1536
buffer_load_dwordx4 v[36:39],v5,s[32:35],s42 offen offset:1552
v_lshrrev_b32 v6,1,v4
v_lshlrev_b32 v6,11,v6
v_and_b32 v7,1,v4
v_lshl_add_u32 v6,v7,9,v6
v_and_b32 v7,1,v2
v_lshl_add_u32 v6,v7,10,v6
v_lshrrev_b32 v7,1,v2
v_lshl_add_u32 v7,v7,2,v3
v_lshl_add_u32 v6,v7,4,v6
v_lshlrev_b32 v4,6,v4
s_lshr_b32 s37,s55,1
s_lshl_b32 s37,s37,16
s_and_b32 s38,s55,1
s_lshl_b32 s38,s38,7
s_add_u32 s37,s37,s38
s_add_u32 s37,s37,57344
s_mov_b32 s38,0xbfb8aa3b
s_mov_b32 s39,0xffff0000
s_cmp_lg_u32 s50,1
s_cbranch_scc1 nz_24
s_lshl_b32 s40,s55,9
s_add_u32 s40,s40,21037056
v_lshl_add_u32 v104,v1,4,s40
s_lshl_b32 s41,s55,7
s_add_u32 s41,s41,21102592
v_writelane_b32 v104,s41,32
v_mov_b32 v108,0
v_mov_b32 v109,0
v_mov_b32 v110,0
v_mov_b32 v111,0
s_mov_b32 exec_hi,1
buffer_store_dwordx4 v[108:111],v104,s[20:23],0 offen sc1
s_mov_b64 exec,-1
nz_24:
v_mov_b32 v112,0
v_mov_b32 v113,0
v_mov_b32 v114,0
v_mov_b32 v115,0
v_mov_b32 v116,0
v_mov_b32 v117,0
v_mov_b32 v118,0
v_mov_b32 v119,0
s_waitcnt vmcnt(8)
v_lshlrev_b32 v96,16,v96
v_mul_f32 v104,s38,v96
v_exp_f32 v104,v104
s_nop 0
v_add_f32 v104,1.0,v104
v_rcp_f32 v104,v104
s_nop 0
v_mul_f32 v104,v104,v96
v_cvt_pk_bf16_f32 v104,v104,v104
v_and_b32 v96,s39,v104
v_lshlrev_b32 v105,16,v64
v_and_b32 v106,s39,v64
v_fmac_f32 v112,v105,v96
v_fmac_f32 v113,v106,v96
v_lshlrev_b32 v105,16,v65
v_and_b32 v106,s39,v65
v_fmac_f32 v114,v105,v96
v_fmac_f32 v115,v106,v96
v_lshlrev_b32 v105,16,v66
v_and_b32 v106,s39,v66
v_fmac_f32 v116,v105,v96
v_fmac_f32 v117,v106,v96
v_lshlrev_b32 v105,16,v67
v_and_b32 v106,s39,v67
v_fmac_f32 v118,v105,v96
v_fmac_f32 v119,v106,v96
v_lshlrev_b32 v97,16,v97
v_mul_f32 v104,s38,v97
v_exp_f32 v104,v104
s_nop 0
v_add_f32 v104,1.0,v104
v_rcp_f32 v104,v104
s_nop 0
v_mul_f32 v104,v104,v97
v_cvt_pk_bf16_f32 v104,v104,v104
v_and_b32 v97,s39,v104
v_lshlrev_b32 v105,16,v68
v_and_b32 v106,s39,v68
v_fmac_f32 v112,v105,v97
v_fmac_f32 v113,v106,v97
v_lshlrev_b32 v105,16,v69
v_and_b32 v106,s39,v69
v_fmac_f32 v114,v105,v97
v_fmac_f32 v115,v106,v97
v_lshlrev_b32 v105,16,v70
v_and_b32 v106,s39,v70
v_fmac_f32 v116,v105,v97
v_fmac_f32 v117,v106,v97
v_lshlrev_b32 v105,16,v71
v_and_b32 v106,s39,v71
v_fmac_f32 v118,v105,v97
v_fmac_f32 v119,v106,v97
v_lshlrev_b32 v98,16,v98
v_mul_f32 v104,s38,v98
v_exp_f32 v104,v104
s_nop 0
v_add_f32 v104,1.0,v104
v_rcp_f32 v104,v104
s_nop 0
v_mul_f32 v104,v104,v98
v_cvt_pk_bf16_f32 v104,v104,v104
v_and_b32 v98,s39,v104
v_lshlrev_b32 v105,16,v72
v_and_b32 v106,s39,v72
v_fmac_f32 v112,v105,v98
v_fmac_f32 v113,v106,v98
v_lshlrev_b32 v105,16,v73
v_and_b32 v106,s39,v73
v_fmac_f32 v114,v105,v98
v_fmac_f32 v115,v106,v98
v_lshlrev_b32 v105,16,v74
v_and_b32 v106,s39,v74
v_fmac_f32 v116,v105,v98
v_fmac_f32 v117,v106,v98
v_lshlrev_b32 v105,16,v75
v_and_b32 v106,s39,v75
v_fmac_f32 v118,v105,v98
v_fmac_f32 v119,v106,v98
v_lshlrev_b32 v99,16,v99
v_mul_f32 v104,s38,v99
v_exp_f32 v104,v104
s_nop 0
v_add_f32 v104,1.0,v104
v_rcp_f32 v104,v104
s_nop 0
v_mul_f32 v104,v104,v99
v_cvt_pk_bf16_f32 v104,v104,v104
v_and_b32 v99,s39,v104
v_lshlrev_b32 v105,16,v76
v_and_b32 v106,s39,v76
v_fmac_f32 v112,v105,v99
v_fmac_f32 v113,v106,v99
v_lshlrev_b32 v105,16,v77
v_and_b32 v106,s39,v77
v_fmac_f32 v114,v105,v99
v_fmac_f32 v115,v106,v99
v_lshlrev_b32 v105,16,v78
v_and_b32 v106,s39,v78
v_fmac_f32 v116,v105,v99
v_fmac_f32 v117,v106,v99
v_lshlrev_b32 v105,16,v79
v_and_b32 v106,s39,v79
v_fmac_f32 v118,v105,v99
v_fmac_f32 v119,v106,v99
v_lshlrev_b32 v100,16,v100
v_mul_f32 v104,s38,v100
v_exp_f32 v104,v104
s_nop 0
v_add_f32 v104,1.0,v104
v_rcp_f32 v104,v104
s_nop 0
v_mul_f32 v104,v104,v100
v_cvt_pk_bf16_f32 v104,v104,v104
v_and_b32 v100,s39,v104
v_lshlrev_b32 v105,16,v80
v_and_b32 v106,s39,v80
v_fmac_f32 v112,v105,v100
v_fmac_f32 v113,v106,v100
v_lshlrev_b32 v105,16,v81
v_and_b32 v106,s39,v81
v_fmac_f32 v114,v105,v100
v_fmac_f32 v115,v106,v100
v_lshlrev_b32 v105,16,v82
v_and_b32 v106,s39,v82
v_fmac_f32 v116,v105,v100
v_fmac_f32 v117,v106,v100
v_lshlrev_b32 v105,16,v83
v_and_b32 v106,s39,v83
v_fmac_f32 v118,v105,v100
v_fmac_f32 v119,v106,v100
v_lshlrev_b32 v101,16,v101
v_mul_f32 v104,s38,v101
v_exp_f32 v104,v104
s_nop 0
v_add_f32 v104,1.0,v104
v_rcp_f32 v104,v104
s_nop 0
v_mul_f32 v104,v104,v101
v_cvt_pk_bf16_f32 v104,v104,v104
v_and_b32 v101,s39,v104
v_lshlrev_b32 v105,16,v84
v_and_b32 v106,s39,v84
v_fmac_f32 v112,v105,v101
v_fmac_f32 v113,v106,v101
v_lshlrev_b32 v105,16,v85
v_and_b32 v106,s39,v85
v_fmac_f32 v114,v105,v101
v_fmac_f32 v115,v106,v101
v_lshlrev_b32 v105,16,v86
v_and_b32 v106,s39,v86
v_fmac_f32 v116,v105,v101
v_fmac_f32 v117,v106,v101
v_lshlrev_b32 v105,16,v87
v_and_b32 v106,s39,v87
v_fmac_f32 v118,v105,v101
v_fmac_f32 v119,v106,v101
v_lshlrev_b32 v102,16,v102
v_mul_f32 v104,s38,v102
v_exp_f32 v104,v104
s_nop 0
v_add_f32 v104,1.0,v104
v_rcp_f32 v104,v104
s_nop 0
v_mul_f32 v104,v104,v102
v_cvt_pk_bf16_f32 v104,v104,v104
v_and_b32 v102,s39,v104
v_lshlrev_b32 v105,16,v88
v_and_b32 v106,s39,v88
v_fmac_f32 v112,v105,v102
v_fmac_f32 v113,v106,v102
v_lshlrev_b32 v105,16,v89
v_and_b32 v106,s39,v89
v_fmac_f32 v114,v105,v102
v_fmac_f32 v115,v106,v102
v_lshlrev_b32 v105,16,v90
v_and_b32 v106,s39,v90
v_fmac_f32 v116,v105,v102
v_fmac_f32 v117,v106,v102
v_lshlrev_b32 v105,16,v91
v_and_b32 v106,s39,v91
v_fmac_f32 v118,v105,v102
v_fmac_f32 v119,v106,v102
v_lshlrev_b32 v103,16,v103
v_mul_f32 v104,s38,v103
v_exp_f32 v104,v104
s_nop 0
v_add_f32 v104,1.0,v104
v_rcp_f32 v104,v104
s_nop 0
v_mul_f32 v104,v104,v103
v_cvt_pk_bf16_f32 v104,v104,v104
v_and_b32 v103,s39,v104
v_lshlrev_b32 v105,16,v92
v_and_b32 v106,s39,v92
v_fmac_f32 v112,v105,v103
v_fmac_f32 v113,v106,v103
v_lshlrev_b32 v105,16,v93
v_and_b32 v106,s39,v93
v_fmac_f32 v114,v105,v103
v_fmac_f32 v115,v106,v103
v_lshlrev_b32 v105,16,v94
v_and_b32 v106,s39,v94
v_fmac_f32 v116,v105,v103
v_fmac_f32 v117,v106,v103
v_lshlrev_b32 v105,16,v95
v_and_b32 v106,s39,v95
v_fmac_f32 v118,v105,v103
v_fmac_f32 v119,v106,v103
v_permlane32_swap_b32 v112,v116
v_permlane32_swap_b32 v113,v117
v_permlane32_swap_b32 v114,v118
v_permlane32_swap_b32 v115,v119
v_add_f32 v112,v112,v116
v_add_f32 v113,v113,v117
v_add_f32 v114,v114,v118
v_add_f32 v115,v115,v119
s_nop 0
v_permlane16_swap_b32 v112,v114
v_permlane16_swap_b32 v113,v115
v_add_f32 v112,v112,v114
v_add_f32 v113,v113,v115
s_nop 0
v_add_f32_dpp v112,v112,v112 row_ror:8 row_mask:0xf bank_mask:0xf
v_add_f32_dpp v113,v113,v113 row_ror:8 row_mask:0xf bank_mask:0xf
v_and_b32 v104,7,v1
v_lshlrev_b32 v104,5,v104
v_lshrrev_b32 v105,5,v1
v_lshl_add_u32 v104,v105,4,v104
v_bfe_u32 v105,v1,4,1
v_lshl_add_u32 v104,v105,3,v104
v_lshl_add_u32 v104,v2,8,v104
ds_write_b64 v104,v[112:113]
v_lshlrev_b32 v105,2,v1
s_lshl_b32 s40,s25,13
s_lshl_b32 s41,s24,8
s_add_u32 s40,s40,s41
s_add_u32 s40,s40,24576
s_waitcnt lgkmcnt(0)
s_barrier
s_cmp_lg_u32 s50,0
s_cbranch_scc1 m1n0_25
ds_read_b32 v112,v105 offset:0
ds_read_b32 v113,v105 offset:256
ds_read_b32 v114,v105 offset:512
ds_read_b32 v115,v105 offset:768
s_waitcnt lgkmcnt(0)
v_add_f32 v112,v112,v113
v_add_f32 v114,v114,v115
v_add_f32 v112,v112,v114
buffer_store_dword v112,v105,s[20:23],s40 offen sc1
m1n0_25:
s_waitcnt vmcnt(0)
s_barrier
s_cmp_lg_u32 s50,0
s_cbranch_scc1 post_9
s_mov_b64 exec,1
v_mov_b32 v184,1
v_mov_b32 v185,0
s_and_b32 s52,s56,1
s_lshl_b32 s52,s52,2
s_add_u32 s52,s52,160
buffer_atomic_add v184,v185,s[44:47],s52 offen sc0 sc1
s_waitcnt vmcnt(0)
v_readfirstlane_b32 s64,v184
s_mov_b64 exec,-1
s_cmp_eq_u32 s56,1
s_cbranch_scc1 post_9
s_cmp_lg_u32 s64,127
s_cbranch_scc1 post_9
v_and_b32 v184,3,v1
v_bfe_u32 v185,v1,2,1
v_lshlrev_b32 v184,2,v184
v_lshl_add_u32 v184,v185,7,v184
v_writelane_b32 v184,32,8
s_mov_b64 exec,0x1ff
vpoll_27:
buffer_load_dword v185,v184,s[44:47],0 offen sc1
s_waitcnt vmcnt(0)
vfirst_30:
v_readlane_b32 s92,v185,0
v_readlane_b32 s93,v185,1
v_readlane_b32 s94,v185,2
v_readlane_b32 s95,v185,3
v_readlane_b32 s96,v185,4
v_readlane_b32 s97,v185,5
v_readlane_b32 s98,v185,6
v_readlane_b32 s99,v185,7
v_readlane_b32 s61,v185,8
s_add_u32 s64,s92,s93
s_add_u32 s64,s64,s94
s_add_u32 s64,s64,s95
s_add_u32 s64,s64,s96
s_add_u32 s64,s64,s97
s_add_u32 s64,s64,s98
s_add_u32 s64,s64,s99
s_min_u32 s65,s92,s93
s_min_u32 s66,s94,s95
s_min_u32 s65,s65,s66
s_min_u32 s66,s96,s97
s_min_u32 s65,s65,s66
s_min_u32 s66,s98,s99
s_min_u32 s65,s65,s66
s_cmp_lt_u32 s65,32
s_cselect_b32 s65,1,0
s_cmp_lt_u32 s64,256
s_cbranch_scc1 vslp_29
s_branch vgot_28
vslp_29:
s_sleep 8
s_sub_u32 s90,s90,1
s_cmp_gt_i32 s90,0
s_cbranch_scc1 vpoll_27
vgot_28:
s_mov_b64 exec,-1
s_and_b32 s61,s61,1
s_lshl_b32 s61,s61,13
s_cmp_lg_u32 s65,0
s_cbranch_scc1 post_9
v_lshlrev_b32 v184,7,v1
v_mov_b32 v185,1
s_mov_b32 s64,21102592
s_mov_b32 s65,21110784
buffer_store_dword v185,v184,s[20:23],s64 offen sc1
buffer_store_dword v185,v184,s[20:23],s65 offen sc1
s_branch post_9
verify_6:
v_mov_b32 v187,158976
s_cmp_lg_u32 s50,0
s_cbranch_scc1 sh0_31
v_and_b32 v184,3,v1
v_bfe_u32 v185,v1,2,1
v_lshlrev_b32 v184,2,v184
v_lshl_add_u32 v184,v185,7,v184
v_writelane_b32 v184,32,8
s_mov_b64 exec,0x1ff
vpoll_32:
buffer_load_dword v185,v184,s[44:47],0 offen sc1
s_waitcnt vmcnt(0)
vfirst_35:
v_readlane_b32 s92,v185,0
v_readlane_b32 s93,v185,1
v_readlane_b32 s94,v185,2
v_readlane_b32 s95,v185,3
v_readlane_b32 s96,v185,4
v_readlane_b32 s97,v185,5
v_readlane_b32 s98,v185,6
v_readlane_b32 s99,v185,7
v_readlane_b32 s61,v185,8
s_add_u32 s64,s92,s93
s_add_u32 s64,s64,s94
s_add_u32 s64,s64,s95
s_add_u32 s64,s64,s96
s_add_u32 s64,s64,s97
s_add_u32 s64,s64,s98
s_add_u32 s64,s64,s99
s_min_u32 s65,s92,s93
s_min_u32 s66,s94,s95
s_min_u32 s65,s65,s66
s_min_u32 s66,s96,s97
s_min_u32 s65,s65,s66
s_min_u32 s66,s98,s99
s_min_u32 s65,s65,s66
s_cmp_lt_u32 s65,32
s_cselect_b32 s65,1,0
s_cmp_lt_u32 s64,256
s_cbranch_scc1 vslp_34
s_branch vgot_33
vslp_34:
s_sleep 8
s_sub_u32 s90,s90,1
s_cmp_gt_i32 s90,0
s_cbranch_scc1 vpoll_32
vgot_33:
s_mov_b64 exec,-1
s_and_b32 s61,s61,1
s_lshl_b32 s61,s61,13
s_mov_b32 s66,s54
s_cmp_gt_u32 s51,0
s_cselect_b32 s64,s92,0
s_add_u32 s66,s66,s64
s_cmp_gt_u32 s51,1
s_cselect_b32 s64,s93,0
s_add_u32 s66,s66,s64
s_cmp_gt_u32 s51,2
s_cselect_b32 s64,s94,0
s_add_u32 s66,s66,s64
s_cmp_gt_u32 s51,3
s_cselect_b32 s64,s95,0
s_add_u32 s66,s66,s64
s_cmp_gt_u32 s51,4
s_cselect_b32 s64,s96,0
s_add_u32 s66,s66,s64
s_cmp_gt_u32 s51,5
s_cselect_b32 s64,s97,0
s_add_u32 s66,s66,s64
s_cmp_gt_u32 s51,6
s_cselect_b32 s64,s98,0
s_add_u32 s66,s66,s64
v_mov_b32 v184,s65
v_mov_b32 v185,s66
v_mov_b32 v186,s61
ds_write_b96 v187,v[184:186] offset:16
s_waitcnt lgkmcnt(0)
sh0_31:
s_barrier
ds_read_b96 v[184:186],v187 offset:16
s_waitcnt lgkmcnt(0)
v_readfirstlane_b32 s65,v184
v_readfirstlane_b32 s66,v185
v_readfirstlane_b32 s61,v186
s_cmp_lg_u32 s65,0
s_cbranch_scc1 slowrole_10
s_mov_b32 s56,0
s_branch done_1
slowrole_10:
s_mov_b32 s57,s66
s_mov_b32 s56,1
s_waitcnt vmcnt(0)
s_barrier
s_cmp_ge_u32 s57,128
s_cbranch_scc1 pre_8
s_cmp_lg_u32 s50,0
s_cbranch_scc1 nadd_36
s_mov_b64 exec,1
v_mov_b32 v184,1
v_mov_b32 v185,0
s_mov_b32 s52,164
buffer_atomic_add v184,v185,s[44:47],s52 offen sc1
s_mov_b64 exec,-1
nadd_36:
s_branch setup_5
post_9:
s_cmp_lt_u32 s55,16
s_cbranch_scc1 xd_38
s_barrier
buffer_load_dwordx4 v[8:11],v5,s[32:35],s36 offen offset:0
buffer_load_dwordx4 v[12:15],v5,s[32:35],s36 offen offset:16
buffer_load_dwordx4 v[16:19],v5,s[32:35],s36 offen offset:512
buffer_load_dwordx4 v[20:23],v5,s[32:35],s36 offen offset:528
buffer_load_dwordx4 v[24:27],v5,s[32:35],s36 offen offset:1024
buffer_load_dwordx4 v[28:31],v5,s[32:35],s36 offen offset:1040
buffer_load_dwordx4 v[32:35],v5,s[32:35],s36 offen offset:1536
buffer_load_dwordx4 v[36:39],v5,s[32:35],s36 offen offset:1552
xd_38:
s_sub_u32 s65,s57,255
s_and_b32 s66,s56,1
s_or_b32 s65,s65,s66
s_or_b32 s65,s65,s50
s_cmp_lg_u32 s65,0
s_cbranch_scc1 nomeas_37
s_mov_b64 exec,1
v_mov_b32 v184,0
s_mov_b32 s52,20971520
s_mov_b32 s53,20979712
s_mov_b32 s70,0x7fffffff
s_mov_b32 s71,0x7fffffff
s_memtime s[72:73]
s_waitcnt lgkmcnt(0)
buffer_store_dword v184,v184,s[20:23],s52 offen sc1
s_waitcnt vmcnt(0)
s_memtime s[74:75]
s_waitcnt lgkmcnt(0)
s_sub_u32 s74,s74,s72
s_min_u32 s70,s70,s74
s_memtime s[72:73]
s_waitcnt lgkmcnt(0)
buffer_store_dword v184,v184,s[20:23],s53 offen sc1
s_waitcnt vmcnt(0)
s_memtime s[74:75]
s_waitcnt lgkmcnt(0)
s_sub_u32 s74,s74,s72
s_min_u32 s71,s71,s74
s_memtime s[72:73]
s_waitcnt lgkmcnt(0)
buffer_store_dword v184,v184,s[20:23],s52 offen sc1
s_waitcnt vmcnt(0)
s_memtime s[74:75]
s_waitcnt lgkmcnt(0)
s_sub_u32 s74,s74,s72
s_min_u32 s70,s70,s74
s_memtime s[72:73]
s_waitcnt lgkmcnt(0)
buffer_store_dword v184,v184,s[20:23],s53 offen sc1
s_waitcnt vmcnt(0)
s_memtime s[74:75]
s_waitcnt lgkmcnt(0)
s_sub_u32 s74,s74,s72
s_min_u32 s71,s71,s74
s_memtime s[72:73]
s_waitcnt lgkmcnt(0)
buffer_store_dword v184,v184,s[20:23],s52 offen sc1
s_waitcnt vmcnt(0)
s_memtime s[74:75]
s_waitcnt lgkmcnt(0)
s_sub_u32 s74,s74,s72
s_min_u32 s70,s70,s74
s_memtime s[72:73]
s_waitcnt lgkmcnt(0)
buffer_store_dword v184,v184,s[20:23],s53 offen sc1
s_waitcnt vmcnt(0)
s_memtime s[74:75]
s_waitcnt lgkmcnt(0)
s_sub_u32 s74,s74,s72
s_min_u32 s71,s71,s74
s_memtime s[72:73]
s_waitcnt lgkmcnt(0)
buffer_store_dword v184,v184,s[20:23],s52 offen sc1
s_waitcnt vmcnt(0)
s_memtime s[74:75]
s_waitcnt lgkmcnt(0)
s_sub_u32 s74,s74,s72
s_min_u32 s70,s70,s74
s_memtime s[72:73]
s_waitcnt lgkmcnt(0)
buffer_store_dword v184,v184,s[20:23],s53 offen sc1
s_waitcnt vmcnt(0)
s_memtime s[74:75]
s_waitcnt lgkmcnt(0)
s_sub_u32 s74,s74,s72
s_min_u32 s71,s71,s74
s_cmp_gt_u32 s71,s70
s_cselect_b32 s65,3,2
v_mov_b32 v185,s65
buffer_store_dword v185,v184,s[44:47],32 offen sc1
s_mov_b64 exec,-1
nomeas_37:
s_waitcnt vmcnt(0)
v_and_b32 v103,s39,v39
v_lshlrev_b32 v102,16,v39
v_and_b32 v101,s39,v38
v_lshlrev_b32 v100,16,v38
v_and_b32 v99,s39,v37
v_lshlrev_b32 v98,16,v37
v_and_b32 v97,s39,v36
v_lshlrev_b32 v96,16,v36
v_and_b32 v95,s39,v35
v_lshlrev_b32 v94,16,v35
v_and_b32 v93,s39,v34
v_lshlrev_b32 v92,16,v34
v_and_b32 v91,s39,v33
v_lshlrev_b32 v90,16,v33
v_and_b32 v89,s39,v32
v_lshlrev_b32 v88,16,v32
v_and_b32 v87,s39,v31
v_lshlrev_b32 v86,16,v31
v_and_b32 v85,s39,v30
v_lshlrev_b32 v84,16,v30
v_and_b32 v83,s39,v29
v_lshlrev_b32 v82,16,v29
v_and_b32 v81,s39,v28
v_lshlrev_b32 v80,16,v28
v_and_b32 v79,s39,v27
v_lshlrev_b32 v78,16,v27
v_and_b32 v77,s39,v26
v_lshlrev_b32 v76,16,v26
v_and_b32 v75,s39,v25
v_lshlrev_b32 v74,16,v25
v_and_b32 v73,s39,v24
v_lshlrev_b32 v72,16,v24
v_and_b32 v71,s39,v23
v_lshlrev_b32 v70,16,v23
v_and_b32 v69,s39,v22
v_lshlrev_b32 v68,16,v22
v_and_b32 v67,s39,v21
v_lshlrev_b32 v66,16,v21
v_and_b32 v65,s39,v20
v_lshlrev_b32 v64,16,v20
v_and_b32 v63,s39,v19
v_lshlrev_b32 v62,16,v19
v_and_b32 v61,s39,v18
v_lshlrev_b32 v60,16,v18
v_and_b32 v59,s39,v17
v_lshlrev_b32 v58,16,v17
v_and_b32 v57,s39,v16
v_lshlrev_b32 v56,16,v16
v_and_b32 v55,s39,v15
v_lshlrev_b32 v54,16,v15
v_and_b32 v53,s39,v14
v_lshlrev_b32 v52,16,v14
v_and_b32 v51,s39,v13
v_lshlrev_b32 v50,16,v13
v_and_b32 v49,s39,v12
v_lshlrev_b32 v48,16,v12
v_and_b32 v47,s39,v11
v_lshlrev_b32 v46,16,v11
v_and_b32 v45,s39,v10
v_lshlrev_b32 v44,16,v10
v_and_b32 v43,s39,v9
v_lshlrev_b32 v42,16,v9
v_and_b32 v41,s39,v8
v_lshlrev_b32 v40,16,v8
v_pk_add_f32 v[8:9],v[40:41],v[42:43]
v_pk_add_f32 v[10:11],v[44:45],v[46:47]
v_pk_add_f32 v[8:9],v[8:9],v[48:49]
v_pk_add_f32 v[10:11],v[10:11],v[50:51]
v_pk_add_f32 v[8:9],v[8:9],v[52:53]
v_pk_add_f32 v[10:11],v[10:11],v[54:55]
v_pk_add_f32 v[8:9],v[8:9],v[56:57]
v_pk_add_f32 v[10:11],v[10:11],v[58:59]
v_pk_add_f32 v[8:9],v[8:9],v[60:61]
v_pk_add_f32 v[10:11],v[10:11],v[62:63]
v_pk_add_f32 v[8:9],v[8:9],v[64:65]
v_pk_add_f32 v[10:11],v[10:11],v[66:67]
v_pk_add_f32 v[8:9],v[8:9],v[68:69]
v_pk_add_f32 v[10:11],v[10:11],v[70:71]
v_pk_add_f32 v[8:9],v[8:9],v[72:73]
v_pk_add_f32 v[10:11],v[10:11],v[74:75]
v_pk_add_f32 v[8:9],v[8:9],v[76:77]
v_pk_add_f32 v[10:11],v[10:11],v[78:79]
v_pk_add_f32 v[8:9],v[8:9],v[80:81]
v_pk_add_f32 v[10:11],v[10:11],v[82:83]
v_pk_add_f32 v[8:9],v[8:9],v[84:85]
v_pk_add_f32 v[10:11],v[10:11],v[86:87]
v_pk_add_f32 v[8:9],v[8:9],v[88:89]
v_pk_add_f32 v[10:11],v[10:11],v[90:91]
v_pk_add_f32 v[8:9],v[8:9],v[92:93]
v_pk_add_f32 v[10:11],v[10:11],v[94:95]
v_pk_add_f32 v[8:9],v[8:9],v[96:97]
v_pk_add_f32 v[10:11],v[10:11],v[98:99]
v_pk_add_f32 v[8:9],v[8:9],v[100:101]
v_pk_add_f32 v[10:11],v[10:11],v[102:103]
v_pk_add_f32 v[8:9],v[8:9],v[10:11]
v_add_f32 v8,v8,v9
s_nop 1
v_add_f32_dpp v8,v8,v8 row_ror:4 row_mask:0xf bank_mask:0xf
s_nop 1
v_add_f32_dpp v8,v8,v8 row_ror:8 row_mask:0xf bank_mask:0xf
v_mov_b32 v12,v8
s_nop 1
v_permlane16_swap_b32 v12,v8
v_add_f32 v8,v8,v12
v_mov_b32 v12,v8
s_nop 1
v_permlane32_swap_b32 v12,v8
v_add_f32 v8,v8,v12
v_mul_f32 v8,0xba800000,v8
v_pk_add_f32 v[40:41],v[40:41],v[8:9] op_sel_hi:[1,0]
v_pk_add_f32 v[42:43],v[42:43],v[8:9] op_sel_hi:[1,0]
v_pk_add_f32 v[44:45],v[44:45],v[8:9] op_sel_hi:[1,0]
v_pk_add_f32 v[46:47],v[46:47],v[8:9] op_sel_hi:[1,0]
v_pk_add_f32 v[48:49],v[48:49],v[8:9] op_sel_hi:[1,0]
v_pk_add_f32 v[50:51],v[50:51],v[8:9] op_sel_hi:[1,0]
v_pk_add_f32 v[52:53],v[52:53],v[8:9] op_sel_hi:[1,0]
v_pk_add_f32 v[54:55],v[54:55],v[8:9] op_sel_hi:[1,0]
v_pk_add_f32 v[56:57],v[56:57],v[8:9] op_sel_hi:[1,0]
v_pk_add_f32 v[58:59],v[58:59],v[8:9] op_sel_hi:[1,0]
v_pk_add_f32 v[60:61],v[60:61],v[8:9] op_sel_hi:[1,0]
v_pk_add_f32 v[62:63],v[62:63],v[8:9] op_sel_hi:[1,0]
v_pk_add_f32 v[64:65],v[64:65],v[8:9] op_sel_hi:[1,0]
v_pk_add_f32 v[66:67],v[66:67],v[8:9] op_sel_hi:[1,0]
v_pk_add_f32 v[68:69],v[68:69],v[8:9] op_sel_hi:[1,0]
v_pk_add_f32 v[70:71],v[70:71],v[8:9] op_sel_hi:[1,0]
v_pk_add_f32 v[72:73],v[72:73],v[8:9] op_sel_hi:[1,0]
v_pk_add_f32 v[74:75],v[74:75],v[8:9] op_sel_hi:[1,0]
v_pk_add_f32 v[76:77],v[76:77],v[8:9] op_sel_hi:[1,0]
v_pk_add_f32 v[78:79],v[78:79],v[8:9] op_sel_hi:[1,0]
v_pk_add_f32 v[80:81],v[80:81],v[8:9] op_sel_hi:[1,0]
v_pk_add_f32 v[82:83],v[82:83],v[8:9] op_sel_hi:[1,0]
v_pk_add_f32 v[84:85],v[84:85],v[8:9] op_sel_hi:[1,0]
v_pk_add_f32 v[86:87],v[86:87],v[8:9] op_sel_hi:[1,0]
v_pk_add_f32 v[88:89],v[88:89],v[8:9] op_sel_hi:[1,0]
v_pk_add_f32 v[90:91],v[90:91],v[8:9] op_sel_hi:[1,0]
v_pk_add_f32 v[92:93],v[92:93],v[8:9] op_sel_hi:[1,0]
v_pk_add_f32 v[94:95],v[94:95],v[8:9] op_sel_hi:[1,0]
v_pk_add_f32 v[96:97],v[96:97],v[8:9] op_sel_hi:[1,0]
v_pk_add_f32 v[98:99],v[98:99],v[8:9] op_sel_hi:[1,0]
v_pk_add_f32 v[100:101],v[100:101],v[8:9] op_sel_hi:[1,0]
v_pk_add_f32 v[102:103],v[102:103],v[8:9] op_sel_hi:[1,0]
v_pk_mul_f32 v[10:11],v[40:41],v[40:41]
v_pk_mul_f32 v[14:15],v[42:43],v[42:43]
v_pk_fma_f32 v[10:11],v[44:45],v[44:45],v[10:11]
v_pk_fma_f32 v[14:15],v[46:47],v[46:47],v[14:15]
v_pk_fma_f32 v[10:11],v[48:49],v[48:49],v[10:11]
v_pk_fma_f32 v[14:15],v[50:51],v[50:51],v[14:15]
v_pk_fma_f32 v[10:11],v[52:53],v[52:53],v[10:11]
v_pk_fma_f32 v[14:15],v[54:55],v[54:55],v[14:15]
v_pk_fma_f32 v[10:11],v[56:57],v[56:57],v[10:11]
v_pk_fma_f32 v[14:15],v[58:59],v[58:59],v[14:15]
v_pk_fma_f32 v[10:11],v[60:61],v[60:61],v[10:11]
v_pk_fma_f32 v[14:15],v[62:63],v[62:63],v[14:15]
v_pk_fma_f32 v[10:11],v[64:65],v[64:65],v[10:11]
v_pk_fma_f32 v[14:15],v[66:67],v[66:67],v[14:15]
v_pk_fma_f32 v[10:11],v[68:69],v[68:69],v[10:11]
v_pk_fma_f32 v[14:15],v[70:71],v[70:71],v[14:15]
v_pk_fma_f32 v[10:11],v[72:73],v[72:73],v[10:11]
v_pk_fma_f32 v[14:15],v[74:75],v[74:75],v[14:15]
v_pk_fma_f32 v[10:11],v[76:77],v[76:77],v[10:11]
v_pk_fma_f32 v[14:15],v[78:79],v[78:79],v[14:15]
v_pk_fma_f32 v[10:11],v[80:81],v[80:81],v[10:11]
v_pk_fma_f32 v[14:15],v[82:83],v[82:83],v[14:15]
v_pk_fma_f32 v[10:11],v[84:85],v[84:85],v[10:11]
v_pk_fma_f32 v[14:15],v[86:87],v[86:87],v[14:15]
v_pk_fma_f32 v[10:11],v[88:89],v[88:89],v[10:11]
v_pk_fma_f32 v[14:15],v[90:91],v[90:91],v[14:15]
v_pk_fma_f32 v[10:11],v[92:93],v[92:93],v[10:11]
v_pk_fma_f32 v[14:15],v[94:95],v[94:95],v[14:15]
v_pk_fma_f32 v[10:11],v[96:97],v[96:97],v[10:11]
v_pk_fma_f32 v[14:15],v[98:99],v[98:99],v[14:15]
v_pk_fma_f32 v[10:11],v[100:101],v[100:101],v[10:11]
v_pk_fma_f32 v[14:15],v[102:103],v[102:103],v[14:15]
v_pk_add_f32 v[10:11],v[10:11],v[14:15]
v_add_f32 v10,v10,v11
s_nop 1
v_add_f32_dpp v10,v10,v10 row_ror:4 row_mask:0xf bank_mask:0xf
s_nop 1
v_add_f32_dpp v10,v10,v10 row_ror:8 row_mask:0xf bank_mask:0xf
v_mov_b32 v12,v10
s_nop 1
v_permlane16_swap_b32 v12,v10
v_add_f32 v10,v10,v12
v_mov_b32 v12,v10
s_nop 1
v_permlane32_swap_b32 v12,v10
v_add_f32 v10,v10,v12
v_mov_b32 v12,0x3727c5ac
v_fmac_f32 v12,0x3a800000,v10
v_rsq_f32 v10,v12
s_nop 0
v_pk_mul_f32 v[40:41],v[40:41],v[10:11] op_sel_hi:[1,0]
v_pk_mul_f32 v[42:43],v[42:43],v[10:11] op_sel_hi:[1,0]
v_pk_mul_f32 v[44:45],v[44:45],v[10:11] op_sel_hi:[1,0]
v_pk_mul_f32 v[46:47],v[46:47],v[10:11] op_sel_hi:[1,0]
v_pk_mul_f32 v[48:49],v[48:49],v[10:11] op_sel_hi:[1,0]
v_pk_mul_f32 v[50:51],v[50:51],v[10:11] op_sel_hi:[1,0]
v_pk_mul_f32 v[52:53],v[52:53],v[10:11] op_sel_hi:[1,0]
v_pk_mul_f32 v[54:55],v[54:55],v[10:11] op_sel_hi:[1,0]
v_pk_mul_f32 v[56:57],v[56:57],v[10:11] op_sel_hi:[1,0]
v_pk_mul_f32 v[58:59],v[58:59],v[10:11] op_sel_hi:[1,0]
v_pk_mul_f32 v[60:61],v[60:61],v[10:11] op_sel_hi:[1,0]
v_pk_mul_f32 v[62:63],v[62:63],v[10:11] op_sel_hi:[1,0]
v_pk_mul_f32 v[64:65],v[64:65],v[10:11] op_sel_hi:[1,0]
v_pk_mul_f32 v[66:67],v[66:67],v[10:11] op_sel_hi:[1,0]
v_pk_mul_f32 v[68:69],v[68:69],v[10:11] op_sel_hi:[1,0]
v_pk_mul_f32 v[70:71],v[70:71],v[10:11] op_sel_hi:[1,0]
v_pk_mul_f32 v[72:73],v[72:73],v[10:11] op_sel_hi:[1,0]
v_pk_mul_f32 v[74:75],v[74:75],v[10:11] op_sel_hi:[1,0]
v_pk_mul_f32 v[76:77],v[76:77],v[10:11] op_sel_hi:[1,0]
v_pk_mul_f32 v[78:79],v[78:79],v[10:11] op_sel_hi:[1,0]
v_pk_mul_f32 v[80:81],v[80:81],v[10:11] op_sel_hi:[1,0]
v_pk_mul_f32 v[82:83],v[82:83],v[10:11] op_sel_hi:[1,0]
v_pk_mul_f32 v[84:85],v[84:85],v[10:11] op_sel_hi:[1,0]
v_pk_mul_f32 v[86:87],v[86:87],v[10:11] op_sel_hi:[1,0]
v_pk_mul_f32 v[88:89],v[88:89],v[10:11] op_sel_hi:[1,0]
v_pk_mul_f32 v[90:91],v[90:91],v[10:11] op_sel_hi:[1,0]
v_pk_mul_f32 v[92:93],v[92:93],v[10:11] op_sel_hi:[1,0]
v_pk_mul_f32 v[94:95],v[94:95],v[10:11] op_sel_hi:[1,0]
v_pk_mul_f32 v[96:97],v[96:97],v[10:11] op_sel_hi:[1,0]
v_pk_mul_f32 v[98:99],v[98:99],v[10:11] op_sel_hi:[1,0]
v_pk_mul_f32 v[100:101],v[100:101],v[10:11] op_sel_hi:[1,0]
v_pk_mul_f32 v[102:103],v[102:103],v[10:11] op_sel_hi:[1,0]
v_mov_b32 v187,158976
s_cmp_lg_u32 s50,0
s_cbranch_scc1 sh0_39
s_mov_b32 s65,0
s_cmp_eq_u32 s56,1
s_cbranch_scc1 m1s_40
s_lshl_b32 s52,s55,7
s_add_u32 s52,s52,21102592
s_mov_b32 s53,0
m1l_41:
v_mov_b32 v184,0
buffer_load_dword v185,v184,s[20:23],s52 offen sc1
s_waitcnt vmcnt(0)
v_readfirstlane_b32 s64,v185
s_mov_b32 s65,0
s_cmp_eq_u32 s64,1
s_cbranch_scc1 m1ok_42
s_sub_u32 s90,s90,1
s_cmp_lt_i32 s90,0
s_cbranch_scc1 m1ok_42
s_add_u32 s53,s53,1
s_and_b32 s64,s53,31
s_cbranch_scc1 m1l_41
v_and_b32 v184,3,v1
v_bfe_u32 v185,v1,2,1
v_lshlrev_b32 v184,2,v184
v_lshl_add_u32 v184,v185,7,v184
v_writelane_b32 v184,32,8
s_mov_b64 exec,0x1ff
vpoll_43:
buffer_load_dword v185,v184,s[44:47],0 offen sc1
s_waitcnt vmcnt(0)
vfirst_46:
v_readlane_b32 s92,v185,0
v_readlane_b32 s93,v185,1
v_readlane_b32 s94,v185,2
v_readlane_b32 s95,v185,3
v_readlane_b32 s96,v185,4
v_readlane_b32 s97,v185,5
v_readlane_b32 s98,v185,6
v_readlane_b32 s99,v185,7
v_readlane_b32 s61,v185,8
s_add_u32 s64,s92,s93
s_add_u32 s64,s64,s94
s_add_u32 s64,s64,s95
s_add_u32 s64,s64,s96
s_add_u32 s64,s64,s97
s_add_u32 s64,s64,s98
s_add_u32 s64,s64,s99
s_min_u32 s65,s92,s93
s_min_u32 s66,s94,s95
s_min_u32 s65,s65,s66
s_min_u32 s66,s96,s97
s_min_u32 s65,s65,s66
s_min_u32 s66,s98,s99
s_min_u32 s65,s65,s66
s_cmp_lt_u32 s65,32
s_cselect_b32 s65,1,0
s_cmp_lt_u32 s64,256
s_cbranch_scc1 vslp_45
s_branch vgot_44
vslp_45:
s_sleep 8
s_sub_u32 s90,s90,1
s_cmp_gt_i32 s90,0
s_cbranch_scc1 vpoll_43
vgot_44:
s_mov_b64 exec,-1
s_and_b32 s61,s61,1
s_lshl_b32 s61,s61,13
s_mov_b32 s66,s54
s_cmp_gt_u32 s51,0
s_cselect_b32 s64,s92,0
s_add_u32 s66,s66,s64
s_cmp_gt_u32 s51,1
s_cselect_b32 s64,s93,0
s_add_u32 s66,s66,s64
s_cmp_gt_u32 s51,2
s_cselect_b32 s64,s94,0
s_add_u32 s66,s66,s64
s_cmp_gt_u32 s51,3
s_cselect_b32 s64,s95,0
s_add_u32 s66,s66,s64
s_cmp_gt_u32 s51,4
s_cselect_b32 s64,s96,0
s_add_u32 s66,s66,s64
s_cmp_gt_u32 s51,5
s_cselect_b32 s64,s97,0
s_add_u32 s66,s66,s64
s_cmp_gt_u32 s51,6
s_cselect_b32 s64,s98,0
s_add_u32 s66,s66,s64
s_cmp_eq_u32 s65,0
s_cbranch_scc1 m1l_41
s_branch m1ok_42
m1s_40:
s_mov_b32 s53,256
s_mov_b32 s52,164
v_mov_b32 v184,0
dp_47:
buffer_load_dword v185,v184,s[44:47],s52 offen sc1
s_waitcnt vmcnt(0)
v_cmp_ne_u32 vcc,s53,v185
s_cbranch_vccz dpok_48
s_sleep 8
s_sub_u32 s90,s90,1
s_cmp_gt_i32 s90,0
s_cbranch_scc1 dp_47
dpok_48:
m1ok_42:
v_mov_b32 v184,s65
v_mov_b32 v185,s66
v_mov_b32 v186,s61
ds_write_b96 v187,v[184:186] offset:16
s_waitcnt lgkmcnt(0)
sh0_39:
s_barrier
ds_read_b96 v[184:186],v187 offset:16
s_waitcnt lgkmcnt(0)
v_readfirstlane_b32 s65,v184
v_readfirstlane_b32 s66,v185
v_readfirstlane_b32 s61,v186
s_cmp_lg_u32 s65,0
s_cbranch_scc1 slowrole_10
s_and_b32 s56,s56,1
s_lshl_b32 s53,s56,2
s_add_u32 s53,s53,4
v_mul_u32_u24 v241,s53,v1
s_lshr_b32 s53,s55,4
s_or_b32 s53,s53,s50
s_cselect_b32 s53,0x7fff0000,32
s_mov_b64 exec,3
buffer_load_dword v240,v241,s[44:47],s53 offen sc1
s_mov_b64 exec,-1
v_lshlrev_b32 v7,5,v0
s_mov_b32 s40,24576
buffer_load_dwordx4 v[104:107],v7,s[20:23],s40 offen offset:0 sc1
buffer_load_dwordx4 v[108:111],v7,s[20:23],s40 offen offset:16 sc1
s_add_u32 s40,s40,8192
buffer_load_dwordx4 v[112:115],v7,s[20:23],s40 offen offset:0 sc1
buffer_load_dwordx4 v[116:119],v7,s[20:23],s40 offen offset:16 sc1
s_add_u32 s40,s40,8192
buffer_load_dwordx4 v[120:123],v7,s[20:23],s40 offen offset:0 sc1
buffer_load_dwordx4 v[124:127],v7,s[20:23],s40 offen offset:16 sc1
s_add_u32 s40,s40,8192
buffer_load_dwordx4 v[128:131],v7,s[20:23],s40 offen offset:0 sc1
buffer_load_dwordx4 v[132:135],v7,s[20:23],s40 offen offset:16 sc1
v_mov_b32 v14,1.0
v_cmp_lt_u32 vcc,127,v0
s_nop 1
v_cndmask_b32 v14,0,v14,vcc
s_waitcnt vmcnt(0)
v_pk_add_f32 v[104:105],v[104:105],v[112:113]
v_pk_add_f32 v[120:121],v[120:121],v[128:129]
v_pk_add_f32 v[106:107],v[106:107],v[114:115]
v_pk_add_f32 v[122:123],v[122:123],v[130:131]
v_pk_add_f32 v[108:109],v[108:109],v[116:117]
v_pk_add_f32 v[124:125],v[124:125],v[132:133]
v_pk_add_f32 v[110:111],v[110:111],v[118:119]
v_pk_add_f32 v[126:127],v[126:127],v[134:135]
v_pk_add_f32 v[104:105],v[104:105],v[120:121]
v_pk_add_f32 v[106:107],v[106:107],v[122:123]
v_pk_add_f32 v[108:109],v[108:109],v[124:125]
v_pk_add_f32 v[110:111],v[110:111],v[126:127]
v_cvt_pk_bf16_f32 v112,v104,v105
v_cvt_pk_bf16_f32 v113,v106,v107
v_cvt_pk_bf16_f32 v114,v108,v109
v_cvt_pk_bf16_f32 v115,v110,v111
v_lshlrev_b32 v104,16,v112
v_and_b32 v105,s39,v112
v_lshlrev_b32 v106,16,v113
v_and_b32 v107,s39,v113
v_lshlrev_b32 v108,16,v114
v_and_b32 v109,s39,v114
v_lshlrev_b32 v110,16,v115
v_and_b32 v111,s39,v115
v_pk_add_f32 v[104:105],v[104:105],v[14:15] op_sel_hi:[1,0]
v_pk_add_f32 v[106:107],v[106:107],v[14:15] op_sel_hi:[1,0]
v_pk_add_f32 v[108:109],v[108:109],v[14:15] op_sel_hi:[1,0]
v_pk_add_f32 v[110:111],v[110:111],v[14:15] op_sel_hi:[1,0]
ds_write_b128 v7,v[104:107] offset:4096
ds_write_b128 v7,v[108:111] offset:4112
s_waitcnt lgkmcnt(0)
s_barrier
ds_read_b128 v[104:107],v4 offset:8192
ds_read_b128 v[168:171],v4 offset:4096
ds_read_b128 v[108:111],v4 offset:8208
ds_read_b128 v[172:175],v4 offset:4112
ds_read_b128 v[112:115],v4 offset:8224
ds_read_b128 v[176:179],v4 offset:4128
ds_read_b128 v[116:119],v4 offset:8240
ds_read_b128 v[180:183],v4 offset:4144
ds_read_b128 v[120:123],v4 offset:9216
ds_read_b128 v[184:187],v4 offset:5120
ds_read_b128 v[124:127],v4 offset:9232
ds_read_b128 v[188:191],v4 offset:5136
ds_read_b128 v[128:131],v4 offset:9248
ds_read_b128 v[192:195],v4 offset:5152
ds_read_b128 v[132:135],v4 offset:9264
ds_read_b128 v[196:199],v4 offset:5168
ds_read_b128 v[136:139],v4 offset:10240
ds_read_b128 v[200:203],v4 offset:6144
ds_read_b128 v[140:143],v4 offset:10256
ds_read_b128 v[204:207],v4 offset:6160
ds_read_b128 v[144:147],v4 offset:10272
ds_read_b128 v[208:211],v4 offset:6176
ds_read_b128 v[148:151],v4 offset:10288
ds_read_b128 v[212:215],v4 offset:6192
ds_read_b128 v[152:155],v4 offset:11264
ds_read_b128 v[216:219],v4 offset:7168
ds_read_b128 v[156:159],v4 offset:11280
ds_read_b128 v[220:223],v4 offset:7184
ds_read_b128 v[160:163],v4 offset:11296
ds_read_b128 v[224:227],v4 offset:7200
ds_read_b128 v[164:167],v4 offset:11312
ds_read_b128 v[228:231],v4 offset:7216
s_waitcnt lgkmcnt(15)
v_pk_fma_f32 v[40:41],v[40:41],v[104:105],v[168:169]
v_pk_fma_f32 v[42:43],v[42:43],v[106:107],v[170:171]
v_pk_fma_f32 v[44:45],v[44:45],v[108:109],v[172:173]
v_pk_fma_f32 v[46:47],v[46:47],v[110:111],v[174:175]
v_pk_fma_f32 v[48:49],v[48:49],v[112:113],v[176:177]
v_pk_fma_f32 v[50:51],v[50:51],v[114:115],v[178:179]
v_pk_fma_f32 v[52:53],v[52:53],v[116:117],v[180:181]
v_pk_fma_f32 v[54:55],v[54:55],v[118:119],v[182:183]
v_cvt_pk_bf16_f32 v16,v40,v41
v_cvt_pk_bf16_f32 v17,v48,v49
v_cvt_pk_bf16_f32 v18,v42,v43
v_cvt_pk_bf16_f32 v19,v50,v51
buffer_store_dwordx4 v[16:19],v6,s[20:23],s37 offen offset:0 sc1
v_cvt_pk_bf16_f32 v20,v44,v45
v_cvt_pk_bf16_f32 v21,v52,v53
v_cvt_pk_bf16_f32 v22,v46,v47
v_cvt_pk_bf16_f32 v23,v54,v55
buffer_store_dwordx4 v[20:23],v6,s[20:23],s37 offen offset:256 sc1
s_waitcnt lgkmcnt(15)
v_pk_fma_f32 v[56:57],v[56:57],v[120:121],v[184:185]
v_pk_fma_f32 v[58:59],v[58:59],v[122:123],v[186:187]
v_pk_fma_f32 v[60:61],v[60:61],v[124:125],v[188:189]
v_pk_fma_f32 v[62:63],v[62:63],v[126:127],v[190:191]
v_pk_fma_f32 v[64:65],v[64:65],v[128:129],v[192:193]
v_pk_fma_f32 v[66:67],v[66:67],v[130:131],v[194:195]
v_pk_fma_f32 v[68:69],v[68:69],v[132:133],v[196:197]
v_pk_fma_f32 v[70:71],v[70:71],v[134:135],v[198:199]
v_cvt_pk_bf16_f32 v24,v56,v57
v_cvt_pk_bf16_f32 v25,v64,v65
v_cvt_pk_bf16_f32 v26,v58,v59
v_cvt_pk_bf16_f32 v27,v66,v67
s_add_u32 s37,s37,16384
buffer_store_dwordx4 v[24:27],v6,s[20:23],s37 offen offset:0 sc1
v_cvt_pk_bf16_f32 v28,v60,v61
v_cvt_pk_bf16_f32 v29,v68,v69
v_cvt_pk_bf16_f32 v30,v62,v63
v_cvt_pk_bf16_f32 v31,v70,v71
buffer_store_dwordx4 v[28:31],v6,s[20:23],s37 offen offset:256 sc1
s_waitcnt lgkmcnt(8)
v_pk_fma_f32 v[72:73],v[72:73],v[136:137],v[200:201]
v_pk_fma_f32 v[74:75],v[74:75],v[138:139],v[202:203]
v_pk_fma_f32 v[76:77],v[76:77],v[140:141],v[204:205]
v_pk_fma_f32 v[78:79],v[78:79],v[142:143],v[206:207]
v_pk_fma_f32 v[80:81],v[80:81],v[144:145],v[208:209]
v_pk_fma_f32 v[82:83],v[82:83],v[146:147],v[210:211]
v_pk_fma_f32 v[84:85],v[84:85],v[148:149],v[212:213]
v_pk_fma_f32 v[86:87],v[86:87],v[150:151],v[214:215]
v_cvt_pk_bf16_f32 v16,v72,v73
v_cvt_pk_bf16_f32 v17,v80,v81
v_cvt_pk_bf16_f32 v18,v74,v75
v_cvt_pk_bf16_f32 v19,v82,v83
s_add_u32 s37,s37,16384
buffer_store_dwordx4 v[16:19],v6,s[20:23],s37 offen offset:0 sc1
v_cvt_pk_bf16_f32 v20,v76,v77
v_cvt_pk_bf16_f32 v21,v84,v85
v_cvt_pk_bf16_f32 v22,v78,v79
v_cvt_pk_bf16_f32 v23,v86,v87
buffer_store_dwordx4 v[20:23],v6,s[20:23],s37 offen offset:256 sc1
s_waitcnt lgkmcnt(0)
v_pk_fma_f32 v[88:89],v[88:89],v[152:153],v[216:217]
v_pk_fma_f32 v[90:91],v[90:91],v[154:155],v[218:219]
v_pk_fma_f32 v[92:93],v[92:93],v[156:157],v[220:221]
v_pk_fma_f32 v[94:95],v[94:95],v[158:159],v[222:223]
v_pk_fma_f32 v[96:97],v[96:97],v[160:161],v[224:225]
v_pk_fma_f32 v[98:99],v[98:99],v[162:163],v[226:227]
v_pk_fma_f32 v[100:101],v[100:101],v[164:165],v[228:229]
v_pk_fma_f32 v[102:103],v[102:103],v[166:167],v[230:231]
v_cvt_pk_bf16_f32 v24,v88,v89
v_cvt_pk_bf16_f32 v25,v96,v97
v_cvt_pk_bf16_f32 v26,v90,v91
v_cvt_pk_bf16_f32 v27,v98,v99
s_add_u32 s37,s37,16384
buffer_store_dwordx4 v[24:27],v6,s[20:23],s37 offen offset:0 sc1
v_cvt_pk_bf16_f32 v28,v92,v93
v_cvt_pk_bf16_f32 v29,v100,v101
v_cvt_pk_bf16_f32 v30,v94,v95
v_cvt_pk_bf16_f32 v31,v102,v103
buffer_store_dwordx4 v[28:31],v6,s[20:23],s37 offen offset:256 sc1
s_waitcnt vmcnt(0)
s_barrier
v_mov_b32 v187,158976
s_cmp_lg_u32 s50,0
s_cbranch_scc1 sh0_49
s_cmp_ge_u32 s55,16
s_cbranch_scc1 nodln_50
rdl_52:
v_readlane_b32 s64,v240,0
v_readlane_b32 s65,v240,1
s_cmp_eq_u32 s56,1
s_cselect_b32 s64,2,s64
s_cmp_eq_u32 s65,128
s_cselect_b32 s64,s64,0
s_cmp_lg_u32 s64,0
s_cbranch_scc1 rdok_53
s_mov_b64 exec,3
buffer_load_dword v240,v241,s[44:47],s53 offen sc1
s_mov_b64 exec,-1
s_sub_u32 s90,s90,1
s_cmp_gt_i32 s90,0
s_waitcnt vmcnt(0)
s_cbranch_scc1 rdl_52
rdok_53:
s_lshl_b32 s65,s55,2
v_lshl_add_u32 v184,v1,7,s65
v_mov_b32 v185,s64
s_mov_b32 s64,21168128
s_mov_b32 s65,21176320
buffer_store_dword v185,v184,s[20:23],s64 offen sc1
buffer_store_dword v185,v184,s[20:23],s65 offen sc1
nodln_50:
s_mov_b32 s61,0
s_cmp_eq_u32 s56,1
s_cbranch_scc1 nopar_51
v_mov_b32 v184,0
dp_54:
buffer_load_dword v185,v184,s[44:47],32 offen sc1
s_waitcnt vmcnt(0)
v_cmp_eq_u32 vcc,0,v185
s_cbranch_vccz dpok_55
s_sleep 4
s_sub_u32 s90,s90,1
s_cmp_gt_i32 s90,0
s_cbranch_scc1 dp_54
dpok_55:
v_readfirstlane_b32 s65,v185
s_and_b32 s65,s65,1
s_lshl_b32 s61,s65,13
nopar_51:
v_mov_b32 v184,s65
v_mov_b32 v185,s66
v_mov_b32 v186,s61
ds_write_b96 v187,v[184:186] offset:16
s_waitcnt lgkmcnt(0)
sh0_49:
s_barrier
ds_read_b96 v[184:186],v187 offset:16
s_waitcnt lgkmcnt(0)
v_readfirstlane_b32 s65,v184
v_readfirstlane_b32 s66,v185
v_readfirstlane_b32 s61,v186
s_sub_u32 s55,s57,128
s_cmp_lg_u32 s50,0
s_cbranch_scc1 nsig_56
s_lshr_b32 s95,s55,4
s_lshl_b32 s95,s95,6
s_add_u32 s95,s95,21052416
s_mov_b64 exec,1
v_mov_b32 v184,112
v_mov_b32 v185,0
buffer_atomic_add v184,v185,s[20:23],s95 offen sc1
s_mov_b64 exec,-1
nsig_56:
s_branch pipe_worker
loops_7:
s_lshl_b32 s64,s50,14
s_add_u32 m0,s64,0
s_add_u32 s65,s64,57344
buffer_load_dwordx4 v16,s[20:23],s65 offen offset:0 lds
buffer_load_dwordx4 v16,s[20:23],s65 offen offset:1024 lds
buffer_load_dwordx4 v16,s[20:23],s65 offen offset:2048 lds
buffer_load_dwordx4 v16,s[20:23],s65 offen offset:3072 lds
s_add_u32 m0,s64,4096
s_add_u32 s65,s64,61440
buffer_load_dwordx4 v16,s[20:23],s65 offen offset:0 lds
buffer_load_dwordx4 v16,s[20:23],s65 offen offset:1024 lds
buffer_load_dwordx4 v16,s[20:23],s65 offen offset:2048 lds
buffer_load_dwordx4 v16,s[20:23],s65 offen offset:3072 lds
s_add_u32 m0,s64,8192
s_add_u32 s65,s64,65536
buffer_load_dwordx4 v16,s[20:23],s65 offen offset:0 lds
buffer_load_dwordx4 v16,s[20:23],s65 offen offset:1024 lds
buffer_load_dwordx4 v16,s[20:23],s65 offen offset:2048 lds
buffer_load_dwordx4 v16,s[20:23],s65 offen offset:3072 lds
s_add_u32 m0,s64,12288
s_add_u32 s65,s64,69632
buffer_load_dwordx4 v16,s[20:23],s65 offen offset:0 lds
buffer_load_dwordx4 v16,s[20:23],s65 offen offset:1024 lds
buffer_load_dwordx4 v16,s[20:23],s65 offen offset:2048 lds
buffer_load_dwordx4 v16,s[20:23],s65 offen offset:3072 lds
s_add_u32 m0,s64,65536
s_add_u32 s65,s64,122880
buffer_load_dwordx4 v16,s[20:23],s65 offen offset:0 lds
buffer_load_dwordx4 v16,s[20:23],s65 offen offset:1024 lds
buffer_load_dwordx4 v16,s[20:23],s65 offen offset:2048 lds
buffer_load_dwordx4 v16,s[20:23],s65 offen offset:3072 lds
s_add_u32 m0,s64,69632
s_add_u32 s65,s64,126976
buffer_load_dwordx4 v16,s[20:23],s65 offen offset:0 lds
buffer_load_dwordx4 v16,s[20:23],s65 offen offset:1024 lds
buffer_load_dwordx4 v16,s[20:23],s65 offen offset:2048 lds
buffer_load_dwordx4 v16,s[20:23],s65 offen offset:3072 lds
s_add_u32 m0,s64,73728
s_add_u32 s65,s64,131072
buffer_load_dwordx4 v16,s[20:23],s65 offen offset:0 lds
buffer_load_dwordx4 v16,s[20:23],s65 offen offset:1024 lds
buffer_load_dwordx4 v16,s[20:23],s65 offen offset:2048 lds
buffer_load_dwordx4 v16,s[20:23],s65 offen offset:3072 lds
s_add_u32 m0,s64,77824
s_add_u32 s65,s64,135168
buffer_load_dwordx4 v16,s[20:23],s65 offen offset:0 lds
buffer_load_dwordx4 v16,s[20:23],s65 offen offset:1024 lds
buffer_load_dwordx4 v16,s[20:23],s65 offen offset:2048 lds
buffer_load_dwordx4 v16,s[20:23],s65 offen offset:3072 lds
s_mov_b64 s[24:25],s[20:21]
s_mov_b64 s[28:29],s[20:21]
s_mov_b32 s27,0x20000
s_mov_b32 s31,0x20000
s_cmp_eq_u32 s56,0
s_cselect_b32 s26,s22,0
s_cselect_b32 s30,0,s22
s_lshl_b32 s64,s58,14
s_add_u32 s64,s64,23068672
v_add_u32 v26,s64,v16
v_add_u32 v27,4096,v26
v_add_u32 v28,8192,v26
v_add_u32 v29,12288,v26
s_lshl_b32 s65,s59,9
s_add_u32 s66,s64,s65
s_lshl_b32 s64,s58,7
s_add_u32 s64,s64,23592960
v_and_b32 v18,31,v1
v_lshl_add_u32 v18,v18,2,s64
s_lshl_b32 s65,s59,2
s_add_u32 s64,s64,s65
v_mov_b32 v13,s64
v_mov_b32 v14,0x4444
v_mov_b32 v22,0xeeee
v_cmp_lt_u32 vcc,7,v3
s_nop 1
v_cndmask_b32 v14,v14,v22,vcc
v_and_b32 v22,1,v3
v_cmp_eq_u32 vcc,0,v22
v_mov_b32 v15,0x03020706
v_mov_b32 v23,0x05040100
v_cndmask_b32 v15,v15,v23,vcc
v_lshlrev_b32 v19,5,v22
v_lshl_add_u32 v19,v4,6,v19
v_lshrrev_b32 v23,1,v3
v_lshl_add_u32 v19,v23,2,v19
s_lshl_b32 s67,s57,10
s_add_u32 s67,s67,23199744
s_lshl_b32 s64,s50,2
s_lshr_b32 s64,0x1320,s64
s_and_b32 s64,s64,3
s_lshl_b32 s64,s64,8
s_add_u32 s64,s64,s67
v_add_u32 v19,s64,v19
v_add_u32 v24,131072,v16
v_mov_b32 v21,158720
v_mov_b32 v25,0
v_mov_b32 v20,v16
v_and_b32 v22,1,v4
v_lshrrev_b32 v23,1,v4
v_lshl_add_u32 v23,v23,4,v3
v_lshlrev_b32 v23,4,v23
v_lshl_add_u32 v23,v22,10,v23
s_lshr_b32 s64,s50,1
s_lshl_b32 s64,s64,9
v_add_u32 v23,s64,v23
s_lshr_b32 s64,s57,2
s_add_u32 s65,s64,32
s_lshl_b32 s65,s65,14
s_and_b32 s68,s57,3
s_lshl_b32 s68,s68,11
s_add_u32 s65,s65,s68
s_add_u32 s65,s65,29360128
v_add_u32 v17,s65,v23
s_lshl_b32 s69,s57,11
s_add_u32 s69,s69,23330816
v_add_u32 v2,s69,v23
s_mov_b32 s81,0x3e0293ee
s_mov_b32 s84,0xff00ff
s_mov_b32 s85,0xff00ff
s_mov_b32 s86,0x33333333
s_mov_b32 s87,0x33333333
s_mov_b32 s62,0x10000
s_mov_b32 s79,-2
ds_write_b32 v21,v25
ds_write_b32 v21,v25 offset:4
ds_write_b32 v21,v25 offset:8
ds_write_b32 v21,v25 offset:12
ds_write_b32 v21,v25 offset:16
ds_write_b32 v21,v25 offset:24
ds_write_b32 v21,v25 offset:28
v_mov_b32 v100,0
v_mov_b32 v101,0
v_mov_b32 v102,0
v_mov_b32 v103,0
s_lshr_b32 s64,s59,3
s_lshl_b32 s64,s64,14
s_and_b32 s65,s59,7
s_lshl_b32 s65,s65,10
s_add_u32 s64,s64,s65
s_lshl_b32 s65,s58,16
s_add_u32 s64,s64,s65
s_add_u32 s64,s64,31195136
v_add_u32 v8,s64,v16
s_cmp_eq_u32 s50,3
s_cbranch_scc1 w3_61
s_cmp_eq_u32 s50,1
s_cbranch_scc1 w1_59
s_cmp_eq_u32 s50,2
s_cbranch_scc1 w2_60
w0_58:
v_and_b32 v22,7,v3
v_lshrrev_b32 v23,2,v22
v_and_b32 v5,2,v22
v_or_b32 v23,v23,v5
v_and_b32 v5,1,v22
v_lshl_add_u32 v23,v23,1,v5
v_lshlrev_b32 v23,5,v23
v_lshrrev_b32 v5,3,v3
v_lshl_add_u32 v23,v5,9,v23
v_lshrrev_b32 v5,1,v4
v_lshl_add_u32 v23,v5,8,v23
v_and_b32 v5,1,v4
v_lshl_add_u32 v23,v5,4,v23
v_add_u32 v8,s67,v23
v_xor_b32 v9,1024,v8
v_xor_b32 v10,2048,v8
v_xor_b32 v11,3072,v8
v_lshlrev_b32 v31,4,v3
v_lshl_add_u32 v31,v5,3,v31
v_add_u32 v31,155648,v31
v_lshl_add_u32 v23,v4,3,v22
v_lshlrev_b32 v23,4,v23
v_add_u32 v12,155648,v23
v_add_u32 v30,s66,v23
v_cmp_gt_u32 vcc,8,v3
v_cmp_lt_u32 s[52:53],1,v4
s_and_b64 vcc,vcc,s[52:53]
v_mov_b32 v22,0xf149f2ca
v_cndmask_b32 v156,v22,0,vcc
v_mov_b32 v157,v156
v_mov_b32 v158,v156
v_mov_b32 v159,v156
v_add_u32 v2,s69,v16
v_xor_b32 v5,2048,v2
v_xor_b32 v6,4096,v2
v_xor_b32 v7,6144,v2
s_lshr_b32 s64,s57,3
s_add_u32 s64,s64,96
s_lshl_b32 s64,s64,14
s_and_b32 s65,s57,7
s_lshl_b32 s65,s65,10
s_add_u32 s64,s64,s65
s_add_u32 s64,s64,29360128
v_add_u32 v3,s64,v16
v_mov_b32 v136,0
v_mov_b32 v137,0
v_mov_b32 v138,0
v_mov_b32 v139,0
v_mov_b32 v140,0
v_mov_b32 v141,0
v_mov_b32 v142,0
v_mov_b32 v143,0
v_mov_b32 v144,0
v_mov_b32 v145,0
v_mov_b32 v146,0
v_mov_b32 v147,0
v_mov_b32 v152,0x3f803f80
v_mov_b32 v153,0x3f803f80
v_mov_b32 v154,0x3f803f80
v_mov_b32 v155,0x3f803f80
s_branch first_62
loop_63:
s_barrier
buffer_load_dword v248,v18,s[20:23],s70 offen offset:0 sc1
s_nop 15
s_nop 5
hl_65:
buffer_load_dword v249,v18,s[20:23],s70 offen offset:0 sc1
s_waitcnt vmcnt(1)
v_cmp_eq_u32 vcc,v25,v248
s_bcnt1_i32_b32 s64,vcc_lo
s_cmp_ge_u32 s64,8
s_cbranch_scc1 hg_66
buffer_load_dword v248,v18,s[20:23],s70 offen offset:0 sc1
s_waitcnt vmcnt(1)
v_cmp_eq_u32 vcc,v25,v249
s_bcnt1_i32_b32 s64,vcc_lo
s_cmp_ge_u32 s64,8
s_cbranch_scc1 hg_66
s_sub_u32 s90,s90,1
s_cmp_gt_i32 s90,0
s_cbranch_scc1 hl_65
hg_66:
buffer_load_dwordx4 v[32:35],v26,s[20:23],s70 offen offset:0 sc1
buffer_load_dwordx4 v[36:39],v26,s[20:23],s70 offen offset:1024 sc1
buffer_load_dwordx4 v[40:43],v26,s[20:23],s70 offen offset:2048 sc1
buffer_load_dwordx4 v[44:47],v26,s[20:23],s70 offen offset:3072 sc1
s_waitcnt vmcnt(3)
ds_write_b128 v24,v[32:35] offset:0
v_min3_u32 v22,v32,v33,v34
v_min_u32 v22,v22,v35
s_waitcnt vmcnt(2)
ds_write_b128 v24,v[36:39] offset:1024
v_min3_u32 v22,v22,v36,v37
v_min3_u32 v22,v22,v38,v39
s_waitcnt vmcnt(1)
ds_write_b128 v24,v[40:43] offset:2048
v_min3_u32 v22,v22,v40,v41
v_min3_u32 v22,v22,v42,v43
s_waitcnt vmcnt(0)
ds_write_b128 v24,v[44:47] offset:3072
v_min3_u32 v22,v22,v44,v45
v_min3_u32 v22,v22,v46,v47
v_cmp_eq_u32 vcc,0,v22
s_cbranch_vccnz art_67
abk_68:
v_smfmac_f32_16x16x64_bf16 v[176:179],v[32:35],a[0:7],v14
s_waitcnt lgkmcnt(0)
s_barrier
ds_read_b128 v[48:51],v24 offset:4096
ds_read_b128 v[52:55],v24 offset:5120
ds_read_b128 v[56:59],v24 offset:6144
ds_read_b128 v[60:63],v24 offset:7168
v_smfmac_f32_16x16x64_bf16 v[176:179],v[36:39],a[8:15],v14
ds_read_b128 v[64:67],v24 offset:8192
ds_read_b128 v[68:71],v24 offset:9216
v_smfmac_f32_16x16x64_bf16 v[176:179],v[40:43],a[16:23],v14
ds_read_b128 v[72:75],v24 offset:10240
ds_read_b128 v[76:79],v24 offset:11264
v_smfmac_f32_16x16x64_bf16 v[176:179],v[44:47],a[24:31],v14
ds_read_b128 v[80:83],v24 offset:12288
ds_read_b128 v[84:87],v24 offset:13312
s_waitcnt lgkmcnt(9)
v_smfmac_f32_16x16x64_bf16 v[176:179],v[48:51],a[32:39],v14
ds_read_b128 v[88:91],v24 offset:14336
s_waitcnt lgkmcnt(9)
v_smfmac_f32_16x16x64_bf16 v[176:179],v[52:55],a[40:47],v14
ds_read_b128 v[92:95],v24 offset:15360
s_waitcnt lgkmcnt(9)
v_smfmac_f32_16x16x64_bf16 v[176:179],v[56:59],a[48:55],v14
s_waitcnt lgkmcnt(8)
v_smfmac_f32_16x16x64_bf16 v[176:179],v[60:63],a[56:63],v14
s_waitcnt lgkmcnt(7)
v_smfmac_f32_16x16x64_bf16 v[176:179],v[64:67],a[64:71],v14
s_waitcnt lgkmcnt(6)
v_smfmac_f32_16x16x64_bf16 v[176:179],v[68:71],a[72:79],v14
s_waitcnt lgkmcnt(5)
v_smfmac_f32_16x16x64_bf16 v[176:179],v[72:75],a[80:87],v14
s_waitcnt lgkmcnt(4)
v_smfmac_f32_16x16x64_bf16 v[176:179],v[76:79],a[88:95],v14
s_waitcnt lgkmcnt(3)
v_smfmac_f32_16x16x64_bf16 v[176:179],v[80:83],a[96:103],v14
s_waitcnt lgkmcnt(2)
v_smfmac_f32_16x16x64_bf16 v[176:179],v[84:87],a[104:111],v14
s_waitcnt lgkmcnt(1)
v_smfmac_f32_16x16x64_bf16 v[176:179],v[88:91],a[112:119],v14
s_waitcnt lgkmcnt(0)
v_smfmac_f32_16x16x64_bf16 v[176:179],v[92:95],a[120:127],v14
s_nop 7
v_permlane32_swap_b32 v176,v178
v_permlane32_swap_b32 v177,v179
v_add_f32 v176,v176,v178
v_add_f32 v177,v177,v179
v_cvt_pk_bf16_f32 v216,v176,v177
s_nop 1
v_mov_b32_dpp v217,v216 quad_perm:[1,0,3,2] row_mask:0xf bank_mask:0xf
v_perm_b32 v216,v217,v216,v15
v_max_u32 v216,1,v216
buffer_store_dword v216,v19,s[24:27],s70 offen
buffer_store_dword v216,v19,s[28:31],s70 offen sc1
s_lshr_b32 s64,s70,9
v_add_u32 v22,s64,v24
s_cmp_eq_u32 s79,0
ds_read_b128 v[128:131],v22 offset:16384
ds_read_b128 v[132:135],v22 offset:17408
s_cbranch_scc1 kt0_69
kt0b_70:
s_nop 15
s_nop 15
s_nop 11
buffer_load_dwordx4 v[32:35],v8,s[20:23],s70 offen sc1
buffer_load_dwordx4 v[36:39],v9,s[20:23],s70 offen sc1
buffer_load_dwordx4 v[40:43],v10,s[20:23],s70 offen sc1
buffer_load_dwordx4 v[44:47],v11,s[20:23],s70 offen sc1
s_nop 9
scp_71:
buffer_load_dwordx4 v[48:51],v8,s[20:23],s70 offen sc1
buffer_load_dwordx4 v[52:55],v9,s[20:23],s70 offen sc1
buffer_load_dwordx4 v[56:59],v10,s[20:23],s70 offen sc1
buffer_load_dwordx4 v[60:63],v11,s[20:23],s70 offen sc1
s_waitcnt vmcnt(4)
v_mfma_f32_16x16x32_bf16 v[168:171],v[32:35],v[32:35],v[156:159]
v_min3_u32 v22,v32,v33,v34
v_min3_u32 v22,v22,v35,v36
v_mfma_f32_16x16x32_bf16 v[164:167],v[100:103],v[32:35],0
v_min3_u32 v22,v22,v37,v38
v_min3_u32 v22,v22,v39,v40
v_mfma_f32_16x16x32_bf16 v[160:163],v[96:99],v[32:35],0
v_min3_u32 v22,v22,v41,v42
v_min3_u32 v22,v22,v43,v44
v_mfma_f32_16x16x32_bf16 v[168:171],v[36:39],v[36:39],v[168:171]
v_min3_u32 v22,v22,v45,v46
v_min_u32 v22,v22,v47
v_mfma_f32_16x16x32_bf16 v[164:167],v[108:111],v[36:39],v[164:167]
v_cmp_eq_u32 vcc,0,v22
s_cbranch_vccnz nx_73
v_mfma_f32_16x16x32_bf16 v[160:163],v[104:107],v[36:39],v[160:163]
v_mov_b32 v172,v32
v_mfma_f32_16x16x32_bf16 v[168:171],v[40:43],v[40:43],v[168:171]
v_mov_b32 v173,v33
v_mfma_f32_16x16x32_bf16 v[164:167],v[116:119],v[40:43],v[164:167]
v_mov_b32 v174,v34
v_mfma_f32_16x16x32_bf16 v[160:163],v[112:115],v[40:43],v[160:163]
v_mov_b32 v175,v35
v_mfma_f32_16x16x32_bf16 v[168:171],v[44:47],v[44:47],v[168:171]
v_mfma_f32_16x16x32_bf16 v[164:167],v[124:127],v[44:47],v[164:167]
v_mfma_f32_16x16x32_bf16 v[160:163],v[120:123],v[44:47],v[160:163]
s_nop 1
s_branch scok_72
nx_73:
buffer_load_dwordx4 v[32:35],v8,s[20:23],s70 offen sc1
buffer_load_dwordx4 v[36:39],v9,s[20:23],s70 offen sc1
buffer_load_dwordx4 v[40:43],v10,s[20:23],s70 offen sc1
buffer_load_dwordx4 v[44:47],v11,s[20:23],s70 offen sc1
s_waitcnt vmcnt(4)
v_mfma_f32_16x16x32_bf16 v[168:171],v[48:51],v[48:51],v[156:159]
v_min3_u32 v22,v48,v49,v50
v_min3_u32 v22,v22,v51,v52
v_mfma_f32_16x16x32_bf16 v[164:167],v[100:103],v[48:51],0
v_min3_u32 v22,v22,v53,v54
v_min3_u32 v22,v22,v55,v56
v_mfma_f32_16x16x32_bf16 v[160:163],v[96:99],v[48:51],0
v_min3_u32 v22,v22,v57,v58
v_min3_u32 v22,v22,v59,v60
v_mfma_f32_16x16x32_bf16 v[168:171],v[52:55],v[52:55],v[168:171]
v_min3_u32 v22,v22,v61,v62
v_min_u32 v22,v22,v63
v_mfma_f32_16x16x32_bf16 v[164:167],v[108:111],v[52:55],v[164:167]
v_cmp_eq_u32 vcc,0,v22
s_cbranch_vccnz nx_74
v_mfma_f32_16x16x32_bf16 v[160:163],v[104:107],v[52:55],v[160:163]
v_mov_b32 v172,v48
v_mfma_f32_16x16x32_bf16 v[168:171],v[56:59],v[56:59],v[168:171]
v_mov_b32 v173,v49
v_mfma_f32_16x16x32_bf16 v[164:167],v[116:119],v[56:59],v[164:167]
v_mov_b32 v174,v50
v_mfma_f32_16x16x32_bf16 v[160:163],v[112:115],v[56:59],v[160:163]
v_mov_b32 v175,v51
v_mfma_f32_16x16x32_bf16 v[168:171],v[60:63],v[60:63],v[168:171]
v_mfma_f32_16x16x32_bf16 v[164:167],v[124:127],v[60:63],v[164:167]
v_mfma_f32_16x16x32_bf16 v[160:163],v[120:123],v[60:63],v[160:163]
s_nop 1
s_branch scok_72
nx_74:
s_sub_u32 s90,s90,1
s_cmp_gt_i32 s90,0
s_cbranch_scc1 scp_71
s_nop 7
scok_72:
ds_read_b64 v[220:221],v21
ds_read_b64 v[136:137],v31
ds_read_b64 v[140:141],v31 offset:256
s_cmp_ge_u32 s79,62
s_cbranch_scc1 ke_76
keb_77:
v_max3_f32 v216,v168,v169,v170
v_mov_b32_dpp v160,v164 row_ror:8 row_mask:0xf bank_mask:0xc
v_mov_b32_dpp v161,v165 row_ror:8 row_mask:0xf bank_mask:0xc
v_mov_b32_dpp v162,v166 row_ror:8 row_mask:0xf bank_mask:0xc
v_mov_b32_dpp v163,v167 row_ror:8 row_mask:0xf bank_mask:0xc
v_max3_f32 v217,v171,v160,v161
v_max3_f32 v216,v216,v162,v163
v_max_f32 v216,v216,v217
s_nop 1
v_max_f32_dpp v216,v216,v216 row_ror:8 row_mask:0xf bank_mask:0xf
v_mov_b32 v217,v216
s_nop 1
v_permlane16_swap_b32 v217,v216
v_max_f32 v216,v216,v217
v_mov_b32 v217,v216
s_nop 1
v_permlane32_swap_b32 v217,v216
v_max_f32 v216,v216,v217
v_mul_f32 v216,s81,v216
v_fma_f32 v160,v160,s81,-v216
v_fma_f32 v161,v161,s81,-v216
v_fma_f32 v162,v162,s81,-v216
v_fma_f32 v163,v163,s81,-v216
v_fma_f32 v168,v168,s81,-v216
v_fma_f32 v169,v169,s81,-v216
v_fma_f32 v170,v170,s81,-v216
v_fma_f32 v171,v171,s81,-v216
v_exp_f32 v160,v160
v_exp_f32 v161,v161
v_exp_f32 v162,v162
v_exp_f32 v163,v163
v_exp_f32 v168,v168
v_exp_f32 v169,v169
v_exp_f32 v170,v170
v_exp_f32 v171,v171
v_cvt_pk_bf16_f32 v148,v160,v161
v_cvt_pk_bf16_f32 v149,v162,v163
v_cvt_pk_bf16_f32 v144,v168,v169
v_mov_b32_dpp v150,v148 row_ror:8 row_mask:0xf bank_mask:0xf
v_mov_b32_dpp v151,v149 row_ror:8 row_mask:0xf bank_mask:0xf
v_cvt_pk_bf16_f32 v145,v170,v171
s_waitcnt lgkmcnt(0)
v_min_u32 v220,v220,v221
v_mfma_f32_16x16x32_bf16 v[232:235],v[152:155],v[148:151],0
v_cmp_ne_u32 vcc,v220,v25
v_mfma_f32_16x16x32_bf16 v[232:235],v[152:155],v[144:147],v[232:235]
v_mfma_f32_16x16x32_bf16 v[224:227],v[128:131],v[148:151],0
v_mfma_f32_16x16x32_bf16 v[228:231],v[132:135],v[148:151],0
s_cbranch_vccnz vw_78
vb_79:
v_mfma_f32_16x16x32_bf16 v[224:227],v[136:139],v[144:147],v[224:227]
v_mfma_f32_16x16x32_bf16 v[228:231],v[140:143],v[144:147],v[228:231]
s_mov_b64 exec,s[84:85]
s_nop 1
v_rcp_f32 v236,v232
s_nop 2
v_pk_mul_f32 v[224:225],v[224:225],v[236:237] op_sel_hi:[1,0]
v_pk_mul_f32 v[226:227],v[226:227],v[236:237] op_sel_hi:[1,0]
v_pk_mul_f32 v[228:229],v[228:229],v[236:237] op_sel_hi:[1,0]
v_pk_mul_f32 v[230:231],v[230:231],v[236:237] op_sel_hi:[1,0]
v_cvt_pk_bf16_f32 v216,v224,v225
v_cvt_pk_bf16_f32 v217,v226,v227
v_cvt_pk_bf16_f32 v218,v228,v229
v_cvt_pk_bf16_f32 v219,v230,v231
v_max_u32 v216,1,v216
v_max_u32 v217,1,v217
v_max_u32 v218,1,v218
v_max_u32 v219,1,v219
buffer_store_dwordx4 v[216:219],v30,s[24:27],s71 offen
buffer_store_dwordx4 v[216:219],v30,s[28:31],s71 offen sc1
s_mov_b64 exec,1
buffer_store_dword v25,v13,s[24:27],s70 offen offset:512
buffer_store_dword v25,v13,s[28:31],s70 offen offset:512 sc1
s_mov_b64 exec,-1
ds_write_b32 v21,v25 offset:8
hl_80:
buffer_load_dword v248,v18,s[20:23],s70 offen offset:512 sc1
s_waitcnt vmcnt(0)
v_cmp_eq_u32 vcc,v25,v248
s_bcnt1_i32_b32 s64,vcc_lo
s_cmp_ge_u32 s64,16
s_cbranch_scc1 hg_81
s_sub_u32 s90,s90,1
s_cmp_gt_i32 s90,0
s_cbranch_scc1 hl_80
hg_81:
buffer_load_dwordx4 v[32:35],v26,s[20:23],s71 offen offset:0 sc1
buffer_load_dwordx4 v[36:39],v26,s[20:23],s71 offen offset:1024 sc1
buffer_load_dwordx4 v[40:43],v26,s[20:23],s71 offen offset:2048 sc1
buffer_load_dwordx4 v[44:47],v26,s[20:23],s71 offen offset:3072 sc1
buffer_load_dwordx4 v[48:51],v27,s[20:23],s71 offen offset:0 sc1
buffer_load_dwordx4 v[52:55],v27,s[20:23],s71 offen offset:1024 sc1
buffer_load_dwordx4 v[56:59],v27,s[20:23],s71 offen offset:2048 sc1
buffer_load_dwordx4 v[60:63],v27,s[20:23],s71 offen offset:3072 sc1
s_mov_b32 s68,0
s_waitcnt vmcnt(6)
v_smfmac_f32_16x16x64_bf16 v[184:187],v[32:35],a[128:135],v14
v_min3_u32 v22,v32,v33,v34
v_min3_u32 v22,v22,v35,v36
v_smfmac_f32_16x16x64_bf16 v[188:191],v[32:35],a[136:143],v14
v_min3_u32 v22,v22,v37,v38
v_smfmac_f32_16x16x64_bf16 v[184:187],v[36:39],a[144:151],v14
v_min_u32 v22,v22,v39
v_smfmac_f32_16x16x64_bf16 v[188:191],v[36:39],a[152:159],v14
v_cmp_eq_u32 s[52:53],0,v22
s_waitcnt vmcnt(4)
v_smfmac_f32_16x16x64_bf16 v[184:187],v[40:43],a[160:167],v14
v_min3_u32 v22,v40,v41,v42
s_cmp_lg_u64 s[52:53],0
v_smfmac_f32_16x16x64_bf16 v[188:191],v[40:43],a[168:175],v14
s_cbranch_scc1 ms_82
bk_83:
v_min3_u32 v22,v22,v43,v44
v_smfmac_f32_16x16x64_bf16 v[184:187],v[44:47],a[176:183],v14
v_min3_u32 v22,v22,v45,v46
v_min_u32 v22,v22,v47
v_smfmac_f32_16x16x64_bf16 v[188:191],v[44:47],a[184:191],v14
v_cmp_eq_u32 s[54:55],0,v22
s_waitcnt vmcnt(2)
v_smfmac_f32_16x16x64_bf16 v[184:187],v[48:51],a[192:199],v14
v_min3_u32 v22,v48,v49,v50
s_cmp_lg_u64 s[54:55],0
v_smfmac_f32_16x16x64_bf16 v[188:191],v[48:51],a[200:207],v14
s_cbranch_scc1 ms_84
bk_85:
v_min3_u32 v22,v22,v51,v52
v_smfmac_f32_16x16x64_bf16 v[184:187],v[52:55],a[208:215],v14
v_min3_u32 v22,v22,v53,v54
v_min_u32 v22,v22,v55
v_smfmac_f32_16x16x64_bf16 v[188:191],v[52:55],a[216:223],v14
v_cmp_eq_u32 s[52:53],0,v22
s_waitcnt vmcnt(0)
v_smfmac_f32_16x16x64_bf16 v[184:187],v[56:59],a[224:231],v14
v_min3_u32 v22,v56,v57,v58
s_cmp_lg_u64 s[52:53],0
v_smfmac_f32_16x16x64_bf16 v[188:191],v[56:59],a[232:239],v14
s_cbranch_scc1 ms_86
bk_87:
v_min3_u32 v22,v22,v59,v60
v_smfmac_f32_16x16x64_bf16 v[184:187],v[60:63],a[240:247],v14
v_min3_u32 v22,v22,v61,v62
v_min_u32 v22,v22,v63
v_smfmac_f32_16x16x64_bf16 v[188:191],v[60:63],a[248:255],v14
v_cmp_eq_u32 s[54:55],0,v22
s_cmp_lg_u64 s[54:55],0
s_cbranch_scc1 ms_90
bk_91:
s_cmp_lg_u32 s68,0
s_cbranch_scc1 rl2_92
fin_88:
s_nop 2
v_permlane32_swap_b32 v184,v188
v_permlane32_swap_b32 v185,v189
v_permlane32_swap_b32 v186,v190
v_permlane32_swap_b32 v187,v191
v_pk_add_f32 v[184:185],v[184:185],v[188:189]
v_pk_add_f32 v[186:187],v[186:187],v[190:191]
ds_write_b128 v24,v[184:187] offset:25600
ds_write_b32 v21,v25 offset:12
s_mov_b64 exec,s[84:85]
ds_read_b128 v[172:175],v12
s_mov_b64 exec,-1
ds_read_b64 v[220:221],v21 offset:24
buffer_load_dwordx4 v[96:99],v2,s[20:23],s72 offen offset:0 sc1
buffer_load_dwordx4 v[100:103],v2,s[20:23],s72 offen offset:1024 sc1
buffer_load_dwordx4 v[104:107],v5,s[20:23],s72 offen offset:0 sc1
buffer_load_dwordx4 v[108:111],v5,s[20:23],s72 offen offset:1024 sc1
buffer_load_dwordx4 v[112:115],v6,s[20:23],s72 offen offset:0 sc1
buffer_load_dwordx4 v[116:119],v6,s[20:23],s72 offen offset:1024 sc1
buffer_load_dwordx4 v[120:123],v7,s[20:23],s72 offen offset:0 sc1
buffer_load_dwordx4 v[124:127],v7,s[20:23],s72 offen offset:1024 sc1
s_waitcnt lgkmcnt(0)
v_min_u32 v220,v220,v221
v_cmp_ne_u32 vcc,v220,v25
s_cbranch_vccnz v2w_93
v2b_94:
buffer_store_dwordx4 v[172:175],v3,s[20:23],s77 offen sc1
s_xor_b32 s62,s62,0x10000
s_add_u32 s63,s79,1
s_and_b32 s64,s63,3
s_lshl_b32 s70,s64,20
s_add_u32 s65,s63,2
s_and_b32 s65,s65,3
s_lshl_b32 s73,s65,20
s_add_u32 s55,s63,3
s_lshl_b32 s78,s55,16
s_add_u32 s78,s78,57344
s_cmp_lt_u32 s55,64
s_cselect_b32 s78,s78,0x7fff0000
s_add_u32 s71,s70,65536
s_add_u32 s60,s63,1
s_and_b32 s60,s60,3
s_lshl_b32 s72,s60,20
v_mov_b32 v184,0
v_mov_b32 v185,0
v_mov_b32 v186,0
v_mov_b32 v187,0
v_mov_b32 v188,0
v_mov_b32 v189,0
v_mov_b32 v190,0
v_mov_b32 v191,0
s_lshl_b32 s77,s63,21
s_lshl_b32 s55,s63,13
s_and_b32 s55,s55,0x2000
s_xor_b32 s55,s55,s61
s_add_u32 s77,s77,s55
v_mov_b32 v176,0
v_mov_b32 v177,0
v_mov_b32 v178,0
v_mov_b32 v179,0
s_add_u32 s79,s79,1
v_add_u32 v25,1,v25
s_waitcnt vmcnt(0) lgkmcnt(0)
s_branch loop_63
last0_75:
wf_95:
ds_read_b32 v23,v21 offset:0
s_sub_u32 s90,s90,1
s_waitcnt lgkmcnt(0)
v_cmp_ne_u32 vcc,v23,v25
s_cmp_lt_i32 s90,0
s_cselect_b64 vcc,0,vcc
s_cbranch_vccnz wf_95
wf_96:
ds_read_b32 v23,v21 offset:4
s_sub_u32 s90,s90,1
s_waitcnt lgkmcnt(0)
v_cmp_ne_u32 vcc,v23,v25
s_cmp_lt_i32 s90,0
s_cselect_b64 vcc,0,vcc
s_cbranch_vccnz wf_96
s_mov_b64 exec,s[84:85]
ds_read_b128 v[172:175],v12
s_mov_b64 exec,-1
s_waitcnt lgkmcnt(0)
buffer_store_dwordx4 v[172:175],v3,s[20:23],s77 offen sc1
s_branch end_57
art_67:
s_sub_u32 s90,s90,1
s_cmp_lt_i32 s90,0
s_cbranch_scc1 abk_68
buffer_load_dwordx4 v[32:35],v26,s[20:23],s70 offen offset:0 sc1
buffer_load_dwordx4 v[36:39],v26,s[20:23],s70 offen offset:1024 sc1
buffer_load_dwordx4 v[40:43],v26,s[20:23],s70 offen offset:2048 sc1
buffer_load_dwordx4 v[44:47],v26,s[20:23],s70 offen offset:3072 sc1
s_waitcnt vmcnt(3)
ds_write_b128 v24,v[32:35] offset:0
v_min3_u32 v22,v32,v33,v34
v_min_u32 v22,v22,v35
s_waitcnt vmcnt(2)
ds_write_b128 v24,v[36:39] offset:1024
v_min3_u32 v22,v22,v36,v37
v_min3_u32 v22,v22,v38,v39
s_waitcnt vmcnt(1)
ds_write_b128 v24,v[40:43] offset:2048
v_min3_u32 v22,v22,v40,v41
v_min3_u32 v22,v22,v42,v43
s_waitcnt vmcnt(0)
ds_write_b128 v24,v[44:47] offset:3072
v_min3_u32 v22,v22,v44,v45
v_min3_u32 v22,v22,v46,v47
v_cmp_eq_u32 vcc,0,v22
s_cbranch_vccnz art_67
s_branch abk_68
kt0_69:
buffer_load_dwordx4 v[96:99],v2,s[20:23],s70 offen offset:0 sc1
buffer_load_dwordx4 v[100:103],v2,s[20:23],s70 offen offset:1024 sc1
buffer_load_dwordx4 v[104:107],v5,s[20:23],s70 offen offset:0 sc1
buffer_load_dwordx4 v[108:111],v5,s[20:23],s70 offen offset:1024 sc1
buffer_load_dwordx4 v[112:115],v6,s[20:23],s70 offen offset:0 sc1
buffer_load_dwordx4 v[116:119],v6,s[20:23],s70 offen offset:1024 sc1
buffer_load_dwordx4 v[120:123],v7,s[20:23],s70 offen offset:0 sc1
buffer_load_dwordx4 v[124:127],v7,s[20:23],s70 offen offset:1024 sc1
s_branch kt0b_70
ke_76:
s_cmp_eq_u32 s79,63
s_cbranch_scc1 last0_75
ds_read_b64 v[222:223],v21 offset:24
s_mov_b64 exec,s[84:85]
ds_read_b128 v[172:175],v12
s_mov_b64 exec,-1
s_waitcnt lgkmcnt(0)
v_min3_u32 v222,v222,v223,v220
v_min_u32 v222,v222,v221
v_cmp_ne_u32 vcc,v222,v25
s_cbranch_vccnz keb_77
buffer_store_dwordx4 v[172:175],v3,s[20:23],s77 offen sc1
s_mov_b32 s77,0x7fff0000
s_branch keb_77
vw_78:
wf_97:
ds_read_b32 v23,v21 offset:0
s_sub_u32 s90,s90,1
s_waitcnt lgkmcnt(0)
v_cmp_ne_u32 vcc,v23,v25
s_cmp_lt_i32 s90,0
s_cselect_b64 vcc,0,vcc
s_cbranch_vccnz wf_97
wf_98:
ds_read_b32 v23,v21 offset:4
s_sub_u32 s90,s90,1
s_waitcnt lgkmcnt(0)
v_cmp_ne_u32 vcc,v23,v25
s_cmp_lt_i32 s90,0
s_cselect_b64 vcc,0,vcc
s_cbranch_vccnz wf_98
ds_read_b64 v[220:221],v21
ds_read_b64 v[136:137],v31
ds_read_b64 v[140:141],v31 offset:256
s_waitcnt lgkmcnt(0)
s_branch vb_79
ms_82:
s_waitcnt vmcnt(0)
buffer_load_dwordx4 v[64:67],v26,s[20:23],s71 offen offset:0 sc1
buffer_load_dwordx4 v[68:71],v26,s[20:23],s71 offen offset:1024 sc1
s_bitset1_b32 s68,0
s_branch bk_83
ms_84:
s_waitcnt vmcnt(0)
buffer_load_dwordx4 v[72:75],v26,s[20:23],s71 offen offset:2048 sc1
buffer_load_dwordx4 v[76:79],v26,s[20:23],s71 offen offset:3072 sc1
s_bitset1_b32 s68,1
s_branch bk_85
ms_86:
s_waitcnt vmcnt(0)
buffer_load_dwordx4 v[80:83],v27,s[20:23],s71 offen offset:0 sc1
buffer_load_dwordx4 v[84:87],v27,s[20:23],s71 offen offset:1024 sc1
s_bitset1_b32 s68,2
s_branch bk_87
ms_90:
s_waitcnt vmcnt(0)
buffer_load_dwordx4 v[88:91],v27,s[20:23],s71 offen offset:2048 sc1
buffer_load_dwordx4 v[92:95],v27,s[20:23],s71 offen offset:3072 sc1
s_bitset1_b32 s68,3
s_branch bk_91
rl_89:
s_bitcmp1_b32 s68,0
s_cbranch_scc0 sk_99
buffer_load_dwordx4 v[64:67],v26,s[20:23],s71 offen offset:0 sc1
buffer_load_dwordx4 v[68:71],v26,s[20:23],s71 offen offset:1024 sc1
sk_99:
s_bitcmp1_b32 s68,1
s_cbranch_scc0 sk_100
buffer_load_dwordx4 v[72:75],v26,s[20:23],s71 offen offset:2048 sc1
buffer_load_dwordx4 v[76:79],v26,s[20:23],s71 offen offset:3072 sc1
sk_100:
s_bitcmp1_b32 s68,2
s_cbranch_scc0 sk_101
buffer_load_dwordx4 v[80:83],v27,s[20:23],s71 offen offset:0 sc1
buffer_load_dwordx4 v[84:87],v27,s[20:23],s71 offen offset:1024 sc1
sk_101:
s_bitcmp1_b32 s68,3
s_cbranch_scc0 sk_102
buffer_load_dwordx4 v[88:91],v27,s[20:23],s71 offen offset:2048 sc1
buffer_load_dwordx4 v[92:95],v27,s[20:23],s71 offen offset:3072 sc1
sk_102:
rl2_92:
s_sub_u32 s90,s90,1
s_cmp_lt_i32 s90,0
s_cbranch_scc1 fin_88
s_waitcnt vmcnt(0)
s_bitcmp1_b32 s68,0
s_cbranch_scc0 sk_103
v_min3_u32 v22,v64,v65,v66
v_min3_u32 v22,v22,v67,v68
v_min3_u32 v22,v22,v69,v70
v_min_u32 v22,v22,v71
v_cmp_eq_u32 vcc,0,v22
v_xor_b32 v64,v32,v64
v_xor_b32 v65,v33,v65
v_xor_b32 v66,v34,v66
v_xor_b32 v67,v35,v67
v_xor_b32 v68,v36,v68
v_xor_b32 v69,v37,v69
v_xor_b32 v70,v38,v70
v_xor_b32 v71,v39,v71
s_cbranch_vccnz nb_104
s_bitset0_b32 s68,0
v_smfmac_f32_16x16x64_bf16 v[184:187],v[64:67],a[128:135],v14
v_smfmac_f32_16x16x64_bf16 v[188:191],v[64:67],a[136:143],v14
v_smfmac_f32_16x16x64_bf16 v[184:187],v[68:71],a[144:151],v14
v_smfmac_f32_16x16x64_bf16 v[188:191],v[68:71],a[152:159],v14
nb_104:
sk_103:
s_bitcmp1_b32 s68,1
s_cbranch_scc0 sk_105
v_min3_u32 v22,v72,v73,v74
v_min3_u32 v22,v22,v75,v76
v_min3_u32 v22,v22,v77,v78
v_min_u32 v22,v22,v79
v_cmp_eq_u32 vcc,0,v22
v_xor_b32 v72,v40,v72
v_xor_b32 v73,v41,v73
v_xor_b32 v74,v42,v74
v_xor_b32 v75,v43,v75
v_xor_b32 v76,v44,v76
v_xor_b32 v77,v45,v77
v_xor_b32 v78,v46,v78
v_xor_b32 v79,v47,v79
s_cbranch_vccnz nb_106
s_bitset0_b32 s68,1
v_smfmac_f32_16x16x64_bf16 v[184:187],v[72:75],a[160:167],v14
v_smfmac_f32_16x16x64_bf16 v[188:191],v[72:75],a[168:175],v14
v_smfmac_f32_16x16x64_bf16 v[184:187],v[76:79],a[176:183],v14
v_smfmac_f32_16x16x64_bf16 v[188:191],v[76:79],a[184:191],v14
nb_106:
sk_105:
s_bitcmp1_b32 s68,2
s_cbranch_scc0 sk_107
v_min3_u32 v22,v80,v81,v82
v_min3_u32 v22,v22,v83,v84
v_min3_u32 v22,v22,v85,v86
v_min_u32 v22,v22,v87
v_cmp_eq_u32 vcc,0,v22
v_xor_b32 v80,v48,v80
v_xor_b32 v81,v49,v81
v_xor_b32 v82,v50,v82
v_xor_b32 v83,v51,v83
v_xor_b32 v84,v52,v84
v_xor_b32 v85,v53,v85
v_xor_b32 v86,v54,v86
v_xor_b32 v87,v55,v87
s_cbranch_vccnz nb_108
s_bitset0_b32 s68,2
v_smfmac_f32_16x16x64_bf16 v[184:187],v[80:83],a[192:199],v14
v_smfmac_f32_16x16x64_bf16 v[188:191],v[80:83],a[200:207],v14
v_smfmac_f32_16x16x64_bf16 v[184:187],v[84:87],a[208:215],v14
v_smfmac_f32_16x16x64_bf16 v[188:191],v[84:87],a[216:223],v14
nb_108:
sk_107:
s_bitcmp1_b32 s68,3
s_cbranch_scc0 sk_109
v_min3_u32 v22,v88,v89,v90
v_min3_u32 v22,v22,v91,v92
v_min3_u32 v22,v22,v93,v94
v_min_u32 v22,v22,v95
v_cmp_eq_u32 vcc,0,v22
v_xor_b32 v88,v56,v88
v_xor_b32 v89,v57,v89
v_xor_b32 v90,v58,v90
v_xor_b32 v91,v59,v91
v_xor_b32 v92,v60,v92
v_xor_b32 v93,v61,v93
v_xor_b32 v94,v62,v94
v_xor_b32 v95,v63,v95
s_cbranch_vccnz nb_110
s_bitset0_b32 s68,3
v_smfmac_f32_16x16x64_bf16 v[184:187],v[88:91],a[224:231],v14
v_smfmac_f32_16x16x64_bf16 v[188:191],v[88:91],a[232:239],v14
v_smfmac_f32_16x16x64_bf16 v[184:187],v[92:95],a[240:247],v14
v_smfmac_f32_16x16x64_bf16 v[188:191],v[92:95],a[248:255],v14
nb_110:
sk_109:
s_cmp_lg_u32 s68,0
s_cbranch_scc1 rl_89
s_nop 2
s_branch fin_88
v2w_93:
wf_111:
ds_read_b32 v23,v21 offset:24
s_sub_u32 s90,s90,1
s_waitcnt lgkmcnt(0)
v_cmp_ne_u32 vcc,v23,v25
s_cmp_lt_i32 s90,0
s_cselect_b64 vcc,0,vcc
s_cbranch_vccnz wf_111
wf_112:
ds_read_b32 v23,v21 offset:28
s_sub_u32 s90,s90,1
s_waitcnt lgkmcnt(0)
v_cmp_ne_u32 vcc,v23,v25
s_cmp_lt_i32 s90,0
s_cselect_b64 vcc,0,vcc
s_cbranch_vccnz wf_112
s_branch v2b_94
first_62:
s_waitcnt vmcnt(0) lgkmcnt(0)
s_barrier
s_add_u32 s64,s15,393216
buffer_load_dwordx4 a[176:179],v32,s[40:43],s64 offen nt
s_add_u32 s64,s15,425984
buffer_load_dwordx4 a[180:183],v32,s[40:43],s64 offen nt
s_add_u32 s64,s15,458752
buffer_load_dwordx4 a[184:187],v32,s[40:43],s64 offen nt
s_add_u32 s64,s15,491520
buffer_load_dwordx4 a[188:191],v32,s[40:43],s64 offen nt
s_add_u32 s64,s15,524288
buffer_load_dwordx4 a[192:195],v32,s[40:43],s64 offen nt
s_add_u32 s64,s15,557056
buffer_load_dwordx4 a[196:199],v32,s[40:43],s64 offen nt
s_add_u32 s64,s15,589824
buffer_load_dwordx4 a[200:203],v32,s[40:43],s64 offen nt
s_add_u32 s64,s15,622592
buffer_load_dwordx4 a[204:207],v32,s[40:43],s64 offen nt
s_add_u32 s64,s15,655360
buffer_load_dwordx4 a[208:211],v32,s[40:43],s64 offen nt
s_add_u32 s64,s15,688128
buffer_load_dwordx4 a[212:215],v32,s[40:43],s64 offen nt
s_add_u32 s64,s15,720896
buffer_load_dwordx4 a[216:219],v32,s[40:43],s64 offen nt
s_add_u32 s64,s15,753664
buffer_load_dwordx4 a[220:223],v32,s[40:43],s64 offen nt
s_add_u32 s64,s15,786432
buffer_load_dwordx4 a[224:227],v32,s[40:43],s64 offen nt
s_add_u32 s64,s15,819200
buffer_load_dwordx4 a[228:231],v32,s[40:43],s64 offen nt
s_add_u32 s64,s15,851968
buffer_load_dwordx4 a[232:235],v32,s[40:43],s64 offen nt
s_add_u32 s64,s15,884736
buffer_load_dwordx4 a[236:239],v32,s[40:43],s64 offen nt
s_add_u32 s64,s15,917504
buffer_load_dwordx4 a[240:243],v32,s[40:43],s64 offen nt
s_add_u32 s64,s15,950272
buffer_load_dwordx4 a[244:247],v32,s[40:43],s64 offen nt
s_add_u32 s64,s15,983040
buffer_load_dwordx4 a[248:251],v32,s[40:43],s64 offen nt
s_add_u32 s64,s15,1015808
buffer_load_dwordx4 a[252:255],v32,s[40:43],s64 offen nt
ds_write_b128 v33,a[0:3] offset:0
ds_write_b128 v33,a[4:7] offset:1024
ds_write_b128 v33,a[8:11] offset:2048
ds_write_b128 v33,a[12:15] offset:3072
s_waitcnt lgkmcnt(0)
v_mov_b32 v38,1
ds_write_b32 v37,v38 offset:0
qs_113:
ds_read_b32 v39,v37 offset:4
s_sub_u32 s90,s90,1
s_waitcnt lgkmcnt(0)
v_cmp_gt_u32 vcc,v38,v39
s_cmp_lt_i32 s90,0
s_cselect_b64 vcc,0,vcc
s_cbranch_vccnz qs_113
ds_read_b64_tr_b16 a[0:1],v36 offset:0
ds_read_b64_tr_b16 a[2:3],v36 offset:128
ds_read_b64_tr_b16 a[4:5],v36 offset:2048
ds_read_b64_tr_b16 a[6:7],v36 offset:2176
ds_read_b64_tr_b16 a[8:9],v36 offset:8192
ds_read_b64_tr_b16 a[10:11],v36 offset:8320
ds_read_b64_tr_b16 a[12:13],v36 offset:10240
ds_read_b64_tr_b16 a[14:15],v36 offset:10368
ds_write_b128 v33,a[16:19] offset:4096
ds_write_b128 v33,a[20:23] offset:5120
ds_write_b128 v33,a[24:27] offset:6144
ds_write_b128 v33,a[28:31] offset:7168
s_waitcnt lgkmcnt(0)
v_mov_b32 v38,2
ds_write_b32 v37,v38 offset:0
qs_114:
ds_read_b32 v39,v37 offset:4
s_sub_u32 s90,s90,1
s_waitcnt lgkmcnt(0)
v_cmp_gt_u32 vcc,v38,v39
s_cmp_lt_i32 s90,0
s_cselect_b64 vcc,0,vcc
s_cbranch_vccnz qs_114
ds_read_b64_tr_b16 a[16:17],v36 offset:4096
ds_read_b64_tr_b16 a[18:19],v36 offset:4224
ds_read_b64_tr_b16 a[20:21],v36 offset:6144
ds_read_b64_tr_b16 a[22:23],v36 offset:6272
ds_read_b64_tr_b16 a[24:25],v36 offset:12288
ds_read_b64_tr_b16 a[26:27],v36 offset:12416
ds_read_b64_tr_b16 a[28:29],v36 offset:14336
ds_read_b64_tr_b16 a[30:31],v36 offset:14464
ds_write_b128 v33,a[32:35] offset:0
ds_write_b128 v33,a[36:39] offset:1024
ds_write_b128 v33,a[40:43] offset:2048
ds_write_b128 v33,a[44:47] offset:3072
s_waitcnt lgkmcnt(0)
v_mov_b32 v38,3
ds_write_b32 v37,v38 offset:0
qs_115:
ds_read_b32 v39,v37 offset:4
s_sub_u32 s90,s90,1
s_waitcnt lgkmcnt(0)
v_cmp_gt_u32 vcc,v38,v39
s_cmp_lt_i32 s90,0
s_cselect_b64 vcc,0,vcc
s_cbranch_vccnz qs_115
ds_read_b64_tr_b16 a[32:33],v36 offset:0
ds_read_b64_tr_b16 a[34:35],v36 offset:128
ds_read_b64_tr_b16 a[36:37],v36 offset:2048
ds_read_b64_tr_b16 a[38:39],v36 offset:2176
ds_read_b64_tr_b16 a[40:41],v36 offset:8192
ds_read_b64_tr_b16 a[42:43],v36 offset:8320
ds_read_b64_tr_b16 a[44:45],v36 offset:10240
ds_read_b64_tr_b16 a[46:47],v36 offset:10368
ds_write_b128 v33,a[48:51] offset:4096
ds_write_b128 v33,a[52:55] offset:5120
ds_write_b128 v33,a[56:59] offset:6144
ds_write_b128 v33,a[60:63] offset:7168
s_waitcnt lgkmcnt(0)
v_mov_b32 v38,4
ds_write_b32 v37,v38 offset:0
qs_116:
ds_read_b32 v39,v37 offset:4
s_sub_u32 s90,s90,1
s_waitcnt lgkmcnt(0)
v_cmp_gt_u32 vcc,v38,v39
s_cmp_lt_i32 s90,0
s_cselect_b64 vcc,0,vcc
s_cbranch_vccnz qs_116
ds_read_b64_tr_b16 a[48:49],v36 offset:4096
ds_read_b64_tr_b16 a[50:51],v36 offset:4224
ds_read_b64_tr_b16 a[52:53],v36 offset:6144
ds_read_b64_tr_b16 a[54:55],v36 offset:6272
ds_read_b64_tr_b16 a[56:57],v36 offset:12288
ds_read_b64_tr_b16 a[58:59],v36 offset:12416
ds_read_b64_tr_b16 a[60:61],v36 offset:14336
ds_read_b64_tr_b16 a[62:63],v36 offset:14464
ds_write_b128 v33,a[64:67] offset:0
ds_write_b128 v33,a[68:71] offset:1024
ds_write_b128 v33,a[72:75] offset:2048
ds_write_b128 v33,a[76:79] offset:3072
s_waitcnt lgkmcnt(0)
v_mov_b32 v38,5
ds_write_b32 v37,v38 offset:0
qs_117:
ds_read_b32 v39,v37 offset:4
s_sub_u32 s90,s90,1
s_waitcnt lgkmcnt(0)
v_cmp_gt_u32 vcc,v38,v39
s_cmp_lt_i32 s90,0
s_cselect_b64 vcc,0,vcc
s_cbranch_vccnz qs_117
ds_read_b64_tr_b16 a[64:65],v36 offset:0
ds_read_b64_tr_b16 a[66:67],v36 offset:128
ds_read_b64_tr_b16 a[68:69],v36 offset:2048
ds_read_b64_tr_b16 a[70:71],v36 offset:2176
ds_read_b64_tr_b16 a[72:73],v36 offset:8192
ds_read_b64_tr_b16 a[74:75],v36 offset:8320
ds_read_b64_tr_b16 a[76:77],v36 offset:10240
ds_read_b64_tr_b16 a[78:79],v36 offset:10368
ds_write_b128 v33,a[80:83] offset:4096
ds_write_b128 v33,a[84:87] offset:5120
ds_write_b128 v33,a[88:91] offset:6144
ds_write_b128 v33,a[92:95] offset:7168
s_waitcnt lgkmcnt(0)
v_mov_b32 v38,6
ds_write_b32 v37,v38 offset:0
qs_118:
ds_read_b32 v39,v37 offset:4
s_sub_u32 s90,s90,1
s_waitcnt lgkmcnt(0)
v_cmp_gt_u32 vcc,v38,v39
s_cmp_lt_i32 s90,0
s_cselect_b64 vcc,0,vcc
s_cbranch_vccnz qs_118
ds_read_b64_tr_b16 a[80:81],v36 offset:4096
ds_read_b64_tr_b16 a[82:83],v36 offset:4224
ds_read_b64_tr_b16 a[84:85],v36 offset:6144
ds_read_b64_tr_b16 a[86:87],v36 offset:6272
ds_read_b64_tr_b16 a[88:89],v36 offset:12288
ds_read_b64_tr_b16 a[90:91],v36 offset:12416
ds_read_b64_tr_b16 a[92:93],v36 offset:14336
ds_read_b64_tr_b16 a[94:95],v36 offset:14464
ds_write_b128 v33,a[96:99] offset:0
ds_write_b128 v33,a[100:103] offset:1024
ds_write_b128 v33,a[104:107] offset:2048
ds_write_b128 v33,a[108:111] offset:3072
s_waitcnt lgkmcnt(0)
v_mov_b32 v38,7
ds_write_b32 v37,v38 offset:0
qs_119:
ds_read_b32 v39,v37 offset:4
s_sub_u32 s90,s90,1
s_waitcnt lgkmcnt(0)
v_cmp_gt_u32 vcc,v38,v39
s_cmp_lt_i32 s90,0
s_cselect_b64 vcc,0,vcc
s_cbranch_vccnz qs_119
ds_read_b64_tr_b16 a[96:97],v36 offset:0
ds_read_b64_tr_b16 a[98:99],v36 offset:128
ds_read_b64_tr_b16 a[100:101],v36 offset:2048
ds_read_b64_tr_b16 a[102:103],v36 offset:2176
ds_read_b64_tr_b16 a[104:105],v36 offset:8192
ds_read_b64_tr_b16 a[106:107],v36 offset:8320
ds_read_b64_tr_b16 a[108:109],v36 offset:10240
ds_read_b64_tr_b16 a[110:111],v36 offset:10368
ds_write_b128 v33,a[112:115] offset:4096
ds_write_b128 v33,a[116:119] offset:5120
ds_write_b128 v33,a[120:123] offset:6144
ds_write_b128 v33,a[124:127] offset:7168
s_waitcnt lgkmcnt(0)
v_mov_b32 v38,8
ds_write_b32 v37,v38 offset:0
qs_120:
ds_read_b32 v39,v37 offset:4
s_sub_u32 s90,s90,1
s_waitcnt lgkmcnt(0)
v_cmp_gt_u32 vcc,v38,v39
s_cmp_lt_i32 s90,0
s_cselect_b64 vcc,0,vcc
s_cbranch_vccnz qs_120
ds_read_b64_tr_b16 a[112:113],v36 offset:4096
ds_read_b64_tr_b16 a[114:115],v36 offset:4224
ds_read_b64_tr_b16 a[116:117],v36 offset:6144
ds_read_b64_tr_b16 a[118:119],v36 offset:6272
ds_read_b64_tr_b16 a[120:121],v36 offset:12288
ds_read_b64_tr_b16 a[122:123],v36 offset:12416
ds_read_b64_tr_b16 a[124:125],v36 offset:14336
ds_read_b64_tr_b16 a[126:127],v36 offset:14464
s_waitcnt lgkmcnt(0)
v_mov_b32 v38,9
ds_write_b32 v37,v38 offset:0
qs_121:
ds_read_b32 v39,v37 offset:4
s_sub_u32 s90,s90,1
s_waitcnt lgkmcnt(0)
v_cmp_gt_u32 vcc,v38,v39
s_cmp_lt_i32 s90,0
s_cselect_b64 vcc,0,vcc
s_cbranch_vccnz qs_121
ds_write_b128 v33,a[128:131] offset:0
ds_write_b128 v33,a[132:135] offset:1024
ds_write_b128 v33,a[136:139] offset:2048
ds_write_b128 v33,a[140:143] offset:3072
s_waitcnt lgkmcnt(0)
ds_read_b64_tr_b16 a[128:129],v34 offset:0
ds_read_b64_tr_b16 a[130:131],v34 offset:128
ds_read_b64_tr_b16 a[132:133],v34 offset:2048
ds_read_b64_tr_b16 a[134:135],v34 offset:2176
ds_read_b64_tr_b16 a[136:137],v34 offset:32
ds_read_b64_tr_b16 a[138:139],v34 offset:160
ds_read_b64_tr_b16 a[140:141],v34 offset:2080
ds_read_b64_tr_b16 a[142:143],v34 offset:2208
ds_write_b128 v33,a[144:147] offset:4096
ds_write_b128 v33,a[148:151] offset:5120
ds_write_b128 v33,a[152:155] offset:6144
ds_write_b128 v33,a[156:159] offset:7168
s_waitcnt lgkmcnt(0)
ds_read_b64_tr_b16 a[144:145],v34 offset:4096
ds_read_b64_tr_b16 a[146:147],v34 offset:4224
ds_read_b64_tr_b16 a[148:149],v34 offset:6144
ds_read_b64_tr_b16 a[150:151],v34 offset:6272
ds_read_b64_tr_b16 a[152:153],v34 offset:4128
ds_read_b64_tr_b16 a[154:155],v34 offset:4256
ds_read_b64_tr_b16 a[156:157],v34 offset:6176
ds_read_b64_tr_b16 a[158:159],v34 offset:6304
ds_write_b128 v33,a[160:163] offset:0
ds_write_b128 v33,a[164:167] offset:1024
ds_write_b128 v33,a[168:171] offset:2048
ds_write_b128 v33,a[172:175] offset:3072
s_waitcnt lgkmcnt(0)
ds_read_b64_tr_b16 a[160:161],v34 offset:0
ds_read_b64_tr_b16 a[162:163],v34 offset:128
ds_read_b64_tr_b16 a[164:165],v34 offset:2048
ds_read_b64_tr_b16 a[166:167],v34 offset:2176
ds_read_b64_tr_b16 a[168:169],v34 offset:32
ds_read_b64_tr_b16 a[170:171],v34 offset:160
ds_read_b64_tr_b16 a[172:173],v34 offset:2080
ds_read_b64_tr_b16 a[174:175],v34 offset:2208
free_122:
ds_read_b64 v[38:39],v37 offset:8
s_sub_u32 s90,s90,1
s_waitcnt lgkmcnt(0)
v_and_b32 v38,v38,v39
v_cmp_eq_u32 vcc,0,v38
s_cmp_lt_i32 s90,0
s_cselect_b64 vcc,0,vcc
s_cbranch_vccnz free_122
s_xor_b32 s64,s61,4194304
buffer_store_dwordx4 v[100:103],v206,s[20:23],s64 offen sc1
buffer_store_dwordx4 v[100:103],v207,s[20:23],s64 offen sc1
s_xor_b32 s64,s61,6299648
buffer_store_dwordx4 v[100:103],v206,s[20:23],s64 offen sc1
buffer_store_dwordx4 v[100:103],v207,s[20:23],s64 offen sc1
s_xor_b32 s64,s61,8388608
buffer_store_dwordx4 v[100:103],v206,s[20:23],s64 offen sc1
buffer_store_dwordx4 v[100:103],v207,s[20:23],s64 offen sc1
s_mov_b32 m0,0
s_mov_b32 s65,188416
buffer_load_dwordx4 v16,s[20:23],s65 offen offset:0 lds
buffer_load_dwordx4 v16,s[20:23],s65 offen offset:1024 lds
buffer_load_dwordx4 v16,s[20:23],s65 offen offset:2048 lds
buffer_load_dwordx4 v16,s[20:23],s65 offen offset:3072 lds
s_mov_b32 m0,4096
s_mov_b32 s65,192512
buffer_load_dwordx4 v16,s[20:23],s65 offen offset:0 lds
buffer_load_dwordx4 v16,s[20:23],s65 offen offset:1024 lds
buffer_load_dwordx4 v16,s[20:23],s65 offen offset:2048 lds
buffer_load_dwordx4 v16,s[20:23],s65 offen offset:3072 lds
s_mov_b32 m0,8192
s_mov_b32 s65,196608
buffer_load_dwordx4 v16,s[20:23],s65 offen offset:0 lds
buffer_load_dwordx4 v16,s[20:23],s65 offen offset:1024 lds
buffer_load_dwordx4 v16,s[20:23],s65 offen offset:2048 lds
buffer_load_dwordx4 v16,s[20:23],s65 offen offset:3072 lds
s_mov_b32 m0,12288
s_mov_b32 s65,200704
buffer_load_dwordx4 v16,s[20:23],s65 offen offset:0 lds
buffer_load_dwordx4 v16,s[20:23],s65 offen offset:1024 lds
buffer_load_dwordx4 v16,s[20:23],s65 offen offset:2048 lds
buffer_load_dwordx4 v16,s[20:23],s65 offen offset:3072 lds
s_mov_b32 m0,16384
s_mov_b32 s65,204800
buffer_load_dwordx4 v16,s[20:23],s65 offen offset:0 lds
buffer_load_dwordx4 v16,s[20:23],s65 offen offset:1024 lds
buffer_load_dwordx4 v16,s[20:23],s65 offen offset:2048 lds
buffer_load_dwordx4 v16,s[20:23],s65 offen offset:3072 lds
s_mov_b32 m0,20480
s_mov_b32 s65,208896
buffer_load_dwordx4 v16,s[20:23],s65 offen offset:0 lds
buffer_load_dwordx4 v16,s[20:23],s65 offen offset:1024 lds
buffer_load_dwordx4 v16,s[20:23],s65 offen offset:2048 lds
buffer_load_dwordx4 v16,s[20:23],s65 offen offset:3072 lds
s_mov_b32 m0,24576
s_mov_b32 s65,212992
buffer_load_dwordx4 v16,s[20:23],s65 offen offset:0 lds
buffer_load_dwordx4 v16,s[20:23],s65 offen offset:1024 lds
buffer_load_dwordx4 v16,s[20:23],s65 offen offset:2048 lds
buffer_load_dwordx4 v16,s[20:23],s65 offen offset:3072 lds
s_mov_b32 m0,28672
s_mov_b32 s65,217088
buffer_load_dwordx4 v16,s[20:23],s65 offen offset:0 lds
buffer_load_dwordx4 v16,s[20:23],s65 offen offset:1024 lds
buffer_load_dwordx4 v16,s[20:23],s65 offen offset:2048 lds
buffer_load_dwordx4 v16,s[20:23],s65 offen offset:3072 lds
s_waitcnt vmcnt(54)
ds_write_b128 v33,a[176:179] offset:4096
ds_write_b128 v33,a[180:183] offset:5120
ds_write_b128 v33,a[184:187] offset:6144
ds_write_b128 v33,a[188:191] offset:7168
s_waitcnt lgkmcnt(0)
ds_read_b64_tr_b16 a[176:177],v34 offset:4096
ds_read_b64_tr_b16 a[178:179],v34 offset:4224
ds_read_b64_tr_b16 a[180:181],v34 offset:6144
ds_read_b64_tr_b16 a[182:183],v34 offset:6272
ds_read_b64_tr_b16 a[184:185],v34 offset:4128
ds_read_b64_tr_b16 a[186:187],v34 offset:4256
ds_read_b64_tr_b16 a[188:189],v34 offset:6176
ds_read_b64_tr_b16 a[190:191],v34 offset:6304
s_waitcnt vmcnt(50)
ds_write_b128 v33,a[192:195] offset:0
ds_write_b128 v33,a[196:199] offset:1024
ds_write_b128 v33,a[200:203] offset:2048
ds_write_b128 v33,a[204:207] offset:3072
s_waitcnt lgkmcnt(0)
ds_read_b64_tr_b16 a[192:193],v34 offset:0
ds_read_b64_tr_b16 a[194:195],v34 offset:128
ds_read_b64_tr_b16 a[196:197],v34 offset:2048
ds_read_b64_tr_b16 a[198:199],v34 offset:2176
ds_read_b64_tr_b16 a[200:201],v34 offset:32
ds_read_b64_tr_b16 a[202:203],v34 offset:160
ds_read_b64_tr_b16 a[204:205],v34 offset:2080
ds_read_b64_tr_b16 a[206:207],v34 offset:2208
s_waitcnt vmcnt(46)
ds_write_b128 v33,a[208:211] offset:4096
ds_write_b128 v33,a[212:215] offset:5120
ds_write_b128 v33,a[216:219] offset:6144
ds_write_b128 v33,a[220:223] offset:7168
s_waitcnt lgkmcnt(0)
ds_read_b64_tr_b16 a[208:209],v34 offset:4096
ds_read_b64_tr_b16 a[210:211],v34 offset:4224
ds_read_b64_tr_b16 a[212:213],v34 offset:6144
ds_read_b64_tr_b16 a[214:215],v34 offset:6272
ds_read_b64_tr_b16 a[216:217],v34 offset:4128
ds_read_b64_tr_b16 a[218:219],v34 offset:4256
ds_read_b64_tr_b16 a[220:221],v34 offset:6176
ds_read_b64_tr_b16 a[222:223],v34 offset:6304
s_waitcnt vmcnt(42)
ds_write_b128 v33,a[224:227] offset:0
ds_write_b128 v33,a[228:231] offset:1024
ds_write_b128 v33,a[232:235] offset:2048
ds_write_b128 v33,a[236:239] offset:3072
s_waitcnt lgkmcnt(0)
ds_read_b64_tr_b16 a[224:225],v34 offset:0
ds_read_b64_tr_b16 a[226:227],v34 offset:128
ds_read_b64_tr_b16 a[228:229],v34 offset:2048
ds_read_b64_tr_b16 a[230:231],v34 offset:2176
ds_read_b64_tr_b16 a[232:233],v34 offset:32
ds_read_b64_tr_b16 a[234:235],v34 offset:160
ds_read_b64_tr_b16 a[236:237],v34 offset:2080
ds_read_b64_tr_b16 a[238:239],v34 offset:2208
s_waitcnt vmcnt(38)
ds_write_b128 v33,a[240:243] offset:4096
ds_write_b128 v33,a[244:247] offset:5120
ds_write_b128 v33,a[248:251] offset:6144
ds_write_b128 v33,a[252:255] offset:7168
s_waitcnt lgkmcnt(0)
ds_read_b64_tr_b16 a[240:241],v34 offset:4096
ds_read_b64_tr_b16 a[242:243],v34 offset:4224
ds_read_b64_tr_b16 a[244:245],v34 offset:6144
ds_read_b64_tr_b16 a[246:247],v34 offset:6272
ds_read_b64_tr_b16 a[248:249],v34 offset:4128
ds_read_b64_tr_b16 a[250:251],v34 offset:4256
ds_read_b64_tr_b16 a[252:253],v34 offset:6176
ds_read_b64_tr_b16 a[254:255],v34 offset:6304
s_mov_b32 s79,0
s_add_u32 s63,s79,0
s_and_b32 s64,s63,3
s_lshl_b32 s70,s64,20
s_add_u32 s65,s63,2
s_and_b32 s65,s65,3
s_lshl_b32 s73,s65,20
s_add_u32 s55,s63,3
s_lshl_b32 s78,s55,16
s_add_u32 s78,s78,57344
s_cmp_lt_u32 s55,64
s_cselect_b32 s78,s78,0x7fff0000
s_add_u32 s71,s70,65536
s_add_u32 s60,s63,1
s_and_b32 s60,s60,3
s_lshl_b32 s72,s60,20
v_mov_b32 v184,0
v_mov_b32 v185,0
v_mov_b32 v186,0
v_mov_b32 v187,0
v_mov_b32 v188,0
v_mov_b32 v189,0
v_mov_b32 v190,0
v_mov_b32 v191,0
s_lshl_b32 s77,s63,21
s_lshl_b32 s55,s63,13
s_and_b32 s55,s55,0x2000
s_xor_b32 s55,s55,s61
s_add_u32 s77,s77,s55
v_mov_b32 v176,0
v_mov_b32 v177,0
v_mov_b32 v178,0
v_mov_b32 v179,0
v_mov_b32 v25,1
s_waitcnt vmcnt(0) lgkmcnt(0)
s_barrier
s_branch loop_63
w1_59:
s_lshr_b32 s64,s57,2
s_add_u32 s64,s64,64
s_lshl_b32 s64,s64,14
s_add_u32 s64,s64,s68
s_add_u32 s64,s64,29360128
v_add_u32 v12,s64,v16
v_and_b32 v22,1,v4
v_lshrrev_b32 v23,1,v4
v_lshl_add_u32 v22,v22,1,v23
v_lshlrev_b32 v22,2,v22
v_lshl_add_u32 v22,v3,4,v22
v_add_u32 v31,155648,v22
v_add_u32 v8,s66,v16
v_add_u32 v9,s67,v16
v_mov_b32 v10,1792
v_mov_b32 v11,0
s_branch first_123
loop_124:
s_barrier
buffer_load_dword v248,v18,s[20:23],s70 offen offset:0 sc1
s_nop 15
s_nop 5
hl_126:
buffer_load_dword v249,v18,s[20:23],s70 offen offset:0 sc1
s_waitcnt vmcnt(1)
v_cmp_eq_u32 vcc,v25,v248
s_bcnt1_i32_b32 s64,vcc_lo
s_cmp_ge_u32 s64,8
s_cbranch_scc1 hg_127
buffer_load_dword v248,v18,s[20:23],s70 offen offset:0 sc1
s_waitcnt vmcnt(1)
v_cmp_eq_u32 vcc,v25,v249
s_bcnt1_i32_b32 s64,vcc_lo
s_cmp_ge_u32 s64,8
s_cbranch_scc1 hg_127
s_sub_u32 s90,s90,1
s_cmp_gt_i32 s90,0
s_cbranch_scc1 hl_126
hg_127:
buffer_load_dwordx4 v[48:51],v27,s[20:23],s70 offen offset:0 sc1
buffer_load_dwordx4 v[52:55],v27,s[20:23],s70 offen offset:1024 sc1
buffer_load_dwordx4 v[56:59],v27,s[20:23],s70 offen offset:2048 sc1
buffer_load_dwordx4 v[60:63],v27,s[20:23],s70 offen offset:3072 sc1
s_waitcnt vmcnt(3)
ds_write_b128 v24,v[48:51] offset:4096
v_min3_u32 v22,v48,v49,v50
v_min_u32 v22,v22,v51
s_waitcnt vmcnt(2)
ds_write_b128 v24,v[52:55] offset:5120
v_min3_u32 v22,v22,v52,v53
v_min3_u32 v22,v22,v54,v55
s_waitcnt vmcnt(1)
ds_write_b128 v24,v[56:59] offset:6144
v_min3_u32 v22,v22,v56,v57
v_min3_u32 v22,v22,v58,v59
s_waitcnt vmcnt(0)
ds_write_b128 v24,v[60:63] offset:7168
v_min3_u32 v22,v22,v60,v61
v_min3_u32 v22,v22,v62,v63
v_cmp_eq_u32 vcc,0,v22
s_cbranch_vccnz art_128
abk_129:
v_smfmac_f32_16x16x64_bf16 v[176:179],v[48:51],a[32:39],v14
s_waitcnt lgkmcnt(0)
s_barrier
ds_read_b128 v[64:67],v24 offset:8192
ds_read_b128 v[68:71],v24 offset:9216
ds_read_b128 v[72:75],v24 offset:10240
ds_read_b128 v[76:79],v24 offset:11264
buffer_store_dwordx4 v[212:215],v12,s[20:23],s76 offen sc1
v_smfmac_f32_16x16x64_bf16 v[176:179],v[52:55],a[40:47],v14
ds_read_b128 v[80:83],v24 offset:12288
ds_read_b128 v[84:87],v24 offset:13312
v_smfmac_f32_16x16x64_bf16 v[176:179],v[56:59],a[48:55],v14
ds_read_b128 v[88:91],v24 offset:14336
ds_read_b128 v[92:95],v24 offset:15360
v_smfmac_f32_16x16x64_bf16 v[176:179],v[60:63],a[56:63],v14
ds_read_b128 v[32:35],v24 offset:0
ds_read_b128 v[36:39],v24 offset:1024
s_waitcnt lgkmcnt(9)
v_smfmac_f32_16x16x64_bf16 v[176:179],v[64:67],a[64:71],v14
ds_read_b128 v[40:43],v24 offset:2048
s_waitcnt lgkmcnt(9)
v_smfmac_f32_16x16x64_bf16 v[176:179],v[68:71],a[72:79],v14
ds_read_b128 v[44:47],v24 offset:3072
s_waitcnt lgkmcnt(9)
v_smfmac_f32_16x16x64_bf16 v[176:179],v[72:75],a[80:87],v14
s_waitcnt lgkmcnt(8)
v_smfmac_f32_16x16x64_bf16 v[176:179],v[76:79],a[88:95],v14
s_waitcnt lgkmcnt(7)
v_smfmac_f32_16x16x64_bf16 v[176:179],v[80:83],a[96:103],v14
s_waitcnt lgkmcnt(6)
v_smfmac_f32_16x16x64_bf16 v[176:179],v[84:87],a[104:111],v14
s_waitcnt lgkmcnt(5)
v_smfmac_f32_16x16x64_bf16 v[176:179],v[88:91],a[112:119],v14
s_waitcnt lgkmcnt(4)
v_smfmac_f32_16x16x64_bf16 v[176:179],v[92:95],a[120:127],v14
s_waitcnt lgkmcnt(3)
v_smfmac_f32_16x16x64_bf16 v[176:179],v[32:35],a[0:7],v14
s_waitcnt lgkmcnt(2)
v_smfmac_f32_16x16x64_bf16 v[176:179],v[36:39],a[8:15],v14
s_waitcnt lgkmcnt(1)
v_smfmac_f32_16x16x64_bf16 v[176:179],v[40:43],a[16:23],v14
s_waitcnt lgkmcnt(0)
v_smfmac_f32_16x16x64_bf16 v[176:179],v[44:47],a[24:31],v14
v_smfmac_f32_16x16x64_bf16 v[180:183],v[32:35],a[128:135],v14
v_smfmac_f32_16x16x64_bf16 v[180:183],v[36:39],a[136:143],v14
s_nop 5
v_permlane32_swap_b32 v176,v178
v_permlane32_swap_b32 v177,v179
v_add_f32 v176,v176,v178
v_add_f32 v177,v177,v179
v_cvt_pk_bf16_f32 v216,v176,v177
s_nop 1
v_mov_b32_dpp v217,v216 quad_perm:[1,0,3,2] row_mask:0xf bank_mask:0xf
v_perm_b32 v216,v217,v216,v15
v_max_u32 v216,1,v216
buffer_store_dword v216,v19,s[24:27],s70 offen
buffer_store_dword v216,v19,s[28:31],s70 offen sc1
v_smfmac_f32_16x16x64_bf16 v[180:183],v[40:43],a[144:151],v14
v_smfmac_f32_16x16x64_bf16 v[180:183],v[44:47],a[152:159],v14
v_smfmac_f32_16x16x64_bf16 v[180:183],v[48:51],a[160:167],v14
v_smfmac_f32_16x16x64_bf16 v[180:183],v[52:55],a[168:175],v14
v_smfmac_f32_16x16x64_bf16 v[180:183],v[56:59],a[176:183],v14
v_smfmac_f32_16x16x64_bf16 v[180:183],v[60:63],a[184:191],v14
v_smfmac_f32_16x16x64_bf16 v[180:183],v[64:67],a[192:199],v14
v_smfmac_f32_16x16x64_bf16 v[180:183],v[68:71],a[200:207],v14
v_smfmac_f32_16x16x64_bf16 v[180:183],v[72:75],a[208:215],v14
v_smfmac_f32_16x16x64_bf16 v[180:183],v[76:79],a[216:223],v14
v_smfmac_f32_16x16x64_bf16 v[180:183],v[80:83],a[224:231],v14
v_smfmac_f32_16x16x64_bf16 v[180:183],v[84:87],a[232:239],v14
v_smfmac_f32_16x16x64_bf16 v[180:183],v[88:91],a[240:247],v14
v_smfmac_f32_16x16x64_bf16 v[180:183],v[92:95],a[248:255],v14
s_nop 7
v_permlane32_swap_b32 v180,v182
v_permlane32_swap_b32 v181,v183
v_add_f32 v180,v180,v182
v_add_f32 v181,v181,v183
v_cvt_pk_bf16_f32 v216,v180,v181
v_max_u32 v216,1,v216
ds_write_b32 v31,v216
ds_write_b32 v21,v25 offset:0
s_cmp_eq_u32 s79,63
s_cbranch_scc1 end_57
s_cmp_ge_i32 s79,62
s_cbranch_scc1 bgsk_131
ds_read_b128 v[64:67],v20 offset:0
ds_read_b128 v[68:71],v20 offset:1024
ds_read_b128 v[72:75],v20 offset:2048
s_waitcnt lgkmcnt(2)
v_mfma_f32_16x16x32_bf16 v[192:195],a[0:3],v[64:67],0
ds_read_b128 v[76:79],v20 offset:3072
v_mfma_f32_16x16x32_bf16 v[200:203],v[64:67],a[128:131],0
s_waitcnt lgkmcnt(2)
v_mfma_f32_16x16x32_bf16 v[196:199],a[0:3],v[68:71],0
ds_read_b128 v[64:67],v20 offset:4096
v_mfma_f32_16x16x32_bf16 v[204:207],v[68:71],a[128:131],0
s_waitcnt lgkmcnt(2)
v_mfma_f32_16x16x32_bf16 v[192:195],a[4:7],v[72:75],v[192:195]
ds_read_b128 v[68:71],v20 offset:5120
v_mfma_f32_16x16x32_bf16 v[200:203],v[72:75],a[132:135],v[200:203]
s_waitcnt lgkmcnt(2)
v_mfma_f32_16x16x32_bf16 v[196:199],a[4:7],v[76:79],v[196:199]
ds_read_b128 v[72:75],v20 offset:6144
v_mfma_f32_16x16x32_bf16 v[204:207],v[76:79],a[132:135],v[204:207]
s_waitcnt lgkmcnt(2)
v_mfma_f32_16x16x32_bf16 v[192:195],a[8:11],v[64:67],v[192:195]
ds_read_b128 v[76:79],v20 offset:7168
v_mfma_f32_16x16x32_bf16 v[200:203],v[64:67],a[136:139],v[200:203]
s_waitcnt lgkmcnt(2)
v_mfma_f32_16x16x32_bf16 v[196:199],a[8:11],v[68:71],v[196:199]
ds_read_b128 v[64:67],v20 offset:8192
v_mfma_f32_16x16x32_bf16 v[204:207],v[68:71],a[136:139],v[204:207]
s_waitcnt lgkmcnt(2)
v_mfma_f32_16x16x32_bf16 v[192:195],a[12:15],v[72:75],v[192:195]
ds_read_b128 v[68:71],v20 offset:9216
v_mfma_f32_16x16x32_bf16 v[200:203],v[72:75],a[140:143],v[200:203]
s_waitcnt lgkmcnt(2)
v_mfma_f32_16x16x32_bf16 v[196:199],a[12:15],v[76:79],v[196:199]
ds_read_b128 v[72:75],v20 offset:10240
v_mfma_f32_16x16x32_bf16 v[204:207],v[76:79],a[140:143],v[204:207]
s_add_u32 m0,s62,0
s_add_u32 s69,s78,0
s_waitcnt lgkmcnt(2)
v_mfma_f32_16x16x32_bf16 v[192:195],a[16:19],v[64:67],v[192:195]
ds_read_b128 v[76:79],v20 offset:11264
v_mfma_f32_16x16x32_bf16 v[200:203],v[64:67],a[144:147],v[200:203]
buffer_load_dwordx4 v16,s[20:23],s69 offen offset:0 lds
s_waitcnt lgkmcnt(2)
v_mfma_f32_16x16x32_bf16 v[196:199],a[16:19],v[68:71],v[196:199]
ds_read_b128 v[64:67],v20 offset:12288
v_mfma_f32_16x16x32_bf16 v[204:207],v[68:71],a[144:147],v[204:207]
buffer_load_dwordx4 v16,s[20:23],s69 offen offset:1024 lds
s_waitcnt lgkmcnt(2)
v_mfma_f32_16x16x32_bf16 v[192:195],a[20:23],v[72:75],v[192:195]
ds_read_b128 v[68:71],v20 offset:13312
v_mfma_f32_16x16x32_bf16 v[200:203],v[72:75],a[148:151],v[200:203]
buffer_load_dwordx4 v16,s[20:23],s69 offen offset:2048 lds
s_waitcnt lgkmcnt(2)
v_mfma_f32_16x16x32_bf16 v[196:199],a[20:23],v[76:79],v[196:199]
ds_read_b128 v[72:75],v20 offset:14336
v_mfma_f32_16x16x32_bf16 v[204:207],v[76:79],a[148:151],v[204:207]
buffer_load_dwordx4 v16,s[20:23],s69 offen offset:3072 lds
s_waitcnt lgkmcnt(2)
v_mfma_f32_16x16x32_bf16 v[192:195],a[24:27],v[64:67],v[192:195]
ds_read_b128 v[76:79],v20 offset:15360
v_mfma_f32_16x16x32_bf16 v[200:203],v[64:67],a[152:155],v[200:203]
s_add_u32 m0,s62,4096
s_add_u32 s69,s78,4096
s_waitcnt lgkmcnt(2)
v_mfma_f32_16x16x32_bf16 v[196:199],a[24:27],v[68:71],v[196:199]
ds_read_b128 v[64:67],v20 offset:16384
v_mfma_f32_16x16x32_bf16 v[204:207],v[68:71],a[152:155],v[204:207]
buffer_load_dwordx4 v16,s[20:23],s69 offen offset:0 lds
s_waitcnt lgkmcnt(2)
v_mfma_f32_16x16x32_bf16 v[192:195],a[28:31],v[72:75],v[192:195]
ds_read_b128 v[68:71],v20 offset:17408
v_mfma_f32_16x16x32_bf16 v[200:203],v[72:75],a[156:159],v[200:203]
buffer_load_dwordx4 v16,s[20:23],s69 offen offset:1024 lds
s_waitcnt lgkmcnt(2)
v_mfma_f32_16x16x32_bf16 v[196:199],a[28:31],v[76:79],v[196:199]
ds_read_b128 v[72:75],v20 offset:18432
v_mfma_f32_16x16x32_bf16 v[204:207],v[76:79],a[156:159],v[204:207]
buffer_load_dwordx4 v16,s[20:23],s69 offen offset:2048 lds
s_waitcnt lgkmcnt(2)
v_mfma_f32_16x16x32_bf16 v[192:195],a[32:35],v[64:67],v[192:195]
ds_read_b128 v[76:79],v20 offset:19456
v_mfma_f32_16x16x32_bf16 v[200:203],v[64:67],a[160:163],v[200:203]
buffer_load_dwordx4 v16,s[20:23],s69 offen offset:3072 lds
s_waitcnt lgkmcnt(2)
v_mfma_f32_16x16x32_bf16 v[196:199],a[32:35],v[68:71],v[196:199]
ds_read_b128 v[64:67],v20 offset:20480
v_mfma_f32_16x16x32_bf16 v[204:207],v[68:71],a[160:163],v[204:207]
s_add_u32 m0,s62,8192
s_add_u32 s69,s78,8192
s_waitcnt lgkmcnt(2)
v_mfma_f32_16x16x32_bf16 v[192:195],a[36:39],v[72:75],v[192:195]
ds_read_b128 v[68:71],v20 offset:21504
v_mfma_f32_16x16x32_bf16 v[200:203],v[72:75],a[164:167],v[200:203]
buffer_load_dwordx4 v16,s[20:23],s69 offen offset:0 lds
s_waitcnt lgkmcnt(2)
v_mfma_f32_16x16x32_bf16 v[196:199],a[36:39],v[76:79],v[196:199]
ds_read_b128 v[72:75],v20 offset:22528
v_mfma_f32_16x16x32_bf16 v[204:207],v[76:79],a[164:167],v[204:207]
buffer_load_dwordx4 v16,s[20:23],s69 offen offset:1024 lds
s_waitcnt lgkmcnt(2)
v_mfma_f32_16x16x32_bf16 v[192:195],a[40:43],v[64:67],v[192:195]
ds_read_b128 v[76:79],v20 offset:23552
v_mfma_f32_16x16x32_bf16 v[200:203],v[64:67],a[168:171],v[200:203]
buffer_load_dwordx4 v16,s[20:23],s69 offen offset:2048 lds
s_waitcnt lgkmcnt(2)
v_mfma_f32_16x16x32_bf16 v[196:199],a[40:43],v[68:71],v[196:199]
ds_read_b128 v[64:67],v20 offset:24576
v_mfma_f32_16x16x32_bf16 v[204:207],v[68:71],a[168:171],v[204:207]
buffer_load_dwordx4 v16,s[20:23],s69 offen offset:3072 lds
s_waitcnt lgkmcnt(2)
v_mfma_f32_16x16x32_bf16 v[192:195],a[44:47],v[72:75],v[192:195]
ds_read_b128 v[68:71],v20 offset:25600
v_mfma_f32_16x16x32_bf16 v[200:203],v[72:75],a[172:175],v[200:203]
s_add_u32 m0,s62,12288
s_add_u32 s69,s78,12288
s_waitcnt lgkmcnt(2)
v_mfma_f32_16x16x32_bf16 v[196:199],a[44:47],v[76:79],v[196:199]
ds_read_b128 v[72:75],v20 offset:26624
v_mfma_f32_16x16x32_bf16 v[204:207],v[76:79],a[172:175],v[204:207]
buffer_load_dwordx4 v16,s[20:23],s69 offen offset:0 lds
s_waitcnt lgkmcnt(2)
v_mfma_f32_16x16x32_bf16 v[192:195],a[48:51],v[64:67],v[192:195]
ds_read_b128 v[76:79],v20 offset:27648
v_mfma_f32_16x16x32_bf16 v[200:203],v[64:67],a[176:179],v[200:203]
buffer_load_dwordx4 v16,s[20:23],s69 offen offset:1024 lds
s_waitcnt lgkmcnt(2)
v_mfma_f32_16x16x32_bf16 v[196:199],a[48:51],v[68:71],v[196:199]
ds_read_b128 v[64:67],v20 offset:28672
v_mfma_f32_16x16x32_bf16 v[204:207],v[68:71],a[176:179],v[204:207]
buffer_load_dwordx4 v16,s[20:23],s69 offen offset:2048 lds
s_waitcnt lgkmcnt(2)
v_mfma_f32_16x16x32_bf16 v[192:195],a[52:55],v[72:75],v[192:195]
ds_read_b128 v[68:71],v20 offset:29696
v_mfma_f32_16x16x32_bf16 v[200:203],v[72:75],a[180:183],v[200:203]
buffer_load_dwordx4 v16,s[20:23],s69 offen offset:3072 lds
s_waitcnt lgkmcnt(2)
v_mfma_f32_16x16x32_bf16 v[196:199],a[52:55],v[76:79],v[196:199]
ds_read_b128 v[72:75],v20 offset:30720
v_mfma_f32_16x16x32_bf16 v[204:207],v[76:79],a[180:183],v[204:207]
s_waitcnt lgkmcnt(2)
v_mfma_f32_16x16x32_bf16 v[192:195],a[56:59],v[64:67],v[192:195]
ds_read_b128 v[76:79],v20 offset:31744
v_mfma_f32_16x16x32_bf16 v[200:203],v[64:67],a[184:187],v[200:203]
s_waitcnt lgkmcnt(2)
v_mfma_f32_16x16x32_bf16 v[196:199],a[56:59],v[68:71],v[196:199]
ds_read_b128 v[64:67],v20 offset:32768
v_mfma_f32_16x16x32_bf16 v[204:207],v[68:71],a[184:187],v[204:207]
s_waitcnt lgkmcnt(2)
v_mfma_f32_16x16x32_bf16 v[192:195],a[60:63],v[72:75],v[192:195]
ds_read_b128 v[68:71],v20 offset:33792
v_mfma_f32_16x16x32_bf16 v[200:203],v[72:75],a[188:191],v[200:203]
s_waitcnt lgkmcnt(2)
v_mfma_f32_16x16x32_bf16 v[196:199],a[60:63],v[76:79],v[196:199]
ds_read_b128 v[72:75],v20 offset:34816
v_mfma_f32_16x16x32_bf16 v[204:207],v[76:79],a[188:191],v[204:207]
s_waitcnt lgkmcnt(2)
v_mfma_f32_16x16x32_bf16 v[192:195],a[64:67],v[64:67],v[192:195]
ds_read_b128 v[76:79],v20 offset:35840
v_mfma_f32_16x16x32_bf16 v[200:203],v[64:67],a[192:195],v[200:203]
s_waitcnt lgkmcnt(2)
v_mfma_f32_16x16x32_bf16 v[196:199],a[64:67],v[68:71],v[196:199]
ds_read_b128 v[64:67],v20 offset:36864
v_mfma_f32_16x16x32_bf16 v[204:207],v[68:71],a[192:195],v[204:207]
s_waitcnt lgkmcnt(2)
v_mfma_f32_16x16x32_bf16 v[192:195],a[68:71],v[72:75],v[192:195]
ds_read_b128 v[68:71],v20 offset:37888
v_mfma_f32_16x16x32_bf16 v[200:203],v[72:75],a[196:199],v[200:203]
s_waitcnt lgkmcnt(2)
v_mfma_f32_16x16x32_bf16 v[196:199],a[68:71],v[76:79],v[196:199]
ds_read_b128 v[72:75],v20 offset:38912
v_mfma_f32_16x16x32_bf16 v[204:207],v[76:79],a[196:199],v[204:207]
s_waitcnt lgkmcnt(2)
v_mfma_f32_16x16x32_bf16 v[192:195],a[72:75],v[64:67],v[192:195]
ds_read_b128 v[76:79],v20 offset:39936
v_mfma_f32_16x16x32_bf16 v[200:203],v[64:67],a[200:203],v[200:203]
s_waitcnt lgkmcnt(2)
v_mfma_f32_16x16x32_bf16 v[196:199],a[72:75],v[68:71],v[196:199]
ds_read_b128 v[64:67],v20 offset:40960
v_mfma_f32_16x16x32_bf16 v[204:207],v[68:71],a[200:203],v[204:207]
s_waitcnt lgkmcnt(2)
v_mfma_f32_16x16x32_bf16 v[192:195],a[76:79],v[72:75],v[192:195]
ds_read_b128 v[68:71],v20 offset:41984
v_mfma_f32_16x16x32_bf16 v[200:203],v[72:75],a[204:207],v[200:203]
s_waitcnt lgkmcnt(2)
v_mfma_f32_16x16x32_bf16 v[196:199],a[76:79],v[76:79],v[196:199]
ds_read_b128 v[72:75],v20 offset:43008
v_mfma_f32_16x16x32_bf16 v[204:207],v[76:79],a[204:207],v[204:207]
s_waitcnt lgkmcnt(2)
v_mfma_f32_16x16x32_bf16 v[192:195],a[80:83],v[64:67],v[192:195]
ds_read_b128 v[76:79],v20 offset:44032
v_mfma_f32_16x16x32_bf16 v[200:203],v[64:67],a[208:211],v[200:203]
s_waitcnt lgkmcnt(2)
v_mfma_f32_16x16x32_bf16 v[196:199],a[80:83],v[68:71],v[196:199]
ds_read_b128 v[64:67],v20 offset:45056
v_mfma_f32_16x16x32_bf16 v[204:207],v[68:71],a[208:211],v[204:207]
s_waitcnt lgkmcnt(2)
v_mfma_f32_16x16x32_bf16 v[192:195],a[84:87],v[72:75],v[192:195]
ds_read_b128 v[68:71],v20 offset:46080
v_mfma_f32_16x16x32_bf16 v[200:203],v[72:75],a[212:215],v[200:203]
s_waitcnt lgkmcnt(2)
v_mfma_f32_16x16x32_bf16 v[196:199],a[84:87],v[76:79],v[196:199]
ds_read_b128 v[72:75],v20 offset:47104
v_mfma_f32_16x16x32_bf16 v[204:207],v[76:79],a[212:215],v[204:207]
s_waitcnt lgkmcnt(2)
v_mfma_f32_16x16x32_bf16 v[192:195],a[88:91],v[64:67],v[192:195]
ds_read_b128 v[76:79],v20 offset:48128
v_mfma_f32_16x16x32_bf16 v[200:203],v[64:67],a[216:219],v[200:203]
s_waitcnt lgkmcnt(2)
v_mfma_f32_16x16x32_bf16 v[196:199],a[88:91],v[68:71],v[196:199]
ds_read_b128 v[64:67],v20 offset:49152
v_mfma_f32_16x16x32_bf16 v[204:207],v[68:71],a[216:219],v[204:207]
s_waitcnt lgkmcnt(2)
v_mfma_f32_16x16x32_bf16 v[192:195],a[92:95],v[72:75],v[192:195]
ds_read_b128 v[68:71],v20 offset:50176
v_mfma_f32_16x16x32_bf16 v[200:203],v[72:75],a[220:223],v[200:203]
s_waitcnt lgkmcnt(2)
v_mfma_f32_16x16x32_bf16 v[196:199],a[92:95],v[76:79],v[196:199]
ds_read_b128 v[72:75],v20 offset:51200
v_mfma_f32_16x16x32_bf16 v[204:207],v[76:79],a[220:223],v[204:207]
s_waitcnt lgkmcnt(2)
v_mfma_f32_16x16x32_bf16 v[192:195],a[96:99],v[64:67],v[192:195]
ds_read_b128 v[76:79],v20 offset:52224
v_mfma_f32_16x16x32_bf16 v[200:203],v[64:67],a[224:227],v[200:203]
s_waitcnt lgkmcnt(2)
v_mfma_f32_16x16x32_bf16 v[196:199],a[96:99],v[68:71],v[196:199]
ds_read_b128 v[64:67],v20 offset:53248
v_mfma_f32_16x16x32_bf16 v[204:207],v[68:71],a[224:227],v[204:207]
s_waitcnt lgkmcnt(2)
v_mfma_f32_16x16x32_bf16 v[192:195],a[100:103],v[72:75],v[192:195]
ds_read_b128 v[68:71],v20 offset:54272
s_add_u32 m0,s62,32768
s_add_u32 s69,s78,32768
v_mfma_f32_16x16x32_bf16 v[200:203],v[72:75],a[228:231],v[200:203]
s_waitcnt lgkmcnt(2)
v_mfma_f32_16x16x32_bf16 v[196:199],a[100:103],v[76:79],v[196:199]
ds_read_b128 v[72:75],v20 offset:55296
buffer_load_dwordx4 v16,s[20:23],s69 offen offset:0 lds
v_mfma_f32_16x16x32_bf16 v[204:207],v[76:79],a[228:231],v[204:207]
s_waitcnt lgkmcnt(2)
v_mfma_f32_16x16x32_bf16 v[192:195],a[104:107],v[64:67],v[192:195]
ds_read_b128 v[76:79],v20 offset:56320
buffer_load_dwordx4 v16,s[20:23],s69 offen offset:1024 lds
v_mfma_f32_16x16x32_bf16 v[200:203],v[64:67],a[232:235],v[200:203]
s_waitcnt lgkmcnt(2)
v_mfma_f32_16x16x32_bf16 v[196:199],a[104:107],v[68:71],v[196:199]
ds_read_b128 v[64:67],v20 offset:57344
buffer_load_dwordx4 v16,s[20:23],s69 offen offset:2048 lds
v_mfma_f32_16x16x32_bf16 v[204:207],v[68:71],a[232:235],v[204:207]
s_waitcnt lgkmcnt(2)
v_mfma_f32_16x16x32_bf16 v[192:195],a[108:111],v[72:75],v[192:195]
ds_read_b128 v[68:71],v20 offset:58368
buffer_load_dwordx4 v16,s[20:23],s69 offen offset:3072 lds
v_mfma_f32_16x16x32_bf16 v[200:203],v[72:75],a[236:239],v[200:203]
s_waitcnt lgkmcnt(2)
v_mfma_f32_16x16x32_bf16 v[196:199],a[108:111],v[76:79],v[196:199]
ds_read_b128 v[72:75],v20 offset:59392
s_add_u32 m0,s62,36864
s_add_u32 s69,s78,36864
v_mfma_f32_16x16x32_bf16 v[204:207],v[76:79],a[236:239],v[204:207]
s_waitcnt lgkmcnt(2)
v_mfma_f32_16x16x32_bf16 v[192:195],a[112:115],v[64:67],v[192:195]
ds_read_b128 v[76:79],v20 offset:60416
buffer_load_dwordx4 v16,s[20:23],s69 offen offset:0 lds
v_mfma_f32_16x16x32_bf16 v[200:203],v[64:67],a[240:243],v[200:203]
s_waitcnt lgkmcnt(2)
v_mfma_f32_16x16x32_bf16 v[196:199],a[112:115],v[68:71],v[196:199]
ds_read_b128 v[64:67],v20 offset:61440
v_mfma_f32_16x16x32_bf16 v[204:207],v[68:71],a[240:243],v[204:207]
buffer_load_dwordx4 v16,s[20:23],s69 offen offset:1024 lds
s_waitcnt lgkmcnt(2)
v_mfma_f32_16x16x32_bf16 v[192:195],a[116:119],v[72:75],v[192:195]
ds_read_b128 v[68:71],v20 offset:62464
v_mfma_f32_16x16x32_bf16 v[200:203],v[72:75],a[244:247],v[200:203]
buffer_load_dwordx4 v16,s[20:23],s69 offen offset:2048 lds
s_waitcnt lgkmcnt(2)
v_mfma_f32_16x16x32_bf16 v[196:199],a[116:119],v[76:79],v[196:199]
ds_read_b128 v[72:75],v20 offset:63488
v_mfma_f32_16x16x32_bf16 v[204:207],v[76:79],a[244:247],v[204:207]
buffer_load_dwordx4 v16,s[20:23],s69 offen offset:3072 lds
s_waitcnt lgkmcnt(2)
v_mfma_f32_16x16x32_bf16 v[192:195],a[120:123],v[64:67],v[192:195]
ds_read_b128 v[76:79],v20 offset:64512
v_mfma_f32_16x16x32_bf16 v[200:203],v[64:67],a[248:251],v[200:203]
s_add_u32 m0,s62,40960
s_add_u32 s69,s78,40960
s_waitcnt lgkmcnt(2)
v_mfma_f32_16x16x32_bf16 v[196:199],a[120:123],v[68:71],v[196:199]
v_mfma_f32_16x16x32_bf16 v[204:207],v[68:71],a[248:251],v[204:207]
buffer_load_dwordx4 v16,s[20:23],s69 offen offset:0 lds
s_waitcnt lgkmcnt(1)
v_mfma_f32_16x16x32_bf16 v[192:195],a[124:127],v[72:75],v[192:195]
v_mfma_f32_16x16x32_bf16 v[200:203],v[72:75],a[252:255],v[200:203]
buffer_load_dwordx4 v16,s[20:23],s69 offen offset:1024 lds
s_waitcnt lgkmcnt(0)
v_mfma_f32_16x16x32_bf16 v[196:199],a[124:127],v[76:79],v[196:199]
v_mfma_f32_16x16x32_bf16 v[204:207],v[76:79],a[252:255],v[204:207]
s_waitcnt vmcnt(26)
ds_write_b32 v21,v25 offset:24
v_xor_b32 v20,0x10000,v20
s_xor_b32 s62,s62,0x10000
s_lshr_b32 s64,s73,9
v_add_u32 v22,s64,v24
v_cvt_pk_bf16_f32 v208,v192,v193
v_cvt_pk_bf16_f32 v209,v194,v195
v_cvt_pk_bf16_f32 v210,v196,v197
v_cvt_pk_bf16_f32 v211,v198,v199
v_cvt_pk_bf16_f32 v212,v200,v201
v_cvt_pk_bf16_f32 v213,v202,v203
v_cvt_pk_bf16_f32 v214,v204,v205
v_cvt_pk_bf16_f32 v215,v206,v207
v_permlane16_swap_b32 v208,v210
v_permlane16_swap_b32 v209,v211
buffer_store_dwordx4 v[208:211],v2,s[24:27],s73 offen
buffer_store_dwordx4 v[208:211],v2,s[28:31],s73 offen sc1
ds_write_b128 v22,v[212:215] offset:16384
buffer_store_dwordx4 v[208:211],v17,s[20:23],s12 offen sc1
bgx_130:
buffer_store_dwordx4 v[100:103],v9,s[24:27],s73 offen
buffer_store_dwordx4 v[100:103],v9,s[28:31],s73 offen sc1
s_mov_b32 exec_hi,0
buffer_store_dwordx4 v[100:103],v8,s[24:27],s73 offen
buffer_store_dwordx4 v[100:103],v8,s[24:27],s71 offen
buffer_store_dwordx4 v[100:103],v8,s[28:31],s73 offen sc1
buffer_store_dwordx4 v[100:103],v8,s[28:31],s71 offen sc1
s_mov_b64 exec,-1
s_waitcnt lgkmcnt(0)
s_add_u32 s63,s79,1
s_and_b32 s64,s63,3
s_lshl_b32 s70,s64,20
s_add_u32 s65,s63,2
s_and_b32 s65,s65,3
s_lshl_b32 s73,s65,20
s_add_u32 s55,s63,3
s_lshl_b32 s78,s55,16
s_add_u32 s78,s78,57344
s_cmp_lt_u32 s55,64
s_cselect_b32 s78,s78,0x7fff0000
s_add_u32 s60,s63,1
s_lshl_b32 s76,s60,21
s_lshl_b32 s55,s60,13
s_and_b32 s55,s55,0x2000
s_xor_b32 s55,s55,s61
s_add_u32 s76,s76,s55
s_cmp_lt_u32 s60,64
s_cselect_b32 s76,s76,0x7fff0000
s_add_u32 s60,s63,2
s_lshl_b32 s12,s60,21
s_lshl_b32 s55,s60,13
s_and_b32 s55,s55,0x2000
s_xor_b32 s55,s55,s61
s_add_u32 s12,s12,s55
s_cmp_lt_u32 s60,64
s_cselect_b32 s12,s12,0x7fff0000
s_add_u32 s71,s73,65536
v_mov_b32 v176,0
v_mov_b32 v177,0
v_mov_b32 v178,0
v_mov_b32 v179,0
v_mov_b32 v180,0
v_mov_b32 v181,0
v_mov_b32 v182,0
v_mov_b32 v183,0
s_add_u32 s79,s79,1
v_add_u32 v25,1,v25
s_waitcnt vmcnt(0)
s_branch loop_124
art_128:
s_sub_u32 s90,s90,1
s_cmp_lt_i32 s90,0
s_cbranch_scc1 abk_129
buffer_load_dwordx4 v[48:51],v27,s[20:23],s70 offen offset:0 sc1
buffer_load_dwordx4 v[52:55],v27,s[20:23],s70 offen offset:1024 sc1
buffer_load_dwordx4 v[56:59],v27,s[20:23],s70 offen offset:2048 sc1
buffer_load_dwordx4 v[60:63],v27,s[20:23],s70 offen offset:3072 sc1
s_waitcnt vmcnt(3)
ds_write_b128 v24,v[48:51] offset:4096
v_min3_u32 v22,v48,v49,v50
v_min_u32 v22,v22,v51
s_waitcnt vmcnt(2)
ds_write_b128 v24,v[52:55] offset:5120
v_min3_u32 v22,v22,v52,v53
v_min3_u32 v22,v22,v54,v55
s_waitcnt vmcnt(1)
ds_write_b128 v24,v[56:59] offset:6144
v_min3_u32 v22,v22,v56,v57
v_min3_u32 v22,v22,v58,v59
s_waitcnt vmcnt(0)
ds_write_b128 v24,v[60:63] offset:7168
v_min3_u32 v22,v22,v60,v61
v_min3_u32 v22,v22,v62,v63
v_cmp_eq_u32 vcc,0,v22
s_cbranch_vccnz art_128
s_branch abk_129
bgsk_131:
s_waitcnt vmcnt(0)
ds_write_b32 v21,v25 offset:24
s_branch bgx_130
first_123:
s_add_u32 s63,s79,0
s_and_b32 s64,s63,3
s_lshl_b32 s70,s64,20
s_add_u32 s65,s63,2
s_and_b32 s65,s65,3
s_lshl_b32 s73,s65,20
s_add_u32 s55,s63,3
s_lshl_b32 s78,s55,16
s_add_u32 s78,s78,57344
s_cmp_lt_u32 s55,64
s_cselect_b32 s78,s78,0x7fff0000
s_add_u32 s60,s63,1
s_lshl_b32 s76,s60,21
s_lshl_b32 s55,s60,13
s_and_b32 s55,s55,0x2000
s_xor_b32 s55,s55,s61
s_add_u32 s76,s76,s55
s_cmp_lt_u32 s60,64
s_cselect_b32 s76,s76,0x7fff0000
s_add_u32 s60,s63,2
s_lshl_b32 s12,s60,21
s_lshl_b32 s55,s60,13
s_and_b32 s55,s55,0x2000
s_xor_b32 s55,s55,s61
s_add_u32 s12,s12,s55
s_cmp_lt_u32 s60,64
s_cselect_b32 s12,s12,0x7fff0000
s_add_u32 s71,s73,65536
v_mov_b32 v176,0
v_mov_b32 v177,0
v_mov_b32 v178,0
v_mov_b32 v179,0
v_mov_b32 v180,0
v_mov_b32 v181,0
v_mov_b32 v182,0
v_mov_b32 v183,0
s_waitcnt vmcnt(0) lgkmcnt(0)
s_barrier
pn1_132:
ds_read_b128 v[64:67],v20 offset:0
ds_read_b128 v[68:71],v20 offset:1024
ds_read_b128 v[72:75],v20 offset:2048
s_waitcnt lgkmcnt(2)
v_mfma_f32_16x16x32_bf16 v[192:195],a[0:3],v[64:67],0
ds_read_b128 v[76:79],v20 offset:3072
v_mfma_f32_16x16x32_bf16 v[200:203],v[64:67],a[128:131],0
s_waitcnt lgkmcnt(2)
v_mfma_f32_16x16x32_bf16 v[196:199],a[0:3],v[68:71],0
ds_read_b128 v[64:67],v20 offset:4096
v_mfma_f32_16x16x32_bf16 v[204:207],v[68:71],a[128:131],0
s_waitcnt lgkmcnt(2)
v_mfma_f32_16x16x32_bf16 v[192:195],a[4:7],v[72:75],v[192:195]
ds_read_b128 v[68:71],v20 offset:5120
v_mfma_f32_16x16x32_bf16 v[200:203],v[72:75],a[132:135],v[200:203]
s_waitcnt lgkmcnt(2)
v_mfma_f32_16x16x32_bf16 v[196:199],a[4:7],v[76:79],v[196:199]
ds_read_b128 v[72:75],v20 offset:6144
v_mfma_f32_16x16x32_bf16 v[204:207],v[76:79],a[132:135],v[204:207]
s_waitcnt lgkmcnt(2)
v_mfma_f32_16x16x32_bf16 v[192:195],a[8:11],v[64:67],v[192:195]
ds_read_b128 v[76:79],v20 offset:7168
v_mfma_f32_16x16x32_bf16 v[200:203],v[64:67],a[136:139],v[200:203]
s_waitcnt lgkmcnt(2)
v_mfma_f32_16x16x32_bf16 v[196:199],a[8:11],v[68:71],v[196:199]
ds_read_b128 v[64:67],v20 offset:8192
v_mfma_f32_16x16x32_bf16 v[204:207],v[68:71],a[136:139],v[204:207]
s_waitcnt lgkmcnt(2)
v_mfma_f32_16x16x32_bf16 v[192:195],a[12:15],v[72:75],v[192:195]
ds_read_b128 v[68:71],v20 offset:9216
v_mfma_f32_16x16x32_bf16 v[200:203],v[72:75],a[140:143],v[200:203]
s_waitcnt lgkmcnt(2)
v_mfma_f32_16x16x32_bf16 v[196:199],a[12:15],v[76:79],v[196:199]
ds_read_b128 v[72:75],v20 offset:10240
v_mfma_f32_16x16x32_bf16 v[204:207],v[76:79],a[140:143],v[204:207]
s_waitcnt lgkmcnt(2)
v_mfma_f32_16x16x32_bf16 v[192:195],a[16:19],v[64:67],v[192:195]
ds_read_b128 v[76:79],v20 offset:11264
v_mfma_f32_16x16x32_bf16 v[200:203],v[64:67],a[144:147],v[200:203]
s_waitcnt lgkmcnt(2)
v_mfma_f32_16x16x32_bf16 v[196:199],a[16:19],v[68:71],v[196:199]
ds_read_b128 v[64:67],v20 offset:12288
v_mfma_f32_16x16x32_bf16 v[204:207],v[68:71],a[144:147],v[204:207]
s_waitcnt lgkmcnt(2)
v_mfma_f32_16x16x32_bf16 v[192:195],a[20:23],v[72:75],v[192:195]
ds_read_b128 v[68:71],v20 offset:13312
v_mfma_f32_16x16x32_bf16 v[200:203],v[72:75],a[148:151],v[200:203]
s_waitcnt lgkmcnt(2)
v_mfma_f32_16x16x32_bf16 v[196:199],a[20:23],v[76:79],v[196:199]
ds_read_b128 v[72:75],v20 offset:14336
v_mfma_f32_16x16x32_bf16 v[204:207],v[76:79],a[148:151],v[204:207]
s_waitcnt lgkmcnt(2)
v_mfma_f32_16x16x32_bf16 v[192:195],a[24:27],v[64:67],v[192:195]
ds_read_b128 v[76:79],v20 offset:15360
v_mfma_f32_16x16x32_bf16 v[200:203],v[64:67],a[152:155],v[200:203]
s_waitcnt lgkmcnt(2)
v_mfma_f32_16x16x32_bf16 v[196:199],a[24:27],v[68:71],v[196:199]
ds_read_b128 v[64:67],v20 offset:16384
v_mfma_f32_16x16x32_bf16 v[204:207],v[68:71],a[152:155],v[204:207]
s_waitcnt lgkmcnt(2)
v_mfma_f32_16x16x32_bf16 v[192:195],a[28:31],v[72:75],v[192:195]
ds_read_b128 v[68:71],v20 offset:17408
v_mfma_f32_16x16x32_bf16 v[200:203],v[72:75],a[156:159],v[200:203]
s_waitcnt lgkmcnt(2)
v_mfma_f32_16x16x32_bf16 v[196:199],a[28:31],v[76:79],v[196:199]
ds_read_b128 v[72:75],v20 offset:18432
v_mfma_f32_16x16x32_bf16 v[204:207],v[76:79],a[156:159],v[204:207]
s_waitcnt lgkmcnt(2)
v_mfma_f32_16x16x32_bf16 v[192:195],a[32:35],v[64:67],v[192:195]
ds_read_b128 v[76:79],v20 offset:19456
v_mfma_f32_16x16x32_bf16 v[200:203],v[64:67],a[160:163],v[200:203]
s_waitcnt lgkmcnt(2)
v_mfma_f32_16x16x32_bf16 v[196:199],a[32:35],v[68:71],v[196:199]
ds_read_b128 v[64:67],v20 offset:20480
v_mfma_f32_16x16x32_bf16 v[204:207],v[68:71],a[160:163],v[204:207]
s_waitcnt lgkmcnt(2)
v_mfma_f32_16x16x32_bf16 v[192:195],a[36:39],v[72:75],v[192:195]
ds_read_b128 v[68:71],v20 offset:21504
v_mfma_f32_16x16x32_bf16 v[200:203],v[72:75],a[164:167],v[200:203]
s_waitcnt lgkmcnt(2)
v_mfma_f32_16x16x32_bf16 v[196:199],a[36:39],v[76:79],v[196:199]
ds_read_b128 v[72:75],v20 offset:22528
v_mfma_f32_16x16x32_bf16 v[204:207],v[76:79],a[164:167],v[204:207]
s_waitcnt lgkmcnt(2)
v_mfma_f32_16x16x32_bf16 v[192:195],a[40:43],v[64:67],v[192:195]
ds_read_b128 v[76:79],v20 offset:23552
v_mfma_f32_16x16x32_bf16 v[200:203],v[64:67],a[168:171],v[200:203]
s_waitcnt lgkmcnt(2)
v_mfma_f32_16x16x32_bf16 v[196:199],a[40:43],v[68:71],v[196:199]
ds_read_b128 v[64:67],v20 offset:24576
v_mfma_f32_16x16x32_bf16 v[204:207],v[68:71],a[168:171],v[204:207]
s_waitcnt lgkmcnt(2)
v_mfma_f32_16x16x32_bf16 v[192:195],a[44:47],v[72:75],v[192:195]
ds_read_b128 v[68:71],v20 offset:25600
v_mfma_f32_16x16x32_bf16 v[200:203],v[72:75],a[172:175],v[200:203]
s_waitcnt lgkmcnt(2)
v_mfma_f32_16x16x32_bf16 v[196:199],a[44:47],v[76:79],v[196:199]
ds_read_b128 v[72:75],v20 offset:26624
v_mfma_f32_16x16x32_bf16 v[204:207],v[76:79],a[172:175],v[204:207]
s_waitcnt lgkmcnt(2)
v_mfma_f32_16x16x32_bf16 v[192:195],a[48:51],v[64:67],v[192:195]
ds_read_b128 v[76:79],v20 offset:27648
v_mfma_f32_16x16x32_bf16 v[200:203],v[64:67],a[176:179],v[200:203]
s_waitcnt lgkmcnt(2)
v_mfma_f32_16x16x32_bf16 v[196:199],a[48:51],v[68:71],v[196:199]
ds_read_b128 v[64:67],v20 offset:28672
v_mfma_f32_16x16x32_bf16 v[204:207],v[68:71],a[176:179],v[204:207]
s_waitcnt lgkmcnt(2)
v_mfma_f32_16x16x32_bf16 v[192:195],a[52:55],v[72:75],v[192:195]
ds_read_b128 v[68:71],v20 offset:29696
v_mfma_f32_16x16x32_bf16 v[200:203],v[72:75],a[180:183],v[200:203]
s_waitcnt lgkmcnt(2)
v_mfma_f32_16x16x32_bf16 v[196:199],a[52:55],v[76:79],v[196:199]
ds_read_b128 v[72:75],v20 offset:30720
v_mfma_f32_16x16x32_bf16 v[204:207],v[76:79],a[180:183],v[204:207]
s_waitcnt lgkmcnt(2)
v_mfma_f32_16x16x32_bf16 v[192:195],a[56:59],v[64:67],v[192:195]
ds_read_b128 v[76:79],v20 offset:31744
v_mfma_f32_16x16x32_bf16 v[200:203],v[64:67],a[184:187],v[200:203]
s_waitcnt lgkmcnt(2)
v_mfma_f32_16x16x32_bf16 v[196:199],a[56:59],v[68:71],v[196:199]
ds_read_b128 v[64:67],v20 offset:32768
v_mfma_f32_16x16x32_bf16 v[204:207],v[68:71],a[184:187],v[204:207]
s_waitcnt lgkmcnt(2)
v_mfma_f32_16x16x32_bf16 v[192:195],a[60:63],v[72:75],v[192:195]
ds_read_b128 v[68:71],v20 offset:33792
v_mfma_f32_16x16x32_bf16 v[200:203],v[72:75],a[188:191],v[200:203]
s_waitcnt lgkmcnt(2)
v_mfma_f32_16x16x32_bf16 v[196:199],a[60:63],v[76:79],v[196:199]
ds_read_b128 v[72:75],v20 offset:34816
v_mfma_f32_16x16x32_bf16 v[204:207],v[76:79],a[188:191],v[204:207]
s_waitcnt lgkmcnt(2)
v_mfma_f32_16x16x32_bf16 v[192:195],a[64:67],v[64:67],v[192:195]
ds_read_b128 v[76:79],v20 offset:35840
v_mfma_f32_16x16x32_bf16 v[200:203],v[64:67],a[192:195],v[200:203]
s_waitcnt lgkmcnt(2)
v_mfma_f32_16x16x32_bf16 v[196:199],a[64:67],v[68:71],v[196:199]
ds_read_b128 v[64:67],v20 offset:36864
v_mfma_f32_16x16x32_bf16 v[204:207],v[68:71],a[192:195],v[204:207]
s_waitcnt lgkmcnt(2)
v_mfma_f32_16x16x32_bf16 v[192:195],a[68:71],v[72:75],v[192:195]
ds_read_b128 v[68:71],v20 offset:37888
v_mfma_f32_16x16x32_bf16 v[200:203],v[72:75],a[196:199],v[200:203]
s_waitcnt lgkmcnt(2)
v_mfma_f32_16x16x32_bf16 v[196:199],a[68:71],v[76:79],v[196:199]
ds_read_b128 v[72:75],v20 offset:38912
v_mfma_f32_16x16x32_bf16 v[204:207],v[76:79],a[196:199],v[204:207]
s_waitcnt lgkmcnt(2)
v_mfma_f32_16x16x32_bf16 v[192:195],a[72:75],v[64:67],v[192:195]
ds_read_b128 v[76:79],v20 offset:39936
v_mfma_f32_16x16x32_bf16 v[200:203],v[64:67],a[200:203],v[200:203]
s_waitcnt lgkmcnt(2)
v_mfma_f32_16x16x32_bf16 v[196:199],a[72:75],v[68:71],v[196:199]
ds_read_b128 v[64:67],v20 offset:40960
v_mfma_f32_16x16x32_bf16 v[204:207],v[68:71],a[200:203],v[204:207]
s_waitcnt lgkmcnt(2)
v_mfma_f32_16x16x32_bf16 v[192:195],a[76:79],v[72:75],v[192:195]
ds_read_b128 v[68:71],v20 offset:41984
v_mfma_f32_16x16x32_bf16 v[200:203],v[72:75],a[204:207],v[200:203]
s_waitcnt lgkmcnt(2)
v_mfma_f32_16x16x32_bf16 v[196:199],a[76:79],v[76:79],v[196:199]
ds_read_b128 v[72:75],v20 offset:43008
v_mfma_f32_16x16x32_bf16 v[204:207],v[76:79],a[204:207],v[204:207]
s_waitcnt lgkmcnt(2)
v_mfma_f32_16x16x32_bf16 v[192:195],a[80:83],v[64:67],v[192:195]
ds_read_b128 v[76:79],v20 offset:44032
v_mfma_f32_16x16x32_bf16 v[200:203],v[64:67],a[208:211],v[200:203]
s_waitcnt lgkmcnt(2)
v_mfma_f32_16x16x32_bf16 v[196:199],a[80:83],v[68:71],v[196:199]
ds_read_b128 v[64:67],v20 offset:45056
v_mfma_f32_16x16x32_bf16 v[204:207],v[68:71],a[208:211],v[204:207]
s_waitcnt lgkmcnt(2)
v_mfma_f32_16x16x32_bf16 v[192:195],a[84:87],v[72:75],v[192:195]
ds_read_b128 v[68:71],v20 offset:46080
v_mfma_f32_16x16x32_bf16 v[200:203],v[72:75],a[212:215],v[200:203]
s_waitcnt lgkmcnt(2)
v_mfma_f32_16x16x32_bf16 v[196:199],a[84:87],v[76:79],v[196:199]
ds_read_b128 v[72:75],v20 offset:47104
v_mfma_f32_16x16x32_bf16 v[204:207],v[76:79],a[212:215],v[204:207]
s_waitcnt lgkmcnt(2)
v_mfma_f32_16x16x32_bf16 v[192:195],a[88:91],v[64:67],v[192:195]
ds_read_b128 v[76:79],v20 offset:48128
v_mfma_f32_16x16x32_bf16 v[200:203],v[64:67],a[216:219],v[200:203]
s_waitcnt lgkmcnt(2)
v_mfma_f32_16x16x32_bf16 v[196:199],a[88:91],v[68:71],v[196:199]
ds_read_b128 v[64:67],v20 offset:49152
v_mfma_f32_16x16x32_bf16 v[204:207],v[68:71],a[216:219],v[204:207]
s_waitcnt lgkmcnt(2)
v_mfma_f32_16x16x32_bf16 v[192:195],a[92:95],v[72:75],v[192:195]
ds_read_b128 v[68:71],v20 offset:50176
v_mfma_f32_16x16x32_bf16 v[200:203],v[72:75],a[220:223],v[200:203]
s_waitcnt lgkmcnt(2)
v_mfma_f32_16x16x32_bf16 v[196:199],a[92:95],v[76:79],v[196:199]
ds_read_b128 v[72:75],v20 offset:51200
v_mfma_f32_16x16x32_bf16 v[204:207],v[76:79],a[220:223],v[204:207]
s_waitcnt lgkmcnt(2)
v_mfma_f32_16x16x32_bf16 v[192:195],a[96:99],v[64:67],v[192:195]
ds_read_b128 v[76:79],v20 offset:52224
v_mfma_f32_16x16x32_bf16 v[200:203],v[64:67],a[224:227],v[200:203]
s_waitcnt lgkmcnt(2)
v_mfma_f32_16x16x32_bf16 v[196:199],a[96:99],v[68:71],v[196:199]
ds_read_b128 v[64:67],v20 offset:53248
v_mfma_f32_16x16x32_bf16 v[204:207],v[68:71],a[224:227],v[204:207]
s_waitcnt lgkmcnt(2)
v_mfma_f32_16x16x32_bf16 v[192:195],a[100:103],v[72:75],v[192:195]
ds_read_b128 v[68:71],v20 offset:54272
v_mfma_f32_16x16x32_bf16 v[200:203],v[72:75],a[228:231],v[200:203]
s_waitcnt lgkmcnt(2)
v_mfma_f32_16x16x32_bf16 v[196:199],a[100:103],v[76:79],v[196:199]
ds_read_b128 v[72:75],v20 offset:55296
v_mfma_f32_16x16x32_bf16 v[204:207],v[76:79],a[228:231],v[204:207]
s_waitcnt lgkmcnt(2)
v_mfma_f32_16x16x32_bf16 v[192:195],a[104:107],v[64:67],v[192:195]
ds_read_b128 v[76:79],v20 offset:56320
v_mfma_f32_16x16x32_bf16 v[200:203],v[64:67],a[232:235],v[200:203]
s_waitcnt lgkmcnt(2)
v_mfma_f32_16x16x32_bf16 v[196:199],a[104:107],v[68:71],v[196:199]
ds_read_b128 v[64:67],v20 offset:57344
v_mfma_f32_16x16x32_bf16 v[204:207],v[68:71],a[232:235],v[204:207]
s_waitcnt lgkmcnt(2)
v_mfma_f32_16x16x32_bf16 v[192:195],a[108:111],v[72:75],v[192:195]
ds_read_b128 v[68:71],v20 offset:58368
v_mfma_f32_16x16x32_bf16 v[200:203],v[72:75],a[236:239],v[200:203]
s_waitcnt lgkmcnt(2)
v_mfma_f32_16x16x32_bf16 v[196:199],a[108:111],v[76:79],v[196:199]
ds_read_b128 v[72:75],v20 offset:59392
v_mfma_f32_16x16x32_bf16 v[204:207],v[76:79],a[236:239],v[204:207]
s_waitcnt lgkmcnt(2)
v_mfma_f32_16x16x32_bf16 v[192:195],a[112:115],v[64:67],v[192:195]
ds_read_b128 v[76:79],v20 offset:60416
v_mfma_f32_16x16x32_bf16 v[200:203],v[64:67],a[240:243],v[200:203]
s_waitcnt lgkmcnt(2)
v_mfma_f32_16x16x32_bf16 v[196:199],a[112:115],v[68:71],v[196:199]
ds_read_b128 v[64:67],v20 offset:61440
v_mfma_f32_16x16x32_bf16 v[204:207],v[68:71],a[240:243],v[204:207]
s_waitcnt lgkmcnt(2)
v_mfma_f32_16x16x32_bf16 v[192:195],a[116:119],v[72:75],v[192:195]
ds_read_b128 v[68:71],v20 offset:62464
v_mfma_f32_16x16x32_bf16 v[200:203],v[72:75],a[244:247],v[200:203]
s_waitcnt lgkmcnt(2)
v_mfma_f32_16x16x32_bf16 v[196:199],a[116:119],v[76:79],v[196:199]
ds_read_b128 v[72:75],v20 offset:63488
v_mfma_f32_16x16x32_bf16 v[204:207],v[76:79],a[244:247],v[204:207]
s_waitcnt lgkmcnt(2)
v_mfma_f32_16x16x32_bf16 v[192:195],a[120:123],v[64:67],v[192:195]
ds_read_b128 v[76:79],v20 offset:64512
v_mfma_f32_16x16x32_bf16 v[200:203],v[64:67],a[248:251],v[200:203]
s_waitcnt lgkmcnt(2)
v_mfma_f32_16x16x32_bf16 v[196:199],a[120:123],v[68:71],v[196:199]
v_mfma_f32_16x16x32_bf16 v[204:207],v[68:71],a[248:251],v[204:207]
s_waitcnt lgkmcnt(1)
v_mfma_f32_16x16x32_bf16 v[192:195],a[124:127],v[72:75],v[192:195]
v_mfma_f32_16x16x32_bf16 v[200:203],v[72:75],a[252:255],v[200:203]
s_waitcnt lgkmcnt(0)
v_mfma_f32_16x16x32_bf16 v[196:199],a[124:127],v[76:79],v[196:199]
v_mfma_f32_16x16x32_bf16 v[204:207],v[76:79],a[252:255],v[204:207]
v_xor_b32 v20,0x10000,v20
s_xor_b32 s62,s62,0x10000
s_lshr_b32 s64,s73,9
v_add_u32 v22,s64,v24
v_cvt_pk_bf16_f32 v208,v192,v193
v_cvt_pk_bf16_f32 v209,v194,v195
s_nop 0
v_cvt_pk_bf16_f32 v210,v196,v197
v_cvt_pk_bf16_f32 v211,v198,v199
v_cvt_pk_bf16_f32 v212,v200,v201
v_cvt_pk_bf16_f32 v213,v202,v203
v_cvt_pk_bf16_f32 v214,v204,v205
v_cvt_pk_bf16_f32 v215,v206,v207
v_permlane16_swap_b32 v208,v210
v_permlane16_swap_b32 v209,v211
buffer_store_dwordx4 v[208:211],v2,s[24:27],s73 offen
buffer_store_dwordx4 v[208:211],v2,s[28:31],s73 offen sc1
ds_write_b128 v22,v[212:215] offset:16384
buffer_store_dwordx4 v[208:211],v17,s[20:23],s12 offen sc1
bgx_134:
s_add_u32 s63,s79,1
s_and_b32 s64,s63,3
s_lshl_b32 s70,s64,20
s_add_u32 s65,s63,2
s_and_b32 s65,s65,3
s_lshl_b32 s73,s65,20
s_add_u32 s55,s63,3
s_lshl_b32 s78,s55,16
s_add_u32 s78,s78,57344
s_cmp_lt_u32 s55,64
s_cselect_b32 s78,s78,0x7fff0000
s_add_u32 s60,s63,1
s_lshl_b32 s76,s60,21
s_lshl_b32 s55,s60,13
s_and_b32 s55,s55,0x2000
s_xor_b32 s55,s55,s61
s_add_u32 s76,s76,s55
s_cmp_lt_u32 s60,64
s_cselect_b32 s76,s76,0x7fff0000
s_add_u32 s60,s63,2
s_lshl_b32 s12,s60,21
s_lshl_b32 s55,s60,13
s_and_b32 s55,s55,0x2000
s_xor_b32 s55,s55,s61
s_add_u32 s12,s12,s55
s_cmp_lt_u32 s60,64
s_cselect_b32 s12,s12,0x7fff0000
s_add_u32 s71,s73,65536
v_mov_b32 v176,0
v_mov_b32 v177,0
v_mov_b32 v178,0
v_mov_b32 v179,0
v_mov_b32 v180,0
v_mov_b32 v181,0
v_mov_b32 v182,0
v_mov_b32 v183,0
s_add_u32 s79,s79,1
s_cmp_eq_u32 s79,0
s_cbranch_scc1 pn2_133
v_mov_b32 v38,1
ds_write_b32 v37,v38 offset:8
buffer_store_dwordx4 v[212:215],v12,s[20:23],s76 offen sc1
s_waitcnt lgkmcnt(0)
s_branch pn1_132
pn2_133:
v_mov_b32 v25,1
s_waitcnt vmcnt(1) lgkmcnt(0)
s_barrier
s_branch loop_124
w2_60:
s_lshr_b32 s64,s57,2
s_add_u32 s64,s64,64
s_lshl_b32 s64,s64,14
s_add_u32 s64,s64,s68
s_add_u32 s64,s64,29361152
v_add_u32 v12,s64,v16
v_and_b32 v22,1,v4
v_lshrrev_b32 v23,1,v4
v_lshl_add_u32 v22,v22,1,v23
v_lshlrev_b32 v22,2,v22
v_lshl_add_u32 v22,v3,4,v22
v_add_u32 v31,155904,v22
s_branch first_135
loop_136:
s_barrier
buffer_load_dword v248,v18,s[20:23],s70 offen offset:0 sc1
s_nop 15
s_nop 5
hl_138:
buffer_load_dword v249,v18,s[20:23],s70 offen offset:0 sc1
s_waitcnt vmcnt(1)
v_cmp_eq_u32 vcc,v25,v248
s_bcnt1_i32_b32 s64,vcc_lo
s_cmp_ge_u32 s64,8
s_cbranch_scc1 hg_139
buffer_load_dword v248,v18,s[20:23],s70 offen offset:0 sc1
s_waitcnt vmcnt(1)
v_cmp_eq_u32 vcc,v25,v249
s_bcnt1_i32_b32 s64,vcc_lo
s_cmp_ge_u32 s64,8
s_cbranch_scc1 hg_139
s_sub_u32 s90,s90,1
s_cmp_gt_i32 s90,0
s_cbranch_scc1 hl_138
hg_139:
buffer_load_dwordx4 v[64:67],v28,s[20:23],s70 offen offset:0 sc1
buffer_load_dwordx4 v[68:71],v28,s[20:23],s70 offen offset:1024 sc1
buffer_load_dwordx4 v[72:75],v28,s[20:23],s70 offen offset:2048 sc1
buffer_load_dwordx4 v[76:79],v28,s[20:23],s70 offen offset:3072 sc1
s_waitcnt vmcnt(3)
ds_write_b128 v24,v[64:67] offset:8192
v_min3_u32 v22,v64,v65,v66
v_min_u32 v22,v22,v67
s_waitcnt vmcnt(2)
ds_write_b128 v24,v[68:71] offset:9216
v_min3_u32 v22,v22,v68,v69
v_min3_u32 v22,v22,v70,v71
s_waitcnt vmcnt(1)
ds_write_b128 v24,v[72:75] offset:10240
v_min3_u32 v22,v22,v72,v73
v_min3_u32 v22,v22,v74,v75
s_waitcnt vmcnt(0)
ds_write_b128 v24,v[76:79] offset:11264
v_min3_u32 v22,v22,v76,v77
v_min3_u32 v22,v22,v78,v79
v_cmp_eq_u32 vcc,0,v22
s_cbranch_vccnz art_140
abk_141:
v_smfmac_f32_16x16x64_bf16 v[176:179],v[64:67],a[64:71],v14
s_waitcnt lgkmcnt(0)
s_barrier
ds_read_b128 v[80:83],v24 offset:12288
ds_read_b128 v[84:87],v24 offset:13312
ds_read_b128 v[88:91],v24 offset:14336
ds_read_b128 v[92:95],v24 offset:15360
buffer_store_dwordx4 v[212:215],v12,s[20:23],s76 offen sc1
v_smfmac_f32_16x16x64_bf16 v[176:179],v[68:71],a[72:79],v14
ds_read_b128 v[32:35],v24 offset:0
ds_read_b128 v[36:39],v24 offset:1024
v_smfmac_f32_16x16x64_bf16 v[176:179],v[72:75],a[80:87],v14
ds_read_b128 v[40:43],v24 offset:2048
ds_read_b128 v[44:47],v24 offset:3072
v_smfmac_f32_16x16x64_bf16 v[176:179],v[76:79],a[88:95],v14
ds_read_b128 v[48:51],v24 offset:4096
ds_read_b128 v[52:55],v24 offset:5120
s_waitcnt lgkmcnt(9)
v_smfmac_f32_16x16x64_bf16 v[176:179],v[80:83],a[96:103],v14
ds_read_b128 v[56:59],v24 offset:6144
s_waitcnt lgkmcnt(9)
v_smfmac_f32_16x16x64_bf16 v[176:179],v[84:87],a[104:111],v14
ds_read_b128 v[60:63],v24 offset:7168
s_waitcnt lgkmcnt(9)
v_smfmac_f32_16x16x64_bf16 v[176:179],v[88:91],a[112:119],v14
s_waitcnt lgkmcnt(8)
v_smfmac_f32_16x16x64_bf16 v[176:179],v[92:95],a[120:127],v14
s_waitcnt lgkmcnt(7)
v_smfmac_f32_16x16x64_bf16 v[176:179],v[32:35],a[0:7],v14
s_waitcnt lgkmcnt(6)
v_smfmac_f32_16x16x64_bf16 v[176:179],v[36:39],a[8:15],v14
s_waitcnt lgkmcnt(5)
v_smfmac_f32_16x16x64_bf16 v[176:179],v[40:43],a[16:23],v14
s_waitcnt lgkmcnt(4)
v_smfmac_f32_16x16x64_bf16 v[176:179],v[44:47],a[24:31],v14
s_waitcnt lgkmcnt(3)
v_smfmac_f32_16x16x64_bf16 v[176:179],v[48:51],a[32:39],v14
s_waitcnt lgkmcnt(2)
v_smfmac_f32_16x16x64_bf16 v[176:179],v[52:55],a[40:47],v14
s_waitcnt lgkmcnt(1)
v_smfmac_f32_16x16x64_bf16 v[176:179],v[56:59],a[48:55],v14
s_waitcnt lgkmcnt(0)
v_smfmac_f32_16x16x64_bf16 v[176:179],v[60:63],a[56:63],v14
v_smfmac_f32_16x16x64_bf16 v[180:183],v[32:35],a[128:135],v14
v_smfmac_f32_16x16x64_bf16 v[180:183],v[36:39],a[136:143],v14
s_nop 5
v_permlane32_swap_b32 v176,v178
v_permlane32_swap_b32 v177,v179
v_add_f32 v176,v176,v178
v_add_f32 v177,v177,v179
v_cvt_pk_bf16_f32 v216,v176,v177
s_nop 1
v_mov_b32_dpp v217,v216 quad_perm:[1,0,3,2] row_mask:0xf bank_mask:0xf
v_perm_b32 v216,v217,v216,v15
v_max_u32 v216,1,v216
buffer_store_dword v216,v19,s[24:27],s70 offen
buffer_store_dword v216,v19,s[28:31],s70 offen sc1
v_smfmac_f32_16x16x64_bf16 v[180:183],v[40:43],a[144:151],v14
v_smfmac_f32_16x16x64_bf16 v[180:183],v[44:47],a[152:159],v14
v_smfmac_f32_16x16x64_bf16 v[180:183],v[48:51],a[160:167],v14
v_smfmac_f32_16x16x64_bf16 v[180:183],v[52:55],a[168:175],v14
v_smfmac_f32_16x16x64_bf16 v[180:183],v[56:59],a[176:183],v14
v_smfmac_f32_16x16x64_bf16 v[180:183],v[60:63],a[184:191],v14
v_smfmac_f32_16x16x64_bf16 v[180:183],v[64:67],a[192:199],v14
v_smfmac_f32_16x16x64_bf16 v[180:183],v[68:71],a[200:207],v14
v_smfmac_f32_16x16x64_bf16 v[180:183],v[72:75],a[208:215],v14
v_smfmac_f32_16x16x64_bf16 v[180:183],v[76:79],a[216:223],v14
v_smfmac_f32_16x16x64_bf16 v[180:183],v[80:83],a[224:231],v14
v_smfmac_f32_16x16x64_bf16 v[180:183],v[84:87],a[232:239],v14
v_smfmac_f32_16x16x64_bf16 v[180:183],v[88:91],a[240:247],v14
v_smfmac_f32_16x16x64_bf16 v[180:183],v[92:95],a[248:255],v14
s_nop 7
v_permlane32_swap_b32 v180,v182
v_permlane32_swap_b32 v181,v183
v_add_f32 v180,v180,v182
v_add_f32 v181,v181,v183
v_cvt_pk_bf16_f32 v216,v180,v181
v_max_u32 v216,1,v216
ds_write_b32 v31,v216
ds_write_b32 v21,v25 offset:4
s_cmp_eq_u32 s79,63
s_cbranch_scc1 end_57
s_cmp_ge_i32 s79,62
s_cbranch_scc1 bgsk_143
ds_read_b128 v[64:67],v20 offset:0
ds_read_b128 v[68:71],v20 offset:1024
ds_read_b128 v[72:75],v20 offset:2048
s_waitcnt lgkmcnt(2)
v_mfma_f32_16x16x32_bf16 v[192:195],a[0:3],v[64:67],0
ds_read_b128 v[76:79],v20 offset:3072
v_mfma_f32_16x16x32_bf16 v[200:203],v[64:67],a[128:131],0
s_waitcnt lgkmcnt(2)
v_mfma_f32_16x16x32_bf16 v[196:199],a[0:3],v[68:71],0
ds_read_b128 v[64:67],v20 offset:4096
v_mfma_f32_16x16x32_bf16 v[204:207],v[68:71],a[128:131],0
s_waitcnt lgkmcnt(2)
v_mfma_f32_16x16x32_bf16 v[192:195],a[4:7],v[72:75],v[192:195]
ds_read_b128 v[68:71],v20 offset:5120
v_mfma_f32_16x16x32_bf16 v[200:203],v[72:75],a[132:135],v[200:203]
s_waitcnt lgkmcnt(2)
v_mfma_f32_16x16x32_bf16 v[196:199],a[4:7],v[76:79],v[196:199]
ds_read_b128 v[72:75],v20 offset:6144
v_mfma_f32_16x16x32_bf16 v[204:207],v[76:79],a[132:135],v[204:207]
s_waitcnt lgkmcnt(2)
v_mfma_f32_16x16x32_bf16 v[192:195],a[8:11],v[64:67],v[192:195]
ds_read_b128 v[76:79],v20 offset:7168
v_mfma_f32_16x16x32_bf16 v[200:203],v[64:67],a[136:139],v[200:203]
s_waitcnt lgkmcnt(2)
v_mfma_f32_16x16x32_bf16 v[196:199],a[8:11],v[68:71],v[196:199]
ds_read_b128 v[64:67],v20 offset:8192
v_mfma_f32_16x16x32_bf16 v[204:207],v[68:71],a[136:139],v[204:207]
s_waitcnt lgkmcnt(2)
v_mfma_f32_16x16x32_bf16 v[192:195],a[12:15],v[72:75],v[192:195]
ds_read_b128 v[68:71],v20 offset:9216
v_mfma_f32_16x16x32_bf16 v[200:203],v[72:75],a[140:143],v[200:203]
s_waitcnt lgkmcnt(2)
v_mfma_f32_16x16x32_bf16 v[196:199],a[12:15],v[76:79],v[196:199]
ds_read_b128 v[72:75],v20 offset:10240
v_mfma_f32_16x16x32_bf16 v[204:207],v[76:79],a[140:143],v[204:207]
s_add_u32 m0,s62,16384
s_add_u32 s69,s78,16384
s_waitcnt lgkmcnt(2)
v_mfma_f32_16x16x32_bf16 v[192:195],a[16:19],v[64:67],v[192:195]
ds_read_b128 v[76:79],v20 offset:11264
v_mfma_f32_16x16x32_bf16 v[200:203],v[64:67],a[144:147],v[200:203]
buffer_load_dwordx4 v16,s[20:23],s69 offen offset:0 lds
s_waitcnt lgkmcnt(2)
v_mfma_f32_16x16x32_bf16 v[196:199],a[16:19],v[68:71],v[196:199]
ds_read_b128 v[64:67],v20 offset:12288
v_mfma_f32_16x16x32_bf16 v[204:207],v[68:71],a[144:147],v[204:207]
buffer_load_dwordx4 v16,s[20:23],s69 offen offset:1024 lds
s_waitcnt lgkmcnt(2)
v_mfma_f32_16x16x32_bf16 v[192:195],a[20:23],v[72:75],v[192:195]
ds_read_b128 v[68:71],v20 offset:13312
v_mfma_f32_16x16x32_bf16 v[200:203],v[72:75],a[148:151],v[200:203]
buffer_load_dwordx4 v16,s[20:23],s69 offen offset:2048 lds
s_waitcnt lgkmcnt(2)
v_mfma_f32_16x16x32_bf16 v[196:199],a[20:23],v[76:79],v[196:199]
ds_read_b128 v[72:75],v20 offset:14336
v_mfma_f32_16x16x32_bf16 v[204:207],v[76:79],a[148:151],v[204:207]
buffer_load_dwordx4 v16,s[20:23],s69 offen offset:3072 lds
s_waitcnt lgkmcnt(2)
v_mfma_f32_16x16x32_bf16 v[192:195],a[24:27],v[64:67],v[192:195]
ds_read_b128 v[76:79],v20 offset:15360
v_mfma_f32_16x16x32_bf16 v[200:203],v[64:67],a[152:155],v[200:203]
s_add_u32 m0,s62,20480
s_add_u32 s69,s78,20480
s_waitcnt lgkmcnt(2)
v_mfma_f32_16x16x32_bf16 v[196:199],a[24:27],v[68:71],v[196:199]
ds_read_b128 v[64:67],v20 offset:16384
v_mfma_f32_16x16x32_bf16 v[204:207],v[68:71],a[152:155],v[204:207]
buffer_load_dwordx4 v16,s[20:23],s69 offen offset:0 lds
s_waitcnt lgkmcnt(2)
v_mfma_f32_16x16x32_bf16 v[192:195],a[28:31],v[72:75],v[192:195]
ds_read_b128 v[68:71],v20 offset:17408
v_mfma_f32_16x16x32_bf16 v[200:203],v[72:75],a[156:159],v[200:203]
buffer_load_dwordx4 v16,s[20:23],s69 offen offset:1024 lds
s_waitcnt lgkmcnt(2)
v_mfma_f32_16x16x32_bf16 v[196:199],a[28:31],v[76:79],v[196:199]
ds_read_b128 v[72:75],v20 offset:18432
v_mfma_f32_16x16x32_bf16 v[204:207],v[76:79],a[156:159],v[204:207]
buffer_load_dwordx4 v16,s[20:23],s69 offen offset:2048 lds
s_waitcnt lgkmcnt(2)
v_mfma_f32_16x16x32_bf16 v[192:195],a[32:35],v[64:67],v[192:195]
ds_read_b128 v[76:79],v20 offset:19456
v_mfma_f32_16x16x32_bf16 v[200:203],v[64:67],a[160:163],v[200:203]
buffer_load_dwordx4 v16,s[20:23],s69 offen offset:3072 lds
s_waitcnt lgkmcnt(2)
v_mfma_f32_16x16x32_bf16 v[196:199],a[32:35],v[68:71],v[196:199]
ds_read_b128 v[64:67],v20 offset:20480
v_mfma_f32_16x16x32_bf16 v[204:207],v[68:71],a[160:163],v[204:207]
s_add_u32 m0,s62,24576
s_add_u32 s69,s78,24576
s_waitcnt lgkmcnt(2)
v_mfma_f32_16x16x32_bf16 v[192:195],a[36:39],v[72:75],v[192:195]
ds_read_b128 v[68:71],v20 offset:21504
v_mfma_f32_16x16x32_bf16 v[200:203],v[72:75],a[164:167],v[200:203]
buffer_load_dwordx4 v16,s[20:23],s69 offen offset:0 lds
s_waitcnt lgkmcnt(2)
v_mfma_f32_16x16x32_bf16 v[196:199],a[36:39],v[76:79],v[196:199]
ds_read_b128 v[72:75],v20 offset:22528
v_mfma_f32_16x16x32_bf16 v[204:207],v[76:79],a[164:167],v[204:207]
buffer_load_dwordx4 v16,s[20:23],s69 offen offset:1024 lds
s_waitcnt lgkmcnt(2)
v_mfma_f32_16x16x32_bf16 v[192:195],a[40:43],v[64:67],v[192:195]
ds_read_b128 v[76:79],v20 offset:23552
v_mfma_f32_16x16x32_bf16 v[200:203],v[64:67],a[168:171],v[200:203]
buffer_load_dwordx4 v16,s[20:23],s69 offen offset:2048 lds
s_waitcnt lgkmcnt(2)
v_mfma_f32_16x16x32_bf16 v[196:199],a[40:43],v[68:71],v[196:199]
ds_read_b128 v[64:67],v20 offset:24576
v_mfma_f32_16x16x32_bf16 v[204:207],v[68:71],a[168:171],v[204:207]
buffer_load_dwordx4 v16,s[20:23],s69 offen offset:3072 lds
s_waitcnt lgkmcnt(2)
v_mfma_f32_16x16x32_bf16 v[192:195],a[44:47],v[72:75],v[192:195]
ds_read_b128 v[68:71],v20 offset:25600
v_mfma_f32_16x16x32_bf16 v[200:203],v[72:75],a[172:175],v[200:203]
s_add_u32 m0,s62,28672
s_add_u32 s69,s78,28672
s_waitcnt lgkmcnt(2)
v_mfma_f32_16x16x32_bf16 v[196:199],a[44:47],v[76:79],v[196:199]
ds_read_b128 v[72:75],v20 offset:26624
v_mfma_f32_16x16x32_bf16 v[204:207],v[76:79],a[172:175],v[204:207]
buffer_load_dwordx4 v16,s[20:23],s69 offen offset:0 lds
s_waitcnt lgkmcnt(2)
v_mfma_f32_16x16x32_bf16 v[192:195],a[48:51],v[64:67],v[192:195]
ds_read_b128 v[76:79],v20 offset:27648
v_mfma_f32_16x16x32_bf16 v[200:203],v[64:67],a[176:179],v[200:203]
buffer_load_dwordx4 v16,s[20:23],s69 offen offset:1024 lds
s_waitcnt lgkmcnt(2)
v_mfma_f32_16x16x32_bf16 v[196:199],a[48:51],v[68:71],v[196:199]
ds_read_b128 v[64:67],v20 offset:28672
v_mfma_f32_16x16x32_bf16 v[204:207],v[68:71],a[176:179],v[204:207]
buffer_load_dwordx4 v16,s[20:23],s69 offen offset:2048 lds
s_waitcnt lgkmcnt(2)
v_mfma_f32_16x16x32_bf16 v[192:195],a[52:55],v[72:75],v[192:195]
ds_read_b128 v[68:71],v20 offset:29696
v_mfma_f32_16x16x32_bf16 v[200:203],v[72:75],a[180:183],v[200:203]
buffer_load_dwordx4 v16,s[20:23],s69 offen offset:3072 lds
s_waitcnt lgkmcnt(2)
v_mfma_f32_16x16x32_bf16 v[196:199],a[52:55],v[76:79],v[196:199]
ds_read_b128 v[72:75],v20 offset:30720
v_mfma_f32_16x16x32_bf16 v[204:207],v[76:79],a[180:183],v[204:207]
s_waitcnt lgkmcnt(2)
v_mfma_f32_16x16x32_bf16 v[192:195],a[56:59],v[64:67],v[192:195]
ds_read_b128 v[76:79],v20 offset:31744
v_mfma_f32_16x16x32_bf16 v[200:203],v[64:67],a[184:187],v[200:203]
s_waitcnt lgkmcnt(2)
v_mfma_f32_16x16x32_bf16 v[196:199],a[56:59],v[68:71],v[196:199]
ds_read_b128 v[64:67],v20 offset:32768
v_mfma_f32_16x16x32_bf16 v[204:207],v[68:71],a[184:187],v[204:207]
s_waitcnt lgkmcnt(2)
v_mfma_f32_16x16x32_bf16 v[192:195],a[60:63],v[72:75],v[192:195]
ds_read_b128 v[68:71],v20 offset:33792
v_mfma_f32_16x16x32_bf16 v[200:203],v[72:75],a[188:191],v[200:203]
s_waitcnt lgkmcnt(2)
v_mfma_f32_16x16x32_bf16 v[196:199],a[60:63],v[76:79],v[196:199]
ds_read_b128 v[72:75],v20 offset:34816
v_mfma_f32_16x16x32_bf16 v[204:207],v[76:79],a[188:191],v[204:207]
s_waitcnt lgkmcnt(2)
v_mfma_f32_16x16x32_bf16 v[192:195],a[64:67],v[64:67],v[192:195]
ds_read_b128 v[76:79],v20 offset:35840
v_mfma_f32_16x16x32_bf16 v[200:203],v[64:67],a[192:195],v[200:203]
s_waitcnt lgkmcnt(2)
v_mfma_f32_16x16x32_bf16 v[196:199],a[64:67],v[68:71],v[196:199]
ds_read_b128 v[64:67],v20 offset:36864
v_mfma_f32_16x16x32_bf16 v[204:207],v[68:71],a[192:195],v[204:207]
s_waitcnt lgkmcnt(2)
v_mfma_f32_16x16x32_bf16 v[192:195],a[68:71],v[72:75],v[192:195]
ds_read_b128 v[68:71],v20 offset:37888
v_mfma_f32_16x16x32_bf16 v[200:203],v[72:75],a[196:199],v[200:203]
s_waitcnt lgkmcnt(2)
v_mfma_f32_16x16x32_bf16 v[196:199],a[68:71],v[76:79],v[196:199]
ds_read_b128 v[72:75],v20 offset:38912
v_mfma_f32_16x16x32_bf16 v[204:207],v[76:79],a[196:199],v[204:207]
s_waitcnt lgkmcnt(2)
v_mfma_f32_16x16x32_bf16 v[192:195],a[72:75],v[64:67],v[192:195]
ds_read_b128 v[76:79],v20 offset:39936
v_mfma_f32_16x16x32_bf16 v[200:203],v[64:67],a[200:203],v[200:203]
s_waitcnt lgkmcnt(2)
v_mfma_f32_16x16x32_bf16 v[196:199],a[72:75],v[68:71],v[196:199]
ds_read_b128 v[64:67],v20 offset:40960
v_mfma_f32_16x16x32_bf16 v[204:207],v[68:71],a[200:203],v[204:207]
s_waitcnt lgkmcnt(2)
v_mfma_f32_16x16x32_bf16 v[192:195],a[76:79],v[72:75],v[192:195]
ds_read_b128 v[68:71],v20 offset:41984
v_mfma_f32_16x16x32_bf16 v[200:203],v[72:75],a[204:207],v[200:203]
s_waitcnt lgkmcnt(2)
v_mfma_f32_16x16x32_bf16 v[196:199],a[76:79],v[76:79],v[196:199]
ds_read_b128 v[72:75],v20 offset:43008
v_mfma_f32_16x16x32_bf16 v[204:207],v[76:79],a[204:207],v[204:207]
s_waitcnt lgkmcnt(2)
v_mfma_f32_16x16x32_bf16 v[192:195],a[80:83],v[64:67],v[192:195]
ds_read_b128 v[76:79],v20 offset:44032
v_mfma_f32_16x16x32_bf16 v[200:203],v[64:67],a[208:211],v[200:203]
s_waitcnt lgkmcnt(2)
v_mfma_f32_16x16x32_bf16 v[196:199],a[80:83],v[68:71],v[196:199]
ds_read_b128 v[64:67],v20 offset:45056
v_mfma_f32_16x16x32_bf16 v[204:207],v[68:71],a[208:211],v[204:207]
s_waitcnt lgkmcnt(2)
v_mfma_f32_16x16x32_bf16 v[192:195],a[84:87],v[72:75],v[192:195]
ds_read_b128 v[68:71],v20 offset:46080
v_mfma_f32_16x16x32_bf16 v[200:203],v[72:75],a[212:215],v[200:203]
s_waitcnt lgkmcnt(2)
v_mfma_f32_16x16x32_bf16 v[196:199],a[84:87],v[76:79],v[196:199]
ds_read_b128 v[72:75],v20 offset:47104
v_mfma_f32_16x16x32_bf16 v[204:207],v[76:79],a[212:215],v[204:207]
s_waitcnt lgkmcnt(2)
v_mfma_f32_16x16x32_bf16 v[192:195],a[88:91],v[64:67],v[192:195]
ds_read_b128 v[76:79],v20 offset:48128
v_mfma_f32_16x16x32_bf16 v[200:203],v[64:67],a[216:219],v[200:203]
s_waitcnt lgkmcnt(2)
v_mfma_f32_16x16x32_bf16 v[196:199],a[88:91],v[68:71],v[196:199]
ds_read_b128 v[64:67],v20 offset:49152
v_mfma_f32_16x16x32_bf16 v[204:207],v[68:71],a[216:219],v[204:207]
s_waitcnt lgkmcnt(2)
v_mfma_f32_16x16x32_bf16 v[192:195],a[92:95],v[72:75],v[192:195]
ds_read_b128 v[68:71],v20 offset:50176
v_mfma_f32_16x16x32_bf16 v[200:203],v[72:75],a[220:223],v[200:203]
s_waitcnt lgkmcnt(2)
v_mfma_f32_16x16x32_bf16 v[196:199],a[92:95],v[76:79],v[196:199]
ds_read_b128 v[72:75],v20 offset:51200
v_mfma_f32_16x16x32_bf16 v[204:207],v[76:79],a[220:223],v[204:207]
s_waitcnt lgkmcnt(2)
v_mfma_f32_16x16x32_bf16 v[192:195],a[96:99],v[64:67],v[192:195]
ds_read_b128 v[76:79],v20 offset:52224
v_mfma_f32_16x16x32_bf16 v[200:203],v[64:67],a[224:227],v[200:203]
s_waitcnt lgkmcnt(2)
v_mfma_f32_16x16x32_bf16 v[196:199],a[96:99],v[68:71],v[196:199]
ds_read_b128 v[64:67],v20 offset:53248
v_mfma_f32_16x16x32_bf16 v[204:207],v[68:71],a[224:227],v[204:207]
s_waitcnt lgkmcnt(2)
v_mfma_f32_16x16x32_bf16 v[192:195],a[100:103],v[72:75],v[192:195]
ds_read_b128 v[68:71],v20 offset:54272
s_add_u32 m0,s62,43008
s_add_u32 s69,s78,43008
v_mfma_f32_16x16x32_bf16 v[200:203],v[72:75],a[228:231],v[200:203]
s_waitcnt lgkmcnt(2)
v_mfma_f32_16x16x32_bf16 v[196:199],a[100:103],v[76:79],v[196:199]
ds_read_b128 v[72:75],v20 offset:55296
buffer_load_dwordx4 v16,s[20:23],s69 offen offset:0 lds
v_mfma_f32_16x16x32_bf16 v[204:207],v[76:79],a[228:231],v[204:207]
s_waitcnt lgkmcnt(2)
v_mfma_f32_16x16x32_bf16 v[192:195],a[104:107],v[64:67],v[192:195]
ds_read_b128 v[76:79],v20 offset:56320
buffer_load_dwordx4 v16,s[20:23],s69 offen offset:1024 lds
v_mfma_f32_16x16x32_bf16 v[200:203],v[64:67],a[232:235],v[200:203]
s_waitcnt lgkmcnt(2)
v_mfma_f32_16x16x32_bf16 v[196:199],a[104:107],v[68:71],v[196:199]
ds_read_b128 v[64:67],v20 offset:57344
buffer_load_dwordx4 v16,s[20:23],s69 offen offset:2048 lds
v_mfma_f32_16x16x32_bf16 v[204:207],v[68:71],a[232:235],v[204:207]
s_waitcnt lgkmcnt(2)
v_mfma_f32_16x16x32_bf16 v[192:195],a[108:111],v[72:75],v[192:195]
ds_read_b128 v[68:71],v20 offset:58368
buffer_load_dwordx4 v16,s[20:23],s69 offen offset:3072 lds
v_mfma_f32_16x16x32_bf16 v[200:203],v[72:75],a[236:239],v[200:203]
s_waitcnt lgkmcnt(2)
v_mfma_f32_16x16x32_bf16 v[196:199],a[108:111],v[76:79],v[196:199]
ds_read_b128 v[72:75],v20 offset:59392
s_add_u32 m0,s62,47104
s_add_u32 s69,s78,47104
v_mfma_f32_16x16x32_bf16 v[204:207],v[76:79],a[236:239],v[204:207]
s_waitcnt lgkmcnt(2)
v_mfma_f32_16x16x32_bf16 v[192:195],a[112:115],v[64:67],v[192:195]
ds_read_b128 v[76:79],v20 offset:60416
buffer_load_dwordx4 v16,s[20:23],s69 offen offset:0 lds
v_mfma_f32_16x16x32_bf16 v[200:203],v[64:67],a[240:243],v[200:203]
s_waitcnt lgkmcnt(2)
v_mfma_f32_16x16x32_bf16 v[196:199],a[112:115],v[68:71],v[196:199]
ds_read_b128 v[64:67],v20 offset:61440
v_mfma_f32_16x16x32_bf16 v[204:207],v[68:71],a[240:243],v[204:207]
buffer_load_dwordx4 v16,s[20:23],s69 offen offset:1024 lds
s_waitcnt lgkmcnt(2)
v_mfma_f32_16x16x32_bf16 v[192:195],a[116:119],v[72:75],v[192:195]
ds_read_b128 v[68:71],v20 offset:62464
v_mfma_f32_16x16x32_bf16 v[200:203],v[72:75],a[244:247],v[200:203]
buffer_load_dwordx4 v16,s[20:23],s69 offen offset:2048 lds
s_waitcnt lgkmcnt(2)
v_mfma_f32_16x16x32_bf16 v[196:199],a[116:119],v[76:79],v[196:199]
ds_read_b128 v[72:75],v20 offset:63488
v_mfma_f32_16x16x32_bf16 v[204:207],v[76:79],a[244:247],v[204:207]
buffer_load_dwordx4 v16,s[20:23],s69 offen offset:3072 lds
s_waitcnt lgkmcnt(2)
v_mfma_f32_16x16x32_bf16 v[192:195],a[120:123],v[64:67],v[192:195]
ds_read_b128 v[76:79],v20 offset:64512
v_mfma_f32_16x16x32_bf16 v[200:203],v[64:67],a[248:251],v[200:203]
s_add_u32 m0,s62,51200
s_add_u32 s69,s78,51200
s_waitcnt lgkmcnt(2)
v_mfma_f32_16x16x32_bf16 v[196:199],a[120:123],v[68:71],v[196:199]
v_mfma_f32_16x16x32_bf16 v[204:207],v[68:71],a[248:251],v[204:207]
buffer_load_dwordx4 v16,s[20:23],s69 offen offset:0 lds
s_waitcnt lgkmcnt(1)
v_mfma_f32_16x16x32_bf16 v[192:195],a[124:127],v[72:75],v[192:195]
v_mfma_f32_16x16x32_bf16 v[200:203],v[72:75],a[252:255],v[200:203]
buffer_load_dwordx4 v16,s[20:23],s69 offen offset:1024 lds
s_waitcnt lgkmcnt(0)
v_mfma_f32_16x16x32_bf16 v[196:199],a[124:127],v[76:79],v[196:199]
v_mfma_f32_16x16x32_bf16 v[204:207],v[76:79],a[252:255],v[204:207]
s_waitcnt vmcnt(26)
ds_write_b32 v21,v25 offset:28
v_xor_b32 v20,0x10000,v20
s_xor_b32 s62,s62,0x10000
s_lshr_b32 s64,s73,9
v_add_u32 v22,s64,v24
v_cvt_pk_bf16_f32 v208,v192,v193
v_cvt_pk_bf16_f32 v209,v194,v195
v_cvt_pk_bf16_f32 v210,v196,v197
v_cvt_pk_bf16_f32 v211,v198,v199
v_cvt_pk_bf16_f32 v212,v200,v201
v_cvt_pk_bf16_f32 v213,v202,v203
v_cvt_pk_bf16_f32 v214,v204,v205
v_cvt_pk_bf16_f32 v215,v206,v207
v_permlane16_swap_b32 v208,v210
v_permlane16_swap_b32 v209,v211
buffer_store_dwordx4 v[208:211],v2,s[24:27],s73 offen
buffer_store_dwordx4 v[208:211],v2,s[28:31],s73 offen sc1
ds_write_b128 v22,v[212:215] offset:17408
buffer_store_dwordx4 v[208:211],v17,s[20:23],s12 offen sc1
bgx_142:
s_waitcnt lgkmcnt(0)
s_andn2_b32 s64,s79,0x14
s_cmp_eq_u32 s64,2
s_cbranch_scc1 late_144
lateb_145:
s_buffer_load_dword s48,s[20:23],s80 offset:0
s_buffer_load_dword s48,s[20:23],s80 offset:64
s_buffer_load_dword s48,s[20:23],s80 offset:128
s_buffer_load_dword s48,s[20:23],s80 offset:192
s_buffer_load_dword s48,s[20:23],s80 offset:256
s_buffer_load_dword s48,s[20:23],s80 offset:320
s_buffer_load_dword s48,s[20:23],s80 offset:384
s_buffer_load_dword s48,s[20:23],s80 offset:448
s_buffer_load_dword s48,s[20:23],s80 offset:512
s_buffer_load_dword s48,s[20:23],s80 offset:576
s_buffer_load_dword s48,s[20:23],s80 offset:640
s_buffer_load_dword s48,s[20:23],s80 offset:704
s_buffer_load_dword s48,s[20:23],s80 offset:768
s_buffer_load_dword s48,s[20:23],s80 offset:832
s_buffer_load_dword s48,s[20:23],s80 offset:896
s_buffer_load_dword s48,s[20:23],s80 offset:960
s_buffer_load_dword s48,s[20:23],s80 offset:1024
s_buffer_load_dword s48,s[20:23],s80 offset:1088
s_buffer_load_dword s48,s[20:23],s80 offset:1152
s_buffer_load_dword s48,s[20:23],s80 offset:1216
s_buffer_load_dword s48,s[20:23],s80 offset:1280
s_buffer_load_dword s48,s[20:23],s80 offset:1344
s_buffer_load_dword s48,s[20:23],s80 offset:1408
s_buffer_load_dword s48,s[20:23],s80 offset:1472
s_buffer_load_dword s48,s[20:23],s80 offset:1536
s_buffer_load_dword s48,s[20:23],s80 offset:1600
s_buffer_load_dword s48,s[20:23],s80 offset:1664
s_buffer_load_dword s48,s[20:23],s80 offset:1728
s_buffer_load_dword s48,s[20:23],s80 offset:1792
s_buffer_load_dword s48,s[20:23],s80 offset:1856
s_buffer_load_dword s48,s[20:23],s80 offset:1920
s_buffer_load_dword s48,s[20:23],s80 offset:1984
s_add_u32 s63,s79,1
s_and_b32 s64,s63,3
s_lshl_b32 s70,s64,20
s_add_u32 s65,s63,2
s_and_b32 s65,s65,3
s_lshl_b32 s73,s65,20
s_add_u32 s55,s63,3
s_lshl_b32 s78,s55,16
s_add_u32 s78,s78,57344
s_cmp_lt_u32 s55,64
s_cselect_b32 s78,s78,0x7fff0000
s_add_u32 s60,s63,1
s_lshl_b32 s76,s60,21
s_lshl_b32 s55,s60,13
s_and_b32 s55,s55,0x2000
s_xor_b32 s55,s55,s61
s_add_u32 s76,s76,s55
s_cmp_lt_u32 s60,64
s_cselect_b32 s76,s76,0x7fff0000
s_add_u32 s60,s63,2
s_lshl_b32 s12,s60,21
s_lshl_b32 s55,s60,13
s_and_b32 s55,s55,0x2000
s_xor_b32 s55,s55,s61
s_add_u32 s12,s12,s55
s_cmp_lt_u32 s60,64
s_cselect_b32 s12,s12,0x7fff0000
s_add_u32 s55,s63,5
s_min_u32 s55,s55,63
s_lshl_b32 s55,s55,16
s_lshl_b32 s60,s59,11
s_add_u32 s80,s55,s60
s_add_u32 s80,s80,57344
v_mov_b32 v176,0
v_mov_b32 v177,0
v_mov_b32 v178,0
v_mov_b32 v179,0
v_mov_b32 v180,0
v_mov_b32 v181,0
v_mov_b32 v182,0
v_mov_b32 v183,0
s_add_u32 s79,s79,1
v_add_u32 v25,1,v25
s_waitcnt vmcnt(0)
s_branch loop_136
art_140:
s_sub_u32 s90,s90,1
s_cmp_lt_i32 s90,0
s_cbranch_scc1 abk_141
buffer_load_dwordx4 v[64:67],v28,s[20:23],s70 offen offset:0 sc1
buffer_load_dwordx4 v[68:71],v28,s[20:23],s70 offen offset:1024 sc1
buffer_load_dwordx4 v[72:75],v28,s[20:23],s70 offen offset:2048 sc1
buffer_load_dwordx4 v[76:79],v28,s[20:23],s70 offen offset:3072 sc1
s_waitcnt vmcnt(3)
ds_write_b128 v24,v[64:67] offset:8192
v_min3_u32 v22,v64,v65,v66
v_min_u32 v22,v22,v67
s_waitcnt vmcnt(2)
ds_write_b128 v24,v[68:71] offset:9216
v_min3_u32 v22,v22,v68,v69
v_min3_u32 v22,v22,v70,v71
s_waitcnt vmcnt(1)
ds_write_b128 v24,v[72:75] offset:10240
v_min3_u32 v22,v22,v72,v73
v_min3_u32 v22,v22,v74,v75
s_waitcnt vmcnt(0)
ds_write_b128 v24,v[76:79] offset:11264
v_min3_u32 v22,v22,v76,v77
v_min3_u32 v22,v22,v78,v79
v_cmp_eq_u32 vcc,0,v22
s_cbranch_vccnz art_140
s_branch abk_141
bgsk_143:
s_waitcnt vmcnt(0)
ds_write_b32 v21,v25 offset:28
s_branch bgx_142
late_144:
s_cmp_eq_u32 s79,22
s_cbranch_scc1 lateb_145
v_lshlrev_b32 v184,2,v16
s_mov_b32 s52,21052416
s_mov_b32 s53,1792
s_lshr_b32 s64,s79,4
s_lshl_b32 s64,0x100,s64
s_cmp_eq_u32 s79,2
s_cselect_b32 exec_lo,0xff,s64
s_mov_b32 exec_hi,0
dp_146:
buffer_load_dword v185,v184,s[20:23],s52 offen sc1
s_waitcnt vmcnt(0)
v_cmp_ne_u32 vcc,s53,v185
s_cbranch_vccz dpok_147
s_sleep 2
s_sub_u32 s90,s90,1
s_cmp_gt_i32 s90,0
s_cbranch_scc1 dp_146
dpok_147:
s_mov_b64 exec,-1
s_branch lateb_145
first_135:
s_add_u32 s63,s79,0
s_and_b32 s64,s63,3
s_lshl_b32 s70,s64,20
s_add_u32 s65,s63,2
s_and_b32 s65,s65,3
s_lshl_b32 s73,s65,20
s_add_u32 s55,s63,3
s_lshl_b32 s78,s55,16
s_add_u32 s78,s78,57344
s_cmp_lt_u32 s55,64
s_cselect_b32 s78,s78,0x7fff0000
s_add_u32 s60,s63,1
s_lshl_b32 s76,s60,21
s_lshl_b32 s55,s60,13
s_and_b32 s55,s55,0x2000
s_xor_b32 s55,s55,s61
s_add_u32 s76,s76,s55
s_cmp_lt_u32 s60,64
s_cselect_b32 s76,s76,0x7fff0000
s_add_u32 s60,s63,2
s_lshl_b32 s12,s60,21
s_lshl_b32 s55,s60,13
s_and_b32 s55,s55,0x2000
s_xor_b32 s55,s55,s61
s_add_u32 s12,s12,s55
s_cmp_lt_u32 s60,64
s_cselect_b32 s12,s12,0x7fff0000
s_add_u32 s55,s63,5
s_min_u32 s55,s55,63
s_lshl_b32 s55,s55,16
s_lshl_b32 s60,s59,11
s_add_u32 s80,s55,s60
s_add_u32 s80,s80,57344
v_mov_b32 v176,0
v_mov_b32 v177,0
v_mov_b32 v178,0
v_mov_b32 v179,0
v_mov_b32 v180,0
v_mov_b32 v181,0
v_mov_b32 v182,0
v_mov_b32 v183,0
s_waitcnt vmcnt(0) lgkmcnt(0)
s_barrier
pn1_148:
ds_read_b128 v[64:67],v20 offset:0
ds_read_b128 v[68:71],v20 offset:1024
ds_read_b128 v[72:75],v20 offset:2048
s_waitcnt lgkmcnt(2)
v_mfma_f32_16x16x32_bf16 v[192:195],a[0:3],v[64:67],0
ds_read_b128 v[76:79],v20 offset:3072
v_mfma_f32_16x16x32_bf16 v[200:203],v[64:67],a[128:131],0
s_waitcnt lgkmcnt(2)
v_mfma_f32_16x16x32_bf16 v[196:199],a[0:3],v[68:71],0
ds_read_b128 v[64:67],v20 offset:4096
v_mfma_f32_16x16x32_bf16 v[204:207],v[68:71],a[128:131],0
s_waitcnt lgkmcnt(2)
v_mfma_f32_16x16x32_bf16 v[192:195],a[4:7],v[72:75],v[192:195]
ds_read_b128 v[68:71],v20 offset:5120
v_mfma_f32_16x16x32_bf16 v[200:203],v[72:75],a[132:135],v[200:203]
s_waitcnt lgkmcnt(2)
v_mfma_f32_16x16x32_bf16 v[196:199],a[4:7],v[76:79],v[196:199]
ds_read_b128 v[72:75],v20 offset:6144
v_mfma_f32_16x16x32_bf16 v[204:207],v[76:79],a[132:135],v[204:207]
s_waitcnt lgkmcnt(2)
v_mfma_f32_16x16x32_bf16 v[192:195],a[8:11],v[64:67],v[192:195]
ds_read_b128 v[76:79],v20 offset:7168
v_mfma_f32_16x16x32_bf16 v[200:203],v[64:67],a[136:139],v[200:203]
s_waitcnt lgkmcnt(2)
v_mfma_f32_16x16x32_bf16 v[196:199],a[8:11],v[68:71],v[196:199]
ds_read_b128 v[64:67],v20 offset:8192
v_mfma_f32_16x16x32_bf16 v[204:207],v[68:71],a[136:139],v[204:207]
s_waitcnt lgkmcnt(2)
v_mfma_f32_16x16x32_bf16 v[192:195],a[12:15],v[72:75],v[192:195]
ds_read_b128 v[68:71],v20 offset:9216
v_mfma_f32_16x16x32_bf16 v[200:203],v[72:75],a[140:143],v[200:203]
s_waitcnt lgkmcnt(2)
v_mfma_f32_16x16x32_bf16 v[196:199],a[12:15],v[76:79],v[196:199]
ds_read_b128 v[72:75],v20 offset:10240
v_mfma_f32_16x16x32_bf16 v[204:207],v[76:79],a[140:143],v[204:207]
s_waitcnt lgkmcnt(2)
v_mfma_f32_16x16x32_bf16 v[192:195],a[16:19],v[64:67],v[192:195]
ds_read_b128 v[76:79],v20 offset:11264
v_mfma_f32_16x16x32_bf16 v[200:203],v[64:67],a[144:147],v[200:203]
s_waitcnt lgkmcnt(2)
v_mfma_f32_16x16x32_bf16 v[196:199],a[16:19],v[68:71],v[196:199]
ds_read_b128 v[64:67],v20 offset:12288
v_mfma_f32_16x16x32_bf16 v[204:207],v[68:71],a[144:147],v[204:207]
s_waitcnt lgkmcnt(2)
v_mfma_f32_16x16x32_bf16 v[192:195],a[20:23],v[72:75],v[192:195]
ds_read_b128 v[68:71],v20 offset:13312
v_mfma_f32_16x16x32_bf16 v[200:203],v[72:75],a[148:151],v[200:203]
s_waitcnt lgkmcnt(2)
v_mfma_f32_16x16x32_bf16 v[196:199],a[20:23],v[76:79],v[196:199]
ds_read_b128 v[72:75],v20 offset:14336
v_mfma_f32_16x16x32_bf16 v[204:207],v[76:79],a[148:151],v[204:207]
s_waitcnt lgkmcnt(2)
v_mfma_f32_16x16x32_bf16 v[192:195],a[24:27],v[64:67],v[192:195]
ds_read_b128 v[76:79],v20 offset:15360
v_mfma_f32_16x16x32_bf16 v[200:203],v[64:67],a[152:155],v[200:203]
s_waitcnt lgkmcnt(2)
v_mfma_f32_16x16x32_bf16 v[196:199],a[24:27],v[68:71],v[196:199]
ds_read_b128 v[64:67],v20 offset:16384
v_mfma_f32_16x16x32_bf16 v[204:207],v[68:71],a[152:155],v[204:207]
s_waitcnt lgkmcnt(2)
v_mfma_f32_16x16x32_bf16 v[192:195],a[28:31],v[72:75],v[192:195]
ds_read_b128 v[68:71],v20 offset:17408
v_mfma_f32_16x16x32_bf16 v[200:203],v[72:75],a[156:159],v[200:203]
s_waitcnt lgkmcnt(2)
v_mfma_f32_16x16x32_bf16 v[196:199],a[28:31],v[76:79],v[196:199]
ds_read_b128 v[72:75],v20 offset:18432
v_mfma_f32_16x16x32_bf16 v[204:207],v[76:79],a[156:159],v[204:207]
s_waitcnt lgkmcnt(2)
v_mfma_f32_16x16x32_bf16 v[192:195],a[32:35],v[64:67],v[192:195]
ds_read_b128 v[76:79],v20 offset:19456
v_mfma_f32_16x16x32_bf16 v[200:203],v[64:67],a[160:163],v[200:203]
s_waitcnt lgkmcnt(2)
v_mfma_f32_16x16x32_bf16 v[196:199],a[32:35],v[68:71],v[196:199]
ds_read_b128 v[64:67],v20 offset:20480
v_mfma_f32_16x16x32_bf16 v[204:207],v[68:71],a[160:163],v[204:207]
s_waitcnt lgkmcnt(2)
v_mfma_f32_16x16x32_bf16 v[192:195],a[36:39],v[72:75],v[192:195]
ds_read_b128 v[68:71],v20 offset:21504
v_mfma_f32_16x16x32_bf16 v[200:203],v[72:75],a[164:167],v[200:203]
s_waitcnt lgkmcnt(2)
v_mfma_f32_16x16x32_bf16 v[196:199],a[36:39],v[76:79],v[196:199]
ds_read_b128 v[72:75],v20 offset:22528
v_mfma_f32_16x16x32_bf16 v[204:207],v[76:79],a[164:167],v[204:207]
s_waitcnt lgkmcnt(2)
v_mfma_f32_16x16x32_bf16 v[192:195],a[40:43],v[64:67],v[192:195]
ds_read_b128 v[76:79],v20 offset:23552
v_mfma_f32_16x16x32_bf16 v[200:203],v[64:67],a[168:171],v[200:203]
s_waitcnt lgkmcnt(2)
v_mfma_f32_16x16x32_bf16 v[196:199],a[40:43],v[68:71],v[196:199]
ds_read_b128 v[64:67],v20 offset:24576
v_mfma_f32_16x16x32_bf16 v[204:207],v[68:71],a[168:171],v[204:207]
s_waitcnt lgkmcnt(2)
v_mfma_f32_16x16x32_bf16 v[192:195],a[44:47],v[72:75],v[192:195]
ds_read_b128 v[68:71],v20 offset:25600
v_mfma_f32_16x16x32_bf16 v[200:203],v[72:75],a[172:175],v[200:203]
s_waitcnt lgkmcnt(2)
v_mfma_f32_16x16x32_bf16 v[196:199],a[44:47],v[76:79],v[196:199]
ds_read_b128 v[72:75],v20 offset:26624
v_mfma_f32_16x16x32_bf16 v[204:207],v[76:79],a[172:175],v[204:207]
s_waitcnt lgkmcnt(2)
v_mfma_f32_16x16x32_bf16 v[192:195],a[48:51],v[64:67],v[192:195]
ds_read_b128 v[76:79],v20 offset:27648
v_mfma_f32_16x16x32_bf16 v[200:203],v[64:67],a[176:179],v[200:203]
s_waitcnt lgkmcnt(2)
v_mfma_f32_16x16x32_bf16 v[196:199],a[48:51],v[68:71],v[196:199]
ds_read_b128 v[64:67],v20 offset:28672
v_mfma_f32_16x16x32_bf16 v[204:207],v[68:71],a[176:179],v[204:207]
s_waitcnt lgkmcnt(2)
v_mfma_f32_16x16x32_bf16 v[192:195],a[52:55],v[72:75],v[192:195]
ds_read_b128 v[68:71],v20 offset:29696
v_mfma_f32_16x16x32_bf16 v[200:203],v[72:75],a[180:183],v[200:203]
s_waitcnt lgkmcnt(2)
v_mfma_f32_16x16x32_bf16 v[196:199],a[52:55],v[76:79],v[196:199]
ds_read_b128 v[72:75],v20 offset:30720
v_mfma_f32_16x16x32_bf16 v[204:207],v[76:79],a[180:183],v[204:207]
s_waitcnt lgkmcnt(2)
v_mfma_f32_16x16x32_bf16 v[192:195],a[56:59],v[64:67],v[192:195]
ds_read_b128 v[76:79],v20 offset:31744
v_mfma_f32_16x16x32_bf16 v[200:203],v[64:67],a[184:187],v[200:203]
s_waitcnt lgkmcnt(2)
v_mfma_f32_16x16x32_bf16 v[196:199],a[56:59],v[68:71],v[196:199]
ds_read_b128 v[64:67],v20 offset:32768
v_mfma_f32_16x16x32_bf16 v[204:207],v[68:71],a[184:187],v[204:207]
s_waitcnt lgkmcnt(2)
v_mfma_f32_16x16x32_bf16 v[192:195],a[60:63],v[72:75],v[192:195]
ds_read_b128 v[68:71],v20 offset:33792
v_mfma_f32_16x16x32_bf16 v[200:203],v[72:75],a[188:191],v[200:203]
s_waitcnt lgkmcnt(2)
v_mfma_f32_16x16x32_bf16 v[196:199],a[60:63],v[76:79],v[196:199]
ds_read_b128 v[72:75],v20 offset:34816
v_mfma_f32_16x16x32_bf16 v[204:207],v[76:79],a[188:191],v[204:207]
s_waitcnt lgkmcnt(2)
v_mfma_f32_16x16x32_bf16 v[192:195],a[64:67],v[64:67],v[192:195]
ds_read_b128 v[76:79],v20 offset:35840
v_mfma_f32_16x16x32_bf16 v[200:203],v[64:67],a[192:195],v[200:203]
s_waitcnt lgkmcnt(2)
v_mfma_f32_16x16x32_bf16 v[196:199],a[64:67],v[68:71],v[196:199]
ds_read_b128 v[64:67],v20 offset:36864
v_mfma_f32_16x16x32_bf16 v[204:207],v[68:71],a[192:195],v[204:207]
s_waitcnt lgkmcnt(2)
v_mfma_f32_16x16x32_bf16 v[192:195],a[68:71],v[72:75],v[192:195]
ds_read_b128 v[68:71],v20 offset:37888
v_mfma_f32_16x16x32_bf16 v[200:203],v[72:75],a[196:199],v[200:203]
s_waitcnt lgkmcnt(2)
v_mfma_f32_16x16x32_bf16 v[196:199],a[68:71],v[76:79],v[196:199]
ds_read_b128 v[72:75],v20 offset:38912
v_mfma_f32_16x16x32_bf16 v[204:207],v[76:79],a[196:199],v[204:207]
s_waitcnt lgkmcnt(2)
v_mfma_f32_16x16x32_bf16 v[192:195],a[72:75],v[64:67],v[192:195]
ds_read_b128 v[76:79],v20 offset:39936
v_mfma_f32_16x16x32_bf16 v[200:203],v[64:67],a[200:203],v[200:203]
s_waitcnt lgkmcnt(2)
v_mfma_f32_16x16x32_bf16 v[196:199],a[72:75],v[68:71],v[196:199]
ds_read_b128 v[64:67],v20 offset:40960
v_mfma_f32_16x16x32_bf16 v[204:207],v[68:71],a[200:203],v[204:207]
s_waitcnt lgkmcnt(2)
v_mfma_f32_16x16x32_bf16 v[192:195],a[76:79],v[72:75],v[192:195]
ds_read_b128 v[68:71],v20 offset:41984
v_mfma_f32_16x16x32_bf16 v[200:203],v[72:75],a[204:207],v[200:203]
s_waitcnt lgkmcnt(2)
v_mfma_f32_16x16x32_bf16 v[196:199],a[76:79],v[76:79],v[196:199]
ds_read_b128 v[72:75],v20 offset:43008
v_mfma_f32_16x16x32_bf16 v[204:207],v[76:79],a[204:207],v[204:207]
s_waitcnt lgkmcnt(2)
v_mfma_f32_16x16x32_bf16 v[192:195],a[80:83],v[64:67],v[192:195]
ds_read_b128 v[76:79],v20 offset:44032
v_mfma_f32_16x16x32_bf16 v[200:203],v[64:67],a[208:211],v[200:203]
s_waitcnt lgkmcnt(2)
v_mfma_f32_16x16x32_bf16 v[196:199],a[80:83],v[68:71],v[196:199]
ds_read_b128 v[64:67],v20 offset:45056
v_mfma_f32_16x16x32_bf16 v[204:207],v[68:71],a[208:211],v[204:207]
s_waitcnt lgkmcnt(2)
v_mfma_f32_16x16x32_bf16 v[192:195],a[84:87],v[72:75],v[192:195]
ds_read_b128 v[68:71],v20 offset:46080
v_mfma_f32_16x16x32_bf16 v[200:203],v[72:75],a[212:215],v[200:203]
s_waitcnt lgkmcnt(2)
v_mfma_f32_16x16x32_bf16 v[196:199],a[84:87],v[76:79],v[196:199]
ds_read_b128 v[72:75],v20 offset:47104
v_mfma_f32_16x16x32_bf16 v[204:207],v[76:79],a[212:215],v[204:207]
s_waitcnt lgkmcnt(2)
v_mfma_f32_16x16x32_bf16 v[192:195],a[88:91],v[64:67],v[192:195]
ds_read_b128 v[76:79],v20 offset:48128
v_mfma_f32_16x16x32_bf16 v[200:203],v[64:67],a[216:219],v[200:203]
s_waitcnt lgkmcnt(2)
v_mfma_f32_16x16x32_bf16 v[196:199],a[88:91],v[68:71],v[196:199]
ds_read_b128 v[64:67],v20 offset:49152
v_mfma_f32_16x16x32_bf16 v[204:207],v[68:71],a[216:219],v[204:207]
s_waitcnt lgkmcnt(2)
v_mfma_f32_16x16x32_bf16 v[192:195],a[92:95],v[72:75],v[192:195]
ds_read_b128 v[68:71],v20 offset:50176
v_mfma_f32_16x16x32_bf16 v[200:203],v[72:75],a[220:223],v[200:203]
s_waitcnt lgkmcnt(2)
v_mfma_f32_16x16x32_bf16 v[196:199],a[92:95],v[76:79],v[196:199]
ds_read_b128 v[72:75],v20 offset:51200
v_mfma_f32_16x16x32_bf16 v[204:207],v[76:79],a[220:223],v[204:207]
s_waitcnt lgkmcnt(2)
v_mfma_f32_16x16x32_bf16 v[192:195],a[96:99],v[64:67],v[192:195]
ds_read_b128 v[76:79],v20 offset:52224
v_mfma_f32_16x16x32_bf16 v[200:203],v[64:67],a[224:227],v[200:203]
s_waitcnt lgkmcnt(2)
v_mfma_f32_16x16x32_bf16 v[196:199],a[96:99],v[68:71],v[196:199]
ds_read_b128 v[64:67],v20 offset:53248
v_mfma_f32_16x16x32_bf16 v[204:207],v[68:71],a[224:227],v[204:207]
s_waitcnt lgkmcnt(2)
v_mfma_f32_16x16x32_bf16 v[192:195],a[100:103],v[72:75],v[192:195]
ds_read_b128 v[68:71],v20 offset:54272
v_mfma_f32_16x16x32_bf16 v[200:203],v[72:75],a[228:231],v[200:203]
s_waitcnt lgkmcnt(2)
v_mfma_f32_16x16x32_bf16 v[196:199],a[100:103],v[76:79],v[196:199]
ds_read_b128 v[72:75],v20 offset:55296
v_mfma_f32_16x16x32_bf16 v[204:207],v[76:79],a[228:231],v[204:207]
s_waitcnt lgkmcnt(2)
v_mfma_f32_16x16x32_bf16 v[192:195],a[104:107],v[64:67],v[192:195]
ds_read_b128 v[76:79],v20 offset:56320
v_mfma_f32_16x16x32_bf16 v[200:203],v[64:67],a[232:235],v[200:203]
s_waitcnt lgkmcnt(2)
v_mfma_f32_16x16x32_bf16 v[196:199],a[104:107],v[68:71],v[196:199]
ds_read_b128 v[64:67],v20 offset:57344
v_mfma_f32_16x16x32_bf16 v[204:207],v[68:71],a[232:235],v[204:207]
s_waitcnt lgkmcnt(2)
v_mfma_f32_16x16x32_bf16 v[192:195],a[108:111],v[72:75],v[192:195]
ds_read_b128 v[68:71],v20 offset:58368
v_mfma_f32_16x16x32_bf16 v[200:203],v[72:75],a[236:239],v[200:203]
s_waitcnt lgkmcnt(2)
v_mfma_f32_16x16x32_bf16 v[196:199],a[108:111],v[76:79],v[196:199]
ds_read_b128 v[72:75],v20 offset:59392
v_mfma_f32_16x16x32_bf16 v[204:207],v[76:79],a[236:239],v[204:207]
s_waitcnt lgkmcnt(2)
v_mfma_f32_16x16x32_bf16 v[192:195],a[112:115],v[64:67],v[192:195]
ds_read_b128 v[76:79],v20 offset:60416
v_mfma_f32_16x16x32_bf16 v[200:203],v[64:67],a[240:243],v[200:203]
s_waitcnt lgkmcnt(2)
v_mfma_f32_16x16x32_bf16 v[196:199],a[112:115],v[68:71],v[196:199]
ds_read_b128 v[64:67],v20 offset:61440
v_mfma_f32_16x16x32_bf16 v[204:207],v[68:71],a[240:243],v[204:207]
s_waitcnt lgkmcnt(2)
v_mfma_f32_16x16x32_bf16 v[192:195],a[116:119],v[72:75],v[192:195]
ds_read_b128 v[68:71],v20 offset:62464
v_mfma_f32_16x16x32_bf16 v[200:203],v[72:75],a[244:247],v[200:203]
s_waitcnt lgkmcnt(2)
v_mfma_f32_16x16x32_bf16 v[196:199],a[116:119],v[76:79],v[196:199]
ds_read_b128 v[72:75],v20 offset:63488
v_mfma_f32_16x16x32_bf16 v[204:207],v[76:79],a[244:247],v[204:207]
s_waitcnt lgkmcnt(2)
v_mfma_f32_16x16x32_bf16 v[192:195],a[120:123],v[64:67],v[192:195]
ds_read_b128 v[76:79],v20 offset:64512
v_mfma_f32_16x16x32_bf16 v[200:203],v[64:67],a[248:251],v[200:203]
s_waitcnt lgkmcnt(2)
v_mfma_f32_16x16x32_bf16 v[196:199],a[120:123],v[68:71],v[196:199]
v_mfma_f32_16x16x32_bf16 v[204:207],v[68:71],a[248:251],v[204:207]
s_waitcnt lgkmcnt(1)
v_mfma_f32_16x16x32_bf16 v[192:195],a[124:127],v[72:75],v[192:195]
v_mfma_f32_16x16x32_bf16 v[200:203],v[72:75],a[252:255],v[200:203]
s_waitcnt lgkmcnt(0)
v_mfma_f32_16x16x32_bf16 v[196:199],a[124:127],v[76:79],v[196:199]
v_mfma_f32_16x16x32_bf16 v[204:207],v[76:79],a[252:255],v[204:207]
v_xor_b32 v20,0x10000,v20
s_xor_b32 s62,s62,0x10000
s_lshr_b32 s64,s73,9
v_add_u32 v22,s64,v24
v_cvt_pk_bf16_f32 v208,v192,v193
v_cvt_pk_bf16_f32 v209,v194,v195
s_nop 0
v_cvt_pk_bf16_f32 v210,v196,v197
v_cvt_pk_bf16_f32 v211,v198,v199
v_cvt_pk_bf16_f32 v212,v200,v201
v_cvt_pk_bf16_f32 v213,v202,v203
v_cvt_pk_bf16_f32 v214,v204,v205
v_cvt_pk_bf16_f32 v215,v206,v207
v_permlane16_swap_b32 v208,v210
v_permlane16_swap_b32 v209,v211
buffer_store_dwordx4 v[208:211],v2,s[24:27],s73 offen
buffer_store_dwordx4 v[208:211],v2,s[28:31],s73 offen sc1
ds_write_b128 v22,v[212:215] offset:17408
buffer_store_dwordx4 v[208:211],v17,s[20:23],s12 offen sc1
bgx_150:
s_add_u32 s63,s79,1
s_and_b32 s64,s63,3
s_lshl_b32 s70,s64,20
s_add_u32 s65,s63,2
s_and_b32 s65,s65,3
s_lshl_b32 s73,s65,20
s_add_u32 s55,s63,3
s_lshl_b32 s78,s55,16
s_add_u32 s78,s78,57344
s_cmp_lt_u32 s55,64
s_cselect_b32 s78,s78,0x7fff0000
s_add_u32 s60,s63,1
s_lshl_b32 s76,s60,21
s_lshl_b32 s55,s60,13
s_and_b32 s55,s55,0x2000
s_xor_b32 s55,s55,s61
s_add_u32 s76,s76,s55
s_cmp_lt_u32 s60,64
s_cselect_b32 s76,s76,0x7fff0000
s_add_u32 s60,s63,2
s_lshl_b32 s12,s60,21
s_lshl_b32 s55,s60,13
s_and_b32 s55,s55,0x2000
s_xor_b32 s55,s55,s61
s_add_u32 s12,s12,s55
s_cmp_lt_u32 s60,64
s_cselect_b32 s12,s12,0x7fff0000
s_add_u32 s55,s63,5
s_min_u32 s55,s55,63
s_lshl_b32 s55,s55,16
s_lshl_b32 s60,s59,11
s_add_u32 s80,s55,s60
s_add_u32 s80,s80,57344
v_mov_b32 v176,0
v_mov_b32 v177,0
v_mov_b32 v178,0
v_mov_b32 v179,0
v_mov_b32 v180,0
v_mov_b32 v181,0
v_mov_b32 v182,0
v_mov_b32 v183,0
s_add_u32 s79,s79,1
s_cmp_eq_u32 s79,0
s_cbranch_scc1 pn2_149
v_mov_b32 v38,1
ds_write_b32 v37,v38 offset:12
buffer_store_dwordx4 v[212:215],v12,s[20:23],s76 offen sc1
s_waitcnt lgkmcnt(0)
s_branch pn1_148
pn2_149:
v_mov_b32 v25,1
s_waitcnt vmcnt(1) lgkmcnt(0)
s_barrier
s_branch loop_136
w3_61:
v_xor_b32 v9,0x10000,v8
v_xor_b32 v10,0x20000,v8
v_xor_b32 v11,0x30000,v8
v_and_b32 v22,2,v4
v_lshrrev_b32 v23,3,v3
v_add_u32 v22,v22,v23
v_lshlrev_b32 v22,3,v22
v_and_b32 v23,1,v4
v_lshl_add_u32 v22,v23,2,v22
v_and_b32 v23,3,v3
v_add_u32 v22,v22,v23
v_lshlrev_b32 v22,4,v22
v_bfe_u32 v23,v3,2,1
v_lshl_add_u32 v22,v23,3,v22
v_add_u32 v30,s66,v22
v_and_b32 v22,7,v3
v_lshl_add_u32 v12,v4,3,v22
v_lshlrev_b32 v12,4,v12
v_add_u32 v12,s66,v12
s_branch first_151
loop_152:
s_barrier
buffer_load_dword v248,v18,s[20:23],s70 offen offset:0 sc1
s_nop 15
s_nop 5
hl_154:
buffer_load_dword v249,v18,s[20:23],s70 offen offset:0 sc1
s_waitcnt vmcnt(1)
v_cmp_eq_u32 vcc,v25,v248
s_bcnt1_i32_b32 s64,vcc_lo
s_cmp_ge_u32 s64,8
s_cbranch_scc1 hg_155
buffer_load_dword v248,v18,s[20:23],s70 offen offset:0 sc1
s_waitcnt vmcnt(1)
v_cmp_eq_u32 vcc,v25,v249
s_bcnt1_i32_b32 s64,vcc_lo
s_cmp_ge_u32 s64,8
s_cbranch_scc1 hg_155
s_sub_u32 s90,s90,1
s_cmp_gt_i32 s90,0
s_cbranch_scc1 hl_154
hg_155:
buffer_load_dwordx4 v[80:83],v29,s[20:23],s70 offen offset:0 sc1
buffer_load_dwordx4 v[84:87],v29,s[20:23],s70 offen offset:1024 sc1
buffer_load_dwordx4 v[88:91],v29,s[20:23],s70 offen offset:2048 sc1
buffer_load_dwordx4 v[92:95],v29,s[20:23],s70 offen offset:3072 sc1
s_waitcnt vmcnt(3)
ds_write_b128 v24,v[80:83] offset:12288
v_min3_u32 v22,v80,v81,v82
v_min_u32 v22,v22,v83
s_waitcnt vmcnt(2)
ds_write_b128 v24,v[84:87] offset:13312
v_min3_u32 v22,v22,v84,v85
v_min3_u32 v22,v22,v86,v87
s_waitcnt vmcnt(1)
ds_write_b128 v24,v[88:91] offset:14336
v_min3_u32 v22,v22,v88,v89
v_min3_u32 v22,v22,v90,v91
s_waitcnt vmcnt(0)
ds_write_b128 v24,v[92:95] offset:15360
v_min3_u32 v22,v22,v92,v93
v_min3_u32 v22,v22,v94,v95
v_cmp_eq_u32 vcc,0,v22
s_cbranch_vccnz art_156
abk_157:
v_smfmac_f32_16x16x64_bf16 v[176:179],v[80:83],a[96:103],v14
s_waitcnt lgkmcnt(0)
s_barrier
ds_read_b128 v[32:35],v24 offset:0
ds_read_b128 v[36:39],v24 offset:1024
ds_read_b128 v[40:43],v24 offset:2048
ds_read_b128 v[44:47],v24 offset:3072
v_smfmac_f32_16x16x64_bf16 v[176:179],v[84:87],a[104:111],v14
ds_read_b128 v[48:51],v24 offset:4096
ds_read_b128 v[52:55],v24 offset:5120
v_smfmac_f32_16x16x64_bf16 v[176:179],v[88:91],a[112:119],v14
ds_read_b128 v[56:59],v24 offset:6144
ds_read_b128 v[60:63],v24 offset:7168
v_smfmac_f32_16x16x64_bf16 v[176:179],v[92:95],a[120:127],v14
ds_read_b128 v[64:67],v24 offset:8192
ds_read_b128 v[68:71],v24 offset:9216
s_waitcnt lgkmcnt(9)
v_smfmac_f32_16x16x64_bf16 v[176:179],v[32:35],a[0:7],v14
ds_read_b128 v[72:75],v24 offset:10240
s_waitcnt lgkmcnt(9)
v_smfmac_f32_16x16x64_bf16 v[176:179],v[36:39],a[8:15],v14
ds_read_b128 v[76:79],v24 offset:11264
s_waitcnt lgkmcnt(9)
v_smfmac_f32_16x16x64_bf16 v[176:179],v[40:43],a[16:23],v14
s_waitcnt lgkmcnt(8)
v_smfmac_f32_16x16x64_bf16 v[176:179],v[44:47],a[24:31],v14
s_waitcnt lgkmcnt(7)
v_smfmac_f32_16x16x64_bf16 v[176:179],v[48:51],a[32:39],v14
s_waitcnt lgkmcnt(6)
v_smfmac_f32_16x16x64_bf16 v[176:179],v[52:55],a[40:47],v14
s_waitcnt lgkmcnt(5)
v_smfmac_f32_16x16x64_bf16 v[176:179],v[56:59],a[48:55],v14
s_waitcnt lgkmcnt(4)
v_smfmac_f32_16x16x64_bf16 v[176:179],v[60:63],a[56:63],v14
s_waitcnt lgkmcnt(3)
v_smfmac_f32_16x16x64_bf16 v[176:179],v[64:67],a[64:71],v14
s_waitcnt lgkmcnt(2)
v_smfmac_f32_16x16x64_bf16 v[176:179],v[68:71],a[72:79],v14
s_waitcnt lgkmcnt(1)
v_smfmac_f32_16x16x64_bf16 v[176:179],v[72:75],a[80:87],v14
s_waitcnt lgkmcnt(0)
v_smfmac_f32_16x16x64_bf16 v[176:179],v[76:79],a[88:95],v14
s_nop 7
v_permlane32_swap_b32 v176,v178
v_permlane32_swap_b32 v177,v179
v_add_f32 v176,v176,v178
v_add_f32 v177,v177,v179
v_cvt_pk_bf16_f32 v216,v176,v177
s_nop 1
v_mov_b32_dpp v217,v216 quad_perm:[1,0,3,2] row_mask:0xf bank_mask:0xf
v_perm_b32 v216,v217,v216,v15
v_max_u32 v216,1,v216
buffer_store_dword v216,v19,s[24:27],s70 offen
buffer_store_dword v216,v19,s[28:31],s70 offen sc1
s_cmp_eq_u32 s79,63
s_cbranch_scc1 end_57
s_nop 15
s_nop 15
s_nop 15
s_nop 15
s_nop 10
s_add_u32 m0,s62,53248
s_add_u32 s69,s78,53248
buffer_load_dwordx4 v16,s[20:23],s69 offen offset:0 lds
s_nop 3
buffer_load_dwordx4 v16,s[20:23],s69 offen offset:1024 lds
s_nop 3
buffer_load_dwordx4 v16,s[20:23],s69 offen offset:2048 lds
s_nop 3
buffer_load_dwordx4 v16,s[20:23],s69 offen offset:3072 lds
s_nop 3
s_add_u32 m0,s62,57344
s_add_u32 s69,s78,57344
buffer_load_dwordx4 v16,s[20:23],s69 offen offset:0 lds
s_nop 3
buffer_load_dwordx4 v16,s[20:23],s69 offen offset:1024 lds
s_nop 3
buffer_load_dwordx4 v16,s[20:23],s69 offen offset:2048 lds
s_nop 3
buffer_load_dwordx4 v16,s[20:23],s69 offen offset:3072 lds
s_nop 3
s_add_u32 m0,s62,61440
s_add_u32 s69,s78,61440
buffer_load_dwordx4 v16,s[20:23],s69 offen offset:0 lds
s_nop 3
buffer_load_dwordx4 v16,s[20:23],s69 offen offset:1024 lds
s_nop 3
buffer_load_dwordx4 v16,s[20:23],s69 offen offset:2048 lds
s_nop 3
buffer_load_dwordx4 v16,s[20:23],s69 offen offset:3072 lds
s_nop 3
s_xor_b32 s62,s62,0x10000
wf_158:
ds_read_b32 v23,v21 offset:8
s_sub_u32 s90,s90,1
s_waitcnt lgkmcnt(0)
v_cmp_ne_u32 vcc,v23,v25
s_cmp_lt_i32 s90,0
s_cselect_b64 vcc,0,vcc
s_cbranch_vccnz wf_158
hl_159:
buffer_load_dword v248,v18,s[20:23],s70 offen offset:512 sc1
s_waitcnt vmcnt(0)
v_cmp_eq_u32 vcc,v25,v248
s_bcnt1_i32_b32 s64,vcc_lo
s_cmp_ge_u32 s64,16
s_cbranch_scc1 hg_160
s_sub_u32 s90,s90,1
s_cmp_gt_i32 s90,0
s_cbranch_scc1 hl_159
hg_160:
buffer_load_dwordx4 v[32:35],v28,s[20:23],s71 offen offset:0 sc1
buffer_load_dwordx4 v[36:39],v28,s[20:23],s71 offen offset:1024 sc1
buffer_load_dwordx4 v[40:43],v28,s[20:23],s71 offen offset:2048 sc1
buffer_load_dwordx4 v[44:47],v28,s[20:23],s71 offen offset:3072 sc1
buffer_load_dwordx4 v[48:51],v29,s[20:23],s71 offen offset:0 sc1
buffer_load_dwordx4 v[52:55],v29,s[20:23],s71 offen offset:1024 sc1
buffer_load_dwordx4 v[56:59],v29,s[20:23],s71 offen offset:2048 sc1
buffer_load_dwordx4 v[60:63],v29,s[20:23],s71 offen offset:3072 sc1
s_mov_b32 s68,0
s_waitcnt vmcnt(6)
v_smfmac_f32_16x16x64_bf16 v[184:187],v[32:35],a[128:135],v14
v_min3_u32 v22,v32,v33,v34
v_min3_u32 v22,v22,v35,v36
v_smfmac_f32_16x16x64_bf16 v[188:191],v[32:35],a[136:143],v14
v_min3_u32 v22,v22,v37,v38
v_smfmac_f32_16x16x64_bf16 v[184:187],v[36:39],a[144:151],v14
v_min_u32 v22,v22,v39
v_smfmac_f32_16x16x64_bf16 v[188:191],v[36:39],a[152:159],v14
v_cmp_eq_u32 s[52:53],0,v22
s_waitcnt vmcnt(4)
v_smfmac_f32_16x16x64_bf16 v[184:187],v[40:43],a[160:167],v14
v_min3_u32 v22,v40,v41,v42
s_cmp_lg_u64 s[52:53],0
v_smfmac_f32_16x16x64_bf16 v[188:191],v[40:43],a[168:175],v14
s_cbranch_scc1 ms_161
bk_162:
v_min3_u32 v22,v22,v43,v44
v_smfmac_f32_16x16x64_bf16 v[184:187],v[44:47],a[176:183],v14
v_min3_u32 v22,v22,v45,v46
v_min_u32 v22,v22,v47
v_smfmac_f32_16x16x64_bf16 v[188:191],v[44:47],a[184:191],v14
v_cmp_eq_u32 s[54:55],0,v22
s_waitcnt vmcnt(2)
v_smfmac_f32_16x16x64_bf16 v[184:187],v[48:51],a[192:199],v14
v_min3_u32 v22,v48,v49,v50
s_cmp_lg_u64 s[54:55],0
v_smfmac_f32_16x16x64_bf16 v[188:191],v[48:51],a[200:207],v14
s_cbranch_scc1 ms_163
bk_164:
v_min3_u32 v22,v22,v51,v52
v_smfmac_f32_16x16x64_bf16 v[184:187],v[52:55],a[208:215],v14
v_min3_u32 v22,v22,v53,v54
v_min_u32 v22,v22,v55
v_smfmac_f32_16x16x64_bf16 v[188:191],v[52:55],a[216:223],v14
v_cmp_eq_u32 s[52:53],0,v22
s_waitcnt vmcnt(0)
v_smfmac_f32_16x16x64_bf16 v[184:187],v[56:59],a[224:231],v14
v_min3_u32 v22,v56,v57,v58
s_cmp_lg_u64 s[52:53],0
v_smfmac_f32_16x16x64_bf16 v[188:191],v[56:59],a[232:239],v14
s_cbranch_scc1 ms_165
bk_166:
v_min3_u32 v22,v22,v59,v60
v_smfmac_f32_16x16x64_bf16 v[184:187],v[60:63],a[240:247],v14
v_min3_u32 v22,v22,v61,v62
v_min_u32 v22,v22,v63
v_smfmac_f32_16x16x64_bf16 v[188:191],v[60:63],a[248:255],v14
v_cmp_eq_u32 s[54:55],0,v22
s_cmp_lg_u64 s[54:55],0
s_cbranch_scc1 ms_169
bk_170:
s_cmp_lg_u32 s68,0
s_cbranch_scc1 rl2_171
fin_167:
s_nop 2
v_permlane32_swap_b32 v184,v188
v_permlane32_swap_b32 v185,v189
v_permlane32_swap_b32 v186,v190
v_permlane32_swap_b32 v187,v191
v_pk_add_f32 v[184:185],v[184:185],v[188:189]
v_pk_add_f32 v[186:187],v[186:187],v[190:191]
wf_172:
ds_read_b32 v23,v21 offset:12
ds_read_b128 v[216:219],v24 offset:25600
s_sub_u32 s90,s90,1
s_waitcnt lgkmcnt(0)
v_cmp_ne_u32 vcc,v23,v25
s_cmp_lt_i32 s90,0
s_cselect_b64 vcc,0,vcc
v_pk_add_f32 v[216:217],v[216:217],v[184:185]
v_pk_add_f32 v[218:219],v[218:219],v[186:187]
s_cbranch_vccnz wf_172
v_max_u32 v216,1,v216
v_max_u32 v217,1,v217
v_max_u32 v218,1,v218
v_max_u32 v219,1,v219
buffer_store_dwordx4 v[216:219],v8,s[20:23],s74 offen sc1
s_mov_b32 s88,s74
s_mov_b32 s89,s72
v_add_u32 v25,1,v25
s_add_u32 s63,s79,1
s_and_b32 s64,s63,3
s_lshl_b32 s70,s64,20
s_add_u32 s65,s63,2
s_and_b32 s65,s65,3
s_lshl_b32 s73,s65,20
s_add_u32 s55,s63,3
s_lshl_b32 s78,s55,16
s_add_u32 s78,s78,57344
s_cmp_lt_u32 s55,64
s_cselect_b32 s78,s78,0x7fff0000
s_add_u32 s71,s70,65536
s_add_u32 s60,s63,1
s_and_b32 s60,s60,3
s_lshl_b32 s72,s60,20
v_mov_b32 v184,0
v_mov_b32 v185,0
v_mov_b32 v186,0
v_mov_b32 v187,0
v_mov_b32 v188,0
v_mov_b32 v189,0
v_mov_b32 v190,0
v_mov_b32 v191,0
s_lshl_b32 s74,s63,21
s_lshl_b32 s55,s63,13
s_and_b32 s55,s55,0x2000
s_xor_b32 s55,s55,s61
s_add_u32 s74,s74,s55
v_mov_b32 v176,0
v_mov_b32 v177,0
v_mov_b32 v178,0
v_mov_b32 v179,0
s_nop 15
s_nop 15
s_nop 15
s_nop 15
s_nop 5
pp_173:
buffer_load_dwordx4 v[32:35],v9,s[20:23],s88 offen sc1
buffer_load_dwordx4 v[36:39],v10,s[20:23],s88 offen sc1
buffer_load_dwordx4 v[40:43],v11,s[20:23],s88 offen sc1
s_waitcnt vmcnt(2)
v_min3_u32 v22,v32,v33,v34
v_pk_add_f32 v[220:221],v[216:217],v[32:33]
v_pk_add_f32 v[222:223],v[218:219],v[34:35]
s_waitcnt vmcnt(0)
v_min3_u32 v22,v22,v35,v36
v_min3_u32 v22,v22,v37,v38
v_min3_u32 v22,v22,v39,v40
v_min3_u32 v22,v22,v41,v42
v_min_u32 v22,v22,v43
v_pk_add_f32 v[36:37],v[36:37],v[40:41]
v_cmp_eq_u32 vcc,0,v22
v_pk_add_f32 v[38:39],v[38:39],v[42:43]
s_cbranch_vccz pok_174
s_sub_u32 s90,s90,1
s_cmp_gt_i32 s90,0
s_cbranch_scc1 pp_173
pok_174:
v_pk_add_f32 v[220:221],v[220:221],v[36:37]
v_pk_add_f32 v[222:223],v[222:223],v[38:39]
s_mov_b64 vcc,s[86:87]
v_cvt_pk_bf16_f32 v216,v220,v221
v_cvt_pk_bf16_f32 v217,v222,v223
s_nop 0
v_mov_b32_dpp v218,v216 quad_perm:[1,0,3,2] row_mask:0xf bank_mask:0xf
v_mov_b32_dpp v219,v217 quad_perm:[1,0,3,2] row_mask:0xf bank_mask:0xf
v_perm_b32 v216,v218,v216,v15
v_perm_b32 v217,v219,v217,v15
s_nop 1
v_cndmask_b32_dpp v220,v217,v216,vcc quad_perm:[2,3,0,1] row_mask:0xf bank_mask:0xf
s_not_b64 vcc,vcc
v_cndmask_b32_dpp v221,v216,v217,vcc quad_perm:[2,3,0,1] row_mask:0xf bank_mask:0xf
v_max_u32 v220,1,v220
v_max_u32 v221,1,v221
buffer_store_dwordx2 v[220:221],v30,s[24:27],s89 offen
buffer_store_dwordx2 v[220:221],v30,s[28:31],s89 offen sc1
s_mov_b64 exec,1
buffer_store_dword v25,v13,s[24:27],s89 offen
buffer_store_dword v25,v13,s[28:31],s89 offen sc1
s_mov_b64 exec,-1
s_add_u32 s79,s79,1
s_branch loop_152
art_156:
s_sub_u32 s90,s90,1
s_cmp_lt_i32 s90,0
s_cbranch_scc1 abk_157
buffer_load_dwordx4 v[80:83],v29,s[20:23],s70 offen offset:0 sc1
buffer_load_dwordx4 v[84:87],v29,s[20:23],s70 offen offset:1024 sc1
buffer_load_dwordx4 v[88:91],v29,s[20:23],s70 offen offset:2048 sc1
buffer_load_dwordx4 v[92:95],v29,s[20:23],s70 offen offset:3072 sc1
s_waitcnt vmcnt(3)
ds_write_b128 v24,v[80:83] offset:12288
v_min3_u32 v22,v80,v81,v82
v_min_u32 v22,v22,v83
s_waitcnt vmcnt(2)
ds_write_b128 v24,v[84:87] offset:13312
v_min3_u32 v22,v22,v84,v85
v_min3_u32 v22,v22,v86,v87
s_waitcnt vmcnt(1)
ds_write_b128 v24,v[88:91] offset:14336
v_min3_u32 v22,v22,v88,v89
v_min3_u32 v22,v22,v90,v91
s_waitcnt vmcnt(0)
ds_write_b128 v24,v[92:95] offset:15360
v_min3_u32 v22,v22,v92,v93
v_min3_u32 v22,v22,v94,v95
v_cmp_eq_u32 vcc,0,v22
s_cbranch_vccnz art_156
s_branch abk_157
ms_161:
s_waitcnt vmcnt(0)
buffer_load_dwordx4 v[64:67],v28,s[20:23],s71 offen offset:0 sc1
buffer_load_dwordx4 v[68:71],v28,s[20:23],s71 offen offset:1024 sc1
s_bitset1_b32 s68,0
s_branch bk_162
ms_163:
s_waitcnt vmcnt(0)
buffer_load_dwordx4 v[72:75],v28,s[20:23],s71 offen offset:2048 sc1
buffer_load_dwordx4 v[76:79],v28,s[20:23],s71 offen offset:3072 sc1
s_bitset1_b32 s68,1
s_branch bk_164
ms_165:
s_waitcnt vmcnt(0)
buffer_load_dwordx4 v[80:83],v29,s[20:23],s71 offen offset:0 sc1
buffer_load_dwordx4 v[84:87],v29,s[20:23],s71 offen offset:1024 sc1
s_bitset1_b32 s68,2
s_branch bk_166
ms_169:
s_waitcnt vmcnt(0)
buffer_load_dwordx4 v[88:91],v29,s[20:23],s71 offen offset:2048 sc1
buffer_load_dwordx4 v[92:95],v29,s[20:23],s71 offen offset:3072 sc1
s_bitset1_b32 s68,3
s_branch bk_170
rl_168:
s_bitcmp1_b32 s68,0
s_cbranch_scc0 sk_175
buffer_load_dwordx4 v[64:67],v28,s[20:23],s71 offen offset:0 sc1
buffer_load_dwordx4 v[68:71],v28,s[20:23],s71 offen offset:1024 sc1
sk_175:
s_bitcmp1_b32 s68,1
s_cbranch_scc0 sk_176
buffer_load_dwordx4 v[72:75],v28,s[20:23],s71 offen offset:2048 sc1
buffer_load_dwordx4 v[76:79],v28,s[20:23],s71 offen offset:3072 sc1
sk_176:
s_bitcmp1_b32 s68,2
s_cbranch_scc0 sk_177
buffer_load_dwordx4 v[80:83],v29,s[20:23],s71 offen offset:0 sc1
buffer_load_dwordx4 v[84:87],v29,s[20:23],s71 offen offset:1024 sc1
sk_177:
s_bitcmp1_b32 s68,3
s_cbranch_scc0 sk_178
buffer_load_dwordx4 v[88:91],v29,s[20:23],s71 offen offset:2048 sc1
buffer_load_dwordx4 v[92:95],v29,s[20:23],s71 offen offset:3072 sc1
sk_178:
rl2_171:
s_sub_u32 s90,s90,1
s_cmp_lt_i32 s90,0
s_cbranch_scc1 fin_167
s_waitcnt vmcnt(0)
s_bitcmp1_b32 s68,0
s_cbranch_scc0 sk_179
v_min3_u32 v22,v64,v65,v66
v_min3_u32 v22,v22,v67,v68
v_min3_u32 v22,v22,v69,v70
v_min_u32 v22,v22,v71
v_cmp_eq_u32 vcc,0,v22
v_xor_b32 v64,v32,v64
v_xor_b32 v65,v33,v65
v_xor_b32 v66,v34,v66
v_xor_b32 v67,v35,v67
v_xor_b32 v68,v36,v68
v_xor_b32 v69,v37,v69
v_xor_b32 v70,v38,v70
v_xor_b32 v71,v39,v71
s_cbranch_vccnz nb_180
s_bitset0_b32 s68,0
v_smfmac_f32_16x16x64_bf16 v[184:187],v[64:67],a[128:135],v14
v_smfmac_f32_16x16x64_bf16 v[188:191],v[64:67],a[136:143],v14
v_smfmac_f32_16x16x64_bf16 v[184:187],v[68:71],a[144:151],v14
v_smfmac_f32_16x16x64_bf16 v[188:191],v[68:71],a[152:159],v14
nb_180:
sk_179:
s_bitcmp1_b32 s68,1
s_cbranch_scc0 sk_181
v_min3_u32 v22,v72,v73,v74
v_min3_u32 v22,v22,v75,v76
v_min3_u32 v22,v22,v77,v78
v_min_u32 v22,v22,v79
v_cmp_eq_u32 vcc,0,v22
v_xor_b32 v72,v40,v72
v_xor_b32 v73,v41,v73
v_xor_b32 v74,v42,v74
v_xor_b32 v75,v43,v75
v_xor_b32 v76,v44,v76
v_xor_b32 v77,v45,v77
v_xor_b32 v78,v46,v78
v_xor_b32 v79,v47,v79
s_cbranch_vccnz nb_182
s_bitset0_b32 s68,1
v_smfmac_f32_16x16x64_bf16 v[184:187],v[72:75],a[160:167],v14
v_smfmac_f32_16x16x64_bf16 v[188:191],v[72:75],a[168:175],v14
v_smfmac_f32_16x16x64_bf16 v[184:187],v[76:79],a[176:183],v14
v_smfmac_f32_16x16x64_bf16 v[188:191],v[76:79],a[184:191],v14
nb_182:
sk_181:
s_bitcmp1_b32 s68,2
s_cbranch_scc0 sk_183
v_min3_u32 v22,v80,v81,v82
v_min3_u32 v22,v22,v83,v84
v_min3_u32 v22,v22,v85,v86
v_min_u32 v22,v22,v87
v_cmp_eq_u32 vcc,0,v22
v_xor_b32 v80,v48,v80
v_xor_b32 v81,v49,v81
v_xor_b32 v82,v50,v82
v_xor_b32 v83,v51,v83
v_xor_b32 v84,v52,v84
v_xor_b32 v85,v53,v85
v_xor_b32 v86,v54,v86
v_xor_b32 v87,v55,v87
s_cbranch_vccnz nb_184
s_bitset0_b32 s68,2
v_smfmac_f32_16x16x64_bf16 v[184:187],v[80:83],a[192:199],v14
v_smfmac_f32_16x16x64_bf16 v[188:191],v[80:83],a[200:207],v14
v_smfmac_f32_16x16x64_bf16 v[184:187],v[84:87],a[208:215],v14
v_smfmac_f32_16x16x64_bf16 v[188:191],v[84:87],a[216:223],v14
nb_184:
sk_183:
s_bitcmp1_b32 s68,3
s_cbranch_scc0 sk_185
v_min3_u32 v22,v88,v89,v90
v_min3_u32 v22,v22,v91,v92
v_min3_u32 v22,v22,v93,v94
v_min_u32 v22,v22,v95
v_cmp_eq_u32 vcc,0,v22
v_xor_b32 v88,v56,v88
v_xor_b32 v89,v57,v89
v_xor_b32 v90,v58,v90
v_xor_b32 v91,v59,v91
v_xor_b32 v92,v60,v92
v_xor_b32 v93,v61,v93
v_xor_b32 v94,v62,v94
v_xor_b32 v95,v63,v95
s_cbranch_vccnz nb_186
s_bitset0_b32 s68,3
v_smfmac_f32_16x16x64_bf16 v[184:187],v[88:91],a[224:231],v14
v_smfmac_f32_16x16x64_bf16 v[188:191],v[88:91],a[232:239],v14
v_smfmac_f32_16x16x64_bf16 v[184:187],v[92:95],a[240:247],v14
v_smfmac_f32_16x16x64_bf16 v[188:191],v[92:95],a[248:255],v14
nb_186:
sk_185:
s_cmp_lg_u32 s68,0
s_cbranch_scc1 rl_168
s_nop 2
s_branch fin_167
first_151:
s_waitcnt vmcnt(0) lgkmcnt(0)
s_barrier
s_add_u32 s64,s15,393216
buffer_load_dwordx4 a[176:179],v32,s[40:43],s64 offen nt
s_add_u32 s64,s15,425984
buffer_load_dwordx4 a[180:183],v32,s[40:43],s64 offen nt
s_add_u32 s64,s15,458752
buffer_load_dwordx4 a[184:187],v32,s[40:43],s64 offen nt
s_add_u32 s64,s15,491520
buffer_load_dwordx4 a[188:191],v32,s[40:43],s64 offen nt
s_add_u32 s64,s15,524288
buffer_load_dwordx4 a[192:195],v32,s[40:43],s64 offen nt
s_add_u32 s64,s15,557056
buffer_load_dwordx4 a[196:199],v32,s[40:43],s64 offen nt
s_add_u32 s64,s15,589824
buffer_load_dwordx4 a[200:203],v32,s[40:43],s64 offen nt
s_add_u32 s64,s15,622592
buffer_load_dwordx4 a[204:207],v32,s[40:43],s64 offen nt
s_add_u32 s64,s15,655360
buffer_load_dwordx4 a[208:211],v32,s[40:43],s64 offen nt
s_add_u32 s64,s15,688128
buffer_load_dwordx4 a[212:215],v32,s[40:43],s64 offen nt
s_add_u32 s64,s15,720896
buffer_load_dwordx4 a[216:219],v32,s[40:43],s64 offen nt
s_add_u32 s64,s15,753664
buffer_load_dwordx4 a[220:223],v32,s[40:43],s64 offen nt
s_add_u32 s64,s15,786432
buffer_load_dwordx4 a[224:227],v32,s[40:43],s64 offen nt
s_add_u32 s64,s15,819200
buffer_load_dwordx4 a[228:231],v32,s[40:43],s64 offen nt
s_add_u32 s64,s15,851968
buffer_load_dwordx4 a[232:235],v32,s[40:43],s64 offen nt
s_add_u32 s64,s15,884736
buffer_load_dwordx4 a[236:239],v32,s[40:43],s64 offen nt
s_add_u32 s64,s15,917504
buffer_load_dwordx4 a[240:243],v32,s[40:43],s64 offen nt
s_add_u32 s64,s15,950272
buffer_load_dwordx4 a[244:247],v32,s[40:43],s64 offen nt
s_add_u32 s64,s15,983040
buffer_load_dwordx4 a[248:251],v32,s[40:43],s64 offen nt
s_add_u32 s64,s15,1015808
buffer_load_dwordx4 a[252:255],v32,s[40:43],s64 offen nt
ds_write_b128 v33,a[0:3] offset:0
ds_write_b128 v33,a[4:7] offset:1024
ds_write_b128 v33,a[8:11] offset:2048
ds_write_b128 v33,a[12:15] offset:3072
s_waitcnt lgkmcnt(0)
v_mov_b32 v38,1
ds_write_b32 v37,v38 offset:4
qs_187:
ds_read_b32 v39,v37 offset:0
s_sub_u32 s90,s90,1
s_waitcnt lgkmcnt(0)
v_cmp_gt_u32 vcc,v38,v39
s_cmp_lt_i32 s90,0
s_cselect_b64 vcc,0,vcc
s_cbranch_vccnz qs_187
ds_read_b64_tr_b16 a[0:1],v36 offset:0
ds_read_b64_tr_b16 a[2:3],v36 offset:128
ds_read_b64_tr_b16 a[4:5],v36 offset:2048
ds_read_b64_tr_b16 a[6:7],v36 offset:2176
ds_read_b64_tr_b16 a[8:9],v36 offset:8192
ds_read_b64_tr_b16 a[10:11],v36 offset:8320
ds_read_b64_tr_b16 a[12:13],v36 offset:10240
ds_read_b64_tr_b16 a[14:15],v36 offset:10368
ds_write_b128 v33,a[16:19] offset:4096
ds_write_b128 v33,a[20:23] offset:5120
ds_write_b128 v33,a[24:27] offset:6144
ds_write_b128 v33,a[28:31] offset:7168
s_waitcnt lgkmcnt(0)
v_mov_b32 v38,2
ds_write_b32 v37,v38 offset:4
qs_188:
ds_read_b32 v39,v37 offset:0
s_sub_u32 s90,s90,1
s_waitcnt lgkmcnt(0)
v_cmp_gt_u32 vcc,v38,v39
s_cmp_lt_i32 s90,0
s_cselect_b64 vcc,0,vcc
s_cbranch_vccnz qs_188
ds_read_b64_tr_b16 a[16:17],v36 offset:4096
ds_read_b64_tr_b16 a[18:19],v36 offset:4224
ds_read_b64_tr_b16 a[20:21],v36 offset:6144
ds_read_b64_tr_b16 a[22:23],v36 offset:6272
ds_read_b64_tr_b16 a[24:25],v36 offset:12288
ds_read_b64_tr_b16 a[26:27],v36 offset:12416
ds_read_b64_tr_b16 a[28:29],v36 offset:14336
ds_read_b64_tr_b16 a[30:31],v36 offset:14464
ds_write_b128 v33,a[32:35] offset:0
ds_write_b128 v33,a[36:39] offset:1024
ds_write_b128 v33,a[40:43] offset:2048
ds_write_b128 v33,a[44:47] offset:3072
s_waitcnt lgkmcnt(0)
v_mov_b32 v38,3
ds_write_b32 v37,v38 offset:4
qs_189:
ds_read_b32 v39,v37 offset:0
s_sub_u32 s90,s90,1
s_waitcnt lgkmcnt(0)
v_cmp_gt_u32 vcc,v38,v39
s_cmp_lt_i32 s90,0
s_cselect_b64 vcc,0,vcc
s_cbranch_vccnz qs_189
ds_read_b64_tr_b16 a[32:33],v36 offset:0
ds_read_b64_tr_b16 a[34:35],v36 offset:128
ds_read_b64_tr_b16 a[36:37],v36 offset:2048
ds_read_b64_tr_b16 a[38:39],v36 offset:2176
ds_read_b64_tr_b16 a[40:41],v36 offset:8192
ds_read_b64_tr_b16 a[42:43],v36 offset:8320
ds_read_b64_tr_b16 a[44:45],v36 offset:10240
ds_read_b64_tr_b16 a[46:47],v36 offset:10368
ds_write_b128 v33,a[48:51] offset:4096
ds_write_b128 v33,a[52:55] offset:5120
ds_write_b128 v33,a[56:59] offset:6144
ds_write_b128 v33,a[60:63] offset:7168
s_waitcnt lgkmcnt(0)
v_mov_b32 v38,4
ds_write_b32 v37,v38 offset:4
qs_190:
ds_read_b32 v39,v37 offset:0
s_sub_u32 s90,s90,1
s_waitcnt lgkmcnt(0)
v_cmp_gt_u32 vcc,v38,v39
s_cmp_lt_i32 s90,0
s_cselect_b64 vcc,0,vcc
s_cbranch_vccnz qs_190
ds_read_b64_tr_b16 a[48:49],v36 offset:4096
ds_read_b64_tr_b16 a[50:51],v36 offset:4224
ds_read_b64_tr_b16 a[52:53],v36 offset:6144
ds_read_b64_tr_b16 a[54:55],v36 offset:6272
ds_read_b64_tr_b16 a[56:57],v36 offset:12288
ds_read_b64_tr_b16 a[58:59],v36 offset:12416
ds_read_b64_tr_b16 a[60:61],v36 offset:14336
ds_read_b64_tr_b16 a[62:63],v36 offset:14464
ds_write_b128 v33,a[64:67] offset:0
ds_write_b128 v33,a[68:71] offset:1024
ds_write_b128 v33,a[72:75] offset:2048
ds_write_b128 v33,a[76:79] offset:3072
s_waitcnt lgkmcnt(0)
v_mov_b32 v38,5
ds_write_b32 v37,v38 offset:4
qs_191:
ds_read_b32 v39,v37 offset:0
s_sub_u32 s90,s90,1
s_waitcnt lgkmcnt(0)
v_cmp_gt_u32 vcc,v38,v39
s_cmp_lt_i32 s90,0
s_cselect_b64 vcc,0,vcc
s_cbranch_vccnz qs_191
ds_read_b64_tr_b16 a[64:65],v36 offset:0
ds_read_b64_tr_b16 a[66:67],v36 offset:128
ds_read_b64_tr_b16 a[68:69],v36 offset:2048
ds_read_b64_tr_b16 a[70:71],v36 offset:2176
ds_read_b64_tr_b16 a[72:73],v36 offset:8192
ds_read_b64_tr_b16 a[74:75],v36 offset:8320
ds_read_b64_tr_b16 a[76:77],v36 offset:10240
ds_read_b64_tr_b16 a[78:79],v36 offset:10368
ds_write_b128 v33,a[80:83] offset:4096
ds_write_b128 v33,a[84:87] offset:5120
ds_write_b128 v33,a[88:91] offset:6144
ds_write_b128 v33,a[92:95] offset:7168
s_waitcnt lgkmcnt(0)
v_mov_b32 v38,6
ds_write_b32 v37,v38 offset:4
qs_192:
ds_read_b32 v39,v37 offset:0
s_sub_u32 s90,s90,1
s_waitcnt lgkmcnt(0)
v_cmp_gt_u32 vcc,v38,v39
s_cmp_lt_i32 s90,0
s_cselect_b64 vcc,0,vcc
s_cbranch_vccnz qs_192
ds_read_b64_tr_b16 a[80:81],v36 offset:4096
ds_read_b64_tr_b16 a[82:83],v36 offset:4224
ds_read_b64_tr_b16 a[84:85],v36 offset:6144
ds_read_b64_tr_b16 a[86:87],v36 offset:6272
ds_read_b64_tr_b16 a[88:89],v36 offset:12288
ds_read_b64_tr_b16 a[90:91],v36 offset:12416
ds_read_b64_tr_b16 a[92:93],v36 offset:14336
ds_read_b64_tr_b16 a[94:95],v36 offset:14464
ds_write_b128 v33,a[96:99] offset:0
ds_write_b128 v33,a[100:103] offset:1024
ds_write_b128 v33,a[104:107] offset:2048
ds_write_b128 v33,a[108:111] offset:3072
s_waitcnt lgkmcnt(0)
v_mov_b32 v38,7
ds_write_b32 v37,v38 offset:4
qs_193:
ds_read_b32 v39,v37 offset:0
s_sub_u32 s90,s90,1
s_waitcnt lgkmcnt(0)
v_cmp_gt_u32 vcc,v38,v39
s_cmp_lt_i32 s90,0
s_cselect_b64 vcc,0,vcc
s_cbranch_vccnz qs_193
ds_read_b64_tr_b16 a[96:97],v36 offset:0
ds_read_b64_tr_b16 a[98:99],v36 offset:128
ds_read_b64_tr_b16 a[100:101],v36 offset:2048
ds_read_b64_tr_b16 a[102:103],v36 offset:2176
ds_read_b64_tr_b16 a[104:105],v36 offset:8192
ds_read_b64_tr_b16 a[106:107],v36 offset:8320
ds_read_b64_tr_b16 a[108:109],v36 offset:10240
ds_read_b64_tr_b16 a[110:111],v36 offset:10368
ds_write_b128 v33,a[112:115] offset:4096
ds_write_b128 v33,a[116:119] offset:5120
ds_write_b128 v33,a[120:123] offset:6144
ds_write_b128 v33,a[124:127] offset:7168
s_waitcnt lgkmcnt(0)
v_mov_b32 v38,8
ds_write_b32 v37,v38 offset:4
qs_194:
ds_read_b32 v39,v37 offset:0
s_sub_u32 s90,s90,1
s_waitcnt lgkmcnt(0)
v_cmp_gt_u32 vcc,v38,v39
s_cmp_lt_i32 s90,0
s_cselect_b64 vcc,0,vcc
s_cbranch_vccnz qs_194
ds_read_b64_tr_b16 a[112:113],v36 offset:4096
ds_read_b64_tr_b16 a[114:115],v36 offset:4224
ds_read_b64_tr_b16 a[116:117],v36 offset:6144
ds_read_b64_tr_b16 a[118:119],v36 offset:6272
ds_read_b64_tr_b16 a[120:121],v36 offset:12288
ds_read_b64_tr_b16 a[122:123],v36 offset:12416
ds_read_b64_tr_b16 a[124:125],v36 offset:14336
ds_read_b64_tr_b16 a[126:127],v36 offset:14464
s_waitcnt lgkmcnt(0)
v_mov_b32 v38,9
ds_write_b32 v37,v38 offset:4
qs_195:
ds_read_b32 v39,v37 offset:0
s_sub_u32 s90,s90,1
s_waitcnt lgkmcnt(0)
v_cmp_gt_u32 vcc,v38,v39
s_cmp_lt_i32 s90,0
s_cselect_b64 vcc,0,vcc
s_cbranch_vccnz qs_195
ds_write_b128 v33,a[128:131] offset:0
ds_write_b128 v33,a[132:135] offset:1024
ds_write_b128 v33,a[136:139] offset:2048
ds_write_b128 v33,a[140:143] offset:3072
s_waitcnt lgkmcnt(0)
ds_read_b64_tr_b16 a[128:129],v34 offset:0
ds_read_b64_tr_b16 a[130:131],v34 offset:128
ds_read_b64_tr_b16 a[132:133],v34 offset:2048
ds_read_b64_tr_b16 a[134:135],v34 offset:2176
ds_read_b64_tr_b16 a[136:137],v34 offset:32
ds_read_b64_tr_b16 a[138:139],v34 offset:160
ds_read_b64_tr_b16 a[140:141],v34 offset:2080
ds_read_b64_tr_b16 a[142:143],v34 offset:2208
ds_write_b128 v33,a[144:147] offset:4096
ds_write_b128 v33,a[148:151] offset:5120
ds_write_b128 v33,a[152:155] offset:6144
ds_write_b128 v33,a[156:159] offset:7168
s_waitcnt lgkmcnt(0)
ds_read_b64_tr_b16 a[144:145],v34 offset:4096
ds_read_b64_tr_b16 a[146:147],v34 offset:4224
ds_read_b64_tr_b16 a[148:149],v34 offset:6144
ds_read_b64_tr_b16 a[150:151],v34 offset:6272
ds_read_b64_tr_b16 a[152:153],v34 offset:4128
ds_read_b64_tr_b16 a[154:155],v34 offset:4256
ds_read_b64_tr_b16 a[156:157],v34 offset:6176
ds_read_b64_tr_b16 a[158:159],v34 offset:6304
ds_write_b128 v33,a[160:163] offset:0
ds_write_b128 v33,a[164:167] offset:1024
ds_write_b128 v33,a[168:171] offset:2048
ds_write_b128 v33,a[172:175] offset:3072
s_waitcnt lgkmcnt(0)
ds_read_b64_tr_b16 a[160:161],v34 offset:0
ds_read_b64_tr_b16 a[162:163],v34 offset:128
ds_read_b64_tr_b16 a[164:165],v34 offset:2048
ds_read_b64_tr_b16 a[166:167],v34 offset:2176
ds_read_b64_tr_b16 a[168:169],v34 offset:32
ds_read_b64_tr_b16 a[170:171],v34 offset:160
ds_read_b64_tr_b16 a[172:173],v34 offset:2080
ds_read_b64_tr_b16 a[174:175],v34 offset:2208
free_196:
ds_read_b64 v[38:39],v37 offset:8
s_sub_u32 s90,s90,1
s_waitcnt lgkmcnt(0)
v_and_b32 v38,v38,v39
v_cmp_eq_u32 vcc,0,v38
s_cmp_lt_i32 s90,0
s_cselect_b64 vcc,0,vcc
s_cbranch_vccnz free_196
s_xor_b32 s64,s61,10493952
buffer_store_dwordx4 v[100:103],v206,s[20:23],s64 offen sc1
buffer_store_dwordx4 v[100:103],v207,s[20:23],s64 offen sc1
s_xor_b32 s64,s61,12582912
buffer_store_dwordx4 v[100:103],v206,s[20:23],s64 offen sc1
buffer_store_dwordx4 v[100:103],v207,s[20:23],s64 offen sc1
s_xor_b32 s64,s61,14688256
buffer_store_dwordx4 v[100:103],v206,s[20:23],s64 offen sc1
buffer_store_dwordx4 v[100:103],v207,s[20:23],s64 offen sc1
s_mov_b32 m0,32768
s_mov_b32 s65,221184
buffer_load_dwordx4 v16,s[20:23],s65 offen offset:0 lds
buffer_load_dwordx4 v16,s[20:23],s65 offen offset:1024 lds
buffer_load_dwordx4 v16,s[20:23],s65 offen offset:2048 lds
buffer_load_dwordx4 v16,s[20:23],s65 offen offset:3072 lds
s_mov_b32 m0,36864
s_mov_b32 s65,225280
buffer_load_dwordx4 v16,s[20:23],s65 offen offset:0 lds
buffer_load_dwordx4 v16,s[20:23],s65 offen offset:1024 lds
buffer_load_dwordx4 v16,s[20:23],s65 offen offset:2048 lds
buffer_load_dwordx4 v16,s[20:23],s65 offen offset:3072 lds
s_mov_b32 m0,40960
s_mov_b32 s65,229376
buffer_load_dwordx4 v16,s[20:23],s65 offen offset:0 lds
buffer_load_dwordx4 v16,s[20:23],s65 offen offset:1024 lds
buffer_load_dwordx4 v16,s[20:23],s65 offen offset:2048 lds
buffer_load_dwordx4 v16,s[20:23],s65 offen offset:3072 lds
s_mov_b32 m0,45056
s_mov_b32 s65,233472
buffer_load_dwordx4 v16,s[20:23],s65 offen offset:0 lds
buffer_load_dwordx4 v16,s[20:23],s65 offen offset:1024 lds
buffer_load_dwordx4 v16,s[20:23],s65 offen offset:2048 lds
buffer_load_dwordx4 v16,s[20:23],s65 offen offset:3072 lds
s_mov_b32 m0,49152
s_mov_b32 s65,237568
buffer_load_dwordx4 v16,s[20:23],s65 offen offset:0 lds
buffer_load_dwordx4 v16,s[20:23],s65 offen offset:1024 lds
buffer_load_dwordx4 v16,s[20:23],s65 offen offset:2048 lds
buffer_load_dwordx4 v16,s[20:23],s65 offen offset:3072 lds
s_mov_b32 m0,53248
s_mov_b32 s65,241664
buffer_load_dwordx4 v16,s[20:23],s65 offen offset:0 lds
buffer_load_dwordx4 v16,s[20:23],s65 offen offset:1024 lds
buffer_load_dwordx4 v16,s[20:23],s65 offen offset:2048 lds
buffer_load_dwordx4 v16,s[20:23],s65 offen offset:3072 lds
s_mov_b32 m0,57344
s_mov_b32 s65,245760
buffer_load_dwordx4 v16,s[20:23],s65 offen offset:0 lds
buffer_load_dwordx4 v16,s[20:23],s65 offen offset:1024 lds
buffer_load_dwordx4 v16,s[20:23],s65 offen offset:2048 lds
buffer_load_dwordx4 v16,s[20:23],s65 offen offset:3072 lds
s_mov_b32 m0,61440
s_mov_b32 s65,249856
buffer_load_dwordx4 v16,s[20:23],s65 offen offset:0 lds
buffer_load_dwordx4 v16,s[20:23],s65 offen offset:1024 lds
buffer_load_dwordx4 v16,s[20:23],s65 offen offset:2048 lds
buffer_load_dwordx4 v16,s[20:23],s65 offen offset:3072 lds
s_waitcnt vmcnt(54)
ds_write_b128 v33,a[176:179] offset:4096
ds_write_b128 v33,a[180:183] offset:5120
ds_write_b128 v33,a[184:187] offset:6144
ds_write_b128 v33,a[188:191] offset:7168
s_waitcnt lgkmcnt(0)
ds_read_b64_tr_b16 a[176:177],v34 offset:4096
ds_read_b64_tr_b16 a[178:179],v34 offset:4224
ds_read_b64_tr_b16 a[180:181],v34 offset:6144
ds_read_b64_tr_b16 a[182:183],v34 offset:6272
ds_read_b64_tr_b16 a[184:185],v34 offset:4128
ds_read_b64_tr_b16 a[186:187],v34 offset:4256
ds_read_b64_tr_b16 a[188:189],v34 offset:6176
ds_read_b64_tr_b16 a[190:191],v34 offset:6304
s_waitcnt vmcnt(50)
ds_write_b128 v33,a[192:195] offset:0
ds_write_b128 v33,a[196:199] offset:1024
ds_write_b128 v33,a[200:203] offset:2048
ds_write_b128 v33,a[204:207] offset:3072
s_waitcnt lgkmcnt(0)
ds_read_b64_tr_b16 a[192:193],v34 offset:0
ds_read_b64_tr_b16 a[194:195],v34 offset:128
ds_read_b64_tr_b16 a[196:197],v34 offset:2048
ds_read_b64_tr_b16 a[198:199],v34 offset:2176
ds_read_b64_tr_b16 a[200:201],v34 offset:32
ds_read_b64_tr_b16 a[202:203],v34 offset:160
ds_read_b64_tr_b16 a[204:205],v34 offset:2080
ds_read_b64_tr_b16 a[206:207],v34 offset:2208
s_waitcnt vmcnt(46)
ds_write_b128 v33,a[208:211] offset:4096
ds_write_b128 v33,a[212:215] offset:5120
ds_write_b128 v33,a[216:219] offset:6144
ds_write_b128 v33,a[220:223] offset:7168
s_waitcnt lgkmcnt(0)
ds_read_b64_tr_b16 a[208:209],v34 offset:4096
ds_read_b64_tr_b16 a[210:211],v34 offset:4224
ds_read_b64_tr_b16 a[212:213],v34 offset:6144
ds_read_b64_tr_b16 a[214:215],v34 offset:6272
ds_read_b64_tr_b16 a[216:217],v34 offset:4128
ds_read_b64_tr_b16 a[218:219],v34 offset:4256
ds_read_b64_tr_b16 a[220:221],v34 offset:6176
ds_read_b64_tr_b16 a[222:223],v34 offset:6304
s_waitcnt vmcnt(42)
ds_write_b128 v33,a[224:227] offset:0
ds_write_b128 v33,a[228:231] offset:1024
ds_write_b128 v33,a[232:235] offset:2048
ds_write_b128 v33,a[236:239] offset:3072
s_waitcnt lgkmcnt(0)
ds_read_b64_tr_b16 a[224:225],v34 offset:0
ds_read_b64_tr_b16 a[226:227],v34 offset:128
ds_read_b64_tr_b16 a[228:229],v34 offset:2048
ds_read_b64_tr_b16 a[230:231],v34 offset:2176
ds_read_b64_tr_b16 a[232:233],v34 offset:32
ds_read_b64_tr_b16 a[234:235],v34 offset:160
ds_read_b64_tr_b16 a[236:237],v34 offset:2080
ds_read_b64_tr_b16 a[238:239],v34 offset:2208
s_waitcnt vmcnt(38)
ds_write_b128 v33,a[240:243] offset:4096
ds_write_b128 v33,a[244:247] offset:5120
ds_write_b128 v33,a[248:251] offset:6144
ds_write_b128 v33,a[252:255] offset:7168
s_waitcnt lgkmcnt(0)
ds_read_b64_tr_b16 a[240:241],v34 offset:4096
ds_read_b64_tr_b16 a[242:243],v34 offset:4224
ds_read_b64_tr_b16 a[244:245],v34 offset:6144
ds_read_b64_tr_b16 a[246:247],v34 offset:6272
ds_read_b64_tr_b16 a[248:249],v34 offset:4128
ds_read_b64_tr_b16 a[250:251],v34 offset:4256
ds_read_b64_tr_b16 a[252:253],v34 offset:6176
ds_read_b64_tr_b16 a[254:255],v34 offset:6304
s_mov_b32 s79,0
s_add_u32 s63,s79,0
s_and_b32 s64,s63,3
s_lshl_b32 s70,s64,20
s_add_u32 s65,s63,2
s_and_b32 s65,s65,3
s_lshl_b32 s73,s65,20
s_add_u32 s55,s63,3
s_lshl_b32 s78,s55,16
s_add_u32 s78,s78,57344
s_cmp_lt_u32 s55,64
s_cselect_b32 s78,s78,0x7fff0000
s_add_u32 s71,s70,65536
s_add_u32 s60,s63,1
s_and_b32 s60,s60,3
s_lshl_b32 s72,s60,20
v_mov_b32 v184,0
v_mov_b32 v185,0
v_mov_b32 v186,0
v_mov_b32 v187,0
v_mov_b32 v188,0
v_mov_b32 v189,0
v_mov_b32 v190,0
v_mov_b32 v191,0
s_lshl_b32 s74,s63,21
s_lshl_b32 s55,s63,13
s_and_b32 s55,s55,0x2000
s_xor_b32 s55,s55,s61
s_add_u32 s74,s74,s55
v_mov_b32 v176,0
v_mov_b32 v177,0
v_mov_b32 v178,0
v_mov_b32 v179,0
v_mov_b32 v25,1
s_waitcnt vmcnt(0) lgkmcnt(0)
s_barrier
v_max_u32 v216,1,v216
v_max_u32 v217,1,v217
v_max_u32 v218,1,v218
v_max_u32 v219,1,v219
s_mov_b64 exec,s[84:85]
buffer_store_dwordx4 v[216:219],v12,s[24:27],s70 offen
buffer_store_dwordx4 v[216:219],v12,s[28:31],s70 offen sc1
s_mov_b64 exec,1
buffer_store_dword v25,v13,s[24:27],s70 offen
buffer_store_dword v25,v13,s[28:31],s70 offen sc1
s_mov_b64 exec,-1
s_branch loop_152
end_57:
s_waitcnt vmcnt(0)
s_barrier
s_mov_b32 s50,s91
done_1:
s_endpgm
pipe_worker:
v_and_b32 v1,63,v0
v_and_b32 v3,15,v1
v_lshrrev_b32 v4,4,v1
v_lshlrev_b32 v16,4,v1
v_mov_b32 v48,0
v_mov_b32 v49,0
v_mov_b32 v50,0
v_mov_b32 v51,0
s_lshr_b32 s58,s55,5
s_and_b32 s59,s55,31
s_xor_b32 s62,s61,0x2000
s_add_u32 s63,s62,21053440
s_lshr_b32 s64,s59,4
s_and_b32 s59,s59,15
s_lshr_b32 s65,s58,1
s_lshl_b32 s65,s65,4
s_add_u32 s59,s59,s65
s_mul_i32 s65,s64,3
s_add_u32 s64,s64,1
s_sub_u32 s58,s58,1
s_cmp_lt_u32 s58,2
s_cselect_b32 s58,s64,s65
s_load_dwordx2 s[4:5],s[0:1],16
v_lshlrev_b32 v5,4,v0
s_lshl_b32 s64,s55,14
s_add_u32 s64,s64,17825792
buffer_store_dwordx4 v[48:51],v5,s[20:23],s64 offen sc1
s_add_u32 s64,s64,4096
buffer_store_dwordx4 v[48:51],v5,s[20:23],s64 offen sc1
s_add_u32 s64,s64,4096
buffer_store_dwordx4 v[48:51],v5,s[20:23],s64 offen sc1
s_add_u32 s64,s64,4096
buffer_store_dwordx4 v[48:51],v5,s[20:23],s64 offen sc1
s_add_u32 s64,s64,4096
s_lshl_b32 s64,s55,12
s_add_u32 s64,s64,8577024
buffer_store_dwordx4 v[48:51],v5,s[20:23],s64 offen sc1
s_lshr_b32 s79,s55,5
s_add_u32 s64,s79,8
s_lshl_b32 s93,s64,21
s_lshl_b32 s64,s64,13
s_and_b32 s64,s64,0x2000
s_xor_b32 s64,s64,s61
s_add_u32 s93,s93,s64
s_add_u32 s93,s93,29360128
s_and_b32 s64,s55,31
s_add_u32 s64,s64,96
s_lshl_b32 s64,s64,14
s_add_u32 s93,s93,s64
s_waitcnt lgkmcnt(0)
s_mov_b32 s32,s4
s_and_b32 s33,s5,0xffff
s_mov_b32 s34,0x800000
s_mov_b32 s35,0x20000
v_lshrrev_b32 v5,3,v3
v_bfe_u32 v6,v3,2,1
v_lshl_add_u32 v7,v5,3,v6
v_lshl_add_u32 v6,v5,2,v6
v_lshrrev_b32 v5,1,v4
v_lshl_add_u32 v7,v5,4,v7
v_and_b32 v5,1,v4
v_lshl_add_u32 v7,v5,2,v7
v_lshl_add_u32 v6,v5,1,v6
v_bfe_u32 v5,v3,1,1
s_lshl_b32 s64,s50,1
v_add_u32 v5,s64,v5
v_xor_b32 v5,v5,v6
v_lshlrev_b32 v5,5,v5
v_lshl_add_u32 v5,v7,8,v5
v_and_b32 v6,1,v3
v_lshl_add_u32 v12,v6,4,v5
s_lshl_b32 s66,s59,8
v_and_b32 v5,15,v1
v_and_b32 v6,1,v4
v_lshlrev_b32 v6,1,v6
v_xor_b32 v5,v5,v6
v_mul_u32_u24 v6,8192,v4
v_xor_b32 v7,0,v5
v_lshl_add_u32 v8,v7,4,v6
v_xor_b32 v7,4,v5
v_lshl_add_u32 v9,v7,4,v6
v_xor_b32 v7,8,v5
v_lshl_add_u32 v10,v7,4,v6
v_xor_b32 v7,12,v5
v_lshl_add_u32 v11,v7,4,v6
s_mul_i32 s74,s50,524288
s_add_u32 s74,s74,s66
s_lshl_b32 s75,s50,14
s_mul_i32 s76,s50,262144
s_add_u32 s76,s76,s66
s_lshl_b32 s77,s50,13
s_add_u32 s64,s74,0
s_add_u32 m0,s75,0
s_nop 0
buffer_load_dwordx4 v8,s[32:35],s64 offen nt lds
s_add_u32 s64,s74,32768
s_add_u32 m0,s75,1024
s_nop 0
buffer_load_dwordx4 v9,s[32:35],s64 offen nt lds
s_add_u32 s64,s74,65536
s_add_u32 m0,s75,2048
s_nop 0
buffer_load_dwordx4 v10,s[32:35],s64 offen nt lds
s_add_u32 s64,s74,98304
s_add_u32 m0,s75,3072
s_nop 0
buffer_load_dwordx4 v11,s[32:35],s64 offen nt lds
s_add_u32 s64,s74,131072
s_add_u32 m0,s75,4096
s_nop 0
buffer_load_dwordx4 v8,s[32:35],s64 offen nt lds
s_add_u32 s64,s74,163840
s_add_u32 m0,s75,5120
s_nop 0
buffer_load_dwordx4 v9,s[32:35],s64 offen nt lds
s_add_u32 s64,s74,196608
s_add_u32 m0,s75,6144
s_nop 0
buffer_load_dwordx4 v10,s[32:35],s64 offen nt lds
s_add_u32 s64,s74,229376
s_add_u32 m0,s75,7168
s_nop 0
buffer_load_dwordx4 v11,s[32:35],s64 offen nt lds
s_add_u32 s64,s74,262144
s_add_u32 m0,s75,8192
s_nop 0
buffer_load_dwordx4 v8,s[32:35],s64 offen nt lds
s_add_u32 s64,s74,294912
s_add_u32 m0,s75,9216
s_nop 0
buffer_load_dwordx4 v9,s[32:35],s64 offen nt lds
s_add_u32 s64,s74,327680
s_add_u32 m0,s75,10240
s_nop 0
buffer_load_dwordx4 v10,s[32:35],s64 offen nt lds
s_add_u32 s64,s74,360448
s_add_u32 m0,s75,11264
s_nop 0
buffer_load_dwordx4 v11,s[32:35],s64 offen nt lds
s_add_u32 s64,s74,393216
s_add_u32 m0,s75,12288
s_nop 0
buffer_load_dwordx4 v8,s[32:35],s64 offen nt lds
s_add_u32 s64,s74,425984
s_add_u32 m0,s75,13312
s_nop 0
buffer_load_dwordx4 v9,s[32:35],s64 offen nt lds
s_add_u32 s64,s74,458752
s_add_u32 m0,s75,14336
s_nop 0
buffer_load_dwordx4 v10,s[32:35],s64 offen nt lds
s_add_u32 s64,s74,491520
s_add_u32 m0,s75,15360
s_nop 0
buffer_load_dwordx4 v11,s[32:35],s64 offen nt lds
s_add_u32 s64,s74,2097152
s_add_u32 m0,s75,65536
s_nop 0
buffer_load_dwordx4 v8,s[32:35],s64 offen nt lds
s_add_u32 s64,s74,2129920
s_add_u32 m0,s75,66560
s_nop 0
buffer_load_dwordx4 v9,s[32:35],s64 offen nt lds
s_add_u32 s64,s74,2162688
s_add_u32 m0,s75,67584
s_nop 0
buffer_load_dwordx4 v10,s[32:35],s64 offen nt lds
s_add_u32 s64,s74,2195456
s_add_u32 m0,s75,68608
s_nop 0
buffer_load_dwordx4 v11,s[32:35],s64 offen nt lds
s_add_u32 s64,s74,2228224
s_add_u32 m0,s75,69632
s_nop 0
buffer_load_dwordx4 v8,s[32:35],s64 offen nt lds
s_add_u32 s64,s74,2260992
s_add_u32 m0,s75,70656
s_nop 0
buffer_load_dwordx4 v9,s[32:35],s64 offen nt lds
s_add_u32 s64,s74,2293760
s_add_u32 m0,s75,71680
s_nop 0
buffer_load_dwordx4 v10,s[32:35],s64 offen nt lds
s_add_u32 s64,s74,2326528
s_add_u32 m0,s75,72704
s_nop 0
buffer_load_dwordx4 v11,s[32:35],s64 offen nt lds
s_add_u32 s64,s74,2359296
s_add_u32 m0,s75,73728
s_nop 0
buffer_load_dwordx4 v8,s[32:35],s64 offen nt lds
s_add_u32 s64,s74,2392064
s_add_u32 m0,s75,74752
s_nop 0
buffer_load_dwordx4 v9,s[32:35],s64 offen nt lds
s_add_u32 s64,s74,2424832
s_add_u32 m0,s75,75776
s_nop 0
buffer_load_dwordx4 v10,s[32:35],s64 offen nt lds
s_add_u32 s64,s74,2457600
s_add_u32 m0,s75,76800
s_nop 0
buffer_load_dwordx4 v11,s[32:35],s64 offen nt lds
s_add_u32 s64,s74,2490368
s_add_u32 m0,s75,77824
s_nop 0
buffer_load_dwordx4 v8,s[32:35],s64 offen nt lds
s_add_u32 s64,s74,2523136
s_add_u32 m0,s75,78848
s_nop 0
buffer_load_dwordx4 v9,s[32:35],s64 offen nt lds
s_add_u32 s64,s74,2555904
s_add_u32 m0,s75,79872
s_nop 0
buffer_load_dwordx4 v10,s[32:35],s64 offen nt lds
s_add_u32 s64,s74,2588672
s_add_u32 m0,s75,80896
s_nop 0
buffer_load_dwordx4 v11,s[32:35],s64 offen nt lds
s_waitcnt vmcnt(16)
s_barrier
ds_read_b64_tr_b16 a[0:1],v12 offset:0
ds_read_b64_tr_b16 a[2:3],v12 offset:512
ds_read_b64_tr_b16 a[128:129],v12 offset:8
ds_read_b64_tr_b16 a[130:131],v12 offset:520
ds_read_b64_tr_b16 a[4:5],v12 offset:8192
ds_read_b64_tr_b16 a[6:7],v12 offset:8704
ds_read_b64_tr_b16 a[132:133],v12 offset:8200
ds_read_b64_tr_b16 a[134:135],v12 offset:8712
s_waitcnt lgkmcnt(4)
ds_read_b64_tr_b16 a[8:9],v12 offset:16384
ds_read_b64_tr_b16 a[10:11],v12 offset:16896
ds_read_b64_tr_b16 a[136:137],v12 offset:16392
ds_read_b64_tr_b16 a[138:139],v12 offset:16904
ds_read_b64_tr_b16 a[12:13],v12 offset:24576
ds_read_b64_tr_b16 a[14:15],v12 offset:25088
ds_read_b64_tr_b16 a[140:141],v12 offset:24584
ds_read_b64_tr_b16 a[142:143],v12 offset:25096
s_waitcnt lgkmcnt(4)
ds_read_b64_tr_b16 a[16:17],v12 offset:32768
ds_read_b64_tr_b16 a[18:19],v12 offset:33280
ds_read_b64_tr_b16 a[144:145],v12 offset:32776
ds_read_b64_tr_b16 a[146:147],v12 offset:33288
ds_read_b64_tr_b16 a[20:21],v12 offset:40960
ds_read_b64_tr_b16 a[22:23],v12 offset:41472
ds_read_b64_tr_b16 a[148:149],v12 offset:40968
ds_read_b64_tr_b16 a[150:151],v12 offset:41480
s_waitcnt lgkmcnt(4)
ds_read_b64_tr_b16 a[24:25],v12 offset:49152
ds_read_b64_tr_b16 a[26:27],v12 offset:49664
ds_read_b64_tr_b16 a[152:153],v12 offset:49160
ds_read_b64_tr_b16 a[154:155],v12 offset:49672
ds_read_b64_tr_b16 a[28:29],v12 offset:57344
ds_read_b64_tr_b16 a[30:31],v12 offset:57856
ds_read_b64_tr_b16 a[156:157],v12 offset:57352
ds_read_b64_tr_b16 a[158:159],v12 offset:57864
s_waitcnt lgkmcnt(4)
v_xor_b32 v12,0x10000,v12
s_waitcnt lgkmcnt(0)
s_barrier
s_add_u32 s64,s74,4194304
s_add_u32 m0,s75,0
s_nop 0
buffer_load_dwordx4 v8,s[32:35],s64 offen nt lds
s_add_u32 s64,s74,4227072
s_add_u32 m0,s75,1024
s_nop 0
buffer_load_dwordx4 v9,s[32:35],s64 offen nt lds
s_add_u32 s64,s74,4259840
s_add_u32 m0,s75,2048
s_nop 0
buffer_load_dwordx4 v10,s[32:35],s64 offen nt lds
s_add_u32 s64,s74,4292608
s_add_u32 m0,s75,3072
s_nop 0
buffer_load_dwordx4 v11,s[32:35],s64 offen nt lds
s_add_u32 s64,s74,4325376
s_add_u32 m0,s75,4096
s_nop 0
buffer_load_dwordx4 v8,s[32:35],s64 offen nt lds
s_add_u32 s64,s74,4358144
s_add_u32 m0,s75,5120
s_nop 0
buffer_load_dwordx4 v9,s[32:35],s64 offen nt lds
s_add_u32 s64,s74,4390912
s_add_u32 m0,s75,6144
s_nop 0
buffer_load_dwordx4 v10,s[32:35],s64 offen nt lds
s_add_u32 s64,s74,4423680
s_add_u32 m0,s75,7168
s_nop 0
buffer_load_dwordx4 v11,s[32:35],s64 offen nt lds
s_add_u32 s64,s74,4456448
s_add_u32 m0,s75,8192
s_nop 0
buffer_load_dwordx4 v8,s[32:35],s64 offen nt lds
s_add_u32 s64,s74,4489216
s_add_u32 m0,s75,9216
s_nop 0
buffer_load_dwordx4 v9,s[32:35],s64 offen nt lds
s_add_u32 s64,s74,4521984
s_add_u32 m0,s75,10240
s_nop 0
buffer_load_dwordx4 v10,s[32:35],s64 offen nt lds
s_add_u32 s64,s74,4554752
s_add_u32 m0,s75,11264
s_nop 0
buffer_load_dwordx4 v11,s[32:35],s64 offen nt lds
s_add_u32 s64,s74,4587520
s_add_u32 m0,s75,12288
s_nop 0
buffer_load_dwordx4 v8,s[32:35],s64 offen nt lds
s_add_u32 s64,s74,4620288
s_add_u32 m0,s75,13312
s_nop 0
buffer_load_dwordx4 v9,s[32:35],s64 offen nt lds
s_add_u32 s64,s74,4653056
s_add_u32 m0,s75,14336
s_nop 0
buffer_load_dwordx4 v10,s[32:35],s64 offen nt lds
s_add_u32 s64,s74,4685824
s_add_u32 m0,s75,15360
s_nop 0
buffer_load_dwordx4 v11,s[32:35],s64 offen nt lds
s_waitcnt vmcnt(16)
s_barrier
ds_read_b64_tr_b16 a[32:33],v12 offset:0
ds_read_b64_tr_b16 a[34:35],v12 offset:512
ds_read_b64_tr_b16 a[160:161],v12 offset:8
ds_read_b64_tr_b16 a[162:163],v12 offset:520
ds_read_b64_tr_b16 a[36:37],v12 offset:8192
ds_read_b64_tr_b16 a[38:39],v12 offset:8704
ds_read_b64_tr_b16 a[164:165],v12 offset:8200
ds_read_b64_tr_b16 a[166:167],v12 offset:8712
s_waitcnt lgkmcnt(4)
ds_read_b64_tr_b16 a[40:41],v12 offset:16384
ds_read_b64_tr_b16 a[42:43],v12 offset:16896
ds_read_b64_tr_b16 a[168:169],v12 offset:16392
ds_read_b64_tr_b16 a[170:171],v12 offset:16904
ds_read_b64_tr_b16 a[44:45],v12 offset:24576
ds_read_b64_tr_b16 a[46:47],v12 offset:25088
ds_read_b64_tr_b16 a[172:173],v12 offset:24584
ds_read_b64_tr_b16 a[174:175],v12 offset:25096
s_waitcnt lgkmcnt(4)
ds_read_b64_tr_b16 a[48:49],v12 offset:32768
ds_read_b64_tr_b16 a[50:51],v12 offset:33280
ds_read_b64_tr_b16 a[176:177],v12 offset:32776
ds_read_b64_tr_b16 a[178:179],v12 offset:33288
ds_read_b64_tr_b16 a[52:53],v12 offset:40960
ds_read_b64_tr_b16 a[54:55],v12 offset:41472
ds_read_b64_tr_b16 a[180:181],v12 offset:40968
ds_read_b64_tr_b16 a[182:183],v12 offset:41480
s_waitcnt lgkmcnt(4)
ds_read_b64_tr_b16 a[56:57],v12 offset:49152
ds_read_b64_tr_b16 a[58:59],v12 offset:49664
ds_read_b64_tr_b16 a[184:185],v12 offset:49160
ds_read_b64_tr_b16 a[186:187],v12 offset:49672
ds_read_b64_tr_b16 a[60:61],v12 offset:57344
ds_read_b64_tr_b16 a[62:63],v12 offset:57856
ds_read_b64_tr_b16 a[188:189],v12 offset:57352
ds_read_b64_tr_b16 a[190:191],v12 offset:57864
s_waitcnt lgkmcnt(4)
v_xor_b32 v12,0x10000,v12
s_waitcnt lgkmcnt(0)
s_barrier
s_add_u32 s64,s74,6291456
s_add_u32 m0,s75,65536
s_nop 0
buffer_load_dwordx4 v8,s[32:35],s64 offen nt lds
s_add_u32 s64,s74,6324224
s_add_u32 m0,s75,66560
s_nop 0
buffer_load_dwordx4 v9,s[32:35],s64 offen nt lds
s_add_u32 s64,s74,6356992
s_add_u32 m0,s75,67584
s_nop 0
buffer_load_dwordx4 v10,s[32:35],s64 offen nt lds
s_add_u32 s64,s74,6389760
s_add_u32 m0,s75,68608
s_nop 0
buffer_load_dwordx4 v11,s[32:35],s64 offen nt lds
s_add_u32 s64,s74,6422528
s_add_u32 m0,s75,69632
s_nop 0
buffer_load_dwordx4 v8,s[32:35],s64 offen nt lds
s_add_u32 s64,s74,6455296
s_add_u32 m0,s75,70656
s_nop 0
buffer_load_dwordx4 v9,s[32:35],s64 offen nt lds
s_add_u32 s64,s74,6488064
s_add_u32 m0,s75,71680
s_nop 0
buffer_load_dwordx4 v10,s[32:35],s64 offen nt lds
s_add_u32 s64,s74,6520832
s_add_u32 m0,s75,72704
s_nop 0
buffer_load_dwordx4 v11,s[32:35],s64 offen nt lds
s_add_u32 s64,s74,6553600
s_add_u32 m0,s75,73728
s_nop 0
buffer_load_dwordx4 v8,s[32:35],s64 offen nt lds
s_add_u32 s64,s74,6586368
s_add_u32 m0,s75,74752
s_nop 0
buffer_load_dwordx4 v9,s[32:35],s64 offen nt lds
s_add_u32 s64,s74,6619136
s_add_u32 m0,s75,75776
s_nop 0
buffer_load_dwordx4 v10,s[32:35],s64 offen nt lds
s_add_u32 s64,s74,6651904
s_add_u32 m0,s75,76800
s_nop 0
buffer_load_dwordx4 v11,s[32:35],s64 offen nt lds
s_add_u32 s64,s74,6684672
s_add_u32 m0,s75,77824
s_nop 0
buffer_load_dwordx4 v8,s[32:35],s64 offen nt lds
s_add_u32 s64,s74,6717440
s_add_u32 m0,s75,78848
s_nop 0
buffer_load_dwordx4 v9,s[32:35],s64 offen nt lds
s_add_u32 s64,s74,6750208
s_add_u32 m0,s75,79872
s_nop 0
buffer_load_dwordx4 v10,s[32:35],s64 offen nt lds
s_add_u32 s64,s74,6782976
s_add_u32 m0,s75,80896
s_nop 0
buffer_load_dwordx4 v11,s[32:35],s64 offen nt lds
s_waitcnt vmcnt(16)
s_barrier
ds_read_b64_tr_b16 a[64:65],v12 offset:0
ds_read_b64_tr_b16 a[66:67],v12 offset:512
ds_read_b64_tr_b16 a[192:193],v12 offset:8
ds_read_b64_tr_b16 a[194:195],v12 offset:520
ds_read_b64_tr_b16 a[68:69],v12 offset:8192
ds_read_b64_tr_b16 a[70:71],v12 offset:8704
ds_read_b64_tr_b16 a[196:197],v12 offset:8200
ds_read_b64_tr_b16 a[198:199],v12 offset:8712
s_waitcnt lgkmcnt(4)
ds_read_b64_tr_b16 a[72:73],v12 offset:16384
ds_read_b64_tr_b16 a[74:75],v12 offset:16896
ds_read_b64_tr_b16 a[200:201],v12 offset:16392
ds_read_b64_tr_b16 a[202:203],v12 offset:16904
ds_read_b64_tr_b16 a[76:77],v12 offset:24576
ds_read_b64_tr_b16 a[78:79],v12 offset:25088
ds_read_b64_tr_b16 a[204:205],v12 offset:24584
ds_read_b64_tr_b16 a[206:207],v12 offset:25096
s_waitcnt lgkmcnt(4)
ds_read_b64_tr_b16 a[80:81],v12 offset:32768
ds_read_b64_tr_b16 a[82:83],v12 offset:33280
ds_read_b64_tr_b16 a[208:209],v12 offset:32776
ds_read_b64_tr_b16 a[210:211],v12 offset:33288
ds_read_b64_tr_b16 a[84:85],v12 offset:40960
ds_read_b64_tr_b16 a[86:87],v12 offset:41472
ds_read_b64_tr_b16 a[212:213],v12 offset:40968
ds_read_b64_tr_b16 a[214:215],v12 offset:41480
s_waitcnt lgkmcnt(4)
ds_read_b64_tr_b16 a[88:89],v12 offset:49152
ds_read_b64_tr_b16 a[90:91],v12 offset:49664
ds_read_b64_tr_b16 a[216:217],v12 offset:49160
ds_read_b64_tr_b16 a[218:219],v12 offset:49672
ds_read_b64_tr_b16 a[92:93],v12 offset:57344
ds_read_b64_tr_b16 a[94:95],v12 offset:57856
ds_read_b64_tr_b16 a[220:221],v12 offset:57352
ds_read_b64_tr_b16 a[222:223],v12 offset:57864
s_waitcnt lgkmcnt(4)
v_xor_b32 v12,0x10000,v12
s_waitcnt lgkmcnt(0)
s_barrier
s_waitcnt vmcnt(0)
s_barrier
ds_read_b64_tr_b16 a[96:97],v12 offset:0
ds_read_b64_tr_b16 a[98:99],v12 offset:512
ds_read_b64_tr_b16 a[224:225],v12 offset:8
ds_read_b64_tr_b16 a[226:227],v12 offset:520
ds_read_b64_tr_b16 a[100:101],v12 offset:8192
ds_read_b64_tr_b16 a[102:103],v12 offset:8704
ds_read_b64_tr_b16 a[228:229],v12 offset:8200
ds_read_b64_tr_b16 a[230:231],v12 offset:8712
s_waitcnt lgkmcnt(4)
ds_read_b64_tr_b16 a[104:105],v12 offset:16384
ds_read_b64_tr_b16 a[106:107],v12 offset:16896
ds_read_b64_tr_b16 a[232:233],v12 offset:16392
ds_read_b64_tr_b16 a[234:235],v12 offset:16904
ds_read_b64_tr_b16 a[108:109],v12 offset:24576
ds_read_b64_tr_b16 a[110:111],v12 offset:25088
ds_read_b64_tr_b16 a[236:237],v12 offset:24584
ds_read_b64_tr_b16 a[238:239],v12 offset:25096
s_waitcnt lgkmcnt(4)
ds_read_b64_tr_b16 a[112:113],v12 offset:32768
ds_read_b64_tr_b16 a[114:115],v12 offset:33280
ds_read_b64_tr_b16 a[240:241],v12 offset:32776
ds_read_b64_tr_b16 a[242:243],v12 offset:33288
ds_read_b64_tr_b16 a[116:117],v12 offset:40960
ds_read_b64_tr_b16 a[118:119],v12 offset:41472
ds_read_b64_tr_b16 a[244:245],v12 offset:40968
ds_read_b64_tr_b16 a[246:247],v12 offset:41480
s_waitcnt lgkmcnt(4)
ds_read_b64_tr_b16 a[120:121],v12 offset:49152
ds_read_b64_tr_b16 a[122:123],v12 offset:49664
ds_read_b64_tr_b16 a[248:249],v12 offset:49160
ds_read_b64_tr_b16 a[250:251],v12 offset:49672
ds_read_b64_tr_b16 a[124:125],v12 offset:57344
ds_read_b64_tr_b16 a[126:127],v12 offset:57856
ds_read_b64_tr_b16 a[252:253],v12 offset:57352
ds_read_b64_tr_b16 a[254:255],v12 offset:57864
s_waitcnt lgkmcnt(4)
v_xor_b32 v12,0x10000,v12
s_waitcnt lgkmcnt(0)
s_barrier
v_and_b32 v21,7,v1
v_lshlrev_b32 v21,6,v21
s_mov_b32 s65,21052416
s_mov_b32 s66,1792
pl_200:
buffer_load_dword v22,v21,s[20:23],s65 offen sc1
s_waitcnt vmcnt(0)
v_cmp_gt_u32 vcc,s66,v22
s_cbranch_vccz pok_201
s_sleep 1
s_sub_u32 s90,s90,1
s_cmp_gt_i32 s90,0
s_cbranch_scc1 pl_200
pok_201:
s_lshl_b32 s72,s50,14
s_lshl_b32 s74,s58,16
s_add_u32 s74,s74,s72
s_add_u32 s74,s74,57344
v_mov_b32 v17,v16
s_lshl_b32 s64,s59,14
s_lshl_b32 s65,s50,11
s_add_u32 s64,s64,s65
v_add_u32 v18,s64,v16
s_lshl_b32 s73,s58,5
s_add_u32 s73,s73,s59
s_lshl_b32 s73,s73,2
s_add_u32 s73,s73,s63
v_lshlrev_b32 v24,4,v0
s_mov_b32 s79,s58
s_add_u32 m0,s72,0
s_add_u32 s65,s74,0
buffer_load_dwordx4 v16,s[20:23],s65 offen offset:0  lds
buffer_load_dwordx4 v16,s[20:23],s65 offen offset:1024  lds
buffer_load_dwordx4 v16,s[20:23],s65 offen offset:2048  lds
buffer_load_dwordx4 v16,s[20:23],s65 offen offset:3072  lds
s_add_u32 m0,s72,4096
s_add_u32 s65,s74,4096
buffer_load_dwordx4 v16,s[20:23],s65 offen offset:0  lds
buffer_load_dwordx4 v16,s[20:23],s65 offen offset:1024  lds
buffer_load_dwordx4 v16,s[20:23],s65 offen offset:2048  lds
buffer_load_dwordx4 v16,s[20:23],s65 offen offset:3072  lds
s_add_u32 m0,s72,8192
s_add_u32 s65,s74,8192
buffer_load_dwordx4 v16,s[20:23],s65 offen offset:0  lds
buffer_load_dwordx4 v16,s[20:23],s65 offen offset:1024  lds
buffer_load_dwordx4 v16,s[20:23],s65 offen offset:2048  lds
buffer_load_dwordx4 v16,s[20:23],s65 offen offset:3072  lds
s_add_u32 m0,s72,12288
s_add_u32 s65,s74,12288
buffer_load_dwordx4 v16,s[20:23],s65 offen offset:0  lds
buffer_load_dwordx4 v16,s[20:23],s65 offen offset:1024  lds
buffer_load_dwordx4 v16,s[20:23],s65 offen offset:2048  lds
buffer_load_dwordx4 v16,s[20:23],s65 offen offset:3072  lds
s_waitcnt vmcnt(0)
s_add_u32 s41,s58,55
s_sub_u32 s64,s58,1
s_cmp_lt_u32 s64,2
s_cselect_b32 s41,s41,64
s_lshl_b32 s76,s50,14
s_add_u32 s76,s76,57344
s_add_u32 s42,s55,32
s_lshl_b32 s42,s42,14
s_add_u32 s42,s42,136314880
s_xor_b32 s64,s62,8192
s_add_u32 s42,s42,s64
s_sub_u32 s64,s42,2097152
s_xor_b32 s64,s64,0x2000
s_cmp_lt_u32 s55,104
s_cselect_b32 s64,s64,0x7fff0000
s_cmp_lt_u32 s55,96
s_cselect_b32 s42,s42,s64
v_add_u32 v25,4096,v24
s_load_dwordx2 s[4:5],s[0:1],96
s_load_dwordx2 s[6:7],s[0:1],104
v_and_b32 v5,3,v0
v_lshrrev_b32 v6,2,v0
v_mul_u32_u24 v112,12288,v6
v_lshl_add_u32 v112,v5,4,v112
v_lshlrev_b32 v113,1,v6
s_add_u32 s43,s55,64
s_lshl_b32 s43,s43,6
s_mov_b32 s48,0
s_mov_b32 s80,0xffff0000
s_mov_b32 s81,0xbfb8aa3b
s_waitcnt lgkmcnt(0)
s_mov_b32 s12,s4
s_and_b32 s13,s5,0xffff
s_mov_b32 s14,0x800
s_mov_b32 s15,0x20000
s_mov_b32 s16,s6
s_and_b32 s17,s7,0xffff
s_mov_b32 s18,0xc00000
s_mov_b32 s19,0x20000
buffer_load_dwordx4 v[104:107],v112,s[16:19],s43 offen nt
buffer_load_ushort v108,v113,s[12:15],s48 offen
s_add_u32 s43,s43,786432
s_add_u32 s48,s48,128
buffer_load_dwordx4 v[116:119],v112,s[16:19],s43 offen nt
buffer_load_ushort v120,v113,s[12:15],s48 offen
s_add_u32 s43,s43,786432
s_add_u32 s48,s48,128
v_mov_b32 v96,0
v_mov_b32 v97,0
v_mov_b32 v98,0
v_mov_b32 v99,0
v_mov_b32 v100,0
v_mov_b32 v101,0
v_mov_b32 v102,0
v_mov_b32 v103,0
s_waitcnt vmcnt(0)
qloop_202:
s_lshr_b32 s64,s79,2
s_cmp_lg_u32 s64,4
s_cbranch_scc1 np2_204
s_waitcnt vmcnt(0)
s_barrier
s_cmp_lg_u32 s50,0
s_cbranch_scc1 ow_205
s_mov_b64 exec,1
v_mov_b32 v22,14
v_mov_b32 v23,0
s_mov_b32 s64,21052928
buffer_atomic_add v22,v23,s[20:23],s64 offen sc1
s_mov_b64 exec,-1
ow_205:
np2_204:
s_cmp_lg_u32 s79,s41
s_cbranch_scc1 npz_203
s_waitcnt vmcnt(0)
s_barrier
s_cmp_lg_u32 s50,0
s_cbranch_scc1 ow_206
s_mov_b64 exec,1
v_mov_b32 v22,14
v_mov_b32 v23,0
s_mov_b32 s64,21052992
buffer_atomic_add v22,v23,s[20:23],s64 offen sc1
s_mov_b64 exec,-1
ow_206:
s_cmp_lg_u32 s50,0
s_cbranch_scc1 ow_207
s_mov_b64 exec,1
v_mov_b32 v22,14
v_mov_b32 v23,0
buffer_store_dword v22,v23,s[20:23],s73 offen sc1
s_mov_b64 exec,-1
ow_207:
npz_203:
s_waitcnt vmcnt(8)
s_barrier
ds_read_b128 v[224:227],v17 offset:0
ds_read_b128 v[228:231],v17 offset:2048
ds_read_b128 v[232:235],v17 offset:4096
ds_read_b128 v[236:239],v17 offset:6144
ds_read_b128 v[240:243],v17 offset:8192
ds_read_b128 v[244:247],v17 offset:10240
ds_read_b128 v[248:251],v17 offset:12288
s_waitcnt lgkmcnt(5)
v_mfma_f32_16x16x32_bf16 v[64:67],a[0:3],v[224:227],0
s_xor_b32 s72,s72,0x10000
s_add_u32 s77,s79,2
v_mfma_f32_16x16x32_bf16 v[72:75],a[128:131],v[224:227],0
ds_read_b128 v[252:255],v17 offset:14336
s_cmp_lt_u32 s79,56
s_cselect_b32 s77,s41,s77
v_mfma_f32_16x16x32_bf16 v[64:67],a[4:7],v[228:231],v[64:67]
s_add_u32 s74,s79,4
s_cmp_lt_u32 s79,52
s_cselect_b32 s77,s74,s77
v_mfma_f32_16x16x32_bf16 v[72:75],a[132:135],v[228:231],v[72:75]
ds_read_b128 v[224:227],v17 offset:16384
s_waitcnt lgkmcnt(5)
v_mfma_f32_16x16x32_bf16 v[64:67],a[8:11],v[232:235],v[64:67]
s_lshl_b32 s74,s77,16
s_add_u32 s74,s74,s76
v_mfma_f32_16x16x32_bf16 v[72:75],a[136:139],v[232:235],v[72:75]
ds_read_b128 v[228:231],v17 offset:18432
s_add_u32 s64,s79,0
v_mfma_f32_16x16x32_bf16 v[64:67],a[12:15],v[236:239],v[64:67]
s_cmp_lt_u32 s77,64
s_cselect_b32 s74,s74,0x7fff0000
v_mfma_f32_16x16x32_bf16 v[72:75],a[140:143],v[236:239],v[72:75]
ds_read_b128 v[232:235],v17 offset:20480
s_waitcnt lgkmcnt(5)
v_mfma_f32_16x16x32_bf16 v[64:67],a[16:19],v[240:243],v[64:67]
s_add_u32 m0,s72,0
v_lshlrev_b32 v108,16,v108
v_mfma_f32_16x16x32_bf16 v[72:75],a[144:147],v[240:243],v[72:75]
ds_read_b128 v[236:239],v17 offset:22528
v_mul_f32 v109,s81,v108
v_mfma_f32_16x16x32_bf16 v[64:67],a[20:23],v[244:247],v[64:67]
s_lshl_b32 s70,s64,21
v_mfma_f32_16x16x32_bf16 v[72:75],a[148:151],v[244:247],v[72:75]
ds_read_b128 v[240:243],v17 offset:24576
s_waitcnt lgkmcnt(5)
v_mfma_f32_16x16x32_bf16 v[64:67],a[24:27],v[248:251],v[64:67]
s_add_u32 s65,s74,0
v_mfma_f32_16x16x32_bf16 v[72:75],a[152:155],v[248:251],v[72:75]
ds_read_b128 v[244:247],v17 offset:26624
v_mfma_f32_16x16x32_bf16 v[64:67],a[28:31],v[252:255],v[64:67]
buffer_load_dwordx4 v16,s[20:23],s65 offen offset:0  lds
v_mfma_f32_16x16x32_bf16 v[72:75],a[156:159],v[252:255],v[72:75]
ds_read_b128 v[248:251],v17 offset:28672
s_waitcnt lgkmcnt(5)
v_mfma_f32_16x16x32_bf16 v[64:67],a[32:35],v[224:227],v[64:67]
s_lshl_b32 s64,s64,13
v_mfma_f32_16x16x32_bf16 v[72:75],a[160:163],v[224:227],v[72:75]
ds_read_b128 v[252:255],v17 offset:30720
v_mfma_f32_16x16x32_bf16 v[64:67],a[36:39],v[228:231],v[64:67]
buffer_load_dwordx4 v16,s[20:23],s65 offen offset:1024  lds
v_mfma_f32_16x16x32_bf16 v[72:75],a[164:167],v[228:231],v[72:75]
ds_read_b128 v[224:227],v17 offset:32768
s_waitcnt lgkmcnt(5)
v_mfma_f32_16x16x32_bf16 v[64:67],a[40:43],v[232:235],v[64:67]
buffer_load_dwordx4 v16,s[20:23],s65 offen offset:2048  lds
v_mfma_f32_16x16x32_bf16 v[72:75],a[168:171],v[232:235],v[72:75]
ds_read_b128 v[228:231],v17 offset:34816
s_and_b32 s64,s64,0x2000
v_mfma_f32_16x16x32_bf16 v[64:67],a[44:47],v[236:239],v[64:67]
v_exp_f32 v109,v109
v_mfma_f32_16x16x32_bf16 v[72:75],a[172:175],v[236:239],v[72:75]
ds_read_b128 v[232:235],v17 offset:36864
s_waitcnt lgkmcnt(5)
v_mfma_f32_16x16x32_bf16 v[64:67],a[48:51],v[240:243],v[64:67]
buffer_load_dwordx4 v16,s[20:23],s65 offen offset:3072  lds
v_mfma_f32_16x16x32_bf16 v[72:75],a[176:179],v[240:243],v[72:75]
ds_read_b128 v[236:239],v17 offset:38912
s_xor_b32 s64,s64,s62
v_mfma_f32_16x16x32_bf16 v[64:67],a[52:55],v[244:247],v[64:67]
s_add_u32 m0,s72,4096
v_add_f32 v109,1.0,v109
v_mfma_f32_16x16x32_bf16 v[72:75],a[180:183],v[244:247],v[72:75]
ds_read_b128 v[240:243],v17 offset:40960
s_waitcnt lgkmcnt(5)
v_mfma_f32_16x16x32_bf16 v[64:67],a[56:59],v[248:251],v[64:67]
v_rcp_f32 v109,v109
v_mfma_f32_16x16x32_bf16 v[72:75],a[184:187],v[248:251],v[72:75]
ds_read_b128 v[244:247],v17 offset:43008
s_add_u32 s65,s74,4096
v_mfma_f32_16x16x32_bf16 v[64:67],a[60:63],v[252:255],v[64:67]
s_add_u32 s70,s70,s64
v_mul_f32 v109,v109,v108
v_mfma_f32_16x16x32_bf16 v[72:75],a[188:191],v[252:255],v[72:75]
ds_read_b128 v[248:251],v17 offset:45056
s_waitcnt lgkmcnt(5)
v_mfma_f32_16x16x32_bf16 v[64:67],a[64:67],v[224:227],v[64:67]
buffer_load_dwordx4 v16,s[20:23],s65 offen offset:0  lds
v_mfma_f32_16x16x32_bf16 v[72:75],a[192:195],v[224:227],v[72:75]
ds_read_b128 v[252:255],v17 offset:47104
v_cvt_pk_bf16_f32 v109,v109,v109
v_mfma_f32_16x16x32_bf16 v[64:67],a[68:71],v[228:231],v[64:67]
v_and_b32 v108,s80,v109
v_lshlrev_b32 v110,16,v104
v_mfma_f32_16x16x32_bf16 v[72:75],a[196:199],v[228:231],v[72:75]
ds_read_b128 v[224:227],v17 offset:49152
s_waitcnt lgkmcnt(5)
v_mfma_f32_16x16x32_bf16 v[64:67],a[72:75],v[232:235],v[64:67]
buffer_load_dwordx4 v16,s[20:23],s65 offen offset:1024  lds
v_mfma_f32_16x16x32_bf16 v[72:75],a[200:203],v[232:235],v[72:75]
ds_read_b128 v[228:231],v17 offset:51200
s_add_u32 s70,s70,29360128
v_mfma_f32_16x16x32_bf16 v[64:67],a[76:79],v[236:239],v[64:67]
buffer_load_dwordx4 v16,s[20:23],s65 offen offset:2048  lds
v_mfma_f32_16x16x32_bf16 v[72:75],a[204:207],v[236:239],v[72:75]
ds_read_b128 v[232:235],v17 offset:53248
s_waitcnt lgkmcnt(5)
v_mfma_f32_16x16x32_bf16 v[64:67],a[80:83],v[240:243],v[64:67]
v_and_b32 v111,s80,v104
v_fmac_f32 v96,v110,v108
v_mfma_f32_16x16x32_bf16 v[72:75],a[208:211],v[240:243],v[72:75]
ds_read_b128 v[236:239],v17 offset:55296
v_fmac_f32 v97,v111,v108
v_mfma_f32_16x16x32_bf16 v[64:67],a[84:87],v[244:247],v[64:67]
buffer_load_dwordx4 v16,s[20:23],s65 offen offset:3072  lds
v_mfma_f32_16x16x32_bf16 v[72:75],a[212:215],v[244:247],v[72:75]
ds_read_b128 v[240:243],v17 offset:57344
s_waitcnt lgkmcnt(5)
v_mfma_f32_16x16x32_bf16 v[64:67],a[88:91],v[248:251],v[64:67]
s_add_u32 m0,s72,8192
v_lshlrev_b32 v110,16,v105
v_mfma_f32_16x16x32_bf16 v[72:75],a[216:219],v[248:251],v[72:75]
ds_read_b128 v[244:247],v17 offset:59392
v_and_b32 v111,s80,v105
v_mfma_f32_16x16x32_bf16 v[64:67],a[92:95],v[252:255],v[64:67]
v_fmac_f32 v98,v110,v108
v_fmac_f32 v99,v111,v108
v_mfma_f32_16x16x32_bf16 v[72:75],a[220:223],v[252:255],v[72:75]
ds_read_b128 v[248:251],v17 offset:61440
s_waitcnt lgkmcnt(5)
v_mfma_f32_16x16x32_bf16 v[64:67],a[96:99],v[224:227],v[64:67]
s_add_u32 s65,s74,8192
v_lshlrev_b32 v110,16,v106
v_mfma_f32_16x16x32_bf16 v[72:75],a[224:227],v[224:227],v[72:75]
ds_read_b128 v[252:255],v17 offset:63488
v_and_b32 v111,s80,v106
v_mfma_f32_16x16x32_bf16 v[64:67],a[100:103],v[228:231],v[64:67]
buffer_load_dwordx4 v16,s[20:23],s65 offen offset:0  lds
v_mfma_f32_16x16x32_bf16 v[72:75],a[228:231],v[228:231],v[72:75]
ds_read_b128 v[224:227],v17 offset:1024
s_waitcnt lgkmcnt(5)
v_mfma_f32_16x16x32_bf16 v[64:67],a[104:107],v[232:235],v[64:67]
v_fmac_f32 v100,v110,v108
v_fmac_f32 v101,v111,v108
v_mfma_f32_16x16x32_bf16 v[72:75],a[232:235],v[232:235],v[72:75]
ds_read_b128 v[228:231],v17 offset:3072
v_lshlrev_b32 v110,16,v107
v_mfma_f32_16x16x32_bf16 v[64:67],a[108:111],v[236:239],v[64:67]
buffer_load_dwordx4 v16,s[20:23],s65 offen offset:1024  lds
v_mfma_f32_16x16x32_bf16 v[72:75],a[236:239],v[236:239],v[72:75]
ds_read_b128 v[232:235],v17 offset:5120
s_waitcnt lgkmcnt(5)
v_mfma_f32_16x16x32_bf16 v[64:67],a[112:115],v[240:243],v[64:67]
buffer_load_dwordx4 v16,s[20:23],s65 offen offset:2048  lds
v_mfma_f32_16x16x32_bf16 v[72:75],a[240:243],v[240:243],v[72:75]
ds_read_b128 v[236:239],v17 offset:7168
v_and_b32 v111,s80,v107
v_mfma_f32_16x16x32_bf16 v[64:67],a[116:119],v[244:247],v[64:67]
v_fmac_f32 v102,v110,v108
v_fmac_f32 v103,v111,v108
v_mfma_f32_16x16x32_bf16 v[72:75],a[244:247],v[244:247],v[72:75]
ds_read_b128 v[240:243],v17 offset:9216
s_waitcnt lgkmcnt(5)
v_mfma_f32_16x16x32_bf16 v[64:67],a[120:123],v[248:251],v[64:67]
buffer_load_dwordx4 v16,s[20:23],s65 offen offset:3072  lds
v_mfma_f32_16x16x32_bf16 v[72:75],a[248:251],v[248:251],v[72:75]
ds_read_b128 v[244:247],v17 offset:11264
v_mfma_f32_16x16x32_bf16 v[64:67],a[124:127],v[252:255],v[64:67]
s_add_u32 m0,s72,12288
v_mfma_f32_16x16x32_bf16 v[72:75],a[252:255],v[252:255],v[72:75]
ds_read_b128 v[248:251],v17 offset:13312
s_waitcnt lgkmcnt(5)
v_mfma_f32_16x16x32_bf16 v[68:71],a[0:3],v[224:227],0
v_mfma_f32_16x16x32_bf16 v[76:79],a[128:131],v[224:227],0
ds_read_b128 v[252:255],v17 offset:15360
s_add_u32 s65,s74,12288
v_mfma_f32_16x16x32_bf16 v[68:71],a[4:7],v[228:231],v[68:71]
v_mfma_f32_16x16x32_bf16 v[76:79],a[132:135],v[228:231],v[76:79]
ds_read_b128 v[224:227],v17 offset:17408
s_waitcnt lgkmcnt(5)
v_mfma_f32_16x16x32_bf16 v[68:71],a[8:11],v[232:235],v[68:71]
buffer_load_dwordx4 v16,s[20:23],s65 offen offset:0  lds
v_mfma_f32_16x16x32_bf16 v[76:79],a[136:139],v[232:235],v[76:79]
ds_read_b128 v[228:231],v17 offset:19456
v_cvt_pk_bf16_f32 v88,v64,v65
v_mfma_f32_16x16x32_bf16 v[68:71],a[12:15],v[236:239],v[68:71]
v_cvt_pk_bf16_f32 v89,v66,v67
v_cvt_pk_bf16_f32 v90,v72,v73
v_mfma_f32_16x16x32_bf16 v[76:79],a[140:143],v[236:239],v[76:79]
ds_read_b128 v[232:235],v17 offset:21504
s_waitcnt lgkmcnt(5)
v_mfma_f32_16x16x32_bf16 v[68:71],a[16:19],v[240:243],v[68:71]
buffer_load_dwordx4 v16,s[20:23],s65 offen offset:1024  lds
v_mfma_f32_16x16x32_bf16 v[76:79],a[144:147],v[240:243],v[76:79]
ds_read_b128 v[236:239],v17 offset:23552
v_cvt_pk_bf16_f32 v91,v74,v75
v_mfma_f32_16x16x32_bf16 v[68:71],a[20:23],v[244:247],v[68:71]
buffer_load_dwordx4 v16,s[20:23],s65 offen offset:2048  lds
v_mfma_f32_16x16x32_bf16 v[76:79],a[148:151],v[244:247],v[76:79]
ds_read_b128 v[240:243],v17 offset:25600
s_waitcnt lgkmcnt(5)
v_mfma_f32_16x16x32_bf16 v[68:71],a[24:27],v[248:251],v[68:71]
v_mfma_f32_16x16x32_bf16 v[76:79],a[152:155],v[248:251],v[76:79]
ds_read_b128 v[244:247],v17 offset:27648
v_mfma_f32_16x16x32_bf16 v[68:71],a[28:31],v[252:255],v[68:71]
buffer_load_dwordx4 v16,s[20:23],s65 offen offset:3072  lds
v_mfma_f32_16x16x32_bf16 v[76:79],a[156:159],v[252:255],v[76:79]
ds_read_b128 v[248:251],v17 offset:29696
s_waitcnt lgkmcnt(5)
v_mfma_f32_16x16x32_bf16 v[68:71],a[32:35],v[224:227],v[68:71]
v_mfma_f32_16x16x32_bf16 v[76:79],a[160:163],v[224:227],v[76:79]
ds_read_b128 v[252:255],v17 offset:31744
v_mfma_f32_16x16x32_bf16 v[68:71],a[36:39],v[228:231],v[68:71]
v_mfma_f32_16x16x32_bf16 v[76:79],a[164:167],v[228:231],v[76:79]
ds_read_b128 v[224:227],v17 offset:33792
s_waitcnt lgkmcnt(5)
v_mfma_f32_16x16x32_bf16 v[68:71],a[40:43],v[232:235],v[68:71]
buffer_store_dwordx4 v[88:91],v18,s[20:23],s70 offen offset:0 sc1
v_mfma_f32_16x16x32_bf16 v[76:79],a[168:171],v[232:235],v[76:79]
ds_read_b128 v[228:231],v17 offset:35840
v_mfma_f32_16x16x32_bf16 v[68:71],a[44:47],v[236:239],v[68:71]
buffer_load_dwordx4 v[104:107],v112,s[16:19],s43 offen nt
v_mfma_f32_16x16x32_bf16 v[76:79],a[172:175],v[236:239],v[76:79]
ds_read_b128 v[232:235],v17 offset:37888
s_waitcnt lgkmcnt(5)
v_mfma_f32_16x16x32_bf16 v[68:71],a[48:51],v[240:243],v[68:71]
v_mfma_f32_16x16x32_bf16 v[76:79],a[176:179],v[240:243],v[76:79]
ds_read_b128 v[236:239],v17 offset:39936
v_mfma_f32_16x16x32_bf16 v[68:71],a[52:55],v[244:247],v[68:71]
buffer_load_ushort v108,v113,s[12:15],s48 offen
v_mfma_f32_16x16x32_bf16 v[76:79],a[180:183],v[244:247],v[76:79]
ds_read_b128 v[240:243],v17 offset:41984
s_waitcnt lgkmcnt(5)
v_mfma_f32_16x16x32_bf16 v[68:71],a[56:59],v[248:251],v[68:71]
s_add_u32 s43,s43,786432
v_mfma_f32_16x16x32_bf16 v[76:79],a[184:187],v[248:251],v[76:79]
ds_read_b128 v[244:247],v17 offset:44032
v_mfma_f32_16x16x32_bf16 v[68:71],a[60:63],v[252:255],v[68:71]
v_mfma_f32_16x16x32_bf16 v[76:79],a[188:191],v[252:255],v[76:79]
ds_read_b128 v[248:251],v17 offset:46080
s_waitcnt lgkmcnt(5)
v_mfma_f32_16x16x32_bf16 v[68:71],a[64:67],v[224:227],v[68:71]
s_add_u32 s48,s48,128
v_mfma_f32_16x16x32_bf16 v[76:79],a[192:195],v[224:227],v[76:79]
ds_read_b128 v[252:255],v17 offset:48128
v_mfma_f32_16x16x32_bf16 v[68:71],a[68:71],v[228:231],v[68:71]
buffer_store_dwordx4 v[48:51],v24,s[20:23],s93 offen sc1
v_mfma_f32_16x16x32_bf16 v[76:79],a[196:199],v[228:231],v[76:79]
ds_read_b128 v[224:227],v17 offset:50176
s_waitcnt lgkmcnt(5)
v_mfma_f32_16x16x32_bf16 v[68:71],a[72:75],v[232:235],v[68:71]
v_mfma_f32_16x16x32_bf16 v[76:79],a[200:203],v[232:235],v[76:79]
ds_read_b128 v[228:231],v17 offset:52224
v_mfma_f32_16x16x32_bf16 v[68:71],a[76:79],v[236:239],v[68:71]
buffer_store_dwordx4 v[48:51],v25,s[20:23],s93 offen sc1
v_mfma_f32_16x16x32_bf16 v[76:79],a[204:207],v[236:239],v[76:79]
ds_read_b128 v[232:235],v17 offset:54272
s_waitcnt lgkmcnt(5)
v_mfma_f32_16x16x32_bf16 v[68:71],a[80:83],v[240:243],v[68:71]
s_add_u32 s93,s93,8388608
v_mfma_f32_16x16x32_bf16 v[76:79],a[208:211],v[240:243],v[76:79]
ds_read_b128 v[236:239],v17 offset:56320
v_mfma_f32_16x16x32_bf16 v[68:71],a[84:87],v[244:247],v[68:71]
v_mfma_f32_16x16x32_bf16 v[76:79],a[212:215],v[244:247],v[76:79]
ds_read_b128 v[240:243],v17 offset:58368
s_waitcnt lgkmcnt(5)
v_mfma_f32_16x16x32_bf16 v[68:71],a[88:91],v[248:251],v[68:71]
s_cmp_lt_u32 s93,163577856
s_cselect_b32 s93,s93,0x7fff0000
v_mfma_f32_16x16x32_bf16 v[76:79],a[216:219],v[248:251],v[76:79]
ds_read_b128 v[244:247],v17 offset:60416
v_mfma_f32_16x16x32_bf16 v[68:71],a[92:95],v[252:255],v[68:71]
buffer_store_dwordx4 v[48:51],v24,s[20:23],s42 offen sc1
v_mfma_f32_16x16x32_bf16 v[76:79],a[220:223],v[252:255],v[76:79]
ds_read_b128 v[248:251],v17 offset:62464
s_waitcnt lgkmcnt(5)
v_mfma_f32_16x16x32_bf16 v[68:71],a[96:99],v[224:227],v[68:71]
v_mfma_f32_16x16x32_bf16 v[76:79],a[224:227],v[224:227],v[76:79]
ds_read_b128 v[252:255],v17 offset:64512
v_mfma_f32_16x16x32_bf16 v[68:71],a[100:103],v[228:231],v[68:71]
buffer_store_dwordx4 v[48:51],v25,s[20:23],s42 offen sc1
v_mfma_f32_16x16x32_bf16 v[76:79],a[228:231],v[228:231],v[76:79]
s_waitcnt lgkmcnt(4)
v_mfma_f32_16x16x32_bf16 v[68:71],a[104:107],v[232:235],v[68:71]
s_add_u32 s42,s42,2097152
v_mfma_f32_16x16x32_bf16 v[76:79],a[232:235],v[232:235],v[76:79]
v_mfma_f32_16x16x32_bf16 v[68:71],a[108:111],v[236:239],v[68:71]
v_mfma_f32_16x16x32_bf16 v[76:79],a[236:239],v[236:239],v[76:79]
s_xor_b32 s42,s42,0x2000
s_waitcnt lgkmcnt(2)
v_mfma_f32_16x16x32_bf16 v[68:71],a[112:115],v[240:243],v[68:71]
v_mfma_f32_16x16x32_bf16 v[76:79],a[240:243],v[240:243],v[76:79]
v_mfma_f32_16x16x32_bf16 v[68:71],a[116:119],v[244:247],v[68:71]
s_cmp_lt_u32 s42,165675008
s_cselect_b32 s42,s42,0x7fff0000
v_mfma_f32_16x16x32_bf16 v[76:79],a[244:247],v[244:247],v[76:79]
s_waitcnt lgkmcnt(0)
v_mfma_f32_16x16x32_bf16 v[68:71],a[120:123],v[248:251],v[68:71]
v_mfma_f32_16x16x32_bf16 v[76:79],a[248:251],v[248:251],v[76:79]
v_mfma_f32_16x16x32_bf16 v[68:71],a[124:127],v[252:255],v[68:71]
v_mfma_f32_16x16x32_bf16 v[76:79],a[252:255],v[252:255],v[76:79]
v_xor_b32 v17,0x10000,v17
s_mov_b32 s79,s77
s_nop 4
v_cvt_pk_bf16_f32 v92,v68,v69
v_cvt_pk_bf16_f32 v93,v70,v71
v_cvt_pk_bf16_f32 v94,v76,v77
v_cvt_pk_bf16_f32 v95,v78,v79
buffer_store_dwordx4 v[92:95],v18,s[20:23],s70 offen offset:1024 sc1
s_waitcnt vmcnt(8)
s_barrier
ds_read_b128 v[224:227],v17 offset:0
ds_read_b128 v[228:231],v17 offset:2048
ds_read_b128 v[232:235],v17 offset:4096
ds_read_b128 v[236:239],v17 offset:6144
ds_read_b128 v[240:243],v17 offset:8192
ds_read_b128 v[244:247],v17 offset:10240
ds_read_b128 v[248:251],v17 offset:12288
s_waitcnt lgkmcnt(5)
v_mfma_f32_16x16x32_bf16 v[64:67],a[0:3],v[224:227],0
s_xor_b32 s72,s72,0x10000
s_add_u32 s77,s79,2
v_mfma_f32_16x16x32_bf16 v[72:75],a[128:131],v[224:227],0
ds_read_b128 v[252:255],v17 offset:14336
s_cmp_lt_u32 s79,56
s_cselect_b32 s77,s41,s77
v_mfma_f32_16x16x32_bf16 v[64:67],a[4:7],v[228:231],v[64:67]
s_add_u32 s74,s79,4
s_cmp_lt_u32 s79,52
s_cselect_b32 s77,s74,s77
v_mfma_f32_16x16x32_bf16 v[72:75],a[132:135],v[228:231],v[72:75]
ds_read_b128 v[224:227],v17 offset:16384
s_waitcnt lgkmcnt(5)
v_mfma_f32_16x16x32_bf16 v[64:67],a[8:11],v[232:235],v[64:67]
s_lshl_b32 s74,s77,16
s_add_u32 s74,s74,s76
v_mfma_f32_16x16x32_bf16 v[72:75],a[136:139],v[232:235],v[72:75]
ds_read_b128 v[228:231],v17 offset:18432
s_add_u32 s64,s79,0
v_mfma_f32_16x16x32_bf16 v[64:67],a[12:15],v[236:239],v[64:67]
s_cmp_lt_u32 s77,64
s_cselect_b32 s74,s74,0x7fff0000
v_mfma_f32_16x16x32_bf16 v[72:75],a[140:143],v[236:239],v[72:75]
ds_read_b128 v[232:235],v17 offset:20480
s_waitcnt lgkmcnt(5)
v_mfma_f32_16x16x32_bf16 v[64:67],a[16:19],v[240:243],v[64:67]
s_add_u32 m0,s72,0
v_lshlrev_b32 v120,16,v120
v_mfma_f32_16x16x32_bf16 v[72:75],a[144:147],v[240:243],v[72:75]
ds_read_b128 v[236:239],v17 offset:22528
v_mul_f32 v109,s81,v120
v_mfma_f32_16x16x32_bf16 v[64:67],a[20:23],v[244:247],v[64:67]
s_lshl_b32 s70,s64,21
v_mfma_f32_16x16x32_bf16 v[72:75],a[148:151],v[244:247],v[72:75]
ds_read_b128 v[240:243],v17 offset:24576
s_waitcnt lgkmcnt(5)
v_mfma_f32_16x16x32_bf16 v[64:67],a[24:27],v[248:251],v[64:67]
s_add_u32 s65,s74,0
v_mfma_f32_16x16x32_bf16 v[72:75],a[152:155],v[248:251],v[72:75]
ds_read_b128 v[244:247],v17 offset:26624
v_mfma_f32_16x16x32_bf16 v[64:67],a[28:31],v[252:255],v[64:67]
buffer_load_dwordx4 v16,s[20:23],s65 offen offset:0  lds
v_mfma_f32_16x16x32_bf16 v[72:75],a[156:159],v[252:255],v[72:75]
ds_read_b128 v[248:251],v17 offset:28672
s_waitcnt lgkmcnt(5)
v_mfma_f32_16x16x32_bf16 v[64:67],a[32:35],v[224:227],v[64:67]
s_lshl_b32 s64,s64,13
v_mfma_f32_16x16x32_bf16 v[72:75],a[160:163],v[224:227],v[72:75]
ds_read_b128 v[252:255],v17 offset:30720
v_mfma_f32_16x16x32_bf16 v[64:67],a[36:39],v[228:231],v[64:67]
buffer_load_dwordx4 v16,s[20:23],s65 offen offset:1024  lds
v_mfma_f32_16x16x32_bf16 v[72:75],a[164:167],v[228:231],v[72:75]
ds_read_b128 v[224:227],v17 offset:32768
s_waitcnt lgkmcnt(5)
v_mfma_f32_16x16x32_bf16 v[64:67],a[40:43],v[232:235],v[64:67]
buffer_load_dwordx4 v16,s[20:23],s65 offen offset:2048  lds
v_mfma_f32_16x16x32_bf16 v[72:75],a[168:171],v[232:235],v[72:75]
ds_read_b128 v[228:231],v17 offset:34816
s_and_b32 s64,s64,0x2000
v_mfma_f32_16x16x32_bf16 v[64:67],a[44:47],v[236:239],v[64:67]
v_exp_f32 v109,v109
v_mfma_f32_16x16x32_bf16 v[72:75],a[172:175],v[236:239],v[72:75]
ds_read_b128 v[232:235],v17 offset:36864
s_waitcnt lgkmcnt(5)
v_mfma_f32_16x16x32_bf16 v[64:67],a[48:51],v[240:243],v[64:67]
buffer_load_dwordx4 v16,s[20:23],s65 offen offset:3072  lds
v_mfma_f32_16x16x32_bf16 v[72:75],a[176:179],v[240:243],v[72:75]
ds_read_b128 v[236:239],v17 offset:38912
s_xor_b32 s64,s64,s62
v_mfma_f32_16x16x32_bf16 v[64:67],a[52:55],v[244:247],v[64:67]
s_add_u32 m0,s72,4096
v_add_f32 v109,1.0,v109
v_mfma_f32_16x16x32_bf16 v[72:75],a[180:183],v[244:247],v[72:75]
ds_read_b128 v[240:243],v17 offset:40960
s_waitcnt lgkmcnt(5)
v_mfma_f32_16x16x32_bf16 v[64:67],a[56:59],v[248:251],v[64:67]
v_rcp_f32 v109,v109
v_mfma_f32_16x16x32_bf16 v[72:75],a[184:187],v[248:251],v[72:75]
ds_read_b128 v[244:247],v17 offset:43008
s_add_u32 s65,s74,4096
v_mfma_f32_16x16x32_bf16 v[64:67],a[60:63],v[252:255],v[64:67]
s_add_u32 s70,s70,s64
v_mul_f32 v109,v109,v120
v_mfma_f32_16x16x32_bf16 v[72:75],a[188:191],v[252:255],v[72:75]
ds_read_b128 v[248:251],v17 offset:45056
s_waitcnt lgkmcnt(5)
v_mfma_f32_16x16x32_bf16 v[64:67],a[64:67],v[224:227],v[64:67]
buffer_load_dwordx4 v16,s[20:23],s65 offen offset:0  lds
v_mfma_f32_16x16x32_bf16 v[72:75],a[192:195],v[224:227],v[72:75]
ds_read_b128 v[252:255],v17 offset:47104
v_cvt_pk_bf16_f32 v109,v109,v109
v_mfma_f32_16x16x32_bf16 v[64:67],a[68:71],v[228:231],v[64:67]
v_and_b32 v120,s80,v109
v_lshlrev_b32 v110,16,v116
v_mfma_f32_16x16x32_bf16 v[72:75],a[196:199],v[228:231],v[72:75]
ds_read_b128 v[224:227],v17 offset:49152
s_waitcnt lgkmcnt(5)
v_mfma_f32_16x16x32_bf16 v[64:67],a[72:75],v[232:235],v[64:67]
buffer_load_dwordx4 v16,s[20:23],s65 offen offset:1024  lds
v_mfma_f32_16x16x32_bf16 v[72:75],a[200:203],v[232:235],v[72:75]
ds_read_b128 v[228:231],v17 offset:51200
s_add_u32 s70,s70,29360128
v_mfma_f32_16x16x32_bf16 v[64:67],a[76:79],v[236:239],v[64:67]
buffer_load_dwordx4 v16,s[20:23],s65 offen offset:2048  lds
v_mfma_f32_16x16x32_bf16 v[72:75],a[204:207],v[236:239],v[72:75]
ds_read_b128 v[232:235],v17 offset:53248
s_waitcnt lgkmcnt(5)
v_mfma_f32_16x16x32_bf16 v[64:67],a[80:83],v[240:243],v[64:67]
v_and_b32 v111,s80,v116
v_fmac_f32 v96,v110,v120
v_mfma_f32_16x16x32_bf16 v[72:75],a[208:211],v[240:243],v[72:75]
ds_read_b128 v[236:239],v17 offset:55296
v_fmac_f32 v97,v111,v120
v_mfma_f32_16x16x32_bf16 v[64:67],a[84:87],v[244:247],v[64:67]
buffer_load_dwordx4 v16,s[20:23],s65 offen offset:3072  lds
v_mfma_f32_16x16x32_bf16 v[72:75],a[212:215],v[244:247],v[72:75]
ds_read_b128 v[240:243],v17 offset:57344
s_waitcnt lgkmcnt(5)
v_mfma_f32_16x16x32_bf16 v[64:67],a[88:91],v[248:251],v[64:67]
s_add_u32 m0,s72,8192
v_lshlrev_b32 v110,16,v117
v_mfma_f32_16x16x32_bf16 v[72:75],a[216:219],v[248:251],v[72:75]
ds_read_b128 v[244:247],v17 offset:59392
v_and_b32 v111,s80,v117
v_mfma_f32_16x16x32_bf16 v[64:67],a[92:95],v[252:255],v[64:67]
v_fmac_f32 v98,v110,v120
v_fmac_f32 v99,v111,v120
v_mfma_f32_16x16x32_bf16 v[72:75],a[220:223],v[252:255],v[72:75]
ds_read_b128 v[248:251],v17 offset:61440
s_waitcnt lgkmcnt(5)
v_mfma_f32_16x16x32_bf16 v[64:67],a[96:99],v[224:227],v[64:67]
s_add_u32 s65,s74,8192
v_lshlrev_b32 v110,16,v118
v_mfma_f32_16x16x32_bf16 v[72:75],a[224:227],v[224:227],v[72:75]
ds_read_b128 v[252:255],v17 offset:63488
v_and_b32 v111,s80,v118
v_mfma_f32_16x16x32_bf16 v[64:67],a[100:103],v[228:231],v[64:67]
buffer_load_dwordx4 v16,s[20:23],s65 offen offset:0  lds
v_mfma_f32_16x16x32_bf16 v[72:75],a[228:231],v[228:231],v[72:75]
ds_read_b128 v[224:227],v17 offset:1024
s_waitcnt lgkmcnt(5)
v_mfma_f32_16x16x32_bf16 v[64:67],a[104:107],v[232:235],v[64:67]
v_fmac_f32 v100,v110,v120
v_fmac_f32 v101,v111,v120
v_mfma_f32_16x16x32_bf16 v[72:75],a[232:235],v[232:235],v[72:75]
ds_read_b128 v[228:231],v17 offset:3072
v_lshlrev_b32 v110,16,v119
v_mfma_f32_16x16x32_bf16 v[64:67],a[108:111],v[236:239],v[64:67]
buffer_load_dwordx4 v16,s[20:23],s65 offen offset:1024  lds
v_mfma_f32_16x16x32_bf16 v[72:75],a[236:239],v[236:239],v[72:75]
ds_read_b128 v[232:235],v17 offset:5120
s_waitcnt lgkmcnt(5)
v_mfma_f32_16x16x32_bf16 v[64:67],a[112:115],v[240:243],v[64:67]
buffer_load_dwordx4 v16,s[20:23],s65 offen offset:2048  lds
v_mfma_f32_16x16x32_bf16 v[72:75],a[240:243],v[240:243],v[72:75]
ds_read_b128 v[236:239],v17 offset:7168
v_and_b32 v111,s80,v119
v_mfma_f32_16x16x32_bf16 v[64:67],a[116:119],v[244:247],v[64:67]
v_fmac_f32 v102,v110,v120
v_fmac_f32 v103,v111,v120
v_mfma_f32_16x16x32_bf16 v[72:75],a[244:247],v[244:247],v[72:75]
ds_read_b128 v[240:243],v17 offset:9216
s_waitcnt lgkmcnt(5)
v_mfma_f32_16x16x32_bf16 v[64:67],a[120:123],v[248:251],v[64:67]
buffer_load_dwordx4 v16,s[20:23],s65 offen offset:3072  lds
v_mfma_f32_16x16x32_bf16 v[72:75],a[248:251],v[248:251],v[72:75]
ds_read_b128 v[244:247],v17 offset:11264
v_mfma_f32_16x16x32_bf16 v[64:67],a[124:127],v[252:255],v[64:67]
s_add_u32 m0,s72,12288
v_mfma_f32_16x16x32_bf16 v[72:75],a[252:255],v[252:255],v[72:75]
ds_read_b128 v[248:251],v17 offset:13312
s_waitcnt lgkmcnt(5)
v_mfma_f32_16x16x32_bf16 v[68:71],a[0:3],v[224:227],0
v_mfma_f32_16x16x32_bf16 v[76:79],a[128:131],v[224:227],0
ds_read_b128 v[252:255],v17 offset:15360
s_add_u32 s65,s74,12288
v_mfma_f32_16x16x32_bf16 v[68:71],a[4:7],v[228:231],v[68:71]
v_mfma_f32_16x16x32_bf16 v[76:79],a[132:135],v[228:231],v[76:79]
ds_read_b128 v[224:227],v17 offset:17408
s_waitcnt lgkmcnt(5)
v_mfma_f32_16x16x32_bf16 v[68:71],a[8:11],v[232:235],v[68:71]
buffer_load_dwordx4 v16,s[20:23],s65 offen offset:0  lds
v_mfma_f32_16x16x32_bf16 v[76:79],a[136:139],v[232:235],v[76:79]
ds_read_b128 v[228:231],v17 offset:19456
v_cvt_pk_bf16_f32 v88,v64,v65
v_mfma_f32_16x16x32_bf16 v[68:71],a[12:15],v[236:239],v[68:71]
v_cvt_pk_bf16_f32 v89,v66,v67
v_cvt_pk_bf16_f32 v90,v72,v73
v_mfma_f32_16x16x32_bf16 v[76:79],a[140:143],v[236:239],v[76:79]
ds_read_b128 v[232:235],v17 offset:21504
s_waitcnt lgkmcnt(5)
v_mfma_f32_16x16x32_bf16 v[68:71],a[16:19],v[240:243],v[68:71]
buffer_load_dwordx4 v16,s[20:23],s65 offen offset:1024  lds
v_mfma_f32_16x16x32_bf16 v[76:79],a[144:147],v[240:243],v[76:79]
ds_read_b128 v[236:239],v17 offset:23552
v_cvt_pk_bf16_f32 v91,v74,v75
v_mfma_f32_16x16x32_bf16 v[68:71],a[20:23],v[244:247],v[68:71]
buffer_load_dwordx4 v16,s[20:23],s65 offen offset:2048  lds
v_mfma_f32_16x16x32_bf16 v[76:79],a[148:151],v[244:247],v[76:79]
ds_read_b128 v[240:243],v17 offset:25600
s_waitcnt lgkmcnt(5)
v_mfma_f32_16x16x32_bf16 v[68:71],a[24:27],v[248:251],v[68:71]
v_mfma_f32_16x16x32_bf16 v[76:79],a[152:155],v[248:251],v[76:79]
ds_read_b128 v[244:247],v17 offset:27648
v_mfma_f32_16x16x32_bf16 v[68:71],a[28:31],v[252:255],v[68:71]
buffer_load_dwordx4 v16,s[20:23],s65 offen offset:3072  lds
v_mfma_f32_16x16x32_bf16 v[76:79],a[156:159],v[252:255],v[76:79]
ds_read_b128 v[248:251],v17 offset:29696
s_waitcnt lgkmcnt(5)
v_mfma_f32_16x16x32_bf16 v[68:71],a[32:35],v[224:227],v[68:71]
v_mfma_f32_16x16x32_bf16 v[76:79],a[160:163],v[224:227],v[76:79]
ds_read_b128 v[252:255],v17 offset:31744
v_mfma_f32_16x16x32_bf16 v[68:71],a[36:39],v[228:231],v[68:71]
v_mfma_f32_16x16x32_bf16 v[76:79],a[164:167],v[228:231],v[76:79]
ds_read_b128 v[224:227],v17 offset:33792
s_waitcnt lgkmcnt(5)
v_mfma_f32_16x16x32_bf16 v[68:71],a[40:43],v[232:235],v[68:71]
buffer_store_dwordx4 v[88:91],v18,s[20:23],s70 offen offset:0 sc1
v_mfma_f32_16x16x32_bf16 v[76:79],a[168:171],v[232:235],v[76:79]
ds_read_b128 v[228:231],v17 offset:35840
v_mfma_f32_16x16x32_bf16 v[68:71],a[44:47],v[236:239],v[68:71]
buffer_load_dwordx4 v[116:119],v112,s[16:19],s43 offen nt
v_mfma_f32_16x16x32_bf16 v[76:79],a[172:175],v[236:239],v[76:79]
ds_read_b128 v[232:235],v17 offset:37888
s_waitcnt lgkmcnt(5)
v_mfma_f32_16x16x32_bf16 v[68:71],a[48:51],v[240:243],v[68:71]
v_mfma_f32_16x16x32_bf16 v[76:79],a[176:179],v[240:243],v[76:79]
ds_read_b128 v[236:239],v17 offset:39936
v_mfma_f32_16x16x32_bf16 v[68:71],a[52:55],v[244:247],v[68:71]
buffer_load_ushort v120,v113,s[12:15],s48 offen
v_mfma_f32_16x16x32_bf16 v[76:79],a[180:183],v[244:247],v[76:79]
ds_read_b128 v[240:243],v17 offset:41984
s_waitcnt lgkmcnt(5)
v_mfma_f32_16x16x32_bf16 v[68:71],a[56:59],v[248:251],v[68:71]
s_add_u32 s43,s43,786432
v_mfma_f32_16x16x32_bf16 v[76:79],a[184:187],v[248:251],v[76:79]
ds_read_b128 v[244:247],v17 offset:44032
v_mfma_f32_16x16x32_bf16 v[68:71],a[60:63],v[252:255],v[68:71]
v_mfma_f32_16x16x32_bf16 v[76:79],a[188:191],v[252:255],v[76:79]
ds_read_b128 v[248:251],v17 offset:46080
s_waitcnt lgkmcnt(5)
v_mfma_f32_16x16x32_bf16 v[68:71],a[64:67],v[224:227],v[68:71]
s_add_u32 s48,s48,128
v_mfma_f32_16x16x32_bf16 v[76:79],a[192:195],v[224:227],v[76:79]
ds_read_b128 v[252:255],v17 offset:48128
v_mfma_f32_16x16x32_bf16 v[68:71],a[68:71],v[228:231],v[68:71]
buffer_store_dwordx4 v[48:51],v24,s[20:23],s93 offen sc1
v_mfma_f32_16x16x32_bf16 v[76:79],a[196:199],v[228:231],v[76:79]
ds_read_b128 v[224:227],v17 offset:50176
s_waitcnt lgkmcnt(5)
v_mfma_f32_16x16x32_bf16 v[68:71],a[72:75],v[232:235],v[68:71]
v_mfma_f32_16x16x32_bf16 v[76:79],a[200:203],v[232:235],v[76:79]
ds_read_b128 v[228:231],v17 offset:52224
v_mfma_f32_16x16x32_bf16 v[68:71],a[76:79],v[236:239],v[68:71]
buffer_store_dwordx4 v[48:51],v25,s[20:23],s93 offen sc1
v_mfma_f32_16x16x32_bf16 v[76:79],a[204:207],v[236:239],v[76:79]
ds_read_b128 v[232:235],v17 offset:54272
s_waitcnt lgkmcnt(5)
v_mfma_f32_16x16x32_bf16 v[68:71],a[80:83],v[240:243],v[68:71]
s_add_u32 s93,s93,8388608
v_mfma_f32_16x16x32_bf16 v[76:79],a[208:211],v[240:243],v[76:79]
ds_read_b128 v[236:239],v17 offset:56320
v_mfma_f32_16x16x32_bf16 v[68:71],a[84:87],v[244:247],v[68:71]
v_mfma_f32_16x16x32_bf16 v[76:79],a[212:215],v[244:247],v[76:79]
ds_read_b128 v[240:243],v17 offset:58368
s_waitcnt lgkmcnt(5)
v_mfma_f32_16x16x32_bf16 v[68:71],a[88:91],v[248:251],v[68:71]
s_cmp_lt_u32 s93,163577856
s_cselect_b32 s93,s93,0x7fff0000
v_mfma_f32_16x16x32_bf16 v[76:79],a[216:219],v[248:251],v[76:79]
ds_read_b128 v[244:247],v17 offset:60416
v_mfma_f32_16x16x32_bf16 v[68:71],a[92:95],v[252:255],v[68:71]
buffer_store_dwordx4 v[48:51],v24,s[20:23],s42 offen sc1
v_mfma_f32_16x16x32_bf16 v[76:79],a[220:223],v[252:255],v[76:79]
ds_read_b128 v[248:251],v17 offset:62464
s_waitcnt lgkmcnt(5)
v_mfma_f32_16x16x32_bf16 v[68:71],a[96:99],v[224:227],v[68:71]
v_mfma_f32_16x16x32_bf16 v[76:79],a[224:227],v[224:227],v[76:79]
ds_read_b128 v[252:255],v17 offset:64512
v_mfma_f32_16x16x32_bf16 v[68:71],a[100:103],v[228:231],v[68:71]
buffer_store_dwordx4 v[48:51],v25,s[20:23],s42 offen sc1
v_mfma_f32_16x16x32_bf16 v[76:79],a[228:231],v[228:231],v[76:79]
s_waitcnt lgkmcnt(4)
v_mfma_f32_16x16x32_bf16 v[68:71],a[104:107],v[232:235],v[68:71]
s_add_u32 s42,s42,2097152
v_mfma_f32_16x16x32_bf16 v[76:79],a[232:235],v[232:235],v[76:79]
v_mfma_f32_16x16x32_bf16 v[68:71],a[108:111],v[236:239],v[68:71]
v_mfma_f32_16x16x32_bf16 v[76:79],a[236:239],v[236:239],v[76:79]
s_xor_b32 s42,s42,0x2000
s_waitcnt lgkmcnt(2)
v_mfma_f32_16x16x32_bf16 v[68:71],a[112:115],v[240:243],v[68:71]
v_mfma_f32_16x16x32_bf16 v[76:79],a[240:243],v[240:243],v[76:79]
v_mfma_f32_16x16x32_bf16 v[68:71],a[116:119],v[244:247],v[68:71]
s_cmp_lt_u32 s42,165675008
s_cselect_b32 s42,s42,0x7fff0000
v_mfma_f32_16x16x32_bf16 v[76:79],a[244:247],v[244:247],v[76:79]
s_waitcnt lgkmcnt(0)
v_mfma_f32_16x16x32_bf16 v[68:71],a[120:123],v[248:251],v[68:71]
v_mfma_f32_16x16x32_bf16 v[76:79],a[248:251],v[248:251],v[76:79]
v_mfma_f32_16x16x32_bf16 v[68:71],a[124:127],v[252:255],v[68:71]
v_mfma_f32_16x16x32_bf16 v[76:79],a[252:255],v[252:255],v[76:79]
v_xor_b32 v17,0x10000,v17
s_mov_b32 s79,s77
s_nop 4
v_cvt_pk_bf16_f32 v92,v68,v69
v_cvt_pk_bf16_f32 v93,v70,v71
v_cvt_pk_bf16_f32 v94,v76,v77
v_cvt_pk_bf16_f32 v95,v78,v79
buffer_store_dwordx4 v[92:95],v18,s[20:23],s70 offen offset:1024 sc1
s_cmp_lt_u32 s79,64
s_cbranch_scc1 qloop_202
s_waitcnt vmcnt(0)
s_barrier
s_cmp_lg_u32 s41,64
s_cbranch_scc1 np3_208
s_cmp_lg_u32 s50,0
s_cbranch_scc1 ow_209
s_mov_b64 exec,1
v_mov_b32 v22,14
v_mov_b32 v23,0
s_mov_b32 s64,21052992
buffer_atomic_add v22,v23,s[20:23],s64 offen sc1
s_mov_b64 exec,-1
ow_209:
np3_208:
s_cmp_lg_u32 s50,0
s_cbranch_scc1 ow_210
s_mov_b64 exec,1
v_mov_b32 v22,18
v_mov_b32 v23,0
buffer_store_dword v22,v23,s[20:23],s73 offen sc1
s_mov_b64 exec,-1
ow_210:
v_lshlrev_b32 v108,16,v108
v_mul_f32 v109,s81,v108
v_exp_f32 v109,v109
s_nop 0
v_add_f32 v109,1.0,v109
v_rcp_f32 v109,v109
s_nop 0
v_mul_f32 v109,v109,v108
v_cvt_pk_bf16_f32 v109,v109,v109
v_and_b32 v108,s80,v109
v_lshlrev_b32 v110,16,v104
v_and_b32 v111,s80,v104
v_fmac_f32 v96,v110,v108
v_fmac_f32 v97,v111,v108
v_lshlrev_b32 v110,16,v105
v_and_b32 v111,s80,v105
v_fmac_f32 v98,v110,v108
v_fmac_f32 v99,v111,v108
v_lshlrev_b32 v110,16,v106
v_and_b32 v111,s80,v106
v_fmac_f32 v100,v110,v108
v_fmac_f32 v101,v111,v108
v_lshlrev_b32 v110,16,v107
v_and_b32 v111,s80,v107
v_fmac_f32 v102,v110,v108
v_fmac_f32 v103,v111,v108
v_lshlrev_b32 v120,16,v120
v_mul_f32 v109,s81,v120
v_exp_f32 v109,v109
s_nop 0
v_add_f32 v109,1.0,v109
v_rcp_f32 v109,v109
s_nop 0
v_mul_f32 v109,v109,v120
v_cvt_pk_bf16_f32 v109,v109,v109
v_and_b32 v120,s80,v109
v_lshlrev_b32 v110,16,v116
v_and_b32 v111,s80,v116
v_fmac_f32 v96,v110,v120
v_fmac_f32 v97,v111,v120
v_lshlrev_b32 v110,16,v117
v_and_b32 v111,s80,v117
v_fmac_f32 v98,v110,v120
v_fmac_f32 v99,v111,v120
v_lshlrev_b32 v110,16,v118
v_and_b32 v111,s80,v118
v_fmac_f32 v100,v110,v120
v_fmac_f32 v101,v111,v120
v_lshlrev_b32 v110,16,v119
v_and_b32 v111,s80,v119
v_fmac_f32 v102,v110,v120
v_fmac_f32 v103,v111,v120
v_lshlrev_b32 v5,5,v0
ds_write_b128 v5,v[96:99]
ds_write_b128 v5,v[100:103] offset:16
v_and_b32 v6,31,v0
v_lshrrev_b32 v7,5,v0
v_lshlrev_b32 v7,10,v7
v_lshl_add_u32 v7,v6,2,v7
s_waitcnt lgkmcnt(0)
s_barrier
ds_read_b32 v8,v7 offset:0
ds_read_b32 v9,v7 offset:128
ds_read_b32 v10,v7 offset:256
ds_read_b32 v11,v7 offset:384
ds_read_b32 v12,v7 offset:512
ds_read_b32 v13,v7 offset:640
ds_read_b32 v14,v7 offset:768
ds_read_b32 v15,v7 offset:896
s_waitcnt lgkmcnt(0)
v_add_f32 v8,v8,v9
v_add_f32 v8,v8,v10
v_add_f32 v8,v8,v11
v_add_f32 v8,v8,v12
v_add_f32 v8,v8,v13
v_add_f32 v8,v8,v14
v_add_f32 v8,v8,v15
v_lshlrev_b32 v5,2,v0
ds_write_b32 v5,v8 offset:8192
v_lshlrev_b32 v7,2,v6
s_waitcnt lgkmcnt(0)
s_barrier
ds_read_b32 v8,v7 offset:8192
ds_read_b32 v9,v7 offset:8320
ds_read_b32 v10,v7 offset:8448
ds_read_b32 v11,v7 offset:8576
ds_read_b32 v12,v7 offset:8704
ds_read_b32 v13,v7 offset:8832
ds_read_b32 v14,v7 offset:8960
ds_read_b32 v15,v7 offset:9088
s_waitcnt lgkmcnt(0)
v_add_f32 v8,v8,v9
v_add_f32 v8,v8,v10
v_add_f32 v8,v8,v11
v_add_f32 v8,v8,v12
v_add_f32 v8,v8,v13
v_add_f32 v8,v8,v14
v_add_f32 v8,v8,v15
v_cvt_pk_bf16_f32 v8,v8,v8
v_and_b32 v8,s80,v8
s_lshl_b32 s64,s55,7
s_add_u32 s64,s64,8192
s_cmp_lg_u32 s50,0
s_cbranch_scc1 ow_211
buffer_store_dword v8,v7,s[20:23],s64 offen sc1
ow_211:
s_waitcnt vmcnt(0)
s_barrier
s_cmp_lg_u32 s50,0
s_cbranch_scc1 ow_212
s_mov_b64 exec,1
v_mov_b32 v22,14
v_mov_b32 v23,0
s_mov_b32 s64,21052032
buffer_atomic_add v22,v23,s[20:23],s64 offen sc1
s_mov_b64 exec,-1
ow_212:
s_lshr_b32 s58,s55,5
s_and_b32 s59,s55,31
s_mov_b32 s57,65
s_mov_b32 s79,0
s_branch common_213
pipe_second:
s_cmp_ge_u32 s59,18
s_cbranch_scc1 giveup_197
s_getpc_b64 s[4:5]
pc2nd:
s_sub_u32 s8,s4,pc2nd-mega_kernel
s_subb_u32 s9,s5,0
s_and_b32 s9,s9,0xffff
s_mov_b32 s10,code_end-mega_kernel
s_mov_b32 s11,0x20000
s_lshl_b32 s12,s59,15
v_lshlrev_b32 v2,7,v0
buffer_load_dword v2,v2,s[8:11],s12 offen
s_add_u32 s55,s57,128
s_and_b32 s64,s59,1
s_lshl_b32 s65,s58,1
s_add_u32 s64,s64,s65
s_lshl_b32 s65,s59,2
s_and_b32 s65,s65,24
s_add_u32 s65,s65,s64
s_add_u32 s64,s64,24
s_cmp_ge_u32 s59,16
s_cselect_b32 s64,s64,s65
s_lshl_b32 s65,s58,3
s_add_u32 s65,s65,s59
s_lshr_b32 s58,s59,3
s_add_u32 s58,s58,1
s_cmp_lt_u32 s59,8
s_cselect_b32 s59,s65,s64
s_xor_b32 s62,s61,0x2000
s_add_u32 s63,s62,21053440
s_mov_b32 s57,65
s_mov_b32 s79,64
s_mov_b32 s90,400000
common_213:
v_and_b32 v1,63,v0
v_and_b32 v3,15,v1
v_lshrrev_b32 v4,4,v1
v_lshlrev_b32 v16,4,v1
v_mov_b32 v48,0
v_mov_b32 v49,0
v_mov_b32 v50,0
v_mov_b32 v51,0
s_mov_b64 s[24:25],s[20:21]
s_mov_b64 s[28:29],s[20:21]
s_mov_b32 s27,0x20000
s_mov_b32 s31,0x20000
s_cmp_eq_u32 s56,0
s_cselect_b32 s26,s22,0
s_cselect_b32 s30,0,s22
s_add_u32 s71,s79,1
s_lshl_b32 s60,s79,4
s_mov_b32 s98,0
s_mov_b32 s99,0
v_mov_b32 v29,0
v_cmp_eq_u32 vcc,0,v1
v_mov_b32 v23,0x40000000
s_nop 0
v_cndmask_b32 v23,v23,v48,vcc
s_mov_b32 s80,0xffff0000
s_cmp_eq_u32 s58,0
s_cbranch_scc1 r_wo_214
s_cmp_eq_u32 s58,1
s_cbranch_scc1 r_w3_215
s_cmp_eq_u32 s58,2
s_cbranch_scc1 r_w4_216
s_and_b32 s41,s59,15
s_cmp_lt_u32 s59,16
s_cbranch_scc1 r_at_219
s_cmp_ge_u32 s59,24
s_cbranch_scc1 r_w2_217
s_load_dwordx2 s[4:5],s[0:1],64
s_and_b32 s41,s59,7
s_lshl_b32 s66,s41,8
s_lshl_b32 s67,s50,1
s_waitcnt lgkmcnt(0)
s_mov_b32 s32,s4
s_and_b32 s33,s5,0xffff
s_mov_b32 s34,0x200000
s_mov_b32 s35,0x20000
v_lshrrev_b32 v5,2,v3
v_lshl_add_u32 v7,v4,3,v5
v_and_b32 v6,3,v3
v_lshlrev_b32 v6,3,v6
v_lshl_add_u32 v6,v7,8,v6
v_and_b32 v7,1,v4
v_lshl_add_u32 v5,v7,2,v5
v_xor_b32 v5,s67,v5
v_lshl_add_u32 v12,v5,5,v6
v_xor_b32 v13,32,v12
v_and_b32 v5,15,v1
v_and_b32 v6,3,v4
v_lshlrev_b32 v6,1,v6
v_xor_b32 v5,v5,v6
v_mul_u32_u24 v6,2048,v4
v_xor_b32 v7,0,v5
v_lshl_add_u32 v8,v7,4,v6
v_xor_b32 v7,8,v5
v_lshl_add_u32 v9,v7,4,v6
s_mul_i32 s74,s50,131072
s_add_u32 s74,s74,s66
s_lshl_b32 s75,s50,14
s_mul_i32 s76,s50,65536
s_add_u32 s76,s76,s66
s_lshl_b32 s77,s50,13
s_add_u32 s64,s74,0
s_add_u32 m0,s75,0
s_nop 0
buffer_load_dwordx4 v8,s[32:35],s64 offen nt lds
s_add_u32 s64,s74,8192
s_add_u32 m0,s75,1024
s_nop 0
buffer_load_dwordx4 v8,s[32:35],s64 offen nt lds
s_add_u32 s64,s74,16384
s_add_u32 m0,s75,2048
s_nop 0
buffer_load_dwordx4 v9,s[32:35],s64 offen nt lds
s_add_u32 s64,s74,24576
s_add_u32 m0,s75,3072
s_nop 0
buffer_load_dwordx4 v9,s[32:35],s64 offen nt lds
s_add_u32 s64,s74,32768
s_add_u32 m0,s75,4096
s_nop 0
buffer_load_dwordx4 v8,s[32:35],s64 offen nt lds
s_add_u32 s64,s74,40960
s_add_u32 m0,s75,5120
s_nop 0
buffer_load_dwordx4 v8,s[32:35],s64 offen nt lds
s_add_u32 s64,s74,49152
s_add_u32 m0,s75,6144
s_nop 0
buffer_load_dwordx4 v9,s[32:35],s64 offen nt lds
s_add_u32 s64,s74,57344
s_add_u32 m0,s75,7168
s_nop 0
buffer_load_dwordx4 v9,s[32:35],s64 offen nt lds
s_add_u32 s64,s74,65536
s_add_u32 m0,s75,8192
s_nop 0
buffer_load_dwordx4 v8,s[32:35],s64 offen nt lds
s_add_u32 s64,s74,73728
s_add_u32 m0,s75,9216
s_nop 0
buffer_load_dwordx4 v8,s[32:35],s64 offen nt lds
s_add_u32 s64,s74,81920
s_add_u32 m0,s75,10240
s_nop 0
buffer_load_dwordx4 v9,s[32:35],s64 offen nt lds
s_add_u32 s64,s74,90112
s_add_u32 m0,s75,11264
s_nop 0
buffer_load_dwordx4 v9,s[32:35],s64 offen nt lds
s_add_u32 s64,s74,98304
s_add_u32 m0,s75,12288
s_nop 0
buffer_load_dwordx4 v8,s[32:35],s64 offen nt lds
s_add_u32 s64,s74,106496
s_add_u32 m0,s75,13312
s_nop 0
buffer_load_dwordx4 v8,s[32:35],s64 offen nt lds
s_add_u32 s64,s74,114688
s_add_u32 m0,s75,14336
s_nop 0
buffer_load_dwordx4 v9,s[32:35],s64 offen nt lds
s_add_u32 s64,s74,122880
s_add_u32 m0,s75,15360
s_nop 0
buffer_load_dwordx4 v9,s[32:35],s64 offen nt lds
s_add_u32 s64,s74,524288
s_add_u32 m0,s75,65536
s_nop 0
buffer_load_dwordx4 v8,s[32:35],s64 offen nt lds
s_add_u32 s64,s74,532480
s_add_u32 m0,s75,66560
s_nop 0
buffer_load_dwordx4 v8,s[32:35],s64 offen nt lds
s_add_u32 s64,s74,540672
s_add_u32 m0,s75,67584
s_nop 0
buffer_load_dwordx4 v9,s[32:35],s64 offen nt lds
s_add_u32 s64,s74,548864
s_add_u32 m0,s75,68608
s_nop 0
buffer_load_dwordx4 v9,s[32:35],s64 offen nt lds
s_add_u32 s64,s74,557056
s_add_u32 m0,s75,69632
s_nop 0
buffer_load_dwordx4 v8,s[32:35],s64 offen nt lds
s_add_u32 s64,s74,565248
s_add_u32 m0,s75,70656
s_nop 0
buffer_load_dwordx4 v8,s[32:35],s64 offen nt lds
s_add_u32 s64,s74,573440
s_add_u32 m0,s75,71680
s_nop 0
buffer_load_dwordx4 v9,s[32:35],s64 offen nt lds
s_add_u32 s64,s74,581632
s_add_u32 m0,s75,72704
s_nop 0
buffer_load_dwordx4 v9,s[32:35],s64 offen nt lds
s_add_u32 s64,s74,589824
s_add_u32 m0,s75,73728
s_nop 0
buffer_load_dwordx4 v8,s[32:35],s64 offen nt lds
s_add_u32 s64,s74,598016
s_add_u32 m0,s75,74752
s_nop 0
buffer_load_dwordx4 v8,s[32:35],s64 offen nt lds
s_add_u32 s64,s74,606208
s_add_u32 m0,s75,75776
s_nop 0
buffer_load_dwordx4 v9,s[32:35],s64 offen nt lds
s_add_u32 s64,s74,614400
s_add_u32 m0,s75,76800
s_nop 0
buffer_load_dwordx4 v9,s[32:35],s64 offen nt lds
s_add_u32 s64,s74,622592
s_add_u32 m0,s75,77824
s_nop 0
buffer_load_dwordx4 v8,s[32:35],s64 offen nt lds
s_add_u32 s64,s74,630784
s_add_u32 m0,s75,78848
s_nop 0
buffer_load_dwordx4 v8,s[32:35],s64 offen nt lds
s_add_u32 s64,s74,638976
s_add_u32 m0,s75,79872
s_nop 0
buffer_load_dwordx4 v9,s[32:35],s64 offen nt lds
s_add_u32 s64,s74,647168
s_add_u32 m0,s75,80896
s_nop 0
buffer_load_dwordx4 v9,s[32:35],s64 offen nt lds
s_waitcnt vmcnt(16)
s_barrier
ds_read_b64_tr_b16 a[0:1],v12 offset:0
ds_read_b64_tr_b16 a[128:129],v13 offset:0
ds_read_b64_tr_b16 a[2:3],v12 offset:1024
ds_read_b64_tr_b16 a[130:131],v13 offset:1024
ds_read_b64_tr_b16 a[4:5],v12 offset:8192
ds_read_b64_tr_b16 a[132:133],v13 offset:8192
ds_read_b64_tr_b16 a[6:7],v12 offset:9216
ds_read_b64_tr_b16 a[134:135],v13 offset:9216
s_waitcnt lgkmcnt(4)
ds_read_b64_tr_b16 a[8:9],v12 offset:16384
ds_read_b64_tr_b16 a[136:137],v13 offset:16384
ds_read_b64_tr_b16 a[10:11],v12 offset:17408
ds_read_b64_tr_b16 a[138:139],v13 offset:17408
ds_read_b64_tr_b16 a[12:13],v12 offset:24576
ds_read_b64_tr_b16 a[140:141],v13 offset:24576
ds_read_b64_tr_b16 a[14:15],v12 offset:25600
ds_read_b64_tr_b16 a[142:143],v13 offset:25600
s_waitcnt lgkmcnt(4)
ds_read_b64_tr_b16 a[16:17],v12 offset:32768
ds_read_b64_tr_b16 a[144:145],v13 offset:32768
ds_read_b64_tr_b16 a[18:19],v12 offset:33792
ds_read_b64_tr_b16 a[146:147],v13 offset:33792
ds_read_b64_tr_b16 a[20:21],v12 offset:40960
ds_read_b64_tr_b16 a[148:149],v13 offset:40960
ds_read_b64_tr_b16 a[22:23],v12 offset:41984
ds_read_b64_tr_b16 a[150:151],v13 offset:41984
s_waitcnt lgkmcnt(4)
ds_read_b64_tr_b16 a[24:25],v12 offset:49152
ds_read_b64_tr_b16 a[152:153],v13 offset:49152
ds_read_b64_tr_b16 a[26:27],v12 offset:50176
ds_read_b64_tr_b16 a[154:155],v13 offset:50176
ds_read_b64_tr_b16 a[28:29],v12 offset:57344
ds_read_b64_tr_b16 a[156:157],v13 offset:57344
ds_read_b64_tr_b16 a[30:31],v12 offset:58368
ds_read_b64_tr_b16 a[158:159],v13 offset:58368
s_waitcnt lgkmcnt(4)
v_xor_b32 v12,0x10000,v12
v_xor_b32 v13,0x10000,v13
s_waitcnt lgkmcnt(0)
s_barrier
s_add_u32 s64,s74,1048576
s_add_u32 m0,s75,0
s_nop 0
buffer_load_dwordx4 v8,s[32:35],s64 offen nt lds
s_add_u32 s64,s74,1056768
s_add_u32 m0,s75,1024
s_nop 0
buffer_load_dwordx4 v8,s[32:35],s64 offen nt lds
s_add_u32 s64,s74,1064960
s_add_u32 m0,s75,2048
s_nop 0
buffer_load_dwordx4 v9,s[32:35],s64 offen nt lds
s_add_u32 s64,s74,1073152
s_add_u32 m0,s75,3072
s_nop 0
buffer_load_dwordx4 v9,s[32:35],s64 offen nt lds
s_add_u32 s64,s74,1081344
s_add_u32 m0,s75,4096
s_nop 0
buffer_load_dwordx4 v8,s[32:35],s64 offen nt lds
s_add_u32 s64,s74,1089536
s_add_u32 m0,s75,5120
s_nop 0
buffer_load_dwordx4 v8,s[32:35],s64 offen nt lds
s_add_u32 s64,s74,1097728
s_add_u32 m0,s75,6144
s_nop 0
buffer_load_dwordx4 v9,s[32:35],s64 offen nt lds
s_add_u32 s64,s74,1105920
s_add_u32 m0,s75,7168
s_nop 0
buffer_load_dwordx4 v9,s[32:35],s64 offen nt lds
s_add_u32 s64,s74,1114112
s_add_u32 m0,s75,8192
s_nop 0
buffer_load_dwordx4 v8,s[32:35],s64 offen nt lds
s_add_u32 s64,s74,1122304
s_add_u32 m0,s75,9216
s_nop 0
buffer_load_dwordx4 v8,s[32:35],s64 offen nt lds
s_add_u32 s64,s74,1130496
s_add_u32 m0,s75,10240
s_nop 0
buffer_load_dwordx4 v9,s[32:35],s64 offen nt lds
s_add_u32 s64,s74,1138688
s_add_u32 m0,s75,11264
s_nop 0
buffer_load_dwordx4 v9,s[32:35],s64 offen nt lds
s_add_u32 s64,s74,1146880
s_add_u32 m0,s75,12288
s_nop 0
buffer_load_dwordx4 v8,s[32:35],s64 offen nt lds
s_add_u32 s64,s74,1155072
s_add_u32 m0,s75,13312
s_nop 0
buffer_load_dwordx4 v8,s[32:35],s64 offen nt lds
s_add_u32 s64,s74,1163264
s_add_u32 m0,s75,14336
s_nop 0
buffer_load_dwordx4 v9,s[32:35],s64 offen nt lds
s_add_u32 s64,s74,1171456
s_add_u32 m0,s75,15360
s_nop 0
buffer_load_dwordx4 v9,s[32:35],s64 offen nt lds
s_waitcnt vmcnt(16)
s_barrier
ds_read_b64_tr_b16 a[32:33],v12 offset:0
ds_read_b64_tr_b16 a[160:161],v13 offset:0
ds_read_b64_tr_b16 a[34:35],v12 offset:1024
ds_read_b64_tr_b16 a[162:163],v13 offset:1024
ds_read_b64_tr_b16 a[36:37],v12 offset:8192
ds_read_b64_tr_b16 a[164:165],v13 offset:8192
ds_read_b64_tr_b16 a[38:39],v12 offset:9216
ds_read_b64_tr_b16 a[166:167],v13 offset:9216
s_waitcnt lgkmcnt(4)
ds_read_b64_tr_b16 a[40:41],v12 offset:16384
ds_read_b64_tr_b16 a[168:169],v13 offset:16384
ds_read_b64_tr_b16 a[42:43],v12 offset:17408
ds_read_b64_tr_b16 a[170:171],v13 offset:17408
ds_read_b64_tr_b16 a[44:45],v12 offset:24576
ds_read_b64_tr_b16 a[172:173],v13 offset:24576
ds_read_b64_tr_b16 a[46:47],v12 offset:25600
ds_read_b64_tr_b16 a[174:175],v13 offset:25600
s_waitcnt lgkmcnt(4)
ds_read_b64_tr_b16 a[48:49],v12 offset:32768
ds_read_b64_tr_b16 a[176:177],v13 offset:32768
ds_read_b64_tr_b16 a[50:51],v12 offset:33792
ds_read_b64_tr_b16 a[178:179],v13 offset:33792
ds_read_b64_tr_b16 a[52:53],v12 offset:40960
ds_read_b64_tr_b16 a[180:181],v13 offset:40960
ds_read_b64_tr_b16 a[54:55],v12 offset:41984
ds_read_b64_tr_b16 a[182:183],v13 offset:41984
s_waitcnt lgkmcnt(4)
ds_read_b64_tr_b16 a[56:57],v12 offset:49152
ds_read_b64_tr_b16 a[184:185],v13 offset:49152
ds_read_b64_tr_b16 a[58:59],v12 offset:50176
ds_read_b64_tr_b16 a[186:187],v13 offset:50176
ds_read_b64_tr_b16 a[60:61],v12 offset:57344
ds_read_b64_tr_b16 a[188:189],v13 offset:57344
ds_read_b64_tr_b16 a[62:63],v12 offset:58368
ds_read_b64_tr_b16 a[190:191],v13 offset:58368
s_waitcnt lgkmcnt(4)
v_xor_b32 v12,0x10000,v12
v_xor_b32 v13,0x10000,v13
s_waitcnt lgkmcnt(0)
s_barrier
s_add_u32 s64,s74,1572864
s_add_u32 m0,s75,65536
s_nop 0
buffer_load_dwordx4 v8,s[32:35],s64 offen nt lds
s_add_u32 s64,s74,1581056
s_add_u32 m0,s75,66560
s_nop 0
buffer_load_dwordx4 v8,s[32:35],s64 offen nt lds
s_add_u32 s64,s74,1589248
s_add_u32 m0,s75,67584
s_nop 0
buffer_load_dwordx4 v9,s[32:35],s64 offen nt lds
s_add_u32 s64,s74,1597440
s_add_u32 m0,s75,68608
s_nop 0
buffer_load_dwordx4 v9,s[32:35],s64 offen nt lds
s_add_u32 s64,s74,1605632
s_add_u32 m0,s75,69632
s_nop 0
buffer_load_dwordx4 v8,s[32:35],s64 offen nt lds
s_add_u32 s64,s74,1613824
s_add_u32 m0,s75,70656
s_nop 0
buffer_load_dwordx4 v8,s[32:35],s64 offen nt lds
s_add_u32 s64,s74,1622016
s_add_u32 m0,s75,71680
s_nop 0
buffer_load_dwordx4 v9,s[32:35],s64 offen nt lds
s_add_u32 s64,s74,1630208
s_add_u32 m0,s75,72704
s_nop 0
buffer_load_dwordx4 v9,s[32:35],s64 offen nt lds
s_add_u32 s64,s74,1638400
s_add_u32 m0,s75,73728
s_nop 0
buffer_load_dwordx4 v8,s[32:35],s64 offen nt lds
s_add_u32 s64,s74,1646592
s_add_u32 m0,s75,74752
s_nop 0
buffer_load_dwordx4 v8,s[32:35],s64 offen nt lds
s_add_u32 s64,s74,1654784
s_add_u32 m0,s75,75776
s_nop 0
buffer_load_dwordx4 v9,s[32:35],s64 offen nt lds
s_add_u32 s64,s74,1662976
s_add_u32 m0,s75,76800
s_nop 0
buffer_load_dwordx4 v9,s[32:35],s64 offen nt lds
s_add_u32 s64,s74,1671168
s_add_u32 m0,s75,77824
s_nop 0
buffer_load_dwordx4 v8,s[32:35],s64 offen nt lds
s_add_u32 s64,s74,1679360
s_add_u32 m0,s75,78848
s_nop 0
buffer_load_dwordx4 v8,s[32:35],s64 offen nt lds
s_add_u32 s64,s74,1687552
s_add_u32 m0,s75,79872
s_nop 0
buffer_load_dwordx4 v9,s[32:35],s64 offen nt lds
s_add_u32 s64,s74,1695744
s_add_u32 m0,s75,80896
s_nop 0
buffer_load_dwordx4 v9,s[32:35],s64 offen nt lds
s_waitcnt vmcnt(16)
s_barrier
ds_read_b64_tr_b16 a[64:65],v12 offset:0
ds_read_b64_tr_b16 a[192:193],v13 offset:0
ds_read_b64_tr_b16 a[66:67],v12 offset:1024
ds_read_b64_tr_b16 a[194:195],v13 offset:1024
ds_read_b64_tr_b16 a[68:69],v12 offset:8192
ds_read_b64_tr_b16 a[196:197],v13 offset:8192
ds_read_b64_tr_b16 a[70:71],v12 offset:9216
ds_read_b64_tr_b16 a[198:199],v13 offset:9216
s_waitcnt lgkmcnt(4)
ds_read_b64_tr_b16 a[72:73],v12 offset:16384
ds_read_b64_tr_b16 a[200:201],v13 offset:16384
ds_read_b64_tr_b16 a[74:75],v12 offset:17408
ds_read_b64_tr_b16 a[202:203],v13 offset:17408
ds_read_b64_tr_b16 a[76:77],v12 offset:24576
ds_read_b64_tr_b16 a[204:205],v13 offset:24576
ds_read_b64_tr_b16 a[78:79],v12 offset:25600
ds_read_b64_tr_b16 a[206:207],v13 offset:25600
s_waitcnt lgkmcnt(4)
ds_read_b64_tr_b16 a[80:81],v12 offset:32768
ds_read_b64_tr_b16 a[208:209],v13 offset:32768
ds_read_b64_tr_b16 a[82:83],v12 offset:33792
ds_read_b64_tr_b16 a[210:211],v13 offset:33792
ds_read_b64_tr_b16 a[84:85],v12 offset:40960
ds_read_b64_tr_b16 a[212:213],v13 offset:40960
ds_read_b64_tr_b16 a[86:87],v12 offset:41984
ds_read_b64_tr_b16 a[214:215],v13 offset:41984
s_waitcnt lgkmcnt(4)
ds_read_b64_tr_b16 a[88:89],v12 offset:49152
ds_read_b64_tr_b16 a[216:217],v13 offset:49152
ds_read_b64_tr_b16 a[90:91],v12 offset:50176
ds_read_b64_tr_b16 a[218:219],v13 offset:50176
ds_read_b64_tr_b16 a[92:93],v12 offset:57344
ds_read_b64_tr_b16 a[220:221],v13 offset:57344
ds_read_b64_tr_b16 a[94:95],v12 offset:58368
ds_read_b64_tr_b16 a[222:223],v13 offset:58368
s_waitcnt lgkmcnt(4)
v_xor_b32 v12,0x10000,v12
v_xor_b32 v13,0x10000,v13
s_waitcnt lgkmcnt(0)
s_barrier
s_waitcnt vmcnt(0)
s_barrier
ds_read_b64_tr_b16 a[96:97],v12 offset:0
ds_read_b64_tr_b16 a[224:225],v13 offset:0
ds_read_b64_tr_b16 a[98:99],v12 offset:1024
ds_read_b64_tr_b16 a[226:227],v13 offset:1024
ds_read_b64_tr_b16 a[100:101],v12 offset:8192
ds_read_b64_tr_b16 a[228:229],v13 offset:8192
ds_read_b64_tr_b16 a[102:103],v12 offset:9216
ds_read_b64_tr_b16 a[230:231],v13 offset:9216
s_waitcnt lgkmcnt(4)
ds_read_b64_tr_b16 a[104:105],v12 offset:16384
ds_read_b64_tr_b16 a[232:233],v13 offset:16384
ds_read_b64_tr_b16 a[106:107],v12 offset:17408
ds_read_b64_tr_b16 a[234:235],v13 offset:17408
ds_read_b64_tr_b16 a[108:109],v12 offset:24576
ds_read_b64_tr_b16 a[236:237],v13 offset:24576
ds_read_b64_tr_b16 a[110:111],v12 offset:25600
ds_read_b64_tr_b16 a[238:239],v13 offset:25600
s_waitcnt lgkmcnt(4)
ds_read_b64_tr_b16 a[112:113],v12 offset:32768
ds_read_b64_tr_b16 a[240:241],v13 offset:32768
ds_read_b64_tr_b16 a[114:115],v12 offset:33792
ds_read_b64_tr_b16 a[242:243],v13 offset:33792
ds_read_b64_tr_b16 a[116:117],v12 offset:40960
ds_read_b64_tr_b16 a[244:245],v13 offset:40960
ds_read_b64_tr_b16 a[118:119],v12 offset:41984
ds_read_b64_tr_b16 a[246:247],v13 offset:41984
s_waitcnt lgkmcnt(4)
ds_read_b64_tr_b16 a[120:121],v12 offset:49152
ds_read_b64_tr_b16 a[248:249],v13 offset:49152
ds_read_b64_tr_b16 a[122:123],v12 offset:50176
ds_read_b64_tr_b16 a[250:251],v13 offset:50176
ds_read_b64_tr_b16 a[124:125],v12 offset:57344
ds_read_b64_tr_b16 a[252:253],v13 offset:57344
ds_read_b64_tr_b16 a[126:127],v12 offset:58368
ds_read_b64_tr_b16 a[254:255],v13 offset:58368
s_waitcnt lgkmcnt(4)
v_xor_b32 v12,0x10000,v12
v_xor_b32 v13,0x10000,v13
s_waitcnt lgkmcnt(0)
s_barrier
v_and_b32 v21,1,v1
v_mul_u32_u24 v21,960,v21
s_mov_b32 s65,21052032
s_mov_b32 s66,1792
pl_220:
buffer_load_dword v22,v21,s[20:23],s65 offen sc1
s_waitcnt vmcnt(0)
v_cmp_gt_u32 vcc,s66,v22
s_cbranch_vccz pok_221
s_sleep 1
s_sub_u32 s90,s90,1
s_cmp_gt_i32 s90,0
s_cbranch_scc1 pl_220
pok_221:
s_mov_b32 s81,0xbdd2d3e8
v_mov_b32 v28,0xc0135761
v_mov_b32 v17,v16
v_and_b32 v21,31,v1
v_lshlrev_b32 v21,2,v21
s_mul_i32 s74,s79,40
s_add_u32 s74,s74,s63
s_add_u32 s74,s74,2560
s_lshl_b32 s42,s41,2
s_add_u32 s42,s42,s50
s_lshl_b32 s73,s41,4
s_lshl_b32 s64,s50,2
s_add_u32 s73,s73,s64
s_add_u32 s73,s73,s63
s_add_u32 s73,s73,3072
s_add_u32 s73,s73,s60
s_lshl_b32 s43,s50,11
s_lshl_b32 s78,s79,21
s_add_u32 s78,s78,29360128
s_mov_b32 s64,0
s_lshr_b32 s65,s50,1
s_and_b32 s66,s50,1
s_lshl_b32 s72,s65,13
s_lshl_b32 s64,s66,11
s_add_u32 s72,s72,s64
s_add_u32 s72,s72,0x10000
s_lshl_b32 s75,s66,15
s_lshl_b32 s64,s65,7
s_add_u32 s75,s75,s64
s_add_u32 s75,s75,1835008
s_lshl_b32 s64,s66,2
v_add_u32 v5,s64,v4
v_and_b32 v6,7,v1
v_xor_b32 v5,v5,v6
v_lshlrev_b32 v5,4,v5
v_bfe_u32 v6,v1,3,2
v_lshl_add_u32 v5,v6,11,v5
v_lshrrev_b32 v6,5,v1
v_lshl_add_u32 v42,v6,14,v5
v_lshrrev_b32 v5,1,v3
v_xor_b32 v5,v5,v4
v_lshlrev_b32 v5,4,v5
v_and_b32 v6,7,v3
v_lshl_add_u32 v5,v6,7,v5
v_lshrrev_b32 v6,3,v3
v_lshl_add_u32 v17,v6,11,v5
v_xor_b32 v43,64,v17
s_lshr_b32 s64,s41,1
s_lshl_b32 s64,s64,2
s_lshr_b32 s64,0x0413,s64
s_and_b32 s64,s64,7
s_add_u32 s65,s41,120
s_lshl_b32 s65,s65,14
s_add_u32 s65,s65,s43
v_lshl_add_u32 v7,v4,8,s65
v_mov_b32 v9,2105344
v_add_u32 v6,s64,v3
v_and_b32 v5,15,v6
v_lshl_add_u32 v5,v5,4,v7
v_bfe_u32 v8,v6,4,1
v_lshl_add_u32 v5,v8,10,v5
v_cmp_lt_u32 vcc,31,v6
s_nop 1
v_cndmask_b32 v8,0,v9,vcc
v_add_u32 v5,v5,v8
v_xor_b32 v18,s62,v5
s_add_u32 s64,s64,16
v_add_u32 v6,s64,v3
v_and_b32 v5,15,v6
v_lshl_add_u32 v5,v5,4,v7
v_bfe_u32 v8,v6,4,1
v_lshl_add_u32 v5,v8,10,v5
v_cmp_lt_u32 vcc,31,v6
s_nop 1
v_cndmask_b32 v8,0,v9,vcc
v_add_u32 v5,v5,v8
v_xor_b32 v19,s62,v5
s_add_u32 s64,s64,16
s_mov_b64 s[84:85],vcc
v_mov_b32 v88,1
v_mov_b32 v89,0
v_mov_b32 v90,0
v_mov_b32 v91,0
v_xor_b32 v5,0x2000,v19
s_mov_b32 s64,163577856
buffer_store_dwordx4 v[88:91],v18,s[20:23],s64 offen sc1
s_andn2_b64 exec,exec,s[84:85]
buffer_store_dwordx4 v[88:91],v19,s[20:23],s64 offen sc1
s_mov_b64 exec,-1
v_mov_b32 v6,0x7fff0000
v_cndmask_b32 v5,v6,v5,s[84:85]
s_mov_b32 s64,27262976
buffer_store_dwordx4 v[88:91],v5,s[20:23],s64 offen sc1
s_waitcnt vmcnt(0)
s_add_u32 s64,s79,0
s_lshl_b32 s70,s64,21
s_lshl_b32 s64,s64,13
s_and_b32 s64,s64,0x2000
s_xor_b32 s64,s64,s62
s_add_u32 s70,s70,s64
s_add_u32 s70,s70,29360128
s_mov_b32 s83,1
s_mov_b32 s87,s74
s_cmp_eq_u32 s50,0
s_cselect_b32 s74,s74,0x7fff0000
v_mov_b32 v47,132096
s_lshl_b32 s64,s50,3
s_add_u32 s64,s64,132096
v_mov_b32 v46,s64
v_mov_b32 v29,0
s_mov_b32 s97,0x7fff0000
s_mov_b32 s69,1
s_mov_b32 s68,0
s_mov_b32 s52,0x30003
s_mov_b32 s53,s52
seg_223:
s_cmp_eq_u32 s83,0
s_cbranch_scc1 ahead_224
s_add_u32 s94,s70,s75
s_add_u32 s95,s94,65536
s_xor_b32 s91,s72,0x10000
s_waitcnt vmcnt(3)
v_cmp_gt_u32 vcc,s71,v29
s_cbranch_vccz nb_227
s_waitcnt vmcnt(0)
v_add_u32 v22,s71,-1
buffer_store_dword v22,v23,s[24:27],s97 offen
buffer_store_dword v22,v23,s[28:31],s97 offen sc1
s_mov_b32 s97,0x7fff0000
s_cmp_lg_u32 s50,0
s_cbranch_scc1 nb_227
buffer_load_dword v32,v21,s[20:23],s74 offen sc1
s_sleep 2
pl_229:
buffer_load_dword v33,v21,s[20:23],s74 offen sc1
s_waitcnt vmcnt(1)
v_cmp_gt_u32 vcc,s71,v32
v_mov_b32 v29,v32
s_cbranch_vccz pok_230
buffer_load_dword v32,v21,s[20:23],s74 offen sc1
s_waitcnt vmcnt(1)
v_cmp_gt_u32 vcc,s71,v33
v_mov_b32 v29,v33
s_cbranch_vccz pok_230
s_sub_u32 s90,s90,1
s_cmp_gt_i32 s90,0
s_cbranch_scc1 pl_229
pok_230:
nb_227:
s_barrier
s_xor_b32 m0,s91,0
s_add_u32 s65,s94,0
buffer_load_dwordx4 v42,s[20:23],s65 offen offset:0 sc1 lds
buffer_load_dwordx4 v42,s[20:23],s65 offen offset:1024 sc1 lds
s_xor_b32 m0,s91,16384
s_add_u32 s65,s94,256
buffer_load_dwordx4 v42,s[20:23],s65 offen offset:0 sc1 lds
buffer_load_dwordx4 v42,s[20:23],s65 offen offset:1024 sc1 lds
s_xor_b32 m0,s91,32768
s_add_u32 s65,s94,512
buffer_load_dwordx4 v42,s[20:23],s65 offen offset:0 sc1 lds
buffer_load_dwordx4 v42,s[20:23],s65 offen offset:1024 sc1 lds
s_xor_b32 m0,s91,49152
s_add_u32 s65,s94,768
buffer_load_dwordx4 v42,s[20:23],s65 offen offset:0 sc1 lds
buffer_load_dwordx4 v42,s[20:23],s65 offen offset:1024 sc1 lds
s_waitcnt vmcnt(8)
v_add_u32 v22,s71,-1
buffer_store_dword v22,v23,s[24:27],s97 offen
buffer_store_dword v22,v23,s[28:31],s97 offen sc1
s_mov_b32 s97,0x7fff0000
s_waitcnt vmcnt(8)
s_barrier
ds_read_b128 v[224:227],v17 offset:0
ds_read_b128 v[228:231],v43 offset:0
ds_read_b128 v[232:235],v17 offset:8192
ds_read_b128 v[236:239],v43 offset:8192
ds_read_b128 v[240:243],v17 offset:1024
ds_read_b128 v[244:247],v43 offset:1024
ds_read_b128 v[248:251],v17 offset:9216
s_waitcnt lgkmcnt(5)
v_mfma_f32_16x16x32_bf16 v[64:67],a[0:3],v[224:227],0
s_xor_b32 m0,s91,4096
s_add_u32 s96,s71,1
v_mfma_f32_16x16x32_bf16 v[72:75],a[128:131],v[224:227],0
ds_read_b128 v[252:255],v43 offset:9216
s_add_u32 s92,s71,2
v_mfma_f32_16x16x32_bf16 v[64:67],a[4:7],v[228:231],v[64:67]
s_add_u32 s65,s95,0
v_min_u32 v27,v224,v228
v_mfma_f32_16x16x32_bf16 v[72:75],a[132:135],v[228:231],v[72:75]
s_waitcnt vmcnt(6)
s_barrier
ds_read_b128 v[224:227],v17 offset:16384
s_waitcnt lgkmcnt(5)
v_mfma_f32_16x16x32_bf16 v[64:67],a[8:11],v[232:235],v[64:67]
buffer_load_dwordx4 v42,s[20:23],s65 offen offset:0 sc1 lds
v_mfma_f32_16x16x32_bf16 v[72:75],a[136:139],v[232:235],v[72:75]
ds_read_b128 v[228:231],v43 offset:16384
v_min3_u32 v27,v27,v232,v236
v_mfma_f32_16x16x32_bf16 v[64:67],a[12:15],v[236:239],v[64:67]
buffer_load_dwordx4 v42,s[20:23],s65 offen offset:1024 sc1 lds
v_mfma_f32_16x16x32_bf16 v[72:75],a[140:143],v[236:239],v[72:75]
ds_read_b128 v[232:235],v17 offset:24576
s_waitcnt lgkmcnt(5)
v_mfma_f32_16x16x32_bf16 v[64:67],a[64:67],v[240:243],v[64:67]
s_xor_b32 m0,s91,20480
v_min3_u32 v27,v27,v240,v244
v_mfma_f32_16x16x32_bf16 v[72:75],a[192:195],v[240:243],v[72:75]
ds_read_b128 v[236:239],v43 offset:24576
v_mfma_f32_16x16x32_bf16 v[64:67],a[68:71],v[244:247],v[64:67]
s_add_u32 s65,s95,256
v_mfma_f32_16x16x32_bf16 v[72:75],a[196:199],v[244:247],v[72:75]
ds_read_b128 v[240:243],v17 offset:17408
s_waitcnt lgkmcnt(5)
v_mfma_f32_16x16x32_bf16 v[64:67],a[72:75],v[248:251],v[64:67]
buffer_load_dwordx4 v42,s[20:23],s65 offen offset:0 sc1 lds
v_mfma_f32_16x16x32_bf16 v[72:75],a[200:203],v[248:251],v[72:75]
ds_read_b128 v[244:247],v43 offset:17408
v_min3_u32 v27,v27,v248,v252
v_mfma_f32_16x16x32_bf16 v[64:67],a[76:79],v[252:255],v[64:67]
buffer_load_dwordx4 v42,s[20:23],s65 offen offset:1024 sc1 lds
v_mfma_f32_16x16x32_bf16 v[72:75],a[204:207],v[252:255],v[72:75]
ds_read_b128 v[248:251],v17 offset:25600
s_waitcnt lgkmcnt(5)
v_mfma_f32_16x16x32_bf16 v[64:67],a[16:19],v[224:227],v[64:67]
s_xor_b32 m0,s91,36864
v_min3_u32 v27,v27,v224,v228
v_mfma_f32_16x16x32_bf16 v[72:75],a[144:147],v[224:227],v[72:75]
ds_read_b128 v[252:255],v43 offset:25600
v_mfma_f32_16x16x32_bf16 v[64:67],a[20:23],v[228:231],v[64:67]
s_add_u32 s65,s95,512
v_mfma_f32_16x16x32_bf16 v[72:75],a[148:151],v[228:231],v[72:75]
s_waitcnt vmcnt(6)
s_barrier
ds_read_b128 v[224:227],v17 offset:32768
s_waitcnt lgkmcnt(5)
v_mfma_f32_16x16x32_bf16 v[64:67],a[24:27],v[232:235],v[64:67]
buffer_load_dwordx4 v42,s[20:23],s65 offen offset:0 sc1 lds
v_mfma_f32_16x16x32_bf16 v[72:75],a[152:155],v[232:235],v[72:75]
ds_read_b128 v[228:231],v43 offset:32768
v_min3_u32 v27,v27,v232,v236
v_mfma_f32_16x16x32_bf16 v[64:67],a[28:31],v[236:239],v[64:67]
buffer_load_dwordx4 v42,s[20:23],s65 offen offset:1024 sc1 lds
v_mfma_f32_16x16x32_bf16 v[72:75],a[156:159],v[236:239],v[72:75]
ds_read_b128 v[232:235],v17 offset:40960
s_waitcnt lgkmcnt(5)
v_mfma_f32_16x16x32_bf16 v[64:67],a[80:83],v[240:243],v[64:67]
s_xor_b32 m0,s91,53248
v_min3_u32 v27,v27,v240,v244
v_mfma_f32_16x16x32_bf16 v[72:75],a[208:211],v[240:243],v[72:75]
ds_read_b128 v[236:239],v43 offset:40960
v_mfma_f32_16x16x32_bf16 v[64:67],a[84:87],v[244:247],v[64:67]
s_add_u32 s65,s95,768
v_mfma_f32_16x16x32_bf16 v[72:75],a[212:215],v[244:247],v[72:75]
ds_read_b128 v[240:243],v17 offset:33792
s_waitcnt lgkmcnt(5)
v_mfma_f32_16x16x32_bf16 v[64:67],a[88:91],v[248:251],v[64:67]
buffer_load_dwordx4 v42,s[20:23],s65 offen offset:0 sc1 lds
v_min3_u32 v27,v27,v248,v252
v_mfma_f32_16x16x32_bf16 v[72:75],a[216:219],v[248:251],v[72:75]
ds_read_b128 v[244:247],v43 offset:33792
s_waitcnt vmcnt(63)
v_mfma_f32_16x16x32_bf16 v[64:67],a[92:95],v[252:255],v[64:67]
buffer_load_dwordx4 v42,s[20:23],s65 offen offset:1024 sc1 lds
v_mfma_f32_16x16x32_bf16 v[72:75],a[220:223],v[252:255],v[72:75]
ds_read_b128 v[248:251],v17 offset:41984
s_waitcnt lgkmcnt(5)
v_mfma_f32_16x16x32_bf16 v[64:67],a[32:35],v[224:227],v[64:67]
v_cmp_gt_u32 vcc,s96,v29
v_cmp_gt_u32 s[92:93],s92,v29
v_mfma_f32_16x16x32_bf16 v[72:75],a[160:163],v[224:227],v[72:75]
ds_read_b128 v[252:255],v43 offset:41984
v_min3_u32 v27,v27,v224,v228
v_mfma_f32_16x16x32_bf16 v[64:67],a[36:39],v[228:231],v[64:67]
v_mov_b32 v44,vcc_lo
v_mov_b32 v45,s92
v_mfma_f32_16x16x32_bf16 v[72:75],a[164:167],v[228:231],v[72:75]
ds_read_b128 v[224:227],v17 offset:49152
s_waitcnt lgkmcnt(5)
v_mfma_f32_16x16x32_bf16 v[64:67],a[40:43],v[232:235],v[64:67]
ds_write_b64 v46,v[44:45]
v_min3_u32 v27,v27,v232,v236
v_mfma_f32_16x16x32_bf16 v[72:75],a[168:171],v[232:235],v[72:75]
ds_read_b128 v[228:231],v43 offset:49152
v_mfma_f32_16x16x32_bf16 v[64:67],a[44:47],v[236:239],v[64:67]
v_mfma_f32_16x16x32_bf16 v[72:75],a[172:175],v[236:239],v[72:75]
ds_read_b128 v[232:235],v17 offset:57344
s_waitcnt lgkmcnt(6)
v_mfma_f32_16x16x32_bf16 v[64:67],a[96:99],v[240:243],v[64:67]
v_min3_u32 v27,v27,v240,v244
s_add_u32 s88,s70,s75
v_mfma_f32_16x16x32_bf16 v[72:75],a[224:227],v[240:243],v[72:75]
ds_read_b128 v[236:239],v43 offset:57344
s_add_u32 s88,s88,2097152
v_mfma_f32_16x16x32_bf16 v[64:67],a[100:103],v[244:247],v[64:67]
s_xor_b32 s88,s88,0x2000
s_add_u32 s89,s88,65536
v_mfma_f32_16x16x32_bf16 v[72:75],a[228:231],v[244:247],v[72:75]
ds_read_b128 v[240:243],v17 offset:50176
s_waitcnt lgkmcnt(6)
v_mfma_f32_16x16x32_bf16 v[64:67],a[104:107],v[248:251],v[64:67]
v_min3_u32 v27,v27,v248,v252
v_mfma_f32_16x16x32_bf16 v[72:75],a[232:235],v[248:251],v[72:75]
ds_read_b128 v[244:247],v43 offset:50176
v_mfma_f32_16x16x32_bf16 v[64:67],a[108:111],v[252:255],v[64:67]
v_mfma_f32_16x16x32_bf16 v[72:75],a[236:239],v[252:255],v[72:75]
ds_read_b128 v[248:251],v17 offset:58368
s_waitcnt lgkmcnt(5)
v_mfma_f32_16x16x32_bf16 v[64:67],a[48:51],v[224:227],v[64:67]
v_min3_u32 v27,v27,v224,v228
v_mfma_f32_16x16x32_bf16 v[72:75],a[176:179],v[224:227],v[72:75]
ds_read_b128 v[252:255],v43 offset:58368
v_mfma_f32_16x16x32_bf16 v[64:67],a[52:55],v[228:231],v[64:67]
v_mfma_f32_16x16x32_bf16 v[72:75],a[180:183],v[228:231],v[72:75]
s_waitcnt vmcnt(4)
s_barrier
ds_read_b64 v[44:45],v47
ds_read_b128 v[224:227],v17 offset:4096
s_waitcnt lgkmcnt(6)
v_mfma_f32_16x16x32_bf16 v[64:67],a[56:59],v[232:235],v[64:67]
v_min3_u32 v27,v27,v232,v236
v_mfma_f32_16x16x32_bf16 v[72:75],a[184:187],v[232:235],v[72:75]
ds_read_b128 v[228:231],v43 offset:4096
v_mfma_f32_16x16x32_bf16 v[64:67],a[60:63],v[236:239],v[64:67]
v_mfma_f32_16x16x32_bf16 v[72:75],a[188:191],v[236:239],v[72:75]
ds_read_b128 v[232:235],v17 offset:12288
s_waitcnt lgkmcnt(6)
v_mfma_f32_16x16x32_bf16 v[64:67],a[112:115],v[240:243],v[64:67]
v_min3_u32 v27,v27,v240,v244
v_mfma_f32_16x16x32_bf16 v[72:75],a[240:243],v[240:243],v[72:75]
ds_read_b128 v[236:239],v43 offset:12288
v_mfma_f32_16x16x32_bf16 v[64:67],a[116:119],v[244:247],v[64:67]
v_mfma_f32_16x16x32_bf16 v[72:75],a[244:247],v[244:247],v[72:75]
ds_read_b128 v[240:243],v17 offset:5120
s_waitcnt lgkmcnt(6)
v_mfma_f32_16x16x32_bf16 v[64:67],a[120:123],v[248:251],v[64:67]
s_waitcnt lgkmcnt(5)
v_readfirstlane_b32 s93,v45
v_mfma_f32_16x16x32_bf16 v[72:75],a[248:251],v[248:251],v[72:75]
ds_read_b128 v[244:247],v43 offset:5120
v_readfirstlane_b32 s83,v44
s_cmp_lg_u32 s83,0
s_cbranch_scc0 keep_233
v_mfma_f32_16x16x32_bf16 v[64:67],a[124:127],v[252:255],v[64:67]
v_min3_u32 v27,v27,v248,v252
v_mfma_f32_16x16x32_bf16 v[72:75],a[252:255],v[252:255],v[72:75]
ds_read_b128 v[248:251],v17 offset:13312
s_waitcnt lgkmcnt(5)
v_mfma_f32_16x16x32_bf16 v[68:71],a[0:3],v[224:227],0
v_cmp_eq_u32 vcc,0,v27
s_cbranch_vccnz retry_222
v_mfma_f32_16x16x32_bf16 v[76:79],a[128:131],v[224:227],0
ds_read_b128 v[252:255],v43 offset:13312
v_min3_u32 v27,v27,v224,v228
v_mfma_f32_16x16x32_bf16 v[68:71],a[4:7],v[228:231],v[68:71]
v_mfma_f32_16x16x32_bf16 v[76:79],a[132:135],v[228:231],v[76:79]
ds_read_b128 v[224:227],v17 offset:20480
s_waitcnt lgkmcnt(5)
v_mfma_f32_16x16x32_bf16 v[68:71],a[8:11],v[232:235],v[68:71]
v_min3_u32 v27,v27,v232,v236
v_mul_f32 v88,v64,v64
v_mul_f32 v92,v72,v72
v_mfma_f32_16x16x32_bf16 v[76:79],a[136:139],v[232:235],v[76:79]
ds_read_b128 v[228:231],v43 offset:20480
v_mul_f32 v89,v65,v65
v_mul_f32 v93,v73,v73
v_mfma_f32_16x16x32_bf16 v[68:71],a[12:15],v[236:239],v[68:71]
v_mul_f32 v90,v66,v66
v_mul_f32 v91,v67,v67
v_mul_f32 v94,v74,v74
v_mfma_f32_16x16x32_bf16 v[76:79],a[140:143],v[236:239],v[76:79]
ds_read_b128 v[232:235],v17 offset:28672
v_mul_f32 v95,v75,v75
s_waitcnt lgkmcnt(5)
v_mfma_f32_16x16x32_bf16 v[68:71],a[64:67],v[240:243],v[68:71]
v_min3_u32 v27,v27,v240,v244
v_fma_f32 v88,v88,s81,v28
v_fma_f32 v92,v92,s81,v28
v_mfma_f32_16x16x32_bf16 v[76:79],a[192:195],v[240:243],v[76:79]
ds_read_b128 v[236:239],v43 offset:28672
v_fma_f32 v89,v89,s81,v28
v_fma_f32 v93,v93,s81,v28
v_mfma_f32_16x16x32_bf16 v[68:71],a[68:71],v[244:247],v[68:71]
v_fma_f32 v90,v90,s81,v28
v_fma_f32 v91,v91,s81,v28
v_fma_f32 v94,v94,s81,v28
v_mfma_f32_16x16x32_bf16 v[76:79],a[196:199],v[244:247],v[76:79]
ds_read_b128 v[240:243],v17 offset:21504
v_fma_f32 v95,v95,s81,v28
s_waitcnt lgkmcnt(5)
v_mfma_f32_16x16x32_bf16 v[68:71],a[72:75],v[248:251],v[68:71]
v_min3_u32 v27,v27,v248,v252
v_mul_f32 v88,v88,v64
v_mul_f32 v92,v92,v72
v_mfma_f32_16x16x32_bf16 v[76:79],a[200:203],v[248:251],v[76:79]
ds_read_b128 v[244:247],v43 offset:21504
v_mul_f32 v89,v89,v65
v_mul_f32 v93,v93,v73
v_mfma_f32_16x16x32_bf16 v[68:71],a[76:79],v[252:255],v[68:71]
v_mul_f32 v90,v90,v66
v_mul_f32 v91,v91,v67
v_mul_f32 v94,v94,v74
v_mfma_f32_16x16x32_bf16 v[76:79],a[204:207],v[252:255],v[76:79]
ds_read_b128 v[248:251],v17 offset:29696
v_mul_f32 v95,v95,v75
s_waitcnt lgkmcnt(5)
v_mfma_f32_16x16x32_bf16 v[68:71],a[16:19],v[224:227],v[68:71]
v_min3_u32 v27,v27,v224,v228
v_exp_f32 v92,v92
v_mfma_f32_16x16x32_bf16 v[76:79],a[144:147],v[224:227],v[76:79]
ds_read_b128 v[252:255],v43 offset:29696
v_exp_f32 v93,v93
v_mfma_f32_16x16x32_bf16 v[68:71],a[20:23],v[228:231],v[68:71]
v_exp_f32 v88,v88
v_mfma_f32_16x16x32_bf16 v[76:79],a[148:151],v[228:231],v[76:79]
s_waitcnt vmcnt(0)
s_barrier
ds_read_b128 v[224:227],v17 offset:36864
s_waitcnt lgkmcnt(5)
v_mfma_f32_16x16x32_bf16 v[68:71],a[24:27],v[232:235],v[68:71]
v_min3_u32 v27,v27,v232,v236
v_exp_f32 v94,v94
v_mfma_f32_16x16x32_bf16 v[76:79],a[152:155],v[232:235],v[76:79]
ds_read_b128 v[228:231],v43 offset:36864
v_exp_f32 v95,v95
v_mfma_f32_16x16x32_bf16 v[68:71],a[28:31],v[236:239],v[68:71]
v_exp_f32 v89,v89
v_add_f32 v92,1.0,v92
v_mfma_f32_16x16x32_bf16 v[76:79],a[156:159],v[236:239],v[76:79]
ds_read_b128 v[232:235],v17 offset:45056
v_add_f32 v93,1.0,v93
s_waitcnt lgkmcnt(5)
v_mfma_f32_16x16x32_bf16 v[68:71],a[80:83],v[240:243],v[68:71]
v_min3_u32 v27,v27,v240,v244
v_add_f32 v94,1.0,v94
v_add_f32 v95,1.0,v95
v_mfma_f32_16x16x32_bf16 v[76:79],a[208:211],v[240:243],v[76:79]
ds_read_b128 v[236:239],v43 offset:45056
v_rcp_f32 v92,v92
v_mfma_f32_16x16x32_bf16 v[68:71],a[84:87],v[244:247],v[68:71]
v_exp_f32 v90,v90
v_mfma_f32_16x16x32_bf16 v[76:79],a[212:215],v[244:247],v[76:79]
ds_read_b128 v[240:243],v17 offset:37888
s_waitcnt lgkmcnt(5)
v_mfma_f32_16x16x32_bf16 v[68:71],a[88:91],v[248:251],v[68:71]
v_min3_u32 v27,v27,v248,v252
v_rcp_f32 v93,v93
v_mfma_f32_16x16x32_bf16 v[76:79],a[216:219],v[248:251],v[76:79]
ds_read_b128 v[244:247],v43 offset:37888
v_rcp_f32 v94,v94
v_mfma_f32_16x16x32_bf16 v[68:71],a[92:95],v[252:255],v[68:71]
v_exp_f32 v91,v91
v_mfma_f32_16x16x32_bf16 v[76:79],a[220:223],v[252:255],v[76:79]
ds_read_b128 v[248:251],v17 offset:46080
s_waitcnt lgkmcnt(5)
v_mfma_f32_16x16x32_bf16 v[68:71],a[32:35],v[224:227],v[68:71]
v_min3_u32 v27,v27,v224,v228
v_add_f32 v88,1.0,v88
v_mfma_f32_16x16x32_bf16 v[76:79],a[160:163],v[224:227],v[76:79]
ds_read_b128 v[252:255],v43 offset:46080
v_add_f32 v89,1.0,v89
v_mfma_f32_16x16x32_bf16 v[68:71],a[36:39],v[228:231],v[68:71]
v_add_f32 v90,1.0,v90
v_add_f32 v91,1.0,v91
v_mfma_f32_16x16x32_bf16 v[76:79],a[164:167],v[228:231],v[76:79]
ds_read_b128 v[224:227],v17 offset:53248
s_waitcnt lgkmcnt(5)
v_mfma_f32_16x16x32_bf16 v[68:71],a[40:43],v[232:235],v[68:71]
v_min3_u32 v27,v27,v232,v236
v_mfma_f32_16x16x32_bf16 v[76:79],a[168:171],v[232:235],v[76:79]
ds_read_b128 v[228:231],v43 offset:53248
v_mfma_f32_16x16x32_bf16 v[68:71],a[44:47],v[236:239],v[68:71]
v_rcp_f32 v88,v88
v_mfma_f32_16x16x32_bf16 v[76:79],a[172:175],v[236:239],v[76:79]
ds_read_b128 v[232:235],v17 offset:61440
s_waitcnt lgkmcnt(5)
v_mfma_f32_16x16x32_bf16 v[68:71],a[96:99],v[240:243],v[68:71]
v_min3_u32 v27,v27,v240,v244
v_mfma_f32_16x16x32_bf16 v[76:79],a[224:227],v[240:243],v[76:79]
ds_read_b128 v[236:239],v43 offset:61440
v_mfma_f32_16x16x32_bf16 v[68:71],a[100:103],v[244:247],v[68:71]
v_rcp_f32 v89,v89
v_mfma_f32_16x16x32_bf16 v[76:79],a[228:231],v[244:247],v[76:79]
ds_read_b128 v[240:243],v17 offset:54272
s_waitcnt lgkmcnt(5)
v_mfma_f32_16x16x32_bf16 v[68:71],a[104:107],v[248:251],v[68:71]
v_min3_u32 v27,v27,v248,v252
v_mfma_f32_16x16x32_bf16 v[76:79],a[232:235],v[248:251],v[76:79]
ds_read_b128 v[244:247],v43 offset:54272
v_mfma_f32_16x16x32_bf16 v[68:71],a[108:111],v[252:255],v[68:71]
v_rcp_f32 v90,v90
v_mfma_f32_16x16x32_bf16 v[76:79],a[236:239],v[252:255],v[76:79]
ds_read_b128 v[248:251],v17 offset:62464
s_waitcnt lgkmcnt(5)
v_mfma_f32_16x16x32_bf16 v[68:71],a[48:51],v[224:227],v[68:71]
v_min3_u32 v27,v27,v224,v228
v_mfma_f32_16x16x32_bf16 v[76:79],a[176:179],v[224:227],v[76:79]
ds_read_b128 v[252:255],v43 offset:62464
v_mfma_f32_16x16x32_bf16 v[68:71],a[52:55],v[228:231],v[68:71]
v_rcp_f32 v91,v91
v_mfma_f32_16x16x32_bf16 v[76:79],a[180:183],v[228:231],v[76:79]
v_mul_f32 v88,v88,v64
s_waitcnt lgkmcnt(4)
v_mfma_f32_16x16x32_bf16 v[68:71],a[56:59],v[232:235],v[68:71]
v_min3_u32 v27,v27,v232,v236
v_mul_f32 v89,v89,v65
v_mfma_f32_16x16x32_bf16 v[76:79],a[184:187],v[232:235],v[76:79]
v_mul_f32 v90,v90,v66
v_mul_f32 v91,v91,v67
v_mfma_f32_16x16x32_bf16 v[68:71],a[60:63],v[236:239],v[68:71]
v_rcp_f32 v95,v95
v_mfma_f32_16x16x32_bf16 v[76:79],a[188:191],v[236:239],v[76:79]
v_mul_f32 v92,v92,v72
s_waitcnt lgkmcnt(2)
v_mfma_f32_16x16x32_bf16 v[68:71],a[112:115],v[240:243],v[68:71]
v_min3_u32 v27,v27,v240,v244
v_mul_f32 v93,v93,v73
v_mfma_f32_16x16x32_bf16 v[76:79],a[240:243],v[240:243],v[76:79]
v_mul_f32 v94,v94,v74
v_mul_f32 v95,v95,v75
v_mfma_f32_16x16x32_bf16 v[68:71],a[116:119],v[244:247],v[68:71]
v_cvt_pk_bf16_f32 v96,v88,v89
v_cvt_pk_bf16_f32 v97,v90,v91
v_mfma_f32_16x16x32_bf16 v[76:79],a[244:247],v[244:247],v[76:79]
v_cvt_pk_bf16_f32 v98,v92,v93
s_waitcnt lgkmcnt(0)
v_mfma_f32_16x16x32_bf16 v[68:71],a[120:123],v[248:251],v[68:71]
v_min3_u32 v27,v27,v248,v252
v_cvt_pk_bf16_f32 v99,v94,v95
v_mfma_f32_16x16x32_bf16 v[76:79],a[248:251],v[248:251],v[76:79]
v_max_u32 v96,1,v96
v_mfma_f32_16x16x32_bf16 v[68:71],a[124:127],v[252:255],v[68:71]
buffer_store_dwordx4 v[96:99],v18,s[20:23],s78 offen sc1
v_mfma_f32_16x16x32_bf16 v[76:79],a[252:255],v[252:255],v[76:79]
v_cmp_eq_u32 vcc,0,v27
s_cbranch_vccnz retry_222
s_branch epi_225
keep_233:
v_mfma_f32_16x16x32_bf16 v[64:67],a[124:127],v[252:255],v[64:67]
v_min3_u32 v27,v27,v248,v252
s_xor_b32 m0,s72,0
v_mfma_f32_16x16x32_bf16 v[72:75],a[252:255],v[252:255],v[72:75]
ds_read_b128 v[248:251],v17 offset:13312
s_waitcnt lgkmcnt(5)
v_mfma_f32_16x16x32_bf16 v[68:71],a[0:3],v[224:227],0
s_add_u32 s65,s88,0
v_cmp_eq_u32 vcc,0,v27
s_cbranch_vccnz retry_222
v_mfma_f32_16x16x32_bf16 v[76:79],a[128:131],v[224:227],0
ds_read_b128 v[252:255],v43 offset:13312
v_min3_u32 v27,v27,v224,v228
v_mfma_f32_16x16x32_bf16 v[68:71],a[4:7],v[228:231],v[68:71]
buffer_load_dwordx4 v42,s[20:23],s65 offen offset:0 sc1 lds
v_mfma_f32_16x16x32_bf16 v[76:79],a[132:135],v[228:231],v[76:79]
ds_read_b128 v[224:227],v17 offset:20480
s_waitcnt lgkmcnt(5)
v_mfma_f32_16x16x32_bf16 v[68:71],a[8:11],v[232:235],v[68:71]
buffer_load_dwordx4 v42,s[20:23],s65 offen offset:1024 sc1 lds
v_mul_f32 v88,v64,v64
v_mul_f32 v89,v65,v65
v_mfma_f32_16x16x32_bf16 v[76:79],a[136:139],v[232:235],v[76:79]
ds_read_b128 v[228:231],v43 offset:20480
s_xor_b32 m0,s72,16384
v_mul_f32 v90,v66,v66
v_mul_f32 v91,v67,v67
v_mfma_f32_16x16x32_bf16 v[68:71],a[12:15],v[236:239],v[68:71]
s_add_u32 s65,s88,256
v_min3_u32 v27,v27,v232,v236
v_fma_f32 v88,v88,s81,v28
v_fma_f32 v89,v89,s81,v28
v_mfma_f32_16x16x32_bf16 v[76:79],a[140:143],v[236:239],v[76:79]
ds_read_b128 v[232:235],v17 offset:28672
v_fma_f32 v90,v90,s81,v28
v_fma_f32 v91,v91,s81,v28
s_waitcnt lgkmcnt(5)
v_mfma_f32_16x16x32_bf16 v[68:71],a[64:67],v[240:243],v[68:71]
buffer_load_dwordx4 v42,s[20:23],s65 offen offset:0 sc1 lds
v_mul_f32 v88,v88,v64
v_mul_f32 v89,v89,v65
v_mfma_f32_16x16x32_bf16 v[76:79],a[192:195],v[240:243],v[76:79]
ds_read_b128 v[236:239],v43 offset:28672
v_min3_u32 v27,v27,v240,v244
v_mul_f32 v90,v90,v66
v_mul_f32 v91,v91,v67
v_mfma_f32_16x16x32_bf16 v[68:71],a[68:71],v[244:247],v[68:71]
buffer_load_dwordx4 v42,s[20:23],s65 offen offset:1024 sc1 lds
v_exp_f32 v88,v88
v_mfma_f32_16x16x32_bf16 v[76:79],a[196:199],v[244:247],v[76:79]
ds_read_b128 v[240:243],v17 offset:21504
v_exp_f32 v89,v89
s_waitcnt lgkmcnt(5)
v_mfma_f32_16x16x32_bf16 v[68:71],a[72:75],v[248:251],v[68:71]
s_xor_b32 m0,s72,32768
s_add_u32 s65,s88,512
v_exp_f32 v90,v90
v_mfma_f32_16x16x32_bf16 v[76:79],a[200:203],v[248:251],v[76:79]
ds_read_b128 v[244:247],v43 offset:21504
v_min3_u32 v27,v27,v248,v252
v_exp_f32 v91,v91
v_mfma_f32_16x16x32_bf16 v[68:71],a[76:79],v[252:255],v[68:71]
buffer_load_dwordx4 v42,s[20:23],s65 offen offset:0 sc1 lds
v_add_f32 v88,1.0,v88
v_add_f32 v89,1.0,v89
v_mfma_f32_16x16x32_bf16 v[76:79],a[204:207],v[252:255],v[76:79]
ds_read_b128 v[248:251],v17 offset:29696
v_add_f32 v90,1.0,v90
v_add_f32 v91,1.0,v91
s_waitcnt lgkmcnt(5)
v_mfma_f32_16x16x32_bf16 v[68:71],a[16:19],v[224:227],v[68:71]
buffer_load_dwordx4 v42,s[20:23],s65 offen offset:1024 sc1 lds
v_rcp_f32 v88,v88
v_mfma_f32_16x16x32_bf16 v[76:79],a[144:147],v[224:227],v[76:79]
ds_read_b128 v[252:255],v43 offset:29696
s_xor_b32 m0,s72,49152
v_mul_f32 v92,v72,v72
v_mul_f32 v93,v73,v73
v_mfma_f32_16x16x32_bf16 v[68:71],a[20:23],v[228:231],v[68:71]
v_min3_u32 v27,v27,v224,v228
v_mul_f32 v94,v74,v74
v_mul_f32 v95,v75,v75
v_fma_f32 v92,v92,s81,v28
v_mfma_f32_16x16x32_bf16 v[76:79],a[148:151],v[228:231],v[76:79]
s_waitcnt vmcnt(6)
s_barrier
ds_read_b128 v[224:227],v17 offset:36864
s_waitcnt lgkmcnt(5)
v_mfma_f32_16x16x32_bf16 v[68:71],a[24:27],v[232:235],v[68:71]
s_add_u32 s65,s88,768
v_min3_u32 v27,v27,v232,v236
v_fma_f32 v93,v93,s81,v28
v_fma_f32 v94,v94,s81,v28
v_mfma_f32_16x16x32_bf16 v[76:79],a[152:155],v[232:235],v[76:79]
ds_read_b128 v[228:231],v43 offset:36864
v_fma_f32 v95,v95,s81,v28
v_mul_f32 v92,v92,v72
v_mul_f32 v93,v93,v73
v_mfma_f32_16x16x32_bf16 v[68:71],a[28:31],v[236:239],v[68:71]
buffer_load_dwordx4 v42,s[20:23],s65 offen offset:0 sc1 lds
v_mul_f32 v94,v94,v74
v_mul_f32 v95,v95,v75
v_mfma_f32_16x16x32_bf16 v[76:79],a[156:159],v[236:239],v[76:79]
ds_read_b128 v[232:235],v17 offset:45056
v_exp_f32 v92,v92
s_waitcnt lgkmcnt(5)
v_mfma_f32_16x16x32_bf16 v[68:71],a[80:83],v[240:243],v[68:71]
buffer_load_dwordx4 v42,s[20:23],s65 offen offset:1024 sc1 lds
v_exp_f32 v93,v93
v_mfma_f32_16x16x32_bf16 v[76:79],a[208:211],v[240:243],v[76:79]
ds_read_b128 v[236:239],v43 offset:45056
s_xor_b32 m0,s72,4096
v_exp_f32 v94,v94
v_mfma_f32_16x16x32_bf16 v[68:71],a[84:87],v[244:247],v[68:71]
s_add_u32 s65,s89,0
v_min3_u32 v27,v27,v240,v244
v_exp_f32 v95,v95
v_mfma_f32_16x16x32_bf16 v[76:79],a[212:215],v[244:247],v[76:79]
ds_read_b128 v[240:243],v17 offset:37888
v_add_f32 v92,1.0,v92
v_add_f32 v93,1.0,v93
s_waitcnt lgkmcnt(5)
v_mfma_f32_16x16x32_bf16 v[68:71],a[88:91],v[248:251],v[68:71]
buffer_load_dwordx4 v42,s[20:23],s65 offen offset:0 sc1 lds
v_add_f32 v94,1.0,v94
v_add_f32 v95,1.0,v95
v_mfma_f32_16x16x32_bf16 v[76:79],a[216:219],v[248:251],v[76:79]
ds_read_b128 v[244:247],v43 offset:37888
v_min3_u32 v27,v27,v248,v252
v_rcp_f32 v92,v92
v_mfma_f32_16x16x32_bf16 v[68:71],a[92:95],v[252:255],v[68:71]
buffer_load_dwordx4 v42,s[20:23],s65 offen offset:1024 sc1 lds
v_rcp_f32 v93,v93
v_mfma_f32_16x16x32_bf16 v[76:79],a[220:223],v[252:255],v[76:79]
ds_read_b128 v[248:251],v17 offset:46080
v_rcp_f32 v94,v94
s_waitcnt lgkmcnt(5)
v_mfma_f32_16x16x32_bf16 v[68:71],a[32:35],v[224:227],v[68:71]
s_xor_b32 m0,s72,20480
s_add_u32 s65,s89,256
v_rcp_f32 v95,v95
v_mfma_f32_16x16x32_bf16 v[76:79],a[160:163],v[224:227],v[76:79]
ds_read_b128 v[252:255],v43 offset:46080
v_min3_u32 v27,v27,v224,v228
v_mfma_f32_16x16x32_bf16 v[68:71],a[36:39],v[228:231],v[68:71]
buffer_load_dwordx4 v42,s[20:23],s65 offen offset:0 sc1 lds
v_mfma_f32_16x16x32_bf16 v[76:79],a[164:167],v[228:231],v[76:79]
ds_read_b128 v[224:227],v17 offset:53248
s_waitcnt lgkmcnt(5)
v_mfma_f32_16x16x32_bf16 v[68:71],a[40:43],v[232:235],v[68:71]
buffer_load_dwordx4 v42,s[20:23],s65 offen offset:1024 sc1 lds
v_mfma_f32_16x16x32_bf16 v[76:79],a[168:171],v[232:235],v[76:79]
ds_read_b128 v[228:231],v43 offset:53248
s_xor_b32 m0,s72,36864
v_mfma_f32_16x16x32_bf16 v[68:71],a[44:47],v[236:239],v[68:71]
s_add_u32 s65,s89,512
v_min3_u32 v27,v27,v232,v236
v_mfma_f32_16x16x32_bf16 v[76:79],a[172:175],v[236:239],v[76:79]
ds_read_b128 v[232:235],v17 offset:61440
s_waitcnt lgkmcnt(5)
v_mfma_f32_16x16x32_bf16 v[68:71],a[96:99],v[240:243],v[68:71]
buffer_load_dwordx4 v42,s[20:23],s65 offen offset:0 sc1 lds
v_mfma_f32_16x16x32_bf16 v[76:79],a[224:227],v[240:243],v[76:79]
ds_read_b128 v[236:239],v43 offset:61440
v_min3_u32 v27,v27,v240,v244
v_mfma_f32_16x16x32_bf16 v[68:71],a[100:103],v[244:247],v[68:71]
buffer_load_dwordx4 v42,s[20:23],s65 offen offset:1024 sc1 lds
v_mfma_f32_16x16x32_bf16 v[76:79],a[228:231],v[244:247],v[76:79]
ds_read_b128 v[240:243],v17 offset:54272
s_waitcnt lgkmcnt(5)
v_mfma_f32_16x16x32_bf16 v[68:71],a[104:107],v[248:251],v[68:71]
s_xor_b32 m0,s72,53248
v_min3_u32 v27,v27,v248,v252
v_mfma_f32_16x16x32_bf16 v[76:79],a[232:235],v[248:251],v[76:79]
ds_read_b128 v[244:247],v43 offset:54272
s_add_u32 s65,s89,768
v_mfma_f32_16x16x32_bf16 v[68:71],a[108:111],v[252:255],v[68:71]
buffer_load_dwordx4 v42,s[20:23],s65 offen offset:0 sc1 lds
v_mfma_f32_16x16x32_bf16 v[76:79],a[236:239],v[252:255],v[76:79]
ds_read_b128 v[248:251],v17 offset:62464
s_waitcnt lgkmcnt(5)
v_mfma_f32_16x16x32_bf16 v[68:71],a[48:51],v[224:227],v[68:71]
buffer_load_dwordx4 v42,s[20:23],s65 offen offset:1024 sc1 lds
v_mfma_f32_16x16x32_bf16 v[76:79],a[176:179],v[224:227],v[76:79]
ds_read_b128 v[252:255],v43 offset:62464
v_min3_u32 v27,v27,v224,v228
v_mfma_f32_16x16x32_bf16 v[68:71],a[52:55],v[228:231],v[68:71]
v_rcp_f32 v89,v89
v_mfma_f32_16x16x32_bf16 v[76:79],a[180:183],v[228:231],v[76:79]
v_mul_f32 v92,v92,v72
s_waitcnt lgkmcnt(4)
v_mfma_f32_16x16x32_bf16 v[68:71],a[56:59],v[232:235],v[68:71]
v_min3_u32 v27,v27,v232,v236
v_mul_f32 v93,v93,v73
v_mfma_f32_16x16x32_bf16 v[76:79],a[184:187],v[232:235],v[76:79]
v_rcp_f32 v90,v90
v_mfma_f32_16x16x32_bf16 v[68:71],a[60:63],v[236:239],v[68:71]
v_rcp_f32 v91,v91
v_mfma_f32_16x16x32_bf16 v[76:79],a[188:191],v[236:239],v[76:79]
v_mul_f32 v88,v88,v64
s_waitcnt lgkmcnt(2)
v_mfma_f32_16x16x32_bf16 v[68:71],a[112:115],v[240:243],v[68:71]
v_min3_u32 v27,v27,v240,v244
v_mul_f32 v89,v89,v65
v_mfma_f32_16x16x32_bf16 v[76:79],a[240:243],v[240:243],v[76:79]
v_mul_f32 v90,v90,v66
v_mul_f32 v91,v91,v67
v_mfma_f32_16x16x32_bf16 v[68:71],a[116:119],v[244:247],v[68:71]
v_mul_f32 v94,v94,v74
v_mul_f32 v95,v95,v75
v_mfma_f32_16x16x32_bf16 v[76:79],a[244:247],v[244:247],v[76:79]
v_cvt_pk_bf16_f32 v96,v88,v89
s_waitcnt lgkmcnt(0)
v_mfma_f32_16x16x32_bf16 v[68:71],a[120:123],v[248:251],v[68:71]
v_min3_u32 v27,v27,v248,v252
v_cvt_pk_bf16_f32 v97,v90,v91
v_mfma_f32_16x16x32_bf16 v[76:79],a[248:251],v[248:251],v[76:79]
v_cvt_pk_bf16_f32 v98,v92,v93
v_cvt_pk_bf16_f32 v99,v94,v95
v_mfma_f32_16x16x32_bf16 v[68:71],a[124:127],v[252:255],v[68:71]
v_max_u32 v96,1,v96
v_mfma_f32_16x16x32_bf16 v[76:79],a[252:255],v[252:255],v[76:79]
buffer_store_dwordx4 v[96:99],v18,s[20:23],s78 offen sc1
v_cmp_eq_u32 vcc,0,v27
s_cbranch_vccnz retry_222
s_branch epi_225
ahead_224:
s_cmp_eq_u32 s93,0
s_cbranch_scc1 both_226
s_waitcnt vmcnt(13) lgkmcnt(0)
s_barrier
ds_read_b128 v[224:227],v17 offset:0
ds_read_b128 v[228:231],v43 offset:0
ds_read_b128 v[232:235],v17 offset:8192
ds_read_b128 v[236:239],v43 offset:8192
ds_read_b128 v[240:243],v17 offset:1024
ds_read_b128 v[244:247],v43 offset:1024
ds_read_b128 v[248:251],v17 offset:9216
s_waitcnt lgkmcnt(5)
v_mfma_f32_16x16x32_bf16 v[64:67],a[0:3],v[224:227],0
s_add_u32 s96,s71,1
s_add_u32 s92,s71,2
v_mfma_f32_16x16x32_bf16 v[72:75],a[128:131],v[224:227],0
ds_read_b128 v[252:255],v43 offset:9216
v_min_u32 v27,v224,v228
v_mfma_f32_16x16x32_bf16 v[64:67],a[4:7],v[228:231],v[64:67]
v_mfma_f32_16x16x32_bf16 v[72:75],a[132:135],v[228:231],v[72:75]
ds_read_b128 v[224:227],v17 offset:16384
s_waitcnt lgkmcnt(5)
v_mfma_f32_16x16x32_bf16 v[64:67],a[8:11],v[232:235],v[64:67]
v_min3_u32 v27,v27,v232,v236
v_mfma_f32_16x16x32_bf16 v[72:75],a[136:139],v[232:235],v[72:75]
ds_read_b128 v[228:231],v43 offset:16384
v_mfma_f32_16x16x32_bf16 v[64:67],a[12:15],v[236:239],v[64:67]
v_mfma_f32_16x16x32_bf16 v[72:75],a[140:143],v[236:239],v[72:75]
ds_read_b128 v[232:235],v17 offset:24576
s_waitcnt lgkmcnt(5)
v_mfma_f32_16x16x32_bf16 v[64:67],a[64:67],v[240:243],v[64:67]
v_min3_u32 v27,v27,v240,v244
v_mfma_f32_16x16x32_bf16 v[72:75],a[192:195],v[240:243],v[72:75]
ds_read_b128 v[236:239],v43 offset:24576
v_mfma_f32_16x16x32_bf16 v[64:67],a[68:71],v[244:247],v[64:67]
v_mfma_f32_16x16x32_bf16 v[72:75],a[196:199],v[244:247],v[72:75]
ds_read_b128 v[240:243],v17 offset:17408
s_waitcnt lgkmcnt(5)
v_mfma_f32_16x16x32_bf16 v[64:67],a[72:75],v[248:251],v[64:67]
v_min3_u32 v27,v27,v248,v252
v_mfma_f32_16x16x32_bf16 v[72:75],a[200:203],v[248:251],v[72:75]
ds_read_b128 v[244:247],v43 offset:17408
v_mfma_f32_16x16x32_bf16 v[64:67],a[76:79],v[252:255],v[64:67]
v_mfma_f32_16x16x32_bf16 v[72:75],a[204:207],v[252:255],v[72:75]
ds_read_b128 v[248:251],v17 offset:25600
s_waitcnt lgkmcnt(5)
v_mfma_f32_16x16x32_bf16 v[64:67],a[16:19],v[224:227],v[64:67]
v_min3_u32 v27,v27,v224,v228
v_mfma_f32_16x16x32_bf16 v[72:75],a[144:147],v[224:227],v[72:75]
ds_read_b128 v[252:255],v43 offset:25600
v_mfma_f32_16x16x32_bf16 v[64:67],a[20:23],v[228:231],v[64:67]
v_mfma_f32_16x16x32_bf16 v[72:75],a[148:151],v[228:231],v[72:75]
ds_read_b128 v[224:227],v17 offset:32768
s_waitcnt lgkmcnt(5)
v_mfma_f32_16x16x32_bf16 v[64:67],a[24:27],v[232:235],v[64:67]
v_min3_u32 v27,v27,v232,v236
v_mfma_f32_16x16x32_bf16 v[72:75],a[152:155],v[232:235],v[72:75]
ds_read_b128 v[228:231],v43 offset:32768
v_mfma_f32_16x16x32_bf16 v[64:67],a[28:31],v[236:239],v[64:67]
v_mfma_f32_16x16x32_bf16 v[72:75],a[156:159],v[236:239],v[72:75]
ds_read_b128 v[232:235],v17 offset:40960
s_waitcnt lgkmcnt(5)
v_mfma_f32_16x16x32_bf16 v[64:67],a[80:83],v[240:243],v[64:67]
v_min3_u32 v27,v27,v240,v244
v_mfma_f32_16x16x32_bf16 v[72:75],a[208:211],v[240:243],v[72:75]
ds_read_b128 v[236:239],v43 offset:40960
v_mfma_f32_16x16x32_bf16 v[64:67],a[84:87],v[244:247],v[64:67]
v_mfma_f32_16x16x32_bf16 v[72:75],a[212:215],v[244:247],v[72:75]
ds_read_b128 v[240:243],v17 offset:33792
s_waitcnt lgkmcnt(5)
v_mfma_f32_16x16x32_bf16 v[64:67],a[88:91],v[248:251],v[64:67]
v_min3_u32 v27,v27,v248,v252
v_mfma_f32_16x16x32_bf16 v[72:75],a[216:219],v[248:251],v[72:75]
ds_read_b128 v[244:247],v43 offset:33792
s_waitcnt vmcnt(3)
v_mfma_f32_16x16x32_bf16 v[64:67],a[92:95],v[252:255],v[64:67]
v_cmp_gt_u32 vcc,s96,v29
v_cmp_gt_u32 s[92:93],s92,v29
v_mfma_f32_16x16x32_bf16 v[72:75],a[220:223],v[252:255],v[72:75]
ds_read_b128 v[248:251],v17 offset:41984
s_waitcnt lgkmcnt(5)
v_mfma_f32_16x16x32_bf16 v[64:67],a[32:35],v[224:227],v[64:67]
v_mov_b32 v44,vcc_lo
v_mov_b32 v45,s92
v_mfma_f32_16x16x32_bf16 v[72:75],a[160:163],v[224:227],v[72:75]
ds_read_b128 v[252:255],v43 offset:41984
ds_write_b64 v46,v[44:45]
v_mfma_f32_16x16x32_bf16 v[64:67],a[36:39],v[228:231],v[64:67]
v_min3_u32 v27,v27,v224,v228
v_mfma_f32_16x16x32_bf16 v[72:75],a[164:167],v[228:231],v[72:75]
ds_read_b128 v[224:227],v17 offset:49152
s_waitcnt lgkmcnt(6)
v_mfma_f32_16x16x32_bf16 v[64:67],a[40:43],v[232:235],v[64:67]
v_min3_u32 v27,v27,v232,v236
v_mfma_f32_16x16x32_bf16 v[72:75],a[168:171],v[232:235],v[72:75]
ds_read_b128 v[228:231],v43 offset:49152
v_mfma_f32_16x16x32_bf16 v[64:67],a[44:47],v[236:239],v[64:67]
v_mfma_f32_16x16x32_bf16 v[72:75],a[172:175],v[236:239],v[72:75]
ds_read_b128 v[232:235],v17 offset:57344
s_waitcnt lgkmcnt(6)
v_mfma_f32_16x16x32_bf16 v[64:67],a[96:99],v[240:243],v[64:67]
v_min3_u32 v27,v27,v240,v244
s_add_u32 s88,s70,s75
v_mfma_f32_16x16x32_bf16 v[72:75],a[224:227],v[240:243],v[72:75]
ds_read_b128 v[236:239],v43 offset:57344
s_add_u32 s88,s88,2097152
v_mfma_f32_16x16x32_bf16 v[64:67],a[100:103],v[244:247],v[64:67]
s_xor_b32 s88,s88,0x2000
s_add_u32 s89,s88,65536
v_mfma_f32_16x16x32_bf16 v[72:75],a[228:231],v[244:247],v[72:75]
ds_read_b128 v[240:243],v17 offset:50176
s_waitcnt lgkmcnt(6)
v_mfma_f32_16x16x32_bf16 v[64:67],a[104:107],v[248:251],v[64:67]
v_min3_u32 v27,v27,v248,v252
v_mfma_f32_16x16x32_bf16 v[72:75],a[232:235],v[248:251],v[72:75]
ds_read_b128 v[244:247],v43 offset:50176
v_mfma_f32_16x16x32_bf16 v[64:67],a[108:111],v[252:255],v[64:67]
v_mfma_f32_16x16x32_bf16 v[72:75],a[236:239],v[252:255],v[72:75]
ds_read_b128 v[248:251],v17 offset:58368
s_waitcnt lgkmcnt(5)
v_mfma_f32_16x16x32_bf16 v[64:67],a[48:51],v[224:227],v[64:67]
v_min3_u32 v27,v27,v224,v228
v_mfma_f32_16x16x32_bf16 v[72:75],a[176:179],v[224:227],v[72:75]
ds_read_b128 v[252:255],v43 offset:58368
v_mfma_f32_16x16x32_bf16 v[64:67],a[52:55],v[228:231],v[64:67]
s_waitcnt vmcnt(0)
v_add_u32 v22,s71,-1
v_mfma_f32_16x16x32_bf16 v[72:75],a[180:183],v[228:231],v[72:75]
s_waitcnt vmcnt(5)
s_barrier
ds_read_b64 v[44:45],v47
ds_read_b128 v[224:227],v17 offset:4096
s_waitcnt lgkmcnt(6)
v_mfma_f32_16x16x32_bf16 v[64:67],a[56:59],v[232:235],v[64:67]
v_min3_u32 v27,v27,v232,v236
buffer_store_dword v22,v23,s[24:27],s97 offen
v_mfma_f32_16x16x32_bf16 v[72:75],a[184:187],v[232:235],v[72:75]
ds_read_b128 v[228:231],v43 offset:4096
v_mfma_f32_16x16x32_bf16 v[64:67],a[60:63],v[236:239],v[64:67]
buffer_store_dword v22,v23,s[28:31],s97 offen sc1
v_mfma_f32_16x16x32_bf16 v[72:75],a[188:191],v[236:239],v[72:75]
ds_read_b128 v[232:235],v17 offset:12288
s_waitcnt lgkmcnt(6)
v_mfma_f32_16x16x32_bf16 v[64:67],a[112:115],v[240:243],v[64:67]
v_min3_u32 v27,v27,v240,v244
s_mov_b32 s97,0x7fff0000
v_mfma_f32_16x16x32_bf16 v[72:75],a[240:243],v[240:243],v[72:75]
ds_read_b128 v[236:239],v43 offset:12288
v_mfma_f32_16x16x32_bf16 v[64:67],a[116:119],v[244:247],v[64:67]
v_mfma_f32_16x16x32_bf16 v[72:75],a[244:247],v[244:247],v[72:75]
ds_read_b128 v[240:243],v17 offset:5120
s_waitcnt lgkmcnt(6)
v_mfma_f32_16x16x32_bf16 v[64:67],a[120:123],v[248:251],v[64:67]
s_waitcnt lgkmcnt(5)
v_readfirstlane_b32 s93,v45
v_mfma_f32_16x16x32_bf16 v[72:75],a[248:251],v[248:251],v[72:75]
ds_read_b128 v[244:247],v43 offset:5120
v_readfirstlane_b32 s83,v44
s_cmp_lg_u32 s83,0
s_cbranch_scc1 keep_234
v_mfma_f32_16x16x32_bf16 v[64:67],a[124:127],v[252:255],v[64:67]
v_min3_u32 v27,v27,v248,v252
s_xor_b32 m0,s72,0
v_mfma_f32_16x16x32_bf16 v[72:75],a[252:255],v[252:255],v[72:75]
ds_read_b128 v[248:251],v17 offset:13312
s_waitcnt lgkmcnt(5)
v_mfma_f32_16x16x32_bf16 v[68:71],a[0:3],v[224:227],0
s_add_u32 s65,s88,0
v_cmp_eq_u32 vcc,0,v27
s_cbranch_vccnz retry_222
v_mfma_f32_16x16x32_bf16 v[76:79],a[128:131],v[224:227],0
ds_read_b128 v[252:255],v43 offset:13312
v_min3_u32 v27,v27,v224,v228
v_mfma_f32_16x16x32_bf16 v[68:71],a[4:7],v[228:231],v[68:71]
buffer_load_dwordx4 v42,s[20:23],s65 offen offset:0 sc1 lds
v_mfma_f32_16x16x32_bf16 v[76:79],a[132:135],v[228:231],v[76:79]
ds_read_b128 v[224:227],v17 offset:20480
s_waitcnt lgkmcnt(5)
v_mfma_f32_16x16x32_bf16 v[68:71],a[8:11],v[232:235],v[68:71]
buffer_load_dwordx4 v42,s[20:23],s65 offen offset:1024 sc1 lds
v_mul_f32 v88,v64,v64
v_mul_f32 v89,v65,v65
v_mfma_f32_16x16x32_bf16 v[76:79],a[136:139],v[232:235],v[76:79]
ds_read_b128 v[228:231],v43 offset:20480
s_xor_b32 m0,s72,16384
v_mul_f32 v90,v66,v66
v_mul_f32 v91,v67,v67
v_mfma_f32_16x16x32_bf16 v[68:71],a[12:15],v[236:239],v[68:71]
s_add_u32 s65,s88,256
v_min3_u32 v27,v27,v232,v236
v_fma_f32 v88,v88,s81,v28
v_fma_f32 v89,v89,s81,v28
v_mfma_f32_16x16x32_bf16 v[76:79],a[140:143],v[236:239],v[76:79]
ds_read_b128 v[232:235],v17 offset:28672
v_fma_f32 v90,v90,s81,v28
v_fma_f32 v91,v91,s81,v28
s_waitcnt lgkmcnt(5)
v_mfma_f32_16x16x32_bf16 v[68:71],a[64:67],v[240:243],v[68:71]
buffer_load_dwordx4 v42,s[20:23],s65 offen offset:0 sc1 lds
v_mul_f32 v88,v88,v64
v_mul_f32 v89,v89,v65
v_mfma_f32_16x16x32_bf16 v[76:79],a[192:195],v[240:243],v[76:79]
ds_read_b128 v[236:239],v43 offset:28672
v_min3_u32 v27,v27,v240,v244
v_mul_f32 v90,v90,v66
v_mul_f32 v91,v91,v67
v_mfma_f32_16x16x32_bf16 v[68:71],a[68:71],v[244:247],v[68:71]
buffer_load_dwordx4 v42,s[20:23],s65 offen offset:1024 sc1 lds
v_exp_f32 v88,v88
v_mfma_f32_16x16x32_bf16 v[76:79],a[196:199],v[244:247],v[76:79]
ds_read_b128 v[240:243],v17 offset:21504
v_exp_f32 v89,v89
s_waitcnt lgkmcnt(5)
v_mfma_f32_16x16x32_bf16 v[68:71],a[72:75],v[248:251],v[68:71]
s_xor_b32 m0,s72,32768
s_add_u32 s65,s88,512
v_exp_f32 v90,v90
v_mfma_f32_16x16x32_bf16 v[76:79],a[200:203],v[248:251],v[76:79]
ds_read_b128 v[244:247],v43 offset:21504
v_min3_u32 v27,v27,v248,v252
v_exp_f32 v91,v91
v_mfma_f32_16x16x32_bf16 v[68:71],a[76:79],v[252:255],v[68:71]
buffer_load_dwordx4 v42,s[20:23],s65 offen offset:0 sc1 lds
v_add_f32 v88,1.0,v88
v_add_f32 v89,1.0,v89
v_mfma_f32_16x16x32_bf16 v[76:79],a[204:207],v[252:255],v[76:79]
ds_read_b128 v[248:251],v17 offset:29696
v_add_f32 v90,1.0,v90
v_add_f32 v91,1.0,v91
s_waitcnt lgkmcnt(5)
v_mfma_f32_16x16x32_bf16 v[68:71],a[16:19],v[224:227],v[68:71]
buffer_load_dwordx4 v42,s[20:23],s65 offen offset:1024 sc1 lds
v_rcp_f32 v88,v88
v_mfma_f32_16x16x32_bf16 v[76:79],a[144:147],v[224:227],v[76:79]
ds_read_b128 v[252:255],v43 offset:29696
s_xor_b32 m0,s72,49152
v_mul_f32 v92,v72,v72
v_mul_f32 v93,v73,v73
v_mfma_f32_16x16x32_bf16 v[68:71],a[20:23],v[228:231],v[68:71]
v_min3_u32 v27,v27,v224,v228
v_mul_f32 v94,v74,v74
v_mul_f32 v95,v75,v75
v_fma_f32 v92,v92,s81,v28
v_mfma_f32_16x16x32_bf16 v[76:79],a[148:151],v[228:231],v[76:79]
ds_read_b128 v[224:227],v17 offset:36864
v_fma_f32 v93,v93,s81,v28
v_fma_f32 v94,v94,s81,v28
s_waitcnt lgkmcnt(5)
v_mfma_f32_16x16x32_bf16 v[68:71],a[24:27],v[232:235],v[68:71]
s_add_u32 s65,s88,768
v_min3_u32 v27,v27,v232,v236
v_fma_f32 v95,v95,s81,v28
v_mul_f32 v92,v92,v72
v_mfma_f32_16x16x32_bf16 v[76:79],a[152:155],v[232:235],v[76:79]
ds_read_b128 v[228:231],v43 offset:36864
v_mul_f32 v93,v93,v73
v_mul_f32 v94,v94,v74
v_mul_f32 v95,v95,v75
v_mfma_f32_16x16x32_bf16 v[68:71],a[28:31],v[236:239],v[68:71]
buffer_load_dwordx4 v42,s[20:23],s65 offen offset:0 sc1 lds
v_exp_f32 v92,v92
v_mfma_f32_16x16x32_bf16 v[76:79],a[156:159],v[236:239],v[76:79]
ds_read_b128 v[232:235],v17 offset:45056
v_exp_f32 v93,v93
s_waitcnt lgkmcnt(5)
v_mfma_f32_16x16x32_bf16 v[68:71],a[80:83],v[240:243],v[68:71]
buffer_load_dwordx4 v42,s[20:23],s65 offen offset:1024 sc1 lds
v_exp_f32 v94,v94
v_mfma_f32_16x16x32_bf16 v[76:79],a[208:211],v[240:243],v[76:79]
ds_read_b128 v[236:239],v43 offset:45056
s_xor_b32 m0,s72,4096
v_exp_f32 v95,v95
v_mfma_f32_16x16x32_bf16 v[68:71],a[84:87],v[244:247],v[68:71]
s_add_u32 s65,s89,0
v_min3_u32 v27,v27,v240,v244
v_add_f32 v92,1.0,v92
v_add_f32 v93,1.0,v93
v_mfma_f32_16x16x32_bf16 v[76:79],a[212:215],v[244:247],v[76:79]
ds_read_b128 v[240:243],v17 offset:37888
v_add_f32 v94,1.0,v94
v_add_f32 v95,1.0,v95
s_waitcnt lgkmcnt(5)
v_mfma_f32_16x16x32_bf16 v[68:71],a[88:91],v[248:251],v[68:71]
buffer_load_dwordx4 v42,s[20:23],s65 offen offset:0 sc1 lds
v_rcp_f32 v92,v92
v_mfma_f32_16x16x32_bf16 v[76:79],a[216:219],v[248:251],v[76:79]
ds_read_b128 v[244:247],v43 offset:37888
v_min3_u32 v27,v27,v248,v252
v_rcp_f32 v93,v93
v_mfma_f32_16x16x32_bf16 v[68:71],a[92:95],v[252:255],v[68:71]
buffer_load_dwordx4 v42,s[20:23],s65 offen offset:1024 sc1 lds
v_rcp_f32 v94,v94
v_mfma_f32_16x16x32_bf16 v[76:79],a[220:223],v[252:255],v[76:79]
ds_read_b128 v[248:251],v17 offset:46080
v_rcp_f32 v95,v95
s_waitcnt lgkmcnt(5)
v_mfma_f32_16x16x32_bf16 v[68:71],a[32:35],v[224:227],v[68:71]
s_xor_b32 m0,s72,20480
s_add_u32 s65,s89,256
v_mfma_f32_16x16x32_bf16 v[76:79],a[160:163],v[224:227],v[76:79]
ds_read_b128 v[252:255],v43 offset:46080
v_min3_u32 v27,v27,v224,v228
v_mfma_f32_16x16x32_bf16 v[68:71],a[36:39],v[228:231],v[68:71]
buffer_load_dwordx4 v42,s[20:23],s65 offen offset:0 sc1 lds
v_mfma_f32_16x16x32_bf16 v[76:79],a[164:167],v[228:231],v[76:79]
ds_read_b128 v[224:227],v17 offset:53248
s_waitcnt lgkmcnt(5)
v_mfma_f32_16x16x32_bf16 v[68:71],a[40:43],v[232:235],v[68:71]
buffer_load_dwordx4 v42,s[20:23],s65 offen offset:1024 sc1 lds
v_mfma_f32_16x16x32_bf16 v[76:79],a[168:171],v[232:235],v[76:79]
ds_read_b128 v[228:231],v43 offset:53248
s_xor_b32 m0,s72,36864
v_mfma_f32_16x16x32_bf16 v[68:71],a[44:47],v[236:239],v[68:71]
s_add_u32 s65,s89,512
v_min3_u32 v27,v27,v232,v236
v_mfma_f32_16x16x32_bf16 v[76:79],a[172:175],v[236:239],v[76:79]
ds_read_b128 v[232:235],v17 offset:61440
s_waitcnt lgkmcnt(5)
v_mfma_f32_16x16x32_bf16 v[68:71],a[96:99],v[240:243],v[68:71]
buffer_load_dwordx4 v42,s[20:23],s65 offen offset:0 sc1 lds
v_mfma_f32_16x16x32_bf16 v[76:79],a[224:227],v[240:243],v[76:79]
ds_read_b128 v[236:239],v43 offset:61440
v_min3_u32 v27,v27,v240,v244
v_mfma_f32_16x16x32_bf16 v[68:71],a[100:103],v[244:247],v[68:71]
buffer_load_dwordx4 v42,s[20:23],s65 offen offset:1024 sc1 lds
v_mfma_f32_16x16x32_bf16 v[76:79],a[228:231],v[244:247],v[76:79]
ds_read_b128 v[240:243],v17 offset:54272
s_waitcnt lgkmcnt(5)
v_mfma_f32_16x16x32_bf16 v[68:71],a[104:107],v[248:251],v[68:71]
s_xor_b32 m0,s72,53248
v_min3_u32 v27,v27,v248,v252
v_mfma_f32_16x16x32_bf16 v[76:79],a[232:235],v[248:251],v[76:79]
ds_read_b128 v[244:247],v43 offset:54272
s_add_u32 s65,s89,768
v_mfma_f32_16x16x32_bf16 v[68:71],a[108:111],v[252:255],v[68:71]
buffer_load_dwordx4 v42,s[20:23],s65 offen offset:0 sc1 lds
v_mfma_f32_16x16x32_bf16 v[76:79],a[236:239],v[252:255],v[76:79]
ds_read_b128 v[248:251],v17 offset:62464
s_waitcnt lgkmcnt(5)
v_mfma_f32_16x16x32_bf16 v[68:71],a[48:51],v[224:227],v[68:71]
buffer_load_dwordx4 v42,s[20:23],s65 offen offset:1024 sc1 lds
v_mfma_f32_16x16x32_bf16 v[76:79],a[176:179],v[224:227],v[76:79]
ds_read_b128 v[252:255],v43 offset:62464
v_min3_u32 v27,v27,v224,v228
v_mfma_f32_16x16x32_bf16 v[68:71],a[52:55],v[228:231],v[68:71]
v_rcp_f32 v89,v89
v_mfma_f32_16x16x32_bf16 v[76:79],a[180:183],v[228:231],v[76:79]
v_mul_f32 v92,v92,v72
s_waitcnt lgkmcnt(4)
v_mfma_f32_16x16x32_bf16 v[68:71],a[56:59],v[232:235],v[68:71]
v_min3_u32 v27,v27,v232,v236
v_mul_f32 v93,v93,v73
v_mfma_f32_16x16x32_bf16 v[76:79],a[184:187],v[232:235],v[76:79]
v_rcp_f32 v90,v90
v_mfma_f32_16x16x32_bf16 v[68:71],a[60:63],v[236:239],v[68:71]
v_rcp_f32 v91,v91
v_mfma_f32_16x16x32_bf16 v[76:79],a[188:191],v[236:239],v[76:79]
v_mul_f32 v88,v88,v64
s_waitcnt lgkmcnt(2)
v_mfma_f32_16x16x32_bf16 v[68:71],a[112:115],v[240:243],v[68:71]
v_min3_u32 v27,v27,v240,v244
v_mul_f32 v89,v89,v65
v_mfma_f32_16x16x32_bf16 v[76:79],a[240:243],v[240:243],v[76:79]
v_mul_f32 v90,v90,v66
v_mul_f32 v91,v91,v67
v_mfma_f32_16x16x32_bf16 v[68:71],a[116:119],v[244:247],v[68:71]
v_mul_f32 v94,v94,v74
v_mul_f32 v95,v95,v75
v_mfma_f32_16x16x32_bf16 v[76:79],a[244:247],v[244:247],v[76:79]
v_cvt_pk_bf16_f32 v96,v88,v89
s_waitcnt lgkmcnt(0)
v_mfma_f32_16x16x32_bf16 v[68:71],a[120:123],v[248:251],v[68:71]
v_min3_u32 v27,v27,v248,v252
v_cvt_pk_bf16_f32 v97,v90,v91
v_mfma_f32_16x16x32_bf16 v[76:79],a[248:251],v[248:251],v[76:79]
v_cvt_pk_bf16_f32 v98,v92,v93
v_cvt_pk_bf16_f32 v99,v94,v95
v_mfma_f32_16x16x32_bf16 v[68:71],a[124:127],v[252:255],v[68:71]
v_max_u32 v96,1,v96
v_mfma_f32_16x16x32_bf16 v[76:79],a[252:255],v[252:255],v[76:79]
buffer_store_dwordx4 v[96:99],v18,s[20:23],s78 offen sc1
v_cmp_eq_u32 vcc,0,v27
s_cbranch_vccnz retry_222
s_branch epi_225
keep_234:
v_mfma_f32_16x16x32_bf16 v[64:67],a[124:127],v[252:255],v[64:67]
v_min3_u32 v27,v27,v248,v252
v_mfma_f32_16x16x32_bf16 v[72:75],a[252:255],v[252:255],v[72:75]
ds_read_b128 v[248:251],v17 offset:13312
s_waitcnt lgkmcnt(5)
v_mfma_f32_16x16x32_bf16 v[68:71],a[0:3],v[224:227],0
v_cmp_eq_u32 vcc,0,v27
s_cbranch_vccnz retry_222
v_mfma_f32_16x16x32_bf16 v[76:79],a[128:131],v[224:227],0
ds_read_b128 v[252:255],v43 offset:13312
v_min3_u32 v27,v27,v224,v228
v_mfma_f32_16x16x32_bf16 v[68:71],a[4:7],v[228:231],v[68:71]
v_mfma_f32_16x16x32_bf16 v[76:79],a[132:135],v[228:231],v[76:79]
ds_read_b128 v[224:227],v17 offset:20480
s_waitcnt lgkmcnt(5)
v_mfma_f32_16x16x32_bf16 v[68:71],a[8:11],v[232:235],v[68:71]
v_min3_u32 v27,v27,v232,v236
v_mul_f32 v88,v64,v64
v_mul_f32 v92,v72,v72
v_mfma_f32_16x16x32_bf16 v[76:79],a[136:139],v[232:235],v[76:79]
ds_read_b128 v[228:231],v43 offset:20480
v_mul_f32 v89,v65,v65
v_mul_f32 v93,v73,v73
v_mfma_f32_16x16x32_bf16 v[68:71],a[12:15],v[236:239],v[68:71]
v_mul_f32 v90,v66,v66
v_mul_f32 v91,v67,v67
v_mul_f32 v94,v74,v74
v_mfma_f32_16x16x32_bf16 v[76:79],a[140:143],v[236:239],v[76:79]
ds_read_b128 v[232:235],v17 offset:28672
v_mul_f32 v95,v75,v75
s_waitcnt lgkmcnt(5)
v_mfma_f32_16x16x32_bf16 v[68:71],a[64:67],v[240:243],v[68:71]
v_min3_u32 v27,v27,v240,v244
v_fma_f32 v88,v88,s81,v28
v_fma_f32 v92,v92,s81,v28
v_mfma_f32_16x16x32_bf16 v[76:79],a[192:195],v[240:243],v[76:79]
ds_read_b128 v[236:239],v43 offset:28672
v_fma_f32 v89,v89,s81,v28
v_fma_f32 v93,v93,s81,v28
v_mfma_f32_16x16x32_bf16 v[68:71],a[68:71],v[244:247],v[68:71]
v_fma_f32 v90,v90,s81,v28
v_fma_f32 v91,v91,s81,v28
v_fma_f32 v94,v94,s81,v28
v_mfma_f32_16x16x32_bf16 v[76:79],a[196:199],v[244:247],v[76:79]
ds_read_b128 v[240:243],v17 offset:21504
v_fma_f32 v95,v95,s81,v28
s_waitcnt lgkmcnt(5)
v_mfma_f32_16x16x32_bf16 v[68:71],a[72:75],v[248:251],v[68:71]
v_min3_u32 v27,v27,v248,v252
v_mul_f32 v88,v88,v64
v_mul_f32 v92,v92,v72
v_mfma_f32_16x16x32_bf16 v[76:79],a[200:203],v[248:251],v[76:79]
ds_read_b128 v[244:247],v43 offset:21504
v_mul_f32 v89,v89,v65
v_mul_f32 v93,v93,v73
v_mfma_f32_16x16x32_bf16 v[68:71],a[76:79],v[252:255],v[68:71]
v_mul_f32 v90,v90,v66
v_mul_f32 v91,v91,v67
v_mul_f32 v94,v94,v74
v_mfma_f32_16x16x32_bf16 v[76:79],a[204:207],v[252:255],v[76:79]
ds_read_b128 v[248:251],v17 offset:29696
v_mul_f32 v95,v95,v75
s_waitcnt lgkmcnt(5)
v_mfma_f32_16x16x32_bf16 v[68:71],a[16:19],v[224:227],v[68:71]
v_min3_u32 v27,v27,v224,v228
v_exp_f32 v92,v92
v_mfma_f32_16x16x32_bf16 v[76:79],a[144:147],v[224:227],v[76:79]
ds_read_b128 v[252:255],v43 offset:29696
v_exp_f32 v93,v93
v_mfma_f32_16x16x32_bf16 v[68:71],a[20:23],v[228:231],v[68:71]
v_exp_f32 v88,v88
v_mfma_f32_16x16x32_bf16 v[76:79],a[148:151],v[228:231],v[76:79]
ds_read_b128 v[224:227],v17 offset:36864
s_waitcnt lgkmcnt(5)
v_mfma_f32_16x16x32_bf16 v[68:71],a[24:27],v[232:235],v[68:71]
v_min3_u32 v27,v27,v232,v236
v_exp_f32 v94,v94
v_mfma_f32_16x16x32_bf16 v[76:79],a[152:155],v[232:235],v[76:79]
ds_read_b128 v[228:231],v43 offset:36864
v_exp_f32 v95,v95
v_mfma_f32_16x16x32_bf16 v[68:71],a[28:31],v[236:239],v[68:71]
v_exp_f32 v89,v89
v_add_f32 v92,1.0,v92
v_mfma_f32_16x16x32_bf16 v[76:79],a[156:159],v[236:239],v[76:79]
ds_read_b128 v[232:235],v17 offset:45056
v_add_f32 v93,1.0,v93
s_waitcnt lgkmcnt(5)
v_mfma_f32_16x16x32_bf16 v[68:71],a[80:83],v[240:243],v[68:71]
v_min3_u32 v27,v27,v240,v244
v_add_f32 v94,1.0,v94
v_add_f32 v95,1.0,v95
v_mfma_f32_16x16x32_bf16 v[76:79],a[208:211],v[240:243],v[76:79]
ds_read_b128 v[236:239],v43 offset:45056
v_rcp_f32 v92,v92
v_mfma_f32_16x16x32_bf16 v[68:71],a[84:87],v[244:247],v[68:71]
v_exp_f32 v90,v90
v_mfma_f32_16x16x32_bf16 v[76:79],a[212:215],v[244:247],v[76:79]
ds_read_b128 v[240:243],v17 offset:37888
s_waitcnt lgkmcnt(5)
v_mfma_f32_16x16x32_bf16 v[68:71],a[88:91],v[248:251],v[68:71]
v_min3_u32 v27,v27,v248,v252
v_rcp_f32 v93,v93
v_mfma_f32_16x16x32_bf16 v[76:79],a[216:219],v[248:251],v[76:79]
ds_read_b128 v[244:247],v43 offset:37888
v_rcp_f32 v94,v94
v_mfma_f32_16x16x32_bf16 v[68:71],a[92:95],v[252:255],v[68:71]
v_exp_f32 v91,v91
v_mfma_f32_16x16x32_bf16 v[76:79],a[220:223],v[252:255],v[76:79]
ds_read_b128 v[248:251],v17 offset:46080
s_waitcnt lgkmcnt(5)
v_mfma_f32_16x16x32_bf16 v[68:71],a[32:35],v[224:227],v[68:71]
v_min3_u32 v27,v27,v224,v228
v_add_f32 v88,1.0,v88
v_mfma_f32_16x16x32_bf16 v[76:79],a[160:163],v[224:227],v[76:79]
ds_read_b128 v[252:255],v43 offset:46080
v_add_f32 v89,1.0,v89
v_mfma_f32_16x16x32_bf16 v[68:71],a[36:39],v[228:231],v[68:71]
v_add_f32 v90,1.0,v90
v_add_f32 v91,1.0,v91
v_mfma_f32_16x16x32_bf16 v[76:79],a[164:167],v[228:231],v[76:79]
ds_read_b128 v[224:227],v17 offset:53248
s_waitcnt lgkmcnt(5)
v_mfma_f32_16x16x32_bf16 v[68:71],a[40:43],v[232:235],v[68:71]
v_min3_u32 v27,v27,v232,v236
v_mfma_f32_16x16x32_bf16 v[76:79],a[168:171],v[232:235],v[76:79]
ds_read_b128 v[228:231],v43 offset:53248
v_mfma_f32_16x16x32_bf16 v[68:71],a[44:47],v[236:239],v[68:71]
v_rcp_f32 v88,v88
v_mfma_f32_16x16x32_bf16 v[76:79],a[172:175],v[236:239],v[76:79]
ds_read_b128 v[232:235],v17 offset:61440
s_waitcnt lgkmcnt(5)
v_mfma_f32_16x16x32_bf16 v[68:71],a[96:99],v[240:243],v[68:71]
v_min3_u32 v27,v27,v240,v244
v_mfma_f32_16x16x32_bf16 v[76:79],a[224:227],v[240:243],v[76:79]
ds_read_b128 v[236:239],v43 offset:61440
v_mfma_f32_16x16x32_bf16 v[68:71],a[100:103],v[244:247],v[68:71]
v_rcp_f32 v89,v89
v_mfma_f32_16x16x32_bf16 v[76:79],a[228:231],v[244:247],v[76:79]
ds_read_b128 v[240:243],v17 offset:54272
s_waitcnt lgkmcnt(5)
v_mfma_f32_16x16x32_bf16 v[68:71],a[104:107],v[248:251],v[68:71]
v_min3_u32 v27,v27,v248,v252
v_mfma_f32_16x16x32_bf16 v[76:79],a[232:235],v[248:251],v[76:79]
ds_read_b128 v[244:247],v43 offset:54272
v_mfma_f32_16x16x32_bf16 v[68:71],a[108:111],v[252:255],v[68:71]
v_rcp_f32 v90,v90
v_mfma_f32_16x16x32_bf16 v[76:79],a[236:239],v[252:255],v[76:79]
ds_read_b128 v[248:251],v17 offset:62464
s_waitcnt lgkmcnt(5)
v_mfma_f32_16x16x32_bf16 v[68:71],a[48:51],v[224:227],v[68:71]
v_min3_u32 v27,v27,v224,v228
v_mfma_f32_16x16x32_bf16 v[76:79],a[176:179],v[224:227],v[76:79]
ds_read_b128 v[252:255],v43 offset:62464
v_mfma_f32_16x16x32_bf16 v[68:71],a[52:55],v[228:231],v[68:71]
v_rcp_f32 v91,v91
v_mfma_f32_16x16x32_bf16 v[76:79],a[180:183],v[228:231],v[76:79]
v_mul_f32 v88,v88,v64
s_waitcnt lgkmcnt(4)
v_mfma_f32_16x16x32_bf16 v[68:71],a[56:59],v[232:235],v[68:71]
v_min3_u32 v27,v27,v232,v236
v_mul_f32 v89,v89,v65
v_mfma_f32_16x16x32_bf16 v[76:79],a[184:187],v[232:235],v[76:79]
v_mul_f32 v90,v90,v66
v_mul_f32 v91,v91,v67
v_mfma_f32_16x16x32_bf16 v[68:71],a[60:63],v[236:239],v[68:71]
v_rcp_f32 v95,v95
v_mfma_f32_16x16x32_bf16 v[76:79],a[188:191],v[236:239],v[76:79]
v_mul_f32 v92,v92,v72
s_waitcnt lgkmcnt(2)
v_mfma_f32_16x16x32_bf16 v[68:71],a[112:115],v[240:243],v[68:71]
v_min3_u32 v27,v27,v240,v244
v_mul_f32 v93,v93,v73
v_mfma_f32_16x16x32_bf16 v[76:79],a[240:243],v[240:243],v[76:79]
v_mul_f32 v94,v94,v74
v_mul_f32 v95,v95,v75
v_mfma_f32_16x16x32_bf16 v[68:71],a[116:119],v[244:247],v[68:71]
v_cvt_pk_bf16_f32 v96,v88,v89
v_cvt_pk_bf16_f32 v97,v90,v91
v_mfma_f32_16x16x32_bf16 v[76:79],a[244:247],v[244:247],v[76:79]
v_cvt_pk_bf16_f32 v98,v92,v93
s_waitcnt lgkmcnt(0)
v_mfma_f32_16x16x32_bf16 v[68:71],a[120:123],v[248:251],v[68:71]
v_min3_u32 v27,v27,v248,v252
v_cvt_pk_bf16_f32 v99,v94,v95
v_mfma_f32_16x16x32_bf16 v[76:79],a[248:251],v[248:251],v[76:79]
v_max_u32 v96,1,v96
v_mfma_f32_16x16x32_bf16 v[68:71],a[124:127],v[252:255],v[68:71]
buffer_store_dwordx4 v[96:99],v18,s[20:23],s78 offen sc1
v_mfma_f32_16x16x32_bf16 v[76:79],a[252:255],v[252:255],v[76:79]
v_cmp_eq_u32 vcc,0,v27
s_cbranch_vccnz retry_222
s_branch epi_225
both_226:
s_waitcnt vmcnt(13) lgkmcnt(0)
s_barrier
ds_read_b128 v[224:227],v17 offset:0
ds_read_b128 v[228:231],v43 offset:0
ds_read_b128 v[232:235],v17 offset:8192
ds_read_b128 v[236:239],v43 offset:8192
ds_read_b128 v[240:243],v17 offset:1024
ds_read_b128 v[244:247],v43 offset:1024
ds_read_b128 v[248:251],v17 offset:9216
s_waitcnt lgkmcnt(5)
v_mfma_f32_16x16x32_bf16 v[64:67],a[0:3],v[224:227],0
s_add_u32 s96,s71,1
s_add_u32 s92,s71,2
v_min_u32 v27,v224,v228
v_mfma_f32_16x16x32_bf16 v[72:75],a[128:131],v[224:227],0
ds_read_b128 v[252:255],v43 offset:9216
s_add_u32 s88,s70,s75
v_mfma_f32_16x16x32_bf16 v[64:67],a[4:7],v[228:231],v[64:67]
s_add_u32 s88,s88,2097152
s_xor_b32 s88,s88,0x2000
v_mfma_f32_16x16x32_bf16 v[72:75],a[132:135],v[228:231],v[72:75]
ds_read_b128 v[224:227],v17 offset:16384
s_waitcnt lgkmcnt(5)
v_mfma_f32_16x16x32_bf16 v[64:67],a[8:11],v[232:235],v[64:67]
s_add_u32 s89,s88,65536
v_min3_u32 v27,v27,v232,v236
v_mfma_f32_16x16x32_bf16 v[72:75],a[136:139],v[232:235],v[72:75]
ds_read_b128 v[228:231],v43 offset:16384
v_mfma_f32_16x16x32_bf16 v[64:67],a[12:15],v[236:239],v[64:67]
s_xor_b32 m0,s72,0
v_mfma_f32_16x16x32_bf16 v[72:75],a[140:143],v[236:239],v[72:75]
ds_read_b128 v[232:235],v17 offset:24576
s_add_u32 s65,s88,0
s_waitcnt lgkmcnt(5)
v_mfma_f32_16x16x32_bf16 v[64:67],a[64:67],v[240:243],v[64:67]
v_min3_u32 v27,v27,v240,v244
v_mfma_f32_16x16x32_bf16 v[72:75],a[192:195],v[240:243],v[72:75]
ds_read_b128 v[236:239],v43 offset:24576
buffer_load_dwordx4 v42,s[20:23],s65 offen offset:0 sc1 lds
v_mfma_f32_16x16x32_bf16 v[64:67],a[68:71],v[244:247],v[64:67]
buffer_load_dwordx4 v42,s[20:23],s65 offen offset:1024 sc1 lds
v_mfma_f32_16x16x32_bf16 v[72:75],a[196:199],v[244:247],v[72:75]
ds_read_b128 v[240:243],v17 offset:17408
s_waitcnt lgkmcnt(5)
v_mfma_f32_16x16x32_bf16 v[64:67],a[72:75],v[248:251],v[64:67]
s_xor_b32 m0,s72,16384
v_min3_u32 v27,v27,v248,v252
v_mfma_f32_16x16x32_bf16 v[72:75],a[200:203],v[248:251],v[72:75]
ds_read_b128 v[244:247],v43 offset:17408
v_mfma_f32_16x16x32_bf16 v[64:67],a[76:79],v[252:255],v[64:67]
s_add_u32 s65,s88,256
v_mfma_f32_16x16x32_bf16 v[72:75],a[204:207],v[252:255],v[72:75]
ds_read_b128 v[248:251],v17 offset:25600
s_waitcnt lgkmcnt(5)
v_mfma_f32_16x16x32_bf16 v[64:67],a[16:19],v[224:227],v[64:67]
buffer_load_dwordx4 v42,s[20:23],s65 offen offset:0 sc1 lds
v_mfma_f32_16x16x32_bf16 v[72:75],a[144:147],v[224:227],v[72:75]
ds_read_b128 v[252:255],v43 offset:25600
buffer_load_dwordx4 v42,s[20:23],s65 offen offset:1024 sc1 lds
v_mfma_f32_16x16x32_bf16 v[64:67],a[20:23],v[228:231],v[64:67]
v_min3_u32 v27,v27,v224,v228
v_mfma_f32_16x16x32_bf16 v[72:75],a[148:151],v[228:231],v[72:75]
ds_read_b128 v[224:227],v17 offset:32768
s_xor_b32 m0,s72,32768
s_waitcnt lgkmcnt(5)
v_mfma_f32_16x16x32_bf16 v[64:67],a[24:27],v[232:235],v[64:67]
s_add_u32 s65,s88,512
v_min3_u32 v27,v27,v232,v236
v_mfma_f32_16x16x32_bf16 v[72:75],a[152:155],v[232:235],v[72:75]
ds_read_b128 v[228:231],v43 offset:32768
v_mfma_f32_16x16x32_bf16 v[64:67],a[28:31],v[236:239],v[64:67]
buffer_load_dwordx4 v42,s[20:23],s65 offen offset:0 sc1 lds
v_mfma_f32_16x16x32_bf16 v[72:75],a[156:159],v[236:239],v[72:75]
ds_read_b128 v[232:235],v17 offset:40960
s_waitcnt lgkmcnt(5)
v_mfma_f32_16x16x32_bf16 v[64:67],a[80:83],v[240:243],v[64:67]
buffer_load_dwordx4 v42,s[20:23],s65 offen offset:1024 sc1 lds
v_mfma_f32_16x16x32_bf16 v[72:75],a[208:211],v[240:243],v[72:75]
ds_read_b128 v[236:239],v43 offset:40960
s_xor_b32 m0,s72,49152
v_mfma_f32_16x16x32_bf16 v[64:67],a[84:87],v[244:247],v[64:67]
v_min3_u32 v27,v27,v240,v244
v_mfma_f32_16x16x32_bf16 v[72:75],a[212:215],v[244:247],v[72:75]
ds_read_b128 v[240:243],v17 offset:33792
s_add_u32 s65,s88,768
s_waitcnt lgkmcnt(5)
v_mfma_f32_16x16x32_bf16 v[64:67],a[88:91],v[248:251],v[64:67]
buffer_load_dwordx4 v42,s[20:23],s65 offen offset:0 sc1 lds
v_min3_u32 v27,v27,v248,v252
v_mfma_f32_16x16x32_bf16 v[72:75],a[216:219],v[248:251],v[72:75]
ds_read_b128 v[244:247],v43 offset:33792
s_waitcnt vmcnt(10)
v_mfma_f32_16x16x32_bf16 v[64:67],a[92:95],v[252:255],v[64:67]
v_cmp_gt_u32 vcc,s96,v29
v_cmp_gt_u32 s[92:93],s92,v29
v_mfma_f32_16x16x32_bf16 v[72:75],a[220:223],v[252:255],v[72:75]
ds_read_b128 v[248:251],v17 offset:41984
s_waitcnt lgkmcnt(5)
v_mfma_f32_16x16x32_bf16 v[64:67],a[32:35],v[224:227],v[64:67]
v_mov_b32 v44,vcc_lo
v_mov_b32 v45,s92
v_min3_u32 v27,v27,v224,v228
v_mfma_f32_16x16x32_bf16 v[72:75],a[160:163],v[224:227],v[72:75]
ds_read_b128 v[252:255],v43 offset:41984
ds_write_b64 v46,v[44:45]
v_mfma_f32_16x16x32_bf16 v[64:67],a[36:39],v[228:231],v[64:67]
buffer_load_dwordx4 v42,s[20:23],s65 offen offset:1024 sc1 lds
v_mfma_f32_16x16x32_bf16 v[72:75],a[164:167],v[228:231],v[72:75]
ds_read_b128 v[224:227],v17 offset:49152
s_waitcnt lgkmcnt(6)
v_mfma_f32_16x16x32_bf16 v[64:67],a[40:43],v[232:235],v[64:67]
s_xor_b32 m0,s72,4096
s_add_u32 s65,s89,0
v_mfma_f32_16x16x32_bf16 v[72:75],a[168:171],v[232:235],v[72:75]
ds_read_b128 v[228:231],v43 offset:49152
v_min3_u32 v27,v27,v232,v236
v_mfma_f32_16x16x32_bf16 v[64:67],a[44:47],v[236:239],v[64:67]
buffer_load_dwordx4 v42,s[20:23],s65 offen offset:0 sc1 lds
v_mfma_f32_16x16x32_bf16 v[72:75],a[172:175],v[236:239],v[72:75]
ds_read_b128 v[232:235],v17 offset:57344
s_waitcnt lgkmcnt(6)
v_mfma_f32_16x16x32_bf16 v[64:67],a[96:99],v[240:243],v[64:67]
buffer_load_dwordx4 v42,s[20:23],s65 offen offset:1024 sc1 lds
v_mfma_f32_16x16x32_bf16 v[72:75],a[224:227],v[240:243],v[72:75]
ds_read_b128 v[236:239],v43 offset:57344
s_xor_b32 m0,s72,20480
v_mfma_f32_16x16x32_bf16 v[64:67],a[100:103],v[244:247],v[64:67]
s_add_u32 s65,s89,256
v_min3_u32 v27,v27,v240,v244
v_mfma_f32_16x16x32_bf16 v[72:75],a[228:231],v[244:247],v[72:75]
ds_read_b128 v[240:243],v17 offset:50176
s_waitcnt lgkmcnt(6)
v_mfma_f32_16x16x32_bf16 v[64:67],a[104:107],v[248:251],v[64:67]
buffer_load_dwordx4 v42,s[20:23],s65 offen offset:0 sc1 lds
v_mfma_f32_16x16x32_bf16 v[72:75],a[232:235],v[248:251],v[72:75]
ds_read_b128 v[244:247],v43 offset:50176
v_min3_u32 v27,v27,v248,v252
v_mfma_f32_16x16x32_bf16 v[64:67],a[108:111],v[252:255],v[64:67]
buffer_load_dwordx4 v42,s[20:23],s65 offen offset:1024 sc1 lds
v_mfma_f32_16x16x32_bf16 v[72:75],a[236:239],v[252:255],v[72:75]
ds_read_b128 v[248:251],v17 offset:58368
s_waitcnt lgkmcnt(5)
v_mfma_f32_16x16x32_bf16 v[64:67],a[48:51],v[224:227],v[64:67]
s_xor_b32 m0,s72,36864
s_add_u32 s65,s89,512
v_mfma_f32_16x16x32_bf16 v[72:75],a[176:179],v[224:227],v[72:75]
ds_read_b128 v[252:255],v43 offset:58368
v_min3_u32 v27,v27,v224,v228
v_mfma_f32_16x16x32_bf16 v[64:67],a[52:55],v[228:231],v[64:67]
buffer_load_dwordx4 v42,s[20:23],s65 offen offset:0 sc1 lds
s_waitcnt vmcnt(13)
v_add_u32 v22,s71,-1
v_mfma_f32_16x16x32_bf16 v[72:75],a[180:183],v[228:231],v[72:75]
s_waitcnt vmcnt(18)
s_barrier
ds_read_b64 v[44:45],v47
ds_read_b128 v[224:227],v17 offset:4096
s_waitcnt lgkmcnt(6)
v_mfma_f32_16x16x32_bf16 v[64:67],a[56:59],v[232:235],v[64:67]
buffer_load_dwordx4 v42,s[20:23],s65 offen offset:1024 sc1 lds
buffer_store_dword v22,v23,s[24:27],s97 offen
v_mfma_f32_16x16x32_bf16 v[72:75],a[184:187],v[232:235],v[72:75]
ds_read_b128 v[228:231],v43 offset:4096
s_xor_b32 m0,s72,53248
buffer_store_dword v22,v23,s[28:31],s97 offen sc1
v_mfma_f32_16x16x32_bf16 v[64:67],a[60:63],v[236:239],v[64:67]
s_add_u32 s65,s89,768
v_min3_u32 v27,v27,v232,v236
s_mov_b32 s97,0x7fff0000
v_mfma_f32_16x16x32_bf16 v[72:75],a[188:191],v[236:239],v[72:75]
ds_read_b128 v[232:235],v17 offset:12288
s_waitcnt lgkmcnt(6)
v_mfma_f32_16x16x32_bf16 v[64:67],a[112:115],v[240:243],v[64:67]
buffer_load_dwordx4 v42,s[20:23],s65 offen offset:0 sc1 lds
v_mfma_f32_16x16x32_bf16 v[72:75],a[240:243],v[240:243],v[72:75]
ds_read_b128 v[236:239],v43 offset:12288
v_min3_u32 v27,v27,v240,v244
v_mfma_f32_16x16x32_bf16 v[64:67],a[116:119],v[244:247],v[64:67]
buffer_load_dwordx4 v42,s[20:23],s65 offen offset:1024 sc1 lds
v_mfma_f32_16x16x32_bf16 v[72:75],a[244:247],v[244:247],v[72:75]
ds_read_b128 v[240:243],v17 offset:5120
s_waitcnt lgkmcnt(6)
v_mfma_f32_16x16x32_bf16 v[64:67],a[120:123],v[248:251],v[64:67]
s_waitcnt lgkmcnt(5)
v_readfirstlane_b32 s93,v45
v_mfma_f32_16x16x32_bf16 v[72:75],a[248:251],v[248:251],v[72:75]
ds_read_b128 v[244:247],v43 offset:5120
v_min3_u32 v27,v27,v248,v252
v_mfma_f32_16x16x32_bf16 v[64:67],a[124:127],v[252:255],v[64:67]
v_mfma_f32_16x16x32_bf16 v[72:75],a[252:255],v[252:255],v[72:75]
ds_read_b128 v[248:251],v17 offset:13312
s_waitcnt lgkmcnt(5)
v_mfma_f32_16x16x32_bf16 v[68:71],a[0:3],v[224:227],0
v_cmp_eq_u32 vcc,0,v27
s_cbranch_vccnz retry_222
v_mfma_f32_16x16x32_bf16 v[76:79],a[128:131],v[224:227],0
ds_read_b128 v[252:255],v43 offset:13312
v_min3_u32 v27,v27,v224,v228
v_mfma_f32_16x16x32_bf16 v[68:71],a[4:7],v[228:231],v[68:71]
v_mfma_f32_16x16x32_bf16 v[76:79],a[132:135],v[228:231],v[76:79]
ds_read_b128 v[224:227],v17 offset:20480
s_waitcnt lgkmcnt(5)
v_mfma_f32_16x16x32_bf16 v[68:71],a[8:11],v[232:235],v[68:71]
v_min3_u32 v27,v27,v232,v236
v_mul_f32 v88,v64,v64
v_mul_f32 v92,v72,v72
v_mfma_f32_16x16x32_bf16 v[76:79],a[136:139],v[232:235],v[76:79]
ds_read_b128 v[228:231],v43 offset:20480
v_mul_f32 v89,v65,v65
v_mul_f32 v93,v73,v73
v_mfma_f32_16x16x32_bf16 v[68:71],a[12:15],v[236:239],v[68:71]
v_mul_f32 v90,v66,v66
v_mul_f32 v91,v67,v67
v_mul_f32 v94,v74,v74
v_mfma_f32_16x16x32_bf16 v[76:79],a[140:143],v[236:239],v[76:79]
ds_read_b128 v[232:235],v17 offset:28672
v_mul_f32 v95,v75,v75
s_waitcnt lgkmcnt(5)
v_mfma_f32_16x16x32_bf16 v[68:71],a[64:67],v[240:243],v[68:71]
v_min3_u32 v27,v27,v240,v244
v_fma_f32 v88,v88,s81,v28
v_fma_f32 v92,v92,s81,v28
v_mfma_f32_16x16x32_bf16 v[76:79],a[192:195],v[240:243],v[76:79]
ds_read_b128 v[236:239],v43 offset:28672
v_fma_f32 v89,v89,s81,v28
v_fma_f32 v93,v93,s81,v28
v_mfma_f32_16x16x32_bf16 v[68:71],a[68:71],v[244:247],v[68:71]
v_fma_f32 v90,v90,s81,v28
v_fma_f32 v91,v91,s81,v28
v_fma_f32 v94,v94,s81,v28
v_mfma_f32_16x16x32_bf16 v[76:79],a[196:199],v[244:247],v[76:79]
ds_read_b128 v[240:243],v17 offset:21504
v_fma_f32 v95,v95,s81,v28
s_waitcnt lgkmcnt(5)
v_mfma_f32_16x16x32_bf16 v[68:71],a[72:75],v[248:251],v[68:71]
v_min3_u32 v27,v27,v248,v252
v_mul_f32 v88,v88,v64
v_mul_f32 v92,v92,v72
v_mfma_f32_16x16x32_bf16 v[76:79],a[200:203],v[248:251],v[76:79]
ds_read_b128 v[244:247],v43 offset:21504
v_mul_f32 v89,v89,v65
v_mul_f32 v93,v93,v73
v_mfma_f32_16x16x32_bf16 v[68:71],a[76:79],v[252:255],v[68:71]
v_mul_f32 v90,v90,v66
v_mul_f32 v91,v91,v67
v_mul_f32 v94,v94,v74
v_mfma_f32_16x16x32_bf16 v[76:79],a[204:207],v[252:255],v[76:79]
ds_read_b128 v[248:251],v17 offset:29696
v_mul_f32 v95,v95,v75
s_waitcnt lgkmcnt(5)
v_mfma_f32_16x16x32_bf16 v[68:71],a[16:19],v[224:227],v[68:71]
v_min3_u32 v27,v27,v224,v228
v_exp_f32 v92,v92
v_mfma_f32_16x16x32_bf16 v[76:79],a[144:147],v[224:227],v[76:79]
ds_read_b128 v[252:255],v43 offset:29696
v_exp_f32 v93,v93
v_mfma_f32_16x16x32_bf16 v[68:71],a[20:23],v[228:231],v[68:71]
v_exp_f32 v88,v88
v_mfma_f32_16x16x32_bf16 v[76:79],a[148:151],v[228:231],v[76:79]
ds_read_b128 v[224:227],v17 offset:36864
s_waitcnt lgkmcnt(5)
v_mfma_f32_16x16x32_bf16 v[68:71],a[24:27],v[232:235],v[68:71]
v_min3_u32 v27,v27,v232,v236
v_exp_f32 v94,v94
v_mfma_f32_16x16x32_bf16 v[76:79],a[152:155],v[232:235],v[76:79]
ds_read_b128 v[228:231],v43 offset:36864
v_exp_f32 v95,v95
v_mfma_f32_16x16x32_bf16 v[68:71],a[28:31],v[236:239],v[68:71]
v_exp_f32 v89,v89
v_add_f32 v92,1.0,v92
v_mfma_f32_16x16x32_bf16 v[76:79],a[156:159],v[236:239],v[76:79]
ds_read_b128 v[232:235],v17 offset:45056
v_add_f32 v93,1.0,v93
s_waitcnt lgkmcnt(5)
v_mfma_f32_16x16x32_bf16 v[68:71],a[80:83],v[240:243],v[68:71]
v_min3_u32 v27,v27,v240,v244
v_add_f32 v94,1.0,v94
v_add_f32 v95,1.0,v95
v_mfma_f32_16x16x32_bf16 v[76:79],a[208:211],v[240:243],v[76:79]
ds_read_b128 v[236:239],v43 offset:45056
v_rcp_f32 v92,v92
v_mfma_f32_16x16x32_bf16 v[68:71],a[84:87],v[244:247],v[68:71]
v_exp_f32 v90,v90
v_mfma_f32_16x16x32_bf16 v[76:79],a[212:215],v[244:247],v[76:79]
ds_read_b128 v[240:243],v17 offset:37888
s_waitcnt lgkmcnt(5)
v_mfma_f32_16x16x32_bf16 v[68:71],a[88:91],v[248:251],v[68:71]
v_min3_u32 v27,v27,v248,v252
v_rcp_f32 v93,v93
v_mfma_f32_16x16x32_bf16 v[76:79],a[216:219],v[248:251],v[76:79]
ds_read_b128 v[244:247],v43 offset:37888
v_rcp_f32 v94,v94
v_mfma_f32_16x16x32_bf16 v[68:71],a[92:95],v[252:255],v[68:71]
v_exp_f32 v91,v91
v_mfma_f32_16x16x32_bf16 v[76:79],a[220:223],v[252:255],v[76:79]
ds_read_b128 v[248:251],v17 offset:46080
s_waitcnt lgkmcnt(5)
v_mfma_f32_16x16x32_bf16 v[68:71],a[32:35],v[224:227],v[68:71]
v_min3_u32 v27,v27,v224,v228
v_add_f32 v88,1.0,v88
v_mfma_f32_16x16x32_bf16 v[76:79],a[160:163],v[224:227],v[76:79]
ds_read_b128 v[252:255],v43 offset:46080
v_add_f32 v89,1.0,v89
v_mfma_f32_16x16x32_bf16 v[68:71],a[36:39],v[228:231],v[68:71]
v_add_f32 v90,1.0,v90
v_add_f32 v91,1.0,v91
v_mfma_f32_16x16x32_bf16 v[76:79],a[164:167],v[228:231],v[76:79]
ds_read_b128 v[224:227],v17 offset:53248
s_waitcnt lgkmcnt(5)
v_mfma_f32_16x16x32_bf16 v[68:71],a[40:43],v[232:235],v[68:71]
v_min3_u32 v27,v27,v232,v236
v_mfma_f32_16x16x32_bf16 v[76:79],a[168:171],v[232:235],v[76:79]
ds_read_b128 v[228:231],v43 offset:53248
v_mfma_f32_16x16x32_bf16 v[68:71],a[44:47],v[236:239],v[68:71]
v_rcp_f32 v88,v88
v_mfma_f32_16x16x32_bf16 v[76:79],a[172:175],v[236:239],v[76:79]
ds_read_b128 v[232:235],v17 offset:61440
s_waitcnt lgkmcnt(5)
v_mfma_f32_16x16x32_bf16 v[68:71],a[96:99],v[240:243],v[68:71]
v_min3_u32 v27,v27,v240,v244
v_mfma_f32_16x16x32_bf16 v[76:79],a[224:227],v[240:243],v[76:79]
ds_read_b128 v[236:239],v43 offset:61440
v_mfma_f32_16x16x32_bf16 v[68:71],a[100:103],v[244:247],v[68:71]
v_rcp_f32 v89,v89
v_mfma_f32_16x16x32_bf16 v[76:79],a[228:231],v[244:247],v[76:79]
ds_read_b128 v[240:243],v17 offset:54272
s_waitcnt lgkmcnt(5)
v_mfma_f32_16x16x32_bf16 v[68:71],a[104:107],v[248:251],v[68:71]
v_min3_u32 v27,v27,v248,v252
v_mfma_f32_16x16x32_bf16 v[76:79],a[232:235],v[248:251],v[76:79]
ds_read_b128 v[244:247],v43 offset:54272
v_mfma_f32_16x16x32_bf16 v[68:71],a[108:111],v[252:255],v[68:71]
v_rcp_f32 v90,v90
v_mfma_f32_16x16x32_bf16 v[76:79],a[236:239],v[252:255],v[76:79]
ds_read_b128 v[248:251],v17 offset:62464
s_waitcnt lgkmcnt(5)
v_mfma_f32_16x16x32_bf16 v[68:71],a[48:51],v[224:227],v[68:71]
v_min3_u32 v27,v27,v224,v228
v_mfma_f32_16x16x32_bf16 v[76:79],a[176:179],v[224:227],v[76:79]
ds_read_b128 v[252:255],v43 offset:62464
v_mfma_f32_16x16x32_bf16 v[68:71],a[52:55],v[228:231],v[68:71]
v_rcp_f32 v91,v91
v_mfma_f32_16x16x32_bf16 v[76:79],a[180:183],v[228:231],v[76:79]
v_mul_f32 v88,v88,v64
s_waitcnt lgkmcnt(4)
v_mfma_f32_16x16x32_bf16 v[68:71],a[56:59],v[232:235],v[68:71]
v_min3_u32 v27,v27,v232,v236
v_mul_f32 v89,v89,v65
v_mfma_f32_16x16x32_bf16 v[76:79],a[184:187],v[232:235],v[76:79]
v_mul_f32 v90,v90,v66
v_mul_f32 v91,v91,v67
v_mfma_f32_16x16x32_bf16 v[68:71],a[60:63],v[236:239],v[68:71]
v_rcp_f32 v95,v95
v_mfma_f32_16x16x32_bf16 v[76:79],a[188:191],v[236:239],v[76:79]
v_mul_f32 v92,v92,v72
s_waitcnt lgkmcnt(2)
v_mfma_f32_16x16x32_bf16 v[68:71],a[112:115],v[240:243],v[68:71]
v_min3_u32 v27,v27,v240,v244
v_mul_f32 v93,v93,v73
v_mfma_f32_16x16x32_bf16 v[76:79],a[240:243],v[240:243],v[76:79]
v_mul_f32 v94,v94,v74
v_mul_f32 v95,v95,v75
v_mfma_f32_16x16x32_bf16 v[68:71],a[116:119],v[244:247],v[68:71]
v_cvt_pk_bf16_f32 v96,v88,v89
v_cvt_pk_bf16_f32 v97,v90,v91
v_mfma_f32_16x16x32_bf16 v[76:79],a[244:247],v[244:247],v[76:79]
v_cvt_pk_bf16_f32 v98,v92,v93
s_waitcnt lgkmcnt(0)
v_mfma_f32_16x16x32_bf16 v[68:71],a[120:123],v[248:251],v[68:71]
v_min3_u32 v27,v27,v248,v252
v_cvt_pk_bf16_f32 v99,v94,v95
v_mfma_f32_16x16x32_bf16 v[76:79],a[248:251],v[248:251],v[76:79]
v_max_u32 v96,1,v96
v_mfma_f32_16x16x32_bf16 v[68:71],a[124:127],v[252:255],v[68:71]
buffer_store_dwordx4 v[96:99],v18,s[20:23],s78 offen sc1
v_mfma_f32_16x16x32_bf16 v[76:79],a[252:255],v[252:255],v[76:79]
v_cmp_eq_u32 vcc,0,v27
s_cbranch_vccnz retry_222
epi_225:
buffer_load_dword v29,v21,s[20:23],s87 offen sc1
s_cmp_gt_u32 s71,51
s_cselect_b32 s65,s73,0x7fff0000
s_cselect_b32 s97,0x7fff0000,s73
v_mov_b32 v22,s71
buffer_store_dword v22,v23,s[24:27],s65 offen
buffer_store_dword v22,v23,s[28:31],s65 offen sc1
v_pk_mul_f32 v[88:89],v[68:69],v[68:69]
v_pk_mul_f32 v[90:91],v[70:71],v[70:71]
v_pk_mul_f32 v[92:93],v[76:77],v[76:77]
v_pk_mul_f32 v[94:95],v[78:79],v[78:79]
v_pk_fma_f32 v[88:89],v[88:89],s[80:81],v[28:29] op_sel:[0,1,0] op_sel_hi:[1,1,0]
v_pk_fma_f32 v[90:91],v[90:91],s[80:81],v[28:29] op_sel:[0,1,0] op_sel_hi:[1,1,0]
v_pk_fma_f32 v[92:93],v[92:93],s[80:81],v[28:29] op_sel:[0,1,0] op_sel_hi:[1,1,0]
v_pk_fma_f32 v[94:95],v[94:95],s[80:81],v[28:29] op_sel:[0,1,0] op_sel_hi:[1,1,0]
v_pk_mul_f32 v[88:89],v[88:89],v[68:69]
v_pk_mul_f32 v[90:91],v[90:91],v[70:71]
v_pk_mul_f32 v[92:93],v[92:93],v[76:77]
v_pk_mul_f32 v[94:95],v[94:95],v[78:79]
v_exp_f32 v88,v88
v_exp_f32 v89,v89
v_exp_f32 v90,v90
v_exp_f32 v91,v91
v_exp_f32 v92,v92
v_exp_f32 v93,v93
v_exp_f32 v94,v94
v_exp_f32 v95,v95
v_pk_add_f32 v[88:89],v[88:89],1.0 op_sel_hi:[1,0]
v_pk_add_f32 v[90:91],v[90:91],1.0 op_sel_hi:[1,0]
v_pk_add_f32 v[92:93],v[92:93],1.0 op_sel_hi:[1,0]
v_pk_add_f32 v[94:95],v[94:95],1.0 op_sel_hi:[1,0]
v_rcp_f32 v88,v88
v_rcp_f32 v89,v89
v_rcp_f32 v90,v90
v_rcp_f32 v91,v91
v_rcp_f32 v92,v92
v_rcp_f32 v93,v93
v_rcp_f32 v94,v94
v_rcp_f32 v95,v95
v_pk_mul_f32 v[88:89],v[88:89],v[68:69]
v_pk_mul_f32 v[90:91],v[90:91],v[70:71]
v_pk_mul_f32 v[92:93],v[92:93],v[76:77]
v_pk_mul_f32 v[94:95],v[94:95],v[78:79]
v_cvt_pk_bf16_f32 v96,v88,v89
v_cvt_pk_bf16_f32 v97,v90,v91
v_cvt_pk_bf16_f32 v98,v92,v93
v_cvt_pk_bf16_f32 v99,v94,v95
v_max_u32 v96,1,v96
buffer_store_dwordx4 v[96:99],v19,s[20:23],s78 offen sc1
v_xor_b32 v18,0x2000,v18
v_xor_b32 v19,0x2000,v19
s_add_u32 s78,s78,2097152
next_232:
v_xor_b32 v43,0x10000,v43
v_xor_b32 v17,0x10000,v17
s_xor_b32 s72,s72,0x10000
s_add_u32 s70,s70,2097152
s_xor_b32 s70,s70,0x2000
s_add_u32 s71,s71,1
s_cmp_le_u32 s71,64
s_cbranch_scc1 seg_223
s_add_u32 s65,s73,2560
v_add_u32 v22,s71,-1
buffer_store_dword v22,v23,s[20:23],s65 offen sc1
s_endpgm
retry_222:
s_sub_u32 s90,s90,64
s_cmp_lt_i32 s90,0
s_cbranch_scc1 giveup_197
s_mov_b32 s83,1
s_waitcnt vmcnt(0) lgkmcnt(0)
s_barrier
s_branch seg_223
r_w2_217:
s_load_dwordx2 s[4:5],s[0:1],72
s_and_b32 s41,s59,7
s_lshl_b32 s66,s41,8
s_lshl_b32 s67,s50,1
s_waitcnt lgkmcnt(0)
s_mov_b32 s32,s4
s_and_b32 s33,s5,0xffff
s_mov_b32 s34,0x200000
s_mov_b32 s35,0x20000
v_lshrrev_b32 v5,2,v3
v_lshl_add_u32 v5,v4,2,v5
v_and_b32 v6,3,v3
v_lshlrev_b32 v6,3,v6
v_lshl_add_u32 v6,v5,8,v6
v_and_b32 v5,7,v5
v_xor_b32 v5,s67,v5
v_lshl_add_u32 v12,v5,5,v6
v_xor_b32 v13,32,v12
v_and_b32 v5,15,v1
v_and_b32 v6,3,v4
v_lshlrev_b32 v6,1,v6
v_xor_b32 v5,v5,v6
v_mul_u32_u24 v6,2048,v4
v_xor_b32 v7,0,v5
v_lshl_add_u32 v8,v7,4,v6
v_xor_b32 v7,8,v5
v_lshl_add_u32 v9,v7,4,v6
s_mul_i32 s74,s50,131072
s_add_u32 s74,s74,s66
s_lshl_b32 s75,s50,14
s_mul_i32 s76,s50,65536
s_add_u32 s76,s76,s66
s_lshl_b32 s77,s50,13
s_add_u32 s64,s74,0
s_add_u32 m0,s75,0
s_nop 0
buffer_load_dwordx4 v8,s[32:35],s64 offen nt lds
s_add_u32 s64,s74,8192
s_add_u32 m0,s75,1024
s_nop 0
buffer_load_dwordx4 v9,s[32:35],s64 offen nt lds
s_add_u32 s64,s74,16384
s_add_u32 m0,s75,2048
s_nop 0
buffer_load_dwordx4 v8,s[32:35],s64 offen nt lds
s_add_u32 s64,s74,24576
s_add_u32 m0,s75,3072
s_nop 0
buffer_load_dwordx4 v9,s[32:35],s64 offen nt lds
s_add_u32 s64,s74,32768
s_add_u32 m0,s75,4096
s_nop 0
buffer_load_dwordx4 v8,s[32:35],s64 offen nt lds
s_add_u32 s64,s74,40960
s_add_u32 m0,s75,5120
s_nop 0
buffer_load_dwordx4 v9,s[32:35],s64 offen nt lds
s_add_u32 s64,s74,49152
s_add_u32 m0,s75,6144
s_nop 0
buffer_load_dwordx4 v8,s[32:35],s64 offen nt lds
s_add_u32 s64,s74,57344
s_add_u32 m0,s75,7168
s_nop 0
buffer_load_dwordx4 v9,s[32:35],s64 offen nt lds
s_add_u32 s64,s74,65536
s_add_u32 m0,s75,8192
s_nop 0
buffer_load_dwordx4 v8,s[32:35],s64 offen nt lds
s_add_u32 s64,s74,73728
s_add_u32 m0,s75,9216
s_nop 0
buffer_load_dwordx4 v9,s[32:35],s64 offen nt lds
s_add_u32 s64,s74,81920
s_add_u32 m0,s75,10240
s_nop 0
buffer_load_dwordx4 v8,s[32:35],s64 offen nt lds
s_add_u32 s64,s74,90112
s_add_u32 m0,s75,11264
s_nop 0
buffer_load_dwordx4 v9,s[32:35],s64 offen nt lds
s_add_u32 s64,s74,98304
s_add_u32 m0,s75,12288
s_nop 0
buffer_load_dwordx4 v8,s[32:35],s64 offen nt lds
s_add_u32 s64,s74,106496
s_add_u32 m0,s75,13312
s_nop 0
buffer_load_dwordx4 v9,s[32:35],s64 offen nt lds
s_add_u32 s64,s74,114688
s_add_u32 m0,s75,14336
s_nop 0
buffer_load_dwordx4 v8,s[32:35],s64 offen nt lds
s_add_u32 s64,s74,122880
s_add_u32 m0,s75,15360
s_nop 0
buffer_load_dwordx4 v9,s[32:35],s64 offen nt lds
s_add_u32 s64,s74,524288
s_add_u32 m0,s75,65536
s_nop 0
buffer_load_dwordx4 v8,s[32:35],s64 offen nt lds
s_add_u32 s64,s74,532480
s_add_u32 m0,s75,66560
s_nop 0
buffer_load_dwordx4 v9,s[32:35],s64 offen nt lds
s_add_u32 s64,s74,540672
s_add_u32 m0,s75,67584
s_nop 0
buffer_load_dwordx4 v8,s[32:35],s64 offen nt lds
s_add_u32 s64,s74,548864
s_add_u32 m0,s75,68608
s_nop 0
buffer_load_dwordx4 v9,s[32:35],s64 offen nt lds
s_add_u32 s64,s74,557056
s_add_u32 m0,s75,69632
s_nop 0
buffer_load_dwordx4 v8,s[32:35],s64 offen nt lds
s_add_u32 s64,s74,565248
s_add_u32 m0,s75,70656
s_nop 0
buffer_load_dwordx4 v9,s[32:35],s64 offen nt lds
s_add_u32 s64,s74,573440
s_add_u32 m0,s75,71680
s_nop 0
buffer_load_dwordx4 v8,s[32:35],s64 offen nt lds
s_add_u32 s64,s74,581632
s_add_u32 m0,s75,72704
s_nop 0
buffer_load_dwordx4 v9,s[32:35],s64 offen nt lds
s_add_u32 s64,s74,589824
s_add_u32 m0,s75,73728
s_nop 0
buffer_load_dwordx4 v8,s[32:35],s64 offen nt lds
s_add_u32 s64,s74,598016
s_add_u32 m0,s75,74752
s_nop 0
buffer_load_dwordx4 v9,s[32:35],s64 offen nt lds
s_add_u32 s64,s74,606208
s_add_u32 m0,s75,75776
s_nop 0
buffer_load_dwordx4 v8,s[32:35],s64 offen nt lds
s_add_u32 s64,s74,614400
s_add_u32 m0,s75,76800
s_nop 0
buffer_load_dwordx4 v9,s[32:35],s64 offen nt lds
s_add_u32 s64,s74,622592
s_add_u32 m0,s75,77824
s_nop 0
buffer_load_dwordx4 v8,s[32:35],s64 offen nt lds
s_add_u32 s64,s74,630784
s_add_u32 m0,s75,78848
s_nop 0
buffer_load_dwordx4 v9,s[32:35],s64 offen nt lds
s_add_u32 s64,s74,638976
s_add_u32 m0,s75,79872
s_nop 0
buffer_load_dwordx4 v8,s[32:35],s64 offen nt lds
s_add_u32 s64,s74,647168
s_add_u32 m0,s75,80896
s_nop 0
buffer_load_dwordx4 v9,s[32:35],s64 offen nt lds
s_waitcnt vmcnt(16)
s_barrier
ds_read_b64_tr_b16 a[0:1],v12 offset:0
ds_read_b64_tr_b16 a[128:129],v13 offset:0
ds_read_b64_tr_b16 a[2:3],v12 offset:4096
ds_read_b64_tr_b16 a[130:131],v13 offset:4096
ds_read_b64_tr_b16 a[4:5],v12 offset:8192
ds_read_b64_tr_b16 a[132:133],v13 offset:8192
ds_read_b64_tr_b16 a[6:7],v12 offset:12288
ds_read_b64_tr_b16 a[134:135],v13 offset:12288
s_waitcnt lgkmcnt(4)
ds_read_b64_tr_b16 a[8:9],v12 offset:16384
ds_read_b64_tr_b16 a[136:137],v13 offset:16384
ds_read_b64_tr_b16 a[10:11],v12 offset:20480
ds_read_b64_tr_b16 a[138:139],v13 offset:20480
ds_read_b64_tr_b16 a[12:13],v12 offset:24576
ds_read_b64_tr_b16 a[140:141],v13 offset:24576
ds_read_b64_tr_b16 a[14:15],v12 offset:28672
ds_read_b64_tr_b16 a[142:143],v13 offset:28672
s_waitcnt lgkmcnt(4)
ds_read_b64_tr_b16 a[16:17],v12 offset:32768
ds_read_b64_tr_b16 a[144:145],v13 offset:32768
ds_read_b64_tr_b16 a[18:19],v12 offset:36864
ds_read_b64_tr_b16 a[146:147],v13 offset:36864
ds_read_b64_tr_b16 a[20:21],v12 offset:40960
ds_read_b64_tr_b16 a[148:149],v13 offset:40960
ds_read_b64_tr_b16 a[22:23],v12 offset:45056
ds_read_b64_tr_b16 a[150:151],v13 offset:45056
s_waitcnt lgkmcnt(4)
ds_read_b64_tr_b16 a[24:25],v12 offset:49152
ds_read_b64_tr_b16 a[152:153],v13 offset:49152
ds_read_b64_tr_b16 a[26:27],v12 offset:53248
ds_read_b64_tr_b16 a[154:155],v13 offset:53248
ds_read_b64_tr_b16 a[28:29],v12 offset:57344
ds_read_b64_tr_b16 a[156:157],v13 offset:57344
ds_read_b64_tr_b16 a[30:31],v12 offset:61440
ds_read_b64_tr_b16 a[158:159],v13 offset:61440
s_waitcnt lgkmcnt(4)
v_xor_b32 v12,0x10000,v12
v_xor_b32 v13,0x10000,v13
s_waitcnt lgkmcnt(0)
s_barrier
s_add_u32 s64,s74,1048576
s_add_u32 m0,s75,0
s_nop 0
buffer_load_dwordx4 v8,s[32:35],s64 offen nt lds
s_add_u32 s64,s74,1056768
s_add_u32 m0,s75,1024
s_nop 0
buffer_load_dwordx4 v9,s[32:35],s64 offen nt lds
s_add_u32 s64,s74,1064960
s_add_u32 m0,s75,2048
s_nop 0
buffer_load_dwordx4 v8,s[32:35],s64 offen nt lds
s_add_u32 s64,s74,1073152
s_add_u32 m0,s75,3072
s_nop 0
buffer_load_dwordx4 v9,s[32:35],s64 offen nt lds
s_add_u32 s64,s74,1081344
s_add_u32 m0,s75,4096
s_nop 0
buffer_load_dwordx4 v8,s[32:35],s64 offen nt lds
s_add_u32 s64,s74,1089536
s_add_u32 m0,s75,5120
s_nop 0
buffer_load_dwordx4 v9,s[32:35],s64 offen nt lds
s_add_u32 s64,s74,1097728
s_add_u32 m0,s75,6144
s_nop 0
buffer_load_dwordx4 v8,s[32:35],s64 offen nt lds
s_add_u32 s64,s74,1105920
s_add_u32 m0,s75,7168
s_nop 0
buffer_load_dwordx4 v9,s[32:35],s64 offen nt lds
s_add_u32 s64,s74,1114112
s_add_u32 m0,s75,8192
s_nop 0
buffer_load_dwordx4 v8,s[32:35],s64 offen nt lds
s_add_u32 s64,s74,1122304
s_add_u32 m0,s75,9216
s_nop 0
buffer_load_dwordx4 v9,s[32:35],s64 offen nt lds
s_add_u32 s64,s74,1130496
s_add_u32 m0,s75,10240
s_nop 0
buffer_load_dwordx4 v8,s[32:35],s64 offen nt lds
s_add_u32 s64,s74,1138688
s_add_u32 m0,s75,11264
s_nop 0
buffer_load_dwordx4 v9,s[32:35],s64 offen nt lds
s_add_u32 s64,s74,1146880
s_add_u32 m0,s75,12288
s_nop 0
buffer_load_dwordx4 v8,s[32:35],s64 offen nt lds
s_add_u32 s64,s74,1155072
s_add_u32 m0,s75,13312
s_nop 0
buffer_load_dwordx4 v9,s[32:35],s64 offen nt lds
s_add_u32 s64,s74,1163264
s_add_u32 m0,s75,14336
s_nop 0
buffer_load_dwordx4 v8,s[32:35],s64 offen nt lds
s_add_u32 s64,s74,1171456
s_add_u32 m0,s75,15360
s_nop 0
buffer_load_dwordx4 v9,s[32:35],s64 offen nt lds
s_waitcnt vmcnt(16)
s_barrier
ds_read_b64_tr_b16 a[32:33],v12 offset:0
ds_read_b64_tr_b16 a[160:161],v13 offset:0
ds_read_b64_tr_b16 a[34:35],v12 offset:4096
ds_read_b64_tr_b16 a[162:163],v13 offset:4096
ds_read_b64_tr_b16 a[36:37],v12 offset:8192
ds_read_b64_tr_b16 a[164:165],v13 offset:8192
ds_read_b64_tr_b16 a[38:39],v12 offset:12288
ds_read_b64_tr_b16 a[166:167],v13 offset:12288
s_waitcnt lgkmcnt(4)
ds_read_b64_tr_b16 a[40:41],v12 offset:16384
ds_read_b64_tr_b16 a[168:169],v13 offset:16384
ds_read_b64_tr_b16 a[42:43],v12 offset:20480
ds_read_b64_tr_b16 a[170:171],v13 offset:20480
ds_read_b64_tr_b16 a[44:45],v12 offset:24576
ds_read_b64_tr_b16 a[172:173],v13 offset:24576
ds_read_b64_tr_b16 a[46:47],v12 offset:28672
ds_read_b64_tr_b16 a[174:175],v13 offset:28672
s_waitcnt lgkmcnt(4)
ds_read_b64_tr_b16 a[48:49],v12 offset:32768
ds_read_b64_tr_b16 a[176:177],v13 offset:32768
ds_read_b64_tr_b16 a[50:51],v12 offset:36864
ds_read_b64_tr_b16 a[178:179],v13 offset:36864
ds_read_b64_tr_b16 a[52:53],v12 offset:40960
ds_read_b64_tr_b16 a[180:181],v13 offset:40960
ds_read_b64_tr_b16 a[54:55],v12 offset:45056
ds_read_b64_tr_b16 a[182:183],v13 offset:45056
s_waitcnt lgkmcnt(4)
ds_read_b64_tr_b16 a[56:57],v12 offset:49152
ds_read_b64_tr_b16 a[184:185],v13 offset:49152
ds_read_b64_tr_b16 a[58:59],v12 offset:53248
ds_read_b64_tr_b16 a[186:187],v13 offset:53248
ds_read_b64_tr_b16 a[60:61],v12 offset:57344
ds_read_b64_tr_b16 a[188:189],v13 offset:57344
ds_read_b64_tr_b16 a[62:63],v12 offset:61440
ds_read_b64_tr_b16 a[190:191],v13 offset:61440
s_waitcnt lgkmcnt(4)
v_xor_b32 v12,0x10000,v12
v_xor_b32 v13,0x10000,v13
s_waitcnt lgkmcnt(0)
s_barrier
s_add_u32 s64,s74,1572864
s_add_u32 m0,s75,65536
s_nop 0
buffer_load_dwordx4 v8,s[32:35],s64 offen nt lds
s_add_u32 s64,s74,1581056
s_add_u32 m0,s75,66560
s_nop 0
buffer_load_dwordx4 v9,s[32:35],s64 offen nt lds
s_add_u32 s64,s74,1589248
s_add_u32 m0,s75,67584
s_nop 0
buffer_load_dwordx4 v8,s[32:35],s64 offen nt lds
s_add_u32 s64,s74,1597440
s_add_u32 m0,s75,68608
s_nop 0
buffer_load_dwordx4 v9,s[32:35],s64 offen nt lds
s_add_u32 s64,s74,1605632
s_add_u32 m0,s75,69632
s_nop 0
buffer_load_dwordx4 v8,s[32:35],s64 offen nt lds
s_add_u32 s64,s74,1613824
s_add_u32 m0,s75,70656
s_nop 0
buffer_load_dwordx4 v9,s[32:35],s64 offen nt lds
s_add_u32 s64,s74,1622016
s_add_u32 m0,s75,71680
s_nop 0
buffer_load_dwordx4 v8,s[32:35],s64 offen nt lds
s_add_u32 s64,s74,1630208
s_add_u32 m0,s75,72704
s_nop 0
buffer_load_dwordx4 v9,s[32:35],s64 offen nt lds
s_add_u32 s64,s74,1638400
s_add_u32 m0,s75,73728
s_nop 0
buffer_load_dwordx4 v8,s[32:35],s64 offen nt lds
s_add_u32 s64,s74,1646592
s_add_u32 m0,s75,74752
s_nop 0
buffer_load_dwordx4 v9,s[32:35],s64 offen nt lds
s_add_u32 s64,s74,1654784
s_add_u32 m0,s75,75776
s_nop 0
buffer_load_dwordx4 v8,s[32:35],s64 offen nt lds
s_add_u32 s64,s74,1662976
s_add_u32 m0,s75,76800
s_nop 0
buffer_load_dwordx4 v9,s[32:35],s64 offen nt lds
s_add_u32 s64,s74,1671168
s_add_u32 m0,s75,77824
s_nop 0
buffer_load_dwordx4 v8,s[32:35],s64 offen nt lds
s_add_u32 s64,s74,1679360
s_add_u32 m0,s75,78848
s_nop 0
buffer_load_dwordx4 v9,s[32:35],s64 offen nt lds
s_add_u32 s64,s74,1687552
s_add_u32 m0,s75,79872
s_nop 0
buffer_load_dwordx4 v8,s[32:35],s64 offen nt lds
s_add_u32 s64,s74,1695744
s_add_u32 m0,s75,80896
s_nop 0
buffer_load_dwordx4 v9,s[32:35],s64 offen nt lds
s_waitcnt vmcnt(16)
s_barrier
ds_read_b64_tr_b16 a[64:65],v12 offset:0
ds_read_b64_tr_b16 a[192:193],v13 offset:0
ds_read_b64_tr_b16 a[66:67],v12 offset:4096
ds_read_b64_tr_b16 a[194:195],v13 offset:4096
ds_read_b64_tr_b16 a[68:69],v12 offset:8192
ds_read_b64_tr_b16 a[196:197],v13 offset:8192
ds_read_b64_tr_b16 a[70:71],v12 offset:12288
ds_read_b64_tr_b16 a[198:199],v13 offset:12288
s_waitcnt lgkmcnt(4)
ds_read_b64_tr_b16 a[72:73],v12 offset:16384
ds_read_b64_tr_b16 a[200:201],v13 offset:16384
ds_read_b64_tr_b16 a[74:75],v12 offset:20480
ds_read_b64_tr_b16 a[202:203],v13 offset:20480
ds_read_b64_tr_b16 a[76:77],v12 offset:24576
ds_read_b64_tr_b16 a[204:205],v13 offset:24576
ds_read_b64_tr_b16 a[78:79],v12 offset:28672
ds_read_b64_tr_b16 a[206:207],v13 offset:28672
s_waitcnt lgkmcnt(4)
ds_read_b64_tr_b16 a[80:81],v12 offset:32768
ds_read_b64_tr_b16 a[208:209],v13 offset:32768
ds_read_b64_tr_b16 a[82:83],v12 offset:36864
ds_read_b64_tr_b16 a[210:211],v13 offset:36864
ds_read_b64_tr_b16 a[84:85],v12 offset:40960
ds_read_b64_tr_b16 a[212:213],v13 offset:40960
ds_read_b64_tr_b16 a[86:87],v12 offset:45056
ds_read_b64_tr_b16 a[214:215],v13 offset:45056
s_waitcnt lgkmcnt(4)
ds_read_b64_tr_b16 a[88:89],v12 offset:49152
ds_read_b64_tr_b16 a[216:217],v13 offset:49152
ds_read_b64_tr_b16 a[90:91],v12 offset:53248
ds_read_b64_tr_b16 a[218:219],v13 offset:53248
ds_read_b64_tr_b16 a[92:93],v12 offset:57344
ds_read_b64_tr_b16 a[220:221],v13 offset:57344
ds_read_b64_tr_b16 a[94:95],v12 offset:61440
ds_read_b64_tr_b16 a[222:223],v13 offset:61440
s_waitcnt lgkmcnt(4)
v_xor_b32 v12,0x10000,v12
v_xor_b32 v13,0x10000,v13
s_waitcnt lgkmcnt(0)
s_barrier
s_waitcnt vmcnt(0)
s_barrier
ds_read_b64_tr_b16 a[96:97],v12 offset:0
ds_read_b64_tr_b16 a[224:225],v13 offset:0
ds_read_b64_tr_b16 a[98:99],v12 offset:4096
ds_read_b64_tr_b16 a[226:227],v13 offset:4096
ds_read_b64_tr_b16 a[100:101],v12 offset:8192
ds_read_b64_tr_b16 a[228:229],v13 offset:8192
ds_read_b64_tr_b16 a[102:103],v12 offset:12288
ds_read_b64_tr_b16 a[230:231],v13 offset:12288
s_waitcnt lgkmcnt(4)
ds_read_b64_tr_b16 a[104:105],v12 offset:16384
ds_read_b64_tr_b16 a[232:233],v13 offset:16384
ds_read_b64_tr_b16 a[106:107],v12 offset:20480
ds_read_b64_tr_b16 a[234:235],v13 offset:20480
ds_read_b64_tr_b16 a[108:109],v12 offset:24576
ds_read_b64_tr_b16 a[236:237],v13 offset:24576
ds_read_b64_tr_b16 a[110:111],v12 offset:28672
ds_read_b64_tr_b16 a[238:239],v13 offset:28672
s_waitcnt lgkmcnt(4)
ds_read_b64_tr_b16 a[112:113],v12 offset:32768
ds_read_b64_tr_b16 a[240:241],v13 offset:32768
ds_read_b64_tr_b16 a[114:115],v12 offset:36864
ds_read_b64_tr_b16 a[242:243],v13 offset:36864
ds_read_b64_tr_b16 a[116:117],v12 offset:40960
ds_read_b64_tr_b16 a[244:245],v13 offset:40960
ds_read_b64_tr_b16 a[118:119],v12 offset:45056
ds_read_b64_tr_b16 a[246:247],v13 offset:45056
s_waitcnt lgkmcnt(4)
ds_read_b64_tr_b16 a[120:121],v12 offset:49152
ds_read_b64_tr_b16 a[248:249],v13 offset:49152
ds_read_b64_tr_b16 a[122:123],v12 offset:53248
ds_read_b64_tr_b16 a[250:251],v13 offset:53248
ds_read_b64_tr_b16 a[124:125],v12 offset:57344
ds_read_b64_tr_b16 a[252:253],v13 offset:57344
ds_read_b64_tr_b16 a[126:127],v12 offset:61440
ds_read_b64_tr_b16 a[254:255],v13 offset:61440
s_waitcnt lgkmcnt(4)
v_xor_b32 v12,0x10000,v12
v_xor_b32 v13,0x10000,v13
s_waitcnt lgkmcnt(0)
s_barrier
v_and_b32 v21,1,v1
v_mul_u32_u24 v21,960,v21
s_mov_b32 s65,21052032
s_mov_b32 s66,1792
pl_237:
buffer_load_dword v22,v21,s[20:23],s65 offen sc1
s_waitcnt vmcnt(0)
v_cmp_gt_u32 vcc,s66,v22
s_cbranch_vccz pok_238
s_sleep 1
s_sub_u32 s90,s90,1
s_cmp_gt_i32 s90,0
s_cbranch_scc1 pl_237
pok_238:
s_mov_b32 s81,0xbdd2d3e8
v_mov_b32 v28,0xc0135761
v_mov_b32 v17,v16
v_and_b32 v21,31,v1
v_lshlrev_b32 v21,2,v21
s_mul_i32 s74,s79,40
s_add_u32 s74,s74,s63
s_add_u32 s74,s74,3072
s_lshl_b32 s42,s41,2
s_add_u32 s42,s42,s50
s_lshl_b32 s73,s41,7
s_lshl_b32 s64,s50,2
s_add_u32 s73,s73,s64
s_add_u32 s73,s73,s63
s_add_u32 s73,s73,6144
s_add_u32 s73,s73,s60
s_lshl_b32 s43,s50,11
s_lshl_b32 s78,s79,21
s_add_u32 s78,s78,27262976
s_mov_b32 s64,0
s_lshr_b32 s65,s50,1
s_and_b32 s66,s50,1
s_lshl_b32 s66,s66,12
s_add_u32 s66,s66,s64
s_lshl_b32 s72,s65,13
s_add_u32 s72,s72,s66
s_add_u32 s72,s72,0x10000
s_lshl_b32 s65,s65,14
s_add_u32 s75,s65,s66
s_add_u32 s75,s75,1966080
s_add_u32 s64,s41,72
s_lshl_b32 s64,s64,14
s_add_u32 s64,s64,s43
v_add_u32 v18,s64,v16
s_lshl_b32 s64,s42,8
s_add_u32 s64,s64,1310720
v_lshl_add_u32 v24,v3,4,s64
v_mov_b32 v5,0x40000000
v_cmp_gt_u32 vcc,16,v1
s_nop 1
v_cndmask_b32 v24,v5,v24,vcc
s_lshl_b32 s64,s42,6
v_and_b32 v5,3,v1
v_xor_b32 v5,v5,v4
v_lshl_add_u32 v5,v5,4,s64
v_lshrrev_b32 v11,2,v1
s_add_u32 s43,s43,133120
v_lshrrev_b32 v6,2,v3
v_lshrrev_b32 v7,1,v4
v_xor_b32 v6,v6,v7
v_lshlrev_b32 v6,4,v6
v_lshl_add_u32 v6,v3,6,v6
v_and_b32 v7,1,v4
v_lshl_add_u32 v6,v7,3,v6
v_add_u32 v40,s43,v6
v_xor_b32 v41,32,v40
v_add_u32 v6,30,v11
v_lshl_add_u32 v9,v6,7,v5
v_and_b32 v9,2047,v9
v_and_b32 v7,3,v6
v_lshl_add_u32 v7,v7,11,v9
v_bfe_u32 v8,v6,2,3
v_lshl_add_u32 v7,v8,14,v7
v_mov_b32 v8,0x2000
v_mov_b32 v9,2097152
v_cmp_gt_u32 vcc,32,v6
s_nop 1
v_cndmask_b32 v8,v9,v8,vcc
v_add_u32 v7,v7,v8
v_add_u32 v7,0,v7
v_xor_b32 v19,s62,v7
v_xor_b32 v19,0x2000,v19
v_add_u32 v6,46,v11
v_lshl_add_u32 v9,v6,7,v5
v_and_b32 v9,2047,v9
v_and_b32 v7,3,v6
v_lshl_add_u32 v7,v7,11,v9
v_bfe_u32 v8,v6,2,3
v_lshl_add_u32 v7,v8,14,v7
v_mov_b32 v8,0x2000
v_mov_b32 v9,2097152
v_cmp_gt_u32 vcc,32,v6
s_nop 1
v_cndmask_b32 v8,v9,v8,vcc
v_add_u32 v7,v7,v8
v_add_u32 v7,0,v7
v_xor_b32 v20,s62,v7
v_xor_b32 v20,0x2000,v20
s_add_u32 s64,s79,0
s_lshl_b32 s70,s64,21
s_lshl_b32 s64,s64,13
s_and_b32 s64,s64,0x2000
s_xor_b32 s64,s64,s62
s_add_u32 s70,s70,s64
s_add_u32 s70,s70,29360128
s_mov_b32 s83,1
s_mov_b32 s87,s74
s_cmp_eq_u32 s50,0
s_cselect_b32 s74,s74,0x7fff0000
v_mov_b32 v47,132096
s_lshl_b32 s64,s50,3
s_add_u32 s64,s64,132096
v_mov_b32 v46,s64
v_mov_b32 v29,0
s_mov_b32 s97,0x7fff0000
s_mov_b32 s69,1
s_mov_b32 s68,0
s_mov_b32 s52,0x30003
s_mov_b32 s53,s52
seg_240:
s_cmp_eq_u32 s83,0
s_cbranch_scc1 ahead_241
s_add_u32 s94,s70,s75
s_cmp_eq_u32 s71,65
s_cselect_b32 s64,2097152,0
s_cselect_b32 s65,0x2000,0
s_sub_u32 s94,s94,s64
s_xor_b32 s94,s94,s65
s_xor_b32 s95,s94,1024
s_xor_b32 s91,s72,0x10000
s_cmp_eq_u32 s69,0
s_mov_b32 s69,1
s_cbranch_scc1 half2_245
s_min_u32 s66,s71,64
s_waitcnt vmcnt(3)
v_cmp_gt_u32 vcc,s66,v29
s_cbranch_vccz nb_244
s_waitcnt vmcnt(0)
v_add_u32 v22,s71,-1
buffer_store_dword v22,v23,s[20:23],s97 offen sc1
s_mov_b32 s97,0x7fff0000
s_cmp_lg_u32 s50,0
s_cbranch_scc1 nb_244
buffer_load_dword v32,v21,s[20:23],s74 offen sc1
s_sleep 2
pl_246:
buffer_load_dword v33,v21,s[20:23],s74 offen sc1
s_waitcnt vmcnt(1)
v_cmp_gt_u32 vcc,s66,v32
v_mov_b32 v29,v32
s_cbranch_vccz pok_247
buffer_load_dword v32,v21,s[20:23],s74 offen sc1
s_waitcnt vmcnt(1)
v_cmp_gt_u32 vcc,s66,v33
v_mov_b32 v29,v33
s_cbranch_vccz pok_247
s_sub_u32 s90,s90,1
s_cmp_gt_i32 s90,0
s_cbranch_scc1 pl_246
pok_247:
nb_244:
s_cmp_eq_u32 s71,64
s_barrier
s_cbranch_scc1 half_248
s_xor_b32 m0,s91,0
s_add_u32 s65,s94,0
buffer_load_dwordx4 v16,s[20:23],s65 offen offset:0 sc1 lds
buffer_load_dwordx4 v16,s[20:23],s65 offen offset:2048 sc1 lds
s_xor_b32 m0,s91,16384
s_add_u32 s65,s94,32768
buffer_load_dwordx4 v16,s[20:23],s65 offen offset:0 sc1 lds
buffer_load_dwordx4 v16,s[20:23],s65 offen offset:2048 sc1 lds
s_xor_b32 m0,s91,32768
s_add_u32 s65,s94,65536
buffer_load_dwordx4 v16,s[20:23],s65 offen offset:0 sc1 lds
buffer_load_dwordx4 v16,s[20:23],s65 offen offset:2048 sc1 lds
s_xor_b32 m0,s91,49152
s_add_u32 s65,s94,98304
buffer_load_dwordx4 v16,s[20:23],s65 offen offset:0 sc1 lds
buffer_load_dwordx4 v16,s[20:23],s65 offen offset:2048 sc1 lds
s_waitcnt vmcnt(8)
v_add_u32 v22,s71,-1
buffer_store_dword v22,v23,s[20:23],s97 offen sc1
s_mov_b32 s97,0x7fff0000
s_waitcnt vmcnt(7)
s_barrier
ds_read_b128 v[224:227],v17 offset:0
ds_read_b128 v[228:231],v17 offset:2048
ds_read_b128 v[232:235],v17 offset:4096
ds_read_b128 v[236:239],v17 offset:6144
ds_read_b128 v[240:243],v17 offset:8192
ds_read_b128 v[244:247],v17 offset:10240
ds_read_b128 v[248:251],v17 offset:12288
s_waitcnt lgkmcnt(5)
v_mfma_f32_16x16x32_bf16 v[64:67],a[0:3],v[224:227],0
s_xor_b32 m0,s91,1024
s_add_u32 s96,s71,1
s_add_u32 s92,s71,2
v_min_u32 v27,v224,v228
v_mfma_f32_16x16x32_bf16 v[72:75],a[128:131],v[224:227],0
ds_read_b128 v[252:255],v17 offset:14336
s_cmp_eq_u32 s96,64
s_cselect_b32 s96,99,s96
v_mfma_f32_16x16x32_bf16 v[64:67],a[4:7],v[228:231],v[64:67]
s_add_u32 s65,s95,0
s_cmp_eq_u32 s92,64
s_cselect_b32 s92,99,s92
v_mfma_f32_16x16x32_bf16 v[72:75],a[132:135],v[228:231],v[72:75]
s_waitcnt vmcnt(5)
s_barrier
ds_read_b128 v[224:227],v17 offset:16384
s_waitcnt lgkmcnt(5)
v_mfma_f32_16x16x32_bf16 v[64:67],a[8:11],v[232:235],v[64:67]
buffer_load_dwordx4 v16,s[20:23],s65 offen offset:0 sc1 lds
v_min3_u32 v27,v27,v232,v236
v_mfma_f32_16x16x32_bf16 v[72:75],a[136:139],v[232:235],v[72:75]
ds_read_b128 v[228:231],v17 offset:18432
s_cmp_eq_u32 s96,65
s_cselect_b32 s96,64,s96
v_mfma_f32_16x16x32_bf16 v[64:67],a[12:15],v[236:239],v[64:67]
buffer_load_dwordx4 v16,s[20:23],s65 offen offset:2048 sc1 lds
v_mfma_f32_16x16x32_bf16 v[72:75],a[140:143],v[236:239],v[72:75]
ds_read_b128 v[232:235],v17 offset:20480
s_waitcnt lgkmcnt(5)
v_mfma_f32_16x16x32_bf16 v[64:67],a[16:19],v[240:243],v[64:67]
s_xor_b32 m0,s91,17408
v_min3_u32 v27,v27,v240,v244
v_mfma_f32_16x16x32_bf16 v[72:75],a[144:147],v[240:243],v[72:75]
ds_read_b128 v[236:239],v17 offset:22528
v_mfma_f32_16x16x32_bf16 v[64:67],a[20:23],v[244:247],v[64:67]
s_add_u32 s65,s95,32768
v_mfma_f32_16x16x32_bf16 v[72:75],a[148:151],v[244:247],v[72:75]
ds_read_b128 v[240:243],v17 offset:24576
s_waitcnt lgkmcnt(5)
v_mfma_f32_16x16x32_bf16 v[64:67],a[24:27],v[248:251],v[64:67]
buffer_load_dwordx4 v16,s[20:23],s65 offen offset:0 sc1 lds
v_mfma_f32_16x16x32_bf16 v[72:75],a[152:155],v[248:251],v[72:75]
ds_read_b128 v[244:247],v17 offset:26624
v_min3_u32 v27,v27,v248,v252
v_mfma_f32_16x16x32_bf16 v[64:67],a[28:31],v[252:255],v[64:67]
buffer_load_dwordx4 v16,s[20:23],s65 offen offset:2048 sc1 lds
v_mfma_f32_16x16x32_bf16 v[72:75],a[156:159],v[252:255],v[72:75]
ds_read_b128 v[248:251],v17 offset:28672
s_waitcnt lgkmcnt(5)
v_mfma_f32_16x16x32_bf16 v[64:67],a[32:35],v[224:227],v[64:67]
s_xor_b32 m0,s91,33792
v_min3_u32 v27,v27,v224,v228
v_mfma_f32_16x16x32_bf16 v[72:75],a[160:163],v[224:227],v[72:75]
ds_read_b128 v[252:255],v17 offset:30720
v_mfma_f32_16x16x32_bf16 v[64:67],a[36:39],v[228:231],v[64:67]
s_add_u32 s65,s95,65536
v_mfma_f32_16x16x32_bf16 v[72:75],a[164:167],v[228:231],v[72:75]
s_waitcnt vmcnt(5)
s_barrier
ds_read_b128 v[224:227],v17 offset:32768
s_waitcnt lgkmcnt(5)
v_mfma_f32_16x16x32_bf16 v[64:67],a[40:43],v[232:235],v[64:67]
buffer_load_dwordx4 v16,s[20:23],s65 offen offset:0 sc1 lds
v_mfma_f32_16x16x32_bf16 v[72:75],a[168:171],v[232:235],v[72:75]
ds_read_b128 v[228:231],v17 offset:34816
v_min3_u32 v27,v27,v232,v236
v_mfma_f32_16x16x32_bf16 v[64:67],a[44:47],v[236:239],v[64:67]
buffer_load_dwordx4 v16,s[20:23],s65 offen offset:2048 sc1 lds
v_mfma_f32_16x16x32_bf16 v[72:75],a[172:175],v[236:239],v[72:75]
ds_read_b128 v[232:235],v17 offset:36864
s_waitcnt lgkmcnt(5)
v_mfma_f32_16x16x32_bf16 v[64:67],a[48:51],v[240:243],v[64:67]
s_xor_b32 m0,s91,50176
v_min3_u32 v27,v27,v240,v244
v_mfma_f32_16x16x32_bf16 v[72:75],a[176:179],v[240:243],v[72:75]
ds_read_b128 v[236:239],v17 offset:38912
v_mfma_f32_16x16x32_bf16 v[64:67],a[52:55],v[244:247],v[64:67]
s_add_u32 s65,s95,98304
v_mfma_f32_16x16x32_bf16 v[72:75],a[180:183],v[244:247],v[72:75]
ds_read_b128 v[240:243],v17 offset:40960
s_waitcnt lgkmcnt(5)
v_mfma_f32_16x16x32_bf16 v[64:67],a[56:59],v[248:251],v[64:67]
buffer_load_dwordx4 v16,s[20:23],s65 offen offset:0 sc1 lds
v_min3_u32 v27,v27,v248,v252
v_mfma_f32_16x16x32_bf16 v[72:75],a[184:187],v[248:251],v[72:75]
ds_read_b128 v[244:247],v17 offset:43008
s_waitcnt vmcnt(63)
v_mfma_f32_16x16x32_bf16 v[64:67],a[60:63],v[252:255],v[64:67]
buffer_load_dwordx4 v16,s[20:23],s65 offen offset:2048 sc1 lds
v_mfma_f32_16x16x32_bf16 v[72:75],a[188:191],v[252:255],v[72:75]
ds_read_b128 v[248:251],v17 offset:45056
s_waitcnt lgkmcnt(5)
v_mfma_f32_16x16x32_bf16 v[64:67],a[64:67],v[224:227],v[64:67]
v_cmp_gt_u32 vcc,s96,v29
v_cmp_gt_u32 s[92:93],s92,v29
v_mfma_f32_16x16x32_bf16 v[72:75],a[192:195],v[224:227],v[72:75]
ds_read_b128 v[252:255],v17 offset:47104
v_min3_u32 v27,v27,v224,v228
v_mfma_f32_16x16x32_bf16 v[64:67],a[68:71],v[228:231],v[64:67]
v_mov_b32 v44,vcc_lo
v_mov_b32 v45,s92
s_add_u32 m0,s43,0
v_mfma_f32_16x16x32_bf16 v[72:75],a[196:199],v[228:231],v[72:75]
ds_read_b128 v[224:227],v17 offset:49152
s_waitcnt lgkmcnt(5)
v_mfma_f32_16x16x32_bf16 v[64:67],a[72:75],v[232:235],v[64:67]
ds_write_b64 v46,v[44:45]
v_min3_u32 v27,v27,v232,v236
v_mfma_f32_16x16x32_bf16 v[72:75],a[200:203],v[232:235],v[72:75]
ds_read_b128 v[228:231],v17 offset:51200
buffer_load_dwordx4 v19,s[20:23],s78 offen sc1 lds
v_mfma_f32_16x16x32_bf16 v[64:67],a[76:79],v[236:239],v[64:67]
s_add_u32 m0,s43,1024
s_nop 0
buffer_load_dwordx4 v20,s[20:23],s78 offen sc1 lds
v_mfma_f32_16x16x32_bf16 v[72:75],a[204:207],v[236:239],v[72:75]
ds_read_b128 v[232:235],v17 offset:53248
s_waitcnt lgkmcnt(6)
v_mfma_f32_16x16x32_bf16 v[64:67],a[80:83],v[240:243],v[64:67]
v_min3_u32 v27,v27,v240,v244
s_add_u32 s88,s70,s75
v_mfma_f32_16x16x32_bf16 v[72:75],a[208:211],v[240:243],v[72:75]
ds_read_b128 v[236:239],v17 offset:55296
s_add_u32 s88,s88,2097152
v_mfma_f32_16x16x32_bf16 v[64:67],a[84:87],v[244:247],v[64:67]
s_xor_b32 s88,s88,0x2000
s_xor_b32 s89,s88,1024
v_mfma_f32_16x16x32_bf16 v[72:75],a[212:215],v[244:247],v[72:75]
ds_read_b128 v[240:243],v17 offset:57344
s_waitcnt lgkmcnt(6)
v_mfma_f32_16x16x32_bf16 v[64:67],a[88:91],v[248:251],v[64:67]
v_min3_u32 v27,v27,v248,v252
v_mfma_f32_16x16x32_bf16 v[72:75],a[216:219],v[248:251],v[72:75]
ds_read_b128 v[244:247],v17 offset:59392
v_mfma_f32_16x16x32_bf16 v[64:67],a[92:95],v[252:255],v[64:67]
v_mfma_f32_16x16x32_bf16 v[72:75],a[220:223],v[252:255],v[72:75]
ds_read_b128 v[248:251],v17 offset:61440
s_waitcnt lgkmcnt(5)
v_mfma_f32_16x16x32_bf16 v[64:67],a[96:99],v[224:227],v[64:67]
v_min3_u32 v27,v27,v224,v228
v_mfma_f32_16x16x32_bf16 v[72:75],a[224:227],v[224:227],v[72:75]
ds_read_b128 v[252:255],v17 offset:63488
v_mfma_f32_16x16x32_bf16 v[64:67],a[100:103],v[228:231],v[64:67]
v_mfma_f32_16x16x32_bf16 v[72:75],a[228:231],v[228:231],v[72:75]
s_waitcnt vmcnt(6)
s_barrier
ds_read_b64 v[44:45],v47
ds_read_b128 v[224:227],v17 offset:1024
s_waitcnt lgkmcnt(6)
v_mfma_f32_16x16x32_bf16 v[64:67],a[104:107],v[232:235],v[64:67]
v_min3_u32 v27,v27,v232,v236
v_mfma_f32_16x16x32_bf16 v[72:75],a[232:235],v[232:235],v[72:75]
ds_read_b128 v[228:231],v17 offset:3072
v_mfma_f32_16x16x32_bf16 v[64:67],a[108:111],v[236:239],v[64:67]
s_waitcnt vmcnt(0)
ds_read_b64 v[120:121],v40 offset:0
v_mfma_f32_16x16x32_bf16 v[72:75],a[236:239],v[236:239],v[72:75]
ds_read_b128 v[232:235],v17 offset:5120
s_waitcnt lgkmcnt(7)
v_mfma_f32_16x16x32_bf16 v[64:67],a[112:115],v[240:243],v[64:67]
v_min3_u32 v27,v27,v240,v244
ds_read_b64 v[122:123],v41 offset:0
v_mfma_f32_16x16x32_bf16 v[72:75],a[240:243],v[240:243],v[72:75]
ds_read_b128 v[236:239],v17 offset:7168
ds_read_b64 v[124:125],v40 offset:1024
v_mfma_f32_16x16x32_bf16 v[64:67],a[116:119],v[244:247],v[64:67]
ds_read_b64 v[126:127],v41 offset:1024
v_mfma_f32_16x16x32_bf16 v[72:75],a[244:247],v[244:247],v[72:75]
ds_read_b128 v[240:243],v17 offset:9216
s_waitcnt lgkmcnt(10)
v_mfma_f32_16x16x32_bf16 v[64:67],a[120:123],v[248:251],v[64:67]
s_waitcnt lgkmcnt(9)
v_readfirstlane_b32 s93,v45
v_mfma_f32_16x16x32_bf16 v[72:75],a[248:251],v[248:251],v[72:75]
ds_read_b128 v[244:247],v17 offset:11264
v_readfirstlane_b32 s83,v44
s_cmp_lg_u32 s83,0
s_cbranch_scc0 keep_250
v_mfma_f32_16x16x32_bf16 v[64:67],a[124:127],v[252:255],v[64:67]
v_min3_u32 v27,v27,v248,v252
v_mfma_f32_16x16x32_bf16 v[72:75],a[252:255],v[252:255],v[72:75]
ds_read_b128 v[248:251],v17 offset:13312
s_waitcnt lgkmcnt(9)
v_mfma_f32_16x16x32_bf16 v[68:71],a[0:3],v[224:227],0
v_cmp_eq_u32 vcc,0,v27
s_cbranch_vccnz retry_239
v_mfma_f32_16x16x32_bf16 v[76:79],a[128:131],v[224:227],0
ds_read_b128 v[252:255],v17 offset:15360
v_min3_u32 v27,v27,v224,v228
v_mfma_f32_16x16x32_bf16 v[68:71],a[4:7],v[228:231],v[68:71]
v_mfma_f32_16x16x32_bf16 v[76:79],a[132:135],v[228:231],v[76:79]
ds_read_b128 v[224:227],v17 offset:17408
s_waitcnt lgkmcnt(7)
v_mfma_f32_16x16x32_bf16 v[68:71],a[8:11],v[232:235],v[68:71]
v_min3_u32 v27,v27,v232,v236
s_waitcnt lgkmcnt(5)
v_lshlrev_b32 v88,16,v120
v_mfma_f32_16x16x32_bf16 v[76:79],a[136:139],v[232:235],v[76:79]
ds_read_b128 v[228:231],v17 offset:19456
v_and_b32 v89,s80,v120
v_lshlrev_b32 v90,16,v121
v_mfma_f32_16x16x32_bf16 v[68:71],a[12:15],v[236:239],v[68:71]
v_and_b32 v91,s80,v121
v_lshlrev_b32 v92,16,v122
v_and_b32 v93,s80,v122
v_mfma_f32_16x16x32_bf16 v[76:79],a[140:143],v[236:239],v[76:79]
ds_read_b128 v[232:235],v17 offset:21504
v_lshlrev_b32 v94,16,v123
s_waitcnt lgkmcnt(5)
v_mfma_f32_16x16x32_bf16 v[68:71],a[16:19],v[240:243],v[68:71]
v_min3_u32 v27,v27,v240,v244
v_and_b32 v95,s80,v123
v_mfma_f32_16x16x32_bf16 v[76:79],a[144:147],v[240:243],v[76:79]
ds_read_b128 v[236:239],v17 offset:23552
v_add_f32 v88,v64,v88
v_mfma_f32_16x16x32_bf16 v[68:71],a[20:23],v[244:247],v[68:71]
v_add_f32 v89,v65,v89
v_add_f32 v90,v66,v90
v_mfma_f32_16x16x32_bf16 v[76:79],a[148:151],v[244:247],v[76:79]
ds_read_b128 v[240:243],v17 offset:25600
s_waitcnt lgkmcnt(5)
v_mfma_f32_16x16x32_bf16 v[68:71],a[24:27],v[248:251],v[68:71]
v_min3_u32 v27,v27,v248,v252
v_add_f32 v91,v67,v91
v_mfma_f32_16x16x32_bf16 v[76:79],a[152:155],v[248:251],v[76:79]
ds_read_b128 v[244:247],v17 offset:27648
v_add_f32 v92,v72,v92
v_mfma_f32_16x16x32_bf16 v[68:71],a[28:31],v[252:255],v[68:71]
v_add_f32 v93,v73,v93
v_add_f32 v94,v74,v94
v_mfma_f32_16x16x32_bf16 v[76:79],a[156:159],v[252:255],v[76:79]
ds_read_b128 v[248:251],v17 offset:29696
s_waitcnt lgkmcnt(5)
v_mfma_f32_16x16x32_bf16 v[68:71],a[32:35],v[224:227],v[68:71]
v_min3_u32 v27,v27,v224,v228
v_add_f32 v95,v75,v95
v_mfma_f32_16x16x32_bf16 v[76:79],a[160:163],v[224:227],v[76:79]
ds_read_b128 v[252:255],v17 offset:31744
v_cvt_pk_bf16_f32 v96,v88,v89
v_mfma_f32_16x16x32_bf16 v[68:71],a[36:39],v[228:231],v[68:71]
v_cvt_pk_bf16_f32 v97,v90,v91
v_cvt_pk_bf16_f32 v98,v92,v93
v_mfma_f32_16x16x32_bf16 v[76:79],a[164:167],v[228:231],v[76:79]
s_waitcnt vmcnt(2)
s_barrier
ds_read_b128 v[224:227],v17 offset:33792
s_waitcnt lgkmcnt(5)
v_mfma_f32_16x16x32_bf16 v[68:71],a[40:43],v[232:235],v[68:71]
v_min3_u32 v27,v27,v232,v236
v_cvt_pk_bf16_f32 v99,v94,v95
v_mfma_f32_16x16x32_bf16 v[76:79],a[168:171],v[232:235],v[76:79]
ds_read_b128 v[228:231],v17 offset:35840
v_max_u32 v96,1,v96
v_mfma_f32_16x16x32_bf16 v[68:71],a[44:47],v[236:239],v[68:71]
buffer_store_dwordx4 v[96:99],v18,s[20:23],s70 offen offset:0 sc1
v_mfma_f32_16x16x32_bf16 v[76:79],a[172:175],v[236:239],v[76:79]
ds_read_b128 v[232:235],v17 offset:37888
s_waitcnt lgkmcnt(5)
v_mfma_f32_16x16x32_bf16 v[68:71],a[48:51],v[240:243],v[68:71]
v_min3_u32 v27,v27,v240,v244
v_lshlrev_b32 v88,16,v96
v_mfma_f32_16x16x32_bf16 v[76:79],a[176:179],v[240:243],v[76:79]
ds_read_b128 v[236:239],v17 offset:39936
v_and_b32 v89,s80,v96
v_mfma_f32_16x16x32_bf16 v[68:71],a[52:55],v[244:247],v[68:71]
v_lshlrev_b32 v90,16,v97
v_and_b32 v91,s80,v97
v_mfma_f32_16x16x32_bf16 v[76:79],a[180:183],v[244:247],v[76:79]
ds_read_b128 v[240:243],v17 offset:41984
s_waitcnt lgkmcnt(5)
v_mfma_f32_16x16x32_bf16 v[68:71],a[56:59],v[248:251],v[68:71]
v_min3_u32 v27,v27,v248,v252
v_lshlrev_b32 v92,16,v98
v_mfma_f32_16x16x32_bf16 v[76:79],a[184:187],v[248:251],v[76:79]
ds_read_b128 v[244:247],v17 offset:44032
v_and_b32 v93,s80,v98
v_mfma_f32_16x16x32_bf16 v[68:71],a[60:63],v[252:255],v[68:71]
v_lshlrev_b32 v94,16,v99
v_and_b32 v95,s80,v99
v_mfma_f32_16x16x32_bf16 v[76:79],a[188:191],v[252:255],v[76:79]
ds_read_b128 v[248:251],v17 offset:46080
s_waitcnt lgkmcnt(5)
v_mfma_f32_16x16x32_bf16 v[68:71],a[64:67],v[224:227],v[68:71]
v_min3_u32 v27,v27,v224,v228
v_add_f32 v108,v88,v89
v_mfma_f32_16x16x32_bf16 v[76:79],a[192:195],v[224:227],v[76:79]
ds_read_b128 v[252:255],v17 offset:48128
v_mul_f32 v109,v88,v88
v_mfma_f32_16x16x32_bf16 v[68:71],a[68:71],v[228:231],v[68:71]
v_add_f32 v100,v90,v91
v_mul_f32 v101,v89,v89
v_mfma_f32_16x16x32_bf16 v[76:79],a[196:199],v[228:231],v[76:79]
ds_read_b128 v[224:227],v17 offset:50176
s_waitcnt lgkmcnt(5)
v_mfma_f32_16x16x32_bf16 v[68:71],a[72:75],v[232:235],v[68:71]
v_min3_u32 v27,v27,v232,v236
v_fmac_f32 v109,v90,v90
v_mfma_f32_16x16x32_bf16 v[76:79],a[200:203],v[232:235],v[76:79]
ds_read_b128 v[228:231],v17 offset:52224
v_fmac_f32 v101,v91,v91
v_mfma_f32_16x16x32_bf16 v[68:71],a[76:79],v[236:239],v[68:71]
v_fmac_f32 v109,v92,v92
v_fmac_f32 v101,v93,v93
v_mfma_f32_16x16x32_bf16 v[76:79],a[204:207],v[236:239],v[76:79]
ds_read_b128 v[232:235],v17 offset:54272
s_waitcnt lgkmcnt(5)
v_mfma_f32_16x16x32_bf16 v[68:71],a[80:83],v[240:243],v[68:71]
v_min3_u32 v27,v27,v240,v244
v_add_f32 v108,v108,v92
v_mfma_f32_16x16x32_bf16 v[76:79],a[208:211],v[240:243],v[76:79]
ds_read_b128 v[236:239],v17 offset:56320
v_add_f32 v100,v100,v93
v_mfma_f32_16x16x32_bf16 v[68:71],a[84:87],v[244:247],v[68:71]
v_fmac_f32 v109,v94,v94
v_fmac_f32 v101,v95,v95
v_mfma_f32_16x16x32_bf16 v[76:79],a[212:215],v[244:247],v[76:79]
ds_read_b128 v[240:243],v17 offset:58368
s_waitcnt lgkmcnt(5)
v_mfma_f32_16x16x32_bf16 v[68:71],a[88:91],v[248:251],v[68:71]
v_min3_u32 v27,v27,v248,v252
v_add_f32 v108,v108,v94
v_mfma_f32_16x16x32_bf16 v[76:79],a[216:219],v[248:251],v[76:79]
ds_read_b128 v[244:247],v17 offset:60416
v_add_f32 v100,v100,v95
v_mfma_f32_16x16x32_bf16 v[68:71],a[92:95],v[252:255],v[68:71]
v_add_f32 v108,v108,v100
v_add_f32 v109,v109,v101
v_mfma_f32_16x16x32_bf16 v[76:79],a[220:223],v[252:255],v[76:79]
ds_read_b128 v[248:251],v17 offset:62464
s_waitcnt lgkmcnt(5)
v_mfma_f32_16x16x32_bf16 v[68:71],a[96:99],v[224:227],v[68:71]
v_min3_u32 v27,v27,v224,v228
v_mov_b32 v100,v108
v_mfma_f32_16x16x32_bf16 v[76:79],a[224:227],v[224:227],v[76:79]
ds_read_b128 v[252:255],v17 offset:64512
v_mov_b32 v101,v109
v_mfma_f32_16x16x32_bf16 v[68:71],a[100:103],v[228:231],v[68:71]
v_permlane16_swap_b32 v100,v108
v_permlane16_swap_b32 v101,v109
v_mfma_f32_16x16x32_bf16 v[76:79],a[228:231],v[228:231],v[76:79]
v_add_f32 v108,v108,v100
s_waitcnt lgkmcnt(4)
v_mfma_f32_16x16x32_bf16 v[68:71],a[104:107],v[232:235],v[68:71]
v_min3_u32 v27,v27,v232,v236
v_add_f32 v109,v109,v101
v_mfma_f32_16x16x32_bf16 v[76:79],a[232:235],v[232:235],v[76:79]
v_mov_b32 v100,v108
v_mov_b32 v101,v109
v_mfma_f32_16x16x32_bf16 v[68:71],a[108:111],v[236:239],v[68:71]
v_permlane32_swap_b32 v100,v108
v_permlane32_swap_b32 v101,v109
v_mfma_f32_16x16x32_bf16 v[76:79],a[236:239],v[236:239],v[76:79]
v_add_f32 v108,v108,v100
s_waitcnt lgkmcnt(2)
v_mfma_f32_16x16x32_bf16 v[68:71],a[112:115],v[240:243],v[68:71]
v_min3_u32 v27,v27,v240,v244
v_add_f32 v109,v109,v101
v_mfma_f32_16x16x32_bf16 v[76:79],a[240:243],v[240:243],v[76:79]
v_min3_u32 v27,v27,v120,v122
v_min3_u32 v27,v27,v124,v126
v_mfma_f32_16x16x32_bf16 v[68:71],a[116:119],v[244:247],v[68:71]
v_lshlrev_b32 v32,16,v124
v_and_b32 v33,s80,v124
v_mfma_f32_16x16x32_bf16 v[76:79],a[244:247],v[244:247],v[76:79]
v_lshlrev_b32 v34,16,v125
s_waitcnt lgkmcnt(0)
v_mfma_f32_16x16x32_bf16 v[68:71],a[120:123],v[248:251],v[68:71]
v_min3_u32 v27,v27,v248,v252
v_and_b32 v35,s80,v125
v_mfma_f32_16x16x32_bf16 v[76:79],a[248:251],v[248:251],v[76:79]
v_lshlrev_b32 v36,16,v126
v_and_b32 v37,s80,v126
v_mfma_f32_16x16x32_bf16 v[68:71],a[124:127],v[252:255],v[68:71]
v_lshlrev_b32 v38,16,v127
v_and_b32 v39,s80,v127
v_mfma_f32_16x16x32_bf16 v[76:79],a[252:255],v[252:255],v[76:79]
v_cmp_eq_u32 vcc,0,v27
s_cbranch_vccnz retry_239
s_branch epi_242
keep_250:
v_mfma_f32_16x16x32_bf16 v[64:67],a[124:127],v[252:255],v[64:67]
v_min3_u32 v27,v27,v248,v252
s_xor_b32 m0,s72,0
v_mfma_f32_16x16x32_bf16 v[72:75],a[252:255],v[252:255],v[72:75]
ds_read_b128 v[248:251],v17 offset:13312
s_waitcnt lgkmcnt(9)
v_mfma_f32_16x16x32_bf16 v[68:71],a[0:3],v[224:227],0
s_add_u32 s65,s88,0
v_cmp_eq_u32 vcc,0,v27
s_cbranch_vccnz retry_239
v_mfma_f32_16x16x32_bf16 v[76:79],a[128:131],v[224:227],0
ds_read_b128 v[252:255],v17 offset:15360
v_min3_u32 v27,v27,v224,v228
v_mfma_f32_16x16x32_bf16 v[68:71],a[4:7],v[228:231],v[68:71]
buffer_load_dwordx4 v16,s[20:23],s65 offen offset:0 sc1 lds
v_mfma_f32_16x16x32_bf16 v[76:79],a[132:135],v[228:231],v[76:79]
ds_read_b128 v[224:227],v17 offset:17408
s_waitcnt lgkmcnt(7)
v_mfma_f32_16x16x32_bf16 v[68:71],a[8:11],v[232:235],v[68:71]
buffer_load_dwordx4 v16,s[20:23],s65 offen offset:2048 sc1 lds
s_waitcnt lgkmcnt(5)
v_lshlrev_b32 v88,16,v120
v_mfma_f32_16x16x32_bf16 v[76:79],a[136:139],v[232:235],v[76:79]
ds_read_b128 v[228:231],v17 offset:19456
s_xor_b32 m0,s72,16384
v_and_b32 v89,s80,v120
v_lshlrev_b32 v90,16,v121
v_mfma_f32_16x16x32_bf16 v[68:71],a[12:15],v[236:239],v[68:71]
s_add_u32 s65,s88,32768
v_min3_u32 v27,v27,v232,v236
v_and_b32 v91,s80,v121
v_lshlrev_b32 v92,16,v122
v_mfma_f32_16x16x32_bf16 v[76:79],a[140:143],v[236:239],v[76:79]
ds_read_b128 v[232:235],v17 offset:21504
v_and_b32 v93,s80,v122
v_lshlrev_b32 v94,16,v123
s_waitcnt lgkmcnt(5)
v_mfma_f32_16x16x32_bf16 v[68:71],a[16:19],v[240:243],v[68:71]
buffer_load_dwordx4 v16,s[20:23],s65 offen offset:0 sc1 lds
v_and_b32 v95,s80,v123
v_add_f32 v88,v64,v88
v_mfma_f32_16x16x32_bf16 v[76:79],a[144:147],v[240:243],v[76:79]
ds_read_b128 v[236:239],v17 offset:23552
v_min3_u32 v27,v27,v240,v244
v_add_f32 v89,v65,v89
v_add_f32 v90,v66,v90
v_mfma_f32_16x16x32_bf16 v[68:71],a[20:23],v[244:247],v[68:71]
buffer_load_dwordx4 v16,s[20:23],s65 offen offset:2048 sc1 lds
v_add_f32 v91,v67,v91
v_add_f32 v92,v72,v92
v_mfma_f32_16x16x32_bf16 v[76:79],a[148:151],v[244:247],v[76:79]
ds_read_b128 v[240:243],v17 offset:25600
v_add_f32 v93,v73,v93
v_add_f32 v94,v74,v94
s_waitcnt lgkmcnt(5)
v_mfma_f32_16x16x32_bf16 v[68:71],a[24:27],v[248:251],v[68:71]
s_xor_b32 m0,s72,32768
s_add_u32 s65,s88,65536
v_add_f32 v95,v75,v95
v_cvt_pk_bf16_f32 v96,v88,v89
v_mfma_f32_16x16x32_bf16 v[76:79],a[152:155],v[248:251],v[76:79]
ds_read_b128 v[244:247],v17 offset:27648
v_min3_u32 v27,v27,v248,v252
v_cvt_pk_bf16_f32 v97,v90,v91
v_cvt_pk_bf16_f32 v98,v92,v93
v_mfma_f32_16x16x32_bf16 v[68:71],a[28:31],v[252:255],v[68:71]
buffer_load_dwordx4 v16,s[20:23],s65 offen offset:0 sc1 lds
v_cvt_pk_bf16_f32 v99,v94,v95
v_max_u32 v96,1,v96
v_mfma_f32_16x16x32_bf16 v[76:79],a[156:159],v[252:255],v[76:79]
ds_read_b128 v[248:251],v17 offset:29696
buffer_store_dwordx4 v[96:99],v18,s[20:23],s70 offen offset:0 sc1
s_waitcnt lgkmcnt(5)
v_mfma_f32_16x16x32_bf16 v[68:71],a[32:35],v[224:227],v[68:71]
buffer_load_dwordx4 v16,s[20:23],s65 offen offset:2048 sc1 lds
v_lshlrev_b32 v88,16,v96
v_and_b32 v89,s80,v96
v_mfma_f32_16x16x32_bf16 v[76:79],a[160:163],v[224:227],v[76:79]
ds_read_b128 v[252:255],v17 offset:31744
s_xor_b32 m0,s72,49152
v_lshlrev_b32 v90,16,v97
v_and_b32 v91,s80,v97
v_mfma_f32_16x16x32_bf16 v[68:71],a[36:39],v[228:231],v[68:71]
v_min3_u32 v27,v27,v224,v228
v_lshlrev_b32 v92,16,v98
v_and_b32 v93,s80,v98
v_lshlrev_b32 v94,16,v99
v_mfma_f32_16x16x32_bf16 v[76:79],a[164:167],v[228:231],v[76:79]
s_waitcnt vmcnt(9)
s_barrier
ds_read_b128 v[224:227],v17 offset:33792
s_waitcnt lgkmcnt(5)
v_mfma_f32_16x16x32_bf16 v[68:71],a[40:43],v[232:235],v[68:71]
s_add_u32 s65,s88,98304
v_min3_u32 v27,v27,v232,v236
v_and_b32 v95,s80,v99
v_add_f32 v108,v88,v89
v_mfma_f32_16x16x32_bf16 v[76:79],a[168:171],v[232:235],v[76:79]
ds_read_b128 v[228:231],v17 offset:35840
v_mul_f32 v109,v88,v88
v_add_f32 v100,v90,v91
v_mul_f32 v101,v89,v89
v_mfma_f32_16x16x32_bf16 v[68:71],a[44:47],v[236:239],v[68:71]
buffer_load_dwordx4 v16,s[20:23],s65 offen offset:0 sc1 lds
v_fmac_f32 v109,v90,v90
v_fmac_f32 v101,v91,v91
v_mfma_f32_16x16x32_bf16 v[76:79],a[172:175],v[236:239],v[76:79]
ds_read_b128 v[232:235],v17 offset:37888
v_fmac_f32 v109,v92,v92
v_fmac_f32 v101,v93,v93
s_waitcnt lgkmcnt(5)
v_mfma_f32_16x16x32_bf16 v[68:71],a[48:51],v[240:243],v[68:71]
buffer_load_dwordx4 v16,s[20:23],s65 offen offset:2048 sc1 lds
v_add_f32 v108,v108,v92
v_add_f32 v100,v100,v93
v_mfma_f32_16x16x32_bf16 v[76:79],a[176:179],v[240:243],v[76:79]
ds_read_b128 v[236:239],v17 offset:39936
s_xor_b32 m0,s72,1024
v_fmac_f32 v109,v94,v94
v_fmac_f32 v101,v95,v95
v_mfma_f32_16x16x32_bf16 v[68:71],a[52:55],v[244:247],v[68:71]
s_add_u32 s65,s89,0
v_min3_u32 v27,v27,v240,v244
v_add_f32 v108,v108,v94
v_add_f32 v100,v100,v95
v_mfma_f32_16x16x32_bf16 v[76:79],a[180:183],v[244:247],v[76:79]
ds_read_b128 v[240:243],v17 offset:41984
v_add_f32 v108,v108,v100
v_add_f32 v109,v109,v101
s_waitcnt lgkmcnt(5)
v_mfma_f32_16x16x32_bf16 v[68:71],a[56:59],v[248:251],v[68:71]
buffer_load_dwordx4 v16,s[20:23],s65 offen offset:0 sc1 lds
v_mfma_f32_16x16x32_bf16 v[76:79],a[184:187],v[248:251],v[76:79]
ds_read_b128 v[244:247],v17 offset:44032
v_min3_u32 v27,v27,v248,v252
v_mfma_f32_16x16x32_bf16 v[68:71],a[60:63],v[252:255],v[68:71]
buffer_load_dwordx4 v16,s[20:23],s65 offen offset:2048 sc1 lds
v_mfma_f32_16x16x32_bf16 v[76:79],a[188:191],v[252:255],v[76:79]
ds_read_b128 v[248:251],v17 offset:46080
s_waitcnt lgkmcnt(5)
v_mfma_f32_16x16x32_bf16 v[68:71],a[64:67],v[224:227],v[68:71]
s_xor_b32 m0,s72,17408
s_add_u32 s65,s89,32768
v_mfma_f32_16x16x32_bf16 v[76:79],a[192:195],v[224:227],v[76:79]
ds_read_b128 v[252:255],v17 offset:48128
v_min3_u32 v27,v27,v224,v228
v_mfma_f32_16x16x32_bf16 v[68:71],a[68:71],v[228:231],v[68:71]
buffer_load_dwordx4 v16,s[20:23],s65 offen offset:0 sc1 lds
v_mfma_f32_16x16x32_bf16 v[76:79],a[196:199],v[228:231],v[76:79]
ds_read_b128 v[224:227],v17 offset:50176
s_waitcnt lgkmcnt(5)
v_mfma_f32_16x16x32_bf16 v[68:71],a[72:75],v[232:235],v[68:71]
buffer_load_dwordx4 v16,s[20:23],s65 offen offset:2048 sc1 lds
v_mfma_f32_16x16x32_bf16 v[76:79],a[200:203],v[232:235],v[76:79]
ds_read_b128 v[228:231],v17 offset:52224
s_xor_b32 m0,s72,33792
v_mfma_f32_16x16x32_bf16 v[68:71],a[76:79],v[236:239],v[68:71]
s_add_u32 s65,s89,65536
v_min3_u32 v27,v27,v232,v236
v_mfma_f32_16x16x32_bf16 v[76:79],a[204:207],v[236:239],v[76:79]
ds_read_b128 v[232:235],v17 offset:54272
s_waitcnt lgkmcnt(5)
v_mfma_f32_16x16x32_bf16 v[68:71],a[80:83],v[240:243],v[68:71]
buffer_load_dwordx4 v16,s[20:23],s65 offen offset:0 sc1 lds
v_mfma_f32_16x16x32_bf16 v[76:79],a[208:211],v[240:243],v[76:79]
ds_read_b128 v[236:239],v17 offset:56320
v_min3_u32 v27,v27,v240,v244
v_mfma_f32_16x16x32_bf16 v[68:71],a[84:87],v[244:247],v[68:71]
buffer_load_dwordx4 v16,s[20:23],s65 offen offset:2048 sc1 lds
v_mfma_f32_16x16x32_bf16 v[76:79],a[212:215],v[244:247],v[76:79]
ds_read_b128 v[240:243],v17 offset:58368
s_waitcnt lgkmcnt(5)
v_mfma_f32_16x16x32_bf16 v[68:71],a[88:91],v[248:251],v[68:71]
s_xor_b32 m0,s72,50176
v_min3_u32 v27,v27,v248,v252
v_mfma_f32_16x16x32_bf16 v[76:79],a[216:219],v[248:251],v[76:79]
ds_read_b128 v[244:247],v17 offset:60416
s_add_u32 s65,s89,98304
v_mfma_f32_16x16x32_bf16 v[68:71],a[92:95],v[252:255],v[68:71]
buffer_load_dwordx4 v16,s[20:23],s65 offen offset:0 sc1 lds
v_mfma_f32_16x16x32_bf16 v[76:79],a[220:223],v[252:255],v[76:79]
ds_read_b128 v[248:251],v17 offset:62464
s_waitcnt lgkmcnt(5)
v_mfma_f32_16x16x32_bf16 v[68:71],a[96:99],v[224:227],v[68:71]
buffer_load_dwordx4 v16,s[20:23],s65 offen offset:2048 sc1 lds
v_mfma_f32_16x16x32_bf16 v[76:79],a[224:227],v[224:227],v[76:79]
ds_read_b128 v[252:255],v17 offset:64512
v_min3_u32 v27,v27,v224,v228
v_mfma_f32_16x16x32_bf16 v[68:71],a[100:103],v[228:231],v[68:71]
v_mov_b32 v100,v108
v_mov_b32 v101,v109
v_mfma_f32_16x16x32_bf16 v[76:79],a[228:231],v[228:231],v[76:79]
v_permlane16_swap_b32 v100,v108
s_waitcnt lgkmcnt(4)
v_mfma_f32_16x16x32_bf16 v[68:71],a[104:107],v[232:235],v[68:71]
v_min3_u32 v27,v27,v232,v236
v_permlane16_swap_b32 v101,v109
v_mfma_f32_16x16x32_bf16 v[76:79],a[232:235],v[232:235],v[76:79]
v_add_f32 v108,v108,v100
v_add_f32 v109,v109,v101
v_mfma_f32_16x16x32_bf16 v[68:71],a[108:111],v[236:239],v[68:71]
v_mov_b32 v100,v108
v_mov_b32 v101,v109
v_mfma_f32_16x16x32_bf16 v[76:79],a[236:239],v[236:239],v[76:79]
v_permlane32_swap_b32 v100,v108
s_waitcnt lgkmcnt(2)
v_mfma_f32_16x16x32_bf16 v[68:71],a[112:115],v[240:243],v[68:71]
v_min3_u32 v27,v27,v240,v244
v_permlane32_swap_b32 v101,v109
v_mfma_f32_16x16x32_bf16 v[76:79],a[240:243],v[240:243],v[76:79]
v_add_f32 v108,v108,v100
v_add_f32 v109,v109,v101
v_mfma_f32_16x16x32_bf16 v[68:71],a[116:119],v[244:247],v[68:71]
v_min3_u32 v27,v27,v120,v122
v_min3_u32 v27,v27,v124,v126
v_mfma_f32_16x16x32_bf16 v[76:79],a[244:247],v[244:247],v[76:79]
v_lshlrev_b32 v32,16,v124
s_waitcnt lgkmcnt(0)
v_mfma_f32_16x16x32_bf16 v[68:71],a[120:123],v[248:251],v[68:71]
v_min3_u32 v27,v27,v248,v252
v_and_b32 v33,s80,v124
v_mfma_f32_16x16x32_bf16 v[76:79],a[248:251],v[248:251],v[76:79]
v_lshlrev_b32 v34,16,v125
v_and_b32 v35,s80,v125
v_mfma_f32_16x16x32_bf16 v[68:71],a[124:127],v[252:255],v[68:71]
v_lshlrev_b32 v36,16,v126
v_and_b32 v37,s80,v126
v_mfma_f32_16x16x32_bf16 v[76:79],a[252:255],v[252:255],v[76:79]
v_lshlrev_b32 v38,16,v127
v_and_b32 v39,s80,v127
v_cmp_eq_u32 vcc,0,v27
s_cbranch_vccnz retry_239
s_branch epi_242
ahead_241:
s_cmp_eq_u32 s93,0
s_cbranch_scc1 both_243
s_waitcnt vmcnt(12) lgkmcnt(0)
s_barrier
ds_read_b128 v[224:227],v17 offset:0
ds_read_b128 v[228:231],v17 offset:2048
ds_read_b128 v[232:235],v17 offset:4096
ds_read_b128 v[236:239],v17 offset:6144
ds_read_b128 v[240:243],v17 offset:8192
ds_read_b128 v[244:247],v17 offset:10240
ds_read_b128 v[248:251],v17 offset:12288
s_waitcnt lgkmcnt(5)
v_mfma_f32_16x16x32_bf16 v[64:67],a[0:3],v[224:227],0
s_add_u32 s96,s71,1
s_add_u32 s92,s71,2
v_min_u32 v27,v224,v228
s_add_u32 m0,s43,0
v_mfma_f32_16x16x32_bf16 v[72:75],a[128:131],v[224:227],0
ds_read_b128 v[252:255],v17 offset:14336
s_cmp_eq_u32 s96,64
s_cselect_b32 s96,99,s96
v_mfma_f32_16x16x32_bf16 v[64:67],a[4:7],v[228:231],v[64:67]
s_cmp_eq_u32 s92,64
s_cselect_b32 s92,99,s92
buffer_load_dwordx4 v19,s[20:23],s78 offen sc1 lds
v_mfma_f32_16x16x32_bf16 v[72:75],a[132:135],v[228:231],v[72:75]
ds_read_b128 v[224:227],v17 offset:16384
s_add_u32 m0,s43,1024
s_waitcnt lgkmcnt(5)
v_mfma_f32_16x16x32_bf16 v[64:67],a[8:11],v[232:235],v[64:67]
s_cmp_eq_u32 s96,65
s_cselect_b32 s96,64,s96
buffer_load_dwordx4 v20,s[20:23],s78 offen sc1 lds
v_mfma_f32_16x16x32_bf16 v[72:75],a[136:139],v[232:235],v[72:75]
ds_read_b128 v[228:231],v17 offset:18432
v_min3_u32 v27,v27,v232,v236
v_mfma_f32_16x16x32_bf16 v[64:67],a[12:15],v[236:239],v[64:67]
v_mfma_f32_16x16x32_bf16 v[72:75],a[140:143],v[236:239],v[72:75]
ds_read_b128 v[232:235],v17 offset:20480
s_waitcnt lgkmcnt(5)
v_mfma_f32_16x16x32_bf16 v[64:67],a[16:19],v[240:243],v[64:67]
v_min3_u32 v27,v27,v240,v244
v_mfma_f32_16x16x32_bf16 v[72:75],a[144:147],v[240:243],v[72:75]
ds_read_b128 v[236:239],v17 offset:22528
v_mfma_f32_16x16x32_bf16 v[64:67],a[20:23],v[244:247],v[64:67]
v_mfma_f32_16x16x32_bf16 v[72:75],a[148:151],v[244:247],v[72:75]
ds_read_b128 v[240:243],v17 offset:24576
s_waitcnt lgkmcnt(5)
v_mfma_f32_16x16x32_bf16 v[64:67],a[24:27],v[248:251],v[64:67]
v_min3_u32 v27,v27,v248,v252
v_mfma_f32_16x16x32_bf16 v[72:75],a[152:155],v[248:251],v[72:75]
ds_read_b128 v[244:247],v17 offset:26624
v_mfma_f32_16x16x32_bf16 v[64:67],a[28:31],v[252:255],v[64:67]
v_mfma_f32_16x16x32_bf16 v[72:75],a[156:159],v[252:255],v[72:75]
ds_read_b128 v[248:251],v17 offset:28672
s_waitcnt lgkmcnt(5)
v_mfma_f32_16x16x32_bf16 v[64:67],a[32:35],v[224:227],v[64:67]
v_min3_u32 v27,v27,v224,v228
v_mfma_f32_16x16x32_bf16 v[72:75],a[160:163],v[224:227],v[72:75]
ds_read_b128 v[252:255],v17 offset:30720
v_mfma_f32_16x16x32_bf16 v[64:67],a[36:39],v[228:231],v[64:67]
v_mfma_f32_16x16x32_bf16 v[72:75],a[164:167],v[228:231],v[72:75]
ds_read_b128 v[224:227],v17 offset:32768
s_waitcnt lgkmcnt(5)
v_mfma_f32_16x16x32_bf16 v[64:67],a[40:43],v[232:235],v[64:67]
v_min3_u32 v27,v27,v232,v236
v_mfma_f32_16x16x32_bf16 v[72:75],a[168:171],v[232:235],v[72:75]
ds_read_b128 v[228:231],v17 offset:34816
v_mfma_f32_16x16x32_bf16 v[64:67],a[44:47],v[236:239],v[64:67]
v_mfma_f32_16x16x32_bf16 v[72:75],a[172:175],v[236:239],v[72:75]
ds_read_b128 v[232:235],v17 offset:36864
s_waitcnt lgkmcnt(5)
v_mfma_f32_16x16x32_bf16 v[64:67],a[48:51],v[240:243],v[64:67]
v_min3_u32 v27,v27,v240,v244
v_mfma_f32_16x16x32_bf16 v[72:75],a[176:179],v[240:243],v[72:75]
ds_read_b128 v[236:239],v17 offset:38912
v_mfma_f32_16x16x32_bf16 v[64:67],a[52:55],v[244:247],v[64:67]
v_mfma_f32_16x16x32_bf16 v[72:75],a[180:183],v[244:247],v[72:75]
ds_read_b128 v[240:243],v17 offset:40960
s_waitcnt lgkmcnt(5)
v_mfma_f32_16x16x32_bf16 v[64:67],a[56:59],v[248:251],v[64:67]
v_min3_u32 v27,v27,v248,v252
v_mfma_f32_16x16x32_bf16 v[72:75],a[184:187],v[248:251],v[72:75]
ds_read_b128 v[244:247],v17 offset:43008
s_waitcnt vmcnt(5)
v_mfma_f32_16x16x32_bf16 v[64:67],a[60:63],v[252:255],v[64:67]
v_cmp_gt_u32 vcc,s96,v29
v_cmp_gt_u32 s[92:93],s92,v29
v_mfma_f32_16x16x32_bf16 v[72:75],a[188:191],v[252:255],v[72:75]
ds_read_b128 v[248:251],v17 offset:45056
s_waitcnt lgkmcnt(5)
v_mfma_f32_16x16x32_bf16 v[64:67],a[64:67],v[224:227],v[64:67]
v_mov_b32 v44,vcc_lo
v_mov_b32 v45,s92
v_mfma_f32_16x16x32_bf16 v[72:75],a[192:195],v[224:227],v[72:75]
ds_read_b128 v[252:255],v17 offset:47104
ds_write_b64 v46,v[44:45]
v_mfma_f32_16x16x32_bf16 v[64:67],a[68:71],v[228:231],v[64:67]
v_min3_u32 v27,v27,v224,v228
v_mfma_f32_16x16x32_bf16 v[72:75],a[196:199],v[228:231],v[72:75]
ds_read_b128 v[224:227],v17 offset:49152
s_waitcnt lgkmcnt(6)
v_mfma_f32_16x16x32_bf16 v[64:67],a[72:75],v[232:235],v[64:67]
v_min3_u32 v27,v27,v232,v236
v_mfma_f32_16x16x32_bf16 v[72:75],a[200:203],v[232:235],v[72:75]
ds_read_b128 v[228:231],v17 offset:51200
v_mfma_f32_16x16x32_bf16 v[64:67],a[76:79],v[236:239],v[64:67]
v_mfma_f32_16x16x32_bf16 v[72:75],a[204:207],v[236:239],v[72:75]
ds_read_b128 v[232:235],v17 offset:53248
s_waitcnt lgkmcnt(6)
v_mfma_f32_16x16x32_bf16 v[64:67],a[80:83],v[240:243],v[64:67]
v_min3_u32 v27,v27,v240,v244
s_add_u32 s88,s70,s75
v_mfma_f32_16x16x32_bf16 v[72:75],a[208:211],v[240:243],v[72:75]
ds_read_b128 v[236:239],v17 offset:55296
s_add_u32 s88,s88,2097152
v_mfma_f32_16x16x32_bf16 v[64:67],a[84:87],v[244:247],v[64:67]
s_xor_b32 s88,s88,0x2000
s_xor_b32 s89,s88,1024
v_mfma_f32_16x16x32_bf16 v[72:75],a[212:215],v[244:247],v[72:75]
ds_read_b128 v[240:243],v17 offset:57344
s_waitcnt lgkmcnt(6)
v_mfma_f32_16x16x32_bf16 v[64:67],a[88:91],v[248:251],v[64:67]
v_min3_u32 v27,v27,v248,v252
v_mfma_f32_16x16x32_bf16 v[72:75],a[216:219],v[248:251],v[72:75]
ds_read_b128 v[244:247],v17 offset:59392
v_mfma_f32_16x16x32_bf16 v[64:67],a[92:95],v[252:255],v[64:67]
v_mfma_f32_16x16x32_bf16 v[72:75],a[220:223],v[252:255],v[72:75]
ds_read_b128 v[248:251],v17 offset:61440
s_waitcnt lgkmcnt(5)
v_mfma_f32_16x16x32_bf16 v[64:67],a[96:99],v[224:227],v[64:67]
v_min3_u32 v27,v27,v224,v228
v_mfma_f32_16x16x32_bf16 v[72:75],a[224:227],v[224:227],v[72:75]
ds_read_b128 v[252:255],v17 offset:63488
v_mfma_f32_16x16x32_bf16 v[64:67],a[100:103],v[228:231],v[64:67]
s_waitcnt vmcnt(2)
v_add_u32 v22,s71,-1
v_mfma_f32_16x16x32_bf16 v[72:75],a[228:231],v[228:231],v[72:75]
s_waitcnt vmcnt(6)
s_barrier
ds_read_b64 v[44:45],v47
ds_read_b128 v[224:227],v17 offset:1024
s_waitcnt lgkmcnt(6)
v_mfma_f32_16x16x32_bf16 v[64:67],a[104:107],v[232:235],v[64:67]
v_min3_u32 v27,v27,v232,v236
v_mfma_f32_16x16x32_bf16 v[72:75],a[232:235],v[232:235],v[72:75]
ds_read_b128 v[228:231],v17 offset:3072
v_mfma_f32_16x16x32_bf16 v[64:67],a[108:111],v[236:239],v[64:67]
buffer_store_dword v22,v23,s[20:23],s97 offen sc1
s_waitcnt vmcnt(1)
v_mfma_f32_16x16x32_bf16 v[72:75],a[236:239],v[236:239],v[72:75]
ds_read_b128 v[232:235],v17 offset:5120
s_waitcnt lgkmcnt(6)
v_mfma_f32_16x16x32_bf16 v[64:67],a[112:115],v[240:243],v[64:67]
v_min3_u32 v27,v27,v240,v244
s_mov_b32 s97,0x7fff0000
v_mfma_f32_16x16x32_bf16 v[72:75],a[240:243],v[240:243],v[72:75]
ds_read_b128 v[236:239],v17 offset:7168
ds_read_b64 v[120:121],v40 offset:0
v_mfma_f32_16x16x32_bf16 v[64:67],a[116:119],v[244:247],v[64:67]
ds_read_b64 v[122:123],v41 offset:0
ds_read_b64 v[124:125],v40 offset:1024
v_mfma_f32_16x16x32_bf16 v[72:75],a[244:247],v[244:247],v[72:75]
ds_read_b128 v[240:243],v17 offset:9216
s_waitcnt lgkmcnt(9)
v_mfma_f32_16x16x32_bf16 v[64:67],a[120:123],v[248:251],v[64:67]
s_waitcnt lgkmcnt(8)
v_readfirstlane_b32 s93,v45
v_mfma_f32_16x16x32_bf16 v[72:75],a[248:251],v[248:251],v[72:75]
ds_read_b128 v[244:247],v17 offset:11264
v_readfirstlane_b32 s83,v44
s_cmp_lg_u32 s83,0
s_cbranch_scc1 keep_251
v_mfma_f32_16x16x32_bf16 v[64:67],a[124:127],v[252:255],v[64:67]
v_min3_u32 v27,v27,v248,v252
ds_read_b64 v[126:127],v41 offset:1024
v_mfma_f32_16x16x32_bf16 v[72:75],a[252:255],v[252:255],v[72:75]
ds_read_b128 v[248:251],v17 offset:13312
s_waitcnt lgkmcnt(9)
v_mfma_f32_16x16x32_bf16 v[68:71],a[0:3],v[224:227],0
s_xor_b32 m0,s72,0
s_add_u32 s65,s88,0
v_min3_u32 v27,v27,v224,v228
v_mfma_f32_16x16x32_bf16 v[76:79],a[128:131],v[224:227],0
ds_read_b128 v[252:255],v17 offset:15360
v_cmp_eq_u32 vcc,0,v27
s_cbranch_vccnz retry_239
v_mfma_f32_16x16x32_bf16 v[68:71],a[4:7],v[228:231],v[68:71]
buffer_load_dwordx4 v16,s[20:23],s65 offen offset:0 sc1 lds
v_mfma_f32_16x16x32_bf16 v[76:79],a[132:135],v[228:231],v[76:79]
ds_read_b128 v[224:227],v17 offset:17408
s_waitcnt lgkmcnt(9)
v_mfma_f32_16x16x32_bf16 v[68:71],a[8:11],v[232:235],v[68:71]
buffer_load_dwordx4 v16,s[20:23],s65 offen offset:2048 sc1 lds
s_waitcnt lgkmcnt(3)
v_lshlrev_b32 v88,16,v120
v_mfma_f32_16x16x32_bf16 v[76:79],a[136:139],v[232:235],v[76:79]
ds_read_b128 v[228:231],v17 offset:19456
s_xor_b32 m0,s72,16384
v_and_b32 v89,s80,v120
v_lshlrev_b32 v90,16,v121
v_mfma_f32_16x16x32_bf16 v[68:71],a[12:15],v[236:239],v[68:71]
s_add_u32 s65,s88,32768
v_min3_u32 v27,v27,v232,v236
v_and_b32 v91,s80,v121
v_lshlrev_b32 v92,16,v122
v_mfma_f32_16x16x32_bf16 v[76:79],a[140:143],v[236:239],v[76:79]
ds_read_b128 v[232:235],v17 offset:21504
v_and_b32 v93,s80,v122
v_lshlrev_b32 v94,16,v123
v_mfma_f32_16x16x32_bf16 v[68:71],a[16:19],v[240:243],v[68:71]
buffer_load_dwordx4 v16,s[20:23],s65 offen offset:0 sc1 lds
v_and_b32 v95,s80,v123
v_add_f32 v88,v64,v88
v_mfma_f32_16x16x32_bf16 v[76:79],a[144:147],v[240:243],v[76:79]
ds_read_b128 v[236:239],v17 offset:23552
v_min3_u32 v27,v27,v240,v244
v_add_f32 v89,v65,v89
v_add_f32 v90,v66,v90
v_mfma_f32_16x16x32_bf16 v[68:71],a[20:23],v[244:247],v[68:71]
buffer_load_dwordx4 v16,s[20:23],s65 offen offset:2048 sc1 lds
v_add_f32 v91,v67,v91
v_add_f32 v92,v72,v92
v_mfma_f32_16x16x32_bf16 v[76:79],a[148:151],v[244:247],v[76:79]
ds_read_b128 v[240:243],v17 offset:25600
v_add_f32 v93,v73,v93
v_add_f32 v94,v74,v94
s_waitcnt lgkmcnt(5)
v_mfma_f32_16x16x32_bf16 v[68:71],a[24:27],v[248:251],v[68:71]
s_xor_b32 m0,s72,32768
s_add_u32 s65,s88,65536
v_add_f32 v95,v75,v95
v_cvt_pk_bf16_f32 v96,v88,v89
v_mfma_f32_16x16x32_bf16 v[76:79],a[152:155],v[248:251],v[76:79]
ds_read_b128 v[244:247],v17 offset:27648
v_min3_u32 v27,v27,v248,v252
v_cvt_pk_bf16_f32 v97,v90,v91
v_cvt_pk_bf16_f32 v98,v92,v93
v_mfma_f32_16x16x32_bf16 v[68:71],a[28:31],v[252:255],v[68:71]
buffer_load_dwordx4 v16,s[20:23],s65 offen offset:0 sc1 lds
v_cvt_pk_bf16_f32 v99,v94,v95
v_max_u32 v96,1,v96
v_mfma_f32_16x16x32_bf16 v[76:79],a[156:159],v[252:255],v[76:79]
ds_read_b128 v[248:251],v17 offset:29696
buffer_store_dwordx4 v[96:99],v18,s[20:23],s70 offen offset:0 sc1
s_waitcnt lgkmcnt(5)
v_mfma_f32_16x16x32_bf16 v[68:71],a[32:35],v[224:227],v[68:71]
buffer_load_dwordx4 v16,s[20:23],s65 offen offset:2048 sc1 lds
v_lshlrev_b32 v88,16,v96
v_and_b32 v89,s80,v96
v_mfma_f32_16x16x32_bf16 v[76:79],a[160:163],v[224:227],v[76:79]
ds_read_b128 v[252:255],v17 offset:31744
s_xor_b32 m0,s72,49152
v_lshlrev_b32 v90,16,v97
v_and_b32 v91,s80,v97
v_mfma_f32_16x16x32_bf16 v[68:71],a[36:39],v[228:231],v[68:71]
v_min3_u32 v27,v27,v224,v228
v_lshlrev_b32 v92,16,v98
v_and_b32 v93,s80,v98
v_lshlrev_b32 v94,16,v99
v_mfma_f32_16x16x32_bf16 v[76:79],a[164:167],v[228:231],v[76:79]
ds_read_b128 v[224:227],v17 offset:33792
v_and_b32 v95,s80,v99
v_add_f32 v108,v88,v89
s_waitcnt lgkmcnt(5)
v_mfma_f32_16x16x32_bf16 v[68:71],a[40:43],v[232:235],v[68:71]
s_add_u32 s65,s88,98304
v_min3_u32 v27,v27,v232,v236
v_mul_f32 v109,v88,v88
v_add_f32 v100,v90,v91
v_mfma_f32_16x16x32_bf16 v[76:79],a[168:171],v[232:235],v[76:79]
ds_read_b128 v[228:231],v17 offset:35840
v_mul_f32 v101,v89,v89
v_fmac_f32 v109,v90,v90
v_fmac_f32 v101,v91,v91
v_mfma_f32_16x16x32_bf16 v[68:71],a[44:47],v[236:239],v[68:71]
buffer_load_dwordx4 v16,s[20:23],s65 offen offset:0 sc1 lds
v_fmac_f32 v109,v92,v92
v_fmac_f32 v101,v93,v93
v_mfma_f32_16x16x32_bf16 v[76:79],a[172:175],v[236:239],v[76:79]
ds_read_b128 v[232:235],v17 offset:37888
v_add_f32 v108,v108,v92
v_add_f32 v100,v100,v93
s_waitcnt lgkmcnt(5)
v_mfma_f32_16x16x32_bf16 v[68:71],a[48:51],v[240:243],v[68:71]
buffer_load_dwordx4 v16,s[20:23],s65 offen offset:2048 sc1 lds
v_fmac_f32 v109,v94,v94
v_fmac_f32 v101,v95,v95
v_mfma_f32_16x16x32_bf16 v[76:79],a[176:179],v[240:243],v[76:79]
ds_read_b128 v[236:239],v17 offset:39936
s_xor_b32 m0,s72,1024
v_add_f32 v108,v108,v94
v_add_f32 v100,v100,v95
v_mfma_f32_16x16x32_bf16 v[68:71],a[52:55],v[244:247],v[68:71]
s_add_u32 s65,s89,0
v_min3_u32 v27,v27,v240,v244
v_add_f32 v108,v108,v100
v_add_f32 v109,v109,v101
v_mfma_f32_16x16x32_bf16 v[76:79],a[180:183],v[244:247],v[76:79]
ds_read_b128 v[240:243],v17 offset:41984
s_waitcnt lgkmcnt(5)
v_mfma_f32_16x16x32_bf16 v[68:71],a[56:59],v[248:251],v[68:71]
buffer_load_dwordx4 v16,s[20:23],s65 offen offset:0 sc1 lds
v_mfma_f32_16x16x32_bf16 v[76:79],a[184:187],v[248:251],v[76:79]
ds_read_b128 v[244:247],v17 offset:44032
v_min3_u32 v27,v27,v248,v252
v_mfma_f32_16x16x32_bf16 v[68:71],a[60:63],v[252:255],v[68:71]
buffer_load_dwordx4 v16,s[20:23],s65 offen offset:2048 sc1 lds
v_mfma_f32_16x16x32_bf16 v[76:79],a[188:191],v[252:255],v[76:79]
ds_read_b128 v[248:251],v17 offset:46080
s_waitcnt lgkmcnt(5)
v_mfma_f32_16x16x32_bf16 v[68:71],a[64:67],v[224:227],v[68:71]
s_xor_b32 m0,s72,17408
s_add_u32 s65,s89,32768
v_mfma_f32_16x16x32_bf16 v[76:79],a[192:195],v[224:227],v[76:79]
ds_read_b128 v[252:255],v17 offset:48128
v_min3_u32 v27,v27,v224,v228
v_mfma_f32_16x16x32_bf16 v[68:71],a[68:71],v[228:231],v[68:71]
buffer_load_dwordx4 v16,s[20:23],s65 offen offset:0 sc1 lds
v_mfma_f32_16x16x32_bf16 v[76:79],a[196:199],v[228:231],v[76:79]
ds_read_b128 v[224:227],v17 offset:50176
s_waitcnt lgkmcnt(5)
v_mfma_f32_16x16x32_bf16 v[68:71],a[72:75],v[232:235],v[68:71]
buffer_load_dwordx4 v16,s[20:23],s65 offen offset:2048 sc1 lds
v_mfma_f32_16x16x32_bf16 v[76:79],a[200:203],v[232:235],v[76:79]
ds_read_b128 v[228:231],v17 offset:52224
s_xor_b32 m0,s72,33792
v_mfma_f32_16x16x32_bf16 v[68:71],a[76:79],v[236:239],v[68:71]
s_add_u32 s65,s89,65536
v_min3_u32 v27,v27,v232,v236
v_mfma_f32_16x16x32_bf16 v[76:79],a[204:207],v[236:239],v[76:79]
ds_read_b128 v[232:235],v17 offset:54272
s_waitcnt lgkmcnt(5)
v_mfma_f32_16x16x32_bf16 v[68:71],a[80:83],v[240:243],v[68:71]
buffer_load_dwordx4 v16,s[20:23],s65 offen offset:0 sc1 lds
v_mfma_f32_16x16x32_bf16 v[76:79],a[208:211],v[240:243],v[76:79]
ds_read_b128 v[236:239],v17 offset:56320
v_min3_u32 v27,v27,v240,v244
v_mfma_f32_16x16x32_bf16 v[68:71],a[84:87],v[244:247],v[68:71]
buffer_load_dwordx4 v16,s[20:23],s65 offen offset:2048 sc1 lds
v_mfma_f32_16x16x32_bf16 v[76:79],a[212:215],v[244:247],v[76:79]
ds_read_b128 v[240:243],v17 offset:58368
s_waitcnt lgkmcnt(5)
v_mfma_f32_16x16x32_bf16 v[68:71],a[88:91],v[248:251],v[68:71]
s_xor_b32 m0,s72,50176
v_min3_u32 v27,v27,v248,v252
v_mfma_f32_16x16x32_bf16 v[76:79],a[216:219],v[248:251],v[76:79]
ds_read_b128 v[244:247],v17 offset:60416
s_add_u32 s65,s89,98304
v_mfma_f32_16x16x32_bf16 v[68:71],a[92:95],v[252:255],v[68:71]
buffer_load_dwordx4 v16,s[20:23],s65 offen offset:0 sc1 lds
v_mfma_f32_16x16x32_bf16 v[76:79],a[220:223],v[252:255],v[76:79]
ds_read_b128 v[248:251],v17 offset:62464
s_waitcnt lgkmcnt(5)
v_mfma_f32_16x16x32_bf16 v[68:71],a[96:99],v[224:227],v[68:71]
buffer_load_dwordx4 v16,s[20:23],s65 offen offset:2048 sc1 lds
v_mfma_f32_16x16x32_bf16 v[76:79],a[224:227],v[224:227],v[76:79]
ds_read_b128 v[252:255],v17 offset:64512
v_min3_u32 v27,v27,v224,v228
v_mfma_f32_16x16x32_bf16 v[68:71],a[100:103],v[228:231],v[68:71]
v_mov_b32 v100,v108
v_mov_b32 v101,v109
v_mfma_f32_16x16x32_bf16 v[76:79],a[228:231],v[228:231],v[76:79]
v_permlane16_swap_b32 v100,v108
s_waitcnt lgkmcnt(4)
v_mfma_f32_16x16x32_bf16 v[68:71],a[104:107],v[232:235],v[68:71]
v_min3_u32 v27,v27,v232,v236
v_permlane16_swap_b32 v101,v109
v_mfma_f32_16x16x32_bf16 v[76:79],a[232:235],v[232:235],v[76:79]
v_add_f32 v108,v108,v100
v_add_f32 v109,v109,v101
v_mfma_f32_16x16x32_bf16 v[68:71],a[108:111],v[236:239],v[68:71]
v_mov_b32 v100,v108
v_mov_b32 v101,v109
v_mfma_f32_16x16x32_bf16 v[76:79],a[236:239],v[236:239],v[76:79]
v_permlane32_swap_b32 v100,v108
s_waitcnt lgkmcnt(2)
v_mfma_f32_16x16x32_bf16 v[68:71],a[112:115],v[240:243],v[68:71]
v_min3_u32 v27,v27,v240,v244
v_permlane32_swap_b32 v101,v109
v_mfma_f32_16x16x32_bf16 v[76:79],a[240:243],v[240:243],v[76:79]
v_add_f32 v108,v108,v100
v_add_f32 v109,v109,v101
v_mfma_f32_16x16x32_bf16 v[68:71],a[116:119],v[244:247],v[68:71]
v_min3_u32 v27,v27,v120,v122
v_min3_u32 v27,v27,v124,v126
v_mfma_f32_16x16x32_bf16 v[76:79],a[244:247],v[244:247],v[76:79]
v_lshlrev_b32 v32,16,v124
s_waitcnt lgkmcnt(0)
v_mfma_f32_16x16x32_bf16 v[68:71],a[120:123],v[248:251],v[68:71]
v_min3_u32 v27,v27,v248,v252
v_and_b32 v33,s80,v124
v_mfma_f32_16x16x32_bf16 v[76:79],a[248:251],v[248:251],v[76:79]
v_lshlrev_b32 v34,16,v125
v_and_b32 v35,s80,v125
v_mfma_f32_16x16x32_bf16 v[68:71],a[124:127],v[252:255],v[68:71]
v_lshlrev_b32 v36,16,v126
v_and_b32 v37,s80,v126
v_mfma_f32_16x16x32_bf16 v[76:79],a[252:255],v[252:255],v[76:79]
v_lshlrev_b32 v38,16,v127
v_and_b32 v39,s80,v127
v_cmp_eq_u32 vcc,0,v27
s_cbranch_vccnz retry_239
s_branch epi_242
keep_251:
v_mfma_f32_16x16x32_bf16 v[64:67],a[124:127],v[252:255],v[64:67]
v_min3_u32 v27,v27,v248,v252
ds_read_b64 v[126:127],v41 offset:1024
v_mfma_f32_16x16x32_bf16 v[72:75],a[252:255],v[252:255],v[72:75]
ds_read_b128 v[248:251],v17 offset:13312
s_waitcnt lgkmcnt(9)
v_mfma_f32_16x16x32_bf16 v[68:71],a[0:3],v[224:227],0
v_cmp_eq_u32 vcc,0,v27
s_cbranch_vccnz retry_239
v_mfma_f32_16x16x32_bf16 v[76:79],a[128:131],v[224:227],0
ds_read_b128 v[252:255],v17 offset:15360
v_min3_u32 v27,v27,v224,v228
v_mfma_f32_16x16x32_bf16 v[68:71],a[4:7],v[228:231],v[68:71]
v_mfma_f32_16x16x32_bf16 v[76:79],a[132:135],v[228:231],v[76:79]
ds_read_b128 v[224:227],v17 offset:17408
s_waitcnt lgkmcnt(9)
v_mfma_f32_16x16x32_bf16 v[68:71],a[8:11],v[232:235],v[68:71]
v_min3_u32 v27,v27,v232,v236
s_waitcnt lgkmcnt(3)
v_lshlrev_b32 v88,16,v120
v_mfma_f32_16x16x32_bf16 v[76:79],a[136:139],v[232:235],v[76:79]
ds_read_b128 v[228:231],v17 offset:19456
v_and_b32 v89,s80,v120
v_lshlrev_b32 v90,16,v121
v_mfma_f32_16x16x32_bf16 v[68:71],a[12:15],v[236:239],v[68:71]
v_and_b32 v91,s80,v121
v_lshlrev_b32 v92,16,v122
v_and_b32 v93,s80,v122
v_mfma_f32_16x16x32_bf16 v[76:79],a[140:143],v[236:239],v[76:79]
ds_read_b128 v[232:235],v17 offset:21504
v_lshlrev_b32 v94,16,v123
v_mfma_f32_16x16x32_bf16 v[68:71],a[16:19],v[240:243],v[68:71]
v_min3_u32 v27,v27,v240,v244
v_and_b32 v95,s80,v123
v_mfma_f32_16x16x32_bf16 v[76:79],a[144:147],v[240:243],v[76:79]
ds_read_b128 v[236:239],v17 offset:23552
v_add_f32 v88,v64,v88
v_mfma_f32_16x16x32_bf16 v[68:71],a[20:23],v[244:247],v[68:71]
v_add_f32 v89,v65,v89
v_add_f32 v90,v66,v90
v_mfma_f32_16x16x32_bf16 v[76:79],a[148:151],v[244:247],v[76:79]
ds_read_b128 v[240:243],v17 offset:25600
s_waitcnt lgkmcnt(5)
v_mfma_f32_16x16x32_bf16 v[68:71],a[24:27],v[248:251],v[68:71]
v_min3_u32 v27,v27,v248,v252
v_add_f32 v91,v67,v91
v_mfma_f32_16x16x32_bf16 v[76:79],a[152:155],v[248:251],v[76:79]
ds_read_b128 v[244:247],v17 offset:27648
v_add_f32 v92,v72,v92
v_mfma_f32_16x16x32_bf16 v[68:71],a[28:31],v[252:255],v[68:71]
v_add_f32 v93,v73,v93
v_add_f32 v94,v74,v94
v_mfma_f32_16x16x32_bf16 v[76:79],a[156:159],v[252:255],v[76:79]
ds_read_b128 v[248:251],v17 offset:29696
s_waitcnt lgkmcnt(5)
v_mfma_f32_16x16x32_bf16 v[68:71],a[32:35],v[224:227],v[68:71]
v_min3_u32 v27,v27,v224,v228
v_add_f32 v95,v75,v95
v_mfma_f32_16x16x32_bf16 v[76:79],a[160:163],v[224:227],v[76:79]
ds_read_b128 v[252:255],v17 offset:31744
v_cvt_pk_bf16_f32 v96,v88,v89
v_mfma_f32_16x16x32_bf16 v[68:71],a[36:39],v[228:231],v[68:71]
v_cvt_pk_bf16_f32 v97,v90,v91
v_cvt_pk_bf16_f32 v98,v92,v93
v_mfma_f32_16x16x32_bf16 v[76:79],a[164:167],v[228:231],v[76:79]
ds_read_b128 v[224:227],v17 offset:33792
s_waitcnt lgkmcnt(5)
v_mfma_f32_16x16x32_bf16 v[68:71],a[40:43],v[232:235],v[68:71]
v_min3_u32 v27,v27,v232,v236
v_cvt_pk_bf16_f32 v99,v94,v95
v_mfma_f32_16x16x32_bf16 v[76:79],a[168:171],v[232:235],v[76:79]
ds_read_b128 v[228:231],v17 offset:35840
v_max_u32 v96,1,v96
v_mfma_f32_16x16x32_bf16 v[68:71],a[44:47],v[236:239],v[68:71]
buffer_store_dwordx4 v[96:99],v18,s[20:23],s70 offen offset:0 sc1
v_mfma_f32_16x16x32_bf16 v[76:79],a[172:175],v[236:239],v[76:79]
ds_read_b128 v[232:235],v17 offset:37888
s_waitcnt lgkmcnt(5)
v_mfma_f32_16x16x32_bf16 v[68:71],a[48:51],v[240:243],v[68:71]
v_min3_u32 v27,v27,v240,v244
v_lshlrev_b32 v88,16,v96
v_mfma_f32_16x16x32_bf16 v[76:79],a[176:179],v[240:243],v[76:79]
ds_read_b128 v[236:239],v17 offset:39936
v_and_b32 v89,s80,v96
v_mfma_f32_16x16x32_bf16 v[68:71],a[52:55],v[244:247],v[68:71]
v_lshlrev_b32 v90,16,v97
v_and_b32 v91,s80,v97
v_mfma_f32_16x16x32_bf16 v[76:79],a[180:183],v[244:247],v[76:79]
ds_read_b128 v[240:243],v17 offset:41984
s_waitcnt lgkmcnt(5)
v_mfma_f32_16x16x32_bf16 v[68:71],a[56:59],v[248:251],v[68:71]
v_min3_u32 v27,v27,v248,v252
v_lshlrev_b32 v92,16,v98
v_mfma_f32_16x16x32_bf16 v[76:79],a[184:187],v[248:251],v[76:79]
ds_read_b128 v[244:247],v17 offset:44032
v_and_b32 v93,s80,v98
v_mfma_f32_16x16x32_bf16 v[68:71],a[60:63],v[252:255],v[68:71]
v_lshlrev_b32 v94,16,v99
v_and_b32 v95,s80,v99
v_mfma_f32_16x16x32_bf16 v[76:79],a[188:191],v[252:255],v[76:79]
ds_read_b128 v[248:251],v17 offset:46080
s_waitcnt lgkmcnt(5)
v_mfma_f32_16x16x32_bf16 v[68:71],a[64:67],v[224:227],v[68:71]
v_min3_u32 v27,v27,v224,v228
v_add_f32 v108,v88,v89
v_mfma_f32_16x16x32_bf16 v[76:79],a[192:195],v[224:227],v[76:79]
ds_read_b128 v[252:255],v17 offset:48128
v_mul_f32 v109,v88,v88
v_mfma_f32_16x16x32_bf16 v[68:71],a[68:71],v[228:231],v[68:71]
v_add_f32 v100,v90,v91
v_mul_f32 v101,v89,v89
v_mfma_f32_16x16x32_bf16 v[76:79],a[196:199],v[228:231],v[76:79]
ds_read_b128 v[224:227],v17 offset:50176
s_waitcnt lgkmcnt(5)
v_mfma_f32_16x16x32_bf16 v[68:71],a[72:75],v[232:235],v[68:71]
v_min3_u32 v27,v27,v232,v236
v_fmac_f32 v109,v90,v90
v_mfma_f32_16x16x32_bf16 v[76:79],a[200:203],v[232:235],v[76:79]
ds_read_b128 v[228:231],v17 offset:52224
v_fmac_f32 v101,v91,v91
v_mfma_f32_16x16x32_bf16 v[68:71],a[76:79],v[236:239],v[68:71]
v_fmac_f32 v109,v92,v92
v_fmac_f32 v101,v93,v93
v_mfma_f32_16x16x32_bf16 v[76:79],a[204:207],v[236:239],v[76:79]
ds_read_b128 v[232:235],v17 offset:54272
s_waitcnt lgkmcnt(5)
v_mfma_f32_16x16x32_bf16 v[68:71],a[80:83],v[240:243],v[68:71]
v_min3_u32 v27,v27,v240,v244
v_add_f32 v108,v108,v92
v_mfma_f32_16x16x32_bf16 v[76:79],a[208:211],v[240:243],v[76:79]
ds_read_b128 v[236:239],v17 offset:56320
v_add_f32 v100,v100,v93
v_mfma_f32_16x16x32_bf16 v[68:71],a[84:87],v[244:247],v[68:71]
v_fmac_f32 v109,v94,v94
v_fmac_f32 v101,v95,v95
v_mfma_f32_16x16x32_bf16 v[76:79],a[212:215],v[244:247],v[76:79]
ds_read_b128 v[240:243],v17 offset:58368
s_waitcnt lgkmcnt(5)
v_mfma_f32_16x16x32_bf16 v[68:71],a[88:91],v[248:251],v[68:71]
v_min3_u32 v27,v27,v248,v252
v_add_f32 v108,v108,v94
v_mfma_f32_16x16x32_bf16 v[76:79],a[216:219],v[248:251],v[76:79]
ds_read_b128 v[244:247],v17 offset:60416
v_add_f32 v100,v100,v95
v_mfma_f32_16x16x32_bf16 v[68:71],a[92:95],v[252:255],v[68:71]
v_add_f32 v108,v108,v100
v_add_f32 v109,v109,v101
v_mfma_f32_16x16x32_bf16 v[76:79],a[220:223],v[252:255],v[76:79]
ds_read_b128 v[248:251],v17 offset:62464
s_waitcnt lgkmcnt(5)
v_mfma_f32_16x16x32_bf16 v[68:71],a[96:99],v[224:227],v[68:71]
v_min3_u32 v27,v27,v224,v228
v_mov_b32 v100,v108
v_mfma_f32_16x16x32_bf16 v[76:79],a[224:227],v[224:227],v[76:79]
ds_read_b128 v[252:255],v17 offset:64512
v_mov_b32 v101,v109
v_mfma_f32_16x16x32_bf16 v[68:71],a[100:103],v[228:231],v[68:71]
v_permlane16_swap_b32 v100,v108
v_permlane16_swap_b32 v101,v109
v_mfma_f32_16x16x32_bf16 v[76:79],a[228:231],v[228:231],v[76:79]
v_add_f32 v108,v108,v100
s_waitcnt lgkmcnt(4)
v_mfma_f32_16x16x32_bf16 v[68:71],a[104:107],v[232:235],v[68:71]
v_min3_u32 v27,v27,v232,v236
v_add_f32 v109,v109,v101
v_mfma_f32_16x16x32_bf16 v[76:79],a[232:235],v[232:235],v[76:79]
v_mov_b32 v100,v108
v_mov_b32 v101,v109
v_mfma_f32_16x16x32_bf16 v[68:71],a[108:111],v[236:239],v[68:71]
v_permlane32_swap_b32 v100,v108
v_permlane32_swap_b32 v101,v109
v_mfma_f32_16x16x32_bf16 v[76:79],a[236:239],v[236:239],v[76:79]
v_add_f32 v108,v108,v100
s_waitcnt lgkmcnt(2)
v_mfma_f32_16x16x32_bf16 v[68:71],a[112:115],v[240:243],v[68:71]
v_min3_u32 v27,v27,v240,v244
v_add_f32 v109,v109,v101
v_mfma_f32_16x16x32_bf16 v[76:79],a[240:243],v[240:243],v[76:79]
v_min3_u32 v27,v27,v120,v122
v_min3_u32 v27,v27,v124,v126
v_mfma_f32_16x16x32_bf16 v[68:71],a[116:119],v[244:247],v[68:71]
v_lshlrev_b32 v32,16,v124
v_and_b32 v33,s80,v124
v_mfma_f32_16x16x32_bf16 v[76:79],a[244:247],v[244:247],v[76:79]
v_lshlrev_b32 v34,16,v125
s_waitcnt lgkmcnt(0)
v_mfma_f32_16x16x32_bf16 v[68:71],a[120:123],v[248:251],v[68:71]
v_min3_u32 v27,v27,v248,v252
v_and_b32 v35,s80,v125
v_mfma_f32_16x16x32_bf16 v[76:79],a[248:251],v[248:251],v[76:79]
v_lshlrev_b32 v36,16,v126
v_and_b32 v37,s80,v126
v_mfma_f32_16x16x32_bf16 v[68:71],a[124:127],v[252:255],v[68:71]
v_lshlrev_b32 v38,16,v127
v_and_b32 v39,s80,v127
v_mfma_f32_16x16x32_bf16 v[76:79],a[252:255],v[252:255],v[76:79]
v_cmp_eq_u32 vcc,0,v27
s_cbranch_vccnz retry_239
s_branch epi_242
both_243:
s_waitcnt vmcnt(12) lgkmcnt(0)
s_barrier
ds_read_b128 v[224:227],v17 offset:0
ds_read_b128 v[228:231],v17 offset:2048
ds_read_b128 v[232:235],v17 offset:4096
ds_read_b128 v[236:239],v17 offset:6144
ds_read_b128 v[240:243],v17 offset:8192
ds_read_b128 v[244:247],v17 offset:10240
ds_read_b128 v[248:251],v17 offset:12288
s_waitcnt lgkmcnt(5)
v_mfma_f32_16x16x32_bf16 v[64:67],a[0:3],v[224:227],0
s_add_u32 s96,s71,1
s_add_u32 s92,s71,2
s_add_u32 s88,s70,s75
v_min_u32 v27,v224,v228
s_add_u32 m0,s43,0
v_mfma_f32_16x16x32_bf16 v[72:75],a[128:131],v[224:227],0
ds_read_b128 v[252:255],v17 offset:14336
s_cmp_eq_u32 s96,64
s_cselect_b32 s96,99,s96
buffer_load_dwordx4 v19,s[20:23],s78 offen sc1 lds
v_mfma_f32_16x16x32_bf16 v[64:67],a[4:7],v[228:231],v[64:67]
s_cmp_eq_u32 s92,64
s_cselect_b32 s92,99,s92
s_add_u32 s88,s88,2097152
s_add_u32 m0,s43,1024
v_mfma_f32_16x16x32_bf16 v[72:75],a[132:135],v[228:231],v[72:75]
ds_read_b128 v[224:227],v17 offset:16384
s_xor_b32 s88,s88,0x2000
buffer_load_dwordx4 v20,s[20:23],s78 offen sc1 lds
s_waitcnt lgkmcnt(5)
v_mfma_f32_16x16x32_bf16 v[64:67],a[8:11],v[232:235],v[64:67]
s_cmp_eq_u32 s96,65
s_cselect_b32 s96,64,s96
v_mfma_f32_16x16x32_bf16 v[72:75],a[136:139],v[232:235],v[72:75]
ds_read_b128 v[228:231],v17 offset:18432
s_xor_b32 s89,s88,1024
v_mfma_f32_16x16x32_bf16 v[64:67],a[12:15],v[236:239],v[64:67]
s_xor_b32 m0,s72,0
v_min3_u32 v27,v27,v232,v236
v_mfma_f32_16x16x32_bf16 v[72:75],a[140:143],v[236:239],v[72:75]
ds_read_b128 v[232:235],v17 offset:20480
s_add_u32 s65,s88,0
s_waitcnt lgkmcnt(5)
v_mfma_f32_16x16x32_bf16 v[64:67],a[16:19],v[240:243],v[64:67]
v_min3_u32 v27,v27,v240,v244
v_mfma_f32_16x16x32_bf16 v[72:75],a[144:147],v[240:243],v[72:75]
ds_read_b128 v[236:239],v17 offset:22528
buffer_load_dwordx4 v16,s[20:23],s65 offen offset:0 sc1 lds
v_mfma_f32_16x16x32_bf16 v[64:67],a[20:23],v[244:247],v[64:67]
buffer_load_dwordx4 v16,s[20:23],s65 offen offset:2048 sc1 lds
v_mfma_f32_16x16x32_bf16 v[72:75],a[148:151],v[244:247],v[72:75]
ds_read_b128 v[240:243],v17 offset:24576
s_waitcnt lgkmcnt(5)
v_mfma_f32_16x16x32_bf16 v[64:67],a[24:27],v[248:251],v[64:67]
s_xor_b32 m0,s72,16384
v_min3_u32 v27,v27,v248,v252
v_mfma_f32_16x16x32_bf16 v[72:75],a[152:155],v[248:251],v[72:75]
ds_read_b128 v[244:247],v17 offset:26624
v_mfma_f32_16x16x32_bf16 v[64:67],a[28:31],v[252:255],v[64:67]
s_add_u32 s65,s88,32768
v_mfma_f32_16x16x32_bf16 v[72:75],a[156:159],v[252:255],v[72:75]
ds_read_b128 v[248:251],v17 offset:28672
s_waitcnt lgkmcnt(5)
v_mfma_f32_16x16x32_bf16 v[64:67],a[32:35],v[224:227],v[64:67]
buffer_load_dwordx4 v16,s[20:23],s65 offen offset:0 sc1 lds
v_mfma_f32_16x16x32_bf16 v[72:75],a[160:163],v[224:227],v[72:75]
ds_read_b128 v[252:255],v17 offset:30720
buffer_load_dwordx4 v16,s[20:23],s65 offen offset:2048 sc1 lds
v_mfma_f32_16x16x32_bf16 v[64:67],a[36:39],v[228:231],v[64:67]
v_min3_u32 v27,v27,v224,v228
v_mfma_f32_16x16x32_bf16 v[72:75],a[164:167],v[228:231],v[72:75]
ds_read_b128 v[224:227],v17 offset:32768
s_xor_b32 m0,s72,32768
s_waitcnt lgkmcnt(5)
v_mfma_f32_16x16x32_bf16 v[64:67],a[40:43],v[232:235],v[64:67]
s_add_u32 s65,s88,65536
v_min3_u32 v27,v27,v232,v236
v_mfma_f32_16x16x32_bf16 v[72:75],a[168:171],v[232:235],v[72:75]
ds_read_b128 v[228:231],v17 offset:34816
v_mfma_f32_16x16x32_bf16 v[64:67],a[44:47],v[236:239],v[64:67]
buffer_load_dwordx4 v16,s[20:23],s65 offen offset:0 sc1 lds
v_mfma_f32_16x16x32_bf16 v[72:75],a[172:175],v[236:239],v[72:75]
ds_read_b128 v[232:235],v17 offset:36864
s_waitcnt lgkmcnt(5)
v_mfma_f32_16x16x32_bf16 v[64:67],a[48:51],v[240:243],v[64:67]
buffer_load_dwordx4 v16,s[20:23],s65 offen offset:2048 sc1 lds
v_mfma_f32_16x16x32_bf16 v[72:75],a[176:179],v[240:243],v[72:75]
ds_read_b128 v[236:239],v17 offset:38912
s_xor_b32 m0,s72,49152
v_mfma_f32_16x16x32_bf16 v[64:67],a[52:55],v[244:247],v[64:67]
v_min3_u32 v27,v27,v240,v244
v_mfma_f32_16x16x32_bf16 v[72:75],a[180:183],v[244:247],v[72:75]
ds_read_b128 v[240:243],v17 offset:40960
s_add_u32 s65,s88,98304
s_waitcnt lgkmcnt(5)
v_mfma_f32_16x16x32_bf16 v[64:67],a[56:59],v[248:251],v[64:67]
buffer_load_dwordx4 v16,s[20:23],s65 offen offset:0 sc1 lds
v_min3_u32 v27,v27,v248,v252
v_mfma_f32_16x16x32_bf16 v[72:75],a[184:187],v[248:251],v[72:75]
ds_read_b128 v[244:247],v17 offset:43008
s_waitcnt vmcnt(12)
v_mfma_f32_16x16x32_bf16 v[64:67],a[60:63],v[252:255],v[64:67]
v_cmp_gt_u32 vcc,s96,v29
v_cmp_gt_u32 s[92:93],s92,v29
v_mfma_f32_16x16x32_bf16 v[72:75],a[188:191],v[252:255],v[72:75]
ds_read_b128 v[248:251],v17 offset:45056
s_waitcnt lgkmcnt(5)
v_mfma_f32_16x16x32_bf16 v[64:67],a[64:67],v[224:227],v[64:67]
v_mov_b32 v44,vcc_lo
v_mov_b32 v45,s92
v_min3_u32 v27,v27,v224,v228
v_mfma_f32_16x16x32_bf16 v[72:75],a[192:195],v[224:227],v[72:75]
ds_read_b128 v[252:255],v17 offset:47104
ds_write_b64 v46,v[44:45]
v_mfma_f32_16x16x32_bf16 v[64:67],a[68:71],v[228:231],v[64:67]
buffer_load_dwordx4 v16,s[20:23],s65 offen offset:2048 sc1 lds
v_mfma_f32_16x16x32_bf16 v[72:75],a[196:199],v[228:231],v[72:75]
ds_read_b128 v[224:227],v17 offset:49152
s_waitcnt lgkmcnt(6)
v_mfma_f32_16x16x32_bf16 v[64:67],a[72:75],v[232:235],v[64:67]
s_xor_b32 m0,s72,1024
s_add_u32 s65,s89,0
v_mfma_f32_16x16x32_bf16 v[72:75],a[200:203],v[232:235],v[72:75]
ds_read_b128 v[228:231],v17 offset:51200
v_min3_u32 v27,v27,v232,v236
v_mfma_f32_16x16x32_bf16 v[64:67],a[76:79],v[236:239],v[64:67]
buffer_load_dwordx4 v16,s[20:23],s65 offen offset:0 sc1 lds
v_mfma_f32_16x16x32_bf16 v[72:75],a[204:207],v[236:239],v[72:75]
ds_read_b128 v[232:235],v17 offset:53248
s_waitcnt lgkmcnt(6)
v_mfma_f32_16x16x32_bf16 v[64:67],a[80:83],v[240:243],v[64:67]
buffer_load_dwordx4 v16,s[20:23],s65 offen offset:2048 sc1 lds
v_mfma_f32_16x16x32_bf16 v[72:75],a[208:211],v[240:243],v[72:75]
ds_read_b128 v[236:239],v17 offset:55296
s_xor_b32 m0,s72,17408
v_mfma_f32_16x16x32_bf16 v[64:67],a[84:87],v[244:247],v[64:67]
s_add_u32 s65,s89,32768
v_min3_u32 v27,v27,v240,v244
v_mfma_f32_16x16x32_bf16 v[72:75],a[212:215],v[244:247],v[72:75]
ds_read_b128 v[240:243],v17 offset:57344
s_waitcnt lgkmcnt(6)
v_mfma_f32_16x16x32_bf16 v[64:67],a[88:91],v[248:251],v[64:67]
buffer_load_dwordx4 v16,s[20:23],s65 offen offset:0 sc1 lds
v_mfma_f32_16x16x32_bf16 v[72:75],a[216:219],v[248:251],v[72:75]
ds_read_b128 v[244:247],v17 offset:59392
v_min3_u32 v27,v27,v248,v252
v_mfma_f32_16x16x32_bf16 v[64:67],a[92:95],v[252:255],v[64:67]
buffer_load_dwordx4 v16,s[20:23],s65 offen offset:2048 sc1 lds
v_mfma_f32_16x16x32_bf16 v[72:75],a[220:223],v[252:255],v[72:75]
ds_read_b128 v[248:251],v17 offset:61440
s_waitcnt lgkmcnt(5)
v_mfma_f32_16x16x32_bf16 v[64:67],a[96:99],v[224:227],v[64:67]
s_xor_b32 m0,s72,33792
s_add_u32 s65,s89,65536
v_mfma_f32_16x16x32_bf16 v[72:75],a[224:227],v[224:227],v[72:75]
ds_read_b128 v[252:255],v17 offset:63488
v_min3_u32 v27,v27,v224,v228
v_mfma_f32_16x16x32_bf16 v[64:67],a[100:103],v[228:231],v[64:67]
buffer_load_dwordx4 v16,s[20:23],s65 offen offset:0 sc1 lds
s_waitcnt vmcnt(15)
v_add_u32 v22,s71,-1
v_mfma_f32_16x16x32_bf16 v[72:75],a[228:231],v[228:231],v[72:75]
s_waitcnt vmcnt(19)
s_barrier
ds_read_b64 v[44:45],v47
ds_read_b128 v[224:227],v17 offset:1024
s_waitcnt lgkmcnt(6)
v_mfma_f32_16x16x32_bf16 v[64:67],a[104:107],v[232:235],v[64:67]
buffer_load_dwordx4 v16,s[20:23],s65 offen offset:2048 sc1 lds
buffer_store_dword v22,v23,s[20:23],s97 offen sc1
v_mfma_f32_16x16x32_bf16 v[72:75],a[232:235],v[232:235],v[72:75]
ds_read_b128 v[228:231],v17 offset:3072
s_xor_b32 m0,s72,50176
s_mov_b32 s97,0x7fff0000
v_mfma_f32_16x16x32_bf16 v[64:67],a[108:111],v[236:239],v[64:67]
s_add_u32 s65,s89,98304
v_min3_u32 v27,v27,v232,v236
s_waitcnt vmcnt(15)
v_mfma_f32_16x16x32_bf16 v[72:75],a[236:239],v[236:239],v[72:75]
ds_read_b128 v[232:235],v17 offset:5120
ds_read_b64 v[120:121],v40 offset:0
s_waitcnt lgkmcnt(7)
v_mfma_f32_16x16x32_bf16 v[64:67],a[112:115],v[240:243],v[64:67]
buffer_load_dwordx4 v16,s[20:23],s65 offen offset:0 sc1 lds
ds_read_b64 v[122:123],v41 offset:0
v_mfma_f32_16x16x32_bf16 v[72:75],a[240:243],v[240:243],v[72:75]
ds_read_b128 v[236:239],v17 offset:7168
v_min3_u32 v27,v27,v240,v244
v_mfma_f32_16x16x32_bf16 v[64:67],a[116:119],v[244:247],v[64:67]
buffer_load_dwordx4 v16,s[20:23],s65 offen offset:2048 sc1 lds
v_mfma_f32_16x16x32_bf16 v[72:75],a[244:247],v[244:247],v[72:75]
ds_read_b128 v[240:243],v17 offset:9216
s_waitcnt lgkmcnt(8)
v_mfma_f32_16x16x32_bf16 v[64:67],a[120:123],v[248:251],v[64:67]
s_waitcnt lgkmcnt(7)
v_readfirstlane_b32 s93,v45
v_mfma_f32_16x16x32_bf16 v[72:75],a[248:251],v[248:251],v[72:75]
ds_read_b128 v[244:247],v17 offset:11264
v_min3_u32 v27,v27,v248,v252
v_mfma_f32_16x16x32_bf16 v[64:67],a[124:127],v[252:255],v[64:67]
ds_read_b64 v[124:125],v40 offset:1024
ds_read_b64 v[126:127],v41 offset:1024
v_mfma_f32_16x16x32_bf16 v[72:75],a[252:255],v[252:255],v[72:75]
ds_read_b128 v[248:251],v17 offset:13312
s_waitcnt lgkmcnt(9)
v_mfma_f32_16x16x32_bf16 v[68:71],a[0:3],v[224:227],0
v_cmp_eq_u32 vcc,0,v27
s_cbranch_vccnz retry_239
v_mfma_f32_16x16x32_bf16 v[76:79],a[128:131],v[224:227],0
ds_read_b128 v[252:255],v17 offset:15360
v_min3_u32 v27,v27,v224,v228
v_mfma_f32_16x16x32_bf16 v[68:71],a[4:7],v[228:231],v[68:71]
v_mfma_f32_16x16x32_bf16 v[76:79],a[132:135],v[228:231],v[76:79]
ds_read_b128 v[224:227],v17 offset:17408
s_waitcnt lgkmcnt(7)
v_mfma_f32_16x16x32_bf16 v[68:71],a[8:11],v[232:235],v[68:71]
v_min3_u32 v27,v27,v232,v236
s_waitcnt lgkmcnt(3)
v_lshlrev_b32 v88,16,v120
v_mfma_f32_16x16x32_bf16 v[76:79],a[136:139],v[232:235],v[76:79]
ds_read_b128 v[228:231],v17 offset:19456
v_and_b32 v89,s80,v120
v_lshlrev_b32 v90,16,v121
v_mfma_f32_16x16x32_bf16 v[68:71],a[12:15],v[236:239],v[68:71]
v_and_b32 v91,s80,v121
v_lshlrev_b32 v92,16,v122
v_and_b32 v93,s80,v122
v_mfma_f32_16x16x32_bf16 v[76:79],a[140:143],v[236:239],v[76:79]
ds_read_b128 v[232:235],v17 offset:21504
v_lshlrev_b32 v94,16,v123
v_mfma_f32_16x16x32_bf16 v[68:71],a[16:19],v[240:243],v[68:71]
v_min3_u32 v27,v27,v240,v244
v_and_b32 v95,s80,v123
v_mfma_f32_16x16x32_bf16 v[76:79],a[144:147],v[240:243],v[76:79]
ds_read_b128 v[236:239],v17 offset:23552
v_add_f32 v88,v64,v88
v_mfma_f32_16x16x32_bf16 v[68:71],a[20:23],v[244:247],v[68:71]
v_add_f32 v89,v65,v89
v_add_f32 v90,v66,v90
v_mfma_f32_16x16x32_bf16 v[76:79],a[148:151],v[244:247],v[76:79]
ds_read_b128 v[240:243],v17 offset:25600
s_waitcnt lgkmcnt(5)
v_mfma_f32_16x16x32_bf16 v[68:71],a[24:27],v[248:251],v[68:71]
v_min3_u32 v27,v27,v248,v252
v_add_f32 v91,v67,v91
v_mfma_f32_16x16x32_bf16 v[76:79],a[152:155],v[248:251],v[76:79]
ds_read_b128 v[244:247],v17 offset:27648
v_add_f32 v92,v72,v92
v_mfma_f32_16x16x32_bf16 v[68:71],a[28:31],v[252:255],v[68:71]
v_add_f32 v93,v73,v93
v_add_f32 v94,v74,v94
v_mfma_f32_16x16x32_bf16 v[76:79],a[156:159],v[252:255],v[76:79]
ds_read_b128 v[248:251],v17 offset:29696
s_waitcnt lgkmcnt(5)
v_mfma_f32_16x16x32_bf16 v[68:71],a[32:35],v[224:227],v[68:71]
v_min3_u32 v27,v27,v224,v228
v_add_f32 v95,v75,v95
v_mfma_f32_16x16x32_bf16 v[76:79],a[160:163],v[224:227],v[76:79]
ds_read_b128 v[252:255],v17 offset:31744
v_cvt_pk_bf16_f32 v96,v88,v89
v_mfma_f32_16x16x32_bf16 v[68:71],a[36:39],v[228:231],v[68:71]
v_cvt_pk_bf16_f32 v97,v90,v91
v_cvt_pk_bf16_f32 v98,v92,v93
v_mfma_f32_16x16x32_bf16 v[76:79],a[164:167],v[228:231],v[76:79]
ds_read_b128 v[224:227],v17 offset:33792
s_waitcnt lgkmcnt(5)
v_mfma_f32_16x16x32_bf16 v[68:71],a[40:43],v[232:235],v[68:71]
v_min3_u32 v27,v27,v232,v236
v_cvt_pk_bf16_f32 v99,v94,v95
v_mfma_f32_16x16x32_bf16 v[76:79],a[168:171],v[232:235],v[76:79]
ds_read_b128 v[228:231],v17 offset:35840
v_max_u32 v96,1,v96
v_mfma_f32_16x16x32_bf16 v[68:71],a[44:47],v[236:239],v[68:71]
buffer_store_dwordx4 v[96:99],v18,s[20:23],s70 offen offset:0 sc1
v_mfma_f32_16x16x32_bf16 v[76:79],a[172:175],v[236:239],v[76:79]
ds_read_b128 v[232:235],v17 offset:37888
s_waitcnt lgkmcnt(5)
v_mfma_f32_16x16x32_bf16 v[68:71],a[48:51],v[240:243],v[68:71]
v_min3_u32 v27,v27,v240,v244
v_lshlrev_b32 v88,16,v96
v_mfma_f32_16x16x32_bf16 v[76:79],a[176:179],v[240:243],v[76:79]
ds_read_b128 v[236:239],v17 offset:39936
v_and_b32 v89,s80,v96
v_mfma_f32_16x16x32_bf16 v[68:71],a[52:55],v[244:247],v[68:71]
v_lshlrev_b32 v90,16,v97
v_and_b32 v91,s80,v97
v_mfma_f32_16x16x32_bf16 v[76:79],a[180:183],v[244:247],v[76:79]
ds_read_b128 v[240:243],v17 offset:41984
s_waitcnt lgkmcnt(5)
v_mfma_f32_16x16x32_bf16 v[68:71],a[56:59],v[248:251],v[68:71]
v_min3_u32 v27,v27,v248,v252
v_lshlrev_b32 v92,16,v98
v_mfma_f32_16x16x32_bf16 v[76:79],a[184:187],v[248:251],v[76:79]
ds_read_b128 v[244:247],v17 offset:44032
v_and_b32 v93,s80,v98
v_mfma_f32_16x16x32_bf16 v[68:71],a[60:63],v[252:255],v[68:71]
v_lshlrev_b32 v94,16,v99
v_and_b32 v95,s80,v99
v_mfma_f32_16x16x32_bf16 v[76:79],a[188:191],v[252:255],v[76:79]
ds_read_b128 v[248:251],v17 offset:46080
s_waitcnt lgkmcnt(5)
v_mfma_f32_16x16x32_bf16 v[68:71],a[64:67],v[224:227],v[68:71]
v_min3_u32 v27,v27,v224,v228
v_add_f32 v108,v88,v89
v_mfma_f32_16x16x32_bf16 v[76:79],a[192:195],v[224:227],v[76:79]
ds_read_b128 v[252:255],v17 offset:48128
v_mul_f32 v109,v88,v88
v_mfma_f32_16x16x32_bf16 v[68:71],a[68:71],v[228:231],v[68:71]
v_add_f32 v100,v90,v91
v_mul_f32 v101,v89,v89
v_mfma_f32_16x16x32_bf16 v[76:79],a[196:199],v[228:231],v[76:79]
ds_read_b128 v[224:227],v17 offset:50176
s_waitcnt lgkmcnt(5)
v_mfma_f32_16x16x32_bf16 v[68:71],a[72:75],v[232:235],v[68:71]
v_min3_u32 v27,v27,v232,v236
v_fmac_f32 v109,v90,v90
v_mfma_f32_16x16x32_bf16 v[76:79],a[200:203],v[232:235],v[76:79]
ds_read_b128 v[228:231],v17 offset:52224
v_fmac_f32 v101,v91,v91
v_mfma_f32_16x16x32_bf16 v[68:71],a[76:79],v[236:239],v[68:71]
v_fmac_f32 v109,v92,v92
v_fmac_f32 v101,v93,v93
v_mfma_f32_16x16x32_bf16 v[76:79],a[204:207],v[236:239],v[76:79]
ds_read_b128 v[232:235],v17 offset:54272
s_waitcnt lgkmcnt(5)
v_mfma_f32_16x16x32_bf16 v[68:71],a[80:83],v[240:243],v[68:71]
v_min3_u32 v27,v27,v240,v244
v_add_f32 v108,v108,v92
v_mfma_f32_16x16x32_bf16 v[76:79],a[208:211],v[240:243],v[76:79]
ds_read_b128 v[236:239],v17 offset:56320
v_add_f32 v100,v100,v93
v_mfma_f32_16x16x32_bf16 v[68:71],a[84:87],v[244:247],v[68:71]
v_fmac_f32 v109,v94,v94
v_fmac_f32 v101,v95,v95
v_mfma_f32_16x16x32_bf16 v[76:79],a[212:215],v[244:247],v[76:79]
ds_read_b128 v[240:243],v17 offset:58368
s_waitcnt lgkmcnt(5)
v_mfma_f32_16x16x32_bf16 v[68:71],a[88:91],v[248:251],v[68:71]
v_min3_u32 v27,v27,v248,v252
v_add_f32 v108,v108,v94
v_mfma_f32_16x16x32_bf16 v[76:79],a[216:219],v[248:251],v[76:79]
ds_read_b128 v[244:247],v17 offset:60416
v_add_f32 v100,v100,v95
v_mfma_f32_16x16x32_bf16 v[68:71],a[92:95],v[252:255],v[68:71]
v_add_f32 v108,v108,v100
v_add_f32 v109,v109,v101
v_mfma_f32_16x16x32_bf16 v[76:79],a[220:223],v[252:255],v[76:79]
ds_read_b128 v[248:251],v17 offset:62464
s_waitcnt lgkmcnt(5)
v_mfma_f32_16x16x32_bf16 v[68:71],a[96:99],v[224:227],v[68:71]
v_min3_u32 v27,v27,v224,v228
v_mov_b32 v100,v108
v_mfma_f32_16x16x32_bf16 v[76:79],a[224:227],v[224:227],v[76:79]
ds_read_b128 v[252:255],v17 offset:64512
v_mov_b32 v101,v109
v_mfma_f32_16x16x32_bf16 v[68:71],a[100:103],v[228:231],v[68:71]
v_permlane16_swap_b32 v100,v108
v_permlane16_swap_b32 v101,v109
v_mfma_f32_16x16x32_bf16 v[76:79],a[228:231],v[228:231],v[76:79]
v_add_f32 v108,v108,v100
s_waitcnt lgkmcnt(4)
v_mfma_f32_16x16x32_bf16 v[68:71],a[104:107],v[232:235],v[68:71]
v_min3_u32 v27,v27,v232,v236
v_add_f32 v109,v109,v101
v_mfma_f32_16x16x32_bf16 v[76:79],a[232:235],v[232:235],v[76:79]
v_mov_b32 v100,v108
v_mov_b32 v101,v109
v_mfma_f32_16x16x32_bf16 v[68:71],a[108:111],v[236:239],v[68:71]
v_permlane32_swap_b32 v100,v108
v_permlane32_swap_b32 v101,v109
v_mfma_f32_16x16x32_bf16 v[76:79],a[236:239],v[236:239],v[76:79]
v_add_f32 v108,v108,v100
s_waitcnt lgkmcnt(2)
v_mfma_f32_16x16x32_bf16 v[68:71],a[112:115],v[240:243],v[68:71]
v_min3_u32 v27,v27,v240,v244
v_add_f32 v109,v109,v101
v_mfma_f32_16x16x32_bf16 v[76:79],a[240:243],v[240:243],v[76:79]
v_min3_u32 v27,v27,v120,v122
v_min3_u32 v27,v27,v124,v126
v_mfma_f32_16x16x32_bf16 v[68:71],a[116:119],v[244:247],v[68:71]
v_lshlrev_b32 v32,16,v124
v_and_b32 v33,s80,v124
v_mfma_f32_16x16x32_bf16 v[76:79],a[244:247],v[244:247],v[76:79]
v_lshlrev_b32 v34,16,v125
s_waitcnt lgkmcnt(0)
v_mfma_f32_16x16x32_bf16 v[68:71],a[120:123],v[248:251],v[68:71]
v_min3_u32 v27,v27,v248,v252
v_and_b32 v35,s80,v125
v_mfma_f32_16x16x32_bf16 v[76:79],a[248:251],v[248:251],v[76:79]
v_lshlrev_b32 v36,16,v126
v_and_b32 v37,s80,v126
v_mfma_f32_16x16x32_bf16 v[68:71],a[124:127],v[252:255],v[68:71]
v_lshlrev_b32 v38,16,v127
v_and_b32 v39,s80,v127
v_mfma_f32_16x16x32_bf16 v[76:79],a[252:255],v[252:255],v[76:79]
v_cmp_eq_u32 vcc,0,v27
s_cbranch_vccnz retry_239
epi_242:
buffer_load_dword v29,v21,s[20:23],s87 offen sc1
s_cmp_gt_u32 s71,51
s_cselect_b32 s65,s73,0x7fff0000
s_cselect_b32 s97,0x7fff0000,s73
v_mov_b32 v22,s71
buffer_store_dword v22,v23,s[20:23],s65 offen sc1
v_pk_add_f32 v[88:89],v[68:69],v[32:33]
v_pk_add_f32 v[90:91],v[70:71],v[34:35]
v_pk_add_f32 v[92:93],v[76:77],v[36:37]
v_pk_add_f32 v[94:95],v[78:79],v[38:39]
v_cvt_pk_bf16_f32 v96,v88,v89
v_cvt_pk_bf16_f32 v97,v90,v91
v_cvt_pk_bf16_f32 v98,v92,v93
v_cvt_pk_bf16_f32 v99,v94,v95
v_max_u32 v96,1,v96
buffer_store_dwordx4 v[96:99],v18,s[20:23],s70 offen offset:1024 sc1
v_lshlrev_b32 v88,16,v96
v_and_b32 v89,s80,v96
v_lshlrev_b32 v90,16,v97
v_and_b32 v91,s80,v97
v_lshlrev_b32 v92,16,v98
v_and_b32 v93,s80,v98
v_lshlrev_b32 v94,16,v99
v_and_b32 v95,s80,v99
v_pk_mul_f32 v[102:103],v[88:89],v[88:89]
v_pk_add_f32 v[100:101],v[88:89],v[90:91]
v_pk_mul_f32 v[106:107],v[90:91],v[90:91]
v_pk_add_f32 v[104:105],v[92:93],v[94:95]
v_pk_fma_f32 v[102:103],v[92:93],v[92:93],v[102:103]
v_pk_fma_f32 v[106:107],v[94:95],v[94:95],v[106:107]
v_pk_add_f32 v[100:101],v[100:101],v[104:105]
v_pk_add_f32 v[102:103],v[102:103],v[106:107]
v_add_f32 v110,v100,v101
v_add_f32 v111,v102,v103
v_mov_b32 v100,v110
v_mov_b32 v101,v111
s_nop 0
v_permlane16_swap_b32 v100,v110
v_permlane16_swap_b32 v101,v111
v_add_f32 v110,v110,v100
v_add_f32 v111,v111,v101
v_mov_b32 v100,v110
v_mov_b32 v101,v111
s_nop 0
v_permlane32_swap_b32 v100,v110
v_permlane32_swap_b32 v101,v111
v_add_f32 v110,v110,v100
v_add_f32 v111,v111,v101
v_max_u32 v109,1,v109
buffer_store_dwordx4 v[108:111],v24,s[20:23],s70 offen sc1
s_cmp_eq_u32 s71,63
s_cselect_b32 s64,0,0x2000
s_cselect_b32 s66,2,1
s_lshl_b32 s66,s66,21
s_add_u32 s78,s78,s66
v_xor_b32 v19,s64,v19
v_xor_b32 v20,s64,v20
next_249:
v_xor_b32 v17,0x10000,v17
s_xor_b32 s72,s72,0x10000
s_add_u32 s70,s70,2097152
s_xor_b32 s70,s70,0x2000
s_add_u32 s71,s71,1
s_cmp_le_u32 s71,s57
s_cbranch_scc1 seg_240
s_endpgm
retry_239:
s_sub_u32 s90,s90,64
s_cmp_lt_i32 s90,0
s_cbranch_scc1 giveup_197
s_mov_b32 s83,1
s_waitcnt vmcnt(0) lgkmcnt(0)
s_barrier
s_branch seg_240
half_248:
s_mov_b32 s88,s94
s_mov_b32 s89,s95
s_add_u32 s94,s94,2097152
s_xor_b32 s94,s94,0x2000
s_xor_b32 s95,s94,1024
s_mov_b64 exec,s[52:53]
s_xor_b32 m0,s91,0
s_add_u32 s65,s94,0
buffer_load_dwordx4 v16,s[20:23],s65 offen offset:0 sc1 lds
buffer_load_dwordx4 v16,s[20:23],s65 offen offset:2048 sc1 lds
s_xor_b32 m0,s91,16384
s_add_u32 s65,s94,32768
buffer_load_dwordx4 v16,s[20:23],s65 offen offset:0 sc1 lds
buffer_load_dwordx4 v16,s[20:23],s65 offen offset:2048 sc1 lds
s_xor_b32 m0,s91,32768
s_add_u32 s65,s94,65536
buffer_load_dwordx4 v16,s[20:23],s65 offen offset:0 sc1 lds
buffer_load_dwordx4 v16,s[20:23],s65 offen offset:2048 sc1 lds
s_xor_b32 m0,s91,49152
s_add_u32 s65,s94,98304
buffer_load_dwordx4 v16,s[20:23],s65 offen offset:0 sc1 lds
buffer_load_dwordx4 v16,s[20:23],s65 offen offset:2048 sc1 lds
s_mov_b64 exec,-1
s_add_u32 m0,s43,0
s_nop 0
buffer_load_dwordx4 v19,s[20:23],s78 offen sc1 lds
s_waitcnt vmcnt(9)
v_add_u32 v22,s71,-1
buffer_store_dword v22,v23,s[20:23],s97 offen sc1
s_mov_b32 s97,0x7fff0000
half2_245:
s_waitcnt vmcnt(8)
s_barrier
ds_read_b128 v[224:227],v17 offset:0
ds_read_b128 v[228:231],v17 offset:2048
ds_read_b128 v[232:235],v17 offset:4096
ds_read_b128 v[236:239],v17 offset:6144
ds_read_b128 v[240:243],v17 offset:8192
ds_read_b128 v[244:247],v17 offset:10240
ds_read_b128 v[248:251],v17 offset:12288
s_waitcnt lgkmcnt(5)
v_mfma_f32_16x16x32_bf16 v[64:67],a[0:3],v[224:227],0
s_xor_b32 m0,s72,0
v_min_u32 v27,v224,v228
v_mfma_f32_16x16x32_bf16 v[72:75],a[128:131],v[224:227],0
ds_read_b128 v[252:255],v17 offset:14336
s_add_u32 s65,s88,0
v_mfma_f32_16x16x32_bf16 v[64:67],a[4:7],v[228:231],v[64:67]
buffer_load_dwordx4 v16,s[20:23],s65 offen offset:0 sc1 lds
v_mfma_f32_16x16x32_bf16 v[72:75],a[132:135],v[228:231],v[72:75]
s_waitcnt vmcnt(7)
s_barrier
ds_read_b128 v[224:227],v17 offset:16384
s_waitcnt lgkmcnt(5)
v_mfma_f32_16x16x32_bf16 v[64:67],a[8:11],v[232:235],v[64:67]
buffer_load_dwordx4 v16,s[20:23],s65 offen offset:2048 sc1 lds
v_mfma_f32_16x16x32_bf16 v[72:75],a[136:139],v[232:235],v[72:75]
ds_read_b128 v[228:231],v17 offset:18432
s_xor_b32 m0,s72,16384
v_mfma_f32_16x16x32_bf16 v[64:67],a[12:15],v[236:239],v[64:67]
s_add_u32 s65,s88,32768
v_min3_u32 v27,v27,v232,v236
v_mfma_f32_16x16x32_bf16 v[72:75],a[140:143],v[236:239],v[72:75]
ds_read_b128 v[232:235],v17 offset:20480
s_waitcnt lgkmcnt(5)
v_mfma_f32_16x16x32_bf16 v[64:67],a[16:19],v[240:243],v[64:67]
buffer_load_dwordx4 v16,s[20:23],s65 offen offset:0 sc1 lds
v_mfma_f32_16x16x32_bf16 v[72:75],a[144:147],v[240:243],v[72:75]
ds_read_b128 v[236:239],v17 offset:22528
buffer_load_dwordx4 v16,s[20:23],s65 offen offset:2048 sc1 lds
v_mfma_f32_16x16x32_bf16 v[64:67],a[20:23],v[244:247],v[64:67]
s_xor_b32 m0,s72,32768
v_min3_u32 v27,v27,v240,v244
v_mfma_f32_16x16x32_bf16 v[72:75],a[148:151],v[244:247],v[72:75]
ds_read_b128 v[240:243],v17 offset:24576
s_add_u32 s65,s88,65536
s_waitcnt lgkmcnt(5)
v_mfma_f32_16x16x32_bf16 v[64:67],a[24:27],v[248:251],v[64:67]
buffer_load_dwordx4 v16,s[20:23],s65 offen offset:0 sc1 lds
v_mfma_f32_16x16x32_bf16 v[72:75],a[152:155],v[248:251],v[72:75]
ds_read_b128 v[244:247],v17 offset:26624
buffer_load_dwordx4 v16,s[20:23],s65 offen offset:2048 sc1 lds
v_mfma_f32_16x16x32_bf16 v[64:67],a[28:31],v[252:255],v[64:67]
v_min3_u32 v27,v27,v248,v252
v_mfma_f32_16x16x32_bf16 v[72:75],a[156:159],v[252:255],v[72:75]
ds_read_b128 v[248:251],v17 offset:28672
s_xor_b32 m0,s72,49152
s_waitcnt lgkmcnt(5)
v_mfma_f32_16x16x32_bf16 v[64:67],a[32:35],v[224:227],v[64:67]
s_add_u32 s65,s88,98304
v_min3_u32 v27,v27,v224,v228
v_mfma_f32_16x16x32_bf16 v[72:75],a[160:163],v[224:227],v[72:75]
ds_read_b128 v[252:255],v17 offset:30720
buffer_load_dwordx4 v16,s[20:23],s65 offen offset:0 sc1 lds
v_mfma_f32_16x16x32_bf16 v[64:67],a[36:39],v[228:231],v[64:67]
buffer_load_dwordx4 v16,s[20:23],s65 offen offset:2048 sc1 lds
v_mfma_f32_16x16x32_bf16 v[72:75],a[164:167],v[228:231],v[72:75]
s_waitcnt vmcnt(10)
s_barrier
ds_read_b128 v[224:227],v17 offset:32768
s_waitcnt lgkmcnt(5)
v_mfma_f32_16x16x32_bf16 v[64:67],a[40:43],v[232:235],v[64:67]
s_xor_b32 m0,s72,1024
v_min3_u32 v27,v27,v232,v236
v_mfma_f32_16x16x32_bf16 v[72:75],a[168:171],v[232:235],v[72:75]
ds_read_b128 v[228:231],v17 offset:34816
s_add_u32 s65,s89,0
v_mfma_f32_16x16x32_bf16 v[64:67],a[44:47],v[236:239],v[64:67]
buffer_load_dwordx4 v16,s[20:23],s65 offen offset:0 sc1 lds
v_mfma_f32_16x16x32_bf16 v[72:75],a[172:175],v[236:239],v[72:75]
ds_read_b128 v[232:235],v17 offset:36864
s_waitcnt lgkmcnt(5)
v_mfma_f32_16x16x32_bf16 v[64:67],a[48:51],v[240:243],v[64:67]
buffer_load_dwordx4 v16,s[20:23],s65 offen offset:2048 sc1 lds
v_mfma_f32_16x16x32_bf16 v[72:75],a[176:179],v[240:243],v[72:75]
ds_read_b128 v[236:239],v17 offset:38912
s_xor_b32 m0,s72,17408
v_mfma_f32_16x16x32_bf16 v[64:67],a[52:55],v[244:247],v[64:67]
s_add_u32 s65,s89,32768
v_min3_u32 v27,v27,v240,v244
v_mfma_f32_16x16x32_bf16 v[72:75],a[180:183],v[244:247],v[72:75]
ds_read_b128 v[240:243],v17 offset:40960
s_waitcnt lgkmcnt(5)
v_mfma_f32_16x16x32_bf16 v[64:67],a[56:59],v[248:251],v[64:67]
buffer_load_dwordx4 v16,s[20:23],s65 offen offset:0 sc1 lds
v_mfma_f32_16x16x32_bf16 v[72:75],a[184:187],v[248:251],v[72:75]
ds_read_b128 v[244:247],v17 offset:43008
v_min3_u32 v27,v27,v248,v252
v_mfma_f32_16x16x32_bf16 v[64:67],a[60:63],v[252:255],v[64:67]
buffer_load_dwordx4 v16,s[20:23],s65 offen offset:2048 sc1 lds
v_mfma_f32_16x16x32_bf16 v[72:75],a[188:191],v[252:255],v[72:75]
ds_read_b128 v[248:251],v17 offset:45056
s_waitcnt lgkmcnt(5)
v_mfma_f32_16x16x32_bf16 v[64:67],a[64:67],v[224:227],v[64:67]
s_xor_b32 m0,s72,33792
s_add_u32 s65,s89,65536
v_mfma_f32_16x16x32_bf16 v[72:75],a[192:195],v[224:227],v[72:75]
ds_read_b128 v[252:255],v17 offset:47104
v_min3_u32 v27,v27,v224,v228
v_mfma_f32_16x16x32_bf16 v[64:67],a[68:71],v[228:231],v[64:67]
buffer_load_dwordx4 v16,s[20:23],s65 offen offset:0 sc1 lds
v_mfma_f32_16x16x32_bf16 v[72:75],a[196:199],v[228:231],v[72:75]
ds_read_b128 v[224:227],v17 offset:49152
s_waitcnt lgkmcnt(5)
v_mfma_f32_16x16x32_bf16 v[64:67],a[72:75],v[232:235],v[64:67]
buffer_load_dwordx4 v16,s[20:23],s65 offen offset:2048 sc1 lds
v_mfma_f32_16x16x32_bf16 v[72:75],a[200:203],v[232:235],v[72:75]
ds_read_b128 v[228:231],v17 offset:51200
s_xor_b32 m0,s72,50176
v_mfma_f32_16x16x32_bf16 v[64:67],a[76:79],v[236:239],v[64:67]
s_add_u32 s65,s89,98304
v_min3_u32 v27,v27,v232,v236
v_mfma_f32_16x16x32_bf16 v[72:75],a[204:207],v[236:239],v[72:75]
ds_read_b128 v[232:235],v17 offset:53248
s_waitcnt lgkmcnt(5)
v_mfma_f32_16x16x32_bf16 v[64:67],a[80:83],v[240:243],v[64:67]
buffer_load_dwordx4 v16,s[20:23],s65 offen offset:0 sc1 lds
v_mfma_f32_16x16x32_bf16 v[72:75],a[208:211],v[240:243],v[72:75]
ds_read_b128 v[236:239],v17 offset:55296
v_min3_u32 v27,v27,v240,v244
v_mfma_f32_16x16x32_bf16 v[64:67],a[84:87],v[244:247],v[64:67]
buffer_load_dwordx4 v16,s[20:23],s65 offen offset:2048 sc1 lds
v_mfma_f32_16x16x32_bf16 v[72:75],a[212:215],v[244:247],v[72:75]
ds_read_b128 v[240:243],v17 offset:57344
s_waitcnt lgkmcnt(5)
v_mfma_f32_16x16x32_bf16 v[64:67],a[88:91],v[248:251],v[64:67]
v_min3_u32 v27,v27,v248,v252
v_mfma_f32_16x16x32_bf16 v[72:75],a[216:219],v[248:251],v[72:75]
ds_read_b128 v[244:247],v17 offset:59392
v_mfma_f32_16x16x32_bf16 v[64:67],a[92:95],v[252:255],v[64:67]
v_mfma_f32_16x16x32_bf16 v[72:75],a[220:223],v[252:255],v[72:75]
ds_read_b128 v[248:251],v17 offset:61440
s_waitcnt lgkmcnt(5)
v_mfma_f32_16x16x32_bf16 v[64:67],a[96:99],v[224:227],v[64:67]
v_min3_u32 v27,v27,v224,v228
v_mfma_f32_16x16x32_bf16 v[72:75],a[224:227],v[224:227],v[72:75]
ds_read_b128 v[252:255],v17 offset:63488
v_mfma_f32_16x16x32_bf16 v[64:67],a[100:103],v[228:231],v[64:67]
v_mfma_f32_16x16x32_bf16 v[72:75],a[228:231],v[228:231],v[72:75]
s_waitcnt lgkmcnt(4)
v_mfma_f32_16x16x32_bf16 v[64:67],a[104:107],v[232:235],v[64:67]
v_min3_u32 v27,v27,v232,v236
s_waitcnt vmcnt(17)
v_mfma_f32_16x16x32_bf16 v[72:75],a[232:235],v[232:235],v[72:75]
ds_read_b64 v[120:121],v40
ds_read_b64 v[122:123],v41
v_mfma_f32_16x16x32_bf16 v[64:67],a[108:111],v[236:239],v[64:67]
v_mfma_f32_16x16x32_bf16 v[72:75],a[236:239],v[236:239],v[72:75]
s_waitcnt lgkmcnt(4)
v_mfma_f32_16x16x32_bf16 v[64:67],a[112:115],v[240:243],v[64:67]
v_min3_u32 v27,v27,v240,v244
v_mfma_f32_16x16x32_bf16 v[72:75],a[240:243],v[240:243],v[72:75]
v_mfma_f32_16x16x32_bf16 v[64:67],a[116:119],v[244:247],v[64:67]
v_mfma_f32_16x16x32_bf16 v[72:75],a[244:247],v[244:247],v[72:75]
s_waitcnt lgkmcnt(2)
v_mfma_f32_16x16x32_bf16 v[64:67],a[120:123],v[248:251],v[64:67]
v_min3_u32 v27,v27,v248,v252
v_mfma_f32_16x16x32_bf16 v[72:75],a[248:251],v[248:251],v[72:75]
v_mfma_f32_16x16x32_bf16 v[64:67],a[124:127],v[252:255],v[64:67]
v_mfma_f32_16x16x32_bf16 v[72:75],a[252:255],v[252:255],v[72:75]
s_waitcnt lgkmcnt(0)
v_min3_u32 v27,v27,v120,v122
v_cmp_eq_u32 vcc,0,v27
s_and_b64 vcc,vcc,s[52:53]
s_cbranch_vccnz retry_239
v_mov_b32 v22,s71
buffer_store_dword v22,v23,s[20:23],s73 offen sc1
v_lshlrev_b32 v88,16,v120
v_and_b32 v89,s80,v120
v_lshlrev_b32 v90,16,v121
v_and_b32 v91,s80,v121
v_lshlrev_b32 v92,16,v122
v_and_b32 v93,s80,v122
v_lshlrev_b32 v94,16,v123
v_and_b32 v95,s80,v123
v_add_f32 v88,v64,v88
v_add_f32 v89,v65,v89
v_add_f32 v90,v66,v90
v_add_f32 v91,v67,v91
v_add_f32 v92,v72,v92
v_add_f32 v93,v73,v93
v_add_f32 v94,v74,v94
v_add_f32 v95,v75,v95
v_cvt_pk_bf16_f32 v96,v88,v89
v_cvt_pk_bf16_f32 v97,v90,v91
v_cvt_pk_bf16_f32 v98,v92,v93
v_cvt_pk_bf16_f32 v99,v94,v95
v_max_u32 v96,1,v96
buffer_store_dwordx4 v[96:99],v18,s[20:23],s70 offen offset:0 sc1
v_lshlrev_b32 v88,16,v96
v_and_b32 v89,s80,v96
v_lshlrev_b32 v90,16,v97
v_and_b32 v91,s80,v97
v_lshlrev_b32 v92,16,v98
v_and_b32 v93,s80,v98
v_lshlrev_b32 v94,16,v99
v_and_b32 v95,s80,v99
v_add_f32 v108,v88,v89
v_mul_f32 v109,v88,v88
v_add_f32 v100,v90,v91
v_mul_f32 v101,v89,v89
v_fmac_f32 v109,v90,v90
v_fmac_f32 v101,v91,v91
v_fmac_f32 v109,v92,v92
v_fmac_f32 v101,v93,v93
v_add_f32 v108,v108,v92
v_add_f32 v100,v100,v93
v_fmac_f32 v109,v94,v94
v_fmac_f32 v101,v95,v95
v_add_f32 v108,v108,v94
v_add_f32 v100,v100,v95
v_add_f32 v108,v108,v100
v_add_f32 v109,v109,v101
v_mov_b32 v100,v108
v_mov_b32 v101,v109
s_nop 0
v_permlane16_swap_b32 v100,v108
v_permlane16_swap_b32 v101,v109
v_add_f32 v108,v108,v100
v_add_f32 v109,v109,v101
v_mov_b32 v100,v108
v_mov_b32 v101,v109
s_nop 0
v_permlane32_swap_b32 v100,v108
v_permlane32_swap_b32 v101,v109
v_add_f32 v108,v108,v100
v_add_f32 v109,v109,v101
v_max_u32 v109,1,v109
buffer_store_dwordx4 v[108:111],v24,s[20:23],s70 offen sc1
v_xor_b32 v19,0x2000,v19
v_xor_b32 v20,0x2000,v20
s_sub_u32 s78,s78,2097152
v_mov_b32 v29,0
s_mov_b32 s83,0
s_mov_b32 s93,1
s_waitcnt vmcnt(3)
s_branch next_249
r_at_219:
v_mov_b32 v128,0
v_mov_b32 v129,0
v_mov_b32 v130,0
v_mov_b32 v131,0
s_cmp_ge_u32 s50,2
s_cbranch_scc1 r_ln_218
v_and_b32 v21,1,v1
v_mul_u32_u24 v21,64,v21
s_mov_b32 s65,21052928
s_mov_b32 s66,1792
pl_254:
buffer_load_dword v22,v21,s[20:23],s65 offen sc1
s_waitcnt vmcnt(0)
v_cmp_gt_u32 vcc,s66,v22
s_cbranch_vccz pok_255
s_sleep 1
s_sub_u32 s90,s90,1
s_cmp_gt_i32 s90,0
s_cbranch_scc1 pl_254
pok_255:
s_lshl_b32 s41,s41,1
s_add_u32 s41,s41,s50
v_and_b32 v21,3,v1
v_lshlrev_b32 v21,7,v21
s_lshl_b32 s65,s41,2
s_add_u32 s87,s65,s63
v_mov_b32 v99,v21
pl_256:
buffer_load_dword v22,v21,s[20:23],s87 offen sc1
s_waitcnt vmcnt(0)
v_cmp_gt_u32 vcc,14,v22
s_cbranch_vccz pok_257
s_sleep 1
s_sub_u32 s90,s90,1
s_cmp_gt_i32 s90,0
s_cbranch_scc1 pl_256
pok_257:
v_mov_b32 v21,s56
v_lshlrev_b32 v21,2,v21
s_mov_b32 s66,128
pl_258:
buffer_load_dword v22,v21,s[44:47],36 offen sc1
s_waitcnt vmcnt(0)
v_cmp_gt_u32 vcc,s66,v22
s_cbranch_vccz pok_259
s_sleep 1
s_sub_u32 s90,s90,1
s_cmp_gt_i32 s90,0
s_cbranch_scc1 pl_258
pok_259:
s_lshl_b32 s42,s41,14
s_lshr_b32 s43,s41,1
s_lshl_b32 s43,s43,14
s_and_b32 s64,s41,1
s_lshl_b32 s64,s64,12
s_add_u32 s43,s43,s64
s_add_u32 s43,s43,1572864
s_lshl_b32 s73,s41,7
s_add_u32 s73,s73,s63
s_add_u32 s73,s73,16384
v_lshrrev_b32 v6,3,v3
v_and_b32 v7,7,v3
v_lshl_add_u32 v6,v6,4,v7
v_lshlrev_b32 v6,4,v6
v_and_b32 v7,1,v4
v_lshl_add_u32 v6,v7,3,v6
v_lshrrev_b32 v8,2,v3
v_and_b32 v9,3,v3
v_lshl_add_u32 v8,v8,3,v9
s_mov_b32 s80,0x3e0293ee
v_mov_b32 v97,0xff800000
v_lshlrev_b32 v96,10,v1
v_lshlrev_b32 v98,3,v4
v_sub_u32 v98,v98,v8
v_cmp_lt_u32 s[48:49],1,v4
v_cmp_ge_i32 s[4:5],-7,v98
v_cmp_ge_i32 s[6:7],-6,v98
v_cmp_ge_i32 s[8:9],-5,v98
v_cmp_ge_i32 s[10:11],-4,v98
v_cmp_ge_i32 s[12:13],-3,v98
v_cmp_ge_i32 s[14:15],-2,v98
v_cmp_ge_i32 s[16:17],-1,v98
v_cmp_ge_i32 s[18:19],0,v98
v_cmp_ge_i32 s[32:33],1,v98
v_cmp_ge_i32 s[34:35],2,v98
v_cmp_ge_i32 s[36:37],3,v98
v_cmp_ge_i32 s[38:39],4,v98
s_add_u32 s64,s79,0
s_lshl_b32 s74,s64,21
s_lshl_b32 s64,s64,13
s_and_b32 s64,s64,0x2000
s_xor_b32 s64,s64,s61
s_add_u32 s74,s74,s64
s_add_u32 s74,s74,29360128
s_add_u32 s66,s74,s43
kp_260:
s_add_u32 s78,s78,2
buffer_load_dwordx4 v[136:139],v16,s[20:23],s66 offen offset:0 sc1
buffer_load_dwordx4 v[140:143],v16,s[20:23],s66 offen offset:1024 sc1
buffer_load_dwordx4 v[144:147],v16,s[20:23],s66 offen offset:2048 sc1
buffer_load_dwordx4 v[148:151],v16,s[20:23],s66 offen offset:3072 sc1
s_waitcnt vmcnt(0)
kck_262:
v_min3_u32 v22,v136,v140,v144
v_min_u32 v22,v22,v148
v_cmp_eq_u32 vcc,0,v22
s_cbranch_vccz kok_261
s_sleep 1
s_sub_u32 s90,s90,1
s_cmp_gt_i32 s90,0
s_cbranch_scc1 kp_260
kok_261:
s_mov_b32 s78,0
s_add_u32 s64,s79,0
s_lshl_b32 s75,s64,21
s_lshl_b32 s64,s64,13
s_and_b32 s64,s64,0x2000
s_xor_b32 s64,s64,s61
s_add_u32 s75,s75,s64
s_add_u32 s75,s75,29360128
s_add_u32 s64,s79,0
s_lshl_b32 s76,s64,21
s_lshl_b32 s64,s64,13
s_and_b32 s64,s64,0x2000
s_xor_b32 s64,s64,s62
s_add_u32 s76,s76,s64
s_add_u32 s76,s76,29360128
s_add_u32 s77,s75,s43
s_add_u32 s75,s75,s42
s_add_u32 s76,s76,s42
s_add_u32 s65,s75,524288
buffer_load_dwordx4 a[32:35],v16,s[20:23],s65 offen offset:0 sc1
buffer_load_dwordx4 a[36:39],v16,s[20:23],s65 offen offset:1024 sc1
buffer_load_dwordx4 a[40:43],v16,s[20:23],s65 offen offset:2048 sc1
buffer_load_dwordx4 a[44:47],v16,s[20:23],s65 offen offset:3072 sc1
s_add_u32 s65,s75,528384
buffer_load_dwordx4 a[48:51],v16,s[20:23],s65 offen offset:0 sc1
buffer_load_dwordx4 a[52:55],v16,s[20:23],s65 offen offset:1024 sc1
buffer_load_dwordx4 a[56:59],v16,s[20:23],s65 offen offset:2048 sc1
buffer_load_dwordx4 a[60:63],v16,s[20:23],s65 offen offset:3072 sc1
s_add_u32 s65,s76,0
buffer_load_dwordx4 a[0:3],v16,s[20:23],s65 offen offset:0 sc1
buffer_load_dwordx4 a[4:7],v16,s[20:23],s65 offen offset:1024 sc1
buffer_load_dwordx4 a[8:11],v16,s[20:23],s65 offen offset:2048 sc1
buffer_load_dwordx4 a[12:15],v16,s[20:23],s65 offen offset:3072 sc1
s_add_u32 s65,s76,4096
buffer_load_dwordx4 a[16:19],v16,s[20:23],s65 offen offset:0 sc1
buffer_load_dwordx4 a[20:23],v16,s[20:23],s65 offen offset:1024 sc1
buffer_load_dwordx4 a[24:27],v16,s[20:23],s65 offen offset:2048 sc1
buffer_load_dwordx4 a[28:31],v16,s[20:23],s65 offen offset:3072 sc1
s_cmp_lt_u32 s79,60
s_cselect_b32 s78,s78,0
s_cmp_lg_u32 s78,0
s_cselect_b32 s66,0x7fff0000,s77
buffer_load_dwordx4 v[136:139],v16,s[20:23],s66 offen offset:0 sc1
buffer_load_dwordx4 v[140:143],v16,s[20:23],s66 offen offset:1024 sc1
buffer_load_dwordx4 v[144:147],v16,s[20:23],s66 offen offset:2048 sc1
buffer_load_dwordx4 v[148:151],v16,s[20:23],s66 offen offset:3072 sc1
s_add_u32 s65,s75,1048576
buffer_load_dwordx4 a[64:67],v16,s[20:23],s65 offen offset:0 sc1
buffer_load_dwordx4 a[68:71],v16,s[20:23],s65 offen offset:1024 sc1
buffer_load_dwordx4 a[72:75],v16,s[20:23],s65 offen offset:2048 sc1
buffer_load_dwordx4 a[76:79],v16,s[20:23],s65 offen offset:3072 sc1
s_add_u32 s65,s75,1052672
buffer_load_dwordx4 a[80:83],v16,s[20:23],s65 offen offset:0 sc1
buffer_load_dwordx4 a[84:87],v16,s[20:23],s65 offen offset:1024 sc1
buffer_load_dwordx4 a[88:91],v16,s[20:23],s65 offen offset:2048 sc1
buffer_load_dwordx4 a[92:95],v16,s[20:23],s65 offen offset:3072 sc1
s_waitcnt vmcnt(0)
aloop_263:
s_add_u32 s64,s79,0
s_lshl_b32 s74,s64,21
s_lshl_b32 s64,s64,13
s_and_b32 s64,s64,0x2000
s_xor_b32 s64,s64,s61
s_add_u32 s74,s74,s64
s_add_u32 s74,s74,29360128
s_add_u32 s64,s79,0
s_lshl_b32 s70,s64,21
s_lshl_b32 s64,s64,13
s_and_b32 s64,s64,0x2000
s_xor_b32 s64,s64,s62
s_add_u32 s70,s70,s64
s_add_u32 s70,s70,29360128
s_waitcnt vmcnt(21)
v_mfma_f32_16x16x32_bf16 v[168:171],a[32:35],a[0:3],0
v_mfma_f32_16x16x32_bf16 v[172:175],a[36:39],a[0:3],0
v_mfma_f32_16x16x32_bf16 v[180:183],a[32:35],a[4:7],0
v_mfma_f32_16x16x32_bf16 v[184:187],a[36:39],a[4:7],0
v_mfma_f32_16x16x32_bf16 v[168:171],a[40:43],a[8:11],v[168:171]
v_mfma_f32_16x16x32_bf16 v[172:175],a[44:47],a[8:11],v[172:175]
v_mfma_f32_16x16x32_bf16 v[180:183],a[40:43],a[12:15],v[180:183]
v_mfma_f32_16x16x32_bf16 v[184:187],a[44:47],a[12:15],v[184:187]
v_mfma_f32_16x16x32_bf16 v[168:171],a[48:51],a[16:19],v[168:171]
v_mfma_f32_16x16x32_bf16 v[172:175],a[52:55],a[16:19],v[172:175]
v_mfma_f32_16x16x32_bf16 v[180:183],a[48:51],a[20:23],v[180:183]
v_mfma_f32_16x16x32_bf16 v[184:187],a[52:55],a[20:23],v[184:187]
v_mfma_f32_16x16x32_bf16 v[168:171],a[56:59],a[24:27],v[168:171]
v_mfma_f32_16x16x32_bf16 v[172:175],a[60:63],a[24:27],v[172:175]
v_mfma_f32_16x16x32_bf16 v[180:183],a[56:59],a[28:31],v[180:183]
v_mfma_f32_16x16x32_bf16 v[184:187],a[60:63],a[28:31],v[184:187]
s_nop 4
v_cndmask_b32 v168,v97,v168,s[18:19]
s_nop 0
v_cndmask_b32 v180,v97,v180,s[38:39]
v_cndmask_b32 v169,v97,v169,s[16:17]
v_cndmask_b32 v181,v97,v181,s[36:37]
v_cndmask_b32 v170,v97,v170,s[14:15]
v_cndmask_b32 v182,v97,v182,s[34:35]
v_cndmask_b32 v171,v97,v171,s[12:13]
v_cndmask_b32 v183,v97,v183,s[32:33]
v_cndmask_b32 v172,v97,v172,s[10:11]
v_cndmask_b32 v184,v97,v184,s[18:19]
v_cndmask_b32 v173,v97,v173,s[8:9]
v_cndmask_b32 v185,v97,v185,s[16:17]
v_cndmask_b32 v174,v97,v174,s[6:7]
v_cndmask_b32 v186,v97,v186,s[14:15]
v_cndmask_b32 v175,v97,v175,s[4:5]
v_cndmask_b32 v187,v97,v187,s[12:13]
v_max3_f32 v116,v168,v169,v170
v_max3_f32 v122,v180,v181,v182
v_max3_f32 v118,v171,v172,v173
v_max3_f32 v124,v183,v184,v185
v_max3_f32 v116,v116,v174,v175
v_max3_f32 v122,v122,v186,v187
v_max_f32 v116,v116,v118
v_max_f32 v122,v122,v124
v_mov_b32 v118,v116
v_mov_b32 v124,v122
s_nop 0
v_permlane16_swap_b32 v118,v116
v_permlane16_swap_b32 v124,v122
v_max_f32 v116,v116,v118
v_max_f32 v122,v122,v124
v_mov_b32 v118,v116
v_mov_b32 v124,v122
s_nop 0
v_permlane32_swap_b32 v118,v116
v_permlane32_swap_b32 v124,v122
v_max_f32 v116,v116,v118
v_max_f32 v122,v122,v124
v_mul_f32 v116,s80,v116
v_mul_f32 v122,s80,v122
v_fma_f32 v168,v168,s80,-v116
v_fma_f32 v180,v180,s80,-v122
v_fma_f32 v169,v169,s80,-v116
v_fma_f32 v181,v181,s80,-v122
v_fma_f32 v170,v170,s80,-v116
v_fma_f32 v182,v182,s80,-v122
v_fma_f32 v171,v171,s80,-v116
v_fma_f32 v183,v183,s80,-v122
v_fma_f32 v172,v172,s80,-v116
v_fma_f32 v184,v184,s80,-v122
v_fma_f32 v173,v173,s80,-v116
v_fma_f32 v185,v185,s80,-v122
v_fma_f32 v174,v174,s80,-v116
v_fma_f32 v186,v186,s80,-v122
v_fma_f32 v175,v175,s80,-v116
v_fma_f32 v187,v187,s80,-v122
v_exp_f32 v168,v168
v_exp_f32 v180,v180
v_exp_f32 v169,v169
v_exp_f32 v181,v181
v_exp_f32 v170,v170
v_exp_f32 v182,v182
v_exp_f32 v171,v171
v_exp_f32 v183,v183
v_exp_f32 v172,v172
v_exp_f32 v184,v184
v_exp_f32 v173,v173
v_exp_f32 v185,v185
v_exp_f32 v174,v174
v_exp_f32 v186,v186
v_exp_f32 v175,v175
v_exp_f32 v187,v187
v_add_f32 v117,v168,v169
v_add_f32 v123,v180,v181
v_add_f32 v119,v170,v171
v_add_f32 v125,v182,v183
v_add_f32 v117,v117,v172
v_add_f32 v123,v123,v184
v_add_f32 v119,v119,v173
v_add_f32 v125,v125,v185
v_add_f32 v117,v117,v174
v_add_f32 v123,v123,v186
v_add_f32 v119,v119,v175
v_add_f32 v125,v125,v187
v_add_f32 v117,v117,v119
v_add_f32 v123,v123,v125
v_mov_b32 v118,v117
v_mov_b32 v124,v123
s_nop 0
v_permlane16_swap_b32 v118,v117
v_permlane16_swap_b32 v124,v123
v_add_f32 v117,v117,v118
v_add_f32 v123,v123,v124
v_mov_b32 v118,v117
v_mov_b32 v124,v123
s_nop 0
v_permlane32_swap_b32 v118,v117
v_permlane32_swap_b32 v124,v123
v_add_f32 v117,v117,v118
v_add_f32 v123,v123,v124
s_cmp_gt_u32 s71,52
s_cselect_b32 s65,0x7fff0000,s73
s_waitcnt vmcnt(12)
v_add_u32 v22,s71,-1
buffer_store_dword v22,v23,s[20:23],s65 offen sc1
s_add_u32 s66,s74,s43
s_cmp_eq_u32 s78,0
s_cbranch_scc1 kx_267
s_cmp_eq_u32 s84,0
s_cselect_b32 s64,3,0
s_add_u32 s64,s64,s78
kbo_269:
s_sleep 2
s_sub_u32 s64,s64,1
s_cmp_gt_i32 s64,0
s_cbranch_scc1 kbo_269
s_cmp_lt_u32 s84,3
s_cselect_b32 s64,1,0
s_cmp_ge_u32 s84,4
s_subb_u32 s78,s78,2
s_add_u32 s84,s84,1
kpr_268:
s_mov_b64 exec,15
buffer_load_dword v22,v96,s[20:23],s66 offen sc1
s_waitcnt vmcnt(0)
v_cmp_eq_u32 vcc,0,v22
s_mov_b64 exec,-1
s_cbranch_vccz kp_264
s_add_u32 s78,s78,s64
s_mov_b32 s64,1
s_mov_b32 s84,0
s_sleep 1
s_sub_u32 s90,s90,1
s_cmp_gt_i32 s90,0
s_cbranch_scc1 kpr_268
s_branch kp_264
kx_267:
s_mov_b32 s84,0
s_waitcnt vmcnt(9)
s_branch kck_266
kp_264:
s_add_u32 s78,s78,2
buffer_load_dwordx4 v[136:139],v16,s[20:23],s66 offen offset:0 sc1
buffer_load_dwordx4 v[140:143],v16,s[20:23],s66 offen offset:1024 sc1
buffer_load_dwordx4 v[144:147],v16,s[20:23],s66 offen offset:2048 sc1
buffer_load_dwordx4 v[148:151],v16,s[20:23],s66 offen offset:3072 sc1
s_waitcnt vmcnt(0)
kck_266:
v_min3_u32 v22,v136,v140,v144
v_min_u32 v22,v22,v148
v_cmp_eq_u32 vcc,0,v22
s_cbranch_vccz kok_265
s_sleep 1
s_sub_u32 s90,s90,1
s_cmp_gt_i32 s90,0
s_cbranch_scc1 kp_264
kok_265:
s_min_u32 s78,s78,40
buffer_load_dwordx2 v[100:101],v6,s[20:23],s66 offen offset:0 sc1
buffer_load_dwordx2 v[102:103],v6,s[20:23],s66 offen offset:512 sc1
buffer_load_dwordx2 v[104:105],v6,s[20:23],s66 offen offset:1024 sc1
buffer_load_dwordx2 v[106:107],v6,s[20:23],s66 offen offset:1536 sc1
buffer_load_dwordx2 v[108:109],v6,s[20:23],s66 offen offset:2048 sc1
buffer_load_dwordx2 v[110:111],v6,s[20:23],s66 offen offset:2560 sc1
buffer_load_dwordx2 v[112:113],v6,s[20:23],s66 offen offset:3072 sc1
buffer_load_dwordx2 v[114:115],v6,s[20:23],s66 offen offset:3584 sc1
v_mfma_f32_16x16x32_bf16 v[176:179],v[136:139],a[0:3],0
v_mfma_f32_16x16x32_bf16 v[188:191],v[136:139],a[4:7],0
v_mfma_f32_16x16x32_bf16 v[176:179],v[140:143],a[8:11],v[176:179]
v_mfma_f32_16x16x32_bf16 v[188:191],v[140:143],a[12:15],v[188:191]
v_mfma_f32_16x16x32_bf16 v[176:179],v[144:147],a[16:19],v[176:179]
v_mfma_f32_16x16x32_bf16 v[188:191],v[144:147],a[20:23],v[188:191]
v_mfma_f32_16x16x32_bf16 v[176:179],v[148:151],a[24:27],v[176:179]
v_mfma_f32_16x16x32_bf16 v[188:191],v[148:151],a[28:31],v[188:191]
s_cmp_lg_u32 s79,55
s_cbranch_scc1 q2nd_270
pl_271:
buffer_load_dword v98,v99,s[20:23],s87 offen sc1
s_waitcnt vmcnt(0)
v_cmp_gt_u32 vcc,18,v98
s_cbranch_vccz pok_272
s_sleep 1
s_sub_u32 s90,s90,1
s_cmp_gt_i32 s90,0
s_cbranch_scc1 pl_271
pok_272:
q2nd_270:
s_add_u32 s64,s79,1
s_lshl_b32 s75,s64,21
s_lshl_b32 s64,s64,13
s_and_b32 s64,s64,0x2000
s_xor_b32 s64,s64,s61
s_add_u32 s75,s75,s64
s_add_u32 s75,s75,29360128
s_add_u32 s64,s79,1
s_lshl_b32 s76,s64,21
s_lshl_b32 s64,s64,13
s_and_b32 s64,s64,0x2000
s_xor_b32 s64,s64,s62
s_add_u32 s76,s76,s64
s_add_u32 s76,s76,29360128
s_add_u32 s77,s75,s43
s_add_u32 s75,s75,s42
s_add_u32 s76,s76,s42
s_cmp_lt_u32 s79,63
s_cselect_b32 s75,s75,0x7fff0000
s_cselect_b32 s76,s76,0x7fff0000
s_cselect_b32 s77,s77,0x7fff0000
s_add_u32 s65,s75,524288
buffer_load_dwordx4 a[32:35],v16,s[20:23],s65 offen offset:0 sc1
buffer_load_dwordx4 a[36:39],v16,s[20:23],s65 offen offset:1024 sc1
buffer_load_dwordx4 a[40:43],v16,s[20:23],s65 offen offset:2048 sc1
buffer_load_dwordx4 a[44:47],v16,s[20:23],s65 offen offset:3072 sc1
s_add_u32 s65,s75,528384
buffer_load_dwordx4 a[48:51],v16,s[20:23],s65 offen offset:0 sc1
buffer_load_dwordx4 a[52:55],v16,s[20:23],s65 offen offset:1024 sc1
buffer_load_dwordx4 a[56:59],v16,s[20:23],s65 offen offset:2048 sc1
buffer_load_dwordx4 a[60:63],v16,s[20:23],s65 offen offset:3072 sc1
s_add_u32 s65,s76,0
buffer_load_dwordx4 a[0:3],v16,s[20:23],s65 offen offset:0 sc1
buffer_load_dwordx4 a[4:7],v16,s[20:23],s65 offen offset:1024 sc1
buffer_load_dwordx4 a[8:11],v16,s[20:23],s65 offen offset:2048 sc1
buffer_load_dwordx4 a[12:15],v16,s[20:23],s65 offen offset:3072 sc1
s_add_u32 s65,s76,4096
buffer_load_dwordx4 a[16:19],v16,s[20:23],s65 offen offset:0 sc1
buffer_load_dwordx4 a[20:23],v16,s[20:23],s65 offen offset:1024 sc1
buffer_load_dwordx4 a[24:27],v16,s[20:23],s65 offen offset:2048 sc1
buffer_load_dwordx4 a[28:31],v16,s[20:23],s65 offen offset:3072 sc1
v_cndmask_b32 v176,v97,v176,s[48:49]
v_cndmask_b32 v188,v97,v188,s[48:49]
v_cndmask_b32 v177,v97,v177,s[48:49]
v_cndmask_b32 v189,v97,v189,s[48:49]
v_cndmask_b32 v178,v97,v178,s[48:49]
v_cndmask_b32 v190,v97,v190,s[48:49]
v_cndmask_b32 v179,v97,v179,s[48:49]
v_cndmask_b32 v191,v97,v191,s[48:49]
v_max3_f32 v119,v176,v177,v178
v_max3_f32 v125,v188,v189,v190
v_max_f32 v119,v119,v179
v_max_f32 v125,v125,v191
v_mov_b32 v118,v119
v_mov_b32 v124,v125
s_nop 0
v_permlane16_swap_b32 v118,v119
v_permlane16_swap_b32 v124,v125
v_max_f32 v119,v119,v118
v_max_f32 v125,v125,v124
v_mov_b32 v118,v119
v_mov_b32 v124,v125
s_nop 0
v_permlane32_swap_b32 v118,v119
v_permlane32_swap_b32 v124,v125
v_max_f32 v119,v119,v118
v_max_f32 v125,v125,v124
v_mul_f32 v119,s80,v119
v_mul_f32 v125,s80,v125
v_max_f32 v119,v119,v116
v_max_f32 v125,v125,v122
v_fma_f32 v176,v176,s80,-v119
v_fma_f32 v188,v188,s80,-v125
v_fma_f32 v177,v177,s80,-v119
v_fma_f32 v189,v189,s80,-v125
v_fma_f32 v178,v178,s80,-v119
v_fma_f32 v190,v190,s80,-v125
v_fma_f32 v179,v179,s80,-v119
v_fma_f32 v191,v191,s80,-v125
v_sub_f32 v116,v116,v119
v_sub_f32 v122,v122,v125
v_exp_f32 v176,v176
v_exp_f32 v188,v188
v_exp_f32 v177,v177
v_exp_f32 v189,v189
v_exp_f32 v178,v178
v_exp_f32 v190,v190
v_exp_f32 v179,v179
v_exp_f32 v191,v191
v_exp_f32 v116,v116
v_exp_f32 v122,v122
v_add_f32 v120,v176,v177
v_add_f32 v126,v188,v189
v_add_f32 v121,v178,v179
v_add_f32 v127,v190,v191
v_add_f32 v120,v120,v121
v_add_f32 v126,v126,v127
v_mov_b32 v118,v120
v_mov_b32 v124,v126
s_nop 0
v_permlane16_swap_b32 v118,v120
v_permlane16_swap_b32 v124,v126
v_add_f32 v120,v120,v118
v_add_f32 v126,v126,v124
v_mov_b32 v118,v120
v_mov_b32 v124,v126
s_nop 0
v_permlane32_swap_b32 v118,v120
v_permlane32_swap_b32 v124,v126
v_add_f32 v120,v120,v118
v_add_f32 v126,v126,v124
v_fmac_f32 v120,v117,v116
v_fmac_f32 v126,v123,v122
v_rcp_f32 v121,v120
v_rcp_f32 v127,v126
v_mul_f32 v119,v116,v121
v_mul_f32 v125,v122,v127
v_pk_mul_f32 v[168:169],v[168:169],v[118:119] op_sel:[0,1] op_sel_hi:[1,1]
v_pk_mul_f32 v[180:181],v[180:181],v[124:125] op_sel:[0,1] op_sel_hi:[1,1]
v_pk_mul_f32 v[170:171],v[170:171],v[118:119] op_sel:[0,1] op_sel_hi:[1,1]
v_pk_mul_f32 v[182:183],v[182:183],v[124:125] op_sel:[0,1] op_sel_hi:[1,1]
v_pk_mul_f32 v[172:173],v[172:173],v[118:119] op_sel:[0,1] op_sel_hi:[1,1]
v_pk_mul_f32 v[184:185],v[184:185],v[124:125] op_sel:[0,1] op_sel_hi:[1,1]
v_pk_mul_f32 v[174:175],v[174:175],v[118:119] op_sel:[0,1] op_sel_hi:[1,1]
v_pk_mul_f32 v[186:187],v[186:187],v[124:125] op_sel:[0,1] op_sel_hi:[1,1]
v_cvt_pk_bf16_f32 v48,v168,v169
v_cvt_pk_bf16_f32 v56,v180,v181
v_cvt_pk_bf16_f32 v49,v170,v171
v_cvt_pk_bf16_f32 v57,v182,v183
v_cvt_pk_bf16_f32 v50,v172,v173
v_cvt_pk_bf16_f32 v58,v184,v185
v_cvt_pk_bf16_f32 v51,v174,v175
v_cvt_pk_bf16_f32 v59,v186,v187
v_pk_mul_f32 v[176:177],v[176:177],v[120:121] op_sel:[0,1] op_sel_hi:[1,1]
v_pk_mul_f32 v[188:189],v[188:189],v[126:127] op_sel:[0,1] op_sel_hi:[1,1]
v_pk_mul_f32 v[178:179],v[178:179],v[120:121] op_sel:[0,1] op_sel_hi:[1,1]
v_pk_mul_f32 v[190:191],v[190:191],v[126:127] op_sel:[0,1] op_sel_hi:[1,1]
v_cvt_pk_bf16_f32 v52,v176,v177
v_cvt_pk_bf16_f32 v60,v188,v189
v_cvt_pk_bf16_f32 v53,v178,v179
v_cvt_pk_bf16_f32 v61,v190,v191
s_add_u32 s70,s70,s42
s_waitcnt vmcnt(24)
v_mfma_f32_16x16x32_bf16 v[192:195],a[64:67],v[48:51],0
v_mfma_f32_16x16x32_bf16 v[196:199],a[64:67],v[56:59],0
v_mfma_f32_16x16x32_bf16 v[200:203],a[68:71],v[48:51],0
v_mfma_f32_16x16x32_bf16 v[204:207],a[68:71],v[56:59],0
v_mfma_f32_16x16x32_bf16 v[208:211],a[72:75],v[48:51],0
v_mfma_f32_16x16x32_bf16 v[212:215],a[72:75],v[56:59],0
v_mfma_f32_16x16x32_bf16 v[216:219],a[76:79],v[48:51],0
v_mfma_f32_16x16x32_bf16 v[220:223],a[76:79],v[56:59],0
s_waitcnt vmcnt(16)
v_mfma_f32_16x16x16_bf16 v[192:195],v[100:101],v[52:53],v[192:195]
v_mfma_f32_16x16x16_bf16 v[196:199],v[100:101],v[60:61],v[196:199]
v_mfma_f32_16x16x16_bf16 v[200:203],v[102:103],v[52:53],v[200:203]
v_mfma_f32_16x16x16_bf16 v[204:207],v[102:103],v[60:61],v[204:207]
v_mfma_f32_16x16x32_bf16 v[224:227],a[80:83],v[48:51],0
v_mfma_f32_16x16x32_bf16 v[228:231],a[80:83],v[56:59],0
v_mfma_f32_16x16x32_bf16 v[232:235],a[84:87],v[48:51],0
v_mfma_f32_16x16x32_bf16 v[236:239],a[84:87],v[56:59],0
v_mfma_f32_16x16x16_bf16 v[208:211],v[104:105],v[52:53],v[208:211]
s_add_u32 s65,s70,524288
v_mfma_f32_16x16x16_bf16 v[212:215],v[104:105],v[60:61],v[212:215]
v_cvt_pk_bf16_f32 v64,v192,v193
v_cvt_pk_bf16_f32 v65,v194,v195
v_mfma_f32_16x16x16_bf16 v[216:219],v[106:107],v[52:53],v[216:219]
v_cvt_pk_bf16_f32 v66,v200,v201
v_mfma_f32_16x16x16_bf16 v[220:223],v[106:107],v[60:61],v[220:223]
v_cvt_pk_bf16_f32 v67,v202,v203
v_max_u32 v64,1,v64
v_mfma_f32_16x16x32_bf16 v[240:243],a[88:91],v[48:51],0
buffer_store_dwordx4 v[64:67],v16,s[20:23],s65 offen offset:0 sc1
v_cvt_pk_bf16_f32 v68,v196,v197
v_mfma_f32_16x16x32_bf16 v[244:247],a[88:91],v[56:59],0
v_cvt_pk_bf16_f32 v69,v198,v199
v_mfma_f32_16x16x32_bf16 v[248:251],a[92:95],v[48:51],0
v_cvt_pk_bf16_f32 v70,v204,v205
v_cvt_pk_bf16_f32 v71,v206,v207
v_mfma_f32_16x16x32_bf16 v[252:255],a[92:95],v[56:59],0
v_max_u32 v68,1,v68
buffer_store_dwordx4 v[68:71],v16,s[20:23],s65 offen offset:1024 sc1
v_mfma_f32_16x16x16_bf16 v[224:227],v[108:109],v[52:53],v[224:227]
v_cvt_pk_bf16_f32 v72,v208,v209
v_mfma_f32_16x16x16_bf16 v[228:231],v[108:109],v[60:61],v[228:231]
v_cvt_pk_bf16_f32 v73,v210,v211
v_cvt_pk_bf16_f32 v74,v216,v217
v_mfma_f32_16x16x16_bf16 v[232:235],v[110:111],v[52:53],v[232:235]
v_cvt_pk_bf16_f32 v75,v218,v219
v_mfma_f32_16x16x16_bf16 v[236:239],v[110:111],v[60:61],v[236:239]
v_max_u32 v72,1,v72
buffer_store_dwordx4 v[72:75],v16,s[20:23],s65 offen offset:2048 sc1
v_mfma_f32_16x16x16_bf16 v[240:243],v[112:113],v[52:53],v[240:243]
v_cvt_pk_bf16_f32 v76,v212,v213
v_mfma_f32_16x16x16_bf16 v[244:247],v[112:113],v[60:61],v[244:247]
v_cvt_pk_bf16_f32 v77,v214,v215
v_cvt_pk_bf16_f32 v78,v220,v221
v_mfma_f32_16x16x16_bf16 v[248:251],v[114:115],v[52:53],v[248:251]
v_cvt_pk_bf16_f32 v79,v222,v223
v_mfma_f32_16x16x16_bf16 v[252:255],v[114:115],v[60:61],v[252:255]
v_max_u32 v76,1,v76
buffer_store_dwordx4 v[76:79],v16,s[20:23],s65 offen offset:3072 sc1
s_cmp_gt_u32 s71,51
s_cselect_b32 s64,s73,0x7fff0000
v_mov_b32 v22,s71
buffer_store_dword v22,v23,s[20:23],s64 offen sc1
s_add_u32 s65,s70,528384
v_cvt_pk_bf16_f32 v64,v224,v225
v_cvt_pk_bf16_f32 v65,v226,v227
v_cvt_pk_bf16_f32 v66,v232,v233
v_cvt_pk_bf16_f32 v67,v234,v235
v_max_u32 v64,1,v64
buffer_store_dwordx4 v[64:67],v16,s[20:23],s65 offen offset:0 sc1
v_cvt_pk_bf16_f32 v68,v228,v229
v_cvt_pk_bf16_f32 v69,v230,v231
v_cvt_pk_bf16_f32 v70,v236,v237
v_cvt_pk_bf16_f32 v71,v238,v239
v_max_u32 v68,1,v68
buffer_store_dwordx4 v[68:71],v16,s[20:23],s65 offen offset:1024 sc1
v_cvt_pk_bf16_f32 v72,v240,v241
v_cvt_pk_bf16_f32 v73,v242,v243
v_cvt_pk_bf16_f32 v74,v248,v249
v_cvt_pk_bf16_f32 v75,v250,v251
v_max_u32 v72,1,v72
buffer_store_dwordx4 v[72:75],v16,s[20:23],s65 offen offset:2048 sc1
v_cvt_pk_bf16_f32 v76,v244,v245
v_cvt_pk_bf16_f32 v77,v246,v247
v_cvt_pk_bf16_f32 v78,v252,v253
v_cvt_pk_bf16_f32 v79,v254,v255
v_max_u32 v76,1,v76
buffer_store_dwordx4 v[76:79],v16,s[20:23],s65 offen offset:3072 sc1
s_cmp_lt_u32 s79,60
s_cselect_b32 s78,s78,0
s_cmp_lg_u32 s78,0
s_cselect_b32 s66,0x7fff0000,s77
buffer_load_dwordx4 v[136:139],v16,s[20:23],s66 offen offset:0 sc1
buffer_load_dwordx4 v[140:143],v16,s[20:23],s66 offen offset:1024 sc1
buffer_load_dwordx4 v[144:147],v16,s[20:23],s66 offen offset:2048 sc1
buffer_load_dwordx4 v[148:151],v16,s[20:23],s66 offen offset:3072 sc1
s_add_u32 s65,s75,1048576
buffer_load_dwordx4 a[64:67],v16,s[20:23],s65 offen offset:0 sc1
buffer_load_dwordx4 a[68:71],v16,s[20:23],s65 offen offset:1024 sc1
buffer_load_dwordx4 a[72:75],v16,s[20:23],s65 offen offset:2048 sc1
buffer_load_dwordx4 a[76:79],v16,s[20:23],s65 offen offset:3072 sc1
s_add_u32 s65,s75,1052672
buffer_load_dwordx4 a[80:83],v16,s[20:23],s65 offen offset:0 sc1
buffer_load_dwordx4 a[84:87],v16,s[20:23],s65 offen offset:1024 sc1
buffer_load_dwordx4 a[88:91],v16,s[20:23],s65 offen offset:2048 sc1
buffer_load_dwordx4 a[92:95],v16,s[20:23],s65 offen offset:3072 sc1
s_add_u32 s79,s79,1
s_add_u32 s71,s71,1
s_cmp_lt_u32 s79,64
s_cbranch_scc1 aloop_263
s_endpgm
r_ln_218:
v_and_b32 v21,1,v1
v_mul_u32_u24 v21,960,v21
s_mov_b32 s65,21052032
s_mov_b32 s66,1792
pl_273:
buffer_load_dword v22,v21,s[20:23],s65 offen sc1
s_waitcnt vmcnt(0)
v_cmp_gt_u32 vcc,s66,v22
s_cbranch_vccz pok_274
s_sleep 1
s_sub_u32 s90,s90,1
s_cmp_gt_i32 s90,0
s_cbranch_scc1 pl_273
pok_274:
s_lshl_b32 s41,s59,1
s_add_u32 s41,s41,s50
s_sub_u32 s41,s41,2
v_lshlrev_b32 v5,5,v1
s_mov_b32 s64,16384
buffer_load_dwordx4 v[40:43],v5,s[20:23],s64 offen offset:0 sc1
buffer_load_dwordx4 v[44:47],v5,s[20:23],s64 offen offset:16 sc1
buffer_load_dwordx4 v[48:51],v5,s[20:23],s64 offen offset:2048 sc1
buffer_load_dwordx4 v[52:55],v5,s[20:23],s64 offen offset:2064 sc1
s_mov_b32 s64,12288
buffer_load_dwordx4 v[56:59],v5,s[20:23],s64 offen offset:0 sc1
buffer_load_dwordx4 v[60:63],v5,s[20:23],s64 offen offset:16 sc1
buffer_load_dwordx4 v[64:67],v5,s[20:23],s64 offen offset:2048 sc1
buffer_load_dwordx4 v[68:71],v5,s[20:23],s64 offen offset:2064 sc1
s_lshr_b32 s64,s41,2
s_add_u32 s64,s64,64
s_lshl_b32 s64,s64,14
s_and_b32 s65,s41,3
s_lshl_b32 s65,s65,11
s_add_u32 s64,s64,s65
v_add_u32 v19,s64,v16
v_add_u32 v19,786432,v19
s_lshl_b32 s65,s41,7
v_add_u32 v5,s65,v16
v_and_b32 v5,2047,v5
v_add_u32 v17,s64,v5
v_xor_b32 v18,1024,v17
v_add_u32 v24,0xfff00000,v17
v_xor_b32 v25,1024,v24
v_lshlrev_b32 v21,2,v1
s_and_b32 s64,s41,4
s_lshl_b32 s64,s64,6
s_add_u32 s74,s63,s64
s_add_u32 s74,s74,2048
s_mov_b32 s83,1
s_lshl_b32 s73,s41,2
s_add_u32 s73,s73,s63
s_add_u32 s73,s73,2560
v_mov_b32 v8,1
v_mov_b32 v9,1
v_mov_b32 v10,1
v_mov_b32 v11,1
s_add_u32 s64,s62,27262976
s_xor_b32 s65,s62,0x2000
s_add_u32 s65,s65,163577856
buffer_store_dwordx4 v[8:11],v24,s[20:23],s64 offen sc1
buffer_store_dwordx4 v[8:11],v25,s[20:23],s64 offen sc1
buffer_store_dwordx4 v[8:11],v24,s[20:23],s65 offen sc1
buffer_store_dwordx4 v[8:11],v25,s[20:23],s65 offen sc1
s_mov_b32 s82,0x3a800000
s_waitcnt vmcnt(0)
v_add_f32 v40,1.0,v40
v_add_f32 v41,1.0,v41
v_add_f32 v42,1.0,v42
v_add_f32 v43,1.0,v43
v_add_f32 v44,1.0,v44
v_add_f32 v45,1.0,v45
v_add_f32 v46,1.0,v46
v_add_f32 v47,1.0,v47
v_add_f32 v48,1.0,v48
v_add_f32 v49,1.0,v49
v_add_f32 v50,1.0,v50
v_add_f32 v51,1.0,v51
v_add_f32 v52,1.0,v52
v_add_f32 v53,1.0,v53
v_add_f32 v54,1.0,v54
v_add_f32 v55,1.0,v55
s_add_u32 s64,s79,0
s_lshl_b32 s70,s64,21
s_lshl_b32 s64,s64,13
s_and_b32 s64,s64,0x2000
s_xor_b32 s64,s64,s62
s_add_u32 s70,s70,s64
s_add_u32 s70,s70,29360128
lloop_275:
s_add_u32 s75,s70,2097152
s_xor_b32 s75,s75,0x2000
s_add_u32 s96,s71,1
s_cmp_eq_u32 s83,0
s_cbranch_scc1 lahead_278
s_cmp_gt_u32 s71,51
s_cbranch_scc1 xp_276
pl_280:
buffer_load_dword v29,v21,s[20:23],s74 offen sc1
s_waitcnt vmcnt(0)
v_cmp_gt_u32 vcc,s71,v29
s_cbranch_vccz pok_281
s_sleep 1
s_sub_u32 s90,s90,1
s_cmp_gt_i32 s90,0
s_cbranch_scc1 pl_280
pok_281:
xp_276:
buffer_load_dwordx4 v[8:11],v17,s[20:23],s70 offen sc1
buffer_load_dwordx4 v[12:15],v18,s[20:23],s70 offen sc1
s_waitcnt vmcnt(0)
v_min3_u32 v22,v8,v10,v12
v_min_u32 v22,v22,v14
v_cmp_eq_u32 vcc,0,v22
s_cbranch_vccz xk_277
s_sleep 1
s_sub_u32 s90,s90,1
s_cmp_gt_i32 s90,0
s_cbranch_scc1 xp_276
s_branch xk_277
lahead_278:
s_waitcnt vmcnt(6)
v_mov_b32 v8,v104
v_mov_b32 v9,v105
v_mov_b32 v10,v106
v_mov_b32 v11,v107
v_mov_b32 v12,v108
v_mov_b32 v13,v109
v_mov_b32 v14,v110
v_mov_b32 v15,v111
v_min3_u32 v22,v8,v10,v12
v_min_u32 v22,v22,v14
v_cmp_eq_u32 vcc,0,v22
s_cbranch_vccnz xp_276
xk_277:
v_cmp_gt_u32 vcc,s96,v29
s_or_b32 s83,vcc_lo,vcc_hi
s_cselect_b32 s76,0x7fff0000,s75
buffer_load_dwordx4 v[104:107],v17,s[20:23],s76 offen sc1
buffer_load_dwordx4 v[108:111],v18,s[20:23],s76 offen sc1
buffer_load_dword v29,v21,s[20:23],s74 offen sc1
v_lshlrev_b32 v80,16,v8
v_and_b32 v81,s80,v8
v_lshlrev_b32 v82,16,v9
v_and_b32 v83,s80,v9
v_lshlrev_b32 v84,16,v10
v_and_b32 v85,s80,v10
v_lshlrev_b32 v86,16,v11
v_and_b32 v87,s80,v11
v_lshlrev_b32 v88,16,v12
v_and_b32 v89,s80,v12
v_lshlrev_b32 v90,16,v13
v_and_b32 v91,s80,v13
v_lshlrev_b32 v92,16,v14
v_and_b32 v93,s80,v14
v_lshlrev_b32 v94,16,v15
v_and_b32 v95,s80,v15
v_pk_add_f32 v[96:97],v[80:81],v[82:83]
v_pk_mul_f32 v[100:101],v[80:81],v[80:81]
v_pk_add_f32 v[98:99],v[88:89],v[90:91]
v_pk_mul_f32 v[102:103],v[88:89],v[88:89]
v_pk_fma_f32 v[100:101],v[82:83],v[82:83],v[100:101]
v_pk_fma_f32 v[102:103],v[90:91],v[90:91],v[102:103]
v_pk_add_f32 v[96:97],v[96:97],v[84:85]
v_pk_fma_f32 v[100:101],v[84:85],v[84:85],v[100:101]
v_pk_add_f32 v[98:99],v[98:99],v[92:93]
v_pk_fma_f32 v[102:103],v[92:93],v[92:93],v[102:103]
v_pk_add_f32 v[96:97],v[96:97],v[86:87]
v_pk_fma_f32 v[100:101],v[86:87],v[86:87],v[100:101]
v_pk_add_f32 v[98:99],v[98:99],v[94:95]
v_pk_fma_f32 v[102:103],v[94:95],v[94:95],v[102:103]
v_pk_add_f32 v[96:97],v[96:97],v[98:99]
v_pk_add_f32 v[100:101],v[100:101],v[102:103]
v_add_f32 v96,v96,v97
v_add_f32 v97,v100,v101
s_nop 0
v_add_f32_dpp v96,v96,v96 quad_perm:[1,0,3,2] row_mask:0xf bank_mask:0xf
v_add_f32_dpp v97,v97,v97 quad_perm:[1,0,3,2] row_mask:0xf bank_mask:0xf
s_nop 0
v_add_f32_dpp v96,v96,v96 quad_perm:[2,3,0,1] row_mask:0xf bank_mask:0xf
v_add_f32_dpp v97,v97,v97 quad_perm:[2,3,0,1] row_mask:0xf bank_mask:0xf
s_nop 0
v_add_f32_dpp v96,v96,v96 row_half_mirror row_mask:0xf bank_mask:0xf
v_add_f32_dpp v97,v97,v97 row_half_mirror row_mask:0xf bank_mask:0xf
s_nop 0
v_add_f32_dpp v96,v96,v96 row_mirror row_mask:0xf bank_mask:0xf
v_add_f32_dpp v97,v97,v97 row_mirror row_mask:0xf bank_mask:0xf
v_mov_b32 v98,v96
v_mov_b32 v99,v97
s_nop 0
v_permlane16_swap_b32 v98,v96
v_permlane16_swap_b32 v99,v97
v_pk_add_f32 v[96:97],v[96:97],v[98:99]
v_mov_b32 v98,v96
v_mov_b32 v99,v97
s_nop 0
v_permlane32_swap_b32 v98,v96
v_permlane32_swap_b32 v99,v97
v_pk_add_f32 v[96:97],v[96:97],v[98:99]
v_mul_f32 v96,0xba800000,v96
v_mul_f32 v98,v96,v96
v_fma_f32 v98,v97,s82,-v98
v_max_f32 v98,0,v98
v_add_f32 v98,0x3727c5ac,v98
v_rsq_f32 v98,v98
s_nop 0
v_mul_f32 v96,v96,v98
v_pk_fma_f32 v[80:81],v[80:81],v[98:99],v[96:97] op_sel_hi:[1,0,0]
v_pk_fma_f32 v[82:83],v[82:83],v[98:99],v[96:97] op_sel_hi:[1,0,0]
v_pk_fma_f32 v[84:85],v[84:85],v[98:99],v[96:97] op_sel_hi:[1,0,0]
v_pk_fma_f32 v[86:87],v[86:87],v[98:99],v[96:97] op_sel_hi:[1,0,0]
v_pk_fma_f32 v[88:89],v[88:89],v[98:99],v[96:97] op_sel_hi:[1,0,0]
v_pk_fma_f32 v[90:91],v[90:91],v[98:99],v[96:97] op_sel_hi:[1,0,0]
v_pk_fma_f32 v[92:93],v[92:93],v[98:99],v[96:97] op_sel_hi:[1,0,0]
v_pk_fma_f32 v[94:95],v[94:95],v[98:99],v[96:97] op_sel_hi:[1,0,0]
v_pk_fma_f32 v[80:81],v[80:81],v[40:41],v[56:57]
v_pk_fma_f32 v[82:83],v[82:83],v[42:43],v[58:59]
v_pk_fma_f32 v[84:85],v[84:85],v[44:45],v[60:61]
v_pk_fma_f32 v[86:87],v[86:87],v[46:47],v[62:63]
v_pk_fma_f32 v[88:89],v[88:89],v[48:49],v[64:65]
v_pk_fma_f32 v[90:91],v[90:91],v[50:51],v[66:67]
v_pk_fma_f32 v[92:93],v[92:93],v[52:53],v[68:69]
v_pk_fma_f32 v[94:95],v[94:95],v[54:55],v[70:71]
v_cvt_pk_bf16_f32 v8,v80,v81
v_cvt_pk_bf16_f32 v9,v82,v83
v_cvt_pk_bf16_f32 v10,v84,v85
v_cvt_pk_bf16_f32 v11,v86,v87
v_cvt_pk_bf16_f32 v12,v88,v89
v_cvt_pk_bf16_f32 v13,v90,v91
v_cvt_pk_bf16_f32 v14,v92,v93
v_cvt_pk_bf16_f32 v15,v94,v95
v_max_u32 v8,1,v8
v_max_u32 v10,1,v10
v_max_u32 v12,1,v12
v_max_u32 v14,1,v14
s_xor_b32 s78,s70,0x2000
s_waitcnt vmcnt(3)
v_add_u32 v22,s71,-1
buffer_store_dword v22,v23,s[24:27],s73 offen
buffer_store_dword v22,v23,s[28:31],s73 offen sc1
buffer_store_dwordx4 v[8:11],v24,s[20:23],s78 offen sc1
buffer_store_dwordx4 v[12:15],v25,s[20:23],s78 offen sc1
v_lshlrev_b32 v80,16,v8
v_and_b32 v81,s80,v8
v_lshlrev_b32 v82,16,v9
v_and_b32 v83,s80,v9
v_lshlrev_b32 v84,16,v10
v_and_b32 v85,s80,v10
v_lshlrev_b32 v86,16,v11
v_and_b32 v87,s80,v11
v_lshlrev_b32 v88,16,v12
v_and_b32 v89,s80,v12
v_lshlrev_b32 v90,16,v13
v_and_b32 v91,s80,v13
v_lshlrev_b32 v92,16,v14
v_and_b32 v93,s80,v14
v_lshlrev_b32 v94,16,v15
v_and_b32 v95,s80,v15
v_pk_add_f32 v[96:97],v[80:81],v[82:83]
v_pk_mul_f32 v[100:101],v[80:81],v[80:81]
v_pk_add_f32 v[98:99],v[88:89],v[90:91]
v_pk_mul_f32 v[102:103],v[88:89],v[88:89]
v_pk_fma_f32 v[100:101],v[82:83],v[82:83],v[100:101]
v_pk_fma_f32 v[102:103],v[90:91],v[90:91],v[102:103]
v_pk_add_f32 v[96:97],v[96:97],v[84:85]
v_pk_fma_f32 v[100:101],v[84:85],v[84:85],v[100:101]
v_pk_add_f32 v[98:99],v[98:99],v[92:93]
v_pk_fma_f32 v[102:103],v[92:93],v[92:93],v[102:103]
v_pk_add_f32 v[96:97],v[96:97],v[86:87]
v_pk_fma_f32 v[100:101],v[86:87],v[86:87],v[100:101]
v_pk_add_f32 v[98:99],v[98:99],v[94:95]
v_pk_fma_f32 v[102:103],v[94:95],v[94:95],v[102:103]
v_pk_add_f32 v[96:97],v[96:97],v[98:99]
v_pk_add_f32 v[100:101],v[100:101],v[102:103]
v_add_f32 v96,v96,v97
v_add_f32 v97,v100,v101
s_nop 0
v_add_f32_dpp v96,v96,v96 quad_perm:[1,0,3,2] row_mask:0xf bank_mask:0xf
v_add_f32_dpp v97,v97,v97 quad_perm:[1,0,3,2] row_mask:0xf bank_mask:0xf
s_nop 0
v_add_f32_dpp v96,v96,v96 quad_perm:[2,3,0,1] row_mask:0xf bank_mask:0xf
v_add_f32_dpp v97,v97,v97 quad_perm:[2,3,0,1] row_mask:0xf bank_mask:0xf
s_nop 0
v_add_f32_dpp v96,v96,v96 row_half_mirror row_mask:0xf bank_mask:0xf
v_add_f32_dpp v97,v97,v97 row_half_mirror row_mask:0xf bank_mask:0xf
s_nop 0
v_add_f32_dpp v96,v96,v96 row_mirror row_mask:0xf bank_mask:0xf
v_add_f32_dpp v97,v97,v97 row_mirror row_mask:0xf bank_mask:0xf
v_mov_b32 v98,v96
v_mov_b32 v99,v97
s_nop 0
v_permlane16_swap_b32 v98,v96
v_permlane16_swap_b32 v99,v97
v_pk_add_f32 v[96:97],v[96:97],v[98:99]
v_mov_b32 v98,v96
v_mov_b32 v99,v97
s_nop 0
v_permlane32_swap_b32 v98,v96
v_permlane32_swap_b32 v99,v97
v_pk_add_f32 v[96:97],v[96:97],v[98:99]
v_mul_f32 v96,0xba800000,v96
v_mul_f32 v98,v96,v96
v_fma_f32 v98,v97,s82,-v98
v_max_f32 v98,0,v98
v_add_f32 v98,0x3727c5ac,v98
v_rsq_f32 v98,v98
s_nop 0
v_mul_f32 v96,v96,v98
v_pk_fma_f32 v[80:81],v[80:81],v[98:99],v[96:97] op_sel_hi:[1,0,0]
v_pk_fma_f32 v[82:83],v[82:83],v[98:99],v[96:97] op_sel_hi:[1,0,0]
v_pk_fma_f32 v[84:85],v[84:85],v[98:99],v[96:97] op_sel_hi:[1,0,0]
v_pk_fma_f32 v[86:87],v[86:87],v[98:99],v[96:97] op_sel_hi:[1,0,0]
v_pk_fma_f32 v[88:89],v[88:89],v[98:99],v[96:97] op_sel_hi:[1,0,0]
v_pk_fma_f32 v[90:91],v[90:91],v[98:99],v[96:97] op_sel_hi:[1,0,0]
v_pk_fma_f32 v[92:93],v[92:93],v[98:99],v[96:97] op_sel_hi:[1,0,0]
v_pk_fma_f32 v[94:95],v[94:95],v[98:99],v[96:97] op_sel_hi:[1,0,0]
v_cvt_pk_bf16_f32 v72,v80,v81
v_cvt_pk_bf16_f32 v73,v82,v83
v_cvt_pk_bf16_f32 v74,v84,v85
v_cvt_pk_bf16_f32 v75,v86,v87
v_cvt_pk_bf16_f32 v76,v88,v89
v_cvt_pk_bf16_f32 v77,v90,v91
v_cvt_pk_bf16_f32 v78,v92,v93
v_cvt_pk_bf16_f32 v79,v94,v95
v_max_u32 v72,1,v72
v_max_u32 v76,1,v76
buffer_store_dwordx4 v[72:75],v19,s[20:23],s70 offen sc1
buffer_store_dwordx4 v[76:79],v19,s[20:23],s70 offen offset:1024 sc1
s_cmp_gt_u32 s71,51
s_cbranch_scc1 fnow_282
s_cmp_eq_u32 s83,0
s_cbranch_scc1 flater_283
s_waitcnt vmcnt(0)
fnow_282:
v_mov_b32 v22,s71
buffer_store_dword v22,v23,s[24:27],s73 offen
buffer_store_dword v22,v23,s[28:31],s73 offen sc1
flater_283:
s_mov_b32 s70,s75
s_add_u32 s79,s79,1
s_add_u32 s71,s71,1
s_cmp_lt_u32 s79,64
s_cbranch_scc1 lloop_275
s_endpgm
r_wo_214:
s_load_dwordx2 s[4:5],s[0:1],40
s_load_dwordx2 s[6:7],s[0:1],0
s_lshr_b32 s41,s59,3
s_and_b32 s42,s59,7
s_mul_i32 s66,s41,2097152
s_lshl_b32 s64,s42,8
s_add_u32 s66,s66,s64
s_lshl_b32 s67,s50,1
s_and_b32 s64,s41,1
s_add_u32 s67,s67,s64
s_waitcnt lgkmcnt(0)
s_mov_b32 s32,s4
s_and_b32 s33,s5,0xffff
s_mov_b32 s34,0x800000
s_mov_b32 s35,0x20000
s_mov_b32 s36,s6
s_and_b32 s37,s7,0xffff
s_mov_b32 s38,0x400000
s_mov_b32 s39,0x20000
v_lshrrev_b32 v5,2,v3
v_lshl_add_u32 v5,v4,2,v5
v_and_b32 v6,3,v3
v_lshlrev_b32 v6,3,v6
v_lshl_add_u32 v6,v5,8,v6
v_and_b32 v5,7,v5
v_xor_b32 v5,s67,v5
v_lshl_add_u32 v12,v5,5,v6
v_xor_b32 v13,32,v12
v_and_b32 v5,15,v1
v_and_b32 v6,3,v4
v_lshlrev_b32 v6,1,v6
v_xor_b32 v5,v5,v6
v_mul_u32_u24 v6,2048,v4
v_xor_b32 v7,0,v5
v_lshl_add_u32 v8,v7,4,v6
v_xor_b32 v7,8,v5
v_lshl_add_u32 v9,v7,4,v6
s_mul_i32 s74,s50,131072
s_add_u32 s74,s74,s66
s_lshl_b32 s75,s50,14
s_mul_i32 s76,s50,65536
s_add_u32 s76,s76,s66
s_lshl_b32 s77,s50,13
s_add_u32 s64,s74,0
s_add_u32 m0,s75,0
s_nop 0
buffer_load_dwordx4 v8,s[32:35],s64 offen nt lds
s_add_u32 s64,s74,8192
s_add_u32 m0,s75,1024
s_nop 0
buffer_load_dwordx4 v9,s[32:35],s64 offen nt lds
s_add_u32 s64,s74,16384
s_add_u32 m0,s75,2048
s_nop 0
buffer_load_dwordx4 v8,s[32:35],s64 offen nt lds
s_add_u32 s64,s74,24576
s_add_u32 m0,s75,3072
s_nop 0
buffer_load_dwordx4 v9,s[32:35],s64 offen nt lds
s_add_u32 s64,s74,32768
s_add_u32 m0,s75,4096
s_nop 0
buffer_load_dwordx4 v8,s[32:35],s64 offen nt lds
s_add_u32 s64,s74,40960
s_add_u32 m0,s75,5120
s_nop 0
buffer_load_dwordx4 v9,s[32:35],s64 offen nt lds
s_add_u32 s64,s74,49152
s_add_u32 m0,s75,6144
s_nop 0
buffer_load_dwordx4 v8,s[32:35],s64 offen nt lds
s_add_u32 s64,s74,57344
s_add_u32 m0,s75,7168
s_nop 0
buffer_load_dwordx4 v9,s[32:35],s64 offen nt lds
s_add_u32 s64,s74,65536
s_add_u32 m0,s75,8192
s_nop 0
buffer_load_dwordx4 v8,s[32:35],s64 offen nt lds
s_add_u32 s64,s74,73728
s_add_u32 m0,s75,9216
s_nop 0
buffer_load_dwordx4 v9,s[32:35],s64 offen nt lds
s_add_u32 s64,s74,81920
s_add_u32 m0,s75,10240
s_nop 0
buffer_load_dwordx4 v8,s[32:35],s64 offen nt lds
s_add_u32 s64,s74,90112
s_add_u32 m0,s75,11264
s_nop 0
buffer_load_dwordx4 v9,s[32:35],s64 offen nt lds
s_add_u32 s64,s74,98304
s_add_u32 m0,s75,12288
s_nop 0
buffer_load_dwordx4 v8,s[32:35],s64 offen nt lds
s_add_u32 s64,s74,106496
s_add_u32 m0,s75,13312
s_nop 0
buffer_load_dwordx4 v9,s[32:35],s64 offen nt lds
s_add_u32 s64,s74,114688
s_add_u32 m0,s75,14336
s_nop 0
buffer_load_dwordx4 v8,s[32:35],s64 offen nt lds
s_add_u32 s64,s74,122880
s_add_u32 m0,s75,15360
s_nop 0
buffer_load_dwordx4 v9,s[32:35],s64 offen nt lds
s_add_u32 s64,s74,524288
s_add_u32 m0,s75,65536
s_nop 0
buffer_load_dwordx4 v8,s[32:35],s64 offen nt lds
s_add_u32 s64,s74,532480
s_add_u32 m0,s75,66560
s_nop 0
buffer_load_dwordx4 v9,s[32:35],s64 offen nt lds
s_add_u32 s64,s74,540672
s_add_u32 m0,s75,67584
s_nop 0
buffer_load_dwordx4 v8,s[32:35],s64 offen nt lds
s_add_u32 s64,s74,548864
s_add_u32 m0,s75,68608
s_nop 0
buffer_load_dwordx4 v9,s[32:35],s64 offen nt lds
s_add_u32 s64,s74,557056
s_add_u32 m0,s75,69632
s_nop 0
buffer_load_dwordx4 v8,s[32:35],s64 offen nt lds
s_add_u32 s64,s74,565248
s_add_u32 m0,s75,70656
s_nop 0
buffer_load_dwordx4 v9,s[32:35],s64 offen nt lds
s_add_u32 s64,s74,573440
s_add_u32 m0,s75,71680
s_nop 0
buffer_load_dwordx4 v8,s[32:35],s64 offen nt lds
s_add_u32 s64,s74,581632
s_add_u32 m0,s75,72704
s_nop 0
buffer_load_dwordx4 v9,s[32:35],s64 offen nt lds
s_add_u32 s64,s74,589824
s_add_u32 m0,s75,73728
s_nop 0
buffer_load_dwordx4 v8,s[32:35],s64 offen nt lds
s_add_u32 s64,s74,598016
s_add_u32 m0,s75,74752
s_nop 0
buffer_load_dwordx4 v9,s[32:35],s64 offen nt lds
s_add_u32 s64,s74,606208
s_add_u32 m0,s75,75776
s_nop 0
buffer_load_dwordx4 v8,s[32:35],s64 offen nt lds
s_add_u32 s64,s74,614400
s_add_u32 m0,s75,76800
s_nop 0
buffer_load_dwordx4 v9,s[32:35],s64 offen nt lds
s_add_u32 s64,s74,622592
s_add_u32 m0,s75,77824
s_nop 0
buffer_load_dwordx4 v8,s[32:35],s64 offen nt lds
s_add_u32 s64,s74,630784
s_add_u32 m0,s75,78848
s_nop 0
buffer_load_dwordx4 v9,s[32:35],s64 offen nt lds
s_add_u32 s64,s74,638976
s_add_u32 m0,s75,79872
s_nop 0
buffer_load_dwordx4 v8,s[32:35],s64 offen nt lds
s_add_u32 s64,s74,647168
s_add_u32 m0,s75,80896
s_nop 0
buffer_load_dwordx4 v9,s[32:35],s64 offen nt lds
s_waitcnt vmcnt(16)
s_barrier
ds_read_b64_tr_b16 a[0:1],v12 offset:0
ds_read_b64_tr_b16 a[128:129],v13 offset:0
ds_read_b64_tr_b16 a[2:3],v12 offset:4096
ds_read_b64_tr_b16 a[130:131],v13 offset:4096
ds_read_b64_tr_b16 a[4:5],v12 offset:8192
ds_read_b64_tr_b16 a[132:133],v13 offset:8192
ds_read_b64_tr_b16 a[6:7],v12 offset:12288
ds_read_b64_tr_b16 a[134:135],v13 offset:12288
s_waitcnt lgkmcnt(4)
ds_read_b64_tr_b16 a[8:9],v12 offset:16384
ds_read_b64_tr_b16 a[136:137],v13 offset:16384
ds_read_b64_tr_b16 a[10:11],v12 offset:20480
ds_read_b64_tr_b16 a[138:139],v13 offset:20480
ds_read_b64_tr_b16 a[12:13],v12 offset:24576
ds_read_b64_tr_b16 a[140:141],v13 offset:24576
ds_read_b64_tr_b16 a[14:15],v12 offset:28672
ds_read_b64_tr_b16 a[142:143],v13 offset:28672
s_waitcnt lgkmcnt(4)
ds_read_b64_tr_b16 a[16:17],v12 offset:32768
ds_read_b64_tr_b16 a[144:145],v13 offset:32768
ds_read_b64_tr_b16 a[18:19],v12 offset:36864
ds_read_b64_tr_b16 a[146:147],v13 offset:36864
ds_read_b64_tr_b16 a[20:21],v12 offset:40960
ds_read_b64_tr_b16 a[148:149],v13 offset:40960
ds_read_b64_tr_b16 a[22:23],v12 offset:45056
ds_read_b64_tr_b16 a[150:151],v13 offset:45056
s_waitcnt lgkmcnt(4)
ds_read_b64_tr_b16 a[24:25],v12 offset:49152
ds_read_b64_tr_b16 a[152:153],v13 offset:49152
ds_read_b64_tr_b16 a[26:27],v12 offset:53248
ds_read_b64_tr_b16 a[154:155],v13 offset:53248
ds_read_b64_tr_b16 a[28:29],v12 offset:57344
ds_read_b64_tr_b16 a[156:157],v13 offset:57344
ds_read_b64_tr_b16 a[30:31],v12 offset:61440
ds_read_b64_tr_b16 a[158:159],v13 offset:61440
s_waitcnt lgkmcnt(4)
v_xor_b32 v12,0x10000,v12
v_xor_b32 v13,0x10000,v13
s_waitcnt lgkmcnt(0)
s_barrier
s_add_u32 s64,s74,1048576
s_add_u32 m0,s75,0
s_nop 0
buffer_load_dwordx4 v8,s[32:35],s64 offen nt lds
s_add_u32 s64,s74,1056768
s_add_u32 m0,s75,1024
s_nop 0
buffer_load_dwordx4 v9,s[32:35],s64 offen nt lds
s_add_u32 s64,s74,1064960
s_add_u32 m0,s75,2048
s_nop 0
buffer_load_dwordx4 v8,s[32:35],s64 offen nt lds
s_add_u32 s64,s74,1073152
s_add_u32 m0,s75,3072
s_nop 0
buffer_load_dwordx4 v9,s[32:35],s64 offen nt lds
s_add_u32 s64,s74,1081344
s_add_u32 m0,s75,4096
s_nop 0
buffer_load_dwordx4 v8,s[32:35],s64 offen nt lds
s_add_u32 s64,s74,1089536
s_add_u32 m0,s75,5120
s_nop 0
buffer_load_dwordx4 v9,s[32:35],s64 offen nt lds
s_add_u32 s64,s74,1097728
s_add_u32 m0,s75,6144
s_nop 0
buffer_load_dwordx4 v8,s[32:35],s64 offen nt lds
s_add_u32 s64,s74,1105920
s_add_u32 m0,s75,7168
s_nop 0
buffer_load_dwordx4 v9,s[32:35],s64 offen nt lds
s_add_u32 s64,s74,1114112
s_add_u32 m0,s75,8192
s_nop 0
buffer_load_dwordx4 v8,s[32:35],s64 offen nt lds
s_add_u32 s64,s74,1122304
s_add_u32 m0,s75,9216
s_nop 0
buffer_load_dwordx4 v9,s[32:35],s64 offen nt lds
s_add_u32 s64,s74,1130496
s_add_u32 m0,s75,10240
s_nop 0
buffer_load_dwordx4 v8,s[32:35],s64 offen nt lds
s_add_u32 s64,s74,1138688
s_add_u32 m0,s75,11264
s_nop 0
buffer_load_dwordx4 v9,s[32:35],s64 offen nt lds
s_add_u32 s64,s74,1146880
s_add_u32 m0,s75,12288
s_nop 0
buffer_load_dwordx4 v8,s[32:35],s64 offen nt lds
s_add_u32 s64,s74,1155072
s_add_u32 m0,s75,13312
s_nop 0
buffer_load_dwordx4 v9,s[32:35],s64 offen nt lds
s_add_u32 s64,s74,1163264
s_add_u32 m0,s75,14336
s_nop 0
buffer_load_dwordx4 v8,s[32:35],s64 offen nt lds
s_add_u32 s64,s74,1171456
s_add_u32 m0,s75,15360
s_nop 0
buffer_load_dwordx4 v9,s[32:35],s64 offen nt lds
s_waitcnt vmcnt(16)
s_barrier
ds_read_b64_tr_b16 a[32:33],v12 offset:0
ds_read_b64_tr_b16 a[160:161],v13 offset:0
ds_read_b64_tr_b16 a[34:35],v12 offset:4096
ds_read_b64_tr_b16 a[162:163],v13 offset:4096
ds_read_b64_tr_b16 a[36:37],v12 offset:8192
ds_read_b64_tr_b16 a[164:165],v13 offset:8192
ds_read_b64_tr_b16 a[38:39],v12 offset:12288
ds_read_b64_tr_b16 a[166:167],v13 offset:12288
s_waitcnt lgkmcnt(4)
ds_read_b64_tr_b16 a[40:41],v12 offset:16384
ds_read_b64_tr_b16 a[168:169],v13 offset:16384
ds_read_b64_tr_b16 a[42:43],v12 offset:20480
ds_read_b64_tr_b16 a[170:171],v13 offset:20480
ds_read_b64_tr_b16 a[44:45],v12 offset:24576
ds_read_b64_tr_b16 a[172:173],v13 offset:24576
ds_read_b64_tr_b16 a[46:47],v12 offset:28672
ds_read_b64_tr_b16 a[174:175],v13 offset:28672
s_waitcnt lgkmcnt(4)
ds_read_b64_tr_b16 a[48:49],v12 offset:32768
ds_read_b64_tr_b16 a[176:177],v13 offset:32768
ds_read_b64_tr_b16 a[50:51],v12 offset:36864
ds_read_b64_tr_b16 a[178:179],v13 offset:36864
ds_read_b64_tr_b16 a[52:53],v12 offset:40960
ds_read_b64_tr_b16 a[180:181],v13 offset:40960
ds_read_b64_tr_b16 a[54:55],v12 offset:45056
ds_read_b64_tr_b16 a[182:183],v13 offset:45056
s_waitcnt lgkmcnt(4)
ds_read_b64_tr_b16 a[56:57],v12 offset:49152
ds_read_b64_tr_b16 a[184:185],v13 offset:49152
ds_read_b64_tr_b16 a[58:59],v12 offset:53248
ds_read_b64_tr_b16 a[186:187],v13 offset:53248
ds_read_b64_tr_b16 a[60:61],v12 offset:57344
ds_read_b64_tr_b16 a[188:189],v13 offset:57344
ds_read_b64_tr_b16 a[62:63],v12 offset:61440
ds_read_b64_tr_b16 a[190:191],v13 offset:61440
s_waitcnt lgkmcnt(4)
v_xor_b32 v12,0x10000,v12
v_xor_b32 v13,0x10000,v13
s_waitcnt lgkmcnt(0)
s_barrier
s_add_u32 s64,s74,1572864
s_add_u32 m0,s75,65536
s_nop 0
buffer_load_dwordx4 v8,s[32:35],s64 offen nt lds
s_add_u32 s64,s74,1581056
s_add_u32 m0,s75,66560
s_nop 0
buffer_load_dwordx4 v9,s[32:35],s64 offen nt lds
s_add_u32 s64,s74,1589248
s_add_u32 m0,s75,67584
s_nop 0
buffer_load_dwordx4 v8,s[32:35],s64 offen nt lds
s_add_u32 s64,s74,1597440
s_add_u32 m0,s75,68608
s_nop 0
buffer_load_dwordx4 v9,s[32:35],s64 offen nt lds
s_add_u32 s64,s74,1605632
s_add_u32 m0,s75,69632
s_nop 0
buffer_load_dwordx4 v8,s[32:35],s64 offen nt lds
s_add_u32 s64,s74,1613824
s_add_u32 m0,s75,70656
s_nop 0
buffer_load_dwordx4 v9,s[32:35],s64 offen nt lds
s_add_u32 s64,s74,1622016
s_add_u32 m0,s75,71680
s_nop 0
buffer_load_dwordx4 v8,s[32:35],s64 offen nt lds
s_add_u32 s64,s74,1630208
s_add_u32 m0,s75,72704
s_nop 0
buffer_load_dwordx4 v9,s[32:35],s64 offen nt lds
s_add_u32 s64,s74,1638400
s_add_u32 m0,s75,73728
s_nop 0
buffer_load_dwordx4 v8,s[32:35],s64 offen nt lds
s_add_u32 s64,s74,1646592
s_add_u32 m0,s75,74752
s_nop 0
buffer_load_dwordx4 v9,s[32:35],s64 offen nt lds
s_add_u32 s64,s74,1654784
s_add_u32 m0,s75,75776
s_nop 0
buffer_load_dwordx4 v8,s[32:35],s64 offen nt lds
s_add_u32 s64,s74,1662976
s_add_u32 m0,s75,76800
s_nop 0
buffer_load_dwordx4 v9,s[32:35],s64 offen nt lds
s_add_u32 s64,s74,1671168
s_add_u32 m0,s75,77824
s_nop 0
buffer_load_dwordx4 v8,s[32:35],s64 offen nt lds
s_add_u32 s64,s74,1679360
s_add_u32 m0,s75,78848
s_nop 0
buffer_load_dwordx4 v9,s[32:35],s64 offen nt lds
s_add_u32 s64,s74,1687552
s_add_u32 m0,s75,79872
s_nop 0
buffer_load_dwordx4 v8,s[32:35],s64 offen nt lds
s_add_u32 s64,s74,1695744
s_add_u32 m0,s75,80896
s_nop 0
buffer_load_dwordx4 v9,s[32:35],s64 offen nt lds
s_waitcnt vmcnt(16)
s_barrier
ds_read_b64_tr_b16 a[64:65],v12 offset:0
ds_read_b64_tr_b16 a[192:193],v13 offset:0
ds_read_b64_tr_b16 a[66:67],v12 offset:4096
ds_read_b64_tr_b16 a[194:195],v13 offset:4096
ds_read_b64_tr_b16 a[68:69],v12 offset:8192
ds_read_b64_tr_b16 a[196:197],v13 offset:8192
ds_read_b64_tr_b16 a[70:71],v12 offset:12288
ds_read_b64_tr_b16 a[198:199],v13 offset:12288
s_waitcnt lgkmcnt(4)
ds_read_b64_tr_b16 a[72:73],v12 offset:16384
ds_read_b64_tr_b16 a[200:201],v13 offset:16384
ds_read_b64_tr_b16 a[74:75],v12 offset:20480
ds_read_b64_tr_b16 a[202:203],v13 offset:20480
ds_read_b64_tr_b16 a[76:77],v12 offset:24576
ds_read_b64_tr_b16 a[204:205],v13 offset:24576
ds_read_b64_tr_b16 a[78:79],v12 offset:28672
ds_read_b64_tr_b16 a[206:207],v13 offset:28672
s_waitcnt lgkmcnt(4)
ds_read_b64_tr_b16 a[80:81],v12 offset:32768
ds_read_b64_tr_b16 a[208:209],v13 offset:32768
ds_read_b64_tr_b16 a[82:83],v12 offset:36864
ds_read_b64_tr_b16 a[210:211],v13 offset:36864
ds_read_b64_tr_b16 a[84:85],v12 offset:40960
ds_read_b64_tr_b16 a[212:213],v13 offset:40960
ds_read_b64_tr_b16 a[86:87],v12 offset:45056
ds_read_b64_tr_b16 a[214:215],v13 offset:45056
s_waitcnt lgkmcnt(4)
ds_read_b64_tr_b16 a[88:89],v12 offset:49152
ds_read_b64_tr_b16 a[216:217],v13 offset:49152
ds_read_b64_tr_b16 a[90:91],v12 offset:53248
ds_read_b64_tr_b16 a[218:219],v13 offset:53248
ds_read_b64_tr_b16 a[92:93],v12 offset:57344
ds_read_b64_tr_b16 a[220:221],v13 offset:57344
ds_read_b64_tr_b16 a[94:95],v12 offset:61440
ds_read_b64_tr_b16 a[222:223],v13 offset:61440
s_waitcnt lgkmcnt(4)
v_xor_b32 v12,0x10000,v12
v_xor_b32 v13,0x10000,v13
s_waitcnt lgkmcnt(0)
s_barrier
s_waitcnt vmcnt(0)
s_barrier
ds_read_b64_tr_b16 a[96:97],v12 offset:0
ds_read_b64_tr_b16 a[224:225],v13 offset:0
ds_read_b64_tr_b16 a[98:99],v12 offset:4096
ds_read_b64_tr_b16 a[226:227],v13 offset:4096
ds_read_b64_tr_b16 a[100:101],v12 offset:8192
ds_read_b64_tr_b16 a[228:229],v13 offset:8192
ds_read_b64_tr_b16 a[102:103],v12 offset:12288
ds_read_b64_tr_b16 a[230:231],v13 offset:12288
s_waitcnt lgkmcnt(4)
ds_read_b64_tr_b16 a[104:105],v12 offset:16384
ds_read_b64_tr_b16 a[232:233],v13 offset:16384
ds_read_b64_tr_b16 a[106:107],v12 offset:20480
ds_read_b64_tr_b16 a[234:235],v13 offset:20480
ds_read_b64_tr_b16 a[108:109],v12 offset:24576
ds_read_b64_tr_b16 a[236:237],v13 offset:24576
ds_read_b64_tr_b16 a[110:111],v12 offset:28672
ds_read_b64_tr_b16 a[238:239],v13 offset:28672
s_waitcnt lgkmcnt(4)
ds_read_b64_tr_b16 a[112:113],v12 offset:32768
ds_read_b64_tr_b16 a[240:241],v13 offset:32768
ds_read_b64_tr_b16 a[114:115],v12 offset:36864
ds_read_b64_tr_b16 a[242:243],v13 offset:36864
ds_read_b64_tr_b16 a[116:117],v12 offset:40960
ds_read_b64_tr_b16 a[244:245],v13 offset:40960
ds_read_b64_tr_b16 a[118:119],v12 offset:45056
ds_read_b64_tr_b16 a[246:247],v13 offset:45056
s_waitcnt lgkmcnt(4)
ds_read_b64_tr_b16 a[120:121],v12 offset:49152
ds_read_b64_tr_b16 a[248:249],v13 offset:49152
ds_read_b64_tr_b16 a[122:123],v12 offset:53248
ds_read_b64_tr_b16 a[250:251],v13 offset:53248
ds_read_b64_tr_b16 a[124:125],v12 offset:57344
ds_read_b64_tr_b16 a[252:253],v13 offset:57344
ds_read_b64_tr_b16 a[126:127],v12 offset:61440
ds_read_b64_tr_b16 a[254:255],v13 offset:61440
s_waitcnt lgkmcnt(4)
v_xor_b32 v12,0x10000,v12
v_xor_b32 v13,0x10000,v13
s_waitcnt lgkmcnt(0)
s_barrier
v_and_b32 v21,1,v1
v_mul_u32_u24 v21,960,v21
s_mov_b32 s65,21052032
s_mov_b32 s66,1792
pl_284:
buffer_load_dword v22,v21,s[20:23],s65 offen sc1
s_waitcnt vmcnt(0)
v_cmp_gt_u32 vcc,s66,v22
s_cbranch_vccz pok_285
s_sleep 1
s_sub_u32 s90,s90,1
s_cmp_gt_i32 s90,0
s_cbranch_scc1 pl_284
pok_285:
s_lshr_b32 s43,s41,1
s_and_b32 s48,s41,1
s_lshl_b32 s64,s42,7
s_lshl_b32 s65,s50,5
s_add_u32 s64,s64,s65
s_lshl_b32 s65,s48,4
s_add_u32 s64,s64,s65
v_lshl_add_u32 v5,v4,2,s64
v_lshlrev_b32 v6,2,v5
s_mov_b32 s64,8192
buffer_load_dwordx4 v[52:55],v6,s[20:23],s64 offen sc1
v_lshlrev_b32 v10,1,v5
v_and_b32 v6,3,v1
v_sub_u32 v5,v6,v4
v_lshl_add_u32 v5,v5,3,v10
v_lshrrev_b32 v11,2,v1
v_lshl_add_u32 v40,v6,4,v11
v_lshlrev_b32 v40,2,v40
v_lshl_add_u32 v41,v3,2,v4
v_lshlrev_b32 v41,2,v41
s_lshl_b32 s64,s43,10
v_add_u32 v17,s64,v16
v_xor_b32 v18,1024,v17
s_xor_b32 s64,s64,1024
s_lshr_b32 s65,s50,1
s_and_b32 s66,s50,1
s_lshl_b32 s66,s66,12
s_add_u32 s66,s66,s64
s_lshl_b32 s72,s65,13
s_add_u32 s72,s72,s66
s_add_u32 s72,s72,0x10000
s_lshl_b32 s65,s65,14
s_add_u32 s75,s65,s66
s_add_u32 s75,s75,524288
s_mul_i32 s64,s41,131072
s_add_u32 s75,s75,s64
s_cmp_lt_u32 s50,2
s_cselect_b32 s86,98304,0x40000000
s_lshl_b32 s76,s79,21
s_add_u32 s76,s76,27262976
s_mov_b32 s77,0
s_lshl_b32 s78,s79,16
s_mov_b32 s49,0
s_cmp_eq_u32 s79,0
s_mov_b32 s66,8577024
s_cselect_b32 s66,17825792,s66
s_lshl_b32 s64,s59,14
s_lshl_b32 s65,s50,12
s_add_u32 s65,s65,s66
s_add_u32 s64,s64,s65
v_add_u32 v26,s64,v16
s_lshl_b32 s64,s42,14
s_add_u32 s64,s64,s65
v_add_u32 v25,s64,v16
s_xor_b32 s33,s41,1
s_xor_b32 s34,s41,2
s_xor_b32 s35,s41,3
s_lshl_b32 s33,s33,17
s_lshl_b32 s34,s34,17
s_lshl_b32 s35,s35,17
v_and_b32 v21,7,v1
v_lshlrev_b32 v21,7,v21
v_bfe_u32 v6,v1,3,0
v_lshl_add_u32 v21,v6,2,v21
s_lshl_b32 s74,s41,10
s_add_u32 s74,s74,s63
s_lshl_b32 s64,s60,4
s_add_u32 s74,s74,s64
s_add_u32 s74,s74,16384
v_lshrrev_b32 v6,2,v11
v_and_b32 v7,3,v11
v_lshl_add_u32 v6,v6,1,s43
v_lshl_add_u32 v8,v6,2,v7
v_lshl_add_u32 v8,v8,7,v5
v_and_b32 v8,2047,v8
v_lshl_add_u32 v8,v7,11,v8
v_lshl_add_u32 v7,v7,11,v5
v_lshl_add_u32 v20,v6,13,v7
v_lshl_add_u32 v19,v6,14,v8
v_add_u32 v19,1048576,v19
s_lshl_b32 s73,s59,2
s_add_u32 s73,s73,s50
s_lshl_b32 s73,s73,2
s_add_u32 s73,s73,s63
s_add_u32 s73,s73,2048
s_mov_b32 s48,1
s_waitcnt vmcnt(0)
s_cmp_lg_u32 s56,0
s_cbranch_scc1 kslow_286
s_add_u32 s64,s79,0
s_lshl_b32 s70,s64,21
s_lshl_b32 s64,s64,13
s_and_b32 s64,s64,0x2000
s_xor_b32 s64,s64,s62
s_add_u32 s70,s70,s64
s_add_u32 s70,s70,29360128
s_mov_b32 s83,1
s_mov_b32 s87,s74
s_cmp_eq_u32 s50,0
s_cselect_b32 s74,s74,0x7fff0000
v_mov_b32 v47,132096
s_lshl_b32 s64,s50,3
s_add_u32 s64,s64,132096
v_mov_b32 v46,s64
v_mov_b32 v29,0
s_mov_b32 s97,0x7fff0000
s_mov_b32 s69,1
s_mov_b32 s68,0
s_mov_b32 s52,0x30003
s_mov_b32 s53,s52
seg_288:
s_cmp_eq_u32 s83,0
s_cbranch_scc1 ahead_289
s_add_u32 s94,s70,s75
s_xor_b32 s95,s94,1024
s_xor_b32 s91,s72,0x10000
s_waitcnt vmcnt(2)
v_cmp_gt_u32 vcc,s71,v29
s_cbranch_vccz nb_292
s_waitcnt vmcnt(0)
v_add_u32 v22,s71,-1
buffer_store_dword v22,v23,s[20:23],s97 offen sc1
s_mov_b32 s97,0x7fff0000
s_cmp_lg_u32 s50,0
s_cbranch_scc1 nb_292
buffer_load_dword v32,v21,s[20:23],s74 offen sc1
s_sleep 2
pl_294:
buffer_load_dword v33,v21,s[20:23],s74 offen sc1
s_waitcnt vmcnt(1)
v_cmp_gt_u32 vcc,s71,v32
v_mov_b32 v29,v32
s_cbranch_vccz pok_295
buffer_load_dword v32,v21,s[20:23],s74 offen sc1
s_waitcnt vmcnt(1)
v_cmp_gt_u32 vcc,s71,v33
v_mov_b32 v29,v33
s_cbranch_vccz pok_295
s_sub_u32 s90,s90,1
s_cmp_gt_i32 s90,0
s_cbranch_scc1 pl_294
pok_295:
nb_292:
s_barrier
s_xor_b32 m0,s91,0
s_add_u32 s65,s94,0
buffer_load_dwordx4 v16,s[20:23],s65 offen offset:0 sc1 lds
buffer_load_dwordx4 v16,s[20:23],s65 offen offset:2048 sc1 lds
s_xor_b32 m0,s91,16384
s_add_u32 s65,s94,32768
buffer_load_dwordx4 v16,s[20:23],s65 offen offset:0 sc1 lds
buffer_load_dwordx4 v16,s[20:23],s65 offen offset:2048 sc1 lds
s_xor_b32 m0,s91,32768
s_add_u32 s65,s94,65536
buffer_load_dwordx4 v16,s[20:23],s65 offen offset:0 sc1 lds
buffer_load_dwordx4 v16,s[20:23],s65 offen offset:2048 sc1 lds
s_xor_b32 m0,s91,49152
s_add_u32 s65,s94,98304
buffer_load_dwordx4 v16,s[20:23],s65 offen offset:0 sc1 lds
buffer_load_dwordx4 v16,s[20:23],s65 offen offset:2048 sc1 lds
s_waitcnt vmcnt(8)
v_add_u32 v22,s71,-1
buffer_store_dword v22,v23,s[20:23],s97 offen sc1
s_mov_b32 s97,0x7fff0000
s_waitcnt vmcnt(7)
s_barrier
ds_read_b128 v[224:227],v18 offset:0
ds_read_b128 v[228:231],v18 offset:2048
ds_read_b128 v[232:235],v18 offset:4096
ds_read_b128 v[236:239],v18 offset:6144
ds_read_b128 v[240:243],v18 offset:8192
ds_read_b128 v[244:247],v18 offset:10240
ds_read_b128 v[248:251],v18 offset:12288
s_waitcnt lgkmcnt(5)
v_mfma_f32_16x16x32_bf16 v[64:67],a[0:3],v[224:227],0
s_xor_b32 m0,s91,1024
s_add_u32 s96,s71,1
v_mfma_f32_16x16x32_bf16 v[68:71],a[128:131],v[224:227],0
ds_read_b128 v[252:255],v18 offset:14336
s_add_u32 s92,s71,2
v_mfma_f32_16x16x32_bf16 v[64:67],a[4:7],v[228:231],v[64:67]
s_add_u32 s65,s95,0
v_min_u32 v27,v224,v228
v_mfma_f32_16x16x32_bf16 v[68:71],a[132:135],v[228:231],v[68:71]
s_waitcnt vmcnt(5)
s_barrier
ds_read_b128 v[224:227],v18 offset:16384
s_waitcnt lgkmcnt(5)
v_mfma_f32_16x16x32_bf16 v[64:67],a[8:11],v[232:235],v[64:67]
buffer_load_dwordx4 v16,s[20:23],s65 offen offset:0 sc1 lds
v_mfma_f32_16x16x32_bf16 v[68:71],a[136:139],v[232:235],v[68:71]
ds_read_b128 v[228:231],v18 offset:18432
v_min3_u32 v27,v27,v232,v236
v_mfma_f32_16x16x32_bf16 v[64:67],a[12:15],v[236:239],v[64:67]
buffer_load_dwordx4 v16,s[20:23],s65 offen offset:2048 sc1 lds
v_mfma_f32_16x16x32_bf16 v[68:71],a[140:143],v[236:239],v[68:71]
ds_read_b128 v[232:235],v18 offset:20480
s_waitcnt lgkmcnt(5)
v_mfma_f32_16x16x32_bf16 v[64:67],a[16:19],v[240:243],v[64:67]
s_xor_b32 m0,s91,17408
v_min3_u32 v27,v27,v240,v244
v_mfma_f32_16x16x32_bf16 v[68:71],a[144:147],v[240:243],v[68:71]
ds_read_b128 v[236:239],v18 offset:22528
v_mfma_f32_16x16x32_bf16 v[64:67],a[20:23],v[244:247],v[64:67]
s_add_u32 s65,s95,32768
v_mfma_f32_16x16x32_bf16 v[68:71],a[148:151],v[244:247],v[68:71]
ds_read_b128 v[240:243],v18 offset:24576
s_waitcnt lgkmcnt(5)
v_mfma_f32_16x16x32_bf16 v[64:67],a[24:27],v[248:251],v[64:67]
buffer_load_dwordx4 v16,s[20:23],s65 offen offset:0 sc1 lds
v_mfma_f32_16x16x32_bf16 v[68:71],a[152:155],v[248:251],v[68:71]
ds_read_b128 v[244:247],v18 offset:26624
v_min3_u32 v27,v27,v248,v252
v_mfma_f32_16x16x32_bf16 v[64:67],a[28:31],v[252:255],v[64:67]
buffer_load_dwordx4 v16,s[20:23],s65 offen offset:2048 sc1 lds
v_mfma_f32_16x16x32_bf16 v[68:71],a[156:159],v[252:255],v[68:71]
ds_read_b128 v[248:251],v18 offset:28672
s_waitcnt lgkmcnt(5)
v_mfma_f32_16x16x32_bf16 v[64:67],a[32:35],v[224:227],v[64:67]
s_xor_b32 m0,s91,33792
v_min3_u32 v27,v27,v224,v228
v_mfma_f32_16x16x32_bf16 v[68:71],a[160:163],v[224:227],v[68:71]
ds_read_b128 v[252:255],v18 offset:30720
v_mfma_f32_16x16x32_bf16 v[64:67],a[36:39],v[228:231],v[64:67]
s_add_u32 s65,s95,65536
s_waitcnt vmcnt(63)
v_mfma_f32_16x16x32_bf16 v[68:71],a[164:167],v[228:231],v[68:71]
s_waitcnt vmcnt(5)
s_barrier
ds_read_b128 v[224:227],v18 offset:32768
s_waitcnt lgkmcnt(5)
v_mfma_f32_16x16x32_bf16 v[64:67],a[40:43],v[232:235],v[64:67]
buffer_load_dwordx4 v16,s[20:23],s65 offen offset:0 sc1 lds
v_min3_u32 v27,v27,v232,v236
v_mfma_f32_16x16x32_bf16 v[68:71],a[168:171],v[232:235],v[68:71]
ds_read_b128 v[228:231],v18 offset:34816
v_cmp_gt_u32 vcc,s96,v29
v_cmp_gt_u32 s[92:93],s92,v29
v_mfma_f32_16x16x32_bf16 v[64:67],a[44:47],v[236:239],v[64:67]
buffer_load_dwordx4 v16,s[20:23],s65 offen offset:2048 sc1 lds
v_mfma_f32_16x16x32_bf16 v[68:71],a[172:175],v[236:239],v[68:71]
ds_read_b128 v[232:235],v18 offset:36864
s_waitcnt lgkmcnt(5)
v_mfma_f32_16x16x32_bf16 v[64:67],a[48:51],v[240:243],v[64:67]
s_xor_b32 m0,s91,50176
v_mov_b32 v44,vcc_lo
v_mov_b32 v45,s92
v_mfma_f32_16x16x32_bf16 v[68:71],a[176:179],v[240:243],v[68:71]
ds_read_b128 v[236:239],v18 offset:38912
ds_write_b64 v46,v[44:45]
v_mfma_f32_16x16x32_bf16 v[64:67],a[52:55],v[244:247],v[64:67]
s_add_u32 s65,s95,98304
v_min3_u32 v27,v27,v240,v244
v_mfma_f32_16x16x32_bf16 v[68:71],a[180:183],v[244:247],v[68:71]
ds_read_b128 v[240:243],v18 offset:40960
s_waitcnt lgkmcnt(6)
v_mfma_f32_16x16x32_bf16 v[64:67],a[56:59],v[248:251],v[64:67]
buffer_load_dwordx4 v16,s[20:23],s65 offen offset:0 sc1 lds
v_mfma_f32_16x16x32_bf16 v[68:71],a[184:187],v[248:251],v[68:71]
ds_read_b128 v[244:247],v18 offset:43008
v_min3_u32 v27,v27,v248,v252
v_mfma_f32_16x16x32_bf16 v[64:67],a[60:63],v[252:255],v[64:67]
buffer_load_dwordx4 v16,s[20:23],s65 offen offset:2048 sc1 lds
v_mfma_f32_16x16x32_bf16 v[68:71],a[188:191],v[252:255],v[68:71]
ds_read_b128 v[248:251],v18 offset:45056
s_waitcnt lgkmcnt(6)
v_mfma_f32_16x16x32_bf16 v[64:67],a[64:67],v[224:227],v[64:67]
v_min3_u32 v27,v27,v224,v228
s_add_u32 s88,s70,s75
v_mfma_f32_16x16x32_bf16 v[68:71],a[192:195],v[224:227],v[68:71]
ds_read_b128 v[252:255],v18 offset:47104
s_add_u32 s88,s88,2097152
v_mfma_f32_16x16x32_bf16 v[64:67],a[68:71],v[228:231],v[64:67]
buffer_load_dwordx2 v[120:121],v20,s[36:39],s78 offen
v_mfma_f32_16x16x32_bf16 v[68:71],a[196:199],v[228:231],v[68:71]
ds_read_b128 v[224:227],v18 offset:49152
s_waitcnt lgkmcnt(6)
v_mfma_f32_16x16x32_bf16 v[64:67],a[72:75],v[232:235],v[64:67]
v_min3_u32 v27,v27,v232,v236
s_xor_b32 s88,s88,0x2000
v_mfma_f32_16x16x32_bf16 v[68:71],a[200:203],v[232:235],v[68:71]
ds_read_b128 v[228:231],v18 offset:51200
s_xor_b32 s89,s88,1024
v_mfma_f32_16x16x32_bf16 v[64:67],a[76:79],v[236:239],v[64:67]
v_mfma_f32_16x16x32_bf16 v[68:71],a[204:207],v[236:239],v[68:71]
ds_read_b128 v[232:235],v18 offset:53248
s_waitcnt lgkmcnt(5)
v_mfma_f32_16x16x32_bf16 v[64:67],a[80:83],v[240:243],v[64:67]
s_waitcnt vmcnt(5)
s_barrier
ds_read_b64 v[44:45],v47
ds_read_b128 v[128:131],v17 offset:0
ds_read_b128 v[132:135],v17 offset:2048
v_mfma_f32_16x16x32_bf16 v[68:71],a[208:211],v[240:243],v[68:71]
ds_read_b128 v[236:239],v18 offset:55296
v_min3_u32 v27,v27,v240,v244
v_mfma_f32_16x16x32_bf16 v[64:67],a[84:87],v[244:247],v[64:67]
ds_read_b128 v[136:139],v17 offset:4096
v_mfma_f32_16x16x32_bf16 v[68:71],a[212:215],v[244:247],v[68:71]
ds_read_b128 v[240:243],v18 offset:57344
s_waitcnt lgkmcnt(9)
v_mfma_f32_16x16x32_bf16 v[64:67],a[88:91],v[248:251],v[64:67]
ds_read_b128 v[140:143],v17 offset:6144
v_min3_u32 v27,v27,v248,v252
v_mfma_f32_16x16x32_bf16 v[68:71],a[216:219],v[248:251],v[68:71]
ds_read_b128 v[244:247],v18 offset:59392
v_mfma_f32_16x16x32_bf16 v[64:67],a[92:95],v[252:255],v[64:67]
ds_read_b128 v[144:147],v17 offset:8192
ds_read_b128 v[148:151],v17 offset:10240
v_mfma_f32_16x16x32_bf16 v[68:71],a[220:223],v[252:255],v[68:71]
ds_read_b128 v[248:251],v18 offset:61440
s_waitcnt lgkmcnt(12)
v_mfma_f32_16x16x32_bf16 v[64:67],a[96:99],v[224:227],v[64:67]
ds_read_b128 v[152:155],v17 offset:12288
s_waitcnt lgkmcnt(11)
v_min3_u32 v27,v27,v224,v228
v_mfma_f32_16x16x32_bf16 v[68:71],a[224:227],v[224:227],v[68:71]
ds_read_b128 v[252:255],v18 offset:63488
v_readfirstlane_b32 s93,v45
v_mfma_f32_16x16x32_bf16 v[64:67],a[100:103],v[228:231],v[64:67]
ds_read_b128 v[156:159],v17 offset:14336
v_readfirstlane_b32 s83,v44
s_cmp_lg_u32 s83,0
s_cbranch_scc0 keep_298
v_mfma_f32_16x16x32_bf16 v[68:71],a[228:231],v[228:231],v[68:71]
s_waitcnt lgkmcnt(10)
v_mfma_f32_16x16x32_bf16 v[64:67],a[104:107],v[232:235],v[64:67]
ds_read_b128 v[160:163],v17 offset:16384
ds_read_b128 v[164:167],v17 offset:18432
v_mfma_f32_16x16x32_bf16 v[68:71],a[232:235],v[232:235],v[68:71]
v_min3_u32 v27,v27,v232,v236
v_mfma_f32_16x16x32_bf16 v[64:67],a[108:111],v[236:239],v[64:67]
ds_read_b128 v[168:171],v17 offset:20480
v_mfma_f32_16x16x32_bf16 v[68:71],a[236:239],v[236:239],v[68:71]
s_waitcnt lgkmcnt(9)
v_mfma_f32_16x16x32_bf16 v[64:67],a[112:115],v[240:243],v[64:67]
ds_read_b128 v[172:175],v17 offset:22528
v_min3_u32 v27,v27,v240,v244
v_mfma_f32_16x16x32_bf16 v[68:71],a[240:243],v[240:243],v[68:71]
v_mfma_f32_16x16x32_bf16 v[64:67],a[116:119],v[244:247],v[64:67]
ds_read_b128 v[176:179],v17 offset:24576
ds_read_b128 v[180:183],v17 offset:26624
v_mfma_f32_16x16x32_bf16 v[68:71],a[244:247],v[244:247],v[68:71]
s_waitcnt lgkmcnt(7)
v_mfma_f32_16x16x32_bf16 v[64:67],a[120:123],v[248:251],v[64:67]
ds_read_b128 v[184:187],v17 offset:28672
v_min3_u32 v27,v27,v248,v252
v_mfma_f32_16x16x32_bf16 v[68:71],a[248:251],v[248:251],v[68:71]
v_mfma_f32_16x16x32_bf16 v[64:67],a[124:127],v[252:255],v[64:67]
ds_read_b128 v[188:191],v17 offset:30720
v_mfma_f32_16x16x32_bf16 v[68:71],a[252:255],v[252:255],v[68:71]
v_mfma_f32_16x16x32_bf16 v[72:75],a[128:131],v[128:131],0
v_cmp_eq_u32 vcc,0,v27
s_cbranch_vccnz retry_287
v_mfma_f32_16x16x32_bf16 v[76:79],a[132:135],v[132:135],0
v_min3_u32 v27,v27,v128,v132
v_mfma_f32_16x16x32_bf16 v[72:75],a[136:139],v[136:139],v[72:75]
s_waitcnt vmcnt(1)
s_barrier
ds_read_b128 v[192:195],v17 offset:32768
v_mfma_f32_16x16x32_bf16 v[76:79],a[140:143],v[140:143],v[76:79]
ds_read_b128 v[196:199],v17 offset:34816
s_waitcnt lgkmcnt(10)
v_mfma_f32_16x16x32_bf16 v[72:75],a[144:147],v[144:147],v[72:75]
ds_read_b128 v[200:203],v17 offset:36864
v_min3_u32 v27,v27,v136,v140
s_waitcnt vmcnt(0)
v_mfma_f32_16x16x32_bf16 v[76:79],a[148:151],v[148:151],v[76:79]
ds_read_b128 v[204:207],v17 offset:38912
v_min3_u32 v27,v27,v144,v148
v_and_or_b32 v64,v64,-4,s48
v_mfma_f32_16x16x32_bf16 v[72:75],a[152:155],v[152:155],v[72:75]
ds_read_b128 v[208:211],v17 offset:40960
s_add_u32 s64,s49,s34
v_mfma_f32_16x16x32_bf16 v[76:79],a[156:159],v[156:159],v[76:79]
v_min3_u32 v27,v27,v152,v156
s_waitcnt lgkmcnt(9)
v_mfma_f32_16x16x32_bf16 v[72:75],a[160:163],v[160:163],v[72:75]
ds_read_b128 v[212:215],v17 offset:43008
buffer_store_dwordx4 v[64:67],v25,s[20:23],s64 offen offset:2048
v_mfma_f32_16x16x32_bf16 v[76:79],a[164:167],v[164:167],v[76:79]
ds_read_b128 v[216:219],v17 offset:45056
v_min3_u32 v27,v27,v160,v164
v_and_or_b32 v68,v68,-4,s48
v_mfma_f32_16x16x32_bf16 v[72:75],a[168:171],v[168:171],v[72:75]
ds_read_b128 v[220:223],v17 offset:47104
s_add_u32 s64,s49,s35
v_mfma_f32_16x16x32_bf16 v[76:79],a[172:175],v[172:175],v[76:79]
ds_read_b128 v[224:227],v17 offset:49152
s_waitcnt lgkmcnt(9)
v_mfma_f32_16x16x32_bf16 v[72:75],a[176:179],v[176:179],v[72:75]
ds_read_b128 v[228:231],v17 offset:51200
v_min3_u32 v27,v27,v168,v172
v_mfma_f32_16x16x32_bf16 v[76:79],a[180:183],v[180:183],v[76:79]
v_min3_u32 v27,v27,v176,v180
buffer_store_dwordx4 v[68:71],v25,s[20:23],s64 offen offset:3072
v_mfma_f32_16x16x32_bf16 v[72:75],a[184:187],v[184:187],v[72:75]
ds_read_b128 v[232:235],v17 offset:53248
s_mov_b32 s49,0x7fff0000
v_mfma_f32_16x16x32_bf16 v[76:79],a[188:191],v[188:191],v[76:79]
ds_read_b128 v[236:239],v17 offset:55296
s_waitcnt lgkmcnt(8)
v_mfma_f32_16x16x32_bf16 v[72:75],a[192:195],v[192:195],v[72:75]
ds_read_b128 v[240:243],v17 offset:57344
v_min3_u32 v27,v27,v184,v188
v_mfma_f32_16x16x32_bf16 v[76:79],a[196:199],v[196:199],v[76:79]
ds_read_b128 v[244:247],v17 offset:59392
v_min3_u32 v27,v27,v192,v196
v_mfma_f32_16x16x32_bf16 v[72:75],a[200:203],v[200:203],v[72:75]
ds_read_b128 v[248:251],v17 offset:61440
ds_bpermute_b32 v124,v41,v120
v_mfma_f32_16x16x32_bf16 v[76:79],a[204:207],v[204:207],v[76:79]
v_min3_u32 v27,v27,v200,v204
s_waitcnt lgkmcnt(8)
v_mfma_f32_16x16x32_bf16 v[72:75],a[208:211],v[208:211],v[72:75]
ds_read_b128 v[252:255],v17 offset:63488
ds_bpermute_b32 v125,v41,v121
v_mfma_f32_16x16x32_bf16 v[76:79],a[212:215],v[212:215],v[76:79]
v_min3_u32 v27,v27,v208,v212
v_mfma_f32_16x16x32_bf16 v[72:75],a[216:219],v[216:219],v[72:75]
v_mfma_f32_16x16x32_bf16 v[76:79],a[220:223],v[220:223],v[76:79]
v_min3_u32 v27,v27,v216,v220
s_waitcnt lgkmcnt(6)
v_mfma_f32_16x16x32_bf16 v[72:75],a[224:227],v[224:227],v[72:75]
s_waitcnt lgkmcnt(0)
v_mfma_f32_16x16x32_bf16 v[76:79],a[228:231],v[228:231],v[76:79]
v_min3_u32 v27,v27,v224,v228
v_mfma_f32_16x16x32_bf16 v[72:75],a[232:235],v[232:235],v[72:75]
v_lshlrev_b32 v104,16,v124
v_mfma_f32_16x16x32_bf16 v[76:79],a[236:239],v[236:239],v[76:79]
v_min3_u32 v27,v27,v232,v236
v_mfma_f32_16x16x32_bf16 v[72:75],a[240:243],v[240:243],v[72:75]
v_mfma_f32_16x16x32_bf16 v[76:79],a[244:247],v[244:247],v[76:79]
v_min3_u32 v27,v27,v240,v244
v_mfma_f32_16x16x32_bf16 v[72:75],a[248:251],v[248:251],v[72:75]
v_and_b32 v105,s80,v124
v_mfma_f32_16x16x32_bf16 v[76:79],a[252:255],v[252:255],v[76:79]
v_min3_u32 v27,v27,v248,v252
v_mfma_f32_16x16x32_bf16 v[80:83],a[0:3],v[128:131],0
v_cmp_eq_u32 vcc,0,v27
s_cbranch_vccnz retry_287
v_mfma_f32_16x16x32_bf16 v[84:87],a[4:7],v[132:135],0
v_lshlrev_b32 v106,16,v125
v_mfma_f32_16x16x32_bf16 v[80:83],a[8:11],v[136:139],v[80:83]
v_mfma_f32_16x16x32_bf16 v[84:87],a[12:15],v[140:143],v[84:87]
v_mfma_f32_16x16x32_bf16 v[80:83],a[16:19],v[144:147],v[80:83]
v_and_b32 v107,s80,v125
v_add_f32 v72,v72,v76
v_mfma_f32_16x16x32_bf16 v[84:87],a[20:23],v[148:151],v[84:87]
v_add_f32 v73,v73,v77
v_add_f32 v74,v74,v78
v_mfma_f32_16x16x32_bf16 v[80:83],a[24:27],v[152:155],v[80:83]
v_add_f32 v75,v75,v79
v_and_or_b32 v72,v72,-4,s48
v_mfma_f32_16x16x32_bf16 v[84:87],a[28:31],v[156:159],v[84:87]
s_add_u32 s64,s77,s33
v_mfma_f32_16x16x32_bf16 v[80:83],a[32:35],v[160:163],v[80:83]
buffer_store_dwordx4 v[72:75],v25,s[20:23],s64 offen offset:1024
v_mfma_f32_16x16x32_bf16 v[84:87],a[36:39],v[164:167],v[84:87]
v_mfma_f32_16x16x32_bf16 v[80:83],a[40:43],v[168:171],v[80:83]
v_mfma_f32_16x16x32_bf16 v[84:87],a[44:47],v[172:175],v[84:87]
v_mfma_f32_16x16x32_bf16 v[80:83],a[48:51],v[176:179],v[80:83]
v_mfma_f32_16x16x32_bf16 v[84:87],a[52:55],v[180:183],v[84:87]
v_mfma_f32_16x16x32_bf16 v[80:83],a[56:59],v[184:187],v[80:83]
v_mfma_f32_16x16x32_bf16 v[84:87],a[60:63],v[188:191],v[84:87]
v_mfma_f32_16x16x32_bf16 v[80:83],a[64:67],v[192:195],v[80:83]
buffer_load_dwordx4 v[96:99],v26,s[20:23],s77 offen offset:2048 sc1
v_mfma_f32_16x16x32_bf16 v[84:87],a[68:71],v[196:199],v[84:87]
buffer_load_dwordx4 v[100:103],v26,s[20:23],s77 offen offset:3072 sc1
v_mfma_f32_16x16x32_bf16 v[80:83],a[72:75],v[200:203],v[80:83]
v_mfma_f32_16x16x32_bf16 v[84:87],a[76:79],v[204:207],v[84:87]
v_mfma_f32_16x16x32_bf16 v[80:83],a[80:83],v[208:211],v[80:83]
v_mfma_f32_16x16x32_bf16 v[84:87],a[84:87],v[212:215],v[84:87]
v_mfma_f32_16x16x32_bf16 v[80:83],a[88:91],v[216:219],v[80:83]
v_mfma_f32_16x16x32_bf16 v[84:87],a[92:95],v[220:223],v[84:87]
v_mfma_f32_16x16x32_bf16 v[80:83],a[96:99],v[224:227],v[80:83]
v_mfma_f32_16x16x32_bf16 v[84:87],a[100:103],v[228:231],v[84:87]
v_mfma_f32_16x16x32_bf16 v[80:83],a[104:107],v[232:235],v[80:83]
buffer_load_dwordx4 v[92:95],v26,s[20:23],s77 offen offset:1024 sc1
v_mfma_f32_16x16x32_bf16 v[84:87],a[108:111],v[236:239],v[84:87]
v_mfma_f32_16x16x32_bf16 v[80:83],a[112:115],v[240:243],v[80:83]
v_mfma_f32_16x16x32_bf16 v[84:87],a[116:119],v[244:247],v[84:87]
v_mfma_f32_16x16x32_bf16 v[80:83],a[120:123],v[248:251],v[80:83]
v_mfma_f32_16x16x32_bf16 v[84:87],a[124:127],v[252:255],v[84:87]
s_branch epi_290
keep_298:
v_mfma_f32_16x16x32_bf16 v[68:71],a[228:231],v[228:231],v[68:71]
s_xor_b32 m0,s72,0
s_waitcnt lgkmcnt(10)
v_mfma_f32_16x16x32_bf16 v[64:67],a[104:107],v[232:235],v[64:67]
ds_read_b128 v[160:163],v17 offset:16384
ds_read_b128 v[164:167],v17 offset:18432
v_mfma_f32_16x16x32_bf16 v[68:71],a[232:235],v[232:235],v[68:71]
s_add_u32 s65,s88,0
v_min3_u32 v27,v27,v232,v236
v_mfma_f32_16x16x32_bf16 v[64:67],a[108:111],v[236:239],v[64:67]
ds_read_b128 v[168:171],v17 offset:20480
v_mfma_f32_16x16x32_bf16 v[68:71],a[236:239],v[236:239],v[68:71]
s_waitcnt lgkmcnt(9)
v_mfma_f32_16x16x32_bf16 v[64:67],a[112:115],v[240:243],v[64:67]
ds_read_b128 v[172:175],v17 offset:22528
v_min3_u32 v27,v27,v240,v244
v_mfma_f32_16x16x32_bf16 v[68:71],a[240:243],v[240:243],v[68:71]
buffer_load_dwordx4 v16,s[20:23],s65 offen offset:0 sc1 lds
v_mfma_f32_16x16x32_bf16 v[64:67],a[116:119],v[244:247],v[64:67]
ds_read_b128 v[176:179],v17 offset:24576
ds_read_b128 v[180:183],v17 offset:26624
v_mfma_f32_16x16x32_bf16 v[68:71],a[244:247],v[244:247],v[68:71]
s_waitcnt lgkmcnt(7)
v_mfma_f32_16x16x32_bf16 v[64:67],a[120:123],v[248:251],v[64:67]
ds_read_b128 v[184:187],v17 offset:28672
v_min3_u32 v27,v27,v248,v252
v_mfma_f32_16x16x32_bf16 v[68:71],a[248:251],v[248:251],v[68:71]
buffer_load_dwordx4 v16,s[20:23],s65 offen offset:2048 sc1 lds
v_mfma_f32_16x16x32_bf16 v[64:67],a[124:127],v[252:255],v[64:67]
ds_read_b128 v[188:191],v17 offset:30720
s_xor_b32 m0,s72,16384
v_mfma_f32_16x16x32_bf16 v[68:71],a[252:255],v[252:255],v[68:71]
s_add_u32 s65,s88,32768
v_mfma_f32_16x16x32_bf16 v[72:75],a[128:131],v[128:131],0
buffer_load_dwordx4 v16,s[20:23],s65 offen offset:0 sc1 lds
v_cmp_eq_u32 vcc,0,v27
s_cbranch_vccnz retry_287
v_mfma_f32_16x16x32_bf16 v[76:79],a[132:135],v[132:135],0
buffer_load_dwordx4 v16,s[20:23],s65 offen offset:2048 sc1 lds
v_mfma_f32_16x16x32_bf16 v[72:75],a[136:139],v[136:139],v[72:75]
s_waitcnt vmcnt(5)
s_barrier
ds_read_b128 v[192:195],v17 offset:32768
v_mfma_f32_16x16x32_bf16 v[76:79],a[140:143],v[140:143],v[76:79]
ds_read_b128 v[196:199],v17 offset:34816
s_waitcnt lgkmcnt(10)
v_mfma_f32_16x16x32_bf16 v[72:75],a[144:147],v[144:147],v[72:75]
ds_read_b128 v[200:203],v17 offset:36864
s_xor_b32 m0,s72,32768
s_waitcnt vmcnt(4)
v_and_or_b32 v64,v64,-4,s48
v_mfma_f32_16x16x32_bf16 v[76:79],a[148:151],v[148:151],v[76:79]
ds_read_b128 v[204:207],v17 offset:38912
s_add_u32 s65,s88,65536
s_add_u32 s64,s49,s34
v_mfma_f32_16x16x32_bf16 v[72:75],a[152:155],v[152:155],v[72:75]
ds_read_b128 v[208:211],v17 offset:40960
v_min3_u32 v27,v27,v128,v132
buffer_store_dwordx4 v[64:67],v25,s[20:23],s64 offen offset:2048
v_mfma_f32_16x16x32_bf16 v[76:79],a[156:159],v[156:159],v[76:79]
v_min3_u32 v27,v27,v136,v140
v_and_or_b32 v68,v68,-4,s48
s_add_u32 s64,s49,s35
s_waitcnt lgkmcnt(9)
v_mfma_f32_16x16x32_bf16 v[72:75],a[160:163],v[160:163],v[72:75]
ds_read_b128 v[212:215],v17 offset:43008
v_min3_u32 v27,v27,v144,v148
buffer_store_dwordx4 v[68:71],v25,s[20:23],s64 offen offset:3072
v_mfma_f32_16x16x32_bf16 v[76:79],a[164:167],v[164:167],v[76:79]
ds_read_b128 v[216:219],v17 offset:45056
v_min3_u32 v27,v27,v152,v156
s_mov_b32 s49,0x7fff0000
v_mfma_f32_16x16x32_bf16 v[72:75],a[168:171],v[168:171],v[72:75]
ds_read_b128 v[220:223],v17 offset:47104
v_min3_u32 v27,v27,v160,v164
v_mfma_f32_16x16x32_bf16 v[76:79],a[172:175],v[172:175],v[76:79]
ds_read_b128 v[224:227],v17 offset:49152
s_waitcnt lgkmcnt(9)
v_mfma_f32_16x16x32_bf16 v[72:75],a[176:179],v[176:179],v[72:75]
ds_read_b128 v[228:231],v17 offset:51200
v_min3_u32 v27,v27,v168,v172
v_mfma_f32_16x16x32_bf16 v[76:79],a[180:183],v[180:183],v[76:79]
buffer_load_dwordx4 v16,s[20:23],s65 offen offset:0 sc1 lds
v_mfma_f32_16x16x32_bf16 v[72:75],a[184:187],v[184:187],v[72:75]
ds_read_b128 v[232:235],v17 offset:53248
v_min3_u32 v27,v27,v176,v180
v_mfma_f32_16x16x32_bf16 v[76:79],a[188:191],v[188:191],v[76:79]
ds_read_b128 v[236:239],v17 offset:55296
s_waitcnt lgkmcnt(8)
v_mfma_f32_16x16x32_bf16 v[72:75],a[192:195],v[192:195],v[72:75]
ds_read_b128 v[240:243],v17 offset:57344
v_min3_u32 v27,v27,v184,v188
v_mfma_f32_16x16x32_bf16 v[76:79],a[196:199],v[196:199],v[76:79]
ds_read_b128 v[244:247],v17 offset:59392
v_min3_u32 v27,v27,v192,v196
v_mfma_f32_16x16x32_bf16 v[72:75],a[200:203],v[200:203],v[72:75]
ds_read_b128 v[248:251],v17 offset:61440
ds_bpermute_b32 v124,v41,v120
v_mfma_f32_16x16x32_bf16 v[76:79],a[204:207],v[204:207],v[76:79]
v_min3_u32 v27,v27,v200,v204
s_waitcnt lgkmcnt(8)
v_mfma_f32_16x16x32_bf16 v[72:75],a[208:211],v[208:211],v[72:75]
ds_read_b128 v[252:255],v17 offset:63488
ds_bpermute_b32 v125,v41,v121
v_mfma_f32_16x16x32_bf16 v[76:79],a[212:215],v[212:215],v[76:79]
buffer_load_dwordx4 v16,s[20:23],s65 offen offset:2048 sc1 lds
v_mfma_f32_16x16x32_bf16 v[72:75],a[216:219],v[216:219],v[72:75]
s_xor_b32 m0,s72,49152
s_add_u32 s65,s88,98304
v_mfma_f32_16x16x32_bf16 v[76:79],a[220:223],v[220:223],v[76:79]
v_min3_u32 v27,v27,v208,v212
s_waitcnt lgkmcnt(6)
v_mfma_f32_16x16x32_bf16 v[72:75],a[224:227],v[224:227],v[72:75]
buffer_load_dwordx4 v16,s[20:23],s65 offen offset:0 sc1 lds
v_mfma_f32_16x16x32_bf16 v[76:79],a[228:231],v[228:231],v[76:79]
buffer_load_dwordx4 v16,s[20:23],s65 offen offset:2048 sc1 lds
v_min3_u32 v27,v27,v224,v228
v_mfma_f32_16x16x32_bf16 v[72:75],a[232:235],v[232:235],v[72:75]
s_xor_b32 m0,s72,1024
s_add_u32 s65,s89,0
v_mfma_f32_16x16x32_bf16 v[76:79],a[236:239],v[236:239],v[76:79]
v_min3_u32 v27,v27,v216,v220
v_min3_u32 v27,v27,v232,v236
s_waitcnt lgkmcnt(1)
v_mfma_f32_16x16x32_bf16 v[72:75],a[240:243],v[240:243],v[72:75]
buffer_load_dwordx4 v16,s[20:23],s65 offen offset:0 sc1 lds
v_mfma_f32_16x16x32_bf16 v[76:79],a[244:247],v[244:247],v[76:79]
buffer_load_dwordx4 v16,s[20:23],s65 offen offset:2048 sc1 lds
v_min3_u32 v27,v27,v240,v244
v_mfma_f32_16x16x32_bf16 v[72:75],a[248:251],v[248:251],v[72:75]
s_xor_b32 m0,s72,17408
s_add_u32 s65,s89,32768
v_mfma_f32_16x16x32_bf16 v[76:79],a[252:255],v[252:255],v[76:79]
buffer_load_dwordx4 v16,s[20:23],s65 offen offset:0 sc1 lds
v_min3_u32 v27,v27,v248,v252
v_mfma_f32_16x16x32_bf16 v[80:83],a[0:3],v[128:131],0
buffer_load_dwordx4 v16,s[20:23],s65 offen offset:2048 sc1 lds
v_cmp_eq_u32 vcc,0,v27
s_cbranch_vccnz retry_287
v_mfma_f32_16x16x32_bf16 v[84:87],a[4:7],v[132:135],0
s_xor_b32 m0,s72,33792
s_add_u32 s65,s89,65536
v_mfma_f32_16x16x32_bf16 v[80:83],a[8:11],v[136:139],v[80:83]
buffer_load_dwordx4 v16,s[20:23],s65 offen offset:0 sc1 lds
v_mfma_f32_16x16x32_bf16 v[84:87],a[12:15],v[140:143],v[84:87]
buffer_load_dwordx4 v16,s[20:23],s65 offen offset:2048 sc1 lds
v_mfma_f32_16x16x32_bf16 v[80:83],a[16:19],v[144:147],v[80:83]
s_xor_b32 m0,s72,50176
s_add_u32 s65,s89,98304
v_add_f32 v72,v72,v76
v_mfma_f32_16x16x32_bf16 v[84:87],a[20:23],v[148:151],v[84:87]
buffer_load_dwordx4 v16,s[20:23],s65 offen offset:0 sc1 lds
v_add_f32 v73,v73,v77
v_mfma_f32_16x16x32_bf16 v[80:83],a[24:27],v[152:155],v[80:83]
buffer_load_dwordx4 v16,s[20:23],s65 offen offset:2048 sc1 lds
v_add_f32 v74,v74,v78
v_mfma_f32_16x16x32_bf16 v[84:87],a[28:31],v[156:159],v[84:87]
s_waitcnt lgkmcnt(0)
v_lshlrev_b32 v104,16,v124
v_add_f32 v75,v75,v79
v_mfma_f32_16x16x32_bf16 v[80:83],a[32:35],v[160:163],v[80:83]
v_and_b32 v105,s80,v124
v_lshlrev_b32 v106,16,v125
v_and_or_b32 v72,v72,-4,s48
v_mfma_f32_16x16x32_bf16 v[84:87],a[36:39],v[164:167],v[84:87]
v_and_b32 v107,s80,v125
s_add_u32 s64,s77,s33
v_mfma_f32_16x16x32_bf16 v[80:83],a[40:43],v[168:171],v[80:83]
buffer_store_dwordx4 v[72:75],v25,s[20:23],s64 offen offset:1024
v_mfma_f32_16x16x32_bf16 v[84:87],a[44:47],v[172:175],v[84:87]
v_mfma_f32_16x16x32_bf16 v[80:83],a[48:51],v[176:179],v[80:83]
v_mfma_f32_16x16x32_bf16 v[84:87],a[52:55],v[180:183],v[84:87]
v_mfma_f32_16x16x32_bf16 v[80:83],a[56:59],v[184:187],v[80:83]
v_mfma_f32_16x16x32_bf16 v[84:87],a[60:63],v[188:191],v[84:87]
v_mfma_f32_16x16x32_bf16 v[80:83],a[64:67],v[192:195],v[80:83]
buffer_load_dwordx4 v[96:99],v26,s[20:23],s77 offen offset:2048 sc1
v_mfma_f32_16x16x32_bf16 v[84:87],a[68:71],v[196:199],v[84:87]
buffer_load_dwordx4 v[100:103],v26,s[20:23],s77 offen offset:3072 sc1
v_mfma_f32_16x16x32_bf16 v[80:83],a[72:75],v[200:203],v[80:83]
v_mfma_f32_16x16x32_bf16 v[84:87],a[76:79],v[204:207],v[84:87]
v_mfma_f32_16x16x32_bf16 v[80:83],a[80:83],v[208:211],v[80:83]
v_mfma_f32_16x16x32_bf16 v[84:87],a[84:87],v[212:215],v[84:87]
v_mfma_f32_16x16x32_bf16 v[80:83],a[88:91],v[216:219],v[80:83]
v_mfma_f32_16x16x32_bf16 v[84:87],a[92:95],v[220:223],v[84:87]
v_mfma_f32_16x16x32_bf16 v[80:83],a[96:99],v[224:227],v[80:83]
v_mfma_f32_16x16x32_bf16 v[84:87],a[100:103],v[228:231],v[84:87]
v_mfma_f32_16x16x32_bf16 v[80:83],a[104:107],v[232:235],v[80:83]
buffer_load_dwordx4 v[92:95],v26,s[20:23],s77 offen offset:1024 sc1
v_mfma_f32_16x16x32_bf16 v[84:87],a[108:111],v[236:239],v[84:87]
v_mfma_f32_16x16x32_bf16 v[80:83],a[112:115],v[240:243],v[80:83]
v_mfma_f32_16x16x32_bf16 v[84:87],a[116:119],v[244:247],v[84:87]
v_mfma_f32_16x16x32_bf16 v[80:83],a[120:123],v[248:251],v[80:83]
v_mfma_f32_16x16x32_bf16 v[84:87],a[124:127],v[252:255],v[84:87]
s_branch epi_290
ahead_289:
s_cmp_eq_u32 s93,0
s_cbranch_scc1 both_291
s_waitcnt vmcnt(15) lgkmcnt(0)
s_barrier
ds_read_b128 v[224:227],v18 offset:0
ds_read_b128 v[228:231],v18 offset:2048
ds_read_b128 v[232:235],v18 offset:4096
ds_read_b128 v[236:239],v18 offset:6144
ds_read_b128 v[240:243],v18 offset:8192
ds_read_b128 v[244:247],v18 offset:10240
ds_read_b128 v[248:251],v18 offset:12288
s_waitcnt lgkmcnt(5)
v_mfma_f32_16x16x32_bf16 v[64:67],a[0:3],v[224:227],0
s_add_u32 s96,s71,1
s_add_u32 s92,s71,2
v_mfma_f32_16x16x32_bf16 v[68:71],a[128:131],v[224:227],0
ds_read_b128 v[252:255],v18 offset:14336
v_min_u32 v27,v224,v228
v_mfma_f32_16x16x32_bf16 v[64:67],a[4:7],v[228:231],v[64:67]
buffer_load_dwordx2 v[120:121],v20,s[36:39],s78 offen
v_mfma_f32_16x16x32_bf16 v[68:71],a[132:135],v[228:231],v[68:71]
ds_read_b128 v[224:227],v18 offset:16384
s_waitcnt lgkmcnt(5)
v_mfma_f32_16x16x32_bf16 v[64:67],a[8:11],v[232:235],v[64:67]
v_min3_u32 v27,v27,v232,v236
v_mfma_f32_16x16x32_bf16 v[68:71],a[136:139],v[232:235],v[68:71]
ds_read_b128 v[228:231],v18 offset:18432
v_mfma_f32_16x16x32_bf16 v[64:67],a[12:15],v[236:239],v[64:67]
v_mfma_f32_16x16x32_bf16 v[68:71],a[140:143],v[236:239],v[68:71]
ds_read_b128 v[232:235],v18 offset:20480
s_waitcnt lgkmcnt(5)
v_mfma_f32_16x16x32_bf16 v[64:67],a[16:19],v[240:243],v[64:67]
v_min3_u32 v27,v27,v240,v244
v_mfma_f32_16x16x32_bf16 v[68:71],a[144:147],v[240:243],v[68:71]
ds_read_b128 v[236:239],v18 offset:22528
v_mfma_f32_16x16x32_bf16 v[64:67],a[20:23],v[244:247],v[64:67]
v_mfma_f32_16x16x32_bf16 v[68:71],a[148:151],v[244:247],v[68:71]
ds_read_b128 v[240:243],v18 offset:24576
s_waitcnt lgkmcnt(5)
v_mfma_f32_16x16x32_bf16 v[64:67],a[24:27],v[248:251],v[64:67]
v_min3_u32 v27,v27,v248,v252
v_mfma_f32_16x16x32_bf16 v[68:71],a[152:155],v[248:251],v[68:71]
ds_read_b128 v[244:247],v18 offset:26624
v_mfma_f32_16x16x32_bf16 v[64:67],a[28:31],v[252:255],v[64:67]
v_mfma_f32_16x16x32_bf16 v[68:71],a[156:159],v[252:255],v[68:71]
ds_read_b128 v[248:251],v18 offset:28672
s_waitcnt lgkmcnt(5)
v_mfma_f32_16x16x32_bf16 v[64:67],a[32:35],v[224:227],v[64:67]
v_min3_u32 v27,v27,v224,v228
v_mfma_f32_16x16x32_bf16 v[68:71],a[160:163],v[224:227],v[68:71]
ds_read_b128 v[252:255],v18 offset:30720
v_mfma_f32_16x16x32_bf16 v[64:67],a[36:39],v[228:231],v[64:67]
s_waitcnt vmcnt(3)
v_mfma_f32_16x16x32_bf16 v[68:71],a[164:167],v[228:231],v[68:71]
ds_read_b128 v[224:227],v18 offset:32768
s_waitcnt lgkmcnt(5)
v_mfma_f32_16x16x32_bf16 v[64:67],a[40:43],v[232:235],v[64:67]
v_cmp_gt_u32 vcc,s96,v29
v_cmp_gt_u32 s[92:93],s92,v29
v_mfma_f32_16x16x32_bf16 v[68:71],a[168:171],v[232:235],v[68:71]
ds_read_b128 v[228:231],v18 offset:34816
v_min3_u32 v27,v27,v232,v236
v_mfma_f32_16x16x32_bf16 v[64:67],a[44:47],v[236:239],v[64:67]
v_mov_b32 v44,vcc_lo
v_mov_b32 v45,s92
v_mfma_f32_16x16x32_bf16 v[68:71],a[172:175],v[236:239],v[68:71]
ds_read_b128 v[232:235],v18 offset:36864
s_waitcnt lgkmcnt(5)
v_mfma_f32_16x16x32_bf16 v[64:67],a[48:51],v[240:243],v[64:67]
ds_write_b64 v46,v[44:45]
v_min3_u32 v27,v27,v240,v244
v_mfma_f32_16x16x32_bf16 v[68:71],a[176:179],v[240:243],v[68:71]
ds_read_b128 v[236:239],v18 offset:38912
v_mfma_f32_16x16x32_bf16 v[64:67],a[52:55],v[244:247],v[64:67]
v_mfma_f32_16x16x32_bf16 v[68:71],a[180:183],v[244:247],v[68:71]
ds_read_b128 v[240:243],v18 offset:40960
s_waitcnt lgkmcnt(6)
v_mfma_f32_16x16x32_bf16 v[64:67],a[56:59],v[248:251],v[64:67]
v_min3_u32 v27,v27,v248,v252
s_add_u32 s88,s70,s75
v_mfma_f32_16x16x32_bf16 v[68:71],a[184:187],v[248:251],v[68:71]
ds_read_b128 v[244:247],v18 offset:43008
s_add_u32 s88,s88,2097152
v_mfma_f32_16x16x32_bf16 v[64:67],a[60:63],v[252:255],v[64:67]
s_xor_b32 s88,s88,0x2000
s_xor_b32 s89,s88,1024
v_mfma_f32_16x16x32_bf16 v[68:71],a[188:191],v[252:255],v[68:71]
ds_read_b128 v[248:251],v18 offset:45056
s_waitcnt lgkmcnt(6)
v_mfma_f32_16x16x32_bf16 v[64:67],a[64:67],v[224:227],v[64:67]
v_min3_u32 v27,v27,v224,v228
v_mfma_f32_16x16x32_bf16 v[68:71],a[192:195],v[224:227],v[68:71]
ds_read_b128 v[252:255],v18 offset:47104
v_mfma_f32_16x16x32_bf16 v[64:67],a[68:71],v[228:231],v[64:67]
v_mfma_f32_16x16x32_bf16 v[68:71],a[196:199],v[228:231],v[68:71]
ds_read_b128 v[224:227],v18 offset:49152
s_waitcnt lgkmcnt(5)
v_mfma_f32_16x16x32_bf16 v[64:67],a[72:75],v[232:235],v[64:67]
v_min3_u32 v27,v27,v232,v236
v_mfma_f32_16x16x32_bf16 v[68:71],a[200:203],v[232:235],v[68:71]
ds_read_b128 v[228:231],v18 offset:51200
v_mfma_f32_16x16x32_bf16 v[64:67],a[76:79],v[236:239],v[64:67]
v_mfma_f32_16x16x32_bf16 v[68:71],a[204:207],v[236:239],v[68:71]
ds_read_b128 v[232:235],v18 offset:53248
s_waitcnt lgkmcnt(5)
v_mfma_f32_16x16x32_bf16 v[64:67],a[80:83],v[240:243],v[64:67]
s_waitcnt vmcnt(8)
s_barrier
ds_read_b64 v[44:45],v47
ds_read_b128 v[128:131],v17 offset:0
ds_read_b128 v[132:135],v17 offset:2048
v_mfma_f32_16x16x32_bf16 v[68:71],a[208:211],v[240:243],v[68:71]
ds_read_b128 v[236:239],v18 offset:55296
v_min3_u32 v27,v27,v240,v244
v_mfma_f32_16x16x32_bf16 v[64:67],a[84:87],v[244:247],v[64:67]
ds_read_b128 v[136:139],v17 offset:4096
v_mfma_f32_16x16x32_bf16 v[68:71],a[212:215],v[244:247],v[68:71]
ds_read_b128 v[240:243],v18 offset:57344
s_waitcnt lgkmcnt(9)
v_mfma_f32_16x16x32_bf16 v[64:67],a[88:91],v[248:251],v[64:67]
ds_read_b128 v[140:143],v17 offset:6144
v_min3_u32 v27,v27,v248,v252
v_mfma_f32_16x16x32_bf16 v[68:71],a[216:219],v[248:251],v[68:71]
ds_read_b128 v[244:247],v18 offset:59392
v_mfma_f32_16x16x32_bf16 v[64:67],a[92:95],v[252:255],v[64:67]
ds_read_b128 v[144:147],v17 offset:8192
ds_read_b128 v[148:151],v17 offset:10240
v_mfma_f32_16x16x32_bf16 v[68:71],a[220:223],v[252:255],v[68:71]
ds_read_b128 v[248:251],v18 offset:61440
s_waitcnt lgkmcnt(12)
v_mfma_f32_16x16x32_bf16 v[64:67],a[96:99],v[224:227],v[64:67]
ds_read_b128 v[152:155],v17 offset:12288
s_waitcnt lgkmcnt(11)
v_min3_u32 v27,v27,v224,v228
v_mfma_f32_16x16x32_bf16 v[68:71],a[224:227],v[224:227],v[68:71]
ds_read_b128 v[252:255],v18 offset:63488
v_readfirstlane_b32 s93,v45
v_mfma_f32_16x16x32_bf16 v[64:67],a[100:103],v[228:231],v[64:67]
ds_read_b128 v[156:159],v17 offset:14336
v_readfirstlane_b32 s83,v44
s_cmp_lg_u32 s83,0
s_cbranch_scc1 keep_299
v_mfma_f32_16x16x32_bf16 v[68:71],a[228:231],v[228:231],v[68:71]
s_waitcnt vmcnt(1)
s_xor_b32 m0,s72,0
s_waitcnt lgkmcnt(10)
v_mfma_f32_16x16x32_bf16 v[64:67],a[104:107],v[232:235],v[64:67]
ds_read_b128 v[160:163],v17 offset:16384
ds_read_b128 v[164:167],v17 offset:18432
s_add_u32 s65,s88,0
v_mfma_f32_16x16x32_bf16 v[68:71],a[232:235],v[232:235],v[68:71]
v_add_u32 v22,s71,-1
v_min3_u32 v27,v27,v232,v236
v_mfma_f32_16x16x32_bf16 v[64:67],a[108:111],v[236:239],v[64:67]
ds_read_b128 v[168:171],v17 offset:20480
buffer_load_dwordx4 v16,s[20:23],s65 offen offset:0 sc1 lds
v_mfma_f32_16x16x32_bf16 v[68:71],a[236:239],v[236:239],v[68:71]
s_waitcnt lgkmcnt(9)
v_mfma_f32_16x16x32_bf16 v[64:67],a[112:115],v[240:243],v[64:67]
ds_read_b128 v[172:175],v17 offset:22528
v_min3_u32 v27,v27,v240,v244
v_mfma_f32_16x16x32_bf16 v[68:71],a[240:243],v[240:243],v[68:71]
buffer_store_dword v22,v23,s[20:23],s97 offen sc1
v_mfma_f32_16x16x32_bf16 v[64:67],a[116:119],v[244:247],v[64:67]
ds_read_b128 v[176:179],v17 offset:24576
ds_read_b128 v[180:183],v17 offset:26624
v_mfma_f32_16x16x32_bf16 v[68:71],a[244:247],v[244:247],v[68:71]
s_mov_b32 s97,0x7fff0000
s_waitcnt lgkmcnt(7)
v_mfma_f32_16x16x32_bf16 v[64:67],a[120:123],v[248:251],v[64:67]
ds_read_b128 v[184:187],v17 offset:28672
v_min3_u32 v27,v27,v248,v252
v_mfma_f32_16x16x32_bf16 v[68:71],a[248:251],v[248:251],v[68:71]
buffer_load_dwordx4 v16,s[20:23],s65 offen offset:2048 sc1 lds
v_mfma_f32_16x16x32_bf16 v[64:67],a[124:127],v[252:255],v[64:67]
ds_read_b128 v[188:191],v17 offset:30720
s_xor_b32 m0,s72,16384
v_mfma_f32_16x16x32_bf16 v[68:71],a[252:255],v[252:255],v[68:71]
s_add_u32 s65,s88,32768
v_mfma_f32_16x16x32_bf16 v[72:75],a[128:131],v[128:131],0
buffer_load_dwordx4 v16,s[20:23],s65 offen offset:0 sc1 lds
v_cmp_eq_u32 vcc,0,v27
s_cbranch_vccnz retry_287
v_mfma_f32_16x16x32_bf16 v[76:79],a[132:135],v[132:135],0
buffer_load_dwordx4 v16,s[20:23],s65 offen offset:2048 sc1 lds
v_mfma_f32_16x16x32_bf16 v[72:75],a[136:139],v[136:139],v[72:75]
ds_read_b128 v[192:195],v17 offset:32768
s_xor_b32 m0,s72,32768
v_mfma_f32_16x16x32_bf16 v[76:79],a[140:143],v[140:143],v[76:79]
ds_read_b128 v[196:199],v17 offset:34816
s_waitcnt lgkmcnt(10)
v_mfma_f32_16x16x32_bf16 v[72:75],a[144:147],v[144:147],v[72:75]
ds_read_b128 v[200:203],v17 offset:36864
s_add_u32 s65,s88,65536
s_waitcnt vmcnt(5)
v_and_or_b32 v64,v64,-4,s48
v_mfma_f32_16x16x32_bf16 v[76:79],a[148:151],v[148:151],v[76:79]
ds_read_b128 v[204:207],v17 offset:38912
v_min3_u32 v27,v27,v128,v132
s_add_u32 s64,s49,s34
v_mfma_f32_16x16x32_bf16 v[72:75],a[152:155],v[152:155],v[72:75]
ds_read_b128 v[208:211],v17 offset:40960
v_min3_u32 v27,v27,v136,v140
buffer_store_dwordx4 v[64:67],v25,s[20:23],s64 offen offset:2048
v_mfma_f32_16x16x32_bf16 v[76:79],a[156:159],v[156:159],v[76:79]
v_min3_u32 v27,v27,v144,v148
v_and_or_b32 v68,v68,-4,s48
s_add_u32 s64,s49,s35
s_waitcnt lgkmcnt(9)
v_mfma_f32_16x16x32_bf16 v[72:75],a[160:163],v[160:163],v[72:75]
ds_read_b128 v[212:215],v17 offset:43008
v_min3_u32 v27,v27,v152,v156
buffer_store_dwordx4 v[68:71],v25,s[20:23],s64 offen offset:3072
v_mfma_f32_16x16x32_bf16 v[76:79],a[164:167],v[164:167],v[76:79]
ds_read_b128 v[216:219],v17 offset:45056
v_min3_u32 v27,v27,v160,v164
v_mfma_f32_16x16x32_bf16 v[72:75],a[168:171],v[168:171],v[72:75]
ds_read_b128 v[220:223],v17 offset:47104
s_mov_b32 s49,0x7fff0000
v_mfma_f32_16x16x32_bf16 v[76:79],a[172:175],v[172:175],v[76:79]
ds_read_b128 v[224:227],v17 offset:49152
s_waitcnt lgkmcnt(9)
v_mfma_f32_16x16x32_bf16 v[72:75],a[176:179],v[176:179],v[72:75]
ds_read_b128 v[228:231],v17 offset:51200
v_min3_u32 v27,v27,v168,v172
v_mfma_f32_16x16x32_bf16 v[76:79],a[180:183],v[180:183],v[76:79]
buffer_load_dwordx4 v16,s[20:23],s65 offen offset:0 sc1 lds
v_mfma_f32_16x16x32_bf16 v[72:75],a[184:187],v[184:187],v[72:75]
ds_read_b128 v[232:235],v17 offset:53248
v_min3_u32 v27,v27,v176,v180
v_mfma_f32_16x16x32_bf16 v[76:79],a[188:191],v[188:191],v[76:79]
ds_read_b128 v[236:239],v17 offset:55296
s_waitcnt lgkmcnt(8)
v_mfma_f32_16x16x32_bf16 v[72:75],a[192:195],v[192:195],v[72:75]
ds_read_b128 v[240:243],v17 offset:57344
v_min3_u32 v27,v27,v184,v188
v_mfma_f32_16x16x32_bf16 v[76:79],a[196:199],v[196:199],v[76:79]
ds_read_b128 v[244:247],v17 offset:59392
v_min3_u32 v27,v27,v192,v196
v_mfma_f32_16x16x32_bf16 v[72:75],a[200:203],v[200:203],v[72:75]
ds_read_b128 v[248:251],v17 offset:61440
ds_bpermute_b32 v124,v41,v120
v_mfma_f32_16x16x32_bf16 v[76:79],a[204:207],v[204:207],v[76:79]
v_min3_u32 v27,v27,v200,v204
s_waitcnt lgkmcnt(8)
v_mfma_f32_16x16x32_bf16 v[72:75],a[208:211],v[208:211],v[72:75]
ds_read_b128 v[252:255],v17 offset:63488
ds_bpermute_b32 v125,v41,v121
v_mfma_f32_16x16x32_bf16 v[76:79],a[212:215],v[212:215],v[76:79]
buffer_load_dwordx4 v16,s[20:23],s65 offen offset:2048 sc1 lds
v_mfma_f32_16x16x32_bf16 v[72:75],a[216:219],v[216:219],v[72:75]
s_xor_b32 m0,s72,49152
s_add_u32 s65,s88,98304
v_mfma_f32_16x16x32_bf16 v[76:79],a[220:223],v[220:223],v[76:79]
v_min3_u32 v27,v27,v208,v212
s_waitcnt lgkmcnt(6)
v_mfma_f32_16x16x32_bf16 v[72:75],a[224:227],v[224:227],v[72:75]
buffer_load_dwordx4 v16,s[20:23],s65 offen offset:0 sc1 lds
v_mfma_f32_16x16x32_bf16 v[76:79],a[228:231],v[228:231],v[76:79]
buffer_load_dwordx4 v16,s[20:23],s65 offen offset:2048 sc1 lds
v_min3_u32 v27,v27,v224,v228
v_mfma_f32_16x16x32_bf16 v[72:75],a[232:235],v[232:235],v[72:75]
s_xor_b32 m0,s72,1024
s_add_u32 s65,s89,0
v_mfma_f32_16x16x32_bf16 v[76:79],a[236:239],v[236:239],v[76:79]
v_min3_u32 v27,v27,v216,v220
v_min3_u32 v27,v27,v232,v236
s_waitcnt lgkmcnt(1)
v_mfma_f32_16x16x32_bf16 v[72:75],a[240:243],v[240:243],v[72:75]
buffer_load_dwordx4 v16,s[20:23],s65 offen offset:0 sc1 lds
v_mfma_f32_16x16x32_bf16 v[76:79],a[244:247],v[244:247],v[76:79]
buffer_load_dwordx4 v16,s[20:23],s65 offen offset:2048 sc1 lds
v_min3_u32 v27,v27,v240,v244
v_mfma_f32_16x16x32_bf16 v[72:75],a[248:251],v[248:251],v[72:75]
s_xor_b32 m0,s72,17408
s_add_u32 s65,s89,32768
v_mfma_f32_16x16x32_bf16 v[76:79],a[252:255],v[252:255],v[76:79]
buffer_load_dwordx4 v16,s[20:23],s65 offen offset:0 sc1 lds
v_min3_u32 v27,v27,v248,v252
v_mfma_f32_16x16x32_bf16 v[80:83],a[0:3],v[128:131],0
buffer_load_dwordx4 v16,s[20:23],s65 offen offset:2048 sc1 lds
v_cmp_eq_u32 vcc,0,v27
s_cbranch_vccnz retry_287
v_mfma_f32_16x16x32_bf16 v[84:87],a[4:7],v[132:135],0
s_xor_b32 m0,s72,33792
s_add_u32 s65,s89,65536
v_mfma_f32_16x16x32_bf16 v[80:83],a[8:11],v[136:139],v[80:83]
buffer_load_dwordx4 v16,s[20:23],s65 offen offset:0 sc1 lds
v_mfma_f32_16x16x32_bf16 v[84:87],a[12:15],v[140:143],v[84:87]
buffer_load_dwordx4 v16,s[20:23],s65 offen offset:2048 sc1 lds
v_mfma_f32_16x16x32_bf16 v[80:83],a[16:19],v[144:147],v[80:83]
s_xor_b32 m0,s72,50176
s_add_u32 s65,s89,98304
v_add_f32 v72,v72,v76
v_mfma_f32_16x16x32_bf16 v[84:87],a[20:23],v[148:151],v[84:87]
buffer_load_dwordx4 v16,s[20:23],s65 offen offset:0 sc1 lds
v_add_f32 v73,v73,v77
v_mfma_f32_16x16x32_bf16 v[80:83],a[24:27],v[152:155],v[80:83]
buffer_load_dwordx4 v16,s[20:23],s65 offen offset:2048 sc1 lds
v_add_f32 v74,v74,v78
v_mfma_f32_16x16x32_bf16 v[84:87],a[28:31],v[156:159],v[84:87]
s_waitcnt lgkmcnt(0)
v_lshlrev_b32 v104,16,v124
v_add_f32 v75,v75,v79
v_mfma_f32_16x16x32_bf16 v[80:83],a[32:35],v[160:163],v[80:83]
v_and_b32 v105,s80,v124
v_lshlrev_b32 v106,16,v125
v_and_or_b32 v72,v72,-4,s48
v_mfma_f32_16x16x32_bf16 v[84:87],a[36:39],v[164:167],v[84:87]
v_and_b32 v107,s80,v125
s_add_u32 s64,s77,s33
v_mfma_f32_16x16x32_bf16 v[80:83],a[40:43],v[168:171],v[80:83]
buffer_store_dwordx4 v[72:75],v25,s[20:23],s64 offen offset:1024
v_mfma_f32_16x16x32_bf16 v[84:87],a[44:47],v[172:175],v[84:87]
v_mfma_f32_16x16x32_bf16 v[80:83],a[48:51],v[176:179],v[80:83]
v_mfma_f32_16x16x32_bf16 v[84:87],a[52:55],v[180:183],v[84:87]
v_mfma_f32_16x16x32_bf16 v[80:83],a[56:59],v[184:187],v[80:83]
v_mfma_f32_16x16x32_bf16 v[84:87],a[60:63],v[188:191],v[84:87]
v_mfma_f32_16x16x32_bf16 v[80:83],a[64:67],v[192:195],v[80:83]
buffer_load_dwordx4 v[96:99],v26,s[20:23],s77 offen offset:2048 sc1
v_mfma_f32_16x16x32_bf16 v[84:87],a[68:71],v[196:199],v[84:87]
buffer_load_dwordx4 v[100:103],v26,s[20:23],s77 offen offset:3072 sc1
v_mfma_f32_16x16x32_bf16 v[80:83],a[72:75],v[200:203],v[80:83]
v_mfma_f32_16x16x32_bf16 v[84:87],a[76:79],v[204:207],v[84:87]
v_mfma_f32_16x16x32_bf16 v[80:83],a[80:83],v[208:211],v[80:83]
v_mfma_f32_16x16x32_bf16 v[84:87],a[84:87],v[212:215],v[84:87]
v_mfma_f32_16x16x32_bf16 v[80:83],a[88:91],v[216:219],v[80:83]
v_mfma_f32_16x16x32_bf16 v[84:87],a[92:95],v[220:223],v[84:87]
v_mfma_f32_16x16x32_bf16 v[80:83],a[96:99],v[224:227],v[80:83]
v_mfma_f32_16x16x32_bf16 v[84:87],a[100:103],v[228:231],v[84:87]
v_mfma_f32_16x16x32_bf16 v[80:83],a[104:107],v[232:235],v[80:83]
buffer_load_dwordx4 v[92:95],v26,s[20:23],s77 offen offset:1024 sc1
v_mfma_f32_16x16x32_bf16 v[84:87],a[108:111],v[236:239],v[84:87]
v_mfma_f32_16x16x32_bf16 v[80:83],a[112:115],v[240:243],v[80:83]
v_mfma_f32_16x16x32_bf16 v[84:87],a[116:119],v[244:247],v[84:87]
v_mfma_f32_16x16x32_bf16 v[80:83],a[120:123],v[248:251],v[80:83]
v_mfma_f32_16x16x32_bf16 v[84:87],a[124:127],v[252:255],v[84:87]
s_branch epi_290
keep_299:
v_mfma_f32_16x16x32_bf16 v[68:71],a[228:231],v[228:231],v[68:71]
s_waitcnt vmcnt(1)
s_waitcnt lgkmcnt(10)
v_mfma_f32_16x16x32_bf16 v[64:67],a[104:107],v[232:235],v[64:67]
ds_read_b128 v[160:163],v17 offset:16384
ds_read_b128 v[164:167],v17 offset:18432
v_mfma_f32_16x16x32_bf16 v[68:71],a[232:235],v[232:235],v[68:71]
v_add_u32 v22,s71,-1
v_min3_u32 v27,v27,v232,v236
v_mfma_f32_16x16x32_bf16 v[64:67],a[108:111],v[236:239],v[64:67]
ds_read_b128 v[168:171],v17 offset:20480
v_mfma_f32_16x16x32_bf16 v[68:71],a[236:239],v[236:239],v[68:71]
s_waitcnt lgkmcnt(9)
v_mfma_f32_16x16x32_bf16 v[64:67],a[112:115],v[240:243],v[64:67]
ds_read_b128 v[172:175],v17 offset:22528
v_min3_u32 v27,v27,v240,v244
v_mfma_f32_16x16x32_bf16 v[68:71],a[240:243],v[240:243],v[68:71]
buffer_store_dword v22,v23,s[20:23],s97 offen sc1
v_mfma_f32_16x16x32_bf16 v[64:67],a[116:119],v[244:247],v[64:67]
ds_read_b128 v[176:179],v17 offset:24576
ds_read_b128 v[180:183],v17 offset:26624
v_mfma_f32_16x16x32_bf16 v[68:71],a[244:247],v[244:247],v[68:71]
s_mov_b32 s97,0x7fff0000
s_waitcnt lgkmcnt(7)
v_mfma_f32_16x16x32_bf16 v[64:67],a[120:123],v[248:251],v[64:67]
ds_read_b128 v[184:187],v17 offset:28672
v_min3_u32 v27,v27,v248,v252
v_mfma_f32_16x16x32_bf16 v[68:71],a[248:251],v[248:251],v[68:71]
v_mfma_f32_16x16x32_bf16 v[64:67],a[124:127],v[252:255],v[64:67]
ds_read_b128 v[188:191],v17 offset:30720
v_mfma_f32_16x16x32_bf16 v[68:71],a[252:255],v[252:255],v[68:71]
v_mfma_f32_16x16x32_bf16 v[72:75],a[128:131],v[128:131],0
v_cmp_eq_u32 vcc,0,v27
s_cbranch_vccnz retry_287
v_mfma_f32_16x16x32_bf16 v[76:79],a[132:135],v[132:135],0
v_min3_u32 v27,v27,v128,v132
v_mfma_f32_16x16x32_bf16 v[72:75],a[136:139],v[136:139],v[72:75]
ds_read_b128 v[192:195],v17 offset:32768
v_mfma_f32_16x16x32_bf16 v[76:79],a[140:143],v[140:143],v[76:79]
ds_read_b128 v[196:199],v17 offset:34816
s_waitcnt lgkmcnt(10)
v_mfma_f32_16x16x32_bf16 v[72:75],a[144:147],v[144:147],v[72:75]
ds_read_b128 v[200:203],v17 offset:36864
v_min3_u32 v27,v27,v136,v140
s_waitcnt vmcnt(1)
v_mfma_f32_16x16x32_bf16 v[76:79],a[148:151],v[148:151],v[76:79]
ds_read_b128 v[204:207],v17 offset:38912
v_min3_u32 v27,v27,v144,v148
v_and_or_b32 v64,v64,-4,s48
v_mfma_f32_16x16x32_bf16 v[72:75],a[152:155],v[152:155],v[72:75]
ds_read_b128 v[208:211],v17 offset:40960
s_add_u32 s64,s49,s34
v_mfma_f32_16x16x32_bf16 v[76:79],a[156:159],v[156:159],v[76:79]
v_min3_u32 v27,v27,v152,v156
s_waitcnt lgkmcnt(9)
v_mfma_f32_16x16x32_bf16 v[72:75],a[160:163],v[160:163],v[72:75]
ds_read_b128 v[212:215],v17 offset:43008
buffer_store_dwordx4 v[64:67],v25,s[20:23],s64 offen offset:2048
v_mfma_f32_16x16x32_bf16 v[76:79],a[164:167],v[164:167],v[76:79]
ds_read_b128 v[216:219],v17 offset:45056
v_min3_u32 v27,v27,v160,v164
v_and_or_b32 v68,v68,-4,s48
v_mfma_f32_16x16x32_bf16 v[72:75],a[168:171],v[168:171],v[72:75]
ds_read_b128 v[220:223],v17 offset:47104
s_add_u32 s64,s49,s35
v_mfma_f32_16x16x32_bf16 v[76:79],a[172:175],v[172:175],v[76:79]
ds_read_b128 v[224:227],v17 offset:49152
s_waitcnt lgkmcnt(9)
v_mfma_f32_16x16x32_bf16 v[72:75],a[176:179],v[176:179],v[72:75]
ds_read_b128 v[228:231],v17 offset:51200
v_min3_u32 v27,v27,v168,v172
v_mfma_f32_16x16x32_bf16 v[76:79],a[180:183],v[180:183],v[76:79]
v_min3_u32 v27,v27,v176,v180
buffer_store_dwordx4 v[68:71],v25,s[20:23],s64 offen offset:3072
v_mfma_f32_16x16x32_bf16 v[72:75],a[184:187],v[184:187],v[72:75]
ds_read_b128 v[232:235],v17 offset:53248
s_mov_b32 s49,0x7fff0000
v_mfma_f32_16x16x32_bf16 v[76:79],a[188:191],v[188:191],v[76:79]
ds_read_b128 v[236:239],v17 offset:55296
s_waitcnt lgkmcnt(8)
v_mfma_f32_16x16x32_bf16 v[72:75],a[192:195],v[192:195],v[72:75]
ds_read_b128 v[240:243],v17 offset:57344
v_min3_u32 v27,v27,v184,v188
v_mfma_f32_16x16x32_bf16 v[76:79],a[196:199],v[196:199],v[76:79]
ds_read_b128 v[244:247],v17 offset:59392
v_min3_u32 v27,v27,v192,v196
v_mfma_f32_16x16x32_bf16 v[72:75],a[200:203],v[200:203],v[72:75]
ds_read_b128 v[248:251],v17 offset:61440
ds_bpermute_b32 v124,v41,v120
v_mfma_f32_16x16x32_bf16 v[76:79],a[204:207],v[204:207],v[76:79]
v_min3_u32 v27,v27,v200,v204
s_waitcnt lgkmcnt(8)
v_mfma_f32_16x16x32_bf16 v[72:75],a[208:211],v[208:211],v[72:75]
ds_read_b128 v[252:255],v17 offset:63488
ds_bpermute_b32 v125,v41,v121
v_mfma_f32_16x16x32_bf16 v[76:79],a[212:215],v[212:215],v[76:79]
v_min3_u32 v27,v27,v208,v212
v_mfma_f32_16x16x32_bf16 v[72:75],a[216:219],v[216:219],v[72:75]
v_mfma_f32_16x16x32_bf16 v[76:79],a[220:223],v[220:223],v[76:79]
v_min3_u32 v27,v27,v216,v220
s_waitcnt lgkmcnt(6)
v_mfma_f32_16x16x32_bf16 v[72:75],a[224:227],v[224:227],v[72:75]
s_waitcnt lgkmcnt(0)
v_mfma_f32_16x16x32_bf16 v[76:79],a[228:231],v[228:231],v[76:79]
v_min3_u32 v27,v27,v224,v228
v_mfma_f32_16x16x32_bf16 v[72:75],a[232:235],v[232:235],v[72:75]
v_lshlrev_b32 v104,16,v124
v_mfma_f32_16x16x32_bf16 v[76:79],a[236:239],v[236:239],v[76:79]
v_min3_u32 v27,v27,v232,v236
v_mfma_f32_16x16x32_bf16 v[72:75],a[240:243],v[240:243],v[72:75]
v_mfma_f32_16x16x32_bf16 v[76:79],a[244:247],v[244:247],v[76:79]
v_min3_u32 v27,v27,v240,v244
v_mfma_f32_16x16x32_bf16 v[72:75],a[248:251],v[248:251],v[72:75]
v_and_b32 v105,s80,v124
v_mfma_f32_16x16x32_bf16 v[76:79],a[252:255],v[252:255],v[76:79]
v_min3_u32 v27,v27,v248,v252
v_mfma_f32_16x16x32_bf16 v[80:83],a[0:3],v[128:131],0
v_cmp_eq_u32 vcc,0,v27
s_cbranch_vccnz retry_287
v_mfma_f32_16x16x32_bf16 v[84:87],a[4:7],v[132:135],0
v_lshlrev_b32 v106,16,v125
v_mfma_f32_16x16x32_bf16 v[80:83],a[8:11],v[136:139],v[80:83]
v_mfma_f32_16x16x32_bf16 v[84:87],a[12:15],v[140:143],v[84:87]
v_mfma_f32_16x16x32_bf16 v[80:83],a[16:19],v[144:147],v[80:83]
v_and_b32 v107,s80,v125
v_add_f32 v72,v72,v76
v_mfma_f32_16x16x32_bf16 v[84:87],a[20:23],v[148:151],v[84:87]
v_add_f32 v73,v73,v77
v_add_f32 v74,v74,v78
v_mfma_f32_16x16x32_bf16 v[80:83],a[24:27],v[152:155],v[80:83]
v_add_f32 v75,v75,v79
v_and_or_b32 v72,v72,-4,s48
v_mfma_f32_16x16x32_bf16 v[84:87],a[28:31],v[156:159],v[84:87]
s_add_u32 s64,s77,s33
v_mfma_f32_16x16x32_bf16 v[80:83],a[32:35],v[160:163],v[80:83]
buffer_store_dwordx4 v[72:75],v25,s[20:23],s64 offen offset:1024
v_mfma_f32_16x16x32_bf16 v[84:87],a[36:39],v[164:167],v[84:87]
v_mfma_f32_16x16x32_bf16 v[80:83],a[40:43],v[168:171],v[80:83]
v_mfma_f32_16x16x32_bf16 v[84:87],a[44:47],v[172:175],v[84:87]
v_mfma_f32_16x16x32_bf16 v[80:83],a[48:51],v[176:179],v[80:83]
v_mfma_f32_16x16x32_bf16 v[84:87],a[52:55],v[180:183],v[84:87]
v_mfma_f32_16x16x32_bf16 v[80:83],a[56:59],v[184:187],v[80:83]
v_mfma_f32_16x16x32_bf16 v[84:87],a[60:63],v[188:191],v[84:87]
v_mfma_f32_16x16x32_bf16 v[80:83],a[64:67],v[192:195],v[80:83]
buffer_load_dwordx4 v[96:99],v26,s[20:23],s77 offen offset:2048 sc1
v_mfma_f32_16x16x32_bf16 v[84:87],a[68:71],v[196:199],v[84:87]
buffer_load_dwordx4 v[100:103],v26,s[20:23],s77 offen offset:3072 sc1
v_mfma_f32_16x16x32_bf16 v[80:83],a[72:75],v[200:203],v[80:83]
v_mfma_f32_16x16x32_bf16 v[84:87],a[76:79],v[204:207],v[84:87]
v_mfma_f32_16x16x32_bf16 v[80:83],a[80:83],v[208:211],v[80:83]
v_mfma_f32_16x16x32_bf16 v[84:87],a[84:87],v[212:215],v[84:87]
v_mfma_f32_16x16x32_bf16 v[80:83],a[88:91],v[216:219],v[80:83]
v_mfma_f32_16x16x32_bf16 v[84:87],a[92:95],v[220:223],v[84:87]
v_mfma_f32_16x16x32_bf16 v[80:83],a[96:99],v[224:227],v[80:83]
v_mfma_f32_16x16x32_bf16 v[84:87],a[100:103],v[228:231],v[84:87]
v_mfma_f32_16x16x32_bf16 v[80:83],a[104:107],v[232:235],v[80:83]
buffer_load_dwordx4 v[92:95],v26,s[20:23],s77 offen offset:1024 sc1
v_mfma_f32_16x16x32_bf16 v[84:87],a[108:111],v[236:239],v[84:87]
v_mfma_f32_16x16x32_bf16 v[80:83],a[112:115],v[240:243],v[80:83]
v_mfma_f32_16x16x32_bf16 v[84:87],a[116:119],v[244:247],v[84:87]
v_mfma_f32_16x16x32_bf16 v[80:83],a[120:123],v[248:251],v[80:83]
v_mfma_f32_16x16x32_bf16 v[84:87],a[124:127],v[252:255],v[84:87]
s_branch epi_290
both_291:
s_waitcnt vmcnt(15) lgkmcnt(0)
s_barrier
ds_read_b128 v[224:227],v18 offset:0
ds_read_b128 v[228:231],v18 offset:2048
ds_read_b128 v[232:235],v18 offset:4096
ds_read_b128 v[236:239],v18 offset:6144
ds_read_b128 v[240:243],v18 offset:8192
ds_read_b128 v[244:247],v18 offset:10240
ds_read_b128 v[248:251],v18 offset:12288
s_waitcnt lgkmcnt(5)
v_mfma_f32_16x16x32_bf16 v[64:67],a[0:3],v[224:227],0
s_add_u32 s96,s71,1
s_add_u32 s92,s71,2
v_min_u32 v27,v224,v228
v_mfma_f32_16x16x32_bf16 v[68:71],a[128:131],v[224:227],0
ds_read_b128 v[252:255],v18 offset:14336
s_add_u32 s88,s70,s75
v_mfma_f32_16x16x32_bf16 v[64:67],a[4:7],v[228:231],v[64:67]
s_add_u32 s88,s88,2097152
s_xor_b32 s88,s88,0x2000
v_mfma_f32_16x16x32_bf16 v[68:71],a[132:135],v[228:231],v[68:71]
ds_read_b128 v[224:227],v18 offset:16384
s_waitcnt lgkmcnt(5)
v_mfma_f32_16x16x32_bf16 v[64:67],a[8:11],v[232:235],v[64:67]
s_xor_b32 s89,s88,1024
v_min3_u32 v27,v27,v232,v236
v_mfma_f32_16x16x32_bf16 v[68:71],a[136:139],v[232:235],v[68:71]
ds_read_b128 v[228:231],v18 offset:18432
v_mfma_f32_16x16x32_bf16 v[64:67],a[12:15],v[236:239],v[64:67]
s_xor_b32 m0,s72,0
v_mfma_f32_16x16x32_bf16 v[68:71],a[140:143],v[236:239],v[68:71]
ds_read_b128 v[232:235],v18 offset:20480
s_waitcnt lgkmcnt(5)
v_mfma_f32_16x16x32_bf16 v[64:67],a[16:19],v[240:243],v[64:67]
s_add_u32 s65,s88,0
v_min3_u32 v27,v27,v240,v244
v_mfma_f32_16x16x32_bf16 v[68:71],a[144:147],v[240:243],v[68:71]
ds_read_b128 v[236:239],v18 offset:22528
v_mfma_f32_16x16x32_bf16 v[64:67],a[20:23],v[244:247],v[64:67]
buffer_load_dwordx4 v16,s[20:23],s65 offen offset:0 sc1 lds
v_mfma_f32_16x16x32_bf16 v[68:71],a[148:151],v[244:247],v[68:71]
ds_read_b128 v[240:243],v18 offset:24576
s_waitcnt lgkmcnt(5)
v_mfma_f32_16x16x32_bf16 v[64:67],a[24:27],v[248:251],v[64:67]
buffer_load_dwordx4 v16,s[20:23],s65 offen offset:2048 sc1 lds
v_mfma_f32_16x16x32_bf16 v[68:71],a[152:155],v[248:251],v[68:71]
ds_read_b128 v[244:247],v18 offset:26624
v_min3_u32 v27,v27,v248,v252
v_mfma_f32_16x16x32_bf16 v[64:67],a[28:31],v[252:255],v[64:67]
s_xor_b32 m0,s72,16384
v_mfma_f32_16x16x32_bf16 v[68:71],a[156:159],v[252:255],v[68:71]
ds_read_b128 v[248:251],v18 offset:28672
s_waitcnt lgkmcnt(5)
v_mfma_f32_16x16x32_bf16 v[64:67],a[32:35],v[224:227],v[64:67]
s_add_u32 s65,s88,32768
v_min3_u32 v27,v27,v224,v228
v_mfma_f32_16x16x32_bf16 v[68:71],a[160:163],v[224:227],v[68:71]
ds_read_b128 v[252:255],v18 offset:30720
v_mfma_f32_16x16x32_bf16 v[64:67],a[36:39],v[228:231],v[64:67]
s_waitcnt vmcnt(4)
buffer_load_dwordx4 v16,s[20:23],s65 offen offset:0 sc1 lds
v_mfma_f32_16x16x32_bf16 v[68:71],a[164:167],v[228:231],v[68:71]
ds_read_b128 v[224:227],v18 offset:32768
s_waitcnt lgkmcnt(5)
v_mfma_f32_16x16x32_bf16 v[64:67],a[40:43],v[232:235],v[64:67]
v_cmp_gt_u32 vcc,s96,v29
v_cmp_gt_u32 s[92:93],s92,v29
v_min3_u32 v27,v27,v232,v236
v_mfma_f32_16x16x32_bf16 v[68:71],a[168:171],v[232:235],v[68:71]
ds_read_b128 v[228:231],v18 offset:34816
buffer_load_dwordx4 v16,s[20:23],s65 offen offset:2048 sc1 lds
v_mfma_f32_16x16x32_bf16 v[64:67],a[44:47],v[236:239],v[64:67]
v_mov_b32 v44,vcc_lo
v_mov_b32 v45,s92
v_mfma_f32_16x16x32_bf16 v[68:71],a[172:175],v[236:239],v[68:71]
ds_read_b128 v[232:235],v18 offset:36864
s_xor_b32 m0,s72,32768
s_waitcnt lgkmcnt(5)
v_mfma_f32_16x16x32_bf16 v[64:67],a[48:51],v[240:243],v[64:67]
ds_write_b64 v46,v[44:45]
v_min3_u32 v27,v27,v240,v244
v_mfma_f32_16x16x32_bf16 v[68:71],a[176:179],v[240:243],v[68:71]
ds_read_b128 v[236:239],v18 offset:38912
s_add_u32 s65,s88,65536
v_mfma_f32_16x16x32_bf16 v[64:67],a[52:55],v[244:247],v[64:67]
buffer_load_dwordx2 v[120:121],v20,s[36:39],s78 offen
v_mfma_f32_16x16x32_bf16 v[68:71],a[180:183],v[244:247],v[68:71]
ds_read_b128 v[240:243],v18 offset:40960
s_waitcnt lgkmcnt(6)
v_mfma_f32_16x16x32_bf16 v[64:67],a[56:59],v[248:251],v[64:67]
buffer_load_dwordx4 v16,s[20:23],s65 offen offset:0 sc1 lds
v_mfma_f32_16x16x32_bf16 v[68:71],a[184:187],v[248:251],v[68:71]
ds_read_b128 v[244:247],v18 offset:43008
buffer_load_dwordx4 v16,s[20:23],s65 offen offset:2048 sc1 lds
v_mfma_f32_16x16x32_bf16 v[64:67],a[60:63],v[252:255],v[64:67]
v_min3_u32 v27,v27,v248,v252
v_mfma_f32_16x16x32_bf16 v[68:71],a[188:191],v[252:255],v[68:71]
ds_read_b128 v[248:251],v18 offset:45056
s_xor_b32 m0,s72,49152
s_waitcnt lgkmcnt(6)
v_mfma_f32_16x16x32_bf16 v[64:67],a[64:67],v[224:227],v[64:67]
v_min3_u32 v27,v27,v224,v228
v_mfma_f32_16x16x32_bf16 v[68:71],a[192:195],v[224:227],v[68:71]
ds_read_b128 v[252:255],v18 offset:47104
s_add_u32 s65,s88,98304
v_mfma_f32_16x16x32_bf16 v[64:67],a[68:71],v[228:231],v[64:67]
v_mfma_f32_16x16x32_bf16 v[68:71],a[196:199],v[228:231],v[68:71]
ds_read_b128 v[224:227],v18 offset:49152
s_waitcnt lgkmcnt(5)
v_mfma_f32_16x16x32_bf16 v[64:67],a[72:75],v[232:235],v[64:67]
buffer_load_dwordx4 v16,s[20:23],s65 offen offset:0 sc1 lds
v_mfma_f32_16x16x32_bf16 v[68:71],a[200:203],v[232:235],v[68:71]
ds_read_b128 v[228:231],v18 offset:51200
buffer_load_dwordx4 v16,s[20:23],s65 offen offset:2048 sc1 lds
v_mfma_f32_16x16x32_bf16 v[64:67],a[76:79],v[236:239],v[64:67]
v_min3_u32 v27,v27,v232,v236
v_mfma_f32_16x16x32_bf16 v[68:71],a[204:207],v[236:239],v[68:71]
ds_read_b128 v[232:235],v18 offset:53248
s_waitcnt lgkmcnt(5)
v_mfma_f32_16x16x32_bf16 v[64:67],a[80:83],v[240:243],v[64:67]
s_waitcnt vmcnt(16)
s_barrier
ds_read_b64 v[44:45],v47
ds_read_b128 v[128:131],v17 offset:0
ds_read_b128 v[132:135],v17 offset:2048
v_mfma_f32_16x16x32_bf16 v[68:71],a[208:211],v[240:243],v[68:71]
ds_read_b128 v[236:239],v18 offset:55296
s_xor_b32 m0,s72,1024
v_min3_u32 v27,v27,v240,v244
v_mfma_f32_16x16x32_bf16 v[64:67],a[84:87],v[244:247],v[64:67]
ds_read_b128 v[136:139],v17 offset:4096
s_add_u32 s65,s89,0
v_mfma_f32_16x16x32_bf16 v[68:71],a[212:215],v[244:247],v[68:71]
ds_read_b128 v[240:243],v18 offset:57344
s_waitcnt lgkmcnt(9)
v_mfma_f32_16x16x32_bf16 v[64:67],a[88:91],v[248:251],v[64:67]
ds_read_b128 v[140:143],v17 offset:6144
buffer_load_dwordx4 v16,s[20:23],s65 offen offset:0 sc1 lds
v_mfma_f32_16x16x32_bf16 v[68:71],a[216:219],v[248:251],v[68:71]
ds_read_b128 v[244:247],v18 offset:59392
v_min3_u32 v27,v27,v248,v252
v_mfma_f32_16x16x32_bf16 v[64:67],a[92:95],v[252:255],v[64:67]
ds_read_b128 v[144:147],v17 offset:8192
ds_read_b128 v[148:151],v17 offset:10240
v_mfma_f32_16x16x32_bf16 v[68:71],a[220:223],v[252:255],v[68:71]
ds_read_b128 v[248:251],v18 offset:61440
s_waitcnt lgkmcnt(12)
v_mfma_f32_16x16x32_bf16 v[64:67],a[96:99],v[224:227],v[64:67]
ds_read_b128 v[152:155],v17 offset:12288
s_waitcnt lgkmcnt(11)
v_min3_u32 v27,v27,v224,v228
v_mfma_f32_16x16x32_bf16 v[68:71],a[224:227],v[224:227],v[68:71]
ds_read_b128 v[252:255],v18 offset:63488
v_readfirstlane_b32 s93,v45
v_mfma_f32_16x16x32_bf16 v[64:67],a[100:103],v[228:231],v[64:67]
ds_read_b128 v[156:159],v17 offset:14336
buffer_load_dwordx4 v16,s[20:23],s65 offen offset:2048 sc1 lds
v_mfma_f32_16x16x32_bf16 v[68:71],a[228:231],v[228:231],v[68:71]
s_xor_b32 m0,s72,17408
s_add_u32 s65,s89,32768
s_waitcnt lgkmcnt(10)
v_mfma_f32_16x16x32_bf16 v[64:67],a[104:107],v[232:235],v[64:67]
ds_read_b128 v[160:163],v17 offset:16384
ds_read_b128 v[164:167],v17 offset:18432
v_min3_u32 v27,v27,v232,v236
v_mfma_f32_16x16x32_bf16 v[68:71],a[232:235],v[232:235],v[68:71]
buffer_load_dwordx4 v16,s[20:23],s65 offen offset:0 sc1 lds
s_waitcnt vmcnt(12)
v_mfma_f32_16x16x32_bf16 v[64:67],a[108:111],v[236:239],v[64:67]
ds_read_b128 v[168:171],v17 offset:20480
buffer_load_dwordx4 v16,s[20:23],s65 offen offset:2048 sc1 lds
v_mfma_f32_16x16x32_bf16 v[68:71],a[236:239],v[236:239],v[68:71]
v_add_u32 v22,s71,-1
s_waitcnt lgkmcnt(9)
v_mfma_f32_16x16x32_bf16 v[64:67],a[112:115],v[240:243],v[64:67]
ds_read_b128 v[172:175],v17 offset:22528
v_min3_u32 v27,v27,v240,v244
v_mfma_f32_16x16x32_bf16 v[68:71],a[240:243],v[240:243],v[68:71]
s_xor_b32 m0,s72,33792
buffer_store_dword v22,v23,s[20:23],s97 offen sc1
v_mfma_f32_16x16x32_bf16 v[64:67],a[116:119],v[244:247],v[64:67]
ds_read_b128 v[176:179],v17 offset:24576
ds_read_b128 v[180:183],v17 offset:26624
s_mov_b32 s97,0x7fff0000
v_mfma_f32_16x16x32_bf16 v[68:71],a[244:247],v[244:247],v[68:71]
s_add_u32 s65,s89,65536
s_waitcnt lgkmcnt(7)
v_mfma_f32_16x16x32_bf16 v[64:67],a[120:123],v[248:251],v[64:67]
ds_read_b128 v[184:187],v17 offset:28672
v_min3_u32 v27,v27,v248,v252
v_mfma_f32_16x16x32_bf16 v[68:71],a[248:251],v[248:251],v[68:71]
buffer_load_dwordx4 v16,s[20:23],s65 offen offset:0 sc1 lds
v_mfma_f32_16x16x32_bf16 v[64:67],a[124:127],v[252:255],v[64:67]
ds_read_b128 v[188:191],v17 offset:30720
v_mfma_f32_16x16x32_bf16 v[68:71],a[252:255],v[252:255],v[68:71]
buffer_load_dwordx4 v16,s[20:23],s65 offen offset:2048 sc1 lds
v_mfma_f32_16x16x32_bf16 v[72:75],a[128:131],v[128:131],0
v_cmp_eq_u32 vcc,0,v27
s_cbranch_vccnz retry_287
v_mfma_f32_16x16x32_bf16 v[76:79],a[132:135],v[132:135],0
s_xor_b32 m0,s72,50176
v_min3_u32 v27,v27,v128,v132
v_mfma_f32_16x16x32_bf16 v[72:75],a[136:139],v[136:139],v[72:75]
ds_read_b128 v[192:195],v17 offset:32768
v_mfma_f32_16x16x32_bf16 v[76:79],a[140:143],v[140:143],v[76:79]
ds_read_b128 v[196:199],v17 offset:34816
s_add_u32 s65,s89,98304
s_waitcnt lgkmcnt(10)
v_mfma_f32_16x16x32_bf16 v[72:75],a[144:147],v[144:147],v[72:75]
ds_read_b128 v[200:203],v17 offset:36864
v_min3_u32 v27,v27,v136,v140
s_waitcnt vmcnt(11)
v_mfma_f32_16x16x32_bf16 v[76:79],a[148:151],v[148:151],v[76:79]
ds_read_b128 v[204:207],v17 offset:38912
buffer_load_dwordx4 v16,s[20:23],s65 offen offset:0 sc1 lds
v_mfma_f32_16x16x32_bf16 v[72:75],a[152:155],v[152:155],v[72:75]
ds_read_b128 v[208:211],v17 offset:40960
v_min3_u32 v27,v27,v144,v148
v_and_or_b32 v64,v64,-4,s48
v_mfma_f32_16x16x32_bf16 v[76:79],a[156:159],v[156:159],v[76:79]
buffer_load_dwordx4 v16,s[20:23],s65 offen offset:2048 sc1 lds
s_waitcnt lgkmcnt(9)
v_mfma_f32_16x16x32_bf16 v[72:75],a[160:163],v[160:163],v[72:75]
ds_read_b128 v[212:215],v17 offset:43008
v_min3_u32 v27,v27,v152,v156
s_add_u32 s64,s49,s34
v_mfma_f32_16x16x32_bf16 v[76:79],a[164:167],v[164:167],v[76:79]
ds_read_b128 v[216:219],v17 offset:45056
v_min3_u32 v27,v27,v160,v164
v_mfma_f32_16x16x32_bf16 v[72:75],a[168:171],v[168:171],v[72:75]
ds_read_b128 v[220:223],v17 offset:47104
buffer_store_dwordx4 v[64:67],v25,s[20:23],s64 offen offset:2048
v_mfma_f32_16x16x32_bf16 v[76:79],a[172:175],v[172:175],v[76:79]
ds_read_b128 v[224:227],v17 offset:49152
v_and_or_b32 v68,v68,-4,s48
s_waitcnt lgkmcnt(9)
v_mfma_f32_16x16x32_bf16 v[72:75],a[176:179],v[176:179],v[72:75]
ds_read_b128 v[228:231],v17 offset:51200
v_min3_u32 v27,v27,v168,v172
s_add_u32 s64,s49,s35
v_mfma_f32_16x16x32_bf16 v[76:79],a[180:183],v[180:183],v[76:79]
v_min3_u32 v27,v27,v176,v180
buffer_store_dwordx4 v[68:71],v25,s[20:23],s64 offen offset:3072
v_mfma_f32_16x16x32_bf16 v[72:75],a[184:187],v[184:187],v[72:75]
ds_read_b128 v[232:235],v17 offset:53248
s_mov_b32 s49,0x7fff0000
v_mfma_f32_16x16x32_bf16 v[76:79],a[188:191],v[188:191],v[76:79]
ds_read_b128 v[236:239],v17 offset:55296
s_waitcnt lgkmcnt(8)
v_mfma_f32_16x16x32_bf16 v[72:75],a[192:195],v[192:195],v[72:75]
ds_read_b128 v[240:243],v17 offset:57344
v_min3_u32 v27,v27,v184,v188
v_mfma_f32_16x16x32_bf16 v[76:79],a[196:199],v[196:199],v[76:79]
ds_read_b128 v[244:247],v17 offset:59392
v_min3_u32 v27,v27,v192,v196
v_mfma_f32_16x16x32_bf16 v[72:75],a[200:203],v[200:203],v[72:75]
ds_read_b128 v[248:251],v17 offset:61440
ds_bpermute_b32 v124,v41,v120
v_mfma_f32_16x16x32_bf16 v[76:79],a[204:207],v[204:207],v[76:79]
v_min3_u32 v27,v27,v200,v204
s_waitcnt lgkmcnt(8)
v_mfma_f32_16x16x32_bf16 v[72:75],a[208:211],v[208:211],v[72:75]
ds_read_b128 v[252:255],v17 offset:63488
ds_bpermute_b32 v125,v41,v121
v_mfma_f32_16x16x32_bf16 v[76:79],a[212:215],v[212:215],v[76:79]
v_min3_u32 v27,v27,v208,v212
v_mfma_f32_16x16x32_bf16 v[72:75],a[216:219],v[216:219],v[72:75]
v_mfma_f32_16x16x32_bf16 v[76:79],a[220:223],v[220:223],v[76:79]
v_min3_u32 v27,v27,v216,v220
s_waitcnt lgkmcnt(6)
v_mfma_f32_16x16x32_bf16 v[72:75],a[224:227],v[224:227],v[72:75]
s_waitcnt lgkmcnt(0)
v_mfma_f32_16x16x32_bf16 v[76:79],a[228:231],v[228:231],v[76:79]
v_min3_u32 v27,v27,v224,v228
v_mfma_f32_16x16x32_bf16 v[72:75],a[232:235],v[232:235],v[72:75]
v_lshlrev_b32 v104,16,v124
v_mfma_f32_16x16x32_bf16 v[76:79],a[236:239],v[236:239],v[76:79]
v_min3_u32 v27,v27,v232,v236
v_mfma_f32_16x16x32_bf16 v[72:75],a[240:243],v[240:243],v[72:75]
v_mfma_f32_16x16x32_bf16 v[76:79],a[244:247],v[244:247],v[76:79]
v_min3_u32 v27,v27,v240,v244
v_mfma_f32_16x16x32_bf16 v[72:75],a[248:251],v[248:251],v[72:75]
v_and_b32 v105,s80,v124
v_mfma_f32_16x16x32_bf16 v[76:79],a[252:255],v[252:255],v[76:79]
v_min3_u32 v27,v27,v248,v252
v_mfma_f32_16x16x32_bf16 v[80:83],a[0:3],v[128:131],0
v_cmp_eq_u32 vcc,0,v27
s_cbranch_vccnz retry_287
v_mfma_f32_16x16x32_bf16 v[84:87],a[4:7],v[132:135],0
v_lshlrev_b32 v106,16,v125
v_mfma_f32_16x16x32_bf16 v[80:83],a[8:11],v[136:139],v[80:83]
v_mfma_f32_16x16x32_bf16 v[84:87],a[12:15],v[140:143],v[84:87]
v_mfma_f32_16x16x32_bf16 v[80:83],a[16:19],v[144:147],v[80:83]
v_and_b32 v107,s80,v125
v_add_f32 v72,v72,v76
v_mfma_f32_16x16x32_bf16 v[84:87],a[20:23],v[148:151],v[84:87]
v_add_f32 v73,v73,v77
v_add_f32 v74,v74,v78
v_mfma_f32_16x16x32_bf16 v[80:83],a[24:27],v[152:155],v[80:83]
v_add_f32 v75,v75,v79
v_and_or_b32 v72,v72,-4,s48
v_mfma_f32_16x16x32_bf16 v[84:87],a[28:31],v[156:159],v[84:87]
s_add_u32 s64,s77,s33
v_mfma_f32_16x16x32_bf16 v[80:83],a[32:35],v[160:163],v[80:83]
buffer_store_dwordx4 v[72:75],v25,s[20:23],s64 offen offset:1024
v_mfma_f32_16x16x32_bf16 v[84:87],a[36:39],v[164:167],v[84:87]
v_mfma_f32_16x16x32_bf16 v[80:83],a[40:43],v[168:171],v[80:83]
v_mfma_f32_16x16x32_bf16 v[84:87],a[44:47],v[172:175],v[84:87]
v_mfma_f32_16x16x32_bf16 v[80:83],a[48:51],v[176:179],v[80:83]
v_mfma_f32_16x16x32_bf16 v[84:87],a[52:55],v[180:183],v[84:87]
v_mfma_f32_16x16x32_bf16 v[80:83],a[56:59],v[184:187],v[80:83]
v_mfma_f32_16x16x32_bf16 v[84:87],a[60:63],v[188:191],v[84:87]
v_mfma_f32_16x16x32_bf16 v[80:83],a[64:67],v[192:195],v[80:83]
buffer_load_dwordx4 v[96:99],v26,s[20:23],s77 offen offset:2048 sc1
v_mfma_f32_16x16x32_bf16 v[84:87],a[68:71],v[196:199],v[84:87]
buffer_load_dwordx4 v[100:103],v26,s[20:23],s77 offen offset:3072 sc1
v_mfma_f32_16x16x32_bf16 v[80:83],a[72:75],v[200:203],v[80:83]
v_mfma_f32_16x16x32_bf16 v[84:87],a[76:79],v[204:207],v[84:87]
v_mfma_f32_16x16x32_bf16 v[80:83],a[80:83],v[208:211],v[80:83]
v_mfma_f32_16x16x32_bf16 v[84:87],a[84:87],v[212:215],v[84:87]
v_mfma_f32_16x16x32_bf16 v[80:83],a[88:91],v[216:219],v[80:83]
v_mfma_f32_16x16x32_bf16 v[84:87],a[92:95],v[220:223],v[84:87]
v_mfma_f32_16x16x32_bf16 v[80:83],a[96:99],v[224:227],v[80:83]
v_mfma_f32_16x16x32_bf16 v[84:87],a[100:103],v[228:231],v[84:87]
v_mfma_f32_16x16x32_bf16 v[80:83],a[104:107],v[232:235],v[80:83]
buffer_load_dwordx4 v[92:95],v26,s[20:23],s77 offen offset:1024 sc1
v_mfma_f32_16x16x32_bf16 v[84:87],a[108:111],v[236:239],v[84:87]
v_mfma_f32_16x16x32_bf16 v[80:83],a[112:115],v[240:243],v[80:83]
v_mfma_f32_16x16x32_bf16 v[84:87],a[116:119],v[244:247],v[84:87]
v_mfma_f32_16x16x32_bf16 v[80:83],a[120:123],v[248:251],v[80:83]
v_mfma_f32_16x16x32_bf16 v[84:87],a[124:127],v[252:255],v[84:87]
epi_290:
buffer_load_dword v29,v21,s[20:23],s87 offen sc1
s_nop 6
v_pk_add_f32 v[88:89],v[80:81],v[84:85]
v_pk_add_f32 v[90:91],v[82:83],v[86:87]
s_waitcnt vmcnt(1)
s_branch ic_302
ip_300:
buffer_load_dwordx4 v[92:95],v26,s[20:23],s77 offen offset:1024 sc1
buffer_load_dwordx4 v[96:99],v26,s[20:23],s77 offen offset:2048 sc1
buffer_load_dwordx4 v[100:103],v26,s[20:23],s77 offen offset:3072 sc1
s_waitcnt vmcnt(0)
ic_302:
v_bitop3_b32 v22,v92,v96,v100 bitop3:0x80
v_and_b32 v22,s48,v22
v_cmp_eq_u32 vcc,0,v22
s_cbranch_vccz ik_301
s_sub_u32 s90,s90,1
s_cmp_gt_i32 s90,0
s_cbranch_scc1 ip_300
ik_301:
v_pk_add_f32 v[88:89],v[88:89],v[92:93]
v_pk_add_f32 v[96:97],v[96:97],v[100:101]
v_pk_add_f32 v[90:91],v[90:91],v[94:95]
v_pk_add_f32 v[98:99],v[98:99],v[102:103]
v_pk_add_f32 v[88:89],v[88:89],v[96:97]
v_pk_add_f32 v[90:91],v[90:91],v[98:99]
v_pk_fma_f32 v[88:89],v[88:89],v[52:53],v[104:105]
v_pk_fma_f32 v[90:91],v[90:91],v[54:55],v[106:107]
v_cvt_pk_bf16_f32 v88,v88,v89
v_cvt_pk_bf16_f32 v89,v90,v91
v_max_u32 v88,1,v88
ds_bpermute_b32 v88,v40,v88
ds_bpermute_b32 v89,v40,v89
v_xor_b32 v18,0x10000,v18
s_xor_b32 s49,s77,524288
s_cselect_b32 s64,0,3
s_xor_b32 s48,s48,s64
s_waitcnt lgkmcnt(0)
buffer_store_dwordx2 v[88:89],v19,s[20:23],s70 offen sc1
s_mov_b32 s77,s49
s_add_u32 s78,s78,65536
s_cmp_gt_u32 s71,51
s_cselect_b32 s65,s73,0x7fff0000
s_cselect_b32 s97,0x7fff0000,s73
v_mov_b32 v22,s71
buffer_store_dword v22,v23,s[20:23],s65 offen sc1
next_297:
v_xor_b32 v17,0x10000,v17
s_xor_b32 s72,s72,0x10000
s_add_u32 s70,s70,2097152
s_xor_b32 s70,s70,0x2000
s_add_u32 s71,s71,1
s_cmp_le_u32 s71,64
s_cbranch_scc1 seg_288
s_endpgm
retry_287:
s_sub_u32 s90,s90,64
s_cmp_lt_i32 s90,0
s_cbranch_scc1 giveup_197
s_mov_b32 s83,1
s_waitcnt vmcnt(0) lgkmcnt(0)
s_barrier
s_branch seg_288
kslow_286:
s_add_u32 s64,s79,0
s_lshl_b32 s70,s64,21
s_lshl_b32 s64,s64,13
s_and_b32 s64,s64,0x2000
s_xor_b32 s64,s64,s62
s_add_u32 s70,s70,s64
s_add_u32 s70,s70,29360128
s_mov_b32 s83,1
s_mov_b32 s87,s74
s_cmp_eq_u32 s50,0
s_cselect_b32 s74,s74,0x7fff0000
v_mov_b32 v47,132096
s_lshl_b32 s64,s50,3
s_add_u32 s64,s64,132096
v_mov_b32 v46,s64
v_mov_b32 v29,0
s_mov_b32 s97,0x7fff0000
s_mov_b32 s69,1
s_mov_b32 s68,0
s_mov_b32 s52,0x30003
s_mov_b32 s53,s52
seg_306:
s_add_u32 s94,s70,s75
s_xor_b32 s95,s94,1024
s_xor_b32 s91,s72,0x10000
s_waitcnt vmcnt(2)
v_cmp_gt_u32 vcc,s71,v29
s_cbranch_vccz nb_310
s_waitcnt vmcnt(0)
v_add_u32 v22,s71,-1
buffer_store_dword v22,v23,s[20:23],s97 offen sc1
s_mov_b32 s97,0x7fff0000
s_cmp_lg_u32 s50,0
s_cbranch_scc1 nb_310
buffer_load_dword v32,v21,s[20:23],s74 offen sc1
s_sleep 2
pl_312:
buffer_load_dword v33,v21,s[20:23],s74 offen sc1
s_waitcnt vmcnt(1)
v_cmp_gt_u32 vcc,s71,v32
v_mov_b32 v29,v32
s_cbranch_vccz pok_313
buffer_load_dword v32,v21,s[20:23],s74 offen sc1
s_waitcnt vmcnt(1)
v_cmp_gt_u32 vcc,s71,v33
v_mov_b32 v29,v33
s_cbranch_vccz pok_313
s_sub_u32 s90,s90,1
s_cmp_gt_i32 s90,0
s_cbranch_scc1 pl_312
pok_313:
nb_310:
s_barrier
s_xor_b32 m0,s91,0
s_add_u32 s65,s94,0
buffer_load_dwordx4 v16,s[20:23],s65 offen offset:0 sc1 lds
buffer_load_dwordx4 v16,s[20:23],s65 offen offset:2048 sc1 lds
s_xor_b32 m0,s91,16384
s_add_u32 s65,s94,32768
buffer_load_dwordx4 v16,s[20:23],s65 offen offset:0 sc1 lds
buffer_load_dwordx4 v16,s[20:23],s65 offen offset:2048 sc1 lds
s_xor_b32 m0,s91,32768
s_add_u32 s65,s94,65536
buffer_load_dwordx4 v16,s[20:23],s65 offen offset:0 sc1 lds
buffer_load_dwordx4 v16,s[20:23],s65 offen offset:2048 sc1 lds
s_xor_b32 m0,s91,49152
s_add_u32 s65,s94,98304
buffer_load_dwordx4 v16,s[20:23],s65 offen offset:0 sc1 lds
buffer_load_dwordx4 v16,s[20:23],s65 offen offset:2048 sc1 lds
s_waitcnt vmcnt(8)
v_add_u32 v22,s71,-1
buffer_store_dword v22,v23,s[20:23],s97 offen sc1
s_mov_b32 s97,0x7fff0000
s_waitcnt vmcnt(7)
s_barrier
ds_read_b128 v[224:227],v18 offset:0
ds_read_b128 v[228:231],v18 offset:2048
ds_read_b128 v[232:235],v18 offset:4096
ds_read_b128 v[236:239],v18 offset:6144
ds_read_b128 v[240:243],v18 offset:8192
ds_read_b128 v[244:247],v18 offset:10240
ds_read_b128 v[248:251],v18 offset:12288
s_waitcnt lgkmcnt(5)
v_mfma_f32_16x16x32_bf16 v[64:67],a[0:3],v[224:227],0
s_xor_b32 m0,s91,1024
v_min_u32 v27,v224,v228
v_mfma_f32_16x16x32_bf16 v[68:71],a[128:131],v[224:227],0
ds_read_b128 v[252:255],v18 offset:14336
v_mfma_f32_16x16x32_bf16 v[64:67],a[4:7],v[228:231],v[64:67]
s_add_u32 s65,s95,0
v_mfma_f32_16x16x32_bf16 v[68:71],a[132:135],v[228:231],v[68:71]
s_waitcnt vmcnt(5)
s_barrier
ds_read_b128 v[224:227],v18 offset:16384
s_waitcnt lgkmcnt(5)
v_mfma_f32_16x16x32_bf16 v[64:67],a[8:11],v[232:235],v[64:67]
buffer_load_dwordx4 v16,s[20:23],s65 offen offset:0 sc1 lds
v_mfma_f32_16x16x32_bf16 v[68:71],a[136:139],v[232:235],v[68:71]
ds_read_b128 v[228:231],v18 offset:18432
v_min3_u32 v27,v27,v232,v236
v_mfma_f32_16x16x32_bf16 v[64:67],a[12:15],v[236:239],v[64:67]
buffer_load_dwordx4 v16,s[20:23],s65 offen offset:2048 sc1 lds
v_mfma_f32_16x16x32_bf16 v[68:71],a[140:143],v[236:239],v[68:71]
ds_read_b128 v[232:235],v18 offset:20480
s_waitcnt lgkmcnt(5)
v_mfma_f32_16x16x32_bf16 v[64:67],a[16:19],v[240:243],v[64:67]
s_xor_b32 m0,s91,17408
v_min3_u32 v27,v27,v240,v244
v_mfma_f32_16x16x32_bf16 v[68:71],a[144:147],v[240:243],v[68:71]
ds_read_b128 v[236:239],v18 offset:22528
v_mfma_f32_16x16x32_bf16 v[64:67],a[20:23],v[244:247],v[64:67]
s_add_u32 s65,s95,32768
v_mfma_f32_16x16x32_bf16 v[68:71],a[148:151],v[244:247],v[68:71]
ds_read_b128 v[240:243],v18 offset:24576
s_waitcnt lgkmcnt(5)
v_mfma_f32_16x16x32_bf16 v[64:67],a[24:27],v[248:251],v[64:67]
buffer_load_dwordx4 v16,s[20:23],s65 offen offset:0 sc1 lds
v_mfma_f32_16x16x32_bf16 v[68:71],a[152:155],v[248:251],v[68:71]
ds_read_b128 v[244:247],v18 offset:26624
v_min3_u32 v27,v27,v248,v252
v_mfma_f32_16x16x32_bf16 v[64:67],a[28:31],v[252:255],v[64:67]
buffer_load_dwordx4 v16,s[20:23],s65 offen offset:2048 sc1 lds
v_mfma_f32_16x16x32_bf16 v[68:71],a[156:159],v[252:255],v[68:71]
ds_read_b128 v[248:251],v18 offset:28672
s_waitcnt lgkmcnt(5)
v_mfma_f32_16x16x32_bf16 v[64:67],a[32:35],v[224:227],v[64:67]
s_xor_b32 m0,s91,33792
v_min3_u32 v27,v27,v224,v228
v_mfma_f32_16x16x32_bf16 v[68:71],a[160:163],v[224:227],v[68:71]
ds_read_b128 v[252:255],v18 offset:30720
v_mfma_f32_16x16x32_bf16 v[64:67],a[36:39],v[228:231],v[64:67]
s_add_u32 s65,s95,65536
v_mfma_f32_16x16x32_bf16 v[68:71],a[164:167],v[228:231],v[68:71]
s_waitcnt vmcnt(5)
s_barrier
ds_read_b128 v[224:227],v18 offset:32768
s_waitcnt lgkmcnt(5)
v_mfma_f32_16x16x32_bf16 v[64:67],a[40:43],v[232:235],v[64:67]
buffer_load_dwordx4 v16,s[20:23],s65 offen offset:0 sc1 lds
v_mfma_f32_16x16x32_bf16 v[68:71],a[168:171],v[232:235],v[68:71]
ds_read_b128 v[228:231],v18 offset:34816
v_min3_u32 v27,v27,v232,v236
v_mfma_f32_16x16x32_bf16 v[64:67],a[44:47],v[236:239],v[64:67]
buffer_load_dwordx4 v16,s[20:23],s65 offen offset:2048 sc1 lds
v_mfma_f32_16x16x32_bf16 v[68:71],a[172:175],v[236:239],v[68:71]
ds_read_b128 v[232:235],v18 offset:36864
s_waitcnt lgkmcnt(5)
v_mfma_f32_16x16x32_bf16 v[64:67],a[48:51],v[240:243],v[64:67]
s_xor_b32 m0,s91,50176
v_min3_u32 v27,v27,v240,v244
v_mfma_f32_16x16x32_bf16 v[68:71],a[176:179],v[240:243],v[68:71]
ds_read_b128 v[236:239],v18 offset:38912
v_mfma_f32_16x16x32_bf16 v[64:67],a[52:55],v[244:247],v[64:67]
s_add_u32 s65,s95,98304
v_mfma_f32_16x16x32_bf16 v[68:71],a[180:183],v[244:247],v[68:71]
ds_read_b128 v[240:243],v18 offset:40960
s_waitcnt lgkmcnt(5)
v_mfma_f32_16x16x32_bf16 v[64:67],a[56:59],v[248:251],v[64:67]
buffer_load_dwordx4 v16,s[20:23],s65 offen offset:0 sc1 lds
v_mfma_f32_16x16x32_bf16 v[68:71],a[184:187],v[248:251],v[68:71]
ds_read_b128 v[244:247],v18 offset:43008
v_min3_u32 v27,v27,v248,v252
v_mfma_f32_16x16x32_bf16 v[64:67],a[60:63],v[252:255],v[64:67]
buffer_load_dwordx4 v16,s[20:23],s65 offen offset:2048 sc1 lds
v_mfma_f32_16x16x32_bf16 v[68:71],a[188:191],v[252:255],v[68:71]
ds_read_b128 v[248:251],v18 offset:45056
s_waitcnt lgkmcnt(5)
v_mfma_f32_16x16x32_bf16 v[64:67],a[64:67],v[224:227],v[64:67]
v_min3_u32 v27,v27,v224,v228
s_add_u32 s88,s70,s75
v_mfma_f32_16x16x32_bf16 v[68:71],a[192:195],v[224:227],v[68:71]
ds_read_b128 v[252:255],v18 offset:47104
s_add_u32 s88,s88,2097152
v_mfma_f32_16x16x32_bf16 v[64:67],a[68:71],v[228:231],v[64:67]
buffer_load_dwordx2 v[120:121],v20,s[36:39],s78 offen
v_mfma_f32_16x16x32_bf16 v[68:71],a[196:199],v[228:231],v[68:71]
ds_read_b128 v[224:227],v18 offset:49152
s_waitcnt lgkmcnt(5)
v_mfma_f32_16x16x32_bf16 v[64:67],a[72:75],v[232:235],v[64:67]
v_min3_u32 v27,v27,v232,v236
s_xor_b32 s88,s88,0x2000
v_mfma_f32_16x16x32_bf16 v[68:71],a[200:203],v[232:235],v[68:71]
ds_read_b128 v[228:231],v18 offset:51200
s_xor_b32 s89,s88,1024
v_mfma_f32_16x16x32_bf16 v[64:67],a[76:79],v[236:239],v[64:67]
v_mfma_f32_16x16x32_bf16 v[68:71],a[204:207],v[236:239],v[68:71]
ds_read_b128 v[232:235],v18 offset:53248
s_waitcnt lgkmcnt(5)
v_mfma_f32_16x16x32_bf16 v[64:67],a[80:83],v[240:243],v[64:67]
s_waitcnt vmcnt(5)
s_barrier
ds_read_b128 v[128:131],v17 offset:0
ds_read_b128 v[132:135],v17 offset:2048
v_mfma_f32_16x16x32_bf16 v[68:71],a[208:211],v[240:243],v[68:71]
ds_read_b128 v[236:239],v18 offset:55296
v_min3_u32 v27,v27,v240,v244
v_mfma_f32_16x16x32_bf16 v[64:67],a[84:87],v[244:247],v[64:67]
ds_read_b128 v[136:139],v17 offset:4096
v_mfma_f32_16x16x32_bf16 v[68:71],a[212:215],v[244:247],v[68:71]
ds_read_b128 v[240:243],v18 offset:57344
s_waitcnt lgkmcnt(8)
v_mfma_f32_16x16x32_bf16 v[64:67],a[88:91],v[248:251],v[64:67]
ds_read_b128 v[140:143],v17 offset:6144
v_min3_u32 v27,v27,v248,v252
v_mfma_f32_16x16x32_bf16 v[68:71],a[216:219],v[248:251],v[68:71]
ds_read_b128 v[244:247],v18 offset:59392
v_mfma_f32_16x16x32_bf16 v[64:67],a[92:95],v[252:255],v[64:67]
ds_read_b128 v[144:147],v17 offset:8192
ds_read_b128 v[148:151],v17 offset:10240
v_mfma_f32_16x16x32_bf16 v[68:71],a[220:223],v[252:255],v[68:71]
ds_read_b128 v[248:251],v18 offset:61440
s_waitcnt lgkmcnt(11)
v_mfma_f32_16x16x32_bf16 v[64:67],a[96:99],v[224:227],v[64:67]
ds_read_b128 v[152:155],v17 offset:12288
v_min3_u32 v27,v27,v224,v228
v_mfma_f32_16x16x32_bf16 v[68:71],a[224:227],v[224:227],v[68:71]
ds_read_b128 v[252:255],v18 offset:63488
v_mfma_f32_16x16x32_bf16 v[64:67],a[100:103],v[228:231],v[64:67]
ds_read_b128 v[156:159],v17 offset:14336
v_mfma_f32_16x16x32_bf16 v[68:71],a[228:231],v[228:231],v[68:71]
s_waitcnt lgkmcnt(10)
v_mfma_f32_16x16x32_bf16 v[64:67],a[104:107],v[232:235],v[64:67]
ds_read_b128 v[160:163],v17 offset:16384
ds_read_b128 v[164:167],v17 offset:18432
v_mfma_f32_16x16x32_bf16 v[68:71],a[232:235],v[232:235],v[68:71]
v_min3_u32 v27,v27,v232,v236
v_mfma_f32_16x16x32_bf16 v[64:67],a[108:111],v[236:239],v[64:67]
ds_read_b128 v[168:171],v17 offset:20480
v_mfma_f32_16x16x32_bf16 v[68:71],a[236:239],v[236:239],v[68:71]
s_waitcnt lgkmcnt(9)
v_mfma_f32_16x16x32_bf16 v[64:67],a[112:115],v[240:243],v[64:67]
ds_read_b128 v[172:175],v17 offset:22528
v_min3_u32 v27,v27,v240,v244
v_mfma_f32_16x16x32_bf16 v[68:71],a[240:243],v[240:243],v[68:71]
v_mfma_f32_16x16x32_bf16 v[64:67],a[116:119],v[244:247],v[64:67]
ds_read_b128 v[176:179],v17 offset:24576
ds_read_b128 v[180:183],v17 offset:26624
v_mfma_f32_16x16x32_bf16 v[68:71],a[244:247],v[244:247],v[68:71]
s_waitcnt lgkmcnt(7)
v_mfma_f32_16x16x32_bf16 v[64:67],a[120:123],v[248:251],v[64:67]
ds_read_b128 v[184:187],v17 offset:28672
v_min3_u32 v27,v27,v248,v252
v_mfma_f32_16x16x32_bf16 v[68:71],a[248:251],v[248:251],v[68:71]
v_mfma_f32_16x16x32_bf16 v[64:67],a[124:127],v[252:255],v[64:67]
ds_read_b128 v[188:191],v17 offset:30720
v_mfma_f32_16x16x32_bf16 v[68:71],a[252:255],v[252:255],v[68:71]
v_mfma_f32_16x16x32_bf16 v[72:75],a[128:131],v[128:131],0
v_cmp_eq_u32 vcc,0,v27
s_cbranch_vccnz retry_305
v_mfma_f32_16x16x32_bf16 v[76:79],a[132:135],v[132:135],0
v_min3_u32 v27,v27,v128,v132
v_mfma_f32_16x16x32_bf16 v[72:75],a[136:139],v[136:139],v[72:75]
s_waitcnt vmcnt(1)
s_barrier
ds_read_b128 v[192:195],v17 offset:32768
v_mfma_f32_16x16x32_bf16 v[76:79],a[140:143],v[140:143],v[76:79]
ds_read_b128 v[196:199],v17 offset:34816
s_waitcnt lgkmcnt(10)
v_mfma_f32_16x16x32_bf16 v[72:75],a[144:147],v[144:147],v[72:75]
ds_read_b128 v[200:203],v17 offset:36864
v_min3_u32 v27,v27,v136,v140
s_waitcnt vmcnt(0)
v_mfma_f32_16x16x32_bf16 v[76:79],a[148:151],v[148:151],v[76:79]
ds_read_b128 v[204:207],v17 offset:38912
v_min3_u32 v27,v27,v144,v148
v_and_or_b32 v64,v64,-4,s48
v_mfma_f32_16x16x32_bf16 v[72:75],a[152:155],v[152:155],v[72:75]
ds_read_b128 v[208:211],v17 offset:40960
s_add_u32 s64,s49,s34
v_mfma_f32_16x16x32_bf16 v[76:79],a[156:159],v[156:159],v[76:79]
v_min3_u32 v27,v27,v152,v156
s_waitcnt lgkmcnt(9)
v_mfma_f32_16x16x32_bf16 v[72:75],a[160:163],v[160:163],v[72:75]
ds_read_b128 v[212:215],v17 offset:43008
buffer_store_dwordx4 v[64:67],v25,s[20:23],s64 offen offset:2048 sc1
v_mfma_f32_16x16x32_bf16 v[76:79],a[164:167],v[164:167],v[76:79]
ds_read_b128 v[216:219],v17 offset:45056
v_min3_u32 v27,v27,v160,v164
v_and_or_b32 v68,v68,-4,s48
v_mfma_f32_16x16x32_bf16 v[72:75],a[168:171],v[168:171],v[72:75]
ds_read_b128 v[220:223],v17 offset:47104
s_add_u32 s64,s49,s35
v_mfma_f32_16x16x32_bf16 v[76:79],a[172:175],v[172:175],v[76:79]
ds_read_b128 v[224:227],v17 offset:49152
s_waitcnt lgkmcnt(9)
v_mfma_f32_16x16x32_bf16 v[72:75],a[176:179],v[176:179],v[72:75]
ds_read_b128 v[228:231],v17 offset:51200
v_min3_u32 v27,v27,v168,v172
v_mfma_f32_16x16x32_bf16 v[76:79],a[180:183],v[180:183],v[76:79]
v_min3_u32 v27,v27,v176,v180
buffer_store_dwordx4 v[68:71],v25,s[20:23],s64 offen offset:3072 sc1
v_mfma_f32_16x16x32_bf16 v[72:75],a[184:187],v[184:187],v[72:75]
ds_read_b128 v[232:235],v17 offset:53248
s_mov_b32 s49,0x7fff0000
v_mfma_f32_16x16x32_bf16 v[76:79],a[188:191],v[188:191],v[76:79]
ds_read_b128 v[236:239],v17 offset:55296
s_waitcnt lgkmcnt(8)
v_mfma_f32_16x16x32_bf16 v[72:75],a[192:195],v[192:195],v[72:75]
ds_read_b128 v[240:243],v17 offset:57344
v_min3_u32 v27,v27,v184,v188
v_mfma_f32_16x16x32_bf16 v[76:79],a[196:199],v[196:199],v[76:79]
ds_read_b128 v[244:247],v17 offset:59392
v_min3_u32 v27,v27,v192,v196
v_mfma_f32_16x16x32_bf16 v[72:75],a[200:203],v[200:203],v[72:75]
ds_read_b128 v[248:251],v17 offset:61440
ds_bpermute_b32 v124,v41,v120
v_mfma_f32_16x16x32_bf16 v[76:79],a[204:207],v[204:207],v[76:79]
v_min3_u32 v27,v27,v200,v204
s_waitcnt lgkmcnt(8)
v_mfma_f32_16x16x32_bf16 v[72:75],a[208:211],v[208:211],v[72:75]
ds_read_b128 v[252:255],v17 offset:63488
ds_bpermute_b32 v125,v41,v121
v_mfma_f32_16x16x32_bf16 v[76:79],a[212:215],v[212:215],v[76:79]
v_min3_u32 v27,v27,v208,v212
v_mfma_f32_16x16x32_bf16 v[72:75],a[216:219],v[216:219],v[72:75]
v_mfma_f32_16x16x32_bf16 v[76:79],a[220:223],v[220:223],v[76:79]
v_min3_u32 v27,v27,v216,v220
s_waitcnt lgkmcnt(6)
v_mfma_f32_16x16x32_bf16 v[72:75],a[224:227],v[224:227],v[72:75]
s_waitcnt lgkmcnt(0)
v_mfma_f32_16x16x32_bf16 v[76:79],a[228:231],v[228:231],v[76:79]
v_min3_u32 v27,v27,v224,v228
v_mfma_f32_16x16x32_bf16 v[72:75],a[232:235],v[232:235],v[72:75]
v_lshlrev_b32 v104,16,v124
v_mfma_f32_16x16x32_bf16 v[76:79],a[236:239],v[236:239],v[76:79]
v_min3_u32 v27,v27,v232,v236
v_mfma_f32_16x16x32_bf16 v[72:75],a[240:243],v[240:243],v[72:75]
v_mfma_f32_16x16x32_bf16 v[76:79],a[244:247],v[244:247],v[76:79]
v_min3_u32 v27,v27,v240,v244
v_mfma_f32_16x16x32_bf16 v[72:75],a[248:251],v[248:251],v[72:75]
v_and_b32 v105,s80,v124
v_mfma_f32_16x16x32_bf16 v[76:79],a[252:255],v[252:255],v[76:79]
v_min3_u32 v27,v27,v248,v252
v_mfma_f32_16x16x32_bf16 v[80:83],a[0:3],v[128:131],0
v_cmp_eq_u32 vcc,0,v27
s_cbranch_vccnz retry_305
v_mfma_f32_16x16x32_bf16 v[84:87],a[4:7],v[132:135],0
v_lshlrev_b32 v106,16,v125
v_mfma_f32_16x16x32_bf16 v[80:83],a[8:11],v[136:139],v[80:83]
v_mfma_f32_16x16x32_bf16 v[84:87],a[12:15],v[140:143],v[84:87]
v_mfma_f32_16x16x32_bf16 v[80:83],a[16:19],v[144:147],v[80:83]
v_and_b32 v107,s80,v125
v_add_f32 v72,v72,v76
v_mfma_f32_16x16x32_bf16 v[84:87],a[20:23],v[148:151],v[84:87]
v_add_f32 v73,v73,v77
v_add_f32 v74,v74,v78
v_mfma_f32_16x16x32_bf16 v[80:83],a[24:27],v[152:155],v[80:83]
v_add_f32 v75,v75,v79
v_and_or_b32 v72,v72,-4,s48
v_mfma_f32_16x16x32_bf16 v[84:87],a[28:31],v[156:159],v[84:87]
s_add_u32 s64,s77,s33
v_mfma_f32_16x16x32_bf16 v[80:83],a[32:35],v[160:163],v[80:83]
buffer_store_dwordx4 v[72:75],v25,s[20:23],s64 offen offset:1024 sc1
v_mfma_f32_16x16x32_bf16 v[84:87],a[36:39],v[164:167],v[84:87]
v_mfma_f32_16x16x32_bf16 v[80:83],a[40:43],v[168:171],v[80:83]
v_mfma_f32_16x16x32_bf16 v[84:87],a[44:47],v[172:175],v[84:87]
v_mfma_f32_16x16x32_bf16 v[80:83],a[48:51],v[176:179],v[80:83]
v_mfma_f32_16x16x32_bf16 v[84:87],a[52:55],v[180:183],v[84:87]
v_mfma_f32_16x16x32_bf16 v[80:83],a[56:59],v[184:187],v[80:83]
v_mfma_f32_16x16x32_bf16 v[84:87],a[60:63],v[188:191],v[84:87]
v_mfma_f32_16x16x32_bf16 v[80:83],a[64:67],v[192:195],v[80:83]
buffer_load_dwordx4 v[96:99],v26,s[20:23],s77 offen offset:2048 sc1
v_mfma_f32_16x16x32_bf16 v[84:87],a[68:71],v[196:199],v[84:87]
buffer_load_dwordx4 v[100:103],v26,s[20:23],s77 offen offset:3072 sc1
v_mfma_f32_16x16x32_bf16 v[80:83],a[72:75],v[200:203],v[80:83]
v_mfma_f32_16x16x32_bf16 v[84:87],a[76:79],v[204:207],v[84:87]
v_mfma_f32_16x16x32_bf16 v[80:83],a[80:83],v[208:211],v[80:83]
v_mfma_f32_16x16x32_bf16 v[84:87],a[84:87],v[212:215],v[84:87]
v_mfma_f32_16x16x32_bf16 v[80:83],a[88:91],v[216:219],v[80:83]
v_mfma_f32_16x16x32_bf16 v[84:87],a[92:95],v[220:223],v[84:87]
v_mfma_f32_16x16x32_bf16 v[80:83],a[96:99],v[224:227],v[80:83]
v_mfma_f32_16x16x32_bf16 v[84:87],a[100:103],v[228:231],v[84:87]
v_mfma_f32_16x16x32_bf16 v[80:83],a[104:107],v[232:235],v[80:83]
buffer_load_dwordx4 v[92:95],v26,s[20:23],s77 offen offset:1024 sc1
v_mfma_f32_16x16x32_bf16 v[84:87],a[108:111],v[236:239],v[84:87]
v_mfma_f32_16x16x32_bf16 v[80:83],a[112:115],v[240:243],v[80:83]
v_mfma_f32_16x16x32_bf16 v[84:87],a[116:119],v[244:247],v[84:87]
v_mfma_f32_16x16x32_bf16 v[80:83],a[120:123],v[248:251],v[80:83]
v_mfma_f32_16x16x32_bf16 v[84:87],a[124:127],v[252:255],v[84:87]
epi_308:
buffer_load_dword v29,v21,s[20:23],s87 offen sc1
s_nop 6
v_pk_add_f32 v[88:89],v[80:81],v[84:85]
v_pk_add_f32 v[90:91],v[82:83],v[86:87]
s_waitcnt vmcnt(1)
s_branch ic_318
ip_316:
buffer_load_dwordx4 v[92:95],v26,s[20:23],s77 offen offset:1024 sc1
buffer_load_dwordx4 v[96:99],v26,s[20:23],s77 offen offset:2048 sc1
buffer_load_dwordx4 v[100:103],v26,s[20:23],s77 offen offset:3072 sc1
s_waitcnt vmcnt(0)
ic_318:
v_bitop3_b32 v22,v92,v96,v100 bitop3:0x80
v_and_b32 v22,s48,v22
v_cmp_eq_u32 vcc,0,v22
s_cbranch_vccz ik_317
s_sub_u32 s90,s90,1
s_cmp_gt_i32 s90,0
s_cbranch_scc1 ip_316
ik_317:
v_pk_add_f32 v[88:89],v[88:89],v[92:93]
v_pk_add_f32 v[96:97],v[96:97],v[100:101]
v_pk_add_f32 v[90:91],v[90:91],v[94:95]
v_pk_add_f32 v[98:99],v[98:99],v[102:103]
v_pk_add_f32 v[88:89],v[88:89],v[96:97]
v_pk_add_f32 v[90:91],v[90:91],v[98:99]
v_pk_fma_f32 v[88:89],v[88:89],v[52:53],v[104:105]
v_pk_fma_f32 v[90:91],v[90:91],v[54:55],v[106:107]
v_cvt_pk_bf16_f32 v88,v88,v89
v_cvt_pk_bf16_f32 v89,v90,v91
v_max_u32 v88,1,v88
ds_bpermute_b32 v88,v40,v88
ds_bpermute_b32 v89,v40,v89
v_xor_b32 v18,0x10000,v18
s_xor_b32 s49,s77,524288
s_cselect_b32 s64,0,3
s_xor_b32 s48,s48,s64
s_waitcnt lgkmcnt(0)
buffer_store_dwordx2 v[88:89],v19,s[20:23],s70 offen sc1
s_mov_b32 s77,s49
s_add_u32 s78,s78,65536
s_cmp_gt_u32 s71,51
s_cselect_b32 s65,s73,0x7fff0000
s_cselect_b32 s97,0x7fff0000,s73
v_mov_b32 v22,s71
buffer_store_dword v22,v23,s[20:23],s65 offen sc1
next_315:
v_xor_b32 v17,0x10000,v17
s_xor_b32 s72,s72,0x10000
s_add_u32 s70,s70,2097152
s_xor_b32 s70,s70,0x2000
s_add_u32 s71,s71,1
s_cmp_le_u32 s71,64
s_cbranch_scc1 seg_306
s_endpgm
retry_305:
s_sub_u32 s90,s90,64
s_cmp_lt_i32 s90,0
s_cbranch_scc1 giveup_197
s_mov_b32 s83,1
s_waitcnt vmcnt(0) lgkmcnt(0)
s_barrier
s_branch seg_306
r_w4_216:
s_load_dwordx2 s[4:5],s[0:1],88
s_load_dwordx2 s[6:7],s[0:1],112
s_lshr_b32 s41,s59,3
s_and_b32 s42,s59,7
s_mul_i32 s66,s41,1835008
s_lshl_b32 s64,s42,8
s_add_u32 s66,s66,s64
s_lshl_b32 s67,s50,1
s_and_b32 s64,s41,1
s_add_u32 s67,s67,s64
s_waitcnt lgkmcnt(0)
s_mov_b32 s32,s4
s_and_b32 s33,s5,0xffff
s_mov_b32 s34,0x700000
s_mov_b32 s35,0x20000
s_sub_u32 s36,s6,0x1000
s_subb_u32 s37,s7,0
s_and_b32 s37,s37,0xffff
s_mov_b32 s38,0x401000
s_mov_b32 s39,0x20000
v_lshrrev_b32 v5,2,v3
v_lshl_add_u32 v5,v4,2,v5
v_and_b32 v6,3,v3
v_lshlrev_b32 v6,3,v6
v_lshl_add_u32 v6,v5,8,v6
v_and_b32 v5,7,v5
v_xor_b32 v5,s67,v5
v_lshl_add_u32 v12,v5,5,v6
v_xor_b32 v13,32,v12
v_and_b32 v5,15,v1
v_and_b32 v6,3,v4
v_lshlrev_b32 v6,1,v6
v_xor_b32 v5,v5,v6
v_mul_u32_u24 v6,2048,v4
v_xor_b32 v7,0,v5
v_lshl_add_u32 v8,v7,4,v6
v_xor_b32 v7,8,v5
v_lshl_add_u32 v9,v7,4,v6
s_mul_i32 s74,s50,131072
s_add_u32 s74,s74,s66
s_lshl_b32 s75,s50,14
s_mul_i32 s76,s50,65536
s_add_u32 s76,s76,s66
s_lshl_b32 s77,s50,13
s_add_u32 s64,s74,0
s_add_u32 m0,s75,0
s_nop 0
buffer_load_dwordx4 v8,s[32:35],s64 offen nt lds
s_add_u32 s64,s74,8192
s_add_u32 m0,s75,1024
s_nop 0
buffer_load_dwordx4 v9,s[32:35],s64 offen nt lds
s_add_u32 s64,s74,16384
s_add_u32 m0,s75,2048
s_nop 0
buffer_load_dwordx4 v8,s[32:35],s64 offen nt lds
s_add_u32 s64,s74,24576
s_add_u32 m0,s75,3072
s_nop 0
buffer_load_dwordx4 v9,s[32:35],s64 offen nt lds
s_add_u32 s64,s74,32768
s_add_u32 m0,s75,4096
s_nop 0
buffer_load_dwordx4 v8,s[32:35],s64 offen nt lds
s_add_u32 s64,s74,40960
s_add_u32 m0,s75,5120
s_nop 0
buffer_load_dwordx4 v9,s[32:35],s64 offen nt lds
s_add_u32 s64,s74,49152
s_add_u32 m0,s75,6144
s_nop 0
buffer_load_dwordx4 v8,s[32:35],s64 offen nt lds
s_add_u32 s64,s74,57344
s_add_u32 m0,s75,7168
s_nop 0
buffer_load_dwordx4 v9,s[32:35],s64 offen nt lds
s_add_u32 s64,s74,65536
s_add_u32 m0,s75,8192
s_nop 0
buffer_load_dwordx4 v8,s[32:35],s64 offen nt lds
s_add_u32 s64,s74,73728
s_add_u32 m0,s75,9216
s_nop 0
buffer_load_dwordx4 v9,s[32:35],s64 offen nt lds
s_add_u32 s64,s74,81920
s_add_u32 m0,s75,10240
s_nop 0
buffer_load_dwordx4 v8,s[32:35],s64 offen nt lds
s_add_u32 s64,s74,90112
s_add_u32 m0,s75,11264
s_nop 0
buffer_load_dwordx4 v9,s[32:35],s64 offen nt lds
s_add_u32 s64,s74,98304
s_add_u32 m0,s75,12288
s_nop 0
buffer_load_dwordx4 v8,s[32:35],s64 offen nt lds
s_add_u32 s64,s74,106496
s_add_u32 m0,s75,13312
s_nop 0
buffer_load_dwordx4 v9,s[32:35],s64 offen nt lds
s_add_u32 s64,s74,114688
s_add_u32 m0,s75,14336
s_nop 0
buffer_load_dwordx4 v8,s[32:35],s64 offen nt lds
s_add_u32 s64,s74,122880
s_add_u32 m0,s75,15360
s_nop 0
buffer_load_dwordx4 v9,s[32:35],s64 offen nt lds
s_add_u32 s64,s74,524288
s_add_u32 m0,s75,65536
s_nop 0
buffer_load_dwordx4 v8,s[32:35],s64 offen nt lds
s_add_u32 s64,s74,532480
s_add_u32 m0,s75,66560
s_nop 0
buffer_load_dwordx4 v9,s[32:35],s64 offen nt lds
s_add_u32 s64,s74,540672
s_add_u32 m0,s75,67584
s_nop 0
buffer_load_dwordx4 v8,s[32:35],s64 offen nt lds
s_add_u32 s64,s74,548864
s_add_u32 m0,s75,68608
s_nop 0
buffer_load_dwordx4 v9,s[32:35],s64 offen nt lds
s_add_u32 s64,s74,557056
s_add_u32 m0,s75,69632
s_nop 0
buffer_load_dwordx4 v8,s[32:35],s64 offen nt lds
s_add_u32 s64,s74,565248
s_add_u32 m0,s75,70656
s_nop 0
buffer_load_dwordx4 v9,s[32:35],s64 offen nt lds
s_add_u32 s64,s74,573440
s_add_u32 m0,s75,71680
s_nop 0
buffer_load_dwordx4 v8,s[32:35],s64 offen nt lds
s_add_u32 s64,s74,581632
s_add_u32 m0,s75,72704
s_nop 0
buffer_load_dwordx4 v9,s[32:35],s64 offen nt lds
s_add_u32 s64,s74,589824
s_add_u32 m0,s75,73728
s_nop 0
buffer_load_dwordx4 v8,s[32:35],s64 offen nt lds
s_add_u32 s64,s74,598016
s_add_u32 m0,s75,74752
s_nop 0
buffer_load_dwordx4 v9,s[32:35],s64 offen nt lds
s_add_u32 s64,s74,606208
s_add_u32 m0,s75,75776
s_nop 0
buffer_load_dwordx4 v8,s[32:35],s64 offen nt lds
s_add_u32 s64,s74,614400
s_add_u32 m0,s75,76800
s_nop 0
buffer_load_dwordx4 v9,s[32:35],s64 offen nt lds
s_add_u32 s64,s74,622592
s_add_u32 m0,s75,77824
s_nop 0
buffer_load_dwordx4 v8,s[32:35],s64 offen nt lds
s_add_u32 s64,s74,630784
s_add_u32 m0,s75,78848
s_nop 0
buffer_load_dwordx4 v9,s[32:35],s64 offen nt lds
s_add_u32 s64,s74,638976
s_add_u32 m0,s75,79872
s_nop 0
buffer_load_dwordx4 v8,s[32:35],s64 offen nt lds
s_add_u32 s64,s74,647168
s_add_u32 m0,s75,80896
s_nop 0
buffer_load_dwordx4 v9,s[32:35],s64 offen nt lds
s_waitcnt vmcnt(16)
s_barrier
ds_read_b64_tr_b16 a[0:1],v12 offset:0
ds_read_b64_tr_b16 a[112:113],v13 offset:0
ds_read_b64_tr_b16 a[2:3],v12 offset:4096
ds_read_b64_tr_b16 a[114:115],v13 offset:4096
ds_read_b64_tr_b16 a[4:5],v12 offset:8192
ds_read_b64_tr_b16 a[116:117],v13 offset:8192
ds_read_b64_tr_b16 a[6:7],v12 offset:12288
ds_read_b64_tr_b16 a[118:119],v13 offset:12288
s_waitcnt lgkmcnt(4)
ds_read_b64_tr_b16 a[8:9],v12 offset:16384
ds_read_b64_tr_b16 a[120:121],v13 offset:16384
ds_read_b64_tr_b16 a[10:11],v12 offset:20480
ds_read_b64_tr_b16 a[122:123],v13 offset:20480
ds_read_b64_tr_b16 a[12:13],v12 offset:28672
ds_read_b64_tr_b16 a[124:125],v13 offset:28672
ds_read_b64_tr_b16 a[14:15],v12 offset:32768
ds_read_b64_tr_b16 a[126:127],v13 offset:32768
s_waitcnt lgkmcnt(4)
ds_read_b64_tr_b16 a[16:17],v12 offset:36864
ds_read_b64_tr_b16 a[128:129],v13 offset:36864
ds_read_b64_tr_b16 a[18:19],v12 offset:40960
ds_read_b64_tr_b16 a[130:131],v13 offset:40960
ds_read_b64_tr_b16 a[20:21],v12 offset:45056
ds_read_b64_tr_b16 a[132:133],v13 offset:45056
ds_read_b64_tr_b16 a[22:23],v12 offset:49152
ds_read_b64_tr_b16 a[134:135],v13 offset:49152
s_waitcnt lgkmcnt(4)
ds_read_b64_tr_b16 a[24:25],v12 offset:57344
ds_read_b64_tr_b16 a[136:137],v13 offset:57344
ds_read_b64_tr_b16 a[26:27],v12 offset:61440
ds_read_b64_tr_b16 a[138:139],v13 offset:61440
ds_read_b64_tr_b16 a[96:97],v12 offset:24576
ds_read_b64_tr_b16 a[208:209],v13 offset:24576
ds_read_b64_tr_b16 a[98:99],v12 offset:53248
ds_read_b64_tr_b16 a[210:211],v13 offset:53248
s_waitcnt lgkmcnt(4)
v_xor_b32 v12,0x10000,v12
v_xor_b32 v13,0x10000,v13
s_waitcnt lgkmcnt(0)
s_barrier
s_add_u32 s64,s74,1048576
s_add_u32 m0,s75,0
s_nop 0
buffer_load_dwordx4 v8,s[32:35],s64 offen nt lds
s_add_u32 s64,s74,1056768
s_add_u32 m0,s75,1024
s_nop 0
buffer_load_dwordx4 v9,s[32:35],s64 offen nt lds
s_add_u32 s64,s74,1064960
s_add_u32 m0,s75,2048
s_nop 0
buffer_load_dwordx4 v8,s[32:35],s64 offen nt lds
s_add_u32 s64,s74,1073152
s_add_u32 m0,s75,3072
s_nop 0
buffer_load_dwordx4 v9,s[32:35],s64 offen nt lds
s_add_u32 s64,s74,1081344
s_add_u32 m0,s75,4096
s_nop 0
buffer_load_dwordx4 v8,s[32:35],s64 offen nt lds
s_add_u32 s64,s74,1089536
s_add_u32 m0,s75,5120
s_nop 0
buffer_load_dwordx4 v9,s[32:35],s64 offen nt lds
s_add_u32 s64,s74,1097728
s_add_u32 m0,s75,6144
s_nop 0
buffer_load_dwordx4 v8,s[32:35],s64 offen nt lds
s_add_u32 s64,s74,1105920
s_add_u32 m0,s75,7168
s_nop 0
buffer_load_dwordx4 v9,s[32:35],s64 offen nt lds
s_add_u32 s64,s74,1114112
s_add_u32 m0,s75,8192
s_nop 0
buffer_load_dwordx4 v8,s[32:35],s64 offen nt lds
s_add_u32 s64,s74,1122304
s_add_u32 m0,s75,9216
s_nop 0
buffer_load_dwordx4 v9,s[32:35],s64 offen nt lds
s_add_u32 s64,s74,1130496
s_add_u32 m0,s75,10240
s_nop 0
buffer_load_dwordx4 v8,s[32:35],s64 offen nt lds
s_add_u32 s64,s74,1138688
s_add_u32 m0,s75,11264
s_nop 0
buffer_load_dwordx4 v9,s[32:35],s64 offen nt lds
s_add_u32 s64,s74,1146880
s_add_u32 m0,s75,12288
s_nop 0
buffer_load_dwordx4 v8,s[32:35],s64 offen nt lds
s_add_u32 s64,s74,1155072
s_add_u32 m0,s75,13312
s_nop 0
buffer_load_dwordx4 v9,s[32:35],s64 offen nt lds
s_add_u32 s64,s74,1163264
s_add_u32 m0,s75,14336
s_nop 0
buffer_load_dwordx4 v8,s[32:35],s64 offen nt lds
s_add_u32 s64,s74,1171456
s_add_u32 m0,s75,15360
s_nop 0
buffer_load_dwordx4 v9,s[32:35],s64 offen nt lds
s_waitcnt vmcnt(16)
s_barrier
ds_read_b64_tr_b16 a[28:29],v12 offset:0
ds_read_b64_tr_b16 a[140:141],v13 offset:0
ds_read_b64_tr_b16 a[30:31],v12 offset:4096
ds_read_b64_tr_b16 a[142:143],v13 offset:4096
ds_read_b64_tr_b16 a[32:33],v12 offset:8192
ds_read_b64_tr_b16 a[144:145],v13 offset:8192
ds_read_b64_tr_b16 a[34:35],v12 offset:12288
ds_read_b64_tr_b16 a[146:147],v13 offset:12288
s_waitcnt lgkmcnt(4)
ds_read_b64_tr_b16 a[36:37],v12 offset:20480
ds_read_b64_tr_b16 a[148:149],v13 offset:20480
ds_read_b64_tr_b16 a[38:39],v12 offset:24576
ds_read_b64_tr_b16 a[150:151],v13 offset:24576
ds_read_b64_tr_b16 a[40:41],v12 offset:28672
ds_read_b64_tr_b16 a[152:153],v13 offset:28672
ds_read_b64_tr_b16 a[42:43],v12 offset:32768
ds_read_b64_tr_b16 a[154:155],v13 offset:32768
s_waitcnt lgkmcnt(4)
ds_read_b64_tr_b16 a[44:45],v12 offset:36864
ds_read_b64_tr_b16 a[156:157],v13 offset:36864
ds_read_b64_tr_b16 a[46:47],v12 offset:40960
ds_read_b64_tr_b16 a[158:159],v13 offset:40960
ds_read_b64_tr_b16 a[48:49],v12 offset:49152
ds_read_b64_tr_b16 a[160:161],v13 offset:49152
ds_read_b64_tr_b16 a[50:51],v12 offset:53248
ds_read_b64_tr_b16 a[162:163],v13 offset:53248
s_waitcnt lgkmcnt(4)
ds_read_b64_tr_b16 a[52:53],v12 offset:57344
ds_read_b64_tr_b16 a[164:165],v13 offset:57344
ds_read_b64_tr_b16 a[54:55],v12 offset:61440
ds_read_b64_tr_b16 a[166:167],v13 offset:61440
ds_read_b64_tr_b16 a[100:101],v12 offset:16384
ds_read_b64_tr_b16 a[212:213],v13 offset:16384
ds_read_b64_tr_b16 a[102:103],v12 offset:45056
ds_read_b64_tr_b16 a[214:215],v13 offset:45056
s_waitcnt lgkmcnt(4)
v_xor_b32 v12,0x10000,v12
v_xor_b32 v13,0x10000,v13
s_waitcnt lgkmcnt(0)
s_barrier
s_add_u32 s64,s76,1572864
s_add_u32 m0,s77,65536
s_nop 0
buffer_load_dwordx4 v8,s[32:35],s64 offen nt lds
s_add_u32 s64,s76,1581056
s_add_u32 m0,s77,66560
s_nop 0
buffer_load_dwordx4 v9,s[32:35],s64 offen nt lds
s_add_u32 s64,s76,1589248
s_add_u32 m0,s77,67584
s_nop 0
buffer_load_dwordx4 v8,s[32:35],s64 offen nt lds
s_add_u32 s64,s76,1597440
s_add_u32 m0,s77,68608
s_nop 0
buffer_load_dwordx4 v9,s[32:35],s64 offen nt lds
s_add_u32 s64,s76,1605632
s_add_u32 m0,s77,69632
s_nop 0
buffer_load_dwordx4 v8,s[32:35],s64 offen nt lds
s_add_u32 s64,s76,1613824
s_add_u32 m0,s77,70656
s_nop 0
buffer_load_dwordx4 v9,s[32:35],s64 offen nt lds
s_add_u32 s64,s76,1622016
s_add_u32 m0,s77,71680
s_nop 0
buffer_load_dwordx4 v8,s[32:35],s64 offen nt lds
s_add_u32 s64,s76,1630208
s_add_u32 m0,s77,72704
s_nop 0
buffer_load_dwordx4 v9,s[32:35],s64 offen nt lds
s_waitcnt vmcnt(8)
s_barrier
ds_read_b64_tr_b16 a[56:57],v12 offset:0
ds_read_b64_tr_b16 a[168:169],v13 offset:0
ds_read_b64_tr_b16 a[58:59],v12 offset:4096
ds_read_b64_tr_b16 a[170:171],v13 offset:4096
ds_read_b64_tr_b16 a[60:61],v12 offset:12288
ds_read_b64_tr_b16 a[172:173],v13 offset:12288
ds_read_b64_tr_b16 a[62:63],v12 offset:16384
ds_read_b64_tr_b16 a[174:175],v13 offset:16384
s_waitcnt lgkmcnt(4)
ds_read_b64_tr_b16 a[64:65],v12 offset:20480
ds_read_b64_tr_b16 a[176:177],v13 offset:20480
ds_read_b64_tr_b16 a[66:67],v12 offset:24576
ds_read_b64_tr_b16 a[178:179],v13 offset:24576
ds_read_b64_tr_b16 a[68:69],v12 offset:28672
ds_read_b64_tr_b16 a[180:181],v13 offset:28672
ds_read_b64_tr_b16 a[70:71],v12 offset:32768
ds_read_b64_tr_b16 a[182:183],v13 offset:32768
s_waitcnt lgkmcnt(4)
ds_read_b64_tr_b16 a[72:73],v12 offset:40960
ds_read_b64_tr_b16 a[184:185],v13 offset:40960
ds_read_b64_tr_b16 a[74:75],v12 offset:45056
ds_read_b64_tr_b16 a[186:187],v13 offset:45056
ds_read_b64_tr_b16 a[76:77],v12 offset:49152
ds_read_b64_tr_b16 a[188:189],v13 offset:49152
ds_read_b64_tr_b16 a[78:79],v12 offset:53248
ds_read_b64_tr_b16 a[190:191],v13 offset:53248
s_waitcnt lgkmcnt(4)
ds_read_b64_tr_b16 a[80:81],v12 offset:57344
ds_read_b64_tr_b16 a[192:193],v13 offset:57344
ds_read_b64_tr_b16 a[82:83],v12 offset:61440
ds_read_b64_tr_b16 a[194:195],v13 offset:61440
ds_read_b64_tr_b16 a[104:105],v12 offset:8192
ds_read_b64_tr_b16 a[216:217],v13 offset:8192
ds_read_b64_tr_b16 a[106:107],v12 offset:36864
ds_read_b64_tr_b16 a[218:219],v13 offset:36864
s_waitcnt lgkmcnt(4)
v_xor_b32 v12,0x10000,v12
v_xor_b32 v13,0x10000,v13
s_waitcnt lgkmcnt(0)
s_barrier
s_waitcnt vmcnt(0)
s_barrier
ds_read_b64_tr_b16 a[84:85],v12 offset:4096
ds_read_b64_tr_b16 a[196:197],v13 offset:4096
ds_read_b64_tr_b16 a[86:87],v12 offset:8192
ds_read_b64_tr_b16 a[198:199],v13 offset:8192
ds_read_b64_tr_b16 a[88:89],v12 offset:12288
ds_read_b64_tr_b16 a[200:201],v13 offset:12288
ds_read_b64_tr_b16 a[90:91],v12 offset:16384
ds_read_b64_tr_b16 a[202:203],v13 offset:16384
s_waitcnt lgkmcnt(4)
ds_read_b64_tr_b16 a[92:93],v12 offset:20480
ds_read_b64_tr_b16 a[204:205],v13 offset:20480
ds_read_b64_tr_b16 a[94:95],v12 offset:24576
ds_read_b64_tr_b16 a[206:207],v13 offset:24576
ds_read_b64_tr_b16 a[108:109],v12 offset:0
ds_read_b64_tr_b16 a[220:221],v13 offset:0
ds_read_b64_tr_b16 a[110:111],v12 offset:28672
ds_read_b64_tr_b16 a[222:223],v13 offset:28672
s_waitcnt lgkmcnt(4)
v_xor_b32 v12,0x10000,v12
v_xor_b32 v13,0x10000,v13
s_waitcnt lgkmcnt(0)
s_barrier
v_and_b32 v21,1,v1
v_mul_u32_u24 v21,960,v21
s_mov_b32 s65,21052032
s_mov_b32 s66,1792
pl_321:
buffer_load_dword v22,v21,s[20:23],s65 offen sc1
s_waitcnt vmcnt(0)
v_cmp_gt_u32 vcc,s66,v22
s_cbranch_vccz pok_322
s_sleep 1
s_sub_u32 s90,s90,1
s_cmp_gt_i32 s90,0
s_cbranch_scc1 pl_321
pok_322:
s_lshr_b32 s43,s41,1
s_and_b32 s48,s41,1
s_lshl_b32 s64,s42,7
s_lshl_b32 s65,s50,5
s_add_u32 s64,s64,s65
s_lshl_b32 s65,s48,4
s_add_u32 s64,s64,s65
v_lshl_add_u32 v5,v4,2,s64
v_lshlrev_b32 v6,2,v5
s_mov_b32 s64,20480
buffer_load_dwordx4 v[52:55],v6,s[20:23],s64 offen sc1
v_lshlrev_b32 v10,1,v5
v_and_b32 v6,3,v1
v_sub_u32 v5,v6,v4
v_lshl_add_u32 v5,v5,3,v10
v_lshrrev_b32 v11,2,v1
v_lshl_add_u32 v40,v6,4,v11
v_lshlrev_b32 v40,2,v40
v_lshl_add_u32 v41,v3,2,v4
v_lshlrev_b32 v41,2,v41
s_lshl_b32 s64,s43,10
v_add_u32 v17,s64,v16
v_xor_b32 v18,1024,v17
s_xor_b32 s64,s64,1024
s_lshr_b32 s65,s50,1
s_and_b32 s66,s50,1
s_lshl_b32 s66,s66,12
s_add_u32 s66,s66,s64
s_lshl_b32 s72,s65,13
s_add_u32 s72,s72,s66
s_add_u32 s72,s72,0x10000
s_lshl_b32 s65,s65,14
s_add_u32 s75,s65,s66
s_add_u32 s75,s75,1327104
s_mul_i32 s64,s41,114688
s_add_u32 s75,s75,s64
s_cmp_lt_u32 s50,2
s_cselect_b32 s86,98304,0x40000000
s_lshl_b32 s76,s79,21
s_add_u32 s76,s76,27262976
s_mov_b32 s77,0
s_lshl_b32 s78,s79,16
s_mov_b32 s49,0
s_cmp_eq_u32 s79,0
s_mov_b32 s66,8577024
s_cselect_b32 s66,18874368,s66
s_lshl_b32 s64,s59,14
s_lshl_b32 s65,s50,12
s_add_u32 s65,s65,s66
s_add_u32 s64,s64,s65
v_add_u32 v26,s64,v16
s_lshl_b32 s64,s42,14
s_add_u32 s64,s64,s65
v_add_u32 v25,s64,v16
s_xor_b32 s33,s41,1
s_xor_b32 s34,s41,2
s_xor_b32 s35,s41,3
s_lshl_b32 s33,s33,17
s_lshl_b32 s34,s34,17
s_lshl_b32 s35,s35,17
v_and_b32 v21,7,v1
v_lshlrev_b32 v21,7,v21
v_bfe_u32 v6,v1,3,2
v_lshl_add_u32 v21,v6,2,v21
s_lshl_b32 s74,s41,10
s_add_u32 s74,s74,s63
s_lshl_b32 s64,s60,4
s_add_u32 s74,s74,s64
s_add_u32 s74,s74,20480
s_lshl_b32 s64,s43,4
v_add_u32 v6,s64,v11
v_lshl_add_u32 v19,v6,11,v5
v_add_u32 v6,s64,v11
v_add_u32 v6,30,v6
v_lshl_add_u32 v9,v6,7,v5
v_and_b32 v9,2047,v9
v_and_b32 v7,3,v6
v_lshl_add_u32 v7,v7,11,v9
v_bfe_u32 v8,v6,2,3
v_lshl_add_u32 v7,v8,14,v7
v_mov_b32 v8,0x2000
v_mov_b32 v9,2097152
v_cmp_gt_u32 vcc,32,v6
s_nop 1
v_cndmask_b32 v8,v9,v8,vcc
v_add_u32 v7,v7,v8
v_add_u32 v7,1048576,v7
v_xor_b32 v20,s62,v7
s_lshl_b32 s64,s42,14
s_lshl_b32 s65,s50,11
s_add_u32 s64,s64,s65
s_lshl_b32 s65,s43,10
s_add_u32 s64,s64,s65
s_lshl_b32 s65,s48,3
s_add_u32 s64,s64,s65
s_add_u32 s64,s64,1179648
v_add_u32 v24,s64,v16
s_mov_b32 s84,0xffffff00
s_or_b32 s64,s43,s79
s_cselect_b32 s84,-1,s84
s_mov_b32 s85,-1
s_mov_b32 s48,1
s_waitcnt vmcnt(0)
s_cmp_lg_u32 s56,0
s_cbranch_scc1 kslow_323
s_add_u32 s64,s79,0
s_lshl_b32 s70,s64,21
s_lshl_b32 s64,s64,13
s_and_b32 s64,s64,0x2000
s_xor_b32 s64,s64,s62
s_add_u32 s70,s70,s64
s_add_u32 s70,s70,29360128
s_mov_b32 s83,1
s_mov_b32 s87,s74
s_cmp_eq_u32 s50,0
s_cselect_b32 s74,s74,0x7fff0000
v_mov_b32 v47,132096
s_lshl_b32 s64,s50,3
s_add_u32 s64,s64,132096
v_mov_b32 v46,s64
v_mov_b32 v29,0
s_mov_b32 s97,0x7fff0000
s_mov_b32 s69,1
s_mov_b32 s68,0
s_mov_b32 s52,0x30003
s_mov_b32 s53,s52
seg_325:
s_cmp_eq_u32 s83,0
s_cbranch_scc1 ahead_326
s_add_u32 s94,s70,s75
s_xor_b32 s95,s94,1024
s_xor_b32 s91,s72,0x10000
s_cmp_eq_u32 s69,0
s_mov_b32 s69,1
s_cbranch_scc1 half2_330
s_waitcnt vmcnt(1)
v_cmp_gt_u32 vcc,s71,v29
s_cbranch_vccz nb_329
s_cmp_lg_u32 s50,0
s_cbranch_scc1 nb_329
buffer_load_dword v32,v21,s[20:23],s74 offen sc1
s_sleep 2
pl_331:
buffer_load_dword v33,v21,s[20:23],s74 offen sc1
s_waitcnt vmcnt(1)
v_cmp_gt_u32 vcc,s71,v32
v_mov_b32 v29,v32
s_cbranch_vccz pok_332
buffer_load_dword v32,v21,s[20:23],s74 offen sc1
s_waitcnt vmcnt(1)
v_cmp_gt_u32 vcc,s71,v33
v_mov_b32 v29,v33
s_cbranch_vccz pok_332
s_sub_u32 s90,s90,1
s_cmp_gt_i32 s90,0
s_cbranch_scc1 pl_331
pok_332:
nb_329:
s_cmp_eq_u32 s71,64
s_barrier
s_cbranch_scc1 half_333
s_xor_b32 m0,s91,0
s_add_u32 s65,s94,0
buffer_load_dwordx4 v16,s[20:23],s65 offen offset:0 sc1 lds
buffer_load_dwordx4 v16,s[20:23],s65 offen offset:2048 sc1 lds
s_xor_b32 m0,s91,16384
s_add_u32 s65,s94,32768
buffer_load_dwordx4 v16,s[20:23],s65 offen offset:0 sc1 lds
buffer_load_dwordx4 v16,s[20:23],s65 offen offset:2048 sc1 lds
s_xor_b32 m0,s91,32768
s_add_u32 s65,s94,65536
buffer_load_dwordx4 v16,s[20:23],s65 offen offset:0 sc1 lds
buffer_load_dwordx4 v16,s[20:23],s65 offen offset:2048 sc1 lds
s_xor_b32 m0,s91,49152
s_add_u32 s65,s94,s86
buffer_load_dwordx4 v16,s[20:23],s65 offen offset:0 sc1 lds
buffer_load_dwordx4 v16,s[20:23],s65 offen offset:2048 sc1 lds
s_waitcnt vmcnt(6)
s_barrier
ds_read_b128 v[224:227],v18 offset:0
ds_read_b128 v[228:231],v18 offset:2048
ds_read_b128 v[232:235],v18 offset:4096
ds_read_b128 v[236:239],v18 offset:6144
ds_read_b128 v[240:243],v18 offset:8192
ds_read_b128 v[244:247],v18 offset:10240
ds_read_b128 v[248:251],v18 offset:12288
s_waitcnt lgkmcnt(5)
v_mfma_f32_16x16x32_bf16 v[64:67],a[0:3],v[224:227],0
s_xor_b32 m0,s91,1024
s_add_u32 s96,s71,1
s_add_u32 s92,s71,2
v_min_u32 v27,v224,v228
v_mfma_f32_16x16x32_bf16 v[68:71],a[112:115],v[224:227],0
ds_read_b128 v[252:255],v18 offset:14336
s_cmp_eq_u32 s96,64
s_cselect_b32 s96,99,s96
v_mfma_f32_16x16x32_bf16 v[64:67],a[4:7],v[228:231],v[64:67]
s_add_u32 s65,s95,0
s_cmp_eq_u32 s92,64
s_cselect_b32 s92,99,s92
v_mfma_f32_16x16x32_bf16 v[68:71],a[116:119],v[228:231],v[68:71]
s_waitcnt vmcnt(4)
s_barrier
ds_read_b128 v[224:227],v18 offset:16384
s_waitcnt lgkmcnt(5)
v_mfma_f32_16x16x32_bf16 v[64:67],a[8:11],v[232:235],v[64:67]
buffer_load_dwordx4 v16,s[20:23],s65 offen offset:0 sc1 lds
v_mfma_f32_16x16x32_bf16 v[68:71],a[120:123],v[232:235],v[68:71]
ds_read_b128 v[228:231],v18 offset:18432
v_min3_u32 v27,v27,v232,v236
v_mfma_f32_16x16x32_bf16 v[64:67],a[12:15],v[236:239],v[64:67]
buffer_load_dwordx4 v16,s[20:23],s65 offen offset:2048 sc1 lds
v_mfma_f32_16x16x32_bf16 v[68:71],a[124:127],v[236:239],v[68:71]
ds_read_b128 v[232:235],v18 offset:20480
s_waitcnt lgkmcnt(5)
v_mfma_f32_16x16x32_bf16 v[64:67],a[16:19],v[240:243],v[64:67]
s_xor_b32 m0,s91,17408
v_min3_u32 v27,v27,v240,v244
v_mfma_f32_16x16x32_bf16 v[68:71],a[128:131],v[240:243],v[68:71]
ds_read_b128 v[236:239],v18 offset:22528
v_mfma_f32_16x16x32_bf16 v[64:67],a[20:23],v[244:247],v[64:67]
s_add_u32 s65,s95,32768
s_waitcnt vmcnt(63)
v_mfma_f32_16x16x32_bf16 v[68:71],a[132:135],v[244:247],v[68:71]
ds_read_b128 v[240:243],v18 offset:24576
s_waitcnt lgkmcnt(5)
v_mfma_f32_16x16x32_bf16 v[64:67],a[24:27],v[248:251],v[64:67]
buffer_load_dwordx4 v16,s[20:23],s65 offen offset:0 sc1 lds
v_min3_u32 v27,v27,v248,v252
v_mfma_f32_16x16x32_bf16 v[68:71],a[136:139],v[248:251],v[68:71]
ds_read_b128 v[244:247],v18 offset:26624
v_cmp_gt_u32 vcc,s96,v29
v_cmp_gt_u32 s[92:93],s92,v29
v_mfma_f32_16x16x32_bf16 v[64:67],a[28:31],v[252:255],v[64:67]
buffer_load_dwordx4 v16,s[20:23],s65 offen offset:2048 sc1 lds
v_mfma_f32_16x16x32_bf16 v[68:71],a[140:143],v[252:255],v[68:71]
ds_read_b128 v[248:251],v18 offset:28672
s_waitcnt lgkmcnt(5)
v_mfma_f32_16x16x32_bf16 v[64:67],a[32:35],v[224:227],v[64:67]
s_xor_b32 m0,s91,33792
v_mov_b32 v44,vcc_lo
v_mov_b32 v45,s92
v_mfma_f32_16x16x32_bf16 v[68:71],a[144:147],v[224:227],v[68:71]
ds_read_b128 v[252:255],v18 offset:30720
ds_write_b64 v46,v[44:45]
v_mfma_f32_16x16x32_bf16 v[64:67],a[36:39],v[228:231],v[64:67]
s_add_u32 s65,s95,65536
v_min3_u32 v27,v27,v224,v228
v_mfma_f32_16x16x32_bf16 v[68:71],a[148:151],v[228:231],v[68:71]
s_waitcnt vmcnt(4)
s_barrier
ds_read_b128 v[224:227],v18 offset:32768
s_waitcnt lgkmcnt(6)
v_mfma_f32_16x16x32_bf16 v[64:67],a[40:43],v[232:235],v[64:67]
buffer_load_dwordx4 v16,s[20:23],s65 offen offset:0 sc1 lds
s_add_u32 s88,s70,s75
v_mfma_f32_16x16x32_bf16 v[68:71],a[152:155],v[232:235],v[68:71]
ds_read_b128 v[228:231],v18 offset:34816
v_min3_u32 v27,v27,v232,v236
s_add_u32 s88,s88,2097152
v_mfma_f32_16x16x32_bf16 v[64:67],a[44:47],v[236:239],v[64:67]
buffer_load_dwordx4 v16,s[20:23],s65 offen offset:2048 sc1 lds
v_mfma_f32_16x16x32_bf16 v[68:71],a[156:159],v[236:239],v[68:71]
ds_read_b128 v[232:235],v18 offset:36864
s_waitcnt lgkmcnt(6)
v_mfma_f32_16x16x32_bf16 v[64:67],a[48:51],v[240:243],v[64:67]
s_xor_b32 m0,s91,50176
v_min3_u32 v27,v27,v240,v244
v_mfma_f32_16x16x32_bf16 v[68:71],a[160:163],v[240:243],v[68:71]
ds_read_b128 v[236:239],v18 offset:38912
s_xor_b32 s88,s88,0x2000
v_mfma_f32_16x16x32_bf16 v[64:67],a[52:55],v[244:247],v[64:67]
s_add_u32 s65,s95,s86
s_xor_b32 s89,s88,1024
v_mfma_f32_16x16x32_bf16 v[68:71],a[164:167],v[244:247],v[68:71]
ds_read_b128 v[240:243],v18 offset:40960
s_waitcnt lgkmcnt(6)
v_mfma_f32_16x16x32_bf16 v[64:67],a[56:59],v[248:251],v[64:67]
buffer_load_dwordx4 v16,s[20:23],s65 offen offset:0 sc1 lds
v_mfma_f32_16x16x32_bf16 v[68:71],a[168:171],v[248:251],v[68:71]
ds_read_b128 v[244:247],v18 offset:43008
v_min3_u32 v27,v27,v248,v252
v_mfma_f32_16x16x32_bf16 v[64:67],a[60:63],v[252:255],v[64:67]
buffer_load_dwordx4 v16,s[20:23],s65 offen offset:2048 sc1 lds
v_mfma_f32_16x16x32_bf16 v[68:71],a[172:175],v[252:255],v[68:71]
ds_read_b128 v[248:251],v18 offset:45056
s_waitcnt lgkmcnt(5)
v_mfma_f32_16x16x32_bf16 v[64:67],a[64:67],v[224:227],v[64:67]
s_waitcnt vmcnt(4)
s_barrier
ds_read_b64 v[44:45],v47
ds_read_b128 v[128:131],v17 offset:0
ds_read_b128 v[132:135],v17 offset:2048
v_mfma_f32_16x16x32_bf16 v[68:71],a[176:179],v[224:227],v[68:71]
ds_read_b128 v[252:255],v18 offset:47104
v_min3_u32 v27,v27,v224,v228
v_mfma_f32_16x16x32_bf16 v[64:67],a[68:71],v[228:231],v[64:67]
ds_read_b128 v[136:139],v17 offset:4096
buffer_load_dwordx2 v[120:121],v20,s[20:23],s76 offen sc1
v_mfma_f32_16x16x32_bf16 v[68:71],a[180:183],v[228:231],v[68:71]
ds_read_b128 v[224:227],v18 offset:49152
s_waitcnt lgkmcnt(9)
v_mfma_f32_16x16x32_bf16 v[64:67],a[72:75],v[232:235],v[64:67]
ds_read_b128 v[140:143],v17 offset:6144
v_min3_u32 v27,v27,v232,v236
v_mfma_f32_16x16x32_bf16 v[68:71],a[184:187],v[232:235],v[68:71]
ds_read_b128 v[228:231],v18 offset:51200
buffer_load_dwordx2 v[122:123],v24,s[20:23],s70 offen sc1
v_mfma_f32_16x16x32_bf16 v[64:67],a[76:79],v[236:239],v[64:67]
ds_read_b128 v[144:147],v17 offset:8192
ds_read_b128 v[148:151],v17 offset:10240
v_mfma_f32_16x16x32_bf16 v[68:71],a[188:191],v[236:239],v[68:71]
ds_read_b128 v[232:235],v18 offset:53248
s_waitcnt lgkmcnt(12)
v_mfma_f32_16x16x32_bf16 v[64:67],a[80:83],v[240:243],v[64:67]
ds_read_b128 v[152:155],v17 offset:12288
s_waitcnt lgkmcnt(11)
v_min3_u32 v27,v27,v240,v244
v_mfma_f32_16x16x32_bf16 v[68:71],a[192:195],v[240:243],v[68:71]
ds_read_b128 v[236:239],v18 offset:55296
v_readfirstlane_b32 s93,v45
v_mfma_f32_16x16x32_bf16 v[64:67],a[84:87],v[244:247],v[64:67]
ds_read_b128 v[156:159],v17 offset:14336
v_readfirstlane_b32 s83,v44
s_cmp_lg_u32 s83,0
s_cbranch_scc0 keep_335
v_mfma_f32_16x16x32_bf16 v[68:71],a[196:199],v[244:247],v[68:71]
s_waitcnt lgkmcnt(10)
v_mfma_f32_16x16x32_bf16 v[64:67],a[88:91],v[248:251],v[64:67]
ds_read_b128 v[160:163],v17 offset:16384
ds_read_b128 v[164:167],v17 offset:18432
v_mfma_f32_16x16x32_bf16 v[68:71],a[200:203],v[248:251],v[68:71]
v_min3_u32 v27,v27,v248,v252
v_mfma_f32_16x16x32_bf16 v[64:67],a[92:95],v[252:255],v[64:67]
ds_read_b128 v[168:171],v17 offset:20480
v_mfma_f32_16x16x32_bf16 v[68:71],a[204:207],v[252:255],v[68:71]
s_waitcnt lgkmcnt(9)
v_mfma_f32_16x16x32_bf16 v[64:67],a[96:99],v[224:227],v[64:67]
ds_read_b128 v[172:175],v17 offset:22528
v_min3_u32 v27,v27,v224,v228
v_mfma_f32_16x16x32_bf16 v[68:71],a[208:211],v[224:227],v[68:71]
v_min3_u32 v27,v27,v226,v230
v_mfma_f32_16x16x32_bf16 v[64:67],a[100:103],v[228:231],v[64:67]
ds_read_b128 v[176:179],v17 offset:24576
ds_read_b128 v[180:183],v17 offset:26624
v_mfma_f32_16x16x32_bf16 v[68:71],a[212:215],v[228:231],v[68:71]
s_waitcnt lgkmcnt(7)
v_mfma_f32_16x16x32_bf16 v[64:67],a[104:107],v[232:235],v[64:67]
ds_read_b128 v[184:187],v17 offset:28672
v_min3_u32 v27,v27,v232,v236
v_mfma_f32_16x16x32_bf16 v[68:71],a[216:219],v[232:235],v[68:71]
v_min3_u32 v27,v27,v234,v238
v_mfma_f32_16x16x32_bf16 v[64:67],a[108:111],v[236:239],v[64:67]
ds_read_b128 v[188:191],v17 offset:30720
v_mfma_f32_16x16x32_bf16 v[68:71],a[220:223],v[236:239],v[68:71]
v_mfma_f32_16x16x32_bf16 v[72:75],a[112:115],v[128:131],0
v_cmp_eq_u32 vcc,0,v27
s_cbranch_vccnz retry_324
v_mfma_f32_16x16x32_bf16 v[76:79],a[116:119],v[132:135],0
v_min3_u32 v27,v27,v128,v132
v_mfma_f32_16x16x32_bf16 v[72:75],a[120:123],v[136:139],v[72:75]
s_waitcnt vmcnt(2)
s_barrier
ds_read_b128 v[192:195],v17 offset:32768
v_mfma_f32_16x16x32_bf16 v[76:79],a[124:127],v[140:143],v[76:79]
ds_read_b128 v[196:199],v17 offset:34816
s_waitcnt lgkmcnt(10)
v_mfma_f32_16x16x32_bf16 v[72:75],a[128:131],v[144:147],v[72:75]
ds_read_b128 v[200:203],v17 offset:36864
v_min3_u32 v27,v27,v136,v140
s_waitcnt vmcnt(0)
v_mfma_f32_16x16x32_bf16 v[76:79],a[132:135],v[148:151],v[76:79]
ds_read_b128 v[204:207],v17 offset:38912
v_min3_u32 v27,v27,v144,v148
v_and_or_b32 v64,v64,-4,s48
v_mfma_f32_16x16x32_bf16 v[72:75],a[136:139],v[152:155],v[72:75]
ds_read_b128 v[208:211],v17 offset:40960
s_add_u32 s64,s49,s34
v_mfma_f32_16x16x32_bf16 v[76:79],a[140:143],v[156:159],v[76:79]
v_min3_u32 v27,v27,v152,v156
s_waitcnt lgkmcnt(9)
v_mfma_f32_16x16x32_bf16 v[72:75],a[144:147],v[160:163],v[72:75]
ds_read_b128 v[212:215],v17 offset:43008
buffer_store_dwordx4 v[64:67],v25,s[20:23],s64 offen offset:2048
v_mfma_f32_16x16x32_bf16 v[76:79],a[148:151],v[164:167],v[76:79]
ds_read_b128 v[216:219],v17 offset:45056
v_min3_u32 v27,v27,v160,v164
v_and_or_b32 v68,v68,-4,s48
v_mfma_f32_16x16x32_bf16 v[72:75],a[152:155],v[168:171],v[72:75]
ds_read_b128 v[220:223],v17 offset:47104
s_add_u32 s64,s49,s35
v_mfma_f32_16x16x32_bf16 v[76:79],a[156:159],v[172:175],v[76:79]
ds_read_b128 v[224:227],v17 offset:49152
s_waitcnt lgkmcnt(9)
v_mfma_f32_16x16x32_bf16 v[72:75],a[160:163],v[176:179],v[72:75]
ds_read_b128 v[228:231],v17 offset:51200
v_min3_u32 v27,v27,v168,v172
v_mfma_f32_16x16x32_bf16 v[76:79],a[164:167],v[180:183],v[76:79]
v_min3_u32 v27,v27,v176,v180
buffer_store_dwordx4 v[68:71],v25,s[20:23],s64 offen offset:3072
v_mfma_f32_16x16x32_bf16 v[72:75],a[168:171],v[184:187],v[72:75]
ds_read_b128 v[232:235],v17 offset:53248
s_mov_b32 s49,0x7fff0000
v_mfma_f32_16x16x32_bf16 v[76:79],a[172:175],v[188:191],v[76:79]
ds_read_b128 v[236:239],v17 offset:55296
s_waitcnt lgkmcnt(8)
v_mfma_f32_16x16x32_bf16 v[72:75],a[176:179],v[192:195],v[72:75]
v_min3_u32 v27,v27,v184,v188
v_mfma_f32_16x16x32_bf16 v[76:79],a[180:183],v[196:199],v[76:79]
v_min3_u32 v27,v27,v192,v196
ds_bpermute_b32 v124,v41,v120
v_mfma_f32_16x16x32_bf16 v[72:75],a[184:187],v[200:203],v[72:75]
v_mfma_f32_16x16x32_bf16 v[76:79],a[188:191],v[204:207],v[76:79]
v_min3_u32 v27,v27,v200,v204
s_waitcnt lgkmcnt(5)
v_mfma_f32_16x16x32_bf16 v[72:75],a[192:195],v[208:211],v[72:75]
ds_bpermute_b32 v125,v41,v121
v_mfma_f32_16x16x32_bf16 v[76:79],a[196:199],v[212:215],v[76:79]
v_min3_u32 v27,v27,v208,v212
v_lshlrev_b32 v108,16,v122
v_mfma_f32_16x16x32_bf16 v[72:75],a[200:203],v[216:219],v[72:75]
v_mfma_f32_16x16x32_bf16 v[76:79],a[204:207],v[220:223],v[76:79]
v_min3_u32 v27,v27,v216,v220
s_waitcnt lgkmcnt(2)
v_mfma_f32_16x16x32_bf16 v[72:75],a[208:211],v[224:227],v[72:75]
v_and_b32 v109,s80,v122
v_mfma_f32_16x16x32_bf16 v[76:79],a[212:215],v[228:231],v[76:79]
v_min3_u32 v27,v27,v224,v228
v_min3_u32 v27,v27,v226,v230
v_mfma_f32_16x16x32_bf16 v[72:75],a[216:219],v[232:235],v[72:75]
v_lshlrev_b32 v110,16,v123
v_mfma_f32_16x16x32_bf16 v[76:79],a[220:223],v[236:239],v[76:79]
v_min3_u32 v27,v27,v232,v236
v_min3_u32 v27,v27,v234,v238
v_mfma_f32_16x16x32_bf16 v[80:83],a[0:3],v[128:131],0
v_cmp_eq_u32 vcc,0,v27
s_cbranch_vccnz retry_324
v_mfma_f32_16x16x32_bf16 v[84:87],a[4:7],v[132:135],0
v_and_b32 v111,s80,v123
s_waitcnt lgkmcnt(0)
v_mfma_f32_16x16x32_bf16 v[80:83],a[8:11],v[136:139],v[80:83]
v_mfma_f32_16x16x32_bf16 v[84:87],a[12:15],v[140:143],v[84:87]
v_lshlrev_b32 v104,16,v124
v_mfma_f32_16x16x32_bf16 v[80:83],a[16:19],v[144:147],v[80:83]
v_add_f32 v72,v72,v76
v_add_f32 v73,v73,v77
v_mfma_f32_16x16x32_bf16 v[84:87],a[20:23],v[148:151],v[84:87]
v_and_b32 v105,s80,v124
v_add_f32 v74,v74,v78
v_mfma_f32_16x16x32_bf16 v[80:83],a[24:27],v[152:155],v[80:83]
v_add_f32 v75,v75,v79
v_and_or_b32 v72,v72,-4,s48
v_mfma_f32_16x16x32_bf16 v[84:87],a[28:31],v[156:159],v[84:87]
v_lshlrev_b32 v106,16,v125
s_add_u32 s64,s77,s33
v_mfma_f32_16x16x32_bf16 v[80:83],a[32:35],v[160:163],v[80:83]
buffer_store_dwordx4 v[72:75],v25,s[20:23],s64 offen offset:1024
v_mfma_f32_16x16x32_bf16 v[84:87],a[36:39],v[164:167],v[84:87]
v_and_b32 v107,s80,v125
v_mfma_f32_16x16x32_bf16 v[80:83],a[40:43],v[168:171],v[80:83]
v_mfma_f32_16x16x32_bf16 v[84:87],a[44:47],v[172:175],v[84:87]
v_mfma_f32_16x16x32_bf16 v[80:83],a[48:51],v[176:179],v[80:83]
buffer_load_dwordx4 v[96:99],v26,s[20:23],s77 offen offset:2048 sc1
v_mfma_f32_16x16x32_bf16 v[84:87],a[52:55],v[180:183],v[84:87]
buffer_load_dwordx4 v[100:103],v26,s[20:23],s77 offen offset:3072 sc1
v_mfma_f32_16x16x32_bf16 v[80:83],a[56:59],v[184:187],v[80:83]
v_mfma_f32_16x16x32_bf16 v[84:87],a[60:63],v[188:191],v[84:87]
v_mfma_f32_16x16x32_bf16 v[80:83],a[64:67],v[192:195],v[80:83]
v_mfma_f32_16x16x32_bf16 v[84:87],a[68:71],v[196:199],v[84:87]
v_mfma_f32_16x16x32_bf16 v[80:83],a[72:75],v[200:203],v[80:83]
v_mfma_f32_16x16x32_bf16 v[84:87],a[76:79],v[204:207],v[84:87]
v_mfma_f32_16x16x32_bf16 v[80:83],a[80:83],v[208:211],v[80:83]
v_mfma_f32_16x16x32_bf16 v[84:87],a[84:87],v[212:215],v[84:87]
v_mfma_f32_16x16x32_bf16 v[80:83],a[88:91],v[216:219],v[80:83]
buffer_load_dwordx4 v[92:95],v26,s[20:23],s77 offen offset:1024 sc1
v_mfma_f32_16x16x32_bf16 v[84:87],a[92:95],v[220:223],v[84:87]
v_mfma_f32_16x16x32_bf16 v[80:83],a[96:99],v[224:227],v[80:83]
v_mfma_f32_16x16x32_bf16 v[84:87],a[100:103],v[228:231],v[84:87]
v_mfma_f32_16x16x32_bf16 v[80:83],a[104:107],v[232:235],v[80:83]
v_mfma_f32_16x16x32_bf16 v[84:87],a[108:111],v[236:239],v[84:87]
s_branch epi_327
keep_335:
v_mfma_f32_16x16x32_bf16 v[68:71],a[196:199],v[244:247],v[68:71]
s_xor_b32 m0,s72,0
s_waitcnt lgkmcnt(10)
v_mfma_f32_16x16x32_bf16 v[64:67],a[88:91],v[248:251],v[64:67]
ds_read_b128 v[160:163],v17 offset:16384
ds_read_b128 v[164:167],v17 offset:18432
s_add_u32 s65,s88,0
v_mfma_f32_16x16x32_bf16 v[68:71],a[200:203],v[248:251],v[68:71]
buffer_load_dwordx4 v16,s[20:23],s65 offen offset:0 sc1 lds
v_mfma_f32_16x16x32_bf16 v[64:67],a[92:95],v[252:255],v[64:67]
ds_read_b128 v[168:171],v17 offset:20480
v_min3_u32 v27,v27,v248,v252
v_mfma_f32_16x16x32_bf16 v[68:71],a[204:207],v[252:255],v[68:71]
buffer_load_dwordx4 v16,s[20:23],s65 offen offset:2048 sc1 lds
s_waitcnt lgkmcnt(9)
v_mfma_f32_16x16x32_bf16 v[64:67],a[96:99],v[224:227],v[64:67]
ds_read_b128 v[172:175],v17 offset:22528
s_xor_b32 m0,s72,16384
v_min3_u32 v27,v27,v224,v228
v_mfma_f32_16x16x32_bf16 v[68:71],a[208:211],v[224:227],v[68:71]
s_add_u32 s65,s88,32768
v_min3_u32 v27,v27,v226,v230
v_mfma_f32_16x16x32_bf16 v[64:67],a[100:103],v[228:231],v[64:67]
ds_read_b128 v[176:179],v17 offset:24576
ds_read_b128 v[180:183],v17 offset:26624
v_mfma_f32_16x16x32_bf16 v[68:71],a[212:215],v[228:231],v[68:71]
buffer_load_dwordx4 v16,s[20:23],s65 offen offset:0 sc1 lds
s_waitcnt lgkmcnt(7)
v_mfma_f32_16x16x32_bf16 v[64:67],a[104:107],v[232:235],v[64:67]
ds_read_b128 v[184:187],v17 offset:28672
v_min3_u32 v27,v27,v232,v236
v_min3_u32 v27,v27,v234,v238
v_mfma_f32_16x16x32_bf16 v[68:71],a[216:219],v[232:235],v[68:71]
buffer_load_dwordx4 v16,s[20:23],s65 offen offset:2048 sc1 lds
v_mfma_f32_16x16x32_bf16 v[64:67],a[108:111],v[236:239],v[64:67]
ds_read_b128 v[188:191],v17 offset:30720
s_xor_b32 m0,s72,32768
v_mfma_f32_16x16x32_bf16 v[68:71],a[220:223],v[236:239],v[68:71]
s_add_u32 s65,s88,65536
v_mfma_f32_16x16x32_bf16 v[72:75],a[112:115],v[128:131],0
buffer_load_dwordx4 v16,s[20:23],s65 offen offset:0 sc1 lds
v_cmp_eq_u32 vcc,0,v27
s_cbranch_vccnz retry_324
v_mfma_f32_16x16x32_bf16 v[76:79],a[116:119],v[132:135],0
buffer_load_dwordx4 v16,s[20:23],s65 offen offset:2048 sc1 lds
v_mfma_f32_16x16x32_bf16 v[72:75],a[120:123],v[136:139],v[72:75]
s_waitcnt vmcnt(8)
s_barrier
ds_read_b128 v[192:195],v17 offset:32768
v_mfma_f32_16x16x32_bf16 v[76:79],a[124:127],v[140:143],v[76:79]
ds_read_b128 v[196:199],v17 offset:34816
s_waitcnt lgkmcnt(10)
v_mfma_f32_16x16x32_bf16 v[72:75],a[128:131],v[144:147],v[72:75]
ds_read_b128 v[200:203],v17 offset:36864
s_xor_b32 m0,s72,49152
s_waitcnt vmcnt(6)
v_and_or_b32 v64,v64,-4,s48
v_mfma_f32_16x16x32_bf16 v[76:79],a[132:135],v[148:151],v[76:79]
ds_read_b128 v[204:207],v17 offset:38912
s_add_u32 s65,s88,s86
s_add_u32 s64,s49,s34
v_mfma_f32_16x16x32_bf16 v[72:75],a[136:139],v[152:155],v[72:75]
ds_read_b128 v[208:211],v17 offset:40960
v_min3_u32 v27,v27,v128,v132
buffer_store_dwordx4 v[64:67],v25,s[20:23],s64 offen offset:2048
v_mfma_f32_16x16x32_bf16 v[76:79],a[140:143],v[156:159],v[76:79]
v_min3_u32 v27,v27,v136,v140
v_and_or_b32 v68,v68,-4,s48
s_add_u32 s64,s49,s35
s_waitcnt lgkmcnt(9)
v_mfma_f32_16x16x32_bf16 v[72:75],a[144:147],v[160:163],v[72:75]
ds_read_b128 v[212:215],v17 offset:43008
v_min3_u32 v27,v27,v144,v148
buffer_store_dwordx4 v[68:71],v25,s[20:23],s64 offen offset:3072
v_mfma_f32_16x16x32_bf16 v[76:79],a[148:151],v[164:167],v[76:79]
ds_read_b128 v[216:219],v17 offset:45056
v_min3_u32 v27,v27,v152,v156
s_mov_b32 s49,0x7fff0000
v_mfma_f32_16x16x32_bf16 v[72:75],a[152:155],v[168:171],v[72:75]
ds_read_b128 v[220:223],v17 offset:47104
v_min3_u32 v27,v27,v160,v164
v_mfma_f32_16x16x32_bf16 v[76:79],a[156:159],v[172:175],v[76:79]
ds_read_b128 v[224:227],v17 offset:49152
s_waitcnt lgkmcnt(9)
v_mfma_f32_16x16x32_bf16 v[72:75],a[160:163],v[176:179],v[72:75]
ds_read_b128 v[228:231],v17 offset:51200
v_min3_u32 v27,v27,v168,v172
v_mfma_f32_16x16x32_bf16 v[76:79],a[164:167],v[180:183],v[76:79]
buffer_load_dwordx4 v16,s[20:23],s65 offen offset:0 sc1 lds
v_mfma_f32_16x16x32_bf16 v[72:75],a[168:171],v[184:187],v[72:75]
ds_read_b128 v[232:235],v17 offset:53248
v_min3_u32 v27,v27,v176,v180
v_mfma_f32_16x16x32_bf16 v[76:79],a[172:175],v[188:191],v[76:79]
ds_read_b128 v[236:239],v17 offset:55296
s_waitcnt lgkmcnt(8)
v_mfma_f32_16x16x32_bf16 v[72:75],a[176:179],v[192:195],v[72:75]
buffer_load_dwordx4 v16,s[20:23],s65 offen offset:2048 sc1 lds
v_mfma_f32_16x16x32_bf16 v[76:79],a[180:183],v[196:199],v[76:79]
s_xor_b32 m0,s72,1024
s_add_u32 s65,s89,0
v_mfma_f32_16x16x32_bf16 v[72:75],a[184:187],v[200:203],v[72:75]
buffer_load_dwordx4 v16,s[20:23],s65 offen offset:0 sc1 lds
v_mfma_f32_16x16x32_bf16 v[76:79],a[188:191],v[204:207],v[76:79]
v_min3_u32 v27,v27,v184,v188
v_min3_u32 v27,v27,v200,v204
s_waitcnt lgkmcnt(4)
v_mfma_f32_16x16x32_bf16 v[72:75],a[192:195],v[208:211],v[72:75]
buffer_load_dwordx4 v16,s[20:23],s65 offen offset:2048 sc1 lds
v_mfma_f32_16x16x32_bf16 v[76:79],a[196:199],v[212:215],v[76:79]
s_xor_b32 m0,s72,17408
s_add_u32 s65,s89,32768
v_min3_u32 v27,v27,v208,v212
v_mfma_f32_16x16x32_bf16 v[72:75],a[200:203],v[216:219],v[72:75]
buffer_load_dwordx4 v16,s[20:23],s65 offen offset:0 sc1 lds
v_mfma_f32_16x16x32_bf16 v[76:79],a[204:207],v[220:223],v[76:79]
v_min3_u32 v27,v27,v192,v196
v_min3_u32 v27,v27,v216,v220
s_waitcnt lgkmcnt(0)
v_mfma_f32_16x16x32_bf16 v[72:75],a[208:211],v[224:227],v[72:75]
buffer_load_dwordx4 v16,s[20:23],s65 offen offset:2048 sc1 lds
v_mfma_f32_16x16x32_bf16 v[76:79],a[212:215],v[228:231],v[76:79]
s_xor_b32 m0,s72,33792
s_add_u32 s65,s89,65536
v_min3_u32 v27,v27,v224,v228
v_mfma_f32_16x16x32_bf16 v[72:75],a[216:219],v[232:235],v[72:75]
buffer_load_dwordx4 v16,s[20:23],s65 offen offset:0 sc1 lds
v_min3_u32 v27,v27,v226,v230
v_mfma_f32_16x16x32_bf16 v[76:79],a[220:223],v[236:239],v[76:79]
buffer_load_dwordx4 v16,s[20:23],s65 offen offset:2048 sc1 lds
v_min3_u32 v27,v27,v232,v236
v_min3_u32 v27,v27,v234,v238
v_mfma_f32_16x16x32_bf16 v[80:83],a[0:3],v[128:131],0
s_xor_b32 m0,s72,50176
s_add_u32 s65,s89,s86
v_cmp_eq_u32 vcc,0,v27
s_cbranch_vccnz retry_324
v_mfma_f32_16x16x32_bf16 v[84:87],a[4:7],v[132:135],0
buffer_load_dwordx4 v16,s[20:23],s65 offen offset:0 sc1 lds
v_mfma_f32_16x16x32_bf16 v[80:83],a[8:11],v[136:139],v[80:83]
buffer_load_dwordx4 v16,s[20:23],s65 offen offset:2048 sc1 lds
v_mfma_f32_16x16x32_bf16 v[84:87],a[12:15],v[140:143],v[84:87]
ds_bpermute_b32 v124,v41,v120
ds_bpermute_b32 v125,v41,v121
v_mfma_f32_16x16x32_bf16 v[80:83],a[16:19],v[144:147],v[80:83]
v_lshlrev_b32 v108,16,v122
v_and_b32 v109,s80,v122
v_add_f32 v72,v72,v76
v_mfma_f32_16x16x32_bf16 v[84:87],a[20:23],v[148:151],v[84:87]
v_lshlrev_b32 v110,16,v123
v_and_b32 v111,s80,v123
v_add_f32 v73,v73,v77
v_mfma_f32_16x16x32_bf16 v[80:83],a[24:27],v[152:155],v[80:83]
s_waitcnt lgkmcnt(0)
v_lshlrev_b32 v104,16,v124
v_add_f32 v74,v74,v78
v_mfma_f32_16x16x32_bf16 v[84:87],a[28:31],v[156:159],v[84:87]
v_and_b32 v105,s80,v124
v_lshlrev_b32 v106,16,v125
v_mfma_f32_16x16x32_bf16 v[80:83],a[32:35],v[160:163],v[80:83]
v_add_f32 v75,v75,v79
v_and_or_b32 v72,v72,-4,s48
v_mfma_f32_16x16x32_bf16 v[84:87],a[36:39],v[164:167],v[84:87]
v_and_b32 v107,s80,v125
s_add_u32 s64,s77,s33
v_mfma_f32_16x16x32_bf16 v[80:83],a[40:43],v[168:171],v[80:83]
buffer_store_dwordx4 v[72:75],v25,s[20:23],s64 offen offset:1024
v_mfma_f32_16x16x32_bf16 v[84:87],a[44:47],v[172:175],v[84:87]
v_mfma_f32_16x16x32_bf16 v[80:83],a[48:51],v[176:179],v[80:83]
buffer_load_dwordx4 v[96:99],v26,s[20:23],s77 offen offset:2048 sc1
v_mfma_f32_16x16x32_bf16 v[84:87],a[52:55],v[180:183],v[84:87]
buffer_load_dwordx4 v[100:103],v26,s[20:23],s77 offen offset:3072 sc1
v_mfma_f32_16x16x32_bf16 v[80:83],a[56:59],v[184:187],v[80:83]
v_mfma_f32_16x16x32_bf16 v[84:87],a[60:63],v[188:191],v[84:87]
v_mfma_f32_16x16x32_bf16 v[80:83],a[64:67],v[192:195],v[80:83]
v_mfma_f32_16x16x32_bf16 v[84:87],a[68:71],v[196:199],v[84:87]
v_mfma_f32_16x16x32_bf16 v[80:83],a[72:75],v[200:203],v[80:83]
v_mfma_f32_16x16x32_bf16 v[84:87],a[76:79],v[204:207],v[84:87]
v_mfma_f32_16x16x32_bf16 v[80:83],a[80:83],v[208:211],v[80:83]
v_mfma_f32_16x16x32_bf16 v[84:87],a[84:87],v[212:215],v[84:87]
v_mfma_f32_16x16x32_bf16 v[80:83],a[88:91],v[216:219],v[80:83]
buffer_load_dwordx4 v[92:95],v26,s[20:23],s77 offen offset:1024 sc1
v_mfma_f32_16x16x32_bf16 v[84:87],a[92:95],v[220:223],v[84:87]
v_mfma_f32_16x16x32_bf16 v[80:83],a[96:99],v[224:227],v[80:83]
v_mfma_f32_16x16x32_bf16 v[84:87],a[100:103],v[228:231],v[84:87]
v_mfma_f32_16x16x32_bf16 v[80:83],a[104:107],v[232:235],v[80:83]
v_mfma_f32_16x16x32_bf16 v[84:87],a[108:111],v[236:239],v[84:87]
s_branch epi_327
ahead_326:
s_cmp_eq_u32 s93,0
s_cbranch_scc1 both_328
s_waitcnt vmcnt(14) lgkmcnt(0)
s_barrier
ds_read_b128 v[224:227],v18 offset:0
ds_read_b128 v[228:231],v18 offset:2048
ds_read_b128 v[232:235],v18 offset:4096
ds_read_b128 v[236:239],v18 offset:6144
ds_read_b128 v[240:243],v18 offset:8192
ds_read_b128 v[244:247],v18 offset:10240
ds_read_b128 v[248:251],v18 offset:12288
s_waitcnt lgkmcnt(5)
v_mfma_f32_16x16x32_bf16 v[64:67],a[0:3],v[224:227],0
s_add_u32 s96,s71,1
s_add_u32 s92,s71,2
v_mfma_f32_16x16x32_bf16 v[68:71],a[112:115],v[224:227],0
ds_read_b128 v[252:255],v18 offset:14336
v_min_u32 v27,v224,v228
v_mfma_f32_16x16x32_bf16 v[64:67],a[4:7],v[228:231],v[64:67]
s_cmp_eq_u32 s96,64
s_cselect_b32 s96,99,s96
v_mfma_f32_16x16x32_bf16 v[68:71],a[116:119],v[228:231],v[68:71]
ds_read_b128 v[224:227],v18 offset:16384
s_waitcnt lgkmcnt(5)
v_mfma_f32_16x16x32_bf16 v[64:67],a[8:11],v[232:235],v[64:67]
s_cmp_eq_u32 s92,64
s_cselect_b32 s92,99,s92
v_mfma_f32_16x16x32_bf16 v[68:71],a[120:123],v[232:235],v[68:71]
ds_read_b128 v[228:231],v18 offset:18432
v_min3_u32 v27,v27,v232,v236
v_mfma_f32_16x16x32_bf16 v[64:67],a[12:15],v[236:239],v[64:67]
buffer_load_dwordx2 v[120:121],v20,s[20:23],s76 offen sc1
v_mfma_f32_16x16x32_bf16 v[68:71],a[124:127],v[236:239],v[68:71]
ds_read_b128 v[232:235],v18 offset:20480
s_waitcnt lgkmcnt(5)
v_mfma_f32_16x16x32_bf16 v[64:67],a[16:19],v[240:243],v[64:67]
v_min3_u32 v27,v27,v240,v244
v_mfma_f32_16x16x32_bf16 v[68:71],a[128:131],v[240:243],v[68:71]
ds_read_b128 v[236:239],v18 offset:22528
v_mfma_f32_16x16x32_bf16 v[64:67],a[20:23],v[244:247],v[64:67]
s_waitcnt vmcnt(2)
v_mfma_f32_16x16x32_bf16 v[68:71],a[132:135],v[244:247],v[68:71]
ds_read_b128 v[240:243],v18 offset:24576
s_waitcnt lgkmcnt(5)
v_mfma_f32_16x16x32_bf16 v[64:67],a[24:27],v[248:251],v[64:67]
v_cmp_gt_u32 vcc,s96,v29
v_cmp_gt_u32 s[92:93],s92,v29
v_mfma_f32_16x16x32_bf16 v[68:71],a[136:139],v[248:251],v[68:71]
ds_read_b128 v[244:247],v18 offset:26624
v_min3_u32 v27,v27,v248,v252
v_mfma_f32_16x16x32_bf16 v[64:67],a[28:31],v[252:255],v[64:67]
v_mov_b32 v44,vcc_lo
v_mov_b32 v45,s92
v_mfma_f32_16x16x32_bf16 v[68:71],a[140:143],v[252:255],v[68:71]
ds_read_b128 v[248:251],v18 offset:28672
s_waitcnt lgkmcnt(5)
v_mfma_f32_16x16x32_bf16 v[64:67],a[32:35],v[224:227],v[64:67]
ds_write_b64 v46,v[44:45]
v_min3_u32 v27,v27,v224,v228
v_mfma_f32_16x16x32_bf16 v[68:71],a[144:147],v[224:227],v[68:71]
ds_read_b128 v[252:255],v18 offset:30720
v_mfma_f32_16x16x32_bf16 v[64:67],a[36:39],v[228:231],v[64:67]
buffer_load_dwordx2 v[122:123],v24,s[20:23],s70 offen sc1
v_mfma_f32_16x16x32_bf16 v[68:71],a[148:151],v[228:231],v[68:71]
ds_read_b128 v[224:227],v18 offset:32768
s_waitcnt lgkmcnt(6)
v_mfma_f32_16x16x32_bf16 v[64:67],a[40:43],v[232:235],v[64:67]
v_min3_u32 v27,v27,v232,v236
s_add_u32 s88,s70,s75
v_mfma_f32_16x16x32_bf16 v[68:71],a[152:155],v[232:235],v[68:71]
ds_read_b128 v[228:231],v18 offset:34816
s_add_u32 s88,s88,2097152
v_mfma_f32_16x16x32_bf16 v[64:67],a[44:47],v[236:239],v[64:67]
s_xor_b32 s88,s88,0x2000
s_xor_b32 s89,s88,1024
v_mfma_f32_16x16x32_bf16 v[68:71],a[156:159],v[236:239],v[68:71]
ds_read_b128 v[232:235],v18 offset:36864
s_waitcnt lgkmcnt(6)
v_mfma_f32_16x16x32_bf16 v[64:67],a[48:51],v[240:243],v[64:67]
v_min3_u32 v27,v27,v240,v244
v_mfma_f32_16x16x32_bf16 v[68:71],a[160:163],v[240:243],v[68:71]
ds_read_b128 v[236:239],v18 offset:38912
v_mfma_f32_16x16x32_bf16 v[64:67],a[52:55],v[244:247],v[64:67]
v_mfma_f32_16x16x32_bf16 v[68:71],a[164:167],v[244:247],v[68:71]
ds_read_b128 v[240:243],v18 offset:40960
s_waitcnt lgkmcnt(5)
v_mfma_f32_16x16x32_bf16 v[64:67],a[56:59],v[248:251],v[64:67]
v_min3_u32 v27,v27,v248,v252
v_mfma_f32_16x16x32_bf16 v[68:71],a[168:171],v[248:251],v[68:71]
ds_read_b128 v[244:247],v18 offset:43008
v_mfma_f32_16x16x32_bf16 v[64:67],a[60:63],v[252:255],v[64:67]
v_mfma_f32_16x16x32_bf16 v[68:71],a[172:175],v[252:255],v[68:71]
ds_read_b128 v[248:251],v18 offset:45056
s_waitcnt lgkmcnt(5)
v_mfma_f32_16x16x32_bf16 v[64:67],a[64:67],v[224:227],v[64:67]
s_waitcnt vmcnt(8)
s_barrier
ds_read_b64 v[44:45],v47
ds_read_b128 v[128:131],v17 offset:0
ds_read_b128 v[132:135],v17 offset:2048
v_mfma_f32_16x16x32_bf16 v[68:71],a[176:179],v[224:227],v[68:71]
ds_read_b128 v[252:255],v18 offset:47104
v_min3_u32 v27,v27,v224,v228
v_mfma_f32_16x16x32_bf16 v[64:67],a[68:71],v[228:231],v[64:67]
ds_read_b128 v[136:139],v17 offset:4096
v_mfma_f32_16x16x32_bf16 v[68:71],a[180:183],v[228:231],v[68:71]
ds_read_b128 v[224:227],v18 offset:49152
s_waitcnt lgkmcnt(9)
v_mfma_f32_16x16x32_bf16 v[64:67],a[72:75],v[232:235],v[64:67]
ds_read_b128 v[140:143],v17 offset:6144
v_min3_u32 v27,v27,v232,v236
v_mfma_f32_16x16x32_bf16 v[68:71],a[184:187],v[232:235],v[68:71]
ds_read_b128 v[228:231],v18 offset:51200
v_mfma_f32_16x16x32_bf16 v[64:67],a[76:79],v[236:239],v[64:67]
ds_read_b128 v[144:147],v17 offset:8192
ds_read_b128 v[148:151],v17 offset:10240
v_mfma_f32_16x16x32_bf16 v[68:71],a[188:191],v[236:239],v[68:71]
ds_read_b128 v[232:235],v18 offset:53248
s_waitcnt lgkmcnt(12)
v_mfma_f32_16x16x32_bf16 v[64:67],a[80:83],v[240:243],v[64:67]
ds_read_b128 v[152:155],v17 offset:12288
s_waitcnt lgkmcnt(11)
v_min3_u32 v27,v27,v240,v244
v_mfma_f32_16x16x32_bf16 v[68:71],a[192:195],v[240:243],v[68:71]
ds_read_b128 v[236:239],v18 offset:55296
v_readfirstlane_b32 s93,v45
v_mfma_f32_16x16x32_bf16 v[64:67],a[84:87],v[244:247],v[64:67]
ds_read_b128 v[156:159],v17 offset:14336
v_readfirstlane_b32 s83,v44
s_cmp_lg_u32 s83,0
s_cbranch_scc1 keep_336
v_mfma_f32_16x16x32_bf16 v[68:71],a[196:199],v[244:247],v[68:71]
s_xor_b32 m0,s72,0
s_waitcnt lgkmcnt(10)
v_mfma_f32_16x16x32_bf16 v[64:67],a[88:91],v[248:251],v[64:67]
ds_read_b128 v[160:163],v17 offset:16384
ds_read_b128 v[164:167],v17 offset:18432
s_add_u32 s65,s88,0
v_mfma_f32_16x16x32_bf16 v[68:71],a[200:203],v[248:251],v[68:71]
buffer_load_dwordx4 v16,s[20:23],s65 offen offset:0 sc1 lds
v_mfma_f32_16x16x32_bf16 v[64:67],a[92:95],v[252:255],v[64:67]
ds_read_b128 v[168:171],v17 offset:20480
v_min3_u32 v27,v27,v248,v252
v_mfma_f32_16x16x32_bf16 v[68:71],a[204:207],v[252:255],v[68:71]
buffer_load_dwordx4 v16,s[20:23],s65 offen offset:2048 sc1 lds
s_waitcnt lgkmcnt(9)
v_mfma_f32_16x16x32_bf16 v[64:67],a[96:99],v[224:227],v[64:67]
ds_read_b128 v[172:175],v17 offset:22528
s_xor_b32 m0,s72,16384
v_min3_u32 v27,v27,v224,v228
v_mfma_f32_16x16x32_bf16 v[68:71],a[208:211],v[224:227],v[68:71]
s_add_u32 s65,s88,32768
v_min3_u32 v27,v27,v226,v230
v_mfma_f32_16x16x32_bf16 v[64:67],a[100:103],v[228:231],v[64:67]
ds_read_b128 v[176:179],v17 offset:24576
ds_read_b128 v[180:183],v17 offset:26624
v_mfma_f32_16x16x32_bf16 v[68:71],a[212:215],v[228:231],v[68:71]
buffer_load_dwordx4 v16,s[20:23],s65 offen offset:0 sc1 lds
s_waitcnt lgkmcnt(7)
v_mfma_f32_16x16x32_bf16 v[64:67],a[104:107],v[232:235],v[64:67]
ds_read_b128 v[184:187],v17 offset:28672
v_min3_u32 v27,v27,v232,v236
v_min3_u32 v27,v27,v234,v238
v_mfma_f32_16x16x32_bf16 v[68:71],a[216:219],v[232:235],v[68:71]
buffer_load_dwordx4 v16,s[20:23],s65 offen offset:2048 sc1 lds
v_mfma_f32_16x16x32_bf16 v[64:67],a[108:111],v[236:239],v[64:67]
ds_read_b128 v[188:191],v17 offset:30720
s_xor_b32 m0,s72,32768
v_mfma_f32_16x16x32_bf16 v[68:71],a[220:223],v[236:239],v[68:71]
s_add_u32 s65,s88,65536
v_mfma_f32_16x16x32_bf16 v[72:75],a[112:115],v[128:131],0
buffer_load_dwordx4 v16,s[20:23],s65 offen offset:0 sc1 lds
v_mfma_f32_16x16x32_bf16 v[76:79],a[116:119],v[132:135],0
buffer_load_dwordx4 v16,s[20:23],s65 offen offset:2048 sc1 lds
v_mfma_f32_16x16x32_bf16 v[72:75],a[120:123],v[136:139],v[72:75]
ds_read_b128 v[192:195],v17 offset:32768
v_cmp_eq_u32 vcc,0,v27
s_cbranch_vccnz retry_324
v_mfma_f32_16x16x32_bf16 v[76:79],a[124:127],v[140:143],v[76:79]
ds_read_b128 v[196:199],v17 offset:34816
s_waitcnt lgkmcnt(10)
v_mfma_f32_16x16x32_bf16 v[72:75],a[128:131],v[144:147],v[72:75]
ds_read_b128 v[200:203],v17 offset:36864
s_xor_b32 m0,s72,49152
s_waitcnt vmcnt(6)
v_and_or_b32 v64,v64,-4,s48
v_mfma_f32_16x16x32_bf16 v[76:79],a[132:135],v[148:151],v[76:79]
ds_read_b128 v[204:207],v17 offset:38912
s_add_u32 s65,s88,s86
s_add_u32 s64,s49,s34
v_mfma_f32_16x16x32_bf16 v[72:75],a[136:139],v[152:155],v[72:75]
ds_read_b128 v[208:211],v17 offset:40960
v_min3_u32 v27,v27,v128,v132
buffer_store_dwordx4 v[64:67],v25,s[20:23],s64 offen offset:2048
v_mfma_f32_16x16x32_bf16 v[76:79],a[140:143],v[156:159],v[76:79]
v_min3_u32 v27,v27,v136,v140
v_and_or_b32 v68,v68,-4,s48
s_add_u32 s64,s49,s35
s_waitcnt lgkmcnt(9)
v_mfma_f32_16x16x32_bf16 v[72:75],a[144:147],v[160:163],v[72:75]
ds_read_b128 v[212:215],v17 offset:43008
v_min3_u32 v27,v27,v144,v148
buffer_store_dwordx4 v[68:71],v25,s[20:23],s64 offen offset:3072
v_mfma_f32_16x16x32_bf16 v[76:79],a[148:151],v[164:167],v[76:79]
ds_read_b128 v[216:219],v17 offset:45056
v_min3_u32 v27,v27,v152,v156
s_mov_b32 s49,0x7fff0000
v_mfma_f32_16x16x32_bf16 v[72:75],a[152:155],v[168:171],v[72:75]
ds_read_b128 v[220:223],v17 offset:47104
v_min3_u32 v27,v27,v160,v164
v_mfma_f32_16x16x32_bf16 v[76:79],a[156:159],v[172:175],v[76:79]
ds_read_b128 v[224:227],v17 offset:49152
s_waitcnt lgkmcnt(9)
v_mfma_f32_16x16x32_bf16 v[72:75],a[160:163],v[176:179],v[72:75]
ds_read_b128 v[228:231],v17 offset:51200
v_min3_u32 v27,v27,v168,v172
v_mfma_f32_16x16x32_bf16 v[76:79],a[164:167],v[180:183],v[76:79]
buffer_load_dwordx4 v16,s[20:23],s65 offen offset:0 sc1 lds
v_mfma_f32_16x16x32_bf16 v[72:75],a[168:171],v[184:187],v[72:75]
ds_read_b128 v[232:235],v17 offset:53248
v_min3_u32 v27,v27,v176,v180
v_mfma_f32_16x16x32_bf16 v[76:79],a[172:175],v[188:191],v[76:79]
ds_read_b128 v[236:239],v17 offset:55296
s_waitcnt lgkmcnt(8)
v_mfma_f32_16x16x32_bf16 v[72:75],a[176:179],v[192:195],v[72:75]
buffer_load_dwordx4 v16,s[20:23],s65 offen offset:2048 sc1 lds
v_mfma_f32_16x16x32_bf16 v[76:79],a[180:183],v[196:199],v[76:79]
s_xor_b32 m0,s72,1024
s_add_u32 s65,s89,0
v_mfma_f32_16x16x32_bf16 v[72:75],a[184:187],v[200:203],v[72:75]
buffer_load_dwordx4 v16,s[20:23],s65 offen offset:0 sc1 lds
v_mfma_f32_16x16x32_bf16 v[76:79],a[188:191],v[204:207],v[76:79]
v_min3_u32 v27,v27,v184,v188
v_min3_u32 v27,v27,v200,v204
s_waitcnt lgkmcnt(4)
v_mfma_f32_16x16x32_bf16 v[72:75],a[192:195],v[208:211],v[72:75]
buffer_load_dwordx4 v16,s[20:23],s65 offen offset:2048 sc1 lds
v_mfma_f32_16x16x32_bf16 v[76:79],a[196:199],v[212:215],v[76:79]
s_xor_b32 m0,s72,17408
s_add_u32 s65,s89,32768
v_min3_u32 v27,v27,v208,v212
v_mfma_f32_16x16x32_bf16 v[72:75],a[200:203],v[216:219],v[72:75]
buffer_load_dwordx4 v16,s[20:23],s65 offen offset:0 sc1 lds
v_mfma_f32_16x16x32_bf16 v[76:79],a[204:207],v[220:223],v[76:79]
v_min3_u32 v27,v27,v192,v196
v_min3_u32 v27,v27,v216,v220
s_waitcnt lgkmcnt(0)
v_mfma_f32_16x16x32_bf16 v[72:75],a[208:211],v[224:227],v[72:75]
buffer_load_dwordx4 v16,s[20:23],s65 offen offset:2048 sc1 lds
v_mfma_f32_16x16x32_bf16 v[76:79],a[212:215],v[228:231],v[76:79]
s_xor_b32 m0,s72,33792
s_add_u32 s65,s89,65536
v_min3_u32 v27,v27,v224,v228
v_mfma_f32_16x16x32_bf16 v[72:75],a[216:219],v[232:235],v[72:75]
buffer_load_dwordx4 v16,s[20:23],s65 offen offset:0 sc1 lds
v_min3_u32 v27,v27,v226,v230
v_mfma_f32_16x16x32_bf16 v[76:79],a[220:223],v[236:239],v[76:79]
buffer_load_dwordx4 v16,s[20:23],s65 offen offset:2048 sc1 lds
v_min3_u32 v27,v27,v232,v236
v_min3_u32 v27,v27,v234,v238
v_mfma_f32_16x16x32_bf16 v[80:83],a[0:3],v[128:131],0
s_xor_b32 m0,s72,50176
s_add_u32 s65,s89,s86
v_cmp_eq_u32 vcc,0,v27
s_cbranch_vccnz retry_324
v_mfma_f32_16x16x32_bf16 v[84:87],a[4:7],v[132:135],0
buffer_load_dwordx4 v16,s[20:23],s65 offen offset:0 sc1 lds
v_mfma_f32_16x16x32_bf16 v[80:83],a[8:11],v[136:139],v[80:83]
buffer_load_dwordx4 v16,s[20:23],s65 offen offset:2048 sc1 lds
v_mfma_f32_16x16x32_bf16 v[84:87],a[12:15],v[140:143],v[84:87]
ds_bpermute_b32 v124,v41,v120
ds_bpermute_b32 v125,v41,v121
v_mfma_f32_16x16x32_bf16 v[80:83],a[16:19],v[144:147],v[80:83]
v_lshlrev_b32 v108,16,v122
v_and_b32 v109,s80,v122
v_add_f32 v72,v72,v76
v_mfma_f32_16x16x32_bf16 v[84:87],a[20:23],v[148:151],v[84:87]
v_lshlrev_b32 v110,16,v123
v_and_b32 v111,s80,v123
v_add_f32 v73,v73,v77
v_mfma_f32_16x16x32_bf16 v[80:83],a[24:27],v[152:155],v[80:83]
s_waitcnt lgkmcnt(0)
v_lshlrev_b32 v104,16,v124
v_add_f32 v74,v74,v78
v_mfma_f32_16x16x32_bf16 v[84:87],a[28:31],v[156:159],v[84:87]
v_and_b32 v105,s80,v124
v_lshlrev_b32 v106,16,v125
v_mfma_f32_16x16x32_bf16 v[80:83],a[32:35],v[160:163],v[80:83]
v_add_f32 v75,v75,v79
v_and_or_b32 v72,v72,-4,s48
v_mfma_f32_16x16x32_bf16 v[84:87],a[36:39],v[164:167],v[84:87]
v_and_b32 v107,s80,v125
s_add_u32 s64,s77,s33
v_mfma_f32_16x16x32_bf16 v[80:83],a[40:43],v[168:171],v[80:83]
buffer_store_dwordx4 v[72:75],v25,s[20:23],s64 offen offset:1024
v_mfma_f32_16x16x32_bf16 v[84:87],a[44:47],v[172:175],v[84:87]
v_mfma_f32_16x16x32_bf16 v[80:83],a[48:51],v[176:179],v[80:83]
buffer_load_dwordx4 v[96:99],v26,s[20:23],s77 offen offset:2048 sc1
v_mfma_f32_16x16x32_bf16 v[84:87],a[52:55],v[180:183],v[84:87]
buffer_load_dwordx4 v[100:103],v26,s[20:23],s77 offen offset:3072 sc1
v_mfma_f32_16x16x32_bf16 v[80:83],a[56:59],v[184:187],v[80:83]
v_mfma_f32_16x16x32_bf16 v[84:87],a[60:63],v[188:191],v[84:87]
v_mfma_f32_16x16x32_bf16 v[80:83],a[64:67],v[192:195],v[80:83]
v_mfma_f32_16x16x32_bf16 v[84:87],a[68:71],v[196:199],v[84:87]
v_mfma_f32_16x16x32_bf16 v[80:83],a[72:75],v[200:203],v[80:83]
v_mfma_f32_16x16x32_bf16 v[84:87],a[76:79],v[204:207],v[84:87]
v_mfma_f32_16x16x32_bf16 v[80:83],a[80:83],v[208:211],v[80:83]
v_mfma_f32_16x16x32_bf16 v[84:87],a[84:87],v[212:215],v[84:87]
v_mfma_f32_16x16x32_bf16 v[80:83],a[88:91],v[216:219],v[80:83]
buffer_load_dwordx4 v[92:95],v26,s[20:23],s77 offen offset:1024 sc1
v_mfma_f32_16x16x32_bf16 v[84:87],a[92:95],v[220:223],v[84:87]
v_mfma_f32_16x16x32_bf16 v[80:83],a[96:99],v[224:227],v[80:83]
v_mfma_f32_16x16x32_bf16 v[84:87],a[100:103],v[228:231],v[84:87]
v_mfma_f32_16x16x32_bf16 v[80:83],a[104:107],v[232:235],v[80:83]
v_mfma_f32_16x16x32_bf16 v[84:87],a[108:111],v[236:239],v[84:87]
s_branch epi_327
keep_336:
v_mfma_f32_16x16x32_bf16 v[68:71],a[196:199],v[244:247],v[68:71]
s_waitcnt lgkmcnt(10)
v_mfma_f32_16x16x32_bf16 v[64:67],a[88:91],v[248:251],v[64:67]
ds_read_b128 v[160:163],v17 offset:16384
ds_read_b128 v[164:167],v17 offset:18432
v_mfma_f32_16x16x32_bf16 v[68:71],a[200:203],v[248:251],v[68:71]
v_min3_u32 v27,v27,v248,v252
v_mfma_f32_16x16x32_bf16 v[64:67],a[92:95],v[252:255],v[64:67]
ds_read_b128 v[168:171],v17 offset:20480
v_mfma_f32_16x16x32_bf16 v[68:71],a[204:207],v[252:255],v[68:71]
s_waitcnt lgkmcnt(9)
v_mfma_f32_16x16x32_bf16 v[64:67],a[96:99],v[224:227],v[64:67]
ds_read_b128 v[172:175],v17 offset:22528
v_min3_u32 v27,v27,v224,v228
v_mfma_f32_16x16x32_bf16 v[68:71],a[208:211],v[224:227],v[68:71]
v_min3_u32 v27,v27,v226,v230
v_mfma_f32_16x16x32_bf16 v[64:67],a[100:103],v[228:231],v[64:67]
ds_read_b128 v[176:179],v17 offset:24576
ds_read_b128 v[180:183],v17 offset:26624
v_mfma_f32_16x16x32_bf16 v[68:71],a[212:215],v[228:231],v[68:71]
s_waitcnt lgkmcnt(7)
v_mfma_f32_16x16x32_bf16 v[64:67],a[104:107],v[232:235],v[64:67]
ds_read_b128 v[184:187],v17 offset:28672
v_min3_u32 v27,v27,v232,v236
v_mfma_f32_16x16x32_bf16 v[68:71],a[216:219],v[232:235],v[68:71]
v_min3_u32 v27,v27,v234,v238
v_mfma_f32_16x16x32_bf16 v[64:67],a[108:111],v[236:239],v[64:67]
ds_read_b128 v[188:191],v17 offset:30720
v_mfma_f32_16x16x32_bf16 v[68:71],a[220:223],v[236:239],v[68:71]
v_mfma_f32_16x16x32_bf16 v[72:75],a[112:115],v[128:131],0
v_cmp_eq_u32 vcc,0,v27
s_cbranch_vccnz retry_324
v_mfma_f32_16x16x32_bf16 v[76:79],a[116:119],v[132:135],0
v_min3_u32 v27,v27,v128,v132
v_mfma_f32_16x16x32_bf16 v[72:75],a[120:123],v[136:139],v[72:75]
ds_read_b128 v[192:195],v17 offset:32768
v_mfma_f32_16x16x32_bf16 v[76:79],a[124:127],v[140:143],v[76:79]
ds_read_b128 v[196:199],v17 offset:34816
s_waitcnt lgkmcnt(10)
v_mfma_f32_16x16x32_bf16 v[72:75],a[128:131],v[144:147],v[72:75]
ds_read_b128 v[200:203],v17 offset:36864
v_min3_u32 v27,v27,v136,v140
s_waitcnt vmcnt(0)
v_mfma_f32_16x16x32_bf16 v[76:79],a[132:135],v[148:151],v[76:79]
ds_read_b128 v[204:207],v17 offset:38912
v_min3_u32 v27,v27,v144,v148
v_and_or_b32 v64,v64,-4,s48
v_mfma_f32_16x16x32_bf16 v[72:75],a[136:139],v[152:155],v[72:75]
ds_read_b128 v[208:211],v17 offset:40960
s_add_u32 s64,s49,s34
v_mfma_f32_16x16x32_bf16 v[76:79],a[140:143],v[156:159],v[76:79]
v_min3_u32 v27,v27,v152,v156
s_waitcnt lgkmcnt(9)
v_mfma_f32_16x16x32_bf16 v[72:75],a[144:147],v[160:163],v[72:75]
ds_read_b128 v[212:215],v17 offset:43008
buffer_store_dwordx4 v[64:67],v25,s[20:23],s64 offen offset:2048
v_mfma_f32_16x16x32_bf16 v[76:79],a[148:151],v[164:167],v[76:79]
ds_read_b128 v[216:219],v17 offset:45056
v_min3_u32 v27,v27,v160,v164
v_and_or_b32 v68,v68,-4,s48
v_mfma_f32_16x16x32_bf16 v[72:75],a[152:155],v[168:171],v[72:75]
ds_read_b128 v[220:223],v17 offset:47104
s_add_u32 s64,s49,s35
v_mfma_f32_16x16x32_bf16 v[76:79],a[156:159],v[172:175],v[76:79]
ds_read_b128 v[224:227],v17 offset:49152
s_waitcnt lgkmcnt(9)
v_mfma_f32_16x16x32_bf16 v[72:75],a[160:163],v[176:179],v[72:75]
ds_read_b128 v[228:231],v17 offset:51200
v_min3_u32 v27,v27,v168,v172
v_mfma_f32_16x16x32_bf16 v[76:79],a[164:167],v[180:183],v[76:79]
v_min3_u32 v27,v27,v176,v180
buffer_store_dwordx4 v[68:71],v25,s[20:23],s64 offen offset:3072
v_mfma_f32_16x16x32_bf16 v[72:75],a[168:171],v[184:187],v[72:75]
ds_read_b128 v[232:235],v17 offset:53248
s_mov_b32 s49,0x7fff0000
v_mfma_f32_16x16x32_bf16 v[76:79],a[172:175],v[188:191],v[76:79]
ds_read_b128 v[236:239],v17 offset:55296
s_waitcnt lgkmcnt(8)
v_mfma_f32_16x16x32_bf16 v[72:75],a[176:179],v[192:195],v[72:75]
v_min3_u32 v27,v27,v184,v188
v_mfma_f32_16x16x32_bf16 v[76:79],a[180:183],v[196:199],v[76:79]
v_min3_u32 v27,v27,v192,v196
ds_bpermute_b32 v124,v41,v120
v_mfma_f32_16x16x32_bf16 v[72:75],a[184:187],v[200:203],v[72:75]
v_mfma_f32_16x16x32_bf16 v[76:79],a[188:191],v[204:207],v[76:79]
v_min3_u32 v27,v27,v200,v204
s_waitcnt lgkmcnt(5)
v_mfma_f32_16x16x32_bf16 v[72:75],a[192:195],v[208:211],v[72:75]
ds_bpermute_b32 v125,v41,v121
v_mfma_f32_16x16x32_bf16 v[76:79],a[196:199],v[212:215],v[76:79]
v_min3_u32 v27,v27,v208,v212
v_lshlrev_b32 v108,16,v122
v_mfma_f32_16x16x32_bf16 v[72:75],a[200:203],v[216:219],v[72:75]
v_mfma_f32_16x16x32_bf16 v[76:79],a[204:207],v[220:223],v[76:79]
v_min3_u32 v27,v27,v216,v220
s_waitcnt lgkmcnt(2)
v_mfma_f32_16x16x32_bf16 v[72:75],a[208:211],v[224:227],v[72:75]
v_and_b32 v109,s80,v122
v_mfma_f32_16x16x32_bf16 v[76:79],a[212:215],v[228:231],v[76:79]
v_min3_u32 v27,v27,v224,v228
v_min3_u32 v27,v27,v226,v230
v_mfma_f32_16x16x32_bf16 v[72:75],a[216:219],v[232:235],v[72:75]
v_lshlrev_b32 v110,16,v123
v_mfma_f32_16x16x32_bf16 v[76:79],a[220:223],v[236:239],v[76:79]
v_min3_u32 v27,v27,v232,v236
v_min3_u32 v27,v27,v234,v238
v_mfma_f32_16x16x32_bf16 v[80:83],a[0:3],v[128:131],0
v_cmp_eq_u32 vcc,0,v27
s_cbranch_vccnz retry_324
v_mfma_f32_16x16x32_bf16 v[84:87],a[4:7],v[132:135],0
v_and_b32 v111,s80,v123
s_waitcnt lgkmcnt(0)
v_mfma_f32_16x16x32_bf16 v[80:83],a[8:11],v[136:139],v[80:83]
v_mfma_f32_16x16x32_bf16 v[84:87],a[12:15],v[140:143],v[84:87]
v_lshlrev_b32 v104,16,v124
v_mfma_f32_16x16x32_bf16 v[80:83],a[16:19],v[144:147],v[80:83]
v_add_f32 v72,v72,v76
v_add_f32 v73,v73,v77
v_mfma_f32_16x16x32_bf16 v[84:87],a[20:23],v[148:151],v[84:87]
v_and_b32 v105,s80,v124
v_add_f32 v74,v74,v78
v_mfma_f32_16x16x32_bf16 v[80:83],a[24:27],v[152:155],v[80:83]
v_add_f32 v75,v75,v79
v_and_or_b32 v72,v72,-4,s48
v_mfma_f32_16x16x32_bf16 v[84:87],a[28:31],v[156:159],v[84:87]
v_lshlrev_b32 v106,16,v125
s_add_u32 s64,s77,s33
v_mfma_f32_16x16x32_bf16 v[80:83],a[32:35],v[160:163],v[80:83]
buffer_store_dwordx4 v[72:75],v25,s[20:23],s64 offen offset:1024
v_mfma_f32_16x16x32_bf16 v[84:87],a[36:39],v[164:167],v[84:87]
v_and_b32 v107,s80,v125
v_mfma_f32_16x16x32_bf16 v[80:83],a[40:43],v[168:171],v[80:83]
v_mfma_f32_16x16x32_bf16 v[84:87],a[44:47],v[172:175],v[84:87]
v_mfma_f32_16x16x32_bf16 v[80:83],a[48:51],v[176:179],v[80:83]
buffer_load_dwordx4 v[96:99],v26,s[20:23],s77 offen offset:2048 sc1
v_mfma_f32_16x16x32_bf16 v[84:87],a[52:55],v[180:183],v[84:87]
buffer_load_dwordx4 v[100:103],v26,s[20:23],s77 offen offset:3072 sc1
v_mfma_f32_16x16x32_bf16 v[80:83],a[56:59],v[184:187],v[80:83]
v_mfma_f32_16x16x32_bf16 v[84:87],a[60:63],v[188:191],v[84:87]
v_mfma_f32_16x16x32_bf16 v[80:83],a[64:67],v[192:195],v[80:83]
v_mfma_f32_16x16x32_bf16 v[84:87],a[68:71],v[196:199],v[84:87]
v_mfma_f32_16x16x32_bf16 v[80:83],a[72:75],v[200:203],v[80:83]
v_mfma_f32_16x16x32_bf16 v[84:87],a[76:79],v[204:207],v[84:87]
v_mfma_f32_16x16x32_bf16 v[80:83],a[80:83],v[208:211],v[80:83]
v_mfma_f32_16x16x32_bf16 v[84:87],a[84:87],v[212:215],v[84:87]
v_mfma_f32_16x16x32_bf16 v[80:83],a[88:91],v[216:219],v[80:83]
buffer_load_dwordx4 v[92:95],v26,s[20:23],s77 offen offset:1024 sc1
v_mfma_f32_16x16x32_bf16 v[84:87],a[92:95],v[220:223],v[84:87]
v_mfma_f32_16x16x32_bf16 v[80:83],a[96:99],v[224:227],v[80:83]
v_mfma_f32_16x16x32_bf16 v[84:87],a[100:103],v[228:231],v[84:87]
v_mfma_f32_16x16x32_bf16 v[80:83],a[104:107],v[232:235],v[80:83]
v_mfma_f32_16x16x32_bf16 v[84:87],a[108:111],v[236:239],v[84:87]
s_branch epi_327
both_328:
s_waitcnt vmcnt(14) lgkmcnt(0)
s_barrier
ds_read_b128 v[224:227],v18 offset:0
ds_read_b128 v[228:231],v18 offset:2048
ds_read_b128 v[232:235],v18 offset:4096
ds_read_b128 v[236:239],v18 offset:6144
ds_read_b128 v[240:243],v18 offset:8192
ds_read_b128 v[244:247],v18 offset:10240
ds_read_b128 v[248:251],v18 offset:12288
s_waitcnt lgkmcnt(5)
v_mfma_f32_16x16x32_bf16 v[64:67],a[0:3],v[224:227],0
s_add_u32 s96,s71,1
s_add_u32 s92,s71,2
s_add_u32 s88,s70,s75
v_mfma_f32_16x16x32_bf16 v[68:71],a[112:115],v[224:227],0
ds_read_b128 v[252:255],v18 offset:14336
s_add_u32 s88,s88,2097152
s_xor_b32 s88,s88,0x2000
v_mfma_f32_16x16x32_bf16 v[64:67],a[4:7],v[228:231],v[64:67]
s_cmp_eq_u32 s96,64
s_cselect_b32 s96,99,s96
v_min_u32 v27,v224,v228
v_mfma_f32_16x16x32_bf16 v[68:71],a[116:119],v[228:231],v[68:71]
ds_read_b128 v[224:227],v18 offset:16384
s_waitcnt lgkmcnt(5)
v_mfma_f32_16x16x32_bf16 v[64:67],a[8:11],v[232:235],v[64:67]
s_cmp_eq_u32 s92,64
s_cselect_b32 s92,99,s92
v_mfma_f32_16x16x32_bf16 v[68:71],a[120:123],v[232:235],v[68:71]
ds_read_b128 v[228:231],v18 offset:18432
s_xor_b32 s89,s88,1024
v_mfma_f32_16x16x32_bf16 v[64:67],a[12:15],v[236:239],v[64:67]
s_xor_b32 m0,s72,0
v_min3_u32 v27,v27,v232,v236
v_mfma_f32_16x16x32_bf16 v[68:71],a[124:127],v[236:239],v[68:71]
ds_read_b128 v[232:235],v18 offset:20480
s_add_u32 s65,s88,0
s_waitcnt lgkmcnt(5)
v_mfma_f32_16x16x32_bf16 v[64:67],a[16:19],v[240:243],v[64:67]
v_min3_u32 v27,v27,v240,v244
buffer_load_dwordx2 v[120:121],v20,s[20:23],s76 offen sc1
v_mfma_f32_16x16x32_bf16 v[68:71],a[128:131],v[240:243],v[68:71]
ds_read_b128 v[236:239],v18 offset:22528
buffer_load_dwordx4 v16,s[20:23],s65 offen offset:0 sc1 lds
v_mfma_f32_16x16x32_bf16 v[64:67],a[20:23],v[244:247],v[64:67]
s_waitcnt vmcnt(3)
v_mfma_f32_16x16x32_bf16 v[68:71],a[132:135],v[244:247],v[68:71]
ds_read_b128 v[240:243],v18 offset:24576
s_waitcnt lgkmcnt(5)
v_mfma_f32_16x16x32_bf16 v[64:67],a[24:27],v[248:251],v[64:67]
v_cmp_gt_u32 vcc,s96,v29
v_cmp_gt_u32 s[92:93],s92,v29
v_min3_u32 v27,v27,v248,v252
v_mfma_f32_16x16x32_bf16 v[68:71],a[136:139],v[248:251],v[68:71]
ds_read_b128 v[244:247],v18 offset:26624
buffer_load_dwordx4 v16,s[20:23],s65 offen offset:2048 sc1 lds
v_mfma_f32_16x16x32_bf16 v[64:67],a[28:31],v[252:255],v[64:67]
v_mov_b32 v44,vcc_lo
v_mov_b32 v45,s92
s_xor_b32 m0,s72,16384
v_mfma_f32_16x16x32_bf16 v[68:71],a[140:143],v[252:255],v[68:71]
ds_read_b128 v[248:251],v18 offset:28672
s_add_u32 s65,s88,32768
s_waitcnt lgkmcnt(5)
v_mfma_f32_16x16x32_bf16 v[64:67],a[32:35],v[224:227],v[64:67]
ds_write_b64 v46,v[44:45]
v_min3_u32 v27,v27,v224,v228
v_mfma_f32_16x16x32_bf16 v[68:71],a[144:147],v[224:227],v[68:71]
ds_read_b128 v[252:255],v18 offset:30720
buffer_load_dwordx4 v16,s[20:23],s65 offen offset:0 sc1 lds
v_mfma_f32_16x16x32_bf16 v[64:67],a[36:39],v[228:231],v[64:67]
buffer_load_dwordx4 v16,s[20:23],s65 offen offset:2048 sc1 lds
v_mfma_f32_16x16x32_bf16 v[68:71],a[148:151],v[228:231],v[68:71]
ds_read_b128 v[224:227],v18 offset:32768
s_waitcnt lgkmcnt(6)
v_mfma_f32_16x16x32_bf16 v[64:67],a[40:43],v[232:235],v[64:67]
s_xor_b32 m0,s72,32768
v_min3_u32 v27,v27,v232,v236
v_mfma_f32_16x16x32_bf16 v[68:71],a[152:155],v[232:235],v[68:71]
ds_read_b128 v[228:231],v18 offset:34816
v_mfma_f32_16x16x32_bf16 v[64:67],a[44:47],v[236:239],v[64:67]
s_add_u32 s65,s88,65536
v_mfma_f32_16x16x32_bf16 v[68:71],a[156:159],v[236:239],v[68:71]
ds_read_b128 v[232:235],v18 offset:36864
s_waitcnt lgkmcnt(6)
v_mfma_f32_16x16x32_bf16 v[64:67],a[48:51],v[240:243],v[64:67]
buffer_load_dwordx4 v16,s[20:23],s65 offen offset:0 sc1 lds
v_mfma_f32_16x16x32_bf16 v[68:71],a[160:163],v[240:243],v[68:71]
ds_read_b128 v[236:239],v18 offset:38912
v_min3_u32 v27,v27,v240,v244
v_mfma_f32_16x16x32_bf16 v[64:67],a[52:55],v[244:247],v[64:67]
buffer_load_dwordx4 v16,s[20:23],s65 offen offset:2048 sc1 lds
v_mfma_f32_16x16x32_bf16 v[68:71],a[164:167],v[244:247],v[68:71]
ds_read_b128 v[240:243],v18 offset:40960
s_waitcnt lgkmcnt(5)
v_mfma_f32_16x16x32_bf16 v[64:67],a[56:59],v[248:251],v[64:67]
s_xor_b32 m0,s72,49152
v_min3_u32 v27,v27,v248,v252
v_mfma_f32_16x16x32_bf16 v[68:71],a[168:171],v[248:251],v[68:71]
ds_read_b128 v[244:247],v18 offset:43008
s_add_u32 s65,s88,s86
v_mfma_f32_16x16x32_bf16 v[64:67],a[60:63],v[252:255],v[64:67]
buffer_load_dwordx2 v[122:123],v24,s[20:23],s70 offen sc1
v_mfma_f32_16x16x32_bf16 v[68:71],a[172:175],v[252:255],v[68:71]
ds_read_b128 v[248:251],v18 offset:45056
s_waitcnt lgkmcnt(5)
v_mfma_f32_16x16x32_bf16 v[64:67],a[64:67],v[224:227],v[64:67]
s_waitcnt vmcnt(14)
s_barrier
ds_read_b64 v[44:45],v47
ds_read_b128 v[128:131],v17 offset:0
ds_read_b128 v[132:135],v17 offset:2048
v_mfma_f32_16x16x32_bf16 v[68:71],a[176:179],v[224:227],v[68:71]
ds_read_b128 v[252:255],v18 offset:47104
buffer_load_dwordx4 v16,s[20:23],s65 offen offset:0 sc1 lds
v_min3_u32 v27,v27,v224,v228
v_mfma_f32_16x16x32_bf16 v[64:67],a[68:71],v[228:231],v[64:67]
ds_read_b128 v[136:139],v17 offset:4096
buffer_load_dwordx4 v16,s[20:23],s65 offen offset:2048 sc1 lds
v_mfma_f32_16x16x32_bf16 v[68:71],a[180:183],v[228:231],v[68:71]
ds_read_b128 v[224:227],v18 offset:49152
s_xor_b32 m0,s72,1024
s_waitcnt lgkmcnt(9)
v_mfma_f32_16x16x32_bf16 v[64:67],a[72:75],v[232:235],v[64:67]
ds_read_b128 v[140:143],v17 offset:6144
v_min3_u32 v27,v27,v232,v236
v_mfma_f32_16x16x32_bf16 v[68:71],a[184:187],v[232:235],v[68:71]
ds_read_b128 v[228:231],v18 offset:51200
s_add_u32 s65,s89,0
v_mfma_f32_16x16x32_bf16 v[64:67],a[76:79],v[236:239],v[64:67]
ds_read_b128 v[144:147],v17 offset:8192
ds_read_b128 v[148:151],v17 offset:10240
v_mfma_f32_16x16x32_bf16 v[68:71],a[188:191],v[236:239],v[68:71]
ds_read_b128 v[232:235],v18 offset:53248
s_waitcnt lgkmcnt(12)
v_mfma_f32_16x16x32_bf16 v[64:67],a[80:83],v[240:243],v[64:67]
ds_read_b128 v[152:155],v17 offset:12288
s_waitcnt lgkmcnt(11)
v_min3_u32 v27,v27,v240,v244
v_mfma_f32_16x16x32_bf16 v[68:71],a[192:195],v[240:243],v[68:71]
ds_read_b128 v[236:239],v18 offset:55296
v_readfirstlane_b32 s93,v45
v_mfma_f32_16x16x32_bf16 v[64:67],a[84:87],v[244:247],v[64:67]
ds_read_b128 v[156:159],v17 offset:14336
buffer_load_dwordx4 v16,s[20:23],s65 offen offset:0 sc1 lds
v_mfma_f32_16x16x32_bf16 v[68:71],a[196:199],v[244:247],v[68:71]
buffer_load_dwordx4 v16,s[20:23],s65 offen offset:2048 sc1 lds
s_waitcnt lgkmcnt(10)
v_mfma_f32_16x16x32_bf16 v[64:67],a[88:91],v[248:251],v[64:67]
ds_read_b128 v[160:163],v17 offset:16384
ds_read_b128 v[164:167],v17 offset:18432
s_xor_b32 m0,s72,17408
v_mfma_f32_16x16x32_bf16 v[68:71],a[200:203],v[248:251],v[68:71]
s_add_u32 s65,s89,32768
v_min3_u32 v27,v27,v248,v252
v_mfma_f32_16x16x32_bf16 v[64:67],a[92:95],v[252:255],v[64:67]
ds_read_b128 v[168:171],v17 offset:20480
buffer_load_dwordx4 v16,s[20:23],s65 offen offset:0 sc1 lds
v_mfma_f32_16x16x32_bf16 v[68:71],a[204:207],v[252:255],v[68:71]
s_waitcnt lgkmcnt(9)
v_mfma_f32_16x16x32_bf16 v[64:67],a[96:99],v[224:227],v[64:67]
ds_read_b128 v[172:175],v17 offset:22528
buffer_load_dwordx4 v16,s[20:23],s65 offen offset:2048 sc1 lds
v_mfma_f32_16x16x32_bf16 v[68:71],a[208:211],v[224:227],v[68:71]
v_min3_u32 v27,v27,v224,v228
v_min3_u32 v27,v27,v226,v230
v_mfma_f32_16x16x32_bf16 v[64:67],a[100:103],v[228:231],v[64:67]
ds_read_b128 v[176:179],v17 offset:24576
ds_read_b128 v[180:183],v17 offset:26624
s_xor_b32 m0,s72,33792
v_mfma_f32_16x16x32_bf16 v[68:71],a[212:215],v[228:231],v[68:71]
s_waitcnt lgkmcnt(7)
v_mfma_f32_16x16x32_bf16 v[64:67],a[104:107],v[232:235],v[64:67]
ds_read_b128 v[184:187],v17 offset:28672
s_add_u32 s65,s89,65536
v_min3_u32 v27,v27,v232,v236
v_mfma_f32_16x16x32_bf16 v[68:71],a[216:219],v[232:235],v[68:71]
buffer_load_dwordx4 v16,s[20:23],s65 offen offset:0 sc1 lds
v_mfma_f32_16x16x32_bf16 v[64:67],a[108:111],v[236:239],v[64:67]
ds_read_b128 v[188:191],v17 offset:30720
v_min3_u32 v27,v27,v234,v238
v_mfma_f32_16x16x32_bf16 v[68:71],a[220:223],v[236:239],v[68:71]
buffer_load_dwordx4 v16,s[20:23],s65 offen offset:2048 sc1 lds
v_mfma_f32_16x16x32_bf16 v[72:75],a[112:115],v[128:131],0
v_cmp_eq_u32 vcc,0,v27
s_cbranch_vccnz retry_324
v_mfma_f32_16x16x32_bf16 v[76:79],a[116:119],v[132:135],0
s_xor_b32 m0,s72,50176
v_min3_u32 v27,v27,v128,v132
v_mfma_f32_16x16x32_bf16 v[72:75],a[120:123],v[136:139],v[72:75]
ds_read_b128 v[192:195],v17 offset:32768
v_mfma_f32_16x16x32_bf16 v[76:79],a[124:127],v[140:143],v[76:79]
ds_read_b128 v[196:199],v17 offset:34816
s_add_u32 s65,s89,s86
s_waitcnt lgkmcnt(10)
v_mfma_f32_16x16x32_bf16 v[72:75],a[128:131],v[144:147],v[72:75]
ds_read_b128 v[200:203],v17 offset:36864
v_min3_u32 v27,v27,v136,v140
s_waitcnt vmcnt(8)
v_mfma_f32_16x16x32_bf16 v[76:79],a[132:135],v[148:151],v[76:79]
ds_read_b128 v[204:207],v17 offset:38912
buffer_load_dwordx4 v16,s[20:23],s65 offen offset:0 sc1 lds
v_mfma_f32_16x16x32_bf16 v[72:75],a[136:139],v[152:155],v[72:75]
ds_read_b128 v[208:211],v17 offset:40960
v_min3_u32 v27,v27,v144,v148
v_and_or_b32 v64,v64,-4,s48
v_mfma_f32_16x16x32_bf16 v[76:79],a[140:143],v[156:159],v[76:79]
buffer_load_dwordx4 v16,s[20:23],s65 offen offset:2048 sc1 lds
s_waitcnt lgkmcnt(9)
v_mfma_f32_16x16x32_bf16 v[72:75],a[144:147],v[160:163],v[72:75]
ds_read_b128 v[212:215],v17 offset:43008
v_min3_u32 v27,v27,v152,v156
s_add_u32 s64,s49,s34
v_mfma_f32_16x16x32_bf16 v[76:79],a[148:151],v[164:167],v[76:79]
ds_read_b128 v[216:219],v17 offset:45056
v_min3_u32 v27,v27,v160,v164
v_mfma_f32_16x16x32_bf16 v[72:75],a[152:155],v[168:171],v[72:75]
ds_read_b128 v[220:223],v17 offset:47104
buffer_store_dwordx4 v[64:67],v25,s[20:23],s64 offen offset:2048
v_mfma_f32_16x16x32_bf16 v[76:79],a[156:159],v[172:175],v[76:79]
ds_read_b128 v[224:227],v17 offset:49152
v_and_or_b32 v68,v68,-4,s48
s_waitcnt lgkmcnt(9)
v_mfma_f32_16x16x32_bf16 v[72:75],a[160:163],v[176:179],v[72:75]
ds_read_b128 v[228:231],v17 offset:51200
v_min3_u32 v27,v27,v168,v172
s_add_u32 s64,s49,s35
v_mfma_f32_16x16x32_bf16 v[76:79],a[164:167],v[180:183],v[76:79]
v_min3_u32 v27,v27,v176,v180
buffer_store_dwordx4 v[68:71],v25,s[20:23],s64 offen offset:3072
v_mfma_f32_16x16x32_bf16 v[72:75],a[168:171],v[184:187],v[72:75]
ds_read_b128 v[232:235],v17 offset:53248
s_mov_b32 s49,0x7fff0000
v_mfma_f32_16x16x32_bf16 v[76:79],a[172:175],v[188:191],v[76:79]
ds_read_b128 v[236:239],v17 offset:55296
s_waitcnt lgkmcnt(8)
v_mfma_f32_16x16x32_bf16 v[72:75],a[176:179],v[192:195],v[72:75]
v_min3_u32 v27,v27,v184,v188
v_mfma_f32_16x16x32_bf16 v[76:79],a[180:183],v[196:199],v[76:79]
v_min3_u32 v27,v27,v192,v196
ds_bpermute_b32 v124,v41,v120
v_mfma_f32_16x16x32_bf16 v[72:75],a[184:187],v[200:203],v[72:75]
v_mfma_f32_16x16x32_bf16 v[76:79],a[188:191],v[204:207],v[76:79]
v_min3_u32 v27,v27,v200,v204
s_waitcnt lgkmcnt(5)
v_mfma_f32_16x16x32_bf16 v[72:75],a[192:195],v[208:211],v[72:75]
ds_bpermute_b32 v125,v41,v121
v_mfma_f32_16x16x32_bf16 v[76:79],a[196:199],v[212:215],v[76:79]
v_min3_u32 v27,v27,v208,v212
v_lshlrev_b32 v108,16,v122
v_mfma_f32_16x16x32_bf16 v[72:75],a[200:203],v[216:219],v[72:75]
v_mfma_f32_16x16x32_bf16 v[76:79],a[204:207],v[220:223],v[76:79]
v_min3_u32 v27,v27,v216,v220
s_waitcnt lgkmcnt(2)
v_mfma_f32_16x16x32_bf16 v[72:75],a[208:211],v[224:227],v[72:75]
v_and_b32 v109,s80,v122
v_mfma_f32_16x16x32_bf16 v[76:79],a[212:215],v[228:231],v[76:79]
v_min3_u32 v27,v27,v224,v228
v_min3_u32 v27,v27,v226,v230
v_mfma_f32_16x16x32_bf16 v[72:75],a[216:219],v[232:235],v[72:75]
v_lshlrev_b32 v110,16,v123
v_mfma_f32_16x16x32_bf16 v[76:79],a[220:223],v[236:239],v[76:79]
v_min3_u32 v27,v27,v232,v236
v_min3_u32 v27,v27,v234,v238
v_mfma_f32_16x16x32_bf16 v[80:83],a[0:3],v[128:131],0
v_cmp_eq_u32 vcc,0,v27
s_cbranch_vccnz retry_324
v_mfma_f32_16x16x32_bf16 v[84:87],a[4:7],v[132:135],0
v_and_b32 v111,s80,v123
s_waitcnt lgkmcnt(0)
v_mfma_f32_16x16x32_bf16 v[80:83],a[8:11],v[136:139],v[80:83]
v_mfma_f32_16x16x32_bf16 v[84:87],a[12:15],v[140:143],v[84:87]
v_lshlrev_b32 v104,16,v124
v_mfma_f32_16x16x32_bf16 v[80:83],a[16:19],v[144:147],v[80:83]
v_add_f32 v72,v72,v76
v_add_f32 v73,v73,v77
v_mfma_f32_16x16x32_bf16 v[84:87],a[20:23],v[148:151],v[84:87]
v_and_b32 v105,s80,v124
v_add_f32 v74,v74,v78
v_mfma_f32_16x16x32_bf16 v[80:83],a[24:27],v[152:155],v[80:83]
v_add_f32 v75,v75,v79
v_and_or_b32 v72,v72,-4,s48
v_mfma_f32_16x16x32_bf16 v[84:87],a[28:31],v[156:159],v[84:87]
v_lshlrev_b32 v106,16,v125
s_add_u32 s64,s77,s33
v_mfma_f32_16x16x32_bf16 v[80:83],a[32:35],v[160:163],v[80:83]
buffer_store_dwordx4 v[72:75],v25,s[20:23],s64 offen offset:1024
v_mfma_f32_16x16x32_bf16 v[84:87],a[36:39],v[164:167],v[84:87]
v_and_b32 v107,s80,v125
v_mfma_f32_16x16x32_bf16 v[80:83],a[40:43],v[168:171],v[80:83]
v_mfma_f32_16x16x32_bf16 v[84:87],a[44:47],v[172:175],v[84:87]
v_mfma_f32_16x16x32_bf16 v[80:83],a[48:51],v[176:179],v[80:83]
buffer_load_dwordx4 v[96:99],v26,s[20:23],s77 offen offset:2048 sc1
v_mfma_f32_16x16x32_bf16 v[84:87],a[52:55],v[180:183],v[84:87]
buffer_load_dwordx4 v[100:103],v26,s[20:23],s77 offen offset:3072 sc1
v_mfma_f32_16x16x32_bf16 v[80:83],a[56:59],v[184:187],v[80:83]
v_mfma_f32_16x16x32_bf16 v[84:87],a[60:63],v[188:191],v[84:87]
v_mfma_f32_16x16x32_bf16 v[80:83],a[64:67],v[192:195],v[80:83]
v_mfma_f32_16x16x32_bf16 v[84:87],a[68:71],v[196:199],v[84:87]
v_mfma_f32_16x16x32_bf16 v[80:83],a[72:75],v[200:203],v[80:83]
v_mfma_f32_16x16x32_bf16 v[84:87],a[76:79],v[204:207],v[84:87]
v_mfma_f32_16x16x32_bf16 v[80:83],a[80:83],v[208:211],v[80:83]
v_mfma_f32_16x16x32_bf16 v[84:87],a[84:87],v[212:215],v[84:87]
v_mfma_f32_16x16x32_bf16 v[80:83],a[88:91],v[216:219],v[80:83]
buffer_load_dwordx4 v[92:95],v26,s[20:23],s77 offen offset:1024 sc1
v_mfma_f32_16x16x32_bf16 v[84:87],a[92:95],v[220:223],v[84:87]
v_mfma_f32_16x16x32_bf16 v[80:83],a[96:99],v[224:227],v[80:83]
v_mfma_f32_16x16x32_bf16 v[84:87],a[100:103],v[228:231],v[84:87]
v_mfma_f32_16x16x32_bf16 v[80:83],a[104:107],v[232:235],v[80:83]
v_mfma_f32_16x16x32_bf16 v[84:87],a[108:111],v[236:239],v[84:87]
epi_327:
buffer_load_dword v29,v21,s[20:23],s87 offen sc1
s_nop 6
v_pk_add_f32 v[88:89],v[80:81],v[84:85]
v_pk_add_f32 v[90:91],v[82:83],v[86:87]
v_pk_add_f32 v[88:89],v[88:89],v[108:109]
v_pk_add_f32 v[90:91],v[90:91],v[110:111]
s_waitcnt vmcnt(1)
s_branch ic_339
ip_337:
buffer_load_dwordx4 v[92:95],v26,s[20:23],s77 offen offset:1024 sc1
buffer_load_dwordx4 v[96:99],v26,s[20:23],s77 offen offset:2048 sc1
buffer_load_dwordx4 v[100:103],v26,s[20:23],s77 offen offset:3072 sc1
s_waitcnt vmcnt(0)
ic_339:
v_bitop3_b32 v22,v92,v96,v100 bitop3:0x80
v_and_b32 v22,s48,v22
v_cmp_eq_u32 vcc,0,v22
s_cbranch_vccz ik_338
s_sub_u32 s90,s90,1
s_cmp_gt_i32 s90,0
s_cbranch_scc1 ip_337
ik_338:
s_cmp_lg_u32 s71,65
s_cbranch_scc1 nl_340
buffer_load_dwordx4 v[132:135],v26,s[20:23],s40 offen offset:1024 sc1
buffer_load_dwordx4 v[136:139],v26,s[20:23],s40 offen offset:2048 sc1
buffer_load_dwordx4 v[140:143],v26,s[20:23],s40 offen offset:3072 sc1
nl_340:
v_pk_add_f32 v[88:89],v[88:89],v[92:93]
v_pk_add_f32 v[96:97],v[96:97],v[100:101]
v_pk_add_f32 v[90:91],v[90:91],v[94:95]
v_pk_add_f32 v[98:99],v[98:99],v[102:103]
v_pk_add_f32 v[88:89],v[88:89],v[96:97]
v_pk_add_f32 v[90:91],v[90:91],v[98:99]
v_pk_fma_f32 v[88:89],v[88:89],v[52:53],v[104:105]
v_pk_fma_f32 v[90:91],v[90:91],v[54:55],v[106:107]
v_cvt_pk_bf16_f32 v88,v88,v89
v_cvt_pk_bf16_f32 v89,v90,v91
ds_bpermute_b32 v88,v40,v88
ds_bpermute_b32 v89,v40,v89
v_xor_b32 v18,0x10000,v18
s_xor_b32 s49,s77,524288
s_cselect_b32 s64,0,3
s_xor_b32 s48,s48,s64
s_cmp_eq_u32 s71,63
s_cselect_b32 s64,0,0x2000
s_cselect_b32 s66,2,1
s_cmp_eq_u32 s71,64
s_cselect_b32 s66,-1,s66
v_xor_b32 v20,s64,v20
s_lshl_b32 s64,s66,21
s_add_u32 s76,s76,s64
s_lshl_b32 s66,s66,16
s_waitcnt lgkmcnt(0)
s_mov_b64 exec,s[84:85]
buffer_store_dwordx2 v[88:89],v19,s[36:39],s78 offen
s_mov_b64 exec,-1
s_mov_b64 s[84:85],-1
s_mov_b32 s77,s49
s_add_u32 s78,s78,s66
next_334:
v_xor_b32 v17,0x10000,v17
s_xor_b32 s72,s72,0x10000
s_add_u32 s70,s70,2097152
s_xor_b32 s70,s70,0x2000
s_add_u32 s71,s71,1
s_cmp_le_u32 s71,s57
s_cbranch_scc1 seg_325
s_cmp_lg_u32 s43,0
s_cbranch_scc1 hn_344
s_waitcnt vmcnt(1)
s_branch hc_343
hp_341:
buffer_load_dwordx4 v[132:135],v26,s[20:23],s40 offen offset:1024 sc1
buffer_load_dwordx4 v[136:139],v26,s[20:23],s40 offen offset:2048 sc1
buffer_load_dwordx4 v[140:143],v26,s[20:23],s40 offen offset:3072 sc1
s_waitcnt vmcnt(0)
hc_343:
v_bitop3_b32 v22,v132,v136,v140 bitop3:0x80
v_and_b32 v22,s60,v22
v_cmp_eq_u32 vcc,0,v22
s_cbranch_vccz hk_342
s_sub_u32 s90,s90,1
s_cmp_gt_i32 s90,0
s_cbranch_scc1 hp_341
hk_342:
v_pk_add_f32 v[112:113],v[112:113],v[132:133]
v_pk_add_f32 v[136:137],v[136:137],v[140:141]
v_pk_add_f32 v[114:115],v[114:115],v[134:135]
v_pk_add_f32 v[138:139],v[138:139],v[142:143]
v_pk_add_f32 v[112:113],v[112:113],v[136:137]
v_pk_add_f32 v[114:115],v[114:115],v[138:139]
v_pk_fma_f32 v[112:113],v[112:113],v[52:53],v[116:117]
v_pk_fma_f32 v[114:115],v[114:115],v[54:55],v[118:119]
v_cvt_pk_bf16_f32 v112,v112,v113
v_cvt_pk_bf16_f32 v113,v114,v115
ds_bpermute_b32 v112,v40,v112
ds_bpermute_b32 v113,v40,v113
s_mov_b32 s64,4194304
s_waitcnt lgkmcnt(0)
buffer_store_dwordx2 v[112:113],v19,s[36:39],s64 offen
hn_344:
s_endpgm
retry_324:
s_sub_u32 s90,s90,64
s_cmp_lt_i32 s90,0
s_cbranch_scc1 giveup_197
s_mov_b32 s83,1
s_waitcnt vmcnt(0) lgkmcnt(0)
s_barrier
s_branch seg_325
half_333:
s_cmp_eq_u32 s43,0
s_cbranch_scc1 hown_345
s_mov_b64 exec,s[52:53]
s_xor_b32 m0,s91,0
s_add_u32 s65,s94,0
buffer_load_dwordx4 v16,s[20:23],s65 offen offset:0 sc1 lds
buffer_load_dwordx4 v16,s[20:23],s65 offen offset:2048 sc1 lds
s_xor_b32 m0,s91,16384
s_add_u32 s65,s94,32768
buffer_load_dwordx4 v16,s[20:23],s65 offen offset:0 sc1 lds
buffer_load_dwordx4 v16,s[20:23],s65 offen offset:2048 sc1 lds
s_xor_b32 m0,s91,32768
s_add_u32 s65,s94,65536
buffer_load_dwordx4 v16,s[20:23],s65 offen offset:0 sc1 lds
buffer_load_dwordx4 v16,s[20:23],s65 offen offset:2048 sc1 lds
s_xor_b32 m0,s91,49152
s_add_u32 s65,s94,s86
buffer_load_dwordx4 v16,s[20:23],s65 offen offset:0 sc1 lds
buffer_load_dwordx4 v16,s[20:23],s65 offen offset:2048 sc1 lds
s_mov_b64 exec,-1
h2a_346:
s_waitcnt vmcnt(6)
s_barrier
ds_read_b128 v[224:227],v18 offset:0
ds_read_b128 v[228:231],v18 offset:2048
ds_read_b128 v[232:235],v18 offset:4096
ds_read_b128 v[236:239],v18 offset:6144
ds_read_b128 v[240:243],v18 offset:8192
ds_read_b128 v[244:247],v18 offset:10240
ds_read_b128 v[248:251],v18 offset:12288
s_waitcnt lgkmcnt(5)
v_mfma_f32_16x16x32_bf16 v[64:67],a[0:3],v[224:227],0
v_min_u32 v27,v224,v228
v_mfma_f32_16x16x32_bf16 v[68:71],a[112:115],v[224:227],0
ds_read_b128 v[252:255],v18 offset:14336
v_mfma_f32_16x16x32_bf16 v[64:67],a[4:7],v[228:231],v[64:67]
v_mfma_f32_16x16x32_bf16 v[68:71],a[116:119],v[228:231],v[68:71]
s_waitcnt vmcnt(4)
s_barrier
ds_read_b128 v[224:227],v18 offset:16384
s_waitcnt lgkmcnt(5)
v_mfma_f32_16x16x32_bf16 v[64:67],a[8:11],v[232:235],v[64:67]
v_min3_u32 v27,v27,v232,v236
v_mfma_f32_16x16x32_bf16 v[68:71],a[120:123],v[232:235],v[68:71]
ds_read_b128 v[228:231],v18 offset:18432
v_mfma_f32_16x16x32_bf16 v[64:67],a[12:15],v[236:239],v[64:67]
v_mfma_f32_16x16x32_bf16 v[68:71],a[124:127],v[236:239],v[68:71]
ds_read_b128 v[232:235],v18 offset:20480
s_waitcnt lgkmcnt(5)
v_mfma_f32_16x16x32_bf16 v[64:67],a[16:19],v[240:243],v[64:67]
v_min3_u32 v27,v27,v240,v244
v_mfma_f32_16x16x32_bf16 v[68:71],a[128:131],v[240:243],v[68:71]
ds_read_b128 v[236:239],v18 offset:22528
v_mfma_f32_16x16x32_bf16 v[64:67],a[20:23],v[244:247],v[64:67]
v_mfma_f32_16x16x32_bf16 v[68:71],a[132:135],v[244:247],v[68:71]
ds_read_b128 v[240:243],v18 offset:24576
s_waitcnt lgkmcnt(5)
v_mfma_f32_16x16x32_bf16 v[64:67],a[24:27],v[248:251],v[64:67]
v_min3_u32 v27,v27,v248,v252
v_mfma_f32_16x16x32_bf16 v[68:71],a[136:139],v[248:251],v[68:71]
ds_read_b128 v[244:247],v18 offset:26624
v_mfma_f32_16x16x32_bf16 v[64:67],a[28:31],v[252:255],v[64:67]
v_mfma_f32_16x16x32_bf16 v[68:71],a[140:143],v[252:255],v[68:71]
ds_read_b128 v[248:251],v18 offset:28672
s_waitcnt lgkmcnt(5)
v_mfma_f32_16x16x32_bf16 v[64:67],a[32:35],v[224:227],v[64:67]
v_min3_u32 v27,v27,v224,v228
v_mfma_f32_16x16x32_bf16 v[68:71],a[144:147],v[224:227],v[68:71]
ds_read_b128 v[252:255],v18 offset:30720
v_mfma_f32_16x16x32_bf16 v[64:67],a[36:39],v[228:231],v[64:67]
v_mfma_f32_16x16x32_bf16 v[68:71],a[148:151],v[228:231],v[68:71]
s_waitcnt vmcnt(0)
s_barrier
ds_read_b128 v[224:227],v18 offset:32768
s_waitcnt lgkmcnt(5)
v_mfma_f32_16x16x32_bf16 v[64:67],a[40:43],v[232:235],v[64:67]
v_min3_u32 v27,v27,v232,v236
v_mfma_f32_16x16x32_bf16 v[68:71],a[152:155],v[232:235],v[68:71]
ds_read_b128 v[228:231],v18 offset:34816
v_mfma_f32_16x16x32_bf16 v[64:67],a[44:47],v[236:239],v[64:67]
v_mfma_f32_16x16x32_bf16 v[68:71],a[156:159],v[236:239],v[68:71]
ds_read_b128 v[232:235],v18 offset:36864
s_waitcnt lgkmcnt(5)
v_mfma_f32_16x16x32_bf16 v[64:67],a[48:51],v[240:243],v[64:67]
v_min3_u32 v27,v27,v240,v244
v_mfma_f32_16x16x32_bf16 v[68:71],a[160:163],v[240:243],v[68:71]
ds_read_b128 v[236:239],v18 offset:38912
v_mfma_f32_16x16x32_bf16 v[64:67],a[52:55],v[244:247],v[64:67]
v_mfma_f32_16x16x32_bf16 v[68:71],a[164:167],v[244:247],v[68:71]
ds_read_b128 v[240:243],v18 offset:40960
s_waitcnt lgkmcnt(5)
v_mfma_f32_16x16x32_bf16 v[64:67],a[56:59],v[248:251],v[64:67]
v_min3_u32 v27,v27,v248,v252
v_mfma_f32_16x16x32_bf16 v[68:71],a[168:171],v[248:251],v[68:71]
ds_read_b128 v[244:247],v18 offset:43008
v_mfma_f32_16x16x32_bf16 v[64:67],a[60:63],v[252:255],v[64:67]
v_mfma_f32_16x16x32_bf16 v[68:71],a[172:175],v[252:255],v[68:71]
ds_read_b128 v[248:251],v18 offset:45056
s_waitcnt lgkmcnt(5)
v_mfma_f32_16x16x32_bf16 v[64:67],a[64:67],v[224:227],v[64:67]
v_min3_u32 v27,v27,v224,v228
v_mfma_f32_16x16x32_bf16 v[68:71],a[176:179],v[224:227],v[68:71]
ds_read_b128 v[252:255],v18 offset:47104
v_mfma_f32_16x16x32_bf16 v[64:67],a[68:71],v[228:231],v[64:67]
v_mfma_f32_16x16x32_bf16 v[68:71],a[180:183],v[228:231],v[68:71]
ds_read_b128 v[224:227],v18 offset:49152
s_waitcnt lgkmcnt(5)
v_mfma_f32_16x16x32_bf16 v[64:67],a[72:75],v[232:235],v[64:67]
v_min3_u32 v27,v27,v232,v236
v_mfma_f32_16x16x32_bf16 v[68:71],a[184:187],v[232:235],v[68:71]
ds_read_b128 v[228:231],v18 offset:51200
v_mfma_f32_16x16x32_bf16 v[64:67],a[76:79],v[236:239],v[64:67]
v_mfma_f32_16x16x32_bf16 v[68:71],a[188:191],v[236:239],v[68:71]
ds_read_b128 v[232:235],v18 offset:53248
s_waitcnt lgkmcnt(5)
v_mfma_f32_16x16x32_bf16 v[64:67],a[80:83],v[240:243],v[64:67]
v_min3_u32 v27,v27,v240,v244
v_mfma_f32_16x16x32_bf16 v[68:71],a[192:195],v[240:243],v[68:71]
ds_read_b128 v[236:239],v18 offset:55296
v_mfma_f32_16x16x32_bf16 v[64:67],a[84:87],v[244:247],v[64:67]
v_mfma_f32_16x16x32_bf16 v[68:71],a[196:199],v[244:247],v[68:71]
s_waitcnt lgkmcnt(4)
v_mfma_f32_16x16x32_bf16 v[64:67],a[88:91],v[248:251],v[64:67]
v_min3_u32 v27,v27,v248,v252
v_mfma_f32_16x16x32_bf16 v[68:71],a[200:203],v[248:251],v[68:71]
v_mfma_f32_16x16x32_bf16 v[64:67],a[92:95],v[252:255],v[64:67]
v_mfma_f32_16x16x32_bf16 v[68:71],a[204:207],v[252:255],v[68:71]
s_waitcnt lgkmcnt(2)
v_mfma_f32_16x16x32_bf16 v[64:67],a[96:99],v[224:227],v[64:67]
v_min3_u32 v27,v27,v224,v228
v_min3_u32 v27,v27,v226,v230
v_mfma_f32_16x16x32_bf16 v[68:71],a[208:211],v[224:227],v[68:71]
v_mfma_f32_16x16x32_bf16 v[64:67],a[100:103],v[228:231],v[64:67]
v_mfma_f32_16x16x32_bf16 v[68:71],a[212:215],v[228:231],v[68:71]
s_waitcnt lgkmcnt(0)
v_mfma_f32_16x16x32_bf16 v[64:67],a[104:107],v[232:235],v[64:67]
v_min3_u32 v27,v27,v232,v236
v_min3_u32 v27,v27,v234,v238
v_mfma_f32_16x16x32_bf16 v[68:71],a[216:219],v[232:235],v[68:71]
v_mfma_f32_16x16x32_bf16 v[64:67],a[108:111],v[236:239],v[64:67]
v_mfma_f32_16x16x32_bf16 v[68:71],a[220:223],v[236:239],v[68:71]
v_cmp_eq_u32 vcc,0,v27
s_and_b64 vcc,vcc,s[52:53]
s_cbranch_vccnz retry_324
buffer_load_dword v29,v21,s[20:23],s87 offen sc1
s_mov_b32 s40,0x7fff0000
s_nop 5
v_and_or_b32 v64,v64,-4,s48
s_add_u32 s64,s77,s34
buffer_store_dwordx4 v[64:67],v25,s[20:23],s64 offen offset:2048
v_and_or_b32 v68,v68,-4,s48
s_add_u32 s64,s77,s35
buffer_store_dwordx4 v[68:71],v25,s[20:23],s64 offen offset:3072
hjoin_348:
v_xor_b32 v18,0x10000,v18
s_xor_b32 s49,s77,524288
s_cselect_b32 s64,0,3
s_xor_b32 s48,s48,s64
v_xor_b32 v20,0x2000,v20
s_sub_u32 s76,s76,2097152
s_mov_b32 s77,s49
s_sub_u32 s78,s78,65536
s_branch next_334
half2_330:
s_cmp_eq_u32 s43,0
s_cbranch_scc1 h2b_347
s_branch h2a_346
hown_345:
s_mov_b64 exec,s[52:53]
s_xor_b32 m0,s91,1024
s_add_u32 s65,s95,0
buffer_load_dwordx4 v16,s[20:23],s65 offen offset:0 sc1 lds
buffer_load_dwordx4 v16,s[20:23],s65 offen offset:2048 sc1 lds
s_xor_b32 m0,s91,17408
s_add_u32 s65,s95,32768
buffer_load_dwordx4 v16,s[20:23],s65 offen offset:0 sc1 lds
buffer_load_dwordx4 v16,s[20:23],s65 offen offset:2048 sc1 lds
s_xor_b32 m0,s91,33792
s_add_u32 s65,s95,65536
buffer_load_dwordx4 v16,s[20:23],s65 offen offset:0 sc1 lds
buffer_load_dwordx4 v16,s[20:23],s65 offen offset:2048 sc1 lds
s_xor_b32 m0,s91,50176
s_add_u32 s65,s95,s86
buffer_load_dwordx4 v16,s[20:23],s65 offen offset:0 sc1 lds
buffer_load_dwordx4 v16,s[20:23],s65 offen offset:2048 sc1 lds
s_mov_b64 exec,-1
h2b_347:
buffer_load_dwordx2 v[120:121],v20,s[20:23],s76 offen sc1
buffer_load_dwordx2 v[122:123],v24,s[20:23],s70 offen sc1
s_waitcnt vmcnt(8)
s_barrier
ds_read_b128 v[128:131],v17 offset:0
ds_read_b128 v[132:135],v17 offset:2048
ds_read_b128 v[136:139],v17 offset:4096
ds_read_b128 v[140:143],v17 offset:6144
ds_read_b128 v[144:147],v17 offset:8192
ds_read_b128 v[148:151],v17 offset:10240
ds_read_b128 v[152:155],v17 offset:12288
s_waitcnt lgkmcnt(5)
v_mfma_f32_16x16x32_bf16 v[72:75],a[112:115],v[128:131],0
v_min_u32 v27,v128,v132
v_mfma_f32_16x16x32_bf16 v[80:83],a[0:3],v[128:131],0
ds_read_b128 v[156:159],v17 offset:14336
v_mfma_f32_16x16x32_bf16 v[76:79],a[116:119],v[132:135],0
v_mfma_f32_16x16x32_bf16 v[84:87],a[4:7],v[132:135],0
s_waitcnt vmcnt(6)
s_barrier
ds_read_b128 v[160:163],v17 offset:16384
s_waitcnt lgkmcnt(5)
v_mfma_f32_16x16x32_bf16 v[72:75],a[120:123],v[136:139],v[72:75]
v_min3_u32 v27,v27,v136,v140
v_mfma_f32_16x16x32_bf16 v[80:83],a[8:11],v[136:139],v[80:83]
ds_read_b128 v[164:167],v17 offset:18432
v_mfma_f32_16x16x32_bf16 v[76:79],a[124:127],v[140:143],v[76:79]
v_mfma_f32_16x16x32_bf16 v[84:87],a[12:15],v[140:143],v[84:87]
ds_read_b128 v[168:171],v17 offset:20480
s_waitcnt lgkmcnt(5)
v_mfma_f32_16x16x32_bf16 v[72:75],a[128:131],v[144:147],v[72:75]
v_min3_u32 v27,v27,v144,v148
v_mfma_f32_16x16x32_bf16 v[80:83],a[16:19],v[144:147],v[80:83]
ds_read_b128 v[172:175],v17 offset:22528
v_mfma_f32_16x16x32_bf16 v[76:79],a[132:135],v[148:151],v[76:79]
v_mfma_f32_16x16x32_bf16 v[84:87],a[20:23],v[148:151],v[84:87]
ds_read_b128 v[176:179],v17 offset:24576
s_waitcnt lgkmcnt(5)
v_mfma_f32_16x16x32_bf16 v[72:75],a[136:139],v[152:155],v[72:75]
v_min3_u32 v27,v27,v152,v156
v_mfma_f32_16x16x32_bf16 v[80:83],a[24:27],v[152:155],v[80:83]
ds_read_b128 v[180:183],v17 offset:26624
v_mfma_f32_16x16x32_bf16 v[76:79],a[140:143],v[156:159],v[76:79]
v_mfma_f32_16x16x32_bf16 v[84:87],a[28:31],v[156:159],v[84:87]
ds_read_b128 v[184:187],v17 offset:28672
s_waitcnt lgkmcnt(5)
v_mfma_f32_16x16x32_bf16 v[72:75],a[144:147],v[160:163],v[72:75]
v_min3_u32 v27,v27,v160,v164
v_mfma_f32_16x16x32_bf16 v[80:83],a[32:35],v[160:163],v[80:83]
ds_read_b128 v[188:191],v17 offset:30720
v_mfma_f32_16x16x32_bf16 v[76:79],a[148:151],v[164:167],v[76:79]
v_mfma_f32_16x16x32_bf16 v[84:87],a[36:39],v[164:167],v[84:87]
s_waitcnt vmcnt(2)
s_barrier
ds_read_b128 v[192:195],v17 offset:32768
s_waitcnt lgkmcnt(5)
v_mfma_f32_16x16x32_bf16 v[72:75],a[152:155],v[168:171],v[72:75]
v_min3_u32 v27,v27,v168,v172
v_mfma_f32_16x16x32_bf16 v[80:83],a[40:43],v[168:171],v[80:83]
ds_read_b128 v[196:199],v17 offset:34816
v_mfma_f32_16x16x32_bf16 v[76:79],a[156:159],v[172:175],v[76:79]
v_mfma_f32_16x16x32_bf16 v[84:87],a[44:47],v[172:175],v[84:87]
ds_read_b128 v[200:203],v17 offset:36864
s_waitcnt lgkmcnt(5)
v_mfma_f32_16x16x32_bf16 v[72:75],a[160:163],v[176:179],v[72:75]
v_min3_u32 v27,v27,v176,v180
v_mfma_f32_16x16x32_bf16 v[80:83],a[48:51],v[176:179],v[80:83]
ds_read_b128 v[204:207],v17 offset:38912
v_mfma_f32_16x16x32_bf16 v[76:79],a[164:167],v[180:183],v[76:79]
v_mfma_f32_16x16x32_bf16 v[84:87],a[52:55],v[180:183],v[84:87]
ds_read_b128 v[208:211],v17 offset:40960
s_waitcnt lgkmcnt(5)
v_mfma_f32_16x16x32_bf16 v[72:75],a[168:171],v[184:187],v[72:75]
v_min3_u32 v27,v27,v184,v188
v_mfma_f32_16x16x32_bf16 v[80:83],a[56:59],v[184:187],v[80:83]
ds_read_b128 v[212:215],v17 offset:43008
v_mfma_f32_16x16x32_bf16 v[76:79],a[172:175],v[188:191],v[76:79]
v_mfma_f32_16x16x32_bf16 v[84:87],a[60:63],v[188:191],v[84:87]
ds_read_b128 v[216:219],v17 offset:45056
s_waitcnt lgkmcnt(5)
v_mfma_f32_16x16x32_bf16 v[72:75],a[176:179],v[192:195],v[72:75]
v_min3_u32 v27,v27,v192,v196
s_waitcnt vmcnt(0)
v_mfma_f32_16x16x32_bf16 v[80:83],a[64:67],v[192:195],v[80:83]
ds_read_b128 v[220:223],v17 offset:47104
ds_bpermute_b32 v124,v41,v120
v_mfma_f32_16x16x32_bf16 v[76:79],a[180:183],v[196:199],v[76:79]
ds_bpermute_b32 v125,v41,v121
v_lshlrev_b32 v108,16,v122
v_mfma_f32_16x16x32_bf16 v[84:87],a[68:71],v[196:199],v[84:87]
ds_read_b128 v[224:227],v17 offset:49152
s_waitcnt lgkmcnt(7)
v_mfma_f32_16x16x32_bf16 v[72:75],a[184:187],v[200:203],v[72:75]
v_min3_u32 v27,v27,v200,v204
v_and_b32 v109,s80,v122
v_mfma_f32_16x16x32_bf16 v[80:83],a[72:75],v[200:203],v[80:83]
ds_read_b128 v[228:231],v17 offset:51200
v_lshlrev_b32 v110,16,v123
v_mfma_f32_16x16x32_bf16 v[76:79],a[188:191],v[204:207],v[76:79]
v_and_b32 v111,s80,v123
s_waitcnt lgkmcnt(2)
v_mfma_f32_16x16x32_bf16 v[84:87],a[76:79],v[204:207],v[84:87]
ds_read_b128 v[232:235],v17 offset:53248
v_mfma_f32_16x16x32_bf16 v[72:75],a[192:195],v[208:211],v[72:75]
v_min3_u32 v27,v27,v208,v212
v_lshlrev_b32 v104,16,v124
v_mfma_f32_16x16x32_bf16 v[80:83],a[80:83],v[208:211],v[80:83]
ds_read_b128 v[236:239],v17 offset:55296
v_and_b32 v105,s80,v124
v_mfma_f32_16x16x32_bf16 v[76:79],a[196:199],v[212:215],v[76:79]
v_lshlrev_b32 v106,16,v125
v_and_b32 v107,s80,v125
v_mfma_f32_16x16x32_bf16 v[84:87],a[84:87],v[212:215],v[84:87]
v_mfma_f32_16x16x32_bf16 v[72:75],a[200:203],v[216:219],v[72:75]
v_min3_u32 v27,v27,v216,v220
v_mfma_f32_16x16x32_bf16 v[80:83],a[88:91],v[216:219],v[80:83]
v_mfma_f32_16x16x32_bf16 v[76:79],a[204:207],v[220:223],v[76:79]
v_mfma_f32_16x16x32_bf16 v[84:87],a[92:95],v[220:223],v[84:87]
s_waitcnt lgkmcnt(2)
v_mfma_f32_16x16x32_bf16 v[72:75],a[208:211],v[224:227],v[72:75]
v_min3_u32 v27,v27,v224,v228
v_min3_u32 v27,v27,v226,v230
v_mfma_f32_16x16x32_bf16 v[80:83],a[96:99],v[224:227],v[80:83]
v_mfma_f32_16x16x32_bf16 v[76:79],a[212:215],v[228:231],v[76:79]
v_mfma_f32_16x16x32_bf16 v[84:87],a[100:103],v[228:231],v[84:87]
s_waitcnt lgkmcnt(0)
v_mfma_f32_16x16x32_bf16 v[72:75],a[216:219],v[232:235],v[72:75]
v_min3_u32 v27,v27,v232,v236
v_min3_u32 v27,v27,v234,v238
v_mfma_f32_16x16x32_bf16 v[80:83],a[104:107],v[232:235],v[80:83]
v_mfma_f32_16x16x32_bf16 v[76:79],a[220:223],v[236:239],v[76:79]
v_mfma_f32_16x16x32_bf16 v[84:87],a[108:111],v[236:239],v[84:87]
v_cmp_eq_u32 vcc,0,v27
s_and_b64 vcc,vcc,s[52:53]
s_cbranch_vccnz retry_324
buffer_load_dword v29,v21,s[20:23],s87 offen sc1
s_nop 6
v_add_f32 v72,v72,v76
v_add_f32 v73,v73,v77
v_add_f32 v74,v74,v78
v_add_f32 v75,v75,v79
v_and_or_b32 v72,v72,-4,s48
s_add_u32 s64,s77,s33
buffer_store_dwordx4 v[72:75],v25,s[20:23],s64 offen offset:1024
v_pk_add_f32 v[112:113],v[80:81],v[84:85]
v_pk_add_f32 v[112:113],v[112:113],v[108:109]
v_pk_add_f32 v[114:115],v[82:83],v[86:87]
v_pk_add_f32 v[114:115],v[114:115],v[110:111]
v_mov_b32 v116,v104
v_mov_b32 v117,v105
v_mov_b32 v118,v106
v_mov_b32 v119,v107
s_mov_b32 s40,s77
s_mov_b32 s60,s48
s_branch hjoin_348
kslow_323:
s_add_u32 s64,s79,0
s_lshl_b32 s70,s64,21
s_lshl_b32 s64,s64,13
s_and_b32 s64,s64,0x2000
s_xor_b32 s64,s64,s62
s_add_u32 s70,s70,s64
s_add_u32 s70,s70,29360128
s_mov_b32 s83,1
s_mov_b32 s87,s74
s_cmp_eq_u32 s50,0
s_cselect_b32 s74,s74,0x7fff0000
v_mov_b32 v47,132096
s_lshl_b32 s64,s50,3
s_add_u32 s64,s64,132096
v_mov_b32 v46,s64
v_mov_b32 v29,0
s_mov_b32 s97,0x7fff0000
s_mov_b32 s69,1
s_mov_b32 s68,0
s_mov_b32 s52,0x30003
s_mov_b32 s53,s52
seg_350:
s_add_u32 s94,s70,s75
s_xor_b32 s95,s94,1024
s_xor_b32 s91,s72,0x10000
s_cmp_eq_u32 s69,0
s_mov_b32 s69,1
s_cbranch_scc1 half2_355
s_waitcnt vmcnt(1)
v_cmp_gt_u32 vcc,s71,v29
s_cbranch_vccz nb_354
s_cmp_lg_u32 s50,0
s_cbranch_scc1 nb_354
buffer_load_dword v32,v21,s[20:23],s74 offen sc1
s_sleep 2
pl_356:
buffer_load_dword v33,v21,s[20:23],s74 offen sc1
s_waitcnt vmcnt(1)
v_cmp_gt_u32 vcc,s71,v32
v_mov_b32 v29,v32
s_cbranch_vccz pok_357
buffer_load_dword v32,v21,s[20:23],s74 offen sc1
s_waitcnt vmcnt(1)
v_cmp_gt_u32 vcc,s71,v33
v_mov_b32 v29,v33
s_cbranch_vccz pok_357
s_sub_u32 s90,s90,1
s_cmp_gt_i32 s90,0
s_cbranch_scc1 pl_356
pok_357:
nb_354:
s_cmp_eq_u32 s71,64
s_barrier
s_cbranch_scc1 half_358
s_xor_b32 m0,s91,0
s_add_u32 s65,s94,0
buffer_load_dwordx4 v16,s[20:23],s65 offen offset:0 sc1 lds
buffer_load_dwordx4 v16,s[20:23],s65 offen offset:2048 sc1 lds
s_xor_b32 m0,s91,16384
s_add_u32 s65,s94,32768
buffer_load_dwordx4 v16,s[20:23],s65 offen offset:0 sc1 lds
buffer_load_dwordx4 v16,s[20:23],s65 offen offset:2048 sc1 lds
s_xor_b32 m0,s91,32768
s_add_u32 s65,s94,65536
buffer_load_dwordx4 v16,s[20:23],s65 offen offset:0 sc1 lds
buffer_load_dwordx4 v16,s[20:23],s65 offen offset:2048 sc1 lds
s_xor_b32 m0,s91,49152
s_add_u32 s65,s94,s86
buffer_load_dwordx4 v16,s[20:23],s65 offen offset:0 sc1 lds
buffer_load_dwordx4 v16,s[20:23],s65 offen offset:2048 sc1 lds
s_waitcnt vmcnt(6)
s_barrier
ds_read_b128 v[224:227],v18 offset:0
ds_read_b128 v[228:231],v18 offset:2048
ds_read_b128 v[232:235],v18 offset:4096
ds_read_b128 v[236:239],v18 offset:6144
ds_read_b128 v[240:243],v18 offset:8192
ds_read_b128 v[244:247],v18 offset:10240
ds_read_b128 v[248:251],v18 offset:12288
s_waitcnt lgkmcnt(5)
v_mfma_f32_16x16x32_bf16 v[64:67],a[0:3],v[224:227],0
s_xor_b32 m0,s91,1024
v_min_u32 v27,v224,v228
v_mfma_f32_16x16x32_bf16 v[68:71],a[112:115],v[224:227],0
ds_read_b128 v[252:255],v18 offset:14336
v_mfma_f32_16x16x32_bf16 v[64:67],a[4:7],v[228:231],v[64:67]
s_add_u32 s65,s95,0
v_mfma_f32_16x16x32_bf16 v[68:71],a[116:119],v[228:231],v[68:71]
s_waitcnt vmcnt(4)
s_barrier
ds_read_b128 v[224:227],v18 offset:16384
s_waitcnt lgkmcnt(5)
v_mfma_f32_16x16x32_bf16 v[64:67],a[8:11],v[232:235],v[64:67]
buffer_load_dwordx4 v16,s[20:23],s65 offen offset:0 sc1 lds
v_mfma_f32_16x16x32_bf16 v[68:71],a[120:123],v[232:235],v[68:71]
ds_read_b128 v[228:231],v18 offset:18432
v_min3_u32 v27,v27,v232,v236
v_mfma_f32_16x16x32_bf16 v[64:67],a[12:15],v[236:239],v[64:67]
buffer_load_dwordx4 v16,s[20:23],s65 offen offset:2048 sc1 lds
v_mfma_f32_16x16x32_bf16 v[68:71],a[124:127],v[236:239],v[68:71]
ds_read_b128 v[232:235],v18 offset:20480
s_waitcnt lgkmcnt(5)
v_mfma_f32_16x16x32_bf16 v[64:67],a[16:19],v[240:243],v[64:67]
s_xor_b32 m0,s91,17408
v_min3_u32 v27,v27,v240,v244
v_mfma_f32_16x16x32_bf16 v[68:71],a[128:131],v[240:243],v[68:71]
ds_read_b128 v[236:239],v18 offset:22528
v_mfma_f32_16x16x32_bf16 v[64:67],a[20:23],v[244:247],v[64:67]
s_add_u32 s65,s95,32768
v_mfma_f32_16x16x32_bf16 v[68:71],a[132:135],v[244:247],v[68:71]
ds_read_b128 v[240:243],v18 offset:24576
s_waitcnt lgkmcnt(5)
v_mfma_f32_16x16x32_bf16 v[64:67],a[24:27],v[248:251],v[64:67]
buffer_load_dwordx4 v16,s[20:23],s65 offen offset:0 sc1 lds
v_mfma_f32_16x16x32_bf16 v[68:71],a[136:139],v[248:251],v[68:71]
ds_read_b128 v[244:247],v18 offset:26624
v_min3_u32 v27,v27,v248,v252
v_mfma_f32_16x16x32_bf16 v[64:67],a[28:31],v[252:255],v[64:67]
buffer_load_dwordx4 v16,s[20:23],s65 offen offset:2048 sc1 lds
v_mfma_f32_16x16x32_bf16 v[68:71],a[140:143],v[252:255],v[68:71]
ds_read_b128 v[248:251],v18 offset:28672
s_waitcnt lgkmcnt(5)
v_mfma_f32_16x16x32_bf16 v[64:67],a[32:35],v[224:227],v[64:67]
s_xor_b32 m0,s91,33792
v_min3_u32 v27,v27,v224,v228
v_mfma_f32_16x16x32_bf16 v[68:71],a[144:147],v[224:227],v[68:71]
ds_read_b128 v[252:255],v18 offset:30720
v_mfma_f32_16x16x32_bf16 v[64:67],a[36:39],v[228:231],v[64:67]
s_add_u32 s65,s95,65536
v_mfma_f32_16x16x32_bf16 v[68:71],a[148:151],v[228:231],v[68:71]
s_waitcnt vmcnt(4)
s_barrier
ds_read_b128 v[224:227],v18 offset:32768
s_waitcnt lgkmcnt(5)
v_mfma_f32_16x16x32_bf16 v[64:67],a[40:43],v[232:235],v[64:67]
buffer_load_dwordx4 v16,s[20:23],s65 offen offset:0 sc1 lds
s_add_u32 s88,s70,s75
v_mfma_f32_16x16x32_bf16 v[68:71],a[152:155],v[232:235],v[68:71]
ds_read_b128 v[228:231],v18 offset:34816
v_min3_u32 v27,v27,v232,v236
s_add_u32 s88,s88,2097152
v_mfma_f32_16x16x32_bf16 v[64:67],a[44:47],v[236:239],v[64:67]
buffer_load_dwordx4 v16,s[20:23],s65 offen offset:2048 sc1 lds
v_mfma_f32_16x16x32_bf16 v[68:71],a[156:159],v[236:239],v[68:71]
ds_read_b128 v[232:235],v18 offset:36864
s_waitcnt lgkmcnt(5)
v_mfma_f32_16x16x32_bf16 v[64:67],a[48:51],v[240:243],v[64:67]
s_xor_b32 m0,s91,50176
v_min3_u32 v27,v27,v240,v244
v_mfma_f32_16x16x32_bf16 v[68:71],a[160:163],v[240:243],v[68:71]
ds_read_b128 v[236:239],v18 offset:38912
s_xor_b32 s88,s88,0x2000
v_mfma_f32_16x16x32_bf16 v[64:67],a[52:55],v[244:247],v[64:67]
s_add_u32 s65,s95,s86
s_xor_b32 s89,s88,1024
v_mfma_f32_16x16x32_bf16 v[68:71],a[164:167],v[244:247],v[68:71]
ds_read_b128 v[240:243],v18 offset:40960
s_waitcnt lgkmcnt(5)
v_mfma_f32_16x16x32_bf16 v[64:67],a[56:59],v[248:251],v[64:67]
buffer_load_dwordx4 v16,s[20:23],s65 offen offset:0 sc1 lds
v_mfma_f32_16x16x32_bf16 v[68:71],a[168:171],v[248:251],v[68:71]
ds_read_b128 v[244:247],v18 offset:43008
v_min3_u32 v27,v27,v248,v252
v_mfma_f32_16x16x32_bf16 v[64:67],a[60:63],v[252:255],v[64:67]
buffer_load_dwordx4 v16,s[20:23],s65 offen offset:2048 sc1 lds
v_mfma_f32_16x16x32_bf16 v[68:71],a[172:175],v[252:255],v[68:71]
ds_read_b128 v[248:251],v18 offset:45056
s_waitcnt lgkmcnt(5)
v_mfma_f32_16x16x32_bf16 v[64:67],a[64:67],v[224:227],v[64:67]
s_waitcnt vmcnt(4)
s_barrier
ds_read_b128 v[128:131],v17 offset:0
ds_read_b128 v[132:135],v17 offset:2048
v_mfma_f32_16x16x32_bf16 v[68:71],a[176:179],v[224:227],v[68:71]
ds_read_b128 v[252:255],v18 offset:47104
v_min3_u32 v27,v27,v224,v228
v_mfma_f32_16x16x32_bf16 v[64:67],a[68:71],v[228:231],v[64:67]
ds_read_b128 v[136:139],v17 offset:4096
buffer_load_dwordx2 v[120:121],v20,s[20:23],s76 offen sc1
v_mfma_f32_16x16x32_bf16 v[68:71],a[180:183],v[228:231],v[68:71]
ds_read_b128 v[224:227],v18 offset:49152
s_waitcnt lgkmcnt(8)
v_mfma_f32_16x16x32_bf16 v[64:67],a[72:75],v[232:235],v[64:67]
ds_read_b128 v[140:143],v17 offset:6144
v_min3_u32 v27,v27,v232,v236
v_mfma_f32_16x16x32_bf16 v[68:71],a[184:187],v[232:235],v[68:71]
ds_read_b128 v[228:231],v18 offset:51200
buffer_load_dwordx2 v[122:123],v24,s[20:23],s70 offen sc1
v_mfma_f32_16x16x32_bf16 v[64:67],a[76:79],v[236:239],v[64:67]
ds_read_b128 v[144:147],v17 offset:8192
ds_read_b128 v[148:151],v17 offset:10240
v_mfma_f32_16x16x32_bf16 v[68:71],a[188:191],v[236:239],v[68:71]
ds_read_b128 v[232:235],v18 offset:53248
s_waitcnt lgkmcnt(11)
v_mfma_f32_16x16x32_bf16 v[64:67],a[80:83],v[240:243],v[64:67]
ds_read_b128 v[152:155],v17 offset:12288
v_min3_u32 v27,v27,v240,v244
v_mfma_f32_16x16x32_bf16 v[68:71],a[192:195],v[240:243],v[68:71]
ds_read_b128 v[236:239],v18 offset:55296
v_mfma_f32_16x16x32_bf16 v[64:67],a[84:87],v[244:247],v[64:67]
ds_read_b128 v[156:159],v17 offset:14336
v_mfma_f32_16x16x32_bf16 v[68:71],a[196:199],v[244:247],v[68:71]
s_waitcnt lgkmcnt(10)
v_mfma_f32_16x16x32_bf16 v[64:67],a[88:91],v[248:251],v[64:67]
ds_read_b128 v[160:163],v17 offset:16384
ds_read_b128 v[164:167],v17 offset:18432
v_mfma_f32_16x16x32_bf16 v[68:71],a[200:203],v[248:251],v[68:71]
v_min3_u32 v27,v27,v248,v252
v_mfma_f32_16x16x32_bf16 v[64:67],a[92:95],v[252:255],v[64:67]
ds_read_b128 v[168:171],v17 offset:20480
v_mfma_f32_16x16x32_bf16 v[68:71],a[204:207],v[252:255],v[68:71]
s_waitcnt lgkmcnt(9)
v_mfma_f32_16x16x32_bf16 v[64:67],a[96:99],v[224:227],v[64:67]
ds_read_b128 v[172:175],v17 offset:22528
v_min3_u32 v27,v27,v224,v228
v_mfma_f32_16x16x32_bf16 v[68:71],a[208:211],v[224:227],v[68:71]
v_min3_u32 v27,v27,v226,v230
v_mfma_f32_16x16x32_bf16 v[64:67],a[100:103],v[228:231],v[64:67]
ds_read_b128 v[176:179],v17 offset:24576
ds_read_b128 v[180:183],v17 offset:26624
v_mfma_f32_16x16x32_bf16 v[68:71],a[212:215],v[228:231],v[68:71]
s_waitcnt lgkmcnt(7)
v_mfma_f32_16x16x32_bf16 v[64:67],a[104:107],v[232:235],v[64:67]
ds_read_b128 v[184:187],v17 offset:28672
v_min3_u32 v27,v27,v232,v236
v_mfma_f32_16x16x32_bf16 v[68:71],a[216:219],v[232:235],v[68:71]
v_min3_u32 v27,v27,v234,v238
v_mfma_f32_16x16x32_bf16 v[64:67],a[108:111],v[236:239],v[64:67]
ds_read_b128 v[188:191],v17 offset:30720
v_mfma_f32_16x16x32_bf16 v[68:71],a[220:223],v[236:239],v[68:71]
v_mfma_f32_16x16x32_bf16 v[72:75],a[112:115],v[128:131],0
v_cmp_eq_u32 vcc,0,v27
s_cbranch_vccnz retry_349
v_mfma_f32_16x16x32_bf16 v[76:79],a[116:119],v[132:135],0
v_min3_u32 v27,v27,v128,v132
v_mfma_f32_16x16x32_bf16 v[72:75],a[120:123],v[136:139],v[72:75]
s_waitcnt vmcnt(2)
s_barrier
ds_read_b128 v[192:195],v17 offset:32768
v_mfma_f32_16x16x32_bf16 v[76:79],a[124:127],v[140:143],v[76:79]
ds_read_b128 v[196:199],v17 offset:34816
s_waitcnt lgkmcnt(10)
v_mfma_f32_16x16x32_bf16 v[72:75],a[128:131],v[144:147],v[72:75]
ds_read_b128 v[200:203],v17 offset:36864
v_min3_u32 v27,v27,v136,v140
s_waitcnt vmcnt(0)
v_mfma_f32_16x16x32_bf16 v[76:79],a[132:135],v[148:151],v[76:79]
ds_read_b128 v[204:207],v17 offset:38912
v_min3_u32 v27,v27,v144,v148
v_and_or_b32 v64,v64,-4,s48
v_mfma_f32_16x16x32_bf16 v[72:75],a[136:139],v[152:155],v[72:75]
ds_read_b128 v[208:211],v17 offset:40960
s_add_u32 s64,s49,s34
v_mfma_f32_16x16x32_bf16 v[76:79],a[140:143],v[156:159],v[76:79]
v_min3_u32 v27,v27,v152,v156
s_waitcnt lgkmcnt(9)
v_mfma_f32_16x16x32_bf16 v[72:75],a[144:147],v[160:163],v[72:75]
ds_read_b128 v[212:215],v17 offset:43008
buffer_store_dwordx4 v[64:67],v25,s[20:23],s64 offen offset:2048 sc1
v_mfma_f32_16x16x32_bf16 v[76:79],a[148:151],v[164:167],v[76:79]
ds_read_b128 v[216:219],v17 offset:45056
v_min3_u32 v27,v27,v160,v164
v_and_or_b32 v68,v68,-4,s48
v_mfma_f32_16x16x32_bf16 v[72:75],a[152:155],v[168:171],v[72:75]
ds_read_b128 v[220:223],v17 offset:47104
s_add_u32 s64,s49,s35
v_mfma_f32_16x16x32_bf16 v[76:79],a[156:159],v[172:175],v[76:79]
ds_read_b128 v[224:227],v17 offset:49152
s_waitcnt lgkmcnt(9)
v_mfma_f32_16x16x32_bf16 v[72:75],a[160:163],v[176:179],v[72:75]
ds_read_b128 v[228:231],v17 offset:51200
v_min3_u32 v27,v27,v168,v172
v_mfma_f32_16x16x32_bf16 v[76:79],a[164:167],v[180:183],v[76:79]
v_min3_u32 v27,v27,v176,v180
buffer_store_dwordx4 v[68:71],v25,s[20:23],s64 offen offset:3072 sc1
v_mfma_f32_16x16x32_bf16 v[72:75],a[168:171],v[184:187],v[72:75]
ds_read_b128 v[232:235],v17 offset:53248
s_mov_b32 s49,0x7fff0000
v_mfma_f32_16x16x32_bf16 v[76:79],a[172:175],v[188:191],v[76:79]
ds_read_b128 v[236:239],v17 offset:55296
s_waitcnt lgkmcnt(8)
v_mfma_f32_16x16x32_bf16 v[72:75],a[176:179],v[192:195],v[72:75]
v_min3_u32 v27,v27,v184,v188
v_mfma_f32_16x16x32_bf16 v[76:79],a[180:183],v[196:199],v[76:79]
v_min3_u32 v27,v27,v192,v196
ds_bpermute_b32 v124,v41,v120
v_mfma_f32_16x16x32_bf16 v[72:75],a[184:187],v[200:203],v[72:75]
v_mfma_f32_16x16x32_bf16 v[76:79],a[188:191],v[204:207],v[76:79]
v_min3_u32 v27,v27,v200,v204
s_waitcnt lgkmcnt(5)
v_mfma_f32_16x16x32_bf16 v[72:75],a[192:195],v[208:211],v[72:75]
ds_bpermute_b32 v125,v41,v121
v_mfma_f32_16x16x32_bf16 v[76:79],a[196:199],v[212:215],v[76:79]
v_min3_u32 v27,v27,v208,v212
v_lshlrev_b32 v108,16,v122
v_mfma_f32_16x16x32_bf16 v[72:75],a[200:203],v[216:219],v[72:75]
v_mfma_f32_16x16x32_bf16 v[76:79],a[204:207],v[220:223],v[76:79]
v_min3_u32 v27,v27,v216,v220
s_waitcnt lgkmcnt(2)
v_mfma_f32_16x16x32_bf16 v[72:75],a[208:211],v[224:227],v[72:75]
v_and_b32 v109,s80,v122
v_mfma_f32_16x16x32_bf16 v[76:79],a[212:215],v[228:231],v[76:79]
v_min3_u32 v27,v27,v224,v228
v_min3_u32 v27,v27,v226,v230
v_mfma_f32_16x16x32_bf16 v[72:75],a[216:219],v[232:235],v[72:75]
v_lshlrev_b32 v110,16,v123
v_mfma_f32_16x16x32_bf16 v[76:79],a[220:223],v[236:239],v[76:79]
v_min3_u32 v27,v27,v232,v236
v_min3_u32 v27,v27,v234,v238
v_mfma_f32_16x16x32_bf16 v[80:83],a[0:3],v[128:131],0
v_cmp_eq_u32 vcc,0,v27
s_cbranch_vccnz retry_349
v_mfma_f32_16x16x32_bf16 v[84:87],a[4:7],v[132:135],0
v_and_b32 v111,s80,v123
s_waitcnt lgkmcnt(0)
v_mfma_f32_16x16x32_bf16 v[80:83],a[8:11],v[136:139],v[80:83]
v_mfma_f32_16x16x32_bf16 v[84:87],a[12:15],v[140:143],v[84:87]
v_lshlrev_b32 v104,16,v124
v_mfma_f32_16x16x32_bf16 v[80:83],a[16:19],v[144:147],v[80:83]
v_add_f32 v72,v72,v76
v_add_f32 v73,v73,v77
v_mfma_f32_16x16x32_bf16 v[84:87],a[20:23],v[148:151],v[84:87]
v_and_b32 v105,s80,v124
v_add_f32 v74,v74,v78
v_mfma_f32_16x16x32_bf16 v[80:83],a[24:27],v[152:155],v[80:83]
v_add_f32 v75,v75,v79
v_and_or_b32 v72,v72,-4,s48
v_mfma_f32_16x16x32_bf16 v[84:87],a[28:31],v[156:159],v[84:87]
v_lshlrev_b32 v106,16,v125
s_add_u32 s64,s77,s33
v_mfma_f32_16x16x32_bf16 v[80:83],a[32:35],v[160:163],v[80:83]
buffer_store_dwordx4 v[72:75],v25,s[20:23],s64 offen offset:1024 sc1
v_mfma_f32_16x16x32_bf16 v[84:87],a[36:39],v[164:167],v[84:87]
v_and_b32 v107,s80,v125
v_mfma_f32_16x16x32_bf16 v[80:83],a[40:43],v[168:171],v[80:83]
v_mfma_f32_16x16x32_bf16 v[84:87],a[44:47],v[172:175],v[84:87]
v_mfma_f32_16x16x32_bf16 v[80:83],a[48:51],v[176:179],v[80:83]
buffer_load_dwordx4 v[96:99],v26,s[20:23],s77 offen offset:2048 sc1
v_mfma_f32_16x16x32_bf16 v[84:87],a[52:55],v[180:183],v[84:87]
buffer_load_dwordx4 v[100:103],v26,s[20:23],s77 offen offset:3072 sc1
v_mfma_f32_16x16x32_bf16 v[80:83],a[56:59],v[184:187],v[80:83]
v_mfma_f32_16x16x32_bf16 v[84:87],a[60:63],v[188:191],v[84:87]
v_mfma_f32_16x16x32_bf16 v[80:83],a[64:67],v[192:195],v[80:83]
v_mfma_f32_16x16x32_bf16 v[84:87],a[68:71],v[196:199],v[84:87]
v_mfma_f32_16x16x32_bf16 v[80:83],a[72:75],v[200:203],v[80:83]
v_mfma_f32_16x16x32_bf16 v[84:87],a[76:79],v[204:207],v[84:87]
v_mfma_f32_16x16x32_bf16 v[80:83],a[80:83],v[208:211],v[80:83]
v_mfma_f32_16x16x32_bf16 v[84:87],a[84:87],v[212:215],v[84:87]
v_mfma_f32_16x16x32_bf16 v[80:83],a[88:91],v[216:219],v[80:83]
buffer_load_dwordx4 v[92:95],v26,s[20:23],s77 offen offset:1024 sc1
v_mfma_f32_16x16x32_bf16 v[84:87],a[92:95],v[220:223],v[84:87]
v_mfma_f32_16x16x32_bf16 v[80:83],a[96:99],v[224:227],v[80:83]
v_mfma_f32_16x16x32_bf16 v[84:87],a[100:103],v[228:231],v[84:87]
v_mfma_f32_16x16x32_bf16 v[80:83],a[104:107],v[232:235],v[80:83]
v_mfma_f32_16x16x32_bf16 v[84:87],a[108:111],v[236:239],v[84:87]
epi_352:
buffer_load_dword v29,v21,s[20:23],s87 offen sc1
s_nop 6
v_pk_add_f32 v[88:89],v[80:81],v[84:85]
v_pk_add_f32 v[90:91],v[82:83],v[86:87]
v_pk_add_f32 v[88:89],v[88:89],v[108:109]
v_pk_add_f32 v[90:91],v[90:91],v[110:111]
s_waitcnt vmcnt(1)
s_branch ic_362
ip_360:
buffer_load_dwordx4 v[92:95],v26,s[20:23],s77 offen offset:1024 sc1
buffer_load_dwordx4 v[96:99],v26,s[20:23],s77 offen offset:2048 sc1
buffer_load_dwordx4 v[100:103],v26,s[20:23],s77 offen offset:3072 sc1
s_waitcnt vmcnt(0)
ic_362:
v_bitop3_b32 v22,v92,v96,v100 bitop3:0x80
v_and_b32 v22,s48,v22
v_cmp_eq_u32 vcc,0,v22
s_cbranch_vccz ik_361
s_sub_u32 s90,s90,1
s_cmp_gt_i32 s90,0
s_cbranch_scc1 ip_360
ik_361:
s_cmp_lg_u32 s71,65
s_cbranch_scc1 nl_363
buffer_load_dwordx4 v[132:135],v26,s[20:23],s40 offen offset:1024 sc1
buffer_load_dwordx4 v[136:139],v26,s[20:23],s40 offen offset:2048 sc1
buffer_load_dwordx4 v[140:143],v26,s[20:23],s40 offen offset:3072 sc1
nl_363:
v_pk_add_f32 v[88:89],v[88:89],v[92:93]
v_pk_add_f32 v[96:97],v[96:97],v[100:101]
v_pk_add_f32 v[90:91],v[90:91],v[94:95]
v_pk_add_f32 v[98:99],v[98:99],v[102:103]
v_pk_add_f32 v[88:89],v[88:89],v[96:97]
v_pk_add_f32 v[90:91],v[90:91],v[98:99]
v_pk_fma_f32 v[88:89],v[88:89],v[52:53],v[104:105]
v_pk_fma_f32 v[90:91],v[90:91],v[54:55],v[106:107]
v_cvt_pk_bf16_f32 v88,v88,v89
v_cvt_pk_bf16_f32 v89,v90,v91
ds_bpermute_b32 v88,v40,v88
ds_bpermute_b32 v89,v40,v89
v_xor_b32 v18,0x10000,v18
s_xor_b32 s49,s77,524288
s_cselect_b32 s64,0,3
s_xor_b32 s48,s48,s64
s_cmp_eq_u32 s71,63
s_cselect_b32 s64,0,0x2000
s_cselect_b32 s66,2,1
s_cmp_eq_u32 s71,64
s_cselect_b32 s66,-1,s66
v_xor_b32 v20,s64,v20
s_lshl_b32 s64,s66,21
s_add_u32 s76,s76,s64
s_lshl_b32 s66,s66,16
s_waitcnt lgkmcnt(0)
s_mov_b64 exec,s[84:85]
buffer_store_dwordx2 v[88:89],v19,s[36:39],s78 offen
s_mov_b64 exec,-1
s_mov_b64 s[84:85],-1
s_mov_b32 s77,s49
s_add_u32 s78,s78,s66
next_359:
v_xor_b32 v17,0x10000,v17
s_xor_b32 s72,s72,0x10000
s_add_u32 s70,s70,2097152
s_xor_b32 s70,s70,0x2000
s_add_u32 s71,s71,1
s_cmp_le_u32 s71,s57
s_cbranch_scc1 seg_350
s_cmp_lg_u32 s43,0
s_cbranch_scc1 hn_367
s_waitcnt vmcnt(1)
s_branch hc_366
hp_364:
buffer_load_dwordx4 v[132:135],v26,s[20:23],s40 offen offset:1024 sc1
buffer_load_dwordx4 v[136:139],v26,s[20:23],s40 offen offset:2048 sc1
buffer_load_dwordx4 v[140:143],v26,s[20:23],s40 offen offset:3072 sc1
s_waitcnt vmcnt(0)
hc_366:
v_bitop3_b32 v22,v132,v136,v140 bitop3:0x80
v_and_b32 v22,s60,v22
v_cmp_eq_u32 vcc,0,v22
s_cbranch_vccz hk_365
s_sub_u32 s90,s90,1
s_cmp_gt_i32 s90,0
s_cbranch_scc1 hp_364
hk_365:
v_pk_add_f32 v[112:113],v[112:113],v[132:133]
v_pk_add_f32 v[136:137],v[136:137],v[140:141]
v_pk_add_f32 v[114:115],v[114:115],v[134:135]
v_pk_add_f32 v[138:139],v[138:139],v[142:143]
v_pk_add_f32 v[112:113],v[112:113],v[136:137]
v_pk_add_f32 v[114:115],v[114:115],v[138:139]
v_pk_fma_f32 v[112:113],v[112:113],v[52:53],v[116:117]
v_pk_fma_f32 v[114:115],v[114:115],v[54:55],v[118:119]
v_cvt_pk_bf16_f32 v112,v112,v113
v_cvt_pk_bf16_f32 v113,v114,v115
ds_bpermute_b32 v112,v40,v112
ds_bpermute_b32 v113,v40,v113
s_mov_b32 s64,4194304
s_waitcnt lgkmcnt(0)
buffer_store_dwordx2 v[112:113],v19,s[36:39],s64 offen
hn_367:
s_endpgm
retry_349:
s_sub_u32 s90,s90,64
s_cmp_lt_i32 s90,0
s_cbranch_scc1 giveup_197
s_mov_b32 s83,1
s_waitcnt vmcnt(0) lgkmcnt(0)
s_barrier
s_branch seg_350
half_358:
s_cmp_eq_u32 s43,0
s_cbranch_scc1 hown_368
s_mov_b64 exec,s[52:53]
s_xor_b32 m0,s91,0
s_add_u32 s65,s94,0
buffer_load_dwordx4 v16,s[20:23],s65 offen offset:0 sc1 lds
buffer_load_dwordx4 v16,s[20:23],s65 offen offset:2048 sc1 lds
s_xor_b32 m0,s91,16384
s_add_u32 s65,s94,32768
buffer_load_dwordx4 v16,s[20:23],s65 offen offset:0 sc1 lds
buffer_load_dwordx4 v16,s[20:23],s65 offen offset:2048 sc1 lds
s_xor_b32 m0,s91,32768
s_add_u32 s65,s94,65536
buffer_load_dwordx4 v16,s[20:23],s65 offen offset:0 sc1 lds
buffer_load_dwordx4 v16,s[20:23],s65 offen offset:2048 sc1 lds
s_xor_b32 m0,s91,49152
s_add_u32 s65,s94,s86
buffer_load_dwordx4 v16,s[20:23],s65 offen offset:0 sc1 lds
buffer_load_dwordx4 v16,s[20:23],s65 offen offset:2048 sc1 lds
s_mov_b64 exec,-1
h2a_369:
s_waitcnt vmcnt(6)
s_barrier
ds_read_b128 v[224:227],v18 offset:0
ds_read_b128 v[228:231],v18 offset:2048
ds_read_b128 v[232:235],v18 offset:4096
ds_read_b128 v[236:239],v18 offset:6144
ds_read_b128 v[240:243],v18 offset:8192
ds_read_b128 v[244:247],v18 offset:10240
ds_read_b128 v[248:251],v18 offset:12288
s_waitcnt lgkmcnt(5)
v_mfma_f32_16x16x32_bf16 v[64:67],a[0:3],v[224:227],0
v_min_u32 v27,v224,v228
v_mfma_f32_16x16x32_bf16 v[68:71],a[112:115],v[224:227],0
ds_read_b128 v[252:255],v18 offset:14336
v_mfma_f32_16x16x32_bf16 v[64:67],a[4:7],v[228:231],v[64:67]
v_mfma_f32_16x16x32_bf16 v[68:71],a[116:119],v[228:231],v[68:71]
s_waitcnt vmcnt(4)
s_barrier
ds_read_b128 v[224:227],v18 offset:16384
s_waitcnt lgkmcnt(5)
v_mfma_f32_16x16x32_bf16 v[64:67],a[8:11],v[232:235],v[64:67]
v_min3_u32 v27,v27,v232,v236
v_mfma_f32_16x16x32_bf16 v[68:71],a[120:123],v[232:235],v[68:71]
ds_read_b128 v[228:231],v18 offset:18432
v_mfma_f32_16x16x32_bf16 v[64:67],a[12:15],v[236:239],v[64:67]
v_mfma_f32_16x16x32_bf16 v[68:71],a[124:127],v[236:239],v[68:71]
ds_read_b128 v[232:235],v18 offset:20480
s_waitcnt lgkmcnt(5)
v_mfma_f32_16x16x32_bf16 v[64:67],a[16:19],v[240:243],v[64:67]
v_min3_u32 v27,v27,v240,v244
v_mfma_f32_16x16x32_bf16 v[68:71],a[128:131],v[240:243],v[68:71]
ds_read_b128 v[236:239],v18 offset:22528
v_mfma_f32_16x16x32_bf16 v[64:67],a[20:23],v[244:247],v[64:67]
v_mfma_f32_16x16x32_bf16 v[68:71],a[132:135],v[244:247],v[68:71]
ds_read_b128 v[240:243],v18 offset:24576
s_waitcnt lgkmcnt(5)
v_mfma_f32_16x16x32_bf16 v[64:67],a[24:27],v[248:251],v[64:67]
v_min3_u32 v27,v27,v248,v252
v_mfma_f32_16x16x32_bf16 v[68:71],a[136:139],v[248:251],v[68:71]
ds_read_b128 v[244:247],v18 offset:26624
v_mfma_f32_16x16x32_bf16 v[64:67],a[28:31],v[252:255],v[64:67]
v_mfma_f32_16x16x32_bf16 v[68:71],a[140:143],v[252:255],v[68:71]
ds_read_b128 v[248:251],v18 offset:28672
s_waitcnt lgkmcnt(5)
v_mfma_f32_16x16x32_bf16 v[64:67],a[32:35],v[224:227],v[64:67]
v_min3_u32 v27,v27,v224,v228
v_mfma_f32_16x16x32_bf16 v[68:71],a[144:147],v[224:227],v[68:71]
ds_read_b128 v[252:255],v18 offset:30720
v_mfma_f32_16x16x32_bf16 v[64:67],a[36:39],v[228:231],v[64:67]
v_mfma_f32_16x16x32_bf16 v[68:71],a[148:151],v[228:231],v[68:71]
s_waitcnt vmcnt(0)
s_barrier
ds_read_b128 v[224:227],v18 offset:32768
s_waitcnt lgkmcnt(5)
v_mfma_f32_16x16x32_bf16 v[64:67],a[40:43],v[232:235],v[64:67]
v_min3_u32 v27,v27,v232,v236
v_mfma_f32_16x16x32_bf16 v[68:71],a[152:155],v[232:235],v[68:71]
ds_read_b128 v[228:231],v18 offset:34816
v_mfma_f32_16x16x32_bf16 v[64:67],a[44:47],v[236:239],v[64:67]
v_mfma_f32_16x16x32_bf16 v[68:71],a[156:159],v[236:239],v[68:71]
ds_read_b128 v[232:235],v18 offset:36864
s_waitcnt lgkmcnt(5)
v_mfma_f32_16x16x32_bf16 v[64:67],a[48:51],v[240:243],v[64:67]
v_min3_u32 v27,v27,v240,v244
v_mfma_f32_16x16x32_bf16 v[68:71],a[160:163],v[240:243],v[68:71]
ds_read_b128 v[236:239],v18 offset:38912
v_mfma_f32_16x16x32_bf16 v[64:67],a[52:55],v[244:247],v[64:67]
v_mfma_f32_16x16x32_bf16 v[68:71],a[164:167],v[244:247],v[68:71]
ds_read_b128 v[240:243],v18 offset:40960
s_waitcnt lgkmcnt(5)
v_mfma_f32_16x16x32_bf16 v[64:67],a[56:59],v[248:251],v[64:67]
v_min3_u32 v27,v27,v248,v252
v_mfma_f32_16x16x32_bf16 v[68:71],a[168:171],v[248:251],v[68:71]
ds_read_b128 v[244:247],v18 offset:43008
v_mfma_f32_16x16x32_bf16 v[64:67],a[60:63],v[252:255],v[64:67]
v_mfma_f32_16x16x32_bf16 v[68:71],a[172:175],v[252:255],v[68:71]
ds_read_b128 v[248:251],v18 offset:45056
s_waitcnt lgkmcnt(5)
v_mfma_f32_16x16x32_bf16 v[64:67],a[64:67],v[224:227],v[64:67]
v_min3_u32 v27,v27,v224,v228
v_mfma_f32_16x16x32_bf16 v[68:71],a[176:179],v[224:227],v[68:71]
ds_read_b128 v[252:255],v18 offset:47104
v_mfma_f32_16x16x32_bf16 v[64:67],a[68:71],v[228:231],v[64:67]
v_mfma_f32_16x16x32_bf16 v[68:71],a[180:183],v[228:231],v[68:71]
ds_read_b128 v[224:227],v18 offset:49152
s_waitcnt lgkmcnt(5)
v_mfma_f32_16x16x32_bf16 v[64:67],a[72:75],v[232:235],v[64:67]
v_min3_u32 v27,v27,v232,v236
v_mfma_f32_16x16x32_bf16 v[68:71],a[184:187],v[232:235],v[68:71]
ds_read_b128 v[228:231],v18 offset:51200
v_mfma_f32_16x16x32_bf16 v[64:67],a[76:79],v[236:239],v[64:67]
v_mfma_f32_16x16x32_bf16 v[68:71],a[188:191],v[236:239],v[68:71]
ds_read_b128 v[232:235],v18 offset:53248
s_waitcnt lgkmcnt(5)
v_mfma_f32_16x16x32_bf16 v[64:67],a[80:83],v[240:243],v[64:67]
v_min3_u32 v27,v27,v240,v244
v_mfma_f32_16x16x32_bf16 v[68:71],a[192:195],v[240:243],v[68:71]
ds_read_b128 v[236:239],v18 offset:55296
v_mfma_f32_16x16x32_bf16 v[64:67],a[84:87],v[244:247],v[64:67]
v_mfma_f32_16x16x32_bf16 v[68:71],a[196:199],v[244:247],v[68:71]
s_waitcnt lgkmcnt(4)
v_mfma_f32_16x16x32_bf16 v[64:67],a[88:91],v[248:251],v[64:67]
v_min3_u32 v27,v27,v248,v252
v_mfma_f32_16x16x32_bf16 v[68:71],a[200:203],v[248:251],v[68:71]
v_mfma_f32_16x16x32_bf16 v[64:67],a[92:95],v[252:255],v[64:67]
v_mfma_f32_16x16x32_bf16 v[68:71],a[204:207],v[252:255],v[68:71]
s_waitcnt lgkmcnt(2)
v_mfma_f32_16x16x32_bf16 v[64:67],a[96:99],v[224:227],v[64:67]
v_min3_u32 v27,v27,v224,v228
v_min3_u32 v27,v27,v226,v230
v_mfma_f32_16x16x32_bf16 v[68:71],a[208:211],v[224:227],v[68:71]
v_mfma_f32_16x16x32_bf16 v[64:67],a[100:103],v[228:231],v[64:67]
v_mfma_f32_16x16x32_bf16 v[68:71],a[212:215],v[228:231],v[68:71]
s_waitcnt lgkmcnt(0)
v_mfma_f32_16x16x32_bf16 v[64:67],a[104:107],v[232:235],v[64:67]
v_min3_u32 v27,v27,v232,v236
v_min3_u32 v27,v27,v234,v238
v_mfma_f32_16x16x32_bf16 v[68:71],a[216:219],v[232:235],v[68:71]
v_mfma_f32_16x16x32_bf16 v[64:67],a[108:111],v[236:239],v[64:67]
v_mfma_f32_16x16x32_bf16 v[68:71],a[220:223],v[236:239],v[68:71]
v_cmp_eq_u32 vcc,0,v27
s_and_b64 vcc,vcc,s[52:53]
s_cbranch_vccnz retry_349
buffer_load_dword v29,v21,s[20:23],s87 offen sc1
s_mov_b32 s40,0x7fff0000
s_nop 5
v_and_or_b32 v64,v64,-4,s48
s_add_u32 s64,s77,s34
buffer_store_dwordx4 v[64:67],v25,s[20:23],s64 offen offset:2048 sc1
v_and_or_b32 v68,v68,-4,s48
s_add_u32 s64,s77,s35
buffer_store_dwordx4 v[68:71],v25,s[20:23],s64 offen offset:3072 sc1
hjoin_371:
v_xor_b32 v18,0x10000,v18
s_xor_b32 s49,s77,524288
s_cselect_b32 s64,0,3
s_xor_b32 s48,s48,s64
v_xor_b32 v20,0x2000,v20
s_sub_u32 s76,s76,2097152
s_mov_b32 s77,s49
s_sub_u32 s78,s78,65536
s_branch next_359
half2_355:
s_cmp_eq_u32 s43,0
s_cbranch_scc1 h2b_370
s_branch h2a_369
hown_368:
s_mov_b64 exec,s[52:53]
s_xor_b32 m0,s91,1024
s_add_u32 s65,s95,0
buffer_load_dwordx4 v16,s[20:23],s65 offen offset:0 sc1 lds
buffer_load_dwordx4 v16,s[20:23],s65 offen offset:2048 sc1 lds
s_xor_b32 m0,s91,17408
s_add_u32 s65,s95,32768
buffer_load_dwordx4 v16,s[20:23],s65 offen offset:0 sc1 lds
buffer_load_dwordx4 v16,s[20:23],s65 offen offset:2048 sc1 lds
s_xor_b32 m0,s91,33792
s_add_u32 s65,s95,65536
buffer_load_dwordx4 v16,s[20:23],s65 offen offset:0 sc1 lds
buffer_load_dwordx4 v16,s[20:23],s65 offen offset:2048 sc1 lds
s_xor_b32 m0,s91,50176
s_add_u32 s65,s95,s86
buffer_load_dwordx4 v16,s[20:23],s65 offen offset:0 sc1 lds
buffer_load_dwordx4 v16,s[20:23],s65 offen offset:2048 sc1 lds
s_mov_b64 exec,-1
h2b_370:
buffer_load_dwordx2 v[120:121],v20,s[20:23],s76 offen sc1
buffer_load_dwordx2 v[122:123],v24,s[20:23],s70 offen sc1
s_waitcnt vmcnt(8)
s_barrier
ds_read_b128 v[128:131],v17 offset:0
ds_read_b128 v[132:135],v17 offset:2048
ds_read_b128 v[136:139],v17 offset:4096
ds_read_b128 v[140:143],v17 offset:6144
ds_read_b128 v[144:147],v17 offset:8192
ds_read_b128 v[148:151],v17 offset:10240
ds_read_b128 v[152:155],v17 offset:12288
s_waitcnt lgkmcnt(5)
v_mfma_f32_16x16x32_bf16 v[72:75],a[112:115],v[128:131],0
v_min_u32 v27,v128,v132
v_mfma_f32_16x16x32_bf16 v[80:83],a[0:3],v[128:131],0
ds_read_b128 v[156:159],v17 offset:14336
v_mfma_f32_16x16x32_bf16 v[76:79],a[116:119],v[132:135],0
v_mfma_f32_16x16x32_bf16 v[84:87],a[4:7],v[132:135],0
s_waitcnt vmcnt(6)
s_barrier
ds_read_b128 v[160:163],v17 offset:16384
s_waitcnt lgkmcnt(5)
v_mfma_f32_16x16x32_bf16 v[72:75],a[120:123],v[136:139],v[72:75]
v_min3_u32 v27,v27,v136,v140
v_mfma_f32_16x16x32_bf16 v[80:83],a[8:11],v[136:139],v[80:83]
ds_read_b128 v[164:167],v17 offset:18432
v_mfma_f32_16x16x32_bf16 v[76:79],a[124:127],v[140:143],v[76:79]
v_mfma_f32_16x16x32_bf16 v[84:87],a[12:15],v[140:143],v[84:87]
ds_read_b128 v[168:171],v17 offset:20480
s_waitcnt lgkmcnt(5)
v_mfma_f32_16x16x32_bf16 v[72:75],a[128:131],v[144:147],v[72:75]
v_min3_u32 v27,v27,v144,v148
v_mfma_f32_16x16x32_bf16 v[80:83],a[16:19],v[144:147],v[80:83]
ds_read_b128 v[172:175],v17 offset:22528
v_mfma_f32_16x16x32_bf16 v[76:79],a[132:135],v[148:151],v[76:79]
v_mfma_f32_16x16x32_bf16 v[84:87],a[20:23],v[148:151],v[84:87]
ds_read_b128 v[176:179],v17 offset:24576
s_waitcnt lgkmcnt(5)
v_mfma_f32_16x16x32_bf16 v[72:75],a[136:139],v[152:155],v[72:75]
v_min3_u32 v27,v27,v152,v156
v_mfma_f32_16x16x32_bf16 v[80:83],a[24:27],v[152:155],v[80:83]
ds_read_b128 v[180:183],v17 offset:26624
v_mfma_f32_16x16x32_bf16 v[76:79],a[140:143],v[156:159],v[76:79]
v_mfma_f32_16x16x32_bf16 v[84:87],a[28:31],v[156:159],v[84:87]
ds_read_b128 v[184:187],v17 offset:28672
s_waitcnt lgkmcnt(5)
v_mfma_f32_16x16x32_bf16 v[72:75],a[144:147],v[160:163],v[72:75]
v_min3_u32 v27,v27,v160,v164
v_mfma_f32_16x16x32_bf16 v[80:83],a[32:35],v[160:163],v[80:83]
ds_read_b128 v[188:191],v17 offset:30720
v_mfma_f32_16x16x32_bf16 v[76:79],a[148:151],v[164:167],v[76:79]
v_mfma_f32_16x16x32_bf16 v[84:87],a[36:39],v[164:167],v[84:87]
s_waitcnt vmcnt(2)
s_barrier
ds_read_b128 v[192:195],v17 offset:32768
s_waitcnt lgkmcnt(5)
v_mfma_f32_16x16x32_bf16 v[72:75],a[152:155],v[168:171],v[72:75]
v_min3_u32 v27,v27,v168,v172
v_mfma_f32_16x16x32_bf16 v[80:83],a[40:43],v[168:171],v[80:83]
ds_read_b128 v[196:199],v17 offset:34816
v_mfma_f32_16x16x32_bf16 v[76:79],a[156:159],v[172:175],v[76:79]
v_mfma_f32_16x16x32_bf16 v[84:87],a[44:47],v[172:175],v[84:87]
ds_read_b128 v[200:203],v17 offset:36864
s_waitcnt lgkmcnt(5)
v_mfma_f32_16x16x32_bf16 v[72:75],a[160:163],v[176:179],v[72:75]
v_min3_u32 v27,v27,v176,v180
v_mfma_f32_16x16x32_bf16 v[80:83],a[48:51],v[176:179],v[80:83]
ds_read_b128 v[204:207],v17 offset:38912
v_mfma_f32_16x16x32_bf16 v[76:79],a[164:167],v[180:183],v[76:79]
v_mfma_f32_16x16x32_bf16 v[84:87],a[52:55],v[180:183],v[84:87]
ds_read_b128 v[208:211],v17 offset:40960
s_waitcnt lgkmcnt(5)
v_mfma_f32_16x16x32_bf16 v[72:75],a[168:171],v[184:187],v[72:75]
v_min3_u32 v27,v27,v184,v188
v_mfma_f32_16x16x32_bf16 v[80:83],a[56:59],v[184:187],v[80:83]
ds_read_b128 v[212:215],v17 offset:43008
v_mfma_f32_16x16x32_bf16 v[76:79],a[172:175],v[188:191],v[76:79]
v_mfma_f32_16x16x32_bf16 v[84:87],a[60:63],v[188:191],v[84:87]
ds_read_b128 v[216:219],v17 offset:45056
s_waitcnt lgkmcnt(5)
v_mfma_f32_16x16x32_bf16 v[72:75],a[176:179],v[192:195],v[72:75]
v_min3_u32 v27,v27,v192,v196
s_waitcnt vmcnt(0)
v_mfma_f32_16x16x32_bf16 v[80:83],a[64:67],v[192:195],v[80:83]
ds_read_b128 v[220:223],v17 offset:47104
ds_bpermute_b32 v124,v41,v120
v_mfma_f32_16x16x32_bf16 v[76:79],a[180:183],v[196:199],v[76:79]
ds_bpermute_b32 v125,v41,v121
v_lshlrev_b32 v108,16,v122
v_mfma_f32_16x16x32_bf16 v[84:87],a[68:71],v[196:199],v[84:87]
ds_read_b128 v[224:227],v17 offset:49152
s_waitcnt lgkmcnt(7)
v_mfma_f32_16x16x32_bf16 v[72:75],a[184:187],v[200:203],v[72:75]
v_min3_u32 v27,v27,v200,v204
v_and_b32 v109,s80,v122
v_mfma_f32_16x16x32_bf16 v[80:83],a[72:75],v[200:203],v[80:83]
ds_read_b128 v[228:231],v17 offset:51200
v_lshlrev_b32 v110,16,v123
v_mfma_f32_16x16x32_bf16 v[76:79],a[188:191],v[204:207],v[76:79]
v_and_b32 v111,s80,v123
s_waitcnt lgkmcnt(2)
v_mfma_f32_16x16x32_bf16 v[84:87],a[76:79],v[204:207],v[84:87]
ds_read_b128 v[232:235],v17 offset:53248
v_mfma_f32_16x16x32_bf16 v[72:75],a[192:195],v[208:211],v[72:75]
v_min3_u32 v27,v27,v208,v212
v_lshlrev_b32 v104,16,v124
v_mfma_f32_16x16x32_bf16 v[80:83],a[80:83],v[208:211],v[80:83]
ds_read_b128 v[236:239],v17 offset:55296
v_and_b32 v105,s80,v124
v_mfma_f32_16x16x32_bf16 v[76:79],a[196:199],v[212:215],v[76:79]
v_lshlrev_b32 v106,16,v125
v_and_b32 v107,s80,v125
v_mfma_f32_16x16x32_bf16 v[84:87],a[84:87],v[212:215],v[84:87]
v_mfma_f32_16x16x32_bf16 v[72:75],a[200:203],v[216:219],v[72:75]
v_min3_u32 v27,v27,v216,v220
v_mfma_f32_16x16x32_bf16 v[80:83],a[88:91],v[216:219],v[80:83]
v_mfma_f32_16x16x32_bf16 v[76:79],a[204:207],v[220:223],v[76:79]
v_mfma_f32_16x16x32_bf16 v[84:87],a[92:95],v[220:223],v[84:87]
s_waitcnt lgkmcnt(2)
v_mfma_f32_16x16x32_bf16 v[72:75],a[208:211],v[224:227],v[72:75]
v_min3_u32 v27,v27,v224,v228
v_min3_u32 v27,v27,v226,v230
v_mfma_f32_16x16x32_bf16 v[80:83],a[96:99],v[224:227],v[80:83]
v_mfma_f32_16x16x32_bf16 v[76:79],a[212:215],v[228:231],v[76:79]
v_mfma_f32_16x16x32_bf16 v[84:87],a[100:103],v[228:231],v[84:87]
s_waitcnt lgkmcnt(0)
v_mfma_f32_16x16x32_bf16 v[72:75],a[216:219],v[232:235],v[72:75]
v_min3_u32 v27,v27,v232,v236
v_min3_u32 v27,v27,v234,v238
v_mfma_f32_16x16x32_bf16 v[80:83],a[104:107],v[232:235],v[80:83]
v_mfma_f32_16x16x32_bf16 v[76:79],a[220:223],v[236:239],v[76:79]
v_mfma_f32_16x16x32_bf16 v[84:87],a[108:111],v[236:239],v[84:87]
v_cmp_eq_u32 vcc,0,v27
s_and_b64 vcc,vcc,s[52:53]
s_cbranch_vccnz retry_349
buffer_load_dword v29,v21,s[20:23],s87 offen sc1
s_nop 6
v_add_f32 v72,v72,v76
v_add_f32 v73,v73,v77
v_add_f32 v74,v74,v78
v_add_f32 v75,v75,v79
v_and_or_b32 v72,v72,-4,s48
s_add_u32 s64,s77,s33
buffer_store_dwordx4 v[72:75],v25,s[20:23],s64 offen offset:1024 sc1
v_pk_add_f32 v[112:113],v[80:81],v[84:85]
v_pk_add_f32 v[112:113],v[112:113],v[108:109]
v_pk_add_f32 v[114:115],v[82:83],v[86:87]
v_pk_add_f32 v[114:115],v[114:115],v[110:111]
v_mov_b32 v116,v104
v_mov_b32 v117,v105
v_mov_b32 v118,v106
v_mov_b32 v119,v107
s_mov_b32 s40,s77
s_mov_b32 s60,s48
s_branch hjoin_371
r_w3_215:
s_load_dwordx2 s[4:5],s[0:1],80
s_mul_i32 s66,s59,224
s_lshl_b32 s67,s50,1
s_waitcnt lgkmcnt(0)
s_mov_b32 s32,s4
s_and_b32 s33,s5,0xffff
s_mov_b32 s34,0x700000
s_mov_b32 s35,0x20000
v_lshrrev_b32 v5,2,v3
v_lshl_add_u32 v5,v4,2,v5
v_and_b32 v6,3,v3
v_lshlrev_b32 v6,3,v6
v_lshl_add_u32 v6,v5,8,v6
v_and_b32 v5,7,v5
v_xor_b32 v5,s67,v5
v_lshl_add_u32 v12,v5,5,v6
v_xor_b32 v13,32,v12
v_and_b32 v5,15,v1
v_and_b32 v6,3,v4
v_lshlrev_b32 v6,1,v6
v_xor_b32 v5,v5,v6
v_mul_u32_u24 v6,7168,v4
v_xor_b32 v7,0,v5
v_lshl_add_u32 v8,v7,4,v6
v_xor_b32 v7,8,v5
v_lshl_add_u32 v9,v7,4,v6
s_mul_i32 s74,s50,458752
s_add_u32 s74,s74,s66
s_lshl_b32 s75,s50,14
s_mul_i32 s76,s50,229376
s_add_u32 s76,s76,s66
s_lshl_b32 s77,s50,13
s_add_u32 s64,s74,0
s_add_u32 m0,s75,0
s_nop 0
buffer_load_dwordx4 v8,s[32:35],s64 offen nt lds
s_add_u32 s64,s74,28672
s_add_u32 m0,s75,1024
s_nop 0
buffer_load_dwordx4 v9,s[32:35],s64 offen nt lds
s_add_u32 s64,s74,57344
s_add_u32 m0,s75,2048
s_nop 0
buffer_load_dwordx4 v8,s[32:35],s64 offen nt lds
s_add_u32 s64,s74,86016
s_add_u32 m0,s75,3072
s_nop 0
buffer_load_dwordx4 v9,s[32:35],s64 offen nt lds
s_add_u32 s64,s74,114688
s_add_u32 m0,s75,4096
s_nop 0
buffer_load_dwordx4 v8,s[32:35],s64 offen nt lds
s_add_u32 s64,s74,143360
s_add_u32 m0,s75,5120
s_nop 0
buffer_load_dwordx4 v9,s[32:35],s64 offen nt lds
s_add_u32 s64,s74,172032
s_add_u32 m0,s75,6144
s_nop 0
buffer_load_dwordx4 v8,s[32:35],s64 offen nt lds
s_add_u32 s64,s74,200704
s_add_u32 m0,s75,7168
s_nop 0
buffer_load_dwordx4 v9,s[32:35],s64 offen nt lds
s_add_u32 s64,s74,229376
s_add_u32 m0,s75,8192
s_nop 0
buffer_load_dwordx4 v8,s[32:35],s64 offen nt lds
s_add_u32 s64,s74,258048
s_add_u32 m0,s75,9216
s_nop 0
buffer_load_dwordx4 v9,s[32:35],s64 offen nt lds
s_add_u32 s64,s74,286720
s_add_u32 m0,s75,10240
s_nop 0
buffer_load_dwordx4 v8,s[32:35],s64 offen nt lds
s_add_u32 s64,s74,315392
s_add_u32 m0,s75,11264
s_nop 0
buffer_load_dwordx4 v9,s[32:35],s64 offen nt lds
s_add_u32 s64,s74,344064
s_add_u32 m0,s75,12288
s_nop 0
buffer_load_dwordx4 v8,s[32:35],s64 offen nt lds
s_add_u32 s64,s74,372736
s_add_u32 m0,s75,13312
s_nop 0
buffer_load_dwordx4 v9,s[32:35],s64 offen nt lds
s_add_u32 s64,s74,401408
s_add_u32 m0,s75,14336
s_nop 0
buffer_load_dwordx4 v8,s[32:35],s64 offen nt lds
s_add_u32 s64,s74,430080
s_add_u32 m0,s75,15360
s_nop 0
buffer_load_dwordx4 v9,s[32:35],s64 offen nt lds
s_add_u32 s64,s74,1835008
s_add_u32 m0,s75,65536
s_nop 0
buffer_load_dwordx4 v8,s[32:35],s64 offen nt lds
s_add_u32 s64,s74,1863680
s_add_u32 m0,s75,66560
s_nop 0
buffer_load_dwordx4 v9,s[32:35],s64 offen nt lds
s_add_u32 s64,s74,1892352
s_add_u32 m0,s75,67584
s_nop 0
buffer_load_dwordx4 v8,s[32:35],s64 offen nt lds
s_add_u32 s64,s74,1921024
s_add_u32 m0,s75,68608
s_nop 0
buffer_load_dwordx4 v9,s[32:35],s64 offen nt lds
s_add_u32 s64,s74,1949696
s_add_u32 m0,s75,69632
s_nop 0
buffer_load_dwordx4 v8,s[32:35],s64 offen nt lds
s_add_u32 s64,s74,1978368
s_add_u32 m0,s75,70656
s_nop 0
buffer_load_dwordx4 v9,s[32:35],s64 offen nt lds
s_add_u32 s64,s74,2007040
s_add_u32 m0,s75,71680
s_nop 0
buffer_load_dwordx4 v8,s[32:35],s64 offen nt lds
s_add_u32 s64,s74,2035712
s_add_u32 m0,s75,72704
s_nop 0
buffer_load_dwordx4 v9,s[32:35],s64 offen nt lds
s_add_u32 s64,s74,2064384
s_add_u32 m0,s75,73728
s_nop 0
buffer_load_dwordx4 v8,s[32:35],s64 offen nt lds
s_add_u32 s64,s74,2093056
s_add_u32 m0,s75,74752
s_nop 0
buffer_load_dwordx4 v9,s[32:35],s64 offen nt lds
s_add_u32 s64,s74,2121728
s_add_u32 m0,s75,75776
s_nop 0
buffer_load_dwordx4 v8,s[32:35],s64 offen nt lds
s_add_u32 s64,s74,2150400
s_add_u32 m0,s75,76800
s_nop 0
buffer_load_dwordx4 v9,s[32:35],s64 offen nt lds
s_add_u32 s64,s74,2179072
s_add_u32 m0,s75,77824
s_nop 0
buffer_load_dwordx4 v8,s[32:35],s64 offen nt lds
s_add_u32 s64,s74,2207744
s_add_u32 m0,s75,78848
s_nop 0
buffer_load_dwordx4 v9,s[32:35],s64 offen nt lds
s_add_u32 s64,s74,2236416
s_add_u32 m0,s75,79872
s_nop 0
buffer_load_dwordx4 v8,s[32:35],s64 offen nt lds
s_add_u32 s64,s74,2265088
s_add_u32 m0,s75,80896
s_nop 0
buffer_load_dwordx4 v9,s[32:35],s64 offen nt lds
s_waitcnt vmcnt(16)
s_barrier
ds_read_b64_tr_b16 a[0:1],v12 offset:0
ds_read_b64_tr_b16 a[128:129],v13 offset:0
ds_read_b64_tr_b16 a[2:3],v12 offset:4096
ds_read_b64_tr_b16 a[130:131],v13 offset:4096
ds_read_b64_tr_b16 a[4:5],v12 offset:8192
ds_read_b64_tr_b16 a[132:133],v13 offset:8192
ds_read_b64_tr_b16 a[6:7],v12 offset:12288
ds_read_b64_tr_b16 a[134:135],v13 offset:12288
s_waitcnt lgkmcnt(4)
ds_read_b64_tr_b16 a[8:9],v12 offset:16384
ds_read_b64_tr_b16 a[136:137],v13 offset:16384
ds_read_b64_tr_b16 a[10:11],v12 offset:20480
ds_read_b64_tr_b16 a[138:139],v13 offset:20480
ds_read_b64_tr_b16 a[12:13],v12 offset:24576
ds_read_b64_tr_b16 a[140:141],v13 offset:24576
ds_read_b64_tr_b16 a[14:15],v12 offset:28672
ds_read_b64_tr_b16 a[142:143],v13 offset:28672
s_waitcnt lgkmcnt(4)
ds_read_b64_tr_b16 a[16:17],v12 offset:32768
ds_read_b64_tr_b16 a[144:145],v13 offset:32768
ds_read_b64_tr_b16 a[18:19],v12 offset:36864
ds_read_b64_tr_b16 a[146:147],v13 offset:36864
ds_read_b64_tr_b16 a[20:21],v12 offset:40960
ds_read_b64_tr_b16 a[148:149],v13 offset:40960
ds_read_b64_tr_b16 a[22:23],v12 offset:45056
ds_read_b64_tr_b16 a[150:151],v13 offset:45056
s_waitcnt lgkmcnt(4)
ds_read_b64_tr_b16 a[24:25],v12 offset:49152
ds_read_b64_tr_b16 a[152:153],v13 offset:49152
ds_read_b64_tr_b16 a[26:27],v12 offset:53248
ds_read_b64_tr_b16 a[154:155],v13 offset:53248
ds_read_b64_tr_b16 a[28:29],v12 offset:57344
ds_read_b64_tr_b16 a[156:157],v13 offset:57344
ds_read_b64_tr_b16 a[30:31],v12 offset:61440
ds_read_b64_tr_b16 a[158:159],v13 offset:61440
s_waitcnt lgkmcnt(4)
v_xor_b32 v12,0x10000,v12
v_xor_b32 v13,0x10000,v13
s_waitcnt lgkmcnt(0)
s_barrier
s_add_u32 s64,s74,3670016
s_add_u32 m0,s75,0
s_nop 0
buffer_load_dwordx4 v8,s[32:35],s64 offen nt lds
s_add_u32 s64,s74,3698688
s_add_u32 m0,s75,1024
s_nop 0
buffer_load_dwordx4 v9,s[32:35],s64 offen nt lds
s_add_u32 s64,s74,3727360
s_add_u32 m0,s75,2048
s_nop 0
buffer_load_dwordx4 v8,s[32:35],s64 offen nt lds
s_add_u32 s64,s74,3756032
s_add_u32 m0,s75,3072
s_nop 0
buffer_load_dwordx4 v9,s[32:35],s64 offen nt lds
s_add_u32 s64,s74,3784704
s_add_u32 m0,s75,4096
s_nop 0
buffer_load_dwordx4 v8,s[32:35],s64 offen nt lds
s_add_u32 s64,s74,3813376
s_add_u32 m0,s75,5120
s_nop 0
buffer_load_dwordx4 v9,s[32:35],s64 offen nt lds
s_add_u32 s64,s74,3842048
s_add_u32 m0,s75,6144
s_nop 0
buffer_load_dwordx4 v8,s[32:35],s64 offen nt lds
s_add_u32 s64,s74,3870720
s_add_u32 m0,s75,7168
s_nop 0
buffer_load_dwordx4 v9,s[32:35],s64 offen nt lds
s_add_u32 s64,s74,3899392
s_add_u32 m0,s75,8192
s_nop 0
buffer_load_dwordx4 v8,s[32:35],s64 offen nt lds
s_add_u32 s64,s74,3928064
s_add_u32 m0,s75,9216
s_nop 0
buffer_load_dwordx4 v9,s[32:35],s64 offen nt lds
s_add_u32 s64,s74,3956736
s_add_u32 m0,s75,10240
s_nop 0
buffer_load_dwordx4 v8,s[32:35],s64 offen nt lds
s_add_u32 s64,s74,3985408
s_add_u32 m0,s75,11264
s_nop 0
buffer_load_dwordx4 v9,s[32:35],s64 offen nt lds
s_add_u32 s64,s74,4014080
s_add_u32 m0,s75,12288
s_nop 0
buffer_load_dwordx4 v8,s[32:35],s64 offen nt lds
s_add_u32 s64,s74,4042752
s_add_u32 m0,s75,13312
s_nop 0
buffer_load_dwordx4 v9,s[32:35],s64 offen nt lds
s_add_u32 s64,s74,4071424
s_add_u32 m0,s75,14336
s_nop 0
buffer_load_dwordx4 v8,s[32:35],s64 offen nt lds
s_add_u32 s64,s74,4100096
s_add_u32 m0,s75,15360
s_nop 0
buffer_load_dwordx4 v9,s[32:35],s64 offen nt lds
s_waitcnt vmcnt(16)
s_barrier
ds_read_b64_tr_b16 a[32:33],v12 offset:0
ds_read_b64_tr_b16 a[160:161],v13 offset:0
ds_read_b64_tr_b16 a[34:35],v12 offset:4096
ds_read_b64_tr_b16 a[162:163],v13 offset:4096
ds_read_b64_tr_b16 a[36:37],v12 offset:8192
ds_read_b64_tr_b16 a[164:165],v13 offset:8192
ds_read_b64_tr_b16 a[38:39],v12 offset:12288
ds_read_b64_tr_b16 a[166:167],v13 offset:12288
s_waitcnt lgkmcnt(4)
ds_read_b64_tr_b16 a[40:41],v12 offset:16384
ds_read_b64_tr_b16 a[168:169],v13 offset:16384
ds_read_b64_tr_b16 a[42:43],v12 offset:20480
ds_read_b64_tr_b16 a[170:171],v13 offset:20480
ds_read_b64_tr_b16 a[44:45],v12 offset:24576
ds_read_b64_tr_b16 a[172:173],v13 offset:24576
ds_read_b64_tr_b16 a[46:47],v12 offset:28672
ds_read_b64_tr_b16 a[174:175],v13 offset:28672
s_waitcnt lgkmcnt(4)
ds_read_b64_tr_b16 a[48:49],v12 offset:32768
ds_read_b64_tr_b16 a[176:177],v13 offset:32768
ds_read_b64_tr_b16 a[50:51],v12 offset:36864
ds_read_b64_tr_b16 a[178:179],v13 offset:36864
ds_read_b64_tr_b16 a[52:53],v12 offset:40960
ds_read_b64_tr_b16 a[180:181],v13 offset:40960
ds_read_b64_tr_b16 a[54:55],v12 offset:45056
ds_read_b64_tr_b16 a[182:183],v13 offset:45056
s_waitcnt lgkmcnt(4)
ds_read_b64_tr_b16 a[56:57],v12 offset:49152
ds_read_b64_tr_b16 a[184:185],v13 offset:49152
ds_read_b64_tr_b16 a[58:59],v12 offset:53248
ds_read_b64_tr_b16 a[186:187],v13 offset:53248
ds_read_b64_tr_b16 a[60:61],v12 offset:57344
ds_read_b64_tr_b16 a[188:189],v13 offset:57344
ds_read_b64_tr_b16 a[62:63],v12 offset:61440
ds_read_b64_tr_b16 a[190:191],v13 offset:61440
s_waitcnt lgkmcnt(4)
v_xor_b32 v12,0x10000,v12
v_xor_b32 v13,0x10000,v13
s_waitcnt lgkmcnt(0)
s_barrier
s_add_u32 s64,s74,5505024
s_add_u32 m0,s75,65536
s_nop 0
buffer_load_dwordx4 v8,s[32:35],s64 offen nt lds
s_add_u32 s64,s74,5533696
s_add_u32 m0,s75,66560
s_nop 0
buffer_load_dwordx4 v9,s[32:35],s64 offen nt lds
s_add_u32 s64,s74,5562368
s_add_u32 m0,s75,67584
s_nop 0
buffer_load_dwordx4 v8,s[32:35],s64 offen nt lds
s_add_u32 s64,s74,5591040
s_add_u32 m0,s75,68608
s_nop 0
buffer_load_dwordx4 v9,s[32:35],s64 offen nt lds
s_add_u32 s64,s74,5619712
s_add_u32 m0,s75,69632
s_nop 0
buffer_load_dwordx4 v8,s[32:35],s64 offen nt lds
s_add_u32 s64,s74,5648384
s_add_u32 m0,s75,70656
s_nop 0
buffer_load_dwordx4 v9,s[32:35],s64 offen nt lds
s_add_u32 s64,s74,5677056
s_add_u32 m0,s75,71680
s_nop 0
buffer_load_dwordx4 v8,s[32:35],s64 offen nt lds
s_add_u32 s64,s74,5705728
s_add_u32 m0,s75,72704
s_nop 0
buffer_load_dwordx4 v9,s[32:35],s64 offen nt lds
s_add_u32 s64,s74,5734400
s_add_u32 m0,s75,73728
s_nop 0
buffer_load_dwordx4 v8,s[32:35],s64 offen nt lds
s_add_u32 s64,s74,5763072
s_add_u32 m0,s75,74752
s_nop 0
buffer_load_dwordx4 v9,s[32:35],s64 offen nt lds
s_add_u32 s64,s74,5791744
s_add_u32 m0,s75,75776
s_nop 0
buffer_load_dwordx4 v8,s[32:35],s64 offen nt lds
s_add_u32 s64,s74,5820416
s_add_u32 m0,s75,76800
s_nop 0
buffer_load_dwordx4 v9,s[32:35],s64 offen nt lds
s_add_u32 s64,s74,5849088
s_add_u32 m0,s75,77824
s_nop 0
buffer_load_dwordx4 v8,s[32:35],s64 offen nt lds
s_add_u32 s64,s74,5877760
s_add_u32 m0,s75,78848
s_nop 0
buffer_load_dwordx4 v9,s[32:35],s64 offen nt lds
s_add_u32 s64,s74,5906432
s_add_u32 m0,s75,79872
s_nop 0
buffer_load_dwordx4 v8,s[32:35],s64 offen nt lds
s_add_u32 s64,s74,5935104
s_add_u32 m0,s75,80896
s_nop 0
buffer_load_dwordx4 v9,s[32:35],s64 offen nt lds
s_waitcnt vmcnt(16)
s_barrier
ds_read_b64_tr_b16 a[64:65],v12 offset:0
ds_read_b64_tr_b16 a[192:193],v13 offset:0
ds_read_b64_tr_b16 a[66:67],v12 offset:4096
ds_read_b64_tr_b16 a[194:195],v13 offset:4096
ds_read_b64_tr_b16 a[68:69],v12 offset:8192
ds_read_b64_tr_b16 a[196:197],v13 offset:8192
ds_read_b64_tr_b16 a[70:71],v12 offset:12288
ds_read_b64_tr_b16 a[198:199],v13 offset:12288
s_waitcnt lgkmcnt(4)
ds_read_b64_tr_b16 a[72:73],v12 offset:16384
ds_read_b64_tr_b16 a[200:201],v13 offset:16384
ds_read_b64_tr_b16 a[74:75],v12 offset:20480
ds_read_b64_tr_b16 a[202:203],v13 offset:20480
ds_read_b64_tr_b16 a[76:77],v12 offset:24576
ds_read_b64_tr_b16 a[204:205],v13 offset:24576
ds_read_b64_tr_b16 a[78:79],v12 offset:28672
ds_read_b64_tr_b16 a[206:207],v13 offset:28672
s_waitcnt lgkmcnt(4)
ds_read_b64_tr_b16 a[80:81],v12 offset:32768
ds_read_b64_tr_b16 a[208:209],v13 offset:32768
ds_read_b64_tr_b16 a[82:83],v12 offset:36864
ds_read_b64_tr_b16 a[210:211],v13 offset:36864
ds_read_b64_tr_b16 a[84:85],v12 offset:40960
ds_read_b64_tr_b16 a[212:213],v13 offset:40960
ds_read_b64_tr_b16 a[86:87],v12 offset:45056
ds_read_b64_tr_b16 a[214:215],v13 offset:45056
s_waitcnt lgkmcnt(4)
ds_read_b64_tr_b16 a[88:89],v12 offset:49152
ds_read_b64_tr_b16 a[216:217],v13 offset:49152
ds_read_b64_tr_b16 a[90:91],v12 offset:53248
ds_read_b64_tr_b16 a[218:219],v13 offset:53248
ds_read_b64_tr_b16 a[92:93],v12 offset:57344
ds_read_b64_tr_b16 a[220:221],v13 offset:57344
ds_read_b64_tr_b16 a[94:95],v12 offset:61440
ds_read_b64_tr_b16 a[222:223],v13 offset:61440
s_waitcnt lgkmcnt(4)
v_xor_b32 v12,0x10000,v12
v_xor_b32 v13,0x10000,v13
s_waitcnt lgkmcnt(0)
s_barrier
s_waitcnt vmcnt(0)
s_barrier
ds_read_b64_tr_b16 a[96:97],v12 offset:0
ds_read_b64_tr_b16 a[224:225],v13 offset:0
ds_read_b64_tr_b16 a[98:99],v12 offset:4096
ds_read_b64_tr_b16 a[226:227],v13 offset:4096
ds_read_b64_tr_b16 a[100:101],v12 offset:8192
ds_read_b64_tr_b16 a[228:229],v13 offset:8192
ds_read_b64_tr_b16 a[102:103],v12 offset:12288
ds_read_b64_tr_b16 a[230:231],v13 offset:12288
s_waitcnt lgkmcnt(4)
ds_read_b64_tr_b16 a[104:105],v12 offset:16384
ds_read_b64_tr_b16 a[232:233],v13 offset:16384
ds_read_b64_tr_b16 a[106:107],v12 offset:20480
ds_read_b64_tr_b16 a[234:235],v13 offset:20480
ds_read_b64_tr_b16 a[108:109],v12 offset:24576
ds_read_b64_tr_b16 a[236:237],v13 offset:24576
ds_read_b64_tr_b16 a[110:111],v12 offset:28672
ds_read_b64_tr_b16 a[238:239],v13 offset:28672
s_waitcnt lgkmcnt(4)
ds_read_b64_tr_b16 a[112:113],v12 offset:32768
ds_read_b64_tr_b16 a[240:241],v13 offset:32768
ds_read_b64_tr_b16 a[114:115],v12 offset:36864
ds_read_b64_tr_b16 a[242:243],v13 offset:36864
ds_read_b64_tr_b16 a[116:117],v12 offset:40960
ds_read_b64_tr_b16 a[244:245],v13 offset:40960
ds_read_b64_tr_b16 a[118:119],v12 offset:45056
ds_read_b64_tr_b16 a[246:247],v13 offset:45056
s_waitcnt lgkmcnt(4)
ds_read_b64_tr_b16 a[120:121],v12 offset:49152
ds_read_b64_tr_b16 a[248:249],v13 offset:49152
ds_read_b64_tr_b16 a[122:123],v12 offset:53248
ds_read_b64_tr_b16 a[250:251],v13 offset:53248
ds_read_b64_tr_b16 a[124:125],v12 offset:57344
ds_read_b64_tr_b16 a[252:253],v13 offset:57344
ds_read_b64_tr_b16 a[126:127],v12 offset:61440
ds_read_b64_tr_b16 a[254:255],v13 offset:61440
s_waitcnt lgkmcnt(4)
v_xor_b32 v12,0x10000,v12
v_xor_b32 v13,0x10000,v13
s_waitcnt lgkmcnt(0)
s_barrier
v_mov_b32 v88,0x3f803f80
v_mov_b32 v89,0x3f803f80
v_mov_b32 v90,0x3f803f80
v_mov_b32 v91,0x3f803f80
s_nop 1
v_mfma_f32_16x16x32_bf16 v[52:55],a[0:3],v[88:91],0
v_mfma_f32_16x16x32_bf16 v[56:59],a[128:131],v[88:91],0
v_mfma_f32_16x16x32_bf16 v[52:55],a[4:7],v[88:91],v[52:55]
v_mfma_f32_16x16x32_bf16 v[56:59],a[132:135],v[88:91],v[56:59]
v_mfma_f32_16x16x32_bf16 v[52:55],a[8:11],v[88:91],v[52:55]
v_mfma_f32_16x16x32_bf16 v[56:59],a[136:139],v[88:91],v[56:59]
v_mfma_f32_16x16x32_bf16 v[52:55],a[12:15],v[88:91],v[52:55]
v_mfma_f32_16x16x32_bf16 v[56:59],a[140:143],v[88:91],v[56:59]
v_mfma_f32_16x16x32_bf16 v[52:55],a[16:19],v[88:91],v[52:55]
v_mfma_f32_16x16x32_bf16 v[56:59],a[144:147],v[88:91],v[56:59]
v_mfma_f32_16x16x32_bf16 v[52:55],a[20:23],v[88:91],v[52:55]
v_mfma_f32_16x16x32_bf16 v[56:59],a[148:151],v[88:91],v[56:59]
v_mfma_f32_16x16x32_bf16 v[52:55],a[24:27],v[88:91],v[52:55]
v_mfma_f32_16x16x32_bf16 v[56:59],a[152:155],v[88:91],v[56:59]
v_mfma_f32_16x16x32_bf16 v[52:55],a[28:31],v[88:91],v[52:55]
v_mfma_f32_16x16x32_bf16 v[56:59],a[156:159],v[88:91],v[56:59]
v_mfma_f32_16x16x32_bf16 v[52:55],a[32:35],v[88:91],v[52:55]
v_mfma_f32_16x16x32_bf16 v[56:59],a[160:163],v[88:91],v[56:59]
v_mfma_f32_16x16x32_bf16 v[52:55],a[36:39],v[88:91],v[52:55]
v_mfma_f32_16x16x32_bf16 v[56:59],a[164:167],v[88:91],v[56:59]
v_mfma_f32_16x16x32_bf16 v[52:55],a[40:43],v[88:91],v[52:55]
v_mfma_f32_16x16x32_bf16 v[56:59],a[168:171],v[88:91],v[56:59]
v_mfma_f32_16x16x32_bf16 v[52:55],a[44:47],v[88:91],v[52:55]
v_mfma_f32_16x16x32_bf16 v[56:59],a[172:175],v[88:91],v[56:59]
v_mfma_f32_16x16x32_bf16 v[52:55],a[48:51],v[88:91],v[52:55]
v_mfma_f32_16x16x32_bf16 v[56:59],a[176:179],v[88:91],v[56:59]
v_mfma_f32_16x16x32_bf16 v[52:55],a[52:55],v[88:91],v[52:55]
v_mfma_f32_16x16x32_bf16 v[56:59],a[180:183],v[88:91],v[56:59]
v_mfma_f32_16x16x32_bf16 v[52:55],a[56:59],v[88:91],v[52:55]
v_mfma_f32_16x16x32_bf16 v[56:59],a[184:187],v[88:91],v[56:59]
v_mfma_f32_16x16x32_bf16 v[52:55],a[60:63],v[88:91],v[52:55]
v_mfma_f32_16x16x32_bf16 v[56:59],a[188:191],v[88:91],v[56:59]
v_mfma_f32_16x16x32_bf16 v[52:55],a[64:67],v[88:91],v[52:55]
v_mfma_f32_16x16x32_bf16 v[56:59],a[192:195],v[88:91],v[56:59]
v_mfma_f32_16x16x32_bf16 v[52:55],a[68:71],v[88:91],v[52:55]
v_mfma_f32_16x16x32_bf16 v[56:59],a[196:199],v[88:91],v[56:59]
v_mfma_f32_16x16x32_bf16 v[52:55],a[72:75],v[88:91],v[52:55]
v_mfma_f32_16x16x32_bf16 v[56:59],a[200:203],v[88:91],v[56:59]
v_mfma_f32_16x16x32_bf16 v[52:55],a[76:79],v[88:91],v[52:55]
v_mfma_f32_16x16x32_bf16 v[56:59],a[204:207],v[88:91],v[56:59]
v_mfma_f32_16x16x32_bf16 v[52:55],a[80:83],v[88:91],v[52:55]
v_mfma_f32_16x16x32_bf16 v[56:59],a[208:211],v[88:91],v[56:59]
v_mfma_f32_16x16x32_bf16 v[52:55],a[84:87],v[88:91],v[52:55]
v_mfma_f32_16x16x32_bf16 v[56:59],a[212:215],v[88:91],v[56:59]
v_mfma_f32_16x16x32_bf16 v[52:55],a[88:91],v[88:91],v[52:55]
v_mfma_f32_16x16x32_bf16 v[56:59],a[216:219],v[88:91],v[56:59]
v_mfma_f32_16x16x32_bf16 v[52:55],a[92:95],v[88:91],v[52:55]
v_mfma_f32_16x16x32_bf16 v[56:59],a[220:223],v[88:91],v[56:59]
v_mfma_f32_16x16x32_bf16 v[52:55],a[96:99],v[88:91],v[52:55]
v_mfma_f32_16x16x32_bf16 v[56:59],a[224:227],v[88:91],v[56:59]
v_mfma_f32_16x16x32_bf16 v[52:55],a[100:103],v[88:91],v[52:55]
v_mfma_f32_16x16x32_bf16 v[56:59],a[228:231],v[88:91],v[56:59]
v_mfma_f32_16x16x32_bf16 v[52:55],a[104:107],v[88:91],v[52:55]
v_mfma_f32_16x16x32_bf16 v[56:59],a[232:235],v[88:91],v[56:59]
v_mfma_f32_16x16x32_bf16 v[52:55],a[108:111],v[88:91],v[52:55]
v_mfma_f32_16x16x32_bf16 v[56:59],a[236:239],v[88:91],v[56:59]
v_mfma_f32_16x16x32_bf16 v[52:55],a[112:115],v[88:91],v[52:55]
v_mfma_f32_16x16x32_bf16 v[56:59],a[240:243],v[88:91],v[56:59]
v_mfma_f32_16x16x32_bf16 v[52:55],a[116:119],v[88:91],v[52:55]
v_mfma_f32_16x16x32_bf16 v[56:59],a[244:247],v[88:91],v[56:59]
v_mfma_f32_16x16x32_bf16 v[52:55],a[120:123],v[88:91],v[52:55]
v_mfma_f32_16x16x32_bf16 v[56:59],a[248:251],v[88:91],v[56:59]
v_mfma_f32_16x16x32_bf16 v[52:55],a[124:127],v[88:91],v[52:55]
v_mfma_f32_16x16x32_bf16 v[56:59],a[252:255],v[88:91],v[56:59]
v_and_b32 v21,1,v1
v_mul_u32_u24 v21,960,v21
s_mov_b32 s65,21052032
s_mov_b32 s66,1792
pl_372:
buffer_load_dword v22,v21,s[20:23],s65 offen sc1
s_waitcnt vmcnt(0)
v_cmp_gt_u32 vcc,s66,v22
s_cbranch_vccz pok_373
s_sleep 1
s_sub_u32 s90,s90,1
s_cmp_gt_i32 s90,0
s_cbranch_scc1 pl_372
pok_373:
s_mov_b32 s81,0xbdd2d3e8
v_mov_b32 v28,0xc0135761
s_lshr_b32 s41,s59,3
s_and_b32 s42,s59,7
s_mul_i32 s64,s42,3
s_add_u32 s64,s64,s50
s_lshr_b32 s65,s42,1
s_add_u32 s65,s65,24
s_cmp_eq_u32 s50,3
s_cselect_b32 s64,s65,s64
s_and_b32 s65,s42,1
s_lshl_b32 s65,s65,3
s_cmp_eq_u32 s50,3
s_cselect_b32 s65,s65,0
s_and_b32 s66,s64,3
s_lshl_b32 s66,s66,11
s_add_u32 s65,s65,s66
s_lshr_b32 s64,s64,2
s_mul_i32 s66,s41,7
s_add_u32 s64,s64,s66
s_add_u32 s64,s64,81
s_lshl_b32 s64,s64,14
s_add_u32 s64,s64,s65
v_add_u32 v18,s64,v16
v_mov_b32 v17,v16
v_lshlrev_b32 v19,4,v3
v_add_u32 v19,131072,v19
v_and_b32 v21,7,v1
v_lshlrev_b32 v21,7,v21
v_bfe_u32 v6,v1,3,2
v_lshl_add_u32 v21,v6,2,v21
s_add_u32 s74,s63,6144
s_add_u32 s74,s74,s60
s_lshl_b32 s73,s59,7
s_lshl_b32 s64,s50,2
s_add_u32 s73,s73,s64
s_add_u32 s73,s73,s63
s_add_u32 s73,s73,20480
s_lshl_b32 s64,s60,4
s_add_u32 s73,s73,s64
s_mov_b32 s82,0x3a800000
s_mov_b32 s64,0
s_lshr_b32 s65,s50,1
s_and_b32 s66,s50,1
s_lshl_b32 s66,s66,12
s_add_u32 s66,s66,s64
s_lshl_b32 s72,s65,13
s_add_u32 s72,s72,s66
s_add_u32 s72,s72,0x10000
s_lshl_b32 s65,s65,14
s_add_u32 s75,s65,s66
s_add_u32 s75,s75,1179648
s_cmp_eq_u32 s50,3
s_cbranch_scc1 w3b_374
s_add_u32 s64,s79,0
s_lshl_b32 s70,s64,21
s_lshl_b32 s64,s64,13
s_and_b32 s64,s64,0x2000
s_xor_b32 s64,s64,s62
s_add_u32 s70,s70,s64
s_add_u32 s70,s70,29360128
s_mov_b32 s83,1
s_mov_b32 s87,s74
s_cmp_eq_u32 s50,0
s_cselect_b32 s74,s74,0x7fff0000
v_mov_b32 v47,132096
s_lshl_b32 s64,s50,3
s_add_u32 s64,s64,132096
v_mov_b32 v46,s64
v_mov_b32 v29,0
s_mov_b32 s97,0x7fff0000
s_mov_b32 s69,1
s_mov_b32 s68,0
s_mov_b32 s52,0x30003
s_mov_b32 s53,s52
seg_376:
s_cmp_eq_u32 s83,0
s_cbranch_scc1 ahead_377
s_add_u32 s94,s70,s75
s_xor_b32 s95,s94,1024
s_xor_b32 s91,s72,0x10000
s_cmp_eq_u32 s69,0
s_mov_b32 s69,1
s_cbranch_scc1 half2_381
s_waitcnt vmcnt(2)
v_cmp_gt_u32 vcc,s71,v29
s_cbranch_vccz nb_380
s_waitcnt vmcnt(0)
v_add_u32 v22,s71,-1
buffer_store_dword v22,v23,s[20:23],s97 offen sc1
s_mov_b32 s97,0x7fff0000
s_cmp_lg_u32 s50,0
s_cbranch_scc1 nb_380
buffer_load_dword v32,v21,s[20:23],s74 offen sc1
s_sleep 2
pl_382:
buffer_load_dword v33,v21,s[20:23],s74 offen sc1
s_waitcnt vmcnt(1)
v_cmp_gt_u32 vcc,s71,v32
v_mov_b32 v29,v32
s_cbranch_vccz pok_383
buffer_load_dword v32,v21,s[20:23],s74 offen sc1
s_waitcnt vmcnt(1)
v_cmp_gt_u32 vcc,s71,v33
v_mov_b32 v29,v33
s_cbranch_vccz pok_383
s_sub_u32 s90,s90,1
s_cmp_gt_i32 s90,0
s_cbranch_scc1 pl_382
pok_383:
nb_380:
s_cmp_eq_u32 s71,64
s_barrier
s_cbranch_scc1 half_384
s_xor_b32 m0,s91,0
s_add_u32 s65,s94,0
buffer_load_dwordx4 v16,s[20:23],s65 offen offset:0 sc1 lds
buffer_load_dwordx4 v16,s[20:23],s65 offen offset:2048 sc1 lds
s_xor_b32 m0,s91,16384
s_add_u32 s65,s94,32768
buffer_load_dwordx4 v16,s[20:23],s65 offen offset:0 sc1 lds
buffer_load_dwordx4 v16,s[20:23],s65 offen offset:2048 sc1 lds
s_xor_b32 m0,s91,32768
s_add_u32 s65,s94,65536
buffer_load_dwordx4 v16,s[20:23],s65 offen offset:0 sc1 lds
buffer_load_dwordx4 v16,s[20:23],s65 offen offset:2048 sc1 lds
s_xor_b32 m0,s91,49152
s_add_u32 s65,s94,98304
buffer_load_dwordx4 v16,s[20:23],s65 offen offset:0 sc1 lds
buffer_load_dwordx4 v16,s[20:23],s65 offen offset:2048 sc1 lds
s_waitcnt vmcnt(8)
v_add_u32 v22,s71,-1
buffer_store_dword v22,v23,s[20:23],s97 offen sc1
s_mov_b32 s97,0x7fff0000
s_waitcnt vmcnt(7)
s_barrier
ds_read_b128 v[224:227],v17 offset:0
ds_read_b128 v[228:231],v17 offset:2048
ds_read_b128 v[232:235],v17 offset:4096
ds_read_b128 v[236:239],v17 offset:6144
ds_read_b128 v[240:243],v17 offset:8192
ds_read_b128 v[244:247],v17 offset:10240
ds_read_b128 v[248:251],v17 offset:12288
s_waitcnt lgkmcnt(5)
v_mfma_f32_16x16x32_bf16 v[64:67],a[0:3],v[224:227],0
s_xor_b32 m0,s91,1024
s_add_u32 s96,s71,1
s_add_u32 s92,s71,2
v_min_u32 v27,v224,v228
v_mfma_f32_16x16x32_bf16 v[72:75],a[128:131],v[224:227],0
ds_read_b128 v[252:255],v17 offset:14336
s_cmp_eq_u32 s96,64
s_cselect_b32 s96,99,s96
v_mfma_f32_16x16x32_bf16 v[64:67],a[4:7],v[228:231],v[64:67]
s_add_u32 s65,s95,0
s_cmp_eq_u32 s92,64
s_cselect_b32 s92,99,s92
v_mfma_f32_16x16x32_bf16 v[72:75],a[132:135],v[228:231],v[72:75]
s_waitcnt vmcnt(5)
s_barrier
ds_read_b128 v[224:227],v17 offset:16384
s_waitcnt lgkmcnt(5)
v_mfma_f32_16x16x32_bf16 v[64:67],a[8:11],v[232:235],v[64:67]
buffer_load_dwordx4 v16,s[20:23],s65 offen offset:0 sc1 lds
v_mfma_f32_16x16x32_bf16 v[72:75],a[136:139],v[232:235],v[72:75]
ds_read_b128 v[228:231],v17 offset:18432
v_min3_u32 v27,v27,v232,v236
v_mfma_f32_16x16x32_bf16 v[64:67],a[12:15],v[236:239],v[64:67]
buffer_load_dwordx4 v16,s[20:23],s65 offen offset:2048 sc1 lds
v_mfma_f32_16x16x32_bf16 v[72:75],a[140:143],v[236:239],v[72:75]
ds_read_b128 v[232:235],v17 offset:20480
s_waitcnt lgkmcnt(5)
v_mfma_f32_16x16x32_bf16 v[64:67],a[16:19],v[240:243],v[64:67]
s_xor_b32 m0,s91,17408
v_min3_u32 v27,v27,v240,v244
v_mfma_f32_16x16x32_bf16 v[72:75],a[144:147],v[240:243],v[72:75]
ds_read_b128 v[236:239],v17 offset:22528
v_mfma_f32_16x16x32_bf16 v[64:67],a[20:23],v[244:247],v[64:67]
s_add_u32 s65,s95,32768
v_mfma_f32_16x16x32_bf16 v[72:75],a[148:151],v[244:247],v[72:75]
ds_read_b128 v[240:243],v17 offset:24576
s_waitcnt lgkmcnt(5)
v_mfma_f32_16x16x32_bf16 v[64:67],a[24:27],v[248:251],v[64:67]
buffer_load_dwordx4 v16,s[20:23],s65 offen offset:0 sc1 lds
v_mfma_f32_16x16x32_bf16 v[72:75],a[152:155],v[248:251],v[72:75]
ds_read_b128 v[244:247],v17 offset:26624
v_min3_u32 v27,v27,v248,v252
v_mfma_f32_16x16x32_bf16 v[64:67],a[28:31],v[252:255],v[64:67]
buffer_load_dwordx4 v16,s[20:23],s65 offen offset:2048 sc1 lds
v_mfma_f32_16x16x32_bf16 v[72:75],a[156:159],v[252:255],v[72:75]
ds_read_b128 v[248:251],v17 offset:28672
s_waitcnt lgkmcnt(5)
v_mfma_f32_16x16x32_bf16 v[64:67],a[32:35],v[224:227],v[64:67]
s_xor_b32 m0,s91,33792
v_min3_u32 v27,v27,v224,v228
v_mfma_f32_16x16x32_bf16 v[72:75],a[160:163],v[224:227],v[72:75]
ds_read_b128 v[252:255],v17 offset:30720
v_mfma_f32_16x16x32_bf16 v[64:67],a[36:39],v[228:231],v[64:67]
s_add_u32 s65,s95,65536
v_mfma_f32_16x16x32_bf16 v[72:75],a[164:167],v[228:231],v[72:75]
s_waitcnt vmcnt(5)
s_barrier
ds_read_b128 v[224:227],v17 offset:32768
s_waitcnt lgkmcnt(5)
v_mfma_f32_16x16x32_bf16 v[64:67],a[40:43],v[232:235],v[64:67]
buffer_load_dwordx4 v16,s[20:23],s65 offen offset:0 sc1 lds
v_mfma_f32_16x16x32_bf16 v[72:75],a[168:171],v[232:235],v[72:75]
ds_read_b128 v[228:231],v17 offset:34816
v_min3_u32 v27,v27,v232,v236
v_mfma_f32_16x16x32_bf16 v[64:67],a[44:47],v[236:239],v[64:67]
buffer_load_dwordx4 v16,s[20:23],s65 offen offset:2048 sc1 lds
v_mfma_f32_16x16x32_bf16 v[72:75],a[172:175],v[236:239],v[72:75]
ds_read_b128 v[232:235],v17 offset:36864
s_waitcnt lgkmcnt(5)
v_mfma_f32_16x16x32_bf16 v[64:67],a[48:51],v[240:243],v[64:67]
s_xor_b32 m0,s91,50176
v_min3_u32 v27,v27,v240,v244
v_mfma_f32_16x16x32_bf16 v[72:75],a[176:179],v[240:243],v[72:75]
ds_read_b128 v[236:239],v17 offset:38912
v_mfma_f32_16x16x32_bf16 v[64:67],a[52:55],v[244:247],v[64:67]
s_add_u32 s65,s95,98304
v_mfma_f32_16x16x32_bf16 v[72:75],a[180:183],v[244:247],v[72:75]
ds_read_b128 v[240:243],v17 offset:40960
s_waitcnt lgkmcnt(5)
v_mfma_f32_16x16x32_bf16 v[64:67],a[56:59],v[248:251],v[64:67]
buffer_load_dwordx4 v16,s[20:23],s65 offen offset:0 sc1 lds
v_min3_u32 v27,v27,v248,v252
v_mfma_f32_16x16x32_bf16 v[72:75],a[184:187],v[248:251],v[72:75]
ds_read_b128 v[244:247],v17 offset:43008
s_waitcnt vmcnt(63)
v_mfma_f32_16x16x32_bf16 v[64:67],a[60:63],v[252:255],v[64:67]
buffer_load_dwordx4 v16,s[20:23],s65 offen offset:2048 sc1 lds
v_mfma_f32_16x16x32_bf16 v[72:75],a[188:191],v[252:255],v[72:75]
ds_read_b128 v[248:251],v17 offset:45056
s_waitcnt lgkmcnt(5)
v_mfma_f32_16x16x32_bf16 v[64:67],a[64:67],v[224:227],v[64:67]
v_cmp_gt_u32 vcc,s96,v29
v_cmp_gt_u32 s[92:93],s92,v29
v_mfma_f32_16x16x32_bf16 v[72:75],a[192:195],v[224:227],v[72:75]
ds_read_b128 v[252:255],v17 offset:47104
v_min3_u32 v27,v27,v224,v228
v_mfma_f32_16x16x32_bf16 v[64:67],a[68:71],v[228:231],v[64:67]
v_mov_b32 v44,vcc_lo
v_mov_b32 v45,s92
v_mfma_f32_16x16x32_bf16 v[72:75],a[196:199],v[228:231],v[72:75]
ds_read_b128 v[224:227],v17 offset:49152
s_waitcnt lgkmcnt(5)
v_mfma_f32_16x16x32_bf16 v[64:67],a[72:75],v[232:235],v[64:67]
ds_write_b64 v46,v[44:45]
v_min3_u32 v27,v27,v232,v236
v_mfma_f32_16x16x32_bf16 v[72:75],a[200:203],v[232:235],v[72:75]
ds_read_b128 v[228:231],v17 offset:51200
v_mfma_f32_16x16x32_bf16 v[64:67],a[76:79],v[236:239],v[64:67]
v_mfma_f32_16x16x32_bf16 v[72:75],a[204:207],v[236:239],v[72:75]
ds_read_b128 v[232:235],v17 offset:53248
s_waitcnt lgkmcnt(6)
v_mfma_f32_16x16x32_bf16 v[64:67],a[80:83],v[240:243],v[64:67]
v_min3_u32 v27,v27,v240,v244
s_add_u32 s88,s70,s75
v_mfma_f32_16x16x32_bf16 v[72:75],a[208:211],v[240:243],v[72:75]
ds_read_b128 v[236:239],v17 offset:55296
s_add_u32 s88,s88,2097152
v_mfma_f32_16x16x32_bf16 v[64:67],a[84:87],v[244:247],v[64:67]
s_xor_b32 s88,s88,0x2000
s_xor_b32 s89,s88,1024
v_mfma_f32_16x16x32_bf16 v[72:75],a[212:215],v[244:247],v[72:75]
ds_read_b128 v[240:243],v17 offset:57344
s_waitcnt lgkmcnt(6)
v_mfma_f32_16x16x32_bf16 v[64:67],a[88:91],v[248:251],v[64:67]
v_min3_u32 v27,v27,v248,v252
v_mfma_f32_16x16x32_bf16 v[72:75],a[216:219],v[248:251],v[72:75]
ds_read_b128 v[244:247],v17 offset:59392
v_mfma_f32_16x16x32_bf16 v[64:67],a[92:95],v[252:255],v[64:67]
v_mfma_f32_16x16x32_bf16 v[72:75],a[220:223],v[252:255],v[72:75]
ds_read_b128 v[248:251],v17 offset:61440
s_waitcnt lgkmcnt(5)
v_mfma_f32_16x16x32_bf16 v[64:67],a[96:99],v[224:227],v[64:67]
v_min3_u32 v27,v27,v224,v228
v_mfma_f32_16x16x32_bf16 v[72:75],a[224:227],v[224:227],v[72:75]
ds_read_b128 v[252:255],v17 offset:63488
v_mfma_f32_16x16x32_bf16 v[64:67],a[100:103],v[228:231],v[64:67]
v_mfma_f32_16x16x32_bf16 v[72:75],a[228:231],v[228:231],v[72:75]
s_waitcnt vmcnt(4)
s_barrier
ds_read_b64 v[44:45],v47
ds_read_b128 v[224:227],v17 offset:1024
s_waitcnt lgkmcnt(6)
v_mfma_f32_16x16x32_bf16 v[64:67],a[104:107],v[232:235],v[64:67]
v_min3_u32 v27,v27,v232,v236
ds_read_b128 v[124:127],v19 offset:256
v_mfma_f32_16x16x32_bf16 v[72:75],a[232:235],v[232:235],v[72:75]
ds_read_b128 v[228:231],v17 offset:3072
ds_read_b128 v[120:123],v19 offset:0
v_mfma_f32_16x16x32_bf16 v[64:67],a[108:111],v[236:239],v[64:67]
v_mfma_f32_16x16x32_bf16 v[72:75],a[236:239],v[236:239],v[72:75]
ds_read_b128 v[232:235],v17 offset:5120
s_waitcnt lgkmcnt(8)
v_mfma_f32_16x16x32_bf16 v[64:67],a[112:115],v[240:243],v[64:67]
v_min3_u32 v27,v27,v240,v244
v_mfma_f32_16x16x32_bf16 v[72:75],a[240:243],v[240:243],v[72:75]
ds_read_b128 v[236:239],v17 offset:7168
v_mfma_f32_16x16x32_bf16 v[64:67],a[116:119],v[244:247],v[64:67]
v_mfma_f32_16x16x32_bf16 v[72:75],a[244:247],v[244:247],v[72:75]
ds_read_b128 v[240:243],v17 offset:9216
s_waitcnt lgkmcnt(8)
v_mfma_f32_16x16x32_bf16 v[64:67],a[120:123],v[248:251],v[64:67]
s_waitcnt lgkmcnt(7)
v_readfirstlane_b32 s93,v45
v_mfma_f32_16x16x32_bf16 v[72:75],a[248:251],v[248:251],v[72:75]
ds_read_b128 v[244:247],v17 offset:11264
v_readfirstlane_b32 s83,v44
s_cmp_lg_u32 s83,0
s_cbranch_scc0 keep_386
v_mfma_f32_16x16x32_bf16 v[64:67],a[124:127],v[252:255],v[64:67]
v_min3_u32 v27,v27,v248,v252
v_mfma_f32_16x16x32_bf16 v[72:75],a[252:255],v[252:255],v[72:75]
ds_read_b128 v[248:251],v17 offset:13312
s_waitcnt lgkmcnt(6)
v_mfma_f32_16x16x32_bf16 v[68:71],a[0:3],v[224:227],0
v_cmp_eq_u32 vcc,0,v27
s_cbranch_vccnz retry_375
v_mfma_f32_16x16x32_bf16 v[76:79],a[128:131],v[224:227],0
ds_read_b128 v[252:255],v17 offset:15360
v_min3_u32 v27,v27,v224,v228
v_mfma_f32_16x16x32_bf16 v[68:71],a[4:7],v[228:231],v[68:71]
s_waitcnt lgkmcnt(6)
v_mfma_f32_16x16x32_bf16 v[76:79],a[132:135],v[228:231],v[76:79]
ds_read_b128 v[224:227],v17 offset:17408
s_waitcnt lgkmcnt(5)
v_mfma_f32_16x16x32_bf16 v[68:71],a[8:11],v[232:235],v[68:71]
v_min3_u32 v27,v27,v232,v236
v_fmac_f32 v64,v52,v120
v_fmac_f32 v72,v56,v120
v_mfma_f32_16x16x32_bf16 v[76:79],a[136:139],v[232:235],v[76:79]
ds_read_b128 v[228:231],v17 offset:19456
v_fmac_f32 v65,v53,v120
v_fmac_f32 v73,v57,v120
v_mfma_f32_16x16x32_bf16 v[68:71],a[12:15],v[236:239],v[68:71]
v_fmac_f32 v66,v54,v120
v_fmac_f32 v67,v55,v120
v_fmac_f32 v74,v58,v120
v_mfma_f32_16x16x32_bf16 v[76:79],a[140:143],v[236:239],v[76:79]
ds_read_b128 v[232:235],v17 offset:21504
v_fmac_f32 v75,v59,v120
s_waitcnt lgkmcnt(5)
v_mfma_f32_16x16x32_bf16 v[68:71],a[16:19],v[240:243],v[68:71]
v_min3_u32 v27,v27,v240,v244
v_mul_f32 v88,v64,v64
v_mul_f32 v92,v72,v72
v_mfma_f32_16x16x32_bf16 v[76:79],a[144:147],v[240:243],v[76:79]
ds_read_b128 v[236:239],v17 offset:23552
v_mul_f32 v89,v65,v65
v_mul_f32 v93,v73,v73
v_mfma_f32_16x16x32_bf16 v[68:71],a[20:23],v[244:247],v[68:71]
v_mul_f32 v90,v66,v66
v_mul_f32 v91,v67,v67
v_mul_f32 v94,v74,v74
v_mfma_f32_16x16x32_bf16 v[76:79],a[148:151],v[244:247],v[76:79]
ds_read_b128 v[240:243],v17 offset:25600
v_mul_f32 v95,v75,v75
s_waitcnt lgkmcnt(5)
v_mfma_f32_16x16x32_bf16 v[68:71],a[24:27],v[248:251],v[68:71]
v_min3_u32 v27,v27,v248,v252
v_fma_f32 v88,v88,v121,v122
v_fma_f32 v92,v92,v121,v122
v_mfma_f32_16x16x32_bf16 v[76:79],a[152:155],v[248:251],v[76:79]
ds_read_b128 v[244:247],v17 offset:27648
v_fma_f32 v89,v89,v121,v122
v_fma_f32 v93,v93,v121,v122
v_mfma_f32_16x16x32_bf16 v[68:71],a[28:31],v[252:255],v[68:71]
v_fma_f32 v90,v90,v121,v122
v_fma_f32 v91,v91,v121,v122
v_fma_f32 v94,v94,v121,v122
v_mfma_f32_16x16x32_bf16 v[76:79],a[156:159],v[252:255],v[76:79]
ds_read_b128 v[248:251],v17 offset:29696
v_fma_f32 v95,v95,v121,v122
s_waitcnt lgkmcnt(5)
v_mfma_f32_16x16x32_bf16 v[68:71],a[32:35],v[224:227],v[68:71]
v_min3_u32 v27,v27,v224,v228
v_mul_f32 v88,v88,v64
v_mul_f32 v92,v92,v72
v_mfma_f32_16x16x32_bf16 v[76:79],a[160:163],v[224:227],v[76:79]
ds_read_b128 v[252:255],v17 offset:31744
v_mul_f32 v89,v89,v65
v_mul_f32 v93,v93,v73
v_mfma_f32_16x16x32_bf16 v[68:71],a[36:39],v[228:231],v[68:71]
v_mul_f32 v90,v90,v66
v_mul_f32 v91,v91,v67
v_mul_f32 v94,v94,v74
v_mfma_f32_16x16x32_bf16 v[76:79],a[164:167],v[228:231],v[76:79]
s_waitcnt vmcnt(0)
s_barrier
ds_read_b128 v[224:227],v17 offset:33792
s_waitcnt lgkmcnt(5)
v_mfma_f32_16x16x32_bf16 v[68:71],a[40:43],v[232:235],v[68:71]
v_min3_u32 v27,v27,v232,v236
v_mul_f32 v95,v95,v75
v_mfma_f32_16x16x32_bf16 v[76:79],a[168:171],v[232:235],v[76:79]
ds_read_b128 v[228:231],v17 offset:35840
v_exp_f32 v92,v92
v_mfma_f32_16x16x32_bf16 v[68:71],a[44:47],v[236:239],v[68:71]
v_exp_f32 v88,v88
v_mfma_f32_16x16x32_bf16 v[76:79],a[172:175],v[236:239],v[76:79]
ds_read_b128 v[232:235],v17 offset:37888
s_waitcnt lgkmcnt(5)
v_mfma_f32_16x16x32_bf16 v[68:71],a[48:51],v[240:243],v[68:71]
v_min3_u32 v27,v27,v240,v244
v_exp_f32 v93,v93
v_mfma_f32_16x16x32_bf16 v[76:79],a[176:179],v[240:243],v[76:79]
ds_read_b128 v[236:239],v17 offset:39936
v_exp_f32 v94,v94
v_mfma_f32_16x16x32_bf16 v[68:71],a[52:55],v[244:247],v[68:71]
v_exp_f32 v89,v89
v_mfma_f32_16x16x32_bf16 v[76:79],a[180:183],v[244:247],v[76:79]
ds_read_b128 v[240:243],v17 offset:41984
s_waitcnt lgkmcnt(5)
v_mfma_f32_16x16x32_bf16 v[68:71],a[56:59],v[248:251],v[68:71]
v_min3_u32 v27,v27,v248,v252
v_exp_f32 v95,v95
v_mfma_f32_16x16x32_bf16 v[76:79],a[184:187],v[248:251],v[76:79]
ds_read_b128 v[244:247],v17 offset:44032
v_fma_f32 v92,v92,v123,v123
v_fma_f32 v93,v93,v123,v123
v_mfma_f32_16x16x32_bf16 v[68:71],a[60:63],v[252:255],v[68:71]
v_exp_f32 v90,v90
v_fma_f32 v94,v94,v123,v123
v_mfma_f32_16x16x32_bf16 v[76:79],a[188:191],v[252:255],v[76:79]
ds_read_b128 v[248:251],v17 offset:46080
v_fma_f32 v95,v95,v123,v123
s_waitcnt lgkmcnt(5)
v_mfma_f32_16x16x32_bf16 v[68:71],a[64:67],v[224:227],v[68:71]
v_min3_u32 v27,v27,v224,v228
v_rcp_f32 v92,v92
v_mfma_f32_16x16x32_bf16 v[76:79],a[192:195],v[224:227],v[76:79]
ds_read_b128 v[252:255],v17 offset:48128
v_rcp_f32 v93,v93
v_mfma_f32_16x16x32_bf16 v[68:71],a[68:71],v[228:231],v[68:71]
v_exp_f32 v91,v91
v_mfma_f32_16x16x32_bf16 v[76:79],a[196:199],v[228:231],v[76:79]
ds_read_b128 v[224:227],v17 offset:50176
s_waitcnt lgkmcnt(5)
v_mfma_f32_16x16x32_bf16 v[68:71],a[72:75],v[232:235],v[68:71]
v_min3_u32 v27,v27,v232,v236
v_fma_f32 v88,v88,v123,v123
v_mfma_f32_16x16x32_bf16 v[76:79],a[200:203],v[232:235],v[76:79]
ds_read_b128 v[228:231],v17 offset:52224
v_fma_f32 v89,v89,v123,v123
v_mfma_f32_16x16x32_bf16 v[68:71],a[76:79],v[236:239],v[68:71]
v_fma_f32 v90,v90,v123,v123
v_fma_f32 v91,v91,v123,v123
v_mfma_f32_16x16x32_bf16 v[76:79],a[204:207],v[236:239],v[76:79]
ds_read_b128 v[232:235],v17 offset:54272
s_waitcnt lgkmcnt(5)
v_mfma_f32_16x16x32_bf16 v[68:71],a[80:83],v[240:243],v[68:71]
v_min3_u32 v27,v27,v240,v244
v_rcp_f32 v94,v94
v_mfma_f32_16x16x32_bf16 v[76:79],a[208:211],v[240:243],v[76:79]
ds_read_b128 v[236:239],v17 offset:56320
v_rcp_f32 v95,v95
v_mfma_f32_16x16x32_bf16 v[68:71],a[84:87],v[244:247],v[68:71]
v_rcp_f32 v88,v88
v_mfma_f32_16x16x32_bf16 v[76:79],a[212:215],v[244:247],v[76:79]
ds_read_b128 v[240:243],v17 offset:58368
s_waitcnt lgkmcnt(5)
v_mfma_f32_16x16x32_bf16 v[68:71],a[88:91],v[248:251],v[68:71]
v_min3_u32 v27,v27,v248,v252
v_mul_f32 v92,v92,v72
v_mfma_f32_16x16x32_bf16 v[76:79],a[216:219],v[248:251],v[76:79]
ds_read_b128 v[244:247],v17 offset:60416
v_mul_f32 v93,v93,v73
v_mfma_f32_16x16x32_bf16 v[68:71],a[92:95],v[252:255],v[68:71]
v_rcp_f32 v89,v89
v_mfma_f32_16x16x32_bf16 v[76:79],a[220:223],v[252:255],v[76:79]
ds_read_b128 v[248:251],v17 offset:62464
s_waitcnt lgkmcnt(5)
v_mfma_f32_16x16x32_bf16 v[68:71],a[96:99],v[224:227],v[68:71]
v_min3_u32 v27,v27,v224,v228
v_mul_f32 v94,v94,v74
v_mfma_f32_16x16x32_bf16 v[76:79],a[224:227],v[224:227],v[76:79]
ds_read_b128 v[252:255],v17 offset:64512
v_mul_f32 v95,v95,v75
v_mfma_f32_16x16x32_bf16 v[68:71],a[100:103],v[228:231],v[68:71]
v_rcp_f32 v90,v90
v_mfma_f32_16x16x32_bf16 v[76:79],a[228:231],v[228:231],v[76:79]
s_waitcnt lgkmcnt(4)
v_mfma_f32_16x16x32_bf16 v[68:71],a[104:107],v[232:235],v[68:71]
v_min3_u32 v27,v27,v232,v236
v_mfma_f32_16x16x32_bf16 v[76:79],a[232:235],v[232:235],v[76:79]
v_rcp_f32 v91,v91
v_mfma_f32_16x16x32_bf16 v[68:71],a[108:111],v[236:239],v[68:71]
v_mul_f32 v88,v88,v64
v_mul_f32 v89,v89,v65
v_mfma_f32_16x16x32_bf16 v[76:79],a[236:239],v[236:239],v[76:79]
v_mul_f32 v90,v90,v66
s_waitcnt lgkmcnt(2)
v_mfma_f32_16x16x32_bf16 v[68:71],a[112:115],v[240:243],v[68:71]
v_min3_u32 v27,v27,v240,v244
v_mul_f32 v91,v91,v67
v_mfma_f32_16x16x32_bf16 v[76:79],a[240:243],v[240:243],v[76:79]
v_cvt_pk_bf16_f32 v96,v88,v89
v_cvt_pk_bf16_f32 v97,v90,v91
v_mfma_f32_16x16x32_bf16 v[68:71],a[116:119],v[244:247],v[68:71]
v_cvt_pk_bf16_f32 v98,v92,v93
v_cvt_pk_bf16_f32 v99,v94,v95
v_mfma_f32_16x16x32_bf16 v[76:79],a[244:247],v[244:247],v[76:79]
v_max_u32 v96,1,v96
s_waitcnt lgkmcnt(0)
v_mfma_f32_16x16x32_bf16 v[68:71],a[120:123],v[248:251],v[68:71]
v_min3_u32 v27,v27,v248,v252
v_mfma_f32_16x16x32_bf16 v[76:79],a[248:251],v[248:251],v[76:79]
buffer_store_dwordx4 v[96:99],v18,s[20:23],s70 offen offset:0 sc1
v_mfma_f32_16x16x32_bf16 v[68:71],a[124:127],v[252:255],v[68:71]
v_mfma_f32_16x16x32_bf16 v[76:79],a[252:255],v[252:255],v[76:79]
v_cmp_eq_u32 vcc,0,v27
s_cbranch_vccnz retry_375
s_branch epi_378
keep_386:
v_mfma_f32_16x16x32_bf16 v[64:67],a[124:127],v[252:255],v[64:67]
v_min3_u32 v27,v27,v248,v252
s_xor_b32 m0,s72,0
v_mfma_f32_16x16x32_bf16 v[72:75],a[252:255],v[252:255],v[72:75]
ds_read_b128 v[248:251],v17 offset:13312
s_waitcnt lgkmcnt(6)
v_mfma_f32_16x16x32_bf16 v[68:71],a[0:3],v[224:227],0
s_add_u32 s65,s88,0
v_cmp_eq_u32 vcc,0,v27
s_cbranch_vccnz retry_375
v_mfma_f32_16x16x32_bf16 v[76:79],a[128:131],v[224:227],0
ds_read_b128 v[252:255],v17 offset:15360
v_min3_u32 v27,v27,v224,v228
s_waitcnt lgkmcnt(6)
v_mfma_f32_16x16x32_bf16 v[68:71],a[4:7],v[228:231],v[68:71]
buffer_load_dwordx4 v16,s[20:23],s65 offen offset:0 sc1 lds
v_mfma_f32_16x16x32_bf16 v[76:79],a[132:135],v[228:231],v[76:79]
ds_read_b128 v[224:227],v17 offset:17408
s_waitcnt lgkmcnt(5)
v_mfma_f32_16x16x32_bf16 v[68:71],a[8:11],v[232:235],v[68:71]
buffer_load_dwordx4 v16,s[20:23],s65 offen offset:2048 sc1 lds
v_fmac_f32 v64,v52,v120
v_fmac_f32 v65,v53,v120
v_mfma_f32_16x16x32_bf16 v[76:79],a[136:139],v[232:235],v[76:79]
ds_read_b128 v[228:231],v17 offset:19456
s_xor_b32 m0,s72,16384
v_fmac_f32 v66,v54,v120
v_fmac_f32 v67,v55,v120
v_mfma_f32_16x16x32_bf16 v[68:71],a[12:15],v[236:239],v[68:71]
s_add_u32 s65,s88,32768
v_min3_u32 v27,v27,v232,v236
v_mul_f32 v88,v64,v64
v_mul_f32 v89,v65,v65
v_mfma_f32_16x16x32_bf16 v[76:79],a[140:143],v[236:239],v[76:79]
ds_read_b128 v[232:235],v17 offset:21504
v_mul_f32 v90,v66,v66
v_mul_f32 v91,v67,v67
s_waitcnt lgkmcnt(5)
v_mfma_f32_16x16x32_bf16 v[68:71],a[16:19],v[240:243],v[68:71]
buffer_load_dwordx4 v16,s[20:23],s65 offen offset:0 sc1 lds
v_fma_f32 v88,v88,v121,v122
v_fma_f32 v89,v89,v121,v122
v_mfma_f32_16x16x32_bf16 v[76:79],a[144:147],v[240:243],v[76:79]
ds_read_b128 v[236:239],v17 offset:23552
v_min3_u32 v27,v27,v240,v244
v_fma_f32 v90,v90,v121,v122
v_fma_f32 v91,v91,v121,v122
v_mfma_f32_16x16x32_bf16 v[68:71],a[20:23],v[244:247],v[68:71]
buffer_load_dwordx4 v16,s[20:23],s65 offen offset:2048 sc1 lds
v_mul_f32 v88,v88,v64
v_mul_f32 v89,v89,v65
v_mfma_f32_16x16x32_bf16 v[76:79],a[148:151],v[244:247],v[76:79]
ds_read_b128 v[240:243],v17 offset:25600
v_mul_f32 v90,v90,v66
v_mul_f32 v91,v91,v67
s_waitcnt lgkmcnt(5)
v_mfma_f32_16x16x32_bf16 v[68:71],a[24:27],v[248:251],v[68:71]
s_xor_b32 m0,s72,32768
s_add_u32 s65,s88,65536
v_exp_f32 v88,v88
v_mfma_f32_16x16x32_bf16 v[76:79],a[152:155],v[248:251],v[76:79]
ds_read_b128 v[244:247],v17 offset:27648
v_min3_u32 v27,v27,v248,v252
v_exp_f32 v89,v89
v_mfma_f32_16x16x32_bf16 v[68:71],a[28:31],v[252:255],v[68:71]
buffer_load_dwordx4 v16,s[20:23],s65 offen offset:0 sc1 lds
v_exp_f32 v90,v90
v_mfma_f32_16x16x32_bf16 v[76:79],a[156:159],v[252:255],v[76:79]
ds_read_b128 v[248:251],v17 offset:29696
v_exp_f32 v91,v91
s_waitcnt lgkmcnt(5)
v_mfma_f32_16x16x32_bf16 v[68:71],a[32:35],v[224:227],v[68:71]
buffer_load_dwordx4 v16,s[20:23],s65 offen offset:2048 sc1 lds
v_fma_f32 v88,v88,v123,v123
v_fma_f32 v89,v89,v123,v123
v_mfma_f32_16x16x32_bf16 v[76:79],a[160:163],v[224:227],v[76:79]
ds_read_b128 v[252:255],v17 offset:31744
s_xor_b32 m0,s72,49152
v_fma_f32 v90,v90,v123,v123
v_fma_f32 v91,v91,v123,v123
v_mfma_f32_16x16x32_bf16 v[68:71],a[36:39],v[228:231],v[68:71]
v_min3_u32 v27,v27,v224,v228
v_rcp_f32 v88,v88
v_fmac_f32 v72,v56,v120
v_mfma_f32_16x16x32_bf16 v[76:79],a[164:167],v[228:231],v[76:79]
s_waitcnt vmcnt(6)
s_barrier
ds_read_b128 v[224:227],v17 offset:33792
s_waitcnt lgkmcnt(5)
v_mfma_f32_16x16x32_bf16 v[68:71],a[40:43],v[232:235],v[68:71]
s_add_u32 s65,s88,98304
v_min3_u32 v27,v27,v232,v236
v_fmac_f32 v73,v57,v120
v_fmac_f32 v74,v58,v120
v_mfma_f32_16x16x32_bf16 v[76:79],a[168:171],v[232:235],v[76:79]
ds_read_b128 v[228:231],v17 offset:35840
v_fmac_f32 v75,v59,v120
v_mul_f32 v92,v72,v72
v_mul_f32 v93,v73,v73
v_mfma_f32_16x16x32_bf16 v[68:71],a[44:47],v[236:239],v[68:71]
buffer_load_dwordx4 v16,s[20:23],s65 offen offset:0 sc1 lds
v_mul_f32 v94,v74,v74
v_mul_f32 v95,v75,v75
v_mfma_f32_16x16x32_bf16 v[76:79],a[172:175],v[236:239],v[76:79]
ds_read_b128 v[232:235],v17 offset:37888
v_fma_f32 v92,v92,v121,v122
v_fma_f32 v93,v93,v121,v122
s_waitcnt lgkmcnt(5)
v_mfma_f32_16x16x32_bf16 v[68:71],a[48:51],v[240:243],v[68:71]
buffer_load_dwordx4 v16,s[20:23],s65 offen offset:2048 sc1 lds
v_fma_f32 v94,v94,v121,v122
v_fma_f32 v95,v95,v121,v122
v_mfma_f32_16x16x32_bf16 v[76:79],a[176:179],v[240:243],v[76:79]
ds_read_b128 v[236:239],v17 offset:39936
s_xor_b32 m0,s72,1024
v_mul_f32 v92,v92,v72
v_mul_f32 v93,v93,v73
v_mfma_f32_16x16x32_bf16 v[68:71],a[52:55],v[244:247],v[68:71]
s_add_u32 s65,s89,0
v_min3_u32 v27,v27,v240,v244
v_mul_f32 v94,v94,v74
v_mul_f32 v95,v95,v75
v_mfma_f32_16x16x32_bf16 v[76:79],a[180:183],v[244:247],v[76:79]
ds_read_b128 v[240:243],v17 offset:41984
v_exp_f32 v92,v92
s_waitcnt lgkmcnt(5)
v_mfma_f32_16x16x32_bf16 v[68:71],a[56:59],v[248:251],v[68:71]
buffer_load_dwordx4 v16,s[20:23],s65 offen offset:0 sc1 lds
v_exp_f32 v93,v93
v_mfma_f32_16x16x32_bf16 v[76:79],a[184:187],v[248:251],v[76:79]
ds_read_b128 v[244:247],v17 offset:44032
v_min3_u32 v27,v27,v248,v252
v_exp_f32 v94,v94
v_mfma_f32_16x16x32_bf16 v[68:71],a[60:63],v[252:255],v[68:71]
buffer_load_dwordx4 v16,s[20:23],s65 offen offset:2048 sc1 lds
v_exp_f32 v95,v95
v_mfma_f32_16x16x32_bf16 v[76:79],a[188:191],v[252:255],v[76:79]
ds_read_b128 v[248:251],v17 offset:46080
v_fma_f32 v92,v92,v123,v123
v_fma_f32 v93,v93,v123,v123
s_waitcnt lgkmcnt(5)
v_mfma_f32_16x16x32_bf16 v[68:71],a[64:67],v[224:227],v[68:71]
s_xor_b32 m0,s72,17408
s_add_u32 s65,s89,32768
v_fma_f32 v94,v94,v123,v123
v_fma_f32 v95,v95,v123,v123
v_mfma_f32_16x16x32_bf16 v[76:79],a[192:195],v[224:227],v[76:79]
ds_read_b128 v[252:255],v17 offset:48128
v_min3_u32 v27,v27,v224,v228
v_rcp_f32 v92,v92
v_mfma_f32_16x16x32_bf16 v[68:71],a[68:71],v[228:231],v[68:71]
buffer_load_dwordx4 v16,s[20:23],s65 offen offset:0 sc1 lds
v_rcp_f32 v93,v93
v_mfma_f32_16x16x32_bf16 v[76:79],a[196:199],v[228:231],v[76:79]
ds_read_b128 v[224:227],v17 offset:50176
v_rcp_f32 v94,v94
s_waitcnt lgkmcnt(5)
v_mfma_f32_16x16x32_bf16 v[68:71],a[72:75],v[232:235],v[68:71]
buffer_load_dwordx4 v16,s[20:23],s65 offen offset:2048 sc1 lds
v_rcp_f32 v95,v95
v_mfma_f32_16x16x32_bf16 v[76:79],a[200:203],v[232:235],v[76:79]
ds_read_b128 v[228:231],v17 offset:52224
s_xor_b32 m0,s72,33792
v_mfma_f32_16x16x32_bf16 v[68:71],a[76:79],v[236:239],v[68:71]
s_add_u32 s65,s89,65536
v_min3_u32 v27,v27,v232,v236
v_mfma_f32_16x16x32_bf16 v[76:79],a[204:207],v[236:239],v[76:79]
ds_read_b128 v[232:235],v17 offset:54272
s_waitcnt lgkmcnt(5)
v_mfma_f32_16x16x32_bf16 v[68:71],a[80:83],v[240:243],v[68:71]
buffer_load_dwordx4 v16,s[20:23],s65 offen offset:0 sc1 lds
v_mfma_f32_16x16x32_bf16 v[76:79],a[208:211],v[240:243],v[76:79]
ds_read_b128 v[236:239],v17 offset:56320
v_min3_u32 v27,v27,v240,v244
v_mfma_f32_16x16x32_bf16 v[68:71],a[84:87],v[244:247],v[68:71]
buffer_load_dwordx4 v16,s[20:23],s65 offen offset:2048 sc1 lds
v_mfma_f32_16x16x32_bf16 v[76:79],a[212:215],v[244:247],v[76:79]
ds_read_b128 v[240:243],v17 offset:58368
s_waitcnt lgkmcnt(5)
v_mfma_f32_16x16x32_bf16 v[68:71],a[88:91],v[248:251],v[68:71]
s_xor_b32 m0,s72,50176
v_min3_u32 v27,v27,v248,v252
v_mfma_f32_16x16x32_bf16 v[76:79],a[216:219],v[248:251],v[76:79]
ds_read_b128 v[244:247],v17 offset:60416
s_add_u32 s65,s89,98304
v_mfma_f32_16x16x32_bf16 v[68:71],a[92:95],v[252:255],v[68:71]
buffer_load_dwordx4 v16,s[20:23],s65 offen offset:0 sc1 lds
v_mfma_f32_16x16x32_bf16 v[76:79],a[220:223],v[252:255],v[76:79]
ds_read_b128 v[248:251],v17 offset:62464
s_waitcnt lgkmcnt(5)
v_mfma_f32_16x16x32_bf16 v[68:71],a[96:99],v[224:227],v[68:71]
buffer_load_dwordx4 v16,s[20:23],s65 offen offset:2048 sc1 lds
v_mfma_f32_16x16x32_bf16 v[76:79],a[224:227],v[224:227],v[76:79]
ds_read_b128 v[252:255],v17 offset:64512
v_min3_u32 v27,v27,v224,v228
v_mfma_f32_16x16x32_bf16 v[68:71],a[100:103],v[228:231],v[68:71]
v_rcp_f32 v89,v89
v_mfma_f32_16x16x32_bf16 v[76:79],a[228:231],v[228:231],v[76:79]
v_mul_f32 v92,v92,v72
s_waitcnt lgkmcnt(4)
v_mfma_f32_16x16x32_bf16 v[68:71],a[104:107],v[232:235],v[68:71]
v_min3_u32 v27,v27,v232,v236
v_mul_f32 v93,v93,v73
v_mfma_f32_16x16x32_bf16 v[76:79],a[232:235],v[232:235],v[76:79]
v_rcp_f32 v90,v90
v_mfma_f32_16x16x32_bf16 v[68:71],a[108:111],v[236:239],v[68:71]
v_rcp_f32 v91,v91
v_mfma_f32_16x16x32_bf16 v[76:79],a[236:239],v[236:239],v[76:79]
v_mul_f32 v88,v88,v64
s_waitcnt lgkmcnt(2)
v_mfma_f32_16x16x32_bf16 v[68:71],a[112:115],v[240:243],v[68:71]
v_min3_u32 v27,v27,v240,v244
v_mul_f32 v89,v89,v65
v_mfma_f32_16x16x32_bf16 v[76:79],a[240:243],v[240:243],v[76:79]
v_mul_f32 v90,v90,v66
v_mul_f32 v91,v91,v67
v_mfma_f32_16x16x32_bf16 v[68:71],a[116:119],v[244:247],v[68:71]
v_mul_f32 v94,v94,v74
v_mul_f32 v95,v95,v75
v_mfma_f32_16x16x32_bf16 v[76:79],a[244:247],v[244:247],v[76:79]
v_cvt_pk_bf16_f32 v96,v88,v89
s_waitcnt lgkmcnt(0)
v_mfma_f32_16x16x32_bf16 v[68:71],a[120:123],v[248:251],v[68:71]
v_min3_u32 v27,v27,v248,v252
v_cvt_pk_bf16_f32 v97,v90,v91
v_mfma_f32_16x16x32_bf16 v[76:79],a[248:251],v[248:251],v[76:79]
v_cvt_pk_bf16_f32 v98,v92,v93
v_cvt_pk_bf16_f32 v99,v94,v95
v_mfma_f32_16x16x32_bf16 v[68:71],a[124:127],v[252:255],v[68:71]
v_max_u32 v96,1,v96
v_mfma_f32_16x16x32_bf16 v[76:79],a[252:255],v[252:255],v[76:79]
buffer_store_dwordx4 v[96:99],v18,s[20:23],s70 offen offset:0 sc1
v_cmp_eq_u32 vcc,0,v27
s_cbranch_vccnz retry_375
s_branch epi_378
ahead_377:
s_cmp_eq_u32 s93,0
s_cbranch_scc1 both_379
s_waitcnt vmcnt(12) lgkmcnt(0)
s_barrier
ds_read_b128 v[224:227],v17 offset:0
ds_read_b128 v[228:231],v17 offset:2048
ds_read_b128 v[232:235],v17 offset:4096
ds_read_b128 v[236:239],v17 offset:6144
ds_read_b128 v[240:243],v17 offset:8192
ds_read_b128 v[244:247],v17 offset:10240
ds_read_b128 v[248:251],v17 offset:12288
s_waitcnt lgkmcnt(5)
v_mfma_f32_16x16x32_bf16 v[64:67],a[0:3],v[224:227],0
s_add_u32 s96,s71,1
s_add_u32 s92,s71,2
v_mfma_f32_16x16x32_bf16 v[72:75],a[128:131],v[224:227],0
ds_read_b128 v[252:255],v17 offset:14336
v_min_u32 v27,v224,v228
v_mfma_f32_16x16x32_bf16 v[64:67],a[4:7],v[228:231],v[64:67]
s_cmp_eq_u32 s96,64
s_cselect_b32 s96,99,s96
v_mfma_f32_16x16x32_bf16 v[72:75],a[132:135],v[228:231],v[72:75]
ds_read_b128 v[224:227],v17 offset:16384
s_waitcnt lgkmcnt(5)
v_mfma_f32_16x16x32_bf16 v[64:67],a[8:11],v[232:235],v[64:67]
s_cmp_eq_u32 s92,64
s_cselect_b32 s92,99,s92
v_mfma_f32_16x16x32_bf16 v[72:75],a[136:139],v[232:235],v[72:75]
ds_read_b128 v[228:231],v17 offset:18432
v_min3_u32 v27,v27,v232,v236
v_mfma_f32_16x16x32_bf16 v[64:67],a[12:15],v[236:239],v[64:67]
v_mfma_f32_16x16x32_bf16 v[72:75],a[140:143],v[236:239],v[72:75]
ds_read_b128 v[232:235],v17 offset:20480
s_waitcnt lgkmcnt(5)
v_mfma_f32_16x16x32_bf16 v[64:67],a[16:19],v[240:243],v[64:67]
v_min3_u32 v27,v27,v240,v244
v_mfma_f32_16x16x32_bf16 v[72:75],a[144:147],v[240:243],v[72:75]
ds_read_b128 v[236:239],v17 offset:22528
v_mfma_f32_16x16x32_bf16 v[64:67],a[20:23],v[244:247],v[64:67]
v_mfma_f32_16x16x32_bf16 v[72:75],a[148:151],v[244:247],v[72:75]
ds_read_b128 v[240:243],v17 offset:24576
s_waitcnt lgkmcnt(5)
v_mfma_f32_16x16x32_bf16 v[64:67],a[24:27],v[248:251],v[64:67]
v_min3_u32 v27,v27,v248,v252
v_mfma_f32_16x16x32_bf16 v[72:75],a[152:155],v[248:251],v[72:75]
ds_read_b128 v[244:247],v17 offset:26624
v_mfma_f32_16x16x32_bf16 v[64:67],a[28:31],v[252:255],v[64:67]
v_mfma_f32_16x16x32_bf16 v[72:75],a[156:159],v[252:255],v[72:75]
ds_read_b128 v[248:251],v17 offset:28672
s_waitcnt lgkmcnt(5)
v_mfma_f32_16x16x32_bf16 v[64:67],a[32:35],v[224:227],v[64:67]
v_min3_u32 v27,v27,v224,v228
v_mfma_f32_16x16x32_bf16 v[72:75],a[160:163],v[224:227],v[72:75]
ds_read_b128 v[252:255],v17 offset:30720
v_mfma_f32_16x16x32_bf16 v[64:67],a[36:39],v[228:231],v[64:67]
v_mfma_f32_16x16x32_bf16 v[72:75],a[164:167],v[228:231],v[72:75]
ds_read_b128 v[224:227],v17 offset:32768
s_waitcnt lgkmcnt(5)
v_mfma_f32_16x16x32_bf16 v[64:67],a[40:43],v[232:235],v[64:67]
v_min3_u32 v27,v27,v232,v236
v_mfma_f32_16x16x32_bf16 v[72:75],a[168:171],v[232:235],v[72:75]
ds_read_b128 v[228:231],v17 offset:34816
v_mfma_f32_16x16x32_bf16 v[64:67],a[44:47],v[236:239],v[64:67]
v_mfma_f32_16x16x32_bf16 v[72:75],a[172:175],v[236:239],v[72:75]
ds_read_b128 v[232:235],v17 offset:36864
s_waitcnt lgkmcnt(5)
v_mfma_f32_16x16x32_bf16 v[64:67],a[48:51],v[240:243],v[64:67]
v_min3_u32 v27,v27,v240,v244
v_mfma_f32_16x16x32_bf16 v[72:75],a[176:179],v[240:243],v[72:75]
ds_read_b128 v[236:239],v17 offset:38912
v_mfma_f32_16x16x32_bf16 v[64:67],a[52:55],v[244:247],v[64:67]
v_mfma_f32_16x16x32_bf16 v[72:75],a[180:183],v[244:247],v[72:75]
ds_read_b128 v[240:243],v17 offset:40960
s_waitcnt lgkmcnt(5)
v_mfma_f32_16x16x32_bf16 v[64:67],a[56:59],v[248:251],v[64:67]
v_min3_u32 v27,v27,v248,v252
v_mfma_f32_16x16x32_bf16 v[72:75],a[184:187],v[248:251],v[72:75]
ds_read_b128 v[244:247],v17 offset:43008
s_waitcnt vmcnt(2)
v_mfma_f32_16x16x32_bf16 v[64:67],a[60:63],v[252:255],v[64:67]
v_cmp_gt_u32 vcc,s96,v29
v_cmp_gt_u32 s[92:93],s92,v29
v_mfma_f32_16x16x32_bf16 v[72:75],a[188:191],v[252:255],v[72:75]
ds_read_b128 v[248:251],v17 offset:45056
s_waitcnt lgkmcnt(5)
v_mfma_f32_16x16x32_bf16 v[64:67],a[64:67],v[224:227],v[64:67]
v_mov_b32 v44,vcc_lo
v_mov_b32 v45,s92
v_mfma_f32_16x16x32_bf16 v[72:75],a[192:195],v[224:227],v[72:75]
ds_read_b128 v[252:255],v17 offset:47104
ds_write_b64 v46,v[44:45]
v_mfma_f32_16x16x32_bf16 v[64:67],a[68:71],v[228:231],v[64:67]
v_min3_u32 v27,v27,v224,v228
v_mfma_f32_16x16x32_bf16 v[72:75],a[196:199],v[228:231],v[72:75]
ds_read_b128 v[224:227],v17 offset:49152
s_waitcnt lgkmcnt(6)
v_mfma_f32_16x16x32_bf16 v[64:67],a[72:75],v[232:235],v[64:67]
v_min3_u32 v27,v27,v232,v236
v_mfma_f32_16x16x32_bf16 v[72:75],a[200:203],v[232:235],v[72:75]
ds_read_b128 v[228:231],v17 offset:51200
v_mfma_f32_16x16x32_bf16 v[64:67],a[76:79],v[236:239],v[64:67]
v_mfma_f32_16x16x32_bf16 v[72:75],a[204:207],v[236:239],v[72:75]
ds_read_b128 v[232:235],v17 offset:53248
s_waitcnt lgkmcnt(6)
v_mfma_f32_16x16x32_bf16 v[64:67],a[80:83],v[240:243],v[64:67]
v_min3_u32 v27,v27,v240,v244
s_add_u32 s88,s70,s75
v_mfma_f32_16x16x32_bf16 v[72:75],a[208:211],v[240:243],v[72:75]
ds_read_b128 v[236:239],v17 offset:55296
s_add_u32 s88,s88,2097152
v_mfma_f32_16x16x32_bf16 v[64:67],a[84:87],v[244:247],v[64:67]
s_xor_b32 s88,s88,0x2000
s_xor_b32 s89,s88,1024
v_mfma_f32_16x16x32_bf16 v[72:75],a[212:215],v[244:247],v[72:75]
ds_read_b128 v[240:243],v17 offset:57344
s_waitcnt lgkmcnt(6)
v_mfma_f32_16x16x32_bf16 v[64:67],a[88:91],v[248:251],v[64:67]
v_min3_u32 v27,v27,v248,v252
v_mfma_f32_16x16x32_bf16 v[72:75],a[216:219],v[248:251],v[72:75]
ds_read_b128 v[244:247],v17 offset:59392
v_mfma_f32_16x16x32_bf16 v[64:67],a[92:95],v[252:255],v[64:67]
v_mfma_f32_16x16x32_bf16 v[72:75],a[220:223],v[252:255],v[72:75]
ds_read_b128 v[248:251],v17 offset:61440
s_waitcnt lgkmcnt(5)
v_mfma_f32_16x16x32_bf16 v[64:67],a[96:99],v[224:227],v[64:67]
v_min3_u32 v27,v27,v224,v228
v_mfma_f32_16x16x32_bf16 v[72:75],a[224:227],v[224:227],v[72:75]
ds_read_b128 v[252:255],v17 offset:63488
v_mfma_f32_16x16x32_bf16 v[64:67],a[100:103],v[228:231],v[64:67]
s_waitcnt vmcnt(0)
v_add_u32 v22,s71,-1
v_mfma_f32_16x16x32_bf16 v[72:75],a[228:231],v[228:231],v[72:75]
s_waitcnt vmcnt(4)
s_barrier
ds_read_b64 v[44:45],v47
ds_read_b128 v[224:227],v17 offset:1024
s_waitcnt lgkmcnt(6)
v_mfma_f32_16x16x32_bf16 v[64:67],a[104:107],v[232:235],v[64:67]
v_min3_u32 v27,v27,v232,v236
ds_read_b128 v[124:127],v19 offset:256
v_mfma_f32_16x16x32_bf16 v[72:75],a[232:235],v[232:235],v[72:75]
ds_read_b128 v[228:231],v17 offset:3072
ds_read_b128 v[120:123],v19 offset:0
v_mfma_f32_16x16x32_bf16 v[64:67],a[108:111],v[236:239],v[64:67]
buffer_store_dword v22,v23,s[20:23],s97 offen sc1
v_mfma_f32_16x16x32_bf16 v[72:75],a[236:239],v[236:239],v[72:75]
ds_read_b128 v[232:235],v17 offset:5120
s_waitcnt lgkmcnt(8)
v_mfma_f32_16x16x32_bf16 v[64:67],a[112:115],v[240:243],v[64:67]
v_min3_u32 v27,v27,v240,v244
s_mov_b32 s97,0x7fff0000
v_mfma_f32_16x16x32_bf16 v[72:75],a[240:243],v[240:243],v[72:75]
ds_read_b128 v[236:239],v17 offset:7168
v_mfma_f32_16x16x32_bf16 v[64:67],a[116:119],v[244:247],v[64:67]
v_mfma_f32_16x16x32_bf16 v[72:75],a[244:247],v[244:247],v[72:75]
ds_read_b128 v[240:243],v17 offset:9216
s_waitcnt lgkmcnt(8)
v_mfma_f32_16x16x32_bf16 v[64:67],a[120:123],v[248:251],v[64:67]
s_waitcnt lgkmcnt(7)
v_readfirstlane_b32 s93,v45
v_mfma_f32_16x16x32_bf16 v[72:75],a[248:251],v[248:251],v[72:75]
ds_read_b128 v[244:247],v17 offset:11264
v_readfirstlane_b32 s83,v44
s_cmp_lg_u32 s83,0
s_cbranch_scc1 keep_387
v_mfma_f32_16x16x32_bf16 v[64:67],a[124:127],v[252:255],v[64:67]
v_min3_u32 v27,v27,v248,v252
s_xor_b32 m0,s72,0
v_mfma_f32_16x16x32_bf16 v[72:75],a[252:255],v[252:255],v[72:75]
ds_read_b128 v[248:251],v17 offset:13312
s_waitcnt lgkmcnt(6)
v_mfma_f32_16x16x32_bf16 v[68:71],a[0:3],v[224:227],0
s_add_u32 s65,s88,0
v_cmp_eq_u32 vcc,0,v27
s_cbranch_vccnz retry_375
v_mfma_f32_16x16x32_bf16 v[76:79],a[128:131],v[224:227],0
ds_read_b128 v[252:255],v17 offset:15360
v_min3_u32 v27,v27,v224,v228
s_waitcnt lgkmcnt(6)
v_mfma_f32_16x16x32_bf16 v[68:71],a[4:7],v[228:231],v[68:71]
buffer_load_dwordx4 v16,s[20:23],s65 offen offset:0 sc1 lds
v_mfma_f32_16x16x32_bf16 v[76:79],a[132:135],v[228:231],v[76:79]
ds_read_b128 v[224:227],v17 offset:17408
s_waitcnt lgkmcnt(5)
v_mfma_f32_16x16x32_bf16 v[68:71],a[8:11],v[232:235],v[68:71]
buffer_load_dwordx4 v16,s[20:23],s65 offen offset:2048 sc1 lds
v_fmac_f32 v64,v52,v120
v_fmac_f32 v65,v53,v120
v_mfma_f32_16x16x32_bf16 v[76:79],a[136:139],v[232:235],v[76:79]
ds_read_b128 v[228:231],v17 offset:19456
s_xor_b32 m0,s72,16384
v_fmac_f32 v66,v54,v120
v_fmac_f32 v67,v55,v120
v_mfma_f32_16x16x32_bf16 v[68:71],a[12:15],v[236:239],v[68:71]
s_add_u32 s65,s88,32768
v_min3_u32 v27,v27,v232,v236
v_mul_f32 v88,v64,v64
v_mul_f32 v89,v65,v65
v_mfma_f32_16x16x32_bf16 v[76:79],a[140:143],v[236:239],v[76:79]
ds_read_b128 v[232:235],v17 offset:21504
v_mul_f32 v90,v66,v66
v_mul_f32 v91,v67,v67
s_waitcnt lgkmcnt(5)
v_mfma_f32_16x16x32_bf16 v[68:71],a[16:19],v[240:243],v[68:71]
buffer_load_dwordx4 v16,s[20:23],s65 offen offset:0 sc1 lds
v_fma_f32 v88,v88,v121,v122
v_fma_f32 v89,v89,v121,v122
v_mfma_f32_16x16x32_bf16 v[76:79],a[144:147],v[240:243],v[76:79]
ds_read_b128 v[236:239],v17 offset:23552
v_min3_u32 v27,v27,v240,v244
v_fma_f32 v90,v90,v121,v122
v_fma_f32 v91,v91,v121,v122
v_mfma_f32_16x16x32_bf16 v[68:71],a[20:23],v[244:247],v[68:71]
buffer_load_dwordx4 v16,s[20:23],s65 offen offset:2048 sc1 lds
v_mul_f32 v88,v88,v64
v_mul_f32 v89,v89,v65
v_mfma_f32_16x16x32_bf16 v[76:79],a[148:151],v[244:247],v[76:79]
ds_read_b128 v[240:243],v17 offset:25600
v_mul_f32 v90,v90,v66
v_mul_f32 v91,v91,v67
s_waitcnt lgkmcnt(5)
v_mfma_f32_16x16x32_bf16 v[68:71],a[24:27],v[248:251],v[68:71]
s_xor_b32 m0,s72,32768
s_add_u32 s65,s88,65536
v_exp_f32 v88,v88
v_mfma_f32_16x16x32_bf16 v[76:79],a[152:155],v[248:251],v[76:79]
ds_read_b128 v[244:247],v17 offset:27648
v_min3_u32 v27,v27,v248,v252
v_exp_f32 v89,v89
v_mfma_f32_16x16x32_bf16 v[68:71],a[28:31],v[252:255],v[68:71]
buffer_load_dwordx4 v16,s[20:23],s65 offen offset:0 sc1 lds
v_exp_f32 v90,v90
v_mfma_f32_16x16x32_bf16 v[76:79],a[156:159],v[252:255],v[76:79]
ds_read_b128 v[248:251],v17 offset:29696
v_exp_f32 v91,v91
s_waitcnt lgkmcnt(5)
v_mfma_f32_16x16x32_bf16 v[68:71],a[32:35],v[224:227],v[68:71]
buffer_load_dwordx4 v16,s[20:23],s65 offen offset:2048 sc1 lds
v_fma_f32 v88,v88,v123,v123
v_fma_f32 v89,v89,v123,v123
v_mfma_f32_16x16x32_bf16 v[76:79],a[160:163],v[224:227],v[76:79]
ds_read_b128 v[252:255],v17 offset:31744
s_xor_b32 m0,s72,49152
v_fma_f32 v90,v90,v123,v123
v_fma_f32 v91,v91,v123,v123
v_mfma_f32_16x16x32_bf16 v[68:71],a[36:39],v[228:231],v[68:71]
v_min3_u32 v27,v27,v224,v228
v_rcp_f32 v88,v88
v_fmac_f32 v72,v56,v120
v_mfma_f32_16x16x32_bf16 v[76:79],a[164:167],v[228:231],v[76:79]
ds_read_b128 v[224:227],v17 offset:33792
v_fmac_f32 v73,v57,v120
v_fmac_f32 v74,v58,v120
s_waitcnt lgkmcnt(5)
v_mfma_f32_16x16x32_bf16 v[68:71],a[40:43],v[232:235],v[68:71]
s_add_u32 s65,s88,98304
v_min3_u32 v27,v27,v232,v236
v_fmac_f32 v75,v59,v120
v_mul_f32 v92,v72,v72
v_mfma_f32_16x16x32_bf16 v[76:79],a[168:171],v[232:235],v[76:79]
ds_read_b128 v[228:231],v17 offset:35840
v_mul_f32 v93,v73,v73
v_mul_f32 v94,v74,v74
v_mul_f32 v95,v75,v75
v_mfma_f32_16x16x32_bf16 v[68:71],a[44:47],v[236:239],v[68:71]
buffer_load_dwordx4 v16,s[20:23],s65 offen offset:0 sc1 lds
v_fma_f32 v92,v92,v121,v122
v_fma_f32 v93,v93,v121,v122
v_mfma_f32_16x16x32_bf16 v[76:79],a[172:175],v[236:239],v[76:79]
ds_read_b128 v[232:235],v17 offset:37888
v_fma_f32 v94,v94,v121,v122
v_fma_f32 v95,v95,v121,v122
s_waitcnt lgkmcnt(5)
v_mfma_f32_16x16x32_bf16 v[68:71],a[48:51],v[240:243],v[68:71]
buffer_load_dwordx4 v16,s[20:23],s65 offen offset:2048 sc1 lds
v_mul_f32 v92,v92,v72
v_mul_f32 v93,v93,v73
v_mfma_f32_16x16x32_bf16 v[76:79],a[176:179],v[240:243],v[76:79]
ds_read_b128 v[236:239],v17 offset:39936
s_xor_b32 m0,s72,1024
v_mul_f32 v94,v94,v74
v_mul_f32 v95,v95,v75
v_mfma_f32_16x16x32_bf16 v[68:71],a[52:55],v[244:247],v[68:71]
s_add_u32 s65,s89,0
v_min3_u32 v27,v27,v240,v244
v_exp_f32 v92,v92
v_mfma_f32_16x16x32_bf16 v[76:79],a[180:183],v[244:247],v[76:79]
ds_read_b128 v[240:243],v17 offset:41984
v_exp_f32 v93,v93
s_waitcnt lgkmcnt(5)
v_mfma_f32_16x16x32_bf16 v[68:71],a[56:59],v[248:251],v[68:71]
buffer_load_dwordx4 v16,s[20:23],s65 offen offset:0 sc1 lds
v_exp_f32 v94,v94
v_mfma_f32_16x16x32_bf16 v[76:79],a[184:187],v[248:251],v[76:79]
ds_read_b128 v[244:247],v17 offset:44032
v_min3_u32 v27,v27,v248,v252
v_exp_f32 v95,v95
v_mfma_f32_16x16x32_bf16 v[68:71],a[60:63],v[252:255],v[68:71]
buffer_load_dwordx4 v16,s[20:23],s65 offen offset:2048 sc1 lds
v_fma_f32 v92,v92,v123,v123
v_fma_f32 v93,v93,v123,v123
v_mfma_f32_16x16x32_bf16 v[76:79],a[188:191],v[252:255],v[76:79]
ds_read_b128 v[248:251],v17 offset:46080
v_fma_f32 v94,v94,v123,v123
v_fma_f32 v95,v95,v123,v123
s_waitcnt lgkmcnt(5)
v_mfma_f32_16x16x32_bf16 v[68:71],a[64:67],v[224:227],v[68:71]
s_xor_b32 m0,s72,17408
s_add_u32 s65,s89,32768
v_rcp_f32 v92,v92
v_mfma_f32_16x16x32_bf16 v[76:79],a[192:195],v[224:227],v[76:79]
ds_read_b128 v[252:255],v17 offset:48128
v_min3_u32 v27,v27,v224,v228
v_rcp_f32 v93,v93
v_mfma_f32_16x16x32_bf16 v[68:71],a[68:71],v[228:231],v[68:71]
buffer_load_dwordx4 v16,s[20:23],s65 offen offset:0 sc1 lds
v_rcp_f32 v94,v94
v_mfma_f32_16x16x32_bf16 v[76:79],a[196:199],v[228:231],v[76:79]
ds_read_b128 v[224:227],v17 offset:50176
v_rcp_f32 v95,v95
s_waitcnt lgkmcnt(5)
v_mfma_f32_16x16x32_bf16 v[68:71],a[72:75],v[232:235],v[68:71]
buffer_load_dwordx4 v16,s[20:23],s65 offen offset:2048 sc1 lds
v_mfma_f32_16x16x32_bf16 v[76:79],a[200:203],v[232:235],v[76:79]
ds_read_b128 v[228:231],v17 offset:52224
s_xor_b32 m0,s72,33792
v_mfma_f32_16x16x32_bf16 v[68:71],a[76:79],v[236:239],v[68:71]
s_add_u32 s65,s89,65536
v_min3_u32 v27,v27,v232,v236
v_mfma_f32_16x16x32_bf16 v[76:79],a[204:207],v[236:239],v[76:79]
ds_read_b128 v[232:235],v17 offset:54272
s_waitcnt lgkmcnt(5)
v_mfma_f32_16x16x32_bf16 v[68:71],a[80:83],v[240:243],v[68:71]
buffer_load_dwordx4 v16,s[20:23],s65 offen offset:0 sc1 lds
v_mfma_f32_16x16x32_bf16 v[76:79],a[208:211],v[240:243],v[76:79]
ds_read_b128 v[236:239],v17 offset:56320
v_min3_u32 v27,v27,v240,v244
v_mfma_f32_16x16x32_bf16 v[68:71],a[84:87],v[244:247],v[68:71]
buffer_load_dwordx4 v16,s[20:23],s65 offen offset:2048 sc1 lds
v_mfma_f32_16x16x32_bf16 v[76:79],a[212:215],v[244:247],v[76:79]
ds_read_b128 v[240:243],v17 offset:58368
s_waitcnt lgkmcnt(5)
v_mfma_f32_16x16x32_bf16 v[68:71],a[88:91],v[248:251],v[68:71]
s_xor_b32 m0,s72,50176
v_min3_u32 v27,v27,v248,v252
v_mfma_f32_16x16x32_bf16 v[76:79],a[216:219],v[248:251],v[76:79]
ds_read_b128 v[244:247],v17 offset:60416
s_add_u32 s65,s89,98304
v_mfma_f32_16x16x32_bf16 v[68:71],a[92:95],v[252:255],v[68:71]
buffer_load_dwordx4 v16,s[20:23],s65 offen offset:0 sc1 lds
v_mfma_f32_16x16x32_bf16 v[76:79],a[220:223],v[252:255],v[76:79]
ds_read_b128 v[248:251],v17 offset:62464
s_waitcnt lgkmcnt(5)
v_mfma_f32_16x16x32_bf16 v[68:71],a[96:99],v[224:227],v[68:71]
buffer_load_dwordx4 v16,s[20:23],s65 offen offset:2048 sc1 lds
v_mfma_f32_16x16x32_bf16 v[76:79],a[224:227],v[224:227],v[76:79]
ds_read_b128 v[252:255],v17 offset:64512
v_min3_u32 v27,v27,v224,v228
v_mfma_f32_16x16x32_bf16 v[68:71],a[100:103],v[228:231],v[68:71]
v_rcp_f32 v89,v89
v_mfma_f32_16x16x32_bf16 v[76:79],a[228:231],v[228:231],v[76:79]
v_mul_f32 v92,v92,v72
s_waitcnt lgkmcnt(4)
v_mfma_f32_16x16x32_bf16 v[68:71],a[104:107],v[232:235],v[68:71]
v_min3_u32 v27,v27,v232,v236
v_mul_f32 v93,v93,v73
v_mfma_f32_16x16x32_bf16 v[76:79],a[232:235],v[232:235],v[76:79]
v_rcp_f32 v90,v90
v_mfma_f32_16x16x32_bf16 v[68:71],a[108:111],v[236:239],v[68:71]
v_rcp_f32 v91,v91
v_mfma_f32_16x16x32_bf16 v[76:79],a[236:239],v[236:239],v[76:79]
v_mul_f32 v88,v88,v64
s_waitcnt lgkmcnt(2)
v_mfma_f32_16x16x32_bf16 v[68:71],a[112:115],v[240:243],v[68:71]
v_min3_u32 v27,v27,v240,v244
v_mul_f32 v89,v89,v65
v_mfma_f32_16x16x32_bf16 v[76:79],a[240:243],v[240:243],v[76:79]
v_mul_f32 v90,v90,v66
v_mul_f32 v91,v91,v67
v_mfma_f32_16x16x32_bf16 v[68:71],a[116:119],v[244:247],v[68:71]
v_mul_f32 v94,v94,v74
v_mul_f32 v95,v95,v75
v_mfma_f32_16x16x32_bf16 v[76:79],a[244:247],v[244:247],v[76:79]
v_cvt_pk_bf16_f32 v96,v88,v89
s_waitcnt lgkmcnt(0)
v_mfma_f32_16x16x32_bf16 v[68:71],a[120:123],v[248:251],v[68:71]
v_min3_u32 v27,v27,v248,v252
v_cvt_pk_bf16_f32 v97,v90,v91
v_mfma_f32_16x16x32_bf16 v[76:79],a[248:251],v[248:251],v[76:79]
v_cvt_pk_bf16_f32 v98,v92,v93
v_cvt_pk_bf16_f32 v99,v94,v95
v_mfma_f32_16x16x32_bf16 v[68:71],a[124:127],v[252:255],v[68:71]
v_max_u32 v96,1,v96
v_mfma_f32_16x16x32_bf16 v[76:79],a[252:255],v[252:255],v[76:79]
buffer_store_dwordx4 v[96:99],v18,s[20:23],s70 offen offset:0 sc1
v_cmp_eq_u32 vcc,0,v27
s_cbranch_vccnz retry_375
s_branch epi_378
keep_387:
v_mfma_f32_16x16x32_bf16 v[64:67],a[124:127],v[252:255],v[64:67]
v_min3_u32 v27,v27,v248,v252
v_mfma_f32_16x16x32_bf16 v[72:75],a[252:255],v[252:255],v[72:75]
ds_read_b128 v[248:251],v17 offset:13312
s_waitcnt lgkmcnt(6)
v_mfma_f32_16x16x32_bf16 v[68:71],a[0:3],v[224:227],0
v_cmp_eq_u32 vcc,0,v27
s_cbranch_vccnz retry_375
v_mfma_f32_16x16x32_bf16 v[76:79],a[128:131],v[224:227],0
ds_read_b128 v[252:255],v17 offset:15360
v_min3_u32 v27,v27,v224,v228
v_mfma_f32_16x16x32_bf16 v[68:71],a[4:7],v[228:231],v[68:71]
s_waitcnt lgkmcnt(6)
v_mfma_f32_16x16x32_bf16 v[76:79],a[132:135],v[228:231],v[76:79]
ds_read_b128 v[224:227],v17 offset:17408
s_waitcnt lgkmcnt(5)
v_mfma_f32_16x16x32_bf16 v[68:71],a[8:11],v[232:235],v[68:71]
v_min3_u32 v27,v27,v232,v236
v_fmac_f32 v64,v52,v120
v_fmac_f32 v72,v56,v120
v_mfma_f32_16x16x32_bf16 v[76:79],a[136:139],v[232:235],v[76:79]
ds_read_b128 v[228:231],v17 offset:19456
v_fmac_f32 v65,v53,v120
v_fmac_f32 v73,v57,v120
v_mfma_f32_16x16x32_bf16 v[68:71],a[12:15],v[236:239],v[68:71]
v_fmac_f32 v66,v54,v120
v_fmac_f32 v67,v55,v120
v_fmac_f32 v74,v58,v120
v_mfma_f32_16x16x32_bf16 v[76:79],a[140:143],v[236:239],v[76:79]
ds_read_b128 v[232:235],v17 offset:21504
v_fmac_f32 v75,v59,v120
s_waitcnt lgkmcnt(5)
v_mfma_f32_16x16x32_bf16 v[68:71],a[16:19],v[240:243],v[68:71]
v_min3_u32 v27,v27,v240,v244
v_mul_f32 v88,v64,v64
v_mul_f32 v92,v72,v72
v_mfma_f32_16x16x32_bf16 v[76:79],a[144:147],v[240:243],v[76:79]
ds_read_b128 v[236:239],v17 offset:23552
v_mul_f32 v89,v65,v65
v_mul_f32 v93,v73,v73
v_mfma_f32_16x16x32_bf16 v[68:71],a[20:23],v[244:247],v[68:71]
v_mul_f32 v90,v66,v66
v_mul_f32 v91,v67,v67
v_mul_f32 v94,v74,v74
v_mfma_f32_16x16x32_bf16 v[76:79],a[148:151],v[244:247],v[76:79]
ds_read_b128 v[240:243],v17 offset:25600
v_mul_f32 v95,v75,v75
s_waitcnt lgkmcnt(5)
v_mfma_f32_16x16x32_bf16 v[68:71],a[24:27],v[248:251],v[68:71]
v_min3_u32 v27,v27,v248,v252
v_fma_f32 v88,v88,v121,v122
v_fma_f32 v92,v92,v121,v122
v_mfma_f32_16x16x32_bf16 v[76:79],a[152:155],v[248:251],v[76:79]
ds_read_b128 v[244:247],v17 offset:27648
v_fma_f32 v89,v89,v121,v122
v_fma_f32 v93,v93,v121,v122
v_mfma_f32_16x16x32_bf16 v[68:71],a[28:31],v[252:255],v[68:71]
v_fma_f32 v90,v90,v121,v122
v_fma_f32 v91,v91,v121,v122
v_fma_f32 v94,v94,v121,v122
v_mfma_f32_16x16x32_bf16 v[76:79],a[156:159],v[252:255],v[76:79]
ds_read_b128 v[248:251],v17 offset:29696
v_fma_f32 v95,v95,v121,v122
s_waitcnt lgkmcnt(5)
v_mfma_f32_16x16x32_bf16 v[68:71],a[32:35],v[224:227],v[68:71]
v_min3_u32 v27,v27,v224,v228
v_mul_f32 v88,v88,v64
v_mul_f32 v92,v92,v72
v_mfma_f32_16x16x32_bf16 v[76:79],a[160:163],v[224:227],v[76:79]
ds_read_b128 v[252:255],v17 offset:31744
v_mul_f32 v89,v89,v65
v_mul_f32 v93,v93,v73
v_mfma_f32_16x16x32_bf16 v[68:71],a[36:39],v[228:231],v[68:71]
v_mul_f32 v90,v90,v66
v_mul_f32 v91,v91,v67
v_mul_f32 v94,v94,v74
v_mfma_f32_16x16x32_bf16 v[76:79],a[164:167],v[228:231],v[76:79]
ds_read_b128 v[224:227],v17 offset:33792
v_mul_f32 v95,v95,v75
s_waitcnt lgkmcnt(5)
v_mfma_f32_16x16x32_bf16 v[68:71],a[40:43],v[232:235],v[68:71]
v_min3_u32 v27,v27,v232,v236
v_exp_f32 v92,v92
v_mfma_f32_16x16x32_bf16 v[76:79],a[168:171],v[232:235],v[76:79]
ds_read_b128 v[228:231],v17 offset:35840
v_exp_f32 v93,v93
v_mfma_f32_16x16x32_bf16 v[68:71],a[44:47],v[236:239],v[68:71]
v_exp_f32 v88,v88
v_mfma_f32_16x16x32_bf16 v[76:79],a[172:175],v[236:239],v[76:79]
ds_read_b128 v[232:235],v17 offset:37888
s_waitcnt lgkmcnt(5)
v_mfma_f32_16x16x32_bf16 v[68:71],a[48:51],v[240:243],v[68:71]
v_min3_u32 v27,v27,v240,v244
v_exp_f32 v94,v94
v_mfma_f32_16x16x32_bf16 v[76:79],a[176:179],v[240:243],v[76:79]
ds_read_b128 v[236:239],v17 offset:39936
v_exp_f32 v95,v95
v_mfma_f32_16x16x32_bf16 v[68:71],a[52:55],v[244:247],v[68:71]
v_exp_f32 v89,v89
v_fma_f32 v92,v92,v123,v123
v_mfma_f32_16x16x32_bf16 v[76:79],a[180:183],v[244:247],v[76:79]
ds_read_b128 v[240:243],v17 offset:41984
v_fma_f32 v93,v93,v123,v123
s_waitcnt lgkmcnt(5)
v_mfma_f32_16x16x32_bf16 v[68:71],a[56:59],v[248:251],v[68:71]
v_min3_u32 v27,v27,v248,v252
v_fma_f32 v94,v94,v123,v123
v_fma_f32 v95,v95,v123,v123
v_mfma_f32_16x16x32_bf16 v[76:79],a[184:187],v[248:251],v[76:79]
ds_read_b128 v[244:247],v17 offset:44032
v_rcp_f32 v92,v92
v_mfma_f32_16x16x32_bf16 v[68:71],a[60:63],v[252:255],v[68:71]
v_exp_f32 v90,v90
v_mfma_f32_16x16x32_bf16 v[76:79],a[188:191],v[252:255],v[76:79]
ds_read_b128 v[248:251],v17 offset:46080
s_waitcnt lgkmcnt(5)
v_mfma_f32_16x16x32_bf16 v[68:71],a[64:67],v[224:227],v[68:71]
v_min3_u32 v27,v27,v224,v228
v_rcp_f32 v93,v93
v_mfma_f32_16x16x32_bf16 v[76:79],a[192:195],v[224:227],v[76:79]
ds_read_b128 v[252:255],v17 offset:48128
v_rcp_f32 v94,v94
v_mfma_f32_16x16x32_bf16 v[68:71],a[68:71],v[228:231],v[68:71]
v_exp_f32 v91,v91
v_mfma_f32_16x16x32_bf16 v[76:79],a[196:199],v[228:231],v[76:79]
ds_read_b128 v[224:227],v17 offset:50176
s_waitcnt lgkmcnt(5)
v_mfma_f32_16x16x32_bf16 v[68:71],a[72:75],v[232:235],v[68:71]
v_min3_u32 v27,v27,v232,v236
v_fma_f32 v88,v88,v123,v123
v_mfma_f32_16x16x32_bf16 v[76:79],a[200:203],v[232:235],v[76:79]
ds_read_b128 v[228:231],v17 offset:52224
v_fma_f32 v89,v89,v123,v123
v_mfma_f32_16x16x32_bf16 v[68:71],a[76:79],v[236:239],v[68:71]
v_fma_f32 v90,v90,v123,v123
v_fma_f32 v91,v91,v123,v123
v_mfma_f32_16x16x32_bf16 v[76:79],a[204:207],v[236:239],v[76:79]
ds_read_b128 v[232:235],v17 offset:54272
s_waitcnt lgkmcnt(5)
v_mfma_f32_16x16x32_bf16 v[68:71],a[80:83],v[240:243],v[68:71]
v_min3_u32 v27,v27,v240,v244
v_rcp_f32 v95,v95
v_mfma_f32_16x16x32_bf16 v[76:79],a[208:211],v[240:243],v[76:79]
ds_read_b128 v[236:239],v17 offset:56320
v_mul_f32 v92,v92,v72
v_mfma_f32_16x16x32_bf16 v[68:71],a[84:87],v[244:247],v[68:71]
v_rcp_f32 v88,v88
v_mfma_f32_16x16x32_bf16 v[76:79],a[212:215],v[244:247],v[76:79]
ds_read_b128 v[240:243],v17 offset:58368
s_waitcnt lgkmcnt(5)
v_mfma_f32_16x16x32_bf16 v[68:71],a[88:91],v[248:251],v[68:71]
v_min3_u32 v27,v27,v248,v252
v_mul_f32 v93,v93,v73
v_mfma_f32_16x16x32_bf16 v[76:79],a[216:219],v[248:251],v[76:79]
ds_read_b128 v[244:247],v17 offset:60416
v_mul_f32 v94,v94,v74
v_mfma_f32_16x16x32_bf16 v[68:71],a[92:95],v[252:255],v[68:71]
v_rcp_f32 v89,v89
v_mfma_f32_16x16x32_bf16 v[76:79],a[220:223],v[252:255],v[76:79]
ds_read_b128 v[248:251],v17 offset:62464
s_waitcnt lgkmcnt(5)
v_mfma_f32_16x16x32_bf16 v[68:71],a[96:99],v[224:227],v[68:71]
v_min3_u32 v27,v27,v224,v228
v_mul_f32 v95,v95,v75
v_mfma_f32_16x16x32_bf16 v[76:79],a[224:227],v[224:227],v[76:79]
ds_read_b128 v[252:255],v17 offset:64512
v_mfma_f32_16x16x32_bf16 v[68:71],a[100:103],v[228:231],v[68:71]
v_rcp_f32 v90,v90
v_mfma_f32_16x16x32_bf16 v[76:79],a[228:231],v[228:231],v[76:79]
s_waitcnt lgkmcnt(4)
v_mfma_f32_16x16x32_bf16 v[68:71],a[104:107],v[232:235],v[68:71]
v_min3_u32 v27,v27,v232,v236
v_mfma_f32_16x16x32_bf16 v[76:79],a[232:235],v[232:235],v[76:79]
v_rcp_f32 v91,v91
v_mfma_f32_16x16x32_bf16 v[68:71],a[108:111],v[236:239],v[68:71]
v_mul_f32 v88,v88,v64
v_mul_f32 v89,v89,v65
v_mfma_f32_16x16x32_bf16 v[76:79],a[236:239],v[236:239],v[76:79]
v_mul_f32 v90,v90,v66
s_waitcnt lgkmcnt(2)
v_mfma_f32_16x16x32_bf16 v[68:71],a[112:115],v[240:243],v[68:71]
v_min3_u32 v27,v27,v240,v244
v_mul_f32 v91,v91,v67
v_mfma_f32_16x16x32_bf16 v[76:79],a[240:243],v[240:243],v[76:79]
v_cvt_pk_bf16_f32 v96,v88,v89
v_cvt_pk_bf16_f32 v97,v90,v91
v_mfma_f32_16x16x32_bf16 v[68:71],a[116:119],v[244:247],v[68:71]
v_cvt_pk_bf16_f32 v98,v92,v93
v_cvt_pk_bf16_f32 v99,v94,v95
v_mfma_f32_16x16x32_bf16 v[76:79],a[244:247],v[244:247],v[76:79]
v_max_u32 v96,1,v96
s_waitcnt lgkmcnt(0)
v_mfma_f32_16x16x32_bf16 v[68:71],a[120:123],v[248:251],v[68:71]
v_min3_u32 v27,v27,v248,v252
v_mfma_f32_16x16x32_bf16 v[76:79],a[248:251],v[248:251],v[76:79]
buffer_store_dwordx4 v[96:99],v18,s[20:23],s70 offen offset:0 sc1
v_mfma_f32_16x16x32_bf16 v[68:71],a[124:127],v[252:255],v[68:71]
v_mfma_f32_16x16x32_bf16 v[76:79],a[252:255],v[252:255],v[76:79]
v_cmp_eq_u32 vcc,0,v27
s_cbranch_vccnz retry_375
s_branch epi_378
both_379:
s_waitcnt vmcnt(12) lgkmcnt(0)
s_barrier
ds_read_b128 v[224:227],v17 offset:0
ds_read_b128 v[228:231],v17 offset:2048
ds_read_b128 v[232:235],v17 offset:4096
ds_read_b128 v[236:239],v17 offset:6144
ds_read_b128 v[240:243],v17 offset:8192
ds_read_b128 v[244:247],v17 offset:10240
ds_read_b128 v[248:251],v17 offset:12288
s_waitcnt lgkmcnt(5)
v_mfma_f32_16x16x32_bf16 v[64:67],a[0:3],v[224:227],0
s_add_u32 s96,s71,1
s_add_u32 s92,s71,2
s_add_u32 s88,s70,s75
v_mfma_f32_16x16x32_bf16 v[72:75],a[128:131],v[224:227],0
ds_read_b128 v[252:255],v17 offset:14336
s_add_u32 s88,s88,2097152
s_xor_b32 s88,s88,0x2000
v_mfma_f32_16x16x32_bf16 v[64:67],a[4:7],v[228:231],v[64:67]
s_cmp_eq_u32 s96,64
s_cselect_b32 s96,99,s96
v_min_u32 v27,v224,v228
v_mfma_f32_16x16x32_bf16 v[72:75],a[132:135],v[228:231],v[72:75]
ds_read_b128 v[224:227],v17 offset:16384
s_waitcnt lgkmcnt(5)
v_mfma_f32_16x16x32_bf16 v[64:67],a[8:11],v[232:235],v[64:67]
s_cmp_eq_u32 s92,64
s_cselect_b32 s92,99,s92
v_mfma_f32_16x16x32_bf16 v[72:75],a[136:139],v[232:235],v[72:75]
ds_read_b128 v[228:231],v17 offset:18432
s_xor_b32 s89,s88,1024
v_mfma_f32_16x16x32_bf16 v[64:67],a[12:15],v[236:239],v[64:67]
s_xor_b32 m0,s72,0
v_min3_u32 v27,v27,v232,v236
v_mfma_f32_16x16x32_bf16 v[72:75],a[140:143],v[236:239],v[72:75]
ds_read_b128 v[232:235],v17 offset:20480
s_add_u32 s65,s88,0
s_waitcnt lgkmcnt(5)
v_mfma_f32_16x16x32_bf16 v[64:67],a[16:19],v[240:243],v[64:67]
v_min3_u32 v27,v27,v240,v244
v_mfma_f32_16x16x32_bf16 v[72:75],a[144:147],v[240:243],v[72:75]
ds_read_b128 v[236:239],v17 offset:22528
buffer_load_dwordx4 v16,s[20:23],s65 offen offset:0 sc1 lds
v_mfma_f32_16x16x32_bf16 v[64:67],a[20:23],v[244:247],v[64:67]
buffer_load_dwordx4 v16,s[20:23],s65 offen offset:2048 sc1 lds
v_mfma_f32_16x16x32_bf16 v[72:75],a[148:151],v[244:247],v[72:75]
ds_read_b128 v[240:243],v17 offset:24576
s_waitcnt lgkmcnt(5)
v_mfma_f32_16x16x32_bf16 v[64:67],a[24:27],v[248:251],v[64:67]
s_xor_b32 m0,s72,16384
v_min3_u32 v27,v27,v248,v252
v_mfma_f32_16x16x32_bf16 v[72:75],a[152:155],v[248:251],v[72:75]
ds_read_b128 v[244:247],v17 offset:26624
v_mfma_f32_16x16x32_bf16 v[64:67],a[28:31],v[252:255],v[64:67]
s_add_u32 s65,s88,32768
v_mfma_f32_16x16x32_bf16 v[72:75],a[156:159],v[252:255],v[72:75]
ds_read_b128 v[248:251],v17 offset:28672
s_waitcnt lgkmcnt(5)
v_mfma_f32_16x16x32_bf16 v[64:67],a[32:35],v[224:227],v[64:67]
buffer_load_dwordx4 v16,s[20:23],s65 offen offset:0 sc1 lds
v_mfma_f32_16x16x32_bf16 v[72:75],a[160:163],v[224:227],v[72:75]
ds_read_b128 v[252:255],v17 offset:30720
buffer_load_dwordx4 v16,s[20:23],s65 offen offset:2048 sc1 lds
v_mfma_f32_16x16x32_bf16 v[64:67],a[36:39],v[228:231],v[64:67]
v_min3_u32 v27,v27,v224,v228
v_mfma_f32_16x16x32_bf16 v[72:75],a[164:167],v[228:231],v[72:75]
ds_read_b128 v[224:227],v17 offset:32768
s_xor_b32 m0,s72,32768
s_waitcnt lgkmcnt(5)
v_mfma_f32_16x16x32_bf16 v[64:67],a[40:43],v[232:235],v[64:67]
s_add_u32 s65,s88,65536
v_min3_u32 v27,v27,v232,v236
v_mfma_f32_16x16x32_bf16 v[72:75],a[168:171],v[232:235],v[72:75]
ds_read_b128 v[228:231],v17 offset:34816
v_mfma_f32_16x16x32_bf16 v[64:67],a[44:47],v[236:239],v[64:67]
buffer_load_dwordx4 v16,s[20:23],s65 offen offset:0 sc1 lds
v_mfma_f32_16x16x32_bf16 v[72:75],a[172:175],v[236:239],v[72:75]
ds_read_b128 v[232:235],v17 offset:36864
s_waitcnt lgkmcnt(5)
v_mfma_f32_16x16x32_bf16 v[64:67],a[48:51],v[240:243],v[64:67]
buffer_load_dwordx4 v16,s[20:23],s65 offen offset:2048 sc1 lds
v_mfma_f32_16x16x32_bf16 v[72:75],a[176:179],v[240:243],v[72:75]
ds_read_b128 v[236:239],v17 offset:38912
s_xor_b32 m0,s72,49152
v_mfma_f32_16x16x32_bf16 v[64:67],a[52:55],v[244:247],v[64:67]
v_min3_u32 v27,v27,v240,v244
v_mfma_f32_16x16x32_bf16 v[72:75],a[180:183],v[244:247],v[72:75]
ds_read_b128 v[240:243],v17 offset:40960
s_add_u32 s65,s88,98304
s_waitcnt lgkmcnt(5)
v_mfma_f32_16x16x32_bf16 v[64:67],a[56:59],v[248:251],v[64:67]
buffer_load_dwordx4 v16,s[20:23],s65 offen offset:0 sc1 lds
v_min3_u32 v27,v27,v248,v252
v_mfma_f32_16x16x32_bf16 v[72:75],a[184:187],v[248:251],v[72:75]
ds_read_b128 v[244:247],v17 offset:43008
s_waitcnt vmcnt(9)
v_mfma_f32_16x16x32_bf16 v[64:67],a[60:63],v[252:255],v[64:67]
v_cmp_gt_u32 vcc,s96,v29
v_cmp_gt_u32 s[92:93],s92,v29
v_mfma_f32_16x16x32_bf16 v[72:75],a[188:191],v[252:255],v[72:75]
ds_read_b128 v[248:251],v17 offset:45056
s_waitcnt lgkmcnt(5)
v_mfma_f32_16x16x32_bf16 v[64:67],a[64:67],v[224:227],v[64:67]
v_mov_b32 v44,vcc_lo
v_mov_b32 v45,s92
v_min3_u32 v27,v27,v224,v228
v_mfma_f32_16x16x32_bf16 v[72:75],a[192:195],v[224:227],v[72:75]
ds_read_b128 v[252:255],v17 offset:47104
ds_write_b64 v46,v[44:45]
v_mfma_f32_16x16x32_bf16 v[64:67],a[68:71],v[228:231],v[64:67]
buffer_load_dwordx4 v16,s[20:23],s65 offen offset:2048 sc1 lds
v_mfma_f32_16x16x32_bf16 v[72:75],a[196:199],v[228:231],v[72:75]
ds_read_b128 v[224:227],v17 offset:49152
s_waitcnt lgkmcnt(6)
v_mfma_f32_16x16x32_bf16 v[64:67],a[72:75],v[232:235],v[64:67]
s_xor_b32 m0,s72,1024
s_add_u32 s65,s89,0
v_mfma_f32_16x16x32_bf16 v[72:75],a[200:203],v[232:235],v[72:75]
ds_read_b128 v[228:231],v17 offset:51200
v_min3_u32 v27,v27,v232,v236
v_mfma_f32_16x16x32_bf16 v[64:67],a[76:79],v[236:239],v[64:67]
buffer_load_dwordx4 v16,s[20:23],s65 offen offset:0 sc1 lds
v_mfma_f32_16x16x32_bf16 v[72:75],a[204:207],v[236:239],v[72:75]
ds_read_b128 v[232:235],v17 offset:53248
s_waitcnt lgkmcnt(6)
v_mfma_f32_16x16x32_bf16 v[64:67],a[80:83],v[240:243],v[64:67]
buffer_load_dwordx4 v16,s[20:23],s65 offen offset:2048 sc1 lds
v_mfma_f32_16x16x32_bf16 v[72:75],a[208:211],v[240:243],v[72:75]
ds_read_b128 v[236:239],v17 offset:55296
s_xor_b32 m0,s72,17408
v_mfma_f32_16x16x32_bf16 v[64:67],a[84:87],v[244:247],v[64:67]
s_add_u32 s65,s89,32768
v_min3_u32 v27,v27,v240,v244
v_mfma_f32_16x16x32_bf16 v[72:75],a[212:215],v[244:247],v[72:75]
ds_read_b128 v[240:243],v17 offset:57344
s_waitcnt lgkmcnt(6)
v_mfma_f32_16x16x32_bf16 v[64:67],a[88:91],v[248:251],v[64:67]
buffer_load_dwordx4 v16,s[20:23],s65 offen offset:0 sc1 lds
v_mfma_f32_16x16x32_bf16 v[72:75],a[216:219],v[248:251],v[72:75]
ds_read_b128 v[244:247],v17 offset:59392
v_min3_u32 v27,v27,v248,v252
v_mfma_f32_16x16x32_bf16 v[64:67],a[92:95],v[252:255],v[64:67]
buffer_load_dwordx4 v16,s[20:23],s65 offen offset:2048 sc1 lds
v_mfma_f32_16x16x32_bf16 v[72:75],a[220:223],v[252:255],v[72:75]
ds_read_b128 v[248:251],v17 offset:61440
s_waitcnt lgkmcnt(5)
v_mfma_f32_16x16x32_bf16 v[64:67],a[96:99],v[224:227],v[64:67]
s_xor_b32 m0,s72,33792
s_add_u32 s65,s89,65536
v_mfma_f32_16x16x32_bf16 v[72:75],a[224:227],v[224:227],v[72:75]
ds_read_b128 v[252:255],v17 offset:63488
v_min3_u32 v27,v27,v224,v228
v_mfma_f32_16x16x32_bf16 v[64:67],a[100:103],v[228:231],v[64:67]
buffer_load_dwordx4 v16,s[20:23],s65 offen offset:0 sc1 lds
s_waitcnt vmcnt(13)
v_add_u32 v22,s71,-1
v_mfma_f32_16x16x32_bf16 v[72:75],a[228:231],v[228:231],v[72:75]
s_waitcnt vmcnt(17)
s_barrier
ds_read_b64 v[44:45],v47
ds_read_b128 v[224:227],v17 offset:1024
s_waitcnt lgkmcnt(6)
v_mfma_f32_16x16x32_bf16 v[64:67],a[104:107],v[232:235],v[64:67]
buffer_load_dwordx4 v16,s[20:23],s65 offen offset:2048 sc1 lds
buffer_store_dword v22,v23,s[20:23],s97 offen sc1
v_mfma_f32_16x16x32_bf16 v[72:75],a[232:235],v[232:235],v[72:75]
ds_read_b128 v[228:231],v17 offset:3072
s_xor_b32 m0,s72,50176
s_mov_b32 s97,0x7fff0000
v_mfma_f32_16x16x32_bf16 v[64:67],a[108:111],v[236:239],v[64:67]
s_add_u32 s65,s89,98304
v_min3_u32 v27,v27,v232,v236
ds_read_b128 v[124:127],v19 offset:256
v_mfma_f32_16x16x32_bf16 v[72:75],a[236:239],v[236:239],v[72:75]
ds_read_b128 v[232:235],v17 offset:5120
ds_read_b128 v[120:123],v19 offset:0
s_waitcnt lgkmcnt(8)
v_mfma_f32_16x16x32_bf16 v[64:67],a[112:115],v[240:243],v[64:67]
buffer_load_dwordx4 v16,s[20:23],s65 offen offset:0 sc1 lds
v_mfma_f32_16x16x32_bf16 v[72:75],a[240:243],v[240:243],v[72:75]
ds_read_b128 v[236:239],v17 offset:7168
v_min3_u32 v27,v27,v240,v244
v_mfma_f32_16x16x32_bf16 v[64:67],a[116:119],v[244:247],v[64:67]
buffer_load_dwordx4 v16,s[20:23],s65 offen offset:2048 sc1 lds
v_mfma_f32_16x16x32_bf16 v[72:75],a[244:247],v[244:247],v[72:75]
ds_read_b128 v[240:243],v17 offset:9216
s_waitcnt lgkmcnt(8)
v_mfma_f32_16x16x32_bf16 v[64:67],a[120:123],v[248:251],v[64:67]
s_waitcnt lgkmcnt(7)
v_readfirstlane_b32 s93,v45
v_mfma_f32_16x16x32_bf16 v[72:75],a[248:251],v[248:251],v[72:75]
ds_read_b128 v[244:247],v17 offset:11264
v_min3_u32 v27,v27,v248,v252
v_mfma_f32_16x16x32_bf16 v[64:67],a[124:127],v[252:255],v[64:67]
v_mfma_f32_16x16x32_bf16 v[72:75],a[252:255],v[252:255],v[72:75]
ds_read_b128 v[248:251],v17 offset:13312
s_waitcnt lgkmcnt(7)
v_mfma_f32_16x16x32_bf16 v[68:71],a[0:3],v[224:227],0
v_cmp_eq_u32 vcc,0,v27
s_cbranch_vccnz retry_375
v_mfma_f32_16x16x32_bf16 v[76:79],a[128:131],v[224:227],0
ds_read_b128 v[252:255],v17 offset:15360
v_min3_u32 v27,v27,v224,v228
v_mfma_f32_16x16x32_bf16 v[68:71],a[4:7],v[228:231],v[68:71]
s_waitcnt lgkmcnt(5)
v_mfma_f32_16x16x32_bf16 v[76:79],a[132:135],v[228:231],v[76:79]
ds_read_b128 v[224:227],v17 offset:17408
s_waitcnt lgkmcnt(5)
v_mfma_f32_16x16x32_bf16 v[68:71],a[8:11],v[232:235],v[68:71]
v_min3_u32 v27,v27,v232,v236
v_fmac_f32 v64,v52,v120
v_fmac_f32 v72,v56,v120
v_mfma_f32_16x16x32_bf16 v[76:79],a[136:139],v[232:235],v[76:79]
ds_read_b128 v[228:231],v17 offset:19456
v_fmac_f32 v65,v53,v120
v_fmac_f32 v73,v57,v120
v_mfma_f32_16x16x32_bf16 v[68:71],a[12:15],v[236:239],v[68:71]
v_fmac_f32 v66,v54,v120
v_fmac_f32 v67,v55,v120
v_fmac_f32 v74,v58,v120
v_mfma_f32_16x16x32_bf16 v[76:79],a[140:143],v[236:239],v[76:79]
ds_read_b128 v[232:235],v17 offset:21504
v_fmac_f32 v75,v59,v120
s_waitcnt lgkmcnt(5)
v_mfma_f32_16x16x32_bf16 v[68:71],a[16:19],v[240:243],v[68:71]
v_min3_u32 v27,v27,v240,v244
v_mul_f32 v88,v64,v64
v_mul_f32 v92,v72,v72
v_mfma_f32_16x16x32_bf16 v[76:79],a[144:147],v[240:243],v[76:79]
ds_read_b128 v[236:239],v17 offset:23552
v_mul_f32 v89,v65,v65
v_mul_f32 v93,v73,v73
v_mfma_f32_16x16x32_bf16 v[68:71],a[20:23],v[244:247],v[68:71]
v_mul_f32 v90,v66,v66
v_mul_f32 v91,v67,v67
v_mul_f32 v94,v74,v74
v_mfma_f32_16x16x32_bf16 v[76:79],a[148:151],v[244:247],v[76:79]
ds_read_b128 v[240:243],v17 offset:25600
v_mul_f32 v95,v75,v75
s_waitcnt lgkmcnt(5)
v_mfma_f32_16x16x32_bf16 v[68:71],a[24:27],v[248:251],v[68:71]
v_min3_u32 v27,v27,v248,v252
v_fma_f32 v88,v88,v121,v122
v_fma_f32 v92,v92,v121,v122
v_mfma_f32_16x16x32_bf16 v[76:79],a[152:155],v[248:251],v[76:79]
ds_read_b128 v[244:247],v17 offset:27648
v_fma_f32 v89,v89,v121,v122
v_fma_f32 v93,v93,v121,v122
v_mfma_f32_16x16x32_bf16 v[68:71],a[28:31],v[252:255],v[68:71]
v_fma_f32 v90,v90,v121,v122
v_fma_f32 v91,v91,v121,v122
v_fma_f32 v94,v94,v121,v122
v_mfma_f32_16x16x32_bf16 v[76:79],a[156:159],v[252:255],v[76:79]
ds_read_b128 v[248:251],v17 offset:29696
v_fma_f32 v95,v95,v121,v122
s_waitcnt lgkmcnt(5)
v_mfma_f32_16x16x32_bf16 v[68:71],a[32:35],v[224:227],v[68:71]
v_min3_u32 v27,v27,v224,v228
v_mul_f32 v88,v88,v64
v_mul_f32 v92,v92,v72
v_mfma_f32_16x16x32_bf16 v[76:79],a[160:163],v[224:227],v[76:79]
ds_read_b128 v[252:255],v17 offset:31744
v_mul_f32 v89,v89,v65
v_mul_f32 v93,v93,v73
v_mfma_f32_16x16x32_bf16 v[68:71],a[36:39],v[228:231],v[68:71]
v_mul_f32 v90,v90,v66
v_mul_f32 v91,v91,v67
v_mul_f32 v94,v94,v74
v_mfma_f32_16x16x32_bf16 v[76:79],a[164:167],v[228:231],v[76:79]
ds_read_b128 v[224:227],v17 offset:33792
v_mul_f32 v95,v95,v75
s_waitcnt lgkmcnt(5)
v_mfma_f32_16x16x32_bf16 v[68:71],a[40:43],v[232:235],v[68:71]
v_min3_u32 v27,v27,v232,v236
v_exp_f32 v92,v92
v_mfma_f32_16x16x32_bf16 v[76:79],a[168:171],v[232:235],v[76:79]
ds_read_b128 v[228:231],v17 offset:35840
v_exp_f32 v93,v93
v_mfma_f32_16x16x32_bf16 v[68:71],a[44:47],v[236:239],v[68:71]
v_exp_f32 v88,v88
v_mfma_f32_16x16x32_bf16 v[76:79],a[172:175],v[236:239],v[76:79]
ds_read_b128 v[232:235],v17 offset:37888
s_waitcnt lgkmcnt(5)
v_mfma_f32_16x16x32_bf16 v[68:71],a[48:51],v[240:243],v[68:71]
v_min3_u32 v27,v27,v240,v244
v_exp_f32 v94,v94
v_mfma_f32_16x16x32_bf16 v[76:79],a[176:179],v[240:243],v[76:79]
ds_read_b128 v[236:239],v17 offset:39936
v_exp_f32 v95,v95
v_mfma_f32_16x16x32_bf16 v[68:71],a[52:55],v[244:247],v[68:71]
v_exp_f32 v89,v89
v_fma_f32 v92,v92,v123,v123
v_mfma_f32_16x16x32_bf16 v[76:79],a[180:183],v[244:247],v[76:79]
ds_read_b128 v[240:243],v17 offset:41984
v_fma_f32 v93,v93,v123,v123
s_waitcnt lgkmcnt(5)
v_mfma_f32_16x16x32_bf16 v[68:71],a[56:59],v[248:251],v[68:71]
v_min3_u32 v27,v27,v248,v252
v_fma_f32 v94,v94,v123,v123
v_fma_f32 v95,v95,v123,v123
v_mfma_f32_16x16x32_bf16 v[76:79],a[184:187],v[248:251],v[76:79]
ds_read_b128 v[244:247],v17 offset:44032
v_rcp_f32 v92,v92
v_mfma_f32_16x16x32_bf16 v[68:71],a[60:63],v[252:255],v[68:71]
v_exp_f32 v90,v90
v_mfma_f32_16x16x32_bf16 v[76:79],a[188:191],v[252:255],v[76:79]
ds_read_b128 v[248:251],v17 offset:46080
s_waitcnt lgkmcnt(5)
v_mfma_f32_16x16x32_bf16 v[68:71],a[64:67],v[224:227],v[68:71]
v_min3_u32 v27,v27,v224,v228
v_rcp_f32 v93,v93
v_mfma_f32_16x16x32_bf16 v[76:79],a[192:195],v[224:227],v[76:79]
ds_read_b128 v[252:255],v17 offset:48128
v_rcp_f32 v94,v94
v_mfma_f32_16x16x32_bf16 v[68:71],a[68:71],v[228:231],v[68:71]
v_exp_f32 v91,v91
v_mfma_f32_16x16x32_bf16 v[76:79],a[196:199],v[228:231],v[76:79]
ds_read_b128 v[224:227],v17 offset:50176
s_waitcnt lgkmcnt(5)
v_mfma_f32_16x16x32_bf16 v[68:71],a[72:75],v[232:235],v[68:71]
v_min3_u32 v27,v27,v232,v236
v_fma_f32 v88,v88,v123,v123
v_mfma_f32_16x16x32_bf16 v[76:79],a[200:203],v[232:235],v[76:79]
ds_read_b128 v[228:231],v17 offset:52224
v_fma_f32 v89,v89,v123,v123
v_mfma_f32_16x16x32_bf16 v[68:71],a[76:79],v[236:239],v[68:71]
v_fma_f32 v90,v90,v123,v123
v_fma_f32 v91,v91,v123,v123
v_mfma_f32_16x16x32_bf16 v[76:79],a[204:207],v[236:239],v[76:79]
ds_read_b128 v[232:235],v17 offset:54272
s_waitcnt lgkmcnt(5)
v_mfma_f32_16x16x32_bf16 v[68:71],a[80:83],v[240:243],v[68:71]
v_min3_u32 v27,v27,v240,v244
v_rcp_f32 v95,v95
v_mfma_f32_16x16x32_bf16 v[76:79],a[208:211],v[240:243],v[76:79]
ds_read_b128 v[236:239],v17 offset:56320
v_mul_f32 v92,v92,v72
v_mfma_f32_16x16x32_bf16 v[68:71],a[84:87],v[244:247],v[68:71]
v_rcp_f32 v88,v88
v_mfma_f32_16x16x32_bf16 v[76:79],a[212:215],v[244:247],v[76:79]
ds_read_b128 v[240:243],v17 offset:58368
s_waitcnt lgkmcnt(5)
v_mfma_f32_16x16x32_bf16 v[68:71],a[88:91],v[248:251],v[68:71]
v_min3_u32 v27,v27,v248,v252
v_mul_f32 v93,v93,v73
v_mfma_f32_16x16x32_bf16 v[76:79],a[216:219],v[248:251],v[76:79]
ds_read_b128 v[244:247],v17 offset:60416
v_mul_f32 v94,v94,v74
v_mfma_f32_16x16x32_bf16 v[68:71],a[92:95],v[252:255],v[68:71]
v_rcp_f32 v89,v89
v_mfma_f32_16x16x32_bf16 v[76:79],a[220:223],v[252:255],v[76:79]
ds_read_b128 v[248:251],v17 offset:62464
s_waitcnt lgkmcnt(5)
v_mfma_f32_16x16x32_bf16 v[68:71],a[96:99],v[224:227],v[68:71]
v_min3_u32 v27,v27,v224,v228
v_mul_f32 v95,v95,v75
v_mfma_f32_16x16x32_bf16 v[76:79],a[224:227],v[224:227],v[76:79]
ds_read_b128 v[252:255],v17 offset:64512
v_mfma_f32_16x16x32_bf16 v[68:71],a[100:103],v[228:231],v[68:71]
v_rcp_f32 v90,v90
v_mfma_f32_16x16x32_bf16 v[76:79],a[228:231],v[228:231],v[76:79]
s_waitcnt lgkmcnt(4)
v_mfma_f32_16x16x32_bf16 v[68:71],a[104:107],v[232:235],v[68:71]
v_min3_u32 v27,v27,v232,v236
v_mfma_f32_16x16x32_bf16 v[76:79],a[232:235],v[232:235],v[76:79]
v_rcp_f32 v91,v91
v_mfma_f32_16x16x32_bf16 v[68:71],a[108:111],v[236:239],v[68:71]
v_mul_f32 v88,v88,v64
v_mul_f32 v89,v89,v65
v_mfma_f32_16x16x32_bf16 v[76:79],a[236:239],v[236:239],v[76:79]
v_mul_f32 v90,v90,v66
s_waitcnt lgkmcnt(2)
v_mfma_f32_16x16x32_bf16 v[68:71],a[112:115],v[240:243],v[68:71]
v_min3_u32 v27,v27,v240,v244
v_mul_f32 v91,v91,v67
v_mfma_f32_16x16x32_bf16 v[76:79],a[240:243],v[240:243],v[76:79]
v_cvt_pk_bf16_f32 v96,v88,v89
v_cvt_pk_bf16_f32 v97,v90,v91
v_mfma_f32_16x16x32_bf16 v[68:71],a[116:119],v[244:247],v[68:71]
v_cvt_pk_bf16_f32 v98,v92,v93
v_cvt_pk_bf16_f32 v99,v94,v95
v_mfma_f32_16x16x32_bf16 v[76:79],a[244:247],v[244:247],v[76:79]
v_max_u32 v96,1,v96
s_waitcnt lgkmcnt(0)
v_mfma_f32_16x16x32_bf16 v[68:71],a[120:123],v[248:251],v[68:71]
v_min3_u32 v27,v27,v248,v252
v_mfma_f32_16x16x32_bf16 v[76:79],a[248:251],v[248:251],v[76:79]
buffer_store_dwordx4 v[96:99],v18,s[20:23],s70 offen offset:0 sc1
v_mfma_f32_16x16x32_bf16 v[68:71],a[124:127],v[252:255],v[68:71]
v_mfma_f32_16x16x32_bf16 v[76:79],a[252:255],v[252:255],v[76:79]
v_cmp_eq_u32 vcc,0,v27
s_cbranch_vccnz retry_375
epi_378:
buffer_load_dword v29,v21,s[20:23],s87 offen sc1
s_nop 3
v_pk_fma_f32 v[68:69],v[52:53],v[124:125],v[68:69] op_sel_hi:[1,0,1]
v_pk_fma_f32 v[70:71],v[54:55],v[124:125],v[70:71] op_sel_hi:[1,0,1]
v_pk_fma_f32 v[76:77],v[56:57],v[124:125],v[76:77] op_sel_hi:[1,0,1]
v_pk_fma_f32 v[78:79],v[58:59],v[124:125],v[78:79] op_sel_hi:[1,0,1]
v_pk_mul_f32 v[88:89],v[68:69],v[68:69]
v_pk_mul_f32 v[90:91],v[70:71],v[70:71]
v_pk_mul_f32 v[92:93],v[76:77],v[76:77]
v_pk_mul_f32 v[94:95],v[78:79],v[78:79]
v_pk_fma_f32 v[88:89],v[88:89],v[124:125],v[126:127] op_sel:[0,1,0] op_sel_hi:[1,1,0]
v_pk_fma_f32 v[90:91],v[90:91],v[124:125],v[126:127] op_sel:[0,1,0] op_sel_hi:[1,1,0]
v_pk_fma_f32 v[92:93],v[92:93],v[124:125],v[126:127] op_sel:[0,1,0] op_sel_hi:[1,1,0]
v_pk_fma_f32 v[94:95],v[94:95],v[124:125],v[126:127] op_sel:[0,1,0] op_sel_hi:[1,1,0]
v_pk_mul_f32 v[88:89],v[88:89],v[68:69]
v_pk_mul_f32 v[90:91],v[90:91],v[70:71]
v_pk_mul_f32 v[92:93],v[92:93],v[76:77]
v_pk_mul_f32 v[94:95],v[94:95],v[78:79]
v_exp_f32 v88,v88
v_exp_f32 v89,v89
v_exp_f32 v90,v90
v_exp_f32 v91,v91
v_exp_f32 v92,v92
v_exp_f32 v93,v93
v_exp_f32 v94,v94
s_cmp_gt_u32 s71,51
s_cselect_b32 s65,s73,0x7fff0000
s_cselect_b32 s97,0x7fff0000,s73
v_mov_b32 v22,s71
buffer_store_dword v22,v23,s[20:23],s65 offen sc1
v_exp_f32 v95,v95
v_pk_fma_f32 v[88:89],v[88:89],v[126:127],v[126:127] op_sel:[0,1,1] op_sel_hi:[1,1,1]
v_pk_fma_f32 v[90:91],v[90:91],v[126:127],v[126:127] op_sel:[0,1,1] op_sel_hi:[1,1,1]
v_pk_fma_f32 v[92:93],v[92:93],v[126:127],v[126:127] op_sel:[0,1,1] op_sel_hi:[1,1,1]
v_pk_fma_f32 v[94:95],v[94:95],v[126:127],v[126:127] op_sel:[0,1,1] op_sel_hi:[1,1,1]
v_rcp_f32 v88,v88
v_rcp_f32 v89,v89
v_rcp_f32 v90,v90
v_rcp_f32 v91,v91
v_rcp_f32 v92,v92
v_rcp_f32 v93,v93
v_rcp_f32 v94,v94
v_rcp_f32 v95,v95
v_pk_mul_f32 v[88:89],v[88:89],v[68:69]
v_pk_mul_f32 v[90:91],v[90:91],v[70:71]
v_pk_mul_f32 v[92:93],v[92:93],v[76:77]
v_pk_mul_f32 v[94:95],v[94:95],v[78:79]
v_cvt_pk_bf16_f32 v96,v88,v89
v_cvt_pk_bf16_f32 v97,v90,v91
v_cvt_pk_bf16_f32 v98,v92,v93
v_cvt_pk_bf16_f32 v99,v94,v95
v_max_u32 v96,1,v96
buffer_store_dwordx4 v[96:99],v18,s[20:23],s70 offen offset:1024 sc1
next_385:
v_xor_b32 v17,0x10000,v17
s_xor_b32 s72,s72,0x10000
s_add_u32 s70,s70,2097152
s_xor_b32 s70,s70,0x2000
s_add_u32 s71,s71,1
s_cmp_le_u32 s71,s57
s_cbranch_scc1 seg_376
s_endpgm
retry_375:
s_sub_u32 s90,s90,64
s_cmp_lt_i32 s90,0
s_cbranch_scc1 giveup_197
s_mov_b32 s83,1
s_waitcnt vmcnt(0) lgkmcnt(0)
s_barrier
s_branch seg_376
half_384:
s_mov_b64 exec,s[52:53]
s_xor_b32 m0,s91,0
s_add_u32 s65,s94,0
buffer_load_dwordx4 v16,s[20:23],s65 offen offset:0 sc1 lds
buffer_load_dwordx4 v16,s[20:23],s65 offen offset:2048 sc1 lds
s_xor_b32 m0,s91,16384
s_add_u32 s65,s94,32768
buffer_load_dwordx4 v16,s[20:23],s65 offen offset:0 sc1 lds
buffer_load_dwordx4 v16,s[20:23],s65 offen offset:2048 sc1 lds
s_xor_b32 m0,s91,32768
s_add_u32 s65,s94,65536
buffer_load_dwordx4 v16,s[20:23],s65 offen offset:0 sc1 lds
buffer_load_dwordx4 v16,s[20:23],s65 offen offset:2048 sc1 lds
s_xor_b32 m0,s91,49152
s_add_u32 s65,s94,98304
buffer_load_dwordx4 v16,s[20:23],s65 offen offset:0 sc1 lds
buffer_load_dwordx4 v16,s[20:23],s65 offen offset:2048 sc1 lds
s_mov_b64 exec,-1
s_waitcnt vmcnt(8)
v_add_u32 v22,s71,-1
buffer_store_dword v22,v23,s[20:23],s97 offen sc1
s_mov_b32 s97,0x7fff0000
half2_381:
s_waitcnt vmcnt(7)
s_barrier
ds_read_b128 v[224:227],v17 offset:0
ds_read_b128 v[228:231],v17 offset:2048
ds_read_b128 v[232:235],v17 offset:4096
ds_read_b128 v[236:239],v17 offset:6144
ds_read_b128 v[240:243],v17 offset:8192
ds_read_b128 v[244:247],v17 offset:10240
ds_read_b128 v[248:251],v17 offset:12288
s_waitcnt lgkmcnt(5)
v_mfma_f32_16x16x32_bf16 v[64:67],a[0:3],v[224:227],0
v_min_u32 v27,v224,v228
v_mfma_f32_16x16x32_bf16 v[72:75],a[128:131],v[224:227],0
ds_read_b128 v[252:255],v17 offset:14336
v_mfma_f32_16x16x32_bf16 v[64:67],a[4:7],v[228:231],v[64:67]
v_mfma_f32_16x16x32_bf16 v[72:75],a[132:135],v[228:231],v[72:75]
s_waitcnt vmcnt(5)
s_barrier
ds_read_b128 v[224:227],v17 offset:16384
s_waitcnt lgkmcnt(5)
v_mfma_f32_16x16x32_bf16 v[64:67],a[8:11],v[232:235],v[64:67]
v_min3_u32 v27,v27,v232,v236
v_mfma_f32_16x16x32_bf16 v[72:75],a[136:139],v[232:235],v[72:75]
ds_read_b128 v[228:231],v17 offset:18432
v_mfma_f32_16x16x32_bf16 v[64:67],a[12:15],v[236:239],v[64:67]
v_mfma_f32_16x16x32_bf16 v[72:75],a[140:143],v[236:239],v[72:75]
ds_read_b128 v[232:235],v17 offset:20480
s_waitcnt lgkmcnt(5)
v_mfma_f32_16x16x32_bf16 v[64:67],a[16:19],v[240:243],v[64:67]
v_min3_u32 v27,v27,v240,v244
v_mfma_f32_16x16x32_bf16 v[72:75],a[144:147],v[240:243],v[72:75]
ds_read_b128 v[236:239],v17 offset:22528
v_mfma_f32_16x16x32_bf16 v[64:67],a[20:23],v[244:247],v[64:67]
v_mfma_f32_16x16x32_bf16 v[72:75],a[148:151],v[244:247],v[72:75]
ds_read_b128 v[240:243],v17 offset:24576
s_waitcnt lgkmcnt(5)
v_mfma_f32_16x16x32_bf16 v[64:67],a[24:27],v[248:251],v[64:67]
v_min3_u32 v27,v27,v248,v252
v_mfma_f32_16x16x32_bf16 v[72:75],a[152:155],v[248:251],v[72:75]
ds_read_b128 v[244:247],v17 offset:26624
v_mfma_f32_16x16x32_bf16 v[64:67],a[28:31],v[252:255],v[64:67]
v_mfma_f32_16x16x32_bf16 v[72:75],a[156:159],v[252:255],v[72:75]
ds_read_b128 v[248:251],v17 offset:28672
s_waitcnt lgkmcnt(5)
v_mfma_f32_16x16x32_bf16 v[64:67],a[32:35],v[224:227],v[64:67]
v_min3_u32 v27,v27,v224,v228
v_mfma_f32_16x16x32_bf16 v[72:75],a[160:163],v[224:227],v[72:75]
ds_read_b128 v[252:255],v17 offset:30720
v_mfma_f32_16x16x32_bf16 v[64:67],a[36:39],v[228:231],v[64:67]
v_mfma_f32_16x16x32_bf16 v[72:75],a[164:167],v[228:231],v[72:75]
s_waitcnt vmcnt(1)
s_barrier
ds_read_b128 v[224:227],v17 offset:32768
s_waitcnt lgkmcnt(5)
v_mfma_f32_16x16x32_bf16 v[64:67],a[40:43],v[232:235],v[64:67]
v_min3_u32 v27,v27,v232,v236
v_mfma_f32_16x16x32_bf16 v[72:75],a[168:171],v[232:235],v[72:75]
ds_read_b128 v[228:231],v17 offset:34816
v_mfma_f32_16x16x32_bf16 v[64:67],a[44:47],v[236:239],v[64:67]
v_mfma_f32_16x16x32_bf16 v[72:75],a[172:175],v[236:239],v[72:75]
ds_read_b128 v[232:235],v17 offset:36864
s_waitcnt lgkmcnt(5)
v_mfma_f32_16x16x32_bf16 v[64:67],a[48:51],v[240:243],v[64:67]
v_min3_u32 v27,v27,v240,v244
v_mfma_f32_16x16x32_bf16 v[72:75],a[176:179],v[240:243],v[72:75]
ds_read_b128 v[236:239],v17 offset:38912
v_mfma_f32_16x16x32_bf16 v[64:67],a[52:55],v[244:247],v[64:67]
v_mfma_f32_16x16x32_bf16 v[72:75],a[180:183],v[244:247],v[72:75]
ds_read_b128 v[240:243],v17 offset:40960
s_waitcnt lgkmcnt(5)
v_mfma_f32_16x16x32_bf16 v[64:67],a[56:59],v[248:251],v[64:67]
v_min3_u32 v27,v27,v248,v252
v_mfma_f32_16x16x32_bf16 v[72:75],a[184:187],v[248:251],v[72:75]
ds_read_b128 v[244:247],v17 offset:43008
v_mfma_f32_16x16x32_bf16 v[64:67],a[60:63],v[252:255],v[64:67]
v_mfma_f32_16x16x32_bf16 v[72:75],a[188:191],v[252:255],v[72:75]
ds_read_b128 v[248:251],v17 offset:45056
s_waitcnt lgkmcnt(5)
v_mfma_f32_16x16x32_bf16 v[64:67],a[64:67],v[224:227],v[64:67]
v_min3_u32 v27,v27,v224,v228
v_mfma_f32_16x16x32_bf16 v[72:75],a[192:195],v[224:227],v[72:75]
ds_read_b128 v[252:255],v17 offset:47104
v_mfma_f32_16x16x32_bf16 v[64:67],a[68:71],v[228:231],v[64:67]
v_mfma_f32_16x16x32_bf16 v[72:75],a[196:199],v[228:231],v[72:75]
ds_read_b128 v[224:227],v17 offset:49152
s_waitcnt lgkmcnt(5)
v_mfma_f32_16x16x32_bf16 v[64:67],a[72:75],v[232:235],v[64:67]
v_min3_u32 v27,v27,v232,v236
v_mfma_f32_16x16x32_bf16 v[72:75],a[200:203],v[232:235],v[72:75]
ds_read_b128 v[228:231],v17 offset:51200
v_mfma_f32_16x16x32_bf16 v[64:67],a[76:79],v[236:239],v[64:67]
v_mfma_f32_16x16x32_bf16 v[72:75],a[204:207],v[236:239],v[72:75]
ds_read_b128 v[232:235],v17 offset:53248
s_waitcnt lgkmcnt(5)
v_mfma_f32_16x16x32_bf16 v[64:67],a[80:83],v[240:243],v[64:67]
v_min3_u32 v27,v27,v240,v244
v_mfma_f32_16x16x32_bf16 v[72:75],a[208:211],v[240:243],v[72:75]
ds_read_b128 v[236:239],v17 offset:55296
v_mfma_f32_16x16x32_bf16 v[64:67],a[84:87],v[244:247],v[64:67]
v_mfma_f32_16x16x32_bf16 v[72:75],a[212:215],v[244:247],v[72:75]
ds_read_b128 v[240:243],v17 offset:57344
s_waitcnt lgkmcnt(5)
v_mfma_f32_16x16x32_bf16 v[64:67],a[88:91],v[248:251],v[64:67]
v_min3_u32 v27,v27,v248,v252
v_mfma_f32_16x16x32_bf16 v[72:75],a[216:219],v[248:251],v[72:75]
ds_read_b128 v[244:247],v17 offset:59392
v_mfma_f32_16x16x32_bf16 v[64:67],a[92:95],v[252:255],v[64:67]
v_mfma_f32_16x16x32_bf16 v[72:75],a[220:223],v[252:255],v[72:75]
ds_read_b128 v[248:251],v17 offset:61440
s_waitcnt lgkmcnt(5)
v_mfma_f32_16x16x32_bf16 v[64:67],a[96:99],v[224:227],v[64:67]
v_min3_u32 v27,v27,v224,v228
v_mfma_f32_16x16x32_bf16 v[72:75],a[224:227],v[224:227],v[72:75]
s_barrier
ds_read_b128 v[252:255],v17 offset:63488
v_mfma_f32_16x16x32_bf16 v[64:67],a[100:103],v[228:231],v[64:67]
ds_read_b128 v[120:123],v19
v_mfma_f32_16x16x32_bf16 v[72:75],a[228:231],v[228:231],v[72:75]
s_waitcnt lgkmcnt(5)
v_mfma_f32_16x16x32_bf16 v[64:67],a[104:107],v[232:235],v[64:67]
v_min3_u32 v27,v27,v232,v236
v_mfma_f32_16x16x32_bf16 v[72:75],a[232:235],v[232:235],v[72:75]
v_mfma_f32_16x16x32_bf16 v[64:67],a[108:111],v[236:239],v[64:67]
v_mfma_f32_16x16x32_bf16 v[72:75],a[236:239],v[236:239],v[72:75]
s_waitcnt lgkmcnt(3)
v_mfma_f32_16x16x32_bf16 v[64:67],a[112:115],v[240:243],v[64:67]
v_min3_u32 v27,v27,v240,v244
v_mfma_f32_16x16x32_bf16 v[72:75],a[240:243],v[240:243],v[72:75]
v_mfma_f32_16x16x32_bf16 v[64:67],a[116:119],v[244:247],v[64:67]
v_mfma_f32_16x16x32_bf16 v[72:75],a[244:247],v[244:247],v[72:75]
s_waitcnt lgkmcnt(1)
v_mfma_f32_16x16x32_bf16 v[64:67],a[120:123],v[248:251],v[64:67]
v_min3_u32 v27,v27,v248,v252
v_mfma_f32_16x16x32_bf16 v[72:75],a[248:251],v[248:251],v[72:75]
v_mfma_f32_16x16x32_bf16 v[64:67],a[124:127],v[252:255],v[64:67]
v_mfma_f32_16x16x32_bf16 v[72:75],a[252:255],v[252:255],v[72:75]
v_cmp_eq_u32 vcc,0,v27
s_and_b64 vcc,vcc,s[52:53]
s_cbranch_vccnz retry_375
s_waitcnt lgkmcnt(0)
s_nop 3
v_pk_fma_f32 v[64:65],v[52:53],v[120:121],v[64:65] op_sel_hi:[1,0,1]
v_pk_fma_f32 v[66:67],v[54:55],v[120:121],v[66:67] op_sel_hi:[1,0,1]
v_pk_fma_f32 v[72:73],v[56:57],v[120:121],v[72:73] op_sel_hi:[1,0,1]
v_pk_fma_f32 v[74:75],v[58:59],v[120:121],v[74:75] op_sel_hi:[1,0,1]
v_pk_mul_f32 v[88:89],v[64:65],v[64:65]
v_pk_mul_f32 v[90:91],v[66:67],v[66:67]
buffer_load_dword v29,v21,s[20:23],s87 offen sc1
v_mov_b32 v22,s71
buffer_store_dword v22,v23,s[20:23],s73 offen sc1
v_pk_mul_f32 v[92:93],v[72:73],v[72:73]
v_pk_mul_f32 v[94:95],v[74:75],v[74:75]
v_pk_fma_f32 v[88:89],v[88:89],v[120:121],v[122:123] op_sel:[0,1,0] op_sel_hi:[1,1,0]
v_pk_fma_f32 v[90:91],v[90:91],v[120:121],v[122:123] op_sel:[0,1,0] op_sel_hi:[1,1,0]
v_pk_fma_f32 v[92:93],v[92:93],v[120:121],v[122:123] op_sel:[0,1,0] op_sel_hi:[1,1,0]
v_pk_fma_f32 v[94:95],v[94:95],v[120:121],v[122:123] op_sel:[0,1,0] op_sel_hi:[1,1,0]
v_pk_mul_f32 v[88:89],v[88:89],v[64:65]
v_pk_mul_f32 v[90:91],v[90:91],v[66:67]
v_pk_mul_f32 v[92:93],v[92:93],v[72:73]
v_pk_mul_f32 v[94:95],v[94:95],v[74:75]
v_exp_f32 v88,v88
v_exp_f32 v89,v89
v_exp_f32 v90,v90
v_exp_f32 v91,v91
v_exp_f32 v92,v92
v_exp_f32 v93,v93
v_exp_f32 v94,v94
v_exp_f32 v95,v95
v_pk_fma_f32 v[88:89],v[88:89],v[122:123],v[122:123] op_sel:[0,1,1] op_sel_hi:[1,1,1]
v_pk_fma_f32 v[90:91],v[90:91],v[122:123],v[122:123] op_sel:[0,1,1] op_sel_hi:[1,1,1]
v_pk_fma_f32 v[92:93],v[92:93],v[122:123],v[122:123] op_sel:[0,1,1] op_sel_hi:[1,1,1]
v_pk_fma_f32 v[94:95],v[94:95],v[122:123],v[122:123] op_sel:[0,1,1] op_sel_hi:[1,1,1]
v_rcp_f32 v88,v88
v_rcp_f32 v89,v89
v_rcp_f32 v90,v90
v_rcp_f32 v91,v91
v_rcp_f32 v92,v92
v_rcp_f32 v93,v93
v_rcp_f32 v94,v94
v_rcp_f32 v95,v95
v_pk_mul_f32 v[88:89],v[88:89],v[64:65]
v_pk_mul_f32 v[90:91],v[90:91],v[66:67]
v_pk_mul_f32 v[92:93],v[92:93],v[72:73]
v_pk_mul_f32 v[94:95],v[94:95],v[74:75]
v_cvt_pk_bf16_f32 v96,v88,v89
v_cvt_pk_bf16_f32 v97,v90,v91
v_cvt_pk_bf16_f32 v98,v92,v93
v_cvt_pk_bf16_f32 v99,v94,v95
v_max_u32 v96,1,v96
buffer_store_dwordx4 v[96:99],v18,s[20:23],s70 offen offset:0 sc1
s_branch next_385
w3b_374:
s_add_u32 s64,s79,0
s_lshl_b32 s70,s64,21
s_lshl_b32 s64,s64,13
s_and_b32 s64,s64,0x2000
s_xor_b32 s64,s64,s62
s_add_u32 s70,s70,s64
s_add_u32 s70,s70,29360128
s_mov_b32 s83,1
s_mov_b32 s87,s74
s_cmp_eq_u32 s50,0
s_cselect_b32 s74,s74,0x7fff0000
v_mov_b32 v47,132096
s_lshl_b32 s64,s50,3
s_add_u32 s64,s64,132096
v_mov_b32 v46,s64
v_mov_b32 v29,0
s_mov_b32 s97,0x7fff0000
s_mov_b32 s69,1
s_mov_b32 s68,0
s_mov_b32 s52,0x30003
s_mov_b32 s53,s52
seg_391:
s_cmp_eq_u32 s83,0
s_cbranch_scc1 ahead_392
s_add_u32 s94,s70,s75
s_xor_b32 s95,s94,1024
s_xor_b32 s91,s72,0x10000
s_cmp_eq_u32 s69,0
s_mov_b32 s69,1
s_cbranch_scc1 half2_396
s_waitcnt vmcnt(2)
v_cmp_gt_u32 vcc,s71,v29
s_cbranch_vccz nb_395
s_waitcnt vmcnt(0)
v_add_u32 v22,s71,-1
buffer_store_dword v22,v23,s[20:23],s97 offen sc1
s_mov_b32 s97,0x7fff0000
s_cmp_lg_u32 s50,0
s_cbranch_scc1 nb_395
buffer_load_dword v32,v21,s[20:23],s74 offen sc1
s_sleep 2
pl_397:
buffer_load_dword v33,v21,s[20:23],s74 offen sc1
s_waitcnt vmcnt(1)
v_cmp_gt_u32 vcc,s71,v32
v_mov_b32 v29,v32
s_cbranch_vccz pok_398
buffer_load_dword v32,v21,s[20:23],s74 offen sc1
s_waitcnt vmcnt(1)
v_cmp_gt_u32 vcc,s71,v33
v_mov_b32 v29,v33
s_cbranch_vccz pok_398
s_sub_u32 s90,s90,1
s_cmp_gt_i32 s90,0
s_cbranch_scc1 pl_397
pok_398:
nb_395:
s_cmp_eq_u32 s71,64
s_barrier
s_cbranch_scc1 half_399
s_xor_b32 m0,s91,0
s_add_u32 s65,s94,0
buffer_load_dwordx4 v16,s[20:23],s65 offen offset:0 sc1 lds
buffer_load_dwordx4 v16,s[20:23],s65 offen offset:2048 sc1 lds
s_xor_b32 m0,s91,16384
s_add_u32 s65,s94,32768
buffer_load_dwordx4 v16,s[20:23],s65 offen offset:0 sc1 lds
buffer_load_dwordx4 v16,s[20:23],s65 offen offset:2048 sc1 lds
s_xor_b32 m0,s91,32768
s_add_u32 s65,s94,65536
buffer_load_dwordx4 v16,s[20:23],s65 offen offset:0 sc1 lds
buffer_load_dwordx4 v16,s[20:23],s65 offen offset:2048 sc1 lds
s_xor_b32 m0,s91,49152
s_add_u32 s65,s94,98304
buffer_load_dwordx4 v16,s[20:23],s65 offen offset:0 sc1 lds
buffer_load_dwordx4 v16,s[20:23],s65 offen offset:2048 sc1 lds
s_add_u32 s66,s94,110592
buffer_load_dwordx4 v[128:131],v16,s[20:23],s66 offen offset:0 sc1
buffer_load_dwordx4 v[132:135],v16,s[20:23],s66 offen offset:1024 sc1
buffer_load_dwordx4 v[136:139],v16,s[20:23],s66 offen offset:2048 sc1
buffer_load_dwordx4 v[140:143],v16,s[20:23],s66 offen offset:3072 sc1
s_add_u32 s66,s94,114688
buffer_load_dwordx4 v[144:147],v16,s[20:23],s66 offen offset:0 sc1
buffer_load_dwordx4 v[148:151],v16,s[20:23],s66 offen offset:1024 sc1
buffer_load_dwordx4 v[152:155],v16,s[20:23],s66 offen offset:2048 sc1
buffer_load_dwordx4 v[156:159],v16,s[20:23],s66 offen offset:3072 sc1
s_waitcnt vmcnt(16)
v_add_u32 v22,s71,-1
buffer_store_dword v22,v23,s[20:23],s97 offen sc1
s_mov_b32 s97,0x7fff0000
s_waitcnt vmcnt(15)
s_barrier
ds_read_b128 v[224:227],v17 offset:0
ds_read_b128 v[228:231],v17 offset:2048
ds_read_b128 v[232:235],v17 offset:4096
ds_read_b128 v[236:239],v17 offset:6144
ds_read_b128 v[240:243],v17 offset:8192
ds_read_b128 v[244:247],v17 offset:10240
ds_read_b128 v[248:251],v17 offset:12288
s_waitcnt lgkmcnt(5)
v_mfma_f32_16x16x32_bf16 v[64:67],a[0:3],v[224:227],0
ds_read_b128 v[252:255],v17 offset:14336
s_xor_b32 m0,s91,1024
s_add_u32 s65,s95,0
buffer_load_dwordx4 v16,s[20:23],s65 offen offset:0 sc1 lds
buffer_load_dwordx4 v16,s[20:23],s65 offen offset:2048 sc1 lds
v_min_u32 v27,v224,v228
v_mfma_f32_16x16x32_bf16 v[72:75],a[4:7],v[228:231],0
s_waitcnt vmcnt(15)
s_barrier
ds_read_b128 v[224:227],v17 offset:16384
s_xor_b32 m0,s91,17408
s_add_u32 s65,s95,32768
s_waitcnt lgkmcnt(5)
v_mfma_f32_16x16x32_bf16 v[64:67],a[8:11],v[232:235],v[64:67]
ds_read_b128 v[228:231],v17 offset:18432
buffer_load_dwordx4 v16,s[20:23],s65 offen offset:0 sc1 lds
buffer_load_dwordx4 v16,s[20:23],s65 offen offset:2048 sc1 lds
s_xor_b32 m0,s91,33792
v_min3_u32 v27,v27,v232,v236
v_mfma_f32_16x16x32_bf16 v[72:75],a[12:15],v[236:239],v[72:75]
ds_read_b128 v[232:235],v17 offset:20480
s_add_u32 s65,s95,65536
buffer_load_dwordx4 v16,s[20:23],s65 offen offset:0 sc1 lds
s_waitcnt lgkmcnt(5)
v_mfma_f32_16x16x32_bf16 v[64:67],a[16:19],v[240:243],v[64:67]
ds_read_b128 v[236:239],v17 offset:22528
buffer_load_dwordx4 v16,s[20:23],s65 offen offset:2048 sc1 lds
s_xor_b32 m0,s91,50176
s_add_u32 s65,s95,98304
v_min3_u32 v27,v27,v240,v244
v_mfma_f32_16x16x32_bf16 v[72:75],a[20:23],v[244:247],v[72:75]
ds_read_b128 v[240:243],v17 offset:24576
buffer_load_dwordx4 v16,s[20:23],s65 offen offset:0 sc1 lds
buffer_load_dwordx4 v16,s[20:23],s65 offen offset:2048 sc1 lds
s_waitcnt lgkmcnt(5)
v_mfma_f32_16x16x32_bf16 v[64:67],a[24:27],v[248:251],v[64:67]
ds_read_b128 v[244:247],v17 offset:26624
v_min3_u32 v27,v27,v248,v252
v_mfma_f32_16x16x32_bf16 v[72:75],a[28:31],v[252:255],v[72:75]
ds_read_b128 v[248:251],v17 offset:28672
s_waitcnt lgkmcnt(5)
v_mfma_f32_16x16x32_bf16 v[64:67],a[32:35],v[224:227],v[64:67]
ds_read_b128 v[252:255],v17 offset:30720
v_min3_u32 v27,v27,v224,v228
v_mfma_f32_16x16x32_bf16 v[72:75],a[36:39],v[228:231],v[72:75]
s_waitcnt vmcnt(17)
s_barrier
ds_read_b128 v[224:227],v17 offset:32768
s_waitcnt lgkmcnt(5)
v_mfma_f32_16x16x32_bf16 v[64:67],a[40:43],v[232:235],v[64:67]
ds_read_b128 v[228:231],v17 offset:34816
v_min3_u32 v27,v27,v232,v236
v_mfma_f32_16x16x32_bf16 v[72:75],a[44:47],v[236:239],v[72:75]
ds_read_b128 v[232:235],v17 offset:36864
s_waitcnt lgkmcnt(5)
v_mfma_f32_16x16x32_bf16 v[64:67],a[48:51],v[240:243],v[64:67]
ds_read_b128 v[236:239],v17 offset:38912
v_min3_u32 v27,v27,v240,v244
v_mfma_f32_16x16x32_bf16 v[72:75],a[52:55],v[244:247],v[72:75]
ds_read_b128 v[240:243],v17 offset:40960
s_add_u32 s88,s70,s75
s_add_u32 s88,s88,2097152
s_xor_b32 s88,s88,0x2000
s_xor_b32 s89,s88,1024
s_waitcnt lgkmcnt(5)
v_mfma_f32_16x16x32_bf16 v[64:67],a[56:59],v[248:251],v[64:67]
ds_read_b128 v[244:247],v17 offset:43008
v_min3_u32 v27,v27,v248,v252
v_mfma_f32_16x16x32_bf16 v[72:75],a[60:63],v[252:255],v[72:75]
ds_read_b128 v[248:251],v17 offset:45056
s_waitcnt lgkmcnt(5)
v_mfma_f32_16x16x32_bf16 v[64:67],a[64:67],v[224:227],v[64:67]
ds_read_b128 v[252:255],v17 offset:47104
v_min3_u32 v27,v27,v224,v228
v_mfma_f32_16x16x32_bf16 v[72:75],a[68:71],v[228:231],v[72:75]
ds_read_b128 v[224:227],v17 offset:49152
s_waitcnt lgkmcnt(5)
v_mfma_f32_16x16x32_bf16 v[64:67],a[72:75],v[232:235],v[64:67]
ds_read_b128 v[228:231],v17 offset:51200
v_min3_u32 v27,v27,v232,v236
v_mfma_f32_16x16x32_bf16 v[72:75],a[76:79],v[236:239],v[72:75]
ds_read_b128 v[232:235],v17 offset:53248
s_waitcnt lgkmcnt(5)
v_mfma_f32_16x16x32_bf16 v[64:67],a[80:83],v[240:243],v[64:67]
ds_read_b128 v[236:239],v17 offset:55296
v_min3_u32 v27,v27,v240,v244
v_mfma_f32_16x16x32_bf16 v[72:75],a[84:87],v[244:247],v[72:75]
ds_read_b128 v[240:243],v17 offset:57344
s_waitcnt lgkmcnt(5)
v_mfma_f32_16x16x32_bf16 v[64:67],a[88:91],v[248:251],v[64:67]
ds_read_b128 v[244:247],v17 offset:59392
v_min3_u32 v27,v27,v248,v252
v_mfma_f32_16x16x32_bf16 v[72:75],a[92:95],v[252:255],v[72:75]
ds_read_b128 v[248:251],v17 offset:61440
s_waitcnt vmcnt(9)
stk_405:
v_min3_u32 v22,v129,v133,v137
v_min3_u32 v22,v22,v141,v145
v_min3_u32 v22,v22,v149,v153
v_min_u32 v22,v22,v157
v_cmp_eq_u32 vcc,0,v22
s_cmp_lt_i32 s90,0
s_cselect_b64 vcc,0,vcc
s_cbranch_vccnz str_406
v_pk_add_f32 v[88:89],v[128:129],v[144:145]
v_pk_add_f32 v[90:91],v[130:131],v[146:147]
v_pk_add_f32 v[92:93],v[132:133],v[148:149]
v_pk_add_f32 v[94:95],v[134:135],v[150:151]
v_pk_add_f32 v[96:97],v[136:137],v[152:153]
v_pk_add_f32 v[98:99],v[138:139],v[154:155]
v_pk_add_f32 v[100:101],v[140:141],v[156:157]
v_pk_add_f32 v[102:103],v[142:143],v[158:159]
v_pk_add_f32 v[88:89],v[88:89],v[96:97]
v_pk_add_f32 v[90:91],v[90:91],v[98:99]
v_pk_add_f32 v[92:93],v[92:93],v[100:101]
v_pk_add_f32 v[94:95],v[94:95],v[102:103]
v_pk_add_f32 v[88:89],v[88:89],v[92:93]
v_pk_add_f32 v[90:91],v[90:91],v[94:95]
v_mov_b32 v92,v88
v_mov_b32 v93,v89
v_mov_b32 v94,v90
v_mov_b32 v95,v91
v_permlane16_swap_b32 v92,v88
v_permlane16_swap_b32 v93,v89
v_permlane16_swap_b32 v94,v90
v_permlane16_swap_b32 v95,v91
v_pk_add_f32 v[88:89],v[88:89],v[92:93]
v_pk_add_f32 v[90:91],v[90:91],v[94:95]
v_mov_b32 v92,v88
v_mov_b32 v93,v89
s_waitcnt lgkmcnt(5)
v_mfma_f32_16x16x32_bf16 v[64:67],a[96:99],v[224:227],v[64:67]
ds_read_b128 v[252:255],v17 offset:63488
v_min3_u32 v27,v27,v224,v228
v_mov_b32 v94,v90
v_mov_b32 v95,v91
v_permlane32_swap_b32 v92,v88
v_permlane32_swap_b32 v93,v89
v_permlane32_swap_b32 v94,v90
v_permlane32_swap_b32 v95,v91
v_pk_add_f32 v[88:89],v[88:89],v[92:93]
v_pk_add_f32 v[90:91],v[90:91],v[94:95]
v_mul_f32 v120,0xba800000,v88
v_mul_f32 v124,0xba800000,v90
v_mul_f32 v92,v120,v120
v_mul_f32 v93,v124,v124
v_fma_f32 v92,v89,s82,-v92
v_fma_f32 v93,v91,s82,-v93
v_max_f32 v92,0,v92
v_max_f32 v93,0,v93
v_add_f32 v92,0x3727c5ac,v92
v_add_f32 v93,0x3727c5ac,v93
v_rsq_f32 v94,v92
v_rsq_f32 v95,v93
v_mul_f32 v123,v92,v94
v_mul_f32 v127,v93,v95
v_mul_f32 v122,v28,v94
v_mul_f32 v126,v28,v95
v_mul_f32 v92,v94,v94
v_mul_f32 v93,v95,v95
v_mul_f32 v94,s81,v94
v_mul_f32 v95,s81,v95
v_mul_f32 v121,v92,v94
v_mul_f32 v125,v93,v95
ds_write_b128 v19,v[120:123] offset:0
ds_write_b128 v19,v[124:127] offset:256
v_mfma_f32_16x16x32_bf16 v[72:75],a[100:103],v[228:231],v[72:75]
s_waitcnt vmcnt(4) lgkmcnt(0)
s_barrier
ds_read_b64 v[44:45],v47
ds_read_b128 v[224:227],v17 offset:1024
v_mfma_f32_16x16x32_bf16 v[64:67],a[104:107],v[232:235],v[64:67]
ds_read_b128 v[228:231],v17 offset:3072
v_min3_u32 v27,v27,v232,v236
v_mfma_f32_16x16x32_bf16 v[72:75],a[108:111],v[236:239],v[72:75]
ds_read_b128 v[232:235],v17 offset:5120
v_mfma_f32_16x16x32_bf16 v[64:67],a[112:115],v[240:243],v[64:67]
ds_read_b128 v[236:239],v17 offset:7168
v_min3_u32 v27,v27,v240,v244
v_mfma_f32_16x16x32_bf16 v[72:75],a[116:119],v[244:247],v[72:75]
ds_read_b128 v[240:243],v17 offset:9216
s_waitcnt lgkmcnt(5)
v_readfirstlane_b32 s93,v45
v_mfma_f32_16x16x32_bf16 v[64:67],a[120:123],v[248:251],v[64:67]
ds_read_b128 v[244:247],v17 offset:11264
v_readfirstlane_b32 s83,v44
s_cmp_lg_u32 s83,0
s_cbranch_scc0 keep_401
v_min3_u32 v27,v27,v248,v252
v_mfma_f32_16x16x32_bf16 v[72:75],a[124:127],v[252:255],v[72:75]
ds_read_b128 v[248:251],v17 offset:13312
s_waitcnt lgkmcnt(5)
v_mfma_f32_16x16x32_bf16 v[68:71],a[0:3],v[224:227],0
ds_read_b128 v[252:255],v17 offset:15360
v_cmp_eq_u32 vcc,0,v27
s_cbranch_vccnz retry_390
v_min3_u32 v27,v27,v224,v228
v_mfma_f32_16x16x32_bf16 v[76:79],a[4:7],v[228:231],0
ds_read_b128 v[224:227],v17 offset:17408
s_waitcnt lgkmcnt(5)
v_mfma_f32_16x16x32_bf16 v[68:71],a[8:11],v[232:235],v[68:71]
ds_read_b128 v[228:231],v17 offset:19456
v_min3_u32 v27,v27,v232,v236
v_mfma_f32_16x16x32_bf16 v[76:79],a[12:15],v[236:239],v[76:79]
ds_read_b128 v[232:235],v17 offset:21504
s_waitcnt lgkmcnt(5)
v_mfma_f32_16x16x32_bf16 v[68:71],a[16:19],v[240:243],v[68:71]
ds_read_b128 v[236:239],v17 offset:23552
v_min3_u32 v27,v27,v240,v244
v_add_f32 v64,v64,v72
v_add_f32 v65,v65,v73
v_add_f32 v66,v66,v74
v_add_f32 v67,v67,v75
v_mfma_f32_16x16x32_bf16 v[76:79],a[20:23],v[244:247],v[76:79]
ds_read_b128 v[240:243],v17 offset:25600
v_fmac_f32 v64,v52,v120
v_fmac_f32 v65,v53,v120
v_fmac_f32 v66,v54,v120
v_fmac_f32 v67,v55,v120
s_waitcnt lgkmcnt(5)
v_mfma_f32_16x16x32_bf16 v[68:71],a[24:27],v[248:251],v[68:71]
ds_read_b128 v[244:247],v17 offset:27648
v_min3_u32 v27,v27,v248,v252
v_mul_f32 v88,v64,v64
v_mul_f32 v89,v65,v65
v_mul_f32 v90,v66,v66
v_mul_f32 v91,v67,v67
v_mfma_f32_16x16x32_bf16 v[76:79],a[28:31],v[252:255],v[76:79]
ds_read_b128 v[248:251],v17 offset:29696
v_fma_f32 v88,v88,v121,v122
v_fma_f32 v89,v89,v121,v122
v_fma_f32 v90,v90,v121,v122
v_fma_f32 v91,v91,v121,v122
s_waitcnt lgkmcnt(5)
v_mfma_f32_16x16x32_bf16 v[68:71],a[32:35],v[224:227],v[68:71]
ds_read_b128 v[252:255],v17 offset:31744
v_min3_u32 v27,v27,v224,v228
v_mul_f32 v88,v88,v64
v_mul_f32 v89,v89,v65
v_mul_f32 v90,v90,v66
v_mul_f32 v91,v91,v67
v_mfma_f32_16x16x32_bf16 v[76:79],a[36:39],v[228:231],v[76:79]
s_waitcnt vmcnt(0)
s_barrier
ds_read_b128 v[224:227],v17 offset:33792
v_exp_f32 v88,v88
s_waitcnt lgkmcnt(5)
v_mfma_f32_16x16x32_bf16 v[68:71],a[40:43],v[232:235],v[68:71]
ds_read_b128 v[228:231],v17 offset:35840
v_min3_u32 v27,v27,v232,v236
v_exp_f32 v89,v89
v_exp_f32 v90,v90
v_mfma_f32_16x16x32_bf16 v[76:79],a[44:47],v[236:239],v[76:79]
ds_read_b128 v[232:235],v17 offset:37888
v_exp_f32 v91,v91
v_fma_f32 v88,v88,v123,v123
v_fma_f32 v89,v89,v123,v123
s_waitcnt lgkmcnt(5)
v_mfma_f32_16x16x32_bf16 v[68:71],a[48:51],v[240:243],v[68:71]
ds_read_b128 v[236:239],v17 offset:39936
v_min3_u32 v27,v27,v240,v244
v_fma_f32 v90,v90,v123,v123
v_fma_f32 v91,v91,v123,v123
v_rcp_f32 v88,v88
v_mfma_f32_16x16x32_bf16 v[76:79],a[52:55],v[244:247],v[76:79]
ds_read_b128 v[240:243],v17 offset:41984
v_rcp_f32 v89,v89
v_rcp_f32 v90,v90
s_waitcnt lgkmcnt(5)
v_mfma_f32_16x16x32_bf16 v[68:71],a[56:59],v[248:251],v[68:71]
ds_read_b128 v[244:247],v17 offset:44032
v_min3_u32 v27,v27,v248,v252
v_rcp_f32 v91,v91
v_mul_f32 v88,v88,v64
v_mul_f32 v89,v89,v65
v_mfma_f32_16x16x32_bf16 v[76:79],a[60:63],v[252:255],v[76:79]
ds_read_b128 v[248:251],v17 offset:46080
v_mul_f32 v90,v90,v66
v_mul_f32 v91,v91,v67
v_cvt_pk_bf16_f32 v96,v88,v89
v_cvt_pk_bf16_f32 v97,v90,v91
s_waitcnt lgkmcnt(5)
v_mfma_f32_16x16x32_bf16 v[68:71],a[64:67],v[224:227],v[68:71]
ds_read_b128 v[252:255],v17 offset:48128
v_min3_u32 v27,v27,v224,v228
v_max_u32 v96,1,v96
buffer_store_dwordx2 v[96:97],v18,s[20:23],s70 offen offset:0 sc1
v_mfma_f32_16x16x32_bf16 v[76:79],a[68:71],v[228:231],v[76:79]
ds_read_b128 v[224:227],v17 offset:50176
s_waitcnt lgkmcnt(5)
v_mfma_f32_16x16x32_bf16 v[68:71],a[72:75],v[232:235],v[68:71]
ds_read_b128 v[228:231],v17 offset:52224
v_min3_u32 v27,v27,v232,v236
v_mfma_f32_16x16x32_bf16 v[76:79],a[76:79],v[236:239],v[76:79]
ds_read_b128 v[232:235],v17 offset:54272
s_waitcnt lgkmcnt(5)
v_mfma_f32_16x16x32_bf16 v[68:71],a[80:83],v[240:243],v[68:71]
ds_read_b128 v[236:239],v17 offset:56320
v_min3_u32 v27,v27,v240,v244
v_mfma_f32_16x16x32_bf16 v[76:79],a[84:87],v[244:247],v[76:79]
ds_read_b128 v[240:243],v17 offset:58368
s_waitcnt lgkmcnt(5)
v_mfma_f32_16x16x32_bf16 v[68:71],a[88:91],v[248:251],v[68:71]
ds_read_b128 v[244:247],v17 offset:60416
v_min3_u32 v27,v27,v248,v252
v_mfma_f32_16x16x32_bf16 v[76:79],a[92:95],v[252:255],v[76:79]
ds_read_b128 v[248:251],v17 offset:62464
s_waitcnt lgkmcnt(5)
v_mfma_f32_16x16x32_bf16 v[68:71],a[96:99],v[224:227],v[68:71]
ds_read_b128 v[252:255],v17 offset:64512
v_min3_u32 v27,v27,v224,v228
v_mfma_f32_16x16x32_bf16 v[76:79],a[100:103],v[228:231],v[76:79]
s_waitcnt lgkmcnt(4)
v_mfma_f32_16x16x32_bf16 v[68:71],a[104:107],v[232:235],v[68:71]
v_min3_u32 v27,v27,v232,v236
v_mfma_f32_16x16x32_bf16 v[76:79],a[108:111],v[236:239],v[76:79]
s_waitcnt lgkmcnt(2)
v_mfma_f32_16x16x32_bf16 v[68:71],a[112:115],v[240:243],v[68:71]
v_min3_u32 v27,v27,v240,v244
v_mfma_f32_16x16x32_bf16 v[76:79],a[116:119],v[244:247],v[76:79]
s_waitcnt lgkmcnt(0)
v_mfma_f32_16x16x32_bf16 v[68:71],a[120:123],v[248:251],v[68:71]
v_min3_u32 v27,v27,v248,v252
v_mfma_f32_16x16x32_bf16 v[76:79],a[124:127],v[252:255],v[76:79]
v_cmp_eq_u32 vcc,0,v27
s_cbranch_vccnz retry_390
s_branch epi_393
keep_401:
v_min3_u32 v27,v27,v248,v252
v_mfma_f32_16x16x32_bf16 v[72:75],a[124:127],v[252:255],v[72:75]
ds_read_b128 v[248:251],v17 offset:13312
s_add_u32 s66,s88,110592
buffer_load_dwordx4 v[128:131],v16,s[20:23],s66 offen offset:0 sc1
buffer_load_dwordx4 v[132:135],v16,s[20:23],s66 offen offset:1024 sc1
s_waitcnt lgkmcnt(5)
v_mfma_f32_16x16x32_bf16 v[68:71],a[0:3],v[224:227],0
ds_read_b128 v[252:255],v17 offset:15360
v_cmp_eq_u32 vcc,0,v27
s_cbranch_vccnz retry_390
v_min3_u32 v27,v27,v224,v228
buffer_load_dwordx4 v[136:139],v16,s[20:23],s66 offen offset:2048 sc1
v_mfma_f32_16x16x32_bf16 v[76:79],a[4:7],v[228:231],0
ds_read_b128 v[224:227],v17 offset:17408
buffer_load_dwordx4 v[140:143],v16,s[20:23],s66 offen offset:3072 sc1
s_add_u32 s66,s88,114688
buffer_load_dwordx4 v[144:147],v16,s[20:23],s66 offen offset:0 sc1
s_waitcnt lgkmcnt(5)
v_mfma_f32_16x16x32_bf16 v[68:71],a[8:11],v[232:235],v[68:71]
ds_read_b128 v[228:231],v17 offset:19456
v_min3_u32 v27,v27,v232,v236
buffer_load_dwordx4 v[148:151],v16,s[20:23],s66 offen offset:1024 sc1
buffer_load_dwordx4 v[152:155],v16,s[20:23],s66 offen offset:2048 sc1
v_mfma_f32_16x16x32_bf16 v[76:79],a[12:15],v[236:239],v[76:79]
ds_read_b128 v[232:235],v17 offset:21504
buffer_load_dwordx4 v[156:159],v16,s[20:23],s66 offen offset:3072 sc1
s_waitcnt lgkmcnt(5)
v_mfma_f32_16x16x32_bf16 v[68:71],a[16:19],v[240:243],v[68:71]
ds_read_b128 v[236:239],v17 offset:23552
v_min3_u32 v27,v27,v240,v244
v_add_f32 v64,v64,v72
v_add_f32 v65,v65,v73
v_add_f32 v66,v66,v74
v_add_f32 v67,v67,v75
s_xor_b32 m0,s72,0
v_mfma_f32_16x16x32_bf16 v[76:79],a[20:23],v[244:247],v[76:79]
ds_read_b128 v[240:243],v17 offset:25600
v_fmac_f32 v64,v52,v120
v_fmac_f32 v65,v53,v120
v_fmac_f32 v66,v54,v120
v_fmac_f32 v67,v55,v120
s_add_u32 s65,s88,0
s_waitcnt lgkmcnt(5)
v_mfma_f32_16x16x32_bf16 v[68:71],a[24:27],v[248:251],v[68:71]
ds_read_b128 v[244:247],v17 offset:27648
v_min3_u32 v27,v27,v248,v252
v_mul_f32 v88,v64,v64
v_mul_f32 v89,v65,v65
v_mul_f32 v90,v66,v66
v_mul_f32 v91,v67,v67
v_mfma_f32_16x16x32_bf16 v[76:79],a[28:31],v[252:255],v[76:79]
ds_read_b128 v[248:251],v17 offset:29696
v_fma_f32 v88,v88,v121,v122
v_fma_f32 v89,v89,v121,v122
v_fma_f32 v90,v90,v121,v122
v_fma_f32 v91,v91,v121,v122
s_waitcnt lgkmcnt(5)
v_mfma_f32_16x16x32_bf16 v[68:71],a[32:35],v[224:227],v[68:71]
ds_read_b128 v[252:255],v17 offset:31744
v_min3_u32 v27,v27,v224,v228
v_mul_f32 v88,v88,v64
v_mul_f32 v89,v89,v65
v_mul_f32 v90,v90,v66
v_mul_f32 v91,v91,v67
v_mfma_f32_16x16x32_bf16 v[76:79],a[36:39],v[228:231],v[76:79]
s_waitcnt vmcnt(8)
s_barrier
ds_read_b128 v[224:227],v17 offset:33792
v_exp_f32 v88,v88
s_waitcnt lgkmcnt(5)
v_mfma_f32_16x16x32_bf16 v[68:71],a[40:43],v[232:235],v[68:71]
ds_read_b128 v[228:231],v17 offset:35840
v_min3_u32 v27,v27,v232,v236
v_exp_f32 v89,v89
v_exp_f32 v90,v90
v_mfma_f32_16x16x32_bf16 v[76:79],a[44:47],v[236:239],v[76:79]
ds_read_b128 v[232:235],v17 offset:37888
v_exp_f32 v91,v91
v_fma_f32 v88,v88,v123,v123
v_fma_f32 v89,v89,v123,v123
s_waitcnt lgkmcnt(5)
v_mfma_f32_16x16x32_bf16 v[68:71],a[48:51],v[240:243],v[68:71]
ds_read_b128 v[236:239],v17 offset:39936
v_min3_u32 v27,v27,v240,v244
v_fma_f32 v90,v90,v123,v123
v_fma_f32 v91,v91,v123,v123
v_rcp_f32 v88,v88
v_mfma_f32_16x16x32_bf16 v[76:79],a[52:55],v[244:247],v[76:79]
ds_read_b128 v[240:243],v17 offset:41984
v_rcp_f32 v89,v89
v_rcp_f32 v90,v90
s_waitcnt lgkmcnt(5)
v_mfma_f32_16x16x32_bf16 v[68:71],a[56:59],v[248:251],v[68:71]
ds_read_b128 v[244:247],v17 offset:44032
v_min3_u32 v27,v27,v248,v252
v_rcp_f32 v91,v91
v_mul_f32 v88,v88,v64
v_mul_f32 v89,v89,v65
v_mfma_f32_16x16x32_bf16 v[76:79],a[60:63],v[252:255],v[76:79]
ds_read_b128 v[248:251],v17 offset:46080
v_mul_f32 v90,v90,v66
v_mul_f32 v91,v91,v67
v_cvt_pk_bf16_f32 v96,v88,v89
v_cvt_pk_bf16_f32 v97,v90,v91
s_waitcnt lgkmcnt(5)
v_mfma_f32_16x16x32_bf16 v[68:71],a[64:67],v[224:227],v[68:71]
ds_read_b128 v[252:255],v17 offset:48128
v_min3_u32 v27,v27,v224,v228
v_max_u32 v96,1,v96
buffer_store_dwordx2 v[96:97],v18,s[20:23],s70 offen offset:0 sc1
buffer_load_dwordx4 v16,s[20:23],s65 offen offset:0 sc1 lds
v_mfma_f32_16x16x32_bf16 v[76:79],a[68:71],v[228:231],v[76:79]
ds_read_b128 v[224:227],v17 offset:50176
buffer_load_dwordx4 v16,s[20:23],s65 offen offset:2048 sc1 lds
s_xor_b32 m0,s72,16384
s_add_u32 s65,s88,32768
s_waitcnt lgkmcnt(5)
v_mfma_f32_16x16x32_bf16 v[68:71],a[72:75],v[232:235],v[68:71]
ds_read_b128 v[228:231],v17 offset:52224
v_min3_u32 v27,v27,v232,v236
buffer_load_dwordx4 v16,s[20:23],s65 offen offset:0 sc1 lds
buffer_load_dwordx4 v16,s[20:23],s65 offen offset:2048 sc1 lds
s_xor_b32 m0,s72,32768
v_mfma_f32_16x16x32_bf16 v[76:79],a[76:79],v[236:239],v[76:79]
ds_read_b128 v[232:235],v17 offset:54272
s_add_u32 s65,s88,65536
buffer_load_dwordx4 v16,s[20:23],s65 offen offset:0 sc1 lds
buffer_load_dwordx4 v16,s[20:23],s65 offen offset:2048 sc1 lds
s_waitcnt lgkmcnt(5)
v_mfma_f32_16x16x32_bf16 v[68:71],a[80:83],v[240:243],v[68:71]
ds_read_b128 v[236:239],v17 offset:56320
v_min3_u32 v27,v27,v240,v244
s_xor_b32 m0,s72,49152
s_add_u32 s65,s88,98304
buffer_load_dwordx4 v16,s[20:23],s65 offen offset:0 sc1 lds
v_mfma_f32_16x16x32_bf16 v[76:79],a[84:87],v[244:247],v[76:79]
ds_read_b128 v[240:243],v17 offset:58368
buffer_load_dwordx4 v16,s[20:23],s65 offen offset:2048 sc1 lds
s_xor_b32 m0,s72,1024
s_add_u32 s65,s89,0
s_waitcnt lgkmcnt(5)
v_mfma_f32_16x16x32_bf16 v[68:71],a[88:91],v[248:251],v[68:71]
ds_read_b128 v[244:247],v17 offset:60416
v_min3_u32 v27,v27,v248,v252
buffer_load_dwordx4 v16,s[20:23],s65 offen offset:0 sc1 lds
buffer_load_dwordx4 v16,s[20:23],s65 offen offset:2048 sc1 lds
v_mfma_f32_16x16x32_bf16 v[76:79],a[92:95],v[252:255],v[76:79]
ds_read_b128 v[248:251],v17 offset:62464
s_xor_b32 m0,s72,17408
s_add_u32 s65,s89,32768
buffer_load_dwordx4 v16,s[20:23],s65 offen offset:0 sc1 lds
s_waitcnt lgkmcnt(5)
v_mfma_f32_16x16x32_bf16 v[68:71],a[96:99],v[224:227],v[68:71]
ds_read_b128 v[252:255],v17 offset:64512
v_min3_u32 v27,v27,v224,v228
buffer_load_dwordx4 v16,s[20:23],s65 offen offset:2048 sc1 lds
s_xor_b32 m0,s72,33792
s_add_u32 s65,s89,65536
v_mfma_f32_16x16x32_bf16 v[76:79],a[100:103],v[228:231],v[76:79]
buffer_load_dwordx4 v16,s[20:23],s65 offen offset:0 sc1 lds
buffer_load_dwordx4 v16,s[20:23],s65 offen offset:2048 sc1 lds
s_xor_b32 m0,s72,50176
s_waitcnt lgkmcnt(4)
v_mfma_f32_16x16x32_bf16 v[68:71],a[104:107],v[232:235],v[68:71]
v_min3_u32 v27,v27,v232,v236
s_add_u32 s65,s89,98304
buffer_load_dwordx4 v16,s[20:23],s65 offen offset:0 sc1 lds
buffer_load_dwordx4 v16,s[20:23],s65 offen offset:2048 sc1 lds
v_mfma_f32_16x16x32_bf16 v[76:79],a[108:111],v[236:239],v[76:79]
s_waitcnt lgkmcnt(2)
v_mfma_f32_16x16x32_bf16 v[68:71],a[112:115],v[240:243],v[68:71]
v_min3_u32 v27,v27,v240,v244
v_mfma_f32_16x16x32_bf16 v[76:79],a[116:119],v[244:247],v[76:79]
s_waitcnt lgkmcnt(0)
v_mfma_f32_16x16x32_bf16 v[68:71],a[120:123],v[248:251],v[68:71]
v_min3_u32 v27,v27,v248,v252
v_mfma_f32_16x16x32_bf16 v[76:79],a[124:127],v[252:255],v[76:79]
v_cmp_eq_u32 vcc,0,v27
s_cbranch_vccnz retry_390
s_branch epi_393
ahead_392:
s_cmp_eq_u32 s93,0
s_cbranch_scc1 both_394
s_waitcnt vmcnt(11) lgkmcnt(0)
s_barrier
ds_read_b128 v[224:227],v17 offset:0
ds_read_b128 v[228:231],v17 offset:2048
ds_read_b128 v[232:235],v17 offset:4096
ds_read_b128 v[236:239],v17 offset:6144
ds_read_b128 v[240:243],v17 offset:8192
ds_read_b128 v[244:247],v17 offset:10240
ds_read_b128 v[248:251],v17 offset:12288
s_waitcnt lgkmcnt(5)
v_mfma_f32_16x16x32_bf16 v[64:67],a[0:3],v[224:227],0
ds_read_b128 v[252:255],v17 offset:14336
v_min_u32 v27,v224,v228
s_waitcnt vmcnt(12)
stk_407:
v_min3_u32 v22,v129,v133,v137
v_min3_u32 v22,v22,v141,v145
v_min3_u32 v22,v22,v149,v153
v_min_u32 v22,v22,v157
v_cmp_eq_u32 vcc,0,v22
s_cmp_lt_i32 s90,0
s_cselect_b64 vcc,0,vcc
s_cbranch_vccnz str_408
v_mfma_f32_16x16x32_bf16 v[72:75],a[4:7],v[228:231],0
ds_read_b128 v[224:227],v17 offset:16384
v_pk_add_f32 v[88:89],v[128:129],v[144:145]
v_pk_add_f32 v[90:91],v[130:131],v[146:147]
v_pk_add_f32 v[92:93],v[132:133],v[148:149]
v_pk_add_f32 v[94:95],v[134:135],v[150:151]
s_waitcnt lgkmcnt(5)
v_mfma_f32_16x16x32_bf16 v[64:67],a[8:11],v[232:235],v[64:67]
ds_read_b128 v[228:231],v17 offset:18432
v_min3_u32 v27,v27,v232,v236
v_pk_add_f32 v[96:97],v[136:137],v[152:153]
v_pk_add_f32 v[98:99],v[138:139],v[154:155]
v_pk_add_f32 v[100:101],v[140:141],v[156:157]
v_pk_add_f32 v[102:103],v[142:143],v[158:159]
v_mfma_f32_16x16x32_bf16 v[72:75],a[12:15],v[236:239],v[72:75]
ds_read_b128 v[232:235],v17 offset:20480
s_waitcnt lgkmcnt(5)
v_mfma_f32_16x16x32_bf16 v[64:67],a[16:19],v[240:243],v[64:67]
ds_read_b128 v[236:239],v17 offset:22528
v_min3_u32 v27,v27,v240,v244
v_pk_add_f32 v[88:89],v[88:89],v[96:97]
v_pk_add_f32 v[90:91],v[90:91],v[98:99]
v_pk_add_f32 v[92:93],v[92:93],v[100:101]
v_mfma_f32_16x16x32_bf16 v[72:75],a[20:23],v[244:247],v[72:75]
ds_read_b128 v[240:243],v17 offset:24576
v_pk_add_f32 v[94:95],v[94:95],v[102:103]
v_pk_add_f32 v[88:89],v[88:89],v[92:93]
v_pk_add_f32 v[90:91],v[90:91],v[94:95]
s_waitcnt lgkmcnt(5)
v_mfma_f32_16x16x32_bf16 v[64:67],a[24:27],v[248:251],v[64:67]
ds_read_b128 v[244:247],v17 offset:26624
v_min3_u32 v27,v27,v248,v252
v_mov_b32 v92,v88
v_mov_b32 v93,v89
v_mov_b32 v94,v90
v_mfma_f32_16x16x32_bf16 v[72:75],a[28:31],v[252:255],v[72:75]
ds_read_b128 v[248:251],v17 offset:28672
v_mov_b32 v95,v91
v_permlane16_swap_b32 v92,v88
v_permlane16_swap_b32 v93,v89
s_waitcnt lgkmcnt(5)
v_mfma_f32_16x16x32_bf16 v[64:67],a[32:35],v[224:227],v[64:67]
ds_read_b128 v[252:255],v17 offset:30720
v_min3_u32 v27,v27,v224,v228
v_permlane16_swap_b32 v94,v90
v_permlane16_swap_b32 v95,v91
v_mfma_f32_16x16x32_bf16 v[72:75],a[36:39],v[228:231],v[72:75]
ds_read_b128 v[224:227],v17 offset:32768
v_pk_add_f32 v[88:89],v[88:89],v[92:93]
v_pk_add_f32 v[90:91],v[90:91],v[94:95]
v_mov_b32 v92,v88
s_waitcnt lgkmcnt(5)
v_mfma_f32_16x16x32_bf16 v[64:67],a[40:43],v[232:235],v[64:67]
ds_read_b128 v[228:231],v17 offset:34816
v_min3_u32 v27,v27,v232,v236
v_mov_b32 v93,v89
v_mov_b32 v94,v90
v_mov_b32 v95,v91
v_mfma_f32_16x16x32_bf16 v[72:75],a[44:47],v[236:239],v[72:75]
ds_read_b128 v[232:235],v17 offset:36864
v_permlane32_swap_b32 v92,v88
v_permlane32_swap_b32 v93,v89
v_permlane32_swap_b32 v94,v90
s_waitcnt lgkmcnt(5)
v_mfma_f32_16x16x32_bf16 v[64:67],a[48:51],v[240:243],v[64:67]
ds_read_b128 v[236:239],v17 offset:38912
v_min3_u32 v27,v27,v240,v244
v_permlane32_swap_b32 v95,v91
v_pk_add_f32 v[88:89],v[88:89],v[92:93]
v_mfma_f32_16x16x32_bf16 v[72:75],a[52:55],v[244:247],v[72:75]
ds_read_b128 v[240:243],v17 offset:40960
v_pk_add_f32 v[90:91],v[90:91],v[94:95]
v_mul_f32 v120,0xba800000,v88
v_mul_f32 v124,0xba800000,v90
s_add_u32 s88,s70,s75
s_waitcnt lgkmcnt(5)
v_mfma_f32_16x16x32_bf16 v[64:67],a[56:59],v[248:251],v[64:67]
ds_read_b128 v[244:247],v17 offset:43008
v_min3_u32 v27,v27,v248,v252
v_mul_f32 v92,v120,v120
v_mul_f32 v93,v124,v124
v_fma_f32 v92,v89,s82,-v92
s_add_u32 s88,s88,2097152
v_mfma_f32_16x16x32_bf16 v[72:75],a[60:63],v[252:255],v[72:75]
ds_read_b128 v[248:251],v17 offset:45056
v_fma_f32 v93,v91,s82,-v93
v_max_f32 v92,0,v92
v_max_f32 v93,0,v93
s_xor_b32 s88,s88,0x2000
s_waitcnt lgkmcnt(5)
v_mfma_f32_16x16x32_bf16 v[64:67],a[64:67],v[224:227],v[64:67]
ds_read_b128 v[252:255],v17 offset:47104
v_min3_u32 v27,v27,v224,v228
v_add_f32 v92,0x3727c5ac,v92
v_add_f32 v93,0x3727c5ac,v93
v_rsq_f32 v94,v92
v_mfma_f32_16x16x32_bf16 v[72:75],a[68:71],v[228:231],v[72:75]
ds_read_b128 v[224:227],v17 offset:49152
v_rsq_f32 v95,v93
v_mul_f32 v123,v92,v94
s_xor_b32 s89,s88,1024
s_waitcnt lgkmcnt(5)
v_mfma_f32_16x16x32_bf16 v[64:67],a[72:75],v[232:235],v[64:67]
ds_read_b128 v[228:231],v17 offset:51200
v_min3_u32 v27,v27,v232,v236
v_mul_f32 v127,v93,v95
v_mul_f32 v122,v28,v94
v_mul_f32 v126,v28,v95
v_mfma_f32_16x16x32_bf16 v[72:75],a[76:79],v[236:239],v[72:75]
ds_read_b128 v[232:235],v17 offset:53248
v_mul_f32 v92,v94,v94
v_mul_f32 v93,v95,v95
v_mul_f32 v94,s81,v94
s_waitcnt lgkmcnt(5)
v_mfma_f32_16x16x32_bf16 v[64:67],a[80:83],v[240:243],v[64:67]
ds_read_b128 v[236:239],v17 offset:55296
v_min3_u32 v27,v27,v240,v244
v_mul_f32 v95,s81,v95
v_mul_f32 v121,v92,v94
v_mul_f32 v125,v93,v95
v_mfma_f32_16x16x32_bf16 v[72:75],a[84:87],v[244:247],v[72:75]
ds_read_b128 v[240:243],v17 offset:57344
ds_write_b128 v19,v[120:123] offset:0
ds_write_b128 v19,v[124:127] offset:256
s_waitcnt lgkmcnt(7)
v_mfma_f32_16x16x32_bf16 v[64:67],a[88:91],v[248:251],v[64:67]
ds_read_b128 v[244:247],v17 offset:59392
v_min3_u32 v27,v27,v248,v252
v_mfma_f32_16x16x32_bf16 v[72:75],a[92:95],v[252:255],v[72:75]
ds_read_b128 v[248:251],v17 offset:61440
s_waitcnt lgkmcnt(7)
v_mfma_f32_16x16x32_bf16 v[64:67],a[96:99],v[224:227],v[64:67]
ds_read_b128 v[252:255],v17 offset:63488
v_min3_u32 v27,v27,v224,v228
v_mfma_f32_16x16x32_bf16 v[72:75],a[100:103],v[228:231],v[72:75]
s_waitcnt vmcnt(3) lgkmcnt(0)
s_barrier
ds_read_b64 v[44:45],v47
ds_read_b128 v[224:227],v17 offset:1024
s_waitcnt vmcnt(0)
v_add_u32 v22,s71,-1
v_mfma_f32_16x16x32_bf16 v[64:67],a[104:107],v[232:235],v[64:67]
ds_read_b128 v[228:231],v17 offset:3072
v_min3_u32 v27,v27,v232,v236
buffer_store_dword v22,v23,s[20:23],s97 offen sc1
s_mov_b32 s97,0x7fff0000
v_mfma_f32_16x16x32_bf16 v[72:75],a[108:111],v[236:239],v[72:75]
ds_read_b128 v[232:235],v17 offset:5120
v_mfma_f32_16x16x32_bf16 v[64:67],a[112:115],v[240:243],v[64:67]
ds_read_b128 v[236:239],v17 offset:7168
v_min3_u32 v27,v27,v240,v244
v_mfma_f32_16x16x32_bf16 v[72:75],a[116:119],v[244:247],v[72:75]
ds_read_b128 v[240:243],v17 offset:9216
s_waitcnt lgkmcnt(5)
v_readfirstlane_b32 s93,v45
v_mfma_f32_16x16x32_bf16 v[64:67],a[120:123],v[248:251],v[64:67]
ds_read_b128 v[244:247],v17 offset:11264
v_readfirstlane_b32 s83,v44
s_cmp_lg_u32 s83,0
s_cbranch_scc1 keep_402
v_min3_u32 v27,v27,v248,v252
v_mfma_f32_16x16x32_bf16 v[72:75],a[124:127],v[252:255],v[72:75]
ds_read_b128 v[248:251],v17 offset:13312
s_add_u32 s66,s88,110592
buffer_load_dwordx4 v[128:131],v16,s[20:23],s66 offen offset:0 sc1
buffer_load_dwordx4 v[132:135],v16,s[20:23],s66 offen offset:1024 sc1
s_waitcnt lgkmcnt(5)
v_mfma_f32_16x16x32_bf16 v[68:71],a[0:3],v[224:227],0
ds_read_b128 v[252:255],v17 offset:15360
v_cmp_eq_u32 vcc,0,v27
s_cbranch_vccnz retry_390
v_min3_u32 v27,v27,v224,v228
buffer_load_dwordx4 v[136:139],v16,s[20:23],s66 offen offset:2048 sc1
v_mfma_f32_16x16x32_bf16 v[76:79],a[4:7],v[228:231],0
ds_read_b128 v[224:227],v17 offset:17408
buffer_load_dwordx4 v[140:143],v16,s[20:23],s66 offen offset:3072 sc1
s_add_u32 s66,s88,114688
buffer_load_dwordx4 v[144:147],v16,s[20:23],s66 offen offset:0 sc1
s_waitcnt lgkmcnt(5)
v_mfma_f32_16x16x32_bf16 v[68:71],a[8:11],v[232:235],v[68:71]
ds_read_b128 v[228:231],v17 offset:19456
v_min3_u32 v27,v27,v232,v236
buffer_load_dwordx4 v[148:151],v16,s[20:23],s66 offen offset:1024 sc1
buffer_load_dwordx4 v[152:155],v16,s[20:23],s66 offen offset:2048 sc1
v_mfma_f32_16x16x32_bf16 v[76:79],a[12:15],v[236:239],v[76:79]
ds_read_b128 v[232:235],v17 offset:21504
buffer_load_dwordx4 v[156:159],v16,s[20:23],s66 offen offset:3072 sc1
s_waitcnt lgkmcnt(5)
v_mfma_f32_16x16x32_bf16 v[68:71],a[16:19],v[240:243],v[68:71]
ds_read_b128 v[236:239],v17 offset:23552
v_min3_u32 v27,v27,v240,v244
v_add_f32 v64,v64,v72
v_add_f32 v65,v65,v73
v_add_f32 v66,v66,v74
v_add_f32 v67,v67,v75
s_xor_b32 m0,s72,0
v_mfma_f32_16x16x32_bf16 v[76:79],a[20:23],v[244:247],v[76:79]
ds_read_b128 v[240:243],v17 offset:25600
v_fmac_f32 v64,v52,v120
v_fmac_f32 v65,v53,v120
v_fmac_f32 v66,v54,v120
v_fmac_f32 v67,v55,v120
s_add_u32 s65,s88,0
s_waitcnt lgkmcnt(5)
v_mfma_f32_16x16x32_bf16 v[68:71],a[24:27],v[248:251],v[68:71]
ds_read_b128 v[244:247],v17 offset:27648
v_min3_u32 v27,v27,v248,v252
v_mul_f32 v88,v64,v64
v_mul_f32 v89,v65,v65
v_mul_f32 v90,v66,v66
v_mul_f32 v91,v67,v67
v_mfma_f32_16x16x32_bf16 v[76:79],a[28:31],v[252:255],v[76:79]
ds_read_b128 v[248:251],v17 offset:29696
v_fma_f32 v88,v88,v121,v122
v_fma_f32 v89,v89,v121,v122
v_fma_f32 v90,v90,v121,v122
v_fma_f32 v91,v91,v121,v122
s_waitcnt lgkmcnt(5)
v_mfma_f32_16x16x32_bf16 v[68:71],a[32:35],v[224:227],v[68:71]
ds_read_b128 v[252:255],v17 offset:31744
v_min3_u32 v27,v27,v224,v228
v_mul_f32 v88,v88,v64
v_mul_f32 v89,v89,v65
v_mul_f32 v90,v90,v66
v_mul_f32 v91,v91,v67
v_mfma_f32_16x16x32_bf16 v[76:79],a[36:39],v[228:231],v[76:79]
ds_read_b128 v[224:227],v17 offset:33792
v_exp_f32 v88,v88
v_exp_f32 v89,v89
s_waitcnt lgkmcnt(5)
v_mfma_f32_16x16x32_bf16 v[68:71],a[40:43],v[232:235],v[68:71]
ds_read_b128 v[228:231],v17 offset:35840
v_min3_u32 v27,v27,v232,v236
v_exp_f32 v90,v90
v_exp_f32 v91,v91
v_mfma_f32_16x16x32_bf16 v[76:79],a[44:47],v[236:239],v[76:79]
ds_read_b128 v[232:235],v17 offset:37888
v_fma_f32 v88,v88,v123,v123
v_fma_f32 v89,v89,v123,v123
v_fma_f32 v90,v90,v123,v123
v_fma_f32 v91,v91,v123,v123
s_waitcnt lgkmcnt(5)
v_mfma_f32_16x16x32_bf16 v[68:71],a[48:51],v[240:243],v[68:71]
ds_read_b128 v[236:239],v17 offset:39936
v_min3_u32 v27,v27,v240,v244
v_rcp_f32 v88,v88
v_rcp_f32 v89,v89
v_mfma_f32_16x16x32_bf16 v[76:79],a[52:55],v[244:247],v[76:79]
ds_read_b128 v[240:243],v17 offset:41984
v_rcp_f32 v90,v90
v_rcp_f32 v91,v91
s_waitcnt lgkmcnt(5)
v_mfma_f32_16x16x32_bf16 v[68:71],a[56:59],v[248:251],v[68:71]
ds_read_b128 v[244:247],v17 offset:44032
v_min3_u32 v27,v27,v248,v252
v_mul_f32 v88,v88,v64
v_mul_f32 v89,v89,v65
v_mul_f32 v90,v90,v66
v_mul_f32 v91,v91,v67
v_mfma_f32_16x16x32_bf16 v[76:79],a[60:63],v[252:255],v[76:79]
ds_read_b128 v[248:251],v17 offset:46080
v_cvt_pk_bf16_f32 v96,v88,v89
v_cvt_pk_bf16_f32 v97,v90,v91
v_max_u32 v96,1,v96
buffer_load_dwordx4 v16,s[20:23],s65 offen offset:0 sc1 lds
s_waitcnt lgkmcnt(5)
v_mfma_f32_16x16x32_bf16 v[68:71],a[64:67],v[224:227],v[68:71]
ds_read_b128 v[252:255],v17 offset:48128
v_min3_u32 v27,v27,v224,v228
buffer_store_dwordx2 v[96:97],v18,s[20:23],s70 offen offset:0 sc1
buffer_load_dwordx4 v16,s[20:23],s65 offen offset:2048 sc1 lds
v_mfma_f32_16x16x32_bf16 v[76:79],a[68:71],v[228:231],v[76:79]
ds_read_b128 v[224:227],v17 offset:50176
s_xor_b32 m0,s72,16384
s_add_u32 s65,s88,32768
buffer_load_dwordx4 v16,s[20:23],s65 offen offset:0 sc1 lds
s_waitcnt lgkmcnt(5)
v_mfma_f32_16x16x32_bf16 v[68:71],a[72:75],v[232:235],v[68:71]
ds_read_b128 v[228:231],v17 offset:52224
v_min3_u32 v27,v27,v232,v236
buffer_load_dwordx4 v16,s[20:23],s65 offen offset:2048 sc1 lds
s_xor_b32 m0,s72,32768
s_add_u32 s65,s88,65536
v_mfma_f32_16x16x32_bf16 v[76:79],a[76:79],v[236:239],v[76:79]
ds_read_b128 v[232:235],v17 offset:54272
buffer_load_dwordx4 v16,s[20:23],s65 offen offset:0 sc1 lds
buffer_load_dwordx4 v16,s[20:23],s65 offen offset:2048 sc1 lds
s_waitcnt lgkmcnt(5)
v_mfma_f32_16x16x32_bf16 v[68:71],a[80:83],v[240:243],v[68:71]
ds_read_b128 v[236:239],v17 offset:56320
v_min3_u32 v27,v27,v240,v244
s_xor_b32 m0,s72,49152
s_add_u32 s65,s88,98304
buffer_load_dwordx4 v16,s[20:23],s65 offen offset:0 sc1 lds
v_mfma_f32_16x16x32_bf16 v[76:79],a[84:87],v[244:247],v[76:79]
ds_read_b128 v[240:243],v17 offset:58368
buffer_load_dwordx4 v16,s[20:23],s65 offen offset:2048 sc1 lds
s_xor_b32 m0,s72,1024
s_add_u32 s65,s89,0
s_waitcnt lgkmcnt(5)
v_mfma_f32_16x16x32_bf16 v[68:71],a[88:91],v[248:251],v[68:71]
ds_read_b128 v[244:247],v17 offset:60416
v_min3_u32 v27,v27,v248,v252
buffer_load_dwordx4 v16,s[20:23],s65 offen offset:0 sc1 lds
buffer_load_dwordx4 v16,s[20:23],s65 offen offset:2048 sc1 lds
v_mfma_f32_16x16x32_bf16 v[76:79],a[92:95],v[252:255],v[76:79]
ds_read_b128 v[248:251],v17 offset:62464
s_xor_b32 m0,s72,17408
s_add_u32 s65,s89,32768
buffer_load_dwordx4 v16,s[20:23],s65 offen offset:0 sc1 lds
s_waitcnt lgkmcnt(5)
v_mfma_f32_16x16x32_bf16 v[68:71],a[96:99],v[224:227],v[68:71]
ds_read_b128 v[252:255],v17 offset:64512
v_min3_u32 v27,v27,v224,v228
buffer_load_dwordx4 v16,s[20:23],s65 offen offset:2048 sc1 lds
s_xor_b32 m0,s72,33792
s_add_u32 s65,s89,65536
v_mfma_f32_16x16x32_bf16 v[76:79],a[100:103],v[228:231],v[76:79]
buffer_load_dwordx4 v16,s[20:23],s65 offen offset:0 sc1 lds
buffer_load_dwordx4 v16,s[20:23],s65 offen offset:2048 sc1 lds
s_xor_b32 m0,s72,50176
s_waitcnt lgkmcnt(4)
v_mfma_f32_16x16x32_bf16 v[68:71],a[104:107],v[232:235],v[68:71]
v_min3_u32 v27,v27,v232,v236
s_add_u32 s65,s89,98304
buffer_load_dwordx4 v16,s[20:23],s65 offen offset:0 sc1 lds
buffer_load_dwordx4 v16,s[20:23],s65 offen offset:2048 sc1 lds
v_mfma_f32_16x16x32_bf16 v[76:79],a[108:111],v[236:239],v[76:79]
s_waitcnt lgkmcnt(2)
v_mfma_f32_16x16x32_bf16 v[68:71],a[112:115],v[240:243],v[68:71]
v_min3_u32 v27,v27,v240,v244
v_mfma_f32_16x16x32_bf16 v[76:79],a[116:119],v[244:247],v[76:79]
s_waitcnt lgkmcnt(0)
v_mfma_f32_16x16x32_bf16 v[68:71],a[120:123],v[248:251],v[68:71]
v_min3_u32 v27,v27,v248,v252
v_mfma_f32_16x16x32_bf16 v[76:79],a[124:127],v[252:255],v[76:79]
v_cmp_eq_u32 vcc,0,v27
s_cbranch_vccnz retry_390
s_branch epi_393
keep_402:
v_min3_u32 v27,v27,v248,v252
v_mfma_f32_16x16x32_bf16 v[72:75],a[124:127],v[252:255],v[72:75]
ds_read_b128 v[248:251],v17 offset:13312
s_waitcnt lgkmcnt(5)
v_mfma_f32_16x16x32_bf16 v[68:71],a[0:3],v[224:227],0
ds_read_b128 v[252:255],v17 offset:15360
v_cmp_eq_u32 vcc,0,v27
s_cbranch_vccnz retry_390
v_min3_u32 v27,v27,v224,v228
v_mfma_f32_16x16x32_bf16 v[76:79],a[4:7],v[228:231],0
ds_read_b128 v[224:227],v17 offset:17408
s_waitcnt lgkmcnt(5)
v_mfma_f32_16x16x32_bf16 v[68:71],a[8:11],v[232:235],v[68:71]
ds_read_b128 v[228:231],v17 offset:19456
v_min3_u32 v27,v27,v232,v236
v_mfma_f32_16x16x32_bf16 v[76:79],a[12:15],v[236:239],v[76:79]
ds_read_b128 v[232:235],v17 offset:21504
s_waitcnt lgkmcnt(5)
v_mfma_f32_16x16x32_bf16 v[68:71],a[16:19],v[240:243],v[68:71]
ds_read_b128 v[236:239],v17 offset:23552
v_min3_u32 v27,v27,v240,v244
v_add_f32 v64,v64,v72
v_add_f32 v65,v65,v73
v_add_f32 v66,v66,v74
v_add_f32 v67,v67,v75
v_mfma_f32_16x16x32_bf16 v[76:79],a[20:23],v[244:247],v[76:79]
ds_read_b128 v[240:243],v17 offset:25600
v_fmac_f32 v64,v52,v120
v_fmac_f32 v65,v53,v120
v_fmac_f32 v66,v54,v120
v_fmac_f32 v67,v55,v120
s_waitcnt lgkmcnt(5)
v_mfma_f32_16x16x32_bf16 v[68:71],a[24:27],v[248:251],v[68:71]
ds_read_b128 v[244:247],v17 offset:27648
v_min3_u32 v27,v27,v248,v252
v_mul_f32 v88,v64,v64
v_mul_f32 v89,v65,v65
v_mul_f32 v90,v66,v66
v_mul_f32 v91,v67,v67
v_mfma_f32_16x16x32_bf16 v[76:79],a[28:31],v[252:255],v[76:79]
ds_read_b128 v[248:251],v17 offset:29696
v_fma_f32 v88,v88,v121,v122
v_fma_f32 v89,v89,v121,v122
v_fma_f32 v90,v90,v121,v122
v_fma_f32 v91,v91,v121,v122
s_waitcnt lgkmcnt(5)
v_mfma_f32_16x16x32_bf16 v[68:71],a[32:35],v[224:227],v[68:71]
ds_read_b128 v[252:255],v17 offset:31744
v_min3_u32 v27,v27,v224,v228
v_mul_f32 v88,v88,v64
v_mul_f32 v89,v89,v65
v_mul_f32 v90,v90,v66
v_mul_f32 v91,v91,v67
v_mfma_f32_16x16x32_bf16 v[76:79],a[36:39],v[228:231],v[76:79]
ds_read_b128 v[224:227],v17 offset:33792
v_exp_f32 v88,v88
v_exp_f32 v89,v89
s_waitcnt lgkmcnt(5)
v_mfma_f32_16x16x32_bf16 v[68:71],a[40:43],v[232:235],v[68:71]
ds_read_b128 v[228:231],v17 offset:35840
v_min3_u32 v27,v27,v232,v236
v_exp_f32 v90,v90
v_exp_f32 v91,v91
v_mfma_f32_16x16x32_bf16 v[76:79],a[44:47],v[236:239],v[76:79]
ds_read_b128 v[232:235],v17 offset:37888
v_fma_f32 v88,v88,v123,v123
v_fma_f32 v89,v89,v123,v123
v_fma_f32 v90,v90,v123,v123
v_fma_f32 v91,v91,v123,v123
s_waitcnt lgkmcnt(5)
v_mfma_f32_16x16x32_bf16 v[68:71],a[48:51],v[240:243],v[68:71]
ds_read_b128 v[236:239],v17 offset:39936
v_min3_u32 v27,v27,v240,v244
v_rcp_f32 v88,v88
v_rcp_f32 v89,v89
v_mfma_f32_16x16x32_bf16 v[76:79],a[52:55],v[244:247],v[76:79]
ds_read_b128 v[240:243],v17 offset:41984
v_rcp_f32 v90,v90
v_rcp_f32 v91,v91
s_waitcnt lgkmcnt(5)
v_mfma_f32_16x16x32_bf16 v[68:71],a[56:59],v[248:251],v[68:71]
ds_read_b128 v[244:247],v17 offset:44032
v_min3_u32 v27,v27,v248,v252
v_mul_f32 v88,v88,v64
v_mul_f32 v89,v89,v65
v_mul_f32 v90,v90,v66
v_mul_f32 v91,v91,v67
v_mfma_f32_16x16x32_bf16 v[76:79],a[60:63],v[252:255],v[76:79]
ds_read_b128 v[248:251],v17 offset:46080
v_cvt_pk_bf16_f32 v96,v88,v89
v_cvt_pk_bf16_f32 v97,v90,v91
v_max_u32 v96,1,v96
s_waitcnt lgkmcnt(5)
v_mfma_f32_16x16x32_bf16 v[68:71],a[64:67],v[224:227],v[68:71]
ds_read_b128 v[252:255],v17 offset:48128
v_min3_u32 v27,v27,v224,v228
buffer_store_dwordx2 v[96:97],v18,s[20:23],s70 offen offset:0 sc1
v_mfma_f32_16x16x32_bf16 v[76:79],a[68:71],v[228:231],v[76:79]
ds_read_b128 v[224:227],v17 offset:50176
s_waitcnt lgkmcnt(5)
v_mfma_f32_16x16x32_bf16 v[68:71],a[72:75],v[232:235],v[68:71]
ds_read_b128 v[228:231],v17 offset:52224
v_min3_u32 v27,v27,v232,v236
v_mfma_f32_16x16x32_bf16 v[76:79],a[76:79],v[236:239],v[76:79]
ds_read_b128 v[232:235],v17 offset:54272
s_waitcnt lgkmcnt(5)
v_mfma_f32_16x16x32_bf16 v[68:71],a[80:83],v[240:243],v[68:71]
ds_read_b128 v[236:239],v17 offset:56320
v_min3_u32 v27,v27,v240,v244
v_mfma_f32_16x16x32_bf16 v[76:79],a[84:87],v[244:247],v[76:79]
ds_read_b128 v[240:243],v17 offset:58368
s_waitcnt lgkmcnt(5)
v_mfma_f32_16x16x32_bf16 v[68:71],a[88:91],v[248:251],v[68:71]
ds_read_b128 v[244:247],v17 offset:60416
v_min3_u32 v27,v27,v248,v252
v_mfma_f32_16x16x32_bf16 v[76:79],a[92:95],v[252:255],v[76:79]
ds_read_b128 v[248:251],v17 offset:62464
s_waitcnt lgkmcnt(5)
v_mfma_f32_16x16x32_bf16 v[68:71],a[96:99],v[224:227],v[68:71]
ds_read_b128 v[252:255],v17 offset:64512
v_min3_u32 v27,v27,v224,v228
v_mfma_f32_16x16x32_bf16 v[76:79],a[100:103],v[228:231],v[76:79]
s_waitcnt lgkmcnt(4)
v_mfma_f32_16x16x32_bf16 v[68:71],a[104:107],v[232:235],v[68:71]
v_min3_u32 v27,v27,v232,v236
v_mfma_f32_16x16x32_bf16 v[76:79],a[108:111],v[236:239],v[76:79]
s_waitcnt lgkmcnt(2)
v_mfma_f32_16x16x32_bf16 v[68:71],a[112:115],v[240:243],v[68:71]
v_min3_u32 v27,v27,v240,v244
v_mfma_f32_16x16x32_bf16 v[76:79],a[116:119],v[244:247],v[76:79]
s_waitcnt lgkmcnt(0)
v_mfma_f32_16x16x32_bf16 v[68:71],a[120:123],v[248:251],v[68:71]
v_min3_u32 v27,v27,v248,v252
v_mfma_f32_16x16x32_bf16 v[76:79],a[124:127],v[252:255],v[76:79]
v_cmp_eq_u32 vcc,0,v27
s_cbranch_vccnz retry_390
s_branch epi_393
both_394:
s_waitcnt vmcnt(11) lgkmcnt(0)
s_barrier
ds_read_b128 v[224:227],v17 offset:0
ds_read_b128 v[228:231],v17 offset:2048
ds_read_b128 v[232:235],v17 offset:4096
ds_read_b128 v[236:239],v17 offset:6144
ds_read_b128 v[240:243],v17 offset:8192
ds_read_b128 v[244:247],v17 offset:10240
ds_read_b128 v[248:251],v17 offset:12288
s_waitcnt lgkmcnt(5)
v_mfma_f32_16x16x32_bf16 v[64:67],a[0:3],v[224:227],0
ds_read_b128 v[252:255],v17 offset:14336
v_min_u32 v27,v224,v228
s_waitcnt vmcnt(12)
stk_409:
v_min3_u32 v22,v129,v133,v137
v_min3_u32 v22,v22,v141,v145
v_min3_u32 v22,v22,v149,v153
v_min_u32 v22,v22,v157
v_cmp_eq_u32 vcc,0,v22
s_cmp_lt_i32 s90,0
s_cselect_b64 vcc,0,vcc
s_cbranch_vccnz str_410
v_mfma_f32_16x16x32_bf16 v[72:75],a[4:7],v[228:231],0
ds_read_b128 v[224:227],v17 offset:16384
v_pk_add_f32 v[88:89],v[128:129],v[144:145]
v_pk_add_f32 v[90:91],v[130:131],v[146:147]
v_pk_add_f32 v[92:93],v[132:133],v[148:149]
v_pk_add_f32 v[94:95],v[134:135],v[150:151]
s_waitcnt lgkmcnt(5)
v_mfma_f32_16x16x32_bf16 v[64:67],a[8:11],v[232:235],v[64:67]
ds_read_b128 v[228:231],v17 offset:18432
v_min3_u32 v27,v27,v232,v236
v_pk_add_f32 v[96:97],v[136:137],v[152:153]
v_pk_add_f32 v[98:99],v[138:139],v[154:155]
v_pk_add_f32 v[100:101],v[140:141],v[156:157]
v_pk_add_f32 v[102:103],v[142:143],v[158:159]
v_mfma_f32_16x16x32_bf16 v[72:75],a[12:15],v[236:239],v[72:75]
ds_read_b128 v[232:235],v17 offset:20480
s_add_u32 s88,s70,s75
s_add_u32 s88,s88,2097152
s_xor_b32 s88,s88,0x2000
s_xor_b32 s89,s88,1024
s_waitcnt lgkmcnt(5)
v_mfma_f32_16x16x32_bf16 v[64:67],a[16:19],v[240:243],v[64:67]
ds_read_b128 v[236:239],v17 offset:22528
v_min3_u32 v27,v27,v240,v244
v_pk_add_f32 v[88:89],v[88:89],v[96:97]
v_pk_add_f32 v[90:91],v[90:91],v[98:99]
v_pk_add_f32 v[92:93],v[92:93],v[100:101]
v_mfma_f32_16x16x32_bf16 v[72:75],a[20:23],v[244:247],v[72:75]
ds_read_b128 v[240:243],v17 offset:24576
v_pk_add_f32 v[94:95],v[94:95],v[102:103]
v_pk_add_f32 v[88:89],v[88:89],v[92:93]
v_pk_add_f32 v[90:91],v[90:91],v[94:95]
s_waitcnt lgkmcnt(5)
v_mfma_f32_16x16x32_bf16 v[64:67],a[24:27],v[248:251],v[64:67]
ds_read_b128 v[244:247],v17 offset:26624
v_min3_u32 v27,v27,v248,v252
v_mov_b32 v92,v88
v_mov_b32 v93,v89
v_mov_b32 v94,v90
v_mfma_f32_16x16x32_bf16 v[72:75],a[28:31],v[252:255],v[72:75]
ds_read_b128 v[248:251],v17 offset:28672
v_mov_b32 v95,v91
v_permlane16_swap_b32 v92,v88
v_permlane16_swap_b32 v93,v89
s_waitcnt lgkmcnt(5)
v_mfma_f32_16x16x32_bf16 v[64:67],a[32:35],v[224:227],v[64:67]
ds_read_b128 v[252:255],v17 offset:30720
v_min3_u32 v27,v27,v224,v228
v_permlane16_swap_b32 v94,v90
v_permlane16_swap_b32 v95,v91
s_add_u32 s66,s88,110592
buffer_load_dwordx4 v[128:131],v16,s[20:23],s66 offen offset:0 sc1
v_mfma_f32_16x16x32_bf16 v[72:75],a[36:39],v[228:231],v[72:75]
ds_read_b128 v[224:227],v17 offset:32768
v_pk_add_f32 v[88:89],v[88:89],v[92:93]
v_pk_add_f32 v[90:91],v[90:91],v[94:95]
v_mov_b32 v92,v88
buffer_load_dwordx4 v[132:135],v16,s[20:23],s66 offen offset:1024 sc1
s_waitcnt lgkmcnt(5)
v_mfma_f32_16x16x32_bf16 v[64:67],a[40:43],v[232:235],v[64:67]
ds_read_b128 v[228:231],v17 offset:34816
v_min3_u32 v27,v27,v232,v236
v_mov_b32 v93,v89
v_mov_b32 v94,v90
v_mov_b32 v95,v91
buffer_load_dwordx4 v[136:139],v16,s[20:23],s66 offen offset:2048 sc1
v_mfma_f32_16x16x32_bf16 v[72:75],a[44:47],v[236:239],v[72:75]
ds_read_b128 v[232:235],v17 offset:36864
v_permlane32_swap_b32 v92,v88
v_permlane32_swap_b32 v93,v89
v_permlane32_swap_b32 v94,v90
buffer_load_dwordx4 v[140:143],v16,s[20:23],s66 offen offset:3072 sc1
s_waitcnt lgkmcnt(5)
v_mfma_f32_16x16x32_bf16 v[64:67],a[48:51],v[240:243],v[64:67]
ds_read_b128 v[236:239],v17 offset:38912
v_min3_u32 v27,v27,v240,v244
v_permlane32_swap_b32 v95,v91
v_pk_add_f32 v[88:89],v[88:89],v[92:93]
s_add_u32 s66,s88,114688
buffer_load_dwordx4 v[144:147],v16,s[20:23],s66 offen offset:0 sc1
v_mfma_f32_16x16x32_bf16 v[72:75],a[52:55],v[244:247],v[72:75]
ds_read_b128 v[240:243],v17 offset:40960
v_pk_add_f32 v[90:91],v[90:91],v[94:95]
v_mul_f32 v120,0xba800000,v88
v_mul_f32 v124,0xba800000,v90
buffer_load_dwordx4 v[148:151],v16,s[20:23],s66 offen offset:1024 sc1
s_waitcnt lgkmcnt(5)
v_mfma_f32_16x16x32_bf16 v[64:67],a[56:59],v[248:251],v[64:67]
ds_read_b128 v[244:247],v17 offset:43008
v_min3_u32 v27,v27,v248,v252
v_mul_f32 v92,v120,v120
v_mul_f32 v93,v124,v124
v_fma_f32 v92,v89,s82,-v92
buffer_load_dwordx4 v[152:155],v16,s[20:23],s66 offen offset:2048 sc1
v_mfma_f32_16x16x32_bf16 v[72:75],a[60:63],v[252:255],v[72:75]
ds_read_b128 v[248:251],v17 offset:45056
v_fma_f32 v93,v91,s82,-v93
v_max_f32 v92,0,v92
v_max_f32 v93,0,v93
buffer_load_dwordx4 v[156:159],v16,s[20:23],s66 offen offset:3072 sc1
s_waitcnt lgkmcnt(5)
v_mfma_f32_16x16x32_bf16 v[64:67],a[64:67],v[224:227],v[64:67]
ds_read_b128 v[252:255],v17 offset:47104
v_min3_u32 v27,v27,v224,v228
v_add_f32 v92,0x3727c5ac,v92
v_add_f32 v93,0x3727c5ac,v93
v_rsq_f32 v94,v92
s_xor_b32 m0,s72,0
v_mfma_f32_16x16x32_bf16 v[72:75],a[68:71],v[228:231],v[72:75]
ds_read_b128 v[224:227],v17 offset:49152
v_rsq_f32 v95,v93
v_mul_f32 v123,v92,v94
s_add_u32 s65,s88,0
s_waitcnt lgkmcnt(5)
v_mfma_f32_16x16x32_bf16 v[64:67],a[72:75],v[232:235],v[64:67]
ds_read_b128 v[228:231],v17 offset:51200
v_min3_u32 v27,v27,v232,v236
v_mul_f32 v127,v93,v95
v_mul_f32 v122,v28,v94
v_mul_f32 v126,v28,v95
buffer_load_dwordx4 v16,s[20:23],s65 offen offset:0 sc1 lds
v_mfma_f32_16x16x32_bf16 v[72:75],a[76:79],v[236:239],v[72:75]
ds_read_b128 v[232:235],v17 offset:53248
v_mul_f32 v92,v94,v94
v_mul_f32 v93,v95,v95
v_mul_f32 v94,s81,v94
buffer_load_dwordx4 v16,s[20:23],s65 offen offset:2048 sc1 lds
s_waitcnt lgkmcnt(5)
v_mfma_f32_16x16x32_bf16 v[64:67],a[80:83],v[240:243],v[64:67]
ds_read_b128 v[236:239],v17 offset:55296
v_min3_u32 v27,v27,v240,v244
v_mul_f32 v95,s81,v95
v_mul_f32 v121,v92,v94
v_mul_f32 v125,v93,v95
s_xor_b32 m0,s72,16384
v_mfma_f32_16x16x32_bf16 v[72:75],a[84:87],v[244:247],v[72:75]
ds_read_b128 v[240:243],v17 offset:57344
ds_write_b128 v19,v[120:123] offset:0
ds_write_b128 v19,v[124:127] offset:256
s_add_u32 s65,s88,32768
s_waitcnt lgkmcnt(7)
v_mfma_f32_16x16x32_bf16 v[64:67],a[88:91],v[248:251],v[64:67]
ds_read_b128 v[244:247],v17 offset:59392
v_min3_u32 v27,v27,v248,v252
buffer_load_dwordx4 v16,s[20:23],s65 offen offset:0 sc1 lds
buffer_load_dwordx4 v16,s[20:23],s65 offen offset:2048 sc1 lds
v_mfma_f32_16x16x32_bf16 v[72:75],a[92:95],v[252:255],v[72:75]
ds_read_b128 v[248:251],v17 offset:61440
s_xor_b32 m0,s72,32768
s_add_u32 s65,s88,65536
buffer_load_dwordx4 v16,s[20:23],s65 offen offset:0 sc1 lds
s_waitcnt lgkmcnt(7)
v_mfma_f32_16x16x32_bf16 v[64:67],a[96:99],v[224:227],v[64:67]
ds_read_b128 v[252:255],v17 offset:63488
v_min3_u32 v27,v27,v224,v228
buffer_load_dwordx4 v16,s[20:23],s65 offen offset:2048 sc1 lds
s_xor_b32 m0,s72,49152
s_add_u32 s65,s88,98304
v_mfma_f32_16x16x32_bf16 v[72:75],a[100:103],v[228:231],v[72:75]
s_waitcnt vmcnt(17) lgkmcnt(0)
s_barrier
ds_read_b64 v[44:45],v47
ds_read_b128 v[224:227],v17 offset:1024
s_waitcnt vmcnt(14)
v_add_u32 v22,s71,-1
v_mfma_f32_16x16x32_bf16 v[64:67],a[104:107],v[232:235],v[64:67]
ds_read_b128 v[228:231],v17 offset:3072
v_min3_u32 v27,v27,v232,v236
buffer_store_dword v22,v23,s[20:23],s97 offen sc1
s_mov_b32 s97,0x7fff0000
v_mfma_f32_16x16x32_bf16 v[72:75],a[108:111],v[236:239],v[72:75]
ds_read_b128 v[232:235],v17 offset:5120
buffer_load_dwordx4 v16,s[20:23],s65 offen offset:0 sc1 lds
buffer_load_dwordx4 v16,s[20:23],s65 offen offset:2048 sc1 lds
v_mfma_f32_16x16x32_bf16 v[64:67],a[112:115],v[240:243],v[64:67]
ds_read_b128 v[236:239],v17 offset:7168
v_min3_u32 v27,v27,v240,v244
s_xor_b32 m0,s72,1024
s_add_u32 s65,s89,0
buffer_load_dwordx4 v16,s[20:23],s65 offen offset:0 sc1 lds
v_mfma_f32_16x16x32_bf16 v[72:75],a[116:119],v[244:247],v[72:75]
ds_read_b128 v[240:243],v17 offset:9216
s_waitcnt lgkmcnt(5)
v_readfirstlane_b32 s93,v45
buffer_load_dwordx4 v16,s[20:23],s65 offen offset:2048 sc1 lds
v_mfma_f32_16x16x32_bf16 v[64:67],a[120:123],v[248:251],v[64:67]
ds_read_b128 v[244:247],v17 offset:11264
v_min3_u32 v27,v27,v248,v252
s_xor_b32 m0,s72,17408
s_add_u32 s65,s89,32768
buffer_load_dwordx4 v16,s[20:23],s65 offen offset:0 sc1 lds
v_mfma_f32_16x16x32_bf16 v[72:75],a[124:127],v[252:255],v[72:75]
ds_read_b128 v[248:251],v17 offset:13312
buffer_load_dwordx4 v16,s[20:23],s65 offen offset:2048 sc1 lds
s_xor_b32 m0,s72,33792
s_add_u32 s65,s89,65536
s_waitcnt lgkmcnt(5)
v_mfma_f32_16x16x32_bf16 v[68:71],a[0:3],v[224:227],0
ds_read_b128 v[252:255],v17 offset:15360
v_cmp_eq_u32 vcc,0,v27
s_cbranch_vccnz retry_390
v_min3_u32 v27,v27,v224,v228
buffer_load_dwordx4 v16,s[20:23],s65 offen offset:0 sc1 lds
v_mfma_f32_16x16x32_bf16 v[76:79],a[4:7],v[228:231],0
ds_read_b128 v[224:227],v17 offset:17408
buffer_load_dwordx4 v16,s[20:23],s65 offen offset:2048 sc1 lds
s_xor_b32 m0,s72,50176
s_add_u32 s65,s89,98304
s_waitcnt lgkmcnt(5)
v_mfma_f32_16x16x32_bf16 v[68:71],a[8:11],v[232:235],v[68:71]
ds_read_b128 v[228:231],v17 offset:19456
v_min3_u32 v27,v27,v232,v236
buffer_load_dwordx4 v16,s[20:23],s65 offen offset:0 sc1 lds
buffer_load_dwordx4 v16,s[20:23],s65 offen offset:2048 sc1 lds
v_mfma_f32_16x16x32_bf16 v[76:79],a[12:15],v[236:239],v[76:79]
ds_read_b128 v[232:235],v17 offset:21504
s_waitcnt lgkmcnt(5)
v_mfma_f32_16x16x32_bf16 v[68:71],a[16:19],v[240:243],v[68:71]
ds_read_b128 v[236:239],v17 offset:23552
v_min3_u32 v27,v27,v240,v244
v_add_f32 v64,v64,v72
v_add_f32 v65,v65,v73
v_add_f32 v66,v66,v74
v_add_f32 v67,v67,v75
v_mfma_f32_16x16x32_bf16 v[76:79],a[20:23],v[244:247],v[76:79]
ds_read_b128 v[240:243],v17 offset:25600
v_fmac_f32 v64,v52,v120
v_fmac_f32 v65,v53,v120
v_fmac_f32 v66,v54,v120
v_fmac_f32 v67,v55,v120
s_waitcnt lgkmcnt(5)
v_mfma_f32_16x16x32_bf16 v[68:71],a[24:27],v[248:251],v[68:71]
ds_read_b128 v[244:247],v17 offset:27648
v_min3_u32 v27,v27,v248,v252
v_mul_f32 v88,v64,v64
v_mul_f32 v89,v65,v65
v_mul_f32 v90,v66,v66
v_mul_f32 v91,v67,v67
v_mfma_f32_16x16x32_bf16 v[76:79],a[28:31],v[252:255],v[76:79]
ds_read_b128 v[248:251],v17 offset:29696
v_fma_f32 v88,v88,v121,v122
v_fma_f32 v89,v89,v121,v122
v_fma_f32 v90,v90,v121,v122
v_fma_f32 v91,v91,v121,v122
s_waitcnt lgkmcnt(5)
v_mfma_f32_16x16x32_bf16 v[68:71],a[32:35],v[224:227],v[68:71]
ds_read_b128 v[252:255],v17 offset:31744
v_min3_u32 v27,v27,v224,v228
v_mul_f32 v88,v88,v64
v_mul_f32 v89,v89,v65
v_mul_f32 v90,v90,v66
v_mul_f32 v91,v91,v67
v_mfma_f32_16x16x32_bf16 v[76:79],a[36:39],v[228:231],v[76:79]
ds_read_b128 v[224:227],v17 offset:33792
v_exp_f32 v88,v88
v_exp_f32 v89,v89
s_waitcnt lgkmcnt(5)
v_mfma_f32_16x16x32_bf16 v[68:71],a[40:43],v[232:235],v[68:71]
ds_read_b128 v[228:231],v17 offset:35840
v_min3_u32 v27,v27,v232,v236
v_exp_f32 v90,v90
v_exp_f32 v91,v91
v_mfma_f32_16x16x32_bf16 v[76:79],a[44:47],v[236:239],v[76:79]
ds_read_b128 v[232:235],v17 offset:37888
v_fma_f32 v88,v88,v123,v123
v_fma_f32 v89,v89,v123,v123
v_fma_f32 v90,v90,v123,v123
v_fma_f32 v91,v91,v123,v123
s_waitcnt lgkmcnt(5)
v_mfma_f32_16x16x32_bf16 v[68:71],a[48:51],v[240:243],v[68:71]
ds_read_b128 v[236:239],v17 offset:39936
v_min3_u32 v27,v27,v240,v244
v_rcp_f32 v88,v88
v_rcp_f32 v89,v89
v_mfma_f32_16x16x32_bf16 v[76:79],a[52:55],v[244:247],v[76:79]
ds_read_b128 v[240:243],v17 offset:41984
v_rcp_f32 v90,v90
v_rcp_f32 v91,v91
s_waitcnt lgkmcnt(5)
v_mfma_f32_16x16x32_bf16 v[68:71],a[56:59],v[248:251],v[68:71]
ds_read_b128 v[244:247],v17 offset:44032
v_min3_u32 v27,v27,v248,v252
v_mul_f32 v88,v88,v64
v_mul_f32 v89,v89,v65
v_mul_f32 v90,v90,v66
v_mul_f32 v91,v91,v67
v_mfma_f32_16x16x32_bf16 v[76:79],a[60:63],v[252:255],v[76:79]
ds_read_b128 v[248:251],v17 offset:46080
v_cvt_pk_bf16_f32 v96,v88,v89
v_cvt_pk_bf16_f32 v97,v90,v91
v_max_u32 v96,1,v96
s_waitcnt lgkmcnt(5)
v_mfma_f32_16x16x32_bf16 v[68:71],a[64:67],v[224:227],v[68:71]
ds_read_b128 v[252:255],v17 offset:48128
v_min3_u32 v27,v27,v224,v228
buffer_store_dwordx2 v[96:97],v18,s[20:23],s70 offen offset:0 sc1
v_mfma_f32_16x16x32_bf16 v[76:79],a[68:71],v[228:231],v[76:79]
ds_read_b128 v[224:227],v17 offset:50176
s_waitcnt lgkmcnt(5)
v_mfma_f32_16x16x32_bf16 v[68:71],a[72:75],v[232:235],v[68:71]
ds_read_b128 v[228:231],v17 offset:52224
v_min3_u32 v27,v27,v232,v236
v_mfma_f32_16x16x32_bf16 v[76:79],a[76:79],v[236:239],v[76:79]
ds_read_b128 v[232:235],v17 offset:54272
s_waitcnt lgkmcnt(5)
v_mfma_f32_16x16x32_bf16 v[68:71],a[80:83],v[240:243],v[68:71]
ds_read_b128 v[236:239],v17 offset:56320
v_min3_u32 v27,v27,v240,v244
v_mfma_f32_16x16x32_bf16 v[76:79],a[84:87],v[244:247],v[76:79]
ds_read_b128 v[240:243],v17 offset:58368
s_waitcnt lgkmcnt(5)
v_mfma_f32_16x16x32_bf16 v[68:71],a[88:91],v[248:251],v[68:71]
ds_read_b128 v[244:247],v17 offset:60416
v_min3_u32 v27,v27,v248,v252
v_mfma_f32_16x16x32_bf16 v[76:79],a[92:95],v[252:255],v[76:79]
ds_read_b128 v[248:251],v17 offset:62464
s_waitcnt lgkmcnt(5)
v_mfma_f32_16x16x32_bf16 v[68:71],a[96:99],v[224:227],v[68:71]
ds_read_b128 v[252:255],v17 offset:64512
v_min3_u32 v27,v27,v224,v228
v_mfma_f32_16x16x32_bf16 v[76:79],a[100:103],v[228:231],v[76:79]
s_waitcnt lgkmcnt(4)
v_mfma_f32_16x16x32_bf16 v[68:71],a[104:107],v[232:235],v[68:71]
v_min3_u32 v27,v27,v232,v236
v_mfma_f32_16x16x32_bf16 v[76:79],a[108:111],v[236:239],v[76:79]
s_waitcnt lgkmcnt(2)
v_mfma_f32_16x16x32_bf16 v[68:71],a[112:115],v[240:243],v[68:71]
v_min3_u32 v27,v27,v240,v244
v_mfma_f32_16x16x32_bf16 v[76:79],a[116:119],v[244:247],v[76:79]
s_waitcnt lgkmcnt(0)
v_mfma_f32_16x16x32_bf16 v[68:71],a[120:123],v[248:251],v[68:71]
v_min3_u32 v27,v27,v248,v252
v_mfma_f32_16x16x32_bf16 v[76:79],a[124:127],v[252:255],v[76:79]
v_cmp_eq_u32 vcc,0,v27
s_cbranch_vccnz retry_390
epi_393:
buffer_load_dword v29,v21,s[20:23],s87 offen sc1
s_nop 4
v_pk_add_f32 v[68:69],v[68:69],v[76:77]
v_pk_add_f32 v[70:71],v[70:71],v[78:79]
v_pk_fma_f32 v[68:69],v[52:53],v[124:125],v[68:69] op_sel_hi:[1,0,1]
v_pk_fma_f32 v[70:71],v[54:55],v[124:125],v[70:71] op_sel_hi:[1,0,1]
v_pk_mul_f32 v[88:89],v[68:69],v[68:69]
v_pk_mul_f32 v[90:91],v[70:71],v[70:71]
v_pk_fma_f32 v[88:89],v[88:89],v[124:125],v[126:127] op_sel:[0,1,0] op_sel_hi:[1,1,0]
v_pk_fma_f32 v[90:91],v[90:91],v[124:125],v[126:127] op_sel:[0,1,0] op_sel_hi:[1,1,0]
v_pk_mul_f32 v[88:89],v[88:89],v[68:69]
v_pk_mul_f32 v[90:91],v[90:91],v[70:71]
v_exp_f32 v88,v88
v_exp_f32 v89,v89
v_exp_f32 v90,v90
s_cmp_gt_u32 s71,51
s_cselect_b32 s65,s73,0x7fff0000
s_cselect_b32 s97,0x7fff0000,s73
v_mov_b32 v22,s71
buffer_store_dword v22,v23,s[20:23],s65 offen sc1
v_exp_f32 v91,v91
v_pk_fma_f32 v[88:89],v[88:89],v[126:127],v[126:127] op_sel:[0,1,1] op_sel_hi:[1,1,1]
v_pk_fma_f32 v[90:91],v[90:91],v[126:127],v[126:127] op_sel:[0,1,1] op_sel_hi:[1,1,1]
v_rcp_f32 v88,v88
v_rcp_f32 v89,v89
v_rcp_f32 v90,v90
v_rcp_f32 v91,v91
v_pk_mul_f32 v[88:89],v[88:89],v[68:69]
v_pk_mul_f32 v[90:91],v[90:91],v[70:71]
v_cvt_pk_bf16_f32 v96,v88,v89
v_cvt_pk_bf16_f32 v97,v90,v91
v_max_u32 v96,1,v96
buffer_store_dwordx2 v[96:97],v18,s[20:23],s70 offen offset:1024 sc1
next_400:
v_xor_b32 v17,0x10000,v17
s_xor_b32 s72,s72,0x10000
s_add_u32 s70,s70,2097152
s_xor_b32 s70,s70,0x2000
s_add_u32 s71,s71,1
s_cmp_le_u32 s71,s57
s_cbranch_scc1 seg_391
s_endpgm
retry_390:
s_sub_u32 s90,s90,64
s_cmp_lt_i32 s90,0
s_cbranch_scc1 giveup_197
s_mov_b32 s83,1
s_waitcnt vmcnt(0) lgkmcnt(0)
s_barrier
s_branch seg_391
half_399:
s_mov_b64 exec,s[52:53]
s_xor_b32 m0,s91,0
s_add_u32 s65,s94,0
buffer_load_dwordx4 v16,s[20:23],s65 offen offset:0 sc1 lds
buffer_load_dwordx4 v16,s[20:23],s65 offen offset:2048 sc1 lds
s_xor_b32 m0,s91,16384
s_add_u32 s65,s94,32768
buffer_load_dwordx4 v16,s[20:23],s65 offen offset:0 sc1 lds
buffer_load_dwordx4 v16,s[20:23],s65 offen offset:2048 sc1 lds
s_xor_b32 m0,s91,32768
s_add_u32 s65,s94,65536
buffer_load_dwordx4 v16,s[20:23],s65 offen offset:0 sc1 lds
buffer_load_dwordx4 v16,s[20:23],s65 offen offset:2048 sc1 lds
s_xor_b32 m0,s91,49152
s_add_u32 s65,s94,98304
buffer_load_dwordx4 v16,s[20:23],s65 offen offset:0 sc1 lds
buffer_load_dwordx4 v16,s[20:23],s65 offen offset:2048 sc1 lds
s_add_u32 s66,s94,110592
buffer_load_dwordx4 v[128:131],v16,s[20:23],s66 offen offset:0 sc1
buffer_load_dwordx4 v[132:135],v16,s[20:23],s66 offen offset:1024 sc1
buffer_load_dwordx4 v[136:139],v16,s[20:23],s66 offen offset:2048 sc1
buffer_load_dwordx4 v[140:143],v16,s[20:23],s66 offen offset:3072 sc1
s_add_u32 s66,s94,114688
buffer_load_dwordx4 v[144:147],v16,s[20:23],s66 offen offset:0 sc1
buffer_load_dwordx4 v[148:151],v16,s[20:23],s66 offen offset:1024 sc1
buffer_load_dwordx4 v[152:155],v16,s[20:23],s66 offen offset:2048 sc1
buffer_load_dwordx4 v[156:159],v16,s[20:23],s66 offen offset:3072 sc1
s_mov_b64 exec,-1
s_waitcnt vmcnt(16)
v_add_u32 v22,s71,-1
buffer_store_dword v22,v23,s[20:23],s97 offen sc1
s_mov_b32 s97,0x7fff0000
half2_396:
s_waitcnt vmcnt(15)
s_barrier
ds_read_b128 v[224:227],v17 offset:0
ds_read_b128 v[228:231],v17 offset:2048
ds_read_b128 v[232:235],v17 offset:4096
ds_read_b128 v[236:239],v17 offset:6144
ds_read_b128 v[240:243],v17 offset:8192
ds_read_b128 v[244:247],v17 offset:10240
ds_read_b128 v[248:251],v17 offset:12288
s_waitcnt lgkmcnt(5)
v_mfma_f32_16x16x32_bf16 v[64:67],a[0:3],v[224:227],0
ds_read_b128 v[252:255],v17 offset:14336
v_min_u32 v27,v224,v228
v_mfma_f32_16x16x32_bf16 v[72:75],a[4:7],v[228:231],0
s_waitcnt vmcnt(13)
s_barrier
ds_read_b128 v[224:227],v17 offset:16384
s_waitcnt lgkmcnt(5)
v_mfma_f32_16x16x32_bf16 v[64:67],a[8:11],v[232:235],v[64:67]
ds_read_b128 v[228:231],v17 offset:18432
v_min3_u32 v27,v27,v232,v236
v_mfma_f32_16x16x32_bf16 v[72:75],a[12:15],v[236:239],v[72:75]
ds_read_b128 v[232:235],v17 offset:20480
s_waitcnt lgkmcnt(5)
v_mfma_f32_16x16x32_bf16 v[64:67],a[16:19],v[240:243],v[64:67]
ds_read_b128 v[236:239],v17 offset:22528
v_min3_u32 v27,v27,v240,v244
v_mfma_f32_16x16x32_bf16 v[72:75],a[20:23],v[244:247],v[72:75]
ds_read_b128 v[240:243],v17 offset:24576
s_waitcnt lgkmcnt(5)
v_mfma_f32_16x16x32_bf16 v[64:67],a[24:27],v[248:251],v[64:67]
ds_read_b128 v[244:247],v17 offset:26624
v_min3_u32 v27,v27,v248,v252
v_mfma_f32_16x16x32_bf16 v[72:75],a[28:31],v[252:255],v[72:75]
ds_read_b128 v[248:251],v17 offset:28672
s_waitcnt lgkmcnt(5)
v_mfma_f32_16x16x32_bf16 v[64:67],a[32:35],v[224:227],v[64:67]
ds_read_b128 v[252:255],v17 offset:30720
v_min3_u32 v27,v27,v224,v228
v_mfma_f32_16x16x32_bf16 v[72:75],a[36:39],v[228:231],v[72:75]
s_waitcnt vmcnt(9)
s_barrier
ds_read_b128 v[224:227],v17 offset:32768
s_waitcnt lgkmcnt(5)
v_mfma_f32_16x16x32_bf16 v[64:67],a[40:43],v[232:235],v[64:67]
ds_read_b128 v[228:231],v17 offset:34816
v_min3_u32 v27,v27,v232,v236
v_mfma_f32_16x16x32_bf16 v[72:75],a[44:47],v[236:239],v[72:75]
ds_read_b128 v[232:235],v17 offset:36864
s_waitcnt lgkmcnt(5)
v_mfma_f32_16x16x32_bf16 v[64:67],a[48:51],v[240:243],v[64:67]
ds_read_b128 v[236:239],v17 offset:38912
v_min3_u32 v27,v27,v240,v244
s_waitcnt vmcnt(1)
stk_411:
v_min3_u32 v22,v129,v133,v137
v_min3_u32 v22,v22,v141,v145
v_min3_u32 v22,v22,v149,v153
v_min_u32 v22,v22,v157
v_cmp_eq_u32 vcc,0,v22
s_and_b64 vcc,vcc,s[52:53]
s_cmp_lt_i32 s90,0
s_cselect_b64 vcc,0,vcc
s_cbranch_vccnz str_412
v_mfma_f32_16x16x32_bf16 v[72:75],a[52:55],v[244:247],v[72:75]
ds_read_b128 v[240:243],v17 offset:40960
v_pk_add_f32 v[88:89],v[128:129],v[144:145]
v_pk_add_f32 v[90:91],v[130:131],v[146:147]
v_pk_add_f32 v[92:93],v[132:133],v[148:149]
v_pk_add_f32 v[94:95],v[134:135],v[150:151]
v_pk_add_f32 v[96:97],v[136:137],v[152:153]
v_pk_add_f32 v[98:99],v[138:139],v[154:155]
v_pk_add_f32 v[100:101],v[140:141],v[156:157]
v_pk_add_f32 v[102:103],v[142:143],v[158:159]
v_pk_add_f32 v[88:89],v[88:89],v[96:97]
v_pk_add_f32 v[90:91],v[90:91],v[98:99]
s_waitcnt lgkmcnt(5)
v_mfma_f32_16x16x32_bf16 v[64:67],a[56:59],v[248:251],v[64:67]
ds_read_b128 v[244:247],v17 offset:43008
v_min3_u32 v27,v27,v248,v252
v_pk_add_f32 v[92:93],v[92:93],v[100:101]
v_pk_add_f32 v[94:95],v[94:95],v[102:103]
v_pk_add_f32 v[88:89],v[88:89],v[92:93]
v_pk_add_f32 v[90:91],v[90:91],v[94:95]
v_mov_b32 v92,v88
v_mov_b32 v93,v89
v_mov_b32 v94,v90
v_mov_b32 v95,v91
v_permlane16_swap_b32 v92,v88
v_mfma_f32_16x16x32_bf16 v[72:75],a[60:63],v[252:255],v[72:75]
ds_read_b128 v[248:251],v17 offset:45056
v_permlane16_swap_b32 v93,v89
v_permlane16_swap_b32 v94,v90
v_permlane16_swap_b32 v95,v91
v_pk_add_f32 v[88:89],v[88:89],v[92:93]
v_pk_add_f32 v[90:91],v[90:91],v[94:95]
v_mov_b32 v92,v88
v_mov_b32 v93,v89
s_waitcnt lgkmcnt(5)
v_mfma_f32_16x16x32_bf16 v[64:67],a[64:67],v[224:227],v[64:67]
ds_read_b128 v[252:255],v17 offset:47104
v_min3_u32 v27,v27,v224,v228
v_mov_b32 v94,v90
v_mov_b32 v95,v91
v_permlane32_swap_b32 v92,v88
v_permlane32_swap_b32 v93,v89
v_permlane32_swap_b32 v94,v90
v_permlane32_swap_b32 v95,v91
v_mfma_f32_16x16x32_bf16 v[72:75],a[68:71],v[228:231],v[72:75]
ds_read_b128 v[224:227],v17 offset:49152
v_pk_add_f32 v[88:89],v[88:89],v[92:93]
v_pk_add_f32 v[90:91],v[90:91],v[94:95]
v_mul_f32 v120,0xba800000,v88
v_mul_f32 v124,0xba800000,v90
s_waitcnt lgkmcnt(5)
v_mfma_f32_16x16x32_bf16 v[64:67],a[72:75],v[232:235],v[64:67]
ds_read_b128 v[228:231],v17 offset:51200
v_min3_u32 v27,v27,v232,v236
v_mul_f32 v92,v120,v120
v_mul_f32 v93,v124,v124
v_fma_f32 v92,v89,s82,-v92
v_fma_f32 v93,v91,s82,-v93
v_mfma_f32_16x16x32_bf16 v[72:75],a[76:79],v[236:239],v[72:75]
ds_read_b128 v[232:235],v17 offset:53248
v_max_f32 v92,0,v92
v_max_f32 v93,0,v93
v_add_f32 v92,0x3727c5ac,v92
v_add_f32 v93,0x3727c5ac,v93
s_waitcnt lgkmcnt(5)
v_mfma_f32_16x16x32_bf16 v[64:67],a[80:83],v[240:243],v[64:67]
ds_read_b128 v[236:239],v17 offset:55296
v_min3_u32 v27,v27,v240,v244
v_rsq_f32 v94,v92
v_rsq_f32 v95,v93
v_mfma_f32_16x16x32_bf16 v[72:75],a[84:87],v[244:247],v[72:75]
ds_read_b128 v[240:243],v17 offset:57344
v_mul_f32 v123,v92,v94
v_mul_f32 v127,v93,v95
v_mul_f32 v122,v28,v94
v_mul_f32 v126,v28,v95
s_waitcnt lgkmcnt(5)
v_mfma_f32_16x16x32_bf16 v[64:67],a[88:91],v[248:251],v[64:67]
ds_read_b128 v[244:247],v17 offset:59392
v_min3_u32 v27,v27,v248,v252
v_mul_f32 v92,v94,v94
v_mul_f32 v93,v95,v95
v_mul_f32 v94,s81,v94
v_mul_f32 v95,s81,v95
v_mfma_f32_16x16x32_bf16 v[72:75],a[92:95],v[252:255],v[72:75]
ds_read_b128 v[248:251],v17 offset:61440
v_mul_f32 v121,v92,v94
v_mul_f32 v125,v93,v95
ds_write_b128 v19,v[120:123] offset:0
ds_write_b128 v19,v[124:127] offset:256
s_waitcnt lgkmcnt(7)
v_mfma_f32_16x16x32_bf16 v[64:67],a[96:99],v[224:227],v[64:67]
s_waitcnt lgkmcnt(0)
s_barrier
ds_read_b128 v[252:255],v17 offset:63488
v_min3_u32 v27,v27,v224,v228
v_mfma_f32_16x16x32_bf16 v[72:75],a[100:103],v[228:231],v[72:75]
v_mfma_f32_16x16x32_bf16 v[64:67],a[104:107],v[232:235],v[64:67]
v_min3_u32 v27,v27,v232,v236
v_mfma_f32_16x16x32_bf16 v[72:75],a[108:111],v[236:239],v[72:75]
v_mfma_f32_16x16x32_bf16 v[64:67],a[112:115],v[240:243],v[64:67]
v_min3_u32 v27,v27,v240,v244
v_mfma_f32_16x16x32_bf16 v[72:75],a[116:119],v[244:247],v[72:75]
s_waitcnt lgkmcnt(0)
v_mfma_f32_16x16x32_bf16 v[64:67],a[120:123],v[248:251],v[64:67]
v_min3_u32 v27,v27,v248,v252
v_mfma_f32_16x16x32_bf16 v[72:75],a[124:127],v[252:255],v[72:75]
v_cmp_eq_u32 vcc,0,v27
s_and_b64 vcc,vcc,s[52:53]
s_cbranch_vccnz retry_390
s_waitcnt lgkmcnt(0)
s_nop 3
v_pk_add_f32 v[64:65],v[64:65],v[72:73]
v_pk_add_f32 v[66:67],v[66:67],v[74:75]
v_pk_fma_f32 v[64:65],v[52:53],v[120:121],v[64:65] op_sel_hi:[1,0,1]
v_pk_fma_f32 v[66:67],v[54:55],v[120:121],v[66:67] op_sel_hi:[1,0,1]
v_pk_mul_f32 v[88:89],v[64:65],v[64:65]
v_pk_mul_f32 v[90:91],v[66:67],v[66:67]
buffer_load_dword v29,v21,s[20:23],s87 offen sc1
v_mov_b32 v22,s71
buffer_store_dword v22,v23,s[20:23],s73 offen sc1
v_pk_fma_f32 v[88:89],v[88:89],v[120:121],v[122:123] op_sel:[0,1,0] op_sel_hi:[1,1,0]
v_pk_fma_f32 v[90:91],v[90:91],v[120:121],v[122:123] op_sel:[0,1,0] op_sel_hi:[1,1,0]
v_pk_mul_f32 v[88:89],v[88:89],v[64:65]
v_pk_mul_f32 v[90:91],v[90:91],v[66:67]
v_exp_f32 v88,v88
v_exp_f32 v89,v89
v_exp_f32 v90,v90
v_exp_f32 v91,v91
v_pk_fma_f32 v[88:89],v[88:89],v[122:123],v[122:123] op_sel:[0,1,1] op_sel_hi:[1,1,1]
v_pk_fma_f32 v[90:91],v[90:91],v[122:123],v[122:123] op_sel:[0,1,1] op_sel_hi:[1,1,1]
v_rcp_f32 v88,v88
v_rcp_f32 v89,v89
v_rcp_f32 v90,v90
v_rcp_f32 v91,v91
v_pk_mul_f32 v[88:89],v[88:89],v[64:65]
v_pk_mul_f32 v[90:91],v[90:91],v[66:67]
v_cvt_pk_bf16_f32 v96,v88,v89
v_cvt_pk_bf16_f32 v97,v90,v91
v_max_u32 v96,1,v96
buffer_store_dwordx2 v[96:97],v18,s[20:23],s70 offen offset:0 sc1
s_branch next_400
str_406:
s_add_u32 s94,s70,s75
s_add_u32 s66,s94,110592
buffer_load_dwordx4 v[128:131],v16,s[20:23],s66 offen offset:0 sc1
buffer_load_dwordx4 v[132:135],v16,s[20:23],s66 offen offset:1024 sc1
buffer_load_dwordx4 v[136:139],v16,s[20:23],s66 offen offset:2048 sc1
buffer_load_dwordx4 v[140:143],v16,s[20:23],s66 offen offset:3072 sc1
s_add_u32 s66,s94,114688
buffer_load_dwordx4 v[144:147],v16,s[20:23],s66 offen offset:0 sc1
buffer_load_dwordx4 v[148:151],v16,s[20:23],s66 offen offset:1024 sc1
buffer_load_dwordx4 v[152:155],v16,s[20:23],s66 offen offset:2048 sc1
buffer_load_dwordx4 v[156:159],v16,s[20:23],s66 offen offset:3072 sc1
s_sub_u32 s90,s90,1
s_waitcnt vmcnt(0)
s_branch stk_405
str_408:
s_add_u32 s94,s70,s75
s_add_u32 s66,s94,110592
buffer_load_dwordx4 v[128:131],v16,s[20:23],s66 offen offset:0 sc1
buffer_load_dwordx4 v[132:135],v16,s[20:23],s66 offen offset:1024 sc1
buffer_load_dwordx4 v[136:139],v16,s[20:23],s66 offen offset:2048 sc1
buffer_load_dwordx4 v[140:143],v16,s[20:23],s66 offen offset:3072 sc1
s_add_u32 s66,s94,114688
buffer_load_dwordx4 v[144:147],v16,s[20:23],s66 offen offset:0 sc1
buffer_load_dwordx4 v[148:151],v16,s[20:23],s66 offen offset:1024 sc1
buffer_load_dwordx4 v[152:155],v16,s[20:23],s66 offen offset:2048 sc1
buffer_load_dwordx4 v[156:159],v16,s[20:23],s66 offen offset:3072 sc1
s_sub_u32 s90,s90,1
s_waitcnt vmcnt(0)
s_branch stk_407
str_410:
s_add_u32 s94,s70,s75
s_add_u32 s66,s94,110592
buffer_load_dwordx4 v[128:131],v16,s[20:23],s66 offen offset:0 sc1
buffer_load_dwordx4 v[132:135],v16,s[20:23],s66 offen offset:1024 sc1
buffer_load_dwordx4 v[136:139],v16,s[20:23],s66 offen offset:2048 sc1
buffer_load_dwordx4 v[140:143],v16,s[20:23],s66 offen offset:3072 sc1
s_add_u32 s66,s94,114688
buffer_load_dwordx4 v[144:147],v16,s[20:23],s66 offen offset:0 sc1
buffer_load_dwordx4 v[148:151],v16,s[20:23],s66 offen offset:1024 sc1
buffer_load_dwordx4 v[152:155],v16,s[20:23],s66 offen offset:2048 sc1
buffer_load_dwordx4 v[156:159],v16,s[20:23],s66 offen offset:3072 sc1
s_sub_u32 s90,s90,1
s_waitcnt vmcnt(0)
s_branch stk_409
str_412:
s_add_u32 s94,s70,s75
s_add_u32 s66,s94,110592
buffer_load_dwordx4 v[128:131],v16,s[20:23],s66 offen offset:0 sc1
buffer_load_dwordx4 v[132:135],v16,s[20:23],s66 offen offset:1024 sc1
buffer_load_dwordx4 v[136:139],v16,s[20:23],s66 offen offset:2048 sc1
buffer_load_dwordx4 v[140:143],v16,s[20:23],s66 offen offset:3072 sc1
s_add_u32 s66,s94,114688
buffer_load_dwordx4 v[144:147],v16,s[20:23],s66 offen offset:0 sc1
buffer_load_dwordx4 v[148:151],v16,s[20:23],s66 offen offset:1024 sc1
buffer_load_dwordx4 v[152:155],v16,s[20:23],s66 offen offset:2048 sc1
buffer_load_dwordx4 v[156:159],v16,s[20:23],s66 offen offset:3072 sc1
s_sub_u32 s90,s90,1
s_waitcnt vmcnt(0)
s_branch stk_411
giveup_197:
s_endpgm
code_end:
.section .rodata,"a"
.p2align 6
.amdhsa_kernel mega_kernel
  .amdhsa_next_free_vgpr 512
  .amdhsa_next_free_sgpr 102
  .amdhsa_accum_offset 256
  .amdhsa_group_segment_fixed_size 0
  .amdhsa_kernarg_size 136
  .amdhsa_user_sgpr_count 2
  .amdhsa_user_sgpr_kernarg_segment_ptr 1
  .amdhsa_system_sgpr_workgroup_id_x 1
.end_amdhsa_kernel
```

```asm
; @launch kernel=mega_kernel grid=(256,1,1) block=(256,1,1) lds=163840
.amdgcn_target "amdgcn-amd-amdhsa--gfx950"
.text
.globl mega_kernel
.p2align 8
.type mega_kernel,@function
mega_kernel:
s_cmp_ge_u32 s2,256
s_cbranch_scc1 done_1
s_load_dwordx4 s[16:19],s[0:1],120
s_load_dword s3,s[0:1],0
s_getpc_b64 s[4:5]
pc_2:
s_sub_u32 s8,s4,pc_2-mega_kernel
s_subb_u32 s9,s5,0
s_and_b32 s9,s9,0xffff
s_mov_b32 s10,code_end-mega_kernel
s_mov_b32 s11,0x20000
v_lshlrev_b32 v180,7,v0
v_cmp_gt_u32 vcc,64,v0
s_cbranch_vccnz nocpf_3
buffer_load_dword v181,v180,s[8:11],0 offen
s_mov_b32 s12,0x8000
buffer_load_dword v182,v180,s[8:11],s12 offen
s_lshr_b32 s12,s2,3
s_and_b32 s12,s12,7
s_add_u32 s12,s12,2
s_lshl_b32 s12,s12,15
buffer_load_dword v183,v180,s[8:11],s12 offen
nocpf_3:
v_and_b32 v1,63,v0
v_lshrrev_b32 v2,6,v0
s_getreg_b32 s51,hwreg(HW_REG_XCC_ID)
v_readfirstlane_b32 s50,v2
s_and_b32 s51,s51,7
s_waitcnt lgkmcnt(0)
s_mov_b32 s20,s18
s_and_b32 s21,s19,0xffff
s_mov_b32 s22,0x10000000
s_mov_b32 s23,0x20000
s_mov_b32 s44,s16
s_and_b32 s45,s17,0xffff
s_mov_b32 s46,0x100
s_mov_b32 s47,0x20000
s_mov_b32 s90,400000
s_mov_b32 s91,s50
v_mov_b32 v187,158976
s_cmp_lg_u32 s50,0
s_cbranch_scc1 norole_4
s_mov_b64 exec,1
v_mov_b32 v184,1
v_mov_b32 v185,0
s_and_b32 s52,s51,3
s_lshl_b32 s52,s52,2
s_lshr_b32 s53,s51,2
s_lshl_b32 s53,s53,7
s_add_u32 s52,s52,s53
buffer_atomic_add v184,v185,s[44:47],s52 offen sc0 sc1
s_mov_b64 exec,-1
buffer_load_dword v181,v180,s[8:11],0 offen
s_mov_b32 s12,0x8000
buffer_load_dword v182,v180,s[8:11],s12 offen
s_lshr_b32 s12,s2,3
s_and_b32 s12,s12,7
s_add_u32 s12,s12,2
s_lshl_b32 s12,s12,15
buffer_load_dword v183,v180,s[8:11],s12 offen
s_mov_b64 exec,1
s_waitcnt vmcnt(3)
ds_write_b32 v187,v184
s_waitcnt lgkmcnt(0)
s_mov_b64 exec,-1
norole_4:
s_barrier
ds_read_b32 v186,v187
s_waitcnt lgkmcnt(0)
v_readfirstlane_b32 s54,v186
s_mov_b32 s56,2
s_lshl_b32 s57,s51,5
s_add_u32 s57,s57,s54
s_cmp_lt_u32 s54,32
s_cselect_b32 s57,s57,999
s_cmp_ge_u32 s57,256
s_cbranch_scc1 verify_6
s_cmp_ge_u32 s57,128
s_cbranch_scc1 pre_8
setup_5:
s_load_dwordx8 s[4:11],s[0:1],8
s_load_dwordx2 s[12:13],s[0:1],40
v_and_b32 v3,15,v1
v_lshrrev_b32 v4,4,v1
v_lshlrev_b32 v16,4,v1
v_lshrrev_b32 v30,2,v1
v_and_b32 v31,3,v1
v_lshlrev_b32 v7,13,v30
v_lshl_add_u32 v7,v31,4,v7
v_lshlrev_b32 v8,11,v30
v_lshl_add_u32 v8,v31,4,v8
s_lshr_b32 s58,s57,5
s_and_b32 s59,s57,31
s_xor_b32 s60,s57,0
s_lshl_b32 s60,s60,6
s_lshl_b32 s61,s50,14
s_lshl_b32 s62,s50,21
s_add_u32 s62,s62,s60
s_lshl_b32 s63,s58,21
s_lshl_b32 s64,s50,19
s_add_u32 s63,s63,s64
s_xor_b32 s64,s59,0
s_lshl_b32 s64,s64,6
s_add_u32 s63,s63,s64
s_waitcnt lgkmcnt(0)
s_mov_b32 s28,s8
s_and_b32 s29,s9,0xffff
s_mov_b32 s30,0x800000
s_mov_b32 s31,0x20000
s_mov_b32 s32,s10
s_and_b32 s33,s11,0xffff
s_mov_b32 s34,0x800000
s_mov_b32 s35,0x20000
s_mov_b32 s36,s6
s_and_b32 s37,s7,0xffff
s_mov_b32 s38,0x800000
s_mov_b32 s39,0x20000
s_mov_b32 s40,s12
s_and_b32 s41,s13,0xffff
s_mov_b32 s42,0x800000
s_mov_b32 s43,0x20000
s_mov_b32 s8,s4
s_and_b32 s9,s5,0xffff
s_mov_b32 s10,0x4000
s_mov_b32 s11,0x20000
v_lshlrev_b32 v9,7,v3
v_lshl_add_u32 v10,v4,11,v9
v_lshl_add_u32 v9,v4,13,v9
s_lshl_b32 s64,s59,2
s_add_u32 s64,s64,s50
s_lshl_b32 s65,s64,16
s_lshl_b32 s66,s58,11
s_add_u32 s65,s65,s66
s_lshl_b32 s66,s64,14
s_lshl_b32 s67,s58,21
s_add_u32 s66,s66,s67
v_and_b32 v9,7,v1
v_lshrrev_b32 v10,3,v1
s_cmp_eq_u32 s58,3
s_cselect_b32 s64,15,3
v_mov_b32 v11,3
v_cmp_eq_u32 vcc,1,v10
s_nop 1
v_cndmask_b32 v11,v11,11,vcc
v_lshlrev_b32 v12,7,v11
v_lshl_add_u32 v12,v9,11,v12
v_mov_b32 v13,s64
v_cmp_eq_u32 vcc,2,v10
s_nop 1
v_cndmask_b32 v11,v11,v13,vcc
v_lshlrev_b32 v11,7,v11
v_lshl_add_u32 v11,v9,13,v11
v_mov_b32 v100,0
v_mov_b32 v101,0
v_mov_b32 v102,0
v_mov_b32 v103,0
s_mov_b32 s53,s65
s_mov_b32 s55,s66
v_and_b32 v22,7,v3
v_lshlrev_b32 v31,11,v22
v_lshl_add_u32 v31,v4,4,v31
s_lshr_b32 s64,s59,3
s_lshl_b32 s64,s64,14
s_and_b32 s65,s59,7
s_lshl_b32 s65,s65,10
s_add_u32 s64,s64,s65
s_lshl_b32 s65,s58,16
s_add_u32 s64,s64,s65
s_add_u32 s64,s64,31195136
s_lshr_b32 s65,s57,3
s_add_u32 s65,s65,96
s_lshl_b32 s65,s65,14
s_and_b32 s66,s57,7
s_lshl_b32 s66,s66,10
s_add_u32 s65,s65,s66
s_add_u32 s65,s65,29360128
v_add_u32 v206,s64,v16
v_add_u32 v207,s65,v16
s_and_b32 s64,s50,1
s_lshl_b32 s64,s64,21
s_lshr_b32 s65,s50,1
s_lshl_b32 s65,s65,13
s_add_u32 s64,s64,s65
buffer_store_dwordx4 v[100:103],v206,s[20:23],s64 offen sc1
buffer_store_dwordx4 v[100:103],v207,s[20:23],s64 offen sc1
s_lshl_b32 s64,s50,20
s_add_u32 s64,s64,23068672
s_cmp_lt_u32 s50,2
s_cselect_b32 s67,s64,0x7fff0000
s_lshl_b32 s65,s57,10
s_add_u32 s65,s65,131072
s_add_u32 s65,s65,s67
buffer_store_dwordx4 v[100:103],v16,s[20:23],s65 offen sc1
s_lshl_b32 s65,s57,9
s_add_u32 s65,s65,s67
s_add_u32 s66,s65,65536
s_mov_b32 exec_hi,0
buffer_store_dwordx4 v[100:103],v16,s[20:23],s65 offen sc1
buffer_store_dwordx4 v[100:103],v16,s[20:23],s66 offen sc1
s_lshl_b32 s65,s57,2
s_add_u32 s65,s65,s64
s_add_u32 s65,s65,524288
s_lshl_b32 s52,s57,7
s_add_u32 s52,s52,21168128
s_mov_b64 exec,1
buffer_store_dword v100,v100,s[20:23],s65 offen sc1
buffer_store_dword v100,v100,s[20:23],s65 offen offset:512 sc1
s_mov_b64 exec,15
buffer_store_dwordx4 v[100:103],v16,s[20:23],s52 offen sc1
s_mov_b64 exec,-1
s_mov_b32 s65,s53
s_mov_b32 s66,s55
v_mov_b32 v37,159008
ds_write_b128 v37,v[100:103]
s_add_u32 s64,s62,0
s_add_u32 m0,s61,0
s_nop 0
buffer_load_dwordx4 v7,s[28:31],s64 offen nt lds
s_add_u32 s64,s62,131072
s_add_u32 m0,s61,1024
s_nop 0
buffer_load_dwordx4 v7,s[28:31],s64 offen nt lds
s_add_u32 s64,s62,262144
s_add_u32 m0,s61,2048
s_nop 0
buffer_load_dwordx4 v7,s[28:31],s64 offen nt lds
s_add_u32 s64,s62,393216
s_add_u32 m0,s61,3072
s_nop 0
buffer_load_dwordx4 v7,s[28:31],s64 offen nt lds
s_add_u32 s64,s62,524288
s_add_u32 m0,s61,4096
s_nop 0
buffer_load_dwordx4 v7,s[28:31],s64 offen nt lds
s_add_u32 s64,s62,655360
s_add_u32 m0,s61,5120
s_nop 0
buffer_load_dwordx4 v7,s[28:31],s64 offen nt lds
s_add_u32 s64,s62,786432
s_add_u32 m0,s61,6144
s_nop 0
buffer_load_dwordx4 v7,s[28:31],s64 offen nt lds
s_add_u32 s64,s62,917504
s_add_u32 m0,s61,7168
s_nop 0
buffer_load_dwordx4 v7,s[28:31],s64 offen nt lds
s_waitcnt vmcnt(8) lgkmcnt(0)
s_barrier
s_cmp_lg_u32 s50,1
s_cbranch_scc1 ws_11
s_and_b32 s64,s56,1
s_lshl_b32 s64,s64,2
s_add_u32 s64,s64,36
s_mov_b64 exec,1
v_mov_b32 v184,1
v_mov_b32 v185,0
buffer_atomic_add v184,v185,s[44:47],s64 offen sc1
s_mov_b64 exec,-1
ws_11:
s_add_u32 s64,s62,1048576
s_add_u32 m0,s61,8192
s_nop 0
buffer_load_dwordx4 v7,s[28:31],s64 offen nt lds
s_add_u32 s64,s62,1179648
s_add_u32 m0,s61,9216
s_nop 0
buffer_load_dwordx4 v7,s[28:31],s64 offen nt lds
s_add_u32 s64,s62,1310720
s_add_u32 m0,s61,10240
s_nop 0
buffer_load_dwordx4 v7,s[28:31],s64 offen nt lds
s_add_u32 s64,s62,1441792
s_add_u32 m0,s61,11264
s_nop 0
buffer_load_dwordx4 v7,s[28:31],s64 offen nt lds
s_add_u32 s64,s62,1572864
s_add_u32 m0,s61,12288
s_nop 0
buffer_load_dwordx4 v7,s[28:31],s64 offen nt lds
s_add_u32 s64,s62,1703936
s_add_u32 m0,s61,13312
s_nop 0
buffer_load_dwordx4 v7,s[28:31],s64 offen nt lds
s_add_u32 s64,s62,1835008
s_add_u32 m0,s61,14336
s_nop 0
buffer_load_dwordx4 v7,s[28:31],s64 offen nt lds
s_add_u32 s64,s62,1966080
s_add_u32 m0,s61,15360
s_nop 0
buffer_load_dwordx4 v7,s[28:31],s64 offen nt lds
s_mov_b64 exec,0xffffff
buffer_load_dword v201,v11,s[32:35],s65 offen
buffer_load_dword v202,v11,s[36:39],s65 offen
s_mov_b64 exec,0xffff
buffer_load_dword v203,v12,s[40:43],s66 offen
s_mov_b64 exec,-1
s_add_u32 s64,s62,0
s_add_u32 m0,s61,65536
s_nop 0
buffer_load_dwordx4 v7,s[32:35],s64 offen nt lds
s_add_u32 s64,s62,131072
s_add_u32 m0,s61,66560
s_nop 0
buffer_load_dwordx4 v7,s[32:35],s64 offen nt lds
s_add_u32 s64,s62,262144
s_add_u32 m0,s61,67584
s_nop 0
buffer_load_dwordx4 v7,s[32:35],s64 offen nt lds
s_add_u32 s64,s62,393216
s_add_u32 m0,s61,68608
s_nop 0
buffer_load_dwordx4 v7,s[32:35],s64 offen nt lds
s_add_u32 s64,s62,524288
s_add_u32 m0,s61,69632
s_nop 0
buffer_load_dwordx4 v7,s[32:35],s64 offen nt lds
s_add_u32 s64,s62,655360
s_add_u32 m0,s61,70656
s_nop 0
buffer_load_dwordx4 v7,s[32:35],s64 offen nt lds
s_add_u32 s64,s62,786432
s_add_u32 m0,s61,71680
s_nop 0
buffer_load_dwordx4 v7,s[32:35],s64 offen nt lds
s_add_u32 s64,s62,917504
s_add_u32 m0,s61,72704
s_nop 0
buffer_load_dwordx4 v7,s[32:35],s64 offen nt lds
s_add_u32 s64,s62,1048576
s_add_u32 m0,s61,73728
s_nop 0
buffer_load_dwordx4 v7,s[32:35],s64 offen nt lds
s_add_u32 s64,s62,1179648
s_add_u32 m0,s61,74752
s_nop 0
buffer_load_dwordx4 v7,s[32:35],s64 offen nt lds
s_add_u32 s64,s62,1310720
s_add_u32 m0,s61,75776
s_nop 0
buffer_load_dwordx4 v7,s[32:35],s64 offen nt lds
s_add_u32 s64,s62,1441792
s_add_u32 m0,s61,76800
s_nop 0
buffer_load_dwordx4 v7,s[32:35],s64 offen nt lds
s_add_u32 s64,s62,1572864
s_add_u32 m0,s61,77824
s_nop 0
buffer_load_dwordx4 v7,s[32:35],s64 offen nt lds
s_add_u32 s64,s62,1703936
s_add_u32 m0,s61,78848
s_nop 0
buffer_load_dwordx4 v7,s[32:35],s64 offen nt lds
s_add_u32 s64,s62,1835008
s_add_u32 m0,s61,79872
s_nop 0
buffer_load_dwordx4 v7,s[32:35],s64 offen nt lds
s_add_u32 s64,s62,1966080
s_add_u32 m0,s61,80896
s_nop 0
buffer_load_dwordx4 v7,s[32:35],s64 offen nt lds
s_lshl_b32 s64,s59,6
buffer_load_dwordx4 v[216:219],v31,s[8:11],s64 offen
v_lshrrev_b32 v184,3,v3
v_bfe_u32 v185,v3,2,1
v_lshrrev_b32 v186,1,v4
v_and_b32 v187,1,v4
v_lshl_add_u32 v188,v184,3,v185
v_lshl_add_u32 v188,v186,4,v188
v_lshl_add_u32 v188,v187,2,v188
v_lshl_add_u32 v189,v184,2,v185
v_lshl_add_u32 v189,v186,3,v189
v_lshl_add_u32 v189,v187,4,v189
v_and_b32 v187,3,v3
v_lshlrev_b32 v187,3,v187
v_lshl_add_u32 v188,v188,6,v187
v_lshl_add_u32 v189,v189,6,v187
s_lshr_b32 s64,s50,1
s_lshl_b32 s64,s64,5
v_add_u32 v190,s64,v188
v_add_u32 v191,0x10000,v190
s_lshl_b32 s64,s64,10
v_add_u32 v192,s64,v189
s_add_u32 s64,s61,0x10000
v_add_u32 v193,s64,v16
s_add_u32 s68,s50,1
s_mov_b32 s69,0
s_waitcnt vmcnt(20)
s_barrier
s_lshl_b32 s64,s57,9
v_mov_b32 v194,s64
s_add_u32 s65,s64,65024
v_mov_b32 v195,s65
v_cmp_lt_u32 vcc,3,v1
s_nop 1
v_cndmask_b32 v194,v194,v195,vcc
s_lshl_b32 s65,s57,10
s_add_u32 s65,s65,130048
v_mov_b32 v195,s65
v_cmp_lt_u32 vcc,7,v1
s_nop 1
v_cndmask_b32 v194,v194,v195,vcc
s_lshl_b32 s65,s57,11
s_add_u32 s65,s65,260096
v_mov_b32 v195,s65
v_cmp_lt_u32 vcc,15,v1
s_nop 1
v_cndmask_b32 v194,v194,v195,vcc
v_lshl_add_u32 v194,v1,7,v194
s_lshl_b32 s65,s58,7
s_add_u32 s65,s65,524288
v_writelane_b32 v194,s65,32
s_add_u32 s65,s65,512
v_writelane_b32 v194,s65,33
s_lshl_b32 s64,s50,20
s_add_u32 s64,s64,23068672
s_mov_b32 exec_hi,3
buffer_load_dword v183,v194,s[20:23],s64 offen sc1
s_mov_b64 exec,-1
s_and_b32 s65,s50,1
s_lshl_b32 s14,s65,19
s_add_u32 s14,s14,s60
s_lshl_b32 s15,s65,19
s_sub_u32 s15,s63,s15
s_lshl_b32 s65,s65,13
s_add_u32 s65,s65,131072
v_mov_b32 v32,v8
v_add_u32 v33,s65,v16
v_add_u32 v34,s65,v189
v_mov_b32 v35,v7
v_add_u32 v36,131072,v190
v_mov_b32 v37,159008
s_bitcmp1_b32 s68,1
s_cbranch_scc0 ws_12
ds_read_b64_tr_b16 a[0:1],v190 offset:0
ds_read_b64_tr_b16 a[2:3],v190 offset:128
ds_read_b64_tr_b16 a[4:5],v190 offset:2048
ds_read_b64_tr_b16 a[6:7],v190 offset:2176
ds_read_b64_tr_b16 a[8:9],v190 offset:4096
ds_read_b64_tr_b16 a[10:11],v190 offset:4224
ds_read_b64_tr_b16 a[12:13],v190 offset:6144
ds_read_b64_tr_b16 a[14:15],v190 offset:6272
s_waitcnt lgkmcnt(0)
ds_read_b64_tr_b16 a[16:17],v190 offset:8192
ds_read_b64_tr_b16 a[18:19],v190 offset:8320
ds_read_b64_tr_b16 a[20:21],v190 offset:10240
ds_read_b64_tr_b16 a[22:23],v190 offset:10368
ds_read_b64_tr_b16 a[24:25],v190 offset:12288
ds_read_b64_tr_b16 a[26:27],v190 offset:12416
ds_read_b64_tr_b16 a[28:29],v190 offset:14336
ds_read_b64_tr_b16 a[30:31],v190 offset:14464
s_waitcnt lgkmcnt(0)
ds_read_b64_tr_b16 a[32:33],v190 offset:16384
ds_read_b64_tr_b16 a[34:35],v190 offset:16512
ds_read_b64_tr_b16 a[36:37],v190 offset:18432
ds_read_b64_tr_b16 a[38:39],v190 offset:18560
ds_read_b64_tr_b16 a[40:41],v190 offset:20480
ds_read_b64_tr_b16 a[42:43],v190 offset:20608
ds_read_b64_tr_b16 a[44:45],v190 offset:22528
ds_read_b64_tr_b16 a[46:47],v190 offset:22656
s_waitcnt lgkmcnt(0)
ds_read_b64_tr_b16 a[48:49],v190 offset:24576
ds_read_b64_tr_b16 a[50:51],v190 offset:24704
ds_read_b64_tr_b16 a[52:53],v190 offset:26624
ds_read_b64_tr_b16 a[54:55],v190 offset:26752
ds_read_b64_tr_b16 a[56:57],v190 offset:28672
ds_read_b64_tr_b16 a[58:59],v190 offset:28800
ds_read_b64_tr_b16 a[60:61],v190 offset:30720
ds_read_b64_tr_b16 a[62:63],v190 offset:30848
s_waitcnt lgkmcnt(0)
ds_read_b64_tr_b16 a[64:65],v190 offset:32768
ds_read_b64_tr_b16 a[66:67],v190 offset:32896
ds_read_b64_tr_b16 a[68:69],v190 offset:34816
ds_read_b64_tr_b16 a[70:71],v190 offset:34944
ds_read_b64_tr_b16 a[72:73],v190 offset:36864
ds_read_b64_tr_b16 a[74:75],v190 offset:36992
ds_read_b64_tr_b16 a[76:77],v190 offset:38912
ds_read_b64_tr_b16 a[78:79],v190 offset:39040
s_waitcnt lgkmcnt(0)
ds_read_b64_tr_b16 a[80:81],v190 offset:40960
ds_read_b64_tr_b16 a[82:83],v190 offset:41088
ds_read_b64_tr_b16 a[84:85],v190 offset:43008
ds_read_b64_tr_b16 a[86:87],v190 offset:43136
ds_read_b64_tr_b16 a[88:89],v190 offset:45056
ds_read_b64_tr_b16 a[90:91],v190 offset:45184
ds_read_b64_tr_b16 a[92:93],v190 offset:47104
ds_read_b64_tr_b16 a[94:95],v190 offset:47232
s_waitcnt lgkmcnt(0)
ds_read_b64_tr_b16 a[96:97],v190 offset:49152
ds_read_b64_tr_b16 a[98:99],v190 offset:49280
ds_read_b64_tr_b16 a[100:101],v190 offset:51200
ds_read_b64_tr_b16 a[102:103],v190 offset:51328
ds_read_b64_tr_b16 a[104:105],v190 offset:53248
ds_read_b64_tr_b16 a[106:107],v190 offset:53376
ds_read_b64_tr_b16 a[108:109],v190 offset:55296
ds_read_b64_tr_b16 a[110:111],v190 offset:55424
s_waitcnt lgkmcnt(0)
ds_read_b64_tr_b16 a[112:113],v190 offset:57344
ds_read_b64_tr_b16 a[114:115],v190 offset:57472
ds_read_b64_tr_b16 a[116:117],v190 offset:59392
ds_read_b64_tr_b16 a[118:119],v190 offset:59520
ds_read_b64_tr_b16 a[120:121],v190 offset:61440
ds_read_b64_tr_b16 a[122:123],v190 offset:61568
ds_read_b64_tr_b16 a[124:125],v190 offset:63488
ds_read_b64_tr_b16 a[126:127],v190 offset:63616
s_waitcnt lgkmcnt(0)
s_waitcnt vmcnt(0)
s_barrier
ds_read_b64_tr_b16 a[128:129],v191 offset:0
ds_read_b64_tr_b16 a[130:131],v191 offset:128
ds_read_b64_tr_b16 a[132:133],v191 offset:2048
ds_read_b64_tr_b16 a[134:135],v191 offset:2176
ds_read_b64_tr_b16 a[136:137],v191 offset:4096
ds_read_b64_tr_b16 a[138:139],v191 offset:4224
ds_read_b64_tr_b16 a[140:141],v191 offset:6144
ds_read_b64_tr_b16 a[142:143],v191 offset:6272
s_waitcnt lgkmcnt(0)
ds_read_b64_tr_b16 a[144:145],v191 offset:8192
ds_read_b64_tr_b16 a[146:147],v191 offset:8320
ds_read_b64_tr_b16 a[148:149],v191 offset:10240
ds_read_b64_tr_b16 a[150:151],v191 offset:10368
ds_read_b64_tr_b16 a[152:153],v191 offset:12288
ds_read_b64_tr_b16 a[154:155],v191 offset:12416
ds_read_b64_tr_b16 a[156:157],v191 offset:14336
ds_read_b64_tr_b16 a[158:159],v191 offset:14464
s_waitcnt lgkmcnt(0)
ds_read_b64_tr_b16 a[160:161],v191 offset:16384
ds_read_b64_tr_b16 a[162:163],v191 offset:16512
ds_read_b64_tr_b16 a[164:165],v191 offset:18432
ds_read_b64_tr_b16 a[166:167],v191 offset:18560
ds_read_b64_tr_b16 a[168:169],v191 offset:20480
ds_read_b64_tr_b16 a[170:171],v191 offset:20608
ds_read_b64_tr_b16 a[172:173],v191 offset:22528
ds_read_b64_tr_b16 a[174:175],v191 offset:22656
s_waitcnt lgkmcnt(0)
ds_read_b64_tr_b16 a[176:177],v191 offset:24576
ds_read_b64_tr_b16 a[178:179],v191 offset:24704
ds_read_b64_tr_b16 a[180:181],v191 offset:26624
ds_read_b64_tr_b16 a[182:183],v191 offset:26752
ds_read_b64_tr_b16 a[184:185],v191 offset:28672
ds_read_b64_tr_b16 a[186:187],v191 offset:28800
ds_read_b64_tr_b16 a[188:189],v191 offset:30720
ds_read_b64_tr_b16 a[190:191],v191 offset:30848
s_waitcnt lgkmcnt(0)
ds_read_b64_tr_b16 a[192:193],v191 offset:32768
ds_read_b64_tr_b16 a[194:195],v191 offset:32896
ds_read_b64_tr_b16 a[196:197],v191 offset:34816
ds_read_b64_tr_b16 a[198:199],v191 offset:34944
ds_read_b64_tr_b16 a[200:201],v191 offset:36864
ds_read_b64_tr_b16 a[202:203],v191 offset:36992
ds_read_b64_tr_b16 a[204:205],v191 offset:38912
ds_read_b64_tr_b16 a[206:207],v191 offset:39040
s_waitcnt lgkmcnt(0)
ds_read_b64_tr_b16 a[208:209],v191 offset:40960
ds_read_b64_tr_b16 a[210:211],v191 offset:41088
ds_read_b64_tr_b16 a[212:213],v191 offset:43008
ds_read_b64_tr_b16 a[214:215],v191 offset:43136
ds_read_b64_tr_b16 a[216:217],v191 offset:45056
ds_read_b64_tr_b16 a[218:219],v191 offset:45184
ds_read_b64_tr_b16 a[220:221],v191 offset:47104
ds_read_b64_tr_b16 a[222:223],v191 offset:47232
s_waitcnt lgkmcnt(0)
ds_read_b64_tr_b16 a[224:225],v191 offset:49152
ds_read_b64_tr_b16 a[226:227],v191 offset:49280
ds_read_b64_tr_b16 a[228:229],v191 offset:51200
ds_read_b64_tr_b16 a[230:231],v191 offset:51328
ds_read_b64_tr_b16 a[232:233],v191 offset:53248
ds_read_b64_tr_b16 a[234:235],v191 offset:53376
ds_read_b64_tr_b16 a[236:237],v191 offset:55296
ds_read_b64_tr_b16 a[238:239],v191 offset:55424
s_waitcnt lgkmcnt(0)
ds_read_b64_tr_b16 a[240:241],v191 offset:57344
ds_read_b64_tr_b16 a[242:243],v191 offset:57472
ds_read_b64_tr_b16 a[244:245],v191 offset:59392
ds_read_b64_tr_b16 a[246:247],v191 offset:59520
ds_read_b64_tr_b16 a[248:249],v191 offset:61440
ds_read_b64_tr_b16 a[250:251],v191 offset:61568
ds_read_b64_tr_b16 a[252:253],v191 offset:63488
ds_read_b64_tr_b16 a[254:255],v191 offset:63616
s_waitcnt lgkmcnt(0)
s_branch ws_14
ws_12:
s_add_u32 s64,s14,0
buffer_load_dwordx4 a[0:3],v35,s[36:39],s64 offen nt
s_add_u32 s64,s14,131072
buffer_load_dwordx4 a[4:7],v35,s[36:39],s64 offen nt
s_add_u32 s64,s14,262144
buffer_load_dwordx4 a[8:11],v35,s[36:39],s64 offen nt
s_add_u32 s64,s14,393216
buffer_load_dwordx4 a[12:15],v35,s[36:39],s64 offen nt
s_add_u32 s64,s14,1048576
buffer_load_dwordx4 a[16:19],v35,s[36:39],s64 offen nt
s_add_u32 s64,s14,1179648
buffer_load_dwordx4 a[20:23],v35,s[36:39],s64 offen nt
s_add_u32 s64,s14,1310720
buffer_load_dwordx4 a[24:27],v35,s[36:39],s64 offen nt
s_add_u32 s64,s14,1441792
buffer_load_dwordx4 a[28:31],v35,s[36:39],s64 offen nt
s_add_u32 s64,s14,2097152
buffer_load_dwordx4 a[32:35],v35,s[36:39],s64 offen nt
s_add_u32 s64,s14,2228224
buffer_load_dwordx4 a[36:39],v35,s[36:39],s64 offen nt
s_add_u32 s64,s14,2359296
buffer_load_dwordx4 a[40:43],v35,s[36:39],s64 offen nt
s_add_u32 s64,s14,2490368
buffer_load_dwordx4 a[44:47],v35,s[36:39],s64 offen nt
s_add_u32 s64,s14,3145728
buffer_load_dwordx4 a[48:51],v35,s[36:39],s64 offen nt
s_add_u32 s64,s14,3276800
buffer_load_dwordx4 a[52:55],v35,s[36:39],s64 offen nt
s_add_u32 s64,s14,3407872
buffer_load_dwordx4 a[56:59],v35,s[36:39],s64 offen nt
s_add_u32 s64,s14,3538944
buffer_load_dwordx4 a[60:63],v35,s[36:39],s64 offen nt
s_add_u32 s64,s14,4194304
buffer_load_dwordx4 a[64:67],v35,s[36:39],s64 offen nt
s_add_u32 s64,s14,4325376
buffer_load_dwordx4 a[68:71],v35,s[36:39],s64 offen nt
s_add_u32 s64,s14,4456448
buffer_load_dwordx4 a[72:75],v35,s[36:39],s64 offen nt
s_add_u32 s64,s14,4587520
buffer_load_dwordx4 a[76:79],v35,s[36:39],s64 offen nt
s_add_u32 s64,s14,5242880
buffer_load_dwordx4 a[80:83],v35,s[36:39],s64 offen nt
s_add_u32 s64,s14,5373952
buffer_load_dwordx4 a[84:87],v35,s[36:39],s64 offen nt
s_add_u32 s64,s14,5505024
buffer_load_dwordx4 a[88:91],v35,s[36:39],s64 offen nt
s_add_u32 s64,s14,5636096
buffer_load_dwordx4 a[92:95],v35,s[36:39],s64 offen nt
s_add_u32 s64,s14,6291456
buffer_load_dwordx4 a[96:99],v35,s[36:39],s64 offen nt
s_add_u32 s64,s14,6422528
buffer_load_dwordx4 a[100:103],v35,s[36:39],s64 offen nt
s_add_u32 s64,s14,6553600
buffer_load_dwordx4 a[104:107],v35,s[36:39],s64 offen nt
s_add_u32 s64,s14,6684672
buffer_load_dwordx4 a[108:111],v35,s[36:39],s64 offen nt
s_add_u32 s64,s14,7340032
buffer_load_dwordx4 a[112:115],v35,s[36:39],s64 offen nt
s_add_u32 s64,s14,7471104
buffer_load_dwordx4 a[116:119],v35,s[36:39],s64 offen nt
s_add_u32 s64,s14,7602176
buffer_load_dwordx4 a[120:123],v35,s[36:39],s64 offen nt
s_add_u32 s64,s14,7733248
buffer_load_dwordx4 a[124:127],v35,s[36:39],s64 offen nt
s_add_u32 s64,s15,0
buffer_load_dwordx4 a[128:131],v32,s[40:43],s64 offen nt
s_add_u32 s64,s15,32768
buffer_load_dwordx4 a[132:135],v32,s[40:43],s64 offen nt
s_add_u32 s64,s15,65536
buffer_load_dwordx4 a[136:139],v32,s[40:43],s64 offen nt
s_add_u32 s64,s15,98304
buffer_load_dwordx4 a[140:143],v32,s[40:43],s64 offen nt
s_add_u32 s64,s15,131072
buffer_load_dwordx4 a[144:147],v32,s[40:43],s64 offen nt
s_add_u32 s64,s15,163840
buffer_load_dwordx4 a[148:151],v32,s[40:43],s64 offen nt
s_add_u32 s64,s15,196608
buffer_load_dwordx4 a[152:155],v32,s[40:43],s64 offen nt
s_add_u32 s64,s15,229376
buffer_load_dwordx4 a[156:159],v32,s[40:43],s64 offen nt
s_add_u32 s64,s15,262144
buffer_load_dwordx4 a[160:163],v32,s[40:43],s64 offen nt
s_add_u32 s64,s15,294912
buffer_load_dwordx4 a[164:167],v32,s[40:43],s64 offen nt
s_add_u32 s64,s15,327680
buffer_load_dwordx4 a[168:171],v32,s[40:43],s64 offen nt
s_add_u32 s64,s15,360448
buffer_load_dwordx4 a[172:175],v32,s[40:43],s64 offen nt
s_waitcnt vmcnt(44)
s_barrier
ws_14:
v_mov_b32 v187,158976
s_cmp_lg_u32 s50,1
s_cbranch_scc1 sh0_17
s_mov_b32 s53,0
stl_18:
s_add_u32 s64,s52,32
s_buffer_load_dwordx8 s[72:79],s[20:23],s52 glc
s_buffer_load_dwordx8 s[80:87],s[20:23],s64 glc
s_waitcnt lgkmcnt(0)
s_min_u32 s72,s72,s80
s_min_u32 s73,s73,s81
s_min_u32 s74,s74,s82
s_min_u32 s75,s75,s83
s_min_u32 s76,s76,s84
s_min_u32 s77,s77,s85
s_min_u32 s78,s78,s86
s_min_u32 s79,s79,s87
s_min_u32 s72,s72,s76
s_min_u32 s73,s73,s77
s_min_u32 s74,s74,s78
s_min_u32 s75,s75,s79
s_min_u32 s72,s72,s74
s_min_u32 s73,s73,s75
s_min_u32 s64,s72,s73
s_mov_b32 s65,0
s_and_b32 s61,s64,1
s_lshl_b32 s61,s61,13
s_cmp_lg_u32 s64,0
s_cbranch_scc1 stok_19
s_sub_u32 s90,s90,1
s_cmp_lt_i32 s90,0
s_cbranch_scc1 stok_19
s_add_u32 s53,s53,1
s_and_b32 s64,s53,31
s_cbranch_scc1 stl_18
s_cmp_eq_u32 s56,1
s_cbranch_scc1 stl_18
v_and_b32 v184,3,v1
v_bfe_u32 v185,v1,2,1
v_lshlrev_b32 v184,2,v184
v_lshl_add_u32 v184,v185,7,v184
v_writelane_b32 v184,32,8
s_mov_b64 exec,0x1ff
vpoll_20:
buffer_load_dword v185,v184,s[44:47],0 offen sc1
s_waitcnt vmcnt(0)
vfirst_23:
v_readlane_b32 s92,v185,0
v_readlane_b32 s93,v185,1
v_readlane_b32 s94,v185,2
v_readlane_b32 s95,v185,3
v_readlane_b32 s96,v185,4
v_readlane_b32 s97,v185,5
v_readlane_b32 s98,v185,6
v_readlane_b32 s99,v185,7
v_readlane_b32 s61,v185,8
s_add_u32 s64,s92,s93
s_add_u32 s64,s64,s94
s_add_u32 s64,s64,s95
s_add_u32 s64,s64,s96
s_add_u32 s64,s64,s97
s_add_u32 s64,s64,s98
s_add_u32 s64,s64,s99
s_min_u32 s65,s92,s93
s_min_u32 s66,s94,s95
s_min_u32 s65,s65,s66
s_min_u32 s66,s96,s97
s_min_u32 s65,s65,s66
s_min_u32 s66,s98,s99
s_min_u32 s65,s65,s66
s_cmp_lt_u32 s65,32
s_cselect_b32 s65,1,0
s_cmp_lt_u32 s64,256
s_cbranch_scc1 vslp_22
s_branch vgot_21
vslp_22:
s_sleep 8
s_sub_u32 s90,s90,1
s_cmp_gt_i32 s90,0
s_cbranch_scc1 vpoll_20
vgot_21:
s_mov_b64 exec,-1
s_and_b32 s61,s61,1
s_lshl_b32 s61,s61,13
s_mov_b32 s66,s54
s_cmp_gt_u32 s51,0
s_cselect_b32 s64,s92,0
s_add_u32 s66,s66,s64
s_cmp_gt_u32 s51,1
s_cselect_b32 s64,s93,0
s_add_u32 s66,s66,s64
s_cmp_gt_u32 s51,2
s_cselect_b32 s64,s94,0
s_add_u32 s66,s66,s64
s_cmp_gt_u32 s51,3
s_cselect_b32 s64,s95,0
s_add_u32 s66,s66,s64
s_cmp_gt_u32 s51,4
s_cselect_b32 s64,s96,0
s_add_u32 s66,s66,s64
s_cmp_gt_u32 s51,5
s_cselect_b32 s64,s97,0
s_add_u32 s66,s66,s64
s_cmp_gt_u32 s51,6
s_cselect_b32 s64,s98,0
s_add_u32 s66,s66,s64
s_cmp_eq_u32 s65,0
s_cbranch_scc1 stl_18
stok_19:
v_mov_b32 v184,s65
v_mov_b32 v185,s66
v_mov_b32 v186,s61
ds_write_b96 v187,v[184:186] offset:16
s_waitcnt lgkmcnt(0)
sh0_17:
s_barrier
ds_read_b96 v[184:186],v187 offset:16
s_waitcnt lgkmcnt(0)
v_readfirstlane_b32 s65,v184
v_readfirstlane_b32 s66,v185
v_readfirstlane_b32 s61,v186
s_cmp_lg_u32 s65,0
s_cbranch_scc1 slowrole_10
s_and_b32 s56,s56,1
s_branch loops_7
pre_8:
s_sub_u32 s55,s57,128
s_load_dwordx4 s[4:7],s[0:1],96
s_load_dwordx2 s[8:9],s[0:1],0
v_and_b32 v1,63,v0
v_lshrrev_b32 v2,6,v0
v_and_b32 v3,7,v0
v_lshrrev_b32 v4,3,v0
v_mul_u32_u24 v5,12288,v4
v_lshl_add_u32 v5,v3,4,v5
v_lshlrev_b32 v6,1,v4
s_and_b32 s24,s55,31
s_lshr_b32 s25,s55,5
s_lshl_b32 s26,s24,7
s_mul_i32 s27,s25,3145728
s_add_u32 s26,s26,s27
s_lshl_b32 s27,s25,9
s_waitcnt lgkmcnt(0)
s_mov_b32 s12,s4
s_and_b32 s13,s5,0xffff
s_mov_b32 s14,0x800
s_mov_b32 s15,0x20000
s_mov_b32 s28,s6
s_and_b32 s29,s7,0xffff
s_mov_b32 s30,0xc00000
s_mov_b32 s31,0x20000
s_mov_b32 s32,s8
s_and_b32 s33,s9,0xffff
s_mov_b32 s34,0x400000
s_mov_b32 s35,0x20000
buffer_load_dwordx4 v[64:67],v5,s[28:31],s26 offen nt
s_add_u32 s26,s26,393216
buffer_load_dwordx4 v[68:71],v5,s[28:31],s26 offen nt
s_add_u32 s26,s26,393216
buffer_load_dwordx4 v[72:75],v5,s[28:31],s26 offen nt
s_add_u32 s26,s26,393216
buffer_load_dwordx4 v[76:79],v5,s[28:31],s26 offen nt
s_add_u32 s26,s26,393216
buffer_load_dwordx4 v[80:83],v5,s[28:31],s26 offen nt
s_add_u32 s26,s26,393216
buffer_load_dwordx4 v[84:87],v5,s[28:31],s26 offen nt
s_add_u32 s26,s26,393216
buffer_load_dwordx4 v[88:91],v5,s[28:31],s26 offen nt
s_add_u32 s26,s26,393216
buffer_load_dwordx4 v[92:95],v5,s[28:31],s26 offen nt
buffer_load_ushort v96,v6,s[12:15],s27 offen offset:0
buffer_load_ushort v97,v6,s[12:15],s27 offen offset:64
buffer_load_ushort v98,v6,s[12:15],s27 offen offset:128
buffer_load_ushort v99,v6,s[12:15],s27 offen offset:192
buffer_load_ushort v100,v6,s[12:15],s27 offen offset:256
buffer_load_ushort v101,v6,s[12:15],s27 offen offset:320
buffer_load_ushort v102,v6,s[12:15],s27 offen offset:384
buffer_load_ushort v103,v6,s[12:15],s27 offen offset:448
v_and_b32 v3,3,v1
v_lshrrev_b32 v4,2,v1
v_lshl_add_u32 v5,v2,2,v3
v_lshlrev_b32 v5,11,v5
v_lshl_add_u32 v5,v4,5,v5
s_lshl_b32 s36,s55,15
s_cmp_lt_u32 s55,16
s_cselect_b32 s42,s36,0x7fff0000
s_cselect_b32 s36,0x7fff0000,s36
buffer_load_dwordx4 v[8:11],v5,s[32:35],s42 offen offset:0
buffer_load_dwordx4 v[12:15],v5,s[32:35],s42 offen offset:16
buffer_load_dwordx4 v[16:19],v5,s[32:35],s42 offen offset:512
buffer_load_dwordx4 v[20:23],v5,s[32:35],s42 offen offset:528
buffer_load_dwordx4 v[24:27],v5,s[32:35],s42 offen offset:1024
buffer_load_dwordx4 v[28:31],v5,s[32:35],s42 offen offset:1040
buffer_load_dwordx4 v[32:35],v5,s[32:35],s42 offen offset:1536
buffer_load_dwordx4 v[36:39],v5,s[32:35],s42 offen offset:1552
v_lshrrev_b32 v6,1,v4
v_lshlrev_b32 v6,11,v6
v_and_b32 v7,1,v4
v_lshl_add_u32 v6,v7,9,v6
v_and_b32 v7,1,v2
v_lshl_add_u32 v6,v7,10,v6
v_lshrrev_b32 v7,1,v2
v_lshl_add_u32 v7,v7,2,v3
v_lshl_add_u32 v6,v7,4,v6
v_lshlrev_b32 v4,6,v4
s_lshr_b32 s37,s55,1
s_lshl_b32 s37,s37,16
s_and_b32 s38,s55,1
s_lshl_b32 s38,s38,7
s_add_u32 s37,s37,s38
s_add_u32 s37,s37,57344
s_mov_b32 s38,0xbfb8aa3b
s_mov_b32 s39,0xffff0000
s_cmp_lg_u32 s50,1
s_cbranch_scc1 nz_24
s_lshl_b32 s40,s55,9
s_add_u32 s40,s40,21037056
v_lshl_add_u32 v104,v1,4,s40
s_lshl_b32 s41,s55,7
s_add_u32 s41,s41,21102592
v_writelane_b32 v104,s41,32
v_mov_b32 v108,0
v_mov_b32 v109,0
v_mov_b32 v110,0
v_mov_b32 v111,0
s_mov_b32 exec_hi,1
buffer_store_dwordx4 v[108:111],v104,s[20:23],0 offen sc1
s_mov_b64 exec,-1
nz_24:
v_mov_b32 v112,0
v_mov_b32 v113,0
v_mov_b32 v114,0
v_mov_b32 v115,0
v_mov_b32 v116,0
v_mov_b32 v117,0
v_mov_b32 v118,0
v_mov_b32 v119,0
s_waitcnt vmcnt(8)
v_lshlrev_b32 v96,16,v96
v_mul_f32 v104,s38,v96
v_exp_f32 v104,v104
s_nop 0
v_add_f32 v104,1.0,v104
v_rcp_f32 v104,v104
s_nop 0
v_mul_f32 v104,v104,v96
v_cvt_pk_bf16_f32 v104,v104,v104
v_and_b32 v96,s39,v104
v_lshlrev_b32 v105,16,v64
v_and_b32 v106,s39,v64
v_fmac_f32 v112,v105,v96
v_fmac_f32 v113,v106,v96
v_lshlrev_b32 v105,16,v65
v_and_b32 v106,s39,v65
v_fmac_f32 v114,v105,v96
v_fmac_f32 v115,v106,v96
v_lshlrev_b32 v105,16,v66
v_and_b32 v106,s39,v66
v_fmac_f32 v116,v105,v96
v_fmac_f32 v117,v106,v96
v_lshlrev_b32 v105,16,v67
v_and_b32 v106,s39,v67
v_fmac_f32 v118,v105,v96
v_fmac_f32 v119,v106,v96
v_lshlrev_b32 v97,16,v97
v_mul_f32 v104,s38,v97
v_exp_f32 v104,v104
s_nop 0
v_add_f32 v104,1.0,v104
v_rcp_f32 v104,v104
s_nop 0
v_mul_f32 v104,v104,v97
v_cvt_pk_bf16_f32 v104,v104,v104
v_and_b32 v97,s39,v104
v_lshlrev_b32 v105,16,v68
v_and_b32 v106,s39,v68
v_fmac_f32 v112,v105,v97
v_fmac_f32 v113,v106,v97
v_lshlrev_b32 v105,16,v69
v_and_b32 v106,s39,v69
v_fmac_f32 v114,v105,v97
v_fmac_f32 v115,v106,v97
v_lshlrev_b32 v105,16,v70
v_and_b32 v106,s39,v70
v_fmac_f32 v116,v105,v97
v_fmac_f32 v117,v106,v97
v_lshlrev_b32 v105,16,v71
v_and_b32 v106,s39,v71
v_fmac_f32 v118,v105,v97
v_fmac_f32 v119,v106,v97
v_lshlrev_b32 v98,16,v98
v_mul_f32 v104,s38,v98
v_exp_f32 v104,v104
s_nop 0
v_add_f32 v104,1.0,v104
v_rcp_f32 v104,v104
s_nop 0
v_mul_f32 v104,v104,v98
v_cvt_pk_bf16_f32 v104,v104,v104
v_and_b32 v98,s39,v104
v_lshlrev_b32 v105,16,v72
v_and_b32 v106,s39,v72
v_fmac_f32 v112,v105,v98
v_fmac_f32 v113,v106,v98
v_lshlrev_b32 v105,16,v73
v_and_b32 v106,s39,v73
v_fmac_f32 v114,v105,v98
v_fmac_f32 v115,v106,v98
v_lshlrev_b32 v105,16,v74
v_and_b32 v106,s39,v74
v_fmac_f32 v116,v105,v98
v_fmac_f32 v117,v106,v98
v_lshlrev_b32 v105,16,v75
v_and_b32 v106,s39,v75
v_fmac_f32 v118,v105,v98
v_fmac_f32 v119,v106,v98
v_lshlrev_b32 v99,16,v99
v_mul_f32 v104,s38,v99
v_exp_f32 v104,v104
s_nop 0
v_add_f32 v104,1.0,v104
v_rcp_f32 v104,v104
s_nop 0
v_mul_f32 v104,v104,v99
v_cvt_pk_bf16_f32 v104,v104,v104
v_and_b32 v99,s39,v104
v_lshlrev_b32 v105,16,v76
v_and_b32 v106,s39,v76
v_fmac_f32 v112,v105,v99
v_fmac_f32 v113,v106,v99
v_lshlrev_b32 v105,16,v77
v_and_b32 v106,s39,v77
v_fmac_f32 v114,v105,v99
v_fmac_f32 v115,v106,v99
v_lshlrev_b32 v105,16,v78
v_and_b32 v106,s39,v78
v_fmac_f32 v116,v105,v99
v_fmac_f32 v117,v106,v99
v_lshlrev_b32 v105,16,v79
v_and_b32 v106,s39,v79
v_fmac_f32 v118,v105,v99
v_fmac_f32 v119,v106,v99
v_lshlrev_b32 v100,16,v100
v_mul_f32 v104,s38,v100
v_exp_f32 v104,v104
s_nop 0
v_add_f32 v104,1.0,v104
v_rcp_f32 v104,v104
s_nop 0
v_mul_f32 v104,v104,v100
v_cvt_pk_bf16_f32 v104,v104,v104
v_and_b32 v100,s39,v104
v_lshlrev_b32 v105,16,v80
v_and_b32 v106,s39,v80
v_fmac_f32 v112,v105,v100
v_fmac_f32 v113,v106,v100
v_lshlrev_b32 v105,16,v81
v_and_b32 v106,s39,v81
v_fmac_f32 v114,v105,v100
v_fmac_f32 v115,v106,v100
v_lshlrev_b32 v105,16,v82
v_and_b32 v106,s39,v82
v_fmac_f32 v116,v105,v100
v_fmac_f32 v117,v106,v100
v_lshlrev_b32 v105,16,v83
v_and_b32 v106,s39,v83
v_fmac_f32 v118,v105,v100
v_fmac_f32 v119,v106,v100
v_lshlrev_b32 v101,16,v101
v_mul_f32 v104,s38,v101
v_exp_f32 v104,v104
s_nop 0
v_add_f32 v104,1.0,v104
v_rcp_f32 v104,v104
s_nop 0
v_mul_f32 v104,v104,v101
v_cvt_pk_bf16_f32 v104,v104,v104
v_and_b32 v101,s39,v104
v_lshlrev_b32 v105,16,v84
v_and_b32 v106,s39,v84
v_fmac_f32 v112,v105,v101
v_fmac_f32 v113,v106,v101
v_lshlrev_b32 v105,16,v85
v_and_b32 v106,s39,v85
v_fmac_f32 v114,v105,v101
v_fmac_f32 v115,v106,v101
v_lshlrev_b32 v105,16,v86
v_and_b32 v106,s39,v86
v_fmac_f32 v116,v105,v101
v_fmac_f32 v117,v106,v101
v_lshlrev_b32 v105,16,v87
v_and_b32 v106,s39,v87
v_fmac_f32 v118,v105,v101
v_fmac_f32 v119,v106,v101
v_lshlrev_b32 v102,16,v102
v_mul_f32 v104,s38,v102
v_exp_f32 v104,v104
s_nop 0
v_add_f32 v104,1.0,v104
v_rcp_f32 v104,v104
s_nop 0
v_mul_f32 v104,v104,v102
v_cvt_pk_bf16_f32 v104,v104,v104
v_and_b32 v102,s39,v104
v_lshlrev_b32 v105,16,v88
v_and_b32 v106,s39,v88
v_fmac_f32 v112,v105,v102
v_fmac_f32 v113,v106,v102
v_lshlrev_b32 v105,16,v89
v_and_b32 v106,s39,v89
v_fmac_f32 v114,v105,v102
v_fmac_f32 v115,v106,v102
v_lshlrev_b32 v105,16,v90
v_and_b32 v106,s39,v90
v_fmac_f32 v116,v105,v102
v_fmac_f32 v117,v106,v102
v_lshlrev_b32 v105,16,v91
v_and_b32 v106,s39,v91
v_fmac_f32 v118,v105,v102
v_fmac_f32 v119,v106,v102
v_lshlrev_b32 v103,16,v103
v_mul_f32 v104,s38,v103
v_exp_f32 v104,v104
s_nop 0
v_add_f32 v104,1.0,v104
v_rcp_f32 v104,v104
s_nop 0
v_mul_f32 v104,v104,v103
v_cvt_pk_bf16_f32 v104,v104,v104
v_and_b32 v103,s39,v104
v_lshlrev_b32 v105,16,v92
v_and_b32 v106,s39,v92
v_fmac_f32 v112,v105,v103
v_fmac_f32 v113,v106,v103
v_lshlrev_b32 v105,16,v93
v_and_b32 v106,s39,v93
v_fmac_f32 v114,v105,v103
v_fmac_f32 v115,v106,v103
v_lshlrev_b32 v105,16,v94
v_and_b32 v106,s39,v94
v_fmac_f32 v116,v105,v103
v_fmac_f32 v117,v106,v103
v_lshlrev_b32 v105,16,v95
v_and_b32 v106,s39,v95
v_fmac_f32 v118,v105,v103
v_fmac_f32 v119,v106,v103
v_permlane32_swap_b32 v112,v116
v_permlane32_swap_b32 v113,v117
v_permlane32_swap_b32 v114,v118
v_permlane32_swap_b32 v115,v119
v_add_f32 v112,v112,v116
v_add_f32 v113,v113,v117
v_add_f32 v114,v114,v118
v_add_f32 v115,v115,v119
s_nop 0
v_permlane16_swap_b32 v112,v114
v_permlane16_swap_b32 v113,v115
v_add_f32 v112,v112,v114
v_add_f32 v113,v113,v115
s_nop 0
v_add_f32_dpp v112,v112,v112 row_ror:8 row_mask:0xf bank_mask:0xf
v_add_f32_dpp v113,v113,v113 row_ror:8 row_mask:0xf bank_mask:0xf
v_and_b32 v104,7,v1
v_lshlrev_b32 v104,5,v104
v_lshrrev_b32 v105,5,v1
v_lshl_add_u32 v104,v105,4,v104
v_bfe_u32 v105,v1,4,1
v_lshl_add_u32 v104,v105,3,v104
v_lshl_add_u32 v104,v2,8,v104
ds_write_b64 v104,v[112:113]
v_lshlrev_b32 v105,2,v1
s_lshl_b32 s40,s25,13
s_lshl_b32 s41,s24,8
s_add_u32 s40,s40,s41
s_add_u32 s40,s40,24576
s_waitcnt lgkmcnt(0)
s_barrier
s_cmp_lg_u32 s50,0
s_cbranch_scc1 m1n0_25
ds_read_b32 v112,v105 offset:0
ds_read_b32 v113,v105 offset:256
ds_read_b32 v114,v105 offset:512
ds_read_b32 v115,v105 offset:768
s_waitcnt lgkmcnt(0)
v_add_f32 v112,v112,v113
v_add_f32 v114,v114,v115
v_add_f32 v112,v112,v114
buffer_store_dword v112,v105,s[20:23],s40 offen sc1
m1n0_25:
s_waitcnt vmcnt(0)
s_barrier
s_cmp_lg_u32 s50,0
s_cbranch_scc1 post_9
s_mov_b64 exec,1
v_mov_b32 v184,1
v_mov_b32 v185,0
s_and_b32 s52,s56,1
s_lshl_b32 s52,s52,2
s_add_u32 s52,s52,160
buffer_atomic_add v184,v185,s[44:47],s52 offen sc0 sc1
s_waitcnt vmcnt(0)
v_readfirstlane_b32 s64,v184
s_mov_b64 exec,-1
s_cmp_eq_u32 s56,1
s_cbranch_scc1 post_9
s_cmp_lg_u32 s64,127
s_cbranch_scc1 post_9
v_and_b32 v184,3,v1
v_bfe_u32 v185,v1,2,1
v_lshlrev_b32 v184,2,v184
v_lshl_add_u32 v184,v185,7,v184
v_writelane_b32 v184,32,8
s_mov_b64 exec,0x1ff
vpoll_27:
buffer_load_dword v185,v184,s[44:47],0 offen sc1
s_waitcnt vmcnt(0)
vfirst_30:
v_readlane_b32 s92,v185,0
v_readlane_b32 s93,v185,1
v_readlane_b32 s94,v185,2
v_readlane_b32 s95,v185,3
v_readlane_b32 s96,v185,4
v_readlane_b32 s97,v185,5
v_readlane_b32 s98,v185,6
v_readlane_b32 s99,v185,7
v_readlane_b32 s61,v185,8
s_add_u32 s64,s92,s93
s_add_u32 s64,s64,s94
s_add_u32 s64,s64,s95
s_add_u32 s64,s64,s96
s_add_u32 s64,s64,s97
s_add_u32 s64,s64,s98
s_add_u32 s64,s64,s99
s_min_u32 s65,s92,s93
s_min_u32 s66,s94,s95
s_min_u32 s65,s65,s66
s_min_u32 s66,s96,s97
s_min_u32 s65,s65,s66
s_min_u32 s66,s98,s99
s_min_u32 s65,s65,s66
s_cmp_lt_u32 s65,32
s_cselect_b32 s65,1,0
s_cmp_lt_u32 s64,256
s_cbranch_scc1 vslp_29
s_branch vgot_28
vslp_29:
s_sleep 8
s_sub_u32 s90,s90,1
s_cmp_gt_i32 s90,0
s_cbranch_scc1 vpoll_27
vgot_28:
s_mov_b64 exec,-1
s_and_b32 s61,s61,1
s_lshl_b32 s61,s61,13
s_cmp_lg_u32 s65,0
s_cbranch_scc1 post_9
v_lshlrev_b32 v184,7,v1
v_mov_b32 v185,1
s_mov_b32 s64,21102592
s_mov_b32 s65,21110784
buffer_store_dword v185,v184,s[20:23],s64 offen sc1
buffer_store_dword v185,v184,s[20:23],s65 offen sc1
s_branch post_9
verify_6:
v_mov_b32 v187,158976
s_cmp_lg_u32 s50,0
s_cbranch_scc1 sh0_31
v_and_b32 v184,3,v1
v_bfe_u32 v185,v1,2,1
v_lshlrev_b32 v184,2,v184
v_lshl_add_u32 v184,v185,7,v184
v_writelane_b32 v184,32,8
s_mov_b64 exec,0x1ff
vpoll_32:
buffer_load_dword v185,v184,s[44:47],0 offen sc1
s_waitcnt vmcnt(0)
vfirst_35:
v_readlane_b32 s92,v185,0
v_readlane_b32 s93,v185,1
v_readlane_b32 s94,v185,2
v_readlane_b32 s95,v185,3
v_readlane_b32 s96,v185,4
v_readlane_b32 s97,v185,5
v_readlane_b32 s98,v185,6
v_readlane_b32 s99,v185,7
v_readlane_b32 s61,v185,8
s_add_u32 s64,s92,s93
s_add_u32 s64,s64,s94
s_add_u32 s64,s64,s95
s_add_u32 s64,s64,s96
s_add_u32 s64,s64,s97
s_add_u32 s64,s64,s98
s_add_u32 s64,s64,s99
s_min_u32 s65,s92,s93
s_min_u32 s66,s94,s95
s_min_u32 s65,s65,s66
s_min_u32 s66,s96,s97
s_min_u32 s65,s65,s66
s_min_u32 s66,s98,s99
s_min_u32 s65,s65,s66
s_cmp_lt_u32 s65,32
s_cselect_b32 s65,1,0
s_cmp_lt_u32 s64,256
s_cbranch_scc1 vslp_34
s_branch vgot_33
vslp_34:
s_sleep 8
s_sub_u32 s90,s90,1
s_cmp_gt_i32 s90,0
s_cbranch_scc1 vpoll_32
vgot_33:
s_mov_b64 exec,-1
s_and_b32 s61,s61,1
s_lshl_b32 s61,s61,13
s_mov_b32 s66,s54
s_cmp_gt_u32 s51,0
s_cselect_b32 s64,s92,0
s_add_u32 s66,s66,s64
s_cmp_gt_u32 s51,1
s_cselect_b32 s64,s93,0
s_add_u32 s66,s66,s64
s_cmp_gt_u32 s51,2
s_cselect_b32 s64,s94,0
s_add_u32 s66,s66,s64
s_cmp_gt_u32 s51,3
s_cselect_b32 s64,s95,0
s_add_u32 s66,s66,s64
s_cmp_gt_u32 s51,4
s_cselect_b32 s64,s96,0
s_add_u32 s66,s66,s64
s_cmp_gt_u32 s51,5
s_cselect_b32 s64,s97,0
s_add_u32 s66,s66,s64
s_cmp_gt_u32 s51,6
s_cselect_b32 s64,s98,0
s_add_u32 s66,s66,s64
v_mov_b32 v184,s65
v_mov_b32 v185,s66
v_mov_b32 v186,s61
ds_write_b96 v187,v[184:186] offset:16
s_waitcnt lgkmcnt(0)
sh0_31:
s_barrier
ds_read_b96 v[184:186],v187 offset:16
s_waitcnt lgkmcnt(0)
v_readfirstlane_b32 s65,v184
v_readfirstlane_b32 s66,v185
v_readfirstlane_b32 s61,v186
s_cmp_lg_u32 s65,0
s_cbranch_scc1 slowrole_10
s_mov_b32 s56,0
s_branch done_1
slowrole_10:
s_mov_b32 s57,s66
s_mov_b32 s56,1
s_waitcnt vmcnt(0)
s_barrier
s_cmp_ge_u32 s57,128
s_cbranch_scc1 pre_8
s_cmp_lg_u32 s50,0
s_cbranch_scc1 nadd_36
s_mov_b64 exec,1
v_mov_b32 v184,1
v_mov_b32 v185,0
s_mov_b32 s52,164
buffer_atomic_add v184,v185,s[44:47],s52 offen sc1
s_mov_b64 exec,-1
nadd_36:
s_branch setup_5
post_9:
s_cmp_lt_u32 s55,16
s_cbranch_scc1 xd_38
s_barrier
buffer_load_dwordx4 v[8:11],v5,s[32:35],s36 offen offset:0
buffer_load_dwordx4 v[12:15],v5,s[32:35],s36 offen offset:16
buffer_load_dwordx4 v[16:19],v5,s[32:35],s36 offen offset:512
buffer_load_dwordx4 v[20:23],v5,s[32:35],s36 offen offset:528
buffer_load_dwordx4 v[24:27],v5,s[32:35],s36 offen offset:1024
buffer_load_dwordx4 v[28:31],v5,s[32:35],s36 offen offset:1040
buffer_load_dwordx4 v[32:35],v5,s[32:35],s36 offen offset:1536
buffer_load_dwordx4 v[36:39],v5,s[32:35],s36 offen offset:1552
xd_38:
s_sub_u32 s65,s57,255
s_and_b32 s66,s56,1
s_or_b32 s65,s65,s66
s_or_b32 s65,s65,s50
s_cmp_lg_u32 s65,0
s_cbranch_scc1 nomeas_37
s_mov_b64 exec,1
v_mov_b32 v184,0
s_mov_b32 s52,20971520
s_mov_b32 s53,20979712
s_mov_b32 s70,0x7fffffff
s_mov_b32 s71,0x7fffffff
s_memtime s[72:73]
s_waitcnt lgkmcnt(0)
buffer_store_dword v184,v184,s[20:23],s52 offen sc1
s_waitcnt vmcnt(0)
s_memtime s[74:75]
s_waitcnt lgkmcnt(0)
s_sub_u32 s74,s74,s72
s_min_u32 s70,s70,s74
s_memtime s[72:73]
s_waitcnt lgkmcnt(0)
buffer_store_dword v184,v184,s[20:23],s53 offen sc1
s_waitcnt vmcnt(0)
s_memtime s[74:75]
s_waitcnt lgkmcnt(0)
s_sub_u32 s74,s74,s72
s_min_u32 s71,s71,s74
s_memtime s[72:73]
s_waitcnt lgkmcnt(0)
buffer_store_dword v184,v184,s[20:23],s52 offen sc1
s_waitcnt vmcnt(0)
s_memtime s[74:75]
s_waitcnt lgkmcnt(0)
s_sub_u32 s74,s74,s72
s_min_u32 s70,s70,s74
s_memtime s[72:73]
s_waitcnt lgkmcnt(0)
buffer_store_dword v184,v184,s[20:23],s53 offen sc1
s_waitcnt vmcnt(0)
s_memtime s[74:75]
s_waitcnt lgkmcnt(0)
s_sub_u32 s74,s74,s72
s_min_u32 s71,s71,s74
s_memtime s[72:73]
s_waitcnt lgkmcnt(0)
buffer_store_dword v184,v184,s[20:23],s52 offen sc1
s_waitcnt vmcnt(0)
s_memtime s[74:75]
s_waitcnt lgkmcnt(0)
s_sub_u32 s74,s74,s72
s_min_u32 s70,s70,s74
s_memtime s[72:73]
s_waitcnt lgkmcnt(0)
buffer_store_dword v184,v184,s[20:23],s53 offen sc1
s_waitcnt vmcnt(0)
s_memtime s[74:75]
s_waitcnt lgkmcnt(0)
s_sub_u32 s74,s74,s72
s_min_u32 s71,s71,s74
s_memtime s[72:73]
s_waitcnt lgkmcnt(0)
buffer_store_dword v184,v184,s[20:23],s52 offen sc1
s_waitcnt vmcnt(0)
s_memtime s[74:75]
s_waitcnt lgkmcnt(0)
s_sub_u32 s74,s74,s72
s_min_u32 s70,s70,s74
s_memtime s[72:73]
s_waitcnt lgkmcnt(0)
buffer_store_dword v184,v184,s[20:23],s53 offen sc1
s_waitcnt vmcnt(0)
s_memtime s[74:75]
s_waitcnt lgkmcnt(0)
s_sub_u32 s74,s74,s72
s_min_u32 s71,s71,s74
s_cmp_gt_u32 s71,s70
s_cselect_b32 s65,3,2
v_mov_b32 v185,s65
buffer_store_dword v185,v184,s[44:47],32 offen sc1
s_mov_b64 exec,-1
nomeas_37:
s_waitcnt vmcnt(0)
v_and_b32 v103,s39,v39
v_lshlrev_b32 v102,16,v39
v_and_b32 v101,s39,v38
v_lshlrev_b32 v100,16,v38
v_and_b32 v99,s39,v37
v_lshlrev_b32 v98,16,v37
v_and_b32 v97,s39,v36
v_lshlrev_b32 v96,16,v36
v_and_b32 v95,s39,v35
v_lshlrev_b32 v94,16,v35
v_and_b32 v93,s39,v34
v_lshlrev_b32 v92,16,v34
v_and_b32 v91,s39,v33
v_lshlrev_b32 v90,16,v33
v_and_b32 v89,s39,v32
v_lshlrev_b32 v88,16,v32
v_and_b32 v87,s39,v31
v_lshlrev_b32 v86,16,v31
v_and_b32 v85,s39,v30
v_lshlrev_b32 v84,16,v30
v_and_b32 v83,s39,v29
v_lshlrev_b32 v82,16,v29
v_and_b32 v81,s39,v28
v_lshlrev_b32 v80,16,v28
v_and_b32 v79,s39,v27
v_lshlrev_b32 v78,16,v27
v_and_b32 v77,s39,v26
v_lshlrev_b32 v76,16,v26
v_and_b32 v75,s39,v25
v_lshlrev_b32 v74,16,v25
v_and_b32 v73,s39,v24
v_lshlrev_b32 v72,16,v24
v_and_b32 v71,s39,v23
v_lshlrev_b32 v70,16,v23
v_and_b32 v69,s39,v22
v_lshlrev_b32 v68,16,v22
v_and_b32 v67,s39,v21
v_lshlrev_b32 v66,16,v21
v_and_b32 v65,s39,v20
v_lshlrev_b32 v64,16,v20
v_and_b32 v63,s39,v19
v_lshlrev_b32 v62,16,v19
v_and_b32 v61,s39,v18
v_lshlrev_b32 v60,16,v18
v_and_b32 v59,s39,v17
v_lshlrev_b32 v58,16,v17
v_and_b32 v57,s39,v16
v_lshlrev_b32 v56,16,v16
v_and_b32 v55,s39,v15
v_lshlrev_b32 v54,16,v15
v_and_b32 v53,s39,v14
v_lshlrev_b32 v52,16,v14
v_and_b32 v51,s39,v13
v_lshlrev_b32 v50,16,v13
v_and_b32 v49,s39,v12
v_lshlrev_b32 v48,16,v12
v_and_b32 v47,s39,v11
v_lshlrev_b32 v46,16,v11
v_and_b32 v45,s39,v10
v_lshlrev_b32 v44,16,v10
v_and_b32 v43,s39,v9
v_lshlrev_b32 v42,16,v9
v_and_b32 v41,s39,v8
v_lshlrev_b32 v40,16,v8
v_pk_add_f32 v[8:9],v[40:41],v[42:43]
v_pk_add_f32 v[10:11],v[44:45],v[46:47]
v_pk_add_f32 v[8:9],v[8:9],v[48:49]
v_pk_add_f32 v[10:11],v[10:11],v[50:51]
v_pk_add_f32 v[8:9],v[8:9],v[52:53]
v_pk_add_f32 v[10:11],v[10:11],v[54:55]
v_pk_add_f32 v[8:9],v[8:9],v[56:57]
v_pk_add_f32 v[10:11],v[10:11],v[58:59]
v_pk_add_f32 v[8:9],v[8:9],v[60:61]
v_pk_add_f32 v[10:11],v[10:11],v[62:63]
v_pk_add_f32 v[8:9],v[8:9],v[64:65]
v_pk_add_f32 v[10:11],v[10:11],v[66:67]
v_pk_add_f32 v[8:9],v[8:9],v[68:69]
v_pk_add_f32 v[10:11],v[10:11],v[70:71]
v_pk_add_f32 v[8:9],v[8:9],v[72:73]
v_pk_add_f32 v[10:11],v[10:11],v[74:75]
v_pk_add_f32 v[8:9],v[8:9],v[76:77]
v_pk_add_f32 v[10:11],v[10:11],v[78:79]
v_pk_add_f32 v[8:9],v[8:9],v[80:81]
v_pk_add_f32 v[10:11],v[10:11],v[82:83]
v_pk_add_f32 v[8:9],v[8:9],v[84:85]
v_pk_add_f32 v[10:11],v[10:11],v[86:87]
v_pk_add_f32 v[8:9],v[8:9],v[88:89]
v_pk_add_f32 v[10:11],v[10:11],v[90:91]
v_pk_add_f32 v[8:9],v[8:9],v[92:93]
v_pk_add_f32 v[10:11],v[10:11],v[94:95]
v_pk_add_f32 v[8:9],v[8:9],v[96:97]
v_pk_add_f32 v[10:11],v[10:11],v[98:99]
v_pk_add_f32 v[8:9],v[8:9],v[100:101]
v_pk_add_f32 v[10:11],v[10:11],v[102:103]
v_pk_add_f32 v[8:9],v[8:9],v[10:11]
v_add_f32 v8,v8,v9
s_nop 1
v_add_f32_dpp v8,v8,v8 row_ror:4 row_mask:0xf bank_mask:0xf
s_nop 1
v_add_f32_dpp v8,v8,v8 row_ror:8 row_mask:0xf bank_mask:0xf
v_mov_b32 v12,v8
s_nop 1
v_permlane16_swap_b32 v12,v8
v_add_f32 v8,v8,v12
v_mov_b32 v12,v8
s_nop 1
v_permlane32_swap_b32 v12,v8
v_add_f32 v8,v8,v12
v_mul_f32 v8,0xba800000,v8
v_pk_add_f32 v[40:41],v[40:41],v[8:9] op_sel_hi:[1,0]
v_pk_add_f32 v[42:43],v[42:43],v[8:9] op_sel_hi:[1,0]
v_pk_add_f32 v[44:45],v[44:45],v[8:9] op_sel_hi:[1,0]
v_pk_add_f32 v[46:47],v[46:47],v[8:9] op_sel_hi:[1,0]
v_pk_add_f32 v[48:49],v[48:49],v[8:9] op_sel_hi:[1,0]
v_pk_add_f32 v[50:51],v[50:51],v[8:9] op_sel_hi:[1,0]
v_pk_add_f32 v[52:53],v[52:53],v[8:9] op_sel_hi:[1,0]
v_pk_add_f32 v[54:55],v[54:55],v[8:9] op_sel_hi:[1,0]
v_pk_add_f32 v[56:57],v[56:57],v[8:9] op_sel_hi:[1,0]
v_pk_add_f32 v[58:59],v[58:59],v[8:9] op_sel_hi:[1,0]
v_pk_add_f32 v[60:61],v[60:61],v[8:9] op_sel_hi:[1,0]
v_pk_add_f32 v[62:63],v[62:63],v[8:9] op_sel_hi:[1,0]
v_pk_add_f32 v[64:65],v[64:65],v[8:9] op_sel_hi:[1,0]
v_pk_add_f32 v[66:67],v[66:67],v[8:9] op_sel_hi:[1,0]
v_pk_add_f32 v[68:69],v[68:69],v[8:9] op_sel_hi:[1,0]
v_pk_add_f32 v[70:71],v[70:71],v[8:9] op_sel_hi:[1,0]
v_pk_add_f32 v[72:73],v[72:73],v[8:9] op_sel_hi:[1,0]
v_pk_add_f32 v[74:75],v[74:75],v[8:9] op_sel_hi:[1,0]
v_pk_add_f32 v[76:77],v[76:77],v[8:9] op_sel_hi:[1,0]
v_pk_add_f32 v[78:79],v[78:79],v[8:9] op_sel_hi:[1,0]
v_pk_add_f32 v[80:81],v[80:81],v[8:9] op_sel_hi:[1,0]
v_pk_add_f32 v[82:83],v[82:83],v[8:9] op_sel_hi:[1,0]
v_pk_add_f32 v[84:85],v[84:85],v[8:9] op_sel_hi:[1,0]
v_pk_add_f32 v[86:87],v[86:87],v[8:9] op_sel_hi:[1,0]
v_pk_add_f32 v[88:89],v[88:89],v[8:9] op_sel_hi:[1,0]
v_pk_add_f32 v[90:91],v[90:91],v[8:9] op_sel_hi:[1,0]
v_pk_add_f32 v[92:93],v[92:93],v[8:9] op_sel_hi:[1,0]
v_pk_add_f32 v[94:95],v[94:95],v[8:9] op_sel_hi:[1,0]
v_pk_add_f32 v[96:97],v[96:97],v[8:9] op_sel_hi:[1,0]
v_pk_add_f32 v[98:99],v[98:99],v[8:9] op_sel_hi:[1,0]
v_pk_add_f32 v[100:101],v[100:101],v[8:9] op_sel_hi:[1,0]
v_pk_add_f32 v[102:103],v[102:103],v[8:9] op_sel_hi:[1,0]
v_pk_mul_f32 v[10:11],v[40:41],v[40:41]
v_pk_mul_f32 v[14:15],v[42:43],v[42:43]
v_pk_fma_f32 v[10:11],v[44:45],v[44:45],v[10:11]
v_pk_fma_f32 v[14:15],v[46:47],v[46:47],v[14:15]
v_pk_fma_f32 v[10:11],v[48:49],v[48:49],v[10:11]
v_pk_fma_f32 v[14:15],v[50:51],v[50:51],v[14:15]
v_pk_fma_f32 v[10:11],v[52:53],v[52:53],v[10:11]
v_pk_fma_f32 v[14:15],v[54:55],v[54:55],v[14:15]
v_pk_fma_f32 v[10:11],v[56:57],v[56:57],v[10:11]
v_pk_fma_f32 v[14:15],v[58:59],v[58:59],v[14:15]
v_pk_fma_f32 v[10:11],v[60:61],v[60:61],v[10:11]
v_pk_fma_f32 v[14:15],v[62:63],v[62:63],v[14:15]
v_pk_fma_f32 v[10:11],v[64:65],v[64:65],v[10:11]
v_pk_fma_f32 v[14:15],v[66:67],v[66:67],v[14:15]
v_pk_fma_f32 v[10:11],v[68:69],v[68:69],v[10:11]
v_pk_fma_f32 v[14:15],v[70:71],v[70:71],v[14:15]
v_pk_fma_f32 v[10:11],v[72:73],v[72:73],v[10:11]
v_pk_fma_f32 v[14:15],v[74:75],v[74:75],v[14:15]
v_pk_fma_f32 v[10:11],v[76:77],v[76:77],v[10:11]
v_pk_fma_f32 v[14:15],v[78:79],v[78:79],v[14:15]
v_pk_fma_f32 v[10:11],v[80:81],v[80:81],v[10:11]
v_pk_fma_f32 v[14:15],v[82:83],v[82:83],v[14:15]
v_pk_fma_f32 v[10:11],v[84:85],v[84:85],v[10:11]
v_pk_fma_f32 v[14:15],v[86:87],v[86:87],v[14:15]
v_pk_fma_f32 v[10:11],v[88:89],v[88:89],v[10:11]
v_pk_fma_f32 v[14:15],v[90:91],v[90:91],v[14:15]
v_pk_fma_f32 v[10:11],v[92:93],v[92:93],v[10:11]
v_pk_fma_f32 v[14:15],v[94:95],v[94:95],v[14:15]
v_pk_fma_f32 v[10:11],v[96:97],v[96:97],v[10:11]
v_pk_fma_f32 v[14:15],v[98:99],v[98:99],v[14:15]
v_pk_fma_f32 v[10:11],v[100:101],v[100:101],v[10:11]
v_pk_fma_f32 v[14:15],v[102:103],v[102:103],v[14:15]
v_pk_add_f32 v[10:11],v[10:11],v[14:15]
v_add_f32 v10,v10,v11
s_nop 1
v_add_f32_dpp v10,v10,v10 row_ror:4 row_mask:0xf bank_mask:0xf
s_nop 1
v_add_f32_dpp v10,v10,v10 row_ror:8 row_mask:0xf bank_mask:0xf
v_mov_b32 v12,v10
s_nop 1
v_permlane16_swap_b32 v12,v10
v_add_f32 v10,v10,v12
v_mov_b32 v12,v10
s_nop 1
v_permlane32_swap_b32 v12,v10
v_add_f32 v10,v10,v12
v_mov_b32 v12,0x3727c5ac
v_fmac_f32 v12,0x3a800000,v10
v_rsq_f32 v10,v12
s_nop 0
v_pk_mul_f32 v[40:41],v[40:41],v[10:11] op_sel_hi:[1,0]
v_pk_mul_f32 v[42:43],v[42:43],v[10:11] op_sel_hi:[1,0]
v_pk_mul_f32 v[44:45],v[44:45],v[10:11] op_sel_hi:[1,0]
v_pk_mul_f32 v[46:47],v[46:47],v[10:11] op_sel_hi:[1,0]
v_pk_mul_f32 v[48:49],v[48:49],v[10:11] op_sel_hi:[1,0]
v_pk_mul_f32 v[50:51],v[50:51],v[10:11] op_sel_hi:[1,0]
v_pk_mul_f32 v[52:53],v[52:53],v[10:11] op_sel_hi:[1,0]
v_pk_mul_f32 v[54:55],v[54:55],v[10:11] op_sel_hi:[1,0]
v_pk_mul_f32 v[56:57],v[56:57],v[10:11] op_sel_hi:[1,0]
v_pk_mul_f32 v[58:59],v[58:59],v[10:11] op_sel_hi:[1,0]
v_pk_mul_f32 v[60:61],v[60:61],v[10:11] op_sel_hi:[1,0]
v_pk_mul_f32 v[62:63],v[62:63],v[10:11] op_sel_hi:[1,0]
v_pk_mul_f32 v[64:65],v[64:65],v[10:11] op_sel_hi:[1,0]
v_pk_mul_f32 v[66:67],v[66:67],v[10:11] op_sel_hi:[1,0]
v_pk_mul_f32 v[68:69],v[68:69],v[10:11] op_sel_hi:[1,0]
v_pk_mul_f32 v[70:71],v[70:71],v[10:11] op_sel_hi:[1,0]
v_pk_mul_f32 v[72:73],v[72:73],v[10:11] op_sel_hi:[1,0]
v_pk_mul_f32 v[74:75],v[74:75],v[10:11] op_sel_hi:[1,0]
v_pk_mul_f32 v[76:77],v[76:77],v[10:11] op_sel_hi:[1,0]
v_pk_mul_f32 v[78:79],v[78:79],v[10:11] op_sel_hi:[1,0]
v_pk_mul_f32 v[80:81],v[80:81],v[10:11] op_sel_hi:[1,0]
v_pk_mul_f32 v[82:83],v[82:83],v[10:11] op_sel_hi:[1,0]
v_pk_mul_f32 v[84:85],v[84:85],v[10:11] op_sel_hi:[1,0]
v_pk_mul_f32 v[86:87],v[86:87],v[10:11] op_sel_hi:[1,0]
v_pk_mul_f32 v[88:89],v[88:89],v[10:11] op_sel_hi:[1,0]
v_pk_mul_f32 v[90:91],v[90:91],v[10:11] op_sel_hi:[1,0]
v_pk_mul_f32 v[92:93],v[92:93],v[10:11] op_sel_hi:[1,0]
v_pk_mul_f32 v[94:95],v[94:95],v[10:11] op_sel_hi:[1,0]
v_pk_mul_f32 v[96:97],v[96:97],v[10:11] op_sel_hi:[1,0]
v_pk_mul_f32 v[98:99],v[98:99],v[10:11] op_sel_hi:[1,0]
v_pk_mul_f32 v[100:101],v[100:101],v[10:11] op_sel_hi:[1,0]
v_pk_mul_f32 v[102:103],v[102:103],v[10:11] op_sel_hi:[1,0]
v_mov_b32 v187,158976
s_cmp_lg_u32 s50,0
s_cbranch_scc1 sh0_39
s_mov_b32 s65,0
s_cmp_eq_u32 s56,1
s_cbranch_scc1 m1s_40
s_lshl_b32 s52,s55,7
s_add_u32 s52,s52,21102592
s_mov_b32 s53,0
m1l_41:
v_mov_b32 v184,0
buffer_load_dword v185,v184,s[20:23],s52 offen sc1
s_waitcnt vmcnt(0)
v_readfirstlane_b32 s64,v185
s_mov_b32 s65,0
s_cmp_eq_u32 s64,1
s_cbranch_scc1 m1ok_42
s_sub_u32 s90,s90,1
s_cmp_lt_i32 s90,0
s_cbranch_scc1 m1ok_42
s_add_u32 s53,s53,1
s_and_b32 s64,s53,31
s_cbranch_scc1 m1l_41
v_and_b32 v184,3,v1
v_bfe_u32 v185,v1,2,1
v_lshlrev_b32 v184,2,v184
v_lshl_add_u32 v184,v185,7,v184
v_writelane_b32 v184,32,8
s_mov_b64 exec,0x1ff
vpoll_43:
buffer_load_dword v185,v184,s[44:47],0 offen sc1
s_waitcnt vmcnt(0)
vfirst_46:
v_readlane_b32 s92,v185,0
v_readlane_b32 s93,v185,1
v_readlane_b32 s94,v185,2
v_readlane_b32 s95,v185,3
v_readlane_b32 s96,v185,4
v_readlane_b32 s97,v185,5
v_readlane_b32 s98,v185,6
v_readlane_b32 s99,v185,7
v_readlane_b32 s61,v185,8
s_add_u32 s64,s92,s93
s_add_u32 s64,s64,s94
s_add_u32 s64,s64,s95
s_add_u32 s64,s64,s96
s_add_u32 s64,s64,s97
s_add_u32 s64,s64,s98
s_add_u32 s64,s64,s99
s_min_u32 s65,s92,s93
s_min_u32 s66,s94,s95
s_min_u32 s65,s65,s66
s_min_u32 s66,s96,s97
s_min_u32 s65,s65,s66
s_min_u32 s66,s98,s99
s_min_u32 s65,s65,s66
s_cmp_lt_u32 s65,32
s_cselect_b32 s65,1,0
s_cmp_lt_u32 s64,256
s_cbranch_scc1 vslp_45
s_branch vgot_44
vslp_45:
s_sleep 8
s_sub_u32 s90,s90,1
s_cmp_gt_i32 s90,0
s_cbranch_scc1 vpoll_43
vgot_44:
s_mov_b64 exec,-1
s_and_b32 s61,s61,1
s_lshl_b32 s61,s61,13
s_mov_b32 s66,s54
s_cmp_gt_u32 s51,0
s_cselect_b32 s64,s92,0
s_add_u32 s66,s66,s64
s_cmp_gt_u32 s51,1
s_cselect_b32 s64,s93,0
s_add_u32 s66,s66,s64
s_cmp_gt_u32 s51,2
s_cselect_b32 s64,s94,0
s_add_u32 s66,s66,s64
s_cmp_gt_u32 s51,3
s_cselect_b32 s64,s95,0
s_add_u32 s66,s66,s64
s_cmp_gt_u32 s51,4
s_cselect_b32 s64,s96,0
s_add_u32 s66,s66,s64
s_cmp_gt_u32 s51,5
s_cselect_b32 s64,s97,0
s_add_u32 s66,s66,s64
s_cmp_gt_u32 s51,6
s_cselect_b32 s64,s98,0
s_add_u32 s66,s66,s64
s_cmp_eq_u32 s65,0
s_cbranch_scc1 m1l_41
s_branch m1ok_42
m1s_40:
s_mov_b32 s53,256
s_mov_b32 s52,164
v_mov_b32 v184,0
dp_47:
buffer_load_dword v185,v184,s[44:47],s52 offen sc1
s_waitcnt vmcnt(0)
v_cmp_ne_u32 vcc,s53,v185
s_cbranch_vccz dpok_48
s_sleep 8
s_sub_u32 s90,s90,1
s_cmp_gt_i32 s90,0
s_cbranch_scc1 dp_47
dpok_48:
m1ok_42:
v_mov_b32 v184,s65
v_mov_b32 v185,s66
v_mov_b32 v186,s61
ds_write_b96 v187,v[184:186] offset:16
s_waitcnt lgkmcnt(0)
sh0_39:
s_barrier
ds_read_b96 v[184:186],v187 offset:16
s_waitcnt lgkmcnt(0)
v_readfirstlane_b32 s65,v184
v_readfirstlane_b32 s66,v185
v_readfirstlane_b32 s61,v186
s_cmp_lg_u32 s65,0
s_cbranch_scc1 slowrole_10
s_and_b32 s56,s56,1
s_lshl_b32 s53,s56,2
s_add_u32 s53,s53,4
v_mul_u32_u24 v241,s53,v1
s_lshr_b32 s53,s55,4
s_or_b32 s53,s53,s50
s_cselect_b32 s53,0x7fff0000,32
s_mov_b64 exec,3
buffer_load_dword v240,v241,s[44:47],s53 offen sc1
s_mov_b64 exec,-1
v_lshlrev_b32 v7,5,v0
s_mov_b32 s40,24576
buffer_load_dwordx4 v[104:107],v7,s[20:23],s40 offen offset:0 sc1
buffer_load_dwordx4 v[108:111],v7,s[20:23],s40 offen offset:16 sc1
s_add_u32 s40,s40,8192
buffer_load_dwordx4 v[112:115],v7,s[20:23],s40 offen offset:0 sc1
buffer_load_dwordx4 v[116:119],v7,s[20:23],s40 offen offset:16 sc1
s_add_u32 s40,s40,8192
buffer_load_dwordx4 v[120:123],v7,s[20:23],s40 offen offset:0 sc1
buffer_load_dwordx4 v[124:127],v7,s[20:23],s40 offen offset:16 sc1
s_add_u32 s40,s40,8192
buffer_load_dwordx4 v[128:131],v7,s[20:23],s40 offen offset:0 sc1
buffer_load_dwordx4 v[132:135],v7,s[20:23],s40 offen offset:16 sc1
v_mov_b32 v14,1.0
v_cmp_lt_u32 vcc,127,v0
s_nop 1
v_cndmask_b32 v14,0,v14,vcc
s_waitcnt vmcnt(0)
v_pk_add_f32 v[104:105],v[104:105],v[112:113]
v_pk_add_f32 v[120:121],v[120:121],v[128:129]
v_pk_add_f32 v[106:107],v[106:107],v[114:115]
v_pk_add_f32 v[122:123],v[122:123],v[130:131]
v_pk_add_f32 v[108:109],v[108:109],v[116:117]
v_pk_add_f32 v[124:125],v[124:125],v[132:133]
v_pk_add_f32 v[110:111],v[110:111],v[118:119]
v_pk_add_f32 v[126:127],v[126:127],v[134:135]
v_pk_add_f32 v[104:105],v[104:105],v[120:121]
v_pk_add_f32 v[106:107],v[106:107],v[122:123]
v_pk_add_f32 v[108:109],v[108:109],v[124:125]
v_pk_add_f32 v[110:111],v[110:111],v[126:127]
v_cvt_pk_bf16_f32 v112,v104,v105
v_cvt_pk_bf16_f32 v113,v106,v107
v_cvt_pk_bf16_f32 v114,v108,v109
v_cvt_pk_bf16_f32 v115,v110,v111
v_lshlrev_b32 v104,16,v112
v_and_b32 v105,s39,v112
v_lshlrev_b32 v106,16,v113
v_and_b32 v107,s39,v113
v_lshlrev_b32 v108,16,v114
v_and_b32 v109,s39,v114
v_lshlrev_b32 v110,16,v115
v_and_b32 v111,s39,v115
v_pk_add_f32 v[104:105],v[104:105],v[14:15] op_sel_hi:[1,0]
v_pk_add_f32 v[106:107],v[106:107],v[14:15] op_sel_hi:[1,0]
v_pk_add_f32 v[108:109],v[108:109],v[14:15] op_sel_hi:[1,0]
v_pk_add_f32 v[110:111],v[110:111],v[14:15] op_sel_hi:[1,0]
ds_write_b128 v7,v[104:107] offset:4096
ds_write_b128 v7,v[108:111] offset:4112
s_waitcnt lgkmcnt(0)
s_barrier
ds_read_b128 v[104:107],v4 offset:8192
ds_read_b128 v[168:171],v4 offset:4096
ds_read_b128 v[108:111],v4 offset:8208
ds_read_b128 v[172:175],v4 offset:4112
ds_read_b128 v[112:115],v4 offset:8224
ds_read_b128 v[176:179],v4 offset:4128
ds_read_b128 v[116:119],v4 offset:8240
ds_read_b128 v[180:183],v4 offset:4144
ds_read_b128 v[120:123],v4 offset:9216
ds_read_b128 v[184:187],v4 offset:5120
ds_read_b128 v[124:127],v4 offset:9232
ds_read_b128 v[188:191],v4 offset:5136
ds_read_b128 v[128:131],v4 offset:9248
ds_read_b128 v[192:195],v4 offset:5152
ds_read_b128 v[132:135],v4 offset:9264
ds_read_b128 v[196:199],v4 offset:5168
ds_read_b128 v[136:139],v4 offset:10240
ds_read_b128 v[200:203],v4 offset:6144
ds_read_b128 v[140:143],v4 offset:10256
ds_read_b128 v[204:207],v4 offset:6160
ds_read_b128 v[144:147],v4 offset:10272
ds_read_b128 v[208:211],v4 offset:6176
ds_read_b128 v[148:151],v4 offset:10288
ds_read_b128 v[212:215],v4 offset:6192
ds_read_b128 v[152:155],v4 offset:11264
ds_read_b128 v[216:219],v4 offset:7168
ds_read_b128 v[156:159],v4 offset:11280
ds_read_b128 v[220:223],v4 offset:7184
ds_read_b128 v[160:163],v4 offset:11296
ds_read_b128 v[224:227],v4 offset:7200
ds_read_b128 v[164:167],v4 offset:11312
ds_read_b128 v[228:231],v4 offset:7216
s_waitcnt lgkmcnt(15)
v_pk_fma_f32 v[40:41],v[40:41],v[104:105],v[168:169]
v_pk_fma_f32 v[42:43],v[42:43],v[106:107],v[170:171]
v_pk_fma_f32 v[44:45],v[44:45],v[108:109],v[172:173]
v_pk_fma_f32 v[46:47],v[46:47],v[110:111],v[174:175]
v_pk_fma_f32 v[48:49],v[48:49],v[112:113],v[176:177]
v_pk_fma_f32 v[50:51],v[50:51],v[114:115],v[178:179]
v_pk_fma_f32 v[52:53],v[52:53],v[116:117],v[180:181]
v_pk_fma_f32 v[54:55],v[54:55],v[118:119],v[182:183]
v_cvt_pk_bf16_f32 v16,v40,v41
v_cvt_pk_bf16_f32 v17,v48,v49
v_cvt_pk_bf16_f32 v18,v42,v43
v_cvt_pk_bf16_f32 v19,v50,v51
buffer_store_dwordx4 v[16:19],v6,s[20:23],s37 offen offset:0 sc1
v_cvt_pk_bf16_f32 v20,v44,v45
v_cvt_pk_bf16_f32 v21,v52,v53
v_cvt_pk_bf16_f32 v22,v46,v47
v_cvt_pk_bf16_f32 v23,v54,v55
buffer_store_dwordx4 v[20:23],v6,s[20:23],s37 offen offset:256 sc1
s_waitcnt lgkmcnt(15)
v_pk_fma_f32 v[56:57],v[56:57],v[120:121],v[184:185]
v_pk_fma_f32 v[58:59],v[58:59],v[122:123],v[186:187]
v_pk_fma_f32 v[60:61],v[60:61],v[124:125],v[188:189]
v_pk_fma_f32 v[62:63],v[62:63],v[126:127],v[190:191]
v_pk_fma_f32 v[64:65],v[64:65],v[128:129],v[192:193]
v_pk_fma_f32 v[66:67],v[66:67],v[130:131],v[194:195]
v_pk_fma_f32 v[68:69],v[68:69],v[132:133],v[196:197]
v_pk_fma_f32 v[70:71],v[70:71],v[134:135],v[198:199]
v_cvt_pk_bf16_f32 v24,v56,v57
v_cvt_pk_bf16_f32 v25,v64,v65
v_cvt_pk_bf16_f32 v26,v58,v59
v_cvt_pk_bf16_f32 v27,v66,v67
s_add_u32 s37,s37,16384
buffer_store_dwordx4 v[24:27],v6,s[20:23],s37 offen offset:0 sc1
v_cvt_pk_bf16_f32 v28,v60,v61
v_cvt_pk_bf16_f32 v29,v68,v69
v_cvt_pk_bf16_f32 v30,v62,v63
v_cvt_pk_bf16_f32 v31,v70,v71
buffer_store_dwordx4 v[28:31],v6,s[20:23],s37 offen offset:256 sc1
s_waitcnt lgkmcnt(8)
v_pk_fma_f32 v[72:73],v[72:73],v[136:137],v[200:201]
v_pk_fma_f32 v[74:75],v[74:75],v[138:139],v[202:203]
v_pk_fma_f32 v[76:77],v[76:77],v[140:141],v[204:205]
v_pk_fma_f32 v[78:79],v[78:79],v[142:143],v[206:207]
v_pk_fma_f32 v[80:81],v[80:81],v[144:145],v[208:209]
v_pk_fma_f32 v[82:83],v[82:83],v[146:147],v[210:211]
v_pk_fma_f32 v[84:85],v[84:85],v[148:149],v[212:213]
v_pk_fma_f32 v[86:87],v[86:87],v[150:151],v[214:215]
v_cvt_pk_bf16_f32 v16,v72,v73
v_cvt_pk_bf16_f32 v17,v80,v81
v_cvt_pk_bf16_f32 v18,v74,v75
v_cvt_pk_bf16_f32 v19,v82,v83
s_add_u32 s37,s37,16384
buffer_store_dwordx4 v[16:19],v6,s[20:23],s37 offen offset:0 sc1
v_cvt_pk_bf16_f32 v20,v76,v77
v_cvt_pk_bf16_f32 v21,v84,v85
v_cvt_pk_bf16_f32 v22,v78,v79
v_cvt_pk_bf16_f32 v23,v86,v87
buffer_store_dwordx4 v[20:23],v6,s[20:23],s37 offen offset:256 sc1
s_waitcnt lgkmcnt(0)
v_pk_fma_f32 v[88:89],v[88:89],v[152:153],v[216:217]
v_pk_fma_f32 v[90:91],v[90:91],v[154:155],v[218:219]
v_pk_fma_f32 v[92:93],v[92:93],v[156:157],v[220:221]
v_pk_fma_f32 v[94:95],v[94:95],v[158:159],v[222:223]
v_pk_fma_f32 v[96:97],v[96:97],v[160:161],v[224:225]
v_pk_fma_f32 v[98:99],v[98:99],v[162:163],v[226:227]
v_pk_fma_f32 v[100:101],v[100:101],v[164:165],v[228:229]
v_pk_fma_f32 v[102:103],v[102:103],v[166:167],v[230:231]
v_cvt_pk_bf16_f32 v24,v88,v89
v_cvt_pk_bf16_f32 v25,v96,v97
v_cvt_pk_bf16_f32 v26,v90,v91
v_cvt_pk_bf16_f32 v27,v98,v99
s_add_u32 s37,s37,16384
buffer_store_dwordx4 v[24:27],v6,s[20:23],s37 offen offset:0 sc1
v_cvt_pk_bf16_f32 v28,v92,v93
v_cvt_pk_bf16_f32 v29,v100,v101
v_cvt_pk_bf16_f32 v30,v94,v95
v_cvt_pk_bf16_f32 v31,v102,v103
buffer_store_dwordx4 v[28:31],v6,s[20:23],s37 offen offset:256 sc1
s_waitcnt vmcnt(0)
s_barrier
v_mov_b32 v187,158976
s_cmp_lg_u32 s50,0
s_cbranch_scc1 sh0_49
s_cmp_ge_u32 s55,16
s_cbranch_scc1 nodln_50
rdl_52:
v_readlane_b32 s64,v240,0
v_readlane_b32 s65,v240,1
s_cmp_eq_u32 s56,1
s_cselect_b32 s64,2,s64
s_cmp_eq_u32 s65,128
s_cselect_b32 s64,s64,0
s_cmp_lg_u32 s64,0
s_cbranch_scc1 rdok_53
s_mov_b64 exec,3
buffer_load_dword v240,v241,s[44:47],s53 offen sc1
s_mov_b64 exec,-1
s_sub_u32 s90,s90,1
s_cmp_gt_i32 s90,0
s_waitcnt vmcnt(0)
s_cbranch_scc1 rdl_52
rdok_53:
s_lshl_b32 s65,s55,2
v_lshl_add_u32 v184,v1,7,s65
v_mov_b32 v185,s64
s_mov_b32 s64,21168128
s_mov_b32 s65,21176320
buffer_store_dword v185,v184,s[20:23],s64 offen sc1
buffer_store_dword v185,v184,s[20:23],s65 offen sc1
nodln_50:
s_mov_b32 s61,0
s_cmp_eq_u32 s56,1
s_cbranch_scc1 nopar_51
v_mov_b32 v184,0
dp_54:
buffer_load_dword v185,v184,s[44:47],32 offen sc1
s_waitcnt vmcnt(0)
v_cmp_eq_u32 vcc,0,v185
s_cbranch_vccz dpok_55
s_sleep 4
s_sub_u32 s90,s90,1
s_cmp_gt_i32 s90,0
s_cbranch_scc1 dp_54
dpok_55:
v_readfirstlane_b32 s65,v185
s_and_b32 s65,s65,1
s_lshl_b32 s61,s65,13
nopar_51:
v_mov_b32 v184,s65
v_mov_b32 v185,s66
v_mov_b32 v186,s61
ds_write_b96 v187,v[184:186] offset:16
s_waitcnt lgkmcnt(0)
sh0_49:
s_barrier
ds_read_b96 v[184:186],v187 offset:16
s_waitcnt lgkmcnt(0)
v_readfirstlane_b32 s65,v184
v_readfirstlane_b32 s66,v185
v_readfirstlane_b32 s61,v186
s_sub_u32 s55,s57,128
s_cmp_lg_u32 s50,0
s_cbranch_scc1 nsig_56
s_lshr_b32 s95,s55,4
s_lshl_b32 s95,s95,6
s_add_u32 s95,s95,21052416
s_mov_b64 exec,1
v_mov_b32 v184,112
v_mov_b32 v185,0
buffer_atomic_add v184,v185,s[20:23],s95 offen sc1
s_mov_b64 exec,-1
nsig_56:
s_branch pipe_worker
loops_7:
s_lshl_b32 s64,s50,14
s_add_u32 m0,s64,0
s_add_u32 s65,s64,57344
buffer_load_dwordx4 v16,s[20:23],s65 offen offset:0 lds
buffer_load_dwordx4 v16,s[20:23],s65 offen offset:1024 lds
buffer_load_dwordx4 v16,s[20:23],s65 offen offset:2048 lds
buffer_load_dwordx4 v16,s[20:23],s65 offen offset:3072 lds
s_add_u32 m0,s64,4096
s_add_u32 s65,s64,61440
buffer_load_dwordx4 v16,s[20:23],s65 offen offset:0 lds
buffer_load_dwordx4 v16,s[20:23],s65 offen offset:1024 lds
buffer_load_dwordx4 v16,s[20:23],s65 offen offset:2048 lds
buffer_load_dwordx4 v16,s[20:23],s65 offen offset:3072 lds
s_add_u32 m0,s64,8192
s_add_u32 s65,s64,65536
buffer_load_dwordx4 v16,s[20:23],s65 offen offset:0 lds
buffer_load_dwordx4 v16,s[20:23],s65 offen offset:1024 lds
buffer_load_dwordx4 v16,s[20:23],s65 offen offset:2048 lds
buffer_load_dwordx4 v16,s[20:23],s65 offen offset:3072 lds
s_add_u32 m0,s64,12288
s_add_u32 s65,s64,69632
buffer_load_dwordx4 v16,s[20:23],s65 offen offset:0 lds
buffer_load_dwordx4 v16,s[20:23],s65 offen offset:1024 lds
buffer_load_dwordx4 v16,s[20:23],s65 offen offset:2048 lds
buffer_load_dwordx4 v16,s[20:23],s65 offen offset:3072 lds
s_add_u32 m0,s64,65536
s_add_u32 s65,s64,122880
buffer_load_dwordx4 v16,s[20:23],s65 offen offset:0 lds
buffer_load_dwordx4 v16,s[20:23],s65 offen offset:1024 lds
buffer_load_dwordx4 v16,s[20:23],s65 offen offset:2048 lds
buffer_load_dwordx4 v16,s[20:23],s65 offen offset:3072 lds
s_add_u32 m0,s64,69632
s_add_u32 s65,s64,126976
buffer_load_dwordx4 v16,s[20:23],s65 offen offset:0 lds
buffer_load_dwordx4 v16,s[20:23],s65 offen offset:1024 lds
buffer_load_dwordx4 v16,s[20:23],s65 offen offset:2048 lds
buffer_load_dwordx4 v16,s[20:23],s65 offen offset:3072 lds
s_add_u32 m0,s64,73728
s_add_u32 s65,s64,131072
buffer_load_dwordx4 v16,s[20:23],s65 offen offset:0 lds
buffer_load_dwordx4 v16,s[20:23],s65 offen offset:1024 lds
buffer_load_dwordx4 v16,s[20:23],s65 offen offset:2048 lds
buffer_load_dwordx4 v16,s[20:23],s65 offen offset:3072 lds
s_add_u32 m0,s64,77824
s_add_u32 s65,s64,135168
buffer_load_dwordx4 v16,s[20:23],s65 offen offset:0 lds
buffer_load_dwordx4 v16,s[20:23],s65 offen offset:1024 lds
buffer_load_dwordx4 v16,s[20:23],s65 offen offset:2048 lds
buffer_load_dwordx4 v16,s[20:23],s65 offen offset:3072 lds
s_mov_b64 s[24:25],s[20:21]
s_mov_b64 s[28:29],s[20:21]
s_mov_b32 s27,0x20000
s_mov_b32 s31,0x20000
s_cmp_eq_u32 s56,0
s_cselect_b32 s26,s22,0
s_cselect_b32 s30,0,s22
s_lshl_b32 s64,s58,14
s_add_u32 s64,s64,23068672
v_add_u32 v26,s64,v16
v_add_u32 v27,4096,v26
v_add_u32 v28,8192,v26
v_add_u32 v29,12288,v26
s_lshl_b32 s65,s59,9
s_add_u32 s66,s64,s65
s_lshl_b32 s64,s58,7
s_add_u32 s64,s64,23592960
v_and_b32 v18,31,v1
v_lshl_add_u32 v18,v18,2,s64
s_lshl_b32 s65,s59,2
s_add_u32 s64,s64,s65
v_mov_b32 v13,s64
v_mov_b32 v14,0x4444
v_mov_b32 v22,0xeeee
v_cmp_lt_u32 vcc,7,v3
s_nop 1
v_cndmask_b32 v14,v14,v22,vcc
v_and_b32 v22,1,v3
v_cmp_eq_u32 vcc,0,v22
v_mov_b32 v15,0x03020706
v_mov_b32 v23,0x05040100
v_cndmask_b32 v15,v15,v23,vcc
v_lshlrev_b32 v19,5,v22
v_lshl_add_u32 v19,v4,6,v19
v_lshrrev_b32 v23,1,v3
v_lshl_add_u32 v19,v23,2,v19
s_lshl_b32 s67,s57,10
s_add_u32 s67,s67,23199744
s_lshl_b32 s64,s50,2
s_lshr_b32 s64,0x1320,s64
s_and_b32 s64,s64,3
s_lshl_b32 s64,s64,8
s_add_u32 s64,s64,s67
v_add_u32 v19,s64,v19
v_add_u32 v24,131072,v16
v_mov_b32 v21,158720
v_mov_b32 v25,0
v_mov_b32 v20,v16
v_and_b32 v22,1,v4
v_lshrrev_b32 v23,1,v4
v_lshl_add_u32 v23,v23,4,v3
v_lshlrev_b32 v23,4,v23
v_lshl_add_u32 v23,v22,10,v23
s_lshr_b32 s64,s50,1
s_lshl_b32 s64,s64,9
v_add_u32 v23,s64,v23
s_lshr_b32 s64,s57,2
s_add_u32 s65,s64,32
s_lshl_b32 s65,s65,14
s_and_b32 s68,s57,3
s_lshl_b32 s68,s68,11
s_add_u32 s65,s65,s68
s_add_u32 s65,s65,29360128
v_add_u32 v17,s65,v23
s_lshl_b32 s69,s57,11
s_add_u32 s69,s69,23330816
v_add_u32 v2,s69,v23
s_mov_b32 s81,0x3e0293ee
s_mov_b32 s84,0xff00ff
s_mov_b32 s85,0xff00ff
s_mov_b32 s86,0x33333333
s_mov_b32 s87,0x33333333
s_mov_b32 s62,0x10000
s_mov_b32 s79,-2
ds_write_b32 v21,v25
ds_write_b32 v21,v25 offset:4
ds_write_b32 v21,v25 offset:8
ds_write_b32 v21,v25 offset:12
ds_write_b32 v21,v25 offset:16
ds_write_b32 v21,v25 offset:24
ds_write_b32 v21,v25 offset:28
v_mov_b32 v100,0
v_mov_b32 v101,0
v_mov_b32 v102,0
v_mov_b32 v103,0
s_lshr_b32 s64,s59,3
s_lshl_b32 s64,s64,14
s_and_b32 s65,s59,7
s_lshl_b32 s65,s65,10
s_add_u32 s64,s64,s65
s_lshl_b32 s65,s58,16
s_add_u32 s64,s64,s65
s_add_u32 s64,s64,31195136
v_add_u32 v8,s64,v16
s_cmp_eq_u32 s50,3
s_cbranch_scc1 w3_61
s_cmp_eq_u32 s50,1
s_cbranch_scc1 w1_59
s_cmp_eq_u32 s50,2
s_cbranch_scc1 w2_60
w0_58:
v_and_b32 v22,7,v3
v_lshrrev_b32 v23,2,v22
v_and_b32 v5,2,v22
v_or_b32 v23,v23,v5
v_and_b32 v5,1,v22
v_lshl_add_u32 v23,v23,1,v5
v_lshlrev_b32 v23,5,v23
v_lshrrev_b32 v5,3,v3
v_lshl_add_u32 v23,v5,9,v23
v_lshrrev_b32 v5,1,v4
v_lshl_add_u32 v23,v5,8,v23
v_and_b32 v5,1,v4
v_lshl_add_u32 v23,v5,4,v23
v_add_u32 v8,s67,v23
v_xor_b32 v9,1024,v8
v_xor_b32 v10,2048,v8
v_xor_b32 v11,3072,v8
v_lshlrev_b32 v31,4,v3
v_lshl_add_u32 v31,v5,3,v31
v_add_u32 v31,155648,v31
v_lshl_add_u32 v23,v4,3,v22
v_lshlrev_b32 v23,4,v23
v_add_u32 v12,155648,v23
v_add_u32 v30,s66,v23
v_cmp_gt_u32 vcc,8,v3
v_cmp_lt_u32 s[52:53],1,v4
s_and_b64 vcc,vcc,s[52:53]
v_mov_b32 v22,0xf149f2ca
v_cndmask_b32 v156,v22,0,vcc
v_mov_b32 v157,v156
v_mov_b32 v158,v156
v_mov_b32 v159,v156
v_add_u32 v2,s69,v16
v_xor_b32 v5,2048,v2
v_xor_b32 v6,4096,v2
v_xor_b32 v7,6144,v2
s_lshr_b32 s64,s57,3
s_add_u32 s64,s64,96
s_lshl_b32 s64,s64,14
s_and_b32 s65,s57,7
s_lshl_b32 s65,s65,10
s_add_u32 s64,s64,s65
s_add_u32 s64,s64,29360128
v_add_u32 v3,s64,v16
v_mov_b32 v136,0
v_mov_b32 v137,0
v_mov_b32 v138,0
v_mov_b32 v139,0
v_mov_b32 v140,0
v_mov_b32 v141,0
v_mov_b32 v142,0
v_mov_b32 v143,0
v_mov_b32 v144,0
v_mov_b32 v145,0
v_mov_b32 v146,0
v_mov_b32 v147,0
v_mov_b32 v152,0x3f803f80
v_mov_b32 v153,0x3f803f80
v_mov_b32 v154,0x3f803f80
v_mov_b32 v155,0x3f803f80
s_branch first_62
loop_63:
s_barrier
buffer_load_dword v248,v18,s[20:23],s70 offen offset:0 sc1
s_nop 15
s_nop 5
hl_65:
buffer_load_dword v249,v18,s[20:23],s70 offen offset:0 sc1
s_waitcnt vmcnt(1)
v_cmp_eq_u32 vcc,v25,v248
s_bcnt1_i32_b32 s64,vcc_lo
s_cmp_ge_u32 s64,8
s_cbranch_scc1 hg_66
buffer_load_dword v248,v18,s[20:23],s70 offen offset:0 sc1
s_waitcnt vmcnt(1)
v_cmp_eq_u32 vcc,v25,v249
s_bcnt1_i32_b32 s64,vcc_lo
s_cmp_ge_u32 s64,8
s_cbranch_scc1 hg_66
s_sub_u32 s90,s90,1
s_cmp_gt_i32 s90,0
s_cbranch_scc1 hl_65
hg_66:
buffer_load_dwordx4 v[32:35],v26,s[20:23],s70 offen offset:0 sc1
buffer_load_dwordx4 v[36:39],v26,s[20:23],s70 offen offset:1024 sc1
buffer_load_dwordx4 v[40:43],v26,s[20:23],s70 offen offset:2048 sc1
buffer_load_dwordx4 v[44:47],v26,s[20:23],s70 offen offset:3072 sc1
s_waitcnt vmcnt(3)
ds_write_b128 v24,v[32:35] offset:0
v_min3_u32 v22,v32,v33,v34
v_min_u32 v22,v22,v35
s_waitcnt vmcnt(2)
ds_write_b128 v24,v[36:39] offset:1024
v_min3_u32 v22,v22,v36,v37
v_min3_u32 v22,v22,v38,v39
s_waitcnt vmcnt(1)
ds_write_b128 v24,v[40:43] offset:2048
v_min3_u32 v22,v22,v40,v41
v_min3_u32 v22,v22,v42,v43
s_waitcnt vmcnt(0)
ds_write_b128 v24,v[44:47] offset:3072
v_min3_u32 v22,v22,v44,v45
v_min3_u32 v22,v22,v46,v47
v_cmp_eq_u32 vcc,0,v22
s_cbranch_vccnz art_67
abk_68:
v_smfmac_f32_16x16x64_bf16 v[176:179],v[32:35],a[0:7],v14
s_waitcnt lgkmcnt(0)
s_barrier
ds_read_b128 v[48:51],v24 offset:4096
ds_read_b128 v[52:55],v24 offset:5120
ds_read_b128 v[56:59],v24 offset:6144
ds_read_b128 v[60:63],v24 offset:7168
v_smfmac_f32_16x16x64_bf16 v[176:179],v[36:39],a[8:15],v14
ds_read_b128 v[64:67],v24 offset:8192
ds_read_b128 v[68:71],v24 offset:9216
v_smfmac_f32_16x16x64_bf16 v[176:179],v[40:43],a[16:23],v14
ds_read_b128 v[72:75],v24 offset:10240
ds_read_b128 v[76:79],v24 offset:11264
v_smfmac_f32_16x16x64_bf16 v[176:179],v[44:47],a[24:31],v14
ds_read_b128 v[80:83],v24 offset:12288
ds_read_b128 v[84:87],v24 offset:13312
s_waitcnt lgkmcnt(9)
v_smfmac_f32_16x16x64_bf16 v[176:179],v[48:51],a[32:39],v14
ds_read_b128 v[88:91],v24 offset:14336
s_waitcnt lgkmcnt(9)
v_smfmac_f32_16x16x64_bf16 v[176:179],v[52:55],a[40:47],v14
ds_read_b128 v[92:95],v24 offset:15360
s_waitcnt lgkmcnt(9)
v_smfmac_f32_16x16x64_bf16 v[176:179],v[56:59],a[48:55],v14
s_waitcnt lgkmcnt(8)
v_smfmac_f32_16x16x64_bf16 v[176:179],v[60:63],a[56:63],v14
s_waitcnt lgkmcnt(7)
v_smfmac_f32_16x16x64_bf16 v[176:179],v[64:67],a[64:71],v14
s_waitcnt lgkmcnt(6)
v_smfmac_f32_16x16x64_bf16 v[176:179],v[68:71],a[72:79],v14
s_waitcnt lgkmcnt(5)
v_smfmac_f32_16x16x64_bf16 v[176:179],v[72:75],a[80:87],v14
s_waitcnt lgkmcnt(4)
v_smfmac_f32_16x16x64_bf16 v[176:179],v[76:79],a[88:95],v14
s_waitcnt lgkmcnt(3)
v_smfmac_f32_16x16x64_bf16 v[176:179],v[80:83],a[96:103],v14
s_waitcnt lgkmcnt(2)
v_smfmac_f32_16x16x64_bf16 v[176:179],v[84:87],a[104:111],v14
s_waitcnt lgkmcnt(1)
v_smfmac_f32_16x16x64_bf16 v[176:179],v[88:91],a[112:119],v14
s_waitcnt lgkmcnt(0)
v_smfmac_f32_16x16x64_bf16 v[176:179],v[92:95],a[120:127],v14
s_nop 7
v_permlane32_swap_b32 v176,v178
v_permlane32_swap_b32 v177,v179
v_add_f32 v176,v176,v178
v_add_f32 v177,v177,v179
v_cvt_pk_bf16_f32 v216,v176,v177
s_nop 1
v_mov_b32_dpp v217,v216 quad_perm:[1,0,3,2] row_mask:0xf bank_mask:0xf
v_perm_b32 v216,v217,v216,v15
v_max_u32 v216,1,v216
buffer_store_dword v216,v19,s[24:27],s70 offen
buffer_store_dword v216,v19,s[28:31],s70 offen sc1
s_lshr_b32 s64,s70,9
v_add_u32 v22,s64,v24
s_cmp_eq_u32 s79,0
ds_read_b128 v[128:131],v22 offset:16384
ds_read_b128 v[132:135],v22 offset:17408
s_cbranch_scc1 kt0_69
kt0b_70:
s_nop 15
s_nop 15
s_nop 11
buffer_load_dwordx4 v[32:35],v8,s[20:23],s70 offen sc1
buffer_load_dwordx4 v[36:39],v9,s[20:23],s70 offen sc1
buffer_load_dwordx4 v[40:43],v10,s[20:23],s70 offen sc1
buffer_load_dwordx4 v[44:47],v11,s[20:23],s70 offen sc1
s_nop 9
scp_71:
buffer_load_dwordx4 v[48:51],v8,s[20:23],s70 offen sc1
buffer_load_dwordx4 v[52:55],v9,s[20:23],s70 offen sc1
buffer_load_dwordx4 v[56:59],v10,s[20:23],s70 offen sc1
buffer_load_dwordx4 v[60:63],v11,s[20:23],s70 offen sc1
s_waitcnt vmcnt(4)
v_mfma_f32_16x16x32_bf16 v[168:171],v[32:35],v[32:35],v[156:159]
v_min3_u32 v22,v32,v33,v34
v_min3_u32 v22,v22,v35,v36
v_mfma_f32_16x16x32_bf16 v[164:167],v[100:103],v[32:35],0
v_min3_u32 v22,v22,v37,v38
v_min3_u32 v22,v22,v39,v40
v_mfma_f32_16x16x32_bf16 v[160:163],v[96:99],v[32:35],0
v_min3_u32 v22,v22,v41,v42
v_min3_u32 v22,v22,v43,v44
v_mfma_f32_16x16x32_bf16 v[168:171],v[36:39],v[36:39],v[168:171]
v_min3_u32 v22,v22,v45,v46
v_min_u32 v22,v22,v47
v_mfma_f32_16x16x32_bf16 v[164:167],v[108:111],v[36:39],v[164:167]
v_cmp_eq_u32 vcc,0,v22
s_cbranch_vccnz nx_73
v_mfma_f32_16x16x32_bf16 v[160:163],v[104:107],v[36:39],v[160:163]
v_mov_b32 v172,v32
v_mfma_f32_16x16x32_bf16 v[168:171],v[40:43],v[40:43],v[168:171]
v_mov_b32 v173,v33
v_mfma_f32_16x16x32_bf16 v[164:167],v[116:119],v[40:43],v[164:167]
v_mov_b32 v174,v34
v_mfma_f32_16x16x32_bf16 v[160:163],v[112:115],v[40:43],v[160:163]
v_mov_b32 v175,v35
v_mfma_f32_16x16x32_bf16 v[168:171],v[44:47],v[44:47],v[168:171]
v_mfma_f32_16x16x32_bf16 v[164:167],v[124:127],v[44:47],v[164:167]
v_mfma_f32_16x16x32_bf16 v[160:163],v[120:123],v[44:47],v[160:163]
s_nop 1
s_branch scok_72
nx_73:
buffer_load_dwordx4 v[32:35],v8,s[20:23],s70 offen sc1
buffer_load_dwordx4 v[36:39],v9,s[20:23],s70 offen sc1
buffer_load_dwordx4 v[40:43],v10,s[20:23],s70 offen sc1
buffer_load_dwordx4 v[44:47],v11,s[20:23],s70 offen sc1
s_waitcnt vmcnt(4)
v_mfma_f32_16x16x32_bf16 v[168:171],v[48:51],v[48:51],v[156:159]
v_min3_u32 v22,v48,v49,v50
v_min3_u32 v22,v22,v51,v52
v_mfma_f32_16x16x32_bf16 v[164:167],v[100:103],v[48:51],0
v_min3_u32 v22,v22,v53,v54
v_min3_u32 v22,v22,v55,v56
v_mfma_f32_16x16x32_bf16 v[160:163],v[96:99],v[48:51],0
v_min3_u32 v22,v22,v57,v58
v_min3_u32 v22,v22,v59,v60
v_mfma_f32_16x16x32_bf16 v[168:171],v[52:55],v[52:55],v[168:171]
v_min3_u32 v22,v22,v61,v62
v_min_u32 v22,v22,v63
v_mfma_f32_16x16x32_bf16 v[164:167],v[108:111],v[52:55],v[164:167]
v_cmp_eq_u32 vcc,0,v22
s_cbranch_vccnz nx_74
v_mfma_f32_16x16x32_bf16 v[160:163],v[104:107],v[52:55],v[160:163]
v_mov_b32 v172,v48
v_mfma_f32_16x16x32_bf16 v[168:171],v[56:59],v[56:59],v[168:171]
v_mov_b32 v173,v49
v_mfma_f32_16x16x32_bf16 v[164:167],v[116:119],v[56:59],v[164:167]
v_mov_b32 v174,v50
v_mfma_f32_16x16x32_bf16 v[160:163],v[112:115],v[56:59],v[160:163]
v_mov_b32 v175,v51
v_mfma_f32_16x16x32_bf16 v[168:171],v[60:63],v[60:63],v[168:171]
v_mfma_f32_16x16x32_bf16 v[164:167],v[124:127],v[60:63],v[164:167]
v_mfma_f32_16x16x32_bf16 v[160:163],v[120:123],v[60:63],v[160:163]
s_nop 1
s_branch scok_72
nx_74:
s_sub_u32 s90,s90,1
s_cmp_gt_i32 s90,0
s_cbranch_scc1 scp_71
s_nop 7
scok_72:
ds_read_b64 v[220:221],v21
ds_read_b64 v[136:137],v31
ds_read_b64 v[140:141],v31 offset:256
s_cmp_ge_u32 s79,62
s_cbranch_scc1 ke_76
keb_77:
v_max3_f32 v216,v168,v169,v170
v_mov_b32_dpp v160,v164 row_ror:8 row_mask:0xf bank_mask:0xc
v_mov_b32_dpp v161,v165 row_ror:8 row_mask:0xf bank_mask:0xc
v_mov_b32_dpp v162,v166 row_ror:8 row_mask:0xf bank_mask:0xc
v_mov_b32_dpp v163,v167 row_ror:8 row_mask:0xf bank_mask:0xc
v_max3_f32 v217,v171,v160,v161
v_max3_f32 v216,v216,v162,v163
v_max_f32 v216,v216,v217
s_nop 1
v_max_f32_dpp v216,v216,v216 row_ror:8 row_mask:0xf bank_mask:0xf
v_mov_b32 v217,v216
s_nop 1
v_permlane16_swap_b32 v217,v216
v_max_f32 v216,v216,v217
v_mov_b32 v217,v216
s_nop 1
v_permlane32_swap_b32 v217,v216
v_max_f32 v216,v216,v217
v_mul_f32 v216,s81,v216
v_fma_f32 v160,v160,s81,-v216
v_fma_f32 v161,v161,s81,-v216
v_fma_f32 v162,v162,s81,-v216
v_fma_f32 v163,v163,s81,-v216
v_fma_f32 v168,v168,s81,-v216
v_fma_f32 v169,v169,s81,-v216
v_fma_f32 v170,v170,s81,-v216
v_fma_f32 v171,v171,s81,-v216
v_exp_f32 v160,v160
v_exp_f32 v161,v161
v_exp_f32 v162,v162
v_exp_f32 v163,v163
v_exp_f32 v168,v168
v_exp_f32 v169,v169
v_exp_f32 v170,v170
v_exp_f32 v171,v171
v_cvt_pk_bf16_f32 v148,v160,v161
v_cvt_pk_bf16_f32 v149,v162,v163
v_cvt_pk_bf16_f32 v144,v168,v169
v_mov_b32_dpp v150,v148 row_ror:8 row_mask:0xf bank_mask:0xf
v_mov_b32_dpp v151,v149 row_ror:8 row_mask:0xf bank_mask:0xf
v_cvt_pk_bf16_f32 v145,v170,v171
s_waitcnt lgkmcnt(0)
v_min_u32 v220,v220,v221
v_mfma_f32_16x16x32_bf16 v[232:235],v[152:155],v[148:151],0
v_cmp_ne_u32 vcc,v220,v25
v_mfma_f32_16x16x32_bf16 v[232:235],v[152:155],v[144:147],v[232:235]
v_mfma_f32_16x16x32_bf16 v[224:227],v[128:131],v[148:151],0
v_mfma_f32_16x16x32_bf16 v[228:231],v[132:135],v[148:151],0
s_cbranch_vccnz vw_78
vb_79:
v_mfma_f32_16x16x32_bf16 v[224:227],v[136:139],v[144:147],v[224:227]
v_mfma_f32_16x16x32_bf16 v[228:231],v[140:143],v[144:147],v[228:231]
s_mov_b64 exec,s[84:85]
s_nop 1
v_rcp_f32 v236,v232
s_nop 2
v_pk_mul_f32 v[224:225],v[224:225],v[236:237] op_sel_hi:[1,0]
v_pk_mul_f32 v[226:227],v[226:227],v[236:237] op_sel_hi:[1,0]
v_pk_mul_f32 v[228:229],v[228:229],v[236:237] op_sel_hi:[1,0]
v_pk_mul_f32 v[230:231],v[230:231],v[236:237] op_sel_hi:[1,0]
v_cvt_pk_bf16_f32 v216,v224,v225
v_cvt_pk_bf16_f32 v217,v226,v227
v_cvt_pk_bf16_f32 v218,v228,v229
v_cvt_pk_bf16_f32 v219,v230,v231
v_max_u32 v216,1,v216
v_max_u32 v217,1,v217
v_max_u32 v218,1,v218
v_max_u32 v219,1,v219
buffer_store_dwordx4 v[216:219],v30,s[24:27],s71 offen
buffer_store_dwordx4 v[216:219],v30,s[28:31],s71 offen sc1
s_mov_b64 exec,1
buffer_store_dword v25,v13,s[24:27],s70 offen offset:512
buffer_store_dword v25,v13,s[28:31],s70 offen offset:512 sc1
s_mov_b64 exec,-1
ds_write_b32 v21,v25 offset:8
hl_80:
buffer_load_dword v248,v18,s[20:23],s70 offen offset:512 sc1
s_waitcnt vmcnt(0)
v_cmp_eq_u32 vcc,v25,v248
s_bcnt1_i32_b32 s64,vcc_lo
s_cmp_ge_u32 s64,16
s_cbranch_scc1 hg_81
s_sub_u32 s90,s90,1
s_cmp_gt_i32 s90,0
s_cbranch_scc1 hl_80
hg_81:
buffer_load_dwordx4 v[32:35],v26,s[20:23],s71 offen offset:0 sc1
buffer_load_dwordx4 v[36:39],v26,s[20:23],s71 offen offset:1024 sc1
buffer_load_dwordx4 v[40:43],v26,s[20:23],s71 offen offset:2048 sc1
buffer_load_dwordx4 v[44:47],v26,s[20:23],s71 offen offset:3072 sc1
buffer_load_dwordx4 v[48:51],v27,s[20:23],s71 offen offset:0 sc1
buffer_load_dwordx4 v[52:55],v27,s[20:23],s71 offen offset:1024 sc1
buffer_load_dwordx4 v[56:59],v27,s[20:23],s71 offen offset:2048 sc1
buffer_load_dwordx4 v[60:63],v27,s[20:23],s71 offen offset:3072 sc1
s_mov_b32 s68,0
s_waitcnt vmcnt(6)
v_smfmac_f32_16x16x64_bf16 v[184:187],v[32:35],a[128:135],v14
v_min3_u32 v22,v32,v33,v34
v_min3_u32 v22,v22,v35,v36
v_smfmac_f32_16x16x64_bf16 v[188:191],v[32:35],a[136:143],v14
v_min3_u32 v22,v22,v37,v38
v_smfmac_f32_16x16x64_bf16 v[184:187],v[36:39],a[144:151],v14
v_min_u32 v22,v22,v39
v_smfmac_f32_16x16x64_bf16 v[188:191],v[36:39],a[152:159],v14
v_cmp_eq_u32 s[52:53],0,v22
s_waitcnt vmcnt(4)
v_smfmac_f32_16x16x64_bf16 v[184:187],v[40:43],a[160:167],v14
v_min3_u32 v22,v40,v41,v42
s_cmp_lg_u64 s[52:53],0
v_smfmac_f32_16x16x64_bf16 v[188:191],v[40:43],a[168:175],v14
s_cbranch_scc1 ms_82
bk_83:
v_min3_u32 v22,v22,v43,v44
v_smfmac_f32_16x16x64_bf16 v[184:187],v[44:47],a[176:183],v14
v_min3_u32 v22,v22,v45,v46
v_min_u32 v22,v22,v47
v_smfmac_f32_16x16x64_bf16 v[188:191],v[44:47],a[184:191],v14
v_cmp_eq_u32 s[54:55],0,v22
s_waitcnt vmcnt(2)
v_smfmac_f32_16x16x64_bf16 v[184:187],v[48:51],a[192:199],v14
v_min3_u32 v22,v48,v49,v50
s_cmp_lg_u64 s[54:55],0
v_smfmac_f32_16x16x64_bf16 v[188:191],v[48:51],a[200:207],v14
s_cbranch_scc1 ms_84
bk_85:
v_min3_u32 v22,v22,v51,v52
v_smfmac_f32_16x16x64_bf16 v[184:187],v[52:55],a[208:215],v14
v_min3_u32 v22,v22,v53,v54
v_min_u32 v22,v22,v55
v_smfmac_f32_16x16x64_bf16 v[188:191],v[52:55],a[216:223],v14
v_cmp_eq_u32 s[52:53],0,v22
s_waitcnt vmcnt(0)
v_smfmac_f32_16x16x64_bf16 v[184:187],v[56:59],a[224:231],v14
v_min3_u32 v22,v56,v57,v58
s_cmp_lg_u64 s[52:53],0
v_smfmac_f32_16x16x64_bf16 v[188:191],v[56:59],a[232:239],v14
s_cbranch_scc1 ms_86
bk_87:
v_min3_u32 v22,v22,v59,v60
v_smfmac_f32_16x16x64_bf16 v[184:187],v[60:63],a[240:247],v14
v_min3_u32 v22,v22,v61,v62
v_min_u32 v22,v22,v63
v_smfmac_f32_16x16x64_bf16 v[188:191],v[60:63],a[248:255],v14
v_cmp_eq_u32 s[54:55],0,v22
s_cmp_lg_u64 s[54:55],0
s_cbranch_scc1 ms_90
bk_91:
s_cmp_lg_u32 s68,0
s_cbranch_scc1 rl2_92
fin_88:
s_nop 2
v_permlane32_swap_b32 v184,v188
v_permlane32_swap_b32 v185,v189
v_permlane32_swap_b32 v186,v190
v_permlane32_swap_b32 v187,v191
v_pk_add_f32 v[184:185],v[184:185],v[188:189]
v_pk_add_f32 v[186:187],v[186:187],v[190:191]
ds_write_b128 v24,v[184:187] offset:25600
ds_write_b32 v21,v25 offset:12
s_mov_b64 exec,s[84:85]
ds_read_b128 v[172:175],v12
s_mov_b64 exec,-1
ds_read_b64 v[220:221],v21 offset:24
buffer_load_dwordx4 v[96:99],v2,s[20:23],s72 offen offset:0 sc1
buffer_load_dwordx4 v[100:103],v2,s[20:23],s72 offen offset:1024 sc1
buffer_load_dwordx4 v[104:107],v5,s[20:23],s72 offen offset:0 sc1
buffer_load_dwordx4 v[108:111],v5,s[20:23],s72 offen offset:1024 sc1
buffer_load_dwordx4 v[112:115],v6,s[20:23],s72 offen offset:0 sc1
buffer_load_dwordx4 v[116:119],v6,s[20:23],s72 offen offset:1024 sc1
buffer_load_dwordx4 v[120:123],v7,s[20:23],s72 offen offset:0 sc1
buffer_load_dwordx4 v[124:127],v7,s[20:23],s72 offen offset:1024 sc1
s_waitcnt lgkmcnt(0)
v_min_u32 v220,v220,v221
v_cmp_ne_u32 vcc,v220,v25
s_cbranch_vccnz v2w_93
v2b_94:
buffer_store_dwordx4 v[172:175],v3,s[20:23],s77 offen sc1
s_xor_b32 s62,s62,0x10000
s_add_u32 s63,s79,1
s_and_b32 s64,s63,3
s_lshl_b32 s70,s64,20
s_add_u32 s65,s63,2
s_and_b32 s65,s65,3
s_lshl_b32 s73,s65,20
s_add_u32 s55,s63,3
s_lshl_b32 s78,s55,16
s_add_u32 s78,s78,57344
s_cmp_lt_u32 s55,64
s_cselect_b32 s78,s78,0x7fff0000
s_add_u32 s71,s70,65536
s_add_u32 s60,s63,1
s_and_b32 s60,s60,3
s_lshl_b32 s72,s60,20
v_mov_b32 v184,0
v_mov_b32 v185,0
v_mov_b32 v186,0
v_mov_b32 v187,0
v_mov_b32 v188,0
v_mov_b32 v189,0
v_mov_b32 v190,0
v_mov_b32 v191,0
s_lshl_b32 s77,s63,21
s_lshl_b32 s55,s63,13
s_and_b32 s55,s55,0x2000
s_xor_b32 s55,s55,s61
s_add_u32 s77,s77,s55
v_mov_b32 v176,0
v_mov_b32 v177,0
v_mov_b32 v178,0
v_mov_b32 v179,0
s_add_u32 s79,s79,1
v_add_u32 v25,1,v25
s_waitcnt vmcnt(0) lgkmcnt(0)
s_branch loop_63
last0_75:
wf_95:
ds_read_b32 v23,v21 offset:0
s_sub_u32 s90,s90,1
s_waitcnt lgkmcnt(0)
v_cmp_ne_u32 vcc,v23,v25
s_cmp_lt_i32 s90,0
s_cselect_b64 vcc,0,vcc
s_cbranch_vccnz wf_95
wf_96:
ds_read_b32 v23,v21 offset:4
s_sub_u32 s90,s90,1
s_waitcnt lgkmcnt(0)
v_cmp_ne_u32 vcc,v23,v25
s_cmp_lt_i32 s90,0
s_cselect_b64 vcc,0,vcc
s_cbranch_vccnz wf_96
s_mov_b64 exec,s[84:85]
ds_read_b128 v[172:175],v12
s_mov_b64 exec,-1
s_waitcnt lgkmcnt(0)
buffer_store_dwordx4 v[172:175],v3,s[20:23],s77 offen sc1
s_branch end_57
art_67:
s_sub_u32 s90,s90,1
s_cmp_lt_i32 s90,0
s_cbranch_scc1 abk_68
buffer_load_dwordx4 v[32:35],v26,s[20:23],s70 offen offset:0 sc1
buffer_load_dwordx4 v[36:39],v26,s[20:23],s70 offen offset:1024 sc1
buffer_load_dwordx4 v[40:43],v26,s[20:23],s70 offen offset:2048 sc1
buffer_load_dwordx4 v[44:47],v26,s[20:23],s70 offen offset:3072 sc1
s_waitcnt vmcnt(3)
ds_write_b128 v24,v[32:35] offset:0
v_min3_u32 v22,v32,v33,v34
v_min_u32 v22,v22,v35
s_waitcnt vmcnt(2)
ds_write_b128 v24,v[36:39] offset:1024
v_min3_u32 v22,v22,v36,v37
v_min3_u32 v22,v22,v38,v39
s_waitcnt vmcnt(1)
ds_write_b128 v24,v[40:43] offset:2048
v_min3_u32 v22,v22,v40,v41
v_min3_u32 v22,v22,v42,v43
s_waitcnt vmcnt(0)
ds_write_b128 v24,v[44:47] offset:3072
v_min3_u32 v22,v22,v44,v45
v_min3_u32 v22,v22,v46,v47
v_cmp_eq_u32 vcc,0,v22
s_cbranch_vccnz art_67
s_branch abk_68
kt0_69:
buffer_load_dwordx4 v[96:99],v2,s[20:23],s70 offen offset:0 sc1
buffer_load_dwordx4 v[100:103],v2,s[20:23],s70 offen offset:1024 sc1
buffer_load_dwordx4 v[104:107],v5,s[20:23],s70 offen offset:0 sc1
buffer_load_dwordx4 v[108:111],v5,s[20:23],s70 offen offset:1024 sc1
buffer_load_dwordx4 v[112:115],v6,s[20:23],s70 offen offset:0 sc1
buffer_load_dwordx4 v[116:119],v6,s[20:23],s70 offen offset:1024 sc1
buffer_load_dwordx4 v[120:123],v7,s[20:23],s70 offen offset:0 sc1
buffer_load_dwordx4 v[124:127],v7,s[20:23],s70 offen offset:1024 sc1
s_branch kt0b_70
ke_76:
s_cmp_eq_u32 s79,63
s_cbranch_scc1 last0_75
ds_read_b64 v[222:223],v21 offset:24
s_mov_b64 exec,s[84:85]
ds_read_b128 v[172:175],v12
s_mov_b64 exec,-1
s_waitcnt lgkmcnt(0)
v_min3_u32 v222,v222,v223,v220
v_min_u32 v222,v222,v221
v_cmp_ne_u32 vcc,v222,v25
s_cbranch_vccnz keb_77
buffer_store_dwordx4 v[172:175],v3,s[20:23],s77 offen sc1
s_mov_b32 s77,0x7fff0000
s_branch keb_77
vw_78:
wf_97:
ds_read_b32 v23,v21 offset:0
s_sub_u32 s90,s90,1
s_waitcnt lgkmcnt(0)
v_cmp_ne_u32 vcc,v23,v25
s_cmp_lt_i32 s90,0
s_cselect_b64 vcc,0,vcc
s_cbranch_vccnz wf_97
wf_98:
ds_read_b32 v23,v21 offset:4
s_sub_u32 s90,s90,1
s_waitcnt lgkmcnt(0)
v_cmp_ne_u32 vcc,v23,v25
s_cmp_lt_i32 s90,0
s_cselect_b64 vcc,0,vcc
s_cbranch_vccnz wf_98
ds_read_b64 v[220:221],v21
ds_read_b64 v[136:137],v31
ds_read_b64 v[140:141],v31 offset:256
s_waitcnt lgkmcnt(0)
s_branch vb_79
ms_82:
s_waitcnt vmcnt(0)
buffer_load_dwordx4 v[64:67],v26,s[20:23],s71 offen offset:0 sc1
buffer_load_dwordx4 v[68:71],v26,s[20:23],s71 offen offset:1024 sc1
s_bitset1_b32 s68,0
s_branch bk_83
ms_84:
s_waitcnt vmcnt(0)
buffer_load_dwordx4 v[72:75],v26,s[20:23],s71 offen offset:2048 sc1
buffer_load_dwordx4 v[76:79],v26,s[20:23],s71 offen offset:3072 sc1
s_bitset1_b32 s68,1
s_branch bk_85
ms_86:
s_waitcnt vmcnt(0)
buffer_load_dwordx4 v[80:83],v27,s[20:23],s71 offen offset:0 sc1
buffer_load_dwordx4 v[84:87],v27,s[20:23],s71 offen offset:1024 sc1
s_bitset1_b32 s68,2
s_branch bk_87
ms_90:
s_waitcnt vmcnt(0)
buffer_load_dwordx4 v[88:91],v27,s[20:23],s71 offen offset:2048 sc1
buffer_load_dwordx4 v[92:95],v27,s[20:23],s71 offen offset:3072 sc1
s_bitset1_b32 s68,3
s_branch bk_91
rl_89:
s_bitcmp1_b32 s68,0
s_cbranch_scc0 sk_99
buffer_load_dwordx4 v[64:67],v26,s[20:23],s71 offen offset:0 sc1
buffer_load_dwordx4 v[68:71],v26,s[20:23],s71 offen offset:1024 sc1
sk_99:
s_bitcmp1_b32 s68,1
s_cbranch_scc0 sk_100
buffer_load_dwordx4 v[72:75],v26,s[20:23],s71 offen offset:2048 sc1
buffer_load_dwordx4 v[76:79],v26,s[20:23],s71 offen offset:3072 sc1
sk_100:
s_bitcmp1_b32 s68,2
s_cbranch_scc0 sk_101
buffer_load_dwordx4 v[80:83],v27,s[20:23],s71 offen offset:0 sc1
buffer_load_dwordx4 v[84:87],v27,s[20:23],s71 offen offset:1024 sc1
sk_101:
s_bitcmp1_b32 s68,3
s_cbranch_scc0 sk_102
buffer_load_dwordx4 v[88:91],v27,s[20:23],s71 offen offset:2048 sc1
buffer_load_dwordx4 v[92:95],v27,s[20:23],s71 offen offset:3072 sc1
sk_102:
rl2_92:
s_sub_u32 s90,s90,1
s_cmp_lt_i32 s90,0
s_cbranch_scc1 fin_88
s_waitcnt vmcnt(0)
s_bitcmp1_b32 s68,0
s_cbranch_scc0 sk_103
v_min3_u32 v22,v64,v65,v66
v_min3_u32 v22,v22,v67,v68
v_min3_u32 v22,v22,v69,v70
v_min_u32 v22,v22,v71
v_cmp_eq_u32 vcc,0,v22
v_xor_b32 v64,v32,v64
v_xor_b32 v65,v33,v65
v_xor_b32 v66,v34,v66
v_xor_b32 v67,v35,v67
v_xor_b32 v68,v36,v68
v_xor_b32 v69,v37,v69
v_xor_b32 v70,v38,v70
v_xor_b32 v71,v39,v71
s_cbranch_vccnz nb_104
s_bitset0_b32 s68,0
v_smfmac_f32_16x16x64_bf16 v[184:187],v[64:67],a[128:135],v14
v_smfmac_f32_16x16x64_bf16 v[188:191],v[64:67],a[136:143],v14
v_smfmac_f32_16x16x64_bf16 v[184:187],v[68:71],a[144:151],v14
v_smfmac_f32_16x16x64_bf16 v[188:191],v[68:71],a[152:159],v14
nb_104:
sk_103:
s_bitcmp1_b32 s68,1
s_cbranch_scc0 sk_105
v_min3_u32 v22,v72,v73,v74
v_min3_u32 v22,v22,v75,v76
v_min3_u32 v22,v22,v77,v78
v_min_u32 v22,v22,v79
v_cmp_eq_u32 vcc,0,v22
v_xor_b32 v72,v40,v72
v_xor_b32 v73,v41,v73
v_xor_b32 v74,v42,v74
v_xor_b32 v75,v43,v75
v_xor_b32 v76,v44,v76
v_xor_b32 v77,v45,v77
v_xor_b32 v78,v46,v78
v_xor_b32 v79,v47,v79
s_cbranch_vccnz nb_106
s_bitset0_b32 s68,1
v_smfmac_f32_16x16x64_bf16 v[184:187],v[72:75],a[160:167],v14
v_smfmac_f32_16x16x64_bf16 v[188:191],v[72:75],a[168:175],v14
v_smfmac_f32_16x16x64_bf16 v[184:187],v[76:79],a[176:183],v14
v_smfmac_f32_16x16x64_bf16 v[188:191],v[76:79],a[184:191],v14
nb_106:
sk_105:
s_bitcmp1_b32 s68,2
s_cbranch_scc0 sk_107
v_min3_u32 v22,v80,v81,v82
v_min3_u32 v22,v22,v83,v84
v_min3_u32 v22,v22,v85,v86
v_min_u32 v22,v22,v87
v_cmp_eq_u32 vcc,0,v22
v_xor_b32 v80,v48,v80
v_xor_b32 v81,v49,v81
v_xor_b32 v82,v50,v82
v_xor_b32 v83,v51,v83
v_xor_b32 v84,v52,v84
v_xor_b32 v85,v53,v85
v_xor_b32 v86,v54,v86
v_xor_b32 v87,v55,v87
s_cbranch_vccnz nb_108
s_bitset0_b32 s68,2
v_smfmac_f32_16x16x64_bf16 v[184:187],v[80:83],a[192:199],v14
v_smfmac_f32_16x16x64_bf16 v[188:191],v[80:83],a[200:207],v14
v_smfmac_f32_16x16x64_bf16 v[184:187],v[84:87],a[208:215],v14
v_smfmac_f32_16x16x64_bf16 v[188:191],v[84:87],a[216:223],v14
nb_108:
sk_107:
s_bitcmp1_b32 s68,3
s_cbranch_scc0 sk_109
v_min3_u32 v22,v88,v89,v90
v_min3_u32 v22,v22,v91,v92
v_min3_u32 v22,v22,v93,v94
v_min_u32 v22,v22,v95
v_cmp_eq_u32 vcc,0,v22
v_xor_b32 v88,v56,v88
v_xor_b32 v89,v57,v89
v_xor_b32 v90,v58,v90
v_xor_b32 v91,v59,v91
v_xor_b32 v92,v60,v92
v_xor_b32 v93,v61,v93
v_xor_b32 v94,v62,v94
v_xor_b32 v95,v63,v95
s_cbranch_vccnz nb_110
s_bitset0_b32 s68,3
v_smfmac_f32_16x16x64_bf16 v[184:187],v[88:91],a[224:231],v14
v_smfmac_f32_16x16x64_bf16 v[188:191],v[88:91],a[232:239],v14
v_smfmac_f32_16x16x64_bf16 v[184:187],v[92:95],a[240:247],v14
v_smfmac_f32_16x16x64_bf16 v[188:191],v[92:95],a[248:255],v14
nb_110:
sk_109:
s_cmp_lg_u32 s68,0
s_cbranch_scc1 rl_89
s_nop 2
s_branch fin_88
v2w_93:
wf_111:
ds_read_b32 v23,v21 offset:24
s_sub_u32 s90,s90,1
s_waitcnt lgkmcnt(0)
v_cmp_ne_u32 vcc,v23,v25
s_cmp_lt_i32 s90,0
s_cselect_b64 vcc,0,vcc
s_cbranch_vccnz wf_111
wf_112:
ds_read_b32 v23,v21 offset:28
s_sub_u32 s90,s90,1
s_waitcnt lgkmcnt(0)
v_cmp_ne_u32 vcc,v23,v25
s_cmp_lt_i32 s90,0
s_cselect_b64 vcc,0,vcc
s_cbranch_vccnz wf_112
s_branch v2b_94
first_62:
s_waitcnt vmcnt(0) lgkmcnt(0)
s_barrier
s_add_u32 s64,s15,393216
buffer_load_dwordx4 a[176:179],v32,s[40:43],s64 offen nt
s_add_u32 s64,s15,425984
buffer_load_dwordx4 a[180:183],v32,s[40:43],s64 offen nt
s_add_u32 s64,s15,458752
buffer_load_dwordx4 a[184:187],v32,s[40:43],s64 offen nt
s_add_u32 s64,s15,491520
buffer_load_dwordx4 a[188:191],v32,s[40:43],s64 offen nt
s_add_u32 s64,s15,524288
buffer_load_dwordx4 a[192:195],v32,s[40:43],s64 offen nt
s_add_u32 s64,s15,557056
buffer_load_dwordx4 a[196:199],v32,s[40:43],s64 offen nt
s_add_u32 s64,s15,589824
buffer_load_dwordx4 a[200:203],v32,s[40:43],s64 offen nt
s_add_u32 s64,s15,622592
buffer_load_dwordx4 a[204:207],v32,s[40:43],s64 offen nt
s_add_u32 s64,s15,655360
buffer_load_dwordx4 a[208:211],v32,s[40:43],s64 offen nt
s_add_u32 s64,s15,688128
buffer_load_dwordx4 a[212:215],v32,s[40:43],s64 offen nt
s_add_u32 s64,s15,720896
buffer_load_dwordx4 a[216:219],v32,s[40:43],s64 offen nt
s_add_u32 s64,s15,753664
buffer_load_dwordx4 a[220:223],v32,s[40:43],s64 offen nt
s_add_u32 s64,s15,786432
buffer_load_dwordx4 a[224:227],v32,s[40:43],s64 offen nt
s_add_u32 s64,s15,819200
buffer_load_dwordx4 a[228:231],v32,s[40:43],s64 offen nt
s_add_u32 s64,s15,851968
buffer_load_dwordx4 a[232:235],v32,s[40:43],s64 offen nt
s_add_u32 s64,s15,884736
buffer_load_dwordx4 a[236:239],v32,s[40:43],s64 offen nt
s_add_u32 s64,s15,917504
buffer_load_dwordx4 a[240:243],v32,s[40:43],s64 offen nt
s_add_u32 s64,s15,950272
buffer_load_dwordx4 a[244:247],v32,s[40:43],s64 offen nt
s_add_u32 s64,s15,983040
buffer_load_dwordx4 a[248:251],v32,s[40:43],s64 offen nt
s_add_u32 s64,s15,1015808
buffer_load_dwordx4 a[252:255],v32,s[40:43],s64 offen nt
ds_write_b128 v33,a[0:3] offset:0
ds_write_b128 v33,a[4:7] offset:1024
ds_write_b128 v33,a[8:11] offset:2048
ds_write_b128 v33,a[12:15] offset:3072
s_waitcnt lgkmcnt(0)
v_mov_b32 v38,1
ds_write_b32 v37,v38 offset:0
qs_113:
ds_read_b32 v39,v37 offset:4
s_sub_u32 s90,s90,1
s_waitcnt lgkmcnt(0)
v_cmp_gt_u32 vcc,v38,v39
s_cmp_lt_i32 s90,0
s_cselect_b64 vcc,0,vcc
s_cbranch_vccnz qs_113
ds_read_b64_tr_b16 a[0:1],v36 offset:0
ds_read_b64_tr_b16 a[2:3],v36 offset:128
ds_read_b64_tr_b16 a[4:5],v36 offset:2048
ds_read_b64_tr_b16 a[6:7],v36 offset:2176
ds_read_b64_tr_b16 a[8:9],v36 offset:8192
ds_read_b64_tr_b16 a[10:11],v36 offset:8320
ds_read_b64_tr_b16 a[12:13],v36 offset:10240
ds_read_b64_tr_b16 a[14:15],v36 offset:10368
ds_write_b128 v33,a[16:19] offset:4096
ds_write_b128 v33,a[20:23] offset:5120
ds_write_b128 v33,a[24:27] offset:6144
ds_write_b128 v33,a[28:31] offset:7168
s_waitcnt lgkmcnt(0)
v_mov_b32 v38,2
ds_write_b32 v37,v38 offset:0
qs_114:
ds_read_b32 v39,v37 offset:4
s_sub_u32 s90,s90,1
s_waitcnt lgkmcnt(0)
v_cmp_gt_u32 vcc,v38,v39
s_cmp_lt_i32 s90,0
s_cselect_b64 vcc,0,vcc
s_cbranch_vccnz qs_114
ds_read_b64_tr_b16 a[16:17],v36 offset:4096
ds_read_b64_tr_b16 a[18:19],v36 offset:4224
ds_read_b64_tr_b16 a[20:21],v36 offset:6144
ds_read_b64_tr_b16 a[22:23],v36 offset:6272
ds_read_b64_tr_b16 a[24:25],v36 offset:12288
ds_read_b64_tr_b16 a[26:27],v36 offset:12416
ds_read_b64_tr_b16 a[28:29],v36 offset:14336
ds_read_b64_tr_b16 a[30:31],v36 offset:14464
ds_write_b128 v33,a[32:35] offset:0
ds_write_b128 v33,a[36:39] offset:1024
ds_write_b128 v33,a[40:43] offset:2048
ds_write_b128 v33,a[44:47] offset:3072
s_waitcnt lgkmcnt(0)
v_mov_b32 v38,3
ds_write_b32 v37,v38 offset:0
qs_115:
ds_read_b32 v39,v37 offset:4
s_sub_u32 s90,s90,1
s_waitcnt lgkmcnt(0)
v_cmp_gt_u32 vcc,v38,v39
s_cmp_lt_i32 s90,0
s_cselect_b64 vcc,0,vcc
s_cbranch_vccnz qs_115
ds_read_b64_tr_b16 a[32:33],v36 offset:0
ds_read_b64_tr_b16 a[34:35],v36 offset:128
ds_read_b64_tr_b16 a[36:37],v36 offset:2048
ds_read_b64_tr_b16 a[38:39],v36 offset:2176
ds_read_b64_tr_b16 a[40:41],v36 offset:8192
ds_read_b64_tr_b16 a[42:43],v36 offset:8320
ds_read_b64_tr_b16 a[44:45],v36 offset:10240
ds_read_b64_tr_b16 a[46:47],v36 offset:10368
ds_write_b128 v33,a[48:51] offset:4096
ds_write_b128 v33,a[52:55] offset:5120
ds_write_b128 v33,a[56:59] offset:6144
ds_write_b128 v33,a[60:63] offset:7168
s_waitcnt lgkmcnt(0)
v_mov_b32 v38,4
ds_write_b32 v37,v38 offset:0
qs_116:
ds_read_b32 v39,v37 offset:4
s_sub_u32 s90,s90,1
s_waitcnt lgkmcnt(0)
v_cmp_gt_u32 vcc,v38,v39
s_cmp_lt_i32 s90,0
s_cselect_b64 vcc,0,vcc
s_cbranch_vccnz qs_116
ds_read_b64_tr_b16 a[48:49],v36 offset:4096
ds_read_b64_tr_b16 a[50:51],v36 offset:4224
ds_read_b64_tr_b16 a[52:53],v36 offset:6144
ds_read_b64_tr_b16 a[54:55],v36 offset:6272
ds_read_b64_tr_b16 a[56:57],v36 offset:12288
ds_read_b64_tr_b16 a[58:59],v36 offset:12416
ds_read_b64_tr_b16 a[60:61],v36 offset:14336
ds_read_b64_tr_b16 a[62:63],v36 offset:14464
ds_write_b128 v33,a[64:67] offset:0
ds_write_b128 v33,a[68:71] offset:1024
ds_write_b128 v33,a[72:75] offset:2048
ds_write_b128 v33,a[76:79] offset:3072
s_waitcnt lgkmcnt(0)
v_mov_b32 v38,5
ds_write_b32 v37,v38 offset:0
qs_117:
ds_read_b32 v39,v37 offset:4
s_sub_u32 s90,s90,1
s_waitcnt lgkmcnt(0)
v_cmp_gt_u32 vcc,v38,v39
s_cmp_lt_i32 s90,0
s_cselect_b64 vcc,0,vcc
s_cbranch_vccnz qs_117
ds_read_b64_tr_b16 a[64:65],v36 offset:0
ds_read_b64_tr_b16 a[66:67],v36 offset:128
ds_read_b64_tr_b16 a[68:69],v36 offset:2048
ds_read_b64_tr_b16 a[70:71],v36 offset:2176
ds_read_b64_tr_b16 a[72:73],v36 offset:8192
ds_read_b64_tr_b16 a[74:75],v36 offset:8320
ds_read_b64_tr_b16 a[76:77],v36 offset:10240
ds_read_b64_tr_b16 a[78:79],v36 offset:10368
ds_write_b128 v33,a[80:83] offset:4096
ds_write_b128 v33,a[84:87] offset:5120
ds_write_b128 v33,a[88:91] offset:6144
ds_write_b128 v33,a[92:95] offset:7168
s_waitcnt lgkmcnt(0)
v_mov_b32 v38,6
ds_write_b32 v37,v38 offset:0
qs_118:
ds_read_b32 v39,v37 offset:4
s_sub_u32 s90,s90,1
s_waitcnt lgkmcnt(0)
v_cmp_gt_u32 vcc,v38,v39
s_cmp_lt_i32 s90,0
s_cselect_b64 vcc,0,vcc
s_cbranch_vccnz qs_118
ds_read_b64_tr_b16 a[80:81],v36 offset:4096
ds_read_b64_tr_b16 a[82:83],v36 offset:4224
ds_read_b64_tr_b16 a[84:85],v36 offset:6144
ds_read_b64_tr_b16 a[86:87],v36 offset:6272
ds_read_b64_tr_b16 a[88:89],v36 offset:12288
ds_read_b64_tr_b16 a[90:91],v36 offset:12416
ds_read_b64_tr_b16 a[92:93],v36 offset:14336
ds_read_b64_tr_b16 a[94:95],v36 offset:14464
ds_write_b128 v33,a[96:99] offset:0
ds_write_b128 v33,a[100:103] offset:1024
ds_write_b128 v33,a[104:107] offset:2048
ds_write_b128 v33,a[108:111] offset:3072
s_waitcnt lgkmcnt(0)
v_mov_b32 v38,7
ds_write_b32 v37,v38 offset:0
qs_119:
ds_read_b32 v39,v37 offset:4
s_sub_u32 s90,s90,1
s_waitcnt lgkmcnt(0)
v_cmp_gt_u32 vcc,v38,v39
s_cmp_lt_i32 s90,0
s_cselect_b64 vcc,0,vcc
s_cbranch_vccnz qs_119
ds_read_b64_tr_b16 a[96:97],v36 offset:0
ds_read_b64_tr_b16 a[98:99],v36 offset:128
ds_read_b64_tr_b16 a[100:101],v36 offset:2048
ds_read_b64_tr_b16 a[102:103],v36 offset:2176
ds_read_b64_tr_b16 a[104:105],v36 offset:8192
ds_read_b64_tr_b16 a[106:107],v36 offset:8320
ds_read_b64_tr_b16 a[108:109],v36 offset:10240
ds_read_b64_tr_b16 a[110:111],v36 offset:10368
ds_write_b128 v33,a[112:115] offset:4096
ds_write_b128 v33,a[116:119] offset:5120
ds_write_b128 v33,a[120:123] offset:6144
ds_write_b128 v33,a[124:127] offset:7168
s_waitcnt lgkmcnt(0)
v_mov_b32 v38,8
ds_write_b32 v37,v38 offset:0
qs_120:
ds_read_b32 v39,v37 offset:4
s_sub_u32 s90,s90,1
s_waitcnt lgkmcnt(0)
v_cmp_gt_u32 vcc,v38,v39
s_cmp_lt_i32 s90,0
s_cselect_b64 vcc,0,vcc
s_cbranch_vccnz qs_120
ds_read_b64_tr_b16 a[112:113],v36 offset:4096
ds_read_b64_tr_b16 a[114:115],v36 offset:4224
ds_read_b64_tr_b16 a[116:117],v36 offset:6144
ds_read_b64_tr_b16 a[118:119],v36 offset:6272
ds_read_b64_tr_b16 a[120:121],v36 offset:12288
ds_read_b64_tr_b16 a[122:123],v36 offset:12416
ds_read_b64_tr_b16 a[124:125],v36 offset:14336
ds_read_b64_tr_b16 a[126:127],v36 offset:14464
s_waitcnt lgkmcnt(0)
v_mov_b32 v38,9
ds_write_b32 v37,v38 offset:0
qs_121:
ds_read_b32 v39,v37 offset:4
s_sub_u32 s90,s90,1
s_waitcnt lgkmcnt(0)
v_cmp_gt_u32 vcc,v38,v39
s_cmp_lt_i32 s90,0
s_cselect_b64 vcc,0,vcc
s_cbranch_vccnz qs_121
ds_write_b128 v33,a[128:131] offset:0
ds_write_b128 v33,a[132:135] offset:1024
ds_write_b128 v33,a[136:139] offset:2048
ds_write_b128 v33,a[140:143] offset:3072
s_waitcnt lgkmcnt(0)
ds_read_b64_tr_b16 a[128:129],v34 offset:0
ds_read_b64_tr_b16 a[130:131],v34 offset:128
ds_read_b64_tr_b16 a[132:133],v34 offset:2048
ds_read_b64_tr_b16 a[134:135],v34 offset:2176
ds_read_b64_tr_b16 a[136:137],v34 offset:32
ds_read_b64_tr_b16 a[138:139],v34 offset:160
ds_read_b64_tr_b16 a[140:141],v34 offset:2080
ds_read_b64_tr_b16 a[142:143],v34 offset:2208
ds_write_b128 v33,a[144:147] offset:4096
ds_write_b128 v33,a[148:151] offset:5120
ds_write_b128 v33,a[152:155] offset:6144
ds_write_b128 v33,a[156:159] offset:7168
s_waitcnt lgkmcnt(0)
ds_read_b64_tr_b16 a[144:145],v34 offset:4096
ds_read_b64_tr_b16 a[146:147],v34 offset:4224
ds_read_b64_tr_b16 a[148:149],v34 offset:6144
ds_read_b64_tr_b16 a[150:151],v34 offset:6272
ds_read_b64_tr_b16 a[152:153],v34 offset:4128
ds_read_b64_tr_b16 a[154:155],v34 offset:4256
ds_read_b64_tr_b16 a[156:157],v34 offset:6176
ds_read_b64_tr_b16 a[158:159],v34 offset:6304
ds_write_b128 v33,a[160:163] offset:0
ds_write_b128 v33,a[164:167] offset:1024
ds_write_b128 v33,a[168:171] offset:2048
ds_write_b128 v33,a[172:175] offset:3072
s_waitcnt lgkmcnt(0)
ds_read_b64_tr_b16 a[160:161],v34 offset:0
ds_read_b64_tr_b16 a[162:163],v34 offset:128
ds_read_b64_tr_b16 a[164:165],v34 offset:2048
ds_read_b64_tr_b16 a[166:167],v34 offset:2176
ds_read_b64_tr_b16 a[168:169],v34 offset:32
ds_read_b64_tr_b16 a[170:171],v34 offset:160
ds_read_b64_tr_b16 a[172:173],v34 offset:2080
ds_read_b64_tr_b16 a[174:175],v34 offset:2208
free_122:
ds_read_b64 v[38:39],v37 offset:8
s_sub_u32 s90,s90,1
s_waitcnt lgkmcnt(0)
v_and_b32 v38,v38,v39
v_cmp_eq_u32 vcc,0,v38
s_cmp_lt_i32 s90,0
s_cselect_b64 vcc,0,vcc
s_cbranch_vccnz free_122
s_xor_b32 s64,s61,4194304
buffer_store_dwordx4 v[100:103],v206,s[20:23],s64 offen sc1
buffer_store_dwordx4 v[100:103],v207,s[20:23],s64 offen sc1
s_xor_b32 s64,s61,6299648
buffer_store_dwordx4 v[100:103],v206,s[20:23],s64 offen sc1
buffer_store_dwordx4 v[100:103],v207,s[20:23],s64 offen sc1
s_xor_b32 s64,s61,8388608
buffer_store_dwordx4 v[100:103],v206,s[20:23],s64 offen sc1
buffer_store_dwordx4 v[100:103],v207,s[20:23],s64 offen sc1
s_mov_b32 m0,0
s_mov_b32 s65,188416
buffer_load_dwordx4 v16,s[20:23],s65 offen offset:0 lds
buffer_load_dwordx4 v16,s[20:23],s65 offen offset:1024 lds
buffer_load_dwordx4 v16,s[20:23],s65 offen offset:2048 lds
buffer_load_dwordx4 v16,s[20:23],s65 offen offset:3072 lds
s_mov_b32 m0,4096
s_mov_b32 s65,192512
buffer_load_dwordx4 v16,s[20:23],s65 offen offset:0 lds
buffer_load_dwordx4 v16,s[20:23],s65 offen offset:1024 lds
buffer_load_dwordx4 v16,s[20:23],s65 offen offset:2048 lds
buffer_load_dwordx4 v16,s[20:23],s65 offen offset:3072 lds
s_mov_b32 m0,8192
s_mov_b32 s65,196608
buffer_load_dwordx4 v16,s[20:23],s65 offen offset:0 lds
buffer_load_dwordx4 v16,s[20:23],s65 offen offset:1024 lds
buffer_load_dwordx4 v16,s[20:23],s65 offen offset:2048 lds
buffer_load_dwordx4 v16,s[20:23],s65 offen offset:3072 lds
s_mov_b32 m0,12288
s_mov_b32 s65,200704
buffer_load_dwordx4 v16,s[20:23],s65 offen offset:0 lds
buffer_load_dwordx4 v16,s[20:23],s65 offen offset:1024 lds
buffer_load_dwordx4 v16,s[20:23],s65 offen offset:2048 lds
buffer_load_dwordx4 v16,s[20:23],s65 offen offset:3072 lds
s_mov_b32 m0,16384
s_mov_b32 s65,204800
buffer_load_dwordx4 v16,s[20:23],s65 offen offset:0 lds
buffer_load_dwordx4 v16,s[20:23],s65 offen offset:1024 lds
buffer_load_dwordx4 v16,s[20:23],s65 offen offset:2048 lds
buffer_load_dwordx4 v16,s[20:23],s65 offen offset:3072 lds
s_mov_b32 m0,20480
s_mov_b32 s65,208896
buffer_load_dwordx4 v16,s[20:23],s65 offen offset:0 lds
buffer_load_dwordx4 v16,s[20:23],s65 offen offset:1024 lds
buffer_load_dwordx4 v16,s[20:23],s65 offen offset:2048 lds
buffer_load_dwordx4 v16,s[20:23],s65 offen offset:3072 lds
s_mov_b32 m0,24576
s_mov_b32 s65,212992
buffer_load_dwordx4 v16,s[20:23],s65 offen offset:0 lds
buffer_load_dwordx4 v16,s[20:23],s65 offen offset:1024 lds
buffer_load_dwordx4 v16,s[20:23],s65 offen offset:2048 lds
buffer_load_dwordx4 v16,s[20:23],s65 offen offset:3072 lds
s_mov_b32 m0,28672
s_mov_b32 s65,217088
buffer_load_dwordx4 v16,s[20:23],s65 offen offset:0 lds
buffer_load_dwordx4 v16,s[20:23],s65 offen offset:1024 lds
buffer_load_dwordx4 v16,s[20:23],s65 offen offset:2048 lds
buffer_load_dwordx4 v16,s[20:23],s65 offen offset:3072 lds
s_waitcnt vmcnt(54)
ds_write_b128 v33,a[176:179] offset:4096
ds_write_b128 v33,a[180:183] offset:5120
ds_write_b128 v33,a[184:187] offset:6144
ds_write_b128 v33,a[188:191] offset:7168
s_waitcnt lgkmcnt(0)
ds_read_b64_tr_b16 a[176:177],v34 offset:4096
ds_read_b64_tr_b16 a[178:179],v34 offset:4224
ds_read_b64_tr_b16 a[180:181],v34 offset:6144
ds_read_b64_tr_b16 a[182:183],v34 offset:6272
ds_read_b64_tr_b16 a[184:185],v34 offset:4128
ds_read_b64_tr_b16 a[186:187],v34 offset:4256
ds_read_b64_tr_b16 a[188:189],v34 offset:6176
ds_read_b64_tr_b16 a[190:191],v34 offset:6304
s_waitcnt vmcnt(50)
ds_write_b128 v33,a[192:195] offset:0
ds_write_b128 v33,a[196:199] offset:1024
ds_write_b128 v33,a[200:203] offset:2048
ds_write_b128 v33,a[204:207] offset:3072
s_waitcnt lgkmcnt(0)
ds_read_b64_tr_b16 a[192:193],v34 offset:0
ds_read_b64_tr_b16 a[194:195],v34 offset:128
ds_read_b64_tr_b16 a[196:197],v34 offset:2048
ds_read_b64_tr_b16 a[198:199],v34 offset:2176
ds_read_b64_tr_b16 a[200:201],v34 offset:32
ds_read_b64_tr_b16 a[202:203],v34 offset:160
ds_read_b64_tr_b16 a[204:205],v34 offset:2080
ds_read_b64_tr_b16 a[206:207],v34 offset:2208
s_waitcnt vmcnt(46)
ds_write_b128 v33,a[208:211] offset:4096
ds_write_b128 v33,a[212:215] offset:5120
ds_write_b128 v33,a[216:219] offset:6144
ds_write_b128 v33,a[220:223] offset:7168
s_waitcnt lgkmcnt(0)
ds_read_b64_tr_b16 a[208:209],v34 offset:4096
ds_read_b64_tr_b16 a[210:211],v34 offset:4224
ds_read_b64_tr_b16 a[212:213],v34 offset:6144
ds_read_b64_tr_b16 a[214:215],v34 offset:6272
ds_read_b64_tr_b16 a[216:217],v34 offset:4128
ds_read_b64_tr_b16 a[218:219],v34 offset:4256
ds_read_b64_tr_b16 a[220:221],v34 offset:6176
ds_read_b64_tr_b16 a[222:223],v34 offset:6304
s_waitcnt vmcnt(42)
ds_write_b128 v33,a[224:227] offset:0
ds_write_b128 v33,a[228:231] offset:1024
ds_write_b128 v33,a[232:235] offset:2048
ds_write_b128 v33,a[236:239] offset:3072
s_waitcnt lgkmcnt(0)
ds_read_b64_tr_b16 a[224:225],v34 offset:0
ds_read_b64_tr_b16 a[226:227],v34 offset:128
ds_read_b64_tr_b16 a[228:229],v34 offset:2048
ds_read_b64_tr_b16 a[230:231],v34 offset:2176
ds_read_b64_tr_b16 a[232:233],v34 offset:32
ds_read_b64_tr_b16 a[234:235],v34 offset:160
ds_read_b64_tr_b16 a[236:237],v34 offset:2080
ds_read_b64_tr_b16 a[238:239],v34 offset:2208
s_waitcnt vmcnt(38)
ds_write_b128 v33,a[240:243] offset:4096
ds_write_b128 v33,a[244:247] offset:5120
ds_write_b128 v33,a[248:251] offset:6144
ds_write_b128 v33,a[252:255] offset:7168
s_waitcnt lgkmcnt(0)
ds_read_b64_tr_b16 a[240:241],v34 offset:4096
ds_read_b64_tr_b16 a[242:243],v34 offset:4224
ds_read_b64_tr_b16 a[244:245],v34 offset:6144
ds_read_b64_tr_b16 a[246:247],v34 offset:6272
ds_read_b64_tr_b16 a[248:249],v34 offset:4128
ds_read_b64_tr_b16 a[250:251],v34 offset:4256
ds_read_b64_tr_b16 a[252:253],v34 offset:6176
ds_read_b64_tr_b16 a[254:255],v34 offset:6304
s_mov_b32 s79,0
s_add_u32 s63,s79,0
s_and_b32 s64,s63,3
s_lshl_b32 s70,s64,20
s_add_u32 s65,s63,2
s_and_b32 s65,s65,3
s_lshl_b32 s73,s65,20
s_add_u32 s55,s63,3
s_lshl_b32 s78,s55,16
s_add_u32 s78,s78,57344
s_cmp_lt_u32 s55,64
s_cselect_b32 s78,s78,0x7fff0000
s_add_u32 s71,s70,65536
s_add_u32 s60,s63,1
s_and_b32 s60,s60,3
s_lshl_b32 s72,s60,20
v_mov_b32 v184,0
v_mov_b32 v185,0
v_mov_b32 v186,0
v_mov_b32 v187,0
v_mov_b32 v188,0
v_mov_b32 v189,0
v_mov_b32 v190,0
v_mov_b32 v191,0
s_lshl_b32 s77,s63,21
s_lshl_b32 s55,s63,13
s_and_b32 s55,s55,0x2000
s_xor_b32 s55,s55,s61
s_add_u32 s77,s77,s55
v_mov_b32 v176,0
v_mov_b32 v177,0
v_mov_b32 v178,0
v_mov_b32 v179,0
v_mov_b32 v25,1
s_waitcnt vmcnt(0) lgkmcnt(0)
s_barrier
s_branch loop_63
w1_59:
s_lshr_b32 s64,s57,2
s_add_u32 s64,s64,64
s_lshl_b32 s64,s64,14
s_add_u32 s64,s64,s68
s_add_u32 s64,s64,29360128
v_add_u32 v12,s64,v16
v_and_b32 v22,1,v4
v_lshrrev_b32 v23,1,v4
v_lshl_add_u32 v22,v22,1,v23
v_lshlrev_b32 v22,2,v22
v_lshl_add_u32 v22,v3,4,v22
v_add_u32 v31,155648,v22
v_add_u32 v8,s66,v16
v_add_u32 v9,s67,v16
v_mov_b32 v10,1792
v_mov_b32 v11,0
s_branch first_123
loop_124:
s_barrier
buffer_load_dword v248,v18,s[20:23],s70 offen offset:0 sc1
s_nop 15
s_nop 5
hl_126:
buffer_load_dword v249,v18,s[20:23],s70 offen offset:0 sc1
s_waitcnt vmcnt(1)
v_cmp_eq_u32 vcc,v25,v248
s_bcnt1_i32_b32 s64,vcc_lo
s_cmp_ge_u32 s64,8
s_cbranch_scc1 hg_127
buffer_load_dword v248,v18,s[20:23],s70 offen offset:0 sc1
s_waitcnt vmcnt(1)
v_cmp_eq_u32 vcc,v25,v249
s_bcnt1_i32_b32 s64,vcc_lo
s_cmp_ge_u32 s64,8
s_cbranch_scc1 hg_127
s_sub_u32 s90,s90,1
s_cmp_gt_i32 s90,0
s_cbranch_scc1 hl_126
hg_127:
buffer_load_dwordx4 v[48:51],v27,s[20:23],s70 offen offset:0 sc1
buffer_load_dwordx4 v[52:55],v27,s[20:23],s70 offen offset:1024 sc1
buffer_load_dwordx4 v[56:59],v27,s[20:23],s70 offen offset:2048 sc1
buffer_load_dwordx4 v[60:63],v27,s[20:23],s70 offen offset:3072 sc1
s_waitcnt vmcnt(3)
ds_write_b128 v24,v[48:51] offset:4096
v_min3_u32 v22,v48,v49,v50
v_min_u32 v22,v22,v51
s_waitcnt vmcnt(2)
ds_write_b128 v24,v[52:55] offset:5120
v_min3_u32 v22,v22,v52,v53
v_min3_u32 v22,v22,v54,v55
s_waitcnt vmcnt(1)
ds_write_b128 v24,v[56:59] offset:6144
v_min3_u32 v22,v22,v56,v57
v_min3_u32 v22,v22,v58,v59
s_waitcnt vmcnt(0)
ds_write_b128 v24,v[60:63] offset:7168
v_min3_u32 v22,v22,v60,v61
v_min3_u32 v22,v22,v62,v63
v_cmp_eq_u32 vcc,0,v22
s_cbranch_vccnz art_128
abk_129:
v_smfmac_f32_16x16x64_bf16 v[176:179],v[48:51],a[32:39],v14
s_waitcnt lgkmcnt(0)
s_barrier
ds_read_b128 v[64:67],v24 offset:8192
ds_read_b128 v[68:71],v24 offset:9216
ds_read_b128 v[72:75],v24 offset:10240
ds_read_b128 v[76:79],v24 offset:11264
buffer_store_dwordx4 v[212:215],v12,s[20:23],s76 offen sc1
v_smfmac_f32_16x16x64_bf16 v[176:179],v[52:55],a[40:47],v14
ds_read_b128 v[80:83],v24 offset:12288
ds_read_b128 v[84:87],v24 offset:13312
v_smfmac_f32_16x16x64_bf16 v[176:179],v[56:59],a[48:55],v14
ds_read_b128 v[88:91],v24 offset:14336
ds_read_b128 v[92:95],v24 offset:15360
v_smfmac_f32_16x16x64_bf16 v[176:179],v[60:63],a[56:63],v14
ds_read_b128 v[32:35],v24 offset:0
ds_read_b128 v[36:39],v24 offset:1024
s_waitcnt lgkmcnt(9)
v_smfmac_f32_16x16x64_bf16 v[176:179],v[64:67],a[64:71],v14
ds_read_b128 v[40:43],v24 offset:2048
s_waitcnt lgkmcnt(9)
v_smfmac_f32_16x16x64_bf16 v[176:179],v[68:71],a[72:79],v14
ds_read_b128 v[44:47],v24 offset:3072
s_waitcnt lgkmcnt(9)
v_smfmac_f32_16x16x64_bf16 v[176:179],v[72:75],a[80:87],v14
s_waitcnt lgkmcnt(8)
v_smfmac_f32_16x16x64_bf16 v[176:179],v[76:79],a[88:95],v14
s_waitcnt lgkmcnt(7)
v_smfmac_f32_16x16x64_bf16 v[176:179],v[80:83],a[96:103],v14
s_waitcnt lgkmcnt(6)
v_smfmac_f32_16x16x64_bf16 v[176:179],v[84:87],a[104:111],v14
s_waitcnt lgkmcnt(5)
v_smfmac_f32_16x16x64_bf16 v[176:179],v[88:91],a[112:119],v14
s_waitcnt lgkmcnt(4)
v_smfmac_f32_16x16x64_bf16 v[176:179],v[92:95],a[120:127],v14
s_waitcnt lgkmcnt(3)
v_smfmac_f32_16x16x64_bf16 v[176:179],v[32:35],a[0:7],v14
s_waitcnt lgkmcnt(2)
v_smfmac_f32_16x16x64_bf16 v[176:179],v[36:39],a[8:15],v14
s_waitcnt lgkmcnt(1)
v_smfmac_f32_16x16x64_bf16 v[176:179],v[40:43],a[16:23],v14
s_waitcnt lgkmcnt(0)
v_smfmac_f32_16x16x64_bf16 v[176:179],v[44:47],a[24:31],v14
v_smfmac_f32_16x16x64_bf16 v[180:183],v[32:35],a[128:135],v14
v_smfmac_f32_16x16x64_bf16 v[180:183],v[36:39],a[136:143],v14
s_nop 5
v_permlane32_swap_b32 v176,v178
v_permlane32_swap_b32 v177,v179
v_add_f32 v176,v176,v178
v_add_f32 v177,v177,v179
v_cvt_pk_bf16_f32 v216,v176,v177
s_nop 1
v_mov_b32_dpp v217,v216 quad_perm:[1,0,3,2] row_mask:0xf bank_mask:0xf
v_perm_b32 v216,v217,v216,v15
v_max_u32 v216,1,v216
buffer_store_dword v216,v19,s[24:27],s70 offen
buffer_store_dword v216,v19,s[28:31],s70 offen sc1
v_smfmac_f32_16x16x64_bf16 v[180:183],v[40:43],a[144:151],v14
v_smfmac_f32_16x16x64_bf16 v[180:183],v[44:47],a[152:159],v14
v_smfmac_f32_16x16x64_bf16 v[180:183],v[48:51],a[160:167],v14
v_smfmac_f32_16x16x64_bf16 v[180:183],v[52:55],a[168:175],v14
v_smfmac_f32_16x16x64_bf16 v[180:183],v[56:59],a[176:183],v14
v_smfmac_f32_16x16x64_bf16 v[180:183],v[60:63],a[184:191],v14
v_smfmac_f32_16x16x64_bf16 v[180:183],v[64:67],a[192:199],v14
v_smfmac_f32_16x16x64_bf16 v[180:183],v[68:71],a[200:207],v14
v_smfmac_f32_16x16x64_bf16 v[180:183],v[72:75],a[208:215],v14
v_smfmac_f32_16x16x64_bf16 v[180:183],v[76:79],a[216:223],v14
v_smfmac_f32_16x16x64_bf16 v[180:183],v[80:83],a[224:231],v14
v_smfmac_f32_16x16x64_bf16 v[180:183],v[84:87],a[232:239],v14
v_smfmac_f32_16x16x64_bf16 v[180:183],v[88:91],a[240:247],v14
v_smfmac_f32_16x16x64_bf16 v[180:183],v[92:95],a[248:255],v14
s_nop 7
v_permlane32_swap_b32 v180,v182
v_permlane32_swap_b32 v181,v183
v_add_f32 v180,v180,v182
v_add_f32 v181,v181,v183
v_cvt_pk_bf16_f32 v216,v180,v181
v_max_u32 v216,1,v216
ds_write_b32 v31,v216
ds_write_b32 v21,v25 offset:0
s_cmp_eq_u32 s79,63
s_cbranch_scc1 end_57
s_cmp_ge_i32 s79,62
s_cbranch_scc1 bgsk_131
ds_read_b128 v[64:67],v20 offset:0
ds_read_b128 v[68:71],v20 offset:1024
ds_read_b128 v[72:75],v20 offset:2048
s_waitcnt lgkmcnt(2)
v_mfma_f32_16x16x32_bf16 v[192:195],a[0:3],v[64:67],0
ds_read_b128 v[76:79],v20 offset:3072
v_mfma_f32_16x16x32_bf16 v[200:203],v[64:67],a[128:131],0
s_waitcnt lgkmcnt(2)
v_mfma_f32_16x16x32_bf16 v[196:199],a[0:3],v[68:71],0
ds_read_b128 v[64:67],v20 offset:4096
v_mfma_f32_16x16x32_bf16 v[204:207],v[68:71],a[128:131],0
s_waitcnt lgkmcnt(2)
v_mfma_f32_16x16x32_bf16 v[192:195],a[4:7],v[72:75],v[192:195]
ds_read_b128 v[68:71],v20 offset:5120
v_mfma_f32_16x16x32_bf16 v[200:203],v[72:75],a[132:135],v[200:203]
s_waitcnt lgkmcnt(2)
v_mfma_f32_16x16x32_bf16 v[196:199],a[4:7],v[76:79],v[196:199]
ds_read_b128 v[72:75],v20 offset:6144
v_mfma_f32_16x16x32_bf16 v[204:207],v[76:79],a[132:135],v[204:207]
s_waitcnt lgkmcnt(2)
v_mfma_f32_16x16x32_bf16 v[192:195],a[8:11],v[64:67],v[192:195]
ds_read_b128 v[76:79],v20 offset:7168
v_mfma_f32_16x16x32_bf16 v[200:203],v[64:67],a[136:139],v[200:203]
s_waitcnt lgkmcnt(2)
v_mfma_f32_16x16x32_bf16 v[196:199],a[8:11],v[68:71],v[196:199]
ds_read_b128 v[64:67],v20 offset:8192
v_mfma_f32_16x16x32_bf16 v[204:207],v[68:71],a[136:139],v[204:207]
s_waitcnt lgkmcnt(2)
v_mfma_f32_16x16x32_bf16 v[192:195],a[12:15],v[72:75],v[192:195]
ds_read_b128 v[68:71],v20 offset:9216
v_mfma_f32_16x16x32_bf16 v[200:203],v[72:75],a[140:143],v[200:203]
s_waitcnt lgkmcnt(2)
v_mfma_f32_16x16x32_bf16 v[196:199],a[12:15],v[76:79],v[196:199]
ds_read_b128 v[72:75],v20 offset:10240
v_mfma_f32_16x16x32_bf16 v[204:207],v[76:79],a[140:143],v[204:207]
s_add_u32 m0,s62,0
s_add_u32 s69,s78,0
s_waitcnt lgkmcnt(2)
v_mfma_f32_16x16x32_bf16 v[192:195],a[16:19],v[64:67],v[192:195]
ds_read_b128 v[76:79],v20 offset:11264
v_mfma_f32_16x16x32_bf16 v[200:203],v[64:67],a[144:147],v[200:203]
buffer_load_dwordx4 v16,s[20:23],s69 offen offset:0 lds
s_waitcnt lgkmcnt(2)
v_mfma_f32_16x16x32_bf16 v[196:199],a[16:19],v[68:71],v[196:199]
ds_read_b128 v[64:67],v20 offset:12288
v_mfma_f32_16x16x32_bf16 v[204:207],v[68:71],a[144:147],v[204:207]
buffer_load_dwordx4 v16,s[20:23],s69 offen offset:1024 lds
s_waitcnt lgkmcnt(2)
v_mfma_f32_16x16x32_bf16 v[192:195],a[20:23],v[72:75],v[192:195]
ds_read_b128 v[68:71],v20 offset:13312
v_mfma_f32_16x16x32_bf16 v[200:203],v[72:75],a[148:151],v[200:203]
buffer_load_dwordx4 v16,s[20:23],s69 offen offset:2048 lds
s_waitcnt lgkmcnt(2)
v_mfma_f32_16x16x32_bf16 v[196:199],a[20:23],v[76:79],v[196:199]
ds_read_b128 v[72:75],v20 offset:14336
v_mfma_f32_16x16x32_bf16 v[204:207],v[76:79],a[148:151],v[204:207]
buffer_load_dwordx4 v16,s[20:23],s69 offen offset:3072 lds
s_waitcnt lgkmcnt(2)
v_mfma_f32_16x16x32_bf16 v[192:195],a[24:27],v[64:67],v[192:195]
ds_read_b128 v[76:79],v20 offset:15360
v_mfma_f32_16x16x32_bf16 v[200:203],v[64:67],a[152:155],v[200:203]
s_add_u32 m0,s62,4096
s_add_u32 s69,s78,4096
s_waitcnt lgkmcnt(2)
v_mfma_f32_16x16x32_bf16 v[196:199],a[24:27],v[68:71],v[196:199]
ds_read_b128 v[64:67],v20 offset:16384
v_mfma_f32_16x16x32_bf16 v[204:207],v[68:71],a[152:155],v[204:207]
buffer_load_dwordx4 v16,s[20:23],s69 offen offset:0 lds
s_waitcnt lgkmcnt(2)
v_mfma_f32_16x16x32_bf16 v[192:195],a[28:31],v[72:75],v[192:195]
ds_read_b128 v[68:71],v20 offset:17408
v_mfma_f32_16x16x32_bf16 v[200:203],v[72:75],a[156:159],v[200:203]
buffer_load_dwordx4 v16,s[20:23],s69 offen offset:1024 lds
s_waitcnt lgkmcnt(2)
v_mfma_f32_16x16x32_bf16 v[196:199],a[28:31],v[76:79],v[196:199]
ds_read_b128 v[72:75],v20 offset:18432
v_mfma_f32_16x16x32_bf16 v[204:207],v[76:79],a[156:159],v[204:207]
buffer_load_dwordx4 v16,s[20:23],s69 offen offset:2048 lds
s_waitcnt lgkmcnt(2)
v_mfma_f32_16x16x32_bf16 v[192:195],a[32:35],v[64:67],v[192:195]
ds_read_b128 v[76:79],v20 offset:19456
v_mfma_f32_16x16x32_bf16 v[200:203],v[64:67],a[160:163],v[200:203]
buffer_load_dwordx4 v16,s[20:23],s69 offen offset:3072 lds
s_waitcnt lgkmcnt(2)
v_mfma_f32_16x16x32_bf16 v[196:199],a[32:35],v[68:71],v[196:199]
ds_read_b128 v[64:67],v20 offset:20480
v_mfma_f32_16x16x32_bf16 v[204:207],v[68:71],a[160:163],v[204:207]
s_add_u32 m0,s62,8192
s_add_u32 s69,s78,8192
s_waitcnt lgkmcnt(2)
v_mfma_f32_16x16x32_bf16 v[192:195],a[36:39],v[72:75],v[192:195]
ds_read_b128 v[68:71],v20 offset:21504
v_mfma_f32_16x16x32_bf16 v[200:203],v[72:75],a[164:167],v[200:203]
buffer_load_dwordx4 v16,s[20:23],s69 offen offset:0 lds
s_waitcnt lgkmcnt(2)
v_mfma_f32_16x16x32_bf16 v[196:199],a[36:39],v[76:79],v[196:199]
ds_read_b128 v[72:75],v20 offset:22528
v_mfma_f32_16x16x32_bf16 v[204:207],v[76:79],a[164:167],v[204:207]
buffer_load_dwordx4 v16,s[20:23],s69 offen offset:1024 lds
s_waitcnt lgkmcnt(2)
v_mfma_f32_16x16x32_bf16 v[192:195],a[40:43],v[64:67],v[192:195]
ds_read_b128 v[76:79],v20 offset:23552
v_mfma_f32_16x16x32_bf16 v[200:203],v[64:67],a[168:171],v[200:203]
buffer_load_dwordx4 v16,s[20:23],s69 offen offset:2048 lds
s_waitcnt lgkmcnt(2)
v_mfma_f32_16x16x32_bf16 v[196:199],a[40:43],v[68:71],v[196:199]
ds_read_b128 v[64:67],v20 offset:24576
v_mfma_f32_16x16x32_bf16 v[204:207],v[68:71],a[168:171],v[204:207]
buffer_load_dwordx4 v16,s[20:23],s69 offen offset:3072 lds
s_waitcnt lgkmcnt(2)
v_mfma_f32_16x16x32_bf16 v[192:195],a[44:47],v[72:75],v[192:195]
ds_read_b128 v[68:71],v20 offset:25600
v_mfma_f32_16x16x32_bf16 v[200:203],v[72:75],a[172:175],v[200:203]
s_add_u32 m0,s62,12288
s_add_u32 s69,s78,12288
s_waitcnt lgkmcnt(2)
v_mfma_f32_16x16x32_bf16 v[196:199],a[44:47],v[76:79],v[196:199]
ds_read_b128 v[72:75],v20 offset:26624
v_mfma_f32_16x16x32_bf16 v[204:207],v[76:79],a[172:175],v[204:207]
buffer_load_dwordx4 v16,s[20:23],s69 offen offset:0 lds
s_waitcnt lgkmcnt(2)
v_mfma_f32_16x16x32_bf16 v[192:195],a[48:51],v[64:67],v[192:195]
ds_read_b128 v[76:79],v20 offset:27648
v_mfma_f32_16x16x32_bf16 v[200:203],v[64:67],a[176:179],v[200:203]
buffer_load_dwordx4 v16,s[20:23],s69 offen offset:1024 lds
s_waitcnt lgkmcnt(2)
v_mfma_f32_16x16x32_bf16 v[196:199],a[48:51],v[68:71],v[196:199]
ds_read_b128 v[64:67],v20 offset:28672
v_mfma_f32_16x16x32_bf16 v[204:207],v[68:71],a[176:179],v[204:207]
buffer_load_dwordx4 v16,s[20:23],s69 offen offset:2048 lds
s_waitcnt lgkmcnt(2)
v_mfma_f32_16x16x32_bf16 v[192:195],a[52:55],v[72:75],v[192:195]
ds_read_b128 v[68:71],v20 offset:29696
v_mfma_f32_16x16x32_bf16 v[200:203],v[72:75],a[180:183],v[200:203]
buffer_load_dwordx4 v16,s[20:23],s69 offen offset:3072 lds
s_waitcnt lgkmcnt(2)
v_mfma_f32_16x16x32_bf16 v[196:199],a[52:55],v[76:79],v[196:199]
ds_read_b128 v[72:75],v20 offset:30720
v_mfma_f32_16x16x32_bf16 v[204:207],v[76:79],a[180:183],v[204:207]
s_waitcnt lgkmcnt(2)
v_mfma_f32_16x16x32_bf16 v[192:195],a[56:59],v[64:67],v[192:195]
ds_read_b128 v[76:79],v20 offset:31744
v_mfma_f32_16x16x32_bf16 v[200:203],v[64:67],a[184:187],v[200:203]
s_waitcnt lgkmcnt(2)
v_mfma_f32_16x16x32_bf16 v[196:199],a[56:59],v[68:71],v[196:199]
ds_read_b128 v[64:67],v20 offset:32768
v_mfma_f32_16x16x32_bf16 v[204:207],v[68:71],a[184:187],v[204:207]
s_waitcnt lgkmcnt(2)
v_mfma_f32_16x16x32_bf16 v[192:195],a[60:63],v[72:75],v[192:195]
ds_read_b128 v[68:71],v20 offset:33792
v_mfma_f32_16x16x32_bf16 v[200:203],v[72:75],a[188:191],v[200:203]
s_waitcnt lgkmcnt(2)
v_mfma_f32_16x16x32_bf16 v[196:199],a[60:63],v[76:79],v[196:199]
ds_read_b128 v[72:75],v20 offset:34816
v_mfma_f32_16x16x32_bf16 v[204:207],v[76:79],a[188:191],v[204:207]
s_waitcnt lgkmcnt(2)
v_mfma_f32_16x16x32_bf16 v[192:195],a[64:67],v[64:67],v[192:195]
ds_read_b128 v[76:79],v20 offset:35840
v_mfma_f32_16x16x32_bf16 v[200:203],v[64:67],a[192:195],v[200:203]
s_waitcnt lgkmcnt(2)
v_mfma_f32_16x16x32_bf16 v[196:199],a[64:67],v[68:71],v[196:199]
ds_read_b128 v[64:67],v20 offset:36864
v_mfma_f32_16x16x32_bf16 v[204:207],v[68:71],a[192:195],v[204:207]
s_waitcnt lgkmcnt(2)
v_mfma_f32_16x16x32_bf16 v[192:195],a[68:71],v[72:75],v[192:195]
ds_read_b128 v[68:71],v20 offset:37888
v_mfma_f32_16x16x32_bf16 v[200:203],v[72:75],a[196:199],v[200:203]
s_waitcnt lgkmcnt(2)
v_mfma_f32_16x16x32_bf16 v[196:199],a[68:71],v[76:79],v[196:199]
ds_read_b128 v[72:75],v20 offset:38912
v_mfma_f32_16x16x32_bf16 v[204:207],v[76:79],a[196:199],v[204:207]
s_waitcnt lgkmcnt(2)
v_mfma_f32_16x16x32_bf16 v[192:195],a[72:75],v[64:67],v[192:195]
ds_read_b128 v[76:79],v20 offset:39936
v_mfma_f32_16x16x32_bf16 v[200:203],v[64:67],a[200:203],v[200:203]
s_waitcnt lgkmcnt(2)
v_mfma_f32_16x16x32_bf16 v[196:199],a[72:75],v[68:71],v[196:199]
ds_read_b128 v[64:67],v20 offset:40960
v_mfma_f32_16x16x32_bf16 v[204:207],v[68:71],a[200:203],v[204:207]
s_waitcnt lgkmcnt(2)
v_mfma_f32_16x16x32_bf16 v[192:195],a[76:79],v[72:75],v[192:195]
ds_read_b128 v[68:71],v20 offset:41984
v_mfma_f32_16x16x32_bf16 v[200:203],v[72:75],a[204:207],v[200:203]
s_waitcnt lgkmcnt(2)
v_mfma_f32_16x16x32_bf16 v[196:199],a[76:79],v[76:79],v[196:199]
ds_read_b128 v[72:75],v20 offset:43008
v_mfma_f32_16x16x32_bf16 v[204:207],v[76:79],a[204:207],v[204:207]
s_waitcnt lgkmcnt(2)
v_mfma_f32_16x16x32_bf16 v[192:195],a[80:83],v[64:67],v[192:195]
ds_read_b128 v[76:79],v20 offset:44032
v_mfma_f32_16x16x32_bf16 v[200:203],v[64:67],a[208:211],v[200:203]
s_waitcnt lgkmcnt(2)
v_mfma_f32_16x16x32_bf16 v[196:199],a[80:83],v[68:71],v[196:199]
ds_read_b128 v[64:67],v20 offset:45056
v_mfma_f32_16x16x32_bf16 v[204:207],v[68:71],a[208:211],v[204:207]
s_waitcnt lgkmcnt(2)
v_mfma_f32_16x16x32_bf16 v[192:195],a[84:87],v[72:75],v[192:195]
ds_read_b128 v[68:71],v20 offset:46080
v_mfma_f32_16x16x32_bf16 v[200:203],v[72:75],a[212:215],v[200:203]
s_waitcnt lgkmcnt(2)
v_mfma_f32_16x16x32_bf16 v[196:199],a[84:87],v[76:79],v[196:199]
ds_read_b128 v[72:75],v20 offset:47104
v_mfma_f32_16x16x32_bf16 v[204:207],v[76:79],a[212:215],v[204:207]
s_waitcnt lgkmcnt(2)
v_mfma_f32_16x16x32_bf16 v[192:195],a[88:91],v[64:67],v[192:195]
ds_read_b128 v[76:79],v20 offset:48128
v_mfma_f32_16x16x32_bf16 v[200:203],v[64:67],a[216:219],v[200:203]
s_waitcnt lgkmcnt(2)
v_mfma_f32_16x16x32_bf16 v[196:199],a[88:91],v[68:71],v[196:199]
ds_read_b128 v[64:67],v20 offset:49152
v_mfma_f32_16x16x32_bf16 v[204:207],v[68:71],a[216:219],v[204:207]
s_waitcnt lgkmcnt(2)
v_mfma_f32_16x16x32_bf16 v[192:195],a[92:95],v[72:75],v[192:195]
ds_read_b128 v[68:71],v20 offset:50176
v_mfma_f32_16x16x32_bf16 v[200:203],v[72:75],a[220:223],v[200:203]
s_waitcnt lgkmcnt(2)
v_mfma_f32_16x16x32_bf16 v[196:199],a[92:95],v[76:79],v[196:199]
ds_read_b128 v[72:75],v20 offset:51200
v_mfma_f32_16x16x32_bf16 v[204:207],v[76:79],a[220:223],v[204:207]
s_waitcnt lgkmcnt(2)
v_mfma_f32_16x16x32_bf16 v[192:195],a[96:99],v[64:67],v[192:195]
ds_read_b128 v[76:79],v20 offset:52224
v_mfma_f32_16x16x32_bf16 v[200:203],v[64:67],a[224:227],v[200:203]
s_waitcnt lgkmcnt(2)
v_mfma_f32_16x16x32_bf16 v[196:199],a[96:99],v[68:71],v[196:199]
ds_read_b128 v[64:67],v20 offset:53248
v_mfma_f32_16x16x32_bf16 v[204:207],v[68:71],a[224:227],v[204:207]
s_waitcnt lgkmcnt(2)
v_mfma_f32_16x16x32_bf16 v[192:195],a[100:103],v[72:75],v[192:195]
ds_read_b128 v[68:71],v20 offset:54272
s_add_u32 m0,s62,32768
s_add_u32 s69,s78,32768
v_mfma_f32_16x16x32_bf16 v[200:203],v[72:75],a[228:231],v[200:203]
s_waitcnt lgkmcnt(2)
v_mfma_f32_16x16x32_bf16 v[196:199],a[100:103],v[76:79],v[196:199]
ds_read_b128 v[72:75],v20 offset:55296
buffer_load_dwordx4 v16,s[20:23],s69 offen offset:0 lds
v_mfma_f32_16x16x32_bf16 v[204:207],v[76:79],a[228:231],v[204:207]
s_waitcnt lgkmcnt(2)
v_mfma_f32_16x16x32_bf16 v[192:195],a[104:107],v[64:67],v[192:195]
ds_read_b128 v[76:79],v20 offset:56320
buffer_load_dwordx4 v16,s[20:23],s69 offen offset:1024 lds
v_mfma_f32_16x16x32_bf16 v[200:203],v[64:67],a[232:235],v[200:203]
s_waitcnt lgkmcnt(2)
v_mfma_f32_16x16x32_bf16 v[196:199],a[104:107],v[68:71],v[196:199]
ds_read_b128 v[64:67],v20 offset:57344
buffer_load_dwordx4 v16,s[20:23],s69 offen offset:2048 lds
v_mfma_f32_16x16x32_bf16 v[204:207],v[68:71],a[232:235],v[204:207]
s_waitcnt lgkmcnt(2)
v_mfma_f32_16x16x32_bf16 v[192:195],a[108:111],v[72:75],v[192:195]
ds_read_b128 v[68:71],v20 offset:58368
buffer_load_dwordx4 v16,s[20:23],s69 offen offset:3072 lds
v_mfma_f32_16x16x32_bf16 v[200:203],v[72:75],a[236:239],v[200:203]
s_waitcnt lgkmcnt(2)
v_mfma_f32_16x16x32_bf16 v[196:199],a[108:111],v[76:79],v[196:199]
ds_read_b128 v[72:75],v20 offset:59392
s_add_u32 m0,s62,36864
s_add_u32 s69,s78,36864
v_mfma_f32_16x16x32_bf16 v[204:207],v[76:79],a[236:239],v[204:207]
s_waitcnt lgkmcnt(2)
v_mfma_f32_16x16x32_bf16 v[192:195],a[112:115],v[64:67],v[192:195]
ds_read_b128 v[76:79],v20 offset:60416
buffer_load_dwordx4 v16,s[20:23],s69 offen offset:0 lds
v_mfma_f32_16x16x32_bf16 v[200:203],v[64:67],a[240:243],v[200:203]
s_waitcnt lgkmcnt(2)
v_mfma_f32_16x16x32_bf16 v[196:199],a[112:115],v[68:71],v[196:199]
ds_read_b128 v[64:67],v20 offset:61440
v_mfma_f32_16x16x32_bf16 v[204:207],v[68:71],a[240:243],v[204:207]
buffer_load_dwordx4 v16,s[20:23],s69 offen offset:1024 lds
s_waitcnt lgkmcnt(2)
v_mfma_f32_16x16x32_bf16 v[192:195],a[116:119],v[72:75],v[192:195]
ds_read_b128 v[68:71],v20 offset:62464
v_mfma_f32_16x16x32_bf16 v[200:203],v[72:75],a[244:247],v[200:203]
buffer_load_dwordx4 v16,s[20:23],s69 offen offset:2048 lds
s_waitcnt lgkmcnt(2)
v_mfma_f32_16x16x32_bf16 v[196:199],a[116:119],v[76:79],v[196:199]
ds_read_b128 v[72:75],v20 offset:63488
v_mfma_f32_16x16x32_bf16 v[204:207],v[76:79],a[244:247],v[204:207]
buffer_load_dwordx4 v16,s[20:23],s69 offen offset:3072 lds
s_waitcnt lgkmcnt(2)
v_mfma_f32_16x16x32_bf16 v[192:195],a[120:123],v[64:67],v[192:195]
ds_read_b128 v[76:79],v20 offset:64512
v_mfma_f32_16x16x32_bf16 v[200:203],v[64:67],a[248:251],v[200:203]
s_add_u32 m0,s62,40960
s_add_u32 s69,s78,40960
s_waitcnt lgkmcnt(2)
v_mfma_f32_16x16x32_bf16 v[196:199],a[120:123],v[68:71],v[196:199]
v_mfma_f32_16x16x32_bf16 v[204:207],v[68:71],a[248:251],v[204:207]
buffer_load_dwordx4 v16,s[20:23],s69 offen offset:0 lds
s_waitcnt lgkmcnt(1)
v_mfma_f32_16x16x32_bf16 v[192:195],a[124:127],v[72:75],v[192:195]
v_mfma_f32_16x16x32_bf16 v[200:203],v[72:75],a[252:255],v[200:203]
buffer_load_dwordx4 v16,s[20:23],s69 offen offset:1024 lds
s_waitcnt lgkmcnt(0)
v_mfma_f32_16x16x32_bf16 v[196:199],a[124:127],v[76:79],v[196:199]
v_mfma_f32_16x16x32_bf16 v[204:207],v[76:79],a[252:255],v[204:207]
s_waitcnt vmcnt(26)
ds_write_b32 v21,v25 offset:24
v_xor_b32 v20,0x10000,v20
s_xor_b32 s62,s62,0x10000
s_lshr_b32 s64,s73,9
v_add_u32 v22,s64,v24
v_cvt_pk_bf16_f32 v208,v192,v193
v_cvt_pk_bf16_f32 v209,v194,v195
v_cvt_pk_bf16_f32 v210,v196,v197
v_cvt_pk_bf16_f32 v211,v198,v199
v_cvt_pk_bf16_f32 v212,v200,v201
v_cvt_pk_bf16_f32 v213,v202,v203
v_cvt_pk_bf16_f32 v214,v204,v205
v_cvt_pk_bf16_f32 v215,v206,v207
v_permlane16_swap_b32 v208,v210
v_permlane16_swap_b32 v209,v211
buffer_store_dwordx4 v[208:211],v2,s[24:27],s73 offen
buffer_store_dwordx4 v[208:211],v2,s[28:31],s73 offen sc1
ds_write_b128 v22,v[212:215] offset:16384
buffer_store_dwordx4 v[208:211],v17,s[20:23],s12 offen sc1
bgx_130:
buffer_store_dwordx4 v[100:103],v9,s[24:27],s73 offen
buffer_store_dwordx4 v[100:103],v9,s[28:31],s73 offen sc1
s_mov_b32 exec_hi,0
buffer_store_dwordx4 v[100:103],v8,s[24:27],s73 offen
buffer_store_dwordx4 v[100:103],v8,s[24:27],s71 offen
buffer_store_dwordx4 v[100:103],v8,s[28:31],s73 offen sc1
buffer_store_dwordx4 v[100:103],v8,s[28:31],s71 offen sc1
s_mov_b64 exec,-1
s_waitcnt lgkmcnt(0)
s_add_u32 s63,s79,1
s_and_b32 s64,s63,3
s_lshl_b32 s70,s64,20
s_add_u32 s65,s63,2
s_and_b32 s65,s65,3
s_lshl_b32 s73,s65,20
s_add_u32 s55,s63,3
s_lshl_b32 s78,s55,16
s_add_u32 s78,s78,57344
s_cmp_lt_u32 s55,64
s_cselect_b32 s78,s78,0x7fff0000
s_add_u32 s60,s63,1
s_lshl_b32 s76,s60,21
s_lshl_b32 s55,s60,13
s_and_b32 s55,s55,0x2000
s_xor_b32 s55,s55,s61
s_add_u32 s76,s76,s55
s_cmp_lt_u32 s60,64
s_cselect_b32 s76,s76,0x7fff0000
s_add_u32 s60,s63,2
s_lshl_b32 s12,s60,21
s_lshl_b32 s55,s60,13
s_and_b32 s55,s55,0x2000
s_xor_b32 s55,s55,s61
s_add_u32 s12,s12,s55
s_cmp_lt_u32 s60,64
s_cselect_b32 s12,s12,0x7fff0000
s_add_u32 s71,s73,65536
v_mov_b32 v176,0
v_mov_b32 v177,0
v_mov_b32 v178,0
v_mov_b32 v179,0
v_mov_b32 v180,0
v_mov_b32 v181,0
v_mov_b32 v182,0
v_mov_b32 v183,0
s_add_u32 s79,s79,1
v_add_u32 v25,1,v25
s_waitcnt vmcnt(0)
s_branch loop_124
art_128:
s_sub_u32 s90,s90,1
s_cmp_lt_i32 s90,0
s_cbranch_scc1 abk_129
buffer_load_dwordx4 v[48:51],v27,s[20:23],s70 offen offset:0 sc1
buffer_load_dwordx4 v[52:55],v27,s[20:23],s70 offen offset:1024 sc1
buffer_load_dwordx4 v[56:59],v27,s[20:23],s70 offen offset:2048 sc1
buffer_load_dwordx4 v[60:63],v27,s[20:23],s70 offen offset:3072 sc1
s_waitcnt vmcnt(3)
ds_write_b128 v24,v[48:51] offset:4096
v_min3_u32 v22,v48,v49,v50
v_min_u32 v22,v22,v51
s_waitcnt vmcnt(2)
ds_write_b128 v24,v[52:55] offset:5120
v_min3_u32 v22,v22,v52,v53
v_min3_u32 v22,v22,v54,v55
s_waitcnt vmcnt(1)
ds_write_b128 v24,v[56:59] offset:6144
v_min3_u32 v22,v22,v56,v57
v_min3_u32 v22,v22,v58,v59
s_waitcnt vmcnt(0)
ds_write_b128 v24,v[60:63] offset:7168
v_min3_u32 v22,v22,v60,v61
v_min3_u32 v22,v22,v62,v63
v_cmp_eq_u32 vcc,0,v22
s_cbranch_vccnz art_128
s_branch abk_129
bgsk_131:
s_waitcnt vmcnt(0)
ds_write_b32 v21,v25 offset:24
s_branch bgx_130
first_123:
s_add_u32 s63,s79,0
s_and_b32 s64,s63,3
s_lshl_b32 s70,s64,20
s_add_u32 s65,s63,2
s_and_b32 s65,s65,3
s_lshl_b32 s73,s65,20
s_add_u32 s55,s63,3
s_lshl_b32 s78,s55,16
s_add_u32 s78,s78,57344
s_cmp_lt_u32 s55,64
s_cselect_b32 s78,s78,0x7fff0000
s_add_u32 s60,s63,1
s_lshl_b32 s76,s60,21
s_lshl_b32 s55,s60,13
s_and_b32 s55,s55,0x2000
s_xor_b32 s55,s55,s61
s_add_u32 s76,s76,s55
s_cmp_lt_u32 s60,64
s_cselect_b32 s76,s76,0x7fff0000
s_add_u32 s60,s63,2
s_lshl_b32 s12,s60,21
s_lshl_b32 s55,s60,13
s_and_b32 s55,s55,0x2000
s_xor_b32 s55,s55,s61
s_add_u32 s12,s12,s55
s_cmp_lt_u32 s60,64
s_cselect_b32 s12,s12,0x7fff0000
s_add_u32 s71,s73,65536
v_mov_b32 v176,0
v_mov_b32 v177,0
v_mov_b32 v178,0
v_mov_b32 v179,0
v_mov_b32 v180,0
v_mov_b32 v181,0
v_mov_b32 v182,0
v_mov_b32 v183,0
s_waitcnt vmcnt(0) lgkmcnt(0)
s_barrier
pn1_132:
ds_read_b128 v[64:67],v20 offset:0
ds_read_b128 v[68:71],v20 offset:1024
ds_read_b128 v[72:75],v20 offset:2048
s_waitcnt lgkmcnt(2)
v_mfma_f32_16x16x32_bf16 v[192:195],a[0:3],v[64:67],0
ds_read_b128 v[76:79],v20 offset:3072
v_mfma_f32_16x16x32_bf16 v[200:203],v[64:67],a[128:131],0
s_waitcnt lgkmcnt(2)
v_mfma_f32_16x16x32_bf16 v[196:199],a[0:3],v[68:71],0
ds_read_b128 v[64:67],v20 offset:4096
v_mfma_f32_16x16x32_bf16 v[204:207],v[68:71],a[128:131],0
s_waitcnt lgkmcnt(2)
v_mfma_f32_16x16x32_bf16 v[192:195],a[4:7],v[72:75],v[192:195]
ds_read_b128 v[68:71],v20 offset:5120
v_mfma_f32_16x16x32_bf16 v[200:203],v[72:75],a[132:135],v[200:203]
s_waitcnt lgkmcnt(2)
v_mfma_f32_16x16x32_bf16 v[196:199],a[4:7],v[76:79],v[196:199]
ds_read_b128 v[72:75],v20 offset:6144
v_mfma_f32_16x16x32_bf16 v[204:207],v[76:79],a[132:135],v[204:207]
s_waitcnt lgkmcnt(2)
v_mfma_f32_16x16x32_bf16 v[192:195],a[8:11],v[64:67],v[192:195]
ds_read_b128 v[76:79],v20 offset:7168
v_mfma_f32_16x16x32_bf16 v[200:203],v[64:67],a[136:139],v[200:203]
s_waitcnt lgkmcnt(2)
v_mfma_f32_16x16x32_bf16 v[196:199],a[8:11],v[68:71],v[196:199]
ds_read_b128 v[64:67],v20 offset:8192
v_mfma_f32_16x16x32_bf16 v[204:207],v[68:71],a[136:139],v[204:207]
s_waitcnt lgkmcnt(2)
v_mfma_f32_16x16x32_bf16 v[192:195],a[12:15],v[72:75],v[192:195]
ds_read_b128 v[68:71],v20 offset:9216
v_mfma_f32_16x16x32_bf16 v[200:203],v[72:75],a[140:143],v[200:203]
s_waitcnt lgkmcnt(2)
v_mfma_f32_16x16x32_bf16 v[196:199],a[12:15],v[76:79],v[196:199]
ds_read_b128 v[72:75],v20 offset:10240
v_mfma_f32_16x16x32_bf16 v[204:207],v[76:79],a[140:143],v[204:207]
s_waitcnt lgkmcnt(2)
v_mfma_f32_16x16x32_bf16 v[192:195],a[16:19],v[64:67],v[192:195]
ds_read_b128 v[76:79],v20 offset:11264
v_mfma_f32_16x16x32_bf16 v[200:203],v[64:67],a[144:147],v[200:203]
s_waitcnt lgkmcnt(2)
v_mfma_f32_16x16x32_bf16 v[196:199],a[16:19],v[68:71],v[196:199]
ds_read_b128 v[64:67],v20 offset:12288
v_mfma_f32_16x16x32_bf16 v[204:207],v[68:71],a[144:147],v[204:207]
s_waitcnt lgkmcnt(2)
v_mfma_f32_16x16x32_bf16 v[192:195],a[20:23],v[72:75],v[192:195]
ds_read_b128 v[68:71],v20 offset:13312
v_mfma_f32_16x16x32_bf16 v[200:203],v[72:75],a[148:151],v[200:203]
s_waitcnt lgkmcnt(2)
v_mfma_f32_16x16x32_bf16 v[196:199],a[20:23],v[76:79],v[196:199]
ds_read_b128 v[72:75],v20 offset:14336
v_mfma_f32_16x16x32_bf16 v[204:207],v[76:79],a[148:151],v[204:207]
s_waitcnt lgkmcnt(2)
v_mfma_f32_16x16x32_bf16 v[192:195],a[24:27],v[64:67],v[192:195]
ds_read_b128 v[76:79],v20 offset:15360
v_mfma_f32_16x16x32_bf16 v[200:203],v[64:67],a[152:155],v[200:203]
s_waitcnt lgkmcnt(2)
v_mfma_f32_16x16x32_bf16 v[196:199],a[24:27],v[68:71],v[196:199]
ds_read_b128 v[64:67],v20 offset:16384
v_mfma_f32_16x16x32_bf16 v[204:207],v[68:71],a[152:155],v[204:207]
s_waitcnt lgkmcnt(2)
v_mfma_f32_16x16x32_bf16 v[192:195],a[28:31],v[72:75],v[192:195]
ds_read_b128 v[68:71],v20 offset:17408
v_mfma_f32_16x16x32_bf16 v[200:203],v[72:75],a[156:159],v[200:203]
s_waitcnt lgkmcnt(2)
v_mfma_f32_16x16x32_bf16 v[196:199],a[28:31],v[76:79],v[196:199]
ds_read_b128 v[72:75],v20 offset:18432
v_mfma_f32_16x16x32_bf16 v[204:207],v[76:79],a[156:159],v[204:207]
s_waitcnt lgkmcnt(2)
v_mfma_f32_16x16x32_bf16 v[192:195],a[32:35],v[64:67],v[192:195]
ds_read_b128 v[76:79],v20 offset:19456
v_mfma_f32_16x16x32_bf16 v[200:203],v[64:67],a[160:163],v[200:203]
s_waitcnt lgkmcnt(2)
v_mfma_f32_16x16x32_bf16 v[196:199],a[32:35],v[68:71],v[196:199]
ds_read_b128 v[64:67],v20 offset:20480
v_mfma_f32_16x16x32_bf16 v[204:207],v[68:71],a[160:163],v[204:207]
s_waitcnt lgkmcnt(2)
v_mfma_f32_16x16x32_bf16 v[192:195],a[36:39],v[72:75],v[192:195]
ds_read_b128 v[68:71],v20 offset:21504
v_mfma_f32_16x16x32_bf16 v[200:203],v[72:75],a[164:167],v[200:203]
s_waitcnt lgkmcnt(2)
v_mfma_f32_16x16x32_bf16 v[196:199],a[36:39],v[76:79],v[196:199]
ds_read_b128 v[72:75],v20 offset:22528
v_mfma_f32_16x16x32_bf16 v[204:207],v[76:79],a[164:167],v[204:207]
s_waitcnt lgkmcnt(2)
v_mfma_f32_16x16x32_bf16 v[192:195],a[40:43],v[64:67],v[192:195]
ds_read_b128 v[76:79],v20 offset:23552
v_mfma_f32_16x16x32_bf16 v[200:203],v[64:67],a[168:171],v[200:203]
s_waitcnt lgkmcnt(2)
v_mfma_f32_16x16x32_bf16 v[196:199],a[40:43],v[68:71],v[196:199]
ds_read_b128 v[64:67],v20 offset:24576
v_mfma_f32_16x16x32_bf16 v[204:207],v[68:71],a[168:171],v[204:207]
s_waitcnt lgkmcnt(2)
v_mfma_f32_16x16x32_bf16 v[192:195],a[44:47],v[72:75],v[192:195]
ds_read_b128 v[68:71],v20 offset:25600
v_mfma_f32_16x16x32_bf16 v[200:203],v[72:75],a[172:175],v[200:203]
s_waitcnt lgkmcnt(2)
v_mfma_f32_16x16x32_bf16 v[196:199],a[44:47],v[76:79],v[196:199]
ds_read_b128 v[72:75],v20 offset:26624
v_mfma_f32_16x16x32_bf16 v[204:207],v[76:79],a[172:175],v[204:207]
s_waitcnt lgkmcnt(2)
v_mfma_f32_16x16x32_bf16 v[192:195],a[48:51],v[64:67],v[192:195]
ds_read_b128 v[76:79],v20 offset:27648
v_mfma_f32_16x16x32_bf16 v[200:203],v[64:67],a[176:179],v[200:203]
s_waitcnt lgkmcnt(2)
v_mfma_f32_16x16x32_bf16 v[196:199],a[48:51],v[68:71],v[196:199]
ds_read_b128 v[64:67],v20 offset:28672
v_mfma_f32_16x16x32_bf16 v[204:207],v[68:71],a[176:179],v[204:207]
s_waitcnt lgkmcnt(2)
v_mfma_f32_16x16x32_bf16 v[192:195],a[52:55],v[72:75],v[192:195]
ds_read_b128 v[68:71],v20 offset:29696
v_mfma_f32_16x16x32_bf16 v[200:203],v[72:75],a[180:183],v[200:203]
s_waitcnt lgkmcnt(2)
v_mfma_f32_16x16x32_bf16 v[196:199],a[52:55],v[76:79],v[196:199]
ds_read_b128 v[72:75],v20 offset:30720
v_mfma_f32_16x16x32_bf16 v[204:207],v[76:79],a[180:183],v[204:207]
s_waitcnt lgkmcnt(2)
v_mfma_f32_16x16x32_bf16 v[192:195],a[56:59],v[64:67],v[192:195]
ds_read_b128 v[76:79],v20 offset:31744
v_mfma_f32_16x16x32_bf16 v[200:203],v[64:67],a[184:187],v[200:203]
s_waitcnt lgkmcnt(2)
v_mfma_f32_16x16x32_bf16 v[196:199],a[56:59],v[68:71],v[196:199]
ds_read_b128 v[64:67],v20 offset:32768
v_mfma_f32_16x16x32_bf16 v[204:207],v[68:71],a[184:187],v[204:207]
s_waitcnt lgkmcnt(2)
v_mfma_f32_16x16x32_bf16 v[192:195],a[60:63],v[72:75],v[192:195]
ds_read_b128 v[68:71],v20 offset:33792
v_mfma_f32_16x16x32_bf16 v[200:203],v[72:75],a[188:191],v[200:203]
s_waitcnt lgkmcnt(2)
v_mfma_f32_16x16x32_bf16 v[196:199],a[60:63],v[76:79],v[196:199]
ds_read_b128 v[72:75],v20 offset:34816
v_mfma_f32_16x16x32_bf16 v[204:207],v[76:79],a[188:191],v[204:207]
s_waitcnt lgkmcnt(2)
v_mfma_f32_16x16x32_bf16 v[192:195],a[64:67],v[64:67],v[192:195]
ds_read_b128 v[76:79],v20 offset:35840
v_mfma_f32_16x16x32_bf16 v[200:203],v[64:67],a[192:195],v[200:203]
s_waitcnt lgkmcnt(2)
v_mfma_f32_16x16x32_bf16 v[196:199],a[64:67],v[68:71],v[196:199]
ds_read_b128 v[64:67],v20 offset:36864
v_mfma_f32_16x16x32_bf16 v[204:207],v[68:71],a[192:195],v[204:207]
s_waitcnt lgkmcnt(2)
v_mfma_f32_16x16x32_bf16 v[192:195],a[68:71],v[72:75],v[192:195]
ds_read_b128 v[68:71],v20 offset:37888
v_mfma_f32_16x16x32_bf16 v[200:203],v[72:75],a[196:199],v[200:203]
s_waitcnt lgkmcnt(2)
v_mfma_f32_16x16x32_bf16 v[196:199],a[68:71],v[76:79],v[196:199]
ds_read_b128 v[72:75],v20 offset:38912
v_mfma_f32_16x16x32_bf16 v[204:207],v[76:79],a[196:199],v[204:207]
s_waitcnt lgkmcnt(2)
v_mfma_f32_16x16x32_bf16 v[192:195],a[72:75],v[64:67],v[192:195]
ds_read_b128 v[76:79],v20 offset:39936
v_mfma_f32_16x16x32_bf16 v[200:203],v[64:67],a[200:203],v[200:203]
s_waitcnt lgkmcnt(2)
v_mfma_f32_16x16x32_bf16 v[196:199],a[72:75],v[68:71],v[196:199]
ds_read_b128 v[64:67],v20 offset:40960
v_mfma_f32_16x16x32_bf16 v[204:207],v[68:71],a[200:203],v[204:207]
s_waitcnt lgkmcnt(2)
v_mfma_f32_16x16x32_bf16 v[192:195],a[76:79],v[72:75],v[192:195]
ds_read_b128 v[68:71],v20 offset:41984
v_mfma_f32_16x16x32_bf16 v[200:203],v[72:75],a[204:207],v[200:203]
s_waitcnt lgkmcnt(2)
v_mfma_f32_16x16x32_bf16 v[196:199],a[76:79],v[76:79],v[196:199]
ds_read_b128 v[72:75],v20 offset:43008
v_mfma_f32_16x16x32_bf16 v[204:207],v[76:79],a[204:207],v[204:207]
s_waitcnt lgkmcnt(2)
v_mfma_f32_16x16x32_bf16 v[192:195],a[80:83],v[64:67],v[192:195]
ds_read_b128 v[76:79],v20 offset:44032
v_mfma_f32_16x16x32_bf16 v[200:203],v[64:67],a[208:211],v[200:203]
s_waitcnt lgkmcnt(2)
v_mfma_f32_16x16x32_bf16 v[196:199],a[80:83],v[68:71],v[196:199]
ds_read_b128 v[64:67],v20 offset:45056
v_mfma_f32_16x16x32_bf16 v[204:207],v[68:71],a[208:211],v[204:207]
s_waitcnt lgkmcnt(2)
v_mfma_f32_16x16x32_bf16 v[192:195],a[84:87],v[72:75],v[192:195]
ds_read_b128 v[68:71],v20 offset:46080
v_mfma_f32_16x16x32_bf16 v[200:203],v[72:75],a[212:215],v[200:203]
s_waitcnt lgkmcnt(2)
v_mfma_f32_16x16x32_bf16 v[196:199],a[84:87],v[76:79],v[196:199]
ds_read_b128 v[72:75],v20 offset:47104
v_mfma_f32_16x16x32_bf16 v[204:207],v[76:79],a[212:215],v[204:207]
s_waitcnt lgkmcnt(2)
v_mfma_f32_16x16x32_bf16 v[192:195],a[88:91],v[64:67],v[192:195]
ds_read_b128 v[76:79],v20 offset:48128
v_mfma_f32_16x16x32_bf16 v[200:203],v[64:67],a[216:219],v[200:203]
s_waitcnt lgkmcnt(2)
v_mfma_f32_16x16x32_bf16 v[196:199],a[88:91],v[68:71],v[196:199]
ds_read_b128 v[64:67],v20 offset:49152
v_mfma_f32_16x16x32_bf16 v[204:207],v[68:71],a[216:219],v[204:207]
s_waitcnt lgkmcnt(2)
v_mfma_f32_16x16x32_bf16 v[192:195],a[92:95],v[72:75],v[192:195]
ds_read_b128 v[68:71],v20 offset:50176
v_mfma_f32_16x16x32_bf16 v[200:203],v[72:75],a[220:223],v[200:203]
s_waitcnt lgkmcnt(2)
v_mfma_f32_16x16x32_bf16 v[196:199],a[92:95],v[76:79],v[196:199]
ds_read_b128 v[72:75],v20 offset:51200
v_mfma_f32_16x16x32_bf16 v[204:207],v[76:79],a[220:223],v[204:207]
s_waitcnt lgkmcnt(2)
v_mfma_f32_16x16x32_bf16 v[192:195],a[96:99],v[64:67],v[192:195]
ds_read_b128 v[76:79],v20 offset:52224
v_mfma_f32_16x16x32_bf16 v[200:203],v[64:67],a[224:227],v[200:203]
s_waitcnt lgkmcnt(2)
v_mfma_f32_16x16x32_bf16 v[196:199],a[96:99],v[68:71],v[196:199]
ds_read_b128 v[64:67],v20 offset:53248
v_mfma_f32_16x16x32_bf16 v[204:207],v[68:71],a[224:227],v[204:207]
s_waitcnt lgkmcnt(2)
v_mfma_f32_16x16x32_bf16 v[192:195],a[100:103],v[72:75],v[192:195]
ds_read_b128 v[68:71],v20 offset:54272
v_mfma_f32_16x16x32_bf16 v[200:203],v[72:75],a[228:231],v[200:203]
s_waitcnt lgkmcnt(2)
v_mfma_f32_16x16x32_bf16 v[196:199],a[100:103],v[76:79],v[196:199]
ds_read_b128 v[72:75],v20 offset:55296
v_mfma_f32_16x16x32_bf16 v[204:207],v[76:79],a[228:231],v[204:207]
s_waitcnt lgkmcnt(2)
v_mfma_f32_16x16x32_bf16 v[192:195],a[104:107],v[64:67],v[192:195]
ds_read_b128 v[76:79],v20 offset:56320
v_mfma_f32_16x16x32_bf16 v[200:203],v[64:67],a[232:235],v[200:203]
s_waitcnt lgkmcnt(2)
v_mfma_f32_16x16x32_bf16 v[196:199],a[104:107],v[68:71],v[196:199]
ds_read_b128 v[64:67],v20 offset:57344
v_mfma_f32_16x16x32_bf16 v[204:207],v[68:71],a[232:235],v[204:207]
s_waitcnt lgkmcnt(2)
v_mfma_f32_16x16x32_bf16 v[192:195],a[108:111],v[72:75],v[192:195]
ds_read_b128 v[68:71],v20 offset:58368
v_mfma_f32_16x16x32_bf16 v[200:203],v[72:75],a[236:239],v[200:203]
s_waitcnt lgkmcnt(2)
v_mfma_f32_16x16x32_bf16 v[196:199],a[108:111],v[76:79],v[196:199]
ds_read_b128 v[72:75],v20 offset:59392
v_mfma_f32_16x16x32_bf16 v[204:207],v[76:79],a[236:239],v[204:207]
s_waitcnt lgkmcnt(2)
v_mfma_f32_16x16x32_bf16 v[192:195],a[112:115],v[64:67],v[192:195]
ds_read_b128 v[76:79],v20 offset:60416
v_mfma_f32_16x16x32_bf16 v[200:203],v[64:67],a[240:243],v[200:203]
s_waitcnt lgkmcnt(2)
v_mfma_f32_16x16x32_bf16 v[196:199],a[112:115],v[68:71],v[196:199]
ds_read_b128 v[64:67],v20 offset:61440
v_mfma_f32_16x16x32_bf16 v[204:207],v[68:71],a[240:243],v[204:207]
s_waitcnt lgkmcnt(2)
v_mfma_f32_16x16x32_bf16 v[192:195],a[116:119],v[72:75],v[192:195]
ds_read_b128 v[68:71],v20 offset:62464
v_mfma_f32_16x16x32_bf16 v[200:203],v[72:75],a[244:247],v[200:203]
s_waitcnt lgkmcnt(2)
v_mfma_f32_16x16x32_bf16 v[196:199],a[116:119],v[76:79],v[196:199]
ds_read_b128 v[72:75],v20 offset:63488
v_mfma_f32_16x16x32_bf16 v[204:207],v[76:79],a[244:247],v[204:207]
s_waitcnt lgkmcnt(2)
v_mfma_f32_16x16x32_bf16 v[192:195],a[120:123],v[64:67],v[192:195]
ds_read_b128 v[76:79],v20 offset:64512
v_mfma_f32_16x16x32_bf16 v[200:203],v[64:67],a[248:251],v[200:203]
s_waitcnt lgkmcnt(2)
v_mfma_f32_16x16x32_bf16 v[196:199],a[120:123],v[68:71],v[196:199]
v_mfma_f32_16x16x32_bf16 v[204:207],v[68:71],a[248:251],v[204:207]
s_waitcnt lgkmcnt(1)
v_mfma_f32_16x16x32_bf16 v[192:195],a[124:127],v[72:75],v[192:195]
v_mfma_f32_16x16x32_bf16 v[200:203],v[72:75],a[252:255],v[200:203]
s_waitcnt lgkmcnt(0)
v_mfma_f32_16x16x32_bf16 v[196:199],a[124:127],v[76:79],v[196:199]
v_mfma_f32_16x16x32_bf16 v[204:207],v[76:79],a[252:255],v[204:207]
v_xor_b32 v20,0x10000,v20
s_xor_b32 s62,s62,0x10000
s_lshr_b32 s64,s73,9
v_add_u32 v22,s64,v24
v_cvt_pk_bf16_f32 v208,v192,v193
v_cvt_pk_bf16_f32 v209,v194,v195
s_nop 0
v_cvt_pk_bf16_f32 v210,v196,v197
v_cvt_pk_bf16_f32 v211,v198,v199
v_cvt_pk_bf16_f32 v212,v200,v201
v_cvt_pk_bf16_f32 v213,v202,v203
v_cvt_pk_bf16_f32 v214,v204,v205
v_cvt_pk_bf16_f32 v215,v206,v207
v_permlane16_swap_b32 v208,v210
v_permlane16_swap_b32 v209,v211
buffer_store_dwordx4 v[208:211],v2,s[24:27],s73 offen
buffer_store_dwordx4 v[208:211],v2,s[28:31],s73 offen sc1
ds_write_b128 v22,v[212:215] offset:16384
buffer_store_dwordx4 v[208:211],v17,s[20:23],s12 offen sc1
bgx_134:
s_add_u32 s63,s79,1
s_and_b32 s64,s63,3
s_lshl_b32 s70,s64,20
s_add_u32 s65,s63,2
s_and_b32 s65,s65,3
s_lshl_b32 s73,s65,20
s_add_u32 s55,s63,3
s_lshl_b32 s78,s55,16
s_add_u32 s78,s78,57344
s_cmp_lt_u32 s55,64
s_cselect_b32 s78,s78,0x7fff0000
s_add_u32 s60,s63,1
s_lshl_b32 s76,s60,21
s_lshl_b32 s55,s60,13
s_and_b32 s55,s55,0x2000
s_xor_b32 s55,s55,s61
s_add_u32 s76,s76,s55
s_cmp_lt_u32 s60,64
s_cselect_b32 s76,s76,0x7fff0000
s_add_u32 s60,s63,2
s_lshl_b32 s12,s60,21
s_lshl_b32 s55,s60,13
s_and_b32 s55,s55,0x2000
s_xor_b32 s55,s55,s61
s_add_u32 s12,s12,s55
s_cmp_lt_u32 s60,64
s_cselect_b32 s12,s12,0x7fff0000
s_add_u32 s71,s73,65536
v_mov_b32 v176,0
v_mov_b32 v177,0
v_mov_b32 v178,0
v_mov_b32 v179,0
v_mov_b32 v180,0
v_mov_b32 v181,0
v_mov_b32 v182,0
v_mov_b32 v183,0
s_add_u32 s79,s79,1
s_cmp_eq_u32 s79,0
s_cbranch_scc1 pn2_133
v_mov_b32 v38,1
ds_write_b32 v37,v38 offset:8
buffer_store_dwordx4 v[212:215],v12,s[20:23],s76 offen sc1
s_waitcnt lgkmcnt(0)
s_branch pn1_132
pn2_133:
v_mov_b32 v25,1
s_waitcnt vmcnt(1) lgkmcnt(0)
s_barrier
s_branch loop_124
w2_60:
s_lshr_b32 s64,s57,2
s_add_u32 s64,s64,64
s_lshl_b32 s64,s64,14
s_add_u32 s64,s64,s68
s_add_u32 s64,s64,29361152
v_add_u32 v12,s64,v16
v_and_b32 v22,1,v4
v_lshrrev_b32 v23,1,v4
v_lshl_add_u32 v22,v22,1,v23
v_lshlrev_b32 v22,2,v22
v_lshl_add_u32 v22,v3,4,v22
v_add_u32 v31,155904,v22
s_branch first_135
loop_136:
s_barrier
buffer_load_dword v248,v18,s[20:23],s70 offen offset:0 sc1
s_nop 15
s_nop 5
hl_138:
buffer_load_dword v249,v18,s[20:23],s70 offen offset:0 sc1
s_waitcnt vmcnt(1)
v_cmp_eq_u32 vcc,v25,v248
s_bcnt1_i32_b32 s64,vcc_lo
s_cmp_ge_u32 s64,8
s_cbranch_scc1 hg_139
buffer_load_dword v248,v18,s[20:23],s70 offen offset:0 sc1
s_waitcnt vmcnt(1)
v_cmp_eq_u32 vcc,v25,v249
s_bcnt1_i32_b32 s64,vcc_lo
s_cmp_ge_u32 s64,8
s_cbranch_scc1 hg_139
s_sub_u32 s90,s90,1
s_cmp_gt_i32 s90,0
s_cbranch_scc1 hl_138
hg_139:
buffer_load_dwordx4 v[64:67],v28,s[20:23],s70 offen offset:0 sc1
buffer_load_dwordx4 v[68:71],v28,s[20:23],s70 offen offset:1024 sc1
buffer_load_dwordx4 v[72:75],v28,s[20:23],s70 offen offset:2048 sc1
buffer_load_dwordx4 v[76:79],v28,s[20:23],s70 offen offset:3072 sc1
s_waitcnt vmcnt(3)
ds_write_b128 v24,v[64:67] offset:8192
v_min3_u32 v22,v64,v65,v66
v_min_u32 v22,v22,v67
s_waitcnt vmcnt(2)
ds_write_b128 v24,v[68:71] offset:9216
v_min3_u32 v22,v22,v68,v69
v_min3_u32 v22,v22,v70,v71
s_waitcnt vmcnt(1)
ds_write_b128 v24,v[72:75] offset:10240
v_min3_u32 v22,v22,v72,v73
v_min3_u32 v22,v22,v74,v75
s_waitcnt vmcnt(0)
ds_write_b128 v24,v[76:79] offset:11264
v_min3_u32 v22,v22,v76,v77
v_min3_u32 v22,v22,v78,v79
v_cmp_eq_u32 vcc,0,v22
s_cbranch_vccnz art_140
abk_141:
v_smfmac_f32_16x16x64_bf16 v[176:179],v[64:67],a[64:71],v14
s_waitcnt lgkmcnt(0)
s_barrier
ds_read_b128 v[80:83],v24 offset:12288
ds_read_b128 v[84:87],v24 offset:13312
ds_read_b128 v[88:91],v24 offset:14336
ds_read_b128 v[92:95],v24 offset:15360
buffer_store_dwordx4 v[212:215],v12,s[20:23],s76 offen sc1
v_smfmac_f32_16x16x64_bf16 v[176:179],v[68:71],a[72:79],v14
ds_read_b128 v[32:35],v24 offset:0
ds_read_b128 v[36:39],v24 offset:1024
v_smfmac_f32_16x16x64_bf16 v[176:179],v[72:75],a[80:87],v14
ds_read_b128 v[40:43],v24 offset:2048
ds_read_b128 v[44:47],v24 offset:3072
v_smfmac_f32_16x16x64_bf16 v[176:179],v[76:79],a[88:95],v14
ds_read_b128 v[48:51],v24 offset:4096
ds_read_b128 v[52:55],v24 offset:5120
s_waitcnt lgkmcnt(9)
v_smfmac_f32_16x16x64_bf16 v[176:179],v[80:83],a[96:103],v14
ds_read_b128 v[56:59],v24 offset:6144
s_waitcnt lgkmcnt(9)
v_smfmac_f32_16x16x64_bf16 v[176:179],v[84:87],a[104:111],v14
ds_read_b128 v[60:63],v24 offset:7168
s_waitcnt lgkmcnt(9)
v_smfmac_f32_16x16x64_bf16 v[176:179],v[88:91],a[112:119],v14
s_waitcnt lgkmcnt(8)
v_smfmac_f32_16x16x64_bf16 v[176:179],v[92:95],a[120:127],v14
s_waitcnt lgkmcnt(7)
v_smfmac_f32_16x16x64_bf16 v[176:179],v[32:35],a[0:7],v14
s_waitcnt lgkmcnt(6)
v_smfmac_f32_16x16x64_bf16 v[176:179],v[36:39],a[8:15],v14
s_waitcnt lgkmcnt(5)
v_smfmac_f32_16x16x64_bf16 v[176:179],v[40:43],a[16:23],v14
s_waitcnt lgkmcnt(4)
v_smfmac_f32_16x16x64_bf16 v[176:179],v[44:47],a[24:31],v14
s_waitcnt lgkmcnt(3)
v_smfmac_f32_16x16x64_bf16 v[176:179],v[48:51],a[32:39],v14
s_waitcnt lgkmcnt(2)
v_smfmac_f32_16x16x64_bf16 v[176:179],v[52:55],a[40:47],v14
s_waitcnt lgkmcnt(1)
v_smfmac_f32_16x16x64_bf16 v[176:179],v[56:59],a[48:55],v14
s_waitcnt lgkmcnt(0)
v_smfmac_f32_16x16x64_bf16 v[176:179],v[60:63],a[56:63],v14
v_smfmac_f32_16x16x64_bf16 v[180:183],v[32:35],a[128:135],v14
v_smfmac_f32_16x16x64_bf16 v[180:183],v[36:39],a[136:143],v14
s_nop 5
v_permlane32_swap_b32 v176,v178
v_permlane32_swap_b32 v177,v179
v_add_f32 v176,v176,v178
v_add_f32 v177,v177,v179
v_cvt_pk_bf16_f32 v216,v176,v177
s_nop 1
v_mov_b32_dpp v217,v216 quad_perm:[1,0,3,2] row_mask:0xf bank_mask:0xf
v_perm_b32 v216,v217,v216,v15
v_max_u32 v216,1,v216
buffer_store_dword v216,v19,s[24:27],s70 offen
buffer_store_dword v216,v19,s[28:31],s70 offen sc1
v_smfmac_f32_16x16x64_bf16 v[180:183],v[40:43],a[144:151],v14
v_smfmac_f32_16x16x64_bf16 v[180:183],v[44:47],a[152:159],v14
v_smfmac_f32_16x16x64_bf16 v[180:183],v[48:51],a[160:167],v14
v_smfmac_f32_16x16x64_bf16 v[180:183],v[52:55],a[168:175],v14
v_smfmac_f32_16x16x64_bf16 v[180:183],v[56:59],a[176:183],v14
v_smfmac_f32_16x16x64_bf16 v[180:183],v[60:63],a[184:191],v14
v_smfmac_f32_16x16x64_bf16 v[180:183],v[64:67],a[192:199],v14
v_smfmac_f32_16x16x64_bf16 v[180:183],v[68:71],a[200:207],v14
v_smfmac_f32_16x16x64_bf16 v[180:183],v[72:75],a[208:215],v14
v_smfmac_f32_16x16x64_bf16 v[180:183],v[76:79],a[216:223],v14
v_smfmac_f32_16x16x64_bf16 v[180:183],v[80:83],a[224:231],v14
v_smfmac_f32_16x16x64_bf16 v[180:183],v[84:87],a[232:239],v14
v_smfmac_f32_16x16x64_bf16 v[180:183],v[88:91],a[240:247],v14
v_smfmac_f32_16x16x64_bf16 v[180:183],v[92:95],a[248:255],v14
s_nop 7
v_permlane32_swap_b32 v180,v182
v_permlane32_swap_b32 v181,v183
v_add_f32 v180,v180,v182
v_add_f32 v181,v181,v183
v_cvt_pk_bf16_f32 v216,v180,v181
v_max_u32 v216,1,v216
ds_write_b32 v31,v216
ds_write_b32 v21,v25 offset:4
s_cmp_eq_u32 s79,63
s_cbranch_scc1 end_57
s_cmp_ge_i32 s79,62
s_cbranch_scc1 bgsk_143
ds_read_b128 v[64:67],v20 offset:0
ds_read_b128 v[68:71],v20 offset:1024
ds_read_b128 v[72:75],v20 offset:2048
s_waitcnt lgkmcnt(2)
v_mfma_f32_16x16x32_bf16 v[192:195],a[0:3],v[64:67],0
ds_read_b128 v[76:79],v20 offset:3072
v_mfma_f32_16x16x32_bf16 v[200:203],v[64:67],a[128:131],0
s_waitcnt lgkmcnt(2)
v_mfma_f32_16x16x32_bf16 v[196:199],a[0:3],v[68:71],0
ds_read_b128 v[64:67],v20 offset:4096
v_mfma_f32_16x16x32_bf16 v[204:207],v[68:71],a[128:131],0
s_waitcnt lgkmcnt(2)
v_mfma_f32_16x16x32_bf16 v[192:195],a[4:7],v[72:75],v[192:195]
ds_read_b128 v[68:71],v20 offset:5120
v_mfma_f32_16x16x32_bf16 v[200:203],v[72:75],a[132:135],v[200:203]
s_waitcnt lgkmcnt(2)
v_mfma_f32_16x16x32_bf16 v[196:199],a[4:7],v[76:79],v[196:199]
ds_read_b128 v[72:75],v20 offset:6144
v_mfma_f32_16x16x32_bf16 v[204:207],v[76:79],a[132:135],v[204:207]
s_waitcnt lgkmcnt(2)
v_mfma_f32_16x16x32_bf16 v[192:195],a[8:11],v[64:67],v[192:195]
ds_read_b128 v[76:79],v20 offset:7168
v_mfma_f32_16x16x32_bf16 v[200:203],v[64:67],a[136:139],v[200:203]
s_waitcnt lgkmcnt(2)
v_mfma_f32_16x16x32_bf16 v[196:199],a[8:11],v[68:71],v[196:199]
ds_read_b128 v[64:67],v20 offset:8192
v_mfma_f32_16x16x32_bf16 v[204:207],v[68:71],a[136:139],v[204:207]
s_waitcnt lgkmcnt(2)
v_mfma_f32_16x16x32_bf16 v[192:195],a[12:15],v[72:75],v[192:195]
ds_read_b128 v[68:71],v20 offset:9216
v_mfma_f32_16x16x32_bf16 v[200:203],v[72:75],a[140:143],v[200:203]
s_waitcnt lgkmcnt(2)
v_mfma_f32_16x16x32_bf16 v[196:199],a[12:15],v[76:79],v[196:199]
ds_read_b128 v[72:75],v20 offset:10240
v_mfma_f32_16x16x32_bf16 v[204:207],v[76:79],a[140:143],v[204:207]
s_add_u32 m0,s62,16384
s_add_u32 s69,s78,16384
s_waitcnt lgkmcnt(2)
v_mfma_f32_16x16x32_bf16 v[192:195],a[16:19],v[64:67],v[192:195]
ds_read_b128 v[76:79],v20 offset:11264
v_mfma_f32_16x16x32_bf16 v[200:203],v[64:67],a[144:147],v[200:203]
buffer_load_dwordx4 v16,s[20:23],s69 offen offset:0 lds
s_waitcnt lgkmcnt(2)
v_mfma_f32_16x16x32_bf16 v[196:199],a[16:19],v[68:71],v[196:199]
ds_read_b128 v[64:67],v20 offset:12288
v_mfma_f32_16x16x32_bf16 v[204:207],v[68:71],a[144:147],v[204:207]
buffer_load_dwordx4 v16,s[20:23],s69 offen offset:1024 lds
s_waitcnt lgkmcnt(2)
v_mfma_f32_16x16x32_bf16 v[192:195],a[20:23],v[72:75],v[192:195]
ds_read_b128 v[68:71],v20 offset:13312
v_mfma_f32_16x16x32_bf16 v[200:203],v[72:75],a[148:151],v[200:203]
buffer_load_dwordx4 v16,s[20:23],s69 offen offset:2048 lds
s_waitcnt lgkmcnt(2)
v_mfma_f32_16x16x32_bf16 v[196:199],a[20:23],v[76:79],v[196:199]
ds_read_b128 v[72:75],v20 offset:14336
v_mfma_f32_16x16x32_bf16 v[204:207],v[76:79],a[148:151],v[204:207]
buffer_load_dwordx4 v16,s[20:23],s69 offen offset:3072 lds
s_waitcnt lgkmcnt(2)
v_mfma_f32_16x16x32_bf16 v[192:195],a[24:27],v[64:67],v[192:195]
ds_read_b128 v[76:79],v20 offset:15360
v_mfma_f32_16x16x32_bf16 v[200:203],v[64:67],a[152:155],v[200:203]
s_add_u32 m0,s62,20480
s_add_u32 s69,s78,20480
s_waitcnt lgkmcnt(2)
v_mfma_f32_16x16x32_bf16 v[196:199],a[24:27],v[68:71],v[196:199]
ds_read_b128 v[64:67],v20 offset:16384
v_mfma_f32_16x16x32_bf16 v[204:207],v[68:71],a[152:155],v[204:207]
buffer_load_dwordx4 v16,s[20:23],s69 offen offset:0 lds
s_waitcnt lgkmcnt(2)
v_mfma_f32_16x16x32_bf16 v[192:195],a[28:31],v[72:75],v[192:195]
ds_read_b128 v[68:71],v20 offset:17408
v_mfma_f32_16x16x32_bf16 v[200:203],v[72:75],a[156:159],v[200:203]
buffer_load_dwordx4 v16,s[20:23],s69 offen offset:1024 lds
s_waitcnt lgkmcnt(2)
v_mfma_f32_16x16x32_bf16 v[196:199],a[28:31],v[76:79],v[196:199]
ds_read_b128 v[72:75],v20 offset:18432
v_mfma_f32_16x16x32_bf16 v[204:207],v[76:79],a[156:159],v[204:207]
buffer_load_dwordx4 v16,s[20:23],s69 offen offset:2048 lds
s_waitcnt lgkmcnt(2)
v_mfma_f32_16x16x32_bf16 v[192:195],a[32:35],v[64:67],v[192:195]
ds_read_b128 v[76:79],v20 offset:19456
v_mfma_f32_16x16x32_bf16 v[200:203],v[64:67],a[160:163],v[200:203]
buffer_load_dwordx4 v16,s[20:23],s69 offen offset:3072 lds
s_waitcnt lgkmcnt(2)
v_mfma_f32_16x16x32_bf16 v[196:199],a[32:35],v[68:71],v[196:199]
ds_read_b128 v[64:67],v20 offset:20480
v_mfma_f32_16x16x32_bf16 v[204:207],v[68:71],a[160:163],v[204:207]
s_add_u32 m0,s62,24576
s_add_u32 s69,s78,24576
s_waitcnt lgkmcnt(2)
v_mfma_f32_16x16x32_bf16 v[192:195],a[36:39],v[72:75],v[192:195]
ds_read_b128 v[68:71],v20 offset:21504
v_mfma_f32_16x16x32_bf16 v[200:203],v[72:75],a[164:167],v[200:203]
buffer_load_dwordx4 v16,s[20:23],s69 offen offset:0 lds
s_waitcnt lgkmcnt(2)
v_mfma_f32_16x16x32_bf16 v[196:199],a[36:39],v[76:79],v[196:199]
ds_read_b128 v[72:75],v20 offset:22528
v_mfma_f32_16x16x32_bf16 v[204:207],v[76:79],a[164:167],v[204:207]
buffer_load_dwordx4 v16,s[20:23],s69 offen offset:1024 lds
s_waitcnt lgkmcnt(2)
v_mfma_f32_16x16x32_bf16 v[192:195],a[40:43],v[64:67],v[192:195]
ds_read_b128 v[76:79],v20 offset:23552
v_mfma_f32_16x16x32_bf16 v[200:203],v[64:67],a[168:171],v[200:203]
buffer_load_dwordx4 v16,s[20:23],s69 offen offset:2048 lds
s_waitcnt lgkmcnt(2)
v_mfma_f32_16x16x32_bf16 v[196:199],a[40:43],v[68:71],v[196:199]
ds_read_b128 v[64:67],v20 offset:24576
v_mfma_f32_16x16x32_bf16 v[204:207],v[68:71],a[168:171],v[204:207]
buffer_load_dwordx4 v16,s[20:23],s69 offen offset:3072 lds
s_waitcnt lgkmcnt(2)
v_mfma_f32_16x16x32_bf16 v[192:195],a[44:47],v[72:75],v[192:195]
ds_read_b128 v[68:71],v20 offset:25600
v_mfma_f32_16x16x32_bf16 v[200:203],v[72:75],a[172:175],v[200:203]
s_add_u32 m0,s62,28672
s_add_u32 s69,s78,28672
s_waitcnt lgkmcnt(2)
v_mfma_f32_16x16x32_bf16 v[196:199],a[44:47],v[76:79],v[196:199]
ds_read_b128 v[72:75],v20 offset:26624
v_mfma_f32_16x16x32_bf16 v[204:207],v[76:79],a[172:175],v[204:207]
buffer_load_dwordx4 v16,s[20:23],s69 offen offset:0 lds
s_waitcnt lgkmcnt(2)
v_mfma_f32_16x16x32_bf16 v[192:195],a[48:51],v[64:67],v[192:195]
ds_read_b128 v[76:79],v20 offset:27648
v_mfma_f32_16x16x32_bf16 v[200:203],v[64:67],a[176:179],v[200:203]
buffer_load_dwordx4 v16,s[20:23],s69 offen offset:1024 lds
s_waitcnt lgkmcnt(2)
v_mfma_f32_16x16x32_bf16 v[196:199],a[48:51],v[68:71],v[196:199]
ds_read_b128 v[64:67],v20 offset:28672
v_mfma_f32_16x16x32_bf16 v[204:207],v[68:71],a[176:179],v[204:207]
buffer_load_dwordx4 v16,s[20:23],s69 offen offset:2048 lds
s_waitcnt lgkmcnt(2)
v_mfma_f32_16x16x32_bf16 v[192:195],a[52:55],v[72:75],v[192:195]
ds_read_b128 v[68:71],v20 offset:29696
v_mfma_f32_16x16x32_bf16 v[200:203],v[72:75],a[180:183],v[200:203]
buffer_load_dwordx4 v16,s[20:23],s69 offen offset:3072 lds
s_waitcnt lgkmcnt(2)
v_mfma_f32_16x16x32_bf16 v[196:199],a[52:55],v[76:79],v[196:199]
ds_read_b128 v[72:75],v20 offset:30720
v_mfma_f32_16x16x32_bf16 v[204:207],v[76:79],a[180:183],v[204:207]
s_waitcnt lgkmcnt(2)
v_mfma_f32_16x16x32_bf16 v[192:195],a[56:59],v[64:67],v[192:195]
ds_read_b128 v[76:79],v20 offset:31744
v_mfma_f32_16x16x32_bf16 v[200:203],v[64:67],a[184:187],v[200:203]
s_waitcnt lgkmcnt(2)
v_mfma_f32_16x16x32_bf16 v[196:199],a[56:59],v[68:71],v[196:199]
ds_read_b128 v[64:67],v20 offset:32768
v_mfma_f32_16x16x32_bf16 v[204:207],v[68:71],a[184:187],v[204:207]
s_waitcnt lgkmcnt(2)
v_mfma_f32_16x16x32_bf16 v[192:195],a[60:63],v[72:75],v[192:195]
ds_read_b128 v[68:71],v20 offset:33792
v_mfma_f32_16x16x32_bf16 v[200:203],v[72:75],a[188:191],v[200:203]
s_waitcnt lgkmcnt(2)
v_mfma_f32_16x16x32_bf16 v[196:199],a[60:63],v[76:79],v[196:199]
ds_read_b128 v[72:75],v20 offset:34816
v_mfma_f32_16x16x32_bf16 v[204:207],v[76:79],a[188:191],v[204:207]
s_waitcnt lgkmcnt(2)
v_mfma_f32_16x16x32_bf16 v[192:195],a[64:67],v[64:67],v[192:195]
ds_read_b128 v[76:79],v20 offset:35840
v_mfma_f32_16x16x32_bf16 v[200:203],v[64:67],a[192:195],v[200:203]
s_waitcnt lgkmcnt(2)
v_mfma_f32_16x16x32_bf16 v[196:199],a[64:67],v[68:71],v[196:199]
ds_read_b128 v[64:67],v20 offset:36864
v_mfma_f32_16x16x32_bf16 v[204:207],v[68:71],a[192:195],v[204:207]
s_waitcnt lgkmcnt(2)
v_mfma_f32_16x16x32_bf16 v[192:195],a[68:71],v[72:75],v[192:195]
ds_read_b128 v[68:71],v20 offset:37888
v_mfma_f32_16x16x32_bf16 v[200:203],v[72:75],a[196:199],v[200:203]
s_waitcnt lgkmcnt(2)
v_mfma_f32_16x16x32_bf16 v[196:199],a[68:71],v[76:79],v[196:199]
ds_read_b128 v[72:75],v20 offset:38912
v_mfma_f32_16x16x32_bf16 v[204:207],v[76:79],a[196:199],v[204:207]
s_waitcnt lgkmcnt(2)
v_mfma_f32_16x16x32_bf16 v[192:195],a[72:75],v[64:67],v[192:195]
ds_read_b128 v[76:79],v20 offset:39936
v_mfma_f32_16x16x32_bf16 v[200:203],v[64:67],a[200:203],v[200:203]
s_waitcnt lgkmcnt(2)
v_mfma_f32_16x16x32_bf16 v[196:199],a[72:75],v[68:71],v[196:199]
ds_read_b128 v[64:67],v20 offset:40960
v_mfma_f32_16x16x32_bf16 v[204:207],v[68:71],a[200:203],v[204:207]
s_waitcnt lgkmcnt(2)
v_mfma_f32_16x16x32_bf16 v[192:195],a[76:79],v[72:75],v[192:195]
ds_read_b128 v[68:71],v20 offset:41984
v_mfma_f32_16x16x32_bf16 v[200:203],v[72:75],a[204:207],v[200:203]
s_waitcnt lgkmcnt(2)
v_mfma_f32_16x16x32_bf16 v[196:199],a[76:79],v[76:79],v[196:199]
ds_read_b128 v[72:75],v20 offset:43008
v_mfma_f32_16x16x32_bf16 v[204:207],v[76:79],a[204:207],v[204:207]
s_waitcnt lgkmcnt(2)
v_mfma_f32_16x16x32_bf16 v[192:195],a[80:83],v[64:67],v[192:195]
ds_read_b128 v[76:79],v20 offset:44032
v_mfma_f32_16x16x32_bf16 v[200:203],v[64:67],a[208:211],v[200:203]
s_waitcnt lgkmcnt(2)
v_mfma_f32_16x16x32_bf16 v[196:199],a[80:83],v[68:71],v[196:199]
ds_read_b128 v[64:67],v20 offset:45056
v_mfma_f32_16x16x32_bf16 v[204:207],v[68:71],a[208:211],v[204:207]
s_waitcnt lgkmcnt(2)
v_mfma_f32_16x16x32_bf16 v[192:195],a[84:87],v[72:75],v[192:195]
ds_read_b128 v[68:71],v20 offset:46080
v_mfma_f32_16x16x32_bf16 v[200:203],v[72:75],a[212:215],v[200:203]
s_waitcnt lgkmcnt(2)
v_mfma_f32_16x16x32_bf16 v[196:199],a[84:87],v[76:79],v[196:199]
ds_read_b128 v[72:75],v20 offset:47104
v_mfma_f32_16x16x32_bf16 v[204:207],v[76:79],a[212:215],v[204:207]
s_waitcnt lgkmcnt(2)
v_mfma_f32_16x16x32_bf16 v[192:195],a[88:91],v[64:67],v[192:195]
ds_read_b128 v[76:79],v20 offset:48128
v_mfma_f32_16x16x32_bf16 v[200:203],v[64:67],a[216:219],v[200:203]
s_waitcnt lgkmcnt(2)
v_mfma_f32_16x16x32_bf16 v[196:199],a[88:91],v[68:71],v[196:199]
ds_read_b128 v[64:67],v20 offset:49152
v_mfma_f32_16x16x32_bf16 v[204:207],v[68:71],a[216:219],v[204:207]
s_waitcnt lgkmcnt(2)
v_mfma_f32_16x16x32_bf16 v[192:195],a[92:95],v[72:75],v[192:195]
ds_read_b128 v[68:71],v20 offset:50176
v_mfma_f32_16x16x32_bf16 v[200:203],v[72:75],a[220:223],v[200:203]
s_waitcnt lgkmcnt(2)
v_mfma_f32_16x16x32_bf16 v[196:199],a[92:95],v[76:79],v[196:199]
ds_read_b128 v[72:75],v20 offset:51200
v_mfma_f32_16x16x32_bf16 v[204:207],v[76:79],a[220:223],v[204:207]
s_waitcnt lgkmcnt(2)
v_mfma_f32_16x16x32_bf16 v[192:195],a[96:99],v[64:67],v[192:195]
ds_read_b128 v[76:79],v20 offset:52224
v_mfma_f32_16x16x32_bf16 v[200:203],v[64:67],a[224:227],v[200:203]
s_waitcnt lgkmcnt(2)
v_mfma_f32_16x16x32_bf16 v[196:199],a[96:99],v[68:71],v[196:199]
ds_read_b128 v[64:67],v20 offset:53248
v_mfma_f32_16x16x32_bf16 v[204:207],v[68:71],a[224:227],v[204:207]
s_waitcnt lgkmcnt(2)
v_mfma_f32_16x16x32_bf16 v[192:195],a[100:103],v[72:75],v[192:195]
ds_read_b128 v[68:71],v20 offset:54272
s_add_u32 m0,s62,43008
s_add_u32 s69,s78,43008
v_mfma_f32_16x16x32_bf16 v[200:203],v[72:75],a[228:231],v[200:203]
s_waitcnt lgkmcnt(2)
v_mfma_f32_16x16x32_bf16 v[196:199],a[100:103],v[76:79],v[196:199]
ds_read_b128 v[72:75],v20 offset:55296
buffer_load_dwordx4 v16,s[20:23],s69 offen offset:0 lds
v_mfma_f32_16x16x32_bf16 v[204:207],v[76:79],a[228:231],v[204:207]
s_waitcnt lgkmcnt(2)
v_mfma_f32_16x16x32_bf16 v[192:195],a[104:107],v[64:67],v[192:195]
ds_read_b128 v[76:79],v20 offset:56320
buffer_load_dwordx4 v16,s[20:23],s69 offen offset:1024 lds
v_mfma_f32_16x16x32_bf16 v[200:203],v[64:67],a[232:235],v[200:203]
s_waitcnt lgkmcnt(2)
v_mfma_f32_16x16x32_bf16 v[196:199],a[104:107],v[68:71],v[196:199]
ds_read_b128 v[64:67],v20 offset:57344
buffer_load_dwordx4 v16,s[20:23],s69 offen offset:2048 lds
v_mfma_f32_16x16x32_bf16 v[204:207],v[68:71],a[232:235],v[204:207]
s_waitcnt lgkmcnt(2)
v_mfma_f32_16x16x32_bf16 v[192:195],a[108:111],v[72:75],v[192:195]
ds_read_b128 v[68:71],v20 offset:58368
buffer_load_dwordx4 v16,s[20:23],s69 offen offset:3072 lds
v_mfma_f32_16x16x32_bf16 v[200:203],v[72:75],a[236:239],v[200:203]
s_waitcnt lgkmcnt(2)
v_mfma_f32_16x16x32_bf16 v[196:199],a[108:111],v[76:79],v[196:199]
ds_read_b128 v[72:75],v20 offset:59392
s_add_u32 m0,s62,47104
s_add_u32 s69,s78,47104
v_mfma_f32_16x16x32_bf16 v[204:207],v[76:79],a[236:239],v[204:207]
s_waitcnt lgkmcnt(2)
v_mfma_f32_16x16x32_bf16 v[192:195],a[112:115],v[64:67],v[192:195]
ds_read_b128 v[76:79],v20 offset:60416
buffer_load_dwordx4 v16,s[20:23],s69 offen offset:0 lds
v_mfma_f32_16x16x32_bf16 v[200:203],v[64:67],a[240:243],v[200:203]
s_waitcnt lgkmcnt(2)
v_mfma_f32_16x16x32_bf16 v[196:199],a[112:115],v[68:71],v[196:199]
ds_read_b128 v[64:67],v20 offset:61440
v_mfma_f32_16x16x32_bf16 v[204:207],v[68:71],a[240:243],v[204:207]
buffer_load_dwordx4 v16,s[20:23],s69 offen offset:1024 lds
s_waitcnt lgkmcnt(2)
v_mfma_f32_16x16x32_bf16 v[192:195],a[116:119],v[72:75],v[192:195]
ds_read_b128 v[68:71],v20 offset:62464
v_mfma_f32_16x16x32_bf16 v[200:203],v[72:75],a[244:247],v[200:203]
buffer_load_dwordx4 v16,s[20:23],s69 offen offset:2048 lds
s_waitcnt lgkmcnt(2)
v_mfma_f32_16x16x32_bf16 v[196:199],a[116:119],v[76:79],v[196:199]
ds_read_b128 v[72:75],v20 offset:63488
v_mfma_f32_16x16x32_bf16 v[204:207],v[76:79],a[244:247],v[204:207]
buffer_load_dwordx4 v16,s[20:23],s69 offen offset:3072 lds
s_waitcnt lgkmcnt(2)
v_mfma_f32_16x16x32_bf16 v[192:195],a[120:123],v[64:67],v[192:195]
ds_read_b128 v[76:79],v20 offset:64512
v_mfma_f32_16x16x32_bf16 v[200:203],v[64:67],a[248:251],v[200:203]
s_add_u32 m0,s62,51200
s_add_u32 s69,s78,51200
s_waitcnt lgkmcnt(2)
v_mfma_f32_16x16x32_bf16 v[196:199],a[120:123],v[68:71],v[196:199]
v_mfma_f32_16x16x32_bf16 v[204:207],v[68:71],a[248:251],v[204:207]
buffer_load_dwordx4 v16,s[20:23],s69 offen offset:0 lds
s_waitcnt lgkmcnt(1)
v_mfma_f32_16x16x32_bf16 v[192:195],a[124:127],v[72:75],v[192:195]
v_mfma_f32_16x16x32_bf16 v[200:203],v[72:75],a[252:255],v[200:203]
buffer_load_dwordx4 v16,s[20:23],s69 offen offset:1024 lds
s_waitcnt lgkmcnt(0)
v_mfma_f32_16x16x32_bf16 v[196:199],a[124:127],v[76:79],v[196:199]
v_mfma_f32_16x16x32_bf16 v[204:207],v[76:79],a[252:255],v[204:207]
s_waitcnt vmcnt(26)
ds_write_b32 v21,v25 offset:28
v_xor_b32 v20,0x10000,v20
s_xor_b32 s62,s62,0x10000
s_lshr_b32 s64,s73,9
v_add_u32 v22,s64,v24
v_cvt_pk_bf16_f32 v208,v192,v193
v_cvt_pk_bf16_f32 v209,v194,v195
v_cvt_pk_bf16_f32 v210,v196,v197
v_cvt_pk_bf16_f32 v211,v198,v199
v_cvt_pk_bf16_f32 v212,v200,v201
v_cvt_pk_bf16_f32 v213,v202,v203
v_cvt_pk_bf16_f32 v214,v204,v205
v_cvt_pk_bf16_f32 v215,v206,v207
v_permlane16_swap_b32 v208,v210
v_permlane16_swap_b32 v209,v211
buffer_store_dwordx4 v[208:211],v2,s[24:27],s73 offen
buffer_store_dwordx4 v[208:211],v2,s[28:31],s73 offen sc1
ds_write_b128 v22,v[212:215] offset:17408
buffer_store_dwordx4 v[208:211],v17,s[20:23],s12 offen sc1
bgx_142:
s_waitcnt lgkmcnt(0)
s_andn2_b32 s64,s79,0x14
s_cmp_eq_u32 s64,2
s_cbranch_scc1 late_144
lateb_145:
s_buffer_load_dword s48,s[20:23],s80 offset:0
s_buffer_load_dword s48,s[20:23],s80 offset:64
s_buffer_load_dword s48,s[20:23],s80 offset:128
s_buffer_load_dword s48,s[20:23],s80 offset:192
s_buffer_load_dword s48,s[20:23],s80 offset:256
s_buffer_load_dword s48,s[20:23],s80 offset:320
s_buffer_load_dword s48,s[20:23],s80 offset:384
s_buffer_load_dword s48,s[20:23],s80 offset:448
s_buffer_load_dword s48,s[20:23],s80 offset:512
s_buffer_load_dword s48,s[20:23],s80 offset:576
s_buffer_load_dword s48,s[20:23],s80 offset:640
s_buffer_load_dword s48,s[20:23],s80 offset:704
s_buffer_load_dword s48,s[20:23],s80 offset:768
s_buffer_load_dword s48,s[20:23],s80 offset:832
s_buffer_load_dword s48,s[20:23],s80 offset:896
s_buffer_load_dword s48,s[20:23],s80 offset:960
s_buffer_load_dword s48,s[20:23],s80 offset:1024
s_buffer_load_dword s48,s[20:23],s80 offset:1088
s_buffer_load_dword s48,s[20:23],s80 offset:1152
s_buffer_load_dword s48,s[20:23],s80 offset:1216
s_buffer_load_dword s48,s[20:23],s80 offset:1280
s_buffer_load_dword s48,s[20:23],s80 offset:1344
s_buffer_load_dword s48,s[20:23],s80 offset:1408
s_buffer_load_dword s48,s[20:23],s80 offset:1472
s_buffer_load_dword s48,s[20:23],s80 offset:1536
s_buffer_load_dword s48,s[20:23],s80 offset:1600
s_buffer_load_dword s48,s[20:23],s80 offset:1664
s_buffer_load_dword s48,s[20:23],s80 offset:1728
s_buffer_load_dword s48,s[20:23],s80 offset:1792
s_buffer_load_dword s48,s[20:23],s80 offset:1856
s_buffer_load_dword s48,s[20:23],s80 offset:1920
s_buffer_load_dword s48,s[20:23],s80 offset:1984
s_add_u32 s63,s79,1
s_and_b32 s64,s63,3
s_lshl_b32 s70,s64,20
s_add_u32 s65,s63,2
s_and_b32 s65,s65,3
s_lshl_b32 s73,s65,20
s_add_u32 s55,s63,3
s_lshl_b32 s78,s55,16
s_add_u32 s78,s78,57344
s_cmp_lt_u32 s55,64
s_cselect_b32 s78,s78,0x7fff0000
s_add_u32 s60,s63,1
s_lshl_b32 s76,s60,21
s_lshl_b32 s55,s60,13
s_and_b32 s55,s55,0x2000
s_xor_b32 s55,s55,s61
s_add_u32 s76,s76,s55
s_cmp_lt_u32 s60,64
s_cselect_b32 s76,s76,0x7fff0000
s_add_u32 s60,s63,2
s_lshl_b32 s12,s60,21
s_lshl_b32 s55,s60,13
s_and_b32 s55,s55,0x2000
s_xor_b32 s55,s55,s61
s_add_u32 s12,s12,s55
s_cmp_lt_u32 s60,64
s_cselect_b32 s12,s12,0x7fff0000
s_add_u32 s55,s63,5
s_min_u32 s55,s55,63
s_lshl_b32 s55,s55,16
s_lshl_b32 s60,s59,11
s_add_u32 s80,s55,s60
s_add_u32 s80,s80,57344
v_mov_b32 v176,0
v_mov_b32 v177,0
v_mov_b32 v178,0
v_mov_b32 v179,0
v_mov_b32 v180,0
v_mov_b32 v181,0
v_mov_b32 v182,0
v_mov_b32 v183,0
s_add_u32 s79,s79,1
v_add_u32 v25,1,v25
s_waitcnt vmcnt(0)
s_branch loop_136
art_140:
s_sub_u32 s90,s90,1
s_cmp_lt_i32 s90,0
s_cbranch_scc1 abk_141
buffer_load_dwordx4 v[64:67],v28,s[20:23],s70 offen offset:0 sc1
buffer_load_dwordx4 v[68:71],v28,s[20:23],s70 offen offset:1024 sc1
buffer_load_dwordx4 v[72:75],v28,s[20:23],s70 offen offset:2048 sc1
buffer_load_dwordx4 v[76:79],v28,s[20:23],s70 offen offset:3072 sc1
s_waitcnt vmcnt(3)
ds_write_b128 v24,v[64:67] offset:8192
v_min3_u32 v22,v64,v65,v66
v_min_u32 v22,v22,v67
s_waitcnt vmcnt(2)
ds_write_b128 v24,v[68:71] offset:9216
v_min3_u32 v22,v22,v68,v69
v_min3_u32 v22,v22,v70,v71
s_waitcnt vmcnt(1)
ds_write_b128 v24,v[72:75] offset:10240
v_min3_u32 v22,v22,v72,v73
v_min3_u32 v22,v22,v74,v75
s_waitcnt vmcnt(0)
ds_write_b128 v24,v[76:79] offset:11264
v_min3_u32 v22,v22,v76,v77
v_min3_u32 v22,v22,v78,v79
v_cmp_eq_u32 vcc,0,v22
s_cbranch_vccnz art_140
s_branch abk_141
bgsk_143:
s_waitcnt vmcnt(0)
ds_write_b32 v21,v25 offset:28
s_branch bgx_142
late_144:
s_cmp_eq_u32 s79,22
s_cbranch_scc1 lateb_145
v_lshlrev_b32 v184,2,v16
s_mov_b32 s52,21052416
s_mov_b32 s53,1792
s_lshr_b32 s64,s79,4
s_lshl_b32 s64,0x100,s64
s_cmp_eq_u32 s79,2
s_cselect_b32 exec_lo,0xff,s64
s_mov_b32 exec_hi,0
dp_146:
buffer_load_dword v185,v184,s[20:23],s52 offen sc1
s_waitcnt vmcnt(0)
v_cmp_ne_u32 vcc,s53,v185
s_cbranch_vccz dpok_147
s_sleep 2
s_sub_u32 s90,s90,1
s_cmp_gt_i32 s90,0
s_cbranch_scc1 dp_146
dpok_147:
s_mov_b64 exec,-1
s_branch lateb_145
first_135:
s_add_u32 s63,s79,0
s_and_b32 s64,s63,3
s_lshl_b32 s70,s64,20
s_add_u32 s65,s63,2
s_and_b32 s65,s65,3
s_lshl_b32 s73,s65,20
s_add_u32 s55,s63,3
s_lshl_b32 s78,s55,16
s_add_u32 s78,s78,57344
s_cmp_lt_u32 s55,64
s_cselect_b32 s78,s78,0x7fff0000
s_add_u32 s60,s63,1
s_lshl_b32 s76,s60,21
s_lshl_b32 s55,s60,13
s_and_b32 s55,s55,0x2000
s_xor_b32 s55,s55,s61
s_add_u32 s76,s76,s55
s_cmp_lt_u32 s60,64
s_cselect_b32 s76,s76,0x7fff0000
s_add_u32 s60,s63,2
s_lshl_b32 s12,s60,21
s_lshl_b32 s55,s60,13
s_and_b32 s55,s55,0x2000
s_xor_b32 s55,s55,s61
s_add_u32 s12,s12,s55
s_cmp_lt_u32 s60,64
s_cselect_b32 s12,s12,0x7fff0000
s_add_u32 s55,s63,5
s_min_u32 s55,s55,63
s_lshl_b32 s55,s55,16
s_lshl_b32 s60,s59,11
s_add_u32 s80,s55,s60
s_add_u32 s80,s80,57344
v_mov_b32 v176,0
v_mov_b32 v177,0
v_mov_b32 v178,0
v_mov_b32 v179,0
v_mov_b32 v180,0
v_mov_b32 v181,0
v_mov_b32 v182,0
v_mov_b32 v183,0
s_waitcnt vmcnt(0) lgkmcnt(0)
s_barrier
pn1_148:
ds_read_b128 v[64:67],v20 offset:0
ds_read_b128 v[68:71],v20 offset:1024
ds_read_b128 v[72:75],v20 offset:2048
s_waitcnt lgkmcnt(2)
v_mfma_f32_16x16x32_bf16 v[192:195],a[0:3],v[64:67],0
ds_read_b128 v[76:79],v20 offset:3072
v_mfma_f32_16x16x32_bf16 v[200:203],v[64:67],a[128:131],0
s_waitcnt lgkmcnt(2)
v_mfma_f32_16x16x32_bf16 v[196:199],a[0:3],v[68:71],0
ds_read_b128 v[64:67],v20 offset:4096
v_mfma_f32_16x16x32_bf16 v[204:207],v[68:71],a[128:131],0
s_waitcnt lgkmcnt(2)
v_mfma_f32_16x16x32_bf16 v[192:195],a[4:7],v[72:75],v[192:195]
ds_read_b128 v[68:71],v20 offset:5120
v_mfma_f32_16x16x32_bf16 v[200:203],v[72:75],a[132:135],v[200:203]
s_waitcnt lgkmcnt(2)
v_mfma_f32_16x16x32_bf16 v[196:199],a[4:7],v[76:79],v[196:199]
ds_read_b128 v[72:75],v20 offset:6144
v_mfma_f32_16x16x32_bf16 v[204:207],v[76:79],a[132:135],v[204:207]
s_waitcnt lgkmcnt(2)
v_mfma_f32_16x16x32_bf16 v[192:195],a[8:11],v[64:67],v[192:195]
ds_read_b128 v[76:79],v20 offset:7168
v_mfma_f32_16x16x32_bf16 v[200:203],v[64:67],a[136:139],v[200:203]
s_waitcnt lgkmcnt(2)
v_mfma_f32_16x16x32_bf16 v[196:199],a[8:11],v[68:71],v[196:199]
ds_read_b128 v[64:67],v20 offset:8192
v_mfma_f32_16x16x32_bf16 v[204:207],v[68:71],a[136:139],v[204:207]
s_waitcnt lgkmcnt(2)
v_mfma_f32_16x16x32_bf16 v[192:195],a[12:15],v[72:75],v[192:195]
ds_read_b128 v[68:71],v20 offset:9216
v_mfma_f32_16x16x32_bf16 v[200:203],v[72:75],a[140:143],v[200:203]
s_waitcnt lgkmcnt(2)
v_mfma_f32_16x16x32_bf16 v[196:199],a[12:15],v[76:79],v[196:199]
ds_read_b128 v[72:75],v20 offset:10240
v_mfma_f32_16x16x32_bf16 v[204:207],v[76:79],a[140:143],v[204:207]
s_waitcnt lgkmcnt(2)
v_mfma_f32_16x16x32_bf16 v[192:195],a[16:19],v[64:67],v[192:195]
ds_read_b128 v[76:79],v20 offset:11264
v_mfma_f32_16x16x32_bf16 v[200:203],v[64:67],a[144:147],v[200:203]
s_waitcnt lgkmcnt(2)
v_mfma_f32_16x16x32_bf16 v[196:199],a[16:19],v[68:71],v[196:199]
ds_read_b128 v[64:67],v20 offset:12288
v_mfma_f32_16x16x32_bf16 v[204:207],v[68:71],a[144:147],v[204:207]
s_waitcnt lgkmcnt(2)
v_mfma_f32_16x16x32_bf16 v[192:195],a[20:23],v[72:75],v[192:195]
ds_read_b128 v[68:71],v20 offset:13312
v_mfma_f32_16x16x32_bf16 v[200:203],v[72:75],a[148:151],v[200:203]
s_waitcnt lgkmcnt(2)
v_mfma_f32_16x16x32_bf16 v[196:199],a[20:23],v[76:79],v[196:199]
ds_read_b128 v[72:75],v20 offset:14336
v_mfma_f32_16x16x32_bf16 v[204:207],v[76:79],a[148:151],v[204:207]
s_waitcnt lgkmcnt(2)
v_mfma_f32_16x16x32_bf16 v[192:195],a[24:27],v[64:67],v[192:195]
ds_read_b128 v[76:79],v20 offset:15360
v_mfma_f32_16x16x32_bf16 v[200:203],v[64:67],a[152:155],v[200:203]
s_waitcnt lgkmcnt(2)
v_mfma_f32_16x16x32_bf16 v[196:199],a[24:27],v[68:71],v[196:199]
ds_read_b128 v[64:67],v20 offset:16384
v_mfma_f32_16x16x32_bf16 v[204:207],v[68:71],a[152:155],v[204:207]
s_waitcnt lgkmcnt(2)
v_mfma_f32_16x16x32_bf16 v[192:195],a[28:31],v[72:75],v[192:195]
ds_read_b128 v[68:71],v20 offset:17408
v_mfma_f32_16x16x32_bf16 v[200:203],v[72:75],a[156:159],v[200:203]
s_waitcnt lgkmcnt(2)
v_mfma_f32_16x16x32_bf16 v[196:199],a[28:31],v[76:79],v[196:199]
ds_read_b128 v[72:75],v20 offset:18432
v_mfma_f32_16x16x32_bf16 v[204:207],v[76:79],a[156:159],v[204:207]
s_waitcnt lgkmcnt(2)
v_mfma_f32_16x16x32_bf16 v[192:195],a[32:35],v[64:67],v[192:195]
ds_read_b128 v[76:79],v20 offset:19456
v_mfma_f32_16x16x32_bf16 v[200:203],v[64:67],a[160:163],v[200:203]
s_waitcnt lgkmcnt(2)
v_mfma_f32_16x16x32_bf16 v[196:199],a[32:35],v[68:71],v[196:199]
ds_read_b128 v[64:67],v20 offset:20480
v_mfma_f32_16x16x32_bf16 v[204:207],v[68:71],a[160:163],v[204:207]
s_waitcnt lgkmcnt(2)
v_mfma_f32_16x16x32_bf16 v[192:195],a[36:39],v[72:75],v[192:195]
ds_read_b128 v[68:71],v20 offset:21504
v_mfma_f32_16x16x32_bf16 v[200:203],v[72:75],a[164:167],v[200:203]
s_waitcnt lgkmcnt(2)
v_mfma_f32_16x16x32_bf16 v[196:199],a[36:39],v[76:79],v[196:199]
ds_read_b128 v[72:75],v20 offset:22528
v_mfma_f32_16x16x32_bf16 v[204:207],v[76:79],a[164:167],v[204:207]
s_waitcnt lgkmcnt(2)
v_mfma_f32_16x16x32_bf16 v[192:195],a[40:43],v[64:67],v[192:195]
ds_read_b128 v[76:79],v20 offset:23552
v_mfma_f32_16x16x32_bf16 v[200:203],v[64:67],a[168:171],v[200:203]
s_waitcnt lgkmcnt(2)
v_mfma_f32_16x16x32_bf16 v[196:199],a[40:43],v[68:71],v[196:199]
ds_read_b128 v[64:67],v20 offset:24576
v_mfma_f32_16x16x32_bf16 v[204:207],v[68:71],a[168:171],v[204:207]
s_waitcnt lgkmcnt(2)
v_mfma_f32_16x16x32_bf16 v[192:195],a[44:47],v[72:75],v[192:195]
ds_read_b128 v[68:71],v20 offset:25600
v_mfma_f32_16x16x32_bf16 v[200:203],v[72:75],a[172:175],v[200:203]
s_waitcnt lgkmcnt(2)
v_mfma_f32_16x16x32_bf16 v[196:199],a[44:47],v[76:79],v[196:199]
ds_read_b128 v[72:75],v20 offset:26624
v_mfma_f32_16x16x32_bf16 v[204:207],v[76:79],a[172:175],v[204:207]
s_waitcnt lgkmcnt(2)
v_mfma_f32_16x16x32_bf16 v[192:195],a[48:51],v[64:67],v[192:195]
ds_read_b128 v[76:79],v20 offset:27648
v_mfma_f32_16x16x32_bf16 v[200:203],v[64:67],a[176:179],v[200:203]
s_waitcnt lgkmcnt(2)
v_mfma_f32_16x16x32_bf16 v[196:199],a[48:51],v[68:71],v[196:199]
ds_read_b128 v[64:67],v20 offset:28672
v_mfma_f32_16x16x32_bf16 v[204:207],v[68:71],a[176:179],v[204:207]
s_waitcnt lgkmcnt(2)
v_mfma_f32_16x16x32_bf16 v[192:195],a[52:55],v[72:75],v[192:195]
ds_read_b128 v[68:71],v20 offset:29696
v_mfma_f32_16x16x32_bf16 v[200:203],v[72:75],a[180:183],v[200:203]
s_waitcnt lgkmcnt(2)
v_mfma_f32_16x16x32_bf16 v[196:199],a[52:55],v[76:79],v[196:199]
ds_read_b128 v[72:75],v20 offset:30720
v_mfma_f32_16x16x32_bf16 v[204:207],v[76:79],a[180:183],v[204:207]
s_waitcnt lgkmcnt(2)
v_mfma_f32_16x16x32_bf16 v[192:195],a[56:59],v[64:67],v[192:195]
ds_read_b128 v[76:79],v20 offset:31744
v_mfma_f32_16x16x32_bf16 v[200:203],v[64:67],a[184:187],v[200:203]
s_waitcnt lgkmcnt(2)
v_mfma_f32_16x16x32_bf16 v[196:199],a[56:59],v[68:71],v[196:199]
ds_read_b128 v[64:67],v20 offset:32768
v_mfma_f32_16x16x32_bf16 v[204:207],v[68:71],a[184:187],v[204:207]
s_waitcnt lgkmcnt(2)
v_mfma_f32_16x16x32_bf16 v[192:195],a[60:63],v[72:75],v[192:195]
ds_read_b128 v[68:71],v20 offset:33792
v_mfma_f32_16x16x32_bf16 v[200:203],v[72:75],a[188:191],v[200:203]
s_waitcnt lgkmcnt(2)
v_mfma_f32_16x16x32_bf16 v[196:199],a[60:63],v[76:79],v[196:199]
ds_read_b128 v[72:75],v20 offset:34816
v_mfma_f32_16x16x32_bf16 v[204:207],v[76:79],a[188:191],v[204:207]
s_waitcnt lgkmcnt(2)
v_mfma_f32_16x16x32_bf16 v[192:195],a[64:67],v[64:67],v[192:195]
ds_read_b128 v[76:79],v20 offset:35840
v_mfma_f32_16x16x32_bf16 v[200:203],v[64:67],a[192:195],v[200:203]
s_waitcnt lgkmcnt(2)
v_mfma_f32_16x16x32_bf16 v[196:199],a[64:67],v[68:71],v[196:199]
ds_read_b128 v[64:67],v20 offset:36864
v_mfma_f32_16x16x32_bf16 v[204:207],v[68:71],a[192:195],v[204:207]
s_waitcnt lgkmcnt(2)
v_mfma_f32_16x16x32_bf16 v[192:195],a[68:71],v[72:75],v[192:195]
ds_read_b128 v[68:71],v20 offset:37888
v_mfma_f32_16x16x32_bf16 v[200:203],v[72:75],a[196:199],v[200:203]
s_waitcnt lgkmcnt(2)
v_mfma_f32_16x16x32_bf16 v[196:199],a[68:71],v[76:79],v[196:199]
ds_read_b128 v[72:75],v20 offset:38912
v_mfma_f32_16x16x32_bf16 v[204:207],v[76:79],a[196:199],v[204:207]
s_waitcnt lgkmcnt(2)
v_mfma_f32_16x16x32_bf16 v[192:195],a[72:75],v[64:67],v[192:195]
ds_read_b128 v[76:79],v20 offset:39936
v_mfma_f32_16x16x32_bf16 v[200:203],v[64:67],a[200:203],v[200:203]
s_waitcnt lgkmcnt(2)
v_mfma_f32_16x16x32_bf16 v[196:199],a[72:75],v[68:71],v[196:199]
ds_read_b128 v[64:67],v20 offset:40960
v_mfma_f32_16x16x32_bf16 v[204:207],v[68:71],a[200:203],v[204:207]
s_waitcnt lgkmcnt(2)
v_mfma_f32_16x16x32_bf16 v[192:195],a[76:79],v[72:75],v[192:195]
ds_read_b128 v[68:71],v20 offset:41984
v_mfma_f32_16x16x32_bf16 v[200:203],v[72:75],a[204:207],v[200:203]
s_waitcnt lgkmcnt(2)
v_mfma_f32_16x16x32_bf16 v[196:199],a[76:79],v[76:79],v[196:199]
ds_read_b128 v[72:75],v20 offset:43008
v_mfma_f32_16x16x32_bf16 v[204:207],v[76:79],a[204:207],v[204:207]
s_waitcnt lgkmcnt(2)
v_mfma_f32_16x16x32_bf16 v[192:195],a[80:83],v[64:67],v[192:195]
ds_read_b128 v[76:79],v20 offset:44032
v_mfma_f32_16x16x32_bf16 v[200:203],v[64:67],a[208:211],v[200:203]
s_waitcnt lgkmcnt(2)
v_mfma_f32_16x16x32_bf16 v[196:199],a[80:83],v[68:71],v[196:199]
ds_read_b128 v[64:67],v20 offset:45056
v_mfma_f32_16x16x32_bf16 v[204:207],v[68:71],a[208:211],v[204:207]
s_waitcnt lgkmcnt(2)
v_mfma_f32_16x16x32_bf16 v[192:195],a[84:87],v[72:75],v[192:195]
ds_read_b128 v[68:71],v20 offset:46080
v_mfma_f32_16x16x32_bf16 v[200:203],v[72:75],a[212:215],v[200:203]
s_waitcnt lgkmcnt(2)
v_mfma_f32_16x16x32_bf16 v[196:199],a[84:87],v[76:79],v[196:199]
ds_read_b128 v[72:75],v20 offset:47104
v_mfma_f32_16x16x32_bf16 v[204:207],v[76:79],a[212:215],v[204:207]
s_waitcnt lgkmcnt(2)
v_mfma_f32_16x16x32_bf16 v[192:195],a[88:91],v[64:67],v[192:195]
ds_read_b128 v[76:79],v20 offset:48128
v_mfma_f32_16x16x32_bf16 v[200:203],v[64:67],a[216:219],v[200:203]
s_waitcnt lgkmcnt(2)
v_mfma_f32_16x16x32_bf16 v[196:199],a[88:91],v[68:71],v[196:199]
ds_read_b128 v[64:67],v20 offset:49152
v_mfma_f32_16x16x32_bf16 v[204:207],v[68:71],a[216:219],v[204:207]
s_waitcnt lgkmcnt(2)
v_mfma_f32_16x16x32_bf16 v[192:195],a[92:95],v[72:75],v[192:195]
ds_read_b128 v[68:71],v20 offset:50176
v_mfma_f32_16x16x32_bf16 v[200:203],v[72:75],a[220:223],v[200:203]
s_waitcnt lgkmcnt(2)
v_mfma_f32_16x16x32_bf16 v[196:199],a[92:95],v[76:79],v[196:199]
ds_read_b128 v[72:75],v20 offset:51200
v_mfma_f32_16x16x32_bf16 v[204:207],v[76:79],a[220:223],v[204:207]
s_waitcnt lgkmcnt(2)
v_mfma_f32_16x16x32_bf16 v[192:195],a[96:99],v[64:67],v[192:195]
ds_read_b128 v[76:79],v20 offset:52224
v_mfma_f32_16x16x32_bf16 v[200:203],v[64:67],a[224:227],v[200:203]
s_waitcnt lgkmcnt(2)
v_mfma_f32_16x16x32_bf16 v[196:199],a[96:99],v[68:71],v[196:199]
ds_read_b128 v[64:67],v20 offset:53248
v_mfma_f32_16x16x32_bf16 v[204:207],v[68:71],a[224:227],v[204:207]
s_waitcnt lgkmcnt(2)
v_mfma_f32_16x16x32_bf16 v[192:195],a[100:103],v[72:75],v[192:195]
ds_read_b128 v[68:71],v20 offset:54272
v_mfma_f32_16x16x32_bf16 v[200:203],v[72:75],a[228:231],v[200:203]
s_waitcnt lgkmcnt(2)
v_mfma_f32_16x16x32_bf16 v[196:199],a[100:103],v[76:79],v[196:199]
ds_read_b128 v[72:75],v20 offset:55296
v_mfma_f32_16x16x32_bf16 v[204:207],v[76:79],a[228:231],v[204:207]
s_waitcnt lgkmcnt(2)
v_mfma_f32_16x16x32_bf16 v[192:195],a[104:107],v[64:67],v[192:195]
ds_read_b128 v[76:79],v20 offset:56320
v_mfma_f32_16x16x32_bf16 v[200:203],v[64:67],a[232:235],v[200:203]
s_waitcnt lgkmcnt(2)
v_mfma_f32_16x16x32_bf16 v[196:199],a[104:107],v[68:71],v[196:199]
ds_read_b128 v[64:67],v20 offset:57344
v_mfma_f32_16x16x32_bf16 v[204:207],v[68:71],a[232:235],v[204:207]
s_waitcnt lgkmcnt(2)
v_mfma_f32_16x16x32_bf16 v[192:195],a[108:111],v[72:75],v[192:195]
ds_read_b128 v[68:71],v20 offset:58368
v_mfma_f32_16x16x32_bf16 v[200:203],v[72:75],a[236:239],v[200:203]
s_waitcnt lgkmcnt(2)
v_mfma_f32_16x16x32_bf16 v[196:199],a[108:111],v[76:79],v[196:199]
ds_read_b128 v[72:75],v20 offset:59392
v_mfma_f32_16x16x32_bf16 v[204:207],v[76:79],a[236:239],v[204:207]
s_waitcnt lgkmcnt(2)
v_mfma_f32_16x16x32_bf16 v[192:195],a[112:115],v[64:67],v[192:195]
ds_read_b128 v[76:79],v20 offset:60416
v_mfma_f32_16x16x32_bf16 v[200:203],v[64:67],a[240:243],v[200:203]
s_waitcnt lgkmcnt(2)
v_mfma_f32_16x16x32_bf16 v[196:199],a[112:115],v[68:71],v[196:199]
ds_read_b128 v[64:67],v20 offset:61440
v_mfma_f32_16x16x32_bf16 v[204:207],v[68:71],a[240:243],v[204:207]
s_waitcnt lgkmcnt(2)
v_mfma_f32_16x16x32_bf16 v[192:195],a[116:119],v[72:75],v[192:195]
ds_read_b128 v[68:71],v20 offset:62464
v_mfma_f32_16x16x32_bf16 v[200:203],v[72:75],a[244:247],v[200:203]
s_waitcnt lgkmcnt(2)
v_mfma_f32_16x16x32_bf16 v[196:199],a[116:119],v[76:79],v[196:199]
ds_read_b128 v[72:75],v20 offset:63488
v_mfma_f32_16x16x32_bf16 v[204:207],v[76:79],a[244:247],v[204:207]
s_waitcnt lgkmcnt(2)
v_mfma_f32_16x16x32_bf16 v[192:195],a[120:123],v[64:67],v[192:195]
ds_read_b128 v[76:79],v20 offset:64512
v_mfma_f32_16x16x32_bf16 v[200:203],v[64:67],a[248:251],v[200:203]
s_waitcnt lgkmcnt(2)
v_mfma_f32_16x16x32_bf16 v[196:199],a[120:123],v[68:71],v[196:199]
v_mfma_f32_16x16x32_bf16 v[204:207],v[68:71],a[248:251],v[204:207]
s_waitcnt lgkmcnt(1)
v_mfma_f32_16x16x32_bf16 v[192:195],a[124:127],v[72:75],v[192:195]
v_mfma_f32_16x16x32_bf16 v[200:203],v[72:75],a[252:255],v[200:203]
s_waitcnt lgkmcnt(0)
v_mfma_f32_16x16x32_bf16 v[196:199],a[124:127],v[76:79],v[196:199]
v_mfma_f32_16x16x32_bf16 v[204:207],v[76:79],a[252:255],v[204:207]
v_xor_b32 v20,0x10000,v20
s_xor_b32 s62,s62,0x10000
s_lshr_b32 s64,s73,9
v_add_u32 v22,s64,v24
v_cvt_pk_bf16_f32 v208,v192,v193
v_cvt_pk_bf16_f32 v209,v194,v195
s_nop 0
v_cvt_pk_bf16_f32 v210,v196,v197
v_cvt_pk_bf16_f32 v211,v198,v199
v_cvt_pk_bf16_f32 v212,v200,v201
v_cvt_pk_bf16_f32 v213,v202,v203
v_cvt_pk_bf16_f32 v214,v204,v205
v_cvt_pk_bf16_f32 v215,v206,v207
v_permlane16_swap_b32 v208,v210
v_permlane16_swap_b32 v209,v211
buffer_store_dwordx4 v[208:211],v2,s[24:27],s73 offen
buffer_store_dwordx4 v[208:211],v2,s[28:31],s73 offen sc1
ds_write_b128 v22,v[212:215] offset:17408
buffer_store_dwordx4 v[208:211],v17,s[20:23],s12 offen sc1
bgx_150:
s_add_u32 s63,s79,1
s_and_b32 s64,s63,3
s_lshl_b32 s70,s64,20
s_add_u32 s65,s63,2
s_and_b32 s65,s65,3
s_lshl_b32 s73,s65,20
s_add_u32 s55,s63,3
s_lshl_b32 s78,s55,16
s_add_u32 s78,s78,57344
s_cmp_lt_u32 s55,64
s_cselect_b32 s78,s78,0x7fff0000
s_add_u32 s60,s63,1
s_lshl_b32 s76,s60,21
s_lshl_b32 s55,s60,13
s_and_b32 s55,s55,0x2000
s_xor_b32 s55,s55,s61
s_add_u32 s76,s76,s55
s_cmp_lt_u32 s60,64
s_cselect_b32 s76,s76,0x7fff0000
s_add_u32 s60,s63,2
s_lshl_b32 s12,s60,21
s_lshl_b32 s55,s60,13
s_and_b32 s55,s55,0x2000
s_xor_b32 s55,s55,s61
s_add_u32 s12,s12,s55
s_cmp_lt_u32 s60,64
s_cselect_b32 s12,s12,0x7fff0000
s_add_u32 s55,s63,5
s_min_u32 s55,s55,63
s_lshl_b32 s55,s55,16
s_lshl_b32 s60,s59,11
s_add_u32 s80,s55,s60
s_add_u32 s80,s80,57344
v_mov_b32 v176,0
v_mov_b32 v177,0
v_mov_b32 v178,0
v_mov_b32 v179,0
v_mov_b32 v180,0
v_mov_b32 v181,0
v_mov_b32 v182,0
v_mov_b32 v183,0
s_add_u32 s79,s79,1
s_cmp_eq_u32 s79,0
s_cbranch_scc1 pn2_149
v_mov_b32 v38,1
ds_write_b32 v37,v38 offset:12
buffer_store_dwordx4 v[212:215],v12,s[20:23],s76 offen sc1
s_waitcnt lgkmcnt(0)
s_branch pn1_148
pn2_149:
v_mov_b32 v25,1
s_waitcnt vmcnt(1) lgkmcnt(0)
s_barrier
s_branch loop_136
w3_61:
v_xor_b32 v9,0x10000,v8
v_xor_b32 v10,0x20000,v8
v_xor_b32 v11,0x30000,v8
v_and_b32 v22,2,v4
v_lshrrev_b32 v23,3,v3
v_add_u32 v22,v22,v23
v_lshlrev_b32 v22,3,v22
v_and_b32 v23,1,v4
v_lshl_add_u32 v22,v23,2,v22
v_and_b32 v23,3,v3
v_add_u32 v22,v22,v23
v_lshlrev_b32 v22,4,v22
v_bfe_u32 v23,v3,2,1
v_lshl_add_u32 v22,v23,3,v22
v_add_u32 v30,s66,v22
v_and_b32 v22,7,v3
v_lshl_add_u32 v12,v4,3,v22
v_lshlrev_b32 v12,4,v12
v_add_u32 v12,s66,v12
s_branch first_151
loop_152:
s_barrier
buffer_load_dword v248,v18,s[20:23],s70 offen offset:0 sc1
s_nop 15
s_nop 5
hl_154:
buffer_load_dword v249,v18,s[20:23],s70 offen offset:0 sc1
s_waitcnt vmcnt(1)
v_cmp_eq_u32 vcc,v25,v248
s_bcnt1_i32_b32 s64,vcc_lo
s_cmp_ge_u32 s64,8
s_cbranch_scc1 hg_155
buffer_load_dword v248,v18,s[20:23],s70 offen offset:0 sc1
s_waitcnt vmcnt(1)
v_cmp_eq_u32 vcc,v25,v249
s_bcnt1_i32_b32 s64,vcc_lo
s_cmp_ge_u32 s64,8
s_cbranch_scc1 hg_155
s_sub_u32 s90,s90,1
s_cmp_gt_i32 s90,0
s_cbranch_scc1 hl_154
hg_155:
buffer_load_dwordx4 v[80:83],v29,s[20:23],s70 offen offset:0 sc1
buffer_load_dwordx4 v[84:87],v29,s[20:23],s70 offen offset:1024 sc1
buffer_load_dwordx4 v[88:91],v29,s[20:23],s70 offen offset:2048 sc1
buffer_load_dwordx4 v[92:95],v29,s[20:23],s70 offen offset:3072 sc1
s_waitcnt vmcnt(3)
ds_write_b128 v24,v[80:83] offset:12288
v_min3_u32 v22,v80,v81,v82
v_min_u32 v22,v22,v83
s_waitcnt vmcnt(2)
ds_write_b128 v24,v[84:87] offset:13312
v_min3_u32 v22,v22,v84,v85
v_min3_u32 v22,v22,v86,v87
s_waitcnt vmcnt(1)
ds_write_b128 v24,v[88:91] offset:14336
v_min3_u32 v22,v22,v88,v89
v_min3_u32 v22,v22,v90,v91
s_waitcnt vmcnt(0)
ds_write_b128 v24,v[92:95] offset:15360
v_min3_u32 v22,v22,v92,v93
v_min3_u32 v22,v22,v94,v95
v_cmp_eq_u32 vcc,0,v22
s_cbranch_vccnz art_156
abk_157:
v_smfmac_f32_16x16x64_bf16 v[176:179],v[80:83],a[96:103],v14
s_waitcnt lgkmcnt(0)
s_barrier
ds_read_b128 v[32:35],v24 offset:0
ds_read_b128 v[36:39],v24 offset:1024
ds_read_b128 v[40:43],v24 offset:2048
ds_read_b128 v[44:47],v24 offset:3072
v_smfmac_f32_16x16x64_bf16 v[176:179],v[84:87],a[104:111],v14
ds_read_b128 v[48:51],v24 offset:4096
ds_read_b128 v[52:55],v24 offset:5120
v_smfmac_f32_16x16x64_bf16 v[176:179],v[88:91],a[112:119],v14
ds_read_b128 v[56:59],v24 offset:6144
ds_read_b128 v[60:63],v24 offset:7168
v_smfmac_f32_16x16x64_bf16 v[176:179],v[92:95],a[120:127],v14
ds_read_b128 v[64:67],v24 offset:8192
ds_read_b128 v[68:71],v24 offset:9216
s_waitcnt lgkmcnt(9)
v_smfmac_f32_16x16x64_bf16 v[176:179],v[32:35],a[0:7],v14
ds_read_b128 v[72:75],v24 offset:10240
s_waitcnt lgkmcnt(9)
v_smfmac_f32_16x16x64_bf16 v[176:179],v[36:39],a[8:15],v14
ds_read_b128 v[76:79],v24 offset:11264
s_waitcnt lgkmcnt(9)
v_smfmac_f32_16x16x64_bf16 v[176:179],v[40:43],a[16:23],v14
s_waitcnt lgkmcnt(8)
v_smfmac_f32_16x16x64_bf16 v[176:179],v[44:47],a[24:31],v14
s_waitcnt lgkmcnt(7)
v_smfmac_f32_16x16x64_bf16 v[176:179],v[48:51],a[32:39],v14
s_waitcnt lgkmcnt(6)
v_smfmac_f32_16x16x64_bf16 v[176:179],v[52:55],a[40:47],v14
s_waitcnt lgkmcnt(5)
v_smfmac_f32_16x16x64_bf16 v[176:179],v[56:59],a[48:55],v14
s_waitcnt lgkmcnt(4)
v_smfmac_f32_16x16x64_bf16 v[176:179],v[60:63],a[56:63],v14
s_waitcnt lgkmcnt(3)
v_smfmac_f32_16x16x64_bf16 v[176:179],v[64:67],a[64:71],v14
s_waitcnt lgkmcnt(2)
v_smfmac_f32_16x16x64_bf16 v[176:179],v[68:71],a[72:79],v14
s_waitcnt lgkmcnt(1)
v_smfmac_f32_16x16x64_bf16 v[176:179],v[72:75],a[80:87],v14
s_waitcnt lgkmcnt(0)
v_smfmac_f32_16x16x64_bf16 v[176:179],v[76:79],a[88:95],v14
s_nop 7
v_permlane32_swap_b32 v176,v178
v_permlane32_swap_b32 v177,v179
v_add_f32 v176,v176,v178
v_add_f32 v177,v177,v179
v_cvt_pk_bf16_f32 v216,v176,v177
s_nop 1
v_mov_b32_dpp v217,v216 quad_perm:[1,0,3,2] row_mask:0xf bank_mask:0xf
v_perm_b32 v216,v217,v216,v15
v_max_u32 v216,1,v216
buffer_store_dword v216,v19,s[24:27],s70 offen
buffer_store_dword v216,v19,s[28:31],s70 offen sc1
s_cmp_eq_u32 s79,63
s_cbranch_scc1 end_57
s_nop 15
s_nop 15
s_nop 15
s_nop 15
s_nop 10
s_add_u32 m0,s62,53248
s_add_u32 s69,s78,53248
buffer_load_dwordx4 v16,s[20:23],s69 offen offset:0 lds
s_nop 3
buffer_load_dwordx4 v16,s[20:23],s69 offen offset:1024 lds
s_nop 3
buffer_load_dwordx4 v16,s[20:23],s69 offen offset:2048 lds
s_nop 3
buffer_load_dwordx4 v16,s[20:23],s69 offen offset:3072 lds
s_nop 3
s_add_u32 m0,s62,57344
s_add_u32 s69,s78,57344
buffer_load_dwordx4 v16,s[20:23],s69 offen offset:0 lds
s_nop 3
buffer_load_dwordx4 v16,s[20:23],s69 offen offset:1024 lds
s_nop 3
buffer_load_dwordx4 v16,s[20:23],s69 offen offset:2048 lds
s_nop 3
buffer_load_dwordx4 v16,s[20:23],s69 offen offset:3072 lds
s_nop 3
s_add_u32 m0,s62,61440
s_add_u32 s69,s78,61440
buffer_load_dwordx4 v16,s[20:23],s69 offen offset:0 lds
s_nop 3
buffer_load_dwordx4 v16,s[20:23],s69 offen offset:1024 lds
s_nop 3
buffer_load_dwordx4 v16,s[20:23],s69 offen offset:2048 lds
s_nop 3
buffer_load_dwordx4 v16,s[20:23],s69 offen offset:3072 lds
s_nop 3
s_xor_b32 s62,s62,0x10000
wf_158:
ds_read_b32 v23,v21 offset:8
s_sub_u32 s90,s90,1
s_waitcnt lgkmcnt(0)
v_cmp_ne_u32 vcc,v23,v25
s_cmp_lt_i32 s90,0
s_cselect_b64 vcc,0,vcc
s_cbranch_vccnz wf_158
hl_159:
buffer_load_dword v248,v18,s[20:23],s70 offen offset:512 sc1
s_waitcnt vmcnt(0)
v_cmp_eq_u32 vcc,v25,v248
s_bcnt1_i32_b32 s64,vcc_lo
s_cmp_ge_u32 s64,16
s_cbranch_scc1 hg_160
s_sub_u32 s90,s90,1
s_cmp_gt_i32 s90,0
s_cbranch_scc1 hl_159
hg_160:
buffer_load_dwordx4 v[32:35],v28,s[20:23],s71 offen offset:0 sc1
buffer_load_dwordx4 v[36:39],v28,s[20:23],s71 offen offset:1024 sc1
buffer_load_dwordx4 v[40:43],v28,s[20:23],s71 offen offset:2048 sc1
buffer_load_dwordx4 v[44:47],v28,s[20:23],s71 offen offset:3072 sc1
buffer_load_dwordx4 v[48:51],v29,s[20:23],s71 offen offset:0 sc1
buffer_load_dwordx4 v[52:55],v29,s[20:23],s71 offen offset:1024 sc1
buffer_load_dwordx4 v[56:59],v29,s[20:23],s71 offen offset:2048 sc1
buffer_load_dwordx4 v[60:63],v29,s[20:23],s71 offen offset:3072 sc1
s_mov_b32 s68,0
s_waitcnt vmcnt(6)
v_smfmac_f32_16x16x64_bf16 v[184:187],v[32:35],a[128:135],v14
v_min3_u32 v22,v32,v33,v34
v_min3_u32 v22,v22,v35,v36
v_smfmac_f32_16x16x64_bf16 v[188:191],v[32:35],a[136:143],v14
v_min3_u32 v22,v22,v37,v38
v_smfmac_f32_16x16x64_bf16 v[184:187],v[36:39],a[144:151],v14
v_min_u32 v22,v22,v39
v_smfmac_f32_16x16x64_bf16 v[188:191],v[36:39],a[152:159],v14
v_cmp_eq_u32 s[52:53],0,v22
s_waitcnt vmcnt(4)
v_smfmac_f32_16x16x64_bf16 v[184:187],v[40:43],a[160:167],v14
v_min3_u32 v22,v40,v41,v42
s_cmp_lg_u64 s[52:53],0
v_smfmac_f32_16x16x64_bf16 v[188:191],v[40:43],a[168:175],v14
s_cbranch_scc1 ms_161
bk_162:
v_min3_u32 v22,v22,v43,v44
v_smfmac_f32_16x16x64_bf16 v[184:187],v[44:47],a[176:183],v14
v_min3_u32 v22,v22,v45,v46
v_min_u32 v22,v22,v47
v_smfmac_f32_16x16x64_bf16 v[188:191],v[44:47],a[184:191],v14
v_cmp_eq_u32 s[54:55],0,v22
s_waitcnt vmcnt(2)
v_smfmac_f32_16x16x64_bf16 v[184:187],v[48:51],a[192:199],v14
v_min3_u32 v22,v48,v49,v50
s_cmp_lg_u64 s[54:55],0
v_smfmac_f32_16x16x64_bf16 v[188:191],v[48:51],a[200:207],v14
s_cbranch_scc1 ms_163
bk_164:
v_min3_u32 v22,v22,v51,v52
v_smfmac_f32_16x16x64_bf16 v[184:187],v[52:55],a[208:215],v14
v_min3_u32 v22,v22,v53,v54
v_min_u32 v22,v22,v55
v_smfmac_f32_16x16x64_bf16 v[188:191],v[52:55],a[216:223],v14
v_cmp_eq_u32 s[52:53],0,v22
s_waitcnt vmcnt(0)
v_smfmac_f32_16x16x64_bf16 v[184:187],v[56:59],a[224:231],v14
v_min3_u32 v22,v56,v57,v58
s_cmp_lg_u64 s[52:53],0
v_smfmac_f32_16x16x64_bf16 v[188:191],v[56:59],a[232:239],v14
s_cbranch_scc1 ms_165
bk_166:
v_min3_u32 v22,v22,v59,v60
v_smfmac_f32_16x16x64_bf16 v[184:187],v[60:63],a[240:247],v14
v_min3_u32 v22,v22,v61,v62
v_min_u32 v22,v22,v63
v_smfmac_f32_16x16x64_bf16 v[188:191],v[60:63],a[248:255],v14
v_cmp_eq_u32 s[54:55],0,v22
s_cmp_lg_u64 s[54:55],0
s_cbranch_scc1 ms_169
bk_170:
s_cmp_lg_u32 s68,0
s_cbranch_scc1 rl2_171
fin_167:
s_nop 2
v_permlane32_swap_b32 v184,v188
v_permlane32_swap_b32 v185,v189
v_permlane32_swap_b32 v186,v190
v_permlane32_swap_b32 v187,v191
v_pk_add_f32 v[184:185],v[184:185],v[188:189]
v_pk_add_f32 v[186:187],v[186:187],v[190:191]
wf_172:
ds_read_b32 v23,v21 offset:12
ds_read_b128 v[216:219],v24 offset:25600
s_sub_u32 s90,s90,1
s_waitcnt lgkmcnt(0)
v_cmp_ne_u32 vcc,v23,v25
s_cmp_lt_i32 s90,0
s_cselect_b64 vcc,0,vcc
v_pk_add_f32 v[216:217],v[216:217],v[184:185]
v_pk_add_f32 v[218:219],v[218:219],v[186:187]
s_cbranch_vccnz wf_172
v_max_u32 v216,1,v216
v_max_u32 v217,1,v217
v_max_u32 v218,1,v218
v_max_u32 v219,1,v219
buffer_store_dwordx4 v[216:219],v8,s[20:23],s74 offen sc1
s_mov_b32 s88,s74
s_mov_b32 s89,s72
v_add_u32 v25,1,v25
s_add_u32 s63,s79,1
s_and_b32 s64,s63,3
s_lshl_b32 s70,s64,20
s_add_u32 s65,s63,2
s_and_b32 s65,s65,3
s_lshl_b32 s73,s65,20
s_add_u32 s55,s63,3
s_lshl_b32 s78,s55,16
s_add_u32 s78,s78,57344
s_cmp_lt_u32 s55,64
s_cselect_b32 s78,s78,0x7fff0000
s_add_u32 s71,s70,65536
s_add_u32 s60,s63,1
s_and_b32 s60,s60,3
s_lshl_b32 s72,s60,20
v_mov_b32 v184,0
v_mov_b32 v185,0
v_mov_b32 v186,0
v_mov_b32 v187,0
v_mov_b32 v188,0
v_mov_b32 v189,0
v_mov_b32 v190,0
v_mov_b32 v191,0
s_lshl_b32 s74,s63,21
s_lshl_b32 s55,s63,13
s_and_b32 s55,s55,0x2000
s_xor_b32 s55,s55,s61
s_add_u32 s74,s74,s55
v_mov_b32 v176,0
v_mov_b32 v177,0
v_mov_b32 v178,0
v_mov_b32 v179,0
s_nop 15
s_nop 15
s_nop 15
s_nop 15
s_nop 5
pp_173:
buffer_load_dwordx4 v[32:35],v9,s[20:23],s88 offen sc1
buffer_load_dwordx4 v[36:39],v10,s[20:23],s88 offen sc1
buffer_load_dwordx4 v[40:43],v11,s[20:23],s88 offen sc1
s_waitcnt vmcnt(2)
v_min3_u32 v22,v32,v33,v34
v_pk_add_f32 v[220:221],v[216:217],v[32:33]
v_pk_add_f32 v[222:223],v[218:219],v[34:35]
s_waitcnt vmcnt(0)
v_min3_u32 v22,v22,v35,v36
v_min3_u32 v22,v22,v37,v38
v_min3_u32 v22,v22,v39,v40
v_min3_u32 v22,v22,v41,v42
v_min_u32 v22,v22,v43
v_pk_add_f32 v[36:37],v[36:37],v[40:41]
v_cmp_eq_u32 vcc,0,v22
v_pk_add_f32 v[38:39],v[38:39],v[42:43]
s_cbranch_vccz pok_174
s_sub_u32 s90,s90,1
s_cmp_gt_i32 s90,0
s_cbranch_scc1 pp_173
pok_174:
v_pk_add_f32 v[220:221],v[220:221],v[36:37]
v_pk_add_f32 v[222:223],v[222:223],v[38:39]
s_mov_b64 vcc,s[86:87]
v_cvt_pk_bf16_f32 v216,v220,v221
v_cvt_pk_bf16_f32 v217,v222,v223
s_nop 0
v_mov_b32_dpp v218,v216 quad_perm:[1,0,3,2] row_mask:0xf bank_mask:0xf
v_mov_b32_dpp v219,v217 quad_perm:[1,0,3,2] row_mask:0xf bank_mask:0xf
v_perm_b32 v216,v218,v216,v15
v_perm_b32 v217,v219,v217,v15
s_nop 1
v_cndmask_b32_dpp v220,v217,v216,vcc quad_perm:[2,3,0,1] row_mask:0xf bank_mask:0xf
s_not_b64 vcc,vcc
v_cndmask_b32_dpp v221,v216,v217,vcc quad_perm:[2,3,0,1] row_mask:0xf bank_mask:0xf
v_max_u32 v220,1,v220
v_max_u32 v221,1,v221
buffer_store_dwordx2 v[220:221],v30,s[24:27],s89 offen
buffer_store_dwordx2 v[220:221],v30,s[28:31],s89 offen sc1
s_mov_b64 exec,1
buffer_store_dword v25,v13,s[24:27],s89 offen
buffer_store_dword v25,v13,s[28:31],s89 offen sc1
s_mov_b64 exec,-1
s_add_u32 s79,s79,1
s_branch loop_152
art_156:
s_sub_u32 s90,s90,1
s_cmp_lt_i32 s90,0
s_cbranch_scc1 abk_157
buffer_load_dwordx4 v[80:83],v29,s[20:23],s70 offen offset:0 sc1
buffer_load_dwordx4 v[84:87],v29,s[20:23],s70 offen offset:1024 sc1
buffer_load_dwordx4 v[88:91],v29,s[20:23],s70 offen offset:2048 sc1
buffer_load_dwordx4 v[92:95],v29,s[20:23],s70 offen offset:3072 sc1
s_waitcnt vmcnt(3)
ds_write_b128 v24,v[80:83] offset:12288
v_min3_u32 v22,v80,v81,v82
v_min_u32 v22,v22,v83
s_waitcnt vmcnt(2)
ds_write_b128 v24,v[84:87] offset:13312
v_min3_u32 v22,v22,v84,v85
v_min3_u32 v22,v22,v86,v87
s_waitcnt vmcnt(1)
ds_write_b128 v24,v[88:91] offset:14336
v_min3_u32 v22,v22,v88,v89
v_min3_u32 v22,v22,v90,v91
s_waitcnt vmcnt(0)
ds_write_b128 v24,v[92:95] offset:15360
v_min3_u32 v22,v22,v92,v93
v_min3_u32 v22,v22,v94,v95
v_cmp_eq_u32 vcc,0,v22
s_cbranch_vccnz art_156
s_branch abk_157
ms_161:
s_waitcnt vmcnt(0)
buffer_load_dwordx4 v[64:67],v28,s[20:23],s71 offen offset:0 sc1
buffer_load_dwordx4 v[68:71],v28,s[20:23],s71 offen offset:1024 sc1
s_bitset1_b32 s68,0
s_branch bk_162
ms_163:
s_waitcnt vmcnt(0)
buffer_load_dwordx4 v[72:75],v28,s[20:23],s71 offen offset:2048 sc1
buffer_load_dwordx4 v[76:79],v28,s[20:23],s71 offen offset:3072 sc1
s_bitset1_b32 s68,1
s_branch bk_164
ms_165:
s_waitcnt vmcnt(0)
buffer_load_dwordx4 v[80:83],v29,s[20:23],s71 offen offset:0 sc1
buffer_load_dwordx4 v[84:87],v29,s[20:23],s71 offen offset:1024 sc1
s_bitset1_b32 s68,2
s_branch bk_166
ms_169:
s_waitcnt vmcnt(0)
buffer_load_dwordx4 v[88:91],v29,s[20:23],s71 offen offset:2048 sc1
buffer_load_dwordx4 v[92:95],v29,s[20:23],s71 offen offset:3072 sc1
s_bitset1_b32 s68,3
s_branch bk_170
rl_168:
s_bitcmp1_b32 s68,0
s_cbranch_scc0 sk_175
buffer_load_dwordx4 v[64:67],v28,s[20:23],s71 offen offset:0 sc1
buffer_load_dwordx4 v[68:71],v28,s[20:23],s71 offen offset:1024 sc1
sk_175:
s_bitcmp1_b32 s68,1
s_cbranch_scc0 sk_176
buffer_load_dwordx4 v[72:75],v28,s[20:23],s71 offen offset:2048 sc1
buffer_load_dwordx4 v[76:79],v28,s[20:23],s71 offen offset:3072 sc1
sk_176:
s_bitcmp1_b32 s68,2
s_cbranch_scc0 sk_177
buffer_load_dwordx4 v[80:83],v29,s[20:23],s71 offen offset:0 sc1
buffer_load_dwordx4 v[84:87],v29,s[20:23],s71 offen offset:1024 sc1
sk_177:
s_bitcmp1_b32 s68,3
s_cbranch_scc0 sk_178
buffer_load_dwordx4 v[88:91],v29,s[20:23],s71 offen offset:2048 sc1
buffer_load_dwordx4 v[92:95],v29,s[20:23],s71 offen offset:3072 sc1
sk_178:
rl2_171:
s_sub_u32 s90,s90,1
s_cmp_lt_i32 s90,0
s_cbranch_scc1 fin_167
s_waitcnt vmcnt(0)
s_bitcmp1_b32 s68,0
s_cbranch_scc0 sk_179
v_min3_u32 v22,v64,v65,v66
v_min3_u32 v22,v22,v67,v68
v_min3_u32 v22,v22,v69,v70
v_min_u32 v22,v22,v71
v_cmp_eq_u32 vcc,0,v22
v_xor_b32 v64,v32,v64
v_xor_b32 v65,v33,v65
v_xor_b32 v66,v34,v66
v_xor_b32 v67,v35,v67
v_xor_b32 v68,v36,v68
v_xor_b32 v69,v37,v69
v_xor_b32 v70,v38,v70
v_xor_b32 v71,v39,v71
s_cbranch_vccnz nb_180
s_bitset0_b32 s68,0
v_smfmac_f32_16x16x64_bf16 v[184:187],v[64:67],a[128:135],v14
v_smfmac_f32_16x16x64_bf16 v[188:191],v[64:67],a[136:143],v14
v_smfmac_f32_16x16x64_bf16 v[184:187],v[68:71],a[144:151],v14
v_smfmac_f32_16x16x64_bf16 v[188:191],v[68:71],a[152:159],v14
nb_180:
sk_179:
s_bitcmp1_b32 s68,1
s_cbranch_scc0 sk_181
v_min3_u32 v22,v72,v73,v74
v_min3_u32 v22,v22,v75,v76
v_min3_u32 v22,v22,v77,v78
v_min_u32 v22,v22,v79
v_cmp_eq_u32 vcc,0,v22
v_xor_b32 v72,v40,v72
v_xor_b32 v73,v41,v73
v_xor_b32 v74,v42,v74
v_xor_b32 v75,v43,v75
v_xor_b32 v76,v44,v76
v_xor_b32 v77,v45,v77
v_xor_b32 v78,v46,v78
v_xor_b32 v79,v47,v79
s_cbranch_vccnz nb_182
s_bitset0_b32 s68,1
v_smfmac_f32_16x16x64_bf16 v[184:187],v[72:75],a[160:167],v14
v_smfmac_f32_16x16x64_bf16 v[188:191],v[72:75],a[168:175],v14
v_smfmac_f32_16x16x64_bf16 v[184:187],v[76:79],a[176:183],v14
v_smfmac_f32_16x16x64_bf16 v[188:191],v[76:79],a[184:191],v14
nb_182:
sk_181:
s_bitcmp1_b32 s68,2
s_cbranch_scc0 sk_183
v_min3_u32 v22,v80,v81,v82
v_min3_u32 v22,v22,v83,v84
v_min3_u32 v22,v22,v85,v86
v_min_u32 v22,v22,v87
v_cmp_eq_u32 vcc,0,v22
v_xor_b32 v80,v48,v80
v_xor_b32 v81,v49,v81
v_xor_b32 v82,v50,v82
v_xor_b32 v83,v51,v83
v_xor_b32 v84,v52,v84
v_xor_b32 v85,v53,v85
v_xor_b32 v86,v54,v86
v_xor_b32 v87,v55,v87
s_cbranch_vccnz nb_184
s_bitset0_b32 s68,2
v_smfmac_f32_16x16x64_bf16 v[184:187],v[80:83],a[192:199],v14
v_smfmac_f32_16x16x64_bf16 v[188:191],v[80:83],a[200:207],v14
v_smfmac_f32_16x16x64_bf16 v[184:187],v[84:87],a[208:215],v14
v_smfmac_f32_16x16x64_bf16 v[188:191],v[84:87],a[216:223],v14
nb_184:
sk_183:
s_bitcmp1_b32 s68,3
s_cbranch_scc0 sk_185
v_min3_u32 v22,v88,v89,v90
v_min3_u32 v22,v22,v91,v92
v_min3_u32 v22,v22,v93,v94
v_min_u32 v22,v22,v95
v_cmp_eq_u32 vcc,0,v22
v_xor_b32 v88,v56,v88
v_xor_b32 v89,v57,v89
v_xor_b32 v90,v58,v90
v_xor_b32 v91,v59,v91
v_xor_b32 v92,v60,v92
v_xor_b32 v93,v61,v93
v_xor_b32 v94,v62,v94
v_xor_b32 v95,v63,v95
s_cbranch_vccnz nb_186
s_bitset0_b32 s68,3
v_smfmac_f32_16x16x64_bf16 v[184:187],v[88:91],a[224:231],v14
v_smfmac_f32_16x16x64_bf16 v[188:191],v[88:91],a[232:239],v14
v_smfmac_f32_16x16x64_bf16 v[184:187],v[92:95],a[240:247],v14
v_smfmac_f32_16x16x64_bf16 v[188:191],v[92:95],a[248:255],v14
nb_186:
sk_185:
s_cmp_lg_u32 s68,0
s_cbranch_scc1 rl_168
s_nop 2
s_branch fin_167
first_151:
s_waitcnt vmcnt(0) lgkmcnt(0)
s_barrier
s_add_u32 s64,s15,393216
buffer_load_dwordx4 a[176:179],v32,s[40:43],s64 offen nt
s_add_u32 s64,s15,425984
buffer_load_dwordx4 a[180:183],v32,s[40:43],s64 offen nt
s_add_u32 s64,s15,458752
buffer_load_dwordx4 a[184:187],v32,s[40:43],s64 offen nt
s_add_u32 s64,s15,491520
buffer_load_dwordx4 a[188:191],v32,s[40:43],s64 offen nt
s_add_u32 s64,s15,524288
buffer_load_dwordx4 a[192:195],v32,s[40:43],s64 offen nt
s_add_u32 s64,s15,557056
buffer_load_dwordx4 a[196:199],v32,s[40:43],s64 offen nt
s_add_u32 s64,s15,589824
buffer_load_dwordx4 a[200:203],v32,s[40:43],s64 offen nt
s_add_u32 s64,s15,622592
buffer_load_dwordx4 a[204:207],v32,s[40:43],s64 offen nt
s_add_u32 s64,s15,655360
buffer_load_dwordx4 a[208:211],v32,s[40:43],s64 offen nt
s_add_u32 s64,s15,688128
buffer_load_dwordx4 a[212:215],v32,s[40:43],s64 offen nt
s_add_u32 s64,s15,720896
buffer_load_dwordx4 a[216:219],v32,s[40:43],s64 offen nt
s_add_u32 s64,s15,753664
buffer_load_dwordx4 a[220:223],v32,s[40:43],s64 offen nt
s_add_u32 s64,s15,786432
buffer_load_dwordx4 a[224:227],v32,s[40:43],s64 offen nt
s_add_u32 s64,s15,819200
buffer_load_dwordx4 a[228:231],v32,s[40:43],s64 offen nt
s_add_u32 s64,s15,851968
buffer_load_dwordx4 a[232:235],v32,s[40:43],s64 offen nt
s_add_u32 s64,s15,884736
buffer_load_dwordx4 a[236:239],v32,s[40:43],s64 offen nt
s_add_u32 s64,s15,917504
buffer_load_dwordx4 a[240:243],v32,s[40:43],s64 offen nt
s_add_u32 s64,s15,950272
buffer_load_dwordx4 a[244:247],v32,s[40:43],s64 offen nt
s_add_u32 s64,s15,983040
buffer_load_dwordx4 a[248:251],v32,s[40:43],s64 offen nt
s_add_u32 s64,s15,1015808
buffer_load_dwordx4 a[252:255],v32,s[40:43],s64 offen nt
ds_write_b128 v33,a[0:3] offset:0
ds_write_b128 v33,a[4:7] offset:1024
ds_write_b128 v33,a[8:11] offset:2048
ds_write_b128 v33,a[12:15] offset:3072
s_waitcnt lgkmcnt(0)
v_mov_b32 v38,1
ds_write_b32 v37,v38 offset:4
qs_187:
ds_read_b32 v39,v37 offset:0
s_sub_u32 s90,s90,1
s_waitcnt lgkmcnt(0)
v_cmp_gt_u32 vcc,v38,v39
s_cmp_lt_i32 s90,0
s_cselect_b64 vcc,0,vcc
s_cbranch_vccnz qs_187
ds_read_b64_tr_b16 a[0:1],v36 offset:0
ds_read_b64_tr_b16 a[2:3],v36 offset:128
ds_read_b64_tr_b16 a[4:5],v36 offset:2048
ds_read_b64_tr_b16 a[6:7],v36 offset:2176
ds_read_b64_tr_b16 a[8:9],v36 offset:8192
ds_read_b64_tr_b16 a[10:11],v36 offset:8320
ds_read_b64_tr_b16 a[12:13],v36 offset:10240
ds_read_b64_tr_b16 a[14:15],v36 offset:10368
ds_write_b128 v33,a[16:19] offset:4096
ds_write_b128 v33,a[20:23] offset:5120
ds_write_b128 v33,a[24:27] offset:6144
ds_write_b128 v33,a[28:31] offset:7168
s_waitcnt lgkmcnt(0)
v_mov_b32 v38,2
ds_write_b32 v37,v38 offset:4
qs_188:
ds_read_b32 v39,v37 offset:0
s_sub_u32 s90,s90,1
s_waitcnt lgkmcnt(0)
v_cmp_gt_u32 vcc,v38,v39
s_cmp_lt_i32 s90,0
s_cselect_b64 vcc,0,vcc
s_cbranch_vccnz qs_188
ds_read_b64_tr_b16 a[16:17],v36 offset:4096
ds_read_b64_tr_b16 a[18:19],v36 offset:4224
ds_read_b64_tr_b16 a[20:21],v36 offset:6144
ds_read_b64_tr_b16 a[22:23],v36 offset:6272
ds_read_b64_tr_b16 a[24:25],v36 offset:12288
ds_read_b64_tr_b16 a[26:27],v36 offset:12416
ds_read_b64_tr_b16 a[28:29],v36 offset:14336
ds_read_b64_tr_b16 a[30:31],v36 offset:14464
ds_write_b128 v33,a[32:35] offset:0
ds_write_b128 v33,a[36:39] offset:1024
ds_write_b128 v33,a[40:43] offset:2048
ds_write_b128 v33,a[44:47] offset:3072
s_waitcnt lgkmcnt(0)
v_mov_b32 v38,3
ds_write_b32 v37,v38 offset:4
qs_189:
ds_read_b32 v39,v37 offset:0
s_sub_u32 s90,s90,1
s_waitcnt lgkmcnt(0)
v_cmp_gt_u32 vcc,v38,v39
s_cmp_lt_i32 s90,0
s_cselect_b64 vcc,0,vcc
s_cbranch_vccnz qs_189
ds_read_b64_tr_b16 a[32:33],v36 offset:0
ds_read_b64_tr_b16 a[34:35],v36 offset:128
ds_read_b64_tr_b16 a[36:37],v36 offset:2048
ds_read_b64_tr_b16 a[38:39],v36 offset:2176
ds_read_b64_tr_b16 a[40:41],v36 offset:8192
ds_read_b64_tr_b16 a[42:43],v36 offset:8320
ds_read_b64_tr_b16 a[44:45],v36 offset:10240
ds_read_b64_tr_b16 a[46:47],v36 offset:10368
ds_write_b128 v33,a[48:51] offset:4096
ds_write_b128 v33,a[52:55] offset:5120
ds_write_b128 v33,a[56:59] offset:6144
ds_write_b128 v33,a[60:63] offset:7168
s_waitcnt lgkmcnt(0)
v_mov_b32 v38,4
ds_write_b32 v37,v38 offset:4
qs_190:
ds_read_b32 v39,v37 offset:0
s_sub_u32 s90,s90,1
s_waitcnt lgkmcnt(0)
v_cmp_gt_u32 vcc,v38,v39
s_cmp_lt_i32 s90,0
s_cselect_b64 vcc,0,vcc
s_cbranch_vccnz qs_190
ds_read_b64_tr_b16 a[48:49],v36 offset:4096
ds_read_b64_tr_b16 a[50:51],v36 offset:4224
ds_read_b64_tr_b16 a[52:53],v36 offset:6144
ds_read_b64_tr_b16 a[54:55],v36 offset:6272
ds_read_b64_tr_b16 a[56:57],v36 offset:12288
ds_read_b64_tr_b16 a[58:59],v36 offset:12416
ds_read_b64_tr_b16 a[60:61],v36 offset:14336
ds_read_b64_tr_b16 a[62:63],v36 offset:14464
ds_write_b128 v33,a[64:67] offset:0
ds_write_b128 v33,a[68:71] offset:1024
ds_write_b128 v33,a[72:75] offset:2048
ds_write_b128 v33,a[76:79] offset:3072
s_waitcnt lgkmcnt(0)
v_mov_b32 v38,5
ds_write_b32 v37,v38 offset:4
qs_191:
ds_read_b32 v39,v37 offset:0
s_sub_u32 s90,s90,1
s_waitcnt lgkmcnt(0)
v_cmp_gt_u32 vcc,v38,v39
s_cmp_lt_i32 s90,0
s_cselect_b64 vcc,0,vcc
s_cbranch_vccnz qs_191
ds_read_b64_tr_b16 a[64:65],v36 offset:0
ds_read_b64_tr_b16 a[66:67],v36 offset:128
ds_read_b64_tr_b16 a[68:69],v36 offset:2048
ds_read_b64_tr_b16 a[70:71],v36 offset:2176
ds_read_b64_tr_b16 a[72:73],v36 offset:8192
ds_read_b64_tr_b16 a[74:75],v36 offset:8320
ds_read_b64_tr_b16 a[76:77],v36 offset:10240
ds_read_b64_tr_b16 a[78:79],v36 offset:10368
ds_write_b128 v33,a[80:83] offset:4096
ds_write_b128 v33,a[84:87] offset:5120
ds_write_b128 v33,a[88:91] offset:6144
ds_write_b128 v33,a[92:95] offset:7168
s_waitcnt lgkmcnt(0)
v_mov_b32 v38,6
ds_write_b32 v37,v38 offset:4
qs_192:
ds_read_b32 v39,v37 offset:0
s_sub_u32 s90,s90,1
s_waitcnt lgkmcnt(0)
v_cmp_gt_u32 vcc,v38,v39
s_cmp_lt_i32 s90,0
s_cselect_b64 vcc,0,vcc
s_cbranch_vccnz qs_192
ds_read_b64_tr_b16 a[80:81],v36 offset:4096
ds_read_b64_tr_b16 a[82:83],v36 offset:4224
ds_read_b64_tr_b16 a[84:85],v36 offset:6144
ds_read_b64_tr_b16 a[86:87],v36 offset:6272
ds_read_b64_tr_b16 a[88:89],v36 offset:12288
ds_read_b64_tr_b16 a[90:91],v36 offset:12416
ds_read_b64_tr_b16 a[92:93],v36 offset:14336
ds_read_b64_tr_b16 a[94:95],v36 offset:14464
ds_write_b128 v33,a[96:99] offset:0
ds_write_b128 v33,a[100:103] offset:1024
ds_write_b128 v33,a[104:107] offset:2048
ds_write_b128 v33,a[108:111] offset:3072
s_waitcnt lgkmcnt(0)
v_mov_b32 v38,7
ds_write_b32 v37,v38 offset:4
qs_193:
ds_read_b32 v39,v37 offset:0
s_sub_u32 s90,s90,1
s_waitcnt lgkmcnt(0)
v_cmp_gt_u32 vcc,v38,v39
s_cmp_lt_i32 s90,0
s_cselect_b64 vcc,0,vcc
s_cbranch_vccnz qs_193
ds_read_b64_tr_b16 a[96:97],v36 offset:0
ds_read_b64_tr_b16 a[98:99],v36 offset:128
ds_read_b64_tr_b16 a[100:101],v36 offset:2048
ds_read_b64_tr_b16 a[102:103],v36 offset:2176
ds_read_b64_tr_b16 a[104:105],v36 offset:8192
ds_read_b64_tr_b16 a[106:107],v36 offset:8320
ds_read_b64_tr_b16 a[108:109],v36 offset:10240
ds_read_b64_tr_b16 a[110:111],v36 offset:10368
ds_write_b128 v33,a[112:115] offset:4096
ds_write_b128 v33,a[116:119] offset:5120
ds_write_b128 v33,a[120:123] offset:6144
ds_write_b128 v33,a[124:127] offset:7168
s_waitcnt lgkmcnt(0)
v_mov_b32 v38,8
ds_write_b32 v37,v38 offset:4
qs_194:
ds_read_b32 v39,v37 offset:0
s_sub_u32 s90,s90,1
s_waitcnt lgkmcnt(0)
v_cmp_gt_u32 vcc,v38,v39
s_cmp_lt_i32 s90,0
s_cselect_b64 vcc,0,vcc
s_cbranch_vccnz qs_194
ds_read_b64_tr_b16 a[112:113],v36 offset:4096
ds_read_b64_tr_b16 a[114:115],v36 offset:4224
ds_read_b64_tr_b16 a[116:117],v36 offset:6144
ds_read_b64_tr_b16 a[118:119],v36 offset:6272
ds_read_b64_tr_b16 a[120:121],v36 offset:12288
ds_read_b64_tr_b16 a[122:123],v36 offset:12416
ds_read_b64_tr_b16 a[124:125],v36 offset:14336
ds_read_b64_tr_b16 a[126:127],v36 offset:14464
s_waitcnt lgkmcnt(0)
v_mov_b32 v38,9
ds_write_b32 v37,v38 offset:4
qs_195:
ds_read_b32 v39,v37 offset:0
s_sub_u32 s90,s90,1
s_waitcnt lgkmcnt(0)
v_cmp_gt_u32 vcc,v38,v39
s_cmp_lt_i32 s90,0
s_cselect_b64 vcc,0,vcc
s_cbranch_vccnz qs_195
ds_write_b128 v33,a[128:131] offset:0
ds_write_b128 v33,a[132:135] offset:1024
ds_write_b128 v33,a[136:139] offset:2048
ds_write_b128 v33,a[140:143] offset:3072
s_waitcnt lgkmcnt(0)
ds_read_b64_tr_b16 a[128:129],v34 offset:0
ds_read_b64_tr_b16 a[130:131],v34 offset:128
ds_read_b64_tr_b16 a[132:133],v34 offset:2048
ds_read_b64_tr_b16 a[134:135],v34 offset:2176
ds_read_b64_tr_b16 a[136:137],v34 offset:32
ds_read_b64_tr_b16 a[138:139],v34 offset:160
ds_read_b64_tr_b16 a[140:141],v34 offset:2080
ds_read_b64_tr_b16 a[142:143],v34 offset:2208
ds_write_b128 v33,a[144:147] offset:4096
ds_write_b128 v33,a[148:151] offset:5120
ds_write_b128 v33,a[152:155] offset:6144
ds_write_b128 v33,a[156:159] offset:7168
s_waitcnt lgkmcnt(0)
ds_read_b64_tr_b16 a[144:145],v34 offset:4096
ds_read_b64_tr_b16 a[146:147],v34 offset:4224
ds_read_b64_tr_b16 a[148:149],v34 offset:6144
ds_read_b64_tr_b16 a[150:151],v34 offset:6272
ds_read_b64_tr_b16 a[152:153],v34 offset:4128
ds_read_b64_tr_b16 a[154:155],v34 offset:4256
ds_read_b64_tr_b16 a[156:157],v34 offset:6176
ds_read_b64_tr_b16 a[158:159],v34 offset:6304
ds_write_b128 v33,a[160:163] offset:0
ds_write_b128 v33,a[164:167] offset:1024
ds_write_b128 v33,a[168:171] offset:2048
ds_write_b128 v33,a[172:175] offset:3072
s_waitcnt lgkmcnt(0)
ds_read_b64_tr_b16 a[160:161],v34 offset:0
ds_read_b64_tr_b16 a[162:163],v34 offset:128
ds_read_b64_tr_b16 a[164:165],v34 offset:2048
ds_read_b64_tr_b16 a[166:167],v34 offset:2176
ds_read_b64_tr_b16 a[168:169],v34 offset:32
ds_read_b64_tr_b16 a[170:171],v34 offset:160
ds_read_b64_tr_b16 a[172:173],v34 offset:2080
ds_read_b64_tr_b16 a[174:175],v34 offset:2208
free_196:
ds_read_b64 v[38:39],v37 offset:8
s_sub_u32 s90,s90,1
s_waitcnt lgkmcnt(0)
v_and_b32 v38,v38,v39
v_cmp_eq_u32 vcc,0,v38
s_cmp_lt_i32 s90,0
s_cselect_b64 vcc,0,vcc
s_cbranch_vccnz free_196
s_xor_b32 s64,s61,10493952
buffer_store_dwordx4 v[100:103],v206,s[20:23],s64 offen sc1
buffer_store_dwordx4 v[100:103],v207,s[20:23],s64 offen sc1
s_xor_b32 s64,s61,12582912
buffer_store_dwordx4 v[100:103],v206,s[20:23],s64 offen sc1
buffer_store_dwordx4 v[100:103],v207,s[20:23],s64 offen sc1
s_xor_b32 s64,s61,14688256
buffer_store_dwordx4 v[100:103],v206,s[20:23],s64 offen sc1
buffer_store_dwordx4 v[100:103],v207,s[20:23],s64 offen sc1
s_mov_b32 m0,32768
s_mov_b32 s65,221184
buffer_load_dwordx4 v16,s[20:23],s65 offen offset:0 lds
buffer_load_dwordx4 v16,s[20:23],s65 offen offset:1024 lds
buffer_load_dwordx4 v16,s[20:23],s65 offen offset:2048 lds
buffer_load_dwordx4 v16,s[20:23],s65 offen offset:3072 lds
s_mov_b32 m0,36864
s_mov_b32 s65,225280
buffer_load_dwordx4 v16,s[20:23],s65 offen offset:0 lds
buffer_load_dwordx4 v16,s[20:23],s65 offen offset:1024 lds
buffer_load_dwordx4 v16,s[20:23],s65 offen offset:2048 lds
buffer_load_dwordx4 v16,s[20:23],s65 offen offset:3072 lds
s_mov_b32 m0,40960
s_mov_b32 s65,229376
buffer_load_dwordx4 v16,s[20:23],s65 offen offset:0 lds
buffer_load_dwordx4 v16,s[20:23],s65 offen offset:1024 lds
buffer_load_dwordx4 v16,s[20:23],s65 offen offset:2048 lds
buffer_load_dwordx4 v16,s[20:23],s65 offen offset:3072 lds
s_mov_b32 m0,45056
s_mov_b32 s65,233472
buffer_load_dwordx4 v16,s[20:23],s65 offen offset:0 lds
buffer_load_dwordx4 v16,s[20:23],s65 offen offset:1024 lds
buffer_load_dwordx4 v16,s[20:23],s65 offen offset:2048 lds
buffer_load_dwordx4 v16,s[20:23],s65 offen offset:3072 lds
s_mov_b32 m0,49152
s_mov_b32 s65,237568
buffer_load_dwordx4 v16,s[20:23],s65 offen offset:0 lds
buffer_load_dwordx4 v16,s[20:23],s65 offen offset:1024 lds
buffer_load_dwordx4 v16,s[20:23],s65 offen offset:2048 lds
buffer_load_dwordx4 v16,s[20:23],s65 offen offset:3072 lds
s_mov_b32 m0,53248
s_mov_b32 s65,241664
buffer_load_dwordx4 v16,s[20:23],s65 offen offset:0 lds
buffer_load_dwordx4 v16,s[20:23],s65 offen offset:1024 lds
buffer_load_dwordx4 v16,s[20:23],s65 offen offset:2048 lds
buffer_load_dwordx4 v16,s[20:23],s65 offen offset:3072 lds
s_mov_b32 m0,57344
s_mov_b32 s65,245760
buffer_load_dwordx4 v16,s[20:23],s65 offen offset:0 lds
buffer_load_dwordx4 v16,s[20:23],s65 offen offset:1024 lds
buffer_load_dwordx4 v16,s[20:23],s65 offen offset:2048 lds
buffer_load_dwordx4 v16,s[20:23],s65 offen offset:3072 lds
s_mov_b32 m0,61440
s_mov_b32 s65,249856
buffer_load_dwordx4 v16,s[20:23],s65 offen offset:0 lds
buffer_load_dwordx4 v16,s[20:23],s65 offen offset:1024 lds
buffer_load_dwordx4 v16,s[20:23],s65 offen offset:2048 lds
buffer_load_dwordx4 v16,s[20:23],s65 offen offset:3072 lds
s_waitcnt vmcnt(54)
ds_write_b128 v33,a[176:179] offset:4096
ds_write_b128 v33,a[180:183] offset:5120
ds_write_b128 v33,a[184:187] offset:6144
ds_write_b128 v33,a[188:191] offset:7168
s_waitcnt lgkmcnt(0)
ds_read_b64_tr_b16 a[176:177],v34 offset:4096
ds_read_b64_tr_b16 a[178:179],v34 offset:4224
ds_read_b64_tr_b16 a[180:181],v34 offset:6144
ds_read_b64_tr_b16 a[182:183],v34 offset:6272
ds_read_b64_tr_b16 a[184:185],v34 offset:4128
ds_read_b64_tr_b16 a[186:187],v34 offset:4256
ds_read_b64_tr_b16 a[188:189],v34 offset:6176
ds_read_b64_tr_b16 a[190:191],v34 offset:6304
s_waitcnt vmcnt(50)
ds_write_b128 v33,a[192:195] offset:0
ds_write_b128 v33,a[196:199] offset:1024
ds_write_b128 v33,a[200:203] offset:2048
ds_write_b128 v33,a[204:207] offset:3072
s_waitcnt lgkmcnt(0)
ds_read_b64_tr_b16 a[192:193],v34 offset:0
ds_read_b64_tr_b16 a[194:195],v34 offset:128
ds_read_b64_tr_b16 a[196:197],v34 offset:2048
ds_read_b64_tr_b16 a[198:199],v34 offset:2176
ds_read_b64_tr_b16 a[200:201],v34 offset:32
ds_read_b64_tr_b16 a[202:203],v34 offset:160
ds_read_b64_tr_b16 a[204:205],v34 offset:2080
ds_read_b64_tr_b16 a[206:207],v34 offset:2208
s_waitcnt vmcnt(46)
ds_write_b128 v33,a[208:211] offset:4096
ds_write_b128 v33,a[212:215] offset:5120
ds_write_b128 v33,a[216:219] offset:6144
ds_write_b128 v33,a[220:223] offset:7168
s_waitcnt lgkmcnt(0)
ds_read_b64_tr_b16 a[208:209],v34 offset:4096
ds_read_b64_tr_b16 a[210:211],v34 offset:4224
ds_read_b64_tr_b16 a[212:213],v34 offset:6144
ds_read_b64_tr_b16 a[214:215],v34 offset:6272
ds_read_b64_tr_b16 a[216:217],v34 offset:4128
ds_read_b64_tr_b16 a[218:219],v34 offset:4256
ds_read_b64_tr_b16 a[220:221],v34 offset:6176
ds_read_b64_tr_b16 a[222:223],v34 offset:6304
s_waitcnt vmcnt(42)
ds_write_b128 v33,a[224:227] offset:0
ds_write_b128 v33,a[228:231] offset:1024
ds_write_b128 v33,a[232:235] offset:2048
ds_write_b128 v33,a[236:239] offset:3072
s_waitcnt lgkmcnt(0)
ds_read_b64_tr_b16 a[224:225],v34 offset:0
ds_read_b64_tr_b16 a[226:227],v34 offset:128
ds_read_b64_tr_b16 a[228:229],v34 offset:2048
ds_read_b64_tr_b16 a[230:231],v34 offset:2176
ds_read_b64_tr_b16 a[232:233],v34 offset:32
ds_read_b64_tr_b16 a[234:235],v34 offset:160
ds_read_b64_tr_b16 a[236:237],v34 offset:2080
ds_read_b64_tr_b16 a[238:239],v34 offset:2208
s_waitcnt vmcnt(38)
ds_write_b128 v33,a[240:243] offset:4096
ds_write_b128 v33,a[244:247] offset:5120
ds_write_b128 v33,a[248:251] offset:6144
ds_write_b128 v33,a[252:255] offset:7168
s_waitcnt lgkmcnt(0)
ds_read_b64_tr_b16 a[240:241],v34 offset:4096
ds_read_b64_tr_b16 a[242:243],v34 offset:4224
ds_read_b64_tr_b16 a[244:245],v34 offset:6144
ds_read_b64_tr_b16 a[246:247],v34 offset:6272
ds_read_b64_tr_b16 a[248:249],v34 offset:4128
ds_read_b64_tr_b16 a[250:251],v34 offset:4256
ds_read_b64_tr_b16 a[252:253],v34 offset:6176
ds_read_b64_tr_b16 a[254:255],v34 offset:6304
s_mov_b32 s79,0
s_add_u32 s63,s79,0
s_and_b32 s64,s63,3
s_lshl_b32 s70,s64,20
s_add_u32 s65,s63,2
s_and_b32 s65,s65,3
s_lshl_b32 s73,s65,20
s_add_u32 s55,s63,3
s_lshl_b32 s78,s55,16
s_add_u32 s78,s78,57344
s_cmp_lt_u32 s55,64
s_cselect_b32 s78,s78,0x7fff0000
s_add_u32 s71,s70,65536
s_add_u32 s60,s63,1
s_and_b32 s60,s60,3
s_lshl_b32 s72,s60,20
v_mov_b32 v184,0
v_mov_b32 v185,0
v_mov_b32 v186,0
v_mov_b32 v187,0
v_mov_b32 v188,0
v_mov_b32 v189,0
v_mov_b32 v190,0
v_mov_b32 v191,0
s_lshl_b32 s74,s63,21
s_lshl_b32 s55,s63,13
s_and_b32 s55,s55,0x2000
s_xor_b32 s55,s55,s61
s_add_u32 s74,s74,s55
v_mov_b32 v176,0
v_mov_b32 v177,0
v_mov_b32 v178,0
v_mov_b32 v179,0
v_mov_b32 v25,1
s_waitcnt vmcnt(0) lgkmcnt(0)
s_barrier
v_max_u32 v216,1,v216
v_max_u32 v217,1,v217
v_max_u32 v218,1,v218
v_max_u32 v219,1,v219
s_mov_b64 exec,s[84:85]
buffer_store_dwordx4 v[216:219],v12,s[24:27],s70 offen
buffer_store_dwordx4 v[216:219],v12,s[28:31],s70 offen sc1
s_mov_b64 exec,1
buffer_store_dword v25,v13,s[24:27],s70 offen
buffer_store_dword v25,v13,s[28:31],s70 offen sc1
s_mov_b64 exec,-1
s_branch loop_152
end_57:
s_waitcnt vmcnt(0)
s_barrier
s_mov_b32 s50,s91
done_1:
s_endpgm
pipe_worker:
v_and_b32 v1,63,v0
v_and_b32 v3,15,v1
v_lshrrev_b32 v4,4,v1
v_lshlrev_b32 v16,4,v1
v_mov_b32 v48,0
v_mov_b32 v49,0
v_mov_b32 v50,0
v_mov_b32 v51,0
s_lshr_b32 s58,s55,5
s_and_b32 s59,s55,31
s_xor_b32 s62,s61,0x2000
s_add_u32 s63,s62,21053440
s_lshr_b32 s64,s59,4
s_and_b32 s59,s59,15
s_lshr_b32 s65,s58,1
s_lshl_b32 s65,s65,4
s_add_u32 s59,s59,s65
s_mul_i32 s65,s64,3
s_add_u32 s64,s64,1
s_sub_u32 s58,s58,1
s_cmp_lt_u32 s58,2
s_cselect_b32 s58,s64,s65
s_load_dwordx2 s[4:5],s[0:1],16
v_lshlrev_b32 v5,4,v0
s_lshl_b32 s64,s55,14
s_add_u32 s64,s64,17825792
buffer_store_dwordx4 v[48:51],v5,s[20:23],s64 offen sc1
s_add_u32 s64,s64,4096
buffer_store_dwordx4 v[48:51],v5,s[20:23],s64 offen sc1
s_add_u32 s64,s64,4096
buffer_store_dwordx4 v[48:51],v5,s[20:23],s64 offen sc1
s_add_u32 s64,s64,4096
buffer_store_dwordx4 v[48:51],v5,s[20:23],s64 offen sc1
s_add_u32 s64,s64,4096
s_lshl_b32 s64,s55,12
s_add_u32 s64,s64,8577024
buffer_store_dwordx4 v[48:51],v5,s[20:23],s64 offen sc1
s_lshr_b32 s79,s55,5
s_add_u32 s64,s79,8
s_lshl_b32 s93,s64,21
s_lshl_b32 s64,s64,13
s_and_b32 s64,s64,0x2000
s_xor_b32 s64,s64,s61
s_add_u32 s93,s93,s64
s_add_u32 s93,s93,29360128
s_and_b32 s64,s55,31
s_add_u32 s64,s64,96
s_lshl_b32 s64,s64,14
s_add_u32 s93,s93,s64
s_waitcnt lgkmcnt(0)
s_mov_b32 s32,s4
s_and_b32 s33,s5,0xffff
s_mov_b32 s34,0x800000
s_mov_b32 s35,0x20000
v_lshrrev_b32 v5,3,v3
v_bfe_u32 v6,v3,2,1
v_lshl_add_u32 v7,v5,3,v6
v_lshl_add_u32 v6,v5,2,v6
v_lshrrev_b32 v5,1,v4
v_lshl_add_u32 v7,v5,4,v7
v_and_b32 v5,1,v4
v_lshl_add_u32 v7,v5,2,v7
v_lshl_add_u32 v6,v5,1,v6
v_bfe_u32 v5,v3,1,1
s_lshl_b32 s64,s50,1
v_add_u32 v5,s64,v5
v_xor_b32 v5,v5,v6
v_lshlrev_b32 v5,5,v5
v_lshl_add_u32 v5,v7,8,v5
v_and_b32 v6,1,v3
v_lshl_add_u32 v12,v6,4,v5
s_lshl_b32 s66,s59,8
v_and_b32 v5,15,v1
v_and_b32 v6,1,v4
v_lshlrev_b32 v6,1,v6
v_xor_b32 v5,v5,v6
v_mul_u32_u24 v6,8192,v4
v_xor_b32 v7,0,v5
v_lshl_add_u32 v8,v7,4,v6
v_xor_b32 v7,4,v5
v_lshl_add_u32 v9,v7,4,v6
v_xor_b32 v7,8,v5
v_lshl_add_u32 v10,v7,4,v6
v_xor_b32 v7,12,v5
v_lshl_add_u32 v11,v7,4,v6
s_mul_i32 s74,s50,524288
s_add_u32 s74,s74,s66
s_lshl_b32 s75,s50,14
s_mul_i32 s76,s50,262144
s_add_u32 s76,s76,s66
s_lshl_b32 s77,s50,13
s_add_u32 s64,s74,0
s_add_u32 m0,s75,0
s_nop 0
buffer_load_dwordx4 v8,s[32:35],s64 offen nt lds
s_add_u32 s64,s74,32768
s_add_u32 m0,s75,1024
s_nop 0
buffer_load_dwordx4 v9,s[32:35],s64 offen nt lds
s_add_u32 s64,s74,65536
s_add_u32 m0,s75,2048
s_nop 0
buffer_load_dwordx4 v10,s[32:35],s64 offen nt lds
s_add_u32 s64,s74,98304
s_add_u32 m0,s75,3072
s_nop 0
buffer_load_dwordx4 v11,s[32:35],s64 offen nt lds
s_add_u32 s64,s74,131072
s_add_u32 m0,s75,4096
s_nop 0
buffer_load_dwordx4 v8,s[32:35],s64 offen nt lds
s_add_u32 s64,s74,163840
s_add_u32 m0,s75,5120
s_nop 0
buffer_load_dwordx4 v9,s[32:35],s64 offen nt lds
s_add_u32 s64,s74,196608
s_add_u32 m0,s75,6144
s_nop 0
buffer_load_dwordx4 v10,s[32:35],s64 offen nt lds
s_add_u32 s64,s74,229376
s_add_u32 m0,s75,7168
s_nop 0
buffer_load_dwordx4 v11,s[32:35],s64 offen nt lds
s_add_u32 s64,s74,262144
s_add_u32 m0,s75,8192
s_nop 0
buffer_load_dwordx4 v8,s[32:35],s64 offen nt lds
s_add_u32 s64,s74,294912
s_add_u32 m0,s75,9216
s_nop 0
buffer_load_dwordx4 v9,s[32:35],s64 offen nt lds
s_add_u32 s64,s74,327680
s_add_u32 m0,s75,10240
s_nop 0
buffer_load_dwordx4 v10,s[32:35],s64 offen nt lds
s_add_u32 s64,s74,360448
s_add_u32 m0,s75,11264
s_nop 0
buffer_load_dwordx4 v11,s[32:35],s64 offen nt lds
s_add_u32 s64,s74,393216
s_add_u32 m0,s75,12288
s_nop 0
buffer_load_dwordx4 v8,s[32:35],s64 offen nt lds
s_add_u32 s64,s74,425984
s_add_u32 m0,s75,13312
s_nop 0
buffer_load_dwordx4 v9,s[32:35],s64 offen nt lds
s_add_u32 s64,s74,458752
s_add_u32 m0,s75,14336
s_nop 0
buffer_load_dwordx4 v10,s[32:35],s64 offen nt lds
s_add_u32 s64,s74,491520
s_add_u32 m0,s75,15360
s_nop 0
buffer_load_dwordx4 v11,s[32:35],s64 offen nt lds
s_add_u32 s64,s74,2097152
s_add_u32 m0,s75,65536
s_nop 0
buffer_load_dwordx4 v8,s[32:35],s64 offen nt lds
s_add_u32 s64,s74,2129920
s_add_u32 m0,s75,66560
s_nop 0
buffer_load_dwordx4 v9,s[32:35],s64 offen nt lds
s_add_u32 s64,s74,2162688
s_add_u32 m0,s75,67584
s_nop 0
buffer_load_dwordx4 v10,s[32:35],s64 offen nt lds
s_add_u32 s64,s74,2195456
s_add_u32 m0,s75,68608
s_nop 0
buffer_load_dwordx4 v11,s[32:35],s64 offen nt lds
s_add_u32 s64,s74,2228224
s_add_u32 m0,s75,69632
s_nop 0
buffer_load_dwordx4 v8,s[32:35],s64 offen nt lds
s_add_u32 s64,s74,2260992
s_add_u32 m0,s75,70656
s_nop 0
buffer_load_dwordx4 v9,s[32:35],s64 offen nt lds
s_add_u32 s64,s74,2293760
s_add_u32 m0,s75,71680
s_nop 0
buffer_load_dwordx4 v10,s[32:35],s64 offen nt lds
s_add_u32 s64,s74,2326528
s_add_u32 m0,s75,72704
s_nop 0
buffer_load_dwordx4 v11,s[32:35],s64 offen nt lds
s_add_u32 s64,s74,2359296
s_add_u32 m0,s75,73728
s_nop 0
buffer_load_dwordx4 v8,s[32:35],s64 offen nt lds
s_add_u32 s64,s74,2392064
s_add_u32 m0,s75,74752
s_nop 0
buffer_load_dwordx4 v9,s[32:35],s64 offen nt lds
s_add_u32 s64,s74,2424832
s_add_u32 m0,s75,75776
s_nop 0
buffer_load_dwordx4 v10,s[32:35],s64 offen nt lds
s_add_u32 s64,s74,2457600
s_add_u32 m0,s75,76800
s_nop 0
buffer_load_dwordx4 v11,s[32:35],s64 offen nt lds
s_add_u32 s64,s74,2490368
s_add_u32 m0,s75,77824
s_nop 0
buffer_load_dwordx4 v8,s[32:35],s64 offen nt lds
s_add_u32 s64,s74,2523136
s_add_u32 m0,s75,78848
s_nop 0
buffer_load_dwordx4 v9,s[32:35],s64 offen nt lds
s_add_u32 s64,s74,2555904
s_add_u32 m0,s75,79872
s_nop 0
buffer_load_dwordx4 v10,s[32:35],s64 offen nt lds
s_add_u32 s64,s74,2588672
s_add_u32 m0,s75,80896
s_nop 0
buffer_load_dwordx4 v11,s[32:35],s64 offen nt lds
s_waitcnt vmcnt(16)
s_barrier
ds_read_b64_tr_b16 a[0:1],v12 offset:0
ds_read_b64_tr_b16 a[2:3],v12 offset:512
ds_read_b64_tr_b16 a[128:129],v12 offset:8
ds_read_b64_tr_b16 a[130:131],v12 offset:520
ds_read_b64_tr_b16 a[4:5],v12 offset:8192
ds_read_b64_tr_b16 a[6:7],v12 offset:8704
ds_read_b64_tr_b16 a[132:133],v12 offset:8200
ds_read_b64_tr_b16 a[134:135],v12 offset:8712
s_waitcnt lgkmcnt(4)
ds_read_b64_tr_b16 a[8:9],v12 offset:16384
ds_read_b64_tr_b16 a[10:11],v12 offset:16896
ds_read_b64_tr_b16 a[136:137],v12 offset:16392
ds_read_b64_tr_b16 a[138:139],v12 offset:16904
ds_read_b64_tr_b16 a[12:13],v12 offset:24576
ds_read_b64_tr_b16 a[14:15],v12 offset:25088
ds_read_b64_tr_b16 a[140:141],v12 offset:24584
ds_read_b64_tr_b16 a[142:143],v12 offset:25096
s_waitcnt lgkmcnt(4)
ds_read_b64_tr_b16 a[16:17],v12 offset:32768
ds_read_b64_tr_b16 a[18:19],v12 offset:33280
ds_read_b64_tr_b16 a[144:145],v12 offset:32776
ds_read_b64_tr_b16 a[146:147],v12 offset:33288
ds_read_b64_tr_b16 a[20:21],v12 offset:40960
ds_read_b64_tr_b16 a[22:23],v12 offset:41472
ds_read_b64_tr_b16 a[148:149],v12 offset:40968
ds_read_b64_tr_b16 a[150:151],v12 offset:41480
s_waitcnt lgkmcnt(4)
ds_read_b64_tr_b16 a[24:25],v12 offset:49152
ds_read_b64_tr_b16 a[26:27],v12 offset:49664
ds_read_b64_tr_b16 a[152:153],v12 offset:49160
ds_read_b64_tr_b16 a[154:155],v12 offset:49672
ds_read_b64_tr_b16 a[28:29],v12 offset:57344
ds_read_b64_tr_b16 a[30:31],v12 offset:57856
ds_read_b64_tr_b16 a[156:157],v12 offset:57352
ds_read_b64_tr_b16 a[158:159],v12 offset:57864
s_waitcnt lgkmcnt(4)
v_xor_b32 v12,0x10000,v12
s_waitcnt lgkmcnt(0)
s_barrier
s_add_u32 s64,s74,4194304
s_add_u32 m0,s75,0
s_nop 0
buffer_load_dwordx4 v8,s[32:35],s64 offen nt lds
s_add_u32 s64,s74,4227072
s_add_u32 m0,s75,1024
s_nop 0
buffer_load_dwordx4 v9,s[32:35],s64 offen nt lds
s_add_u32 s64,s74,4259840
s_add_u32 m0,s75,2048
s_nop 0
buffer_load_dwordx4 v10,s[32:35],s64 offen nt lds
s_add_u32 s64,s74,4292608
s_add_u32 m0,s75,3072
s_nop 0
buffer_load_dwordx4 v11,s[32:35],s64 offen nt lds
s_add_u32 s64,s74,4325376
s_add_u32 m0,s75,4096
s_nop 0
buffer_load_dwordx4 v8,s[32:35],s64 offen nt lds
s_add_u32 s64,s74,4358144
s_add_u32 m0,s75,5120
s_nop 0
buffer_load_dwordx4 v9,s[32:35],s64 offen nt lds
s_add_u32 s64,s74,4390912
s_add_u32 m0,s75,6144
s_nop 0
buffer_load_dwordx4 v10,s[32:35],s64 offen nt lds
s_add_u32 s64,s74,4423680
s_add_u32 m0,s75,7168
s_nop 0
buffer_load_dwordx4 v11,s[32:35],s64 offen nt lds
s_add_u32 s64,s74,4456448
s_add_u32 m0,s75,8192
s_nop 0
buffer_load_dwordx4 v8,s[32:35],s64 offen nt lds
s_add_u32 s64,s74,4489216
s_add_u32 m0,s75,9216
s_nop 0
buffer_load_dwordx4 v9,s[32:35],s64 offen nt lds
s_add_u32 s64,s74,4521984
s_add_u32 m0,s75,10240
s_nop 0
buffer_load_dwordx4 v10,s[32:35],s64 offen nt lds
s_add_u32 s64,s74,4554752
s_add_u32 m0,s75,11264
s_nop 0
buffer_load_dwordx4 v11,s[32:35],s64 offen nt lds
s_add_u32 s64,s74,4587520
s_add_u32 m0,s75,12288
s_nop 0
buffer_load_dwordx4 v8,s[32:35],s64 offen nt lds
s_add_u32 s64,s74,4620288
s_add_u32 m0,s75,13312
s_nop 0
buffer_load_dwordx4 v9,s[32:35],s64 offen nt lds
s_add_u32 s64,s74,4653056
s_add_u32 m0,s75,14336
s_nop 0
buffer_load_dwordx4 v10,s[32:35],s64 offen nt lds
s_add_u32 s64,s74,4685824
s_add_u32 m0,s75,15360
s_nop 0
buffer_load_dwordx4 v11,s[32:35],s64 offen nt lds
s_waitcnt vmcnt(16)
s_barrier
ds_read_b64_tr_b16 a[32:33],v12 offset:0
ds_read_b64_tr_b16 a[34:35],v12 offset:512
ds_read_b64_tr_b16 a[160:161],v12 offset:8
ds_read_b64_tr_b16 a[162:163],v12 offset:520
ds_read_b64_tr_b16 a[36:37],v12 offset:8192
ds_read_b64_tr_b16 a[38:39],v12 offset:8704
ds_read_b64_tr_b16 a[164:165],v12 offset:8200
ds_read_b64_tr_b16 a[166:167],v12 offset:8712
s_waitcnt lgkmcnt(4)
ds_read_b64_tr_b16 a[40:41],v12 offset:16384
ds_read_b64_tr_b16 a[42:43],v12 offset:16896
ds_read_b64_tr_b16 a[168:169],v12 offset:16392
ds_read_b64_tr_b16 a[170:171],v12 offset:16904
ds_read_b64_tr_b16 a[44:45],v12 offset:24576
ds_read_b64_tr_b16 a[46:47],v12 offset:25088
ds_read_b64_tr_b16 a[172:173],v12 offset:24584
ds_read_b64_tr_b16 a[174:175],v12 offset:25096
s_waitcnt lgkmcnt(4)
ds_read_b64_tr_b16 a[48:49],v12 offset:32768
ds_read_b64_tr_b16 a[50:51],v12 offset:33280
ds_read_b64_tr_b16 a[176:177],v12 offset:32776
ds_read_b64_tr_b16 a[178:179],v12 offset:33288
ds_read_b64_tr_b16 a[52:53],v12 offset:40960
ds_read_b64_tr_b16 a[54:55],v12 offset:41472
ds_read_b64_tr_b16 a[180:181],v12 offset:40968
ds_read_b64_tr_b16 a[182:183],v12 offset:41480
s_waitcnt lgkmcnt(4)
ds_read_b64_tr_b16 a[56:57],v12 offset:49152
ds_read_b64_tr_b16 a[58:59],v12 offset:49664
ds_read_b64_tr_b16 a[184:185],v12 offset:49160
ds_read_b64_tr_b16 a[186:187],v12 offset:49672
ds_read_b64_tr_b16 a[60:61],v12 offset:57344
ds_read_b64_tr_b16 a[62:63],v12 offset:57856
ds_read_b64_tr_b16 a[188:189],v12 offset:57352
ds_read_b64_tr_b16 a[190:191],v12 offset:57864
s_waitcnt lgkmcnt(4)
v_xor_b32 v12,0x10000,v12
s_waitcnt lgkmcnt(0)
s_barrier
s_add_u32 s64,s74,6291456
s_add_u32 m0,s75,65536
s_nop 0
buffer_load_dwordx4 v8,s[32:35],s64 offen nt lds
s_add_u32 s64,s74,6324224
s_add_u32 m0,s75,66560
s_nop 0
buffer_load_dwordx4 v9,s[32:35],s64 offen nt lds
s_add_u32 s64,s74,6356992
s_add_u32 m0,s75,67584
s_nop 0
buffer_load_dwordx4 v10,s[32:35],s64 offen nt lds
s_add_u32 s64,s74,6389760
s_add_u32 m0,s75,68608
s_nop 0
buffer_load_dwordx4 v11,s[32:35],s64 offen nt lds
s_add_u32 s64,s74,6422528
s_add_u32 m0,s75,69632
s_nop 0
buffer_load_dwordx4 v8,s[32:35],s64 offen nt lds
s_add_u32 s64,s74,6455296
s_add_u32 m0,s75,70656
s_nop 0
buffer_load_dwordx4 v9,s[32:35],s64 offen nt lds
s_add_u32 s64,s74,6488064
s_add_u32 m0,s75,71680
s_nop 0
buffer_load_dwordx4 v10,s[32:35],s64 offen nt lds
s_add_u32 s64,s74,6520832
s_add_u32 m0,s75,72704
s_nop 0
buffer_load_dwordx4 v11,s[32:35],s64 offen nt lds
s_add_u32 s64,s74,6553600
s_add_u32 m0,s75,73728
s_nop 0
buffer_load_dwordx4 v8,s[32:35],s64 offen nt lds
s_add_u32 s64,s74,6586368
s_add_u32 m0,s75,74752
s_nop 0
buffer_load_dwordx4 v9,s[32:35],s64 offen nt lds
s_add_u32 s64,s74,6619136
s_add_u32 m0,s75,75776
s_nop 0
buffer_load_dwordx4 v10,s[32:35],s64 offen nt lds
s_add_u32 s64,s74,6651904
s_add_u32 m0,s75,76800
s_nop 0
buffer_load_dwordx4 v11,s[32:35],s64 offen nt lds
s_add_u32 s64,s74,6684672
s_add_u32 m0,s75,77824
s_nop 0
buffer_load_dwordx4 v8,s[32:35],s64 offen nt lds
s_add_u32 s64,s74,6717440
s_add_u32 m0,s75,78848
s_nop 0
buffer_load_dwordx4 v9,s[32:35],s64 offen nt lds
s_add_u32 s64,s74,6750208
s_add_u32 m0,s75,79872
s_nop 0
buffer_load_dwordx4 v10,s[32:35],s64 offen nt lds
s_add_u32 s64,s74,6782976
s_add_u32 m0,s75,80896
s_nop 0
buffer_load_dwordx4 v11,s[32:35],s64 offen nt lds
s_waitcnt vmcnt(16)
s_barrier
ds_read_b64_tr_b16 a[64:65],v12 offset:0
ds_read_b64_tr_b16 a[66:67],v12 offset:512
ds_read_b64_tr_b16 a[192:193],v12 offset:8
ds_read_b64_tr_b16 a[194:195],v12 offset:520
ds_read_b64_tr_b16 a[68:69],v12 offset:8192
ds_read_b64_tr_b16 a[70:71],v12 offset:8704
ds_read_b64_tr_b16 a[196:197],v12 offset:8200
ds_read_b64_tr_b16 a[198:199],v12 offset:8712
s_waitcnt lgkmcnt(4)
ds_read_b64_tr_b16 a[72:73],v12 offset:16384
ds_read_b64_tr_b16 a[74:75],v12 offset:16896
ds_read_b64_tr_b16 a[200:201],v12 offset:16392
ds_read_b64_tr_b16 a[202:203],v12 offset:16904
ds_read_b64_tr_b16 a[76:77],v12 offset:24576
ds_read_b64_tr_b16 a[78:79],v12 offset:25088
ds_read_b64_tr_b16 a[204:205],v12 offset:24584
ds_read_b64_tr_b16 a[206:207],v12 offset:25096
s_waitcnt lgkmcnt(4)
ds_read_b64_tr_b16 a[80:81],v12 offset:32768
ds_read_b64_tr_b16 a[82:83],v12 offset:33280
ds_read_b64_tr_b16 a[208:209],v12 offset:32776
ds_read_b64_tr_b16 a[210:211],v12 offset:33288
ds_read_b64_tr_b16 a[84:85],v12 offset:40960
ds_read_b64_tr_b16 a[86:87],v12 offset:41472
ds_read_b64_tr_b16 a[212:213],v12 offset:40968
ds_read_b64_tr_b16 a[214:215],v12 offset:41480
s_waitcnt lgkmcnt(4)
ds_read_b64_tr_b16 a[88:89],v12 offset:49152
ds_read_b64_tr_b16 a[90:91],v12 offset:49664
ds_read_b64_tr_b16 a[216:217],v12 offset:49160
ds_read_b64_tr_b16 a[218:219],v12 offset:49672
ds_read_b64_tr_b16 a[92:93],v12 offset:57344
ds_read_b64_tr_b16 a[94:95],v12 offset:57856
ds_read_b64_tr_b16 a[220:221],v12 offset:57352
ds_read_b64_tr_b16 a[222:223],v12 offset:57864
s_waitcnt lgkmcnt(4)
v_xor_b32 v12,0x10000,v12
s_waitcnt lgkmcnt(0)
s_barrier
s_waitcnt vmcnt(0)
s_barrier
ds_read_b64_tr_b16 a[96:97],v12 offset:0
ds_read_b64_tr_b16 a[98:99],v12 offset:512
ds_read_b64_tr_b16 a[224:225],v12 offset:8
ds_read_b64_tr_b16 a[226:227],v12 offset:520
ds_read_b64_tr_b16 a[100:101],v12 offset:8192
ds_read_b64_tr_b16 a[102:103],v12 offset:8704
ds_read_b64_tr_b16 a[228:229],v12 offset:8200
ds_read_b64_tr_b16 a[230:231],v12 offset:8712
s_waitcnt lgkmcnt(4)
ds_read_b64_tr_b16 a[104:105],v12 offset:16384
ds_read_b64_tr_b16 a[106:107],v12 offset:16896
ds_read_b64_tr_b16 a[232:233],v12 offset:16392
ds_read_b64_tr_b16 a[234:235],v12 offset:16904
ds_read_b64_tr_b16 a[108:109],v12 offset:24576
ds_read_b64_tr_b16 a[110:111],v12 offset:25088
ds_read_b64_tr_b16 a[236:237],v12 offset:24584
ds_read_b64_tr_b16 a[238:239],v12 offset:25096
s_waitcnt lgkmcnt(4)
ds_read_b64_tr_b16 a[112:113],v12 offset:32768
ds_read_b64_tr_b16 a[114:115],v12 offset:33280
ds_read_b64_tr_b16 a[240:241],v12 offset:32776
ds_read_b64_tr_b16 a[242:243],v12 offset:33288
ds_read_b64_tr_b16 a[116:117],v12 offset:40960
ds_read_b64_tr_b16 a[118:119],v12 offset:41472
ds_read_b64_tr_b16 a[244:245],v12 offset:40968
ds_read_b64_tr_b16 a[246:247],v12 offset:41480
s_waitcnt lgkmcnt(4)
ds_read_b64_tr_b16 a[120:121],v12 offset:49152
ds_read_b64_tr_b16 a[122:123],v12 offset:49664
ds_read_b64_tr_b16 a[248:249],v12 offset:49160
ds_read_b64_tr_b16 a[250:251],v12 offset:49672
ds_read_b64_tr_b16 a[124:125],v12 offset:57344
ds_read_b64_tr_b16 a[126:127],v12 offset:57856
ds_read_b64_tr_b16 a[252:253],v12 offset:57352
ds_read_b64_tr_b16 a[254:255],v12 offset:57864
s_waitcnt lgkmcnt(4)
v_xor_b32 v12,0x10000,v12
s_waitcnt lgkmcnt(0)
s_barrier
v_and_b32 v21,7,v1
v_lshlrev_b32 v21,6,v21
s_mov_b32 s65,21052416
s_mov_b32 s66,1792
pl_200:
buffer_load_dword v22,v21,s[20:23],s65 offen sc1
s_waitcnt vmcnt(0)
v_cmp_gt_u32 vcc,s66,v22
s_cbranch_vccz pok_201
s_sleep 1
s_sub_u32 s90,s90,1
s_cmp_gt_i32 s90,0
s_cbranch_scc1 pl_200
pok_201:
s_lshl_b32 s72,s50,14
s_lshl_b32 s74,s58,16
s_add_u32 s74,s74,s72
s_add_u32 s74,s74,57344
v_mov_b32 v17,v16
s_lshl_b32 s64,s59,14
s_lshl_b32 s65,s50,11
s_add_u32 s64,s64,s65
v_add_u32 v18,s64,v16
s_lshl_b32 s73,s58,5
s_add_u32 s73,s73,s59
s_lshl_b32 s73,s73,2
s_add_u32 s73,s73,s63
v_lshlrev_b32 v24,4,v0
s_mov_b32 s79,s58
s_add_u32 m0,s72,0
s_add_u32 s65,s74,0
buffer_load_dwordx4 v16,s[20:23],s65 offen offset:0  lds
buffer_load_dwordx4 v16,s[20:23],s65 offen offset:1024  lds
buffer_load_dwordx4 v16,s[20:23],s65 offen offset:2048  lds
buffer_load_dwordx4 v16,s[20:23],s65 offen offset:3072  lds
s_add_u32 m0,s72,4096
s_add_u32 s65,s74,4096
buffer_load_dwordx4 v16,s[20:23],s65 offen offset:0  lds
buffer_load_dwordx4 v16,s[20:23],s65 offen offset:1024  lds
buffer_load_dwordx4 v16,s[20:23],s65 offen offset:2048  lds
buffer_load_dwordx4 v16,s[20:23],s65 offen offset:3072  lds
s_add_u32 m0,s72,8192
s_add_u32 s65,s74,8192
buffer_load_dwordx4 v16,s[20:23],s65 offen offset:0  lds
buffer_load_dwordx4 v16,s[20:23],s65 offen offset:1024  lds
buffer_load_dwordx4 v16,s[20:23],s65 offen offset:2048  lds
buffer_load_dwordx4 v16,s[20:23],s65 offen offset:3072  lds
s_add_u32 m0,s72,12288
s_add_u32 s65,s74,12288
buffer_load_dwordx4 v16,s[20:23],s65 offen offset:0  lds
buffer_load_dwordx4 v16,s[20:23],s65 offen offset:1024  lds
buffer_load_dwordx4 v16,s[20:23],s65 offen offset:2048  lds
buffer_load_dwordx4 v16,s[20:23],s65 offen offset:3072  lds
s_waitcnt vmcnt(0)
s_add_u32 s41,s58,55
s_sub_u32 s64,s58,1
s_cmp_lt_u32 s64,2
s_cselect_b32 s41,s41,64
s_lshl_b32 s76,s50,14
s_add_u32 s76,s76,57344
s_add_u32 s42,s55,32
s_lshl_b32 s42,s42,14
s_add_u32 s42,s42,121634816
s_xor_b32 s64,s62,0
s_add_u32 s42,s42,s64
s_sub_u32 s64,s42,2097152
s_xor_b32 s64,s64,0x2000
s_cmp_lt_u32 s55,104
s_cselect_b32 s64,s64,0x7fff0000
s_cmp_lt_u32 s55,96
s_cselect_b32 s42,s42,s64
v_add_u32 v25,4096,v24
s_load_dwordx2 s[4:5],s[0:1],96
s_load_dwordx2 s[6:7],s[0:1],104
v_and_b32 v5,3,v0
v_lshrrev_b32 v6,2,v0
v_mul_u32_u24 v112,12288,v6
v_lshl_add_u32 v112,v5,4,v112
v_lshlrev_b32 v113,1,v6
s_add_u32 s43,s55,64
s_lshl_b32 s43,s43,6
s_mov_b32 s48,0
s_mov_b32 s80,0xffff0000
s_mov_b32 s81,0xbfb8aa3b
s_waitcnt lgkmcnt(0)
s_mov_b32 s12,s4
s_and_b32 s13,s5,0xffff
s_mov_b32 s14,0x800
s_mov_b32 s15,0x20000
s_mov_b32 s16,s6
s_and_b32 s17,s7,0xffff
s_mov_b32 s18,0xc00000
s_mov_b32 s19,0x20000
buffer_load_dwordx4 v[104:107],v112,s[16:19],s43 offen nt
buffer_load_ushort v108,v113,s[12:15],s48 offen
s_add_u32 s43,s43,786432
s_add_u32 s48,s48,128
buffer_load_dwordx4 v[116:119],v112,s[16:19],s43 offen nt
buffer_load_ushort v120,v113,s[12:15],s48 offen
s_add_u32 s43,s43,786432
s_add_u32 s48,s48,128
v_mov_b32 v96,0
v_mov_b32 v97,0
v_mov_b32 v98,0
v_mov_b32 v99,0
v_mov_b32 v100,0
v_mov_b32 v101,0
v_mov_b32 v102,0
v_mov_b32 v103,0
s_waitcnt vmcnt(0)
qloop_202:
s_lshr_b32 s64,s79,2
s_cmp_lg_u32 s64,4
s_cbranch_scc1 np2_204
s_waitcnt vmcnt(0)
s_barrier
s_cmp_lg_u32 s50,0
s_cbranch_scc1 ow_205
s_mov_b64 exec,1
v_mov_b32 v22,14
v_mov_b32 v23,0
s_mov_b32 s64,21052928
buffer_atomic_add v22,v23,s[20:23],s64 offen sc1
s_mov_b64 exec,-1
ow_205:
np2_204:
s_cmp_lg_u32 s79,s41
s_cbranch_scc1 npz_203
s_waitcnt vmcnt(0)
s_barrier
s_cmp_lg_u32 s50,0
s_cbranch_scc1 ow_206
s_mov_b64 exec,1
v_mov_b32 v22,14
v_mov_b32 v23,0
s_mov_b32 s64,21052992
buffer_atomic_add v22,v23,s[20:23],s64 offen sc1
s_mov_b64 exec,-1
ow_206:
s_cmp_lg_u32 s50,0
s_cbranch_scc1 ow_207
s_mov_b64 exec,1
v_mov_b32 v22,14
v_mov_b32 v23,0
buffer_store_dword v22,v23,s[20:23],s73 offen sc1
s_mov_b64 exec,-1
ow_207:
npz_203:
s_waitcnt vmcnt(10)
s_barrier
ds_read_b128 v[224:227],v17 offset:0
ds_read_b128 v[228:231],v17 offset:2048
ds_read_b128 v[232:235],v17 offset:4096
ds_read_b128 v[236:239],v17 offset:6144
ds_read_b128 v[240:243],v17 offset:8192
ds_read_b128 v[244:247],v17 offset:10240
ds_read_b128 v[248:251],v17 offset:12288
s_waitcnt lgkmcnt(5)
v_mfma_f32_16x16x32_bf16 v[64:67],a[0:3],v[224:227],0
s_xor_b32 s72,s72,0x10000
s_add_u32 s77,s79,2
v_mfma_f32_16x16x32_bf16 v[72:75],a[128:131],v[224:227],0
ds_read_b128 v[252:255],v17 offset:14336
s_cmp_lt_u32 s79,56
s_cselect_b32 s77,s41,s77
v_mfma_f32_16x16x32_bf16 v[64:67],a[4:7],v[228:231],v[64:67]
s_add_u32 s74,s79,4
s_cmp_lt_u32 s79,52
s_cselect_b32 s77,s74,s77
v_mfma_f32_16x16x32_bf16 v[72:75],a[132:135],v[228:231],v[72:75]
ds_read_b128 v[224:227],v17 offset:16384
s_waitcnt lgkmcnt(5)
v_mfma_f32_16x16x32_bf16 v[64:67],a[8:11],v[232:235],v[64:67]
s_lshl_b32 s74,s77,16
s_add_u32 s74,s74,s76
v_mfma_f32_16x16x32_bf16 v[72:75],a[136:139],v[232:235],v[72:75]
ds_read_b128 v[228:231],v17 offset:18432
s_add_u32 s64,s79,0
v_mfma_f32_16x16x32_bf16 v[64:67],a[12:15],v[236:239],v[64:67]
s_cmp_lt_u32 s77,64
s_cselect_b32 s74,s74,0x7fff0000
v_mfma_f32_16x16x32_bf16 v[72:75],a[140:143],v[236:239],v[72:75]
ds_read_b128 v[232:235],v17 offset:20480
s_waitcnt lgkmcnt(5)
v_mfma_f32_16x16x32_bf16 v[64:67],a[16:19],v[240:243],v[64:67]
s_add_u32 m0,s72,0
v_lshlrev_b32 v108,16,v108
v_mfma_f32_16x16x32_bf16 v[72:75],a[144:147],v[240:243],v[72:75]
ds_read_b128 v[236:239],v17 offset:22528
v_mul_f32 v109,s81,v108
v_mfma_f32_16x16x32_bf16 v[64:67],a[20:23],v[244:247],v[64:67]
s_lshl_b32 s70,s64,21
v_mfma_f32_16x16x32_bf16 v[72:75],a[148:151],v[244:247],v[72:75]
ds_read_b128 v[240:243],v17 offset:24576
s_waitcnt lgkmcnt(5)
v_mfma_f32_16x16x32_bf16 v[64:67],a[24:27],v[248:251],v[64:67]
s_add_u32 s65,s74,0
v_mfma_f32_16x16x32_bf16 v[72:75],a[152:155],v[248:251],v[72:75]
ds_read_b128 v[244:247],v17 offset:26624
v_mfma_f32_16x16x32_bf16 v[64:67],a[28:31],v[252:255],v[64:67]
buffer_load_dwordx4 v16,s[20:23],s65 offen offset:0  lds
v_mfma_f32_16x16x32_bf16 v[72:75],a[156:159],v[252:255],v[72:75]
ds_read_b128 v[248:251],v17 offset:28672
s_waitcnt lgkmcnt(5)
v_mfma_f32_16x16x32_bf16 v[64:67],a[32:35],v[224:227],v[64:67]
s_lshl_b32 s64,s64,13
v_mfma_f32_16x16x32_bf16 v[72:75],a[160:163],v[224:227],v[72:75]
ds_read_b128 v[252:255],v17 offset:30720
v_mfma_f32_16x16x32_bf16 v[64:67],a[36:39],v[228:231],v[64:67]
buffer_load_dwordx4 v16,s[20:23],s65 offen offset:1024  lds
v_mfma_f32_16x16x32_bf16 v[72:75],a[164:167],v[228:231],v[72:75]
ds_read_b128 v[224:227],v17 offset:32768
s_waitcnt lgkmcnt(5)
v_mfma_f32_16x16x32_bf16 v[64:67],a[40:43],v[232:235],v[64:67]
buffer_load_dwordx4 v16,s[20:23],s65 offen offset:2048  lds
v_mfma_f32_16x16x32_bf16 v[72:75],a[168:171],v[232:235],v[72:75]
ds_read_b128 v[228:231],v17 offset:34816
s_and_b32 s64,s64,0x2000
v_mfma_f32_16x16x32_bf16 v[64:67],a[44:47],v[236:239],v[64:67]
v_exp_f32 v109,v109
v_mfma_f32_16x16x32_bf16 v[72:75],a[172:175],v[236:239],v[72:75]
ds_read_b128 v[232:235],v17 offset:36864
s_waitcnt lgkmcnt(5)
v_mfma_f32_16x16x32_bf16 v[64:67],a[48:51],v[240:243],v[64:67]
buffer_load_dwordx4 v16,s[20:23],s65 offen offset:3072  lds
v_mfma_f32_16x16x32_bf16 v[72:75],a[176:179],v[240:243],v[72:75]
ds_read_b128 v[236:239],v17 offset:38912
s_xor_b32 s64,s64,s62
v_mfma_f32_16x16x32_bf16 v[64:67],a[52:55],v[244:247],v[64:67]
s_add_u32 m0,s72,4096
v_add_f32 v109,1.0,v109
v_mfma_f32_16x16x32_bf16 v[72:75],a[180:183],v[244:247],v[72:75]
ds_read_b128 v[240:243],v17 offset:40960
s_waitcnt lgkmcnt(5)
v_mfma_f32_16x16x32_bf16 v[64:67],a[56:59],v[248:251],v[64:67]
v_rcp_f32 v109,v109
v_mfma_f32_16x16x32_bf16 v[72:75],a[184:187],v[248:251],v[72:75]
ds_read_b128 v[244:247],v17 offset:43008
s_add_u32 s65,s74,4096
v_mfma_f32_16x16x32_bf16 v[64:67],a[60:63],v[252:255],v[64:67]
s_add_u32 s70,s70,s64
v_mul_f32 v109,v109,v108
v_mfma_f32_16x16x32_bf16 v[72:75],a[188:191],v[252:255],v[72:75]
ds_read_b128 v[248:251],v17 offset:45056
s_waitcnt lgkmcnt(5)
v_mfma_f32_16x16x32_bf16 v[64:67],a[64:67],v[224:227],v[64:67]
buffer_load_dwordx4 v16,s[20:23],s65 offen offset:0  lds
v_mfma_f32_16x16x32_bf16 v[72:75],a[192:195],v[224:227],v[72:75]
ds_read_b128 v[252:255],v17 offset:47104
v_cvt_pk_bf16_f32 v109,v109,v109
v_mfma_f32_16x16x32_bf16 v[64:67],a[68:71],v[228:231],v[64:67]
v_and_b32 v108,s80,v109
v_lshlrev_b32 v110,16,v104
v_mfma_f32_16x16x32_bf16 v[72:75],a[196:199],v[228:231],v[72:75]
ds_read_b128 v[224:227],v17 offset:49152
s_waitcnt lgkmcnt(5)
v_mfma_f32_16x16x32_bf16 v[64:67],a[72:75],v[232:235],v[64:67]
buffer_load_dwordx4 v16,s[20:23],s65 offen offset:1024  lds
v_mfma_f32_16x16x32_bf16 v[72:75],a[200:203],v[232:235],v[72:75]
ds_read_b128 v[228:231],v17 offset:51200
s_add_u32 s70,s70,29360128
v_mfma_f32_16x16x32_bf16 v[64:67],a[76:79],v[236:239],v[64:67]
buffer_load_dwordx4 v16,s[20:23],s65 offen offset:2048  lds
v_mfma_f32_16x16x32_bf16 v[72:75],a[204:207],v[236:239],v[72:75]
ds_read_b128 v[232:235],v17 offset:53248
s_waitcnt lgkmcnt(5)
v_mfma_f32_16x16x32_bf16 v[64:67],a[80:83],v[240:243],v[64:67]
v_and_b32 v111,s80,v104
v_fmac_f32 v96,v110,v108
v_mfma_f32_16x16x32_bf16 v[72:75],a[208:211],v[240:243],v[72:75]
ds_read_b128 v[236:239],v17 offset:55296
v_fmac_f32 v97,v111,v108
v_mfma_f32_16x16x32_bf16 v[64:67],a[84:87],v[244:247],v[64:67]
buffer_load_dwordx4 v16,s[20:23],s65 offen offset:3072  lds
v_mfma_f32_16x16x32_bf16 v[72:75],a[212:215],v[244:247],v[72:75]
ds_read_b128 v[240:243],v17 offset:57344
s_waitcnt lgkmcnt(5)
v_mfma_f32_16x16x32_bf16 v[64:67],a[88:91],v[248:251],v[64:67]
s_add_u32 m0,s72,8192
v_lshlrev_b32 v110,16,v105
v_mfma_f32_16x16x32_bf16 v[72:75],a[216:219],v[248:251],v[72:75]
ds_read_b128 v[244:247],v17 offset:59392
v_and_b32 v111,s80,v105
v_mfma_f32_16x16x32_bf16 v[64:67],a[92:95],v[252:255],v[64:67]
v_fmac_f32 v98,v110,v108
v_fmac_f32 v99,v111,v108
v_mfma_f32_16x16x32_bf16 v[72:75],a[220:223],v[252:255],v[72:75]
ds_read_b128 v[248:251],v17 offset:61440
s_waitcnt lgkmcnt(5)
v_mfma_f32_16x16x32_bf16 v[64:67],a[96:99],v[224:227],v[64:67]
s_add_u32 s65,s74,8192
v_lshlrev_b32 v110,16,v106
v_mfma_f32_16x16x32_bf16 v[72:75],a[224:227],v[224:227],v[72:75]
ds_read_b128 v[252:255],v17 offset:63488
v_and_b32 v111,s80,v106
v_mfma_f32_16x16x32_bf16 v[64:67],a[100:103],v[228:231],v[64:67]
buffer_load_dwordx4 v16,s[20:23],s65 offen offset:0  lds
v_mfma_f32_16x16x32_bf16 v[72:75],a[228:231],v[228:231],v[72:75]
ds_read_b128 v[224:227],v17 offset:1024
s_waitcnt lgkmcnt(5)
v_mfma_f32_16x16x32_bf16 v[64:67],a[104:107],v[232:235],v[64:67]
v_fmac_f32 v100,v110,v108
v_fmac_f32 v101,v111,v108
v_mfma_f32_16x16x32_bf16 v[72:75],a[232:235],v[232:235],v[72:75]
ds_read_b128 v[228:231],v17 offset:3072
v_lshlrev_b32 v110,16,v107
v_mfma_f32_16x16x32_bf16 v[64:67],a[108:111],v[236:239],v[64:67]
buffer_load_dwordx4 v16,s[20:23],s65 offen offset:1024  lds
v_mfma_f32_16x16x32_bf16 v[72:75],a[236:239],v[236:239],v[72:75]
ds_read_b128 v[232:235],v17 offset:5120
s_waitcnt lgkmcnt(5)
v_mfma_f32_16x16x32_bf16 v[64:67],a[112:115],v[240:243],v[64:67]
buffer_load_dwordx4 v16,s[20:23],s65 offen offset:2048  lds
v_mfma_f32_16x16x32_bf16 v[72:75],a[240:243],v[240:243],v[72:75]
ds_read_b128 v[236:239],v17 offset:7168
v_and_b32 v111,s80,v107
v_mfma_f32_16x16x32_bf16 v[64:67],a[116:119],v[244:247],v[64:67]
v_fmac_f32 v102,v110,v108
v_fmac_f32 v103,v111,v108
v_mfma_f32_16x16x32_bf16 v[72:75],a[244:247],v[244:247],v[72:75]
ds_read_b128 v[240:243],v17 offset:9216
s_waitcnt lgkmcnt(5)
v_mfma_f32_16x16x32_bf16 v[64:67],a[120:123],v[248:251],v[64:67]
buffer_load_dwordx4 v16,s[20:23],s65 offen offset:3072  lds
v_mfma_f32_16x16x32_bf16 v[72:75],a[248:251],v[248:251],v[72:75]
ds_read_b128 v[244:247],v17 offset:11264
v_mfma_f32_16x16x32_bf16 v[64:67],a[124:127],v[252:255],v[64:67]
s_add_u32 m0,s72,12288
v_mfma_f32_16x16x32_bf16 v[72:75],a[252:255],v[252:255],v[72:75]
ds_read_b128 v[248:251],v17 offset:13312
s_waitcnt lgkmcnt(5)
v_mfma_f32_16x16x32_bf16 v[68:71],a[0:3],v[224:227],0
v_mfma_f32_16x16x32_bf16 v[76:79],a[128:131],v[224:227],0
ds_read_b128 v[252:255],v17 offset:15360
s_add_u32 s65,s74,12288
v_mfma_f32_16x16x32_bf16 v[68:71],a[4:7],v[228:231],v[68:71]
v_mfma_f32_16x16x32_bf16 v[76:79],a[132:135],v[228:231],v[76:79]
ds_read_b128 v[224:227],v17 offset:17408
s_waitcnt lgkmcnt(5)
v_mfma_f32_16x16x32_bf16 v[68:71],a[8:11],v[232:235],v[68:71]
buffer_load_dwordx4 v16,s[20:23],s65 offen offset:0  lds
v_mfma_f32_16x16x32_bf16 v[76:79],a[136:139],v[232:235],v[76:79]
ds_read_b128 v[228:231],v17 offset:19456
v_cvt_pk_bf16_f32 v88,v64,v65
v_mfma_f32_16x16x32_bf16 v[68:71],a[12:15],v[236:239],v[68:71]
v_cvt_pk_bf16_f32 v89,v66,v67
v_cvt_pk_bf16_f32 v90,v72,v73
v_mfma_f32_16x16x32_bf16 v[76:79],a[140:143],v[236:239],v[76:79]
ds_read_b128 v[232:235],v17 offset:21504
s_waitcnt lgkmcnt(5)
v_mfma_f32_16x16x32_bf16 v[68:71],a[16:19],v[240:243],v[68:71]
buffer_load_dwordx4 v16,s[20:23],s65 offen offset:1024  lds
v_mfma_f32_16x16x32_bf16 v[76:79],a[144:147],v[240:243],v[76:79]
ds_read_b128 v[236:239],v17 offset:23552
v_cvt_pk_bf16_f32 v91,v74,v75
v_mfma_f32_16x16x32_bf16 v[68:71],a[20:23],v[244:247],v[68:71]
buffer_load_dwordx4 v16,s[20:23],s65 offen offset:2048  lds
v_mfma_f32_16x16x32_bf16 v[76:79],a[148:151],v[244:247],v[76:79]
ds_read_b128 v[240:243],v17 offset:25600
s_waitcnt lgkmcnt(5)
v_mfma_f32_16x16x32_bf16 v[68:71],a[24:27],v[248:251],v[68:71]
v_mfma_f32_16x16x32_bf16 v[76:79],a[152:155],v[248:251],v[76:79]
ds_read_b128 v[244:247],v17 offset:27648
v_mfma_f32_16x16x32_bf16 v[68:71],a[28:31],v[252:255],v[68:71]
buffer_load_dwordx4 v16,s[20:23],s65 offen offset:3072  lds
v_mfma_f32_16x16x32_bf16 v[76:79],a[156:159],v[252:255],v[76:79]
ds_read_b128 v[248:251],v17 offset:29696
s_waitcnt lgkmcnt(5)
v_mfma_f32_16x16x32_bf16 v[68:71],a[32:35],v[224:227],v[68:71]
v_mfma_f32_16x16x32_bf16 v[76:79],a[160:163],v[224:227],v[76:79]
ds_read_b128 v[252:255],v17 offset:31744
v_mfma_f32_16x16x32_bf16 v[68:71],a[36:39],v[228:231],v[68:71]
v_mfma_f32_16x16x32_bf16 v[76:79],a[164:167],v[228:231],v[76:79]
ds_read_b128 v[224:227],v17 offset:33792
s_waitcnt lgkmcnt(5)
v_mfma_f32_16x16x32_bf16 v[68:71],a[40:43],v[232:235],v[68:71]
buffer_store_dwordx4 v[88:91],v18,s[20:23],s70 offen offset:0 sc1
v_mfma_f32_16x16x32_bf16 v[76:79],a[168:171],v[232:235],v[76:79]
ds_read_b128 v[228:231],v17 offset:35840
v_mfma_f32_16x16x32_bf16 v[68:71],a[44:47],v[236:239],v[68:71]
buffer_load_dwordx4 v[104:107],v112,s[16:19],s43 offen nt
v_mfma_f32_16x16x32_bf16 v[76:79],a[172:175],v[236:239],v[76:79]
ds_read_b128 v[232:235],v17 offset:37888
s_waitcnt lgkmcnt(5)
v_mfma_f32_16x16x32_bf16 v[68:71],a[48:51],v[240:243],v[68:71]
buffer_load_ushort v108,v113,s[12:15],s48 offen
v_mfma_f32_16x16x32_bf16 v[76:79],a[176:179],v[240:243],v[76:79]
ds_read_b128 v[236:239],v17 offset:39936
s_add_u32 s43,s43,786432
v_mfma_f32_16x16x32_bf16 v[68:71],a[52:55],v[244:247],v[68:71]
v_mfma_f32_16x16x32_bf16 v[76:79],a[180:183],v[244:247],v[76:79]
ds_read_b128 v[240:243],v17 offset:41984
s_waitcnt lgkmcnt(5)
v_mfma_f32_16x16x32_bf16 v[68:71],a[56:59],v[248:251],v[68:71]
s_add_u32 s48,s48,128
v_mfma_f32_16x16x32_bf16 v[76:79],a[184:187],v[248:251],v[76:79]
ds_read_b128 v[244:247],v17 offset:44032
v_mfma_f32_16x16x32_bf16 v[68:71],a[60:63],v[252:255],v[68:71]
buffer_store_dwordx4 v[48:51],v24,s[20:23],s93 offen sc1
v_mfma_f32_16x16x32_bf16 v[76:79],a[188:191],v[252:255],v[76:79]
ds_read_b128 v[248:251],v17 offset:46080
s_waitcnt lgkmcnt(5)
v_mfma_f32_16x16x32_bf16 v[68:71],a[64:67],v[224:227],v[68:71]
buffer_store_dwordx4 v[48:51],v25,s[20:23],s93 offen sc1
v_mfma_f32_16x16x32_bf16 v[76:79],a[192:195],v[224:227],v[76:79]
ds_read_b128 v[252:255],v17 offset:48128
v_mfma_f32_16x16x32_bf16 v[68:71],a[68:71],v[228:231],v[68:71]
s_add_u32 s93,s93,8388608
v_mfma_f32_16x16x32_bf16 v[76:79],a[196:199],v[228:231],v[76:79]
ds_read_b128 v[224:227],v17 offset:50176
s_waitcnt lgkmcnt(5)
v_mfma_f32_16x16x32_bf16 v[68:71],a[72:75],v[232:235],v[68:71]
v_mfma_f32_16x16x32_bf16 v[76:79],a[200:203],v[232:235],v[76:79]
ds_read_b128 v[228:231],v17 offset:52224
v_mfma_f32_16x16x32_bf16 v[68:71],a[76:79],v[236:239],v[68:71]
s_cmp_lt_u32 s93,163577856
s_cselect_b32 s93,s93,0x7fff0000
v_mfma_f32_16x16x32_bf16 v[76:79],a[204:207],v[236:239],v[76:79]
ds_read_b128 v[232:235],v17 offset:54272
s_waitcnt lgkmcnt(5)
v_mfma_f32_16x16x32_bf16 v[68:71],a[80:83],v[240:243],v[68:71]
buffer_store_dwordx4 v[48:51],v24,s[20:23],s42 offen sc1
v_mfma_f32_16x16x32_bf16 v[76:79],a[208:211],v[240:243],v[76:79]
ds_read_b128 v[236:239],v17 offset:56320
v_mfma_f32_16x16x32_bf16 v[68:71],a[84:87],v[244:247],v[68:71]
buffer_store_dwordx4 v[48:51],v25,s[20:23],s42 offen sc1
v_mfma_f32_16x16x32_bf16 v[76:79],a[212:215],v[244:247],v[76:79]
ds_read_b128 v[240:243],v17 offset:58368
s_waitcnt lgkmcnt(5)
v_mfma_f32_16x16x32_bf16 v[68:71],a[88:91],v[248:251],v[68:71]
s_add_u32 s42,s42,2097152
v_mfma_f32_16x16x32_bf16 v[76:79],a[216:219],v[248:251],v[76:79]
ds_read_b128 v[244:247],v17 offset:60416
v_mfma_f32_16x16x32_bf16 v[68:71],a[92:95],v[252:255],v[68:71]
s_xor_b32 s42,s42,0x2000
v_mfma_f32_16x16x32_bf16 v[76:79],a[220:223],v[252:255],v[76:79]
ds_read_b128 v[248:251],v17 offset:62464
s_waitcnt lgkmcnt(5)
v_mfma_f32_16x16x32_bf16 v[68:71],a[96:99],v[224:227],v[68:71]
s_cmp_lt_u32 s42,165675008
s_cselect_b32 s42,s42,0x7fff0000
v_mfma_f32_16x16x32_bf16 v[76:79],a[224:227],v[224:227],v[76:79]
ds_read_b128 v[252:255],v17 offset:64512
v_mfma_f32_16x16x32_bf16 v[68:71],a[100:103],v[228:231],v[68:71]
buffer_store_dwordx4 v[48:51],v24,s[20:23],s42 offen sc1
v_mfma_f32_16x16x32_bf16 v[76:79],a[228:231],v[228:231],v[76:79]
s_waitcnt lgkmcnt(4)
v_mfma_f32_16x16x32_bf16 v[68:71],a[104:107],v[232:235],v[68:71]
buffer_store_dwordx4 v[48:51],v25,s[20:23],s42 offen sc1
v_mfma_f32_16x16x32_bf16 v[76:79],a[232:235],v[232:235],v[76:79]
v_mfma_f32_16x16x32_bf16 v[68:71],a[108:111],v[236:239],v[68:71]
v_mfma_f32_16x16x32_bf16 v[76:79],a[236:239],v[236:239],v[76:79]
s_add_u32 s42,s42,2097152
s_waitcnt lgkmcnt(2)
v_mfma_f32_16x16x32_bf16 v[68:71],a[112:115],v[240:243],v[68:71]
v_mfma_f32_16x16x32_bf16 v[76:79],a[240:243],v[240:243],v[76:79]
s_xor_b32 s42,s42,0x2000
v_mfma_f32_16x16x32_bf16 v[68:71],a[116:119],v[244:247],v[68:71]
v_mfma_f32_16x16x32_bf16 v[76:79],a[244:247],v[244:247],v[76:79]
s_waitcnt lgkmcnt(0)
v_mfma_f32_16x16x32_bf16 v[68:71],a[120:123],v[248:251],v[68:71]
s_cmp_lt_u32 s42,165675008
s_cselect_b32 s42,s42,0x7fff0000
v_mfma_f32_16x16x32_bf16 v[76:79],a[248:251],v[248:251],v[76:79]
v_mfma_f32_16x16x32_bf16 v[68:71],a[124:127],v[252:255],v[68:71]
v_mfma_f32_16x16x32_bf16 v[76:79],a[252:255],v[252:255],v[76:79]
v_xor_b32 v17,0x10000,v17
s_mov_b32 s79,s77
s_nop 4
v_cvt_pk_bf16_f32 v92,v68,v69
v_cvt_pk_bf16_f32 v93,v70,v71
v_cvt_pk_bf16_f32 v94,v76,v77
v_cvt_pk_bf16_f32 v95,v78,v79
buffer_store_dwordx4 v[92:95],v18,s[20:23],s70 offen offset:1024 sc1
s_waitcnt vmcnt(10)
s_barrier
ds_read_b128 v[224:227],v17 offset:0
ds_read_b128 v[228:231],v17 offset:2048
ds_read_b128 v[232:235],v17 offset:4096
ds_read_b128 v[236:239],v17 offset:6144
ds_read_b128 v[240:243],v17 offset:8192
ds_read_b128 v[244:247],v17 offset:10240
ds_read_b128 v[248:251],v17 offset:12288
s_waitcnt lgkmcnt(5)
v_mfma_f32_16x16x32_bf16 v[64:67],a[0:3],v[224:227],0
s_xor_b32 s72,s72,0x10000
s_add_u32 s77,s79,2
v_mfma_f32_16x16x32_bf16 v[72:75],a[128:131],v[224:227],0
ds_read_b128 v[252:255],v17 offset:14336
s_cmp_lt_u32 s79,56
s_cselect_b32 s77,s41,s77
v_mfma_f32_16x16x32_bf16 v[64:67],a[4:7],v[228:231],v[64:67]
s_add_u32 s74,s79,4
s_cmp_lt_u32 s79,52
s_cselect_b32 s77,s74,s77
v_mfma_f32_16x16x32_bf16 v[72:75],a[132:135],v[228:231],v[72:75]
ds_read_b128 v[224:227],v17 offset:16384
s_waitcnt lgkmcnt(5)
v_mfma_f32_16x16x32_bf16 v[64:67],a[8:11],v[232:235],v[64:67]
s_lshl_b32 s74,s77,16
s_add_u32 s74,s74,s76
v_mfma_f32_16x16x32_bf16 v[72:75],a[136:139],v[232:235],v[72:75]
ds_read_b128 v[228:231],v17 offset:18432
s_add_u32 s64,s79,0
v_mfma_f32_16x16x32_bf16 v[64:67],a[12:15],v[236:239],v[64:67]
s_cmp_lt_u32 s77,64
s_cselect_b32 s74,s74,0x7fff0000
v_mfma_f32_16x16x32_bf16 v[72:75],a[140:143],v[236:239],v[72:75]
ds_read_b128 v[232:235],v17 offset:20480
s_waitcnt lgkmcnt(5)
v_mfma_f32_16x16x32_bf16 v[64:67],a[16:19],v[240:243],v[64:67]
s_add_u32 m0,s72,0
v_lshlrev_b32 v120,16,v120
v_mfma_f32_16x16x32_bf16 v[72:75],a[144:147],v[240:243],v[72:75]
ds_read_b128 v[236:239],v17 offset:22528
v_mul_f32 v109,s81,v120
v_mfma_f32_16x16x32_bf16 v[64:67],a[20:23],v[244:247],v[64:67]
s_lshl_b32 s70,s64,21
v_mfma_f32_16x16x32_bf16 v[72:75],a[148:151],v[244:247],v[72:75]
ds_read_b128 v[240:243],v17 offset:24576
s_waitcnt lgkmcnt(5)
v_mfma_f32_16x16x32_bf16 v[64:67],a[24:27],v[248:251],v[64:67]
s_add_u32 s65,s74,0
v_mfma_f32_16x16x32_bf16 v[72:75],a[152:155],v[248:251],v[72:75]
ds_read_b128 v[244:247],v17 offset:26624
v_mfma_f32_16x16x32_bf16 v[64:67],a[28:31],v[252:255],v[64:67]
buffer_load_dwordx4 v16,s[20:23],s65 offen offset:0  lds
v_mfma_f32_16x16x32_bf16 v[72:75],a[156:159],v[252:255],v[72:75]
ds_read_b128 v[248:251],v17 offset:28672
s_waitcnt lgkmcnt(5)
v_mfma_f32_16x16x32_bf16 v[64:67],a[32:35],v[224:227],v[64:67]
s_lshl_b32 s64,s64,13
v_mfma_f32_16x16x32_bf16 v[72:75],a[160:163],v[224:227],v[72:75]
ds_read_b128 v[252:255],v17 offset:30720
v_mfma_f32_16x16x32_bf16 v[64:67],a[36:39],v[228:231],v[64:67]
buffer_load_dwordx4 v16,s[20:23],s65 offen offset:1024  lds
v_mfma_f32_16x16x32_bf16 v[72:75],a[164:167],v[228:231],v[72:75]
ds_read_b128 v[224:227],v17 offset:32768
s_waitcnt lgkmcnt(5)
v_mfma_f32_16x16x32_bf16 v[64:67],a[40:43],v[232:235],v[64:67]
buffer_load_dwordx4 v16,s[20:23],s65 offen offset:2048  lds
v_mfma_f32_16x16x32_bf16 v[72:75],a[168:171],v[232:235],v[72:75]
ds_read_b128 v[228:231],v17 offset:34816
s_and_b32 s64,s64,0x2000
v_mfma_f32_16x16x32_bf16 v[64:67],a[44:47],v[236:239],v[64:67]
v_exp_f32 v109,v109
v_mfma_f32_16x16x32_bf16 v[72:75],a[172:175],v[236:239],v[72:75]
ds_read_b128 v[232:235],v17 offset:36864
s_waitcnt lgkmcnt(5)
v_mfma_f32_16x16x32_bf16 v[64:67],a[48:51],v[240:243],v[64:67]
buffer_load_dwordx4 v16,s[20:23],s65 offen offset:3072  lds
v_mfma_f32_16x16x32_bf16 v[72:75],a[176:179],v[240:243],v[72:75]
ds_read_b128 v[236:239],v17 offset:38912
s_xor_b32 s64,s64,s62
v_mfma_f32_16x16x32_bf16 v[64:67],a[52:55],v[244:247],v[64:67]
s_add_u32 m0,s72,4096
v_add_f32 v109,1.0,v109
v_mfma_f32_16x16x32_bf16 v[72:75],a[180:183],v[244:247],v[72:75]
ds_read_b128 v[240:243],v17 offset:40960
s_waitcnt lgkmcnt(5)
v_mfma_f32_16x16x32_bf16 v[64:67],a[56:59],v[248:251],v[64:67]
v_rcp_f32 v109,v109
v_mfma_f32_16x16x32_bf16 v[72:75],a[184:187],v[248:251],v[72:75]
ds_read_b128 v[244:247],v17 offset:43008
s_add_u32 s65,s74,4096
v_mfma_f32_16x16x32_bf16 v[64:67],a[60:63],v[252:255],v[64:67]
s_add_u32 s70,s70,s64
v_mul_f32 v109,v109,v120
v_mfma_f32_16x16x32_bf16 v[72:75],a[188:191],v[252:255],v[72:75]
ds_read_b128 v[248:251],v17 offset:45056
s_waitcnt lgkmcnt(5)
v_mfma_f32_16x16x32_bf16 v[64:67],a[64:67],v[224:227],v[64:67]
buffer_load_dwordx4 v16,s[20:23],s65 offen offset:0  lds
v_mfma_f32_16x16x32_bf16 v[72:75],a[192:195],v[224:227],v[72:75]
ds_read_b128 v[252:255],v17 offset:47104
v_cvt_pk_bf16_f32 v109,v109,v109
v_mfma_f32_16x16x32_bf16 v[64:67],a[68:71],v[228:231],v[64:67]
v_and_b32 v120,s80,v109
v_lshlrev_b32 v110,16,v116
v_mfma_f32_16x16x32_bf16 v[72:75],a[196:199],v[228:231],v[72:75]
ds_read_b128 v[224:227],v17 offset:49152
s_waitcnt lgkmcnt(5)
v_mfma_f32_16x16x32_bf16 v[64:67],a[72:75],v[232:235],v[64:67]
buffer_load_dwordx4 v16,s[20:23],s65 offen offset:1024  lds
v_mfma_f32_16x16x32_bf16 v[72:75],a[200:203],v[232:235],v[72:75]
ds_read_b128 v[228:231],v17 offset:51200
s_add_u32 s70,s70,29360128
v_mfma_f32_16x16x32_bf16 v[64:67],a[76:79],v[236:239],v[64:67]
buffer_load_dwordx4 v16,s[20:23],s65 offen offset:2048  lds
v_mfma_f32_16x16x32_bf16 v[72:75],a[204:207],v[236:239],v[72:75]
ds_read_b128 v[232:235],v17 offset:53248
s_waitcnt lgkmcnt(5)
v_mfma_f32_16x16x32_bf16 v[64:67],a[80:83],v[240:243],v[64:67]
v_and_b32 v111,s80,v116
v_fmac_f32 v96,v110,v120
v_mfma_f32_16x16x32_bf16 v[72:75],a[208:211],v[240:243],v[72:75]
ds_read_b128 v[236:239],v17 offset:55296
v_fmac_f32 v97,v111,v120
v_mfma_f32_16x16x32_bf16 v[64:67],a[84:87],v[244:247],v[64:67]
buffer_load_dwordx4 v16,s[20:23],s65 offen offset:3072  lds
v_mfma_f32_16x16x32_bf16 v[72:75],a[212:215],v[244:247],v[72:75]
ds_read_b128 v[240:243],v17 offset:57344
s_waitcnt lgkmcnt(5)
v_mfma_f32_16x16x32_bf16 v[64:67],a[88:91],v[248:251],v[64:67]
s_add_u32 m0,s72,8192
v_lshlrev_b32 v110,16,v117
v_mfma_f32_16x16x32_bf16 v[72:75],a[216:219],v[248:251],v[72:75]
ds_read_b128 v[244:247],v17 offset:59392
v_and_b32 v111,s80,v117
v_mfma_f32_16x16x32_bf16 v[64:67],a[92:95],v[252:255],v[64:67]
v_fmac_f32 v98,v110,v120
v_fmac_f32 v99,v111,v120
v_mfma_f32_16x16x32_bf16 v[72:75],a[220:223],v[252:255],v[72:75]
ds_read_b128 v[248:251],v17 offset:61440
s_waitcnt lgkmcnt(5)
v_mfma_f32_16x16x32_bf16 v[64:67],a[96:99],v[224:227],v[64:67]
s_add_u32 s65,s74,8192
v_lshlrev_b32 v110,16,v118
v_mfma_f32_16x16x32_bf16 v[72:75],a[224:227],v[224:227],v[72:75]
ds_read_b128 v[252:255],v17 offset:63488
v_and_b32 v111,s80,v118
v_mfma_f32_16x16x32_bf16 v[64:67],a[100:103],v[228:231],v[64:67]
buffer_load_dwordx4 v16,s[20:23],s65 offen offset:0  lds
v_mfma_f32_16x16x32_bf16 v[72:75],a[228:231],v[228:231],v[72:75]
ds_read_b128 v[224:227],v17 offset:1024
s_waitcnt lgkmcnt(5)
v_mfma_f32_16x16x32_bf16 v[64:67],a[104:107],v[232:235],v[64:67]
v_fmac_f32 v100,v110,v120
v_fmac_f32 v101,v111,v120
v_mfma_f32_16x16x32_bf16 v[72:75],a[232:235],v[232:235],v[72:75]
ds_read_b128 v[228:231],v17 offset:3072
v_lshlrev_b32 v110,16,v119
v_mfma_f32_16x16x32_bf16 v[64:67],a[108:111],v[236:239],v[64:67]
buffer_load_dwordx4 v16,s[20:23],s65 offen offset:1024  lds
v_mfma_f32_16x16x32_bf16 v[72:75],a[236:239],v[236:239],v[72:75]
ds_read_b128 v[232:235],v17 offset:5120
s_waitcnt lgkmcnt(5)
v_mfma_f32_16x16x32_bf16 v[64:67],a[112:115],v[240:243],v[64:67]
buffer_load_dwordx4 v16,s[20:23],s65 offen offset:2048  lds
v_mfma_f32_16x16x32_bf16 v[72:75],a[240:243],v[240:243],v[72:75]
ds_read_b128 v[236:239],v17 offset:7168
v_and_b32 v111,s80,v119
v_mfma_f32_16x16x32_bf16 v[64:67],a[116:119],v[244:247],v[64:67]
v_fmac_f32 v102,v110,v120
v_fmac_f32 v103,v111,v120
v_mfma_f32_16x16x32_bf16 v[72:75],a[244:247],v[244:247],v[72:75]
ds_read_b128 v[240:243],v17 offset:9216
s_waitcnt lgkmcnt(5)
v_mfma_f32_16x16x32_bf16 v[64:67],a[120:123],v[248:251],v[64:67]
buffer_load_dwordx4 v16,s[20:23],s65 offen offset:3072  lds
v_mfma_f32_16x16x32_bf16 v[72:75],a[248:251],v[248:251],v[72:75]
ds_read_b128 v[244:247],v17 offset:11264
v_mfma_f32_16x16x32_bf16 v[64:67],a[124:127],v[252:255],v[64:67]
s_add_u32 m0,s72,12288
v_mfma_f32_16x16x32_bf16 v[72:75],a[252:255],v[252:255],v[72:75]
ds_read_b128 v[248:251],v17 offset:13312
s_waitcnt lgkmcnt(5)
v_mfma_f32_16x16x32_bf16 v[68:71],a[0:3],v[224:227],0
v_mfma_f32_16x16x32_bf16 v[76:79],a[128:131],v[224:227],0
ds_read_b128 v[252:255],v17 offset:15360
s_add_u32 s65,s74,12288
v_mfma_f32_16x16x32_bf16 v[68:71],a[4:7],v[228:231],v[68:71]
v_mfma_f32_16x16x32_bf16 v[76:79],a[132:135],v[228:231],v[76:79]
ds_read_b128 v[224:227],v17 offset:17408
s_waitcnt lgkmcnt(5)
v_mfma_f32_16x16x32_bf16 v[68:71],a[8:11],v[232:235],v[68:71]
buffer_load_dwordx4 v16,s[20:23],s65 offen offset:0  lds
v_mfma_f32_16x16x32_bf16 v[76:79],a[136:139],v[232:235],v[76:79]
ds_read_b128 v[228:231],v17 offset:19456
v_cvt_pk_bf16_f32 v88,v64,v65
v_mfma_f32_16x16x32_bf16 v[68:71],a[12:15],v[236:239],v[68:71]
v_cvt_pk_bf16_f32 v89,v66,v67
v_cvt_pk_bf16_f32 v90,v72,v73
v_mfma_f32_16x16x32_bf16 v[76:79],a[140:143],v[236:239],v[76:79]
ds_read_b128 v[232:235],v17 offset:21504
s_waitcnt lgkmcnt(5)
v_mfma_f32_16x16x32_bf16 v[68:71],a[16:19],v[240:243],v[68:71]
buffer_load_dwordx4 v16,s[20:23],s65 offen offset:1024  lds
v_mfma_f32_16x16x32_bf16 v[76:79],a[144:147],v[240:243],v[76:79]
ds_read_b128 v[236:239],v17 offset:23552
v_cvt_pk_bf16_f32 v91,v74,v75
v_mfma_f32_16x16x32_bf16 v[68:71],a[20:23],v[244:247],v[68:71]
buffer_load_dwordx4 v16,s[20:23],s65 offen offset:2048  lds
v_mfma_f32_16x16x32_bf16 v[76:79],a[148:151],v[244:247],v[76:79]
ds_read_b128 v[240:243],v17 offset:25600
s_waitcnt lgkmcnt(5)
v_mfma_f32_16x16x32_bf16 v[68:71],a[24:27],v[248:251],v[68:71]
v_mfma_f32_16x16x32_bf16 v[76:79],a[152:155],v[248:251],v[76:79]
ds_read_b128 v[244:247],v17 offset:27648
v_mfma_f32_16x16x32_bf16 v[68:71],a[28:31],v[252:255],v[68:71]
buffer_load_dwordx4 v16,s[20:23],s65 offen offset:3072  lds
v_mfma_f32_16x16x32_bf16 v[76:79],a[156:159],v[252:255],v[76:79]
ds_read_b128 v[248:251],v17 offset:29696
s_waitcnt lgkmcnt(5)
v_mfma_f32_16x16x32_bf16 v[68:71],a[32:35],v[224:227],v[68:71]
v_mfma_f32_16x16x32_bf16 v[76:79],a[160:163],v[224:227],v[76:79]
ds_read_b128 v[252:255],v17 offset:31744
v_mfma_f32_16x16x32_bf16 v[68:71],a[36:39],v[228:231],v[68:71]
v_mfma_f32_16x16x32_bf16 v[76:79],a[164:167],v[228:231],v[76:79]
ds_read_b128 v[224:227],v17 offset:33792
s_waitcnt lgkmcnt(5)
v_mfma_f32_16x16x32_bf16 v[68:71],a[40:43],v[232:235],v[68:71]
buffer_store_dwordx4 v[88:91],v18,s[20:23],s70 offen offset:0 sc1
v_mfma_f32_16x16x32_bf16 v[76:79],a[168:171],v[232:235],v[76:79]
ds_read_b128 v[228:231],v17 offset:35840
v_mfma_f32_16x16x32_bf16 v[68:71],a[44:47],v[236:239],v[68:71]
buffer_load_dwordx4 v[116:119],v112,s[16:19],s43 offen nt
v_mfma_f32_16x16x32_bf16 v[76:79],a[172:175],v[236:239],v[76:79]
ds_read_b128 v[232:235],v17 offset:37888
s_waitcnt lgkmcnt(5)
v_mfma_f32_16x16x32_bf16 v[68:71],a[48:51],v[240:243],v[68:71]
buffer_load_ushort v120,v113,s[12:15],s48 offen
v_mfma_f32_16x16x32_bf16 v[76:79],a[176:179],v[240:243],v[76:79]
ds_read_b128 v[236:239],v17 offset:39936
s_add_u32 s43,s43,786432
v_mfma_f32_16x16x32_bf16 v[68:71],a[52:55],v[244:247],v[68:71]
v_mfma_f32_16x16x32_bf16 v[76:79],a[180:183],v[244:247],v[76:79]
ds_read_b128 v[240:243],v17 offset:41984
s_waitcnt lgkmcnt(5)
v_mfma_f32_16x16x32_bf16 v[68:71],a[56:59],v[248:251],v[68:71]
s_add_u32 s48,s48,128
v_mfma_f32_16x16x32_bf16 v[76:79],a[184:187],v[248:251],v[76:79]
ds_read_b128 v[244:247],v17 offset:44032
v_mfma_f32_16x16x32_bf16 v[68:71],a[60:63],v[252:255],v[68:71]
buffer_store_dwordx4 v[48:51],v24,s[20:23],s93 offen sc1
v_mfma_f32_16x16x32_bf16 v[76:79],a[188:191],v[252:255],v[76:79]
ds_read_b128 v[248:251],v17 offset:46080
s_waitcnt lgkmcnt(5)
v_mfma_f32_16x16x32_bf16 v[68:71],a[64:67],v[224:227],v[68:71]
buffer_store_dwordx4 v[48:51],v25,s[20:23],s93 offen sc1
v_mfma_f32_16x16x32_bf16 v[76:79],a[192:195],v[224:227],v[76:79]
ds_read_b128 v[252:255],v17 offset:48128
v_mfma_f32_16x16x32_bf16 v[68:71],a[68:71],v[228:231],v[68:71]
s_add_u32 s93,s93,8388608
v_mfma_f32_16x16x32_bf16 v[76:79],a[196:199],v[228:231],v[76:79]
ds_read_b128 v[224:227],v17 offset:50176
s_waitcnt lgkmcnt(5)
v_mfma_f32_16x16x32_bf16 v[68:71],a[72:75],v[232:235],v[68:71]
v_mfma_f32_16x16x32_bf16 v[76:79],a[200:203],v[232:235],v[76:79]
ds_read_b128 v[228:231],v17 offset:52224
v_mfma_f32_16x16x32_bf16 v[68:71],a[76:79],v[236:239],v[68:71]
s_cmp_lt_u32 s93,163577856
s_cselect_b32 s93,s93,0x7fff0000
v_mfma_f32_16x16x32_bf16 v[76:79],a[204:207],v[236:239],v[76:79]
ds_read_b128 v[232:235],v17 offset:54272
s_waitcnt lgkmcnt(5)
v_mfma_f32_16x16x32_bf16 v[68:71],a[80:83],v[240:243],v[68:71]
buffer_store_dwordx4 v[48:51],v24,s[20:23],s42 offen sc1
v_mfma_f32_16x16x32_bf16 v[76:79],a[208:211],v[240:243],v[76:79]
ds_read_b128 v[236:239],v17 offset:56320
v_mfma_f32_16x16x32_bf16 v[68:71],a[84:87],v[244:247],v[68:71]
buffer_store_dwordx4 v[48:51],v25,s[20:23],s42 offen sc1
v_mfma_f32_16x16x32_bf16 v[76:79],a[212:215],v[244:247],v[76:79]
ds_read_b128 v[240:243],v17 offset:58368
s_waitcnt lgkmcnt(5)
v_mfma_f32_16x16x32_bf16 v[68:71],a[88:91],v[248:251],v[68:71]
s_add_u32 s42,s42,2097152
v_mfma_f32_16x16x32_bf16 v[76:79],a[216:219],v[248:251],v[76:79]
ds_read_b128 v[244:247],v17 offset:60416
v_mfma_f32_16x16x32_bf16 v[68:71],a[92:95],v[252:255],v[68:71]
s_xor_b32 s42,s42,0x2000
v_mfma_f32_16x16x32_bf16 v[76:79],a[220:223],v[252:255],v[76:79]
ds_read_b128 v[248:251],v17 offset:62464
s_waitcnt lgkmcnt(5)
v_mfma_f32_16x16x32_bf16 v[68:71],a[96:99],v[224:227],v[68:71]
s_cmp_lt_u32 s42,165675008
s_cselect_b32 s42,s42,0x7fff0000
v_mfma_f32_16x16x32_bf16 v[76:79],a[224:227],v[224:227],v[76:79]
ds_read_b128 v[252:255],v17 offset:64512
v_mfma_f32_16x16x32_bf16 v[68:71],a[100:103],v[228:231],v[68:71]
buffer_store_dwordx4 v[48:51],v24,s[20:23],s42 offen sc1
v_mfma_f32_16x16x32_bf16 v[76:79],a[228:231],v[228:231],v[76:79]
s_waitcnt lgkmcnt(4)
v_mfma_f32_16x16x32_bf16 v[68:71],a[104:107],v[232:235],v[68:71]
buffer_store_dwordx4 v[48:51],v25,s[20:23],s42 offen sc1
v_mfma_f32_16x16x32_bf16 v[76:79],a[232:235],v[232:235],v[76:79]
v_mfma_f32_16x16x32_bf16 v[68:71],a[108:111],v[236:239],v[68:71]
v_mfma_f32_16x16x32_bf16 v[76:79],a[236:239],v[236:239],v[76:79]
s_add_u32 s42,s42,2097152
s_waitcnt lgkmcnt(2)
v_mfma_f32_16x16x32_bf16 v[68:71],a[112:115],v[240:243],v[68:71]
v_mfma_f32_16x16x32_bf16 v[76:79],a[240:243],v[240:243],v[76:79]
s_xor_b32 s42,s42,0x2000
v_mfma_f32_16x16x32_bf16 v[68:71],a[116:119],v[244:247],v[68:71]
v_mfma_f32_16x16x32_bf16 v[76:79],a[244:247],v[244:247],v[76:79]
s_waitcnt lgkmcnt(0)
v_mfma_f32_16x16x32_bf16 v[68:71],a[120:123],v[248:251],v[68:71]
s_cmp_lt_u32 s42,165675008
s_cselect_b32 s42,s42,0x7fff0000
v_mfma_f32_16x16x32_bf16 v[76:79],a[248:251],v[248:251],v[76:79]
v_mfma_f32_16x16x32_bf16 v[68:71],a[124:127],v[252:255],v[68:71]
v_mfma_f32_16x16x32_bf16 v[76:79],a[252:255],v[252:255],v[76:79]
v_xor_b32 v17,0x10000,v17
s_mov_b32 s79,s77
s_nop 4
v_cvt_pk_bf16_f32 v92,v68,v69
v_cvt_pk_bf16_f32 v93,v70,v71
v_cvt_pk_bf16_f32 v94,v76,v77
v_cvt_pk_bf16_f32 v95,v78,v79
buffer_store_dwordx4 v[92:95],v18,s[20:23],s70 offen offset:1024 sc1
s_cmp_lt_u32 s79,64
s_cbranch_scc1 qloop_202
s_waitcnt vmcnt(0)
s_barrier
s_cmp_lg_u32 s41,64
s_cbranch_scc1 np3_208
s_cmp_lg_u32 s50,0
s_cbranch_scc1 ow_209
s_mov_b64 exec,1
v_mov_b32 v22,14
v_mov_b32 v23,0
s_mov_b32 s64,21052992
buffer_atomic_add v22,v23,s[20:23],s64 offen sc1
s_mov_b64 exec,-1
ow_209:
np3_208:
s_cmp_lg_u32 s50,0
s_cbranch_scc1 ow_210
s_mov_b64 exec,1
v_mov_b32 v22,18
v_mov_b32 v23,0
buffer_store_dword v22,v23,s[20:23],s73 offen sc1
s_mov_b64 exec,-1
ow_210:
v_lshlrev_b32 v108,16,v108
v_mul_f32 v109,s81,v108
v_exp_f32 v109,v109
s_nop 0
v_add_f32 v109,1.0,v109
v_rcp_f32 v109,v109
s_nop 0
v_mul_f32 v109,v109,v108
v_cvt_pk_bf16_f32 v109,v109,v109
v_and_b32 v108,s80,v109
v_lshlrev_b32 v110,16,v104
v_and_b32 v111,s80,v104
v_fmac_f32 v96,v110,v108
v_fmac_f32 v97,v111,v108
v_lshlrev_b32 v110,16,v105
v_and_b32 v111,s80,v105
v_fmac_f32 v98,v110,v108
v_fmac_f32 v99,v111,v108
v_lshlrev_b32 v110,16,v106
v_and_b32 v111,s80,v106
v_fmac_f32 v100,v110,v108
v_fmac_f32 v101,v111,v108
v_lshlrev_b32 v110,16,v107
v_and_b32 v111,s80,v107
v_fmac_f32 v102,v110,v108
v_fmac_f32 v103,v111,v108
v_lshlrev_b32 v120,16,v120
v_mul_f32 v109,s81,v120
v_exp_f32 v109,v109
s_nop 0
v_add_f32 v109,1.0,v109
v_rcp_f32 v109,v109
s_nop 0
v_mul_f32 v109,v109,v120
v_cvt_pk_bf16_f32 v109,v109,v109
v_and_b32 v120,s80,v109
v_lshlrev_b32 v110,16,v116
v_and_b32 v111,s80,v116
v_fmac_f32 v96,v110,v120
v_fmac_f32 v97,v111,v120
v_lshlrev_b32 v110,16,v117
v_and_b32 v111,s80,v117
v_fmac_f32 v98,v110,v120
v_fmac_f32 v99,v111,v120
v_lshlrev_b32 v110,16,v118
v_and_b32 v111,s80,v118
v_fmac_f32 v100,v110,v120
v_fmac_f32 v101,v111,v120
v_lshlrev_b32 v110,16,v119
v_and_b32 v111,s80,v119
v_fmac_f32 v102,v110,v120
v_fmac_f32 v103,v111,v120
v_lshlrev_b32 v5,5,v0
ds_write_b128 v5,v[96:99]
ds_write_b128 v5,v[100:103] offset:16
v_and_b32 v6,31,v0
v_lshrrev_b32 v7,5,v0
v_lshlrev_b32 v7,10,v7
v_lshl_add_u32 v7,v6,2,v7
s_waitcnt lgkmcnt(0)
s_barrier
ds_read_b32 v8,v7 offset:0
ds_read_b32 v9,v7 offset:128
ds_read_b32 v10,v7 offset:256
ds_read_b32 v11,v7 offset:384
ds_read_b32 v12,v7 offset:512
ds_read_b32 v13,v7 offset:640
ds_read_b32 v14,v7 offset:768
ds_read_b32 v15,v7 offset:896
s_waitcnt lgkmcnt(0)
v_add_f32 v8,v8,v9
v_add_f32 v8,v8,v10
v_add_f32 v8,v8,v11
v_add_f32 v8,v8,v12
v_add_f32 v8,v8,v13
v_add_f32 v8,v8,v14
v_add_f32 v8,v8,v15
v_lshlrev_b32 v5,2,v0
ds_write_b32 v5,v8 offset:8192
v_lshlrev_b32 v7,2,v6
s_waitcnt lgkmcnt(0)
s_barrier
ds_read_b32 v8,v7 offset:8192
ds_read_b32 v9,v7 offset:8320
ds_read_b32 v10,v7 offset:8448
ds_read_b32 v11,v7 offset:8576
ds_read_b32 v12,v7 offset:8704
ds_read_b32 v13,v7 offset:8832
ds_read_b32 v14,v7 offset:8960
ds_read_b32 v15,v7 offset:9088
s_waitcnt lgkmcnt(0)
v_add_f32 v8,v8,v9
v_add_f32 v8,v8,v10
v_add_f32 v8,v8,v11
v_add_f32 v8,v8,v12
v_add_f32 v8,v8,v13
v_add_f32 v8,v8,v14
v_add_f32 v8,v8,v15
v_cvt_pk_bf16_f32 v8,v8,v8
v_and_b32 v8,s80,v8
s_lshl_b32 s64,s55,7
s_add_u32 s64,s64,8192
s_cmp_lg_u32 s50,0
s_cbranch_scc1 ow_211
buffer_store_dword v8,v7,s[20:23],s64 offen sc1
ow_211:
s_waitcnt vmcnt(0)
s_barrier
s_cmp_lg_u32 s50,0
s_cbranch_scc1 ow_212
s_mov_b64 exec,1
v_mov_b32 v22,14
v_mov_b32 v23,0
s_mov_b32 s64,21052032
buffer_atomic_add v22,v23,s[20:23],s64 offen sc1
s_mov_b64 exec,-1
ow_212:
s_lshr_b32 s58,s55,5
s_and_b32 s59,s55,31
s_mov_b32 s57,65
s_mov_b32 s79,0
s_branch common_213
pipe_second:
s_cmp_ge_u32 s59,18
s_cbranch_scc1 giveup_197
s_getpc_b64 s[4:5]
pc2nd:
s_sub_u32 s8,s4,pc2nd-mega_kernel
s_subb_u32 s9,s5,0
s_and_b32 s9,s9,0xffff
s_mov_b32 s10,code_end-mega_kernel
s_mov_b32 s11,0x20000
s_lshl_b32 s12,s59,15
v_lshlrev_b32 v2,7,v0
buffer_load_dword v2,v2,s[8:11],s12 offen
s_add_u32 s55,s57,128
s_and_b32 s64,s59,1
s_lshl_b32 s65,s58,1
s_add_u32 s64,s64,s65
s_lshl_b32 s65,s59,2
s_and_b32 s65,s65,24
s_add_u32 s65,s65,s64
s_add_u32 s64,s64,24
s_cmp_ge_u32 s59,16
s_cselect_b32 s64,s64,s65
s_lshl_b32 s65,s58,3
s_add_u32 s65,s65,s59
s_lshr_b32 s58,s59,3
s_add_u32 s58,s58,1
s_cmp_lt_u32 s59,8
s_cselect_b32 s59,s65,s64
s_xor_b32 s62,s61,0x2000
s_add_u32 s63,s62,21053440
s_mov_b32 s57,65
s_mov_b32 s79,64
s_mov_b32 s90,400000
common_213:
v_and_b32 v1,63,v0
v_and_b32 v3,15,v1
v_lshrrev_b32 v4,4,v1
v_lshlrev_b32 v16,4,v1
v_mov_b32 v48,0
v_mov_b32 v49,0
v_mov_b32 v50,0
v_mov_b32 v51,0
s_mov_b64 s[24:25],s[20:21]
s_mov_b64 s[28:29],s[20:21]
s_mov_b32 s27,0x20000
s_mov_b32 s31,0x20000
s_cmp_eq_u32 s56,0
s_cselect_b32 s26,s22,0
s_cselect_b32 s30,0,s22
s_add_u32 s71,s79,1
s_lshl_b32 s60,s79,4
s_mov_b32 s98,0
s_mov_b32 s99,0
v_mov_b32 v29,0
v_cmp_eq_u32 vcc,0,v1
v_mov_b32 v23,0x40000000
s_nop 0
v_cndmask_b32 v23,v23,v48,vcc
s_mov_b32 s80,0xffff0000
s_cmp_eq_u32 s58,0
s_cbranch_scc1 r_wo_214
s_cmp_eq_u32 s58,1
s_cbranch_scc1 r_w3_215
s_cmp_eq_u32 s58,2
s_cbranch_scc1 r_w4_216
s_and_b32 s41,s59,15
s_cmp_lt_u32 s59,16
s_cbranch_scc1 r_at_219
s_cmp_ge_u32 s59,24
s_cbranch_scc1 r_w2_217
s_load_dwordx2 s[4:5],s[0:1],64
s_and_b32 s41,s59,7
s_lshl_b32 s66,s41,8
s_lshl_b32 s67,s50,1
s_waitcnt lgkmcnt(0)
s_mov_b32 s32,s4
s_and_b32 s33,s5,0xffff
s_mov_b32 s34,0x200000
s_mov_b32 s35,0x20000
v_lshrrev_b32 v5,2,v3
v_lshl_add_u32 v7,v4,3,v5
v_and_b32 v6,3,v3
v_lshlrev_b32 v6,3,v6
v_lshl_add_u32 v6,v7,8,v6
v_and_b32 v7,1,v4
v_lshl_add_u32 v5,v7,2,v5
v_xor_b32 v5,s67,v5
v_lshl_add_u32 v12,v5,5,v6
v_xor_b32 v13,32,v12
v_and_b32 v5,15,v1
v_and_b32 v6,3,v4
v_lshlrev_b32 v6,1,v6
v_xor_b32 v5,v5,v6
v_mul_u32_u24 v6,2048,v4
v_xor_b32 v7,0,v5
v_lshl_add_u32 v8,v7,4,v6
v_xor_b32 v7,8,v5
v_lshl_add_u32 v9,v7,4,v6
s_mul_i32 s74,s50,131072
s_add_u32 s74,s74,s66
s_lshl_b32 s75,s50,14
s_mul_i32 s76,s50,65536
s_add_u32 s76,s76,s66
s_lshl_b32 s77,s50,13
s_add_u32 s64,s74,0
s_add_u32 m0,s75,0
s_nop 0
buffer_load_dwordx4 v8,s[32:35],s64 offen nt lds
s_add_u32 s64,s74,8192
s_add_u32 m0,s75,1024
s_nop 0
buffer_load_dwordx4 v8,s[32:35],s64 offen nt lds
s_add_u32 s64,s74,16384
s_add_u32 m0,s75,2048
s_nop 0
buffer_load_dwordx4 v9,s[32:35],s64 offen nt lds
s_add_u32 s64,s74,24576
s_add_u32 m0,s75,3072
s_nop 0
buffer_load_dwordx4 v9,s[32:35],s64 offen nt lds
s_add_u32 s64,s74,32768
s_add_u32 m0,s75,4096
s_nop 0
buffer_load_dwordx4 v8,s[32:35],s64 offen nt lds
s_add_u32 s64,s74,40960
s_add_u32 m0,s75,5120
s_nop 0
buffer_load_dwordx4 v8,s[32:35],s64 offen nt lds
s_add_u32 s64,s74,49152
s_add_u32 m0,s75,6144
s_nop 0
buffer_load_dwordx4 v9,s[32:35],s64 offen nt lds
s_add_u32 s64,s74,57344
s_add_u32 m0,s75,7168
s_nop 0
buffer_load_dwordx4 v9,s[32:35],s64 offen nt lds
s_add_u32 s64,s74,65536
s_add_u32 m0,s75,8192
s_nop 0
buffer_load_dwordx4 v8,s[32:35],s64 offen nt lds
s_add_u32 s64,s74,73728
s_add_u32 m0,s75,9216
s_nop 0
buffer_load_dwordx4 v8,s[32:35],s64 offen nt lds
s_add_u32 s64,s74,81920
s_add_u32 m0,s75,10240
s_nop 0
buffer_load_dwordx4 v9,s[32:35],s64 offen nt lds
s_add_u32 s64,s74,90112
s_add_u32 m0,s75,11264
s_nop 0
buffer_load_dwordx4 v9,s[32:35],s64 offen nt lds
s_add_u32 s64,s74,98304
s_add_u32 m0,s75,12288
s_nop 0
buffer_load_dwordx4 v8,s[32:35],s64 offen nt lds
s_add_u32 s64,s74,106496
s_add_u32 m0,s75,13312
s_nop 0
buffer_load_dwordx4 v8,s[32:35],s64 offen nt lds
s_add_u32 s64,s74,114688
s_add_u32 m0,s75,14336
s_nop 0
buffer_load_dwordx4 v9,s[32:35],s64 offen nt lds
s_add_u32 s64,s74,122880
s_add_u32 m0,s75,15360
s_nop 0
buffer_load_dwordx4 v9,s[32:35],s64 offen nt lds
s_add_u32 s64,s74,524288
s_add_u32 m0,s75,65536
s_nop 0
buffer_load_dwordx4 v8,s[32:35],s64 offen nt lds
s_add_u32 s64,s74,532480
s_add_u32 m0,s75,66560
s_nop 0
buffer_load_dwordx4 v8,s[32:35],s64 offen nt lds
s_add_u32 s64,s74,540672
s_add_u32 m0,s75,67584
s_nop 0
buffer_load_dwordx4 v9,s[32:35],s64 offen nt lds
s_add_u32 s64,s74,548864
s_add_u32 m0,s75,68608
s_nop 0
buffer_load_dwordx4 v9,s[32:35],s64 offen nt lds
s_add_u32 s64,s74,557056
s_add_u32 m0,s75,69632
s_nop 0
buffer_load_dwordx4 v8,s[32:35],s64 offen nt lds
s_add_u32 s64,s74,565248
s_add_u32 m0,s75,70656
s_nop 0
buffer_load_dwordx4 v8,s[32:35],s64 offen nt lds
s_add_u32 s64,s74,573440
s_add_u32 m0,s75,71680
s_nop 0
buffer_load_dwordx4 v9,s[32:35],s64 offen nt lds
s_add_u32 s64,s74,581632
s_add_u32 m0,s75,72704
s_nop 0
buffer_load_dwordx4 v9,s[32:35],s64 offen nt lds
s_add_u32 s64,s74,589824
s_add_u32 m0,s75,73728
s_nop 0
buffer_load_dwordx4 v8,s[32:35],s64 offen nt lds
s_add_u32 s64,s74,598016
s_add_u32 m0,s75,74752
s_nop 0
buffer_load_dwordx4 v8,s[32:35],s64 offen nt lds
s_add_u32 s64,s74,606208
s_add_u32 m0,s75,75776
s_nop 0
buffer_load_dwordx4 v9,s[32:35],s64 offen nt lds
s_add_u32 s64,s74,614400
s_add_u32 m0,s75,76800
s_nop 0
buffer_load_dwordx4 v9,s[32:35],s64 offen nt lds
s_add_u32 s64,s74,622592
s_add_u32 m0,s75,77824
s_nop 0
buffer_load_dwordx4 v8,s[32:35],s64 offen nt lds
s_add_u32 s64,s74,630784
s_add_u32 m0,s75,78848
s_nop 0
buffer_load_dwordx4 v8,s[32:35],s64 offen nt lds
s_add_u32 s64,s74,638976
s_add_u32 m0,s75,79872
s_nop 0
buffer_load_dwordx4 v9,s[32:35],s64 offen nt lds
s_add_u32 s64,s74,647168
s_add_u32 m0,s75,80896
s_nop 0
buffer_load_dwordx4 v9,s[32:35],s64 offen nt lds
s_waitcnt vmcnt(16)
s_barrier
ds_read_b64_tr_b16 a[0:1],v12 offset:0
ds_read_b64_tr_b16 a[128:129],v13 offset:0
ds_read_b64_tr_b16 a[2:3],v12 offset:1024
ds_read_b64_tr_b16 a[130:131],v13 offset:1024
ds_read_b64_tr_b16 a[4:5],v12 offset:8192
ds_read_b64_tr_b16 a[132:133],v13 offset:8192
ds_read_b64_tr_b16 a[6:7],v12 offset:9216
ds_read_b64_tr_b16 a[134:135],v13 offset:9216
s_waitcnt lgkmcnt(4)
ds_read_b64_tr_b16 a[8:9],v12 offset:16384
ds_read_b64_tr_b16 a[136:137],v13 offset:16384
ds_read_b64_tr_b16 a[10:11],v12 offset:17408
ds_read_b64_tr_b16 a[138:139],v13 offset:17408
ds_read_b64_tr_b16 a[12:13],v12 offset:24576
ds_read_b64_tr_b16 a[140:141],v13 offset:24576
ds_read_b64_tr_b16 a[14:15],v12 offset:25600
ds_read_b64_tr_b16 a[142:143],v13 offset:25600
s_waitcnt lgkmcnt(4)
ds_read_b64_tr_b16 a[16:17],v12 offset:32768
ds_read_b64_tr_b16 a[144:145],v13 offset:32768
ds_read_b64_tr_b16 a[18:19],v12 offset:33792
ds_read_b64_tr_b16 a[146:147],v13 offset:33792
ds_read_b64_tr_b16 a[20:21],v12 offset:40960
ds_read_b64_tr_b16 a[148:149],v13 offset:40960
ds_read_b64_tr_b16 a[22:23],v12 offset:41984
ds_read_b64_tr_b16 a[150:151],v13 offset:41984
s_waitcnt lgkmcnt(4)
ds_read_b64_tr_b16 a[24:25],v12 offset:49152
ds_read_b64_tr_b16 a[152:153],v13 offset:49152
ds_read_b64_tr_b16 a[26:27],v12 offset:50176
ds_read_b64_tr_b16 a[154:155],v13 offset:50176
ds_read_b64_tr_b16 a[28:29],v12 offset:57344
ds_read_b64_tr_b16 a[156:157],v13 offset:57344
ds_read_b64_tr_b16 a[30:31],v12 offset:58368
ds_read_b64_tr_b16 a[158:159],v13 offset:58368
s_waitcnt lgkmcnt(4)
v_xor_b32 v12,0x10000,v12
v_xor_b32 v13,0x10000,v13
s_waitcnt lgkmcnt(0)
s_barrier
s_add_u32 s64,s74,1048576
s_add_u32 m0,s75,0
s_nop 0
buffer_load_dwordx4 v8,s[32:35],s64 offen nt lds
s_add_u32 s64,s74,1056768
s_add_u32 m0,s75,1024
s_nop 0
buffer_load_dwordx4 v8,s[32:35],s64 offen nt lds
s_add_u32 s64,s74,1064960
s_add_u32 m0,s75,2048
s_nop 0
buffer_load_dwordx4 v9,s[32:35],s64 offen nt lds
s_add_u32 s64,s74,1073152
s_add_u32 m0,s75,3072
s_nop 0
buffer_load_dwordx4 v9,s[32:35],s64 offen nt lds
s_add_u32 s64,s74,1081344
s_add_u32 m0,s75,4096
s_nop 0
buffer_load_dwordx4 v8,s[32:35],s64 offen nt lds
s_add_u32 s64,s74,1089536
s_add_u32 m0,s75,5120
s_nop 0
buffer_load_dwordx4 v8,s[32:35],s64 offen nt lds
s_add_u32 s64,s74,1097728
s_add_u32 m0,s75,6144
s_nop 0
buffer_load_dwordx4 v9,s[32:35],s64 offen nt lds
s_add_u32 s64,s74,1105920
s_add_u32 m0,s75,7168
s_nop 0
buffer_load_dwordx4 v9,s[32:35],s64 offen nt lds
s_add_u32 s64,s74,1114112
s_add_u32 m0,s75,8192
s_nop 0
buffer_load_dwordx4 v8,s[32:35],s64 offen nt lds
s_add_u32 s64,s74,1122304
s_add_u32 m0,s75,9216
s_nop 0
buffer_load_dwordx4 v8,s[32:35],s64 offen nt lds
s_add_u32 s64,s74,1130496
s_add_u32 m0,s75,10240
s_nop 0
buffer_load_dwordx4 v9,s[32:35],s64 offen nt lds
s_add_u32 s64,s74,1138688
s_add_u32 m0,s75,11264
s_nop 0
buffer_load_dwordx4 v9,s[32:35],s64 offen nt lds
s_add_u32 s64,s74,1146880
s_add_u32 m0,s75,12288
s_nop 0
buffer_load_dwordx4 v8,s[32:35],s64 offen nt lds
s_add_u32 s64,s74,1155072
s_add_u32 m0,s75,13312
s_nop 0
buffer_load_dwordx4 v8,s[32:35],s64 offen nt lds
s_add_u32 s64,s74,1163264
s_add_u32 m0,s75,14336
s_nop 0
buffer_load_dwordx4 v9,s[32:35],s64 offen nt lds
s_add_u32 s64,s74,1171456
s_add_u32 m0,s75,15360
s_nop 0
buffer_load_dwordx4 v9,s[32:35],s64 offen nt lds
s_waitcnt vmcnt(16)
s_barrier
ds_read_b64_tr_b16 a[32:33],v12 offset:0
ds_read_b64_tr_b16 a[160:161],v13 offset:0
ds_read_b64_tr_b16 a[34:35],v12 offset:1024
ds_read_b64_tr_b16 a[162:163],v13 offset:1024
ds_read_b64_tr_b16 a[36:37],v12 offset:8192
ds_read_b64_tr_b16 a[164:165],v13 offset:8192
ds_read_b64_tr_b16 a[38:39],v12 offset:9216
ds_read_b64_tr_b16 a[166:167],v13 offset:9216
s_waitcnt lgkmcnt(4)
ds_read_b64_tr_b16 a[40:41],v12 offset:16384
ds_read_b64_tr_b16 a[168:169],v13 offset:16384
ds_read_b64_tr_b16 a[42:43],v12 offset:17408
ds_read_b64_tr_b16 a[170:171],v13 offset:17408
ds_read_b64_tr_b16 a[44:45],v12 offset:24576
ds_read_b64_tr_b16 a[172:173],v13 offset:24576
ds_read_b64_tr_b16 a[46:47],v12 offset:25600
ds_read_b64_tr_b16 a[174:175],v13 offset:25600
s_waitcnt lgkmcnt(4)
ds_read_b64_tr_b16 a[48:49],v12 offset:32768
ds_read_b64_tr_b16 a[176:177],v13 offset:32768
ds_read_b64_tr_b16 a[50:51],v12 offset:33792
ds_read_b64_tr_b16 a[178:179],v13 offset:33792
ds_read_b64_tr_b16 a[52:53],v12 offset:40960
ds_read_b64_tr_b16 a[180:181],v13 offset:40960
ds_read_b64_tr_b16 a[54:55],v12 offset:41984
ds_read_b64_tr_b16 a[182:183],v13 offset:41984
s_waitcnt lgkmcnt(4)
ds_read_b64_tr_b16 a[56:57],v12 offset:49152
ds_read_b64_tr_b16 a[184:185],v13 offset:49152
ds_read_b64_tr_b16 a[58:59],v12 offset:50176
ds_read_b64_tr_b16 a[186:187],v13 offset:50176
ds_read_b64_tr_b16 a[60:61],v12 offset:57344
ds_read_b64_tr_b16 a[188:189],v13 offset:57344
ds_read_b64_tr_b16 a[62:63],v12 offset:58368
ds_read_b64_tr_b16 a[190:191],v13 offset:58368
s_waitcnt lgkmcnt(4)
v_xor_b32 v12,0x10000,v12
v_xor_b32 v13,0x10000,v13
s_waitcnt lgkmcnt(0)
s_barrier
s_add_u32 s64,s74,1572864
s_add_u32 m0,s75,65536
s_nop 0
buffer_load_dwordx4 v8,s[32:35],s64 offen nt lds
s_add_u32 s64,s74,1581056
s_add_u32 m0,s75,66560
s_nop 0
buffer_load_dwordx4 v8,s[32:35],s64 offen nt lds
s_add_u32 s64,s74,1589248
s_add_u32 m0,s75,67584
s_nop 0
buffer_load_dwordx4 v9,s[32:35],s64 offen nt lds
s_add_u32 s64,s74,1597440
s_add_u32 m0,s75,68608
s_nop 0
buffer_load_dwordx4 v9,s[32:35],s64 offen nt lds
s_add_u32 s64,s74,1605632
s_add_u32 m0,s75,69632
s_nop 0
buffer_load_dwordx4 v8,s[32:35],s64 offen nt lds
s_add_u32 s64,s74,1613824
s_add_u32 m0,s75,70656
s_nop 0
buffer_load_dwordx4 v8,s[32:35],s64 offen nt lds
s_add_u32 s64,s74,1622016
s_add_u32 m0,s75,71680
s_nop 0
buffer_load_dwordx4 v9,s[32:35],s64 offen nt lds
s_add_u32 s64,s74,1630208
s_add_u32 m0,s75,72704
s_nop 0
buffer_load_dwordx4 v9,s[32:35],s64 offen nt lds
s_add_u32 s64,s74,1638400
s_add_u32 m0,s75,73728
s_nop 0
buffer_load_dwordx4 v8,s[32:35],s64 offen nt lds
s_add_u32 s64,s74,1646592
s_add_u32 m0,s75,74752
s_nop 0
buffer_load_dwordx4 v8,s[32:35],s64 offen nt lds
s_add_u32 s64,s74,1654784
s_add_u32 m0,s75,75776
s_nop 0
buffer_load_dwordx4 v9,s[32:35],s64 offen nt lds
s_add_u32 s64,s74,1662976
s_add_u32 m0,s75,76800
s_nop 0
buffer_load_dwordx4 v9,s[32:35],s64 offen nt lds
s_add_u32 s64,s74,1671168
s_add_u32 m0,s75,77824
s_nop 0
buffer_load_dwordx4 v8,s[32:35],s64 offen nt lds
s_add_u32 s64,s74,1679360
s_add_u32 m0,s75,78848
s_nop 0
buffer_load_dwordx4 v8,s[32:35],s64 offen nt lds
s_add_u32 s64,s74,1687552
s_add_u32 m0,s75,79872
s_nop 0
buffer_load_dwordx4 v9,s[32:35],s64 offen nt lds
s_add_u32 s64,s74,1695744
s_add_u32 m0,s75,80896
s_nop 0
buffer_load_dwordx4 v9,s[32:35],s64 offen nt lds
s_waitcnt vmcnt(16)
s_barrier
ds_read_b64_tr_b16 a[64:65],v12 offset:0
ds_read_b64_tr_b16 a[192:193],v13 offset:0
ds_read_b64_tr_b16 a[66:67],v12 offset:1024
ds_read_b64_tr_b16 a[194:195],v13 offset:1024
ds_read_b64_tr_b16 a[68:69],v12 offset:8192
ds_read_b64_tr_b16 a[196:197],v13 offset:8192
ds_read_b64_tr_b16 a[70:71],v12 offset:9216
ds_read_b64_tr_b16 a[198:199],v13 offset:9216
s_waitcnt lgkmcnt(4)
ds_read_b64_tr_b16 a[72:73],v12 offset:16384
ds_read_b64_tr_b16 a[200:201],v13 offset:16384
ds_read_b64_tr_b16 a[74:75],v12 offset:17408
ds_read_b64_tr_b16 a[202:203],v13 offset:17408
ds_read_b64_tr_b16 a[76:77],v12 offset:24576
ds_read_b64_tr_b16 a[204:205],v13 offset:24576
ds_read_b64_tr_b16 a[78:79],v12 offset:25600
ds_read_b64_tr_b16 a[206:207],v13 offset:25600
s_waitcnt lgkmcnt(4)
ds_read_b64_tr_b16 a[80:81],v12 offset:32768
ds_read_b64_tr_b16 a[208:209],v13 offset:32768
ds_read_b64_tr_b16 a[82:83],v12 offset:33792
ds_read_b64_tr_b16 a[210:211],v13 offset:33792
ds_read_b64_tr_b16 a[84:85],v12 offset:40960
ds_read_b64_tr_b16 a[212:213],v13 offset:40960
ds_read_b64_tr_b16 a[86:87],v12 offset:41984
ds_read_b64_tr_b16 a[214:215],v13 offset:41984
s_waitcnt lgkmcnt(4)
ds_read_b64_tr_b16 a[88:89],v12 offset:49152
ds_read_b64_tr_b16 a[216:217],v13 offset:49152
ds_read_b64_tr_b16 a[90:91],v12 offset:50176
ds_read_b64_tr_b16 a[218:219],v13 offset:50176
ds_read_b64_tr_b16 a[92:93],v12 offset:57344
ds_read_b64_tr_b16 a[220:221],v13 offset:57344
ds_read_b64_tr_b16 a[94:95],v12 offset:58368
ds_read_b64_tr_b16 a[222:223],v13 offset:58368
s_waitcnt lgkmcnt(4)
v_xor_b32 v12,0x10000,v12
v_xor_b32 v13,0x10000,v13
s_waitcnt lgkmcnt(0)
s_barrier
s_waitcnt vmcnt(0)
s_barrier
ds_read_b64_tr_b16 a[96:97],v12 offset:0
ds_read_b64_tr_b16 a[224:225],v13 offset:0
ds_read_b64_tr_b16 a[98:99],v12 offset:1024
ds_read_b64_tr_b16 a[226:227],v13 offset:1024
ds_read_b64_tr_b16 a[100:101],v12 offset:8192
ds_read_b64_tr_b16 a[228:229],v13 offset:8192
ds_read_b64_tr_b16 a[102:103],v12 offset:9216
ds_read_b64_tr_b16 a[230:231],v13 offset:9216
s_waitcnt lgkmcnt(4)
ds_read_b64_tr_b16 a[104:105],v12 offset:16384
ds_read_b64_tr_b16 a[232:233],v13 offset:16384
ds_read_b64_tr_b16 a[106:107],v12 offset:17408
ds_read_b64_tr_b16 a[234:235],v13 offset:17408
ds_read_b64_tr_b16 a[108:109],v12 offset:24576
ds_read_b64_tr_b16 a[236:237],v13 offset:24576
ds_read_b64_tr_b16 a[110:111],v12 offset:25600
ds_read_b64_tr_b16 a[238:239],v13 offset:25600
s_waitcnt lgkmcnt(4)
ds_read_b64_tr_b16 a[112:113],v12 offset:32768
ds_read_b64_tr_b16 a[240:241],v13 offset:32768
ds_read_b64_tr_b16 a[114:115],v12 offset:33792
ds_read_b64_tr_b16 a[242:243],v13 offset:33792
ds_read_b64_tr_b16 a[116:117],v12 offset:40960
ds_read_b64_tr_b16 a[244:245],v13 offset:40960
ds_read_b64_tr_b16 a[118:119],v12 offset:41984
ds_read_b64_tr_b16 a[246:247],v13 offset:41984
s_waitcnt lgkmcnt(4)
ds_read_b64_tr_b16 a[120:121],v12 offset:49152
ds_read_b64_tr_b16 a[248:249],v13 offset:49152
ds_read_b64_tr_b16 a[122:123],v12 offset:50176
ds_read_b64_tr_b16 a[250:251],v13 offset:50176
ds_read_b64_tr_b16 a[124:125],v12 offset:57344
ds_read_b64_tr_b16 a[252:253],v13 offset:57344
ds_read_b64_tr_b16 a[126:127],v12 offset:58368
ds_read_b64_tr_b16 a[254:255],v13 offset:58368
s_waitcnt lgkmcnt(4)
v_xor_b32 v12,0x10000,v12
v_xor_b32 v13,0x10000,v13
s_waitcnt lgkmcnt(0)
s_barrier
v_and_b32 v21,1,v1
v_mul_u32_u24 v21,960,v21
s_mov_b32 s65,21052032
s_mov_b32 s66,1792
pl_220:
buffer_load_dword v22,v21,s[20:23],s65 offen sc1
s_waitcnt vmcnt(0)
v_cmp_gt_u32 vcc,s66,v22
s_cbranch_vccz pok_221
s_sleep 1
s_sub_u32 s90,s90,1
s_cmp_gt_i32 s90,0
s_cbranch_scc1 pl_220
pok_221:
s_mov_b32 s81,0xbdd2d3e8
v_mov_b32 v28,0xc0135761
v_mov_b32 v17,v16
v_and_b32 v21,31,v1
v_lshlrev_b32 v21,2,v21
s_mul_i32 s74,s79,40
s_add_u32 s74,s74,s63
s_add_u32 s74,s74,2560
s_lshl_b32 s42,s41,2
s_add_u32 s42,s42,s50
s_lshl_b32 s73,s41,4
s_lshl_b32 s64,s50,2
s_add_u32 s73,s73,s64
s_add_u32 s73,s73,s63
s_add_u32 s73,s73,3072
s_add_u32 s73,s73,s60
s_lshl_b32 s43,s50,11
s_lshl_b32 s78,s79,21
s_add_u32 s78,s78,29360128
s_mov_b32 s64,0
s_lshr_b32 s65,s50,1
s_and_b32 s66,s50,1
s_lshl_b32 s72,s65,13
s_lshl_b32 s64,s66,11
s_add_u32 s72,s72,s64
s_add_u32 s72,s72,0x10000
s_lshl_b32 s75,s66,15
s_lshl_b32 s64,s65,7
s_add_u32 s75,s75,s64
s_add_u32 s75,s75,1835008
s_lshl_b32 s64,s66,2
v_add_u32 v5,s64,v4
v_and_b32 v6,7,v1
v_xor_b32 v5,v5,v6
v_lshlrev_b32 v5,4,v5
v_bfe_u32 v6,v1,3,2
v_lshl_add_u32 v5,v6,11,v5
v_lshrrev_b32 v6,5,v1
v_lshl_add_u32 v42,v6,14,v5
v_lshrrev_b32 v5,1,v3
v_xor_b32 v5,v5,v4
v_lshlrev_b32 v5,4,v5
v_and_b32 v6,7,v3
v_lshl_add_u32 v5,v6,7,v5
v_lshrrev_b32 v6,3,v3
v_lshl_add_u32 v17,v6,11,v5
v_xor_b32 v43,64,v17
s_lshr_b32 s64,s41,1
s_lshl_b32 s64,s64,2
s_lshr_b32 s64,0x0413,s64
s_and_b32 s64,s64,7
s_add_u32 s65,s41,120
s_lshl_b32 s65,s65,14
s_add_u32 s65,s65,s43
v_lshl_add_u32 v7,v4,8,s65
v_mov_b32 v9,2105344
v_add_u32 v6,s64,v3
v_and_b32 v5,15,v6
v_lshl_add_u32 v5,v5,4,v7
v_bfe_u32 v8,v6,4,1
v_lshl_add_u32 v5,v8,10,v5
v_cmp_lt_u32 vcc,31,v6
s_nop 1
v_cndmask_b32 v8,0,v9,vcc
v_add_u32 v5,v5,v8
v_xor_b32 v18,s62,v5
s_add_u32 s64,s64,16
v_add_u32 v6,s64,v3
v_and_b32 v5,15,v6
v_lshl_add_u32 v5,v5,4,v7
v_bfe_u32 v8,v6,4,1
v_lshl_add_u32 v5,v8,10,v5
v_cmp_lt_u32 vcc,31,v6
s_nop 1
v_cndmask_b32 v8,0,v9,vcc
v_add_u32 v5,v5,v8
v_xor_b32 v19,s62,v5
s_add_u32 s64,s64,16
s_mov_b64 s[84:85],vcc
v_mov_b32 v88,1
v_mov_b32 v89,0
v_mov_b32 v90,0
v_mov_b32 v91,0
v_xor_b32 v5,0x2000,v19
s_mov_b32 s64,163577856
buffer_store_dwordx4 v[88:91],v18,s[20:23],s64 offen sc1
s_andn2_b64 exec,exec,s[84:85]
buffer_store_dwordx4 v[88:91],v19,s[20:23],s64 offen sc1
s_mov_b64 exec,-1
v_mov_b32 v6,0x7fff0000
v_cndmask_b32 v5,v6,v5,s[84:85]
s_mov_b32 s64,27262976
buffer_store_dwordx4 v[88:91],v5,s[20:23],s64 offen sc1
s_waitcnt vmcnt(0)
s_add_u32 s64,s79,0
s_lshl_b32 s70,s64,21
s_lshl_b32 s64,s64,13
s_and_b32 s64,s64,0x2000
s_xor_b32 s64,s64,s62
s_add_u32 s70,s70,s64
s_add_u32 s70,s70,29360128
s_mov_b32 s83,1
s_mov_b32 s87,s74
s_cmp_eq_u32 s50,0
s_cselect_b32 s74,s74,0x7fff0000
v_mov_b32 v47,132096
s_lshl_b32 s64,s50,3
s_add_u32 s64,s64,132096
v_mov_b32 v46,s64
v_mov_b32 v29,0
s_mov_b32 s97,0x7fff0000
s_mov_b32 s69,1
s_mov_b32 s68,0
s_mov_b32 s52,0x30003
s_mov_b32 s53,s52
seg_223:
s_cmp_eq_u32 s83,0
s_cbranch_scc1 ahead_224
s_add_u32 s94,s70,s75
s_add_u32 s95,s94,65536
s_xor_b32 s91,s72,0x10000
s_waitcnt vmcnt(3)
v_cmp_gt_u32 vcc,s71,v29
s_cbranch_vccz nb_227
s_waitcnt vmcnt(0)
v_add_u32 v22,s71,-1
buffer_store_dword v22,v23,s[24:27],s97 offen
buffer_store_dword v22,v23,s[28:31],s97 offen sc1
s_mov_b32 s97,0x7fff0000
s_cmp_lg_u32 s50,0
s_cbranch_scc1 nb_227
buffer_load_dword v32,v21,s[20:23],s74 offen sc1
s_sleep 2
pl_229:
buffer_load_dword v33,v21,s[20:23],s74 offen sc1
s_waitcnt vmcnt(1)
v_cmp_gt_u32 vcc,s71,v32
v_mov_b32 v29,v32
s_cbranch_vccz pok_230
buffer_load_dword v32,v21,s[20:23],s74 offen sc1
s_waitcnt vmcnt(1)
v_cmp_gt_u32 vcc,s71,v33
v_mov_b32 v29,v33
s_cbranch_vccz pok_230
s_sub_u32 s90,s90,1
s_cmp_gt_i32 s90,0
s_cbranch_scc1 pl_229
pok_230:
nb_227:
s_barrier
s_xor_b32 m0,s91,0
s_add_u32 s65,s94,0
buffer_load_dwordx4 v42,s[20:23],s65 offen offset:0 sc1 lds
buffer_load_dwordx4 v42,s[20:23],s65 offen offset:1024 sc1 lds
s_xor_b32 m0,s91,16384
s_add_u32 s65,s94,256
buffer_load_dwordx4 v42,s[20:23],s65 offen offset:0 sc1 lds
buffer_load_dwordx4 v42,s[20:23],s65 offen offset:1024 sc1 lds
s_xor_b32 m0,s91,32768
s_add_u32 s65,s94,512
buffer_load_dwordx4 v42,s[20:23],s65 offen offset:0 sc1 lds
buffer_load_dwordx4 v42,s[20:23],s65 offen offset:1024 sc1 lds
s_xor_b32 m0,s91,49152
s_add_u32 s65,s94,768
buffer_load_dwordx4 v42,s[20:23],s65 offen offset:0 sc1 lds
buffer_load_dwordx4 v42,s[20:23],s65 offen offset:1024 sc1 lds
s_waitcnt vmcnt(8)
v_add_u32 v22,s71,-1
buffer_store_dword v22,v23,s[24:27],s97 offen
buffer_store_dword v22,v23,s[28:31],s97 offen sc1
s_mov_b32 s97,0x7fff0000
s_waitcnt vmcnt(8)
s_barrier
ds_read_b128 v[224:227],v17 offset:0
ds_read_b128 v[228:231],v43 offset:0
ds_read_b128 v[232:235],v17 offset:8192
ds_read_b128 v[236:239],v43 offset:8192
ds_read_b128 v[240:243],v17 offset:1024
ds_read_b128 v[244:247],v43 offset:1024
ds_read_b128 v[248:251],v17 offset:9216
s_waitcnt lgkmcnt(5)
v_mfma_f32_16x16x32_bf16 v[64:67],a[0:3],v[224:227],0
s_xor_b32 m0,s91,4096
s_add_u32 s96,s71,1
v_mfma_f32_16x16x32_bf16 v[72:75],a[128:131],v[224:227],0
ds_read_b128 v[252:255],v43 offset:9216
s_add_u32 s92,s71,2
v_mfma_f32_16x16x32_bf16 v[64:67],a[4:7],v[228:231],v[64:67]
s_add_u32 s65,s95,0
v_min_u32 v27,v224,v228
v_mfma_f32_16x16x32_bf16 v[72:75],a[132:135],v[228:231],v[72:75]
s_waitcnt vmcnt(6)
s_barrier
ds_read_b128 v[224:227],v17 offset:16384
s_waitcnt lgkmcnt(5)
v_mfma_f32_16x16x32_bf16 v[64:67],a[8:11],v[232:235],v[64:67]
buffer_load_dwordx4 v42,s[20:23],s65 offen offset:0 sc1 lds
v_mfma_f32_16x16x32_bf16 v[72:75],a[136:139],v[232:235],v[72:75]
ds_read_b128 v[228:231],v43 offset:16384
v_min3_u32 v27,v27,v232,v236
v_mfma_f32_16x16x32_bf16 v[64:67],a[12:15],v[236:239],v[64:67]
buffer_load_dwordx4 v42,s[20:23],s65 offen offset:1024 sc1 lds
v_mfma_f32_16x16x32_bf16 v[72:75],a[140:143],v[236:239],v[72:75]
ds_read_b128 v[232:235],v17 offset:24576
s_waitcnt lgkmcnt(5)
v_mfma_f32_16x16x32_bf16 v[64:67],a[64:67],v[240:243],v[64:67]
s_xor_b32 m0,s91,20480
v_min3_u32 v27,v27,v240,v244
v_mfma_f32_16x16x32_bf16 v[72:75],a[192:195],v[240:243],v[72:75]
ds_read_b128 v[236:239],v43 offset:24576
v_mfma_f32_16x16x32_bf16 v[64:67],a[68:71],v[244:247],v[64:67]
s_add_u32 s65,s95,256
v_mfma_f32_16x16x32_bf16 v[72:75],a[196:199],v[244:247],v[72:75]
ds_read_b128 v[240:243],v17 offset:17408
s_waitcnt lgkmcnt(5)
v_mfma_f32_16x16x32_bf16 v[64:67],a[72:75],v[248:251],v[64:67]
buffer_load_dwordx4 v42,s[20:23],s65 offen offset:0 sc1 lds
v_mfma_f32_16x16x32_bf16 v[72:75],a[200:203],v[248:251],v[72:75]
ds_read_b128 v[244:247],v43 offset:17408
v_min3_u32 v27,v27,v248,v252
v_mfma_f32_16x16x32_bf16 v[64:67],a[76:79],v[252:255],v[64:67]
buffer_load_dwordx4 v42,s[20:23],s65 offen offset:1024 sc1 lds
v_mfma_f32_16x16x32_bf16 v[72:75],a[204:207],v[252:255],v[72:75]
ds_read_b128 v[248:251],v17 offset:25600
s_waitcnt lgkmcnt(5)
v_mfma_f32_16x16x32_bf16 v[64:67],a[16:19],v[224:227],v[64:67]
s_xor_b32 m0,s91,36864
v_min3_u32 v27,v27,v224,v228
v_mfma_f32_16x16x32_bf16 v[72:75],a[144:147],v[224:227],v[72:75]
ds_read_b128 v[252:255],v43 offset:25600
v_mfma_f32_16x16x32_bf16 v[64:67],a[20:23],v[228:231],v[64:67]
s_add_u32 s65,s95,512
v_mfma_f32_16x16x32_bf16 v[72:75],a[148:151],v[228:231],v[72:75]
s_waitcnt vmcnt(6)
s_barrier
ds_read_b128 v[224:227],v17 offset:32768
s_waitcnt lgkmcnt(5)
v_mfma_f32_16x16x32_bf16 v[64:67],a[24:27],v[232:235],v[64:67]
buffer_load_dwordx4 v42,s[20:23],s65 offen offset:0 sc1 lds
v_mfma_f32_16x16x32_bf16 v[72:75],a[152:155],v[232:235],v[72:75]
ds_read_b128 v[228:231],v43 offset:32768
v_min3_u32 v27,v27,v232,v236
v_mfma_f32_16x16x32_bf16 v[64:67],a[28:31],v[236:239],v[64:67]
buffer_load_dwordx4 v42,s[20:23],s65 offen offset:1024 sc1 lds
v_mfma_f32_16x16x32_bf16 v[72:75],a[156:159],v[236:239],v[72:75]
ds_read_b128 v[232:235],v17 offset:40960
s_waitcnt lgkmcnt(5)
v_mfma_f32_16x16x32_bf16 v[64:67],a[80:83],v[240:243],v[64:67]
s_xor_b32 m0,s91,53248
v_min3_u32 v27,v27,v240,v244
v_mfma_f32_16x16x32_bf16 v[72:75],a[208:211],v[240:243],v[72:75]
ds_read_b128 v[236:239],v43 offset:40960
v_mfma_f32_16x16x32_bf16 v[64:67],a[84:87],v[244:247],v[64:67]
s_add_u32 s65,s95,768
v_mfma_f32_16x16x32_bf16 v[72:75],a[212:215],v[244:247],v[72:75]
ds_read_b128 v[240:243],v17 offset:33792
s_waitcnt lgkmcnt(5)
v_mfma_f32_16x16x32_bf16 v[64:67],a[88:91],v[248:251],v[64:67]
buffer_load_dwordx4 v42,s[20:23],s65 offen offset:0 sc1 lds
v_min3_u32 v27,v27,v248,v252
v_mfma_f32_16x16x32_bf16 v[72:75],a[216:219],v[248:251],v[72:75]
ds_read_b128 v[244:247],v43 offset:33792
s_waitcnt vmcnt(63)
v_mfma_f32_16x16x32_bf16 v[64:67],a[92:95],v[252:255],v[64:67]
buffer_load_dwordx4 v42,s[20:23],s65 offen offset:1024 sc1 lds
v_mfma_f32_16x16x32_bf16 v[72:75],a[220:223],v[252:255],v[72:75]
ds_read_b128 v[248:251],v17 offset:41984
s_waitcnt lgkmcnt(5)
v_mfma_f32_16x16x32_bf16 v[64:67],a[32:35],v[224:227],v[64:67]
v_cmp_gt_u32 vcc,s96,v29
v_cmp_gt_u32 s[92:93],s92,v29
v_mfma_f32_16x16x32_bf16 v[72:75],a[160:163],v[224:227],v[72:75]
ds_read_b128 v[252:255],v43 offset:41984
v_min3_u32 v27,v27,v224,v228
v_mfma_f32_16x16x32_bf16 v[64:67],a[36:39],v[228:231],v[64:67]
v_mov_b32 v44,vcc_lo
v_mov_b32 v45,s92
v_mfma_f32_16x16x32_bf16 v[72:75],a[164:167],v[228:231],v[72:75]
ds_read_b128 v[224:227],v17 offset:49152
s_waitcnt lgkmcnt(5)
v_mfma_f32_16x16x32_bf16 v[64:67],a[40:43],v[232:235],v[64:67]
ds_write_b64 v46,v[44:45]
v_min3_u32 v27,v27,v232,v236
v_mfma_f32_16x16x32_bf16 v[72:75],a[168:171],v[232:235],v[72:75]
ds_read_b128 v[228:231],v43 offset:49152
v_mfma_f32_16x16x32_bf16 v[64:67],a[44:47],v[236:239],v[64:67]
v_mfma_f32_16x16x32_bf16 v[72:75],a[172:175],v[236:239],v[72:75]
ds_read_b128 v[232:235],v17 offset:57344
s_waitcnt lgkmcnt(6)
v_mfma_f32_16x16x32_bf16 v[64:67],a[96:99],v[240:243],v[64:67]
v_min3_u32 v27,v27,v240,v244
s_add_u32 s88,s70,s75
v_mfma_f32_16x16x32_bf16 v[72:75],a[224:227],v[240:243],v[72:75]
ds_read_b128 v[236:239],v43 offset:57344
s_add_u32 s88,s88,2097152
v_mfma_f32_16x16x32_bf16 v[64:67],a[100:103],v[244:247],v[64:67]
s_xor_b32 s88,s88,0x2000
s_add_u32 s89,s88,65536
v_mfma_f32_16x16x32_bf16 v[72:75],a[228:231],v[244:247],v[72:75]
ds_read_b128 v[240:243],v17 offset:50176
s_waitcnt lgkmcnt(6)
v_mfma_f32_16x16x32_bf16 v[64:67],a[104:107],v[248:251],v[64:67]
v_min3_u32 v27,v27,v248,v252
v_mfma_f32_16x16x32_bf16 v[72:75],a[232:235],v[248:251],v[72:75]
ds_read_b128 v[244:247],v43 offset:50176
v_mfma_f32_16x16x32_bf16 v[64:67],a[108:111],v[252:255],v[64:67]
v_mfma_f32_16x16x32_bf16 v[72:75],a[236:239],v[252:255],v[72:75]
ds_read_b128 v[248:251],v17 offset:58368
s_waitcnt lgkmcnt(5)
v_mfma_f32_16x16x32_bf16 v[64:67],a[48:51],v[224:227],v[64:67]
v_min3_u32 v27,v27,v224,v228
v_mfma_f32_16x16x32_bf16 v[72:75],a[176:179],v[224:227],v[72:75]
ds_read_b128 v[252:255],v43 offset:58368
v_mfma_f32_16x16x32_bf16 v[64:67],a[52:55],v[228:231],v[64:67]
v_mfma_f32_16x16x32_bf16 v[72:75],a[180:183],v[228:231],v[72:75]
s_waitcnt vmcnt(4)
s_barrier
ds_read_b64 v[44:45],v47
ds_read_b128 v[224:227],v17 offset:4096
s_waitcnt lgkmcnt(6)
v_mfma_f32_16x16x32_bf16 v[64:67],a[56:59],v[232:235],v[64:67]
v_min3_u32 v27,v27,v232,v236
v_mfma_f32_16x16x32_bf16 v[72:75],a[184:187],v[232:235],v[72:75]
ds_read_b128 v[228:231],v43 offset:4096
v_mfma_f32_16x16x32_bf16 v[64:67],a[60:63],v[236:239],v[64:67]
v_mfma_f32_16x16x32_bf16 v[72:75],a[188:191],v[236:239],v[72:75]
ds_read_b128 v[232:235],v17 offset:12288
s_waitcnt lgkmcnt(6)
v_mfma_f32_16x16x32_bf16 v[64:67],a[112:115],v[240:243],v[64:67]
v_min3_u32 v27,v27,v240,v244
v_mfma_f32_16x16x32_bf16 v[72:75],a[240:243],v[240:243],v[72:75]
ds_read_b128 v[236:239],v43 offset:12288
v_mfma_f32_16x16x32_bf16 v[64:67],a[116:119],v[244:247],v[64:67]
v_mfma_f32_16x16x32_bf16 v[72:75],a[244:247],v[244:247],v[72:75]
ds_read_b128 v[240:243],v17 offset:5120
s_waitcnt lgkmcnt(6)
v_mfma_f32_16x16x32_bf16 v[64:67],a[120:123],v[248:251],v[64:67]
s_waitcnt lgkmcnt(5)
v_readfirstlane_b32 s93,v45
v_mfma_f32_16x16x32_bf16 v[72:75],a[248:251],v[248:251],v[72:75]
ds_read_b128 v[244:247],v43 offset:5120
v_readfirstlane_b32 s83,v44
s_cmp_lg_u32 s83,0
s_cbranch_scc0 keep_233
v_mfma_f32_16x16x32_bf16 v[64:67],a[124:127],v[252:255],v[64:67]
v_min3_u32 v27,v27,v248,v252
v_mfma_f32_16x16x32_bf16 v[72:75],a[252:255],v[252:255],v[72:75]
ds_read_b128 v[248:251],v17 offset:13312
s_waitcnt lgkmcnt(5)
v_mfma_f32_16x16x32_bf16 v[68:71],a[0:3],v[224:227],0
v_cmp_eq_u32 vcc,0,v27
s_cbranch_vccnz retry_222
v_mfma_f32_16x16x32_bf16 v[76:79],a[128:131],v[224:227],0
ds_read_b128 v[252:255],v43 offset:13312
v_min3_u32 v27,v27,v224,v228
v_mfma_f32_16x16x32_bf16 v[68:71],a[4:7],v[228:231],v[68:71]
v_mfma_f32_16x16x32_bf16 v[76:79],a[132:135],v[228:231],v[76:79]
ds_read_b128 v[224:227],v17 offset:20480
s_waitcnt lgkmcnt(5)
v_mfma_f32_16x16x32_bf16 v[68:71],a[8:11],v[232:235],v[68:71]
v_min3_u32 v27,v27,v232,v236
v_mul_f32 v88,v64,v64
v_mul_f32 v92,v72,v72
v_mfma_f32_16x16x32_bf16 v[76:79],a[136:139],v[232:235],v[76:79]
ds_read_b128 v[228:231],v43 offset:20480
v_mul_f32 v89,v65,v65
v_mul_f32 v93,v73,v73
v_mfma_f32_16x16x32_bf16 v[68:71],a[12:15],v[236:239],v[68:71]
v_mul_f32 v90,v66,v66
v_mul_f32 v91,v67,v67
v_mul_f32 v94,v74,v74
v_mfma_f32_16x16x32_bf16 v[76:79],a[140:143],v[236:239],v[76:79]
ds_read_b128 v[232:235],v17 offset:28672
v_mul_f32 v95,v75,v75
s_waitcnt lgkmcnt(5)
v_mfma_f32_16x16x32_bf16 v[68:71],a[64:67],v[240:243],v[68:71]
v_min3_u32 v27,v27,v240,v244
v_fma_f32 v88,v88,s81,v28
v_fma_f32 v92,v92,s81,v28
v_mfma_f32_16x16x32_bf16 v[76:79],a[192:195],v[240:243],v[76:79]
ds_read_b128 v[236:239],v43 offset:28672
v_fma_f32 v89,v89,s81,v28
v_fma_f32 v93,v93,s81,v28
v_mfma_f32_16x16x32_bf16 v[68:71],a[68:71],v[244:247],v[68:71]
v_fma_f32 v90,v90,s81,v28
v_fma_f32 v91,v91,s81,v28
v_fma_f32 v94,v94,s81,v28
v_mfma_f32_16x16x32_bf16 v[76:79],a[196:199],v[244:247],v[76:79]
ds_read_b128 v[240:243],v17 offset:21504
v_fma_f32 v95,v95,s81,v28
s_waitcnt lgkmcnt(5)
v_mfma_f32_16x16x32_bf16 v[68:71],a[72:75],v[248:251],v[68:71]
v_min3_u32 v27,v27,v248,v252
v_mul_f32 v88,v88,v64
v_mul_f32 v92,v92,v72
v_mfma_f32_16x16x32_bf16 v[76:79],a[200:203],v[248:251],v[76:79]
ds_read_b128 v[244:247],v43 offset:21504
v_mul_f32 v89,v89,v65
v_mul_f32 v93,v93,v73
v_mfma_f32_16x16x32_bf16 v[68:71],a[76:79],v[252:255],v[68:71]
v_mul_f32 v90,v90,v66
v_mul_f32 v91,v91,v67
v_mul_f32 v94,v94,v74
v_mfma_f32_16x16x32_bf16 v[76:79],a[204:207],v[252:255],v[76:79]
ds_read_b128 v[248:251],v17 offset:29696
v_mul_f32 v95,v95,v75
s_waitcnt lgkmcnt(5)
v_mfma_f32_16x16x32_bf16 v[68:71],a[16:19],v[224:227],v[68:71]
v_min3_u32 v27,v27,v224,v228
v_exp_f32 v92,v92
v_mfma_f32_16x16x32_bf16 v[76:79],a[144:147],v[224:227],v[76:79]
ds_read_b128 v[252:255],v43 offset:29696
v_exp_f32 v93,v93
v_mfma_f32_16x16x32_bf16 v[68:71],a[20:23],v[228:231],v[68:71]
v_exp_f32 v88,v88
v_mfma_f32_16x16x32_bf16 v[76:79],a[148:151],v[228:231],v[76:79]
s_waitcnt vmcnt(0)
s_barrier
ds_read_b128 v[224:227],v17 offset:36864
s_waitcnt lgkmcnt(5)
v_mfma_f32_16x16x32_bf16 v[68:71],a[24:27],v[232:235],v[68:71]
v_min3_u32 v27,v27,v232,v236
v_exp_f32 v94,v94
v_mfma_f32_16x16x32_bf16 v[76:79],a[152:155],v[232:235],v[76:79]
ds_read_b128 v[228:231],v43 offset:36864
v_exp_f32 v95,v95
v_mfma_f32_16x16x32_bf16 v[68:71],a[28:31],v[236:239],v[68:71]
v_exp_f32 v89,v89
v_add_f32 v92,1.0,v92
v_mfma_f32_16x16x32_bf16 v[76:79],a[156:159],v[236:239],v[76:79]
ds_read_b128 v[232:235],v17 offset:45056
v_add_f32 v93,1.0,v93
s_waitcnt lgkmcnt(5)
v_mfma_f32_16x16x32_bf16 v[68:71],a[80:83],v[240:243],v[68:71]
v_min3_u32 v27,v27,v240,v244
v_add_f32 v94,1.0,v94
v_add_f32 v95,1.0,v95
v_mfma_f32_16x16x32_bf16 v[76:79],a[208:211],v[240:243],v[76:79]
ds_read_b128 v[236:239],v43 offset:45056
v_rcp_f32 v92,v92
v_mfma_f32_16x16x32_bf16 v[68:71],a[84:87],v[244:247],v[68:71]
v_exp_f32 v90,v90
v_mfma_f32_16x16x32_bf16 v[76:79],a[212:215],v[244:247],v[76:79]
ds_read_b128 v[240:243],v17 offset:37888
s_waitcnt lgkmcnt(5)
v_mfma_f32_16x16x32_bf16 v[68:71],a[88:91],v[248:251],v[68:71]
v_min3_u32 v27,v27,v248,v252
v_rcp_f32 v93,v93
v_mfma_f32_16x16x32_bf16 v[76:79],a[216:219],v[248:251],v[76:79]
ds_read_b128 v[244:247],v43 offset:37888
v_rcp_f32 v94,v94
v_mfma_f32_16x16x32_bf16 v[68:71],a[92:95],v[252:255],v[68:71]
v_exp_f32 v91,v91
v_mfma_f32_16x16x32_bf16 v[76:79],a[220:223],v[252:255],v[76:79]
ds_read_b128 v[248:251],v17 offset:46080
s_waitcnt lgkmcnt(5)
v_mfma_f32_16x16x32_bf16 v[68:71],a[32:35],v[224:227],v[68:71]
v_min3_u32 v27,v27,v224,v228
v_add_f32 v88,1.0,v88
v_mfma_f32_16x16x32_bf16 v[76:79],a[160:163],v[224:227],v[76:79]
ds_read_b128 v[252:255],v43 offset:46080
v_add_f32 v89,1.0,v89
v_mfma_f32_16x16x32_bf16 v[68:71],a[36:39],v[228:231],v[68:71]
v_add_f32 v90,1.0,v90
v_add_f32 v91,1.0,v91
v_mfma_f32_16x16x32_bf16 v[76:79],a[164:167],v[228:231],v[76:79]
ds_read_b128 v[224:227],v17 offset:53248
s_waitcnt lgkmcnt(5)
v_mfma_f32_16x16x32_bf16 v[68:71],a[40:43],v[232:235],v[68:71]
v_min3_u32 v27,v27,v232,v236
v_mfma_f32_16x16x32_bf16 v[76:79],a[168:171],v[232:235],v[76:79]
ds_read_b128 v[228:231],v43 offset:53248
v_mfma_f32_16x16x32_bf16 v[68:71],a[44:47],v[236:239],v[68:71]
v_rcp_f32 v88,v88
v_mfma_f32_16x16x32_bf16 v[76:79],a[172:175],v[236:239],v[76:79]
ds_read_b128 v[232:235],v17 offset:61440
s_waitcnt lgkmcnt(5)
v_mfma_f32_16x16x32_bf16 v[68:71],a[96:99],v[240:243],v[68:71]
v_min3_u32 v27,v27,v240,v244
v_mfma_f32_16x16x32_bf16 v[76:79],a[224:227],v[240:243],v[76:79]
ds_read_b128 v[236:239],v43 offset:61440
v_mfma_f32_16x16x32_bf16 v[68:71],a[100:103],v[244:247],v[68:71]
v_rcp_f32 v89,v89
v_mfma_f32_16x16x32_bf16 v[76:79],a[228:231],v[244:247],v[76:79]
ds_read_b128 v[240:243],v17 offset:54272
s_waitcnt lgkmcnt(5)
v_mfma_f32_16x16x32_bf16 v[68:71],a[104:107],v[248:251],v[68:71]
v_min3_u32 v27,v27,v248,v252
v_mfma_f32_16x16x32_bf16 v[76:79],a[232:235],v[248:251],v[76:79]
ds_read_b128 v[244:247],v43 offset:54272
v_mfma_f32_16x16x32_bf16 v[68:71],a[108:111],v[252:255],v[68:71]
v_rcp_f32 v90,v90
v_mfma_f32_16x16x32_bf16 v[76:79],a[236:239],v[252:255],v[76:79]
ds_read_b128 v[248:251],v17 offset:62464
s_waitcnt lgkmcnt(5)
v_mfma_f32_16x16x32_bf16 v[68:71],a[48:51],v[224:227],v[68:71]
v_min3_u32 v27,v27,v224,v228
v_mfma_f32_16x16x32_bf16 v[76:79],a[176:179],v[224:227],v[76:79]
ds_read_b128 v[252:255],v43 offset:62464
v_mfma_f32_16x16x32_bf16 v[68:71],a[52:55],v[228:231],v[68:71]
v_rcp_f32 v91,v91
v_mfma_f32_16x16x32_bf16 v[76:79],a[180:183],v[228:231],v[76:79]
v_mul_f32 v88,v88,v64
s_waitcnt lgkmcnt(4)
v_mfma_f32_16x16x32_bf16 v[68:71],a[56:59],v[232:235],v[68:71]
v_min3_u32 v27,v27,v232,v236
v_mul_f32 v89,v89,v65
v_mfma_f32_16x16x32_bf16 v[76:79],a[184:187],v[232:235],v[76:79]
v_mul_f32 v90,v90,v66
v_mul_f32 v91,v91,v67
v_mfma_f32_16x16x32_bf16 v[68:71],a[60:63],v[236:239],v[68:71]
v_rcp_f32 v95,v95
v_mfma_f32_16x16x32_bf16 v[76:79],a[188:191],v[236:239],v[76:79]
v_mul_f32 v92,v92,v72
s_waitcnt lgkmcnt(2)
v_mfma_f32_16x16x32_bf16 v[68:71],a[112:115],v[240:243],v[68:71]
v_min3_u32 v27,v27,v240,v244
v_mul_f32 v93,v93,v73
v_mfma_f32_16x16x32_bf16 v[76:79],a[240:243],v[240:243],v[76:79]
v_mul_f32 v94,v94,v74
v_mul_f32 v95,v95,v75
v_mfma_f32_16x16x32_bf16 v[68:71],a[116:119],v[244:247],v[68:71]
v_cvt_pk_bf16_f32 v96,v88,v89
v_cvt_pk_bf16_f32 v97,v90,v91
v_mfma_f32_16x16x32_bf16 v[76:79],a[244:247],v[244:247],v[76:79]
v_cvt_pk_bf16_f32 v98,v92,v93
s_waitcnt lgkmcnt(0)
v_mfma_f32_16x16x32_bf16 v[68:71],a[120:123],v[248:251],v[68:71]
v_min3_u32 v27,v27,v248,v252
v_cvt_pk_bf16_f32 v99,v94,v95
v_mfma_f32_16x16x32_bf16 v[76:79],a[248:251],v[248:251],v[76:79]
v_max_u32 v96,1,v96
v_mfma_f32_16x16x32_bf16 v[68:71],a[124:127],v[252:255],v[68:71]
buffer_store_dwordx4 v[96:99],v18,s[20:23],s78 offen sc1
v_mfma_f32_16x16x32_bf16 v[76:79],a[252:255],v[252:255],v[76:79]
v_cmp_eq_u32 vcc,0,v27
s_cbranch_vccnz retry_222
s_branch epi_225
keep_233:
v_mfma_f32_16x16x32_bf16 v[64:67],a[124:127],v[252:255],v[64:67]
v_min3_u32 v27,v27,v248,v252
s_xor_b32 m0,s72,0
v_mfma_f32_16x16x32_bf16 v[72:75],a[252:255],v[252:255],v[72:75]
ds_read_b128 v[248:251],v17 offset:13312
s_add_u32 s65,s88,0
s_waitcnt lgkmcnt(5)
v_mfma_f32_16x16x32_bf16 v[68:71],a[0:3],v[224:227],0
buffer_load_dwordx4 v42,s[20:23],s65 offen offset:0 sc1 lds
v_min3_u32 v27,v27,v224,v228
v_mfma_f32_16x16x32_bf16 v[76:79],a[128:131],v[224:227],0
ds_read_b128 v[252:255],v43 offset:13312
buffer_load_dwordx4 v42,s[20:23],s65 offen offset:1024 sc1 lds
v_mfma_f32_16x16x32_bf16 v[68:71],a[4:7],v[228:231],v[68:71]
v_cmp_eq_u32 vcc,0,v27
s_cbranch_vccnz retry_222
v_mfma_f32_16x16x32_bf16 v[76:79],a[132:135],v[228:231],v[76:79]
ds_read_b128 v[224:227],v17 offset:20480
s_xor_b32 m0,s72,16384
s_waitcnt lgkmcnt(5)
v_mfma_f32_16x16x32_bf16 v[68:71],a[8:11],v[232:235],v[68:71]
s_add_u32 s65,s88,256
v_min3_u32 v27,v27,v232,v236
v_mul_f32 v88,v64,v64
v_mul_f32 v92,v72,v72
v_mfma_f32_16x16x32_bf16 v[76:79],a[136:139],v[232:235],v[76:79]
ds_read_b128 v[228:231],v43 offset:20480
buffer_load_dwordx4 v42,s[20:23],s65 offen offset:0 sc1 lds
v_mul_f32 v93,v73,v73
v_mfma_f32_16x16x32_bf16 v[68:71],a[12:15],v[236:239],v[68:71]
v_mul_f32 v89,v65,v65
v_mul_f32 v90,v66,v66
v_mul_f32 v91,v67,v67
v_mul_f32 v94,v74,v74
v_mfma_f32_16x16x32_bf16 v[76:79],a[140:143],v[236:239],v[76:79]
ds_read_b128 v[232:235],v17 offset:28672
v_fma_f32 v88,v88,s81,v28
v_mul_f32 v95,v75,v75
s_waitcnt lgkmcnt(5)
v_mfma_f32_16x16x32_bf16 v[68:71],a[64:67],v[240:243],v[68:71]
buffer_load_dwordx4 v42,s[20:23],s65 offen offset:1024 sc1 lds
s_xor_b32 m0,s72,32768
v_fma_f32 v92,v92,s81,v28
v_mfma_f32_16x16x32_bf16 v[76:79],a[192:195],v[240:243],v[76:79]
ds_read_b128 v[236:239],v43 offset:28672
s_add_u32 s65,s88,512
v_fma_f32 v89,v89,s81,v28
v_fma_f32 v93,v93,s81,v28
v_mfma_f32_16x16x32_bf16 v[68:71],a[68:71],v[244:247],v[68:71]
v_min3_u32 v27,v27,v240,v244
v_fma_f32 v90,v90,s81,v28
v_fma_f32 v91,v91,s81,v28
v_fma_f32 v94,v94,s81,v28
v_mfma_f32_16x16x32_bf16 v[76:79],a[196:199],v[244:247],v[76:79]
ds_read_b128 v[240:243],v17 offset:21504
v_mul_f32 v88,v88,v64
v_fma_f32 v95,v95,s81,v28
s_waitcnt lgkmcnt(5)
v_mfma_f32_16x16x32_bf16 v[68:71],a[72:75],v[248:251],v[68:71]
buffer_load_dwordx4 v42,s[20:23],s65 offen offset:0 sc1 lds
v_mul_f32 v89,v89,v65
v_mul_f32 v92,v92,v72
v_mfma_f32_16x16x32_bf16 v[76:79],a[200:203],v[248:251],v[76:79]
ds_read_b128 v[244:247],v43 offset:21504
buffer_load_dwordx4 v42,s[20:23],s65 offen offset:1024 sc1 lds
v_mul_f32 v93,v93,v73
v_mfma_f32_16x16x32_bf16 v[68:71],a[76:79],v[252:255],v[68:71]
s_xor_b32 m0,s72,49152
v_min3_u32 v27,v27,v248,v252
v_mul_f32 v90,v90,v66
v_mul_f32 v94,v94,v74
v_mfma_f32_16x16x32_bf16 v[76:79],a[204:207],v[252:255],v[76:79]
ds_read_b128 v[248:251],v17 offset:29696
s_add_u32 s65,s88,768
v_mul_f32 v95,v95,v75
s_waitcnt lgkmcnt(5)
v_mfma_f32_16x16x32_bf16 v[68:71],a[16:19],v[224:227],v[68:71]
buffer_load_dwordx4 v42,s[20:23],s65 offen offset:0 sc1 lds
v_mul_f32 v91,v91,v67
v_mfma_f32_16x16x32_bf16 v[76:79],a[144:147],v[224:227],v[76:79]
ds_read_b128 v[252:255],v43 offset:29696
v_min3_u32 v27,v27,v224,v228
v_exp_f32 v92,v92
v_mfma_f32_16x16x32_bf16 v[68:71],a[20:23],v[228:231],v[68:71]
buffer_load_dwordx4 v42,s[20:23],s65 offen offset:1024 sc1 lds
v_exp_f32 v93,v93
v_mfma_f32_16x16x32_bf16 v[76:79],a[148:151],v[228:231],v[76:79]
s_waitcnt vmcnt(8)
s_barrier
ds_read_b128 v[224:227],v17 offset:36864
s_waitcnt lgkmcnt(5)
v_mfma_f32_16x16x32_bf16 v[68:71],a[24:27],v[232:235],v[68:71]
s_xor_b32 m0,s72,4096
s_add_u32 s65,s89,0
v_exp_f32 v94,v94
v_mfma_f32_16x16x32_bf16 v[76:79],a[152:155],v[232:235],v[76:79]
ds_read_b128 v[228:231],v43 offset:36864
v_min3_u32 v27,v27,v232,v236
v_exp_f32 v95,v95
v_mfma_f32_16x16x32_bf16 v[68:71],a[28:31],v[236:239],v[68:71]
buffer_load_dwordx4 v42,s[20:23],s65 offen offset:0 sc1 lds
v_add_f32 v92,1.0,v92
v_add_f32 v93,1.0,v93
v_mfma_f32_16x16x32_bf16 v[76:79],a[156:159],v[236:239],v[76:79]
ds_read_b128 v[232:235],v17 offset:45056
v_add_f32 v94,1.0,v94
v_add_f32 v95,1.0,v95
s_waitcnt lgkmcnt(5)
v_mfma_f32_16x16x32_bf16 v[68:71],a[80:83],v[240:243],v[68:71]
buffer_load_dwordx4 v42,s[20:23],s65 offen offset:1024 sc1 lds
v_rcp_f32 v92,v92
v_mfma_f32_16x16x32_bf16 v[76:79],a[208:211],v[240:243],v[76:79]
ds_read_b128 v[236:239],v43 offset:45056
s_xor_b32 m0,s72,20480
v_rcp_f32 v93,v93
v_mfma_f32_16x16x32_bf16 v[68:71],a[84:87],v[244:247],v[68:71]
s_add_u32 s65,s89,256
v_min3_u32 v27,v27,v240,v244
v_rcp_f32 v94,v94
v_mfma_f32_16x16x32_bf16 v[76:79],a[212:215],v[244:247],v[76:79]
ds_read_b128 v[240:243],v17 offset:37888
v_rcp_f32 v95,v95
s_waitcnt lgkmcnt(5)
v_mfma_f32_16x16x32_bf16 v[68:71],a[88:91],v[248:251],v[68:71]
buffer_load_dwordx4 v42,s[20:23],s65 offen offset:0 sc1 lds
v_mul_f32 v92,v92,v72
v_mul_f32 v93,v93,v73
v_mfma_f32_16x16x32_bf16 v[76:79],a[216:219],v[248:251],v[76:79]
ds_read_b128 v[244:247],v43 offset:37888
v_min3_u32 v27,v27,v248,v252
v_mfma_f32_16x16x32_bf16 v[68:71],a[92:95],v[252:255],v[68:71]
buffer_load_dwordx4 v42,s[20:23],s65 offen offset:1024 sc1 lds
v_mfma_f32_16x16x32_bf16 v[76:79],a[220:223],v[252:255],v[76:79]
ds_read_b128 v[248:251],v17 offset:46080
s_waitcnt lgkmcnt(5)
v_mfma_f32_16x16x32_bf16 v[68:71],a[32:35],v[224:227],v[68:71]
s_xor_b32 m0,s72,36864
s_add_u32 s65,s89,512
v_mfma_f32_16x16x32_bf16 v[76:79],a[160:163],v[224:227],v[76:79]
ds_read_b128 v[252:255],v43 offset:46080
v_min3_u32 v27,v27,v224,v228
v_mfma_f32_16x16x32_bf16 v[68:71],a[36:39],v[228:231],v[68:71]
buffer_load_dwordx4 v42,s[20:23],s65 offen offset:0 sc1 lds
v_mfma_f32_16x16x32_bf16 v[76:79],a[164:167],v[228:231],v[76:79]
ds_read_b128 v[224:227],v17 offset:53248
s_waitcnt lgkmcnt(5)
v_mfma_f32_16x16x32_bf16 v[68:71],a[40:43],v[232:235],v[68:71]
buffer_load_dwordx4 v42,s[20:23],s65 offen offset:1024 sc1 lds
v_mfma_f32_16x16x32_bf16 v[76:79],a[168:171],v[232:235],v[76:79]
ds_read_b128 v[228:231],v43 offset:53248
s_xor_b32 m0,s72,53248
v_mfma_f32_16x16x32_bf16 v[68:71],a[44:47],v[236:239],v[68:71]
s_add_u32 s65,s89,768
v_min3_u32 v27,v27,v232,v236
v_mfma_f32_16x16x32_bf16 v[76:79],a[172:175],v[236:239],v[76:79]
ds_read_b128 v[232:235],v17 offset:61440
s_waitcnt lgkmcnt(5)
v_mfma_f32_16x16x32_bf16 v[68:71],a[96:99],v[240:243],v[68:71]
buffer_load_dwordx4 v42,s[20:23],s65 offen offset:0 sc1 lds
v_mfma_f32_16x16x32_bf16 v[76:79],a[224:227],v[240:243],v[76:79]
ds_read_b128 v[236:239],v43 offset:61440
v_min3_u32 v27,v27,v240,v244
v_mfma_f32_16x16x32_bf16 v[68:71],a[100:103],v[244:247],v[68:71]
buffer_load_dwordx4 v42,s[20:23],s65 offen offset:1024 sc1 lds
v_mfma_f32_16x16x32_bf16 v[76:79],a[228:231],v[244:247],v[76:79]
ds_read_b128 v[240:243],v17 offset:54272
s_waitcnt lgkmcnt(5)
v_mfma_f32_16x16x32_bf16 v[68:71],a[104:107],v[248:251],v[68:71]
v_min3_u32 v27,v27,v248,v252
v_exp_f32 v88,v88
v_mfma_f32_16x16x32_bf16 v[76:79],a[232:235],v[248:251],v[76:79]
ds_read_b128 v[244:247],v43 offset:54272
v_exp_f32 v89,v89
v_mfma_f32_16x16x32_bf16 v[68:71],a[108:111],v[252:255],v[68:71]
v_exp_f32 v90,v90
v_mfma_f32_16x16x32_bf16 v[76:79],a[236:239],v[252:255],v[76:79]
ds_read_b128 v[248:251],v17 offset:62464
s_waitcnt lgkmcnt(5)
v_mfma_f32_16x16x32_bf16 v[68:71],a[48:51],v[224:227],v[68:71]
v_min3_u32 v27,v27,v224,v228
v_exp_f32 v91,v91
v_mfma_f32_16x16x32_bf16 v[76:79],a[176:179],v[224:227],v[76:79]
ds_read_b128 v[252:255],v43 offset:62464
v_add_f32 v88,1.0,v88
v_add_f32 v89,1.0,v89
v_mfma_f32_16x16x32_bf16 v[68:71],a[52:55],v[228:231],v[68:71]
v_add_f32 v90,1.0,v90
v_add_f32 v91,1.0,v91
v_mfma_f32_16x16x32_bf16 v[76:79],a[180:183],v[228:231],v[76:79]
v_rcp_f32 v88,v88
s_waitcnt lgkmcnt(4)
v_mfma_f32_16x16x32_bf16 v[68:71],a[56:59],v[232:235],v[68:71]
v_min3_u32 v27,v27,v232,v236
v_rcp_f32 v89,v89
v_mfma_f32_16x16x32_bf16 v[76:79],a[184:187],v[232:235],v[76:79]
v_rcp_f32 v90,v90
v_mfma_f32_16x16x32_bf16 v[68:71],a[60:63],v[236:239],v[68:71]
v_rcp_f32 v91,v91
v_mfma_f32_16x16x32_bf16 v[76:79],a[188:191],v[236:239],v[76:79]
v_mul_f32 v88,v88,v64
s_waitcnt lgkmcnt(2)
v_mfma_f32_16x16x32_bf16 v[68:71],a[112:115],v[240:243],v[68:71]
v_min3_u32 v27,v27,v240,v244
v_mul_f32 v89,v89,v65
v_mfma_f32_16x16x32_bf16 v[76:79],a[240:243],v[240:243],v[76:79]
v_mul_f32 v90,v90,v66
v_mul_f32 v91,v91,v67
v_mfma_f32_16x16x32_bf16 v[68:71],a[116:119],v[244:247],v[68:71]
v_mul_f32 v94,v94,v74
v_mul_f32 v95,v95,v75
v_mfma_f32_16x16x32_bf16 v[76:79],a[244:247],v[244:247],v[76:79]
v_cvt_pk_bf16_f32 v96,v88,v89
s_waitcnt lgkmcnt(0)
v_mfma_f32_16x16x32_bf16 v[68:71],a[120:123],v[248:251],v[68:71]
v_min3_u32 v27,v27,v248,v252
v_cvt_pk_bf16_f32 v97,v90,v91
v_mfma_f32_16x16x32_bf16 v[76:79],a[248:251],v[248:251],v[76:79]
v_cvt_pk_bf16_f32 v98,v92,v93
v_cvt_pk_bf16_f32 v99,v94,v95
v_mfma_f32_16x16x32_bf16 v[68:71],a[124:127],v[252:255],v[68:71]
v_max_u32 v96,1,v96
v_mfma_f32_16x16x32_bf16 v[76:79],a[252:255],v[252:255],v[76:79]
buffer_store_dwordx4 v[96:99],v18,s[20:23],s78 offen sc1
v_cmp_eq_u32 vcc,0,v27
s_cbranch_vccnz retry_222
s_branch epi_225
ahead_224:
s_cmp_eq_u32 s93,0
s_cbranch_scc1 both_226
s_waitcnt vmcnt(13) lgkmcnt(0)
s_barrier
ds_read_b128 v[224:227],v17 offset:0
ds_read_b128 v[228:231],v43 offset:0
ds_read_b128 v[232:235],v17 offset:8192
ds_read_b128 v[236:239],v43 offset:8192
ds_read_b128 v[240:243],v17 offset:1024
ds_read_b128 v[244:247],v43 offset:1024
ds_read_b128 v[248:251],v17 offset:9216
s_waitcnt lgkmcnt(5)
v_mfma_f32_16x16x32_bf16 v[64:67],a[0:3],v[224:227],0
s_add_u32 s96,s71,1
s_add_u32 s92,s71,2
v_mfma_f32_16x16x32_bf16 v[72:75],a[128:131],v[224:227],0
ds_read_b128 v[252:255],v43 offset:9216
v_min_u32 v27,v224,v228
v_mfma_f32_16x16x32_bf16 v[64:67],a[4:7],v[228:231],v[64:67]
v_mfma_f32_16x16x32_bf16 v[72:75],a[132:135],v[228:231],v[72:75]
ds_read_b128 v[224:227],v17 offset:16384
s_waitcnt lgkmcnt(5)
v_mfma_f32_16x16x32_bf16 v[64:67],a[8:11],v[232:235],v[64:67]
v_min3_u32 v27,v27,v232,v236
v_mfma_f32_16x16x32_bf16 v[72:75],a[136:139],v[232:235],v[72:75]
ds_read_b128 v[228:231],v43 offset:16384
v_mfma_f32_16x16x32_bf16 v[64:67],a[12:15],v[236:239],v[64:67]
v_mfma_f32_16x16x32_bf16 v[72:75],a[140:143],v[236:239],v[72:75]
ds_read_b128 v[232:235],v17 offset:24576
s_waitcnt lgkmcnt(5)
v_mfma_f32_16x16x32_bf16 v[64:67],a[64:67],v[240:243],v[64:67]
v_min3_u32 v27,v27,v240,v244
v_mfma_f32_16x16x32_bf16 v[72:75],a[192:195],v[240:243],v[72:75]
ds_read_b128 v[236:239],v43 offset:24576
v_mfma_f32_16x16x32_bf16 v[64:67],a[68:71],v[244:247],v[64:67]
v_mfma_f32_16x16x32_bf16 v[72:75],a[196:199],v[244:247],v[72:75]
ds_read_b128 v[240:243],v17 offset:17408
s_waitcnt lgkmcnt(5)
v_mfma_f32_16x16x32_bf16 v[64:67],a[72:75],v[248:251],v[64:67]
v_min3_u32 v27,v27,v248,v252
v_mfma_f32_16x16x32_bf16 v[72:75],a[200:203],v[248:251],v[72:75]
ds_read_b128 v[244:247],v43 offset:17408
v_mfma_f32_16x16x32_bf16 v[64:67],a[76:79],v[252:255],v[64:67]
v_mfma_f32_16x16x32_bf16 v[72:75],a[204:207],v[252:255],v[72:75]
ds_read_b128 v[248:251],v17 offset:25600
s_waitcnt lgkmcnt(5)
v_mfma_f32_16x16x32_bf16 v[64:67],a[16:19],v[224:227],v[64:67]
v_min3_u32 v27,v27,v224,v228
v_mfma_f32_16x16x32_bf16 v[72:75],a[144:147],v[224:227],v[72:75]
ds_read_b128 v[252:255],v43 offset:25600
v_mfma_f32_16x16x32_bf16 v[64:67],a[20:23],v[228:231],v[64:67]
v_mfma_f32_16x16x32_bf16 v[72:75],a[148:151],v[228:231],v[72:75]
ds_read_b128 v[224:227],v17 offset:32768
s_waitcnt lgkmcnt(5)
v_mfma_f32_16x16x32_bf16 v[64:67],a[24:27],v[232:235],v[64:67]
v_min3_u32 v27,v27,v232,v236
v_mfma_f32_16x16x32_bf16 v[72:75],a[152:155],v[232:235],v[72:75]
ds_read_b128 v[228:231],v43 offset:32768
v_mfma_f32_16x16x32_bf16 v[64:67],a[28:31],v[236:239],v[64:67]
v_mfma_f32_16x16x32_bf16 v[72:75],a[156:159],v[236:239],v[72:75]
ds_read_b128 v[232:235],v17 offset:40960
s_waitcnt lgkmcnt(5)
v_mfma_f32_16x16x32_bf16 v[64:67],a[80:83],v[240:243],v[64:67]
v_min3_u32 v27,v27,v240,v244
v_mfma_f32_16x16x32_bf16 v[72:75],a[208:211],v[240:243],v[72:75]
ds_read_b128 v[236:239],v43 offset:40960
v_mfma_f32_16x16x32_bf16 v[64:67],a[84:87],v[244:247],v[64:67]
v_mfma_f32_16x16x32_bf16 v[72:75],a[212:215],v[244:247],v[72:75]
ds_read_b128 v[240:243],v17 offset:33792
s_waitcnt lgkmcnt(5)
v_mfma_f32_16x16x32_bf16 v[64:67],a[88:91],v[248:251],v[64:67]
v_min3_u32 v27,v27,v248,v252
v_mfma_f32_16x16x32_bf16 v[72:75],a[216:219],v[248:251],v[72:75]
ds_read_b128 v[244:247],v43 offset:33792
s_waitcnt vmcnt(3)
v_mfma_f32_16x16x32_bf16 v[64:67],a[92:95],v[252:255],v[64:67]
v_cmp_gt_u32 vcc,s96,v29
v_cmp_gt_u32 s[92:93],s92,v29
v_mfma_f32_16x16x32_bf16 v[72:75],a[220:223],v[252:255],v[72:75]
ds_read_b128 v[248:251],v17 offset:41984
s_waitcnt lgkmcnt(5)
v_mfma_f32_16x16x32_bf16 v[64:67],a[32:35],v[224:227],v[64:67]
v_mov_b32 v44,vcc_lo
v_mov_b32 v45,s92
v_mfma_f32_16x16x32_bf16 v[72:75],a[160:163],v[224:227],v[72:75]
ds_read_b128 v[252:255],v43 offset:41984
ds_write_b64 v46,v[44:45]
v_mfma_f32_16x16x32_bf16 v[64:67],a[36:39],v[228:231],v[64:67]
v_min3_u32 v27,v27,v224,v228
v_mfma_f32_16x16x32_bf16 v[72:75],a[164:167],v[228:231],v[72:75]
ds_read_b128 v[224:227],v17 offset:49152
s_waitcnt lgkmcnt(6)
v_mfma_f32_16x16x32_bf16 v[64:67],a[40:43],v[232:235],v[64:67]
v_min3_u32 v27,v27,v232,v236
v_mfma_f32_16x16x32_bf16 v[72:75],a[168:171],v[232:235],v[72:75]
ds_read_b128 v[228:231],v43 offset:49152
v_mfma_f32_16x16x32_bf16 v[64:67],a[44:47],v[236:239],v[64:67]
v_mfma_f32_16x16x32_bf16 v[72:75],a[172:175],v[236:239],v[72:75]
ds_read_b128 v[232:235],v17 offset:57344
s_waitcnt lgkmcnt(6)
v_mfma_f32_16x16x32_bf16 v[64:67],a[96:99],v[240:243],v[64:67]
v_min3_u32 v27,v27,v240,v244
s_add_u32 s88,s70,s75
v_mfma_f32_16x16x32_bf16 v[72:75],a[224:227],v[240:243],v[72:75]
ds_read_b128 v[236:239],v43 offset:57344
s_add_u32 s88,s88,2097152
v_mfma_f32_16x16x32_bf16 v[64:67],a[100:103],v[244:247],v[64:67]
s_xor_b32 s88,s88,0x2000
s_add_u32 s89,s88,65536
v_mfma_f32_16x16x32_bf16 v[72:75],a[228:231],v[244:247],v[72:75]
ds_read_b128 v[240:243],v17 offset:50176
s_waitcnt lgkmcnt(6)
v_mfma_f32_16x16x32_bf16 v[64:67],a[104:107],v[248:251],v[64:67]
v_min3_u32 v27,v27,v248,v252
v_mfma_f32_16x16x32_bf16 v[72:75],a[232:235],v[248:251],v[72:75]
ds_read_b128 v[244:247],v43 offset:50176
v_mfma_f32_16x16x32_bf16 v[64:67],a[108:111],v[252:255],v[64:67]
v_mfma_f32_16x16x32_bf16 v[72:75],a[236:239],v[252:255],v[72:75]
ds_read_b128 v[248:251],v17 offset:58368
s_waitcnt lgkmcnt(5)
v_mfma_f32_16x16x32_bf16 v[64:67],a[48:51],v[224:227],v[64:67]
v_min3_u32 v27,v27,v224,v228
v_mfma_f32_16x16x32_bf16 v[72:75],a[176:179],v[224:227],v[72:75]
ds_read_b128 v[252:255],v43 offset:58368
v_mfma_f32_16x16x32_bf16 v[64:67],a[52:55],v[228:231],v[64:67]
s_waitcnt vmcnt(0)
v_add_u32 v22,s71,-1
v_mfma_f32_16x16x32_bf16 v[72:75],a[180:183],v[228:231],v[72:75]
s_waitcnt vmcnt(5)
s_barrier
ds_read_b64 v[44:45],v47
ds_read_b128 v[224:227],v17 offset:4096
s_waitcnt lgkmcnt(6)
v_mfma_f32_16x16x32_bf16 v[64:67],a[56:59],v[232:235],v[64:67]
v_min3_u32 v27,v27,v232,v236
buffer_store_dword v22,v23,s[24:27],s97 offen
v_mfma_f32_16x16x32_bf16 v[72:75],a[184:187],v[232:235],v[72:75]
ds_read_b128 v[228:231],v43 offset:4096
v_mfma_f32_16x16x32_bf16 v[64:67],a[60:63],v[236:239],v[64:67]
buffer_store_dword v22,v23,s[28:31],s97 offen sc1
v_mfma_f32_16x16x32_bf16 v[72:75],a[188:191],v[236:239],v[72:75]
ds_read_b128 v[232:235],v17 offset:12288
s_waitcnt lgkmcnt(6)
v_mfma_f32_16x16x32_bf16 v[64:67],a[112:115],v[240:243],v[64:67]
v_min3_u32 v27,v27,v240,v244
s_mov_b32 s97,0x7fff0000
v_mfma_f32_16x16x32_bf16 v[72:75],a[240:243],v[240:243],v[72:75]
ds_read_b128 v[236:239],v43 offset:12288
v_mfma_f32_16x16x32_bf16 v[64:67],a[116:119],v[244:247],v[64:67]
v_mfma_f32_16x16x32_bf16 v[72:75],a[244:247],v[244:247],v[72:75]
ds_read_b128 v[240:243],v17 offset:5120
s_waitcnt lgkmcnt(6)
v_mfma_f32_16x16x32_bf16 v[64:67],a[120:123],v[248:251],v[64:67]
s_waitcnt lgkmcnt(5)
v_readfirstlane_b32 s93,v45
v_mfma_f32_16x16x32_bf16 v[72:75],a[248:251],v[248:251],v[72:75]
ds_read_b128 v[244:247],v43 offset:5120
v_readfirstlane_b32 s83,v44
s_cmp_lg_u32 s83,0
s_cbranch_scc1 keep_234
v_mfma_f32_16x16x32_bf16 v[64:67],a[124:127],v[252:255],v[64:67]
v_min3_u32 v27,v27,v248,v252
s_xor_b32 m0,s72,0
v_mfma_f32_16x16x32_bf16 v[72:75],a[252:255],v[252:255],v[72:75]
ds_read_b128 v[248:251],v17 offset:13312
s_add_u32 s65,s88,0
s_waitcnt lgkmcnt(5)
v_mfma_f32_16x16x32_bf16 v[68:71],a[0:3],v[224:227],0
buffer_load_dwordx4 v42,s[20:23],s65 offen offset:0 sc1 lds
v_min3_u32 v27,v27,v224,v228
v_mfma_f32_16x16x32_bf16 v[76:79],a[128:131],v[224:227],0
ds_read_b128 v[252:255],v43 offset:13312
buffer_load_dwordx4 v42,s[20:23],s65 offen offset:1024 sc1 lds
v_mfma_f32_16x16x32_bf16 v[68:71],a[4:7],v[228:231],v[68:71]
v_cmp_eq_u32 vcc,0,v27
s_cbranch_vccnz retry_222
v_mfma_f32_16x16x32_bf16 v[76:79],a[132:135],v[228:231],v[76:79]
ds_read_b128 v[224:227],v17 offset:20480
s_xor_b32 m0,s72,16384
s_waitcnt lgkmcnt(5)
v_mfma_f32_16x16x32_bf16 v[68:71],a[8:11],v[232:235],v[68:71]
s_add_u32 s65,s88,256
v_min3_u32 v27,v27,v232,v236
v_mul_f32 v88,v64,v64
v_mul_f32 v92,v72,v72
v_mfma_f32_16x16x32_bf16 v[76:79],a[136:139],v[232:235],v[76:79]
ds_read_b128 v[228:231],v43 offset:20480
buffer_load_dwordx4 v42,s[20:23],s65 offen offset:0 sc1 lds
v_mul_f32 v93,v73,v73
v_mfma_f32_16x16x32_bf16 v[68:71],a[12:15],v[236:239],v[68:71]
v_mul_f32 v89,v65,v65
v_mul_f32 v90,v66,v66
v_mul_f32 v91,v67,v67
v_mul_f32 v94,v74,v74
v_mfma_f32_16x16x32_bf16 v[76:79],a[140:143],v[236:239],v[76:79]
ds_read_b128 v[232:235],v17 offset:28672
v_fma_f32 v88,v88,s81,v28
v_mul_f32 v95,v75,v75
s_waitcnt lgkmcnt(5)
v_mfma_f32_16x16x32_bf16 v[68:71],a[64:67],v[240:243],v[68:71]
buffer_load_dwordx4 v42,s[20:23],s65 offen offset:1024 sc1 lds
s_xor_b32 m0,s72,32768
v_fma_f32 v92,v92,s81,v28
v_mfma_f32_16x16x32_bf16 v[76:79],a[192:195],v[240:243],v[76:79]
ds_read_b128 v[236:239],v43 offset:28672
s_add_u32 s65,s88,512
v_fma_f32 v89,v89,s81,v28
v_fma_f32 v93,v93,s81,v28
v_mfma_f32_16x16x32_bf16 v[68:71],a[68:71],v[244:247],v[68:71]
v_min3_u32 v27,v27,v240,v244
v_fma_f32 v90,v90,s81,v28
v_fma_f32 v91,v91,s81,v28
v_fma_f32 v94,v94,s81,v28
v_mfma_f32_16x16x32_bf16 v[76:79],a[196:199],v[244:247],v[76:79]
ds_read_b128 v[240:243],v17 offset:21504
v_mul_f32 v88,v88,v64
v_fma_f32 v95,v95,s81,v28
s_waitcnt lgkmcnt(5)
v_mfma_f32_16x16x32_bf16 v[68:71],a[72:75],v[248:251],v[68:71]
buffer_load_dwordx4 v42,s[20:23],s65 offen offset:0 sc1 lds
v_mul_f32 v89,v89,v65
v_mul_f32 v92,v92,v72
v_mfma_f32_16x16x32_bf16 v[76:79],a[200:203],v[248:251],v[76:79]
ds_read_b128 v[244:247],v43 offset:21504
buffer_load_dwordx4 v42,s[20:23],s65 offen offset:1024 sc1 lds
v_mul_f32 v93,v93,v73
v_mfma_f32_16x16x32_bf16 v[68:71],a[76:79],v[252:255],v[68:71]
s_xor_b32 m0,s72,49152
v_min3_u32 v27,v27,v248,v252
v_mul_f32 v90,v90,v66
v_mul_f32 v94,v94,v74
v_mfma_f32_16x16x32_bf16 v[76:79],a[204:207],v[252:255],v[76:79]
ds_read_b128 v[248:251],v17 offset:29696
s_add_u32 s65,s88,768
v_mul_f32 v95,v95,v75
s_waitcnt lgkmcnt(5)
v_mfma_f32_16x16x32_bf16 v[68:71],a[16:19],v[224:227],v[68:71]
buffer_load_dwordx4 v42,s[20:23],s65 offen offset:0 sc1 lds
v_mul_f32 v91,v91,v67
v_mfma_f32_16x16x32_bf16 v[76:79],a[144:147],v[224:227],v[76:79]
ds_read_b128 v[252:255],v43 offset:29696
v_min3_u32 v27,v27,v224,v228
v_exp_f32 v92,v92
v_mfma_f32_16x16x32_bf16 v[68:71],a[20:23],v[228:231],v[68:71]
buffer_load_dwordx4 v42,s[20:23],s65 offen offset:1024 sc1 lds
v_exp_f32 v93,v93
v_mfma_f32_16x16x32_bf16 v[76:79],a[148:151],v[228:231],v[76:79]
ds_read_b128 v[224:227],v17 offset:36864
v_exp_f32 v94,v94
s_waitcnt lgkmcnt(5)
v_mfma_f32_16x16x32_bf16 v[68:71],a[24:27],v[232:235],v[68:71]
s_xor_b32 m0,s72,4096
s_add_u32 s65,s89,0
v_exp_f32 v95,v95
v_mfma_f32_16x16x32_bf16 v[76:79],a[152:155],v[232:235],v[76:79]
ds_read_b128 v[228:231],v43 offset:36864
v_min3_u32 v27,v27,v232,v236
v_add_f32 v92,1.0,v92
v_add_f32 v93,1.0,v93
v_mfma_f32_16x16x32_bf16 v[68:71],a[28:31],v[236:239],v[68:71]
buffer_load_dwordx4 v42,s[20:23],s65 offen offset:0 sc1 lds
v_add_f32 v94,1.0,v94
v_add_f32 v95,1.0,v95
v_mfma_f32_16x16x32_bf16 v[76:79],a[156:159],v[236:239],v[76:79]
ds_read_b128 v[232:235],v17 offset:45056
v_rcp_f32 v92,v92
s_waitcnt lgkmcnt(5)
v_mfma_f32_16x16x32_bf16 v[68:71],a[80:83],v[240:243],v[68:71]
buffer_load_dwordx4 v42,s[20:23],s65 offen offset:1024 sc1 lds
v_rcp_f32 v93,v93
v_mfma_f32_16x16x32_bf16 v[76:79],a[208:211],v[240:243],v[76:79]
ds_read_b128 v[236:239],v43 offset:45056
s_xor_b32 m0,s72,20480
v_rcp_f32 v94,v94
v_mfma_f32_16x16x32_bf16 v[68:71],a[84:87],v[244:247],v[68:71]
s_add_u32 s65,s89,256
v_min3_u32 v27,v27,v240,v244
v_rcp_f32 v95,v95
v_mfma_f32_16x16x32_bf16 v[76:79],a[212:215],v[244:247],v[76:79]
ds_read_b128 v[240:243],v17 offset:37888
v_mul_f32 v92,v92,v72
v_mul_f32 v93,v93,v73
s_waitcnt lgkmcnt(5)
v_mfma_f32_16x16x32_bf16 v[68:71],a[88:91],v[248:251],v[68:71]
buffer_load_dwordx4 v42,s[20:23],s65 offen offset:0 sc1 lds
v_mfma_f32_16x16x32_bf16 v[76:79],a[216:219],v[248:251],v[76:79]
ds_read_b128 v[244:247],v43 offset:37888
v_min3_u32 v27,v27,v248,v252
v_mfma_f32_16x16x32_bf16 v[68:71],a[92:95],v[252:255],v[68:71]
buffer_load_dwordx4 v42,s[20:23],s65 offen offset:1024 sc1 lds
v_mfma_f32_16x16x32_bf16 v[76:79],a[220:223],v[252:255],v[76:79]
ds_read_b128 v[248:251],v17 offset:46080
s_waitcnt lgkmcnt(5)
v_mfma_f32_16x16x32_bf16 v[68:71],a[32:35],v[224:227],v[68:71]
s_xor_b32 m0,s72,36864
s_add_u32 s65,s89,512
v_mfma_f32_16x16x32_bf16 v[76:79],a[160:163],v[224:227],v[76:79]
ds_read_b128 v[252:255],v43 offset:46080
v_min3_u32 v27,v27,v224,v228
v_mfma_f32_16x16x32_bf16 v[68:71],a[36:39],v[228:231],v[68:71]
buffer_load_dwordx4 v42,s[20:23],s65 offen offset:0 sc1 lds
v_mfma_f32_16x16x32_bf16 v[76:79],a[164:167],v[228:231],v[76:79]
ds_read_b128 v[224:227],v17 offset:53248
s_waitcnt lgkmcnt(5)
v_mfma_f32_16x16x32_bf16 v[68:71],a[40:43],v[232:235],v[68:71]
buffer_load_dwordx4 v42,s[20:23],s65 offen offset:1024 sc1 lds
v_mfma_f32_16x16x32_bf16 v[76:79],a[168:171],v[232:235],v[76:79]
ds_read_b128 v[228:231],v43 offset:53248
s_xor_b32 m0,s72,53248
v_mfma_f32_16x16x32_bf16 v[68:71],a[44:47],v[236:239],v[68:71]
s_add_u32 s65,s89,768
v_min3_u32 v27,v27,v232,v236
v_mfma_f32_16x16x32_bf16 v[76:79],a[172:175],v[236:239],v[76:79]
ds_read_b128 v[232:235],v17 offset:61440
s_waitcnt lgkmcnt(5)
v_mfma_f32_16x16x32_bf16 v[68:71],a[96:99],v[240:243],v[68:71]
buffer_load_dwordx4 v42,s[20:23],s65 offen offset:0 sc1 lds
v_mfma_f32_16x16x32_bf16 v[76:79],a[224:227],v[240:243],v[76:79]
ds_read_b128 v[236:239],v43 offset:61440
v_min3_u32 v27,v27,v240,v244
v_mfma_f32_16x16x32_bf16 v[68:71],a[100:103],v[244:247],v[68:71]
buffer_load_dwordx4 v42,s[20:23],s65 offen offset:1024 sc1 lds
v_mfma_f32_16x16x32_bf16 v[76:79],a[228:231],v[244:247],v[76:79]
ds_read_b128 v[240:243],v17 offset:54272
s_waitcnt lgkmcnt(5)
v_mfma_f32_16x16x32_bf16 v[68:71],a[104:107],v[248:251],v[68:71]
v_min3_u32 v27,v27,v248,v252
v_exp_f32 v88,v88
v_mfma_f32_16x16x32_bf16 v[76:79],a[232:235],v[248:251],v[76:79]
ds_read_b128 v[244:247],v43 offset:54272
v_exp_f32 v89,v89
v_mfma_f32_16x16x32_bf16 v[68:71],a[108:111],v[252:255],v[68:71]
v_exp_f32 v90,v90
v_mfma_f32_16x16x32_bf16 v[76:79],a[236:239],v[252:255],v[76:79]
ds_read_b128 v[248:251],v17 offset:62464
s_waitcnt lgkmcnt(5)
v_mfma_f32_16x16x32_bf16 v[68:71],a[48:51],v[224:227],v[68:71]
v_min3_u32 v27,v27,v224,v228
v_exp_f32 v91,v91
v_mfma_f32_16x16x32_bf16 v[76:79],a[176:179],v[224:227],v[76:79]
ds_read_b128 v[252:255],v43 offset:62464
v_add_f32 v88,1.0,v88
v_add_f32 v89,1.0,v89
v_mfma_f32_16x16x32_bf16 v[68:71],a[52:55],v[228:231],v[68:71]
v_add_f32 v90,1.0,v90
v_add_f32 v91,1.0,v91
v_mfma_f32_16x16x32_bf16 v[76:79],a[180:183],v[228:231],v[76:79]
v_rcp_f32 v88,v88
s_waitcnt lgkmcnt(4)
v_mfma_f32_16x16x32_bf16 v[68:71],a[56:59],v[232:235],v[68:71]
v_min3_u32 v27,v27,v232,v236
v_rcp_f32 v89,v89
v_mfma_f32_16x16x32_bf16 v[76:79],a[184:187],v[232:235],v[76:79]
v_rcp_f32 v90,v90
v_mfma_f32_16x16x32_bf16 v[68:71],a[60:63],v[236:239],v[68:71]
v_rcp_f32 v91,v91
v_mfma_f32_16x16x32_bf16 v[76:79],a[188:191],v[236:239],v[76:79]
v_mul_f32 v88,v88,v64
s_waitcnt lgkmcnt(2)
v_mfma_f32_16x16x32_bf16 v[68:71],a[112:115],v[240:243],v[68:71]
v_min3_u32 v27,v27,v240,v244
v_mul_f32 v89,v89,v65
v_mfma_f32_16x16x32_bf16 v[76:79],a[240:243],v[240:243],v[76:79]
v_mul_f32 v90,v90,v66
v_mul_f32 v91,v91,v67
v_mfma_f32_16x16x32_bf16 v[68:71],a[116:119],v[244:247],v[68:71]
v_mul_f32 v94,v94,v74
v_mul_f32 v95,v95,v75
v_mfma_f32_16x16x32_bf16 v[76:79],a[244:247],v[244:247],v[76:79]
v_cvt_pk_bf16_f32 v96,v88,v89
s_waitcnt lgkmcnt(0)
v_mfma_f32_16x16x32_bf16 v[68:71],a[120:123],v[248:251],v[68:71]
v_min3_u32 v27,v27,v248,v252
v_cvt_pk_bf16_f32 v97,v90,v91
v_mfma_f32_16x16x32_bf16 v[76:79],a[248:251],v[248:251],v[76:79]
v_cvt_pk_bf16_f32 v98,v92,v93
v_cvt_pk_bf16_f32 v99,v94,v95
v_mfma_f32_16x16x32_bf16 v[68:71],a[124:127],v[252:255],v[68:71]
v_max_u32 v96,1,v96
v_mfma_f32_16x16x32_bf16 v[76:79],a[252:255],v[252:255],v[76:79]
buffer_store_dwordx4 v[96:99],v18,s[20:23],s78 offen sc1
v_cmp_eq_u32 vcc,0,v27
s_cbranch_vccnz retry_222
s_branch epi_225
keep_234:
v_mfma_f32_16x16x32_bf16 v[64:67],a[124:127],v[252:255],v[64:67]
v_min3_u32 v27,v27,v248,v252
v_mfma_f32_16x16x32_bf16 v[72:75],a[252:255],v[252:255],v[72:75]
ds_read_b128 v[248:251],v17 offset:13312
s_waitcnt lgkmcnt(5)
v_mfma_f32_16x16x32_bf16 v[68:71],a[0:3],v[224:227],0
v_cmp_eq_u32 vcc,0,v27
s_cbranch_vccnz retry_222
v_mfma_f32_16x16x32_bf16 v[76:79],a[128:131],v[224:227],0
ds_read_b128 v[252:255],v43 offset:13312
v_min3_u32 v27,v27,v224,v228
v_mfma_f32_16x16x32_bf16 v[68:71],a[4:7],v[228:231],v[68:71]
v_mfma_f32_16x16x32_bf16 v[76:79],a[132:135],v[228:231],v[76:79]
ds_read_b128 v[224:227],v17 offset:20480
s_waitcnt lgkmcnt(5)
v_mfma_f32_16x16x32_bf16 v[68:71],a[8:11],v[232:235],v[68:71]
v_min3_u32 v27,v27,v232,v236
v_mul_f32 v88,v64,v64
v_mul_f32 v92,v72,v72
v_mfma_f32_16x16x32_bf16 v[76:79],a[136:139],v[232:235],v[76:79]
ds_read_b128 v[228:231],v43 offset:20480
v_mul_f32 v89,v65,v65
v_mul_f32 v93,v73,v73
v_mfma_f32_16x16x32_bf16 v[68:71],a[12:15],v[236:239],v[68:71]
v_mul_f32 v90,v66,v66
v_mul_f32 v91,v67,v67
v_mul_f32 v94,v74,v74
v_mfma_f32_16x16x32_bf16 v[76:79],a[140:143],v[236:239],v[76:79]
ds_read_b128 v[232:235],v17 offset:28672
v_mul_f32 v95,v75,v75
s_waitcnt lgkmcnt(5)
v_mfma_f32_16x16x32_bf16 v[68:71],a[64:67],v[240:243],v[68:71]
v_min3_u32 v27,v27,v240,v244
v_fma_f32 v88,v88,s81,v28
v_fma_f32 v92,v92,s81,v28
v_mfma_f32_16x16x32_bf16 v[76:79],a[192:195],v[240:243],v[76:79]
ds_read_b128 v[236:239],v43 offset:28672
v_fma_f32 v89,v89,s81,v28
v_fma_f32 v93,v93,s81,v28
v_mfma_f32_16x16x32_bf16 v[68:71],a[68:71],v[244:247],v[68:71]
v_fma_f32 v90,v90,s81,v28
v_fma_f32 v91,v91,s81,v28
v_fma_f32 v94,v94,s81,v28
v_mfma_f32_16x16x32_bf16 v[76:79],a[196:199],v[244:247],v[76:79]
ds_read_b128 v[240:243],v17 offset:21504
v_fma_f32 v95,v95,s81,v28
s_waitcnt lgkmcnt(5)
v_mfma_f32_16x16x32_bf16 v[68:71],a[72:75],v[248:251],v[68:71]
v_min3_u32 v27,v27,v248,v252
v_mul_f32 v88,v88,v64
v_mul_f32 v92,v92,v72
v_mfma_f32_16x16x32_bf16 v[76:79],a[200:203],v[248:251],v[76:79]
ds_read_b128 v[244:247],v43 offset:21504
v_mul_f32 v89,v89,v65
v_mul_f32 v93,v93,v73
v_mfma_f32_16x16x32_bf16 v[68:71],a[76:79],v[252:255],v[68:71]
v_mul_f32 v90,v90,v66
v_mul_f32 v91,v91,v67
v_mul_f32 v94,v94,v74
v_mfma_f32_16x16x32_bf16 v[76:79],a[204:207],v[252:255],v[76:79]
ds_read_b128 v[248:251],v17 offset:29696
v_mul_f32 v95,v95,v75
s_waitcnt lgkmcnt(5)
v_mfma_f32_16x16x32_bf16 v[68:71],a[16:19],v[224:227],v[68:71]
v_min3_u32 v27,v27,v224,v228
v_exp_f32 v92,v92
v_mfma_f32_16x16x32_bf16 v[76:79],a[144:147],v[224:227],v[76:79]
ds_read_b128 v[252:255],v43 offset:29696
v_exp_f32 v93,v93
v_mfma_f32_16x16x32_bf16 v[68:71],a[20:23],v[228:231],v[68:71]
v_exp_f32 v88,v88
v_mfma_f32_16x16x32_bf16 v[76:79],a[148:151],v[228:231],v[76:79]
ds_read_b128 v[224:227],v17 offset:36864
s_waitcnt lgkmcnt(5)
v_mfma_f32_16x16x32_bf16 v[68:71],a[24:27],v[232:235],v[68:71]
v_min3_u32 v27,v27,v232,v236
v_exp_f32 v94,v94
v_mfma_f32_16x16x32_bf16 v[76:79],a[152:155],v[232:235],v[76:79]
ds_read_b128 v[228:231],v43 offset:36864
v_exp_f32 v95,v95
v_mfma_f32_16x16x32_bf16 v[68:71],a[28:31],v[236:239],v[68:71]
v_exp_f32 v89,v89
v_add_f32 v92,1.0,v92
v_mfma_f32_16x16x32_bf16 v[76:79],a[156:159],v[236:239],v[76:79]
ds_read_b128 v[232:235],v17 offset:45056
v_add_f32 v93,1.0,v93
s_waitcnt lgkmcnt(5)
v_mfma_f32_16x16x32_bf16 v[68:71],a[80:83],v[240:243],v[68:71]
v_min3_u32 v27,v27,v240,v244
v_add_f32 v94,1.0,v94
v_add_f32 v95,1.0,v95
v_mfma_f32_16x16x32_bf16 v[76:79],a[208:211],v[240:243],v[76:79]
ds_read_b128 v[236:239],v43 offset:45056
v_rcp_f32 v92,v92
v_mfma_f32_16x16x32_bf16 v[68:71],a[84:87],v[244:247],v[68:71]
v_exp_f32 v90,v90
v_mfma_f32_16x16x32_bf16 v[76:79],a[212:215],v[244:247],v[76:79]
ds_read_b128 v[240:243],v17 offset:37888
s_waitcnt lgkmcnt(5)
v_mfma_f32_16x16x32_bf16 v[68:71],a[88:91],v[248:251],v[68:71]
v_min3_u32 v27,v27,v248,v252
v_rcp_f32 v93,v93
v_mfma_f32_16x16x32_bf16 v[76:79],a[216:219],v[248:251],v[76:79]
ds_read_b128 v[244:247],v43 offset:37888
v_rcp_f32 v94,v94
v_mfma_f32_16x16x32_bf16 v[68:71],a[92:95],v[252:255],v[68:71]
v_exp_f32 v91,v91
v_mfma_f32_16x16x32_bf16 v[76:79],a[220:223],v[252:255],v[76:79]
ds_read_b128 v[248:251],v17 offset:46080
s_waitcnt lgkmcnt(5)
v_mfma_f32_16x16x32_bf16 v[68:71],a[32:35],v[224:227],v[68:71]
v_min3_u32 v27,v27,v224,v228
v_add_f32 v88,1.0,v88
v_mfma_f32_16x16x32_bf16 v[76:79],a[160:163],v[224:227],v[76:79]
ds_read_b128 v[252:255],v43 offset:46080
v_add_f32 v89,1.0,v89
v_mfma_f32_16x16x32_bf16 v[68:71],a[36:39],v[228:231],v[68:71]
v_add_f32 v90,1.0,v90
v_add_f32 v91,1.0,v91
v_mfma_f32_16x16x32_bf16 v[76:79],a[164:167],v[228:231],v[76:79]
ds_read_b128 v[224:227],v17 offset:53248
s_waitcnt lgkmcnt(5)
v_mfma_f32_16x16x32_bf16 v[68:71],a[40:43],v[232:235],v[68:71]
v_min3_u32 v27,v27,v232,v236
v_mfma_f32_16x16x32_bf16 v[76:79],a[168:171],v[232:235],v[76:79]
ds_read_b128 v[228:231],v43 offset:53248
v_mfma_f32_16x16x32_bf16 v[68:71],a[44:47],v[236:239],v[68:71]
v_rcp_f32 v88,v88
v_mfma_f32_16x16x32_bf16 v[76:79],a[172:175],v[236:239],v[76:79]
ds_read_b128 v[232:235],v17 offset:61440
s_waitcnt lgkmcnt(5)
v_mfma_f32_16x16x32_bf16 v[68:71],a[96:99],v[240:243],v[68:71]
v_min3_u32 v27,v27,v240,v244
v_mfma_f32_16x16x32_bf16 v[76:79],a[224:227],v[240:243],v[76:79]
ds_read_b128 v[236:239],v43 offset:61440
v_mfma_f32_16x16x32_bf16 v[68:71],a[100:103],v[244:247],v[68:71]
v_rcp_f32 v89,v89
v_mfma_f32_16x16x32_bf16 v[76:79],a[228:231],v[244:247],v[76:79]
ds_read_b128 v[240:243],v17 offset:54272
s_waitcnt lgkmcnt(5)
v_mfma_f32_16x16x32_bf16 v[68:71],a[104:107],v[248:251],v[68:71]
v_min3_u32 v27,v27,v248,v252
v_mfma_f32_16x16x32_bf16 v[76:79],a[232:235],v[248:251],v[76:79]
ds_read_b128 v[244:247],v43 offset:54272
v_mfma_f32_16x16x32_bf16 v[68:71],a[108:111],v[252:255],v[68:71]
v_rcp_f32 v90,v90
v_mfma_f32_16x16x32_bf16 v[76:79],a[236:239],v[252:255],v[76:79]
ds_read_b128 v[248:251],v17 offset:62464
s_waitcnt lgkmcnt(5)
v_mfma_f32_16x16x32_bf16 v[68:71],a[48:51],v[224:227],v[68:71]
v_min3_u32 v27,v27,v224,v228
v_mfma_f32_16x16x32_bf16 v[76:79],a[176:179],v[224:227],v[76:79]
ds_read_b128 v[252:255],v43 offset:62464
v_mfma_f32_16x16x32_bf16 v[68:71],a[52:55],v[228:231],v[68:71]
v_rcp_f32 v91,v91
v_mfma_f32_16x16x32_bf16 v[76:79],a[180:183],v[228:231],v[76:79]
v_mul_f32 v88,v88,v64
s_waitcnt lgkmcnt(4)
v_mfma_f32_16x16x32_bf16 v[68:71],a[56:59],v[232:235],v[68:71]
v_min3_u32 v27,v27,v232,v236
v_mul_f32 v89,v89,v65
v_mfma_f32_16x16x32_bf16 v[76:79],a[184:187],v[232:235],v[76:79]
v_mul_f32 v90,v90,v66
v_mul_f32 v91,v91,v67
v_mfma_f32_16x16x32_bf16 v[68:71],a[60:63],v[236:239],v[68:71]
v_rcp_f32 v95,v95
v_mfma_f32_16x16x32_bf16 v[76:79],a[188:191],v[236:239],v[76:79]
v_mul_f32 v92,v92,v72
s_waitcnt lgkmcnt(2)
v_mfma_f32_16x16x32_bf16 v[68:71],a[112:115],v[240:243],v[68:71]
v_min3_u32 v27,v27,v240,v244
v_mul_f32 v93,v93,v73
v_mfma_f32_16x16x32_bf16 v[76:79],a[240:243],v[240:243],v[76:79]
v_mul_f32 v94,v94,v74
v_mul_f32 v95,v95,v75
v_mfma_f32_16x16x32_bf16 v[68:71],a[116:119],v[244:247],v[68:71]
v_cvt_pk_bf16_f32 v96,v88,v89
v_cvt_pk_bf16_f32 v97,v90,v91
v_mfma_f32_16x16x32_bf16 v[76:79],a[244:247],v[244:247],v[76:79]
v_cvt_pk_bf16_f32 v98,v92,v93
s_waitcnt lgkmcnt(0)
v_mfma_f32_16x16x32_bf16 v[68:71],a[120:123],v[248:251],v[68:71]
v_min3_u32 v27,v27,v248,v252
v_cvt_pk_bf16_f32 v99,v94,v95
v_mfma_f32_16x16x32_bf16 v[76:79],a[248:251],v[248:251],v[76:79]
v_max_u32 v96,1,v96
v_mfma_f32_16x16x32_bf16 v[68:71],a[124:127],v[252:255],v[68:71]
buffer_store_dwordx4 v[96:99],v18,s[20:23],s78 offen sc1
v_mfma_f32_16x16x32_bf16 v[76:79],a[252:255],v[252:255],v[76:79]
v_cmp_eq_u32 vcc,0,v27
s_cbranch_vccnz retry_222
s_branch epi_225
both_226:
s_waitcnt vmcnt(13) lgkmcnt(0)
s_barrier
ds_read_b128 v[224:227],v17 offset:0
ds_read_b128 v[228:231],v43 offset:0
ds_read_b128 v[232:235],v17 offset:8192
ds_read_b128 v[236:239],v43 offset:8192
ds_read_b128 v[240:243],v17 offset:1024
ds_read_b128 v[244:247],v43 offset:1024
ds_read_b128 v[248:251],v17 offset:9216
s_waitcnt lgkmcnt(5)
v_mfma_f32_16x16x32_bf16 v[64:67],a[0:3],v[224:227],0
s_add_u32 s96,s71,1
s_add_u32 s92,s71,2
v_min_u32 v27,v224,v228
v_mfma_f32_16x16x32_bf16 v[72:75],a[128:131],v[224:227],0
ds_read_b128 v[252:255],v43 offset:9216
s_add_u32 s88,s70,s75
v_mfma_f32_16x16x32_bf16 v[64:67],a[4:7],v[228:231],v[64:67]
s_add_u32 s88,s88,2097152
s_xor_b32 s88,s88,0x2000
v_mfma_f32_16x16x32_bf16 v[72:75],a[132:135],v[228:231],v[72:75]
ds_read_b128 v[224:227],v17 offset:16384
s_waitcnt lgkmcnt(5)
v_mfma_f32_16x16x32_bf16 v[64:67],a[8:11],v[232:235],v[64:67]
s_add_u32 s89,s88,65536
v_min3_u32 v27,v27,v232,v236
v_mfma_f32_16x16x32_bf16 v[72:75],a[136:139],v[232:235],v[72:75]
ds_read_b128 v[228:231],v43 offset:16384
v_mfma_f32_16x16x32_bf16 v[64:67],a[12:15],v[236:239],v[64:67]
s_xor_b32 m0,s72,0
v_mfma_f32_16x16x32_bf16 v[72:75],a[140:143],v[236:239],v[72:75]
ds_read_b128 v[232:235],v17 offset:24576
s_add_u32 s65,s88,0
s_waitcnt lgkmcnt(5)
v_mfma_f32_16x16x32_bf16 v[64:67],a[64:67],v[240:243],v[64:67]
v_min3_u32 v27,v27,v240,v244
v_mfma_f32_16x16x32_bf16 v[72:75],a[192:195],v[240:243],v[72:75]
ds_read_b128 v[236:239],v43 offset:24576
buffer_load_dwordx4 v42,s[20:23],s65 offen offset:0 sc1 lds
v_mfma_f32_16x16x32_bf16 v[64:67],a[68:71],v[244:247],v[64:67]
buffer_load_dwordx4 v42,s[20:23],s65 offen offset:1024 sc1 lds
v_mfma_f32_16x16x32_bf16 v[72:75],a[196:199],v[244:247],v[72:75]
ds_read_b128 v[240:243],v17 offset:17408
s_waitcnt lgkmcnt(5)
v_mfma_f32_16x16x32_bf16 v[64:67],a[72:75],v[248:251],v[64:67]
s_xor_b32 m0,s72,16384
v_min3_u32 v27,v27,v248,v252
v_mfma_f32_16x16x32_bf16 v[72:75],a[200:203],v[248:251],v[72:75]
ds_read_b128 v[244:247],v43 offset:17408
v_mfma_f32_16x16x32_bf16 v[64:67],a[76:79],v[252:255],v[64:67]
s_add_u32 s65,s88,256
v_mfma_f32_16x16x32_bf16 v[72:75],a[204:207],v[252:255],v[72:75]
ds_read_b128 v[248:251],v17 offset:25600
s_waitcnt lgkmcnt(5)
v_mfma_f32_16x16x32_bf16 v[64:67],a[16:19],v[224:227],v[64:67]
buffer_load_dwordx4 v42,s[20:23],s65 offen offset:0 sc1 lds
v_mfma_f32_16x16x32_bf16 v[72:75],a[144:147],v[224:227],v[72:75]
ds_read_b128 v[252:255],v43 offset:25600
buffer_load_dwordx4 v42,s[20:23],s65 offen offset:1024 sc1 lds
v_mfma_f32_16x16x32_bf16 v[64:67],a[20:23],v[228:231],v[64:67]
v_min3_u32 v27,v27,v224,v228
v_mfma_f32_16x16x32_bf16 v[72:75],a[148:151],v[228:231],v[72:75]
ds_read_b128 v[224:227],v17 offset:32768
s_xor_b32 m0,s72,32768
s_waitcnt lgkmcnt(5)
v_mfma_f32_16x16x32_bf16 v[64:67],a[24:27],v[232:235],v[64:67]
s_add_u32 s65,s88,512
v_min3_u32 v27,v27,v232,v236
v_mfma_f32_16x16x32_bf16 v[72:75],a[152:155],v[232:235],v[72:75]
ds_read_b128 v[228:231],v43 offset:32768
v_mfma_f32_16x16x32_bf16 v[64:67],a[28:31],v[236:239],v[64:67]
buffer_load_dwordx4 v42,s[20:23],s65 offen offset:0 sc1 lds
v_mfma_f32_16x16x32_bf16 v[72:75],a[156:159],v[236:239],v[72:75]
ds_read_b128 v[232:235],v17 offset:40960
s_waitcnt lgkmcnt(5)
v_mfma_f32_16x16x32_bf16 v[64:67],a[80:83],v[240:243],v[64:67]
buffer_load_dwordx4 v42,s[20:23],s65 offen offset:1024 sc1 lds
v_mfma_f32_16x16x32_bf16 v[72:75],a[208:211],v[240:243],v[72:75]
ds_read_b128 v[236:239],v43 offset:40960
s_xor_b32 m0,s72,49152
v_mfma_f32_16x16x32_bf16 v[64:67],a[84:87],v[244:247],v[64:67]
v_min3_u32 v27,v27,v240,v244
v_mfma_f32_16x16x32_bf16 v[72:75],a[212:215],v[244:247],v[72:75]
ds_read_b128 v[240:243],v17 offset:33792
s_add_u32 s65,s88,768
s_waitcnt lgkmcnt(5)
v_mfma_f32_16x16x32_bf16 v[64:67],a[88:91],v[248:251],v[64:67]
buffer_load_dwordx4 v42,s[20:23],s65 offen offset:0 sc1 lds
v_min3_u32 v27,v27,v248,v252
v_mfma_f32_16x16x32_bf16 v[72:75],a[216:219],v[248:251],v[72:75]
ds_read_b128 v[244:247],v43 offset:33792
s_waitcnt vmcnt(10)
v_mfma_f32_16x16x32_bf16 v[64:67],a[92:95],v[252:255],v[64:67]
v_cmp_gt_u32 vcc,s96,v29
v_cmp_gt_u32 s[92:93],s92,v29
v_mfma_f32_16x16x32_bf16 v[72:75],a[220:223],v[252:255],v[72:75]
ds_read_b128 v[248:251],v17 offset:41984
s_waitcnt lgkmcnt(5)
v_mfma_f32_16x16x32_bf16 v[64:67],a[32:35],v[224:227],v[64:67]
v_mov_b32 v44,vcc_lo
v_mov_b32 v45,s92
v_min3_u32 v27,v27,v224,v228
v_mfma_f32_16x16x32_bf16 v[72:75],a[160:163],v[224:227],v[72:75]
ds_read_b128 v[252:255],v43 offset:41984
ds_write_b64 v46,v[44:45]
v_mfma_f32_16x16x32_bf16 v[64:67],a[36:39],v[228:231],v[64:67]
buffer_load_dwordx4 v42,s[20:23],s65 offen offset:1024 sc1 lds
v_mfma_f32_16x16x32_bf16 v[72:75],a[164:167],v[228:231],v[72:75]
ds_read_b128 v[224:227],v17 offset:49152
s_waitcnt lgkmcnt(6)
v_mfma_f32_16x16x32_bf16 v[64:67],a[40:43],v[232:235],v[64:67]
s_xor_b32 m0,s72,4096
s_add_u32 s65,s89,0
v_mfma_f32_16x16x32_bf16 v[72:75],a[168:171],v[232:235],v[72:75]
ds_read_b128 v[228:231],v43 offset:49152
v_min3_u32 v27,v27,v232,v236
v_mfma_f32_16x16x32_bf16 v[64:67],a[44:47],v[236:239],v[64:67]
buffer_load_dwordx4 v42,s[20:23],s65 offen offset:0 sc1 lds
v_mfma_f32_16x16x32_bf16 v[72:75],a[172:175],v[236:239],v[72:75]
ds_read_b128 v[232:235],v17 offset:57344
s_waitcnt lgkmcnt(6)
v_mfma_f32_16x16x32_bf16 v[64:67],a[96:99],v[240:243],v[64:67]
buffer_load_dwordx4 v42,s[20:23],s65 offen offset:1024 sc1 lds
v_mfma_f32_16x16x32_bf16 v[72:75],a[224:227],v[240:243],v[72:75]
ds_read_b128 v[236:239],v43 offset:57344
s_xor_b32 m0,s72,20480
v_mfma_f32_16x16x32_bf16 v[64:67],a[100:103],v[244:247],v[64:67]
s_add_u32 s65,s89,256
v_min3_u32 v27,v27,v240,v244
v_mfma_f32_16x16x32_bf16 v[72:75],a[228:231],v[244:247],v[72:75]
ds_read_b128 v[240:243],v17 offset:50176
s_waitcnt lgkmcnt(6)
v_mfma_f32_16x16x32_bf16 v[64:67],a[104:107],v[248:251],v[64:67]
buffer_load_dwordx4 v42,s[20:23],s65 offen offset:0 sc1 lds
v_mfma_f32_16x16x32_bf16 v[72:75],a[232:235],v[248:251],v[72:75]
ds_read_b128 v[244:247],v43 offset:50176
v_min3_u32 v27,v27,v248,v252
v_mfma_f32_16x16x32_bf16 v[64:67],a[108:111],v[252:255],v[64:67]
buffer_load_dwordx4 v42,s[20:23],s65 offen offset:1024 sc1 lds
v_mfma_f32_16x16x32_bf16 v[72:75],a[236:239],v[252:255],v[72:75]
ds_read_b128 v[248:251],v17 offset:58368
s_waitcnt lgkmcnt(5)
v_mfma_f32_16x16x32_bf16 v[64:67],a[48:51],v[224:227],v[64:67]
s_xor_b32 m0,s72,36864
s_add_u32 s65,s89,512
v_mfma_f32_16x16x32_bf16 v[72:75],a[176:179],v[224:227],v[72:75]
ds_read_b128 v[252:255],v43 offset:58368
v_min3_u32 v27,v27,v224,v228
v_mfma_f32_16x16x32_bf16 v[64:67],a[52:55],v[228:231],v[64:67]
buffer_load_dwordx4 v42,s[20:23],s65 offen offset:0 sc1 lds
s_waitcnt vmcnt(13)
v_add_u32 v22,s71,-1
v_mfma_f32_16x16x32_bf16 v[72:75],a[180:183],v[228:231],v[72:75]
s_waitcnt vmcnt(18)
s_barrier
ds_read_b64 v[44:45],v47
ds_read_b128 v[224:227],v17 offset:4096
s_waitcnt lgkmcnt(6)
v_mfma_f32_16x16x32_bf16 v[64:67],a[56:59],v[232:235],v[64:67]
buffer_load_dwordx4 v42,s[20:23],s65 offen offset:1024 sc1 lds
buffer_store_dword v22,v23,s[24:27],s97 offen
v_mfma_f32_16x16x32_bf16 v[72:75],a[184:187],v[232:235],v[72:75]
ds_read_b128 v[228:231],v43 offset:4096
s_xor_b32 m0,s72,53248
buffer_store_dword v22,v23,s[28:31],s97 offen sc1
v_mfma_f32_16x16x32_bf16 v[64:67],a[60:63],v[236:239],v[64:67]
s_add_u32 s65,s89,768
v_min3_u32 v27,v27,v232,v236
s_mov_b32 s97,0x7fff0000
v_mfma_f32_16x16x32_bf16 v[72:75],a[188:191],v[236:239],v[72:75]
ds_read_b128 v[232:235],v17 offset:12288
s_waitcnt lgkmcnt(6)
v_mfma_f32_16x16x32_bf16 v[64:67],a[112:115],v[240:243],v[64:67]
buffer_load_dwordx4 v42,s[20:23],s65 offen offset:0 sc1 lds
v_mfma_f32_16x16x32_bf16 v[72:75],a[240:243],v[240:243],v[72:75]
ds_read_b128 v[236:239],v43 offset:12288
v_min3_u32 v27,v27,v240,v244
v_mfma_f32_16x16x32_bf16 v[64:67],a[116:119],v[244:247],v[64:67]
buffer_load_dwordx4 v42,s[20:23],s65 offen offset:1024 sc1 lds
v_mfma_f32_16x16x32_bf16 v[72:75],a[244:247],v[244:247],v[72:75]
ds_read_b128 v[240:243],v17 offset:5120
s_waitcnt lgkmcnt(6)
v_mfma_f32_16x16x32_bf16 v[64:67],a[120:123],v[248:251],v[64:67]
s_waitcnt lgkmcnt(5)
v_readfirstlane_b32 s93,v45
v_mfma_f32_16x16x32_bf16 v[72:75],a[248:251],v[248:251],v[72:75]
ds_read_b128 v[244:247],v43 offset:5120
v_min3_u32 v27,v27,v248,v252
v_mfma_f32_16x16x32_bf16 v[64:67],a[124:127],v[252:255],v[64:67]
v_mfma_f32_16x16x32_bf16 v[72:75],a[252:255],v[252:255],v[72:75]
ds_read_b128 v[248:251],v17 offset:13312
s_waitcnt lgkmcnt(5)
v_mfma_f32_16x16x32_bf16 v[68:71],a[0:3],v[224:227],0
v_cmp_eq_u32 vcc,0,v27
s_cbranch_vccnz retry_222
v_mfma_f32_16x16x32_bf16 v[76:79],a[128:131],v[224:227],0
ds_read_b128 v[252:255],v43 offset:13312
v_min3_u32 v27,v27,v224,v228
v_mfma_f32_16x16x32_bf16 v[68:71],a[4:7],v[228:231],v[68:71]
v_mfma_f32_16x16x32_bf16 v[76:79],a[132:135],v[228:231],v[76:79]
ds_read_b128 v[224:227],v17 offset:20480
s_waitcnt lgkmcnt(5)
v_mfma_f32_16x16x32_bf16 v[68:71],a[8:11],v[232:235],v[68:71]
v_min3_u32 v27,v27,v232,v236
v_mul_f32 v88,v64,v64
v_mul_f32 v92,v72,v72
v_mfma_f32_16x16x32_bf16 v[76:79],a[136:139],v[232:235],v[76:79]
ds_read_b128 v[228:231],v43 offset:20480
v_mul_f32 v89,v65,v65
v_mul_f32 v93,v73,v73
v_mfma_f32_16x16x32_bf16 v[68:71],a[12:15],v[236:239],v[68:71]
v_mul_f32 v90,v66,v66
v_mul_f32 v91,v67,v67
v_mul_f32 v94,v74,v74
v_mfma_f32_16x16x32_bf16 v[76:79],a[140:143],v[236:239],v[76:79]
ds_read_b128 v[232:235],v17 offset:28672
v_mul_f32 v95,v75,v75
s_waitcnt lgkmcnt(5)
v_mfma_f32_16x16x32_bf16 v[68:71],a[64:67],v[240:243],v[68:71]
v_min3_u32 v27,v27,v240,v244
v_fma_f32 v88,v88,s81,v28
v_fma_f32 v92,v92,s81,v28
v_mfma_f32_16x16x32_bf16 v[76:79],a[192:195],v[240:243],v[76:79]
ds_read_b128 v[236:239],v43 offset:28672
v_fma_f32 v89,v89,s81,v28
v_fma_f32 v93,v93,s81,v28
v_mfma_f32_16x16x32_bf16 v[68:71],a[68:71],v[244:247],v[68:71]
v_fma_f32 v90,v90,s81,v28
v_fma_f32 v91,v91,s81,v28
v_fma_f32 v94,v94,s81,v28
v_mfma_f32_16x16x32_bf16 v[76:79],a[196:199],v[244:247],v[76:79]
ds_read_b128 v[240:243],v17 offset:21504
v_fma_f32 v95,v95,s81,v28
s_waitcnt lgkmcnt(5)
v_mfma_f32_16x16x32_bf16 v[68:71],a[72:75],v[248:251],v[68:71]
v_min3_u32 v27,v27,v248,v252
v_mul_f32 v88,v88,v64
v_mul_f32 v92,v92,v72
v_mfma_f32_16x16x32_bf16 v[76:79],a[200:203],v[248:251],v[76:79]
ds_read_b128 v[244:247],v43 offset:21504
v_mul_f32 v89,v89,v65
v_mul_f32 v93,v93,v73
v_mfma_f32_16x16x32_bf16 v[68:71],a[76:79],v[252:255],v[68:71]
v_mul_f32 v90,v90,v66
v_mul_f32 v91,v91,v67
v_mul_f32 v94,v94,v74
v_mfma_f32_16x16x32_bf16 v[76:79],a[204:207],v[252:255],v[76:79]
ds_read_b128 v[248:251],v17 offset:29696
v_mul_f32 v95,v95,v75
s_waitcnt lgkmcnt(5)
v_mfma_f32_16x16x32_bf16 v[68:71],a[16:19],v[224:227],v[68:71]
v_min3_u32 v27,v27,v224,v228
v_exp_f32 v92,v92
v_mfma_f32_16x16x32_bf16 v[76:79],a[144:147],v[224:227],v[76:79]
ds_read_b128 v[252:255],v43 offset:29696
v_exp_f32 v93,v93
v_mfma_f32_16x16x32_bf16 v[68:71],a[20:23],v[228:231],v[68:71]
v_exp_f32 v88,v88
v_mfma_f32_16x16x32_bf16 v[76:79],a[148:151],v[228:231],v[76:79]
ds_read_b128 v[224:227],v17 offset:36864
s_waitcnt lgkmcnt(5)
v_mfma_f32_16x16x32_bf16 v[68:71],a[24:27],v[232:235],v[68:71]
v_min3_u32 v27,v27,v232,v236
v_exp_f32 v94,v94
v_mfma_f32_16x16x32_bf16 v[76:79],a[152:155],v[232:235],v[76:79]
ds_read_b128 v[228:231],v43 offset:36864
v_exp_f32 v95,v95
v_mfma_f32_16x16x32_bf16 v[68:71],a[28:31],v[236:239],v[68:71]
v_exp_f32 v89,v89
v_add_f32 v92,1.0,v92
v_mfma_f32_16x16x32_bf16 v[76:79],a[156:159],v[236:239],v[76:79]
ds_read_b128 v[232:235],v17 offset:45056
v_add_f32 v93,1.0,v93
s_waitcnt lgkmcnt(5)
v_mfma_f32_16x16x32_bf16 v[68:71],a[80:83],v[240:243],v[68:71]
v_min3_u32 v27,v27,v240,v244
v_add_f32 v94,1.0,v94
v_add_f32 v95,1.0,v95
v_mfma_f32_16x16x32_bf16 v[76:79],a[208:211],v[240:243],v[76:79]
ds_read_b128 v[236:239],v43 offset:45056
v_rcp_f32 v92,v92
v_mfma_f32_16x16x32_bf16 v[68:71],a[84:87],v[244:247],v[68:71]
v_exp_f32 v90,v90
v_mfma_f32_16x16x32_bf16 v[76:79],a[212:215],v[244:247],v[76:79]
ds_read_b128 v[240:243],v17 offset:37888
s_waitcnt lgkmcnt(5)
v_mfma_f32_16x16x32_bf16 v[68:71],a[88:91],v[248:251],v[68:71]
v_min3_u32 v27,v27,v248,v252
v_rcp_f32 v93,v93
v_mfma_f32_16x16x32_bf16 v[76:79],a[216:219],v[248:251],v[76:79]
ds_read_b128 v[244:247],v43 offset:37888
v_rcp_f32 v94,v94
v_mfma_f32_16x16x32_bf16 v[68:71],a[92:95],v[252:255],v[68:71]
v_exp_f32 v91,v91
v_mfma_f32_16x16x32_bf16 v[76:79],a[220:223],v[252:255],v[76:79]
ds_read_b128 v[248:251],v17 offset:46080
s_waitcnt lgkmcnt(5)
v_mfma_f32_16x16x32_bf16 v[68:71],a[32:35],v[224:227],v[68:71]
v_min3_u32 v27,v27,v224,v228
v_add_f32 v88,1.0,v88
v_mfma_f32_16x16x32_bf16 v[76:79],a[160:163],v[224:227],v[76:79]
ds_read_b128 v[252:255],v43 offset:46080
v_add_f32 v89,1.0,v89
v_mfma_f32_16x16x32_bf16 v[68:71],a[36:39],v[228:231],v[68:71]
v_add_f32 v90,1.0,v90
v_add_f32 v91,1.0,v91
v_mfma_f32_16x16x32_bf16 v[76:79],a[164:167],v[228:231],v[76:79]
ds_read_b128 v[224:227],v17 offset:53248
s_waitcnt lgkmcnt(5)
v_mfma_f32_16x16x32_bf16 v[68:71],a[40:43],v[232:235],v[68:71]
v_min3_u32 v27,v27,v232,v236
v_mfma_f32_16x16x32_bf16 v[76:79],a[168:171],v[232:235],v[76:79]
ds_read_b128 v[228:231],v43 offset:53248
v_mfma_f32_16x16x32_bf16 v[68:71],a[44:47],v[236:239],v[68:71]
v_rcp_f32 v88,v88
v_mfma_f32_16x16x32_bf16 v[76:79],a[172:175],v[236:239],v[76:79]
ds_read_b128 v[232:235],v17 offset:61440
s_waitcnt lgkmcnt(5)
v_mfma_f32_16x16x32_bf16 v[68:71],a[96:99],v[240:243],v[68:71]
v_min3_u32 v27,v27,v240,v244
v_mfma_f32_16x16x32_bf16 v[76:79],a[224:227],v[240:243],v[76:79]
ds_read_b128 v[236:239],v43 offset:61440
v_mfma_f32_16x16x32_bf16 v[68:71],a[100:103],v[244:247],v[68:71]
v_rcp_f32 v89,v89
v_mfma_f32_16x16x32_bf16 v[76:79],a[228:231],v[244:247],v[76:79]
ds_read_b128 v[240:243],v17 offset:54272
s_waitcnt lgkmcnt(5)
v_mfma_f32_16x16x32_bf16 v[68:71],a[104:107],v[248:251],v[68:71]
v_min3_u32 v27,v27,v248,v252
v_mfma_f32_16x16x32_bf16 v[76:79],a[232:235],v[248:251],v[76:79]
ds_read_b128 v[244:247],v43 offset:54272
v_mfma_f32_16x16x32_bf16 v[68:71],a[108:111],v[252:255],v[68:71]
v_rcp_f32 v90,v90
v_mfma_f32_16x16x32_bf16 v[76:79],a[236:239],v[252:255],v[76:79]
ds_read_b128 v[248:251],v17 offset:62464
s_waitcnt lgkmcnt(5)
v_mfma_f32_16x16x32_bf16 v[68:71],a[48:51],v[224:227],v[68:71]
v_min3_u32 v27,v27,v224,v228
v_mfma_f32_16x16x32_bf16 v[76:79],a[176:179],v[224:227],v[76:79]
ds_read_b128 v[252:255],v43 offset:62464
v_mfma_f32_16x16x32_bf16 v[68:71],a[52:55],v[228:231],v[68:71]
v_rcp_f32 v91,v91
v_mfma_f32_16x16x32_bf16 v[76:79],a[180:183],v[228:231],v[76:79]
v_mul_f32 v88,v88,v64
s_waitcnt lgkmcnt(4)
v_mfma_f32_16x16x32_bf16 v[68:71],a[56:59],v[232:235],v[68:71]
v_min3_u32 v27,v27,v232,v236
v_mul_f32 v89,v89,v65
v_mfma_f32_16x16x32_bf16 v[76:79],a[184:187],v[232:235],v[76:79]
v_mul_f32 v90,v90,v66
v_mul_f32 v91,v91,v67
v_mfma_f32_16x16x32_bf16 v[68:71],a[60:63],v[236:239],v[68:71]
v_rcp_f32 v95,v95
v_mfma_f32_16x16x32_bf16 v[76:79],a[188:191],v[236:239],v[76:79]
v_mul_f32 v92,v92,v72
s_waitcnt lgkmcnt(2)
v_mfma_f32_16x16x32_bf16 v[68:71],a[112:115],v[240:243],v[68:71]
v_min3_u32 v27,v27,v240,v244
v_mul_f32 v93,v93,v73
v_mfma_f32_16x16x32_bf16 v[76:79],a[240:243],v[240:243],v[76:79]
v_mul_f32 v94,v94,v74
v_mul_f32 v95,v95,v75
v_mfma_f32_16x16x32_bf16 v[68:71],a[116:119],v[244:247],v[68:71]
v_cvt_pk_bf16_f32 v96,v88,v89
v_cvt_pk_bf16_f32 v97,v90,v91
v_mfma_f32_16x16x32_bf16 v[76:79],a[244:247],v[244:247],v[76:79]
v_cvt_pk_bf16_f32 v98,v92,v93
s_waitcnt lgkmcnt(0)
v_mfma_f32_16x16x32_bf16 v[68:71],a[120:123],v[248:251],v[68:71]
v_min3_u32 v27,v27,v248,v252
v_cvt_pk_bf16_f32 v99,v94,v95
v_mfma_f32_16x16x32_bf16 v[76:79],a[248:251],v[248:251],v[76:79]
v_max_u32 v96,1,v96
v_mfma_f32_16x16x32_bf16 v[68:71],a[124:127],v[252:255],v[68:71]
buffer_store_dwordx4 v[96:99],v18,s[20:23],s78 offen sc1
v_mfma_f32_16x16x32_bf16 v[76:79],a[252:255],v[252:255],v[76:79]
v_cmp_eq_u32 vcc,0,v27
s_cbranch_vccnz retry_222
epi_225:
buffer_load_dword v29,v21,s[20:23],s87 offen sc1
s_cmp_gt_u32 s71,44
s_cselect_b32 s65,s73,0x7fff0000
s_cselect_b32 s97,0x7fff0000,s73
v_mov_b32 v22,s71
buffer_store_dword v22,v23,s[24:27],s65 offen
buffer_store_dword v22,v23,s[28:31],s65 offen sc1
v_pk_mul_f32 v[88:89],v[68:69],v[68:69]
v_pk_mul_f32 v[90:91],v[70:71],v[70:71]
v_pk_mul_f32 v[92:93],v[76:77],v[76:77]
v_pk_mul_f32 v[94:95],v[78:79],v[78:79]
v_pk_fma_f32 v[88:89],v[88:89],s[80:81],v[28:29] op_sel:[0,1,0] op_sel_hi:[1,1,0]
v_pk_fma_f32 v[90:91],v[90:91],s[80:81],v[28:29] op_sel:[0,1,0] op_sel_hi:[1,1,0]
v_pk_fma_f32 v[92:93],v[92:93],s[80:81],v[28:29] op_sel:[0,1,0] op_sel_hi:[1,1,0]
v_pk_fma_f32 v[94:95],v[94:95],s[80:81],v[28:29] op_sel:[0,1,0] op_sel_hi:[1,1,0]
v_pk_mul_f32 v[88:89],v[88:89],v[68:69]
v_pk_mul_f32 v[90:91],v[90:91],v[70:71]
v_pk_mul_f32 v[92:93],v[92:93],v[76:77]
v_pk_mul_f32 v[94:95],v[94:95],v[78:79]
v_exp_f32 v88,v88
v_exp_f32 v89,v89
v_exp_f32 v90,v90
v_exp_f32 v91,v91
v_exp_f32 v92,v92
v_exp_f32 v93,v93
v_exp_f32 v94,v94
v_exp_f32 v95,v95
v_pk_add_f32 v[88:89],v[88:89],1.0 op_sel_hi:[1,0]
v_pk_add_f32 v[90:91],v[90:91],1.0 op_sel_hi:[1,0]
v_pk_add_f32 v[92:93],v[92:93],1.0 op_sel_hi:[1,0]
v_pk_add_f32 v[94:95],v[94:95],1.0 op_sel_hi:[1,0]
v_rcp_f32 v88,v88
v_rcp_f32 v89,v89
v_rcp_f32 v90,v90
v_rcp_f32 v91,v91
v_rcp_f32 v92,v92
v_rcp_f32 v93,v93
v_rcp_f32 v94,v94
v_rcp_f32 v95,v95
v_pk_mul_f32 v[88:89],v[88:89],v[68:69]
v_pk_mul_f32 v[90:91],v[90:91],v[70:71]
v_pk_mul_f32 v[92:93],v[92:93],v[76:77]
v_pk_mul_f32 v[94:95],v[94:95],v[78:79]
v_cvt_pk_bf16_f32 v96,v88,v89
v_cvt_pk_bf16_f32 v97,v90,v91
v_cvt_pk_bf16_f32 v98,v92,v93
v_cvt_pk_bf16_f32 v99,v94,v95
v_max_u32 v96,1,v96
buffer_store_dwordx4 v[96:99],v19,s[20:23],s78 offen sc1
v_xor_b32 v18,0x2000,v18
v_xor_b32 v19,0x2000,v19
s_add_u32 s78,s78,2097152
next_232:
v_xor_b32 v43,0x10000,v43
v_xor_b32 v17,0x10000,v17
s_xor_b32 s72,s72,0x10000
s_add_u32 s70,s70,2097152
s_xor_b32 s70,s70,0x2000
s_add_u32 s71,s71,1
s_cmp_le_u32 s71,64
s_cbranch_scc1 seg_223
s_add_u32 s65,s73,2560
v_add_u32 v22,s71,-1
buffer_store_dword v22,v23,s[20:23],s65 offen sc1
s_endpgm
retry_222:
s_sub_u32 s90,s90,64
s_cmp_lt_i32 s90,0
s_cbranch_scc1 giveup_197
s_mov_b32 s83,1
s_waitcnt vmcnt(0) lgkmcnt(0)
s_barrier
s_branch seg_223
r_w2_217:
s_load_dwordx2 s[4:5],s[0:1],72
s_and_b32 s41,s59,7
s_lshl_b32 s66,s41,8
s_lshl_b32 s67,s50,1
s_waitcnt lgkmcnt(0)
s_mov_b32 s32,s4
s_and_b32 s33,s5,0xffff
s_mov_b32 s34,0x200000
s_mov_b32 s35,0x20000
v_lshrrev_b32 v5,2,v3
v_lshl_add_u32 v5,v4,2,v5
v_and_b32 v6,3,v3
v_lshlrev_b32 v6,3,v6
v_lshl_add_u32 v6,v5,8,v6
v_and_b32 v5,7,v5
v_xor_b32 v5,s67,v5
v_lshl_add_u32 v12,v5,5,v6
v_xor_b32 v13,32,v12
v_and_b32 v5,15,v1
v_and_b32 v6,3,v4
v_lshlrev_b32 v6,1,v6
v_xor_b32 v5,v5,v6
v_mul_u32_u24 v6,2048,v4
v_xor_b32 v7,0,v5
v_lshl_add_u32 v8,v7,4,v6
v_xor_b32 v7,8,v5
v_lshl_add_u32 v9,v7,4,v6
s_mul_i32 s74,s50,131072
s_add_u32 s74,s74,s66
s_lshl_b32 s75,s50,14
s_mul_i32 s76,s50,65536
s_add_u32 s76,s76,s66
s_lshl_b32 s77,s50,13
s_add_u32 s64,s74,0
s_add_u32 m0,s75,0
s_nop 0
buffer_load_dwordx4 v8,s[32:35],s64 offen nt lds
s_add_u32 s64,s74,8192
s_add_u32 m0,s75,1024
s_nop 0
buffer_load_dwordx4 v9,s[32:35],s64 offen nt lds
s_add_u32 s64,s74,16384
s_add_u32 m0,s75,2048
s_nop 0
buffer_load_dwordx4 v8,s[32:35],s64 offen nt lds
s_add_u32 s64,s74,24576
s_add_u32 m0,s75,3072
s_nop 0
buffer_load_dwordx4 v9,s[32:35],s64 offen nt lds
s_add_u32 s64,s74,32768
s_add_u32 m0,s75,4096
s_nop 0
buffer_load_dwordx4 v8,s[32:35],s64 offen nt lds
s_add_u32 s64,s74,40960
s_add_u32 m0,s75,5120
s_nop 0
buffer_load_dwordx4 v9,s[32:35],s64 offen nt lds
s_add_u32 s64,s74,49152
s_add_u32 m0,s75,6144
s_nop 0
buffer_load_dwordx4 v8,s[32:35],s64 offen nt lds
s_add_u32 s64,s74,57344
s_add_u32 m0,s75,7168
s_nop 0
buffer_load_dwordx4 v9,s[32:35],s64 offen nt lds
s_add_u32 s64,s74,65536
s_add_u32 m0,s75,8192
s_nop 0
buffer_load_dwordx4 v8,s[32:35],s64 offen nt lds
s_add_u32 s64,s74,73728
s_add_u32 m0,s75,9216
s_nop 0
buffer_load_dwordx4 v9,s[32:35],s64 offen nt lds
s_add_u32 s64,s74,81920
s_add_u32 m0,s75,10240
s_nop 0
buffer_load_dwordx4 v8,s[32:35],s64 offen nt lds
s_add_u32 s64,s74,90112
s_add_u32 m0,s75,11264
s_nop 0
buffer_load_dwordx4 v9,s[32:35],s64 offen nt lds
s_add_u32 s64,s74,98304
s_add_u32 m0,s75,12288
s_nop 0
buffer_load_dwordx4 v8,s[32:35],s64 offen nt lds
s_add_u32 s64,s74,106496
s_add_u32 m0,s75,13312
s_nop 0
buffer_load_dwordx4 v9,s[32:35],s64 offen nt lds
s_add_u32 s64,s74,114688
s_add_u32 m0,s75,14336
s_nop 0
buffer_load_dwordx4 v8,s[32:35],s64 offen nt lds
s_add_u32 s64,s74,122880
s_add_u32 m0,s75,15360
s_nop 0
buffer_load_dwordx4 v9,s[32:35],s64 offen nt lds
s_add_u32 s64,s74,524288
s_add_u32 m0,s75,65536
s_nop 0
buffer_load_dwordx4 v8,s[32:35],s64 offen nt lds
s_add_u32 s64,s74,532480
s_add_u32 m0,s75,66560
s_nop 0
buffer_load_dwordx4 v9,s[32:35],s64 offen nt lds
s_add_u32 s64,s74,540672
s_add_u32 m0,s75,67584
s_nop 0
buffer_load_dwordx4 v8,s[32:35],s64 offen nt lds
s_add_u32 s64,s74,548864
s_add_u32 m0,s75,68608
s_nop 0
buffer_load_dwordx4 v9,s[32:35],s64 offen nt lds
s_add_u32 s64,s74,557056
s_add_u32 m0,s75,69632
s_nop 0
buffer_load_dwordx4 v8,s[32:35],s64 offen nt lds
s_add_u32 s64,s74,565248
s_add_u32 m0,s75,70656
s_nop 0
buffer_load_dwordx4 v9,s[32:35],s64 offen nt lds
s_add_u32 s64,s74,573440
s_add_u32 m0,s75,71680
s_nop 0
buffer_load_dwordx4 v8,s[32:35],s64 offen nt lds
s_add_u32 s64,s74,581632
s_add_u32 m0,s75,72704
s_nop 0
buffer_load_dwordx4 v9,s[32:35],s64 offen nt lds
s_add_u32 s64,s74,589824
s_add_u32 m0,s75,73728
s_nop 0
buffer_load_dwordx4 v8,s[32:35],s64 offen nt lds
s_add_u32 s64,s74,598016
s_add_u32 m0,s75,74752
s_nop 0
buffer_load_dwordx4 v9,s[32:35],s64 offen nt lds
s_add_u32 s64,s74,606208
s_add_u32 m0,s75,75776
s_nop 0
buffer_load_dwordx4 v8,s[32:35],s64 offen nt lds
s_add_u32 s64,s74,614400
s_add_u32 m0,s75,76800
s_nop 0
buffer_load_dwordx4 v9,s[32:35],s64 offen nt lds
s_add_u32 s64,s74,622592
s_add_u32 m0,s75,77824
s_nop 0
buffer_load_dwordx4 v8,s[32:35],s64 offen nt lds
s_add_u32 s64,s74,630784
s_add_u32 m0,s75,78848
s_nop 0
buffer_load_dwordx4 v9,s[32:35],s64 offen nt lds
s_add_u32 s64,s74,638976
s_add_u32 m0,s75,79872
s_nop 0
buffer_load_dwordx4 v8,s[32:35],s64 offen nt lds
s_add_u32 s64,s74,647168
s_add_u32 m0,s75,80896
s_nop 0
buffer_load_dwordx4 v9,s[32:35],s64 offen nt lds
s_waitcnt vmcnt(16)
s_barrier
ds_read_b64_tr_b16 a[0:1],v12 offset:0
ds_read_b64_tr_b16 a[128:129],v13 offset:0
ds_read_b64_tr_b16 a[2:3],v12 offset:4096
ds_read_b64_tr_b16 a[130:131],v13 offset:4096
ds_read_b64_tr_b16 a[4:5],v12 offset:8192
ds_read_b64_tr_b16 a[132:133],v13 offset:8192
ds_read_b64_tr_b16 a[6:7],v12 offset:12288
ds_read_b64_tr_b16 a[134:135],v13 offset:12288
s_waitcnt lgkmcnt(4)
ds_read_b64_tr_b16 a[8:9],v12 offset:16384
ds_read_b64_tr_b16 a[136:137],v13 offset:16384
ds_read_b64_tr_b16 a[10:11],v12 offset:20480
ds_read_b64_tr_b16 a[138:139],v13 offset:20480
ds_read_b64_tr_b16 a[12:13],v12 offset:24576
ds_read_b64_tr_b16 a[140:141],v13 offset:24576
ds_read_b64_tr_b16 a[14:15],v12 offset:28672
ds_read_b64_tr_b16 a[142:143],v13 offset:28672
s_waitcnt lgkmcnt(4)
ds_read_b64_tr_b16 a[16:17],v12 offset:32768
ds_read_b64_tr_b16 a[144:145],v13 offset:32768
ds_read_b64_tr_b16 a[18:19],v12 offset:36864
ds_read_b64_tr_b16 a[146:147],v13 offset:36864
ds_read_b64_tr_b16 a[20:21],v12 offset:40960
ds_read_b64_tr_b16 a[148:149],v13 offset:40960
ds_read_b64_tr_b16 a[22:23],v12 offset:45056
ds_read_b64_tr_b16 a[150:151],v13 offset:45056
s_waitcnt lgkmcnt(4)
ds_read_b64_tr_b16 a[24:25],v12 offset:49152
ds_read_b64_tr_b16 a[152:153],v13 offset:49152
ds_read_b64_tr_b16 a[26:27],v12 offset:53248
ds_read_b64_tr_b16 a[154:155],v13 offset:53248
ds_read_b64_tr_b16 a[28:29],v12 offset:57344
ds_read_b64_tr_b16 a[156:157],v13 offset:57344
ds_read_b64_tr_b16 a[30:31],v12 offset:61440
ds_read_b64_tr_b16 a[158:159],v13 offset:61440
s_waitcnt lgkmcnt(4)
v_xor_b32 v12,0x10000,v12
v_xor_b32 v13,0x10000,v13
s_waitcnt lgkmcnt(0)
s_barrier
s_add_u32 s64,s74,1048576
s_add_u32 m0,s75,0
s_nop 0
buffer_load_dwordx4 v8,s[32:35],s64 offen nt lds
s_add_u32 s64,s74,1056768
s_add_u32 m0,s75,1024
s_nop 0
buffer_load_dwordx4 v9,s[32:35],s64 offen nt lds
s_add_u32 s64,s74,1064960
s_add_u32 m0,s75,2048
s_nop 0
buffer_load_dwordx4 v8,s[32:35],s64 offen nt lds
s_add_u32 s64,s74,1073152
s_add_u32 m0,s75,3072
s_nop 0
buffer_load_dwordx4 v9,s[32:35],s64 offen nt lds
s_add_u32 s64,s74,1081344
s_add_u32 m0,s75,4096
s_nop 0
buffer_load_dwordx4 v8,s[32:35],s64 offen nt lds
s_add_u32 s64,s74,1089536
s_add_u32 m0,s75,5120
s_nop 0
buffer_load_dwordx4 v9,s[32:35],s64 offen nt lds
s_add_u32 s64,s74,1097728
s_add_u32 m0,s75,6144
s_nop 0
buffer_load_dwordx4 v8,s[32:35],s64 offen nt lds
s_add_u32 s64,s74,1105920
s_add_u32 m0,s75,7168
s_nop 0
buffer_load_dwordx4 v9,s[32:35],s64 offen nt lds
s_add_u32 s64,s74,1114112
s_add_u32 m0,s75,8192
s_nop 0
buffer_load_dwordx4 v8,s[32:35],s64 offen nt lds
s_add_u32 s64,s74,1122304
s_add_u32 m0,s75,9216
s_nop 0
buffer_load_dwordx4 v9,s[32:35],s64 offen nt lds
s_add_u32 s64,s74,1130496
s_add_u32 m0,s75,10240
s_nop 0
buffer_load_dwordx4 v8,s[32:35],s64 offen nt lds
s_add_u32 s64,s74,1138688
s_add_u32 m0,s75,11264
s_nop 0
buffer_load_dwordx4 v9,s[32:35],s64 offen nt lds
s_add_u32 s64,s74,1146880
s_add_u32 m0,s75,12288
s_nop 0
buffer_load_dwordx4 v8,s[32:35],s64 offen nt lds
s_add_u32 s64,s74,1155072
s_add_u32 m0,s75,13312
s_nop 0
buffer_load_dwordx4 v9,s[32:35],s64 offen nt lds
s_add_u32 s64,s74,1163264
s_add_u32 m0,s75,14336
s_nop 0
buffer_load_dwordx4 v8,s[32:35],s64 offen nt lds
s_add_u32 s64,s74,1171456
s_add_u32 m0,s75,15360
s_nop 0
buffer_load_dwordx4 v9,s[32:35],s64 offen nt lds
s_waitcnt vmcnt(16)
s_barrier
ds_read_b64_tr_b16 a[32:33],v12 offset:0
ds_read_b64_tr_b16 a[160:161],v13 offset:0
ds_read_b64_tr_b16 a[34:35],v12 offset:4096
ds_read_b64_tr_b16 a[162:163],v13 offset:4096
ds_read_b64_tr_b16 a[36:37],v12 offset:8192
ds_read_b64_tr_b16 a[164:165],v13 offset:8192
ds_read_b64_tr_b16 a[38:39],v12 offset:12288
ds_read_b64_tr_b16 a[166:167],v13 offset:12288
s_waitcnt lgkmcnt(4)
ds_read_b64_tr_b16 a[40:41],v12 offset:16384
ds_read_b64_tr_b16 a[168:169],v13 offset:16384
ds_read_b64_tr_b16 a[42:43],v12 offset:20480
ds_read_b64_tr_b16 a[170:171],v13 offset:20480
ds_read_b64_tr_b16 a[44:45],v12 offset:24576
ds_read_b64_tr_b16 a[172:173],v13 offset:24576
ds_read_b64_tr_b16 a[46:47],v12 offset:28672
ds_read_b64_tr_b16 a[174:175],v13 offset:28672
s_waitcnt lgkmcnt(4)
ds_read_b64_tr_b16 a[48:49],v12 offset:32768
ds_read_b64_tr_b16 a[176:177],v13 offset:32768
ds_read_b64_tr_b16 a[50:51],v12 offset:36864
ds_read_b64_tr_b16 a[178:179],v13 offset:36864
ds_read_b64_tr_b16 a[52:53],v12 offset:40960
ds_read_b64_tr_b16 a[180:181],v13 offset:40960
ds_read_b64_tr_b16 a[54:55],v12 offset:45056
ds_read_b64_tr_b16 a[182:183],v13 offset:45056
s_waitcnt lgkmcnt(4)
ds_read_b64_tr_b16 a[56:57],v12 offset:49152
ds_read_b64_tr_b16 a[184:185],v13 offset:49152
ds_read_b64_tr_b16 a[58:59],v12 offset:53248
ds_read_b64_tr_b16 a[186:187],v13 offset:53248
ds_read_b64_tr_b16 a[60:61],v12 offset:57344
ds_read_b64_tr_b16 a[188:189],v13 offset:57344
ds_read_b64_tr_b16 a[62:63],v12 offset:61440
ds_read_b64_tr_b16 a[190:191],v13 offset:61440
s_waitcnt lgkmcnt(4)
v_xor_b32 v12,0x10000,v12
v_xor_b32 v13,0x10000,v13
s_waitcnt lgkmcnt(0)
s_barrier
s_add_u32 s64,s74,1572864
s_add_u32 m0,s75,65536
s_nop 0
buffer_load_dwordx4 v8,s[32:35],s64 offen nt lds
s_add_u32 s64,s74,1581056
s_add_u32 m0,s75,66560
s_nop 0
buffer_load_dwordx4 v9,s[32:35],s64 offen nt lds
s_add_u32 s64,s74,1589248
s_add_u32 m0,s75,67584
s_nop 0
buffer_load_dwordx4 v8,s[32:35],s64 offen nt lds
s_add_u32 s64,s74,1597440
s_add_u32 m0,s75,68608
s_nop 0
buffer_load_dwordx4 v9,s[32:35],s64 offen nt lds
s_add_u32 s64,s74,1605632
s_add_u32 m0,s75,69632
s_nop 0
buffer_load_dwordx4 v8,s[32:35],s64 offen nt lds
s_add_u32 s64,s74,1613824
s_add_u32 m0,s75,70656
s_nop 0
buffer_load_dwordx4 v9,s[32:35],s64 offen nt lds
s_add_u32 s64,s74,1622016
s_add_u32 m0,s75,71680
s_nop 0
buffer_load_dwordx4 v8,s[32:35],s64 offen nt lds
s_add_u32 s64,s74,1630208
s_add_u32 m0,s75,72704
s_nop 0
buffer_load_dwordx4 v9,s[32:35],s64 offen nt lds
s_add_u32 s64,s74,1638400
s_add_u32 m0,s75,73728
s_nop 0
buffer_load_dwordx4 v8,s[32:35],s64 offen nt lds
s_add_u32 s64,s74,1646592
s_add_u32 m0,s75,74752
s_nop 0
buffer_load_dwordx4 v9,s[32:35],s64 offen nt lds
s_add_u32 s64,s74,1654784
s_add_u32 m0,s75,75776
s_nop 0
buffer_load_dwordx4 v8,s[32:35],s64 offen nt lds
s_add_u32 s64,s74,1662976
s_add_u32 m0,s75,76800
s_nop 0
buffer_load_dwordx4 v9,s[32:35],s64 offen nt lds
s_add_u32 s64,s74,1671168
s_add_u32 m0,s75,77824
s_nop 0
buffer_load_dwordx4 v8,s[32:35],s64 offen nt lds
s_add_u32 s64,s74,1679360
s_add_u32 m0,s75,78848
s_nop 0
buffer_load_dwordx4 v9,s[32:35],s64 offen nt lds
s_add_u32 s64,s74,1687552
s_add_u32 m0,s75,79872
s_nop 0
buffer_load_dwordx4 v8,s[32:35],s64 offen nt lds
s_add_u32 s64,s74,1695744
s_add_u32 m0,s75,80896
s_nop 0
buffer_load_dwordx4 v9,s[32:35],s64 offen nt lds
s_waitcnt vmcnt(16)
s_barrier
ds_read_b64_tr_b16 a[64:65],v12 offset:0
ds_read_b64_tr_b16 a[192:193],v13 offset:0
ds_read_b64_tr_b16 a[66:67],v12 offset:4096
ds_read_b64_tr_b16 a[194:195],v13 offset:4096
ds_read_b64_tr_b16 a[68:69],v12 offset:8192
ds_read_b64_tr_b16 a[196:197],v13 offset:8192
ds_read_b64_tr_b16 a[70:71],v12 offset:12288
ds_read_b64_tr_b16 a[198:199],v13 offset:12288
s_waitcnt lgkmcnt(4)
ds_read_b64_tr_b16 a[72:73],v12 offset:16384
ds_read_b64_tr_b16 a[200:201],v13 offset:16384
ds_read_b64_tr_b16 a[74:75],v12 offset:20480
ds_read_b64_tr_b16 a[202:203],v13 offset:20480
ds_read_b64_tr_b16 a[76:77],v12 offset:24576
ds_read_b64_tr_b16 a[204:205],v13 offset:24576
ds_read_b64_tr_b16 a[78:79],v12 offset:28672
ds_read_b64_tr_b16 a[206:207],v13 offset:28672
s_waitcnt lgkmcnt(4)
ds_read_b64_tr_b16 a[80:81],v12 offset:32768
ds_read_b64_tr_b16 a[208:209],v13 offset:32768
ds_read_b64_tr_b16 a[82:83],v12 offset:36864
ds_read_b64_tr_b16 a[210:211],v13 offset:36864
ds_read_b64_tr_b16 a[84:85],v12 offset:40960
ds_read_b64_tr_b16 a[212:213],v13 offset:40960
ds_read_b64_tr_b16 a[86:87],v12 offset:45056
ds_read_b64_tr_b16 a[214:215],v13 offset:45056
s_waitcnt lgkmcnt(4)
ds_read_b64_tr_b16 a[88:89],v12 offset:49152
ds_read_b64_tr_b16 a[216:217],v13 offset:49152
ds_read_b64_tr_b16 a[90:91],v12 offset:53248
ds_read_b64_tr_b16 a[218:219],v13 offset:53248
ds_read_b64_tr_b16 a[92:93],v12 offset:57344
ds_read_b64_tr_b16 a[220:221],v13 offset:57344
ds_read_b64_tr_b16 a[94:95],v12 offset:61440
ds_read_b64_tr_b16 a[222:223],v13 offset:61440
s_waitcnt lgkmcnt(4)
v_xor_b32 v12,0x10000,v12
v_xor_b32 v13,0x10000,v13
s_waitcnt lgkmcnt(0)
s_barrier
s_waitcnt vmcnt(0)
s_barrier
ds_read_b64_tr_b16 a[96:97],v12 offset:0
ds_read_b64_tr_b16 a[224:225],v13 offset:0
ds_read_b64_tr_b16 a[98:99],v12 offset:4096
ds_read_b64_tr_b16 a[226:227],v13 offset:4096
ds_read_b64_tr_b16 a[100:101],v12 offset:8192
ds_read_b64_tr_b16 a[228:229],v13 offset:8192
ds_read_b64_tr_b16 a[102:103],v12 offset:12288
ds_read_b64_tr_b16 a[230:231],v13 offset:12288
s_waitcnt lgkmcnt(4)
ds_read_b64_tr_b16 a[104:105],v12 offset:16384
ds_read_b64_tr_b16 a[232:233],v13 offset:16384
ds_read_b64_tr_b16 a[106:107],v12 offset:20480
ds_read_b64_tr_b16 a[234:235],v13 offset:20480
ds_read_b64_tr_b16 a[108:109],v12 offset:24576
ds_read_b64_tr_b16 a[236:237],v13 offset:24576
ds_read_b64_tr_b16 a[110:111],v12 offset:28672
ds_read_b64_tr_b16 a[238:239],v13 offset:28672
s_waitcnt lgkmcnt(4)
ds_read_b64_tr_b16 a[112:113],v12 offset:32768
ds_read_b64_tr_b16 a[240:241],v13 offset:32768
ds_read_b64_tr_b16 a[114:115],v12 offset:36864
ds_read_b64_tr_b16 a[242:243],v13 offset:36864
ds_read_b64_tr_b16 a[116:117],v12 offset:40960
ds_read_b64_tr_b16 a[244:245],v13 offset:40960
ds_read_b64_tr_b16 a[118:119],v12 offset:45056
ds_read_b64_tr_b16 a[246:247],v13 offset:45056
s_waitcnt lgkmcnt(4)
ds_read_b64_tr_b16 a[120:121],v12 offset:49152
ds_read_b64_tr_b16 a[248:249],v13 offset:49152
ds_read_b64_tr_b16 a[122:123],v12 offset:53248
ds_read_b64_tr_b16 a[250:251],v13 offset:53248
ds_read_b64_tr_b16 a[124:125],v12 offset:57344
ds_read_b64_tr_b16 a[252:253],v13 offset:57344
ds_read_b64_tr_b16 a[126:127],v12 offset:61440
ds_read_b64_tr_b16 a[254:255],v13 offset:61440
s_waitcnt lgkmcnt(4)
v_xor_b32 v12,0x10000,v12
v_xor_b32 v13,0x10000,v13
s_waitcnt lgkmcnt(0)
s_barrier
v_and_b32 v21,1,v1
v_mul_u32_u24 v21,960,v21
s_mov_b32 s65,21052032
s_mov_b32 s66,1792
pl_237:
buffer_load_dword v22,v21,s[20:23],s65 offen sc1
s_waitcnt vmcnt(0)
v_cmp_gt_u32 vcc,s66,v22
s_cbranch_vccz pok_238
s_sleep 1
s_sub_u32 s90,s90,1
s_cmp_gt_i32 s90,0
s_cbranch_scc1 pl_237
pok_238:
s_mov_b32 s81,0xbdd2d3e8
v_mov_b32 v28,0xc0135761
v_mov_b32 v17,v16
v_and_b32 v21,31,v1
v_lshlrev_b32 v21,2,v21
s_mul_i32 s74,s79,40
s_add_u32 s74,s74,s63
s_add_u32 s74,s74,3072
s_lshl_b32 s42,s41,2
s_add_u32 s42,s42,s50
s_lshl_b32 s73,s41,7
s_lshl_b32 s64,s50,2
s_add_u32 s73,s73,s64
s_add_u32 s73,s73,s63
s_add_u32 s73,s73,6144
s_add_u32 s73,s73,s60
s_lshl_b32 s43,s50,11
s_lshl_b32 s78,s79,21
s_add_u32 s78,s78,27262976
s_mov_b32 s64,0
s_lshr_b32 s65,s50,1
s_and_b32 s66,s50,1
s_lshl_b32 s66,s66,12
s_add_u32 s66,s66,s64
s_lshl_b32 s72,s65,13
s_add_u32 s72,s72,s66
s_add_u32 s72,s72,0x10000
s_lshl_b32 s65,s65,14
s_add_u32 s75,s65,s66
s_add_u32 s75,s75,1966080
s_add_u32 s64,s41,72
s_lshl_b32 s64,s64,14
s_add_u32 s64,s64,s43
v_add_u32 v18,s64,v16
s_lshl_b32 s64,s42,8
s_add_u32 s64,s64,1310720
v_lshl_add_u32 v24,v3,4,s64
v_mov_b32 v5,0x40000000
v_cmp_gt_u32 vcc,16,v1
s_nop 1
v_cndmask_b32 v24,v5,v24,vcc
s_lshl_b32 s64,s42,6
v_and_b32 v5,3,v1
v_xor_b32 v5,v5,v4
v_lshl_add_u32 v5,v5,4,s64
v_lshrrev_b32 v11,2,v1
s_add_u32 s43,s43,133120
v_lshrrev_b32 v6,2,v3
v_lshrrev_b32 v7,1,v4
v_xor_b32 v6,v6,v7
v_lshlrev_b32 v6,4,v6
v_lshl_add_u32 v6,v3,6,v6
v_and_b32 v7,1,v4
v_lshl_add_u32 v6,v7,3,v6
v_add_u32 v40,s43,v6
v_xor_b32 v41,32,v40
v_add_u32 v6,30,v11
v_lshl_add_u32 v9,v6,7,v5
v_and_b32 v9,2047,v9
v_and_b32 v7,3,v6
v_lshl_add_u32 v7,v7,11,v9
v_bfe_u32 v8,v6,2,3
v_lshl_add_u32 v7,v8,14,v7
v_mov_b32 v8,0x2000
v_mov_b32 v9,2097152
v_cmp_gt_u32 vcc,32,v6
s_nop 1
v_cndmask_b32 v8,v9,v8,vcc
v_add_u32 v7,v7,v8
v_add_u32 v7,0,v7
v_xor_b32 v19,s62,v7
v_xor_b32 v19,0x2000,v19
v_add_u32 v6,46,v11
v_lshl_add_u32 v9,v6,7,v5
v_and_b32 v9,2047,v9
v_and_b32 v7,3,v6
v_lshl_add_u32 v7,v7,11,v9
v_bfe_u32 v8,v6,2,3
v_lshl_add_u32 v7,v8,14,v7
v_mov_b32 v8,0x2000
v_mov_b32 v9,2097152
v_cmp_gt_u32 vcc,32,v6
s_nop 1
v_cndmask_b32 v8,v9,v8,vcc
v_add_u32 v7,v7,v8
v_add_u32 v7,0,v7
v_xor_b32 v20,s62,v7
v_xor_b32 v20,0x2000,v20
s_add_u32 s64,s79,0
s_lshl_b32 s70,s64,21
s_lshl_b32 s64,s64,13
s_and_b32 s64,s64,0x2000
s_xor_b32 s64,s64,s62
s_add_u32 s70,s70,s64
s_add_u32 s70,s70,29360128
s_mov_b32 s83,1
s_mov_b32 s87,s74
s_cmp_eq_u32 s50,0
s_cselect_b32 s74,s74,0x7fff0000
v_mov_b32 v47,132096
s_lshl_b32 s64,s50,3
s_add_u32 s64,s64,132096
v_mov_b32 v46,s64
v_mov_b32 v29,0
s_mov_b32 s97,0x7fff0000
s_mov_b32 s69,1
s_mov_b32 s68,0
s_mov_b32 s52,0x30003
s_mov_b32 s53,s52
seg_240:
s_cmp_eq_u32 s83,0
s_cbranch_scc1 ahead_241
s_add_u32 s94,s70,s75
s_cmp_eq_u32 s71,65
s_cselect_b32 s64,2097152,0
s_cselect_b32 s65,0x2000,0
s_sub_u32 s94,s94,s64
s_xor_b32 s94,s94,s65
s_xor_b32 s95,s94,1024
s_xor_b32 s91,s72,0x10000
s_cmp_eq_u32 s69,0
s_mov_b32 s69,1
s_cbranch_scc1 half2_245
s_min_u32 s66,s71,64
s_waitcnt vmcnt(3)
v_cmp_gt_u32 vcc,s66,v29
s_cbranch_vccz nb_244
s_waitcnt vmcnt(0)
v_add_u32 v22,s71,-1
buffer_store_dword v22,v23,s[20:23],s97 offen sc1
s_mov_b32 s97,0x7fff0000
s_cmp_lg_u32 s50,0
s_cbranch_scc1 nb_244
buffer_load_dword v32,v21,s[20:23],s74 offen sc1
s_sleep 2
pl_246:
buffer_load_dword v33,v21,s[20:23],s74 offen sc1
s_waitcnt vmcnt(1)
v_cmp_gt_u32 vcc,s66,v32
v_mov_b32 v29,v32
s_cbranch_vccz pok_247
buffer_load_dword v32,v21,s[20:23],s74 offen sc1
s_waitcnt vmcnt(1)
v_cmp_gt_u32 vcc,s66,v33
v_mov_b32 v29,v33
s_cbranch_vccz pok_247
s_sub_u32 s90,s90,1
s_cmp_gt_i32 s90,0
s_cbranch_scc1 pl_246
pok_247:
nb_244:
s_cmp_eq_u32 s71,64
s_barrier
s_cbranch_scc1 half_248
s_xor_b32 m0,s91,0
s_add_u32 s65,s94,0
buffer_load_dwordx4 v16,s[20:23],s65 offen offset:0 sc1 lds
buffer_load_dwordx4 v16,s[20:23],s65 offen offset:2048 sc1 lds
s_xor_b32 m0,s91,16384
s_add_u32 s65,s94,32768
buffer_load_dwordx4 v16,s[20:23],s65 offen offset:0 sc1 lds
buffer_load_dwordx4 v16,s[20:23],s65 offen offset:2048 sc1 lds
s_xor_b32 m0,s91,32768
s_add_u32 s65,s94,65536
buffer_load_dwordx4 v16,s[20:23],s65 offen offset:0 sc1 lds
buffer_load_dwordx4 v16,s[20:23],s65 offen offset:2048 sc1 lds
s_xor_b32 m0,s91,49152
s_add_u32 s65,s94,98304
buffer_load_dwordx4 v16,s[20:23],s65 offen offset:0 sc1 lds
buffer_load_dwordx4 v16,s[20:23],s65 offen offset:2048 sc1 lds
s_waitcnt vmcnt(8)
v_add_u32 v22,s71,-1
buffer_store_dword v22,v23,s[20:23],s97 offen sc1
s_mov_b32 s97,0x7fff0000
s_waitcnt vmcnt(7)
s_barrier
ds_read_b128 v[224:227],v17 offset:0
ds_read_b128 v[228:231],v17 offset:2048
ds_read_b128 v[232:235],v17 offset:4096
ds_read_b128 v[236:239],v17 offset:6144
ds_read_b128 v[240:243],v17 offset:8192
ds_read_b128 v[244:247],v17 offset:10240
ds_read_b128 v[248:251],v17 offset:12288
s_waitcnt lgkmcnt(5)
v_mfma_f32_16x16x32_bf16 v[64:67],a[0:3],v[224:227],0
s_xor_b32 m0,s91,1024
s_add_u32 s96,s71,1
s_add_u32 s92,s71,2
v_min_u32 v27,v224,v228
v_mfma_f32_16x16x32_bf16 v[72:75],a[128:131],v[224:227],0
ds_read_b128 v[252:255],v17 offset:14336
s_cmp_eq_u32 s96,64
s_cselect_b32 s96,99,s96
v_mfma_f32_16x16x32_bf16 v[64:67],a[4:7],v[228:231],v[64:67]
s_add_u32 s65,s95,0
s_cmp_eq_u32 s92,64
s_cselect_b32 s92,99,s92
v_mfma_f32_16x16x32_bf16 v[72:75],a[132:135],v[228:231],v[72:75]
s_waitcnt vmcnt(5)
s_barrier
ds_read_b128 v[224:227],v17 offset:16384
s_waitcnt lgkmcnt(5)
v_mfma_f32_16x16x32_bf16 v[64:67],a[8:11],v[232:235],v[64:67]
buffer_load_dwordx4 v16,s[20:23],s65 offen offset:0 sc1 lds
v_min3_u32 v27,v27,v232,v236
v_mfma_f32_16x16x32_bf16 v[72:75],a[136:139],v[232:235],v[72:75]
ds_read_b128 v[228:231],v17 offset:18432
s_cmp_eq_u32 s96,65
s_cselect_b32 s96,64,s96
v_mfma_f32_16x16x32_bf16 v[64:67],a[12:15],v[236:239],v[64:67]
buffer_load_dwordx4 v16,s[20:23],s65 offen offset:2048 sc1 lds
v_mfma_f32_16x16x32_bf16 v[72:75],a[140:143],v[236:239],v[72:75]
ds_read_b128 v[232:235],v17 offset:20480
s_waitcnt lgkmcnt(5)
v_mfma_f32_16x16x32_bf16 v[64:67],a[16:19],v[240:243],v[64:67]
s_xor_b32 m0,s91,17408
v_min3_u32 v27,v27,v240,v244
v_mfma_f32_16x16x32_bf16 v[72:75],a[144:147],v[240:243],v[72:75]
ds_read_b128 v[236:239],v17 offset:22528
v_mfma_f32_16x16x32_bf16 v[64:67],a[20:23],v[244:247],v[64:67]
s_add_u32 s65,s95,32768
v_mfma_f32_16x16x32_bf16 v[72:75],a[148:151],v[244:247],v[72:75]
ds_read_b128 v[240:243],v17 offset:24576
s_waitcnt lgkmcnt(5)
v_mfma_f32_16x16x32_bf16 v[64:67],a[24:27],v[248:251],v[64:67]
buffer_load_dwordx4 v16,s[20:23],s65 offen offset:0 sc1 lds
v_mfma_f32_16x16x32_bf16 v[72:75],a[152:155],v[248:251],v[72:75]
ds_read_b128 v[244:247],v17 offset:26624
v_min3_u32 v27,v27,v248,v252
v_mfma_f32_16x16x32_bf16 v[64:67],a[28:31],v[252:255],v[64:67]
buffer_load_dwordx4 v16,s[20:23],s65 offen offset:2048 sc1 lds
v_mfma_f32_16x16x32_bf16 v[72:75],a[156:159],v[252:255],v[72:75]
ds_read_b128 v[248:251],v17 offset:28672
s_waitcnt lgkmcnt(5)
v_mfma_f32_16x16x32_bf16 v[64:67],a[32:35],v[224:227],v[64:67]
s_xor_b32 m0,s91,33792
v_min3_u32 v27,v27,v224,v228
v_mfma_f32_16x16x32_bf16 v[72:75],a[160:163],v[224:227],v[72:75]
ds_read_b128 v[252:255],v17 offset:30720
v_mfma_f32_16x16x32_bf16 v[64:67],a[36:39],v[228:231],v[64:67]
s_add_u32 s65,s95,65536
v_mfma_f32_16x16x32_bf16 v[72:75],a[164:167],v[228:231],v[72:75]
s_waitcnt vmcnt(5)
s_barrier
ds_read_b128 v[224:227],v17 offset:32768
s_waitcnt lgkmcnt(5)
v_mfma_f32_16x16x32_bf16 v[64:67],a[40:43],v[232:235],v[64:67]
buffer_load_dwordx4 v16,s[20:23],s65 offen offset:0 sc1 lds
v_mfma_f32_16x16x32_bf16 v[72:75],a[168:171],v[232:235],v[72:75]
ds_read_b128 v[228:231],v17 offset:34816
v_min3_u32 v27,v27,v232,v236
v_mfma_f32_16x16x32_bf16 v[64:67],a[44:47],v[236:239],v[64:67]
buffer_load_dwordx4 v16,s[20:23],s65 offen offset:2048 sc1 lds
v_mfma_f32_16x16x32_bf16 v[72:75],a[172:175],v[236:239],v[72:75]
ds_read_b128 v[232:235],v17 offset:36864
s_waitcnt lgkmcnt(5)
v_mfma_f32_16x16x32_bf16 v[64:67],a[48:51],v[240:243],v[64:67]
s_xor_b32 m0,s91,50176
v_min3_u32 v27,v27,v240,v244
v_mfma_f32_16x16x32_bf16 v[72:75],a[176:179],v[240:243],v[72:75]
ds_read_b128 v[236:239],v17 offset:38912
v_mfma_f32_16x16x32_bf16 v[64:67],a[52:55],v[244:247],v[64:67]
s_add_u32 s65,s95,98304
v_mfma_f32_16x16x32_bf16 v[72:75],a[180:183],v[244:247],v[72:75]
ds_read_b128 v[240:243],v17 offset:40960
s_waitcnt lgkmcnt(5)
v_mfma_f32_16x16x32_bf16 v[64:67],a[56:59],v[248:251],v[64:67]
buffer_load_dwordx4 v16,s[20:23],s65 offen offset:0 sc1 lds
v_min3_u32 v27,v27,v248,v252
v_mfma_f32_16x16x32_bf16 v[72:75],a[184:187],v[248:251],v[72:75]
ds_read_b128 v[244:247],v17 offset:43008
s_waitcnt vmcnt(63)
v_mfma_f32_16x16x32_bf16 v[64:67],a[60:63],v[252:255],v[64:67]
buffer_load_dwordx4 v16,s[20:23],s65 offen offset:2048 sc1 lds
v_mfma_f32_16x16x32_bf16 v[72:75],a[188:191],v[252:255],v[72:75]
ds_read_b128 v[248:251],v17 offset:45056
s_waitcnt lgkmcnt(5)
v_mfma_f32_16x16x32_bf16 v[64:67],a[64:67],v[224:227],v[64:67]
v_cmp_gt_u32 vcc,s96,v29
v_cmp_gt_u32 s[92:93],s92,v29
v_mfma_f32_16x16x32_bf16 v[72:75],a[192:195],v[224:227],v[72:75]
ds_read_b128 v[252:255],v17 offset:47104
v_min3_u32 v27,v27,v224,v228
v_mfma_f32_16x16x32_bf16 v[64:67],a[68:71],v[228:231],v[64:67]
v_mov_b32 v44,vcc_lo
v_mov_b32 v45,s92
s_add_u32 m0,s43,0
v_mfma_f32_16x16x32_bf16 v[72:75],a[196:199],v[228:231],v[72:75]
ds_read_b128 v[224:227],v17 offset:49152
s_waitcnt lgkmcnt(5)
v_mfma_f32_16x16x32_bf16 v[64:67],a[72:75],v[232:235],v[64:67]
ds_write_b64 v46,v[44:45]
v_min3_u32 v27,v27,v232,v236
v_mfma_f32_16x16x32_bf16 v[72:75],a[200:203],v[232:235],v[72:75]
ds_read_b128 v[228:231],v17 offset:51200
buffer_load_dwordx4 v19,s[20:23],s78 offen sc1 lds
v_mfma_f32_16x16x32_bf16 v[64:67],a[76:79],v[236:239],v[64:67]
s_add_u32 m0,s43,1024
s_nop 0
buffer_load_dwordx4 v20,s[20:23],s78 offen sc1 lds
v_mfma_f32_16x16x32_bf16 v[72:75],a[204:207],v[236:239],v[72:75]
ds_read_b128 v[232:235],v17 offset:53248
s_waitcnt lgkmcnt(6)
v_mfma_f32_16x16x32_bf16 v[64:67],a[80:83],v[240:243],v[64:67]
v_min3_u32 v27,v27,v240,v244
s_add_u32 s88,s70,s75
v_mfma_f32_16x16x32_bf16 v[72:75],a[208:211],v[240:243],v[72:75]
ds_read_b128 v[236:239],v17 offset:55296
s_add_u32 s88,s88,2097152
v_mfma_f32_16x16x32_bf16 v[64:67],a[84:87],v[244:247],v[64:67]
s_xor_b32 s88,s88,0x2000
s_xor_b32 s89,s88,1024
v_mfma_f32_16x16x32_bf16 v[72:75],a[212:215],v[244:247],v[72:75]
ds_read_b128 v[240:243],v17 offset:57344
s_waitcnt lgkmcnt(6)
v_mfma_f32_16x16x32_bf16 v[64:67],a[88:91],v[248:251],v[64:67]
v_min3_u32 v27,v27,v248,v252
v_mfma_f32_16x16x32_bf16 v[72:75],a[216:219],v[248:251],v[72:75]
ds_read_b128 v[244:247],v17 offset:59392
v_mfma_f32_16x16x32_bf16 v[64:67],a[92:95],v[252:255],v[64:67]
v_mfma_f32_16x16x32_bf16 v[72:75],a[220:223],v[252:255],v[72:75]
ds_read_b128 v[248:251],v17 offset:61440
s_waitcnt lgkmcnt(5)
v_mfma_f32_16x16x32_bf16 v[64:67],a[96:99],v[224:227],v[64:67]
v_min3_u32 v27,v27,v224,v228
v_mfma_f32_16x16x32_bf16 v[72:75],a[224:227],v[224:227],v[72:75]
ds_read_b128 v[252:255],v17 offset:63488
v_mfma_f32_16x16x32_bf16 v[64:67],a[100:103],v[228:231],v[64:67]
v_mfma_f32_16x16x32_bf16 v[72:75],a[228:231],v[228:231],v[72:75]
s_waitcnt vmcnt(6)
s_barrier
ds_read_b64 v[44:45],v47
ds_read_b128 v[224:227],v17 offset:1024
s_waitcnt lgkmcnt(6)
v_mfma_f32_16x16x32_bf16 v[64:67],a[104:107],v[232:235],v[64:67]
v_min3_u32 v27,v27,v232,v236
v_mfma_f32_16x16x32_bf16 v[72:75],a[232:235],v[232:235],v[72:75]
ds_read_b128 v[228:231],v17 offset:3072
v_mfma_f32_16x16x32_bf16 v[64:67],a[108:111],v[236:239],v[64:67]
s_waitcnt vmcnt(0)
ds_read_b64 v[120:121],v40 offset:0
v_mfma_f32_16x16x32_bf16 v[72:75],a[236:239],v[236:239],v[72:75]
ds_read_b128 v[232:235],v17 offset:5120
s_waitcnt lgkmcnt(7)
v_mfma_f32_16x16x32_bf16 v[64:67],a[112:115],v[240:243],v[64:67]
v_min3_u32 v27,v27,v240,v244
ds_read_b64 v[122:123],v41 offset:0
v_mfma_f32_16x16x32_bf16 v[72:75],a[240:243],v[240:243],v[72:75]
ds_read_b128 v[236:239],v17 offset:7168
ds_read_b64 v[124:125],v40 offset:1024
v_mfma_f32_16x16x32_bf16 v[64:67],a[116:119],v[244:247],v[64:67]
ds_read_b64 v[126:127],v41 offset:1024
v_mfma_f32_16x16x32_bf16 v[72:75],a[244:247],v[244:247],v[72:75]
ds_read_b128 v[240:243],v17 offset:9216
s_waitcnt lgkmcnt(10)
v_mfma_f32_16x16x32_bf16 v[64:67],a[120:123],v[248:251],v[64:67]
s_waitcnt lgkmcnt(9)
v_readfirstlane_b32 s93,v45
v_mfma_f32_16x16x32_bf16 v[72:75],a[248:251],v[248:251],v[72:75]
ds_read_b128 v[244:247],v17 offset:11264
v_readfirstlane_b32 s83,v44
s_cmp_lg_u32 s83,0
s_cbranch_scc0 keep_250
v_mfma_f32_16x16x32_bf16 v[64:67],a[124:127],v[252:255],v[64:67]
v_min3_u32 v27,v27,v248,v252
v_mfma_f32_16x16x32_bf16 v[72:75],a[252:255],v[252:255],v[72:75]
ds_read_b128 v[248:251],v17 offset:13312
s_waitcnt lgkmcnt(9)
v_mfma_f32_16x16x32_bf16 v[68:71],a[0:3],v[224:227],0
v_cmp_eq_u32 vcc,0,v27
s_cbranch_vccnz retry_239
v_mfma_f32_16x16x32_bf16 v[76:79],a[128:131],v[224:227],0
ds_read_b128 v[252:255],v17 offset:15360
v_min3_u32 v27,v27,v224,v228
v_mfma_f32_16x16x32_bf16 v[68:71],a[4:7],v[228:231],v[68:71]
v_mfma_f32_16x16x32_bf16 v[76:79],a[132:135],v[228:231],v[76:79]
ds_read_b128 v[224:227],v17 offset:17408
s_waitcnt lgkmcnt(7)
v_mfma_f32_16x16x32_bf16 v[68:71],a[8:11],v[232:235],v[68:71]
v_min3_u32 v27,v27,v232,v236
s_waitcnt lgkmcnt(5)
v_lshlrev_b32 v88,16,v120
v_mfma_f32_16x16x32_bf16 v[76:79],a[136:139],v[232:235],v[76:79]
ds_read_b128 v[228:231],v17 offset:19456
v_and_b32 v89,s80,v120
v_lshlrev_b32 v90,16,v121
v_mfma_f32_16x16x32_bf16 v[68:71],a[12:15],v[236:239],v[68:71]
v_and_b32 v91,s80,v121
v_lshlrev_b32 v92,16,v122
v_and_b32 v93,s80,v122
v_mfma_f32_16x16x32_bf16 v[76:79],a[140:143],v[236:239],v[76:79]
ds_read_b128 v[232:235],v17 offset:21504
v_lshlrev_b32 v94,16,v123
s_waitcnt lgkmcnt(5)
v_mfma_f32_16x16x32_bf16 v[68:71],a[16:19],v[240:243],v[68:71]
v_min3_u32 v27,v27,v240,v244
v_and_b32 v95,s80,v123
v_mfma_f32_16x16x32_bf16 v[76:79],a[144:147],v[240:243],v[76:79]
ds_read_b128 v[236:239],v17 offset:23552
v_add_f32 v88,v64,v88
v_mfma_f32_16x16x32_bf16 v[68:71],a[20:23],v[244:247],v[68:71]
v_add_f32 v89,v65,v89
v_add_f32 v90,v66,v90
v_mfma_f32_16x16x32_bf16 v[76:79],a[148:151],v[244:247],v[76:79]
ds_read_b128 v[240:243],v17 offset:25600
s_waitcnt lgkmcnt(5)
v_mfma_f32_16x16x32_bf16 v[68:71],a[24:27],v[248:251],v[68:71]
v_min3_u32 v27,v27,v248,v252
v_add_f32 v91,v67,v91
v_mfma_f32_16x16x32_bf16 v[76:79],a[152:155],v[248:251],v[76:79]
ds_read_b128 v[244:247],v17 offset:27648
v_add_f32 v92,v72,v92
v_mfma_f32_16x16x32_bf16 v[68:71],a[28:31],v[252:255],v[68:71]
v_add_f32 v93,v73,v93
v_add_f32 v94,v74,v94
v_mfma_f32_16x16x32_bf16 v[76:79],a[156:159],v[252:255],v[76:79]
ds_read_b128 v[248:251],v17 offset:29696
s_waitcnt lgkmcnt(5)
v_mfma_f32_16x16x32_bf16 v[68:71],a[32:35],v[224:227],v[68:71]
v_min3_u32 v27,v27,v224,v228
v_add_f32 v95,v75,v95
v_mfma_f32_16x16x32_bf16 v[76:79],a[160:163],v[224:227],v[76:79]
ds_read_b128 v[252:255],v17 offset:31744
v_cvt_pk_bf16_f32 v96,v88,v89
v_mfma_f32_16x16x32_bf16 v[68:71],a[36:39],v[228:231],v[68:71]
v_cvt_pk_bf16_f32 v97,v90,v91
v_cvt_pk_bf16_f32 v98,v92,v93
v_mfma_f32_16x16x32_bf16 v[76:79],a[164:167],v[228:231],v[76:79]
s_waitcnt vmcnt(2)
s_barrier
ds_read_b128 v[224:227],v17 offset:33792
s_waitcnt lgkmcnt(5)
v_mfma_f32_16x16x32_bf16 v[68:71],a[40:43],v[232:235],v[68:71]
v_min3_u32 v27,v27,v232,v236
v_cvt_pk_bf16_f32 v99,v94,v95
v_mfma_f32_16x16x32_bf16 v[76:79],a[168:171],v[232:235],v[76:79]
ds_read_b128 v[228:231],v17 offset:35840
v_max_u32 v96,1,v96
v_mfma_f32_16x16x32_bf16 v[68:71],a[44:47],v[236:239],v[68:71]
buffer_store_dwordx4 v[96:99],v18,s[20:23],s70 offen offset:0 sc1
v_mfma_f32_16x16x32_bf16 v[76:79],a[172:175],v[236:239],v[76:79]
ds_read_b128 v[232:235],v17 offset:37888
s_waitcnt lgkmcnt(5)
v_mfma_f32_16x16x32_bf16 v[68:71],a[48:51],v[240:243],v[68:71]
v_min3_u32 v27,v27,v240,v244
v_lshlrev_b32 v88,16,v96
v_mfma_f32_16x16x32_bf16 v[76:79],a[176:179],v[240:243],v[76:79]
ds_read_b128 v[236:239],v17 offset:39936
v_and_b32 v89,s80,v96
v_mfma_f32_16x16x32_bf16 v[68:71],a[52:55],v[244:247],v[68:71]
v_lshlrev_b32 v90,16,v97
v_and_b32 v91,s80,v97
v_mfma_f32_16x16x32_bf16 v[76:79],a[180:183],v[244:247],v[76:79]
ds_read_b128 v[240:243],v17 offset:41984
s_waitcnt lgkmcnt(5)
v_mfma_f32_16x16x32_bf16 v[68:71],a[56:59],v[248:251],v[68:71]
v_min3_u32 v27,v27,v248,v252
v_lshlrev_b32 v92,16,v98
v_mfma_f32_16x16x32_bf16 v[76:79],a[184:187],v[248:251],v[76:79]
ds_read_b128 v[244:247],v17 offset:44032
v_and_b32 v93,s80,v98
v_mfma_f32_16x16x32_bf16 v[68:71],a[60:63],v[252:255],v[68:71]
v_lshlrev_b32 v94,16,v99
v_and_b32 v95,s80,v99
v_mfma_f32_16x16x32_bf16 v[76:79],a[188:191],v[252:255],v[76:79]
ds_read_b128 v[248:251],v17 offset:46080
s_waitcnt lgkmcnt(5)
v_mfma_f32_16x16x32_bf16 v[68:71],a[64:67],v[224:227],v[68:71]
v_min3_u32 v27,v27,v224,v228
v_add_f32 v108,v88,v89
v_mfma_f32_16x16x32_bf16 v[76:79],a[192:195],v[224:227],v[76:79]
ds_read_b128 v[252:255],v17 offset:48128
v_mul_f32 v109,v88,v88
v_mfma_f32_16x16x32_bf16 v[68:71],a[68:71],v[228:231],v[68:71]
v_add_f32 v100,v90,v91
v_mul_f32 v101,v89,v89
v_mfma_f32_16x16x32_bf16 v[76:79],a[196:199],v[228:231],v[76:79]
ds_read_b128 v[224:227],v17 offset:50176
s_waitcnt lgkmcnt(5)
v_mfma_f32_16x16x32_bf16 v[68:71],a[72:75],v[232:235],v[68:71]
v_min3_u32 v27,v27,v232,v236
v_fmac_f32 v109,v90,v90
v_mfma_f32_16x16x32_bf16 v[76:79],a[200:203],v[232:235],v[76:79]
ds_read_b128 v[228:231],v17 offset:52224
v_fmac_f32 v101,v91,v91
v_mfma_f32_16x16x32_bf16 v[68:71],a[76:79],v[236:239],v[68:71]
v_fmac_f32 v109,v92,v92
v_fmac_f32 v101,v93,v93
v_mfma_f32_16x16x32_bf16 v[76:79],a[204:207],v[236:239],v[76:79]
ds_read_b128 v[232:235],v17 offset:54272
s_waitcnt lgkmcnt(5)
v_mfma_f32_16x16x32_bf16 v[68:71],a[80:83],v[240:243],v[68:71]
v_min3_u32 v27,v27,v240,v244
v_add_f32 v108,v108,v92
v_mfma_f32_16x16x32_bf16 v[76:79],a[208:211],v[240:243],v[76:79]
ds_read_b128 v[236:239],v17 offset:56320
v_add_f32 v100,v100,v93
v_mfma_f32_16x16x32_bf16 v[68:71],a[84:87],v[244:247],v[68:71]
v_fmac_f32 v109,v94,v94
v_fmac_f32 v101,v95,v95
v_mfma_f32_16x16x32_bf16 v[76:79],a[212:215],v[244:247],v[76:79]
ds_read_b128 v[240:243],v17 offset:58368
s_waitcnt lgkmcnt(5)
v_mfma_f32_16x16x32_bf16 v[68:71],a[88:91],v[248:251],v[68:71]
v_min3_u32 v27,v27,v248,v252
v_add_f32 v108,v108,v94
v_mfma_f32_16x16x32_bf16 v[76:79],a[216:219],v[248:251],v[76:79]
ds_read_b128 v[244:247],v17 offset:60416
v_add_f32 v100,v100,v95
v_mfma_f32_16x16x32_bf16 v[68:71],a[92:95],v[252:255],v[68:71]
v_add_f32 v108,v108,v100
v_add_f32 v109,v109,v101
v_mfma_f32_16x16x32_bf16 v[76:79],a[220:223],v[252:255],v[76:79]
ds_read_b128 v[248:251],v17 offset:62464
s_waitcnt lgkmcnt(5)
v_mfma_f32_16x16x32_bf16 v[68:71],a[96:99],v[224:227],v[68:71]
v_min3_u32 v27,v27,v224,v228
v_mov_b32 v100,v108
v_mfma_f32_16x16x32_bf16 v[76:79],a[224:227],v[224:227],v[76:79]
ds_read_b128 v[252:255],v17 offset:64512
v_mov_b32 v101,v109
v_mfma_f32_16x16x32_bf16 v[68:71],a[100:103],v[228:231],v[68:71]
v_permlane16_swap_b32 v100,v108
v_permlane16_swap_b32 v101,v109
v_mfma_f32_16x16x32_bf16 v[76:79],a[228:231],v[228:231],v[76:79]
v_add_f32 v108,v108,v100
s_waitcnt lgkmcnt(4)
v_mfma_f32_16x16x32_bf16 v[68:71],a[104:107],v[232:235],v[68:71]
v_min3_u32 v27,v27,v232,v236
v_add_f32 v109,v109,v101
v_mfma_f32_16x16x32_bf16 v[76:79],a[232:235],v[232:235],v[76:79]
v_mov_b32 v100,v108
v_mov_b32 v101,v109
v_mfma_f32_16x16x32_bf16 v[68:71],a[108:111],v[236:239],v[68:71]
v_permlane32_swap_b32 v100,v108
v_permlane32_swap_b32 v101,v109
v_mfma_f32_16x16x32_bf16 v[76:79],a[236:239],v[236:239],v[76:79]
v_add_f32 v108,v108,v100
s_waitcnt lgkmcnt(2)
v_mfma_f32_16x16x32_bf16 v[68:71],a[112:115],v[240:243],v[68:71]
v_min3_u32 v27,v27,v240,v244
v_add_f32 v109,v109,v101
v_mfma_f32_16x16x32_bf16 v[76:79],a[240:243],v[240:243],v[76:79]
v_min3_u32 v27,v27,v120,v122
v_min3_u32 v27,v27,v124,v126
v_mfma_f32_16x16x32_bf16 v[68:71],a[116:119],v[244:247],v[68:71]
v_lshlrev_b32 v32,16,v124
v_and_b32 v33,s80,v124
v_mfma_f32_16x16x32_bf16 v[76:79],a[244:247],v[244:247],v[76:79]
v_lshlrev_b32 v34,16,v125
s_waitcnt lgkmcnt(0)
v_mfma_f32_16x16x32_bf16 v[68:71],a[120:123],v[248:251],v[68:71]
v_min3_u32 v27,v27,v248,v252
v_and_b32 v35,s80,v125
v_mfma_f32_16x16x32_bf16 v[76:79],a[248:251],v[248:251],v[76:79]
v_lshlrev_b32 v36,16,v126
v_and_b32 v37,s80,v126
v_mfma_f32_16x16x32_bf16 v[68:71],a[124:127],v[252:255],v[68:71]
v_lshlrev_b32 v38,16,v127
v_and_b32 v39,s80,v127
v_mfma_f32_16x16x32_bf16 v[76:79],a[252:255],v[252:255],v[76:79]
v_cmp_eq_u32 vcc,0,v27
s_cbranch_vccnz retry_239
s_branch epi_242
keep_250:
v_mfma_f32_16x16x32_bf16 v[64:67],a[124:127],v[252:255],v[64:67]
v_min3_u32 v27,v27,v248,v252
s_xor_b32 m0,s72,0
v_mfma_f32_16x16x32_bf16 v[72:75],a[252:255],v[252:255],v[72:75]
ds_read_b128 v[248:251],v17 offset:13312
s_add_u32 s65,s88,0
s_waitcnt lgkmcnt(9)
v_mfma_f32_16x16x32_bf16 v[68:71],a[0:3],v[224:227],0
buffer_load_dwordx4 v16,s[20:23],s65 offen offset:0 sc1 lds
v_min3_u32 v27,v27,v224,v228
v_mfma_f32_16x16x32_bf16 v[76:79],a[128:131],v[224:227],0
ds_read_b128 v[252:255],v17 offset:15360
buffer_load_dwordx4 v16,s[20:23],s65 offen offset:2048 sc1 lds
v_mfma_f32_16x16x32_bf16 v[68:71],a[4:7],v[228:231],v[68:71]
v_cmp_eq_u32 vcc,0,v27
s_cbranch_vccnz retry_239
v_mfma_f32_16x16x32_bf16 v[76:79],a[132:135],v[228:231],v[76:79]
ds_read_b128 v[224:227],v17 offset:17408
s_xor_b32 m0,s72,16384
s_waitcnt lgkmcnt(7)
v_mfma_f32_16x16x32_bf16 v[68:71],a[8:11],v[232:235],v[68:71]
s_add_u32 s65,s88,32768
v_min3_u32 v27,v27,v232,v236
s_waitcnt lgkmcnt(5)
v_mfma_f32_16x16x32_bf16 v[76:79],a[136:139],v[232:235],v[76:79]
ds_read_b128 v[228:231],v17 offset:19456
buffer_load_dwordx4 v16,s[20:23],s65 offen offset:0 sc1 lds
v_mfma_f32_16x16x32_bf16 v[68:71],a[12:15],v[236:239],v[68:71]
v_lshlrev_b32 v88,16,v120
v_and_b32 v89,s80,v120
v_lshlrev_b32 v90,16,v121
v_mfma_f32_16x16x32_bf16 v[76:79],a[140:143],v[236:239],v[76:79]
ds_read_b128 v[232:235],v17 offset:21504
v_and_b32 v91,s80,v121
s_waitcnt lgkmcnt(5)
v_mfma_f32_16x16x32_bf16 v[68:71],a[16:19],v[240:243],v[68:71]
buffer_load_dwordx4 v16,s[20:23],s65 offen offset:2048 sc1 lds
s_xor_b32 m0,s72,32768
v_mfma_f32_16x16x32_bf16 v[76:79],a[144:147],v[240:243],v[76:79]
ds_read_b128 v[236:239],v17 offset:23552
s_add_u32 s65,s88,65536
v_lshlrev_b32 v92,16,v122
v_mfma_f32_16x16x32_bf16 v[68:71],a[20:23],v[244:247],v[68:71]
v_min3_u32 v27,v27,v240,v244
v_and_b32 v93,s80,v122
v_lshlrev_b32 v94,16,v123
v_mfma_f32_16x16x32_bf16 v[76:79],a[148:151],v[244:247],v[76:79]
ds_read_b128 v[240:243],v17 offset:25600
v_and_b32 v95,s80,v123
s_waitcnt lgkmcnt(5)
v_mfma_f32_16x16x32_bf16 v[68:71],a[24:27],v[248:251],v[68:71]
buffer_load_dwordx4 v16,s[20:23],s65 offen offset:0 sc1 lds
v_add_f32 v88,v64,v88
v_mfma_f32_16x16x32_bf16 v[76:79],a[152:155],v[248:251],v[76:79]
ds_read_b128 v[244:247],v17 offset:27648
buffer_load_dwordx4 v16,s[20:23],s65 offen offset:2048 sc1 lds
v_mfma_f32_16x16x32_bf16 v[68:71],a[28:31],v[252:255],v[68:71]
s_xor_b32 m0,s72,49152
v_min3_u32 v27,v27,v248,v252
v_add_f32 v89,v65,v89
v_mfma_f32_16x16x32_bf16 v[76:79],a[156:159],v[252:255],v[76:79]
ds_read_b128 v[248:251],v17 offset:29696
s_add_u32 s65,s88,98304
s_waitcnt lgkmcnt(5)
v_mfma_f32_16x16x32_bf16 v[68:71],a[32:35],v[224:227],v[68:71]
buffer_load_dwordx4 v16,s[20:23],s65 offen offset:0 sc1 lds
v_add_f32 v90,v66,v90
v_mfma_f32_16x16x32_bf16 v[76:79],a[160:163],v[224:227],v[76:79]
ds_read_b128 v[252:255],v17 offset:31744
v_min3_u32 v27,v27,v224,v228
v_add_f32 v91,v67,v91
v_mfma_f32_16x16x32_bf16 v[68:71],a[36:39],v[228:231],v[68:71]
buffer_load_dwordx4 v16,s[20:23],s65 offen offset:2048 sc1 lds
v_add_f32 v92,v72,v92
v_mfma_f32_16x16x32_bf16 v[76:79],a[164:167],v[228:231],v[76:79]
s_waitcnt vmcnt(10)
s_barrier
ds_read_b128 v[224:227],v17 offset:33792
s_waitcnt lgkmcnt(5)
v_mfma_f32_16x16x32_bf16 v[68:71],a[40:43],v[232:235],v[68:71]
s_xor_b32 m0,s72,1024
s_add_u32 s65,s89,0
v_add_f32 v93,v73,v93
v_mfma_f32_16x16x32_bf16 v[76:79],a[168:171],v[232:235],v[76:79]
ds_read_b128 v[228:231],v17 offset:35840
v_min3_u32 v27,v27,v232,v236
v_add_f32 v94,v74,v94
v_mfma_f32_16x16x32_bf16 v[68:71],a[44:47],v[236:239],v[68:71]
buffer_load_dwordx4 v16,s[20:23],s65 offen offset:0 sc1 lds
v_add_f32 v95,v75,v95
v_mfma_f32_16x16x32_bf16 v[76:79],a[172:175],v[236:239],v[76:79]
ds_read_b128 v[232:235],v17 offset:37888
v_cvt_pk_bf16_f32 v96,v88,v89
s_waitcnt lgkmcnt(5)
v_mfma_f32_16x16x32_bf16 v[68:71],a[48:51],v[240:243],v[68:71]
buffer_load_dwordx4 v16,s[20:23],s65 offen offset:2048 sc1 lds
v_cvt_pk_bf16_f32 v97,v90,v91
v_mfma_f32_16x16x32_bf16 v[76:79],a[176:179],v[240:243],v[76:79]
ds_read_b128 v[236:239],v17 offset:39936
s_xor_b32 m0,s72,17408
v_cvt_pk_bf16_f32 v98,v92,v93
v_mfma_f32_16x16x32_bf16 v[68:71],a[52:55],v[244:247],v[68:71]
s_add_u32 s65,s89,32768
v_min3_u32 v27,v27,v240,v244
v_cvt_pk_bf16_f32 v99,v94,v95
v_mfma_f32_16x16x32_bf16 v[76:79],a[180:183],v[244:247],v[76:79]
ds_read_b128 v[240:243],v17 offset:41984
v_max_u32 v96,1,v96
s_waitcnt lgkmcnt(5)
v_mfma_f32_16x16x32_bf16 v[68:71],a[56:59],v[248:251],v[68:71]
buffer_load_dwordx4 v16,s[20:23],s65 offen offset:0 sc1 lds
v_mfma_f32_16x16x32_bf16 v[76:79],a[184:187],v[248:251],v[76:79]
ds_read_b128 v[244:247],v17 offset:44032
v_min3_u32 v27,v27,v248,v252
v_mfma_f32_16x16x32_bf16 v[68:71],a[60:63],v[252:255],v[68:71]
buffer_load_dwordx4 v16,s[20:23],s65 offen offset:2048 sc1 lds
v_mfma_f32_16x16x32_bf16 v[76:79],a[188:191],v[252:255],v[76:79]
ds_read_b128 v[248:251],v17 offset:46080
s_waitcnt lgkmcnt(5)
v_mfma_f32_16x16x32_bf16 v[68:71],a[64:67],v[224:227],v[68:71]
s_xor_b32 m0,s72,33792
s_add_u32 s65,s89,65536
v_mfma_f32_16x16x32_bf16 v[76:79],a[192:195],v[224:227],v[76:79]
ds_read_b128 v[252:255],v17 offset:48128
v_min3_u32 v27,v27,v224,v228
v_mfma_f32_16x16x32_bf16 v[68:71],a[68:71],v[228:231],v[68:71]
buffer_load_dwordx4 v16,s[20:23],s65 offen offset:0 sc1 lds
v_mfma_f32_16x16x32_bf16 v[76:79],a[196:199],v[228:231],v[76:79]
ds_read_b128 v[224:227],v17 offset:50176
s_waitcnt lgkmcnt(5)
v_mfma_f32_16x16x32_bf16 v[68:71],a[72:75],v[232:235],v[68:71]
buffer_load_dwordx4 v16,s[20:23],s65 offen offset:2048 sc1 lds
v_mfma_f32_16x16x32_bf16 v[76:79],a[200:203],v[232:235],v[76:79]
ds_read_b128 v[228:231],v17 offset:52224
s_xor_b32 m0,s72,50176
v_mfma_f32_16x16x32_bf16 v[68:71],a[76:79],v[236:239],v[68:71]
s_add_u32 s65,s89,98304
v_min3_u32 v27,v27,v232,v236
v_mfma_f32_16x16x32_bf16 v[76:79],a[204:207],v[236:239],v[76:79]
ds_read_b128 v[232:235],v17 offset:54272
s_waitcnt lgkmcnt(5)
v_mfma_f32_16x16x32_bf16 v[68:71],a[80:83],v[240:243],v[68:71]
buffer_load_dwordx4 v16,s[20:23],s65 offen offset:0 sc1 lds
v_mfma_f32_16x16x32_bf16 v[76:79],a[208:211],v[240:243],v[76:79]
ds_read_b128 v[236:239],v17 offset:56320
v_min3_u32 v27,v27,v240,v244
v_mfma_f32_16x16x32_bf16 v[68:71],a[84:87],v[244:247],v[68:71]
buffer_load_dwordx4 v16,s[20:23],s65 offen offset:2048 sc1 lds
v_mfma_f32_16x16x32_bf16 v[76:79],a[212:215],v[244:247],v[76:79]
ds_read_b128 v[240:243],v17 offset:58368
s_waitcnt lgkmcnt(5)
v_mfma_f32_16x16x32_bf16 v[68:71],a[88:91],v[248:251],v[68:71]
v_min3_u32 v27,v27,v248,v252
buffer_store_dwordx4 v[96:99],v18,s[20:23],s70 offen offset:0 sc1
v_mfma_f32_16x16x32_bf16 v[76:79],a[216:219],v[248:251],v[76:79]
ds_read_b128 v[244:247],v17 offset:60416
v_lshlrev_b32 v88,16,v96
v_and_b32 v89,s80,v96
v_mfma_f32_16x16x32_bf16 v[68:71],a[92:95],v[252:255],v[68:71]
v_lshlrev_b32 v90,16,v97
v_and_b32 v91,s80,v97
v_lshlrev_b32 v92,16,v98
v_mfma_f32_16x16x32_bf16 v[76:79],a[220:223],v[252:255],v[76:79]
ds_read_b128 v[248:251],v17 offset:62464
v_and_b32 v93,s80,v98
s_waitcnt lgkmcnt(5)
v_mfma_f32_16x16x32_bf16 v[68:71],a[96:99],v[224:227],v[68:71]
v_min3_u32 v27,v27,v224,v228
v_lshlrev_b32 v94,16,v99
v_and_b32 v95,s80,v99
v_mfma_f32_16x16x32_bf16 v[76:79],a[224:227],v[224:227],v[76:79]
ds_read_b128 v[252:255],v17 offset:64512
v_add_f32 v108,v88,v89
v_mul_f32 v109,v88,v88
v_mfma_f32_16x16x32_bf16 v[68:71],a[100:103],v[228:231],v[68:71]
v_add_f32 v100,v90,v91
v_mul_f32 v101,v89,v89
v_fmac_f32 v109,v90,v90
v_mfma_f32_16x16x32_bf16 v[76:79],a[228:231],v[228:231],v[76:79]
v_fmac_f32 v101,v91,v91
v_fmac_f32 v109,v92,v92
s_waitcnt lgkmcnt(4)
v_mfma_f32_16x16x32_bf16 v[68:71],a[104:107],v[232:235],v[68:71]
v_min3_u32 v27,v27,v232,v236
v_fmac_f32 v101,v93,v93
v_add_f32 v108,v108,v92
v_mfma_f32_16x16x32_bf16 v[76:79],a[232:235],v[232:235],v[76:79]
v_add_f32 v100,v100,v93
v_fmac_f32 v109,v94,v94
v_fmac_f32 v101,v95,v95
v_mfma_f32_16x16x32_bf16 v[68:71],a[108:111],v[236:239],v[68:71]
v_add_f32 v108,v108,v94
v_add_f32 v100,v100,v95
v_add_f32 v108,v108,v100
v_mfma_f32_16x16x32_bf16 v[76:79],a[236:239],v[236:239],v[76:79]
v_add_f32 v109,v109,v101
v_mov_b32 v100,v108
s_waitcnt lgkmcnt(2)
v_mfma_f32_16x16x32_bf16 v[68:71],a[112:115],v[240:243],v[68:71]
v_min3_u32 v27,v27,v240,v244
v_mov_b32 v101,v109
v_permlane16_swap_b32 v100,v108
v_mfma_f32_16x16x32_bf16 v[76:79],a[240:243],v[240:243],v[76:79]
v_permlane16_swap_b32 v101,v109
v_add_f32 v108,v108,v100
v_add_f32 v109,v109,v101
v_mfma_f32_16x16x32_bf16 v[68:71],a[116:119],v[244:247],v[68:71]
v_mov_b32 v100,v108
v_mov_b32 v101,v109
s_nop 0
v_permlane32_swap_b32 v100,v108
v_mfma_f32_16x16x32_bf16 v[76:79],a[244:247],v[244:247],v[76:79]
v_permlane32_swap_b32 v101,v109
v_add_f32 v108,v108,v100
s_waitcnt lgkmcnt(0)
v_mfma_f32_16x16x32_bf16 v[68:71],a[120:123],v[248:251],v[68:71]
v_min3_u32 v27,v27,v248,v252
v_add_f32 v109,v109,v101
v_min3_u32 v27,v27,v120,v122
v_mfma_f32_16x16x32_bf16 v[76:79],a[248:251],v[248:251],v[76:79]
v_min3_u32 v27,v27,v124,v126
v_lshlrev_b32 v32,16,v124
v_and_b32 v33,s80,v124
v_mfma_f32_16x16x32_bf16 v[68:71],a[124:127],v[252:255],v[68:71]
v_lshlrev_b32 v34,16,v125
v_and_b32 v35,s80,v125
v_lshlrev_b32 v36,16,v126
v_mfma_f32_16x16x32_bf16 v[76:79],a[252:255],v[252:255],v[76:79]
v_and_b32 v37,s80,v126
v_lshlrev_b32 v38,16,v127
v_and_b32 v39,s80,v127
v_cmp_eq_u32 vcc,0,v27
s_cbranch_vccnz retry_239
s_branch epi_242
ahead_241:
s_cmp_eq_u32 s93,0
s_cbranch_scc1 both_243
s_waitcnt vmcnt(13) lgkmcnt(0)
s_barrier
ds_read_b128 v[224:227],v17 offset:0
ds_read_b128 v[228:231],v17 offset:2048
ds_read_b128 v[232:235],v17 offset:4096
ds_read_b128 v[236:239],v17 offset:6144
ds_read_b128 v[240:243],v17 offset:8192
ds_read_b128 v[244:247],v17 offset:10240
ds_read_b128 v[248:251],v17 offset:12288
s_waitcnt lgkmcnt(5)
v_mfma_f32_16x16x32_bf16 v[64:67],a[0:3],v[224:227],0
s_add_u32 s96,s71,1
s_add_u32 s92,s71,2
v_min_u32 v27,v224,v228
s_add_u32 m0,s43,0
v_mfma_f32_16x16x32_bf16 v[72:75],a[128:131],v[224:227],0
ds_read_b128 v[252:255],v17 offset:14336
s_cmp_eq_u32 s96,64
s_cselect_b32 s96,99,s96
v_mfma_f32_16x16x32_bf16 v[64:67],a[4:7],v[228:231],v[64:67]
s_cmp_eq_u32 s92,64
s_cselect_b32 s92,99,s92
buffer_load_dwordx4 v19,s[20:23],s78 offen sc1 lds
v_mfma_f32_16x16x32_bf16 v[72:75],a[132:135],v[228:231],v[72:75]
ds_read_b128 v[224:227],v17 offset:16384
s_add_u32 m0,s43,1024
s_waitcnt lgkmcnt(5)
v_mfma_f32_16x16x32_bf16 v[64:67],a[8:11],v[232:235],v[64:67]
s_cmp_eq_u32 s96,65
s_cselect_b32 s96,64,s96
buffer_load_dwordx4 v20,s[20:23],s78 offen sc1 lds
v_mfma_f32_16x16x32_bf16 v[72:75],a[136:139],v[232:235],v[72:75]
ds_read_b128 v[228:231],v17 offset:18432
v_min3_u32 v27,v27,v232,v236
v_mfma_f32_16x16x32_bf16 v[64:67],a[12:15],v[236:239],v[64:67]
v_mfma_f32_16x16x32_bf16 v[72:75],a[140:143],v[236:239],v[72:75]
ds_read_b128 v[232:235],v17 offset:20480
s_waitcnt lgkmcnt(5)
v_mfma_f32_16x16x32_bf16 v[64:67],a[16:19],v[240:243],v[64:67]
v_min3_u32 v27,v27,v240,v244
v_mfma_f32_16x16x32_bf16 v[72:75],a[144:147],v[240:243],v[72:75]
ds_read_b128 v[236:239],v17 offset:22528
v_mfma_f32_16x16x32_bf16 v[64:67],a[20:23],v[244:247],v[64:67]
v_mfma_f32_16x16x32_bf16 v[72:75],a[148:151],v[244:247],v[72:75]
ds_read_b128 v[240:243],v17 offset:24576
s_waitcnt lgkmcnt(5)
v_mfma_f32_16x16x32_bf16 v[64:67],a[24:27],v[248:251],v[64:67]
v_min3_u32 v27,v27,v248,v252
v_mfma_f32_16x16x32_bf16 v[72:75],a[152:155],v[248:251],v[72:75]
ds_read_b128 v[244:247],v17 offset:26624
v_mfma_f32_16x16x32_bf16 v[64:67],a[28:31],v[252:255],v[64:67]
v_mfma_f32_16x16x32_bf16 v[72:75],a[156:159],v[252:255],v[72:75]
ds_read_b128 v[248:251],v17 offset:28672
s_waitcnt lgkmcnt(5)
v_mfma_f32_16x16x32_bf16 v[64:67],a[32:35],v[224:227],v[64:67]
v_min3_u32 v27,v27,v224,v228
v_mfma_f32_16x16x32_bf16 v[72:75],a[160:163],v[224:227],v[72:75]
ds_read_b128 v[252:255],v17 offset:30720
v_mfma_f32_16x16x32_bf16 v[64:67],a[36:39],v[228:231],v[64:67]
v_mfma_f32_16x16x32_bf16 v[72:75],a[164:167],v[228:231],v[72:75]
ds_read_b128 v[224:227],v17 offset:32768
s_waitcnt lgkmcnt(5)
v_mfma_f32_16x16x32_bf16 v[64:67],a[40:43],v[232:235],v[64:67]
v_min3_u32 v27,v27,v232,v236
v_mfma_f32_16x16x32_bf16 v[72:75],a[168:171],v[232:235],v[72:75]
ds_read_b128 v[228:231],v17 offset:34816
v_mfma_f32_16x16x32_bf16 v[64:67],a[44:47],v[236:239],v[64:67]
v_mfma_f32_16x16x32_bf16 v[72:75],a[172:175],v[236:239],v[72:75]
ds_read_b128 v[232:235],v17 offset:36864
s_waitcnt lgkmcnt(5)
v_mfma_f32_16x16x32_bf16 v[64:67],a[48:51],v[240:243],v[64:67]
v_min3_u32 v27,v27,v240,v244
v_mfma_f32_16x16x32_bf16 v[72:75],a[176:179],v[240:243],v[72:75]
ds_read_b128 v[236:239],v17 offset:38912
v_mfma_f32_16x16x32_bf16 v[64:67],a[52:55],v[244:247],v[64:67]
v_mfma_f32_16x16x32_bf16 v[72:75],a[180:183],v[244:247],v[72:75]
ds_read_b128 v[240:243],v17 offset:40960
s_waitcnt lgkmcnt(5)
v_mfma_f32_16x16x32_bf16 v[64:67],a[56:59],v[248:251],v[64:67]
v_min3_u32 v27,v27,v248,v252
v_mfma_f32_16x16x32_bf16 v[72:75],a[184:187],v[248:251],v[72:75]
ds_read_b128 v[244:247],v17 offset:43008
s_waitcnt vmcnt(5)
v_mfma_f32_16x16x32_bf16 v[64:67],a[60:63],v[252:255],v[64:67]
v_cmp_gt_u32 vcc,s96,v29
v_cmp_gt_u32 s[92:93],s92,v29
v_mfma_f32_16x16x32_bf16 v[72:75],a[188:191],v[252:255],v[72:75]
ds_read_b128 v[248:251],v17 offset:45056
s_waitcnt lgkmcnt(5)
v_mfma_f32_16x16x32_bf16 v[64:67],a[64:67],v[224:227],v[64:67]
v_mov_b32 v44,vcc_lo
v_mov_b32 v45,s92
v_mfma_f32_16x16x32_bf16 v[72:75],a[192:195],v[224:227],v[72:75]
ds_read_b128 v[252:255],v17 offset:47104
ds_write_b64 v46,v[44:45]
v_mfma_f32_16x16x32_bf16 v[64:67],a[68:71],v[228:231],v[64:67]
v_min3_u32 v27,v27,v224,v228
v_mfma_f32_16x16x32_bf16 v[72:75],a[196:199],v[228:231],v[72:75]
ds_read_b128 v[224:227],v17 offset:49152
s_waitcnt lgkmcnt(6)
v_mfma_f32_16x16x32_bf16 v[64:67],a[72:75],v[232:235],v[64:67]
v_min3_u32 v27,v27,v232,v236
v_mfma_f32_16x16x32_bf16 v[72:75],a[200:203],v[232:235],v[72:75]
ds_read_b128 v[228:231],v17 offset:51200
v_mfma_f32_16x16x32_bf16 v[64:67],a[76:79],v[236:239],v[64:67]
v_mfma_f32_16x16x32_bf16 v[72:75],a[204:207],v[236:239],v[72:75]
ds_read_b128 v[232:235],v17 offset:53248
s_waitcnt lgkmcnt(6)
v_mfma_f32_16x16x32_bf16 v[64:67],a[80:83],v[240:243],v[64:67]
v_min3_u32 v27,v27,v240,v244
s_add_u32 s88,s70,s75
v_mfma_f32_16x16x32_bf16 v[72:75],a[208:211],v[240:243],v[72:75]
ds_read_b128 v[236:239],v17 offset:55296
s_add_u32 s88,s88,2097152
v_mfma_f32_16x16x32_bf16 v[64:67],a[84:87],v[244:247],v[64:67]
s_xor_b32 s88,s88,0x2000
s_xor_b32 s89,s88,1024
v_mfma_f32_16x16x32_bf16 v[72:75],a[212:215],v[244:247],v[72:75]
ds_read_b128 v[240:243],v17 offset:57344
s_waitcnt lgkmcnt(6)
v_mfma_f32_16x16x32_bf16 v[64:67],a[88:91],v[248:251],v[64:67]
v_min3_u32 v27,v27,v248,v252
v_mfma_f32_16x16x32_bf16 v[72:75],a[216:219],v[248:251],v[72:75]
ds_read_b128 v[244:247],v17 offset:59392
v_mfma_f32_16x16x32_bf16 v[64:67],a[92:95],v[252:255],v[64:67]
v_mfma_f32_16x16x32_bf16 v[72:75],a[220:223],v[252:255],v[72:75]
ds_read_b128 v[248:251],v17 offset:61440
s_waitcnt lgkmcnt(5)
v_mfma_f32_16x16x32_bf16 v[64:67],a[96:99],v[224:227],v[64:67]
v_min3_u32 v27,v27,v224,v228
v_mfma_f32_16x16x32_bf16 v[72:75],a[224:227],v[224:227],v[72:75]
ds_read_b128 v[252:255],v17 offset:63488
v_mfma_f32_16x16x32_bf16 v[64:67],a[100:103],v[228:231],v[64:67]
s_waitcnt vmcnt(2)
v_add_u32 v22,s71,-1
v_mfma_f32_16x16x32_bf16 v[72:75],a[228:231],v[228:231],v[72:75]
s_waitcnt vmcnt(7)
s_barrier
ds_read_b64 v[44:45],v47
ds_read_b128 v[224:227],v17 offset:1024
s_waitcnt lgkmcnt(6)
v_mfma_f32_16x16x32_bf16 v[64:67],a[104:107],v[232:235],v[64:67]
v_min3_u32 v27,v27,v232,v236
v_mfma_f32_16x16x32_bf16 v[72:75],a[232:235],v[232:235],v[72:75]
ds_read_b128 v[228:231],v17 offset:3072
v_mfma_f32_16x16x32_bf16 v[64:67],a[108:111],v[236:239],v[64:67]
buffer_store_dword v22,v23,s[20:23],s97 offen sc1
s_waitcnt vmcnt(1)
v_mfma_f32_16x16x32_bf16 v[72:75],a[236:239],v[236:239],v[72:75]
ds_read_b128 v[232:235],v17 offset:5120
s_waitcnt lgkmcnt(6)
v_mfma_f32_16x16x32_bf16 v[64:67],a[112:115],v[240:243],v[64:67]
v_min3_u32 v27,v27,v240,v244
s_mov_b32 s97,0x7fff0000
v_mfma_f32_16x16x32_bf16 v[72:75],a[240:243],v[240:243],v[72:75]
ds_read_b128 v[236:239],v17 offset:7168
ds_read_b64 v[120:121],v40 offset:0
v_mfma_f32_16x16x32_bf16 v[64:67],a[116:119],v[244:247],v[64:67]
ds_read_b64 v[122:123],v41 offset:0
ds_read_b64 v[124:125],v40 offset:1024
v_mfma_f32_16x16x32_bf16 v[72:75],a[244:247],v[244:247],v[72:75]
ds_read_b128 v[240:243],v17 offset:9216
s_waitcnt lgkmcnt(9)
v_mfma_f32_16x16x32_bf16 v[64:67],a[120:123],v[248:251],v[64:67]
s_waitcnt lgkmcnt(8)
v_readfirstlane_b32 s93,v45
v_mfma_f32_16x16x32_bf16 v[72:75],a[248:251],v[248:251],v[72:75]
ds_read_b128 v[244:247],v17 offset:11264
v_readfirstlane_b32 s83,v44
s_cmp_lg_u32 s83,0
s_cbranch_scc1 keep_251
v_mfma_f32_16x16x32_bf16 v[64:67],a[124:127],v[252:255],v[64:67]
v_min3_u32 v27,v27,v248,v252
ds_read_b64 v[126:127],v41 offset:1024
s_xor_b32 m0,s72,0
v_mfma_f32_16x16x32_bf16 v[72:75],a[252:255],v[252:255],v[72:75]
ds_read_b128 v[248:251],v17 offset:13312
s_add_u32 s65,s88,0
s_waitcnt lgkmcnt(9)
v_mfma_f32_16x16x32_bf16 v[68:71],a[0:3],v[224:227],0
buffer_load_dwordx4 v16,s[20:23],s65 offen offset:0 sc1 lds
v_min3_u32 v27,v27,v224,v228
v_mfma_f32_16x16x32_bf16 v[76:79],a[128:131],v[224:227],0
ds_read_b128 v[252:255],v17 offset:15360
buffer_load_dwordx4 v16,s[20:23],s65 offen offset:2048 sc1 lds
v_mfma_f32_16x16x32_bf16 v[68:71],a[4:7],v[228:231],v[68:71]
v_cmp_eq_u32 vcc,0,v27
s_cbranch_vccnz retry_239
v_mfma_f32_16x16x32_bf16 v[76:79],a[132:135],v[228:231],v[76:79]
ds_read_b128 v[224:227],v17 offset:17408
s_xor_b32 m0,s72,16384
s_waitcnt lgkmcnt(9)
v_mfma_f32_16x16x32_bf16 v[68:71],a[8:11],v[232:235],v[68:71]
s_add_u32 s65,s88,32768
v_min3_u32 v27,v27,v232,v236
s_waitcnt lgkmcnt(3)
v_mfma_f32_16x16x32_bf16 v[76:79],a[136:139],v[232:235],v[76:79]
ds_read_b128 v[228:231],v17 offset:19456
buffer_load_dwordx4 v16,s[20:23],s65 offen offset:0 sc1 lds
v_mfma_f32_16x16x32_bf16 v[68:71],a[12:15],v[236:239],v[68:71]
v_lshlrev_b32 v88,16,v120
v_and_b32 v89,s80,v120
v_lshlrev_b32 v90,16,v121
v_mfma_f32_16x16x32_bf16 v[76:79],a[140:143],v[236:239],v[76:79]
ds_read_b128 v[232:235],v17 offset:21504
v_and_b32 v91,s80,v121
v_mfma_f32_16x16x32_bf16 v[68:71],a[16:19],v[240:243],v[68:71]
buffer_load_dwordx4 v16,s[20:23],s65 offen offset:2048 sc1 lds
s_xor_b32 m0,s72,32768
v_mfma_f32_16x16x32_bf16 v[76:79],a[144:147],v[240:243],v[76:79]
ds_read_b128 v[236:239],v17 offset:23552
s_add_u32 s65,s88,65536
v_lshlrev_b32 v92,16,v122
v_mfma_f32_16x16x32_bf16 v[68:71],a[20:23],v[244:247],v[68:71]
v_min3_u32 v27,v27,v240,v244
v_and_b32 v93,s80,v122
v_lshlrev_b32 v94,16,v123
v_mfma_f32_16x16x32_bf16 v[76:79],a[148:151],v[244:247],v[76:79]
ds_read_b128 v[240:243],v17 offset:25600
v_and_b32 v95,s80,v123
s_waitcnt lgkmcnt(5)
v_mfma_f32_16x16x32_bf16 v[68:71],a[24:27],v[248:251],v[68:71]
buffer_load_dwordx4 v16,s[20:23],s65 offen offset:0 sc1 lds
v_add_f32 v88,v64,v88
v_mfma_f32_16x16x32_bf16 v[76:79],a[152:155],v[248:251],v[76:79]
ds_read_b128 v[244:247],v17 offset:27648
buffer_load_dwordx4 v16,s[20:23],s65 offen offset:2048 sc1 lds
v_mfma_f32_16x16x32_bf16 v[68:71],a[28:31],v[252:255],v[68:71]
s_xor_b32 m0,s72,49152
v_min3_u32 v27,v27,v248,v252
v_add_f32 v89,v65,v89
v_mfma_f32_16x16x32_bf16 v[76:79],a[156:159],v[252:255],v[76:79]
ds_read_b128 v[248:251],v17 offset:29696
s_add_u32 s65,s88,98304
s_waitcnt lgkmcnt(5)
v_mfma_f32_16x16x32_bf16 v[68:71],a[32:35],v[224:227],v[68:71]
buffer_load_dwordx4 v16,s[20:23],s65 offen offset:0 sc1 lds
v_add_f32 v90,v66,v90
v_mfma_f32_16x16x32_bf16 v[76:79],a[160:163],v[224:227],v[76:79]
ds_read_b128 v[252:255],v17 offset:31744
v_min3_u32 v27,v27,v224,v228
v_add_f32 v91,v67,v91
v_mfma_f32_16x16x32_bf16 v[68:71],a[36:39],v[228:231],v[68:71]
buffer_load_dwordx4 v16,s[20:23],s65 offen offset:2048 sc1 lds
v_add_f32 v92,v72,v92
v_mfma_f32_16x16x32_bf16 v[76:79],a[164:167],v[228:231],v[76:79]
ds_read_b128 v[224:227],v17 offset:33792
v_add_f32 v93,v73,v93
s_waitcnt lgkmcnt(5)
v_mfma_f32_16x16x32_bf16 v[68:71],a[40:43],v[232:235],v[68:71]
s_xor_b32 m0,s72,1024
s_add_u32 s65,s89,0
v_add_f32 v94,v74,v94
v_mfma_f32_16x16x32_bf16 v[76:79],a[168:171],v[232:235],v[76:79]
ds_read_b128 v[228:231],v17 offset:35840
v_min3_u32 v27,v27,v232,v236
v_add_f32 v95,v75,v95
v_mfma_f32_16x16x32_bf16 v[68:71],a[44:47],v[236:239],v[68:71]
buffer_load_dwordx4 v16,s[20:23],s65 offen offset:0 sc1 lds
v_cvt_pk_bf16_f32 v96,v88,v89
v_mfma_f32_16x16x32_bf16 v[76:79],a[172:175],v[236:239],v[76:79]
ds_read_b128 v[232:235],v17 offset:37888
v_cvt_pk_bf16_f32 v97,v90,v91
s_waitcnt lgkmcnt(5)
v_mfma_f32_16x16x32_bf16 v[68:71],a[48:51],v[240:243],v[68:71]
buffer_load_dwordx4 v16,s[20:23],s65 offen offset:2048 sc1 lds
v_cvt_pk_bf16_f32 v98,v92,v93
v_mfma_f32_16x16x32_bf16 v[76:79],a[176:179],v[240:243],v[76:79]
ds_read_b128 v[236:239],v17 offset:39936
s_xor_b32 m0,s72,17408
v_cvt_pk_bf16_f32 v99,v94,v95
v_mfma_f32_16x16x32_bf16 v[68:71],a[52:55],v[244:247],v[68:71]
s_add_u32 s65,s89,32768
v_min3_u32 v27,v27,v240,v244
v_max_u32 v96,1,v96
v_mfma_f32_16x16x32_bf16 v[76:79],a[180:183],v[244:247],v[76:79]
ds_read_b128 v[240:243],v17 offset:41984
s_waitcnt lgkmcnt(5)
v_mfma_f32_16x16x32_bf16 v[68:71],a[56:59],v[248:251],v[68:71]
buffer_load_dwordx4 v16,s[20:23],s65 offen offset:0 sc1 lds
v_mfma_f32_16x16x32_bf16 v[76:79],a[184:187],v[248:251],v[76:79]
ds_read_b128 v[244:247],v17 offset:44032
v_min3_u32 v27,v27,v248,v252
v_mfma_f32_16x16x32_bf16 v[68:71],a[60:63],v[252:255],v[68:71]
buffer_load_dwordx4 v16,s[20:23],s65 offen offset:2048 sc1 lds
v_mfma_f32_16x16x32_bf16 v[76:79],a[188:191],v[252:255],v[76:79]
ds_read_b128 v[248:251],v17 offset:46080
s_waitcnt lgkmcnt(5)
v_mfma_f32_16x16x32_bf16 v[68:71],a[64:67],v[224:227],v[68:71]
s_xor_b32 m0,s72,33792
s_add_u32 s65,s89,65536
v_mfma_f32_16x16x32_bf16 v[76:79],a[192:195],v[224:227],v[76:79]
ds_read_b128 v[252:255],v17 offset:48128
v_min3_u32 v27,v27,v224,v228
v_mfma_f32_16x16x32_bf16 v[68:71],a[68:71],v[228:231],v[68:71]
buffer_load_dwordx4 v16,s[20:23],s65 offen offset:0 sc1 lds
v_mfma_f32_16x16x32_bf16 v[76:79],a[196:199],v[228:231],v[76:79]
ds_read_b128 v[224:227],v17 offset:50176
s_waitcnt lgkmcnt(5)
v_mfma_f32_16x16x32_bf16 v[68:71],a[72:75],v[232:235],v[68:71]
buffer_load_dwordx4 v16,s[20:23],s65 offen offset:2048 sc1 lds
v_mfma_f32_16x16x32_bf16 v[76:79],a[200:203],v[232:235],v[76:79]
ds_read_b128 v[228:231],v17 offset:52224
s_xor_b32 m0,s72,50176
v_mfma_f32_16x16x32_bf16 v[68:71],a[76:79],v[236:239],v[68:71]
s_add_u32 s65,s89,98304
v_min3_u32 v27,v27,v232,v236
v_mfma_f32_16x16x32_bf16 v[76:79],a[204:207],v[236:239],v[76:79]
ds_read_b128 v[232:235],v17 offset:54272
s_waitcnt lgkmcnt(5)
v_mfma_f32_16x16x32_bf16 v[68:71],a[80:83],v[240:243],v[68:71]
buffer_load_dwordx4 v16,s[20:23],s65 offen offset:0 sc1 lds
v_mfma_f32_16x16x32_bf16 v[76:79],a[208:211],v[240:243],v[76:79]
ds_read_b128 v[236:239],v17 offset:56320
v_min3_u32 v27,v27,v240,v244
v_mfma_f32_16x16x32_bf16 v[68:71],a[84:87],v[244:247],v[68:71]
buffer_load_dwordx4 v16,s[20:23],s65 offen offset:2048 sc1 lds
v_mfma_f32_16x16x32_bf16 v[76:79],a[212:215],v[244:247],v[76:79]
ds_read_b128 v[240:243],v17 offset:58368
s_waitcnt lgkmcnt(5)
v_mfma_f32_16x16x32_bf16 v[68:71],a[88:91],v[248:251],v[68:71]
v_min3_u32 v27,v27,v248,v252
buffer_store_dwordx4 v[96:99],v18,s[20:23],s70 offen offset:0 sc1
v_mfma_f32_16x16x32_bf16 v[76:79],a[216:219],v[248:251],v[76:79]
ds_read_b128 v[244:247],v17 offset:60416
v_lshlrev_b32 v88,16,v96
v_and_b32 v89,s80,v96
v_mfma_f32_16x16x32_bf16 v[68:71],a[92:95],v[252:255],v[68:71]
v_lshlrev_b32 v90,16,v97
v_and_b32 v91,s80,v97
v_lshlrev_b32 v92,16,v98
v_mfma_f32_16x16x32_bf16 v[76:79],a[220:223],v[252:255],v[76:79]
ds_read_b128 v[248:251],v17 offset:62464
v_and_b32 v93,s80,v98
s_waitcnt lgkmcnt(5)
v_mfma_f32_16x16x32_bf16 v[68:71],a[96:99],v[224:227],v[68:71]
v_min3_u32 v27,v27,v224,v228
v_lshlrev_b32 v94,16,v99
v_and_b32 v95,s80,v99
v_mfma_f32_16x16x32_bf16 v[76:79],a[224:227],v[224:227],v[76:79]
ds_read_b128 v[252:255],v17 offset:64512
v_add_f32 v108,v88,v89
v_mul_f32 v109,v88,v88
v_mfma_f32_16x16x32_bf16 v[68:71],a[100:103],v[228:231],v[68:71]
v_add_f32 v100,v90,v91
v_mul_f32 v101,v89,v89
v_fmac_f32 v109,v90,v90
v_mfma_f32_16x16x32_bf16 v[76:79],a[228:231],v[228:231],v[76:79]
v_fmac_f32 v101,v91,v91
v_fmac_f32 v109,v92,v92
s_waitcnt lgkmcnt(4)
v_mfma_f32_16x16x32_bf16 v[68:71],a[104:107],v[232:235],v[68:71]
v_min3_u32 v27,v27,v232,v236
v_fmac_f32 v101,v93,v93
v_add_f32 v108,v108,v92
v_mfma_f32_16x16x32_bf16 v[76:79],a[232:235],v[232:235],v[76:79]
v_add_f32 v100,v100,v93
v_fmac_f32 v109,v94,v94
v_fmac_f32 v101,v95,v95
v_mfma_f32_16x16x32_bf16 v[68:71],a[108:111],v[236:239],v[68:71]
v_add_f32 v108,v108,v94
v_add_f32 v100,v100,v95
v_add_f32 v108,v108,v100
v_mfma_f32_16x16x32_bf16 v[76:79],a[236:239],v[236:239],v[76:79]
v_add_f32 v109,v109,v101
v_mov_b32 v100,v108
s_waitcnt lgkmcnt(2)
v_mfma_f32_16x16x32_bf16 v[68:71],a[112:115],v[240:243],v[68:71]
v_min3_u32 v27,v27,v240,v244
v_mov_b32 v101,v109
v_permlane16_swap_b32 v100,v108
v_mfma_f32_16x16x32_bf16 v[76:79],a[240:243],v[240:243],v[76:79]
v_permlane16_swap_b32 v101,v109
v_add_f32 v108,v108,v100
v_add_f32 v109,v109,v101
v_mfma_f32_16x16x32_bf16 v[68:71],a[116:119],v[244:247],v[68:71]
v_mov_b32 v100,v108
v_mov_b32 v101,v109
s_nop 0
v_permlane32_swap_b32 v100,v108
v_mfma_f32_16x16x32_bf16 v[76:79],a[244:247],v[244:247],v[76:79]
v_permlane32_swap_b32 v101,v109
v_add_f32 v108,v108,v100
s_waitcnt lgkmcnt(0)
v_mfma_f32_16x16x32_bf16 v[68:71],a[120:123],v[248:251],v[68:71]
v_min3_u32 v27,v27,v248,v252
v_add_f32 v109,v109,v101
v_min3_u32 v27,v27,v120,v122
v_mfma_f32_16x16x32_bf16 v[76:79],a[248:251],v[248:251],v[76:79]
v_min3_u32 v27,v27,v124,v126
v_lshlrev_b32 v32,16,v124
v_and_b32 v33,s80,v124
v_mfma_f32_16x16x32_bf16 v[68:71],a[124:127],v[252:255],v[68:71]
v_lshlrev_b32 v34,16,v125
v_and_b32 v35,s80,v125
v_lshlrev_b32 v36,16,v126
v_mfma_f32_16x16x32_bf16 v[76:79],a[252:255],v[252:255],v[76:79]
v_and_b32 v37,s80,v126
v_lshlrev_b32 v38,16,v127
v_and_b32 v39,s80,v127
v_cmp_eq_u32 vcc,0,v27
s_cbranch_vccnz retry_239
s_branch epi_242
keep_251:
v_mfma_f32_16x16x32_bf16 v[64:67],a[124:127],v[252:255],v[64:67]
v_min3_u32 v27,v27,v248,v252
ds_read_b64 v[126:127],v41 offset:1024
v_mfma_f32_16x16x32_bf16 v[72:75],a[252:255],v[252:255],v[72:75]
ds_read_b128 v[248:251],v17 offset:13312
s_waitcnt lgkmcnt(9)
v_mfma_f32_16x16x32_bf16 v[68:71],a[0:3],v[224:227],0
v_cmp_eq_u32 vcc,0,v27
s_cbranch_vccnz retry_239
v_mfma_f32_16x16x32_bf16 v[76:79],a[128:131],v[224:227],0
ds_read_b128 v[252:255],v17 offset:15360
v_min3_u32 v27,v27,v224,v228
v_mfma_f32_16x16x32_bf16 v[68:71],a[4:7],v[228:231],v[68:71]
v_mfma_f32_16x16x32_bf16 v[76:79],a[132:135],v[228:231],v[76:79]
ds_read_b128 v[224:227],v17 offset:17408
s_waitcnt lgkmcnt(9)
v_mfma_f32_16x16x32_bf16 v[68:71],a[8:11],v[232:235],v[68:71]
v_min3_u32 v27,v27,v232,v236
s_waitcnt lgkmcnt(3)
v_lshlrev_b32 v88,16,v120
v_mfma_f32_16x16x32_bf16 v[76:79],a[136:139],v[232:235],v[76:79]
ds_read_b128 v[228:231],v17 offset:19456
v_and_b32 v89,s80,v120
v_lshlrev_b32 v90,16,v121
v_mfma_f32_16x16x32_bf16 v[68:71],a[12:15],v[236:239],v[68:71]
v_and_b32 v91,s80,v121
v_lshlrev_b32 v92,16,v122
v_and_b32 v93,s80,v122
v_mfma_f32_16x16x32_bf16 v[76:79],a[140:143],v[236:239],v[76:79]
ds_read_b128 v[232:235],v17 offset:21504
v_lshlrev_b32 v94,16,v123
v_mfma_f32_16x16x32_bf16 v[68:71],a[16:19],v[240:243],v[68:71]
v_min3_u32 v27,v27,v240,v244
v_and_b32 v95,s80,v123
v_mfma_f32_16x16x32_bf16 v[76:79],a[144:147],v[240:243],v[76:79]
ds_read_b128 v[236:239],v17 offset:23552
v_add_f32 v88,v64,v88
v_mfma_f32_16x16x32_bf16 v[68:71],a[20:23],v[244:247],v[68:71]
v_add_f32 v89,v65,v89
v_add_f32 v90,v66,v90
v_mfma_f32_16x16x32_bf16 v[76:79],a[148:151],v[244:247],v[76:79]
ds_read_b128 v[240:243],v17 offset:25600
s_waitcnt lgkmcnt(5)
v_mfma_f32_16x16x32_bf16 v[68:71],a[24:27],v[248:251],v[68:71]
v_min3_u32 v27,v27,v248,v252
v_add_f32 v91,v67,v91
v_mfma_f32_16x16x32_bf16 v[76:79],a[152:155],v[248:251],v[76:79]
ds_read_b128 v[244:247],v17 offset:27648
v_add_f32 v92,v72,v92
v_mfma_f32_16x16x32_bf16 v[68:71],a[28:31],v[252:255],v[68:71]
v_add_f32 v93,v73,v93
v_add_f32 v94,v74,v94
v_mfma_f32_16x16x32_bf16 v[76:79],a[156:159],v[252:255],v[76:79]
ds_read_b128 v[248:251],v17 offset:29696
s_waitcnt lgkmcnt(5)
v_mfma_f32_16x16x32_bf16 v[68:71],a[32:35],v[224:227],v[68:71]
v_min3_u32 v27,v27,v224,v228
v_add_f32 v95,v75,v95
v_mfma_f32_16x16x32_bf16 v[76:79],a[160:163],v[224:227],v[76:79]
ds_read_b128 v[252:255],v17 offset:31744
v_cvt_pk_bf16_f32 v96,v88,v89
v_mfma_f32_16x16x32_bf16 v[68:71],a[36:39],v[228:231],v[68:71]
v_cvt_pk_bf16_f32 v97,v90,v91
v_cvt_pk_bf16_f32 v98,v92,v93
v_mfma_f32_16x16x32_bf16 v[76:79],a[164:167],v[228:231],v[76:79]
ds_read_b128 v[224:227],v17 offset:33792
s_waitcnt lgkmcnt(5)
v_mfma_f32_16x16x32_bf16 v[68:71],a[40:43],v[232:235],v[68:71]
v_min3_u32 v27,v27,v232,v236
v_cvt_pk_bf16_f32 v99,v94,v95
v_mfma_f32_16x16x32_bf16 v[76:79],a[168:171],v[232:235],v[76:79]
ds_read_b128 v[228:231],v17 offset:35840
v_max_u32 v96,1,v96
v_mfma_f32_16x16x32_bf16 v[68:71],a[44:47],v[236:239],v[68:71]
buffer_store_dwordx4 v[96:99],v18,s[20:23],s70 offen offset:0 sc1
v_mfma_f32_16x16x32_bf16 v[76:79],a[172:175],v[236:239],v[76:79]
ds_read_b128 v[232:235],v17 offset:37888
s_waitcnt lgkmcnt(5)
v_mfma_f32_16x16x32_bf16 v[68:71],a[48:51],v[240:243],v[68:71]
v_min3_u32 v27,v27,v240,v244
v_lshlrev_b32 v88,16,v96
v_mfma_f32_16x16x32_bf16 v[76:79],a[176:179],v[240:243],v[76:79]
ds_read_b128 v[236:239],v17 offset:39936
v_and_b32 v89,s80,v96
v_mfma_f32_16x16x32_bf16 v[68:71],a[52:55],v[244:247],v[68:71]
v_lshlrev_b32 v90,16,v97
v_and_b32 v91,s80,v97
v_mfma_f32_16x16x32_bf16 v[76:79],a[180:183],v[244:247],v[76:79]
ds_read_b128 v[240:243],v17 offset:41984
s_waitcnt lgkmcnt(5)
v_mfma_f32_16x16x32_bf16 v[68:71],a[56:59],v[248:251],v[68:71]
v_min3_u32 v27,v27,v248,v252
v_lshlrev_b32 v92,16,v98
v_mfma_f32_16x16x32_bf16 v[76:79],a[184:187],v[248:251],v[76:79]
ds_read_b128 v[244:247],v17 offset:44032
v_and_b32 v93,s80,v98
v_mfma_f32_16x16x32_bf16 v[68:71],a[60:63],v[252:255],v[68:71]
v_lshlrev_b32 v94,16,v99
v_and_b32 v95,s80,v99
v_mfma_f32_16x16x32_bf16 v[76:79],a[188:191],v[252:255],v[76:79]
ds_read_b128 v[248:251],v17 offset:46080
s_waitcnt lgkmcnt(5)
v_mfma_f32_16x16x32_bf16 v[68:71],a[64:67],v[224:227],v[68:71]
v_min3_u32 v27,v27,v224,v228
v_add_f32 v108,v88,v89
v_mfma_f32_16x16x32_bf16 v[76:79],a[192:195],v[224:227],v[76:79]
ds_read_b128 v[252:255],v17 offset:48128
v_mul_f32 v109,v88,v88
v_mfma_f32_16x16x32_bf16 v[68:71],a[68:71],v[228:231],v[68:71]
v_add_f32 v100,v90,v91
v_mul_f32 v101,v89,v89
v_mfma_f32_16x16x32_bf16 v[76:79],a[196:199],v[228:231],v[76:79]
ds_read_b128 v[224:227],v17 offset:50176
s_waitcnt lgkmcnt(5)
v_mfma_f32_16x16x32_bf16 v[68:71],a[72:75],v[232:235],v[68:71]
v_min3_u32 v27,v27,v232,v236
v_fmac_f32 v109,v90,v90
v_mfma_f32_16x16x32_bf16 v[76:79],a[200:203],v[232:235],v[76:79]
ds_read_b128 v[228:231],v17 offset:52224
v_fmac_f32 v101,v91,v91
v_mfma_f32_16x16x32_bf16 v[68:71],a[76:79],v[236:239],v[68:71]
v_fmac_f32 v109,v92,v92
v_fmac_f32 v101,v93,v93
v_mfma_f32_16x16x32_bf16 v[76:79],a[204:207],v[236:239],v[76:79]
ds_read_b128 v[232:235],v17 offset:54272
s_waitcnt lgkmcnt(5)
v_mfma_f32_16x16x32_bf16 v[68:71],a[80:83],v[240:243],v[68:71]
v_min3_u32 v27,v27,v240,v244
v_add_f32 v108,v108,v92
v_mfma_f32_16x16x32_bf16 v[76:79],a[208:211],v[240:243],v[76:79]
ds_read_b128 v[236:239],v17 offset:56320
v_add_f32 v100,v100,v93
v_mfma_f32_16x16x32_bf16 v[68:71],a[84:87],v[244:247],v[68:71]
v_fmac_f32 v109,v94,v94
v_fmac_f32 v101,v95,v95
v_mfma_f32_16x16x32_bf16 v[76:79],a[212:215],v[244:247],v[76:79]
ds_read_b128 v[240:243],v17 offset:58368
s_waitcnt lgkmcnt(5)
v_mfma_f32_16x16x32_bf16 v[68:71],a[88:91],v[248:251],v[68:71]
v_min3_u32 v27,v27,v248,v252
v_add_f32 v108,v108,v94
v_mfma_f32_16x16x32_bf16 v[76:79],a[216:219],v[248:251],v[76:79]
ds_read_b128 v[244:247],v17 offset:60416
v_add_f32 v100,v100,v95
v_mfma_f32_16x16x32_bf16 v[68:71],a[92:95],v[252:255],v[68:71]
v_add_f32 v108,v108,v100
v_add_f32 v109,v109,v101
v_mfma_f32_16x16x32_bf16 v[76:79],a[220:223],v[252:255],v[76:79]
ds_read_b128 v[248:251],v17 offset:62464
s_waitcnt lgkmcnt(5)
v_mfma_f32_16x16x32_bf16 v[68:71],a[96:99],v[224:227],v[68:71]
v_min3_u32 v27,v27,v224,v228
v_mov_b32 v100,v108
v_mfma_f32_16x16x32_bf16 v[76:79],a[224:227],v[224:227],v[76:79]
ds_read_b128 v[252:255],v17 offset:64512
v_mov_b32 v101,v109
v_mfma_f32_16x16x32_bf16 v[68:71],a[100:103],v[228:231],v[68:71]
v_permlane16_swap_b32 v100,v108
v_permlane16_swap_b32 v101,v109
v_mfma_f32_16x16x32_bf16 v[76:79],a[228:231],v[228:231],v[76:79]
v_add_f32 v108,v108,v100
s_waitcnt lgkmcnt(4)
v_mfma_f32_16x16x32_bf16 v[68:71],a[104:107],v[232:235],v[68:71]
v_min3_u32 v27,v27,v232,v236
v_add_f32 v109,v109,v101
v_mfma_f32_16x16x32_bf16 v[76:79],a[232:235],v[232:235],v[76:79]
v_mov_b32 v100,v108
v_mov_b32 v101,v109
v_mfma_f32_16x16x32_bf16 v[68:71],a[108:111],v[236:239],v[68:71]
v_permlane32_swap_b32 v100,v108
v_permlane32_swap_b32 v101,v109
v_mfma_f32_16x16x32_bf16 v[76:79],a[236:239],v[236:239],v[76:79]
v_add_f32 v108,v108,v100
s_waitcnt lgkmcnt(2)
v_mfma_f32_16x16x32_bf16 v[68:71],a[112:115],v[240:243],v[68:71]
v_min3_u32 v27,v27,v240,v244
v_add_f32 v109,v109,v101
v_mfma_f32_16x16x32_bf16 v[76:79],a[240:243],v[240:243],v[76:79]
v_min3_u32 v27,v27,v120,v122
v_min3_u32 v27,v27,v124,v126
v_mfma_f32_16x16x32_bf16 v[68:71],a[116:119],v[244:247],v[68:71]
v_lshlrev_b32 v32,16,v124
v_and_b32 v33,s80,v124
v_mfma_f32_16x16x32_bf16 v[76:79],a[244:247],v[244:247],v[76:79]
v_lshlrev_b32 v34,16,v125
s_waitcnt lgkmcnt(0)
v_mfma_f32_16x16x32_bf16 v[68:71],a[120:123],v[248:251],v[68:71]
v_min3_u32 v27,v27,v248,v252
v_and_b32 v35,s80,v125
v_mfma_f32_16x16x32_bf16 v[76:79],a[248:251],v[248:251],v[76:79]
v_lshlrev_b32 v36,16,v126
v_and_b32 v37,s80,v126
v_mfma_f32_16x16x32_bf16 v[68:71],a[124:127],v[252:255],v[68:71]
v_lshlrev_b32 v38,16,v127
v_and_b32 v39,s80,v127
v_mfma_f32_16x16x32_bf16 v[76:79],a[252:255],v[252:255],v[76:79]
v_cmp_eq_u32 vcc,0,v27
s_cbranch_vccnz retry_239
s_branch epi_242
both_243:
s_waitcnt vmcnt(13) lgkmcnt(0)
s_barrier
ds_read_b128 v[224:227],v17 offset:0
ds_read_b128 v[228:231],v17 offset:2048
ds_read_b128 v[232:235],v17 offset:4096
ds_read_b128 v[236:239],v17 offset:6144
ds_read_b128 v[240:243],v17 offset:8192
ds_read_b128 v[244:247],v17 offset:10240
ds_read_b128 v[248:251],v17 offset:12288
s_waitcnt lgkmcnt(5)
v_mfma_f32_16x16x32_bf16 v[64:67],a[0:3],v[224:227],0
s_add_u32 s96,s71,1
s_add_u32 s92,s71,2
s_add_u32 s88,s70,s75
v_min_u32 v27,v224,v228
s_add_u32 m0,s43,0
v_mfma_f32_16x16x32_bf16 v[72:75],a[128:131],v[224:227],0
ds_read_b128 v[252:255],v17 offset:14336
s_cmp_eq_u32 s96,64
s_cselect_b32 s96,99,s96
buffer_load_dwordx4 v19,s[20:23],s78 offen sc1 lds
v_mfma_f32_16x16x32_bf16 v[64:67],a[4:7],v[228:231],v[64:67]
s_cmp_eq_u32 s92,64
s_cselect_b32 s92,99,s92
s_add_u32 s88,s88,2097152
s_add_u32 m0,s43,1024
v_mfma_f32_16x16x32_bf16 v[72:75],a[132:135],v[228:231],v[72:75]
ds_read_b128 v[224:227],v17 offset:16384
s_xor_b32 s88,s88,0x2000
buffer_load_dwordx4 v20,s[20:23],s78 offen sc1 lds
s_waitcnt lgkmcnt(5)
v_mfma_f32_16x16x32_bf16 v[64:67],a[8:11],v[232:235],v[64:67]
s_cmp_eq_u32 s96,65
s_cselect_b32 s96,64,s96
v_mfma_f32_16x16x32_bf16 v[72:75],a[136:139],v[232:235],v[72:75]
ds_read_b128 v[228:231],v17 offset:18432
s_xor_b32 s89,s88,1024
v_mfma_f32_16x16x32_bf16 v[64:67],a[12:15],v[236:239],v[64:67]
s_xor_b32 m0,s72,0
v_min3_u32 v27,v27,v232,v236
v_mfma_f32_16x16x32_bf16 v[72:75],a[140:143],v[236:239],v[72:75]
ds_read_b128 v[232:235],v17 offset:20480
s_add_u32 s65,s88,0
s_waitcnt lgkmcnt(5)
v_mfma_f32_16x16x32_bf16 v[64:67],a[16:19],v[240:243],v[64:67]
v_min3_u32 v27,v27,v240,v244
v_mfma_f32_16x16x32_bf16 v[72:75],a[144:147],v[240:243],v[72:75]
ds_read_b128 v[236:239],v17 offset:22528
buffer_load_dwordx4 v16,s[20:23],s65 offen offset:0 sc1 lds
v_mfma_f32_16x16x32_bf16 v[64:67],a[20:23],v[244:247],v[64:67]
buffer_load_dwordx4 v16,s[20:23],s65 offen offset:2048 sc1 lds
v_mfma_f32_16x16x32_bf16 v[72:75],a[148:151],v[244:247],v[72:75]
ds_read_b128 v[240:243],v17 offset:24576
s_waitcnt lgkmcnt(5)
v_mfma_f32_16x16x32_bf16 v[64:67],a[24:27],v[248:251],v[64:67]
s_xor_b32 m0,s72,16384
v_min3_u32 v27,v27,v248,v252
v_mfma_f32_16x16x32_bf16 v[72:75],a[152:155],v[248:251],v[72:75]
ds_read_b128 v[244:247],v17 offset:26624
v_mfma_f32_16x16x32_bf16 v[64:67],a[28:31],v[252:255],v[64:67]
s_add_u32 s65,s88,32768
v_mfma_f32_16x16x32_bf16 v[72:75],a[156:159],v[252:255],v[72:75]
ds_read_b128 v[248:251],v17 offset:28672
s_waitcnt lgkmcnt(5)
v_mfma_f32_16x16x32_bf16 v[64:67],a[32:35],v[224:227],v[64:67]
buffer_load_dwordx4 v16,s[20:23],s65 offen offset:0 sc1 lds
v_mfma_f32_16x16x32_bf16 v[72:75],a[160:163],v[224:227],v[72:75]
ds_read_b128 v[252:255],v17 offset:30720
buffer_load_dwordx4 v16,s[20:23],s65 offen offset:2048 sc1 lds
v_mfma_f32_16x16x32_bf16 v[64:67],a[36:39],v[228:231],v[64:67]
v_min3_u32 v27,v27,v224,v228
v_mfma_f32_16x16x32_bf16 v[72:75],a[164:167],v[228:231],v[72:75]
ds_read_b128 v[224:227],v17 offset:32768
s_xor_b32 m0,s72,32768
s_waitcnt lgkmcnt(5)
v_mfma_f32_16x16x32_bf16 v[64:67],a[40:43],v[232:235],v[64:67]
s_add_u32 s65,s88,65536
v_min3_u32 v27,v27,v232,v236
v_mfma_f32_16x16x32_bf16 v[72:75],a[168:171],v[232:235],v[72:75]
ds_read_b128 v[228:231],v17 offset:34816
v_mfma_f32_16x16x32_bf16 v[64:67],a[44:47],v[236:239],v[64:67]
buffer_load_dwordx4 v16,s[20:23],s65 offen offset:0 sc1 lds
v_mfma_f32_16x16x32_bf16 v[72:75],a[172:175],v[236:239],v[72:75]
ds_read_b128 v[232:235],v17 offset:36864
s_waitcnt lgkmcnt(5)
v_mfma_f32_16x16x32_bf16 v[64:67],a[48:51],v[240:243],v[64:67]
buffer_load_dwordx4 v16,s[20:23],s65 offen offset:2048 sc1 lds
v_mfma_f32_16x16x32_bf16 v[72:75],a[176:179],v[240:243],v[72:75]
ds_read_b128 v[236:239],v17 offset:38912
s_xor_b32 m0,s72,49152
v_mfma_f32_16x16x32_bf16 v[64:67],a[52:55],v[244:247],v[64:67]
v_min3_u32 v27,v27,v240,v244
v_mfma_f32_16x16x32_bf16 v[72:75],a[180:183],v[244:247],v[72:75]
ds_read_b128 v[240:243],v17 offset:40960
s_add_u32 s65,s88,98304
s_waitcnt lgkmcnt(5)
v_mfma_f32_16x16x32_bf16 v[64:67],a[56:59],v[248:251],v[64:67]
buffer_load_dwordx4 v16,s[20:23],s65 offen offset:0 sc1 lds
v_min3_u32 v27,v27,v248,v252
v_mfma_f32_16x16x32_bf16 v[72:75],a[184:187],v[248:251],v[72:75]
ds_read_b128 v[244:247],v17 offset:43008
s_waitcnt vmcnt(12)
v_mfma_f32_16x16x32_bf16 v[64:67],a[60:63],v[252:255],v[64:67]
v_cmp_gt_u32 vcc,s96,v29
v_cmp_gt_u32 s[92:93],s92,v29
v_mfma_f32_16x16x32_bf16 v[72:75],a[188:191],v[252:255],v[72:75]
ds_read_b128 v[248:251],v17 offset:45056
s_waitcnt lgkmcnt(5)
v_mfma_f32_16x16x32_bf16 v[64:67],a[64:67],v[224:227],v[64:67]
v_mov_b32 v44,vcc_lo
v_mov_b32 v45,s92
v_min3_u32 v27,v27,v224,v228
v_mfma_f32_16x16x32_bf16 v[72:75],a[192:195],v[224:227],v[72:75]
ds_read_b128 v[252:255],v17 offset:47104
ds_write_b64 v46,v[44:45]
v_mfma_f32_16x16x32_bf16 v[64:67],a[68:71],v[228:231],v[64:67]
buffer_load_dwordx4 v16,s[20:23],s65 offen offset:2048 sc1 lds
v_mfma_f32_16x16x32_bf16 v[72:75],a[196:199],v[228:231],v[72:75]
ds_read_b128 v[224:227],v17 offset:49152
s_waitcnt lgkmcnt(6)
v_mfma_f32_16x16x32_bf16 v[64:67],a[72:75],v[232:235],v[64:67]
s_xor_b32 m0,s72,1024
s_add_u32 s65,s89,0
v_mfma_f32_16x16x32_bf16 v[72:75],a[200:203],v[232:235],v[72:75]
ds_read_b128 v[228:231],v17 offset:51200
v_min3_u32 v27,v27,v232,v236
v_mfma_f32_16x16x32_bf16 v[64:67],a[76:79],v[236:239],v[64:67]
buffer_load_dwordx4 v16,s[20:23],s65 offen offset:0 sc1 lds
v_mfma_f32_16x16x32_bf16 v[72:75],a[204:207],v[236:239],v[72:75]
ds_read_b128 v[232:235],v17 offset:53248
s_waitcnt lgkmcnt(6)
v_mfma_f32_16x16x32_bf16 v[64:67],a[80:83],v[240:243],v[64:67]
buffer_load_dwordx4 v16,s[20:23],s65 offen offset:2048 sc1 lds
v_mfma_f32_16x16x32_bf16 v[72:75],a[208:211],v[240:243],v[72:75]
ds_read_b128 v[236:239],v17 offset:55296
s_xor_b32 m0,s72,17408
v_mfma_f32_16x16x32_bf16 v[64:67],a[84:87],v[244:247],v[64:67]
s_add_u32 s65,s89,32768
v_min3_u32 v27,v27,v240,v244
v_mfma_f32_16x16x32_bf16 v[72:75],a[212:215],v[244:247],v[72:75]
ds_read_b128 v[240:243],v17 offset:57344
s_waitcnt lgkmcnt(6)
v_mfma_f32_16x16x32_bf16 v[64:67],a[88:91],v[248:251],v[64:67]
buffer_load_dwordx4 v16,s[20:23],s65 offen offset:0 sc1 lds
v_mfma_f32_16x16x32_bf16 v[72:75],a[216:219],v[248:251],v[72:75]
ds_read_b128 v[244:247],v17 offset:59392
v_min3_u32 v27,v27,v248,v252
v_mfma_f32_16x16x32_bf16 v[64:67],a[92:95],v[252:255],v[64:67]
buffer_load_dwordx4 v16,s[20:23],s65 offen offset:2048 sc1 lds
v_mfma_f32_16x16x32_bf16 v[72:75],a[220:223],v[252:255],v[72:75]
ds_read_b128 v[248:251],v17 offset:61440
s_waitcnt lgkmcnt(5)
v_mfma_f32_16x16x32_bf16 v[64:67],a[96:99],v[224:227],v[64:67]
s_xor_b32 m0,s72,33792
s_add_u32 s65,s89,65536
v_mfma_f32_16x16x32_bf16 v[72:75],a[224:227],v[224:227],v[72:75]
ds_read_b128 v[252:255],v17 offset:63488
v_min3_u32 v27,v27,v224,v228
v_mfma_f32_16x16x32_bf16 v[64:67],a[100:103],v[228:231],v[64:67]
buffer_load_dwordx4 v16,s[20:23],s65 offen offset:0 sc1 lds
s_waitcnt vmcnt(15)
v_add_u32 v22,s71,-1
v_mfma_f32_16x16x32_bf16 v[72:75],a[228:231],v[228:231],v[72:75]
s_waitcnt vmcnt(20)
s_barrier
ds_read_b64 v[44:45],v47
ds_read_b128 v[224:227],v17 offset:1024
s_waitcnt lgkmcnt(6)
v_mfma_f32_16x16x32_bf16 v[64:67],a[104:107],v[232:235],v[64:67]
buffer_load_dwordx4 v16,s[20:23],s65 offen offset:2048 sc1 lds
buffer_store_dword v22,v23,s[20:23],s97 offen sc1
v_mfma_f32_16x16x32_bf16 v[72:75],a[232:235],v[232:235],v[72:75]
ds_read_b128 v[228:231],v17 offset:3072
s_xor_b32 m0,s72,50176
s_mov_b32 s97,0x7fff0000
v_mfma_f32_16x16x32_bf16 v[64:67],a[108:111],v[236:239],v[64:67]
s_add_u32 s65,s89,98304
v_min3_u32 v27,v27,v232,v236
s_waitcnt vmcnt(15)
v_mfma_f32_16x16x32_bf16 v[72:75],a[236:239],v[236:239],v[72:75]
ds_read_b128 v[232:235],v17 offset:5120
ds_read_b64 v[120:121],v40 offset:0
s_waitcnt lgkmcnt(7)
v_mfma_f32_16x16x32_bf16 v[64:67],a[112:115],v[240:243],v[64:67]
buffer_load_dwordx4 v16,s[20:23],s65 offen offset:0 sc1 lds
ds_read_b64 v[122:123],v41 offset:0
v_mfma_f32_16x16x32_bf16 v[72:75],a[240:243],v[240:243],v[72:75]
ds_read_b128 v[236:239],v17 offset:7168
v_min3_u32 v27,v27,v240,v244
v_mfma_f32_16x16x32_bf16 v[64:67],a[116:119],v[244:247],v[64:67]
buffer_load_dwordx4 v16,s[20:23],s65 offen offset:2048 sc1 lds
v_mfma_f32_16x16x32_bf16 v[72:75],a[244:247],v[244:247],v[72:75]
ds_read_b128 v[240:243],v17 offset:9216
s_waitcnt lgkmcnt(8)
v_mfma_f32_16x16x32_bf16 v[64:67],a[120:123],v[248:251],v[64:67]
s_waitcnt lgkmcnt(7)
v_readfirstlane_b32 s93,v45
v_mfma_f32_16x16x32_bf16 v[72:75],a[248:251],v[248:251],v[72:75]
ds_read_b128 v[244:247],v17 offset:11264
v_min3_u32 v27,v27,v248,v252
v_mfma_f32_16x16x32_bf16 v[64:67],a[124:127],v[252:255],v[64:67]
ds_read_b64 v[124:125],v40 offset:1024
ds_read_b64 v[126:127],v41 offset:1024
v_mfma_f32_16x16x32_bf16 v[72:75],a[252:255],v[252:255],v[72:75]
ds_read_b128 v[248:251],v17 offset:13312
s_waitcnt lgkmcnt(9)
v_mfma_f32_16x16x32_bf16 v[68:71],a[0:3],v[224:227],0
v_cmp_eq_u32 vcc,0,v27
s_cbranch_vccnz retry_239
v_mfma_f32_16x16x32_bf16 v[76:79],a[128:131],v[224:227],0
ds_read_b128 v[252:255],v17 offset:15360
v_min3_u32 v27,v27,v224,v228
v_mfma_f32_16x16x32_bf16 v[68:71],a[4:7],v[228:231],v[68:71]
v_mfma_f32_16x16x32_bf16 v[76:79],a[132:135],v[228:231],v[76:79]
ds_read_b128 v[224:227],v17 offset:17408
s_waitcnt lgkmcnt(7)
v_mfma_f32_16x16x32_bf16 v[68:71],a[8:11],v[232:235],v[68:71]
v_min3_u32 v27,v27,v232,v236
s_waitcnt lgkmcnt(3)
v_lshlrev_b32 v88,16,v120
v_mfma_f32_16x16x32_bf16 v[76:79],a[136:139],v[232:235],v[76:79]
ds_read_b128 v[228:231],v17 offset:19456
v_and_b32 v89,s80,v120
v_lshlrev_b32 v90,16,v121
v_mfma_f32_16x16x32_bf16 v[68:71],a[12:15],v[236:239],v[68:71]
v_and_b32 v91,s80,v121
v_lshlrev_b32 v92,16,v122
v_and_b32 v93,s80,v122
v_mfma_f32_16x16x32_bf16 v[76:79],a[140:143],v[236:239],v[76:79]
ds_read_b128 v[232:235],v17 offset:21504
v_lshlrev_b32 v94,16,v123
v_mfma_f32_16x16x32_bf16 v[68:71],a[16:19],v[240:243],v[68:71]
v_min3_u32 v27,v27,v240,v244
v_and_b32 v95,s80,v123
v_mfma_f32_16x16x32_bf16 v[76:79],a[144:147],v[240:243],v[76:79]
ds_read_b128 v[236:239],v17 offset:23552
v_add_f32 v88,v64,v88
v_mfma_f32_16x16x32_bf16 v[68:71],a[20:23],v[244:247],v[68:71]
v_add_f32 v89,v65,v89
v_add_f32 v90,v66,v90
v_mfma_f32_16x16x32_bf16 v[76:79],a[148:151],v[244:247],v[76:79]
ds_read_b128 v[240:243],v17 offset:25600
s_waitcnt lgkmcnt(5)
v_mfma_f32_16x16x32_bf16 v[68:71],a[24:27],v[248:251],v[68:71]
v_min3_u32 v27,v27,v248,v252
v_add_f32 v91,v67,v91
v_mfma_f32_16x16x32_bf16 v[76:79],a[152:155],v[248:251],v[76:79]
ds_read_b128 v[244:247],v17 offset:27648
v_add_f32 v92,v72,v92
v_mfma_f32_16x16x32_bf16 v[68:71],a[28:31],v[252:255],v[68:71]
v_add_f32 v93,v73,v93
v_add_f32 v94,v74,v94
v_mfma_f32_16x16x32_bf16 v[76:79],a[156:159],v[252:255],v[76:79]
ds_read_b128 v[248:251],v17 offset:29696
s_waitcnt lgkmcnt(5)
v_mfma_f32_16x16x32_bf16 v[68:71],a[32:35],v[224:227],v[68:71]
v_min3_u32 v27,v27,v224,v228
v_add_f32 v95,v75,v95
v_mfma_f32_16x16x32_bf16 v[76:79],a[160:163],v[224:227],v[76:79]
ds_read_b128 v[252:255],v17 offset:31744
v_cvt_pk_bf16_f32 v96,v88,v89
v_mfma_f32_16x16x32_bf16 v[68:71],a[36:39],v[228:231],v[68:71]
v_cvt_pk_bf16_f32 v97,v90,v91
v_cvt_pk_bf16_f32 v98,v92,v93
v_mfma_f32_16x16x32_bf16 v[76:79],a[164:167],v[228:231],v[76:79]
ds_read_b128 v[224:227],v17 offset:33792
s_waitcnt lgkmcnt(5)
v_mfma_f32_16x16x32_bf16 v[68:71],a[40:43],v[232:235],v[68:71]
v_min3_u32 v27,v27,v232,v236
v_cvt_pk_bf16_f32 v99,v94,v95
v_mfma_f32_16x16x32_bf16 v[76:79],a[168:171],v[232:235],v[76:79]
ds_read_b128 v[228:231],v17 offset:35840
v_max_u32 v96,1,v96
v_mfma_f32_16x16x32_bf16 v[68:71],a[44:47],v[236:239],v[68:71]
buffer_store_dwordx4 v[96:99],v18,s[20:23],s70 offen offset:0 sc1
v_mfma_f32_16x16x32_bf16 v[76:79],a[172:175],v[236:239],v[76:79]
ds_read_b128 v[232:235],v17 offset:37888
s_waitcnt lgkmcnt(5)
v_mfma_f32_16x16x32_bf16 v[68:71],a[48:51],v[240:243],v[68:71]
v_min3_u32 v27,v27,v240,v244
v_lshlrev_b32 v88,16,v96
v_mfma_f32_16x16x32_bf16 v[76:79],a[176:179],v[240:243],v[76:79]
ds_read_b128 v[236:239],v17 offset:39936
v_and_b32 v89,s80,v96
v_mfma_f32_16x16x32_bf16 v[68:71],a[52:55],v[244:247],v[68:71]
v_lshlrev_b32 v90,16,v97
v_and_b32 v91,s80,v97
v_mfma_f32_16x16x32_bf16 v[76:79],a[180:183],v[244:247],v[76:79]
ds_read_b128 v[240:243],v17 offset:41984
s_waitcnt lgkmcnt(5)
v_mfma_f32_16x16x32_bf16 v[68:71],a[56:59],v[248:251],v[68:71]
v_min3_u32 v27,v27,v248,v252
v_lshlrev_b32 v92,16,v98
v_mfma_f32_16x16x32_bf16 v[76:79],a[184:187],v[248:251],v[76:79]
ds_read_b128 v[244:247],v17 offset:44032
v_and_b32 v93,s80,v98
v_mfma_f32_16x16x32_bf16 v[68:71],a[60:63],v[252:255],v[68:71]
v_lshlrev_b32 v94,16,v99
v_and_b32 v95,s80,v99
v_mfma_f32_16x16x32_bf16 v[76:79],a[188:191],v[252:255],v[76:79]
ds_read_b128 v[248:251],v17 offset:46080
s_waitcnt lgkmcnt(5)
v_mfma_f32_16x16x32_bf16 v[68:71],a[64:67],v[224:227],v[68:71]
v_min3_u32 v27,v27,v224,v228
v_add_f32 v108,v88,v89
v_mfma_f32_16x16x32_bf16 v[76:79],a[192:195],v[224:227],v[76:79]
ds_read_b128 v[252:255],v17 offset:48128
v_mul_f32 v109,v88,v88
v_mfma_f32_16x16x32_bf16 v[68:71],a[68:71],v[228:231],v[68:71]
v_add_f32 v100,v90,v91
v_mul_f32 v101,v89,v89
v_mfma_f32_16x16x32_bf16 v[76:79],a[196:199],v[228:231],v[76:79]
ds_read_b128 v[224:227],v17 offset:50176
s_waitcnt lgkmcnt(5)
v_mfma_f32_16x16x32_bf16 v[68:71],a[72:75],v[232:235],v[68:71]
v_min3_u32 v27,v27,v232,v236
v_fmac_f32 v109,v90,v90
v_mfma_f32_16x16x32_bf16 v[76:79],a[200:203],v[232:235],v[76:79]
ds_read_b128 v[228:231],v17 offset:52224
v_fmac_f32 v101,v91,v91
v_mfma_f32_16x16x32_bf16 v[68:71],a[76:79],v[236:239],v[68:71]
v_fmac_f32 v109,v92,v92
v_fmac_f32 v101,v93,v93
v_mfma_f32_16x16x32_bf16 v[76:79],a[204:207],v[236:239],v[76:79]
ds_read_b128 v[232:235],v17 offset:54272
s_waitcnt lgkmcnt(5)
v_mfma_f32_16x16x32_bf16 v[68:71],a[80:83],v[240:243],v[68:71]
v_min3_u32 v27,v27,v240,v244
v_add_f32 v108,v108,v92
v_mfma_f32_16x16x32_bf16 v[76:79],a[208:211],v[240:243],v[76:79]
ds_read_b128 v[236:239],v17 offset:56320
v_add_f32 v100,v100,v93
v_mfma_f32_16x16x32_bf16 v[68:71],a[84:87],v[244:247],v[68:71]
v_fmac_f32 v109,v94,v94
v_fmac_f32 v101,v95,v95
v_mfma_f32_16x16x32_bf16 v[76:79],a[212:215],v[244:247],v[76:79]
ds_read_b128 v[240:243],v17 offset:58368
s_waitcnt lgkmcnt(5)
v_mfma_f32_16x16x32_bf16 v[68:71],a[88:91],v[248:251],v[68:71]
v_min3_u32 v27,v27,v248,v252
v_add_f32 v108,v108,v94
v_mfma_f32_16x16x32_bf16 v[76:79],a[216:219],v[248:251],v[76:79]
ds_read_b128 v[244:247],v17 offset:60416
v_add_f32 v100,v100,v95
v_mfma_f32_16x16x32_bf16 v[68:71],a[92:95],v[252:255],v[68:71]
v_add_f32 v108,v108,v100
v_add_f32 v109,v109,v101
v_mfma_f32_16x16x32_bf16 v[76:79],a[220:223],v[252:255],v[76:79]
ds_read_b128 v[248:251],v17 offset:62464
s_waitcnt lgkmcnt(5)
v_mfma_f32_16x16x32_bf16 v[68:71],a[96:99],v[224:227],v[68:71]
v_min3_u32 v27,v27,v224,v228
v_mov_b32 v100,v108
v_mfma_f32_16x16x32_bf16 v[76:79],a[224:227],v[224:227],v[76:79]
ds_read_b128 v[252:255],v17 offset:64512
v_mov_b32 v101,v109
v_mfma_f32_16x16x32_bf16 v[68:71],a[100:103],v[228:231],v[68:71]
v_permlane16_swap_b32 v100,v108
v_permlane16_swap_b32 v101,v109
v_mfma_f32_16x16x32_bf16 v[76:79],a[228:231],v[228:231],v[76:79]
v_add_f32 v108,v108,v100
s_waitcnt lgkmcnt(4)
v_mfma_f32_16x16x32_bf16 v[68:71],a[104:107],v[232:235],v[68:71]
v_min3_u32 v27,v27,v232,v236
v_add_f32 v109,v109,v101
v_mfma_f32_16x16x32_bf16 v[76:79],a[232:235],v[232:235],v[76:79]
v_mov_b32 v100,v108
v_mov_b32 v101,v109
v_mfma_f32_16x16x32_bf16 v[68:71],a[108:111],v[236:239],v[68:71]
v_permlane32_swap_b32 v100,v108
v_permlane32_swap_b32 v101,v109
v_mfma_f32_16x16x32_bf16 v[76:79],a[236:239],v[236:239],v[76:79]
v_add_f32 v108,v108,v100
s_waitcnt lgkmcnt(2)
v_mfma_f32_16x16x32_bf16 v[68:71],a[112:115],v[240:243],v[68:71]
v_min3_u32 v27,v27,v240,v244
v_add_f32 v109,v109,v101
v_mfma_f32_16x16x32_bf16 v[76:79],a[240:243],v[240:243],v[76:79]
v_min3_u32 v27,v27,v120,v122
v_min3_u32 v27,v27,v124,v126
v_mfma_f32_16x16x32_bf16 v[68:71],a[116:119],v[244:247],v[68:71]
v_lshlrev_b32 v32,16,v124
v_and_b32 v33,s80,v124
v_mfma_f32_16x16x32_bf16 v[76:79],a[244:247],v[244:247],v[76:79]
v_lshlrev_b32 v34,16,v125
s_waitcnt lgkmcnt(0)
v_mfma_f32_16x16x32_bf16 v[68:71],a[120:123],v[248:251],v[68:71]
v_min3_u32 v27,v27,v248,v252
v_and_b32 v35,s80,v125
v_mfma_f32_16x16x32_bf16 v[76:79],a[248:251],v[248:251],v[76:79]
v_lshlrev_b32 v36,16,v126
v_and_b32 v37,s80,v126
v_mfma_f32_16x16x32_bf16 v[68:71],a[124:127],v[252:255],v[68:71]
v_lshlrev_b32 v38,16,v127
v_and_b32 v39,s80,v127
v_mfma_f32_16x16x32_bf16 v[76:79],a[252:255],v[252:255],v[76:79]
v_cmp_eq_u32 vcc,0,v27
s_cbranch_vccnz retry_239
epi_242:
buffer_load_dword v29,v21,s[20:23],s87 offen sc1
s_cmp_gt_u32 s71,44
s_cselect_b32 s65,s73,0x7fff0000
s_cselect_b32 s97,0x7fff0000,s73
v_mov_b32 v22,s71
buffer_store_dword v22,v23,s[20:23],s65 offen sc1
v_pk_add_f32 v[88:89],v[68:69],v[32:33]
v_pk_add_f32 v[90:91],v[70:71],v[34:35]
v_pk_add_f32 v[92:93],v[76:77],v[36:37]
v_pk_add_f32 v[94:95],v[78:79],v[38:39]
v_cvt_pk_bf16_f32 v96,v88,v89
v_cvt_pk_bf16_f32 v97,v90,v91
v_cvt_pk_bf16_f32 v98,v92,v93
v_cvt_pk_bf16_f32 v99,v94,v95
v_max_u32 v96,1,v96
buffer_store_dwordx4 v[96:99],v18,s[20:23],s70 offen offset:1024 sc1
v_lshlrev_b32 v88,16,v96
v_and_b32 v89,s80,v96
v_lshlrev_b32 v90,16,v97
v_and_b32 v91,s80,v97
v_lshlrev_b32 v92,16,v98
v_and_b32 v93,s80,v98
v_lshlrev_b32 v94,16,v99
v_and_b32 v95,s80,v99
v_pk_mul_f32 v[102:103],v[88:89],v[88:89]
v_pk_add_f32 v[100:101],v[88:89],v[90:91]
v_pk_mul_f32 v[106:107],v[90:91],v[90:91]
v_pk_add_f32 v[104:105],v[92:93],v[94:95]
v_pk_fma_f32 v[102:103],v[92:93],v[92:93],v[102:103]
v_pk_fma_f32 v[106:107],v[94:95],v[94:95],v[106:107]
v_pk_add_f32 v[100:101],v[100:101],v[104:105]
v_pk_add_f32 v[102:103],v[102:103],v[106:107]
v_add_f32 v110,v100,v101
v_add_f32 v111,v102,v103
v_mov_b32 v100,v110
v_mov_b32 v101,v111
s_nop 0
v_permlane16_swap_b32 v100,v110
v_permlane16_swap_b32 v101,v111
v_add_f32 v110,v110,v100
v_add_f32 v111,v111,v101
v_mov_b32 v100,v110
v_mov_b32 v101,v111
s_nop 0
v_permlane32_swap_b32 v100,v110
v_permlane32_swap_b32 v101,v111
v_add_f32 v110,v110,v100
v_add_f32 v111,v111,v101
v_max_u32 v109,1,v109
buffer_store_dwordx4 v[108:111],v24,s[20:23],s70 offen sc1
s_cmp_eq_u32 s71,63
s_cselect_b32 s64,0,0x2000
s_cselect_b32 s66,2,1
s_lshl_b32 s66,s66,21
s_add_u32 s78,s78,s66
v_xor_b32 v19,s64,v19
v_xor_b32 v20,s64,v20
next_249:
v_xor_b32 v17,0x10000,v17
s_xor_b32 s72,s72,0x10000
s_add_u32 s70,s70,2097152
s_xor_b32 s70,s70,0x2000
s_add_u32 s71,s71,1
s_cmp_le_u32 s71,s57
s_cbranch_scc1 seg_240
s_endpgm
retry_239:
s_sub_u32 s90,s90,64
s_cmp_lt_i32 s90,0
s_cbranch_scc1 giveup_197
s_mov_b32 s83,1
s_waitcnt vmcnt(0) lgkmcnt(0)
s_barrier
s_branch seg_240
half_248:
s_mov_b32 s88,s94
s_mov_b32 s89,s95
s_add_u32 s94,s94,2097152
s_xor_b32 s94,s94,0x2000
s_xor_b32 s95,s94,1024
s_mov_b64 exec,s[52:53]
s_xor_b32 m0,s91,0
s_add_u32 s65,s94,0
buffer_load_dwordx4 v16,s[20:23],s65 offen offset:0 sc1 lds
buffer_load_dwordx4 v16,s[20:23],s65 offen offset:2048 sc1 lds
s_xor_b32 m0,s91,16384
s_add_u32 s65,s94,32768
buffer_load_dwordx4 v16,s[20:23],s65 offen offset:0 sc1 lds
buffer_load_dwordx4 v16,s[20:23],s65 offen offset:2048 sc1 lds
s_xor_b32 m0,s91,32768
s_add_u32 s65,s94,65536
buffer_load_dwordx4 v16,s[20:23],s65 offen offset:0 sc1 lds
buffer_load_dwordx4 v16,s[20:23],s65 offen offset:2048 sc1 lds
s_xor_b32 m0,s91,49152
s_add_u32 s65,s94,98304
buffer_load_dwordx4 v16,s[20:23],s65 offen offset:0 sc1 lds
buffer_load_dwordx4 v16,s[20:23],s65 offen offset:2048 sc1 lds
s_mov_b64 exec,-1
s_add_u32 m0,s43,0
s_nop 0
buffer_load_dwordx4 v19,s[20:23],s78 offen sc1 lds
s_waitcnt vmcnt(9)
v_add_u32 v22,s71,-1
buffer_store_dword v22,v23,s[20:23],s97 offen sc1
s_mov_b32 s97,0x7fff0000
half2_245:
s_waitcnt vmcnt(8)
s_barrier
ds_read_b128 v[224:227],v17 offset:0
ds_read_b128 v[228:231],v17 offset:2048
ds_read_b128 v[232:235],v17 offset:4096
ds_read_b128 v[236:239],v17 offset:6144
ds_read_b128 v[240:243],v17 offset:8192
ds_read_b128 v[244:247],v17 offset:10240
ds_read_b128 v[248:251],v17 offset:12288
s_waitcnt lgkmcnt(5)
v_mfma_f32_16x16x32_bf16 v[64:67],a[0:3],v[224:227],0
s_xor_b32 m0,s72,0
v_min_u32 v27,v224,v228
v_mfma_f32_16x16x32_bf16 v[72:75],a[128:131],v[224:227],0
ds_read_b128 v[252:255],v17 offset:14336
s_add_u32 s65,s88,0
v_mfma_f32_16x16x32_bf16 v[64:67],a[4:7],v[228:231],v[64:67]
buffer_load_dwordx4 v16,s[20:23],s65 offen offset:0 sc1 lds
v_mfma_f32_16x16x32_bf16 v[72:75],a[132:135],v[228:231],v[72:75]
s_waitcnt vmcnt(7)
s_barrier
ds_read_b128 v[224:227],v17 offset:16384
s_waitcnt lgkmcnt(5)
v_mfma_f32_16x16x32_bf16 v[64:67],a[8:11],v[232:235],v[64:67]
buffer_load_dwordx4 v16,s[20:23],s65 offen offset:2048 sc1 lds
v_mfma_f32_16x16x32_bf16 v[72:75],a[136:139],v[232:235],v[72:75]
ds_read_b128 v[228:231],v17 offset:18432
s_xor_b32 m0,s72,16384
v_mfma_f32_16x16x32_bf16 v[64:67],a[12:15],v[236:239],v[64:67]
s_add_u32 s65,s88,32768
v_min3_u32 v27,v27,v232,v236
v_mfma_f32_16x16x32_bf16 v[72:75],a[140:143],v[236:239],v[72:75]
ds_read_b128 v[232:235],v17 offset:20480
s_waitcnt lgkmcnt(5)
v_mfma_f32_16x16x32_bf16 v[64:67],a[16:19],v[240:243],v[64:67]
buffer_load_dwordx4 v16,s[20:23],s65 offen offset:0 sc1 lds
v_mfma_f32_16x16x32_bf16 v[72:75],a[144:147],v[240:243],v[72:75]
ds_read_b128 v[236:239],v17 offset:22528
buffer_load_dwordx4 v16,s[20:23],s65 offen offset:2048 sc1 lds
v_mfma_f32_16x16x32_bf16 v[64:67],a[20:23],v[244:247],v[64:67]
s_xor_b32 m0,s72,32768
v_min3_u32 v27,v27,v240,v244
v_mfma_f32_16x16x32_bf16 v[72:75],a[148:151],v[244:247],v[72:75]
ds_read_b128 v[240:243],v17 offset:24576
s_add_u32 s65,s88,65536
s_waitcnt lgkmcnt(5)
v_mfma_f32_16x16x32_bf16 v[64:67],a[24:27],v[248:251],v[64:67]
buffer_load_dwordx4 v16,s[20:23],s65 offen offset:0 sc1 lds
v_mfma_f32_16x16x32_bf16 v[72:75],a[152:155],v[248:251],v[72:75]
ds_read_b128 v[244:247],v17 offset:26624
buffer_load_dwordx4 v16,s[20:23],s65 offen offset:2048 sc1 lds
v_mfma_f32_16x16x32_bf16 v[64:67],a[28:31],v[252:255],v[64:67]
v_min3_u32 v27,v27,v248,v252
v_mfma_f32_16x16x32_bf16 v[72:75],a[156:159],v[252:255],v[72:75]
ds_read_b128 v[248:251],v17 offset:28672
s_xor_b32 m0,s72,49152
s_waitcnt lgkmcnt(5)
v_mfma_f32_16x16x32_bf16 v[64:67],a[32:35],v[224:227],v[64:67]
s_add_u32 s65,s88,98304
v_min3_u32 v27,v27,v224,v228
v_mfma_f32_16x16x32_bf16 v[72:75],a[160:163],v[224:227],v[72:75]
ds_read_b128 v[252:255],v17 offset:30720
buffer_load_dwordx4 v16,s[20:23],s65 offen offset:0 sc1 lds
v_mfma_f32_16x16x32_bf16 v[64:67],a[36:39],v[228:231],v[64:67]
buffer_load_dwordx4 v16,s[20:23],s65 offen offset:2048 sc1 lds
v_mfma_f32_16x16x32_bf16 v[72:75],a[164:167],v[228:231],v[72:75]
s_waitcnt vmcnt(10)
s_barrier
ds_read_b128 v[224:227],v17 offset:32768
s_waitcnt lgkmcnt(5)
v_mfma_f32_16x16x32_bf16 v[64:67],a[40:43],v[232:235],v[64:67]
s_xor_b32 m0,s72,1024
v_min3_u32 v27,v27,v232,v236
v_mfma_f32_16x16x32_bf16 v[72:75],a[168:171],v[232:235],v[72:75]
ds_read_b128 v[228:231],v17 offset:34816
s_add_u32 s65,s89,0
v_mfma_f32_16x16x32_bf16 v[64:67],a[44:47],v[236:239],v[64:67]
buffer_load_dwordx4 v16,s[20:23],s65 offen offset:0 sc1 lds
v_mfma_f32_16x16x32_bf16 v[72:75],a[172:175],v[236:239],v[72:75]
ds_read_b128 v[232:235],v17 offset:36864
s_waitcnt lgkmcnt(5)
v_mfma_f32_16x16x32_bf16 v[64:67],a[48:51],v[240:243],v[64:67]
buffer_load_dwordx4 v16,s[20:23],s65 offen offset:2048 sc1 lds
v_mfma_f32_16x16x32_bf16 v[72:75],a[176:179],v[240:243],v[72:75]
ds_read_b128 v[236:239],v17 offset:38912
s_xor_b32 m0,s72,17408
v_mfma_f32_16x16x32_bf16 v[64:67],a[52:55],v[244:247],v[64:67]
s_add_u32 s65,s89,32768
v_min3_u32 v27,v27,v240,v244
v_mfma_f32_16x16x32_bf16 v[72:75],a[180:183],v[244:247],v[72:75]
ds_read_b128 v[240:243],v17 offset:40960
s_waitcnt lgkmcnt(5)
v_mfma_f32_16x16x32_bf16 v[64:67],a[56:59],v[248:251],v[64:67]
buffer_load_dwordx4 v16,s[20:23],s65 offen offset:0 sc1 lds
v_mfma_f32_16x16x32_bf16 v[72:75],a[184:187],v[248:251],v[72:75]
ds_read_b128 v[244:247],v17 offset:43008
v_min3_u32 v27,v27,v248,v252
v_mfma_f32_16x16x32_bf16 v[64:67],a[60:63],v[252:255],v[64:67]
buffer_load_dwordx4 v16,s[20:23],s65 offen offset:2048 sc1 lds
v_mfma_f32_16x16x32_bf16 v[72:75],a[188:191],v[252:255],v[72:75]
ds_read_b128 v[248:251],v17 offset:45056
s_waitcnt lgkmcnt(5)
v_mfma_f32_16x16x32_bf16 v[64:67],a[64:67],v[224:227],v[64:67]
s_xor_b32 m0,s72,33792
s_add_u32 s65,s89,65536
v_mfma_f32_16x16x32_bf16 v[72:75],a[192:195],v[224:227],v[72:75]
ds_read_b128 v[252:255],v17 offset:47104
v_min3_u32 v27,v27,v224,v228
v_mfma_f32_16x16x32_bf16 v[64:67],a[68:71],v[228:231],v[64:67]
buffer_load_dwordx4 v16,s[20:23],s65 offen offset:0 sc1 lds
v_mfma_f32_16x16x32_bf16 v[72:75],a[196:199],v[228:231],v[72:75]
ds_read_b128 v[224:227],v17 offset:49152
s_waitcnt lgkmcnt(5)
v_mfma_f32_16x16x32_bf16 v[64:67],a[72:75],v[232:235],v[64:67]
buffer_load_dwordx4 v16,s[20:23],s65 offen offset:2048 sc1 lds
v_mfma_f32_16x16x32_bf16 v[72:75],a[200:203],v[232:235],v[72:75]
ds_read_b128 v[228:231],v17 offset:51200
s_xor_b32 m0,s72,50176
v_mfma_f32_16x16x32_bf16 v[64:67],a[76:79],v[236:239],v[64:67]
s_add_u32 s65,s89,98304
v_min3_u32 v27,v27,v232,v236
v_mfma_f32_16x16x32_bf16 v[72:75],a[204:207],v[236:239],v[72:75]
ds_read_b128 v[232:235],v17 offset:53248
s_waitcnt lgkmcnt(5)
v_mfma_f32_16x16x32_bf16 v[64:67],a[80:83],v[240:243],v[64:67]
buffer_load_dwordx4 v16,s[20:23],s65 offen offset:0 sc1 lds
v_mfma_f32_16x16x32_bf16 v[72:75],a[208:211],v[240:243],v[72:75]
ds_read_b128 v[236:239],v17 offset:55296
v_min3_u32 v27,v27,v240,v244
v_mfma_f32_16x16x32_bf16 v[64:67],a[84:87],v[244:247],v[64:67]
buffer_load_dwordx4 v16,s[20:23],s65 offen offset:2048 sc1 lds
v_mfma_f32_16x16x32_bf16 v[72:75],a[212:215],v[244:247],v[72:75]
ds_read_b128 v[240:243],v17 offset:57344
s_waitcnt lgkmcnt(5)
v_mfma_f32_16x16x32_bf16 v[64:67],a[88:91],v[248:251],v[64:67]
v_min3_u32 v27,v27,v248,v252
v_mfma_f32_16x16x32_bf16 v[72:75],a[216:219],v[248:251],v[72:75]
ds_read_b128 v[244:247],v17 offset:59392
v_mfma_f32_16x16x32_bf16 v[64:67],a[92:95],v[252:255],v[64:67]
v_mfma_f32_16x16x32_bf16 v[72:75],a[220:223],v[252:255],v[72:75]
ds_read_b128 v[248:251],v17 offset:61440
s_waitcnt lgkmcnt(5)
v_mfma_f32_16x16x32_bf16 v[64:67],a[96:99],v[224:227],v[64:67]
v_min3_u32 v27,v27,v224,v228
v_mfma_f32_16x16x32_bf16 v[72:75],a[224:227],v[224:227],v[72:75]
ds_read_b128 v[252:255],v17 offset:63488
v_mfma_f32_16x16x32_bf16 v[64:67],a[100:103],v[228:231],v[64:67]
v_mfma_f32_16x16x32_bf16 v[72:75],a[228:231],v[228:231],v[72:75]
s_waitcnt lgkmcnt(4)
v_mfma_f32_16x16x32_bf16 v[64:67],a[104:107],v[232:235],v[64:67]
v_min3_u32 v27,v27,v232,v236
s_waitcnt vmcnt(17)
v_mfma_f32_16x16x32_bf16 v[72:75],a[232:235],v[232:235],v[72:75]
ds_read_b64 v[120:121],v40
ds_read_b64 v[122:123],v41
v_mfma_f32_16x16x32_bf16 v[64:67],a[108:111],v[236:239],v[64:67]
v_mfma_f32_16x16x32_bf16 v[72:75],a[236:239],v[236:239],v[72:75]
s_waitcnt lgkmcnt(4)
v_mfma_f32_16x16x32_bf16 v[64:67],a[112:115],v[240:243],v[64:67]
v_min3_u32 v27,v27,v240,v244
v_mfma_f32_16x16x32_bf16 v[72:75],a[240:243],v[240:243],v[72:75]
v_mfma_f32_16x16x32_bf16 v[64:67],a[116:119],v[244:247],v[64:67]
v_mfma_f32_16x16x32_bf16 v[72:75],a[244:247],v[244:247],v[72:75]
s_waitcnt lgkmcnt(2)
v_mfma_f32_16x16x32_bf16 v[64:67],a[120:123],v[248:251],v[64:67]
v_min3_u32 v27,v27,v248,v252
v_mfma_f32_16x16x32_bf16 v[72:75],a[248:251],v[248:251],v[72:75]
v_mfma_f32_16x16x32_bf16 v[64:67],a[124:127],v[252:255],v[64:67]
v_mfma_f32_16x16x32_bf16 v[72:75],a[252:255],v[252:255],v[72:75]
s_waitcnt lgkmcnt(0)
v_min3_u32 v27,v27,v120,v122
v_cmp_eq_u32 vcc,0,v27
s_and_b64 vcc,vcc,s[52:53]
s_cbranch_vccnz retry_239
v_mov_b32 v22,s71
buffer_store_dword v22,v23,s[20:23],s73 offen sc1
v_lshlrev_b32 v88,16,v120
v_and_b32 v89,s80,v120
v_lshlrev_b32 v90,16,v121
v_and_b32 v91,s80,v121
v_lshlrev_b32 v92,16,v122
v_and_b32 v93,s80,v122
v_lshlrev_b32 v94,16,v123
v_and_b32 v95,s80,v123
v_add_f32 v88,v64,v88
v_add_f32 v89,v65,v89
v_add_f32 v90,v66,v90
v_add_f32 v91,v67,v91
v_add_f32 v92,v72,v92
v_add_f32 v93,v73,v93
v_add_f32 v94,v74,v94
v_add_f32 v95,v75,v95
v_cvt_pk_bf16_f32 v96,v88,v89
v_cvt_pk_bf16_f32 v97,v90,v91
v_cvt_pk_bf16_f32 v98,v92,v93
v_cvt_pk_bf16_f32 v99,v94,v95
v_max_u32 v96,1,v96
buffer_store_dwordx4 v[96:99],v18,s[20:23],s70 offen offset:0 sc1
v_lshlrev_b32 v88,16,v96
v_and_b32 v89,s80,v96
v_lshlrev_b32 v90,16,v97
v_and_b32 v91,s80,v97
v_lshlrev_b32 v92,16,v98
v_and_b32 v93,s80,v98
v_lshlrev_b32 v94,16,v99
v_and_b32 v95,s80,v99
v_add_f32 v108,v88,v89
v_mul_f32 v109,v88,v88
v_add_f32 v100,v90,v91
v_mul_f32 v101,v89,v89
v_fmac_f32 v109,v90,v90
v_fmac_f32 v101,v91,v91
v_fmac_f32 v109,v92,v92
v_fmac_f32 v101,v93,v93
v_add_f32 v108,v108,v92
v_add_f32 v100,v100,v93
v_fmac_f32 v109,v94,v94
v_fmac_f32 v101,v95,v95
v_add_f32 v108,v108,v94
v_add_f32 v100,v100,v95
v_add_f32 v108,v108,v100
v_add_f32 v109,v109,v101
v_mov_b32 v100,v108
v_mov_b32 v101,v109
s_nop 0
v_permlane16_swap_b32 v100,v108
v_permlane16_swap_b32 v101,v109
v_add_f32 v108,v108,v100
v_add_f32 v109,v109,v101
v_mov_b32 v100,v108
v_mov_b32 v101,v109
s_nop 0
v_permlane32_swap_b32 v100,v108
v_permlane32_swap_b32 v101,v109
v_add_f32 v108,v108,v100
v_add_f32 v109,v109,v101
v_max_u32 v109,1,v109
buffer_store_dwordx4 v[108:111],v24,s[20:23],s70 offen sc1
v_xor_b32 v19,0x2000,v19
v_xor_b32 v20,0x2000,v20
s_sub_u32 s78,s78,2097152
v_mov_b32 v29,0
s_mov_b32 s83,0
s_mov_b32 s93,1
s_waitcnt vmcnt(3)
s_branch next_249
r_at_219:
v_mov_b32 v128,0
v_mov_b32 v129,0
v_mov_b32 v130,0
v_mov_b32 v131,0
s_cmp_ge_u32 s50,2
s_cbranch_scc1 r_ln_218
v_and_b32 v21,1,v1
v_mul_u32_u24 v21,64,v21
s_mov_b32 s65,21052928
s_mov_b32 s66,1792
pl_254:
buffer_load_dword v22,v21,s[20:23],s65 offen sc1
s_waitcnt vmcnt(0)
v_cmp_gt_u32 vcc,s66,v22
s_cbranch_vccz pok_255
s_sleep 1
s_sub_u32 s90,s90,1
s_cmp_gt_i32 s90,0
s_cbranch_scc1 pl_254
pok_255:
s_lshl_b32 s41,s41,1
s_add_u32 s41,s41,s50
v_and_b32 v21,3,v1
v_lshlrev_b32 v21,7,v21
s_lshl_b32 s65,s41,2
s_add_u32 s87,s65,s63
v_mov_b32 v99,v21
pl_256:
buffer_load_dword v22,v21,s[20:23],s87 offen sc1
s_waitcnt vmcnt(0)
v_cmp_gt_u32 vcc,14,v22
s_cbranch_vccz pok_257
s_sleep 1
s_sub_u32 s90,s90,1
s_cmp_gt_i32 s90,0
s_cbranch_scc1 pl_256
pok_257:
v_mov_b32 v21,s56
v_lshlrev_b32 v21,2,v21
s_mov_b32 s66,128
pl_258:
buffer_load_dword v22,v21,s[44:47],36 offen sc1
s_waitcnt vmcnt(0)
v_cmp_gt_u32 vcc,s66,v22
s_cbranch_vccz pok_259
s_sleep 1
s_sub_u32 s90,s90,1
s_cmp_gt_i32 s90,0
s_cbranch_scc1 pl_258
pok_259:
s_lshl_b32 s42,s41,14
s_lshr_b32 s43,s41,1
s_lshl_b32 s43,s43,14
s_and_b32 s64,s41,1
s_lshl_b32 s64,s64,12
s_add_u32 s43,s43,s64
s_add_u32 s43,s43,1572864
s_lshl_b32 s73,s41,7
s_add_u32 s73,s73,s63
s_add_u32 s73,s73,16384
v_lshrrev_b32 v6,3,v3
v_and_b32 v7,7,v3
v_lshl_add_u32 v6,v6,4,v7
v_lshlrev_b32 v6,4,v6
v_and_b32 v7,1,v4
v_lshl_add_u32 v6,v7,3,v6
v_lshrrev_b32 v8,2,v3
v_and_b32 v9,3,v3
v_lshl_add_u32 v8,v8,3,v9
s_mov_b32 s80,0x3e0293ee
v_mov_b32 v97,0xff800000
v_lshlrev_b32 v96,10,v1
v_lshlrev_b32 v98,3,v4
v_sub_u32 v98,v98,v8
v_cmp_lt_u32 s[48:49],1,v4
v_cmp_ge_i32 s[4:5],-7,v98
v_cmp_ge_i32 s[6:7],-6,v98
v_cmp_ge_i32 s[8:9],-5,v98
v_cmp_ge_i32 s[10:11],-4,v98
v_cmp_ge_i32 s[12:13],-3,v98
v_cmp_ge_i32 s[14:15],-2,v98
v_cmp_ge_i32 s[16:17],-1,v98
v_cmp_ge_i32 s[18:19],0,v98
v_cmp_ge_i32 s[32:33],1,v98
v_cmp_ge_i32 s[34:35],2,v98
v_cmp_ge_i32 s[36:37],3,v98
v_cmp_ge_i32 s[38:39],4,v98
s_add_u32 s64,s79,0
s_lshl_b32 s74,s64,21
s_lshl_b32 s64,s64,13
s_and_b32 s64,s64,0x2000
s_xor_b32 s64,s64,s61
s_add_u32 s74,s74,s64
s_add_u32 s74,s74,29360128
s_lshl_b32 s64,s50,2
s_add_u32 s64,s64,147456
v_mov_b32 v95,s64
ds_write_b32 v95,v128
s_add_u32 s66,s74,s43
kp_260:
s_add_u32 s78,s78,2
buffer_load_dwordx4 v[136:139],v16,s[20:23],s66 offen offset:0 sc1
buffer_load_dwordx4 v[140:143],v16,s[20:23],s66 offen offset:1024 sc1
buffer_load_dwordx4 v[144:147],v16,s[20:23],s66 offen offset:2048 sc1
buffer_load_dwordx4 v[148:151],v16,s[20:23],s66 offen offset:3072 sc1
s_waitcnt vmcnt(0)
kck_262:
v_min3_u32 v22,v136,v140,v144
v_min_u32 v22,v22,v148
v_cmp_eq_u32 vcc,0,v22
s_cbranch_vccz kok_261
s_sleep 1
s_sub_u32 s90,s90,1
s_cmp_gt_i32 s90,0
s_cbranch_scc1 kp_260
kok_261:
s_mov_b32 s78,0
s_add_u32 s64,s79,0
s_lshl_b32 s75,s64,21
s_lshl_b32 s64,s64,13
s_and_b32 s64,s64,0x2000
s_xor_b32 s64,s64,s61
s_add_u32 s75,s75,s64
s_add_u32 s75,s75,29360128
s_add_u32 s64,s79,0
s_lshl_b32 s76,s64,21
s_lshl_b32 s64,s64,13
s_and_b32 s64,s64,0x2000
s_xor_b32 s64,s64,s62
s_add_u32 s76,s76,s64
s_add_u32 s76,s76,29360128
s_add_u32 s77,s75,s43
s_add_u32 s75,s75,s42
s_add_u32 s76,s76,s42
s_add_u32 s65,s75,524288
buffer_load_dwordx4 a[32:35],v16,s[20:23],s65 offen offset:0 sc1
buffer_load_dwordx4 a[36:39],v16,s[20:23],s65 offen offset:1024 sc1
buffer_load_dwordx4 a[40:43],v16,s[20:23],s65 offen offset:2048 sc1
buffer_load_dwordx4 a[44:47],v16,s[20:23],s65 offen offset:3072 sc1
s_add_u32 s65,s75,528384
buffer_load_dwordx4 a[48:51],v16,s[20:23],s65 offen offset:0 sc1
buffer_load_dwordx4 a[52:55],v16,s[20:23],s65 offen offset:1024 sc1
buffer_load_dwordx4 a[56:59],v16,s[20:23],s65 offen offset:2048 sc1
buffer_load_dwordx4 a[60:63],v16,s[20:23],s65 offen offset:3072 sc1
s_add_u32 s65,s76,0
buffer_load_dwordx4 a[0:3],v16,s[20:23],s65 offen offset:0 sc1
buffer_load_dwordx4 a[4:7],v16,s[20:23],s65 offen offset:1024 sc1
buffer_load_dwordx4 a[8:11],v16,s[20:23],s65 offen offset:2048 sc1
buffer_load_dwordx4 a[12:15],v16,s[20:23],s65 offen offset:3072 sc1
s_add_u32 s65,s76,4096
buffer_load_dwordx4 a[16:19],v16,s[20:23],s65 offen offset:0 sc1
buffer_load_dwordx4 a[20:23],v16,s[20:23],s65 offen offset:1024 sc1
buffer_load_dwordx4 a[24:27],v16,s[20:23],s65 offen offset:2048 sc1
buffer_load_dwordx4 a[28:31],v16,s[20:23],s65 offen offset:3072 sc1
s_cmp_lt_u32 s79,58
s_cselect_b32 s78,s78,0
s_cmp_lg_u32 s78,0
s_cselect_b32 s66,0x7fff0000,s77
buffer_load_dwordx4 v[136:139],v16,s[20:23],s66 offen offset:0 sc1
buffer_load_dwordx4 v[140:143],v16,s[20:23],s66 offen offset:1024 sc1
buffer_load_dwordx4 v[144:147],v16,s[20:23],s66 offen offset:2048 sc1
buffer_load_dwordx4 v[148:151],v16,s[20:23],s66 offen offset:3072 sc1
s_add_u32 s65,s75,1048576
buffer_load_dwordx4 a[64:67],v16,s[20:23],s65 offen offset:0 sc1
buffer_load_dwordx4 a[68:71],v16,s[20:23],s65 offen offset:1024 sc1
buffer_load_dwordx4 a[72:75],v16,s[20:23],s65 offen offset:2048 sc1
buffer_load_dwordx4 a[76:79],v16,s[20:23],s65 offen offset:3072 sc1
s_add_u32 s65,s75,1052672
buffer_load_dwordx4 a[80:83],v16,s[20:23],s65 offen offset:0 sc1
buffer_load_dwordx4 a[84:87],v16,s[20:23],s65 offen offset:1024 sc1
buffer_load_dwordx4 a[88:91],v16,s[20:23],s65 offen offset:2048 sc1
buffer_load_dwordx4 a[92:95],v16,s[20:23],s65 offen offset:3072 sc1
s_waitcnt vmcnt(0)
aloop_263:
s_cmp_ge_u32 s79,44
s_cbranch_scc1 tk_265
tw_264:
ds_read_b32 v94,v95
s_waitcnt lgkmcnt(0)
v_readfirstlane_b32 s64,v94
s_add_u32 s64,s64,8
s_cmp_ge_u32 s64,s79
s_cbranch_scc1 tk_265
s_sleep 4
s_sub_u32 s90,s90,1
s_cmp_gt_i32 s90,0
s_cbranch_scc1 tw_264
tk_265:
s_add_u32 s64,s79,0
s_lshl_b32 s74,s64,21
s_lshl_b32 s64,s64,13
s_and_b32 s64,s64,0x2000
s_xor_b32 s64,s64,s61
s_add_u32 s74,s74,s64
s_add_u32 s74,s74,29360128
s_add_u32 s64,s79,0
s_lshl_b32 s70,s64,21
s_lshl_b32 s64,s64,13
s_and_b32 s64,s64,0x2000
s_xor_b32 s64,s64,s62
s_add_u32 s70,s70,s64
s_add_u32 s70,s70,29360128
s_waitcnt vmcnt(21)
v_mfma_f32_16x16x32_bf16 v[168:171],a[32:35],a[0:3],0
v_mfma_f32_16x16x32_bf16 v[172:175],a[36:39],a[0:3],0
v_mfma_f32_16x16x32_bf16 v[180:183],a[32:35],a[4:7],0
v_mfma_f32_16x16x32_bf16 v[184:187],a[36:39],a[4:7],0
v_mfma_f32_16x16x32_bf16 v[168:171],a[40:43],a[8:11],v[168:171]
v_mfma_f32_16x16x32_bf16 v[172:175],a[44:47],a[8:11],v[172:175]
v_mfma_f32_16x16x32_bf16 v[180:183],a[40:43],a[12:15],v[180:183]
v_mfma_f32_16x16x32_bf16 v[184:187],a[44:47],a[12:15],v[184:187]
v_mfma_f32_16x16x32_bf16 v[168:171],a[48:51],a[16:19],v[168:171]
v_mfma_f32_16x16x32_bf16 v[172:175],a[52:55],a[16:19],v[172:175]
v_mfma_f32_16x16x32_bf16 v[180:183],a[48:51],a[20:23],v[180:183]
v_mfma_f32_16x16x32_bf16 v[184:187],a[52:55],a[20:23],v[184:187]
v_mfma_f32_16x16x32_bf16 v[168:171],a[56:59],a[24:27],v[168:171]
v_mfma_f32_16x16x32_bf16 v[172:175],a[60:63],a[24:27],v[172:175]
v_mfma_f32_16x16x32_bf16 v[180:183],a[56:59],a[28:31],v[180:183]
v_mfma_f32_16x16x32_bf16 v[184:187],a[60:63],a[28:31],v[184:187]
s_nop 4
v_cndmask_b32 v168,v97,v168,s[18:19]
s_nop 0
v_cndmask_b32 v180,v97,v180,s[38:39]
v_cndmask_b32 v169,v97,v169,s[16:17]
v_cndmask_b32 v181,v97,v181,s[36:37]
v_cndmask_b32 v170,v97,v170,s[14:15]
v_cndmask_b32 v182,v97,v182,s[34:35]
v_cndmask_b32 v171,v97,v171,s[12:13]
v_cndmask_b32 v183,v97,v183,s[32:33]
v_cndmask_b32 v172,v97,v172,s[10:11]
v_cndmask_b32 v184,v97,v184,s[18:19]
v_cndmask_b32 v173,v97,v173,s[8:9]
v_cndmask_b32 v185,v97,v185,s[16:17]
v_cndmask_b32 v174,v97,v174,s[6:7]
v_cndmask_b32 v186,v97,v186,s[14:15]
v_cndmask_b32 v175,v97,v175,s[4:5]
v_cndmask_b32 v187,v97,v187,s[12:13]
v_max3_f32 v116,v168,v169,v170
v_max3_f32 v122,v180,v181,v182
v_max3_f32 v118,v171,v172,v173
v_max3_f32 v124,v183,v184,v185
v_max3_f32 v116,v116,v174,v175
v_max3_f32 v122,v122,v186,v187
v_max_f32 v116,v116,v118
v_max_f32 v122,v122,v124
v_mov_b32 v118,v116
v_mov_b32 v124,v122
s_nop 0
v_permlane16_swap_b32 v118,v116
v_permlane16_swap_b32 v124,v122
v_max_f32 v116,v116,v118
v_max_f32 v122,v122,v124
v_mov_b32 v118,v116
v_mov_b32 v124,v122
s_nop 0
v_permlane32_swap_b32 v118,v116
v_permlane32_swap_b32 v124,v122
v_max_f32 v116,v116,v118
v_max_f32 v122,v122,v124
v_mul_f32 v116,s80,v116
v_mul_f32 v122,s80,v122
v_fma_f32 v168,v168,s80,-v116
v_fma_f32 v180,v180,s80,-v122
v_fma_f32 v169,v169,s80,-v116
v_fma_f32 v181,v181,s80,-v122
v_fma_f32 v170,v170,s80,-v116
v_fma_f32 v182,v182,s80,-v122
v_fma_f32 v171,v171,s80,-v116
v_fma_f32 v183,v183,s80,-v122
v_fma_f32 v172,v172,s80,-v116
v_fma_f32 v184,v184,s80,-v122
v_fma_f32 v173,v173,s80,-v116
v_fma_f32 v185,v185,s80,-v122
v_fma_f32 v174,v174,s80,-v116
v_fma_f32 v186,v186,s80,-v122
v_fma_f32 v175,v175,s80,-v116
v_fma_f32 v187,v187,s80,-v122
v_exp_f32 v168,v168
v_exp_f32 v180,v180
v_exp_f32 v169,v169
v_exp_f32 v181,v181
v_exp_f32 v170,v170
v_exp_f32 v182,v182
v_exp_f32 v171,v171
v_exp_f32 v183,v183
v_exp_f32 v172,v172
v_exp_f32 v184,v184
v_exp_f32 v173,v173
v_exp_f32 v185,v185
v_exp_f32 v174,v174
v_exp_f32 v186,v186
v_exp_f32 v175,v175
v_exp_f32 v187,v187
v_add_f32 v117,v168,v169
v_add_f32 v123,v180,v181
v_add_f32 v119,v170,v171
v_add_f32 v125,v182,v183
v_add_f32 v117,v117,v172
v_add_f32 v123,v123,v184
v_add_f32 v119,v119,v173
v_add_f32 v125,v125,v185
v_add_f32 v117,v117,v174
v_add_f32 v123,v123,v186
v_add_f32 v119,v119,v175
v_add_f32 v125,v125,v187
v_add_f32 v117,v117,v119
v_add_f32 v123,v123,v125
v_mov_b32 v118,v117
v_mov_b32 v124,v123
s_nop 0
v_permlane16_swap_b32 v118,v117
v_permlane16_swap_b32 v124,v123
v_add_f32 v117,v117,v118
v_add_f32 v123,v123,v124
v_mov_b32 v118,v117
v_mov_b32 v124,v123
s_nop 0
v_permlane32_swap_b32 v118,v117
v_permlane32_swap_b32 v124,v123
v_add_f32 v117,v117,v118
v_add_f32 v123,v123,v124
s_cmp_gt_u32 s71,45
s_cselect_b32 s65,0x7fff0000,s73
s_waitcnt vmcnt(12)
v_add_u32 v22,s71,-1
buffer_store_dword v22,v23,s[20:23],s65 offen sc1
s_add_u32 s66,s74,s43
s_cmp_eq_u32 s78,0
s_cbranch_scc1 kx_269
s_cmp_eq_u32 s84,0
s_cselect_b32 s64,3,0
s_add_u32 s64,s64,s78
kbo_271:
s_sleep 2
s_sub_u32 s64,s64,1
s_cmp_gt_i32 s64,0
s_cbranch_scc1 kbo_271
s_cmp_lt_u32 s84,3
s_cselect_b32 s64,1,0
s_cmp_ge_u32 s84,4
s_subb_u32 s78,s78,2
s_add_u32 s84,s84,1
kpr_270:
s_mov_b64 exec,15
buffer_load_dword v22,v96,s[20:23],s66 offen sc1
s_waitcnt vmcnt(0)
v_cmp_eq_u32 vcc,0,v22
s_mov_b64 exec,-1
s_cbranch_vccz kp_266
s_add_u32 s78,s78,s64
s_mov_b32 s64,1
s_mov_b32 s84,0
s_sleep 1
s_sub_u32 s90,s90,1
s_cmp_gt_i32 s90,0
s_cbranch_scc1 kpr_270
s_branch kp_266
kx_269:
s_mov_b32 s84,0
s_waitcnt vmcnt(9)
s_branch kck_268
kp_266:
s_add_u32 s78,s78,2
buffer_load_dwordx4 v[136:139],v16,s[20:23],s66 offen offset:0 sc1
buffer_load_dwordx4 v[140:143],v16,s[20:23],s66 offen offset:1024 sc1
buffer_load_dwordx4 v[144:147],v16,s[20:23],s66 offen offset:2048 sc1
buffer_load_dwordx4 v[148:151],v16,s[20:23],s66 offen offset:3072 sc1
s_waitcnt vmcnt(0)
kck_268:
v_min3_u32 v22,v136,v140,v144
v_min_u32 v22,v22,v148
v_cmp_eq_u32 vcc,0,v22
s_cbranch_vccz kok_267
s_sleep 1
s_sub_u32 s90,s90,1
s_cmp_gt_i32 s90,0
s_cbranch_scc1 kp_266
kok_267:
s_min_u32 s78,s78,40
buffer_load_dwordx2 v[100:101],v6,s[20:23],s66 offen offset:0 sc1
buffer_load_dwordx2 v[102:103],v6,s[20:23],s66 offen offset:512 sc1
buffer_load_dwordx2 v[104:105],v6,s[20:23],s66 offen offset:1024 sc1
buffer_load_dwordx2 v[106:107],v6,s[20:23],s66 offen offset:1536 sc1
buffer_load_dwordx2 v[108:109],v6,s[20:23],s66 offen offset:2048 sc1
buffer_load_dwordx2 v[110:111],v6,s[20:23],s66 offen offset:2560 sc1
buffer_load_dwordx2 v[112:113],v6,s[20:23],s66 offen offset:3072 sc1
buffer_load_dwordx2 v[114:115],v6,s[20:23],s66 offen offset:3584 sc1
v_mfma_f32_16x16x32_bf16 v[176:179],v[136:139],a[0:3],0
v_mfma_f32_16x16x32_bf16 v[188:191],v[136:139],a[4:7],0
v_mfma_f32_16x16x32_bf16 v[176:179],v[140:143],a[8:11],v[176:179]
v_mfma_f32_16x16x32_bf16 v[188:191],v[140:143],a[12:15],v[188:191]
v_mfma_f32_16x16x32_bf16 v[176:179],v[144:147],a[16:19],v[176:179]
v_mfma_f32_16x16x32_bf16 v[188:191],v[144:147],a[20:23],v[188:191]
v_mfma_f32_16x16x32_bf16 v[176:179],v[148:151],a[24:27],v[176:179]
v_mfma_f32_16x16x32_bf16 v[188:191],v[148:151],a[28:31],v[188:191]
s_cmp_lg_u32 s79,55
s_cbranch_scc1 q2nd_272
pl_273:
buffer_load_dword v98,v99,s[20:23],s87 offen sc1
s_waitcnt vmcnt(0)
v_cmp_gt_u32 vcc,18,v98
s_cbranch_vccz pok_274
s_sleep 1
s_sub_u32 s90,s90,1
s_cmp_gt_i32 s90,0
s_cbranch_scc1 pl_273
pok_274:
q2nd_272:
s_add_u32 s64,s79,1
s_lshl_b32 s75,s64,21
s_lshl_b32 s64,s64,13
s_and_b32 s64,s64,0x2000
s_xor_b32 s64,s64,s61
s_add_u32 s75,s75,s64
s_add_u32 s75,s75,29360128
s_add_u32 s64,s79,1
s_lshl_b32 s76,s64,21
s_lshl_b32 s64,s64,13
s_and_b32 s64,s64,0x2000
s_xor_b32 s64,s64,s62
s_add_u32 s76,s76,s64
s_add_u32 s76,s76,29360128
s_add_u32 s77,s75,s43
s_add_u32 s75,s75,s42
s_add_u32 s76,s76,s42
s_cmp_lt_u32 s79,63
s_cselect_b32 s75,s75,0x7fff0000
s_cselect_b32 s76,s76,0x7fff0000
s_cselect_b32 s77,s77,0x7fff0000
s_add_u32 s65,s75,524288
buffer_load_dwordx4 a[32:35],v16,s[20:23],s65 offen offset:0 sc1
buffer_load_dwordx4 a[36:39],v16,s[20:23],s65 offen offset:1024 sc1
buffer_load_dwordx4 a[40:43],v16,s[20:23],s65 offen offset:2048 sc1
buffer_load_dwordx4 a[44:47],v16,s[20:23],s65 offen offset:3072 sc1
s_add_u32 s65,s75,528384
buffer_load_dwordx4 a[48:51],v16,s[20:23],s65 offen offset:0 sc1
buffer_load_dwordx4 a[52:55],v16,s[20:23],s65 offen offset:1024 sc1
buffer_load_dwordx4 a[56:59],v16,s[20:23],s65 offen offset:2048 sc1
buffer_load_dwordx4 a[60:63],v16,s[20:23],s65 offen offset:3072 sc1
s_add_u32 s65,s76,0
buffer_load_dwordx4 a[0:3],v16,s[20:23],s65 offen offset:0 sc1
buffer_load_dwordx4 a[4:7],v16,s[20:23],s65 offen offset:1024 sc1
buffer_load_dwordx4 a[8:11],v16,s[20:23],s65 offen offset:2048 sc1
buffer_load_dwordx4 a[12:15],v16,s[20:23],s65 offen offset:3072 sc1
s_add_u32 s65,s76,4096
buffer_load_dwordx4 a[16:19],v16,s[20:23],s65 offen offset:0 sc1
buffer_load_dwordx4 a[20:23],v16,s[20:23],s65 offen offset:1024 sc1
buffer_load_dwordx4 a[24:27],v16,s[20:23],s65 offen offset:2048 sc1
buffer_load_dwordx4 a[28:31],v16,s[20:23],s65 offen offset:3072 sc1
v_cndmask_b32 v176,v97,v176,s[48:49]
v_cndmask_b32 v188,v97,v188,s[48:49]
v_cndmask_b32 v177,v97,v177,s[48:49]
v_cndmask_b32 v189,v97,v189,s[48:49]
v_cndmask_b32 v178,v97,v178,s[48:49]
v_cndmask_b32 v190,v97,v190,s[48:49]
v_cndmask_b32 v179,v97,v179,s[48:49]
v_cndmask_b32 v191,v97,v191,s[48:49]
v_max3_f32 v119,v176,v177,v178
v_max3_f32 v125,v188,v189,v190
v_max_f32 v119,v119,v179
v_max_f32 v125,v125,v191
v_mov_b32 v118,v119
v_mov_b32 v124,v125
s_nop 0
v_permlane16_swap_b32 v118,v119
v_permlane16_swap_b32 v124,v125
v_max_f32 v119,v119,v118
v_max_f32 v125,v125,v124
v_mov_b32 v118,v119
v_mov_b32 v124,v125
s_nop 0
v_permlane32_swap_b32 v118,v119
v_permlane32_swap_b32 v124,v125
v_max_f32 v119,v119,v118
v_max_f32 v125,v125,v124
v_mul_f32 v119,s80,v119
v_mul_f32 v125,s80,v125
v_max_f32 v119,v119,v116
v_max_f32 v125,v125,v122
v_fma_f32 v176,v176,s80,-v119
v_fma_f32 v188,v188,s80,-v125
v_fma_f32 v177,v177,s80,-v119
v_fma_f32 v189,v189,s80,-v125
v_fma_f32 v178,v178,s80,-v119
v_fma_f32 v190,v190,s80,-v125
v_fma_f32 v179,v179,s80,-v119
v_fma_f32 v191,v191,s80,-v125
v_sub_f32 v116,v116,v119
v_sub_f32 v122,v122,v125
v_exp_f32 v176,v176
v_exp_f32 v188,v188
v_exp_f32 v177,v177
v_exp_f32 v189,v189
v_exp_f32 v178,v178
v_exp_f32 v190,v190
v_exp_f32 v179,v179
v_exp_f32 v191,v191
v_exp_f32 v116,v116
v_exp_f32 v122,v122
v_add_f32 v120,v176,v177
v_add_f32 v126,v188,v189
v_add_f32 v121,v178,v179
v_add_f32 v127,v190,v191
v_add_f32 v120,v120,v121
v_add_f32 v126,v126,v127
v_mov_b32 v118,v120
v_mov_b32 v124,v126
s_nop 0
v_permlane16_swap_b32 v118,v120
v_permlane16_swap_b32 v124,v126
v_add_f32 v120,v120,v118
v_add_f32 v126,v126,v124
v_mov_b32 v118,v120
v_mov_b32 v124,v126
s_nop 0
v_permlane32_swap_b32 v118,v120
v_permlane32_swap_b32 v124,v126
v_add_f32 v120,v120,v118
v_add_f32 v126,v126,v124
v_fmac_f32 v120,v117,v116
v_fmac_f32 v126,v123,v122
v_rcp_f32 v121,v120
v_rcp_f32 v127,v126
v_mul_f32 v119,v116,v121
v_mul_f32 v125,v122,v127
v_pk_mul_f32 v[168:169],v[168:169],v[118:119] op_sel:[0,1] op_sel_hi:[1,1]
v_pk_mul_f32 v[180:181],v[180:181],v[124:125] op_sel:[0,1] op_sel_hi:[1,1]
v_pk_mul_f32 v[170:171],v[170:171],v[118:119] op_sel:[0,1] op_sel_hi:[1,1]
v_pk_mul_f32 v[182:183],v[182:183],v[124:125] op_sel:[0,1] op_sel_hi:[1,1]
v_pk_mul_f32 v[172:173],v[172:173],v[118:119] op_sel:[0,1] op_sel_hi:[1,1]
v_pk_mul_f32 v[184:185],v[184:185],v[124:125] op_sel:[0,1] op_sel_hi:[1,1]
v_pk_mul_f32 v[174:175],v[174:175],v[118:119] op_sel:[0,1] op_sel_hi:[1,1]
v_pk_mul_f32 v[186:187],v[186:187],v[124:125] op_sel:[0,1] op_sel_hi:[1,1]
v_cvt_pk_bf16_f32 v48,v168,v169
v_cvt_pk_bf16_f32 v56,v180,v181
v_cvt_pk_bf16_f32 v49,v170,v171
v_cvt_pk_bf16_f32 v57,v182,v183
v_cvt_pk_bf16_f32 v50,v172,v173
v_cvt_pk_bf16_f32 v58,v184,v185
v_cvt_pk_bf16_f32 v51,v174,v175
v_cvt_pk_bf16_f32 v59,v186,v187
v_pk_mul_f32 v[176:177],v[176:177],v[120:121] op_sel:[0,1] op_sel_hi:[1,1]
v_pk_mul_f32 v[188:189],v[188:189],v[126:127] op_sel:[0,1] op_sel_hi:[1,1]
v_pk_mul_f32 v[178:179],v[178:179],v[120:121] op_sel:[0,1] op_sel_hi:[1,1]
v_pk_mul_f32 v[190:191],v[190:191],v[126:127] op_sel:[0,1] op_sel_hi:[1,1]
v_cvt_pk_bf16_f32 v52,v176,v177
v_cvt_pk_bf16_f32 v60,v188,v189
v_cvt_pk_bf16_f32 v53,v178,v179
v_cvt_pk_bf16_f32 v61,v190,v191
s_add_u32 s70,s70,s42
s_waitcnt vmcnt(24)
v_mfma_f32_16x16x32_bf16 v[192:195],a[64:67],v[48:51],0
v_mfma_f32_16x16x32_bf16 v[196:199],a[64:67],v[56:59],0
v_mfma_f32_16x16x32_bf16 v[200:203],a[68:71],v[48:51],0
v_mfma_f32_16x16x32_bf16 v[204:207],a[68:71],v[56:59],0
v_mfma_f32_16x16x32_bf16 v[208:211],a[72:75],v[48:51],0
v_mfma_f32_16x16x32_bf16 v[212:215],a[72:75],v[56:59],0
v_mfma_f32_16x16x32_bf16 v[216:219],a[76:79],v[48:51],0
v_mfma_f32_16x16x32_bf16 v[220:223],a[76:79],v[56:59],0
s_waitcnt vmcnt(16)
v_mfma_f32_16x16x16_bf16 v[192:195],v[100:101],v[52:53],v[192:195]
v_mfma_f32_16x16x16_bf16 v[196:199],v[100:101],v[60:61],v[196:199]
v_mfma_f32_16x16x16_bf16 v[200:203],v[102:103],v[52:53],v[200:203]
v_mfma_f32_16x16x16_bf16 v[204:207],v[102:103],v[60:61],v[204:207]
v_mfma_f32_16x16x32_bf16 v[224:227],a[80:83],v[48:51],0
v_mfma_f32_16x16x32_bf16 v[228:231],a[80:83],v[56:59],0
v_mfma_f32_16x16x32_bf16 v[232:235],a[84:87],v[48:51],0
v_mfma_f32_16x16x32_bf16 v[236:239],a[84:87],v[56:59],0
v_mfma_f32_16x16x16_bf16 v[208:211],v[104:105],v[52:53],v[208:211]
s_add_u32 s65,s70,524288
v_mfma_f32_16x16x16_bf16 v[212:215],v[104:105],v[60:61],v[212:215]
v_cvt_pk_bf16_f32 v64,v192,v193
v_cvt_pk_bf16_f32 v65,v194,v195
v_mfma_f32_16x16x16_bf16 v[216:219],v[106:107],v[52:53],v[216:219]
v_cvt_pk_bf16_f32 v66,v200,v201
v_mfma_f32_16x16x16_bf16 v[220:223],v[106:107],v[60:61],v[220:223]
v_cvt_pk_bf16_f32 v67,v202,v203
v_max_u32 v64,1,v64
v_mfma_f32_16x16x32_bf16 v[240:243],a[88:91],v[48:51],0
buffer_store_dwordx4 v[64:67],v16,s[20:23],s65 offen offset:0 sc1
v_cvt_pk_bf16_f32 v68,v196,v197
v_mfma_f32_16x16x32_bf16 v[244:247],a[88:91],v[56:59],0
v_cvt_pk_bf16_f32 v69,v198,v199
v_mfma_f32_16x16x32_bf16 v[248:251],a[92:95],v[48:51],0
v_cvt_pk_bf16_f32 v70,v204,v205
v_cvt_pk_bf16_f32 v71,v206,v207
v_mfma_f32_16x16x32_bf16 v[252:255],a[92:95],v[56:59],0
v_max_u32 v68,1,v68
buffer_store_dwordx4 v[68:71],v16,s[20:23],s65 offen offset:1024 sc1
v_mfma_f32_16x16x16_bf16 v[224:227],v[108:109],v[52:53],v[224:227]
v_cvt_pk_bf16_f32 v72,v208,v209
v_mfma_f32_16x16x16_bf16 v[228:231],v[108:109],v[60:61],v[228:231]
v_cvt_pk_bf16_f32 v73,v210,v211
v_cvt_pk_bf16_f32 v74,v216,v217
v_mfma_f32_16x16x16_bf16 v[232:235],v[110:111],v[52:53],v[232:235]
v_cvt_pk_bf16_f32 v75,v218,v219
v_mfma_f32_16x16x16_bf16 v[236:239],v[110:111],v[60:61],v[236:239]
v_max_u32 v72,1,v72
buffer_store_dwordx4 v[72:75],v16,s[20:23],s65 offen offset:2048 sc1
v_mfma_f32_16x16x16_bf16 v[240:243],v[112:113],v[52:53],v[240:243]
v_cvt_pk_bf16_f32 v76,v212,v213
v_mfma_f32_16x16x16_bf16 v[244:247],v[112:113],v[60:61],v[244:247]
v_cvt_pk_bf16_f32 v77,v214,v215
v_cvt_pk_bf16_f32 v78,v220,v221
v_mfma_f32_16x16x16_bf16 v[248:251],v[114:115],v[52:53],v[248:251]
v_cvt_pk_bf16_f32 v79,v222,v223
v_mfma_f32_16x16x16_bf16 v[252:255],v[114:115],v[60:61],v[252:255]
v_max_u32 v76,1,v76
buffer_store_dwordx4 v[76:79],v16,s[20:23],s65 offen offset:3072 sc1
s_cmp_gt_u32 s71,44
s_cselect_b32 s64,s73,0x7fff0000
v_mov_b32 v22,s71
buffer_store_dword v22,v23,s[20:23],s64 offen sc1
s_add_u32 s65,s70,528384
v_cvt_pk_bf16_f32 v64,v224,v225
v_cvt_pk_bf16_f32 v65,v226,v227
v_cvt_pk_bf16_f32 v66,v232,v233
v_cvt_pk_bf16_f32 v67,v234,v235
v_max_u32 v64,1,v64
buffer_store_dwordx4 v[64:67],v16,s[20:23],s65 offen offset:0 sc1
v_cvt_pk_bf16_f32 v68,v228,v229
v_cvt_pk_bf16_f32 v69,v230,v231
v_cvt_pk_bf16_f32 v70,v236,v237
v_cvt_pk_bf16_f32 v71,v238,v239
v_max_u32 v68,1,v68
buffer_store_dwordx4 v[68:71],v16,s[20:23],s65 offen offset:1024 sc1
v_cvt_pk_bf16_f32 v72,v240,v241
v_cvt_pk_bf16_f32 v73,v242,v243
v_cvt_pk_bf16_f32 v74,v248,v249
v_cvt_pk_bf16_f32 v75,v250,v251
v_max_u32 v72,1,v72
buffer_store_dwordx4 v[72:75],v16,s[20:23],s65 offen offset:2048 sc1
v_cvt_pk_bf16_f32 v76,v244,v245
v_cvt_pk_bf16_f32 v77,v246,v247
v_cvt_pk_bf16_f32 v78,v252,v253
v_cvt_pk_bf16_f32 v79,v254,v255
v_max_u32 v76,1,v76
buffer_store_dwordx4 v[76:79],v16,s[20:23],s65 offen offset:3072 sc1
s_cmp_lt_u32 s79,58
s_cselect_b32 s78,s78,0
s_cmp_lg_u32 s78,0
s_cselect_b32 s66,0x7fff0000,s77
buffer_load_dwordx4 v[136:139],v16,s[20:23],s66 offen offset:0 sc1
buffer_load_dwordx4 v[140:143],v16,s[20:23],s66 offen offset:1024 sc1
buffer_load_dwordx4 v[144:147],v16,s[20:23],s66 offen offset:2048 sc1
buffer_load_dwordx4 v[148:151],v16,s[20:23],s66 offen offset:3072 sc1
s_add_u32 s65,s75,1048576
buffer_load_dwordx4 a[64:67],v16,s[20:23],s65 offen offset:0 sc1
buffer_load_dwordx4 a[68:71],v16,s[20:23],s65 offen offset:1024 sc1
buffer_load_dwordx4 a[72:75],v16,s[20:23],s65 offen offset:2048 sc1
buffer_load_dwordx4 a[76:79],v16,s[20:23],s65 offen offset:3072 sc1
s_add_u32 s65,s75,1052672
buffer_load_dwordx4 a[80:83],v16,s[20:23],s65 offen offset:0 sc1
buffer_load_dwordx4 a[84:87],v16,s[20:23],s65 offen offset:1024 sc1
buffer_load_dwordx4 a[88:91],v16,s[20:23],s65 offen offset:2048 sc1
buffer_load_dwordx4 a[92:95],v16,s[20:23],s65 offen offset:3072 sc1
s_add_u32 s79,s79,1
s_add_u32 s71,s71,1
s_cmp_lt_u32 s79,64
s_cbranch_scc1 aloop_263
s_endpgm
r_ln_218:
v_and_b32 v21,1,v1
v_mul_u32_u24 v21,960,v21
s_mov_b32 s65,21052032
s_mov_b32 s66,1792
pl_275:
buffer_load_dword v22,v21,s[20:23],s65 offen sc1
s_waitcnt vmcnt(0)
v_cmp_gt_u32 vcc,s66,v22
s_cbranch_vccz pok_276
s_sleep 1
s_sub_u32 s90,s90,1
s_cmp_gt_i32 s90,0
s_cbranch_scc1 pl_275
pok_276:
s_lshl_b32 s41,s59,1
s_add_u32 s41,s41,s50
s_sub_u32 s41,s41,2
v_lshlrev_b32 v5,5,v1
s_mov_b32 s64,16384
buffer_load_dwordx4 v[40:43],v5,s[20:23],s64 offen offset:0 sc1
buffer_load_dwordx4 v[44:47],v5,s[20:23],s64 offen offset:16 sc1
buffer_load_dwordx4 v[48:51],v5,s[20:23],s64 offen offset:2048 sc1
buffer_load_dwordx4 v[52:55],v5,s[20:23],s64 offen offset:2064 sc1
s_mov_b32 s64,12288
buffer_load_dwordx4 v[56:59],v5,s[20:23],s64 offen offset:0 sc1
buffer_load_dwordx4 v[60:63],v5,s[20:23],s64 offen offset:16 sc1
buffer_load_dwordx4 v[64:67],v5,s[20:23],s64 offen offset:2048 sc1
buffer_load_dwordx4 v[68:71],v5,s[20:23],s64 offen offset:2064 sc1
s_lshr_b32 s64,s41,2
s_add_u32 s64,s64,64
s_lshl_b32 s64,s64,14
s_and_b32 s65,s41,3
s_lshl_b32 s65,s65,11
s_add_u32 s64,s64,s65
v_add_u32 v19,s64,v16
v_add_u32 v19,786432,v19
s_lshl_b32 s65,s41,7
v_add_u32 v5,s65,v16
v_and_b32 v5,2047,v5
v_add_u32 v17,s64,v5
v_xor_b32 v18,1024,v17
v_add_u32 v24,0xfff00000,v17
v_xor_b32 v25,1024,v24
v_lshlrev_b32 v21,2,v1
s_and_b32 s64,s41,4
s_lshl_b32 s64,s64,6
s_add_u32 s74,s63,s64
s_add_u32 s74,s74,2048
s_mov_b32 s83,1
s_lshl_b32 s73,s41,2
s_add_u32 s73,s73,s63
s_add_u32 s73,s73,2560
v_mov_b32 v8,1
v_mov_b32 v9,1
v_mov_b32 v10,1
v_mov_b32 v11,1
s_add_u32 s64,s62,27262976
s_xor_b32 s65,s62,0x2000
s_add_u32 s65,s65,163577856
buffer_store_dwordx4 v[8:11],v24,s[20:23],s64 offen sc1
buffer_store_dwordx4 v[8:11],v25,s[20:23],s64 offen sc1
buffer_store_dwordx4 v[8:11],v24,s[20:23],s65 offen sc1
buffer_store_dwordx4 v[8:11],v25,s[20:23],s65 offen sc1
s_mov_b32 s82,0x3a800000
s_waitcnt vmcnt(0)
v_add_f32 v40,1.0,v40
v_add_f32 v41,1.0,v41
v_add_f32 v42,1.0,v42
v_add_f32 v43,1.0,v43
v_add_f32 v44,1.0,v44
v_add_f32 v45,1.0,v45
v_add_f32 v46,1.0,v46
v_add_f32 v47,1.0,v47
v_add_f32 v48,1.0,v48
v_add_f32 v49,1.0,v49
v_add_f32 v50,1.0,v50
v_add_f32 v51,1.0,v51
v_add_f32 v52,1.0,v52
v_add_f32 v53,1.0,v53
v_add_f32 v54,1.0,v54
v_add_f32 v55,1.0,v55
s_lshl_b32 s64,s50,2
s_add_u32 s64,s64,147448
v_mov_b32 v7,s64
s_add_u32 s64,s79,0
s_lshl_b32 s70,s64,21
s_lshl_b32 s64,s64,13
s_and_b32 s64,s64,0x2000
s_xor_b32 s64,s64,s62
s_add_u32 s70,s70,s64
s_add_u32 s70,s70,29360128
lloop_277:
s_add_u32 s75,s70,2097152
s_xor_b32 s75,s75,0x2000
s_add_u32 s96,s71,1
s_cmp_eq_u32 s83,0
s_cbranch_scc1 lahead_280
s_cmp_gt_u32 s71,44
s_cbranch_scc1 xp_278
pl_282:
buffer_load_dword v29,v21,s[20:23],s74 offen sc1
s_waitcnt vmcnt(0)
v_cmp_gt_u32 vcc,s71,v29
s_cbranch_vccz pok_283
s_sleep 1
s_sub_u32 s90,s90,1
s_cmp_gt_i32 s90,0
s_cbranch_scc1 pl_282
pok_283:
xp_278:
buffer_load_dwordx4 v[8:11],v17,s[20:23],s70 offen sc1
buffer_load_dwordx4 v[12:15],v18,s[20:23],s70 offen sc1
s_waitcnt vmcnt(0)
v_min3_u32 v22,v8,v10,v12
v_min_u32 v22,v22,v14
v_cmp_eq_u32 vcc,0,v22
s_cbranch_vccz xk_279
s_sleep 1
s_sub_u32 s90,s90,1
s_cmp_gt_i32 s90,0
s_cbranch_scc1 xp_278
s_branch xk_279
lahead_280:
s_waitcnt vmcnt(6)
v_mov_b32 v8,v104
v_mov_b32 v9,v105
v_mov_b32 v10,v106
v_mov_b32 v11,v107
v_mov_b32 v12,v108
v_mov_b32 v13,v109
v_mov_b32 v14,v110
v_mov_b32 v15,v111
v_min3_u32 v22,v8,v10,v12
v_min_u32 v22,v22,v14
v_cmp_eq_u32 vcc,0,v22
s_cbranch_vccnz xp_278
xk_279:
v_cmp_gt_u32 vcc,s96,v29
s_or_b32 s83,vcc_lo,vcc_hi
s_cselect_b32 s76,0x7fff0000,s75
buffer_load_dwordx4 v[104:107],v17,s[20:23],s76 offen sc1
buffer_load_dwordx4 v[108:111],v18,s[20:23],s76 offen sc1
buffer_load_dword v29,v21,s[20:23],s74 offen sc1
v_lshlrev_b32 v80,16,v8
v_and_b32 v81,s80,v8
v_lshlrev_b32 v82,16,v9
v_and_b32 v83,s80,v9
v_lshlrev_b32 v84,16,v10
v_and_b32 v85,s80,v10
v_lshlrev_b32 v86,16,v11
v_and_b32 v87,s80,v11
v_lshlrev_b32 v88,16,v12
v_and_b32 v89,s80,v12
v_lshlrev_b32 v90,16,v13
v_and_b32 v91,s80,v13
v_lshlrev_b32 v92,16,v14
v_and_b32 v93,s80,v14
v_lshlrev_b32 v94,16,v15
v_and_b32 v95,s80,v15
v_pk_add_f32 v[96:97],v[80:81],v[82:83]
v_pk_mul_f32 v[100:101],v[80:81],v[80:81]
v_pk_add_f32 v[98:99],v[88:89],v[90:91]
v_pk_mul_f32 v[102:103],v[88:89],v[88:89]
v_pk_fma_f32 v[100:101],v[82:83],v[82:83],v[100:101]
v_pk_fma_f32 v[102:103],v[90:91],v[90:91],v[102:103]
v_pk_add_f32 v[96:97],v[96:97],v[84:85]
v_pk_fma_f32 v[100:101],v[84:85],v[84:85],v[100:101]
v_pk_add_f32 v[98:99],v[98:99],v[92:93]
v_pk_fma_f32 v[102:103],v[92:93],v[92:93],v[102:103]
v_pk_add_f32 v[96:97],v[96:97],v[86:87]
v_pk_fma_f32 v[100:101],v[86:87],v[86:87],v[100:101]
v_pk_add_f32 v[98:99],v[98:99],v[94:95]
v_pk_fma_f32 v[102:103],v[94:95],v[94:95],v[102:103]
v_pk_add_f32 v[96:97],v[96:97],v[98:99]
v_pk_add_f32 v[100:101],v[100:101],v[102:103]
v_add_f32 v96,v96,v97
v_add_f32 v97,v100,v101
s_nop 0
v_add_f32_dpp v96,v96,v96 quad_perm:[1,0,3,2] row_mask:0xf bank_mask:0xf
v_add_f32_dpp v97,v97,v97 quad_perm:[1,0,3,2] row_mask:0xf bank_mask:0xf
s_nop 0
v_add_f32_dpp v96,v96,v96 quad_perm:[2,3,0,1] row_mask:0xf bank_mask:0xf
v_add_f32_dpp v97,v97,v97 quad_perm:[2,3,0,1] row_mask:0xf bank_mask:0xf
s_nop 0
v_add_f32_dpp v96,v96,v96 row_half_mirror row_mask:0xf bank_mask:0xf
v_add_f32_dpp v97,v97,v97 row_half_mirror row_mask:0xf bank_mask:0xf
s_nop 0
v_add_f32_dpp v96,v96,v96 row_mirror row_mask:0xf bank_mask:0xf
v_add_f32_dpp v97,v97,v97 row_mirror row_mask:0xf bank_mask:0xf
v_mov_b32 v98,v96
v_mov_b32 v99,v97
s_nop 0
v_permlane16_swap_b32 v98,v96
v_permlane16_swap_b32 v99,v97
v_pk_add_f32 v[96:97],v[96:97],v[98:99]
v_mov_b32 v98,v96
v_mov_b32 v99,v97
s_nop 0
v_permlane32_swap_b32 v98,v96
v_permlane32_swap_b32 v99,v97
v_pk_add_f32 v[96:97],v[96:97],v[98:99]
v_mul_f32 v96,0xba800000,v96
v_mul_f32 v98,v96,v96
v_fma_f32 v98,v97,s82,-v98
v_max_f32 v98,0,v98
v_add_f32 v98,0x3727c5ac,v98
v_rsq_f32 v98,v98
s_nop 0
v_mul_f32 v96,v96,v98
v_pk_fma_f32 v[80:81],v[80:81],v[98:99],v[96:97] op_sel_hi:[1,0,0]
v_pk_fma_f32 v[82:83],v[82:83],v[98:99],v[96:97] op_sel_hi:[1,0,0]
v_pk_fma_f32 v[84:85],v[84:85],v[98:99],v[96:97] op_sel_hi:[1,0,0]
v_pk_fma_f32 v[86:87],v[86:87],v[98:99],v[96:97] op_sel_hi:[1,0,0]
v_pk_fma_f32 v[88:89],v[88:89],v[98:99],v[96:97] op_sel_hi:[1,0,0]
v_pk_fma_f32 v[90:91],v[90:91],v[98:99],v[96:97] op_sel_hi:[1,0,0]
v_pk_fma_f32 v[92:93],v[92:93],v[98:99],v[96:97] op_sel_hi:[1,0,0]
v_pk_fma_f32 v[94:95],v[94:95],v[98:99],v[96:97] op_sel_hi:[1,0,0]
v_pk_fma_f32 v[80:81],v[80:81],v[40:41],v[56:57]
v_pk_fma_f32 v[82:83],v[82:83],v[42:43],v[58:59]
v_pk_fma_f32 v[84:85],v[84:85],v[44:45],v[60:61]
v_pk_fma_f32 v[86:87],v[86:87],v[46:47],v[62:63]
v_pk_fma_f32 v[88:89],v[88:89],v[48:49],v[64:65]
v_pk_fma_f32 v[90:91],v[90:91],v[50:51],v[66:67]
v_pk_fma_f32 v[92:93],v[92:93],v[52:53],v[68:69]
v_pk_fma_f32 v[94:95],v[94:95],v[54:55],v[70:71]
v_cvt_pk_bf16_f32 v8,v80,v81
v_cvt_pk_bf16_f32 v9,v82,v83
v_cvt_pk_bf16_f32 v10,v84,v85
v_cvt_pk_bf16_f32 v11,v86,v87
v_cvt_pk_bf16_f32 v12,v88,v89
v_cvt_pk_bf16_f32 v13,v90,v91
v_cvt_pk_bf16_f32 v14,v92,v93
v_cvt_pk_bf16_f32 v15,v94,v95
v_max_u32 v8,1,v8
v_max_u32 v10,1,v10
v_max_u32 v12,1,v12
v_max_u32 v14,1,v14
s_xor_b32 s78,s70,0x2000
s_waitcnt vmcnt(3)
v_add_u32 v22,s71,-1
buffer_store_dword v22,v23,s[24:27],s73 offen
buffer_store_dword v22,v23,s[28:31],s73 offen sc1
buffer_store_dwordx4 v[8:11],v24,s[20:23],s78 offen sc1
buffer_store_dwordx4 v[12:15],v25,s[20:23],s78 offen sc1
v_lshlrev_b32 v80,16,v8
v_and_b32 v81,s80,v8
v_lshlrev_b32 v82,16,v9
v_and_b32 v83,s80,v9
v_lshlrev_b32 v84,16,v10
v_and_b32 v85,s80,v10
v_lshlrev_b32 v86,16,v11
v_and_b32 v87,s80,v11
v_lshlrev_b32 v88,16,v12
v_and_b32 v89,s80,v12
v_lshlrev_b32 v90,16,v13
v_and_b32 v91,s80,v13
v_lshlrev_b32 v92,16,v14
v_and_b32 v93,s80,v14
v_lshlrev_b32 v94,16,v15
v_and_b32 v95,s80,v15
v_pk_add_f32 v[96:97],v[80:81],v[82:83]
v_pk_mul_f32 v[100:101],v[80:81],v[80:81]
v_pk_add_f32 v[98:99],v[88:89],v[90:91]
v_pk_mul_f32 v[102:103],v[88:89],v[88:89]
v_pk_fma_f32 v[100:101],v[82:83],v[82:83],v[100:101]
v_pk_fma_f32 v[102:103],v[90:91],v[90:91],v[102:103]
v_pk_add_f32 v[96:97],v[96:97],v[84:85]
v_pk_fma_f32 v[100:101],v[84:85],v[84:85],v[100:101]
v_pk_add_f32 v[98:99],v[98:99],v[92:93]
v_pk_fma_f32 v[102:103],v[92:93],v[92:93],v[102:103]
v_pk_add_f32 v[96:97],v[96:97],v[86:87]
v_pk_fma_f32 v[100:101],v[86:87],v[86:87],v[100:101]
v_pk_add_f32 v[98:99],v[98:99],v[94:95]
v_pk_fma_f32 v[102:103],v[94:95],v[94:95],v[102:103]
v_pk_add_f32 v[96:97],v[96:97],v[98:99]
v_pk_add_f32 v[100:101],v[100:101],v[102:103]
v_add_f32 v96,v96,v97
v_add_f32 v97,v100,v101
s_nop 0
v_add_f32_dpp v96,v96,v96 quad_perm:[1,0,3,2] row_mask:0xf bank_mask:0xf
v_add_f32_dpp v97,v97,v97 quad_perm:[1,0,3,2] row_mask:0xf bank_mask:0xf
s_nop 0
v_add_f32_dpp v96,v96,v96 quad_perm:[2,3,0,1] row_mask:0xf bank_mask:0xf
v_add_f32_dpp v97,v97,v97 quad_perm:[2,3,0,1] row_mask:0xf bank_mask:0xf
s_nop 0
v_add_f32_dpp v96,v96,v96 row_half_mirror row_mask:0xf bank_mask:0xf
v_add_f32_dpp v97,v97,v97 row_half_mirror row_mask:0xf bank_mask:0xf
s_nop 0
v_add_f32_dpp v96,v96,v96 row_mirror row_mask:0xf bank_mask:0xf
v_add_f32_dpp v97,v97,v97 row_mirror row_mask:0xf bank_mask:0xf
v_mov_b32 v98,v96
v_mov_b32 v99,v97
s_nop 0
v_permlane16_swap_b32 v98,v96
v_permlane16_swap_b32 v99,v97
v_pk_add_f32 v[96:97],v[96:97],v[98:99]
v_mov_b32 v98,v96
v_mov_b32 v99,v97
s_nop 0
v_permlane32_swap_b32 v98,v96
v_permlane32_swap_b32 v99,v97
v_pk_add_f32 v[96:97],v[96:97],v[98:99]
v_mul_f32 v96,0xba800000,v96
v_mul_f32 v98,v96,v96
v_fma_f32 v98,v97,s82,-v98
v_max_f32 v98,0,v98
v_add_f32 v98,0x3727c5ac,v98
v_rsq_f32 v98,v98
s_nop 0
v_mul_f32 v96,v96,v98
v_pk_fma_f32 v[80:81],v[80:81],v[98:99],v[96:97] op_sel_hi:[1,0,0]
v_pk_fma_f32 v[82:83],v[82:83],v[98:99],v[96:97] op_sel_hi:[1,0,0]
v_pk_fma_f32 v[84:85],v[84:85],v[98:99],v[96:97] op_sel_hi:[1,0,0]
v_pk_fma_f32 v[86:87],v[86:87],v[98:99],v[96:97] op_sel_hi:[1,0,0]
v_pk_fma_f32 v[88:89],v[88:89],v[98:99],v[96:97] op_sel_hi:[1,0,0]
v_pk_fma_f32 v[90:91],v[90:91],v[98:99],v[96:97] op_sel_hi:[1,0,0]
v_pk_fma_f32 v[92:93],v[92:93],v[98:99],v[96:97] op_sel_hi:[1,0,0]
v_pk_fma_f32 v[94:95],v[94:95],v[98:99],v[96:97] op_sel_hi:[1,0,0]
v_cvt_pk_bf16_f32 v72,v80,v81
v_cvt_pk_bf16_f32 v73,v82,v83
v_cvt_pk_bf16_f32 v74,v84,v85
v_cvt_pk_bf16_f32 v75,v86,v87
v_cvt_pk_bf16_f32 v76,v88,v89
v_cvt_pk_bf16_f32 v77,v90,v91
v_cvt_pk_bf16_f32 v78,v92,v93
v_cvt_pk_bf16_f32 v79,v94,v95
v_max_u32 v72,1,v72
v_max_u32 v76,1,v76
buffer_store_dwordx4 v[72:75],v19,s[20:23],s70 offen sc1
buffer_store_dwordx4 v[76:79],v19,s[20:23],s70 offen offset:1024 sc1
s_cmp_gt_u32 s71,44
s_cbranch_scc1 fnow_284
s_cmp_eq_u32 s83,0
s_cbranch_scc1 flater_285
s_waitcnt vmcnt(0)
fnow_284:
v_mov_b32 v22,s71
buffer_store_dword v22,v23,s[24:27],s73 offen
buffer_store_dword v22,v23,s[28:31],s73 offen sc1
flater_285:
v_mov_b32 v6,s71
ds_write_b32 v7,v6
s_mov_b32 s70,s75
s_add_u32 s79,s79,1
s_add_u32 s71,s71,1
s_cmp_lt_u32 s79,64
s_cbranch_scc1 lloop_277
s_endpgm
r_wo_214:
s_load_dwordx2 s[4:5],s[0:1],40
s_load_dwordx2 s[6:7],s[0:1],0
s_lshr_b32 s41,s59,3
s_and_b32 s42,s59,7
s_mul_i32 s66,s41,2097152
s_lshl_b32 s64,s42,8
s_add_u32 s66,s66,s64
s_lshl_b32 s67,s50,1
s_and_b32 s64,s41,1
s_add_u32 s67,s67,s64
s_waitcnt lgkmcnt(0)
s_mov_b32 s32,s4
s_and_b32 s33,s5,0xffff
s_mov_b32 s34,0x800000
s_mov_b32 s35,0x20000
s_mov_b32 s36,s6
s_and_b32 s37,s7,0xffff
s_mov_b32 s38,0x400000
s_mov_b32 s39,0x20000
v_lshrrev_b32 v5,2,v3
v_lshl_add_u32 v5,v4,2,v5
v_and_b32 v6,3,v3
v_lshlrev_b32 v6,3,v6
v_lshl_add_u32 v6,v5,8,v6
v_and_b32 v5,7,v5
v_xor_b32 v5,s67,v5
v_lshl_add_u32 v12,v5,5,v6
v_xor_b32 v13,32,v12
v_and_b32 v5,15,v1
v_and_b32 v6,3,v4
v_lshlrev_b32 v6,1,v6
v_xor_b32 v5,v5,v6
v_mul_u32_u24 v6,2048,v4
v_xor_b32 v7,0,v5
v_lshl_add_u32 v8,v7,4,v6
v_xor_b32 v7,8,v5
v_lshl_add_u32 v9,v7,4,v6
s_mul_i32 s74,s50,131072
s_add_u32 s74,s74,s66
s_lshl_b32 s75,s50,14
s_mul_i32 s76,s50,65536
s_add_u32 s76,s76,s66
s_lshl_b32 s77,s50,13
s_add_u32 s64,s74,0
s_add_u32 m0,s75,0
s_nop 0
buffer_load_dwordx4 v8,s[32:35],s64 offen nt lds
s_add_u32 s64,s74,8192
s_add_u32 m0,s75,1024
s_nop 0
buffer_load_dwordx4 v9,s[32:35],s64 offen nt lds
s_add_u32 s64,s74,16384
s_add_u32 m0,s75,2048
s_nop 0
buffer_load_dwordx4 v8,s[32:35],s64 offen nt lds
s_add_u32 s64,s74,24576
s_add_u32 m0,s75,3072
s_nop 0
buffer_load_dwordx4 v9,s[32:35],s64 offen nt lds
s_add_u32 s64,s74,32768
s_add_u32 m0,s75,4096
s_nop 0
buffer_load_dwordx4 v8,s[32:35],s64 offen nt lds
s_add_u32 s64,s74,40960
s_add_u32 m0,s75,5120
s_nop 0
buffer_load_dwordx4 v9,s[32:35],s64 offen nt lds
s_add_u32 s64,s74,49152
s_add_u32 m0,s75,6144
s_nop 0
buffer_load_dwordx4 v8,s[32:35],s64 offen nt lds
s_add_u32 s64,s74,57344
s_add_u32 m0,s75,7168
s_nop 0
buffer_load_dwordx4 v9,s[32:35],s64 offen nt lds
s_add_u32 s64,s74,65536
s_add_u32 m0,s75,8192
s_nop 0
buffer_load_dwordx4 v8,s[32:35],s64 offen nt lds
s_add_u32 s64,s74,73728
s_add_u32 m0,s75,9216
s_nop 0
buffer_load_dwordx4 v9,s[32:35],s64 offen nt lds
s_add_u32 s64,s74,81920
s_add_u32 m0,s75,10240
s_nop 0
buffer_load_dwordx4 v8,s[32:35],s64 offen nt lds
s_add_u32 s64,s74,90112
s_add_u32 m0,s75,11264
s_nop 0
buffer_load_dwordx4 v9,s[32:35],s64 offen nt lds
s_add_u32 s64,s74,98304
s_add_u32 m0,s75,12288
s_nop 0
buffer_load_dwordx4 v8,s[32:35],s64 offen nt lds
s_add_u32 s64,s74,106496
s_add_u32 m0,s75,13312
s_nop 0
buffer_load_dwordx4 v9,s[32:35],s64 offen nt lds
s_add_u32 s64,s74,114688
s_add_u32 m0,s75,14336
s_nop 0
buffer_load_dwordx4 v8,s[32:35],s64 offen nt lds
s_add_u32 s64,s74,122880
s_add_u32 m0,s75,15360
s_nop 0
buffer_load_dwordx4 v9,s[32:35],s64 offen nt lds
s_add_u32 s64,s74,524288
s_add_u32 m0,s75,65536
s_nop 0
buffer_load_dwordx4 v8,s[32:35],s64 offen nt lds
s_add_u32 s64,s74,532480
s_add_u32 m0,s75,66560
s_nop 0
buffer_load_dwordx4 v9,s[32:35],s64 offen nt lds
s_add_u32 s64,s74,540672
s_add_u32 m0,s75,67584
s_nop 0
buffer_load_dwordx4 v8,s[32:35],s64 offen nt lds
s_add_u32 s64,s74,548864
s_add_u32 m0,s75,68608
s_nop 0
buffer_load_dwordx4 v9,s[32:35],s64 offen nt lds
s_add_u32 s64,s74,557056
s_add_u32 m0,s75,69632
s_nop 0
buffer_load_dwordx4 v8,s[32:35],s64 offen nt lds
s_add_u32 s64,s74,565248
s_add_u32 m0,s75,70656
s_nop 0
buffer_load_dwordx4 v9,s[32:35],s64 offen nt lds
s_add_u32 s64,s74,573440
s_add_u32 m0,s75,71680
s_nop 0
buffer_load_dwordx4 v8,s[32:35],s64 offen nt lds
s_add_u32 s64,s74,581632
s_add_u32 m0,s75,72704
s_nop 0
buffer_load_dwordx4 v9,s[32:35],s64 offen nt lds
s_add_u32 s64,s74,589824
s_add_u32 m0,s75,73728
s_nop 0
buffer_load_dwordx4 v8,s[32:35],s64 offen nt lds
s_add_u32 s64,s74,598016
s_add_u32 m0,s75,74752
s_nop 0
buffer_load_dwordx4 v9,s[32:35],s64 offen nt lds
s_add_u32 s64,s74,606208
s_add_u32 m0,s75,75776
s_nop 0
buffer_load_dwordx4 v8,s[32:35],s64 offen nt lds
s_add_u32 s64,s74,614400
s_add_u32 m0,s75,76800
s_nop 0
buffer_load_dwordx4 v9,s[32:35],s64 offen nt lds
s_add_u32 s64,s74,622592
s_add_u32 m0,s75,77824
s_nop 0
buffer_load_dwordx4 v8,s[32:35],s64 offen nt lds
s_add_u32 s64,s74,630784
s_add_u32 m0,s75,78848
s_nop 0
buffer_load_dwordx4 v9,s[32:35],s64 offen nt lds
s_add_u32 s64,s74,638976
s_add_u32 m0,s75,79872
s_nop 0
buffer_load_dwordx4 v8,s[32:35],s64 offen nt lds
s_add_u32 s64,s74,647168
s_add_u32 m0,s75,80896
s_nop 0
buffer_load_dwordx4 v9,s[32:35],s64 offen nt lds
s_waitcnt vmcnt(16)
s_barrier
ds_read_b64_tr_b16 a[0:1],v12 offset:0
ds_read_b64_tr_b16 a[128:129],v13 offset:0
ds_read_b64_tr_b16 a[2:3],v12 offset:4096
ds_read_b64_tr_b16 a[130:131],v13 offset:4096
ds_read_b64_tr_b16 a[4:5],v12 offset:8192
ds_read_b64_tr_b16 a[132:133],v13 offset:8192
ds_read_b64_tr_b16 a[6:7],v12 offset:12288
ds_read_b64_tr_b16 a[134:135],v13 offset:12288
s_waitcnt lgkmcnt(4)
ds_read_b64_tr_b16 a[8:9],v12 offset:16384
ds_read_b64_tr_b16 a[136:137],v13 offset:16384
ds_read_b64_tr_b16 a[10:11],v12 offset:20480
ds_read_b64_tr_b16 a[138:139],v13 offset:20480
ds_read_b64_tr_b16 a[12:13],v12 offset:24576
ds_read_b64_tr_b16 a[140:141],v13 offset:24576
ds_read_b64_tr_b16 a[14:15],v12 offset:28672
ds_read_b64_tr_b16 a[142:143],v13 offset:28672
s_waitcnt lgkmcnt(4)
ds_read_b64_tr_b16 a[16:17],v12 offset:32768
ds_read_b64_tr_b16 a[144:145],v13 offset:32768
ds_read_b64_tr_b16 a[18:19],v12 offset:36864
ds_read_b64_tr_b16 a[146:147],v13 offset:36864
ds_read_b64_tr_b16 a[20:21],v12 offset:40960
ds_read_b64_tr_b16 a[148:149],v13 offset:40960
ds_read_b64_tr_b16 a[22:23],v12 offset:45056
ds_read_b64_tr_b16 a[150:151],v13 offset:45056
s_waitcnt lgkmcnt(4)
ds_read_b64_tr_b16 a[24:25],v12 offset:49152
ds_read_b64_tr_b16 a[152:153],v13 offset:49152
ds_read_b64_tr_b16 a[26:27],v12 offset:53248
ds_read_b64_tr_b16 a[154:155],v13 offset:53248
ds_read_b64_tr_b16 a[28:29],v12 offset:57344
ds_read_b64_tr_b16 a[156:157],v13 offset:57344
ds_read_b64_tr_b16 a[30:31],v12 offset:61440
ds_read_b64_tr_b16 a[158:159],v13 offset:61440
s_waitcnt lgkmcnt(4)
v_xor_b32 v12,0x10000,v12
v_xor_b32 v13,0x10000,v13
s_waitcnt lgkmcnt(0)
s_barrier
s_add_u32 s64,s74,1048576
s_add_u32 m0,s75,0
s_nop 0
buffer_load_dwordx4 v8,s[32:35],s64 offen nt lds
s_add_u32 s64,s74,1056768
s_add_u32 m0,s75,1024
s_nop 0
buffer_load_dwordx4 v9,s[32:35],s64 offen nt lds
s_add_u32 s64,s74,1064960
s_add_u32 m0,s75,2048
s_nop 0
buffer_load_dwordx4 v8,s[32:35],s64 offen nt lds
s_add_u32 s64,s74,1073152
s_add_u32 m0,s75,3072
s_nop 0
buffer_load_dwordx4 v9,s[32:35],s64 offen nt lds
s_add_u32 s64,s74,1081344
s_add_u32 m0,s75,4096
s_nop 0
buffer_load_dwordx4 v8,s[32:35],s64 offen nt lds
s_add_u32 s64,s74,1089536
s_add_u32 m0,s75,5120
s_nop 0
buffer_load_dwordx4 v9,s[32:35],s64 offen nt lds
s_add_u32 s64,s74,1097728
s_add_u32 m0,s75,6144
s_nop 0
buffer_load_dwordx4 v8,s[32:35],s64 offen nt lds
s_add_u32 s64,s74,1105920
s_add_u32 m0,s75,7168
s_nop 0
buffer_load_dwordx4 v9,s[32:35],s64 offen nt lds
s_add_u32 s64,s74,1114112
s_add_u32 m0,s75,8192
s_nop 0
buffer_load_dwordx4 v8,s[32:35],s64 offen nt lds
s_add_u32 s64,s74,1122304
s_add_u32 m0,s75,9216
s_nop 0
buffer_load_dwordx4 v9,s[32:35],s64 offen nt lds
s_add_u32 s64,s74,1130496
s_add_u32 m0,s75,10240
s_nop 0
buffer_load_dwordx4 v8,s[32:35],s64 offen nt lds
s_add_u32 s64,s74,1138688
s_add_u32 m0,s75,11264
s_nop 0
buffer_load_dwordx4 v9,s[32:35],s64 offen nt lds
s_add_u32 s64,s74,1146880
s_add_u32 m0,s75,12288
s_nop 0
buffer_load_dwordx4 v8,s[32:35],s64 offen nt lds
s_add_u32 s64,s74,1155072
s_add_u32 m0,s75,13312
s_nop 0
buffer_load_dwordx4 v9,s[32:35],s64 offen nt lds
s_add_u32 s64,s74,1163264
s_add_u32 m0,s75,14336
s_nop 0
buffer_load_dwordx4 v8,s[32:35],s64 offen nt lds
s_add_u32 s64,s74,1171456
s_add_u32 m0,s75,15360
s_nop 0
buffer_load_dwordx4 v9,s[32:35],s64 offen nt lds
s_waitcnt vmcnt(16)
s_barrier
ds_read_b64_tr_b16 a[32:33],v12 offset:0
ds_read_b64_tr_b16 a[160:161],v13 offset:0
ds_read_b64_tr_b16 a[34:35],v12 offset:4096
ds_read_b64_tr_b16 a[162:163],v13 offset:4096
ds_read_b64_tr_b16 a[36:37],v12 offset:8192
ds_read_b64_tr_b16 a[164:165],v13 offset:8192
ds_read_b64_tr_b16 a[38:39],v12 offset:12288
ds_read_b64_tr_b16 a[166:167],v13 offset:12288
s_waitcnt lgkmcnt(4)
ds_read_b64_tr_b16 a[40:41],v12 offset:16384
ds_read_b64_tr_b16 a[168:169],v13 offset:16384
ds_read_b64_tr_b16 a[42:43],v12 offset:20480
ds_read_b64_tr_b16 a[170:171],v13 offset:20480
ds_read_b64_tr_b16 a[44:45],v12 offset:24576
ds_read_b64_tr_b16 a[172:173],v13 offset:24576
ds_read_b64_tr_b16 a[46:47],v12 offset:28672
ds_read_b64_tr_b16 a[174:175],v13 offset:28672
s_waitcnt lgkmcnt(4)
ds_read_b64_tr_b16 a[48:49],v12 offset:32768
ds_read_b64_tr_b16 a[176:177],v13 offset:32768
ds_read_b64_tr_b16 a[50:51],v12 offset:36864
ds_read_b64_tr_b16 a[178:179],v13 offset:36864
ds_read_b64_tr_b16 a[52:53],v12 offset:40960
ds_read_b64_tr_b16 a[180:181],v13 offset:40960
ds_read_b64_tr_b16 a[54:55],v12 offset:45056
ds_read_b64_tr_b16 a[182:183],v13 offset:45056
s_waitcnt lgkmcnt(4)
ds_read_b64_tr_b16 a[56:57],v12 offset:49152
ds_read_b64_tr_b16 a[184:185],v13 offset:49152
ds_read_b64_tr_b16 a[58:59],v12 offset:53248
ds_read_b64_tr_b16 a[186:187],v13 offset:53248
ds_read_b64_tr_b16 a[60:61],v12 offset:57344
ds_read_b64_tr_b16 a[188:189],v13 offset:57344
ds_read_b64_tr_b16 a[62:63],v12 offset:61440
ds_read_b64_tr_b16 a[190:191],v13 offset:61440
s_waitcnt lgkmcnt(4)
v_xor_b32 v12,0x10000,v12
v_xor_b32 v13,0x10000,v13
s_waitcnt lgkmcnt(0)
s_barrier
s_add_u32 s64,s74,1572864
s_add_u32 m0,s75,65536
s_nop 0
buffer_load_dwordx4 v8,s[32:35],s64 offen nt lds
s_add_u32 s64,s74,1581056
s_add_u32 m0,s75,66560
s_nop 0
buffer_load_dwordx4 v9,s[32:35],s64 offen nt lds
s_add_u32 s64,s74,1589248
s_add_u32 m0,s75,67584
s_nop 0
buffer_load_dwordx4 v8,s[32:35],s64 offen nt lds
s_add_u32 s64,s74,1597440
s_add_u32 m0,s75,68608
s_nop 0
buffer_load_dwordx4 v9,s[32:35],s64 offen nt lds
s_add_u32 s64,s74,1605632
s_add_u32 m0,s75,69632
s_nop 0
buffer_load_dwordx4 v8,s[32:35],s64 offen nt lds
s_add_u32 s64,s74,1613824
s_add_u32 m0,s75,70656
s_nop 0
buffer_load_dwordx4 v9,s[32:35],s64 offen nt lds
s_add_u32 s64,s74,1622016
s_add_u32 m0,s75,71680
s_nop 0
buffer_load_dwordx4 v8,s[32:35],s64 offen nt lds
s_add_u32 s64,s74,1630208
s_add_u32 m0,s75,72704
s_nop 0
buffer_load_dwordx4 v9,s[32:35],s64 offen nt lds
s_add_u32 s64,s74,1638400
s_add_u32 m0,s75,73728
s_nop 0
buffer_load_dwordx4 v8,s[32:35],s64 offen nt lds
s_add_u32 s64,s74,1646592
s_add_u32 m0,s75,74752
s_nop 0
buffer_load_dwordx4 v9,s[32:35],s64 offen nt lds
s_add_u32 s64,s74,1654784
s_add_u32 m0,s75,75776
s_nop 0
buffer_load_dwordx4 v8,s[32:35],s64 offen nt lds
s_add_u32 s64,s74,1662976
s_add_u32 m0,s75,76800
s_nop 0
buffer_load_dwordx4 v9,s[32:35],s64 offen nt lds
s_add_u32 s64,s74,1671168
s_add_u32 m0,s75,77824
s_nop 0
buffer_load_dwordx4 v8,s[32:35],s64 offen nt lds
s_add_u32 s64,s74,1679360
s_add_u32 m0,s75,78848
s_nop 0
buffer_load_dwordx4 v9,s[32:35],s64 offen nt lds
s_add_u32 s64,s74,1687552
s_add_u32 m0,s75,79872
s_nop 0
buffer_load_dwordx4 v8,s[32:35],s64 offen nt lds
s_add_u32 s64,s74,1695744
s_add_u32 m0,s75,80896
s_nop 0
buffer_load_dwordx4 v9,s[32:35],s64 offen nt lds
s_waitcnt vmcnt(16)
s_barrier
ds_read_b64_tr_b16 a[64:65],v12 offset:0
ds_read_b64_tr_b16 a[192:193],v13 offset:0
ds_read_b64_tr_b16 a[66:67],v12 offset:4096
ds_read_b64_tr_b16 a[194:195],v13 offset:4096
ds_read_b64_tr_b16 a[68:69],v12 offset:8192
ds_read_b64_tr_b16 a[196:197],v13 offset:8192
ds_read_b64_tr_b16 a[70:71],v12 offset:12288
ds_read_b64_tr_b16 a[198:199],v13 offset:12288
s_waitcnt lgkmcnt(4)
ds_read_b64_tr_b16 a[72:73],v12 offset:16384
ds_read_b64_tr_b16 a[200:201],v13 offset:16384
ds_read_b64_tr_b16 a[74:75],v12 offset:20480
ds_read_b64_tr_b16 a[202:203],v13 offset:20480
ds_read_b64_tr_b16 a[76:77],v12 offset:24576
ds_read_b64_tr_b16 a[204:205],v13 offset:24576
ds_read_b64_tr_b16 a[78:79],v12 offset:28672
ds_read_b64_tr_b16 a[206:207],v13 offset:28672
s_waitcnt lgkmcnt(4)
ds_read_b64_tr_b16 a[80:81],v12 offset:32768
ds_read_b64_tr_b16 a[208:209],v13 offset:32768
ds_read_b64_tr_b16 a[82:83],v12 offset:36864
ds_read_b64_tr_b16 a[210:211],v13 offset:36864
ds_read_b64_tr_b16 a[84:85],v12 offset:40960
ds_read_b64_tr_b16 a[212:213],v13 offset:40960
ds_read_b64_tr_b16 a[86:87],v12 offset:45056
ds_read_b64_tr_b16 a[214:215],v13 offset:45056
s_waitcnt lgkmcnt(4)
ds_read_b64_tr_b16 a[88:89],v12 offset:49152
ds_read_b64_tr_b16 a[216:217],v13 offset:49152
ds_read_b64_tr_b16 a[90:91],v12 offset:53248
ds_read_b64_tr_b16 a[218:219],v13 offset:53248
ds_read_b64_tr_b16 a[92:93],v12 offset:57344
ds_read_b64_tr_b16 a[220:221],v13 offset:57344
ds_read_b64_tr_b16 a[94:95],v12 offset:61440
ds_read_b64_tr_b16 a[222:223],v13 offset:61440
s_waitcnt lgkmcnt(4)
v_xor_b32 v12,0x10000,v12
v_xor_b32 v13,0x10000,v13
s_waitcnt lgkmcnt(0)
s_barrier
s_waitcnt vmcnt(0)
s_barrier
ds_read_b64_tr_b16 a[96:97],v12 offset:0
ds_read_b64_tr_b16 a[224:225],v13 offset:0
ds_read_b64_tr_b16 a[98:99],v12 offset:4096
ds_read_b64_tr_b16 a[226:227],v13 offset:4096
ds_read_b64_tr_b16 a[100:101],v12 offset:8192
ds_read_b64_tr_b16 a[228:229],v13 offset:8192
ds_read_b64_tr_b16 a[102:103],v12 offset:12288
ds_read_b64_tr_b16 a[230:231],v13 offset:12288
s_waitcnt lgkmcnt(4)
ds_read_b64_tr_b16 a[104:105],v12 offset:16384
ds_read_b64_tr_b16 a[232:233],v13 offset:16384
ds_read_b64_tr_b16 a[106:107],v12 offset:20480
ds_read_b64_tr_b16 a[234:235],v13 offset:20480
ds_read_b64_tr_b16 a[108:109],v12 offset:24576
ds_read_b64_tr_b16 a[236:237],v13 offset:24576
ds_read_b64_tr_b16 a[110:111],v12 offset:28672
ds_read_b64_tr_b16 a[238:239],v13 offset:28672
s_waitcnt lgkmcnt(4)
ds_read_b64_tr_b16 a[112:113],v12 offset:32768
ds_read_b64_tr_b16 a[240:241],v13 offset:32768
ds_read_b64_tr_b16 a[114:115],v12 offset:36864
ds_read_b64_tr_b16 a[242:243],v13 offset:36864
ds_read_b64_tr_b16 a[116:117],v12 offset:40960
ds_read_b64_tr_b16 a[244:245],v13 offset:40960
ds_read_b64_tr_b16 a[118:119],v12 offset:45056
ds_read_b64_tr_b16 a[246:247],v13 offset:45056
s_waitcnt lgkmcnt(4)
ds_read_b64_tr_b16 a[120:121],v12 offset:49152
ds_read_b64_tr_b16 a[248:249],v13 offset:49152
ds_read_b64_tr_b16 a[122:123],v12 offset:53248
ds_read_b64_tr_b16 a[250:251],v13 offset:53248
ds_read_b64_tr_b16 a[124:125],v12 offset:57344
ds_read_b64_tr_b16 a[252:253],v13 offset:57344
ds_read_b64_tr_b16 a[126:127],v12 offset:61440
ds_read_b64_tr_b16 a[254:255],v13 offset:61440
s_waitcnt lgkmcnt(4)
v_xor_b32 v12,0x10000,v12
v_xor_b32 v13,0x10000,v13
s_waitcnt lgkmcnt(0)
s_barrier
v_and_b32 v21,1,v1
v_mul_u32_u24 v21,960,v21
s_mov_b32 s65,21052032
s_mov_b32 s66,1792
pl_286:
buffer_load_dword v22,v21,s[20:23],s65 offen sc1
s_waitcnt vmcnt(0)
v_cmp_gt_u32 vcc,s66,v22
s_cbranch_vccz pok_287
s_sleep 1
s_sub_u32 s90,s90,1
s_cmp_gt_i32 s90,0
s_cbranch_scc1 pl_286
pok_287:
s_lshr_b32 s43,s41,1
s_and_b32 s48,s41,1
s_lshl_b32 s64,s42,7
s_lshl_b32 s65,s50,5
s_add_u32 s64,s64,s65
s_lshl_b32 s65,s48,4
s_add_u32 s64,s64,s65
v_lshl_add_u32 v5,v4,2,s64
v_lshlrev_b32 v6,2,v5
s_mov_b32 s64,8192
buffer_load_dwordx4 v[52:55],v6,s[20:23],s64 offen sc1
v_lshlrev_b32 v10,1,v5
v_and_b32 v6,3,v1
v_sub_u32 v5,v6,v4
v_lshl_add_u32 v5,v5,3,v10
v_lshrrev_b32 v11,2,v1
v_lshl_add_u32 v40,v6,4,v11
v_lshlrev_b32 v40,2,v40
v_lshl_add_u32 v41,v3,2,v4
v_lshlrev_b32 v41,2,v41
s_lshl_b32 s64,s43,10
v_add_u32 v17,s64,v16
v_xor_b32 v18,1024,v17
s_xor_b32 s64,s64,1024
s_lshr_b32 s65,s50,1
s_and_b32 s66,s50,1
s_lshl_b32 s66,s66,12
s_add_u32 s66,s66,s64
s_lshl_b32 s72,s65,13
s_add_u32 s72,s72,s66
s_add_u32 s72,s72,0x10000
s_lshl_b32 s65,s65,14
s_add_u32 s75,s65,s66
s_add_u32 s75,s75,524288
s_mul_i32 s64,s41,131072
s_add_u32 s75,s75,s64
s_cmp_lt_u32 s50,2
s_cselect_b32 s86,98304,0x40000000
s_lshl_b32 s76,s79,21
s_add_u32 s76,s76,27262976
s_mov_b32 s77,0
s_lshl_b32 s78,s79,16
s_mov_b32 s49,0
s_cmp_eq_u32 s79,0
s_mov_b32 s66,8577024
s_cselect_b32 s66,17825792,s66
s_lshl_b32 s64,s59,14
s_lshl_b32 s65,s50,12
s_add_u32 s65,s65,s66
s_add_u32 s64,s64,s65
v_add_u32 v26,s64,v16
s_lshl_b32 s64,s42,14
s_add_u32 s64,s64,s65
v_add_u32 v25,s64,v16
s_xor_b32 s33,s41,1
s_xor_b32 s34,s41,2
s_xor_b32 s35,s41,3
s_lshl_b32 s33,s33,17
s_lshl_b32 s34,s34,17
s_lshl_b32 s35,s35,17
v_and_b32 v21,7,v1
v_lshlrev_b32 v21,7,v21
v_bfe_u32 v6,v1,3,0
v_lshl_add_u32 v21,v6,2,v21
s_lshl_b32 s74,s41,10
s_add_u32 s74,s74,s63
s_lshl_b32 s64,s60,4
s_add_u32 s74,s74,s64
s_add_u32 s74,s74,16384
v_lshrrev_b32 v6,2,v11
v_and_b32 v7,3,v11
v_lshl_add_u32 v6,v6,1,s43
v_lshl_add_u32 v8,v6,2,v7
v_lshl_add_u32 v8,v8,7,v5
v_and_b32 v8,2047,v8
v_lshl_add_u32 v8,v7,11,v8
v_lshl_add_u32 v7,v7,11,v5
v_lshl_add_u32 v20,v6,13,v7
v_lshl_add_u32 v19,v6,14,v8
v_add_u32 v19,1048576,v19
s_lshl_b32 s73,s59,2
s_add_u32 s73,s73,s50
s_lshl_b32 s73,s73,2
s_add_u32 s73,s73,s63
s_add_u32 s73,s73,2048
s_mov_b32 s48,1
s_waitcnt vmcnt(0)
s_cmp_lg_u32 s56,0
s_cbranch_scc1 kslow_288
s_add_u32 s64,s79,0
s_lshl_b32 s70,s64,21
s_lshl_b32 s64,s64,13
s_and_b32 s64,s64,0x2000
s_xor_b32 s64,s64,s62
s_add_u32 s70,s70,s64
s_add_u32 s70,s70,29360128
s_mov_b32 s83,1
s_mov_b32 s87,s74
s_cmp_eq_u32 s50,0
s_cselect_b32 s74,s74,0x7fff0000
v_mov_b32 v47,132096
s_lshl_b32 s64,s50,3
s_add_u32 s64,s64,132096
v_mov_b32 v46,s64
v_mov_b32 v29,0
s_mov_b32 s97,0x7fff0000
s_mov_b32 s69,1
s_mov_b32 s68,0
s_mov_b32 s52,0x30003
s_mov_b32 s53,s52
seg_290:
s_cmp_eq_u32 s83,0
s_cbranch_scc1 ahead_291
s_add_u32 s94,s70,s75
s_xor_b32 s95,s94,1024
s_xor_b32 s91,s72,0x10000
s_waitcnt vmcnt(2)
v_cmp_gt_u32 vcc,s71,v29
s_cbranch_vccz nb_294
s_waitcnt vmcnt(0)
v_add_u32 v22,s71,-1
buffer_store_dword v22,v23,s[20:23],s97 offen sc1
s_mov_b32 s97,0x7fff0000
s_cmp_lg_u32 s50,0
s_cbranch_scc1 nb_294
buffer_load_dword v32,v21,s[20:23],s74 offen sc1
s_sleep 2
pl_296:
buffer_load_dword v33,v21,s[20:23],s74 offen sc1
s_waitcnt vmcnt(1)
v_cmp_gt_u32 vcc,s71,v32
v_mov_b32 v29,v32
s_cbranch_vccz pok_297
buffer_load_dword v32,v21,s[20:23],s74 offen sc1
s_waitcnt vmcnt(1)
v_cmp_gt_u32 vcc,s71,v33
v_mov_b32 v29,v33
s_cbranch_vccz pok_297
s_sub_u32 s90,s90,1
s_cmp_gt_i32 s90,0
s_cbranch_scc1 pl_296
pok_297:
nb_294:
s_barrier
s_xor_b32 m0,s91,0
s_add_u32 s65,s94,0
buffer_load_dwordx4 v16,s[20:23],s65 offen offset:0 sc1 lds
buffer_load_dwordx4 v16,s[20:23],s65 offen offset:2048 sc1 lds
s_xor_b32 m0,s91,16384
s_add_u32 s65,s94,32768
buffer_load_dwordx4 v16,s[20:23],s65 offen offset:0 sc1 lds
buffer_load_dwordx4 v16,s[20:23],s65 offen offset:2048 sc1 lds
s_xor_b32 m0,s91,32768
s_add_u32 s65,s94,65536
buffer_load_dwordx4 v16,s[20:23],s65 offen offset:0 sc1 lds
buffer_load_dwordx4 v16,s[20:23],s65 offen offset:2048 sc1 lds
s_xor_b32 m0,s91,49152
s_add_u32 s65,s94,98304
buffer_load_dwordx4 v16,s[20:23],s65 offen offset:0 sc1 lds
buffer_load_dwordx4 v16,s[20:23],s65 offen offset:2048 sc1 lds
s_waitcnt vmcnt(8)
v_add_u32 v22,s71,-1
buffer_store_dword v22,v23,s[20:23],s97 offen sc1
s_mov_b32 s97,0x7fff0000
s_waitcnt vmcnt(7)
s_barrier
ds_read_b128 v[224:227],v18 offset:0
ds_read_b128 v[228:231],v18 offset:2048
ds_read_b128 v[232:235],v18 offset:4096
ds_read_b128 v[236:239],v18 offset:6144
ds_read_b128 v[240:243],v18 offset:8192
ds_read_b128 v[244:247],v18 offset:10240
ds_read_b128 v[248:251],v18 offset:12288
s_waitcnt lgkmcnt(5)
v_mfma_f32_16x16x32_bf16 v[64:67],a[0:3],v[224:227],0
s_xor_b32 m0,s91,1024
s_add_u32 s96,s71,1
v_mfma_f32_16x16x32_bf16 v[68:71],a[128:131],v[224:227],0
ds_read_b128 v[252:255],v18 offset:14336
s_add_u32 s92,s71,2
v_mfma_f32_16x16x32_bf16 v[64:67],a[4:7],v[228:231],v[64:67]
s_add_u32 s65,s95,0
v_min_u32 v27,v224,v228
v_mfma_f32_16x16x32_bf16 v[68:71],a[132:135],v[228:231],v[68:71]
s_waitcnt vmcnt(5)
s_barrier
ds_read_b128 v[224:227],v18 offset:16384
s_waitcnt lgkmcnt(5)
v_mfma_f32_16x16x32_bf16 v[64:67],a[8:11],v[232:235],v[64:67]
buffer_load_dwordx4 v16,s[20:23],s65 offen offset:0 sc1 lds
v_mfma_f32_16x16x32_bf16 v[68:71],a[136:139],v[232:235],v[68:71]
ds_read_b128 v[228:231],v18 offset:18432
v_min3_u32 v27,v27,v232,v236
v_mfma_f32_16x16x32_bf16 v[64:67],a[12:15],v[236:239],v[64:67]
buffer_load_dwordx4 v16,s[20:23],s65 offen offset:2048 sc1 lds
v_mfma_f32_16x16x32_bf16 v[68:71],a[140:143],v[236:239],v[68:71]
ds_read_b128 v[232:235],v18 offset:20480
s_waitcnt lgkmcnt(5)
v_mfma_f32_16x16x32_bf16 v[64:67],a[16:19],v[240:243],v[64:67]
s_xor_b32 m0,s91,17408
v_min3_u32 v27,v27,v240,v244
v_mfma_f32_16x16x32_bf16 v[68:71],a[144:147],v[240:243],v[68:71]
ds_read_b128 v[236:239],v18 offset:22528
v_mfma_f32_16x16x32_bf16 v[64:67],a[20:23],v[244:247],v[64:67]
s_add_u32 s65,s95,32768
v_mfma_f32_16x16x32_bf16 v[68:71],a[148:151],v[244:247],v[68:71]
ds_read_b128 v[240:243],v18 offset:24576
s_waitcnt lgkmcnt(5)
v_mfma_f32_16x16x32_bf16 v[64:67],a[24:27],v[248:251],v[64:67]
buffer_load_dwordx4 v16,s[20:23],s65 offen offset:0 sc1 lds
v_mfma_f32_16x16x32_bf16 v[68:71],a[152:155],v[248:251],v[68:71]
ds_read_b128 v[244:247],v18 offset:26624
v_min3_u32 v27,v27,v248,v252
v_mfma_f32_16x16x32_bf16 v[64:67],a[28:31],v[252:255],v[64:67]
buffer_load_dwordx4 v16,s[20:23],s65 offen offset:2048 sc1 lds
v_mfma_f32_16x16x32_bf16 v[68:71],a[156:159],v[252:255],v[68:71]
ds_read_b128 v[248:251],v18 offset:28672
s_waitcnt lgkmcnt(5)
v_mfma_f32_16x16x32_bf16 v[64:67],a[32:35],v[224:227],v[64:67]
s_xor_b32 m0,s91,33792
v_min3_u32 v27,v27,v224,v228
v_mfma_f32_16x16x32_bf16 v[68:71],a[160:163],v[224:227],v[68:71]
ds_read_b128 v[252:255],v18 offset:30720
v_mfma_f32_16x16x32_bf16 v[64:67],a[36:39],v[228:231],v[64:67]
s_add_u32 s65,s95,65536
s_waitcnt vmcnt(63)
v_mfma_f32_16x16x32_bf16 v[68:71],a[164:167],v[228:231],v[68:71]
s_waitcnt vmcnt(5)
s_barrier
ds_read_b128 v[224:227],v18 offset:32768
s_waitcnt lgkmcnt(5)
v_mfma_f32_16x16x32_bf16 v[64:67],a[40:43],v[232:235],v[64:67]
buffer_load_dwordx4 v16,s[20:23],s65 offen offset:0 sc1 lds
v_min3_u32 v27,v27,v232,v236
v_mfma_f32_16x16x32_bf16 v[68:71],a[168:171],v[232:235],v[68:71]
ds_read_b128 v[228:231],v18 offset:34816
v_cmp_gt_u32 vcc,s96,v29
v_cmp_gt_u32 s[92:93],s92,v29
v_mfma_f32_16x16x32_bf16 v[64:67],a[44:47],v[236:239],v[64:67]
buffer_load_dwordx4 v16,s[20:23],s65 offen offset:2048 sc1 lds
v_mfma_f32_16x16x32_bf16 v[68:71],a[172:175],v[236:239],v[68:71]
ds_read_b128 v[232:235],v18 offset:36864
s_waitcnt lgkmcnt(5)
v_mfma_f32_16x16x32_bf16 v[64:67],a[48:51],v[240:243],v[64:67]
s_xor_b32 m0,s91,50176
v_mov_b32 v44,vcc_lo
v_mov_b32 v45,s92
v_mfma_f32_16x16x32_bf16 v[68:71],a[176:179],v[240:243],v[68:71]
ds_read_b128 v[236:239],v18 offset:38912
ds_write_b64 v46,v[44:45]
v_mfma_f32_16x16x32_bf16 v[64:67],a[52:55],v[244:247],v[64:67]
s_add_u32 s65,s95,98304
v_min3_u32 v27,v27,v240,v244
v_mfma_f32_16x16x32_bf16 v[68:71],a[180:183],v[244:247],v[68:71]
ds_read_b128 v[240:243],v18 offset:40960
s_waitcnt lgkmcnt(6)
v_mfma_f32_16x16x32_bf16 v[64:67],a[56:59],v[248:251],v[64:67]
buffer_load_dwordx4 v16,s[20:23],s65 offen offset:0 sc1 lds
v_mfma_f32_16x16x32_bf16 v[68:71],a[184:187],v[248:251],v[68:71]
ds_read_b128 v[244:247],v18 offset:43008
v_min3_u32 v27,v27,v248,v252
v_mfma_f32_16x16x32_bf16 v[64:67],a[60:63],v[252:255],v[64:67]
buffer_load_dwordx4 v16,s[20:23],s65 offen offset:2048 sc1 lds
v_mfma_f32_16x16x32_bf16 v[68:71],a[188:191],v[252:255],v[68:71]
ds_read_b128 v[248:251],v18 offset:45056
s_waitcnt lgkmcnt(6)
v_mfma_f32_16x16x32_bf16 v[64:67],a[64:67],v[224:227],v[64:67]
v_min3_u32 v27,v27,v224,v228
s_add_u32 s88,s70,s75
v_mfma_f32_16x16x32_bf16 v[68:71],a[192:195],v[224:227],v[68:71]
ds_read_b128 v[252:255],v18 offset:47104
s_add_u32 s88,s88,2097152
v_mfma_f32_16x16x32_bf16 v[64:67],a[68:71],v[228:231],v[64:67]
buffer_load_dwordx2 v[120:121],v20,s[36:39],s78 offen
v_mfma_f32_16x16x32_bf16 v[68:71],a[196:199],v[228:231],v[68:71]
ds_read_b128 v[224:227],v18 offset:49152
s_waitcnt lgkmcnt(6)
v_mfma_f32_16x16x32_bf16 v[64:67],a[72:75],v[232:235],v[64:67]
v_min3_u32 v27,v27,v232,v236
s_xor_b32 s88,s88,0x2000
v_mfma_f32_16x16x32_bf16 v[68:71],a[200:203],v[232:235],v[68:71]
ds_read_b128 v[228:231],v18 offset:51200
s_xor_b32 s89,s88,1024
v_mfma_f32_16x16x32_bf16 v[64:67],a[76:79],v[236:239],v[64:67]
v_mfma_f32_16x16x32_bf16 v[68:71],a[204:207],v[236:239],v[68:71]
ds_read_b128 v[232:235],v18 offset:53248
s_waitcnt lgkmcnt(5)
v_mfma_f32_16x16x32_bf16 v[64:67],a[80:83],v[240:243],v[64:67]
s_waitcnt vmcnt(5)
s_barrier
ds_read_b64 v[44:45],v47
ds_read_b128 v[128:131],v17 offset:0
ds_read_b128 v[132:135],v17 offset:2048
v_mfma_f32_16x16x32_bf16 v[68:71],a[208:211],v[240:243],v[68:71]
ds_read_b128 v[236:239],v18 offset:55296
v_min3_u32 v27,v27,v240,v244
v_mfma_f32_16x16x32_bf16 v[64:67],a[84:87],v[244:247],v[64:67]
ds_read_b128 v[136:139],v17 offset:4096
v_mfma_f32_16x16x32_bf16 v[68:71],a[212:215],v[244:247],v[68:71]
ds_read_b128 v[240:243],v18 offset:57344
s_waitcnt lgkmcnt(9)
v_mfma_f32_16x16x32_bf16 v[64:67],a[88:91],v[248:251],v[64:67]
ds_read_b128 v[140:143],v17 offset:6144
v_min3_u32 v27,v27,v248,v252
v_mfma_f32_16x16x32_bf16 v[68:71],a[216:219],v[248:251],v[68:71]
ds_read_b128 v[244:247],v18 offset:59392
v_mfma_f32_16x16x32_bf16 v[64:67],a[92:95],v[252:255],v[64:67]
ds_read_b128 v[144:147],v17 offset:8192
ds_read_b128 v[148:151],v17 offset:10240
v_mfma_f32_16x16x32_bf16 v[68:71],a[220:223],v[252:255],v[68:71]
ds_read_b128 v[248:251],v18 offset:61440
s_waitcnt lgkmcnt(12)
v_mfma_f32_16x16x32_bf16 v[64:67],a[96:99],v[224:227],v[64:67]
ds_read_b128 v[152:155],v17 offset:12288
s_waitcnt lgkmcnt(11)
v_min3_u32 v27,v27,v224,v228
v_mfma_f32_16x16x32_bf16 v[68:71],a[224:227],v[224:227],v[68:71]
ds_read_b128 v[252:255],v18 offset:63488
v_readfirstlane_b32 s93,v45
v_mfma_f32_16x16x32_bf16 v[64:67],a[100:103],v[228:231],v[64:67]
ds_read_b128 v[156:159],v17 offset:14336
v_readfirstlane_b32 s83,v44
s_cmp_lg_u32 s83,0
s_cbranch_scc0 keep_300
v_mfma_f32_16x16x32_bf16 v[68:71],a[228:231],v[228:231],v[68:71]
s_waitcnt lgkmcnt(10)
v_mfma_f32_16x16x32_bf16 v[64:67],a[104:107],v[232:235],v[64:67]
ds_read_b128 v[160:163],v17 offset:16384
ds_read_b128 v[164:167],v17 offset:18432
v_mfma_f32_16x16x32_bf16 v[68:71],a[232:235],v[232:235],v[68:71]
v_min3_u32 v27,v27,v232,v236
v_mfma_f32_16x16x32_bf16 v[64:67],a[108:111],v[236:239],v[64:67]
ds_read_b128 v[168:171],v17 offset:20480
v_mfma_f32_16x16x32_bf16 v[68:71],a[236:239],v[236:239],v[68:71]
s_waitcnt lgkmcnt(9)
v_mfma_f32_16x16x32_bf16 v[64:67],a[112:115],v[240:243],v[64:67]
ds_read_b128 v[172:175],v17 offset:22528
v_min3_u32 v27,v27,v240,v244
v_mfma_f32_16x16x32_bf16 v[68:71],a[240:243],v[240:243],v[68:71]
v_mfma_f32_16x16x32_bf16 v[64:67],a[116:119],v[244:247],v[64:67]
ds_read_b128 v[176:179],v17 offset:24576
ds_read_b128 v[180:183],v17 offset:26624
v_mfma_f32_16x16x32_bf16 v[68:71],a[244:247],v[244:247],v[68:71]
s_waitcnt lgkmcnt(7)
v_mfma_f32_16x16x32_bf16 v[64:67],a[120:123],v[248:251],v[64:67]
ds_read_b128 v[184:187],v17 offset:28672
v_min3_u32 v27,v27,v248,v252
v_mfma_f32_16x16x32_bf16 v[68:71],a[248:251],v[248:251],v[68:71]
v_mfma_f32_16x16x32_bf16 v[64:67],a[124:127],v[252:255],v[64:67]
ds_read_b128 v[188:191],v17 offset:30720
v_mfma_f32_16x16x32_bf16 v[68:71],a[252:255],v[252:255],v[68:71]
v_mfma_f32_16x16x32_bf16 v[72:75],a[128:131],v[128:131],0
v_cmp_eq_u32 vcc,0,v27
s_cbranch_vccnz retry_289
v_mfma_f32_16x16x32_bf16 v[76:79],a[132:135],v[132:135],0
v_min3_u32 v27,v27,v128,v132
v_mfma_f32_16x16x32_bf16 v[72:75],a[136:139],v[136:139],v[72:75]
s_waitcnt vmcnt(1)
s_barrier
ds_read_b128 v[192:195],v17 offset:32768
v_mfma_f32_16x16x32_bf16 v[76:79],a[140:143],v[140:143],v[76:79]
ds_read_b128 v[196:199],v17 offset:34816
s_waitcnt lgkmcnt(10)
v_mfma_f32_16x16x32_bf16 v[72:75],a[144:147],v[144:147],v[72:75]
ds_read_b128 v[200:203],v17 offset:36864
v_min3_u32 v27,v27,v136,v140
s_waitcnt vmcnt(0)
v_mfma_f32_16x16x32_bf16 v[76:79],a[148:151],v[148:151],v[76:79]
ds_read_b128 v[204:207],v17 offset:38912
v_min3_u32 v27,v27,v144,v148
v_and_or_b32 v64,v64,-4,s48
v_mfma_f32_16x16x32_bf16 v[72:75],a[152:155],v[152:155],v[72:75]
ds_read_b128 v[208:211],v17 offset:40960
s_add_u32 s64,s49,s34
v_mfma_f32_16x16x32_bf16 v[76:79],a[156:159],v[156:159],v[76:79]
v_min3_u32 v27,v27,v152,v156
s_waitcnt lgkmcnt(9)
v_mfma_f32_16x16x32_bf16 v[72:75],a[160:163],v[160:163],v[72:75]
ds_read_b128 v[212:215],v17 offset:43008
buffer_store_dwordx4 v[64:67],v25,s[20:23],s64 offen offset:2048
v_mfma_f32_16x16x32_bf16 v[76:79],a[164:167],v[164:167],v[76:79]
ds_read_b128 v[216:219],v17 offset:45056
v_min3_u32 v27,v27,v160,v164
v_and_or_b32 v68,v68,-4,s48
v_mfma_f32_16x16x32_bf16 v[72:75],a[168:171],v[168:171],v[72:75]
ds_read_b128 v[220:223],v17 offset:47104
s_add_u32 s64,s49,s35
v_mfma_f32_16x16x32_bf16 v[76:79],a[172:175],v[172:175],v[76:79]
ds_read_b128 v[224:227],v17 offset:49152
s_waitcnt lgkmcnt(9)
v_mfma_f32_16x16x32_bf16 v[72:75],a[176:179],v[176:179],v[72:75]
ds_read_b128 v[228:231],v17 offset:51200
v_min3_u32 v27,v27,v168,v172
v_mfma_f32_16x16x32_bf16 v[76:79],a[180:183],v[180:183],v[76:79]
v_min3_u32 v27,v27,v176,v180
buffer_store_dwordx4 v[68:71],v25,s[20:23],s64 offen offset:3072
v_mfma_f32_16x16x32_bf16 v[72:75],a[184:187],v[184:187],v[72:75]
ds_read_b128 v[232:235],v17 offset:53248
s_mov_b32 s49,0x7fff0000
v_mfma_f32_16x16x32_bf16 v[76:79],a[188:191],v[188:191],v[76:79]
ds_read_b128 v[236:239],v17 offset:55296
s_waitcnt lgkmcnt(8)
v_mfma_f32_16x16x32_bf16 v[72:75],a[192:195],v[192:195],v[72:75]
ds_read_b128 v[240:243],v17 offset:57344
v_min3_u32 v27,v27,v184,v188
v_mfma_f32_16x16x32_bf16 v[76:79],a[196:199],v[196:199],v[76:79]
ds_read_b128 v[244:247],v17 offset:59392
v_min3_u32 v27,v27,v192,v196
v_mfma_f32_16x16x32_bf16 v[72:75],a[200:203],v[200:203],v[72:75]
ds_read_b128 v[248:251],v17 offset:61440
ds_bpermute_b32 v124,v41,v120
v_mfma_f32_16x16x32_bf16 v[76:79],a[204:207],v[204:207],v[76:79]
v_min3_u32 v27,v27,v200,v204
s_waitcnt lgkmcnt(8)
v_mfma_f32_16x16x32_bf16 v[72:75],a[208:211],v[208:211],v[72:75]
ds_read_b128 v[252:255],v17 offset:63488
ds_bpermute_b32 v125,v41,v121
v_mfma_f32_16x16x32_bf16 v[76:79],a[212:215],v[212:215],v[76:79]
v_min3_u32 v27,v27,v208,v212
v_mfma_f32_16x16x32_bf16 v[72:75],a[216:219],v[216:219],v[72:75]
v_mfma_f32_16x16x32_bf16 v[76:79],a[220:223],v[220:223],v[76:79]
v_min3_u32 v27,v27,v216,v220
s_waitcnt lgkmcnt(6)
v_mfma_f32_16x16x32_bf16 v[72:75],a[224:227],v[224:227],v[72:75]
s_waitcnt lgkmcnt(0)
v_mfma_f32_16x16x32_bf16 v[76:79],a[228:231],v[228:231],v[76:79]
v_min3_u32 v27,v27,v224,v228
v_mfma_f32_16x16x32_bf16 v[72:75],a[232:235],v[232:235],v[72:75]
v_lshlrev_b32 v104,16,v124
v_mfma_f32_16x16x32_bf16 v[76:79],a[236:239],v[236:239],v[76:79]
v_min3_u32 v27,v27,v232,v236
v_mfma_f32_16x16x32_bf16 v[72:75],a[240:243],v[240:243],v[72:75]
v_mfma_f32_16x16x32_bf16 v[76:79],a[244:247],v[244:247],v[76:79]
v_min3_u32 v27,v27,v240,v244
v_mfma_f32_16x16x32_bf16 v[72:75],a[248:251],v[248:251],v[72:75]
v_and_b32 v105,s80,v124
v_mfma_f32_16x16x32_bf16 v[76:79],a[252:255],v[252:255],v[76:79]
v_min3_u32 v27,v27,v248,v252
v_mfma_f32_16x16x32_bf16 v[80:83],a[0:3],v[128:131],0
v_cmp_eq_u32 vcc,0,v27
s_cbranch_vccnz retry_289
v_mfma_f32_16x16x32_bf16 v[84:87],a[4:7],v[132:135],0
v_lshlrev_b32 v106,16,v125
v_mfma_f32_16x16x32_bf16 v[80:83],a[8:11],v[136:139],v[80:83]
v_mfma_f32_16x16x32_bf16 v[84:87],a[12:15],v[140:143],v[84:87]
v_mfma_f32_16x16x32_bf16 v[80:83],a[16:19],v[144:147],v[80:83]
v_and_b32 v107,s80,v125
v_add_f32 v72,v72,v76
v_mfma_f32_16x16x32_bf16 v[84:87],a[20:23],v[148:151],v[84:87]
v_add_f32 v73,v73,v77
v_add_f32 v74,v74,v78
v_mfma_f32_16x16x32_bf16 v[80:83],a[24:27],v[152:155],v[80:83]
v_add_f32 v75,v75,v79
v_and_or_b32 v72,v72,-4,s48
v_mfma_f32_16x16x32_bf16 v[84:87],a[28:31],v[156:159],v[84:87]
s_add_u32 s64,s77,s33
v_mfma_f32_16x16x32_bf16 v[80:83],a[32:35],v[160:163],v[80:83]
buffer_store_dwordx4 v[72:75],v25,s[20:23],s64 offen offset:1024
v_mfma_f32_16x16x32_bf16 v[84:87],a[36:39],v[164:167],v[84:87]
v_mfma_f32_16x16x32_bf16 v[80:83],a[40:43],v[168:171],v[80:83]
v_mfma_f32_16x16x32_bf16 v[84:87],a[44:47],v[172:175],v[84:87]
v_mfma_f32_16x16x32_bf16 v[80:83],a[48:51],v[176:179],v[80:83]
v_mfma_f32_16x16x32_bf16 v[84:87],a[52:55],v[180:183],v[84:87]
v_mfma_f32_16x16x32_bf16 v[80:83],a[56:59],v[184:187],v[80:83]
v_mfma_f32_16x16x32_bf16 v[84:87],a[60:63],v[188:191],v[84:87]
v_mfma_f32_16x16x32_bf16 v[80:83],a[64:67],v[192:195],v[80:83]
buffer_load_dwordx4 v[96:99],v26,s[20:23],s77 offen offset:2048 sc1
v_mfma_f32_16x16x32_bf16 v[84:87],a[68:71],v[196:199],v[84:87]
buffer_load_dwordx4 v[100:103],v26,s[20:23],s77 offen offset:3072 sc1
v_mfma_f32_16x16x32_bf16 v[80:83],a[72:75],v[200:203],v[80:83]
v_mfma_f32_16x16x32_bf16 v[84:87],a[76:79],v[204:207],v[84:87]
v_mfma_f32_16x16x32_bf16 v[80:83],a[80:83],v[208:211],v[80:83]
v_mfma_f32_16x16x32_bf16 v[84:87],a[84:87],v[212:215],v[84:87]
v_mfma_f32_16x16x32_bf16 v[80:83],a[88:91],v[216:219],v[80:83]
v_mfma_f32_16x16x32_bf16 v[84:87],a[92:95],v[220:223],v[84:87]
v_mfma_f32_16x16x32_bf16 v[80:83],a[96:99],v[224:227],v[80:83]
v_mfma_f32_16x16x32_bf16 v[84:87],a[100:103],v[228:231],v[84:87]
v_mfma_f32_16x16x32_bf16 v[80:83],a[104:107],v[232:235],v[80:83]
buffer_load_dwordx4 v[92:95],v26,s[20:23],s77 offen offset:1024 sc1
v_mfma_f32_16x16x32_bf16 v[84:87],a[108:111],v[236:239],v[84:87]
v_mfma_f32_16x16x32_bf16 v[80:83],a[112:115],v[240:243],v[80:83]
v_mfma_f32_16x16x32_bf16 v[84:87],a[116:119],v[244:247],v[84:87]
v_mfma_f32_16x16x32_bf16 v[80:83],a[120:123],v[248:251],v[80:83]
v_mfma_f32_16x16x32_bf16 v[84:87],a[124:127],v[252:255],v[84:87]
s_branch epi_292
keep_300:
v_mfma_f32_16x16x32_bf16 v[68:71],a[228:231],v[228:231],v[68:71]
s_xor_b32 m0,s72,0
s_waitcnt lgkmcnt(10)
v_mfma_f32_16x16x32_bf16 v[64:67],a[104:107],v[232:235],v[64:67]
ds_read_b128 v[160:163],v17 offset:16384
ds_read_b128 v[164:167],v17 offset:18432
s_add_u32 s65,s88,0
v_mfma_f32_16x16x32_bf16 v[68:71],a[232:235],v[232:235],v[68:71]
buffer_load_dwordx4 v16,s[20:23],s65 offen offset:0 sc1 lds
v_min3_u32 v27,v27,v232,v236
v_mfma_f32_16x16x32_bf16 v[64:67],a[108:111],v[236:239],v[64:67]
ds_read_b128 v[168:171],v17 offset:20480
buffer_load_dwordx4 v16,s[20:23],s65 offen offset:2048 sc1 lds
v_mfma_f32_16x16x32_bf16 v[68:71],a[236:239],v[236:239],v[68:71]
s_xor_b32 m0,s72,16384
s_waitcnt lgkmcnt(9)
v_mfma_f32_16x16x32_bf16 v[64:67],a[112:115],v[240:243],v[64:67]
ds_read_b128 v[172:175],v17 offset:22528
v_min3_u32 v27,v27,v240,v244
v_mfma_f32_16x16x32_bf16 v[68:71],a[240:243],v[240:243],v[68:71]
s_add_u32 s65,s88,32768
v_mfma_f32_16x16x32_bf16 v[64:67],a[116:119],v[244:247],v[64:67]
ds_read_b128 v[176:179],v17 offset:24576
ds_read_b128 v[180:183],v17 offset:26624
v_mfma_f32_16x16x32_bf16 v[68:71],a[244:247],v[244:247],v[68:71]
buffer_load_dwordx4 v16,s[20:23],s65 offen offset:0 sc1 lds
s_waitcnt lgkmcnt(7)
v_mfma_f32_16x16x32_bf16 v[64:67],a[120:123],v[248:251],v[64:67]
ds_read_b128 v[184:187],v17 offset:28672
buffer_load_dwordx4 v16,s[20:23],s65 offen offset:2048 sc1 lds
v_mfma_f32_16x16x32_bf16 v[68:71],a[248:251],v[248:251],v[68:71]
s_xor_b32 m0,s72,32768
s_add_u32 s65,s88,65536
v_mfma_f32_16x16x32_bf16 v[64:67],a[124:127],v[252:255],v[64:67]
ds_read_b128 v[188:191],v17 offset:30720
v_min3_u32 v27,v27,v248,v252
v_mfma_f32_16x16x32_bf16 v[68:71],a[252:255],v[252:255],v[68:71]
buffer_load_dwordx4 v16,s[20:23],s65 offen offset:0 sc1 lds
v_mfma_f32_16x16x32_bf16 v[72:75],a[128:131],v[128:131],0
buffer_load_dwordx4 v16,s[20:23],s65 offen offset:2048 sc1 lds
v_mfma_f32_16x16x32_bf16 v[76:79],a[132:135],v[132:135],0
s_xor_b32 m0,s72,49152
v_cmp_eq_u32 vcc,0,v27
s_cbranch_vccnz retry_289
v_mfma_f32_16x16x32_bf16 v[72:75],a[136:139],v[136:139],v[72:75]
s_waitcnt vmcnt(7)
s_barrier
ds_read_b128 v[192:195],v17 offset:32768
v_mfma_f32_16x16x32_bf16 v[76:79],a[140:143],v[140:143],v[76:79]
ds_read_b128 v[196:199],v17 offset:34816
s_add_u32 s65,s88,98304
s_waitcnt lgkmcnt(10)
v_mfma_f32_16x16x32_bf16 v[72:75],a[144:147],v[144:147],v[72:75]
ds_read_b128 v[200:203],v17 offset:36864
buffer_load_dwordx4 v16,s[20:23],s65 offen offset:0 sc1 lds
s_waitcnt vmcnt(7)
v_mfma_f32_16x16x32_bf16 v[76:79],a[148:151],v[148:151],v[76:79]
ds_read_b128 v[204:207],v17 offset:38912
buffer_load_dwordx4 v16,s[20:23],s65 offen offset:2048 sc1 lds
v_and_or_b32 v64,v64,-4,s48
v_mfma_f32_16x16x32_bf16 v[72:75],a[152:155],v[152:155],v[72:75]
ds_read_b128 v[208:211],v17 offset:40960
s_xor_b32 m0,s72,1024
s_add_u32 s64,s49,s34
v_mfma_f32_16x16x32_bf16 v[76:79],a[156:159],v[156:159],v[76:79]
s_add_u32 s65,s89,0
buffer_store_dwordx4 v[64:67],v25,s[20:23],s64 offen offset:2048
s_waitcnt lgkmcnt(9)
v_mfma_f32_16x16x32_bf16 v[72:75],a[160:163],v[160:163],v[72:75]
ds_read_b128 v[212:215],v17 offset:43008
buffer_load_dwordx4 v16,s[20:23],s65 offen offset:0 sc1 lds
v_and_or_b32 v68,v68,-4,s48
v_mfma_f32_16x16x32_bf16 v[76:79],a[164:167],v[164:167],v[76:79]
ds_read_b128 v[216:219],v17 offset:45056
v_min3_u32 v27,v27,v128,v132
s_add_u32 s64,s49,s35
v_mfma_f32_16x16x32_bf16 v[72:75],a[168:171],v[168:171],v[72:75]
ds_read_b128 v[220:223],v17 offset:47104
buffer_load_dwordx4 v16,s[20:23],s65 offen offset:2048 sc1 lds
v_mfma_f32_16x16x32_bf16 v[76:79],a[172:175],v[172:175],v[76:79]
ds_read_b128 v[224:227],v17 offset:49152
s_xor_b32 m0,s72,17408
s_waitcnt lgkmcnt(9)
v_mfma_f32_16x16x32_bf16 v[72:75],a[176:179],v[176:179],v[72:75]
ds_read_b128 v[228:231],v17 offset:51200
s_add_u32 s65,s89,32768
buffer_store_dwordx4 v[68:71],v25,s[20:23],s64 offen offset:3072
v_mfma_f32_16x16x32_bf16 v[76:79],a[180:183],v[180:183],v[76:79]
buffer_load_dwordx4 v16,s[20:23],s65 offen offset:0 sc1 lds
s_mov_b32 s49,0x7fff0000
v_mfma_f32_16x16x32_bf16 v[72:75],a[184:187],v[184:187],v[72:75]
ds_read_b128 v[232:235],v17 offset:53248
v_min3_u32 v27,v27,v136,v140
v_mfma_f32_16x16x32_bf16 v[76:79],a[188:191],v[188:191],v[76:79]
ds_read_b128 v[236:239],v17 offset:55296
s_waitcnt lgkmcnt(8)
v_mfma_f32_16x16x32_bf16 v[72:75],a[192:195],v[192:195],v[72:75]
ds_read_b128 v[240:243],v17 offset:57344
buffer_load_dwordx4 v16,s[20:23],s65 offen offset:2048 sc1 lds
v_mfma_f32_16x16x32_bf16 v[76:79],a[196:199],v[196:199],v[76:79]
ds_read_b128 v[244:247],v17 offset:59392
s_xor_b32 m0,s72,33792
v_mfma_f32_16x16x32_bf16 v[72:75],a[200:203],v[200:203],v[72:75]
ds_read_b128 v[248:251],v17 offset:61440
s_add_u32 s65,s89,65536
v_mfma_f32_16x16x32_bf16 v[76:79],a[204:207],v[204:207],v[76:79]
v_min3_u32 v27,v27,v144,v148
s_waitcnt lgkmcnt(7)
v_mfma_f32_16x16x32_bf16 v[72:75],a[208:211],v[208:211],v[72:75]
ds_read_b128 v[252:255],v17 offset:63488
v_min3_u32 v27,v27,v152,v156
v_mfma_f32_16x16x32_bf16 v[76:79],a[212:215],v[212:215],v[76:79]
buffer_load_dwordx4 v16,s[20:23],s65 offen offset:0 sc1 lds
v_mfma_f32_16x16x32_bf16 v[72:75],a[216:219],v[216:219],v[72:75]
buffer_load_dwordx4 v16,s[20:23],s65 offen offset:2048 sc1 lds
v_mfma_f32_16x16x32_bf16 v[76:79],a[220:223],v[220:223],v[76:79]
s_xor_b32 m0,s72,50176
s_waitcnt lgkmcnt(4)
v_mfma_f32_16x16x32_bf16 v[72:75],a[224:227],v[224:227],v[72:75]
s_add_u32 s65,s89,98304
v_min3_u32 v27,v27,v160,v164
v_mfma_f32_16x16x32_bf16 v[76:79],a[228:231],v[228:231],v[76:79]
buffer_load_dwordx4 v16,s[20:23],s65 offen offset:0 sc1 lds
v_mfma_f32_16x16x32_bf16 v[72:75],a[232:235],v[232:235],v[72:75]
buffer_load_dwordx4 v16,s[20:23],s65 offen offset:2048 sc1 lds
v_mfma_f32_16x16x32_bf16 v[76:79],a[236:239],v[236:239],v[76:79]
v_min3_u32 v27,v27,v168,v172
s_waitcnt lgkmcnt(0)
v_mfma_f32_16x16x32_bf16 v[72:75],a[240:243],v[240:243],v[72:75]
v_min3_u32 v27,v27,v176,v180
v_min3_u32 v27,v27,v184,v188
v_mfma_f32_16x16x32_bf16 v[76:79],a[244:247],v[244:247],v[76:79]
v_min3_u32 v27,v27,v192,v196
v_min3_u32 v27,v27,v200,v204
v_min3_u32 v27,v27,v240,v244
v_mfma_f32_16x16x32_bf16 v[72:75],a[248:251],v[248:251],v[72:75]
v_min3_u32 v27,v27,v208,v212
v_min3_u32 v27,v27,v216,v220
v_mfma_f32_16x16x32_bf16 v[76:79],a[252:255],v[252:255],v[76:79]
v_min3_u32 v27,v27,v224,v228
v_min3_u32 v27,v27,v232,v236
v_min3_u32 v27,v27,v248,v252
v_mfma_f32_16x16x32_bf16 v[80:83],a[0:3],v[128:131],0
v_cmp_eq_u32 vcc,0,v27
s_cbranch_vccnz retry_289
v_mfma_f32_16x16x32_bf16 v[84:87],a[4:7],v[132:135],0
ds_bpermute_b32 v124,v41,v120
ds_bpermute_b32 v125,v41,v121
v_mfma_f32_16x16x32_bf16 v[80:83],a[8:11],v[136:139],v[80:83]
s_waitcnt lgkmcnt(0)
v_lshlrev_b32 v104,16,v124
v_mfma_f32_16x16x32_bf16 v[84:87],a[12:15],v[140:143],v[84:87]
v_and_b32 v105,s80,v124
v_lshlrev_b32 v106,16,v125
v_mfma_f32_16x16x32_bf16 v[80:83],a[16:19],v[144:147],v[80:83]
v_and_b32 v107,s80,v125
v_add_f32 v72,v72,v76
v_mfma_f32_16x16x32_bf16 v[84:87],a[20:23],v[148:151],v[84:87]
v_add_f32 v73,v73,v77
v_add_f32 v74,v74,v78
v_mfma_f32_16x16x32_bf16 v[80:83],a[24:27],v[152:155],v[80:83]
v_add_f32 v75,v75,v79
v_and_or_b32 v72,v72,-4,s48
v_mfma_f32_16x16x32_bf16 v[84:87],a[28:31],v[156:159],v[84:87]
s_add_u32 s64,s77,s33
v_mfma_f32_16x16x32_bf16 v[80:83],a[32:35],v[160:163],v[80:83]
buffer_store_dwordx4 v[72:75],v25,s[20:23],s64 offen offset:1024
v_mfma_f32_16x16x32_bf16 v[84:87],a[36:39],v[164:167],v[84:87]
v_mfma_f32_16x16x32_bf16 v[80:83],a[40:43],v[168:171],v[80:83]
v_mfma_f32_16x16x32_bf16 v[84:87],a[44:47],v[172:175],v[84:87]
v_mfma_f32_16x16x32_bf16 v[80:83],a[48:51],v[176:179],v[80:83]
v_mfma_f32_16x16x32_bf16 v[84:87],a[52:55],v[180:183],v[84:87]
v_mfma_f32_16x16x32_bf16 v[80:83],a[56:59],v[184:187],v[80:83]
v_mfma_f32_16x16x32_bf16 v[84:87],a[60:63],v[188:191],v[84:87]
v_mfma_f32_16x16x32_bf16 v[80:83],a[64:67],v[192:195],v[80:83]
buffer_load_dwordx4 v[96:99],v26,s[20:23],s77 offen offset:2048 sc1
v_mfma_f32_16x16x32_bf16 v[84:87],a[68:71],v[196:199],v[84:87]
buffer_load_dwordx4 v[100:103],v26,s[20:23],s77 offen offset:3072 sc1
v_mfma_f32_16x16x32_bf16 v[80:83],a[72:75],v[200:203],v[80:83]
v_mfma_f32_16x16x32_bf16 v[84:87],a[76:79],v[204:207],v[84:87]
v_mfma_f32_16x16x32_bf16 v[80:83],a[80:83],v[208:211],v[80:83]
v_mfma_f32_16x16x32_bf16 v[84:87],a[84:87],v[212:215],v[84:87]
v_mfma_f32_16x16x32_bf16 v[80:83],a[88:91],v[216:219],v[80:83]
v_mfma_f32_16x16x32_bf16 v[84:87],a[92:95],v[220:223],v[84:87]
v_mfma_f32_16x16x32_bf16 v[80:83],a[96:99],v[224:227],v[80:83]
v_mfma_f32_16x16x32_bf16 v[84:87],a[100:103],v[228:231],v[84:87]
v_mfma_f32_16x16x32_bf16 v[80:83],a[104:107],v[232:235],v[80:83]
buffer_load_dwordx4 v[92:95],v26,s[20:23],s77 offen offset:1024 sc1
v_mfma_f32_16x16x32_bf16 v[84:87],a[108:111],v[236:239],v[84:87]
v_mfma_f32_16x16x32_bf16 v[80:83],a[112:115],v[240:243],v[80:83]
v_mfma_f32_16x16x32_bf16 v[84:87],a[116:119],v[244:247],v[84:87]
v_mfma_f32_16x16x32_bf16 v[80:83],a[120:123],v[248:251],v[80:83]
v_mfma_f32_16x16x32_bf16 v[84:87],a[124:127],v[252:255],v[84:87]
s_branch epi_292
ahead_291:
s_cmp_eq_u32 s93,0
s_cbranch_scc1 both_293
s_waitcnt vmcnt(15) lgkmcnt(0)
s_barrier
ds_read_b128 v[224:227],v18 offset:0
ds_read_b128 v[228:231],v18 offset:2048
ds_read_b128 v[232:235],v18 offset:4096
ds_read_b128 v[236:239],v18 offset:6144
ds_read_b128 v[240:243],v18 offset:8192
ds_read_b128 v[244:247],v18 offset:10240
ds_read_b128 v[248:251],v18 offset:12288
s_waitcnt lgkmcnt(5)
v_mfma_f32_16x16x32_bf16 v[64:67],a[0:3],v[224:227],0
s_add_u32 s96,s71,1
s_add_u32 s92,s71,2
v_mfma_f32_16x16x32_bf16 v[68:71],a[128:131],v[224:227],0
ds_read_b128 v[252:255],v18 offset:14336
v_min_u32 v27,v224,v228
v_mfma_f32_16x16x32_bf16 v[64:67],a[4:7],v[228:231],v[64:67]
buffer_load_dwordx2 v[120:121],v20,s[36:39],s78 offen
v_mfma_f32_16x16x32_bf16 v[68:71],a[132:135],v[228:231],v[68:71]
ds_read_b128 v[224:227],v18 offset:16384
s_waitcnt lgkmcnt(5)
v_mfma_f32_16x16x32_bf16 v[64:67],a[8:11],v[232:235],v[64:67]
v_min3_u32 v27,v27,v232,v236
v_mfma_f32_16x16x32_bf16 v[68:71],a[136:139],v[232:235],v[68:71]
ds_read_b128 v[228:231],v18 offset:18432
v_mfma_f32_16x16x32_bf16 v[64:67],a[12:15],v[236:239],v[64:67]
v_mfma_f32_16x16x32_bf16 v[68:71],a[140:143],v[236:239],v[68:71]
ds_read_b128 v[232:235],v18 offset:20480
s_waitcnt lgkmcnt(5)
v_mfma_f32_16x16x32_bf16 v[64:67],a[16:19],v[240:243],v[64:67]
v_min3_u32 v27,v27,v240,v244
v_mfma_f32_16x16x32_bf16 v[68:71],a[144:147],v[240:243],v[68:71]
ds_read_b128 v[236:239],v18 offset:22528
v_mfma_f32_16x16x32_bf16 v[64:67],a[20:23],v[244:247],v[64:67]
v_mfma_f32_16x16x32_bf16 v[68:71],a[148:151],v[244:247],v[68:71]
ds_read_b128 v[240:243],v18 offset:24576
s_waitcnt lgkmcnt(5)
v_mfma_f32_16x16x32_bf16 v[64:67],a[24:27],v[248:251],v[64:67]
v_min3_u32 v27,v27,v248,v252
v_mfma_f32_16x16x32_bf16 v[68:71],a[152:155],v[248:251],v[68:71]
ds_read_b128 v[244:247],v18 offset:26624
v_mfma_f32_16x16x32_bf16 v[64:67],a[28:31],v[252:255],v[64:67]
v_mfma_f32_16x16x32_bf16 v[68:71],a[156:159],v[252:255],v[68:71]
ds_read_b128 v[248:251],v18 offset:28672
s_waitcnt lgkmcnt(5)
v_mfma_f32_16x16x32_bf16 v[64:67],a[32:35],v[224:227],v[64:67]
v_min3_u32 v27,v27,v224,v228
v_mfma_f32_16x16x32_bf16 v[68:71],a[160:163],v[224:227],v[68:71]
ds_read_b128 v[252:255],v18 offset:30720
v_mfma_f32_16x16x32_bf16 v[64:67],a[36:39],v[228:231],v[64:67]
s_waitcnt vmcnt(3)
v_mfma_f32_16x16x32_bf16 v[68:71],a[164:167],v[228:231],v[68:71]
ds_read_b128 v[224:227],v18 offset:32768
s_waitcnt lgkmcnt(5)
v_mfma_f32_16x16x32_bf16 v[64:67],a[40:43],v[232:235],v[64:67]
v_cmp_gt_u32 vcc,s96,v29
v_cmp_gt_u32 s[92:93],s92,v29
v_mfma_f32_16x16x32_bf16 v[68:71],a[168:171],v[232:235],v[68:71]
ds_read_b128 v[228:231],v18 offset:34816
v_min3_u32 v27,v27,v232,v236
v_mfma_f32_16x16x32_bf16 v[64:67],a[44:47],v[236:239],v[64:67]
v_mov_b32 v44,vcc_lo
v_mov_b32 v45,s92
v_mfma_f32_16x16x32_bf16 v[68:71],a[172:175],v[236:239],v[68:71]
ds_read_b128 v[232:235],v18 offset:36864
s_waitcnt lgkmcnt(5)
v_mfma_f32_16x16x32_bf16 v[64:67],a[48:51],v[240:243],v[64:67]
ds_write_b64 v46,v[44:45]
v_min3_u32 v27,v27,v240,v244
v_mfma_f32_16x16x32_bf16 v[68:71],a[176:179],v[240:243],v[68:71]
ds_read_b128 v[236:239],v18 offset:38912
v_mfma_f32_16x16x32_bf16 v[64:67],a[52:55],v[244:247],v[64:67]
v_mfma_f32_16x16x32_bf16 v[68:71],a[180:183],v[244:247],v[68:71]
ds_read_b128 v[240:243],v18 offset:40960
s_waitcnt lgkmcnt(6)
v_mfma_f32_16x16x32_bf16 v[64:67],a[56:59],v[248:251],v[64:67]
v_min3_u32 v27,v27,v248,v252
s_add_u32 s88,s70,s75
v_mfma_f32_16x16x32_bf16 v[68:71],a[184:187],v[248:251],v[68:71]
ds_read_b128 v[244:247],v18 offset:43008
s_add_u32 s88,s88,2097152
v_mfma_f32_16x16x32_bf16 v[64:67],a[60:63],v[252:255],v[64:67]
s_xor_b32 s88,s88,0x2000
s_xor_b32 s89,s88,1024
v_mfma_f32_16x16x32_bf16 v[68:71],a[188:191],v[252:255],v[68:71]
ds_read_b128 v[248:251],v18 offset:45056
s_waitcnt lgkmcnt(6)
v_mfma_f32_16x16x32_bf16 v[64:67],a[64:67],v[224:227],v[64:67]
v_min3_u32 v27,v27,v224,v228
v_mfma_f32_16x16x32_bf16 v[68:71],a[192:195],v[224:227],v[68:71]
ds_read_b128 v[252:255],v18 offset:47104
v_mfma_f32_16x16x32_bf16 v[64:67],a[68:71],v[228:231],v[64:67]
v_mfma_f32_16x16x32_bf16 v[68:71],a[196:199],v[228:231],v[68:71]
ds_read_b128 v[224:227],v18 offset:49152
s_waitcnt lgkmcnt(5)
v_mfma_f32_16x16x32_bf16 v[64:67],a[72:75],v[232:235],v[64:67]
v_min3_u32 v27,v27,v232,v236
v_mfma_f32_16x16x32_bf16 v[68:71],a[200:203],v[232:235],v[68:71]
ds_read_b128 v[228:231],v18 offset:51200
v_mfma_f32_16x16x32_bf16 v[64:67],a[76:79],v[236:239],v[64:67]
v_mfma_f32_16x16x32_bf16 v[68:71],a[204:207],v[236:239],v[68:71]
ds_read_b128 v[232:235],v18 offset:53248
s_waitcnt lgkmcnt(5)
v_mfma_f32_16x16x32_bf16 v[64:67],a[80:83],v[240:243],v[64:67]
s_waitcnt vmcnt(8)
s_barrier
ds_read_b64 v[44:45],v47
ds_read_b128 v[128:131],v17 offset:0
ds_read_b128 v[132:135],v17 offset:2048
v_mfma_f32_16x16x32_bf16 v[68:71],a[208:211],v[240:243],v[68:71]
ds_read_b128 v[236:239],v18 offset:55296
v_min3_u32 v27,v27,v240,v244
v_mfma_f32_16x16x32_bf16 v[64:67],a[84:87],v[244:247],v[64:67]
ds_read_b128 v[136:139],v17 offset:4096
v_mfma_f32_16x16x32_bf16 v[68:71],a[212:215],v[244:247],v[68:71]
ds_read_b128 v[240:243],v18 offset:57344
s_waitcnt lgkmcnt(9)
v_mfma_f32_16x16x32_bf16 v[64:67],a[88:91],v[248:251],v[64:67]
ds_read_b128 v[140:143],v17 offset:6144
v_min3_u32 v27,v27,v248,v252
v_mfma_f32_16x16x32_bf16 v[68:71],a[216:219],v[248:251],v[68:71]
ds_read_b128 v[244:247],v18 offset:59392
v_mfma_f32_16x16x32_bf16 v[64:67],a[92:95],v[252:255],v[64:67]
ds_read_b128 v[144:147],v17 offset:8192
ds_read_b128 v[148:151],v17 offset:10240
v_mfma_f32_16x16x32_bf16 v[68:71],a[220:223],v[252:255],v[68:71]
ds_read_b128 v[248:251],v18 offset:61440
s_waitcnt lgkmcnt(12)
v_mfma_f32_16x16x32_bf16 v[64:67],a[96:99],v[224:227],v[64:67]
ds_read_b128 v[152:155],v17 offset:12288
s_waitcnt lgkmcnt(11)
v_min3_u32 v27,v27,v224,v228
v_mfma_f32_16x16x32_bf16 v[68:71],a[224:227],v[224:227],v[68:71]
ds_read_b128 v[252:255],v18 offset:63488
v_readfirstlane_b32 s93,v45
v_mfma_f32_16x16x32_bf16 v[64:67],a[100:103],v[228:231],v[64:67]
ds_read_b128 v[156:159],v17 offset:14336
v_readfirstlane_b32 s83,v44
s_cmp_lg_u32 s83,0
s_cbranch_scc1 keep_301
v_mfma_f32_16x16x32_bf16 v[68:71],a[228:231],v[228:231],v[68:71]
s_waitcnt vmcnt(1)
s_xor_b32 m0,s72,0
s_waitcnt lgkmcnt(10)
v_mfma_f32_16x16x32_bf16 v[64:67],a[104:107],v[232:235],v[64:67]
ds_read_b128 v[160:163],v17 offset:16384
ds_read_b128 v[164:167],v17 offset:18432
s_add_u32 s65,s88,0
v_min3_u32 v27,v27,v232,v236
v_mfma_f32_16x16x32_bf16 v[68:71],a[232:235],v[232:235],v[68:71]
v_add_u32 v22,s71,-1
buffer_load_dwordx4 v16,s[20:23],s65 offen offset:0 sc1 lds
v_mfma_f32_16x16x32_bf16 v[64:67],a[108:111],v[236:239],v[64:67]
ds_read_b128 v[168:171],v17 offset:20480
buffer_load_dwordx4 v16,s[20:23],s65 offen offset:2048 sc1 lds
v_mfma_f32_16x16x32_bf16 v[68:71],a[236:239],v[236:239],v[68:71]
s_xor_b32 m0,s72,16384
s_waitcnt lgkmcnt(9)
v_mfma_f32_16x16x32_bf16 v[64:67],a[112:115],v[240:243],v[64:67]
ds_read_b128 v[172:175],v17 offset:22528
v_min3_u32 v27,v27,v240,v244
v_mfma_f32_16x16x32_bf16 v[68:71],a[240:243],v[240:243],v[68:71]
buffer_store_dword v22,v23,s[20:23],s97 offen sc1
s_add_u32 s65,s88,32768
v_mfma_f32_16x16x32_bf16 v[64:67],a[116:119],v[244:247],v[64:67]
ds_read_b128 v[176:179],v17 offset:24576
ds_read_b128 v[180:183],v17 offset:26624
v_mfma_f32_16x16x32_bf16 v[68:71],a[244:247],v[244:247],v[68:71]
s_mov_b32 s97,0x7fff0000
s_waitcnt lgkmcnt(7)
v_mfma_f32_16x16x32_bf16 v[64:67],a[120:123],v[248:251],v[64:67]
ds_read_b128 v[184:187],v17 offset:28672
buffer_load_dwordx4 v16,s[20:23],s65 offen offset:0 sc1 lds
v_mfma_f32_16x16x32_bf16 v[68:71],a[248:251],v[248:251],v[68:71]
buffer_load_dwordx4 v16,s[20:23],s65 offen offset:2048 sc1 lds
s_xor_b32 m0,s72,32768
v_mfma_f32_16x16x32_bf16 v[64:67],a[124:127],v[252:255],v[64:67]
ds_read_b128 v[188:191],v17 offset:30720
s_add_u32 s65,s88,65536
v_min3_u32 v27,v27,v248,v252
v_mfma_f32_16x16x32_bf16 v[68:71],a[252:255],v[252:255],v[68:71]
buffer_load_dwordx4 v16,s[20:23],s65 offen offset:0 sc1 lds
v_mfma_f32_16x16x32_bf16 v[72:75],a[128:131],v[128:131],0
buffer_load_dwordx4 v16,s[20:23],s65 offen offset:2048 sc1 lds
v_mfma_f32_16x16x32_bf16 v[76:79],a[132:135],v[132:135],0
s_xor_b32 m0,s72,49152
v_cmp_eq_u32 vcc,0,v27
s_cbranch_vccnz retry_289
v_mfma_f32_16x16x32_bf16 v[72:75],a[136:139],v[136:139],v[72:75]
ds_read_b128 v[192:195],v17 offset:32768
s_add_u32 s65,s88,98304
v_mfma_f32_16x16x32_bf16 v[76:79],a[140:143],v[140:143],v[76:79]
ds_read_b128 v[196:199],v17 offset:34816
s_waitcnt lgkmcnt(10)
v_mfma_f32_16x16x32_bf16 v[72:75],a[144:147],v[144:147],v[72:75]
ds_read_b128 v[200:203],v17 offset:36864
buffer_load_dwordx4 v16,s[20:23],s65 offen offset:0 sc1 lds
s_waitcnt vmcnt(8)
v_mfma_f32_16x16x32_bf16 v[76:79],a[148:151],v[148:151],v[76:79]
ds_read_b128 v[204:207],v17 offset:38912
buffer_load_dwordx4 v16,s[20:23],s65 offen offset:2048 sc1 lds
v_and_or_b32 v64,v64,-4,s48
v_mfma_f32_16x16x32_bf16 v[72:75],a[152:155],v[152:155],v[72:75]
ds_read_b128 v[208:211],v17 offset:40960
s_xor_b32 m0,s72,1024
s_add_u32 s64,s49,s34
v_mfma_f32_16x16x32_bf16 v[76:79],a[156:159],v[156:159],v[76:79]
s_add_u32 s65,s89,0
buffer_store_dwordx4 v[64:67],v25,s[20:23],s64 offen offset:2048
s_waitcnt lgkmcnt(9)
v_mfma_f32_16x16x32_bf16 v[72:75],a[160:163],v[160:163],v[72:75]
ds_read_b128 v[212:215],v17 offset:43008
buffer_load_dwordx4 v16,s[20:23],s65 offen offset:0 sc1 lds
v_and_or_b32 v68,v68,-4,s48
v_mfma_f32_16x16x32_bf16 v[76:79],a[164:167],v[164:167],v[76:79]
ds_read_b128 v[216:219],v17 offset:45056
v_min3_u32 v27,v27,v128,v132
s_add_u32 s64,s49,s35
v_mfma_f32_16x16x32_bf16 v[72:75],a[168:171],v[168:171],v[72:75]
ds_read_b128 v[220:223],v17 offset:47104
buffer_load_dwordx4 v16,s[20:23],s65 offen offset:2048 sc1 lds
v_mfma_f32_16x16x32_bf16 v[76:79],a[172:175],v[172:175],v[76:79]
ds_read_b128 v[224:227],v17 offset:49152
s_xor_b32 m0,s72,17408
s_waitcnt lgkmcnt(9)
v_mfma_f32_16x16x32_bf16 v[72:75],a[176:179],v[176:179],v[72:75]
ds_read_b128 v[228:231],v17 offset:51200
s_add_u32 s65,s89,32768
buffer_store_dwordx4 v[68:71],v25,s[20:23],s64 offen offset:3072
v_mfma_f32_16x16x32_bf16 v[76:79],a[180:183],v[180:183],v[76:79]
buffer_load_dwordx4 v16,s[20:23],s65 offen offset:0 sc1 lds
s_mov_b32 s49,0x7fff0000
v_mfma_f32_16x16x32_bf16 v[72:75],a[184:187],v[184:187],v[72:75]
ds_read_b128 v[232:235],v17 offset:53248
v_min3_u32 v27,v27,v136,v140
v_mfma_f32_16x16x32_bf16 v[76:79],a[188:191],v[188:191],v[76:79]
ds_read_b128 v[236:239],v17 offset:55296
s_waitcnt lgkmcnt(8)
v_mfma_f32_16x16x32_bf16 v[72:75],a[192:195],v[192:195],v[72:75]
ds_read_b128 v[240:243],v17 offset:57344
buffer_load_dwordx4 v16,s[20:23],s65 offen offset:2048 sc1 lds
v_mfma_f32_16x16x32_bf16 v[76:79],a[196:199],v[196:199],v[76:79]
ds_read_b128 v[244:247],v17 offset:59392
s_xor_b32 m0,s72,33792
v_mfma_f32_16x16x32_bf16 v[72:75],a[200:203],v[200:203],v[72:75]
ds_read_b128 v[248:251],v17 offset:61440
s_add_u32 s65,s89,65536
v_mfma_f32_16x16x32_bf16 v[76:79],a[204:207],v[204:207],v[76:79]
v_min3_u32 v27,v27,v144,v148
s_waitcnt lgkmcnt(7)
v_mfma_f32_16x16x32_bf16 v[72:75],a[208:211],v[208:211],v[72:75]
ds_read_b128 v[252:255],v17 offset:63488
v_min3_u32 v27,v27,v152,v156
v_mfma_f32_16x16x32_bf16 v[76:79],a[212:215],v[212:215],v[76:79]
buffer_load_dwordx4 v16,s[20:23],s65 offen offset:0 sc1 lds
v_mfma_f32_16x16x32_bf16 v[72:75],a[216:219],v[216:219],v[72:75]
buffer_load_dwordx4 v16,s[20:23],s65 offen offset:2048 sc1 lds
v_mfma_f32_16x16x32_bf16 v[76:79],a[220:223],v[220:223],v[76:79]
s_xor_b32 m0,s72,50176
s_waitcnt lgkmcnt(4)
v_mfma_f32_16x16x32_bf16 v[72:75],a[224:227],v[224:227],v[72:75]
s_add_u32 s65,s89,98304
v_min3_u32 v27,v27,v160,v164
v_mfma_f32_16x16x32_bf16 v[76:79],a[228:231],v[228:231],v[76:79]
buffer_load_dwordx4 v16,s[20:23],s65 offen offset:0 sc1 lds
v_mfma_f32_16x16x32_bf16 v[72:75],a[232:235],v[232:235],v[72:75]
buffer_load_dwordx4 v16,s[20:23],s65 offen offset:2048 sc1 lds
v_mfma_f32_16x16x32_bf16 v[76:79],a[236:239],v[236:239],v[76:79]
v_min3_u32 v27,v27,v168,v172
s_waitcnt lgkmcnt(0)
v_mfma_f32_16x16x32_bf16 v[72:75],a[240:243],v[240:243],v[72:75]
v_min3_u32 v27,v27,v176,v180
v_min3_u32 v27,v27,v184,v188
v_mfma_f32_16x16x32_bf16 v[76:79],a[244:247],v[244:247],v[76:79]
v_min3_u32 v27,v27,v192,v196
v_min3_u32 v27,v27,v200,v204
v_min3_u32 v27,v27,v240,v244
v_mfma_f32_16x16x32_bf16 v[72:75],a[248:251],v[248:251],v[72:75]
v_min3_u32 v27,v27,v208,v212
v_min3_u32 v27,v27,v216,v220
v_mfma_f32_16x16x32_bf16 v[76:79],a[252:255],v[252:255],v[76:79]
v_min3_u32 v27,v27,v224,v228
v_min3_u32 v27,v27,v232,v236
v_min3_u32 v27,v27,v248,v252
v_mfma_f32_16x16x32_bf16 v[80:83],a[0:3],v[128:131],0
v_cmp_eq_u32 vcc,0,v27
s_cbranch_vccnz retry_289
v_mfma_f32_16x16x32_bf16 v[84:87],a[4:7],v[132:135],0
ds_bpermute_b32 v124,v41,v120
ds_bpermute_b32 v125,v41,v121
v_mfma_f32_16x16x32_bf16 v[80:83],a[8:11],v[136:139],v[80:83]
s_waitcnt lgkmcnt(0)
v_lshlrev_b32 v104,16,v124
v_mfma_f32_16x16x32_bf16 v[84:87],a[12:15],v[140:143],v[84:87]
v_and_b32 v105,s80,v124
v_lshlrev_b32 v106,16,v125
v_mfma_f32_16x16x32_bf16 v[80:83],a[16:19],v[144:147],v[80:83]
v_and_b32 v107,s80,v125
v_add_f32 v72,v72,v76
v_mfma_f32_16x16x32_bf16 v[84:87],a[20:23],v[148:151],v[84:87]
v_add_f32 v73,v73,v77
v_add_f32 v74,v74,v78
v_mfma_f32_16x16x32_bf16 v[80:83],a[24:27],v[152:155],v[80:83]
v_add_f32 v75,v75,v79
v_and_or_b32 v72,v72,-4,s48
v_mfma_f32_16x16x32_bf16 v[84:87],a[28:31],v[156:159],v[84:87]
s_add_u32 s64,s77,s33
v_mfma_f32_16x16x32_bf16 v[80:83],a[32:35],v[160:163],v[80:83]
buffer_store_dwordx4 v[72:75],v25,s[20:23],s64 offen offset:1024
v_mfma_f32_16x16x32_bf16 v[84:87],a[36:39],v[164:167],v[84:87]
v_mfma_f32_16x16x32_bf16 v[80:83],a[40:43],v[168:171],v[80:83]
v_mfma_f32_16x16x32_bf16 v[84:87],a[44:47],v[172:175],v[84:87]
v_mfma_f32_16x16x32_bf16 v[80:83],a[48:51],v[176:179],v[80:83]
v_mfma_f32_16x16x32_bf16 v[84:87],a[52:55],v[180:183],v[84:87]
v_mfma_f32_16x16x32_bf16 v[80:83],a[56:59],v[184:187],v[80:83]
v_mfma_f32_16x16x32_bf16 v[84:87],a[60:63],v[188:191],v[84:87]
v_mfma_f32_16x16x32_bf16 v[80:83],a[64:67],v[192:195],v[80:83]
buffer_load_dwordx4 v[96:99],v26,s[20:23],s77 offen offset:2048 sc1
v_mfma_f32_16x16x32_bf16 v[84:87],a[68:71],v[196:199],v[84:87]
buffer_load_dwordx4 v[100:103],v26,s[20:23],s77 offen offset:3072 sc1
v_mfma_f32_16x16x32_bf16 v[80:83],a[72:75],v[200:203],v[80:83]
v_mfma_f32_16x16x32_bf16 v[84:87],a[76:79],v[204:207],v[84:87]
v_mfma_f32_16x16x32_bf16 v[80:83],a[80:83],v[208:211],v[80:83]
v_mfma_f32_16x16x32_bf16 v[84:87],a[84:87],v[212:215],v[84:87]
v_mfma_f32_16x16x32_bf16 v[80:83],a[88:91],v[216:219],v[80:83]
v_mfma_f32_16x16x32_bf16 v[84:87],a[92:95],v[220:223],v[84:87]
v_mfma_f32_16x16x32_bf16 v[80:83],a[96:99],v[224:227],v[80:83]
v_mfma_f32_16x16x32_bf16 v[84:87],a[100:103],v[228:231],v[84:87]
v_mfma_f32_16x16x32_bf16 v[80:83],a[104:107],v[232:235],v[80:83]
buffer_load_dwordx4 v[92:95],v26,s[20:23],s77 offen offset:1024 sc1
v_mfma_f32_16x16x32_bf16 v[84:87],a[108:111],v[236:239],v[84:87]
v_mfma_f32_16x16x32_bf16 v[80:83],a[112:115],v[240:243],v[80:83]
v_mfma_f32_16x16x32_bf16 v[84:87],a[116:119],v[244:247],v[84:87]
v_mfma_f32_16x16x32_bf16 v[80:83],a[120:123],v[248:251],v[80:83]
v_mfma_f32_16x16x32_bf16 v[84:87],a[124:127],v[252:255],v[84:87]
s_branch epi_292
keep_301:
v_mfma_f32_16x16x32_bf16 v[68:71],a[228:231],v[228:231],v[68:71]
s_waitcnt vmcnt(1)
s_waitcnt lgkmcnt(10)
v_mfma_f32_16x16x32_bf16 v[64:67],a[104:107],v[232:235],v[64:67]
ds_read_b128 v[160:163],v17 offset:16384
ds_read_b128 v[164:167],v17 offset:18432
v_mfma_f32_16x16x32_bf16 v[68:71],a[232:235],v[232:235],v[68:71]
v_add_u32 v22,s71,-1
v_min3_u32 v27,v27,v232,v236
v_mfma_f32_16x16x32_bf16 v[64:67],a[108:111],v[236:239],v[64:67]
ds_read_b128 v[168:171],v17 offset:20480
v_mfma_f32_16x16x32_bf16 v[68:71],a[236:239],v[236:239],v[68:71]
s_waitcnt lgkmcnt(9)
v_mfma_f32_16x16x32_bf16 v[64:67],a[112:115],v[240:243],v[64:67]
ds_read_b128 v[172:175],v17 offset:22528
v_min3_u32 v27,v27,v240,v244
v_mfma_f32_16x16x32_bf16 v[68:71],a[240:243],v[240:243],v[68:71]
buffer_store_dword v22,v23,s[20:23],s97 offen sc1
v_mfma_f32_16x16x32_bf16 v[64:67],a[116:119],v[244:247],v[64:67]
ds_read_b128 v[176:179],v17 offset:24576
ds_read_b128 v[180:183],v17 offset:26624
v_mfma_f32_16x16x32_bf16 v[68:71],a[244:247],v[244:247],v[68:71]
s_mov_b32 s97,0x7fff0000
s_waitcnt lgkmcnt(7)
v_mfma_f32_16x16x32_bf16 v[64:67],a[120:123],v[248:251],v[64:67]
ds_read_b128 v[184:187],v17 offset:28672
v_min3_u32 v27,v27,v248,v252
v_mfma_f32_16x16x32_bf16 v[68:71],a[248:251],v[248:251],v[68:71]
v_mfma_f32_16x16x32_bf16 v[64:67],a[124:127],v[252:255],v[64:67]
ds_read_b128 v[188:191],v17 offset:30720
v_mfma_f32_16x16x32_bf16 v[68:71],a[252:255],v[252:255],v[68:71]
v_mfma_f32_16x16x32_bf16 v[72:75],a[128:131],v[128:131],0
v_cmp_eq_u32 vcc,0,v27
s_cbranch_vccnz retry_289
v_mfma_f32_16x16x32_bf16 v[76:79],a[132:135],v[132:135],0
v_min3_u32 v27,v27,v128,v132
v_mfma_f32_16x16x32_bf16 v[72:75],a[136:139],v[136:139],v[72:75]
ds_read_b128 v[192:195],v17 offset:32768
v_mfma_f32_16x16x32_bf16 v[76:79],a[140:143],v[140:143],v[76:79]
ds_read_b128 v[196:199],v17 offset:34816
s_waitcnt lgkmcnt(10)
v_mfma_f32_16x16x32_bf16 v[72:75],a[144:147],v[144:147],v[72:75]
ds_read_b128 v[200:203],v17 offset:36864
v_min3_u32 v27,v27,v136,v140
s_waitcnt vmcnt(1)
v_mfma_f32_16x16x32_bf16 v[76:79],a[148:151],v[148:151],v[76:79]
ds_read_b128 v[204:207],v17 offset:38912
v_min3_u32 v27,v27,v144,v148
v_and_or_b32 v64,v64,-4,s48
v_mfma_f32_16x16x32_bf16 v[72:75],a[152:155],v[152:155],v[72:75]
ds_read_b128 v[208:211],v17 offset:40960
s_add_u32 s64,s49,s34
v_mfma_f32_16x16x32_bf16 v[76:79],a[156:159],v[156:159],v[76:79]
v_min3_u32 v27,v27,v152,v156
s_waitcnt lgkmcnt(9)
v_mfma_f32_16x16x32_bf16 v[72:75],a[160:163],v[160:163],v[72:75]
ds_read_b128 v[212:215],v17 offset:43008
buffer_store_dwordx4 v[64:67],v25,s[20:23],s64 offen offset:2048
v_mfma_f32_16x16x32_bf16 v[76:79],a[164:167],v[164:167],v[76:79]
ds_read_b128 v[216:219],v17 offset:45056
v_min3_u32 v27,v27,v160,v164
v_and_or_b32 v68,v68,-4,s48
v_mfma_f32_16x16x32_bf16 v[72:75],a[168:171],v[168:171],v[72:75]
ds_read_b128 v[220:223],v17 offset:47104
s_add_u32 s64,s49,s35
v_mfma_f32_16x16x32_bf16 v[76:79],a[172:175],v[172:175],v[76:79]
ds_read_b128 v[224:227],v17 offset:49152
s_waitcnt lgkmcnt(9)
v_mfma_f32_16x16x32_bf16 v[72:75],a[176:179],v[176:179],v[72:75]
ds_read_b128 v[228:231],v17 offset:51200
v_min3_u32 v27,v27,v168,v172
v_mfma_f32_16x16x32_bf16 v[76:79],a[180:183],v[180:183],v[76:79]
v_min3_u32 v27,v27,v176,v180
buffer_store_dwordx4 v[68:71],v25,s[20:23],s64 offen offset:3072
v_mfma_f32_16x16x32_bf16 v[72:75],a[184:187],v[184:187],v[72:75]
ds_read_b128 v[232:235],v17 offset:53248
s_mov_b32 s49,0x7fff0000
v_mfma_f32_16x16x32_bf16 v[76:79],a[188:191],v[188:191],v[76:79]
ds_read_b128 v[236:239],v17 offset:55296
s_waitcnt lgkmcnt(8)
v_mfma_f32_16x16x32_bf16 v[72:75],a[192:195],v[192:195],v[72:75]
ds_read_b128 v[240:243],v17 offset:57344
v_min3_u32 v27,v27,v184,v188
v_mfma_f32_16x16x32_bf16 v[76:79],a[196:199],v[196:199],v[76:79]
ds_read_b128 v[244:247],v17 offset:59392
v_min3_u32 v27,v27,v192,v196
v_mfma_f32_16x16x32_bf16 v[72:75],a[200:203],v[200:203],v[72:75]
ds_read_b128 v[248:251],v17 offset:61440
ds_bpermute_b32 v124,v41,v120
v_mfma_f32_16x16x32_bf16 v[76:79],a[204:207],v[204:207],v[76:79]
v_min3_u32 v27,v27,v200,v204
s_waitcnt lgkmcnt(8)
v_mfma_f32_16x16x32_bf16 v[72:75],a[208:211],v[208:211],v[72:75]
ds_read_b128 v[252:255],v17 offset:63488
ds_bpermute_b32 v125,v41,v121
v_mfma_f32_16x16x32_bf16 v[76:79],a[212:215],v[212:215],v[76:79]
v_min3_u32 v27,v27,v208,v212
v_mfma_f32_16x16x32_bf16 v[72:75],a[216:219],v[216:219],v[72:75]
v_mfma_f32_16x16x32_bf16 v[76:79],a[220:223],v[220:223],v[76:79]
v_min3_u32 v27,v27,v216,v220
s_waitcnt lgkmcnt(6)
v_mfma_f32_16x16x32_bf16 v[72:75],a[224:227],v[224:227],v[72:75]
s_waitcnt lgkmcnt(0)
v_mfma_f32_16x16x32_bf16 v[76:79],a[228:231],v[228:231],v[76:79]
v_min3_u32 v27,v27,v224,v228
v_mfma_f32_16x16x32_bf16 v[72:75],a[232:235],v[232:235],v[72:75]
v_lshlrev_b32 v104,16,v124
v_mfma_f32_16x16x32_bf16 v[76:79],a[236:239],v[236:239],v[76:79]
v_min3_u32 v27,v27,v232,v236
v_mfma_f32_16x16x32_bf16 v[72:75],a[240:243],v[240:243],v[72:75]
v_mfma_f32_16x16x32_bf16 v[76:79],a[244:247],v[244:247],v[76:79]
v_min3_u32 v27,v27,v240,v244
v_mfma_f32_16x16x32_bf16 v[72:75],a[248:251],v[248:251],v[72:75]
v_and_b32 v105,s80,v124
v_mfma_f32_16x16x32_bf16 v[76:79],a[252:255],v[252:255],v[76:79]
v_min3_u32 v27,v27,v248,v252
v_mfma_f32_16x16x32_bf16 v[80:83],a[0:3],v[128:131],0
v_cmp_eq_u32 vcc,0,v27
s_cbranch_vccnz retry_289
v_mfma_f32_16x16x32_bf16 v[84:87],a[4:7],v[132:135],0
v_lshlrev_b32 v106,16,v125
v_mfma_f32_16x16x32_bf16 v[80:83],a[8:11],v[136:139],v[80:83]
v_mfma_f32_16x16x32_bf16 v[84:87],a[12:15],v[140:143],v[84:87]
v_mfma_f32_16x16x32_bf16 v[80:83],a[16:19],v[144:147],v[80:83]
v_and_b32 v107,s80,v125
v_add_f32 v72,v72,v76
v_mfma_f32_16x16x32_bf16 v[84:87],a[20:23],v[148:151],v[84:87]
v_add_f32 v73,v73,v77
v_add_f32 v74,v74,v78
v_mfma_f32_16x16x32_bf16 v[80:83],a[24:27],v[152:155],v[80:83]
v_add_f32 v75,v75,v79
v_and_or_b32 v72,v72,-4,s48
v_mfma_f32_16x16x32_bf16 v[84:87],a[28:31],v[156:159],v[84:87]
s_add_u32 s64,s77,s33
v_mfma_f32_16x16x32_bf16 v[80:83],a[32:35],v[160:163],v[80:83]
buffer_store_dwordx4 v[72:75],v25,s[20:23],s64 offen offset:1024
v_mfma_f32_16x16x32_bf16 v[84:87],a[36:39],v[164:167],v[84:87]
v_mfma_f32_16x16x32_bf16 v[80:83],a[40:43],v[168:171],v[80:83]
v_mfma_f32_16x16x32_bf16 v[84:87],a[44:47],v[172:175],v[84:87]
v_mfma_f32_16x16x32_bf16 v[80:83],a[48:51],v[176:179],v[80:83]
v_mfma_f32_16x16x32_bf16 v[84:87],a[52:55],v[180:183],v[84:87]
v_mfma_f32_16x16x32_bf16 v[80:83],a[56:59],v[184:187],v[80:83]
v_mfma_f32_16x16x32_bf16 v[84:87],a[60:63],v[188:191],v[84:87]
v_mfma_f32_16x16x32_bf16 v[80:83],a[64:67],v[192:195],v[80:83]
buffer_load_dwordx4 v[96:99],v26,s[20:23],s77 offen offset:2048 sc1
v_mfma_f32_16x16x32_bf16 v[84:87],a[68:71],v[196:199],v[84:87]
buffer_load_dwordx4 v[100:103],v26,s[20:23],s77 offen offset:3072 sc1
v_mfma_f32_16x16x32_bf16 v[80:83],a[72:75],v[200:203],v[80:83]
v_mfma_f32_16x16x32_bf16 v[84:87],a[76:79],v[204:207],v[84:87]
v_mfma_f32_16x16x32_bf16 v[80:83],a[80:83],v[208:211],v[80:83]
v_mfma_f32_16x16x32_bf16 v[84:87],a[84:87],v[212:215],v[84:87]
v_mfma_f32_16x16x32_bf16 v[80:83],a[88:91],v[216:219],v[80:83]
v_mfma_f32_16x16x32_bf16 v[84:87],a[92:95],v[220:223],v[84:87]
v_mfma_f32_16x16x32_bf16 v[80:83],a[96:99],v[224:227],v[80:83]
v_mfma_f32_16x16x32_bf16 v[84:87],a[100:103],v[228:231],v[84:87]
v_mfma_f32_16x16x32_bf16 v[80:83],a[104:107],v[232:235],v[80:83]
buffer_load_dwordx4 v[92:95],v26,s[20:23],s77 offen offset:1024 sc1
v_mfma_f32_16x16x32_bf16 v[84:87],a[108:111],v[236:239],v[84:87]
v_mfma_f32_16x16x32_bf16 v[80:83],a[112:115],v[240:243],v[80:83]
v_mfma_f32_16x16x32_bf16 v[84:87],a[116:119],v[244:247],v[84:87]
v_mfma_f32_16x16x32_bf16 v[80:83],a[120:123],v[248:251],v[80:83]
v_mfma_f32_16x16x32_bf16 v[84:87],a[124:127],v[252:255],v[84:87]
s_branch epi_292
both_293:
s_waitcnt vmcnt(15) lgkmcnt(0)
s_barrier
ds_read_b128 v[224:227],v18 offset:0
ds_read_b128 v[228:231],v18 offset:2048
ds_read_b128 v[232:235],v18 offset:4096
ds_read_b128 v[236:239],v18 offset:6144
ds_read_b128 v[240:243],v18 offset:8192
ds_read_b128 v[244:247],v18 offset:10240
ds_read_b128 v[248:251],v18 offset:12288
s_waitcnt lgkmcnt(5)
v_mfma_f32_16x16x32_bf16 v[64:67],a[0:3],v[224:227],0
s_add_u32 s96,s71,1
s_add_u32 s92,s71,2
v_min_u32 v27,v224,v228
v_mfma_f32_16x16x32_bf16 v[68:71],a[128:131],v[224:227],0
ds_read_b128 v[252:255],v18 offset:14336
s_add_u32 s88,s70,s75
v_mfma_f32_16x16x32_bf16 v[64:67],a[4:7],v[228:231],v[64:67]
s_add_u32 s88,s88,2097152
s_xor_b32 s88,s88,0x2000
v_mfma_f32_16x16x32_bf16 v[68:71],a[132:135],v[228:231],v[68:71]
ds_read_b128 v[224:227],v18 offset:16384
s_waitcnt lgkmcnt(5)
v_mfma_f32_16x16x32_bf16 v[64:67],a[8:11],v[232:235],v[64:67]
s_xor_b32 s89,s88,1024
v_min3_u32 v27,v27,v232,v236
v_mfma_f32_16x16x32_bf16 v[68:71],a[136:139],v[232:235],v[68:71]
ds_read_b128 v[228:231],v18 offset:18432
v_mfma_f32_16x16x32_bf16 v[64:67],a[12:15],v[236:239],v[64:67]
s_xor_b32 m0,s72,0
v_mfma_f32_16x16x32_bf16 v[68:71],a[140:143],v[236:239],v[68:71]
ds_read_b128 v[232:235],v18 offset:20480
s_waitcnt lgkmcnt(5)
v_mfma_f32_16x16x32_bf16 v[64:67],a[16:19],v[240:243],v[64:67]
s_add_u32 s65,s88,0
v_min3_u32 v27,v27,v240,v244
v_mfma_f32_16x16x32_bf16 v[68:71],a[144:147],v[240:243],v[68:71]
ds_read_b128 v[236:239],v18 offset:22528
v_mfma_f32_16x16x32_bf16 v[64:67],a[20:23],v[244:247],v[64:67]
buffer_load_dwordx4 v16,s[20:23],s65 offen offset:0 sc1 lds
v_mfma_f32_16x16x32_bf16 v[68:71],a[148:151],v[244:247],v[68:71]
ds_read_b128 v[240:243],v18 offset:24576
s_waitcnt lgkmcnt(5)
v_mfma_f32_16x16x32_bf16 v[64:67],a[24:27],v[248:251],v[64:67]
buffer_load_dwordx4 v16,s[20:23],s65 offen offset:2048 sc1 lds
v_mfma_f32_16x16x32_bf16 v[68:71],a[152:155],v[248:251],v[68:71]
ds_read_b128 v[244:247],v18 offset:26624
v_min3_u32 v27,v27,v248,v252
v_mfma_f32_16x16x32_bf16 v[64:67],a[28:31],v[252:255],v[64:67]
s_xor_b32 m0,s72,16384
v_mfma_f32_16x16x32_bf16 v[68:71],a[156:159],v[252:255],v[68:71]
ds_read_b128 v[248:251],v18 offset:28672
s_waitcnt lgkmcnt(5)
v_mfma_f32_16x16x32_bf16 v[64:67],a[32:35],v[224:227],v[64:67]
s_add_u32 s65,s88,32768
v_min3_u32 v27,v27,v224,v228
v_mfma_f32_16x16x32_bf16 v[68:71],a[160:163],v[224:227],v[68:71]
ds_read_b128 v[252:255],v18 offset:30720
v_mfma_f32_16x16x32_bf16 v[64:67],a[36:39],v[228:231],v[64:67]
s_waitcnt vmcnt(4)
buffer_load_dwordx4 v16,s[20:23],s65 offen offset:0 sc1 lds
v_mfma_f32_16x16x32_bf16 v[68:71],a[164:167],v[228:231],v[68:71]
ds_read_b128 v[224:227],v18 offset:32768
s_waitcnt lgkmcnt(5)
v_mfma_f32_16x16x32_bf16 v[64:67],a[40:43],v[232:235],v[64:67]
v_cmp_gt_u32 vcc,s96,v29
v_cmp_gt_u32 s[92:93],s92,v29
v_min3_u32 v27,v27,v232,v236
v_mfma_f32_16x16x32_bf16 v[68:71],a[168:171],v[232:235],v[68:71]
ds_read_b128 v[228:231],v18 offset:34816
buffer_load_dwordx4 v16,s[20:23],s65 offen offset:2048 sc1 lds
v_mfma_f32_16x16x32_bf16 v[64:67],a[44:47],v[236:239],v[64:67]
v_mov_b32 v44,vcc_lo
v_mov_b32 v45,s92
v_mfma_f32_16x16x32_bf16 v[68:71],a[172:175],v[236:239],v[68:71]
ds_read_b128 v[232:235],v18 offset:36864
s_xor_b32 m0,s72,32768
s_waitcnt lgkmcnt(5)
v_mfma_f32_16x16x32_bf16 v[64:67],a[48:51],v[240:243],v[64:67]
ds_write_b64 v46,v[44:45]
v_min3_u32 v27,v27,v240,v244
v_mfma_f32_16x16x32_bf16 v[68:71],a[176:179],v[240:243],v[68:71]
ds_read_b128 v[236:239],v18 offset:38912
s_add_u32 s65,s88,65536
v_mfma_f32_16x16x32_bf16 v[64:67],a[52:55],v[244:247],v[64:67]
buffer_load_dwordx2 v[120:121],v20,s[36:39],s78 offen
v_mfma_f32_16x16x32_bf16 v[68:71],a[180:183],v[244:247],v[68:71]
ds_read_b128 v[240:243],v18 offset:40960
s_waitcnt lgkmcnt(6)
v_mfma_f32_16x16x32_bf16 v[64:67],a[56:59],v[248:251],v[64:67]
buffer_load_dwordx4 v16,s[20:23],s65 offen offset:0 sc1 lds
v_mfma_f32_16x16x32_bf16 v[68:71],a[184:187],v[248:251],v[68:71]
ds_read_b128 v[244:247],v18 offset:43008
buffer_load_dwordx4 v16,s[20:23],s65 offen offset:2048 sc1 lds
v_mfma_f32_16x16x32_bf16 v[64:67],a[60:63],v[252:255],v[64:67]
v_min3_u32 v27,v27,v248,v252
v_mfma_f32_16x16x32_bf16 v[68:71],a[188:191],v[252:255],v[68:71]
ds_read_b128 v[248:251],v18 offset:45056
s_xor_b32 m0,s72,49152
s_waitcnt lgkmcnt(6)
v_mfma_f32_16x16x32_bf16 v[64:67],a[64:67],v[224:227],v[64:67]
v_min3_u32 v27,v27,v224,v228
v_mfma_f32_16x16x32_bf16 v[68:71],a[192:195],v[224:227],v[68:71]
ds_read_b128 v[252:255],v18 offset:47104
s_add_u32 s65,s88,98304
v_mfma_f32_16x16x32_bf16 v[64:67],a[68:71],v[228:231],v[64:67]
v_mfma_f32_16x16x32_bf16 v[68:71],a[196:199],v[228:231],v[68:71]
ds_read_b128 v[224:227],v18 offset:49152
s_waitcnt lgkmcnt(5)
v_mfma_f32_16x16x32_bf16 v[64:67],a[72:75],v[232:235],v[64:67]
buffer_load_dwordx4 v16,s[20:23],s65 offen offset:0 sc1 lds
v_mfma_f32_16x16x32_bf16 v[68:71],a[200:203],v[232:235],v[68:71]
ds_read_b128 v[228:231],v18 offset:51200
buffer_load_dwordx4 v16,s[20:23],s65 offen offset:2048 sc1 lds
v_mfma_f32_16x16x32_bf16 v[64:67],a[76:79],v[236:239],v[64:67]
v_min3_u32 v27,v27,v232,v236
v_mfma_f32_16x16x32_bf16 v[68:71],a[204:207],v[236:239],v[68:71]
ds_read_b128 v[232:235],v18 offset:53248
s_waitcnt lgkmcnt(5)
v_mfma_f32_16x16x32_bf16 v[64:67],a[80:83],v[240:243],v[64:67]
s_waitcnt vmcnt(16)
s_barrier
ds_read_b64 v[44:45],v47
ds_read_b128 v[128:131],v17 offset:0
ds_read_b128 v[132:135],v17 offset:2048
v_mfma_f32_16x16x32_bf16 v[68:71],a[208:211],v[240:243],v[68:71]
ds_read_b128 v[236:239],v18 offset:55296
s_xor_b32 m0,s72,1024
v_min3_u32 v27,v27,v240,v244
v_mfma_f32_16x16x32_bf16 v[64:67],a[84:87],v[244:247],v[64:67]
ds_read_b128 v[136:139],v17 offset:4096
s_add_u32 s65,s89,0
v_mfma_f32_16x16x32_bf16 v[68:71],a[212:215],v[244:247],v[68:71]
ds_read_b128 v[240:243],v18 offset:57344
s_waitcnt lgkmcnt(9)
v_mfma_f32_16x16x32_bf16 v[64:67],a[88:91],v[248:251],v[64:67]
ds_read_b128 v[140:143],v17 offset:6144
buffer_load_dwordx4 v16,s[20:23],s65 offen offset:0 sc1 lds
v_mfma_f32_16x16x32_bf16 v[68:71],a[216:219],v[248:251],v[68:71]
ds_read_b128 v[244:247],v18 offset:59392
v_min3_u32 v27,v27,v248,v252
v_mfma_f32_16x16x32_bf16 v[64:67],a[92:95],v[252:255],v[64:67]
ds_read_b128 v[144:147],v17 offset:8192
ds_read_b128 v[148:151],v17 offset:10240
v_mfma_f32_16x16x32_bf16 v[68:71],a[220:223],v[252:255],v[68:71]
ds_read_b128 v[248:251],v18 offset:61440
s_waitcnt lgkmcnt(12)
v_mfma_f32_16x16x32_bf16 v[64:67],a[96:99],v[224:227],v[64:67]
ds_read_b128 v[152:155],v17 offset:12288
s_waitcnt lgkmcnt(11)
v_min3_u32 v27,v27,v224,v228
v_mfma_f32_16x16x32_bf16 v[68:71],a[224:227],v[224:227],v[68:71]
ds_read_b128 v[252:255],v18 offset:63488
v_readfirstlane_b32 s93,v45
v_mfma_f32_16x16x32_bf16 v[64:67],a[100:103],v[228:231],v[64:67]
ds_read_b128 v[156:159],v17 offset:14336
buffer_load_dwordx4 v16,s[20:23],s65 offen offset:2048 sc1 lds
v_mfma_f32_16x16x32_bf16 v[68:71],a[228:231],v[228:231],v[68:71]
s_xor_b32 m0,s72,17408
s_add_u32 s65,s89,32768
s_waitcnt lgkmcnt(10)
v_mfma_f32_16x16x32_bf16 v[64:67],a[104:107],v[232:235],v[64:67]
ds_read_b128 v[160:163],v17 offset:16384
ds_read_b128 v[164:167],v17 offset:18432
v_min3_u32 v27,v27,v232,v236
v_mfma_f32_16x16x32_bf16 v[68:71],a[232:235],v[232:235],v[68:71]
buffer_load_dwordx4 v16,s[20:23],s65 offen offset:0 sc1 lds
s_waitcnt vmcnt(12)
v_mfma_f32_16x16x32_bf16 v[64:67],a[108:111],v[236:239],v[64:67]
ds_read_b128 v[168:171],v17 offset:20480
buffer_load_dwordx4 v16,s[20:23],s65 offen offset:2048 sc1 lds
v_mfma_f32_16x16x32_bf16 v[68:71],a[236:239],v[236:239],v[68:71]
v_add_u32 v22,s71,-1
s_waitcnt lgkmcnt(9)
v_mfma_f32_16x16x32_bf16 v[64:67],a[112:115],v[240:243],v[64:67]
ds_read_b128 v[172:175],v17 offset:22528
v_min3_u32 v27,v27,v240,v244
v_mfma_f32_16x16x32_bf16 v[68:71],a[240:243],v[240:243],v[68:71]
s_xor_b32 m0,s72,33792
buffer_store_dword v22,v23,s[20:23],s97 offen sc1
v_mfma_f32_16x16x32_bf16 v[64:67],a[116:119],v[244:247],v[64:67]
ds_read_b128 v[176:179],v17 offset:24576
ds_read_b128 v[180:183],v17 offset:26624
s_mov_b32 s97,0x7fff0000
v_mfma_f32_16x16x32_bf16 v[68:71],a[244:247],v[244:247],v[68:71]
s_add_u32 s65,s89,65536
s_waitcnt lgkmcnt(7)
v_mfma_f32_16x16x32_bf16 v[64:67],a[120:123],v[248:251],v[64:67]
ds_read_b128 v[184:187],v17 offset:28672
v_min3_u32 v27,v27,v248,v252
v_mfma_f32_16x16x32_bf16 v[68:71],a[248:251],v[248:251],v[68:71]
buffer_load_dwordx4 v16,s[20:23],s65 offen offset:0 sc1 lds
v_mfma_f32_16x16x32_bf16 v[64:67],a[124:127],v[252:255],v[64:67]
ds_read_b128 v[188:191],v17 offset:30720
v_mfma_f32_16x16x32_bf16 v[68:71],a[252:255],v[252:255],v[68:71]
buffer_load_dwordx4 v16,s[20:23],s65 offen offset:2048 sc1 lds
v_mfma_f32_16x16x32_bf16 v[72:75],a[128:131],v[128:131],0
v_cmp_eq_u32 vcc,0,v27
s_cbranch_vccnz retry_289
v_mfma_f32_16x16x32_bf16 v[76:79],a[132:135],v[132:135],0
s_xor_b32 m0,s72,50176
v_min3_u32 v27,v27,v128,v132
v_mfma_f32_16x16x32_bf16 v[72:75],a[136:139],v[136:139],v[72:75]
ds_read_b128 v[192:195],v17 offset:32768
v_mfma_f32_16x16x32_bf16 v[76:79],a[140:143],v[140:143],v[76:79]
ds_read_b128 v[196:199],v17 offset:34816
s_add_u32 s65,s89,98304
s_waitcnt lgkmcnt(10)
v_mfma_f32_16x16x32_bf16 v[72:75],a[144:147],v[144:147],v[72:75]
ds_read_b128 v[200:203],v17 offset:36864
v_min3_u32 v27,v27,v136,v140
s_waitcnt vmcnt(11)
v_mfma_f32_16x16x32_bf16 v[76:79],a[148:151],v[148:151],v[76:79]
ds_read_b128 v[204:207],v17 offset:38912
buffer_load_dwordx4 v16,s[20:23],s65 offen offset:0 sc1 lds
v_mfma_f32_16x16x32_bf16 v[72:75],a[152:155],v[152:155],v[72:75]
ds_read_b128 v[208:211],v17 offset:40960
v_min3_u32 v27,v27,v144,v148
v_and_or_b32 v64,v64,-4,s48
v_mfma_f32_16x16x32_bf16 v[76:79],a[156:159],v[156:159],v[76:79]
buffer_load_dwordx4 v16,s[20:23],s65 offen offset:2048 sc1 lds
s_waitcnt lgkmcnt(9)
v_mfma_f32_16x16x32_bf16 v[72:75],a[160:163],v[160:163],v[72:75]
ds_read_b128 v[212:215],v17 offset:43008
v_min3_u32 v27,v27,v152,v156
s_add_u32 s64,s49,s34
v_mfma_f32_16x16x32_bf16 v[76:79],a[164:167],v[164:167],v[76:79]
ds_read_b128 v[216:219],v17 offset:45056
v_min3_u32 v27,v27,v160,v164
v_mfma_f32_16x16x32_bf16 v[72:75],a[168:171],v[168:171],v[72:75]
ds_read_b128 v[220:223],v17 offset:47104
buffer_store_dwordx4 v[64:67],v25,s[20:23],s64 offen offset:2048
v_mfma_f32_16x16x32_bf16 v[76:79],a[172:175],v[172:175],v[76:79]
ds_read_b128 v[224:227],v17 offset:49152
v_and_or_b32 v68,v68,-4,s48
s_waitcnt lgkmcnt(9)
v_mfma_f32_16x16x32_bf16 v[72:75],a[176:179],v[176:179],v[72:75]
ds_read_b128 v[228:231],v17 offset:51200
v_min3_u32 v27,v27,v168,v172
s_add_u32 s64,s49,s35
v_mfma_f32_16x16x32_bf16 v[76:79],a[180:183],v[180:183],v[76:79]
v_min3_u32 v27,v27,v176,v180
buffer_store_dwordx4 v[68:71],v25,s[20:23],s64 offen offset:3072
v_mfma_f32_16x16x32_bf16 v[72:75],a[184:187],v[184:187],v[72:75]
ds_read_b128 v[232:235],v17 offset:53248
s_mov_b32 s49,0x7fff0000
v_mfma_f32_16x16x32_bf16 v[76:79],a[188:191],v[188:191],v[76:79]
ds_read_b128 v[236:239],v17 offset:55296
s_waitcnt lgkmcnt(8)
v_mfma_f32_16x16x32_bf16 v[72:75],a[192:195],v[192:195],v[72:75]
ds_read_b128 v[240:243],v17 offset:57344
v_min3_u32 v27,v27,v184,v188
v_mfma_f32_16x16x32_bf16 v[76:79],a[196:199],v[196:199],v[76:79]
ds_read_b128 v[244:247],v17 offset:59392
v_min3_u32 v27,v27,v192,v196
v_mfma_f32_16x16x32_bf16 v[72:75],a[200:203],v[200:203],v[72:75]
ds_read_b128 v[248:251],v17 offset:61440
ds_bpermute_b32 v124,v41,v120
v_mfma_f32_16x16x32_bf16 v[76:79],a[204:207],v[204:207],v[76:79]
v_min3_u32 v27,v27,v200,v204
s_waitcnt lgkmcnt(8)
v_mfma_f32_16x16x32_bf16 v[72:75],a[208:211],v[208:211],v[72:75]
ds_read_b128 v[252:255],v17 offset:63488
ds_bpermute_b32 v125,v41,v121
v_mfma_f32_16x16x32_bf16 v[76:79],a[212:215],v[212:215],v[76:79]
v_min3_u32 v27,v27,v208,v212
v_mfma_f32_16x16x32_bf16 v[72:75],a[216:219],v[216:219],v[72:75]
v_mfma_f32_16x16x32_bf16 v[76:79],a[220:223],v[220:223],v[76:79]
v_min3_u32 v27,v27,v216,v220
s_waitcnt lgkmcnt(6)
v_mfma_f32_16x16x32_bf16 v[72:75],a[224:227],v[224:227],v[72:75]
s_waitcnt lgkmcnt(0)
v_mfma_f32_16x16x32_bf16 v[76:79],a[228:231],v[228:231],v[76:79]
v_min3_u32 v27,v27,v224,v228
v_mfma_f32_16x16x32_bf16 v[72:75],a[232:235],v[232:235],v[72:75]
v_lshlrev_b32 v104,16,v124
v_mfma_f32_16x16x32_bf16 v[76:79],a[236:239],v[236:239],v[76:79]
v_min3_u32 v27,v27,v232,v236
v_mfma_f32_16x16x32_bf16 v[72:75],a[240:243],v[240:243],v[72:75]
v_mfma_f32_16x16x32_bf16 v[76:79],a[244:247],v[244:247],v[76:79]
v_min3_u32 v27,v27,v240,v244
v_mfma_f32_16x16x32_bf16 v[72:75],a[248:251],v[248:251],v[72:75]
v_and_b32 v105,s80,v124
v_mfma_f32_16x16x32_bf16 v[76:79],a[252:255],v[252:255],v[76:79]
v_min3_u32 v27,v27,v248,v252
v_mfma_f32_16x16x32_bf16 v[80:83],a[0:3],v[128:131],0
v_cmp_eq_u32 vcc,0,v27
s_cbranch_vccnz retry_289
v_mfma_f32_16x16x32_bf16 v[84:87],a[4:7],v[132:135],0
v_lshlrev_b32 v106,16,v125
v_mfma_f32_16x16x32_bf16 v[80:83],a[8:11],v[136:139],v[80:83]
v_mfma_f32_16x16x32_bf16 v[84:87],a[12:15],v[140:143],v[84:87]
v_mfma_f32_16x16x32_bf16 v[80:83],a[16:19],v[144:147],v[80:83]
v_and_b32 v107,s80,v125
v_add_f32 v72,v72,v76
v_mfma_f32_16x16x32_bf16 v[84:87],a[20:23],v[148:151],v[84:87]
v_add_f32 v73,v73,v77
v_add_f32 v74,v74,v78
v_mfma_f32_16x16x32_bf16 v[80:83],a[24:27],v[152:155],v[80:83]
v_add_f32 v75,v75,v79
v_and_or_b32 v72,v72,-4,s48
v_mfma_f32_16x16x32_bf16 v[84:87],a[28:31],v[156:159],v[84:87]
s_add_u32 s64,s77,s33
v_mfma_f32_16x16x32_bf16 v[80:83],a[32:35],v[160:163],v[80:83]
buffer_store_dwordx4 v[72:75],v25,s[20:23],s64 offen offset:1024
v_mfma_f32_16x16x32_bf16 v[84:87],a[36:39],v[164:167],v[84:87]
v_mfma_f32_16x16x32_bf16 v[80:83],a[40:43],v[168:171],v[80:83]
v_mfma_f32_16x16x32_bf16 v[84:87],a[44:47],v[172:175],v[84:87]
v_mfma_f32_16x16x32_bf16 v[80:83],a[48:51],v[176:179],v[80:83]
v_mfma_f32_16x16x32_bf16 v[84:87],a[52:55],v[180:183],v[84:87]
v_mfma_f32_16x16x32_bf16 v[80:83],a[56:59],v[184:187],v[80:83]
v_mfma_f32_16x16x32_bf16 v[84:87],a[60:63],v[188:191],v[84:87]
v_mfma_f32_16x16x32_bf16 v[80:83],a[64:67],v[192:195],v[80:83]
buffer_load_dwordx4 v[96:99],v26,s[20:23],s77 offen offset:2048 sc1
v_mfma_f32_16x16x32_bf16 v[84:87],a[68:71],v[196:199],v[84:87]
buffer_load_dwordx4 v[100:103],v26,s[20:23],s77 offen offset:3072 sc1
v_mfma_f32_16x16x32_bf16 v[80:83],a[72:75],v[200:203],v[80:83]
v_mfma_f32_16x16x32_bf16 v[84:87],a[76:79],v[204:207],v[84:87]
v_mfma_f32_16x16x32_bf16 v[80:83],a[80:83],v[208:211],v[80:83]
v_mfma_f32_16x16x32_bf16 v[84:87],a[84:87],v[212:215],v[84:87]
v_mfma_f32_16x16x32_bf16 v[80:83],a[88:91],v[216:219],v[80:83]
v_mfma_f32_16x16x32_bf16 v[84:87],a[92:95],v[220:223],v[84:87]
v_mfma_f32_16x16x32_bf16 v[80:83],a[96:99],v[224:227],v[80:83]
v_mfma_f32_16x16x32_bf16 v[84:87],a[100:103],v[228:231],v[84:87]
v_mfma_f32_16x16x32_bf16 v[80:83],a[104:107],v[232:235],v[80:83]
buffer_load_dwordx4 v[92:95],v26,s[20:23],s77 offen offset:1024 sc1
v_mfma_f32_16x16x32_bf16 v[84:87],a[108:111],v[236:239],v[84:87]
v_mfma_f32_16x16x32_bf16 v[80:83],a[112:115],v[240:243],v[80:83]
v_mfma_f32_16x16x32_bf16 v[84:87],a[116:119],v[244:247],v[84:87]
v_mfma_f32_16x16x32_bf16 v[80:83],a[120:123],v[248:251],v[80:83]
v_mfma_f32_16x16x32_bf16 v[84:87],a[124:127],v[252:255],v[84:87]
epi_292:
buffer_load_dword v29,v21,s[20:23],s87 offen sc1
s_nop 6
v_pk_add_f32 v[88:89],v[80:81],v[84:85]
v_pk_add_f32 v[90:91],v[82:83],v[86:87]
s_waitcnt vmcnt(1)
s_branch ic_304
ip_302:
buffer_load_dwordx4 v[92:95],v26,s[20:23],s77 offen offset:1024 sc1
buffer_load_dwordx4 v[96:99],v26,s[20:23],s77 offen offset:2048 sc1
buffer_load_dwordx4 v[100:103],v26,s[20:23],s77 offen offset:3072 sc1
s_waitcnt vmcnt(0)
ic_304:
v_bitop3_b32 v22,v92,v96,v100 bitop3:0x80
v_and_b32 v22,s48,v22
v_cmp_eq_u32 vcc,0,v22
s_cbranch_vccz ik_303
s_sub_u32 s90,s90,1
s_cmp_gt_i32 s90,0
s_cbranch_scc1 ip_302
ik_303:
v_pk_add_f32 v[88:89],v[88:89],v[92:93]
v_pk_add_f32 v[96:97],v[96:97],v[100:101]
v_pk_add_f32 v[90:91],v[90:91],v[94:95]
v_pk_add_f32 v[98:99],v[98:99],v[102:103]
v_pk_add_f32 v[88:89],v[88:89],v[96:97]
v_pk_add_f32 v[90:91],v[90:91],v[98:99]
v_pk_fma_f32 v[88:89],v[88:89],v[52:53],v[104:105]
v_pk_fma_f32 v[90:91],v[90:91],v[54:55],v[106:107]
v_cvt_pk_bf16_f32 v88,v88,v89
v_cvt_pk_bf16_f32 v89,v90,v91
v_max_u32 v88,1,v88
ds_bpermute_b32 v88,v40,v88
ds_bpermute_b32 v89,v40,v89
v_xor_b32 v18,0x10000,v18
s_xor_b32 s49,s77,524288
s_cselect_b32 s64,0,3
s_xor_b32 s48,s48,s64
s_waitcnt lgkmcnt(0)
buffer_store_dwordx2 v[88:89],v19,s[20:23],s70 offen sc1
s_mov_b32 s77,s49
s_add_u32 s78,s78,65536
s_cmp_gt_u32 s71,44
s_cselect_b32 s65,s73,0x7fff0000
s_cselect_b32 s97,0x7fff0000,s73
v_mov_b32 v22,s71
buffer_store_dword v22,v23,s[20:23],s65 offen sc1
next_299:
v_xor_b32 v17,0x10000,v17
s_xor_b32 s72,s72,0x10000
s_add_u32 s70,s70,2097152
s_xor_b32 s70,s70,0x2000
s_add_u32 s71,s71,1
s_cmp_le_u32 s71,64
s_cbranch_scc1 seg_290
s_endpgm
retry_289:
s_sub_u32 s90,s90,64
s_cmp_lt_i32 s90,0
s_cbranch_scc1 giveup_197
s_mov_b32 s83,1
s_waitcnt vmcnt(0) lgkmcnt(0)
s_barrier
s_branch seg_290
kslow_288:
s_add_u32 s64,s79,0
s_lshl_b32 s70,s64,21
s_lshl_b32 s64,s64,13
s_and_b32 s64,s64,0x2000
s_xor_b32 s64,s64,s62
s_add_u32 s70,s70,s64
s_add_u32 s70,s70,29360128
s_mov_b32 s83,1
s_mov_b32 s87,s74
s_cmp_eq_u32 s50,0
s_cselect_b32 s74,s74,0x7fff0000
v_mov_b32 v47,132096
s_lshl_b32 s64,s50,3
s_add_u32 s64,s64,132096
v_mov_b32 v46,s64
v_mov_b32 v29,0
s_mov_b32 s97,0x7fff0000
s_mov_b32 s69,1
s_mov_b32 s68,0
s_mov_b32 s52,0x30003
s_mov_b32 s53,s52
seg_308:
s_add_u32 s94,s70,s75
s_xor_b32 s95,s94,1024
s_xor_b32 s91,s72,0x10000
s_waitcnt vmcnt(2)
v_cmp_gt_u32 vcc,s71,v29
s_cbranch_vccz nb_312
s_waitcnt vmcnt(0)
v_add_u32 v22,s71,-1
buffer_store_dword v22,v23,s[20:23],s97 offen sc1
s_mov_b32 s97,0x7fff0000
s_cmp_lg_u32 s50,0
s_cbranch_scc1 nb_312
buffer_load_dword v32,v21,s[20:23],s74 offen sc1
s_sleep 2
pl_314:
buffer_load_dword v33,v21,s[20:23],s74 offen sc1
s_waitcnt vmcnt(1)
v_cmp_gt_u32 vcc,s71,v32
v_mov_b32 v29,v32
s_cbranch_vccz pok_315
buffer_load_dword v32,v21,s[20:23],s74 offen sc1
s_waitcnt vmcnt(1)
v_cmp_gt_u32 vcc,s71,v33
v_mov_b32 v29,v33
s_cbranch_vccz pok_315
s_sub_u32 s90,s90,1
s_cmp_gt_i32 s90,0
s_cbranch_scc1 pl_314
pok_315:
nb_312:
s_barrier
s_xor_b32 m0,s91,0
s_add_u32 s65,s94,0
buffer_load_dwordx4 v16,s[20:23],s65 offen offset:0 sc1 lds
buffer_load_dwordx4 v16,s[20:23],s65 offen offset:2048 sc1 lds
s_xor_b32 m0,s91,16384
s_add_u32 s65,s94,32768
buffer_load_dwordx4 v16,s[20:23],s65 offen offset:0 sc1 lds
buffer_load_dwordx4 v16,s[20:23],s65 offen offset:2048 sc1 lds
s_xor_b32 m0,s91,32768
s_add_u32 s65,s94,65536
buffer_load_dwordx4 v16,s[20:23],s65 offen offset:0 sc1 lds
buffer_load_dwordx4 v16,s[20:23],s65 offen offset:2048 sc1 lds
s_xor_b32 m0,s91,49152
s_add_u32 s65,s94,98304
buffer_load_dwordx4 v16,s[20:23],s65 offen offset:0 sc1 lds
buffer_load_dwordx4 v16,s[20:23],s65 offen offset:2048 sc1 lds
s_waitcnt vmcnt(8)
v_add_u32 v22,s71,-1
buffer_store_dword v22,v23,s[20:23],s97 offen sc1
s_mov_b32 s97,0x7fff0000
s_waitcnt vmcnt(7)
s_barrier
ds_read_b128 v[224:227],v18 offset:0
ds_read_b128 v[228:231],v18 offset:2048
ds_read_b128 v[232:235],v18 offset:4096
ds_read_b128 v[236:239],v18 offset:6144
ds_read_b128 v[240:243],v18 offset:8192
ds_read_b128 v[244:247],v18 offset:10240
ds_read_b128 v[248:251],v18 offset:12288
s_waitcnt lgkmcnt(5)
v_mfma_f32_16x16x32_bf16 v[64:67],a[0:3],v[224:227],0
s_xor_b32 m0,s91,1024
v_min_u32 v27,v224,v228
v_mfma_f32_16x16x32_bf16 v[68:71],a[128:131],v[224:227],0
ds_read_b128 v[252:255],v18 offset:14336
v_mfma_f32_16x16x32_bf16 v[64:67],a[4:7],v[228:231],v[64:67]
s_add_u32 s65,s95,0
v_mfma_f32_16x16x32_bf16 v[68:71],a[132:135],v[228:231],v[68:71]
s_waitcnt vmcnt(5)
s_barrier
ds_read_b128 v[224:227],v18 offset:16384
s_waitcnt lgkmcnt(5)
v_mfma_f32_16x16x32_bf16 v[64:67],a[8:11],v[232:235],v[64:67]
buffer_load_dwordx4 v16,s[20:23],s65 offen offset:0 sc1 lds
v_mfma_f32_16x16x32_bf16 v[68:71],a[136:139],v[232:235],v[68:71]
ds_read_b128 v[228:231],v18 offset:18432
v_min3_u32 v27,v27,v232,v236
v_mfma_f32_16x16x32_bf16 v[64:67],a[12:15],v[236:239],v[64:67]
buffer_load_dwordx4 v16,s[20:23],s65 offen offset:2048 sc1 lds
v_mfma_f32_16x16x32_bf16 v[68:71],a[140:143],v[236:239],v[68:71]
ds_read_b128 v[232:235],v18 offset:20480
s_waitcnt lgkmcnt(5)
v_mfma_f32_16x16x32_bf16 v[64:67],a[16:19],v[240:243],v[64:67]
s_xor_b32 m0,s91,17408
v_min3_u32 v27,v27,v240,v244
v_mfma_f32_16x16x32_bf16 v[68:71],a[144:147],v[240:243],v[68:71]
ds_read_b128 v[236:239],v18 offset:22528
v_mfma_f32_16x16x32_bf16 v[64:67],a[20:23],v[244:247],v[64:67]
s_add_u32 s65,s95,32768
v_mfma_f32_16x16x32_bf16 v[68:71],a[148:151],v[244:247],v[68:71]
ds_read_b128 v[240:243],v18 offset:24576
s_waitcnt lgkmcnt(5)
v_mfma_f32_16x16x32_bf16 v[64:67],a[24:27],v[248:251],v[64:67]
buffer_load_dwordx4 v16,s[20:23],s65 offen offset:0 sc1 lds
v_mfma_f32_16x16x32_bf16 v[68:71],a[152:155],v[248:251],v[68:71]
ds_read_b128 v[244:247],v18 offset:26624
v_min3_u32 v27,v27,v248,v252
v_mfma_f32_16x16x32_bf16 v[64:67],a[28:31],v[252:255],v[64:67]
buffer_load_dwordx4 v16,s[20:23],s65 offen offset:2048 sc1 lds
v_mfma_f32_16x16x32_bf16 v[68:71],a[156:159],v[252:255],v[68:71]
ds_read_b128 v[248:251],v18 offset:28672
s_waitcnt lgkmcnt(5)
v_mfma_f32_16x16x32_bf16 v[64:67],a[32:35],v[224:227],v[64:67]
s_xor_b32 m0,s91,33792
v_min3_u32 v27,v27,v224,v228
v_mfma_f32_16x16x32_bf16 v[68:71],a[160:163],v[224:227],v[68:71]
ds_read_b128 v[252:255],v18 offset:30720
v_mfma_f32_16x16x32_bf16 v[64:67],a[36:39],v[228:231],v[64:67]
s_add_u32 s65,s95,65536
v_mfma_f32_16x16x32_bf16 v[68:71],a[164:167],v[228:231],v[68:71]
s_waitcnt vmcnt(5)
s_barrier
ds_read_b128 v[224:227],v18 offset:32768
s_waitcnt lgkmcnt(5)
v_mfma_f32_16x16x32_bf16 v[64:67],a[40:43],v[232:235],v[64:67]
buffer_load_dwordx4 v16,s[20:23],s65 offen offset:0 sc1 lds
v_mfma_f32_16x16x32_bf16 v[68:71],a[168:171],v[232:235],v[68:71]
ds_read_b128 v[228:231],v18 offset:34816
v_min3_u32 v27,v27,v232,v236
v_mfma_f32_16x16x32_bf16 v[64:67],a[44:47],v[236:239],v[64:67]
buffer_load_dwordx4 v16,s[20:23],s65 offen offset:2048 sc1 lds
v_mfma_f32_16x16x32_bf16 v[68:71],a[172:175],v[236:239],v[68:71]
ds_read_b128 v[232:235],v18 offset:36864
s_waitcnt lgkmcnt(5)
v_mfma_f32_16x16x32_bf16 v[64:67],a[48:51],v[240:243],v[64:67]
s_xor_b32 m0,s91,50176
v_min3_u32 v27,v27,v240,v244
v_mfma_f32_16x16x32_bf16 v[68:71],a[176:179],v[240:243],v[68:71]
ds_read_b128 v[236:239],v18 offset:38912
v_mfma_f32_16x16x32_bf16 v[64:67],a[52:55],v[244:247],v[64:67]
s_add_u32 s65,s95,98304
v_mfma_f32_16x16x32_bf16 v[68:71],a[180:183],v[244:247],v[68:71]
ds_read_b128 v[240:243],v18 offset:40960
s_waitcnt lgkmcnt(5)
v_mfma_f32_16x16x32_bf16 v[64:67],a[56:59],v[248:251],v[64:67]
buffer_load_dwordx4 v16,s[20:23],s65 offen offset:0 sc1 lds
v_mfma_f32_16x16x32_bf16 v[68:71],a[184:187],v[248:251],v[68:71]
ds_read_b128 v[244:247],v18 offset:43008
v_min3_u32 v27,v27,v248,v252
v_mfma_f32_16x16x32_bf16 v[64:67],a[60:63],v[252:255],v[64:67]
buffer_load_dwordx4 v16,s[20:23],s65 offen offset:2048 sc1 lds
v_mfma_f32_16x16x32_bf16 v[68:71],a[188:191],v[252:255],v[68:71]
ds_read_b128 v[248:251],v18 offset:45056
s_waitcnt lgkmcnt(5)
v_mfma_f32_16x16x32_bf16 v[64:67],a[64:67],v[224:227],v[64:67]
v_min3_u32 v27,v27,v224,v228
s_add_u32 s88,s70,s75
v_mfma_f32_16x16x32_bf16 v[68:71],a[192:195],v[224:227],v[68:71]
ds_read_b128 v[252:255],v18 offset:47104
s_add_u32 s88,s88,2097152
v_mfma_f32_16x16x32_bf16 v[64:67],a[68:71],v[228:231],v[64:67]
buffer_load_dwordx2 v[120:121],v20,s[36:39],s78 offen
v_mfma_f32_16x16x32_bf16 v[68:71],a[196:199],v[228:231],v[68:71]
ds_read_b128 v[224:227],v18 offset:49152
s_waitcnt lgkmcnt(5)
v_mfma_f32_16x16x32_bf16 v[64:67],a[72:75],v[232:235],v[64:67]
v_min3_u32 v27,v27,v232,v236
s_xor_b32 s88,s88,0x2000
v_mfma_f32_16x16x32_bf16 v[68:71],a[200:203],v[232:235],v[68:71]
ds_read_b128 v[228:231],v18 offset:51200
s_xor_b32 s89,s88,1024
v_mfma_f32_16x16x32_bf16 v[64:67],a[76:79],v[236:239],v[64:67]
v_mfma_f32_16x16x32_bf16 v[68:71],a[204:207],v[236:239],v[68:71]
ds_read_b128 v[232:235],v18 offset:53248
s_waitcnt lgkmcnt(5)
v_mfma_f32_16x16x32_bf16 v[64:67],a[80:83],v[240:243],v[64:67]
s_waitcnt vmcnt(5)
s_barrier
ds_read_b128 v[128:131],v17 offset:0
ds_read_b128 v[132:135],v17 offset:2048
v_mfma_f32_16x16x32_bf16 v[68:71],a[208:211],v[240:243],v[68:71]
ds_read_b128 v[236:239],v18 offset:55296
v_min3_u32 v27,v27,v240,v244
v_mfma_f32_16x16x32_bf16 v[64:67],a[84:87],v[244:247],v[64:67]
ds_read_b128 v[136:139],v17 offset:4096
v_mfma_f32_16x16x32_bf16 v[68:71],a[212:215],v[244:247],v[68:71]
ds_read_b128 v[240:243],v18 offset:57344
s_waitcnt lgkmcnt(8)
v_mfma_f32_16x16x32_bf16 v[64:67],a[88:91],v[248:251],v[64:67]
ds_read_b128 v[140:143],v17 offset:6144
v_min3_u32 v27,v27,v248,v252
v_mfma_f32_16x16x32_bf16 v[68:71],a[216:219],v[248:251],v[68:71]
ds_read_b128 v[244:247],v18 offset:59392
v_mfma_f32_16x16x32_bf16 v[64:67],a[92:95],v[252:255],v[64:67]
ds_read_b128 v[144:147],v17 offset:8192
ds_read_b128 v[148:151],v17 offset:10240
v_mfma_f32_16x16x32_bf16 v[68:71],a[220:223],v[252:255],v[68:71]
ds_read_b128 v[248:251],v18 offset:61440
s_waitcnt lgkmcnt(11)
v_mfma_f32_16x16x32_bf16 v[64:67],a[96:99],v[224:227],v[64:67]
ds_read_b128 v[152:155],v17 offset:12288
v_min3_u32 v27,v27,v224,v228
v_mfma_f32_16x16x32_bf16 v[68:71],a[224:227],v[224:227],v[68:71]
ds_read_b128 v[252:255],v18 offset:63488
v_mfma_f32_16x16x32_bf16 v[64:67],a[100:103],v[228:231],v[64:67]
ds_read_b128 v[156:159],v17 offset:14336
v_mfma_f32_16x16x32_bf16 v[68:71],a[228:231],v[228:231],v[68:71]
s_waitcnt lgkmcnt(10)
v_mfma_f32_16x16x32_bf16 v[64:67],a[104:107],v[232:235],v[64:67]
ds_read_b128 v[160:163],v17 offset:16384
ds_read_b128 v[164:167],v17 offset:18432
v_mfma_f32_16x16x32_bf16 v[68:71],a[232:235],v[232:235],v[68:71]
v_min3_u32 v27,v27,v232,v236
v_mfma_f32_16x16x32_bf16 v[64:67],a[108:111],v[236:239],v[64:67]
ds_read_b128 v[168:171],v17 offset:20480
v_mfma_f32_16x16x32_bf16 v[68:71],a[236:239],v[236:239],v[68:71]
s_waitcnt lgkmcnt(9)
v_mfma_f32_16x16x32_bf16 v[64:67],a[112:115],v[240:243],v[64:67]
ds_read_b128 v[172:175],v17 offset:22528
v_min3_u32 v27,v27,v240,v244
v_mfma_f32_16x16x32_bf16 v[68:71],a[240:243],v[240:243],v[68:71]
v_mfma_f32_16x16x32_bf16 v[64:67],a[116:119],v[244:247],v[64:67]
ds_read_b128 v[176:179],v17 offset:24576
ds_read_b128 v[180:183],v17 offset:26624
v_mfma_f32_16x16x32_bf16 v[68:71],a[244:247],v[244:247],v[68:71]
s_waitcnt lgkmcnt(7)
v_mfma_f32_16x16x32_bf16 v[64:67],a[120:123],v[248:251],v[64:67]
ds_read_b128 v[184:187],v17 offset:28672
v_min3_u32 v27,v27,v248,v252
v_mfma_f32_16x16x32_bf16 v[68:71],a[248:251],v[248:251],v[68:71]
v_mfma_f32_16x16x32_bf16 v[64:67],a[124:127],v[252:255],v[64:67]
ds_read_b128 v[188:191],v17 offset:30720
v_mfma_f32_16x16x32_bf16 v[68:71],a[252:255],v[252:255],v[68:71]
v_mfma_f32_16x16x32_bf16 v[72:75],a[128:131],v[128:131],0
v_cmp_eq_u32 vcc,0,v27
s_cbranch_vccnz retry_307
v_mfma_f32_16x16x32_bf16 v[76:79],a[132:135],v[132:135],0
v_min3_u32 v27,v27,v128,v132
v_mfma_f32_16x16x32_bf16 v[72:75],a[136:139],v[136:139],v[72:75]
s_waitcnt vmcnt(1)
s_barrier
ds_read_b128 v[192:195],v17 offset:32768
v_mfma_f32_16x16x32_bf16 v[76:79],a[140:143],v[140:143],v[76:79]
ds_read_b128 v[196:199],v17 offset:34816
s_waitcnt lgkmcnt(10)
v_mfma_f32_16x16x32_bf16 v[72:75],a[144:147],v[144:147],v[72:75]
ds_read_b128 v[200:203],v17 offset:36864
v_min3_u32 v27,v27,v136,v140
s_waitcnt vmcnt(0)
v_mfma_f32_16x16x32_bf16 v[76:79],a[148:151],v[148:151],v[76:79]
ds_read_b128 v[204:207],v17 offset:38912
v_min3_u32 v27,v27,v144,v148
v_and_or_b32 v64,v64,-4,s48
v_mfma_f32_16x16x32_bf16 v[72:75],a[152:155],v[152:155],v[72:75]
ds_read_b128 v[208:211],v17 offset:40960
s_add_u32 s64,s49,s34
v_mfma_f32_16x16x32_bf16 v[76:79],a[156:159],v[156:159],v[76:79]
v_min3_u32 v27,v27,v152,v156
s_waitcnt lgkmcnt(9)
v_mfma_f32_16x16x32_bf16 v[72:75],a[160:163],v[160:163],v[72:75]
ds_read_b128 v[212:215],v17 offset:43008
buffer_store_dwordx4 v[64:67],v25,s[20:23],s64 offen offset:2048 sc1
v_mfma_f32_16x16x32_bf16 v[76:79],a[164:167],v[164:167],v[76:79]
ds_read_b128 v[216:219],v17 offset:45056
v_min3_u32 v27,v27,v160,v164
v_and_or_b32 v68,v68,-4,s48
v_mfma_f32_16x16x32_bf16 v[72:75],a[168:171],v[168:171],v[72:75]
ds_read_b128 v[220:223],v17 offset:47104
s_add_u32 s64,s49,s35
v_mfma_f32_16x16x32_bf16 v[76:79],a[172:175],v[172:175],v[76:79]
ds_read_b128 v[224:227],v17 offset:49152
s_waitcnt lgkmcnt(9)
v_mfma_f32_16x16x32_bf16 v[72:75],a[176:179],v[176:179],v[72:75]
ds_read_b128 v[228:231],v17 offset:51200
v_min3_u32 v27,v27,v168,v172
v_mfma_f32_16x16x32_bf16 v[76:79],a[180:183],v[180:183],v[76:79]
v_min3_u32 v27,v27,v176,v180
buffer_store_dwordx4 v[68:71],v25,s[20:23],s64 offen offset:3072 sc1
v_mfma_f32_16x16x32_bf16 v[72:75],a[184:187],v[184:187],v[72:75]
ds_read_b128 v[232:235],v17 offset:53248
s_mov_b32 s49,0x7fff0000
v_mfma_f32_16x16x32_bf16 v[76:79],a[188:191],v[188:191],v[76:79]
ds_read_b128 v[236:239],v17 offset:55296
s_waitcnt lgkmcnt(8)
v_mfma_f32_16x16x32_bf16 v[72:75],a[192:195],v[192:195],v[72:75]
ds_read_b128 v[240:243],v17 offset:57344
v_min3_u32 v27,v27,v184,v188
v_mfma_f32_16x16x32_bf16 v[76:79],a[196:199],v[196:199],v[76:79]
ds_read_b128 v[244:247],v17 offset:59392
v_min3_u32 v27,v27,v192,v196
v_mfma_f32_16x16x32_bf16 v[72:75],a[200:203],v[200:203],v[72:75]
ds_read_b128 v[248:251],v17 offset:61440
ds_bpermute_b32 v124,v41,v120
v_mfma_f32_16x16x32_bf16 v[76:79],a[204:207],v[204:207],v[76:79]
v_min3_u32 v27,v27,v200,v204
s_waitcnt lgkmcnt(8)
v_mfma_f32_16x16x32_bf16 v[72:75],a[208:211],v[208:211],v[72:75]
ds_read_b128 v[252:255],v17 offset:63488
ds_bpermute_b32 v125,v41,v121
v_mfma_f32_16x16x32_bf16 v[76:79],a[212:215],v[212:215],v[76:79]
v_min3_u32 v27,v27,v208,v212
v_mfma_f32_16x16x32_bf16 v[72:75],a[216:219],v[216:219],v[72:75]
v_mfma_f32_16x16x32_bf16 v[76:79],a[220:223],v[220:223],v[76:79]
v_min3_u32 v27,v27,v216,v220
s_waitcnt lgkmcnt(6)
v_mfma_f32_16x16x32_bf16 v[72:75],a[224:227],v[224:227],v[72:75]
s_waitcnt lgkmcnt(0)
v_mfma_f32_16x16x32_bf16 v[76:79],a[228:231],v[228:231],v[76:79]
v_min3_u32 v27,v27,v224,v228
v_mfma_f32_16x16x32_bf16 v[72:75],a[232:235],v[232:235],v[72:75]
v_lshlrev_b32 v104,16,v124
v_mfma_f32_16x16x32_bf16 v[76:79],a[236:239],v[236:239],v[76:79]
v_min3_u32 v27,v27,v232,v236
v_mfma_f32_16x16x32_bf16 v[72:75],a[240:243],v[240:243],v[72:75]
v_mfma_f32_16x16x32_bf16 v[76:79],a[244:247],v[244:247],v[76:79]
v_min3_u32 v27,v27,v240,v244
v_mfma_f32_16x16x32_bf16 v[72:75],a[248:251],v[248:251],v[72:75]
v_and_b32 v105,s80,v124
v_mfma_f32_16x16x32_bf16 v[76:79],a[252:255],v[252:255],v[76:79]
v_min3_u32 v27,v27,v248,v252
v_mfma_f32_16x16x32_bf16 v[80:83],a[0:3],v[128:131],0
v_cmp_eq_u32 vcc,0,v27
s_cbranch_vccnz retry_307
v_mfma_f32_16x16x32_bf16 v[84:87],a[4:7],v[132:135],0
v_lshlrev_b32 v106,16,v125
v_mfma_f32_16x16x32_bf16 v[80:83],a[8:11],v[136:139],v[80:83]
v_mfma_f32_16x16x32_bf16 v[84:87],a[12:15],v[140:143],v[84:87]
v_mfma_f32_16x16x32_bf16 v[80:83],a[16:19],v[144:147],v[80:83]
v_and_b32 v107,s80,v125
v_add_f32 v72,v72,v76
v_mfma_f32_16x16x32_bf16 v[84:87],a[20:23],v[148:151],v[84:87]
v_add_f32 v73,v73,v77
v_add_f32 v74,v74,v78
v_mfma_f32_16x16x32_bf16 v[80:83],a[24:27],v[152:155],v[80:83]
v_add_f32 v75,v75,v79
v_and_or_b32 v72,v72,-4,s48
v_mfma_f32_16x16x32_bf16 v[84:87],a[28:31],v[156:159],v[84:87]
s_add_u32 s64,s77,s33
v_mfma_f32_16x16x32_bf16 v[80:83],a[32:35],v[160:163],v[80:83]
buffer_store_dwordx4 v[72:75],v25,s[20:23],s64 offen offset:1024 sc1
v_mfma_f32_16x16x32_bf16 v[84:87],a[36:39],v[164:167],v[84:87]
v_mfma_f32_16x16x32_bf16 v[80:83],a[40:43],v[168:171],v[80:83]
v_mfma_f32_16x16x32_bf16 v[84:87],a[44:47],v[172:175],v[84:87]
v_mfma_f32_16x16x32_bf16 v[80:83],a[48:51],v[176:179],v[80:83]
v_mfma_f32_16x16x32_bf16 v[84:87],a[52:55],v[180:183],v[84:87]
v_mfma_f32_16x16x32_bf16 v[80:83],a[56:59],v[184:187],v[80:83]
v_mfma_f32_16x16x32_bf16 v[84:87],a[60:63],v[188:191],v[84:87]
v_mfma_f32_16x16x32_bf16 v[80:83],a[64:67],v[192:195],v[80:83]
buffer_load_dwordx4 v[96:99],v26,s[20:23],s77 offen offset:2048 sc1
v_mfma_f32_16x16x32_bf16 v[84:87],a[68:71],v[196:199],v[84:87]
buffer_load_dwordx4 v[100:103],v26,s[20:23],s77 offen offset:3072 sc1
v_mfma_f32_16x16x32_bf16 v[80:83],a[72:75],v[200:203],v[80:83]
v_mfma_f32_16x16x32_bf16 v[84:87],a[76:79],v[204:207],v[84:87]
v_mfma_f32_16x16x32_bf16 v[80:83],a[80:83],v[208:211],v[80:83]
v_mfma_f32_16x16x32_bf16 v[84:87],a[84:87],v[212:215],v[84:87]
v_mfma_f32_16x16x32_bf16 v[80:83],a[88:91],v[216:219],v[80:83]
v_mfma_f32_16x16x32_bf16 v[84:87],a[92:95],v[220:223],v[84:87]
v_mfma_f32_16x16x32_bf16 v[80:83],a[96:99],v[224:227],v[80:83]
v_mfma_f32_16x16x32_bf16 v[84:87],a[100:103],v[228:231],v[84:87]
v_mfma_f32_16x16x32_bf16 v[80:83],a[104:107],v[232:235],v[80:83]
buffer_load_dwordx4 v[92:95],v26,s[20:23],s77 offen offset:1024 sc1
v_mfma_f32_16x16x32_bf16 v[84:87],a[108:111],v[236:239],v[84:87]
v_mfma_f32_16x16x32_bf16 v[80:83],a[112:115],v[240:243],v[80:83]
v_mfma_f32_16x16x32_bf16 v[84:87],a[116:119],v[244:247],v[84:87]
v_mfma_f32_16x16x32_bf16 v[80:83],a[120:123],v[248:251],v[80:83]
v_mfma_f32_16x16x32_bf16 v[84:87],a[124:127],v[252:255],v[84:87]
epi_310:
buffer_load_dword v29,v21,s[20:23],s87 offen sc1
s_nop 6
v_pk_add_f32 v[88:89],v[80:81],v[84:85]
v_pk_add_f32 v[90:91],v[82:83],v[86:87]
s_waitcnt vmcnt(1)
s_branch ic_320
ip_318:
buffer_load_dwordx4 v[92:95],v26,s[20:23],s77 offen offset:1024 sc1
buffer_load_dwordx4 v[96:99],v26,s[20:23],s77 offen offset:2048 sc1
buffer_load_dwordx4 v[100:103],v26,s[20:23],s77 offen offset:3072 sc1
s_waitcnt vmcnt(0)
ic_320:
v_bitop3_b32 v22,v92,v96,v100 bitop3:0x80
v_and_b32 v22,s48,v22
v_cmp_eq_u32 vcc,0,v22
s_cbranch_vccz ik_319
s_sub_u32 s90,s90,1
s_cmp_gt_i32 s90,0
s_cbranch_scc1 ip_318
ik_319:
v_pk_add_f32 v[88:89],v[88:89],v[92:93]
v_pk_add_f32 v[96:97],v[96:97],v[100:101]
v_pk_add_f32 v[90:91],v[90:91],v[94:95]
v_pk_add_f32 v[98:99],v[98:99],v[102:103]
v_pk_add_f32 v[88:89],v[88:89],v[96:97]
v_pk_add_f32 v[90:91],v[90:91],v[98:99]
v_pk_fma_f32 v[88:89],v[88:89],v[52:53],v[104:105]
v_pk_fma_f32 v[90:91],v[90:91],v[54:55],v[106:107]
v_cvt_pk_bf16_f32 v88,v88,v89
v_cvt_pk_bf16_f32 v89,v90,v91
v_max_u32 v88,1,v88
ds_bpermute_b32 v88,v40,v88
ds_bpermute_b32 v89,v40,v89
v_xor_b32 v18,0x10000,v18
s_xor_b32 s49,s77,524288
s_cselect_b32 s64,0,3
s_xor_b32 s48,s48,s64
s_waitcnt lgkmcnt(0)
buffer_store_dwordx2 v[88:89],v19,s[20:23],s70 offen sc1
s_mov_b32 s77,s49
s_add_u32 s78,s78,65536
s_cmp_gt_u32 s71,44
s_cselect_b32 s65,s73,0x7fff0000
s_cselect_b32 s97,0x7fff0000,s73
v_mov_b32 v22,s71
buffer_store_dword v22,v23,s[20:23],s65 offen sc1
next_317:
v_xor_b32 v17,0x10000,v17
s_xor_b32 s72,s72,0x10000
s_add_u32 s70,s70,2097152
s_xor_b32 s70,s70,0x2000
s_add_u32 s71,s71,1
s_cmp_le_u32 s71,64
s_cbranch_scc1 seg_308
s_endpgm
retry_307:
s_sub_u32 s90,s90,64
s_cmp_lt_i32 s90,0
s_cbranch_scc1 giveup_197
s_mov_b32 s83,1
s_waitcnt vmcnt(0) lgkmcnt(0)
s_barrier
s_branch seg_308
r_w4_216:
s_load_dwordx2 s[4:5],s[0:1],88
s_load_dwordx2 s[6:7],s[0:1],112
s_lshr_b32 s41,s59,3
s_and_b32 s42,s59,7
s_mul_i32 s66,s41,1835008
s_lshl_b32 s64,s42,8
s_add_u32 s66,s66,s64
s_lshl_b32 s67,s50,1
s_and_b32 s64,s41,1
s_add_u32 s67,s67,s64
s_waitcnt lgkmcnt(0)
s_mov_b32 s32,s4
s_and_b32 s33,s5,0xffff
s_mov_b32 s34,0x700000
s_mov_b32 s35,0x20000
s_sub_u32 s36,s6,0x1000
s_subb_u32 s37,s7,0
s_and_b32 s37,s37,0xffff
s_mov_b32 s38,0x401000
s_mov_b32 s39,0x20000
v_lshrrev_b32 v5,2,v3
v_lshl_add_u32 v5,v4,2,v5
v_and_b32 v6,3,v3
v_lshlrev_b32 v6,3,v6
v_lshl_add_u32 v6,v5,8,v6
v_and_b32 v5,7,v5
v_xor_b32 v5,s67,v5
v_lshl_add_u32 v12,v5,5,v6
v_xor_b32 v13,32,v12
v_and_b32 v5,15,v1
v_and_b32 v6,3,v4
v_lshlrev_b32 v6,1,v6
v_xor_b32 v5,v5,v6
v_mul_u32_u24 v6,2048,v4
v_xor_b32 v7,0,v5
v_lshl_add_u32 v8,v7,4,v6
v_xor_b32 v7,8,v5
v_lshl_add_u32 v9,v7,4,v6
s_mul_i32 s74,s50,131072
s_add_u32 s74,s74,s66
s_lshl_b32 s75,s50,14
s_mul_i32 s76,s50,65536
s_add_u32 s76,s76,s66
s_lshl_b32 s77,s50,13
s_add_u32 s64,s74,0
s_add_u32 m0,s75,0
s_nop 0
buffer_load_dwordx4 v8,s[32:35],s64 offen nt lds
s_add_u32 s64,s74,8192
s_add_u32 m0,s75,1024
s_nop 0
buffer_load_dwordx4 v9,s[32:35],s64 offen nt lds
s_add_u32 s64,s74,16384
s_add_u32 m0,s75,2048
s_nop 0
buffer_load_dwordx4 v8,s[32:35],s64 offen nt lds
s_add_u32 s64,s74,24576
s_add_u32 m0,s75,3072
s_nop 0
buffer_load_dwordx4 v9,s[32:35],s64 offen nt lds
s_add_u32 s64,s74,32768
s_add_u32 m0,s75,4096
s_nop 0
buffer_load_dwordx4 v8,s[32:35],s64 offen nt lds
s_add_u32 s64,s74,40960
s_add_u32 m0,s75,5120
s_nop 0
buffer_load_dwordx4 v9,s[32:35],s64 offen nt lds
s_add_u32 s64,s74,49152
s_add_u32 m0,s75,6144
s_nop 0
buffer_load_dwordx4 v8,s[32:35],s64 offen nt lds
s_add_u32 s64,s74,57344
s_add_u32 m0,s75,7168
s_nop 0
buffer_load_dwordx4 v9,s[32:35],s64 offen nt lds
s_add_u32 s64,s74,65536
s_add_u32 m0,s75,8192
s_nop 0
buffer_load_dwordx4 v8,s[32:35],s64 offen nt lds
s_add_u32 s64,s74,73728
s_add_u32 m0,s75,9216
s_nop 0
buffer_load_dwordx4 v9,s[32:35],s64 offen nt lds
s_add_u32 s64,s74,81920
s_add_u32 m0,s75,10240
s_nop 0
buffer_load_dwordx4 v8,s[32:35],s64 offen nt lds
s_add_u32 s64,s74,90112
s_add_u32 m0,s75,11264
s_nop 0
buffer_load_dwordx4 v9,s[32:35],s64 offen nt lds
s_add_u32 s64,s74,98304
s_add_u32 m0,s75,12288
s_nop 0
buffer_load_dwordx4 v8,s[32:35],s64 offen nt lds
s_add_u32 s64,s74,106496
s_add_u32 m0,s75,13312
s_nop 0
buffer_load_dwordx4 v9,s[32:35],s64 offen nt lds
s_add_u32 s64,s74,114688
s_add_u32 m0,s75,14336
s_nop 0
buffer_load_dwordx4 v8,s[32:35],s64 offen nt lds
s_add_u32 s64,s74,122880
s_add_u32 m0,s75,15360
s_nop 0
buffer_load_dwordx4 v9,s[32:35],s64 offen nt lds
s_add_u32 s64,s74,524288
s_add_u32 m0,s75,65536
s_nop 0
buffer_load_dwordx4 v8,s[32:35],s64 offen nt lds
s_add_u32 s64,s74,532480
s_add_u32 m0,s75,66560
s_nop 0
buffer_load_dwordx4 v9,s[32:35],s64 offen nt lds
s_add_u32 s64,s74,540672
s_add_u32 m0,s75,67584
s_nop 0
buffer_load_dwordx4 v8,s[32:35],s64 offen nt lds
s_add_u32 s64,s74,548864
s_add_u32 m0,s75,68608
s_nop 0
buffer_load_dwordx4 v9,s[32:35],s64 offen nt lds
s_add_u32 s64,s74,557056
s_add_u32 m0,s75,69632
s_nop 0
buffer_load_dwordx4 v8,s[32:35],s64 offen nt lds
s_add_u32 s64,s74,565248
s_add_u32 m0,s75,70656
s_nop 0
buffer_load_dwordx4 v9,s[32:35],s64 offen nt lds
s_add_u32 s64,s74,573440
s_add_u32 m0,s75,71680
s_nop 0
buffer_load_dwordx4 v8,s[32:35],s64 offen nt lds
s_add_u32 s64,s74,581632
s_add_u32 m0,s75,72704
s_nop 0
buffer_load_dwordx4 v9,s[32:35],s64 offen nt lds
s_add_u32 s64,s74,589824
s_add_u32 m0,s75,73728
s_nop 0
buffer_load_dwordx4 v8,s[32:35],s64 offen nt lds
s_add_u32 s64,s74,598016
s_add_u32 m0,s75,74752
s_nop 0
buffer_load_dwordx4 v9,s[32:35],s64 offen nt lds
s_add_u32 s64,s74,606208
s_add_u32 m0,s75,75776
s_nop 0
buffer_load_dwordx4 v8,s[32:35],s64 offen nt lds
s_add_u32 s64,s74,614400
s_add_u32 m0,s75,76800
s_nop 0
buffer_load_dwordx4 v9,s[32:35],s64 offen nt lds
s_add_u32 s64,s74,622592
s_add_u32 m0,s75,77824
s_nop 0
buffer_load_dwordx4 v8,s[32:35],s64 offen nt lds
s_add_u32 s64,s74,630784
s_add_u32 m0,s75,78848
s_nop 0
buffer_load_dwordx4 v9,s[32:35],s64 offen nt lds
s_add_u32 s64,s74,638976
s_add_u32 m0,s75,79872
s_nop 0
buffer_load_dwordx4 v8,s[32:35],s64 offen nt lds
s_add_u32 s64,s74,647168
s_add_u32 m0,s75,80896
s_nop 0
buffer_load_dwordx4 v9,s[32:35],s64 offen nt lds
s_waitcnt vmcnt(16)
s_barrier
ds_read_b64_tr_b16 a[0:1],v12 offset:0
ds_read_b64_tr_b16 a[112:113],v13 offset:0
ds_read_b64_tr_b16 a[2:3],v12 offset:4096
ds_read_b64_tr_b16 a[114:115],v13 offset:4096
ds_read_b64_tr_b16 a[4:5],v12 offset:8192
ds_read_b64_tr_b16 a[116:117],v13 offset:8192
ds_read_b64_tr_b16 a[6:7],v12 offset:12288
ds_read_b64_tr_b16 a[118:119],v13 offset:12288
s_waitcnt lgkmcnt(4)
ds_read_b64_tr_b16 a[8:9],v12 offset:16384
ds_read_b64_tr_b16 a[120:121],v13 offset:16384
ds_read_b64_tr_b16 a[10:11],v12 offset:20480
ds_read_b64_tr_b16 a[122:123],v13 offset:20480
ds_read_b64_tr_b16 a[12:13],v12 offset:28672
ds_read_b64_tr_b16 a[124:125],v13 offset:28672
ds_read_b64_tr_b16 a[14:15],v12 offset:32768
ds_read_b64_tr_b16 a[126:127],v13 offset:32768
s_waitcnt lgkmcnt(4)
ds_read_b64_tr_b16 a[16:17],v12 offset:36864
ds_read_b64_tr_b16 a[128:129],v13 offset:36864
ds_read_b64_tr_b16 a[18:19],v12 offset:40960
ds_read_b64_tr_b16 a[130:131],v13 offset:40960
ds_read_b64_tr_b16 a[20:21],v12 offset:45056
ds_read_b64_tr_b16 a[132:133],v13 offset:45056
ds_read_b64_tr_b16 a[22:23],v12 offset:49152
ds_read_b64_tr_b16 a[134:135],v13 offset:49152
s_waitcnt lgkmcnt(4)
ds_read_b64_tr_b16 a[24:25],v12 offset:57344
ds_read_b64_tr_b16 a[136:137],v13 offset:57344
ds_read_b64_tr_b16 a[26:27],v12 offset:61440
ds_read_b64_tr_b16 a[138:139],v13 offset:61440
ds_read_b64_tr_b16 a[96:97],v12 offset:24576
ds_read_b64_tr_b16 a[208:209],v13 offset:24576
ds_read_b64_tr_b16 a[98:99],v12 offset:53248
ds_read_b64_tr_b16 a[210:211],v13 offset:53248
s_waitcnt lgkmcnt(4)
v_xor_b32 v12,0x10000,v12
v_xor_b32 v13,0x10000,v13
s_waitcnt lgkmcnt(0)
s_barrier
s_add_u32 s64,s74,1048576
s_add_u32 m0,s75,0
s_nop 0
buffer_load_dwordx4 v8,s[32:35],s64 offen nt lds
s_add_u32 s64,s74,1056768
s_add_u32 m0,s75,1024
s_nop 0
buffer_load_dwordx4 v9,s[32:35],s64 offen nt lds
s_add_u32 s64,s74,1064960
s_add_u32 m0,s75,2048
s_nop 0
buffer_load_dwordx4 v8,s[32:35],s64 offen nt lds
s_add_u32 s64,s74,1073152
s_add_u32 m0,s75,3072
s_nop 0
buffer_load_dwordx4 v9,s[32:35],s64 offen nt lds
s_add_u32 s64,s74,1081344
s_add_u32 m0,s75,4096
s_nop 0
buffer_load_dwordx4 v8,s[32:35],s64 offen nt lds
s_add_u32 s64,s74,1089536
s_add_u32 m0,s75,5120
s_nop 0
buffer_load_dwordx4 v9,s[32:35],s64 offen nt lds
s_add_u32 s64,s74,1097728
s_add_u32 m0,s75,6144
s_nop 0
buffer_load_dwordx4 v8,s[32:35],s64 offen nt lds
s_add_u32 s64,s74,1105920
s_add_u32 m0,s75,7168
s_nop 0
buffer_load_dwordx4 v9,s[32:35],s64 offen nt lds
s_add_u32 s64,s74,1114112
s_add_u32 m0,s75,8192
s_nop 0
buffer_load_dwordx4 v8,s[32:35],s64 offen nt lds
s_add_u32 s64,s74,1122304
s_add_u32 m0,s75,9216
s_nop 0
buffer_load_dwordx4 v9,s[32:35],s64 offen nt lds
s_add_u32 s64,s74,1130496
s_add_u32 m0,s75,10240
s_nop 0
buffer_load_dwordx4 v8,s[32:35],s64 offen nt lds
s_add_u32 s64,s74,1138688
s_add_u32 m0,s75,11264
s_nop 0
buffer_load_dwordx4 v9,s[32:35],s64 offen nt lds
s_add_u32 s64,s74,1146880
s_add_u32 m0,s75,12288
s_nop 0
buffer_load_dwordx4 v8,s[32:35],s64 offen nt lds
s_add_u32 s64,s74,1155072
s_add_u32 m0,s75,13312
s_nop 0
buffer_load_dwordx4 v9,s[32:35],s64 offen nt lds
s_add_u32 s64,s74,1163264
s_add_u32 m0,s75,14336
s_nop 0
buffer_load_dwordx4 v8,s[32:35],s64 offen nt lds
s_add_u32 s64,s74,1171456
s_add_u32 m0,s75,15360
s_nop 0
buffer_load_dwordx4 v9,s[32:35],s64 offen nt lds
s_waitcnt vmcnt(16)
s_barrier
ds_read_b64_tr_b16 a[28:29],v12 offset:0
ds_read_b64_tr_b16 a[140:141],v13 offset:0
ds_read_b64_tr_b16 a[30:31],v12 offset:4096
ds_read_b64_tr_b16 a[142:143],v13 offset:4096
ds_read_b64_tr_b16 a[32:33],v12 offset:8192
ds_read_b64_tr_b16 a[144:145],v13 offset:8192
ds_read_b64_tr_b16 a[34:35],v12 offset:12288
ds_read_b64_tr_b16 a[146:147],v13 offset:12288
s_waitcnt lgkmcnt(4)
ds_read_b64_tr_b16 a[36:37],v12 offset:20480
ds_read_b64_tr_b16 a[148:149],v13 offset:20480
ds_read_b64_tr_b16 a[38:39],v12 offset:24576
ds_read_b64_tr_b16 a[150:151],v13 offset:24576
ds_read_b64_tr_b16 a[40:41],v12 offset:28672
ds_read_b64_tr_b16 a[152:153],v13 offset:28672
ds_read_b64_tr_b16 a[42:43],v12 offset:32768
ds_read_b64_tr_b16 a[154:155],v13 offset:32768
s_waitcnt lgkmcnt(4)
ds_read_b64_tr_b16 a[44:45],v12 offset:36864
ds_read_b64_tr_b16 a[156:157],v13 offset:36864
ds_read_b64_tr_b16 a[46:47],v12 offset:40960
ds_read_b64_tr_b16 a[158:159],v13 offset:40960
ds_read_b64_tr_b16 a[48:49],v12 offset:49152
ds_read_b64_tr_b16 a[160:161],v13 offset:49152
ds_read_b64_tr_b16 a[50:51],v12 offset:53248
ds_read_b64_tr_b16 a[162:163],v13 offset:53248
s_waitcnt lgkmcnt(4)
ds_read_b64_tr_b16 a[52:53],v12 offset:57344
ds_read_b64_tr_b16 a[164:165],v13 offset:57344
ds_read_b64_tr_b16 a[54:55],v12 offset:61440
ds_read_b64_tr_b16 a[166:167],v13 offset:61440
ds_read_b64_tr_b16 a[100:101],v12 offset:16384
ds_read_b64_tr_b16 a[212:213],v13 offset:16384
ds_read_b64_tr_b16 a[102:103],v12 offset:45056
ds_read_b64_tr_b16 a[214:215],v13 offset:45056
s_waitcnt lgkmcnt(4)
v_xor_b32 v12,0x10000,v12
v_xor_b32 v13,0x10000,v13
s_waitcnt lgkmcnt(0)
s_barrier
s_add_u32 s64,s76,1572864
s_add_u32 m0,s77,65536
s_nop 0
buffer_load_dwordx4 v8,s[32:35],s64 offen nt lds
s_add_u32 s64,s76,1581056
s_add_u32 m0,s77,66560
s_nop 0
buffer_load_dwordx4 v9,s[32:35],s64 offen nt lds
s_add_u32 s64,s76,1589248
s_add_u32 m0,s77,67584
s_nop 0
buffer_load_dwordx4 v8,s[32:35],s64 offen nt lds
s_add_u32 s64,s76,1597440
s_add_u32 m0,s77,68608
s_nop 0
buffer_load_dwordx4 v9,s[32:35],s64 offen nt lds
s_add_u32 s64,s76,1605632
s_add_u32 m0,s77,69632
s_nop 0
buffer_load_dwordx4 v8,s[32:35],s64 offen nt lds
s_add_u32 s64,s76,1613824
s_add_u32 m0,s77,70656
s_nop 0
buffer_load_dwordx4 v9,s[32:35],s64 offen nt lds
s_add_u32 s64,s76,1622016
s_add_u32 m0,s77,71680
s_nop 0
buffer_load_dwordx4 v8,s[32:35],s64 offen nt lds
s_add_u32 s64,s76,1630208
s_add_u32 m0,s77,72704
s_nop 0
buffer_load_dwordx4 v9,s[32:35],s64 offen nt lds
s_waitcnt vmcnt(8)
s_barrier
ds_read_b64_tr_b16 a[56:57],v12 offset:0
ds_read_b64_tr_b16 a[168:169],v13 offset:0
ds_read_b64_tr_b16 a[58:59],v12 offset:4096
ds_read_b64_tr_b16 a[170:171],v13 offset:4096
ds_read_b64_tr_b16 a[60:61],v12 offset:12288
ds_read_b64_tr_b16 a[172:173],v13 offset:12288
ds_read_b64_tr_b16 a[62:63],v12 offset:16384
ds_read_b64_tr_b16 a[174:175],v13 offset:16384
s_waitcnt lgkmcnt(4)
ds_read_b64_tr_b16 a[64:65],v12 offset:20480
ds_read_b64_tr_b16 a[176:177],v13 offset:20480
ds_read_b64_tr_b16 a[66:67],v12 offset:24576
ds_read_b64_tr_b16 a[178:179],v13 offset:24576
ds_read_b64_tr_b16 a[68:69],v12 offset:28672
ds_read_b64_tr_b16 a[180:181],v13 offset:28672
ds_read_b64_tr_b16 a[70:71],v12 offset:32768
ds_read_b64_tr_b16 a[182:183],v13 offset:32768
s_waitcnt lgkmcnt(4)
ds_read_b64_tr_b16 a[72:73],v12 offset:40960
ds_read_b64_tr_b16 a[184:185],v13 offset:40960
ds_read_b64_tr_b16 a[74:75],v12 offset:45056
ds_read_b64_tr_b16 a[186:187],v13 offset:45056
ds_read_b64_tr_b16 a[76:77],v12 offset:49152
ds_read_b64_tr_b16 a[188:189],v13 offset:49152
ds_read_b64_tr_b16 a[78:79],v12 offset:53248
ds_read_b64_tr_b16 a[190:191],v13 offset:53248
s_waitcnt lgkmcnt(4)
ds_read_b64_tr_b16 a[80:81],v12 offset:57344
ds_read_b64_tr_b16 a[192:193],v13 offset:57344
ds_read_b64_tr_b16 a[82:83],v12 offset:61440
ds_read_b64_tr_b16 a[194:195],v13 offset:61440
ds_read_b64_tr_b16 a[104:105],v12 offset:8192
ds_read_b64_tr_b16 a[216:217],v13 offset:8192
ds_read_b64_tr_b16 a[106:107],v12 offset:36864
ds_read_b64_tr_b16 a[218:219],v13 offset:36864
s_waitcnt lgkmcnt(4)
v_xor_b32 v12,0x10000,v12
v_xor_b32 v13,0x10000,v13
s_waitcnt lgkmcnt(0)
s_barrier
s_waitcnt vmcnt(0)
s_barrier
ds_read_b64_tr_b16 a[84:85],v12 offset:4096
ds_read_b64_tr_b16 a[196:197],v13 offset:4096
ds_read_b64_tr_b16 a[86:87],v12 offset:8192
ds_read_b64_tr_b16 a[198:199],v13 offset:8192
ds_read_b64_tr_b16 a[88:89],v12 offset:12288
ds_read_b64_tr_b16 a[200:201],v13 offset:12288
ds_read_b64_tr_b16 a[90:91],v12 offset:16384
ds_read_b64_tr_b16 a[202:203],v13 offset:16384
s_waitcnt lgkmcnt(4)
ds_read_b64_tr_b16 a[92:93],v12 offset:20480
ds_read_b64_tr_b16 a[204:205],v13 offset:20480
ds_read_b64_tr_b16 a[94:95],v12 offset:24576
ds_read_b64_tr_b16 a[206:207],v13 offset:24576
ds_read_b64_tr_b16 a[108:109],v12 offset:0
ds_read_b64_tr_b16 a[220:221],v13 offset:0
ds_read_b64_tr_b16 a[110:111],v12 offset:28672
ds_read_b64_tr_b16 a[222:223],v13 offset:28672
s_waitcnt lgkmcnt(4)
v_xor_b32 v12,0x10000,v12
v_xor_b32 v13,0x10000,v13
s_waitcnt lgkmcnt(0)
s_barrier
v_and_b32 v21,1,v1
v_mul_u32_u24 v21,960,v21
s_mov_b32 s65,21052032
s_mov_b32 s66,1792
pl_323:
buffer_load_dword v22,v21,s[20:23],s65 offen sc1
s_waitcnt vmcnt(0)
v_cmp_gt_u32 vcc,s66,v22
s_cbranch_vccz pok_324
s_sleep 1
s_sub_u32 s90,s90,1
s_cmp_gt_i32 s90,0
s_cbranch_scc1 pl_323
pok_324:
s_lshr_b32 s43,s41,1
s_and_b32 s48,s41,1
s_lshl_b32 s64,s42,7
s_lshl_b32 s65,s50,5
s_add_u32 s64,s64,s65
s_lshl_b32 s65,s48,4
s_add_u32 s64,s64,s65
v_lshl_add_u32 v5,v4,2,s64
v_lshlrev_b32 v6,2,v5
s_mov_b32 s64,20480
buffer_load_dwordx4 v[52:55],v6,s[20:23],s64 offen sc1
v_lshlrev_b32 v10,1,v5
v_and_b32 v6,3,v1
v_sub_u32 v5,v6,v4
v_lshl_add_u32 v5,v5,3,v10
v_lshrrev_b32 v11,2,v1
v_lshl_add_u32 v40,v6,4,v11
v_lshlrev_b32 v40,2,v40
v_lshl_add_u32 v41,v3,2,v4
v_lshlrev_b32 v41,2,v41
s_lshl_b32 s64,s43,10
v_add_u32 v17,s64,v16
v_xor_b32 v18,1024,v17
s_xor_b32 s64,s64,1024
s_lshr_b32 s65,s50,1
s_and_b32 s66,s50,1
s_lshl_b32 s66,s66,12
s_add_u32 s66,s66,s64
s_lshl_b32 s72,s65,13
s_add_u32 s72,s72,s66
s_add_u32 s72,s72,0x10000
s_lshl_b32 s65,s65,14
s_add_u32 s75,s65,s66
s_add_u32 s75,s75,1327104
s_mul_i32 s64,s41,114688
s_add_u32 s75,s75,s64
s_cmp_lt_u32 s50,2
s_cselect_b32 s86,98304,0x40000000
s_lshl_b32 s76,s79,21
s_add_u32 s76,s76,27262976
s_mov_b32 s77,0
s_lshl_b32 s78,s79,16
s_mov_b32 s49,0
s_cmp_eq_u32 s79,0
s_mov_b32 s66,8577024
s_cselect_b32 s66,18874368,s66
s_lshl_b32 s64,s59,14
s_lshl_b32 s65,s50,12
s_add_u32 s65,s65,s66
s_add_u32 s64,s64,s65
v_add_u32 v26,s64,v16
s_lshl_b32 s64,s42,14
s_add_u32 s64,s64,s65
v_add_u32 v25,s64,v16
s_xor_b32 s33,s41,1
s_xor_b32 s34,s41,2
s_xor_b32 s35,s41,3
s_lshl_b32 s33,s33,17
s_lshl_b32 s34,s34,17
s_lshl_b32 s35,s35,17
v_and_b32 v21,7,v1
v_lshlrev_b32 v21,7,v21
v_bfe_u32 v6,v1,3,2
v_lshl_add_u32 v21,v6,2,v21
s_lshl_b32 s74,s41,10
s_add_u32 s74,s74,s63
s_lshl_b32 s64,s60,4
s_add_u32 s74,s74,s64
s_add_u32 s74,s74,20480
s_lshl_b32 s64,s43,4
v_add_u32 v6,s64,v11
v_lshl_add_u32 v19,v6,11,v5
v_add_u32 v6,s64,v11
v_add_u32 v6,30,v6
v_lshl_add_u32 v9,v6,7,v5
v_and_b32 v9,2047,v9
v_and_b32 v7,3,v6
v_lshl_add_u32 v7,v7,11,v9
v_bfe_u32 v8,v6,2,3
v_lshl_add_u32 v7,v8,14,v7
v_mov_b32 v8,0x2000
v_mov_b32 v9,2097152
v_cmp_gt_u32 vcc,32,v6
s_nop 1
v_cndmask_b32 v8,v9,v8,vcc
v_add_u32 v7,v7,v8
v_add_u32 v7,1048576,v7
v_xor_b32 v20,s62,v7
s_lshl_b32 s64,s42,14
s_lshl_b32 s65,s50,11
s_add_u32 s64,s64,s65
s_lshl_b32 s65,s43,10
s_add_u32 s64,s64,s65
s_lshl_b32 s65,s48,3
s_add_u32 s64,s64,s65
s_add_u32 s64,s64,1179648
v_add_u32 v24,s64,v16
s_mov_b32 s84,0xffffff00
s_or_b32 s64,s43,s79
s_cselect_b32 s84,-1,s84
s_mov_b32 s85,-1
s_mov_b32 s48,1
s_waitcnt vmcnt(0)
s_cmp_lg_u32 s56,0
s_cbranch_scc1 kslow_325
s_add_u32 s64,s79,0
s_lshl_b32 s70,s64,21
s_lshl_b32 s64,s64,13
s_and_b32 s64,s64,0x2000
s_xor_b32 s64,s64,s62
s_add_u32 s70,s70,s64
s_add_u32 s70,s70,29360128
s_mov_b32 s83,1
s_mov_b32 s87,s74
s_cmp_eq_u32 s50,0
s_cselect_b32 s74,s74,0x7fff0000
v_mov_b32 v47,132096
s_lshl_b32 s64,s50,3
s_add_u32 s64,s64,132096
v_mov_b32 v46,s64
v_mov_b32 v29,0
s_mov_b32 s97,0x7fff0000
s_mov_b32 s69,1
s_mov_b32 s68,0
s_mov_b32 s52,0x30003
s_mov_b32 s53,s52
seg_327:
s_cmp_eq_u32 s83,0
s_cbranch_scc1 ahead_328
s_add_u32 s94,s70,s75
s_xor_b32 s95,s94,1024
s_xor_b32 s91,s72,0x10000
s_cmp_eq_u32 s69,0
s_mov_b32 s69,1
s_cbranch_scc1 half2_332
s_waitcnt vmcnt(1)
v_cmp_gt_u32 vcc,s71,v29
s_cbranch_vccz nb_331
s_cmp_lg_u32 s50,0
s_cbranch_scc1 nb_331
buffer_load_dword v32,v21,s[20:23],s74 offen sc1
s_sleep 2
pl_333:
buffer_load_dword v33,v21,s[20:23],s74 offen sc1
s_waitcnt vmcnt(1)
v_cmp_gt_u32 vcc,s71,v32
v_mov_b32 v29,v32
s_cbranch_vccz pok_334
buffer_load_dword v32,v21,s[20:23],s74 offen sc1
s_waitcnt vmcnt(1)
v_cmp_gt_u32 vcc,s71,v33
v_mov_b32 v29,v33
s_cbranch_vccz pok_334
s_sub_u32 s90,s90,1
s_cmp_gt_i32 s90,0
s_cbranch_scc1 pl_333
pok_334:
nb_331:
s_cmp_eq_u32 s71,64
s_barrier
s_cbranch_scc1 half_335
s_xor_b32 m0,s91,0
s_add_u32 s65,s94,0
buffer_load_dwordx4 v16,s[20:23],s65 offen offset:0 sc1 lds
buffer_load_dwordx4 v16,s[20:23],s65 offen offset:2048 sc1 lds
s_xor_b32 m0,s91,16384
s_add_u32 s65,s94,32768
buffer_load_dwordx4 v16,s[20:23],s65 offen offset:0 sc1 lds
buffer_load_dwordx4 v16,s[20:23],s65 offen offset:2048 sc1 lds
s_xor_b32 m0,s91,32768
s_add_u32 s65,s94,65536
buffer_load_dwordx4 v16,s[20:23],s65 offen offset:0 sc1 lds
buffer_load_dwordx4 v16,s[20:23],s65 offen offset:2048 sc1 lds
s_xor_b32 m0,s91,49152
s_add_u32 s65,s94,s86
buffer_load_dwordx4 v16,s[20:23],s65 offen offset:0 sc1 lds
buffer_load_dwordx4 v16,s[20:23],s65 offen offset:2048 sc1 lds
s_waitcnt vmcnt(6)
s_barrier
ds_read_b128 v[224:227],v18 offset:0
ds_read_b128 v[228:231],v18 offset:2048
ds_read_b128 v[232:235],v18 offset:4096
ds_read_b128 v[236:239],v18 offset:6144
ds_read_b128 v[240:243],v18 offset:8192
ds_read_b128 v[244:247],v18 offset:10240
ds_read_b128 v[248:251],v18 offset:12288
s_waitcnt lgkmcnt(5)
v_mfma_f32_16x16x32_bf16 v[64:67],a[0:3],v[224:227],0
s_xor_b32 m0,s91,1024
s_add_u32 s96,s71,1
s_add_u32 s92,s71,2
v_min_u32 v27,v224,v228
v_mfma_f32_16x16x32_bf16 v[68:71],a[112:115],v[224:227],0
ds_read_b128 v[252:255],v18 offset:14336
s_cmp_eq_u32 s96,64
s_cselect_b32 s96,99,s96
v_mfma_f32_16x16x32_bf16 v[64:67],a[4:7],v[228:231],v[64:67]
s_add_u32 s65,s95,0
s_cmp_eq_u32 s92,64
s_cselect_b32 s92,99,s92
v_mfma_f32_16x16x32_bf16 v[68:71],a[116:119],v[228:231],v[68:71]
s_waitcnt vmcnt(4)
s_barrier
ds_read_b128 v[224:227],v18 offset:16384
s_waitcnt lgkmcnt(5)
v_mfma_f32_16x16x32_bf16 v[64:67],a[8:11],v[232:235],v[64:67]
buffer_load_dwordx4 v16,s[20:23],s65 offen offset:0 sc1 lds
v_mfma_f32_16x16x32_bf16 v[68:71],a[120:123],v[232:235],v[68:71]
ds_read_b128 v[228:231],v18 offset:18432
v_min3_u32 v27,v27,v232,v236
v_mfma_f32_16x16x32_bf16 v[64:67],a[12:15],v[236:239],v[64:67]
buffer_load_dwordx4 v16,s[20:23],s65 offen offset:2048 sc1 lds
v_mfma_f32_16x16x32_bf16 v[68:71],a[124:127],v[236:239],v[68:71]
ds_read_b128 v[232:235],v18 offset:20480
s_waitcnt lgkmcnt(5)
v_mfma_f32_16x16x32_bf16 v[64:67],a[16:19],v[240:243],v[64:67]
s_xor_b32 m0,s91,17408
v_min3_u32 v27,v27,v240,v244
v_mfma_f32_16x16x32_bf16 v[68:71],a[128:131],v[240:243],v[68:71]
ds_read_b128 v[236:239],v18 offset:22528
v_mfma_f32_16x16x32_bf16 v[64:67],a[20:23],v[244:247],v[64:67]
s_add_u32 s65,s95,32768
s_waitcnt vmcnt(63)
v_mfma_f32_16x16x32_bf16 v[68:71],a[132:135],v[244:247],v[68:71]
ds_read_b128 v[240:243],v18 offset:24576
s_waitcnt lgkmcnt(5)
v_mfma_f32_16x16x32_bf16 v[64:67],a[24:27],v[248:251],v[64:67]
buffer_load_dwordx4 v16,s[20:23],s65 offen offset:0 sc1 lds
v_min3_u32 v27,v27,v248,v252
v_mfma_f32_16x16x32_bf16 v[68:71],a[136:139],v[248:251],v[68:71]
ds_read_b128 v[244:247],v18 offset:26624
v_cmp_gt_u32 vcc,s96,v29
v_cmp_gt_u32 s[92:93],s92,v29
v_mfma_f32_16x16x32_bf16 v[64:67],a[28:31],v[252:255],v[64:67]
buffer_load_dwordx4 v16,s[20:23],s65 offen offset:2048 sc1 lds
v_mfma_f32_16x16x32_bf16 v[68:71],a[140:143],v[252:255],v[68:71]
ds_read_b128 v[248:251],v18 offset:28672
s_waitcnt lgkmcnt(5)
v_mfma_f32_16x16x32_bf16 v[64:67],a[32:35],v[224:227],v[64:67]
s_xor_b32 m0,s91,33792
v_mov_b32 v44,vcc_lo
v_mov_b32 v45,s92
v_mfma_f32_16x16x32_bf16 v[68:71],a[144:147],v[224:227],v[68:71]
ds_read_b128 v[252:255],v18 offset:30720
ds_write_b64 v46,v[44:45]
v_mfma_f32_16x16x32_bf16 v[64:67],a[36:39],v[228:231],v[64:67]
s_add_u32 s65,s95,65536
v_min3_u32 v27,v27,v224,v228
v_mfma_f32_16x16x32_bf16 v[68:71],a[148:151],v[228:231],v[68:71]
s_waitcnt vmcnt(4)
s_barrier
ds_read_b128 v[224:227],v18 offset:32768
s_waitcnt lgkmcnt(6)
v_mfma_f32_16x16x32_bf16 v[64:67],a[40:43],v[232:235],v[64:67]
buffer_load_dwordx4 v16,s[20:23],s65 offen offset:0 sc1 lds
s_add_u32 s88,s70,s75
v_mfma_f32_16x16x32_bf16 v[68:71],a[152:155],v[232:235],v[68:71]
ds_read_b128 v[228:231],v18 offset:34816
v_min3_u32 v27,v27,v232,v236
s_add_u32 s88,s88,2097152
v_mfma_f32_16x16x32_bf16 v[64:67],a[44:47],v[236:239],v[64:67]
buffer_load_dwordx4 v16,s[20:23],s65 offen offset:2048 sc1 lds
v_mfma_f32_16x16x32_bf16 v[68:71],a[156:159],v[236:239],v[68:71]
ds_read_b128 v[232:235],v18 offset:36864
s_waitcnt lgkmcnt(6)
v_mfma_f32_16x16x32_bf16 v[64:67],a[48:51],v[240:243],v[64:67]
s_xor_b32 m0,s91,50176
v_min3_u32 v27,v27,v240,v244
v_mfma_f32_16x16x32_bf16 v[68:71],a[160:163],v[240:243],v[68:71]
ds_read_b128 v[236:239],v18 offset:38912
s_xor_b32 s88,s88,0x2000
v_mfma_f32_16x16x32_bf16 v[64:67],a[52:55],v[244:247],v[64:67]
s_add_u32 s65,s95,s86
s_xor_b32 s89,s88,1024
v_mfma_f32_16x16x32_bf16 v[68:71],a[164:167],v[244:247],v[68:71]
ds_read_b128 v[240:243],v18 offset:40960
s_waitcnt lgkmcnt(6)
v_mfma_f32_16x16x32_bf16 v[64:67],a[56:59],v[248:251],v[64:67]
buffer_load_dwordx4 v16,s[20:23],s65 offen offset:0 sc1 lds
v_mfma_f32_16x16x32_bf16 v[68:71],a[168:171],v[248:251],v[68:71]
ds_read_b128 v[244:247],v18 offset:43008
v_min3_u32 v27,v27,v248,v252
v_mfma_f32_16x16x32_bf16 v[64:67],a[60:63],v[252:255],v[64:67]
buffer_load_dwordx4 v16,s[20:23],s65 offen offset:2048 sc1 lds
v_mfma_f32_16x16x32_bf16 v[68:71],a[172:175],v[252:255],v[68:71]
ds_read_b128 v[248:251],v18 offset:45056
s_waitcnt lgkmcnt(5)
v_mfma_f32_16x16x32_bf16 v[64:67],a[64:67],v[224:227],v[64:67]
s_waitcnt vmcnt(4)
s_barrier
ds_read_b64 v[44:45],v47
ds_read_b128 v[128:131],v17 offset:0
ds_read_b128 v[132:135],v17 offset:2048
v_mfma_f32_16x16x32_bf16 v[68:71],a[176:179],v[224:227],v[68:71]
ds_read_b128 v[252:255],v18 offset:47104
v_min3_u32 v27,v27,v224,v228
v_mfma_f32_16x16x32_bf16 v[64:67],a[68:71],v[228:231],v[64:67]
ds_read_b128 v[136:139],v17 offset:4096
buffer_load_dwordx2 v[120:121],v20,s[20:23],s76 offen sc1
v_mfma_f32_16x16x32_bf16 v[68:71],a[180:183],v[228:231],v[68:71]
ds_read_b128 v[224:227],v18 offset:49152
s_waitcnt lgkmcnt(9)
v_mfma_f32_16x16x32_bf16 v[64:67],a[72:75],v[232:235],v[64:67]
ds_read_b128 v[140:143],v17 offset:6144
v_min3_u32 v27,v27,v232,v236
v_mfma_f32_16x16x32_bf16 v[68:71],a[184:187],v[232:235],v[68:71]
ds_read_b128 v[228:231],v18 offset:51200
buffer_load_dwordx2 v[122:123],v24,s[20:23],s70 offen sc1
v_mfma_f32_16x16x32_bf16 v[64:67],a[76:79],v[236:239],v[64:67]
ds_read_b128 v[144:147],v17 offset:8192
ds_read_b128 v[148:151],v17 offset:10240
v_mfma_f32_16x16x32_bf16 v[68:71],a[188:191],v[236:239],v[68:71]
ds_read_b128 v[232:235],v18 offset:53248
s_waitcnt lgkmcnt(12)
v_mfma_f32_16x16x32_bf16 v[64:67],a[80:83],v[240:243],v[64:67]
ds_read_b128 v[152:155],v17 offset:12288
s_waitcnt lgkmcnt(11)
v_min3_u32 v27,v27,v240,v244
v_mfma_f32_16x16x32_bf16 v[68:71],a[192:195],v[240:243],v[68:71]
ds_read_b128 v[236:239],v18 offset:55296
v_readfirstlane_b32 s93,v45
v_mfma_f32_16x16x32_bf16 v[64:67],a[84:87],v[244:247],v[64:67]
ds_read_b128 v[156:159],v17 offset:14336
v_readfirstlane_b32 s83,v44
s_cmp_lg_u32 s83,0
s_cbranch_scc0 keep_337
v_mfma_f32_16x16x32_bf16 v[68:71],a[196:199],v[244:247],v[68:71]
s_waitcnt lgkmcnt(10)
v_mfma_f32_16x16x32_bf16 v[64:67],a[88:91],v[248:251],v[64:67]
ds_read_b128 v[160:163],v17 offset:16384
ds_read_b128 v[164:167],v17 offset:18432
v_mfma_f32_16x16x32_bf16 v[68:71],a[200:203],v[248:251],v[68:71]
v_min3_u32 v27,v27,v248,v252
v_mfma_f32_16x16x32_bf16 v[64:67],a[92:95],v[252:255],v[64:67]
ds_read_b128 v[168:171],v17 offset:20480
v_mfma_f32_16x16x32_bf16 v[68:71],a[204:207],v[252:255],v[68:71]
s_waitcnt lgkmcnt(9)
v_mfma_f32_16x16x32_bf16 v[64:67],a[96:99],v[224:227],v[64:67]
ds_read_b128 v[172:175],v17 offset:22528
v_min3_u32 v27,v27,v224,v228
v_mfma_f32_16x16x32_bf16 v[68:71],a[208:211],v[224:227],v[68:71]
v_min3_u32 v27,v27,v226,v230
v_mfma_f32_16x16x32_bf16 v[64:67],a[100:103],v[228:231],v[64:67]
ds_read_b128 v[176:179],v17 offset:24576
ds_read_b128 v[180:183],v17 offset:26624
v_mfma_f32_16x16x32_bf16 v[68:71],a[212:215],v[228:231],v[68:71]
s_waitcnt lgkmcnt(7)
v_mfma_f32_16x16x32_bf16 v[64:67],a[104:107],v[232:235],v[64:67]
ds_read_b128 v[184:187],v17 offset:28672
v_min3_u32 v27,v27,v232,v236
v_mfma_f32_16x16x32_bf16 v[68:71],a[216:219],v[232:235],v[68:71]
v_min3_u32 v27,v27,v234,v238
v_mfma_f32_16x16x32_bf16 v[64:67],a[108:111],v[236:239],v[64:67]
ds_read_b128 v[188:191],v17 offset:30720
v_mfma_f32_16x16x32_bf16 v[68:71],a[220:223],v[236:239],v[68:71]
v_mfma_f32_16x16x32_bf16 v[72:75],a[112:115],v[128:131],0
v_cmp_eq_u32 vcc,0,v27
s_cbranch_vccnz retry_326
v_mfma_f32_16x16x32_bf16 v[76:79],a[116:119],v[132:135],0
v_min3_u32 v27,v27,v128,v132
v_mfma_f32_16x16x32_bf16 v[72:75],a[120:123],v[136:139],v[72:75]
s_waitcnt vmcnt(2)
s_barrier
ds_read_b128 v[192:195],v17 offset:32768
v_mfma_f32_16x16x32_bf16 v[76:79],a[124:127],v[140:143],v[76:79]
ds_read_b128 v[196:199],v17 offset:34816
s_waitcnt lgkmcnt(10)
v_mfma_f32_16x16x32_bf16 v[72:75],a[128:131],v[144:147],v[72:75]
ds_read_b128 v[200:203],v17 offset:36864
v_min3_u32 v27,v27,v136,v140
s_waitcnt vmcnt(0)
v_mfma_f32_16x16x32_bf16 v[76:79],a[132:135],v[148:151],v[76:79]
ds_read_b128 v[204:207],v17 offset:38912
v_min3_u32 v27,v27,v144,v148
v_and_or_b32 v64,v64,-4,s48
v_mfma_f32_16x16x32_bf16 v[72:75],a[136:139],v[152:155],v[72:75]
ds_read_b128 v[208:211],v17 offset:40960
s_add_u32 s64,s49,s34
v_mfma_f32_16x16x32_bf16 v[76:79],a[140:143],v[156:159],v[76:79]
v_min3_u32 v27,v27,v152,v156
s_waitcnt lgkmcnt(9)
v_mfma_f32_16x16x32_bf16 v[72:75],a[144:147],v[160:163],v[72:75]
ds_read_b128 v[212:215],v17 offset:43008
buffer_store_dwordx4 v[64:67],v25,s[20:23],s64 offen offset:2048
v_mfma_f32_16x16x32_bf16 v[76:79],a[148:151],v[164:167],v[76:79]
ds_read_b128 v[216:219],v17 offset:45056
v_min3_u32 v27,v27,v160,v164
v_and_or_b32 v68,v68,-4,s48
v_mfma_f32_16x16x32_bf16 v[72:75],a[152:155],v[168:171],v[72:75]
ds_read_b128 v[220:223],v17 offset:47104
s_add_u32 s64,s49,s35
v_mfma_f32_16x16x32_bf16 v[76:79],a[156:159],v[172:175],v[76:79]
ds_read_b128 v[224:227],v17 offset:49152
s_waitcnt lgkmcnt(9)
v_mfma_f32_16x16x32_bf16 v[72:75],a[160:163],v[176:179],v[72:75]
ds_read_b128 v[228:231],v17 offset:51200
v_min3_u32 v27,v27,v168,v172
v_mfma_f32_16x16x32_bf16 v[76:79],a[164:167],v[180:183],v[76:79]
v_min3_u32 v27,v27,v176,v180
buffer_store_dwordx4 v[68:71],v25,s[20:23],s64 offen offset:3072
v_mfma_f32_16x16x32_bf16 v[72:75],a[168:171],v[184:187],v[72:75]
ds_read_b128 v[232:235],v17 offset:53248
s_mov_b32 s49,0x7fff0000
v_mfma_f32_16x16x32_bf16 v[76:79],a[172:175],v[188:191],v[76:79]
ds_read_b128 v[236:239],v17 offset:55296
s_waitcnt lgkmcnt(8)
v_mfma_f32_16x16x32_bf16 v[72:75],a[176:179],v[192:195],v[72:75]
v_min3_u32 v27,v27,v184,v188
v_mfma_f32_16x16x32_bf16 v[76:79],a[180:183],v[196:199],v[76:79]
v_min3_u32 v27,v27,v192,v196
ds_bpermute_b32 v124,v41,v120
v_mfma_f32_16x16x32_bf16 v[72:75],a[184:187],v[200:203],v[72:75]
v_mfma_f32_16x16x32_bf16 v[76:79],a[188:191],v[204:207],v[76:79]
v_min3_u32 v27,v27,v200,v204
s_waitcnt lgkmcnt(5)
v_mfma_f32_16x16x32_bf16 v[72:75],a[192:195],v[208:211],v[72:75]
ds_bpermute_b32 v125,v41,v121
v_mfma_f32_16x16x32_bf16 v[76:79],a[196:199],v[212:215],v[76:79]
v_min3_u32 v27,v27,v208,v212
v_lshlrev_b32 v108,16,v122
v_mfma_f32_16x16x32_bf16 v[72:75],a[200:203],v[216:219],v[72:75]
v_mfma_f32_16x16x32_bf16 v[76:79],a[204:207],v[220:223],v[76:79]
v_min3_u32 v27,v27,v216,v220
s_waitcnt lgkmcnt(2)
v_mfma_f32_16x16x32_bf16 v[72:75],a[208:211],v[224:227],v[72:75]
v_and_b32 v109,s80,v122
v_mfma_f32_16x16x32_bf16 v[76:79],a[212:215],v[228:231],v[76:79]
v_min3_u32 v27,v27,v224,v228
v_min3_u32 v27,v27,v226,v230
v_mfma_f32_16x16x32_bf16 v[72:75],a[216:219],v[232:235],v[72:75]
v_lshlrev_b32 v110,16,v123
v_mfma_f32_16x16x32_bf16 v[76:79],a[220:223],v[236:239],v[76:79]
v_min3_u32 v27,v27,v232,v236
v_min3_u32 v27,v27,v234,v238
v_mfma_f32_16x16x32_bf16 v[80:83],a[0:3],v[128:131],0
v_cmp_eq_u32 vcc,0,v27
s_cbranch_vccnz retry_326
v_mfma_f32_16x16x32_bf16 v[84:87],a[4:7],v[132:135],0
v_and_b32 v111,s80,v123
s_waitcnt lgkmcnt(0)
v_mfma_f32_16x16x32_bf16 v[80:83],a[8:11],v[136:139],v[80:83]
v_mfma_f32_16x16x32_bf16 v[84:87],a[12:15],v[140:143],v[84:87]
v_lshlrev_b32 v104,16,v124
v_mfma_f32_16x16x32_bf16 v[80:83],a[16:19],v[144:147],v[80:83]
v_add_f32 v72,v72,v76
v_add_f32 v73,v73,v77
v_mfma_f32_16x16x32_bf16 v[84:87],a[20:23],v[148:151],v[84:87]
v_and_b32 v105,s80,v124
v_add_f32 v74,v74,v78
v_mfma_f32_16x16x32_bf16 v[80:83],a[24:27],v[152:155],v[80:83]
v_add_f32 v75,v75,v79
v_and_or_b32 v72,v72,-4,s48
v_mfma_f32_16x16x32_bf16 v[84:87],a[28:31],v[156:159],v[84:87]
v_lshlrev_b32 v106,16,v125
s_add_u32 s64,s77,s33
v_mfma_f32_16x16x32_bf16 v[80:83],a[32:35],v[160:163],v[80:83]
buffer_store_dwordx4 v[72:75],v25,s[20:23],s64 offen offset:1024
v_mfma_f32_16x16x32_bf16 v[84:87],a[36:39],v[164:167],v[84:87]
v_and_b32 v107,s80,v125
v_mfma_f32_16x16x32_bf16 v[80:83],a[40:43],v[168:171],v[80:83]
v_mfma_f32_16x16x32_bf16 v[84:87],a[44:47],v[172:175],v[84:87]
v_mfma_f32_16x16x32_bf16 v[80:83],a[48:51],v[176:179],v[80:83]
buffer_load_dwordx4 v[96:99],v26,s[20:23],s77 offen offset:2048 sc1
v_mfma_f32_16x16x32_bf16 v[84:87],a[52:55],v[180:183],v[84:87]
buffer_load_dwordx4 v[100:103],v26,s[20:23],s77 offen offset:3072 sc1
v_mfma_f32_16x16x32_bf16 v[80:83],a[56:59],v[184:187],v[80:83]
v_mfma_f32_16x16x32_bf16 v[84:87],a[60:63],v[188:191],v[84:87]
v_mfma_f32_16x16x32_bf16 v[80:83],a[64:67],v[192:195],v[80:83]
v_mfma_f32_16x16x32_bf16 v[84:87],a[68:71],v[196:199],v[84:87]
v_mfma_f32_16x16x32_bf16 v[80:83],a[72:75],v[200:203],v[80:83]
v_mfma_f32_16x16x32_bf16 v[84:87],a[76:79],v[204:207],v[84:87]
v_mfma_f32_16x16x32_bf16 v[80:83],a[80:83],v[208:211],v[80:83]
v_mfma_f32_16x16x32_bf16 v[84:87],a[84:87],v[212:215],v[84:87]
v_mfma_f32_16x16x32_bf16 v[80:83],a[88:91],v[216:219],v[80:83]
buffer_load_dwordx4 v[92:95],v26,s[20:23],s77 offen offset:1024 sc1
v_mfma_f32_16x16x32_bf16 v[84:87],a[92:95],v[220:223],v[84:87]
v_mfma_f32_16x16x32_bf16 v[80:83],a[96:99],v[224:227],v[80:83]
v_mfma_f32_16x16x32_bf16 v[84:87],a[100:103],v[228:231],v[84:87]
v_mfma_f32_16x16x32_bf16 v[80:83],a[104:107],v[232:235],v[80:83]
v_mfma_f32_16x16x32_bf16 v[84:87],a[108:111],v[236:239],v[84:87]
s_branch epi_329
keep_337:
v_mfma_f32_16x16x32_bf16 v[68:71],a[196:199],v[244:247],v[68:71]
s_xor_b32 m0,s72,0
s_add_u32 s65,s88,0
s_waitcnt lgkmcnt(10)
v_mfma_f32_16x16x32_bf16 v[64:67],a[88:91],v[248:251],v[64:67]
ds_read_b128 v[160:163],v17 offset:16384
ds_read_b128 v[164:167],v17 offset:18432
v_min3_u32 v27,v27,v248,v252
v_mfma_f32_16x16x32_bf16 v[68:71],a[200:203],v[248:251],v[68:71]
buffer_load_dwordx4 v16,s[20:23],s65 offen offset:0 sc1 lds
v_mfma_f32_16x16x32_bf16 v[64:67],a[92:95],v[252:255],v[64:67]
ds_read_b128 v[168:171],v17 offset:20480
buffer_load_dwordx4 v16,s[20:23],s65 offen offset:2048 sc1 lds
v_mfma_f32_16x16x32_bf16 v[68:71],a[204:207],v[252:255],v[68:71]
s_xor_b32 m0,s72,16384
s_add_u32 s65,s88,32768
s_waitcnt lgkmcnt(9)
v_mfma_f32_16x16x32_bf16 v[64:67],a[96:99],v[224:227],v[64:67]
ds_read_b128 v[172:175],v17 offset:22528
buffer_load_dwordx4 v16,s[20:23],s65 offen offset:0 sc1 lds
v_min3_u32 v27,v27,v224,v228
v_mfma_f32_16x16x32_bf16 v[68:71],a[208:211],v[224:227],v[68:71]
buffer_load_dwordx4 v16,s[20:23],s65 offen offset:2048 sc1 lds
v_min3_u32 v27,v27,v226,v230
v_mfma_f32_16x16x32_bf16 v[64:67],a[100:103],v[228:231],v[64:67]
ds_read_b128 v[176:179],v17 offset:24576
ds_read_b128 v[180:183],v17 offset:26624
s_xor_b32 m0,s72,32768
v_mfma_f32_16x16x32_bf16 v[68:71],a[212:215],v[228:231],v[68:71]
s_add_u32 s65,s88,65536
s_waitcnt lgkmcnt(7)
v_mfma_f32_16x16x32_bf16 v[64:67],a[104:107],v[232:235],v[64:67]
ds_read_b128 v[184:187],v17 offset:28672
buffer_load_dwordx4 v16,s[20:23],s65 offen offset:0 sc1 lds
v_mfma_f32_16x16x32_bf16 v[68:71],a[216:219],v[232:235],v[68:71]
buffer_load_dwordx4 v16,s[20:23],s65 offen offset:2048 sc1 lds
v_min3_u32 v27,v27,v232,v236
v_mfma_f32_16x16x32_bf16 v[64:67],a[108:111],v[236:239],v[64:67]
ds_read_b128 v[188:191],v17 offset:30720
s_xor_b32 m0,s72,49152
v_min3_u32 v27,v27,v234,v238
v_mfma_f32_16x16x32_bf16 v[68:71],a[220:223],v[236:239],v[68:71]
s_add_u32 s65,s88,s86
v_mfma_f32_16x16x32_bf16 v[72:75],a[112:115],v[128:131],0
buffer_load_dwordx4 v16,s[20:23],s65 offen offset:0 sc1 lds
v_cmp_eq_u32 vcc,0,v27
s_cbranch_vccnz retry_326
v_mfma_f32_16x16x32_bf16 v[76:79],a[116:119],v[132:135],0
buffer_load_dwordx4 v16,s[20:23],s65 offen offset:2048 sc1 lds
v_mfma_f32_16x16x32_bf16 v[72:75],a[120:123],v[136:139],v[72:75]
s_waitcnt vmcnt(10)
s_barrier
ds_read_b128 v[192:195],v17 offset:32768
v_mfma_f32_16x16x32_bf16 v[76:79],a[124:127],v[140:143],v[76:79]
ds_read_b128 v[196:199],v17 offset:34816
s_xor_b32 m0,s72,1024
s_waitcnt lgkmcnt(10)
v_mfma_f32_16x16x32_bf16 v[72:75],a[128:131],v[144:147],v[72:75]
ds_read_b128 v[200:203],v17 offset:36864
s_add_u32 s65,s89,0
s_waitcnt vmcnt(8)
v_and_or_b32 v64,v64,-4,s48
v_mfma_f32_16x16x32_bf16 v[76:79],a[132:135],v[148:151],v[76:79]
ds_read_b128 v[204:207],v17 offset:38912
buffer_load_dwordx4 v16,s[20:23],s65 offen offset:0 sc1 lds
s_add_u32 s64,s49,s34
v_mfma_f32_16x16x32_bf16 v[72:75],a[136:139],v[152:155],v[72:75]
ds_read_b128 v[208:211],v17 offset:40960
buffer_load_dwordx4 v16,s[20:23],s65 offen offset:2048 sc1 lds
v_mfma_f32_16x16x32_bf16 v[76:79],a[140:143],v[156:159],v[76:79]
s_xor_b32 m0,s72,17408
s_add_u32 s65,s89,32768
s_waitcnt lgkmcnt(9)
v_mfma_f32_16x16x32_bf16 v[72:75],a[144:147],v[160:163],v[72:75]
ds_read_b128 v[212:215],v17 offset:43008
buffer_load_dwordx4 v16,s[20:23],s65 offen offset:0 sc1 lds
v_mfma_f32_16x16x32_bf16 v[76:79],a[148:151],v[164:167],v[76:79]
ds_read_b128 v[216:219],v17 offset:45056
buffer_load_dwordx4 v16,s[20:23],s65 offen offset:2048 sc1 lds
v_mfma_f32_16x16x32_bf16 v[72:75],a[152:155],v[168:171],v[72:75]
ds_read_b128 v[220:223],v17 offset:47104
s_xor_b32 m0,s72,33792
buffer_store_dwordx4 v[64:67],v25,s[20:23],s64 offen offset:2048
v_mfma_f32_16x16x32_bf16 v[76:79],a[156:159],v[172:175],v[76:79]
ds_read_b128 v[224:227],v17 offset:49152
v_and_or_b32 v68,v68,-4,s48
s_add_u32 s64,s49,s35
s_waitcnt lgkmcnt(9)
v_mfma_f32_16x16x32_bf16 v[72:75],a[160:163],v[176:179],v[72:75]
ds_read_b128 v[228:231],v17 offset:51200
s_add_u32 s65,s89,65536
buffer_store_dwordx4 v[68:71],v25,s[20:23],s64 offen offset:3072
v_mfma_f32_16x16x32_bf16 v[76:79],a[164:167],v[180:183],v[76:79]
buffer_load_dwordx4 v16,s[20:23],s65 offen offset:0 sc1 lds
s_mov_b32 s49,0x7fff0000
v_mfma_f32_16x16x32_bf16 v[72:75],a[168:171],v[184:187],v[72:75]
ds_read_b128 v[232:235],v17 offset:53248
v_min3_u32 v27,v27,v128,v132
v_mfma_f32_16x16x32_bf16 v[76:79],a[172:175],v[188:191],v[76:79]
ds_read_b128 v[236:239],v17 offset:55296
s_waitcnt lgkmcnt(8)
v_mfma_f32_16x16x32_bf16 v[72:75],a[176:179],v[192:195],v[72:75]
buffer_load_dwordx4 v16,s[20:23],s65 offen offset:2048 sc1 lds
v_mfma_f32_16x16x32_bf16 v[76:79],a[180:183],v[196:199],v[76:79]
s_xor_b32 m0,s72,50176
s_add_u32 s65,s89,s86
v_mfma_f32_16x16x32_bf16 v[72:75],a[184:187],v[200:203],v[72:75]
buffer_load_dwordx4 v16,s[20:23],s65 offen offset:0 sc1 lds
v_mfma_f32_16x16x32_bf16 v[76:79],a[188:191],v[204:207],v[76:79]
v_min3_u32 v27,v27,v136,v140
s_waitcnt lgkmcnt(4)
v_mfma_f32_16x16x32_bf16 v[72:75],a[192:195],v[208:211],v[72:75]
buffer_load_dwordx4 v16,s[20:23],s65 offen offset:2048 sc1 lds
v_mfma_f32_16x16x32_bf16 v[76:79],a[196:199],v[212:215],v[76:79]
v_min3_u32 v27,v27,v144,v148
v_min3_u32 v27,v27,v152,v156
v_mfma_f32_16x16x32_bf16 v[72:75],a[200:203],v[216:219],v[72:75]
v_min3_u32 v27,v27,v160,v164
v_min3_u32 v27,v27,v168,v172
v_mfma_f32_16x16x32_bf16 v[76:79],a[204:207],v[220:223],v[76:79]
v_min3_u32 v27,v27,v176,v180
s_waitcnt lgkmcnt(0)
v_mfma_f32_16x16x32_bf16 v[72:75],a[208:211],v[224:227],v[72:75]
v_min3_u32 v27,v27,v184,v188
v_min3_u32 v27,v27,v192,v196
v_mfma_f32_16x16x32_bf16 v[76:79],a[212:215],v[228:231],v[76:79]
v_min3_u32 v27,v27,v200,v204
v_min3_u32 v27,v27,v208,v212
v_mfma_f32_16x16x32_bf16 v[72:75],a[216:219],v[232:235],v[72:75]
v_min3_u32 v27,v27,v216,v220
v_min3_u32 v27,v27,v224,v228
v_mfma_f32_16x16x32_bf16 v[76:79],a[220:223],v[236:239],v[76:79]
v_min3_u32 v27,v27,v226,v230
v_min3_u32 v27,v27,v232,v236
v_min3_u32 v27,v27,v234,v238
v_mfma_f32_16x16x32_bf16 v[80:83],a[0:3],v[128:131],0
v_cmp_eq_u32 vcc,0,v27
s_cbranch_vccnz retry_326
v_mfma_f32_16x16x32_bf16 v[84:87],a[4:7],v[132:135],0
ds_bpermute_b32 v124,v41,v120
ds_bpermute_b32 v125,v41,v121
v_mfma_f32_16x16x32_bf16 v[80:83],a[8:11],v[136:139],v[80:83]
v_lshlrev_b32 v108,16,v122
v_and_b32 v109,s80,v122
v_mfma_f32_16x16x32_bf16 v[84:87],a[12:15],v[140:143],v[84:87]
v_lshlrev_b32 v110,16,v123
v_and_b32 v111,s80,v123
v_mfma_f32_16x16x32_bf16 v[80:83],a[16:19],v[144:147],v[80:83]
s_waitcnt lgkmcnt(0)
v_lshlrev_b32 v104,16,v124
v_mfma_f32_16x16x32_bf16 v[84:87],a[20:23],v[148:151],v[84:87]
v_and_b32 v105,s80,v124
v_add_f32 v72,v72,v76
v_mfma_f32_16x16x32_bf16 v[80:83],a[24:27],v[152:155],v[80:83]
v_add_f32 v73,v73,v77
v_add_f32 v74,v74,v78
v_mfma_f32_16x16x32_bf16 v[84:87],a[28:31],v[156:159],v[84:87]
v_lshlrev_b32 v106,16,v125
v_add_f32 v75,v75,v79
v_mfma_f32_16x16x32_bf16 v[80:83],a[32:35],v[160:163],v[80:83]
v_and_or_b32 v72,v72,-4,s48
s_add_u32 s64,s77,s33
v_mfma_f32_16x16x32_bf16 v[84:87],a[36:39],v[164:167],v[84:87]
v_and_b32 v107,s80,v125
v_mfma_f32_16x16x32_bf16 v[80:83],a[40:43],v[168:171],v[80:83]
buffer_store_dwordx4 v[72:75],v25,s[20:23],s64 offen offset:1024
v_mfma_f32_16x16x32_bf16 v[84:87],a[44:47],v[172:175],v[84:87]
v_mfma_f32_16x16x32_bf16 v[80:83],a[48:51],v[176:179],v[80:83]
buffer_load_dwordx4 v[96:99],v26,s[20:23],s77 offen offset:2048 sc1
v_mfma_f32_16x16x32_bf16 v[84:87],a[52:55],v[180:183],v[84:87]
buffer_load_dwordx4 v[100:103],v26,s[20:23],s77 offen offset:3072 sc1
v_mfma_f32_16x16x32_bf16 v[80:83],a[56:59],v[184:187],v[80:83]
v_mfma_f32_16x16x32_bf16 v[84:87],a[60:63],v[188:191],v[84:87]
v_mfma_f32_16x16x32_bf16 v[80:83],a[64:67],v[192:195],v[80:83]
v_mfma_f32_16x16x32_bf16 v[84:87],a[68:71],v[196:199],v[84:87]
v_mfma_f32_16x16x32_bf16 v[80:83],a[72:75],v[200:203],v[80:83]
v_mfma_f32_16x16x32_bf16 v[84:87],a[76:79],v[204:207],v[84:87]
v_mfma_f32_16x16x32_bf16 v[80:83],a[80:83],v[208:211],v[80:83]
v_mfma_f32_16x16x32_bf16 v[84:87],a[84:87],v[212:215],v[84:87]
v_mfma_f32_16x16x32_bf16 v[80:83],a[88:91],v[216:219],v[80:83]
buffer_load_dwordx4 v[92:95],v26,s[20:23],s77 offen offset:1024 sc1
v_mfma_f32_16x16x32_bf16 v[84:87],a[92:95],v[220:223],v[84:87]
v_mfma_f32_16x16x32_bf16 v[80:83],a[96:99],v[224:227],v[80:83]
v_mfma_f32_16x16x32_bf16 v[84:87],a[100:103],v[228:231],v[84:87]
v_mfma_f32_16x16x32_bf16 v[80:83],a[104:107],v[232:235],v[80:83]
v_mfma_f32_16x16x32_bf16 v[84:87],a[108:111],v[236:239],v[84:87]
s_branch epi_329
ahead_328:
s_cmp_eq_u32 s93,0
s_cbranch_scc1 both_330
s_waitcnt vmcnt(14) lgkmcnt(0)
s_barrier
ds_read_b128 v[224:227],v18 offset:0
ds_read_b128 v[228:231],v18 offset:2048
ds_read_b128 v[232:235],v18 offset:4096
ds_read_b128 v[236:239],v18 offset:6144
ds_read_b128 v[240:243],v18 offset:8192
ds_read_b128 v[244:247],v18 offset:10240
ds_read_b128 v[248:251],v18 offset:12288
s_waitcnt lgkmcnt(5)
v_mfma_f32_16x16x32_bf16 v[64:67],a[0:3],v[224:227],0
s_add_u32 s96,s71,1
s_add_u32 s92,s71,2
v_mfma_f32_16x16x32_bf16 v[68:71],a[112:115],v[224:227],0
ds_read_b128 v[252:255],v18 offset:14336
v_min_u32 v27,v224,v228
v_mfma_f32_16x16x32_bf16 v[64:67],a[4:7],v[228:231],v[64:67]
s_cmp_eq_u32 s96,64
s_cselect_b32 s96,99,s96
v_mfma_f32_16x16x32_bf16 v[68:71],a[116:119],v[228:231],v[68:71]
ds_read_b128 v[224:227],v18 offset:16384
s_waitcnt lgkmcnt(5)
v_mfma_f32_16x16x32_bf16 v[64:67],a[8:11],v[232:235],v[64:67]
s_cmp_eq_u32 s92,64
s_cselect_b32 s92,99,s92
v_mfma_f32_16x16x32_bf16 v[68:71],a[120:123],v[232:235],v[68:71]
ds_read_b128 v[228:231],v18 offset:18432
v_min3_u32 v27,v27,v232,v236
v_mfma_f32_16x16x32_bf16 v[64:67],a[12:15],v[236:239],v[64:67]
buffer_load_dwordx2 v[120:121],v20,s[20:23],s76 offen sc1
v_mfma_f32_16x16x32_bf16 v[68:71],a[124:127],v[236:239],v[68:71]
ds_read_b128 v[232:235],v18 offset:20480
s_waitcnt lgkmcnt(5)
v_mfma_f32_16x16x32_bf16 v[64:67],a[16:19],v[240:243],v[64:67]
v_min3_u32 v27,v27,v240,v244
v_mfma_f32_16x16x32_bf16 v[68:71],a[128:131],v[240:243],v[68:71]
ds_read_b128 v[236:239],v18 offset:22528
v_mfma_f32_16x16x32_bf16 v[64:67],a[20:23],v[244:247],v[64:67]
s_waitcnt vmcnt(2)
v_mfma_f32_16x16x32_bf16 v[68:71],a[132:135],v[244:247],v[68:71]
ds_read_b128 v[240:243],v18 offset:24576
s_waitcnt lgkmcnt(5)
v_mfma_f32_16x16x32_bf16 v[64:67],a[24:27],v[248:251],v[64:67]
v_cmp_gt_u32 vcc,s96,v29
v_cmp_gt_u32 s[92:93],s92,v29
v_mfma_f32_16x16x32_bf16 v[68:71],a[136:139],v[248:251],v[68:71]
ds_read_b128 v[244:247],v18 offset:26624
v_min3_u32 v27,v27,v248,v252
v_mfma_f32_16x16x32_bf16 v[64:67],a[28:31],v[252:255],v[64:67]
v_mov_b32 v44,vcc_lo
v_mov_b32 v45,s92
v_mfma_f32_16x16x32_bf16 v[68:71],a[140:143],v[252:255],v[68:71]
ds_read_b128 v[248:251],v18 offset:28672
s_waitcnt lgkmcnt(5)
v_mfma_f32_16x16x32_bf16 v[64:67],a[32:35],v[224:227],v[64:67]
ds_write_b64 v46,v[44:45]
v_min3_u32 v27,v27,v224,v228
v_mfma_f32_16x16x32_bf16 v[68:71],a[144:147],v[224:227],v[68:71]
ds_read_b128 v[252:255],v18 offset:30720
v_mfma_f32_16x16x32_bf16 v[64:67],a[36:39],v[228:231],v[64:67]
buffer_load_dwordx2 v[122:123],v24,s[20:23],s70 offen sc1
v_mfma_f32_16x16x32_bf16 v[68:71],a[148:151],v[228:231],v[68:71]
ds_read_b128 v[224:227],v18 offset:32768
s_waitcnt lgkmcnt(6)
v_mfma_f32_16x16x32_bf16 v[64:67],a[40:43],v[232:235],v[64:67]
v_min3_u32 v27,v27,v232,v236
s_add_u32 s88,s70,s75
v_mfma_f32_16x16x32_bf16 v[68:71],a[152:155],v[232:235],v[68:71]
ds_read_b128 v[228:231],v18 offset:34816
s_add_u32 s88,s88,2097152
v_mfma_f32_16x16x32_bf16 v[64:67],a[44:47],v[236:239],v[64:67]
s_xor_b32 s88,s88,0x2000
s_xor_b32 s89,s88,1024
v_mfma_f32_16x16x32_bf16 v[68:71],a[156:159],v[236:239],v[68:71]
ds_read_b128 v[232:235],v18 offset:36864
s_waitcnt lgkmcnt(6)
v_mfma_f32_16x16x32_bf16 v[64:67],a[48:51],v[240:243],v[64:67]
v_min3_u32 v27,v27,v240,v244
v_mfma_f32_16x16x32_bf16 v[68:71],a[160:163],v[240:243],v[68:71]
ds_read_b128 v[236:239],v18 offset:38912
v_mfma_f32_16x16x32_bf16 v[64:67],a[52:55],v[244:247],v[64:67]
v_mfma_f32_16x16x32_bf16 v[68:71],a[164:167],v[244:247],v[68:71]
ds_read_b128 v[240:243],v18 offset:40960
s_waitcnt lgkmcnt(5)
v_mfma_f32_16x16x32_bf16 v[64:67],a[56:59],v[248:251],v[64:67]
v_min3_u32 v27,v27,v248,v252
v_mfma_f32_16x16x32_bf16 v[68:71],a[168:171],v[248:251],v[68:71]
ds_read_b128 v[244:247],v18 offset:43008
v_mfma_f32_16x16x32_bf16 v[64:67],a[60:63],v[252:255],v[64:67]
v_mfma_f32_16x16x32_bf16 v[68:71],a[172:175],v[252:255],v[68:71]
ds_read_b128 v[248:251],v18 offset:45056
s_waitcnt lgkmcnt(5)
v_mfma_f32_16x16x32_bf16 v[64:67],a[64:67],v[224:227],v[64:67]
s_waitcnt vmcnt(8)
s_barrier
ds_read_b64 v[44:45],v47
ds_read_b128 v[128:131],v17 offset:0
ds_read_b128 v[132:135],v17 offset:2048
v_mfma_f32_16x16x32_bf16 v[68:71],a[176:179],v[224:227],v[68:71]
ds_read_b128 v[252:255],v18 offset:47104
v_min3_u32 v27,v27,v224,v228
v_mfma_f32_16x16x32_bf16 v[64:67],a[68:71],v[228:231],v[64:67]
ds_read_b128 v[136:139],v17 offset:4096
v_mfma_f32_16x16x32_bf16 v[68:71],a[180:183],v[228:231],v[68:71]
ds_read_b128 v[224:227],v18 offset:49152
s_waitcnt lgkmcnt(9)
v_mfma_f32_16x16x32_bf16 v[64:67],a[72:75],v[232:235],v[64:67]
ds_read_b128 v[140:143],v17 offset:6144
v_min3_u32 v27,v27,v232,v236
v_mfma_f32_16x16x32_bf16 v[68:71],a[184:187],v[232:235],v[68:71]
ds_read_b128 v[228:231],v18 offset:51200
v_mfma_f32_16x16x32_bf16 v[64:67],a[76:79],v[236:239],v[64:67]
ds_read_b128 v[144:147],v17 offset:8192
ds_read_b128 v[148:151],v17 offset:10240
v_mfma_f32_16x16x32_bf16 v[68:71],a[188:191],v[236:239],v[68:71]
ds_read_b128 v[232:235],v18 offset:53248
s_waitcnt lgkmcnt(12)
v_mfma_f32_16x16x32_bf16 v[64:67],a[80:83],v[240:243],v[64:67]
ds_read_b128 v[152:155],v17 offset:12288
s_waitcnt lgkmcnt(11)
v_min3_u32 v27,v27,v240,v244
v_mfma_f32_16x16x32_bf16 v[68:71],a[192:195],v[240:243],v[68:71]
ds_read_b128 v[236:239],v18 offset:55296
v_readfirstlane_b32 s93,v45
v_mfma_f32_16x16x32_bf16 v[64:67],a[84:87],v[244:247],v[64:67]
ds_read_b128 v[156:159],v17 offset:14336
v_readfirstlane_b32 s83,v44
s_cmp_lg_u32 s83,0
s_cbranch_scc1 keep_338
v_mfma_f32_16x16x32_bf16 v[68:71],a[196:199],v[244:247],v[68:71]
s_xor_b32 m0,s72,0
s_add_u32 s65,s88,0
s_waitcnt lgkmcnt(10)
v_mfma_f32_16x16x32_bf16 v[64:67],a[88:91],v[248:251],v[64:67]
ds_read_b128 v[160:163],v17 offset:16384
ds_read_b128 v[164:167],v17 offset:18432
v_min3_u32 v27,v27,v248,v252
v_mfma_f32_16x16x32_bf16 v[68:71],a[200:203],v[248:251],v[68:71]
buffer_load_dwordx4 v16,s[20:23],s65 offen offset:0 sc1 lds
v_mfma_f32_16x16x32_bf16 v[64:67],a[92:95],v[252:255],v[64:67]
ds_read_b128 v[168:171],v17 offset:20480
buffer_load_dwordx4 v16,s[20:23],s65 offen offset:2048 sc1 lds
v_mfma_f32_16x16x32_bf16 v[68:71],a[204:207],v[252:255],v[68:71]
s_xor_b32 m0,s72,16384
s_add_u32 s65,s88,32768
s_waitcnt lgkmcnt(9)
v_mfma_f32_16x16x32_bf16 v[64:67],a[96:99],v[224:227],v[64:67]
ds_read_b128 v[172:175],v17 offset:22528
buffer_load_dwordx4 v16,s[20:23],s65 offen offset:0 sc1 lds
v_min3_u32 v27,v27,v224,v228
v_mfma_f32_16x16x32_bf16 v[68:71],a[208:211],v[224:227],v[68:71]
buffer_load_dwordx4 v16,s[20:23],s65 offen offset:2048 sc1 lds
v_min3_u32 v27,v27,v226,v230
v_mfma_f32_16x16x32_bf16 v[64:67],a[100:103],v[228:231],v[64:67]
ds_read_b128 v[176:179],v17 offset:24576
ds_read_b128 v[180:183],v17 offset:26624
s_xor_b32 m0,s72,32768
v_mfma_f32_16x16x32_bf16 v[68:71],a[212:215],v[228:231],v[68:71]
s_add_u32 s65,s88,65536
s_waitcnt lgkmcnt(7)
v_mfma_f32_16x16x32_bf16 v[64:67],a[104:107],v[232:235],v[64:67]
ds_read_b128 v[184:187],v17 offset:28672
buffer_load_dwordx4 v16,s[20:23],s65 offen offset:0 sc1 lds
v_mfma_f32_16x16x32_bf16 v[68:71],a[216:219],v[232:235],v[68:71]
buffer_load_dwordx4 v16,s[20:23],s65 offen offset:2048 sc1 lds
v_min3_u32 v27,v27,v232,v236
v_mfma_f32_16x16x32_bf16 v[64:67],a[108:111],v[236:239],v[64:67]
ds_read_b128 v[188:191],v17 offset:30720
s_xor_b32 m0,s72,49152
v_min3_u32 v27,v27,v234,v238
v_mfma_f32_16x16x32_bf16 v[68:71],a[220:223],v[236:239],v[68:71]
s_add_u32 s65,s88,s86
v_mfma_f32_16x16x32_bf16 v[72:75],a[112:115],v[128:131],0
buffer_load_dwordx4 v16,s[20:23],s65 offen offset:0 sc1 lds
v_cmp_eq_u32 vcc,0,v27
s_cbranch_vccnz retry_326
v_mfma_f32_16x16x32_bf16 v[76:79],a[116:119],v[132:135],0
buffer_load_dwordx4 v16,s[20:23],s65 offen offset:2048 sc1 lds
v_mfma_f32_16x16x32_bf16 v[72:75],a[120:123],v[136:139],v[72:75]
ds_read_b128 v[192:195],v17 offset:32768
s_xor_b32 m0,s72,1024
v_mfma_f32_16x16x32_bf16 v[76:79],a[124:127],v[140:143],v[76:79]
ds_read_b128 v[196:199],v17 offset:34816
s_add_u32 s65,s89,0
s_waitcnt lgkmcnt(10)
v_mfma_f32_16x16x32_bf16 v[72:75],a[128:131],v[144:147],v[72:75]
ds_read_b128 v[200:203],v17 offset:36864
buffer_load_dwordx4 v16,s[20:23],s65 offen offset:0 sc1 lds
s_waitcnt vmcnt(9)
v_mfma_f32_16x16x32_bf16 v[76:79],a[132:135],v[148:151],v[76:79]
ds_read_b128 v[204:207],v17 offset:38912
buffer_load_dwordx4 v16,s[20:23],s65 offen offset:2048 sc1 lds
v_and_or_b32 v64,v64,-4,s48
v_mfma_f32_16x16x32_bf16 v[72:75],a[136:139],v[152:155],v[72:75]
ds_read_b128 v[208:211],v17 offset:40960
s_xor_b32 m0,s72,17408
s_add_u32 s64,s49,s34
v_mfma_f32_16x16x32_bf16 v[76:79],a[140:143],v[156:159],v[76:79]
s_add_u32 s65,s89,32768
buffer_store_dwordx4 v[64:67],v25,s[20:23],s64 offen offset:2048
s_waitcnt lgkmcnt(9)
v_mfma_f32_16x16x32_bf16 v[72:75],a[144:147],v[160:163],v[72:75]
ds_read_b128 v[212:215],v17 offset:43008
buffer_load_dwordx4 v16,s[20:23],s65 offen offset:0 sc1 lds
v_and_or_b32 v68,v68,-4,s48
v_mfma_f32_16x16x32_bf16 v[76:79],a[148:151],v[164:167],v[76:79]
ds_read_b128 v[216:219],v17 offset:45056
buffer_load_dwordx4 v16,s[20:23],s65 offen offset:2048 sc1 lds
s_add_u32 s64,s49,s35
v_mfma_f32_16x16x32_bf16 v[72:75],a[152:155],v[168:171],v[72:75]
ds_read_b128 v[220:223],v17 offset:47104
s_xor_b32 m0,s72,33792
buffer_store_dwordx4 v[68:71],v25,s[20:23],s64 offen offset:3072
v_mfma_f32_16x16x32_bf16 v[76:79],a[156:159],v[172:175],v[76:79]
ds_read_b128 v[224:227],v17 offset:49152
s_mov_b32 s49,0x7fff0000
s_waitcnt lgkmcnt(9)
v_mfma_f32_16x16x32_bf16 v[72:75],a[160:163],v[176:179],v[72:75]
ds_read_b128 v[228:231],v17 offset:51200
s_add_u32 s65,s89,65536
v_mfma_f32_16x16x32_bf16 v[76:79],a[164:167],v[180:183],v[76:79]
buffer_load_dwordx4 v16,s[20:23],s65 offen offset:0 sc1 lds
v_mfma_f32_16x16x32_bf16 v[72:75],a[168:171],v[184:187],v[72:75]
ds_read_b128 v[232:235],v17 offset:53248
v_min3_u32 v27,v27,v128,v132
v_mfma_f32_16x16x32_bf16 v[76:79],a[172:175],v[188:191],v[76:79]
ds_read_b128 v[236:239],v17 offset:55296
s_waitcnt lgkmcnt(8)
v_mfma_f32_16x16x32_bf16 v[72:75],a[176:179],v[192:195],v[72:75]
buffer_load_dwordx4 v16,s[20:23],s65 offen offset:2048 sc1 lds
v_mfma_f32_16x16x32_bf16 v[76:79],a[180:183],v[196:199],v[76:79]
s_xor_b32 m0,s72,50176
s_add_u32 s65,s89,s86
v_mfma_f32_16x16x32_bf16 v[72:75],a[184:187],v[200:203],v[72:75]
buffer_load_dwordx4 v16,s[20:23],s65 offen offset:0 sc1 lds
v_mfma_f32_16x16x32_bf16 v[76:79],a[188:191],v[204:207],v[76:79]
v_min3_u32 v27,v27,v136,v140
s_waitcnt lgkmcnt(4)
v_mfma_f32_16x16x32_bf16 v[72:75],a[192:195],v[208:211],v[72:75]
buffer_load_dwordx4 v16,s[20:23],s65 offen offset:2048 sc1 lds
v_mfma_f32_16x16x32_bf16 v[76:79],a[196:199],v[212:215],v[76:79]
v_min3_u32 v27,v27,v144,v148
v_min3_u32 v27,v27,v152,v156
v_mfma_f32_16x16x32_bf16 v[72:75],a[200:203],v[216:219],v[72:75]
v_min3_u32 v27,v27,v160,v164
v_min3_u32 v27,v27,v168,v172
v_mfma_f32_16x16x32_bf16 v[76:79],a[204:207],v[220:223],v[76:79]
v_min3_u32 v27,v27,v176,v180
s_waitcnt lgkmcnt(0)
v_mfma_f32_16x16x32_bf16 v[72:75],a[208:211],v[224:227],v[72:75]
v_min3_u32 v27,v27,v184,v188
v_min3_u32 v27,v27,v192,v196
v_mfma_f32_16x16x32_bf16 v[76:79],a[212:215],v[228:231],v[76:79]
v_min3_u32 v27,v27,v200,v204
v_min3_u32 v27,v27,v208,v212
v_mfma_f32_16x16x32_bf16 v[72:75],a[216:219],v[232:235],v[72:75]
v_min3_u32 v27,v27,v216,v220
v_min3_u32 v27,v27,v224,v228
v_mfma_f32_16x16x32_bf16 v[76:79],a[220:223],v[236:239],v[76:79]
v_min3_u32 v27,v27,v226,v230
v_min3_u32 v27,v27,v232,v236
v_min3_u32 v27,v27,v234,v238
v_mfma_f32_16x16x32_bf16 v[80:83],a[0:3],v[128:131],0
v_cmp_eq_u32 vcc,0,v27
s_cbranch_vccnz retry_326
v_mfma_f32_16x16x32_bf16 v[84:87],a[4:7],v[132:135],0
ds_bpermute_b32 v124,v41,v120
ds_bpermute_b32 v125,v41,v121
v_mfma_f32_16x16x32_bf16 v[80:83],a[8:11],v[136:139],v[80:83]
v_lshlrev_b32 v108,16,v122
v_and_b32 v109,s80,v122
v_mfma_f32_16x16x32_bf16 v[84:87],a[12:15],v[140:143],v[84:87]
v_lshlrev_b32 v110,16,v123
v_and_b32 v111,s80,v123
v_mfma_f32_16x16x32_bf16 v[80:83],a[16:19],v[144:147],v[80:83]
s_waitcnt lgkmcnt(0)
v_lshlrev_b32 v104,16,v124
v_mfma_f32_16x16x32_bf16 v[84:87],a[20:23],v[148:151],v[84:87]
v_and_b32 v105,s80,v124
v_add_f32 v72,v72,v76
v_mfma_f32_16x16x32_bf16 v[80:83],a[24:27],v[152:155],v[80:83]
v_add_f32 v73,v73,v77
v_add_f32 v74,v74,v78
v_mfma_f32_16x16x32_bf16 v[84:87],a[28:31],v[156:159],v[84:87]
v_lshlrev_b32 v106,16,v125
v_add_f32 v75,v75,v79
v_mfma_f32_16x16x32_bf16 v[80:83],a[32:35],v[160:163],v[80:83]
v_and_or_b32 v72,v72,-4,s48
s_add_u32 s64,s77,s33
v_mfma_f32_16x16x32_bf16 v[84:87],a[36:39],v[164:167],v[84:87]
v_and_b32 v107,s80,v125
v_mfma_f32_16x16x32_bf16 v[80:83],a[40:43],v[168:171],v[80:83]
buffer_store_dwordx4 v[72:75],v25,s[20:23],s64 offen offset:1024
v_mfma_f32_16x16x32_bf16 v[84:87],a[44:47],v[172:175],v[84:87]
v_mfma_f32_16x16x32_bf16 v[80:83],a[48:51],v[176:179],v[80:83]
buffer_load_dwordx4 v[96:99],v26,s[20:23],s77 offen offset:2048 sc1
v_mfma_f32_16x16x32_bf16 v[84:87],a[52:55],v[180:183],v[84:87]
buffer_load_dwordx4 v[100:103],v26,s[20:23],s77 offen offset:3072 sc1
v_mfma_f32_16x16x32_bf16 v[80:83],a[56:59],v[184:187],v[80:83]
v_mfma_f32_16x16x32_bf16 v[84:87],a[60:63],v[188:191],v[84:87]
v_mfma_f32_16x16x32_bf16 v[80:83],a[64:67],v[192:195],v[80:83]
v_mfma_f32_16x16x32_bf16 v[84:87],a[68:71],v[196:199],v[84:87]
v_mfma_f32_16x16x32_bf16 v[80:83],a[72:75],v[200:203],v[80:83]
v_mfma_f32_16x16x32_bf16 v[84:87],a[76:79],v[204:207],v[84:87]
v_mfma_f32_16x16x32_bf16 v[80:83],a[80:83],v[208:211],v[80:83]
v_mfma_f32_16x16x32_bf16 v[84:87],a[84:87],v[212:215],v[84:87]
v_mfma_f32_16x16x32_bf16 v[80:83],a[88:91],v[216:219],v[80:83]
buffer_load_dwordx4 v[92:95],v26,s[20:23],s77 offen offset:1024 sc1
v_mfma_f32_16x16x32_bf16 v[84:87],a[92:95],v[220:223],v[84:87]
v_mfma_f32_16x16x32_bf16 v[80:83],a[96:99],v[224:227],v[80:83]
v_mfma_f32_16x16x32_bf16 v[84:87],a[100:103],v[228:231],v[84:87]
v_mfma_f32_16x16x32_bf16 v[80:83],a[104:107],v[232:235],v[80:83]
v_mfma_f32_16x16x32_bf16 v[84:87],a[108:111],v[236:239],v[84:87]
s_branch epi_329
keep_338:
v_mfma_f32_16x16x32_bf16 v[68:71],a[196:199],v[244:247],v[68:71]
s_waitcnt lgkmcnt(10)
v_mfma_f32_16x16x32_bf16 v[64:67],a[88:91],v[248:251],v[64:67]
ds_read_b128 v[160:163],v17 offset:16384
ds_read_b128 v[164:167],v17 offset:18432
v_mfma_f32_16x16x32_bf16 v[68:71],a[200:203],v[248:251],v[68:71]
v_min3_u32 v27,v27,v248,v252
v_mfma_f32_16x16x32_bf16 v[64:67],a[92:95],v[252:255],v[64:67]
ds_read_b128 v[168:171],v17 offset:20480
v_mfma_f32_16x16x32_bf16 v[68:71],a[204:207],v[252:255],v[68:71]
s_waitcnt lgkmcnt(9)
v_mfma_f32_16x16x32_bf16 v[64:67],a[96:99],v[224:227],v[64:67]
ds_read_b128 v[172:175],v17 offset:22528
v_min3_u32 v27,v27,v224,v228
v_mfma_f32_16x16x32_bf16 v[68:71],a[208:211],v[224:227],v[68:71]
v_min3_u32 v27,v27,v226,v230
v_mfma_f32_16x16x32_bf16 v[64:67],a[100:103],v[228:231],v[64:67]
ds_read_b128 v[176:179],v17 offset:24576
ds_read_b128 v[180:183],v17 offset:26624
v_mfma_f32_16x16x32_bf16 v[68:71],a[212:215],v[228:231],v[68:71]
s_waitcnt lgkmcnt(7)
v_mfma_f32_16x16x32_bf16 v[64:67],a[104:107],v[232:235],v[64:67]
ds_read_b128 v[184:187],v17 offset:28672
v_min3_u32 v27,v27,v232,v236
v_mfma_f32_16x16x32_bf16 v[68:71],a[216:219],v[232:235],v[68:71]
v_min3_u32 v27,v27,v234,v238
v_mfma_f32_16x16x32_bf16 v[64:67],a[108:111],v[236:239],v[64:67]
ds_read_b128 v[188:191],v17 offset:30720
v_mfma_f32_16x16x32_bf16 v[68:71],a[220:223],v[236:239],v[68:71]
v_mfma_f32_16x16x32_bf16 v[72:75],a[112:115],v[128:131],0
v_cmp_eq_u32 vcc,0,v27
s_cbranch_vccnz retry_326
v_mfma_f32_16x16x32_bf16 v[76:79],a[116:119],v[132:135],0
v_min3_u32 v27,v27,v128,v132
v_mfma_f32_16x16x32_bf16 v[72:75],a[120:123],v[136:139],v[72:75]
ds_read_b128 v[192:195],v17 offset:32768
v_mfma_f32_16x16x32_bf16 v[76:79],a[124:127],v[140:143],v[76:79]
ds_read_b128 v[196:199],v17 offset:34816
s_waitcnt lgkmcnt(10)
v_mfma_f32_16x16x32_bf16 v[72:75],a[128:131],v[144:147],v[72:75]
ds_read_b128 v[200:203],v17 offset:36864
v_min3_u32 v27,v27,v136,v140
s_waitcnt vmcnt(0)
v_mfma_f32_16x16x32_bf16 v[76:79],a[132:135],v[148:151],v[76:79]
ds_read_b128 v[204:207],v17 offset:38912
v_min3_u32 v27,v27,v144,v148
v_and_or_b32 v64,v64,-4,s48
v_mfma_f32_16x16x32_bf16 v[72:75],a[136:139],v[152:155],v[72:75]
ds_read_b128 v[208:211],v17 offset:40960
s_add_u32 s64,s49,s34
v_mfma_f32_16x16x32_bf16 v[76:79],a[140:143],v[156:159],v[76:79]
v_min3_u32 v27,v27,v152,v156
s_waitcnt lgkmcnt(9)
v_mfma_f32_16x16x32_bf16 v[72:75],a[144:147],v[160:163],v[72:75]
ds_read_b128 v[212:215],v17 offset:43008
buffer_store_dwordx4 v[64:67],v25,s[20:23],s64 offen offset:2048
v_mfma_f32_16x16x32_bf16 v[76:79],a[148:151],v[164:167],v[76:79]
ds_read_b128 v[216:219],v17 offset:45056
v_min3_u32 v27,v27,v160,v164
v_and_or_b32 v68,v68,-4,s48
v_mfma_f32_16x16x32_bf16 v[72:75],a[152:155],v[168:171],v[72:75]
ds_read_b128 v[220:223],v17 offset:47104
s_add_u32 s64,s49,s35
v_mfma_f32_16x16x32_bf16 v[76:79],a[156:159],v[172:175],v[76:79]
ds_read_b128 v[224:227],v17 offset:49152
s_waitcnt lgkmcnt(9)
v_mfma_f32_16x16x32_bf16 v[72:75],a[160:163],v[176:179],v[72:75]
ds_read_b128 v[228:231],v17 offset:51200
v_min3_u32 v27,v27,v168,v172
v_mfma_f32_16x16x32_bf16 v[76:79],a[164:167],v[180:183],v[76:79]
v_min3_u32 v27,v27,v176,v180
buffer_store_dwordx4 v[68:71],v25,s[20:23],s64 offen offset:3072
v_mfma_f32_16x16x32_bf16 v[72:75],a[168:171],v[184:187],v[72:75]
ds_read_b128 v[232:235],v17 offset:53248
s_mov_b32 s49,0x7fff0000
v_mfma_f32_16x16x32_bf16 v[76:79],a[172:175],v[188:191],v[76:79]
ds_read_b128 v[236:239],v17 offset:55296
s_waitcnt lgkmcnt(8)
v_mfma_f32_16x16x32_bf16 v[72:75],a[176:179],v[192:195],v[72:75]
v_min3_u32 v27,v27,v184,v188
v_mfma_f32_16x16x32_bf16 v[76:79],a[180:183],v[196:199],v[76:79]
v_min3_u32 v27,v27,v192,v196
ds_bpermute_b32 v124,v41,v120
v_mfma_f32_16x16x32_bf16 v[72:75],a[184:187],v[200:203],v[72:75]
v_mfma_f32_16x16x32_bf16 v[76:79],a[188:191],v[204:207],v[76:79]
v_min3_u32 v27,v27,v200,v204
s_waitcnt lgkmcnt(5)
v_mfma_f32_16x16x32_bf16 v[72:75],a[192:195],v[208:211],v[72:75]
ds_bpermute_b32 v125,v41,v121
v_mfma_f32_16x16x32_bf16 v[76:79],a[196:199],v[212:215],v[76:79]
v_min3_u32 v27,v27,v208,v212
v_lshlrev_b32 v108,16,v122
v_mfma_f32_16x16x32_bf16 v[72:75],a[200:203],v[216:219],v[72:75]
v_mfma_f32_16x16x32_bf16 v[76:79],a[204:207],v[220:223],v[76:79]
v_min3_u32 v27,v27,v216,v220
s_waitcnt lgkmcnt(2)
v_mfma_f32_16x16x32_bf16 v[72:75],a[208:211],v[224:227],v[72:75]
v_and_b32 v109,s80,v122
v_mfma_f32_16x16x32_bf16 v[76:79],a[212:215],v[228:231],v[76:79]
v_min3_u32 v27,v27,v224,v228
v_min3_u32 v27,v27,v226,v230
v_mfma_f32_16x16x32_bf16 v[72:75],a[216:219],v[232:235],v[72:75]
v_lshlrev_b32 v110,16,v123
v_mfma_f32_16x16x32_bf16 v[76:79],a[220:223],v[236:239],v[76:79]
v_min3_u32 v27,v27,v232,v236
v_min3_u32 v27,v27,v234,v238
v_mfma_f32_16x16x32_bf16 v[80:83],a[0:3],v[128:131],0
v_cmp_eq_u32 vcc,0,v27
s_cbranch_vccnz retry_326
v_mfma_f32_16x16x32_bf16 v[84:87],a[4:7],v[132:135],0
v_and_b32 v111,s80,v123
s_waitcnt lgkmcnt(0)
v_mfma_f32_16x16x32_bf16 v[80:83],a[8:11],v[136:139],v[80:83]
v_mfma_f32_16x16x32_bf16 v[84:87],a[12:15],v[140:143],v[84:87]
v_lshlrev_b32 v104,16,v124
v_mfma_f32_16x16x32_bf16 v[80:83],a[16:19],v[144:147],v[80:83]
v_add_f32 v72,v72,v76
v_add_f32 v73,v73,v77
v_mfma_f32_16x16x32_bf16 v[84:87],a[20:23],v[148:151],v[84:87]
v_and_b32 v105,s80,v124
v_add_f32 v74,v74,v78
v_mfma_f32_16x16x32_bf16 v[80:83],a[24:27],v[152:155],v[80:83]
v_add_f32 v75,v75,v79
v_and_or_b32 v72,v72,-4,s48
v_mfma_f32_16x16x32_bf16 v[84:87],a[28:31],v[156:159],v[84:87]
v_lshlrev_b32 v106,16,v125
s_add_u32 s64,s77,s33
v_mfma_f32_16x16x32_bf16 v[80:83],a[32:35],v[160:163],v[80:83]
buffer_store_dwordx4 v[72:75],v25,s[20:23],s64 offen offset:1024
v_mfma_f32_16x16x32_bf16 v[84:87],a[36:39],v[164:167],v[84:87]
v_and_b32 v107,s80,v125
v_mfma_f32_16x16x32_bf16 v[80:83],a[40:43],v[168:171],v[80:83]
v_mfma_f32_16x16x32_bf16 v[84:87],a[44:47],v[172:175],v[84:87]
v_mfma_f32_16x16x32_bf16 v[80:83],a[48:51],v[176:179],v[80:83]
buffer_load_dwordx4 v[96:99],v26,s[20:23],s77 offen offset:2048 sc1
v_mfma_f32_16x16x32_bf16 v[84:87],a[52:55],v[180:183],v[84:87]
buffer_load_dwordx4 v[100:103],v26,s[20:23],s77 offen offset:3072 sc1
v_mfma_f32_16x16x32_bf16 v[80:83],a[56:59],v[184:187],v[80:83]
v_mfma_f32_16x16x32_bf16 v[84:87],a[60:63],v[188:191],v[84:87]
v_mfma_f32_16x16x32_bf16 v[80:83],a[64:67],v[192:195],v[80:83]
v_mfma_f32_16x16x32_bf16 v[84:87],a[68:71],v[196:199],v[84:87]
v_mfma_f32_16x16x32_bf16 v[80:83],a[72:75],v[200:203],v[80:83]
v_mfma_f32_16x16x32_bf16 v[84:87],a[76:79],v[204:207],v[84:87]
v_mfma_f32_16x16x32_bf16 v[80:83],a[80:83],v[208:211],v[80:83]
v_mfma_f32_16x16x32_bf16 v[84:87],a[84:87],v[212:215],v[84:87]
v_mfma_f32_16x16x32_bf16 v[80:83],a[88:91],v[216:219],v[80:83]
buffer_load_dwordx4 v[92:95],v26,s[20:23],s77 offen offset:1024 sc1
v_mfma_f32_16x16x32_bf16 v[84:87],a[92:95],v[220:223],v[84:87]
v_mfma_f32_16x16x32_bf16 v[80:83],a[96:99],v[224:227],v[80:83]
v_mfma_f32_16x16x32_bf16 v[84:87],a[100:103],v[228:231],v[84:87]
v_mfma_f32_16x16x32_bf16 v[80:83],a[104:107],v[232:235],v[80:83]
v_mfma_f32_16x16x32_bf16 v[84:87],a[108:111],v[236:239],v[84:87]
s_branch epi_329
both_330:
s_waitcnt vmcnt(14) lgkmcnt(0)
s_barrier
ds_read_b128 v[224:227],v18 offset:0
ds_read_b128 v[228:231],v18 offset:2048
ds_read_b128 v[232:235],v18 offset:4096
ds_read_b128 v[236:239],v18 offset:6144
ds_read_b128 v[240:243],v18 offset:8192
ds_read_b128 v[244:247],v18 offset:10240
ds_read_b128 v[248:251],v18 offset:12288
s_waitcnt lgkmcnt(5)
v_mfma_f32_16x16x32_bf16 v[64:67],a[0:3],v[224:227],0
s_add_u32 s96,s71,1
s_add_u32 s92,s71,2
s_add_u32 s88,s70,s75
v_mfma_f32_16x16x32_bf16 v[68:71],a[112:115],v[224:227],0
ds_read_b128 v[252:255],v18 offset:14336
s_add_u32 s88,s88,2097152
s_xor_b32 s88,s88,0x2000
v_mfma_f32_16x16x32_bf16 v[64:67],a[4:7],v[228:231],v[64:67]
s_cmp_eq_u32 s96,64
s_cselect_b32 s96,99,s96
v_min_u32 v27,v224,v228
v_mfma_f32_16x16x32_bf16 v[68:71],a[116:119],v[228:231],v[68:71]
ds_read_b128 v[224:227],v18 offset:16384
s_waitcnt lgkmcnt(5)
v_mfma_f32_16x16x32_bf16 v[64:67],a[8:11],v[232:235],v[64:67]
s_cmp_eq_u32 s92,64
s_cselect_b32 s92,99,s92
v_mfma_f32_16x16x32_bf16 v[68:71],a[120:123],v[232:235],v[68:71]
ds_read_b128 v[228:231],v18 offset:18432
s_xor_b32 s89,s88,1024
v_mfma_f32_16x16x32_bf16 v[64:67],a[12:15],v[236:239],v[64:67]
s_xor_b32 m0,s72,0
v_min3_u32 v27,v27,v232,v236
v_mfma_f32_16x16x32_bf16 v[68:71],a[124:127],v[236:239],v[68:71]
ds_read_b128 v[232:235],v18 offset:20480
s_add_u32 s65,s88,0
s_waitcnt lgkmcnt(5)
v_mfma_f32_16x16x32_bf16 v[64:67],a[16:19],v[240:243],v[64:67]
v_min3_u32 v27,v27,v240,v244
buffer_load_dwordx2 v[120:121],v20,s[20:23],s76 offen sc1
v_mfma_f32_16x16x32_bf16 v[68:71],a[128:131],v[240:243],v[68:71]
ds_read_b128 v[236:239],v18 offset:22528
buffer_load_dwordx4 v16,s[20:23],s65 offen offset:0 sc1 lds
v_mfma_f32_16x16x32_bf16 v[64:67],a[20:23],v[244:247],v[64:67]
s_waitcnt vmcnt(3)
v_mfma_f32_16x16x32_bf16 v[68:71],a[132:135],v[244:247],v[68:71]
ds_read_b128 v[240:243],v18 offset:24576
s_waitcnt lgkmcnt(5)
v_mfma_f32_16x16x32_bf16 v[64:67],a[24:27],v[248:251],v[64:67]
v_cmp_gt_u32 vcc,s96,v29
v_cmp_gt_u32 s[92:93],s92,v29
v_min3_u32 v27,v27,v248,v252
v_mfma_f32_16x16x32_bf16 v[68:71],a[136:139],v[248:251],v[68:71]
ds_read_b128 v[244:247],v18 offset:26624
buffer_load_dwordx4 v16,s[20:23],s65 offen offset:2048 sc1 lds
v_mfma_f32_16x16x32_bf16 v[64:67],a[28:31],v[252:255],v[64:67]
v_mov_b32 v44,vcc_lo
v_mov_b32 v45,s92
s_xor_b32 m0,s72,16384
v_mfma_f32_16x16x32_bf16 v[68:71],a[140:143],v[252:255],v[68:71]
ds_read_b128 v[248:251],v18 offset:28672
s_add_u32 s65,s88,32768
s_waitcnt lgkmcnt(5)
v_mfma_f32_16x16x32_bf16 v[64:67],a[32:35],v[224:227],v[64:67]
ds_write_b64 v46,v[44:45]
v_min3_u32 v27,v27,v224,v228
v_mfma_f32_16x16x32_bf16 v[68:71],a[144:147],v[224:227],v[68:71]
ds_read_b128 v[252:255],v18 offset:30720
buffer_load_dwordx4 v16,s[20:23],s65 offen offset:0 sc1 lds
v_mfma_f32_16x16x32_bf16 v[64:67],a[36:39],v[228:231],v[64:67]
buffer_load_dwordx4 v16,s[20:23],s65 offen offset:2048 sc1 lds
v_mfma_f32_16x16x32_bf16 v[68:71],a[148:151],v[228:231],v[68:71]
ds_read_b128 v[224:227],v18 offset:32768
s_waitcnt lgkmcnt(6)
v_mfma_f32_16x16x32_bf16 v[64:67],a[40:43],v[232:235],v[64:67]
s_xor_b32 m0,s72,32768
v_min3_u32 v27,v27,v232,v236
v_mfma_f32_16x16x32_bf16 v[68:71],a[152:155],v[232:235],v[68:71]
ds_read_b128 v[228:231],v18 offset:34816
v_mfma_f32_16x16x32_bf16 v[64:67],a[44:47],v[236:239],v[64:67]
s_add_u32 s65,s88,65536
v_mfma_f32_16x16x32_bf16 v[68:71],a[156:159],v[236:239],v[68:71]
ds_read_b128 v[232:235],v18 offset:36864
s_waitcnt lgkmcnt(6)
v_mfma_f32_16x16x32_bf16 v[64:67],a[48:51],v[240:243],v[64:67]
buffer_load_dwordx4 v16,s[20:23],s65 offen offset:0 sc1 lds
v_mfma_f32_16x16x32_bf16 v[68:71],a[160:163],v[240:243],v[68:71]
ds_read_b128 v[236:239],v18 offset:38912
v_min3_u32 v27,v27,v240,v244
v_mfma_f32_16x16x32_bf16 v[64:67],a[52:55],v[244:247],v[64:67]
buffer_load_dwordx4 v16,s[20:23],s65 offen offset:2048 sc1 lds
v_mfma_f32_16x16x32_bf16 v[68:71],a[164:167],v[244:247],v[68:71]
ds_read_b128 v[240:243],v18 offset:40960
s_waitcnt lgkmcnt(5)
v_mfma_f32_16x16x32_bf16 v[64:67],a[56:59],v[248:251],v[64:67]
s_xor_b32 m0,s72,49152
v_min3_u32 v27,v27,v248,v252
v_mfma_f32_16x16x32_bf16 v[68:71],a[168:171],v[248:251],v[68:71]
ds_read_b128 v[244:247],v18 offset:43008
s_add_u32 s65,s88,s86
v_mfma_f32_16x16x32_bf16 v[64:67],a[60:63],v[252:255],v[64:67]
buffer_load_dwordx2 v[122:123],v24,s[20:23],s70 offen sc1
v_mfma_f32_16x16x32_bf16 v[68:71],a[172:175],v[252:255],v[68:71]
ds_read_b128 v[248:251],v18 offset:45056
s_waitcnt lgkmcnt(5)
v_mfma_f32_16x16x32_bf16 v[64:67],a[64:67],v[224:227],v[64:67]
s_waitcnt vmcnt(14)
s_barrier
ds_read_b64 v[44:45],v47
ds_read_b128 v[128:131],v17 offset:0
ds_read_b128 v[132:135],v17 offset:2048
v_mfma_f32_16x16x32_bf16 v[68:71],a[176:179],v[224:227],v[68:71]
ds_read_b128 v[252:255],v18 offset:47104
buffer_load_dwordx4 v16,s[20:23],s65 offen offset:0 sc1 lds
v_min3_u32 v27,v27,v224,v228
v_mfma_f32_16x16x32_bf16 v[64:67],a[68:71],v[228:231],v[64:67]
ds_read_b128 v[136:139],v17 offset:4096
buffer_load_dwordx4 v16,s[20:23],s65 offen offset:2048 sc1 lds
v_mfma_f32_16x16x32_bf16 v[68:71],a[180:183],v[228:231],v[68:71]
ds_read_b128 v[224:227],v18 offset:49152
s_xor_b32 m0,s72,1024
s_waitcnt lgkmcnt(9)
v_mfma_f32_16x16x32_bf16 v[64:67],a[72:75],v[232:235],v[64:67]
ds_read_b128 v[140:143],v17 offset:6144
v_min3_u32 v27,v27,v232,v236
v_mfma_f32_16x16x32_bf16 v[68:71],a[184:187],v[232:235],v[68:71]
ds_read_b128 v[228:231],v18 offset:51200
s_add_u32 s65,s89,0
v_mfma_f32_16x16x32_bf16 v[64:67],a[76:79],v[236:239],v[64:67]
ds_read_b128 v[144:147],v17 offset:8192
ds_read_b128 v[148:151],v17 offset:10240
v_mfma_f32_16x16x32_bf16 v[68:71],a[188:191],v[236:239],v[68:71]
ds_read_b128 v[232:235],v18 offset:53248
s_waitcnt lgkmcnt(12)
v_mfma_f32_16x16x32_bf16 v[64:67],a[80:83],v[240:243],v[64:67]
ds_read_b128 v[152:155],v17 offset:12288
s_waitcnt lgkmcnt(11)
v_min3_u32 v27,v27,v240,v244
v_mfma_f32_16x16x32_bf16 v[68:71],a[192:195],v[240:243],v[68:71]
ds_read_b128 v[236:239],v18 offset:55296
v_readfirstlane_b32 s93,v45
v_mfma_f32_16x16x32_bf16 v[64:67],a[84:87],v[244:247],v[64:67]
ds_read_b128 v[156:159],v17 offset:14336
buffer_load_dwordx4 v16,s[20:23],s65 offen offset:0 sc1 lds
v_mfma_f32_16x16x32_bf16 v[68:71],a[196:199],v[244:247],v[68:71]
buffer_load_dwordx4 v16,s[20:23],s65 offen offset:2048 sc1 lds
s_waitcnt lgkmcnt(10)
v_mfma_f32_16x16x32_bf16 v[64:67],a[88:91],v[248:251],v[64:67]
ds_read_b128 v[160:163],v17 offset:16384
ds_read_b128 v[164:167],v17 offset:18432
s_xor_b32 m0,s72,17408
v_mfma_f32_16x16x32_bf16 v[68:71],a[200:203],v[248:251],v[68:71]
s_add_u32 s65,s89,32768
v_min3_u32 v27,v27,v248,v252
v_mfma_f32_16x16x32_bf16 v[64:67],a[92:95],v[252:255],v[64:67]
ds_read_b128 v[168:171],v17 offset:20480
buffer_load_dwordx4 v16,s[20:23],s65 offen offset:0 sc1 lds
v_mfma_f32_16x16x32_bf16 v[68:71],a[204:207],v[252:255],v[68:71]
s_waitcnt lgkmcnt(9)
v_mfma_f32_16x16x32_bf16 v[64:67],a[96:99],v[224:227],v[64:67]
ds_read_b128 v[172:175],v17 offset:22528
buffer_load_dwordx4 v16,s[20:23],s65 offen offset:2048 sc1 lds
v_mfma_f32_16x16x32_bf16 v[68:71],a[208:211],v[224:227],v[68:71]
v_min3_u32 v27,v27,v224,v228
v_min3_u32 v27,v27,v226,v230
v_mfma_f32_16x16x32_bf16 v[64:67],a[100:103],v[228:231],v[64:67]
ds_read_b128 v[176:179],v17 offset:24576
ds_read_b128 v[180:183],v17 offset:26624
s_xor_b32 m0,s72,33792
v_mfma_f32_16x16x32_bf16 v[68:71],a[212:215],v[228:231],v[68:71]
s_waitcnt lgkmcnt(7)
v_mfma_f32_16x16x32_bf16 v[64:67],a[104:107],v[232:235],v[64:67]
ds_read_b128 v[184:187],v17 offset:28672
s_add_u32 s65,s89,65536
v_min3_u32 v27,v27,v232,v236
v_mfma_f32_16x16x32_bf16 v[68:71],a[216:219],v[232:235],v[68:71]
buffer_load_dwordx4 v16,s[20:23],s65 offen offset:0 sc1 lds
v_mfma_f32_16x16x32_bf16 v[64:67],a[108:111],v[236:239],v[64:67]
ds_read_b128 v[188:191],v17 offset:30720
v_min3_u32 v27,v27,v234,v238
v_mfma_f32_16x16x32_bf16 v[68:71],a[220:223],v[236:239],v[68:71]
buffer_load_dwordx4 v16,s[20:23],s65 offen offset:2048 sc1 lds
v_mfma_f32_16x16x32_bf16 v[72:75],a[112:115],v[128:131],0
v_cmp_eq_u32 vcc,0,v27
s_cbranch_vccnz retry_326
v_mfma_f32_16x16x32_bf16 v[76:79],a[116:119],v[132:135],0
s_xor_b32 m0,s72,50176
v_min3_u32 v27,v27,v128,v132
v_mfma_f32_16x16x32_bf16 v[72:75],a[120:123],v[136:139],v[72:75]
ds_read_b128 v[192:195],v17 offset:32768
v_mfma_f32_16x16x32_bf16 v[76:79],a[124:127],v[140:143],v[76:79]
ds_read_b128 v[196:199],v17 offset:34816
s_add_u32 s65,s89,s86
s_waitcnt lgkmcnt(10)
v_mfma_f32_16x16x32_bf16 v[72:75],a[128:131],v[144:147],v[72:75]
ds_read_b128 v[200:203],v17 offset:36864
v_min3_u32 v27,v27,v136,v140
s_waitcnt vmcnt(8)
v_mfma_f32_16x16x32_bf16 v[76:79],a[132:135],v[148:151],v[76:79]
ds_read_b128 v[204:207],v17 offset:38912
buffer_load_dwordx4 v16,s[20:23],s65 offen offset:0 sc1 lds
v_mfma_f32_16x16x32_bf16 v[72:75],a[136:139],v[152:155],v[72:75]
ds_read_b128 v[208:211],v17 offset:40960
v_min3_u32 v27,v27,v144,v148
v_and_or_b32 v64,v64,-4,s48
v_mfma_f32_16x16x32_bf16 v[76:79],a[140:143],v[156:159],v[76:79]
buffer_load_dwordx4 v16,s[20:23],s65 offen offset:2048 sc1 lds
s_waitcnt lgkmcnt(9)
v_mfma_f32_16x16x32_bf16 v[72:75],a[144:147],v[160:163],v[72:75]
ds_read_b128 v[212:215],v17 offset:43008
v_min3_u32 v27,v27,v152,v156
s_add_u32 s64,s49,s34
v_mfma_f32_16x16x32_bf16 v[76:79],a[148:151],v[164:167],v[76:79]
ds_read_b128 v[216:219],v17 offset:45056
v_min3_u32 v27,v27,v160,v164
v_mfma_f32_16x16x32_bf16 v[72:75],a[152:155],v[168:171],v[72:75]
ds_read_b128 v[220:223],v17 offset:47104
buffer_store_dwordx4 v[64:67],v25,s[20:23],s64 offen offset:2048
v_mfma_f32_16x16x32_bf16 v[76:79],a[156:159],v[172:175],v[76:79]
ds_read_b128 v[224:227],v17 offset:49152
v_and_or_b32 v68,v68,-4,s48
s_waitcnt lgkmcnt(9)
v_mfma_f32_16x16x32_bf16 v[72:75],a[160:163],v[176:179],v[72:75]
ds_read_b128 v[228:231],v17 offset:51200
v_min3_u32 v27,v27,v168,v172
s_add_u32 s64,s49,s35
v_mfma_f32_16x16x32_bf16 v[76:79],a[164:167],v[180:183],v[76:79]
v_min3_u32 v27,v27,v176,v180
buffer_store_dwordx4 v[68:71],v25,s[20:23],s64 offen offset:3072
v_mfma_f32_16x16x32_bf16 v[72:75],a[168:171],v[184:187],v[72:75]
ds_read_b128 v[232:235],v17 offset:53248
s_mov_b32 s49,0x7fff0000
v_mfma_f32_16x16x32_bf16 v[76:79],a[172:175],v[188:191],v[76:79]
ds_read_b128 v[236:239],v17 offset:55296
s_waitcnt lgkmcnt(8)
v_mfma_f32_16x16x32_bf16 v[72:75],a[176:179],v[192:195],v[72:75]
v_min3_u32 v27,v27,v184,v188
v_mfma_f32_16x16x32_bf16 v[76:79],a[180:183],v[196:199],v[76:79]
v_min3_u32 v27,v27,v192,v196
ds_bpermute_b32 v124,v41,v120
v_mfma_f32_16x16x32_bf16 v[72:75],a[184:187],v[200:203],v[72:75]
v_mfma_f32_16x16x32_bf16 v[76:79],a[188:191],v[204:207],v[76:79]
v_min3_u32 v27,v27,v200,v204
s_waitcnt lgkmcnt(5)
v_mfma_f32_16x16x32_bf16 v[72:75],a[192:195],v[208:211],v[72:75]
ds_bpermute_b32 v125,v41,v121
v_mfma_f32_16x16x32_bf16 v[76:79],a[196:199],v[212:215],v[76:79]
v_min3_u32 v27,v27,v208,v212
v_lshlrev_b32 v108,16,v122
v_mfma_f32_16x16x32_bf16 v[72:75],a[200:203],v[216:219],v[72:75]
v_mfma_f32_16x16x32_bf16 v[76:79],a[204:207],v[220:223],v[76:79]
v_min3_u32 v27,v27,v216,v220
s_waitcnt lgkmcnt(2)
v_mfma_f32_16x16x32_bf16 v[72:75],a[208:211],v[224:227],v[72:75]
v_and_b32 v109,s80,v122
v_mfma_f32_16x16x32_bf16 v[76:79],a[212:215],v[228:231],v[76:79]
v_min3_u32 v27,v27,v224,v228
v_min3_u32 v27,v27,v226,v230
v_mfma_f32_16x16x32_bf16 v[72:75],a[216:219],v[232:235],v[72:75]
v_lshlrev_b32 v110,16,v123
v_mfma_f32_16x16x32_bf16 v[76:79],a[220:223],v[236:239],v[76:79]
v_min3_u32 v27,v27,v232,v236
v_min3_u32 v27,v27,v234,v238
v_mfma_f32_16x16x32_bf16 v[80:83],a[0:3],v[128:131],0
v_cmp_eq_u32 vcc,0,v27
s_cbranch_vccnz retry_326
v_mfma_f32_16x16x32_bf16 v[84:87],a[4:7],v[132:135],0
v_and_b32 v111,s80,v123
s_waitcnt lgkmcnt(0)
v_mfma_f32_16x16x32_bf16 v[80:83],a[8:11],v[136:139],v[80:83]
v_mfma_f32_16x16x32_bf16 v[84:87],a[12:15],v[140:143],v[84:87]
v_lshlrev_b32 v104,16,v124
v_mfma_f32_16x16x32_bf16 v[80:83],a[16:19],v[144:147],v[80:83]
v_add_f32 v72,v72,v76
v_add_f32 v73,v73,v77
v_mfma_f32_16x16x32_bf16 v[84:87],a[20:23],v[148:151],v[84:87]
v_and_b32 v105,s80,v124
v_add_f32 v74,v74,v78
v_mfma_f32_16x16x32_bf16 v[80:83],a[24:27],v[152:155],v[80:83]
v_add_f32 v75,v75,v79
v_and_or_b32 v72,v72,-4,s48
v_mfma_f32_16x16x32_bf16 v[84:87],a[28:31],v[156:159],v[84:87]
v_lshlrev_b32 v106,16,v125
s_add_u32 s64,s77,s33
v_mfma_f32_16x16x32_bf16 v[80:83],a[32:35],v[160:163],v[80:83]
buffer_store_dwordx4 v[72:75],v25,s[20:23],s64 offen offset:1024
v_mfma_f32_16x16x32_bf16 v[84:87],a[36:39],v[164:167],v[84:87]
v_and_b32 v107,s80,v125
v_mfma_f32_16x16x32_bf16 v[80:83],a[40:43],v[168:171],v[80:83]
v_mfma_f32_16x16x32_bf16 v[84:87],a[44:47],v[172:175],v[84:87]
v_mfma_f32_16x16x32_bf16 v[80:83],a[48:51],v[176:179],v[80:83]
buffer_load_dwordx4 v[96:99],v26,s[20:23],s77 offen offset:2048 sc1
v_mfma_f32_16x16x32_bf16 v[84:87],a[52:55],v[180:183],v[84:87]
buffer_load_dwordx4 v[100:103],v26,s[20:23],s77 offen offset:3072 sc1
v_mfma_f32_16x16x32_bf16 v[80:83],a[56:59],v[184:187],v[80:83]
v_mfma_f32_16x16x32_bf16 v[84:87],a[60:63],v[188:191],v[84:87]
v_mfma_f32_16x16x32_bf16 v[80:83],a[64:67],v[192:195],v[80:83]
v_mfma_f32_16x16x32_bf16 v[84:87],a[68:71],v[196:199],v[84:87]
v_mfma_f32_16x16x32_bf16 v[80:83],a[72:75],v[200:203],v[80:83]
v_mfma_f32_16x16x32_bf16 v[84:87],a[76:79],v[204:207],v[84:87]
v_mfma_f32_16x16x32_bf16 v[80:83],a[80:83],v[208:211],v[80:83]
v_mfma_f32_16x16x32_bf16 v[84:87],a[84:87],v[212:215],v[84:87]
v_mfma_f32_16x16x32_bf16 v[80:83],a[88:91],v[216:219],v[80:83]
buffer_load_dwordx4 v[92:95],v26,s[20:23],s77 offen offset:1024 sc1
v_mfma_f32_16x16x32_bf16 v[84:87],a[92:95],v[220:223],v[84:87]
v_mfma_f32_16x16x32_bf16 v[80:83],a[96:99],v[224:227],v[80:83]
v_mfma_f32_16x16x32_bf16 v[84:87],a[100:103],v[228:231],v[84:87]
v_mfma_f32_16x16x32_bf16 v[80:83],a[104:107],v[232:235],v[80:83]
v_mfma_f32_16x16x32_bf16 v[84:87],a[108:111],v[236:239],v[84:87]
epi_329:
buffer_load_dword v29,v21,s[20:23],s87 offen sc1
s_nop 6
v_pk_add_f32 v[88:89],v[80:81],v[84:85]
v_pk_add_f32 v[90:91],v[82:83],v[86:87]
v_pk_add_f32 v[88:89],v[88:89],v[108:109]
v_pk_add_f32 v[90:91],v[90:91],v[110:111]
s_waitcnt vmcnt(1)
s_branch ic_341
ip_339:
buffer_load_dwordx4 v[92:95],v26,s[20:23],s77 offen offset:1024 sc1
buffer_load_dwordx4 v[96:99],v26,s[20:23],s77 offen offset:2048 sc1
buffer_load_dwordx4 v[100:103],v26,s[20:23],s77 offen offset:3072 sc1
s_waitcnt vmcnt(0)
ic_341:
v_bitop3_b32 v22,v92,v96,v100 bitop3:0x80
v_and_b32 v22,s48,v22
v_cmp_eq_u32 vcc,0,v22
s_cbranch_vccz ik_340
s_sub_u32 s90,s90,1
s_cmp_gt_i32 s90,0
s_cbranch_scc1 ip_339
ik_340:
s_cmp_lg_u32 s71,65
s_cbranch_scc1 nl_342
buffer_load_dwordx4 v[132:135],v26,s[20:23],s40 offen offset:1024 sc1
buffer_load_dwordx4 v[136:139],v26,s[20:23],s40 offen offset:2048 sc1
buffer_load_dwordx4 v[140:143],v26,s[20:23],s40 offen offset:3072 sc1
nl_342:
v_pk_add_f32 v[88:89],v[88:89],v[92:93]
v_pk_add_f32 v[96:97],v[96:97],v[100:101]
v_pk_add_f32 v[90:91],v[90:91],v[94:95]
v_pk_add_f32 v[98:99],v[98:99],v[102:103]
v_pk_add_f32 v[88:89],v[88:89],v[96:97]
v_pk_add_f32 v[90:91],v[90:91],v[98:99]
v_pk_fma_f32 v[88:89],v[88:89],v[52:53],v[104:105]
v_pk_fma_f32 v[90:91],v[90:91],v[54:55],v[106:107]
v_cvt_pk_bf16_f32 v88,v88,v89
v_cvt_pk_bf16_f32 v89,v90,v91
ds_bpermute_b32 v88,v40,v88
ds_bpermute_b32 v89,v40,v89
v_xor_b32 v18,0x10000,v18
s_xor_b32 s49,s77,524288
s_cselect_b32 s64,0,3
s_xor_b32 s48,s48,s64
s_cmp_eq_u32 s71,63
s_cselect_b32 s64,0,0x2000
s_cselect_b32 s66,2,1
s_cmp_eq_u32 s71,64
s_cselect_b32 s66,-1,s66
v_xor_b32 v20,s64,v20
s_lshl_b32 s64,s66,21
s_add_u32 s76,s76,s64
s_lshl_b32 s66,s66,16
s_waitcnt lgkmcnt(0)
s_mov_b64 exec,s[84:85]
buffer_store_dwordx2 v[88:89],v19,s[36:39],s78 offen
s_mov_b64 exec,-1
s_mov_b64 s[84:85],-1
s_mov_b32 s77,s49
s_add_u32 s78,s78,s66
next_336:
v_xor_b32 v17,0x10000,v17
s_xor_b32 s72,s72,0x10000
s_add_u32 s70,s70,2097152
s_xor_b32 s70,s70,0x2000
s_add_u32 s71,s71,1
s_cmp_le_u32 s71,s57
s_cbranch_scc1 seg_327
s_cmp_lg_u32 s43,0
s_cbranch_scc1 hn_346
s_waitcnt vmcnt(1)
s_branch hc_345
hp_343:
buffer_load_dwordx4 v[132:135],v26,s[20:23],s40 offen offset:1024 sc1
buffer_load_dwordx4 v[136:139],v26,s[20:23],s40 offen offset:2048 sc1
buffer_load_dwordx4 v[140:143],v26,s[20:23],s40 offen offset:3072 sc1
s_waitcnt vmcnt(0)
hc_345:
v_bitop3_b32 v22,v132,v136,v140 bitop3:0x80
v_and_b32 v22,s60,v22
v_cmp_eq_u32 vcc,0,v22
s_cbranch_vccz hk_344
s_sub_u32 s90,s90,1
s_cmp_gt_i32 s90,0
s_cbranch_scc1 hp_343
hk_344:
v_pk_add_f32 v[112:113],v[112:113],v[132:133]
v_pk_add_f32 v[136:137],v[136:137],v[140:141]
v_pk_add_f32 v[114:115],v[114:115],v[134:135]
v_pk_add_f32 v[138:139],v[138:139],v[142:143]
v_pk_add_f32 v[112:113],v[112:113],v[136:137]
v_pk_add_f32 v[114:115],v[114:115],v[138:139]
v_pk_fma_f32 v[112:113],v[112:113],v[52:53],v[116:117]
v_pk_fma_f32 v[114:115],v[114:115],v[54:55],v[118:119]
v_cvt_pk_bf16_f32 v112,v112,v113
v_cvt_pk_bf16_f32 v113,v114,v115
ds_bpermute_b32 v112,v40,v112
ds_bpermute_b32 v113,v40,v113
s_mov_b32 s64,4194304
s_waitcnt lgkmcnt(0)
buffer_store_dwordx2 v[112:113],v19,s[36:39],s64 offen
hn_346:
s_endpgm
retry_326:
s_sub_u32 s90,s90,64
s_cmp_lt_i32 s90,0
s_cbranch_scc1 giveup_197
s_mov_b32 s83,1
s_waitcnt vmcnt(0) lgkmcnt(0)
s_barrier
s_branch seg_327
half_335:
s_cmp_eq_u32 s43,0
s_cbranch_scc1 hown_347
s_mov_b64 exec,s[52:53]
s_xor_b32 m0,s91,0
s_add_u32 s65,s94,0
buffer_load_dwordx4 v16,s[20:23],s65 offen offset:0 sc1 lds
buffer_load_dwordx4 v16,s[20:23],s65 offen offset:2048 sc1 lds
s_xor_b32 m0,s91,16384
s_add_u32 s65,s94,32768
buffer_load_dwordx4 v16,s[20:23],s65 offen offset:0 sc1 lds
buffer_load_dwordx4 v16,s[20:23],s65 offen offset:2048 sc1 lds
s_xor_b32 m0,s91,32768
s_add_u32 s65,s94,65536
buffer_load_dwordx4 v16,s[20:23],s65 offen offset:0 sc1 lds
buffer_load_dwordx4 v16,s[20:23],s65 offen offset:2048 sc1 lds
s_xor_b32 m0,s91,49152
s_add_u32 s65,s94,s86
buffer_load_dwordx4 v16,s[20:23],s65 offen offset:0 sc1 lds
buffer_load_dwordx4 v16,s[20:23],s65 offen offset:2048 sc1 lds
s_mov_b64 exec,-1
h2a_348:
s_waitcnt vmcnt(6)
s_barrier
ds_read_b128 v[224:227],v18 offset:0
ds_read_b128 v[228:231],v18 offset:2048
ds_read_b128 v[232:235],v18 offset:4096
ds_read_b128 v[236:239],v18 offset:6144
ds_read_b128 v[240:243],v18 offset:8192
ds_read_b128 v[244:247],v18 offset:10240
ds_read_b128 v[248:251],v18 offset:12288
s_waitcnt lgkmcnt(5)
v_mfma_f32_16x16x32_bf16 v[64:67],a[0:3],v[224:227],0
v_min_u32 v27,v224,v228
v_mfma_f32_16x16x32_bf16 v[68:71],a[112:115],v[224:227],0
ds_read_b128 v[252:255],v18 offset:14336
v_mfma_f32_16x16x32_bf16 v[64:67],a[4:7],v[228:231],v[64:67]
v_mfma_f32_16x16x32_bf16 v[68:71],a[116:119],v[228:231],v[68:71]
s_waitcnt vmcnt(4)
s_barrier
ds_read_b128 v[224:227],v18 offset:16384
s_waitcnt lgkmcnt(5)
v_mfma_f32_16x16x32_bf16 v[64:67],a[8:11],v[232:235],v[64:67]
v_min3_u32 v27,v27,v232,v236
v_mfma_f32_16x16x32_bf16 v[68:71],a[120:123],v[232:235],v[68:71]
ds_read_b128 v[228:231],v18 offset:18432
v_mfma_f32_16x16x32_bf16 v[64:67],a[12:15],v[236:239],v[64:67]
v_mfma_f32_16x16x32_bf16 v[68:71],a[124:127],v[236:239],v[68:71]
ds_read_b128 v[232:235],v18 offset:20480
s_waitcnt lgkmcnt(5)
v_mfma_f32_16x16x32_bf16 v[64:67],a[16:19],v[240:243],v[64:67]
v_min3_u32 v27,v27,v240,v244
v_mfma_f32_16x16x32_bf16 v[68:71],a[128:131],v[240:243],v[68:71]
ds_read_b128 v[236:239],v18 offset:22528
v_mfma_f32_16x16x32_bf16 v[64:67],a[20:23],v[244:247],v[64:67]
v_mfma_f32_16x16x32_bf16 v[68:71],a[132:135],v[244:247],v[68:71]
ds_read_b128 v[240:243],v18 offset:24576
s_waitcnt lgkmcnt(5)
v_mfma_f32_16x16x32_bf16 v[64:67],a[24:27],v[248:251],v[64:67]
v_min3_u32 v27,v27,v248,v252
v_mfma_f32_16x16x32_bf16 v[68:71],a[136:139],v[248:251],v[68:71]
ds_read_b128 v[244:247],v18 offset:26624
v_mfma_f32_16x16x32_bf16 v[64:67],a[28:31],v[252:255],v[64:67]
v_mfma_f32_16x16x32_bf16 v[68:71],a[140:143],v[252:255],v[68:71]
ds_read_b128 v[248:251],v18 offset:28672
s_waitcnt lgkmcnt(5)
v_mfma_f32_16x16x32_bf16 v[64:67],a[32:35],v[224:227],v[64:67]
v_min3_u32 v27,v27,v224,v228
v_mfma_f32_16x16x32_bf16 v[68:71],a[144:147],v[224:227],v[68:71]
ds_read_b128 v[252:255],v18 offset:30720
v_mfma_f32_16x16x32_bf16 v[64:67],a[36:39],v[228:231],v[64:67]
v_mfma_f32_16x16x32_bf16 v[68:71],a[148:151],v[228:231],v[68:71]
s_waitcnt vmcnt(0)
s_barrier
ds_read_b128 v[224:227],v18 offset:32768
s_waitcnt lgkmcnt(5)
v_mfma_f32_16x16x32_bf16 v[64:67],a[40:43],v[232:235],v[64:67]
v_min3_u32 v27,v27,v232,v236
v_mfma_f32_16x16x32_bf16 v[68:71],a[152:155],v[232:235],v[68:71]
ds_read_b128 v[228:231],v18 offset:34816
v_mfma_f32_16x16x32_bf16 v[64:67],a[44:47],v[236:239],v[64:67]
v_mfma_f32_16x16x32_bf16 v[68:71],a[156:159],v[236:239],v[68:71]
ds_read_b128 v[232:235],v18 offset:36864
s_waitcnt lgkmcnt(5)
v_mfma_f32_16x16x32_bf16 v[64:67],a[48:51],v[240:243],v[64:67]
v_min3_u32 v27,v27,v240,v244
v_mfma_f32_16x16x32_bf16 v[68:71],a[160:163],v[240:243],v[68:71]
ds_read_b128 v[236:239],v18 offset:38912
v_mfma_f32_16x16x32_bf16 v[64:67],a[52:55],v[244:247],v[64:67]
v_mfma_f32_16x16x32_bf16 v[68:71],a[164:167],v[244:247],v[68:71]
ds_read_b128 v[240:243],v18 offset:40960
s_waitcnt lgkmcnt(5)
v_mfma_f32_16x16x32_bf16 v[64:67],a[56:59],v[248:251],v[64:67]
v_min3_u32 v27,v27,v248,v252
v_mfma_f32_16x16x32_bf16 v[68:71],a[168:171],v[248:251],v[68:71]
ds_read_b128 v[244:247],v18 offset:43008
v_mfma_f32_16x16x32_bf16 v[64:67],a[60:63],v[252:255],v[64:67]
v_mfma_f32_16x16x32_bf16 v[68:71],a[172:175],v[252:255],v[68:71]
ds_read_b128 v[248:251],v18 offset:45056
s_waitcnt lgkmcnt(5)
v_mfma_f32_16x16x32_bf16 v[64:67],a[64:67],v[224:227],v[64:67]
v_min3_u32 v27,v27,v224,v228
v_mfma_f32_16x16x32_bf16 v[68:71],a[176:179],v[224:227],v[68:71]
ds_read_b128 v[252:255],v18 offset:47104
v_mfma_f32_16x16x32_bf16 v[64:67],a[68:71],v[228:231],v[64:67]
v_mfma_f32_16x16x32_bf16 v[68:71],a[180:183],v[228:231],v[68:71]
ds_read_b128 v[224:227],v18 offset:49152
s_waitcnt lgkmcnt(5)
v_mfma_f32_16x16x32_bf16 v[64:67],a[72:75],v[232:235],v[64:67]
v_min3_u32 v27,v27,v232,v236
v_mfma_f32_16x16x32_bf16 v[68:71],a[184:187],v[232:235],v[68:71]
ds_read_b128 v[228:231],v18 offset:51200
v_mfma_f32_16x16x32_bf16 v[64:67],a[76:79],v[236:239],v[64:67]
v_mfma_f32_16x16x32_bf16 v[68:71],a[188:191],v[236:239],v[68:71]
ds_read_b128 v[232:235],v18 offset:53248
s_waitcnt lgkmcnt(5)
v_mfma_f32_16x16x32_bf16 v[64:67],a[80:83],v[240:243],v[64:67]
v_min3_u32 v27,v27,v240,v244
v_mfma_f32_16x16x32_bf16 v[68:71],a[192:195],v[240:243],v[68:71]
ds_read_b128 v[236:239],v18 offset:55296
v_mfma_f32_16x16x32_bf16 v[64:67],a[84:87],v[244:247],v[64:67]
v_mfma_f32_16x16x32_bf16 v[68:71],a[196:199],v[244:247],v[68:71]
s_waitcnt lgkmcnt(4)
v_mfma_f32_16x16x32_bf16 v[64:67],a[88:91],v[248:251],v[64:67]
v_min3_u32 v27,v27,v248,v252
v_mfma_f32_16x16x32_bf16 v[68:71],a[200:203],v[248:251],v[68:71]
v_mfma_f32_16x16x32_bf16 v[64:67],a[92:95],v[252:255],v[64:67]
v_mfma_f32_16x16x32_bf16 v[68:71],a[204:207],v[252:255],v[68:71]
s_waitcnt lgkmcnt(2)
v_mfma_f32_16x16x32_bf16 v[64:67],a[96:99],v[224:227],v[64:67]
v_min3_u32 v27,v27,v224,v228
v_min3_u32 v27,v27,v226,v230
v_mfma_f32_16x16x32_bf16 v[68:71],a[208:211],v[224:227],v[68:71]
v_mfma_f32_16x16x32_bf16 v[64:67],a[100:103],v[228:231],v[64:67]
v_mfma_f32_16x16x32_bf16 v[68:71],a[212:215],v[228:231],v[68:71]
s_waitcnt lgkmcnt(0)
v_mfma_f32_16x16x32_bf16 v[64:67],a[104:107],v[232:235],v[64:67]
v_min3_u32 v27,v27,v232,v236
v_min3_u32 v27,v27,v234,v238
v_mfma_f32_16x16x32_bf16 v[68:71],a[216:219],v[232:235],v[68:71]
v_mfma_f32_16x16x32_bf16 v[64:67],a[108:111],v[236:239],v[64:67]
v_mfma_f32_16x16x32_bf16 v[68:71],a[220:223],v[236:239],v[68:71]
v_cmp_eq_u32 vcc,0,v27
s_and_b64 vcc,vcc,s[52:53]
s_cbranch_vccnz retry_326
buffer_load_dword v29,v21,s[20:23],s87 offen sc1
s_mov_b32 s40,0x7fff0000
s_nop 5
v_and_or_b32 v64,v64,-4,s48
s_add_u32 s64,s77,s34
buffer_store_dwordx4 v[64:67],v25,s[20:23],s64 offen offset:2048
v_and_or_b32 v68,v68,-4,s48
s_add_u32 s64,s77,s35
buffer_store_dwordx4 v[68:71],v25,s[20:23],s64 offen offset:3072
hjoin_350:
v_xor_b32 v18,0x10000,v18
s_xor_b32 s49,s77,524288
s_cselect_b32 s64,0,3
s_xor_b32 s48,s48,s64
v_xor_b32 v20,0x2000,v20
s_sub_u32 s76,s76,2097152
s_mov_b32 s77,s49
s_sub_u32 s78,s78,65536
s_branch next_336
half2_332:
s_cmp_eq_u32 s43,0
s_cbranch_scc1 h2b_349
s_branch h2a_348
hown_347:
s_mov_b64 exec,s[52:53]
s_xor_b32 m0,s91,1024
s_add_u32 s65,s95,0
buffer_load_dwordx4 v16,s[20:23],s65 offen offset:0 sc1 lds
buffer_load_dwordx4 v16,s[20:23],s65 offen offset:2048 sc1 lds
s_xor_b32 m0,s91,17408
s_add_u32 s65,s95,32768
buffer_load_dwordx4 v16,s[20:23],s65 offen offset:0 sc1 lds
buffer_load_dwordx4 v16,s[20:23],s65 offen offset:2048 sc1 lds
s_xor_b32 m0,s91,33792
s_add_u32 s65,s95,65536
buffer_load_dwordx4 v16,s[20:23],s65 offen offset:0 sc1 lds
buffer_load_dwordx4 v16,s[20:23],s65 offen offset:2048 sc1 lds
s_xor_b32 m0,s91,50176
s_add_u32 s65,s95,s86
buffer_load_dwordx4 v16,s[20:23],s65 offen offset:0 sc1 lds
buffer_load_dwordx4 v16,s[20:23],s65 offen offset:2048 sc1 lds
s_mov_b64 exec,-1
h2b_349:
buffer_load_dwordx2 v[120:121],v20,s[20:23],s76 offen sc1
buffer_load_dwordx2 v[122:123],v24,s[20:23],s70 offen sc1
s_waitcnt vmcnt(8)
s_barrier
ds_read_b128 v[128:131],v17 offset:0
ds_read_b128 v[132:135],v17 offset:2048
ds_read_b128 v[136:139],v17 offset:4096
ds_read_b128 v[140:143],v17 offset:6144
ds_read_b128 v[144:147],v17 offset:8192
ds_read_b128 v[148:151],v17 offset:10240
ds_read_b128 v[152:155],v17 offset:12288
s_waitcnt lgkmcnt(5)
v_mfma_f32_16x16x32_bf16 v[72:75],a[112:115],v[128:131],0
v_min_u32 v27,v128,v132
v_mfma_f32_16x16x32_bf16 v[80:83],a[0:3],v[128:131],0
ds_read_b128 v[156:159],v17 offset:14336
v_mfma_f32_16x16x32_bf16 v[76:79],a[116:119],v[132:135],0
v_mfma_f32_16x16x32_bf16 v[84:87],a[4:7],v[132:135],0
s_waitcnt vmcnt(6)
s_barrier
ds_read_b128 v[160:163],v17 offset:16384
s_waitcnt lgkmcnt(5)
v_mfma_f32_16x16x32_bf16 v[72:75],a[120:123],v[136:139],v[72:75]
v_min3_u32 v27,v27,v136,v140
v_mfma_f32_16x16x32_bf16 v[80:83],a[8:11],v[136:139],v[80:83]
ds_read_b128 v[164:167],v17 offset:18432
v_mfma_f32_16x16x32_bf16 v[76:79],a[124:127],v[140:143],v[76:79]
v_mfma_f32_16x16x32_bf16 v[84:87],a[12:15],v[140:143],v[84:87]
ds_read_b128 v[168:171],v17 offset:20480
s_waitcnt lgkmcnt(5)
v_mfma_f32_16x16x32_bf16 v[72:75],a[128:131],v[144:147],v[72:75]
v_min3_u32 v27,v27,v144,v148
v_mfma_f32_16x16x32_bf16 v[80:83],a[16:19],v[144:147],v[80:83]
ds_read_b128 v[172:175],v17 offset:22528
v_mfma_f32_16x16x32_bf16 v[76:79],a[132:135],v[148:151],v[76:79]
v_mfma_f32_16x16x32_bf16 v[84:87],a[20:23],v[148:151],v[84:87]
ds_read_b128 v[176:179],v17 offset:24576
s_waitcnt lgkmcnt(5)
v_mfma_f32_16x16x32_bf16 v[72:75],a[136:139],v[152:155],v[72:75]
v_min3_u32 v27,v27,v152,v156
v_mfma_f32_16x16x32_bf16 v[80:83],a[24:27],v[152:155],v[80:83]
ds_read_b128 v[180:183],v17 offset:26624
v_mfma_f32_16x16x32_bf16 v[76:79],a[140:143],v[156:159],v[76:79]
v_mfma_f32_16x16x32_bf16 v[84:87],a[28:31],v[156:159],v[84:87]
ds_read_b128 v[184:187],v17 offset:28672
s_waitcnt lgkmcnt(5)
v_mfma_f32_16x16x32_bf16 v[72:75],a[144:147],v[160:163],v[72:75]
v_min3_u32 v27,v27,v160,v164
v_mfma_f32_16x16x32_bf16 v[80:83],a[32:35],v[160:163],v[80:83]
ds_read_b128 v[188:191],v17 offset:30720
v_mfma_f32_16x16x32_bf16 v[76:79],a[148:151],v[164:167],v[76:79]
v_mfma_f32_16x16x32_bf16 v[84:87],a[36:39],v[164:167],v[84:87]
s_waitcnt vmcnt(2)
s_barrier
ds_read_b128 v[192:195],v17 offset:32768
s_waitcnt lgkmcnt(5)
v_mfma_f32_16x16x32_bf16 v[72:75],a[152:155],v[168:171],v[72:75]
v_min3_u32 v27,v27,v168,v172
v_mfma_f32_16x16x32_bf16 v[80:83],a[40:43],v[168:171],v[80:83]
ds_read_b128 v[196:199],v17 offset:34816
v_mfma_f32_16x16x32_bf16 v[76:79],a[156:159],v[172:175],v[76:79]
v_mfma_f32_16x16x32_bf16 v[84:87],a[44:47],v[172:175],v[84:87]
ds_read_b128 v[200:203],v17 offset:36864
s_waitcnt lgkmcnt(5)
v_mfma_f32_16x16x32_bf16 v[72:75],a[160:163],v[176:179],v[72:75]
v_min3_u32 v27,v27,v176,v180
v_mfma_f32_16x16x32_bf16 v[80:83],a[48:51],v[176:179],v[80:83]
ds_read_b128 v[204:207],v17 offset:38912
v_mfma_f32_16x16x32_bf16 v[76:79],a[164:167],v[180:183],v[76:79]
v_mfma_f32_16x16x32_bf16 v[84:87],a[52:55],v[180:183],v[84:87]
ds_read_b128 v[208:211],v17 offset:40960
s_waitcnt lgkmcnt(5)
v_mfma_f32_16x16x32_bf16 v[72:75],a[168:171],v[184:187],v[72:75]
v_min3_u32 v27,v27,v184,v188
v_mfma_f32_16x16x32_bf16 v[80:83],a[56:59],v[184:187],v[80:83]
ds_read_b128 v[212:215],v17 offset:43008
v_mfma_f32_16x16x32_bf16 v[76:79],a[172:175],v[188:191],v[76:79]
v_mfma_f32_16x16x32_bf16 v[84:87],a[60:63],v[188:191],v[84:87]
ds_read_b128 v[216:219],v17 offset:45056
s_waitcnt lgkmcnt(5)
v_mfma_f32_16x16x32_bf16 v[72:75],a[176:179],v[192:195],v[72:75]
v_min3_u32 v27,v27,v192,v196
s_waitcnt vmcnt(0)
v_mfma_f32_16x16x32_bf16 v[80:83],a[64:67],v[192:195],v[80:83]
ds_read_b128 v[220:223],v17 offset:47104
ds_bpermute_b32 v124,v41,v120
v_mfma_f32_16x16x32_bf16 v[76:79],a[180:183],v[196:199],v[76:79]
ds_bpermute_b32 v125,v41,v121
v_lshlrev_b32 v108,16,v122
v_mfma_f32_16x16x32_bf16 v[84:87],a[68:71],v[196:199],v[84:87]
ds_read_b128 v[224:227],v17 offset:49152
s_waitcnt lgkmcnt(7)
v_mfma_f32_16x16x32_bf16 v[72:75],a[184:187],v[200:203],v[72:75]
v_min3_u32 v27,v27,v200,v204
v_and_b32 v109,s80,v122
v_mfma_f32_16x16x32_bf16 v[80:83],a[72:75],v[200:203],v[80:83]
ds_read_b128 v[228:231],v17 offset:51200
v_lshlrev_b32 v110,16,v123
v_mfma_f32_16x16x32_bf16 v[76:79],a[188:191],v[204:207],v[76:79]
v_and_b32 v111,s80,v123
s_waitcnt lgkmcnt(2)
v_mfma_f32_16x16x32_bf16 v[84:87],a[76:79],v[204:207],v[84:87]
ds_read_b128 v[232:235],v17 offset:53248
v_mfma_f32_16x16x32_bf16 v[72:75],a[192:195],v[208:211],v[72:75]
v_min3_u32 v27,v27,v208,v212
v_lshlrev_b32 v104,16,v124
v_mfma_f32_16x16x32_bf16 v[80:83],a[80:83],v[208:211],v[80:83]
ds_read_b128 v[236:239],v17 offset:55296
v_and_b32 v105,s80,v124
v_mfma_f32_16x16x32_bf16 v[76:79],a[196:199],v[212:215],v[76:79]
v_lshlrev_b32 v106,16,v125
v_and_b32 v107,s80,v125
v_mfma_f32_16x16x32_bf16 v[84:87],a[84:87],v[212:215],v[84:87]
v_mfma_f32_16x16x32_bf16 v[72:75],a[200:203],v[216:219],v[72:75]
v_min3_u32 v27,v27,v216,v220
v_mfma_f32_16x16x32_bf16 v[80:83],a[88:91],v[216:219],v[80:83]
v_mfma_f32_16x16x32_bf16 v[76:79],a[204:207],v[220:223],v[76:79]
v_mfma_f32_16x16x32_bf16 v[84:87],a[92:95],v[220:223],v[84:87]
s_waitcnt lgkmcnt(2)
v_mfma_f32_16x16x32_bf16 v[72:75],a[208:211],v[224:227],v[72:75]
v_min3_u32 v27,v27,v224,v228
v_min3_u32 v27,v27,v226,v230
v_mfma_f32_16x16x32_bf16 v[80:83],a[96:99],v[224:227],v[80:83]
v_mfma_f32_16x16x32_bf16 v[76:79],a[212:215],v[228:231],v[76:79]
v_mfma_f32_16x16x32_bf16 v[84:87],a[100:103],v[228:231],v[84:87]
s_waitcnt lgkmcnt(0)
v_mfma_f32_16x16x32_bf16 v[72:75],a[216:219],v[232:235],v[72:75]
v_min3_u32 v27,v27,v232,v236
v_min3_u32 v27,v27,v234,v238
v_mfma_f32_16x16x32_bf16 v[80:83],a[104:107],v[232:235],v[80:83]
v_mfma_f32_16x16x32_bf16 v[76:79],a[220:223],v[236:239],v[76:79]
v_mfma_f32_16x16x32_bf16 v[84:87],a[108:111],v[236:239],v[84:87]
v_cmp_eq_u32 vcc,0,v27
s_and_b64 vcc,vcc,s[52:53]
s_cbranch_vccnz retry_326
buffer_load_dword v29,v21,s[20:23],s87 offen sc1
s_nop 6
v_add_f32 v72,v72,v76
v_add_f32 v73,v73,v77
v_add_f32 v74,v74,v78
v_add_f32 v75,v75,v79
v_and_or_b32 v72,v72,-4,s48
s_add_u32 s64,s77,s33
buffer_store_dwordx4 v[72:75],v25,s[20:23],s64 offen offset:1024
v_pk_add_f32 v[112:113],v[80:81],v[84:85]
v_pk_add_f32 v[112:113],v[112:113],v[108:109]
v_pk_add_f32 v[114:115],v[82:83],v[86:87]
v_pk_add_f32 v[114:115],v[114:115],v[110:111]
v_mov_b32 v116,v104
v_mov_b32 v117,v105
v_mov_b32 v118,v106
v_mov_b32 v119,v107
s_mov_b32 s40,s77
s_mov_b32 s60,s48
s_branch hjoin_350
kslow_325:
s_add_u32 s64,s79,0
s_lshl_b32 s70,s64,21
s_lshl_b32 s64,s64,13
s_and_b32 s64,s64,0x2000
s_xor_b32 s64,s64,s62
s_add_u32 s70,s70,s64
s_add_u32 s70,s70,29360128
s_mov_b32 s83,1
s_mov_b32 s87,s74
s_cmp_eq_u32 s50,0
s_cselect_b32 s74,s74,0x7fff0000
v_mov_b32 v47,132096
s_lshl_b32 s64,s50,3
s_add_u32 s64,s64,132096
v_mov_b32 v46,s64
v_mov_b32 v29,0
s_mov_b32 s97,0x7fff0000
s_mov_b32 s69,1
s_mov_b32 s68,0
s_mov_b32 s52,0x30003
s_mov_b32 s53,s52
seg_352:
s_add_u32 s94,s70,s75
s_xor_b32 s95,s94,1024
s_xor_b32 s91,s72,0x10000
s_cmp_eq_u32 s69,0
s_mov_b32 s69,1
s_cbranch_scc1 half2_357
s_waitcnt vmcnt(1)
v_cmp_gt_u32 vcc,s71,v29
s_cbranch_vccz nb_356
s_cmp_lg_u32 s50,0
s_cbranch_scc1 nb_356
buffer_load_dword v32,v21,s[20:23],s74 offen sc1
s_sleep 2
pl_358:
buffer_load_dword v33,v21,s[20:23],s74 offen sc1
s_waitcnt vmcnt(1)
v_cmp_gt_u32 vcc,s71,v32
v_mov_b32 v29,v32
s_cbranch_vccz pok_359
buffer_load_dword v32,v21,s[20:23],s74 offen sc1
s_waitcnt vmcnt(1)
v_cmp_gt_u32 vcc,s71,v33
v_mov_b32 v29,v33
s_cbranch_vccz pok_359
s_sub_u32 s90,s90,1
s_cmp_gt_i32 s90,0
s_cbranch_scc1 pl_358
pok_359:
nb_356:
s_cmp_eq_u32 s71,64
s_barrier
s_cbranch_scc1 half_360
s_xor_b32 m0,s91,0
s_add_u32 s65,s94,0
buffer_load_dwordx4 v16,s[20:23],s65 offen offset:0 sc1 lds
buffer_load_dwordx4 v16,s[20:23],s65 offen offset:2048 sc1 lds
s_xor_b32 m0,s91,16384
s_add_u32 s65,s94,32768
buffer_load_dwordx4 v16,s[20:23],s65 offen offset:0 sc1 lds
buffer_load_dwordx4 v16,s[20:23],s65 offen offset:2048 sc1 lds
s_xor_b32 m0,s91,32768
s_add_u32 s65,s94,65536
buffer_load_dwordx4 v16,s[20:23],s65 offen offset:0 sc1 lds
buffer_load_dwordx4 v16,s[20:23],s65 offen offset:2048 sc1 lds
s_xor_b32 m0,s91,49152
s_add_u32 s65,s94,s86
buffer_load_dwordx4 v16,s[20:23],s65 offen offset:0 sc1 lds
buffer_load_dwordx4 v16,s[20:23],s65 offen offset:2048 sc1 lds
s_waitcnt vmcnt(6)
s_barrier
ds_read_b128 v[224:227],v18 offset:0
ds_read_b128 v[228:231],v18 offset:2048
ds_read_b128 v[232:235],v18 offset:4096
ds_read_b128 v[236:239],v18 offset:6144
ds_read_b128 v[240:243],v18 offset:8192
ds_read_b128 v[244:247],v18 offset:10240
ds_read_b128 v[248:251],v18 offset:12288
s_waitcnt lgkmcnt(5)
v_mfma_f32_16x16x32_bf16 v[64:67],a[0:3],v[224:227],0
s_xor_b32 m0,s91,1024
v_min_u32 v27,v224,v228
v_mfma_f32_16x16x32_bf16 v[68:71],a[112:115],v[224:227],0
ds_read_b128 v[252:255],v18 offset:14336
v_mfma_f32_16x16x32_bf16 v[64:67],a[4:7],v[228:231],v[64:67]
s_add_u32 s65,s95,0
v_mfma_f32_16x16x32_bf16 v[68:71],a[116:119],v[228:231],v[68:71]
s_waitcnt vmcnt(4)
s_barrier
ds_read_b128 v[224:227],v18 offset:16384
s_waitcnt lgkmcnt(5)
v_mfma_f32_16x16x32_bf16 v[64:67],a[8:11],v[232:235],v[64:67]
buffer_load_dwordx4 v16,s[20:23],s65 offen offset:0 sc1 lds
v_mfma_f32_16x16x32_bf16 v[68:71],a[120:123],v[232:235],v[68:71]
ds_read_b128 v[228:231],v18 offset:18432
v_min3_u32 v27,v27,v232,v236
v_mfma_f32_16x16x32_bf16 v[64:67],a[12:15],v[236:239],v[64:67]
buffer_load_dwordx4 v16,s[20:23],s65 offen offset:2048 sc1 lds
v_mfma_f32_16x16x32_bf16 v[68:71],a[124:127],v[236:239],v[68:71]
ds_read_b128 v[232:235],v18 offset:20480
s_waitcnt lgkmcnt(5)
v_mfma_f32_16x16x32_bf16 v[64:67],a[16:19],v[240:243],v[64:67]
s_xor_b32 m0,s91,17408
v_min3_u32 v27,v27,v240,v244
v_mfma_f32_16x16x32_bf16 v[68:71],a[128:131],v[240:243],v[68:71]
ds_read_b128 v[236:239],v18 offset:22528
v_mfma_f32_16x16x32_bf16 v[64:67],a[20:23],v[244:247],v[64:67]
s_add_u32 s65,s95,32768
v_mfma_f32_16x16x32_bf16 v[68:71],a[132:135],v[244:247],v[68:71]
ds_read_b128 v[240:243],v18 offset:24576
s_waitcnt lgkmcnt(5)
v_mfma_f32_16x16x32_bf16 v[64:67],a[24:27],v[248:251],v[64:67]
buffer_load_dwordx4 v16,s[20:23],s65 offen offset:0 sc1 lds
v_mfma_f32_16x16x32_bf16 v[68:71],a[136:139],v[248:251],v[68:71]
ds_read_b128 v[244:247],v18 offset:26624
v_min3_u32 v27,v27,v248,v252
v_mfma_f32_16x16x32_bf16 v[64:67],a[28:31],v[252:255],v[64:67]
buffer_load_dwordx4 v16,s[20:23],s65 offen offset:2048 sc1 lds
v_mfma_f32_16x16x32_bf16 v[68:71],a[140:143],v[252:255],v[68:71]
ds_read_b128 v[248:251],v18 offset:28672
s_waitcnt lgkmcnt(5)
v_mfma_f32_16x16x32_bf16 v[64:67],a[32:35],v[224:227],v[64:67]
s_xor_b32 m0,s91,33792
v_min3_u32 v27,v27,v224,v228
v_mfma_f32_16x16x32_bf16 v[68:71],a[144:147],v[224:227],v[68:71]
ds_read_b128 v[252:255],v18 offset:30720
v_mfma_f32_16x16x32_bf16 v[64:67],a[36:39],v[228:231],v[64:67]
s_add_u32 s65,s95,65536
v_mfma_f32_16x16x32_bf16 v[68:71],a[148:151],v[228:231],v[68:71]
s_waitcnt vmcnt(4)
s_barrier
ds_read_b128 v[224:227],v18 offset:32768
s_waitcnt lgkmcnt(5)
v_mfma_f32_16x16x32_bf16 v[64:67],a[40:43],v[232:235],v[64:67]
buffer_load_dwordx4 v16,s[20:23],s65 offen offset:0 sc1 lds
s_add_u32 s88,s70,s75
v_mfma_f32_16x16x32_bf16 v[68:71],a[152:155],v[232:235],v[68:71]
ds_read_b128 v[228:231],v18 offset:34816
v_min3_u32 v27,v27,v232,v236
s_add_u32 s88,s88,2097152
v_mfma_f32_16x16x32_bf16 v[64:67],a[44:47],v[236:239],v[64:67]
buffer_load_dwordx4 v16,s[20:23],s65 offen offset:2048 sc1 lds
v_mfma_f32_16x16x32_bf16 v[68:71],a[156:159],v[236:239],v[68:71]
ds_read_b128 v[232:235],v18 offset:36864
s_waitcnt lgkmcnt(5)
v_mfma_f32_16x16x32_bf16 v[64:67],a[48:51],v[240:243],v[64:67]
s_xor_b32 m0,s91,50176
v_min3_u32 v27,v27,v240,v244
v_mfma_f32_16x16x32_bf16 v[68:71],a[160:163],v[240:243],v[68:71]
ds_read_b128 v[236:239],v18 offset:38912
s_xor_b32 s88,s88,0x2000
v_mfma_f32_16x16x32_bf16 v[64:67],a[52:55],v[244:247],v[64:67]
s_add_u32 s65,s95,s86
s_xor_b32 s89,s88,1024
v_mfma_f32_16x16x32_bf16 v[68:71],a[164:167],v[244:247],v[68:71]
ds_read_b128 v[240:243],v18 offset:40960
s_waitcnt lgkmcnt(5)
v_mfma_f32_16x16x32_bf16 v[64:67],a[56:59],v[248:251],v[64:67]
buffer_load_dwordx4 v16,s[20:23],s65 offen offset:0 sc1 lds
v_mfma_f32_16x16x32_bf16 v[68:71],a[168:171],v[248:251],v[68:71]
ds_read_b128 v[244:247],v18 offset:43008
v_min3_u32 v27,v27,v248,v252
v_mfma_f32_16x16x32_bf16 v[64:67],a[60:63],v[252:255],v[64:67]
buffer_load_dwordx4 v16,s[20:23],s65 offen offset:2048 sc1 lds
v_mfma_f32_16x16x32_bf16 v[68:71],a[172:175],v[252:255],v[68:71]
ds_read_b128 v[248:251],v18 offset:45056
s_waitcnt lgkmcnt(5)
v_mfma_f32_16x16x32_bf16 v[64:67],a[64:67],v[224:227],v[64:67]
s_waitcnt vmcnt(4)
s_barrier
ds_read_b128 v[128:131],v17 offset:0
ds_read_b128 v[132:135],v17 offset:2048
v_mfma_f32_16x16x32_bf16 v[68:71],a[176:179],v[224:227],v[68:71]
ds_read_b128 v[252:255],v18 offset:47104
v_min3_u32 v27,v27,v224,v228
v_mfma_f32_16x16x32_bf16 v[64:67],a[68:71],v[228:231],v[64:67]
ds_read_b128 v[136:139],v17 offset:4096
buffer_load_dwordx2 v[120:121],v20,s[20:23],s76 offen sc1
v_mfma_f32_16x16x32_bf16 v[68:71],a[180:183],v[228:231],v[68:71]
ds_read_b128 v[224:227],v18 offset:49152
s_waitcnt lgkmcnt(8)
v_mfma_f32_16x16x32_bf16 v[64:67],a[72:75],v[232:235],v[64:67]
ds_read_b128 v[140:143],v17 offset:6144
v_min3_u32 v27,v27,v232,v236
v_mfma_f32_16x16x32_bf16 v[68:71],a[184:187],v[232:235],v[68:71]
ds_read_b128 v[228:231],v18 offset:51200
buffer_load_dwordx2 v[122:123],v24,s[20:23],s70 offen sc1
v_mfma_f32_16x16x32_bf16 v[64:67],a[76:79],v[236:239],v[64:67]
ds_read_b128 v[144:147],v17 offset:8192
ds_read_b128 v[148:151],v17 offset:10240
v_mfma_f32_16x16x32_bf16 v[68:71],a[188:191],v[236:239],v[68:71]
ds_read_b128 v[232:235],v18 offset:53248
s_waitcnt lgkmcnt(11)
v_mfma_f32_16x16x32_bf16 v[64:67],a[80:83],v[240:243],v[64:67]
ds_read_b128 v[152:155],v17 offset:12288
v_min3_u32 v27,v27,v240,v244
v_mfma_f32_16x16x32_bf16 v[68:71],a[192:195],v[240:243],v[68:71]
ds_read_b128 v[236:239],v18 offset:55296
v_mfma_f32_16x16x32_bf16 v[64:67],a[84:87],v[244:247],v[64:67]
ds_read_b128 v[156:159],v17 offset:14336
v_mfma_f32_16x16x32_bf16 v[68:71],a[196:199],v[244:247],v[68:71]
s_waitcnt lgkmcnt(10)
v_mfma_f32_16x16x32_bf16 v[64:67],a[88:91],v[248:251],v[64:67]
ds_read_b128 v[160:163],v17 offset:16384
ds_read_b128 v[164:167],v17 offset:18432
v_mfma_f32_16x16x32_bf16 v[68:71],a[200:203],v[248:251],v[68:71]
v_min3_u32 v27,v27,v248,v252
v_mfma_f32_16x16x32_bf16 v[64:67],a[92:95],v[252:255],v[64:67]
ds_read_b128 v[168:171],v17 offset:20480
v_mfma_f32_16x16x32_bf16 v[68:71],a[204:207],v[252:255],v[68:71]
s_waitcnt lgkmcnt(9)
v_mfma_f32_16x16x32_bf16 v[64:67],a[96:99],v[224:227],v[64:67]
ds_read_b128 v[172:175],v17 offset:22528
v_min3_u32 v27,v27,v224,v228
v_mfma_f32_16x16x32_bf16 v[68:71],a[208:211],v[224:227],v[68:71]
v_min3_u32 v27,v27,v226,v230
v_mfma_f32_16x16x32_bf16 v[64:67],a[100:103],v[228:231],v[64:67]
ds_read_b128 v[176:179],v17 offset:24576
ds_read_b128 v[180:183],v17 offset:26624
v_mfma_f32_16x16x32_bf16 v[68:71],a[212:215],v[228:231],v[68:71]
s_waitcnt lgkmcnt(7)
v_mfma_f32_16x16x32_bf16 v[64:67],a[104:107],v[232:235],v[64:67]
ds_read_b128 v[184:187],v17 offset:28672
v_min3_u32 v27,v27,v232,v236
v_mfma_f32_16x16x32_bf16 v[68:71],a[216:219],v[232:235],v[68:71]
v_min3_u32 v27,v27,v234,v238
v_mfma_f32_16x16x32_bf16 v[64:67],a[108:111],v[236:239],v[64:67]
ds_read_b128 v[188:191],v17 offset:30720
v_mfma_f32_16x16x32_bf16 v[68:71],a[220:223],v[236:239],v[68:71]
v_mfma_f32_16x16x32_bf16 v[72:75],a[112:115],v[128:131],0
v_cmp_eq_u32 vcc,0,v27
s_cbranch_vccnz retry_351
v_mfma_f32_16x16x32_bf16 v[76:79],a[116:119],v[132:135],0
v_min3_u32 v27,v27,v128,v132
v_mfma_f32_16x16x32_bf16 v[72:75],a[120:123],v[136:139],v[72:75]
s_waitcnt vmcnt(2)
s_barrier
ds_read_b128 v[192:195],v17 offset:32768
v_mfma_f32_16x16x32_bf16 v[76:79],a[124:127],v[140:143],v[76:79]
ds_read_b128 v[196:199],v17 offset:34816
s_waitcnt lgkmcnt(10)
v_mfma_f32_16x16x32_bf16 v[72:75],a[128:131],v[144:147],v[72:75]
ds_read_b128 v[200:203],v17 offset:36864
v_min3_u32 v27,v27,v136,v140
s_waitcnt vmcnt(0)
v_mfma_f32_16x16x32_bf16 v[76:79],a[132:135],v[148:151],v[76:79]
ds_read_b128 v[204:207],v17 offset:38912
v_min3_u32 v27,v27,v144,v148
v_and_or_b32 v64,v64,-4,s48
v_mfma_f32_16x16x32_bf16 v[72:75],a[136:139],v[152:155],v[72:75]
ds_read_b128 v[208:211],v17 offset:40960
s_add_u32 s64,s49,s34
v_mfma_f32_16x16x32_bf16 v[76:79],a[140:143],v[156:159],v[76:79]
v_min3_u32 v27,v27,v152,v156
s_waitcnt lgkmcnt(9)
v_mfma_f32_16x16x32_bf16 v[72:75],a[144:147],v[160:163],v[72:75]
ds_read_b128 v[212:215],v17 offset:43008
buffer_store_dwordx4 v[64:67],v25,s[20:23],s64 offen offset:2048 sc1
v_mfma_f32_16x16x32_bf16 v[76:79],a[148:151],v[164:167],v[76:79]
ds_read_b128 v[216:219],v17 offset:45056
v_min3_u32 v27,v27,v160,v164
v_and_or_b32 v68,v68,-4,s48
v_mfma_f32_16x16x32_bf16 v[72:75],a[152:155],v[168:171],v[72:75]
ds_read_b128 v[220:223],v17 offset:47104
s_add_u32 s64,s49,s35
v_mfma_f32_16x16x32_bf16 v[76:79],a[156:159],v[172:175],v[76:79]
ds_read_b128 v[224:227],v17 offset:49152
s_waitcnt lgkmcnt(9)
v_mfma_f32_16x16x32_bf16 v[72:75],a[160:163],v[176:179],v[72:75]
ds_read_b128 v[228:231],v17 offset:51200
v_min3_u32 v27,v27,v168,v172
v_mfma_f32_16x16x32_bf16 v[76:79],a[164:167],v[180:183],v[76:79]
v_min3_u32 v27,v27,v176,v180
buffer_store_dwordx4 v[68:71],v25,s[20:23],s64 offen offset:3072 sc1
v_mfma_f32_16x16x32_bf16 v[72:75],a[168:171],v[184:187],v[72:75]
ds_read_b128 v[232:235],v17 offset:53248
s_mov_b32 s49,0x7fff0000
v_mfma_f32_16x16x32_bf16 v[76:79],a[172:175],v[188:191],v[76:79]
ds_read_b128 v[236:239],v17 offset:55296
s_waitcnt lgkmcnt(8)
v_mfma_f32_16x16x32_bf16 v[72:75],a[176:179],v[192:195],v[72:75]
v_min3_u32 v27,v27,v184,v188
v_mfma_f32_16x16x32_bf16 v[76:79],a[180:183],v[196:199],v[76:79]
v_min3_u32 v27,v27,v192,v196
ds_bpermute_b32 v124,v41,v120
v_mfma_f32_16x16x32_bf16 v[72:75],a[184:187],v[200:203],v[72:75]
v_mfma_f32_16x16x32_bf16 v[76:79],a[188:191],v[204:207],v[76:79]
v_min3_u32 v27,v27,v200,v204
s_waitcnt lgkmcnt(5)
v_mfma_f32_16x16x32_bf16 v[72:75],a[192:195],v[208:211],v[72:75]
ds_bpermute_b32 v125,v41,v121
v_mfma_f32_16x16x32_bf16 v[76:79],a[196:199],v[212:215],v[76:79]
v_min3_u32 v27,v27,v208,v212
v_lshlrev_b32 v108,16,v122
v_mfma_f32_16x16x32_bf16 v[72:75],a[200:203],v[216:219],v[72:75]
v_mfma_f32_16x16x32_bf16 v[76:79],a[204:207],v[220:223],v[76:79]
v_min3_u32 v27,v27,v216,v220
s_waitcnt lgkmcnt(2)
v_mfma_f32_16x16x32_bf16 v[72:75],a[208:211],v[224:227],v[72:75]
v_and_b32 v109,s80,v122
v_mfma_f32_16x16x32_bf16 v[76:79],a[212:215],v[228:231],v[76:79]
v_min3_u32 v27,v27,v224,v228
v_min3_u32 v27,v27,v226,v230
v_mfma_f32_16x16x32_bf16 v[72:75],a[216:219],v[232:235],v[72:75]
v_lshlrev_b32 v110,16,v123
v_mfma_f32_16x16x32_bf16 v[76:79],a[220:223],v[236:239],v[76:79]
v_min3_u32 v27,v27,v232,v236
v_min3_u32 v27,v27,v234,v238
v_mfma_f32_16x16x32_bf16 v[80:83],a[0:3],v[128:131],0
v_cmp_eq_u32 vcc,0,v27
s_cbranch_vccnz retry_351
v_mfma_f32_16x16x32_bf16 v[84:87],a[4:7],v[132:135],0
v_and_b32 v111,s80,v123
s_waitcnt lgkmcnt(0)
v_mfma_f32_16x16x32_bf16 v[80:83],a[8:11],v[136:139],v[80:83]
v_mfma_f32_16x16x32_bf16 v[84:87],a[12:15],v[140:143],v[84:87]
v_lshlrev_b32 v104,16,v124
v_mfma_f32_16x16x32_bf16 v[80:83],a[16:19],v[144:147],v[80:83]
v_add_f32 v72,v72,v76
v_add_f32 v73,v73,v77
v_mfma_f32_16x16x32_bf16 v[84:87],a[20:23],v[148:151],v[84:87]
v_and_b32 v105,s80,v124
v_add_f32 v74,v74,v78
v_mfma_f32_16x16x32_bf16 v[80:83],a[24:27],v[152:155],v[80:83]
v_add_f32 v75,v75,v79
v_and_or_b32 v72,v72,-4,s48
v_mfma_f32_16x16x32_bf16 v[84:87],a[28:31],v[156:159],v[84:87]
v_lshlrev_b32 v106,16,v125
s_add_u32 s64,s77,s33
v_mfma_f32_16x16x32_bf16 v[80:83],a[32:35],v[160:163],v[80:83]
buffer_store_dwordx4 v[72:75],v25,s[20:23],s64 offen offset:1024 sc1
v_mfma_f32_16x16x32_bf16 v[84:87],a[36:39],v[164:167],v[84:87]
v_and_b32 v107,s80,v125
v_mfma_f32_16x16x32_bf16 v[80:83],a[40:43],v[168:171],v[80:83]
v_mfma_f32_16x16x32_bf16 v[84:87],a[44:47],v[172:175],v[84:87]
v_mfma_f32_16x16x32_bf16 v[80:83],a[48:51],v[176:179],v[80:83]
buffer_load_dwordx4 v[96:99],v26,s[20:23],s77 offen offset:2048 sc1
v_mfma_f32_16x16x32_bf16 v[84:87],a[52:55],v[180:183],v[84:87]
buffer_load_dwordx4 v[100:103],v26,s[20:23],s77 offen offset:3072 sc1
v_mfma_f32_16x16x32_bf16 v[80:83],a[56:59],v[184:187],v[80:83]
v_mfma_f32_16x16x32_bf16 v[84:87],a[60:63],v[188:191],v[84:87]
v_mfma_f32_16x16x32_bf16 v[80:83],a[64:67],v[192:195],v[80:83]
v_mfma_f32_16x16x32_bf16 v[84:87],a[68:71],v[196:199],v[84:87]
v_mfma_f32_16x16x32_bf16 v[80:83],a[72:75],v[200:203],v[80:83]
v_mfma_f32_16x16x32_bf16 v[84:87],a[76:79],v[204:207],v[84:87]
v_mfma_f32_16x16x32_bf16 v[80:83],a[80:83],v[208:211],v[80:83]
v_mfma_f32_16x16x32_bf16 v[84:87],a[84:87],v[212:215],v[84:87]
v_mfma_f32_16x16x32_bf16 v[80:83],a[88:91],v[216:219],v[80:83]
buffer_load_dwordx4 v[92:95],v26,s[20:23],s77 offen offset:1024 sc1
v_mfma_f32_16x16x32_bf16 v[84:87],a[92:95],v[220:223],v[84:87]
v_mfma_f32_16x16x32_bf16 v[80:83],a[96:99],v[224:227],v[80:83]
v_mfma_f32_16x16x32_bf16 v[84:87],a[100:103],v[228:231],v[84:87]
v_mfma_f32_16x16x32_bf16 v[80:83],a[104:107],v[232:235],v[80:83]
v_mfma_f32_16x16x32_bf16 v[84:87],a[108:111],v[236:239],v[84:87]
epi_354:
buffer_load_dword v29,v21,s[20:23],s87 offen sc1
s_nop 6
v_pk_add_f32 v[88:89],v[80:81],v[84:85]
v_pk_add_f32 v[90:91],v[82:83],v[86:87]
v_pk_add_f32 v[88:89],v[88:89],v[108:109]
v_pk_add_f32 v[90:91],v[90:91],v[110:111]
s_waitcnt vmcnt(1)
s_branch ic_364
ip_362:
buffer_load_dwordx4 v[92:95],v26,s[20:23],s77 offen offset:1024 sc1
buffer_load_dwordx4 v[96:99],v26,s[20:23],s77 offen offset:2048 sc1
buffer_load_dwordx4 v[100:103],v26,s[20:23],s77 offen offset:3072 sc1
s_waitcnt vmcnt(0)
ic_364:
v_bitop3_b32 v22,v92,v96,v100 bitop3:0x80
v_and_b32 v22,s48,v22
v_cmp_eq_u32 vcc,0,v22
s_cbranch_vccz ik_363
s_sub_u32 s90,s90,1
s_cmp_gt_i32 s90,0
s_cbranch_scc1 ip_362
ik_363:
s_cmp_lg_u32 s71,65
s_cbranch_scc1 nl_365
buffer_load_dwordx4 v[132:135],v26,s[20:23],s40 offen offset:1024 sc1
buffer_load_dwordx4 v[136:139],v26,s[20:23],s40 offen offset:2048 sc1
buffer_load_dwordx4 v[140:143],v26,s[20:23],s40 offen offset:3072 sc1
nl_365:
v_pk_add_f32 v[88:89],v[88:89],v[92:93]
v_pk_add_f32 v[96:97],v[96:97],v[100:101]
v_pk_add_f32 v[90:91],v[90:91],v[94:95]
v_pk_add_f32 v[98:99],v[98:99],v[102:103]
v_pk_add_f32 v[88:89],v[88:89],v[96:97]
v_pk_add_f32 v[90:91],v[90:91],v[98:99]
v_pk_fma_f32 v[88:89],v[88:89],v[52:53],v[104:105]
v_pk_fma_f32 v[90:91],v[90:91],v[54:55],v[106:107]
v_cvt_pk_bf16_f32 v88,v88,v89
v_cvt_pk_bf16_f32 v89,v90,v91
ds_bpermute_b32 v88,v40,v88
ds_bpermute_b32 v89,v40,v89
v_xor_b32 v18,0x10000,v18
s_xor_b32 s49,s77,524288
s_cselect_b32 s64,0,3
s_xor_b32 s48,s48,s64
s_cmp_eq_u32 s71,63
s_cselect_b32 s64,0,0x2000
s_cselect_b32 s66,2,1
s_cmp_eq_u32 s71,64
s_cselect_b32 s66,-1,s66
v_xor_b32 v20,s64,v20
s_lshl_b32 s64,s66,21
s_add_u32 s76,s76,s64
s_lshl_b32 s66,s66,16
s_waitcnt lgkmcnt(0)
s_mov_b64 exec,s[84:85]
buffer_store_dwordx2 v[88:89],v19,s[36:39],s78 offen
s_mov_b64 exec,-1
s_mov_b64 s[84:85],-1
s_mov_b32 s77,s49
s_add_u32 s78,s78,s66
next_361:
v_xor_b32 v17,0x10000,v17
s_xor_b32 s72,s72,0x10000
s_add_u32 s70,s70,2097152
s_xor_b32 s70,s70,0x2000
s_add_u32 s71,s71,1
s_cmp_le_u32 s71,s57
s_cbranch_scc1 seg_352
s_cmp_lg_u32 s43,0
s_cbranch_scc1 hn_369
s_waitcnt vmcnt(1)
s_branch hc_368
hp_366:
buffer_load_dwordx4 v[132:135],v26,s[20:23],s40 offen offset:1024 sc1
buffer_load_dwordx4 v[136:139],v26,s[20:23],s40 offen offset:2048 sc1
buffer_load_dwordx4 v[140:143],v26,s[20:23],s40 offen offset:3072 sc1
s_waitcnt vmcnt(0)
hc_368:
v_bitop3_b32 v22,v132,v136,v140 bitop3:0x80
v_and_b32 v22,s60,v22
v_cmp_eq_u32 vcc,0,v22
s_cbranch_vccz hk_367
s_sub_u32 s90,s90,1
s_cmp_gt_i32 s90,0
s_cbranch_scc1 hp_366
hk_367:
v_pk_add_f32 v[112:113],v[112:113],v[132:133]
v_pk_add_f32 v[136:137],v[136:137],v[140:141]
v_pk_add_f32 v[114:115],v[114:115],v[134:135]
v_pk_add_f32 v[138:139],v[138:139],v[142:143]
v_pk_add_f32 v[112:113],v[112:113],v[136:137]
v_pk_add_f32 v[114:115],v[114:115],v[138:139]
v_pk_fma_f32 v[112:113],v[112:113],v[52:53],v[116:117]
v_pk_fma_f32 v[114:115],v[114:115],v[54:55],v[118:119]
v_cvt_pk_bf16_f32 v112,v112,v113
v_cvt_pk_bf16_f32 v113,v114,v115
ds_bpermute_b32 v112,v40,v112
ds_bpermute_b32 v113,v40,v113
s_mov_b32 s64,4194304
s_waitcnt lgkmcnt(0)
buffer_store_dwordx2 v[112:113],v19,s[36:39],s64 offen
hn_369:
s_endpgm
retry_351:
s_sub_u32 s90,s90,64
s_cmp_lt_i32 s90,0
s_cbranch_scc1 giveup_197
s_mov_b32 s83,1
s_waitcnt vmcnt(0) lgkmcnt(0)
s_barrier
s_branch seg_352
half_360:
s_cmp_eq_u32 s43,0
s_cbranch_scc1 hown_370
s_mov_b64 exec,s[52:53]
s_xor_b32 m0,s91,0
s_add_u32 s65,s94,0
buffer_load_dwordx4 v16,s[20:23],s65 offen offset:0 sc1 lds
buffer_load_dwordx4 v16,s[20:23],s65 offen offset:2048 sc1 lds
s_xor_b32 m0,s91,16384
s_add_u32 s65,s94,32768
buffer_load_dwordx4 v16,s[20:23],s65 offen offset:0 sc1 lds
buffer_load_dwordx4 v16,s[20:23],s65 offen offset:2048 sc1 lds
s_xor_b32 m0,s91,32768
s_add_u32 s65,s94,65536
buffer_load_dwordx4 v16,s[20:23],s65 offen offset:0 sc1 lds
buffer_load_dwordx4 v16,s[20:23],s65 offen offset:2048 sc1 lds
s_xor_b32 m0,s91,49152
s_add_u32 s65,s94,s86
buffer_load_dwordx4 v16,s[20:23],s65 offen offset:0 sc1 lds
buffer_load_dwordx4 v16,s[20:23],s65 offen offset:2048 sc1 lds
s_mov_b64 exec,-1
h2a_371:
s_waitcnt vmcnt(6)
s_barrier
ds_read_b128 v[224:227],v18 offset:0
ds_read_b128 v[228:231],v18 offset:2048
ds_read_b128 v[232:235],v18 offset:4096
ds_read_b128 v[236:239],v18 offset:6144
ds_read_b128 v[240:243],v18 offset:8192
ds_read_b128 v[244:247],v18 offset:10240
ds_read_b128 v[248:251],v18 offset:12288
s_waitcnt lgkmcnt(5)
v_mfma_f32_16x16x32_bf16 v[64:67],a[0:3],v[224:227],0
v_min_u32 v27,v224,v228
v_mfma_f32_16x16x32_bf16 v[68:71],a[112:115],v[224:227],0
ds_read_b128 v[252:255],v18 offset:14336
v_mfma_f32_16x16x32_bf16 v[64:67],a[4:7],v[228:231],v[64:67]
v_mfma_f32_16x16x32_bf16 v[68:71],a[116:119],v[228:231],v[68:71]
s_waitcnt vmcnt(4)
s_barrier
ds_read_b128 v[224:227],v18 offset:16384
s_waitcnt lgkmcnt(5)
v_mfma_f32_16x16x32_bf16 v[64:67],a[8:11],v[232:235],v[64:67]
v_min3_u32 v27,v27,v232,v236
v_mfma_f32_16x16x32_bf16 v[68:71],a[120:123],v[232:235],v[68:71]
ds_read_b128 v[228:231],v18 offset:18432
v_mfma_f32_16x16x32_bf16 v[64:67],a[12:15],v[236:239],v[64:67]
v_mfma_f32_16x16x32_bf16 v[68:71],a[124:127],v[236:239],v[68:71]
ds_read_b128 v[232:235],v18 offset:20480
s_waitcnt lgkmcnt(5)
v_mfma_f32_16x16x32_bf16 v[64:67],a[16:19],v[240:243],v[64:67]
v_min3_u32 v27,v27,v240,v244
v_mfma_f32_16x16x32_bf16 v[68:71],a[128:131],v[240:243],v[68:71]
ds_read_b128 v[236:239],v18 offset:22528
v_mfma_f32_16x16x32_bf16 v[64:67],a[20:23],v[244:247],v[64:67]
v_mfma_f32_16x16x32_bf16 v[68:71],a[132:135],v[244:247],v[68:71]
ds_read_b128 v[240:243],v18 offset:24576
s_waitcnt lgkmcnt(5)
v_mfma_f32_16x16x32_bf16 v[64:67],a[24:27],v[248:251],v[64:67]
v_min3_u32 v27,v27,v248,v252
v_mfma_f32_16x16x32_bf16 v[68:71],a[136:139],v[248:251],v[68:71]
ds_read_b128 v[244:247],v18 offset:26624
v_mfma_f32_16x16x32_bf16 v[64:67],a[28:31],v[252:255],v[64:67]
v_mfma_f32_16x16x32_bf16 v[68:71],a[140:143],v[252:255],v[68:71]
ds_read_b128 v[248:251],v18 offset:28672
s_waitcnt lgkmcnt(5)
v_mfma_f32_16x16x32_bf16 v[64:67],a[32:35],v[224:227],v[64:67]
v_min3_u32 v27,v27,v224,v228
v_mfma_f32_16x16x32_bf16 v[68:71],a[144:147],v[224:227],v[68:71]
ds_read_b128 v[252:255],v18 offset:30720
v_mfma_f32_16x16x32_bf16 v[64:67],a[36:39],v[228:231],v[64:67]
v_mfma_f32_16x16x32_bf16 v[68:71],a[148:151],v[228:231],v[68:71]
s_waitcnt vmcnt(0)
s_barrier
ds_read_b128 v[224:227],v18 offset:32768
s_waitcnt lgkmcnt(5)
v_mfma_f32_16x16x32_bf16 v[64:67],a[40:43],v[232:235],v[64:67]
v_min3_u32 v27,v27,v232,v236
v_mfma_f32_16x16x32_bf16 v[68:71],a[152:155],v[232:235],v[68:71]
ds_read_b128 v[228:231],v18 offset:34816
v_mfma_f32_16x16x32_bf16 v[64:67],a[44:47],v[236:239],v[64:67]
v_mfma_f32_16x16x32_bf16 v[68:71],a[156:159],v[236:239],v[68:71]
ds_read_b128 v[232:235],v18 offset:36864
s_waitcnt lgkmcnt(5)
v_mfma_f32_16x16x32_bf16 v[64:67],a[48:51],v[240:243],v[64:67]
v_min3_u32 v27,v27,v240,v244
v_mfma_f32_16x16x32_bf16 v[68:71],a[160:163],v[240:243],v[68:71]
ds_read_b128 v[236:239],v18 offset:38912
v_mfma_f32_16x16x32_bf16 v[64:67],a[52:55],v[244:247],v[64:67]
v_mfma_f32_16x16x32_bf16 v[68:71],a[164:167],v[244:247],v[68:71]
ds_read_b128 v[240:243],v18 offset:40960
s_waitcnt lgkmcnt(5)
v_mfma_f32_16x16x32_bf16 v[64:67],a[56:59],v[248:251],v[64:67]
v_min3_u32 v27,v27,v248,v252
v_mfma_f32_16x16x32_bf16 v[68:71],a[168:171],v[248:251],v[68:71]
ds_read_b128 v[244:247],v18 offset:43008
v_mfma_f32_16x16x32_bf16 v[64:67],a[60:63],v[252:255],v[64:67]
v_mfma_f32_16x16x32_bf16 v[68:71],a[172:175],v[252:255],v[68:71]
ds_read_b128 v[248:251],v18 offset:45056
s_waitcnt lgkmcnt(5)
v_mfma_f32_16x16x32_bf16 v[64:67],a[64:67],v[224:227],v[64:67]
v_min3_u32 v27,v27,v224,v228
v_mfma_f32_16x16x32_bf16 v[68:71],a[176:179],v[224:227],v[68:71]
ds_read_b128 v[252:255],v18 offset:47104
v_mfma_f32_16x16x32_bf16 v[64:67],a[68:71],v[228:231],v[64:67]
v_mfma_f32_16x16x32_bf16 v[68:71],a[180:183],v[228:231],v[68:71]
ds_read_b128 v[224:227],v18 offset:49152
s_waitcnt lgkmcnt(5)
v_mfma_f32_16x16x32_bf16 v[64:67],a[72:75],v[232:235],v[64:67]
v_min3_u32 v27,v27,v232,v236
v_mfma_f32_16x16x32_bf16 v[68:71],a[184:187],v[232:235],v[68:71]
ds_read_b128 v[228:231],v18 offset:51200
v_mfma_f32_16x16x32_bf16 v[64:67],a[76:79],v[236:239],v[64:67]
v_mfma_f32_16x16x32_bf16 v[68:71],a[188:191],v[236:239],v[68:71]
ds_read_b128 v[232:235],v18 offset:53248
s_waitcnt lgkmcnt(5)
v_mfma_f32_16x16x32_bf16 v[64:67],a[80:83],v[240:243],v[64:67]
v_min3_u32 v27,v27,v240,v244
v_mfma_f32_16x16x32_bf16 v[68:71],a[192:195],v[240:243],v[68:71]
ds_read_b128 v[236:239],v18 offset:55296
v_mfma_f32_16x16x32_bf16 v[64:67],a[84:87],v[244:247],v[64:67]
v_mfma_f32_16x16x32_bf16 v[68:71],a[196:199],v[244:247],v[68:71]
s_waitcnt lgkmcnt(4)
v_mfma_f32_16x16x32_bf16 v[64:67],a[88:91],v[248:251],v[64:67]
v_min3_u32 v27,v27,v248,v252
v_mfma_f32_16x16x32_bf16 v[68:71],a[200:203],v[248:251],v[68:71]
v_mfma_f32_16x16x32_bf16 v[64:67],a[92:95],v[252:255],v[64:67]
v_mfma_f32_16x16x32_bf16 v[68:71],a[204:207],v[252:255],v[68:71]
s_waitcnt lgkmcnt(2)
v_mfma_f32_16x16x32_bf16 v[64:67],a[96:99],v[224:227],v[64:67]
v_min3_u32 v27,v27,v224,v228
v_min3_u32 v27,v27,v226,v230
v_mfma_f32_16x16x32_bf16 v[68:71],a[208:211],v[224:227],v[68:71]
v_mfma_f32_16x16x32_bf16 v[64:67],a[100:103],v[228:231],v[64:67]
v_mfma_f32_16x16x32_bf16 v[68:71],a[212:215],v[228:231],v[68:71]
s_waitcnt lgkmcnt(0)
v_mfma_f32_16x16x32_bf16 v[64:67],a[104:107],v[232:235],v[64:67]
v_min3_u32 v27,v27,v232,v236
v_min3_u32 v27,v27,v234,v238
v_mfma_f32_16x16x32_bf16 v[68:71],a[216:219],v[232:235],v[68:71]
v_mfma_f32_16x16x32_bf16 v[64:67],a[108:111],v[236:239],v[64:67]
v_mfma_f32_16x16x32_bf16 v[68:71],a[220:223],v[236:239],v[68:71]
v_cmp_eq_u32 vcc,0,v27
s_and_b64 vcc,vcc,s[52:53]
s_cbranch_vccnz retry_351
buffer_load_dword v29,v21,s[20:23],s87 offen sc1
s_mov_b32 s40,0x7fff0000
s_nop 5
v_and_or_b32 v64,v64,-4,s48
s_add_u32 s64,s77,s34
buffer_store_dwordx4 v[64:67],v25,s[20:23],s64 offen offset:2048 sc1
v_and_or_b32 v68,v68,-4,s48
s_add_u32 s64,s77,s35
buffer_store_dwordx4 v[68:71],v25,s[20:23],s64 offen offset:3072 sc1
hjoin_373:
v_xor_b32 v18,0x10000,v18
s_xor_b32 s49,s77,524288
s_cselect_b32 s64,0,3
s_xor_b32 s48,s48,s64
v_xor_b32 v20,0x2000,v20
s_sub_u32 s76,s76,2097152
s_mov_b32 s77,s49
s_sub_u32 s78,s78,65536
s_branch next_361
half2_357:
s_cmp_eq_u32 s43,0
s_cbranch_scc1 h2b_372
s_branch h2a_371
hown_370:
s_mov_b64 exec,s[52:53]
s_xor_b32 m0,s91,1024
s_add_u32 s65,s95,0
buffer_load_dwordx4 v16,s[20:23],s65 offen offset:0 sc1 lds
buffer_load_dwordx4 v16,s[20:23],s65 offen offset:2048 sc1 lds
s_xor_b32 m0,s91,17408
s_add_u32 s65,s95,32768
buffer_load_dwordx4 v16,s[20:23],s65 offen offset:0 sc1 lds
buffer_load_dwordx4 v16,s[20:23],s65 offen offset:2048 sc1 lds
s_xor_b32 m0,s91,33792
s_add_u32 s65,s95,65536
buffer_load_dwordx4 v16,s[20:23],s65 offen offset:0 sc1 lds
buffer_load_dwordx4 v16,s[20:23],s65 offen offset:2048 sc1 lds
s_xor_b32 m0,s91,50176
s_add_u32 s65,s95,s86
buffer_load_dwordx4 v16,s[20:23],s65 offen offset:0 sc1 lds
buffer_load_dwordx4 v16,s[20:23],s65 offen offset:2048 sc1 lds
s_mov_b64 exec,-1
h2b_372:
buffer_load_dwordx2 v[120:121],v20,s[20:23],s76 offen sc1
buffer_load_dwordx2 v[122:123],v24,s[20:23],s70 offen sc1
s_waitcnt vmcnt(8)
s_barrier
ds_read_b128 v[128:131],v17 offset:0
ds_read_b128 v[132:135],v17 offset:2048
ds_read_b128 v[136:139],v17 offset:4096
ds_read_b128 v[140:143],v17 offset:6144
ds_read_b128 v[144:147],v17 offset:8192
ds_read_b128 v[148:151],v17 offset:10240
ds_read_b128 v[152:155],v17 offset:12288
s_waitcnt lgkmcnt(5)
v_mfma_f32_16x16x32_bf16 v[72:75],a[112:115],v[128:131],0
v_min_u32 v27,v128,v132
v_mfma_f32_16x16x32_bf16 v[80:83],a[0:3],v[128:131],0
ds_read_b128 v[156:159],v17 offset:14336
v_mfma_f32_16x16x32_bf16 v[76:79],a[116:119],v[132:135],0
v_mfma_f32_16x16x32_bf16 v[84:87],a[4:7],v[132:135],0
s_waitcnt vmcnt(6)
s_barrier
ds_read_b128 v[160:163],v17 offset:16384
s_waitcnt lgkmcnt(5)
v_mfma_f32_16x16x32_bf16 v[72:75],a[120:123],v[136:139],v[72:75]
v_min3_u32 v27,v27,v136,v140
v_mfma_f32_16x16x32_bf16 v[80:83],a[8:11],v[136:139],v[80:83]
ds_read_b128 v[164:167],v17 offset:18432
v_mfma_f32_16x16x32_bf16 v[76:79],a[124:127],v[140:143],v[76:79]
v_mfma_f32_16x16x32_bf16 v[84:87],a[12:15],v[140:143],v[84:87]
ds_read_b128 v[168:171],v17 offset:20480
s_waitcnt lgkmcnt(5)
v_mfma_f32_16x16x32_bf16 v[72:75],a[128:131],v[144:147],v[72:75]
v_min3_u32 v27,v27,v144,v148
v_mfma_f32_16x16x32_bf16 v[80:83],a[16:19],v[144:147],v[80:83]
ds_read_b128 v[172:175],v17 offset:22528
v_mfma_f32_16x16x32_bf16 v[76:79],a[132:135],v[148:151],v[76:79]
v_mfma_f32_16x16x32_bf16 v[84:87],a[20:23],v[148:151],v[84:87]
ds_read_b128 v[176:179],v17 offset:24576
s_waitcnt lgkmcnt(5)
v_mfma_f32_16x16x32_bf16 v[72:75],a[136:139],v[152:155],v[72:75]
v_min3_u32 v27,v27,v152,v156
v_mfma_f32_16x16x32_bf16 v[80:83],a[24:27],v[152:155],v[80:83]
ds_read_b128 v[180:183],v17 offset:26624
v_mfma_f32_16x16x32_bf16 v[76:79],a[140:143],v[156:159],v[76:79]
v_mfma_f32_16x16x32_bf16 v[84:87],a[28:31],v[156:159],v[84:87]
ds_read_b128 v[184:187],v17 offset:28672
s_waitcnt lgkmcnt(5)
v_mfma_f32_16x16x32_bf16 v[72:75],a[144:147],v[160:163],v[72:75]
v_min3_u32 v27,v27,v160,v164
v_mfma_f32_16x16x32_bf16 v[80:83],a[32:35],v[160:163],v[80:83]
ds_read_b128 v[188:191],v17 offset:30720
v_mfma_f32_16x16x32_bf16 v[76:79],a[148:151],v[164:167],v[76:79]
v_mfma_f32_16x16x32_bf16 v[84:87],a[36:39],v[164:167],v[84:87]
s_waitcnt vmcnt(2)
s_barrier
ds_read_b128 v[192:195],v17 offset:32768
s_waitcnt lgkmcnt(5)
v_mfma_f32_16x16x32_bf16 v[72:75],a[152:155],v[168:171],v[72:75]
v_min3_u32 v27,v27,v168,v172
v_mfma_f32_16x16x32_bf16 v[80:83],a[40:43],v[168:171],v[80:83]
ds_read_b128 v[196:199],v17 offset:34816
v_mfma_f32_16x16x32_bf16 v[76:79],a[156:159],v[172:175],v[76:79]
v_mfma_f32_16x16x32_bf16 v[84:87],a[44:47],v[172:175],v[84:87]
ds_read_b128 v[200:203],v17 offset:36864
s_waitcnt lgkmcnt(5)
v_mfma_f32_16x16x32_bf16 v[72:75],a[160:163],v[176:179],v[72:75]
v_min3_u32 v27,v27,v176,v180
v_mfma_f32_16x16x32_bf16 v[80:83],a[48:51],v[176:179],v[80:83]
ds_read_b128 v[204:207],v17 offset:38912
v_mfma_f32_16x16x32_bf16 v[76:79],a[164:167],v[180:183],v[76:79]
v_mfma_f32_16x16x32_bf16 v[84:87],a[52:55],v[180:183],v[84:87]
ds_read_b128 v[208:211],v17 offset:40960
s_waitcnt lgkmcnt(5)
v_mfma_f32_16x16x32_bf16 v[72:75],a[168:171],v[184:187],v[72:75]
v_min3_u32 v27,v27,v184,v188
v_mfma_f32_16x16x32_bf16 v[80:83],a[56:59],v[184:187],v[80:83]
ds_read_b128 v[212:215],v17 offset:43008
v_mfma_f32_16x16x32_bf16 v[76:79],a[172:175],v[188:191],v[76:79]
v_mfma_f32_16x16x32_bf16 v[84:87],a[60:63],v[188:191],v[84:87]
ds_read_b128 v[216:219],v17 offset:45056
s_waitcnt lgkmcnt(5)
v_mfma_f32_16x16x32_bf16 v[72:75],a[176:179],v[192:195],v[72:75]
v_min3_u32 v27,v27,v192,v196
s_waitcnt vmcnt(0)
v_mfma_f32_16x16x32_bf16 v[80:83],a[64:67],v[192:195],v[80:83]
ds_read_b128 v[220:223],v17 offset:47104
ds_bpermute_b32 v124,v41,v120
v_mfma_f32_16x16x32_bf16 v[76:79],a[180:183],v[196:199],v[76:79]
ds_bpermute_b32 v125,v41,v121
v_lshlrev_b32 v108,16,v122
v_mfma_f32_16x16x32_bf16 v[84:87],a[68:71],v[196:199],v[84:87]
ds_read_b128 v[224:227],v17 offset:49152
s_waitcnt lgkmcnt(7)
v_mfma_f32_16x16x32_bf16 v[72:75],a[184:187],v[200:203],v[72:75]
v_min3_u32 v27,v27,v200,v204
v_and_b32 v109,s80,v122
v_mfma_f32_16x16x32_bf16 v[80:83],a[72:75],v[200:203],v[80:83]
ds_read_b128 v[228:231],v17 offset:51200
v_lshlrev_b32 v110,16,v123
v_mfma_f32_16x16x32_bf16 v[76:79],a[188:191],v[204:207],v[76:79]
v_and_b32 v111,s80,v123
s_waitcnt lgkmcnt(2)
v_mfma_f32_16x16x32_bf16 v[84:87],a[76:79],v[204:207],v[84:87]
ds_read_b128 v[232:235],v17 offset:53248
v_mfma_f32_16x16x32_bf16 v[72:75],a[192:195],v[208:211],v[72:75]
v_min3_u32 v27,v27,v208,v212
v_lshlrev_b32 v104,16,v124
v_mfma_f32_16x16x32_bf16 v[80:83],a[80:83],v[208:211],v[80:83]
ds_read_b128 v[236:239],v17 offset:55296
v_and_b32 v105,s80,v124
v_mfma_f32_16x16x32_bf16 v[76:79],a[196:199],v[212:215],v[76:79]
v_lshlrev_b32 v106,16,v125
v_and_b32 v107,s80,v125
v_mfma_f32_16x16x32_bf16 v[84:87],a[84:87],v[212:215],v[84:87]
v_mfma_f32_16x16x32_bf16 v[72:75],a[200:203],v[216:219],v[72:75]
v_min3_u32 v27,v27,v216,v220
v_mfma_f32_16x16x32_bf16 v[80:83],a[88:91],v[216:219],v[80:83]
v_mfma_f32_16x16x32_bf16 v[76:79],a[204:207],v[220:223],v[76:79]
v_mfma_f32_16x16x32_bf16 v[84:87],a[92:95],v[220:223],v[84:87]
s_waitcnt lgkmcnt(2)
v_mfma_f32_16x16x32_bf16 v[72:75],a[208:211],v[224:227],v[72:75]
v_min3_u32 v27,v27,v224,v228
v_min3_u32 v27,v27,v226,v230
v_mfma_f32_16x16x32_bf16 v[80:83],a[96:99],v[224:227],v[80:83]
v_mfma_f32_16x16x32_bf16 v[76:79],a[212:215],v[228:231],v[76:79]
v_mfma_f32_16x16x32_bf16 v[84:87],a[100:103],v[228:231],v[84:87]
s_waitcnt lgkmcnt(0)
v_mfma_f32_16x16x32_bf16 v[72:75],a[216:219],v[232:235],v[72:75]
v_min3_u32 v27,v27,v232,v236
v_min3_u32 v27,v27,v234,v238
v_mfma_f32_16x16x32_bf16 v[80:83],a[104:107],v[232:235],v[80:83]
v_mfma_f32_16x16x32_bf16 v[76:79],a[220:223],v[236:239],v[76:79]
v_mfma_f32_16x16x32_bf16 v[84:87],a[108:111],v[236:239],v[84:87]
v_cmp_eq_u32 vcc,0,v27
s_and_b64 vcc,vcc,s[52:53]
s_cbranch_vccnz retry_351
buffer_load_dword v29,v21,s[20:23],s87 offen sc1
s_nop 6
v_add_f32 v72,v72,v76
v_add_f32 v73,v73,v77
v_add_f32 v74,v74,v78
v_add_f32 v75,v75,v79
v_and_or_b32 v72,v72,-4,s48
s_add_u32 s64,s77,s33
buffer_store_dwordx4 v[72:75],v25,s[20:23],s64 offen offset:1024 sc1
v_pk_add_f32 v[112:113],v[80:81],v[84:85]
v_pk_add_f32 v[112:113],v[112:113],v[108:109]
v_pk_add_f32 v[114:115],v[82:83],v[86:87]
v_pk_add_f32 v[114:115],v[114:115],v[110:111]
v_mov_b32 v116,v104
v_mov_b32 v117,v105
v_mov_b32 v118,v106
v_mov_b32 v119,v107
s_mov_b32 s40,s77
s_mov_b32 s60,s48
s_branch hjoin_373
r_w3_215:
s_load_dwordx2 s[4:5],s[0:1],80
s_mul_i32 s66,s59,224
s_lshl_b32 s67,s50,1
s_waitcnt lgkmcnt(0)
s_mov_b32 s32,s4
s_and_b32 s33,s5,0xffff
s_mov_b32 s34,0x700000
s_mov_b32 s35,0x20000
v_lshrrev_b32 v5,2,v3
v_lshl_add_u32 v5,v4,2,v5
v_and_b32 v6,3,v3
v_lshlrev_b32 v6,3,v6
v_lshl_add_u32 v6,v5,8,v6
v_and_b32 v5,7,v5
v_xor_b32 v5,s67,v5
v_lshl_add_u32 v12,v5,5,v6
v_xor_b32 v13,32,v12
v_and_b32 v5,15,v1
v_and_b32 v6,3,v4
v_lshlrev_b32 v6,1,v6
v_xor_b32 v5,v5,v6
v_mul_u32_u24 v6,7168,v4
v_xor_b32 v7,0,v5
v_lshl_add_u32 v8,v7,4,v6
v_xor_b32 v7,8,v5
v_lshl_add_u32 v9,v7,4,v6
s_mul_i32 s74,s50,458752
s_add_u32 s74,s74,s66
s_lshl_b32 s75,s50,14
s_mul_i32 s76,s50,229376
s_add_u32 s76,s76,s66
s_lshl_b32 s77,s50,13
s_add_u32 s64,s74,0
s_add_u32 m0,s75,0
s_nop 0
buffer_load_dwordx4 v8,s[32:35],s64 offen nt lds
s_add_u32 s64,s74,28672
s_add_u32 m0,s75,1024
s_nop 0
buffer_load_dwordx4 v9,s[32:35],s64 offen nt lds
s_add_u32 s64,s74,57344
s_add_u32 m0,s75,2048
s_nop 0
buffer_load_dwordx4 v8,s[32:35],s64 offen nt lds
s_add_u32 s64,s74,86016
s_add_u32 m0,s75,3072
s_nop 0
buffer_load_dwordx4 v9,s[32:35],s64 offen nt lds
s_add_u32 s64,s74,114688
s_add_u32 m0,s75,4096
s_nop 0
buffer_load_dwordx4 v8,s[32:35],s64 offen nt lds
s_add_u32 s64,s74,143360
s_add_u32 m0,s75,5120
s_nop 0
buffer_load_dwordx4 v9,s[32:35],s64 offen nt lds
s_add_u32 s64,s74,172032
s_add_u32 m0,s75,6144
s_nop 0
buffer_load_dwordx4 v8,s[32:35],s64 offen nt lds
s_add_u32 s64,s74,200704
s_add_u32 m0,s75,7168
s_nop 0
buffer_load_dwordx4 v9,s[32:35],s64 offen nt lds
s_add_u32 s64,s74,229376
s_add_u32 m0,s75,8192
s_nop 0
buffer_load_dwordx4 v8,s[32:35],s64 offen nt lds
s_add_u32 s64,s74,258048
s_add_u32 m0,s75,9216
s_nop 0
buffer_load_dwordx4 v9,s[32:35],s64 offen nt lds
s_add_u32 s64,s74,286720
s_add_u32 m0,s75,10240
s_nop 0
buffer_load_dwordx4 v8,s[32:35],s64 offen nt lds
s_add_u32 s64,s74,315392
s_add_u32 m0,s75,11264
s_nop 0
buffer_load_dwordx4 v9,s[32:35],s64 offen nt lds
s_add_u32 s64,s74,344064
s_add_u32 m0,s75,12288
s_nop 0
buffer_load_dwordx4 v8,s[32:35],s64 offen nt lds
s_add_u32 s64,s74,372736
s_add_u32 m0,s75,13312
s_nop 0
buffer_load_dwordx4 v9,s[32:35],s64 offen nt lds
s_add_u32 s64,s74,401408
s_add_u32 m0,s75,14336
s_nop 0
buffer_load_dwordx4 v8,s[32:35],s64 offen nt lds
s_add_u32 s64,s74,430080
s_add_u32 m0,s75,15360
s_nop 0
buffer_load_dwordx4 v9,s[32:35],s64 offen nt lds
s_add_u32 s64,s74,1835008
s_add_u32 m0,s75,65536
s_nop 0
buffer_load_dwordx4 v8,s[32:35],s64 offen nt lds
s_add_u32 s64,s74,1863680
s_add_u32 m0,s75,66560
s_nop 0
buffer_load_dwordx4 v9,s[32:35],s64 offen nt lds
s_add_u32 s64,s74,1892352
s_add_u32 m0,s75,67584
s_nop 0
buffer_load_dwordx4 v8,s[32:35],s64 offen nt lds
s_add_u32 s64,s74,1921024
s_add_u32 m0,s75,68608
s_nop 0
buffer_load_dwordx4 v9,s[32:35],s64 offen nt lds
s_add_u32 s64,s74,1949696
s_add_u32 m0,s75,69632
s_nop 0
buffer_load_dwordx4 v8,s[32:35],s64 offen nt lds
s_add_u32 s64,s74,1978368
s_add_u32 m0,s75,70656
s_nop 0
buffer_load_dwordx4 v9,s[32:35],s64 offen nt lds
s_add_u32 s64,s74,2007040
s_add_u32 m0,s75,71680
s_nop 0
buffer_load_dwordx4 v8,s[32:35],s64 offen nt lds
s_add_u32 s64,s74,2035712
s_add_u32 m0,s75,72704
s_nop 0
buffer_load_dwordx4 v9,s[32:35],s64 offen nt lds
s_add_u32 s64,s74,2064384
s_add_u32 m0,s75,73728
s_nop 0
buffer_load_dwordx4 v8,s[32:35],s64 offen nt lds
s_add_u32 s64,s74,2093056
s_add_u32 m0,s75,74752
s_nop 0
buffer_load_dwordx4 v9,s[32:35],s64 offen nt lds
s_add_u32 s64,s74,2121728
s_add_u32 m0,s75,75776
s_nop 0
buffer_load_dwordx4 v8,s[32:35],s64 offen nt lds
s_add_u32 s64,s74,2150400
s_add_u32 m0,s75,76800
s_nop 0
buffer_load_dwordx4 v9,s[32:35],s64 offen nt lds
s_add_u32 s64,s74,2179072
s_add_u32 m0,s75,77824
s_nop 0
buffer_load_dwordx4 v8,s[32:35],s64 offen nt lds
s_add_u32 s64,s74,2207744
s_add_u32 m0,s75,78848
s_nop 0
buffer_load_dwordx4 v9,s[32:35],s64 offen nt lds
s_add_u32 s64,s74,2236416
s_add_u32 m0,s75,79872
s_nop 0
buffer_load_dwordx4 v8,s[32:35],s64 offen nt lds
s_add_u32 s64,s74,2265088
s_add_u32 m0,s75,80896
s_nop 0
buffer_load_dwordx4 v9,s[32:35],s64 offen nt lds
s_waitcnt vmcnt(16)
s_barrier
ds_read_b64_tr_b16 a[0:1],v12 offset:0
ds_read_b64_tr_b16 a[128:129],v13 offset:0
ds_read_b64_tr_b16 a[2:3],v12 offset:4096
ds_read_b64_tr_b16 a[130:131],v13 offset:4096
ds_read_b64_tr_b16 a[4:5],v12 offset:8192
ds_read_b64_tr_b16 a[132:133],v13 offset:8192
ds_read_b64_tr_b16 a[6:7],v12 offset:12288
ds_read_b64_tr_b16 a[134:135],v13 offset:12288
s_waitcnt lgkmcnt(4)
ds_read_b64_tr_b16 a[8:9],v12 offset:16384
ds_read_b64_tr_b16 a[136:137],v13 offset:16384
ds_read_b64_tr_b16 a[10:11],v12 offset:20480
ds_read_b64_tr_b16 a[138:139],v13 offset:20480
ds_read_b64_tr_b16 a[12:13],v12 offset:24576
ds_read_b64_tr_b16 a[140:141],v13 offset:24576
ds_read_b64_tr_b16 a[14:15],v12 offset:28672
ds_read_b64_tr_b16 a[142:143],v13 offset:28672
s_waitcnt lgkmcnt(4)
ds_read_b64_tr_b16 a[16:17],v12 offset:32768
ds_read_b64_tr_b16 a[144:145],v13 offset:32768
ds_read_b64_tr_b16 a[18:19],v12 offset:36864
ds_read_b64_tr_b16 a[146:147],v13 offset:36864
ds_read_b64_tr_b16 a[20:21],v12 offset:40960
ds_read_b64_tr_b16 a[148:149],v13 offset:40960
ds_read_b64_tr_b16 a[22:23],v12 offset:45056
ds_read_b64_tr_b16 a[150:151],v13 offset:45056
s_waitcnt lgkmcnt(4)
ds_read_b64_tr_b16 a[24:25],v12 offset:49152
ds_read_b64_tr_b16 a[152:153],v13 offset:49152
ds_read_b64_tr_b16 a[26:27],v12 offset:53248
ds_read_b64_tr_b16 a[154:155],v13 offset:53248
ds_read_b64_tr_b16 a[28:29],v12 offset:57344
ds_read_b64_tr_b16 a[156:157],v13 offset:57344
ds_read_b64_tr_b16 a[30:31],v12 offset:61440
ds_read_b64_tr_b16 a[158:159],v13 offset:61440
s_waitcnt lgkmcnt(4)
v_xor_b32 v12,0x10000,v12
v_xor_b32 v13,0x10000,v13
s_waitcnt lgkmcnt(0)
s_barrier
s_add_u32 s64,s74,3670016
s_add_u32 m0,s75,0
s_nop 0
buffer_load_dwordx4 v8,s[32:35],s64 offen nt lds
s_add_u32 s64,s74,3698688
s_add_u32 m0,s75,1024
s_nop 0
buffer_load_dwordx4 v9,s[32:35],s64 offen nt lds
s_add_u32 s64,s74,3727360
s_add_u32 m0,s75,2048
s_nop 0
buffer_load_dwordx4 v8,s[32:35],s64 offen nt lds
s_add_u32 s64,s74,3756032
s_add_u32 m0,s75,3072
s_nop 0
buffer_load_dwordx4 v9,s[32:35],s64 offen nt lds
s_add_u32 s64,s74,3784704
s_add_u32 m0,s75,4096
s_nop 0
buffer_load_dwordx4 v8,s[32:35],s64 offen nt lds
s_add_u32 s64,s74,3813376
s_add_u32 m0,s75,5120
s_nop 0
buffer_load_dwordx4 v9,s[32:35],s64 offen nt lds
s_add_u32 s64,s74,3842048
s_add_u32 m0,s75,6144
s_nop 0
buffer_load_dwordx4 v8,s[32:35],s64 offen nt lds
s_add_u32 s64,s74,3870720
s_add_u32 m0,s75,7168
s_nop 0
buffer_load_dwordx4 v9,s[32:35],s64 offen nt lds
s_add_u32 s64,s74,3899392
s_add_u32 m0,s75,8192
s_nop 0
buffer_load_dwordx4 v8,s[32:35],s64 offen nt lds
s_add_u32 s64,s74,3928064
s_add_u32 m0,s75,9216
s_nop 0
buffer_load_dwordx4 v9,s[32:35],s64 offen nt lds
s_add_u32 s64,s74,3956736
s_add_u32 m0,s75,10240
s_nop 0
buffer_load_dwordx4 v8,s[32:35],s64 offen nt lds
s_add_u32 s64,s74,3985408
s_add_u32 m0,s75,11264
s_nop 0
buffer_load_dwordx4 v9,s[32:35],s64 offen nt lds
s_add_u32 s64,s74,4014080
s_add_u32 m0,s75,12288
s_nop 0
buffer_load_dwordx4 v8,s[32:35],s64 offen nt lds
s_add_u32 s64,s74,4042752
s_add_u32 m0,s75,13312
s_nop 0
buffer_load_dwordx4 v9,s[32:35],s64 offen nt lds
s_add_u32 s64,s74,4071424
s_add_u32 m0,s75,14336
s_nop 0
buffer_load_dwordx4 v8,s[32:35],s64 offen nt lds
s_add_u32 s64,s74,4100096
s_add_u32 m0,s75,15360
s_nop 0
buffer_load_dwordx4 v9,s[32:35],s64 offen nt lds
s_waitcnt vmcnt(16)
s_barrier
ds_read_b64_tr_b16 a[32:33],v12 offset:0
ds_read_b64_tr_b16 a[160:161],v13 offset:0
ds_read_b64_tr_b16 a[34:35],v12 offset:4096
ds_read_b64_tr_b16 a[162:163],v13 offset:4096
ds_read_b64_tr_b16 a[36:37],v12 offset:8192
ds_read_b64_tr_b16 a[164:165],v13 offset:8192
ds_read_b64_tr_b16 a[38:39],v12 offset:12288
ds_read_b64_tr_b16 a[166:167],v13 offset:12288
s_waitcnt lgkmcnt(4)
ds_read_b64_tr_b16 a[40:41],v12 offset:16384
ds_read_b64_tr_b16 a[168:169],v13 offset:16384
ds_read_b64_tr_b16 a[42:43],v12 offset:20480
ds_read_b64_tr_b16 a[170:171],v13 offset:20480
ds_read_b64_tr_b16 a[44:45],v12 offset:24576
ds_read_b64_tr_b16 a[172:173],v13 offset:24576
ds_read_b64_tr_b16 a[46:47],v12 offset:28672
ds_read_b64_tr_b16 a[174:175],v13 offset:28672
s_waitcnt lgkmcnt(4)
ds_read_b64_tr_b16 a[48:49],v12 offset:32768
ds_read_b64_tr_b16 a[176:177],v13 offset:32768
ds_read_b64_tr_b16 a[50:51],v12 offset:36864
ds_read_b64_tr_b16 a[178:179],v13 offset:36864
ds_read_b64_tr_b16 a[52:53],v12 offset:40960
ds_read_b64_tr_b16 a[180:181],v13 offset:40960
ds_read_b64_tr_b16 a[54:55],v12 offset:45056
ds_read_b64_tr_b16 a[182:183],v13 offset:45056
s_waitcnt lgkmcnt(4)
ds_read_b64_tr_b16 a[56:57],v12 offset:49152
ds_read_b64_tr_b16 a[184:185],v13 offset:49152
ds_read_b64_tr_b16 a[58:59],v12 offset:53248
ds_read_b64_tr_b16 a[186:187],v13 offset:53248
ds_read_b64_tr_b16 a[60:61],v12 offset:57344
ds_read_b64_tr_b16 a[188:189],v13 offset:57344
ds_read_b64_tr_b16 a[62:63],v12 offset:61440
ds_read_b64_tr_b16 a[190:191],v13 offset:61440
s_waitcnt lgkmcnt(4)
v_xor_b32 v12,0x10000,v12
v_xor_b32 v13,0x10000,v13
s_waitcnt lgkmcnt(0)
s_barrier
s_add_u32 s64,s74,5505024
s_add_u32 m0,s75,65536
s_nop 0
buffer_load_dwordx4 v8,s[32:35],s64 offen nt lds
s_add_u32 s64,s74,5533696
s_add_u32 m0,s75,66560
s_nop 0
buffer_load_dwordx4 v9,s[32:35],s64 offen nt lds
s_add_u32 s64,s74,5562368
s_add_u32 m0,s75,67584
s_nop 0
buffer_load_dwordx4 v8,s[32:35],s64 offen nt lds
s_add_u32 s64,s74,5591040
s_add_u32 m0,s75,68608
s_nop 0
buffer_load_dwordx4 v9,s[32:35],s64 offen nt lds
s_add_u32 s64,s74,5619712
s_add_u32 m0,s75,69632
s_nop 0
buffer_load_dwordx4 v8,s[32:35],s64 offen nt lds
s_add_u32 s64,s74,5648384
s_add_u32 m0,s75,70656
s_nop 0
buffer_load_dwordx4 v9,s[32:35],s64 offen nt lds
s_add_u32 s64,s74,5677056
s_add_u32 m0,s75,71680
s_nop 0
buffer_load_dwordx4 v8,s[32:35],s64 offen nt lds
s_add_u32 s64,s74,5705728
s_add_u32 m0,s75,72704
s_nop 0
buffer_load_dwordx4 v9,s[32:35],s64 offen nt lds
s_add_u32 s64,s74,5734400
s_add_u32 m0,s75,73728
s_nop 0
buffer_load_dwordx4 v8,s[32:35],s64 offen nt lds
s_add_u32 s64,s74,5763072
s_add_u32 m0,s75,74752
s_nop 0
buffer_load_dwordx4 v9,s[32:35],s64 offen nt lds
s_add_u32 s64,s74,5791744
s_add_u32 m0,s75,75776
s_nop 0
buffer_load_dwordx4 v8,s[32:35],s64 offen nt lds
s_add_u32 s64,s74,5820416
s_add_u32 m0,s75,76800
s_nop 0
buffer_load_dwordx4 v9,s[32:35],s64 offen nt lds
s_add_u32 s64,s74,5849088
s_add_u32 m0,s75,77824
s_nop 0
buffer_load_dwordx4 v8,s[32:35],s64 offen nt lds
s_add_u32 s64,s74,5877760
s_add_u32 m0,s75,78848
s_nop 0
buffer_load_dwordx4 v9,s[32:35],s64 offen nt lds
s_add_u32 s64,s74,5906432
s_add_u32 m0,s75,79872
s_nop 0
buffer_load_dwordx4 v8,s[32:35],s64 offen nt lds
s_add_u32 s64,s74,5935104
s_add_u32 m0,s75,80896
s_nop 0
buffer_load_dwordx4 v9,s[32:35],s64 offen nt lds
s_waitcnt vmcnt(16)
s_barrier
ds_read_b64_tr_b16 a[64:65],v12 offset:0
ds_read_b64_tr_b16 a[192:193],v13 offset:0
ds_read_b64_tr_b16 a[66:67],v12 offset:4096
ds_read_b64_tr_b16 a[194:195],v13 offset:4096
ds_read_b64_tr_b16 a[68:69],v12 offset:8192
ds_read_b64_tr_b16 a[196:197],v13 offset:8192
ds_read_b64_tr_b16 a[70:71],v12 offset:12288
ds_read_b64_tr_b16 a[198:199],v13 offset:12288
s_waitcnt lgkmcnt(4)
ds_read_b64_tr_b16 a[72:73],v12 offset:16384
ds_read_b64_tr_b16 a[200:201],v13 offset:16384
ds_read_b64_tr_b16 a[74:75],v12 offset:20480
ds_read_b64_tr_b16 a[202:203],v13 offset:20480
ds_read_b64_tr_b16 a[76:77],v12 offset:24576
ds_read_b64_tr_b16 a[204:205],v13 offset:24576
ds_read_b64_tr_b16 a[78:79],v12 offset:28672
ds_read_b64_tr_b16 a[206:207],v13 offset:28672
s_waitcnt lgkmcnt(4)
ds_read_b64_tr_b16 a[80:81],v12 offset:32768
ds_read_b64_tr_b16 a[208:209],v13 offset:32768
ds_read_b64_tr_b16 a[82:83],v12 offset:36864
ds_read_b64_tr_b16 a[210:211],v13 offset:36864
ds_read_b64_tr_b16 a[84:85],v12 offset:40960
ds_read_b64_tr_b16 a[212:213],v13 offset:40960
ds_read_b64_tr_b16 a[86:87],v12 offset:45056
ds_read_b64_tr_b16 a[214:215],v13 offset:45056
s_waitcnt lgkmcnt(4)
ds_read_b64_tr_b16 a[88:89],v12 offset:49152
ds_read_b64_tr_b16 a[216:217],v13 offset:49152
ds_read_b64_tr_b16 a[90:91],v12 offset:53248
ds_read_b64_tr_b16 a[218:219],v13 offset:53248
ds_read_b64_tr_b16 a[92:93],v12 offset:57344
ds_read_b64_tr_b16 a[220:221],v13 offset:57344
ds_read_b64_tr_b16 a[94:95],v12 offset:61440
ds_read_b64_tr_b16 a[222:223],v13 offset:61440
s_waitcnt lgkmcnt(4)
v_xor_b32 v12,0x10000,v12
v_xor_b32 v13,0x10000,v13
s_waitcnt lgkmcnt(0)
s_barrier
s_waitcnt vmcnt(0)
s_barrier
ds_read_b64_tr_b16 a[96:97],v12 offset:0
ds_read_b64_tr_b16 a[224:225],v13 offset:0
ds_read_b64_tr_b16 a[98:99],v12 offset:4096
ds_read_b64_tr_b16 a[226:227],v13 offset:4096
ds_read_b64_tr_b16 a[100:101],v12 offset:8192
ds_read_b64_tr_b16 a[228:229],v13 offset:8192
ds_read_b64_tr_b16 a[102:103],v12 offset:12288
ds_read_b64_tr_b16 a[230:231],v13 offset:12288
s_waitcnt lgkmcnt(4)
ds_read_b64_tr_b16 a[104:105],v12 offset:16384
ds_read_b64_tr_b16 a[232:233],v13 offset:16384
ds_read_b64_tr_b16 a[106:107],v12 offset:20480
ds_read_b64_tr_b16 a[234:235],v13 offset:20480
ds_read_b64_tr_b16 a[108:109],v12 offset:24576
ds_read_b64_tr_b16 a[236:237],v13 offset:24576
ds_read_b64_tr_b16 a[110:111],v12 offset:28672
ds_read_b64_tr_b16 a[238:239],v13 offset:28672
s_waitcnt lgkmcnt(4)
ds_read_b64_tr_b16 a[112:113],v12 offset:32768
ds_read_b64_tr_b16 a[240:241],v13 offset:32768
ds_read_b64_tr_b16 a[114:115],v12 offset:36864
ds_read_b64_tr_b16 a[242:243],v13 offset:36864
ds_read_b64_tr_b16 a[116:117],v12 offset:40960
ds_read_b64_tr_b16 a[244:245],v13 offset:40960
ds_read_b64_tr_b16 a[118:119],v12 offset:45056
ds_read_b64_tr_b16 a[246:247],v13 offset:45056
s_waitcnt lgkmcnt(4)
ds_read_b64_tr_b16 a[120:121],v12 offset:49152
ds_read_b64_tr_b16 a[248:249],v13 offset:49152
ds_read_b64_tr_b16 a[122:123],v12 offset:53248
ds_read_b64_tr_b16 a[250:251],v13 offset:53248
ds_read_b64_tr_b16 a[124:125],v12 offset:57344
ds_read_b64_tr_b16 a[252:253],v13 offset:57344
ds_read_b64_tr_b16 a[126:127],v12 offset:61440
ds_read_b64_tr_b16 a[254:255],v13 offset:61440
s_waitcnt lgkmcnt(4)
v_xor_b32 v12,0x10000,v12
v_xor_b32 v13,0x10000,v13
s_waitcnt lgkmcnt(0)
s_barrier
v_mov_b32 v88,0x3f803f80
v_mov_b32 v89,0x3f803f80
v_mov_b32 v90,0x3f803f80
v_mov_b32 v91,0x3f803f80
s_nop 1
v_mfma_f32_16x16x32_bf16 v[52:55],a[0:3],v[88:91],0
v_mfma_f32_16x16x32_bf16 v[56:59],a[128:131],v[88:91],0
v_mfma_f32_16x16x32_bf16 v[52:55],a[4:7],v[88:91],v[52:55]
v_mfma_f32_16x16x32_bf16 v[56:59],a[132:135],v[88:91],v[56:59]
v_mfma_f32_16x16x32_bf16 v[52:55],a[8:11],v[88:91],v[52:55]
v_mfma_f32_16x16x32_bf16 v[56:59],a[136:139],v[88:91],v[56:59]
v_mfma_f32_16x16x32_bf16 v[52:55],a[12:15],v[88:91],v[52:55]
v_mfma_f32_16x16x32_bf16 v[56:59],a[140:143],v[88:91],v[56:59]
v_mfma_f32_16x16x32_bf16 v[52:55],a[16:19],v[88:91],v[52:55]
v_mfma_f32_16x16x32_bf16 v[56:59],a[144:147],v[88:91],v[56:59]
v_mfma_f32_16x16x32_bf16 v[52:55],a[20:23],v[88:91],v[52:55]
v_mfma_f32_16x16x32_bf16 v[56:59],a[148:151],v[88:91],v[56:59]
v_mfma_f32_16x16x32_bf16 v[52:55],a[24:27],v[88:91],v[52:55]
v_mfma_f32_16x16x32_bf16 v[56:59],a[152:155],v[88:91],v[56:59]
v_mfma_f32_16x16x32_bf16 v[52:55],a[28:31],v[88:91],v[52:55]
v_mfma_f32_16x16x32_bf16 v[56:59],a[156:159],v[88:91],v[56:59]
v_mfma_f32_16x16x32_bf16 v[52:55],a[32:35],v[88:91],v[52:55]
v_mfma_f32_16x16x32_bf16 v[56:59],a[160:163],v[88:91],v[56:59]
v_mfma_f32_16x16x32_bf16 v[52:55],a[36:39],v[88:91],v[52:55]
v_mfma_f32_16x16x32_bf16 v[56:59],a[164:167],v[88:91],v[56:59]
v_mfma_f32_16x16x32_bf16 v[52:55],a[40:43],v[88:91],v[52:55]
v_mfma_f32_16x16x32_bf16 v[56:59],a[168:171],v[88:91],v[56:59]
v_mfma_f32_16x16x32_bf16 v[52:55],a[44:47],v[88:91],v[52:55]
v_mfma_f32_16x16x32_bf16 v[56:59],a[172:175],v[88:91],v[56:59]
v_mfma_f32_16x16x32_bf16 v[52:55],a[48:51],v[88:91],v[52:55]
v_mfma_f32_16x16x32_bf16 v[56:59],a[176:179],v[88:91],v[56:59]
v_mfma_f32_16x16x32_bf16 v[52:55],a[52:55],v[88:91],v[52:55]
v_mfma_f32_16x16x32_bf16 v[56:59],a[180:183],v[88:91],v[56:59]
v_mfma_f32_16x16x32_bf16 v[52:55],a[56:59],v[88:91],v[52:55]
v_mfma_f32_16x16x32_bf16 v[56:59],a[184:187],v[88:91],v[56:59]
v_mfma_f32_16x16x32_bf16 v[52:55],a[60:63],v[88:91],v[52:55]
v_mfma_f32_16x16x32_bf16 v[56:59],a[188:191],v[88:91],v[56:59]
v_mfma_f32_16x16x32_bf16 v[52:55],a[64:67],v[88:91],v[52:55]
v_mfma_f32_16x16x32_bf16 v[56:59],a[192:195],v[88:91],v[56:59]
v_mfma_f32_16x16x32_bf16 v[52:55],a[68:71],v[88:91],v[52:55]
v_mfma_f32_16x16x32_bf16 v[56:59],a[196:199],v[88:91],v[56:59]
v_mfma_f32_16x16x32_bf16 v[52:55],a[72:75],v[88:91],v[52:55]
v_mfma_f32_16x16x32_bf16 v[56:59],a[200:203],v[88:91],v[56:59]
v_mfma_f32_16x16x32_bf16 v[52:55],a[76:79],v[88:91],v[52:55]
v_mfma_f32_16x16x32_bf16 v[56:59],a[204:207],v[88:91],v[56:59]
v_mfma_f32_16x16x32_bf16 v[52:55],a[80:83],v[88:91],v[52:55]
v_mfma_f32_16x16x32_bf16 v[56:59],a[208:211],v[88:91],v[56:59]
v_mfma_f32_16x16x32_bf16 v[52:55],a[84:87],v[88:91],v[52:55]
v_mfma_f32_16x16x32_bf16 v[56:59],a[212:215],v[88:91],v[56:59]
v_mfma_f32_16x16x32_bf16 v[52:55],a[88:91],v[88:91],v[52:55]
v_mfma_f32_16x16x32_bf16 v[56:59],a[216:219],v[88:91],v[56:59]
v_mfma_f32_16x16x32_bf16 v[52:55],a[92:95],v[88:91],v[52:55]
v_mfma_f32_16x16x32_bf16 v[56:59],a[220:223],v[88:91],v[56:59]
v_mfma_f32_16x16x32_bf16 v[52:55],a[96:99],v[88:91],v[52:55]
v_mfma_f32_16x16x32_bf16 v[56:59],a[224:227],v[88:91],v[56:59]
v_mfma_f32_16x16x32_bf16 v[52:55],a[100:103],v[88:91],v[52:55]
v_mfma_f32_16x16x32_bf16 v[56:59],a[228:231],v[88:91],v[56:59]
v_mfma_f32_16x16x32_bf16 v[52:55],a[104:107],v[88:91],v[52:55]
v_mfma_f32_16x16x32_bf16 v[56:59],a[232:235],v[88:91],v[56:59]
v_mfma_f32_16x16x32_bf16 v[52:55],a[108:111],v[88:91],v[52:55]
v_mfma_f32_16x16x32_bf16 v[56:59],a[236:239],v[88:91],v[56:59]
v_mfma_f32_16x16x32_bf16 v[52:55],a[112:115],v[88:91],v[52:55]
v_mfma_f32_16x16x32_bf16 v[56:59],a[240:243],v[88:91],v[56:59]
v_mfma_f32_16x16x32_bf16 v[52:55],a[116:119],v[88:91],v[52:55]
v_mfma_f32_16x16x32_bf16 v[56:59],a[244:247],v[88:91],v[56:59]
v_mfma_f32_16x16x32_bf16 v[52:55],a[120:123],v[88:91],v[52:55]
v_mfma_f32_16x16x32_bf16 v[56:59],a[248:251],v[88:91],v[56:59]
v_mfma_f32_16x16x32_bf16 v[52:55],a[124:127],v[88:91],v[52:55]
v_mfma_f32_16x16x32_bf16 v[56:59],a[252:255],v[88:91],v[56:59]
v_and_b32 v21,1,v1
v_mul_u32_u24 v21,960,v21
s_mov_b32 s65,21052032
s_mov_b32 s66,1792
pl_374:
buffer_load_dword v22,v21,s[20:23],s65 offen sc1
s_waitcnt vmcnt(0)
v_cmp_gt_u32 vcc,s66,v22
s_cbranch_vccz pok_375
s_sleep 1
s_sub_u32 s90,s90,1
s_cmp_gt_i32 s90,0
s_cbranch_scc1 pl_374
pok_375:
s_mov_b32 s81,0xbdd2d3e8
v_mov_b32 v28,0xc0135761
s_lshr_b32 s41,s59,3
s_and_b32 s42,s59,7
s_mul_i32 s64,s42,3
s_add_u32 s64,s64,s50
s_lshr_b32 s65,s42,1
s_add_u32 s65,s65,24
s_cmp_eq_u32 s50,3
s_cselect_b32 s64,s65,s64
s_and_b32 s65,s42,1
s_lshl_b32 s65,s65,3
s_cmp_eq_u32 s50,3
s_cselect_b32 s65,s65,0
s_and_b32 s66,s64,3
s_lshl_b32 s66,s66,11
s_add_u32 s65,s65,s66
s_lshr_b32 s64,s64,2
s_mul_i32 s66,s41,7
s_add_u32 s64,s64,s66
s_add_u32 s64,s64,81
s_lshl_b32 s64,s64,14
s_add_u32 s64,s64,s65
v_add_u32 v18,s64,v16
v_mov_b32 v17,v16
v_lshlrev_b32 v19,4,v3
v_add_u32 v19,131072,v19
v_and_b32 v21,7,v1
v_lshlrev_b32 v21,7,v21
v_bfe_u32 v6,v1,3,2
v_lshl_add_u32 v21,v6,2,v21
s_add_u32 s74,s63,6144
s_add_u32 s74,s74,s60
s_lshl_b32 s73,s59,7
s_lshl_b32 s64,s50,2
s_add_u32 s73,s73,s64
s_add_u32 s73,s73,s63
s_add_u32 s73,s73,20480
s_lshl_b32 s64,s60,4
s_add_u32 s73,s73,s64
s_mov_b32 s82,0x3a800000
s_mov_b32 s64,0
s_lshr_b32 s65,s50,1
s_and_b32 s66,s50,1
s_lshl_b32 s66,s66,12
s_add_u32 s66,s66,s64
s_lshl_b32 s72,s65,13
s_add_u32 s72,s72,s66
s_add_u32 s72,s72,0x10000
s_lshl_b32 s65,s65,14
s_add_u32 s75,s65,s66
s_add_u32 s75,s75,1179648
s_cmp_eq_u32 s50,3
s_cbranch_scc1 w3b_376
s_add_u32 s64,s79,0
s_lshl_b32 s70,s64,21
s_lshl_b32 s64,s64,13
s_and_b32 s64,s64,0x2000
s_xor_b32 s64,s64,s62
s_add_u32 s70,s70,s64
s_add_u32 s70,s70,29360128
s_mov_b32 s83,1
s_mov_b32 s87,s74
s_cmp_eq_u32 s50,0
s_cselect_b32 s74,s74,0x7fff0000
v_mov_b32 v47,132096
s_lshl_b32 s64,s50,3
s_add_u32 s64,s64,132096
v_mov_b32 v46,s64
v_mov_b32 v29,0
s_mov_b32 s97,0x7fff0000
s_mov_b32 s69,1
s_mov_b32 s68,0
s_mov_b32 s52,0x30003
s_mov_b32 s53,s52
seg_378:
s_cmp_eq_u32 s83,0
s_cbranch_scc1 ahead_379
s_add_u32 s94,s70,s75
s_xor_b32 s95,s94,1024
s_xor_b32 s91,s72,0x10000
s_cmp_eq_u32 s69,0
s_mov_b32 s69,1
s_cbranch_scc1 half2_383
s_waitcnt vmcnt(2)
v_cmp_gt_u32 vcc,s71,v29
s_cbranch_vccz nb_382
s_waitcnt vmcnt(0)
v_add_u32 v22,s71,-1
buffer_store_dword v22,v23,s[20:23],s97 offen sc1
s_mov_b32 s97,0x7fff0000
s_cmp_lg_u32 s50,0
s_cbranch_scc1 nb_382
buffer_load_dword v32,v21,s[20:23],s74 offen sc1
s_sleep 2
pl_384:
buffer_load_dword v33,v21,s[20:23],s74 offen sc1
s_waitcnt vmcnt(1)
v_cmp_gt_u32 vcc,s71,v32
v_mov_b32 v29,v32
s_cbranch_vccz pok_385
buffer_load_dword v32,v21,s[20:23],s74 offen sc1
s_waitcnt vmcnt(1)
v_cmp_gt_u32 vcc,s71,v33
v_mov_b32 v29,v33
s_cbranch_vccz pok_385
s_sub_u32 s90,s90,1
s_cmp_gt_i32 s90,0
s_cbranch_scc1 pl_384
pok_385:
nb_382:
s_cmp_eq_u32 s71,64
s_barrier
s_cbranch_scc1 half_386
s_xor_b32 m0,s91,0
s_add_u32 s65,s94,0
buffer_load_dwordx4 v16,s[20:23],s65 offen offset:0 sc1 lds
buffer_load_dwordx4 v16,s[20:23],s65 offen offset:2048 sc1 lds
s_xor_b32 m0,s91,16384
s_add_u32 s65,s94,32768
buffer_load_dwordx4 v16,s[20:23],s65 offen offset:0 sc1 lds
buffer_load_dwordx4 v16,s[20:23],s65 offen offset:2048 sc1 lds
s_xor_b32 m0,s91,32768
s_add_u32 s65,s94,65536
buffer_load_dwordx4 v16,s[20:23],s65 offen offset:0 sc1 lds
buffer_load_dwordx4 v16,s[20:23],s65 offen offset:2048 sc1 lds
s_xor_b32 m0,s91,49152
s_add_u32 s65,s94,98304
buffer_load_dwordx4 v16,s[20:23],s65 offen offset:0 sc1 lds
buffer_load_dwordx4 v16,s[20:23],s65 offen offset:2048 sc1 lds
s_waitcnt vmcnt(8)
v_add_u32 v22,s71,-1
buffer_store_dword v22,v23,s[20:23],s97 offen sc1
s_mov_b32 s97,0x7fff0000
s_waitcnt vmcnt(7)
s_barrier
ds_read_b128 v[224:227],v17 offset:0
ds_read_b128 v[228:231],v17 offset:2048
ds_read_b128 v[232:235],v17 offset:4096
ds_read_b128 v[236:239],v17 offset:6144
ds_read_b128 v[240:243],v17 offset:8192
ds_read_b128 v[244:247],v17 offset:10240
ds_read_b128 v[248:251],v17 offset:12288
s_waitcnt lgkmcnt(5)
v_mfma_f32_16x16x32_bf16 v[64:67],a[0:3],v[224:227],0
s_xor_b32 m0,s91,1024
s_add_u32 s96,s71,1
s_add_u32 s92,s71,2
v_min_u32 v27,v224,v228
v_mfma_f32_16x16x32_bf16 v[72:75],a[128:131],v[224:227],0
ds_read_b128 v[252:255],v17 offset:14336
s_cmp_eq_u32 s96,64
s_cselect_b32 s96,99,s96
v_mfma_f32_16x16x32_bf16 v[64:67],a[4:7],v[228:231],v[64:67]
s_add_u32 s65,s95,0
s_cmp_eq_u32 s92,64
s_cselect_b32 s92,99,s92
v_mfma_f32_16x16x32_bf16 v[72:75],a[132:135],v[228:231],v[72:75]
s_waitcnt vmcnt(5)
s_barrier
ds_read_b128 v[224:227],v17 offset:16384
s_waitcnt lgkmcnt(5)
v_mfma_f32_16x16x32_bf16 v[64:67],a[8:11],v[232:235],v[64:67]
buffer_load_dwordx4 v16,s[20:23],s65 offen offset:0 sc1 lds
v_mfma_f32_16x16x32_bf16 v[72:75],a[136:139],v[232:235],v[72:75]
ds_read_b128 v[228:231],v17 offset:18432
v_min3_u32 v27,v27,v232,v236
v_mfma_f32_16x16x32_bf16 v[64:67],a[12:15],v[236:239],v[64:67]
buffer_load_dwordx4 v16,s[20:23],s65 offen offset:2048 sc1 lds
v_mfma_f32_16x16x32_bf16 v[72:75],a[140:143],v[236:239],v[72:75]
ds_read_b128 v[232:235],v17 offset:20480
s_waitcnt lgkmcnt(5)
v_mfma_f32_16x16x32_bf16 v[64:67],a[16:19],v[240:243],v[64:67]
s_xor_b32 m0,s91,17408
v_min3_u32 v27,v27,v240,v244
v_mfma_f32_16x16x32_bf16 v[72:75],a[144:147],v[240:243],v[72:75]
ds_read_b128 v[236:239],v17 offset:22528
v_mfma_f32_16x16x32_bf16 v[64:67],a[20:23],v[244:247],v[64:67]
s_add_u32 s65,s95,32768
v_mfma_f32_16x16x32_bf16 v[72:75],a[148:151],v[244:247],v[72:75]
ds_read_b128 v[240:243],v17 offset:24576
s_waitcnt lgkmcnt(5)
v_mfma_f32_16x16x32_bf16 v[64:67],a[24:27],v[248:251],v[64:67]
buffer_load_dwordx4 v16,s[20:23],s65 offen offset:0 sc1 lds
v_mfma_f32_16x16x32_bf16 v[72:75],a[152:155],v[248:251],v[72:75]
ds_read_b128 v[244:247],v17 offset:26624
v_min3_u32 v27,v27,v248,v252
v_mfma_f32_16x16x32_bf16 v[64:67],a[28:31],v[252:255],v[64:67]
buffer_load_dwordx4 v16,s[20:23],s65 offen offset:2048 sc1 lds
v_mfma_f32_16x16x32_bf16 v[72:75],a[156:159],v[252:255],v[72:75]
ds_read_b128 v[248:251],v17 offset:28672
s_waitcnt lgkmcnt(5)
v_mfma_f32_16x16x32_bf16 v[64:67],a[32:35],v[224:227],v[64:67]
s_xor_b32 m0,s91,33792
v_min3_u32 v27,v27,v224,v228
v_mfma_f32_16x16x32_bf16 v[72:75],a[160:163],v[224:227],v[72:75]
ds_read_b128 v[252:255],v17 offset:30720
v_mfma_f32_16x16x32_bf16 v[64:67],a[36:39],v[228:231],v[64:67]
s_add_u32 s65,s95,65536
v_mfma_f32_16x16x32_bf16 v[72:75],a[164:167],v[228:231],v[72:75]
s_waitcnt vmcnt(5)
s_barrier
ds_read_b128 v[224:227],v17 offset:32768
s_waitcnt lgkmcnt(5)
v_mfma_f32_16x16x32_bf16 v[64:67],a[40:43],v[232:235],v[64:67]
buffer_load_dwordx4 v16,s[20:23],s65 offen offset:0 sc1 lds
v_mfma_f32_16x16x32_bf16 v[72:75],a[168:171],v[232:235],v[72:75]
ds_read_b128 v[228:231],v17 offset:34816
v_min3_u32 v27,v27,v232,v236
v_mfma_f32_16x16x32_bf16 v[64:67],a[44:47],v[236:239],v[64:67]
buffer_load_dwordx4 v16,s[20:23],s65 offen offset:2048 sc1 lds
v_mfma_f32_16x16x32_bf16 v[72:75],a[172:175],v[236:239],v[72:75]
ds_read_b128 v[232:235],v17 offset:36864
s_waitcnt lgkmcnt(5)
v_mfma_f32_16x16x32_bf16 v[64:67],a[48:51],v[240:243],v[64:67]
s_xor_b32 m0,s91,50176
v_min3_u32 v27,v27,v240,v244
v_mfma_f32_16x16x32_bf16 v[72:75],a[176:179],v[240:243],v[72:75]
ds_read_b128 v[236:239],v17 offset:38912
v_mfma_f32_16x16x32_bf16 v[64:67],a[52:55],v[244:247],v[64:67]
s_add_u32 s65,s95,98304
v_mfma_f32_16x16x32_bf16 v[72:75],a[180:183],v[244:247],v[72:75]
ds_read_b128 v[240:243],v17 offset:40960
s_waitcnt lgkmcnt(5)
v_mfma_f32_16x16x32_bf16 v[64:67],a[56:59],v[248:251],v[64:67]
buffer_load_dwordx4 v16,s[20:23],s65 offen offset:0 sc1 lds
v_min3_u32 v27,v27,v248,v252
v_mfma_f32_16x16x32_bf16 v[72:75],a[184:187],v[248:251],v[72:75]
ds_read_b128 v[244:247],v17 offset:43008
s_waitcnt vmcnt(63)
v_mfma_f32_16x16x32_bf16 v[64:67],a[60:63],v[252:255],v[64:67]
buffer_load_dwordx4 v16,s[20:23],s65 offen offset:2048 sc1 lds
v_mfma_f32_16x16x32_bf16 v[72:75],a[188:191],v[252:255],v[72:75]
ds_read_b128 v[248:251],v17 offset:45056
s_waitcnt lgkmcnt(5)
v_mfma_f32_16x16x32_bf16 v[64:67],a[64:67],v[224:227],v[64:67]
v_cmp_gt_u32 vcc,s96,v29
v_cmp_gt_u32 s[92:93],s92,v29
v_mfma_f32_16x16x32_bf16 v[72:75],a[192:195],v[224:227],v[72:75]
ds_read_b128 v[252:255],v17 offset:47104
v_min3_u32 v27,v27,v224,v228
v_mfma_f32_16x16x32_bf16 v[64:67],a[68:71],v[228:231],v[64:67]
v_mov_b32 v44,vcc_lo
v_mov_b32 v45,s92
v_mfma_f32_16x16x32_bf16 v[72:75],a[196:199],v[228:231],v[72:75]
ds_read_b128 v[224:227],v17 offset:49152
s_waitcnt lgkmcnt(5)
v_mfma_f32_16x16x32_bf16 v[64:67],a[72:75],v[232:235],v[64:67]
ds_write_b64 v46,v[44:45]
v_min3_u32 v27,v27,v232,v236
v_mfma_f32_16x16x32_bf16 v[72:75],a[200:203],v[232:235],v[72:75]
ds_read_b128 v[228:231],v17 offset:51200
v_mfma_f32_16x16x32_bf16 v[64:67],a[76:79],v[236:239],v[64:67]
v_mfma_f32_16x16x32_bf16 v[72:75],a[204:207],v[236:239],v[72:75]
ds_read_b128 v[232:235],v17 offset:53248
s_waitcnt lgkmcnt(6)
v_mfma_f32_16x16x32_bf16 v[64:67],a[80:83],v[240:243],v[64:67]
v_min3_u32 v27,v27,v240,v244
s_add_u32 s88,s70,s75
v_mfma_f32_16x16x32_bf16 v[72:75],a[208:211],v[240:243],v[72:75]
ds_read_b128 v[236:239],v17 offset:55296
s_add_u32 s88,s88,2097152
v_mfma_f32_16x16x32_bf16 v[64:67],a[84:87],v[244:247],v[64:67]
s_xor_b32 s88,s88,0x2000
s_xor_b32 s89,s88,1024
v_mfma_f32_16x16x32_bf16 v[72:75],a[212:215],v[244:247],v[72:75]
ds_read_b128 v[240:243],v17 offset:57344
s_waitcnt lgkmcnt(6)
v_mfma_f32_16x16x32_bf16 v[64:67],a[88:91],v[248:251],v[64:67]
v_min3_u32 v27,v27,v248,v252
v_mfma_f32_16x16x32_bf16 v[72:75],a[216:219],v[248:251],v[72:75]
ds_read_b128 v[244:247],v17 offset:59392
v_mfma_f32_16x16x32_bf16 v[64:67],a[92:95],v[252:255],v[64:67]
v_mfma_f32_16x16x32_bf16 v[72:75],a[220:223],v[252:255],v[72:75]
ds_read_b128 v[248:251],v17 offset:61440
s_waitcnt lgkmcnt(5)
v_mfma_f32_16x16x32_bf16 v[64:67],a[96:99],v[224:227],v[64:67]
v_min3_u32 v27,v27,v224,v228
v_mfma_f32_16x16x32_bf16 v[72:75],a[224:227],v[224:227],v[72:75]
ds_read_b128 v[252:255],v17 offset:63488
v_mfma_f32_16x16x32_bf16 v[64:67],a[100:103],v[228:231],v[64:67]
v_mfma_f32_16x16x32_bf16 v[72:75],a[228:231],v[228:231],v[72:75]
s_waitcnt vmcnt(4)
s_barrier
ds_read_b64 v[44:45],v47
ds_read_b128 v[224:227],v17 offset:1024
s_waitcnt lgkmcnt(6)
v_mfma_f32_16x16x32_bf16 v[64:67],a[104:107],v[232:235],v[64:67]
v_min3_u32 v27,v27,v232,v236
ds_read_b128 v[124:127],v19 offset:256
v_mfma_f32_16x16x32_bf16 v[72:75],a[232:235],v[232:235],v[72:75]
ds_read_b128 v[228:231],v17 offset:3072
ds_read_b128 v[120:123],v19 offset:0
v_mfma_f32_16x16x32_bf16 v[64:67],a[108:111],v[236:239],v[64:67]
v_mfma_f32_16x16x32_bf16 v[72:75],a[236:239],v[236:239],v[72:75]
ds_read_b128 v[232:235],v17 offset:5120
s_waitcnt lgkmcnt(8)
v_mfma_f32_16x16x32_bf16 v[64:67],a[112:115],v[240:243],v[64:67]
v_min3_u32 v27,v27,v240,v244
v_mfma_f32_16x16x32_bf16 v[72:75],a[240:243],v[240:243],v[72:75]
ds_read_b128 v[236:239],v17 offset:7168
v_mfma_f32_16x16x32_bf16 v[64:67],a[116:119],v[244:247],v[64:67]
v_mfma_f32_16x16x32_bf16 v[72:75],a[244:247],v[244:247],v[72:75]
ds_read_b128 v[240:243],v17 offset:9216
s_waitcnt lgkmcnt(8)
v_mfma_f32_16x16x32_bf16 v[64:67],a[120:123],v[248:251],v[64:67]
s_waitcnt lgkmcnt(7)
v_readfirstlane_b32 s93,v45
v_mfma_f32_16x16x32_bf16 v[72:75],a[248:251],v[248:251],v[72:75]
ds_read_b128 v[244:247],v17 offset:11264
v_readfirstlane_b32 s83,v44
s_cmp_lg_u32 s83,0
s_cbranch_scc0 keep_388
v_mfma_f32_16x16x32_bf16 v[64:67],a[124:127],v[252:255],v[64:67]
v_min3_u32 v27,v27,v248,v252
v_mfma_f32_16x16x32_bf16 v[72:75],a[252:255],v[252:255],v[72:75]
ds_read_b128 v[248:251],v17 offset:13312
s_waitcnt lgkmcnt(6)
v_mfma_f32_16x16x32_bf16 v[68:71],a[0:3],v[224:227],0
v_cmp_eq_u32 vcc,0,v27
s_cbranch_vccnz retry_377
v_mfma_f32_16x16x32_bf16 v[76:79],a[128:131],v[224:227],0
ds_read_b128 v[252:255],v17 offset:15360
v_min3_u32 v27,v27,v224,v228
v_mfma_f32_16x16x32_bf16 v[68:71],a[4:7],v[228:231],v[68:71]
s_waitcnt lgkmcnt(6)
v_mfma_f32_16x16x32_bf16 v[76:79],a[132:135],v[228:231],v[76:79]
ds_read_b128 v[224:227],v17 offset:17408
s_waitcnt lgkmcnt(5)
v_mfma_f32_16x16x32_bf16 v[68:71],a[8:11],v[232:235],v[68:71]
v_min3_u32 v27,v27,v232,v236
v_fmac_f32 v64,v52,v120
v_fmac_f32 v72,v56,v120
v_mfma_f32_16x16x32_bf16 v[76:79],a[136:139],v[232:235],v[76:79]
ds_read_b128 v[228:231],v17 offset:19456
v_fmac_f32 v65,v53,v120
v_fmac_f32 v73,v57,v120
v_mfma_f32_16x16x32_bf16 v[68:71],a[12:15],v[236:239],v[68:71]
v_fmac_f32 v66,v54,v120
v_fmac_f32 v67,v55,v120
v_fmac_f32 v74,v58,v120
v_mfma_f32_16x16x32_bf16 v[76:79],a[140:143],v[236:239],v[76:79]
ds_read_b128 v[232:235],v17 offset:21504
v_fmac_f32 v75,v59,v120
s_waitcnt lgkmcnt(5)
v_mfma_f32_16x16x32_bf16 v[68:71],a[16:19],v[240:243],v[68:71]
v_min3_u32 v27,v27,v240,v244
v_mul_f32 v88,v64,v64
v_mul_f32 v92,v72,v72
v_mfma_f32_16x16x32_bf16 v[76:79],a[144:147],v[240:243],v[76:79]
ds_read_b128 v[236:239],v17 offset:23552
v_mul_f32 v89,v65,v65
v_mul_f32 v93,v73,v73
v_mfma_f32_16x16x32_bf16 v[68:71],a[20:23],v[244:247],v[68:71]
v_mul_f32 v90,v66,v66
v_mul_f32 v91,v67,v67
v_mul_f32 v94,v74,v74
v_mfma_f32_16x16x32_bf16 v[76:79],a[148:151],v[244:247],v[76:79]
ds_read_b128 v[240:243],v17 offset:25600
v_mul_f32 v95,v75,v75
s_waitcnt lgkmcnt(5)
v_mfma_f32_16x16x32_bf16 v[68:71],a[24:27],v[248:251],v[68:71]
v_min3_u32 v27,v27,v248,v252
v_fma_f32 v88,v88,v121,v122
v_fma_f32 v92,v92,v121,v122
v_mfma_f32_16x16x32_bf16 v[76:79],a[152:155],v[248:251],v[76:79]
ds_read_b128 v[244:247],v17 offset:27648
v_fma_f32 v89,v89,v121,v122
v_fma_f32 v93,v93,v121,v122
v_mfma_f32_16x16x32_bf16 v[68:71],a[28:31],v[252:255],v[68:71]
v_fma_f32 v90,v90,v121,v122
v_fma_f32 v91,v91,v121,v122
v_fma_f32 v94,v94,v121,v122
v_mfma_f32_16x16x32_bf16 v[76:79],a[156:159],v[252:255],v[76:79]
ds_read_b128 v[248:251],v17 offset:29696
v_fma_f32 v95,v95,v121,v122
s_waitcnt lgkmcnt(5)
v_mfma_f32_16x16x32_bf16 v[68:71],a[32:35],v[224:227],v[68:71]
v_min3_u32 v27,v27,v224,v228
v_mul_f32 v88,v88,v64
v_mul_f32 v92,v92,v72
v_mfma_f32_16x16x32_bf16 v[76:79],a[160:163],v[224:227],v[76:79]
ds_read_b128 v[252:255],v17 offset:31744
v_mul_f32 v89,v89,v65
v_mul_f32 v93,v93,v73
v_mfma_f32_16x16x32_bf16 v[68:71],a[36:39],v[228:231],v[68:71]
v_mul_f32 v90,v90,v66
v_mul_f32 v91,v91,v67
v_mul_f32 v94,v94,v74
v_mfma_f32_16x16x32_bf16 v[76:79],a[164:167],v[228:231],v[76:79]
s_waitcnt vmcnt(0)
s_barrier
ds_read_b128 v[224:227],v17 offset:33792
s_waitcnt lgkmcnt(5)
v_mfma_f32_16x16x32_bf16 v[68:71],a[40:43],v[232:235],v[68:71]
v_min3_u32 v27,v27,v232,v236
v_mul_f32 v95,v95,v75
v_mfma_f32_16x16x32_bf16 v[76:79],a[168:171],v[232:235],v[76:79]
ds_read_b128 v[228:231],v17 offset:35840
v_exp_f32 v92,v92
v_mfma_f32_16x16x32_bf16 v[68:71],a[44:47],v[236:239],v[68:71]
v_exp_f32 v88,v88
v_mfma_f32_16x16x32_bf16 v[76:79],a[172:175],v[236:239],v[76:79]
ds_read_b128 v[232:235],v17 offset:37888
s_waitcnt lgkmcnt(5)
v_mfma_f32_16x16x32_bf16 v[68:71],a[48:51],v[240:243],v[68:71]
v_min3_u32 v27,v27,v240,v244
v_exp_f32 v93,v93
v_mfma_f32_16x16x32_bf16 v[76:79],a[176:179],v[240:243],v[76:79]
ds_read_b128 v[236:239],v17 offset:39936
v_exp_f32 v94,v94
v_mfma_f32_16x16x32_bf16 v[68:71],a[52:55],v[244:247],v[68:71]
v_exp_f32 v89,v89
v_mfma_f32_16x16x32_bf16 v[76:79],a[180:183],v[244:247],v[76:79]
ds_read_b128 v[240:243],v17 offset:41984
s_waitcnt lgkmcnt(5)
v_mfma_f32_16x16x32_bf16 v[68:71],a[56:59],v[248:251],v[68:71]
v_min3_u32 v27,v27,v248,v252
v_exp_f32 v95,v95
v_mfma_f32_16x16x32_bf16 v[76:79],a[184:187],v[248:251],v[76:79]
ds_read_b128 v[244:247],v17 offset:44032
v_fma_f32 v92,v92,v123,v123
v_fma_f32 v93,v93,v123,v123
v_mfma_f32_16x16x32_bf16 v[68:71],a[60:63],v[252:255],v[68:71]
v_exp_f32 v90,v90
v_fma_f32 v94,v94,v123,v123
v_mfma_f32_16x16x32_bf16 v[76:79],a[188:191],v[252:255],v[76:79]
ds_read_b128 v[248:251],v17 offset:46080
v_fma_f32 v95,v95,v123,v123
s_waitcnt lgkmcnt(5)
v_mfma_f32_16x16x32_bf16 v[68:71],a[64:67],v[224:227],v[68:71]
v_min3_u32 v27,v27,v224,v228
v_rcp_f32 v92,v92
v_mfma_f32_16x16x32_bf16 v[76:79],a[192:195],v[224:227],v[76:79]
ds_read_b128 v[252:255],v17 offset:48128
v_rcp_f32 v93,v93
v_mfma_f32_16x16x32_bf16 v[68:71],a[68:71],v[228:231],v[68:71]
v_exp_f32 v91,v91
v_mfma_f32_16x16x32_bf16 v[76:79],a[196:199],v[228:231],v[76:79]
ds_read_b128 v[224:227],v17 offset:50176
s_waitcnt lgkmcnt(5)
v_mfma_f32_16x16x32_bf16 v[68:71],a[72:75],v[232:235],v[68:71]
v_min3_u32 v27,v27,v232,v236
v_fma_f32 v88,v88,v123,v123
v_mfma_f32_16x16x32_bf16 v[76:79],a[200:203],v[232:235],v[76:79]
ds_read_b128 v[228:231],v17 offset:52224
v_fma_f32 v89,v89,v123,v123
v_mfma_f32_16x16x32_bf16 v[68:71],a[76:79],v[236:239],v[68:71]
v_fma_f32 v90,v90,v123,v123
v_fma_f32 v91,v91,v123,v123
v_mfma_f32_16x16x32_bf16 v[76:79],a[204:207],v[236:239],v[76:79]
ds_read_b128 v[232:235],v17 offset:54272
s_waitcnt lgkmcnt(5)
v_mfma_f32_16x16x32_bf16 v[68:71],a[80:83],v[240:243],v[68:71]
v_min3_u32 v27,v27,v240,v244
v_rcp_f32 v94,v94
v_mfma_f32_16x16x32_bf16 v[76:79],a[208:211],v[240:243],v[76:79]
ds_read_b128 v[236:239],v17 offset:56320
v_rcp_f32 v95,v95
v_mfma_f32_16x16x32_bf16 v[68:71],a[84:87],v[244:247],v[68:71]
v_rcp_f32 v88,v88
v_mfma_f32_16x16x32_bf16 v[76:79],a[212:215],v[244:247],v[76:79]
ds_read_b128 v[240:243],v17 offset:58368
s_waitcnt lgkmcnt(5)
v_mfma_f32_16x16x32_bf16 v[68:71],a[88:91],v[248:251],v[68:71]
v_min3_u32 v27,v27,v248,v252
v_mul_f32 v92,v92,v72
v_mfma_f32_16x16x32_bf16 v[76:79],a[216:219],v[248:251],v[76:79]
ds_read_b128 v[244:247],v17 offset:60416
v_mul_f32 v93,v93,v73
v_mfma_f32_16x16x32_bf16 v[68:71],a[92:95],v[252:255],v[68:71]
v_rcp_f32 v89,v89
v_mfma_f32_16x16x32_bf16 v[76:79],a[220:223],v[252:255],v[76:79]
ds_read_b128 v[248:251],v17 offset:62464
s_waitcnt lgkmcnt(5)
v_mfma_f32_16x16x32_bf16 v[68:71],a[96:99],v[224:227],v[68:71]
v_min3_u32 v27,v27,v224,v228
v_mul_f32 v94,v94,v74
v_mfma_f32_16x16x32_bf16 v[76:79],a[224:227],v[224:227],v[76:79]
ds_read_b128 v[252:255],v17 offset:64512
v_mul_f32 v95,v95,v75
v_mfma_f32_16x16x32_bf16 v[68:71],a[100:103],v[228:231],v[68:71]
v_rcp_f32 v90,v90
v_mfma_f32_16x16x32_bf16 v[76:79],a[228:231],v[228:231],v[76:79]
s_waitcnt lgkmcnt(4)
v_mfma_f32_16x16x32_bf16 v[68:71],a[104:107],v[232:235],v[68:71]
v_min3_u32 v27,v27,v232,v236
v_mfma_f32_16x16x32_bf16 v[76:79],a[232:235],v[232:235],v[76:79]
v_rcp_f32 v91,v91
v_mfma_f32_16x16x32_bf16 v[68:71],a[108:111],v[236:239],v[68:71]
v_mul_f32 v88,v88,v64
v_mul_f32 v89,v89,v65
v_mfma_f32_16x16x32_bf16 v[76:79],a[236:239],v[236:239],v[76:79]
v_mul_f32 v90,v90,v66
s_waitcnt lgkmcnt(2)
v_mfma_f32_16x16x32_bf16 v[68:71],a[112:115],v[240:243],v[68:71]
v_min3_u32 v27,v27,v240,v244
v_mul_f32 v91,v91,v67
v_mfma_f32_16x16x32_bf16 v[76:79],a[240:243],v[240:243],v[76:79]
v_cvt_pk_bf16_f32 v96,v88,v89
v_cvt_pk_bf16_f32 v97,v90,v91
v_mfma_f32_16x16x32_bf16 v[68:71],a[116:119],v[244:247],v[68:71]
v_cvt_pk_bf16_f32 v98,v92,v93
v_cvt_pk_bf16_f32 v99,v94,v95
v_mfma_f32_16x16x32_bf16 v[76:79],a[244:247],v[244:247],v[76:79]
v_max_u32 v96,1,v96
s_waitcnt lgkmcnt(0)
v_mfma_f32_16x16x32_bf16 v[68:71],a[120:123],v[248:251],v[68:71]
v_min3_u32 v27,v27,v248,v252
v_mfma_f32_16x16x32_bf16 v[76:79],a[248:251],v[248:251],v[76:79]
buffer_store_dwordx4 v[96:99],v18,s[20:23],s70 offen offset:0 sc1
v_mfma_f32_16x16x32_bf16 v[68:71],a[124:127],v[252:255],v[68:71]
v_mfma_f32_16x16x32_bf16 v[76:79],a[252:255],v[252:255],v[76:79]
v_cmp_eq_u32 vcc,0,v27
s_cbranch_vccnz retry_377
s_branch epi_380
keep_388:
v_mfma_f32_16x16x32_bf16 v[64:67],a[124:127],v[252:255],v[64:67]
v_min3_u32 v27,v27,v248,v252
s_xor_b32 m0,s72,0
v_mfma_f32_16x16x32_bf16 v[72:75],a[252:255],v[252:255],v[72:75]
ds_read_b128 v[248:251],v17 offset:13312
s_add_u32 s65,s88,0
s_waitcnt lgkmcnt(6)
v_mfma_f32_16x16x32_bf16 v[68:71],a[0:3],v[224:227],0
buffer_load_dwordx4 v16,s[20:23],s65 offen offset:0 sc1 lds
v_min3_u32 v27,v27,v224,v228
v_mfma_f32_16x16x32_bf16 v[76:79],a[128:131],v[224:227],0
ds_read_b128 v[252:255],v17 offset:15360
buffer_load_dwordx4 v16,s[20:23],s65 offen offset:2048 sc1 lds
v_mfma_f32_16x16x32_bf16 v[68:71],a[4:7],v[228:231],v[68:71]
v_cmp_eq_u32 vcc,0,v27
s_cbranch_vccnz retry_377
s_waitcnt lgkmcnt(6)
v_mfma_f32_16x16x32_bf16 v[76:79],a[132:135],v[228:231],v[76:79]
ds_read_b128 v[224:227],v17 offset:17408
s_xor_b32 m0,s72,16384
s_waitcnt lgkmcnt(5)
v_mfma_f32_16x16x32_bf16 v[68:71],a[8:11],v[232:235],v[68:71]
s_add_u32 s65,s88,32768
v_min3_u32 v27,v27,v232,v236
v_fmac_f32 v64,v52,v120
v_fmac_f32 v72,v56,v120
v_mfma_f32_16x16x32_bf16 v[76:79],a[136:139],v[232:235],v[76:79]
ds_read_b128 v[228:231],v17 offset:19456
buffer_load_dwordx4 v16,s[20:23],s65 offen offset:0 sc1 lds
v_fmac_f32 v73,v57,v120
v_mfma_f32_16x16x32_bf16 v[68:71],a[12:15],v[236:239],v[68:71]
v_fmac_f32 v65,v53,v120
v_fmac_f32 v66,v54,v120
v_fmac_f32 v67,v55,v120
v_fmac_f32 v74,v58,v120
v_mfma_f32_16x16x32_bf16 v[76:79],a[140:143],v[236:239],v[76:79]
ds_read_b128 v[232:235],v17 offset:21504
v_mul_f32 v88,v64,v64
v_fmac_f32 v75,v59,v120
s_waitcnt lgkmcnt(5)
v_mfma_f32_16x16x32_bf16 v[68:71],a[16:19],v[240:243],v[68:71]
buffer_load_dwordx4 v16,s[20:23],s65 offen offset:2048 sc1 lds
s_xor_b32 m0,s72,32768
v_mul_f32 v92,v72,v72
v_mfma_f32_16x16x32_bf16 v[76:79],a[144:147],v[240:243],v[76:79]
ds_read_b128 v[236:239],v17 offset:23552
s_add_u32 s65,s88,65536
v_mul_f32 v89,v65,v65
v_mul_f32 v93,v73,v73
v_mfma_f32_16x16x32_bf16 v[68:71],a[20:23],v[244:247],v[68:71]
v_min3_u32 v27,v27,v240,v244
v_mul_f32 v90,v66,v66
v_mul_f32 v91,v67,v67
v_mul_f32 v94,v74,v74
v_mfma_f32_16x16x32_bf16 v[76:79],a[148:151],v[244:247],v[76:79]
ds_read_b128 v[240:243],v17 offset:25600
v_fma_f32 v88,v88,v121,v122
v_mul_f32 v95,v75,v75
s_waitcnt lgkmcnt(5)
v_mfma_f32_16x16x32_bf16 v[68:71],a[24:27],v[248:251],v[68:71]
buffer_load_dwordx4 v16,s[20:23],s65 offen offset:0 sc1 lds
v_fma_f32 v89,v89,v121,v122
v_fma_f32 v92,v92,v121,v122
v_mfma_f32_16x16x32_bf16 v[76:79],a[152:155],v[248:251],v[76:79]
ds_read_b128 v[244:247],v17 offset:27648
buffer_load_dwordx4 v16,s[20:23],s65 offen offset:2048 sc1 lds
v_fma_f32 v93,v93,v121,v122
v_mfma_f32_16x16x32_bf16 v[68:71],a[28:31],v[252:255],v[68:71]
s_xor_b32 m0,s72,49152
v_min3_u32 v27,v27,v248,v252
v_fma_f32 v90,v90,v121,v122
v_fma_f32 v94,v94,v121,v122
v_mfma_f32_16x16x32_bf16 v[76:79],a[156:159],v[252:255],v[76:79]
ds_read_b128 v[248:251],v17 offset:29696
s_add_u32 s65,s88,98304
v_fma_f32 v95,v95,v121,v122
s_waitcnt lgkmcnt(5)
v_mfma_f32_16x16x32_bf16 v[68:71],a[32:35],v[224:227],v[68:71]
buffer_load_dwordx4 v16,s[20:23],s65 offen offset:0 sc1 lds
v_fma_f32 v91,v91,v121,v122
v_mul_f32 v92,v92,v72
v_mfma_f32_16x16x32_bf16 v[76:79],a[160:163],v[224:227],v[76:79]
ds_read_b128 v[252:255],v17 offset:31744
v_min3_u32 v27,v27,v224,v228
v_mul_f32 v88,v88,v64
v_mul_f32 v93,v93,v73
v_mfma_f32_16x16x32_bf16 v[68:71],a[36:39],v[228:231],v[68:71]
buffer_load_dwordx4 v16,s[20:23],s65 offen offset:2048 sc1 lds
v_mul_f32 v89,v89,v65
v_mul_f32 v94,v94,v74
v_mfma_f32_16x16x32_bf16 v[76:79],a[164:167],v[228:231],v[76:79]
s_waitcnt vmcnt(8)
s_barrier
ds_read_b128 v[224:227],v17 offset:33792
s_waitcnt lgkmcnt(5)
v_mfma_f32_16x16x32_bf16 v[68:71],a[40:43],v[232:235],v[68:71]
s_xor_b32 m0,s72,1024
s_add_u32 s65,s89,0
v_mul_f32 v90,v90,v66
v_mul_f32 v95,v95,v75
v_mfma_f32_16x16x32_bf16 v[76:79],a[168:171],v[232:235],v[76:79]
ds_read_b128 v[228:231],v17 offset:35840
v_min3_u32 v27,v27,v232,v236
v_mul_f32 v91,v91,v67
v_mfma_f32_16x16x32_bf16 v[68:71],a[44:47],v[236:239],v[68:71]
buffer_load_dwordx4 v16,s[20:23],s65 offen offset:0 sc1 lds
v_exp_f32 v92,v92
v_mfma_f32_16x16x32_bf16 v[76:79],a[172:175],v[236:239],v[76:79]
ds_read_b128 v[232:235],v17 offset:37888
v_exp_f32 v93,v93
s_waitcnt lgkmcnt(5)
v_mfma_f32_16x16x32_bf16 v[68:71],a[48:51],v[240:243],v[68:71]
buffer_load_dwordx4 v16,s[20:23],s65 offen offset:2048 sc1 lds
v_exp_f32 v94,v94
v_mfma_f32_16x16x32_bf16 v[76:79],a[176:179],v[240:243],v[76:79]
ds_read_b128 v[236:239],v17 offset:39936
s_xor_b32 m0,s72,17408
v_exp_f32 v95,v95
v_mfma_f32_16x16x32_bf16 v[68:71],a[52:55],v[244:247],v[68:71]
s_add_u32 s65,s89,32768
v_min3_u32 v27,v27,v240,v244
v_fma_f32 v92,v92,v123,v123
v_fma_f32 v93,v93,v123,v123
v_mfma_f32_16x16x32_bf16 v[76:79],a[180:183],v[244:247],v[76:79]
ds_read_b128 v[240:243],v17 offset:41984
v_fma_f32 v94,v94,v123,v123
v_fma_f32 v95,v95,v123,v123
s_waitcnt lgkmcnt(5)
v_mfma_f32_16x16x32_bf16 v[68:71],a[56:59],v[248:251],v[68:71]
buffer_load_dwordx4 v16,s[20:23],s65 offen offset:0 sc1 lds
v_rcp_f32 v92,v92
v_mfma_f32_16x16x32_bf16 v[76:79],a[184:187],v[248:251],v[76:79]
ds_read_b128 v[244:247],v17 offset:44032
v_min3_u32 v27,v27,v248,v252
v_rcp_f32 v93,v93
v_mfma_f32_16x16x32_bf16 v[68:71],a[60:63],v[252:255],v[68:71]
buffer_load_dwordx4 v16,s[20:23],s65 offen offset:2048 sc1 lds
v_rcp_f32 v94,v94
v_mfma_f32_16x16x32_bf16 v[76:79],a[188:191],v[252:255],v[76:79]
ds_read_b128 v[248:251],v17 offset:46080
v_rcp_f32 v95,v95
s_waitcnt lgkmcnt(5)
v_mfma_f32_16x16x32_bf16 v[68:71],a[64:67],v[224:227],v[68:71]
s_xor_b32 m0,s72,33792
s_add_u32 s65,s89,65536
v_mul_f32 v92,v92,v72
v_mul_f32 v93,v93,v73
v_mfma_f32_16x16x32_bf16 v[76:79],a[192:195],v[224:227],v[76:79]
ds_read_b128 v[252:255],v17 offset:48128
v_min3_u32 v27,v27,v224,v228
v_mfma_f32_16x16x32_bf16 v[68:71],a[68:71],v[228:231],v[68:71]
buffer_load_dwordx4 v16,s[20:23],s65 offen offset:0 sc1 lds
v_mfma_f32_16x16x32_bf16 v[76:79],a[196:199],v[228:231],v[76:79]
ds_read_b128 v[224:227],v17 offset:50176
s_waitcnt lgkmcnt(5)
v_mfma_f32_16x16x32_bf16 v[68:71],a[72:75],v[232:235],v[68:71]
buffer_load_dwordx4 v16,s[20:23],s65 offen offset:2048 sc1 lds
v_mfma_f32_16x16x32_bf16 v[76:79],a[200:203],v[232:235],v[76:79]
ds_read_b128 v[228:231],v17 offset:52224
s_xor_b32 m0,s72,50176
v_mfma_f32_16x16x32_bf16 v[68:71],a[76:79],v[236:239],v[68:71]
s_add_u32 s65,s89,98304
v_min3_u32 v27,v27,v232,v236
v_mfma_f32_16x16x32_bf16 v[76:79],a[204:207],v[236:239],v[76:79]
ds_read_b128 v[232:235],v17 offset:54272
s_waitcnt lgkmcnt(5)
v_mfma_f32_16x16x32_bf16 v[68:71],a[80:83],v[240:243],v[68:71]
buffer_load_dwordx4 v16,s[20:23],s65 offen offset:0 sc1 lds
v_mfma_f32_16x16x32_bf16 v[76:79],a[208:211],v[240:243],v[76:79]
ds_read_b128 v[236:239],v17 offset:56320
v_min3_u32 v27,v27,v240,v244
v_mfma_f32_16x16x32_bf16 v[68:71],a[84:87],v[244:247],v[68:71]
buffer_load_dwordx4 v16,s[20:23],s65 offen offset:2048 sc1 lds
v_mfma_f32_16x16x32_bf16 v[76:79],a[212:215],v[244:247],v[76:79]
ds_read_b128 v[240:243],v17 offset:58368
s_waitcnt lgkmcnt(5)
v_mfma_f32_16x16x32_bf16 v[68:71],a[88:91],v[248:251],v[68:71]
v_min3_u32 v27,v27,v248,v252
v_exp_f32 v88,v88
v_mfma_f32_16x16x32_bf16 v[76:79],a[216:219],v[248:251],v[76:79]
ds_read_b128 v[244:247],v17 offset:60416
v_exp_f32 v89,v89
v_mfma_f32_16x16x32_bf16 v[68:71],a[92:95],v[252:255],v[68:71]
v_exp_f32 v90,v90
v_mfma_f32_16x16x32_bf16 v[76:79],a[220:223],v[252:255],v[76:79]
ds_read_b128 v[248:251],v17 offset:62464
s_waitcnt lgkmcnt(5)
v_mfma_f32_16x16x32_bf16 v[68:71],a[96:99],v[224:227],v[68:71]
v_min3_u32 v27,v27,v224,v228
v_exp_f32 v91,v91
v_mfma_f32_16x16x32_bf16 v[76:79],a[224:227],v[224:227],v[76:79]
ds_read_b128 v[252:255],v17 offset:64512
v_fma_f32 v88,v88,v123,v123
v_fma_f32 v89,v89,v123,v123
v_mfma_f32_16x16x32_bf16 v[68:71],a[100:103],v[228:231],v[68:71]
v_fma_f32 v90,v90,v123,v123
v_fma_f32 v91,v91,v123,v123
v_mfma_f32_16x16x32_bf16 v[76:79],a[228:231],v[228:231],v[76:79]
v_rcp_f32 v88,v88
s_waitcnt lgkmcnt(4)
v_mfma_f32_16x16x32_bf16 v[68:71],a[104:107],v[232:235],v[68:71]
v_min3_u32 v27,v27,v232,v236
v_rcp_f32 v89,v89
v_mfma_f32_16x16x32_bf16 v[76:79],a[232:235],v[232:235],v[76:79]
v_rcp_f32 v90,v90
v_mfma_f32_16x16x32_bf16 v[68:71],a[108:111],v[236:239],v[68:71]
v_rcp_f32 v91,v91
v_mfma_f32_16x16x32_bf16 v[76:79],a[236:239],v[236:239],v[76:79]
v_mul_f32 v88,v88,v64
s_waitcnt lgkmcnt(2)
v_mfma_f32_16x16x32_bf16 v[68:71],a[112:115],v[240:243],v[68:71]
v_min3_u32 v27,v27,v240,v244
v_mul_f32 v89,v89,v65
v_mfma_f32_16x16x32_bf16 v[76:79],a[240:243],v[240:243],v[76:79]
v_mul_f32 v90,v90,v66
v_mul_f32 v91,v91,v67
v_mfma_f32_16x16x32_bf16 v[68:71],a[116:119],v[244:247],v[68:71]
v_mul_f32 v94,v94,v74
v_mul_f32 v95,v95,v75
v_mfma_f32_16x16x32_bf16 v[76:79],a[244:247],v[244:247],v[76:79]
v_cvt_pk_bf16_f32 v96,v88,v89
s_waitcnt lgkmcnt(0)
v_mfma_f32_16x16x32_bf16 v[68:71],a[120:123],v[248:251],v[68:71]
v_min3_u32 v27,v27,v248,v252
v_cvt_pk_bf16_f32 v97,v90,v91
v_mfma_f32_16x16x32_bf16 v[76:79],a[248:251],v[248:251],v[76:79]
v_cvt_pk_bf16_f32 v98,v92,v93
v_cvt_pk_bf16_f32 v99,v94,v95
v_mfma_f32_16x16x32_bf16 v[68:71],a[124:127],v[252:255],v[68:71]
v_max_u32 v96,1,v96
v_mfma_f32_16x16x32_bf16 v[76:79],a[252:255],v[252:255],v[76:79]
buffer_store_dwordx4 v[96:99],v18,s[20:23],s70 offen offset:0 sc1
v_cmp_eq_u32 vcc,0,v27
s_cbranch_vccnz retry_377
s_branch epi_380
ahead_379:
s_cmp_eq_u32 s93,0
s_cbranch_scc1 both_381
s_waitcnt vmcnt(12) lgkmcnt(0)
s_barrier
ds_read_b128 v[224:227],v17 offset:0
ds_read_b128 v[228:231],v17 offset:2048
ds_read_b128 v[232:235],v17 offset:4096
ds_read_b128 v[236:239],v17 offset:6144
ds_read_b128 v[240:243],v17 offset:8192
ds_read_b128 v[244:247],v17 offset:10240
ds_read_b128 v[248:251],v17 offset:12288
s_waitcnt lgkmcnt(5)
v_mfma_f32_16x16x32_bf16 v[64:67],a[0:3],v[224:227],0
s_add_u32 s96,s71,1
s_add_u32 s92,s71,2
v_mfma_f32_16x16x32_bf16 v[72:75],a[128:131],v[224:227],0
ds_read_b128 v[252:255],v17 offset:14336
v_min_u32 v27,v224,v228
v_mfma_f32_16x16x32_bf16 v[64:67],a[4:7],v[228:231],v[64:67]
s_cmp_eq_u32 s96,64
s_cselect_b32 s96,99,s96
v_mfma_f32_16x16x32_bf16 v[72:75],a[132:135],v[228:231],v[72:75]
ds_read_b128 v[224:227],v17 offset:16384
s_waitcnt lgkmcnt(5)
v_mfma_f32_16x16x32_bf16 v[64:67],a[8:11],v[232:235],v[64:67]
s_cmp_eq_u32 s92,64
s_cselect_b32 s92,99,s92
v_mfma_f32_16x16x32_bf16 v[72:75],a[136:139],v[232:235],v[72:75]
ds_read_b128 v[228:231],v17 offset:18432
v_min3_u32 v27,v27,v232,v236
v_mfma_f32_16x16x32_bf16 v[64:67],a[12:15],v[236:239],v[64:67]
v_mfma_f32_16x16x32_bf16 v[72:75],a[140:143],v[236:239],v[72:75]
ds_read_b128 v[232:235],v17 offset:20480
s_waitcnt lgkmcnt(5)
v_mfma_f32_16x16x32_bf16 v[64:67],a[16:19],v[240:243],v[64:67]
v_min3_u32 v27,v27,v240,v244
v_mfma_f32_16x16x32_bf16 v[72:75],a[144:147],v[240:243],v[72:75]
ds_read_b128 v[236:239],v17 offset:22528
v_mfma_f32_16x16x32_bf16 v[64:67],a[20:23],v[244:247],v[64:67]
v_mfma_f32_16x16x32_bf16 v[72:75],a[148:151],v[244:247],v[72:75]
ds_read_b128 v[240:243],v17 offset:24576
s_waitcnt lgkmcnt(5)
v_mfma_f32_16x16x32_bf16 v[64:67],a[24:27],v[248:251],v[64:67]
v_min3_u32 v27,v27,v248,v252
v_mfma_f32_16x16x32_bf16 v[72:75],a[152:155],v[248:251],v[72:75]
ds_read_b128 v[244:247],v17 offset:26624
v_mfma_f32_16x16x32_bf16 v[64:67],a[28:31],v[252:255],v[64:67]
v_mfma_f32_16x16x32_bf16 v[72:75],a[156:159],v[252:255],v[72:75]
ds_read_b128 v[248:251],v17 offset:28672
s_waitcnt lgkmcnt(5)
v_mfma_f32_16x16x32_bf16 v[64:67],a[32:35],v[224:227],v[64:67]
v_min3_u32 v27,v27,v224,v228
v_mfma_f32_16x16x32_bf16 v[72:75],a[160:163],v[224:227],v[72:75]
ds_read_b128 v[252:255],v17 offset:30720
v_mfma_f32_16x16x32_bf16 v[64:67],a[36:39],v[228:231],v[64:67]
v_mfma_f32_16x16x32_bf16 v[72:75],a[164:167],v[228:231],v[72:75]
ds_read_b128 v[224:227],v17 offset:32768
s_waitcnt lgkmcnt(5)
v_mfma_f32_16x16x32_bf16 v[64:67],a[40:43],v[232:235],v[64:67]
v_min3_u32 v27,v27,v232,v236
v_mfma_f32_16x16x32_bf16 v[72:75],a[168:171],v[232:235],v[72:75]
ds_read_b128 v[228:231],v17 offset:34816
v_mfma_f32_16x16x32_bf16 v[64:67],a[44:47],v[236:239],v[64:67]
v_mfma_f32_16x16x32_bf16 v[72:75],a[172:175],v[236:239],v[72:75]
ds_read_b128 v[232:235],v17 offset:36864
s_waitcnt lgkmcnt(5)
v_mfma_f32_16x16x32_bf16 v[64:67],a[48:51],v[240:243],v[64:67]
v_min3_u32 v27,v27,v240,v244
v_mfma_f32_16x16x32_bf16 v[72:75],a[176:179],v[240:243],v[72:75]
ds_read_b128 v[236:239],v17 offset:38912
v_mfma_f32_16x16x32_bf16 v[64:67],a[52:55],v[244:247],v[64:67]
v_mfma_f32_16x16x32_bf16 v[72:75],a[180:183],v[244:247],v[72:75]
ds_read_b128 v[240:243],v17 offset:40960
s_waitcnt lgkmcnt(5)
v_mfma_f32_16x16x32_bf16 v[64:67],a[56:59],v[248:251],v[64:67]
v_min3_u32 v27,v27,v248,v252
v_mfma_f32_16x16x32_bf16 v[72:75],a[184:187],v[248:251],v[72:75]
ds_read_b128 v[244:247],v17 offset:43008
s_waitcnt vmcnt(2)
v_mfma_f32_16x16x32_bf16 v[64:67],a[60:63],v[252:255],v[64:67]
v_cmp_gt_u32 vcc,s96,v29
v_cmp_gt_u32 s[92:93],s92,v29
v_mfma_f32_16x16x32_bf16 v[72:75],a[188:191],v[252:255],v[72:75]
ds_read_b128 v[248:251],v17 offset:45056
s_waitcnt lgkmcnt(5)
v_mfma_f32_16x16x32_bf16 v[64:67],a[64:67],v[224:227],v[64:67]
v_mov_b32 v44,vcc_lo
v_mov_b32 v45,s92
v_mfma_f32_16x16x32_bf16 v[72:75],a[192:195],v[224:227],v[72:75]
ds_read_b128 v[252:255],v17 offset:47104
ds_write_b64 v46,v[44:45]
v_mfma_f32_16x16x32_bf16 v[64:67],a[68:71],v[228:231],v[64:67]
v_min3_u32 v27,v27,v224,v228
v_mfma_f32_16x16x32_bf16 v[72:75],a[196:199],v[228:231],v[72:75]
ds_read_b128 v[224:227],v17 offset:49152
s_waitcnt lgkmcnt(6)
v_mfma_f32_16x16x32_bf16 v[64:67],a[72:75],v[232:235],v[64:67]
v_min3_u32 v27,v27,v232,v236
v_mfma_f32_16x16x32_bf16 v[72:75],a[200:203],v[232:235],v[72:75]
ds_read_b128 v[228:231],v17 offset:51200
v_mfma_f32_16x16x32_bf16 v[64:67],a[76:79],v[236:239],v[64:67]
v_mfma_f32_16x16x32_bf16 v[72:75],a[204:207],v[236:239],v[72:75]
ds_read_b128 v[232:235],v17 offset:53248
s_waitcnt lgkmcnt(6)
v_mfma_f32_16x16x32_bf16 v[64:67],a[80:83],v[240:243],v[64:67]
v_min3_u32 v27,v27,v240,v244
s_add_u32 s88,s70,s75
v_mfma_f32_16x16x32_bf16 v[72:75],a[208:211],v[240:243],v[72:75]
ds_read_b128 v[236:239],v17 offset:55296
s_add_u32 s88,s88,2097152
v_mfma_f32_16x16x32_bf16 v[64:67],a[84:87],v[244:247],v[64:67]
s_xor_b32 s88,s88,0x2000
s_xor_b32 s89,s88,1024
v_mfma_f32_16x16x32_bf16 v[72:75],a[212:215],v[244:247],v[72:75]
ds_read_b128 v[240:243],v17 offset:57344
s_waitcnt lgkmcnt(6)
v_mfma_f32_16x16x32_bf16 v[64:67],a[88:91],v[248:251],v[64:67]
v_min3_u32 v27,v27,v248,v252
v_mfma_f32_16x16x32_bf16 v[72:75],a[216:219],v[248:251],v[72:75]
ds_read_b128 v[244:247],v17 offset:59392
v_mfma_f32_16x16x32_bf16 v[64:67],a[92:95],v[252:255],v[64:67]
v_mfma_f32_16x16x32_bf16 v[72:75],a[220:223],v[252:255],v[72:75]
ds_read_b128 v[248:251],v17 offset:61440
s_waitcnt lgkmcnt(5)
v_mfma_f32_16x16x32_bf16 v[64:67],a[96:99],v[224:227],v[64:67]
v_min3_u32 v27,v27,v224,v228
v_mfma_f32_16x16x32_bf16 v[72:75],a[224:227],v[224:227],v[72:75]
ds_read_b128 v[252:255],v17 offset:63488
v_mfma_f32_16x16x32_bf16 v[64:67],a[100:103],v[228:231],v[64:67]
s_waitcnt vmcnt(0)
v_add_u32 v22,s71,-1
v_mfma_f32_16x16x32_bf16 v[72:75],a[228:231],v[228:231],v[72:75]
s_waitcnt vmcnt(4)
s_barrier
ds_read_b64 v[44:45],v47
ds_read_b128 v[224:227],v17 offset:1024
s_waitcnt lgkmcnt(6)
v_mfma_f32_16x16x32_bf16 v[64:67],a[104:107],v[232:235],v[64:67]
v_min3_u32 v27,v27,v232,v236
ds_read_b128 v[124:127],v19 offset:256
v_mfma_f32_16x16x32_bf16 v[72:75],a[232:235],v[232:235],v[72:75]
ds_read_b128 v[228:231],v17 offset:3072
ds_read_b128 v[120:123],v19 offset:0
v_mfma_f32_16x16x32_bf16 v[64:67],a[108:111],v[236:239],v[64:67]
buffer_store_dword v22,v23,s[20:23],s97 offen sc1
v_mfma_f32_16x16x32_bf16 v[72:75],a[236:239],v[236:239],v[72:75]
ds_read_b128 v[232:235],v17 offset:5120
s_waitcnt lgkmcnt(8)
v_mfma_f32_16x16x32_bf16 v[64:67],a[112:115],v[240:243],v[64:67]
v_min3_u32 v27,v27,v240,v244
s_mov_b32 s97,0x7fff0000
v_mfma_f32_16x16x32_bf16 v[72:75],a[240:243],v[240:243],v[72:75]
ds_read_b128 v[236:239],v17 offset:7168
v_mfma_f32_16x16x32_bf16 v[64:67],a[116:119],v[244:247],v[64:67]
v_mfma_f32_16x16x32_bf16 v[72:75],a[244:247],v[244:247],v[72:75]
ds_read_b128 v[240:243],v17 offset:9216
s_waitcnt lgkmcnt(8)
v_mfma_f32_16x16x32_bf16 v[64:67],a[120:123],v[248:251],v[64:67]
s_waitcnt lgkmcnt(7)
v_readfirstlane_b32 s93,v45
v_mfma_f32_16x16x32_bf16 v[72:75],a[248:251],v[248:251],v[72:75]
ds_read_b128 v[244:247],v17 offset:11264
v_readfirstlane_b32 s83,v44
s_cmp_lg_u32 s83,0
s_cbranch_scc1 keep_389
v_mfma_f32_16x16x32_bf16 v[64:67],a[124:127],v[252:255],v[64:67]
v_min3_u32 v27,v27,v248,v252
s_xor_b32 m0,s72,0
v_mfma_f32_16x16x32_bf16 v[72:75],a[252:255],v[252:255],v[72:75]
ds_read_b128 v[248:251],v17 offset:13312
s_add_u32 s65,s88,0
s_waitcnt lgkmcnt(6)
v_mfma_f32_16x16x32_bf16 v[68:71],a[0:3],v[224:227],0
buffer_load_dwordx4 v16,s[20:23],s65 offen offset:0 sc1 lds
v_min3_u32 v27,v27,v224,v228
v_mfma_f32_16x16x32_bf16 v[76:79],a[128:131],v[224:227],0
ds_read_b128 v[252:255],v17 offset:15360
buffer_load_dwordx4 v16,s[20:23],s65 offen offset:2048 sc1 lds
v_mfma_f32_16x16x32_bf16 v[68:71],a[4:7],v[228:231],v[68:71]
v_cmp_eq_u32 vcc,0,v27
s_cbranch_vccnz retry_377
s_waitcnt lgkmcnt(6)
v_mfma_f32_16x16x32_bf16 v[76:79],a[132:135],v[228:231],v[76:79]
ds_read_b128 v[224:227],v17 offset:17408
s_xor_b32 m0,s72,16384
s_waitcnt lgkmcnt(5)
v_mfma_f32_16x16x32_bf16 v[68:71],a[8:11],v[232:235],v[68:71]
s_add_u32 s65,s88,32768
v_min3_u32 v27,v27,v232,v236
v_fmac_f32 v64,v52,v120
v_fmac_f32 v72,v56,v120
v_mfma_f32_16x16x32_bf16 v[76:79],a[136:139],v[232:235],v[76:79]
ds_read_b128 v[228:231],v17 offset:19456
buffer_load_dwordx4 v16,s[20:23],s65 offen offset:0 sc1 lds
v_fmac_f32 v73,v57,v120
v_mfma_f32_16x16x32_bf16 v[68:71],a[12:15],v[236:239],v[68:71]
v_fmac_f32 v65,v53,v120
v_fmac_f32 v66,v54,v120
v_fmac_f32 v67,v55,v120
v_fmac_f32 v74,v58,v120
v_mfma_f32_16x16x32_bf16 v[76:79],a[140:143],v[236:239],v[76:79]
ds_read_b128 v[232:235],v17 offset:21504
v_mul_f32 v88,v64,v64
v_fmac_f32 v75,v59,v120
s_waitcnt lgkmcnt(5)
v_mfma_f32_16x16x32_bf16 v[68:71],a[16:19],v[240:243],v[68:71]
buffer_load_dwordx4 v16,s[20:23],s65 offen offset:2048 sc1 lds
s_xor_b32 m0,s72,32768
v_mul_f32 v92,v72,v72
v_mfma_f32_16x16x32_bf16 v[76:79],a[144:147],v[240:243],v[76:79]
ds_read_b128 v[236:239],v17 offset:23552
s_add_u32 s65,s88,65536
v_mul_f32 v89,v65,v65
v_mul_f32 v93,v73,v73
v_mfma_f32_16x16x32_bf16 v[68:71],a[20:23],v[244:247],v[68:71]
v_min3_u32 v27,v27,v240,v244
v_mul_f32 v90,v66,v66
v_mul_f32 v91,v67,v67
v_mul_f32 v94,v74,v74
v_mfma_f32_16x16x32_bf16 v[76:79],a[148:151],v[244:247],v[76:79]
ds_read_b128 v[240:243],v17 offset:25600
v_fma_f32 v88,v88,v121,v122
v_mul_f32 v95,v75,v75
s_waitcnt lgkmcnt(5)
v_mfma_f32_16x16x32_bf16 v[68:71],a[24:27],v[248:251],v[68:71]
buffer_load_dwordx4 v16,s[20:23],s65 offen offset:0 sc1 lds
v_fma_f32 v89,v89,v121,v122
v_fma_f32 v92,v92,v121,v122
v_mfma_f32_16x16x32_bf16 v[76:79],a[152:155],v[248:251],v[76:79]
ds_read_b128 v[244:247],v17 offset:27648
buffer_load_dwordx4 v16,s[20:23],s65 offen offset:2048 sc1 lds
v_fma_f32 v93,v93,v121,v122
v_mfma_f32_16x16x32_bf16 v[68:71],a[28:31],v[252:255],v[68:71]
s_xor_b32 m0,s72,49152
v_min3_u32 v27,v27,v248,v252
v_fma_f32 v90,v90,v121,v122
v_fma_f32 v94,v94,v121,v122
v_mfma_f32_16x16x32_bf16 v[76:79],a[156:159],v[252:255],v[76:79]
ds_read_b128 v[248:251],v17 offset:29696
s_add_u32 s65,s88,98304
v_fma_f32 v95,v95,v121,v122
s_waitcnt lgkmcnt(5)
v_mfma_f32_16x16x32_bf16 v[68:71],a[32:35],v[224:227],v[68:71]
buffer_load_dwordx4 v16,s[20:23],s65 offen offset:0 sc1 lds
v_fma_f32 v91,v91,v121,v122
v_mul_f32 v92,v92,v72
v_mfma_f32_16x16x32_bf16 v[76:79],a[160:163],v[224:227],v[76:79]
ds_read_b128 v[252:255],v17 offset:31744
v_min3_u32 v27,v27,v224,v228
v_mul_f32 v88,v88,v64
v_mul_f32 v93,v93,v73
v_mfma_f32_16x16x32_bf16 v[68:71],a[36:39],v[228:231],v[68:71]
buffer_load_dwordx4 v16,s[20:23],s65 offen offset:2048 sc1 lds
v_mul_f32 v89,v89,v65
v_mul_f32 v94,v94,v74
v_mfma_f32_16x16x32_bf16 v[76:79],a[164:167],v[228:231],v[76:79]
ds_read_b128 v[224:227],v17 offset:33792
v_mul_f32 v90,v90,v66
v_mul_f32 v95,v95,v75
s_waitcnt lgkmcnt(5)
v_mfma_f32_16x16x32_bf16 v[68:71],a[40:43],v[232:235],v[68:71]
s_xor_b32 m0,s72,1024
s_add_u32 s65,s89,0
v_mul_f32 v91,v91,v67
v_mfma_f32_16x16x32_bf16 v[76:79],a[168:171],v[232:235],v[76:79]
ds_read_b128 v[228:231],v17 offset:35840
v_min3_u32 v27,v27,v232,v236
v_exp_f32 v92,v92
v_mfma_f32_16x16x32_bf16 v[68:71],a[44:47],v[236:239],v[68:71]
buffer_load_dwordx4 v16,s[20:23],s65 offen offset:0 sc1 lds
v_exp_f32 v93,v93
v_mfma_f32_16x16x32_bf16 v[76:79],a[172:175],v[236:239],v[76:79]
ds_read_b128 v[232:235],v17 offset:37888
v_exp_f32 v94,v94
s_waitcnt lgkmcnt(5)
v_mfma_f32_16x16x32_bf16 v[68:71],a[48:51],v[240:243],v[68:71]
buffer_load_dwordx4 v16,s[20:23],s65 offen offset:2048 sc1 lds
v_exp_f32 v95,v95
v_mfma_f32_16x16x32_bf16 v[76:79],a[176:179],v[240:243],v[76:79]
ds_read_b128 v[236:239],v17 offset:39936
s_xor_b32 m0,s72,17408
v_fma_f32 v92,v92,v123,v123
v_fma_f32 v93,v93,v123,v123
v_mfma_f32_16x16x32_bf16 v[68:71],a[52:55],v[244:247],v[68:71]
s_add_u32 s65,s89,32768
v_min3_u32 v27,v27,v240,v244
v_fma_f32 v94,v94,v123,v123
v_fma_f32 v95,v95,v123,v123
v_mfma_f32_16x16x32_bf16 v[76:79],a[180:183],v[244:247],v[76:79]
ds_read_b128 v[240:243],v17 offset:41984
v_rcp_f32 v92,v92
s_waitcnt lgkmcnt(5)
v_mfma_f32_16x16x32_bf16 v[68:71],a[56:59],v[248:251],v[68:71]
buffer_load_dwordx4 v16,s[20:23],s65 offen offset:0 sc1 lds
v_rcp_f32 v93,v93
v_mfma_f32_16x16x32_bf16 v[76:79],a[184:187],v[248:251],v[76:79]
ds_read_b128 v[244:247],v17 offset:44032
v_min3_u32 v27,v27,v248,v252
v_rcp_f32 v94,v94
v_mfma_f32_16x16x32_bf16 v[68:71],a[60:63],v[252:255],v[68:71]
buffer_load_dwordx4 v16,s[20:23],s65 offen offset:2048 sc1 lds
v_rcp_f32 v95,v95
v_mfma_f32_16x16x32_bf16 v[76:79],a[188:191],v[252:255],v[76:79]
ds_read_b128 v[248:251],v17 offset:46080
v_mul_f32 v92,v92,v72
v_mul_f32 v93,v93,v73
s_waitcnt lgkmcnt(5)
v_mfma_f32_16x16x32_bf16 v[68:71],a[64:67],v[224:227],v[68:71]
s_xor_b32 m0,s72,33792
s_add_u32 s65,s89,65536
v_mfma_f32_16x16x32_bf16 v[76:79],a[192:195],v[224:227],v[76:79]
ds_read_b128 v[252:255],v17 offset:48128
v_min3_u32 v27,v27,v224,v228
v_mfma_f32_16x16x32_bf16 v[68:71],a[68:71],v[228:231],v[68:71]
buffer_load_dwordx4 v16,s[20:23],s65 offen offset:0 sc1 lds
v_mfma_f32_16x16x32_bf16 v[76:79],a[196:199],v[228:231],v[76:79]
ds_read_b128 v[224:227],v17 offset:50176
s_waitcnt lgkmcnt(5)
v_mfma_f32_16x16x32_bf16 v[68:71],a[72:75],v[232:235],v[68:71]
buffer_load_dwordx4 v16,s[20:23],s65 offen offset:2048 sc1 lds
v_mfma_f32_16x16x32_bf16 v[76:79],a[200:203],v[232:235],v[76:79]
ds_read_b128 v[228:231],v17 offset:52224
s_xor_b32 m0,s72,50176
v_mfma_f32_16x16x32_bf16 v[68:71],a[76:79],v[236:239],v[68:71]
s_add_u32 s65,s89,98304
v_min3_u32 v27,v27,v232,v236
v_mfma_f32_16x16x32_bf16 v[76:79],a[204:207],v[236:239],v[76:79]
ds_read_b128 v[232:235],v17 offset:54272
s_waitcnt lgkmcnt(5)
v_mfma_f32_16x16x32_bf16 v[68:71],a[80:83],v[240:243],v[68:71]
buffer_load_dwordx4 v16,s[20:23],s65 offen offset:0 sc1 lds
v_mfma_f32_16x16x32_bf16 v[76:79],a[208:211],v[240:243],v[76:79]
ds_read_b128 v[236:239],v17 offset:56320
v_min3_u32 v27,v27,v240,v244
v_mfma_f32_16x16x32_bf16 v[68:71],a[84:87],v[244:247],v[68:71]
buffer_load_dwordx4 v16,s[20:23],s65 offen offset:2048 sc1 lds
v_mfma_f32_16x16x32_bf16 v[76:79],a[212:215],v[244:247],v[76:79]
ds_read_b128 v[240:243],v17 offset:58368
s_waitcnt lgkmcnt(5)
v_mfma_f32_16x16x32_bf16 v[68:71],a[88:91],v[248:251],v[68:71]
v_min3_u32 v27,v27,v248,v252
v_exp_f32 v88,v88
v_mfma_f32_16x16x32_bf16 v[76:79],a[216:219],v[248:251],v[76:79]
ds_read_b128 v[244:247],v17 offset:60416
v_exp_f32 v89,v89
v_mfma_f32_16x16x32_bf16 v[68:71],a[92:95],v[252:255],v[68:71]
v_exp_f32 v90,v90
v_mfma_f32_16x16x32_bf16 v[76:79],a[220:223],v[252:255],v[76:79]
ds_read_b128 v[248:251],v17 offset:62464
s_waitcnt lgkmcnt(5)
v_mfma_f32_16x16x32_bf16 v[68:71],a[96:99],v[224:227],v[68:71]
v_min3_u32 v27,v27,v224,v228
v_exp_f32 v91,v91
v_mfma_f32_16x16x32_bf16 v[76:79],a[224:227],v[224:227],v[76:79]
ds_read_b128 v[252:255],v17 offset:64512
v_fma_f32 v88,v88,v123,v123
v_fma_f32 v89,v89,v123,v123
v_mfma_f32_16x16x32_bf16 v[68:71],a[100:103],v[228:231],v[68:71]
v_fma_f32 v90,v90,v123,v123
v_fma_f32 v91,v91,v123,v123
v_mfma_f32_16x16x32_bf16 v[76:79],a[228:231],v[228:231],v[76:79]
v_rcp_f32 v88,v88
s_waitcnt lgkmcnt(4)
v_mfma_f32_16x16x32_bf16 v[68:71],a[104:107],v[232:235],v[68:71]
v_min3_u32 v27,v27,v232,v236
v_rcp_f32 v89,v89
v_mfma_f32_16x16x32_bf16 v[76:79],a[232:235],v[232:235],v[76:79]
v_rcp_f32 v90,v90
v_mfma_f32_16x16x32_bf16 v[68:71],a[108:111],v[236:239],v[68:71]
v_rcp_f32 v91,v91
v_mfma_f32_16x16x32_bf16 v[76:79],a[236:239],v[236:239],v[76:79]
v_mul_f32 v88,v88,v64
s_waitcnt lgkmcnt(2)
v_mfma_f32_16x16x32_bf16 v[68:71],a[112:115],v[240:243],v[68:71]
v_min3_u32 v27,v27,v240,v244
v_mul_f32 v89,v89,v65
v_mfma_f32_16x16x32_bf16 v[76:79],a[240:243],v[240:243],v[76:79]
v_mul_f32 v90,v90,v66
v_mul_f32 v91,v91,v67
v_mfma_f32_16x16x32_bf16 v[68:71],a[116:119],v[244:247],v[68:71]
v_mul_f32 v94,v94,v74
v_mul_f32 v95,v95,v75
v_mfma_f32_16x16x32_bf16 v[76:79],a[244:247],v[244:247],v[76:79]
v_cvt_pk_bf16_f32 v96,v88,v89
s_waitcnt lgkmcnt(0)
v_mfma_f32_16x16x32_bf16 v[68:71],a[120:123],v[248:251],v[68:71]
v_min3_u32 v27,v27,v248,v252
v_cvt_pk_bf16_f32 v97,v90,v91
v_mfma_f32_16x16x32_bf16 v[76:79],a[248:251],v[248:251],v[76:79]
v_cvt_pk_bf16_f32 v98,v92,v93
v_cvt_pk_bf16_f32 v99,v94,v95
v_mfma_f32_16x16x32_bf16 v[68:71],a[124:127],v[252:255],v[68:71]
v_max_u32 v96,1,v96
v_mfma_f32_16x16x32_bf16 v[76:79],a[252:255],v[252:255],v[76:79]
buffer_store_dwordx4 v[96:99],v18,s[20:23],s70 offen offset:0 sc1
v_cmp_eq_u32 vcc,0,v27
s_cbranch_vccnz retry_377
s_branch epi_380
keep_389:
v_mfma_f32_16x16x32_bf16 v[64:67],a[124:127],v[252:255],v[64:67]
v_min3_u32 v27,v27,v248,v252
v_mfma_f32_16x16x32_bf16 v[72:75],a[252:255],v[252:255],v[72:75]
ds_read_b128 v[248:251],v17 offset:13312
s_waitcnt lgkmcnt(6)
v_mfma_f32_16x16x32_bf16 v[68:71],a[0:3],v[224:227],0
v_cmp_eq_u32 vcc,0,v27
s_cbranch_vccnz retry_377
v_mfma_f32_16x16x32_bf16 v[76:79],a[128:131],v[224:227],0
ds_read_b128 v[252:255],v17 offset:15360
v_min3_u32 v27,v27,v224,v228
v_mfma_f32_16x16x32_bf16 v[68:71],a[4:7],v[228:231],v[68:71]
s_waitcnt lgkmcnt(6)
v_mfma_f32_16x16x32_bf16 v[76:79],a[132:135],v[228:231],v[76:79]
ds_read_b128 v[224:227],v17 offset:17408
s_waitcnt lgkmcnt(5)
v_mfma_f32_16x16x32_bf16 v[68:71],a[8:11],v[232:235],v[68:71]
v_min3_u32 v27,v27,v232,v236
v_fmac_f32 v64,v52,v120
v_fmac_f32 v72,v56,v120
v_mfma_f32_16x16x32_bf16 v[76:79],a[136:139],v[232:235],v[76:79]
ds_read_b128 v[228:231],v17 offset:19456
v_fmac_f32 v65,v53,v120
v_fmac_f32 v73,v57,v120
v_mfma_f32_16x16x32_bf16 v[68:71],a[12:15],v[236:239],v[68:71]
v_fmac_f32 v66,v54,v120
v_fmac_f32 v67,v55,v120
v_fmac_f32 v74,v58,v120
v_mfma_f32_16x16x32_bf16 v[76:79],a[140:143],v[236:239],v[76:79]
ds_read_b128 v[232:235],v17 offset:21504
v_fmac_f32 v75,v59,v120
s_waitcnt lgkmcnt(5)
v_mfma_f32_16x16x32_bf16 v[68:71],a[16:19],v[240:243],v[68:71]
v_min3_u32 v27,v27,v240,v244
v_mul_f32 v88,v64,v64
v_mul_f32 v92,v72,v72
v_mfma_f32_16x16x32_bf16 v[76:79],a[144:147],v[240:243],v[76:79]
ds_read_b128 v[236:239],v17 offset:23552
v_mul_f32 v89,v65,v65
v_mul_f32 v93,v73,v73
v_mfma_f32_16x16x32_bf16 v[68:71],a[20:23],v[244:247],v[68:71]
v_mul_f32 v90,v66,v66
v_mul_f32 v91,v67,v67
v_mul_f32 v94,v74,v74
v_mfma_f32_16x16x32_bf16 v[76:79],a[148:151],v[244:247],v[76:79]
ds_read_b128 v[240:243],v17 offset:25600
v_mul_f32 v95,v75,v75
s_waitcnt lgkmcnt(5)
v_mfma_f32_16x16x32_bf16 v[68:71],a[24:27],v[248:251],v[68:71]
v_min3_u32 v27,v27,v248,v252
v_fma_f32 v88,v88,v121,v122
v_fma_f32 v92,v92,v121,v122
v_mfma_f32_16x16x32_bf16 v[76:79],a[152:155],v[248:251],v[76:79]
ds_read_b128 v[244:247],v17 offset:27648
v_fma_f32 v89,v89,v121,v122
v_fma_f32 v93,v93,v121,v122
v_mfma_f32_16x16x32_bf16 v[68:71],a[28:31],v[252:255],v[68:71]
v_fma_f32 v90,v90,v121,v122
v_fma_f32 v91,v91,v121,v122
v_fma_f32 v94,v94,v121,v122
v_mfma_f32_16x16x32_bf16 v[76:79],a[156:159],v[252:255],v[76:79]
ds_read_b128 v[248:251],v17 offset:29696
v_fma_f32 v95,v95,v121,v122
s_waitcnt lgkmcnt(5)
v_mfma_f32_16x16x32_bf16 v[68:71],a[32:35],v[224:227],v[68:71]
v_min3_u32 v27,v27,v224,v228
v_mul_f32 v88,v88,v64
v_mul_f32 v92,v92,v72
v_mfma_f32_16x16x32_bf16 v[76:79],a[160:163],v[224:227],v[76:79]
ds_read_b128 v[252:255],v17 offset:31744
v_mul_f32 v89,v89,v65
v_mul_f32 v93,v93,v73
v_mfma_f32_16x16x32_bf16 v[68:71],a[36:39],v[228:231],v[68:71]
v_mul_f32 v90,v90,v66
v_mul_f32 v91,v91,v67
v_mul_f32 v94,v94,v74
v_mfma_f32_16x16x32_bf16 v[76:79],a[164:167],v[228:231],v[76:79]
ds_read_b128 v[224:227],v17 offset:33792
v_mul_f32 v95,v95,v75
s_waitcnt lgkmcnt(5)
v_mfma_f32_16x16x32_bf16 v[68:71],a[40:43],v[232:235],v[68:71]
v_min3_u32 v27,v27,v232,v236
v_exp_f32 v92,v92
v_mfma_f32_16x16x32_bf16 v[76:79],a[168:171],v[232:235],v[76:79]
ds_read_b128 v[228:231],v17 offset:35840
v_exp_f32 v93,v93
v_mfma_f32_16x16x32_bf16 v[68:71],a[44:47],v[236:239],v[68:71]
v_exp_f32 v88,v88
v_mfma_f32_16x16x32_bf16 v[76:79],a[172:175],v[236:239],v[76:79]
ds_read_b128 v[232:235],v17 offset:37888
s_waitcnt lgkmcnt(5)
v_mfma_f32_16x16x32_bf16 v[68:71],a[48:51],v[240:243],v[68:71]
v_min3_u32 v27,v27,v240,v244
v_exp_f32 v94,v94
v_mfma_f32_16x16x32_bf16 v[76:79],a[176:179],v[240:243],v[76:79]
ds_read_b128 v[236:239],v17 offset:39936
v_exp_f32 v95,v95
v_mfma_f32_16x16x32_bf16 v[68:71],a[52:55],v[244:247],v[68:71]
v_exp_f32 v89,v89
v_fma_f32 v92,v92,v123,v123
v_mfma_f32_16x16x32_bf16 v[76:79],a[180:183],v[244:247],v[76:79]
ds_read_b128 v[240:243],v17 offset:41984
v_fma_f32 v93,v93,v123,v123
s_waitcnt lgkmcnt(5)
v_mfma_f32_16x16x32_bf16 v[68:71],a[56:59],v[248:251],v[68:71]
v_min3_u32 v27,v27,v248,v252
v_fma_f32 v94,v94,v123,v123
v_fma_f32 v95,v95,v123,v123
v_mfma_f32_16x16x32_bf16 v[76:79],a[184:187],v[248:251],v[76:79]
ds_read_b128 v[244:247],v17 offset:44032
v_rcp_f32 v92,v92
v_mfma_f32_16x16x32_bf16 v[68:71],a[60:63],v[252:255],v[68:71]
v_exp_f32 v90,v90
v_mfma_f32_16x16x32_bf16 v[76:79],a[188:191],v[252:255],v[76:79]
ds_read_b128 v[248:251],v17 offset:46080
s_waitcnt lgkmcnt(5)
v_mfma_f32_16x16x32_bf16 v[68:71],a[64:67],v[224:227],v[68:71]
v_min3_u32 v27,v27,v224,v228
v_rcp_f32 v93,v93
v_mfma_f32_16x16x32_bf16 v[76:79],a[192:195],v[224:227],v[76:79]
ds_read_b128 v[252:255],v17 offset:48128
v_rcp_f32 v94,v94
v_mfma_f32_16x16x32_bf16 v[68:71],a[68:71],v[228:231],v[68:71]
v_exp_f32 v91,v91
v_mfma_f32_16x16x32_bf16 v[76:79],a[196:199],v[228:231],v[76:79]
ds_read_b128 v[224:227],v17 offset:50176
s_waitcnt lgkmcnt(5)
v_mfma_f32_16x16x32_bf16 v[68:71],a[72:75],v[232:235],v[68:71]
v_min3_u32 v27,v27,v232,v236
v_fma_f32 v88,v88,v123,v123
v_mfma_f32_16x16x32_bf16 v[76:79],a[200:203],v[232:235],v[76:79]
ds_read_b128 v[228:231],v17 offset:52224
v_fma_f32 v89,v89,v123,v123
v_mfma_f32_16x16x32_bf16 v[68:71],a[76:79],v[236:239],v[68:71]
v_fma_f32 v90,v90,v123,v123
v_fma_f32 v91,v91,v123,v123
v_mfma_f32_16x16x32_bf16 v[76:79],a[204:207],v[236:239],v[76:79]
ds_read_b128 v[232:235],v17 offset:54272
s_waitcnt lgkmcnt(5)
v_mfma_f32_16x16x32_bf16 v[68:71],a[80:83],v[240:243],v[68:71]
v_min3_u32 v27,v27,v240,v244
v_rcp_f32 v95,v95
v_mfma_f32_16x16x32_bf16 v[76:79],a[208:211],v[240:243],v[76:79]
ds_read_b128 v[236:239],v17 offset:56320
v_mul_f32 v92,v92,v72
v_mfma_f32_16x16x32_bf16 v[68:71],a[84:87],v[244:247],v[68:71]
v_rcp_f32 v88,v88
v_mfma_f32_16x16x32_bf16 v[76:79],a[212:215],v[244:247],v[76:79]
ds_read_b128 v[240:243],v17 offset:58368
s_waitcnt lgkmcnt(5)
v_mfma_f32_16x16x32_bf16 v[68:71],a[88:91],v[248:251],v[68:71]
v_min3_u32 v27,v27,v248,v252
v_mul_f32 v93,v93,v73
v_mfma_f32_16x16x32_bf16 v[76:79],a[216:219],v[248:251],v[76:79]
ds_read_b128 v[244:247],v17 offset:60416
v_mul_f32 v94,v94,v74
v_mfma_f32_16x16x32_bf16 v[68:71],a[92:95],v[252:255],v[68:71]
v_rcp_f32 v89,v89
v_mfma_f32_16x16x32_bf16 v[76:79],a[220:223],v[252:255],v[76:79]
ds_read_b128 v[248:251],v17 offset:62464
s_waitcnt lgkmcnt(5)
v_mfma_f32_16x16x32_bf16 v[68:71],a[96:99],v[224:227],v[68:71]
v_min3_u32 v27,v27,v224,v228
v_mul_f32 v95,v95,v75
v_mfma_f32_16x16x32_bf16 v[76:79],a[224:227],v[224:227],v[76:79]
ds_read_b128 v[252:255],v17 offset:64512
v_mfma_f32_16x16x32_bf16 v[68:71],a[100:103],v[228:231],v[68:71]
v_rcp_f32 v90,v90
v_mfma_f32_16x16x32_bf16 v[76:79],a[228:231],v[228:231],v[76:79]
s_waitcnt lgkmcnt(4)
v_mfma_f32_16x16x32_bf16 v[68:71],a[104:107],v[232:235],v[68:71]
v_min3_u32 v27,v27,v232,v236
v_mfma_f32_16x16x32_bf16 v[76:79],a[232:235],v[232:235],v[76:79]
v_rcp_f32 v91,v91
v_mfma_f32_16x16x32_bf16 v[68:71],a[108:111],v[236:239],v[68:71]
v_mul_f32 v88,v88,v64
v_mul_f32 v89,v89,v65
v_mfma_f32_16x16x32_bf16 v[76:79],a[236:239],v[236:239],v[76:79]
v_mul_f32 v90,v90,v66
s_waitcnt lgkmcnt(2)
v_mfma_f32_16x16x32_bf16 v[68:71],a[112:115],v[240:243],v[68:71]
v_min3_u32 v27,v27,v240,v244
v_mul_f32 v91,v91,v67
v_mfma_f32_16x16x32_bf16 v[76:79],a[240:243],v[240:243],v[76:79]
v_cvt_pk_bf16_f32 v96,v88,v89
v_cvt_pk_bf16_f32 v97,v90,v91
v_mfma_f32_16x16x32_bf16 v[68:71],a[116:119],v[244:247],v[68:71]
v_cvt_pk_bf16_f32 v98,v92,v93
v_cvt_pk_bf16_f32 v99,v94,v95
v_mfma_f32_16x16x32_bf16 v[76:79],a[244:247],v[244:247],v[76:79]
v_max_u32 v96,1,v96
s_waitcnt lgkmcnt(0)
v_mfma_f32_16x16x32_bf16 v[68:71],a[120:123],v[248:251],v[68:71]
v_min3_u32 v27,v27,v248,v252
v_mfma_f32_16x16x32_bf16 v[76:79],a[248:251],v[248:251],v[76:79]
buffer_store_dwordx4 v[96:99],v18,s[20:23],s70 offen offset:0 sc1
v_mfma_f32_16x16x32_bf16 v[68:71],a[124:127],v[252:255],v[68:71]
v_mfma_f32_16x16x32_bf16 v[76:79],a[252:255],v[252:255],v[76:79]
v_cmp_eq_u32 vcc,0,v27
s_cbranch_vccnz retry_377
s_branch epi_380
both_381:
s_waitcnt vmcnt(12) lgkmcnt(0)
s_barrier
ds_read_b128 v[224:227],v17 offset:0
ds_read_b128 v[228:231],v17 offset:2048
ds_read_b128 v[232:235],v17 offset:4096
ds_read_b128 v[236:239],v17 offset:6144
ds_read_b128 v[240:243],v17 offset:8192
ds_read_b128 v[244:247],v17 offset:10240
ds_read_b128 v[248:251],v17 offset:12288
s_waitcnt lgkmcnt(5)
v_mfma_f32_16x16x32_bf16 v[64:67],a[0:3],v[224:227],0
s_add_u32 s96,s71,1
s_add_u32 s92,s71,2
s_add_u32 s88,s70,s75
v_mfma_f32_16x16x32_bf16 v[72:75],a[128:131],v[224:227],0
ds_read_b128 v[252:255],v17 offset:14336
s_add_u32 s88,s88,2097152
s_xor_b32 s88,s88,0x2000
v_mfma_f32_16x16x32_bf16 v[64:67],a[4:7],v[228:231],v[64:67]
s_cmp_eq_u32 s96,64
s_cselect_b32 s96,99,s96
v_min_u32 v27,v224,v228
v_mfma_f32_16x16x32_bf16 v[72:75],a[132:135],v[228:231],v[72:75]
ds_read_b128 v[224:227],v17 offset:16384
s_waitcnt lgkmcnt(5)
v_mfma_f32_16x16x32_bf16 v[64:67],a[8:11],v[232:235],v[64:67]
s_cmp_eq_u32 s92,64
s_cselect_b32 s92,99,s92
v_mfma_f32_16x16x32_bf16 v[72:75],a[136:139],v[232:235],v[72:75]
ds_read_b128 v[228:231],v17 offset:18432
s_xor_b32 s89,s88,1024
v_mfma_f32_16x16x32_bf16 v[64:67],a[12:15],v[236:239],v[64:67]
s_xor_b32 m0,s72,0
v_min3_u32 v27,v27,v232,v236
v_mfma_f32_16x16x32_bf16 v[72:75],a[140:143],v[236:239],v[72:75]
ds_read_b128 v[232:235],v17 offset:20480
s_add_u32 s65,s88,0
s_waitcnt lgkmcnt(5)
v_mfma_f32_16x16x32_bf16 v[64:67],a[16:19],v[240:243],v[64:67]
v_min3_u32 v27,v27,v240,v244
v_mfma_f32_16x16x32_bf16 v[72:75],a[144:147],v[240:243],v[72:75]
ds_read_b128 v[236:239],v17 offset:22528
buffer_load_dwordx4 v16,s[20:23],s65 offen offset:0 sc1 lds
v_mfma_f32_16x16x32_bf16 v[64:67],a[20:23],v[244:247],v[64:67]
buffer_load_dwordx4 v16,s[20:23],s65 offen offset:2048 sc1 lds
v_mfma_f32_16x16x32_bf16 v[72:75],a[148:151],v[244:247],v[72:75]
ds_read_b128 v[240:243],v17 offset:24576
s_waitcnt lgkmcnt(5)
v_mfma_f32_16x16x32_bf16 v[64:67],a[24:27],v[248:251],v[64:67]
s_xor_b32 m0,s72,16384
v_min3_u32 v27,v27,v248,v252
v_mfma_f32_16x16x32_bf16 v[72:75],a[152:155],v[248:251],v[72:75]
ds_read_b128 v[244:247],v17 offset:26624
v_mfma_f32_16x16x32_bf16 v[64:67],a[28:31],v[252:255],v[64:67]
s_add_u32 s65,s88,32768
v_mfma_f32_16x16x32_bf16 v[72:75],a[156:159],v[252:255],v[72:75]
ds_read_b128 v[248:251],v17 offset:28672
s_waitcnt lgkmcnt(5)
v_mfma_f32_16x16x32_bf16 v[64:67],a[32:35],v[224:227],v[64:67]
buffer_load_dwordx4 v16,s[20:23],s65 offen offset:0 sc1 lds
v_mfma_f32_16x16x32_bf16 v[72:75],a[160:163],v[224:227],v[72:75]
ds_read_b128 v[252:255],v17 offset:30720
buffer_load_dwordx4 v16,s[20:23],s65 offen offset:2048 sc1 lds
v_mfma_f32_16x16x32_bf16 v[64:67],a[36:39],v[228:231],v[64:67]
v_min3_u32 v27,v27,v224,v228
v_mfma_f32_16x16x32_bf16 v[72:75],a[164:167],v[228:231],v[72:75]
ds_read_b128 v[224:227],v17 offset:32768
s_xor_b32 m0,s72,32768
s_waitcnt lgkmcnt(5)
v_mfma_f32_16x16x32_bf16 v[64:67],a[40:43],v[232:235],v[64:67]
s_add_u32 s65,s88,65536
v_min3_u32 v27,v27,v232,v236
v_mfma_f32_16x16x32_bf16 v[72:75],a[168:171],v[232:235],v[72:75]
ds_read_b128 v[228:231],v17 offset:34816
v_mfma_f32_16x16x32_bf16 v[64:67],a[44:47],v[236:239],v[64:67]
buffer_load_dwordx4 v16,s[20:23],s65 offen offset:0 sc1 lds
v_mfma_f32_16x16x32_bf16 v[72:75],a[172:175],v[236:239],v[72:75]
ds_read_b128 v[232:235],v17 offset:36864
s_waitcnt lgkmcnt(5)
v_mfma_f32_16x16x32_bf16 v[64:67],a[48:51],v[240:243],v[64:67]
buffer_load_dwordx4 v16,s[20:23],s65 offen offset:2048 sc1 lds
v_mfma_f32_16x16x32_bf16 v[72:75],a[176:179],v[240:243],v[72:75]
ds_read_b128 v[236:239],v17 offset:38912
s_xor_b32 m0,s72,49152
v_mfma_f32_16x16x32_bf16 v[64:67],a[52:55],v[244:247],v[64:67]
v_min3_u32 v27,v27,v240,v244
v_mfma_f32_16x16x32_bf16 v[72:75],a[180:183],v[244:247],v[72:75]
ds_read_b128 v[240:243],v17 offset:40960
s_add_u32 s65,s88,98304
s_waitcnt lgkmcnt(5)
v_mfma_f32_16x16x32_bf16 v[64:67],a[56:59],v[248:251],v[64:67]
buffer_load_dwordx4 v16,s[20:23],s65 offen offset:0 sc1 lds
v_min3_u32 v27,v27,v248,v252
v_mfma_f32_16x16x32_bf16 v[72:75],a[184:187],v[248:251],v[72:75]
ds_read_b128 v[244:247],v17 offset:43008
s_waitcnt vmcnt(9)
v_mfma_f32_16x16x32_bf16 v[64:67],a[60:63],v[252:255],v[64:67]
v_cmp_gt_u32 vcc,s96,v29
v_cmp_gt_u32 s[92:93],s92,v29
v_mfma_f32_16x16x32_bf16 v[72:75],a[188:191],v[252:255],v[72:75]
ds_read_b128 v[248:251],v17 offset:45056
s_waitcnt lgkmcnt(5)
v_mfma_f32_16x16x32_bf16 v[64:67],a[64:67],v[224:227],v[64:67]
v_mov_b32 v44,vcc_lo
v_mov_b32 v45,s92
v_min3_u32 v27,v27,v224,v228
v_mfma_f32_16x16x32_bf16 v[72:75],a[192:195],v[224:227],v[72:75]
ds_read_b128 v[252:255],v17 offset:47104
ds_write_b64 v46,v[44:45]
v_mfma_f32_16x16x32_bf16 v[64:67],a[68:71],v[228:231],v[64:67]
buffer_load_dwordx4 v16,s[20:23],s65 offen offset:2048 sc1 lds
v_mfma_f32_16x16x32_bf16 v[72:75],a[196:199],v[228:231],v[72:75]
ds_read_b128 v[224:227],v17 offset:49152
s_waitcnt lgkmcnt(6)
v_mfma_f32_16x16x32_bf16 v[64:67],a[72:75],v[232:235],v[64:67]
s_xor_b32 m0,s72,1024
s_add_u32 s65,s89,0
v_mfma_f32_16x16x32_bf16 v[72:75],a[200:203],v[232:235],v[72:75]
ds_read_b128 v[228:231],v17 offset:51200
v_min3_u32 v27,v27,v232,v236
v_mfma_f32_16x16x32_bf16 v[64:67],a[76:79],v[236:239],v[64:67]
buffer_load_dwordx4 v16,s[20:23],s65 offen offset:0 sc1 lds
v_mfma_f32_16x16x32_bf16 v[72:75],a[204:207],v[236:239],v[72:75]
ds_read_b128 v[232:235],v17 offset:53248
s_waitcnt lgkmcnt(6)
v_mfma_f32_16x16x32_bf16 v[64:67],a[80:83],v[240:243],v[64:67]
buffer_load_dwordx4 v16,s[20:23],s65 offen offset:2048 sc1 lds
v_mfma_f32_16x16x32_bf16 v[72:75],a[208:211],v[240:243],v[72:75]
ds_read_b128 v[236:239],v17 offset:55296
s_xor_b32 m0,s72,17408
v_mfma_f32_16x16x32_bf16 v[64:67],a[84:87],v[244:247],v[64:67]
s_add_u32 s65,s89,32768
v_min3_u32 v27,v27,v240,v244
v_mfma_f32_16x16x32_bf16 v[72:75],a[212:215],v[244:247],v[72:75]
ds_read_b128 v[240:243],v17 offset:57344
s_waitcnt lgkmcnt(6)
v_mfma_f32_16x16x32_bf16 v[64:67],a[88:91],v[248:251],v[64:67]
buffer_load_dwordx4 v16,s[20:23],s65 offen offset:0 sc1 lds
v_mfma_f32_16x16x32_bf16 v[72:75],a[216:219],v[248:251],v[72:75]
ds_read_b128 v[244:247],v17 offset:59392
v_min3_u32 v27,v27,v248,v252
v_mfma_f32_16x16x32_bf16 v[64:67],a[92:95],v[252:255],v[64:67]
buffer_load_dwordx4 v16,s[20:23],s65 offen offset:2048 sc1 lds
v_mfma_f32_16x16x32_bf16 v[72:75],a[220:223],v[252:255],v[72:75]
ds_read_b128 v[248:251],v17 offset:61440
s_waitcnt lgkmcnt(5)
v_mfma_f32_16x16x32_bf16 v[64:67],a[96:99],v[224:227],v[64:67]
s_xor_b32 m0,s72,33792
s_add_u32 s65,s89,65536
v_mfma_f32_16x16x32_bf16 v[72:75],a[224:227],v[224:227],v[72:75]
ds_read_b128 v[252:255],v17 offset:63488
v_min3_u32 v27,v27,v224,v228
v_mfma_f32_16x16x32_bf16 v[64:67],a[100:103],v[228:231],v[64:67]
buffer_load_dwordx4 v16,s[20:23],s65 offen offset:0 sc1 lds
s_waitcnt vmcnt(13)
v_add_u32 v22,s71,-1
v_mfma_f32_16x16x32_bf16 v[72:75],a[228:231],v[228:231],v[72:75]
s_waitcnt vmcnt(17)
s_barrier
ds_read_b64 v[44:45],v47
ds_read_b128 v[224:227],v17 offset:1024
s_waitcnt lgkmcnt(6)
v_mfma_f32_16x16x32_bf16 v[64:67],a[104:107],v[232:235],v[64:67]
buffer_load_dwordx4 v16,s[20:23],s65 offen offset:2048 sc1 lds
buffer_store_dword v22,v23,s[20:23],s97 offen sc1
v_mfma_f32_16x16x32_bf16 v[72:75],a[232:235],v[232:235],v[72:75]
ds_read_b128 v[228:231],v17 offset:3072
s_xor_b32 m0,s72,50176
s_mov_b32 s97,0x7fff0000
v_mfma_f32_16x16x32_bf16 v[64:67],a[108:111],v[236:239],v[64:67]
s_add_u32 s65,s89,98304
v_min3_u32 v27,v27,v232,v236
ds_read_b128 v[124:127],v19 offset:256
v_mfma_f32_16x16x32_bf16 v[72:75],a[236:239],v[236:239],v[72:75]
ds_read_b128 v[232:235],v17 offset:5120
ds_read_b128 v[120:123],v19 offset:0
s_waitcnt lgkmcnt(8)
v_mfma_f32_16x16x32_bf16 v[64:67],a[112:115],v[240:243],v[64:67]
buffer_load_dwordx4 v16,s[20:23],s65 offen offset:0 sc1 lds
v_mfma_f32_16x16x32_bf16 v[72:75],a[240:243],v[240:243],v[72:75]
ds_read_b128 v[236:239],v17 offset:7168
v_min3_u32 v27,v27,v240,v244
v_mfma_f32_16x16x32_bf16 v[64:67],a[116:119],v[244:247],v[64:67]
buffer_load_dwordx4 v16,s[20:23],s65 offen offset:2048 sc1 lds
v_mfma_f32_16x16x32_bf16 v[72:75],a[244:247],v[244:247],v[72:75]
ds_read_b128 v[240:243],v17 offset:9216
s_waitcnt lgkmcnt(8)
v_mfma_f32_16x16x32_bf16 v[64:67],a[120:123],v[248:251],v[64:67]
s_waitcnt lgkmcnt(7)
v_readfirstlane_b32 s93,v45
v_mfma_f32_16x16x32_bf16 v[72:75],a[248:251],v[248:251],v[72:75]
ds_read_b128 v[244:247],v17 offset:11264
v_min3_u32 v27,v27,v248,v252
v_mfma_f32_16x16x32_bf16 v[64:67],a[124:127],v[252:255],v[64:67]
v_mfma_f32_16x16x32_bf16 v[72:75],a[252:255],v[252:255],v[72:75]
ds_read_b128 v[248:251],v17 offset:13312
s_waitcnt lgkmcnt(7)
v_mfma_f32_16x16x32_bf16 v[68:71],a[0:3],v[224:227],0
v_cmp_eq_u32 vcc,0,v27
s_cbranch_vccnz retry_377
v_mfma_f32_16x16x32_bf16 v[76:79],a[128:131],v[224:227],0
ds_read_b128 v[252:255],v17 offset:15360
v_min3_u32 v27,v27,v224,v228
v_mfma_f32_16x16x32_bf16 v[68:71],a[4:7],v[228:231],v[68:71]
s_waitcnt lgkmcnt(5)
v_mfma_f32_16x16x32_bf16 v[76:79],a[132:135],v[228:231],v[76:79]
ds_read_b128 v[224:227],v17 offset:17408
s_waitcnt lgkmcnt(5)
v_mfma_f32_16x16x32_bf16 v[68:71],a[8:11],v[232:235],v[68:71]
v_min3_u32 v27,v27,v232,v236
v_fmac_f32 v64,v52,v120
v_fmac_f32 v72,v56,v120
v_mfma_f32_16x16x32_bf16 v[76:79],a[136:139],v[232:235],v[76:79]
ds_read_b128 v[228:231],v17 offset:19456
v_fmac_f32 v65,v53,v120
v_fmac_f32 v73,v57,v120
v_mfma_f32_16x16x32_bf16 v[68:71],a[12:15],v[236:239],v[68:71]
v_fmac_f32 v66,v54,v120
v_fmac_f32 v67,v55,v120
v_fmac_f32 v74,v58,v120
v_mfma_f32_16x16x32_bf16 v[76:79],a[140:143],v[236:239],v[76:79]
ds_read_b128 v[232:235],v17 offset:21504
v_fmac_f32 v75,v59,v120
s_waitcnt lgkmcnt(5)
v_mfma_f32_16x16x32_bf16 v[68:71],a[16:19],v[240:243],v[68:71]
v_min3_u32 v27,v27,v240,v244
v_mul_f32 v88,v64,v64
v_mul_f32 v92,v72,v72
v_mfma_f32_16x16x32_bf16 v[76:79],a[144:147],v[240:243],v[76:79]
ds_read_b128 v[236:239],v17 offset:23552
v_mul_f32 v89,v65,v65
v_mul_f32 v93,v73,v73
v_mfma_f32_16x16x32_bf16 v[68:71],a[20:23],v[244:247],v[68:71]
v_mul_f32 v90,v66,v66
v_mul_f32 v91,v67,v67
v_mul_f32 v94,v74,v74
v_mfma_f32_16x16x32_bf16 v[76:79],a[148:151],v[244:247],v[76:79]
ds_read_b128 v[240:243],v17 offset:25600
v_mul_f32 v95,v75,v75
s_waitcnt lgkmcnt(5)
v_mfma_f32_16x16x32_bf16 v[68:71],a[24:27],v[248:251],v[68:71]
v_min3_u32 v27,v27,v248,v252
v_fma_f32 v88,v88,v121,v122
v_fma_f32 v92,v92,v121,v122
v_mfma_f32_16x16x32_bf16 v[76:79],a[152:155],v[248:251],v[76:79]
ds_read_b128 v[244:247],v17 offset:27648
v_fma_f32 v89,v89,v121,v122
v_fma_f32 v93,v93,v121,v122
v_mfma_f32_16x16x32_bf16 v[68:71],a[28:31],v[252:255],v[68:71]
v_fma_f32 v90,v90,v121,v122
v_fma_f32 v91,v91,v121,v122
v_fma_f32 v94,v94,v121,v122
v_mfma_f32_16x16x32_bf16 v[76:79],a[156:159],v[252:255],v[76:79]
ds_read_b128 v[248:251],v17 offset:29696
v_fma_f32 v95,v95,v121,v122
s_waitcnt lgkmcnt(5)
v_mfma_f32_16x16x32_bf16 v[68:71],a[32:35],v[224:227],v[68:71]
v_min3_u32 v27,v27,v224,v228
v_mul_f32 v88,v88,v64
v_mul_f32 v92,v92,v72
v_mfma_f32_16x16x32_bf16 v[76:79],a[160:163],v[224:227],v[76:79]
ds_read_b128 v[252:255],v17 offset:31744
v_mul_f32 v89,v89,v65
v_mul_f32 v93,v93,v73
v_mfma_f32_16x16x32_bf16 v[68:71],a[36:39],v[228:231],v[68:71]
v_mul_f32 v90,v90,v66
v_mul_f32 v91,v91,v67
v_mul_f32 v94,v94,v74
v_mfma_f32_16x16x32_bf16 v[76:79],a[164:167],v[228:231],v[76:79]
ds_read_b128 v[224:227],v17 offset:33792
v_mul_f32 v95,v95,v75
s_waitcnt lgkmcnt(5)
v_mfma_f32_16x16x32_bf16 v[68:71],a[40:43],v[232:235],v[68:71]
v_min3_u32 v27,v27,v232,v236
v_exp_f32 v92,v92
v_mfma_f32_16x16x32_bf16 v[76:79],a[168:171],v[232:235],v[76:79]
ds_read_b128 v[228:231],v17 offset:35840
v_exp_f32 v93,v93
v_mfma_f32_16x16x32_bf16 v[68:71],a[44:47],v[236:239],v[68:71]
v_exp_f32 v88,v88
v_mfma_f32_16x16x32_bf16 v[76:79],a[172:175],v[236:239],v[76:79]
ds_read_b128 v[232:235],v17 offset:37888
s_waitcnt lgkmcnt(5)
v_mfma_f32_16x16x32_bf16 v[68:71],a[48:51],v[240:243],v[68:71]
v_min3_u32 v27,v27,v240,v244
v_exp_f32 v94,v94
v_mfma_f32_16x16x32_bf16 v[76:79],a[176:179],v[240:243],v[76:79]
ds_read_b128 v[236:239],v17 offset:39936
v_exp_f32 v95,v95
v_mfma_f32_16x16x32_bf16 v[68:71],a[52:55],v[244:247],v[68:71]
v_exp_f32 v89,v89
v_fma_f32 v92,v92,v123,v123
v_mfma_f32_16x16x32_bf16 v[76:79],a[180:183],v[244:247],v[76:79]
ds_read_b128 v[240:243],v17 offset:41984
v_fma_f32 v93,v93,v123,v123
s_waitcnt lgkmcnt(5)
v_mfma_f32_16x16x32_bf16 v[68:71],a[56:59],v[248:251],v[68:71]
v_min3_u32 v27,v27,v248,v252
v_fma_f32 v94,v94,v123,v123
v_fma_f32 v95,v95,v123,v123
v_mfma_f32_16x16x32_bf16 v[76:79],a[184:187],v[248:251],v[76:79]
ds_read_b128 v[244:247],v17 offset:44032
v_rcp_f32 v92,v92
v_mfma_f32_16x16x32_bf16 v[68:71],a[60:63],v[252:255],v[68:71]
v_exp_f32 v90,v90
v_mfma_f32_16x16x32_bf16 v[76:79],a[188:191],v[252:255],v[76:79]
ds_read_b128 v[248:251],v17 offset:46080
s_waitcnt lgkmcnt(5)
v_mfma_f32_16x16x32_bf16 v[68:71],a[64:67],v[224:227],v[68:71]
v_min3_u32 v27,v27,v224,v228
v_rcp_f32 v93,v93
v_mfma_f32_16x16x32_bf16 v[76:79],a[192:195],v[224:227],v[76:79]
ds_read_b128 v[252:255],v17 offset:48128
v_rcp_f32 v94,v94
v_mfma_f32_16x16x32_bf16 v[68:71],a[68:71],v[228:231],v[68:71]
v_exp_f32 v91,v91
v_mfma_f32_16x16x32_bf16 v[76:79],a[196:199],v[228:231],v[76:79]
ds_read_b128 v[224:227],v17 offset:50176
s_waitcnt lgkmcnt(5)
v_mfma_f32_16x16x32_bf16 v[68:71],a[72:75],v[232:235],v[68:71]
v_min3_u32 v27,v27,v232,v236
v_fma_f32 v88,v88,v123,v123
v_mfma_f32_16x16x32_bf16 v[76:79],a[200:203],v[232:235],v[76:79]
ds_read_b128 v[228:231],v17 offset:52224
v_fma_f32 v89,v89,v123,v123
v_mfma_f32_16x16x32_bf16 v[68:71],a[76:79],v[236:239],v[68:71]
v_fma_f32 v90,v90,v123,v123
v_fma_f32 v91,v91,v123,v123
v_mfma_f32_16x16x32_bf16 v[76:79],a[204:207],v[236:239],v[76:79]
ds_read_b128 v[232:235],v17 offset:54272
s_waitcnt lgkmcnt(5)
v_mfma_f32_16x16x32_bf16 v[68:71],a[80:83],v[240:243],v[68:71]
v_min3_u32 v27,v27,v240,v244
v_rcp_f32 v95,v95
v_mfma_f32_16x16x32_bf16 v[76:79],a[208:211],v[240:243],v[76:79]
ds_read_b128 v[236:239],v17 offset:56320
v_mul_f32 v92,v92,v72
v_mfma_f32_16x16x32_bf16 v[68:71],a[84:87],v[244:247],v[68:71]
v_rcp_f32 v88,v88
v_mfma_f32_16x16x32_bf16 v[76:79],a[212:215],v[244:247],v[76:79]
ds_read_b128 v[240:243],v17 offset:58368
s_waitcnt lgkmcnt(5)
v_mfma_f32_16x16x32_bf16 v[68:71],a[88:91],v[248:251],v[68:71]
v_min3_u32 v27,v27,v248,v252
v_mul_f32 v93,v93,v73
v_mfma_f32_16x16x32_bf16 v[76:79],a[216:219],v[248:251],v[76:79]
ds_read_b128 v[244:247],v17 offset:60416
v_mul_f32 v94,v94,v74
v_mfma_f32_16x16x32_bf16 v[68:71],a[92:95],v[252:255],v[68:71]
v_rcp_f32 v89,v89
v_mfma_f32_16x16x32_bf16 v[76:79],a[220:223],v[252:255],v[76:79]
ds_read_b128 v[248:251],v17 offset:62464
s_waitcnt lgkmcnt(5)
v_mfma_f32_16x16x32_bf16 v[68:71],a[96:99],v[224:227],v[68:71]
v_min3_u32 v27,v27,v224,v228
v_mul_f32 v95,v95,v75
v_mfma_f32_16x16x32_bf16 v[76:79],a[224:227],v[224:227],v[76:79]
ds_read_b128 v[252:255],v17 offset:64512
v_mfma_f32_16x16x32_bf16 v[68:71],a[100:103],v[228:231],v[68:71]
v_rcp_f32 v90,v90
v_mfma_f32_16x16x32_bf16 v[76:79],a[228:231],v[228:231],v[76:79]
s_waitcnt lgkmcnt(4)
v_mfma_f32_16x16x32_bf16 v[68:71],a[104:107],v[232:235],v[68:71]
v_min3_u32 v27,v27,v232,v236
v_mfma_f32_16x16x32_bf16 v[76:79],a[232:235],v[232:235],v[76:79]
v_rcp_f32 v91,v91
v_mfma_f32_16x16x32_bf16 v[68:71],a[108:111],v[236:239],v[68:71]
v_mul_f32 v88,v88,v64
v_mul_f32 v89,v89,v65
v_mfma_f32_16x16x32_bf16 v[76:79],a[236:239],v[236:239],v[76:79]
v_mul_f32 v90,v90,v66
s_waitcnt lgkmcnt(2)
v_mfma_f32_16x16x32_bf16 v[68:71],a[112:115],v[240:243],v[68:71]
v_min3_u32 v27,v27,v240,v244
v_mul_f32 v91,v91,v67
v_mfma_f32_16x16x32_bf16 v[76:79],a[240:243],v[240:243],v[76:79]
v_cvt_pk_bf16_f32 v96,v88,v89
v_cvt_pk_bf16_f32 v97,v90,v91
v_mfma_f32_16x16x32_bf16 v[68:71],a[116:119],v[244:247],v[68:71]
v_cvt_pk_bf16_f32 v98,v92,v93
v_cvt_pk_bf16_f32 v99,v94,v95
v_mfma_f32_16x16x32_bf16 v[76:79],a[244:247],v[244:247],v[76:79]
v_max_u32 v96,1,v96
s_waitcnt lgkmcnt(0)
v_mfma_f32_16x16x32_bf16 v[68:71],a[120:123],v[248:251],v[68:71]
v_min3_u32 v27,v27,v248,v252
v_mfma_f32_16x16x32_bf16 v[76:79],a[248:251],v[248:251],v[76:79]
buffer_store_dwordx4 v[96:99],v18,s[20:23],s70 offen offset:0 sc1
v_mfma_f32_16x16x32_bf16 v[68:71],a[124:127],v[252:255],v[68:71]
v_mfma_f32_16x16x32_bf16 v[76:79],a[252:255],v[252:255],v[76:79]
v_cmp_eq_u32 vcc,0,v27
s_cbranch_vccnz retry_377
epi_380:
buffer_load_dword v29,v21,s[20:23],s87 offen sc1
s_nop 3
v_pk_fma_f32 v[68:69],v[52:53],v[124:125],v[68:69] op_sel_hi:[1,0,1]
v_pk_fma_f32 v[70:71],v[54:55],v[124:125],v[70:71] op_sel_hi:[1,0,1]
v_pk_fma_f32 v[76:77],v[56:57],v[124:125],v[76:77] op_sel_hi:[1,0,1]
v_pk_fma_f32 v[78:79],v[58:59],v[124:125],v[78:79] op_sel_hi:[1,0,1]
v_pk_mul_f32 v[88:89],v[68:69],v[68:69]
v_pk_mul_f32 v[90:91],v[70:71],v[70:71]
v_pk_mul_f32 v[92:93],v[76:77],v[76:77]
v_pk_mul_f32 v[94:95],v[78:79],v[78:79]
v_pk_fma_f32 v[88:89],v[88:89],v[124:125],v[126:127] op_sel:[0,1,0] op_sel_hi:[1,1,0]
v_pk_fma_f32 v[90:91],v[90:91],v[124:125],v[126:127] op_sel:[0,1,0] op_sel_hi:[1,1,0]
v_pk_fma_f32 v[92:93],v[92:93],v[124:125],v[126:127] op_sel:[0,1,0] op_sel_hi:[1,1,0]
v_pk_fma_f32 v[94:95],v[94:95],v[124:125],v[126:127] op_sel:[0,1,0] op_sel_hi:[1,1,0]
v_pk_mul_f32 v[88:89],v[88:89],v[68:69]
v_pk_mul_f32 v[90:91],v[90:91],v[70:71]
v_pk_mul_f32 v[92:93],v[92:93],v[76:77]
v_pk_mul_f32 v[94:95],v[94:95],v[78:79]
v_exp_f32 v88,v88
v_exp_f32 v89,v89
v_exp_f32 v90,v90
v_exp_f32 v91,v91
v_exp_f32 v92,v92
v_exp_f32 v93,v93
v_exp_f32 v94,v94
s_cmp_gt_u32 s71,44
s_cselect_b32 s65,s73,0x7fff0000
s_cselect_b32 s97,0x7fff0000,s73
v_mov_b32 v22,s71
buffer_store_dword v22,v23,s[20:23],s65 offen sc1
v_exp_f32 v95,v95
v_pk_fma_f32 v[88:89],v[88:89],v[126:127],v[126:127] op_sel:[0,1,1] op_sel_hi:[1,1,1]
v_pk_fma_f32 v[90:91],v[90:91],v[126:127],v[126:127] op_sel:[0,1,1] op_sel_hi:[1,1,1]
v_pk_fma_f32 v[92:93],v[92:93],v[126:127],v[126:127] op_sel:[0,1,1] op_sel_hi:[1,1,1]
v_pk_fma_f32 v[94:95],v[94:95],v[126:127],v[126:127] op_sel:[0,1,1] op_sel_hi:[1,1,1]
v_rcp_f32 v88,v88
v_rcp_f32 v89,v89
v_rcp_f32 v90,v90
v_rcp_f32 v91,v91
v_rcp_f32 v92,v92
v_rcp_f32 v93,v93
v_rcp_f32 v94,v94
v_rcp_f32 v95,v95
v_pk_mul_f32 v[88:89],v[88:89],v[68:69]
v_pk_mul_f32 v[90:91],v[90:91],v[70:71]
v_pk_mul_f32 v[92:93],v[92:93],v[76:77]
v_pk_mul_f32 v[94:95],v[94:95],v[78:79]
v_cvt_pk_bf16_f32 v96,v88,v89
v_cvt_pk_bf16_f32 v97,v90,v91
v_cvt_pk_bf16_f32 v98,v92,v93
v_cvt_pk_bf16_f32 v99,v94,v95
v_max_u32 v96,1,v96
buffer_store_dwordx4 v[96:99],v18,s[20:23],s70 offen offset:1024 sc1
next_387:
v_xor_b32 v17,0x10000,v17
s_xor_b32 s72,s72,0x10000
s_add_u32 s70,s70,2097152
s_xor_b32 s70,s70,0x2000
s_add_u32 s71,s71,1
s_cmp_le_u32 s71,s57
s_cbranch_scc1 seg_378
s_endpgm
retry_377:
s_sub_u32 s90,s90,64
s_cmp_lt_i32 s90,0
s_cbranch_scc1 giveup_197
s_mov_b32 s83,1
s_waitcnt vmcnt(0) lgkmcnt(0)
s_barrier
s_branch seg_378
half_386:
s_mov_b64 exec,s[52:53]
s_xor_b32 m0,s91,0
s_add_u32 s65,s94,0
buffer_load_dwordx4 v16,s[20:23],s65 offen offset:0 sc1 lds
buffer_load_dwordx4 v16,s[20:23],s65 offen offset:2048 sc1 lds
s_xor_b32 m0,s91,16384
s_add_u32 s65,s94,32768
buffer_load_dwordx4 v16,s[20:23],s65 offen offset:0 sc1 lds
buffer_load_dwordx4 v16,s[20:23],s65 offen offset:2048 sc1 lds
s_xor_b32 m0,s91,32768
s_add_u32 s65,s94,65536
buffer_load_dwordx4 v16,s[20:23],s65 offen offset:0 sc1 lds
buffer_load_dwordx4 v16,s[20:23],s65 offen offset:2048 sc1 lds
s_xor_b32 m0,s91,49152
s_add_u32 s65,s94,98304
buffer_load_dwordx4 v16,s[20:23],s65 offen offset:0 sc1 lds
buffer_load_dwordx4 v16,s[20:23],s65 offen offset:2048 sc1 lds
s_mov_b64 exec,-1
s_waitcnt vmcnt(8)
v_add_u32 v22,s71,-1
buffer_store_dword v22,v23,s[20:23],s97 offen sc1
s_mov_b32 s97,0x7fff0000
half2_383:
s_waitcnt vmcnt(7)
s_barrier
ds_read_b128 v[224:227],v17 offset:0
ds_read_b128 v[228:231],v17 offset:2048
ds_read_b128 v[232:235],v17 offset:4096
ds_read_b128 v[236:239],v17 offset:6144
ds_read_b128 v[240:243],v17 offset:8192
ds_read_b128 v[244:247],v17 offset:10240
ds_read_b128 v[248:251],v17 offset:12288
s_waitcnt lgkmcnt(5)
v_mfma_f32_16x16x32_bf16 v[64:67],a[0:3],v[224:227],0
v_min_u32 v27,v224,v228
v_mfma_f32_16x16x32_bf16 v[72:75],a[128:131],v[224:227],0
ds_read_b128 v[252:255],v17 offset:14336
v_mfma_f32_16x16x32_bf16 v[64:67],a[4:7],v[228:231],v[64:67]
v_mfma_f32_16x16x32_bf16 v[72:75],a[132:135],v[228:231],v[72:75]
s_waitcnt vmcnt(5)
s_barrier
ds_read_b128 v[224:227],v17 offset:16384
s_waitcnt lgkmcnt(5)
v_mfma_f32_16x16x32_bf16 v[64:67],a[8:11],v[232:235],v[64:67]
v_min3_u32 v27,v27,v232,v236
v_mfma_f32_16x16x32_bf16 v[72:75],a[136:139],v[232:235],v[72:75]
ds_read_b128 v[228:231],v17 offset:18432
v_mfma_f32_16x16x32_bf16 v[64:67],a[12:15],v[236:239],v[64:67]
v_mfma_f32_16x16x32_bf16 v[72:75],a[140:143],v[236:239],v[72:75]
ds_read_b128 v[232:235],v17 offset:20480
s_waitcnt lgkmcnt(5)
v_mfma_f32_16x16x32_bf16 v[64:67],a[16:19],v[240:243],v[64:67]
v_min3_u32 v27,v27,v240,v244
v_mfma_f32_16x16x32_bf16 v[72:75],a[144:147],v[240:243],v[72:75]
ds_read_b128 v[236:239],v17 offset:22528
v_mfma_f32_16x16x32_bf16 v[64:67],a[20:23],v[244:247],v[64:67]
v_mfma_f32_16x16x32_bf16 v[72:75],a[148:151],v[244:247],v[72:75]
ds_read_b128 v[240:243],v17 offset:24576
s_waitcnt lgkmcnt(5)
v_mfma_f32_16x16x32_bf16 v[64:67],a[24:27],v[248:251],v[64:67]
v_min3_u32 v27,v27,v248,v252
v_mfma_f32_16x16x32_bf16 v[72:75],a[152:155],v[248:251],v[72:75]
ds_read_b128 v[244:247],v17 offset:26624
v_mfma_f32_16x16x32_bf16 v[64:67],a[28:31],v[252:255],v[64:67]
v_mfma_f32_16x16x32_bf16 v[72:75],a[156:159],v[252:255],v[72:75]
ds_read_b128 v[248:251],v17 offset:28672
s_waitcnt lgkmcnt(5)
v_mfma_f32_16x16x32_bf16 v[64:67],a[32:35],v[224:227],v[64:67]
v_min3_u32 v27,v27,v224,v228
v_mfma_f32_16x16x32_bf16 v[72:75],a[160:163],v[224:227],v[72:75]
ds_read_b128 v[252:255],v17 offset:30720
v_mfma_f32_16x16x32_bf16 v[64:67],a[36:39],v[228:231],v[64:67]
v_mfma_f32_16x16x32_bf16 v[72:75],a[164:167],v[228:231],v[72:75]
s_waitcnt vmcnt(1)
s_barrier
ds_read_b128 v[224:227],v17 offset:32768
s_waitcnt lgkmcnt(5)
v_mfma_f32_16x16x32_bf16 v[64:67],a[40:43],v[232:235],v[64:67]
v_min3_u32 v27,v27,v232,v236
v_mfma_f32_16x16x32_bf16 v[72:75],a[168:171],v[232:235],v[72:75]
ds_read_b128 v[228:231],v17 offset:34816
v_mfma_f32_16x16x32_bf16 v[64:67],a[44:47],v[236:239],v[64:67]
v_mfma_f32_16x16x32_bf16 v[72:75],a[172:175],v[236:239],v[72:75]
ds_read_b128 v[232:235],v17 offset:36864
s_waitcnt lgkmcnt(5)
v_mfma_f32_16x16x32_bf16 v[64:67],a[48:51],v[240:243],v[64:67]
v_min3_u32 v27,v27,v240,v244
v_mfma_f32_16x16x32_bf16 v[72:75],a[176:179],v[240:243],v[72:75]
ds_read_b128 v[236:239],v17 offset:38912
v_mfma_f32_16x16x32_bf16 v[64:67],a[52:55],v[244:247],v[64:67]
v_mfma_f32_16x16x32_bf16 v[72:75],a[180:183],v[244:247],v[72:75]
ds_read_b128 v[240:243],v17 offset:40960
s_waitcnt lgkmcnt(5)
v_mfma_f32_16x16x32_bf16 v[64:67],a[56:59],v[248:251],v[64:67]
v_min3_u32 v27,v27,v248,v252
v_mfma_f32_16x16x32_bf16 v[72:75],a[184:187],v[248:251],v[72:75]
ds_read_b128 v[244:247],v17 offset:43008
v_mfma_f32_16x16x32_bf16 v[64:67],a[60:63],v[252:255],v[64:67]
v_mfma_f32_16x16x32_bf16 v[72:75],a[188:191],v[252:255],v[72:75]
ds_read_b128 v[248:251],v17 offset:45056
s_waitcnt lgkmcnt(5)
v_mfma_f32_16x16x32_bf16 v[64:67],a[64:67],v[224:227],v[64:67]
v_min3_u32 v27,v27,v224,v228
v_mfma_f32_16x16x32_bf16 v[72:75],a[192:195],v[224:227],v[72:75]
ds_read_b128 v[252:255],v17 offset:47104
v_mfma_f32_16x16x32_bf16 v[64:67],a[68:71],v[228:231],v[64:67]
v_mfma_f32_16x16x32_bf16 v[72:75],a[196:199],v[228:231],v[72:75]
ds_read_b128 v[224:227],v17 offset:49152
s_waitcnt lgkmcnt(5)
v_mfma_f32_16x16x32_bf16 v[64:67],a[72:75],v[232:235],v[64:67]
v_min3_u32 v27,v27,v232,v236
v_mfma_f32_16x16x32_bf16 v[72:75],a[200:203],v[232:235],v[72:75]
ds_read_b128 v[228:231],v17 offset:51200
v_mfma_f32_16x16x32_bf16 v[64:67],a[76:79],v[236:239],v[64:67]
v_mfma_f32_16x16x32_bf16 v[72:75],a[204:207],v[236:239],v[72:75]
ds_read_b128 v[232:235],v17 offset:53248
s_waitcnt lgkmcnt(5)
v_mfma_f32_16x16x32_bf16 v[64:67],a[80:83],v[240:243],v[64:67]
v_min3_u32 v27,v27,v240,v244
v_mfma_f32_16x16x32_bf16 v[72:75],a[208:211],v[240:243],v[72:75]
ds_read_b128 v[236:239],v17 offset:55296
v_mfma_f32_16x16x32_bf16 v[64:67],a[84:87],v[244:247],v[64:67]
v_mfma_f32_16x16x32_bf16 v[72:75],a[212:215],v[244:247],v[72:75]
ds_read_b128 v[240:243],v17 offset:57344
s_waitcnt lgkmcnt(5)
v_mfma_f32_16x16x32_bf16 v[64:67],a[88:91],v[248:251],v[64:67]
v_min3_u32 v27,v27,v248,v252
v_mfma_f32_16x16x32_bf16 v[72:75],a[216:219],v[248:251],v[72:75]
ds_read_b128 v[244:247],v17 offset:59392
v_mfma_f32_16x16x32_bf16 v[64:67],a[92:95],v[252:255],v[64:67]
v_mfma_f32_16x16x32_bf16 v[72:75],a[220:223],v[252:255],v[72:75]
ds_read_b128 v[248:251],v17 offset:61440
s_waitcnt lgkmcnt(5)
v_mfma_f32_16x16x32_bf16 v[64:67],a[96:99],v[224:227],v[64:67]
v_min3_u32 v27,v27,v224,v228
v_mfma_f32_16x16x32_bf16 v[72:75],a[224:227],v[224:227],v[72:75]
s_barrier
ds_read_b128 v[252:255],v17 offset:63488
v_mfma_f32_16x16x32_bf16 v[64:67],a[100:103],v[228:231],v[64:67]
ds_read_b128 v[120:123],v19
v_mfma_f32_16x16x32_bf16 v[72:75],a[228:231],v[228:231],v[72:75]
s_waitcnt lgkmcnt(5)
v_mfma_f32_16x16x32_bf16 v[64:67],a[104:107],v[232:235],v[64:67]
v_min3_u32 v27,v27,v232,v236
v_mfma_f32_16x16x32_bf16 v[72:75],a[232:235],v[232:235],v[72:75]
v_mfma_f32_16x16x32_bf16 v[64:67],a[108:111],v[236:239],v[64:67]
v_mfma_f32_16x16x32_bf16 v[72:75],a[236:239],v[236:239],v[72:75]
s_waitcnt lgkmcnt(3)
v_mfma_f32_16x16x32_bf16 v[64:67],a[112:115],v[240:243],v[64:67]
v_min3_u32 v27,v27,v240,v244
v_mfma_f32_16x16x32_bf16 v[72:75],a[240:243],v[240:243],v[72:75]
v_mfma_f32_16x16x32_bf16 v[64:67],a[116:119],v[244:247],v[64:67]
v_mfma_f32_16x16x32_bf16 v[72:75],a[244:247],v[244:247],v[72:75]
s_waitcnt lgkmcnt(1)
v_mfma_f32_16x16x32_bf16 v[64:67],a[120:123],v[248:251],v[64:67]
v_min3_u32 v27,v27,v248,v252
v_mfma_f32_16x16x32_bf16 v[72:75],a[248:251],v[248:251],v[72:75]
v_mfma_f32_16x16x32_bf16 v[64:67],a[124:127],v[252:255],v[64:67]
v_mfma_f32_16x16x32_bf16 v[72:75],a[252:255],v[252:255],v[72:75]
v_cmp_eq_u32 vcc,0,v27
s_and_b64 vcc,vcc,s[52:53]
s_cbranch_vccnz retry_377
s_waitcnt lgkmcnt(0)
s_nop 3
v_pk_fma_f32 v[64:65],v[52:53],v[120:121],v[64:65] op_sel_hi:[1,0,1]
v_pk_fma_f32 v[66:67],v[54:55],v[120:121],v[66:67] op_sel_hi:[1,0,1]
v_pk_fma_f32 v[72:73],v[56:57],v[120:121],v[72:73] op_sel_hi:[1,0,1]
v_pk_fma_f32 v[74:75],v[58:59],v[120:121],v[74:75] op_sel_hi:[1,0,1]
v_pk_mul_f32 v[88:89],v[64:65],v[64:65]
v_pk_mul_f32 v[90:91],v[66:67],v[66:67]
buffer_load_dword v29,v21,s[20:23],s87 offen sc1
v_mov_b32 v22,s71
buffer_store_dword v22,v23,s[20:23],s73 offen sc1
v_pk_mul_f32 v[92:93],v[72:73],v[72:73]
v_pk_mul_f32 v[94:95],v[74:75],v[74:75]
v_pk_fma_f32 v[88:89],v[88:89],v[120:121],v[122:123] op_sel:[0,1,0] op_sel_hi:[1,1,0]
v_pk_fma_f32 v[90:91],v[90:91],v[120:121],v[122:123] op_sel:[0,1,0] op_sel_hi:[1,1,0]
v_pk_fma_f32 v[92:93],v[92:93],v[120:121],v[122:123] op_sel:[0,1,0] op_sel_hi:[1,1,0]
v_pk_fma_f32 v[94:95],v[94:95],v[120:121],v[122:123] op_sel:[0,1,0] op_sel_hi:[1,1,0]
v_pk_mul_f32 v[88:89],v[88:89],v[64:65]
v_pk_mul_f32 v[90:91],v[90:91],v[66:67]
v_pk_mul_f32 v[92:93],v[92:93],v[72:73]
v_pk_mul_f32 v[94:95],v[94:95],v[74:75]
v_exp_f32 v88,v88
v_exp_f32 v89,v89
v_exp_f32 v90,v90
v_exp_f32 v91,v91
v_exp_f32 v92,v92
v_exp_f32 v93,v93
v_exp_f32 v94,v94
v_exp_f32 v95,v95
v_pk_fma_f32 v[88:89],v[88:89],v[122:123],v[122:123] op_sel:[0,1,1] op_sel_hi:[1,1,1]
v_pk_fma_f32 v[90:91],v[90:91],v[122:123],v[122:123] op_sel:[0,1,1] op_sel_hi:[1,1,1]
v_pk_fma_f32 v[92:93],v[92:93],v[122:123],v[122:123] op_sel:[0,1,1] op_sel_hi:[1,1,1]
v_pk_fma_f32 v[94:95],v[94:95],v[122:123],v[122:123] op_sel:[0,1,1] op_sel_hi:[1,1,1]
v_rcp_f32 v88,v88
v_rcp_f32 v89,v89
v_rcp_f32 v90,v90
v_rcp_f32 v91,v91
v_rcp_f32 v92,v92
v_rcp_f32 v93,v93
v_rcp_f32 v94,v94
v_rcp_f32 v95,v95
v_pk_mul_f32 v[88:89],v[88:89],v[64:65]
v_pk_mul_f32 v[90:91],v[90:91],v[66:67]
v_pk_mul_f32 v[92:93],v[92:93],v[72:73]
v_pk_mul_f32 v[94:95],v[94:95],v[74:75]
v_cvt_pk_bf16_f32 v96,v88,v89
v_cvt_pk_bf16_f32 v97,v90,v91
v_cvt_pk_bf16_f32 v98,v92,v93
v_cvt_pk_bf16_f32 v99,v94,v95
v_max_u32 v96,1,v96
buffer_store_dwordx4 v[96:99],v18,s[20:23],s70 offen offset:0 sc1
s_branch next_387
w3b_376:
s_add_u32 s64,s79,0
s_lshl_b32 s70,s64,21
s_lshl_b32 s64,s64,13
s_and_b32 s64,s64,0x2000
s_xor_b32 s64,s64,s62
s_add_u32 s70,s70,s64
s_add_u32 s70,s70,29360128
s_mov_b32 s83,1
s_mov_b32 s87,s74
s_cmp_eq_u32 s50,0
s_cselect_b32 s74,s74,0x7fff0000
v_mov_b32 v47,132096
s_lshl_b32 s64,s50,3
s_add_u32 s64,s64,132096
v_mov_b32 v46,s64
v_mov_b32 v29,0
s_mov_b32 s97,0x7fff0000
s_mov_b32 s69,1
s_mov_b32 s68,0
s_mov_b32 s52,0x30003
s_mov_b32 s53,s52
seg_393:
s_cmp_eq_u32 s83,0
s_cbranch_scc1 ahead_394
s_add_u32 s94,s70,s75
s_xor_b32 s95,s94,1024
s_xor_b32 s91,s72,0x10000
s_cmp_eq_u32 s69,0
s_mov_b32 s69,1
s_cbranch_scc1 half2_398
s_waitcnt vmcnt(2)
v_cmp_gt_u32 vcc,s71,v29
s_cbranch_vccz nb_397
s_waitcnt vmcnt(0)
v_add_u32 v22,s71,-1
buffer_store_dword v22,v23,s[20:23],s97 offen sc1
s_mov_b32 s97,0x7fff0000
s_cmp_lg_u32 s50,0
s_cbranch_scc1 nb_397
buffer_load_dword v32,v21,s[20:23],s74 offen sc1
s_sleep 2
pl_399:
buffer_load_dword v33,v21,s[20:23],s74 offen sc1
s_waitcnt vmcnt(1)
v_cmp_gt_u32 vcc,s71,v32
v_mov_b32 v29,v32
s_cbranch_vccz pok_400
buffer_load_dword v32,v21,s[20:23],s74 offen sc1
s_waitcnt vmcnt(1)
v_cmp_gt_u32 vcc,s71,v33
v_mov_b32 v29,v33
s_cbranch_vccz pok_400
s_sub_u32 s90,s90,1
s_cmp_gt_i32 s90,0
s_cbranch_scc1 pl_399
pok_400:
nb_397:
s_cmp_eq_u32 s71,64
s_barrier
s_cbranch_scc1 half_401
s_xor_b32 m0,s91,0
s_add_u32 s65,s94,0
buffer_load_dwordx4 v16,s[20:23],s65 offen offset:0 sc1 lds
buffer_load_dwordx4 v16,s[20:23],s65 offen offset:2048 sc1 lds
s_xor_b32 m0,s91,16384
s_add_u32 s65,s94,32768
buffer_load_dwordx4 v16,s[20:23],s65 offen offset:0 sc1 lds
buffer_load_dwordx4 v16,s[20:23],s65 offen offset:2048 sc1 lds
s_xor_b32 m0,s91,32768
s_add_u32 s65,s94,65536
buffer_load_dwordx4 v16,s[20:23],s65 offen offset:0 sc1 lds
buffer_load_dwordx4 v16,s[20:23],s65 offen offset:2048 sc1 lds
s_xor_b32 m0,s91,49152
s_add_u32 s65,s94,98304
buffer_load_dwordx4 v16,s[20:23],s65 offen offset:0 sc1 lds
buffer_load_dwordx4 v16,s[20:23],s65 offen offset:2048 sc1 lds
s_add_u32 s66,s94,110592
buffer_load_dwordx4 v[128:131],v16,s[20:23],s66 offen offset:0 sc1
buffer_load_dwordx4 v[132:135],v16,s[20:23],s66 offen offset:1024 sc1
buffer_load_dwordx4 v[136:139],v16,s[20:23],s66 offen offset:2048 sc1
buffer_load_dwordx4 v[140:143],v16,s[20:23],s66 offen offset:3072 sc1
s_add_u32 s66,s94,114688
buffer_load_dwordx4 v[144:147],v16,s[20:23],s66 offen offset:0 sc1
buffer_load_dwordx4 v[148:151],v16,s[20:23],s66 offen offset:1024 sc1
buffer_load_dwordx4 v[152:155],v16,s[20:23],s66 offen offset:2048 sc1
buffer_load_dwordx4 v[156:159],v16,s[20:23],s66 offen offset:3072 sc1
s_waitcnt vmcnt(16)
v_add_u32 v22,s71,-1
buffer_store_dword v22,v23,s[20:23],s97 offen sc1
s_mov_b32 s97,0x7fff0000
s_waitcnt vmcnt(15)
s_barrier
ds_read_b128 v[224:227],v17 offset:0
ds_read_b128 v[228:231],v17 offset:2048
ds_read_b128 v[232:235],v17 offset:4096
ds_read_b128 v[236:239],v17 offset:6144
ds_read_b128 v[240:243],v17 offset:8192
ds_read_b128 v[244:247],v17 offset:10240
ds_read_b128 v[248:251],v17 offset:12288
s_waitcnt lgkmcnt(5)
v_mfma_f32_16x16x32_bf16 v[64:67],a[0:3],v[224:227],0
ds_read_b128 v[252:255],v17 offset:14336
s_xor_b32 m0,s91,1024
s_add_u32 s65,s95,0
buffer_load_dwordx4 v16,s[20:23],s65 offen offset:0 sc1 lds
buffer_load_dwordx4 v16,s[20:23],s65 offen offset:2048 sc1 lds
v_min_u32 v27,v224,v228
v_mfma_f32_16x16x32_bf16 v[72:75],a[4:7],v[228:231],0
s_waitcnt vmcnt(15)
s_barrier
ds_read_b128 v[224:227],v17 offset:16384
s_xor_b32 m0,s91,17408
s_add_u32 s65,s95,32768
s_waitcnt lgkmcnt(5)
v_mfma_f32_16x16x32_bf16 v[64:67],a[8:11],v[232:235],v[64:67]
ds_read_b128 v[228:231],v17 offset:18432
buffer_load_dwordx4 v16,s[20:23],s65 offen offset:0 sc1 lds
buffer_load_dwordx4 v16,s[20:23],s65 offen offset:2048 sc1 lds
s_xor_b32 m0,s91,33792
v_min3_u32 v27,v27,v232,v236
v_mfma_f32_16x16x32_bf16 v[72:75],a[12:15],v[236:239],v[72:75]
ds_read_b128 v[232:235],v17 offset:20480
s_add_u32 s65,s95,65536
buffer_load_dwordx4 v16,s[20:23],s65 offen offset:0 sc1 lds
s_waitcnt lgkmcnt(5)
v_mfma_f32_16x16x32_bf16 v[64:67],a[16:19],v[240:243],v[64:67]
ds_read_b128 v[236:239],v17 offset:22528
buffer_load_dwordx4 v16,s[20:23],s65 offen offset:2048 sc1 lds
s_xor_b32 m0,s91,50176
s_add_u32 s65,s95,98304
v_min3_u32 v27,v27,v240,v244
v_mfma_f32_16x16x32_bf16 v[72:75],a[20:23],v[244:247],v[72:75]
ds_read_b128 v[240:243],v17 offset:24576
buffer_load_dwordx4 v16,s[20:23],s65 offen offset:0 sc1 lds
buffer_load_dwordx4 v16,s[20:23],s65 offen offset:2048 sc1 lds
s_waitcnt lgkmcnt(5)
v_mfma_f32_16x16x32_bf16 v[64:67],a[24:27],v[248:251],v[64:67]
ds_read_b128 v[244:247],v17 offset:26624
v_min3_u32 v27,v27,v248,v252
v_mfma_f32_16x16x32_bf16 v[72:75],a[28:31],v[252:255],v[72:75]
ds_read_b128 v[248:251],v17 offset:28672
s_waitcnt lgkmcnt(5)
v_mfma_f32_16x16x32_bf16 v[64:67],a[32:35],v[224:227],v[64:67]
ds_read_b128 v[252:255],v17 offset:30720
v_min3_u32 v27,v27,v224,v228
v_mfma_f32_16x16x32_bf16 v[72:75],a[36:39],v[228:231],v[72:75]
s_waitcnt vmcnt(17)
s_barrier
ds_read_b128 v[224:227],v17 offset:32768
s_waitcnt lgkmcnt(5)
v_mfma_f32_16x16x32_bf16 v[64:67],a[40:43],v[232:235],v[64:67]
ds_read_b128 v[228:231],v17 offset:34816
v_min3_u32 v27,v27,v232,v236
v_mfma_f32_16x16x32_bf16 v[72:75],a[44:47],v[236:239],v[72:75]
ds_read_b128 v[232:235],v17 offset:36864
s_waitcnt lgkmcnt(5)
v_mfma_f32_16x16x32_bf16 v[64:67],a[48:51],v[240:243],v[64:67]
ds_read_b128 v[236:239],v17 offset:38912
v_min3_u32 v27,v27,v240,v244
v_mfma_f32_16x16x32_bf16 v[72:75],a[52:55],v[244:247],v[72:75]
ds_read_b128 v[240:243],v17 offset:40960
s_add_u32 s88,s70,s75
s_add_u32 s88,s88,2097152
s_xor_b32 s88,s88,0x2000
s_xor_b32 s89,s88,1024
s_waitcnt lgkmcnt(5)
v_mfma_f32_16x16x32_bf16 v[64:67],a[56:59],v[248:251],v[64:67]
ds_read_b128 v[244:247],v17 offset:43008
v_min3_u32 v27,v27,v248,v252
v_mfma_f32_16x16x32_bf16 v[72:75],a[60:63],v[252:255],v[72:75]
ds_read_b128 v[248:251],v17 offset:45056
s_waitcnt lgkmcnt(5)
v_mfma_f32_16x16x32_bf16 v[64:67],a[64:67],v[224:227],v[64:67]
ds_read_b128 v[252:255],v17 offset:47104
v_min3_u32 v27,v27,v224,v228
v_mfma_f32_16x16x32_bf16 v[72:75],a[68:71],v[228:231],v[72:75]
ds_read_b128 v[224:227],v17 offset:49152
s_waitcnt lgkmcnt(5)
v_mfma_f32_16x16x32_bf16 v[64:67],a[72:75],v[232:235],v[64:67]
ds_read_b128 v[228:231],v17 offset:51200
v_min3_u32 v27,v27,v232,v236
v_mfma_f32_16x16x32_bf16 v[72:75],a[76:79],v[236:239],v[72:75]
ds_read_b128 v[232:235],v17 offset:53248
s_waitcnt lgkmcnt(5)
v_mfma_f32_16x16x32_bf16 v[64:67],a[80:83],v[240:243],v[64:67]
ds_read_b128 v[236:239],v17 offset:55296
v_min3_u32 v27,v27,v240,v244
v_mfma_f32_16x16x32_bf16 v[72:75],a[84:87],v[244:247],v[72:75]
ds_read_b128 v[240:243],v17 offset:57344
s_waitcnt lgkmcnt(5)
v_mfma_f32_16x16x32_bf16 v[64:67],a[88:91],v[248:251],v[64:67]
ds_read_b128 v[244:247],v17 offset:59392
v_min3_u32 v27,v27,v248,v252
v_mfma_f32_16x16x32_bf16 v[72:75],a[92:95],v[252:255],v[72:75]
ds_read_b128 v[248:251],v17 offset:61440
s_waitcnt vmcnt(9)
stk_407:
v_min3_u32 v22,v129,v133,v137
v_min3_u32 v22,v22,v141,v145
v_min3_u32 v22,v22,v149,v153
v_min_u32 v22,v22,v157
v_cmp_eq_u32 vcc,0,v22
s_cmp_lt_i32 s90,0
s_cselect_b64 vcc,0,vcc
s_cbranch_vccnz str_408
v_pk_add_f32 v[88:89],v[128:129],v[144:145]
v_pk_add_f32 v[90:91],v[130:131],v[146:147]
v_pk_add_f32 v[92:93],v[132:133],v[148:149]
v_pk_add_f32 v[94:95],v[134:135],v[150:151]
v_pk_add_f32 v[96:97],v[136:137],v[152:153]
v_pk_add_f32 v[98:99],v[138:139],v[154:155]
v_pk_add_f32 v[100:101],v[140:141],v[156:157]
v_pk_add_f32 v[102:103],v[142:143],v[158:159]
v_pk_add_f32 v[88:89],v[88:89],v[96:97]
v_pk_add_f32 v[90:91],v[90:91],v[98:99]
v_pk_add_f32 v[92:93],v[92:93],v[100:101]
v_pk_add_f32 v[94:95],v[94:95],v[102:103]
v_pk_add_f32 v[88:89],v[88:89],v[92:93]
v_pk_add_f32 v[90:91],v[90:91],v[94:95]
v_mov_b32 v92,v88
v_mov_b32 v93,v89
v_mov_b32 v94,v90
v_mov_b32 v95,v91
v_permlane16_swap_b32 v92,v88
v_permlane16_swap_b32 v93,v89
v_permlane16_swap_b32 v94,v90
v_permlane16_swap_b32 v95,v91
v_pk_add_f32 v[88:89],v[88:89],v[92:93]
v_pk_add_f32 v[90:91],v[90:91],v[94:95]
v_mov_b32 v92,v88
v_mov_b32 v93,v89
s_waitcnt lgkmcnt(5)
v_mfma_f32_16x16x32_bf16 v[64:67],a[96:99],v[224:227],v[64:67]
ds_read_b128 v[252:255],v17 offset:63488
v_min3_u32 v27,v27,v224,v228
v_mov_b32 v94,v90
v_mov_b32 v95,v91
v_permlane32_swap_b32 v92,v88
v_permlane32_swap_b32 v93,v89
v_permlane32_swap_b32 v94,v90
v_permlane32_swap_b32 v95,v91
v_pk_add_f32 v[88:89],v[88:89],v[92:93]
v_pk_add_f32 v[90:91],v[90:91],v[94:95]
v_mul_f32 v120,0xba800000,v88
v_mul_f32 v124,0xba800000,v90
v_mul_f32 v92,v120,v120
v_mul_f32 v93,v124,v124
v_fma_f32 v92,v89,s82,-v92
v_fma_f32 v93,v91,s82,-v93
v_max_f32 v92,0,v92
v_max_f32 v93,0,v93
v_add_f32 v92,0x3727c5ac,v92
v_add_f32 v93,0x3727c5ac,v93
v_rsq_f32 v94,v92
v_rsq_f32 v95,v93
v_mul_f32 v123,v92,v94
v_mul_f32 v127,v93,v95
v_mul_f32 v122,v28,v94
v_mul_f32 v126,v28,v95
v_mul_f32 v92,v94,v94
v_mul_f32 v93,v95,v95
v_mul_f32 v94,s81,v94
v_mul_f32 v95,s81,v95
v_mul_f32 v121,v92,v94
v_mul_f32 v125,v93,v95
ds_write_b128 v19,v[120:123] offset:0
ds_write_b128 v19,v[124:127] offset:256
v_mfma_f32_16x16x32_bf16 v[72:75],a[100:103],v[228:231],v[72:75]
s_waitcnt vmcnt(4) lgkmcnt(0)
s_barrier
ds_read_b64 v[44:45],v47
ds_read_b128 v[224:227],v17 offset:1024
v_mfma_f32_16x16x32_bf16 v[64:67],a[104:107],v[232:235],v[64:67]
ds_read_b128 v[228:231],v17 offset:3072
v_min3_u32 v27,v27,v232,v236
v_mfma_f32_16x16x32_bf16 v[72:75],a[108:111],v[236:239],v[72:75]
ds_read_b128 v[232:235],v17 offset:5120
v_mfma_f32_16x16x32_bf16 v[64:67],a[112:115],v[240:243],v[64:67]
ds_read_b128 v[236:239],v17 offset:7168
v_min3_u32 v27,v27,v240,v244
v_mfma_f32_16x16x32_bf16 v[72:75],a[116:119],v[244:247],v[72:75]
ds_read_b128 v[240:243],v17 offset:9216
s_waitcnt lgkmcnt(5)
v_readfirstlane_b32 s93,v45
v_mfma_f32_16x16x32_bf16 v[64:67],a[120:123],v[248:251],v[64:67]
ds_read_b128 v[244:247],v17 offset:11264
v_readfirstlane_b32 s83,v44
s_cmp_lg_u32 s83,0
s_cbranch_scc0 keep_403
v_min3_u32 v27,v27,v248,v252
v_mfma_f32_16x16x32_bf16 v[72:75],a[124:127],v[252:255],v[72:75]
ds_read_b128 v[248:251],v17 offset:13312
s_waitcnt lgkmcnt(5)
v_mfma_f32_16x16x32_bf16 v[68:71],a[0:3],v[224:227],0
ds_read_b128 v[252:255],v17 offset:15360
v_cmp_eq_u32 vcc,0,v27
s_cbranch_vccnz retry_392
v_min3_u32 v27,v27,v224,v228
v_mfma_f32_16x16x32_bf16 v[76:79],a[4:7],v[228:231],0
ds_read_b128 v[224:227],v17 offset:17408
s_waitcnt lgkmcnt(5)
v_mfma_f32_16x16x32_bf16 v[68:71],a[8:11],v[232:235],v[68:71]
ds_read_b128 v[228:231],v17 offset:19456
v_min3_u32 v27,v27,v232,v236
v_mfma_f32_16x16x32_bf16 v[76:79],a[12:15],v[236:239],v[76:79]
ds_read_b128 v[232:235],v17 offset:21504
s_waitcnt lgkmcnt(5)
v_mfma_f32_16x16x32_bf16 v[68:71],a[16:19],v[240:243],v[68:71]
ds_read_b128 v[236:239],v17 offset:23552
v_min3_u32 v27,v27,v240,v244
v_add_f32 v64,v64,v72
v_add_f32 v65,v65,v73
v_add_f32 v66,v66,v74
v_add_f32 v67,v67,v75
v_mfma_f32_16x16x32_bf16 v[76:79],a[20:23],v[244:247],v[76:79]
ds_read_b128 v[240:243],v17 offset:25600
v_fmac_f32 v64,v52,v120
v_fmac_f32 v65,v53,v120
v_fmac_f32 v66,v54,v120
v_fmac_f32 v67,v55,v120
s_waitcnt lgkmcnt(5)
v_mfma_f32_16x16x32_bf16 v[68:71],a[24:27],v[248:251],v[68:71]
ds_read_b128 v[244:247],v17 offset:27648
v_min3_u32 v27,v27,v248,v252
v_mul_f32 v88,v64,v64
v_mul_f32 v89,v65,v65
v_mul_f32 v90,v66,v66
v_mul_f32 v91,v67,v67
v_mfma_f32_16x16x32_bf16 v[76:79],a[28:31],v[252:255],v[76:79]
ds_read_b128 v[248:251],v17 offset:29696
v_fma_f32 v88,v88,v121,v122
v_fma_f32 v89,v89,v121,v122
v_fma_f32 v90,v90,v121,v122
v_fma_f32 v91,v91,v121,v122
s_waitcnt lgkmcnt(5)
v_mfma_f32_16x16x32_bf16 v[68:71],a[32:35],v[224:227],v[68:71]
ds_read_b128 v[252:255],v17 offset:31744
v_min3_u32 v27,v27,v224,v228
v_mul_f32 v88,v88,v64
v_mul_f32 v89,v89,v65
v_mul_f32 v90,v90,v66
v_mul_f32 v91,v91,v67
v_mfma_f32_16x16x32_bf16 v[76:79],a[36:39],v[228:231],v[76:79]
s_waitcnt vmcnt(0)
s_barrier
ds_read_b128 v[224:227],v17 offset:33792
v_exp_f32 v88,v88
s_waitcnt lgkmcnt(5)
v_mfma_f32_16x16x32_bf16 v[68:71],a[40:43],v[232:235],v[68:71]
ds_read_b128 v[228:231],v17 offset:35840
v_min3_u32 v27,v27,v232,v236
v_exp_f32 v89,v89
v_exp_f32 v90,v90
v_mfma_f32_16x16x32_bf16 v[76:79],a[44:47],v[236:239],v[76:79]
ds_read_b128 v[232:235],v17 offset:37888
v_exp_f32 v91,v91
v_fma_f32 v88,v88,v123,v123
v_fma_f32 v89,v89,v123,v123
s_waitcnt lgkmcnt(5)
v_mfma_f32_16x16x32_bf16 v[68:71],a[48:51],v[240:243],v[68:71]
ds_read_b128 v[236:239],v17 offset:39936
v_min3_u32 v27,v27,v240,v244
v_fma_f32 v90,v90,v123,v123
v_fma_f32 v91,v91,v123,v123
v_rcp_f32 v88,v88
v_mfma_f32_16x16x32_bf16 v[76:79],a[52:55],v[244:247],v[76:79]
ds_read_b128 v[240:243],v17 offset:41984
v_rcp_f32 v89,v89
v_rcp_f32 v90,v90
s_waitcnt lgkmcnt(5)
v_mfma_f32_16x16x32_bf16 v[68:71],a[56:59],v[248:251],v[68:71]
ds_read_b128 v[244:247],v17 offset:44032
v_min3_u32 v27,v27,v248,v252
v_rcp_f32 v91,v91
v_mul_f32 v88,v88,v64
v_mul_f32 v89,v89,v65
v_mfma_f32_16x16x32_bf16 v[76:79],a[60:63],v[252:255],v[76:79]
ds_read_b128 v[248:251],v17 offset:46080
v_mul_f32 v90,v90,v66
v_mul_f32 v91,v91,v67
v_cvt_pk_bf16_f32 v96,v88,v89
v_cvt_pk_bf16_f32 v97,v90,v91
s_waitcnt lgkmcnt(5)
v_mfma_f32_16x16x32_bf16 v[68:71],a[64:67],v[224:227],v[68:71]
ds_read_b128 v[252:255],v17 offset:48128
v_min3_u32 v27,v27,v224,v228
v_max_u32 v96,1,v96
buffer_store_dwordx2 v[96:97],v18,s[20:23],s70 offen offset:0 sc1
v_mfma_f32_16x16x32_bf16 v[76:79],a[68:71],v[228:231],v[76:79]
ds_read_b128 v[224:227],v17 offset:50176
s_waitcnt lgkmcnt(5)
v_mfma_f32_16x16x32_bf16 v[68:71],a[72:75],v[232:235],v[68:71]
ds_read_b128 v[228:231],v17 offset:52224
v_min3_u32 v27,v27,v232,v236
v_mfma_f32_16x16x32_bf16 v[76:79],a[76:79],v[236:239],v[76:79]
ds_read_b128 v[232:235],v17 offset:54272
s_waitcnt lgkmcnt(5)
v_mfma_f32_16x16x32_bf16 v[68:71],a[80:83],v[240:243],v[68:71]
ds_read_b128 v[236:239],v17 offset:56320
v_min3_u32 v27,v27,v240,v244
v_mfma_f32_16x16x32_bf16 v[76:79],a[84:87],v[244:247],v[76:79]
ds_read_b128 v[240:243],v17 offset:58368
s_waitcnt lgkmcnt(5)
v_mfma_f32_16x16x32_bf16 v[68:71],a[88:91],v[248:251],v[68:71]
ds_read_b128 v[244:247],v17 offset:60416
v_min3_u32 v27,v27,v248,v252
v_mfma_f32_16x16x32_bf16 v[76:79],a[92:95],v[252:255],v[76:79]
ds_read_b128 v[248:251],v17 offset:62464
s_waitcnt lgkmcnt(5)
v_mfma_f32_16x16x32_bf16 v[68:71],a[96:99],v[224:227],v[68:71]
ds_read_b128 v[252:255],v17 offset:64512
v_min3_u32 v27,v27,v224,v228
v_mfma_f32_16x16x32_bf16 v[76:79],a[100:103],v[228:231],v[76:79]
s_waitcnt lgkmcnt(4)
v_mfma_f32_16x16x32_bf16 v[68:71],a[104:107],v[232:235],v[68:71]
v_min3_u32 v27,v27,v232,v236
v_mfma_f32_16x16x32_bf16 v[76:79],a[108:111],v[236:239],v[76:79]
s_waitcnt lgkmcnt(2)
v_mfma_f32_16x16x32_bf16 v[68:71],a[112:115],v[240:243],v[68:71]
v_min3_u32 v27,v27,v240,v244
v_mfma_f32_16x16x32_bf16 v[76:79],a[116:119],v[244:247],v[76:79]
s_waitcnt lgkmcnt(0)
v_mfma_f32_16x16x32_bf16 v[68:71],a[120:123],v[248:251],v[68:71]
v_min3_u32 v27,v27,v248,v252
v_mfma_f32_16x16x32_bf16 v[76:79],a[124:127],v[252:255],v[76:79]
v_cmp_eq_u32 vcc,0,v27
s_cbranch_vccnz retry_392
s_branch epi_395
keep_403:
v_min3_u32 v27,v27,v248,v252
v_mfma_f32_16x16x32_bf16 v[72:75],a[124:127],v[252:255],v[72:75]
ds_read_b128 v[248:251],v17 offset:13312
s_add_u32 s66,s88,110592
buffer_load_dwordx4 v[128:131],v16,s[20:23],s66 offen offset:0 sc1
buffer_load_dwordx4 v[132:135],v16,s[20:23],s66 offen offset:1024 sc1
s_waitcnt lgkmcnt(5)
v_mfma_f32_16x16x32_bf16 v[68:71],a[0:3],v[224:227],0
ds_read_b128 v[252:255],v17 offset:15360
v_cmp_eq_u32 vcc,0,v27
s_cbranch_vccnz retry_392
v_min3_u32 v27,v27,v224,v228
buffer_load_dwordx4 v[136:139],v16,s[20:23],s66 offen offset:2048 sc1
buffer_load_dwordx4 v[140:143],v16,s[20:23],s66 offen offset:3072 sc1
v_mfma_f32_16x16x32_bf16 v[76:79],a[4:7],v[228:231],0
ds_read_b128 v[224:227],v17 offset:17408
s_add_u32 s66,s88,114688
buffer_load_dwordx4 v[144:147],v16,s[20:23],s66 offen offset:0 sc1
buffer_load_dwordx4 v[148:151],v16,s[20:23],s66 offen offset:1024 sc1
s_waitcnt lgkmcnt(5)
v_mfma_f32_16x16x32_bf16 v[68:71],a[8:11],v[232:235],v[68:71]
ds_read_b128 v[228:231],v17 offset:19456
v_min3_u32 v27,v27,v232,v236
buffer_load_dwordx4 v[152:155],v16,s[20:23],s66 offen offset:2048 sc1
buffer_load_dwordx4 v[156:159],v16,s[20:23],s66 offen offset:3072 sc1
v_mfma_f32_16x16x32_bf16 v[76:79],a[12:15],v[236:239],v[76:79]
ds_read_b128 v[232:235],v17 offset:21504
s_xor_b32 m0,s72,0
s_add_u32 s65,s88,0
s_waitcnt lgkmcnt(5)
v_mfma_f32_16x16x32_bf16 v[68:71],a[16:19],v[240:243],v[68:71]
ds_read_b128 v[236:239],v17 offset:23552
v_min3_u32 v27,v27,v240,v244
v_add_f32 v64,v64,v72
v_add_f32 v65,v65,v73
v_add_f32 v66,v66,v74
v_add_f32 v67,v67,v75
buffer_load_dwordx4 v16,s[20:23],s65 offen offset:0 sc1 lds
v_mfma_f32_16x16x32_bf16 v[76:79],a[20:23],v[244:247],v[76:79]
ds_read_b128 v[240:243],v17 offset:25600
v_fmac_f32 v64,v52,v120
v_fmac_f32 v65,v53,v120
v_fmac_f32 v66,v54,v120
v_fmac_f32 v67,v55,v120
buffer_load_dwordx4 v16,s[20:23],s65 offen offset:2048 sc1 lds
s_waitcnt lgkmcnt(5)
v_mfma_f32_16x16x32_bf16 v[68:71],a[24:27],v[248:251],v[68:71]
ds_read_b128 v[244:247],v17 offset:27648
v_min3_u32 v27,v27,v248,v252
v_mul_f32 v88,v64,v64
v_mul_f32 v89,v65,v65
v_mul_f32 v90,v66,v66
v_mul_f32 v91,v67,v67
s_xor_b32 m0,s72,16384
s_add_u32 s65,s88,32768
v_mfma_f32_16x16x32_bf16 v[76:79],a[28:31],v[252:255],v[76:79]
ds_read_b128 v[248:251],v17 offset:29696
v_fma_f32 v88,v88,v121,v122
v_fma_f32 v89,v89,v121,v122
v_fma_f32 v90,v90,v121,v122
v_fma_f32 v91,v91,v121,v122
buffer_load_dwordx4 v16,s[20:23],s65 offen offset:0 sc1 lds
s_waitcnt lgkmcnt(5)
v_mfma_f32_16x16x32_bf16 v[68:71],a[32:35],v[224:227],v[68:71]
ds_read_b128 v[252:255],v17 offset:31744
v_min3_u32 v27,v27,v224,v228
v_mul_f32 v88,v88,v64
v_mul_f32 v89,v89,v65
v_mul_f32 v90,v90,v66
v_mul_f32 v91,v91,v67
buffer_load_dwordx4 v16,s[20:23],s65 offen offset:2048 sc1 lds
v_mfma_f32_16x16x32_bf16 v[76:79],a[36:39],v[228:231],v[76:79]
s_waitcnt vmcnt(12)
s_barrier
ds_read_b128 v[224:227],v17 offset:33792
v_exp_f32 v88,v88
s_xor_b32 m0,s72,32768
s_add_u32 s65,s88,65536
s_waitcnt lgkmcnt(5)
v_mfma_f32_16x16x32_bf16 v[68:71],a[40:43],v[232:235],v[68:71]
ds_read_b128 v[228:231],v17 offset:35840
v_min3_u32 v27,v27,v232,v236
v_exp_f32 v89,v89
v_exp_f32 v90,v90
buffer_load_dwordx4 v16,s[20:23],s65 offen offset:0 sc1 lds
v_mfma_f32_16x16x32_bf16 v[76:79],a[44:47],v[236:239],v[76:79]
ds_read_b128 v[232:235],v17 offset:37888
v_exp_f32 v91,v91
v_fma_f32 v88,v88,v123,v123
v_fma_f32 v89,v89,v123,v123
buffer_load_dwordx4 v16,s[20:23],s65 offen offset:2048 sc1 lds
s_waitcnt lgkmcnt(5)
v_mfma_f32_16x16x32_bf16 v[68:71],a[48:51],v[240:243],v[68:71]
ds_read_b128 v[236:239],v17 offset:39936
v_min3_u32 v27,v27,v240,v244
v_fma_f32 v90,v90,v123,v123
v_fma_f32 v91,v91,v123,v123
v_rcp_f32 v88,v88
s_xor_b32 m0,s72,49152
s_add_u32 s65,s88,98304
v_mfma_f32_16x16x32_bf16 v[76:79],a[52:55],v[244:247],v[76:79]
ds_read_b128 v[240:243],v17 offset:41984
v_rcp_f32 v89,v89
v_rcp_f32 v90,v90
buffer_load_dwordx4 v16,s[20:23],s65 offen offset:0 sc1 lds
s_waitcnt lgkmcnt(5)
v_mfma_f32_16x16x32_bf16 v[68:71],a[56:59],v[248:251],v[68:71]
ds_read_b128 v[244:247],v17 offset:44032
v_min3_u32 v27,v27,v248,v252
v_rcp_f32 v91,v91
v_mul_f32 v88,v88,v64
v_mul_f32 v89,v89,v65
buffer_load_dwordx4 v16,s[20:23],s65 offen offset:2048 sc1 lds
v_mfma_f32_16x16x32_bf16 v[76:79],a[60:63],v[252:255],v[76:79]
ds_read_b128 v[248:251],v17 offset:46080
v_mul_f32 v90,v90,v66
v_mul_f32 v91,v91,v67
v_cvt_pk_bf16_f32 v96,v88,v89
v_cvt_pk_bf16_f32 v97,v90,v91
s_waitcnt lgkmcnt(5)
v_mfma_f32_16x16x32_bf16 v[68:71],a[64:67],v[224:227],v[68:71]
ds_read_b128 v[252:255],v17 offset:48128
v_min3_u32 v27,v27,v224,v228
v_max_u32 v96,1,v96
buffer_store_dwordx2 v[96:97],v18,s[20:23],s70 offen offset:0 sc1
s_xor_b32 m0,s72,1024
v_mfma_f32_16x16x32_bf16 v[76:79],a[68:71],v[228:231],v[76:79]
ds_read_b128 v[224:227],v17 offset:50176
s_add_u32 s65,s89,0
buffer_load_dwordx4 v16,s[20:23],s65 offen offset:0 sc1 lds
s_waitcnt lgkmcnt(5)
v_mfma_f32_16x16x32_bf16 v[68:71],a[72:75],v[232:235],v[68:71]
ds_read_b128 v[228:231],v17 offset:52224
v_min3_u32 v27,v27,v232,v236
buffer_load_dwordx4 v16,s[20:23],s65 offen offset:2048 sc1 lds
s_xor_b32 m0,s72,17408
s_add_u32 s65,s89,32768
v_mfma_f32_16x16x32_bf16 v[76:79],a[76:79],v[236:239],v[76:79]
ds_read_b128 v[232:235],v17 offset:54272
buffer_load_dwordx4 v16,s[20:23],s65 offen offset:0 sc1 lds
buffer_load_dwordx4 v16,s[20:23],s65 offen offset:2048 sc1 lds
s_waitcnt lgkmcnt(5)
v_mfma_f32_16x16x32_bf16 v[68:71],a[80:83],v[240:243],v[68:71]
ds_read_b128 v[236:239],v17 offset:56320
v_min3_u32 v27,v27,v240,v244
s_xor_b32 m0,s72,33792
s_add_u32 s65,s89,65536
buffer_load_dwordx4 v16,s[20:23],s65 offen offset:0 sc1 lds
v_mfma_f32_16x16x32_bf16 v[76:79],a[84:87],v[244:247],v[76:79]
ds_read_b128 v[240:243],v17 offset:58368
buffer_load_dwordx4 v16,s[20:23],s65 offen offset:2048 sc1 lds
s_xor_b32 m0,s72,50176
s_add_u32 s65,s89,98304
s_waitcnt lgkmcnt(5)
v_mfma_f32_16x16x32_bf16 v[68:71],a[88:91],v[248:251],v[68:71]
ds_read_b128 v[244:247],v17 offset:60416
v_min3_u32 v27,v27,v248,v252
buffer_load_dwordx4 v16,s[20:23],s65 offen offset:0 sc1 lds
buffer_load_dwordx4 v16,s[20:23],s65 offen offset:2048 sc1 lds
v_mfma_f32_16x16x32_bf16 v[76:79],a[92:95],v[252:255],v[76:79]
ds_read_b128 v[248:251],v17 offset:62464
s_waitcnt lgkmcnt(5)
v_mfma_f32_16x16x32_bf16 v[68:71],a[96:99],v[224:227],v[68:71]
ds_read_b128 v[252:255],v17 offset:64512
v_min3_u32 v27,v27,v224,v228
v_mfma_f32_16x16x32_bf16 v[76:79],a[100:103],v[228:231],v[76:79]
s_waitcnt lgkmcnt(4)
v_mfma_f32_16x16x32_bf16 v[68:71],a[104:107],v[232:235],v[68:71]
v_min3_u32 v27,v27,v232,v236
v_mfma_f32_16x16x32_bf16 v[76:79],a[108:111],v[236:239],v[76:79]
s_waitcnt lgkmcnt(2)
v_mfma_f32_16x16x32_bf16 v[68:71],a[112:115],v[240:243],v[68:71]
v_min3_u32 v27,v27,v240,v244
v_mfma_f32_16x16x32_bf16 v[76:79],a[116:119],v[244:247],v[76:79]
s_waitcnt lgkmcnt(0)
v_mfma_f32_16x16x32_bf16 v[68:71],a[120:123],v[248:251],v[68:71]
v_min3_u32 v27,v27,v248,v252
v_mfma_f32_16x16x32_bf16 v[76:79],a[124:127],v[252:255],v[76:79]
v_cmp_eq_u32 vcc,0,v27
s_cbranch_vccnz retry_392
s_branch epi_395
ahead_394:
s_cmp_eq_u32 s93,0
s_cbranch_scc1 both_396
s_waitcnt vmcnt(11) lgkmcnt(0)
s_barrier
ds_read_b128 v[224:227],v17 offset:0
ds_read_b128 v[228:231],v17 offset:2048
ds_read_b128 v[232:235],v17 offset:4096
ds_read_b128 v[236:239],v17 offset:6144
ds_read_b128 v[240:243],v17 offset:8192
ds_read_b128 v[244:247],v17 offset:10240
ds_read_b128 v[248:251],v17 offset:12288
s_waitcnt lgkmcnt(5)
v_mfma_f32_16x16x32_bf16 v[64:67],a[0:3],v[224:227],0
ds_read_b128 v[252:255],v17 offset:14336
v_min_u32 v27,v224,v228
s_waitcnt vmcnt(12)
stk_409:
v_min3_u32 v22,v129,v133,v137
v_min3_u32 v22,v22,v141,v145
v_min3_u32 v22,v22,v149,v153
v_min_u32 v22,v22,v157
v_cmp_eq_u32 vcc,0,v22
s_cmp_lt_i32 s90,0
s_cselect_b64 vcc,0,vcc
s_cbranch_vccnz str_410
v_mfma_f32_16x16x32_bf16 v[72:75],a[4:7],v[228:231],0
ds_read_b128 v[224:227],v17 offset:16384
v_pk_add_f32 v[88:89],v[128:129],v[144:145]
v_pk_add_f32 v[90:91],v[130:131],v[146:147]
v_pk_add_f32 v[92:93],v[132:133],v[148:149]
v_pk_add_f32 v[94:95],v[134:135],v[150:151]
s_waitcnt lgkmcnt(5)
v_mfma_f32_16x16x32_bf16 v[64:67],a[8:11],v[232:235],v[64:67]
ds_read_b128 v[228:231],v17 offset:18432
v_min3_u32 v27,v27,v232,v236
v_pk_add_f32 v[96:97],v[136:137],v[152:153]
v_pk_add_f32 v[98:99],v[138:139],v[154:155]
v_pk_add_f32 v[100:101],v[140:141],v[156:157]
v_pk_add_f32 v[102:103],v[142:143],v[158:159]
v_mfma_f32_16x16x32_bf16 v[72:75],a[12:15],v[236:239],v[72:75]
ds_read_b128 v[232:235],v17 offset:20480
s_waitcnt lgkmcnt(5)
v_mfma_f32_16x16x32_bf16 v[64:67],a[16:19],v[240:243],v[64:67]
ds_read_b128 v[236:239],v17 offset:22528
v_min3_u32 v27,v27,v240,v244
v_pk_add_f32 v[88:89],v[88:89],v[96:97]
v_pk_add_f32 v[90:91],v[90:91],v[98:99]
v_pk_add_f32 v[92:93],v[92:93],v[100:101]
v_mfma_f32_16x16x32_bf16 v[72:75],a[20:23],v[244:247],v[72:75]
ds_read_b128 v[240:243],v17 offset:24576
v_pk_add_f32 v[94:95],v[94:95],v[102:103]
v_pk_add_f32 v[88:89],v[88:89],v[92:93]
v_pk_add_f32 v[90:91],v[90:91],v[94:95]
s_waitcnt lgkmcnt(5)
v_mfma_f32_16x16x32_bf16 v[64:67],a[24:27],v[248:251],v[64:67]
ds_read_b128 v[244:247],v17 offset:26624
v_min3_u32 v27,v27,v248,v252
v_mov_b32 v92,v88
v_mov_b32 v93,v89
v_mov_b32 v94,v90
v_mfma_f32_16x16x32_bf16 v[72:75],a[28:31],v[252:255],v[72:75]
ds_read_b128 v[248:251],v17 offset:28672
v_mov_b32 v95,v91
v_permlane16_swap_b32 v92,v88
v_permlane16_swap_b32 v93,v89
s_waitcnt lgkmcnt(5)
v_mfma_f32_16x16x32_bf16 v[64:67],a[32:35],v[224:227],v[64:67]
ds_read_b128 v[252:255],v17 offset:30720
v_min3_u32 v27,v27,v224,v228
v_permlane16_swap_b32 v94,v90
v_permlane16_swap_b32 v95,v91
v_mfma_f32_16x16x32_bf16 v[72:75],a[36:39],v[228:231],v[72:75]
ds_read_b128 v[224:227],v17 offset:32768
v_pk_add_f32 v[88:89],v[88:89],v[92:93]
v_pk_add_f32 v[90:91],v[90:91],v[94:95]
v_mov_b32 v92,v88
s_waitcnt lgkmcnt(5)
v_mfma_f32_16x16x32_bf16 v[64:67],a[40:43],v[232:235],v[64:67]
ds_read_b128 v[228:231],v17 offset:34816
v_min3_u32 v27,v27,v232,v236
v_mov_b32 v93,v89
v_mov_b32 v94,v90
v_mov_b32 v95,v91
v_mfma_f32_16x16x32_bf16 v[72:75],a[44:47],v[236:239],v[72:75]
ds_read_b128 v[232:235],v17 offset:36864
v_permlane32_swap_b32 v92,v88
v_permlane32_swap_b32 v93,v89
v_permlane32_swap_b32 v94,v90
s_waitcnt lgkmcnt(5)
v_mfma_f32_16x16x32_bf16 v[64:67],a[48:51],v[240:243],v[64:67]
ds_read_b128 v[236:239],v17 offset:38912
v_min3_u32 v27,v27,v240,v244
v_permlane32_swap_b32 v95,v91
v_pk_add_f32 v[88:89],v[88:89],v[92:93]
v_mfma_f32_16x16x32_bf16 v[72:75],a[52:55],v[244:247],v[72:75]
ds_read_b128 v[240:243],v17 offset:40960
v_pk_add_f32 v[90:91],v[90:91],v[94:95]
v_mul_f32 v120,0xba800000,v88
v_mul_f32 v124,0xba800000,v90
s_add_u32 s88,s70,s75
s_waitcnt lgkmcnt(5)
v_mfma_f32_16x16x32_bf16 v[64:67],a[56:59],v[248:251],v[64:67]
ds_read_b128 v[244:247],v17 offset:43008
v_min3_u32 v27,v27,v248,v252
v_mul_f32 v92,v120,v120
v_mul_f32 v93,v124,v124
v_fma_f32 v92,v89,s82,-v92
s_add_u32 s88,s88,2097152
v_mfma_f32_16x16x32_bf16 v[72:75],a[60:63],v[252:255],v[72:75]
ds_read_b128 v[248:251],v17 offset:45056
v_fma_f32 v93,v91,s82,-v93
v_max_f32 v92,0,v92
v_max_f32 v93,0,v93
s_xor_b32 s88,s88,0x2000
s_waitcnt lgkmcnt(5)
v_mfma_f32_16x16x32_bf16 v[64:67],a[64:67],v[224:227],v[64:67]
ds_read_b128 v[252:255],v17 offset:47104
v_min3_u32 v27,v27,v224,v228
v_add_f32 v92,0x3727c5ac,v92
v_add_f32 v93,0x3727c5ac,v93
v_rsq_f32 v94,v92
v_mfma_f32_16x16x32_bf16 v[72:75],a[68:71],v[228:231],v[72:75]
ds_read_b128 v[224:227],v17 offset:49152
v_rsq_f32 v95,v93
v_mul_f32 v123,v92,v94
s_xor_b32 s89,s88,1024
s_waitcnt lgkmcnt(5)
v_mfma_f32_16x16x32_bf16 v[64:67],a[72:75],v[232:235],v[64:67]
ds_read_b128 v[228:231],v17 offset:51200
v_min3_u32 v27,v27,v232,v236
v_mul_f32 v127,v93,v95
v_mul_f32 v122,v28,v94
v_mul_f32 v126,v28,v95
v_mfma_f32_16x16x32_bf16 v[72:75],a[76:79],v[236:239],v[72:75]
ds_read_b128 v[232:235],v17 offset:53248
v_mul_f32 v92,v94,v94
v_mul_f32 v93,v95,v95
v_mul_f32 v94,s81,v94
s_waitcnt lgkmcnt(5)
v_mfma_f32_16x16x32_bf16 v[64:67],a[80:83],v[240:243],v[64:67]
ds_read_b128 v[236:239],v17 offset:55296
v_min3_u32 v27,v27,v240,v244
v_mul_f32 v95,s81,v95
v_mul_f32 v121,v92,v94
v_mul_f32 v125,v93,v95
v_mfma_f32_16x16x32_bf16 v[72:75],a[84:87],v[244:247],v[72:75]
ds_read_b128 v[240:243],v17 offset:57344
ds_write_b128 v19,v[120:123] offset:0
ds_write_b128 v19,v[124:127] offset:256
s_waitcnt lgkmcnt(7)
v_mfma_f32_16x16x32_bf16 v[64:67],a[88:91],v[248:251],v[64:67]
ds_read_b128 v[244:247],v17 offset:59392
v_min3_u32 v27,v27,v248,v252
v_mfma_f32_16x16x32_bf16 v[72:75],a[92:95],v[252:255],v[72:75]
ds_read_b128 v[248:251],v17 offset:61440
s_waitcnt lgkmcnt(7)
v_mfma_f32_16x16x32_bf16 v[64:67],a[96:99],v[224:227],v[64:67]
ds_read_b128 v[252:255],v17 offset:63488
v_min3_u32 v27,v27,v224,v228
v_mfma_f32_16x16x32_bf16 v[72:75],a[100:103],v[228:231],v[72:75]
s_waitcnt vmcnt(3) lgkmcnt(0)
s_barrier
ds_read_b64 v[44:45],v47
ds_read_b128 v[224:227],v17 offset:1024
s_waitcnt vmcnt(0)
v_add_u32 v22,s71,-1
v_mfma_f32_16x16x32_bf16 v[64:67],a[104:107],v[232:235],v[64:67]
ds_read_b128 v[228:231],v17 offset:3072
v_min3_u32 v27,v27,v232,v236
buffer_store_dword v22,v23,s[20:23],s97 offen sc1
s_mov_b32 s97,0x7fff0000
v_mfma_f32_16x16x32_bf16 v[72:75],a[108:111],v[236:239],v[72:75]
ds_read_b128 v[232:235],v17 offset:5120
v_mfma_f32_16x16x32_bf16 v[64:67],a[112:115],v[240:243],v[64:67]
ds_read_b128 v[236:239],v17 offset:7168
v_min3_u32 v27,v27,v240,v244
v_mfma_f32_16x16x32_bf16 v[72:75],a[116:119],v[244:247],v[72:75]
ds_read_b128 v[240:243],v17 offset:9216
s_waitcnt lgkmcnt(5)
v_readfirstlane_b32 s93,v45
v_mfma_f32_16x16x32_bf16 v[64:67],a[120:123],v[248:251],v[64:67]
ds_read_b128 v[244:247],v17 offset:11264
v_readfirstlane_b32 s83,v44
s_cmp_lg_u32 s83,0
s_cbranch_scc1 keep_404
v_min3_u32 v27,v27,v248,v252
v_mfma_f32_16x16x32_bf16 v[72:75],a[124:127],v[252:255],v[72:75]
ds_read_b128 v[248:251],v17 offset:13312
s_add_u32 s66,s88,110592
buffer_load_dwordx4 v[128:131],v16,s[20:23],s66 offen offset:0 sc1
buffer_load_dwordx4 v[132:135],v16,s[20:23],s66 offen offset:1024 sc1
s_waitcnt lgkmcnt(5)
v_mfma_f32_16x16x32_bf16 v[68:71],a[0:3],v[224:227],0
ds_read_b128 v[252:255],v17 offset:15360
v_cmp_eq_u32 vcc,0,v27
s_cbranch_vccnz retry_392
v_min3_u32 v27,v27,v224,v228
buffer_load_dwordx4 v[136:139],v16,s[20:23],s66 offen offset:2048 sc1
buffer_load_dwordx4 v[140:143],v16,s[20:23],s66 offen offset:3072 sc1
v_mfma_f32_16x16x32_bf16 v[76:79],a[4:7],v[228:231],0
ds_read_b128 v[224:227],v17 offset:17408
s_add_u32 s66,s88,114688
buffer_load_dwordx4 v[144:147],v16,s[20:23],s66 offen offset:0 sc1
buffer_load_dwordx4 v[148:151],v16,s[20:23],s66 offen offset:1024 sc1
s_waitcnt lgkmcnt(5)
v_mfma_f32_16x16x32_bf16 v[68:71],a[8:11],v[232:235],v[68:71]
ds_read_b128 v[228:231],v17 offset:19456
v_min3_u32 v27,v27,v232,v236
buffer_load_dwordx4 v[152:155],v16,s[20:23],s66 offen offset:2048 sc1
buffer_load_dwordx4 v[156:159],v16,s[20:23],s66 offen offset:3072 sc1
v_mfma_f32_16x16x32_bf16 v[76:79],a[12:15],v[236:239],v[76:79]
ds_read_b128 v[232:235],v17 offset:21504
s_xor_b32 m0,s72,0
s_add_u32 s65,s88,0
s_waitcnt lgkmcnt(5)
v_mfma_f32_16x16x32_bf16 v[68:71],a[16:19],v[240:243],v[68:71]
ds_read_b128 v[236:239],v17 offset:23552
v_min3_u32 v27,v27,v240,v244
v_add_f32 v64,v64,v72
v_add_f32 v65,v65,v73
v_add_f32 v66,v66,v74
v_add_f32 v67,v67,v75
buffer_load_dwordx4 v16,s[20:23],s65 offen offset:0 sc1 lds
v_mfma_f32_16x16x32_bf16 v[76:79],a[20:23],v[244:247],v[76:79]
ds_read_b128 v[240:243],v17 offset:25600
v_fmac_f32 v64,v52,v120
v_fmac_f32 v65,v53,v120
v_fmac_f32 v66,v54,v120
v_fmac_f32 v67,v55,v120
buffer_load_dwordx4 v16,s[20:23],s65 offen offset:2048 sc1 lds
s_waitcnt lgkmcnt(5)
v_mfma_f32_16x16x32_bf16 v[68:71],a[24:27],v[248:251],v[68:71]
ds_read_b128 v[244:247],v17 offset:27648
v_min3_u32 v27,v27,v248,v252
v_mul_f32 v88,v64,v64
v_mul_f32 v89,v65,v65
v_mul_f32 v90,v66,v66
v_mul_f32 v91,v67,v67
s_xor_b32 m0,s72,16384
s_add_u32 s65,s88,32768
v_mfma_f32_16x16x32_bf16 v[76:79],a[28:31],v[252:255],v[76:79]
ds_read_b128 v[248:251],v17 offset:29696
v_fma_f32 v88,v88,v121,v122
v_fma_f32 v89,v89,v121,v122
v_fma_f32 v90,v90,v121,v122
v_fma_f32 v91,v91,v121,v122
buffer_load_dwordx4 v16,s[20:23],s65 offen offset:0 sc1 lds
s_waitcnt lgkmcnt(5)
v_mfma_f32_16x16x32_bf16 v[68:71],a[32:35],v[224:227],v[68:71]
ds_read_b128 v[252:255],v17 offset:31744
v_min3_u32 v27,v27,v224,v228
v_mul_f32 v88,v88,v64
v_mul_f32 v89,v89,v65
v_mul_f32 v90,v90,v66
v_mul_f32 v91,v91,v67
buffer_load_dwordx4 v16,s[20:23],s65 offen offset:2048 sc1 lds
v_mfma_f32_16x16x32_bf16 v[76:79],a[36:39],v[228:231],v[76:79]
ds_read_b128 v[224:227],v17 offset:33792
v_exp_f32 v88,v88
v_exp_f32 v89,v89
s_xor_b32 m0,s72,32768
s_add_u32 s65,s88,65536
s_waitcnt lgkmcnt(5)
v_mfma_f32_16x16x32_bf16 v[68:71],a[40:43],v[232:235],v[68:71]
ds_read_b128 v[228:231],v17 offset:35840
v_min3_u32 v27,v27,v232,v236
v_exp_f32 v90,v90
v_exp_f32 v91,v91
buffer_load_dwordx4 v16,s[20:23],s65 offen offset:0 sc1 lds
v_mfma_f32_16x16x32_bf16 v[76:79],a[44:47],v[236:239],v[76:79]
ds_read_b128 v[232:235],v17 offset:37888
v_fma_f32 v88,v88,v123,v123
v_fma_f32 v89,v89,v123,v123
v_fma_f32 v90,v90,v123,v123
v_fma_f32 v91,v91,v123,v123
buffer_load_dwordx4 v16,s[20:23],s65 offen offset:2048 sc1 lds
s_waitcnt lgkmcnt(5)
v_mfma_f32_16x16x32_bf16 v[68:71],a[48:51],v[240:243],v[68:71]
ds_read_b128 v[236:239],v17 offset:39936
v_min3_u32 v27,v27,v240,v244
v_rcp_f32 v88,v88
v_rcp_f32 v89,v89
s_xor_b32 m0,s72,49152
s_add_u32 s65,s88,98304
v_mfma_f32_16x16x32_bf16 v[76:79],a[52:55],v[244:247],v[76:79]
ds_read_b128 v[240:243],v17 offset:41984
v_rcp_f32 v90,v90
v_rcp_f32 v91,v91
buffer_load_dwordx4 v16,s[20:23],s65 offen offset:0 sc1 lds
s_waitcnt lgkmcnt(5)
v_mfma_f32_16x16x32_bf16 v[68:71],a[56:59],v[248:251],v[68:71]
ds_read_b128 v[244:247],v17 offset:44032
v_min3_u32 v27,v27,v248,v252
v_mul_f32 v88,v88,v64
v_mul_f32 v89,v89,v65
v_mul_f32 v90,v90,v66
v_mul_f32 v91,v91,v67
v_mfma_f32_16x16x32_bf16 v[76:79],a[60:63],v[252:255],v[76:79]
ds_read_b128 v[248:251],v17 offset:46080
v_cvt_pk_bf16_f32 v96,v88,v89
v_cvt_pk_bf16_f32 v97,v90,v91
v_max_u32 v96,1,v96
s_waitcnt lgkmcnt(5)
v_mfma_f32_16x16x32_bf16 v[68:71],a[64:67],v[224:227],v[68:71]
ds_read_b128 v[252:255],v17 offset:48128
v_min3_u32 v27,v27,v224,v228
buffer_store_dwordx2 v[96:97],v18,s[20:23],s70 offen offset:0 sc1
buffer_load_dwordx4 v16,s[20:23],s65 offen offset:2048 sc1 lds
v_mfma_f32_16x16x32_bf16 v[76:79],a[68:71],v[228:231],v[76:79]
ds_read_b128 v[224:227],v17 offset:50176
s_xor_b32 m0,s72,1024
s_add_u32 s65,s89,0
buffer_load_dwordx4 v16,s[20:23],s65 offen offset:0 sc1 lds
s_waitcnt lgkmcnt(5)
v_mfma_f32_16x16x32_bf16 v[68:71],a[72:75],v[232:235],v[68:71]
ds_read_b128 v[228:231],v17 offset:52224
v_min3_u32 v27,v27,v232,v236
buffer_load_dwordx4 v16,s[20:23],s65 offen offset:2048 sc1 lds
s_xor_b32 m0,s72,17408
s_add_u32 s65,s89,32768
v_mfma_f32_16x16x32_bf16 v[76:79],a[76:79],v[236:239],v[76:79]
ds_read_b128 v[232:235],v17 offset:54272
buffer_load_dwordx4 v16,s[20:23],s65 offen offset:0 sc1 lds
buffer_load_dwordx4 v16,s[20:23],s65 offen offset:2048 sc1 lds
s_waitcnt lgkmcnt(5)
v_mfma_f32_16x16x32_bf16 v[68:71],a[80:83],v[240:243],v[68:71]
ds_read_b128 v[236:239],v17 offset:56320
v_min3_u32 v27,v27,v240,v244
s_xor_b32 m0,s72,33792
s_add_u32 s65,s89,65536
buffer_load_dwordx4 v16,s[20:23],s65 offen offset:0 sc1 lds
v_mfma_f32_16x16x32_bf16 v[76:79],a[84:87],v[244:247],v[76:79]
ds_read_b128 v[240:243],v17 offset:58368
buffer_load_dwordx4 v16,s[20:23],s65 offen offset:2048 sc1 lds
s_xor_b32 m0,s72,50176
s_add_u32 s65,s89,98304
s_waitcnt lgkmcnt(5)
v_mfma_f32_16x16x32_bf16 v[68:71],a[88:91],v[248:251],v[68:71]
ds_read_b128 v[244:247],v17 offset:60416
v_min3_u32 v27,v27,v248,v252
buffer_load_dwordx4 v16,s[20:23],s65 offen offset:0 sc1 lds
buffer_load_dwordx4 v16,s[20:23],s65 offen offset:2048 sc1 lds
v_mfma_f32_16x16x32_bf16 v[76:79],a[92:95],v[252:255],v[76:79]
ds_read_b128 v[248:251],v17 offset:62464
s_waitcnt lgkmcnt(5)
v_mfma_f32_16x16x32_bf16 v[68:71],a[96:99],v[224:227],v[68:71]
ds_read_b128 v[252:255],v17 offset:64512
v_min3_u32 v27,v27,v224,v228
v_mfma_f32_16x16x32_bf16 v[76:79],a[100:103],v[228:231],v[76:79]
s_waitcnt lgkmcnt(4)
v_mfma_f32_16x16x32_bf16 v[68:71],a[104:107],v[232:235],v[68:71]
v_min3_u32 v27,v27,v232,v236
v_mfma_f32_16x16x32_bf16 v[76:79],a[108:111],v[236:239],v[76:79]
s_waitcnt lgkmcnt(2)
v_mfma_f32_16x16x32_bf16 v[68:71],a[112:115],v[240:243],v[68:71]
v_min3_u32 v27,v27,v240,v244
v_mfma_f32_16x16x32_bf16 v[76:79],a[116:119],v[244:247],v[76:79]
s_waitcnt lgkmcnt(0)
v_mfma_f32_16x16x32_bf16 v[68:71],a[120:123],v[248:251],v[68:71]
v_min3_u32 v27,v27,v248,v252
v_mfma_f32_16x16x32_bf16 v[76:79],a[124:127],v[252:255],v[76:79]
v_cmp_eq_u32 vcc,0,v27
s_cbranch_vccnz retry_392
s_branch epi_395
keep_404:
v_min3_u32 v27,v27,v248,v252
v_mfma_f32_16x16x32_bf16 v[72:75],a[124:127],v[252:255],v[72:75]
ds_read_b128 v[248:251],v17 offset:13312
s_waitcnt lgkmcnt(5)
v_mfma_f32_16x16x32_bf16 v[68:71],a[0:3],v[224:227],0
ds_read_b128 v[252:255],v17 offset:15360
v_cmp_eq_u32 vcc,0,v27
s_cbranch_vccnz retry_392
v_min3_u32 v27,v27,v224,v228
v_mfma_f32_16x16x32_bf16 v[76:79],a[4:7],v[228:231],0
ds_read_b128 v[224:227],v17 offset:17408
s_waitcnt lgkmcnt(5)
v_mfma_f32_16x16x32_bf16 v[68:71],a[8:11],v[232:235],v[68:71]
ds_read_b128 v[228:231],v17 offset:19456
v_min3_u32 v27,v27,v232,v236
v_mfma_f32_16x16x32_bf16 v[76:79],a[12:15],v[236:239],v[76:79]
ds_read_b128 v[232:235],v17 offset:21504
s_waitcnt lgkmcnt(5)
v_mfma_f32_16x16x32_bf16 v[68:71],a[16:19],v[240:243],v[68:71]
ds_read_b128 v[236:239],v17 offset:23552
v_min3_u32 v27,v27,v240,v244
v_add_f32 v64,v64,v72
v_add_f32 v65,v65,v73
v_add_f32 v66,v66,v74
v_add_f32 v67,v67,v75
v_mfma_f32_16x16x32_bf16 v[76:79],a[20:23],v[244:247],v[76:79]
ds_read_b128 v[240:243],v17 offset:25600
v_fmac_f32 v64,v52,v120
v_fmac_f32 v65,v53,v120
v_fmac_f32 v66,v54,v120
v_fmac_f32 v67,v55,v120
s_waitcnt lgkmcnt(5)
v_mfma_f32_16x16x32_bf16 v[68:71],a[24:27],v[248:251],v[68:71]
ds_read_b128 v[244:247],v17 offset:27648
v_min3_u32 v27,v27,v248,v252
v_mul_f32 v88,v64,v64
v_mul_f32 v89,v65,v65
v_mul_f32 v90,v66,v66
v_mul_f32 v91,v67,v67
v_mfma_f32_16x16x32_bf16 v[76:79],a[28:31],v[252:255],v[76:79]
ds_read_b128 v[248:251],v17 offset:29696
v_fma_f32 v88,v88,v121,v122
v_fma_f32 v89,v89,v121,v122
v_fma_f32 v90,v90,v121,v122
v_fma_f32 v91,v91,v121,v122
s_waitcnt lgkmcnt(5)
v_mfma_f32_16x16x32_bf16 v[68:71],a[32:35],v[224:227],v[68:71]
ds_read_b128 v[252:255],v17 offset:31744
v_min3_u32 v27,v27,v224,v228
v_mul_f32 v88,v88,v64
v_mul_f32 v89,v89,v65
v_mul_f32 v90,v90,v66
v_mul_f32 v91,v91,v67
v_mfma_f32_16x16x32_bf16 v[76:79],a[36:39],v[228:231],v[76:79]
ds_read_b128 v[224:227],v17 offset:33792
v_exp_f32 v88,v88
v_exp_f32 v89,v89
s_waitcnt lgkmcnt(5)
v_mfma_f32_16x16x32_bf16 v[68:71],a[40:43],v[232:235],v[68:71]
ds_read_b128 v[228:231],v17 offset:35840
v_min3_u32 v27,v27,v232,v236
v_exp_f32 v90,v90
v_exp_f32 v91,v91
v_mfma_f32_16x16x32_bf16 v[76:79],a[44:47],v[236:239],v[76:79]
ds_read_b128 v[232:235],v17 offset:37888
v_fma_f32 v88,v88,v123,v123
v_fma_f32 v89,v89,v123,v123
v_fma_f32 v90,v90,v123,v123
v_fma_f32 v91,v91,v123,v123
s_waitcnt lgkmcnt(5)
v_mfma_f32_16x16x32_bf16 v[68:71],a[48:51],v[240:243],v[68:71]
ds_read_b128 v[236:239],v17 offset:39936
v_min3_u32 v27,v27,v240,v244
v_rcp_f32 v88,v88
v_rcp_f32 v89,v89
v_mfma_f32_16x16x32_bf16 v[76:79],a[52:55],v[244:247],v[76:79]
ds_read_b128 v[240:243],v17 offset:41984
v_rcp_f32 v90,v90
v_rcp_f32 v91,v91
s_waitcnt lgkmcnt(5)
v_mfma_f32_16x16x32_bf16 v[68:71],a[56:59],v[248:251],v[68:71]
ds_read_b128 v[244:247],v17 offset:44032
v_min3_u32 v27,v27,v248,v252
v_mul_f32 v88,v88,v64
v_mul_f32 v89,v89,v65
v_mul_f32 v90,v90,v66
v_mul_f32 v91,v91,v67
v_mfma_f32_16x16x32_bf16 v[76:79],a[60:63],v[252:255],v[76:79]
ds_read_b128 v[248:251],v17 offset:46080
v_cvt_pk_bf16_f32 v96,v88,v89
v_cvt_pk_bf16_f32 v97,v90,v91
v_max_u32 v96,1,v96
s_waitcnt lgkmcnt(5)
v_mfma_f32_16x16x32_bf16 v[68:71],a[64:67],v[224:227],v[68:71]
ds_read_b128 v[252:255],v17 offset:48128
v_min3_u32 v27,v27,v224,v228
buffer_store_dwordx2 v[96:97],v18,s[20:23],s70 offen offset:0 sc1
v_mfma_f32_16x16x32_bf16 v[76:79],a[68:71],v[228:231],v[76:79]
ds_read_b128 v[224:227],v17 offset:50176
s_waitcnt lgkmcnt(5)
v_mfma_f32_16x16x32_bf16 v[68:71],a[72:75],v[232:235],v[68:71]
ds_read_b128 v[228:231],v17 offset:52224
v_min3_u32 v27,v27,v232,v236
v_mfma_f32_16x16x32_bf16 v[76:79],a[76:79],v[236:239],v[76:79]
ds_read_b128 v[232:235],v17 offset:54272
s_waitcnt lgkmcnt(5)
v_mfma_f32_16x16x32_bf16 v[68:71],a[80:83],v[240:243],v[68:71]
ds_read_b128 v[236:239],v17 offset:56320
v_min3_u32 v27,v27,v240,v244
v_mfma_f32_16x16x32_bf16 v[76:79],a[84:87],v[244:247],v[76:79]
ds_read_b128 v[240:243],v17 offset:58368
s_waitcnt lgkmcnt(5)
v_mfma_f32_16x16x32_bf16 v[68:71],a[88:91],v[248:251],v[68:71]
ds_read_b128 v[244:247],v17 offset:60416
v_min3_u32 v27,v27,v248,v252
v_mfma_f32_16x16x32_bf16 v[76:79],a[92:95],v[252:255],v[76:79]
ds_read_b128 v[248:251],v17 offset:62464
s_waitcnt lgkmcnt(5)
v_mfma_f32_16x16x32_bf16 v[68:71],a[96:99],v[224:227],v[68:71]
ds_read_b128 v[252:255],v17 offset:64512
v_min3_u32 v27,v27,v224,v228
v_mfma_f32_16x16x32_bf16 v[76:79],a[100:103],v[228:231],v[76:79]
s_waitcnt lgkmcnt(4)
v_mfma_f32_16x16x32_bf16 v[68:71],a[104:107],v[232:235],v[68:71]
v_min3_u32 v27,v27,v232,v236
v_mfma_f32_16x16x32_bf16 v[76:79],a[108:111],v[236:239],v[76:79]
s_waitcnt lgkmcnt(2)
v_mfma_f32_16x16x32_bf16 v[68:71],a[112:115],v[240:243],v[68:71]
v_min3_u32 v27,v27,v240,v244
v_mfma_f32_16x16x32_bf16 v[76:79],a[116:119],v[244:247],v[76:79]
s_waitcnt lgkmcnt(0)
v_mfma_f32_16x16x32_bf16 v[68:71],a[120:123],v[248:251],v[68:71]
v_min3_u32 v27,v27,v248,v252
v_mfma_f32_16x16x32_bf16 v[76:79],a[124:127],v[252:255],v[76:79]
v_cmp_eq_u32 vcc,0,v27
s_cbranch_vccnz retry_392
s_branch epi_395
both_396:
s_waitcnt vmcnt(11) lgkmcnt(0)
s_barrier
ds_read_b128 v[224:227],v17 offset:0
ds_read_b128 v[228:231],v17 offset:2048
ds_read_b128 v[232:235],v17 offset:4096
ds_read_b128 v[236:239],v17 offset:6144
ds_read_b128 v[240:243],v17 offset:8192
ds_read_b128 v[244:247],v17 offset:10240
ds_read_b128 v[248:251],v17 offset:12288
s_waitcnt lgkmcnt(5)
v_mfma_f32_16x16x32_bf16 v[64:67],a[0:3],v[224:227],0
ds_read_b128 v[252:255],v17 offset:14336
v_min_u32 v27,v224,v228
s_waitcnt vmcnt(12)
stk_411:
v_min3_u32 v22,v129,v133,v137
v_min3_u32 v22,v22,v141,v145
v_min3_u32 v22,v22,v149,v153
v_min_u32 v22,v22,v157
v_cmp_eq_u32 vcc,0,v22
s_cmp_lt_i32 s90,0
s_cselect_b64 vcc,0,vcc
s_cbranch_vccnz str_412
v_mfma_f32_16x16x32_bf16 v[72:75],a[4:7],v[228:231],0
ds_read_b128 v[224:227],v17 offset:16384
v_pk_add_f32 v[88:89],v[128:129],v[144:145]
v_pk_add_f32 v[90:91],v[130:131],v[146:147]
v_pk_add_f32 v[92:93],v[132:133],v[148:149]
v_pk_add_f32 v[94:95],v[134:135],v[150:151]
s_waitcnt lgkmcnt(5)
v_mfma_f32_16x16x32_bf16 v[64:67],a[8:11],v[232:235],v[64:67]
ds_read_b128 v[228:231],v17 offset:18432
v_min3_u32 v27,v27,v232,v236
v_pk_add_f32 v[96:97],v[136:137],v[152:153]
v_pk_add_f32 v[98:99],v[138:139],v[154:155]
v_pk_add_f32 v[100:101],v[140:141],v[156:157]
v_pk_add_f32 v[102:103],v[142:143],v[158:159]
v_mfma_f32_16x16x32_bf16 v[72:75],a[12:15],v[236:239],v[72:75]
ds_read_b128 v[232:235],v17 offset:20480
s_add_u32 s88,s70,s75
s_add_u32 s88,s88,2097152
s_xor_b32 s88,s88,0x2000
s_xor_b32 s89,s88,1024
s_waitcnt lgkmcnt(5)
v_mfma_f32_16x16x32_bf16 v[64:67],a[16:19],v[240:243],v[64:67]
ds_read_b128 v[236:239],v17 offset:22528
v_min3_u32 v27,v27,v240,v244
v_pk_add_f32 v[88:89],v[88:89],v[96:97]
v_pk_add_f32 v[90:91],v[90:91],v[98:99]
v_pk_add_f32 v[92:93],v[92:93],v[100:101]
v_mfma_f32_16x16x32_bf16 v[72:75],a[20:23],v[244:247],v[72:75]
ds_read_b128 v[240:243],v17 offset:24576
v_pk_add_f32 v[94:95],v[94:95],v[102:103]
v_pk_add_f32 v[88:89],v[88:89],v[92:93]
v_pk_add_f32 v[90:91],v[90:91],v[94:95]
s_waitcnt lgkmcnt(5)
v_mfma_f32_16x16x32_bf16 v[64:67],a[24:27],v[248:251],v[64:67]
ds_read_b128 v[244:247],v17 offset:26624
v_min3_u32 v27,v27,v248,v252
v_mov_b32 v92,v88
v_mov_b32 v93,v89
v_mov_b32 v94,v90
v_mfma_f32_16x16x32_bf16 v[72:75],a[28:31],v[252:255],v[72:75]
ds_read_b128 v[248:251],v17 offset:28672
v_mov_b32 v95,v91
v_permlane16_swap_b32 v92,v88
v_permlane16_swap_b32 v93,v89
s_waitcnt lgkmcnt(5)
v_mfma_f32_16x16x32_bf16 v[64:67],a[32:35],v[224:227],v[64:67]
ds_read_b128 v[252:255],v17 offset:30720
v_min3_u32 v27,v27,v224,v228
v_permlane16_swap_b32 v94,v90
v_permlane16_swap_b32 v95,v91
s_add_u32 s66,s88,110592
buffer_load_dwordx4 v[128:131],v16,s[20:23],s66 offen offset:0 sc1
v_mfma_f32_16x16x32_bf16 v[72:75],a[36:39],v[228:231],v[72:75]
ds_read_b128 v[224:227],v17 offset:32768
v_pk_add_f32 v[88:89],v[88:89],v[92:93]
v_pk_add_f32 v[90:91],v[90:91],v[94:95]
v_mov_b32 v92,v88
buffer_load_dwordx4 v[132:135],v16,s[20:23],s66 offen offset:1024 sc1
s_waitcnt lgkmcnt(5)
v_mfma_f32_16x16x32_bf16 v[64:67],a[40:43],v[232:235],v[64:67]
ds_read_b128 v[228:231],v17 offset:34816
v_min3_u32 v27,v27,v232,v236
v_mov_b32 v93,v89
v_mov_b32 v94,v90
v_mov_b32 v95,v91
buffer_load_dwordx4 v[136:139],v16,s[20:23],s66 offen offset:2048 sc1
v_mfma_f32_16x16x32_bf16 v[72:75],a[44:47],v[236:239],v[72:75]
ds_read_b128 v[232:235],v17 offset:36864
v_permlane32_swap_b32 v92,v88
v_permlane32_swap_b32 v93,v89
v_permlane32_swap_b32 v94,v90
buffer_load_dwordx4 v[140:143],v16,s[20:23],s66 offen offset:3072 sc1
s_waitcnt lgkmcnt(5)
v_mfma_f32_16x16x32_bf16 v[64:67],a[48:51],v[240:243],v[64:67]
ds_read_b128 v[236:239],v17 offset:38912
v_min3_u32 v27,v27,v240,v244
v_permlane32_swap_b32 v95,v91
v_pk_add_f32 v[88:89],v[88:89],v[92:93]
s_add_u32 s66,s88,114688
buffer_load_dwordx4 v[144:147],v16,s[20:23],s66 offen offset:0 sc1
v_mfma_f32_16x16x32_bf16 v[72:75],a[52:55],v[244:247],v[72:75]
ds_read_b128 v[240:243],v17 offset:40960
v_pk_add_f32 v[90:91],v[90:91],v[94:95]
v_mul_f32 v120,0xba800000,v88
v_mul_f32 v124,0xba800000,v90
buffer_load_dwordx4 v[148:151],v16,s[20:23],s66 offen offset:1024 sc1
s_waitcnt lgkmcnt(5)
v_mfma_f32_16x16x32_bf16 v[64:67],a[56:59],v[248:251],v[64:67]
ds_read_b128 v[244:247],v17 offset:43008
v_min3_u32 v27,v27,v248,v252
v_mul_f32 v92,v120,v120
v_mul_f32 v93,v124,v124
v_fma_f32 v92,v89,s82,-v92
buffer_load_dwordx4 v[152:155],v16,s[20:23],s66 offen offset:2048 sc1
v_mfma_f32_16x16x32_bf16 v[72:75],a[60:63],v[252:255],v[72:75]
ds_read_b128 v[248:251],v17 offset:45056
v_fma_f32 v93,v91,s82,-v93
v_max_f32 v92,0,v92
v_max_f32 v93,0,v93
buffer_load_dwordx4 v[156:159],v16,s[20:23],s66 offen offset:3072 sc1
s_waitcnt lgkmcnt(5)
v_mfma_f32_16x16x32_bf16 v[64:67],a[64:67],v[224:227],v[64:67]
ds_read_b128 v[252:255],v17 offset:47104
v_min3_u32 v27,v27,v224,v228
v_add_f32 v92,0x3727c5ac,v92
v_add_f32 v93,0x3727c5ac,v93
v_rsq_f32 v94,v92
s_xor_b32 m0,s72,0
v_mfma_f32_16x16x32_bf16 v[72:75],a[68:71],v[228:231],v[72:75]
ds_read_b128 v[224:227],v17 offset:49152
v_rsq_f32 v95,v93
v_mul_f32 v123,v92,v94
s_add_u32 s65,s88,0
s_waitcnt lgkmcnt(5)
v_mfma_f32_16x16x32_bf16 v[64:67],a[72:75],v[232:235],v[64:67]
ds_read_b128 v[228:231],v17 offset:51200
v_min3_u32 v27,v27,v232,v236
v_mul_f32 v127,v93,v95
v_mul_f32 v122,v28,v94
v_mul_f32 v126,v28,v95
buffer_load_dwordx4 v16,s[20:23],s65 offen offset:0 sc1 lds
v_mfma_f32_16x16x32_bf16 v[72:75],a[76:79],v[236:239],v[72:75]
ds_read_b128 v[232:235],v17 offset:53248
v_mul_f32 v92,v94,v94
v_mul_f32 v93,v95,v95
v_mul_f32 v94,s81,v94
buffer_load_dwordx4 v16,s[20:23],s65 offen offset:2048 sc1 lds
s_waitcnt lgkmcnt(5)
v_mfma_f32_16x16x32_bf16 v[64:67],a[80:83],v[240:243],v[64:67]
ds_read_b128 v[236:239],v17 offset:55296
v_min3_u32 v27,v27,v240,v244
v_mul_f32 v95,s81,v95
v_mul_f32 v121,v92,v94
v_mul_f32 v125,v93,v95
s_xor_b32 m0,s72,16384
v_mfma_f32_16x16x32_bf16 v[72:75],a[84:87],v[244:247],v[72:75]
ds_read_b128 v[240:243],v17 offset:57344
ds_write_b128 v19,v[120:123] offset:0
ds_write_b128 v19,v[124:127] offset:256
s_add_u32 s65,s88,32768
s_waitcnt lgkmcnt(7)
v_mfma_f32_16x16x32_bf16 v[64:67],a[88:91],v[248:251],v[64:67]
ds_read_b128 v[244:247],v17 offset:59392
v_min3_u32 v27,v27,v248,v252
buffer_load_dwordx4 v16,s[20:23],s65 offen offset:0 sc1 lds
buffer_load_dwordx4 v16,s[20:23],s65 offen offset:2048 sc1 lds
v_mfma_f32_16x16x32_bf16 v[72:75],a[92:95],v[252:255],v[72:75]
ds_read_b128 v[248:251],v17 offset:61440
s_xor_b32 m0,s72,32768
s_add_u32 s65,s88,65536
buffer_load_dwordx4 v16,s[20:23],s65 offen offset:0 sc1 lds
s_waitcnt lgkmcnt(7)
v_mfma_f32_16x16x32_bf16 v[64:67],a[96:99],v[224:227],v[64:67]
ds_read_b128 v[252:255],v17 offset:63488
v_min3_u32 v27,v27,v224,v228
buffer_load_dwordx4 v16,s[20:23],s65 offen offset:2048 sc1 lds
s_xor_b32 m0,s72,49152
s_add_u32 s65,s88,98304
v_mfma_f32_16x16x32_bf16 v[72:75],a[100:103],v[228:231],v[72:75]
s_waitcnt vmcnt(17) lgkmcnt(0)
s_barrier
ds_read_b64 v[44:45],v47
ds_read_b128 v[224:227],v17 offset:1024
s_waitcnt vmcnt(14)
v_add_u32 v22,s71,-1
v_mfma_f32_16x16x32_bf16 v[64:67],a[104:107],v[232:235],v[64:67]
ds_read_b128 v[228:231],v17 offset:3072
v_min3_u32 v27,v27,v232,v236
buffer_store_dword v22,v23,s[20:23],s97 offen sc1
s_mov_b32 s97,0x7fff0000
v_mfma_f32_16x16x32_bf16 v[72:75],a[108:111],v[236:239],v[72:75]
ds_read_b128 v[232:235],v17 offset:5120
buffer_load_dwordx4 v16,s[20:23],s65 offen offset:0 sc1 lds
buffer_load_dwordx4 v16,s[20:23],s65 offen offset:2048 sc1 lds
v_mfma_f32_16x16x32_bf16 v[64:67],a[112:115],v[240:243],v[64:67]
ds_read_b128 v[236:239],v17 offset:7168
v_min3_u32 v27,v27,v240,v244
s_xor_b32 m0,s72,1024
s_add_u32 s65,s89,0
buffer_load_dwordx4 v16,s[20:23],s65 offen offset:0 sc1 lds
v_mfma_f32_16x16x32_bf16 v[72:75],a[116:119],v[244:247],v[72:75]
ds_read_b128 v[240:243],v17 offset:9216
s_waitcnt lgkmcnt(5)
v_readfirstlane_b32 s93,v45
buffer_load_dwordx4 v16,s[20:23],s65 offen offset:2048 sc1 lds
v_mfma_f32_16x16x32_bf16 v[64:67],a[120:123],v[248:251],v[64:67]
ds_read_b128 v[244:247],v17 offset:11264
v_min3_u32 v27,v27,v248,v252
s_xor_b32 m0,s72,17408
s_add_u32 s65,s89,32768
buffer_load_dwordx4 v16,s[20:23],s65 offen offset:0 sc1 lds
v_mfma_f32_16x16x32_bf16 v[72:75],a[124:127],v[252:255],v[72:75]
ds_read_b128 v[248:251],v17 offset:13312
buffer_load_dwordx4 v16,s[20:23],s65 offen offset:2048 sc1 lds
s_xor_b32 m0,s72,33792
s_add_u32 s65,s89,65536
s_waitcnt lgkmcnt(5)
v_mfma_f32_16x16x32_bf16 v[68:71],a[0:3],v[224:227],0
ds_read_b128 v[252:255],v17 offset:15360
v_cmp_eq_u32 vcc,0,v27
s_cbranch_vccnz retry_392
v_min3_u32 v27,v27,v224,v228
buffer_load_dwordx4 v16,s[20:23],s65 offen offset:0 sc1 lds
v_mfma_f32_16x16x32_bf16 v[76:79],a[4:7],v[228:231],0
ds_read_b128 v[224:227],v17 offset:17408
buffer_load_dwordx4 v16,s[20:23],s65 offen offset:2048 sc1 lds
s_xor_b32 m0,s72,50176
s_add_u32 s65,s89,98304
s_waitcnt lgkmcnt(5)
v_mfma_f32_16x16x32_bf16 v[68:71],a[8:11],v[232:235],v[68:71]
ds_read_b128 v[228:231],v17 offset:19456
v_min3_u32 v27,v27,v232,v236
buffer_load_dwordx4 v16,s[20:23],s65 offen offset:0 sc1 lds
buffer_load_dwordx4 v16,s[20:23],s65 offen offset:2048 sc1 lds
v_mfma_f32_16x16x32_bf16 v[76:79],a[12:15],v[236:239],v[76:79]
ds_read_b128 v[232:235],v17 offset:21504
s_waitcnt lgkmcnt(5)
v_mfma_f32_16x16x32_bf16 v[68:71],a[16:19],v[240:243],v[68:71]
ds_read_b128 v[236:239],v17 offset:23552
v_min3_u32 v27,v27,v240,v244
v_add_f32 v64,v64,v72
v_add_f32 v65,v65,v73
v_add_f32 v66,v66,v74
v_add_f32 v67,v67,v75
v_mfma_f32_16x16x32_bf16 v[76:79],a[20:23],v[244:247],v[76:79]
ds_read_b128 v[240:243],v17 offset:25600
v_fmac_f32 v64,v52,v120
v_fmac_f32 v65,v53,v120
v_fmac_f32 v66,v54,v120
v_fmac_f32 v67,v55,v120
s_waitcnt lgkmcnt(5)
v_mfma_f32_16x16x32_bf16 v[68:71],a[24:27],v[248:251],v[68:71]
ds_read_b128 v[244:247],v17 offset:27648
v_min3_u32 v27,v27,v248,v252
v_mul_f32 v88,v64,v64
v_mul_f32 v89,v65,v65
v_mul_f32 v90,v66,v66
v_mul_f32 v91,v67,v67
v_mfma_f32_16x16x32_bf16 v[76:79],a[28:31],v[252:255],v[76:79]
ds_read_b128 v[248:251],v17 offset:29696
v_fma_f32 v88,v88,v121,v122
v_fma_f32 v89,v89,v121,v122
v_fma_f32 v90,v90,v121,v122
v_fma_f32 v91,v91,v121,v122
s_waitcnt lgkmcnt(5)
v_mfma_f32_16x16x32_bf16 v[68:71],a[32:35],v[224:227],v[68:71]
ds_read_b128 v[252:255],v17 offset:31744
v_min3_u32 v27,v27,v224,v228
v_mul_f32 v88,v88,v64
v_mul_f32 v89,v89,v65
v_mul_f32 v90,v90,v66
v_mul_f32 v91,v91,v67
v_mfma_f32_16x16x32_bf16 v[76:79],a[36:39],v[228:231],v[76:79]
ds_read_b128 v[224:227],v17 offset:33792
v_exp_f32 v88,v88
v_exp_f32 v89,v89
s_waitcnt lgkmcnt(5)
v_mfma_f32_16x16x32_bf16 v[68:71],a[40:43],v[232:235],v[68:71]
ds_read_b128 v[228:231],v17 offset:35840
v_min3_u32 v27,v27,v232,v236
v_exp_f32 v90,v90
v_exp_f32 v91,v91
v_mfma_f32_16x16x32_bf16 v[76:79],a[44:47],v[236:239],v[76:79]
ds_read_b128 v[232:235],v17 offset:37888
v_fma_f32 v88,v88,v123,v123
v_fma_f32 v89,v89,v123,v123
v_fma_f32 v90,v90,v123,v123
v_fma_f32 v91,v91,v123,v123
s_waitcnt lgkmcnt(5)
v_mfma_f32_16x16x32_bf16 v[68:71],a[48:51],v[240:243],v[68:71]
ds_read_b128 v[236:239],v17 offset:39936
v_min3_u32 v27,v27,v240,v244
v_rcp_f32 v88,v88
v_rcp_f32 v89,v89
v_mfma_f32_16x16x32_bf16 v[76:79],a[52:55],v[244:247],v[76:79]
ds_read_b128 v[240:243],v17 offset:41984
v_rcp_f32 v90,v90
v_rcp_f32 v91,v91
s_waitcnt lgkmcnt(5)
v_mfma_f32_16x16x32_bf16 v[68:71],a[56:59],v[248:251],v[68:71]
ds_read_b128 v[244:247],v17 offset:44032
v_min3_u32 v27,v27,v248,v252
v_mul_f32 v88,v88,v64
v_mul_f32 v89,v89,v65
v_mul_f32 v90,v90,v66
v_mul_f32 v91,v91,v67
v_mfma_f32_16x16x32_bf16 v[76:79],a[60:63],v[252:255],v[76:79]
ds_read_b128 v[248:251],v17 offset:46080
v_cvt_pk_bf16_f32 v96,v88,v89
v_cvt_pk_bf16_f32 v97,v90,v91
v_max_u32 v96,1,v96
s_waitcnt lgkmcnt(5)
v_mfma_f32_16x16x32_bf16 v[68:71],a[64:67],v[224:227],v[68:71]
ds_read_b128 v[252:255],v17 offset:48128
v_min3_u32 v27,v27,v224,v228
buffer_store_dwordx2 v[96:97],v18,s[20:23],s70 offen offset:0 sc1
v_mfma_f32_16x16x32_bf16 v[76:79],a[68:71],v[228:231],v[76:79]
ds_read_b128 v[224:227],v17 offset:50176
s_waitcnt lgkmcnt(5)
v_mfma_f32_16x16x32_bf16 v[68:71],a[72:75],v[232:235],v[68:71]
ds_read_b128 v[228:231],v17 offset:52224
v_min3_u32 v27,v27,v232,v236
v_mfma_f32_16x16x32_bf16 v[76:79],a[76:79],v[236:239],v[76:79]
ds_read_b128 v[232:235],v17 offset:54272
s_waitcnt lgkmcnt(5)
v_mfma_f32_16x16x32_bf16 v[68:71],a[80:83],v[240:243],v[68:71]
ds_read_b128 v[236:239],v17 offset:56320
v_min3_u32 v27,v27,v240,v244
v_mfma_f32_16x16x32_bf16 v[76:79],a[84:87],v[244:247],v[76:79]
ds_read_b128 v[240:243],v17 offset:58368
s_waitcnt lgkmcnt(5)
v_mfma_f32_16x16x32_bf16 v[68:71],a[88:91],v[248:251],v[68:71]
ds_read_b128 v[244:247],v17 offset:60416
v_min3_u32 v27,v27,v248,v252
v_mfma_f32_16x16x32_bf16 v[76:79],a[92:95],v[252:255],v[76:79]
ds_read_b128 v[248:251],v17 offset:62464
s_waitcnt lgkmcnt(5)
v_mfma_f32_16x16x32_bf16 v[68:71],a[96:99],v[224:227],v[68:71]
ds_read_b128 v[252:255],v17 offset:64512
v_min3_u32 v27,v27,v224,v228
v_mfma_f32_16x16x32_bf16 v[76:79],a[100:103],v[228:231],v[76:79]
s_waitcnt lgkmcnt(4)
v_mfma_f32_16x16x32_bf16 v[68:71],a[104:107],v[232:235],v[68:71]
v_min3_u32 v27,v27,v232,v236
v_mfma_f32_16x16x32_bf16 v[76:79],a[108:111],v[236:239],v[76:79]
s_waitcnt lgkmcnt(2)
v_mfma_f32_16x16x32_bf16 v[68:71],a[112:115],v[240:243],v[68:71]
v_min3_u32 v27,v27,v240,v244
v_mfma_f32_16x16x32_bf16 v[76:79],a[116:119],v[244:247],v[76:79]
s_waitcnt lgkmcnt(0)
v_mfma_f32_16x16x32_bf16 v[68:71],a[120:123],v[248:251],v[68:71]
v_min3_u32 v27,v27,v248,v252
v_mfma_f32_16x16x32_bf16 v[76:79],a[124:127],v[252:255],v[76:79]
v_cmp_eq_u32 vcc,0,v27
s_cbranch_vccnz retry_392
epi_395:
buffer_load_dword v29,v21,s[20:23],s87 offen sc1
s_nop 4
v_pk_add_f32 v[68:69],v[68:69],v[76:77]
v_pk_add_f32 v[70:71],v[70:71],v[78:79]
v_pk_fma_f32 v[68:69],v[52:53],v[124:125],v[68:69] op_sel_hi:[1,0,1]
v_pk_fma_f32 v[70:71],v[54:55],v[124:125],v[70:71] op_sel_hi:[1,0,1]
v_pk_mul_f32 v[88:89],v[68:69],v[68:69]
v_pk_mul_f32 v[90:91],v[70:71],v[70:71]
v_pk_fma_f32 v[88:89],v[88:89],v[124:125],v[126:127] op_sel:[0,1,0] op_sel_hi:[1,1,0]
v_pk_fma_f32 v[90:91],v[90:91],v[124:125],v[126:127] op_sel:[0,1,0] op_sel_hi:[1,1,0]
v_pk_mul_f32 v[88:89],v[88:89],v[68:69]
v_pk_mul_f32 v[90:91],v[90:91],v[70:71]
v_exp_f32 v88,v88
v_exp_f32 v89,v89
v_exp_f32 v90,v90
s_cmp_gt_u32 s71,44
s_cselect_b32 s65,s73,0x7fff0000
s_cselect_b32 s97,0x7fff0000,s73
v_mov_b32 v22,s71
buffer_store_dword v22,v23,s[20:23],s65 offen sc1
v_exp_f32 v91,v91
v_pk_fma_f32 v[88:89],v[88:89],v[126:127],v[126:127] op_sel:[0,1,1] op_sel_hi:[1,1,1]
v_pk_fma_f32 v[90:91],v[90:91],v[126:127],v[126:127] op_sel:[0,1,1] op_sel_hi:[1,1,1]
v_rcp_f32 v88,v88
v_rcp_f32 v89,v89
v_rcp_f32 v90,v90
v_rcp_f32 v91,v91
v_pk_mul_f32 v[88:89],v[88:89],v[68:69]
v_pk_mul_f32 v[90:91],v[90:91],v[70:71]
v_cvt_pk_bf16_f32 v96,v88,v89
v_cvt_pk_bf16_f32 v97,v90,v91
v_max_u32 v96,1,v96
buffer_store_dwordx2 v[96:97],v18,s[20:23],s70 offen offset:1024 sc1
next_402:
v_xor_b32 v17,0x10000,v17
s_xor_b32 s72,s72,0x10000
s_add_u32 s70,s70,2097152
s_xor_b32 s70,s70,0x2000
s_add_u32 s71,s71,1
s_cmp_le_u32 s71,s57
s_cbranch_scc1 seg_393
s_endpgm
retry_392:
s_sub_u32 s90,s90,64
s_cmp_lt_i32 s90,0
s_cbranch_scc1 giveup_197
s_mov_b32 s83,1
s_waitcnt vmcnt(0) lgkmcnt(0)
s_barrier
s_branch seg_393
half_401:
s_mov_b64 exec,s[52:53]
s_xor_b32 m0,s91,0
s_add_u32 s65,s94,0
buffer_load_dwordx4 v16,s[20:23],s65 offen offset:0 sc1 lds
buffer_load_dwordx4 v16,s[20:23],s65 offen offset:2048 sc1 lds
s_xor_b32 m0,s91,16384
s_add_u32 s65,s94,32768
buffer_load_dwordx4 v16,s[20:23],s65 offen offset:0 sc1 lds
buffer_load_dwordx4 v16,s[20:23],s65 offen offset:2048 sc1 lds
s_xor_b32 m0,s91,32768
s_add_u32 s65,s94,65536
buffer_load_dwordx4 v16,s[20:23],s65 offen offset:0 sc1 lds
buffer_load_dwordx4 v16,s[20:23],s65 offen offset:2048 sc1 lds
s_xor_b32 m0,s91,49152
s_add_u32 s65,s94,98304
buffer_load_dwordx4 v16,s[20:23],s65 offen offset:0 sc1 lds
buffer_load_dwordx4 v16,s[20:23],s65 offen offset:2048 sc1 lds
s_add_u32 s66,s94,110592
buffer_load_dwordx4 v[128:131],v16,s[20:23],s66 offen offset:0 sc1
buffer_load_dwordx4 v[132:135],v16,s[20:23],s66 offen offset:1024 sc1
buffer_load_dwordx4 v[136:139],v16,s[20:23],s66 offen offset:2048 sc1
buffer_load_dwordx4 v[140:143],v16,s[20:23],s66 offen offset:3072 sc1
s_add_u32 s66,s94,114688
buffer_load_dwordx4 v[144:147],v16,s[20:23],s66 offen offset:0 sc1
buffer_load_dwordx4 v[148:151],v16,s[20:23],s66 offen offset:1024 sc1
buffer_load_dwordx4 v[152:155],v16,s[20:23],s66 offen offset:2048 sc1
buffer_load_dwordx4 v[156:159],v16,s[20:23],s66 offen offset:3072 sc1
s_mov_b64 exec,-1
s_waitcnt vmcnt(16)
v_add_u32 v22,s71,-1
buffer_store_dword v22,v23,s[20:23],s97 offen sc1
s_mov_b32 s97,0x7fff0000
half2_398:
s_waitcnt vmcnt(15)
s_barrier
ds_read_b128 v[224:227],v17 offset:0
ds_read_b128 v[228:231],v17 offset:2048
ds_read_b128 v[232:235],v17 offset:4096
ds_read_b128 v[236:239],v17 offset:6144
ds_read_b128 v[240:243],v17 offset:8192
ds_read_b128 v[244:247],v17 offset:10240
ds_read_b128 v[248:251],v17 offset:12288
s_waitcnt lgkmcnt(5)
v_mfma_f32_16x16x32_bf16 v[64:67],a[0:3],v[224:227],0
ds_read_b128 v[252:255],v17 offset:14336
v_min_u32 v27,v224,v228
v_mfma_f32_16x16x32_bf16 v[72:75],a[4:7],v[228:231],0
s_waitcnt vmcnt(13)
s_barrier
ds_read_b128 v[224:227],v17 offset:16384
s_waitcnt lgkmcnt(5)
v_mfma_f32_16x16x32_bf16 v[64:67],a[8:11],v[232:235],v[64:67]
ds_read_b128 v[228:231],v17 offset:18432
v_min3_u32 v27,v27,v232,v236
v_mfma_f32_16x16x32_bf16 v[72:75],a[12:15],v[236:239],v[72:75]
ds_read_b128 v[232:235],v17 offset:20480
s_waitcnt lgkmcnt(5)
v_mfma_f32_16x16x32_bf16 v[64:67],a[16:19],v[240:243],v[64:67]
ds_read_b128 v[236:239],v17 offset:22528
v_min3_u32 v27,v27,v240,v244
v_mfma_f32_16x16x32_bf16 v[72:75],a[20:23],v[244:247],v[72:75]
ds_read_b128 v[240:243],v17 offset:24576
s_waitcnt lgkmcnt(5)
v_mfma_f32_16x16x32_bf16 v[64:67],a[24:27],v[248:251],v[64:67]
ds_read_b128 v[244:247],v17 offset:26624
v_min3_u32 v27,v27,v248,v252
v_mfma_f32_16x16x32_bf16 v[72:75],a[28:31],v[252:255],v[72:75]
ds_read_b128 v[248:251],v17 offset:28672
s_waitcnt lgkmcnt(5)
v_mfma_f32_16x16x32_bf16 v[64:67],a[32:35],v[224:227],v[64:67]
ds_read_b128 v[252:255],v17 offset:30720
v_min3_u32 v27,v27,v224,v228
v_mfma_f32_16x16x32_bf16 v[72:75],a[36:39],v[228:231],v[72:75]
s_waitcnt vmcnt(9)
s_barrier
ds_read_b128 v[224:227],v17 offset:32768
s_waitcnt lgkmcnt(5)
v_mfma_f32_16x16x32_bf16 v[64:67],a[40:43],v[232:235],v[64:67]
ds_read_b128 v[228:231],v17 offset:34816
v_min3_u32 v27,v27,v232,v236
v_mfma_f32_16x16x32_bf16 v[72:75],a[44:47],v[236:239],v[72:75]
ds_read_b128 v[232:235],v17 offset:36864
s_waitcnt lgkmcnt(5)
v_mfma_f32_16x16x32_bf16 v[64:67],a[48:51],v[240:243],v[64:67]
ds_read_b128 v[236:239],v17 offset:38912
v_min3_u32 v27,v27,v240,v244
s_waitcnt vmcnt(1)
stk_413:
v_min3_u32 v22,v129,v133,v137
v_min3_u32 v22,v22,v141,v145
v_min3_u32 v22,v22,v149,v153
v_min_u32 v22,v22,v157
v_cmp_eq_u32 vcc,0,v22
s_and_b64 vcc,vcc,s[52:53]
s_cmp_lt_i32 s90,0
s_cselect_b64 vcc,0,vcc
s_cbranch_vccnz str_414
v_mfma_f32_16x16x32_bf16 v[72:75],a[52:55],v[244:247],v[72:75]
ds_read_b128 v[240:243],v17 offset:40960
v_pk_add_f32 v[88:89],v[128:129],v[144:145]
v_pk_add_f32 v[90:91],v[130:131],v[146:147]
v_pk_add_f32 v[92:93],v[132:133],v[148:149]
v_pk_add_f32 v[94:95],v[134:135],v[150:151]
v_pk_add_f32 v[96:97],v[136:137],v[152:153]
v_pk_add_f32 v[98:99],v[138:139],v[154:155]
v_pk_add_f32 v[100:101],v[140:141],v[156:157]
v_pk_add_f32 v[102:103],v[142:143],v[158:159]
v_pk_add_f32 v[88:89],v[88:89],v[96:97]
v_pk_add_f32 v[90:91],v[90:91],v[98:99]
s_waitcnt lgkmcnt(5)
v_mfma_f32_16x16x32_bf16 v[64:67],a[56:59],v[248:251],v[64:67]
ds_read_b128 v[244:247],v17 offset:43008
v_min3_u32 v27,v27,v248,v252
v_pk_add_f32 v[92:93],v[92:93],v[100:101]
v_pk_add_f32 v[94:95],v[94:95],v[102:103]
v_pk_add_f32 v[88:89],v[88:89],v[92:93]
v_pk_add_f32 v[90:91],v[90:91],v[94:95]
v_mov_b32 v92,v88
v_mov_b32 v93,v89
v_mov_b32 v94,v90
v_mov_b32 v95,v91
v_permlane16_swap_b32 v92,v88
v_mfma_f32_16x16x32_bf16 v[72:75],a[60:63],v[252:255],v[72:75]
ds_read_b128 v[248:251],v17 offset:45056
v_permlane16_swap_b32 v93,v89
v_permlane16_swap_b32 v94,v90
v_permlane16_swap_b32 v95,v91
v_pk_add_f32 v[88:89],v[88:89],v[92:93]
v_pk_add_f32 v[90:91],v[90:91],v[94:95]
v_mov_b32 v92,v88
v_mov_b32 v93,v89
s_waitcnt lgkmcnt(5)
v_mfma_f32_16x16x32_bf16 v[64:67],a[64:67],v[224:227],v[64:67]
ds_read_b128 v[252:255],v17 offset:47104
v_min3_u32 v27,v27,v224,v228
v_mov_b32 v94,v90
v_mov_b32 v95,v91
v_permlane32_swap_b32 v92,v88
v_permlane32_swap_b32 v93,v89
v_permlane32_swap_b32 v94,v90
v_permlane32_swap_b32 v95,v91
v_mfma_f32_16x16x32_bf16 v[72:75],a[68:71],v[228:231],v[72:75]
ds_read_b128 v[224:227],v17 offset:49152
v_pk_add_f32 v[88:89],v[88:89],v[92:93]
v_pk_add_f32 v[90:91],v[90:91],v[94:95]
v_mul_f32 v120,0xba800000,v88
v_mul_f32 v124,0xba800000,v90
s_waitcnt lgkmcnt(5)
v_mfma_f32_16x16x32_bf16 v[64:67],a[72:75],v[232:235],v[64:67]
ds_read_b128 v[228:231],v17 offset:51200
v_min3_u32 v27,v27,v232,v236
v_mul_f32 v92,v120,v120
v_mul_f32 v93,v124,v124
v_fma_f32 v92,v89,s82,-v92
v_fma_f32 v93,v91,s82,-v93
v_mfma_f32_16x16x32_bf16 v[72:75],a[76:79],v[236:239],v[72:75]
ds_read_b128 v[232:235],v17 offset:53248
v_max_f32 v92,0,v92
v_max_f32 v93,0,v93
v_add_f32 v92,0x3727c5ac,v92
v_add_f32 v93,0x3727c5ac,v93
s_waitcnt lgkmcnt(5)
v_mfma_f32_16x16x32_bf16 v[64:67],a[80:83],v[240:243],v[64:67]
ds_read_b128 v[236:239],v17 offset:55296
v_min3_u32 v27,v27,v240,v244
v_rsq_f32 v94,v92
v_rsq_f32 v95,v93
v_mfma_f32_16x16x32_bf16 v[72:75],a[84:87],v[244:247],v[72:75]
ds_read_b128 v[240:243],v17 offset:57344
v_mul_f32 v123,v92,v94
v_mul_f32 v127,v93,v95
v_mul_f32 v122,v28,v94
v_mul_f32 v126,v28,v95
s_waitcnt lgkmcnt(5)
v_mfma_f32_16x16x32_bf16 v[64:67],a[88:91],v[248:251],v[64:67]
ds_read_b128 v[244:247],v17 offset:59392
v_min3_u32 v27,v27,v248,v252
v_mul_f32 v92,v94,v94
v_mul_f32 v93,v95,v95
v_mul_f32 v94,s81,v94
v_mul_f32 v95,s81,v95
v_mfma_f32_16x16x32_bf16 v[72:75],a[92:95],v[252:255],v[72:75]
ds_read_b128 v[248:251],v17 offset:61440
v_mul_f32 v121,v92,v94
v_mul_f32 v125,v93,v95
ds_write_b128 v19,v[120:123] offset:0
ds_write_b128 v19,v[124:127] offset:256
s_waitcnt lgkmcnt(7)
v_mfma_f32_16x16x32_bf16 v[64:67],a[96:99],v[224:227],v[64:67]
s_waitcnt lgkmcnt(0)
s_barrier
ds_read_b128 v[252:255],v17 offset:63488
v_min3_u32 v27,v27,v224,v228
v_mfma_f32_16x16x32_bf16 v[72:75],a[100:103],v[228:231],v[72:75]
v_mfma_f32_16x16x32_bf16 v[64:67],a[104:107],v[232:235],v[64:67]
v_min3_u32 v27,v27,v232,v236
v_mfma_f32_16x16x32_bf16 v[72:75],a[108:111],v[236:239],v[72:75]
v_mfma_f32_16x16x32_bf16 v[64:67],a[112:115],v[240:243],v[64:67]
v_min3_u32 v27,v27,v240,v244
v_mfma_f32_16x16x32_bf16 v[72:75],a[116:119],v[244:247],v[72:75]
s_waitcnt lgkmcnt(0)
v_mfma_f32_16x16x32_bf16 v[64:67],a[120:123],v[248:251],v[64:67]
v_min3_u32 v27,v27,v248,v252
v_mfma_f32_16x16x32_bf16 v[72:75],a[124:127],v[252:255],v[72:75]
v_cmp_eq_u32 vcc,0,v27
s_and_b64 vcc,vcc,s[52:53]
s_cbranch_vccnz retry_392
s_waitcnt lgkmcnt(0)
s_nop 3
v_pk_add_f32 v[64:65],v[64:65],v[72:73]
v_pk_add_f32 v[66:67],v[66:67],v[74:75]
v_pk_fma_f32 v[64:65],v[52:53],v[120:121],v[64:65] op_sel_hi:[1,0,1]
v_pk_fma_f32 v[66:67],v[54:55],v[120:121],v[66:67] op_sel_hi:[1,0,1]
v_pk_mul_f32 v[88:89],v[64:65],v[64:65]
v_pk_mul_f32 v[90:91],v[66:67],v[66:67]
buffer_load_dword v29,v21,s[20:23],s87 offen sc1
v_mov_b32 v22,s71
buffer_store_dword v22,v23,s[20:23],s73 offen sc1
v_pk_fma_f32 v[88:89],v[88:89],v[120:121],v[122:123] op_sel:[0,1,0] op_sel_hi:[1,1,0]
v_pk_fma_f32 v[90:91],v[90:91],v[120:121],v[122:123] op_sel:[0,1,0] op_sel_hi:[1,1,0]
v_pk_mul_f32 v[88:89],v[88:89],v[64:65]
v_pk_mul_f32 v[90:91],v[90:91],v[66:67]
v_exp_f32 v88,v88
v_exp_f32 v89,v89
v_exp_f32 v90,v90
v_exp_f32 v91,v91
v_pk_fma_f32 v[88:89],v[88:89],v[122:123],v[122:123] op_sel:[0,1,1] op_sel_hi:[1,1,1]
v_pk_fma_f32 v[90:91],v[90:91],v[122:123],v[122:123] op_sel:[0,1,1] op_sel_hi:[1,1,1]
v_rcp_f32 v88,v88
v_rcp_f32 v89,v89
v_rcp_f32 v90,v90
v_rcp_f32 v91,v91
v_pk_mul_f32 v[88:89],v[88:89],v[64:65]
v_pk_mul_f32 v[90:91],v[90:91],v[66:67]
v_cvt_pk_bf16_f32 v96,v88,v89
v_cvt_pk_bf16_f32 v97,v90,v91
v_max_u32 v96,1,v96
buffer_store_dwordx2 v[96:97],v18,s[20:23],s70 offen offset:0 sc1
s_branch next_402
str_408:
s_add_u32 s94,s70,s75
s_add_u32 s66,s94,110592
buffer_load_dwordx4 v[128:131],v16,s[20:23],s66 offen offset:0 sc1
buffer_load_dwordx4 v[132:135],v16,s[20:23],s66 offen offset:1024 sc1
buffer_load_dwordx4 v[136:139],v16,s[20:23],s66 offen offset:2048 sc1
buffer_load_dwordx4 v[140:143],v16,s[20:23],s66 offen offset:3072 sc1
s_add_u32 s66,s94,114688
buffer_load_dwordx4 v[144:147],v16,s[20:23],s66 offen offset:0 sc1
buffer_load_dwordx4 v[148:151],v16,s[20:23],s66 offen offset:1024 sc1
buffer_load_dwordx4 v[152:155],v16,s[20:23],s66 offen offset:2048 sc1
buffer_load_dwordx4 v[156:159],v16,s[20:23],s66 offen offset:3072 sc1
s_sub_u32 s90,s90,1
s_waitcnt vmcnt(0)
s_branch stk_407
str_410:
s_add_u32 s94,s70,s75
s_add_u32 s66,s94,110592
buffer_load_dwordx4 v[128:131],v16,s[20:23],s66 offen offset:0 sc1
buffer_load_dwordx4 v[132:135],v16,s[20:23],s66 offen offset:1024 sc1
buffer_load_dwordx4 v[136:139],v16,s[20:23],s66 offen offset:2048 sc1
buffer_load_dwordx4 v[140:143],v16,s[20:23],s66 offen offset:3072 sc1
s_add_u32 s66,s94,114688
buffer_load_dwordx4 v[144:147],v16,s[20:23],s66 offen offset:0 sc1
buffer_load_dwordx4 v[148:151],v16,s[20:23],s66 offen offset:1024 sc1
buffer_load_dwordx4 v[152:155],v16,s[20:23],s66 offen offset:2048 sc1
buffer_load_dwordx4 v[156:159],v16,s[20:23],s66 offen offset:3072 sc1
s_sub_u32 s90,s90,1
s_waitcnt vmcnt(0)
s_branch stk_409
str_412:
s_add_u32 s94,s70,s75
s_add_u32 s66,s94,110592
buffer_load_dwordx4 v[128:131],v16,s[20:23],s66 offen offset:0 sc1
buffer_load_dwordx4 v[132:135],v16,s[20:23],s66 offen offset:1024 sc1
buffer_load_dwordx4 v[136:139],v16,s[20:23],s66 offen offset:2048 sc1
buffer_load_dwordx4 v[140:143],v16,s[20:23],s66 offen offset:3072 sc1
s_add_u32 s66,s94,114688
buffer_load_dwordx4 v[144:147],v16,s[20:23],s66 offen offset:0 sc1
buffer_load_dwordx4 v[148:151],v16,s[20:23],s66 offen offset:1024 sc1
buffer_load_dwordx4 v[152:155],v16,s[20:23],s66 offen offset:2048 sc1
buffer_load_dwordx4 v[156:159],v16,s[20:23],s66 offen offset:3072 sc1
s_sub_u32 s90,s90,1
s_waitcnt vmcnt(0)
s_branch stk_411
str_414:
s_add_u32 s94,s70,s75
s_add_u32 s66,s94,110592
buffer_load_dwordx4 v[128:131],v16,s[20:23],s66 offen offset:0 sc1
buffer_load_dwordx4 v[132:135],v16,s[20:23],s66 offen offset:1024 sc1
buffer_load_dwordx4 v[136:139],v16,s[20:23],s66 offen offset:2048 sc1
buffer_load_dwordx4 v[140:143],v16,s[20:23],s66 offen offset:3072 sc1
s_add_u32 s66,s94,114688
buffer_load_dwordx4 v[144:147],v16,s[20:23],s66 offen offset:0 sc1
buffer_load_dwordx4 v[148:151],v16,s[20:23],s66 offen offset:1024 sc1
buffer_load_dwordx4 v[152:155],v16,s[20:23],s66 offen offset:2048 sc1
buffer_load_dwordx4 v[156:159],v16,s[20:23],s66 offen offset:3072 sc1
s_sub_u32 s90,s90,1
s_waitcnt vmcnt(0)
s_branch stk_413
giveup_197:
s_endpgm
code_end:
.section .rodata,"a"
.p2align 6
.amdhsa_kernel mega_kernel
  .amdhsa_next_free_vgpr 512
  .amdhsa_next_free_sgpr 102
  .amdhsa_accum_offset 256
  .amdhsa_group_segment_fixed_size 0
  .amdhsa_kernarg_size 136
  .amdhsa_user_sgpr_count 2
  .amdhsa_user_sgpr_kernarg_segment_ptr 1
  .amdhsa_system_sgpr_workgroup_id_x 1
.end_amdhsa_kernel
```

```asm
; @launch kernel=mega_kernel grid=(256,1,1) block=(256,1,1) lds=163840
.amdgcn_target "amdgcn-amd-amdhsa--gfx950"
.text
.globl mega_kernel
.p2align 8
.type mega_kernel,@function
mega_kernel:
s_cmp_ge_u32 s2,256
s_cbranch_scc1 done_1
s_load_dwordx4 s[16:19],s[0:1],120
s_load_dword s3,s[0:1],0
s_getpc_b64 s[4:5]
pc_2:
s_sub_u32 s8,s4,pc_2-mega_kernel
s_subb_u32 s9,s5,0
s_and_b32 s9,s9,0xffff
s_mov_b32 s10,code_end-mega_kernel
s_mov_b32 s11,0x20000
v_lshlrev_b32 v180,7,v0
v_cmp_gt_u32 vcc,64,v0
s_cbranch_vccnz nocpf_3
buffer_load_dword v181,v180,s[8:11],0 offen
s_mov_b32 s12,0x8000
buffer_load_dword v182,v180,s[8:11],s12 offen
s_lshr_b32 s12,s2,3
s_and_b32 s12,s12,7
s_add_u32 s12,s12,2
s_lshl_b32 s12,s12,15
buffer_load_dword v183,v180,s[8:11],s12 offen
nocpf_3:
v_and_b32 v1,63,v0
v_lshrrev_b32 v2,6,v0
s_getreg_b32 s51,hwreg(HW_REG_XCC_ID)
v_readfirstlane_b32 s50,v2
s_and_b32 s51,s51,7
s_waitcnt lgkmcnt(0)
s_mov_b32 s20,s18
s_and_b32 s21,s19,0xffff
s_mov_b32 s22,0x10000000
s_mov_b32 s23,0x20000
s_mov_b32 s44,s16
s_and_b32 s45,s17,0xffff
s_mov_b32 s46,0x100
s_mov_b32 s47,0x20000
s_mov_b32 s90,400000
s_mov_b32 s91,s50
v_mov_b32 v187,158976
s_cmp_lg_u32 s50,0
s_cbranch_scc1 norole_4
s_mov_b64 exec,1
v_mov_b32 v184,1
v_mov_b32 v185,0
s_and_b32 s52,s51,3
s_lshl_b32 s52,s52,2
s_lshr_b32 s53,s51,2
s_lshl_b32 s53,s53,7
s_add_u32 s52,s52,s53
buffer_atomic_add v184,v185,s[44:47],s52 offen sc0 sc1
s_mov_b64 exec,-1
buffer_load_dword v181,v180,s[8:11],0 offen
s_mov_b32 s12,0x8000
buffer_load_dword v182,v180,s[8:11],s12 offen
s_lshr_b32 s12,s2,3
s_and_b32 s12,s12,7
s_add_u32 s12,s12,2
s_lshl_b32 s12,s12,15
buffer_load_dword v183,v180,s[8:11],s12 offen
s_mov_b64 exec,1
s_waitcnt vmcnt(3)
ds_write_b32 v187,v184
s_waitcnt lgkmcnt(0)
s_mov_b64 exec,-1
norole_4:
s_barrier
ds_read_b32 v186,v187
s_waitcnt lgkmcnt(0)
v_readfirstlane_b32 s54,v186
s_mov_b32 s56,2
s_lshl_b32 s57,s51,5
s_add_u32 s57,s57,s54
s_cmp_lt_u32 s54,32
s_cselect_b32 s57,s57,999
s_cmp_ge_u32 s57,256
s_cbranch_scc1 verify_6
s_cmp_ge_u32 s57,128
s_cbranch_scc1 pre_8
setup_5:
s_load_dwordx8 s[4:11],s[0:1],8
s_load_dwordx2 s[12:13],s[0:1],40
v_and_b32 v3,15,v1
v_lshrrev_b32 v4,4,v1
v_lshlrev_b32 v16,4,v1
v_lshrrev_b32 v30,2,v1
v_and_b32 v31,3,v1
v_lshlrev_b32 v7,13,v30
v_lshl_add_u32 v7,v31,4,v7
v_lshlrev_b32 v8,11,v30
v_lshl_add_u32 v8,v31,4,v8
s_lshr_b32 s58,s57,5
s_and_b32 s59,s57,31
s_xor_b32 s60,s57,0
s_lshl_b32 s60,s60,6
s_lshl_b32 s61,s50,14
s_lshl_b32 s62,s50,21
s_add_u32 s62,s62,s60
s_lshl_b32 s63,s58,21
s_lshl_b32 s64,s50,19
s_add_u32 s63,s63,s64
s_xor_b32 s64,s59,0
s_lshl_b32 s64,s64,6
s_add_u32 s63,s63,s64
s_waitcnt lgkmcnt(0)
s_mov_b32 s28,s8
s_and_b32 s29,s9,0xffff
s_mov_b32 s30,0x800000
s_mov_b32 s31,0x20000
s_mov_b32 s32,s10
s_and_b32 s33,s11,0xffff
s_mov_b32 s34,0x800000
s_mov_b32 s35,0x20000
s_mov_b32 s36,s6
s_and_b32 s37,s7,0xffff
s_mov_b32 s38,0x800000
s_mov_b32 s39,0x20000
s_mov_b32 s40,s12
s_and_b32 s41,s13,0xffff
s_mov_b32 s42,0x800000
s_mov_b32 s43,0x20000
s_mov_b32 s8,s4
s_and_b32 s9,s5,0xffff
s_mov_b32 s10,0x4000
s_mov_b32 s11,0x20000
v_lshlrev_b32 v9,7,v3
v_lshl_add_u32 v10,v4,11,v9
v_lshl_add_u32 v9,v4,13,v9
s_lshl_b32 s64,s59,2
s_add_u32 s64,s64,s50
s_lshl_b32 s65,s64,16
s_lshl_b32 s66,s58,11
s_add_u32 s65,s65,s66
s_lshl_b32 s66,s64,14
s_lshl_b32 s67,s58,21
s_add_u32 s66,s66,s67
v_and_b32 v9,7,v1
v_lshrrev_b32 v10,3,v1
s_cmp_eq_u32 s58,3
s_cselect_b32 s64,15,3
v_mov_b32 v11,3
v_cmp_eq_u32 vcc,1,v10
s_nop 1
v_cndmask_b32 v11,v11,11,vcc
v_lshlrev_b32 v12,7,v11
v_lshl_add_u32 v12,v9,11,v12
v_mov_b32 v13,s64
v_cmp_eq_u32 vcc,2,v10
s_nop 1
v_cndmask_b32 v11,v11,v13,vcc
v_lshlrev_b32 v11,7,v11
v_lshl_add_u32 v11,v9,13,v11
v_mov_b32 v100,0
v_mov_b32 v101,0
v_mov_b32 v102,0
v_mov_b32 v103,0
s_mov_b32 s53,s65
s_mov_b32 s55,s66
v_and_b32 v22,7,v3
v_lshlrev_b32 v31,11,v22
v_lshl_add_u32 v31,v4,4,v31
s_lshr_b32 s64,s59,3
s_lshl_b32 s64,s64,14
s_and_b32 s65,s59,7
s_lshl_b32 s65,s65,10
s_add_u32 s64,s64,s65
s_lshl_b32 s65,s58,16
s_add_u32 s64,s64,s65
s_add_u32 s64,s64,31195136
s_lshr_b32 s65,s57,3
s_add_u32 s65,s65,96
s_lshl_b32 s65,s65,14
s_and_b32 s66,s57,7
s_lshl_b32 s66,s66,10
s_add_u32 s65,s65,s66
s_add_u32 s65,s65,29360128
v_add_u32 v206,s64,v16
v_add_u32 v207,s65,v16
s_and_b32 s64,s50,1
s_lshl_b32 s64,s64,21
s_lshr_b32 s65,s50,1
s_lshl_b32 s65,s65,13
s_add_u32 s64,s64,s65
buffer_store_dwordx4 v[100:103],v206,s[20:23],s64 offen sc1
buffer_store_dwordx4 v[100:103],v207,s[20:23],s64 offen sc1
s_lshl_b32 s64,s50,20
s_add_u32 s64,s64,23068672
s_cmp_lt_u32 s50,2
s_cselect_b32 s67,s64,0x7fff0000
s_lshl_b32 s65,s57,10
s_add_u32 s65,s65,131072
s_add_u32 s65,s65,s67
buffer_store_dwordx4 v[100:103],v16,s[20:23],s65 offen sc1
s_lshl_b32 s65,s57,9
s_add_u32 s65,s65,s67
s_add_u32 s66,s65,65536
s_mov_b32 exec_hi,0
buffer_store_dwordx4 v[100:103],v16,s[20:23],s65 offen sc1
buffer_store_dwordx4 v[100:103],v16,s[20:23],s66 offen sc1
s_lshl_b32 s65,s57,2
s_add_u32 s65,s65,s64
s_add_u32 s65,s65,524288
s_lshl_b32 s52,s57,7
s_add_u32 s52,s52,21168128
s_mov_b64 exec,1
buffer_store_dword v100,v100,s[20:23],s65 offen sc1
buffer_store_dword v100,v100,s[20:23],s65 offen offset:512 sc1
s_mov_b64 exec,15
buffer_store_dwordx4 v[100:103],v16,s[20:23],s52 offen sc1
s_mov_b64 exec,-1
s_mov_b32 s65,s53
s_mov_b32 s66,s55
v_mov_b32 v37,159008
ds_write_b128 v37,v[100:103]
s_add_u32 s64,s62,0
s_add_u32 m0,s61,0
s_nop 0
buffer_load_dwordx4 v7,s[28:31],s64 offen nt lds
s_add_u32 s64,s62,131072
s_add_u32 m0,s61,1024
s_nop 0
buffer_load_dwordx4 v7,s[28:31],s64 offen nt lds
s_add_u32 s64,s62,262144
s_add_u32 m0,s61,2048
s_nop 0
buffer_load_dwordx4 v7,s[28:31],s64 offen nt lds
s_add_u32 s64,s62,393216
s_add_u32 m0,s61,3072
s_nop 0
buffer_load_dwordx4 v7,s[28:31],s64 offen nt lds
s_add_u32 s64,s62,524288
s_add_u32 m0,s61,4096
s_nop 0
buffer_load_dwordx4 v7,s[28:31],s64 offen nt lds
s_add_u32 s64,s62,655360
s_add_u32 m0,s61,5120
s_nop 0
buffer_load_dwordx4 v7,s[28:31],s64 offen nt lds
s_add_u32 s64,s62,786432
s_add_u32 m0,s61,6144
s_nop 0
buffer_load_dwordx4 v7,s[28:31],s64 offen nt lds
s_add_u32 s64,s62,917504
s_add_u32 m0,s61,7168
s_nop 0
buffer_load_dwordx4 v7,s[28:31],s64 offen nt lds
s_waitcnt vmcnt(8) lgkmcnt(0)
s_barrier
s_cmp_lg_u32 s50,1
s_cbranch_scc1 ws_11
s_and_b32 s64,s56,1
s_lshl_b32 s64,s64,2
s_add_u32 s64,s64,36
s_mov_b64 exec,1
v_mov_b32 v184,1
v_mov_b32 v185,0
buffer_atomic_add v184,v185,s[44:47],s64 offen sc1
s_mov_b64 exec,-1
ws_11:
s_add_u32 s64,s62,1048576
s_add_u32 m0,s61,8192
s_nop 0
buffer_load_dwordx4 v7,s[28:31],s64 offen nt lds
s_add_u32 s64,s62,1179648
s_add_u32 m0,s61,9216
s_nop 0
buffer_load_dwordx4 v7,s[28:31],s64 offen nt lds
s_add_u32 s64,s62,1310720
s_add_u32 m0,s61,10240
s_nop 0
buffer_load_dwordx4 v7,s[28:31],s64 offen nt lds
s_add_u32 s64,s62,1441792
s_add_u32 m0,s61,11264
s_nop 0
buffer_load_dwordx4 v7,s[28:31],s64 offen nt lds
s_add_u32 s64,s62,1572864
s_add_u32 m0,s61,12288
s_nop 0
buffer_load_dwordx4 v7,s[28:31],s64 offen nt lds
s_add_u32 s64,s62,1703936
s_add_u32 m0,s61,13312
s_nop 0
buffer_load_dwordx4 v7,s[28:31],s64 offen nt lds
s_add_u32 s64,s62,1835008
s_add_u32 m0,s61,14336
s_nop 0
buffer_load_dwordx4 v7,s[28:31],s64 offen nt lds
s_add_u32 s64,s62,1966080
s_add_u32 m0,s61,15360
s_nop 0
buffer_load_dwordx4 v7,s[28:31],s64 offen nt lds
s_mov_b64 exec,0xffffff
buffer_load_dword v201,v11,s[32:35],s65 offen
buffer_load_dword v202,v11,s[36:39],s65 offen
s_mov_b64 exec,0xffff
buffer_load_dword v203,v12,s[40:43],s66 offen
s_mov_b64 exec,-1
s_add_u32 s64,s62,0
s_add_u32 m0,s61,65536
s_nop 0
buffer_load_dwordx4 v7,s[32:35],s64 offen nt lds
s_add_u32 s64,s62,131072
s_add_u32 m0,s61,66560
s_nop 0
buffer_load_dwordx4 v7,s[32:35],s64 offen nt lds
s_add_u32 s64,s62,262144
s_add_u32 m0,s61,67584
s_nop 0
buffer_load_dwordx4 v7,s[32:35],s64 offen nt lds
s_add_u32 s64,s62,393216
s_add_u32 m0,s61,68608
s_nop 0
buffer_load_dwordx4 v7,s[32:35],s64 offen nt lds
s_add_u32 s64,s62,524288
s_add_u32 m0,s61,69632
s_nop 0
buffer_load_dwordx4 v7,s[32:35],s64 offen nt lds
s_add_u32 s64,s62,655360
s_add_u32 m0,s61,70656
s_nop 0
buffer_load_dwordx4 v7,s[32:35],s64 offen nt lds
s_add_u32 s64,s62,786432
s_add_u32 m0,s61,71680
s_nop 0
buffer_load_dwordx4 v7,s[32:35],s64 offen nt lds
s_add_u32 s64,s62,917504
s_add_u32 m0,s61,72704
s_nop 0
buffer_load_dwordx4 v7,s[32:35],s64 offen nt lds
s_add_u32 s64,s62,1048576
s_add_u32 m0,s61,73728
s_nop 0
buffer_load_dwordx4 v7,s[32:35],s64 offen nt lds
s_add_u32 s64,s62,1179648
s_add_u32 m0,s61,74752
s_nop 0
buffer_load_dwordx4 v7,s[32:35],s64 offen nt lds
s_add_u32 s64,s62,1310720
s_add_u32 m0,s61,75776
s_nop 0
buffer_load_dwordx4 v7,s[32:35],s64 offen nt lds
s_add_u32 s64,s62,1441792
s_add_u32 m0,s61,76800
s_nop 0
buffer_load_dwordx4 v7,s[32:35],s64 offen nt lds
s_add_u32 s64,s62,1572864
s_add_u32 m0,s61,77824
s_nop 0
buffer_load_dwordx4 v7,s[32:35],s64 offen nt lds
s_add_u32 s64,s62,1703936
s_add_u32 m0,s61,78848
s_nop 0
buffer_load_dwordx4 v7,s[32:35],s64 offen nt lds
s_add_u32 s64,s62,1835008
s_add_u32 m0,s61,79872
s_nop 0
buffer_load_dwordx4 v7,s[32:35],s64 offen nt lds
s_add_u32 s64,s62,1966080
s_add_u32 m0,s61,80896
s_nop 0
buffer_load_dwordx4 v7,s[32:35],s64 offen nt lds
s_lshl_b32 s64,s59,6
buffer_load_dwordx4 v[216:219],v31,s[8:11],s64 offen
v_lshrrev_b32 v184,3,v3
v_bfe_u32 v185,v3,2,1
v_lshrrev_b32 v186,1,v4
v_and_b32 v187,1,v4
v_lshl_add_u32 v188,v184,3,v185
v_lshl_add_u32 v188,v186,4,v188
v_lshl_add_u32 v188,v187,2,v188
v_lshl_add_u32 v189,v184,2,v185
v_lshl_add_u32 v189,v186,3,v189
v_lshl_add_u32 v189,v187,4,v189
v_and_b32 v187,3,v3
v_lshlrev_b32 v187,3,v187
v_lshl_add_u32 v188,v188,6,v187
v_lshl_add_u32 v189,v189,6,v187
s_lshr_b32 s64,s50,1
s_lshl_b32 s64,s64,5
v_add_u32 v190,s64,v188
v_add_u32 v191,0x10000,v190
s_lshl_b32 s64,s64,10
v_add_u32 v192,s64,v189
s_add_u32 s64,s61,0x10000
v_add_u32 v193,s64,v16
s_add_u32 s68,s50,1
s_mov_b32 s69,0
s_waitcnt vmcnt(20)
s_barrier
s_lshl_b32 s64,s57,9
v_mov_b32 v194,s64
s_add_u32 s65,s64,65024
v_mov_b32 v195,s65
v_cmp_lt_u32 vcc,3,v1
s_nop 1
v_cndmask_b32 v194,v194,v195,vcc
s_lshl_b32 s65,s57,10
s_add_u32 s65,s65,130048
v_mov_b32 v195,s65
v_cmp_lt_u32 vcc,7,v1
s_nop 1
v_cndmask_b32 v194,v194,v195,vcc
s_lshl_b32 s65,s57,11
s_add_u32 s65,s65,260096
v_mov_b32 v195,s65
v_cmp_lt_u32 vcc,15,v1
s_nop 1
v_cndmask_b32 v194,v194,v195,vcc
v_lshl_add_u32 v194,v1,7,v194
s_lshl_b32 s65,s58,7
s_add_u32 s65,s65,524288
v_writelane_b32 v194,s65,32
s_add_u32 s65,s65,512
v_writelane_b32 v194,s65,33
s_lshl_b32 s64,s50,20
s_add_u32 s64,s64,23068672
s_mov_b32 exec_hi,3
buffer_load_dword v183,v194,s[20:23],s64 offen sc1
s_mov_b64 exec,-1
s_and_b32 s65,s50,1
s_lshl_b32 s14,s65,19
s_add_u32 s14,s14,s60
s_lshl_b32 s15,s65,19
s_sub_u32 s15,s63,s15
s_lshl_b32 s65,s65,13
s_add_u32 s65,s65,131072
v_mov_b32 v32,v8
v_add_u32 v33,s65,v16
v_add_u32 v34,s65,v189
v_mov_b32 v35,v7
v_add_u32 v36,131072,v190
v_mov_b32 v37,159008
s_bitcmp1_b32 s68,1
s_cbranch_scc0 ws_12
ds_read_b64_tr_b16 a[0:1],v190 offset:0
ds_read_b64_tr_b16 a[2:3],v190 offset:128
ds_read_b64_tr_b16 a[4:5],v190 offset:2048
ds_read_b64_tr_b16 a[6:7],v190 offset:2176
ds_read_b64_tr_b16 a[8:9],v190 offset:4096
ds_read_b64_tr_b16 a[10:11],v190 offset:4224
ds_read_b64_tr_b16 a[12:13],v190 offset:6144
ds_read_b64_tr_b16 a[14:15],v190 offset:6272
s_waitcnt lgkmcnt(0)
ds_read_b64_tr_b16 a[16:17],v190 offset:8192
ds_read_b64_tr_b16 a[18:19],v190 offset:8320
ds_read_b64_tr_b16 a[20:21],v190 offset:10240
ds_read_b64_tr_b16 a[22:23],v190 offset:10368
ds_read_b64_tr_b16 a[24:25],v190 offset:12288
ds_read_b64_tr_b16 a[26:27],v190 offset:12416
ds_read_b64_tr_b16 a[28:29],v190 offset:14336
ds_read_b64_tr_b16 a[30:31],v190 offset:14464
s_waitcnt lgkmcnt(0)
ds_read_b64_tr_b16 a[32:33],v190 offset:16384
ds_read_b64_tr_b16 a[34:35],v190 offset:16512
ds_read_b64_tr_b16 a[36:37],v190 offset:18432
ds_read_b64_tr_b16 a[38:39],v190 offset:18560
ds_read_b64_tr_b16 a[40:41],v190 offset:20480
ds_read_b64_tr_b16 a[42:43],v190 offset:20608
ds_read_b64_tr_b16 a[44:45],v190 offset:22528
ds_read_b64_tr_b16 a[46:47],v190 offset:22656
s_waitcnt lgkmcnt(0)
ds_read_b64_tr_b16 a[48:49],v190 offset:24576
ds_read_b64_tr_b16 a[50:51],v190 offset:24704
ds_read_b64_tr_b16 a[52:53],v190 offset:26624
ds_read_b64_tr_b16 a[54:55],v190 offset:26752
ds_read_b64_tr_b16 a[56:57],v190 offset:28672
ds_read_b64_tr_b16 a[58:59],v190 offset:28800
ds_read_b64_tr_b16 a[60:61],v190 offset:30720
ds_read_b64_tr_b16 a[62:63],v190 offset:30848
s_waitcnt lgkmcnt(0)
ds_read_b64_tr_b16 a[64:65],v190 offset:32768
ds_read_b64_tr_b16 a[66:67],v190 offset:32896
ds_read_b64_tr_b16 a[68:69],v190 offset:34816
ds_read_b64_tr_b16 a[70:71],v190 offset:34944
ds_read_b64_tr_b16 a[72:73],v190 offset:36864
ds_read_b64_tr_b16 a[74:75],v190 offset:36992
ds_read_b64_tr_b16 a[76:77],v190 offset:38912
ds_read_b64_tr_b16 a[78:79],v190 offset:39040
s_waitcnt lgkmcnt(0)
ds_read_b64_tr_b16 a[80:81],v190 offset:40960
ds_read_b64_tr_b16 a[82:83],v190 offset:41088
ds_read_b64_tr_b16 a[84:85],v190 offset:43008
ds_read_b64_tr_b16 a[86:87],v190 offset:43136
ds_read_b64_tr_b16 a[88:89],v190 offset:45056
ds_read_b64_tr_b16 a[90:91],v190 offset:45184
ds_read_b64_tr_b16 a[92:93],v190 offset:47104
ds_read_b64_tr_b16 a[94:95],v190 offset:47232
s_waitcnt lgkmcnt(0)
ds_read_b64_tr_b16 a[96:97],v190 offset:49152
ds_read_b64_tr_b16 a[98:99],v190 offset:49280
ds_read_b64_tr_b16 a[100:101],v190 offset:51200
ds_read_b64_tr_b16 a[102:103],v190 offset:51328
ds_read_b64_tr_b16 a[104:105],v190 offset:53248
ds_read_b64_tr_b16 a[106:107],v190 offset:53376
ds_read_b64_tr_b16 a[108:109],v190 offset:55296
ds_read_b64_tr_b16 a[110:111],v190 offset:55424
s_waitcnt lgkmcnt(0)
ds_read_b64_tr_b16 a[112:113],v190 offset:57344
ds_read_b64_tr_b16 a[114:115],v190 offset:57472
ds_read_b64_tr_b16 a[116:117],v190 offset:59392
ds_read_b64_tr_b16 a[118:119],v190 offset:59520
ds_read_b64_tr_b16 a[120:121],v190 offset:61440
ds_read_b64_tr_b16 a[122:123],v190 offset:61568
ds_read_b64_tr_b16 a[124:125],v190 offset:63488
ds_read_b64_tr_b16 a[126:127],v190 offset:63616
s_waitcnt lgkmcnt(0)
s_waitcnt vmcnt(0)
s_barrier
ds_read_b64_tr_b16 a[128:129],v191 offset:0
ds_read_b64_tr_b16 a[130:131],v191 offset:128
ds_read_b64_tr_b16 a[132:133],v191 offset:2048
ds_read_b64_tr_b16 a[134:135],v191 offset:2176
ds_read_b64_tr_b16 a[136:137],v191 offset:4096
ds_read_b64_tr_b16 a[138:139],v191 offset:4224
ds_read_b64_tr_b16 a[140:141],v191 offset:6144
ds_read_b64_tr_b16 a[142:143],v191 offset:6272
s_waitcnt lgkmcnt(0)
ds_read_b64_tr_b16 a[144:145],v191 offset:8192
ds_read_b64_tr_b16 a[146:147],v191 offset:8320
ds_read_b64_tr_b16 a[148:149],v191 offset:10240
ds_read_b64_tr_b16 a[150:151],v191 offset:10368
ds_read_b64_tr_b16 a[152:153],v191 offset:12288
ds_read_b64_tr_b16 a[154:155],v191 offset:12416
ds_read_b64_tr_b16 a[156:157],v191 offset:14336
ds_read_b64_tr_b16 a[158:159],v191 offset:14464
s_waitcnt lgkmcnt(0)
ds_read_b64_tr_b16 a[160:161],v191 offset:16384
ds_read_b64_tr_b16 a[162:163],v191 offset:16512
ds_read_b64_tr_b16 a[164:165],v191 offset:18432
ds_read_b64_tr_b16 a[166:167],v191 offset:18560
ds_read_b64_tr_b16 a[168:169],v191 offset:20480
ds_read_b64_tr_b16 a[170:171],v191 offset:20608
ds_read_b64_tr_b16 a[172:173],v191 offset:22528
ds_read_b64_tr_b16 a[174:175],v191 offset:22656
s_waitcnt lgkmcnt(0)
ds_read_b64_tr_b16 a[176:177],v191 offset:24576
ds_read_b64_tr_b16 a[178:179],v191 offset:24704
ds_read_b64_tr_b16 a[180:181],v191 offset:26624
ds_read_b64_tr_b16 a[182:183],v191 offset:26752
ds_read_b64_tr_b16 a[184:185],v191 offset:28672
ds_read_b64_tr_b16 a[186:187],v191 offset:28800
ds_read_b64_tr_b16 a[188:189],v191 offset:30720
ds_read_b64_tr_b16 a[190:191],v191 offset:30848
s_waitcnt lgkmcnt(0)
ds_read_b64_tr_b16 a[192:193],v191 offset:32768
ds_read_b64_tr_b16 a[194:195],v191 offset:32896
ds_read_b64_tr_b16 a[196:197],v191 offset:34816
ds_read_b64_tr_b16 a[198:199],v191 offset:34944
ds_read_b64_tr_b16 a[200:201],v191 offset:36864
ds_read_b64_tr_b16 a[202:203],v191 offset:36992
ds_read_b64_tr_b16 a[204:205],v191 offset:38912
ds_read_b64_tr_b16 a[206:207],v191 offset:39040
s_waitcnt lgkmcnt(0)
ds_read_b64_tr_b16 a[208:209],v191 offset:40960
ds_read_b64_tr_b16 a[210:211],v191 offset:41088
ds_read_b64_tr_b16 a[212:213],v191 offset:43008
ds_read_b64_tr_b16 a[214:215],v191 offset:43136
ds_read_b64_tr_b16 a[216:217],v191 offset:45056
ds_read_b64_tr_b16 a[218:219],v191 offset:45184
ds_read_b64_tr_b16 a[220:221],v191 offset:47104
ds_read_b64_tr_b16 a[222:223],v191 offset:47232
s_waitcnt lgkmcnt(0)
ds_read_b64_tr_b16 a[224:225],v191 offset:49152
ds_read_b64_tr_b16 a[226:227],v191 offset:49280
ds_read_b64_tr_b16 a[228:229],v191 offset:51200
ds_read_b64_tr_b16 a[230:231],v191 offset:51328
ds_read_b64_tr_b16 a[232:233],v191 offset:53248
ds_read_b64_tr_b16 a[234:235],v191 offset:53376
ds_read_b64_tr_b16 a[236:237],v191 offset:55296
ds_read_b64_tr_b16 a[238:239],v191 offset:55424
s_waitcnt lgkmcnt(0)
ds_read_b64_tr_b16 a[240:241],v191 offset:57344
ds_read_b64_tr_b16 a[242:243],v191 offset:57472
ds_read_b64_tr_b16 a[244:245],v191 offset:59392
ds_read_b64_tr_b16 a[246:247],v191 offset:59520
ds_read_b64_tr_b16 a[248:249],v191 offset:61440
ds_read_b64_tr_b16 a[250:251],v191 offset:61568
ds_read_b64_tr_b16 a[252:253],v191 offset:63488
ds_read_b64_tr_b16 a[254:255],v191 offset:63616
s_waitcnt lgkmcnt(0)
s_branch ws_14
ws_12:
s_add_u32 s64,s14,0
buffer_load_dwordx4 a[0:3],v35,s[36:39],s64 offen nt
s_add_u32 s64,s14,131072
buffer_load_dwordx4 a[4:7],v35,s[36:39],s64 offen nt
s_add_u32 s64,s14,262144
buffer_load_dwordx4 a[8:11],v35,s[36:39],s64 offen nt
s_add_u32 s64,s14,393216
buffer_load_dwordx4 a[12:15],v35,s[36:39],s64 offen nt
s_add_u32 s64,s14,1048576
buffer_load_dwordx4 a[16:19],v35,s[36:39],s64 offen nt
s_add_u32 s64,s14,1179648
buffer_load_dwordx4 a[20:23],v35,s[36:39],s64 offen nt
s_add_u32 s64,s14,1310720
buffer_load_dwordx4 a[24:27],v35,s[36:39],s64 offen nt
s_add_u32 s64,s14,1441792
buffer_load_dwordx4 a[28:31],v35,s[36:39],s64 offen nt
s_add_u32 s64,s14,2097152
buffer_load_dwordx4 a[32:35],v35,s[36:39],s64 offen nt
s_add_u32 s64,s14,2228224
buffer_load_dwordx4 a[36:39],v35,s[36:39],s64 offen nt
s_add_u32 s64,s14,2359296
buffer_load_dwordx4 a[40:43],v35,s[36:39],s64 offen nt
s_add_u32 s64,s14,2490368
buffer_load_dwordx4 a[44:47],v35,s[36:39],s64 offen nt
s_add_u32 s64,s14,3145728
buffer_load_dwordx4 a[48:51],v35,s[36:39],s64 offen nt
s_add_u32 s64,s14,3276800
buffer_load_dwordx4 a[52:55],v35,s[36:39],s64 offen nt
s_add_u32 s64,s14,3407872
buffer_load_dwordx4 a[56:59],v35,s[36:39],s64 offen nt
s_add_u32 s64,s14,3538944
buffer_load_dwordx4 a[60:63],v35,s[36:39],s64 offen nt
s_add_u32 s64,s14,4194304
buffer_load_dwordx4 a[64:67],v35,s[36:39],s64 offen nt
s_add_u32 s64,s14,4325376
buffer_load_dwordx4 a[68:71],v35,s[36:39],s64 offen nt
s_add_u32 s64,s14,4456448
buffer_load_dwordx4 a[72:75],v35,s[36:39],s64 offen nt
s_add_u32 s64,s14,4587520
buffer_load_dwordx4 a[76:79],v35,s[36:39],s64 offen nt
s_add_u32 s64,s14,5242880
buffer_load_dwordx4 a[80:83],v35,s[36:39],s64 offen nt
s_add_u32 s64,s14,5373952
buffer_load_dwordx4 a[84:87],v35,s[36:39],s64 offen nt
s_add_u32 s64,s14,5505024
buffer_load_dwordx4 a[88:91],v35,s[36:39],s64 offen nt
s_add_u32 s64,s14,5636096
buffer_load_dwordx4 a[92:95],v35,s[36:39],s64 offen nt
s_add_u32 s64,s14,6291456
buffer_load_dwordx4 a[96:99],v35,s[36:39],s64 offen nt
s_add_u32 s64,s14,6422528
buffer_load_dwordx4 a[100:103],v35,s[36:39],s64 offen nt
s_add_u32 s64,s14,6553600
buffer_load_dwordx4 a[104:107],v35,s[36:39],s64 offen nt
s_add_u32 s64,s14,6684672
buffer_load_dwordx4 a[108:111],v35,s[36:39],s64 offen nt
s_add_u32 s64,s14,7340032
buffer_load_dwordx4 a[112:115],v35,s[36:39],s64 offen nt
s_add_u32 s64,s14,7471104
buffer_load_dwordx4 a[116:119],v35,s[36:39],s64 offen nt
s_add_u32 s64,s14,7602176
buffer_load_dwordx4 a[120:123],v35,s[36:39],s64 offen nt
s_add_u32 s64,s14,7733248
buffer_load_dwordx4 a[124:127],v35,s[36:39],s64 offen nt
s_add_u32 s64,s15,0
buffer_load_dwordx4 a[128:131],v32,s[40:43],s64 offen nt
s_add_u32 s64,s15,32768
buffer_load_dwordx4 a[132:135],v32,s[40:43],s64 offen nt
s_add_u32 s64,s15,65536
buffer_load_dwordx4 a[136:139],v32,s[40:43],s64 offen nt
s_add_u32 s64,s15,98304
buffer_load_dwordx4 a[140:143],v32,s[40:43],s64 offen nt
s_add_u32 s64,s15,131072
buffer_load_dwordx4 a[144:147],v32,s[40:43],s64 offen nt
s_add_u32 s64,s15,163840
buffer_load_dwordx4 a[148:151],v32,s[40:43],s64 offen nt
s_add_u32 s64,s15,196608
buffer_load_dwordx4 a[152:155],v32,s[40:43],s64 offen nt
s_add_u32 s64,s15,229376
buffer_load_dwordx4 a[156:159],v32,s[40:43],s64 offen nt
s_add_u32 s64,s15,262144
buffer_load_dwordx4 a[160:163],v32,s[40:43],s64 offen nt
s_add_u32 s64,s15,294912
buffer_load_dwordx4 a[164:167],v32,s[40:43],s64 offen nt
s_add_u32 s64,s15,327680
buffer_load_dwordx4 a[168:171],v32,s[40:43],s64 offen nt
s_add_u32 s64,s15,360448
buffer_load_dwordx4 a[172:175],v32,s[40:43],s64 offen nt
s_waitcnt vmcnt(44)
s_barrier
ws_14:
v_mov_b32 v187,158976
s_cmp_lg_u32 s50,1
s_cbranch_scc1 sh0_17
s_mov_b32 s53,0
stl_18:
s_add_u32 s64,s52,32
s_buffer_load_dwordx8 s[72:79],s[20:23],s52 glc
s_buffer_load_dwordx8 s[80:87],s[20:23],s64 glc
s_waitcnt lgkmcnt(0)
s_min_u32 s72,s72,s80
s_min_u32 s73,s73,s81
s_min_u32 s74,s74,s82
s_min_u32 s75,s75,s83
s_min_u32 s76,s76,s84
s_min_u32 s77,s77,s85
s_min_u32 s78,s78,s86
s_min_u32 s79,s79,s87
s_min_u32 s72,s72,s76
s_min_u32 s73,s73,s77
s_min_u32 s74,s74,s78
s_min_u32 s75,s75,s79
s_min_u32 s72,s72,s74
s_min_u32 s73,s73,s75
s_min_u32 s64,s72,s73
s_mov_b32 s65,0
s_and_b32 s61,s64,1
s_lshl_b32 s61,s61,13
s_cmp_lg_u32 s64,0
s_cbranch_scc1 stok_19
s_sub_u32 s90,s90,1
s_cmp_lt_i32 s90,0
s_cbranch_scc1 stok_19
s_add_u32 s53,s53,1
s_and_b32 s64,s53,31
s_cbranch_scc1 stl_18
s_cmp_eq_u32 s56,1
s_cbranch_scc1 stl_18
v_and_b32 v184,3,v1
v_bfe_u32 v185,v1,2,1
v_lshlrev_b32 v184,2,v184
v_lshl_add_u32 v184,v185,7,v184
v_writelane_b32 v184,32,8
s_mov_b64 exec,0x1ff
vpoll_20:
buffer_load_dword v185,v184,s[44:47],0 offen sc1
s_waitcnt vmcnt(0)
vfirst_23:
v_readlane_b32 s92,v185,0
v_readlane_b32 s93,v185,1
v_readlane_b32 s94,v185,2
v_readlane_b32 s95,v185,3
v_readlane_b32 s96,v185,4
v_readlane_b32 s97,v185,5
v_readlane_b32 s98,v185,6
v_readlane_b32 s99,v185,7
v_readlane_b32 s61,v185,8
s_add_u32 s64,s92,s93
s_add_u32 s64,s64,s94
s_add_u32 s64,s64,s95
s_add_u32 s64,s64,s96
s_add_u32 s64,s64,s97
s_add_u32 s64,s64,s98
s_add_u32 s64,s64,s99
s_min_u32 s65,s92,s93
s_min_u32 s66,s94,s95
s_min_u32 s65,s65,s66
s_min_u32 s66,s96,s97
s_min_u32 s65,s65,s66
s_min_u32 s66,s98,s99
s_min_u32 s65,s65,s66
s_cmp_lt_u32 s65,32
s_cselect_b32 s65,1,0
s_cmp_lt_u32 s64,256
s_cbranch_scc1 vslp_22
s_branch vgot_21
vslp_22:
s_sleep 8
s_sub_u32 s90,s90,1
s_cmp_gt_i32 s90,0
s_cbranch_scc1 vpoll_20
vgot_21:
s_mov_b64 exec,-1
s_and_b32 s61,s61,1
s_lshl_b32 s61,s61,13
s_mov_b32 s66,s54
s_cmp_gt_u32 s51,0
s_cselect_b32 s64,s92,0
s_add_u32 s66,s66,s64
s_cmp_gt_u32 s51,1
s_cselect_b32 s64,s93,0
s_add_u32 s66,s66,s64
s_cmp_gt_u32 s51,2
s_cselect_b32 s64,s94,0
s_add_u32 s66,s66,s64
s_cmp_gt_u32 s51,3
s_cselect_b32 s64,s95,0
s_add_u32 s66,s66,s64
s_cmp_gt_u32 s51,4
s_cselect_b32 s64,s96,0
s_add_u32 s66,s66,s64
s_cmp_gt_u32 s51,5
s_cselect_b32 s64,s97,0
s_add_u32 s66,s66,s64
s_cmp_gt_u32 s51,6
s_cselect_b32 s64,s98,0
s_add_u32 s66,s66,s64
s_cmp_eq_u32 s65,0
s_cbranch_scc1 stl_18
stok_19:
v_mov_b32 v184,s65
v_mov_b32 v185,s66
v_mov_b32 v186,s61
ds_write_b96 v187,v[184:186] offset:16
s_waitcnt lgkmcnt(0)
sh0_17:
s_barrier
ds_read_b96 v[184:186],v187 offset:16
s_waitcnt lgkmcnt(0)
v_readfirstlane_b32 s65,v184
v_readfirstlane_b32 s66,v185
v_readfirstlane_b32 s61,v186
s_cmp_lg_u32 s65,0
s_cbranch_scc1 slowrole_10
s_and_b32 s56,s56,1
s_branch loops_7
pre_8:
s_sub_u32 s55,s57,128
s_load_dwordx4 s[4:7],s[0:1],96
s_load_dwordx2 s[8:9],s[0:1],0
v_and_b32 v1,63,v0
v_lshrrev_b32 v2,6,v0
v_and_b32 v3,7,v0
v_lshrrev_b32 v4,3,v0
v_mul_u32_u24 v5,12288,v4
v_lshl_add_u32 v5,v3,4,v5
v_lshlrev_b32 v6,1,v4
s_and_b32 s24,s55,31
s_lshr_b32 s25,s55,5
s_lshl_b32 s26,s24,7
s_mul_i32 s27,s25,3145728
s_add_u32 s26,s26,s27
s_lshl_b32 s27,s25,9
s_waitcnt lgkmcnt(0)
s_mov_b32 s12,s4
s_and_b32 s13,s5,0xffff
s_mov_b32 s14,0x800
s_mov_b32 s15,0x20000
s_mov_b32 s28,s6
s_and_b32 s29,s7,0xffff
s_mov_b32 s30,0xc00000
s_mov_b32 s31,0x20000
s_mov_b32 s32,s8
s_and_b32 s33,s9,0xffff
s_mov_b32 s34,0x400000
s_mov_b32 s35,0x20000
buffer_load_dwordx4 v[64:67],v5,s[28:31],s26 offen nt
s_add_u32 s26,s26,393216
buffer_load_dwordx4 v[68:71],v5,s[28:31],s26 offen nt
s_add_u32 s26,s26,393216
buffer_load_dwordx4 v[72:75],v5,s[28:31],s26 offen nt
s_add_u32 s26,s26,393216
buffer_load_dwordx4 v[76:79],v5,s[28:31],s26 offen nt
s_add_u32 s26,s26,393216
buffer_load_dwordx4 v[80:83],v5,s[28:31],s26 offen nt
s_add_u32 s26,s26,393216
buffer_load_dwordx4 v[84:87],v5,s[28:31],s26 offen nt
s_add_u32 s26,s26,393216
buffer_load_dwordx4 v[88:91],v5,s[28:31],s26 offen nt
s_add_u32 s26,s26,393216
buffer_load_dwordx4 v[92:95],v5,s[28:31],s26 offen nt
buffer_load_ushort v96,v6,s[12:15],s27 offen offset:0
buffer_load_ushort v97,v6,s[12:15],s27 offen offset:64
buffer_load_ushort v98,v6,s[12:15],s27 offen offset:128
buffer_load_ushort v99,v6,s[12:15],s27 offen offset:192
buffer_load_ushort v100,v6,s[12:15],s27 offen offset:256
buffer_load_ushort v101,v6,s[12:15],s27 offen offset:320
buffer_load_ushort v102,v6,s[12:15],s27 offen offset:384
buffer_load_ushort v103,v6,s[12:15],s27 offen offset:448
v_and_b32 v3,3,v1
v_lshrrev_b32 v4,2,v1
v_lshl_add_u32 v5,v2,2,v3
v_lshlrev_b32 v5,11,v5
v_lshl_add_u32 v5,v4,5,v5
s_lshl_b32 s36,s55,15
s_cmp_lt_u32 s55,16
s_cselect_b32 s42,s36,0x7fff0000
s_cselect_b32 s36,0x7fff0000,s36
buffer_load_dwordx4 v[8:11],v5,s[32:35],s42 offen offset:0
buffer_load_dwordx4 v[12:15],v5,s[32:35],s42 offen offset:16
buffer_load_dwordx4 v[16:19],v5,s[32:35],s42 offen offset:512
buffer_load_dwordx4 v[20:23],v5,s[32:35],s42 offen offset:528
buffer_load_dwordx4 v[24:27],v5,s[32:35],s42 offen offset:1024
buffer_load_dwordx4 v[28:31],v5,s[32:35],s42 offen offset:1040
buffer_load_dwordx4 v[32:35],v5,s[32:35],s42 offen offset:1536
buffer_load_dwordx4 v[36:39],v5,s[32:35],s42 offen offset:1552
v_lshrrev_b32 v6,1,v4
v_lshlrev_b32 v6,11,v6
v_and_b32 v7,1,v4
v_lshl_add_u32 v6,v7,9,v6
v_and_b32 v7,1,v2
v_lshl_add_u32 v6,v7,10,v6
v_lshrrev_b32 v7,1,v2
v_lshl_add_u32 v7,v7,2,v3
v_lshl_add_u32 v6,v7,4,v6
v_lshlrev_b32 v4,6,v4
s_lshr_b32 s37,s55,1
s_lshl_b32 s37,s37,16
s_and_b32 s38,s55,1
s_lshl_b32 s38,s38,7
s_add_u32 s37,s37,s38
s_add_u32 s37,s37,57344
s_mov_b32 s38,0xbfb8aa3b
s_mov_b32 s39,0xffff0000
s_cmp_lg_u32 s50,1
s_cbranch_scc1 nz_24
s_lshl_b32 s40,s55,9
s_add_u32 s40,s40,21037056
v_lshl_add_u32 v104,v1,4,s40
s_lshl_b32 s41,s55,7
s_add_u32 s41,s41,21102592
v_writelane_b32 v104,s41,32
v_mov_b32 v108,0
v_mov_b32 v109,0
v_mov_b32 v110,0
v_mov_b32 v111,0
s_mov_b32 exec_hi,1
buffer_store_dwordx4 v[108:111],v104,s[20:23],0 offen sc1
s_mov_b64 exec,-1
nz_24:
v_mov_b32 v112,0
v_mov_b32 v113,0
v_mov_b32 v114,0
v_mov_b32 v115,0
v_mov_b32 v116,0
v_mov_b32 v117,0
v_mov_b32 v118,0
v_mov_b32 v119,0
s_waitcnt vmcnt(8)
v_lshlrev_b32 v96,16,v96
v_mul_f32 v104,s38,v96
v_exp_f32 v104,v104
s_nop 0
v_add_f32 v104,1.0,v104
v_rcp_f32 v104,v104
s_nop 0
v_mul_f32 v104,v104,v96
v_cvt_pk_bf16_f32 v104,v104,v104
v_and_b32 v96,s39,v104
v_lshlrev_b32 v105,16,v64
v_and_b32 v106,s39,v64
v_fmac_f32 v112,v105,v96
v_fmac_f32 v113,v106,v96
v_lshlrev_b32 v105,16,v65
v_and_b32 v106,s39,v65
v_fmac_f32 v114,v105,v96
v_fmac_f32 v115,v106,v96
v_lshlrev_b32 v105,16,v66
v_and_b32 v106,s39,v66
v_fmac_f32 v116,v105,v96
v_fmac_f32 v117,v106,v96
v_lshlrev_b32 v105,16,v67
v_and_b32 v106,s39,v67
v_fmac_f32 v118,v105,v96
v_fmac_f32 v119,v106,v96
v_lshlrev_b32 v97,16,v97
v_mul_f32 v104,s38,v97
v_exp_f32 v104,v104
s_nop 0
v_add_f32 v104,1.0,v104
v_rcp_f32 v104,v104
s_nop 0
v_mul_f32 v104,v104,v97
v_cvt_pk_bf16_f32 v104,v104,v104
v_and_b32 v97,s39,v104
v_lshlrev_b32 v105,16,v68
v_and_b32 v106,s39,v68
v_fmac_f32 v112,v105,v97
v_fmac_f32 v113,v106,v97
v_lshlrev_b32 v105,16,v69
v_and_b32 v106,s39,v69
v_fmac_f32 v114,v105,v97
v_fmac_f32 v115,v106,v97
v_lshlrev_b32 v105,16,v70
v_and_b32 v106,s39,v70
v_fmac_f32 v116,v105,v97
v_fmac_f32 v117,v106,v97
v_lshlrev_b32 v105,16,v71
v_and_b32 v106,s39,v71
v_fmac_f32 v118,v105,v97
v_fmac_f32 v119,v106,v97
v_lshlrev_b32 v98,16,v98
v_mul_f32 v104,s38,v98
v_exp_f32 v104,v104
s_nop 0
v_add_f32 v104,1.0,v104
v_rcp_f32 v104,v104
s_nop 0
v_mul_f32 v104,v104,v98
v_cvt_pk_bf16_f32 v104,v104,v104
v_and_b32 v98,s39,v104
v_lshlrev_b32 v105,16,v72
v_and_b32 v106,s39,v72
v_fmac_f32 v112,v105,v98
v_fmac_f32 v113,v106,v98
v_lshlrev_b32 v105,16,v73
v_and_b32 v106,s39,v73
v_fmac_f32 v114,v105,v98
v_fmac_f32 v115,v106,v98
v_lshlrev_b32 v105,16,v74
v_and_b32 v106,s39,v74
v_fmac_f32 v116,v105,v98
v_fmac_f32 v117,v106,v98
v_lshlrev_b32 v105,16,v75
v_and_b32 v106,s39,v75
v_fmac_f32 v118,v105,v98
v_fmac_f32 v119,v106,v98
v_lshlrev_b32 v99,16,v99
v_mul_f32 v104,s38,v99
v_exp_f32 v104,v104
s_nop 0
v_add_f32 v104,1.0,v104
v_rcp_f32 v104,v104
s_nop 0
v_mul_f32 v104,v104,v99
v_cvt_pk_bf16_f32 v104,v104,v104
v_and_b32 v99,s39,v104
v_lshlrev_b32 v105,16,v76
v_and_b32 v106,s39,v76
v_fmac_f32 v112,v105,v99
v_fmac_f32 v113,v106,v99
v_lshlrev_b32 v105,16,v77
v_and_b32 v106,s39,v77
v_fmac_f32 v114,v105,v99
v_fmac_f32 v115,v106,v99
v_lshlrev_b32 v105,16,v78
v_and_b32 v106,s39,v78
v_fmac_f32 v116,v105,v99
v_fmac_f32 v117,v106,v99
v_lshlrev_b32 v105,16,v79
v_and_b32 v106,s39,v79
v_fmac_f32 v118,v105,v99
v_fmac_f32 v119,v106,v99
v_lshlrev_b32 v100,16,v100
v_mul_f32 v104,s38,v100
v_exp_f32 v104,v104
s_nop 0
v_add_f32 v104,1.0,v104
v_rcp_f32 v104,v104
s_nop 0
v_mul_f32 v104,v104,v100
v_cvt_pk_bf16_f32 v104,v104,v104
v_and_b32 v100,s39,v104
v_lshlrev_b32 v105,16,v80
v_and_b32 v106,s39,v80
v_fmac_f32 v112,v105,v100
v_fmac_f32 v113,v106,v100
v_lshlrev_b32 v105,16,v81
v_and_b32 v106,s39,v81
v_fmac_f32 v114,v105,v100
v_fmac_f32 v115,v106,v100
v_lshlrev_b32 v105,16,v82
v_and_b32 v106,s39,v82
v_fmac_f32 v116,v105,v100
v_fmac_f32 v117,v106,v100
v_lshlrev_b32 v105,16,v83
v_and_b32 v106,s39,v83
v_fmac_f32 v118,v105,v100
v_fmac_f32 v119,v106,v100
v_lshlrev_b32 v101,16,v101
v_mul_f32 v104,s38,v101
v_exp_f32 v104,v104
s_nop 0
v_add_f32 v104,1.0,v104
v_rcp_f32 v104,v104
s_nop 0
v_mul_f32 v104,v104,v101
v_cvt_pk_bf16_f32 v104,v104,v104
v_and_b32 v101,s39,v104
v_lshlrev_b32 v105,16,v84
v_and_b32 v106,s39,v84
v_fmac_f32 v112,v105,v101
v_fmac_f32 v113,v106,v101
v_lshlrev_b32 v105,16,v85
v_and_b32 v106,s39,v85
v_fmac_f32 v114,v105,v101
v_fmac_f32 v115,v106,v101
v_lshlrev_b32 v105,16,v86
v_and_b32 v106,s39,v86
v_fmac_f32 v116,v105,v101
v_fmac_f32 v117,v106,v101
v_lshlrev_b32 v105,16,v87
v_and_b32 v106,s39,v87
v_fmac_f32 v118,v105,v101
v_fmac_f32 v119,v106,v101
v_lshlrev_b32 v102,16,v102
v_mul_f32 v104,s38,v102
v_exp_f32 v104,v104
s_nop 0
v_add_f32 v104,1.0,v104
v_rcp_f32 v104,v104
s_nop 0
v_mul_f32 v104,v104,v102
v_cvt_pk_bf16_f32 v104,v104,v104
v_and_b32 v102,s39,v104
v_lshlrev_b32 v105,16,v88
v_and_b32 v106,s39,v88
v_fmac_f32 v112,v105,v102
v_fmac_f32 v113,v106,v102
v_lshlrev_b32 v105,16,v89
v_and_b32 v106,s39,v89
v_fmac_f32 v114,v105,v102
v_fmac_f32 v115,v106,v102
v_lshlrev_b32 v105,16,v90
v_and_b32 v106,s39,v90
v_fmac_f32 v116,v105,v102
v_fmac_f32 v117,v106,v102
v_lshlrev_b32 v105,16,v91
v_and_b32 v106,s39,v91
v_fmac_f32 v118,v105,v102
v_fmac_f32 v119,v106,v102
v_lshlrev_b32 v103,16,v103
v_mul_f32 v104,s38,v103
v_exp_f32 v104,v104
s_nop 0
v_add_f32 v104,1.0,v104
v_rcp_f32 v104,v104
s_nop 0
v_mul_f32 v104,v104,v103
v_cvt_pk_bf16_f32 v104,v104,v104
v_and_b32 v103,s39,v104
v_lshlrev_b32 v105,16,v92
v_and_b32 v106,s39,v92
v_fmac_f32 v112,v105,v103
v_fmac_f32 v113,v106,v103
v_lshlrev_b32 v105,16,v93
v_and_b32 v106,s39,v93
v_fmac_f32 v114,v105,v103
v_fmac_f32 v115,v106,v103
v_lshlrev_b32 v105,16,v94
v_and_b32 v106,s39,v94
v_fmac_f32 v116,v105,v103
v_fmac_f32 v117,v106,v103
v_lshlrev_b32 v105,16,v95
v_and_b32 v106,s39,v95
v_fmac_f32 v118,v105,v103
v_fmac_f32 v119,v106,v103
v_permlane32_swap_b32 v112,v116
v_permlane32_swap_b32 v113,v117
v_permlane32_swap_b32 v114,v118
v_permlane32_swap_b32 v115,v119
v_add_f32 v112,v112,v116
v_add_f32 v113,v113,v117
v_add_f32 v114,v114,v118
v_add_f32 v115,v115,v119
s_nop 0
v_permlane16_swap_b32 v112,v114
v_permlane16_swap_b32 v113,v115
v_add_f32 v112,v112,v114
v_add_f32 v113,v113,v115
s_nop 0
v_add_f32_dpp v112,v112,v112 row_ror:8 row_mask:0xf bank_mask:0xf
v_add_f32_dpp v113,v113,v113 row_ror:8 row_mask:0xf bank_mask:0xf
v_and_b32 v104,7,v1
v_lshlrev_b32 v104,5,v104
v_lshrrev_b32 v105,5,v1
v_lshl_add_u32 v104,v105,4,v104
v_bfe_u32 v105,v1,4,1
v_lshl_add_u32 v104,v105,3,v104
v_lshl_add_u32 v104,v2,8,v104
ds_write_b64 v104,v[112:113]
v_lshlrev_b32 v105,2,v1
s_lshl_b32 s40,s25,13
s_lshl_b32 s41,s24,8
s_add_u32 s40,s40,s41
s_add_u32 s40,s40,24576
s_waitcnt lgkmcnt(0)
s_barrier
s_cmp_lg_u32 s50,0
s_cbranch_scc1 m1n0_25
ds_read_b32 v112,v105 offset:0
ds_read_b32 v113,v105 offset:256
ds_read_b32 v114,v105 offset:512
ds_read_b32 v115,v105 offset:768
s_waitcnt lgkmcnt(0)
v_add_f32 v112,v112,v113
v_add_f32 v114,v114,v115
v_add_f32 v112,v112,v114
buffer_store_dword v112,v105,s[20:23],s40 offen sc1
m1n0_25:
s_waitcnt vmcnt(0)
s_barrier
s_cmp_lg_u32 s50,0
s_cbranch_scc1 post_9
s_mov_b64 exec,1
v_mov_b32 v184,1
v_mov_b32 v185,0
s_and_b32 s52,s56,1
s_lshl_b32 s52,s52,2
s_add_u32 s52,s52,160
buffer_atomic_add v184,v185,s[44:47],s52 offen sc0 sc1
s_waitcnt vmcnt(0)
v_readfirstlane_b32 s64,v184
s_mov_b64 exec,-1
s_cmp_eq_u32 s56,1
s_cbranch_scc1 post_9
s_cmp_lg_u32 s64,127
s_cbranch_scc1 post_9
v_and_b32 v184,3,v1
v_bfe_u32 v185,v1,2,1
v_lshlrev_b32 v184,2,v184
v_lshl_add_u32 v184,v185,7,v184
v_writelane_b32 v184,32,8
s_mov_b64 exec,0x1ff
vpoll_27:
buffer_load_dword v185,v184,s[44:47],0 offen sc1
s_waitcnt vmcnt(0)
vfirst_30:
v_readlane_b32 s92,v185,0
v_readlane_b32 s93,v185,1
v_readlane_b32 s94,v185,2
v_readlane_b32 s95,v185,3
v_readlane_b32 s96,v185,4
v_readlane_b32 s97,v185,5
v_readlane_b32 s98,v185,6
v_readlane_b32 s99,v185,7
v_readlane_b32 s61,v185,8
s_add_u32 s64,s92,s93
s_add_u32 s64,s64,s94
s_add_u32 s64,s64,s95
s_add_u32 s64,s64,s96
s_add_u32 s64,s64,s97
s_add_u32 s64,s64,s98
s_add_u32 s64,s64,s99
s_min_u32 s65,s92,s93
s_min_u32 s66,s94,s95
s_min_u32 s65,s65,s66
s_min_u32 s66,s96,s97
s_min_u32 s65,s65,s66
s_min_u32 s66,s98,s99
s_min_u32 s65,s65,s66
s_cmp_lt_u32 s65,32
s_cselect_b32 s65,1,0
s_cmp_lt_u32 s64,256
s_cbranch_scc1 vslp_29
s_branch vgot_28
vslp_29:
s_sleep 8
s_sub_u32 s90,s90,1
s_cmp_gt_i32 s90,0
s_cbranch_scc1 vpoll_27
vgot_28:
s_mov_b64 exec,-1
s_and_b32 s61,s61,1
s_lshl_b32 s61,s61,13
s_cmp_lg_u32 s65,0
s_cbranch_scc1 post_9
v_lshlrev_b32 v184,7,v1
v_mov_b32 v185,1
s_mov_b32 s64,21102592
s_mov_b32 s65,21110784
buffer_store_dword v185,v184,s[20:23],s64 offen sc1
buffer_store_dword v185,v184,s[20:23],s65 offen sc1
s_branch post_9
verify_6:
v_mov_b32 v187,158976
s_cmp_lg_u32 s50,0
s_cbranch_scc1 sh0_31
v_and_b32 v184,3,v1
v_bfe_u32 v185,v1,2,1
v_lshlrev_b32 v184,2,v184
v_lshl_add_u32 v184,v185,7,v184
v_writelane_b32 v184,32,8
s_mov_b64 exec,0x1ff
vpoll_32:
buffer_load_dword v185,v184,s[44:47],0 offen sc1
s_waitcnt vmcnt(0)
vfirst_35:
v_readlane_b32 s92,v185,0
v_readlane_b32 s93,v185,1
v_readlane_b32 s94,v185,2
v_readlane_b32 s95,v185,3
v_readlane_b32 s96,v185,4
v_readlane_b32 s97,v185,5
v_readlane_b32 s98,v185,6
v_readlane_b32 s99,v185,7
v_readlane_b32 s61,v185,8
s_add_u32 s64,s92,s93
s_add_u32 s64,s64,s94
s_add_u32 s64,s64,s95
s_add_u32 s64,s64,s96
s_add_u32 s64,s64,s97
s_add_u32 s64,s64,s98
s_add_u32 s64,s64,s99
s_min_u32 s65,s92,s93
s_min_u32 s66,s94,s95
s_min_u32 s65,s65,s66
s_min_u32 s66,s96,s97
s_min_u32 s65,s65,s66
s_min_u32 s66,s98,s99
s_min_u32 s65,s65,s66
s_cmp_lt_u32 s65,32
s_cselect_b32 s65,1,0
s_cmp_lt_u32 s64,256
s_cbranch_scc1 vslp_34
s_branch vgot_33
vslp_34:
s_sleep 8
s_sub_u32 s90,s90,1
s_cmp_gt_i32 s90,0
s_cbranch_scc1 vpoll_32
vgot_33:
s_mov_b64 exec,-1
s_and_b32 s61,s61,1
s_lshl_b32 s61,s61,13
s_mov_b32 s66,s54
s_cmp_gt_u32 s51,0
s_cselect_b32 s64,s92,0
s_add_u32 s66,s66,s64
s_cmp_gt_u32 s51,1
s_cselect_b32 s64,s93,0
s_add_u32 s66,s66,s64
s_cmp_gt_u32 s51,2
s_cselect_b32 s64,s94,0
s_add_u32 s66,s66,s64
s_cmp_gt_u32 s51,3
s_cselect_b32 s64,s95,0
s_add_u32 s66,s66,s64
s_cmp_gt_u32 s51,4
s_cselect_b32 s64,s96,0
s_add_u32 s66,s66,s64
s_cmp_gt_u32 s51,5
s_cselect_b32 s64,s97,0
s_add_u32 s66,s66,s64
s_cmp_gt_u32 s51,6
s_cselect_b32 s64,s98,0
s_add_u32 s66,s66,s64
v_mov_b32 v184,s65
v_mov_b32 v185,s66
v_mov_b32 v186,s61
ds_write_b96 v187,v[184:186] offset:16
s_waitcnt lgkmcnt(0)
sh0_31:
s_barrier
ds_read_b96 v[184:186],v187 offset:16
s_waitcnt lgkmcnt(0)
v_readfirstlane_b32 s65,v184
v_readfirstlane_b32 s66,v185
v_readfirstlane_b32 s61,v186
s_cmp_lg_u32 s65,0
s_cbranch_scc1 slowrole_10
s_mov_b32 s56,0
s_branch done_1
slowrole_10:
s_mov_b32 s57,s66
s_mov_b32 s56,1
s_waitcnt vmcnt(0)
s_barrier
s_cmp_ge_u32 s57,128
s_cbranch_scc1 pre_8
s_cmp_lg_u32 s50,0
s_cbranch_scc1 nadd_36
s_mov_b64 exec,1
v_mov_b32 v184,1
v_mov_b32 v185,0
s_mov_b32 s52,164
buffer_atomic_add v184,v185,s[44:47],s52 offen sc1
s_mov_b64 exec,-1
nadd_36:
s_branch setup_5
post_9:
s_cmp_lt_u32 s55,16
s_cbranch_scc1 xd_38
s_barrier
buffer_load_dwordx4 v[8:11],v5,s[32:35],s36 offen offset:0
buffer_load_dwordx4 v[12:15],v5,s[32:35],s36 offen offset:16
buffer_load_dwordx4 v[16:19],v5,s[32:35],s36 offen offset:512
buffer_load_dwordx4 v[20:23],v5,s[32:35],s36 offen offset:528
buffer_load_dwordx4 v[24:27],v5,s[32:35],s36 offen offset:1024
buffer_load_dwordx4 v[28:31],v5,s[32:35],s36 offen offset:1040
buffer_load_dwordx4 v[32:35],v5,s[32:35],s36 offen offset:1536
buffer_load_dwordx4 v[36:39],v5,s[32:35],s36 offen offset:1552
xd_38:
s_sub_u32 s65,s57,255
s_and_b32 s66,s56,1
s_or_b32 s65,s65,s66
s_or_b32 s65,s65,s50
s_cmp_lg_u32 s65,0
s_cbranch_scc1 nomeas_37
s_mov_b64 exec,1
v_mov_b32 v184,0
s_mov_b32 s52,20971520
s_mov_b32 s53,20979712
s_mov_b32 s70,0x7fffffff
s_mov_b32 s71,0x7fffffff
s_memtime s[72:73]
s_waitcnt lgkmcnt(0)
buffer_store_dword v184,v184,s[20:23],s52 offen sc1
s_waitcnt vmcnt(0)
s_memtime s[74:75]
s_waitcnt lgkmcnt(0)
s_sub_u32 s74,s74,s72
s_min_u32 s70,s70,s74
s_memtime s[72:73]
s_waitcnt lgkmcnt(0)
buffer_store_dword v184,v184,s[20:23],s53 offen sc1
s_waitcnt vmcnt(0)
s_memtime s[74:75]
s_waitcnt lgkmcnt(0)
s_sub_u32 s74,s74,s72
s_min_u32 s71,s71,s74
s_memtime s[72:73]
s_waitcnt lgkmcnt(0)
buffer_store_dword v184,v184,s[20:23],s52 offen sc1
s_waitcnt vmcnt(0)
s_memtime s[74:75]
s_waitcnt lgkmcnt(0)
s_sub_u32 s74,s74,s72
s_min_u32 s70,s70,s74
s_memtime s[72:73]
s_waitcnt lgkmcnt(0)
buffer_store_dword v184,v184,s[20:23],s53 offen sc1
s_waitcnt vmcnt(0)
s_memtime s[74:75]
s_waitcnt lgkmcnt(0)
s_sub_u32 s74,s74,s72
s_min_u32 s71,s71,s74
s_memtime s[72:73]
s_waitcnt lgkmcnt(0)
buffer_store_dword v184,v184,s[20:23],s52 offen sc1
s_waitcnt vmcnt(0)
s_memtime s[74:75]
s_waitcnt lgkmcnt(0)
s_sub_u32 s74,s74,s72
s_min_u32 s70,s70,s74
s_memtime s[72:73]
s_waitcnt lgkmcnt(0)
buffer_store_dword v184,v184,s[20:23],s53 offen sc1
s_waitcnt vmcnt(0)
s_memtime s[74:75]
s_waitcnt lgkmcnt(0)
s_sub_u32 s74,s74,s72
s_min_u32 s71,s71,s74
s_memtime s[72:73]
s_waitcnt lgkmcnt(0)
buffer_store_dword v184,v184,s[20:23],s52 offen sc1
s_waitcnt vmcnt(0)
s_memtime s[74:75]
s_waitcnt lgkmcnt(0)
s_sub_u32 s74,s74,s72
s_min_u32 s70,s70,s74
s_memtime s[72:73]
s_waitcnt lgkmcnt(0)
buffer_store_dword v184,v184,s[20:23],s53 offen sc1
s_waitcnt vmcnt(0)
s_memtime s[74:75]
s_waitcnt lgkmcnt(0)
s_sub_u32 s74,s74,s72
s_min_u32 s71,s71,s74
s_cmp_gt_u32 s71,s70
s_cselect_b32 s65,3,2
v_mov_b32 v185,s65
buffer_store_dword v185,v184,s[44:47],32 offen sc1
s_mov_b64 exec,-1
nomeas_37:
s_waitcnt vmcnt(0)
v_and_b32 v103,s39,v39
v_lshlrev_b32 v102,16,v39
v_and_b32 v101,s39,v38
v_lshlrev_b32 v100,16,v38
v_and_b32 v99,s39,v37
v_lshlrev_b32 v98,16,v37
v_and_b32 v97,s39,v36
v_lshlrev_b32 v96,16,v36
v_and_b32 v95,s39,v35
v_lshlrev_b32 v94,16,v35
v_and_b32 v93,s39,v34
v_lshlrev_b32 v92,16,v34
v_and_b32 v91,s39,v33
v_lshlrev_b32 v90,16,v33
v_and_b32 v89,s39,v32
v_lshlrev_b32 v88,16,v32
v_and_b32 v87,s39,v31
v_lshlrev_b32 v86,16,v31
v_and_b32 v85,s39,v30
v_lshlrev_b32 v84,16,v30
v_and_b32 v83,s39,v29
v_lshlrev_b32 v82,16,v29
v_and_b32 v81,s39,v28
v_lshlrev_b32 v80,16,v28
v_and_b32 v79,s39,v27
v_lshlrev_b32 v78,16,v27
v_and_b32 v77,s39,v26
v_lshlrev_b32 v76,16,v26
v_and_b32 v75,s39,v25
v_lshlrev_b32 v74,16,v25
v_and_b32 v73,s39,v24
v_lshlrev_b32 v72,16,v24
v_and_b32 v71,s39,v23
v_lshlrev_b32 v70,16,v23
v_and_b32 v69,s39,v22
v_lshlrev_b32 v68,16,v22
v_and_b32 v67,s39,v21
v_lshlrev_b32 v66,16,v21
v_and_b32 v65,s39,v20
v_lshlrev_b32 v64,16,v20
v_and_b32 v63,s39,v19
v_lshlrev_b32 v62,16,v19
v_and_b32 v61,s39,v18
v_lshlrev_b32 v60,16,v18
v_and_b32 v59,s39,v17
v_lshlrev_b32 v58,16,v17
v_and_b32 v57,s39,v16
v_lshlrev_b32 v56,16,v16
v_and_b32 v55,s39,v15
v_lshlrev_b32 v54,16,v15
v_and_b32 v53,s39,v14
v_lshlrev_b32 v52,16,v14
v_and_b32 v51,s39,v13
v_lshlrev_b32 v50,16,v13
v_and_b32 v49,s39,v12
v_lshlrev_b32 v48,16,v12
v_and_b32 v47,s39,v11
v_lshlrev_b32 v46,16,v11
v_and_b32 v45,s39,v10
v_lshlrev_b32 v44,16,v10
v_and_b32 v43,s39,v9
v_lshlrev_b32 v42,16,v9
v_and_b32 v41,s39,v8
v_lshlrev_b32 v40,16,v8
v_pk_add_f32 v[8:9],v[40:41],v[42:43]
v_pk_add_f32 v[10:11],v[44:45],v[46:47]
v_pk_add_f32 v[8:9],v[8:9],v[48:49]
v_pk_add_f32 v[10:11],v[10:11],v[50:51]
v_pk_add_f32 v[8:9],v[8:9],v[52:53]
v_pk_add_f32 v[10:11],v[10:11],v[54:55]
v_pk_add_f32 v[8:9],v[8:9],v[56:57]
v_pk_add_f32 v[10:11],v[10:11],v[58:59]
v_pk_add_f32 v[8:9],v[8:9],v[60:61]
v_pk_add_f32 v[10:11],v[10:11],v[62:63]
v_pk_add_f32 v[8:9],v[8:9],v[64:65]
v_pk_add_f32 v[10:11],v[10:11],v[66:67]
v_pk_add_f32 v[8:9],v[8:9],v[68:69]
v_pk_add_f32 v[10:11],v[10:11],v[70:71]
v_pk_add_f32 v[8:9],v[8:9],v[72:73]
v_pk_add_f32 v[10:11],v[10:11],v[74:75]
v_pk_add_f32 v[8:9],v[8:9],v[76:77]
v_pk_add_f32 v[10:11],v[10:11],v[78:79]
v_pk_add_f32 v[8:9],v[8:9],v[80:81]
v_pk_add_f32 v[10:11],v[10:11],v[82:83]
v_pk_add_f32 v[8:9],v[8:9],v[84:85]
v_pk_add_f32 v[10:11],v[10:11],v[86:87]
v_pk_add_f32 v[8:9],v[8:9],v[88:89]
v_pk_add_f32 v[10:11],v[10:11],v[90:91]
v_pk_add_f32 v[8:9],v[8:9],v[92:93]
v_pk_add_f32 v[10:11],v[10:11],v[94:95]
v_pk_add_f32 v[8:9],v[8:9],v[96:97]
v_pk_add_f32 v[10:11],v[10:11],v[98:99]
v_pk_add_f32 v[8:9],v[8:9],v[100:101]
v_pk_add_f32 v[10:11],v[10:11],v[102:103]
v_pk_add_f32 v[8:9],v[8:9],v[10:11]
v_add_f32 v8,v8,v9
s_nop 1
v_add_f32_dpp v8,v8,v8 row_ror:4 row_mask:0xf bank_mask:0xf
s_nop 1
v_add_f32_dpp v8,v8,v8 row_ror:8 row_mask:0xf bank_mask:0xf
v_mov_b32 v12,v8
s_nop 1
v_permlane16_swap_b32 v12,v8
v_add_f32 v8,v8,v12
v_mov_b32 v12,v8
s_nop 1
v_permlane32_swap_b32 v12,v8
v_add_f32 v8,v8,v12
v_mul_f32 v8,0xba800000,v8
v_pk_add_f32 v[40:41],v[40:41],v[8:9] op_sel_hi:[1,0]
v_pk_add_f32 v[42:43],v[42:43],v[8:9] op_sel_hi:[1,0]
v_pk_add_f32 v[44:45],v[44:45],v[8:9] op_sel_hi:[1,0]
v_pk_add_f32 v[46:47],v[46:47],v[8:9] op_sel_hi:[1,0]
v_pk_add_f32 v[48:49],v[48:49],v[8:9] op_sel_hi:[1,0]
v_pk_add_f32 v[50:51],v[50:51],v[8:9] op_sel_hi:[1,0]
v_pk_add_f32 v[52:53],v[52:53],v[8:9] op_sel_hi:[1,0]
v_pk_add_f32 v[54:55],v[54:55],v[8:9] op_sel_hi:[1,0]
v_pk_add_f32 v[56:57],v[56:57],v[8:9] op_sel_hi:[1,0]
v_pk_add_f32 v[58:59],v[58:59],v[8:9] op_sel_hi:[1,0]
v_pk_add_f32 v[60:61],v[60:61],v[8:9] op_sel_hi:[1,0]
v_pk_add_f32 v[62:63],v[62:63],v[8:9] op_sel_hi:[1,0]
v_pk_add_f32 v[64:65],v[64:65],v[8:9] op_sel_hi:[1,0]
v_pk_add_f32 v[66:67],v[66:67],v[8:9] op_sel_hi:[1,0]
v_pk_add_f32 v[68:69],v[68:69],v[8:9] op_sel_hi:[1,0]
v_pk_add_f32 v[70:71],v[70:71],v[8:9] op_sel_hi:[1,0]
v_pk_add_f32 v[72:73],v[72:73],v[8:9] op_sel_hi:[1,0]
v_pk_add_f32 v[74:75],v[74:75],v[8:9] op_sel_hi:[1,0]
v_pk_add_f32 v[76:77],v[76:77],v[8:9] op_sel_hi:[1,0]
v_pk_add_f32 v[78:79],v[78:79],v[8:9] op_sel_hi:[1,0]
v_pk_add_f32 v[80:81],v[80:81],v[8:9] op_sel_hi:[1,0]
v_pk_add_f32 v[82:83],v[82:83],v[8:9] op_sel_hi:[1,0]
v_pk_add_f32 v[84:85],v[84:85],v[8:9] op_sel_hi:[1,0]
v_pk_add_f32 v[86:87],v[86:87],v[8:9] op_sel_hi:[1,0]
v_pk_add_f32 v[88:89],v[88:89],v[8:9] op_sel_hi:[1,0]
v_pk_add_f32 v[90:91],v[90:91],v[8:9] op_sel_hi:[1,0]
v_pk_add_f32 v[92:93],v[92:93],v[8:9] op_sel_hi:[1,0]
v_pk_add_f32 v[94:95],v[94:95],v[8:9] op_sel_hi:[1,0]
v_pk_add_f32 v[96:97],v[96:97],v[8:9] op_sel_hi:[1,0]
v_pk_add_f32 v[98:99],v[98:99],v[8:9] op_sel_hi:[1,0]
v_pk_add_f32 v[100:101],v[100:101],v[8:9] op_sel_hi:[1,0]
v_pk_add_f32 v[102:103],v[102:103],v[8:9] op_sel_hi:[1,0]
v_pk_mul_f32 v[10:11],v[40:41],v[40:41]
v_pk_mul_f32 v[14:15],v[42:43],v[42:43]
v_pk_fma_f32 v[10:11],v[44:45],v[44:45],v[10:11]
v_pk_fma_f32 v[14:15],v[46:47],v[46:47],v[14:15]
v_pk_fma_f32 v[10:11],v[48:49],v[48:49],v[10:11]
v_pk_fma_f32 v[14:15],v[50:51],v[50:51],v[14:15]
v_pk_fma_f32 v[10:11],v[52:53],v[52:53],v[10:11]
v_pk_fma_f32 v[14:15],v[54:55],v[54:55],v[14:15]
v_pk_fma_f32 v[10:11],v[56:57],v[56:57],v[10:11]
v_pk_fma_f32 v[14:15],v[58:59],v[58:59],v[14:15]
v_pk_fma_f32 v[10:11],v[60:61],v[60:61],v[10:11]
v_pk_fma_f32 v[14:15],v[62:63],v[62:63],v[14:15]
v_pk_fma_f32 v[10:11],v[64:65],v[64:65],v[10:11]
v_pk_fma_f32 v[14:15],v[66:67],v[66:67],v[14:15]
v_pk_fma_f32 v[10:11],v[68:69],v[68:69],v[10:11]
v_pk_fma_f32 v[14:15],v[70:71],v[70:71],v[14:15]
v_pk_fma_f32 v[10:11],v[72:73],v[72:73],v[10:11]
v_pk_fma_f32 v[14:15],v[74:75],v[74:75],v[14:15]
v_pk_fma_f32 v[10:11],v[76:77],v[76:77],v[10:11]
v_pk_fma_f32 v[14:15],v[78:79],v[78:79],v[14:15]
v_pk_fma_f32 v[10:11],v[80:81],v[80:81],v[10:11]
v_pk_fma_f32 v[14:15],v[82:83],v[82:83],v[14:15]
v_pk_fma_f32 v[10:11],v[84:85],v[84:85],v[10:11]
v_pk_fma_f32 v[14:15],v[86:87],v[86:87],v[14:15]
v_pk_fma_f32 v[10:11],v[88:89],v[88:89],v[10:11]
v_pk_fma_f32 v[14:15],v[90:91],v[90:91],v[14:15]
v_pk_fma_f32 v[10:11],v[92:93],v[92:93],v[10:11]
v_pk_fma_f32 v[14:15],v[94:95],v[94:95],v[14:15]
v_pk_fma_f32 v[10:11],v[96:97],v[96:97],v[10:11]
v_pk_fma_f32 v[14:15],v[98:99],v[98:99],v[14:15]
v_pk_fma_f32 v[10:11],v[100:101],v[100:101],v[10:11]
v_pk_fma_f32 v[14:15],v[102:103],v[102:103],v[14:15]
v_pk_add_f32 v[10:11],v[10:11],v[14:15]
v_add_f32 v10,v10,v11
s_nop 1
v_add_f32_dpp v10,v10,v10 row_ror:4 row_mask:0xf bank_mask:0xf
s_nop 1
v_add_f32_dpp v10,v10,v10 row_ror:8 row_mask:0xf bank_mask:0xf
v_mov_b32 v12,v10
s_nop 1
v_permlane16_swap_b32 v12,v10
v_add_f32 v10,v10,v12
v_mov_b32 v12,v10
s_nop 1
v_permlane32_swap_b32 v12,v10
v_add_f32 v10,v10,v12
v_mov_b32 v12,0x3727c5ac
v_fmac_f32 v12,0x3a800000,v10
v_rsq_f32 v10,v12
s_nop 0
v_pk_mul_f32 v[40:41],v[40:41],v[10:11] op_sel_hi:[1,0]
v_pk_mul_f32 v[42:43],v[42:43],v[10:11] op_sel_hi:[1,0]
v_pk_mul_f32 v[44:45],v[44:45],v[10:11] op_sel_hi:[1,0]
v_pk_mul_f32 v[46:47],v[46:47],v[10:11] op_sel_hi:[1,0]
v_pk_mul_f32 v[48:49],v[48:49],v[10:11] op_sel_hi:[1,0]
v_pk_mul_f32 v[50:51],v[50:51],v[10:11] op_sel_hi:[1,0]
v_pk_mul_f32 v[52:53],v[52:53],v[10:11] op_sel_hi:[1,0]
v_pk_mul_f32 v[54:55],v[54:55],v[10:11] op_sel_hi:[1,0]
v_pk_mul_f32 v[56:57],v[56:57],v[10:11] op_sel_hi:[1,0]
v_pk_mul_f32 v[58:59],v[58:59],v[10:11] op_sel_hi:[1,0]
v_pk_mul_f32 v[60:61],v[60:61],v[10:11] op_sel_hi:[1,0]
v_pk_mul_f32 v[62:63],v[62:63],v[10:11] op_sel_hi:[1,0]
v_pk_mul_f32 v[64:65],v[64:65],v[10:11] op_sel_hi:[1,0]
v_pk_mul_f32 v[66:67],v[66:67],v[10:11] op_sel_hi:[1,0]
v_pk_mul_f32 v[68:69],v[68:69],v[10:11] op_sel_hi:[1,0]
v_pk_mul_f32 v[70:71],v[70:71],v[10:11] op_sel_hi:[1,0]
v_pk_mul_f32 v[72:73],v[72:73],v[10:11] op_sel_hi:[1,0]
v_pk_mul_f32 v[74:75],v[74:75],v[10:11] op_sel_hi:[1,0]
v_pk_mul_f32 v[76:77],v[76:77],v[10:11] op_sel_hi:[1,0]
v_pk_mul_f32 v[78:79],v[78:79],v[10:11] op_sel_hi:[1,0]
v_pk_mul_f32 v[80:81],v[80:81],v[10:11] op_sel_hi:[1,0]
v_pk_mul_f32 v[82:83],v[82:83],v[10:11] op_sel_hi:[1,0]
v_pk_mul_f32 v[84:85],v[84:85],v[10:11] op_sel_hi:[1,0]
v_pk_mul_f32 v[86:87],v[86:87],v[10:11] op_sel_hi:[1,0]
v_pk_mul_f32 v[88:89],v[88:89],v[10:11] op_sel_hi:[1,0]
v_pk_mul_f32 v[90:91],v[90:91],v[10:11] op_sel_hi:[1,0]
v_pk_mul_f32 v[92:93],v[92:93],v[10:11] op_sel_hi:[1,0]
v_pk_mul_f32 v[94:95],v[94:95],v[10:11] op_sel_hi:[1,0]
v_pk_mul_f32 v[96:97],v[96:97],v[10:11] op_sel_hi:[1,0]
v_pk_mul_f32 v[98:99],v[98:99],v[10:11] op_sel_hi:[1,0]
v_pk_mul_f32 v[100:101],v[100:101],v[10:11] op_sel_hi:[1,0]
v_pk_mul_f32 v[102:103],v[102:103],v[10:11] op_sel_hi:[1,0]
v_mov_b32 v187,158976
s_cmp_lg_u32 s50,0
s_cbranch_scc1 sh0_39
s_mov_b32 s65,0
s_cmp_eq_u32 s56,1
s_cbranch_scc1 m1s_40
s_lshl_b32 s52,s55,7
s_add_u32 s52,s52,21102592
s_mov_b32 s53,0
m1l_41:
v_mov_b32 v184,0
buffer_load_dword v185,v184,s[20:23],s52 offen sc1
s_waitcnt vmcnt(0)
v_readfirstlane_b32 s64,v185
s_mov_b32 s65,0
s_cmp_eq_u32 s64,1
s_cbranch_scc1 m1ok_42
s_sub_u32 s90,s90,1
s_cmp_lt_i32 s90,0
s_cbranch_scc1 m1ok_42
s_add_u32 s53,s53,1
s_and_b32 s64,s53,31
s_cbranch_scc1 m1l_41
v_and_b32 v184,3,v1
v_bfe_u32 v185,v1,2,1
v_lshlrev_b32 v184,2,v184
v_lshl_add_u32 v184,v185,7,v184
v_writelane_b32 v184,32,8
s_mov_b64 exec,0x1ff
vpoll_43:
buffer_load_dword v185,v184,s[44:47],0 offen sc1
s_waitcnt vmcnt(0)
vfirst_46:
v_readlane_b32 s92,v185,0
v_readlane_b32 s93,v185,1
v_readlane_b32 s94,v185,2
v_readlane_b32 s95,v185,3
v_readlane_b32 s96,v185,4
v_readlane_b32 s97,v185,5
v_readlane_b32 s98,v185,6
v_readlane_b32 s99,v185,7
v_readlane_b32 s61,v185,8
s_add_u32 s64,s92,s93
s_add_u32 s64,s64,s94
s_add_u32 s64,s64,s95
s_add_u32 s64,s64,s96
s_add_u32 s64,s64,s97
s_add_u32 s64,s64,s98
s_add_u32 s64,s64,s99
s_min_u32 s65,s92,s93
s_min_u32 s66,s94,s95
s_min_u32 s65,s65,s66
s_min_u32 s66,s96,s97
s_min_u32 s65,s65,s66
s_min_u32 s66,s98,s99
s_min_u32 s65,s65,s66
s_cmp_lt_u32 s65,32
s_cselect_b32 s65,1,0
s_cmp_lt_u32 s64,256
s_cbranch_scc1 vslp_45
s_branch vgot_44
vslp_45:
s_sleep 8
s_sub_u32 s90,s90,1
s_cmp_gt_i32 s90,0
s_cbranch_scc1 vpoll_43
vgot_44:
s_mov_b64 exec,-1
s_and_b32 s61,s61,1
s_lshl_b32 s61,s61,13
s_mov_b32 s66,s54
s_cmp_gt_u32 s51,0
s_cselect_b32 s64,s92,0
s_add_u32 s66,s66,s64
s_cmp_gt_u32 s51,1
s_cselect_b32 s64,s93,0
s_add_u32 s66,s66,s64
s_cmp_gt_u32 s51,2
s_cselect_b32 s64,s94,0
s_add_u32 s66,s66,s64
s_cmp_gt_u32 s51,3
s_cselect_b32 s64,s95,0
s_add_u32 s66,s66,s64
s_cmp_gt_u32 s51,4
s_cselect_b32 s64,s96,0
s_add_u32 s66,s66,s64
s_cmp_gt_u32 s51,5
s_cselect_b32 s64,s97,0
s_add_u32 s66,s66,s64
s_cmp_gt_u32 s51,6
s_cselect_b32 s64,s98,0
s_add_u32 s66,s66,s64
s_cmp_eq_u32 s65,0
s_cbranch_scc1 m1l_41
s_branch m1ok_42
m1s_40:
s_mov_b32 s53,256
s_mov_b32 s52,164
v_mov_b32 v184,0
dp_47:
buffer_load_dword v185,v184,s[44:47],s52 offen sc1
s_waitcnt vmcnt(0)
v_cmp_ne_u32 vcc,s53,v185
s_cbranch_vccz dpok_48
s_sleep 8
s_sub_u32 s90,s90,1
s_cmp_gt_i32 s90,0
s_cbranch_scc1 dp_47
dpok_48:
m1ok_42:
v_mov_b32 v184,s65
v_mov_b32 v185,s66
v_mov_b32 v186,s61
ds_write_b96 v187,v[184:186] offset:16
s_waitcnt lgkmcnt(0)
sh0_39:
s_barrier
ds_read_b96 v[184:186],v187 offset:16
s_waitcnt lgkmcnt(0)
v_readfirstlane_b32 s65,v184
v_readfirstlane_b32 s66,v185
v_readfirstlane_b32 s61,v186
s_cmp_lg_u32 s65,0
s_cbranch_scc1 slowrole_10
s_and_b32 s56,s56,1
s_lshl_b32 s53,s56,2
s_add_u32 s53,s53,4
v_mul_u32_u24 v241,s53,v1
s_lshr_b32 s53,s55,4
s_or_b32 s53,s53,s50
s_cselect_b32 s53,0x7fff0000,32
s_mov_b64 exec,3
buffer_load_dword v240,v241,s[44:47],s53 offen sc1
s_mov_b64 exec,-1
v_lshlrev_b32 v7,5,v0
s_mov_b32 s40,24576
buffer_load_dwordx4 v[104:107],v7,s[20:23],s40 offen offset:0 sc1
buffer_load_dwordx4 v[108:111],v7,s[20:23],s40 offen offset:16 sc1
s_add_u32 s40,s40,8192
buffer_load_dwordx4 v[112:115],v7,s[20:23],s40 offen offset:0 sc1
buffer_load_dwordx4 v[116:119],v7,s[20:23],s40 offen offset:16 sc1
s_add_u32 s40,s40,8192
buffer_load_dwordx4 v[120:123],v7,s[20:23],s40 offen offset:0 sc1
buffer_load_dwordx4 v[124:127],v7,s[20:23],s40 offen offset:16 sc1
s_add_u32 s40,s40,8192
buffer_load_dwordx4 v[128:131],v7,s[20:23],s40 offen offset:0 sc1
buffer_load_dwordx4 v[132:135],v7,s[20:23],s40 offen offset:16 sc1
v_mov_b32 v14,1.0
v_cmp_lt_u32 vcc,127,v0
s_nop 1
v_cndmask_b32 v14,0,v14,vcc
s_waitcnt vmcnt(0)
v_pk_add_f32 v[104:105],v[104:105],v[112:113]
v_pk_add_f32 v[120:121],v[120:121],v[128:129]
v_pk_add_f32 v[106:107],v[106:107],v[114:115]
v_pk_add_f32 v[122:123],v[122:123],v[130:131]
v_pk_add_f32 v[108:109],v[108:109],v[116:117]
v_pk_add_f32 v[124:125],v[124:125],v[132:133]
v_pk_add_f32 v[110:111],v[110:111],v[118:119]
v_pk_add_f32 v[126:127],v[126:127],v[134:135]
v_pk_add_f32 v[104:105],v[104:105],v[120:121]
v_pk_add_f32 v[106:107],v[106:107],v[122:123]
v_pk_add_f32 v[108:109],v[108:109],v[124:125]
v_pk_add_f32 v[110:111],v[110:111],v[126:127]
v_cvt_pk_bf16_f32 v112,v104,v105
v_cvt_pk_bf16_f32 v113,v106,v107
v_cvt_pk_bf16_f32 v114,v108,v109
v_cvt_pk_bf16_f32 v115,v110,v111
v_lshlrev_b32 v104,16,v112
v_and_b32 v105,s39,v112
v_lshlrev_b32 v106,16,v113
v_and_b32 v107,s39,v113
v_lshlrev_b32 v108,16,v114
v_and_b32 v109,s39,v114
v_lshlrev_b32 v110,16,v115
v_and_b32 v111,s39,v115
v_pk_add_f32 v[104:105],v[104:105],v[14:15] op_sel_hi:[1,0]
v_pk_add_f32 v[106:107],v[106:107],v[14:15] op_sel_hi:[1,0]
v_pk_add_f32 v[108:109],v[108:109],v[14:15] op_sel_hi:[1,0]
v_pk_add_f32 v[110:111],v[110:111],v[14:15] op_sel_hi:[1,0]
ds_write_b128 v7,v[104:107] offset:4096
ds_write_b128 v7,v[108:111] offset:4112
s_waitcnt lgkmcnt(0)
s_barrier
ds_read_b128 v[104:107],v4 offset:8192
ds_read_b128 v[168:171],v4 offset:4096
ds_read_b128 v[108:111],v4 offset:8208
ds_read_b128 v[172:175],v4 offset:4112
ds_read_b128 v[112:115],v4 offset:8224
ds_read_b128 v[176:179],v4 offset:4128
ds_read_b128 v[116:119],v4 offset:8240
ds_read_b128 v[180:183],v4 offset:4144
ds_read_b128 v[120:123],v4 offset:9216
ds_read_b128 v[184:187],v4 offset:5120
ds_read_b128 v[124:127],v4 offset:9232
ds_read_b128 v[188:191],v4 offset:5136
ds_read_b128 v[128:131],v4 offset:9248
ds_read_b128 v[192:195],v4 offset:5152
ds_read_b128 v[132:135],v4 offset:9264
ds_read_b128 v[196:199],v4 offset:5168
ds_read_b128 v[136:139],v4 offset:10240
ds_read_b128 v[200:203],v4 offset:6144
ds_read_b128 v[140:143],v4 offset:10256
ds_read_b128 v[204:207],v4 offset:6160
ds_read_b128 v[144:147],v4 offset:10272
ds_read_b128 v[208:211],v4 offset:6176
ds_read_b128 v[148:151],v4 offset:10288
ds_read_b128 v[212:215],v4 offset:6192
ds_read_b128 v[152:155],v4 offset:11264
ds_read_b128 v[216:219],v4 offset:7168
ds_read_b128 v[156:159],v4 offset:11280
ds_read_b128 v[220:223],v4 offset:7184
ds_read_b128 v[160:163],v4 offset:11296
ds_read_b128 v[224:227],v4 offset:7200
ds_read_b128 v[164:167],v4 offset:11312
ds_read_b128 v[228:231],v4 offset:7216
s_waitcnt lgkmcnt(15)
v_pk_fma_f32 v[40:41],v[40:41],v[104:105],v[168:169]
v_pk_fma_f32 v[42:43],v[42:43],v[106:107],v[170:171]
v_pk_fma_f32 v[44:45],v[44:45],v[108:109],v[172:173]
v_pk_fma_f32 v[46:47],v[46:47],v[110:111],v[174:175]
v_pk_fma_f32 v[48:49],v[48:49],v[112:113],v[176:177]
v_pk_fma_f32 v[50:51],v[50:51],v[114:115],v[178:179]
v_pk_fma_f32 v[52:53],v[52:53],v[116:117],v[180:181]
v_pk_fma_f32 v[54:55],v[54:55],v[118:119],v[182:183]
v_cvt_pk_bf16_f32 v16,v40,v41
v_cvt_pk_bf16_f32 v17,v48,v49
v_cvt_pk_bf16_f32 v18,v42,v43
v_cvt_pk_bf16_f32 v19,v50,v51
buffer_store_dwordx4 v[16:19],v6,s[20:23],s37 offen offset:0 sc1
v_cvt_pk_bf16_f32 v20,v44,v45
v_cvt_pk_bf16_f32 v21,v52,v53
v_cvt_pk_bf16_f32 v22,v46,v47
v_cvt_pk_bf16_f32 v23,v54,v55
buffer_store_dwordx4 v[20:23],v6,s[20:23],s37 offen offset:256 sc1
s_waitcnt lgkmcnt(15)
v_pk_fma_f32 v[56:57],v[56:57],v[120:121],v[184:185]
v_pk_fma_f32 v[58:59],v[58:59],v[122:123],v[186:187]
v_pk_fma_f32 v[60:61],v[60:61],v[124:125],v[188:189]
v_pk_fma_f32 v[62:63],v[62:63],v[126:127],v[190:191]
v_pk_fma_f32 v[64:65],v[64:65],v[128:129],v[192:193]
v_pk_fma_f32 v[66:67],v[66:67],v[130:131],v[194:195]
v_pk_fma_f32 v[68:69],v[68:69],v[132:133],v[196:197]
v_pk_fma_f32 v[70:71],v[70:71],v[134:135],v[198:199]
v_cvt_pk_bf16_f32 v24,v56,v57
v_cvt_pk_bf16_f32 v25,v64,v65
v_cvt_pk_bf16_f32 v26,v58,v59
v_cvt_pk_bf16_f32 v27,v66,v67
s_add_u32 s37,s37,16384
buffer_store_dwordx4 v[24:27],v6,s[20:23],s37 offen offset:0 sc1
v_cvt_pk_bf16_f32 v28,v60,v61
v_cvt_pk_bf16_f32 v29,v68,v69
v_cvt_pk_bf16_f32 v30,v62,v63
v_cvt_pk_bf16_f32 v31,v70,v71
buffer_store_dwordx4 v[28:31],v6,s[20:23],s37 offen offset:256 sc1
s_waitcnt lgkmcnt(8)
v_pk_fma_f32 v[72:73],v[72:73],v[136:137],v[200:201]
v_pk_fma_f32 v[74:75],v[74:75],v[138:139],v[202:203]
v_pk_fma_f32 v[76:77],v[76:77],v[140:141],v[204:205]
v_pk_fma_f32 v[78:79],v[78:79],v[142:143],v[206:207]
v_pk_fma_f32 v[80:81],v[80:81],v[144:145],v[208:209]
v_pk_fma_f32 v[82:83],v[82:83],v[146:147],v[210:211]
v_pk_fma_f32 v[84:85],v[84:85],v[148:149],v[212:213]
v_pk_fma_f32 v[86:87],v[86:87],v[150:151],v[214:215]
v_cvt_pk_bf16_f32 v16,v72,v73
v_cvt_pk_bf16_f32 v17,v80,v81
v_cvt_pk_bf16_f32 v18,v74,v75
v_cvt_pk_bf16_f32 v19,v82,v83
s_add_u32 s37,s37,16384
buffer_store_dwordx4 v[16:19],v6,s[20:23],s37 offen offset:0 sc1
v_cvt_pk_bf16_f32 v20,v76,v77
v_cvt_pk_bf16_f32 v21,v84,v85
v_cvt_pk_bf16_f32 v22,v78,v79
v_cvt_pk_bf16_f32 v23,v86,v87
buffer_store_dwordx4 v[20:23],v6,s[20:23],s37 offen offset:256 sc1
s_waitcnt lgkmcnt(0)
v_pk_fma_f32 v[88:89],v[88:89],v[152:153],v[216:217]
v_pk_fma_f32 v[90:91],v[90:91],v[154:155],v[218:219]
v_pk_fma_f32 v[92:93],v[92:93],v[156:157],v[220:221]
v_pk_fma_f32 v[94:95],v[94:95],v[158:159],v[222:223]
v_pk_fma_f32 v[96:97],v[96:97],v[160:161],v[224:225]
v_pk_fma_f32 v[98:99],v[98:99],v[162:163],v[226:227]
v_pk_fma_f32 v[100:101],v[100:101],v[164:165],v[228:229]
v_pk_fma_f32 v[102:103],v[102:103],v[166:167],v[230:231]
v_cvt_pk_bf16_f32 v24,v88,v89
v_cvt_pk_bf16_f32 v25,v96,v97
v_cvt_pk_bf16_f32 v26,v90,v91
v_cvt_pk_bf16_f32 v27,v98,v99
s_add_u32 s37,s37,16384
buffer_store_dwordx4 v[24:27],v6,s[20:23],s37 offen offset:0 sc1
v_cvt_pk_bf16_f32 v28,v92,v93
v_cvt_pk_bf16_f32 v29,v100,v101
v_cvt_pk_bf16_f32 v30,v94,v95
v_cvt_pk_bf16_f32 v31,v102,v103
buffer_store_dwordx4 v[28:31],v6,s[20:23],s37 offen offset:256 sc1
s_waitcnt vmcnt(0)
s_barrier
v_mov_b32 v187,158976
s_cmp_lg_u32 s50,0
s_cbranch_scc1 sh0_49
s_cmp_ge_u32 s55,16
s_cbranch_scc1 nodln_50
rdl_52:
v_readlane_b32 s64,v240,0
v_readlane_b32 s65,v240,1
s_cmp_eq_u32 s56,1
s_cselect_b32 s64,2,s64
s_cmp_eq_u32 s65,128
s_cselect_b32 s64,s64,0
s_cmp_lg_u32 s64,0
s_cbranch_scc1 rdok_53
s_mov_b64 exec,3
buffer_load_dword v240,v241,s[44:47],s53 offen sc1
s_mov_b64 exec,-1
s_sub_u32 s90,s90,1
s_cmp_gt_i32 s90,0
s_waitcnt vmcnt(0)
s_cbranch_scc1 rdl_52
rdok_53:
s_lshl_b32 s65,s55,2
v_lshl_add_u32 v184,v1,7,s65
v_mov_b32 v185,s64
s_mov_b32 s64,21168128
s_mov_b32 s65,21176320
buffer_store_dword v185,v184,s[20:23],s64 offen sc1
buffer_store_dword v185,v184,s[20:23],s65 offen sc1
nodln_50:
s_mov_b32 s61,0
s_cmp_eq_u32 s56,1
s_cbranch_scc1 nopar_51
v_mov_b32 v184,0
dp_54:
buffer_load_dword v185,v184,s[44:47],32 offen sc1
s_waitcnt vmcnt(0)
v_cmp_eq_u32 vcc,0,v185
s_cbranch_vccz dpok_55
s_sleep 4
s_sub_u32 s90,s90,1
s_cmp_gt_i32 s90,0
s_cbranch_scc1 dp_54
dpok_55:
v_readfirstlane_b32 s65,v185
s_and_b32 s65,s65,1
s_lshl_b32 s61,s65,13
nopar_51:
v_mov_b32 v184,s65
v_mov_b32 v185,s66
v_mov_b32 v186,s61
ds_write_b96 v187,v[184:186] offset:16
s_waitcnt lgkmcnt(0)
sh0_49:
s_barrier
ds_read_b96 v[184:186],v187 offset:16
s_waitcnt lgkmcnt(0)
v_readfirstlane_b32 s65,v184
v_readfirstlane_b32 s66,v185
v_readfirstlane_b32 s61,v186
s_sub_u32 s55,s57,128
s_cmp_lg_u32 s50,0
s_cbranch_scc1 nsig_56
s_lshr_b32 s95,s55,4
s_lshl_b32 s95,s95,6
s_add_u32 s95,s95,21052416
s_mov_b64 exec,1
v_mov_b32 v184,112
v_mov_b32 v185,0
buffer_atomic_add v184,v185,s[20:23],s95 offen sc1
s_mov_b64 exec,-1
nsig_56:
s_branch pipe_worker
loops_7:
s_lshl_b32 s64,s50,14
s_add_u32 m0,s64,0
s_add_u32 s65,s64,57344
buffer_load_dwordx4 v16,s[20:23],s65 offen offset:0 lds
buffer_load_dwordx4 v16,s[20:23],s65 offen offset:1024 lds
buffer_load_dwordx4 v16,s[20:23],s65 offen offset:2048 lds
buffer_load_dwordx4 v16,s[20:23],s65 offen offset:3072 lds
s_add_u32 m0,s64,4096
s_add_u32 s65,s64,61440
buffer_load_dwordx4 v16,s[20:23],s65 offen offset:0 lds
buffer_load_dwordx4 v16,s[20:23],s65 offen offset:1024 lds
buffer_load_dwordx4 v16,s[20:23],s65 offen offset:2048 lds
buffer_load_dwordx4 v16,s[20:23],s65 offen offset:3072 lds
s_add_u32 m0,s64,8192
s_add_u32 s65,s64,65536
buffer_load_dwordx4 v16,s[20:23],s65 offen offset:0 lds
buffer_load_dwordx4 v16,s[20:23],s65 offen offset:1024 lds
buffer_load_dwordx4 v16,s[20:23],s65 offen offset:2048 lds
buffer_load_dwordx4 v16,s[20:23],s65 offen offset:3072 lds
s_add_u32 m0,s64,12288
s_add_u32 s65,s64,69632
buffer_load_dwordx4 v16,s[20:23],s65 offen offset:0 lds
buffer_load_dwordx4 v16,s[20:23],s65 offen offset:1024 lds
buffer_load_dwordx4 v16,s[20:23],s65 offen offset:2048 lds
buffer_load_dwordx4 v16,s[20:23],s65 offen offset:3072 lds
s_add_u32 m0,s64,65536
s_add_u32 s65,s64,122880
buffer_load_dwordx4 v16,s[20:23],s65 offen offset:0 lds
buffer_load_dwordx4 v16,s[20:23],s65 offen offset:1024 lds
buffer_load_dwordx4 v16,s[20:23],s65 offen offset:2048 lds
buffer_load_dwordx4 v16,s[20:23],s65 offen offset:3072 lds
s_add_u32 m0,s64,69632
s_add_u32 s65,s64,126976
buffer_load_dwordx4 v16,s[20:23],s65 offen offset:0 lds
buffer_load_dwordx4 v16,s[20:23],s65 offen offset:1024 lds
buffer_load_dwordx4 v16,s[20:23],s65 offen offset:2048 lds
buffer_load_dwordx4 v16,s[20:23],s65 offen offset:3072 lds
s_add_u32 m0,s64,73728
s_add_u32 s65,s64,131072
buffer_load_dwordx4 v16,s[20:23],s65 offen offset:0 lds
buffer_load_dwordx4 v16,s[20:23],s65 offen offset:1024 lds
buffer_load_dwordx4 v16,s[20:23],s65 offen offset:2048 lds
buffer_load_dwordx4 v16,s[20:23],s65 offen offset:3072 lds
s_add_u32 m0,s64,77824
s_add_u32 s65,s64,135168
buffer_load_dwordx4 v16,s[20:23],s65 offen offset:0 lds
buffer_load_dwordx4 v16,s[20:23],s65 offen offset:1024 lds
buffer_load_dwordx4 v16,s[20:23],s65 offen offset:2048 lds
buffer_load_dwordx4 v16,s[20:23],s65 offen offset:3072 lds
s_mov_b64 s[24:25],s[20:21]
s_mov_b64 s[28:29],s[20:21]
s_mov_b32 s27,0x20000
s_mov_b32 s31,0x20000
s_cmp_eq_u32 s56,0
s_cselect_b32 s26,s22,0
s_cselect_b32 s30,0,s22
s_lshl_b32 s64,s58,14
s_add_u32 s64,s64,23068672
v_add_u32 v26,s64,v16
v_add_u32 v27,4096,v26
v_add_u32 v28,8192,v26
v_add_u32 v29,12288,v26
s_lshl_b32 s65,s59,9
s_add_u32 s66,s64,s65
s_lshl_b32 s64,s58,7
s_add_u32 s64,s64,23592960
v_and_b32 v18,31,v1
v_lshl_add_u32 v18,v18,2,s64
s_lshl_b32 s65,s59,2
s_add_u32 s64,s64,s65
v_mov_b32 v13,s64
v_mov_b32 v14,0x4444
v_mov_b32 v22,0xeeee
v_cmp_lt_u32 vcc,7,v3
s_nop 1
v_cndmask_b32 v14,v14,v22,vcc
v_and_b32 v22,1,v3
v_cmp_eq_u32 vcc,0,v22
v_mov_b32 v15,0x03020706
v_mov_b32 v23,0x05040100
v_cndmask_b32 v15,v15,v23,vcc
v_lshlrev_b32 v19,5,v22
v_lshl_add_u32 v19,v4,6,v19
v_lshrrev_b32 v23,1,v3
v_lshl_add_u32 v19,v23,2,v19
s_lshl_b32 s67,s57,10
s_add_u32 s67,s67,23199744
s_lshl_b32 s64,s50,2
s_lshr_b32 s64,0x1320,s64
s_and_b32 s64,s64,3
s_lshl_b32 s64,s64,8
s_add_u32 s64,s64,s67
v_add_u32 v19,s64,v19
v_add_u32 v24,131072,v16
v_mov_b32 v21,158720
v_mov_b32 v25,0
v_mov_b32 v20,v16
v_and_b32 v22,1,v4
v_lshrrev_b32 v23,1,v4
v_lshl_add_u32 v23,v23,4,v3
v_lshlrev_b32 v23,4,v23
v_lshl_add_u32 v23,v22,10,v23
s_lshr_b32 s64,s50,1
s_lshl_b32 s64,s64,9
v_add_u32 v23,s64,v23
s_lshr_b32 s64,s57,2
s_add_u32 s65,s64,32
s_lshl_b32 s65,s65,14
s_and_b32 s68,s57,3
s_lshl_b32 s68,s68,11
s_add_u32 s65,s65,s68
s_add_u32 s65,s65,29360128
v_add_u32 v17,s65,v23
s_lshl_b32 s69,s57,11
s_add_u32 s69,s69,23330816
v_add_u32 v2,s69,v23
s_mov_b32 s81,0x3e0293ee
s_mov_b32 s84,0xff00ff
s_mov_b32 s85,0xff00ff
s_mov_b32 s86,0x33333333
s_mov_b32 s87,0x33333333
s_mov_b32 s62,0x10000
s_mov_b32 s79,-2
ds_write_b32 v21,v25
ds_write_b32 v21,v25 offset:4
ds_write_b32 v21,v25 offset:8
ds_write_b32 v21,v25 offset:12
ds_write_b32 v21,v25 offset:16
ds_write_b32 v21,v25 offset:24
ds_write_b32 v21,v25 offset:28
v_mov_b32 v100,0
v_mov_b32 v101,0
v_mov_b32 v102,0
v_mov_b32 v103,0
s_lshr_b32 s64,s59,3
s_lshl_b32 s64,s64,14
s_and_b32 s65,s59,7
s_lshl_b32 s65,s65,10
s_add_u32 s64,s64,s65
s_lshl_b32 s65,s58,16
s_add_u32 s64,s64,s65
s_add_u32 s64,s64,31195136
v_add_u32 v8,s64,v16
s_cmp_eq_u32 s50,3
s_cbranch_scc1 w3_61
s_cmp_eq_u32 s50,1
s_cbranch_scc1 w1_59
s_cmp_eq_u32 s50,2
s_cbranch_scc1 w2_60
w0_58:
v_and_b32 v22,7,v3
v_lshrrev_b32 v23,2,v22
v_and_b32 v5,2,v22
v_or_b32 v23,v23,v5
v_and_b32 v5,1,v22
v_lshl_add_u32 v23,v23,1,v5
v_lshlrev_b32 v23,5,v23
v_lshrrev_b32 v5,3,v3
v_lshl_add_u32 v23,v5,9,v23
v_lshrrev_b32 v5,1,v4
v_lshl_add_u32 v23,v5,8,v23
v_and_b32 v5,1,v4
v_lshl_add_u32 v23,v5,4,v23
v_add_u32 v8,s67,v23
v_xor_b32 v9,1024,v8
v_xor_b32 v10,2048,v8
v_xor_b32 v11,3072,v8
v_lshlrev_b32 v31,4,v3
v_lshl_add_u32 v31,v5,3,v31
v_add_u32 v31,155648,v31
v_lshl_add_u32 v23,v4,3,v22
v_lshlrev_b32 v23,4,v23
v_add_u32 v12,155648,v23
v_add_u32 v30,s66,v23
v_cmp_gt_u32 vcc,8,v3
v_cmp_lt_u32 s[52:53],1,v4
s_and_b64 vcc,vcc,s[52:53]
v_mov_b32 v22,0xf149f2ca
v_cndmask_b32 v156,v22,0,vcc
v_mov_b32 v157,v156
v_mov_b32 v158,v156
v_mov_b32 v159,v156
v_add_u32 v2,s69,v16
v_xor_b32 v5,2048,v2
v_xor_b32 v6,4096,v2
v_xor_b32 v7,6144,v2
s_lshr_b32 s64,s57,3
s_add_u32 s64,s64,96
s_lshl_b32 s64,s64,14
s_and_b32 s65,s57,7
s_lshl_b32 s65,s65,10
s_add_u32 s64,s64,s65
s_add_u32 s64,s64,29360128
v_add_u32 v3,s64,v16
v_mov_b32 v136,0
v_mov_b32 v137,0
v_mov_b32 v138,0
v_mov_b32 v139,0
v_mov_b32 v140,0
v_mov_b32 v141,0
v_mov_b32 v142,0
v_mov_b32 v143,0
v_mov_b32 v144,0
v_mov_b32 v145,0
v_mov_b32 v146,0
v_mov_b32 v147,0
v_mov_b32 v152,0x3f803f80
v_mov_b32 v153,0x3f803f80
v_mov_b32 v154,0x3f803f80
v_mov_b32 v155,0x3f803f80
s_branch first_62
loop_63:
s_barrier
buffer_load_dword v248,v18,s[20:23],s70 offen offset:0 sc1
s_nop 15
s_nop 5
hl_65:
buffer_load_dword v249,v18,s[20:23],s70 offen offset:0 sc1
s_waitcnt vmcnt(1)
v_cmp_eq_u32 vcc,v25,v248
s_bcnt1_i32_b32 s64,vcc_lo
s_cmp_ge_u32 s64,8
s_cbranch_scc1 hg_66
buffer_load_dword v248,v18,s[20:23],s70 offen offset:0 sc1
s_waitcnt vmcnt(1)
v_cmp_eq_u32 vcc,v25,v249
s_bcnt1_i32_b32 s64,vcc_lo
s_cmp_ge_u32 s64,8
s_cbranch_scc1 hg_66
s_sub_u32 s90,s90,1
s_cmp_gt_i32 s90,0
s_cbranch_scc1 hl_65
hg_66:
buffer_load_dwordx4 v[32:35],v26,s[20:23],s70 offen offset:0 sc1
buffer_load_dwordx4 v[36:39],v26,s[20:23],s70 offen offset:1024 sc1
buffer_load_dwordx4 v[40:43],v26,s[20:23],s70 offen offset:2048 sc1
buffer_load_dwordx4 v[44:47],v26,s[20:23],s70 offen offset:3072 sc1
s_waitcnt vmcnt(3)
ds_write_b128 v24,v[32:35] offset:0
v_min3_u32 v22,v32,v33,v34
v_min_u32 v22,v22,v35
s_waitcnt vmcnt(2)
ds_write_b128 v24,v[36:39] offset:1024
v_min3_u32 v22,v22,v36,v37
v_min3_u32 v22,v22,v38,v39
s_waitcnt vmcnt(1)
ds_write_b128 v24,v[40:43] offset:2048
v_min3_u32 v22,v22,v40,v41
v_min3_u32 v22,v22,v42,v43
s_waitcnt vmcnt(0)
ds_write_b128 v24,v[44:47] offset:3072
v_min3_u32 v22,v22,v44,v45
v_min3_u32 v22,v22,v46,v47
v_cmp_eq_u32 vcc,0,v22
s_cbranch_vccnz art_67
abk_68:
v_smfmac_f32_16x16x64_bf16 v[176:179],v[32:35],a[0:7],v14
s_waitcnt lgkmcnt(0)
s_barrier
ds_read_b128 v[48:51],v24 offset:4096
ds_read_b128 v[52:55],v24 offset:5120
ds_read_b128 v[56:59],v24 offset:6144
ds_read_b128 v[60:63],v24 offset:7168
v_smfmac_f32_16x16x64_bf16 v[176:179],v[36:39],a[8:15],v14
ds_read_b128 v[64:67],v24 offset:8192
ds_read_b128 v[68:71],v24 offset:9216
v_smfmac_f32_16x16x64_bf16 v[176:179],v[40:43],a[16:23],v14
ds_read_b128 v[72:75],v24 offset:10240
ds_read_b128 v[76:79],v24 offset:11264
v_smfmac_f32_16x16x64_bf16 v[176:179],v[44:47],a[24:31],v14
ds_read_b128 v[80:83],v24 offset:12288
ds_read_b128 v[84:87],v24 offset:13312
s_waitcnt lgkmcnt(9)
v_smfmac_f32_16x16x64_bf16 v[176:179],v[48:51],a[32:39],v14
ds_read_b128 v[88:91],v24 offset:14336
s_waitcnt lgkmcnt(9)
v_smfmac_f32_16x16x64_bf16 v[176:179],v[52:55],a[40:47],v14
ds_read_b128 v[92:95],v24 offset:15360
s_waitcnt lgkmcnt(9)
v_smfmac_f32_16x16x64_bf16 v[176:179],v[56:59],a[48:55],v14
s_waitcnt lgkmcnt(8)
v_smfmac_f32_16x16x64_bf16 v[176:179],v[60:63],a[56:63],v14
s_waitcnt lgkmcnt(7)
v_smfmac_f32_16x16x64_bf16 v[176:179],v[64:67],a[64:71],v14
s_waitcnt lgkmcnt(6)
v_smfmac_f32_16x16x64_bf16 v[176:179],v[68:71],a[72:79],v14
s_waitcnt lgkmcnt(5)
v_smfmac_f32_16x16x64_bf16 v[176:179],v[72:75],a[80:87],v14
s_waitcnt lgkmcnt(4)
v_smfmac_f32_16x16x64_bf16 v[176:179],v[76:79],a[88:95],v14
s_waitcnt lgkmcnt(3)
v_smfmac_f32_16x16x64_bf16 v[176:179],v[80:83],a[96:103],v14
s_waitcnt lgkmcnt(2)
v_smfmac_f32_16x16x64_bf16 v[176:179],v[84:87],a[104:111],v14
s_waitcnt lgkmcnt(1)
v_smfmac_f32_16x16x64_bf16 v[176:179],v[88:91],a[112:119],v14
s_waitcnt lgkmcnt(0)
v_smfmac_f32_16x16x64_bf16 v[176:179],v[92:95],a[120:127],v14
s_nop 7
v_permlane32_swap_b32 v176,v178
v_permlane32_swap_b32 v177,v179
v_add_f32 v176,v176,v178
v_add_f32 v177,v177,v179
v_cvt_pk_bf16_f32 v216,v176,v177
s_nop 1
v_mov_b32_dpp v217,v216 quad_perm:[1,0,3,2] row_mask:0xf bank_mask:0xf
v_perm_b32 v216,v217,v216,v15
v_max_u32 v216,1,v216
buffer_store_dword v216,v19,s[24:27],s70 offen
buffer_store_dword v216,v19,s[28:31],s70 offen sc1
s_lshr_b32 s64,s70,9
v_add_u32 v22,s64,v24
s_cmp_eq_u32 s79,0
ds_read_b128 v[128:131],v22 offset:16384
ds_read_b128 v[132:135],v22 offset:17408
s_cbranch_scc1 kt0_69
kt0b_70:
s_nop 15
s_nop 12
buffer_load_dwordx4 v[32:35],v8,s[20:23],s70 offen sc1
buffer_load_dwordx4 v[36:39],v9,s[20:23],s70 offen sc1
buffer_load_dwordx4 v[40:43],v10,s[20:23],s70 offen sc1
buffer_load_dwordx4 v[44:47],v11,s[20:23],s70 offen sc1
s_nop 9
scp_71:
buffer_load_dwordx4 v[48:51],v8,s[20:23],s70 offen sc1
buffer_load_dwordx4 v[52:55],v9,s[20:23],s70 offen sc1
buffer_load_dwordx4 v[56:59],v10,s[20:23],s70 offen sc1
buffer_load_dwordx4 v[60:63],v11,s[20:23],s70 offen sc1
s_waitcnt vmcnt(4)
v_mfma_f32_16x16x32_bf16 v[168:171],v[32:35],v[32:35],v[156:159]
v_min3_u32 v22,v32,v33,v34
v_min3_u32 v22,v22,v35,v36
v_mfma_f32_16x16x32_bf16 v[164:167],v[100:103],v[32:35],0
v_min3_u32 v22,v22,v37,v38
v_min3_u32 v22,v22,v39,v40
v_mfma_f32_16x16x32_bf16 v[160:163],v[96:99],v[32:35],0
v_min3_u32 v22,v22,v41,v42
v_min3_u32 v22,v22,v43,v44
v_mfma_f32_16x16x32_bf16 v[168:171],v[36:39],v[36:39],v[168:171]
v_min3_u32 v22,v22,v45,v46
v_min_u32 v22,v22,v47
v_mfma_f32_16x16x32_bf16 v[164:167],v[108:111],v[36:39],v[164:167]
v_cmp_eq_u32 vcc,0,v22
s_cbranch_vccnz nx_73
v_mfma_f32_16x16x32_bf16 v[160:163],v[104:107],v[36:39],v[160:163]
v_mov_b32 v172,v32
v_mfma_f32_16x16x32_bf16 v[168:171],v[40:43],v[40:43],v[168:171]
v_mov_b32 v173,v33
v_mfma_f32_16x16x32_bf16 v[164:167],v[116:119],v[40:43],v[164:167]
v_mov_b32 v174,v34
v_mfma_f32_16x16x32_bf16 v[160:163],v[112:115],v[40:43],v[160:163]
v_mov_b32 v175,v35
v_mfma_f32_16x16x32_bf16 v[168:171],v[44:47],v[44:47],v[168:171]
v_mfma_f32_16x16x32_bf16 v[164:167],v[124:127],v[44:47],v[164:167]
v_mfma_f32_16x16x32_bf16 v[160:163],v[120:123],v[44:47],v[160:163]
s_nop 1
s_branch scok_72
nx_73:
buffer_load_dwordx4 v[32:35],v8,s[20:23],s70 offen sc1
buffer_load_dwordx4 v[36:39],v9,s[20:23],s70 offen sc1
buffer_load_dwordx4 v[40:43],v10,s[20:23],s70 offen sc1
buffer_load_dwordx4 v[44:47],v11,s[20:23],s70 offen sc1
s_waitcnt vmcnt(4)
v_mfma_f32_16x16x32_bf16 v[168:171],v[48:51],v[48:51],v[156:159]
v_min3_u32 v22,v48,v49,v50
v_min3_u32 v22,v22,v51,v52
v_mfma_f32_16x16x32_bf16 v[164:167],v[100:103],v[48:51],0
v_min3_u32 v22,v22,v53,v54
v_min3_u32 v22,v22,v55,v56
v_mfma_f32_16x16x32_bf16 v[160:163],v[96:99],v[48:51],0
v_min3_u32 v22,v22,v57,v58
v_min3_u32 v22,v22,v59,v60
v_mfma_f32_16x16x32_bf16 v[168:171],v[52:55],v[52:55],v[168:171]
v_min3_u32 v22,v22,v61,v62
v_min_u32 v22,v22,v63
v_mfma_f32_16x16x32_bf16 v[164:167],v[108:111],v[52:55],v[164:167]
v_cmp_eq_u32 vcc,0,v22
s_cbranch_vccnz nx_74
v_mfma_f32_16x16x32_bf16 v[160:163],v[104:107],v[52:55],v[160:163]
v_mov_b32 v172,v48
v_mfma_f32_16x16x32_bf16 v[168:171],v[56:59],v[56:59],v[168:171]
v_mov_b32 v173,v49
v_mfma_f32_16x16x32_bf16 v[164:167],v[116:119],v[56:59],v[164:167]
v_mov_b32 v174,v50
v_mfma_f32_16x16x32_bf16 v[160:163],v[112:115],v[56:59],v[160:163]
v_mov_b32 v175,v51
v_mfma_f32_16x16x32_bf16 v[168:171],v[60:63],v[60:63],v[168:171]
v_mfma_f32_16x16x32_bf16 v[164:167],v[124:127],v[60:63],v[164:167]
v_mfma_f32_16x16x32_bf16 v[160:163],v[120:123],v[60:63],v[160:163]
s_nop 1
s_branch scok_72
nx_74:
s_sub_u32 s90,s90,1
s_cmp_gt_i32 s90,0
s_cbranch_scc1 scp_71
s_nop 7
scok_72:
ds_read_b64 v[220:221],v21
ds_read_b64 v[136:137],v31
ds_read_b64 v[140:141],v31 offset:256
s_cmp_ge_u32 s79,62
s_cbranch_scc1 ke_76
keb_77:
v_max3_f32 v216,v168,v169,v170
v_mov_b32_dpp v160,v164 row_ror:8 row_mask:0xf bank_mask:0xc
v_mov_b32_dpp v161,v165 row_ror:8 row_mask:0xf bank_mask:0xc
v_mov_b32_dpp v162,v166 row_ror:8 row_mask:0xf bank_mask:0xc
v_mov_b32_dpp v163,v167 row_ror:8 row_mask:0xf bank_mask:0xc
v_max3_f32 v217,v171,v160,v161
v_max3_f32 v216,v216,v162,v163
v_max_f32 v216,v216,v217
s_nop 1
v_max_f32_dpp v216,v216,v216 row_ror:8 row_mask:0xf bank_mask:0xf
v_mov_b32 v217,v216
s_nop 1
v_permlane16_swap_b32 v217,v216
v_max_f32 v216,v216,v217
v_mov_b32 v217,v216
s_nop 1
v_permlane32_swap_b32 v217,v216
v_max_f32 v216,v216,v217
v_mul_f32 v216,s81,v216
v_fma_f32 v160,v160,s81,-v216
v_fma_f32 v161,v161,s81,-v216
v_fma_f32 v162,v162,s81,-v216
v_fma_f32 v163,v163,s81,-v216
v_fma_f32 v168,v168,s81,-v216
v_fma_f32 v169,v169,s81,-v216
v_fma_f32 v170,v170,s81,-v216
v_fma_f32 v171,v171,s81,-v216
v_exp_f32 v160,v160
v_exp_f32 v161,v161
v_exp_f32 v162,v162
v_exp_f32 v163,v163
v_exp_f32 v168,v168
v_exp_f32 v169,v169
v_exp_f32 v170,v170
v_exp_f32 v171,v171
v_cvt_pk_bf16_f32 v148,v160,v161
v_cvt_pk_bf16_f32 v149,v162,v163
v_cvt_pk_bf16_f32 v144,v168,v169
v_mov_b32_dpp v150,v148 row_ror:8 row_mask:0xf bank_mask:0xf
v_mov_b32_dpp v151,v149 row_ror:8 row_mask:0xf bank_mask:0xf
v_cvt_pk_bf16_f32 v145,v170,v171
s_waitcnt lgkmcnt(0)
v_min_u32 v220,v220,v221
v_mfma_f32_16x16x32_bf16 v[232:235],v[152:155],v[148:151],0
v_cmp_ne_u32 vcc,v220,v25
v_mfma_f32_16x16x32_bf16 v[232:235],v[152:155],v[144:147],v[232:235]
v_mfma_f32_16x16x32_bf16 v[224:227],v[128:131],v[148:151],0
v_mfma_f32_16x16x32_bf16 v[228:231],v[132:135],v[148:151],0
s_cbranch_vccnz vw_78
vb_79:
v_mfma_f32_16x16x32_bf16 v[224:227],v[136:139],v[144:147],v[224:227]
v_mfma_f32_16x16x32_bf16 v[228:231],v[140:143],v[144:147],v[228:231]
s_mov_b64 exec,s[84:85]
s_nop 1
v_rcp_f32 v236,v232
s_nop 2
v_pk_mul_f32 v[224:225],v[224:225],v[236:237] op_sel_hi:[1,0]
v_pk_mul_f32 v[226:227],v[226:227],v[236:237] op_sel_hi:[1,0]
v_pk_mul_f32 v[228:229],v[228:229],v[236:237] op_sel_hi:[1,0]
v_pk_mul_f32 v[230:231],v[230:231],v[236:237] op_sel_hi:[1,0]
v_cvt_pk_bf16_f32 v216,v224,v225
v_cvt_pk_bf16_f32 v217,v226,v227
v_cvt_pk_bf16_f32 v218,v228,v229
v_cvt_pk_bf16_f32 v219,v230,v231
v_max_u32 v216,1,v216
v_max_u32 v217,1,v217
v_max_u32 v218,1,v218
v_max_u32 v219,1,v219
buffer_store_dwordx4 v[216:219],v30,s[24:27],s71 offen
buffer_store_dwordx4 v[216:219],v30,s[28:31],s71 offen sc1
s_mov_b64 exec,1
buffer_store_dword v25,v13,s[24:27],s70 offen offset:512
buffer_store_dword v25,v13,s[28:31],s70 offen offset:512 sc1
s_mov_b64 exec,-1
ds_write_b32 v21,v25 offset:8
hl_80:
buffer_load_dword v248,v18,s[20:23],s70 offen offset:512 sc1
s_waitcnt vmcnt(0)
v_cmp_eq_u32 vcc,v25,v248
s_bcnt1_i32_b32 s64,vcc_lo
s_cmp_ge_u32 s64,16
s_cbranch_scc1 hg_81
s_sub_u32 s90,s90,1
s_cmp_gt_i32 s90,0
s_cbranch_scc1 hl_80
hg_81:
buffer_load_dwordx4 v[32:35],v26,s[20:23],s71 offen offset:0 sc1
buffer_load_dwordx4 v[36:39],v26,s[20:23],s71 offen offset:1024 sc1
buffer_load_dwordx4 v[40:43],v26,s[20:23],s71 offen offset:2048 sc1
buffer_load_dwordx4 v[44:47],v26,s[20:23],s71 offen offset:3072 sc1
buffer_load_dwordx4 v[48:51],v27,s[20:23],s71 offen offset:0 sc1
buffer_load_dwordx4 v[52:55],v27,s[20:23],s71 offen offset:1024 sc1
buffer_load_dwordx4 v[56:59],v27,s[20:23],s71 offen offset:2048 sc1
buffer_load_dwordx4 v[60:63],v27,s[20:23],s71 offen offset:3072 sc1
s_mov_b32 s68,0
s_waitcnt vmcnt(6)
v_smfmac_f32_16x16x64_bf16 v[184:187],v[32:35],a[128:135],v14
v_min3_u32 v22,v32,v33,v34
v_min3_u32 v22,v22,v35,v36
v_smfmac_f32_16x16x64_bf16 v[188:191],v[32:35],a[136:143],v14
v_min3_u32 v22,v22,v37,v38
v_smfmac_f32_16x16x64_bf16 v[184:187],v[36:39],a[144:151],v14
v_min_u32 v22,v22,v39
v_smfmac_f32_16x16x64_bf16 v[188:191],v[36:39],a[152:159],v14
v_cmp_eq_u32 s[52:53],0,v22
s_waitcnt vmcnt(4)
v_smfmac_f32_16x16x64_bf16 v[184:187],v[40:43],a[160:167],v14
v_min3_u32 v22,v40,v41,v42
s_cmp_lg_u64 s[52:53],0
v_smfmac_f32_16x16x64_bf16 v[188:191],v[40:43],a[168:175],v14
s_cbranch_scc1 ms_82
bk_83:
v_min3_u32 v22,v22,v43,v44
v_smfmac_f32_16x16x64_bf16 v[184:187],v[44:47],a[176:183],v14
v_min3_u32 v22,v22,v45,v46
v_min_u32 v22,v22,v47
v_smfmac_f32_16x16x64_bf16 v[188:191],v[44:47],a[184:191],v14
v_cmp_eq_u32 s[54:55],0,v22
s_waitcnt vmcnt(2)
v_smfmac_f32_16x16x64_bf16 v[184:187],v[48:51],a[192:199],v14
v_min3_u32 v22,v48,v49,v50
s_cmp_lg_u64 s[54:55],0
v_smfmac_f32_16x16x64_bf16 v[188:191],v[48:51],a[200:207],v14
s_cbranch_scc1 ms_84
bk_85:
v_min3_u32 v22,v22,v51,v52
v_smfmac_f32_16x16x64_bf16 v[184:187],v[52:55],a[208:215],v14
v_min3_u32 v22,v22,v53,v54
v_min_u32 v22,v22,v55
v_smfmac_f32_16x16x64_bf16 v[188:191],v[52:55],a[216:223],v14
v_cmp_eq_u32 s[52:53],0,v22
s_waitcnt vmcnt(0)
v_smfmac_f32_16x16x64_bf16 v[184:187],v[56:59],a[224:231],v14
v_min3_u32 v22,v56,v57,v58
s_cmp_lg_u64 s[52:53],0
v_smfmac_f32_16x16x64_bf16 v[188:191],v[56:59],a[232:239],v14
s_cbranch_scc1 ms_86
bk_87:
v_min3_u32 v22,v22,v59,v60
v_smfmac_f32_16x16x64_bf16 v[184:187],v[60:63],a[240:247],v14
v_min3_u32 v22,v22,v61,v62
v_min_u32 v22,v22,v63
v_smfmac_f32_16x16x64_bf16 v[188:191],v[60:63],a[248:255],v14
v_cmp_eq_u32 s[54:55],0,v22
s_cmp_lg_u64 s[54:55],0
s_cbranch_scc1 ms_90
bk_91:
s_cmp_lg_u32 s68,0
s_cbranch_scc1 rl2_92
fin_88:
s_nop 2
v_permlane32_swap_b32 v184,v188
v_permlane32_swap_b32 v185,v189
v_permlane32_swap_b32 v186,v190
v_permlane32_swap_b32 v187,v191
v_pk_add_f32 v[184:185],v[184:185],v[188:189]
v_pk_add_f32 v[186:187],v[186:187],v[190:191]
ds_write_b128 v24,v[184:187] offset:25600
ds_write_b32 v21,v25 offset:12
s_mov_b64 exec,s[84:85]
ds_read_b128 v[172:175],v12
s_mov_b64 exec,-1
ds_read_b64 v[220:221],v21 offset:24
buffer_load_dwordx4 v[96:99],v2,s[20:23],s72 offen offset:0 sc1
buffer_load_dwordx4 v[100:103],v2,s[20:23],s72 offen offset:1024 sc1
buffer_load_dwordx4 v[104:107],v5,s[20:23],s72 offen offset:0 sc1
buffer_load_dwordx4 v[108:111],v5,s[20:23],s72 offen offset:1024 sc1
buffer_load_dwordx4 v[112:115],v6,s[20:23],s72 offen offset:0 sc1
buffer_load_dwordx4 v[116:119],v6,s[20:23],s72 offen offset:1024 sc1
buffer_load_dwordx4 v[120:123],v7,s[20:23],s72 offen offset:0 sc1
buffer_load_dwordx4 v[124:127],v7,s[20:23],s72 offen offset:1024 sc1
s_waitcnt lgkmcnt(0)
v_min_u32 v220,v220,v221
v_cmp_ne_u32 vcc,v220,v25
s_cbranch_vccnz v2w_93
v2b_94:
buffer_store_dwordx4 v[172:175],v3,s[20:23],s77 offen sc1
s_xor_b32 s62,s62,0x10000
s_add_u32 s63,s79,1
s_and_b32 s64,s63,3
s_lshl_b32 s70,s64,20
s_add_u32 s65,s63,2
s_and_b32 s65,s65,3
s_lshl_b32 s73,s65,20
s_add_u32 s55,s63,3
s_lshl_b32 s78,s55,16
s_add_u32 s78,s78,57344
s_cmp_lt_u32 s55,64
s_cselect_b32 s78,s78,0x7fff0000
s_add_u32 s71,s70,65536
s_add_u32 s60,s63,1
s_and_b32 s60,s60,3
s_lshl_b32 s72,s60,20
v_mov_b32 v184,0
v_mov_b32 v185,0
v_mov_b32 v186,0
v_mov_b32 v187,0
v_mov_b32 v188,0
v_mov_b32 v189,0
v_mov_b32 v190,0
v_mov_b32 v191,0
s_lshl_b32 s77,s63,21
s_lshl_b32 s55,s63,13
s_and_b32 s55,s55,0x2000
s_xor_b32 s55,s55,s61
s_add_u32 s77,s77,s55
v_mov_b32 v176,0
v_mov_b32 v177,0
v_mov_b32 v178,0
v_mov_b32 v179,0
s_add_u32 s79,s79,1
v_add_u32 v25,1,v25
s_waitcnt vmcnt(0) lgkmcnt(0)
s_branch loop_63
last0_75:
wf_95:
ds_read_b32 v23,v21 offset:0
s_sub_u32 s90,s90,1
s_waitcnt lgkmcnt(0)
v_cmp_ne_u32 vcc,v23,v25
s_cmp_lt_i32 s90,0
s_cselect_b64 vcc,0,vcc
s_cbranch_vccnz wf_95
wf_96:
ds_read_b32 v23,v21 offset:4
s_sub_u32 s90,s90,1
s_waitcnt lgkmcnt(0)
v_cmp_ne_u32 vcc,v23,v25
s_cmp_lt_i32 s90,0
s_cselect_b64 vcc,0,vcc
s_cbranch_vccnz wf_96
s_mov_b64 exec,s[84:85]
ds_read_b128 v[172:175],v12
s_mov_b64 exec,-1
s_waitcnt lgkmcnt(0)
buffer_store_dwordx4 v[172:175],v3,s[20:23],s77 offen sc1
s_branch end_57
art_67:
s_sub_u32 s90,s90,1
s_cmp_lt_i32 s90,0
s_cbranch_scc1 abk_68
buffer_load_dwordx4 v[32:35],v26,s[20:23],s70 offen offset:0 sc1
buffer_load_dwordx4 v[36:39],v26,s[20:23],s70 offen offset:1024 sc1
buffer_load_dwordx4 v[40:43],v26,s[20:23],s70 offen offset:2048 sc1
buffer_load_dwordx4 v[44:47],v26,s[20:23],s70 offen offset:3072 sc1
s_waitcnt vmcnt(3)
ds_write_b128 v24,v[32:35] offset:0
v_min3_u32 v22,v32,v33,v34
v_min_u32 v22,v22,v35
s_waitcnt vmcnt(2)
ds_write_b128 v24,v[36:39] offset:1024
v_min3_u32 v22,v22,v36,v37
v_min3_u32 v22,v22,v38,v39
s_waitcnt vmcnt(1)
ds_write_b128 v24,v[40:43] offset:2048
v_min3_u32 v22,v22,v40,v41
v_min3_u32 v22,v22,v42,v43
s_waitcnt vmcnt(0)
ds_write_b128 v24,v[44:47] offset:3072
v_min3_u32 v22,v22,v44,v45
v_min3_u32 v22,v22,v46,v47
v_cmp_eq_u32 vcc,0,v22
s_cbranch_vccnz art_67
s_branch abk_68
kt0_69:
buffer_load_dwordx4 v[96:99],v2,s[20:23],s70 offen offset:0 sc1
buffer_load_dwordx4 v[100:103],v2,s[20:23],s70 offen offset:1024 sc1
buffer_load_dwordx4 v[104:107],v5,s[20:23],s70 offen offset:0 sc1
buffer_load_dwordx4 v[108:111],v5,s[20:23],s70 offen offset:1024 sc1
buffer_load_dwordx4 v[112:115],v6,s[20:23],s70 offen offset:0 sc1
buffer_load_dwordx4 v[116:119],v6,s[20:23],s70 offen offset:1024 sc1
buffer_load_dwordx4 v[120:123],v7,s[20:23],s70 offen offset:0 sc1
buffer_load_dwordx4 v[124:127],v7,s[20:23],s70 offen offset:1024 sc1
s_branch kt0b_70
ke_76:
s_cmp_eq_u32 s79,63
s_cbranch_scc1 last0_75
ds_read_b64 v[222:223],v21 offset:24
s_mov_b64 exec,s[84:85]
ds_read_b128 v[172:175],v12
s_mov_b64 exec,-1
s_waitcnt lgkmcnt(0)
v_min3_u32 v222,v222,v223,v220
v_min_u32 v222,v222,v221
v_cmp_ne_u32 vcc,v222,v25
s_cbranch_vccnz keb_77
buffer_store_dwordx4 v[172:175],v3,s[20:23],s77 offen sc1
s_mov_b32 s77,0x7fff0000
s_branch keb_77
vw_78:
wf_97:
ds_read_b32 v23,v21 offset:0
s_sub_u32 s90,s90,1
s_waitcnt lgkmcnt(0)
v_cmp_ne_u32 vcc,v23,v25
s_cmp_lt_i32 s90,0
s_cselect_b64 vcc,0,vcc
s_cbranch_vccnz wf_97
wf_98:
ds_read_b32 v23,v21 offset:4
s_sub_u32 s90,s90,1
s_waitcnt lgkmcnt(0)
v_cmp_ne_u32 vcc,v23,v25
s_cmp_lt_i32 s90,0
s_cselect_b64 vcc,0,vcc
s_cbranch_vccnz wf_98
ds_read_b64 v[220:221],v21
ds_read_b64 v[136:137],v31
ds_read_b64 v[140:141],v31 offset:256
s_waitcnt lgkmcnt(0)
s_branch vb_79
ms_82:
s_waitcnt vmcnt(0)
buffer_load_dwordx4 v[64:67],v26,s[20:23],s71 offen offset:0 sc1
buffer_load_dwordx4 v[68:71],v26,s[20:23],s71 offen offset:1024 sc1
s_bitset1_b32 s68,0
s_branch bk_83
ms_84:
s_waitcnt vmcnt(0)
buffer_load_dwordx4 v[72:75],v26,s[20:23],s71 offen offset:2048 sc1
buffer_load_dwordx4 v[76:79],v26,s[20:23],s71 offen offset:3072 sc1
s_bitset1_b32 s68,1
s_branch bk_85
ms_86:
s_waitcnt vmcnt(0)
buffer_load_dwordx4 v[80:83],v27,s[20:23],s71 offen offset:0 sc1
buffer_load_dwordx4 v[84:87],v27,s[20:23],s71 offen offset:1024 sc1
s_bitset1_b32 s68,2
s_branch bk_87
ms_90:
s_waitcnt vmcnt(0)
buffer_load_dwordx4 v[88:91],v27,s[20:23],s71 offen offset:2048 sc1
buffer_load_dwordx4 v[92:95],v27,s[20:23],s71 offen offset:3072 sc1
s_bitset1_b32 s68,3
s_branch bk_91
rl_89:
s_bitcmp1_b32 s68,0
s_cbranch_scc0 sk_99
buffer_load_dwordx4 v[64:67],v26,s[20:23],s71 offen offset:0 sc1
buffer_load_dwordx4 v[68:71],v26,s[20:23],s71 offen offset:1024 sc1
sk_99:
s_bitcmp1_b32 s68,1
s_cbranch_scc0 sk_100
buffer_load_dwordx4 v[72:75],v26,s[20:23],s71 offen offset:2048 sc1
buffer_load_dwordx4 v[76:79],v26,s[20:23],s71 offen offset:3072 sc1
sk_100:
s_bitcmp1_b32 s68,2
s_cbranch_scc0 sk_101
buffer_load_dwordx4 v[80:83],v27,s[20:23],s71 offen offset:0 sc1
buffer_load_dwordx4 v[84:87],v27,s[20:23],s71 offen offset:1024 sc1
sk_101:
s_bitcmp1_b32 s68,3
s_cbranch_scc0 sk_102
buffer_load_dwordx4 v[88:91],v27,s[20:23],s71 offen offset:2048 sc1
buffer_load_dwordx4 v[92:95],v27,s[20:23],s71 offen offset:3072 sc1
sk_102:
rl2_92:
s_sub_u32 s90,s90,1
s_cmp_lt_i32 s90,0
s_cbranch_scc1 fin_88
s_waitcnt vmcnt(0)
s_bitcmp1_b32 s68,0
s_cbranch_scc0 sk_103
v_min3_u32 v22,v64,v65,v66
v_min3_u32 v22,v22,v67,v68
v_min3_u32 v22,v22,v69,v70
v_min_u32 v22,v22,v71
v_cmp_eq_u32 vcc,0,v22
v_xor_b32 v64,v32,v64
v_xor_b32 v65,v33,v65
v_xor_b32 v66,v34,v66
v_xor_b32 v67,v35,v67
v_xor_b32 v68,v36,v68
v_xor_b32 v69,v37,v69
v_xor_b32 v70,v38,v70
v_xor_b32 v71,v39,v71
s_cbranch_vccnz nb_104
s_bitset0_b32 s68,0
v_smfmac_f32_16x16x64_bf16 v[184:187],v[64:67],a[128:135],v14
v_smfmac_f32_16x16x64_bf16 v[188:191],v[64:67],a[136:143],v14
v_smfmac_f32_16x16x64_bf16 v[184:187],v[68:71],a[144:151],v14
v_smfmac_f32_16x16x64_bf16 v[188:191],v[68:71],a[152:159],v14
nb_104:
sk_103:
s_bitcmp1_b32 s68,1
s_cbranch_scc0 sk_105
v_min3_u32 v22,v72,v73,v74
v_min3_u32 v22,v22,v75,v76
v_min3_u32 v22,v22,v77,v78
v_min_u32 v22,v22,v79
v_cmp_eq_u32 vcc,0,v22
v_xor_b32 v72,v40,v72
v_xor_b32 v73,v41,v73
v_xor_b32 v74,v42,v74
v_xor_b32 v75,v43,v75
v_xor_b32 v76,v44,v76
v_xor_b32 v77,v45,v77
v_xor_b32 v78,v46,v78
v_xor_b32 v79,v47,v79
s_cbranch_vccnz nb_106
s_bitset0_b32 s68,1
v_smfmac_f32_16x16x64_bf16 v[184:187],v[72:75],a[160:167],v14
v_smfmac_f32_16x16x64_bf16 v[188:191],v[72:75],a[168:175],v14
v_smfmac_f32_16x16x64_bf16 v[184:187],v[76:79],a[176:183],v14
v_smfmac_f32_16x16x64_bf16 v[188:191],v[76:79],a[184:191],v14
nb_106:
sk_105:
s_bitcmp1_b32 s68,2
s_cbranch_scc0 sk_107
v_min3_u32 v22,v80,v81,v82
v_min3_u32 v22,v22,v83,v84
v_min3_u32 v22,v22,v85,v86
v_min_u32 v22,v22,v87
v_cmp_eq_u32 vcc,0,v22
v_xor_b32 v80,v48,v80
v_xor_b32 v81,v49,v81
v_xor_b32 v82,v50,v82
v_xor_b32 v83,v51,v83
v_xor_b32 v84,v52,v84
v_xor_b32 v85,v53,v85
v_xor_b32 v86,v54,v86
v_xor_b32 v87,v55,v87
s_cbranch_vccnz nb_108
s_bitset0_b32 s68,2
v_smfmac_f32_16x16x64_bf16 v[184:187],v[80:83],a[192:199],v14
v_smfmac_f32_16x16x64_bf16 v[188:191],v[80:83],a[200:207],v14
v_smfmac_f32_16x16x64_bf16 v[184:187],v[84:87],a[208:215],v14
v_smfmac_f32_16x16x64_bf16 v[188:191],v[84:87],a[216:223],v14
nb_108:
sk_107:
s_bitcmp1_b32 s68,3
s_cbranch_scc0 sk_109
v_min3_u32 v22,v88,v89,v90
v_min3_u32 v22,v22,v91,v92
v_min3_u32 v22,v22,v93,v94
v_min_u32 v22,v22,v95
v_cmp_eq_u32 vcc,0,v22
v_xor_b32 v88,v56,v88
v_xor_b32 v89,v57,v89
v_xor_b32 v90,v58,v90
v_xor_b32 v91,v59,v91
v_xor_b32 v92,v60,v92
v_xor_b32 v93,v61,v93
v_xor_b32 v94,v62,v94
v_xor_b32 v95,v63,v95
s_cbranch_vccnz nb_110
s_bitset0_b32 s68,3
v_smfmac_f32_16x16x64_bf16 v[184:187],v[88:91],a[224:231],v14
v_smfmac_f32_16x16x64_bf16 v[188:191],v[88:91],a[232:239],v14
v_smfmac_f32_16x16x64_bf16 v[184:187],v[92:95],a[240:247],v14
v_smfmac_f32_16x16x64_bf16 v[188:191],v[92:95],a[248:255],v14
nb_110:
sk_109:
s_cmp_lg_u32 s68,0
s_cbranch_scc1 rl_89
s_nop 2
s_branch fin_88
v2w_93:
wf_111:
ds_read_b32 v23,v21 offset:24
s_sub_u32 s90,s90,1
s_waitcnt lgkmcnt(0)
v_cmp_ne_u32 vcc,v23,v25
s_cmp_lt_i32 s90,0
s_cselect_b64 vcc,0,vcc
s_cbranch_vccnz wf_111
wf_112:
ds_read_b32 v23,v21 offset:28
s_sub_u32 s90,s90,1
s_waitcnt lgkmcnt(0)
v_cmp_ne_u32 vcc,v23,v25
s_cmp_lt_i32 s90,0
s_cselect_b64 vcc,0,vcc
s_cbranch_vccnz wf_112
s_branch v2b_94
first_62:
s_waitcnt vmcnt(0) lgkmcnt(0)
s_barrier
s_add_u32 s64,s15,393216
buffer_load_dwordx4 a[176:179],v32,s[40:43],s64 offen nt
s_add_u32 s64,s15,425984
buffer_load_dwordx4 a[180:183],v32,s[40:43],s64 offen nt
s_add_u32 s64,s15,458752
buffer_load_dwordx4 a[184:187],v32,s[40:43],s64 offen nt
s_add_u32 s64,s15,491520
buffer_load_dwordx4 a[188:191],v32,s[40:43],s64 offen nt
s_add_u32 s64,s15,524288
buffer_load_dwordx4 a[192:195],v32,s[40:43],s64 offen nt
s_add_u32 s64,s15,557056
buffer_load_dwordx4 a[196:199],v32,s[40:43],s64 offen nt
s_add_u32 s64,s15,589824
buffer_load_dwordx4 a[200:203],v32,s[40:43],s64 offen nt
s_add_u32 s64,s15,622592
buffer_load_dwordx4 a[204:207],v32,s[40:43],s64 offen nt
s_add_u32 s64,s15,655360
buffer_load_dwordx4 a[208:211],v32,s[40:43],s64 offen nt
s_add_u32 s64,s15,688128
buffer_load_dwordx4 a[212:215],v32,s[40:43],s64 offen nt
s_add_u32 s64,s15,720896
buffer_load_dwordx4 a[216:219],v32,s[40:43],s64 offen nt
s_add_u32 s64,s15,753664
buffer_load_dwordx4 a[220:223],v32,s[40:43],s64 offen nt
s_add_u32 s64,s15,786432
buffer_load_dwordx4 a[224:227],v32,s[40:43],s64 offen nt
s_add_u32 s64,s15,819200
buffer_load_dwordx4 a[228:231],v32,s[40:43],s64 offen nt
s_add_u32 s64,s15,851968
buffer_load_dwordx4 a[232:235],v32,s[40:43],s64 offen nt
s_add_u32 s64,s15,884736
buffer_load_dwordx4 a[236:239],v32,s[40:43],s64 offen nt
s_add_u32 s64,s15,917504
buffer_load_dwordx4 a[240:243],v32,s[40:43],s64 offen nt
s_add_u32 s64,s15,950272
buffer_load_dwordx4 a[244:247],v32,s[40:43],s64 offen nt
s_add_u32 s64,s15,983040
buffer_load_dwordx4 a[248:251],v32,s[40:43],s64 offen nt
s_add_u32 s64,s15,1015808
buffer_load_dwordx4 a[252:255],v32,s[40:43],s64 offen nt
ds_write_b128 v33,a[0:3] offset:0
ds_write_b128 v33,a[4:7] offset:1024
ds_write_b128 v33,a[8:11] offset:2048
ds_write_b128 v33,a[12:15] offset:3072
s_waitcnt lgkmcnt(0)
v_mov_b32 v38,1
ds_write_b32 v37,v38 offset:0
qs_113:
ds_read_b32 v39,v37 offset:4
s_sub_u32 s90,s90,1
s_waitcnt lgkmcnt(0)
v_cmp_gt_u32 vcc,v38,v39
s_cmp_lt_i32 s90,0
s_cselect_b64 vcc,0,vcc
s_cbranch_vccnz qs_113
ds_read_b64_tr_b16 a[0:1],v36 offset:0
ds_read_b64_tr_b16 a[2:3],v36 offset:128
ds_read_b64_tr_b16 a[4:5],v36 offset:2048
ds_read_b64_tr_b16 a[6:7],v36 offset:2176
ds_read_b64_tr_b16 a[8:9],v36 offset:8192
ds_read_b64_tr_b16 a[10:11],v36 offset:8320
ds_read_b64_tr_b16 a[12:13],v36 offset:10240
ds_read_b64_tr_b16 a[14:15],v36 offset:10368
ds_write_b128 v33,a[16:19] offset:4096
ds_write_b128 v33,a[20:23] offset:5120
ds_write_b128 v33,a[24:27] offset:6144
ds_write_b128 v33,a[28:31] offset:7168
s_waitcnt lgkmcnt(0)
v_mov_b32 v38,2
ds_write_b32 v37,v38 offset:0
qs_114:
ds_read_b32 v39,v37 offset:4
s_sub_u32 s90,s90,1
s_waitcnt lgkmcnt(0)
v_cmp_gt_u32 vcc,v38,v39
s_cmp_lt_i32 s90,0
s_cselect_b64 vcc,0,vcc
s_cbranch_vccnz qs_114
ds_read_b64_tr_b16 a[16:17],v36 offset:4096
ds_read_b64_tr_b16 a[18:19],v36 offset:4224
ds_read_b64_tr_b16 a[20:21],v36 offset:6144
ds_read_b64_tr_b16 a[22:23],v36 offset:6272
ds_read_b64_tr_b16 a[24:25],v36 offset:12288
ds_read_b64_tr_b16 a[26:27],v36 offset:12416
ds_read_b64_tr_b16 a[28:29],v36 offset:14336
ds_read_b64_tr_b16 a[30:31],v36 offset:14464
ds_write_b128 v33,a[32:35] offset:0
ds_write_b128 v33,a[36:39] offset:1024
ds_write_b128 v33,a[40:43] offset:2048
ds_write_b128 v33,a[44:47] offset:3072
s_waitcnt lgkmcnt(0)
v_mov_b32 v38,3
ds_write_b32 v37,v38 offset:0
qs_115:
ds_read_b32 v39,v37 offset:4
s_sub_u32 s90,s90,1
s_waitcnt lgkmcnt(0)
v_cmp_gt_u32 vcc,v38,v39
s_cmp_lt_i32 s90,0
s_cselect_b64 vcc,0,vcc
s_cbranch_vccnz qs_115
ds_read_b64_tr_b16 a[32:33],v36 offset:0
ds_read_b64_tr_b16 a[34:35],v36 offset:128
ds_read_b64_tr_b16 a[36:37],v36 offset:2048
ds_read_b64_tr_b16 a[38:39],v36 offset:2176
ds_read_b64_tr_b16 a[40:41],v36 offset:8192
ds_read_b64_tr_b16 a[42:43],v36 offset:8320
ds_read_b64_tr_b16 a[44:45],v36 offset:10240
ds_read_b64_tr_b16 a[46:47],v36 offset:10368
ds_write_b128 v33,a[48:51] offset:4096
ds_write_b128 v33,a[52:55] offset:5120
ds_write_b128 v33,a[56:59] offset:6144
ds_write_b128 v33,a[60:63] offset:7168
s_waitcnt lgkmcnt(0)
v_mov_b32 v38,4
ds_write_b32 v37,v38 offset:0
qs_116:
ds_read_b32 v39,v37 offset:4
s_sub_u32 s90,s90,1
s_waitcnt lgkmcnt(0)
v_cmp_gt_u32 vcc,v38,v39
s_cmp_lt_i32 s90,0
s_cselect_b64 vcc,0,vcc
s_cbranch_vccnz qs_116
ds_read_b64_tr_b16 a[48:49],v36 offset:4096
ds_read_b64_tr_b16 a[50:51],v36 offset:4224
ds_read_b64_tr_b16 a[52:53],v36 offset:6144
ds_read_b64_tr_b16 a[54:55],v36 offset:6272
ds_read_b64_tr_b16 a[56:57],v36 offset:12288
ds_read_b64_tr_b16 a[58:59],v36 offset:12416
ds_read_b64_tr_b16 a[60:61],v36 offset:14336
ds_read_b64_tr_b16 a[62:63],v36 offset:14464
ds_write_b128 v33,a[64:67] offset:0
ds_write_b128 v33,a[68:71] offset:1024
ds_write_b128 v33,a[72:75] offset:2048
ds_write_b128 v33,a[76:79] offset:3072
s_waitcnt lgkmcnt(0)
v_mov_b32 v38,5
ds_write_b32 v37,v38 offset:0
qs_117:
ds_read_b32 v39,v37 offset:4
s_sub_u32 s90,s90,1
s_waitcnt lgkmcnt(0)
v_cmp_gt_u32 vcc,v38,v39
s_cmp_lt_i32 s90,0
s_cselect_b64 vcc,0,vcc
s_cbranch_vccnz qs_117
ds_read_b64_tr_b16 a[64:65],v36 offset:0
ds_read_b64_tr_b16 a[66:67],v36 offset:128
ds_read_b64_tr_b16 a[68:69],v36 offset:2048
ds_read_b64_tr_b16 a[70:71],v36 offset:2176
ds_read_b64_tr_b16 a[72:73],v36 offset:8192
ds_read_b64_tr_b16 a[74:75],v36 offset:8320
ds_read_b64_tr_b16 a[76:77],v36 offset:10240
ds_read_b64_tr_b16 a[78:79],v36 offset:10368
ds_write_b128 v33,a[80:83] offset:4096
ds_write_b128 v33,a[84:87] offset:5120
ds_write_b128 v33,a[88:91] offset:6144
ds_write_b128 v33,a[92:95] offset:7168
s_waitcnt lgkmcnt(0)
v_mov_b32 v38,6
ds_write_b32 v37,v38 offset:0
qs_118:
ds_read_b32 v39,v37 offset:4
s_sub_u32 s90,s90,1
s_waitcnt lgkmcnt(0)
v_cmp_gt_u32 vcc,v38,v39
s_cmp_lt_i32 s90,0
s_cselect_b64 vcc,0,vcc
s_cbranch_vccnz qs_118
ds_read_b64_tr_b16 a[80:81],v36 offset:4096
ds_read_b64_tr_b16 a[82:83],v36 offset:4224
ds_read_b64_tr_b16 a[84:85],v36 offset:6144
ds_read_b64_tr_b16 a[86:87],v36 offset:6272
ds_read_b64_tr_b16 a[88:89],v36 offset:12288
ds_read_b64_tr_b16 a[90:91],v36 offset:12416
ds_read_b64_tr_b16 a[92:93],v36 offset:14336
ds_read_b64_tr_b16 a[94:95],v36 offset:14464
ds_write_b128 v33,a[96:99] offset:0
ds_write_b128 v33,a[100:103] offset:1024
ds_write_b128 v33,a[104:107] offset:2048
ds_write_b128 v33,a[108:111] offset:3072
s_waitcnt lgkmcnt(0)
v_mov_b32 v38,7
ds_write_b32 v37,v38 offset:0
qs_119:
ds_read_b32 v39,v37 offset:4
s_sub_u32 s90,s90,1
s_waitcnt lgkmcnt(0)
v_cmp_gt_u32 vcc,v38,v39
s_cmp_lt_i32 s90,0
s_cselect_b64 vcc,0,vcc
s_cbranch_vccnz qs_119
ds_read_b64_tr_b16 a[96:97],v36 offset:0
ds_read_b64_tr_b16 a[98:99],v36 offset:128
ds_read_b64_tr_b16 a[100:101],v36 offset:2048
ds_read_b64_tr_b16 a[102:103],v36 offset:2176
ds_read_b64_tr_b16 a[104:105],v36 offset:8192
ds_read_b64_tr_b16 a[106:107],v36 offset:8320
ds_read_b64_tr_b16 a[108:109],v36 offset:10240
ds_read_b64_tr_b16 a[110:111],v36 offset:10368
ds_write_b128 v33,a[112:115] offset:4096
ds_write_b128 v33,a[116:119] offset:5120
ds_write_b128 v33,a[120:123] offset:6144
ds_write_b128 v33,a[124:127] offset:7168
s_waitcnt lgkmcnt(0)
v_mov_b32 v38,8
ds_write_b32 v37,v38 offset:0
qs_120:
ds_read_b32 v39,v37 offset:4
s_sub_u32 s90,s90,1
s_waitcnt lgkmcnt(0)
v_cmp_gt_u32 vcc,v38,v39
s_cmp_lt_i32 s90,0
s_cselect_b64 vcc,0,vcc
s_cbranch_vccnz qs_120
ds_read_b64_tr_b16 a[112:113],v36 offset:4096
ds_read_b64_tr_b16 a[114:115],v36 offset:4224
ds_read_b64_tr_b16 a[116:117],v36 offset:6144
ds_read_b64_tr_b16 a[118:119],v36 offset:6272
ds_read_b64_tr_b16 a[120:121],v36 offset:12288
ds_read_b64_tr_b16 a[122:123],v36 offset:12416
ds_read_b64_tr_b16 a[124:125],v36 offset:14336
ds_read_b64_tr_b16 a[126:127],v36 offset:14464
s_waitcnt lgkmcnt(0)
v_mov_b32 v38,9
ds_write_b32 v37,v38 offset:0
qs_121:
ds_read_b32 v39,v37 offset:4
s_sub_u32 s90,s90,1
s_waitcnt lgkmcnt(0)
v_cmp_gt_u32 vcc,v38,v39
s_cmp_lt_i32 s90,0
s_cselect_b64 vcc,0,vcc
s_cbranch_vccnz qs_121
ds_write_b128 v33,a[128:131] offset:0
ds_write_b128 v33,a[132:135] offset:1024
ds_write_b128 v33,a[136:139] offset:2048
ds_write_b128 v33,a[140:143] offset:3072
s_waitcnt lgkmcnt(0)
ds_read_b64_tr_b16 a[128:129],v34 offset:0
ds_read_b64_tr_b16 a[130:131],v34 offset:128
ds_read_b64_tr_b16 a[132:133],v34 offset:2048
ds_read_b64_tr_b16 a[134:135],v34 offset:2176
ds_read_b64_tr_b16 a[136:137],v34 offset:32
ds_read_b64_tr_b16 a[138:139],v34 offset:160
ds_read_b64_tr_b16 a[140:141],v34 offset:2080
ds_read_b64_tr_b16 a[142:143],v34 offset:2208
ds_write_b128 v33,a[144:147] offset:4096
ds_write_b128 v33,a[148:151] offset:5120
ds_write_b128 v33,a[152:155] offset:6144
ds_write_b128 v33,a[156:159] offset:7168
s_waitcnt lgkmcnt(0)
ds_read_b64_tr_b16 a[144:145],v34 offset:4096
ds_read_b64_tr_b16 a[146:147],v34 offset:4224
ds_read_b64_tr_b16 a[148:149],v34 offset:6144
ds_read_b64_tr_b16 a[150:151],v34 offset:6272
ds_read_b64_tr_b16 a[152:153],v34 offset:4128
ds_read_b64_tr_b16 a[154:155],v34 offset:4256
ds_read_b64_tr_b16 a[156:157],v34 offset:6176
ds_read_b64_tr_b16 a[158:159],v34 offset:6304
ds_write_b128 v33,a[160:163] offset:0
ds_write_b128 v33,a[164:167] offset:1024
ds_write_b128 v33,a[168:171] offset:2048
ds_write_b128 v33,a[172:175] offset:3072
s_waitcnt lgkmcnt(0)
ds_read_b64_tr_b16 a[160:161],v34 offset:0
ds_read_b64_tr_b16 a[162:163],v34 offset:128
ds_read_b64_tr_b16 a[164:165],v34 offset:2048
ds_read_b64_tr_b16 a[166:167],v34 offset:2176
ds_read_b64_tr_b16 a[168:169],v34 offset:32
ds_read_b64_tr_b16 a[170:171],v34 offset:160
ds_read_b64_tr_b16 a[172:173],v34 offset:2080
ds_read_b64_tr_b16 a[174:175],v34 offset:2208
free_122:
ds_read_b64 v[38:39],v37 offset:8
s_sub_u32 s90,s90,1
s_waitcnt lgkmcnt(0)
v_and_b32 v38,v38,v39
v_cmp_eq_u32 vcc,0,v38
s_cmp_lt_i32 s90,0
s_cselect_b64 vcc,0,vcc
s_cbranch_vccnz free_122
s_xor_b32 s64,s61,4194304
buffer_store_dwordx4 v[100:103],v206,s[20:23],s64 offen sc1
buffer_store_dwordx4 v[100:103],v207,s[20:23],s64 offen sc1
s_xor_b32 s64,s61,6299648
buffer_store_dwordx4 v[100:103],v206,s[20:23],s64 offen sc1
buffer_store_dwordx4 v[100:103],v207,s[20:23],s64 offen sc1
s_xor_b32 s64,s61,8388608
buffer_store_dwordx4 v[100:103],v206,s[20:23],s64 offen sc1
buffer_store_dwordx4 v[100:103],v207,s[20:23],s64 offen sc1
s_mov_b32 m0,0
s_mov_b32 s65,188416
buffer_load_dwordx4 v16,s[20:23],s65 offen offset:0 lds
buffer_load_dwordx4 v16,s[20:23],s65 offen offset:1024 lds
buffer_load_dwordx4 v16,s[20:23],s65 offen offset:2048 lds
buffer_load_dwordx4 v16,s[20:23],s65 offen offset:3072 lds
s_mov_b32 m0,4096
s_mov_b32 s65,192512
buffer_load_dwordx4 v16,s[20:23],s65 offen offset:0 lds
buffer_load_dwordx4 v16,s[20:23],s65 offen offset:1024 lds
buffer_load_dwordx4 v16,s[20:23],s65 offen offset:2048 lds
buffer_load_dwordx4 v16,s[20:23],s65 offen offset:3072 lds
s_mov_b32 m0,8192
s_mov_b32 s65,196608
buffer_load_dwordx4 v16,s[20:23],s65 offen offset:0 lds
buffer_load_dwordx4 v16,s[20:23],s65 offen offset:1024 lds
buffer_load_dwordx4 v16,s[20:23],s65 offen offset:2048 lds
buffer_load_dwordx4 v16,s[20:23],s65 offen offset:3072 lds
s_mov_b32 m0,12288
s_mov_b32 s65,200704
buffer_load_dwordx4 v16,s[20:23],s65 offen offset:0 lds
buffer_load_dwordx4 v16,s[20:23],s65 offen offset:1024 lds
buffer_load_dwordx4 v16,s[20:23],s65 offen offset:2048 lds
buffer_load_dwordx4 v16,s[20:23],s65 offen offset:3072 lds
s_mov_b32 m0,16384
s_mov_b32 s65,204800
buffer_load_dwordx4 v16,s[20:23],s65 offen offset:0 lds
buffer_load_dwordx4 v16,s[20:23],s65 offen offset:1024 lds
buffer_load_dwordx4 v16,s[20:23],s65 offen offset:2048 lds
buffer_load_dwordx4 v16,s[20:23],s65 offen offset:3072 lds
s_mov_b32 m0,20480
s_mov_b32 s65,208896
buffer_load_dwordx4 v16,s[20:23],s65 offen offset:0 lds
buffer_load_dwordx4 v16,s[20:23],s65 offen offset:1024 lds
buffer_load_dwordx4 v16,s[20:23],s65 offen offset:2048 lds
buffer_load_dwordx4 v16,s[20:23],s65 offen offset:3072 lds
s_mov_b32 m0,24576
s_mov_b32 s65,212992
buffer_load_dwordx4 v16,s[20:23],s65 offen offset:0 lds
buffer_load_dwordx4 v16,s[20:23],s65 offen offset:1024 lds
buffer_load_dwordx4 v16,s[20:23],s65 offen offset:2048 lds
buffer_load_dwordx4 v16,s[20:23],s65 offen offset:3072 lds
s_mov_b32 m0,28672
s_mov_b32 s65,217088
buffer_load_dwordx4 v16,s[20:23],s65 offen offset:0 lds
buffer_load_dwordx4 v16,s[20:23],s65 offen offset:1024 lds
buffer_load_dwordx4 v16,s[20:23],s65 offen offset:2048 lds
buffer_load_dwordx4 v16,s[20:23],s65 offen offset:3072 lds
s_waitcnt vmcnt(54)
ds_write_b128 v33,a[176:179] offset:4096
ds_write_b128 v33,a[180:183] offset:5120
ds_write_b128 v33,a[184:187] offset:6144
ds_write_b128 v33,a[188:191] offset:7168
s_waitcnt lgkmcnt(0)
ds_read_b64_tr_b16 a[176:177],v34 offset:4096
ds_read_b64_tr_b16 a[178:179],v34 offset:4224
ds_read_b64_tr_b16 a[180:181],v34 offset:6144
ds_read_b64_tr_b16 a[182:183],v34 offset:6272
ds_read_b64_tr_b16 a[184:185],v34 offset:4128
ds_read_b64_tr_b16 a[186:187],v34 offset:4256
ds_read_b64_tr_b16 a[188:189],v34 offset:6176
ds_read_b64_tr_b16 a[190:191],v34 offset:6304
s_waitcnt vmcnt(50)
ds_write_b128 v33,a[192:195] offset:0
ds_write_b128 v33,a[196:199] offset:1024
ds_write_b128 v33,a[200:203] offset:2048
ds_write_b128 v33,a[204:207] offset:3072
s_waitcnt lgkmcnt(0)
ds_read_b64_tr_b16 a[192:193],v34 offset:0
ds_read_b64_tr_b16 a[194:195],v34 offset:128
ds_read_b64_tr_b16 a[196:197],v34 offset:2048
ds_read_b64_tr_b16 a[198:199],v34 offset:2176
ds_read_b64_tr_b16 a[200:201],v34 offset:32
ds_read_b64_tr_b16 a[202:203],v34 offset:160
ds_read_b64_tr_b16 a[204:205],v34 offset:2080
ds_read_b64_tr_b16 a[206:207],v34 offset:2208
s_waitcnt vmcnt(46)
ds_write_b128 v33,a[208:211] offset:4096
ds_write_b128 v33,a[212:215] offset:5120
ds_write_b128 v33,a[216:219] offset:6144
ds_write_b128 v33,a[220:223] offset:7168
s_waitcnt lgkmcnt(0)
ds_read_b64_tr_b16 a[208:209],v34 offset:4096
ds_read_b64_tr_b16 a[210:211],v34 offset:4224
ds_read_b64_tr_b16 a[212:213],v34 offset:6144
ds_read_b64_tr_b16 a[214:215],v34 offset:6272
ds_read_b64_tr_b16 a[216:217],v34 offset:4128
ds_read_b64_tr_b16 a[218:219],v34 offset:4256
ds_read_b64_tr_b16 a[220:221],v34 offset:6176
ds_read_b64_tr_b16 a[222:223],v34 offset:6304
s_waitcnt vmcnt(42)
ds_write_b128 v33,a[224:227] offset:0
ds_write_b128 v33,a[228:231] offset:1024
ds_write_b128 v33,a[232:235] offset:2048
ds_write_b128 v33,a[236:239] offset:3072
s_waitcnt lgkmcnt(0)
ds_read_b64_tr_b16 a[224:225],v34 offset:0
ds_read_b64_tr_b16 a[226:227],v34 offset:128
ds_read_b64_tr_b16 a[228:229],v34 offset:2048
ds_read_b64_tr_b16 a[230:231],v34 offset:2176
ds_read_b64_tr_b16 a[232:233],v34 offset:32
ds_read_b64_tr_b16 a[234:235],v34 offset:160
ds_read_b64_tr_b16 a[236:237],v34 offset:2080
ds_read_b64_tr_b16 a[238:239],v34 offset:2208
s_waitcnt vmcnt(38)
ds_write_b128 v33,a[240:243] offset:4096
ds_write_b128 v33,a[244:247] offset:5120
ds_write_b128 v33,a[248:251] offset:6144
ds_write_b128 v33,a[252:255] offset:7168
s_waitcnt lgkmcnt(0)
ds_read_b64_tr_b16 a[240:241],v34 offset:4096
ds_read_b64_tr_b16 a[242:243],v34 offset:4224
ds_read_b64_tr_b16 a[244:245],v34 offset:6144
ds_read_b64_tr_b16 a[246:247],v34 offset:6272
ds_read_b64_tr_b16 a[248:249],v34 offset:4128
ds_read_b64_tr_b16 a[250:251],v34 offset:4256
ds_read_b64_tr_b16 a[252:253],v34 offset:6176
ds_read_b64_tr_b16 a[254:255],v34 offset:6304
s_mov_b32 s79,0
s_add_u32 s63,s79,0
s_and_b32 s64,s63,3
s_lshl_b32 s70,s64,20
s_add_u32 s65,s63,2
s_and_b32 s65,s65,3
s_lshl_b32 s73,s65,20
s_add_u32 s55,s63,3
s_lshl_b32 s78,s55,16
s_add_u32 s78,s78,57344
s_cmp_lt_u32 s55,64
s_cselect_b32 s78,s78,0x7fff0000
s_add_u32 s71,s70,65536
s_add_u32 s60,s63,1
s_and_b32 s60,s60,3
s_lshl_b32 s72,s60,20
v_mov_b32 v184,0
v_mov_b32 v185,0
v_mov_b32 v186,0
v_mov_b32 v187,0
v_mov_b32 v188,0
v_mov_b32 v189,0
v_mov_b32 v190,0
v_mov_b32 v191,0
s_lshl_b32 s77,s63,21
s_lshl_b32 s55,s63,13
s_and_b32 s55,s55,0x2000
s_xor_b32 s55,s55,s61
s_add_u32 s77,s77,s55
v_mov_b32 v176,0
v_mov_b32 v177,0
v_mov_b32 v178,0
v_mov_b32 v179,0
v_mov_b32 v25,1
s_waitcnt vmcnt(0) lgkmcnt(0)
s_barrier
s_branch loop_63
w1_59:
s_lshr_b32 s64,s57,2
s_add_u32 s64,s64,64
s_lshl_b32 s64,s64,14
s_add_u32 s64,s64,s68
s_add_u32 s64,s64,29360128
v_add_u32 v12,s64,v16
v_and_b32 v22,1,v4
v_lshrrev_b32 v23,1,v4
v_lshl_add_u32 v22,v22,1,v23
v_lshlrev_b32 v22,2,v22
v_lshl_add_u32 v22,v3,4,v22
v_add_u32 v31,155648,v22
v_add_u32 v8,s66,v16
v_add_u32 v9,s67,v16
v_mov_b32 v10,1792
v_mov_b32 v11,0
s_branch first_123
loop_124:
s_barrier
buffer_load_dword v248,v18,s[20:23],s70 offen offset:0 sc1
s_nop 15
s_nop 5
hl_126:
buffer_load_dword v249,v18,s[20:23],s70 offen offset:0 sc1
s_waitcnt vmcnt(1)
v_cmp_eq_u32 vcc,v25,v248
s_bcnt1_i32_b32 s64,vcc_lo
s_cmp_ge_u32 s64,8
s_cbranch_scc1 hg_127
buffer_load_dword v248,v18,s[20:23],s70 offen offset:0 sc1
s_waitcnt vmcnt(1)
v_cmp_eq_u32 vcc,v25,v249
s_bcnt1_i32_b32 s64,vcc_lo
s_cmp_ge_u32 s64,8
s_cbranch_scc1 hg_127
s_sub_u32 s90,s90,1
s_cmp_gt_i32 s90,0
s_cbranch_scc1 hl_126
hg_127:
buffer_load_dwordx4 v[48:51],v27,s[20:23],s70 offen offset:0 sc1
buffer_load_dwordx4 v[52:55],v27,s[20:23],s70 offen offset:1024 sc1
buffer_load_dwordx4 v[56:59],v27,s[20:23],s70 offen offset:2048 sc1
buffer_load_dwordx4 v[60:63],v27,s[20:23],s70 offen offset:3072 sc1
s_waitcnt vmcnt(3)
ds_write_b128 v24,v[48:51] offset:4096
v_min3_u32 v22,v48,v49,v50
v_min_u32 v22,v22,v51
s_waitcnt vmcnt(2)
ds_write_b128 v24,v[52:55] offset:5120
v_min3_u32 v22,v22,v52,v53
v_min3_u32 v22,v22,v54,v55
s_waitcnt vmcnt(1)
ds_write_b128 v24,v[56:59] offset:6144
v_min3_u32 v22,v22,v56,v57
v_min3_u32 v22,v22,v58,v59
s_waitcnt vmcnt(0)
ds_write_b128 v24,v[60:63] offset:7168
v_min3_u32 v22,v22,v60,v61
v_min3_u32 v22,v22,v62,v63
v_cmp_eq_u32 vcc,0,v22
s_cbranch_vccnz art_128
abk_129:
v_smfmac_f32_16x16x64_bf16 v[176:179],v[48:51],a[32:39],v14
s_waitcnt lgkmcnt(0)
s_barrier
ds_read_b128 v[64:67],v24 offset:8192
ds_read_b128 v[68:71],v24 offset:9216
ds_read_b128 v[72:75],v24 offset:10240
ds_read_b128 v[76:79],v24 offset:11264
buffer_store_dwordx4 v[212:215],v12,s[20:23],s76 offen sc1
v_smfmac_f32_16x16x64_bf16 v[176:179],v[52:55],a[40:47],v14
ds_read_b128 v[80:83],v24 offset:12288
ds_read_b128 v[84:87],v24 offset:13312
v_smfmac_f32_16x16x64_bf16 v[176:179],v[56:59],a[48:55],v14
ds_read_b128 v[88:91],v24 offset:14336
ds_read_b128 v[92:95],v24 offset:15360
v_smfmac_f32_16x16x64_bf16 v[176:179],v[60:63],a[56:63],v14
ds_read_b128 v[32:35],v24 offset:0
ds_read_b128 v[36:39],v24 offset:1024
s_waitcnt lgkmcnt(9)
v_smfmac_f32_16x16x64_bf16 v[176:179],v[64:67],a[64:71],v14
ds_read_b128 v[40:43],v24 offset:2048
s_waitcnt lgkmcnt(9)
v_smfmac_f32_16x16x64_bf16 v[176:179],v[68:71],a[72:79],v14
ds_read_b128 v[44:47],v24 offset:3072
s_waitcnt lgkmcnt(9)
v_smfmac_f32_16x16x64_bf16 v[176:179],v[72:75],a[80:87],v14
s_waitcnt lgkmcnt(8)
v_smfmac_f32_16x16x64_bf16 v[176:179],v[76:79],a[88:95],v14
s_waitcnt lgkmcnt(7)
v_smfmac_f32_16x16x64_bf16 v[176:179],v[80:83],a[96:103],v14
s_waitcnt lgkmcnt(6)
v_smfmac_f32_16x16x64_bf16 v[176:179],v[84:87],a[104:111],v14
s_waitcnt lgkmcnt(5)
v_smfmac_f32_16x16x64_bf16 v[176:179],v[88:91],a[112:119],v14
s_waitcnt lgkmcnt(4)
v_smfmac_f32_16x16x64_bf16 v[176:179],v[92:95],a[120:127],v14
s_waitcnt lgkmcnt(3)
v_smfmac_f32_16x16x64_bf16 v[176:179],v[32:35],a[0:7],v14
s_waitcnt lgkmcnt(2)
v_smfmac_f32_16x16x64_bf16 v[176:179],v[36:39],a[8:15],v14
s_waitcnt lgkmcnt(1)
v_smfmac_f32_16x16x64_bf16 v[176:179],v[40:43],a[16:23],v14
s_waitcnt lgkmcnt(0)
v_smfmac_f32_16x16x64_bf16 v[176:179],v[44:47],a[24:31],v14
v_smfmac_f32_16x16x64_bf16 v[180:183],v[32:35],a[128:135],v14
v_smfmac_f32_16x16x64_bf16 v[180:183],v[36:39],a[136:143],v14
s_nop 5
v_permlane32_swap_b32 v176,v178
v_permlane32_swap_b32 v177,v179
v_add_f32 v176,v176,v178
v_add_f32 v177,v177,v179
v_cvt_pk_bf16_f32 v216,v176,v177
s_nop 1
v_mov_b32_dpp v217,v216 quad_perm:[1,0,3,2] row_mask:0xf bank_mask:0xf
v_perm_b32 v216,v217,v216,v15
v_max_u32 v216,1,v216
buffer_store_dword v216,v19,s[24:27],s70 offen
buffer_store_dword v216,v19,s[28:31],s70 offen sc1
v_smfmac_f32_16x16x64_bf16 v[180:183],v[40:43],a[144:151],v14
v_smfmac_f32_16x16x64_bf16 v[180:183],v[44:47],a[152:159],v14
v_smfmac_f32_16x16x64_bf16 v[180:183],v[48:51],a[160:167],v14
v_smfmac_f32_16x16x64_bf16 v[180:183],v[52:55],a[168:175],v14
v_smfmac_f32_16x16x64_bf16 v[180:183],v[56:59],a[176:183],v14
v_smfmac_f32_16x16x64_bf16 v[180:183],v[60:63],a[184:191],v14
v_smfmac_f32_16x16x64_bf16 v[180:183],v[64:67],a[192:199],v14
v_smfmac_f32_16x16x64_bf16 v[180:183],v[68:71],a[200:207],v14
v_smfmac_f32_16x16x64_bf16 v[180:183],v[72:75],a[208:215],v14
v_smfmac_f32_16x16x64_bf16 v[180:183],v[76:79],a[216:223],v14
v_smfmac_f32_16x16x64_bf16 v[180:183],v[80:83],a[224:231],v14
v_smfmac_f32_16x16x64_bf16 v[180:183],v[84:87],a[232:239],v14
v_smfmac_f32_16x16x64_bf16 v[180:183],v[88:91],a[240:247],v14
v_smfmac_f32_16x16x64_bf16 v[180:183],v[92:95],a[248:255],v14
s_nop 7
v_permlane32_swap_b32 v180,v182
v_permlane32_swap_b32 v181,v183
v_add_f32 v180,v180,v182
v_add_f32 v181,v181,v183
v_cvt_pk_bf16_f32 v216,v180,v181
v_max_u32 v216,1,v216
ds_write_b32 v31,v216
ds_write_b32 v21,v25 offset:0
s_cmp_eq_u32 s79,63
s_cbranch_scc1 end_57
s_cmp_ge_i32 s79,62
s_cbranch_scc1 bgsk_131
ds_read_b128 v[64:67],v20 offset:0
ds_read_b128 v[68:71],v20 offset:1024
ds_read_b128 v[72:75],v20 offset:2048
s_waitcnt lgkmcnt(2)
v_mfma_f32_16x16x32_bf16 v[192:195],a[0:3],v[64:67],0
ds_read_b128 v[76:79],v20 offset:3072
v_mfma_f32_16x16x32_bf16 v[200:203],v[64:67],a[128:131],0
s_waitcnt lgkmcnt(2)
v_mfma_f32_16x16x32_bf16 v[196:199],a[0:3],v[68:71],0
ds_read_b128 v[64:67],v20 offset:4096
v_mfma_f32_16x16x32_bf16 v[204:207],v[68:71],a[128:131],0
s_waitcnt lgkmcnt(2)
v_mfma_f32_16x16x32_bf16 v[192:195],a[4:7],v[72:75],v[192:195]
ds_read_b128 v[68:71],v20 offset:5120
v_mfma_f32_16x16x32_bf16 v[200:203],v[72:75],a[132:135],v[200:203]
s_waitcnt lgkmcnt(2)
v_mfma_f32_16x16x32_bf16 v[196:199],a[4:7],v[76:79],v[196:199]
ds_read_b128 v[72:75],v20 offset:6144
v_mfma_f32_16x16x32_bf16 v[204:207],v[76:79],a[132:135],v[204:207]
s_waitcnt lgkmcnt(2)
v_mfma_f32_16x16x32_bf16 v[192:195],a[8:11],v[64:67],v[192:195]
ds_read_b128 v[76:79],v20 offset:7168
v_mfma_f32_16x16x32_bf16 v[200:203],v[64:67],a[136:139],v[200:203]
s_waitcnt lgkmcnt(2)
v_mfma_f32_16x16x32_bf16 v[196:199],a[8:11],v[68:71],v[196:199]
ds_read_b128 v[64:67],v20 offset:8192
v_mfma_f32_16x16x32_bf16 v[204:207],v[68:71],a[136:139],v[204:207]
s_waitcnt lgkmcnt(2)
v_mfma_f32_16x16x32_bf16 v[192:195],a[12:15],v[72:75],v[192:195]
ds_read_b128 v[68:71],v20 offset:9216
v_mfma_f32_16x16x32_bf16 v[200:203],v[72:75],a[140:143],v[200:203]
s_waitcnt lgkmcnt(2)
v_mfma_f32_16x16x32_bf16 v[196:199],a[12:15],v[76:79],v[196:199]
ds_read_b128 v[72:75],v20 offset:10240
v_mfma_f32_16x16x32_bf16 v[204:207],v[76:79],a[140:143],v[204:207]
s_add_u32 m0,s62,0
s_add_u32 s69,s78,0
s_waitcnt lgkmcnt(2)
v_mfma_f32_16x16x32_bf16 v[192:195],a[16:19],v[64:67],v[192:195]
ds_read_b128 v[76:79],v20 offset:11264
v_mfma_f32_16x16x32_bf16 v[200:203],v[64:67],a[144:147],v[200:203]
buffer_load_dwordx4 v16,s[20:23],s69 offen offset:0 lds
s_waitcnt lgkmcnt(2)
v_mfma_f32_16x16x32_bf16 v[196:199],a[16:19],v[68:71],v[196:199]
ds_read_b128 v[64:67],v20 offset:12288
v_mfma_f32_16x16x32_bf16 v[204:207],v[68:71],a[144:147],v[204:207]
buffer_load_dwordx4 v16,s[20:23],s69 offen offset:1024 lds
s_waitcnt lgkmcnt(2)
v_mfma_f32_16x16x32_bf16 v[192:195],a[20:23],v[72:75],v[192:195]
ds_read_b128 v[68:71],v20 offset:13312
v_mfma_f32_16x16x32_bf16 v[200:203],v[72:75],a[148:151],v[200:203]
buffer_load_dwordx4 v16,s[20:23],s69 offen offset:2048 lds
s_waitcnt lgkmcnt(2)
v_mfma_f32_16x16x32_bf16 v[196:199],a[20:23],v[76:79],v[196:199]
ds_read_b128 v[72:75],v20 offset:14336
v_mfma_f32_16x16x32_bf16 v[204:207],v[76:79],a[148:151],v[204:207]
buffer_load_dwordx4 v16,s[20:23],s69 offen offset:3072 lds
s_waitcnt lgkmcnt(2)
v_mfma_f32_16x16x32_bf16 v[192:195],a[24:27],v[64:67],v[192:195]
ds_read_b128 v[76:79],v20 offset:15360
v_mfma_f32_16x16x32_bf16 v[200:203],v[64:67],a[152:155],v[200:203]
s_add_u32 m0,s62,4096
s_add_u32 s69,s78,4096
s_waitcnt lgkmcnt(2)
v_mfma_f32_16x16x32_bf16 v[196:199],a[24:27],v[68:71],v[196:199]
ds_read_b128 v[64:67],v20 offset:16384
v_mfma_f32_16x16x32_bf16 v[204:207],v[68:71],a[152:155],v[204:207]
buffer_load_dwordx4 v16,s[20:23],s69 offen offset:0 lds
s_waitcnt lgkmcnt(2)
v_mfma_f32_16x16x32_bf16 v[192:195],a[28:31],v[72:75],v[192:195]
ds_read_b128 v[68:71],v20 offset:17408
v_mfma_f32_16x16x32_bf16 v[200:203],v[72:75],a[156:159],v[200:203]
buffer_load_dwordx4 v16,s[20:23],s69 offen offset:1024 lds
s_waitcnt lgkmcnt(2)
v_mfma_f32_16x16x32_bf16 v[196:199],a[28:31],v[76:79],v[196:199]
ds_read_b128 v[72:75],v20 offset:18432
v_mfma_f32_16x16x32_bf16 v[204:207],v[76:79],a[156:159],v[204:207]
buffer_load_dwordx4 v16,s[20:23],s69 offen offset:2048 lds
s_waitcnt lgkmcnt(2)
v_mfma_f32_16x16x32_bf16 v[192:195],a[32:35],v[64:67],v[192:195]
ds_read_b128 v[76:79],v20 offset:19456
v_mfma_f32_16x16x32_bf16 v[200:203],v[64:67],a[160:163],v[200:203]
buffer_load_dwordx4 v16,s[20:23],s69 offen offset:3072 lds
s_waitcnt lgkmcnt(2)
v_mfma_f32_16x16x32_bf16 v[196:199],a[32:35],v[68:71],v[196:199]
ds_read_b128 v[64:67],v20 offset:20480
v_mfma_f32_16x16x32_bf16 v[204:207],v[68:71],a[160:163],v[204:207]
s_add_u32 m0,s62,8192
s_add_u32 s69,s78,8192
s_waitcnt lgkmcnt(2)
v_mfma_f32_16x16x32_bf16 v[192:195],a[36:39],v[72:75],v[192:195]
ds_read_b128 v[68:71],v20 offset:21504
v_mfma_f32_16x16x32_bf16 v[200:203],v[72:75],a[164:167],v[200:203]
buffer_load_dwordx4 v16,s[20:23],s69 offen offset:0 lds
s_waitcnt lgkmcnt(2)
v_mfma_f32_16x16x32_bf16 v[196:199],a[36:39],v[76:79],v[196:199]
ds_read_b128 v[72:75],v20 offset:22528
v_mfma_f32_16x16x32_bf16 v[204:207],v[76:79],a[164:167],v[204:207]
buffer_load_dwordx4 v16,s[20:23],s69 offen offset:1024 lds
s_waitcnt lgkmcnt(2)
v_mfma_f32_16x16x32_bf16 v[192:195],a[40:43],v[64:67],v[192:195]
ds_read_b128 v[76:79],v20 offset:23552
v_mfma_f32_16x16x32_bf16 v[200:203],v[64:67],a[168:171],v[200:203]
buffer_load_dwordx4 v16,s[20:23],s69 offen offset:2048 lds
s_waitcnt lgkmcnt(2)
v_mfma_f32_16x16x32_bf16 v[196:199],a[40:43],v[68:71],v[196:199]
ds_read_b128 v[64:67],v20 offset:24576
v_mfma_f32_16x16x32_bf16 v[204:207],v[68:71],a[168:171],v[204:207]
buffer_load_dwordx4 v16,s[20:23],s69 offen offset:3072 lds
s_waitcnt lgkmcnt(2)
v_mfma_f32_16x16x32_bf16 v[192:195],a[44:47],v[72:75],v[192:195]
ds_read_b128 v[68:71],v20 offset:25600
v_mfma_f32_16x16x32_bf16 v[200:203],v[72:75],a[172:175],v[200:203]
s_add_u32 m0,s62,12288
s_add_u32 s69,s78,12288
s_waitcnt lgkmcnt(2)
v_mfma_f32_16x16x32_bf16 v[196:199],a[44:47],v[76:79],v[196:199]
ds_read_b128 v[72:75],v20 offset:26624
v_mfma_f32_16x16x32_bf16 v[204:207],v[76:79],a[172:175],v[204:207]
buffer_load_dwordx4 v16,s[20:23],s69 offen offset:0 lds
s_waitcnt lgkmcnt(2)
v_mfma_f32_16x16x32_bf16 v[192:195],a[48:51],v[64:67],v[192:195]
ds_read_b128 v[76:79],v20 offset:27648
v_mfma_f32_16x16x32_bf16 v[200:203],v[64:67],a[176:179],v[200:203]
buffer_load_dwordx4 v16,s[20:23],s69 offen offset:1024 lds
s_waitcnt lgkmcnt(2)
v_mfma_f32_16x16x32_bf16 v[196:199],a[48:51],v[68:71],v[196:199]
ds_read_b128 v[64:67],v20 offset:28672
v_mfma_f32_16x16x32_bf16 v[204:207],v[68:71],a[176:179],v[204:207]
buffer_load_dwordx4 v16,s[20:23],s69 offen offset:2048 lds
s_waitcnt lgkmcnt(2)
v_mfma_f32_16x16x32_bf16 v[192:195],a[52:55],v[72:75],v[192:195]
ds_read_b128 v[68:71],v20 offset:29696
v_mfma_f32_16x16x32_bf16 v[200:203],v[72:75],a[180:183],v[200:203]
buffer_load_dwordx4 v16,s[20:23],s69 offen offset:3072 lds
s_waitcnt lgkmcnt(2)
v_mfma_f32_16x16x32_bf16 v[196:199],a[52:55],v[76:79],v[196:199]
ds_read_b128 v[72:75],v20 offset:30720
v_mfma_f32_16x16x32_bf16 v[204:207],v[76:79],a[180:183],v[204:207]
s_waitcnt lgkmcnt(2)
v_mfma_f32_16x16x32_bf16 v[192:195],a[56:59],v[64:67],v[192:195]
ds_read_b128 v[76:79],v20 offset:31744
v_mfma_f32_16x16x32_bf16 v[200:203],v[64:67],a[184:187],v[200:203]
s_waitcnt lgkmcnt(2)
v_mfma_f32_16x16x32_bf16 v[196:199],a[56:59],v[68:71],v[196:199]
ds_read_b128 v[64:67],v20 offset:32768
v_mfma_f32_16x16x32_bf16 v[204:207],v[68:71],a[184:187],v[204:207]
s_waitcnt lgkmcnt(2)
v_mfma_f32_16x16x32_bf16 v[192:195],a[60:63],v[72:75],v[192:195]
ds_read_b128 v[68:71],v20 offset:33792
v_mfma_f32_16x16x32_bf16 v[200:203],v[72:75],a[188:191],v[200:203]
s_waitcnt lgkmcnt(2)
v_mfma_f32_16x16x32_bf16 v[196:199],a[60:63],v[76:79],v[196:199]
ds_read_b128 v[72:75],v20 offset:34816
v_mfma_f32_16x16x32_bf16 v[204:207],v[76:79],a[188:191],v[204:207]
s_waitcnt lgkmcnt(2)
v_mfma_f32_16x16x32_bf16 v[192:195],a[64:67],v[64:67],v[192:195]
ds_read_b128 v[76:79],v20 offset:35840
v_mfma_f32_16x16x32_bf16 v[200:203],v[64:67],a[192:195],v[200:203]
s_waitcnt lgkmcnt(2)
v_mfma_f32_16x16x32_bf16 v[196:199],a[64:67],v[68:71],v[196:199]
ds_read_b128 v[64:67],v20 offset:36864
v_mfma_f32_16x16x32_bf16 v[204:207],v[68:71],a[192:195],v[204:207]
s_waitcnt lgkmcnt(2)
v_mfma_f32_16x16x32_bf16 v[192:195],a[68:71],v[72:75],v[192:195]
ds_read_b128 v[68:71],v20 offset:37888
v_mfma_f32_16x16x32_bf16 v[200:203],v[72:75],a[196:199],v[200:203]
s_waitcnt lgkmcnt(2)
v_mfma_f32_16x16x32_bf16 v[196:199],a[68:71],v[76:79],v[196:199]
ds_read_b128 v[72:75],v20 offset:38912
v_mfma_f32_16x16x32_bf16 v[204:207],v[76:79],a[196:199],v[204:207]
s_waitcnt lgkmcnt(2)
v_mfma_f32_16x16x32_bf16 v[192:195],a[72:75],v[64:67],v[192:195]
ds_read_b128 v[76:79],v20 offset:39936
v_mfma_f32_16x16x32_bf16 v[200:203],v[64:67],a[200:203],v[200:203]
s_waitcnt lgkmcnt(2)
v_mfma_f32_16x16x32_bf16 v[196:199],a[72:75],v[68:71],v[196:199]
ds_read_b128 v[64:67],v20 offset:40960
v_mfma_f32_16x16x32_bf16 v[204:207],v[68:71],a[200:203],v[204:207]
s_waitcnt lgkmcnt(2)
v_mfma_f32_16x16x32_bf16 v[192:195],a[76:79],v[72:75],v[192:195]
ds_read_b128 v[68:71],v20 offset:41984
v_mfma_f32_16x16x32_bf16 v[200:203],v[72:75],a[204:207],v[200:203]
s_waitcnt lgkmcnt(2)
v_mfma_f32_16x16x32_bf16 v[196:199],a[76:79],v[76:79],v[196:199]
ds_read_b128 v[72:75],v20 offset:43008
v_mfma_f32_16x16x32_bf16 v[204:207],v[76:79],a[204:207],v[204:207]
s_waitcnt lgkmcnt(2)
v_mfma_f32_16x16x32_bf16 v[192:195],a[80:83],v[64:67],v[192:195]
ds_read_b128 v[76:79],v20 offset:44032
v_mfma_f32_16x16x32_bf16 v[200:203],v[64:67],a[208:211],v[200:203]
s_waitcnt lgkmcnt(2)
v_mfma_f32_16x16x32_bf16 v[196:199],a[80:83],v[68:71],v[196:199]
ds_read_b128 v[64:67],v20 offset:45056
v_mfma_f32_16x16x32_bf16 v[204:207],v[68:71],a[208:211],v[204:207]
s_waitcnt lgkmcnt(2)
v_mfma_f32_16x16x32_bf16 v[192:195],a[84:87],v[72:75],v[192:195]
ds_read_b128 v[68:71],v20 offset:46080
v_mfma_f32_16x16x32_bf16 v[200:203],v[72:75],a[212:215],v[200:203]
s_waitcnt lgkmcnt(2)
v_mfma_f32_16x16x32_bf16 v[196:199],a[84:87],v[76:79],v[196:199]
ds_read_b128 v[72:75],v20 offset:47104
v_mfma_f32_16x16x32_bf16 v[204:207],v[76:79],a[212:215],v[204:207]
s_waitcnt lgkmcnt(2)
v_mfma_f32_16x16x32_bf16 v[192:195],a[88:91],v[64:67],v[192:195]
ds_read_b128 v[76:79],v20 offset:48128
v_mfma_f32_16x16x32_bf16 v[200:203],v[64:67],a[216:219],v[200:203]
s_waitcnt lgkmcnt(2)
v_mfma_f32_16x16x32_bf16 v[196:199],a[88:91],v[68:71],v[196:199]
ds_read_b128 v[64:67],v20 offset:49152
v_mfma_f32_16x16x32_bf16 v[204:207],v[68:71],a[216:219],v[204:207]
s_waitcnt lgkmcnt(2)
v_mfma_f32_16x16x32_bf16 v[192:195],a[92:95],v[72:75],v[192:195]
ds_read_b128 v[68:71],v20 offset:50176
v_mfma_f32_16x16x32_bf16 v[200:203],v[72:75],a[220:223],v[200:203]
s_waitcnt lgkmcnt(2)
v_mfma_f32_16x16x32_bf16 v[196:199],a[92:95],v[76:79],v[196:199]
ds_read_b128 v[72:75],v20 offset:51200
v_mfma_f32_16x16x32_bf16 v[204:207],v[76:79],a[220:223],v[204:207]
s_waitcnt lgkmcnt(2)
v_mfma_f32_16x16x32_bf16 v[192:195],a[96:99],v[64:67],v[192:195]
ds_read_b128 v[76:79],v20 offset:52224
v_mfma_f32_16x16x32_bf16 v[200:203],v[64:67],a[224:227],v[200:203]
s_waitcnt lgkmcnt(2)
v_mfma_f32_16x16x32_bf16 v[196:199],a[96:99],v[68:71],v[196:199]
ds_read_b128 v[64:67],v20 offset:53248
v_mfma_f32_16x16x32_bf16 v[204:207],v[68:71],a[224:227],v[204:207]
s_waitcnt lgkmcnt(2)
v_mfma_f32_16x16x32_bf16 v[192:195],a[100:103],v[72:75],v[192:195]
ds_read_b128 v[68:71],v20 offset:54272
s_add_u32 m0,s62,32768
s_add_u32 s69,s78,32768
v_mfma_f32_16x16x32_bf16 v[200:203],v[72:75],a[228:231],v[200:203]
s_waitcnt lgkmcnt(2)
v_mfma_f32_16x16x32_bf16 v[196:199],a[100:103],v[76:79],v[196:199]
ds_read_b128 v[72:75],v20 offset:55296
buffer_load_dwordx4 v16,s[20:23],s69 offen offset:0 lds
v_mfma_f32_16x16x32_bf16 v[204:207],v[76:79],a[228:231],v[204:207]
s_waitcnt lgkmcnt(2)
v_mfma_f32_16x16x32_bf16 v[192:195],a[104:107],v[64:67],v[192:195]
ds_read_b128 v[76:79],v20 offset:56320
buffer_load_dwordx4 v16,s[20:23],s69 offen offset:1024 lds
v_mfma_f32_16x16x32_bf16 v[200:203],v[64:67],a[232:235],v[200:203]
s_waitcnt lgkmcnt(2)
v_mfma_f32_16x16x32_bf16 v[196:199],a[104:107],v[68:71],v[196:199]
ds_read_b128 v[64:67],v20 offset:57344
buffer_load_dwordx4 v16,s[20:23],s69 offen offset:2048 lds
v_mfma_f32_16x16x32_bf16 v[204:207],v[68:71],a[232:235],v[204:207]
s_waitcnt lgkmcnt(2)
v_mfma_f32_16x16x32_bf16 v[192:195],a[108:111],v[72:75],v[192:195]
ds_read_b128 v[68:71],v20 offset:58368
buffer_load_dwordx4 v16,s[20:23],s69 offen offset:3072 lds
v_mfma_f32_16x16x32_bf16 v[200:203],v[72:75],a[236:239],v[200:203]
s_waitcnt lgkmcnt(2)
v_mfma_f32_16x16x32_bf16 v[196:199],a[108:111],v[76:79],v[196:199]
ds_read_b128 v[72:75],v20 offset:59392
s_add_u32 m0,s62,36864
s_add_u32 s69,s78,36864
v_mfma_f32_16x16x32_bf16 v[204:207],v[76:79],a[236:239],v[204:207]
s_waitcnt lgkmcnt(2)
v_mfma_f32_16x16x32_bf16 v[192:195],a[112:115],v[64:67],v[192:195]
ds_read_b128 v[76:79],v20 offset:60416
buffer_load_dwordx4 v16,s[20:23],s69 offen offset:0 lds
v_mfma_f32_16x16x32_bf16 v[200:203],v[64:67],a[240:243],v[200:203]
s_waitcnt lgkmcnt(2)
v_mfma_f32_16x16x32_bf16 v[196:199],a[112:115],v[68:71],v[196:199]
ds_read_b128 v[64:67],v20 offset:61440
v_mfma_f32_16x16x32_bf16 v[204:207],v[68:71],a[240:243],v[204:207]
buffer_load_dwordx4 v16,s[20:23],s69 offen offset:1024 lds
s_waitcnt lgkmcnt(2)
v_mfma_f32_16x16x32_bf16 v[192:195],a[116:119],v[72:75],v[192:195]
ds_read_b128 v[68:71],v20 offset:62464
v_mfma_f32_16x16x32_bf16 v[200:203],v[72:75],a[244:247],v[200:203]
buffer_load_dwordx4 v16,s[20:23],s69 offen offset:2048 lds
s_waitcnt lgkmcnt(2)
v_mfma_f32_16x16x32_bf16 v[196:199],a[116:119],v[76:79],v[196:199]
ds_read_b128 v[72:75],v20 offset:63488
v_mfma_f32_16x16x32_bf16 v[204:207],v[76:79],a[244:247],v[204:207]
buffer_load_dwordx4 v16,s[20:23],s69 offen offset:3072 lds
s_waitcnt lgkmcnt(2)
v_mfma_f32_16x16x32_bf16 v[192:195],a[120:123],v[64:67],v[192:195]
ds_read_b128 v[76:79],v20 offset:64512
v_mfma_f32_16x16x32_bf16 v[200:203],v[64:67],a[248:251],v[200:203]
s_add_u32 m0,s62,40960
s_add_u32 s69,s78,40960
s_waitcnt lgkmcnt(2)
v_mfma_f32_16x16x32_bf16 v[196:199],a[120:123],v[68:71],v[196:199]
v_mfma_f32_16x16x32_bf16 v[204:207],v[68:71],a[248:251],v[204:207]
buffer_load_dwordx4 v16,s[20:23],s69 offen offset:0 lds
s_waitcnt lgkmcnt(1)
v_mfma_f32_16x16x32_bf16 v[192:195],a[124:127],v[72:75],v[192:195]
v_mfma_f32_16x16x32_bf16 v[200:203],v[72:75],a[252:255],v[200:203]
buffer_load_dwordx4 v16,s[20:23],s69 offen offset:1024 lds
s_waitcnt lgkmcnt(0)
v_mfma_f32_16x16x32_bf16 v[196:199],a[124:127],v[76:79],v[196:199]
v_mfma_f32_16x16x32_bf16 v[204:207],v[76:79],a[252:255],v[204:207]
s_waitcnt vmcnt(26)
ds_write_b32 v21,v25 offset:24
v_xor_b32 v20,0x10000,v20
s_xor_b32 s62,s62,0x10000
s_lshr_b32 s64,s73,9
v_add_u32 v22,s64,v24
v_cvt_pk_bf16_f32 v208,v192,v193
v_cvt_pk_bf16_f32 v209,v194,v195
v_cvt_pk_bf16_f32 v210,v196,v197
v_cvt_pk_bf16_f32 v211,v198,v199
v_cvt_pk_bf16_f32 v212,v200,v201
v_cvt_pk_bf16_f32 v213,v202,v203
v_cvt_pk_bf16_f32 v214,v204,v205
v_cvt_pk_bf16_f32 v215,v206,v207
v_permlane16_swap_b32 v208,v210
v_permlane16_swap_b32 v209,v211
buffer_store_dwordx4 v[208:211],v2,s[24:27],s73 offen
buffer_store_dwordx4 v[208:211],v2,s[28:31],s73 offen sc1
ds_write_b128 v22,v[212:215] offset:16384
buffer_store_dwordx4 v[208:211],v17,s[20:23],s12 offen sc1
bgx_130:
buffer_store_dwordx4 v[100:103],v9,s[24:27],s73 offen
buffer_store_dwordx4 v[100:103],v9,s[28:31],s73 offen sc1
s_mov_b32 exec_hi,0
buffer_store_dwordx4 v[100:103],v8,s[24:27],s73 offen
buffer_store_dwordx4 v[100:103],v8,s[24:27],s71 offen
buffer_store_dwordx4 v[100:103],v8,s[28:31],s73 offen sc1
buffer_store_dwordx4 v[100:103],v8,s[28:31],s71 offen sc1
s_mov_b64 exec,-1
s_waitcnt lgkmcnt(0)
s_add_u32 s63,s79,1
s_and_b32 s64,s63,3
s_lshl_b32 s70,s64,20
s_add_u32 s65,s63,2
s_and_b32 s65,s65,3
s_lshl_b32 s73,s65,20
s_add_u32 s55,s63,3
s_lshl_b32 s78,s55,16
s_add_u32 s78,s78,57344
s_cmp_lt_u32 s55,64
s_cselect_b32 s78,s78,0x7fff0000
s_add_u32 s60,s63,1
s_lshl_b32 s76,s60,21
s_lshl_b32 s55,s60,13
s_and_b32 s55,s55,0x2000
s_xor_b32 s55,s55,s61
s_add_u32 s76,s76,s55
s_cmp_lt_u32 s60,64
s_cselect_b32 s76,s76,0x7fff0000
s_add_u32 s60,s63,2
s_lshl_b32 s12,s60,21
s_lshl_b32 s55,s60,13
s_and_b32 s55,s55,0x2000
s_xor_b32 s55,s55,s61
s_add_u32 s12,s12,s55
s_cmp_lt_u32 s60,64
s_cselect_b32 s12,s12,0x7fff0000
s_add_u32 s71,s73,65536
v_mov_b32 v176,0
v_mov_b32 v177,0
v_mov_b32 v178,0
v_mov_b32 v179,0
v_mov_b32 v180,0
v_mov_b32 v181,0
v_mov_b32 v182,0
v_mov_b32 v183,0
s_add_u32 s79,s79,1
v_add_u32 v25,1,v25
s_waitcnt vmcnt(0)
s_branch loop_124
art_128:
s_sub_u32 s90,s90,1
s_cmp_lt_i32 s90,0
s_cbranch_scc1 abk_129
buffer_load_dwordx4 v[48:51],v27,s[20:23],s70 offen offset:0 sc1
buffer_load_dwordx4 v[52:55],v27,s[20:23],s70 offen offset:1024 sc1
buffer_load_dwordx4 v[56:59],v27,s[20:23],s70 offen offset:2048 sc1
buffer_load_dwordx4 v[60:63],v27,s[20:23],s70 offen offset:3072 sc1
s_waitcnt vmcnt(3)
ds_write_b128 v24,v[48:51] offset:4096
v_min3_u32 v22,v48,v49,v50
v_min_u32 v22,v22,v51
s_waitcnt vmcnt(2)
ds_write_b128 v24,v[52:55] offset:5120
v_min3_u32 v22,v22,v52,v53
v_min3_u32 v22,v22,v54,v55
s_waitcnt vmcnt(1)
ds_write_b128 v24,v[56:59] offset:6144
v_min3_u32 v22,v22,v56,v57
v_min3_u32 v22,v22,v58,v59
s_waitcnt vmcnt(0)
ds_write_b128 v24,v[60:63] offset:7168
v_min3_u32 v22,v22,v60,v61
v_min3_u32 v22,v22,v62,v63
v_cmp_eq_u32 vcc,0,v22
s_cbranch_vccnz art_128
s_branch abk_129
bgsk_131:
s_waitcnt vmcnt(0)
ds_write_b32 v21,v25 offset:24
s_branch bgx_130
first_123:
s_add_u32 s63,s79,0
s_and_b32 s64,s63,3
s_lshl_b32 s70,s64,20
s_add_u32 s65,s63,2
s_and_b32 s65,s65,3
s_lshl_b32 s73,s65,20
s_add_u32 s55,s63,3
s_lshl_b32 s78,s55,16
s_add_u32 s78,s78,57344
s_cmp_lt_u32 s55,64
s_cselect_b32 s78,s78,0x7fff0000
s_add_u32 s60,s63,1
s_lshl_b32 s76,s60,21
s_lshl_b32 s55,s60,13
s_and_b32 s55,s55,0x2000
s_xor_b32 s55,s55,s61
s_add_u32 s76,s76,s55
s_cmp_lt_u32 s60,64
s_cselect_b32 s76,s76,0x7fff0000
s_add_u32 s60,s63,2
s_lshl_b32 s12,s60,21
s_lshl_b32 s55,s60,13
s_and_b32 s55,s55,0x2000
s_xor_b32 s55,s55,s61
s_add_u32 s12,s12,s55
s_cmp_lt_u32 s60,64
s_cselect_b32 s12,s12,0x7fff0000
s_add_u32 s71,s73,65536
v_mov_b32 v176,0
v_mov_b32 v177,0
v_mov_b32 v178,0
v_mov_b32 v179,0
v_mov_b32 v180,0
v_mov_b32 v181,0
v_mov_b32 v182,0
v_mov_b32 v183,0
s_waitcnt vmcnt(0) lgkmcnt(0)
s_barrier
pn1_132:
ds_read_b128 v[64:67],v20 offset:0
ds_read_b128 v[68:71],v20 offset:1024
ds_read_b128 v[72:75],v20 offset:2048
s_waitcnt lgkmcnt(2)
v_mfma_f32_16x16x32_bf16 v[192:195],a[0:3],v[64:67],0
ds_read_b128 v[76:79],v20 offset:3072
v_mfma_f32_16x16x32_bf16 v[200:203],v[64:67],a[128:131],0
s_waitcnt lgkmcnt(2)
v_mfma_f32_16x16x32_bf16 v[196:199],a[0:3],v[68:71],0
ds_read_b128 v[64:67],v20 offset:4096
v_mfma_f32_16x16x32_bf16 v[204:207],v[68:71],a[128:131],0
s_waitcnt lgkmcnt(2)
v_mfma_f32_16x16x32_bf16 v[192:195],a[4:7],v[72:75],v[192:195]
ds_read_b128 v[68:71],v20 offset:5120
v_mfma_f32_16x16x32_bf16 v[200:203],v[72:75],a[132:135],v[200:203]
s_waitcnt lgkmcnt(2)
v_mfma_f32_16x16x32_bf16 v[196:199],a[4:7],v[76:79],v[196:199]
ds_read_b128 v[72:75],v20 offset:6144
v_mfma_f32_16x16x32_bf16 v[204:207],v[76:79],a[132:135],v[204:207]
s_waitcnt lgkmcnt(2)
v_mfma_f32_16x16x32_bf16 v[192:195],a[8:11],v[64:67],v[192:195]
ds_read_b128 v[76:79],v20 offset:7168
v_mfma_f32_16x16x32_bf16 v[200:203],v[64:67],a[136:139],v[200:203]
s_waitcnt lgkmcnt(2)
v_mfma_f32_16x16x32_bf16 v[196:199],a[8:11],v[68:71],v[196:199]
ds_read_b128 v[64:67],v20 offset:8192
v_mfma_f32_16x16x32_bf16 v[204:207],v[68:71],a[136:139],v[204:207]
s_waitcnt lgkmcnt(2)
v_mfma_f32_16x16x32_bf16 v[192:195],a[12:15],v[72:75],v[192:195]
ds_read_b128 v[68:71],v20 offset:9216
v_mfma_f32_16x16x32_bf16 v[200:203],v[72:75],a[140:143],v[200:203]
s_waitcnt lgkmcnt(2)
v_mfma_f32_16x16x32_bf16 v[196:199],a[12:15],v[76:79],v[196:199]
ds_read_b128 v[72:75],v20 offset:10240
v_mfma_f32_16x16x32_bf16 v[204:207],v[76:79],a[140:143],v[204:207]
s_waitcnt lgkmcnt(2)
v_mfma_f32_16x16x32_bf16 v[192:195],a[16:19],v[64:67],v[192:195]
ds_read_b128 v[76:79],v20 offset:11264
v_mfma_f32_16x16x32_bf16 v[200:203],v[64:67],a[144:147],v[200:203]
s_waitcnt lgkmcnt(2)
v_mfma_f32_16x16x32_bf16 v[196:199],a[16:19],v[68:71],v[196:199]
ds_read_b128 v[64:67],v20 offset:12288
v_mfma_f32_16x16x32_bf16 v[204:207],v[68:71],a[144:147],v[204:207]
s_waitcnt lgkmcnt(2)
v_mfma_f32_16x16x32_bf16 v[192:195],a[20:23],v[72:75],v[192:195]
ds_read_b128 v[68:71],v20 offset:13312
v_mfma_f32_16x16x32_bf16 v[200:203],v[72:75],a[148:151],v[200:203]
s_waitcnt lgkmcnt(2)
v_mfma_f32_16x16x32_bf16 v[196:199],a[20:23],v[76:79],v[196:199]
ds_read_b128 v[72:75],v20 offset:14336
v_mfma_f32_16x16x32_bf16 v[204:207],v[76:79],a[148:151],v[204:207]
s_waitcnt lgkmcnt(2)
v_mfma_f32_16x16x32_bf16 v[192:195],a[24:27],v[64:67],v[192:195]
ds_read_b128 v[76:79],v20 offset:15360
v_mfma_f32_16x16x32_bf16 v[200:203],v[64:67],a[152:155],v[200:203]
s_waitcnt lgkmcnt(2)
v_mfma_f32_16x16x32_bf16 v[196:199],a[24:27],v[68:71],v[196:199]
ds_read_b128 v[64:67],v20 offset:16384
v_mfma_f32_16x16x32_bf16 v[204:207],v[68:71],a[152:155],v[204:207]
s_waitcnt lgkmcnt(2)
v_mfma_f32_16x16x32_bf16 v[192:195],a[28:31],v[72:75],v[192:195]
ds_read_b128 v[68:71],v20 offset:17408
v_mfma_f32_16x16x32_bf16 v[200:203],v[72:75],a[156:159],v[200:203]
s_waitcnt lgkmcnt(2)
v_mfma_f32_16x16x32_bf16 v[196:199],a[28:31],v[76:79],v[196:199]
ds_read_b128 v[72:75],v20 offset:18432
v_mfma_f32_16x16x32_bf16 v[204:207],v[76:79],a[156:159],v[204:207]
s_waitcnt lgkmcnt(2)
v_mfma_f32_16x16x32_bf16 v[192:195],a[32:35],v[64:67],v[192:195]
ds_read_b128 v[76:79],v20 offset:19456
v_mfma_f32_16x16x32_bf16 v[200:203],v[64:67],a[160:163],v[200:203]
s_waitcnt lgkmcnt(2)
v_mfma_f32_16x16x32_bf16 v[196:199],a[32:35],v[68:71],v[196:199]
ds_read_b128 v[64:67],v20 offset:20480
v_mfma_f32_16x16x32_bf16 v[204:207],v[68:71],a[160:163],v[204:207]
s_waitcnt lgkmcnt(2)
v_mfma_f32_16x16x32_bf16 v[192:195],a[36:39],v[72:75],v[192:195]
ds_read_b128 v[68:71],v20 offset:21504
v_mfma_f32_16x16x32_bf16 v[200:203],v[72:75],a[164:167],v[200:203]
s_waitcnt lgkmcnt(2)
v_mfma_f32_16x16x32_bf16 v[196:199],a[36:39],v[76:79],v[196:199]
ds_read_b128 v[72:75],v20 offset:22528
v_mfma_f32_16x16x32_bf16 v[204:207],v[76:79],a[164:167],v[204:207]
s_waitcnt lgkmcnt(2)
v_mfma_f32_16x16x32_bf16 v[192:195],a[40:43],v[64:67],v[192:195]
ds_read_b128 v[76:79],v20 offset:23552
v_mfma_f32_16x16x32_bf16 v[200:203],v[64:67],a[168:171],v[200:203]
s_waitcnt lgkmcnt(2)
v_mfma_f32_16x16x32_bf16 v[196:199],a[40:43],v[68:71],v[196:199]
ds_read_b128 v[64:67],v20 offset:24576
v_mfma_f32_16x16x32_bf16 v[204:207],v[68:71],a[168:171],v[204:207]
s_waitcnt lgkmcnt(2)
v_mfma_f32_16x16x32_bf16 v[192:195],a[44:47],v[72:75],v[192:195]
ds_read_b128 v[68:71],v20 offset:25600
v_mfma_f32_16x16x32_bf16 v[200:203],v[72:75],a[172:175],v[200:203]
s_waitcnt lgkmcnt(2)
v_mfma_f32_16x16x32_bf16 v[196:199],a[44:47],v[76:79],v[196:199]
ds_read_b128 v[72:75],v20 offset:26624
v_mfma_f32_16x16x32_bf16 v[204:207],v[76:79],a[172:175],v[204:207]
s_waitcnt lgkmcnt(2)
v_mfma_f32_16x16x32_bf16 v[192:195],a[48:51],v[64:67],v[192:195]
ds_read_b128 v[76:79],v20 offset:27648
v_mfma_f32_16x16x32_bf16 v[200:203],v[64:67],a[176:179],v[200:203]
s_waitcnt lgkmcnt(2)
v_mfma_f32_16x16x32_bf16 v[196:199],a[48:51],v[68:71],v[196:199]
ds_read_b128 v[64:67],v20 offset:28672
v_mfma_f32_16x16x32_bf16 v[204:207],v[68:71],a[176:179],v[204:207]
s_waitcnt lgkmcnt(2)
v_mfma_f32_16x16x32_bf16 v[192:195],a[52:55],v[72:75],v[192:195]
ds_read_b128 v[68:71],v20 offset:29696
v_mfma_f32_16x16x32_bf16 v[200:203],v[72:75],a[180:183],v[200:203]
s_waitcnt lgkmcnt(2)
v_mfma_f32_16x16x32_bf16 v[196:199],a[52:55],v[76:79],v[196:199]
ds_read_b128 v[72:75],v20 offset:30720
v_mfma_f32_16x16x32_bf16 v[204:207],v[76:79],a[180:183],v[204:207]
s_waitcnt lgkmcnt(2)
v_mfma_f32_16x16x32_bf16 v[192:195],a[56:59],v[64:67],v[192:195]
ds_read_b128 v[76:79],v20 offset:31744
v_mfma_f32_16x16x32_bf16 v[200:203],v[64:67],a[184:187],v[200:203]
s_waitcnt lgkmcnt(2)
v_mfma_f32_16x16x32_bf16 v[196:199],a[56:59],v[68:71],v[196:199]
ds_read_b128 v[64:67],v20 offset:32768
v_mfma_f32_16x16x32_bf16 v[204:207],v[68:71],a[184:187],v[204:207]
s_waitcnt lgkmcnt(2)
v_mfma_f32_16x16x32_bf16 v[192:195],a[60:63],v[72:75],v[192:195]
ds_read_b128 v[68:71],v20 offset:33792
v_mfma_f32_16x16x32_bf16 v[200:203],v[72:75],a[188:191],v[200:203]
s_waitcnt lgkmcnt(2)
v_mfma_f32_16x16x32_bf16 v[196:199],a[60:63],v[76:79],v[196:199]
ds_read_b128 v[72:75],v20 offset:34816
v_mfma_f32_16x16x32_bf16 v[204:207],v[76:79],a[188:191],v[204:207]
s_waitcnt lgkmcnt(2)
v_mfma_f32_16x16x32_bf16 v[192:195],a[64:67],v[64:67],v[192:195]
ds_read_b128 v[76:79],v20 offset:35840
v_mfma_f32_16x16x32_bf16 v[200:203],v[64:67],a[192:195],v[200:203]
s_waitcnt lgkmcnt(2)
v_mfma_f32_16x16x32_bf16 v[196:199],a[64:67],v[68:71],v[196:199]
ds_read_b128 v[64:67],v20 offset:36864
v_mfma_f32_16x16x32_bf16 v[204:207],v[68:71],a[192:195],v[204:207]
s_waitcnt lgkmcnt(2)
v_mfma_f32_16x16x32_bf16 v[192:195],a[68:71],v[72:75],v[192:195]
ds_read_b128 v[68:71],v20 offset:37888
v_mfma_f32_16x16x32_bf16 v[200:203],v[72:75],a[196:199],v[200:203]
s_waitcnt lgkmcnt(2)
v_mfma_f32_16x16x32_bf16 v[196:199],a[68:71],v[76:79],v[196:199]
ds_read_b128 v[72:75],v20 offset:38912
v_mfma_f32_16x16x32_bf16 v[204:207],v[76:79],a[196:199],v[204:207]
s_waitcnt lgkmcnt(2)
v_mfma_f32_16x16x32_bf16 v[192:195],a[72:75],v[64:67],v[192:195]
ds_read_b128 v[76:79],v20 offset:39936
v_mfma_f32_16x16x32_bf16 v[200:203],v[64:67],a[200:203],v[200:203]
s_waitcnt lgkmcnt(2)
v_mfma_f32_16x16x32_bf16 v[196:199],a[72:75],v[68:71],v[196:199]
ds_read_b128 v[64:67],v20 offset:40960
v_mfma_f32_16x16x32_bf16 v[204:207],v[68:71],a[200:203],v[204:207]
s_waitcnt lgkmcnt(2)
v_mfma_f32_16x16x32_bf16 v[192:195],a[76:79],v[72:75],v[192:195]
ds_read_b128 v[68:71],v20 offset:41984
v_mfma_f32_16x16x32_bf16 v[200:203],v[72:75],a[204:207],v[200:203]
s_waitcnt lgkmcnt(2)
v_mfma_f32_16x16x32_bf16 v[196:199],a[76:79],v[76:79],v[196:199]
ds_read_b128 v[72:75],v20 offset:43008
v_mfma_f32_16x16x32_bf16 v[204:207],v[76:79],a[204:207],v[204:207]
s_waitcnt lgkmcnt(2)
v_mfma_f32_16x16x32_bf16 v[192:195],a[80:83],v[64:67],v[192:195]
ds_read_b128 v[76:79],v20 offset:44032
v_mfma_f32_16x16x32_bf16 v[200:203],v[64:67],a[208:211],v[200:203]
s_waitcnt lgkmcnt(2)
v_mfma_f32_16x16x32_bf16 v[196:199],a[80:83],v[68:71],v[196:199]
ds_read_b128 v[64:67],v20 offset:45056
v_mfma_f32_16x16x32_bf16 v[204:207],v[68:71],a[208:211],v[204:207]
s_waitcnt lgkmcnt(2)
v_mfma_f32_16x16x32_bf16 v[192:195],a[84:87],v[72:75],v[192:195]
ds_read_b128 v[68:71],v20 offset:46080
v_mfma_f32_16x16x32_bf16 v[200:203],v[72:75],a[212:215],v[200:203]
s_waitcnt lgkmcnt(2)
v_mfma_f32_16x16x32_bf16 v[196:199],a[84:87],v[76:79],v[196:199]
ds_read_b128 v[72:75],v20 offset:47104
v_mfma_f32_16x16x32_bf16 v[204:207],v[76:79],a[212:215],v[204:207]
s_waitcnt lgkmcnt(2)
v_mfma_f32_16x16x32_bf16 v[192:195],a[88:91],v[64:67],v[192:195]
ds_read_b128 v[76:79],v20 offset:48128
v_mfma_f32_16x16x32_bf16 v[200:203],v[64:67],a[216:219],v[200:203]
s_waitcnt lgkmcnt(2)
v_mfma_f32_16x16x32_bf16 v[196:199],a[88:91],v[68:71],v[196:199]
ds_read_b128 v[64:67],v20 offset:49152
v_mfma_f32_16x16x32_bf16 v[204:207],v[68:71],a[216:219],v[204:207]
s_waitcnt lgkmcnt(2)
v_mfma_f32_16x16x32_bf16 v[192:195],a[92:95],v[72:75],v[192:195]
ds_read_b128 v[68:71],v20 offset:50176
v_mfma_f32_16x16x32_bf16 v[200:203],v[72:75],a[220:223],v[200:203]
s_waitcnt lgkmcnt(2)
v_mfma_f32_16x16x32_bf16 v[196:199],a[92:95],v[76:79],v[196:199]
ds_read_b128 v[72:75],v20 offset:51200
v_mfma_f32_16x16x32_bf16 v[204:207],v[76:79],a[220:223],v[204:207]
s_waitcnt lgkmcnt(2)
v_mfma_f32_16x16x32_bf16 v[192:195],a[96:99],v[64:67],v[192:195]
ds_read_b128 v[76:79],v20 offset:52224
v_mfma_f32_16x16x32_bf16 v[200:203],v[64:67],a[224:227],v[200:203]
s_waitcnt lgkmcnt(2)
v_mfma_f32_16x16x32_bf16 v[196:199],a[96:99],v[68:71],v[196:199]
ds_read_b128 v[64:67],v20 offset:53248
v_mfma_f32_16x16x32_bf16 v[204:207],v[68:71],a[224:227],v[204:207]
s_waitcnt lgkmcnt(2)
v_mfma_f32_16x16x32_bf16 v[192:195],a[100:103],v[72:75],v[192:195]
ds_read_b128 v[68:71],v20 offset:54272
v_mfma_f32_16x16x32_bf16 v[200:203],v[72:75],a[228:231],v[200:203]
s_waitcnt lgkmcnt(2)
v_mfma_f32_16x16x32_bf16 v[196:199],a[100:103],v[76:79],v[196:199]
ds_read_b128 v[72:75],v20 offset:55296
v_mfma_f32_16x16x32_bf16 v[204:207],v[76:79],a[228:231],v[204:207]
s_waitcnt lgkmcnt(2)
v_mfma_f32_16x16x32_bf16 v[192:195],a[104:107],v[64:67],v[192:195]
ds_read_b128 v[76:79],v20 offset:56320
v_mfma_f32_16x16x32_bf16 v[200:203],v[64:67],a[232:235],v[200:203]
s_waitcnt lgkmcnt(2)
v_mfma_f32_16x16x32_bf16 v[196:199],a[104:107],v[68:71],v[196:199]
ds_read_b128 v[64:67],v20 offset:57344
v_mfma_f32_16x16x32_bf16 v[204:207],v[68:71],a[232:235],v[204:207]
s_waitcnt lgkmcnt(2)
v_mfma_f32_16x16x32_bf16 v[192:195],a[108:111],v[72:75],v[192:195]
ds_read_b128 v[68:71],v20 offset:58368
v_mfma_f32_16x16x32_bf16 v[200:203],v[72:75],a[236:239],v[200:203]
s_waitcnt lgkmcnt(2)
v_mfma_f32_16x16x32_bf16 v[196:199],a[108:111],v[76:79],v[196:199]
ds_read_b128 v[72:75],v20 offset:59392
v_mfma_f32_16x16x32_bf16 v[204:207],v[76:79],a[236:239],v[204:207]
s_waitcnt lgkmcnt(2)
v_mfma_f32_16x16x32_bf16 v[192:195],a[112:115],v[64:67],v[192:195]
ds_read_b128 v[76:79],v20 offset:60416
v_mfma_f32_16x16x32_bf16 v[200:203],v[64:67],a[240:243],v[200:203]
s_waitcnt lgkmcnt(2)
v_mfma_f32_16x16x32_bf16 v[196:199],a[112:115],v[68:71],v[196:199]
ds_read_b128 v[64:67],v20 offset:61440
v_mfma_f32_16x16x32_bf16 v[204:207],v[68:71],a[240:243],v[204:207]
s_waitcnt lgkmcnt(2)
v_mfma_f32_16x16x32_bf16 v[192:195],a[116:119],v[72:75],v[192:195]
ds_read_b128 v[68:71],v20 offset:62464
v_mfma_f32_16x16x32_bf16 v[200:203],v[72:75],a[244:247],v[200:203]
s_waitcnt lgkmcnt(2)
v_mfma_f32_16x16x32_bf16 v[196:199],a[116:119],v[76:79],v[196:199]
ds_read_b128 v[72:75],v20 offset:63488
v_mfma_f32_16x16x32_bf16 v[204:207],v[76:79],a[244:247],v[204:207]
s_waitcnt lgkmcnt(2)
v_mfma_f32_16x16x32_bf16 v[192:195],a[120:123],v[64:67],v[192:195]
ds_read_b128 v[76:79],v20 offset:64512
v_mfma_f32_16x16x32_bf16 v[200:203],v[64:67],a[248:251],v[200:203]
s_waitcnt lgkmcnt(2)
v_mfma_f32_16x16x32_bf16 v[196:199],a[120:123],v[68:71],v[196:199]
v_mfma_f32_16x16x32_bf16 v[204:207],v[68:71],a[248:251],v[204:207]
s_waitcnt lgkmcnt(1)
v_mfma_f32_16x16x32_bf16 v[192:195],a[124:127],v[72:75],v[192:195]
v_mfma_f32_16x16x32_bf16 v[200:203],v[72:75],a[252:255],v[200:203]
s_waitcnt lgkmcnt(0)
v_mfma_f32_16x16x32_bf16 v[196:199],a[124:127],v[76:79],v[196:199]
v_mfma_f32_16x16x32_bf16 v[204:207],v[76:79],a[252:255],v[204:207]
v_xor_b32 v20,0x10000,v20
s_xor_b32 s62,s62,0x10000
s_lshr_b32 s64,s73,9
v_add_u32 v22,s64,v24
v_cvt_pk_bf16_f32 v208,v192,v193
v_cvt_pk_bf16_f32 v209,v194,v195
s_nop 0
v_cvt_pk_bf16_f32 v210,v196,v197
v_cvt_pk_bf16_f32 v211,v198,v199
v_cvt_pk_bf16_f32 v212,v200,v201
v_cvt_pk_bf16_f32 v213,v202,v203
v_cvt_pk_bf16_f32 v214,v204,v205
v_cvt_pk_bf16_f32 v215,v206,v207
v_permlane16_swap_b32 v208,v210
v_permlane16_swap_b32 v209,v211
buffer_store_dwordx4 v[208:211],v2,s[24:27],s73 offen
buffer_store_dwordx4 v[208:211],v2,s[28:31],s73 offen sc1
ds_write_b128 v22,v[212:215] offset:16384
buffer_store_dwordx4 v[208:211],v17,s[20:23],s12 offen sc1
bgx_134:
s_add_u32 s63,s79,1
s_and_b32 s64,s63,3
s_lshl_b32 s70,s64,20
s_add_u32 s65,s63,2
s_and_b32 s65,s65,3
s_lshl_b32 s73,s65,20
s_add_u32 s55,s63,3
s_lshl_b32 s78,s55,16
s_add_u32 s78,s78,57344
s_cmp_lt_u32 s55,64
s_cselect_b32 s78,s78,0x7fff0000
s_add_u32 s60,s63,1
s_lshl_b32 s76,s60,21
s_lshl_b32 s55,s60,13
s_and_b32 s55,s55,0x2000
s_xor_b32 s55,s55,s61
s_add_u32 s76,s76,s55
s_cmp_lt_u32 s60,64
s_cselect_b32 s76,s76,0x7fff0000
s_add_u32 s60,s63,2
s_lshl_b32 s12,s60,21
s_lshl_b32 s55,s60,13
s_and_b32 s55,s55,0x2000
s_xor_b32 s55,s55,s61
s_add_u32 s12,s12,s55
s_cmp_lt_u32 s60,64
s_cselect_b32 s12,s12,0x7fff0000
s_add_u32 s71,s73,65536
v_mov_b32 v176,0
v_mov_b32 v177,0
v_mov_b32 v178,0
v_mov_b32 v179,0
v_mov_b32 v180,0
v_mov_b32 v181,0
v_mov_b32 v182,0
v_mov_b32 v183,0
s_add_u32 s79,s79,1
s_cmp_eq_u32 s79,0
s_cbranch_scc1 pn2_133
v_mov_b32 v38,1
ds_write_b32 v37,v38 offset:8
buffer_store_dwordx4 v[212:215],v12,s[20:23],s76 offen sc1
s_waitcnt lgkmcnt(0)
s_branch pn1_132
pn2_133:
v_mov_b32 v25,1
s_waitcnt vmcnt(1) lgkmcnt(0)
s_barrier
s_branch loop_124
w2_60:
s_lshr_b32 s64,s57,2
s_add_u32 s64,s64,64
s_lshl_b32 s64,s64,14
s_add_u32 s64,s64,s68
s_add_u32 s64,s64,29361152
v_add_u32 v12,s64,v16
v_and_b32 v22,1,v4
v_lshrrev_b32 v23,1,v4
v_lshl_add_u32 v22,v22,1,v23
v_lshlrev_b32 v22,2,v22
v_lshl_add_u32 v22,v3,4,v22
v_add_u32 v31,155904,v22
s_branch first_135
loop_136:
s_barrier
buffer_load_dword v248,v18,s[20:23],s70 offen offset:0 sc1
s_nop 15
s_nop 5
hl_138:
buffer_load_dword v249,v18,s[20:23],s70 offen offset:0 sc1
s_waitcnt vmcnt(1)
v_cmp_eq_u32 vcc,v25,v248
s_bcnt1_i32_b32 s64,vcc_lo
s_cmp_ge_u32 s64,8
s_cbranch_scc1 hg_139
buffer_load_dword v248,v18,s[20:23],s70 offen offset:0 sc1
s_waitcnt vmcnt(1)
v_cmp_eq_u32 vcc,v25,v249
s_bcnt1_i32_b32 s64,vcc_lo
s_cmp_ge_u32 s64,8
s_cbranch_scc1 hg_139
s_sub_u32 s90,s90,1
s_cmp_gt_i32 s90,0
s_cbranch_scc1 hl_138
hg_139:
buffer_load_dwordx4 v[64:67],v28,s[20:23],s70 offen offset:0 sc1
buffer_load_dwordx4 v[68:71],v28,s[20:23],s70 offen offset:1024 sc1
buffer_load_dwordx4 v[72:75],v28,s[20:23],s70 offen offset:2048 sc1
buffer_load_dwordx4 v[76:79],v28,s[20:23],s70 offen offset:3072 sc1
s_waitcnt vmcnt(3)
ds_write_b128 v24,v[64:67] offset:8192
v_min3_u32 v22,v64,v65,v66
v_min_u32 v22,v22,v67
s_waitcnt vmcnt(2)
ds_write_b128 v24,v[68:71] offset:9216
v_min3_u32 v22,v22,v68,v69
v_min3_u32 v22,v22,v70,v71
s_waitcnt vmcnt(1)
ds_write_b128 v24,v[72:75] offset:10240
v_min3_u32 v22,v22,v72,v73
v_min3_u32 v22,v22,v74,v75
s_waitcnt vmcnt(0)
ds_write_b128 v24,v[76:79] offset:11264
v_min3_u32 v22,v22,v76,v77
v_min3_u32 v22,v22,v78,v79
v_cmp_eq_u32 vcc,0,v22
s_cbranch_vccnz art_140
abk_141:
v_smfmac_f32_16x16x64_bf16 v[176:179],v[64:67],a[64:71],v14
s_waitcnt lgkmcnt(0)
s_barrier
ds_read_b128 v[80:83],v24 offset:12288
ds_read_b128 v[84:87],v24 offset:13312
ds_read_b128 v[88:91],v24 offset:14336
ds_read_b128 v[92:95],v24 offset:15360
buffer_store_dwordx4 v[212:215],v12,s[20:23],s76 offen sc1
v_smfmac_f32_16x16x64_bf16 v[176:179],v[68:71],a[72:79],v14
ds_read_b128 v[32:35],v24 offset:0
ds_read_b128 v[36:39],v24 offset:1024
v_smfmac_f32_16x16x64_bf16 v[176:179],v[72:75],a[80:87],v14
ds_read_b128 v[40:43],v24 offset:2048
ds_read_b128 v[44:47],v24 offset:3072
v_smfmac_f32_16x16x64_bf16 v[176:179],v[76:79],a[88:95],v14
ds_read_b128 v[48:51],v24 offset:4096
ds_read_b128 v[52:55],v24 offset:5120
s_waitcnt lgkmcnt(9)
v_smfmac_f32_16x16x64_bf16 v[176:179],v[80:83],a[96:103],v14
ds_read_b128 v[56:59],v24 offset:6144
s_waitcnt lgkmcnt(9)
v_smfmac_f32_16x16x64_bf16 v[176:179],v[84:87],a[104:111],v14
ds_read_b128 v[60:63],v24 offset:7168
s_waitcnt lgkmcnt(9)
v_smfmac_f32_16x16x64_bf16 v[176:179],v[88:91],a[112:119],v14
s_waitcnt lgkmcnt(8)
v_smfmac_f32_16x16x64_bf16 v[176:179],v[92:95],a[120:127],v14
s_waitcnt lgkmcnt(7)
v_smfmac_f32_16x16x64_bf16 v[176:179],v[32:35],a[0:7],v14
s_waitcnt lgkmcnt(6)
v_smfmac_f32_16x16x64_bf16 v[176:179],v[36:39],a[8:15],v14
s_waitcnt lgkmcnt(5)
v_smfmac_f32_16x16x64_bf16 v[176:179],v[40:43],a[16:23],v14
s_waitcnt lgkmcnt(4)
v_smfmac_f32_16x16x64_bf16 v[176:179],v[44:47],a[24:31],v14
s_waitcnt lgkmcnt(3)
v_smfmac_f32_16x16x64_bf16 v[176:179],v[48:51],a[32:39],v14
s_waitcnt lgkmcnt(2)
v_smfmac_f32_16x16x64_bf16 v[176:179],v[52:55],a[40:47],v14
s_waitcnt lgkmcnt(1)
v_smfmac_f32_16x16x64_bf16 v[176:179],v[56:59],a[48:55],v14
s_waitcnt lgkmcnt(0)
v_smfmac_f32_16x16x64_bf16 v[176:179],v[60:63],a[56:63],v14
v_smfmac_f32_16x16x64_bf16 v[180:183],v[32:35],a[128:135],v14
v_smfmac_f32_16x16x64_bf16 v[180:183],v[36:39],a[136:143],v14
s_nop 5
v_permlane32_swap_b32 v176,v178
v_permlane32_swap_b32 v177,v179
v_add_f32 v176,v176,v178
v_add_f32 v177,v177,v179
v_cvt_pk_bf16_f32 v216,v176,v177
s_nop 1
v_mov_b32_dpp v217,v216 quad_perm:[1,0,3,2] row_mask:0xf bank_mask:0xf
v_perm_b32 v216,v217,v216,v15
v_max_u32 v216,1,v216
buffer_store_dword v216,v19,s[24:27],s70 offen
buffer_store_dword v216,v19,s[28:31],s70 offen sc1
v_smfmac_f32_16x16x64_bf16 v[180:183],v[40:43],a[144:151],v14
v_smfmac_f32_16x16x64_bf16 v[180:183],v[44:47],a[152:159],v14
v_smfmac_f32_16x16x64_bf16 v[180:183],v[48:51],a[160:167],v14
v_smfmac_f32_16x16x64_bf16 v[180:183],v[52:55],a[168:175],v14
v_smfmac_f32_16x16x64_bf16 v[180:183],v[56:59],a[176:183],v14
v_smfmac_f32_16x16x64_bf16 v[180:183],v[60:63],a[184:191],v14
v_smfmac_f32_16x16x64_bf16 v[180:183],v[64:67],a[192:199],v14
v_smfmac_f32_16x16x64_bf16 v[180:183],v[68:71],a[200:207],v14
v_smfmac_f32_16x16x64_bf16 v[180:183],v[72:75],a[208:215],v14
v_smfmac_f32_16x16x64_bf16 v[180:183],v[76:79],a[216:223],v14
v_smfmac_f32_16x16x64_bf16 v[180:183],v[80:83],a[224:231],v14
v_smfmac_f32_16x16x64_bf16 v[180:183],v[84:87],a[232:239],v14
v_smfmac_f32_16x16x64_bf16 v[180:183],v[88:91],a[240:247],v14
v_smfmac_f32_16x16x64_bf16 v[180:183],v[92:95],a[248:255],v14
s_nop 7
v_permlane32_swap_b32 v180,v182
v_permlane32_swap_b32 v181,v183
v_add_f32 v180,v180,v182
v_add_f32 v181,v181,v183
v_cvt_pk_bf16_f32 v216,v180,v181
v_max_u32 v216,1,v216
ds_write_b32 v31,v216
ds_write_b32 v21,v25 offset:4
s_cmp_eq_u32 s79,63
s_cbranch_scc1 end_57
s_cmp_ge_i32 s79,62
s_cbranch_scc1 bgsk_143
ds_read_b128 v[64:67],v20 offset:0
ds_read_b128 v[68:71],v20 offset:1024
ds_read_b128 v[72:75],v20 offset:2048
s_waitcnt lgkmcnt(2)
v_mfma_f32_16x16x32_bf16 v[192:195],a[0:3],v[64:67],0
ds_read_b128 v[76:79],v20 offset:3072
v_mfma_f32_16x16x32_bf16 v[200:203],v[64:67],a[128:131],0
s_waitcnt lgkmcnt(2)
v_mfma_f32_16x16x32_bf16 v[196:199],a[0:3],v[68:71],0
ds_read_b128 v[64:67],v20 offset:4096
v_mfma_f32_16x16x32_bf16 v[204:207],v[68:71],a[128:131],0
s_waitcnt lgkmcnt(2)
v_mfma_f32_16x16x32_bf16 v[192:195],a[4:7],v[72:75],v[192:195]
ds_read_b128 v[68:71],v20 offset:5120
v_mfma_f32_16x16x32_bf16 v[200:203],v[72:75],a[132:135],v[200:203]
s_waitcnt lgkmcnt(2)
v_mfma_f32_16x16x32_bf16 v[196:199],a[4:7],v[76:79],v[196:199]
ds_read_b128 v[72:75],v20 offset:6144
v_mfma_f32_16x16x32_bf16 v[204:207],v[76:79],a[132:135],v[204:207]
s_waitcnt lgkmcnt(2)
v_mfma_f32_16x16x32_bf16 v[192:195],a[8:11],v[64:67],v[192:195]
ds_read_b128 v[76:79],v20 offset:7168
v_mfma_f32_16x16x32_bf16 v[200:203],v[64:67],a[136:139],v[200:203]
s_waitcnt lgkmcnt(2)
v_mfma_f32_16x16x32_bf16 v[196:199],a[8:11],v[68:71],v[196:199]
ds_read_b128 v[64:67],v20 offset:8192
v_mfma_f32_16x16x32_bf16 v[204:207],v[68:71],a[136:139],v[204:207]
s_waitcnt lgkmcnt(2)
v_mfma_f32_16x16x32_bf16 v[192:195],a[12:15],v[72:75],v[192:195]
ds_read_b128 v[68:71],v20 offset:9216
v_mfma_f32_16x16x32_bf16 v[200:203],v[72:75],a[140:143],v[200:203]
s_waitcnt lgkmcnt(2)
v_mfma_f32_16x16x32_bf16 v[196:199],a[12:15],v[76:79],v[196:199]
ds_read_b128 v[72:75],v20 offset:10240
v_mfma_f32_16x16x32_bf16 v[204:207],v[76:79],a[140:143],v[204:207]
s_add_u32 m0,s62,16384
s_add_u32 s69,s78,16384
s_waitcnt lgkmcnt(2)
v_mfma_f32_16x16x32_bf16 v[192:195],a[16:19],v[64:67],v[192:195]
ds_read_b128 v[76:79],v20 offset:11264
v_mfma_f32_16x16x32_bf16 v[200:203],v[64:67],a[144:147],v[200:203]
buffer_load_dwordx4 v16,s[20:23],s69 offen offset:0 lds
s_waitcnt lgkmcnt(2)
v_mfma_f32_16x16x32_bf16 v[196:199],a[16:19],v[68:71],v[196:199]
ds_read_b128 v[64:67],v20 offset:12288
v_mfma_f32_16x16x32_bf16 v[204:207],v[68:71],a[144:147],v[204:207]
buffer_load_dwordx4 v16,s[20:23],s69 offen offset:1024 lds
s_waitcnt lgkmcnt(2)
v_mfma_f32_16x16x32_bf16 v[192:195],a[20:23],v[72:75],v[192:195]
ds_read_b128 v[68:71],v20 offset:13312
v_mfma_f32_16x16x32_bf16 v[200:203],v[72:75],a[148:151],v[200:203]
buffer_load_dwordx4 v16,s[20:23],s69 offen offset:2048 lds
s_waitcnt lgkmcnt(2)
v_mfma_f32_16x16x32_bf16 v[196:199],a[20:23],v[76:79],v[196:199]
ds_read_b128 v[72:75],v20 offset:14336
v_mfma_f32_16x16x32_bf16 v[204:207],v[76:79],a[148:151],v[204:207]
buffer_load_dwordx4 v16,s[20:23],s69 offen offset:3072 lds
s_waitcnt lgkmcnt(2)
v_mfma_f32_16x16x32_bf16 v[192:195],a[24:27],v[64:67],v[192:195]
ds_read_b128 v[76:79],v20 offset:15360
v_mfma_f32_16x16x32_bf16 v[200:203],v[64:67],a[152:155],v[200:203]
s_add_u32 m0,s62,20480
s_add_u32 s69,s78,20480
s_waitcnt lgkmcnt(2)
v_mfma_f32_16x16x32_bf16 v[196:199],a[24:27],v[68:71],v[196:199]
ds_read_b128 v[64:67],v20 offset:16384
v_mfma_f32_16x16x32_bf16 v[204:207],v[68:71],a[152:155],v[204:207]
buffer_load_dwordx4 v16,s[20:23],s69 offen offset:0 lds
s_waitcnt lgkmcnt(2)
v_mfma_f32_16x16x32_bf16 v[192:195],a[28:31],v[72:75],v[192:195]
ds_read_b128 v[68:71],v20 offset:17408
v_mfma_f32_16x16x32_bf16 v[200:203],v[72:75],a[156:159],v[200:203]
buffer_load_dwordx4 v16,s[20:23],s69 offen offset:1024 lds
s_waitcnt lgkmcnt(2)
v_mfma_f32_16x16x32_bf16 v[196:199],a[28:31],v[76:79],v[196:199]
ds_read_b128 v[72:75],v20 offset:18432
v_mfma_f32_16x16x32_bf16 v[204:207],v[76:79],a[156:159],v[204:207]
buffer_load_dwordx4 v16,s[20:23],s69 offen offset:2048 lds
s_waitcnt lgkmcnt(2)
v_mfma_f32_16x16x32_bf16 v[192:195],a[32:35],v[64:67],v[192:195]
ds_read_b128 v[76:79],v20 offset:19456
v_mfma_f32_16x16x32_bf16 v[200:203],v[64:67],a[160:163],v[200:203]
buffer_load_dwordx4 v16,s[20:23],s69 offen offset:3072 lds
s_waitcnt lgkmcnt(2)
v_mfma_f32_16x16x32_bf16 v[196:199],a[32:35],v[68:71],v[196:199]
ds_read_b128 v[64:67],v20 offset:20480
v_mfma_f32_16x16x32_bf16 v[204:207],v[68:71],a[160:163],v[204:207]
s_add_u32 m0,s62,24576
s_add_u32 s69,s78,24576
s_waitcnt lgkmcnt(2)
v_mfma_f32_16x16x32_bf16 v[192:195],a[36:39],v[72:75],v[192:195]
ds_read_b128 v[68:71],v20 offset:21504
v_mfma_f32_16x16x32_bf16 v[200:203],v[72:75],a[164:167],v[200:203]
buffer_load_dwordx4 v16,s[20:23],s69 offen offset:0 lds
s_waitcnt lgkmcnt(2)
v_mfma_f32_16x16x32_bf16 v[196:199],a[36:39],v[76:79],v[196:199]
ds_read_b128 v[72:75],v20 offset:22528
v_mfma_f32_16x16x32_bf16 v[204:207],v[76:79],a[164:167],v[204:207]
buffer_load_dwordx4 v16,s[20:23],s69 offen offset:1024 lds
s_waitcnt lgkmcnt(2)
v_mfma_f32_16x16x32_bf16 v[192:195],a[40:43],v[64:67],v[192:195]
ds_read_b128 v[76:79],v20 offset:23552
v_mfma_f32_16x16x32_bf16 v[200:203],v[64:67],a[168:171],v[200:203]
buffer_load_dwordx4 v16,s[20:23],s69 offen offset:2048 lds
s_waitcnt lgkmcnt(2)
v_mfma_f32_16x16x32_bf16 v[196:199],a[40:43],v[68:71],v[196:199]
ds_read_b128 v[64:67],v20 offset:24576
v_mfma_f32_16x16x32_bf16 v[204:207],v[68:71],a[168:171],v[204:207]
buffer_load_dwordx4 v16,s[20:23],s69 offen offset:3072 lds
s_waitcnt lgkmcnt(2)
v_mfma_f32_16x16x32_bf16 v[192:195],a[44:47],v[72:75],v[192:195]
ds_read_b128 v[68:71],v20 offset:25600
v_mfma_f32_16x16x32_bf16 v[200:203],v[72:75],a[172:175],v[200:203]
s_add_u32 m0,s62,28672
s_add_u32 s69,s78,28672
s_waitcnt lgkmcnt(2)
v_mfma_f32_16x16x32_bf16 v[196:199],a[44:47],v[76:79],v[196:199]
ds_read_b128 v[72:75],v20 offset:26624
v_mfma_f32_16x16x32_bf16 v[204:207],v[76:79],a[172:175],v[204:207]
buffer_load_dwordx4 v16,s[20:23],s69 offen offset:0 lds
s_waitcnt lgkmcnt(2)
v_mfma_f32_16x16x32_bf16 v[192:195],a[48:51],v[64:67],v[192:195]
ds_read_b128 v[76:79],v20 offset:27648
v_mfma_f32_16x16x32_bf16 v[200:203],v[64:67],a[176:179],v[200:203]
buffer_load_dwordx4 v16,s[20:23],s69 offen offset:1024 lds
s_waitcnt lgkmcnt(2)
v_mfma_f32_16x16x32_bf16 v[196:199],a[48:51],v[68:71],v[196:199]
ds_read_b128 v[64:67],v20 offset:28672
v_mfma_f32_16x16x32_bf16 v[204:207],v[68:71],a[176:179],v[204:207]
buffer_load_dwordx4 v16,s[20:23],s69 offen offset:2048 lds
s_waitcnt lgkmcnt(2)
v_mfma_f32_16x16x32_bf16 v[192:195],a[52:55],v[72:75],v[192:195]
ds_read_b128 v[68:71],v20 offset:29696
v_mfma_f32_16x16x32_bf16 v[200:203],v[72:75],a[180:183],v[200:203]
buffer_load_dwordx4 v16,s[20:23],s69 offen offset:3072 lds
s_waitcnt lgkmcnt(2)
v_mfma_f32_16x16x32_bf16 v[196:199],a[52:55],v[76:79],v[196:199]
ds_read_b128 v[72:75],v20 offset:30720
v_mfma_f32_16x16x32_bf16 v[204:207],v[76:79],a[180:183],v[204:207]
s_waitcnt lgkmcnt(2)
v_mfma_f32_16x16x32_bf16 v[192:195],a[56:59],v[64:67],v[192:195]
ds_read_b128 v[76:79],v20 offset:31744
v_mfma_f32_16x16x32_bf16 v[200:203],v[64:67],a[184:187],v[200:203]
s_waitcnt lgkmcnt(2)
v_mfma_f32_16x16x32_bf16 v[196:199],a[56:59],v[68:71],v[196:199]
ds_read_b128 v[64:67],v20 offset:32768
v_mfma_f32_16x16x32_bf16 v[204:207],v[68:71],a[184:187],v[204:207]
s_waitcnt lgkmcnt(2)
v_mfma_f32_16x16x32_bf16 v[192:195],a[60:63],v[72:75],v[192:195]
ds_read_b128 v[68:71],v20 offset:33792
v_mfma_f32_16x16x32_bf16 v[200:203],v[72:75],a[188:191],v[200:203]
s_waitcnt lgkmcnt(2)
v_mfma_f32_16x16x32_bf16 v[196:199],a[60:63],v[76:79],v[196:199]
ds_read_b128 v[72:75],v20 offset:34816
v_mfma_f32_16x16x32_bf16 v[204:207],v[76:79],a[188:191],v[204:207]
s_waitcnt lgkmcnt(2)
v_mfma_f32_16x16x32_bf16 v[192:195],a[64:67],v[64:67],v[192:195]
ds_read_b128 v[76:79],v20 offset:35840
v_mfma_f32_16x16x32_bf16 v[200:203],v[64:67],a[192:195],v[200:203]
s_waitcnt lgkmcnt(2)
v_mfma_f32_16x16x32_bf16 v[196:199],a[64:67],v[68:71],v[196:199]
ds_read_b128 v[64:67],v20 offset:36864
v_mfma_f32_16x16x32_bf16 v[204:207],v[68:71],a[192:195],v[204:207]
s_waitcnt lgkmcnt(2)
v_mfma_f32_16x16x32_bf16 v[192:195],a[68:71],v[72:75],v[192:195]
ds_read_b128 v[68:71],v20 offset:37888
v_mfma_f32_16x16x32_bf16 v[200:203],v[72:75],a[196:199],v[200:203]
s_waitcnt lgkmcnt(2)
v_mfma_f32_16x16x32_bf16 v[196:199],a[68:71],v[76:79],v[196:199]
ds_read_b128 v[72:75],v20 offset:38912
v_mfma_f32_16x16x32_bf16 v[204:207],v[76:79],a[196:199],v[204:207]
s_waitcnt lgkmcnt(2)
v_mfma_f32_16x16x32_bf16 v[192:195],a[72:75],v[64:67],v[192:195]
ds_read_b128 v[76:79],v20 offset:39936
v_mfma_f32_16x16x32_bf16 v[200:203],v[64:67],a[200:203],v[200:203]
s_waitcnt lgkmcnt(2)
v_mfma_f32_16x16x32_bf16 v[196:199],a[72:75],v[68:71],v[196:199]
ds_read_b128 v[64:67],v20 offset:40960
v_mfma_f32_16x16x32_bf16 v[204:207],v[68:71],a[200:203],v[204:207]
s_waitcnt lgkmcnt(2)
v_mfma_f32_16x16x32_bf16 v[192:195],a[76:79],v[72:75],v[192:195]
ds_read_b128 v[68:71],v20 offset:41984
v_mfma_f32_16x16x32_bf16 v[200:203],v[72:75],a[204:207],v[200:203]
s_waitcnt lgkmcnt(2)
v_mfma_f32_16x16x32_bf16 v[196:199],a[76:79],v[76:79],v[196:199]
ds_read_b128 v[72:75],v20 offset:43008
v_mfma_f32_16x16x32_bf16 v[204:207],v[76:79],a[204:207],v[204:207]
s_waitcnt lgkmcnt(2)
v_mfma_f32_16x16x32_bf16 v[192:195],a[80:83],v[64:67],v[192:195]
ds_read_b128 v[76:79],v20 offset:44032
v_mfma_f32_16x16x32_bf16 v[200:203],v[64:67],a[208:211],v[200:203]
s_waitcnt lgkmcnt(2)
v_mfma_f32_16x16x32_bf16 v[196:199],a[80:83],v[68:71],v[196:199]
ds_read_b128 v[64:67],v20 offset:45056
v_mfma_f32_16x16x32_bf16 v[204:207],v[68:71],a[208:211],v[204:207]
s_waitcnt lgkmcnt(2)
v_mfma_f32_16x16x32_bf16 v[192:195],a[84:87],v[72:75],v[192:195]
ds_read_b128 v[68:71],v20 offset:46080
v_mfma_f32_16x16x32_bf16 v[200:203],v[72:75],a[212:215],v[200:203]
s_waitcnt lgkmcnt(2)
v_mfma_f32_16x16x32_bf16 v[196:199],a[84:87],v[76:79],v[196:199]
ds_read_b128 v[72:75],v20 offset:47104
v_mfma_f32_16x16x32_bf16 v[204:207],v[76:79],a[212:215],v[204:207]
s_waitcnt lgkmcnt(2)
v_mfma_f32_16x16x32_bf16 v[192:195],a[88:91],v[64:67],v[192:195]
ds_read_b128 v[76:79],v20 offset:48128
v_mfma_f32_16x16x32_bf16 v[200:203],v[64:67],a[216:219],v[200:203]
s_waitcnt lgkmcnt(2)
v_mfma_f32_16x16x32_bf16 v[196:199],a[88:91],v[68:71],v[196:199]
ds_read_b128 v[64:67],v20 offset:49152
v_mfma_f32_16x16x32_bf16 v[204:207],v[68:71],a[216:219],v[204:207]
s_waitcnt lgkmcnt(2)
v_mfma_f32_16x16x32_bf16 v[192:195],a[92:95],v[72:75],v[192:195]
ds_read_b128 v[68:71],v20 offset:50176
v_mfma_f32_16x16x32_bf16 v[200:203],v[72:75],a[220:223],v[200:203]
s_waitcnt lgkmcnt(2)
v_mfma_f32_16x16x32_bf16 v[196:199],a[92:95],v[76:79],v[196:199]
ds_read_b128 v[72:75],v20 offset:51200
v_mfma_f32_16x16x32_bf16 v[204:207],v[76:79],a[220:223],v[204:207]
s_waitcnt lgkmcnt(2)
v_mfma_f32_16x16x32_bf16 v[192:195],a[96:99],v[64:67],v[192:195]
ds_read_b128 v[76:79],v20 offset:52224
v_mfma_f32_16x16x32_bf16 v[200:203],v[64:67],a[224:227],v[200:203]
s_waitcnt lgkmcnt(2)
v_mfma_f32_16x16x32_bf16 v[196:199],a[96:99],v[68:71],v[196:199]
ds_read_b128 v[64:67],v20 offset:53248
v_mfma_f32_16x16x32_bf16 v[204:207],v[68:71],a[224:227],v[204:207]
s_waitcnt lgkmcnt(2)
v_mfma_f32_16x16x32_bf16 v[192:195],a[100:103],v[72:75],v[192:195]
ds_read_b128 v[68:71],v20 offset:54272
s_add_u32 m0,s62,43008
s_add_u32 s69,s78,43008
v_mfma_f32_16x16x32_bf16 v[200:203],v[72:75],a[228:231],v[200:203]
s_waitcnt lgkmcnt(2)
v_mfma_f32_16x16x32_bf16 v[196:199],a[100:103],v[76:79],v[196:199]
ds_read_b128 v[72:75],v20 offset:55296
buffer_load_dwordx4 v16,s[20:23],s69 offen offset:0 lds
v_mfma_f32_16x16x32_bf16 v[204:207],v[76:79],a[228:231],v[204:207]
s_waitcnt lgkmcnt(2)
v_mfma_f32_16x16x32_bf16 v[192:195],a[104:107],v[64:67],v[192:195]
ds_read_b128 v[76:79],v20 offset:56320
buffer_load_dwordx4 v16,s[20:23],s69 offen offset:1024 lds
v_mfma_f32_16x16x32_bf16 v[200:203],v[64:67],a[232:235],v[200:203]
s_waitcnt lgkmcnt(2)
v_mfma_f32_16x16x32_bf16 v[196:199],a[104:107],v[68:71],v[196:199]
ds_read_b128 v[64:67],v20 offset:57344
buffer_load_dwordx4 v16,s[20:23],s69 offen offset:2048 lds
v_mfma_f32_16x16x32_bf16 v[204:207],v[68:71],a[232:235],v[204:207]
s_waitcnt lgkmcnt(2)
v_mfma_f32_16x16x32_bf16 v[192:195],a[108:111],v[72:75],v[192:195]
ds_read_b128 v[68:71],v20 offset:58368
buffer_load_dwordx4 v16,s[20:23],s69 offen offset:3072 lds
v_mfma_f32_16x16x32_bf16 v[200:203],v[72:75],a[236:239],v[200:203]
s_waitcnt lgkmcnt(2)
v_mfma_f32_16x16x32_bf16 v[196:199],a[108:111],v[76:79],v[196:199]
ds_read_b128 v[72:75],v20 offset:59392
s_add_u32 m0,s62,47104
s_add_u32 s69,s78,47104
v_mfma_f32_16x16x32_bf16 v[204:207],v[76:79],a[236:239],v[204:207]
s_waitcnt lgkmcnt(2)
v_mfma_f32_16x16x32_bf16 v[192:195],a[112:115],v[64:67],v[192:195]
ds_read_b128 v[76:79],v20 offset:60416
buffer_load_dwordx4 v16,s[20:23],s69 offen offset:0 lds
v_mfma_f32_16x16x32_bf16 v[200:203],v[64:67],a[240:243],v[200:203]
s_waitcnt lgkmcnt(2)
v_mfma_f32_16x16x32_bf16 v[196:199],a[112:115],v[68:71],v[196:199]
ds_read_b128 v[64:67],v20 offset:61440
v_mfma_f32_16x16x32_bf16 v[204:207],v[68:71],a[240:243],v[204:207]
buffer_load_dwordx4 v16,s[20:23],s69 offen offset:1024 lds
s_waitcnt lgkmcnt(2)
v_mfma_f32_16x16x32_bf16 v[192:195],a[116:119],v[72:75],v[192:195]
ds_read_b128 v[68:71],v20 offset:62464
v_mfma_f32_16x16x32_bf16 v[200:203],v[72:75],a[244:247],v[200:203]
buffer_load_dwordx4 v16,s[20:23],s69 offen offset:2048 lds
s_waitcnt lgkmcnt(2)
v_mfma_f32_16x16x32_bf16 v[196:199],a[116:119],v[76:79],v[196:199]
ds_read_b128 v[72:75],v20 offset:63488
v_mfma_f32_16x16x32_bf16 v[204:207],v[76:79],a[244:247],v[204:207]
buffer_load_dwordx4 v16,s[20:23],s69 offen offset:3072 lds
s_waitcnt lgkmcnt(2)
v_mfma_f32_16x16x32_bf16 v[192:195],a[120:123],v[64:67],v[192:195]
ds_read_b128 v[76:79],v20 offset:64512
v_mfma_f32_16x16x32_bf16 v[200:203],v[64:67],a[248:251],v[200:203]
s_add_u32 m0,s62,51200
s_add_u32 s69,s78,51200
s_waitcnt lgkmcnt(2)
v_mfma_f32_16x16x32_bf16 v[196:199],a[120:123],v[68:71],v[196:199]
v_mfma_f32_16x16x32_bf16 v[204:207],v[68:71],a[248:251],v[204:207]
buffer_load_dwordx4 v16,s[20:23],s69 offen offset:0 lds
s_waitcnt lgkmcnt(1)
v_mfma_f32_16x16x32_bf16 v[192:195],a[124:127],v[72:75],v[192:195]
v_mfma_f32_16x16x32_bf16 v[200:203],v[72:75],a[252:255],v[200:203]
buffer_load_dwordx4 v16,s[20:23],s69 offen offset:1024 lds
s_waitcnt lgkmcnt(0)
v_mfma_f32_16x16x32_bf16 v[196:199],a[124:127],v[76:79],v[196:199]
v_mfma_f32_16x16x32_bf16 v[204:207],v[76:79],a[252:255],v[204:207]
s_waitcnt vmcnt(26)
ds_write_b32 v21,v25 offset:28
v_xor_b32 v20,0x10000,v20
s_xor_b32 s62,s62,0x10000
s_lshr_b32 s64,s73,9
v_add_u32 v22,s64,v24
v_cvt_pk_bf16_f32 v208,v192,v193
v_cvt_pk_bf16_f32 v209,v194,v195
v_cvt_pk_bf16_f32 v210,v196,v197
v_cvt_pk_bf16_f32 v211,v198,v199
v_cvt_pk_bf16_f32 v212,v200,v201
v_cvt_pk_bf16_f32 v213,v202,v203
v_cvt_pk_bf16_f32 v214,v204,v205
v_cvt_pk_bf16_f32 v215,v206,v207
v_permlane16_swap_b32 v208,v210
v_permlane16_swap_b32 v209,v211
buffer_store_dwordx4 v[208:211],v2,s[24:27],s73 offen
buffer_store_dwordx4 v[208:211],v2,s[28:31],s73 offen sc1
ds_write_b128 v22,v[212:215] offset:17408
buffer_store_dwordx4 v[208:211],v17,s[20:23],s12 offen sc1
bgx_142:
s_waitcnt lgkmcnt(0)
s_andn2_b32 s64,s79,0x14
s_cmp_eq_u32 s64,2
s_cbranch_scc1 late_144
lateb_145:
s_buffer_load_dword s48,s[20:23],s80 offset:0
s_buffer_load_dword s48,s[20:23],s80 offset:64
s_buffer_load_dword s48,s[20:23],s80 offset:128
s_buffer_load_dword s48,s[20:23],s80 offset:192
s_buffer_load_dword s48,s[20:23],s80 offset:256
s_buffer_load_dword s48,s[20:23],s80 offset:320
s_buffer_load_dword s48,s[20:23],s80 offset:384
s_buffer_load_dword s48,s[20:23],s80 offset:448
s_buffer_load_dword s48,s[20:23],s80 offset:512
s_buffer_load_dword s48,s[20:23],s80 offset:576
s_buffer_load_dword s48,s[20:23],s80 offset:640
s_buffer_load_dword s48,s[20:23],s80 offset:704
s_buffer_load_dword s48,s[20:23],s80 offset:768
s_buffer_load_dword s48,s[20:23],s80 offset:832
s_buffer_load_dword s48,s[20:23],s80 offset:896
s_buffer_load_dword s48,s[20:23],s80 offset:960
s_buffer_load_dword s48,s[20:23],s80 offset:1024
s_buffer_load_dword s48,s[20:23],s80 offset:1088
s_buffer_load_dword s48,s[20:23],s80 offset:1152
s_buffer_load_dword s48,s[20:23],s80 offset:1216
s_buffer_load_dword s48,s[20:23],s80 offset:1280
s_buffer_load_dword s48,s[20:23],s80 offset:1344
s_buffer_load_dword s48,s[20:23],s80 offset:1408
s_buffer_load_dword s48,s[20:23],s80 offset:1472
s_buffer_load_dword s48,s[20:23],s80 offset:1536
s_buffer_load_dword s48,s[20:23],s80 offset:1600
s_buffer_load_dword s48,s[20:23],s80 offset:1664
s_buffer_load_dword s48,s[20:23],s80 offset:1728
s_buffer_load_dword s48,s[20:23],s80 offset:1792
s_buffer_load_dword s48,s[20:23],s80 offset:1856
s_buffer_load_dword s48,s[20:23],s80 offset:1920
s_buffer_load_dword s48,s[20:23],s80 offset:1984
s_add_u32 s63,s79,1
s_and_b32 s64,s63,3
s_lshl_b32 s70,s64,20
s_add_u32 s65,s63,2
s_and_b32 s65,s65,3
s_lshl_b32 s73,s65,20
s_add_u32 s55,s63,3
s_lshl_b32 s78,s55,16
s_add_u32 s78,s78,57344
s_cmp_lt_u32 s55,64
s_cselect_b32 s78,s78,0x7fff0000
s_add_u32 s60,s63,1
s_lshl_b32 s76,s60,21
s_lshl_b32 s55,s60,13
s_and_b32 s55,s55,0x2000
s_xor_b32 s55,s55,s61
s_add_u32 s76,s76,s55
s_cmp_lt_u32 s60,64
s_cselect_b32 s76,s76,0x7fff0000
s_add_u32 s60,s63,2
s_lshl_b32 s12,s60,21
s_lshl_b32 s55,s60,13
s_and_b32 s55,s55,0x2000
s_xor_b32 s55,s55,s61
s_add_u32 s12,s12,s55
s_cmp_lt_u32 s60,64
s_cselect_b32 s12,s12,0x7fff0000
s_add_u32 s55,s63,5
s_min_u32 s55,s55,63
s_lshl_b32 s55,s55,16
s_lshl_b32 s60,s59,11
s_add_u32 s80,s55,s60
s_add_u32 s80,s80,57344
v_mov_b32 v176,0
v_mov_b32 v177,0
v_mov_b32 v178,0
v_mov_b32 v179,0
v_mov_b32 v180,0
v_mov_b32 v181,0
v_mov_b32 v182,0
v_mov_b32 v183,0
s_add_u32 s79,s79,1
v_add_u32 v25,1,v25
s_waitcnt vmcnt(0)
s_branch loop_136
art_140:
s_sub_u32 s90,s90,1
s_cmp_lt_i32 s90,0
s_cbranch_scc1 abk_141
buffer_load_dwordx4 v[64:67],v28,s[20:23],s70 offen offset:0 sc1
buffer_load_dwordx4 v[68:71],v28,s[20:23],s70 offen offset:1024 sc1
buffer_load_dwordx4 v[72:75],v28,s[20:23],s70 offen offset:2048 sc1
buffer_load_dwordx4 v[76:79],v28,s[20:23],s70 offen offset:3072 sc1
s_waitcnt vmcnt(3)
ds_write_b128 v24,v[64:67] offset:8192
v_min3_u32 v22,v64,v65,v66
v_min_u32 v22,v22,v67
s_waitcnt vmcnt(2)
ds_write_b128 v24,v[68:71] offset:9216
v_min3_u32 v22,v22,v68,v69
v_min3_u32 v22,v22,v70,v71
s_waitcnt vmcnt(1)
ds_write_b128 v24,v[72:75] offset:10240
v_min3_u32 v22,v22,v72,v73
v_min3_u32 v22,v22,v74,v75
s_waitcnt vmcnt(0)
ds_write_b128 v24,v[76:79] offset:11264
v_min3_u32 v22,v22,v76,v77
v_min3_u32 v22,v22,v78,v79
v_cmp_eq_u32 vcc,0,v22
s_cbranch_vccnz art_140
s_branch abk_141
bgsk_143:
s_waitcnt vmcnt(0)
ds_write_b32 v21,v25 offset:28
s_branch bgx_142
late_144:
s_cmp_eq_u32 s79,22
s_cbranch_scc1 lateb_145
v_lshlrev_b32 v184,2,v16
s_mov_b32 s52,21052416
s_mov_b32 s53,1792
s_lshr_b32 s64,s79,4
s_lshl_b32 s64,0x100,s64
s_cmp_eq_u32 s79,2
s_cselect_b32 exec_lo,0xff,s64
s_mov_b32 exec_hi,0
dp_146:
buffer_load_dword v185,v184,s[20:23],s52 offen sc1
s_waitcnt vmcnt(0)
v_cmp_ne_u32 vcc,s53,v185
s_cbranch_vccz dpok_147
s_sleep 2
s_sub_u32 s90,s90,1
s_cmp_gt_i32 s90,0
s_cbranch_scc1 dp_146
dpok_147:
s_mov_b64 exec,-1
s_branch lateb_145
first_135:
s_add_u32 s63,s79,0
s_and_b32 s64,s63,3
s_lshl_b32 s70,s64,20
s_add_u32 s65,s63,2
s_and_b32 s65,s65,3
s_lshl_b32 s73,s65,20
s_add_u32 s55,s63,3
s_lshl_b32 s78,s55,16
s_add_u32 s78,s78,57344
s_cmp_lt_u32 s55,64
s_cselect_b32 s78,s78,0x7fff0000
s_add_u32 s60,s63,1
s_lshl_b32 s76,s60,21
s_lshl_b32 s55,s60,13
s_and_b32 s55,s55,0x2000
s_xor_b32 s55,s55,s61
s_add_u32 s76,s76,s55
s_cmp_lt_u32 s60,64
s_cselect_b32 s76,s76,0x7fff0000
s_add_u32 s60,s63,2
s_lshl_b32 s12,s60,21
s_lshl_b32 s55,s60,13
s_and_b32 s55,s55,0x2000
s_xor_b32 s55,s55,s61
s_add_u32 s12,s12,s55
s_cmp_lt_u32 s60,64
s_cselect_b32 s12,s12,0x7fff0000
s_add_u32 s55,s63,5
s_min_u32 s55,s55,63
s_lshl_b32 s55,s55,16
s_lshl_b32 s60,s59,11
s_add_u32 s80,s55,s60
s_add_u32 s80,s80,57344
v_mov_b32 v176,0
v_mov_b32 v177,0
v_mov_b32 v178,0
v_mov_b32 v179,0
v_mov_b32 v180,0
v_mov_b32 v181,0
v_mov_b32 v182,0
v_mov_b32 v183,0
s_waitcnt vmcnt(0) lgkmcnt(0)
s_barrier
pn1_148:
ds_read_b128 v[64:67],v20 offset:0
ds_read_b128 v[68:71],v20 offset:1024
ds_read_b128 v[72:75],v20 offset:2048
s_waitcnt lgkmcnt(2)
v_mfma_f32_16x16x32_bf16 v[192:195],a[0:3],v[64:67],0
ds_read_b128 v[76:79],v20 offset:3072
v_mfma_f32_16x16x32_bf16 v[200:203],v[64:67],a[128:131],0
s_waitcnt lgkmcnt(2)
v_mfma_f32_16x16x32_bf16 v[196:199],a[0:3],v[68:71],0
ds_read_b128 v[64:67],v20 offset:4096
v_mfma_f32_16x16x32_bf16 v[204:207],v[68:71],a[128:131],0
s_waitcnt lgkmcnt(2)
v_mfma_f32_16x16x32_bf16 v[192:195],a[4:7],v[72:75],v[192:195]
ds_read_b128 v[68:71],v20 offset:5120
v_mfma_f32_16x16x32_bf16 v[200:203],v[72:75],a[132:135],v[200:203]
s_waitcnt lgkmcnt(2)
v_mfma_f32_16x16x32_bf16 v[196:199],a[4:7],v[76:79],v[196:199]
ds_read_b128 v[72:75],v20 offset:6144
v_mfma_f32_16x16x32_bf16 v[204:207],v[76:79],a[132:135],v[204:207]
s_waitcnt lgkmcnt(2)
v_mfma_f32_16x16x32_bf16 v[192:195],a[8:11],v[64:67],v[192:195]
ds_read_b128 v[76:79],v20 offset:7168
v_mfma_f32_16x16x32_bf16 v[200:203],v[64:67],a[136:139],v[200:203]
s_waitcnt lgkmcnt(2)
v_mfma_f32_16x16x32_bf16 v[196:199],a[8:11],v[68:71],v[196:199]
ds_read_b128 v[64:67],v20 offset:8192
v_mfma_f32_16x16x32_bf16 v[204:207],v[68:71],a[136:139],v[204:207]
s_waitcnt lgkmcnt(2)
v_mfma_f32_16x16x32_bf16 v[192:195],a[12:15],v[72:75],v[192:195]
ds_read_b128 v[68:71],v20 offset:9216
v_mfma_f32_16x16x32_bf16 v[200:203],v[72:75],a[140:143],v[200:203]
s_waitcnt lgkmcnt(2)
v_mfma_f32_16x16x32_bf16 v[196:199],a[12:15],v[76:79],v[196:199]
ds_read_b128 v[72:75],v20 offset:10240
v_mfma_f32_16x16x32_bf16 v[204:207],v[76:79],a[140:143],v[204:207]
s_waitcnt lgkmcnt(2)
v_mfma_f32_16x16x32_bf16 v[192:195],a[16:19],v[64:67],v[192:195]
ds_read_b128 v[76:79],v20 offset:11264
v_mfma_f32_16x16x32_bf16 v[200:203],v[64:67],a[144:147],v[200:203]
s_waitcnt lgkmcnt(2)
v_mfma_f32_16x16x32_bf16 v[196:199],a[16:19],v[68:71],v[196:199]
ds_read_b128 v[64:67],v20 offset:12288
v_mfma_f32_16x16x32_bf16 v[204:207],v[68:71],a[144:147],v[204:207]
s_waitcnt lgkmcnt(2)
v_mfma_f32_16x16x32_bf16 v[192:195],a[20:23],v[72:75],v[192:195]
ds_read_b128 v[68:71],v20 offset:13312
v_mfma_f32_16x16x32_bf16 v[200:203],v[72:75],a[148:151],v[200:203]
s_waitcnt lgkmcnt(2)
v_mfma_f32_16x16x32_bf16 v[196:199],a[20:23],v[76:79],v[196:199]
ds_read_b128 v[72:75],v20 offset:14336
v_mfma_f32_16x16x32_bf16 v[204:207],v[76:79],a[148:151],v[204:207]
s_waitcnt lgkmcnt(2)
v_mfma_f32_16x16x32_bf16 v[192:195],a[24:27],v[64:67],v[192:195]
ds_read_b128 v[76:79],v20 offset:15360
v_mfma_f32_16x16x32_bf16 v[200:203],v[64:67],a[152:155],v[200:203]
s_waitcnt lgkmcnt(2)
v_mfma_f32_16x16x32_bf16 v[196:199],a[24:27],v[68:71],v[196:199]
ds_read_b128 v[64:67],v20 offset:16384
v_mfma_f32_16x16x32_bf16 v[204:207],v[68:71],a[152:155],v[204:207]
s_waitcnt lgkmcnt(2)
v_mfma_f32_16x16x32_bf16 v[192:195],a[28:31],v[72:75],v[192:195]
ds_read_b128 v[68:71],v20 offset:17408
v_mfma_f32_16x16x32_bf16 v[200:203],v[72:75],a[156:159],v[200:203]
s_waitcnt lgkmcnt(2)
v_mfma_f32_16x16x32_bf16 v[196:199],a[28:31],v[76:79],v[196:199]
ds_read_b128 v[72:75],v20 offset:18432
v_mfma_f32_16x16x32_bf16 v[204:207],v[76:79],a[156:159],v[204:207]
s_waitcnt lgkmcnt(2)
v_mfma_f32_16x16x32_bf16 v[192:195],a[32:35],v[64:67],v[192:195]
ds_read_b128 v[76:79],v20 offset:19456
v_mfma_f32_16x16x32_bf16 v[200:203],v[64:67],a[160:163],v[200:203]
s_waitcnt lgkmcnt(2)
v_mfma_f32_16x16x32_bf16 v[196:199],a[32:35],v[68:71],v[196:199]
ds_read_b128 v[64:67],v20 offset:20480
v_mfma_f32_16x16x32_bf16 v[204:207],v[68:71],a[160:163],v[204:207]
s_waitcnt lgkmcnt(2)
v_mfma_f32_16x16x32_bf16 v[192:195],a[36:39],v[72:75],v[192:195]
ds_read_b128 v[68:71],v20 offset:21504
v_mfma_f32_16x16x32_bf16 v[200:203],v[72:75],a[164:167],v[200:203]
s_waitcnt lgkmcnt(2)
v_mfma_f32_16x16x32_bf16 v[196:199],a[36:39],v[76:79],v[196:199]
ds_read_b128 v[72:75],v20 offset:22528
v_mfma_f32_16x16x32_bf16 v[204:207],v[76:79],a[164:167],v[204:207]
s_waitcnt lgkmcnt(2)
v_mfma_f32_16x16x32_bf16 v[192:195],a[40:43],v[64:67],v[192:195]
ds_read_b128 v[76:79],v20 offset:23552
v_mfma_f32_16x16x32_bf16 v[200:203],v[64:67],a[168:171],v[200:203]
s_waitcnt lgkmcnt(2)
v_mfma_f32_16x16x32_bf16 v[196:199],a[40:43],v[68:71],v[196:199]
ds_read_b128 v[64:67],v20 offset:24576
v_mfma_f32_16x16x32_bf16 v[204:207],v[68:71],a[168:171],v[204:207]
s_waitcnt lgkmcnt(2)
v_mfma_f32_16x16x32_bf16 v[192:195],a[44:47],v[72:75],v[192:195]
ds_read_b128 v[68:71],v20 offset:25600
v_mfma_f32_16x16x32_bf16 v[200:203],v[72:75],a[172:175],v[200:203]
s_waitcnt lgkmcnt(2)
v_mfma_f32_16x16x32_bf16 v[196:199],a[44:47],v[76:79],v[196:199]
ds_read_b128 v[72:75],v20 offset:26624
v_mfma_f32_16x16x32_bf16 v[204:207],v[76:79],a[172:175],v[204:207]
s_waitcnt lgkmcnt(2)
v_mfma_f32_16x16x32_bf16 v[192:195],a[48:51],v[64:67],v[192:195]
ds_read_b128 v[76:79],v20 offset:27648
v_mfma_f32_16x16x32_bf16 v[200:203],v[64:67],a[176:179],v[200:203]
s_waitcnt lgkmcnt(2)
v_mfma_f32_16x16x32_bf16 v[196:199],a[48:51],v[68:71],v[196:199]
ds_read_b128 v[64:67],v20 offset:28672
v_mfma_f32_16x16x32_bf16 v[204:207],v[68:71],a[176:179],v[204:207]
s_waitcnt lgkmcnt(2)
v_mfma_f32_16x16x32_bf16 v[192:195],a[52:55],v[72:75],v[192:195]
ds_read_b128 v[68:71],v20 offset:29696
v_mfma_f32_16x16x32_bf16 v[200:203],v[72:75],a[180:183],v[200:203]
s_waitcnt lgkmcnt(2)
v_mfma_f32_16x16x32_bf16 v[196:199],a[52:55],v[76:79],v[196:199]
ds_read_b128 v[72:75],v20 offset:30720
v_mfma_f32_16x16x32_bf16 v[204:207],v[76:79],a[180:183],v[204:207]
s_waitcnt lgkmcnt(2)
v_mfma_f32_16x16x32_bf16 v[192:195],a[56:59],v[64:67],v[192:195]
ds_read_b128 v[76:79],v20 offset:31744
v_mfma_f32_16x16x32_bf16 v[200:203],v[64:67],a[184:187],v[200:203]
s_waitcnt lgkmcnt(2)
v_mfma_f32_16x16x32_bf16 v[196:199],a[56:59],v[68:71],v[196:199]
ds_read_b128 v[64:67],v20 offset:32768
v_mfma_f32_16x16x32_bf16 v[204:207],v[68:71],a[184:187],v[204:207]
s_waitcnt lgkmcnt(2)
v_mfma_f32_16x16x32_bf16 v[192:195],a[60:63],v[72:75],v[192:195]
ds_read_b128 v[68:71],v20 offset:33792
v_mfma_f32_16x16x32_bf16 v[200:203],v[72:75],a[188:191],v[200:203]
s_waitcnt lgkmcnt(2)
v_mfma_f32_16x16x32_bf16 v[196:199],a[60:63],v[76:79],v[196:199]
ds_read_b128 v[72:75],v20 offset:34816
v_mfma_f32_16x16x32_bf16 v[204:207],v[76:79],a[188:191],v[204:207]
s_waitcnt lgkmcnt(2)
v_mfma_f32_16x16x32_bf16 v[192:195],a[64:67],v[64:67],v[192:195]
ds_read_b128 v[76:79],v20 offset:35840
v_mfma_f32_16x16x32_bf16 v[200:203],v[64:67],a[192:195],v[200:203]
s_waitcnt lgkmcnt(2)
v_mfma_f32_16x16x32_bf16 v[196:199],a[64:67],v[68:71],v[196:199]
ds_read_b128 v[64:67],v20 offset:36864
v_mfma_f32_16x16x32_bf16 v[204:207],v[68:71],a[192:195],v[204:207]
s_waitcnt lgkmcnt(2)
v_mfma_f32_16x16x32_bf16 v[192:195],a[68:71],v[72:75],v[192:195]
ds_read_b128 v[68:71],v20 offset:37888
v_mfma_f32_16x16x32_bf16 v[200:203],v[72:75],a[196:199],v[200:203]
s_waitcnt lgkmcnt(2)
v_mfma_f32_16x16x32_bf16 v[196:199],a[68:71],v[76:79],v[196:199]
ds_read_b128 v[72:75],v20 offset:38912
v_mfma_f32_16x16x32_bf16 v[204:207],v[76:79],a[196:199],v[204:207]
s_waitcnt lgkmcnt(2)
v_mfma_f32_16x16x32_bf16 v[192:195],a[72:75],v[64:67],v[192:195]
ds_read_b128 v[76:79],v20 offset:39936
v_mfma_f32_16x16x32_bf16 v[200:203],v[64:67],a[200:203],v[200:203]
s_waitcnt lgkmcnt(2)
v_mfma_f32_16x16x32_bf16 v[196:199],a[72:75],v[68:71],v[196:199]
ds_read_b128 v[64:67],v20 offset:40960
v_mfma_f32_16x16x32_bf16 v[204:207],v[68:71],a[200:203],v[204:207]
s_waitcnt lgkmcnt(2)
v_mfma_f32_16x16x32_bf16 v[192:195],a[76:79],v[72:75],v[192:195]
ds_read_b128 v[68:71],v20 offset:41984
v_mfma_f32_16x16x32_bf16 v[200:203],v[72:75],a[204:207],v[200:203]
s_waitcnt lgkmcnt(2)
v_mfma_f32_16x16x32_bf16 v[196:199],a[76:79],v[76:79],v[196:199]
ds_read_b128 v[72:75],v20 offset:43008
v_mfma_f32_16x16x32_bf16 v[204:207],v[76:79],a[204:207],v[204:207]
s_waitcnt lgkmcnt(2)
v_mfma_f32_16x16x32_bf16 v[192:195],a[80:83],v[64:67],v[192:195]
ds_read_b128 v[76:79],v20 offset:44032
v_mfma_f32_16x16x32_bf16 v[200:203],v[64:67],a[208:211],v[200:203]
s_waitcnt lgkmcnt(2)
v_mfma_f32_16x16x32_bf16 v[196:199],a[80:83],v[68:71],v[196:199]
ds_read_b128 v[64:67],v20 offset:45056
v_mfma_f32_16x16x32_bf16 v[204:207],v[68:71],a[208:211],v[204:207]
s_waitcnt lgkmcnt(2)
v_mfma_f32_16x16x32_bf16 v[192:195],a[84:87],v[72:75],v[192:195]
ds_read_b128 v[68:71],v20 offset:46080
v_mfma_f32_16x16x32_bf16 v[200:203],v[72:75],a[212:215],v[200:203]
s_waitcnt lgkmcnt(2)
v_mfma_f32_16x16x32_bf16 v[196:199],a[84:87],v[76:79],v[196:199]
ds_read_b128 v[72:75],v20 offset:47104
v_mfma_f32_16x16x32_bf16 v[204:207],v[76:79],a[212:215],v[204:207]
s_waitcnt lgkmcnt(2)
v_mfma_f32_16x16x32_bf16 v[192:195],a[88:91],v[64:67],v[192:195]
ds_read_b128 v[76:79],v20 offset:48128
v_mfma_f32_16x16x32_bf16 v[200:203],v[64:67],a[216:219],v[200:203]
s_waitcnt lgkmcnt(2)
v_mfma_f32_16x16x32_bf16 v[196:199],a[88:91],v[68:71],v[196:199]
ds_read_b128 v[64:67],v20 offset:49152
v_mfma_f32_16x16x32_bf16 v[204:207],v[68:71],a[216:219],v[204:207]
s_waitcnt lgkmcnt(2)
v_mfma_f32_16x16x32_bf16 v[192:195],a[92:95],v[72:75],v[192:195]
ds_read_b128 v[68:71],v20 offset:50176
v_mfma_f32_16x16x32_bf16 v[200:203],v[72:75],a[220:223],v[200:203]
s_waitcnt lgkmcnt(2)
v_mfma_f32_16x16x32_bf16 v[196:199],a[92:95],v[76:79],v[196:199]
ds_read_b128 v[72:75],v20 offset:51200
v_mfma_f32_16x16x32_bf16 v[204:207],v[76:79],a[220:223],v[204:207]
s_waitcnt lgkmcnt(2)
v_mfma_f32_16x16x32_bf16 v[192:195],a[96:99],v[64:67],v[192:195]
ds_read_b128 v[76:79],v20 offset:52224
v_mfma_f32_16x16x32_bf16 v[200:203],v[64:67],a[224:227],v[200:203]
s_waitcnt lgkmcnt(2)
v_mfma_f32_16x16x32_bf16 v[196:199],a[96:99],v[68:71],v[196:199]
ds_read_b128 v[64:67],v20 offset:53248
v_mfma_f32_16x16x32_bf16 v[204:207],v[68:71],a[224:227],v[204:207]
s_waitcnt lgkmcnt(2)
v_mfma_f32_16x16x32_bf16 v[192:195],a[100:103],v[72:75],v[192:195]
ds_read_b128 v[68:71],v20 offset:54272
v_mfma_f32_16x16x32_bf16 v[200:203],v[72:75],a[228:231],v[200:203]
s_waitcnt lgkmcnt(2)
v_mfma_f32_16x16x32_bf16 v[196:199],a[100:103],v[76:79],v[196:199]
ds_read_b128 v[72:75],v20 offset:55296
v_mfma_f32_16x16x32_bf16 v[204:207],v[76:79],a[228:231],v[204:207]
s_waitcnt lgkmcnt(2)
v_mfma_f32_16x16x32_bf16 v[192:195],a[104:107],v[64:67],v[192:195]
ds_read_b128 v[76:79],v20 offset:56320
v_mfma_f32_16x16x32_bf16 v[200:203],v[64:67],a[232:235],v[200:203]
s_waitcnt lgkmcnt(2)
v_mfma_f32_16x16x32_bf16 v[196:199],a[104:107],v[68:71],v[196:199]
ds_read_b128 v[64:67],v20 offset:57344
v_mfma_f32_16x16x32_bf16 v[204:207],v[68:71],a[232:235],v[204:207]
s_waitcnt lgkmcnt(2)
v_mfma_f32_16x16x32_bf16 v[192:195],a[108:111],v[72:75],v[192:195]
ds_read_b128 v[68:71],v20 offset:58368
v_mfma_f32_16x16x32_bf16 v[200:203],v[72:75],a[236:239],v[200:203]
s_waitcnt lgkmcnt(2)
v_mfma_f32_16x16x32_bf16 v[196:199],a[108:111],v[76:79],v[196:199]
ds_read_b128 v[72:75],v20 offset:59392
v_mfma_f32_16x16x32_bf16 v[204:207],v[76:79],a[236:239],v[204:207]
s_waitcnt lgkmcnt(2)
v_mfma_f32_16x16x32_bf16 v[192:195],a[112:115],v[64:67],v[192:195]
ds_read_b128 v[76:79],v20 offset:60416
v_mfma_f32_16x16x32_bf16 v[200:203],v[64:67],a[240:243],v[200:203]
s_waitcnt lgkmcnt(2)
v_mfma_f32_16x16x32_bf16 v[196:199],a[112:115],v[68:71],v[196:199]
ds_read_b128 v[64:67],v20 offset:61440
v_mfma_f32_16x16x32_bf16 v[204:207],v[68:71],a[240:243],v[204:207]
s_waitcnt lgkmcnt(2)
v_mfma_f32_16x16x32_bf16 v[192:195],a[116:119],v[72:75],v[192:195]
ds_read_b128 v[68:71],v20 offset:62464
v_mfma_f32_16x16x32_bf16 v[200:203],v[72:75],a[244:247],v[200:203]
s_waitcnt lgkmcnt(2)
v_mfma_f32_16x16x32_bf16 v[196:199],a[116:119],v[76:79],v[196:199]
ds_read_b128 v[72:75],v20 offset:63488
v_mfma_f32_16x16x32_bf16 v[204:207],v[76:79],a[244:247],v[204:207]
s_waitcnt lgkmcnt(2)
v_mfma_f32_16x16x32_bf16 v[192:195],a[120:123],v[64:67],v[192:195]
ds_read_b128 v[76:79],v20 offset:64512
v_mfma_f32_16x16x32_bf16 v[200:203],v[64:67],a[248:251],v[200:203]
s_waitcnt lgkmcnt(2)
v_mfma_f32_16x16x32_bf16 v[196:199],a[120:123],v[68:71],v[196:199]
v_mfma_f32_16x16x32_bf16 v[204:207],v[68:71],a[248:251],v[204:207]
s_waitcnt lgkmcnt(1)
v_mfma_f32_16x16x32_bf16 v[192:195],a[124:127],v[72:75],v[192:195]
v_mfma_f32_16x16x32_bf16 v[200:203],v[72:75],a[252:255],v[200:203]
s_waitcnt lgkmcnt(0)
v_mfma_f32_16x16x32_bf16 v[196:199],a[124:127],v[76:79],v[196:199]
v_mfma_f32_16x16x32_bf16 v[204:207],v[76:79],a[252:255],v[204:207]
v_xor_b32 v20,0x10000,v20
s_xor_b32 s62,s62,0x10000
s_lshr_b32 s64,s73,9
v_add_u32 v22,s64,v24
v_cvt_pk_bf16_f32 v208,v192,v193
v_cvt_pk_bf16_f32 v209,v194,v195
s_nop 0
v_cvt_pk_bf16_f32 v210,v196,v197
v_cvt_pk_bf16_f32 v211,v198,v199
v_cvt_pk_bf16_f32 v212,v200,v201
v_cvt_pk_bf16_f32 v213,v202,v203
v_cvt_pk_bf16_f32 v214,v204,v205
v_cvt_pk_bf16_f32 v215,v206,v207
v_permlane16_swap_b32 v208,v210
v_permlane16_swap_b32 v209,v211
buffer_store_dwordx4 v[208:211],v2,s[24:27],s73 offen
buffer_store_dwordx4 v[208:211],v2,s[28:31],s73 offen sc1
ds_write_b128 v22,v[212:215] offset:17408
buffer_store_dwordx4 v[208:211],v17,s[20:23],s12 offen sc1
bgx_150:
s_add_u32 s63,s79,1
s_and_b32 s64,s63,3
s_lshl_b32 s70,s64,20
s_add_u32 s65,s63,2
s_and_b32 s65,s65,3
s_lshl_b32 s73,s65,20
s_add_u32 s55,s63,3
s_lshl_b32 s78,s55,16
s_add_u32 s78,s78,57344
s_cmp_lt_u32 s55,64
s_cselect_b32 s78,s78,0x7fff0000
s_add_u32 s60,s63,1
s_lshl_b32 s76,s60,21
s_lshl_b32 s55,s60,13
s_and_b32 s55,s55,0x2000
s_xor_b32 s55,s55,s61
s_add_u32 s76,s76,s55
s_cmp_lt_u32 s60,64
s_cselect_b32 s76,s76,0x7fff0000
s_add_u32 s60,s63,2
s_lshl_b32 s12,s60,21
s_lshl_b32 s55,s60,13
s_and_b32 s55,s55,0x2000
s_xor_b32 s55,s55,s61
s_add_u32 s12,s12,s55
s_cmp_lt_u32 s60,64
s_cselect_b32 s12,s12,0x7fff0000
s_add_u32 s55,s63,5
s_min_u32 s55,s55,63
s_lshl_b32 s55,s55,16
s_lshl_b32 s60,s59,11
s_add_u32 s80,s55,s60
s_add_u32 s80,s80,57344
v_mov_b32 v176,0
v_mov_b32 v177,0
v_mov_b32 v178,0
v_mov_b32 v179,0
v_mov_b32 v180,0
v_mov_b32 v181,0
v_mov_b32 v182,0
v_mov_b32 v183,0
s_add_u32 s79,s79,1
s_cmp_eq_u32 s79,0
s_cbranch_scc1 pn2_149
v_mov_b32 v38,1
ds_write_b32 v37,v38 offset:12
buffer_store_dwordx4 v[212:215],v12,s[20:23],s76 offen sc1
s_waitcnt lgkmcnt(0)
s_branch pn1_148
pn2_149:
v_mov_b32 v25,1
s_waitcnt vmcnt(1) lgkmcnt(0)
s_barrier
s_branch loop_136
w3_61:
v_xor_b32 v9,0x10000,v8
v_xor_b32 v10,0x20000,v8
v_xor_b32 v11,0x30000,v8
v_and_b32 v22,2,v4
v_lshrrev_b32 v23,3,v3
v_add_u32 v22,v22,v23
v_lshlrev_b32 v22,3,v22
v_and_b32 v23,1,v4
v_lshl_add_u32 v22,v23,2,v22
v_and_b32 v23,3,v3
v_add_u32 v22,v22,v23
v_lshlrev_b32 v22,4,v22
v_bfe_u32 v23,v3,2,1
v_lshl_add_u32 v22,v23,3,v22
v_add_u32 v30,s66,v22
v_and_b32 v22,7,v3
v_lshl_add_u32 v12,v4,3,v22
v_lshlrev_b32 v12,4,v12
v_add_u32 v12,s66,v12
s_branch first_151
loop_152:
s_barrier
buffer_load_dword v248,v18,s[20:23],s70 offen offset:0 sc1
s_nop 15
s_nop 5
hl_154:
buffer_load_dword v249,v18,s[20:23],s70 offen offset:0 sc1
s_waitcnt vmcnt(1)
v_cmp_eq_u32 vcc,v25,v248
s_bcnt1_i32_b32 s64,vcc_lo
s_cmp_ge_u32 s64,8
s_cbranch_scc1 hg_155
buffer_load_dword v248,v18,s[20:23],s70 offen offset:0 sc1
s_waitcnt vmcnt(1)
v_cmp_eq_u32 vcc,v25,v249
s_bcnt1_i32_b32 s64,vcc_lo
s_cmp_ge_u32 s64,8
s_cbranch_scc1 hg_155
s_sub_u32 s90,s90,1
s_cmp_gt_i32 s90,0
s_cbranch_scc1 hl_154
hg_155:
buffer_load_dwordx4 v[80:83],v29,s[20:23],s70 offen offset:0 sc1
buffer_load_dwordx4 v[84:87],v29,s[20:23],s70 offen offset:1024 sc1
buffer_load_dwordx4 v[88:91],v29,s[20:23],s70 offen offset:2048 sc1
buffer_load_dwordx4 v[92:95],v29,s[20:23],s70 offen offset:3072 sc1
s_waitcnt vmcnt(3)
ds_write_b128 v24,v[80:83] offset:12288
v_min3_u32 v22,v80,v81,v82
v_min_u32 v22,v22,v83
s_waitcnt vmcnt(2)
ds_write_b128 v24,v[84:87] offset:13312
v_min3_u32 v22,v22,v84,v85
v_min3_u32 v22,v22,v86,v87
s_waitcnt vmcnt(1)
ds_write_b128 v24,v[88:91] offset:14336
v_min3_u32 v22,v22,v88,v89
v_min3_u32 v22,v22,v90,v91
s_waitcnt vmcnt(0)
ds_write_b128 v24,v[92:95] offset:15360
v_min3_u32 v22,v22,v92,v93
v_min3_u32 v22,v22,v94,v95
v_cmp_eq_u32 vcc,0,v22
s_cbranch_vccnz art_156
abk_157:
v_smfmac_f32_16x16x64_bf16 v[176:179],v[80:83],a[96:103],v14
s_waitcnt lgkmcnt(0)
s_barrier
ds_read_b128 v[32:35],v24 offset:0
ds_read_b128 v[36:39],v24 offset:1024
ds_read_b128 v[40:43],v24 offset:2048
ds_read_b128 v[44:47],v24 offset:3072
v_smfmac_f32_16x16x64_bf16 v[176:179],v[84:87],a[104:111],v14
ds_read_b128 v[48:51],v24 offset:4096
ds_read_b128 v[52:55],v24 offset:5120
v_smfmac_f32_16x16x64_bf16 v[176:179],v[88:91],a[112:119],v14
ds_read_b128 v[56:59],v24 offset:6144
ds_read_b128 v[60:63],v24 offset:7168
v_smfmac_f32_16x16x64_bf16 v[176:179],v[92:95],a[120:127],v14
ds_read_b128 v[64:67],v24 offset:8192
ds_read_b128 v[68:71],v24 offset:9216
s_waitcnt lgkmcnt(9)
v_smfmac_f32_16x16x64_bf16 v[176:179],v[32:35],a[0:7],v14
ds_read_b128 v[72:75],v24 offset:10240
s_waitcnt lgkmcnt(9)
v_smfmac_f32_16x16x64_bf16 v[176:179],v[36:39],a[8:15],v14
ds_read_b128 v[76:79],v24 offset:11264
s_waitcnt lgkmcnt(9)
v_smfmac_f32_16x16x64_bf16 v[176:179],v[40:43],a[16:23],v14
s_waitcnt lgkmcnt(8)
v_smfmac_f32_16x16x64_bf16 v[176:179],v[44:47],a[24:31],v14
s_waitcnt lgkmcnt(7)
v_smfmac_f32_16x16x64_bf16 v[176:179],v[48:51],a[32:39],v14
s_waitcnt lgkmcnt(6)
v_smfmac_f32_16x16x64_bf16 v[176:179],v[52:55],a[40:47],v14
s_waitcnt lgkmcnt(5)
v_smfmac_f32_16x16x64_bf16 v[176:179],v[56:59],a[48:55],v14
s_waitcnt lgkmcnt(4)
v_smfmac_f32_16x16x64_bf16 v[176:179],v[60:63],a[56:63],v14
s_waitcnt lgkmcnt(3)
v_smfmac_f32_16x16x64_bf16 v[176:179],v[64:67],a[64:71],v14
s_waitcnt lgkmcnt(2)
v_smfmac_f32_16x16x64_bf16 v[176:179],v[68:71],a[72:79],v14
s_waitcnt lgkmcnt(1)
v_smfmac_f32_16x16x64_bf16 v[176:179],v[72:75],a[80:87],v14
s_waitcnt lgkmcnt(0)
v_smfmac_f32_16x16x64_bf16 v[176:179],v[76:79],a[88:95],v14
s_nop 7
v_permlane32_swap_b32 v176,v178
v_permlane32_swap_b32 v177,v179
v_add_f32 v176,v176,v178
v_add_f32 v177,v177,v179
v_cvt_pk_bf16_f32 v216,v176,v177
s_nop 1
v_mov_b32_dpp v217,v216 quad_perm:[1,0,3,2] row_mask:0xf bank_mask:0xf
v_perm_b32 v216,v217,v216,v15
v_max_u32 v216,1,v216
buffer_store_dword v216,v19,s[24:27],s70 offen
buffer_store_dword v216,v19,s[28:31],s70 offen sc1
s_cmp_eq_u32 s79,63
s_cbranch_scc1 end_57
s_nop 15
s_nop 15
s_nop 15
s_nop 11
s_add_u32 m0,s62,53248
s_add_u32 s69,s78,53248
buffer_load_dwordx4 v16,s[20:23],s69 offen offset:0 lds
s_nop 3
buffer_load_dwordx4 v16,s[20:23],s69 offen offset:1024 lds
s_nop 3
buffer_load_dwordx4 v16,s[20:23],s69 offen offset:2048 lds
s_nop 3
buffer_load_dwordx4 v16,s[20:23],s69 offen offset:3072 lds
s_nop 3
s_add_u32 m0,s62,57344
s_add_u32 s69,s78,57344
buffer_load_dwordx4 v16,s[20:23],s69 offen offset:0 lds
s_nop 3
buffer_load_dwordx4 v16,s[20:23],s69 offen offset:1024 lds
s_nop 3
buffer_load_dwordx4 v16,s[20:23],s69 offen offset:2048 lds
s_nop 3
buffer_load_dwordx4 v16,s[20:23],s69 offen offset:3072 lds
s_nop 3
s_add_u32 m0,s62,61440
s_add_u32 s69,s78,61440
buffer_load_dwordx4 v16,s[20:23],s69 offen offset:0 lds
s_nop 3
buffer_load_dwordx4 v16,s[20:23],s69 offen offset:1024 lds
s_nop 3
buffer_load_dwordx4 v16,s[20:23],s69 offen offset:2048 lds
s_nop 3
buffer_load_dwordx4 v16,s[20:23],s69 offen offset:3072 lds
s_nop 3
s_xor_b32 s62,s62,0x10000
wf_158:
ds_read_b32 v23,v21 offset:8
s_sub_u32 s90,s90,1
s_waitcnt lgkmcnt(0)
v_cmp_ne_u32 vcc,v23,v25
s_cmp_lt_i32 s90,0
s_cselect_b64 vcc,0,vcc
s_cbranch_vccnz wf_158
hl_159:
buffer_load_dword v248,v18,s[20:23],s70 offen offset:512 sc1
s_waitcnt vmcnt(0)
v_cmp_eq_u32 vcc,v25,v248
s_bcnt1_i32_b32 s64,vcc_lo
s_cmp_ge_u32 s64,16
s_cbranch_scc1 hg_160
s_sub_u32 s90,s90,1
s_cmp_gt_i32 s90,0
s_cbranch_scc1 hl_159
hg_160:
buffer_load_dwordx4 v[32:35],v28,s[20:23],s71 offen offset:0 sc1
buffer_load_dwordx4 v[36:39],v28,s[20:23],s71 offen offset:1024 sc1
buffer_load_dwordx4 v[40:43],v28,s[20:23],s71 offen offset:2048 sc1
buffer_load_dwordx4 v[44:47],v28,s[20:23],s71 offen offset:3072 sc1
buffer_load_dwordx4 v[48:51],v29,s[20:23],s71 offen offset:0 sc1
buffer_load_dwordx4 v[52:55],v29,s[20:23],s71 offen offset:1024 sc1
buffer_load_dwordx4 v[56:59],v29,s[20:23],s71 offen offset:2048 sc1
buffer_load_dwordx4 v[60:63],v29,s[20:23],s71 offen offset:3072 sc1
s_mov_b32 s68,0
s_waitcnt vmcnt(6)
v_smfmac_f32_16x16x64_bf16 v[184:187],v[32:35],a[128:135],v14
v_min3_u32 v22,v32,v33,v34
v_min3_u32 v22,v22,v35,v36
v_smfmac_f32_16x16x64_bf16 v[188:191],v[32:35],a[136:143],v14
v_min3_u32 v22,v22,v37,v38
v_smfmac_f32_16x16x64_bf16 v[184:187],v[36:39],a[144:151],v14
v_min_u32 v22,v22,v39
v_smfmac_f32_16x16x64_bf16 v[188:191],v[36:39],a[152:159],v14
v_cmp_eq_u32 s[52:53],0,v22
s_waitcnt vmcnt(4)
v_smfmac_f32_16x16x64_bf16 v[184:187],v[40:43],a[160:167],v14
v_min3_u32 v22,v40,v41,v42
s_cmp_lg_u64 s[52:53],0
v_smfmac_f32_16x16x64_bf16 v[188:191],v[40:43],a[168:175],v14
s_cbranch_scc1 ms_161
bk_162:
v_min3_u32 v22,v22,v43,v44
v_smfmac_f32_16x16x64_bf16 v[184:187],v[44:47],a[176:183],v14
v_min3_u32 v22,v22,v45,v46
v_min_u32 v22,v22,v47
v_smfmac_f32_16x16x64_bf16 v[188:191],v[44:47],a[184:191],v14
v_cmp_eq_u32 s[54:55],0,v22
s_waitcnt vmcnt(2)
v_smfmac_f32_16x16x64_bf16 v[184:187],v[48:51],a[192:199],v14
v_min3_u32 v22,v48,v49,v50
s_cmp_lg_u64 s[54:55],0
v_smfmac_f32_16x16x64_bf16 v[188:191],v[48:51],a[200:207],v14
s_cbranch_scc1 ms_163
bk_164:
v_min3_u32 v22,v22,v51,v52
v_smfmac_f32_16x16x64_bf16 v[184:187],v[52:55],a[208:215],v14
v_min3_u32 v22,v22,v53,v54
v_min_u32 v22,v22,v55
v_smfmac_f32_16x16x64_bf16 v[188:191],v[52:55],a[216:223],v14
v_cmp_eq_u32 s[52:53],0,v22
s_waitcnt vmcnt(0)
v_smfmac_f32_16x16x64_bf16 v[184:187],v[56:59],a[224:231],v14
v_min3_u32 v22,v56,v57,v58
s_cmp_lg_u64 s[52:53],0
v_smfmac_f32_16x16x64_bf16 v[188:191],v[56:59],a[232:239],v14
s_cbranch_scc1 ms_165
bk_166:
v_min3_u32 v22,v22,v59,v60
v_smfmac_f32_16x16x64_bf16 v[184:187],v[60:63],a[240:247],v14
v_min3_u32 v22,v22,v61,v62
v_min_u32 v22,v22,v63
v_smfmac_f32_16x16x64_bf16 v[188:191],v[60:63],a[248:255],v14
v_cmp_eq_u32 s[54:55],0,v22
s_cmp_lg_u64 s[54:55],0
s_cbranch_scc1 ms_169
bk_170:
s_cmp_lg_u32 s68,0
s_cbranch_scc1 rl2_171
fin_167:
s_nop 2
v_permlane32_swap_b32 v184,v188
v_permlane32_swap_b32 v185,v189
v_permlane32_swap_b32 v186,v190
v_permlane32_swap_b32 v187,v191
v_pk_add_f32 v[184:185],v[184:185],v[188:189]
v_pk_add_f32 v[186:187],v[186:187],v[190:191]
wf_172:
ds_read_b32 v23,v21 offset:12
ds_read_b128 v[216:219],v24 offset:25600
s_sub_u32 s90,s90,1
s_waitcnt lgkmcnt(0)
v_cmp_ne_u32 vcc,v23,v25
s_cmp_lt_i32 s90,0
s_cselect_b64 vcc,0,vcc
v_pk_add_f32 v[216:217],v[216:217],v[184:185]
v_pk_add_f32 v[218:219],v[218:219],v[186:187]
s_cbranch_vccnz wf_172
v_max_u32 v216,1,v216
v_max_u32 v217,1,v217
v_max_u32 v218,1,v218
v_max_u32 v219,1,v219
buffer_store_dwordx4 v[216:219],v8,s[20:23],s74 offen sc1
s_mov_b32 s88,s74
s_mov_b32 s89,s72
v_add_u32 v25,1,v25
s_add_u32 s63,s79,1
s_and_b32 s64,s63,3
s_lshl_b32 s70,s64,20
s_add_u32 s65,s63,2
s_and_b32 s65,s65,3
s_lshl_b32 s73,s65,20
s_add_u32 s55,s63,3
s_lshl_b32 s78,s55,16
s_add_u32 s78,s78,57344
s_cmp_lt_u32 s55,64
s_cselect_b32 s78,s78,0x7fff0000
s_add_u32 s71,s70,65536
s_add_u32 s60,s63,1
s_and_b32 s60,s60,3
s_lshl_b32 s72,s60,20
v_mov_b32 v184,0
v_mov_b32 v185,0
v_mov_b32 v186,0
v_mov_b32 v187,0
v_mov_b32 v188,0
v_mov_b32 v189,0
v_mov_b32 v190,0
v_mov_b32 v191,0
s_lshl_b32 s74,s63,21
s_lshl_b32 s55,s63,13
s_and_b32 s55,s55,0x2000
s_xor_b32 s55,s55,s61
s_add_u32 s74,s74,s55
v_mov_b32 v176,0
v_mov_b32 v177,0
v_mov_b32 v178,0
v_mov_b32 v179,0
s_nop 15
s_nop 15
s_nop 15
s_nop 15
s_nop 15
s_nop 15
s_nop 15
pp_173:
buffer_load_dwordx4 v[32:35],v9,s[20:23],s88 offen sc1
buffer_load_dwordx4 v[36:39],v10,s[20:23],s88 offen sc1
buffer_load_dwordx4 v[40:43],v11,s[20:23],s88 offen sc1
s_waitcnt vmcnt(2)
v_min3_u32 v22,v32,v33,v34
v_pk_add_f32 v[220:221],v[216:217],v[32:33]
v_pk_add_f32 v[222:223],v[218:219],v[34:35]
s_waitcnt vmcnt(0)
v_min3_u32 v22,v22,v35,v36
v_min3_u32 v22,v22,v37,v38
v_min3_u32 v22,v22,v39,v40
v_min3_u32 v22,v22,v41,v42
v_min_u32 v22,v22,v43
v_pk_add_f32 v[36:37],v[36:37],v[40:41]
v_cmp_eq_u32 vcc,0,v22
v_pk_add_f32 v[38:39],v[38:39],v[42:43]
s_cbranch_vccz pok_174
s_sub_u32 s90,s90,1
s_cmp_gt_i32 s90,0
s_cbranch_scc1 pp_173
pok_174:
v_pk_add_f32 v[220:221],v[220:221],v[36:37]
v_pk_add_f32 v[222:223],v[222:223],v[38:39]
s_mov_b64 vcc,s[86:87]
v_cvt_pk_bf16_f32 v216,v220,v221
v_cvt_pk_bf16_f32 v217,v222,v223
s_nop 0
v_mov_b32_dpp v218,v216 quad_perm:[1,0,3,2] row_mask:0xf bank_mask:0xf
v_mov_b32_dpp v219,v217 quad_perm:[1,0,3,2] row_mask:0xf bank_mask:0xf
v_perm_b32 v216,v218,v216,v15
v_perm_b32 v217,v219,v217,v15
s_nop 1
v_cndmask_b32_dpp v220,v217,v216,vcc quad_perm:[2,3,0,1] row_mask:0xf bank_mask:0xf
s_not_b64 vcc,vcc
v_cndmask_b32_dpp v221,v216,v217,vcc quad_perm:[2,3,0,1] row_mask:0xf bank_mask:0xf
v_max_u32 v220,1,v220
v_max_u32 v221,1,v221
buffer_store_dwordx2 v[220:221],v30,s[24:27],s89 offen
buffer_store_dwordx2 v[220:221],v30,s[28:31],s89 offen sc1
s_mov_b64 exec,1
buffer_store_dword v25,v13,s[24:27],s89 offen
buffer_store_dword v25,v13,s[28:31],s89 offen sc1
s_mov_b64 exec,-1
s_add_u32 s79,s79,1
s_branch loop_152
art_156:
s_sub_u32 s90,s90,1
s_cmp_lt_i32 s90,0
s_cbranch_scc1 abk_157
buffer_load_dwordx4 v[80:83],v29,s[20:23],s70 offen offset:0 sc1
buffer_load_dwordx4 v[84:87],v29,s[20:23],s70 offen offset:1024 sc1
buffer_load_dwordx4 v[88:91],v29,s[20:23],s70 offen offset:2048 sc1
buffer_load_dwordx4 v[92:95],v29,s[20:23],s70 offen offset:3072 sc1
s_waitcnt vmcnt(3)
ds_write_b128 v24,v[80:83] offset:12288
v_min3_u32 v22,v80,v81,v82
v_min_u32 v22,v22,v83
s_waitcnt vmcnt(2)
ds_write_b128 v24,v[84:87] offset:13312
v_min3_u32 v22,v22,v84,v85
v_min3_u32 v22,v22,v86,v87
s_waitcnt vmcnt(1)
ds_write_b128 v24,v[88:91] offset:14336
v_min3_u32 v22,v22,v88,v89
v_min3_u32 v22,v22,v90,v91
s_waitcnt vmcnt(0)
ds_write_b128 v24,v[92:95] offset:15360
v_min3_u32 v22,v22,v92,v93
v_min3_u32 v22,v22,v94,v95
v_cmp_eq_u32 vcc,0,v22
s_cbranch_vccnz art_156
s_branch abk_157
ms_161:
s_waitcnt vmcnt(0)
buffer_load_dwordx4 v[64:67],v28,s[20:23],s71 offen offset:0 sc1
buffer_load_dwordx4 v[68:71],v28,s[20:23],s71 offen offset:1024 sc1
s_bitset1_b32 s68,0
s_branch bk_162
ms_163:
s_waitcnt vmcnt(0)
buffer_load_dwordx4 v[72:75],v28,s[20:23],s71 offen offset:2048 sc1
buffer_load_dwordx4 v[76:79],v28,s[20:23],s71 offen offset:3072 sc1
s_bitset1_b32 s68,1
s_branch bk_164
ms_165:
s_waitcnt vmcnt(0)
buffer_load_dwordx4 v[80:83],v29,s[20:23],s71 offen offset:0 sc1
buffer_load_dwordx4 v[84:87],v29,s[20:23],s71 offen offset:1024 sc1
s_bitset1_b32 s68,2
s_branch bk_166
ms_169:
s_waitcnt vmcnt(0)
buffer_load_dwordx4 v[88:91],v29,s[20:23],s71 offen offset:2048 sc1
buffer_load_dwordx4 v[92:95],v29,s[20:23],s71 offen offset:3072 sc1
s_bitset1_b32 s68,3
s_branch bk_170
rl_168:
s_bitcmp1_b32 s68,0
s_cbranch_scc0 sk_175
buffer_load_dwordx4 v[64:67],v28,s[20:23],s71 offen offset:0 sc1
buffer_load_dwordx4 v[68:71],v28,s[20:23],s71 offen offset:1024 sc1
sk_175:
s_bitcmp1_b32 s68,1
s_cbranch_scc0 sk_176
buffer_load_dwordx4 v[72:75],v28,s[20:23],s71 offen offset:2048 sc1
buffer_load_dwordx4 v[76:79],v28,s[20:23],s71 offen offset:3072 sc1
sk_176:
s_bitcmp1_b32 s68,2
s_cbranch_scc0 sk_177
buffer_load_dwordx4 v[80:83],v29,s[20:23],s71 offen offset:0 sc1
buffer_load_dwordx4 v[84:87],v29,s[20:23],s71 offen offset:1024 sc1
sk_177:
s_bitcmp1_b32 s68,3
s_cbranch_scc0 sk_178
buffer_load_dwordx4 v[88:91],v29,s[20:23],s71 offen offset:2048 sc1
buffer_load_dwordx4 v[92:95],v29,s[20:23],s71 offen offset:3072 sc1
sk_178:
rl2_171:
s_sub_u32 s90,s90,1
s_cmp_lt_i32 s90,0
s_cbranch_scc1 fin_167
s_waitcnt vmcnt(0)
s_bitcmp1_b32 s68,0
s_cbranch_scc0 sk_179
v_min3_u32 v22,v64,v65,v66
v_min3_u32 v22,v22,v67,v68
v_min3_u32 v22,v22,v69,v70
v_min_u32 v22,v22,v71
v_cmp_eq_u32 vcc,0,v22
v_xor_b32 v64,v32,v64
v_xor_b32 v65,v33,v65
v_xor_b32 v66,v34,v66
v_xor_b32 v67,v35,v67
v_xor_b32 v68,v36,v68
v_xor_b32 v69,v37,v69
v_xor_b32 v70,v38,v70
v_xor_b32 v71,v39,v71
s_cbranch_vccnz nb_180
s_bitset0_b32 s68,0
v_smfmac_f32_16x16x64_bf16 v[184:187],v[64:67],a[128:135],v14
v_smfmac_f32_16x16x64_bf16 v[188:191],v[64:67],a[136:143],v14
v_smfmac_f32_16x16x64_bf16 v[184:187],v[68:71],a[144:151],v14
v_smfmac_f32_16x16x64_bf16 v[188:191],v[68:71],a[152:159],v14
nb_180:
sk_179:
s_bitcmp1_b32 s68,1
s_cbranch_scc0 sk_181
v_min3_u32 v22,v72,v73,v74
v_min3_u32 v22,v22,v75,v76
v_min3_u32 v22,v22,v77,v78
v_min_u32 v22,v22,v79
v_cmp_eq_u32 vcc,0,v22
v_xor_b32 v72,v40,v72
v_xor_b32 v73,v41,v73
v_xor_b32 v74,v42,v74
v_xor_b32 v75,v43,v75
v_xor_b32 v76,v44,v76
v_xor_b32 v77,v45,v77
v_xor_b32 v78,v46,v78
v_xor_b32 v79,v47,v79
s_cbranch_vccnz nb_182
s_bitset0_b32 s68,1
v_smfmac_f32_16x16x64_bf16 v[184:187],v[72:75],a[160:167],v14
v_smfmac_f32_16x16x64_bf16 v[188:191],v[72:75],a[168:175],v14
v_smfmac_f32_16x16x64_bf16 v[184:187],v[76:79],a[176:183],v14
v_smfmac_f32_16x16x64_bf16 v[188:191],v[76:79],a[184:191],v14
nb_182:
sk_181:
s_bitcmp1_b32 s68,2
s_cbranch_scc0 sk_183
v_min3_u32 v22,v80,v81,v82
v_min3_u32 v22,v22,v83,v84
v_min3_u32 v22,v22,v85,v86
v_min_u32 v22,v22,v87
v_cmp_eq_u32 vcc,0,v22
v_xor_b32 v80,v48,v80
v_xor_b32 v81,v49,v81
v_xor_b32 v82,v50,v82
v_xor_b32 v83,v51,v83
v_xor_b32 v84,v52,v84
v_xor_b32 v85,v53,v85
v_xor_b32 v86,v54,v86
v_xor_b32 v87,v55,v87
s_cbranch_vccnz nb_184
s_bitset0_b32 s68,2
v_smfmac_f32_16x16x64_bf16 v[184:187],v[80:83],a[192:199],v14
v_smfmac_f32_16x16x64_bf16 v[188:191],v[80:83],a[200:207],v14
v_smfmac_f32_16x16x64_bf16 v[184:187],v[84:87],a[208:215],v14
v_smfmac_f32_16x16x64_bf16 v[188:191],v[84:87],a[216:223],v14
nb_184:
sk_183:
s_bitcmp1_b32 s68,3
s_cbranch_scc0 sk_185
v_min3_u32 v22,v88,v89,v90
v_min3_u32 v22,v22,v91,v92
v_min3_u32 v22,v22,v93,v94
v_min_u32 v22,v22,v95
v_cmp_eq_u32 vcc,0,v22
v_xor_b32 v88,v56,v88
v_xor_b32 v89,v57,v89
v_xor_b32 v90,v58,v90
v_xor_b32 v91,v59,v91
v_xor_b32 v92,v60,v92
v_xor_b32 v93,v61,v93
v_xor_b32 v94,v62,v94
v_xor_b32 v95,v63,v95
s_cbranch_vccnz nb_186
s_bitset0_b32 s68,3
v_smfmac_f32_16x16x64_bf16 v[184:187],v[88:91],a[224:231],v14
v_smfmac_f32_16x16x64_bf16 v[188:191],v[88:91],a[232:239],v14
v_smfmac_f32_16x16x64_bf16 v[184:187],v[92:95],a[240:247],v14
v_smfmac_f32_16x16x64_bf16 v[188:191],v[92:95],a[248:255],v14
nb_186:
sk_185:
s_cmp_lg_u32 s68,0
s_cbranch_scc1 rl_168
s_nop 2
s_branch fin_167
first_151:
s_waitcnt vmcnt(0) lgkmcnt(0)
s_barrier
s_add_u32 s64,s15,393216
buffer_load_dwordx4 a[176:179],v32,s[40:43],s64 offen nt
s_add_u32 s64,s15,425984
buffer_load_dwordx4 a[180:183],v32,s[40:43],s64 offen nt
s_add_u32 s64,s15,458752
buffer_load_dwordx4 a[184:187],v32,s[40:43],s64 offen nt
s_add_u32 s64,s15,491520
buffer_load_dwordx4 a[188:191],v32,s[40:43],s64 offen nt
s_add_u32 s64,s15,524288
buffer_load_dwordx4 a[192:195],v32,s[40:43],s64 offen nt
s_add_u32 s64,s15,557056
buffer_load_dwordx4 a[196:199],v32,s[40:43],s64 offen nt
s_add_u32 s64,s15,589824
buffer_load_dwordx4 a[200:203],v32,s[40:43],s64 offen nt
s_add_u32 s64,s15,622592
buffer_load_dwordx4 a[204:207],v32,s[40:43],s64 offen nt
s_add_u32 s64,s15,655360
buffer_load_dwordx4 a[208:211],v32,s[40:43],s64 offen nt
s_add_u32 s64,s15,688128
buffer_load_dwordx4 a[212:215],v32,s[40:43],s64 offen nt
s_add_u32 s64,s15,720896
buffer_load_dwordx4 a[216:219],v32,s[40:43],s64 offen nt
s_add_u32 s64,s15,753664
buffer_load_dwordx4 a[220:223],v32,s[40:43],s64 offen nt
s_add_u32 s64,s15,786432
buffer_load_dwordx4 a[224:227],v32,s[40:43],s64 offen nt
s_add_u32 s64,s15,819200
buffer_load_dwordx4 a[228:231],v32,s[40:43],s64 offen nt
s_add_u32 s64,s15,851968
buffer_load_dwordx4 a[232:235],v32,s[40:43],s64 offen nt
s_add_u32 s64,s15,884736
buffer_load_dwordx4 a[236:239],v32,s[40:43],s64 offen nt
s_add_u32 s64,s15,917504
buffer_load_dwordx4 a[240:243],v32,s[40:43],s64 offen nt
s_add_u32 s64,s15,950272
buffer_load_dwordx4 a[244:247],v32,s[40:43],s64 offen nt
s_add_u32 s64,s15,983040
buffer_load_dwordx4 a[248:251],v32,s[40:43],s64 offen nt
s_add_u32 s64,s15,1015808
buffer_load_dwordx4 a[252:255],v32,s[40:43],s64 offen nt
ds_write_b128 v33,a[0:3] offset:0
ds_write_b128 v33,a[4:7] offset:1024
ds_write_b128 v33,a[8:11] offset:2048
ds_write_b128 v33,a[12:15] offset:3072
s_waitcnt lgkmcnt(0)
v_mov_b32 v38,1
ds_write_b32 v37,v38 offset:4
qs_187:
ds_read_b32 v39,v37 offset:0
s_sub_u32 s90,s90,1
s_waitcnt lgkmcnt(0)
v_cmp_gt_u32 vcc,v38,v39
s_cmp_lt_i32 s90,0
s_cselect_b64 vcc,0,vcc
s_cbranch_vccnz qs_187
ds_read_b64_tr_b16 a[0:1],v36 offset:0
ds_read_b64_tr_b16 a[2:3],v36 offset:128
ds_read_b64_tr_b16 a[4:5],v36 offset:2048
ds_read_b64_tr_b16 a[6:7],v36 offset:2176
ds_read_b64_tr_b16 a[8:9],v36 offset:8192
ds_read_b64_tr_b16 a[10:11],v36 offset:8320
ds_read_b64_tr_b16 a[12:13],v36 offset:10240
ds_read_b64_tr_b16 a[14:15],v36 offset:10368
ds_write_b128 v33,a[16:19] offset:4096
ds_write_b128 v33,a[20:23] offset:5120
ds_write_b128 v33,a[24:27] offset:6144
ds_write_b128 v33,a[28:31] offset:7168
s_waitcnt lgkmcnt(0)
v_mov_b32 v38,2
ds_write_b32 v37,v38 offset:4
qs_188:
ds_read_b32 v39,v37 offset:0
s_sub_u32 s90,s90,1
s_waitcnt lgkmcnt(0)
v_cmp_gt_u32 vcc,v38,v39
s_cmp_lt_i32 s90,0
s_cselect_b64 vcc,0,vcc
s_cbranch_vccnz qs_188
ds_read_b64_tr_b16 a[16:17],v36 offset:4096
ds_read_b64_tr_b16 a[18:19],v36 offset:4224
ds_read_b64_tr_b16 a[20:21],v36 offset:6144
ds_read_b64_tr_b16 a[22:23],v36 offset:6272
ds_read_b64_tr_b16 a[24:25],v36 offset:12288
ds_read_b64_tr_b16 a[26:27],v36 offset:12416
ds_read_b64_tr_b16 a[28:29],v36 offset:14336
ds_read_b64_tr_b16 a[30:31],v36 offset:14464
ds_write_b128 v33,a[32:35] offset:0
ds_write_b128 v33,a[36:39] offset:1024
ds_write_b128 v33,a[40:43] offset:2048
ds_write_b128 v33,a[44:47] offset:3072
s_waitcnt lgkmcnt(0)
v_mov_b32 v38,3
ds_write_b32 v37,v38 offset:4
qs_189:
ds_read_b32 v39,v37 offset:0
s_sub_u32 s90,s90,1
s_waitcnt lgkmcnt(0)
v_cmp_gt_u32 vcc,v38,v39
s_cmp_lt_i32 s90,0
s_cselect_b64 vcc,0,vcc
s_cbranch_vccnz qs_189
ds_read_b64_tr_b16 a[32:33],v36 offset:0
ds_read_b64_tr_b16 a[34:35],v36 offset:128
ds_read_b64_tr_b16 a[36:37],v36 offset:2048
ds_read_b64_tr_b16 a[38:39],v36 offset:2176
ds_read_b64_tr_b16 a[40:41],v36 offset:8192
ds_read_b64_tr_b16 a[42:43],v36 offset:8320
ds_read_b64_tr_b16 a[44:45],v36 offset:10240
ds_read_b64_tr_b16 a[46:47],v36 offset:10368
ds_write_b128 v33,a[48:51] offset:4096
ds_write_b128 v33,a[52:55] offset:5120
ds_write_b128 v33,a[56:59] offset:6144
ds_write_b128 v33,a[60:63] offset:7168
s_waitcnt lgkmcnt(0)
v_mov_b32 v38,4
ds_write_b32 v37,v38 offset:4
qs_190:
ds_read_b32 v39,v37 offset:0
s_sub_u32 s90,s90,1
s_waitcnt lgkmcnt(0)
v_cmp_gt_u32 vcc,v38,v39
s_cmp_lt_i32 s90,0
s_cselect_b64 vcc,0,vcc
s_cbranch_vccnz qs_190
ds_read_b64_tr_b16 a[48:49],v36 offset:4096
ds_read_b64_tr_b16 a[50:51],v36 offset:4224
ds_read_b64_tr_b16 a[52:53],v36 offset:6144
ds_read_b64_tr_b16 a[54:55],v36 offset:6272
ds_read_b64_tr_b16 a[56:57],v36 offset:12288
ds_read_b64_tr_b16 a[58:59],v36 offset:12416
ds_read_b64_tr_b16 a[60:61],v36 offset:14336
ds_read_b64_tr_b16 a[62:63],v36 offset:14464
ds_write_b128 v33,a[64:67] offset:0
ds_write_b128 v33,a[68:71] offset:1024
ds_write_b128 v33,a[72:75] offset:2048
ds_write_b128 v33,a[76:79] offset:3072
s_waitcnt lgkmcnt(0)
v_mov_b32 v38,5
ds_write_b32 v37,v38 offset:4
qs_191:
ds_read_b32 v39,v37 offset:0
s_sub_u32 s90,s90,1
s_waitcnt lgkmcnt(0)
v_cmp_gt_u32 vcc,v38,v39
s_cmp_lt_i32 s90,0
s_cselect_b64 vcc,0,vcc
s_cbranch_vccnz qs_191
ds_read_b64_tr_b16 a[64:65],v36 offset:0
ds_read_b64_tr_b16 a[66:67],v36 offset:128
ds_read_b64_tr_b16 a[68:69],v36 offset:2048
ds_read_b64_tr_b16 a[70:71],v36 offset:2176
ds_read_b64_tr_b16 a[72:73],v36 offset:8192
ds_read_b64_tr_b16 a[74:75],v36 offset:8320
ds_read_b64_tr_b16 a[76:77],v36 offset:10240
ds_read_b64_tr_b16 a[78:79],v36 offset:10368
ds_write_b128 v33,a[80:83] offset:4096
ds_write_b128 v33,a[84:87] offset:5120
ds_write_b128 v33,a[88:91] offset:6144
ds_write_b128 v33,a[92:95] offset:7168
s_waitcnt lgkmcnt(0)
v_mov_b32 v38,6
ds_write_b32 v37,v38 offset:4
qs_192:
ds_read_b32 v39,v37 offset:0
s_sub_u32 s90,s90,1
s_waitcnt lgkmcnt(0)
v_cmp_gt_u32 vcc,v38,v39
s_cmp_lt_i32 s90,0
s_cselect_b64 vcc,0,vcc
s_cbranch_vccnz qs_192
ds_read_b64_tr_b16 a[80:81],v36 offset:4096
ds_read_b64_tr_b16 a[82:83],v36 offset:4224
ds_read_b64_tr_b16 a[84:85],v36 offset:6144
ds_read_b64_tr_b16 a[86:87],v36 offset:6272
ds_read_b64_tr_b16 a[88:89],v36 offset:12288
ds_read_b64_tr_b16 a[90:91],v36 offset:12416
ds_read_b64_tr_b16 a[92:93],v36 offset:14336
ds_read_b64_tr_b16 a[94:95],v36 offset:14464
ds_write_b128 v33,a[96:99] offset:0
ds_write_b128 v33,a[100:103] offset:1024
ds_write_b128 v33,a[104:107] offset:2048
ds_write_b128 v33,a[108:111] offset:3072
s_waitcnt lgkmcnt(0)
v_mov_b32 v38,7
ds_write_b32 v37,v38 offset:4
qs_193:
ds_read_b32 v39,v37 offset:0
s_sub_u32 s90,s90,1
s_waitcnt lgkmcnt(0)
v_cmp_gt_u32 vcc,v38,v39
s_cmp_lt_i32 s90,0
s_cselect_b64 vcc,0,vcc
s_cbranch_vccnz qs_193
ds_read_b64_tr_b16 a[96:97],v36 offset:0
ds_read_b64_tr_b16 a[98:99],v36 offset:128
ds_read_b64_tr_b16 a[100:101],v36 offset:2048
ds_read_b64_tr_b16 a[102:103],v36 offset:2176
ds_read_b64_tr_b16 a[104:105],v36 offset:8192
ds_read_b64_tr_b16 a[106:107],v36 offset:8320
ds_read_b64_tr_b16 a[108:109],v36 offset:10240
ds_read_b64_tr_b16 a[110:111],v36 offset:10368
ds_write_b128 v33,a[112:115] offset:4096
ds_write_b128 v33,a[116:119] offset:5120
ds_write_b128 v33,a[120:123] offset:6144
ds_write_b128 v33,a[124:127] offset:7168
s_waitcnt lgkmcnt(0)
v_mov_b32 v38,8
ds_write_b32 v37,v38 offset:4
qs_194:
ds_read_b32 v39,v37 offset:0
s_sub_u32 s90,s90,1
s_waitcnt lgkmcnt(0)
v_cmp_gt_u32 vcc,v38,v39
s_cmp_lt_i32 s90,0
s_cselect_b64 vcc,0,vcc
s_cbranch_vccnz qs_194
ds_read_b64_tr_b16 a[112:113],v36 offset:4096
ds_read_b64_tr_b16 a[114:115],v36 offset:4224
ds_read_b64_tr_b16 a[116:117],v36 offset:6144
ds_read_b64_tr_b16 a[118:119],v36 offset:6272
ds_read_b64_tr_b16 a[120:121],v36 offset:12288
ds_read_b64_tr_b16 a[122:123],v36 offset:12416
ds_read_b64_tr_b16 a[124:125],v36 offset:14336
ds_read_b64_tr_b16 a[126:127],v36 offset:14464
s_waitcnt lgkmcnt(0)
v_mov_b32 v38,9
ds_write_b32 v37,v38 offset:4
qs_195:
ds_read_b32 v39,v37 offset:0
s_sub_u32 s90,s90,1
s_waitcnt lgkmcnt(0)
v_cmp_gt_u32 vcc,v38,v39
s_cmp_lt_i32 s90,0
s_cselect_b64 vcc,0,vcc
s_cbranch_vccnz qs_195
ds_write_b128 v33,a[128:131] offset:0
ds_write_b128 v33,a[132:135] offset:1024
ds_write_b128 v33,a[136:139] offset:2048
ds_write_b128 v33,a[140:143] offset:3072
s_waitcnt lgkmcnt(0)
ds_read_b64_tr_b16 a[128:129],v34 offset:0
ds_read_b64_tr_b16 a[130:131],v34 offset:128
ds_read_b64_tr_b16 a[132:133],v34 offset:2048
ds_read_b64_tr_b16 a[134:135],v34 offset:2176
ds_read_b64_tr_b16 a[136:137],v34 offset:32
ds_read_b64_tr_b16 a[138:139],v34 offset:160
ds_read_b64_tr_b16 a[140:141],v34 offset:2080
ds_read_b64_tr_b16 a[142:143],v34 offset:2208
ds_write_b128 v33,a[144:147] offset:4096
ds_write_b128 v33,a[148:151] offset:5120
ds_write_b128 v33,a[152:155] offset:6144
ds_write_b128 v33,a[156:159] offset:7168
s_waitcnt lgkmcnt(0)
ds_read_b64_tr_b16 a[144:145],v34 offset:4096
ds_read_b64_tr_b16 a[146:147],v34 offset:4224
ds_read_b64_tr_b16 a[148:149],v34 offset:6144
ds_read_b64_tr_b16 a[150:151],v34 offset:6272
ds_read_b64_tr_b16 a[152:153],v34 offset:4128
ds_read_b64_tr_b16 a[154:155],v34 offset:4256
ds_read_b64_tr_b16 a[156:157],v34 offset:6176
ds_read_b64_tr_b16 a[158:159],v34 offset:6304
ds_write_b128 v33,a[160:163] offset:0
ds_write_b128 v33,a[164:167] offset:1024
ds_write_b128 v33,a[168:171] offset:2048
ds_write_b128 v33,a[172:175] offset:3072
s_waitcnt lgkmcnt(0)
ds_read_b64_tr_b16 a[160:161],v34 offset:0
ds_read_b64_tr_b16 a[162:163],v34 offset:128
ds_read_b64_tr_b16 a[164:165],v34 offset:2048
ds_read_b64_tr_b16 a[166:167],v34 offset:2176
ds_read_b64_tr_b16 a[168:169],v34 offset:32
ds_read_b64_tr_b16 a[170:171],v34 offset:160
ds_read_b64_tr_b16 a[172:173],v34 offset:2080
ds_read_b64_tr_b16 a[174:175],v34 offset:2208
free_196:
ds_read_b64 v[38:39],v37 offset:8
s_sub_u32 s90,s90,1
s_waitcnt lgkmcnt(0)
v_and_b32 v38,v38,v39
v_cmp_eq_u32 vcc,0,v38
s_cmp_lt_i32 s90,0
s_cselect_b64 vcc,0,vcc
s_cbranch_vccnz free_196
s_xor_b32 s64,s61,10493952
buffer_store_dwordx4 v[100:103],v206,s[20:23],s64 offen sc1
buffer_store_dwordx4 v[100:103],v207,s[20:23],s64 offen sc1
s_xor_b32 s64,s61,12582912
buffer_store_dwordx4 v[100:103],v206,s[20:23],s64 offen sc1
buffer_store_dwordx4 v[100:103],v207,s[20:23],s64 offen sc1
s_xor_b32 s64,s61,14688256
buffer_store_dwordx4 v[100:103],v206,s[20:23],s64 offen sc1
buffer_store_dwordx4 v[100:103],v207,s[20:23],s64 offen sc1
s_mov_b32 m0,32768
s_mov_b32 s65,221184
buffer_load_dwordx4 v16,s[20:23],s65 offen offset:0 lds
buffer_load_dwordx4 v16,s[20:23],s65 offen offset:1024 lds
buffer_load_dwordx4 v16,s[20:23],s65 offen offset:2048 lds
buffer_load_dwordx4 v16,s[20:23],s65 offen offset:3072 lds
s_mov_b32 m0,36864
s_mov_b32 s65,225280
buffer_load_dwordx4 v16,s[20:23],s65 offen offset:0 lds
buffer_load_dwordx4 v16,s[20:23],s65 offen offset:1024 lds
buffer_load_dwordx4 v16,s[20:23],s65 offen offset:2048 lds
buffer_load_dwordx4 v16,s[20:23],s65 offen offset:3072 lds
s_mov_b32 m0,40960
s_mov_b32 s65,229376
buffer_load_dwordx4 v16,s[20:23],s65 offen offset:0 lds
buffer_load_dwordx4 v16,s[20:23],s65 offen offset:1024 lds
buffer_load_dwordx4 v16,s[20:23],s65 offen offset:2048 lds
buffer_load_dwordx4 v16,s[20:23],s65 offen offset:3072 lds
s_mov_b32 m0,45056
s_mov_b32 s65,233472
buffer_load_dwordx4 v16,s[20:23],s65 offen offset:0 lds
buffer_load_dwordx4 v16,s[20:23],s65 offen offset:1024 lds
buffer_load_dwordx4 v16,s[20:23],s65 offen offset:2048 lds
buffer_load_dwordx4 v16,s[20:23],s65 offen offset:3072 lds
s_mov_b32 m0,49152
s_mov_b32 s65,237568
buffer_load_dwordx4 v16,s[20:23],s65 offen offset:0 lds
buffer_load_dwordx4 v16,s[20:23],s65 offen offset:1024 lds
buffer_load_dwordx4 v16,s[20:23],s65 offen offset:2048 lds
buffer_load_dwordx4 v16,s[20:23],s65 offen offset:3072 lds
s_mov_b32 m0,53248
s_mov_b32 s65,241664
buffer_load_dwordx4 v16,s[20:23],s65 offen offset:0 lds
buffer_load_dwordx4 v16,s[20:23],s65 offen offset:1024 lds
buffer_load_dwordx4 v16,s[20:23],s65 offen offset:2048 lds
buffer_load_dwordx4 v16,s[20:23],s65 offen offset:3072 lds
s_mov_b32 m0,57344
s_mov_b32 s65,245760
buffer_load_dwordx4 v16,s[20:23],s65 offen offset:0 lds
buffer_load_dwordx4 v16,s[20:23],s65 offen offset:1024 lds
buffer_load_dwordx4 v16,s[20:23],s65 offen offset:2048 lds
buffer_load_dwordx4 v16,s[20:23],s65 offen offset:3072 lds
s_mov_b32 m0,61440
s_mov_b32 s65,249856
buffer_load_dwordx4 v16,s[20:23],s65 offen offset:0 lds
buffer_load_dwordx4 v16,s[20:23],s65 offen offset:1024 lds
buffer_load_dwordx4 v16,s[20:23],s65 offen offset:2048 lds
buffer_load_dwordx4 v16,s[20:23],s65 offen offset:3072 lds
s_waitcnt vmcnt(54)
ds_write_b128 v33,a[176:179] offset:4096
ds_write_b128 v33,a[180:183] offset:5120
ds_write_b128 v33,a[184:187] offset:6144
ds_write_b128 v33,a[188:191] offset:7168
s_waitcnt lgkmcnt(0)
ds_read_b64_tr_b16 a[176:177],v34 offset:4096
ds_read_b64_tr_b16 a[178:179],v34 offset:4224
ds_read_b64_tr_b16 a[180:181],v34 offset:6144
ds_read_b64_tr_b16 a[182:183],v34 offset:6272
ds_read_b64_tr_b16 a[184:185],v34 offset:4128
ds_read_b64_tr_b16 a[186:187],v34 offset:4256
ds_read_b64_tr_b16 a[188:189],v34 offset:6176
ds_read_b64_tr_b16 a[190:191],v34 offset:6304
s_waitcnt vmcnt(50)
ds_write_b128 v33,a[192:195] offset:0
ds_write_b128 v33,a[196:199] offset:1024
ds_write_b128 v33,a[200:203] offset:2048
ds_write_b128 v33,a[204:207] offset:3072
s_waitcnt lgkmcnt(0)
ds_read_b64_tr_b16 a[192:193],v34 offset:0
ds_read_b64_tr_b16 a[194:195],v34 offset:128
ds_read_b64_tr_b16 a[196:197],v34 offset:2048
ds_read_b64_tr_b16 a[198:199],v34 offset:2176
ds_read_b64_tr_b16 a[200:201],v34 offset:32
ds_read_b64_tr_b16 a[202:203],v34 offset:160
ds_read_b64_tr_b16 a[204:205],v34 offset:2080
ds_read_b64_tr_b16 a[206:207],v34 offset:2208
s_waitcnt vmcnt(46)
ds_write_b128 v33,a[208:211] offset:4096
ds_write_b128 v33,a[212:215] offset:5120
ds_write_b128 v33,a[216:219] offset:6144
ds_write_b128 v33,a[220:223] offset:7168
s_waitcnt lgkmcnt(0)
ds_read_b64_tr_b16 a[208:209],v34 offset:4096
ds_read_b64_tr_b16 a[210:211],v34 offset:4224
ds_read_b64_tr_b16 a[212:213],v34 offset:6144
ds_read_b64_tr_b16 a[214:215],v34 offset:6272
ds_read_b64_tr_b16 a[216:217],v34 offset:4128
ds_read_b64_tr_b16 a[218:219],v34 offset:4256
ds_read_b64_tr_b16 a[220:221],v34 offset:6176
ds_read_b64_tr_b16 a[222:223],v34 offset:6304
s_waitcnt vmcnt(42)
ds_write_b128 v33,a[224:227] offset:0
ds_write_b128 v33,a[228:231] offset:1024
ds_write_b128 v33,a[232:235] offset:2048
ds_write_b128 v33,a[236:239] offset:3072
s_waitcnt lgkmcnt(0)
ds_read_b64_tr_b16 a[224:225],v34 offset:0
ds_read_b64_tr_b16 a[226:227],v34 offset:128
ds_read_b64_tr_b16 a[228:229],v34 offset:2048
ds_read_b64_tr_b16 a[230:231],v34 offset:2176
ds_read_b64_tr_b16 a[232:233],v34 offset:32
ds_read_b64_tr_b16 a[234:235],v34 offset:160
ds_read_b64_tr_b16 a[236:237],v34 offset:2080
ds_read_b64_tr_b16 a[238:239],v34 offset:2208
s_waitcnt vmcnt(38)
ds_write_b128 v33,a[240:243] offset:4096
ds_write_b128 v33,a[244:247] offset:5120
ds_write_b128 v33,a[248:251] offset:6144
ds_write_b128 v33,a[252:255] offset:7168
s_waitcnt lgkmcnt(0)
ds_read_b64_tr_b16 a[240:241],v34 offset:4096
ds_read_b64_tr_b16 a[242:243],v34 offset:4224
ds_read_b64_tr_b16 a[244:245],v34 offset:6144
ds_read_b64_tr_b16 a[246:247],v34 offset:6272
ds_read_b64_tr_b16 a[248:249],v34 offset:4128
ds_read_b64_tr_b16 a[250:251],v34 offset:4256
ds_read_b64_tr_b16 a[252:253],v34 offset:6176
ds_read_b64_tr_b16 a[254:255],v34 offset:6304
s_mov_b32 s79,0
s_add_u32 s63,s79,0
s_and_b32 s64,s63,3
s_lshl_b32 s70,s64,20
s_add_u32 s65,s63,2
s_and_b32 s65,s65,3
s_lshl_b32 s73,s65,20
s_add_u32 s55,s63,3
s_lshl_b32 s78,s55,16
s_add_u32 s78,s78,57344
s_cmp_lt_u32 s55,64
s_cselect_b32 s78,s78,0x7fff0000
s_add_u32 s71,s70,65536
s_add_u32 s60,s63,1
s_and_b32 s60,s60,3
s_lshl_b32 s72,s60,20
v_mov_b32 v184,0
v_mov_b32 v185,0
v_mov_b32 v186,0
v_mov_b32 v187,0
v_mov_b32 v188,0
v_mov_b32 v189,0
v_mov_b32 v190,0
v_mov_b32 v191,0
s_lshl_b32 s74,s63,21
s_lshl_b32 s55,s63,13
s_and_b32 s55,s55,0x2000
s_xor_b32 s55,s55,s61
s_add_u32 s74,s74,s55
v_mov_b32 v176,0
v_mov_b32 v177,0
v_mov_b32 v178,0
v_mov_b32 v179,0
v_mov_b32 v25,1
s_waitcnt vmcnt(0) lgkmcnt(0)
s_barrier
v_max_u32 v216,1,v216
v_max_u32 v217,1,v217
v_max_u32 v218,1,v218
v_max_u32 v219,1,v219
s_mov_b64 exec,s[84:85]
buffer_store_dwordx4 v[216:219],v12,s[24:27],s70 offen
buffer_store_dwordx4 v[216:219],v12,s[28:31],s70 offen sc1
s_mov_b64 exec,1
buffer_store_dword v25,v13,s[24:27],s70 offen
buffer_store_dword v25,v13,s[28:31],s70 offen sc1
s_mov_b64 exec,-1
s_branch loop_152
end_57:
s_waitcnt vmcnt(0)
s_barrier
s_mov_b32 s50,s91
done_1:
s_endpgm
pipe_worker:
v_and_b32 v1,63,v0
v_and_b32 v3,15,v1
v_lshrrev_b32 v4,4,v1
v_lshlrev_b32 v16,4,v1
v_mov_b32 v48,0
v_mov_b32 v49,0
v_mov_b32 v50,0
v_mov_b32 v51,0
s_lshr_b32 s58,s55,5
s_and_b32 s59,s55,31
s_xor_b32 s62,s61,0x2000
s_add_u32 s63,s62,21053440
s_lshr_b32 s64,s59,4
s_and_b32 s59,s59,15
s_lshr_b32 s65,s58,1
s_lshl_b32 s65,s65,4
s_add_u32 s59,s59,s65
s_mul_i32 s65,s64,3
s_add_u32 s64,s64,1
s_sub_u32 s58,s58,1
s_cmp_lt_u32 s58,2
s_cselect_b32 s58,s64,s65
s_load_dwordx2 s[4:5],s[0:1],16
v_lshlrev_b32 v5,4,v0
s_lshl_b32 s64,s55,14
s_add_u32 s64,s64,17825792
buffer_store_dwordx4 v[48:51],v5,s[20:23],s64 offen sc1
s_add_u32 s64,s64,4096
buffer_store_dwordx4 v[48:51],v5,s[20:23],s64 offen sc1
s_add_u32 s64,s64,4096
buffer_store_dwordx4 v[48:51],v5,s[20:23],s64 offen sc1
s_add_u32 s64,s64,4096
buffer_store_dwordx4 v[48:51],v5,s[20:23],s64 offen sc1
s_add_u32 s64,s64,4096
s_lshl_b32 s64,s55,12
s_add_u32 s64,s64,8577024
buffer_store_dwordx4 v[48:51],v5,s[20:23],s64 offen sc1
s_lshr_b32 s79,s55,5
s_add_u32 s64,s79,8
s_lshl_b32 s93,s64,21
s_lshl_b32 s64,s64,13
s_and_b32 s64,s64,0x2000
s_xor_b32 s64,s64,s61
s_add_u32 s93,s93,s64
s_add_u32 s93,s93,29360128
s_and_b32 s64,s55,31
s_add_u32 s64,s64,96
s_lshl_b32 s64,s64,14
s_add_u32 s93,s93,s64
s_waitcnt lgkmcnt(0)
s_mov_b32 s32,s4
s_and_b32 s33,s5,0xffff
s_mov_b32 s34,0x800000
s_mov_b32 s35,0x20000
v_lshrrev_b32 v5,3,v3
v_bfe_u32 v6,v3,2,1
v_lshl_add_u32 v7,v5,3,v6
v_lshl_add_u32 v6,v5,2,v6
v_lshrrev_b32 v5,1,v4
v_lshl_add_u32 v7,v5,4,v7
v_and_b32 v5,1,v4
v_lshl_add_u32 v7,v5,2,v7
v_lshl_add_u32 v6,v5,1,v6
v_bfe_u32 v5,v3,1,1
s_lshl_b32 s64,s50,1
v_add_u32 v5,s64,v5
v_xor_b32 v5,v5,v6
v_lshlrev_b32 v5,5,v5
v_lshl_add_u32 v5,v7,8,v5
v_and_b32 v6,1,v3
v_lshl_add_u32 v12,v6,4,v5
s_lshl_b32 s66,s59,8
v_and_b32 v5,15,v1
v_and_b32 v6,1,v4
v_lshlrev_b32 v6,1,v6
v_xor_b32 v5,v5,v6
v_mul_u32_u24 v6,8192,v4
v_xor_b32 v7,0,v5
v_lshl_add_u32 v8,v7,4,v6
v_xor_b32 v7,4,v5
v_lshl_add_u32 v9,v7,4,v6
v_xor_b32 v7,8,v5
v_lshl_add_u32 v10,v7,4,v6
v_xor_b32 v7,12,v5
v_lshl_add_u32 v11,v7,4,v6
s_mul_i32 s74,s50,524288
s_add_u32 s74,s74,s66
s_lshl_b32 s75,s50,14
s_mul_i32 s76,s50,262144
s_add_u32 s76,s76,s66
s_lshl_b32 s77,s50,13
s_add_u32 s64,s74,0
s_add_u32 m0,s75,0
s_nop 0
buffer_load_dwordx4 v8,s[32:35],s64 offen nt lds
s_add_u32 s64,s74,32768
s_add_u32 m0,s75,1024
s_nop 0
buffer_load_dwordx4 v9,s[32:35],s64 offen nt lds
s_add_u32 s64,s74,65536
s_add_u32 m0,s75,2048
s_nop 0
buffer_load_dwordx4 v10,s[32:35],s64 offen nt lds
s_add_u32 s64,s74,98304
s_add_u32 m0,s75,3072
s_nop 0
buffer_load_dwordx4 v11,s[32:35],s64 offen nt lds
s_add_u32 s64,s74,131072
s_add_u32 m0,s75,4096
s_nop 0
buffer_load_dwordx4 v8,s[32:35],s64 offen nt lds
s_add_u32 s64,s74,163840
s_add_u32 m0,s75,5120
s_nop 0
buffer_load_dwordx4 v9,s[32:35],s64 offen nt lds
s_add_u32 s64,s74,196608
s_add_u32 m0,s75,6144
s_nop 0
buffer_load_dwordx4 v10,s[32:35],s64 offen nt lds
s_add_u32 s64,s74,229376
s_add_u32 m0,s75,7168
s_nop 0
buffer_load_dwordx4 v11,s[32:35],s64 offen nt lds
s_add_u32 s64,s74,262144
s_add_u32 m0,s75,8192
s_nop 0
buffer_load_dwordx4 v8,s[32:35],s64 offen nt lds
s_add_u32 s64,s74,294912
s_add_u32 m0,s75,9216
s_nop 0
buffer_load_dwordx4 v9,s[32:35],s64 offen nt lds
s_add_u32 s64,s74,327680
s_add_u32 m0,s75,10240
s_nop 0
buffer_load_dwordx4 v10,s[32:35],s64 offen nt lds
s_add_u32 s64,s74,360448
s_add_u32 m0,s75,11264
s_nop 0
buffer_load_dwordx4 v11,s[32:35],s64 offen nt lds
s_add_u32 s64,s74,393216
s_add_u32 m0,s75,12288
s_nop 0
buffer_load_dwordx4 v8,s[32:35],s64 offen nt lds
s_add_u32 s64,s74,425984
s_add_u32 m0,s75,13312
s_nop 0
buffer_load_dwordx4 v9,s[32:35],s64 offen nt lds
s_add_u32 s64,s74,458752
s_add_u32 m0,s75,14336
s_nop 0
buffer_load_dwordx4 v10,s[32:35],s64 offen nt lds
s_add_u32 s64,s74,491520
s_add_u32 m0,s75,15360
s_nop 0
buffer_load_dwordx4 v11,s[32:35],s64 offen nt lds
s_add_u32 s64,s74,2097152
s_add_u32 m0,s75,65536
s_nop 0
buffer_load_dwordx4 v8,s[32:35],s64 offen nt lds
s_add_u32 s64,s74,2129920
s_add_u32 m0,s75,66560
s_nop 0
buffer_load_dwordx4 v9,s[32:35],s64 offen nt lds
s_add_u32 s64,s74,2162688
s_add_u32 m0,s75,67584
s_nop 0
buffer_load_dwordx4 v10,s[32:35],s64 offen nt lds
s_add_u32 s64,s74,2195456
s_add_u32 m0,s75,68608
s_nop 0
buffer_load_dwordx4 v11,s[32:35],s64 offen nt lds
s_add_u32 s64,s74,2228224
s_add_u32 m0,s75,69632
s_nop 0
buffer_load_dwordx4 v8,s[32:35],s64 offen nt lds
s_add_u32 s64,s74,2260992
s_add_u32 m0,s75,70656
s_nop 0
buffer_load_dwordx4 v9,s[32:35],s64 offen nt lds
s_add_u32 s64,s74,2293760
s_add_u32 m0,s75,71680
s_nop 0
buffer_load_dwordx4 v10,s[32:35],s64 offen nt lds
s_add_u32 s64,s74,2326528
s_add_u32 m0,s75,72704
s_nop 0
buffer_load_dwordx4 v11,s[32:35],s64 offen nt lds
s_add_u32 s64,s74,2359296
s_add_u32 m0,s75,73728
s_nop 0
buffer_load_dwordx4 v8,s[32:35],s64 offen nt lds
s_add_u32 s64,s74,2392064
s_add_u32 m0,s75,74752
s_nop 0
buffer_load_dwordx4 v9,s[32:35],s64 offen nt lds
s_add_u32 s64,s74,2424832
s_add_u32 m0,s75,75776
s_nop 0
buffer_load_dwordx4 v10,s[32:35],s64 offen nt lds
s_add_u32 s64,s74,2457600
s_add_u32 m0,s75,76800
s_nop 0
buffer_load_dwordx4 v11,s[32:35],s64 offen nt lds
s_add_u32 s64,s74,2490368
s_add_u32 m0,s75,77824
s_nop 0
buffer_load_dwordx4 v8,s[32:35],s64 offen nt lds
s_add_u32 s64,s74,2523136
s_add_u32 m0,s75,78848
s_nop 0
buffer_load_dwordx4 v9,s[32:35],s64 offen nt lds
s_add_u32 s64,s74,2555904
s_add_u32 m0,s75,79872
s_nop 0
buffer_load_dwordx4 v10,s[32:35],s64 offen nt lds
s_add_u32 s64,s74,2588672
s_add_u32 m0,s75,80896
s_nop 0
buffer_load_dwordx4 v11,s[32:35],s64 offen nt lds
s_waitcnt vmcnt(16)
s_barrier
ds_read_b64_tr_b16 a[0:1],v12 offset:0
ds_read_b64_tr_b16 a[2:3],v12 offset:512
ds_read_b64_tr_b16 a[128:129],v12 offset:8
ds_read_b64_tr_b16 a[130:131],v12 offset:520
ds_read_b64_tr_b16 a[4:5],v12 offset:8192
ds_read_b64_tr_b16 a[6:7],v12 offset:8704
ds_read_b64_tr_b16 a[132:133],v12 offset:8200
ds_read_b64_tr_b16 a[134:135],v12 offset:8712
s_waitcnt lgkmcnt(4)
ds_read_b64_tr_b16 a[8:9],v12 offset:16384
ds_read_b64_tr_b16 a[10:11],v12 offset:16896
ds_read_b64_tr_b16 a[136:137],v12 offset:16392
ds_read_b64_tr_b16 a[138:139],v12 offset:16904
ds_read_b64_tr_b16 a[12:13],v12 offset:24576
ds_read_b64_tr_b16 a[14:15],v12 offset:25088
ds_read_b64_tr_b16 a[140:141],v12 offset:24584
ds_read_b64_tr_b16 a[142:143],v12 offset:25096
s_waitcnt lgkmcnt(4)
ds_read_b64_tr_b16 a[16:17],v12 offset:32768
ds_read_b64_tr_b16 a[18:19],v12 offset:33280
ds_read_b64_tr_b16 a[144:145],v12 offset:32776
ds_read_b64_tr_b16 a[146:147],v12 offset:33288
ds_read_b64_tr_b16 a[20:21],v12 offset:40960
ds_read_b64_tr_b16 a[22:23],v12 offset:41472
ds_read_b64_tr_b16 a[148:149],v12 offset:40968
ds_read_b64_tr_b16 a[150:151],v12 offset:41480
s_waitcnt lgkmcnt(4)
ds_read_b64_tr_b16 a[24:25],v12 offset:49152
ds_read_b64_tr_b16 a[26:27],v12 offset:49664
ds_read_b64_tr_b16 a[152:153],v12 offset:49160
ds_read_b64_tr_b16 a[154:155],v12 offset:49672
ds_read_b64_tr_b16 a[28:29],v12 offset:57344
ds_read_b64_tr_b16 a[30:31],v12 offset:57856
ds_read_b64_tr_b16 a[156:157],v12 offset:57352
ds_read_b64_tr_b16 a[158:159],v12 offset:57864
s_waitcnt lgkmcnt(4)
v_xor_b32 v12,0x10000,v12
s_waitcnt lgkmcnt(0)
s_barrier
s_add_u32 s64,s74,4194304
s_add_u32 m0,s75,0
s_nop 0
buffer_load_dwordx4 v8,s[32:35],s64 offen nt lds
s_add_u32 s64,s74,4227072
s_add_u32 m0,s75,1024
s_nop 0
buffer_load_dwordx4 v9,s[32:35],s64 offen nt lds
s_add_u32 s64,s74,4259840
s_add_u32 m0,s75,2048
s_nop 0
buffer_load_dwordx4 v10,s[32:35],s64 offen nt lds
s_add_u32 s64,s74,4292608
s_add_u32 m0,s75,3072
s_nop 0
buffer_load_dwordx4 v11,s[32:35],s64 offen nt lds
s_add_u32 s64,s74,4325376
s_add_u32 m0,s75,4096
s_nop 0
buffer_load_dwordx4 v8,s[32:35],s64 offen nt lds
s_add_u32 s64,s74,4358144
s_add_u32 m0,s75,5120
s_nop 0
buffer_load_dwordx4 v9,s[32:35],s64 offen nt lds
s_add_u32 s64,s74,4390912
s_add_u32 m0,s75,6144
s_nop 0
buffer_load_dwordx4 v10,s[32:35],s64 offen nt lds
s_add_u32 s64,s74,4423680
s_add_u32 m0,s75,7168
s_nop 0
buffer_load_dwordx4 v11,s[32:35],s64 offen nt lds
s_add_u32 s64,s74,4456448
s_add_u32 m0,s75,8192
s_nop 0
buffer_load_dwordx4 v8,s[32:35],s64 offen nt lds
s_add_u32 s64,s74,4489216
s_add_u32 m0,s75,9216
s_nop 0
buffer_load_dwordx4 v9,s[32:35],s64 offen nt lds
s_add_u32 s64,s74,4521984
s_add_u32 m0,s75,10240
s_nop 0
buffer_load_dwordx4 v10,s[32:35],s64 offen nt lds
s_add_u32 s64,s74,4554752
s_add_u32 m0,s75,11264
s_nop 0
buffer_load_dwordx4 v11,s[32:35],s64 offen nt lds
s_add_u32 s64,s74,4587520
s_add_u32 m0,s75,12288
s_nop 0
buffer_load_dwordx4 v8,s[32:35],s64 offen nt lds
s_add_u32 s64,s74,4620288
s_add_u32 m0,s75,13312
s_nop 0
buffer_load_dwordx4 v9,s[32:35],s64 offen nt lds
s_add_u32 s64,s74,4653056
s_add_u32 m0,s75,14336
s_nop 0
buffer_load_dwordx4 v10,s[32:35],s64 offen nt lds
s_add_u32 s64,s74,4685824
s_add_u32 m0,s75,15360
s_nop 0
buffer_load_dwordx4 v11,s[32:35],s64 offen nt lds
s_waitcnt vmcnt(16)
s_barrier
ds_read_b64_tr_b16 a[32:33],v12 offset:0
ds_read_b64_tr_b16 a[34:35],v12 offset:512
ds_read_b64_tr_b16 a[160:161],v12 offset:8
ds_read_b64_tr_b16 a[162:163],v12 offset:520
ds_read_b64_tr_b16 a[36:37],v12 offset:8192
ds_read_b64_tr_b16 a[38:39],v12 offset:8704
ds_read_b64_tr_b16 a[164:165],v12 offset:8200
ds_read_b64_tr_b16 a[166:167],v12 offset:8712
s_waitcnt lgkmcnt(4)
ds_read_b64_tr_b16 a[40:41],v12 offset:16384
ds_read_b64_tr_b16 a[42:43],v12 offset:16896
ds_read_b64_tr_b16 a[168:169],v12 offset:16392
ds_read_b64_tr_b16 a[170:171],v12 offset:16904
ds_read_b64_tr_b16 a[44:45],v12 offset:24576
ds_read_b64_tr_b16 a[46:47],v12 offset:25088
ds_read_b64_tr_b16 a[172:173],v12 offset:24584
ds_read_b64_tr_b16 a[174:175],v12 offset:25096
s_waitcnt lgkmcnt(4)
ds_read_b64_tr_b16 a[48:49],v12 offset:32768
ds_read_b64_tr_b16 a[50:51],v12 offset:33280
ds_read_b64_tr_b16 a[176:177],v12 offset:32776
ds_read_b64_tr_b16 a[178:179],v12 offset:33288
ds_read_b64_tr_b16 a[52:53],v12 offset:40960
ds_read_b64_tr_b16 a[54:55],v12 offset:41472
ds_read_b64_tr_b16 a[180:181],v12 offset:40968
ds_read_b64_tr_b16 a[182:183],v12 offset:41480
s_waitcnt lgkmcnt(4)
ds_read_b64_tr_b16 a[56:57],v12 offset:49152
ds_read_b64_tr_b16 a[58:59],v12 offset:49664
ds_read_b64_tr_b16 a[184:185],v12 offset:49160
ds_read_b64_tr_b16 a[186:187],v12 offset:49672
ds_read_b64_tr_b16 a[60:61],v12 offset:57344
ds_read_b64_tr_b16 a[62:63],v12 offset:57856
ds_read_b64_tr_b16 a[188:189],v12 offset:57352
ds_read_b64_tr_b16 a[190:191],v12 offset:57864
s_waitcnt lgkmcnt(4)
v_xor_b32 v12,0x10000,v12
s_waitcnt lgkmcnt(0)
s_barrier
s_add_u32 s64,s74,6291456
s_add_u32 m0,s75,65536
s_nop 0
buffer_load_dwordx4 v8,s[32:35],s64 offen nt lds
s_add_u32 s64,s74,6324224
s_add_u32 m0,s75,66560
s_nop 0
buffer_load_dwordx4 v9,s[32:35],s64 offen nt lds
s_add_u32 s64,s74,6356992
s_add_u32 m0,s75,67584
s_nop 0
buffer_load_dwordx4 v10,s[32:35],s64 offen nt lds
s_add_u32 s64,s74,6389760
s_add_u32 m0,s75,68608
s_nop 0
buffer_load_dwordx4 v11,s[32:35],s64 offen nt lds
s_add_u32 s64,s74,6422528
s_add_u32 m0,s75,69632
s_nop 0
buffer_load_dwordx4 v8,s[32:35],s64 offen nt lds
s_add_u32 s64,s74,6455296
s_add_u32 m0,s75,70656
s_nop 0
buffer_load_dwordx4 v9,s[32:35],s64 offen nt lds
s_add_u32 s64,s74,6488064
s_add_u32 m0,s75,71680
s_nop 0
buffer_load_dwordx4 v10,s[32:35],s64 offen nt lds
s_add_u32 s64,s74,6520832
s_add_u32 m0,s75,72704
s_nop 0
buffer_load_dwordx4 v11,s[32:35],s64 offen nt lds
s_add_u32 s64,s74,6553600
s_add_u32 m0,s75,73728
s_nop 0
buffer_load_dwordx4 v8,s[32:35],s64 offen nt lds
s_add_u32 s64,s74,6586368
s_add_u32 m0,s75,74752
s_nop 0
buffer_load_dwordx4 v9,s[32:35],s64 offen nt lds
s_add_u32 s64,s74,6619136
s_add_u32 m0,s75,75776
s_nop 0
buffer_load_dwordx4 v10,s[32:35],s64 offen nt lds
s_add_u32 s64,s74,6651904
s_add_u32 m0,s75,76800
s_nop 0
buffer_load_dwordx4 v11,s[32:35],s64 offen nt lds
s_add_u32 s64,s74,6684672
s_add_u32 m0,s75,77824
s_nop 0
buffer_load_dwordx4 v8,s[32:35],s64 offen nt lds
s_add_u32 s64,s74,6717440
s_add_u32 m0,s75,78848
s_nop 0
buffer_load_dwordx4 v9,s[32:35],s64 offen nt lds
s_add_u32 s64,s74,6750208
s_add_u32 m0,s75,79872
s_nop 0
buffer_load_dwordx4 v10,s[32:35],s64 offen nt lds
s_add_u32 s64,s74,6782976
s_add_u32 m0,s75,80896
s_nop 0
buffer_load_dwordx4 v11,s[32:35],s64 offen nt lds
s_waitcnt vmcnt(16)
s_barrier
ds_read_b64_tr_b16 a[64:65],v12 offset:0
ds_read_b64_tr_b16 a[66:67],v12 offset:512
ds_read_b64_tr_b16 a[192:193],v12 offset:8
ds_read_b64_tr_b16 a[194:195],v12 offset:520
ds_read_b64_tr_b16 a[68:69],v12 offset:8192
ds_read_b64_tr_b16 a[70:71],v12 offset:8704
ds_read_b64_tr_b16 a[196:197],v12 offset:8200
ds_read_b64_tr_b16 a[198:199],v12 offset:8712
s_waitcnt lgkmcnt(4)
ds_read_b64_tr_b16 a[72:73],v12 offset:16384
ds_read_b64_tr_b16 a[74:75],v12 offset:16896
ds_read_b64_tr_b16 a[200:201],v12 offset:16392
ds_read_b64_tr_b16 a[202:203],v12 offset:16904
ds_read_b64_tr_b16 a[76:77],v12 offset:24576
ds_read_b64_tr_b16 a[78:79],v12 offset:25088
ds_read_b64_tr_b16 a[204:205],v12 offset:24584
ds_read_b64_tr_b16 a[206:207],v12 offset:25096
s_waitcnt lgkmcnt(4)
ds_read_b64_tr_b16 a[80:81],v12 offset:32768
ds_read_b64_tr_b16 a[82:83],v12 offset:33280
ds_read_b64_tr_b16 a[208:209],v12 offset:32776
ds_read_b64_tr_b16 a[210:211],v12 offset:33288
ds_read_b64_tr_b16 a[84:85],v12 offset:40960
ds_read_b64_tr_b16 a[86:87],v12 offset:41472
ds_read_b64_tr_b16 a[212:213],v12 offset:40968
ds_read_b64_tr_b16 a[214:215],v12 offset:41480
s_waitcnt lgkmcnt(4)
ds_read_b64_tr_b16 a[88:89],v12 offset:49152
ds_read_b64_tr_b16 a[90:91],v12 offset:49664
ds_read_b64_tr_b16 a[216:217],v12 offset:49160
ds_read_b64_tr_b16 a[218:219],v12 offset:49672
ds_read_b64_tr_b16 a[92:93],v12 offset:57344
ds_read_b64_tr_b16 a[94:95],v12 offset:57856
ds_read_b64_tr_b16 a[220:221],v12 offset:57352
ds_read_b64_tr_b16 a[222:223],v12 offset:57864
s_waitcnt lgkmcnt(4)
v_xor_b32 v12,0x10000,v12
s_waitcnt lgkmcnt(0)
s_barrier
s_waitcnt vmcnt(0)
s_barrier
ds_read_b64_tr_b16 a[96:97],v12 offset:0
ds_read_b64_tr_b16 a[98:99],v12 offset:512
ds_read_b64_tr_b16 a[224:225],v12 offset:8
ds_read_b64_tr_b16 a[226:227],v12 offset:520
ds_read_b64_tr_b16 a[100:101],v12 offset:8192
ds_read_b64_tr_b16 a[102:103],v12 offset:8704
ds_read_b64_tr_b16 a[228:229],v12 offset:8200
ds_read_b64_tr_b16 a[230:231],v12 offset:8712
s_waitcnt lgkmcnt(4)
ds_read_b64_tr_b16 a[104:105],v12 offset:16384
ds_read_b64_tr_b16 a[106:107],v12 offset:16896
ds_read_b64_tr_b16 a[232:233],v12 offset:16392
ds_read_b64_tr_b16 a[234:235],v12 offset:16904
ds_read_b64_tr_b16 a[108:109],v12 offset:24576
ds_read_b64_tr_b16 a[110:111],v12 offset:25088
ds_read_b64_tr_b16 a[236:237],v12 offset:24584
ds_read_b64_tr_b16 a[238:239],v12 offset:25096
s_waitcnt lgkmcnt(4)
ds_read_b64_tr_b16 a[112:113],v12 offset:32768
ds_read_b64_tr_b16 a[114:115],v12 offset:33280
ds_read_b64_tr_b16 a[240:241],v12 offset:32776
ds_read_b64_tr_b16 a[242:243],v12 offset:33288
ds_read_b64_tr_b16 a[116:117],v12 offset:40960
ds_read_b64_tr_b16 a[118:119],v12 offset:41472
ds_read_b64_tr_b16 a[244:245],v12 offset:40968
ds_read_b64_tr_b16 a[246:247],v12 offset:41480
s_waitcnt lgkmcnt(4)
ds_read_b64_tr_b16 a[120:121],v12 offset:49152
ds_read_b64_tr_b16 a[122:123],v12 offset:49664
ds_read_b64_tr_b16 a[248:249],v12 offset:49160
ds_read_b64_tr_b16 a[250:251],v12 offset:49672
ds_read_b64_tr_b16 a[124:125],v12 offset:57344
ds_read_b64_tr_b16 a[126:127],v12 offset:57856
ds_read_b64_tr_b16 a[252:253],v12 offset:57352
ds_read_b64_tr_b16 a[254:255],v12 offset:57864
s_waitcnt lgkmcnt(4)
v_xor_b32 v12,0x10000,v12
s_waitcnt lgkmcnt(0)
s_barrier
v_and_b32 v21,7,v1
v_lshlrev_b32 v21,6,v21
s_mov_b32 s65,21052416
s_mov_b32 s66,1792
pl_200:
buffer_load_dword v22,v21,s[20:23],s65 offen sc1
s_waitcnt vmcnt(0)
v_cmp_gt_u32 vcc,s66,v22
s_cbranch_vccz pok_201
s_sleep 1
s_sub_u32 s90,s90,1
s_cmp_gt_i32 s90,0
s_cbranch_scc1 pl_200
pok_201:
s_lshl_b32 s72,s50,14
s_lshl_b32 s74,s58,16
s_add_u32 s74,s74,s72
s_add_u32 s74,s74,57344
v_mov_b32 v17,v16
s_lshl_b32 s64,s59,14
s_lshl_b32 s65,s50,11
s_add_u32 s64,s64,s65
v_add_u32 v18,s64,v16
s_lshl_b32 s73,s58,5
s_add_u32 s73,s73,s59
s_lshl_b32 s73,s73,2
s_add_u32 s73,s73,s63
v_lshlrev_b32 v24,4,v0
s_mov_b32 s79,s58
s_add_u32 m0,s72,0
s_add_u32 s65,s74,0
buffer_load_dwordx4 v16,s[20:23],s65 offen offset:0  lds
buffer_load_dwordx4 v16,s[20:23],s65 offen offset:1024  lds
buffer_load_dwordx4 v16,s[20:23],s65 offen offset:2048  lds
buffer_load_dwordx4 v16,s[20:23],s65 offen offset:3072  lds
s_add_u32 m0,s72,4096
s_add_u32 s65,s74,4096
buffer_load_dwordx4 v16,s[20:23],s65 offen offset:0  lds
buffer_load_dwordx4 v16,s[20:23],s65 offen offset:1024  lds
buffer_load_dwordx4 v16,s[20:23],s65 offen offset:2048  lds
buffer_load_dwordx4 v16,s[20:23],s65 offen offset:3072  lds
s_add_u32 m0,s72,8192
s_add_u32 s65,s74,8192
buffer_load_dwordx4 v16,s[20:23],s65 offen offset:0  lds
buffer_load_dwordx4 v16,s[20:23],s65 offen offset:1024  lds
buffer_load_dwordx4 v16,s[20:23],s65 offen offset:2048  lds
buffer_load_dwordx4 v16,s[20:23],s65 offen offset:3072  lds
s_add_u32 m0,s72,12288
s_add_u32 s65,s74,12288
buffer_load_dwordx4 v16,s[20:23],s65 offen offset:0  lds
buffer_load_dwordx4 v16,s[20:23],s65 offen offset:1024  lds
buffer_load_dwordx4 v16,s[20:23],s65 offen offset:2048  lds
buffer_load_dwordx4 v16,s[20:23],s65 offen offset:3072  lds
s_waitcnt vmcnt(0)
s_add_u32 s41,s58,55
s_sub_u32 s64,s58,1
s_cmp_lt_u32 s64,2
s_cselect_b32 s41,s41,64
s_lshl_b32 s76,s50,14
s_add_u32 s76,s76,57344
s_add_u32 s42,s55,32
s_lshl_b32 s42,s42,14
s_add_u32 s42,s42,113246208
s_xor_b32 s64,s62,0
s_add_u32 s42,s42,s64
s_sub_u32 s64,s42,2097152
s_xor_b32 s64,s64,0x2000
s_cmp_lt_u32 s55,104
s_cselect_b32 s64,s64,0x7fff0000
s_cmp_lt_u32 s55,96
s_cselect_b32 s42,s42,s64
v_add_u32 v25,4096,v24
s_load_dwordx2 s[4:5],s[0:1],96
s_load_dwordx2 s[6:7],s[0:1],104
v_and_b32 v5,3,v0
v_lshrrev_b32 v6,2,v0
v_mul_u32_u24 v112,12288,v6
v_lshl_add_u32 v112,v5,4,v112
v_lshlrev_b32 v113,1,v6
s_add_u32 s43,s55,64
s_lshl_b32 s43,s43,6
s_mov_b32 s48,0
s_mov_b32 s80,0xffff0000
s_mov_b32 s81,0xbfb8aa3b
s_waitcnt lgkmcnt(0)
s_mov_b32 s12,s4
s_and_b32 s13,s5,0xffff
s_mov_b32 s14,0x800
s_mov_b32 s15,0x20000
s_mov_b32 s16,s6
s_and_b32 s17,s7,0xffff
s_mov_b32 s18,0xc00000
s_mov_b32 s19,0x20000
buffer_load_dwordx4 v[104:107],v112,s[16:19],s43 offen nt
buffer_load_ushort v108,v113,s[12:15],s48 offen
s_add_u32 s43,s43,786432
s_add_u32 s48,s48,128
buffer_load_dwordx4 v[116:119],v112,s[16:19],s43 offen nt
buffer_load_ushort v120,v113,s[12:15],s48 offen
s_add_u32 s43,s43,786432
s_add_u32 s48,s48,128
v_mov_b32 v96,0
v_mov_b32 v97,0
v_mov_b32 v98,0
v_mov_b32 v99,0
v_mov_b32 v100,0
v_mov_b32 v101,0
v_mov_b32 v102,0
v_mov_b32 v103,0
s_waitcnt vmcnt(0)
qloop_202:
s_lshr_b32 s64,s79,2
s_cmp_lg_u32 s64,4
s_cbranch_scc1 np2_204
s_waitcnt vmcnt(0)
s_barrier
s_cmp_lg_u32 s50,0
s_cbranch_scc1 ow_205
s_mov_b64 exec,1
v_mov_b32 v22,14
v_mov_b32 v23,0
s_mov_b32 s64,21052928
buffer_atomic_add v22,v23,s[20:23],s64 offen sc1
s_mov_b64 exec,-1
ow_205:
np2_204:
s_cmp_lg_u32 s79,s41
s_cbranch_scc1 npz_203
s_waitcnt vmcnt(0)
s_barrier
s_cmp_lg_u32 s50,0
s_cbranch_scc1 ow_206
s_mov_b64 exec,1
v_mov_b32 v22,14
v_mov_b32 v23,0
s_mov_b32 s64,21052992
buffer_atomic_add v22,v23,s[20:23],s64 offen sc1
s_mov_b64 exec,-1
ow_206:
s_cmp_lg_u32 s50,0
s_cbranch_scc1 ow_207
s_mov_b64 exec,1
v_mov_b32 v22,14
v_mov_b32 v23,0
buffer_store_dword v22,v23,s[20:23],s73 offen sc1
s_mov_b64 exec,-1
ow_207:
npz_203:
s_waitcnt vmcnt(10)
s_barrier
ds_read_b128 v[224:227],v17 offset:0
ds_read_b128 v[228:231],v17 offset:2048
ds_read_b128 v[232:235],v17 offset:4096
ds_read_b128 v[236:239],v17 offset:6144
ds_read_b128 v[240:243],v17 offset:8192
ds_read_b128 v[244:247],v17 offset:10240
ds_read_b128 v[248:251],v17 offset:12288
s_waitcnt lgkmcnt(5)
v_mfma_f32_16x16x32_bf16 v[64:67],a[0:3],v[224:227],0
s_xor_b32 s72,s72,0x10000
s_add_u32 s77,s79,2
v_mfma_f32_16x16x32_bf16 v[72:75],a[128:131],v[224:227],0
ds_read_b128 v[252:255],v17 offset:14336
s_cmp_lt_u32 s79,56
s_cselect_b32 s77,s41,s77
v_mfma_f32_16x16x32_bf16 v[64:67],a[4:7],v[228:231],v[64:67]
s_add_u32 s74,s79,4
s_cmp_lt_u32 s79,52
s_cselect_b32 s77,s74,s77
v_mfma_f32_16x16x32_bf16 v[72:75],a[132:135],v[228:231],v[72:75]
ds_read_b128 v[224:227],v17 offset:16384
v_lshlrev_b32 v108,16,v108
s_waitcnt lgkmcnt(5)
v_mfma_f32_16x16x32_bf16 v[64:67],a[8:11],v[232:235],v[64:67]
s_lshl_b32 s74,s77,16
s_add_u32 s74,s74,s76
v_mul_f32 v109,s81,v108
v_mfma_f32_16x16x32_bf16 v[72:75],a[136:139],v[232:235],v[72:75]
ds_read_b128 v[228:231],v17 offset:18432
s_add_u32 s64,s79,0
v_mfma_f32_16x16x32_bf16 v[64:67],a[12:15],v[236:239],v[64:67]
s_cmp_lt_u32 s77,64
s_cselect_b32 s74,s74,0x7fff0000
v_mfma_f32_16x16x32_bf16 v[72:75],a[140:143],v[236:239],v[72:75]
ds_read_b128 v[232:235],v17 offset:20480
s_waitcnt lgkmcnt(5)
v_mfma_f32_16x16x32_bf16 v[64:67],a[16:19],v[240:243],v[64:67]
s_add_u32 m0,s72,0
v_exp_f32 v109,v109
v_mfma_f32_16x16x32_bf16 v[72:75],a[144:147],v[240:243],v[72:75]
ds_read_b128 v[236:239],v17 offset:22528
v_add_f32 v109,1.0,v109
v_mfma_f32_16x16x32_bf16 v[64:67],a[20:23],v[244:247],v[64:67]
s_add_u32 s65,s74,0
s_lshl_b32 s70,s64,21
v_mfma_f32_16x16x32_bf16 v[72:75],a[148:151],v[244:247],v[72:75]
ds_read_b128 v[240:243],v17 offset:24576
s_waitcnt lgkmcnt(5)
v_mfma_f32_16x16x32_bf16 v[64:67],a[24:27],v[248:251],v[64:67]
v_rcp_f32 v109,v109
v_mfma_f32_16x16x32_bf16 v[72:75],a[152:155],v[248:251],v[72:75]
ds_read_b128 v[244:247],v17 offset:26624
v_mul_f32 v109,v109,v108
v_mfma_f32_16x16x32_bf16 v[64:67],a[28:31],v[252:255],v[64:67]
buffer_load_dwordx4 v16,s[20:23],s65 offen offset:0  lds
v_mfma_f32_16x16x32_bf16 v[72:75],a[156:159],v[252:255],v[72:75]
ds_read_b128 v[248:251],v17 offset:28672
s_waitcnt lgkmcnt(5)
v_mfma_f32_16x16x32_bf16 v[64:67],a[32:35],v[224:227],v[64:67]
buffer_load_dwordx4 v16,s[20:23],s65 offen offset:1024  lds
v_mfma_f32_16x16x32_bf16 v[72:75],a[160:163],v[224:227],v[72:75]
ds_read_b128 v[252:255],v17 offset:30720
s_lshl_b32 s64,s64,13
v_mfma_f32_16x16x32_bf16 v[64:67],a[36:39],v[228:231],v[64:67]
buffer_load_dwordx4 v16,s[20:23],s65 offen offset:2048  lds
v_mfma_f32_16x16x32_bf16 v[72:75],a[164:167],v[228:231],v[72:75]
ds_read_b128 v[224:227],v17 offset:32768
s_waitcnt lgkmcnt(5)
v_mfma_f32_16x16x32_bf16 v[64:67],a[40:43],v[232:235],v[64:67]
buffer_load_dwordx4 v16,s[20:23],s65 offen offset:3072  lds
v_mfma_f32_16x16x32_bf16 v[72:75],a[168:171],v[232:235],v[72:75]
ds_read_b128 v[228:231],v17 offset:34816
s_and_b32 s64,s64,0x2000
v_mfma_f32_16x16x32_bf16 v[64:67],a[44:47],v[236:239],v[64:67]
v_cvt_pk_bf16_f32 v109,v109,v109
v_and_b32 v108,s80,v109
v_mfma_f32_16x16x32_bf16 v[72:75],a[172:175],v[236:239],v[72:75]
ds_read_b128 v[232:235],v17 offset:36864
s_waitcnt lgkmcnt(5)
v_mfma_f32_16x16x32_bf16 v[64:67],a[48:51],v[240:243],v[64:67]
s_add_u32 m0,s72,4096
v_lshlrev_b32 v110,16,v104
v_mfma_f32_16x16x32_bf16 v[72:75],a[176:179],v[240:243],v[72:75]
ds_read_b128 v[236:239],v17 offset:38912
s_add_u32 s65,s74,4096
v_mfma_f32_16x16x32_bf16 v[64:67],a[52:55],v[244:247],v[64:67]
s_xor_b32 s64,s64,s62
v_and_b32 v111,s80,v104
v_mfma_f32_16x16x32_bf16 v[72:75],a[180:183],v[244:247],v[72:75]
ds_read_b128 v[240:243],v17 offset:40960
s_waitcnt lgkmcnt(5)
v_mfma_f32_16x16x32_bf16 v[64:67],a[56:59],v[248:251],v[64:67]
buffer_load_dwordx4 v16,s[20:23],s65 offen offset:0  lds
v_mfma_f32_16x16x32_bf16 v[72:75],a[184:187],v[248:251],v[72:75]
ds_read_b128 v[244:247],v17 offset:43008
v_fmac_f32 v96,v110,v108
v_mfma_f32_16x16x32_bf16 v[64:67],a[60:63],v[252:255],v[64:67]
buffer_load_dwordx4 v16,s[20:23],s65 offen offset:1024  lds
v_mfma_f32_16x16x32_bf16 v[72:75],a[188:191],v[252:255],v[72:75]
ds_read_b128 v[248:251],v17 offset:45056
s_waitcnt lgkmcnt(5)
v_mfma_f32_16x16x32_bf16 v[64:67],a[64:67],v[224:227],v[64:67]
s_add_u32 s70,s70,s64
v_fmac_f32 v97,v111,v108
v_mfma_f32_16x16x32_bf16 v[72:75],a[192:195],v[224:227],v[72:75]
ds_read_b128 v[252:255],v17 offset:47104
v_lshlrev_b32 v110,16,v105
v_mfma_f32_16x16x32_bf16 v[64:67],a[68:71],v[228:231],v[64:67]
buffer_load_dwordx4 v16,s[20:23],s65 offen offset:2048  lds
v_mfma_f32_16x16x32_bf16 v[72:75],a[196:199],v[228:231],v[72:75]
ds_read_b128 v[224:227],v17 offset:49152
s_waitcnt lgkmcnt(5)
v_mfma_f32_16x16x32_bf16 v[64:67],a[72:75],v[232:235],v[64:67]
buffer_load_dwordx4 v16,s[20:23],s65 offen offset:3072  lds
v_mfma_f32_16x16x32_bf16 v[72:75],a[200:203],v[232:235],v[72:75]
ds_read_b128 v[228:231],v17 offset:51200
s_add_u32 s70,s70,29360128
v_mfma_f32_16x16x32_bf16 v[64:67],a[76:79],v[236:239],v[64:67]
s_add_u32 m0,s72,8192
v_and_b32 v111,s80,v105
v_mfma_f32_16x16x32_bf16 v[72:75],a[204:207],v[236:239],v[72:75]
ds_read_b128 v[232:235],v17 offset:53248
s_waitcnt lgkmcnt(5)
v_mfma_f32_16x16x32_bf16 v[64:67],a[80:83],v[240:243],v[64:67]
s_add_u32 s65,s74,8192
v_fmac_f32 v98,v110,v108
v_mfma_f32_16x16x32_bf16 v[72:75],a[208:211],v[240:243],v[72:75]
ds_read_b128 v[236:239],v17 offset:55296
v_fmac_f32 v99,v111,v108
v_mfma_f32_16x16x32_bf16 v[64:67],a[84:87],v[244:247],v[64:67]
v_lshlrev_b32 v110,16,v106
v_and_b32 v111,s80,v106
v_mfma_f32_16x16x32_bf16 v[72:75],a[212:215],v[244:247],v[72:75]
ds_read_b128 v[240:243],v17 offset:57344
s_waitcnt lgkmcnt(5)
v_mfma_f32_16x16x32_bf16 v[64:67],a[88:91],v[248:251],v[64:67]
buffer_load_dwordx4 v16,s[20:23],s65 offen offset:0  lds
v_mfma_f32_16x16x32_bf16 v[72:75],a[216:219],v[248:251],v[72:75]
ds_read_b128 v[244:247],v17 offset:59392
v_fmac_f32 v100,v110,v108
v_mfma_f32_16x16x32_bf16 v[64:67],a[92:95],v[252:255],v[64:67]
buffer_load_dwordx4 v16,s[20:23],s65 offen offset:1024  lds
v_mfma_f32_16x16x32_bf16 v[72:75],a[220:223],v[252:255],v[72:75]
ds_read_b128 v[248:251],v17 offset:61440
s_waitcnt lgkmcnt(5)
v_mfma_f32_16x16x32_bf16 v[64:67],a[96:99],v[224:227],v[64:67]
buffer_load_dwordx4 v16,s[20:23],s65 offen offset:2048  lds
v_mfma_f32_16x16x32_bf16 v[72:75],a[224:227],v[224:227],v[72:75]
ds_read_b128 v[252:255],v17 offset:63488
v_fmac_f32 v101,v111,v108
v_mfma_f32_16x16x32_bf16 v[64:67],a[100:103],v[228:231],v[64:67]
buffer_load_dwordx4 v16,s[20:23],s65 offen offset:3072  lds
v_mfma_f32_16x16x32_bf16 v[72:75],a[228:231],v[228:231],v[72:75]
ds_read_b128 v[224:227],v17 offset:1024
s_waitcnt lgkmcnt(5)
v_mfma_f32_16x16x32_bf16 v[64:67],a[104:107],v[232:235],v[64:67]
v_lshlrev_b32 v110,16,v107
v_and_b32 v111,s80,v107
v_mfma_f32_16x16x32_bf16 v[72:75],a[232:235],v[232:235],v[72:75]
ds_read_b128 v[228:231],v17 offset:3072
s_add_u32 m0,s72,12288
v_mfma_f32_16x16x32_bf16 v[64:67],a[108:111],v[236:239],v[64:67]
v_fmac_f32 v102,v110,v108
v_fmac_f32 v103,v111,v108
v_mfma_f32_16x16x32_bf16 v[72:75],a[236:239],v[236:239],v[72:75]
ds_read_b128 v[232:235],v17 offset:5120
s_waitcnt lgkmcnt(5)
v_mfma_f32_16x16x32_bf16 v[64:67],a[112:115],v[240:243],v[64:67]
s_add_u32 s65,s74,12288
v_mfma_f32_16x16x32_bf16 v[72:75],a[240:243],v[240:243],v[72:75]
ds_read_b128 v[236:239],v17 offset:7168
v_mfma_f32_16x16x32_bf16 v[64:67],a[116:119],v[244:247],v[64:67]
buffer_load_dwordx4 v16,s[20:23],s65 offen offset:0  lds
v_mfma_f32_16x16x32_bf16 v[72:75],a[244:247],v[244:247],v[72:75]
ds_read_b128 v[240:243],v17 offset:9216
s_waitcnt lgkmcnt(5)
v_mfma_f32_16x16x32_bf16 v[64:67],a[120:123],v[248:251],v[64:67]
buffer_load_dwordx4 v16,s[20:23],s65 offen offset:1024  lds
v_mfma_f32_16x16x32_bf16 v[72:75],a[248:251],v[248:251],v[72:75]
ds_read_b128 v[244:247],v17 offset:11264
v_mfma_f32_16x16x32_bf16 v[64:67],a[124:127],v[252:255],v[64:67]
v_mfma_f32_16x16x32_bf16 v[72:75],a[252:255],v[252:255],v[72:75]
ds_read_b128 v[248:251],v17 offset:13312
s_waitcnt lgkmcnt(5)
v_mfma_f32_16x16x32_bf16 v[68:71],a[0:3],v[224:227],0
buffer_load_dwordx4 v16,s[20:23],s65 offen offset:2048  lds
v_mfma_f32_16x16x32_bf16 v[76:79],a[128:131],v[224:227],0
ds_read_b128 v[252:255],v17 offset:15360
v_mfma_f32_16x16x32_bf16 v[68:71],a[4:7],v[228:231],v[68:71]
buffer_load_dwordx4 v16,s[20:23],s65 offen offset:3072  lds
v_mfma_f32_16x16x32_bf16 v[76:79],a[132:135],v[228:231],v[76:79]
ds_read_b128 v[224:227],v17 offset:17408
s_waitcnt lgkmcnt(5)
v_mfma_f32_16x16x32_bf16 v[68:71],a[8:11],v[232:235],v[68:71]
v_cvt_pk_bf16_f32 v88,v64,v65
v_cvt_pk_bf16_f32 v89,v66,v67
v_cvt_pk_bf16_f32 v90,v72,v73
v_cvt_pk_bf16_f32 v91,v74,v75
v_mfma_f32_16x16x32_bf16 v[76:79],a[136:139],v[232:235],v[76:79]
ds_read_b128 v[228:231],v17 offset:19456
v_mfma_f32_16x16x32_bf16 v[68:71],a[12:15],v[236:239],v[68:71]
v_mfma_f32_16x16x32_bf16 v[76:79],a[140:143],v[236:239],v[76:79]
ds_read_b128 v[232:235],v17 offset:21504
s_waitcnt lgkmcnt(5)
v_mfma_f32_16x16x32_bf16 v[68:71],a[16:19],v[240:243],v[68:71]
buffer_store_dwordx4 v[88:91],v18,s[20:23],s70 offen offset:0 sc1
v_mfma_f32_16x16x32_bf16 v[76:79],a[144:147],v[240:243],v[76:79]
ds_read_b128 v[236:239],v17 offset:23552
v_mfma_f32_16x16x32_bf16 v[68:71],a[20:23],v[244:247],v[68:71]
buffer_load_dwordx4 v[104:107],v112,s[16:19],s43 offen nt
v_mfma_f32_16x16x32_bf16 v[76:79],a[148:151],v[244:247],v[76:79]
ds_read_b128 v[240:243],v17 offset:25600
s_waitcnt lgkmcnt(5)
v_mfma_f32_16x16x32_bf16 v[68:71],a[24:27],v[248:251],v[68:71]
buffer_load_ushort v108,v113,s[12:15],s48 offen
v_mfma_f32_16x16x32_bf16 v[76:79],a[152:155],v[248:251],v[76:79]
ds_read_b128 v[244:247],v17 offset:27648
v_mfma_f32_16x16x32_bf16 v[68:71],a[28:31],v[252:255],v[68:71]
v_mfma_f32_16x16x32_bf16 v[76:79],a[156:159],v[252:255],v[76:79]
ds_read_b128 v[248:251],v17 offset:29696
s_waitcnt lgkmcnt(5)
v_mfma_f32_16x16x32_bf16 v[68:71],a[32:35],v[224:227],v[68:71]
s_add_u32 s43,s43,786432
v_mfma_f32_16x16x32_bf16 v[76:79],a[160:163],v[224:227],v[76:79]
ds_read_b128 v[252:255],v17 offset:31744
v_mfma_f32_16x16x32_bf16 v[68:71],a[36:39],v[228:231],v[68:71]
s_add_u32 s48,s48,128
v_mfma_f32_16x16x32_bf16 v[76:79],a[164:167],v[228:231],v[76:79]
ds_read_b128 v[224:227],v17 offset:33792
s_waitcnt lgkmcnt(5)
v_mfma_f32_16x16x32_bf16 v[68:71],a[40:43],v[232:235],v[68:71]
v_mfma_f32_16x16x32_bf16 v[76:79],a[168:171],v[232:235],v[76:79]
ds_read_b128 v[228:231],v17 offset:35840
v_mfma_f32_16x16x32_bf16 v[68:71],a[44:47],v[236:239],v[68:71]
buffer_store_dwordx4 v[48:51],v24,s[20:23],s93 offen sc1
v_mfma_f32_16x16x32_bf16 v[76:79],a[172:175],v[236:239],v[76:79]
ds_read_b128 v[232:235],v17 offset:37888
s_waitcnt lgkmcnt(5)
v_mfma_f32_16x16x32_bf16 v[68:71],a[48:51],v[240:243],v[68:71]
buffer_store_dwordx4 v[48:51],v25,s[20:23],s93 offen sc1
v_mfma_f32_16x16x32_bf16 v[76:79],a[176:179],v[240:243],v[76:79]
ds_read_b128 v[236:239],v17 offset:39936
v_mfma_f32_16x16x32_bf16 v[68:71],a[52:55],v[244:247],v[68:71]
v_mfma_f32_16x16x32_bf16 v[76:79],a[180:183],v[244:247],v[76:79]
ds_read_b128 v[240:243],v17 offset:41984
s_waitcnt lgkmcnt(5)
v_mfma_f32_16x16x32_bf16 v[68:71],a[56:59],v[248:251],v[68:71]
s_add_u32 s93,s93,8388608
v_mfma_f32_16x16x32_bf16 v[76:79],a[184:187],v[248:251],v[76:79]
ds_read_b128 v[244:247],v17 offset:44032
v_mfma_f32_16x16x32_bf16 v[68:71],a[60:63],v[252:255],v[68:71]
s_cmp_lt_u32 s93,163577856
s_cselect_b32 s93,s93,0x7fff0000
v_mfma_f32_16x16x32_bf16 v[76:79],a[188:191],v[252:255],v[76:79]
ds_read_b128 v[248:251],v17 offset:46080
s_waitcnt lgkmcnt(5)
v_mfma_f32_16x16x32_bf16 v[68:71],a[64:67],v[224:227],v[68:71]
v_mfma_f32_16x16x32_bf16 v[76:79],a[192:195],v[224:227],v[76:79]
ds_read_b128 v[252:255],v17 offset:48128
v_mfma_f32_16x16x32_bf16 v[68:71],a[68:71],v[228:231],v[68:71]
buffer_store_dwordx4 v[48:51],v24,s[20:23],s42 offen sc1
v_mfma_f32_16x16x32_bf16 v[76:79],a[196:199],v[228:231],v[76:79]
ds_read_b128 v[224:227],v17 offset:50176
s_waitcnt lgkmcnt(5)
v_mfma_f32_16x16x32_bf16 v[68:71],a[72:75],v[232:235],v[68:71]
buffer_store_dwordx4 v[48:51],v25,s[20:23],s42 offen sc1
v_mfma_f32_16x16x32_bf16 v[76:79],a[200:203],v[232:235],v[76:79]
ds_read_b128 v[228:231],v17 offset:52224
v_mfma_f32_16x16x32_bf16 v[68:71],a[76:79],v[236:239],v[68:71]
s_add_u32 s42,s42,2097152
v_mfma_f32_16x16x32_bf16 v[76:79],a[204:207],v[236:239],v[76:79]
ds_read_b128 v[232:235],v17 offset:54272
s_waitcnt lgkmcnt(5)
v_mfma_f32_16x16x32_bf16 v[68:71],a[80:83],v[240:243],v[68:71]
v_mfma_f32_16x16x32_bf16 v[76:79],a[208:211],v[240:243],v[76:79]
ds_read_b128 v[236:239],v17 offset:56320
s_xor_b32 s42,s42,0x2000
v_mfma_f32_16x16x32_bf16 v[68:71],a[84:87],v[244:247],v[68:71]
v_mfma_f32_16x16x32_bf16 v[76:79],a[212:215],v[244:247],v[76:79]
ds_read_b128 v[240:243],v17 offset:58368
s_waitcnt lgkmcnt(5)
v_mfma_f32_16x16x32_bf16 v[68:71],a[88:91],v[248:251],v[68:71]
s_cmp_lt_u32 s42,165675008
s_cselect_b32 s42,s42,0x7fff0000
v_mfma_f32_16x16x32_bf16 v[76:79],a[216:219],v[248:251],v[76:79]
ds_read_b128 v[244:247],v17 offset:60416
v_mfma_f32_16x16x32_bf16 v[68:71],a[92:95],v[252:255],v[68:71]
v_mfma_f32_16x16x32_bf16 v[76:79],a[220:223],v[252:255],v[76:79]
ds_read_b128 v[248:251],v17 offset:62464
s_waitcnt lgkmcnt(5)
v_mfma_f32_16x16x32_bf16 v[68:71],a[96:99],v[224:227],v[68:71]
buffer_store_dwordx4 v[48:51],v24,s[20:23],s42 offen sc1
v_mfma_f32_16x16x32_bf16 v[76:79],a[224:227],v[224:227],v[76:79]
ds_read_b128 v[252:255],v17 offset:64512
v_mfma_f32_16x16x32_bf16 v[68:71],a[100:103],v[228:231],v[68:71]
buffer_store_dwordx4 v[48:51],v25,s[20:23],s42 offen sc1
v_mfma_f32_16x16x32_bf16 v[76:79],a[228:231],v[228:231],v[76:79]
s_waitcnt lgkmcnt(4)
v_mfma_f32_16x16x32_bf16 v[68:71],a[104:107],v[232:235],v[68:71]
v_mfma_f32_16x16x32_bf16 v[76:79],a[232:235],v[232:235],v[76:79]
s_add_u32 s42,s42,2097152
v_mfma_f32_16x16x32_bf16 v[68:71],a[108:111],v[236:239],v[68:71]
v_mfma_f32_16x16x32_bf16 v[76:79],a[236:239],v[236:239],v[76:79]
s_waitcnt lgkmcnt(2)
v_mfma_f32_16x16x32_bf16 v[68:71],a[112:115],v[240:243],v[68:71]
s_xor_b32 s42,s42,0x2000
v_mfma_f32_16x16x32_bf16 v[76:79],a[240:243],v[240:243],v[76:79]
v_mfma_f32_16x16x32_bf16 v[68:71],a[116:119],v[244:247],v[68:71]
v_mfma_f32_16x16x32_bf16 v[76:79],a[244:247],v[244:247],v[76:79]
s_waitcnt lgkmcnt(0)
v_mfma_f32_16x16x32_bf16 v[68:71],a[120:123],v[248:251],v[68:71]
s_cmp_lt_u32 s42,165675008
s_cselect_b32 s42,s42,0x7fff0000
v_mfma_f32_16x16x32_bf16 v[76:79],a[248:251],v[248:251],v[76:79]
v_mfma_f32_16x16x32_bf16 v[68:71],a[124:127],v[252:255],v[68:71]
v_mfma_f32_16x16x32_bf16 v[76:79],a[252:255],v[252:255],v[76:79]
v_xor_b32 v17,0x10000,v17
s_mov_b32 s79,s77
s_nop 4
v_cvt_pk_bf16_f32 v92,v68,v69
v_cvt_pk_bf16_f32 v93,v70,v71
v_cvt_pk_bf16_f32 v94,v76,v77
v_cvt_pk_bf16_f32 v95,v78,v79
buffer_store_dwordx4 v[92:95],v18,s[20:23],s70 offen offset:1024 sc1
s_waitcnt vmcnt(10)
s_barrier
ds_read_b128 v[224:227],v17 offset:0
ds_read_b128 v[228:231],v17 offset:2048
ds_read_b128 v[232:235],v17 offset:4096
ds_read_b128 v[236:239],v17 offset:6144
ds_read_b128 v[240:243],v17 offset:8192
ds_read_b128 v[244:247],v17 offset:10240
ds_read_b128 v[248:251],v17 offset:12288
s_waitcnt lgkmcnt(5)
v_mfma_f32_16x16x32_bf16 v[64:67],a[0:3],v[224:227],0
s_xor_b32 s72,s72,0x10000
s_add_u32 s77,s79,2
v_mfma_f32_16x16x32_bf16 v[72:75],a[128:131],v[224:227],0
ds_read_b128 v[252:255],v17 offset:14336
s_cmp_lt_u32 s79,56
s_cselect_b32 s77,s41,s77
v_mfma_f32_16x16x32_bf16 v[64:67],a[4:7],v[228:231],v[64:67]
s_add_u32 s74,s79,4
s_cmp_lt_u32 s79,52
s_cselect_b32 s77,s74,s77
v_mfma_f32_16x16x32_bf16 v[72:75],a[132:135],v[228:231],v[72:75]
ds_read_b128 v[224:227],v17 offset:16384
v_lshlrev_b32 v120,16,v120
s_waitcnt lgkmcnt(5)
v_mfma_f32_16x16x32_bf16 v[64:67],a[8:11],v[232:235],v[64:67]
s_lshl_b32 s74,s77,16
s_add_u32 s74,s74,s76
v_mul_f32 v109,s81,v120
v_mfma_f32_16x16x32_bf16 v[72:75],a[136:139],v[232:235],v[72:75]
ds_read_b128 v[228:231],v17 offset:18432
s_add_u32 s64,s79,0
v_mfma_f32_16x16x32_bf16 v[64:67],a[12:15],v[236:239],v[64:67]
s_cmp_lt_u32 s77,64
s_cselect_b32 s74,s74,0x7fff0000
v_mfma_f32_16x16x32_bf16 v[72:75],a[140:143],v[236:239],v[72:75]
ds_read_b128 v[232:235],v17 offset:20480
s_waitcnt lgkmcnt(5)
v_mfma_f32_16x16x32_bf16 v[64:67],a[16:19],v[240:243],v[64:67]
s_add_u32 m0,s72,0
v_exp_f32 v109,v109
v_mfma_f32_16x16x32_bf16 v[72:75],a[144:147],v[240:243],v[72:75]
ds_read_b128 v[236:239],v17 offset:22528
v_add_f32 v109,1.0,v109
v_mfma_f32_16x16x32_bf16 v[64:67],a[20:23],v[244:247],v[64:67]
s_add_u32 s65,s74,0
s_lshl_b32 s70,s64,21
v_mfma_f32_16x16x32_bf16 v[72:75],a[148:151],v[244:247],v[72:75]
ds_read_b128 v[240:243],v17 offset:24576
s_waitcnt lgkmcnt(5)
v_mfma_f32_16x16x32_bf16 v[64:67],a[24:27],v[248:251],v[64:67]
v_rcp_f32 v109,v109
v_mfma_f32_16x16x32_bf16 v[72:75],a[152:155],v[248:251],v[72:75]
ds_read_b128 v[244:247],v17 offset:26624
v_mul_f32 v109,v109,v120
v_mfma_f32_16x16x32_bf16 v[64:67],a[28:31],v[252:255],v[64:67]
buffer_load_dwordx4 v16,s[20:23],s65 offen offset:0  lds
v_mfma_f32_16x16x32_bf16 v[72:75],a[156:159],v[252:255],v[72:75]
ds_read_b128 v[248:251],v17 offset:28672
s_waitcnt lgkmcnt(5)
v_mfma_f32_16x16x32_bf16 v[64:67],a[32:35],v[224:227],v[64:67]
buffer_load_dwordx4 v16,s[20:23],s65 offen offset:1024  lds
v_mfma_f32_16x16x32_bf16 v[72:75],a[160:163],v[224:227],v[72:75]
ds_read_b128 v[252:255],v17 offset:30720
s_lshl_b32 s64,s64,13
v_mfma_f32_16x16x32_bf16 v[64:67],a[36:39],v[228:231],v[64:67]
buffer_load_dwordx4 v16,s[20:23],s65 offen offset:2048  lds
v_mfma_f32_16x16x32_bf16 v[72:75],a[164:167],v[228:231],v[72:75]
ds_read_b128 v[224:227],v17 offset:32768
s_waitcnt lgkmcnt(5)
v_mfma_f32_16x16x32_bf16 v[64:67],a[40:43],v[232:235],v[64:67]
buffer_load_dwordx4 v16,s[20:23],s65 offen offset:3072  lds
v_mfma_f32_16x16x32_bf16 v[72:75],a[168:171],v[232:235],v[72:75]
ds_read_b128 v[228:231],v17 offset:34816
s_and_b32 s64,s64,0x2000
v_mfma_f32_16x16x32_bf16 v[64:67],a[44:47],v[236:239],v[64:67]
v_cvt_pk_bf16_f32 v109,v109,v109
v_and_b32 v120,s80,v109
v_mfma_f32_16x16x32_bf16 v[72:75],a[172:175],v[236:239],v[72:75]
ds_read_b128 v[232:235],v17 offset:36864
s_waitcnt lgkmcnt(5)
v_mfma_f32_16x16x32_bf16 v[64:67],a[48:51],v[240:243],v[64:67]
s_add_u32 m0,s72,4096
v_lshlrev_b32 v110,16,v116
v_mfma_f32_16x16x32_bf16 v[72:75],a[176:179],v[240:243],v[72:75]
ds_read_b128 v[236:239],v17 offset:38912
s_add_u32 s65,s74,4096
v_mfma_f32_16x16x32_bf16 v[64:67],a[52:55],v[244:247],v[64:67]
s_xor_b32 s64,s64,s62
v_and_b32 v111,s80,v116
v_mfma_f32_16x16x32_bf16 v[72:75],a[180:183],v[244:247],v[72:75]
ds_read_b128 v[240:243],v17 offset:40960
s_waitcnt lgkmcnt(5)
v_mfma_f32_16x16x32_bf16 v[64:67],a[56:59],v[248:251],v[64:67]
buffer_load_dwordx4 v16,s[20:23],s65 offen offset:0  lds
v_mfma_f32_16x16x32_bf16 v[72:75],a[184:187],v[248:251],v[72:75]
ds_read_b128 v[244:247],v17 offset:43008
v_fmac_f32 v96,v110,v120
v_mfma_f32_16x16x32_bf16 v[64:67],a[60:63],v[252:255],v[64:67]
buffer_load_dwordx4 v16,s[20:23],s65 offen offset:1024  lds
v_mfma_f32_16x16x32_bf16 v[72:75],a[188:191],v[252:255],v[72:75]
ds_read_b128 v[248:251],v17 offset:45056
s_waitcnt lgkmcnt(5)
v_mfma_f32_16x16x32_bf16 v[64:67],a[64:67],v[224:227],v[64:67]
s_add_u32 s70,s70,s64
v_fmac_f32 v97,v111,v120
v_mfma_f32_16x16x32_bf16 v[72:75],a[192:195],v[224:227],v[72:75]
ds_read_b128 v[252:255],v17 offset:47104
v_lshlrev_b32 v110,16,v117
v_mfma_f32_16x16x32_bf16 v[64:67],a[68:71],v[228:231],v[64:67]
buffer_load_dwordx4 v16,s[20:23],s65 offen offset:2048  lds
v_mfma_f32_16x16x32_bf16 v[72:75],a[196:199],v[228:231],v[72:75]
ds_read_b128 v[224:227],v17 offset:49152
s_waitcnt lgkmcnt(5)
v_mfma_f32_16x16x32_bf16 v[64:67],a[72:75],v[232:235],v[64:67]
buffer_load_dwordx4 v16,s[20:23],s65 offen offset:3072  lds
v_mfma_f32_16x16x32_bf16 v[72:75],a[200:203],v[232:235],v[72:75]
ds_read_b128 v[228:231],v17 offset:51200
s_add_u32 s70,s70,29360128
v_mfma_f32_16x16x32_bf16 v[64:67],a[76:79],v[236:239],v[64:67]
s_add_u32 m0,s72,8192
v_and_b32 v111,s80,v117
v_mfma_f32_16x16x32_bf16 v[72:75],a[204:207],v[236:239],v[72:75]
ds_read_b128 v[232:235],v17 offset:53248
s_waitcnt lgkmcnt(5)
v_mfma_f32_16x16x32_bf16 v[64:67],a[80:83],v[240:243],v[64:67]
s_add_u32 s65,s74,8192
v_fmac_f32 v98,v110,v120
v_mfma_f32_16x16x32_bf16 v[72:75],a[208:211],v[240:243],v[72:75]
ds_read_b128 v[236:239],v17 offset:55296
v_fmac_f32 v99,v111,v120
v_mfma_f32_16x16x32_bf16 v[64:67],a[84:87],v[244:247],v[64:67]
v_lshlrev_b32 v110,16,v118
v_and_b32 v111,s80,v118
v_mfma_f32_16x16x32_bf16 v[72:75],a[212:215],v[244:247],v[72:75]
ds_read_b128 v[240:243],v17 offset:57344
s_waitcnt lgkmcnt(5)
v_mfma_f32_16x16x32_bf16 v[64:67],a[88:91],v[248:251],v[64:67]
buffer_load_dwordx4 v16,s[20:23],s65 offen offset:0  lds
v_mfma_f32_16x16x32_bf16 v[72:75],a[216:219],v[248:251],v[72:75]
ds_read_b128 v[244:247],v17 offset:59392
v_fmac_f32 v100,v110,v120
v_mfma_f32_16x16x32_bf16 v[64:67],a[92:95],v[252:255],v[64:67]
buffer_load_dwordx4 v16,s[20:23],s65 offen offset:1024  lds
v_mfma_f32_16x16x32_bf16 v[72:75],a[220:223],v[252:255],v[72:75]
ds_read_b128 v[248:251],v17 offset:61440
s_waitcnt lgkmcnt(5)
v_mfma_f32_16x16x32_bf16 v[64:67],a[96:99],v[224:227],v[64:67]
buffer_load_dwordx4 v16,s[20:23],s65 offen offset:2048  lds
v_mfma_f32_16x16x32_bf16 v[72:75],a[224:227],v[224:227],v[72:75]
ds_read_b128 v[252:255],v17 offset:63488
v_fmac_f32 v101,v111,v120
v_mfma_f32_16x16x32_bf16 v[64:67],a[100:103],v[228:231],v[64:67]
buffer_load_dwordx4 v16,s[20:23],s65 offen offset:3072  lds
v_mfma_f32_16x16x32_bf16 v[72:75],a[228:231],v[228:231],v[72:75]
ds_read_b128 v[224:227],v17 offset:1024
s_waitcnt lgkmcnt(5)
v_mfma_f32_16x16x32_bf16 v[64:67],a[104:107],v[232:235],v[64:67]
v_lshlrev_b32 v110,16,v119
v_and_b32 v111,s80,v119
v_mfma_f32_16x16x32_bf16 v[72:75],a[232:235],v[232:235],v[72:75]
ds_read_b128 v[228:231],v17 offset:3072
s_add_u32 m0,s72,12288
v_mfma_f32_16x16x32_bf16 v[64:67],a[108:111],v[236:239],v[64:67]
v_fmac_f32 v102,v110,v120
v_fmac_f32 v103,v111,v120
v_mfma_f32_16x16x32_bf16 v[72:75],a[236:239],v[236:239],v[72:75]
ds_read_b128 v[232:235],v17 offset:5120
s_waitcnt lgkmcnt(5)
v_mfma_f32_16x16x32_bf16 v[64:67],a[112:115],v[240:243],v[64:67]
s_add_u32 s65,s74,12288
v_mfma_f32_16x16x32_bf16 v[72:75],a[240:243],v[240:243],v[72:75]
ds_read_b128 v[236:239],v17 offset:7168
v_mfma_f32_16x16x32_bf16 v[64:67],a[116:119],v[244:247],v[64:67]
buffer_load_dwordx4 v16,s[20:23],s65 offen offset:0  lds
v_mfma_f32_16x16x32_bf16 v[72:75],a[244:247],v[244:247],v[72:75]
ds_read_b128 v[240:243],v17 offset:9216
s_waitcnt lgkmcnt(5)
v_mfma_f32_16x16x32_bf16 v[64:67],a[120:123],v[248:251],v[64:67]
buffer_load_dwordx4 v16,s[20:23],s65 offen offset:1024  lds
v_mfma_f32_16x16x32_bf16 v[72:75],a[248:251],v[248:251],v[72:75]
ds_read_b128 v[244:247],v17 offset:11264
v_mfma_f32_16x16x32_bf16 v[64:67],a[124:127],v[252:255],v[64:67]
v_mfma_f32_16x16x32_bf16 v[72:75],a[252:255],v[252:255],v[72:75]
ds_read_b128 v[248:251],v17 offset:13312
s_waitcnt lgkmcnt(5)
v_mfma_f32_16x16x32_bf16 v[68:71],a[0:3],v[224:227],0
buffer_load_dwordx4 v16,s[20:23],s65 offen offset:2048  lds
v_mfma_f32_16x16x32_bf16 v[76:79],a[128:131],v[224:227],0
ds_read_b128 v[252:255],v17 offset:15360
v_mfma_f32_16x16x32_bf16 v[68:71],a[4:7],v[228:231],v[68:71]
buffer_load_dwordx4 v16,s[20:23],s65 offen offset:3072  lds
v_mfma_f32_16x16x32_bf16 v[76:79],a[132:135],v[228:231],v[76:79]
ds_read_b128 v[224:227],v17 offset:17408
s_waitcnt lgkmcnt(5)
v_mfma_f32_16x16x32_bf16 v[68:71],a[8:11],v[232:235],v[68:71]
v_cvt_pk_bf16_f32 v88,v64,v65
v_cvt_pk_bf16_f32 v89,v66,v67
v_cvt_pk_bf16_f32 v90,v72,v73
v_cvt_pk_bf16_f32 v91,v74,v75
v_mfma_f32_16x16x32_bf16 v[76:79],a[136:139],v[232:235],v[76:79]
ds_read_b128 v[228:231],v17 offset:19456
v_mfma_f32_16x16x32_bf16 v[68:71],a[12:15],v[236:239],v[68:71]
v_mfma_f32_16x16x32_bf16 v[76:79],a[140:143],v[236:239],v[76:79]
ds_read_b128 v[232:235],v17 offset:21504
s_waitcnt lgkmcnt(5)
v_mfma_f32_16x16x32_bf16 v[68:71],a[16:19],v[240:243],v[68:71]
buffer_store_dwordx4 v[88:91],v18,s[20:23],s70 offen offset:0 sc1
v_mfma_f32_16x16x32_bf16 v[76:79],a[144:147],v[240:243],v[76:79]
ds_read_b128 v[236:239],v17 offset:23552
v_mfma_f32_16x16x32_bf16 v[68:71],a[20:23],v[244:247],v[68:71]
buffer_load_dwordx4 v[116:119],v112,s[16:19],s43 offen nt
v_mfma_f32_16x16x32_bf16 v[76:79],a[148:151],v[244:247],v[76:79]
ds_read_b128 v[240:243],v17 offset:25600
s_waitcnt lgkmcnt(5)
v_mfma_f32_16x16x32_bf16 v[68:71],a[24:27],v[248:251],v[68:71]
buffer_load_ushort v120,v113,s[12:15],s48 offen
v_mfma_f32_16x16x32_bf16 v[76:79],a[152:155],v[248:251],v[76:79]
ds_read_b128 v[244:247],v17 offset:27648
v_mfma_f32_16x16x32_bf16 v[68:71],a[28:31],v[252:255],v[68:71]
v_mfma_f32_16x16x32_bf16 v[76:79],a[156:159],v[252:255],v[76:79]
ds_read_b128 v[248:251],v17 offset:29696
s_waitcnt lgkmcnt(5)
v_mfma_f32_16x16x32_bf16 v[68:71],a[32:35],v[224:227],v[68:71]
s_add_u32 s43,s43,786432
v_mfma_f32_16x16x32_bf16 v[76:79],a[160:163],v[224:227],v[76:79]
ds_read_b128 v[252:255],v17 offset:31744
v_mfma_f32_16x16x32_bf16 v[68:71],a[36:39],v[228:231],v[68:71]
s_add_u32 s48,s48,128
v_mfma_f32_16x16x32_bf16 v[76:79],a[164:167],v[228:231],v[76:79]
ds_read_b128 v[224:227],v17 offset:33792
s_waitcnt lgkmcnt(5)
v_mfma_f32_16x16x32_bf16 v[68:71],a[40:43],v[232:235],v[68:71]
v_mfma_f32_16x16x32_bf16 v[76:79],a[168:171],v[232:235],v[76:79]
ds_read_b128 v[228:231],v17 offset:35840
v_mfma_f32_16x16x32_bf16 v[68:71],a[44:47],v[236:239],v[68:71]
buffer_store_dwordx4 v[48:51],v24,s[20:23],s93 offen sc1
v_mfma_f32_16x16x32_bf16 v[76:79],a[172:175],v[236:239],v[76:79]
ds_read_b128 v[232:235],v17 offset:37888
s_waitcnt lgkmcnt(5)
v_mfma_f32_16x16x32_bf16 v[68:71],a[48:51],v[240:243],v[68:71]
buffer_store_dwordx4 v[48:51],v25,s[20:23],s93 offen sc1
v_mfma_f32_16x16x32_bf16 v[76:79],a[176:179],v[240:243],v[76:79]
ds_read_b128 v[236:239],v17 offset:39936
v_mfma_f32_16x16x32_bf16 v[68:71],a[52:55],v[244:247],v[68:71]
v_mfma_f32_16x16x32_bf16 v[76:79],a[180:183],v[244:247],v[76:79]
ds_read_b128 v[240:243],v17 offset:41984
s_waitcnt lgkmcnt(5)
v_mfma_f32_16x16x32_bf16 v[68:71],a[56:59],v[248:251],v[68:71]
s_add_u32 s93,s93,8388608
v_mfma_f32_16x16x32_bf16 v[76:79],a[184:187],v[248:251],v[76:79]
ds_read_b128 v[244:247],v17 offset:44032
v_mfma_f32_16x16x32_bf16 v[68:71],a[60:63],v[252:255],v[68:71]
s_cmp_lt_u32 s93,163577856
s_cselect_b32 s93,s93,0x7fff0000
v_mfma_f32_16x16x32_bf16 v[76:79],a[188:191],v[252:255],v[76:79]
ds_read_b128 v[248:251],v17 offset:46080
s_waitcnt lgkmcnt(5)
v_mfma_f32_16x16x32_bf16 v[68:71],a[64:67],v[224:227],v[68:71]
v_mfma_f32_16x16x32_bf16 v[76:79],a[192:195],v[224:227],v[76:79]
ds_read_b128 v[252:255],v17 offset:48128
v_mfma_f32_16x16x32_bf16 v[68:71],a[68:71],v[228:231],v[68:71]
buffer_store_dwordx4 v[48:51],v24,s[20:23],s42 offen sc1
v_mfma_f32_16x16x32_bf16 v[76:79],a[196:199],v[228:231],v[76:79]
ds_read_b128 v[224:227],v17 offset:50176
s_waitcnt lgkmcnt(5)
v_mfma_f32_16x16x32_bf16 v[68:71],a[72:75],v[232:235],v[68:71]
buffer_store_dwordx4 v[48:51],v25,s[20:23],s42 offen sc1
v_mfma_f32_16x16x32_bf16 v[76:79],a[200:203],v[232:235],v[76:79]
ds_read_b128 v[228:231],v17 offset:52224
v_mfma_f32_16x16x32_bf16 v[68:71],a[76:79],v[236:239],v[68:71]
s_add_u32 s42,s42,2097152
v_mfma_f32_16x16x32_bf16 v[76:79],a[204:207],v[236:239],v[76:79]
ds_read_b128 v[232:235],v17 offset:54272
s_waitcnt lgkmcnt(5)
v_mfma_f32_16x16x32_bf16 v[68:71],a[80:83],v[240:243],v[68:71]
v_mfma_f32_16x16x32_bf16 v[76:79],a[208:211],v[240:243],v[76:79]
ds_read_b128 v[236:239],v17 offset:56320
s_xor_b32 s42,s42,0x2000
v_mfma_f32_16x16x32_bf16 v[68:71],a[84:87],v[244:247],v[68:71]
v_mfma_f32_16x16x32_bf16 v[76:79],a[212:215],v[244:247],v[76:79]
ds_read_b128 v[240:243],v17 offset:58368
s_waitcnt lgkmcnt(5)
v_mfma_f32_16x16x32_bf16 v[68:71],a[88:91],v[248:251],v[68:71]
s_cmp_lt_u32 s42,165675008
s_cselect_b32 s42,s42,0x7fff0000
v_mfma_f32_16x16x32_bf16 v[76:79],a[216:219],v[248:251],v[76:79]
ds_read_b128 v[244:247],v17 offset:60416
v_mfma_f32_16x16x32_bf16 v[68:71],a[92:95],v[252:255],v[68:71]
v_mfma_f32_16x16x32_bf16 v[76:79],a[220:223],v[252:255],v[76:79]
ds_read_b128 v[248:251],v17 offset:62464
s_waitcnt lgkmcnt(5)
v_mfma_f32_16x16x32_bf16 v[68:71],a[96:99],v[224:227],v[68:71]
buffer_store_dwordx4 v[48:51],v24,s[20:23],s42 offen sc1
v_mfma_f32_16x16x32_bf16 v[76:79],a[224:227],v[224:227],v[76:79]
ds_read_b128 v[252:255],v17 offset:64512
v_mfma_f32_16x16x32_bf16 v[68:71],a[100:103],v[228:231],v[68:71]
buffer_store_dwordx4 v[48:51],v25,s[20:23],s42 offen sc1
v_mfma_f32_16x16x32_bf16 v[76:79],a[228:231],v[228:231],v[76:79]
s_waitcnt lgkmcnt(4)
v_mfma_f32_16x16x32_bf16 v[68:71],a[104:107],v[232:235],v[68:71]
v_mfma_f32_16x16x32_bf16 v[76:79],a[232:235],v[232:235],v[76:79]
s_add_u32 s42,s42,2097152
v_mfma_f32_16x16x32_bf16 v[68:71],a[108:111],v[236:239],v[68:71]
v_mfma_f32_16x16x32_bf16 v[76:79],a[236:239],v[236:239],v[76:79]
s_waitcnt lgkmcnt(2)
v_mfma_f32_16x16x32_bf16 v[68:71],a[112:115],v[240:243],v[68:71]
s_xor_b32 s42,s42,0x2000
v_mfma_f32_16x16x32_bf16 v[76:79],a[240:243],v[240:243],v[76:79]
v_mfma_f32_16x16x32_bf16 v[68:71],a[116:119],v[244:247],v[68:71]
v_mfma_f32_16x16x32_bf16 v[76:79],a[244:247],v[244:247],v[76:79]
s_waitcnt lgkmcnt(0)
v_mfma_f32_16x16x32_bf16 v[68:71],a[120:123],v[248:251],v[68:71]
s_cmp_lt_u32 s42,165675008
s_cselect_b32 s42,s42,0x7fff0000
v_mfma_f32_16x16x32_bf16 v[76:79],a[248:251],v[248:251],v[76:79]
v_mfma_f32_16x16x32_bf16 v[68:71],a[124:127],v[252:255],v[68:71]
v_mfma_f32_16x16x32_bf16 v[76:79],a[252:255],v[252:255],v[76:79]
v_xor_b32 v17,0x10000,v17
s_mov_b32 s79,s77
s_nop 4
v_cvt_pk_bf16_f32 v92,v68,v69
v_cvt_pk_bf16_f32 v93,v70,v71
v_cvt_pk_bf16_f32 v94,v76,v77
v_cvt_pk_bf16_f32 v95,v78,v79
buffer_store_dwordx4 v[92:95],v18,s[20:23],s70 offen offset:1024 sc1
s_cmp_lt_u32 s79,64
s_cbranch_scc1 qloop_202
s_waitcnt vmcnt(0)
s_barrier
s_cmp_lg_u32 s41,64
s_cbranch_scc1 np3_208
s_cmp_lg_u32 s50,0
s_cbranch_scc1 ow_209
s_mov_b64 exec,1
v_mov_b32 v22,14
v_mov_b32 v23,0
s_mov_b32 s64,21052992
buffer_atomic_add v22,v23,s[20:23],s64 offen sc1
s_mov_b64 exec,-1
ow_209:
np3_208:
s_cmp_lg_u32 s50,0
s_cbranch_scc1 ow_210
s_mov_b64 exec,1
v_mov_b32 v22,18
v_mov_b32 v23,0
buffer_store_dword v22,v23,s[20:23],s73 offen sc1
s_mov_b64 exec,-1
ow_210:
v_lshlrev_b32 v108,16,v108
v_mul_f32 v109,s81,v108
v_exp_f32 v109,v109
s_nop 0
v_add_f32 v109,1.0,v109
v_rcp_f32 v109,v109
s_nop 0
v_mul_f32 v109,v109,v108
v_cvt_pk_bf16_f32 v109,v109,v109
v_and_b32 v108,s80,v109
v_lshlrev_b32 v110,16,v104
v_and_b32 v111,s80,v104
v_fmac_f32 v96,v110,v108
v_fmac_f32 v97,v111,v108
v_lshlrev_b32 v110,16,v105
v_and_b32 v111,s80,v105
v_fmac_f32 v98,v110,v108
v_fmac_f32 v99,v111,v108
v_lshlrev_b32 v110,16,v106
v_and_b32 v111,s80,v106
v_fmac_f32 v100,v110,v108
v_fmac_f32 v101,v111,v108
v_lshlrev_b32 v110,16,v107
v_and_b32 v111,s80,v107
v_fmac_f32 v102,v110,v108
v_fmac_f32 v103,v111,v108
v_lshlrev_b32 v120,16,v120
v_mul_f32 v109,s81,v120
v_exp_f32 v109,v109
s_nop 0
v_add_f32 v109,1.0,v109
v_rcp_f32 v109,v109
s_nop 0
v_mul_f32 v109,v109,v120
v_cvt_pk_bf16_f32 v109,v109,v109
v_and_b32 v120,s80,v109
v_lshlrev_b32 v110,16,v116
v_and_b32 v111,s80,v116
v_fmac_f32 v96,v110,v120
v_fmac_f32 v97,v111,v120
v_lshlrev_b32 v110,16,v117
v_and_b32 v111,s80,v117
v_fmac_f32 v98,v110,v120
v_fmac_f32 v99,v111,v120
v_lshlrev_b32 v110,16,v118
v_and_b32 v111,s80,v118
v_fmac_f32 v100,v110,v120
v_fmac_f32 v101,v111,v120
v_lshlrev_b32 v110,16,v119
v_and_b32 v111,s80,v119
v_fmac_f32 v102,v110,v120
v_fmac_f32 v103,v111,v120
v_lshlrev_b32 v5,5,v0
ds_write_b128 v5,v[96:99]
ds_write_b128 v5,v[100:103] offset:16
v_and_b32 v6,31,v0
v_lshrrev_b32 v7,5,v0
v_lshlrev_b32 v7,10,v7
v_lshl_add_u32 v7,v6,2,v7
s_waitcnt lgkmcnt(0)
s_barrier
ds_read_b32 v8,v7 offset:0
ds_read_b32 v9,v7 offset:128
ds_read_b32 v10,v7 offset:256
ds_read_b32 v11,v7 offset:384
ds_read_b32 v12,v7 offset:512
ds_read_b32 v13,v7 offset:640
ds_read_b32 v14,v7 offset:768
ds_read_b32 v15,v7 offset:896
s_waitcnt lgkmcnt(0)
v_add_f32 v8,v8,v9
v_add_f32 v8,v8,v10
v_add_f32 v8,v8,v11
v_add_f32 v8,v8,v12
v_add_f32 v8,v8,v13
v_add_f32 v8,v8,v14
v_add_f32 v8,v8,v15
v_lshlrev_b32 v5,2,v0
ds_write_b32 v5,v8 offset:8192
v_lshlrev_b32 v7,2,v6
s_waitcnt lgkmcnt(0)
s_barrier
ds_read_b32 v8,v7 offset:8192
ds_read_b32 v9,v7 offset:8320
ds_read_b32 v10,v7 offset:8448
ds_read_b32 v11,v7 offset:8576
ds_read_b32 v12,v7 offset:8704
ds_read_b32 v13,v7 offset:8832
ds_read_b32 v14,v7 offset:8960
ds_read_b32 v15,v7 offset:9088
s_waitcnt lgkmcnt(0)
v_add_f32 v8,v8,v9
v_add_f32 v8,v8,v10
v_add_f32 v8,v8,v11
v_add_f32 v8,v8,v12
v_add_f32 v8,v8,v13
v_add_f32 v8,v8,v14
v_add_f32 v8,v8,v15
v_cvt_pk_bf16_f32 v8,v8,v8
v_and_b32 v8,s80,v8
s_lshl_b32 s64,s55,7
s_add_u32 s64,s64,8192
s_cmp_lg_u32 s50,0
s_cbranch_scc1 ow_211
buffer_store_dword v8,v7,s[20:23],s64 offen sc1
ow_211:
s_waitcnt vmcnt(0)
s_barrier
s_cmp_lg_u32 s50,0
s_cbranch_scc1 ow_212
s_mov_b64 exec,1
v_mov_b32 v22,14
v_mov_b32 v23,0
s_mov_b32 s64,21052032
buffer_atomic_add v22,v23,s[20:23],s64 offen sc1
s_mov_b64 exec,-1
ow_212:
s_lshr_b32 s58,s55,5
s_and_b32 s59,s55,31
s_mov_b32 s57,65
s_mov_b32 s79,0
s_branch common_213
pipe_second:
s_cmp_ge_u32 s59,18
s_cbranch_scc1 giveup_197
s_getpc_b64 s[4:5]
pc2nd:
s_sub_u32 s8,s4,pc2nd-mega_kernel
s_subb_u32 s9,s5,0
s_and_b32 s9,s9,0xffff
s_mov_b32 s10,code_end-mega_kernel
s_mov_b32 s11,0x20000
s_lshl_b32 s12,s59,15
v_lshlrev_b32 v2,7,v0
buffer_load_dword v2,v2,s[8:11],s12 offen
s_add_u32 s55,s57,128
s_and_b32 s64,s59,1
s_lshl_b32 s65,s58,1
s_add_u32 s64,s64,s65
s_lshl_b32 s65,s59,2
s_and_b32 s65,s65,24
s_add_u32 s65,s65,s64
s_add_u32 s64,s64,24
s_cmp_ge_u32 s59,16
s_cselect_b32 s64,s64,s65
s_lshl_b32 s65,s58,3
s_add_u32 s65,s65,s59
s_lshr_b32 s58,s59,3
s_add_u32 s58,s58,1
s_cmp_lt_u32 s59,8
s_cselect_b32 s59,s65,s64
s_xor_b32 s62,s61,0x2000
s_add_u32 s63,s62,21053440
s_mov_b32 s57,65
s_mov_b32 s79,64
s_mov_b32 s90,400000
common_213:
v_and_b32 v1,63,v0
v_and_b32 v3,15,v1
v_lshrrev_b32 v4,4,v1
v_lshlrev_b32 v16,4,v1
v_mov_b32 v48,0
v_mov_b32 v49,0
v_mov_b32 v50,0
v_mov_b32 v51,0
s_mov_b64 s[24:25],s[20:21]
s_mov_b64 s[28:29],s[20:21]
s_mov_b32 s27,0x20000
s_mov_b32 s31,0x20000
s_cmp_eq_u32 s56,0
s_cselect_b32 s26,s22,0
s_cselect_b32 s30,0,s22
s_add_u32 s71,s79,1
s_lshl_b32 s60,s79,4
s_mov_b32 s98,0
s_mov_b32 s99,0
v_mov_b32 v29,0
v_cmp_eq_u32 vcc,0,v1
v_mov_b32 v23,0x40000000
s_nop 0
v_cndmask_b32 v23,v23,v48,vcc
s_mov_b32 s80,0xffff0000
s_cmp_eq_u32 s58,0
s_cbranch_scc1 r_wo_214
s_cmp_eq_u32 s58,1
s_cbranch_scc1 r_w3_215
s_cmp_eq_u32 s58,2
s_cbranch_scc1 r_w4_216
s_and_b32 s41,s59,15
s_cmp_lt_u32 s59,16
s_cbranch_scc1 r_at_219
s_cmp_ge_u32 s59,24
s_cbranch_scc1 r_w2_217
s_load_dwordx2 s[4:5],s[0:1],64
s_and_b32 s41,s59,7
s_lshl_b32 s66,s41,8
s_lshl_b32 s67,s50,1
s_waitcnt lgkmcnt(0)
s_mov_b32 s32,s4
s_and_b32 s33,s5,0xffff
s_mov_b32 s34,0x200000
s_mov_b32 s35,0x20000
v_lshrrev_b32 v5,2,v3
v_lshl_add_u32 v7,v4,3,v5
v_and_b32 v6,3,v3
v_lshlrev_b32 v6,3,v6
v_lshl_add_u32 v6,v7,8,v6
v_and_b32 v7,1,v4
v_lshl_add_u32 v5,v7,2,v5
v_xor_b32 v5,s67,v5
v_lshl_add_u32 v12,v5,5,v6
v_xor_b32 v13,32,v12
v_and_b32 v5,15,v1
v_and_b32 v6,3,v4
v_lshlrev_b32 v6,1,v6
v_xor_b32 v5,v5,v6
v_mul_u32_u24 v6,2048,v4
v_xor_b32 v7,0,v5
v_lshl_add_u32 v8,v7,4,v6
v_xor_b32 v7,8,v5
v_lshl_add_u32 v9,v7,4,v6
s_mul_i32 s74,s50,131072
s_add_u32 s74,s74,s66
s_lshl_b32 s75,s50,14
s_mul_i32 s76,s50,65536
s_add_u32 s76,s76,s66
s_lshl_b32 s77,s50,13
s_add_u32 s64,s74,0
s_add_u32 m0,s75,0
s_nop 0
buffer_load_dwordx4 v8,s[32:35],s64 offen nt lds
s_add_u32 s64,s74,8192
s_add_u32 m0,s75,1024
s_nop 0
buffer_load_dwordx4 v8,s[32:35],s64 offen nt lds
s_add_u32 s64,s74,16384
s_add_u32 m0,s75,2048
s_nop 0
buffer_load_dwordx4 v9,s[32:35],s64 offen nt lds
s_add_u32 s64,s74,24576
s_add_u32 m0,s75,3072
s_nop 0
buffer_load_dwordx4 v9,s[32:35],s64 offen nt lds
s_add_u32 s64,s74,32768
s_add_u32 m0,s75,4096
s_nop 0
buffer_load_dwordx4 v8,s[32:35],s64 offen nt lds
s_add_u32 s64,s74,40960
s_add_u32 m0,s75,5120
s_nop 0
buffer_load_dwordx4 v8,s[32:35],s64 offen nt lds
s_add_u32 s64,s74,49152
s_add_u32 m0,s75,6144
s_nop 0
buffer_load_dwordx4 v9,s[32:35],s64 offen nt lds
s_add_u32 s64,s74,57344
s_add_u32 m0,s75,7168
s_nop 0
buffer_load_dwordx4 v9,s[32:35],s64 offen nt lds
s_add_u32 s64,s74,65536
s_add_u32 m0,s75,8192
s_nop 0
buffer_load_dwordx4 v8,s[32:35],s64 offen nt lds
s_add_u32 s64,s74,73728
s_add_u32 m0,s75,9216
s_nop 0
buffer_load_dwordx4 v8,s[32:35],s64 offen nt lds
s_add_u32 s64,s74,81920
s_add_u32 m0,s75,10240
s_nop 0
buffer_load_dwordx4 v9,s[32:35],s64 offen nt lds
s_add_u32 s64,s74,90112
s_add_u32 m0,s75,11264
s_nop 0
buffer_load_dwordx4 v9,s[32:35],s64 offen nt lds
s_add_u32 s64,s74,98304
s_add_u32 m0,s75,12288
s_nop 0
buffer_load_dwordx4 v8,s[32:35],s64 offen nt lds
s_add_u32 s64,s74,106496
s_add_u32 m0,s75,13312
s_nop 0
buffer_load_dwordx4 v8,s[32:35],s64 offen nt lds
s_add_u32 s64,s74,114688
s_add_u32 m0,s75,14336
s_nop 0
buffer_load_dwordx4 v9,s[32:35],s64 offen nt lds
s_add_u32 s64,s74,122880
s_add_u32 m0,s75,15360
s_nop 0
buffer_load_dwordx4 v9,s[32:35],s64 offen nt lds
s_add_u32 s64,s74,524288
s_add_u32 m0,s75,65536
s_nop 0
buffer_load_dwordx4 v8,s[32:35],s64 offen nt lds
s_add_u32 s64,s74,532480
s_add_u32 m0,s75,66560
s_nop 0
buffer_load_dwordx4 v8,s[32:35],s64 offen nt lds
s_add_u32 s64,s74,540672
s_add_u32 m0,s75,67584
s_nop 0
buffer_load_dwordx4 v9,s[32:35],s64 offen nt lds
s_add_u32 s64,s74,548864
s_add_u32 m0,s75,68608
s_nop 0
buffer_load_dwordx4 v9,s[32:35],s64 offen nt lds
s_add_u32 s64,s74,557056
s_add_u32 m0,s75,69632
s_nop 0
buffer_load_dwordx4 v8,s[32:35],s64 offen nt lds
s_add_u32 s64,s74,565248
s_add_u32 m0,s75,70656
s_nop 0
buffer_load_dwordx4 v8,s[32:35],s64 offen nt lds
s_add_u32 s64,s74,573440
s_add_u32 m0,s75,71680
s_nop 0
buffer_load_dwordx4 v9,s[32:35],s64 offen nt lds
s_add_u32 s64,s74,581632
s_add_u32 m0,s75,72704
s_nop 0
buffer_load_dwordx4 v9,s[32:35],s64 offen nt lds
s_add_u32 s64,s74,589824
s_add_u32 m0,s75,73728
s_nop 0
buffer_load_dwordx4 v8,s[32:35],s64 offen nt lds
s_add_u32 s64,s74,598016
s_add_u32 m0,s75,74752
s_nop 0
buffer_load_dwordx4 v8,s[32:35],s64 offen nt lds
s_add_u32 s64,s74,606208
s_add_u32 m0,s75,75776
s_nop 0
buffer_load_dwordx4 v9,s[32:35],s64 offen nt lds
s_add_u32 s64,s74,614400
s_add_u32 m0,s75,76800
s_nop 0
buffer_load_dwordx4 v9,s[32:35],s64 offen nt lds
s_add_u32 s64,s74,622592
s_add_u32 m0,s75,77824
s_nop 0
buffer_load_dwordx4 v8,s[32:35],s64 offen nt lds
s_add_u32 s64,s74,630784
s_add_u32 m0,s75,78848
s_nop 0
buffer_load_dwordx4 v8,s[32:35],s64 offen nt lds
s_add_u32 s64,s74,638976
s_add_u32 m0,s75,79872
s_nop 0
buffer_load_dwordx4 v9,s[32:35],s64 offen nt lds
s_add_u32 s64,s74,647168
s_add_u32 m0,s75,80896
s_nop 0
buffer_load_dwordx4 v9,s[32:35],s64 offen nt lds
s_waitcnt vmcnt(16)
s_barrier
ds_read_b64_tr_b16 a[0:1],v12 offset:0
ds_read_b64_tr_b16 a[128:129],v13 offset:0
ds_read_b64_tr_b16 a[2:3],v12 offset:1024
ds_read_b64_tr_b16 a[130:131],v13 offset:1024
ds_read_b64_tr_b16 a[4:5],v12 offset:8192
ds_read_b64_tr_b16 a[132:133],v13 offset:8192
ds_read_b64_tr_b16 a[6:7],v12 offset:9216
ds_read_b64_tr_b16 a[134:135],v13 offset:9216
s_waitcnt lgkmcnt(4)
ds_read_b64_tr_b16 a[8:9],v12 offset:16384
ds_read_b64_tr_b16 a[136:137],v13 offset:16384
ds_read_b64_tr_b16 a[10:11],v12 offset:17408
ds_read_b64_tr_b16 a[138:139],v13 offset:17408
ds_read_b64_tr_b16 a[12:13],v12 offset:24576
ds_read_b64_tr_b16 a[140:141],v13 offset:24576
ds_read_b64_tr_b16 a[14:15],v12 offset:25600
ds_read_b64_tr_b16 a[142:143],v13 offset:25600
s_waitcnt lgkmcnt(4)
ds_read_b64_tr_b16 a[16:17],v12 offset:32768
ds_read_b64_tr_b16 a[144:145],v13 offset:32768
ds_read_b64_tr_b16 a[18:19],v12 offset:33792
ds_read_b64_tr_b16 a[146:147],v13 offset:33792
ds_read_b64_tr_b16 a[20:21],v12 offset:40960
ds_read_b64_tr_b16 a[148:149],v13 offset:40960
ds_read_b64_tr_b16 a[22:23],v12 offset:41984
ds_read_b64_tr_b16 a[150:151],v13 offset:41984
s_waitcnt lgkmcnt(4)
ds_read_b64_tr_b16 a[24:25],v12 offset:49152
ds_read_b64_tr_b16 a[152:153],v13 offset:49152
ds_read_b64_tr_b16 a[26:27],v12 offset:50176
ds_read_b64_tr_b16 a[154:155],v13 offset:50176
ds_read_b64_tr_b16 a[28:29],v12 offset:57344
ds_read_b64_tr_b16 a[156:157],v13 offset:57344
ds_read_b64_tr_b16 a[30:31],v12 offset:58368
ds_read_b64_tr_b16 a[158:159],v13 offset:58368
s_waitcnt lgkmcnt(4)
v_xor_b32 v12,0x10000,v12
v_xor_b32 v13,0x10000,v13
s_waitcnt lgkmcnt(0)
s_barrier
s_add_u32 s64,s74,1048576
s_add_u32 m0,s75,0
s_nop 0
buffer_load_dwordx4 v8,s[32:35],s64 offen nt lds
s_add_u32 s64,s74,1056768
s_add_u32 m0,s75,1024
s_nop 0
buffer_load_dwordx4 v8,s[32:35],s64 offen nt lds
s_add_u32 s64,s74,1064960
s_add_u32 m0,s75,2048
s_nop 0
buffer_load_dwordx4 v9,s[32:35],s64 offen nt lds
s_add_u32 s64,s74,1073152
s_add_u32 m0,s75,3072
s_nop 0
buffer_load_dwordx4 v9,s[32:35],s64 offen nt lds
s_add_u32 s64,s74,1081344
s_add_u32 m0,s75,4096
s_nop 0
buffer_load_dwordx4 v8,s[32:35],s64 offen nt lds
s_add_u32 s64,s74,1089536
s_add_u32 m0,s75,5120
s_nop 0
buffer_load_dwordx4 v8,s[32:35],s64 offen nt lds
s_add_u32 s64,s74,1097728
s_add_u32 m0,s75,6144
s_nop 0
buffer_load_dwordx4 v9,s[32:35],s64 offen nt lds
s_add_u32 s64,s74,1105920
s_add_u32 m0,s75,7168
s_nop 0
buffer_load_dwordx4 v9,s[32:35],s64 offen nt lds
s_add_u32 s64,s74,1114112
s_add_u32 m0,s75,8192
s_nop 0
buffer_load_dwordx4 v8,s[32:35],s64 offen nt lds
s_add_u32 s64,s74,1122304
s_add_u32 m0,s75,9216
s_nop 0
buffer_load_dwordx4 v8,s[32:35],s64 offen nt lds
s_add_u32 s64,s74,1130496
s_add_u32 m0,s75,10240
s_nop 0
buffer_load_dwordx4 v9,s[32:35],s64 offen nt lds
s_add_u32 s64,s74,1138688
s_add_u32 m0,s75,11264
s_nop 0
buffer_load_dwordx4 v9,s[32:35],s64 offen nt lds
s_add_u32 s64,s74,1146880
s_add_u32 m0,s75,12288
s_nop 0
buffer_load_dwordx4 v8,s[32:35],s64 offen nt lds
s_add_u32 s64,s74,1155072
s_add_u32 m0,s75,13312
s_nop 0
buffer_load_dwordx4 v8,s[32:35],s64 offen nt lds
s_add_u32 s64,s74,1163264
s_add_u32 m0,s75,14336
s_nop 0
buffer_load_dwordx4 v9,s[32:35],s64 offen nt lds
s_add_u32 s64,s74,1171456
s_add_u32 m0,s75,15360
s_nop 0
buffer_load_dwordx4 v9,s[32:35],s64 offen nt lds
s_waitcnt vmcnt(16)
s_barrier
ds_read_b64_tr_b16 a[32:33],v12 offset:0
ds_read_b64_tr_b16 a[160:161],v13 offset:0
ds_read_b64_tr_b16 a[34:35],v12 offset:1024
ds_read_b64_tr_b16 a[162:163],v13 offset:1024
ds_read_b64_tr_b16 a[36:37],v12 offset:8192
ds_read_b64_tr_b16 a[164:165],v13 offset:8192
ds_read_b64_tr_b16 a[38:39],v12 offset:9216
ds_read_b64_tr_b16 a[166:167],v13 offset:9216
s_waitcnt lgkmcnt(4)
ds_read_b64_tr_b16 a[40:41],v12 offset:16384
ds_read_b64_tr_b16 a[168:169],v13 offset:16384
ds_read_b64_tr_b16 a[42:43],v12 offset:17408
ds_read_b64_tr_b16 a[170:171],v13 offset:17408
ds_read_b64_tr_b16 a[44:45],v12 offset:24576
ds_read_b64_tr_b16 a[172:173],v13 offset:24576
ds_read_b64_tr_b16 a[46:47],v12 offset:25600
ds_read_b64_tr_b16 a[174:175],v13 offset:25600
s_waitcnt lgkmcnt(4)
ds_read_b64_tr_b16 a[48:49],v12 offset:32768
ds_read_b64_tr_b16 a[176:177],v13 offset:32768
ds_read_b64_tr_b16 a[50:51],v12 offset:33792
ds_read_b64_tr_b16 a[178:179],v13 offset:33792
ds_read_b64_tr_b16 a[52:53],v12 offset:40960
ds_read_b64_tr_b16 a[180:181],v13 offset:40960
ds_read_b64_tr_b16 a[54:55],v12 offset:41984
ds_read_b64_tr_b16 a[182:183],v13 offset:41984
s_waitcnt lgkmcnt(4)
ds_read_b64_tr_b16 a[56:57],v12 offset:49152
ds_read_b64_tr_b16 a[184:185],v13 offset:49152
ds_read_b64_tr_b16 a[58:59],v12 offset:50176
ds_read_b64_tr_b16 a[186:187],v13 offset:50176
ds_read_b64_tr_b16 a[60:61],v12 offset:57344
ds_read_b64_tr_b16 a[188:189],v13 offset:57344
ds_read_b64_tr_b16 a[62:63],v12 offset:58368
ds_read_b64_tr_b16 a[190:191],v13 offset:58368
s_waitcnt lgkmcnt(4)
v_xor_b32 v12,0x10000,v12
v_xor_b32 v13,0x10000,v13
s_waitcnt lgkmcnt(0)
s_barrier
s_add_u32 s64,s74,1572864
s_add_u32 m0,s75,65536
s_nop 0
buffer_load_dwordx4 v8,s[32:35],s64 offen nt lds
s_add_u32 s64,s74,1581056
s_add_u32 m0,s75,66560
s_nop 0
buffer_load_dwordx4 v8,s[32:35],s64 offen nt lds
s_add_u32 s64,s74,1589248
s_add_u32 m0,s75,67584
s_nop 0
buffer_load_dwordx4 v9,s[32:35],s64 offen nt lds
s_add_u32 s64,s74,1597440
s_add_u32 m0,s75,68608
s_nop 0
buffer_load_dwordx4 v9,s[32:35],s64 offen nt lds
s_add_u32 s64,s74,1605632
s_add_u32 m0,s75,69632
s_nop 0
buffer_load_dwordx4 v8,s[32:35],s64 offen nt lds
s_add_u32 s64,s74,1613824
s_add_u32 m0,s75,70656
s_nop 0
buffer_load_dwordx4 v8,s[32:35],s64 offen nt lds
s_add_u32 s64,s74,1622016
s_add_u32 m0,s75,71680
s_nop 0
buffer_load_dwordx4 v9,s[32:35],s64 offen nt lds
s_add_u32 s64,s74,1630208
s_add_u32 m0,s75,72704
s_nop 0
buffer_load_dwordx4 v9,s[32:35],s64 offen nt lds
s_add_u32 s64,s74,1638400
s_add_u32 m0,s75,73728
s_nop 0
buffer_load_dwordx4 v8,s[32:35],s64 offen nt lds
s_add_u32 s64,s74,1646592
s_add_u32 m0,s75,74752
s_nop 0
buffer_load_dwordx4 v8,s[32:35],s64 offen nt lds
s_add_u32 s64,s74,1654784
s_add_u32 m0,s75,75776
s_nop 0
buffer_load_dwordx4 v9,s[32:35],s64 offen nt lds
s_add_u32 s64,s74,1662976
s_add_u32 m0,s75,76800
s_nop 0
buffer_load_dwordx4 v9,s[32:35],s64 offen nt lds
s_add_u32 s64,s74,1671168
s_add_u32 m0,s75,77824
s_nop 0
buffer_load_dwordx4 v8,s[32:35],s64 offen nt lds
s_add_u32 s64,s74,1679360
s_add_u32 m0,s75,78848
s_nop 0
buffer_load_dwordx4 v8,s[32:35],s64 offen nt lds
s_add_u32 s64,s74,1687552
s_add_u32 m0,s75,79872
s_nop 0
buffer_load_dwordx4 v9,s[32:35],s64 offen nt lds
s_add_u32 s64,s74,1695744
s_add_u32 m0,s75,80896
s_nop 0
buffer_load_dwordx4 v9,s[32:35],s64 offen nt lds
s_waitcnt vmcnt(16)
s_barrier
ds_read_b64_tr_b16 a[64:65],v12 offset:0
ds_read_b64_tr_b16 a[192:193],v13 offset:0
ds_read_b64_tr_b16 a[66:67],v12 offset:1024
ds_read_b64_tr_b16 a[194:195],v13 offset:1024
ds_read_b64_tr_b16 a[68:69],v12 offset:8192
ds_read_b64_tr_b16 a[196:197],v13 offset:8192
ds_read_b64_tr_b16 a[70:71],v12 offset:9216
ds_read_b64_tr_b16 a[198:199],v13 offset:9216
s_waitcnt lgkmcnt(4)
ds_read_b64_tr_b16 a[72:73],v12 offset:16384
ds_read_b64_tr_b16 a[200:201],v13 offset:16384
ds_read_b64_tr_b16 a[74:75],v12 offset:17408
ds_read_b64_tr_b16 a[202:203],v13 offset:17408
ds_read_b64_tr_b16 a[76:77],v12 offset:24576
ds_read_b64_tr_b16 a[204:205],v13 offset:24576
ds_read_b64_tr_b16 a[78:79],v12 offset:25600
ds_read_b64_tr_b16 a[206:207],v13 offset:25600
s_waitcnt lgkmcnt(4)
ds_read_b64_tr_b16 a[80:81],v12 offset:32768
ds_read_b64_tr_b16 a[208:209],v13 offset:32768
ds_read_b64_tr_b16 a[82:83],v12 offset:33792
ds_read_b64_tr_b16 a[210:211],v13 offset:33792
ds_read_b64_tr_b16 a[84:85],v12 offset:40960
ds_read_b64_tr_b16 a[212:213],v13 offset:40960
ds_read_b64_tr_b16 a[86:87],v12 offset:41984
ds_read_b64_tr_b16 a[214:215],v13 offset:41984
s_waitcnt lgkmcnt(4)
ds_read_b64_tr_b16 a[88:89],v12 offset:49152
ds_read_b64_tr_b16 a[216:217],v13 offset:49152
ds_read_b64_tr_b16 a[90:91],v12 offset:50176
ds_read_b64_tr_b16 a[218:219],v13 offset:50176
ds_read_b64_tr_b16 a[92:93],v12 offset:57344
ds_read_b64_tr_b16 a[220:221],v13 offset:57344
ds_read_b64_tr_b16 a[94:95],v12 offset:58368
ds_read_b64_tr_b16 a[222:223],v13 offset:58368
s_waitcnt lgkmcnt(4)
v_xor_b32 v12,0x10000,v12
v_xor_b32 v13,0x10000,v13
s_waitcnt lgkmcnt(0)
s_barrier
s_waitcnt vmcnt(0)
s_barrier
ds_read_b64_tr_b16 a[96:97],v12 offset:0
ds_read_b64_tr_b16 a[224:225],v13 offset:0
ds_read_b64_tr_b16 a[98:99],v12 offset:1024
ds_read_b64_tr_b16 a[226:227],v13 offset:1024
ds_read_b64_tr_b16 a[100:101],v12 offset:8192
ds_read_b64_tr_b16 a[228:229],v13 offset:8192
ds_read_b64_tr_b16 a[102:103],v12 offset:9216
ds_read_b64_tr_b16 a[230:231],v13 offset:9216
s_waitcnt lgkmcnt(4)
ds_read_b64_tr_b16 a[104:105],v12 offset:16384
ds_read_b64_tr_b16 a[232:233],v13 offset:16384
ds_read_b64_tr_b16 a[106:107],v12 offset:17408
ds_read_b64_tr_b16 a[234:235],v13 offset:17408
ds_read_b64_tr_b16 a[108:109],v12 offset:24576
ds_read_b64_tr_b16 a[236:237],v13 offset:24576
ds_read_b64_tr_b16 a[110:111],v12 offset:25600
ds_read_b64_tr_b16 a[238:239],v13 offset:25600
s_waitcnt lgkmcnt(4)
ds_read_b64_tr_b16 a[112:113],v12 offset:32768
ds_read_b64_tr_b16 a[240:241],v13 offset:32768
ds_read_b64_tr_b16 a[114:115],v12 offset:33792
ds_read_b64_tr_b16 a[242:243],v13 offset:33792
ds_read_b64_tr_b16 a[116:117],v12 offset:40960
ds_read_b64_tr_b16 a[244:245],v13 offset:40960
ds_read_b64_tr_b16 a[118:119],v12 offset:41984
ds_read_b64_tr_b16 a[246:247],v13 offset:41984
s_waitcnt lgkmcnt(4)
ds_read_b64_tr_b16 a[120:121],v12 offset:49152
ds_read_b64_tr_b16 a[248:249],v13 offset:49152
ds_read_b64_tr_b16 a[122:123],v12 offset:50176
ds_read_b64_tr_b16 a[250:251],v13 offset:50176
ds_read_b64_tr_b16 a[124:125],v12 offset:57344
ds_read_b64_tr_b16 a[252:253],v13 offset:57344
ds_read_b64_tr_b16 a[126:127],v12 offset:58368
ds_read_b64_tr_b16 a[254:255],v13 offset:58368
s_waitcnt lgkmcnt(4)
v_xor_b32 v12,0x10000,v12
v_xor_b32 v13,0x10000,v13
s_waitcnt lgkmcnt(0)
s_barrier
v_and_b32 v21,1,v1
v_mul_u32_u24 v21,960,v21
s_mov_b32 s65,21052032
s_mov_b32 s66,1792
pl_220:
buffer_load_dword v22,v21,s[20:23],s65 offen sc1
s_waitcnt vmcnt(0)
v_cmp_gt_u32 vcc,s66,v22
s_cbranch_vccz pok_221
s_sleep 1
s_sub_u32 s90,s90,1
s_cmp_gt_i32 s90,0
s_cbranch_scc1 pl_220
pok_221:
s_mov_b32 s81,0xbdd2d3e8
v_mov_b32 v28,0xc0135761
v_mov_b32 v17,v16
v_and_b32 v21,31,v1
v_lshlrev_b32 v21,2,v21
s_mul_i32 s74,s79,40
s_add_u32 s74,s74,s63
s_add_u32 s74,s74,2560
s_lshl_b32 s42,s41,2
s_add_u32 s42,s42,s50
s_lshl_b32 s73,s41,4
s_lshl_b32 s64,s50,2
s_add_u32 s73,s73,s64
s_add_u32 s73,s73,s63
s_add_u32 s73,s73,3072
s_add_u32 s73,s73,s60
s_lshl_b32 s43,s50,11
s_lshl_b32 s78,s79,21
s_add_u32 s78,s78,29360128
s_mov_b32 s64,0
s_lshr_b32 s65,s50,1
s_and_b32 s66,s50,1
s_lshl_b32 s72,s65,13
s_lshl_b32 s64,s66,11
s_add_u32 s72,s72,s64
s_add_u32 s72,s72,0x10000
s_lshl_b32 s75,s66,15
s_lshl_b32 s64,s65,7
s_add_u32 s75,s75,s64
s_add_u32 s75,s75,1835008
s_lshl_b32 s64,s66,2
v_add_u32 v5,s64,v4
v_and_b32 v6,7,v1
v_xor_b32 v5,v5,v6
v_lshlrev_b32 v5,4,v5
v_bfe_u32 v6,v1,3,2
v_lshl_add_u32 v5,v6,11,v5
v_lshrrev_b32 v6,5,v1
v_lshl_add_u32 v42,v6,14,v5
v_lshrrev_b32 v5,1,v3
v_xor_b32 v5,v5,v4
v_lshlrev_b32 v5,4,v5
v_and_b32 v6,7,v3
v_lshl_add_u32 v5,v6,7,v5
v_lshrrev_b32 v6,3,v3
v_lshl_add_u32 v17,v6,11,v5
v_xor_b32 v43,64,v17
s_lshr_b32 s64,s41,1
s_lshl_b32 s64,s64,2
s_lshr_b32 s64,0x0413,s64
s_and_b32 s64,s64,7
s_add_u32 s65,s41,120
s_lshl_b32 s65,s65,14
s_add_u32 s65,s65,s43
v_lshl_add_u32 v7,v4,8,s65
v_mov_b32 v9,2105344
v_add_u32 v6,s64,v3
v_and_b32 v5,15,v6
v_lshl_add_u32 v5,v5,4,v7
v_bfe_u32 v8,v6,4,1
v_lshl_add_u32 v5,v8,10,v5
v_cmp_lt_u32 vcc,31,v6
s_nop 1
v_cndmask_b32 v8,0,v9,vcc
v_add_u32 v5,v5,v8
v_xor_b32 v18,s62,v5
s_add_u32 s64,s64,16
v_add_u32 v6,s64,v3
v_and_b32 v5,15,v6
v_lshl_add_u32 v5,v5,4,v7
v_bfe_u32 v8,v6,4,1
v_lshl_add_u32 v5,v8,10,v5
v_cmp_lt_u32 vcc,31,v6
s_nop 1
v_cndmask_b32 v8,0,v9,vcc
v_add_u32 v5,v5,v8
v_xor_b32 v19,s62,v5
s_add_u32 s64,s64,16
s_mov_b64 s[84:85],vcc
v_mov_b32 v88,1
v_mov_b32 v89,0
v_mov_b32 v90,0
v_mov_b32 v91,0
v_xor_b32 v5,0x2000,v19
s_mov_b32 s64,163577856
buffer_store_dwordx4 v[88:91],v18,s[20:23],s64 offen sc1
s_andn2_b64 exec,exec,s[84:85]
buffer_store_dwordx4 v[88:91],v19,s[20:23],s64 offen sc1
s_mov_b64 exec,-1
v_mov_b32 v6,0x7fff0000
v_cndmask_b32 v5,v6,v5,s[84:85]
s_mov_b32 s64,27262976
buffer_store_dwordx4 v[88:91],v5,s[20:23],s64 offen sc1
s_waitcnt vmcnt(0)
s_add_u32 s64,s79,0
s_lshl_b32 s70,s64,21
s_lshl_b32 s64,s64,13
s_and_b32 s64,s64,0x2000
s_xor_b32 s64,s64,s62
s_add_u32 s70,s70,s64
s_add_u32 s70,s70,29360128
s_mov_b32 s83,1
s_mov_b32 s87,s74
s_cmp_eq_u32 s50,0
s_cselect_b32 s74,s74,0x7fff0000
v_mov_b32 v47,132096
s_lshl_b32 s64,s50,3
s_add_u32 s64,s64,132096
v_mov_b32 v46,s64
v_mov_b32 v29,0
s_mov_b32 s97,0x7fff0000
s_mov_b32 s69,1
s_mov_b32 s68,0
s_mov_b32 s52,0x30003
s_mov_b32 s53,s52
seg_223:
s_cmp_eq_u32 s83,0
s_cbranch_scc1 ahead_224
s_add_u32 s94,s70,s75
s_add_u32 s95,s94,65536
s_xor_b32 s91,s72,0x10000
s_waitcnt vmcnt(3)
v_cmp_gt_u32 vcc,s71,v29
s_cbranch_vccz nb_227
s_waitcnt vmcnt(0)
v_add_u32 v22,s71,-1
buffer_store_dword v22,v23,s[24:27],s97 offen
buffer_store_dword v22,v23,s[28:31],s97 offen sc1
s_mov_b32 s97,0x7fff0000
s_cmp_lg_u32 s50,0
s_cbranch_scc1 nb_227
buffer_load_dword v32,v21,s[20:23],s74 offen sc1
s_sleep 2
pl_229:
buffer_load_dword v33,v21,s[20:23],s74 offen sc1
s_waitcnt vmcnt(1)
v_cmp_gt_u32 vcc,s71,v32
v_mov_b32 v29,v32
s_cbranch_vccz pok_230
buffer_load_dword v32,v21,s[20:23],s74 offen sc1
s_waitcnt vmcnt(1)
v_cmp_gt_u32 vcc,s71,v33
v_mov_b32 v29,v33
s_cbranch_vccz pok_230
s_sub_u32 s90,s90,1
s_cmp_gt_i32 s90,0
s_cbranch_scc1 pl_229
pok_230:
nb_227:
s_barrier
s_xor_b32 m0,s91,0
s_add_u32 s65,s94,0
buffer_load_dwordx4 v42,s[20:23],s65 offen offset:0 sc1 lds
buffer_load_dwordx4 v42,s[20:23],s65 offen offset:1024 sc1 lds
s_xor_b32 m0,s91,16384
s_add_u32 s65,s94,256
buffer_load_dwordx4 v42,s[20:23],s65 offen offset:0 sc1 lds
buffer_load_dwordx4 v42,s[20:23],s65 offen offset:1024 sc1 lds
s_xor_b32 m0,s91,32768
s_add_u32 s65,s94,512
buffer_load_dwordx4 v42,s[20:23],s65 offen offset:0 sc1 lds
buffer_load_dwordx4 v42,s[20:23],s65 offen offset:1024 sc1 lds
s_xor_b32 m0,s91,49152
s_add_u32 s65,s94,768
buffer_load_dwordx4 v42,s[20:23],s65 offen offset:0 sc1 lds
buffer_load_dwordx4 v42,s[20:23],s65 offen offset:1024 sc1 lds
s_waitcnt vmcnt(8)
v_add_u32 v22,s71,-1
buffer_store_dword v22,v23,s[24:27],s97 offen
buffer_store_dword v22,v23,s[28:31],s97 offen sc1
s_mov_b32 s97,0x7fff0000
s_waitcnt vmcnt(8)
s_barrier
ds_read_b128 v[224:227],v17 offset:0
ds_read_b128 v[228:231],v43 offset:0
ds_read_b128 v[232:235],v17 offset:8192
ds_read_b128 v[236:239],v43 offset:8192
ds_read_b128 v[240:243],v17 offset:1024
ds_read_b128 v[244:247],v43 offset:1024
ds_read_b128 v[248:251],v17 offset:9216
s_waitcnt lgkmcnt(5)
v_mfma_f32_16x16x32_bf16 v[64:67],a[0:3],v[224:227],0
s_xor_b32 m0,s91,4096
s_add_u32 s96,s71,1
v_mfma_f32_16x16x32_bf16 v[72:75],a[128:131],v[224:227],0
ds_read_b128 v[252:255],v43 offset:9216
s_add_u32 s92,s71,2
v_mfma_f32_16x16x32_bf16 v[64:67],a[4:7],v[228:231],v[64:67]
s_add_u32 s65,s95,0
v_min_u32 v27,v224,v228
v_mfma_f32_16x16x32_bf16 v[72:75],a[132:135],v[228:231],v[72:75]
s_waitcnt vmcnt(6)
s_barrier
ds_read_b128 v[224:227],v17 offset:16384
s_waitcnt lgkmcnt(5)
v_mfma_f32_16x16x32_bf16 v[64:67],a[8:11],v[232:235],v[64:67]
buffer_load_dwordx4 v42,s[20:23],s65 offen offset:0 sc1 lds
v_mfma_f32_16x16x32_bf16 v[72:75],a[136:139],v[232:235],v[72:75]
ds_read_b128 v[228:231],v43 offset:16384
v_min3_u32 v27,v27,v232,v236
v_mfma_f32_16x16x32_bf16 v[64:67],a[12:15],v[236:239],v[64:67]
buffer_load_dwordx4 v42,s[20:23],s65 offen offset:1024 sc1 lds
v_mfma_f32_16x16x32_bf16 v[72:75],a[140:143],v[236:239],v[72:75]
ds_read_b128 v[232:235],v17 offset:24576
s_waitcnt lgkmcnt(5)
v_mfma_f32_16x16x32_bf16 v[64:67],a[64:67],v[240:243],v[64:67]
s_xor_b32 m0,s91,20480
v_min3_u32 v27,v27,v240,v244
v_mfma_f32_16x16x32_bf16 v[72:75],a[192:195],v[240:243],v[72:75]
ds_read_b128 v[236:239],v43 offset:24576
v_mfma_f32_16x16x32_bf16 v[64:67],a[68:71],v[244:247],v[64:67]
s_add_u32 s65,s95,256
v_mfma_f32_16x16x32_bf16 v[72:75],a[196:199],v[244:247],v[72:75]
ds_read_b128 v[240:243],v17 offset:17408
s_waitcnt lgkmcnt(5)
v_mfma_f32_16x16x32_bf16 v[64:67],a[72:75],v[248:251],v[64:67]
buffer_load_dwordx4 v42,s[20:23],s65 offen offset:0 sc1 lds
v_mfma_f32_16x16x32_bf16 v[72:75],a[200:203],v[248:251],v[72:75]
ds_read_b128 v[244:247],v43 offset:17408
v_min3_u32 v27,v27,v248,v252
v_mfma_f32_16x16x32_bf16 v[64:67],a[76:79],v[252:255],v[64:67]
buffer_load_dwordx4 v42,s[20:23],s65 offen offset:1024 sc1 lds
v_mfma_f32_16x16x32_bf16 v[72:75],a[204:207],v[252:255],v[72:75]
ds_read_b128 v[248:251],v17 offset:25600
s_waitcnt lgkmcnt(5)
v_mfma_f32_16x16x32_bf16 v[64:67],a[16:19],v[224:227],v[64:67]
s_xor_b32 m0,s91,36864
v_min3_u32 v27,v27,v224,v228
v_mfma_f32_16x16x32_bf16 v[72:75],a[144:147],v[224:227],v[72:75]
ds_read_b128 v[252:255],v43 offset:25600
v_mfma_f32_16x16x32_bf16 v[64:67],a[20:23],v[228:231],v[64:67]
s_add_u32 s65,s95,512
v_mfma_f32_16x16x32_bf16 v[72:75],a[148:151],v[228:231],v[72:75]
s_waitcnt vmcnt(6)
s_barrier
ds_read_b128 v[224:227],v17 offset:32768
s_waitcnt lgkmcnt(5)
v_mfma_f32_16x16x32_bf16 v[64:67],a[24:27],v[232:235],v[64:67]
buffer_load_dwordx4 v42,s[20:23],s65 offen offset:0 sc1 lds
v_mfma_f32_16x16x32_bf16 v[72:75],a[152:155],v[232:235],v[72:75]
ds_read_b128 v[228:231],v43 offset:32768
v_min3_u32 v27,v27,v232,v236
v_mfma_f32_16x16x32_bf16 v[64:67],a[28:31],v[236:239],v[64:67]
buffer_load_dwordx4 v42,s[20:23],s65 offen offset:1024 sc1 lds
v_mfma_f32_16x16x32_bf16 v[72:75],a[156:159],v[236:239],v[72:75]
ds_read_b128 v[232:235],v17 offset:40960
s_waitcnt lgkmcnt(5)
v_mfma_f32_16x16x32_bf16 v[64:67],a[80:83],v[240:243],v[64:67]
s_xor_b32 m0,s91,53248
v_min3_u32 v27,v27,v240,v244
v_mfma_f32_16x16x32_bf16 v[72:75],a[208:211],v[240:243],v[72:75]
ds_read_b128 v[236:239],v43 offset:40960
v_mfma_f32_16x16x32_bf16 v[64:67],a[84:87],v[244:247],v[64:67]
s_add_u32 s65,s95,768
v_mfma_f32_16x16x32_bf16 v[72:75],a[212:215],v[244:247],v[72:75]
ds_read_b128 v[240:243],v17 offset:33792
s_waitcnt lgkmcnt(5)
v_mfma_f32_16x16x32_bf16 v[64:67],a[88:91],v[248:251],v[64:67]
buffer_load_dwordx4 v42,s[20:23],s65 offen offset:0 sc1 lds
v_min3_u32 v27,v27,v248,v252
v_mfma_f32_16x16x32_bf16 v[72:75],a[216:219],v[248:251],v[72:75]
ds_read_b128 v[244:247],v43 offset:33792
s_waitcnt vmcnt(63)
v_mfma_f32_16x16x32_bf16 v[64:67],a[92:95],v[252:255],v[64:67]
buffer_load_dwordx4 v42,s[20:23],s65 offen offset:1024 sc1 lds
v_mfma_f32_16x16x32_bf16 v[72:75],a[220:223],v[252:255],v[72:75]
ds_read_b128 v[248:251],v17 offset:41984
s_waitcnt lgkmcnt(5)
v_mfma_f32_16x16x32_bf16 v[64:67],a[32:35],v[224:227],v[64:67]
v_cmp_gt_u32 vcc,s96,v29
v_cmp_gt_u32 s[92:93],s92,v29
v_mfma_f32_16x16x32_bf16 v[72:75],a[160:163],v[224:227],v[72:75]
ds_read_b128 v[252:255],v43 offset:41984
v_min3_u32 v27,v27,v224,v228
v_mfma_f32_16x16x32_bf16 v[64:67],a[36:39],v[228:231],v[64:67]
v_mov_b32 v44,vcc_lo
v_mov_b32 v45,s92
v_mfma_f32_16x16x32_bf16 v[72:75],a[164:167],v[228:231],v[72:75]
ds_read_b128 v[224:227],v17 offset:49152
s_waitcnt lgkmcnt(5)
v_mfma_f32_16x16x32_bf16 v[64:67],a[40:43],v[232:235],v[64:67]
ds_write_b64 v46,v[44:45]
v_min3_u32 v27,v27,v232,v236
v_mfma_f32_16x16x32_bf16 v[72:75],a[168:171],v[232:235],v[72:75]
ds_read_b128 v[228:231],v43 offset:49152
v_mfma_f32_16x16x32_bf16 v[64:67],a[44:47],v[236:239],v[64:67]
v_mfma_f32_16x16x32_bf16 v[72:75],a[172:175],v[236:239],v[72:75]
ds_read_b128 v[232:235],v17 offset:57344
s_waitcnt lgkmcnt(6)
v_mfma_f32_16x16x32_bf16 v[64:67],a[96:99],v[240:243],v[64:67]
v_min3_u32 v27,v27,v240,v244
s_add_u32 s88,s70,s75
v_mfma_f32_16x16x32_bf16 v[72:75],a[224:227],v[240:243],v[72:75]
ds_read_b128 v[236:239],v43 offset:57344
s_add_u32 s88,s88,2097152
v_mfma_f32_16x16x32_bf16 v[64:67],a[100:103],v[244:247],v[64:67]
s_xor_b32 s88,s88,0x2000
s_add_u32 s89,s88,65536
v_mfma_f32_16x16x32_bf16 v[72:75],a[228:231],v[244:247],v[72:75]
ds_read_b128 v[240:243],v17 offset:50176
s_waitcnt lgkmcnt(6)
v_mfma_f32_16x16x32_bf16 v[64:67],a[104:107],v[248:251],v[64:67]
v_min3_u32 v27,v27,v248,v252
v_mfma_f32_16x16x32_bf16 v[72:75],a[232:235],v[248:251],v[72:75]
ds_read_b128 v[244:247],v43 offset:50176
v_mfma_f32_16x16x32_bf16 v[64:67],a[108:111],v[252:255],v[64:67]
v_mfma_f32_16x16x32_bf16 v[72:75],a[236:239],v[252:255],v[72:75]
ds_read_b128 v[248:251],v17 offset:58368
s_waitcnt lgkmcnt(5)
v_mfma_f32_16x16x32_bf16 v[64:67],a[48:51],v[224:227],v[64:67]
v_min3_u32 v27,v27,v224,v228
v_mfma_f32_16x16x32_bf16 v[72:75],a[176:179],v[224:227],v[72:75]
ds_read_b128 v[252:255],v43 offset:58368
v_mfma_f32_16x16x32_bf16 v[64:67],a[52:55],v[228:231],v[64:67]
v_mfma_f32_16x16x32_bf16 v[72:75],a[180:183],v[228:231],v[72:75]
s_waitcnt vmcnt(4)
s_barrier
ds_read_b64 v[44:45],v47
ds_read_b128 v[224:227],v17 offset:4096
s_waitcnt lgkmcnt(6)
v_mfma_f32_16x16x32_bf16 v[64:67],a[56:59],v[232:235],v[64:67]
v_min3_u32 v27,v27,v232,v236
v_mfma_f32_16x16x32_bf16 v[72:75],a[184:187],v[232:235],v[72:75]
ds_read_b128 v[228:231],v43 offset:4096
v_mfma_f32_16x16x32_bf16 v[64:67],a[60:63],v[236:239],v[64:67]
v_mfma_f32_16x16x32_bf16 v[72:75],a[188:191],v[236:239],v[72:75]
ds_read_b128 v[232:235],v17 offset:12288
s_waitcnt lgkmcnt(6)
v_mfma_f32_16x16x32_bf16 v[64:67],a[112:115],v[240:243],v[64:67]
v_min3_u32 v27,v27,v240,v244
v_mfma_f32_16x16x32_bf16 v[72:75],a[240:243],v[240:243],v[72:75]
ds_read_b128 v[236:239],v43 offset:12288
v_mfma_f32_16x16x32_bf16 v[64:67],a[116:119],v[244:247],v[64:67]
v_mfma_f32_16x16x32_bf16 v[72:75],a[244:247],v[244:247],v[72:75]
ds_read_b128 v[240:243],v17 offset:5120
s_waitcnt lgkmcnt(6)
v_mfma_f32_16x16x32_bf16 v[64:67],a[120:123],v[248:251],v[64:67]
s_waitcnt lgkmcnt(5)
v_readfirstlane_b32 s93,v45
v_mfma_f32_16x16x32_bf16 v[72:75],a[248:251],v[248:251],v[72:75]
ds_read_b128 v[244:247],v43 offset:5120
v_readfirstlane_b32 s83,v44
s_cmp_lg_u32 s83,0
s_cbranch_scc0 keep_233
v_mfma_f32_16x16x32_bf16 v[64:67],a[124:127],v[252:255],v[64:67]
v_min3_u32 v27,v27,v248,v252
v_mfma_f32_16x16x32_bf16 v[72:75],a[252:255],v[252:255],v[72:75]
ds_read_b128 v[248:251],v17 offset:13312
s_waitcnt lgkmcnt(5)
v_mfma_f32_16x16x32_bf16 v[68:71],a[0:3],v[224:227],0
v_cmp_eq_u32 vcc,0,v27
s_cbranch_vccnz retry_222
v_mfma_f32_16x16x32_bf16 v[76:79],a[128:131],v[224:227],0
ds_read_b128 v[252:255],v43 offset:13312
v_min3_u32 v27,v27,v224,v228
v_mfma_f32_16x16x32_bf16 v[68:71],a[4:7],v[228:231],v[68:71]
v_mfma_f32_16x16x32_bf16 v[76:79],a[132:135],v[228:231],v[76:79]
ds_read_b128 v[224:227],v17 offset:20480
s_waitcnt lgkmcnt(5)
v_mfma_f32_16x16x32_bf16 v[68:71],a[8:11],v[232:235],v[68:71]
v_min3_u32 v27,v27,v232,v236
v_mul_f32 v88,v64,v64
v_mul_f32 v92,v72,v72
v_mfma_f32_16x16x32_bf16 v[76:79],a[136:139],v[232:235],v[76:79]
ds_read_b128 v[228:231],v43 offset:20480
v_mul_f32 v89,v65,v65
v_mul_f32 v93,v73,v73
v_mfma_f32_16x16x32_bf16 v[68:71],a[12:15],v[236:239],v[68:71]
v_mul_f32 v90,v66,v66
v_mul_f32 v91,v67,v67
v_mul_f32 v94,v74,v74
v_mfma_f32_16x16x32_bf16 v[76:79],a[140:143],v[236:239],v[76:79]
ds_read_b128 v[232:235],v17 offset:28672
v_mul_f32 v95,v75,v75
s_waitcnt lgkmcnt(5)
v_mfma_f32_16x16x32_bf16 v[68:71],a[64:67],v[240:243],v[68:71]
v_min3_u32 v27,v27,v240,v244
v_fma_f32 v88,v88,s81,v28
v_fma_f32 v92,v92,s81,v28
v_mfma_f32_16x16x32_bf16 v[76:79],a[192:195],v[240:243],v[76:79]
ds_read_b128 v[236:239],v43 offset:28672
v_fma_f32 v89,v89,s81,v28
v_fma_f32 v93,v93,s81,v28
v_mfma_f32_16x16x32_bf16 v[68:71],a[68:71],v[244:247],v[68:71]
v_fma_f32 v90,v90,s81,v28
v_fma_f32 v91,v91,s81,v28
v_fma_f32 v94,v94,s81,v28
v_mfma_f32_16x16x32_bf16 v[76:79],a[196:199],v[244:247],v[76:79]
ds_read_b128 v[240:243],v17 offset:21504
v_fma_f32 v95,v95,s81,v28
s_waitcnt lgkmcnt(5)
v_mfma_f32_16x16x32_bf16 v[68:71],a[72:75],v[248:251],v[68:71]
v_min3_u32 v27,v27,v248,v252
v_mul_f32 v88,v88,v64
v_mul_f32 v92,v92,v72
v_mfma_f32_16x16x32_bf16 v[76:79],a[200:203],v[248:251],v[76:79]
ds_read_b128 v[244:247],v43 offset:21504
v_mul_f32 v89,v89,v65
v_mul_f32 v93,v93,v73
v_mfma_f32_16x16x32_bf16 v[68:71],a[76:79],v[252:255],v[68:71]
v_mul_f32 v90,v90,v66
v_mul_f32 v91,v91,v67
v_mul_f32 v94,v94,v74
v_mfma_f32_16x16x32_bf16 v[76:79],a[204:207],v[252:255],v[76:79]
ds_read_b128 v[248:251],v17 offset:29696
v_mul_f32 v95,v95,v75
s_waitcnt lgkmcnt(5)
v_mfma_f32_16x16x32_bf16 v[68:71],a[16:19],v[224:227],v[68:71]
v_min3_u32 v27,v27,v224,v228
v_exp_f32 v92,v92
v_mfma_f32_16x16x32_bf16 v[76:79],a[144:147],v[224:227],v[76:79]
ds_read_b128 v[252:255],v43 offset:29696
v_exp_f32 v93,v93
v_mfma_f32_16x16x32_bf16 v[68:71],a[20:23],v[228:231],v[68:71]
v_exp_f32 v88,v88
v_mfma_f32_16x16x32_bf16 v[76:79],a[148:151],v[228:231],v[76:79]
s_waitcnt vmcnt(0)
s_barrier
ds_read_b128 v[224:227],v17 offset:36864
s_waitcnt lgkmcnt(5)
v_mfma_f32_16x16x32_bf16 v[68:71],a[24:27],v[232:235],v[68:71]
v_min3_u32 v27,v27,v232,v236
v_exp_f32 v94,v94
v_mfma_f32_16x16x32_bf16 v[76:79],a[152:155],v[232:235],v[76:79]
ds_read_b128 v[228:231],v43 offset:36864
v_exp_f32 v95,v95
v_mfma_f32_16x16x32_bf16 v[68:71],a[28:31],v[236:239],v[68:71]
v_exp_f32 v89,v89
v_add_f32 v92,1.0,v92
v_mfma_f32_16x16x32_bf16 v[76:79],a[156:159],v[236:239],v[76:79]
ds_read_b128 v[232:235],v17 offset:45056
v_add_f32 v93,1.0,v93
s_waitcnt lgkmcnt(5)
v_mfma_f32_16x16x32_bf16 v[68:71],a[80:83],v[240:243],v[68:71]
v_min3_u32 v27,v27,v240,v244
v_add_f32 v94,1.0,v94
v_add_f32 v95,1.0,v95
v_mfma_f32_16x16x32_bf16 v[76:79],a[208:211],v[240:243],v[76:79]
ds_read_b128 v[236:239],v43 offset:45056
v_rcp_f32 v92,v92
v_mfma_f32_16x16x32_bf16 v[68:71],a[84:87],v[244:247],v[68:71]
v_exp_f32 v90,v90
v_mfma_f32_16x16x32_bf16 v[76:79],a[212:215],v[244:247],v[76:79]
ds_read_b128 v[240:243],v17 offset:37888
s_waitcnt lgkmcnt(5)
v_mfma_f32_16x16x32_bf16 v[68:71],a[88:91],v[248:251],v[68:71]
v_min3_u32 v27,v27,v248,v252
v_rcp_f32 v93,v93
v_mfma_f32_16x16x32_bf16 v[76:79],a[216:219],v[248:251],v[76:79]
ds_read_b128 v[244:247],v43 offset:37888
v_rcp_f32 v94,v94
v_mfma_f32_16x16x32_bf16 v[68:71],a[92:95],v[252:255],v[68:71]
v_exp_f32 v91,v91
v_mfma_f32_16x16x32_bf16 v[76:79],a[220:223],v[252:255],v[76:79]
ds_read_b128 v[248:251],v17 offset:46080
s_waitcnt lgkmcnt(5)
v_mfma_f32_16x16x32_bf16 v[68:71],a[32:35],v[224:227],v[68:71]
v_min3_u32 v27,v27,v224,v228
v_add_f32 v88,1.0,v88
v_mfma_f32_16x16x32_bf16 v[76:79],a[160:163],v[224:227],v[76:79]
ds_read_b128 v[252:255],v43 offset:46080
v_add_f32 v89,1.0,v89
v_mfma_f32_16x16x32_bf16 v[68:71],a[36:39],v[228:231],v[68:71]
v_add_f32 v90,1.0,v90
v_add_f32 v91,1.0,v91
v_mfma_f32_16x16x32_bf16 v[76:79],a[164:167],v[228:231],v[76:79]
ds_read_b128 v[224:227],v17 offset:53248
s_waitcnt lgkmcnt(5)
v_mfma_f32_16x16x32_bf16 v[68:71],a[40:43],v[232:235],v[68:71]
v_min3_u32 v27,v27,v232,v236
v_mfma_f32_16x16x32_bf16 v[76:79],a[168:171],v[232:235],v[76:79]
ds_read_b128 v[228:231],v43 offset:53248
v_mfma_f32_16x16x32_bf16 v[68:71],a[44:47],v[236:239],v[68:71]
v_rcp_f32 v88,v88
v_mfma_f32_16x16x32_bf16 v[76:79],a[172:175],v[236:239],v[76:79]
ds_read_b128 v[232:235],v17 offset:61440
s_waitcnt lgkmcnt(5)
v_mfma_f32_16x16x32_bf16 v[68:71],a[96:99],v[240:243],v[68:71]
v_min3_u32 v27,v27,v240,v244
v_mfma_f32_16x16x32_bf16 v[76:79],a[224:227],v[240:243],v[76:79]
ds_read_b128 v[236:239],v43 offset:61440
v_mfma_f32_16x16x32_bf16 v[68:71],a[100:103],v[244:247],v[68:71]
v_rcp_f32 v89,v89
v_mfma_f32_16x16x32_bf16 v[76:79],a[228:231],v[244:247],v[76:79]
ds_read_b128 v[240:243],v17 offset:54272
s_waitcnt lgkmcnt(5)
v_mfma_f32_16x16x32_bf16 v[68:71],a[104:107],v[248:251],v[68:71]
v_min3_u32 v27,v27,v248,v252
v_mfma_f32_16x16x32_bf16 v[76:79],a[232:235],v[248:251],v[76:79]
ds_read_b128 v[244:247],v43 offset:54272
v_mfma_f32_16x16x32_bf16 v[68:71],a[108:111],v[252:255],v[68:71]
v_rcp_f32 v90,v90
v_mfma_f32_16x16x32_bf16 v[76:79],a[236:239],v[252:255],v[76:79]
ds_read_b128 v[248:251],v17 offset:62464
s_waitcnt lgkmcnt(5)
v_mfma_f32_16x16x32_bf16 v[68:71],a[48:51],v[224:227],v[68:71]
v_min3_u32 v27,v27,v224,v228
v_mfma_f32_16x16x32_bf16 v[76:79],a[176:179],v[224:227],v[76:79]
ds_read_b128 v[252:255],v43 offset:62464
v_mfma_f32_16x16x32_bf16 v[68:71],a[52:55],v[228:231],v[68:71]
v_rcp_f32 v91,v91
v_mfma_f32_16x16x32_bf16 v[76:79],a[180:183],v[228:231],v[76:79]
v_mul_f32 v88,v88,v64
s_waitcnt lgkmcnt(4)
v_mfma_f32_16x16x32_bf16 v[68:71],a[56:59],v[232:235],v[68:71]
v_min3_u32 v27,v27,v232,v236
v_mul_f32 v89,v89,v65
v_mfma_f32_16x16x32_bf16 v[76:79],a[184:187],v[232:235],v[76:79]
v_mul_f32 v90,v90,v66
v_mul_f32 v91,v91,v67
v_mfma_f32_16x16x32_bf16 v[68:71],a[60:63],v[236:239],v[68:71]
v_rcp_f32 v95,v95
v_mfma_f32_16x16x32_bf16 v[76:79],a[188:191],v[236:239],v[76:79]
v_mul_f32 v92,v92,v72
s_waitcnt lgkmcnt(2)
v_mfma_f32_16x16x32_bf16 v[68:71],a[112:115],v[240:243],v[68:71]
v_min3_u32 v27,v27,v240,v244
v_mul_f32 v93,v93,v73
v_mfma_f32_16x16x32_bf16 v[76:79],a[240:243],v[240:243],v[76:79]
v_mul_f32 v94,v94,v74
v_mul_f32 v95,v95,v75
v_mfma_f32_16x16x32_bf16 v[68:71],a[116:119],v[244:247],v[68:71]
v_cvt_pk_bf16_f32 v96,v88,v89
v_cvt_pk_bf16_f32 v97,v90,v91
v_mfma_f32_16x16x32_bf16 v[76:79],a[244:247],v[244:247],v[76:79]
v_cvt_pk_bf16_f32 v98,v92,v93
s_waitcnt lgkmcnt(0)
v_mfma_f32_16x16x32_bf16 v[68:71],a[120:123],v[248:251],v[68:71]
v_min3_u32 v27,v27,v248,v252
v_cvt_pk_bf16_f32 v99,v94,v95
v_mfma_f32_16x16x32_bf16 v[76:79],a[248:251],v[248:251],v[76:79]
v_max_u32 v96,1,v96
v_mfma_f32_16x16x32_bf16 v[68:71],a[124:127],v[252:255],v[68:71]
buffer_store_dwordx4 v[96:99],v18,s[20:23],s78 offen sc1
v_mfma_f32_16x16x32_bf16 v[76:79],a[252:255],v[252:255],v[76:79]
v_cmp_eq_u32 vcc,0,v27
s_cbranch_vccnz retry_222
s_branch epi_225
keep_233:
v_mfma_f32_16x16x32_bf16 v[64:67],a[124:127],v[252:255],v[64:67]
v_min3_u32 v27,v27,v248,v252
s_xor_b32 m0,s72,0
v_mfma_f32_16x16x32_bf16 v[72:75],a[252:255],v[252:255],v[72:75]
ds_read_b128 v[248:251],v17 offset:13312
s_add_u32 s65,s88,0
s_waitcnt lgkmcnt(5)
v_mfma_f32_16x16x32_bf16 v[68:71],a[0:3],v[224:227],0
buffer_load_dwordx4 v42,s[20:23],s65 offen offset:0 sc1 lds
v_min3_u32 v27,v27,v224,v228
v_mfma_f32_16x16x32_bf16 v[76:79],a[128:131],v[224:227],0
ds_read_b128 v[252:255],v43 offset:13312
buffer_load_dwordx4 v42,s[20:23],s65 offen offset:1024 sc1 lds
v_mfma_f32_16x16x32_bf16 v[68:71],a[4:7],v[228:231],v[68:71]
v_cmp_eq_u32 vcc,0,v27
s_cbranch_vccnz retry_222
v_mfma_f32_16x16x32_bf16 v[76:79],a[132:135],v[228:231],v[76:79]
ds_read_b128 v[224:227],v17 offset:20480
s_xor_b32 m0,s72,16384
s_waitcnt lgkmcnt(5)
v_mfma_f32_16x16x32_bf16 v[68:71],a[8:11],v[232:235],v[68:71]
s_add_u32 s65,s88,256
v_min3_u32 v27,v27,v232,v236
v_mul_f32 v88,v64,v64
v_mul_f32 v92,v72,v72
v_mfma_f32_16x16x32_bf16 v[76:79],a[136:139],v[232:235],v[76:79]
ds_read_b128 v[228:231],v43 offset:20480
buffer_load_dwordx4 v42,s[20:23],s65 offen offset:0 sc1 lds
v_mul_f32 v93,v73,v73
v_mfma_f32_16x16x32_bf16 v[68:71],a[12:15],v[236:239],v[68:71]
v_mul_f32 v89,v65,v65
v_mul_f32 v90,v66,v66
v_mul_f32 v91,v67,v67
v_mul_f32 v94,v74,v74
v_mfma_f32_16x16x32_bf16 v[76:79],a[140:143],v[236:239],v[76:79]
ds_read_b128 v[232:235],v17 offset:28672
v_fma_f32 v88,v88,s81,v28
v_mul_f32 v95,v75,v75
s_waitcnt lgkmcnt(5)
v_mfma_f32_16x16x32_bf16 v[68:71],a[64:67],v[240:243],v[68:71]
buffer_load_dwordx4 v42,s[20:23],s65 offen offset:1024 sc1 lds
s_xor_b32 m0,s72,32768
v_fma_f32 v92,v92,s81,v28
v_mfma_f32_16x16x32_bf16 v[76:79],a[192:195],v[240:243],v[76:79]
ds_read_b128 v[236:239],v43 offset:28672
s_add_u32 s65,s88,512
v_fma_f32 v89,v89,s81,v28
v_fma_f32 v93,v93,s81,v28
v_mfma_f32_16x16x32_bf16 v[68:71],a[68:71],v[244:247],v[68:71]
v_min3_u32 v27,v27,v240,v244
v_fma_f32 v90,v90,s81,v28
v_fma_f32 v91,v91,s81,v28
v_fma_f32 v94,v94,s81,v28
v_mfma_f32_16x16x32_bf16 v[76:79],a[196:199],v[244:247],v[76:79]
ds_read_b128 v[240:243],v17 offset:21504
v_mul_f32 v88,v88,v64
v_fma_f32 v95,v95,s81,v28
s_waitcnt lgkmcnt(5)
v_mfma_f32_16x16x32_bf16 v[68:71],a[72:75],v[248:251],v[68:71]
buffer_load_dwordx4 v42,s[20:23],s65 offen offset:0 sc1 lds
v_mul_f32 v89,v89,v65
v_mul_f32 v92,v92,v72
v_mfma_f32_16x16x32_bf16 v[76:79],a[200:203],v[248:251],v[76:79]
ds_read_b128 v[244:247],v43 offset:21504
buffer_load_dwordx4 v42,s[20:23],s65 offen offset:1024 sc1 lds
v_mul_f32 v93,v93,v73
v_mfma_f32_16x16x32_bf16 v[68:71],a[76:79],v[252:255],v[68:71]
s_xor_b32 m0,s72,49152
v_min3_u32 v27,v27,v248,v252
v_mul_f32 v90,v90,v66
v_mul_f32 v94,v94,v74
v_mfma_f32_16x16x32_bf16 v[76:79],a[204:207],v[252:255],v[76:79]
ds_read_b128 v[248:251],v17 offset:29696
s_add_u32 s65,s88,768
v_mul_f32 v95,v95,v75
s_waitcnt lgkmcnt(5)
v_mfma_f32_16x16x32_bf16 v[68:71],a[16:19],v[224:227],v[68:71]
buffer_load_dwordx4 v42,s[20:23],s65 offen offset:0 sc1 lds
v_mul_f32 v91,v91,v67
v_mfma_f32_16x16x32_bf16 v[76:79],a[144:147],v[224:227],v[76:79]
ds_read_b128 v[252:255],v43 offset:29696
v_min3_u32 v27,v27,v224,v228
v_exp_f32 v92,v92
v_mfma_f32_16x16x32_bf16 v[68:71],a[20:23],v[228:231],v[68:71]
buffer_load_dwordx4 v42,s[20:23],s65 offen offset:1024 sc1 lds
v_exp_f32 v93,v93
v_mfma_f32_16x16x32_bf16 v[76:79],a[148:151],v[228:231],v[76:79]
s_waitcnt vmcnt(8)
s_barrier
ds_read_b128 v[224:227],v17 offset:36864
s_waitcnt lgkmcnt(5)
v_mfma_f32_16x16x32_bf16 v[68:71],a[24:27],v[232:235],v[68:71]
s_xor_b32 m0,s72,4096
s_add_u32 s65,s89,0
v_exp_f32 v94,v94
v_mfma_f32_16x16x32_bf16 v[76:79],a[152:155],v[232:235],v[76:79]
ds_read_b128 v[228:231],v43 offset:36864
v_min3_u32 v27,v27,v232,v236
v_exp_f32 v95,v95
v_mfma_f32_16x16x32_bf16 v[68:71],a[28:31],v[236:239],v[68:71]
buffer_load_dwordx4 v42,s[20:23],s65 offen offset:0 sc1 lds
v_add_f32 v92,1.0,v92
v_add_f32 v93,1.0,v93
v_mfma_f32_16x16x32_bf16 v[76:79],a[156:159],v[236:239],v[76:79]
ds_read_b128 v[232:235],v17 offset:45056
v_add_f32 v94,1.0,v94
v_add_f32 v95,1.0,v95
s_waitcnt lgkmcnt(5)
v_mfma_f32_16x16x32_bf16 v[68:71],a[80:83],v[240:243],v[68:71]
buffer_load_dwordx4 v42,s[20:23],s65 offen offset:1024 sc1 lds
v_rcp_f32 v92,v92
v_mfma_f32_16x16x32_bf16 v[76:79],a[208:211],v[240:243],v[76:79]
ds_read_b128 v[236:239],v43 offset:45056
s_xor_b32 m0,s72,20480
v_rcp_f32 v93,v93
v_mfma_f32_16x16x32_bf16 v[68:71],a[84:87],v[244:247],v[68:71]
s_add_u32 s65,s89,256
v_min3_u32 v27,v27,v240,v244
v_rcp_f32 v94,v94
v_mfma_f32_16x16x32_bf16 v[76:79],a[212:215],v[244:247],v[76:79]
ds_read_b128 v[240:243],v17 offset:37888
v_rcp_f32 v95,v95
s_waitcnt lgkmcnt(5)
v_mfma_f32_16x16x32_bf16 v[68:71],a[88:91],v[248:251],v[68:71]
buffer_load_dwordx4 v42,s[20:23],s65 offen offset:0 sc1 lds
v_mul_f32 v92,v92,v72
v_mul_f32 v93,v93,v73
v_mfma_f32_16x16x32_bf16 v[76:79],a[216:219],v[248:251],v[76:79]
ds_read_b128 v[244:247],v43 offset:37888
v_min3_u32 v27,v27,v248,v252
v_mfma_f32_16x16x32_bf16 v[68:71],a[92:95],v[252:255],v[68:71]
buffer_load_dwordx4 v42,s[20:23],s65 offen offset:1024 sc1 lds
v_mfma_f32_16x16x32_bf16 v[76:79],a[220:223],v[252:255],v[76:79]
ds_read_b128 v[248:251],v17 offset:46080
s_waitcnt lgkmcnt(5)
v_mfma_f32_16x16x32_bf16 v[68:71],a[32:35],v[224:227],v[68:71]
s_xor_b32 m0,s72,36864
s_add_u32 s65,s89,512
v_mfma_f32_16x16x32_bf16 v[76:79],a[160:163],v[224:227],v[76:79]
ds_read_b128 v[252:255],v43 offset:46080
v_min3_u32 v27,v27,v224,v228
v_mfma_f32_16x16x32_bf16 v[68:71],a[36:39],v[228:231],v[68:71]
buffer_load_dwordx4 v42,s[20:23],s65 offen offset:0 sc1 lds
v_mfma_f32_16x16x32_bf16 v[76:79],a[164:167],v[228:231],v[76:79]
ds_read_b128 v[224:227],v17 offset:53248
s_waitcnt lgkmcnt(5)
v_mfma_f32_16x16x32_bf16 v[68:71],a[40:43],v[232:235],v[68:71]
buffer_load_dwordx4 v42,s[20:23],s65 offen offset:1024 sc1 lds
v_mfma_f32_16x16x32_bf16 v[76:79],a[168:171],v[232:235],v[76:79]
ds_read_b128 v[228:231],v43 offset:53248
s_xor_b32 m0,s72,53248
v_mfma_f32_16x16x32_bf16 v[68:71],a[44:47],v[236:239],v[68:71]
s_add_u32 s65,s89,768
v_min3_u32 v27,v27,v232,v236
v_mfma_f32_16x16x32_bf16 v[76:79],a[172:175],v[236:239],v[76:79]
ds_read_b128 v[232:235],v17 offset:61440
s_waitcnt lgkmcnt(5)
v_mfma_f32_16x16x32_bf16 v[68:71],a[96:99],v[240:243],v[68:71]
buffer_load_dwordx4 v42,s[20:23],s65 offen offset:0 sc1 lds
v_mfma_f32_16x16x32_bf16 v[76:79],a[224:227],v[240:243],v[76:79]
ds_read_b128 v[236:239],v43 offset:61440
v_min3_u32 v27,v27,v240,v244
v_mfma_f32_16x16x32_bf16 v[68:71],a[100:103],v[244:247],v[68:71]
buffer_load_dwordx4 v42,s[20:23],s65 offen offset:1024 sc1 lds
v_mfma_f32_16x16x32_bf16 v[76:79],a[228:231],v[244:247],v[76:79]
ds_read_b128 v[240:243],v17 offset:54272
s_waitcnt lgkmcnt(5)
v_mfma_f32_16x16x32_bf16 v[68:71],a[104:107],v[248:251],v[68:71]
v_min3_u32 v27,v27,v248,v252
v_exp_f32 v88,v88
v_mfma_f32_16x16x32_bf16 v[76:79],a[232:235],v[248:251],v[76:79]
ds_read_b128 v[244:247],v43 offset:54272
v_exp_f32 v89,v89
v_mfma_f32_16x16x32_bf16 v[68:71],a[108:111],v[252:255],v[68:71]
v_exp_f32 v90,v90
v_mfma_f32_16x16x32_bf16 v[76:79],a[236:239],v[252:255],v[76:79]
ds_read_b128 v[248:251],v17 offset:62464
s_waitcnt lgkmcnt(5)
v_mfma_f32_16x16x32_bf16 v[68:71],a[48:51],v[224:227],v[68:71]
v_min3_u32 v27,v27,v224,v228
v_exp_f32 v91,v91
v_mfma_f32_16x16x32_bf16 v[76:79],a[176:179],v[224:227],v[76:79]
ds_read_b128 v[252:255],v43 offset:62464
v_add_f32 v88,1.0,v88
v_add_f32 v89,1.0,v89
v_mfma_f32_16x16x32_bf16 v[68:71],a[52:55],v[228:231],v[68:71]
v_add_f32 v90,1.0,v90
v_add_f32 v91,1.0,v91
v_mfma_f32_16x16x32_bf16 v[76:79],a[180:183],v[228:231],v[76:79]
v_rcp_f32 v88,v88
s_waitcnt lgkmcnt(4)
v_mfma_f32_16x16x32_bf16 v[68:71],a[56:59],v[232:235],v[68:71]
v_min3_u32 v27,v27,v232,v236
v_rcp_f32 v89,v89
v_mfma_f32_16x16x32_bf16 v[76:79],a[184:187],v[232:235],v[76:79]
v_rcp_f32 v90,v90
v_mfma_f32_16x16x32_bf16 v[68:71],a[60:63],v[236:239],v[68:71]
v_rcp_f32 v91,v91
v_mfma_f32_16x16x32_bf16 v[76:79],a[188:191],v[236:239],v[76:79]
v_mul_f32 v88,v88,v64
s_waitcnt lgkmcnt(2)
v_mfma_f32_16x16x32_bf16 v[68:71],a[112:115],v[240:243],v[68:71]
v_min3_u32 v27,v27,v240,v244
v_mul_f32 v89,v89,v65
v_mfma_f32_16x16x32_bf16 v[76:79],a[240:243],v[240:243],v[76:79]
v_mul_f32 v90,v90,v66
v_mul_f32 v91,v91,v67
v_mfma_f32_16x16x32_bf16 v[68:71],a[116:119],v[244:247],v[68:71]
v_mul_f32 v94,v94,v74
v_mul_f32 v95,v95,v75
v_mfma_f32_16x16x32_bf16 v[76:79],a[244:247],v[244:247],v[76:79]
v_cvt_pk_bf16_f32 v96,v88,v89
s_waitcnt lgkmcnt(0)
v_mfma_f32_16x16x32_bf16 v[68:71],a[120:123],v[248:251],v[68:71]
v_min3_u32 v27,v27,v248,v252
v_cvt_pk_bf16_f32 v97,v90,v91
v_mfma_f32_16x16x32_bf16 v[76:79],a[248:251],v[248:251],v[76:79]
v_cvt_pk_bf16_f32 v98,v92,v93
v_cvt_pk_bf16_f32 v99,v94,v95
v_mfma_f32_16x16x32_bf16 v[68:71],a[124:127],v[252:255],v[68:71]
v_max_u32 v96,1,v96
v_mfma_f32_16x16x32_bf16 v[76:79],a[252:255],v[252:255],v[76:79]
buffer_store_dwordx4 v[96:99],v18,s[20:23],s78 offen sc1
v_cmp_eq_u32 vcc,0,v27
s_cbranch_vccnz retry_222
s_branch epi_225
ahead_224:
s_cmp_eq_u32 s93,0
s_cbranch_scc1 both_226
s_waitcnt vmcnt(13) lgkmcnt(0)
s_barrier
ds_read_b128 v[224:227],v17 offset:0
ds_read_b128 v[228:231],v43 offset:0
ds_read_b128 v[232:235],v17 offset:8192
ds_read_b128 v[236:239],v43 offset:8192
ds_read_b128 v[240:243],v17 offset:1024
ds_read_b128 v[244:247],v43 offset:1024
ds_read_b128 v[248:251],v17 offset:9216
s_waitcnt lgkmcnt(5)
v_mfma_f32_16x16x32_bf16 v[64:67],a[0:3],v[224:227],0
s_add_u32 s96,s71,1
s_add_u32 s92,s71,2
v_mfma_f32_16x16x32_bf16 v[72:75],a[128:131],v[224:227],0
ds_read_b128 v[252:255],v43 offset:9216
v_min_u32 v27,v224,v228
v_mfma_f32_16x16x32_bf16 v[64:67],a[4:7],v[228:231],v[64:67]
v_mfma_f32_16x16x32_bf16 v[72:75],a[132:135],v[228:231],v[72:75]
ds_read_b128 v[224:227],v17 offset:16384
s_waitcnt lgkmcnt(5)
v_mfma_f32_16x16x32_bf16 v[64:67],a[8:11],v[232:235],v[64:67]
v_min3_u32 v27,v27,v232,v236
v_mfma_f32_16x16x32_bf16 v[72:75],a[136:139],v[232:235],v[72:75]
ds_read_b128 v[228:231],v43 offset:16384
v_mfma_f32_16x16x32_bf16 v[64:67],a[12:15],v[236:239],v[64:67]
v_mfma_f32_16x16x32_bf16 v[72:75],a[140:143],v[236:239],v[72:75]
ds_read_b128 v[232:235],v17 offset:24576
s_waitcnt lgkmcnt(5)
v_mfma_f32_16x16x32_bf16 v[64:67],a[64:67],v[240:243],v[64:67]
v_min3_u32 v27,v27,v240,v244
v_mfma_f32_16x16x32_bf16 v[72:75],a[192:195],v[240:243],v[72:75]
ds_read_b128 v[236:239],v43 offset:24576
v_mfma_f32_16x16x32_bf16 v[64:67],a[68:71],v[244:247],v[64:67]
v_mfma_f32_16x16x32_bf16 v[72:75],a[196:199],v[244:247],v[72:75]
ds_read_b128 v[240:243],v17 offset:17408
s_waitcnt lgkmcnt(5)
v_mfma_f32_16x16x32_bf16 v[64:67],a[72:75],v[248:251],v[64:67]
v_min3_u32 v27,v27,v248,v252
v_mfma_f32_16x16x32_bf16 v[72:75],a[200:203],v[248:251],v[72:75]
ds_read_b128 v[244:247],v43 offset:17408
v_mfma_f32_16x16x32_bf16 v[64:67],a[76:79],v[252:255],v[64:67]
v_mfma_f32_16x16x32_bf16 v[72:75],a[204:207],v[252:255],v[72:75]
ds_read_b128 v[248:251],v17 offset:25600
s_waitcnt lgkmcnt(5)
v_mfma_f32_16x16x32_bf16 v[64:67],a[16:19],v[224:227],v[64:67]
v_min3_u32 v27,v27,v224,v228
v_mfma_f32_16x16x32_bf16 v[72:75],a[144:147],v[224:227],v[72:75]
ds_read_b128 v[252:255],v43 offset:25600
v_mfma_f32_16x16x32_bf16 v[64:67],a[20:23],v[228:231],v[64:67]
v_mfma_f32_16x16x32_bf16 v[72:75],a[148:151],v[228:231],v[72:75]
ds_read_b128 v[224:227],v17 offset:32768
s_waitcnt lgkmcnt(5)
v_mfma_f32_16x16x32_bf16 v[64:67],a[24:27],v[232:235],v[64:67]
v_min3_u32 v27,v27,v232,v236
v_mfma_f32_16x16x32_bf16 v[72:75],a[152:155],v[232:235],v[72:75]
ds_read_b128 v[228:231],v43 offset:32768
v_mfma_f32_16x16x32_bf16 v[64:67],a[28:31],v[236:239],v[64:67]
v_mfma_f32_16x16x32_bf16 v[72:75],a[156:159],v[236:239],v[72:75]
ds_read_b128 v[232:235],v17 offset:40960
s_waitcnt lgkmcnt(5)
v_mfma_f32_16x16x32_bf16 v[64:67],a[80:83],v[240:243],v[64:67]
v_min3_u32 v27,v27,v240,v244
v_mfma_f32_16x16x32_bf16 v[72:75],a[208:211],v[240:243],v[72:75]
ds_read_b128 v[236:239],v43 offset:40960
v_mfma_f32_16x16x32_bf16 v[64:67],a[84:87],v[244:247],v[64:67]
v_mfma_f32_16x16x32_bf16 v[72:75],a[212:215],v[244:247],v[72:75]
ds_read_b128 v[240:243],v17 offset:33792
s_waitcnt lgkmcnt(5)
v_mfma_f32_16x16x32_bf16 v[64:67],a[88:91],v[248:251],v[64:67]
v_min3_u32 v27,v27,v248,v252
v_mfma_f32_16x16x32_bf16 v[72:75],a[216:219],v[248:251],v[72:75]
ds_read_b128 v[244:247],v43 offset:33792
s_waitcnt vmcnt(3)
v_mfma_f32_16x16x32_bf16 v[64:67],a[92:95],v[252:255],v[64:67]
v_cmp_gt_u32 vcc,s96,v29
v_cmp_gt_u32 s[92:93],s92,v29
v_mfma_f32_16x16x32_bf16 v[72:75],a[220:223],v[252:255],v[72:75]
ds_read_b128 v[248:251],v17 offset:41984
s_waitcnt lgkmcnt(5)
v_mfma_f32_16x16x32_bf16 v[64:67],a[32:35],v[224:227],v[64:67]
v_mov_b32 v44,vcc_lo
v_mov_b32 v45,s92
v_mfma_f32_16x16x32_bf16 v[72:75],a[160:163],v[224:227],v[72:75]
ds_read_b128 v[252:255],v43 offset:41984
ds_write_b64 v46,v[44:45]
v_mfma_f32_16x16x32_bf16 v[64:67],a[36:39],v[228:231],v[64:67]
v_min3_u32 v27,v27,v224,v228
v_mfma_f32_16x16x32_bf16 v[72:75],a[164:167],v[228:231],v[72:75]
ds_read_b128 v[224:227],v17 offset:49152
s_waitcnt lgkmcnt(6)
v_mfma_f32_16x16x32_bf16 v[64:67],a[40:43],v[232:235],v[64:67]
v_min3_u32 v27,v27,v232,v236
v_mfma_f32_16x16x32_bf16 v[72:75],a[168:171],v[232:235],v[72:75]
ds_read_b128 v[228:231],v43 offset:49152
v_mfma_f32_16x16x32_bf16 v[64:67],a[44:47],v[236:239],v[64:67]
v_mfma_f32_16x16x32_bf16 v[72:75],a[172:175],v[236:239],v[72:75]
ds_read_b128 v[232:235],v17 offset:57344
s_waitcnt lgkmcnt(6)
v_mfma_f32_16x16x32_bf16 v[64:67],a[96:99],v[240:243],v[64:67]
v_min3_u32 v27,v27,v240,v244
s_add_u32 s88,s70,s75
v_mfma_f32_16x16x32_bf16 v[72:75],a[224:227],v[240:243],v[72:75]
ds_read_b128 v[236:239],v43 offset:57344
s_add_u32 s88,s88,2097152
v_mfma_f32_16x16x32_bf16 v[64:67],a[100:103],v[244:247],v[64:67]
s_xor_b32 s88,s88,0x2000
s_add_u32 s89,s88,65536
v_mfma_f32_16x16x32_bf16 v[72:75],a[228:231],v[244:247],v[72:75]
ds_read_b128 v[240:243],v17 offset:50176
s_waitcnt lgkmcnt(6)
v_mfma_f32_16x16x32_bf16 v[64:67],a[104:107],v[248:251],v[64:67]
v_min3_u32 v27,v27,v248,v252
v_mfma_f32_16x16x32_bf16 v[72:75],a[232:235],v[248:251],v[72:75]
ds_read_b128 v[244:247],v43 offset:50176
v_mfma_f32_16x16x32_bf16 v[64:67],a[108:111],v[252:255],v[64:67]
v_mfma_f32_16x16x32_bf16 v[72:75],a[236:239],v[252:255],v[72:75]
ds_read_b128 v[248:251],v17 offset:58368
s_waitcnt lgkmcnt(5)
v_mfma_f32_16x16x32_bf16 v[64:67],a[48:51],v[224:227],v[64:67]
v_min3_u32 v27,v27,v224,v228
v_mfma_f32_16x16x32_bf16 v[72:75],a[176:179],v[224:227],v[72:75]
ds_read_b128 v[252:255],v43 offset:58368
v_mfma_f32_16x16x32_bf16 v[64:67],a[52:55],v[228:231],v[64:67]
s_waitcnt vmcnt(0)
v_add_u32 v22,s71,-1
v_mfma_f32_16x16x32_bf16 v[72:75],a[180:183],v[228:231],v[72:75]
s_waitcnt vmcnt(5)
s_barrier
ds_read_b64 v[44:45],v47
ds_read_b128 v[224:227],v17 offset:4096
s_waitcnt lgkmcnt(6)
v_mfma_f32_16x16x32_bf16 v[64:67],a[56:59],v[232:235],v[64:67]
v_min3_u32 v27,v27,v232,v236
buffer_store_dword v22,v23,s[24:27],s97 offen
v_mfma_f32_16x16x32_bf16 v[72:75],a[184:187],v[232:235],v[72:75]
ds_read_b128 v[228:231],v43 offset:4096
v_mfma_f32_16x16x32_bf16 v[64:67],a[60:63],v[236:239],v[64:67]
buffer_store_dword v22,v23,s[28:31],s97 offen sc1
v_mfma_f32_16x16x32_bf16 v[72:75],a[188:191],v[236:239],v[72:75]
ds_read_b128 v[232:235],v17 offset:12288
s_waitcnt lgkmcnt(6)
v_mfma_f32_16x16x32_bf16 v[64:67],a[112:115],v[240:243],v[64:67]
v_min3_u32 v27,v27,v240,v244
s_mov_b32 s97,0x7fff0000
v_mfma_f32_16x16x32_bf16 v[72:75],a[240:243],v[240:243],v[72:75]
ds_read_b128 v[236:239],v43 offset:12288
v_mfma_f32_16x16x32_bf16 v[64:67],a[116:119],v[244:247],v[64:67]
v_mfma_f32_16x16x32_bf16 v[72:75],a[244:247],v[244:247],v[72:75]
ds_read_b128 v[240:243],v17 offset:5120
s_waitcnt lgkmcnt(6)
v_mfma_f32_16x16x32_bf16 v[64:67],a[120:123],v[248:251],v[64:67]
s_waitcnt lgkmcnt(5)
v_readfirstlane_b32 s93,v45
v_mfma_f32_16x16x32_bf16 v[72:75],a[248:251],v[248:251],v[72:75]
ds_read_b128 v[244:247],v43 offset:5120
v_readfirstlane_b32 s83,v44
s_cmp_lg_u32 s83,0
s_cbranch_scc1 keep_234
v_mfma_f32_16x16x32_bf16 v[64:67],a[124:127],v[252:255],v[64:67]
v_min3_u32 v27,v27,v248,v252
s_xor_b32 m0,s72,0
v_mfma_f32_16x16x32_bf16 v[72:75],a[252:255],v[252:255],v[72:75]
ds_read_b128 v[248:251],v17 offset:13312
s_add_u32 s65,s88,0
s_waitcnt lgkmcnt(5)
v_mfma_f32_16x16x32_bf16 v[68:71],a[0:3],v[224:227],0
buffer_load_dwordx4 v42,s[20:23],s65 offen offset:0 sc1 lds
v_min3_u32 v27,v27,v224,v228
v_mfma_f32_16x16x32_bf16 v[76:79],a[128:131],v[224:227],0
ds_read_b128 v[252:255],v43 offset:13312
buffer_load_dwordx4 v42,s[20:23],s65 offen offset:1024 sc1 lds
v_mfma_f32_16x16x32_bf16 v[68:71],a[4:7],v[228:231],v[68:71]
v_cmp_eq_u32 vcc,0,v27
s_cbranch_vccnz retry_222
v_mfma_f32_16x16x32_bf16 v[76:79],a[132:135],v[228:231],v[76:79]
ds_read_b128 v[224:227],v17 offset:20480
s_xor_b32 m0,s72,16384
s_waitcnt lgkmcnt(5)
v_mfma_f32_16x16x32_bf16 v[68:71],a[8:11],v[232:235],v[68:71]
s_add_u32 s65,s88,256
v_min3_u32 v27,v27,v232,v236
v_mul_f32 v88,v64,v64
v_mul_f32 v92,v72,v72
v_mfma_f32_16x16x32_bf16 v[76:79],a[136:139],v[232:235],v[76:79]
ds_read_b128 v[228:231],v43 offset:20480
buffer_load_dwordx4 v42,s[20:23],s65 offen offset:0 sc1 lds
v_mul_f32 v93,v73,v73
v_mfma_f32_16x16x32_bf16 v[68:71],a[12:15],v[236:239],v[68:71]
v_mul_f32 v89,v65,v65
v_mul_f32 v90,v66,v66
v_mul_f32 v91,v67,v67
v_mul_f32 v94,v74,v74
v_mfma_f32_16x16x32_bf16 v[76:79],a[140:143],v[236:239],v[76:79]
ds_read_b128 v[232:235],v17 offset:28672
v_fma_f32 v88,v88,s81,v28
v_mul_f32 v95,v75,v75
s_waitcnt lgkmcnt(5)
v_mfma_f32_16x16x32_bf16 v[68:71],a[64:67],v[240:243],v[68:71]
buffer_load_dwordx4 v42,s[20:23],s65 offen offset:1024 sc1 lds
s_xor_b32 m0,s72,32768
v_fma_f32 v92,v92,s81,v28
v_mfma_f32_16x16x32_bf16 v[76:79],a[192:195],v[240:243],v[76:79]
ds_read_b128 v[236:239],v43 offset:28672
s_add_u32 s65,s88,512
v_fma_f32 v89,v89,s81,v28
v_fma_f32 v93,v93,s81,v28
v_mfma_f32_16x16x32_bf16 v[68:71],a[68:71],v[244:247],v[68:71]
v_min3_u32 v27,v27,v240,v244
v_fma_f32 v90,v90,s81,v28
v_fma_f32 v91,v91,s81,v28
v_fma_f32 v94,v94,s81,v28
v_mfma_f32_16x16x32_bf16 v[76:79],a[196:199],v[244:247],v[76:79]
ds_read_b128 v[240:243],v17 offset:21504
v_mul_f32 v88,v88,v64
v_fma_f32 v95,v95,s81,v28
s_waitcnt lgkmcnt(5)
v_mfma_f32_16x16x32_bf16 v[68:71],a[72:75],v[248:251],v[68:71]
buffer_load_dwordx4 v42,s[20:23],s65 offen offset:0 sc1 lds
v_mul_f32 v89,v89,v65
v_mul_f32 v92,v92,v72
v_mfma_f32_16x16x32_bf16 v[76:79],a[200:203],v[248:251],v[76:79]
ds_read_b128 v[244:247],v43 offset:21504
buffer_load_dwordx4 v42,s[20:23],s65 offen offset:1024 sc1 lds
v_mul_f32 v93,v93,v73
v_mfma_f32_16x16x32_bf16 v[68:71],a[76:79],v[252:255],v[68:71]
s_xor_b32 m0,s72,49152
v_min3_u32 v27,v27,v248,v252
v_mul_f32 v90,v90,v66
v_mul_f32 v94,v94,v74
v_mfma_f32_16x16x32_bf16 v[76:79],a[204:207],v[252:255],v[76:79]
ds_read_b128 v[248:251],v17 offset:29696
s_add_u32 s65,s88,768
v_mul_f32 v95,v95,v75
s_waitcnt lgkmcnt(5)
v_mfma_f32_16x16x32_bf16 v[68:71],a[16:19],v[224:227],v[68:71]
buffer_load_dwordx4 v42,s[20:23],s65 offen offset:0 sc1 lds
v_mul_f32 v91,v91,v67
v_mfma_f32_16x16x32_bf16 v[76:79],a[144:147],v[224:227],v[76:79]
ds_read_b128 v[252:255],v43 offset:29696
v_min3_u32 v27,v27,v224,v228
v_exp_f32 v92,v92
v_mfma_f32_16x16x32_bf16 v[68:71],a[20:23],v[228:231],v[68:71]
buffer_load_dwordx4 v42,s[20:23],s65 offen offset:1024 sc1 lds
v_exp_f32 v93,v93
v_mfma_f32_16x16x32_bf16 v[76:79],a[148:151],v[228:231],v[76:79]
ds_read_b128 v[224:227],v17 offset:36864
v_exp_f32 v94,v94
s_waitcnt lgkmcnt(5)
v_mfma_f32_16x16x32_bf16 v[68:71],a[24:27],v[232:235],v[68:71]
s_xor_b32 m0,s72,4096
s_add_u32 s65,s89,0
v_exp_f32 v95,v95
v_mfma_f32_16x16x32_bf16 v[76:79],a[152:155],v[232:235],v[76:79]
ds_read_b128 v[228:231],v43 offset:36864
v_min3_u32 v27,v27,v232,v236
v_add_f32 v92,1.0,v92
v_add_f32 v93,1.0,v93
v_mfma_f32_16x16x32_bf16 v[68:71],a[28:31],v[236:239],v[68:71]
buffer_load_dwordx4 v42,s[20:23],s65 offen offset:0 sc1 lds
v_add_f32 v94,1.0,v94
v_add_f32 v95,1.0,v95
v_mfma_f32_16x16x32_bf16 v[76:79],a[156:159],v[236:239],v[76:79]
ds_read_b128 v[232:235],v17 offset:45056
v_rcp_f32 v92,v92
s_waitcnt lgkmcnt(5)
v_mfma_f32_16x16x32_bf16 v[68:71],a[80:83],v[240:243],v[68:71]
buffer_load_dwordx4 v42,s[20:23],s65 offen offset:1024 sc1 lds
v_rcp_f32 v93,v93
v_mfma_f32_16x16x32_bf16 v[76:79],a[208:211],v[240:243],v[76:79]
ds_read_b128 v[236:239],v43 offset:45056
s_xor_b32 m0,s72,20480
v_rcp_f32 v94,v94
v_mfma_f32_16x16x32_bf16 v[68:71],a[84:87],v[244:247],v[68:71]
s_add_u32 s65,s89,256
v_min3_u32 v27,v27,v240,v244
v_rcp_f32 v95,v95
v_mfma_f32_16x16x32_bf16 v[76:79],a[212:215],v[244:247],v[76:79]
ds_read_b128 v[240:243],v17 offset:37888
v_mul_f32 v92,v92,v72
v_mul_f32 v93,v93,v73
s_waitcnt lgkmcnt(5)
v_mfma_f32_16x16x32_bf16 v[68:71],a[88:91],v[248:251],v[68:71]
buffer_load_dwordx4 v42,s[20:23],s65 offen offset:0 sc1 lds
v_mfma_f32_16x16x32_bf16 v[76:79],a[216:219],v[248:251],v[76:79]
ds_read_b128 v[244:247],v43 offset:37888
v_min3_u32 v27,v27,v248,v252
v_mfma_f32_16x16x32_bf16 v[68:71],a[92:95],v[252:255],v[68:71]
buffer_load_dwordx4 v42,s[20:23],s65 offen offset:1024 sc1 lds
v_mfma_f32_16x16x32_bf16 v[76:79],a[220:223],v[252:255],v[76:79]
ds_read_b128 v[248:251],v17 offset:46080
s_waitcnt lgkmcnt(5)
v_mfma_f32_16x16x32_bf16 v[68:71],a[32:35],v[224:227],v[68:71]
s_xor_b32 m0,s72,36864
s_add_u32 s65,s89,512
v_mfma_f32_16x16x32_bf16 v[76:79],a[160:163],v[224:227],v[76:79]
ds_read_b128 v[252:255],v43 offset:46080
v_min3_u32 v27,v27,v224,v228
v_mfma_f32_16x16x32_bf16 v[68:71],a[36:39],v[228:231],v[68:71]
buffer_load_dwordx4 v42,s[20:23],s65 offen offset:0 sc1 lds
v_mfma_f32_16x16x32_bf16 v[76:79],a[164:167],v[228:231],v[76:79]
ds_read_b128 v[224:227],v17 offset:53248
s_waitcnt lgkmcnt(5)
v_mfma_f32_16x16x32_bf16 v[68:71],a[40:43],v[232:235],v[68:71]
buffer_load_dwordx4 v42,s[20:23],s65 offen offset:1024 sc1 lds
v_mfma_f32_16x16x32_bf16 v[76:79],a[168:171],v[232:235],v[76:79]
ds_read_b128 v[228:231],v43 offset:53248
s_xor_b32 m0,s72,53248
v_mfma_f32_16x16x32_bf16 v[68:71],a[44:47],v[236:239],v[68:71]
s_add_u32 s65,s89,768
v_min3_u32 v27,v27,v232,v236
v_mfma_f32_16x16x32_bf16 v[76:79],a[172:175],v[236:239],v[76:79]
ds_read_b128 v[232:235],v17 offset:61440
s_waitcnt lgkmcnt(5)
v_mfma_f32_16x16x32_bf16 v[68:71],a[96:99],v[240:243],v[68:71]
buffer_load_dwordx4 v42,s[20:23],s65 offen offset:0 sc1 lds
v_mfma_f32_16x16x32_bf16 v[76:79],a[224:227],v[240:243],v[76:79]
ds_read_b128 v[236:239],v43 offset:61440
v_min3_u32 v27,v27,v240,v244
v_mfma_f32_16x16x32_bf16 v[68:71],a[100:103],v[244:247],v[68:71]
buffer_load_dwordx4 v42,s[20:23],s65 offen offset:1024 sc1 lds
v_mfma_f32_16x16x32_bf16 v[76:79],a[228:231],v[244:247],v[76:79]
ds_read_b128 v[240:243],v17 offset:54272
s_waitcnt lgkmcnt(5)
v_mfma_f32_16x16x32_bf16 v[68:71],a[104:107],v[248:251],v[68:71]
v_min3_u32 v27,v27,v248,v252
v_exp_f32 v88,v88
v_mfma_f32_16x16x32_bf16 v[76:79],a[232:235],v[248:251],v[76:79]
ds_read_b128 v[244:247],v43 offset:54272
v_exp_f32 v89,v89
v_mfma_f32_16x16x32_bf16 v[68:71],a[108:111],v[252:255],v[68:71]
v_exp_f32 v90,v90
v_mfma_f32_16x16x32_bf16 v[76:79],a[236:239],v[252:255],v[76:79]
ds_read_b128 v[248:251],v17 offset:62464
s_waitcnt lgkmcnt(5)
v_mfma_f32_16x16x32_bf16 v[68:71],a[48:51],v[224:227],v[68:71]
v_min3_u32 v27,v27,v224,v228
v_exp_f32 v91,v91
v_mfma_f32_16x16x32_bf16 v[76:79],a[176:179],v[224:227],v[76:79]
ds_read_b128 v[252:255],v43 offset:62464
v_add_f32 v88,1.0,v88
v_add_f32 v89,1.0,v89
v_mfma_f32_16x16x32_bf16 v[68:71],a[52:55],v[228:231],v[68:71]
v_add_f32 v90,1.0,v90
v_add_f32 v91,1.0,v91
v_mfma_f32_16x16x32_bf16 v[76:79],a[180:183],v[228:231],v[76:79]
v_rcp_f32 v88,v88
s_waitcnt lgkmcnt(4)
v_mfma_f32_16x16x32_bf16 v[68:71],a[56:59],v[232:235],v[68:71]
v_min3_u32 v27,v27,v232,v236
v_rcp_f32 v89,v89
v_mfma_f32_16x16x32_bf16 v[76:79],a[184:187],v[232:235],v[76:79]
v_rcp_f32 v90,v90
v_mfma_f32_16x16x32_bf16 v[68:71],a[60:63],v[236:239],v[68:71]
v_rcp_f32 v91,v91
v_mfma_f32_16x16x32_bf16 v[76:79],a[188:191],v[236:239],v[76:79]
v_mul_f32 v88,v88,v64
s_waitcnt lgkmcnt(2)
v_mfma_f32_16x16x32_bf16 v[68:71],a[112:115],v[240:243],v[68:71]
v_min3_u32 v27,v27,v240,v244
v_mul_f32 v89,v89,v65
v_mfma_f32_16x16x32_bf16 v[76:79],a[240:243],v[240:243],v[76:79]
v_mul_f32 v90,v90,v66
v_mul_f32 v91,v91,v67
v_mfma_f32_16x16x32_bf16 v[68:71],a[116:119],v[244:247],v[68:71]
v_mul_f32 v94,v94,v74
v_mul_f32 v95,v95,v75
v_mfma_f32_16x16x32_bf16 v[76:79],a[244:247],v[244:247],v[76:79]
v_cvt_pk_bf16_f32 v96,v88,v89
s_waitcnt lgkmcnt(0)
v_mfma_f32_16x16x32_bf16 v[68:71],a[120:123],v[248:251],v[68:71]
v_min3_u32 v27,v27,v248,v252
v_cvt_pk_bf16_f32 v97,v90,v91
v_mfma_f32_16x16x32_bf16 v[76:79],a[248:251],v[248:251],v[76:79]
v_cvt_pk_bf16_f32 v98,v92,v93
v_cvt_pk_bf16_f32 v99,v94,v95
v_mfma_f32_16x16x32_bf16 v[68:71],a[124:127],v[252:255],v[68:71]
v_max_u32 v96,1,v96
v_mfma_f32_16x16x32_bf16 v[76:79],a[252:255],v[252:255],v[76:79]
buffer_store_dwordx4 v[96:99],v18,s[20:23],s78 offen sc1
v_cmp_eq_u32 vcc,0,v27
s_cbranch_vccnz retry_222
s_branch epi_225
keep_234:
v_mfma_f32_16x16x32_bf16 v[64:67],a[124:127],v[252:255],v[64:67]
v_min3_u32 v27,v27,v248,v252
v_mfma_f32_16x16x32_bf16 v[72:75],a[252:255],v[252:255],v[72:75]
ds_read_b128 v[248:251],v17 offset:13312
s_waitcnt lgkmcnt(5)
v_mfma_f32_16x16x32_bf16 v[68:71],a[0:3],v[224:227],0
v_cmp_eq_u32 vcc,0,v27
s_cbranch_vccnz retry_222
v_mfma_f32_16x16x32_bf16 v[76:79],a[128:131],v[224:227],0
ds_read_b128 v[252:255],v43 offset:13312
v_min3_u32 v27,v27,v224,v228
v_mfma_f32_16x16x32_bf16 v[68:71],a[4:7],v[228:231],v[68:71]
v_mfma_f32_16x16x32_bf16 v[76:79],a[132:135],v[228:231],v[76:79]
ds_read_b128 v[224:227],v17 offset:20480
s_waitcnt lgkmcnt(5)
v_mfma_f32_16x16x32_bf16 v[68:71],a[8:11],v[232:235],v[68:71]
v_min3_u32 v27,v27,v232,v236
v_mul_f32 v88,v64,v64
v_mul_f32 v92,v72,v72
v_mfma_f32_16x16x32_bf16 v[76:79],a[136:139],v[232:235],v[76:79]
ds_read_b128 v[228:231],v43 offset:20480
v_mul_f32 v89,v65,v65
v_mul_f32 v93,v73,v73
v_mfma_f32_16x16x32_bf16 v[68:71],a[12:15],v[236:239],v[68:71]
v_mul_f32 v90,v66,v66
v_mul_f32 v91,v67,v67
v_mul_f32 v94,v74,v74
v_mfma_f32_16x16x32_bf16 v[76:79],a[140:143],v[236:239],v[76:79]
ds_read_b128 v[232:235],v17 offset:28672
v_mul_f32 v95,v75,v75
s_waitcnt lgkmcnt(5)
v_mfma_f32_16x16x32_bf16 v[68:71],a[64:67],v[240:243],v[68:71]
v_min3_u32 v27,v27,v240,v244
v_fma_f32 v88,v88,s81,v28
v_fma_f32 v92,v92,s81,v28
v_mfma_f32_16x16x32_bf16 v[76:79],a[192:195],v[240:243],v[76:79]
ds_read_b128 v[236:239],v43 offset:28672
v_fma_f32 v89,v89,s81,v28
v_fma_f32 v93,v93,s81,v28
v_mfma_f32_16x16x32_bf16 v[68:71],a[68:71],v[244:247],v[68:71]
v_fma_f32 v90,v90,s81,v28
v_fma_f32 v91,v91,s81,v28
v_fma_f32 v94,v94,s81,v28
v_mfma_f32_16x16x32_bf16 v[76:79],a[196:199],v[244:247],v[76:79]
ds_read_b128 v[240:243],v17 offset:21504
v_fma_f32 v95,v95,s81,v28
s_waitcnt lgkmcnt(5)
v_mfma_f32_16x16x32_bf16 v[68:71],a[72:75],v[248:251],v[68:71]
v_min3_u32 v27,v27,v248,v252
v_mul_f32 v88,v88,v64
v_mul_f32 v92,v92,v72
v_mfma_f32_16x16x32_bf16 v[76:79],a[200:203],v[248:251],v[76:79]
ds_read_b128 v[244:247],v43 offset:21504
v_mul_f32 v89,v89,v65
v_mul_f32 v93,v93,v73
v_mfma_f32_16x16x32_bf16 v[68:71],a[76:79],v[252:255],v[68:71]
v_mul_f32 v90,v90,v66
v_mul_f32 v91,v91,v67
v_mul_f32 v94,v94,v74
v_mfma_f32_16x16x32_bf16 v[76:79],a[204:207],v[252:255],v[76:79]
ds_read_b128 v[248:251],v17 offset:29696
v_mul_f32 v95,v95,v75
s_waitcnt lgkmcnt(5)
v_mfma_f32_16x16x32_bf16 v[68:71],a[16:19],v[224:227],v[68:71]
v_min3_u32 v27,v27,v224,v228
v_exp_f32 v92,v92
v_mfma_f32_16x16x32_bf16 v[76:79],a[144:147],v[224:227],v[76:79]
ds_read_b128 v[252:255],v43 offset:29696
v_exp_f32 v93,v93
v_mfma_f32_16x16x32_bf16 v[68:71],a[20:23],v[228:231],v[68:71]
v_exp_f32 v88,v88
v_mfma_f32_16x16x32_bf16 v[76:79],a[148:151],v[228:231],v[76:79]
ds_read_b128 v[224:227],v17 offset:36864
s_waitcnt lgkmcnt(5)
v_mfma_f32_16x16x32_bf16 v[68:71],a[24:27],v[232:235],v[68:71]
v_min3_u32 v27,v27,v232,v236
v_exp_f32 v94,v94
v_mfma_f32_16x16x32_bf16 v[76:79],a[152:155],v[232:235],v[76:79]
ds_read_b128 v[228:231],v43 offset:36864
v_exp_f32 v95,v95
v_mfma_f32_16x16x32_bf16 v[68:71],a[28:31],v[236:239],v[68:71]
v_exp_f32 v89,v89
v_add_f32 v92,1.0,v92
v_mfma_f32_16x16x32_bf16 v[76:79],a[156:159],v[236:239],v[76:79]
ds_read_b128 v[232:235],v17 offset:45056
v_add_f32 v93,1.0,v93
s_waitcnt lgkmcnt(5)
v_mfma_f32_16x16x32_bf16 v[68:71],a[80:83],v[240:243],v[68:71]
v_min3_u32 v27,v27,v240,v244
v_add_f32 v94,1.0,v94
v_add_f32 v95,1.0,v95
v_mfma_f32_16x16x32_bf16 v[76:79],a[208:211],v[240:243],v[76:79]
ds_read_b128 v[236:239],v43 offset:45056
v_rcp_f32 v92,v92
v_mfma_f32_16x16x32_bf16 v[68:71],a[84:87],v[244:247],v[68:71]
v_exp_f32 v90,v90
v_mfma_f32_16x16x32_bf16 v[76:79],a[212:215],v[244:247],v[76:79]
ds_read_b128 v[240:243],v17 offset:37888
s_waitcnt lgkmcnt(5)
v_mfma_f32_16x16x32_bf16 v[68:71],a[88:91],v[248:251],v[68:71]
v_min3_u32 v27,v27,v248,v252
v_rcp_f32 v93,v93
v_mfma_f32_16x16x32_bf16 v[76:79],a[216:219],v[248:251],v[76:79]
ds_read_b128 v[244:247],v43 offset:37888
v_rcp_f32 v94,v94
v_mfma_f32_16x16x32_bf16 v[68:71],a[92:95],v[252:255],v[68:71]
v_exp_f32 v91,v91
v_mfma_f32_16x16x32_bf16 v[76:79],a[220:223],v[252:255],v[76:79]
ds_read_b128 v[248:251],v17 offset:46080
s_waitcnt lgkmcnt(5)
v_mfma_f32_16x16x32_bf16 v[68:71],a[32:35],v[224:227],v[68:71]
v_min3_u32 v27,v27,v224,v228
v_add_f32 v88,1.0,v88
v_mfma_f32_16x16x32_bf16 v[76:79],a[160:163],v[224:227],v[76:79]
ds_read_b128 v[252:255],v43 offset:46080
v_add_f32 v89,1.0,v89
v_mfma_f32_16x16x32_bf16 v[68:71],a[36:39],v[228:231],v[68:71]
v_add_f32 v90,1.0,v90
v_add_f32 v91,1.0,v91
v_mfma_f32_16x16x32_bf16 v[76:79],a[164:167],v[228:231],v[76:79]
ds_read_b128 v[224:227],v17 offset:53248
s_waitcnt lgkmcnt(5)
v_mfma_f32_16x16x32_bf16 v[68:71],a[40:43],v[232:235],v[68:71]
v_min3_u32 v27,v27,v232,v236
v_mfma_f32_16x16x32_bf16 v[76:79],a[168:171],v[232:235],v[76:79]
ds_read_b128 v[228:231],v43 offset:53248
v_mfma_f32_16x16x32_bf16 v[68:71],a[44:47],v[236:239],v[68:71]
v_rcp_f32 v88,v88
v_mfma_f32_16x16x32_bf16 v[76:79],a[172:175],v[236:239],v[76:79]
ds_read_b128 v[232:235],v17 offset:61440
s_waitcnt lgkmcnt(5)
v_mfma_f32_16x16x32_bf16 v[68:71],a[96:99],v[240:243],v[68:71]
v_min3_u32 v27,v27,v240,v244
v_mfma_f32_16x16x32_bf16 v[76:79],a[224:227],v[240:243],v[76:79]
ds_read_b128 v[236:239],v43 offset:61440
v_mfma_f32_16x16x32_bf16 v[68:71],a[100:103],v[244:247],v[68:71]
v_rcp_f32 v89,v89
v_mfma_f32_16x16x32_bf16 v[76:79],a[228:231],v[244:247],v[76:79]
ds_read_b128 v[240:243],v17 offset:54272
s_waitcnt lgkmcnt(5)
v_mfma_f32_16x16x32_bf16 v[68:71],a[104:107],v[248:251],v[68:71]
v_min3_u32 v27,v27,v248,v252
v_mfma_f32_16x16x32_bf16 v[76:79],a[232:235],v[248:251],v[76:79]
ds_read_b128 v[244:247],v43 offset:54272
v_mfma_f32_16x16x32_bf16 v[68:71],a[108:111],v[252:255],v[68:71]
v_rcp_f32 v90,v90
v_mfma_f32_16x16x32_bf16 v[76:79],a[236:239],v[252:255],v[76:79]
ds_read_b128 v[248:251],v17 offset:62464
s_waitcnt lgkmcnt(5)
v_mfma_f32_16x16x32_bf16 v[68:71],a[48:51],v[224:227],v[68:71]
v_min3_u32 v27,v27,v224,v228
v_mfma_f32_16x16x32_bf16 v[76:79],a[176:179],v[224:227],v[76:79]
ds_read_b128 v[252:255],v43 offset:62464
v_mfma_f32_16x16x32_bf16 v[68:71],a[52:55],v[228:231],v[68:71]
v_rcp_f32 v91,v91
v_mfma_f32_16x16x32_bf16 v[76:79],a[180:183],v[228:231],v[76:79]
v_mul_f32 v88,v88,v64
s_waitcnt lgkmcnt(4)
v_mfma_f32_16x16x32_bf16 v[68:71],a[56:59],v[232:235],v[68:71]
v_min3_u32 v27,v27,v232,v236
v_mul_f32 v89,v89,v65
v_mfma_f32_16x16x32_bf16 v[76:79],a[184:187],v[232:235],v[76:79]
v_mul_f32 v90,v90,v66
v_mul_f32 v91,v91,v67
v_mfma_f32_16x16x32_bf16 v[68:71],a[60:63],v[236:239],v[68:71]
v_rcp_f32 v95,v95
v_mfma_f32_16x16x32_bf16 v[76:79],a[188:191],v[236:239],v[76:79]
v_mul_f32 v92,v92,v72
s_waitcnt lgkmcnt(2)
v_mfma_f32_16x16x32_bf16 v[68:71],a[112:115],v[240:243],v[68:71]
v_min3_u32 v27,v27,v240,v244
v_mul_f32 v93,v93,v73
v_mfma_f32_16x16x32_bf16 v[76:79],a[240:243],v[240:243],v[76:79]
v_mul_f32 v94,v94,v74
v_mul_f32 v95,v95,v75
v_mfma_f32_16x16x32_bf16 v[68:71],a[116:119],v[244:247],v[68:71]
v_cvt_pk_bf16_f32 v96,v88,v89
v_cvt_pk_bf16_f32 v97,v90,v91
v_mfma_f32_16x16x32_bf16 v[76:79],a[244:247],v[244:247],v[76:79]
v_cvt_pk_bf16_f32 v98,v92,v93
s_waitcnt lgkmcnt(0)
v_mfma_f32_16x16x32_bf16 v[68:71],a[120:123],v[248:251],v[68:71]
v_min3_u32 v27,v27,v248,v252
v_cvt_pk_bf16_f32 v99,v94,v95
v_mfma_f32_16x16x32_bf16 v[76:79],a[248:251],v[248:251],v[76:79]
v_max_u32 v96,1,v96
v_mfma_f32_16x16x32_bf16 v[68:71],a[124:127],v[252:255],v[68:71]
buffer_store_dwordx4 v[96:99],v18,s[20:23],s78 offen sc1
v_mfma_f32_16x16x32_bf16 v[76:79],a[252:255],v[252:255],v[76:79]
v_cmp_eq_u32 vcc,0,v27
s_cbranch_vccnz retry_222
s_branch epi_225
both_226:
s_waitcnt vmcnt(13) lgkmcnt(0)
s_barrier
ds_read_b128 v[224:227],v17 offset:0
ds_read_b128 v[228:231],v43 offset:0
ds_read_b128 v[232:235],v17 offset:8192
ds_read_b128 v[236:239],v43 offset:8192
ds_read_b128 v[240:243],v17 offset:1024
ds_read_b128 v[244:247],v43 offset:1024
ds_read_b128 v[248:251],v17 offset:9216
s_waitcnt lgkmcnt(5)
v_mfma_f32_16x16x32_bf16 v[64:67],a[0:3],v[224:227],0
s_add_u32 s96,s71,1
s_add_u32 s92,s71,2
v_min_u32 v27,v224,v228
v_mfma_f32_16x16x32_bf16 v[72:75],a[128:131],v[224:227],0
ds_read_b128 v[252:255],v43 offset:9216
s_add_u32 s88,s70,s75
v_mfma_f32_16x16x32_bf16 v[64:67],a[4:7],v[228:231],v[64:67]
s_add_u32 s88,s88,2097152
s_xor_b32 s88,s88,0x2000
v_mfma_f32_16x16x32_bf16 v[72:75],a[132:135],v[228:231],v[72:75]
ds_read_b128 v[224:227],v17 offset:16384
s_waitcnt lgkmcnt(5)
v_mfma_f32_16x16x32_bf16 v[64:67],a[8:11],v[232:235],v[64:67]
s_add_u32 s89,s88,65536
v_min3_u32 v27,v27,v232,v236
v_mfma_f32_16x16x32_bf16 v[72:75],a[136:139],v[232:235],v[72:75]
ds_read_b128 v[228:231],v43 offset:16384
v_mfma_f32_16x16x32_bf16 v[64:67],a[12:15],v[236:239],v[64:67]
s_xor_b32 m0,s72,0
v_mfma_f32_16x16x32_bf16 v[72:75],a[140:143],v[236:239],v[72:75]
ds_read_b128 v[232:235],v17 offset:24576
s_add_u32 s65,s88,0
s_waitcnt lgkmcnt(5)
v_mfma_f32_16x16x32_bf16 v[64:67],a[64:67],v[240:243],v[64:67]
v_min3_u32 v27,v27,v240,v244
v_mfma_f32_16x16x32_bf16 v[72:75],a[192:195],v[240:243],v[72:75]
ds_read_b128 v[236:239],v43 offset:24576
buffer_load_dwordx4 v42,s[20:23],s65 offen offset:0 sc1 lds
v_mfma_f32_16x16x32_bf16 v[64:67],a[68:71],v[244:247],v[64:67]
buffer_load_dwordx4 v42,s[20:23],s65 offen offset:1024 sc1 lds
v_mfma_f32_16x16x32_bf16 v[72:75],a[196:199],v[244:247],v[72:75]
ds_read_b128 v[240:243],v17 offset:17408
s_waitcnt lgkmcnt(5)
v_mfma_f32_16x16x32_bf16 v[64:67],a[72:75],v[248:251],v[64:67]
s_xor_b32 m0,s72,16384
v_min3_u32 v27,v27,v248,v252
v_mfma_f32_16x16x32_bf16 v[72:75],a[200:203],v[248:251],v[72:75]
ds_read_b128 v[244:247],v43 offset:17408
v_mfma_f32_16x16x32_bf16 v[64:67],a[76:79],v[252:255],v[64:67]
s_add_u32 s65,s88,256
v_mfma_f32_16x16x32_bf16 v[72:75],a[204:207],v[252:255],v[72:75]
ds_read_b128 v[248:251],v17 offset:25600
s_waitcnt lgkmcnt(5)
v_mfma_f32_16x16x32_bf16 v[64:67],a[16:19],v[224:227],v[64:67]
buffer_load_dwordx4 v42,s[20:23],s65 offen offset:0 sc1 lds
v_mfma_f32_16x16x32_bf16 v[72:75],a[144:147],v[224:227],v[72:75]
ds_read_b128 v[252:255],v43 offset:25600
buffer_load_dwordx4 v42,s[20:23],s65 offen offset:1024 sc1 lds
v_mfma_f32_16x16x32_bf16 v[64:67],a[20:23],v[228:231],v[64:67]
v_min3_u32 v27,v27,v224,v228
v_mfma_f32_16x16x32_bf16 v[72:75],a[148:151],v[228:231],v[72:75]
ds_read_b128 v[224:227],v17 offset:32768
s_xor_b32 m0,s72,32768
s_waitcnt lgkmcnt(5)
v_mfma_f32_16x16x32_bf16 v[64:67],a[24:27],v[232:235],v[64:67]
s_add_u32 s65,s88,512
v_min3_u32 v27,v27,v232,v236
v_mfma_f32_16x16x32_bf16 v[72:75],a[152:155],v[232:235],v[72:75]
ds_read_b128 v[228:231],v43 offset:32768
v_mfma_f32_16x16x32_bf16 v[64:67],a[28:31],v[236:239],v[64:67]
buffer_load_dwordx4 v42,s[20:23],s65 offen offset:0 sc1 lds
v_mfma_f32_16x16x32_bf16 v[72:75],a[156:159],v[236:239],v[72:75]
ds_read_b128 v[232:235],v17 offset:40960
s_waitcnt lgkmcnt(5)
v_mfma_f32_16x16x32_bf16 v[64:67],a[80:83],v[240:243],v[64:67]
buffer_load_dwordx4 v42,s[20:23],s65 offen offset:1024 sc1 lds
v_mfma_f32_16x16x32_bf16 v[72:75],a[208:211],v[240:243],v[72:75]
ds_read_b128 v[236:239],v43 offset:40960
s_xor_b32 m0,s72,49152
v_mfma_f32_16x16x32_bf16 v[64:67],a[84:87],v[244:247],v[64:67]
v_min3_u32 v27,v27,v240,v244
v_mfma_f32_16x16x32_bf16 v[72:75],a[212:215],v[244:247],v[72:75]
ds_read_b128 v[240:243],v17 offset:33792
s_add_u32 s65,s88,768
s_waitcnt lgkmcnt(5)
v_mfma_f32_16x16x32_bf16 v[64:67],a[88:91],v[248:251],v[64:67]
buffer_load_dwordx4 v42,s[20:23],s65 offen offset:0 sc1 lds
v_min3_u32 v27,v27,v248,v252
v_mfma_f32_16x16x32_bf16 v[72:75],a[216:219],v[248:251],v[72:75]
ds_read_b128 v[244:247],v43 offset:33792
s_waitcnt vmcnt(10)
v_mfma_f32_16x16x32_bf16 v[64:67],a[92:95],v[252:255],v[64:67]
v_cmp_gt_u32 vcc,s96,v29
v_cmp_gt_u32 s[92:93],s92,v29
v_mfma_f32_16x16x32_bf16 v[72:75],a[220:223],v[252:255],v[72:75]
ds_read_b128 v[248:251],v17 offset:41984
s_waitcnt lgkmcnt(5)
v_mfma_f32_16x16x32_bf16 v[64:67],a[32:35],v[224:227],v[64:67]
v_mov_b32 v44,vcc_lo
v_mov_b32 v45,s92
v_min3_u32 v27,v27,v224,v228
v_mfma_f32_16x16x32_bf16 v[72:75],a[160:163],v[224:227],v[72:75]
ds_read_b128 v[252:255],v43 offset:41984
ds_write_b64 v46,v[44:45]
v_mfma_f32_16x16x32_bf16 v[64:67],a[36:39],v[228:231],v[64:67]
buffer_load_dwordx4 v42,s[20:23],s65 offen offset:1024 sc1 lds
v_mfma_f32_16x16x32_bf16 v[72:75],a[164:167],v[228:231],v[72:75]
ds_read_b128 v[224:227],v17 offset:49152
s_waitcnt lgkmcnt(6)
v_mfma_f32_16x16x32_bf16 v[64:67],a[40:43],v[232:235],v[64:67]
s_xor_b32 m0,s72,4096
s_add_u32 s65,s89,0
v_mfma_f32_16x16x32_bf16 v[72:75],a[168:171],v[232:235],v[72:75]
ds_read_b128 v[228:231],v43 offset:49152
v_min3_u32 v27,v27,v232,v236
v_mfma_f32_16x16x32_bf16 v[64:67],a[44:47],v[236:239],v[64:67]
buffer_load_dwordx4 v42,s[20:23],s65 offen offset:0 sc1 lds
v_mfma_f32_16x16x32_bf16 v[72:75],a[172:175],v[236:239],v[72:75]
ds_read_b128 v[232:235],v17 offset:57344
s_waitcnt lgkmcnt(6)
v_mfma_f32_16x16x32_bf16 v[64:67],a[96:99],v[240:243],v[64:67]
buffer_load_dwordx4 v42,s[20:23],s65 offen offset:1024 sc1 lds
v_mfma_f32_16x16x32_bf16 v[72:75],a[224:227],v[240:243],v[72:75]
ds_read_b128 v[236:239],v43 offset:57344
s_xor_b32 m0,s72,20480
v_mfma_f32_16x16x32_bf16 v[64:67],a[100:103],v[244:247],v[64:67]
s_add_u32 s65,s89,256
v_min3_u32 v27,v27,v240,v244
v_mfma_f32_16x16x32_bf16 v[72:75],a[228:231],v[244:247],v[72:75]
ds_read_b128 v[240:243],v17 offset:50176
s_waitcnt lgkmcnt(6)
v_mfma_f32_16x16x32_bf16 v[64:67],a[104:107],v[248:251],v[64:67]
buffer_load_dwordx4 v42,s[20:23],s65 offen offset:0 sc1 lds
v_mfma_f32_16x16x32_bf16 v[72:75],a[232:235],v[248:251],v[72:75]
ds_read_b128 v[244:247],v43 offset:50176
v_min3_u32 v27,v27,v248,v252
v_mfma_f32_16x16x32_bf16 v[64:67],a[108:111],v[252:255],v[64:67]
buffer_load_dwordx4 v42,s[20:23],s65 offen offset:1024 sc1 lds
v_mfma_f32_16x16x32_bf16 v[72:75],a[236:239],v[252:255],v[72:75]
ds_read_b128 v[248:251],v17 offset:58368
s_waitcnt lgkmcnt(5)
v_mfma_f32_16x16x32_bf16 v[64:67],a[48:51],v[224:227],v[64:67]
s_xor_b32 m0,s72,36864
s_add_u32 s65,s89,512
v_mfma_f32_16x16x32_bf16 v[72:75],a[176:179],v[224:227],v[72:75]
ds_read_b128 v[252:255],v43 offset:58368
v_min3_u32 v27,v27,v224,v228
v_mfma_f32_16x16x32_bf16 v[64:67],a[52:55],v[228:231],v[64:67]
buffer_load_dwordx4 v42,s[20:23],s65 offen offset:0 sc1 lds
s_waitcnt vmcnt(13)
v_add_u32 v22,s71,-1
v_mfma_f32_16x16x32_bf16 v[72:75],a[180:183],v[228:231],v[72:75]
s_waitcnt vmcnt(18)
s_barrier
ds_read_b64 v[44:45],v47
ds_read_b128 v[224:227],v17 offset:4096
s_waitcnt lgkmcnt(6)
v_mfma_f32_16x16x32_bf16 v[64:67],a[56:59],v[232:235],v[64:67]
buffer_load_dwordx4 v42,s[20:23],s65 offen offset:1024 sc1 lds
buffer_store_dword v22,v23,s[24:27],s97 offen
v_mfma_f32_16x16x32_bf16 v[72:75],a[184:187],v[232:235],v[72:75]
ds_read_b128 v[228:231],v43 offset:4096
s_xor_b32 m0,s72,53248
buffer_store_dword v22,v23,s[28:31],s97 offen sc1
v_mfma_f32_16x16x32_bf16 v[64:67],a[60:63],v[236:239],v[64:67]
s_add_u32 s65,s89,768
v_min3_u32 v27,v27,v232,v236
s_mov_b32 s97,0x7fff0000
v_mfma_f32_16x16x32_bf16 v[72:75],a[188:191],v[236:239],v[72:75]
ds_read_b128 v[232:235],v17 offset:12288
s_waitcnt lgkmcnt(6)
v_mfma_f32_16x16x32_bf16 v[64:67],a[112:115],v[240:243],v[64:67]
buffer_load_dwordx4 v42,s[20:23],s65 offen offset:0 sc1 lds
v_mfma_f32_16x16x32_bf16 v[72:75],a[240:243],v[240:243],v[72:75]
ds_read_b128 v[236:239],v43 offset:12288
v_min3_u32 v27,v27,v240,v244
v_mfma_f32_16x16x32_bf16 v[64:67],a[116:119],v[244:247],v[64:67]
buffer_load_dwordx4 v42,s[20:23],s65 offen offset:1024 sc1 lds
v_mfma_f32_16x16x32_bf16 v[72:75],a[244:247],v[244:247],v[72:75]
ds_read_b128 v[240:243],v17 offset:5120
s_waitcnt lgkmcnt(6)
v_mfma_f32_16x16x32_bf16 v[64:67],a[120:123],v[248:251],v[64:67]
s_waitcnt lgkmcnt(5)
v_readfirstlane_b32 s93,v45
v_mfma_f32_16x16x32_bf16 v[72:75],a[248:251],v[248:251],v[72:75]
ds_read_b128 v[244:247],v43 offset:5120
v_min3_u32 v27,v27,v248,v252
v_mfma_f32_16x16x32_bf16 v[64:67],a[124:127],v[252:255],v[64:67]
v_mfma_f32_16x16x32_bf16 v[72:75],a[252:255],v[252:255],v[72:75]
ds_read_b128 v[248:251],v17 offset:13312
s_waitcnt lgkmcnt(5)
v_mfma_f32_16x16x32_bf16 v[68:71],a[0:3],v[224:227],0
v_cmp_eq_u32 vcc,0,v27
s_cbranch_vccnz retry_222
v_mfma_f32_16x16x32_bf16 v[76:79],a[128:131],v[224:227],0
ds_read_b128 v[252:255],v43 offset:13312
v_min3_u32 v27,v27,v224,v228
v_mfma_f32_16x16x32_bf16 v[68:71],a[4:7],v[228:231],v[68:71]
v_mfma_f32_16x16x32_bf16 v[76:79],a[132:135],v[228:231],v[76:79]
ds_read_b128 v[224:227],v17 offset:20480
s_waitcnt lgkmcnt(5)
v_mfma_f32_16x16x32_bf16 v[68:71],a[8:11],v[232:235],v[68:71]
v_min3_u32 v27,v27,v232,v236
v_mul_f32 v88,v64,v64
v_mul_f32 v92,v72,v72
v_mfma_f32_16x16x32_bf16 v[76:79],a[136:139],v[232:235],v[76:79]
ds_read_b128 v[228:231],v43 offset:20480
v_mul_f32 v89,v65,v65
v_mul_f32 v93,v73,v73
v_mfma_f32_16x16x32_bf16 v[68:71],a[12:15],v[236:239],v[68:71]
v_mul_f32 v90,v66,v66
v_mul_f32 v91,v67,v67
v_mul_f32 v94,v74,v74
v_mfma_f32_16x16x32_bf16 v[76:79],a[140:143],v[236:239],v[76:79]
ds_read_b128 v[232:235],v17 offset:28672
v_mul_f32 v95,v75,v75
s_waitcnt lgkmcnt(5)
v_mfma_f32_16x16x32_bf16 v[68:71],a[64:67],v[240:243],v[68:71]
v_min3_u32 v27,v27,v240,v244
v_fma_f32 v88,v88,s81,v28
v_fma_f32 v92,v92,s81,v28
v_mfma_f32_16x16x32_bf16 v[76:79],a[192:195],v[240:243],v[76:79]
ds_read_b128 v[236:239],v43 offset:28672
v_fma_f32 v89,v89,s81,v28
v_fma_f32 v93,v93,s81,v28
v_mfma_f32_16x16x32_bf16 v[68:71],a[68:71],v[244:247],v[68:71]
v_fma_f32 v90,v90,s81,v28
v_fma_f32 v91,v91,s81,v28
v_fma_f32 v94,v94,s81,v28
v_mfma_f32_16x16x32_bf16 v[76:79],a[196:199],v[244:247],v[76:79]
ds_read_b128 v[240:243],v17 offset:21504
v_fma_f32 v95,v95,s81,v28
s_waitcnt lgkmcnt(5)
v_mfma_f32_16x16x32_bf16 v[68:71],a[72:75],v[248:251],v[68:71]
v_min3_u32 v27,v27,v248,v252
v_mul_f32 v88,v88,v64
v_mul_f32 v92,v92,v72
v_mfma_f32_16x16x32_bf16 v[76:79],a[200:203],v[248:251],v[76:79]
ds_read_b128 v[244:247],v43 offset:21504
v_mul_f32 v89,v89,v65
v_mul_f32 v93,v93,v73
v_mfma_f32_16x16x32_bf16 v[68:71],a[76:79],v[252:255],v[68:71]
v_mul_f32 v90,v90,v66
v_mul_f32 v91,v91,v67
v_mul_f32 v94,v94,v74
v_mfma_f32_16x16x32_bf16 v[76:79],a[204:207],v[252:255],v[76:79]
ds_read_b128 v[248:251],v17 offset:29696
v_mul_f32 v95,v95,v75
s_waitcnt lgkmcnt(5)
v_mfma_f32_16x16x32_bf16 v[68:71],a[16:19],v[224:227],v[68:71]
v_min3_u32 v27,v27,v224,v228
v_exp_f32 v92,v92
v_mfma_f32_16x16x32_bf16 v[76:79],a[144:147],v[224:227],v[76:79]
ds_read_b128 v[252:255],v43 offset:29696
v_exp_f32 v93,v93
v_mfma_f32_16x16x32_bf16 v[68:71],a[20:23],v[228:231],v[68:71]
v_exp_f32 v88,v88
v_mfma_f32_16x16x32_bf16 v[76:79],a[148:151],v[228:231],v[76:79]
ds_read_b128 v[224:227],v17 offset:36864
s_waitcnt lgkmcnt(5)
v_mfma_f32_16x16x32_bf16 v[68:71],a[24:27],v[232:235],v[68:71]
v_min3_u32 v27,v27,v232,v236
v_exp_f32 v94,v94
v_mfma_f32_16x16x32_bf16 v[76:79],a[152:155],v[232:235],v[76:79]
ds_read_b128 v[228:231],v43 offset:36864
v_exp_f32 v95,v95
v_mfma_f32_16x16x32_bf16 v[68:71],a[28:31],v[236:239],v[68:71]
v_exp_f32 v89,v89
v_add_f32 v92,1.0,v92
v_mfma_f32_16x16x32_bf16 v[76:79],a[156:159],v[236:239],v[76:79]
ds_read_b128 v[232:235],v17 offset:45056
v_add_f32 v93,1.0,v93
s_waitcnt lgkmcnt(5)
v_mfma_f32_16x16x32_bf16 v[68:71],a[80:83],v[240:243],v[68:71]
v_min3_u32 v27,v27,v240,v244
v_add_f32 v94,1.0,v94
v_add_f32 v95,1.0,v95
v_mfma_f32_16x16x32_bf16 v[76:79],a[208:211],v[240:243],v[76:79]
ds_read_b128 v[236:239],v43 offset:45056
v_rcp_f32 v92,v92
v_mfma_f32_16x16x32_bf16 v[68:71],a[84:87],v[244:247],v[68:71]
v_exp_f32 v90,v90
v_mfma_f32_16x16x32_bf16 v[76:79],a[212:215],v[244:247],v[76:79]
ds_read_b128 v[240:243],v17 offset:37888
s_waitcnt lgkmcnt(5)
v_mfma_f32_16x16x32_bf16 v[68:71],a[88:91],v[248:251],v[68:71]
v_min3_u32 v27,v27,v248,v252
v_rcp_f32 v93,v93
v_mfma_f32_16x16x32_bf16 v[76:79],a[216:219],v[248:251],v[76:79]
ds_read_b128 v[244:247],v43 offset:37888
v_rcp_f32 v94,v94
v_mfma_f32_16x16x32_bf16 v[68:71],a[92:95],v[252:255],v[68:71]
v_exp_f32 v91,v91
v_mfma_f32_16x16x32_bf16 v[76:79],a[220:223],v[252:255],v[76:79]
ds_read_b128 v[248:251],v17 offset:46080
s_waitcnt lgkmcnt(5)
v_mfma_f32_16x16x32_bf16 v[68:71],a[32:35],v[224:227],v[68:71]
v_min3_u32 v27,v27,v224,v228
v_add_f32 v88,1.0,v88
v_mfma_f32_16x16x32_bf16 v[76:79],a[160:163],v[224:227],v[76:79]
ds_read_b128 v[252:255],v43 offset:46080
v_add_f32 v89,1.0,v89
v_mfma_f32_16x16x32_bf16 v[68:71],a[36:39],v[228:231],v[68:71]
v_add_f32 v90,1.0,v90
v_add_f32 v91,1.0,v91
v_mfma_f32_16x16x32_bf16 v[76:79],a[164:167],v[228:231],v[76:79]
ds_read_b128 v[224:227],v17 offset:53248
s_waitcnt lgkmcnt(5)
v_mfma_f32_16x16x32_bf16 v[68:71],a[40:43],v[232:235],v[68:71]
v_min3_u32 v27,v27,v232,v236
v_mfma_f32_16x16x32_bf16 v[76:79],a[168:171],v[232:235],v[76:79]
ds_read_b128 v[228:231],v43 offset:53248
v_mfma_f32_16x16x32_bf16 v[68:71],a[44:47],v[236:239],v[68:71]
v_rcp_f32 v88,v88
v_mfma_f32_16x16x32_bf16 v[76:79],a[172:175],v[236:239],v[76:79]
ds_read_b128 v[232:235],v17 offset:61440
s_waitcnt lgkmcnt(5)
v_mfma_f32_16x16x32_bf16 v[68:71],a[96:99],v[240:243],v[68:71]
v_min3_u32 v27,v27,v240,v244
v_mfma_f32_16x16x32_bf16 v[76:79],a[224:227],v[240:243],v[76:79]
ds_read_b128 v[236:239],v43 offset:61440
v_mfma_f32_16x16x32_bf16 v[68:71],a[100:103],v[244:247],v[68:71]
v_rcp_f32 v89,v89
v_mfma_f32_16x16x32_bf16 v[76:79],a[228:231],v[244:247],v[76:79]
ds_read_b128 v[240:243],v17 offset:54272
s_waitcnt lgkmcnt(5)
v_mfma_f32_16x16x32_bf16 v[68:71],a[104:107],v[248:251],v[68:71]
v_min3_u32 v27,v27,v248,v252
v_mfma_f32_16x16x32_bf16 v[76:79],a[232:235],v[248:251],v[76:79]
ds_read_b128 v[244:247],v43 offset:54272
v_mfma_f32_16x16x32_bf16 v[68:71],a[108:111],v[252:255],v[68:71]
v_rcp_f32 v90,v90
v_mfma_f32_16x16x32_bf16 v[76:79],a[236:239],v[252:255],v[76:79]
ds_read_b128 v[248:251],v17 offset:62464
s_waitcnt lgkmcnt(5)
v_mfma_f32_16x16x32_bf16 v[68:71],a[48:51],v[224:227],v[68:71]
v_min3_u32 v27,v27,v224,v228
v_mfma_f32_16x16x32_bf16 v[76:79],a[176:179],v[224:227],v[76:79]
ds_read_b128 v[252:255],v43 offset:62464
v_mfma_f32_16x16x32_bf16 v[68:71],a[52:55],v[228:231],v[68:71]
v_rcp_f32 v91,v91
v_mfma_f32_16x16x32_bf16 v[76:79],a[180:183],v[228:231],v[76:79]
v_mul_f32 v88,v88,v64
s_waitcnt lgkmcnt(4)
v_mfma_f32_16x16x32_bf16 v[68:71],a[56:59],v[232:235],v[68:71]
v_min3_u32 v27,v27,v232,v236
v_mul_f32 v89,v89,v65
v_mfma_f32_16x16x32_bf16 v[76:79],a[184:187],v[232:235],v[76:79]
v_mul_f32 v90,v90,v66
v_mul_f32 v91,v91,v67
v_mfma_f32_16x16x32_bf16 v[68:71],a[60:63],v[236:239],v[68:71]
v_rcp_f32 v95,v95
v_mfma_f32_16x16x32_bf16 v[76:79],a[188:191],v[236:239],v[76:79]
v_mul_f32 v92,v92,v72
s_waitcnt lgkmcnt(2)
v_mfma_f32_16x16x32_bf16 v[68:71],a[112:115],v[240:243],v[68:71]
v_min3_u32 v27,v27,v240,v244
v_mul_f32 v93,v93,v73
v_mfma_f32_16x16x32_bf16 v[76:79],a[240:243],v[240:243],v[76:79]
v_mul_f32 v94,v94,v74
v_mul_f32 v95,v95,v75
v_mfma_f32_16x16x32_bf16 v[68:71],a[116:119],v[244:247],v[68:71]
v_cvt_pk_bf16_f32 v96,v88,v89
v_cvt_pk_bf16_f32 v97,v90,v91
v_mfma_f32_16x16x32_bf16 v[76:79],a[244:247],v[244:247],v[76:79]
v_cvt_pk_bf16_f32 v98,v92,v93
s_waitcnt lgkmcnt(0)
v_mfma_f32_16x16x32_bf16 v[68:71],a[120:123],v[248:251],v[68:71]
v_min3_u32 v27,v27,v248,v252
v_cvt_pk_bf16_f32 v99,v94,v95
v_mfma_f32_16x16x32_bf16 v[76:79],a[248:251],v[248:251],v[76:79]
v_max_u32 v96,1,v96
v_mfma_f32_16x16x32_bf16 v[68:71],a[124:127],v[252:255],v[68:71]
buffer_store_dwordx4 v[96:99],v18,s[20:23],s78 offen sc1
v_mfma_f32_16x16x32_bf16 v[76:79],a[252:255],v[252:255],v[76:79]
v_cmp_eq_u32 vcc,0,v27
s_cbranch_vccnz retry_222
epi_225:
buffer_load_dword v29,v21,s[20:23],s87 offen sc1
s_cmp_gt_u32 s71,40
s_cselect_b32 s65,s73,0x7fff0000
s_cselect_b32 s97,0x7fff0000,s73
v_mov_b32 v22,s71
buffer_store_dword v22,v23,s[24:27],s65 offen
buffer_store_dword v22,v23,s[28:31],s65 offen sc1
v_pk_mul_f32 v[88:89],v[68:69],v[68:69]
v_pk_mul_f32 v[90:91],v[70:71],v[70:71]
v_pk_mul_f32 v[92:93],v[76:77],v[76:77]
v_pk_mul_f32 v[94:95],v[78:79],v[78:79]
v_pk_fma_f32 v[88:89],v[88:89],s[80:81],v[28:29] op_sel:[0,1,0] op_sel_hi:[1,1,0]
v_pk_fma_f32 v[90:91],v[90:91],s[80:81],v[28:29] op_sel:[0,1,0] op_sel_hi:[1,1,0]
v_pk_fma_f32 v[92:93],v[92:93],s[80:81],v[28:29] op_sel:[0,1,0] op_sel_hi:[1,1,0]
v_pk_fma_f32 v[94:95],v[94:95],s[80:81],v[28:29] op_sel:[0,1,0] op_sel_hi:[1,1,0]
v_pk_mul_f32 v[88:89],v[88:89],v[68:69]
v_pk_mul_f32 v[90:91],v[90:91],v[70:71]
v_pk_mul_f32 v[92:93],v[92:93],v[76:77]
v_pk_mul_f32 v[94:95],v[94:95],v[78:79]
v_exp_f32 v88,v88
v_exp_f32 v89,v89
v_exp_f32 v90,v90
v_exp_f32 v91,v91
v_exp_f32 v92,v92
v_exp_f32 v93,v93
v_exp_f32 v94,v94
v_exp_f32 v95,v95
v_pk_add_f32 v[88:89],v[88:89],1.0 op_sel_hi:[1,0]
v_pk_add_f32 v[90:91],v[90:91],1.0 op_sel_hi:[1,0]
v_pk_add_f32 v[92:93],v[92:93],1.0 op_sel_hi:[1,0]
v_pk_add_f32 v[94:95],v[94:95],1.0 op_sel_hi:[1,0]
v_rcp_f32 v88,v88
v_rcp_f32 v89,v89
v_rcp_f32 v90,v90
v_rcp_f32 v91,v91
v_rcp_f32 v92,v92
v_rcp_f32 v93,v93
v_rcp_f32 v94,v94
v_rcp_f32 v95,v95
v_pk_mul_f32 v[88:89],v[88:89],v[68:69]
v_pk_mul_f32 v[90:91],v[90:91],v[70:71]
v_pk_mul_f32 v[92:93],v[92:93],v[76:77]
v_pk_mul_f32 v[94:95],v[94:95],v[78:79]
v_cvt_pk_bf16_f32 v96,v88,v89
v_cvt_pk_bf16_f32 v97,v90,v91
v_cvt_pk_bf16_f32 v98,v92,v93
v_cvt_pk_bf16_f32 v99,v94,v95
v_max_u32 v96,1,v96
buffer_store_dwordx4 v[96:99],v19,s[20:23],s78 offen sc1
v_xor_b32 v18,0x2000,v18
v_xor_b32 v19,0x2000,v19
s_add_u32 s78,s78,2097152
next_232:
v_xor_b32 v43,0x10000,v43
v_xor_b32 v17,0x10000,v17
s_xor_b32 s72,s72,0x10000
s_add_u32 s70,s70,2097152
s_xor_b32 s70,s70,0x2000
s_add_u32 s71,s71,1
s_cmp_le_u32 s71,64
s_cbranch_scc1 seg_223
s_add_u32 s65,s73,2560
v_add_u32 v22,s71,-1
buffer_store_dword v22,v23,s[20:23],s65 offen sc1
s_endpgm
retry_222:
s_sub_u32 s90,s90,64
s_cmp_lt_i32 s90,0
s_cbranch_scc1 giveup_197
s_mov_b32 s83,1
s_waitcnt vmcnt(0) lgkmcnt(0)
s_barrier
s_branch seg_223
r_w2_217:
s_load_dwordx2 s[4:5],s[0:1],72
s_and_b32 s41,s59,7
s_lshl_b32 s66,s41,8
s_lshl_b32 s67,s50,1
s_waitcnt lgkmcnt(0)
s_mov_b32 s32,s4
s_and_b32 s33,s5,0xffff
s_mov_b32 s34,0x200000
s_mov_b32 s35,0x20000
v_lshrrev_b32 v5,2,v3
v_lshl_add_u32 v5,v4,2,v5
v_and_b32 v6,3,v3
v_lshlrev_b32 v6,3,v6
v_lshl_add_u32 v6,v5,8,v6
v_and_b32 v5,7,v5
v_xor_b32 v5,s67,v5
v_lshl_add_u32 v12,v5,5,v6
v_xor_b32 v13,32,v12
v_and_b32 v5,15,v1
v_and_b32 v6,3,v4
v_lshlrev_b32 v6,1,v6
v_xor_b32 v5,v5,v6
v_mul_u32_u24 v6,2048,v4
v_xor_b32 v7,0,v5
v_lshl_add_u32 v8,v7,4,v6
v_xor_b32 v7,8,v5
v_lshl_add_u32 v9,v7,4,v6
s_mul_i32 s74,s50,131072
s_add_u32 s74,s74,s66
s_lshl_b32 s75,s50,14
s_mul_i32 s76,s50,65536
s_add_u32 s76,s76,s66
s_lshl_b32 s77,s50,13
s_add_u32 s64,s74,0
s_add_u32 m0,s75,0
s_nop 0
buffer_load_dwordx4 v8,s[32:35],s64 offen nt lds
s_add_u32 s64,s74,8192
s_add_u32 m0,s75,1024
s_nop 0
buffer_load_dwordx4 v9,s[32:35],s64 offen nt lds
s_add_u32 s64,s74,16384
s_add_u32 m0,s75,2048
s_nop 0
buffer_load_dwordx4 v8,s[32:35],s64 offen nt lds
s_add_u32 s64,s74,24576
s_add_u32 m0,s75,3072
s_nop 0
buffer_load_dwordx4 v9,s[32:35],s64 offen nt lds
s_add_u32 s64,s74,32768
s_add_u32 m0,s75,4096
s_nop 0
buffer_load_dwordx4 v8,s[32:35],s64 offen nt lds
s_add_u32 s64,s74,40960
s_add_u32 m0,s75,5120
s_nop 0
buffer_load_dwordx4 v9,s[32:35],s64 offen nt lds
s_add_u32 s64,s74,49152
s_add_u32 m0,s75,6144
s_nop 0
buffer_load_dwordx4 v8,s[32:35],s64 offen nt lds
s_add_u32 s64,s74,57344
s_add_u32 m0,s75,7168
s_nop 0
buffer_load_dwordx4 v9,s[32:35],s64 offen nt lds
s_add_u32 s64,s74,65536
s_add_u32 m0,s75,8192
s_nop 0
buffer_load_dwordx4 v8,s[32:35],s64 offen nt lds
s_add_u32 s64,s74,73728
s_add_u32 m0,s75,9216
s_nop 0
buffer_load_dwordx4 v9,s[32:35],s64 offen nt lds
s_add_u32 s64,s74,81920
s_add_u32 m0,s75,10240
s_nop 0
buffer_load_dwordx4 v8,s[32:35],s64 offen nt lds
s_add_u32 s64,s74,90112
s_add_u32 m0,s75,11264
s_nop 0
buffer_load_dwordx4 v9,s[32:35],s64 offen nt lds
s_add_u32 s64,s74,98304
s_add_u32 m0,s75,12288
s_nop 0
buffer_load_dwordx4 v8,s[32:35],s64 offen nt lds
s_add_u32 s64,s74,106496
s_add_u32 m0,s75,13312
s_nop 0
buffer_load_dwordx4 v9,s[32:35],s64 offen nt lds
s_add_u32 s64,s74,114688
s_add_u32 m0,s75,14336
s_nop 0
buffer_load_dwordx4 v8,s[32:35],s64 offen nt lds
s_add_u32 s64,s74,122880
s_add_u32 m0,s75,15360
s_nop 0
buffer_load_dwordx4 v9,s[32:35],s64 offen nt lds
s_add_u32 s64,s74,524288
s_add_u32 m0,s75,65536
s_nop 0
buffer_load_dwordx4 v8,s[32:35],s64 offen nt lds
s_add_u32 s64,s74,532480
s_add_u32 m0,s75,66560
s_nop 0
buffer_load_dwordx4 v9,s[32:35],s64 offen nt lds
s_add_u32 s64,s74,540672
s_add_u32 m0,s75,67584
s_nop 0
buffer_load_dwordx4 v8,s[32:35],s64 offen nt lds
s_add_u32 s64,s74,548864
s_add_u32 m0,s75,68608
s_nop 0
buffer_load_dwordx4 v9,s[32:35],s64 offen nt lds
s_add_u32 s64,s74,557056
s_add_u32 m0,s75,69632
s_nop 0
buffer_load_dwordx4 v8,s[32:35],s64 offen nt lds
s_add_u32 s64,s74,565248
s_add_u32 m0,s75,70656
s_nop 0
buffer_load_dwordx4 v9,s[32:35],s64 offen nt lds
s_add_u32 s64,s74,573440
s_add_u32 m0,s75,71680
s_nop 0
buffer_load_dwordx4 v8,s[32:35],s64 offen nt lds
s_add_u32 s64,s74,581632
s_add_u32 m0,s75,72704
s_nop 0
buffer_load_dwordx4 v9,s[32:35],s64 offen nt lds
s_add_u32 s64,s74,589824
s_add_u32 m0,s75,73728
s_nop 0
buffer_load_dwordx4 v8,s[32:35],s64 offen nt lds
s_add_u32 s64,s74,598016
s_add_u32 m0,s75,74752
s_nop 0
buffer_load_dwordx4 v9,s[32:35],s64 offen nt lds
s_add_u32 s64,s74,606208
s_add_u32 m0,s75,75776
s_nop 0
buffer_load_dwordx4 v8,s[32:35],s64 offen nt lds
s_add_u32 s64,s74,614400
s_add_u32 m0,s75,76800
s_nop 0
buffer_load_dwordx4 v9,s[32:35],s64 offen nt lds
s_add_u32 s64,s74,622592
s_add_u32 m0,s75,77824
s_nop 0
buffer_load_dwordx4 v8,s[32:35],s64 offen nt lds
s_add_u32 s64,s74,630784
s_add_u32 m0,s75,78848
s_nop 0
buffer_load_dwordx4 v9,s[32:35],s64 offen nt lds
s_add_u32 s64,s74,638976
s_add_u32 m0,s75,79872
s_nop 0
buffer_load_dwordx4 v8,s[32:35],s64 offen nt lds
s_add_u32 s64,s74,647168
s_add_u32 m0,s75,80896
s_nop 0
buffer_load_dwordx4 v9,s[32:35],s64 offen nt lds
s_waitcnt vmcnt(16)
s_barrier
ds_read_b64_tr_b16 a[0:1],v12 offset:0
ds_read_b64_tr_b16 a[128:129],v13 offset:0
ds_read_b64_tr_b16 a[2:3],v12 offset:4096
ds_read_b64_tr_b16 a[130:131],v13 offset:4096
ds_read_b64_tr_b16 a[4:5],v12 offset:8192
ds_read_b64_tr_b16 a[132:133],v13 offset:8192
ds_read_b64_tr_b16 a[6:7],v12 offset:12288
ds_read_b64_tr_b16 a[134:135],v13 offset:12288
s_waitcnt lgkmcnt(4)
ds_read_b64_tr_b16 a[8:9],v12 offset:16384
ds_read_b64_tr_b16 a[136:137],v13 offset:16384
ds_read_b64_tr_b16 a[10:11],v12 offset:20480
ds_read_b64_tr_b16 a[138:139],v13 offset:20480
ds_read_b64_tr_b16 a[12:13],v12 offset:24576
ds_read_b64_tr_b16 a[140:141],v13 offset:24576
ds_read_b64_tr_b16 a[14:15],v12 offset:28672
ds_read_b64_tr_b16 a[142:143],v13 offset:28672
s_waitcnt lgkmcnt(4)
ds_read_b64_tr_b16 a[16:17],v12 offset:32768
ds_read_b64_tr_b16 a[144:145],v13 offset:32768
ds_read_b64_tr_b16 a[18:19],v12 offset:36864
ds_read_b64_tr_b16 a[146:147],v13 offset:36864
ds_read_b64_tr_b16 a[20:21],v12 offset:40960
ds_read_b64_tr_b16 a[148:149],v13 offset:40960
ds_read_b64_tr_b16 a[22:23],v12 offset:45056
ds_read_b64_tr_b16 a[150:151],v13 offset:45056
s_waitcnt lgkmcnt(4)
ds_read_b64_tr_b16 a[24:25],v12 offset:49152
ds_read_b64_tr_b16 a[152:153],v13 offset:49152
ds_read_b64_tr_b16 a[26:27],v12 offset:53248
ds_read_b64_tr_b16 a[154:155],v13 offset:53248
ds_read_b64_tr_b16 a[28:29],v12 offset:57344
ds_read_b64_tr_b16 a[156:157],v13 offset:57344
ds_read_b64_tr_b16 a[30:31],v12 offset:61440
ds_read_b64_tr_b16 a[158:159],v13 offset:61440
s_waitcnt lgkmcnt(4)
v_xor_b32 v12,0x10000,v12
v_xor_b32 v13,0x10000,v13
s_waitcnt lgkmcnt(0)
s_barrier
s_add_u32 s64,s74,1048576
s_add_u32 m0,s75,0
s_nop 0
buffer_load_dwordx4 v8,s[32:35],s64 offen nt lds
s_add_u32 s64,s74,1056768
s_add_u32 m0,s75,1024
s_nop 0
buffer_load_dwordx4 v9,s[32:35],s64 offen nt lds
s_add_u32 s64,s74,1064960
s_add_u32 m0,s75,2048
s_nop 0
buffer_load_dwordx4 v8,s[32:35],s64 offen nt lds
s_add_u32 s64,s74,1073152
s_add_u32 m0,s75,3072
s_nop 0
buffer_load_dwordx4 v9,s[32:35],s64 offen nt lds
s_add_u32 s64,s74,1081344
s_add_u32 m0,s75,4096
s_nop 0
buffer_load_dwordx4 v8,s[32:35],s64 offen nt lds
s_add_u32 s64,s74,1089536
s_add_u32 m0,s75,5120
s_nop 0
buffer_load_dwordx4 v9,s[32:35],s64 offen nt lds
s_add_u32 s64,s74,1097728
s_add_u32 m0,s75,6144
s_nop 0
buffer_load_dwordx4 v8,s[32:35],s64 offen nt lds
s_add_u32 s64,s74,1105920
s_add_u32 m0,s75,7168
s_nop 0
buffer_load_dwordx4 v9,s[32:35],s64 offen nt lds
s_add_u32 s64,s74,1114112
s_add_u32 m0,s75,8192
s_nop 0
buffer_load_dwordx4 v8,s[32:35],s64 offen nt lds
s_add_u32 s64,s74,1122304
s_add_u32 m0,s75,9216
s_nop 0
buffer_load_dwordx4 v9,s[32:35],s64 offen nt lds
s_add_u32 s64,s74,1130496
s_add_u32 m0,s75,10240
s_nop 0
buffer_load_dwordx4 v8,s[32:35],s64 offen nt lds
s_add_u32 s64,s74,1138688
s_add_u32 m0,s75,11264
s_nop 0
buffer_load_dwordx4 v9,s[32:35],s64 offen nt lds
s_add_u32 s64,s74,1146880
s_add_u32 m0,s75,12288
s_nop 0
buffer_load_dwordx4 v8,s[32:35],s64 offen nt lds
s_add_u32 s64,s74,1155072
s_add_u32 m0,s75,13312
s_nop 0
buffer_load_dwordx4 v9,s[32:35],s64 offen nt lds
s_add_u32 s64,s74,1163264
s_add_u32 m0,s75,14336
s_nop 0
buffer_load_dwordx4 v8,s[32:35],s64 offen nt lds
s_add_u32 s64,s74,1171456
s_add_u32 m0,s75,15360
s_nop 0
buffer_load_dwordx4 v9,s[32:35],s64 offen nt lds
s_waitcnt vmcnt(16)
s_barrier
ds_read_b64_tr_b16 a[32:33],v12 offset:0
ds_read_b64_tr_b16 a[160:161],v13 offset:0
ds_read_b64_tr_b16 a[34:35],v12 offset:4096
ds_read_b64_tr_b16 a[162:163],v13 offset:4096
ds_read_b64_tr_b16 a[36:37],v12 offset:8192
ds_read_b64_tr_b16 a[164:165],v13 offset:8192
ds_read_b64_tr_b16 a[38:39],v12 offset:12288
ds_read_b64_tr_b16 a[166:167],v13 offset:12288
s_waitcnt lgkmcnt(4)
ds_read_b64_tr_b16 a[40:41],v12 offset:16384
ds_read_b64_tr_b16 a[168:169],v13 offset:16384
ds_read_b64_tr_b16 a[42:43],v12 offset:20480
ds_read_b64_tr_b16 a[170:171],v13 offset:20480
ds_read_b64_tr_b16 a[44:45],v12 offset:24576
ds_read_b64_tr_b16 a[172:173],v13 offset:24576
ds_read_b64_tr_b16 a[46:47],v12 offset:28672
ds_read_b64_tr_b16 a[174:175],v13 offset:28672
s_waitcnt lgkmcnt(4)
ds_read_b64_tr_b16 a[48:49],v12 offset:32768
ds_read_b64_tr_b16 a[176:177],v13 offset:32768
ds_read_b64_tr_b16 a[50:51],v12 offset:36864
ds_read_b64_tr_b16 a[178:179],v13 offset:36864
ds_read_b64_tr_b16 a[52:53],v12 offset:40960
ds_read_b64_tr_b16 a[180:181],v13 offset:40960
ds_read_b64_tr_b16 a[54:55],v12 offset:45056
ds_read_b64_tr_b16 a[182:183],v13 offset:45056
s_waitcnt lgkmcnt(4)
ds_read_b64_tr_b16 a[56:57],v12 offset:49152
ds_read_b64_tr_b16 a[184:185],v13 offset:49152
ds_read_b64_tr_b16 a[58:59],v12 offset:53248
ds_read_b64_tr_b16 a[186:187],v13 offset:53248
ds_read_b64_tr_b16 a[60:61],v12 offset:57344
ds_read_b64_tr_b16 a[188:189],v13 offset:57344
ds_read_b64_tr_b16 a[62:63],v12 offset:61440
ds_read_b64_tr_b16 a[190:191],v13 offset:61440
s_waitcnt lgkmcnt(4)
v_xor_b32 v12,0x10000,v12
v_xor_b32 v13,0x10000,v13
s_waitcnt lgkmcnt(0)
s_barrier
s_add_u32 s64,s74,1572864
s_add_u32 m0,s75,65536
s_nop 0
buffer_load_dwordx4 v8,s[32:35],s64 offen nt lds
s_add_u32 s64,s74,1581056
s_add_u32 m0,s75,66560
s_nop 0
buffer_load_dwordx4 v9,s[32:35],s64 offen nt lds
s_add_u32 s64,s74,1589248
s_add_u32 m0,s75,67584
s_nop 0
buffer_load_dwordx4 v8,s[32:35],s64 offen nt lds
s_add_u32 s64,s74,1597440
s_add_u32 m0,s75,68608
s_nop 0
buffer_load_dwordx4 v9,s[32:35],s64 offen nt lds
s_add_u32 s64,s74,1605632
s_add_u32 m0,s75,69632
s_nop 0
buffer_load_dwordx4 v8,s[32:35],s64 offen nt lds
s_add_u32 s64,s74,1613824
s_add_u32 m0,s75,70656
s_nop 0
buffer_load_dwordx4 v9,s[32:35],s64 offen nt lds
s_add_u32 s64,s74,1622016
s_add_u32 m0,s75,71680
s_nop 0
buffer_load_dwordx4 v8,s[32:35],s64 offen nt lds
s_add_u32 s64,s74,1630208
s_add_u32 m0,s75,72704
s_nop 0
buffer_load_dwordx4 v9,s[32:35],s64 offen nt lds
s_add_u32 s64,s74,1638400
s_add_u32 m0,s75,73728
s_nop 0
buffer_load_dwordx4 v8,s[32:35],s64 offen nt lds
s_add_u32 s64,s74,1646592
s_add_u32 m0,s75,74752
s_nop 0
buffer_load_dwordx4 v9,s[32:35],s64 offen nt lds
s_add_u32 s64,s74,1654784
s_add_u32 m0,s75,75776
s_nop 0
buffer_load_dwordx4 v8,s[32:35],s64 offen nt lds
s_add_u32 s64,s74,1662976
s_add_u32 m0,s75,76800
s_nop 0
buffer_load_dwordx4 v9,s[32:35],s64 offen nt lds
s_add_u32 s64,s74,1671168
s_add_u32 m0,s75,77824
s_nop 0
buffer_load_dwordx4 v8,s[32:35],s64 offen nt lds
s_add_u32 s64,s74,1679360
s_add_u32 m0,s75,78848
s_nop 0
buffer_load_dwordx4 v9,s[32:35],s64 offen nt lds
s_add_u32 s64,s74,1687552
s_add_u32 m0,s75,79872
s_nop 0
buffer_load_dwordx4 v8,s[32:35],s64 offen nt lds
s_add_u32 s64,s74,1695744
s_add_u32 m0,s75,80896
s_nop 0
buffer_load_dwordx4 v9,s[32:35],s64 offen nt lds
s_waitcnt vmcnt(16)
s_barrier
ds_read_b64_tr_b16 a[64:65],v12 offset:0
ds_read_b64_tr_b16 a[192:193],v13 offset:0
ds_read_b64_tr_b16 a[66:67],v12 offset:4096
ds_read_b64_tr_b16 a[194:195],v13 offset:4096
ds_read_b64_tr_b16 a[68:69],v12 offset:8192
ds_read_b64_tr_b16 a[196:197],v13 offset:8192
ds_read_b64_tr_b16 a[70:71],v12 offset:12288
ds_read_b64_tr_b16 a[198:199],v13 offset:12288
s_waitcnt lgkmcnt(4)
ds_read_b64_tr_b16 a[72:73],v12 offset:16384
ds_read_b64_tr_b16 a[200:201],v13 offset:16384
ds_read_b64_tr_b16 a[74:75],v12 offset:20480
ds_read_b64_tr_b16 a[202:203],v13 offset:20480
ds_read_b64_tr_b16 a[76:77],v12 offset:24576
ds_read_b64_tr_b16 a[204:205],v13 offset:24576
ds_read_b64_tr_b16 a[78:79],v12 offset:28672
ds_read_b64_tr_b16 a[206:207],v13 offset:28672
s_waitcnt lgkmcnt(4)
ds_read_b64_tr_b16 a[80:81],v12 offset:32768
ds_read_b64_tr_b16 a[208:209],v13 offset:32768
ds_read_b64_tr_b16 a[82:83],v12 offset:36864
ds_read_b64_tr_b16 a[210:211],v13 offset:36864
ds_read_b64_tr_b16 a[84:85],v12 offset:40960
ds_read_b64_tr_b16 a[212:213],v13 offset:40960
ds_read_b64_tr_b16 a[86:87],v12 offset:45056
ds_read_b64_tr_b16 a[214:215],v13 offset:45056
s_waitcnt lgkmcnt(4)
ds_read_b64_tr_b16 a[88:89],v12 offset:49152
ds_read_b64_tr_b16 a[216:217],v13 offset:49152
ds_read_b64_tr_b16 a[90:91],v12 offset:53248
ds_read_b64_tr_b16 a[218:219],v13 offset:53248
ds_read_b64_tr_b16 a[92:93],v12 offset:57344
ds_read_b64_tr_b16 a[220:221],v13 offset:57344
ds_read_b64_tr_b16 a[94:95],v12 offset:61440
ds_read_b64_tr_b16 a[222:223],v13 offset:61440
s_waitcnt lgkmcnt(4)
v_xor_b32 v12,0x10000,v12
v_xor_b32 v13,0x10000,v13
s_waitcnt lgkmcnt(0)
s_barrier
s_waitcnt vmcnt(0)
s_barrier
ds_read_b64_tr_b16 a[96:97],v12 offset:0
ds_read_b64_tr_b16 a[224:225],v13 offset:0
ds_read_b64_tr_b16 a[98:99],v12 offset:4096
ds_read_b64_tr_b16 a[226:227],v13 offset:4096
ds_read_b64_tr_b16 a[100:101],v12 offset:8192
ds_read_b64_tr_b16 a[228:229],v13 offset:8192
ds_read_b64_tr_b16 a[102:103],v12 offset:12288
ds_read_b64_tr_b16 a[230:231],v13 offset:12288
s_waitcnt lgkmcnt(4)
ds_read_b64_tr_b16 a[104:105],v12 offset:16384
ds_read_b64_tr_b16 a[232:233],v13 offset:16384
ds_read_b64_tr_b16 a[106:107],v12 offset:20480
ds_read_b64_tr_b16 a[234:235],v13 offset:20480
ds_read_b64_tr_b16 a[108:109],v12 offset:24576
ds_read_b64_tr_b16 a[236:237],v13 offset:24576
ds_read_b64_tr_b16 a[110:111],v12 offset:28672
ds_read_b64_tr_b16 a[238:239],v13 offset:28672
s_waitcnt lgkmcnt(4)
ds_read_b64_tr_b16 a[112:113],v12 offset:32768
ds_read_b64_tr_b16 a[240:241],v13 offset:32768
ds_read_b64_tr_b16 a[114:115],v12 offset:36864
ds_read_b64_tr_b16 a[242:243],v13 offset:36864
ds_read_b64_tr_b16 a[116:117],v12 offset:40960
ds_read_b64_tr_b16 a[244:245],v13 offset:40960
ds_read_b64_tr_b16 a[118:119],v12 offset:45056
ds_read_b64_tr_b16 a[246:247],v13 offset:45056
s_waitcnt lgkmcnt(4)
ds_read_b64_tr_b16 a[120:121],v12 offset:49152
ds_read_b64_tr_b16 a[248:249],v13 offset:49152
ds_read_b64_tr_b16 a[122:123],v12 offset:53248
ds_read_b64_tr_b16 a[250:251],v13 offset:53248
ds_read_b64_tr_b16 a[124:125],v12 offset:57344
ds_read_b64_tr_b16 a[252:253],v13 offset:57344
ds_read_b64_tr_b16 a[126:127],v12 offset:61440
ds_read_b64_tr_b16 a[254:255],v13 offset:61440
s_waitcnt lgkmcnt(4)
v_xor_b32 v12,0x10000,v12
v_xor_b32 v13,0x10000,v13
s_waitcnt lgkmcnt(0)
s_barrier
v_and_b32 v21,1,v1
v_mul_u32_u24 v21,960,v21
s_mov_b32 s65,21052032
s_mov_b32 s66,1792
pl_237:
buffer_load_dword v22,v21,s[20:23],s65 offen sc1
s_waitcnt vmcnt(0)
v_cmp_gt_u32 vcc,s66,v22
s_cbranch_vccz pok_238
s_sleep 1
s_sub_u32 s90,s90,1
s_cmp_gt_i32 s90,0
s_cbranch_scc1 pl_237
pok_238:
s_mov_b32 s81,0xbdd2d3e8
v_mov_b32 v28,0xc0135761
v_mov_b32 v17,v16
v_and_b32 v21,31,v1
v_lshlrev_b32 v21,2,v21
s_mul_i32 s74,s79,40
s_add_u32 s74,s74,s63
s_add_u32 s74,s74,3072
s_lshl_b32 s42,s41,2
s_add_u32 s42,s42,s50
s_lshl_b32 s73,s41,7
s_lshl_b32 s64,s50,2
s_add_u32 s73,s73,s64
s_add_u32 s73,s73,s63
s_add_u32 s73,s73,6144
s_add_u32 s73,s73,s60
s_lshl_b32 s43,s50,11
s_lshl_b32 s78,s79,21
s_add_u32 s78,s78,27262976
s_mov_b32 s64,0
s_lshr_b32 s65,s50,1
s_and_b32 s66,s50,1
s_lshl_b32 s66,s66,12
s_add_u32 s66,s66,s64
s_lshl_b32 s72,s65,13
s_add_u32 s72,s72,s66
s_add_u32 s72,s72,0x10000
s_lshl_b32 s65,s65,14
s_add_u32 s75,s65,s66
s_add_u32 s75,s75,1966080
s_add_u32 s64,s41,72
s_lshl_b32 s64,s64,14
s_add_u32 s64,s64,s43
v_add_u32 v18,s64,v16
s_lshl_b32 s64,s42,8
s_add_u32 s64,s64,1310720
v_lshl_add_u32 v24,v3,4,s64
v_mov_b32 v5,0x40000000
v_cmp_gt_u32 vcc,16,v1
s_nop 1
v_cndmask_b32 v24,v5,v24,vcc
s_lshl_b32 s64,s42,6
v_and_b32 v5,3,v1
v_xor_b32 v5,v5,v4
v_lshl_add_u32 v5,v5,4,s64
v_lshrrev_b32 v11,2,v1
s_add_u32 s43,s43,133120
v_lshrrev_b32 v6,2,v3
v_lshrrev_b32 v7,1,v4
v_xor_b32 v6,v6,v7
v_lshlrev_b32 v6,4,v6
v_lshl_add_u32 v6,v3,6,v6
v_and_b32 v7,1,v4
v_lshl_add_u32 v6,v7,3,v6
v_add_u32 v40,s43,v6
v_xor_b32 v41,32,v40
v_add_u32 v6,30,v11
v_lshl_add_u32 v9,v6,7,v5
v_and_b32 v9,2047,v9
v_and_b32 v7,3,v6
v_lshl_add_u32 v7,v7,11,v9
v_bfe_u32 v8,v6,2,3
v_lshl_add_u32 v7,v8,14,v7
v_mov_b32 v8,0x2000
v_mov_b32 v9,2097152
v_cmp_gt_u32 vcc,32,v6
s_nop 1
v_cndmask_b32 v8,v9,v8,vcc
v_add_u32 v7,v7,v8
v_add_u32 v7,0,v7
v_xor_b32 v19,s62,v7
v_xor_b32 v19,0x2000,v19
v_add_u32 v6,46,v11
v_lshl_add_u32 v9,v6,7,v5
v_and_b32 v9,2047,v9
v_and_b32 v7,3,v6
v_lshl_add_u32 v7,v7,11,v9
v_bfe_u32 v8,v6,2,3
v_lshl_add_u32 v7,v8,14,v7
v_mov_b32 v8,0x2000
v_mov_b32 v9,2097152
v_cmp_gt_u32 vcc,32,v6
s_nop 1
v_cndmask_b32 v8,v9,v8,vcc
v_add_u32 v7,v7,v8
v_add_u32 v7,0,v7
v_xor_b32 v20,s62,v7
v_xor_b32 v20,0x2000,v20
s_add_u32 s64,s79,0
s_lshl_b32 s70,s64,21
s_lshl_b32 s64,s64,13
s_and_b32 s64,s64,0x2000
s_xor_b32 s64,s64,s62
s_add_u32 s70,s70,s64
s_add_u32 s70,s70,29360128
s_mov_b32 s83,1
s_mov_b32 s87,s74
s_cmp_eq_u32 s50,0
s_cselect_b32 s74,s74,0x7fff0000
v_mov_b32 v47,132096
s_lshl_b32 s64,s50,3
s_add_u32 s64,s64,132096
v_mov_b32 v46,s64
v_mov_b32 v29,0
s_mov_b32 s97,0x7fff0000
s_mov_b32 s69,1
s_mov_b32 s68,0
s_mov_b32 s52,0x30003
s_mov_b32 s53,s52
seg_240:
s_cmp_eq_u32 s83,0
s_cbranch_scc1 ahead_241
s_add_u32 s94,s70,s75
s_cmp_eq_u32 s71,65
s_cselect_b32 s64,2097152,0
s_cselect_b32 s65,0x2000,0
s_sub_u32 s94,s94,s64
s_xor_b32 s94,s94,s65
s_xor_b32 s95,s94,1024
s_xor_b32 s91,s72,0x10000
s_cmp_eq_u32 s69,0
s_mov_b32 s69,1
s_cbranch_scc1 half2_245
s_min_u32 s66,s71,64
s_waitcnt vmcnt(3)
v_cmp_gt_u32 vcc,s66,v29
s_cbranch_vccz nb_244
s_waitcnt vmcnt(0)
v_add_u32 v22,s71,-1
buffer_store_dword v22,v23,s[20:23],s97 offen sc1
s_mov_b32 s97,0x7fff0000
s_cmp_lg_u32 s50,0
s_cbranch_scc1 nb_244
buffer_load_dword v32,v21,s[20:23],s74 offen sc1
s_sleep 2
pl_246:
buffer_load_dword v33,v21,s[20:23],s74 offen sc1
s_waitcnt vmcnt(1)
v_cmp_gt_u32 vcc,s66,v32
v_mov_b32 v29,v32
s_cbranch_vccz pok_247
buffer_load_dword v32,v21,s[20:23],s74 offen sc1
s_waitcnt vmcnt(1)
v_cmp_gt_u32 vcc,s66,v33
v_mov_b32 v29,v33
s_cbranch_vccz pok_247
s_sub_u32 s90,s90,1
s_cmp_gt_i32 s90,0
s_cbranch_scc1 pl_246
pok_247:
nb_244:
s_cmp_eq_u32 s71,64
s_barrier
s_cbranch_scc1 half_248
s_xor_b32 m0,s91,0
s_add_u32 s65,s94,0
buffer_load_dwordx4 v16,s[20:23],s65 offen offset:0 sc1 lds
buffer_load_dwordx4 v16,s[20:23],s65 offen offset:2048 sc1 lds
s_xor_b32 m0,s91,16384
s_add_u32 s65,s94,32768
buffer_load_dwordx4 v16,s[20:23],s65 offen offset:0 sc1 lds
buffer_load_dwordx4 v16,s[20:23],s65 offen offset:2048 sc1 lds
s_xor_b32 m0,s91,32768
s_add_u32 s65,s94,65536
buffer_load_dwordx4 v16,s[20:23],s65 offen offset:0 sc1 lds
buffer_load_dwordx4 v16,s[20:23],s65 offen offset:2048 sc1 lds
s_xor_b32 m0,s91,49152
s_add_u32 s65,s94,98304
buffer_load_dwordx4 v16,s[20:23],s65 offen offset:0 sc1 lds
buffer_load_dwordx4 v16,s[20:23],s65 offen offset:2048 sc1 lds
s_waitcnt vmcnt(8)
v_add_u32 v22,s71,-1
buffer_store_dword v22,v23,s[20:23],s97 offen sc1
s_mov_b32 s97,0x7fff0000
s_waitcnt vmcnt(7)
s_barrier
ds_read_b128 v[224:227],v17 offset:0
ds_read_b128 v[228:231],v17 offset:2048
ds_read_b128 v[232:235],v17 offset:4096
ds_read_b128 v[236:239],v17 offset:6144
ds_read_b128 v[240:243],v17 offset:8192
ds_read_b128 v[244:247],v17 offset:10240
ds_read_b128 v[248:251],v17 offset:12288
s_waitcnt lgkmcnt(5)
v_mfma_f32_16x16x32_bf16 v[64:67],a[0:3],v[224:227],0
s_xor_b32 m0,s91,1024
s_add_u32 s96,s71,1
s_add_u32 s92,s71,2
v_min_u32 v27,v224,v228
v_mfma_f32_16x16x32_bf16 v[72:75],a[128:131],v[224:227],0
ds_read_b128 v[252:255],v17 offset:14336
s_cmp_eq_u32 s96,64
s_cselect_b32 s96,99,s96
v_mfma_f32_16x16x32_bf16 v[64:67],a[4:7],v[228:231],v[64:67]
s_add_u32 s65,s95,0
s_cmp_eq_u32 s92,64
s_cselect_b32 s92,99,s92
v_mfma_f32_16x16x32_bf16 v[72:75],a[132:135],v[228:231],v[72:75]
s_waitcnt vmcnt(5)
s_barrier
ds_read_b128 v[224:227],v17 offset:16384
s_waitcnt lgkmcnt(5)
v_mfma_f32_16x16x32_bf16 v[64:67],a[8:11],v[232:235],v[64:67]
buffer_load_dwordx4 v16,s[20:23],s65 offen offset:0 sc1 lds
v_min3_u32 v27,v27,v232,v236
v_mfma_f32_16x16x32_bf16 v[72:75],a[136:139],v[232:235],v[72:75]
ds_read_b128 v[228:231],v17 offset:18432
s_cmp_eq_u32 s96,65
s_cselect_b32 s96,64,s96
v_mfma_f32_16x16x32_bf16 v[64:67],a[12:15],v[236:239],v[64:67]
buffer_load_dwordx4 v16,s[20:23],s65 offen offset:2048 sc1 lds
v_mfma_f32_16x16x32_bf16 v[72:75],a[140:143],v[236:239],v[72:75]
ds_read_b128 v[232:235],v17 offset:20480
s_waitcnt lgkmcnt(5)
v_mfma_f32_16x16x32_bf16 v[64:67],a[16:19],v[240:243],v[64:67]
s_xor_b32 m0,s91,17408
v_min3_u32 v27,v27,v240,v244
v_mfma_f32_16x16x32_bf16 v[72:75],a[144:147],v[240:243],v[72:75]
ds_read_b128 v[236:239],v17 offset:22528
v_mfma_f32_16x16x32_bf16 v[64:67],a[20:23],v[244:247],v[64:67]
s_add_u32 s65,s95,32768
v_mfma_f32_16x16x32_bf16 v[72:75],a[148:151],v[244:247],v[72:75]
ds_read_b128 v[240:243],v17 offset:24576
s_waitcnt lgkmcnt(5)
v_mfma_f32_16x16x32_bf16 v[64:67],a[24:27],v[248:251],v[64:67]
buffer_load_dwordx4 v16,s[20:23],s65 offen offset:0 sc1 lds
v_mfma_f32_16x16x32_bf16 v[72:75],a[152:155],v[248:251],v[72:75]
ds_read_b128 v[244:247],v17 offset:26624
v_min3_u32 v27,v27,v248,v252
v_mfma_f32_16x16x32_bf16 v[64:67],a[28:31],v[252:255],v[64:67]
buffer_load_dwordx4 v16,s[20:23],s65 offen offset:2048 sc1 lds
v_mfma_f32_16x16x32_bf16 v[72:75],a[156:159],v[252:255],v[72:75]
ds_read_b128 v[248:251],v17 offset:28672
s_waitcnt lgkmcnt(5)
v_mfma_f32_16x16x32_bf16 v[64:67],a[32:35],v[224:227],v[64:67]
s_xor_b32 m0,s91,33792
v_min3_u32 v27,v27,v224,v228
v_mfma_f32_16x16x32_bf16 v[72:75],a[160:163],v[224:227],v[72:75]
ds_read_b128 v[252:255],v17 offset:30720
v_mfma_f32_16x16x32_bf16 v[64:67],a[36:39],v[228:231],v[64:67]
s_add_u32 s65,s95,65536
v_mfma_f32_16x16x32_bf16 v[72:75],a[164:167],v[228:231],v[72:75]
s_waitcnt vmcnt(5)
s_barrier
ds_read_b128 v[224:227],v17 offset:32768
s_waitcnt lgkmcnt(5)
v_mfma_f32_16x16x32_bf16 v[64:67],a[40:43],v[232:235],v[64:67]
buffer_load_dwordx4 v16,s[20:23],s65 offen offset:0 sc1 lds
v_mfma_f32_16x16x32_bf16 v[72:75],a[168:171],v[232:235],v[72:75]
ds_read_b128 v[228:231],v17 offset:34816
v_min3_u32 v27,v27,v232,v236
v_mfma_f32_16x16x32_bf16 v[64:67],a[44:47],v[236:239],v[64:67]
buffer_load_dwordx4 v16,s[20:23],s65 offen offset:2048 sc1 lds
v_mfma_f32_16x16x32_bf16 v[72:75],a[172:175],v[236:239],v[72:75]
ds_read_b128 v[232:235],v17 offset:36864
s_waitcnt lgkmcnt(5)
v_mfma_f32_16x16x32_bf16 v[64:67],a[48:51],v[240:243],v[64:67]
s_xor_b32 m0,s91,50176
v_min3_u32 v27,v27,v240,v244
v_mfma_f32_16x16x32_bf16 v[72:75],a[176:179],v[240:243],v[72:75]
ds_read_b128 v[236:239],v17 offset:38912
v_mfma_f32_16x16x32_bf16 v[64:67],a[52:55],v[244:247],v[64:67]
s_add_u32 s65,s95,98304
v_mfma_f32_16x16x32_bf16 v[72:75],a[180:183],v[244:247],v[72:75]
ds_read_b128 v[240:243],v17 offset:40960
s_waitcnt lgkmcnt(5)
v_mfma_f32_16x16x32_bf16 v[64:67],a[56:59],v[248:251],v[64:67]
buffer_load_dwordx4 v16,s[20:23],s65 offen offset:0 sc1 lds
v_min3_u32 v27,v27,v248,v252
v_mfma_f32_16x16x32_bf16 v[72:75],a[184:187],v[248:251],v[72:75]
ds_read_b128 v[244:247],v17 offset:43008
s_waitcnt vmcnt(63)
v_mfma_f32_16x16x32_bf16 v[64:67],a[60:63],v[252:255],v[64:67]
buffer_load_dwordx4 v16,s[20:23],s65 offen offset:2048 sc1 lds
v_mfma_f32_16x16x32_bf16 v[72:75],a[188:191],v[252:255],v[72:75]
ds_read_b128 v[248:251],v17 offset:45056
s_waitcnt lgkmcnt(5)
v_mfma_f32_16x16x32_bf16 v[64:67],a[64:67],v[224:227],v[64:67]
v_cmp_gt_u32 vcc,s96,v29
v_cmp_gt_u32 s[92:93],s92,v29
v_mfma_f32_16x16x32_bf16 v[72:75],a[192:195],v[224:227],v[72:75]
ds_read_b128 v[252:255],v17 offset:47104
v_min3_u32 v27,v27,v224,v228
v_mfma_f32_16x16x32_bf16 v[64:67],a[68:71],v[228:231],v[64:67]
v_mov_b32 v44,vcc_lo
v_mov_b32 v45,s92
s_add_u32 m0,s43,0
v_mfma_f32_16x16x32_bf16 v[72:75],a[196:199],v[228:231],v[72:75]
ds_read_b128 v[224:227],v17 offset:49152
s_waitcnt lgkmcnt(5)
v_mfma_f32_16x16x32_bf16 v[64:67],a[72:75],v[232:235],v[64:67]
ds_write_b64 v46,v[44:45]
v_min3_u32 v27,v27,v232,v236
v_mfma_f32_16x16x32_bf16 v[72:75],a[200:203],v[232:235],v[72:75]
ds_read_b128 v[228:231],v17 offset:51200
buffer_load_dwordx4 v19,s[20:23],s78 offen sc1 lds
v_mfma_f32_16x16x32_bf16 v[64:67],a[76:79],v[236:239],v[64:67]
s_add_u32 m0,s43,1024
s_nop 0
buffer_load_dwordx4 v20,s[20:23],s78 offen sc1 lds
v_mfma_f32_16x16x32_bf16 v[72:75],a[204:207],v[236:239],v[72:75]
ds_read_b128 v[232:235],v17 offset:53248
s_waitcnt lgkmcnt(6)
v_mfma_f32_16x16x32_bf16 v[64:67],a[80:83],v[240:243],v[64:67]
v_min3_u32 v27,v27,v240,v244
s_add_u32 s88,s70,s75
v_mfma_f32_16x16x32_bf16 v[72:75],a[208:211],v[240:243],v[72:75]
ds_read_b128 v[236:239],v17 offset:55296
s_add_u32 s88,s88,2097152
v_mfma_f32_16x16x32_bf16 v[64:67],a[84:87],v[244:247],v[64:67]
s_xor_b32 s88,s88,0x2000
s_xor_b32 s89,s88,1024
v_mfma_f32_16x16x32_bf16 v[72:75],a[212:215],v[244:247],v[72:75]
ds_read_b128 v[240:243],v17 offset:57344
s_waitcnt lgkmcnt(6)
v_mfma_f32_16x16x32_bf16 v[64:67],a[88:91],v[248:251],v[64:67]
v_min3_u32 v27,v27,v248,v252
v_mfma_f32_16x16x32_bf16 v[72:75],a[216:219],v[248:251],v[72:75]
ds_read_b128 v[244:247],v17 offset:59392
v_mfma_f32_16x16x32_bf16 v[64:67],a[92:95],v[252:255],v[64:67]
v_mfma_f32_16x16x32_bf16 v[72:75],a[220:223],v[252:255],v[72:75]
ds_read_b128 v[248:251],v17 offset:61440
s_waitcnt lgkmcnt(5)
v_mfma_f32_16x16x32_bf16 v[64:67],a[96:99],v[224:227],v[64:67]
v_min3_u32 v27,v27,v224,v228
v_mfma_f32_16x16x32_bf16 v[72:75],a[224:227],v[224:227],v[72:75]
ds_read_b128 v[252:255],v17 offset:63488
v_mfma_f32_16x16x32_bf16 v[64:67],a[100:103],v[228:231],v[64:67]
v_mfma_f32_16x16x32_bf16 v[72:75],a[228:231],v[228:231],v[72:75]
s_waitcnt vmcnt(6)
s_barrier
ds_read_b64 v[44:45],v47
ds_read_b128 v[224:227],v17 offset:1024
s_waitcnt lgkmcnt(6)
v_mfma_f32_16x16x32_bf16 v[64:67],a[104:107],v[232:235],v[64:67]
v_min3_u32 v27,v27,v232,v236
v_mfma_f32_16x16x32_bf16 v[72:75],a[232:235],v[232:235],v[72:75]
ds_read_b128 v[228:231],v17 offset:3072
v_mfma_f32_16x16x32_bf16 v[64:67],a[108:111],v[236:239],v[64:67]
s_waitcnt vmcnt(0)
ds_read_b64 v[120:121],v40 offset:0
v_mfma_f32_16x16x32_bf16 v[72:75],a[236:239],v[236:239],v[72:75]
ds_read_b128 v[232:235],v17 offset:5120
s_waitcnt lgkmcnt(7)
v_mfma_f32_16x16x32_bf16 v[64:67],a[112:115],v[240:243],v[64:67]
v_min3_u32 v27,v27,v240,v244
ds_read_b64 v[122:123],v41 offset:0
v_mfma_f32_16x16x32_bf16 v[72:75],a[240:243],v[240:243],v[72:75]
ds_read_b128 v[236:239],v17 offset:7168
ds_read_b64 v[124:125],v40 offset:1024
v_mfma_f32_16x16x32_bf16 v[64:67],a[116:119],v[244:247],v[64:67]
ds_read_b64 v[126:127],v41 offset:1024
v_mfma_f32_16x16x32_bf16 v[72:75],a[244:247],v[244:247],v[72:75]
ds_read_b128 v[240:243],v17 offset:9216
s_waitcnt lgkmcnt(10)
v_mfma_f32_16x16x32_bf16 v[64:67],a[120:123],v[248:251],v[64:67]
s_waitcnt lgkmcnt(9)
v_readfirstlane_b32 s93,v45
v_mfma_f32_16x16x32_bf16 v[72:75],a[248:251],v[248:251],v[72:75]
ds_read_b128 v[244:247],v17 offset:11264
v_readfirstlane_b32 s83,v44
s_cmp_lg_u32 s83,0
s_cbranch_scc0 keep_250
v_mfma_f32_16x16x32_bf16 v[64:67],a[124:127],v[252:255],v[64:67]
v_min3_u32 v27,v27,v248,v252
v_mfma_f32_16x16x32_bf16 v[72:75],a[252:255],v[252:255],v[72:75]
ds_read_b128 v[248:251],v17 offset:13312
s_waitcnt lgkmcnt(9)
v_mfma_f32_16x16x32_bf16 v[68:71],a[0:3],v[224:227],0
v_cmp_eq_u32 vcc,0,v27
s_cbranch_vccnz retry_239
v_mfma_f32_16x16x32_bf16 v[76:79],a[128:131],v[224:227],0
ds_read_b128 v[252:255],v17 offset:15360
v_min3_u32 v27,v27,v224,v228
v_mfma_f32_16x16x32_bf16 v[68:71],a[4:7],v[228:231],v[68:71]
v_mfma_f32_16x16x32_bf16 v[76:79],a[132:135],v[228:231],v[76:79]
ds_read_b128 v[224:227],v17 offset:17408
s_waitcnt lgkmcnt(7)
v_mfma_f32_16x16x32_bf16 v[68:71],a[8:11],v[232:235],v[68:71]
v_min3_u32 v27,v27,v232,v236
s_waitcnt lgkmcnt(5)
v_lshlrev_b32 v88,16,v120
v_mfma_f32_16x16x32_bf16 v[76:79],a[136:139],v[232:235],v[76:79]
ds_read_b128 v[228:231],v17 offset:19456
v_and_b32 v89,s80,v120
v_lshlrev_b32 v90,16,v121
v_mfma_f32_16x16x32_bf16 v[68:71],a[12:15],v[236:239],v[68:71]
v_and_b32 v91,s80,v121
v_lshlrev_b32 v92,16,v122
v_and_b32 v93,s80,v122
v_mfma_f32_16x16x32_bf16 v[76:79],a[140:143],v[236:239],v[76:79]
ds_read_b128 v[232:235],v17 offset:21504
v_lshlrev_b32 v94,16,v123
s_waitcnt lgkmcnt(5)
v_mfma_f32_16x16x32_bf16 v[68:71],a[16:19],v[240:243],v[68:71]
v_min3_u32 v27,v27,v240,v244
v_and_b32 v95,s80,v123
v_mfma_f32_16x16x32_bf16 v[76:79],a[144:147],v[240:243],v[76:79]
ds_read_b128 v[236:239],v17 offset:23552
v_add_f32 v88,v64,v88
v_mfma_f32_16x16x32_bf16 v[68:71],a[20:23],v[244:247],v[68:71]
v_add_f32 v89,v65,v89
v_add_f32 v90,v66,v90
v_mfma_f32_16x16x32_bf16 v[76:79],a[148:151],v[244:247],v[76:79]
ds_read_b128 v[240:243],v17 offset:25600
s_waitcnt lgkmcnt(5)
v_mfma_f32_16x16x32_bf16 v[68:71],a[24:27],v[248:251],v[68:71]
v_min3_u32 v27,v27,v248,v252
v_add_f32 v91,v67,v91
v_mfma_f32_16x16x32_bf16 v[76:79],a[152:155],v[248:251],v[76:79]
ds_read_b128 v[244:247],v17 offset:27648
v_add_f32 v92,v72,v92
v_mfma_f32_16x16x32_bf16 v[68:71],a[28:31],v[252:255],v[68:71]
v_add_f32 v93,v73,v93
v_add_f32 v94,v74,v94
v_mfma_f32_16x16x32_bf16 v[76:79],a[156:159],v[252:255],v[76:79]
ds_read_b128 v[248:251],v17 offset:29696
s_waitcnt lgkmcnt(5)
v_mfma_f32_16x16x32_bf16 v[68:71],a[32:35],v[224:227],v[68:71]
v_min3_u32 v27,v27,v224,v228
v_add_f32 v95,v75,v95
v_mfma_f32_16x16x32_bf16 v[76:79],a[160:163],v[224:227],v[76:79]
ds_read_b128 v[252:255],v17 offset:31744
v_cvt_pk_bf16_f32 v96,v88,v89
v_mfma_f32_16x16x32_bf16 v[68:71],a[36:39],v[228:231],v[68:71]
v_cvt_pk_bf16_f32 v97,v90,v91
v_cvt_pk_bf16_f32 v98,v92,v93
v_mfma_f32_16x16x32_bf16 v[76:79],a[164:167],v[228:231],v[76:79]
s_waitcnt vmcnt(2)
s_barrier
ds_read_b128 v[224:227],v17 offset:33792
s_waitcnt lgkmcnt(5)
v_mfma_f32_16x16x32_bf16 v[68:71],a[40:43],v[232:235],v[68:71]
v_min3_u32 v27,v27,v232,v236
v_cvt_pk_bf16_f32 v99,v94,v95
v_mfma_f32_16x16x32_bf16 v[76:79],a[168:171],v[232:235],v[76:79]
ds_read_b128 v[228:231],v17 offset:35840
v_max_u32 v96,1,v96
v_mfma_f32_16x16x32_bf16 v[68:71],a[44:47],v[236:239],v[68:71]
buffer_store_dwordx4 v[96:99],v18,s[20:23],s70 offen offset:0 sc1
v_mfma_f32_16x16x32_bf16 v[76:79],a[172:175],v[236:239],v[76:79]
ds_read_b128 v[232:235],v17 offset:37888
s_waitcnt lgkmcnt(5)
v_mfma_f32_16x16x32_bf16 v[68:71],a[48:51],v[240:243],v[68:71]
v_min3_u32 v27,v27,v240,v244
v_lshlrev_b32 v88,16,v96
v_mfma_f32_16x16x32_bf16 v[76:79],a[176:179],v[240:243],v[76:79]
ds_read_b128 v[236:239],v17 offset:39936
v_and_b32 v89,s80,v96
v_mfma_f32_16x16x32_bf16 v[68:71],a[52:55],v[244:247],v[68:71]
v_lshlrev_b32 v90,16,v97
v_and_b32 v91,s80,v97
v_mfma_f32_16x16x32_bf16 v[76:79],a[180:183],v[244:247],v[76:79]
ds_read_b128 v[240:243],v17 offset:41984
s_waitcnt lgkmcnt(5)
v_mfma_f32_16x16x32_bf16 v[68:71],a[56:59],v[248:251],v[68:71]
v_min3_u32 v27,v27,v248,v252
v_lshlrev_b32 v92,16,v98
v_mfma_f32_16x16x32_bf16 v[76:79],a[184:187],v[248:251],v[76:79]
ds_read_b128 v[244:247],v17 offset:44032
v_and_b32 v93,s80,v98
v_mfma_f32_16x16x32_bf16 v[68:71],a[60:63],v[252:255],v[68:71]
v_lshlrev_b32 v94,16,v99
v_and_b32 v95,s80,v99
v_mfma_f32_16x16x32_bf16 v[76:79],a[188:191],v[252:255],v[76:79]
ds_read_b128 v[248:251],v17 offset:46080
s_waitcnt lgkmcnt(5)
v_mfma_f32_16x16x32_bf16 v[68:71],a[64:67],v[224:227],v[68:71]
v_min3_u32 v27,v27,v224,v228
v_add_f32 v108,v88,v89
v_mfma_f32_16x16x32_bf16 v[76:79],a[192:195],v[224:227],v[76:79]
ds_read_b128 v[252:255],v17 offset:48128
v_mul_f32 v109,v88,v88
v_mfma_f32_16x16x32_bf16 v[68:71],a[68:71],v[228:231],v[68:71]
v_add_f32 v100,v90,v91
v_mul_f32 v101,v89,v89
v_mfma_f32_16x16x32_bf16 v[76:79],a[196:199],v[228:231],v[76:79]
ds_read_b128 v[224:227],v17 offset:50176
s_waitcnt lgkmcnt(5)
v_mfma_f32_16x16x32_bf16 v[68:71],a[72:75],v[232:235],v[68:71]
v_min3_u32 v27,v27,v232,v236
v_fmac_f32 v109,v90,v90
v_mfma_f32_16x16x32_bf16 v[76:79],a[200:203],v[232:235],v[76:79]
ds_read_b128 v[228:231],v17 offset:52224
v_fmac_f32 v101,v91,v91
v_mfma_f32_16x16x32_bf16 v[68:71],a[76:79],v[236:239],v[68:71]
v_fmac_f32 v109,v92,v92
v_fmac_f32 v101,v93,v93
v_mfma_f32_16x16x32_bf16 v[76:79],a[204:207],v[236:239],v[76:79]
ds_read_b128 v[232:235],v17 offset:54272
s_waitcnt lgkmcnt(5)
v_mfma_f32_16x16x32_bf16 v[68:71],a[80:83],v[240:243],v[68:71]
v_min3_u32 v27,v27,v240,v244
v_add_f32 v108,v108,v92
v_mfma_f32_16x16x32_bf16 v[76:79],a[208:211],v[240:243],v[76:79]
ds_read_b128 v[236:239],v17 offset:56320
v_add_f32 v100,v100,v93
v_mfma_f32_16x16x32_bf16 v[68:71],a[84:87],v[244:247],v[68:71]
v_fmac_f32 v109,v94,v94
v_fmac_f32 v101,v95,v95
v_mfma_f32_16x16x32_bf16 v[76:79],a[212:215],v[244:247],v[76:79]
ds_read_b128 v[240:243],v17 offset:58368
s_waitcnt lgkmcnt(5)
v_mfma_f32_16x16x32_bf16 v[68:71],a[88:91],v[248:251],v[68:71]
v_min3_u32 v27,v27,v248,v252
v_add_f32 v108,v108,v94
v_mfma_f32_16x16x32_bf16 v[76:79],a[216:219],v[248:251],v[76:79]
ds_read_b128 v[244:247],v17 offset:60416
v_add_f32 v100,v100,v95
v_mfma_f32_16x16x32_bf16 v[68:71],a[92:95],v[252:255],v[68:71]
v_add_f32 v108,v108,v100
v_add_f32 v109,v109,v101
v_mfma_f32_16x16x32_bf16 v[76:79],a[220:223],v[252:255],v[76:79]
ds_read_b128 v[248:251],v17 offset:62464
s_waitcnt lgkmcnt(5)
v_mfma_f32_16x16x32_bf16 v[68:71],a[96:99],v[224:227],v[68:71]
v_min3_u32 v27,v27,v224,v228
v_mov_b32 v100,v108
v_mfma_f32_16x16x32_bf16 v[76:79],a[224:227],v[224:227],v[76:79]
ds_read_b128 v[252:255],v17 offset:64512
v_mov_b32 v101,v109
v_mfma_f32_16x16x32_bf16 v[68:71],a[100:103],v[228:231],v[68:71]
v_permlane16_swap_b32 v100,v108
v_permlane16_swap_b32 v101,v109
v_mfma_f32_16x16x32_bf16 v[76:79],a[228:231],v[228:231],v[76:79]
v_add_f32 v108,v108,v100
s_waitcnt lgkmcnt(4)
v_mfma_f32_16x16x32_bf16 v[68:71],a[104:107],v[232:235],v[68:71]
v_min3_u32 v27,v27,v232,v236
v_add_f32 v109,v109,v101
v_mfma_f32_16x16x32_bf16 v[76:79],a[232:235],v[232:235],v[76:79]
v_mov_b32 v100,v108
v_mov_b32 v101,v109
v_mfma_f32_16x16x32_bf16 v[68:71],a[108:111],v[236:239],v[68:71]
v_permlane32_swap_b32 v100,v108
v_permlane32_swap_b32 v101,v109
v_mfma_f32_16x16x32_bf16 v[76:79],a[236:239],v[236:239],v[76:79]
v_add_f32 v108,v108,v100
s_waitcnt lgkmcnt(2)
v_mfma_f32_16x16x32_bf16 v[68:71],a[112:115],v[240:243],v[68:71]
v_min3_u32 v27,v27,v240,v244
v_add_f32 v109,v109,v101
v_mfma_f32_16x16x32_bf16 v[76:79],a[240:243],v[240:243],v[76:79]
v_min3_u32 v27,v27,v120,v122
v_min3_u32 v27,v27,v124,v126
v_mfma_f32_16x16x32_bf16 v[68:71],a[116:119],v[244:247],v[68:71]
v_lshlrev_b32 v32,16,v124
v_and_b32 v33,s80,v124
v_mfma_f32_16x16x32_bf16 v[76:79],a[244:247],v[244:247],v[76:79]
v_lshlrev_b32 v34,16,v125
s_waitcnt lgkmcnt(0)
v_mfma_f32_16x16x32_bf16 v[68:71],a[120:123],v[248:251],v[68:71]
v_min3_u32 v27,v27,v248,v252
v_and_b32 v35,s80,v125
v_mfma_f32_16x16x32_bf16 v[76:79],a[248:251],v[248:251],v[76:79]
v_lshlrev_b32 v36,16,v126
v_and_b32 v37,s80,v126
v_mfma_f32_16x16x32_bf16 v[68:71],a[124:127],v[252:255],v[68:71]
v_lshlrev_b32 v38,16,v127
v_and_b32 v39,s80,v127
v_mfma_f32_16x16x32_bf16 v[76:79],a[252:255],v[252:255],v[76:79]
v_cmp_eq_u32 vcc,0,v27
s_cbranch_vccnz retry_239
s_branch epi_242
keep_250:
v_mfma_f32_16x16x32_bf16 v[64:67],a[124:127],v[252:255],v[64:67]
v_min3_u32 v27,v27,v248,v252
s_xor_b32 m0,s72,0
v_mfma_f32_16x16x32_bf16 v[72:75],a[252:255],v[252:255],v[72:75]
ds_read_b128 v[248:251],v17 offset:13312
s_add_u32 s65,s88,0
s_waitcnt lgkmcnt(9)
v_mfma_f32_16x16x32_bf16 v[68:71],a[0:3],v[224:227],0
buffer_load_dwordx4 v16,s[20:23],s65 offen offset:0 sc1 lds
v_min3_u32 v27,v27,v224,v228
v_mfma_f32_16x16x32_bf16 v[76:79],a[128:131],v[224:227],0
ds_read_b128 v[252:255],v17 offset:15360
buffer_load_dwordx4 v16,s[20:23],s65 offen offset:2048 sc1 lds
v_mfma_f32_16x16x32_bf16 v[68:71],a[4:7],v[228:231],v[68:71]
v_cmp_eq_u32 vcc,0,v27
s_cbranch_vccnz retry_239
v_mfma_f32_16x16x32_bf16 v[76:79],a[132:135],v[228:231],v[76:79]
ds_read_b128 v[224:227],v17 offset:17408
s_xor_b32 m0,s72,16384
s_waitcnt lgkmcnt(7)
v_mfma_f32_16x16x32_bf16 v[68:71],a[8:11],v[232:235],v[68:71]
s_add_u32 s65,s88,32768
v_min3_u32 v27,v27,v232,v236
s_waitcnt lgkmcnt(5)
v_mfma_f32_16x16x32_bf16 v[76:79],a[136:139],v[232:235],v[76:79]
ds_read_b128 v[228:231],v17 offset:19456
buffer_load_dwordx4 v16,s[20:23],s65 offen offset:0 sc1 lds
v_mfma_f32_16x16x32_bf16 v[68:71],a[12:15],v[236:239],v[68:71]
v_lshlrev_b32 v88,16,v120
v_and_b32 v89,s80,v120
v_lshlrev_b32 v90,16,v121
v_mfma_f32_16x16x32_bf16 v[76:79],a[140:143],v[236:239],v[76:79]
ds_read_b128 v[232:235],v17 offset:21504
v_and_b32 v91,s80,v121
s_waitcnt lgkmcnt(5)
v_mfma_f32_16x16x32_bf16 v[68:71],a[16:19],v[240:243],v[68:71]
buffer_load_dwordx4 v16,s[20:23],s65 offen offset:2048 sc1 lds
s_xor_b32 m0,s72,32768
v_mfma_f32_16x16x32_bf16 v[76:79],a[144:147],v[240:243],v[76:79]
ds_read_b128 v[236:239],v17 offset:23552
s_add_u32 s65,s88,65536
v_lshlrev_b32 v92,16,v122
v_mfma_f32_16x16x32_bf16 v[68:71],a[20:23],v[244:247],v[68:71]
v_min3_u32 v27,v27,v240,v244
v_and_b32 v93,s80,v122
v_lshlrev_b32 v94,16,v123
v_mfma_f32_16x16x32_bf16 v[76:79],a[148:151],v[244:247],v[76:79]
ds_read_b128 v[240:243],v17 offset:25600
v_and_b32 v95,s80,v123
s_waitcnt lgkmcnt(5)
v_mfma_f32_16x16x32_bf16 v[68:71],a[24:27],v[248:251],v[68:71]
buffer_load_dwordx4 v16,s[20:23],s65 offen offset:0 sc1 lds
v_add_f32 v88,v64,v88
v_mfma_f32_16x16x32_bf16 v[76:79],a[152:155],v[248:251],v[76:79]
ds_read_b128 v[244:247],v17 offset:27648
buffer_load_dwordx4 v16,s[20:23],s65 offen offset:2048 sc1 lds
v_mfma_f32_16x16x32_bf16 v[68:71],a[28:31],v[252:255],v[68:71]
s_xor_b32 m0,s72,49152
v_min3_u32 v27,v27,v248,v252
v_add_f32 v89,v65,v89
v_mfma_f32_16x16x32_bf16 v[76:79],a[156:159],v[252:255],v[76:79]
ds_read_b128 v[248:251],v17 offset:29696
s_add_u32 s65,s88,98304
s_waitcnt lgkmcnt(5)
v_mfma_f32_16x16x32_bf16 v[68:71],a[32:35],v[224:227],v[68:71]
buffer_load_dwordx4 v16,s[20:23],s65 offen offset:0 sc1 lds
v_add_f32 v90,v66,v90
v_mfma_f32_16x16x32_bf16 v[76:79],a[160:163],v[224:227],v[76:79]
ds_read_b128 v[252:255],v17 offset:31744
v_min3_u32 v27,v27,v224,v228
v_add_f32 v91,v67,v91
v_mfma_f32_16x16x32_bf16 v[68:71],a[36:39],v[228:231],v[68:71]
buffer_load_dwordx4 v16,s[20:23],s65 offen offset:2048 sc1 lds
v_add_f32 v92,v72,v92
v_mfma_f32_16x16x32_bf16 v[76:79],a[164:167],v[228:231],v[76:79]
s_waitcnt vmcnt(10)
s_barrier
ds_read_b128 v[224:227],v17 offset:33792
s_waitcnt lgkmcnt(5)
v_mfma_f32_16x16x32_bf16 v[68:71],a[40:43],v[232:235],v[68:71]
s_xor_b32 m0,s72,1024
s_add_u32 s65,s89,0
v_add_f32 v93,v73,v93
v_mfma_f32_16x16x32_bf16 v[76:79],a[168:171],v[232:235],v[76:79]
ds_read_b128 v[228:231],v17 offset:35840
v_min3_u32 v27,v27,v232,v236
v_add_f32 v94,v74,v94
v_mfma_f32_16x16x32_bf16 v[68:71],a[44:47],v[236:239],v[68:71]
buffer_load_dwordx4 v16,s[20:23],s65 offen offset:0 sc1 lds
v_add_f32 v95,v75,v95
v_mfma_f32_16x16x32_bf16 v[76:79],a[172:175],v[236:239],v[76:79]
ds_read_b128 v[232:235],v17 offset:37888
v_cvt_pk_bf16_f32 v96,v88,v89
s_waitcnt lgkmcnt(5)
v_mfma_f32_16x16x32_bf16 v[68:71],a[48:51],v[240:243],v[68:71]
buffer_load_dwordx4 v16,s[20:23],s65 offen offset:2048 sc1 lds
v_cvt_pk_bf16_f32 v97,v90,v91
v_mfma_f32_16x16x32_bf16 v[76:79],a[176:179],v[240:243],v[76:79]
ds_read_b128 v[236:239],v17 offset:39936
s_xor_b32 m0,s72,17408
v_cvt_pk_bf16_f32 v98,v92,v93
v_mfma_f32_16x16x32_bf16 v[68:71],a[52:55],v[244:247],v[68:71]
s_add_u32 s65,s89,32768
v_min3_u32 v27,v27,v240,v244
v_cvt_pk_bf16_f32 v99,v94,v95
v_mfma_f32_16x16x32_bf16 v[76:79],a[180:183],v[244:247],v[76:79]
ds_read_b128 v[240:243],v17 offset:41984
v_max_u32 v96,1,v96
s_waitcnt lgkmcnt(5)
v_mfma_f32_16x16x32_bf16 v[68:71],a[56:59],v[248:251],v[68:71]
buffer_load_dwordx4 v16,s[20:23],s65 offen offset:0 sc1 lds
v_mfma_f32_16x16x32_bf16 v[76:79],a[184:187],v[248:251],v[76:79]
ds_read_b128 v[244:247],v17 offset:44032
v_min3_u32 v27,v27,v248,v252
v_mfma_f32_16x16x32_bf16 v[68:71],a[60:63],v[252:255],v[68:71]
buffer_load_dwordx4 v16,s[20:23],s65 offen offset:2048 sc1 lds
v_mfma_f32_16x16x32_bf16 v[76:79],a[188:191],v[252:255],v[76:79]
ds_read_b128 v[248:251],v17 offset:46080
s_waitcnt lgkmcnt(5)
v_mfma_f32_16x16x32_bf16 v[68:71],a[64:67],v[224:227],v[68:71]
s_xor_b32 m0,s72,33792
s_add_u32 s65,s89,65536
v_mfma_f32_16x16x32_bf16 v[76:79],a[192:195],v[224:227],v[76:79]
ds_read_b128 v[252:255],v17 offset:48128
v_min3_u32 v27,v27,v224,v228
v_mfma_f32_16x16x32_bf16 v[68:71],a[68:71],v[228:231],v[68:71]
buffer_load_dwordx4 v16,s[20:23],s65 offen offset:0 sc1 lds
v_mfma_f32_16x16x32_bf16 v[76:79],a[196:199],v[228:231],v[76:79]
ds_read_b128 v[224:227],v17 offset:50176
s_waitcnt lgkmcnt(5)
v_mfma_f32_16x16x32_bf16 v[68:71],a[72:75],v[232:235],v[68:71]
buffer_load_dwordx4 v16,s[20:23],s65 offen offset:2048 sc1 lds
v_mfma_f32_16x16x32_bf16 v[76:79],a[200:203],v[232:235],v[76:79]
ds_read_b128 v[228:231],v17 offset:52224
s_xor_b32 m0,s72,50176
v_mfma_f32_16x16x32_bf16 v[68:71],a[76:79],v[236:239],v[68:71]
s_add_u32 s65,s89,98304
v_min3_u32 v27,v27,v232,v236
v_mfma_f32_16x16x32_bf16 v[76:79],a[204:207],v[236:239],v[76:79]
ds_read_b128 v[232:235],v17 offset:54272
s_waitcnt lgkmcnt(5)
v_mfma_f32_16x16x32_bf16 v[68:71],a[80:83],v[240:243],v[68:71]
buffer_load_dwordx4 v16,s[20:23],s65 offen offset:0 sc1 lds
v_mfma_f32_16x16x32_bf16 v[76:79],a[208:211],v[240:243],v[76:79]
ds_read_b128 v[236:239],v17 offset:56320
v_min3_u32 v27,v27,v240,v244
v_mfma_f32_16x16x32_bf16 v[68:71],a[84:87],v[244:247],v[68:71]
buffer_load_dwordx4 v16,s[20:23],s65 offen offset:2048 sc1 lds
v_mfma_f32_16x16x32_bf16 v[76:79],a[212:215],v[244:247],v[76:79]
ds_read_b128 v[240:243],v17 offset:58368
s_waitcnt lgkmcnt(5)
v_mfma_f32_16x16x32_bf16 v[68:71],a[88:91],v[248:251],v[68:71]
v_min3_u32 v27,v27,v248,v252
buffer_store_dwordx4 v[96:99],v18,s[20:23],s70 offen offset:0 sc1
v_mfma_f32_16x16x32_bf16 v[76:79],a[216:219],v[248:251],v[76:79]
ds_read_b128 v[244:247],v17 offset:60416
v_lshlrev_b32 v88,16,v96
v_and_b32 v89,s80,v96
v_mfma_f32_16x16x32_bf16 v[68:71],a[92:95],v[252:255],v[68:71]
v_lshlrev_b32 v90,16,v97
v_and_b32 v91,s80,v97
v_lshlrev_b32 v92,16,v98
v_mfma_f32_16x16x32_bf16 v[76:79],a[220:223],v[252:255],v[76:79]
ds_read_b128 v[248:251],v17 offset:62464
v_and_b32 v93,s80,v98
s_waitcnt lgkmcnt(5)
v_mfma_f32_16x16x32_bf16 v[68:71],a[96:99],v[224:227],v[68:71]
v_min3_u32 v27,v27,v224,v228
v_lshlrev_b32 v94,16,v99
v_and_b32 v95,s80,v99
v_mfma_f32_16x16x32_bf16 v[76:79],a[224:227],v[224:227],v[76:79]
ds_read_b128 v[252:255],v17 offset:64512
v_add_f32 v108,v88,v89
v_mul_f32 v109,v88,v88
v_mfma_f32_16x16x32_bf16 v[68:71],a[100:103],v[228:231],v[68:71]
v_add_f32 v100,v90,v91
v_mul_f32 v101,v89,v89
v_fmac_f32 v109,v90,v90
v_mfma_f32_16x16x32_bf16 v[76:79],a[228:231],v[228:231],v[76:79]
v_fmac_f32 v101,v91,v91
v_fmac_f32 v109,v92,v92
s_waitcnt lgkmcnt(4)
v_mfma_f32_16x16x32_bf16 v[68:71],a[104:107],v[232:235],v[68:71]
v_min3_u32 v27,v27,v232,v236
v_fmac_f32 v101,v93,v93
v_add_f32 v108,v108,v92
v_mfma_f32_16x16x32_bf16 v[76:79],a[232:235],v[232:235],v[76:79]
v_add_f32 v100,v100,v93
v_fmac_f32 v109,v94,v94
v_fmac_f32 v101,v95,v95
v_mfma_f32_16x16x32_bf16 v[68:71],a[108:111],v[236:239],v[68:71]
v_add_f32 v108,v108,v94
v_add_f32 v100,v100,v95
v_add_f32 v108,v108,v100
v_mfma_f32_16x16x32_bf16 v[76:79],a[236:239],v[236:239],v[76:79]
v_add_f32 v109,v109,v101
v_mov_b32 v100,v108
s_waitcnt lgkmcnt(2)
v_mfma_f32_16x16x32_bf16 v[68:71],a[112:115],v[240:243],v[68:71]
v_min3_u32 v27,v27,v240,v244
v_mov_b32 v101,v109
v_permlane16_swap_b32 v100,v108
v_mfma_f32_16x16x32_bf16 v[76:79],a[240:243],v[240:243],v[76:79]
v_permlane16_swap_b32 v101,v109
v_add_f32 v108,v108,v100
v_add_f32 v109,v109,v101
v_mfma_f32_16x16x32_bf16 v[68:71],a[116:119],v[244:247],v[68:71]
v_mov_b32 v100,v108
v_mov_b32 v101,v109
s_nop 0
v_permlane32_swap_b32 v100,v108
v_mfma_f32_16x16x32_bf16 v[76:79],a[244:247],v[244:247],v[76:79]
v_permlane32_swap_b32 v101,v109
v_add_f32 v108,v108,v100
s_waitcnt lgkmcnt(0)
v_mfma_f32_16x16x32_bf16 v[68:71],a[120:123],v[248:251],v[68:71]
v_min3_u32 v27,v27,v248,v252
v_add_f32 v109,v109,v101
v_min3_u32 v27,v27,v120,v122
v_mfma_f32_16x16x32_bf16 v[76:79],a[248:251],v[248:251],v[76:79]
v_min3_u32 v27,v27,v124,v126
v_lshlrev_b32 v32,16,v124
v_and_b32 v33,s80,v124
v_mfma_f32_16x16x32_bf16 v[68:71],a[124:127],v[252:255],v[68:71]
v_lshlrev_b32 v34,16,v125
v_and_b32 v35,s80,v125
v_lshlrev_b32 v36,16,v126
v_mfma_f32_16x16x32_bf16 v[76:79],a[252:255],v[252:255],v[76:79]
v_and_b32 v37,s80,v126
v_lshlrev_b32 v38,16,v127
v_and_b32 v39,s80,v127
v_cmp_eq_u32 vcc,0,v27
s_cbranch_vccnz retry_239
s_branch epi_242
ahead_241:
s_cmp_eq_u32 s93,0
s_cbranch_scc1 both_243
s_waitcnt vmcnt(13) lgkmcnt(0)
s_barrier
ds_read_b128 v[224:227],v17 offset:0
ds_read_b128 v[228:231],v17 offset:2048
ds_read_b128 v[232:235],v17 offset:4096
ds_read_b128 v[236:239],v17 offset:6144
ds_read_b128 v[240:243],v17 offset:8192
ds_read_b128 v[244:247],v17 offset:10240
ds_read_b128 v[248:251],v17 offset:12288
s_waitcnt lgkmcnt(5)
v_mfma_f32_16x16x32_bf16 v[64:67],a[0:3],v[224:227],0
s_add_u32 s96,s71,1
s_add_u32 s92,s71,2
v_min_u32 v27,v224,v228
s_add_u32 m0,s43,0
v_mfma_f32_16x16x32_bf16 v[72:75],a[128:131],v[224:227],0
ds_read_b128 v[252:255],v17 offset:14336
s_cmp_eq_u32 s96,64
s_cselect_b32 s96,99,s96
v_mfma_f32_16x16x32_bf16 v[64:67],a[4:7],v[228:231],v[64:67]
s_cmp_eq_u32 s92,64
s_cselect_b32 s92,99,s92
buffer_load_dwordx4 v19,s[20:23],s78 offen sc1 lds
v_mfma_f32_16x16x32_bf16 v[72:75],a[132:135],v[228:231],v[72:75]
ds_read_b128 v[224:227],v17 offset:16384
s_add_u32 m0,s43,1024
s_waitcnt lgkmcnt(5)
v_mfma_f32_16x16x32_bf16 v[64:67],a[8:11],v[232:235],v[64:67]
s_cmp_eq_u32 s96,65
s_cselect_b32 s96,64,s96
buffer_load_dwordx4 v20,s[20:23],s78 offen sc1 lds
v_mfma_f32_16x16x32_bf16 v[72:75],a[136:139],v[232:235],v[72:75]
ds_read_b128 v[228:231],v17 offset:18432
v_min3_u32 v27,v27,v232,v236
v_mfma_f32_16x16x32_bf16 v[64:67],a[12:15],v[236:239],v[64:67]
v_mfma_f32_16x16x32_bf16 v[72:75],a[140:143],v[236:239],v[72:75]
ds_read_b128 v[232:235],v17 offset:20480
s_waitcnt lgkmcnt(5)
v_mfma_f32_16x16x32_bf16 v[64:67],a[16:19],v[240:243],v[64:67]
v_min3_u32 v27,v27,v240,v244
v_mfma_f32_16x16x32_bf16 v[72:75],a[144:147],v[240:243],v[72:75]
ds_read_b128 v[236:239],v17 offset:22528
v_mfma_f32_16x16x32_bf16 v[64:67],a[20:23],v[244:247],v[64:67]
v_mfma_f32_16x16x32_bf16 v[72:75],a[148:151],v[244:247],v[72:75]
ds_read_b128 v[240:243],v17 offset:24576
s_waitcnt lgkmcnt(5)
v_mfma_f32_16x16x32_bf16 v[64:67],a[24:27],v[248:251],v[64:67]
v_min3_u32 v27,v27,v248,v252
v_mfma_f32_16x16x32_bf16 v[72:75],a[152:155],v[248:251],v[72:75]
ds_read_b128 v[244:247],v17 offset:26624
v_mfma_f32_16x16x32_bf16 v[64:67],a[28:31],v[252:255],v[64:67]
v_mfma_f32_16x16x32_bf16 v[72:75],a[156:159],v[252:255],v[72:75]
ds_read_b128 v[248:251],v17 offset:28672
s_waitcnt lgkmcnt(5)
v_mfma_f32_16x16x32_bf16 v[64:67],a[32:35],v[224:227],v[64:67]
v_min3_u32 v27,v27,v224,v228
v_mfma_f32_16x16x32_bf16 v[72:75],a[160:163],v[224:227],v[72:75]
ds_read_b128 v[252:255],v17 offset:30720
v_mfma_f32_16x16x32_bf16 v[64:67],a[36:39],v[228:231],v[64:67]
v_mfma_f32_16x16x32_bf16 v[72:75],a[164:167],v[228:231],v[72:75]
ds_read_b128 v[224:227],v17 offset:32768
s_waitcnt lgkmcnt(5)
v_mfma_f32_16x16x32_bf16 v[64:67],a[40:43],v[232:235],v[64:67]
v_min3_u32 v27,v27,v232,v236
v_mfma_f32_16x16x32_bf16 v[72:75],a[168:171],v[232:235],v[72:75]
ds_read_b128 v[228:231],v17 offset:34816
v_mfma_f32_16x16x32_bf16 v[64:67],a[44:47],v[236:239],v[64:67]
v_mfma_f32_16x16x32_bf16 v[72:75],a[172:175],v[236:239],v[72:75]
ds_read_b128 v[232:235],v17 offset:36864
s_waitcnt lgkmcnt(5)
v_mfma_f32_16x16x32_bf16 v[64:67],a[48:51],v[240:243],v[64:67]
v_min3_u32 v27,v27,v240,v244
v_mfma_f32_16x16x32_bf16 v[72:75],a[176:179],v[240:243],v[72:75]
ds_read_b128 v[236:239],v17 offset:38912
v_mfma_f32_16x16x32_bf16 v[64:67],a[52:55],v[244:247],v[64:67]
v_mfma_f32_16x16x32_bf16 v[72:75],a[180:183],v[244:247],v[72:75]
ds_read_b128 v[240:243],v17 offset:40960
s_waitcnt lgkmcnt(5)
v_mfma_f32_16x16x32_bf16 v[64:67],a[56:59],v[248:251],v[64:67]
v_min3_u32 v27,v27,v248,v252
v_mfma_f32_16x16x32_bf16 v[72:75],a[184:187],v[248:251],v[72:75]
ds_read_b128 v[244:247],v17 offset:43008
s_waitcnt vmcnt(5)
v_mfma_f32_16x16x32_bf16 v[64:67],a[60:63],v[252:255],v[64:67]
v_cmp_gt_u32 vcc,s96,v29
v_cmp_gt_u32 s[92:93],s92,v29
v_mfma_f32_16x16x32_bf16 v[72:75],a[188:191],v[252:255],v[72:75]
ds_read_b128 v[248:251],v17 offset:45056
s_waitcnt lgkmcnt(5)
v_mfma_f32_16x16x32_bf16 v[64:67],a[64:67],v[224:227],v[64:67]
v_mov_b32 v44,vcc_lo
v_mov_b32 v45,s92
v_mfma_f32_16x16x32_bf16 v[72:75],a[192:195],v[224:227],v[72:75]
ds_read_b128 v[252:255],v17 offset:47104
ds_write_b64 v46,v[44:45]
v_mfma_f32_16x16x32_bf16 v[64:67],a[68:71],v[228:231],v[64:67]
v_min3_u32 v27,v27,v224,v228
v_mfma_f32_16x16x32_bf16 v[72:75],a[196:199],v[228:231],v[72:75]
ds_read_b128 v[224:227],v17 offset:49152
s_waitcnt lgkmcnt(6)
v_mfma_f32_16x16x32_bf16 v[64:67],a[72:75],v[232:235],v[64:67]
v_min3_u32 v27,v27,v232,v236
v_mfma_f32_16x16x32_bf16 v[72:75],a[200:203],v[232:235],v[72:75]
ds_read_b128 v[228:231],v17 offset:51200
v_mfma_f32_16x16x32_bf16 v[64:67],a[76:79],v[236:239],v[64:67]
v_mfma_f32_16x16x32_bf16 v[72:75],a[204:207],v[236:239],v[72:75]
ds_read_b128 v[232:235],v17 offset:53248
s_waitcnt lgkmcnt(6)
v_mfma_f32_16x16x32_bf16 v[64:67],a[80:83],v[240:243],v[64:67]
v_min3_u32 v27,v27,v240,v244
s_add_u32 s88,s70,s75
v_mfma_f32_16x16x32_bf16 v[72:75],a[208:211],v[240:243],v[72:75]
ds_read_b128 v[236:239],v17 offset:55296
s_add_u32 s88,s88,2097152
v_mfma_f32_16x16x32_bf16 v[64:67],a[84:87],v[244:247],v[64:67]
s_xor_b32 s88,s88,0x2000
s_xor_b32 s89,s88,1024
v_mfma_f32_16x16x32_bf16 v[72:75],a[212:215],v[244:247],v[72:75]
ds_read_b128 v[240:243],v17 offset:57344
s_waitcnt lgkmcnt(6)
v_mfma_f32_16x16x32_bf16 v[64:67],a[88:91],v[248:251],v[64:67]
v_min3_u32 v27,v27,v248,v252
v_mfma_f32_16x16x32_bf16 v[72:75],a[216:219],v[248:251],v[72:75]
ds_read_b128 v[244:247],v17 offset:59392
v_mfma_f32_16x16x32_bf16 v[64:67],a[92:95],v[252:255],v[64:67]
v_mfma_f32_16x16x32_bf16 v[72:75],a[220:223],v[252:255],v[72:75]
ds_read_b128 v[248:251],v17 offset:61440
s_waitcnt lgkmcnt(5)
v_mfma_f32_16x16x32_bf16 v[64:67],a[96:99],v[224:227],v[64:67]
v_min3_u32 v27,v27,v224,v228
v_mfma_f32_16x16x32_bf16 v[72:75],a[224:227],v[224:227],v[72:75]
ds_read_b128 v[252:255],v17 offset:63488
v_mfma_f32_16x16x32_bf16 v[64:67],a[100:103],v[228:231],v[64:67]
s_waitcnt vmcnt(2)
v_add_u32 v22,s71,-1
v_mfma_f32_16x16x32_bf16 v[72:75],a[228:231],v[228:231],v[72:75]
s_waitcnt vmcnt(7)
s_barrier
ds_read_b64 v[44:45],v47
ds_read_b128 v[224:227],v17 offset:1024
s_waitcnt lgkmcnt(6)
v_mfma_f32_16x16x32_bf16 v[64:67],a[104:107],v[232:235],v[64:67]
v_min3_u32 v27,v27,v232,v236
v_mfma_f32_16x16x32_bf16 v[72:75],a[232:235],v[232:235],v[72:75]
ds_read_b128 v[228:231],v17 offset:3072
v_mfma_f32_16x16x32_bf16 v[64:67],a[108:111],v[236:239],v[64:67]
buffer_store_dword v22,v23,s[20:23],s97 offen sc1
s_waitcnt vmcnt(1)
v_mfma_f32_16x16x32_bf16 v[72:75],a[236:239],v[236:239],v[72:75]
ds_read_b128 v[232:235],v17 offset:5120
s_waitcnt lgkmcnt(6)
v_mfma_f32_16x16x32_bf16 v[64:67],a[112:115],v[240:243],v[64:67]
v_min3_u32 v27,v27,v240,v244
s_mov_b32 s97,0x7fff0000
v_mfma_f32_16x16x32_bf16 v[72:75],a[240:243],v[240:243],v[72:75]
ds_read_b128 v[236:239],v17 offset:7168
ds_read_b64 v[120:121],v40 offset:0
v_mfma_f32_16x16x32_bf16 v[64:67],a[116:119],v[244:247],v[64:67]
ds_read_b64 v[122:123],v41 offset:0
ds_read_b64 v[124:125],v40 offset:1024
v_mfma_f32_16x16x32_bf16 v[72:75],a[244:247],v[244:247],v[72:75]
ds_read_b128 v[240:243],v17 offset:9216
s_waitcnt lgkmcnt(9)
v_mfma_f32_16x16x32_bf16 v[64:67],a[120:123],v[248:251],v[64:67]
s_waitcnt lgkmcnt(8)
v_readfirstlane_b32 s93,v45
v_mfma_f32_16x16x32_bf16 v[72:75],a[248:251],v[248:251],v[72:75]
ds_read_b128 v[244:247],v17 offset:11264
v_readfirstlane_b32 s83,v44
s_cmp_lg_u32 s83,0
s_cbranch_scc1 keep_251
v_mfma_f32_16x16x32_bf16 v[64:67],a[124:127],v[252:255],v[64:67]
v_min3_u32 v27,v27,v248,v252
ds_read_b64 v[126:127],v41 offset:1024
s_xor_b32 m0,s72,0
v_mfma_f32_16x16x32_bf16 v[72:75],a[252:255],v[252:255],v[72:75]
ds_read_b128 v[248:251],v17 offset:13312
s_add_u32 s65,s88,0
s_waitcnt lgkmcnt(9)
v_mfma_f32_16x16x32_bf16 v[68:71],a[0:3],v[224:227],0
buffer_load_dwordx4 v16,s[20:23],s65 offen offset:0 sc1 lds
v_min3_u32 v27,v27,v224,v228
v_mfma_f32_16x16x32_bf16 v[76:79],a[128:131],v[224:227],0
ds_read_b128 v[252:255],v17 offset:15360
buffer_load_dwordx4 v16,s[20:23],s65 offen offset:2048 sc1 lds
v_mfma_f32_16x16x32_bf16 v[68:71],a[4:7],v[228:231],v[68:71]
v_cmp_eq_u32 vcc,0,v27
s_cbranch_vccnz retry_239
v_mfma_f32_16x16x32_bf16 v[76:79],a[132:135],v[228:231],v[76:79]
ds_read_b128 v[224:227],v17 offset:17408
s_xor_b32 m0,s72,16384
s_waitcnt lgkmcnt(9)
v_mfma_f32_16x16x32_bf16 v[68:71],a[8:11],v[232:235],v[68:71]
s_add_u32 s65,s88,32768
v_min3_u32 v27,v27,v232,v236
s_waitcnt lgkmcnt(3)
v_mfma_f32_16x16x32_bf16 v[76:79],a[136:139],v[232:235],v[76:79]
ds_read_b128 v[228:231],v17 offset:19456
buffer_load_dwordx4 v16,s[20:23],s65 offen offset:0 sc1 lds
v_mfma_f32_16x16x32_bf16 v[68:71],a[12:15],v[236:239],v[68:71]
v_lshlrev_b32 v88,16,v120
v_and_b32 v89,s80,v120
v_lshlrev_b32 v90,16,v121
v_mfma_f32_16x16x32_bf16 v[76:79],a[140:143],v[236:239],v[76:79]
ds_read_b128 v[232:235],v17 offset:21504
v_and_b32 v91,s80,v121
v_mfma_f32_16x16x32_bf16 v[68:71],a[16:19],v[240:243],v[68:71]
buffer_load_dwordx4 v16,s[20:23],s65 offen offset:2048 sc1 lds
s_xor_b32 m0,s72,32768
v_mfma_f32_16x16x32_bf16 v[76:79],a[144:147],v[240:243],v[76:79]
ds_read_b128 v[236:239],v17 offset:23552
s_add_u32 s65,s88,65536
v_lshlrev_b32 v92,16,v122
v_mfma_f32_16x16x32_bf16 v[68:71],a[20:23],v[244:247],v[68:71]
v_min3_u32 v27,v27,v240,v244
v_and_b32 v93,s80,v122
v_lshlrev_b32 v94,16,v123
v_mfma_f32_16x16x32_bf16 v[76:79],a[148:151],v[244:247],v[76:79]
ds_read_b128 v[240:243],v17 offset:25600
v_and_b32 v95,s80,v123
s_waitcnt lgkmcnt(5)
v_mfma_f32_16x16x32_bf16 v[68:71],a[24:27],v[248:251],v[68:71]
buffer_load_dwordx4 v16,s[20:23],s65 offen offset:0 sc1 lds
v_add_f32 v88,v64,v88
v_mfma_f32_16x16x32_bf16 v[76:79],a[152:155],v[248:251],v[76:79]
ds_read_b128 v[244:247],v17 offset:27648
buffer_load_dwordx4 v16,s[20:23],s65 offen offset:2048 sc1 lds
v_mfma_f32_16x16x32_bf16 v[68:71],a[28:31],v[252:255],v[68:71]
s_xor_b32 m0,s72,49152
v_min3_u32 v27,v27,v248,v252
v_add_f32 v89,v65,v89
v_mfma_f32_16x16x32_bf16 v[76:79],a[156:159],v[252:255],v[76:79]
ds_read_b128 v[248:251],v17 offset:29696
s_add_u32 s65,s88,98304
s_waitcnt lgkmcnt(5)
v_mfma_f32_16x16x32_bf16 v[68:71],a[32:35],v[224:227],v[68:71]
buffer_load_dwordx4 v16,s[20:23],s65 offen offset:0 sc1 lds
v_add_f32 v90,v66,v90
v_mfma_f32_16x16x32_bf16 v[76:79],a[160:163],v[224:227],v[76:79]
ds_read_b128 v[252:255],v17 offset:31744
v_min3_u32 v27,v27,v224,v228
v_add_f32 v91,v67,v91
v_mfma_f32_16x16x32_bf16 v[68:71],a[36:39],v[228:231],v[68:71]
buffer_load_dwordx4 v16,s[20:23],s65 offen offset:2048 sc1 lds
v_add_f32 v92,v72,v92
v_mfma_f32_16x16x32_bf16 v[76:79],a[164:167],v[228:231],v[76:79]
ds_read_b128 v[224:227],v17 offset:33792
v_add_f32 v93,v73,v93
s_waitcnt lgkmcnt(5)
v_mfma_f32_16x16x32_bf16 v[68:71],a[40:43],v[232:235],v[68:71]
s_xor_b32 m0,s72,1024
s_add_u32 s65,s89,0
v_add_f32 v94,v74,v94
v_mfma_f32_16x16x32_bf16 v[76:79],a[168:171],v[232:235],v[76:79]
ds_read_b128 v[228:231],v17 offset:35840
v_min3_u32 v27,v27,v232,v236
v_add_f32 v95,v75,v95
v_mfma_f32_16x16x32_bf16 v[68:71],a[44:47],v[236:239],v[68:71]
buffer_load_dwordx4 v16,s[20:23],s65 offen offset:0 sc1 lds
v_cvt_pk_bf16_f32 v96,v88,v89
v_mfma_f32_16x16x32_bf16 v[76:79],a[172:175],v[236:239],v[76:79]
ds_read_b128 v[232:235],v17 offset:37888
v_cvt_pk_bf16_f32 v97,v90,v91
s_waitcnt lgkmcnt(5)
v_mfma_f32_16x16x32_bf16 v[68:71],a[48:51],v[240:243],v[68:71]
buffer_load_dwordx4 v16,s[20:23],s65 offen offset:2048 sc1 lds
v_cvt_pk_bf16_f32 v98,v92,v93
v_mfma_f32_16x16x32_bf16 v[76:79],a[176:179],v[240:243],v[76:79]
ds_read_b128 v[236:239],v17 offset:39936
s_xor_b32 m0,s72,17408
v_cvt_pk_bf16_f32 v99,v94,v95
v_mfma_f32_16x16x32_bf16 v[68:71],a[52:55],v[244:247],v[68:71]
s_add_u32 s65,s89,32768
v_min3_u32 v27,v27,v240,v244
v_max_u32 v96,1,v96
v_mfma_f32_16x16x32_bf16 v[76:79],a[180:183],v[244:247],v[76:79]
ds_read_b128 v[240:243],v17 offset:41984
s_waitcnt lgkmcnt(5)
v_mfma_f32_16x16x32_bf16 v[68:71],a[56:59],v[248:251],v[68:71]
buffer_load_dwordx4 v16,s[20:23],s65 offen offset:0 sc1 lds
v_mfma_f32_16x16x32_bf16 v[76:79],a[184:187],v[248:251],v[76:79]
ds_read_b128 v[244:247],v17 offset:44032
v_min3_u32 v27,v27,v248,v252
v_mfma_f32_16x16x32_bf16 v[68:71],a[60:63],v[252:255],v[68:71]
buffer_load_dwordx4 v16,s[20:23],s65 offen offset:2048 sc1 lds
v_mfma_f32_16x16x32_bf16 v[76:79],a[188:191],v[252:255],v[76:79]
ds_read_b128 v[248:251],v17 offset:46080
s_waitcnt lgkmcnt(5)
v_mfma_f32_16x16x32_bf16 v[68:71],a[64:67],v[224:227],v[68:71]
s_xor_b32 m0,s72,33792
s_add_u32 s65,s89,65536
v_mfma_f32_16x16x32_bf16 v[76:79],a[192:195],v[224:227],v[76:79]
ds_read_b128 v[252:255],v17 offset:48128
v_min3_u32 v27,v27,v224,v228
v_mfma_f32_16x16x32_bf16 v[68:71],a[68:71],v[228:231],v[68:71]
buffer_load_dwordx4 v16,s[20:23],s65 offen offset:0 sc1 lds
v_mfma_f32_16x16x32_bf16 v[76:79],a[196:199],v[228:231],v[76:79]
ds_read_b128 v[224:227],v17 offset:50176
s_waitcnt lgkmcnt(5)
v_mfma_f32_16x16x32_bf16 v[68:71],a[72:75],v[232:235],v[68:71]
buffer_load_dwordx4 v16,s[20:23],s65 offen offset:2048 sc1 lds
v_mfma_f32_16x16x32_bf16 v[76:79],a[200:203],v[232:235],v[76:79]
ds_read_b128 v[228:231],v17 offset:52224
s_xor_b32 m0,s72,50176
v_mfma_f32_16x16x32_bf16 v[68:71],a[76:79],v[236:239],v[68:71]
s_add_u32 s65,s89,98304
v_min3_u32 v27,v27,v232,v236
v_mfma_f32_16x16x32_bf16 v[76:79],a[204:207],v[236:239],v[76:79]
ds_read_b128 v[232:235],v17 offset:54272
s_waitcnt lgkmcnt(5)
v_mfma_f32_16x16x32_bf16 v[68:71],a[80:83],v[240:243],v[68:71]
buffer_load_dwordx4 v16,s[20:23],s65 offen offset:0 sc1 lds
v_mfma_f32_16x16x32_bf16 v[76:79],a[208:211],v[240:243],v[76:79]
ds_read_b128 v[236:239],v17 offset:56320
v_min3_u32 v27,v27,v240,v244
v_mfma_f32_16x16x32_bf16 v[68:71],a[84:87],v[244:247],v[68:71]
buffer_load_dwordx4 v16,s[20:23],s65 offen offset:2048 sc1 lds
v_mfma_f32_16x16x32_bf16 v[76:79],a[212:215],v[244:247],v[76:79]
ds_read_b128 v[240:243],v17 offset:58368
s_waitcnt lgkmcnt(5)
v_mfma_f32_16x16x32_bf16 v[68:71],a[88:91],v[248:251],v[68:71]
v_min3_u32 v27,v27,v248,v252
buffer_store_dwordx4 v[96:99],v18,s[20:23],s70 offen offset:0 sc1
v_mfma_f32_16x16x32_bf16 v[76:79],a[216:219],v[248:251],v[76:79]
ds_read_b128 v[244:247],v17 offset:60416
v_lshlrev_b32 v88,16,v96
v_and_b32 v89,s80,v96
v_mfma_f32_16x16x32_bf16 v[68:71],a[92:95],v[252:255],v[68:71]
v_lshlrev_b32 v90,16,v97
v_and_b32 v91,s80,v97
v_lshlrev_b32 v92,16,v98
v_mfma_f32_16x16x32_bf16 v[76:79],a[220:223],v[252:255],v[76:79]
ds_read_b128 v[248:251],v17 offset:62464
v_and_b32 v93,s80,v98
s_waitcnt lgkmcnt(5)
v_mfma_f32_16x16x32_bf16 v[68:71],a[96:99],v[224:227],v[68:71]
v_min3_u32 v27,v27,v224,v228
v_lshlrev_b32 v94,16,v99
v_and_b32 v95,s80,v99
v_mfma_f32_16x16x32_bf16 v[76:79],a[224:227],v[224:227],v[76:79]
ds_read_b128 v[252:255],v17 offset:64512
v_add_f32 v108,v88,v89
v_mul_f32 v109,v88,v88
v_mfma_f32_16x16x32_bf16 v[68:71],a[100:103],v[228:231],v[68:71]
v_add_f32 v100,v90,v91
v_mul_f32 v101,v89,v89
v_fmac_f32 v109,v90,v90
v_mfma_f32_16x16x32_bf16 v[76:79],a[228:231],v[228:231],v[76:79]
v_fmac_f32 v101,v91,v91
v_fmac_f32 v109,v92,v92
s_waitcnt lgkmcnt(4)
v_mfma_f32_16x16x32_bf16 v[68:71],a[104:107],v[232:235],v[68:71]
v_min3_u32 v27,v27,v232,v236
v_fmac_f32 v101,v93,v93
v_add_f32 v108,v108,v92
v_mfma_f32_16x16x32_bf16 v[76:79],a[232:235],v[232:235],v[76:79]
v_add_f32 v100,v100,v93
v_fmac_f32 v109,v94,v94
v_fmac_f32 v101,v95,v95
v_mfma_f32_16x16x32_bf16 v[68:71],a[108:111],v[236:239],v[68:71]
v_add_f32 v108,v108,v94
v_add_f32 v100,v100,v95
v_add_f32 v108,v108,v100
v_mfma_f32_16x16x32_bf16 v[76:79],a[236:239],v[236:239],v[76:79]
v_add_f32 v109,v109,v101
v_mov_b32 v100,v108
s_waitcnt lgkmcnt(2)
v_mfma_f32_16x16x32_bf16 v[68:71],a[112:115],v[240:243],v[68:71]
v_min3_u32 v27,v27,v240,v244
v_mov_b32 v101,v109
v_permlane16_swap_b32 v100,v108
v_mfma_f32_16x16x32_bf16 v[76:79],a[240:243],v[240:243],v[76:79]
v_permlane16_swap_b32 v101,v109
v_add_f32 v108,v108,v100
v_add_f32 v109,v109,v101
v_mfma_f32_16x16x32_bf16 v[68:71],a[116:119],v[244:247],v[68:71]
v_mov_b32 v100,v108
v_mov_b32 v101,v109
s_nop 0
v_permlane32_swap_b32 v100,v108
v_mfma_f32_16x16x32_bf16 v[76:79],a[244:247],v[244:247],v[76:79]
v_permlane32_swap_b32 v101,v109
v_add_f32 v108,v108,v100
s_waitcnt lgkmcnt(0)
v_mfma_f32_16x16x32_bf16 v[68:71],a[120:123],v[248:251],v[68:71]
v_min3_u32 v27,v27,v248,v252
v_add_f32 v109,v109,v101
v_min3_u32 v27,v27,v120,v122
v_mfma_f32_16x16x32_bf16 v[76:79],a[248:251],v[248:251],v[76:79]
v_min3_u32 v27,v27,v124,v126
v_lshlrev_b32 v32,16,v124
v_and_b32 v33,s80,v124
v_mfma_f32_16x16x32_bf16 v[68:71],a[124:127],v[252:255],v[68:71]
v_lshlrev_b32 v34,16,v125
v_and_b32 v35,s80,v125
v_lshlrev_b32 v36,16,v126
v_mfma_f32_16x16x32_bf16 v[76:79],a[252:255],v[252:255],v[76:79]
v_and_b32 v37,s80,v126
v_lshlrev_b32 v38,16,v127
v_and_b32 v39,s80,v127
v_cmp_eq_u32 vcc,0,v27
s_cbranch_vccnz retry_239
s_branch epi_242
keep_251:
v_mfma_f32_16x16x32_bf16 v[64:67],a[124:127],v[252:255],v[64:67]
v_min3_u32 v27,v27,v248,v252
ds_read_b64 v[126:127],v41 offset:1024
v_mfma_f32_16x16x32_bf16 v[72:75],a[252:255],v[252:255],v[72:75]
ds_read_b128 v[248:251],v17 offset:13312
s_waitcnt lgkmcnt(9)
v_mfma_f32_16x16x32_bf16 v[68:71],a[0:3],v[224:227],0
v_cmp_eq_u32 vcc,0,v27
s_cbranch_vccnz retry_239
v_mfma_f32_16x16x32_bf16 v[76:79],a[128:131],v[224:227],0
ds_read_b128 v[252:255],v17 offset:15360
v_min3_u32 v27,v27,v224,v228
v_mfma_f32_16x16x32_bf16 v[68:71],a[4:7],v[228:231],v[68:71]
v_mfma_f32_16x16x32_bf16 v[76:79],a[132:135],v[228:231],v[76:79]
ds_read_b128 v[224:227],v17 offset:17408
s_waitcnt lgkmcnt(9)
v_mfma_f32_16x16x32_bf16 v[68:71],a[8:11],v[232:235],v[68:71]
v_min3_u32 v27,v27,v232,v236
s_waitcnt lgkmcnt(3)
v_lshlrev_b32 v88,16,v120
v_mfma_f32_16x16x32_bf16 v[76:79],a[136:139],v[232:235],v[76:79]
ds_read_b128 v[228:231],v17 offset:19456
v_and_b32 v89,s80,v120
v_lshlrev_b32 v90,16,v121
v_mfma_f32_16x16x32_bf16 v[68:71],a[12:15],v[236:239],v[68:71]
v_and_b32 v91,s80,v121
v_lshlrev_b32 v92,16,v122
v_and_b32 v93,s80,v122
v_mfma_f32_16x16x32_bf16 v[76:79],a[140:143],v[236:239],v[76:79]
ds_read_b128 v[232:235],v17 offset:21504
v_lshlrev_b32 v94,16,v123
v_mfma_f32_16x16x32_bf16 v[68:71],a[16:19],v[240:243],v[68:71]
v_min3_u32 v27,v27,v240,v244
v_and_b32 v95,s80,v123
v_mfma_f32_16x16x32_bf16 v[76:79],a[144:147],v[240:243],v[76:79]
ds_read_b128 v[236:239],v17 offset:23552
v_add_f32 v88,v64,v88
v_mfma_f32_16x16x32_bf16 v[68:71],a[20:23],v[244:247],v[68:71]
v_add_f32 v89,v65,v89
v_add_f32 v90,v66,v90
v_mfma_f32_16x16x32_bf16 v[76:79],a[148:151],v[244:247],v[76:79]
ds_read_b128 v[240:243],v17 offset:25600
s_waitcnt lgkmcnt(5)
v_mfma_f32_16x16x32_bf16 v[68:71],a[24:27],v[248:251],v[68:71]
v_min3_u32 v27,v27,v248,v252
v_add_f32 v91,v67,v91
v_mfma_f32_16x16x32_bf16 v[76:79],a[152:155],v[248:251],v[76:79]
ds_read_b128 v[244:247],v17 offset:27648
v_add_f32 v92,v72,v92
v_mfma_f32_16x16x32_bf16 v[68:71],a[28:31],v[252:255],v[68:71]
v_add_f32 v93,v73,v93
v_add_f32 v94,v74,v94
v_mfma_f32_16x16x32_bf16 v[76:79],a[156:159],v[252:255],v[76:79]
ds_read_b128 v[248:251],v17 offset:29696
s_waitcnt lgkmcnt(5)
v_mfma_f32_16x16x32_bf16 v[68:71],a[32:35],v[224:227],v[68:71]
v_min3_u32 v27,v27,v224,v228
v_add_f32 v95,v75,v95
v_mfma_f32_16x16x32_bf16 v[76:79],a[160:163],v[224:227],v[76:79]
ds_read_b128 v[252:255],v17 offset:31744
v_cvt_pk_bf16_f32 v96,v88,v89
v_mfma_f32_16x16x32_bf16 v[68:71],a[36:39],v[228:231],v[68:71]
v_cvt_pk_bf16_f32 v97,v90,v91
v_cvt_pk_bf16_f32 v98,v92,v93
v_mfma_f32_16x16x32_bf16 v[76:79],a[164:167],v[228:231],v[76:79]
ds_read_b128 v[224:227],v17 offset:33792
s_waitcnt lgkmcnt(5)
v_mfma_f32_16x16x32_bf16 v[68:71],a[40:43],v[232:235],v[68:71]
v_min3_u32 v27,v27,v232,v236
v_cvt_pk_bf16_f32 v99,v94,v95
v_mfma_f32_16x16x32_bf16 v[76:79],a[168:171],v[232:235],v[76:79]
ds_read_b128 v[228:231],v17 offset:35840
v_max_u32 v96,1,v96
v_mfma_f32_16x16x32_bf16 v[68:71],a[44:47],v[236:239],v[68:71]
buffer_store_dwordx4 v[96:99],v18,s[20:23],s70 offen offset:0 sc1
v_mfma_f32_16x16x32_bf16 v[76:79],a[172:175],v[236:239],v[76:79]
ds_read_b128 v[232:235],v17 offset:37888
s_waitcnt lgkmcnt(5)
v_mfma_f32_16x16x32_bf16 v[68:71],a[48:51],v[240:243],v[68:71]
v_min3_u32 v27,v27,v240,v244
v_lshlrev_b32 v88,16,v96
v_mfma_f32_16x16x32_bf16 v[76:79],a[176:179],v[240:243],v[76:79]
ds_read_b128 v[236:239],v17 offset:39936
v_and_b32 v89,s80,v96
v_mfma_f32_16x16x32_bf16 v[68:71],a[52:55],v[244:247],v[68:71]
v_lshlrev_b32 v90,16,v97
v_and_b32 v91,s80,v97
v_mfma_f32_16x16x32_bf16 v[76:79],a[180:183],v[244:247],v[76:79]
ds_read_b128 v[240:243],v17 offset:41984
s_waitcnt lgkmcnt(5)
v_mfma_f32_16x16x32_bf16 v[68:71],a[56:59],v[248:251],v[68:71]
v_min3_u32 v27,v27,v248,v252
v_lshlrev_b32 v92,16,v98
v_mfma_f32_16x16x32_bf16 v[76:79],a[184:187],v[248:251],v[76:79]
ds_read_b128 v[244:247],v17 offset:44032
v_and_b32 v93,s80,v98
v_mfma_f32_16x16x32_bf16 v[68:71],a[60:63],v[252:255],v[68:71]
v_lshlrev_b32 v94,16,v99
v_and_b32 v95,s80,v99
v_mfma_f32_16x16x32_bf16 v[76:79],a[188:191],v[252:255],v[76:79]
ds_read_b128 v[248:251],v17 offset:46080
s_waitcnt lgkmcnt(5)
v_mfma_f32_16x16x32_bf16 v[68:71],a[64:67],v[224:227],v[68:71]
v_min3_u32 v27,v27,v224,v228
v_add_f32 v108,v88,v89
v_mfma_f32_16x16x32_bf16 v[76:79],a[192:195],v[224:227],v[76:79]
ds_read_b128 v[252:255],v17 offset:48128
v_mul_f32 v109,v88,v88
v_mfma_f32_16x16x32_bf16 v[68:71],a[68:71],v[228:231],v[68:71]
v_add_f32 v100,v90,v91
v_mul_f32 v101,v89,v89
v_mfma_f32_16x16x32_bf16 v[76:79],a[196:199],v[228:231],v[76:79]
ds_read_b128 v[224:227],v17 offset:50176
s_waitcnt lgkmcnt(5)
v_mfma_f32_16x16x32_bf16 v[68:71],a[72:75],v[232:235],v[68:71]
v_min3_u32 v27,v27,v232,v236
v_fmac_f32 v109,v90,v90
v_mfma_f32_16x16x32_bf16 v[76:79],a[200:203],v[232:235],v[76:79]
ds_read_b128 v[228:231],v17 offset:52224
v_fmac_f32 v101,v91,v91
v_mfma_f32_16x16x32_bf16 v[68:71],a[76:79],v[236:239],v[68:71]
v_fmac_f32 v109,v92,v92
v_fmac_f32 v101,v93,v93
v_mfma_f32_16x16x32_bf16 v[76:79],a[204:207],v[236:239],v[76:79]
ds_read_b128 v[232:235],v17 offset:54272
s_waitcnt lgkmcnt(5)
v_mfma_f32_16x16x32_bf16 v[68:71],a[80:83],v[240:243],v[68:71]
v_min3_u32 v27,v27,v240,v244
v_add_f32 v108,v108,v92
v_mfma_f32_16x16x32_bf16 v[76:79],a[208:211],v[240:243],v[76:79]
ds_read_b128 v[236:239],v17 offset:56320
v_add_f32 v100,v100,v93
v_mfma_f32_16x16x32_bf16 v[68:71],a[84:87],v[244:247],v[68:71]
v_fmac_f32 v109,v94,v94
v_fmac_f32 v101,v95,v95
v_mfma_f32_16x16x32_bf16 v[76:79],a[212:215],v[244:247],v[76:79]
ds_read_b128 v[240:243],v17 offset:58368
s_waitcnt lgkmcnt(5)
v_mfma_f32_16x16x32_bf16 v[68:71],a[88:91],v[248:251],v[68:71]
v_min3_u32 v27,v27,v248,v252
v_add_f32 v108,v108,v94
v_mfma_f32_16x16x32_bf16 v[76:79],a[216:219],v[248:251],v[76:79]
ds_read_b128 v[244:247],v17 offset:60416
v_add_f32 v100,v100,v95
v_mfma_f32_16x16x32_bf16 v[68:71],a[92:95],v[252:255],v[68:71]
v_add_f32 v108,v108,v100
v_add_f32 v109,v109,v101
v_mfma_f32_16x16x32_bf16 v[76:79],a[220:223],v[252:255],v[76:79]
ds_read_b128 v[248:251],v17 offset:62464
s_waitcnt lgkmcnt(5)
v_mfma_f32_16x16x32_bf16 v[68:71],a[96:99],v[224:227],v[68:71]
v_min3_u32 v27,v27,v224,v228
v_mov_b32 v100,v108
v_mfma_f32_16x16x32_bf16 v[76:79],a[224:227],v[224:227],v[76:79]
ds_read_b128 v[252:255],v17 offset:64512
v_mov_b32 v101,v109
v_mfma_f32_16x16x32_bf16 v[68:71],a[100:103],v[228:231],v[68:71]
v_permlane16_swap_b32 v100,v108
v_permlane16_swap_b32 v101,v109
v_mfma_f32_16x16x32_bf16 v[76:79],a[228:231],v[228:231],v[76:79]
v_add_f32 v108,v108,v100
s_waitcnt lgkmcnt(4)
v_mfma_f32_16x16x32_bf16 v[68:71],a[104:107],v[232:235],v[68:71]
v_min3_u32 v27,v27,v232,v236
v_add_f32 v109,v109,v101
v_mfma_f32_16x16x32_bf16 v[76:79],a[232:235],v[232:235],v[76:79]
v_mov_b32 v100,v108
v_mov_b32 v101,v109
v_mfma_f32_16x16x32_bf16 v[68:71],a[108:111],v[236:239],v[68:71]
v_permlane32_swap_b32 v100,v108
v_permlane32_swap_b32 v101,v109
v_mfma_f32_16x16x32_bf16 v[76:79],a[236:239],v[236:239],v[76:79]
v_add_f32 v108,v108,v100
s_waitcnt lgkmcnt(2)
v_mfma_f32_16x16x32_bf16 v[68:71],a[112:115],v[240:243],v[68:71]
v_min3_u32 v27,v27,v240,v244
v_add_f32 v109,v109,v101
v_mfma_f32_16x16x32_bf16 v[76:79],a[240:243],v[240:243],v[76:79]
v_min3_u32 v27,v27,v120,v122
v_min3_u32 v27,v27,v124,v126
v_mfma_f32_16x16x32_bf16 v[68:71],a[116:119],v[244:247],v[68:71]
v_lshlrev_b32 v32,16,v124
v_and_b32 v33,s80,v124
v_mfma_f32_16x16x32_bf16 v[76:79],a[244:247],v[244:247],v[76:79]
v_lshlrev_b32 v34,16,v125
s_waitcnt lgkmcnt(0)
v_mfma_f32_16x16x32_bf16 v[68:71],a[120:123],v[248:251],v[68:71]
v_min3_u32 v27,v27,v248,v252
v_and_b32 v35,s80,v125
v_mfma_f32_16x16x32_bf16 v[76:79],a[248:251],v[248:251],v[76:79]
v_lshlrev_b32 v36,16,v126
v_and_b32 v37,s80,v126
v_mfma_f32_16x16x32_bf16 v[68:71],a[124:127],v[252:255],v[68:71]
v_lshlrev_b32 v38,16,v127
v_and_b32 v39,s80,v127
v_mfma_f32_16x16x32_bf16 v[76:79],a[252:255],v[252:255],v[76:79]
v_cmp_eq_u32 vcc,0,v27
s_cbranch_vccnz retry_239
s_branch epi_242
both_243:
s_waitcnt vmcnt(13) lgkmcnt(0)
s_barrier
ds_read_b128 v[224:227],v17 offset:0
ds_read_b128 v[228:231],v17 offset:2048
ds_read_b128 v[232:235],v17 offset:4096
ds_read_b128 v[236:239],v17 offset:6144
ds_read_b128 v[240:243],v17 offset:8192
ds_read_b128 v[244:247],v17 offset:10240
ds_read_b128 v[248:251],v17 offset:12288
s_waitcnt lgkmcnt(5)
v_mfma_f32_16x16x32_bf16 v[64:67],a[0:3],v[224:227],0
s_add_u32 s96,s71,1
s_add_u32 s92,s71,2
s_add_u32 s88,s70,s75
v_min_u32 v27,v224,v228
s_add_u32 m0,s43,0
v_mfma_f32_16x16x32_bf16 v[72:75],a[128:131],v[224:227],0
ds_read_b128 v[252:255],v17 offset:14336
s_cmp_eq_u32 s96,64
s_cselect_b32 s96,99,s96
buffer_load_dwordx4 v19,s[20:23],s78 offen sc1 lds
v_mfma_f32_16x16x32_bf16 v[64:67],a[4:7],v[228:231],v[64:67]
s_cmp_eq_u32 s92,64
s_cselect_b32 s92,99,s92
s_add_u32 s88,s88,2097152
s_add_u32 m0,s43,1024
v_mfma_f32_16x16x32_bf16 v[72:75],a[132:135],v[228:231],v[72:75]
ds_read_b128 v[224:227],v17 offset:16384
s_xor_b32 s88,s88,0x2000
buffer_load_dwordx4 v20,s[20:23],s78 offen sc1 lds
s_waitcnt lgkmcnt(5)
v_mfma_f32_16x16x32_bf16 v[64:67],a[8:11],v[232:235],v[64:67]
s_cmp_eq_u32 s96,65
s_cselect_b32 s96,64,s96
v_mfma_f32_16x16x32_bf16 v[72:75],a[136:139],v[232:235],v[72:75]
ds_read_b128 v[228:231],v17 offset:18432
s_xor_b32 s89,s88,1024
v_mfma_f32_16x16x32_bf16 v[64:67],a[12:15],v[236:239],v[64:67]
s_xor_b32 m0,s72,0
v_min3_u32 v27,v27,v232,v236
v_mfma_f32_16x16x32_bf16 v[72:75],a[140:143],v[236:239],v[72:75]
ds_read_b128 v[232:235],v17 offset:20480
s_add_u32 s65,s88,0
s_waitcnt lgkmcnt(5)
v_mfma_f32_16x16x32_bf16 v[64:67],a[16:19],v[240:243],v[64:67]
v_min3_u32 v27,v27,v240,v244
v_mfma_f32_16x16x32_bf16 v[72:75],a[144:147],v[240:243],v[72:75]
ds_read_b128 v[236:239],v17 offset:22528
buffer_load_dwordx4 v16,s[20:23],s65 offen offset:0 sc1 lds
v_mfma_f32_16x16x32_bf16 v[64:67],a[20:23],v[244:247],v[64:67]
buffer_load_dwordx4 v16,s[20:23],s65 offen offset:2048 sc1 lds
v_mfma_f32_16x16x32_bf16 v[72:75],a[148:151],v[244:247],v[72:75]
ds_read_b128 v[240:243],v17 offset:24576
s_waitcnt lgkmcnt(5)
v_mfma_f32_16x16x32_bf16 v[64:67],a[24:27],v[248:251],v[64:67]
s_xor_b32 m0,s72,16384
v_min3_u32 v27,v27,v248,v252
v_mfma_f32_16x16x32_bf16 v[72:75],a[152:155],v[248:251],v[72:75]
ds_read_b128 v[244:247],v17 offset:26624
v_mfma_f32_16x16x32_bf16 v[64:67],a[28:31],v[252:255],v[64:67]
s_add_u32 s65,s88,32768
v_mfma_f32_16x16x32_bf16 v[72:75],a[156:159],v[252:255],v[72:75]
ds_read_b128 v[248:251],v17 offset:28672
s_waitcnt lgkmcnt(5)
v_mfma_f32_16x16x32_bf16 v[64:67],a[32:35],v[224:227],v[64:67]
buffer_load_dwordx4 v16,s[20:23],s65 offen offset:0 sc1 lds
v_mfma_f32_16x16x32_bf16 v[72:75],a[160:163],v[224:227],v[72:75]
ds_read_b128 v[252:255],v17 offset:30720
buffer_load_dwordx4 v16,s[20:23],s65 offen offset:2048 sc1 lds
v_mfma_f32_16x16x32_bf16 v[64:67],a[36:39],v[228:231],v[64:67]
v_min3_u32 v27,v27,v224,v228
v_mfma_f32_16x16x32_bf16 v[72:75],a[164:167],v[228:231],v[72:75]
ds_read_b128 v[224:227],v17 offset:32768
s_xor_b32 m0,s72,32768
s_waitcnt lgkmcnt(5)
v_mfma_f32_16x16x32_bf16 v[64:67],a[40:43],v[232:235],v[64:67]
s_add_u32 s65,s88,65536
v_min3_u32 v27,v27,v232,v236
v_mfma_f32_16x16x32_bf16 v[72:75],a[168:171],v[232:235],v[72:75]
ds_read_b128 v[228:231],v17 offset:34816
v_mfma_f32_16x16x32_bf16 v[64:67],a[44:47],v[236:239],v[64:67]
buffer_load_dwordx4 v16,s[20:23],s65 offen offset:0 sc1 lds
v_mfma_f32_16x16x32_bf16 v[72:75],a[172:175],v[236:239],v[72:75]
ds_read_b128 v[232:235],v17 offset:36864
s_waitcnt lgkmcnt(5)
v_mfma_f32_16x16x32_bf16 v[64:67],a[48:51],v[240:243],v[64:67]
buffer_load_dwordx4 v16,s[20:23],s65 offen offset:2048 sc1 lds
v_mfma_f32_16x16x32_bf16 v[72:75],a[176:179],v[240:243],v[72:75]
ds_read_b128 v[236:239],v17 offset:38912
s_xor_b32 m0,s72,49152
v_mfma_f32_16x16x32_bf16 v[64:67],a[52:55],v[244:247],v[64:67]
v_min3_u32 v27,v27,v240,v244
v_mfma_f32_16x16x32_bf16 v[72:75],a[180:183],v[244:247],v[72:75]
ds_read_b128 v[240:243],v17 offset:40960
s_add_u32 s65,s88,98304
s_waitcnt lgkmcnt(5)
v_mfma_f32_16x16x32_bf16 v[64:67],a[56:59],v[248:251],v[64:67]
buffer_load_dwordx4 v16,s[20:23],s65 offen offset:0 sc1 lds
v_min3_u32 v27,v27,v248,v252
v_mfma_f32_16x16x32_bf16 v[72:75],a[184:187],v[248:251],v[72:75]
ds_read_b128 v[244:247],v17 offset:43008
s_waitcnt vmcnt(12)
v_mfma_f32_16x16x32_bf16 v[64:67],a[60:63],v[252:255],v[64:67]
v_cmp_gt_u32 vcc,s96,v29
v_cmp_gt_u32 s[92:93],s92,v29
v_mfma_f32_16x16x32_bf16 v[72:75],a[188:191],v[252:255],v[72:75]
ds_read_b128 v[248:251],v17 offset:45056
s_waitcnt lgkmcnt(5)
v_mfma_f32_16x16x32_bf16 v[64:67],a[64:67],v[224:227],v[64:67]
v_mov_b32 v44,vcc_lo
v_mov_b32 v45,s92
v_min3_u32 v27,v27,v224,v228
v_mfma_f32_16x16x32_bf16 v[72:75],a[192:195],v[224:227],v[72:75]
ds_read_b128 v[252:255],v17 offset:47104
ds_write_b64 v46,v[44:45]
v_mfma_f32_16x16x32_bf16 v[64:67],a[68:71],v[228:231],v[64:67]
buffer_load_dwordx4 v16,s[20:23],s65 offen offset:2048 sc1 lds
v_mfma_f32_16x16x32_bf16 v[72:75],a[196:199],v[228:231],v[72:75]
ds_read_b128 v[224:227],v17 offset:49152
s_waitcnt lgkmcnt(6)
v_mfma_f32_16x16x32_bf16 v[64:67],a[72:75],v[232:235],v[64:67]
s_xor_b32 m0,s72,1024
s_add_u32 s65,s89,0
v_mfma_f32_16x16x32_bf16 v[72:75],a[200:203],v[232:235],v[72:75]
ds_read_b128 v[228:231],v17 offset:51200
v_min3_u32 v27,v27,v232,v236
v_mfma_f32_16x16x32_bf16 v[64:67],a[76:79],v[236:239],v[64:67]
buffer_load_dwordx4 v16,s[20:23],s65 offen offset:0 sc1 lds
v_mfma_f32_16x16x32_bf16 v[72:75],a[204:207],v[236:239],v[72:75]
ds_read_b128 v[232:235],v17 offset:53248
s_waitcnt lgkmcnt(6)
v_mfma_f32_16x16x32_bf16 v[64:67],a[80:83],v[240:243],v[64:67]
buffer_load_dwordx4 v16,s[20:23],s65 offen offset:2048 sc1 lds
v_mfma_f32_16x16x32_bf16 v[72:75],a[208:211],v[240:243],v[72:75]
ds_read_b128 v[236:239],v17 offset:55296
s_xor_b32 m0,s72,17408
v_mfma_f32_16x16x32_bf16 v[64:67],a[84:87],v[244:247],v[64:67]
s_add_u32 s65,s89,32768
v_min3_u32 v27,v27,v240,v244
v_mfma_f32_16x16x32_bf16 v[72:75],a[212:215],v[244:247],v[72:75]
ds_read_b128 v[240:243],v17 offset:57344
s_waitcnt lgkmcnt(6)
v_mfma_f32_16x16x32_bf16 v[64:67],a[88:91],v[248:251],v[64:67]
buffer_load_dwordx4 v16,s[20:23],s65 offen offset:0 sc1 lds
v_mfma_f32_16x16x32_bf16 v[72:75],a[216:219],v[248:251],v[72:75]
ds_read_b128 v[244:247],v17 offset:59392
v_min3_u32 v27,v27,v248,v252
v_mfma_f32_16x16x32_bf16 v[64:67],a[92:95],v[252:255],v[64:67]
buffer_load_dwordx4 v16,s[20:23],s65 offen offset:2048 sc1 lds
v_mfma_f32_16x16x32_bf16 v[72:75],a[220:223],v[252:255],v[72:75]
ds_read_b128 v[248:251],v17 offset:61440
s_waitcnt lgkmcnt(5)
v_mfma_f32_16x16x32_bf16 v[64:67],a[96:99],v[224:227],v[64:67]
s_xor_b32 m0,s72,33792
s_add_u32 s65,s89,65536
v_mfma_f32_16x16x32_bf16 v[72:75],a[224:227],v[224:227],v[72:75]
ds_read_b128 v[252:255],v17 offset:63488
v_min3_u32 v27,v27,v224,v228
v_mfma_f32_16x16x32_bf16 v[64:67],a[100:103],v[228:231],v[64:67]
buffer_load_dwordx4 v16,s[20:23],s65 offen offset:0 sc1 lds
s_waitcnt vmcnt(15)
v_add_u32 v22,s71,-1
v_mfma_f32_16x16x32_bf16 v[72:75],a[228:231],v[228:231],v[72:75]
s_waitcnt vmcnt(20)
s_barrier
ds_read_b64 v[44:45],v47
ds_read_b128 v[224:227],v17 offset:1024
s_waitcnt lgkmcnt(6)
v_mfma_f32_16x16x32_bf16 v[64:67],a[104:107],v[232:235],v[64:67]
buffer_load_dwordx4 v16,s[20:23],s65 offen offset:2048 sc1 lds
buffer_store_dword v22,v23,s[20:23],s97 offen sc1
v_mfma_f32_16x16x32_bf16 v[72:75],a[232:235],v[232:235],v[72:75]
ds_read_b128 v[228:231],v17 offset:3072
s_xor_b32 m0,s72,50176
s_mov_b32 s97,0x7fff0000
v_mfma_f32_16x16x32_bf16 v[64:67],a[108:111],v[236:239],v[64:67]
s_add_u32 s65,s89,98304
v_min3_u32 v27,v27,v232,v236
s_waitcnt vmcnt(15)
v_mfma_f32_16x16x32_bf16 v[72:75],a[236:239],v[236:239],v[72:75]
ds_read_b128 v[232:235],v17 offset:5120
ds_read_b64 v[120:121],v40 offset:0
s_waitcnt lgkmcnt(7)
v_mfma_f32_16x16x32_bf16 v[64:67],a[112:115],v[240:243],v[64:67]
buffer_load_dwordx4 v16,s[20:23],s65 offen offset:0 sc1 lds
ds_read_b64 v[122:123],v41 offset:0
v_mfma_f32_16x16x32_bf16 v[72:75],a[240:243],v[240:243],v[72:75]
ds_read_b128 v[236:239],v17 offset:7168
v_min3_u32 v27,v27,v240,v244
v_mfma_f32_16x16x32_bf16 v[64:67],a[116:119],v[244:247],v[64:67]
buffer_load_dwordx4 v16,s[20:23],s65 offen offset:2048 sc1 lds
v_mfma_f32_16x16x32_bf16 v[72:75],a[244:247],v[244:247],v[72:75]
ds_read_b128 v[240:243],v17 offset:9216
s_waitcnt lgkmcnt(8)
v_mfma_f32_16x16x32_bf16 v[64:67],a[120:123],v[248:251],v[64:67]
s_waitcnt lgkmcnt(7)
v_readfirstlane_b32 s93,v45
v_mfma_f32_16x16x32_bf16 v[72:75],a[248:251],v[248:251],v[72:75]
ds_read_b128 v[244:247],v17 offset:11264
v_min3_u32 v27,v27,v248,v252
v_mfma_f32_16x16x32_bf16 v[64:67],a[124:127],v[252:255],v[64:67]
ds_read_b64 v[124:125],v40 offset:1024
ds_read_b64 v[126:127],v41 offset:1024
v_mfma_f32_16x16x32_bf16 v[72:75],a[252:255],v[252:255],v[72:75]
ds_read_b128 v[248:251],v17 offset:13312
s_waitcnt lgkmcnt(9)
v_mfma_f32_16x16x32_bf16 v[68:71],a[0:3],v[224:227],0
v_cmp_eq_u32 vcc,0,v27
s_cbranch_vccnz retry_239
v_mfma_f32_16x16x32_bf16 v[76:79],a[128:131],v[224:227],0
ds_read_b128 v[252:255],v17 offset:15360
v_min3_u32 v27,v27,v224,v228
v_mfma_f32_16x16x32_bf16 v[68:71],a[4:7],v[228:231],v[68:71]
v_mfma_f32_16x16x32_bf16 v[76:79],a[132:135],v[228:231],v[76:79]
ds_read_b128 v[224:227],v17 offset:17408
s_waitcnt lgkmcnt(7)
v_mfma_f32_16x16x32_bf16 v[68:71],a[8:11],v[232:235],v[68:71]
v_min3_u32 v27,v27,v232,v236
s_waitcnt lgkmcnt(3)
v_lshlrev_b32 v88,16,v120
v_mfma_f32_16x16x32_bf16 v[76:79],a[136:139],v[232:235],v[76:79]
ds_read_b128 v[228:231],v17 offset:19456
v_and_b32 v89,s80,v120
v_lshlrev_b32 v90,16,v121
v_mfma_f32_16x16x32_bf16 v[68:71],a[12:15],v[236:239],v[68:71]
v_and_b32 v91,s80,v121
v_lshlrev_b32 v92,16,v122
v_and_b32 v93,s80,v122
v_mfma_f32_16x16x32_bf16 v[76:79],a[140:143],v[236:239],v[76:79]
ds_read_b128 v[232:235],v17 offset:21504
v_lshlrev_b32 v94,16,v123
v_mfma_f32_16x16x32_bf16 v[68:71],a[16:19],v[240:243],v[68:71]
v_min3_u32 v27,v27,v240,v244
v_and_b32 v95,s80,v123
v_mfma_f32_16x16x32_bf16 v[76:79],a[144:147],v[240:243],v[76:79]
ds_read_b128 v[236:239],v17 offset:23552
v_add_f32 v88,v64,v88
v_mfma_f32_16x16x32_bf16 v[68:71],a[20:23],v[244:247],v[68:71]
v_add_f32 v89,v65,v89
v_add_f32 v90,v66,v90
v_mfma_f32_16x16x32_bf16 v[76:79],a[148:151],v[244:247],v[76:79]
ds_read_b128 v[240:243],v17 offset:25600
s_waitcnt lgkmcnt(5)
v_mfma_f32_16x16x32_bf16 v[68:71],a[24:27],v[248:251],v[68:71]
v_min3_u32 v27,v27,v248,v252
v_add_f32 v91,v67,v91
v_mfma_f32_16x16x32_bf16 v[76:79],a[152:155],v[248:251],v[76:79]
ds_read_b128 v[244:247],v17 offset:27648
v_add_f32 v92,v72,v92
v_mfma_f32_16x16x32_bf16 v[68:71],a[28:31],v[252:255],v[68:71]
v_add_f32 v93,v73,v93
v_add_f32 v94,v74,v94
v_mfma_f32_16x16x32_bf16 v[76:79],a[156:159],v[252:255],v[76:79]
ds_read_b128 v[248:251],v17 offset:29696
s_waitcnt lgkmcnt(5)
v_mfma_f32_16x16x32_bf16 v[68:71],a[32:35],v[224:227],v[68:71]
v_min3_u32 v27,v27,v224,v228
v_add_f32 v95,v75,v95
v_mfma_f32_16x16x32_bf16 v[76:79],a[160:163],v[224:227],v[76:79]
ds_read_b128 v[252:255],v17 offset:31744
v_cvt_pk_bf16_f32 v96,v88,v89
v_mfma_f32_16x16x32_bf16 v[68:71],a[36:39],v[228:231],v[68:71]
v_cvt_pk_bf16_f32 v97,v90,v91
v_cvt_pk_bf16_f32 v98,v92,v93
v_mfma_f32_16x16x32_bf16 v[76:79],a[164:167],v[228:231],v[76:79]
ds_read_b128 v[224:227],v17 offset:33792
s_waitcnt lgkmcnt(5)
v_mfma_f32_16x16x32_bf16 v[68:71],a[40:43],v[232:235],v[68:71]
v_min3_u32 v27,v27,v232,v236
v_cvt_pk_bf16_f32 v99,v94,v95
v_mfma_f32_16x16x32_bf16 v[76:79],a[168:171],v[232:235],v[76:79]
ds_read_b128 v[228:231],v17 offset:35840
v_max_u32 v96,1,v96
v_mfma_f32_16x16x32_bf16 v[68:71],a[44:47],v[236:239],v[68:71]
buffer_store_dwordx4 v[96:99],v18,s[20:23],s70 offen offset:0 sc1
v_mfma_f32_16x16x32_bf16 v[76:79],a[172:175],v[236:239],v[76:79]
ds_read_b128 v[232:235],v17 offset:37888
s_waitcnt lgkmcnt(5)
v_mfma_f32_16x16x32_bf16 v[68:71],a[48:51],v[240:243],v[68:71]
v_min3_u32 v27,v27,v240,v244
v_lshlrev_b32 v88,16,v96
v_mfma_f32_16x16x32_bf16 v[76:79],a[176:179],v[240:243],v[76:79]
ds_read_b128 v[236:239],v17 offset:39936
v_and_b32 v89,s80,v96
v_mfma_f32_16x16x32_bf16 v[68:71],a[52:55],v[244:247],v[68:71]
v_lshlrev_b32 v90,16,v97
v_and_b32 v91,s80,v97
v_mfma_f32_16x16x32_bf16 v[76:79],a[180:183],v[244:247],v[76:79]
ds_read_b128 v[240:243],v17 offset:41984
s_waitcnt lgkmcnt(5)
v_mfma_f32_16x16x32_bf16 v[68:71],a[56:59],v[248:251],v[68:71]
v_min3_u32 v27,v27,v248,v252
v_lshlrev_b32 v92,16,v98
v_mfma_f32_16x16x32_bf16 v[76:79],a[184:187],v[248:251],v[76:79]
ds_read_b128 v[244:247],v17 offset:44032
v_and_b32 v93,s80,v98
v_mfma_f32_16x16x32_bf16 v[68:71],a[60:63],v[252:255],v[68:71]
v_lshlrev_b32 v94,16,v99
v_and_b32 v95,s80,v99
v_mfma_f32_16x16x32_bf16 v[76:79],a[188:191],v[252:255],v[76:79]
ds_read_b128 v[248:251],v17 offset:46080
s_waitcnt lgkmcnt(5)
v_mfma_f32_16x16x32_bf16 v[68:71],a[64:67],v[224:227],v[68:71]
v_min3_u32 v27,v27,v224,v228
v_add_f32 v108,v88,v89
v_mfma_f32_16x16x32_bf16 v[76:79],a[192:195],v[224:227],v[76:79]
ds_read_b128 v[252:255],v17 offset:48128
v_mul_f32 v109,v88,v88
v_mfma_f32_16x16x32_bf16 v[68:71],a[68:71],v[228:231],v[68:71]
v_add_f32 v100,v90,v91
v_mul_f32 v101,v89,v89
v_mfma_f32_16x16x32_bf16 v[76:79],a[196:199],v[228:231],v[76:79]
ds_read_b128 v[224:227],v17 offset:50176
s_waitcnt lgkmcnt(5)
v_mfma_f32_16x16x32_bf16 v[68:71],a[72:75],v[232:235],v[68:71]
v_min3_u32 v27,v27,v232,v236
v_fmac_f32 v109,v90,v90
v_mfma_f32_16x16x32_bf16 v[76:79],a[200:203],v[232:235],v[76:79]
ds_read_b128 v[228:231],v17 offset:52224
v_fmac_f32 v101,v91,v91
v_mfma_f32_16x16x32_bf16 v[68:71],a[76:79],v[236:239],v[68:71]
v_fmac_f32 v109,v92,v92
v_fmac_f32 v101,v93,v93
v_mfma_f32_16x16x32_bf16 v[76:79],a[204:207],v[236:239],v[76:79]
ds_read_b128 v[232:235],v17 offset:54272
s_waitcnt lgkmcnt(5)
v_mfma_f32_16x16x32_bf16 v[68:71],a[80:83],v[240:243],v[68:71]
v_min3_u32 v27,v27,v240,v244
v_add_f32 v108,v108,v92
v_mfma_f32_16x16x32_bf16 v[76:79],a[208:211],v[240:243],v[76:79]
ds_read_b128 v[236:239],v17 offset:56320
v_add_f32 v100,v100,v93
v_mfma_f32_16x16x32_bf16 v[68:71],a[84:87],v[244:247],v[68:71]
v_fmac_f32 v109,v94,v94
v_fmac_f32 v101,v95,v95
v_mfma_f32_16x16x32_bf16 v[76:79],a[212:215],v[244:247],v[76:79]
ds_read_b128 v[240:243],v17 offset:58368
s_waitcnt lgkmcnt(5)
v_mfma_f32_16x16x32_bf16 v[68:71],a[88:91],v[248:251],v[68:71]
v_min3_u32 v27,v27,v248,v252
v_add_f32 v108,v108,v94
v_mfma_f32_16x16x32_bf16 v[76:79],a[216:219],v[248:251],v[76:79]
ds_read_b128 v[244:247],v17 offset:60416
v_add_f32 v100,v100,v95
v_mfma_f32_16x16x32_bf16 v[68:71],a[92:95],v[252:255],v[68:71]
v_add_f32 v108,v108,v100
v_add_f32 v109,v109,v101
v_mfma_f32_16x16x32_bf16 v[76:79],a[220:223],v[252:255],v[76:79]
ds_read_b128 v[248:251],v17 offset:62464
s_waitcnt lgkmcnt(5)
v_mfma_f32_16x16x32_bf16 v[68:71],a[96:99],v[224:227],v[68:71]
v_min3_u32 v27,v27,v224,v228
v_mov_b32 v100,v108
v_mfma_f32_16x16x32_bf16 v[76:79],a[224:227],v[224:227],v[76:79]
ds_read_b128 v[252:255],v17 offset:64512
v_mov_b32 v101,v109
v_mfma_f32_16x16x32_bf16 v[68:71],a[100:103],v[228:231],v[68:71]
v_permlane16_swap_b32 v100,v108
v_permlane16_swap_b32 v101,v109
v_mfma_f32_16x16x32_bf16 v[76:79],a[228:231],v[228:231],v[76:79]
v_add_f32 v108,v108,v100
s_waitcnt lgkmcnt(4)
v_mfma_f32_16x16x32_bf16 v[68:71],a[104:107],v[232:235],v[68:71]
v_min3_u32 v27,v27,v232,v236
v_add_f32 v109,v109,v101
v_mfma_f32_16x16x32_bf16 v[76:79],a[232:235],v[232:235],v[76:79]
v_mov_b32 v100,v108
v_mov_b32 v101,v109
v_mfma_f32_16x16x32_bf16 v[68:71],a[108:111],v[236:239],v[68:71]
v_permlane32_swap_b32 v100,v108
v_permlane32_swap_b32 v101,v109
v_mfma_f32_16x16x32_bf16 v[76:79],a[236:239],v[236:239],v[76:79]
v_add_f32 v108,v108,v100
s_waitcnt lgkmcnt(2)
v_mfma_f32_16x16x32_bf16 v[68:71],a[112:115],v[240:243],v[68:71]
v_min3_u32 v27,v27,v240,v244
v_add_f32 v109,v109,v101
v_mfma_f32_16x16x32_bf16 v[76:79],a[240:243],v[240:243],v[76:79]
v_min3_u32 v27,v27,v120,v122
v_min3_u32 v27,v27,v124,v126
v_mfma_f32_16x16x32_bf16 v[68:71],a[116:119],v[244:247],v[68:71]
v_lshlrev_b32 v32,16,v124
v_and_b32 v33,s80,v124
v_mfma_f32_16x16x32_bf16 v[76:79],a[244:247],v[244:247],v[76:79]
v_lshlrev_b32 v34,16,v125
s_waitcnt lgkmcnt(0)
v_mfma_f32_16x16x32_bf16 v[68:71],a[120:123],v[248:251],v[68:71]
v_min3_u32 v27,v27,v248,v252
v_and_b32 v35,s80,v125
v_mfma_f32_16x16x32_bf16 v[76:79],a[248:251],v[248:251],v[76:79]
v_lshlrev_b32 v36,16,v126
v_and_b32 v37,s80,v126
v_mfma_f32_16x16x32_bf16 v[68:71],a[124:127],v[252:255],v[68:71]
v_lshlrev_b32 v38,16,v127
v_and_b32 v39,s80,v127
v_mfma_f32_16x16x32_bf16 v[76:79],a[252:255],v[252:255],v[76:79]
v_cmp_eq_u32 vcc,0,v27
s_cbranch_vccnz retry_239
epi_242:
buffer_load_dword v29,v21,s[20:23],s87 offen sc1
s_cmp_gt_u32 s71,40
s_cselect_b32 s65,s73,0x7fff0000
s_cselect_b32 s97,0x7fff0000,s73
v_mov_b32 v22,s71
buffer_store_dword v22,v23,s[20:23],s65 offen sc1
v_pk_add_f32 v[88:89],v[68:69],v[32:33]
v_pk_add_f32 v[90:91],v[70:71],v[34:35]
v_pk_add_f32 v[92:93],v[76:77],v[36:37]
v_pk_add_f32 v[94:95],v[78:79],v[38:39]
v_cvt_pk_bf16_f32 v96,v88,v89
v_cvt_pk_bf16_f32 v97,v90,v91
v_cvt_pk_bf16_f32 v98,v92,v93
v_cvt_pk_bf16_f32 v99,v94,v95
v_max_u32 v96,1,v96
buffer_store_dwordx4 v[96:99],v18,s[20:23],s70 offen offset:1024 sc1
v_lshlrev_b32 v88,16,v96
v_and_b32 v89,s80,v96
v_lshlrev_b32 v90,16,v97
v_and_b32 v91,s80,v97
v_lshlrev_b32 v92,16,v98
v_and_b32 v93,s80,v98
v_lshlrev_b32 v94,16,v99
v_and_b32 v95,s80,v99
v_pk_mul_f32 v[102:103],v[88:89],v[88:89]
v_pk_add_f32 v[100:101],v[88:89],v[90:91]
v_pk_mul_f32 v[106:107],v[90:91],v[90:91]
v_pk_add_f32 v[104:105],v[92:93],v[94:95]
v_pk_fma_f32 v[102:103],v[92:93],v[92:93],v[102:103]
v_pk_fma_f32 v[106:107],v[94:95],v[94:95],v[106:107]
v_pk_add_f32 v[100:101],v[100:101],v[104:105]
v_pk_add_f32 v[102:103],v[102:103],v[106:107]
v_add_f32 v110,v100,v101
v_add_f32 v111,v102,v103
v_mov_b32 v100,v110
v_mov_b32 v101,v111
s_nop 0
v_permlane16_swap_b32 v100,v110
v_permlane16_swap_b32 v101,v111
v_add_f32 v110,v110,v100
v_add_f32 v111,v111,v101
v_mov_b32 v100,v110
v_mov_b32 v101,v111
s_nop 0
v_permlane32_swap_b32 v100,v110
v_permlane32_swap_b32 v101,v111
v_add_f32 v110,v110,v100
v_add_f32 v111,v111,v101
v_max_u32 v109,1,v109
buffer_store_dwordx4 v[108:111],v24,s[20:23],s70 offen sc1
s_cmp_eq_u32 s71,63
s_cselect_b32 s64,0,0x2000
s_cselect_b32 s66,2,1
s_lshl_b32 s66,s66,21
s_add_u32 s78,s78,s66
v_xor_b32 v19,s64,v19
v_xor_b32 v20,s64,v20
next_249:
v_xor_b32 v17,0x10000,v17
s_xor_b32 s72,s72,0x10000
s_add_u32 s70,s70,2097152
s_xor_b32 s70,s70,0x2000
s_add_u32 s71,s71,1
s_cmp_le_u32 s71,s57
s_cbranch_scc1 seg_240
s_endpgm
retry_239:
s_sub_u32 s90,s90,64
s_cmp_lt_i32 s90,0
s_cbranch_scc1 giveup_197
s_mov_b32 s83,1
s_waitcnt vmcnt(0) lgkmcnt(0)
s_barrier
s_branch seg_240
half_248:
s_mov_b32 s88,s94
s_mov_b32 s89,s95
s_add_u32 s94,s94,2097152
s_xor_b32 s94,s94,0x2000
s_xor_b32 s95,s94,1024
s_mov_b64 exec,s[52:53]
s_xor_b32 m0,s91,0
s_add_u32 s65,s94,0
buffer_load_dwordx4 v16,s[20:23],s65 offen offset:0 sc1 lds
buffer_load_dwordx4 v16,s[20:23],s65 offen offset:2048 sc1 lds
s_xor_b32 m0,s91,16384
s_add_u32 s65,s94,32768
buffer_load_dwordx4 v16,s[20:23],s65 offen offset:0 sc1 lds
buffer_load_dwordx4 v16,s[20:23],s65 offen offset:2048 sc1 lds
s_xor_b32 m0,s91,32768
s_add_u32 s65,s94,65536
buffer_load_dwordx4 v16,s[20:23],s65 offen offset:0 sc1 lds
buffer_load_dwordx4 v16,s[20:23],s65 offen offset:2048 sc1 lds
s_xor_b32 m0,s91,49152
s_add_u32 s65,s94,98304
buffer_load_dwordx4 v16,s[20:23],s65 offen offset:0 sc1 lds
buffer_load_dwordx4 v16,s[20:23],s65 offen offset:2048 sc1 lds
s_mov_b64 exec,-1
s_add_u32 m0,s43,0
s_nop 0
buffer_load_dwordx4 v19,s[20:23],s78 offen sc1 lds
s_waitcnt vmcnt(9)
v_add_u32 v22,s71,-1
buffer_store_dword v22,v23,s[20:23],s97 offen sc1
s_mov_b32 s97,0x7fff0000
half2_245:
s_waitcnt vmcnt(8)
s_barrier
ds_read_b128 v[224:227],v17 offset:0
ds_read_b128 v[228:231],v17 offset:2048
ds_read_b128 v[232:235],v17 offset:4096
ds_read_b128 v[236:239],v17 offset:6144
ds_read_b128 v[240:243],v17 offset:8192
ds_read_b128 v[244:247],v17 offset:10240
ds_read_b128 v[248:251],v17 offset:12288
s_waitcnt lgkmcnt(5)
v_mfma_f32_16x16x32_bf16 v[64:67],a[0:3],v[224:227],0
s_xor_b32 m0,s72,0
v_min_u32 v27,v224,v228
v_mfma_f32_16x16x32_bf16 v[72:75],a[128:131],v[224:227],0
ds_read_b128 v[252:255],v17 offset:14336
s_add_u32 s65,s88,0
v_mfma_f32_16x16x32_bf16 v[64:67],a[4:7],v[228:231],v[64:67]
buffer_load_dwordx4 v16,s[20:23],s65 offen offset:0 sc1 lds
v_mfma_f32_16x16x32_bf16 v[72:75],a[132:135],v[228:231],v[72:75]
s_waitcnt vmcnt(7)
s_barrier
ds_read_b128 v[224:227],v17 offset:16384
s_waitcnt lgkmcnt(5)
v_mfma_f32_16x16x32_bf16 v[64:67],a[8:11],v[232:235],v[64:67]
buffer_load_dwordx4 v16,s[20:23],s65 offen offset:2048 sc1 lds
v_mfma_f32_16x16x32_bf16 v[72:75],a[136:139],v[232:235],v[72:75]
ds_read_b128 v[228:231],v17 offset:18432
s_xor_b32 m0,s72,16384
v_mfma_f32_16x16x32_bf16 v[64:67],a[12:15],v[236:239],v[64:67]
s_add_u32 s65,s88,32768
v_min3_u32 v27,v27,v232,v236
v_mfma_f32_16x16x32_bf16 v[72:75],a[140:143],v[236:239],v[72:75]
ds_read_b128 v[232:235],v17 offset:20480
s_waitcnt lgkmcnt(5)
v_mfma_f32_16x16x32_bf16 v[64:67],a[16:19],v[240:243],v[64:67]
buffer_load_dwordx4 v16,s[20:23],s65 offen offset:0 sc1 lds
v_mfma_f32_16x16x32_bf16 v[72:75],a[144:147],v[240:243],v[72:75]
ds_read_b128 v[236:239],v17 offset:22528
buffer_load_dwordx4 v16,s[20:23],s65 offen offset:2048 sc1 lds
v_mfma_f32_16x16x32_bf16 v[64:67],a[20:23],v[244:247],v[64:67]
s_xor_b32 m0,s72,32768
v_min3_u32 v27,v27,v240,v244
v_mfma_f32_16x16x32_bf16 v[72:75],a[148:151],v[244:247],v[72:75]
ds_read_b128 v[240:243],v17 offset:24576
s_add_u32 s65,s88,65536
s_waitcnt lgkmcnt(5)
v_mfma_f32_16x16x32_bf16 v[64:67],a[24:27],v[248:251],v[64:67]
buffer_load_dwordx4 v16,s[20:23],s65 offen offset:0 sc1 lds
v_mfma_f32_16x16x32_bf16 v[72:75],a[152:155],v[248:251],v[72:75]
ds_read_b128 v[244:247],v17 offset:26624
buffer_load_dwordx4 v16,s[20:23],s65 offen offset:2048 sc1 lds
v_mfma_f32_16x16x32_bf16 v[64:67],a[28:31],v[252:255],v[64:67]
v_min3_u32 v27,v27,v248,v252
v_mfma_f32_16x16x32_bf16 v[72:75],a[156:159],v[252:255],v[72:75]
ds_read_b128 v[248:251],v17 offset:28672
s_xor_b32 m0,s72,49152
s_waitcnt lgkmcnt(5)
v_mfma_f32_16x16x32_bf16 v[64:67],a[32:35],v[224:227],v[64:67]
s_add_u32 s65,s88,98304
v_min3_u32 v27,v27,v224,v228
v_mfma_f32_16x16x32_bf16 v[72:75],a[160:163],v[224:227],v[72:75]
ds_read_b128 v[252:255],v17 offset:30720
buffer_load_dwordx4 v16,s[20:23],s65 offen offset:0 sc1 lds
v_mfma_f32_16x16x32_bf16 v[64:67],a[36:39],v[228:231],v[64:67]
buffer_load_dwordx4 v16,s[20:23],s65 offen offset:2048 sc1 lds
v_mfma_f32_16x16x32_bf16 v[72:75],a[164:167],v[228:231],v[72:75]
s_waitcnt vmcnt(10)
s_barrier
ds_read_b128 v[224:227],v17 offset:32768
s_waitcnt lgkmcnt(5)
v_mfma_f32_16x16x32_bf16 v[64:67],a[40:43],v[232:235],v[64:67]
s_xor_b32 m0,s72,1024
v_min3_u32 v27,v27,v232,v236
v_mfma_f32_16x16x32_bf16 v[72:75],a[168:171],v[232:235],v[72:75]
ds_read_b128 v[228:231],v17 offset:34816
s_add_u32 s65,s89,0
v_mfma_f32_16x16x32_bf16 v[64:67],a[44:47],v[236:239],v[64:67]
buffer_load_dwordx4 v16,s[20:23],s65 offen offset:0 sc1 lds
v_mfma_f32_16x16x32_bf16 v[72:75],a[172:175],v[236:239],v[72:75]
ds_read_b128 v[232:235],v17 offset:36864
s_waitcnt lgkmcnt(5)
v_mfma_f32_16x16x32_bf16 v[64:67],a[48:51],v[240:243],v[64:67]
buffer_load_dwordx4 v16,s[20:23],s65 offen offset:2048 sc1 lds
v_mfma_f32_16x16x32_bf16 v[72:75],a[176:179],v[240:243],v[72:75]
ds_read_b128 v[236:239],v17 offset:38912
s_xor_b32 m0,s72,17408
v_mfma_f32_16x16x32_bf16 v[64:67],a[52:55],v[244:247],v[64:67]
s_add_u32 s65,s89,32768
v_min3_u32 v27,v27,v240,v244
v_mfma_f32_16x16x32_bf16 v[72:75],a[180:183],v[244:247],v[72:75]
ds_read_b128 v[240:243],v17 offset:40960
s_waitcnt lgkmcnt(5)
v_mfma_f32_16x16x32_bf16 v[64:67],a[56:59],v[248:251],v[64:67]
buffer_load_dwordx4 v16,s[20:23],s65 offen offset:0 sc1 lds
v_mfma_f32_16x16x32_bf16 v[72:75],a[184:187],v[248:251],v[72:75]
ds_read_b128 v[244:247],v17 offset:43008
v_min3_u32 v27,v27,v248,v252
v_mfma_f32_16x16x32_bf16 v[64:67],a[60:63],v[252:255],v[64:67]
buffer_load_dwordx4 v16,s[20:23],s65 offen offset:2048 sc1 lds
v_mfma_f32_16x16x32_bf16 v[72:75],a[188:191],v[252:255],v[72:75]
ds_read_b128 v[248:251],v17 offset:45056
s_waitcnt lgkmcnt(5)
v_mfma_f32_16x16x32_bf16 v[64:67],a[64:67],v[224:227],v[64:67]
s_xor_b32 m0,s72,33792
s_add_u32 s65,s89,65536
v_mfma_f32_16x16x32_bf16 v[72:75],a[192:195],v[224:227],v[72:75]
ds_read_b128 v[252:255],v17 offset:47104
v_min3_u32 v27,v27,v224,v228
v_mfma_f32_16x16x32_bf16 v[64:67],a[68:71],v[228:231],v[64:67]
buffer_load_dwordx4 v16,s[20:23],s65 offen offset:0 sc1 lds
v_mfma_f32_16x16x32_bf16 v[72:75],a[196:199],v[228:231],v[72:75]
ds_read_b128 v[224:227],v17 offset:49152
s_waitcnt lgkmcnt(5)
v_mfma_f32_16x16x32_bf16 v[64:67],a[72:75],v[232:235],v[64:67]
buffer_load_dwordx4 v16,s[20:23],s65 offen offset:2048 sc1 lds
v_mfma_f32_16x16x32_bf16 v[72:75],a[200:203],v[232:235],v[72:75]
ds_read_b128 v[228:231],v17 offset:51200
s_xor_b32 m0,s72,50176
v_mfma_f32_16x16x32_bf16 v[64:67],a[76:79],v[236:239],v[64:67]
s_add_u32 s65,s89,98304
v_min3_u32 v27,v27,v232,v236
v_mfma_f32_16x16x32_bf16 v[72:75],a[204:207],v[236:239],v[72:75]
ds_read_b128 v[232:235],v17 offset:53248
s_waitcnt lgkmcnt(5)
v_mfma_f32_16x16x32_bf16 v[64:67],a[80:83],v[240:243],v[64:67]
buffer_load_dwordx4 v16,s[20:23],s65 offen offset:0 sc1 lds
v_mfma_f32_16x16x32_bf16 v[72:75],a[208:211],v[240:243],v[72:75]
ds_read_b128 v[236:239],v17 offset:55296
v_min3_u32 v27,v27,v240,v244
v_mfma_f32_16x16x32_bf16 v[64:67],a[84:87],v[244:247],v[64:67]
buffer_load_dwordx4 v16,s[20:23],s65 offen offset:2048 sc1 lds
v_mfma_f32_16x16x32_bf16 v[72:75],a[212:215],v[244:247],v[72:75]
ds_read_b128 v[240:243],v17 offset:57344
s_waitcnt lgkmcnt(5)
v_mfma_f32_16x16x32_bf16 v[64:67],a[88:91],v[248:251],v[64:67]
v_min3_u32 v27,v27,v248,v252
v_mfma_f32_16x16x32_bf16 v[72:75],a[216:219],v[248:251],v[72:75]
ds_read_b128 v[244:247],v17 offset:59392
v_mfma_f32_16x16x32_bf16 v[64:67],a[92:95],v[252:255],v[64:67]
v_mfma_f32_16x16x32_bf16 v[72:75],a[220:223],v[252:255],v[72:75]
ds_read_b128 v[248:251],v17 offset:61440
s_waitcnt lgkmcnt(5)
v_mfma_f32_16x16x32_bf16 v[64:67],a[96:99],v[224:227],v[64:67]
v_min3_u32 v27,v27,v224,v228
v_mfma_f32_16x16x32_bf16 v[72:75],a[224:227],v[224:227],v[72:75]
ds_read_b128 v[252:255],v17 offset:63488
v_mfma_f32_16x16x32_bf16 v[64:67],a[100:103],v[228:231],v[64:67]
v_mfma_f32_16x16x32_bf16 v[72:75],a[228:231],v[228:231],v[72:75]
s_waitcnt lgkmcnt(4)
v_mfma_f32_16x16x32_bf16 v[64:67],a[104:107],v[232:235],v[64:67]
v_min3_u32 v27,v27,v232,v236
s_waitcnt vmcnt(17)
v_mfma_f32_16x16x32_bf16 v[72:75],a[232:235],v[232:235],v[72:75]
ds_read_b64 v[120:121],v40
ds_read_b64 v[122:123],v41
v_mfma_f32_16x16x32_bf16 v[64:67],a[108:111],v[236:239],v[64:67]
v_mfma_f32_16x16x32_bf16 v[72:75],a[236:239],v[236:239],v[72:75]
s_waitcnt lgkmcnt(4)
v_mfma_f32_16x16x32_bf16 v[64:67],a[112:115],v[240:243],v[64:67]
v_min3_u32 v27,v27,v240,v244
v_mfma_f32_16x16x32_bf16 v[72:75],a[240:243],v[240:243],v[72:75]
v_mfma_f32_16x16x32_bf16 v[64:67],a[116:119],v[244:247],v[64:67]
v_mfma_f32_16x16x32_bf16 v[72:75],a[244:247],v[244:247],v[72:75]
s_waitcnt lgkmcnt(2)
v_mfma_f32_16x16x32_bf16 v[64:67],a[120:123],v[248:251],v[64:67]
v_min3_u32 v27,v27,v248,v252
v_mfma_f32_16x16x32_bf16 v[72:75],a[248:251],v[248:251],v[72:75]
v_mfma_f32_16x16x32_bf16 v[64:67],a[124:127],v[252:255],v[64:67]
v_mfma_f32_16x16x32_bf16 v[72:75],a[252:255],v[252:255],v[72:75]
s_waitcnt lgkmcnt(0)
v_min3_u32 v27,v27,v120,v122
v_cmp_eq_u32 vcc,0,v27
s_and_b64 vcc,vcc,s[52:53]
s_cbranch_vccnz retry_239
v_mov_b32 v22,s71
buffer_store_dword v22,v23,s[20:23],s73 offen sc1
v_lshlrev_b32 v88,16,v120
v_and_b32 v89,s80,v120
v_lshlrev_b32 v90,16,v121
v_and_b32 v91,s80,v121
v_lshlrev_b32 v92,16,v122
v_and_b32 v93,s80,v122
v_lshlrev_b32 v94,16,v123
v_and_b32 v95,s80,v123
v_add_f32 v88,v64,v88
v_add_f32 v89,v65,v89
v_add_f32 v90,v66,v90
v_add_f32 v91,v67,v91
v_add_f32 v92,v72,v92
v_add_f32 v93,v73,v93
v_add_f32 v94,v74,v94
v_add_f32 v95,v75,v95
v_cvt_pk_bf16_f32 v96,v88,v89
v_cvt_pk_bf16_f32 v97,v90,v91
v_cvt_pk_bf16_f32 v98,v92,v93
v_cvt_pk_bf16_f32 v99,v94,v95
v_max_u32 v96,1,v96
buffer_store_dwordx4 v[96:99],v18,s[20:23],s70 offen offset:0 sc1
v_lshlrev_b32 v88,16,v96
v_and_b32 v89,s80,v96
v_lshlrev_b32 v90,16,v97
v_and_b32 v91,s80,v97
v_lshlrev_b32 v92,16,v98
v_and_b32 v93,s80,v98
v_lshlrev_b32 v94,16,v99
v_and_b32 v95,s80,v99
v_add_f32 v108,v88,v89
v_mul_f32 v109,v88,v88
v_add_f32 v100,v90,v91
v_mul_f32 v101,v89,v89
v_fmac_f32 v109,v90,v90
v_fmac_f32 v101,v91,v91
v_fmac_f32 v109,v92,v92
v_fmac_f32 v101,v93,v93
v_add_f32 v108,v108,v92
v_add_f32 v100,v100,v93
v_fmac_f32 v109,v94,v94
v_fmac_f32 v101,v95,v95
v_add_f32 v108,v108,v94
v_add_f32 v100,v100,v95
v_add_f32 v108,v108,v100
v_add_f32 v109,v109,v101
v_mov_b32 v100,v108
v_mov_b32 v101,v109
s_nop 0
v_permlane16_swap_b32 v100,v108
v_permlane16_swap_b32 v101,v109
v_add_f32 v108,v108,v100
v_add_f32 v109,v109,v101
v_mov_b32 v100,v108
v_mov_b32 v101,v109
s_nop 0
v_permlane32_swap_b32 v100,v108
v_permlane32_swap_b32 v101,v109
v_add_f32 v108,v108,v100
v_add_f32 v109,v109,v101
v_max_u32 v109,1,v109
buffer_store_dwordx4 v[108:111],v24,s[20:23],s70 offen sc1
v_xor_b32 v19,0x2000,v19
v_xor_b32 v20,0x2000,v20
s_sub_u32 s78,s78,2097152
v_mov_b32 v29,0
s_mov_b32 s83,0
s_mov_b32 s93,1
s_waitcnt vmcnt(3)
s_branch next_249
r_at_219:
v_mov_b32 v128,0
v_mov_b32 v129,0
v_mov_b32 v130,0
v_mov_b32 v131,0
s_cmp_ge_u32 s50,2
s_cbranch_scc1 r_ln_218
v_and_b32 v21,1,v1
v_mul_u32_u24 v21,64,v21
s_mov_b32 s65,21052928
s_mov_b32 s66,1792
pl_254:
buffer_load_dword v22,v21,s[20:23],s65 offen sc1
s_waitcnt vmcnt(0)
v_cmp_gt_u32 vcc,s66,v22
s_cbranch_vccz pok_255
s_sleep 1
s_sub_u32 s90,s90,1
s_cmp_gt_i32 s90,0
s_cbranch_scc1 pl_254
pok_255:
s_lshl_b32 s41,s41,1
s_add_u32 s41,s41,s50
v_and_b32 v21,3,v1
v_lshlrev_b32 v21,7,v21
s_lshl_b32 s65,s41,2
s_add_u32 s87,s65,s63
v_mov_b32 v99,v21
pl_256:
buffer_load_dword v22,v21,s[20:23],s87 offen sc1
s_waitcnt vmcnt(0)
v_cmp_gt_u32 vcc,14,v22
s_cbranch_vccz pok_257
s_sleep 1
s_sub_u32 s90,s90,1
s_cmp_gt_i32 s90,0
s_cbranch_scc1 pl_256
pok_257:
v_mov_b32 v21,s56
v_lshlrev_b32 v21,2,v21
s_mov_b32 s66,128
pl_258:
buffer_load_dword v22,v21,s[44:47],36 offen sc1
s_waitcnt vmcnt(0)
v_cmp_gt_u32 vcc,s66,v22
s_cbranch_vccz pok_259
s_sleep 1
s_sub_u32 s90,s90,1
s_cmp_gt_i32 s90,0
s_cbranch_scc1 pl_258
pok_259:
s_lshl_b32 s42,s41,14
s_lshr_b32 s43,s41,1
s_lshl_b32 s43,s43,14
s_and_b32 s64,s41,1
s_lshl_b32 s64,s64,12
s_add_u32 s43,s43,s64
s_add_u32 s43,s43,1572864
s_lshl_b32 s73,s41,7
s_add_u32 s73,s73,s63
s_add_u32 s73,s73,16384
v_lshrrev_b32 v6,3,v3
v_and_b32 v7,7,v3
v_lshl_add_u32 v6,v6,4,v7
v_lshlrev_b32 v6,4,v6
v_and_b32 v7,1,v4
v_lshl_add_u32 v6,v7,3,v6
v_lshrrev_b32 v8,2,v3
v_and_b32 v9,3,v3
v_lshl_add_u32 v8,v8,3,v9
s_mov_b32 s80,0x3e0293ee
v_mov_b32 v97,0xff800000
v_lshlrev_b32 v96,10,v1
v_lshlrev_b32 v98,3,v4
v_sub_u32 v98,v98,v8
v_cmp_lt_u32 s[48:49],1,v4
v_cmp_ge_i32 s[4:5],-7,v98
v_cmp_ge_i32 s[6:7],-6,v98
v_cmp_ge_i32 s[8:9],-5,v98
v_cmp_ge_i32 s[10:11],-4,v98
v_cmp_ge_i32 s[12:13],-3,v98
v_cmp_ge_i32 s[14:15],-2,v98
v_cmp_ge_i32 s[16:17],-1,v98
v_cmp_ge_i32 s[18:19],0,v98
v_cmp_ge_i32 s[32:33],1,v98
v_cmp_ge_i32 s[34:35],2,v98
v_cmp_ge_i32 s[36:37],3,v98
v_cmp_ge_i32 s[38:39],4,v98
s_add_u32 s64,s79,0
s_lshl_b32 s74,s64,21
s_lshl_b32 s64,s64,13
s_and_b32 s64,s64,0x2000
s_xor_b32 s64,s64,s61
s_add_u32 s74,s74,s64
s_add_u32 s74,s74,29360128
s_lshl_b32 s64,s50,2
s_add_u32 s64,s64,147456
v_mov_b32 v95,s64
ds_write_b32 v95,v128
s_add_u32 s66,s74,s43
kp_260:
s_add_u32 s78,s78,2
buffer_load_dwordx4 v[136:139],v16,s[20:23],s66 offen offset:0 sc1
buffer_load_dwordx4 v[140:143],v16,s[20:23],s66 offen offset:1024 sc1
buffer_load_dwordx4 v[144:147],v16,s[20:23],s66 offen offset:2048 sc1
buffer_load_dwordx4 v[148:151],v16,s[20:23],s66 offen offset:3072 sc1
s_waitcnt vmcnt(0)
kck_262:
v_min3_u32 v22,v136,v140,v144
v_min_u32 v22,v22,v148
v_cmp_eq_u32 vcc,0,v22
s_cbranch_vccz kok_261
s_sleep 1
s_sub_u32 s90,s90,1
s_cmp_gt_i32 s90,0
s_cbranch_scc1 kp_260
kok_261:
s_mov_b32 s78,0
s_add_u32 s64,s79,0
s_lshl_b32 s75,s64,21
s_lshl_b32 s64,s64,13
s_and_b32 s64,s64,0x2000
s_xor_b32 s64,s64,s61
s_add_u32 s75,s75,s64
s_add_u32 s75,s75,29360128
s_add_u32 s64,s79,0
s_lshl_b32 s76,s64,21
s_lshl_b32 s64,s64,13
s_and_b32 s64,s64,0x2000
s_xor_b32 s64,s64,s62
s_add_u32 s76,s76,s64
s_add_u32 s76,s76,29360128
s_add_u32 s77,s75,s43
s_add_u32 s75,s75,s42
s_add_u32 s76,s76,s42
s_add_u32 s65,s75,524288
buffer_load_dwordx4 a[32:35],v16,s[20:23],s65 offen offset:0 sc1
buffer_load_dwordx4 a[36:39],v16,s[20:23],s65 offen offset:1024 sc1
buffer_load_dwordx4 a[40:43],v16,s[20:23],s65 offen offset:2048 sc1
buffer_load_dwordx4 a[44:47],v16,s[20:23],s65 offen offset:3072 sc1
s_add_u32 s65,s75,528384
buffer_load_dwordx4 a[48:51],v16,s[20:23],s65 offen offset:0 sc1
buffer_load_dwordx4 a[52:55],v16,s[20:23],s65 offen offset:1024 sc1
buffer_load_dwordx4 a[56:59],v16,s[20:23],s65 offen offset:2048 sc1
buffer_load_dwordx4 a[60:63],v16,s[20:23],s65 offen offset:3072 sc1
s_add_u32 s65,s76,0
buffer_load_dwordx4 a[0:3],v16,s[20:23],s65 offen offset:0 sc1
buffer_load_dwordx4 a[4:7],v16,s[20:23],s65 offen offset:1024 sc1
buffer_load_dwordx4 a[8:11],v16,s[20:23],s65 offen offset:2048 sc1
buffer_load_dwordx4 a[12:15],v16,s[20:23],s65 offen offset:3072 sc1
s_add_u32 s65,s76,4096
buffer_load_dwordx4 a[16:19],v16,s[20:23],s65 offen offset:0 sc1
buffer_load_dwordx4 a[20:23],v16,s[20:23],s65 offen offset:1024 sc1
buffer_load_dwordx4 a[24:27],v16,s[20:23],s65 offen offset:2048 sc1
buffer_load_dwordx4 a[28:31],v16,s[20:23],s65 offen offset:3072 sc1
s_cmp_lt_u32 s79,58
s_cselect_b32 s78,s78,0
s_cmp_lg_u32 s78,0
s_cselect_b32 s66,0x7fff0000,s77
buffer_load_dwordx4 v[136:139],v16,s[20:23],s66 offen offset:0 sc1
buffer_load_dwordx4 v[140:143],v16,s[20:23],s66 offen offset:1024 sc1
buffer_load_dwordx4 v[144:147],v16,s[20:23],s66 offen offset:2048 sc1
buffer_load_dwordx4 v[148:151],v16,s[20:23],s66 offen offset:3072 sc1
s_add_u32 s65,s75,1048576
buffer_load_dwordx4 a[64:67],v16,s[20:23],s65 offen offset:0 sc1
buffer_load_dwordx4 a[68:71],v16,s[20:23],s65 offen offset:1024 sc1
buffer_load_dwordx4 a[72:75],v16,s[20:23],s65 offen offset:2048 sc1
buffer_load_dwordx4 a[76:79],v16,s[20:23],s65 offen offset:3072 sc1
s_add_u32 s65,s75,1052672
buffer_load_dwordx4 a[80:83],v16,s[20:23],s65 offen offset:0 sc1
buffer_load_dwordx4 a[84:87],v16,s[20:23],s65 offen offset:1024 sc1
buffer_load_dwordx4 a[88:91],v16,s[20:23],s65 offen offset:2048 sc1
buffer_load_dwordx4 a[92:95],v16,s[20:23],s65 offen offset:3072 sc1
s_waitcnt vmcnt(0)
aloop_263:
s_cmp_ge_u32 s79,44
s_cbranch_scc1 tk_265
tw_264:
ds_read_b32 v94,v95
s_waitcnt lgkmcnt(0)
v_readfirstlane_b32 s64,v94
s_add_u32 s64,s64,8
s_cmp_ge_u32 s64,s79
s_cbranch_scc1 tk_265
s_sleep 4
s_sub_u32 s90,s90,1
s_cmp_gt_i32 s90,0
s_cbranch_scc1 tw_264
tk_265:
s_add_u32 s64,s79,0
s_lshl_b32 s74,s64,21
s_lshl_b32 s64,s64,13
s_and_b32 s64,s64,0x2000
s_xor_b32 s64,s64,s61
s_add_u32 s74,s74,s64
s_add_u32 s74,s74,29360128
s_add_u32 s64,s79,0
s_lshl_b32 s70,s64,21
s_lshl_b32 s64,s64,13
s_and_b32 s64,s64,0x2000
s_xor_b32 s64,s64,s62
s_add_u32 s70,s70,s64
s_add_u32 s70,s70,29360128
s_waitcnt vmcnt(21)
v_mfma_f32_16x16x32_bf16 v[168:171],a[32:35],a[0:3],0
v_mfma_f32_16x16x32_bf16 v[172:175],a[36:39],a[0:3],0
v_mfma_f32_16x16x32_bf16 v[180:183],a[32:35],a[4:7],0
v_mfma_f32_16x16x32_bf16 v[184:187],a[36:39],a[4:7],0
v_mfma_f32_16x16x32_bf16 v[168:171],a[40:43],a[8:11],v[168:171]
v_mfma_f32_16x16x32_bf16 v[172:175],a[44:47],a[8:11],v[172:175]
v_mfma_f32_16x16x32_bf16 v[180:183],a[40:43],a[12:15],v[180:183]
v_mfma_f32_16x16x32_bf16 v[184:187],a[44:47],a[12:15],v[184:187]
v_mfma_f32_16x16x32_bf16 v[168:171],a[48:51],a[16:19],v[168:171]
v_mfma_f32_16x16x32_bf16 v[172:175],a[52:55],a[16:19],v[172:175]
v_mfma_f32_16x16x32_bf16 v[180:183],a[48:51],a[20:23],v[180:183]
v_mfma_f32_16x16x32_bf16 v[184:187],a[52:55],a[20:23],v[184:187]
v_mfma_f32_16x16x32_bf16 v[168:171],a[56:59],a[24:27],v[168:171]
v_mfma_f32_16x16x32_bf16 v[172:175],a[60:63],a[24:27],v[172:175]
v_mfma_f32_16x16x32_bf16 v[180:183],a[56:59],a[28:31],v[180:183]
v_mfma_f32_16x16x32_bf16 v[184:187],a[60:63],a[28:31],v[184:187]
s_nop 4
v_cndmask_b32 v168,v97,v168,s[18:19]
s_nop 0
v_cndmask_b32 v180,v97,v180,s[38:39]
v_cndmask_b32 v169,v97,v169,s[16:17]
v_cndmask_b32 v181,v97,v181,s[36:37]
v_cndmask_b32 v170,v97,v170,s[14:15]
v_cndmask_b32 v182,v97,v182,s[34:35]
v_cndmask_b32 v171,v97,v171,s[12:13]
v_cndmask_b32 v183,v97,v183,s[32:33]
v_cndmask_b32 v172,v97,v172,s[10:11]
v_cndmask_b32 v184,v97,v184,s[18:19]
v_cndmask_b32 v173,v97,v173,s[8:9]
v_cndmask_b32 v185,v97,v185,s[16:17]
v_cndmask_b32 v174,v97,v174,s[6:7]
v_cndmask_b32 v186,v97,v186,s[14:15]
v_cndmask_b32 v175,v97,v175,s[4:5]
v_cndmask_b32 v187,v97,v187,s[12:13]
v_max3_f32 v116,v168,v169,v170
v_max3_f32 v122,v180,v181,v182
v_max3_f32 v118,v171,v172,v173
v_max3_f32 v124,v183,v184,v185
v_max3_f32 v116,v116,v174,v175
v_max3_f32 v122,v122,v186,v187
v_max_f32 v116,v116,v118
v_max_f32 v122,v122,v124
v_mov_b32 v118,v116
v_mov_b32 v124,v122
s_nop 0
v_permlane16_swap_b32 v118,v116
v_permlane16_swap_b32 v124,v122
v_max_f32 v116,v116,v118
v_max_f32 v122,v122,v124
v_mov_b32 v118,v116
v_mov_b32 v124,v122
s_nop 0
v_permlane32_swap_b32 v118,v116
v_permlane32_swap_b32 v124,v122
v_max_f32 v116,v116,v118
v_max_f32 v122,v122,v124
v_mul_f32 v116,s80,v116
v_mul_f32 v122,s80,v122
v_fma_f32 v168,v168,s80,-v116
v_fma_f32 v180,v180,s80,-v122
v_fma_f32 v169,v169,s80,-v116
v_fma_f32 v181,v181,s80,-v122
v_fma_f32 v170,v170,s80,-v116
v_fma_f32 v182,v182,s80,-v122
v_fma_f32 v171,v171,s80,-v116
v_fma_f32 v183,v183,s80,-v122
v_fma_f32 v172,v172,s80,-v116
v_fma_f32 v184,v184,s80,-v122
v_fma_f32 v173,v173,s80,-v116
v_fma_f32 v185,v185,s80,-v122
v_fma_f32 v174,v174,s80,-v116
v_fma_f32 v186,v186,s80,-v122
v_fma_f32 v175,v175,s80,-v116
v_fma_f32 v187,v187,s80,-v122
v_exp_f32 v168,v168
v_exp_f32 v180,v180
v_exp_f32 v169,v169
v_exp_f32 v181,v181
v_exp_f32 v170,v170
v_exp_f32 v182,v182
v_exp_f32 v171,v171
v_exp_f32 v183,v183
v_exp_f32 v172,v172
v_exp_f32 v184,v184
v_exp_f32 v173,v173
v_exp_f32 v185,v185
v_exp_f32 v174,v174
v_exp_f32 v186,v186
v_exp_f32 v175,v175
v_exp_f32 v187,v187
v_add_f32 v117,v168,v169
v_add_f32 v123,v180,v181
v_add_f32 v119,v170,v171
v_add_f32 v125,v182,v183
v_add_f32 v117,v117,v172
v_add_f32 v123,v123,v184
v_add_f32 v119,v119,v173
v_add_f32 v125,v125,v185
v_add_f32 v117,v117,v174
v_add_f32 v123,v123,v186
v_add_f32 v119,v119,v175
v_add_f32 v125,v125,v187
v_add_f32 v117,v117,v119
v_add_f32 v123,v123,v125
v_mov_b32 v118,v117
v_mov_b32 v124,v123
s_nop 0
v_permlane16_swap_b32 v118,v117
v_permlane16_swap_b32 v124,v123
v_add_f32 v117,v117,v118
v_add_f32 v123,v123,v124
v_mov_b32 v118,v117
v_mov_b32 v124,v123
s_nop 0
v_permlane32_swap_b32 v118,v117
v_permlane32_swap_b32 v124,v123
v_add_f32 v117,v117,v118
v_add_f32 v123,v123,v124
s_cmp_gt_u32 s71,41
s_cselect_b32 s65,0x7fff0000,s73
s_waitcnt vmcnt(12)
v_add_u32 v22,s71,-1
buffer_store_dword v22,v23,s[20:23],s65 offen sc1
s_add_u32 s66,s74,s43
s_cmp_eq_u32 s78,0
s_cbranch_scc1 kx_269
s_cmp_eq_u32 s84,0
s_cselect_b32 s64,3,0
s_add_u32 s64,s64,s78
kbo_271:
s_sleep 2
s_sub_u32 s64,s64,1
s_cmp_gt_i32 s64,0
s_cbranch_scc1 kbo_271
s_cmp_lt_u32 s84,3
s_cselect_b32 s64,1,0
s_cmp_ge_u32 s84,4
s_subb_u32 s78,s78,2
s_add_u32 s84,s84,1
kpr_270:
s_mov_b64 exec,15
buffer_load_dword v22,v96,s[20:23],s66 offen sc1
s_waitcnt vmcnt(0)
v_cmp_eq_u32 vcc,0,v22
s_mov_b64 exec,-1
s_cbranch_vccz kp_266
s_add_u32 s78,s78,s64
s_mov_b32 s64,1
s_mov_b32 s84,0
s_sleep 1
s_sub_u32 s90,s90,1
s_cmp_gt_i32 s90,0
s_cbranch_scc1 kpr_270
s_branch kp_266
kx_269:
s_mov_b32 s84,0
s_waitcnt vmcnt(9)
s_branch kck_268
kp_266:
s_add_u32 s78,s78,2
buffer_load_dwordx4 v[136:139],v16,s[20:23],s66 offen offset:0 sc1
buffer_load_dwordx4 v[140:143],v16,s[20:23],s66 offen offset:1024 sc1
buffer_load_dwordx4 v[144:147],v16,s[20:23],s66 offen offset:2048 sc1
buffer_load_dwordx4 v[148:151],v16,s[20:23],s66 offen offset:3072 sc1
s_waitcnt vmcnt(0)
kck_268:
v_min3_u32 v22,v136,v140,v144
v_min_u32 v22,v22,v148
v_cmp_eq_u32 vcc,0,v22
s_cbranch_vccz kok_267
s_sleep 1
s_sub_u32 s90,s90,1
s_cmp_gt_i32 s90,0
s_cbranch_scc1 kp_266
kok_267:
s_min_u32 s78,s78,40
buffer_load_dwordx2 v[100:101],v6,s[20:23],s66 offen offset:0 sc1
buffer_load_dwordx2 v[102:103],v6,s[20:23],s66 offen offset:512 sc1
buffer_load_dwordx2 v[104:105],v6,s[20:23],s66 offen offset:1024 sc1
buffer_load_dwordx2 v[106:107],v6,s[20:23],s66 offen offset:1536 sc1
buffer_load_dwordx2 v[108:109],v6,s[20:23],s66 offen offset:2048 sc1
buffer_load_dwordx2 v[110:111],v6,s[20:23],s66 offen offset:2560 sc1
buffer_load_dwordx2 v[112:113],v6,s[20:23],s66 offen offset:3072 sc1
buffer_load_dwordx2 v[114:115],v6,s[20:23],s66 offen offset:3584 sc1
v_mfma_f32_16x16x32_bf16 v[176:179],v[136:139],a[0:3],0
v_mfma_f32_16x16x32_bf16 v[188:191],v[136:139],a[4:7],0
v_mfma_f32_16x16x32_bf16 v[176:179],v[140:143],a[8:11],v[176:179]
v_mfma_f32_16x16x32_bf16 v[188:191],v[140:143],a[12:15],v[188:191]
v_mfma_f32_16x16x32_bf16 v[176:179],v[144:147],a[16:19],v[176:179]
v_mfma_f32_16x16x32_bf16 v[188:191],v[144:147],a[20:23],v[188:191]
v_mfma_f32_16x16x32_bf16 v[176:179],v[148:151],a[24:27],v[176:179]
v_mfma_f32_16x16x32_bf16 v[188:191],v[148:151],a[28:31],v[188:191]
s_cmp_lg_u32 s79,55
s_cbranch_scc1 q2nd_272
pl_273:
buffer_load_dword v98,v99,s[20:23],s87 offen sc1
s_waitcnt vmcnt(0)
v_cmp_gt_u32 vcc,18,v98
s_cbranch_vccz pok_274
s_sleep 1
s_sub_u32 s90,s90,1
s_cmp_gt_i32 s90,0
s_cbranch_scc1 pl_273
pok_274:
q2nd_272:
s_add_u32 s64,s79,1
s_lshl_b32 s75,s64,21
s_lshl_b32 s64,s64,13
s_and_b32 s64,s64,0x2000
s_xor_b32 s64,s64,s61
s_add_u32 s75,s75,s64
s_add_u32 s75,s75,29360128
s_add_u32 s64,s79,1
s_lshl_b32 s76,s64,21
s_lshl_b32 s64,s64,13
s_and_b32 s64,s64,0x2000
s_xor_b32 s64,s64,s62
s_add_u32 s76,s76,s64
s_add_u32 s76,s76,29360128
s_add_u32 s77,s75,s43
s_add_u32 s75,s75,s42
s_add_u32 s76,s76,s42
s_cmp_lt_u32 s79,63
s_cselect_b32 s75,s75,0x7fff0000
s_cselect_b32 s76,s76,0x7fff0000
s_cselect_b32 s77,s77,0x7fff0000
s_add_u32 s65,s75,524288
buffer_load_dwordx4 a[32:35],v16,s[20:23],s65 offen offset:0 sc1
buffer_load_dwordx4 a[36:39],v16,s[20:23],s65 offen offset:1024 sc1
buffer_load_dwordx4 a[40:43],v16,s[20:23],s65 offen offset:2048 sc1
buffer_load_dwordx4 a[44:47],v16,s[20:23],s65 offen offset:3072 sc1
s_add_u32 s65,s75,528384
buffer_load_dwordx4 a[48:51],v16,s[20:23],s65 offen offset:0 sc1
buffer_load_dwordx4 a[52:55],v16,s[20:23],s65 offen offset:1024 sc1
buffer_load_dwordx4 a[56:59],v16,s[20:23],s65 offen offset:2048 sc1
buffer_load_dwordx4 a[60:63],v16,s[20:23],s65 offen offset:3072 sc1
s_add_u32 s65,s76,0
buffer_load_dwordx4 a[0:3],v16,s[20:23],s65 offen offset:0 sc1
buffer_load_dwordx4 a[4:7],v16,s[20:23],s65 offen offset:1024 sc1
buffer_load_dwordx4 a[8:11],v16,s[20:23],s65 offen offset:2048 sc1
buffer_load_dwordx4 a[12:15],v16,s[20:23],s65 offen offset:3072 sc1
s_add_u32 s65,s76,4096
buffer_load_dwordx4 a[16:19],v16,s[20:23],s65 offen offset:0 sc1
buffer_load_dwordx4 a[20:23],v16,s[20:23],s65 offen offset:1024 sc1
buffer_load_dwordx4 a[24:27],v16,s[20:23],s65 offen offset:2048 sc1
buffer_load_dwordx4 a[28:31],v16,s[20:23],s65 offen offset:3072 sc1
v_cndmask_b32 v176,v97,v176,s[48:49]
v_cndmask_b32 v188,v97,v188,s[48:49]
v_cndmask_b32 v177,v97,v177,s[48:49]
v_cndmask_b32 v189,v97,v189,s[48:49]
v_cndmask_b32 v178,v97,v178,s[48:49]
v_cndmask_b32 v190,v97,v190,s[48:49]
v_cndmask_b32 v179,v97,v179,s[48:49]
v_cndmask_b32 v191,v97,v191,s[48:49]
v_max3_f32 v119,v176,v177,v178
v_max3_f32 v125,v188,v189,v190
v_max_f32 v119,v119,v179
v_max_f32 v125,v125,v191
v_mov_b32 v118,v119
v_mov_b32 v124,v125
s_nop 0
v_permlane16_swap_b32 v118,v119
v_permlane16_swap_b32 v124,v125
v_max_f32 v119,v119,v118
v_max_f32 v125,v125,v124
v_mov_b32 v118,v119
v_mov_b32 v124,v125
s_nop 0
v_permlane32_swap_b32 v118,v119
v_permlane32_swap_b32 v124,v125
v_max_f32 v119,v119,v118
v_max_f32 v125,v125,v124
v_mul_f32 v119,s80,v119
v_mul_f32 v125,s80,v125
v_max_f32 v119,v119,v116
v_max_f32 v125,v125,v122
v_fma_f32 v176,v176,s80,-v119
v_fma_f32 v188,v188,s80,-v125
v_fma_f32 v177,v177,s80,-v119
v_fma_f32 v189,v189,s80,-v125
v_fma_f32 v178,v178,s80,-v119
v_fma_f32 v190,v190,s80,-v125
v_fma_f32 v179,v179,s80,-v119
v_fma_f32 v191,v191,s80,-v125
v_sub_f32 v116,v116,v119
v_sub_f32 v122,v122,v125
v_exp_f32 v176,v176
v_exp_f32 v188,v188
v_exp_f32 v177,v177
v_exp_f32 v189,v189
v_exp_f32 v178,v178
v_exp_f32 v190,v190
v_exp_f32 v179,v179
v_exp_f32 v191,v191
v_exp_f32 v116,v116
v_exp_f32 v122,v122
v_add_f32 v120,v176,v177
v_add_f32 v126,v188,v189
v_add_f32 v121,v178,v179
v_add_f32 v127,v190,v191
v_add_f32 v120,v120,v121
v_add_f32 v126,v126,v127
v_mov_b32 v118,v120
v_mov_b32 v124,v126
s_nop 0
v_permlane16_swap_b32 v118,v120
v_permlane16_swap_b32 v124,v126
v_add_f32 v120,v120,v118
v_add_f32 v126,v126,v124
v_mov_b32 v118,v120
v_mov_b32 v124,v126
s_nop 0
v_permlane32_swap_b32 v118,v120
v_permlane32_swap_b32 v124,v126
v_add_f32 v120,v120,v118
v_add_f32 v126,v126,v124
v_fmac_f32 v120,v117,v116
v_fmac_f32 v126,v123,v122
v_rcp_f32 v121,v120
v_rcp_f32 v127,v126
v_mul_f32 v119,v116,v121
v_mul_f32 v125,v122,v127
v_pk_mul_f32 v[168:169],v[168:169],v[118:119] op_sel:[0,1] op_sel_hi:[1,1]
v_pk_mul_f32 v[180:181],v[180:181],v[124:125] op_sel:[0,1] op_sel_hi:[1,1]
v_pk_mul_f32 v[170:171],v[170:171],v[118:119] op_sel:[0,1] op_sel_hi:[1,1]
v_pk_mul_f32 v[182:183],v[182:183],v[124:125] op_sel:[0,1] op_sel_hi:[1,1]
v_pk_mul_f32 v[172:173],v[172:173],v[118:119] op_sel:[0,1] op_sel_hi:[1,1]
v_pk_mul_f32 v[184:185],v[184:185],v[124:125] op_sel:[0,1] op_sel_hi:[1,1]
v_pk_mul_f32 v[174:175],v[174:175],v[118:119] op_sel:[0,1] op_sel_hi:[1,1]
v_pk_mul_f32 v[186:187],v[186:187],v[124:125] op_sel:[0,1] op_sel_hi:[1,1]
v_cvt_pk_bf16_f32 v48,v168,v169
v_cvt_pk_bf16_f32 v56,v180,v181
v_cvt_pk_bf16_f32 v49,v170,v171
v_cvt_pk_bf16_f32 v57,v182,v183
v_cvt_pk_bf16_f32 v50,v172,v173
v_cvt_pk_bf16_f32 v58,v184,v185
v_cvt_pk_bf16_f32 v51,v174,v175
v_cvt_pk_bf16_f32 v59,v186,v187
v_pk_mul_f32 v[176:177],v[176:177],v[120:121] op_sel:[0,1] op_sel_hi:[1,1]
v_pk_mul_f32 v[188:189],v[188:189],v[126:127] op_sel:[0,1] op_sel_hi:[1,1]
v_pk_mul_f32 v[178:179],v[178:179],v[120:121] op_sel:[0,1] op_sel_hi:[1,1]
v_pk_mul_f32 v[190:191],v[190:191],v[126:127] op_sel:[0,1] op_sel_hi:[1,1]
v_cvt_pk_bf16_f32 v52,v176,v177
v_cvt_pk_bf16_f32 v60,v188,v189
v_cvt_pk_bf16_f32 v53,v178,v179
v_cvt_pk_bf16_f32 v61,v190,v191
s_add_u32 s70,s70,s42
s_waitcnt vmcnt(24)
v_mfma_f32_16x16x32_bf16 v[192:195],a[64:67],v[48:51],0
v_mfma_f32_16x16x32_bf16 v[196:199],a[64:67],v[56:59],0
v_mfma_f32_16x16x32_bf16 v[200:203],a[68:71],v[48:51],0
v_mfma_f32_16x16x32_bf16 v[204:207],a[68:71],v[56:59],0
v_mfma_f32_16x16x32_bf16 v[208:211],a[72:75],v[48:51],0
v_mfma_f32_16x16x32_bf16 v[212:215],a[72:75],v[56:59],0
v_mfma_f32_16x16x32_bf16 v[216:219],a[76:79],v[48:51],0
v_mfma_f32_16x16x32_bf16 v[220:223],a[76:79],v[56:59],0
s_waitcnt vmcnt(16)
v_mfma_f32_16x16x16_bf16 v[192:195],v[100:101],v[52:53],v[192:195]
v_mfma_f32_16x16x16_bf16 v[196:199],v[100:101],v[60:61],v[196:199]
v_mfma_f32_16x16x16_bf16 v[200:203],v[102:103],v[52:53],v[200:203]
v_mfma_f32_16x16x16_bf16 v[204:207],v[102:103],v[60:61],v[204:207]
v_mfma_f32_16x16x32_bf16 v[224:227],a[80:83],v[48:51],0
v_mfma_f32_16x16x32_bf16 v[228:231],a[80:83],v[56:59],0
v_mfma_f32_16x16x32_bf16 v[232:235],a[84:87],v[48:51],0
v_mfma_f32_16x16x32_bf16 v[236:239],a[84:87],v[56:59],0
v_mfma_f32_16x16x16_bf16 v[208:211],v[104:105],v[52:53],v[208:211]
s_add_u32 s65,s70,524288
v_mfma_f32_16x16x16_bf16 v[212:215],v[104:105],v[60:61],v[212:215]
v_cvt_pk_bf16_f32 v64,v192,v193
v_cvt_pk_bf16_f32 v65,v194,v195
v_mfma_f32_16x16x16_bf16 v[216:219],v[106:107],v[52:53],v[216:219]
v_cvt_pk_bf16_f32 v66,v200,v201
v_mfma_f32_16x16x16_bf16 v[220:223],v[106:107],v[60:61],v[220:223]
v_cvt_pk_bf16_f32 v67,v202,v203
v_max_u32 v64,1,v64
v_mfma_f32_16x16x32_bf16 v[240:243],a[88:91],v[48:51],0
buffer_store_dwordx4 v[64:67],v16,s[20:23],s65 offen offset:0 sc1
v_cvt_pk_bf16_f32 v68,v196,v197
v_mfma_f32_16x16x32_bf16 v[244:247],a[88:91],v[56:59],0
v_cvt_pk_bf16_f32 v69,v198,v199
v_mfma_f32_16x16x32_bf16 v[248:251],a[92:95],v[48:51],0
v_cvt_pk_bf16_f32 v70,v204,v205
v_cvt_pk_bf16_f32 v71,v206,v207
v_mfma_f32_16x16x32_bf16 v[252:255],a[92:95],v[56:59],0
v_max_u32 v68,1,v68
buffer_store_dwordx4 v[68:71],v16,s[20:23],s65 offen offset:1024 sc1
v_mfma_f32_16x16x16_bf16 v[224:227],v[108:109],v[52:53],v[224:227]
v_cvt_pk_bf16_f32 v72,v208,v209
v_mfma_f32_16x16x16_bf16 v[228:231],v[108:109],v[60:61],v[228:231]
v_cvt_pk_bf16_f32 v73,v210,v211
v_cvt_pk_bf16_f32 v74,v216,v217
v_mfma_f32_16x16x16_bf16 v[232:235],v[110:111],v[52:53],v[232:235]
v_cvt_pk_bf16_f32 v75,v218,v219
v_mfma_f32_16x16x16_bf16 v[236:239],v[110:111],v[60:61],v[236:239]
v_max_u32 v72,1,v72
buffer_store_dwordx4 v[72:75],v16,s[20:23],s65 offen offset:2048 sc1
v_mfma_f32_16x16x16_bf16 v[240:243],v[112:113],v[52:53],v[240:243]
v_cvt_pk_bf16_f32 v76,v212,v213
v_mfma_f32_16x16x16_bf16 v[244:247],v[112:113],v[60:61],v[244:247]
v_cvt_pk_bf16_f32 v77,v214,v215
v_cvt_pk_bf16_f32 v78,v220,v221
v_mfma_f32_16x16x16_bf16 v[248:251],v[114:115],v[52:53],v[248:251]
v_cvt_pk_bf16_f32 v79,v222,v223
v_mfma_f32_16x16x16_bf16 v[252:255],v[114:115],v[60:61],v[252:255]
v_max_u32 v76,1,v76
buffer_store_dwordx4 v[76:79],v16,s[20:23],s65 offen offset:3072 sc1
s_cmp_gt_u32 s71,40
s_cselect_b32 s64,s73,0x7fff0000
v_mov_b32 v22,s71
buffer_store_dword v22,v23,s[20:23],s64 offen sc1
s_add_u32 s65,s70,528384
v_cvt_pk_bf16_f32 v64,v224,v225
v_cvt_pk_bf16_f32 v65,v226,v227
v_cvt_pk_bf16_f32 v66,v232,v233
v_cvt_pk_bf16_f32 v67,v234,v235
v_max_u32 v64,1,v64
buffer_store_dwordx4 v[64:67],v16,s[20:23],s65 offen offset:0 sc1
v_cvt_pk_bf16_f32 v68,v228,v229
v_cvt_pk_bf16_f32 v69,v230,v231
v_cvt_pk_bf16_f32 v70,v236,v237
v_cvt_pk_bf16_f32 v71,v238,v239
v_max_u32 v68,1,v68
buffer_store_dwordx4 v[68:71],v16,s[20:23],s65 offen offset:1024 sc1
v_cvt_pk_bf16_f32 v72,v240,v241
v_cvt_pk_bf16_f32 v73,v242,v243
v_cvt_pk_bf16_f32 v74,v248,v249
v_cvt_pk_bf16_f32 v75,v250,v251
v_max_u32 v72,1,v72
buffer_store_dwordx4 v[72:75],v16,s[20:23],s65 offen offset:2048 sc1
v_cvt_pk_bf16_f32 v76,v244,v245
v_cvt_pk_bf16_f32 v77,v246,v247
v_cvt_pk_bf16_f32 v78,v252,v253
v_cvt_pk_bf16_f32 v79,v254,v255
v_max_u32 v76,1,v76
buffer_store_dwordx4 v[76:79],v16,s[20:23],s65 offen offset:3072 sc1
s_cmp_lt_u32 s79,58
s_cselect_b32 s78,s78,0
s_cmp_lg_u32 s78,0
s_cselect_b32 s66,0x7fff0000,s77
buffer_load_dwordx4 v[136:139],v16,s[20:23],s66 offen offset:0 sc1
buffer_load_dwordx4 v[140:143],v16,s[20:23],s66 offen offset:1024 sc1
buffer_load_dwordx4 v[144:147],v16,s[20:23],s66 offen offset:2048 sc1
buffer_load_dwordx4 v[148:151],v16,s[20:23],s66 offen offset:3072 sc1
s_add_u32 s65,s75,1048576
buffer_load_dwordx4 a[64:67],v16,s[20:23],s65 offen offset:0 sc1
buffer_load_dwordx4 a[68:71],v16,s[20:23],s65 offen offset:1024 sc1
buffer_load_dwordx4 a[72:75],v16,s[20:23],s65 offen offset:2048 sc1
buffer_load_dwordx4 a[76:79],v16,s[20:23],s65 offen offset:3072 sc1
s_add_u32 s65,s75,1052672
buffer_load_dwordx4 a[80:83],v16,s[20:23],s65 offen offset:0 sc1
buffer_load_dwordx4 a[84:87],v16,s[20:23],s65 offen offset:1024 sc1
buffer_load_dwordx4 a[88:91],v16,s[20:23],s65 offen offset:2048 sc1
buffer_load_dwordx4 a[92:95],v16,s[20:23],s65 offen offset:3072 sc1
s_add_u32 s79,s79,1
s_add_u32 s71,s71,1
s_cmp_lt_u32 s79,64
s_cbranch_scc1 aloop_263
s_endpgm
r_ln_218:
v_and_b32 v21,1,v1
v_mul_u32_u24 v21,960,v21
s_mov_b32 s65,21052032
s_mov_b32 s66,1792
pl_275:
buffer_load_dword v22,v21,s[20:23],s65 offen sc1
s_waitcnt vmcnt(0)
v_cmp_gt_u32 vcc,s66,v22
s_cbranch_vccz pok_276
s_sleep 1
s_sub_u32 s90,s90,1
s_cmp_gt_i32 s90,0
s_cbranch_scc1 pl_275
pok_276:
s_lshl_b32 s41,s59,1
s_add_u32 s41,s41,s50
s_sub_u32 s41,s41,2
v_lshlrev_b32 v5,5,v1
s_mov_b32 s64,16384
buffer_load_dwordx4 v[40:43],v5,s[20:23],s64 offen offset:0 sc1
buffer_load_dwordx4 v[44:47],v5,s[20:23],s64 offen offset:16 sc1
buffer_load_dwordx4 v[48:51],v5,s[20:23],s64 offen offset:2048 sc1
buffer_load_dwordx4 v[52:55],v5,s[20:23],s64 offen offset:2064 sc1
s_mov_b32 s64,12288
buffer_load_dwordx4 v[56:59],v5,s[20:23],s64 offen offset:0 sc1
buffer_load_dwordx4 v[60:63],v5,s[20:23],s64 offen offset:16 sc1
buffer_load_dwordx4 v[64:67],v5,s[20:23],s64 offen offset:2048 sc1
buffer_load_dwordx4 v[68:71],v5,s[20:23],s64 offen offset:2064 sc1
s_lshr_b32 s64,s41,2
s_add_u32 s64,s64,64
s_lshl_b32 s64,s64,14
s_and_b32 s65,s41,3
s_lshl_b32 s65,s65,11
s_add_u32 s64,s64,s65
v_add_u32 v19,s64,v16
v_add_u32 v19,786432,v19
s_lshl_b32 s65,s41,7
v_add_u32 v5,s65,v16
v_and_b32 v5,2047,v5
v_add_u32 v17,s64,v5
v_xor_b32 v18,1024,v17
v_add_u32 v24,0xfff00000,v17
v_xor_b32 v25,1024,v24
v_lshlrev_b32 v21,2,v1
s_and_b32 s64,s41,4
s_lshl_b32 s64,s64,6
s_add_u32 s74,s63,s64
s_add_u32 s74,s74,2048
s_mov_b32 s83,1
s_lshl_b32 s73,s41,2
s_add_u32 s73,s73,s63
s_add_u32 s73,s73,2560
v_mov_b32 v8,1
v_mov_b32 v9,1
v_mov_b32 v10,1
v_mov_b32 v11,1
s_add_u32 s64,s62,27262976
s_xor_b32 s65,s62,0x2000
s_add_u32 s65,s65,163577856
buffer_store_dwordx4 v[8:11],v24,s[20:23],s64 offen sc1
buffer_store_dwordx4 v[8:11],v25,s[20:23],s64 offen sc1
buffer_store_dwordx4 v[8:11],v24,s[20:23],s65 offen sc1
buffer_store_dwordx4 v[8:11],v25,s[20:23],s65 offen sc1
s_mov_b32 s82,0x3a800000
s_waitcnt vmcnt(0)
v_add_f32 v40,1.0,v40
v_add_f32 v41,1.0,v41
v_add_f32 v42,1.0,v42
v_add_f32 v43,1.0,v43
v_add_f32 v44,1.0,v44
v_add_f32 v45,1.0,v45
v_add_f32 v46,1.0,v46
v_add_f32 v47,1.0,v47
v_add_f32 v48,1.0,v48
v_add_f32 v49,1.0,v49
v_add_f32 v50,1.0,v50
v_add_f32 v51,1.0,v51
v_add_f32 v52,1.0,v52
v_add_f32 v53,1.0,v53
v_add_f32 v54,1.0,v54
v_add_f32 v55,1.0,v55
s_lshl_b32 s64,s50,2
s_add_u32 s64,s64,147448
v_mov_b32 v7,s64
s_add_u32 s64,s79,0
s_lshl_b32 s70,s64,21
s_lshl_b32 s64,s64,13
s_and_b32 s64,s64,0x2000
s_xor_b32 s64,s64,s62
s_add_u32 s70,s70,s64
s_add_u32 s70,s70,29360128
lloop_277:
s_add_u32 s75,s70,2097152
s_xor_b32 s75,s75,0x2000
s_add_u32 s96,s71,1
s_cmp_eq_u32 s83,0
s_cbranch_scc1 lahead_280
s_cmp_gt_u32 s71,40
s_cbranch_scc1 xp_278
pl_282:
buffer_load_dword v29,v21,s[20:23],s74 offen sc1
s_waitcnt vmcnt(0)
v_cmp_gt_u32 vcc,s71,v29
s_cbranch_vccz pok_283
s_sleep 1
s_sub_u32 s90,s90,1
s_cmp_gt_i32 s90,0
s_cbranch_scc1 pl_282
pok_283:
xp_278:
buffer_load_dwordx4 v[8:11],v17,s[20:23],s70 offen sc1
buffer_load_dwordx4 v[12:15],v18,s[20:23],s70 offen sc1
s_waitcnt vmcnt(0)
v_min3_u32 v22,v8,v10,v12
v_min_u32 v22,v22,v14
v_cmp_eq_u32 vcc,0,v22
s_cbranch_vccz xk_279
s_sleep 1
s_sub_u32 s90,s90,1
s_cmp_gt_i32 s90,0
s_cbranch_scc1 xp_278
s_branch xk_279
lahead_280:
s_waitcnt vmcnt(6)
v_mov_b32 v8,v104
v_mov_b32 v9,v105
v_mov_b32 v10,v106
v_mov_b32 v11,v107
v_mov_b32 v12,v108
v_mov_b32 v13,v109
v_mov_b32 v14,v110
v_mov_b32 v15,v111
v_min3_u32 v22,v8,v10,v12
v_min_u32 v22,v22,v14
v_cmp_eq_u32 vcc,0,v22
s_cbranch_vccnz xp_278
xk_279:
v_cmp_gt_u32 vcc,s96,v29
s_or_b32 s83,vcc_lo,vcc_hi
s_cselect_b32 s76,0x7fff0000,s75
buffer_load_dwordx4 v[104:107],v17,s[20:23],s76 offen sc1
buffer_load_dwordx4 v[108:111],v18,s[20:23],s76 offen sc1
buffer_load_dword v29,v21,s[20:23],s74 offen sc1
v_lshlrev_b32 v80,16,v8
v_and_b32 v81,s80,v8
v_lshlrev_b32 v82,16,v9
v_and_b32 v83,s80,v9
v_lshlrev_b32 v84,16,v10
v_and_b32 v85,s80,v10
v_lshlrev_b32 v86,16,v11
v_and_b32 v87,s80,v11
v_lshlrev_b32 v88,16,v12
v_and_b32 v89,s80,v12
v_lshlrev_b32 v90,16,v13
v_and_b32 v91,s80,v13
v_lshlrev_b32 v92,16,v14
v_and_b32 v93,s80,v14
v_lshlrev_b32 v94,16,v15
v_and_b32 v95,s80,v15
v_pk_add_f32 v[96:97],v[80:81],v[82:83]
v_pk_mul_f32 v[100:101],v[80:81],v[80:81]
v_pk_add_f32 v[98:99],v[88:89],v[90:91]
v_pk_mul_f32 v[102:103],v[88:89],v[88:89]
v_pk_fma_f32 v[100:101],v[82:83],v[82:83],v[100:101]
v_pk_fma_f32 v[102:103],v[90:91],v[90:91],v[102:103]
v_pk_add_f32 v[96:97],v[96:97],v[84:85]
v_pk_fma_f32 v[100:101],v[84:85],v[84:85],v[100:101]
v_pk_add_f32 v[98:99],v[98:99],v[92:93]
v_pk_fma_f32 v[102:103],v[92:93],v[92:93],v[102:103]
v_pk_add_f32 v[96:97],v[96:97],v[86:87]
v_pk_fma_f32 v[100:101],v[86:87],v[86:87],v[100:101]
v_pk_add_f32 v[98:99],v[98:99],v[94:95]
v_pk_fma_f32 v[102:103],v[94:95],v[94:95],v[102:103]
v_pk_add_f32 v[96:97],v[96:97],v[98:99]
v_pk_add_f32 v[100:101],v[100:101],v[102:103]
v_add_f32 v96,v96,v97
v_add_f32 v97,v100,v101
s_nop 0
v_add_f32_dpp v96,v96,v96 quad_perm:[1,0,3,2] row_mask:0xf bank_mask:0xf
v_add_f32_dpp v97,v97,v97 quad_perm:[1,0,3,2] row_mask:0xf bank_mask:0xf
s_nop 0
v_add_f32_dpp v96,v96,v96 quad_perm:[2,3,0,1] row_mask:0xf bank_mask:0xf
v_add_f32_dpp v97,v97,v97 quad_perm:[2,3,0,1] row_mask:0xf bank_mask:0xf
s_nop 0
v_add_f32_dpp v96,v96,v96 row_half_mirror row_mask:0xf bank_mask:0xf
v_add_f32_dpp v97,v97,v97 row_half_mirror row_mask:0xf bank_mask:0xf
s_nop 0
v_add_f32_dpp v96,v96,v96 row_mirror row_mask:0xf bank_mask:0xf
v_add_f32_dpp v97,v97,v97 row_mirror row_mask:0xf bank_mask:0xf
v_mov_b32 v98,v96
v_mov_b32 v99,v97
s_nop 0
v_permlane16_swap_b32 v98,v96
v_permlane16_swap_b32 v99,v97
v_pk_add_f32 v[96:97],v[96:97],v[98:99]
v_mov_b32 v98,v96
v_mov_b32 v99,v97
s_nop 0
v_permlane32_swap_b32 v98,v96
v_permlane32_swap_b32 v99,v97
v_pk_add_f32 v[96:97],v[96:97],v[98:99]
v_mul_f32 v96,0xba800000,v96
v_mul_f32 v98,v96,v96
v_fma_f32 v98,v97,s82,-v98
v_max_f32 v98,0,v98
v_add_f32 v98,0x3727c5ac,v98
v_rsq_f32 v98,v98
s_nop 0
v_mul_f32 v96,v96,v98
v_pk_fma_f32 v[80:81],v[80:81],v[98:99],v[96:97] op_sel_hi:[1,0,0]
v_pk_fma_f32 v[82:83],v[82:83],v[98:99],v[96:97] op_sel_hi:[1,0,0]
v_pk_fma_f32 v[84:85],v[84:85],v[98:99],v[96:97] op_sel_hi:[1,0,0]
v_pk_fma_f32 v[86:87],v[86:87],v[98:99],v[96:97] op_sel_hi:[1,0,0]
v_pk_fma_f32 v[88:89],v[88:89],v[98:99],v[96:97] op_sel_hi:[1,0,0]
v_pk_fma_f32 v[90:91],v[90:91],v[98:99],v[96:97] op_sel_hi:[1,0,0]
v_pk_fma_f32 v[92:93],v[92:93],v[98:99],v[96:97] op_sel_hi:[1,0,0]
v_pk_fma_f32 v[94:95],v[94:95],v[98:99],v[96:97] op_sel_hi:[1,0,0]
v_pk_fma_f32 v[80:81],v[80:81],v[40:41],v[56:57]
v_pk_fma_f32 v[82:83],v[82:83],v[42:43],v[58:59]
v_pk_fma_f32 v[84:85],v[84:85],v[44:45],v[60:61]
v_pk_fma_f32 v[86:87],v[86:87],v[46:47],v[62:63]
v_pk_fma_f32 v[88:89],v[88:89],v[48:49],v[64:65]
v_pk_fma_f32 v[90:91],v[90:91],v[50:51],v[66:67]
v_pk_fma_f32 v[92:93],v[92:93],v[52:53],v[68:69]
v_pk_fma_f32 v[94:95],v[94:95],v[54:55],v[70:71]
v_cvt_pk_bf16_f32 v8,v80,v81
v_cvt_pk_bf16_f32 v9,v82,v83
v_cvt_pk_bf16_f32 v10,v84,v85
v_cvt_pk_bf16_f32 v11,v86,v87
v_cvt_pk_bf16_f32 v12,v88,v89
v_cvt_pk_bf16_f32 v13,v90,v91
v_cvt_pk_bf16_f32 v14,v92,v93
v_cvt_pk_bf16_f32 v15,v94,v95
v_max_u32 v8,1,v8
v_max_u32 v10,1,v10
v_max_u32 v12,1,v12
v_max_u32 v14,1,v14
s_xor_b32 s78,s70,0x2000
s_waitcnt vmcnt(3)
v_add_u32 v22,s71,-1
buffer_store_dword v22,v23,s[24:27],s73 offen
buffer_store_dword v22,v23,s[28:31],s73 offen sc1
buffer_store_dwordx4 v[8:11],v24,s[20:23],s78 offen sc1
buffer_store_dwordx4 v[12:15],v25,s[20:23],s78 offen sc1
v_lshlrev_b32 v80,16,v8
v_and_b32 v81,s80,v8
v_lshlrev_b32 v82,16,v9
v_and_b32 v83,s80,v9
v_lshlrev_b32 v84,16,v10
v_and_b32 v85,s80,v10
v_lshlrev_b32 v86,16,v11
v_and_b32 v87,s80,v11
v_lshlrev_b32 v88,16,v12
v_and_b32 v89,s80,v12
v_lshlrev_b32 v90,16,v13
v_and_b32 v91,s80,v13
v_lshlrev_b32 v92,16,v14
v_and_b32 v93,s80,v14
v_lshlrev_b32 v94,16,v15
v_and_b32 v95,s80,v15
v_pk_add_f32 v[96:97],v[80:81],v[82:83]
v_pk_mul_f32 v[100:101],v[80:81],v[80:81]
v_pk_add_f32 v[98:99],v[88:89],v[90:91]
v_pk_mul_f32 v[102:103],v[88:89],v[88:89]
v_pk_fma_f32 v[100:101],v[82:83],v[82:83],v[100:101]
v_pk_fma_f32 v[102:103],v[90:91],v[90:91],v[102:103]
v_pk_add_f32 v[96:97],v[96:97],v[84:85]
v_pk_fma_f32 v[100:101],v[84:85],v[84:85],v[100:101]
v_pk_add_f32 v[98:99],v[98:99],v[92:93]
v_pk_fma_f32 v[102:103],v[92:93],v[92:93],v[102:103]
v_pk_add_f32 v[96:97],v[96:97],v[86:87]
v_pk_fma_f32 v[100:101],v[86:87],v[86:87],v[100:101]
v_pk_add_f32 v[98:99],v[98:99],v[94:95]
v_pk_fma_f32 v[102:103],v[94:95],v[94:95],v[102:103]
v_pk_add_f32 v[96:97],v[96:97],v[98:99]
v_pk_add_f32 v[100:101],v[100:101],v[102:103]
v_add_f32 v96,v96,v97
v_add_f32 v97,v100,v101
s_nop 0
v_add_f32_dpp v96,v96,v96 quad_perm:[1,0,3,2] row_mask:0xf bank_mask:0xf
v_add_f32_dpp v97,v97,v97 quad_perm:[1,0,3,2] row_mask:0xf bank_mask:0xf
s_nop 0
v_add_f32_dpp v96,v96,v96 quad_perm:[2,3,0,1] row_mask:0xf bank_mask:0xf
v_add_f32_dpp v97,v97,v97 quad_perm:[2,3,0,1] row_mask:0xf bank_mask:0xf
s_nop 0
v_add_f32_dpp v96,v96,v96 row_half_mirror row_mask:0xf bank_mask:0xf
v_add_f32_dpp v97,v97,v97 row_half_mirror row_mask:0xf bank_mask:0xf
s_nop 0
v_add_f32_dpp v96,v96,v96 row_mirror row_mask:0xf bank_mask:0xf
v_add_f32_dpp v97,v97,v97 row_mirror row_mask:0xf bank_mask:0xf
v_mov_b32 v98,v96
v_mov_b32 v99,v97
s_nop 0
v_permlane16_swap_b32 v98,v96
v_permlane16_swap_b32 v99,v97
v_pk_add_f32 v[96:97],v[96:97],v[98:99]
v_mov_b32 v98,v96
v_mov_b32 v99,v97
s_nop 0
v_permlane32_swap_b32 v98,v96
v_permlane32_swap_b32 v99,v97
v_pk_add_f32 v[96:97],v[96:97],v[98:99]
v_mul_f32 v96,0xba800000,v96
v_mul_f32 v98,v96,v96
v_fma_f32 v98,v97,s82,-v98
v_max_f32 v98,0,v98
v_add_f32 v98,0x3727c5ac,v98
v_rsq_f32 v98,v98
s_nop 0
v_mul_f32 v96,v96,v98
v_pk_fma_f32 v[80:81],v[80:81],v[98:99],v[96:97] op_sel_hi:[1,0,0]
v_pk_fma_f32 v[82:83],v[82:83],v[98:99],v[96:97] op_sel_hi:[1,0,0]
v_pk_fma_f32 v[84:85],v[84:85],v[98:99],v[96:97] op_sel_hi:[1,0,0]
v_pk_fma_f32 v[86:87],v[86:87],v[98:99],v[96:97] op_sel_hi:[1,0,0]
v_pk_fma_f32 v[88:89],v[88:89],v[98:99],v[96:97] op_sel_hi:[1,0,0]
v_pk_fma_f32 v[90:91],v[90:91],v[98:99],v[96:97] op_sel_hi:[1,0,0]
v_pk_fma_f32 v[92:93],v[92:93],v[98:99],v[96:97] op_sel_hi:[1,0,0]
v_pk_fma_f32 v[94:95],v[94:95],v[98:99],v[96:97] op_sel_hi:[1,0,0]
v_cvt_pk_bf16_f32 v72,v80,v81
v_cvt_pk_bf16_f32 v73,v82,v83
v_cvt_pk_bf16_f32 v74,v84,v85
v_cvt_pk_bf16_f32 v75,v86,v87
v_cvt_pk_bf16_f32 v76,v88,v89
v_cvt_pk_bf16_f32 v77,v90,v91
v_cvt_pk_bf16_f32 v78,v92,v93
v_cvt_pk_bf16_f32 v79,v94,v95
v_max_u32 v72,1,v72
v_max_u32 v76,1,v76
buffer_store_dwordx4 v[72:75],v19,s[20:23],s70 offen sc1
buffer_store_dwordx4 v[76:79],v19,s[20:23],s70 offen offset:1024 sc1
s_cmp_gt_u32 s71,40
s_cbranch_scc1 fnow_284
s_cmp_eq_u32 s83,0
s_cbranch_scc1 flater_285
s_waitcnt vmcnt(0)
fnow_284:
v_mov_b32 v22,s71
buffer_store_dword v22,v23,s[24:27],s73 offen
buffer_store_dword v22,v23,s[28:31],s73 offen sc1
flater_285:
v_mov_b32 v6,s71
ds_write_b32 v7,v6
s_mov_b32 s70,s75
s_add_u32 s79,s79,1
s_add_u32 s71,s71,1
s_cmp_lt_u32 s79,64
s_cbranch_scc1 lloop_277
s_endpgm
r_wo_214:
s_load_dwordx2 s[4:5],s[0:1],40
s_load_dwordx2 s[6:7],s[0:1],0
s_lshr_b32 s41,s59,3
s_and_b32 s42,s59,7
s_mul_i32 s66,s41,2097152
s_lshl_b32 s64,s42,8
s_add_u32 s66,s66,s64
s_lshl_b32 s67,s50,1
s_and_b32 s64,s41,1
s_add_u32 s67,s67,s64
s_waitcnt lgkmcnt(0)
s_mov_b32 s32,s4
s_and_b32 s33,s5,0xffff
s_mov_b32 s34,0x800000
s_mov_b32 s35,0x20000
s_mov_b32 s36,s6
s_and_b32 s37,s7,0xffff
s_mov_b32 s38,0x400000
s_mov_b32 s39,0x20000
v_lshrrev_b32 v5,2,v3
v_lshl_add_u32 v5,v4,2,v5
v_and_b32 v6,3,v3
v_lshlrev_b32 v6,3,v6
v_lshl_add_u32 v6,v5,8,v6
v_and_b32 v5,7,v5
v_xor_b32 v5,s67,v5
v_lshl_add_u32 v12,v5,5,v6
v_xor_b32 v13,32,v12
v_and_b32 v5,15,v1
v_and_b32 v6,3,v4
v_lshlrev_b32 v6,1,v6
v_xor_b32 v5,v5,v6
v_mul_u32_u24 v6,2048,v4
v_xor_b32 v7,0,v5
v_lshl_add_u32 v8,v7,4,v6
v_xor_b32 v7,8,v5
v_lshl_add_u32 v9,v7,4,v6
s_mul_i32 s74,s50,131072
s_add_u32 s74,s74,s66
s_lshl_b32 s75,s50,14
s_mul_i32 s76,s50,65536
s_add_u32 s76,s76,s66
s_lshl_b32 s77,s50,13
s_add_u32 s64,s74,0
s_add_u32 m0,s75,0
s_nop 0
buffer_load_dwordx4 v8,s[32:35],s64 offen nt lds
s_add_u32 s64,s74,8192
s_add_u32 m0,s75,1024
s_nop 0
buffer_load_dwordx4 v9,s[32:35],s64 offen nt lds
s_add_u32 s64,s74,16384
s_add_u32 m0,s75,2048
s_nop 0
buffer_load_dwordx4 v8,s[32:35],s64 offen nt lds
s_add_u32 s64,s74,24576
s_add_u32 m0,s75,3072
s_nop 0
buffer_load_dwordx4 v9,s[32:35],s64 offen nt lds
s_add_u32 s64,s74,32768
s_add_u32 m0,s75,4096
s_nop 0
buffer_load_dwordx4 v8,s[32:35],s64 offen nt lds
s_add_u32 s64,s74,40960
s_add_u32 m0,s75,5120
s_nop 0
buffer_load_dwordx4 v9,s[32:35],s64 offen nt lds
s_add_u32 s64,s74,49152
s_add_u32 m0,s75,6144
s_nop 0
buffer_load_dwordx4 v8,s[32:35],s64 offen nt lds
s_add_u32 s64,s74,57344
s_add_u32 m0,s75,7168
s_nop 0
buffer_load_dwordx4 v9,s[32:35],s64 offen nt lds
s_add_u32 s64,s74,65536
s_add_u32 m0,s75,8192
s_nop 0
buffer_load_dwordx4 v8,s[32:35],s64 offen nt lds
s_add_u32 s64,s74,73728
s_add_u32 m0,s75,9216
s_nop 0
buffer_load_dwordx4 v9,s[32:35],s64 offen nt lds
s_add_u32 s64,s74,81920
s_add_u32 m0,s75,10240
s_nop 0
buffer_load_dwordx4 v8,s[32:35],s64 offen nt lds
s_add_u32 s64,s74,90112
s_add_u32 m0,s75,11264
s_nop 0
buffer_load_dwordx4 v9,s[32:35],s64 offen nt lds
s_add_u32 s64,s74,98304
s_add_u32 m0,s75,12288
s_nop 0
buffer_load_dwordx4 v8,s[32:35],s64 offen nt lds
s_add_u32 s64,s74,106496
s_add_u32 m0,s75,13312
s_nop 0
buffer_load_dwordx4 v9,s[32:35],s64 offen nt lds
s_add_u32 s64,s74,114688
s_add_u32 m0,s75,14336
s_nop 0
buffer_load_dwordx4 v8,s[32:35],s64 offen nt lds
s_add_u32 s64,s74,122880
s_add_u32 m0,s75,15360
s_nop 0
buffer_load_dwordx4 v9,s[32:35],s64 offen nt lds
s_add_u32 s64,s74,524288
s_add_u32 m0,s75,65536
s_nop 0
buffer_load_dwordx4 v8,s[32:35],s64 offen nt lds
s_add_u32 s64,s74,532480
s_add_u32 m0,s75,66560
s_nop 0
buffer_load_dwordx4 v9,s[32:35],s64 offen nt lds
s_add_u32 s64,s74,540672
s_add_u32 m0,s75,67584
s_nop 0
buffer_load_dwordx4 v8,s[32:35],s64 offen nt lds
s_add_u32 s64,s74,548864
s_add_u32 m0,s75,68608
s_nop 0
buffer_load_dwordx4 v9,s[32:35],s64 offen nt lds
s_add_u32 s64,s74,557056
s_add_u32 m0,s75,69632
s_nop 0
buffer_load_dwordx4 v8,s[32:35],s64 offen nt lds
s_add_u32 s64,s74,565248
s_add_u32 m0,s75,70656
s_nop 0
buffer_load_dwordx4 v9,s[32:35],s64 offen nt lds
s_add_u32 s64,s74,573440
s_add_u32 m0,s75,71680
s_nop 0
buffer_load_dwordx4 v8,s[32:35],s64 offen nt lds
s_add_u32 s64,s74,581632
s_add_u32 m0,s75,72704
s_nop 0
buffer_load_dwordx4 v9,s[32:35],s64 offen nt lds
s_add_u32 s64,s74,589824
s_add_u32 m0,s75,73728
s_nop 0
buffer_load_dwordx4 v8,s[32:35],s64 offen nt lds
s_add_u32 s64,s74,598016
s_add_u32 m0,s75,74752
s_nop 0
buffer_load_dwordx4 v9,s[32:35],s64 offen nt lds
s_add_u32 s64,s74,606208
s_add_u32 m0,s75,75776
s_nop 0
buffer_load_dwordx4 v8,s[32:35],s64 offen nt lds
s_add_u32 s64,s74,614400
s_add_u32 m0,s75,76800
s_nop 0
buffer_load_dwordx4 v9,s[32:35],s64 offen nt lds
s_add_u32 s64,s74,622592
s_add_u32 m0,s75,77824
s_nop 0
buffer_load_dwordx4 v8,s[32:35],s64 offen nt lds
s_add_u32 s64,s74,630784
s_add_u32 m0,s75,78848
s_nop 0
buffer_load_dwordx4 v9,s[32:35],s64 offen nt lds
s_add_u32 s64,s74,638976
s_add_u32 m0,s75,79872
s_nop 0
buffer_load_dwordx4 v8,s[32:35],s64 offen nt lds
s_add_u32 s64,s74,647168
s_add_u32 m0,s75,80896
s_nop 0
buffer_load_dwordx4 v9,s[32:35],s64 offen nt lds
s_waitcnt vmcnt(16)
s_barrier
ds_read_b64_tr_b16 a[0:1],v12 offset:0
ds_read_b64_tr_b16 a[128:129],v13 offset:0
ds_read_b64_tr_b16 a[2:3],v12 offset:4096
ds_read_b64_tr_b16 a[130:131],v13 offset:4096
ds_read_b64_tr_b16 a[4:5],v12 offset:8192
ds_read_b64_tr_b16 a[132:133],v13 offset:8192
ds_read_b64_tr_b16 a[6:7],v12 offset:12288
ds_read_b64_tr_b16 a[134:135],v13 offset:12288
s_waitcnt lgkmcnt(4)
ds_read_b64_tr_b16 a[8:9],v12 offset:16384
ds_read_b64_tr_b16 a[136:137],v13 offset:16384
ds_read_b64_tr_b16 a[10:11],v12 offset:20480
ds_read_b64_tr_b16 a[138:139],v13 offset:20480
ds_read_b64_tr_b16 a[12:13],v12 offset:24576
ds_read_b64_tr_b16 a[140:141],v13 offset:24576
ds_read_b64_tr_b16 a[14:15],v12 offset:28672
ds_read_b64_tr_b16 a[142:143],v13 offset:28672
s_waitcnt lgkmcnt(4)
ds_read_b64_tr_b16 a[16:17],v12 offset:32768
ds_read_b64_tr_b16 a[144:145],v13 offset:32768
ds_read_b64_tr_b16 a[18:19],v12 offset:36864
ds_read_b64_tr_b16 a[146:147],v13 offset:36864
ds_read_b64_tr_b16 a[20:21],v12 offset:40960
ds_read_b64_tr_b16 a[148:149],v13 offset:40960
ds_read_b64_tr_b16 a[22:23],v12 offset:45056
ds_read_b64_tr_b16 a[150:151],v13 offset:45056
s_waitcnt lgkmcnt(4)
ds_read_b64_tr_b16 a[24:25],v12 offset:49152
ds_read_b64_tr_b16 a[152:153],v13 offset:49152
ds_read_b64_tr_b16 a[26:27],v12 offset:53248
ds_read_b64_tr_b16 a[154:155],v13 offset:53248
ds_read_b64_tr_b16 a[28:29],v12 offset:57344
ds_read_b64_tr_b16 a[156:157],v13 offset:57344
ds_read_b64_tr_b16 a[30:31],v12 offset:61440
ds_read_b64_tr_b16 a[158:159],v13 offset:61440
s_waitcnt lgkmcnt(4)
v_xor_b32 v12,0x10000,v12
v_xor_b32 v13,0x10000,v13
s_waitcnt lgkmcnt(0)
s_barrier
s_add_u32 s64,s74,1048576
s_add_u32 m0,s75,0
s_nop 0
buffer_load_dwordx4 v8,s[32:35],s64 offen nt lds
s_add_u32 s64,s74,1056768
s_add_u32 m0,s75,1024
s_nop 0
buffer_load_dwordx4 v9,s[32:35],s64 offen nt lds
s_add_u32 s64,s74,1064960
s_add_u32 m0,s75,2048
s_nop 0
buffer_load_dwordx4 v8,s[32:35],s64 offen nt lds
s_add_u32 s64,s74,1073152
s_add_u32 m0,s75,3072
s_nop 0
buffer_load_dwordx4 v9,s[32:35],s64 offen nt lds
s_add_u32 s64,s74,1081344
s_add_u32 m0,s75,4096
s_nop 0
buffer_load_dwordx4 v8,s[32:35],s64 offen nt lds
s_add_u32 s64,s74,1089536
s_add_u32 m0,s75,5120
s_nop 0
buffer_load_dwordx4 v9,s[32:35],s64 offen nt lds
s_add_u32 s64,s74,1097728
s_add_u32 m0,s75,6144
s_nop 0
buffer_load_dwordx4 v8,s[32:35],s64 offen nt lds
s_add_u32 s64,s74,1105920
s_add_u32 m0,s75,7168
s_nop 0
buffer_load_dwordx4 v9,s[32:35],s64 offen nt lds
s_add_u32 s64,s74,1114112
s_add_u32 m0,s75,8192
s_nop 0
buffer_load_dwordx4 v8,s[32:35],s64 offen nt lds
s_add_u32 s64,s74,1122304
s_add_u32 m0,s75,9216
s_nop 0
buffer_load_dwordx4 v9,s[32:35],s64 offen nt lds
s_add_u32 s64,s74,1130496
s_add_u32 m0,s75,10240
s_nop 0
buffer_load_dwordx4 v8,s[32:35],s64 offen nt lds
s_add_u32 s64,s74,1138688
s_add_u32 m0,s75,11264
s_nop 0
buffer_load_dwordx4 v9,s[32:35],s64 offen nt lds
s_add_u32 s64,s74,1146880
s_add_u32 m0,s75,12288
s_nop 0
buffer_load_dwordx4 v8,s[32:35],s64 offen nt lds
s_add_u32 s64,s74,1155072
s_add_u32 m0,s75,13312
s_nop 0
buffer_load_dwordx4 v9,s[32:35],s64 offen nt lds
s_add_u32 s64,s74,1163264
s_add_u32 m0,s75,14336
s_nop 0
buffer_load_dwordx4 v8,s[32:35],s64 offen nt lds
s_add_u32 s64,s74,1171456
s_add_u32 m0,s75,15360
s_nop 0
buffer_load_dwordx4 v9,s[32:35],s64 offen nt lds
s_waitcnt vmcnt(16)
s_barrier
ds_read_b64_tr_b16 a[32:33],v12 offset:0
ds_read_b64_tr_b16 a[160:161],v13 offset:0
ds_read_b64_tr_b16 a[34:35],v12 offset:4096
ds_read_b64_tr_b16 a[162:163],v13 offset:4096
ds_read_b64_tr_b16 a[36:37],v12 offset:8192
ds_read_b64_tr_b16 a[164:165],v13 offset:8192
ds_read_b64_tr_b16 a[38:39],v12 offset:12288
ds_read_b64_tr_b16 a[166:167],v13 offset:12288
s_waitcnt lgkmcnt(4)
ds_read_b64_tr_b16 a[40:41],v12 offset:16384
ds_read_b64_tr_b16 a[168:169],v13 offset:16384
ds_read_b64_tr_b16 a[42:43],v12 offset:20480
ds_read_b64_tr_b16 a[170:171],v13 offset:20480
ds_read_b64_tr_b16 a[44:45],v12 offset:24576
ds_read_b64_tr_b16 a[172:173],v13 offset:24576
ds_read_b64_tr_b16 a[46:47],v12 offset:28672
ds_read_b64_tr_b16 a[174:175],v13 offset:28672
s_waitcnt lgkmcnt(4)
ds_read_b64_tr_b16 a[48:49],v12 offset:32768
ds_read_b64_tr_b16 a[176:177],v13 offset:32768
ds_read_b64_tr_b16 a[50:51],v12 offset:36864
ds_read_b64_tr_b16 a[178:179],v13 offset:36864
ds_read_b64_tr_b16 a[52:53],v12 offset:40960
ds_read_b64_tr_b16 a[180:181],v13 offset:40960
ds_read_b64_tr_b16 a[54:55],v12 offset:45056
ds_read_b64_tr_b16 a[182:183],v13 offset:45056
s_waitcnt lgkmcnt(4)
ds_read_b64_tr_b16 a[56:57],v12 offset:49152
ds_read_b64_tr_b16 a[184:185],v13 offset:49152
ds_read_b64_tr_b16 a[58:59],v12 offset:53248
ds_read_b64_tr_b16 a[186:187],v13 offset:53248
ds_read_b64_tr_b16 a[60:61],v12 offset:57344
ds_read_b64_tr_b16 a[188:189],v13 offset:57344
ds_read_b64_tr_b16 a[62:63],v12 offset:61440
ds_read_b64_tr_b16 a[190:191],v13 offset:61440
s_waitcnt lgkmcnt(4)
v_xor_b32 v12,0x10000,v12
v_xor_b32 v13,0x10000,v13
s_waitcnt lgkmcnt(0)
s_barrier
s_add_u32 s64,s74,1572864
s_add_u32 m0,s75,65536
s_nop 0
buffer_load_dwordx4 v8,s[32:35],s64 offen nt lds
s_add_u32 s64,s74,1581056
s_add_u32 m0,s75,66560
s_nop 0
buffer_load_dwordx4 v9,s[32:35],s64 offen nt lds
s_add_u32 s64,s74,1589248
s_add_u32 m0,s75,67584
s_nop 0
buffer_load_dwordx4 v8,s[32:35],s64 offen nt lds
s_add_u32 s64,s74,1597440
s_add_u32 m0,s75,68608
s_nop 0
buffer_load_dwordx4 v9,s[32:35],s64 offen nt lds
s_add_u32 s64,s74,1605632
s_add_u32 m0,s75,69632
s_nop 0
buffer_load_dwordx4 v8,s[32:35],s64 offen nt lds
s_add_u32 s64,s74,1613824
s_add_u32 m0,s75,70656
s_nop 0
buffer_load_dwordx4 v9,s[32:35],s64 offen nt lds
s_add_u32 s64,s74,1622016
s_add_u32 m0,s75,71680
s_nop 0
buffer_load_dwordx4 v8,s[32:35],s64 offen nt lds
s_add_u32 s64,s74,1630208
s_add_u32 m0,s75,72704
s_nop 0
buffer_load_dwordx4 v9,s[32:35],s64 offen nt lds
s_add_u32 s64,s74,1638400
s_add_u32 m0,s75,73728
s_nop 0
buffer_load_dwordx4 v8,s[32:35],s64 offen nt lds
s_add_u32 s64,s74,1646592
s_add_u32 m0,s75,74752
s_nop 0
buffer_load_dwordx4 v9,s[32:35],s64 offen nt lds
s_add_u32 s64,s74,1654784
s_add_u32 m0,s75,75776
s_nop 0
buffer_load_dwordx4 v8,s[32:35],s64 offen nt lds
s_add_u32 s64,s74,1662976
s_add_u32 m0,s75,76800
s_nop 0
buffer_load_dwordx4 v9,s[32:35],s64 offen nt lds
s_add_u32 s64,s74,1671168
s_add_u32 m0,s75,77824
s_nop 0
buffer_load_dwordx4 v8,s[32:35],s64 offen nt lds
s_add_u32 s64,s74,1679360
s_add_u32 m0,s75,78848
s_nop 0
buffer_load_dwordx4 v9,s[32:35],s64 offen nt lds
s_add_u32 s64,s74,1687552
s_add_u32 m0,s75,79872
s_nop 0
buffer_load_dwordx4 v8,s[32:35],s64 offen nt lds
s_add_u32 s64,s74,1695744
s_add_u32 m0,s75,80896
s_nop 0
buffer_load_dwordx4 v9,s[32:35],s64 offen nt lds
s_waitcnt vmcnt(16)
s_barrier
ds_read_b64_tr_b16 a[64:65],v12 offset:0
ds_read_b64_tr_b16 a[192:193],v13 offset:0
ds_read_b64_tr_b16 a[66:67],v12 offset:4096
ds_read_b64_tr_b16 a[194:195],v13 offset:4096
ds_read_b64_tr_b16 a[68:69],v12 offset:8192
ds_read_b64_tr_b16 a[196:197],v13 offset:8192
ds_read_b64_tr_b16 a[70:71],v12 offset:12288
ds_read_b64_tr_b16 a[198:199],v13 offset:12288
s_waitcnt lgkmcnt(4)
ds_read_b64_tr_b16 a[72:73],v12 offset:16384
ds_read_b64_tr_b16 a[200:201],v13 offset:16384
ds_read_b64_tr_b16 a[74:75],v12 offset:20480
ds_read_b64_tr_b16 a[202:203],v13 offset:20480
ds_read_b64_tr_b16 a[76:77],v12 offset:24576
ds_read_b64_tr_b16 a[204:205],v13 offset:24576
ds_read_b64_tr_b16 a[78:79],v12 offset:28672
ds_read_b64_tr_b16 a[206:207],v13 offset:28672
s_waitcnt lgkmcnt(4)
ds_read_b64_tr_b16 a[80:81],v12 offset:32768
ds_read_b64_tr_b16 a[208:209],v13 offset:32768
ds_read_b64_tr_b16 a[82:83],v12 offset:36864
ds_read_b64_tr_b16 a[210:211],v13 offset:36864
ds_read_b64_tr_b16 a[84:85],v12 offset:40960
ds_read_b64_tr_b16 a[212:213],v13 offset:40960
ds_read_b64_tr_b16 a[86:87],v12 offset:45056
ds_read_b64_tr_b16 a[214:215],v13 offset:45056
s_waitcnt lgkmcnt(4)
ds_read_b64_tr_b16 a[88:89],v12 offset:49152
ds_read_b64_tr_b16 a[216:217],v13 offset:49152
ds_read_b64_tr_b16 a[90:91],v12 offset:53248
ds_read_b64_tr_b16 a[218:219],v13 offset:53248
ds_read_b64_tr_b16 a[92:93],v12 offset:57344
ds_read_b64_tr_b16 a[220:221],v13 offset:57344
ds_read_b64_tr_b16 a[94:95],v12 offset:61440
ds_read_b64_tr_b16 a[222:223],v13 offset:61440
s_waitcnt lgkmcnt(4)
v_xor_b32 v12,0x10000,v12
v_xor_b32 v13,0x10000,v13
s_waitcnt lgkmcnt(0)
s_barrier
s_waitcnt vmcnt(0)
s_barrier
ds_read_b64_tr_b16 a[96:97],v12 offset:0
ds_read_b64_tr_b16 a[224:225],v13 offset:0
ds_read_b64_tr_b16 a[98:99],v12 offset:4096
ds_read_b64_tr_b16 a[226:227],v13 offset:4096
ds_read_b64_tr_b16 a[100:101],v12 offset:8192
ds_read_b64_tr_b16 a[228:229],v13 offset:8192
ds_read_b64_tr_b16 a[102:103],v12 offset:12288
ds_read_b64_tr_b16 a[230:231],v13 offset:12288
s_waitcnt lgkmcnt(4)
ds_read_b64_tr_b16 a[104:105],v12 offset:16384
ds_read_b64_tr_b16 a[232:233],v13 offset:16384
ds_read_b64_tr_b16 a[106:107],v12 offset:20480
ds_read_b64_tr_b16 a[234:235],v13 offset:20480
ds_read_b64_tr_b16 a[108:109],v12 offset:24576
ds_read_b64_tr_b16 a[236:237],v13 offset:24576
ds_read_b64_tr_b16 a[110:111],v12 offset:28672
ds_read_b64_tr_b16 a[238:239],v13 offset:28672
s_waitcnt lgkmcnt(4)
ds_read_b64_tr_b16 a[112:113],v12 offset:32768
ds_read_b64_tr_b16 a[240:241],v13 offset:32768
ds_read_b64_tr_b16 a[114:115],v12 offset:36864
ds_read_b64_tr_b16 a[242:243],v13 offset:36864
ds_read_b64_tr_b16 a[116:117],v12 offset:40960
ds_read_b64_tr_b16 a[244:245],v13 offset:40960
ds_read_b64_tr_b16 a[118:119],v12 offset:45056
ds_read_b64_tr_b16 a[246:247],v13 offset:45056
s_waitcnt lgkmcnt(4)
ds_read_b64_tr_b16 a[120:121],v12 offset:49152
ds_read_b64_tr_b16 a[248:249],v13 offset:49152
ds_read_b64_tr_b16 a[122:123],v12 offset:53248
ds_read_b64_tr_b16 a[250:251],v13 offset:53248
ds_read_b64_tr_b16 a[124:125],v12 offset:57344
ds_read_b64_tr_b16 a[252:253],v13 offset:57344
ds_read_b64_tr_b16 a[126:127],v12 offset:61440
ds_read_b64_tr_b16 a[254:255],v13 offset:61440
s_waitcnt lgkmcnt(4)
v_xor_b32 v12,0x10000,v12
v_xor_b32 v13,0x10000,v13
s_waitcnt lgkmcnt(0)
s_barrier
v_and_b32 v21,1,v1
v_mul_u32_u24 v21,960,v21
s_mov_b32 s65,21052032
s_mov_b32 s66,1792
pl_286:
buffer_load_dword v22,v21,s[20:23],s65 offen sc1
s_waitcnt vmcnt(0)
v_cmp_gt_u32 vcc,s66,v22
s_cbranch_vccz pok_287
s_sleep 1
s_sub_u32 s90,s90,1
s_cmp_gt_i32 s90,0
s_cbranch_scc1 pl_286
pok_287:
s_lshr_b32 s43,s41,1
s_and_b32 s48,s41,1
s_lshl_b32 s64,s42,7
s_lshl_b32 s65,s50,5
s_add_u32 s64,s64,s65
s_lshl_b32 s65,s48,4
s_add_u32 s64,s64,s65
v_lshl_add_u32 v5,v4,2,s64
v_lshlrev_b32 v6,2,v5
s_mov_b32 s64,8192
buffer_load_dwordx4 v[52:55],v6,s[20:23],s64 offen sc1
v_lshlrev_b32 v10,1,v5
v_and_b32 v6,3,v1
v_sub_u32 v5,v6,v4
v_lshl_add_u32 v5,v5,3,v10
v_lshrrev_b32 v11,2,v1
v_lshl_add_u32 v40,v6,4,v11
v_lshlrev_b32 v40,2,v40
v_lshl_add_u32 v41,v3,2,v4
v_lshlrev_b32 v41,2,v41
s_lshl_b32 s64,s43,10
v_add_u32 v17,s64,v16
v_xor_b32 v18,1024,v17
s_xor_b32 s64,s64,1024
s_lshr_b32 s65,s50,1
s_and_b32 s66,s50,1
s_lshl_b32 s66,s66,12
s_add_u32 s66,s66,s64
s_lshl_b32 s72,s65,13
s_add_u32 s72,s72,s66
s_add_u32 s72,s72,0x10000
s_lshl_b32 s65,s65,14
s_add_u32 s75,s65,s66
s_add_u32 s75,s75,524288
s_mul_i32 s64,s41,131072
s_add_u32 s75,s75,s64
s_cmp_lt_u32 s50,2
s_cselect_b32 s86,98304,0x40000000
s_lshl_b32 s76,s79,21
s_add_u32 s76,s76,27262976
s_mov_b32 s77,0
s_lshl_b32 s78,s79,16
s_mov_b32 s49,0
s_cmp_eq_u32 s79,0
s_mov_b32 s66,8577024
s_cselect_b32 s66,17825792,s66
s_lshl_b32 s64,s59,14
s_lshl_b32 s65,s50,12
s_add_u32 s65,s65,s66
s_add_u32 s64,s64,s65
v_add_u32 v26,s64,v16
s_lshl_b32 s64,s42,14
s_add_u32 s64,s64,s65
v_add_u32 v25,s64,v16
s_xor_b32 s33,s41,1
s_xor_b32 s34,s41,2
s_xor_b32 s35,s41,3
s_lshl_b32 s33,s33,17
s_lshl_b32 s34,s34,17
s_lshl_b32 s35,s35,17
v_and_b32 v21,7,v1
v_lshlrev_b32 v21,7,v21
v_bfe_u32 v6,v1,3,0
v_lshl_add_u32 v21,v6,2,v21
s_lshl_b32 s74,s41,10
s_add_u32 s74,s74,s63
s_lshl_b32 s64,s60,4
s_add_u32 s74,s74,s64
s_add_u32 s74,s74,16384
v_lshrrev_b32 v6,2,v11
v_and_b32 v7,3,v11
v_lshl_add_u32 v6,v6,1,s43
v_lshl_add_u32 v8,v6,2,v7
v_lshl_add_u32 v8,v8,7,v5
v_and_b32 v8,2047,v8
v_lshl_add_u32 v8,v7,11,v8
v_lshl_add_u32 v7,v7,11,v5
v_lshl_add_u32 v20,v6,13,v7
v_lshl_add_u32 v19,v6,14,v8
v_add_u32 v19,1048576,v19
s_lshl_b32 s73,s59,2
s_add_u32 s73,s73,s50
s_lshl_b32 s73,s73,2
s_add_u32 s73,s73,s63
s_add_u32 s73,s73,2048
s_mov_b32 s48,1
s_waitcnt vmcnt(0)
s_cmp_lg_u32 s56,0
s_cbranch_scc1 kslow_288
s_add_u32 s64,s79,0
s_lshl_b32 s70,s64,21
s_lshl_b32 s64,s64,13
s_and_b32 s64,s64,0x2000
s_xor_b32 s64,s64,s62
s_add_u32 s70,s70,s64
s_add_u32 s70,s70,29360128
s_mov_b32 s83,1
s_mov_b32 s87,s74
s_cmp_eq_u32 s50,0
s_cselect_b32 s74,s74,0x7fff0000
v_mov_b32 v47,132096
s_lshl_b32 s64,s50,3
s_add_u32 s64,s64,132096
v_mov_b32 v46,s64
v_mov_b32 v29,0
s_mov_b32 s97,0x7fff0000
s_mov_b32 s69,1
s_mov_b32 s68,0
s_mov_b32 s52,0x30003
s_mov_b32 s53,s52
seg_290:
s_cmp_eq_u32 s83,0
s_cbranch_scc1 ahead_291
s_add_u32 s94,s70,s75
s_xor_b32 s95,s94,1024
s_xor_b32 s91,s72,0x10000
s_waitcnt vmcnt(2)
v_cmp_gt_u32 vcc,s71,v29
s_cbranch_vccz nb_294
s_waitcnt vmcnt(0)
v_add_u32 v22,s71,-1
buffer_store_dword v22,v23,s[20:23],s97 offen sc1
s_mov_b32 s97,0x7fff0000
s_cmp_lg_u32 s50,0
s_cbranch_scc1 nb_294
buffer_load_dword v32,v21,s[20:23],s74 offen sc1
s_sleep 2
pl_296:
buffer_load_dword v33,v21,s[20:23],s74 offen sc1
s_waitcnt vmcnt(1)
v_cmp_gt_u32 vcc,s71,v32
v_mov_b32 v29,v32
s_cbranch_vccz pok_297
buffer_load_dword v32,v21,s[20:23],s74 offen sc1
s_waitcnt vmcnt(1)
v_cmp_gt_u32 vcc,s71,v33
v_mov_b32 v29,v33
s_cbranch_vccz pok_297
s_sub_u32 s90,s90,1
s_cmp_gt_i32 s90,0
s_cbranch_scc1 pl_296
pok_297:
nb_294:
s_barrier
s_xor_b32 m0,s91,0
s_add_u32 s65,s94,0
buffer_load_dwordx4 v16,s[20:23],s65 offen offset:0 sc1 lds
buffer_load_dwordx4 v16,s[20:23],s65 offen offset:2048 sc1 lds
s_xor_b32 m0,s91,16384
s_add_u32 s65,s94,32768
buffer_load_dwordx4 v16,s[20:23],s65 offen offset:0 sc1 lds
buffer_load_dwordx4 v16,s[20:23],s65 offen offset:2048 sc1 lds
s_xor_b32 m0,s91,32768
s_add_u32 s65,s94,65536
buffer_load_dwordx4 v16,s[20:23],s65 offen offset:0 sc1 lds
buffer_load_dwordx4 v16,s[20:23],s65 offen offset:2048 sc1 lds
s_xor_b32 m0,s91,49152
s_add_u32 s65,s94,98304
buffer_load_dwordx4 v16,s[20:23],s65 offen offset:0 sc1 lds
buffer_load_dwordx4 v16,s[20:23],s65 offen offset:2048 sc1 lds
s_waitcnt vmcnt(8)
v_add_u32 v22,s71,-1
buffer_store_dword v22,v23,s[20:23],s97 offen sc1
s_mov_b32 s97,0x7fff0000
s_waitcnt vmcnt(7)
s_barrier
ds_read_b128 v[224:227],v18 offset:0
ds_read_b128 v[228:231],v18 offset:2048
ds_read_b128 v[232:235],v18 offset:4096
ds_read_b128 v[236:239],v18 offset:6144
ds_read_b128 v[240:243],v18 offset:8192
ds_read_b128 v[244:247],v18 offset:10240
ds_read_b128 v[248:251],v18 offset:12288
s_waitcnt lgkmcnt(5)
v_mfma_f32_16x16x32_bf16 v[64:67],a[0:3],v[224:227],0
s_xor_b32 m0,s91,1024
s_add_u32 s96,s71,1
v_mfma_f32_16x16x32_bf16 v[68:71],a[128:131],v[224:227],0
ds_read_b128 v[252:255],v18 offset:14336
s_add_u32 s92,s71,2
v_mfma_f32_16x16x32_bf16 v[64:67],a[4:7],v[228:231],v[64:67]
s_add_u32 s65,s95,0
v_min_u32 v27,v224,v228
v_mfma_f32_16x16x32_bf16 v[68:71],a[132:135],v[228:231],v[68:71]
s_waitcnt vmcnt(5)
s_barrier
ds_read_b128 v[224:227],v18 offset:16384
s_waitcnt lgkmcnt(5)
v_mfma_f32_16x16x32_bf16 v[64:67],a[8:11],v[232:235],v[64:67]
buffer_load_dwordx4 v16,s[20:23],s65 offen offset:0 sc1 lds
v_mfma_f32_16x16x32_bf16 v[68:71],a[136:139],v[232:235],v[68:71]
ds_read_b128 v[228:231],v18 offset:18432
v_min3_u32 v27,v27,v232,v236
v_mfma_f32_16x16x32_bf16 v[64:67],a[12:15],v[236:239],v[64:67]
buffer_load_dwordx4 v16,s[20:23],s65 offen offset:2048 sc1 lds
v_mfma_f32_16x16x32_bf16 v[68:71],a[140:143],v[236:239],v[68:71]
ds_read_b128 v[232:235],v18 offset:20480
s_waitcnt lgkmcnt(5)
v_mfma_f32_16x16x32_bf16 v[64:67],a[16:19],v[240:243],v[64:67]
s_xor_b32 m0,s91,17408
v_min3_u32 v27,v27,v240,v244
v_mfma_f32_16x16x32_bf16 v[68:71],a[144:147],v[240:243],v[68:71]
ds_read_b128 v[236:239],v18 offset:22528
v_mfma_f32_16x16x32_bf16 v[64:67],a[20:23],v[244:247],v[64:67]
s_add_u32 s65,s95,32768
v_mfma_f32_16x16x32_bf16 v[68:71],a[148:151],v[244:247],v[68:71]
ds_read_b128 v[240:243],v18 offset:24576
s_waitcnt lgkmcnt(5)
v_mfma_f32_16x16x32_bf16 v[64:67],a[24:27],v[248:251],v[64:67]
buffer_load_dwordx4 v16,s[20:23],s65 offen offset:0 sc1 lds
v_mfma_f32_16x16x32_bf16 v[68:71],a[152:155],v[248:251],v[68:71]
ds_read_b128 v[244:247],v18 offset:26624
v_min3_u32 v27,v27,v248,v252
v_mfma_f32_16x16x32_bf16 v[64:67],a[28:31],v[252:255],v[64:67]
buffer_load_dwordx4 v16,s[20:23],s65 offen offset:2048 sc1 lds
v_mfma_f32_16x16x32_bf16 v[68:71],a[156:159],v[252:255],v[68:71]
ds_read_b128 v[248:251],v18 offset:28672
s_waitcnt lgkmcnt(5)
v_mfma_f32_16x16x32_bf16 v[64:67],a[32:35],v[224:227],v[64:67]
s_xor_b32 m0,s91,33792
v_min3_u32 v27,v27,v224,v228
v_mfma_f32_16x16x32_bf16 v[68:71],a[160:163],v[224:227],v[68:71]
ds_read_b128 v[252:255],v18 offset:30720
v_mfma_f32_16x16x32_bf16 v[64:67],a[36:39],v[228:231],v[64:67]
s_add_u32 s65,s95,65536
s_waitcnt vmcnt(63)
v_mfma_f32_16x16x32_bf16 v[68:71],a[164:167],v[228:231],v[68:71]
s_waitcnt vmcnt(5)
s_barrier
ds_read_b128 v[224:227],v18 offset:32768
s_waitcnt lgkmcnt(5)
v_mfma_f32_16x16x32_bf16 v[64:67],a[40:43],v[232:235],v[64:67]
buffer_load_dwordx4 v16,s[20:23],s65 offen offset:0 sc1 lds
v_min3_u32 v27,v27,v232,v236
v_mfma_f32_16x16x32_bf16 v[68:71],a[168:171],v[232:235],v[68:71]
ds_read_b128 v[228:231],v18 offset:34816
v_cmp_gt_u32 vcc,s96,v29
v_cmp_gt_u32 s[92:93],s92,v29
v_mfma_f32_16x16x32_bf16 v[64:67],a[44:47],v[236:239],v[64:67]
buffer_load_dwordx4 v16,s[20:23],s65 offen offset:2048 sc1 lds
v_mfma_f32_16x16x32_bf16 v[68:71],a[172:175],v[236:239],v[68:71]
ds_read_b128 v[232:235],v18 offset:36864
s_waitcnt lgkmcnt(5)
v_mfma_f32_16x16x32_bf16 v[64:67],a[48:51],v[240:243],v[64:67]
s_xor_b32 m0,s91,50176
v_mov_b32 v44,vcc_lo
v_mov_b32 v45,s92
v_mfma_f32_16x16x32_bf16 v[68:71],a[176:179],v[240:243],v[68:71]
ds_read_b128 v[236:239],v18 offset:38912
ds_write_b64 v46,v[44:45]
v_mfma_f32_16x16x32_bf16 v[64:67],a[52:55],v[244:247],v[64:67]
s_add_u32 s65,s95,98304
v_min3_u32 v27,v27,v240,v244
v_mfma_f32_16x16x32_bf16 v[68:71],a[180:183],v[244:247],v[68:71]
ds_read_b128 v[240:243],v18 offset:40960
s_waitcnt lgkmcnt(6)
v_mfma_f32_16x16x32_bf16 v[64:67],a[56:59],v[248:251],v[64:67]
buffer_load_dwordx4 v16,s[20:23],s65 offen offset:0 sc1 lds
v_mfma_f32_16x16x32_bf16 v[68:71],a[184:187],v[248:251],v[68:71]
ds_read_b128 v[244:247],v18 offset:43008
v_min3_u32 v27,v27,v248,v252
v_mfma_f32_16x16x32_bf16 v[64:67],a[60:63],v[252:255],v[64:67]
buffer_load_dwordx4 v16,s[20:23],s65 offen offset:2048 sc1 lds
v_mfma_f32_16x16x32_bf16 v[68:71],a[188:191],v[252:255],v[68:71]
ds_read_b128 v[248:251],v18 offset:45056
s_waitcnt lgkmcnt(6)
v_mfma_f32_16x16x32_bf16 v[64:67],a[64:67],v[224:227],v[64:67]
v_min3_u32 v27,v27,v224,v228
s_add_u32 s88,s70,s75
v_mfma_f32_16x16x32_bf16 v[68:71],a[192:195],v[224:227],v[68:71]
ds_read_b128 v[252:255],v18 offset:47104
s_add_u32 s88,s88,2097152
v_mfma_f32_16x16x32_bf16 v[64:67],a[68:71],v[228:231],v[64:67]
buffer_load_dwordx2 v[120:121],v20,s[36:39],s78 offen
v_mfma_f32_16x16x32_bf16 v[68:71],a[196:199],v[228:231],v[68:71]
ds_read_b128 v[224:227],v18 offset:49152
s_waitcnt lgkmcnt(6)
v_mfma_f32_16x16x32_bf16 v[64:67],a[72:75],v[232:235],v[64:67]
v_min3_u32 v27,v27,v232,v236
s_xor_b32 s88,s88,0x2000
v_mfma_f32_16x16x32_bf16 v[68:71],a[200:203],v[232:235],v[68:71]
ds_read_b128 v[228:231],v18 offset:51200
s_xor_b32 s89,s88,1024
v_mfma_f32_16x16x32_bf16 v[64:67],a[76:79],v[236:239],v[64:67]
v_mfma_f32_16x16x32_bf16 v[68:71],a[204:207],v[236:239],v[68:71]
ds_read_b128 v[232:235],v18 offset:53248
s_waitcnt lgkmcnt(5)
v_mfma_f32_16x16x32_bf16 v[64:67],a[80:83],v[240:243],v[64:67]
s_waitcnt vmcnt(5)
s_barrier
ds_read_b64 v[44:45],v47
ds_read_b128 v[128:131],v17 offset:0
ds_read_b128 v[132:135],v17 offset:2048
v_mfma_f32_16x16x32_bf16 v[68:71],a[208:211],v[240:243],v[68:71]
ds_read_b128 v[236:239],v18 offset:55296
v_min3_u32 v27,v27,v240,v244
v_mfma_f32_16x16x32_bf16 v[64:67],a[84:87],v[244:247],v[64:67]
ds_read_b128 v[136:139],v17 offset:4096
v_mfma_f32_16x16x32_bf16 v[68:71],a[212:215],v[244:247],v[68:71]
ds_read_b128 v[240:243],v18 offset:57344
s_waitcnt lgkmcnt(9)
v_mfma_f32_16x16x32_bf16 v[64:67],a[88:91],v[248:251],v[64:67]
ds_read_b128 v[140:143],v17 offset:6144
v_min3_u32 v27,v27,v248,v252
v_mfma_f32_16x16x32_bf16 v[68:71],a[216:219],v[248:251],v[68:71]
ds_read_b128 v[244:247],v18 offset:59392
v_mfma_f32_16x16x32_bf16 v[64:67],a[92:95],v[252:255],v[64:67]
ds_read_b128 v[144:147],v17 offset:8192
ds_read_b128 v[148:151],v17 offset:10240
v_mfma_f32_16x16x32_bf16 v[68:71],a[220:223],v[252:255],v[68:71]
ds_read_b128 v[248:251],v18 offset:61440
s_waitcnt lgkmcnt(12)
v_mfma_f32_16x16x32_bf16 v[64:67],a[96:99],v[224:227],v[64:67]
ds_read_b128 v[152:155],v17 offset:12288
s_waitcnt lgkmcnt(11)
v_min3_u32 v27,v27,v224,v228
v_mfma_f32_16x16x32_bf16 v[68:71],a[224:227],v[224:227],v[68:71]
ds_read_b128 v[252:255],v18 offset:63488
v_readfirstlane_b32 s93,v45
v_mfma_f32_16x16x32_bf16 v[64:67],a[100:103],v[228:231],v[64:67]
ds_read_b128 v[156:159],v17 offset:14336
v_readfirstlane_b32 s83,v44
s_cmp_lg_u32 s83,0
s_cbranch_scc0 keep_300
v_mfma_f32_16x16x32_bf16 v[68:71],a[228:231],v[228:231],v[68:71]
s_waitcnt lgkmcnt(10)
v_mfma_f32_16x16x32_bf16 v[64:67],a[104:107],v[232:235],v[64:67]
ds_read_b128 v[160:163],v17 offset:16384
ds_read_b128 v[164:167],v17 offset:18432
v_mfma_f32_16x16x32_bf16 v[68:71],a[232:235],v[232:235],v[68:71]
v_min3_u32 v27,v27,v232,v236
v_mfma_f32_16x16x32_bf16 v[64:67],a[108:111],v[236:239],v[64:67]
ds_read_b128 v[168:171],v17 offset:20480
v_mfma_f32_16x16x32_bf16 v[68:71],a[236:239],v[236:239],v[68:71]
s_waitcnt lgkmcnt(9)
v_mfma_f32_16x16x32_bf16 v[64:67],a[112:115],v[240:243],v[64:67]
ds_read_b128 v[172:175],v17 offset:22528
v_min3_u32 v27,v27,v240,v244
v_mfma_f32_16x16x32_bf16 v[68:71],a[240:243],v[240:243],v[68:71]
v_mfma_f32_16x16x32_bf16 v[64:67],a[116:119],v[244:247],v[64:67]
ds_read_b128 v[176:179],v17 offset:24576
ds_read_b128 v[180:183],v17 offset:26624
v_mfma_f32_16x16x32_bf16 v[68:71],a[244:247],v[244:247],v[68:71]
s_waitcnt lgkmcnt(7)
v_mfma_f32_16x16x32_bf16 v[64:67],a[120:123],v[248:251],v[64:67]
ds_read_b128 v[184:187],v17 offset:28672
v_min3_u32 v27,v27,v248,v252
v_mfma_f32_16x16x32_bf16 v[68:71],a[248:251],v[248:251],v[68:71]
v_mfma_f32_16x16x32_bf16 v[64:67],a[124:127],v[252:255],v[64:67]
ds_read_b128 v[188:191],v17 offset:30720
v_mfma_f32_16x16x32_bf16 v[68:71],a[252:255],v[252:255],v[68:71]
v_mfma_f32_16x16x32_bf16 v[72:75],a[128:131],v[128:131],0
v_cmp_eq_u32 vcc,0,v27
s_cbranch_vccnz retry_289
v_mfma_f32_16x16x32_bf16 v[76:79],a[132:135],v[132:135],0
v_min3_u32 v27,v27,v128,v132
v_mfma_f32_16x16x32_bf16 v[72:75],a[136:139],v[136:139],v[72:75]
s_waitcnt vmcnt(1)
s_barrier
ds_read_b128 v[192:195],v17 offset:32768
v_mfma_f32_16x16x32_bf16 v[76:79],a[140:143],v[140:143],v[76:79]
ds_read_b128 v[196:199],v17 offset:34816
s_waitcnt lgkmcnt(10)
v_mfma_f32_16x16x32_bf16 v[72:75],a[144:147],v[144:147],v[72:75]
ds_read_b128 v[200:203],v17 offset:36864
v_min3_u32 v27,v27,v136,v140
s_waitcnt vmcnt(0)
v_mfma_f32_16x16x32_bf16 v[76:79],a[148:151],v[148:151],v[76:79]
ds_read_b128 v[204:207],v17 offset:38912
v_min3_u32 v27,v27,v144,v148
v_and_or_b32 v64,v64,-4,s48
v_mfma_f32_16x16x32_bf16 v[72:75],a[152:155],v[152:155],v[72:75]
ds_read_b128 v[208:211],v17 offset:40960
s_add_u32 s64,s49,s34
v_mfma_f32_16x16x32_bf16 v[76:79],a[156:159],v[156:159],v[76:79]
v_min3_u32 v27,v27,v152,v156
s_waitcnt lgkmcnt(9)
v_mfma_f32_16x16x32_bf16 v[72:75],a[160:163],v[160:163],v[72:75]
ds_read_b128 v[212:215],v17 offset:43008
buffer_store_dwordx4 v[64:67],v25,s[20:23],s64 offen offset:2048
v_mfma_f32_16x16x32_bf16 v[76:79],a[164:167],v[164:167],v[76:79]
ds_read_b128 v[216:219],v17 offset:45056
v_min3_u32 v27,v27,v160,v164
v_and_or_b32 v68,v68,-4,s48
v_mfma_f32_16x16x32_bf16 v[72:75],a[168:171],v[168:171],v[72:75]
ds_read_b128 v[220:223],v17 offset:47104
s_add_u32 s64,s49,s35
v_mfma_f32_16x16x32_bf16 v[76:79],a[172:175],v[172:175],v[76:79]
ds_read_b128 v[224:227],v17 offset:49152
s_waitcnt lgkmcnt(9)
v_mfma_f32_16x16x32_bf16 v[72:75],a[176:179],v[176:179],v[72:75]
ds_read_b128 v[228:231],v17 offset:51200
v_min3_u32 v27,v27,v168,v172
v_mfma_f32_16x16x32_bf16 v[76:79],a[180:183],v[180:183],v[76:79]
v_min3_u32 v27,v27,v176,v180
buffer_store_dwordx4 v[68:71],v25,s[20:23],s64 offen offset:3072
v_mfma_f32_16x16x32_bf16 v[72:75],a[184:187],v[184:187],v[72:75]
ds_read_b128 v[232:235],v17 offset:53248
s_mov_b32 s49,0x7fff0000
v_mfma_f32_16x16x32_bf16 v[76:79],a[188:191],v[188:191],v[76:79]
ds_read_b128 v[236:239],v17 offset:55296
s_waitcnt lgkmcnt(8)
v_mfma_f32_16x16x32_bf16 v[72:75],a[192:195],v[192:195],v[72:75]
ds_read_b128 v[240:243],v17 offset:57344
v_min3_u32 v27,v27,v184,v188
v_mfma_f32_16x16x32_bf16 v[76:79],a[196:199],v[196:199],v[76:79]
ds_read_b128 v[244:247],v17 offset:59392
v_min3_u32 v27,v27,v192,v196
v_mfma_f32_16x16x32_bf16 v[72:75],a[200:203],v[200:203],v[72:75]
ds_read_b128 v[248:251],v17 offset:61440
ds_bpermute_b32 v124,v41,v120
v_mfma_f32_16x16x32_bf16 v[76:79],a[204:207],v[204:207],v[76:79]
v_min3_u32 v27,v27,v200,v204
s_waitcnt lgkmcnt(8)
v_mfma_f32_16x16x32_bf16 v[72:75],a[208:211],v[208:211],v[72:75]
ds_read_b128 v[252:255],v17 offset:63488
ds_bpermute_b32 v125,v41,v121
v_mfma_f32_16x16x32_bf16 v[76:79],a[212:215],v[212:215],v[76:79]
v_min3_u32 v27,v27,v208,v212
v_mfma_f32_16x16x32_bf16 v[72:75],a[216:219],v[216:219],v[72:75]
v_mfma_f32_16x16x32_bf16 v[76:79],a[220:223],v[220:223],v[76:79]
v_min3_u32 v27,v27,v216,v220
s_waitcnt lgkmcnt(6)
v_mfma_f32_16x16x32_bf16 v[72:75],a[224:227],v[224:227],v[72:75]
s_waitcnt lgkmcnt(0)
v_mfma_f32_16x16x32_bf16 v[76:79],a[228:231],v[228:231],v[76:79]
v_min3_u32 v27,v27,v224,v228
v_mfma_f32_16x16x32_bf16 v[72:75],a[232:235],v[232:235],v[72:75]
v_lshlrev_b32 v104,16,v124
v_mfma_f32_16x16x32_bf16 v[76:79],a[236:239],v[236:239],v[76:79]
v_min3_u32 v27,v27,v232,v236
v_mfma_f32_16x16x32_bf16 v[72:75],a[240:243],v[240:243],v[72:75]
v_mfma_f32_16x16x32_bf16 v[76:79],a[244:247],v[244:247],v[76:79]
v_min3_u32 v27,v27,v240,v244
v_mfma_f32_16x16x32_bf16 v[72:75],a[248:251],v[248:251],v[72:75]
v_and_b32 v105,s80,v124
v_mfma_f32_16x16x32_bf16 v[76:79],a[252:255],v[252:255],v[76:79]
v_min3_u32 v27,v27,v248,v252
v_mfma_f32_16x16x32_bf16 v[80:83],a[0:3],v[128:131],0
v_cmp_eq_u32 vcc,0,v27
s_cbranch_vccnz retry_289
v_mfma_f32_16x16x32_bf16 v[84:87],a[4:7],v[132:135],0
v_lshlrev_b32 v106,16,v125
v_mfma_f32_16x16x32_bf16 v[80:83],a[8:11],v[136:139],v[80:83]
v_mfma_f32_16x16x32_bf16 v[84:87],a[12:15],v[140:143],v[84:87]
v_mfma_f32_16x16x32_bf16 v[80:83],a[16:19],v[144:147],v[80:83]
v_and_b32 v107,s80,v125
v_add_f32 v72,v72,v76
v_mfma_f32_16x16x32_bf16 v[84:87],a[20:23],v[148:151],v[84:87]
v_add_f32 v73,v73,v77
v_add_f32 v74,v74,v78
v_mfma_f32_16x16x32_bf16 v[80:83],a[24:27],v[152:155],v[80:83]
v_add_f32 v75,v75,v79
v_and_or_b32 v72,v72,-4,s48
v_mfma_f32_16x16x32_bf16 v[84:87],a[28:31],v[156:159],v[84:87]
s_add_u32 s64,s77,s33
v_mfma_f32_16x16x32_bf16 v[80:83],a[32:35],v[160:163],v[80:83]
buffer_store_dwordx4 v[72:75],v25,s[20:23],s64 offen offset:1024
v_mfma_f32_16x16x32_bf16 v[84:87],a[36:39],v[164:167],v[84:87]
v_mfma_f32_16x16x32_bf16 v[80:83],a[40:43],v[168:171],v[80:83]
v_mfma_f32_16x16x32_bf16 v[84:87],a[44:47],v[172:175],v[84:87]
v_mfma_f32_16x16x32_bf16 v[80:83],a[48:51],v[176:179],v[80:83]
v_mfma_f32_16x16x32_bf16 v[84:87],a[52:55],v[180:183],v[84:87]
v_mfma_f32_16x16x32_bf16 v[80:83],a[56:59],v[184:187],v[80:83]
v_mfma_f32_16x16x32_bf16 v[84:87],a[60:63],v[188:191],v[84:87]
v_mfma_f32_16x16x32_bf16 v[80:83],a[64:67],v[192:195],v[80:83]
buffer_load_dwordx4 v[96:99],v26,s[20:23],s77 offen offset:2048 sc1
v_mfma_f32_16x16x32_bf16 v[84:87],a[68:71],v[196:199],v[84:87]
buffer_load_dwordx4 v[100:103],v26,s[20:23],s77 offen offset:3072 sc1
v_mfma_f32_16x16x32_bf16 v[80:83],a[72:75],v[200:203],v[80:83]
v_mfma_f32_16x16x32_bf16 v[84:87],a[76:79],v[204:207],v[84:87]
v_mfma_f32_16x16x32_bf16 v[80:83],a[80:83],v[208:211],v[80:83]
v_mfma_f32_16x16x32_bf16 v[84:87],a[84:87],v[212:215],v[84:87]
v_mfma_f32_16x16x32_bf16 v[80:83],a[88:91],v[216:219],v[80:83]
v_mfma_f32_16x16x32_bf16 v[84:87],a[92:95],v[220:223],v[84:87]
v_mfma_f32_16x16x32_bf16 v[80:83],a[96:99],v[224:227],v[80:83]
v_mfma_f32_16x16x32_bf16 v[84:87],a[100:103],v[228:231],v[84:87]
v_mfma_f32_16x16x32_bf16 v[80:83],a[104:107],v[232:235],v[80:83]
buffer_load_dwordx4 v[92:95],v26,s[20:23],s77 offen offset:1024 sc1
v_mfma_f32_16x16x32_bf16 v[84:87],a[108:111],v[236:239],v[84:87]
v_mfma_f32_16x16x32_bf16 v[80:83],a[112:115],v[240:243],v[80:83]
v_mfma_f32_16x16x32_bf16 v[84:87],a[116:119],v[244:247],v[84:87]
v_mfma_f32_16x16x32_bf16 v[80:83],a[120:123],v[248:251],v[80:83]
v_mfma_f32_16x16x32_bf16 v[84:87],a[124:127],v[252:255],v[84:87]
s_branch epi_292
keep_300:
v_mfma_f32_16x16x32_bf16 v[68:71],a[228:231],v[228:231],v[68:71]
s_xor_b32 m0,s72,0
s_waitcnt lgkmcnt(10)
v_mfma_f32_16x16x32_bf16 v[64:67],a[104:107],v[232:235],v[64:67]
ds_read_b128 v[160:163],v17 offset:16384
ds_read_b128 v[164:167],v17 offset:18432
s_add_u32 s65,s88,0
v_mfma_f32_16x16x32_bf16 v[68:71],a[232:235],v[232:235],v[68:71]
buffer_load_dwordx4 v16,s[20:23],s65 offen offset:0 sc1 lds
v_min3_u32 v27,v27,v232,v236
v_mfma_f32_16x16x32_bf16 v[64:67],a[108:111],v[236:239],v[64:67]
ds_read_b128 v[168:171],v17 offset:20480
buffer_load_dwordx4 v16,s[20:23],s65 offen offset:2048 sc1 lds
v_mfma_f32_16x16x32_bf16 v[68:71],a[236:239],v[236:239],v[68:71]
s_xor_b32 m0,s72,16384
s_waitcnt lgkmcnt(9)
v_mfma_f32_16x16x32_bf16 v[64:67],a[112:115],v[240:243],v[64:67]
ds_read_b128 v[172:175],v17 offset:22528
v_min3_u32 v27,v27,v240,v244
v_mfma_f32_16x16x32_bf16 v[68:71],a[240:243],v[240:243],v[68:71]
s_add_u32 s65,s88,32768
v_mfma_f32_16x16x32_bf16 v[64:67],a[116:119],v[244:247],v[64:67]
ds_read_b128 v[176:179],v17 offset:24576
ds_read_b128 v[180:183],v17 offset:26624
v_mfma_f32_16x16x32_bf16 v[68:71],a[244:247],v[244:247],v[68:71]
buffer_load_dwordx4 v16,s[20:23],s65 offen offset:0 sc1 lds
s_waitcnt lgkmcnt(7)
v_mfma_f32_16x16x32_bf16 v[64:67],a[120:123],v[248:251],v[64:67]
ds_read_b128 v[184:187],v17 offset:28672
buffer_load_dwordx4 v16,s[20:23],s65 offen offset:2048 sc1 lds
v_mfma_f32_16x16x32_bf16 v[68:71],a[248:251],v[248:251],v[68:71]
s_xor_b32 m0,s72,32768
s_add_u32 s65,s88,65536
v_mfma_f32_16x16x32_bf16 v[64:67],a[124:127],v[252:255],v[64:67]
ds_read_b128 v[188:191],v17 offset:30720
v_min3_u32 v27,v27,v248,v252
v_mfma_f32_16x16x32_bf16 v[68:71],a[252:255],v[252:255],v[68:71]
buffer_load_dwordx4 v16,s[20:23],s65 offen offset:0 sc1 lds
v_mfma_f32_16x16x32_bf16 v[72:75],a[128:131],v[128:131],0
buffer_load_dwordx4 v16,s[20:23],s65 offen offset:2048 sc1 lds
v_mfma_f32_16x16x32_bf16 v[76:79],a[132:135],v[132:135],0
s_xor_b32 m0,s72,49152
v_cmp_eq_u32 vcc,0,v27
s_cbranch_vccnz retry_289
v_mfma_f32_16x16x32_bf16 v[72:75],a[136:139],v[136:139],v[72:75]
s_waitcnt vmcnt(7)
s_barrier
ds_read_b128 v[192:195],v17 offset:32768
v_mfma_f32_16x16x32_bf16 v[76:79],a[140:143],v[140:143],v[76:79]
ds_read_b128 v[196:199],v17 offset:34816
s_add_u32 s65,s88,98304
s_waitcnt lgkmcnt(10)
v_mfma_f32_16x16x32_bf16 v[72:75],a[144:147],v[144:147],v[72:75]
ds_read_b128 v[200:203],v17 offset:36864
buffer_load_dwordx4 v16,s[20:23],s65 offen offset:0 sc1 lds
s_waitcnt vmcnt(7)
v_mfma_f32_16x16x32_bf16 v[76:79],a[148:151],v[148:151],v[76:79]
ds_read_b128 v[204:207],v17 offset:38912
buffer_load_dwordx4 v16,s[20:23],s65 offen offset:2048 sc1 lds
v_and_or_b32 v64,v64,-4,s48
v_mfma_f32_16x16x32_bf16 v[72:75],a[152:155],v[152:155],v[72:75]
ds_read_b128 v[208:211],v17 offset:40960
s_xor_b32 m0,s72,1024
s_add_u32 s64,s49,s34
v_mfma_f32_16x16x32_bf16 v[76:79],a[156:159],v[156:159],v[76:79]
s_add_u32 s65,s89,0
buffer_store_dwordx4 v[64:67],v25,s[20:23],s64 offen offset:2048
s_waitcnt lgkmcnt(9)
v_mfma_f32_16x16x32_bf16 v[72:75],a[160:163],v[160:163],v[72:75]
ds_read_b128 v[212:215],v17 offset:43008
buffer_load_dwordx4 v16,s[20:23],s65 offen offset:0 sc1 lds
v_and_or_b32 v68,v68,-4,s48
v_mfma_f32_16x16x32_bf16 v[76:79],a[164:167],v[164:167],v[76:79]
ds_read_b128 v[216:219],v17 offset:45056
v_min3_u32 v27,v27,v128,v132
s_add_u32 s64,s49,s35
v_mfma_f32_16x16x32_bf16 v[72:75],a[168:171],v[168:171],v[72:75]
ds_read_b128 v[220:223],v17 offset:47104
buffer_load_dwordx4 v16,s[20:23],s65 offen offset:2048 sc1 lds
v_mfma_f32_16x16x32_bf16 v[76:79],a[172:175],v[172:175],v[76:79]
ds_read_b128 v[224:227],v17 offset:49152
s_xor_b32 m0,s72,17408
s_waitcnt lgkmcnt(9)
v_mfma_f32_16x16x32_bf16 v[72:75],a[176:179],v[176:179],v[72:75]
ds_read_b128 v[228:231],v17 offset:51200
s_add_u32 s65,s89,32768
buffer_store_dwordx4 v[68:71],v25,s[20:23],s64 offen offset:3072
v_mfma_f32_16x16x32_bf16 v[76:79],a[180:183],v[180:183],v[76:79]
buffer_load_dwordx4 v16,s[20:23],s65 offen offset:0 sc1 lds
s_mov_b32 s49,0x7fff0000
v_mfma_f32_16x16x32_bf16 v[72:75],a[184:187],v[184:187],v[72:75]
ds_read_b128 v[232:235],v17 offset:53248
v_min3_u32 v27,v27,v136,v140
v_mfma_f32_16x16x32_bf16 v[76:79],a[188:191],v[188:191],v[76:79]
ds_read_b128 v[236:239],v17 offset:55296
s_waitcnt lgkmcnt(8)
v_mfma_f32_16x16x32_bf16 v[72:75],a[192:195],v[192:195],v[72:75]
ds_read_b128 v[240:243],v17 offset:57344
buffer_load_dwordx4 v16,s[20:23],s65 offen offset:2048 sc1 lds
v_mfma_f32_16x16x32_bf16 v[76:79],a[196:199],v[196:199],v[76:79]
ds_read_b128 v[244:247],v17 offset:59392
s_xor_b32 m0,s72,33792
v_mfma_f32_16x16x32_bf16 v[72:75],a[200:203],v[200:203],v[72:75]
ds_read_b128 v[248:251],v17 offset:61440
s_add_u32 s65,s89,65536
v_mfma_f32_16x16x32_bf16 v[76:79],a[204:207],v[204:207],v[76:79]
v_min3_u32 v27,v27,v144,v148
s_waitcnt lgkmcnt(7)
v_mfma_f32_16x16x32_bf16 v[72:75],a[208:211],v[208:211],v[72:75]
ds_read_b128 v[252:255],v17 offset:63488
v_min3_u32 v27,v27,v152,v156
v_mfma_f32_16x16x32_bf16 v[76:79],a[212:215],v[212:215],v[76:79]
buffer_load_dwordx4 v16,s[20:23],s65 offen offset:0 sc1 lds
v_mfma_f32_16x16x32_bf16 v[72:75],a[216:219],v[216:219],v[72:75]
buffer_load_dwordx4 v16,s[20:23],s65 offen offset:2048 sc1 lds
v_mfma_f32_16x16x32_bf16 v[76:79],a[220:223],v[220:223],v[76:79]
s_xor_b32 m0,s72,50176
s_waitcnt lgkmcnt(4)
v_mfma_f32_16x16x32_bf16 v[72:75],a[224:227],v[224:227],v[72:75]
s_add_u32 s65,s89,98304
v_min3_u32 v27,v27,v160,v164
v_mfma_f32_16x16x32_bf16 v[76:79],a[228:231],v[228:231],v[76:79]
buffer_load_dwordx4 v16,s[20:23],s65 offen offset:0 sc1 lds
v_mfma_f32_16x16x32_bf16 v[72:75],a[232:235],v[232:235],v[72:75]
buffer_load_dwordx4 v16,s[20:23],s65 offen offset:2048 sc1 lds
v_mfma_f32_16x16x32_bf16 v[76:79],a[236:239],v[236:239],v[76:79]
v_min3_u32 v27,v27,v168,v172
s_waitcnt lgkmcnt(0)
v_mfma_f32_16x16x32_bf16 v[72:75],a[240:243],v[240:243],v[72:75]
v_min3_u32 v27,v27,v176,v180
v_min3_u32 v27,v27,v184,v188
v_mfma_f32_16x16x32_bf16 v[76:79],a[244:247],v[244:247],v[76:79]
v_min3_u32 v27,v27,v192,v196
v_min3_u32 v27,v27,v200,v204
v_min3_u32 v27,v27,v240,v244
v_mfma_f32_16x16x32_bf16 v[72:75],a[248:251],v[248:251],v[72:75]
v_min3_u32 v27,v27,v208,v212
v_min3_u32 v27,v27,v216,v220
v_mfma_f32_16x16x32_bf16 v[76:79],a[252:255],v[252:255],v[76:79]
v_min3_u32 v27,v27,v224,v228
v_min3_u32 v27,v27,v232,v236
v_min3_u32 v27,v27,v248,v252
v_mfma_f32_16x16x32_bf16 v[80:83],a[0:3],v[128:131],0
v_cmp_eq_u32 vcc,0,v27
s_cbranch_vccnz retry_289
v_mfma_f32_16x16x32_bf16 v[84:87],a[4:7],v[132:135],0
ds_bpermute_b32 v124,v41,v120
ds_bpermute_b32 v125,v41,v121
v_mfma_f32_16x16x32_bf16 v[80:83],a[8:11],v[136:139],v[80:83]
s_waitcnt lgkmcnt(0)
v_lshlrev_b32 v104,16,v124
v_mfma_f32_16x16x32_bf16 v[84:87],a[12:15],v[140:143],v[84:87]
v_and_b32 v105,s80,v124
v_lshlrev_b32 v106,16,v125
v_mfma_f32_16x16x32_bf16 v[80:83],a[16:19],v[144:147],v[80:83]
v_and_b32 v107,s80,v125
v_add_f32 v72,v72,v76
v_mfma_f32_16x16x32_bf16 v[84:87],a[20:23],v[148:151],v[84:87]
v_add_f32 v73,v73,v77
v_add_f32 v74,v74,v78
v_mfma_f32_16x16x32_bf16 v[80:83],a[24:27],v[152:155],v[80:83]
v_add_f32 v75,v75,v79
v_and_or_b32 v72,v72,-4,s48
v_mfma_f32_16x16x32_bf16 v[84:87],a[28:31],v[156:159],v[84:87]
s_add_u32 s64,s77,s33
v_mfma_f32_16x16x32_bf16 v[80:83],a[32:35],v[160:163],v[80:83]
buffer_store_dwordx4 v[72:75],v25,s[20:23],s64 offen offset:1024
v_mfma_f32_16x16x32_bf16 v[84:87],a[36:39],v[164:167],v[84:87]
v_mfma_f32_16x16x32_bf16 v[80:83],a[40:43],v[168:171],v[80:83]
v_mfma_f32_16x16x32_bf16 v[84:87],a[44:47],v[172:175],v[84:87]
v_mfma_f32_16x16x32_bf16 v[80:83],a[48:51],v[176:179],v[80:83]
v_mfma_f32_16x16x32_bf16 v[84:87],a[52:55],v[180:183],v[84:87]
v_mfma_f32_16x16x32_bf16 v[80:83],a[56:59],v[184:187],v[80:83]
v_mfma_f32_16x16x32_bf16 v[84:87],a[60:63],v[188:191],v[84:87]
v_mfma_f32_16x16x32_bf16 v[80:83],a[64:67],v[192:195],v[80:83]
buffer_load_dwordx4 v[96:99],v26,s[20:23],s77 offen offset:2048 sc1
v_mfma_f32_16x16x32_bf16 v[84:87],a[68:71],v[196:199],v[84:87]
buffer_load_dwordx4 v[100:103],v26,s[20:23],s77 offen offset:3072 sc1
v_mfma_f32_16x16x32_bf16 v[80:83],a[72:75],v[200:203],v[80:83]
v_mfma_f32_16x16x32_bf16 v[84:87],a[76:79],v[204:207],v[84:87]
v_mfma_f32_16x16x32_bf16 v[80:83],a[80:83],v[208:211],v[80:83]
v_mfma_f32_16x16x32_bf16 v[84:87],a[84:87],v[212:215],v[84:87]
v_mfma_f32_16x16x32_bf16 v[80:83],a[88:91],v[216:219],v[80:83]
v_mfma_f32_16x16x32_bf16 v[84:87],a[92:95],v[220:223],v[84:87]
v_mfma_f32_16x16x32_bf16 v[80:83],a[96:99],v[224:227],v[80:83]
v_mfma_f32_16x16x32_bf16 v[84:87],a[100:103],v[228:231],v[84:87]
v_mfma_f32_16x16x32_bf16 v[80:83],a[104:107],v[232:235],v[80:83]
buffer_load_dwordx4 v[92:95],v26,s[20:23],s77 offen offset:1024 sc1
v_mfma_f32_16x16x32_bf16 v[84:87],a[108:111],v[236:239],v[84:87]
v_mfma_f32_16x16x32_bf16 v[80:83],a[112:115],v[240:243],v[80:83]
v_mfma_f32_16x16x32_bf16 v[84:87],a[116:119],v[244:247],v[84:87]
v_mfma_f32_16x16x32_bf16 v[80:83],a[120:123],v[248:251],v[80:83]
v_mfma_f32_16x16x32_bf16 v[84:87],a[124:127],v[252:255],v[84:87]
s_branch epi_292
ahead_291:
s_cmp_eq_u32 s93,0
s_cbranch_scc1 both_293
s_waitcnt vmcnt(15) lgkmcnt(0)
s_barrier
ds_read_b128 v[224:227],v18 offset:0
ds_read_b128 v[228:231],v18 offset:2048
ds_read_b128 v[232:235],v18 offset:4096
ds_read_b128 v[236:239],v18 offset:6144
ds_read_b128 v[240:243],v18 offset:8192
ds_read_b128 v[244:247],v18 offset:10240
ds_read_b128 v[248:251],v18 offset:12288
s_waitcnt lgkmcnt(5)
v_mfma_f32_16x16x32_bf16 v[64:67],a[0:3],v[224:227],0
s_add_u32 s96,s71,1
s_add_u32 s92,s71,2
v_mfma_f32_16x16x32_bf16 v[68:71],a[128:131],v[224:227],0
ds_read_b128 v[252:255],v18 offset:14336
v_min_u32 v27,v224,v228
v_mfma_f32_16x16x32_bf16 v[64:67],a[4:7],v[228:231],v[64:67]
buffer_load_dwordx2 v[120:121],v20,s[36:39],s78 offen
v_mfma_f32_16x16x32_bf16 v[68:71],a[132:135],v[228:231],v[68:71]
ds_read_b128 v[224:227],v18 offset:16384
s_waitcnt lgkmcnt(5)
v_mfma_f32_16x16x32_bf16 v[64:67],a[8:11],v[232:235],v[64:67]
v_min3_u32 v27,v27,v232,v236
v_mfma_f32_16x16x32_bf16 v[68:71],a[136:139],v[232:235],v[68:71]
ds_read_b128 v[228:231],v18 offset:18432
v_mfma_f32_16x16x32_bf16 v[64:67],a[12:15],v[236:239],v[64:67]
v_mfma_f32_16x16x32_bf16 v[68:71],a[140:143],v[236:239],v[68:71]
ds_read_b128 v[232:235],v18 offset:20480
s_waitcnt lgkmcnt(5)
v_mfma_f32_16x16x32_bf16 v[64:67],a[16:19],v[240:243],v[64:67]
v_min3_u32 v27,v27,v240,v244
v_mfma_f32_16x16x32_bf16 v[68:71],a[144:147],v[240:243],v[68:71]
ds_read_b128 v[236:239],v18 offset:22528
v_mfma_f32_16x16x32_bf16 v[64:67],a[20:23],v[244:247],v[64:67]
v_mfma_f32_16x16x32_bf16 v[68:71],a[148:151],v[244:247],v[68:71]
ds_read_b128 v[240:243],v18 offset:24576
s_waitcnt lgkmcnt(5)
v_mfma_f32_16x16x32_bf16 v[64:67],a[24:27],v[248:251],v[64:67]
v_min3_u32 v27,v27,v248,v252
v_mfma_f32_16x16x32_bf16 v[68:71],a[152:155],v[248:251],v[68:71]
ds_read_b128 v[244:247],v18 offset:26624
v_mfma_f32_16x16x32_bf16 v[64:67],a[28:31],v[252:255],v[64:67]
v_mfma_f32_16x16x32_bf16 v[68:71],a[156:159],v[252:255],v[68:71]
ds_read_b128 v[248:251],v18 offset:28672
s_waitcnt lgkmcnt(5)
v_mfma_f32_16x16x32_bf16 v[64:67],a[32:35],v[224:227],v[64:67]
v_min3_u32 v27,v27,v224,v228
v_mfma_f32_16x16x32_bf16 v[68:71],a[160:163],v[224:227],v[68:71]
ds_read_b128 v[252:255],v18 offset:30720
v_mfma_f32_16x16x32_bf16 v[64:67],a[36:39],v[228:231],v[64:67]
s_waitcnt vmcnt(3)
v_mfma_f32_16x16x32_bf16 v[68:71],a[164:167],v[228:231],v[68:71]
ds_read_b128 v[224:227],v18 offset:32768
s_waitcnt lgkmcnt(5)
v_mfma_f32_16x16x32_bf16 v[64:67],a[40:43],v[232:235],v[64:67]
v_cmp_gt_u32 vcc,s96,v29
v_cmp_gt_u32 s[92:93],s92,v29
v_mfma_f32_16x16x32_bf16 v[68:71],a[168:171],v[232:235],v[68:71]
ds_read_b128 v[228:231],v18 offset:34816
v_min3_u32 v27,v27,v232,v236
v_mfma_f32_16x16x32_bf16 v[64:67],a[44:47],v[236:239],v[64:67]
v_mov_b32 v44,vcc_lo
v_mov_b32 v45,s92
v_mfma_f32_16x16x32_bf16 v[68:71],a[172:175],v[236:239],v[68:71]
ds_read_b128 v[232:235],v18 offset:36864
s_waitcnt lgkmcnt(5)
v_mfma_f32_16x16x32_bf16 v[64:67],a[48:51],v[240:243],v[64:67]
ds_write_b64 v46,v[44:45]
v_min3_u32 v27,v27,v240,v244
v_mfma_f32_16x16x32_bf16 v[68:71],a[176:179],v[240:243],v[68:71]
ds_read_b128 v[236:239],v18 offset:38912
v_mfma_f32_16x16x32_bf16 v[64:67],a[52:55],v[244:247],v[64:67]
v_mfma_f32_16x16x32_bf16 v[68:71],a[180:183],v[244:247],v[68:71]
ds_read_b128 v[240:243],v18 offset:40960
s_waitcnt lgkmcnt(6)
v_mfma_f32_16x16x32_bf16 v[64:67],a[56:59],v[248:251],v[64:67]
v_min3_u32 v27,v27,v248,v252
s_add_u32 s88,s70,s75
v_mfma_f32_16x16x32_bf16 v[68:71],a[184:187],v[248:251],v[68:71]
ds_read_b128 v[244:247],v18 offset:43008
s_add_u32 s88,s88,2097152
v_mfma_f32_16x16x32_bf16 v[64:67],a[60:63],v[252:255],v[64:67]
s_xor_b32 s88,s88,0x2000
s_xor_b32 s89,s88,1024
v_mfma_f32_16x16x32_bf16 v[68:71],a[188:191],v[252:255],v[68:71]
ds_read_b128 v[248:251],v18 offset:45056
s_waitcnt lgkmcnt(6)
v_mfma_f32_16x16x32_bf16 v[64:67],a[64:67],v[224:227],v[64:67]
v_min3_u32 v27,v27,v224,v228
v_mfma_f32_16x16x32_bf16 v[68:71],a[192:195],v[224:227],v[68:71]
ds_read_b128 v[252:255],v18 offset:47104
v_mfma_f32_16x16x32_bf16 v[64:67],a[68:71],v[228:231],v[64:67]
v_mfma_f32_16x16x32_bf16 v[68:71],a[196:199],v[228:231],v[68:71]
ds_read_b128 v[224:227],v18 offset:49152
s_waitcnt lgkmcnt(5)
v_mfma_f32_16x16x32_bf16 v[64:67],a[72:75],v[232:235],v[64:67]
v_min3_u32 v27,v27,v232,v236
v_mfma_f32_16x16x32_bf16 v[68:71],a[200:203],v[232:235],v[68:71]
ds_read_b128 v[228:231],v18 offset:51200
v_mfma_f32_16x16x32_bf16 v[64:67],a[76:79],v[236:239],v[64:67]
v_mfma_f32_16x16x32_bf16 v[68:71],a[204:207],v[236:239],v[68:71]
ds_read_b128 v[232:235],v18 offset:53248
s_waitcnt lgkmcnt(5)
v_mfma_f32_16x16x32_bf16 v[64:67],a[80:83],v[240:243],v[64:67]
s_waitcnt vmcnt(8)
s_barrier
ds_read_b64 v[44:45],v47
ds_read_b128 v[128:131],v17 offset:0
ds_read_b128 v[132:135],v17 offset:2048
v_mfma_f32_16x16x32_bf16 v[68:71],a[208:211],v[240:243],v[68:71]
ds_read_b128 v[236:239],v18 offset:55296
v_min3_u32 v27,v27,v240,v244
v_mfma_f32_16x16x32_bf16 v[64:67],a[84:87],v[244:247],v[64:67]
ds_read_b128 v[136:139],v17 offset:4096
v_mfma_f32_16x16x32_bf16 v[68:71],a[212:215],v[244:247],v[68:71]
ds_read_b128 v[240:243],v18 offset:57344
s_waitcnt lgkmcnt(9)
v_mfma_f32_16x16x32_bf16 v[64:67],a[88:91],v[248:251],v[64:67]
ds_read_b128 v[140:143],v17 offset:6144
v_min3_u32 v27,v27,v248,v252
v_mfma_f32_16x16x32_bf16 v[68:71],a[216:219],v[248:251],v[68:71]
ds_read_b128 v[244:247],v18 offset:59392
v_mfma_f32_16x16x32_bf16 v[64:67],a[92:95],v[252:255],v[64:67]
ds_read_b128 v[144:147],v17 offset:8192
ds_read_b128 v[148:151],v17 offset:10240
v_mfma_f32_16x16x32_bf16 v[68:71],a[220:223],v[252:255],v[68:71]
ds_read_b128 v[248:251],v18 offset:61440
s_waitcnt lgkmcnt(12)
v_mfma_f32_16x16x32_bf16 v[64:67],a[96:99],v[224:227],v[64:67]
ds_read_b128 v[152:155],v17 offset:12288
s_waitcnt lgkmcnt(11)
v_min3_u32 v27,v27,v224,v228
v_mfma_f32_16x16x32_bf16 v[68:71],a[224:227],v[224:227],v[68:71]
ds_read_b128 v[252:255],v18 offset:63488
v_readfirstlane_b32 s93,v45
v_mfma_f32_16x16x32_bf16 v[64:67],a[100:103],v[228:231],v[64:67]
ds_read_b128 v[156:159],v17 offset:14336
v_readfirstlane_b32 s83,v44
s_cmp_lg_u32 s83,0
s_cbranch_scc1 keep_301
v_mfma_f32_16x16x32_bf16 v[68:71],a[228:231],v[228:231],v[68:71]
s_waitcnt vmcnt(1)
s_xor_b32 m0,s72,0
s_waitcnt lgkmcnt(10)
v_mfma_f32_16x16x32_bf16 v[64:67],a[104:107],v[232:235],v[64:67]
ds_read_b128 v[160:163],v17 offset:16384
ds_read_b128 v[164:167],v17 offset:18432
s_add_u32 s65,s88,0
v_min3_u32 v27,v27,v232,v236
v_mfma_f32_16x16x32_bf16 v[68:71],a[232:235],v[232:235],v[68:71]
v_add_u32 v22,s71,-1
buffer_load_dwordx4 v16,s[20:23],s65 offen offset:0 sc1 lds
v_mfma_f32_16x16x32_bf16 v[64:67],a[108:111],v[236:239],v[64:67]
ds_read_b128 v[168:171],v17 offset:20480
buffer_load_dwordx4 v16,s[20:23],s65 offen offset:2048 sc1 lds
v_mfma_f32_16x16x32_bf16 v[68:71],a[236:239],v[236:239],v[68:71]
s_xor_b32 m0,s72,16384
s_waitcnt lgkmcnt(9)
v_mfma_f32_16x16x32_bf16 v[64:67],a[112:115],v[240:243],v[64:67]
ds_read_b128 v[172:175],v17 offset:22528
v_min3_u32 v27,v27,v240,v244
v_mfma_f32_16x16x32_bf16 v[68:71],a[240:243],v[240:243],v[68:71]
buffer_store_dword v22,v23,s[20:23],s97 offen sc1
s_add_u32 s65,s88,32768
v_mfma_f32_16x16x32_bf16 v[64:67],a[116:119],v[244:247],v[64:67]
ds_read_b128 v[176:179],v17 offset:24576
ds_read_b128 v[180:183],v17 offset:26624
v_mfma_f32_16x16x32_bf16 v[68:71],a[244:247],v[244:247],v[68:71]
s_mov_b32 s97,0x7fff0000
s_waitcnt lgkmcnt(7)
v_mfma_f32_16x16x32_bf16 v[64:67],a[120:123],v[248:251],v[64:67]
ds_read_b128 v[184:187],v17 offset:28672
buffer_load_dwordx4 v16,s[20:23],s65 offen offset:0 sc1 lds
v_mfma_f32_16x16x32_bf16 v[68:71],a[248:251],v[248:251],v[68:71]
buffer_load_dwordx4 v16,s[20:23],s65 offen offset:2048 sc1 lds
s_xor_b32 m0,s72,32768
v_mfma_f32_16x16x32_bf16 v[64:67],a[124:127],v[252:255],v[64:67]
ds_read_b128 v[188:191],v17 offset:30720
s_add_u32 s65,s88,65536
v_min3_u32 v27,v27,v248,v252
v_mfma_f32_16x16x32_bf16 v[68:71],a[252:255],v[252:255],v[68:71]
buffer_load_dwordx4 v16,s[20:23],s65 offen offset:0 sc1 lds
v_mfma_f32_16x16x32_bf16 v[72:75],a[128:131],v[128:131],0
buffer_load_dwordx4 v16,s[20:23],s65 offen offset:2048 sc1 lds
v_mfma_f32_16x16x32_bf16 v[76:79],a[132:135],v[132:135],0
s_xor_b32 m0,s72,49152
v_cmp_eq_u32 vcc,0,v27
s_cbranch_vccnz retry_289
v_mfma_f32_16x16x32_bf16 v[72:75],a[136:139],v[136:139],v[72:75]
ds_read_b128 v[192:195],v17 offset:32768
s_add_u32 s65,s88,98304
v_mfma_f32_16x16x32_bf16 v[76:79],a[140:143],v[140:143],v[76:79]
ds_read_b128 v[196:199],v17 offset:34816
s_waitcnt lgkmcnt(10)
v_mfma_f32_16x16x32_bf16 v[72:75],a[144:147],v[144:147],v[72:75]
ds_read_b128 v[200:203],v17 offset:36864
buffer_load_dwordx4 v16,s[20:23],s65 offen offset:0 sc1 lds
s_waitcnt vmcnt(8)
v_mfma_f32_16x16x32_bf16 v[76:79],a[148:151],v[148:151],v[76:79]
ds_read_b128 v[204:207],v17 offset:38912
buffer_load_dwordx4 v16,s[20:23],s65 offen offset:2048 sc1 lds
v_and_or_b32 v64,v64,-4,s48
v_mfma_f32_16x16x32_bf16 v[72:75],a[152:155],v[152:155],v[72:75]
ds_read_b128 v[208:211],v17 offset:40960
s_xor_b32 m0,s72,1024
s_add_u32 s64,s49,s34
v_mfma_f32_16x16x32_bf16 v[76:79],a[156:159],v[156:159],v[76:79]
s_add_u32 s65,s89,0
buffer_store_dwordx4 v[64:67],v25,s[20:23],s64 offen offset:2048
s_waitcnt lgkmcnt(9)
v_mfma_f32_16x16x32_bf16 v[72:75],a[160:163],v[160:163],v[72:75]
ds_read_b128 v[212:215],v17 offset:43008
buffer_load_dwordx4 v16,s[20:23],s65 offen offset:0 sc1 lds
v_and_or_b32 v68,v68,-4,s48
v_mfma_f32_16x16x32_bf16 v[76:79],a[164:167],v[164:167],v[76:79]
ds_read_b128 v[216:219],v17 offset:45056
v_min3_u32 v27,v27,v128,v132
s_add_u32 s64,s49,s35
v_mfma_f32_16x16x32_bf16 v[72:75],a[168:171],v[168:171],v[72:75]
ds_read_b128 v[220:223],v17 offset:47104
buffer_load_dwordx4 v16,s[20:23],s65 offen offset:2048 sc1 lds
v_mfma_f32_16x16x32_bf16 v[76:79],a[172:175],v[172:175],v[76:79]
ds_read_b128 v[224:227],v17 offset:49152
s_xor_b32 m0,s72,17408
s_waitcnt lgkmcnt(9)
v_mfma_f32_16x16x32_bf16 v[72:75],a[176:179],v[176:179],v[72:75]
ds_read_b128 v[228:231],v17 offset:51200
s_add_u32 s65,s89,32768
buffer_store_dwordx4 v[68:71],v25,s[20:23],s64 offen offset:3072
v_mfma_f32_16x16x32_bf16 v[76:79],a[180:183],v[180:183],v[76:79]
buffer_load_dwordx4 v16,s[20:23],s65 offen offset:0 sc1 lds
s_mov_b32 s49,0x7fff0000
v_mfma_f32_16x16x32_bf16 v[72:75],a[184:187],v[184:187],v[72:75]
ds_read_b128 v[232:235],v17 offset:53248
v_min3_u32 v27,v27,v136,v140
v_mfma_f32_16x16x32_bf16 v[76:79],a[188:191],v[188:191],v[76:79]
ds_read_b128 v[236:239],v17 offset:55296
s_waitcnt lgkmcnt(8)
v_mfma_f32_16x16x32_bf16 v[72:75],a[192:195],v[192:195],v[72:75]
ds_read_b128 v[240:243],v17 offset:57344
buffer_load_dwordx4 v16,s[20:23],s65 offen offset:2048 sc1 lds
v_mfma_f32_16x16x32_bf16 v[76:79],a[196:199],v[196:199],v[76:79]
ds_read_b128 v[244:247],v17 offset:59392
s_xor_b32 m0,s72,33792
v_mfma_f32_16x16x32_bf16 v[72:75],a[200:203],v[200:203],v[72:75]
ds_read_b128 v[248:251],v17 offset:61440
s_add_u32 s65,s89,65536
v_mfma_f32_16x16x32_bf16 v[76:79],a[204:207],v[204:207],v[76:79]
v_min3_u32 v27,v27,v144,v148
s_waitcnt lgkmcnt(7)
v_mfma_f32_16x16x32_bf16 v[72:75],a[208:211],v[208:211],v[72:75]
ds_read_b128 v[252:255],v17 offset:63488
v_min3_u32 v27,v27,v152,v156
v_mfma_f32_16x16x32_bf16 v[76:79],a[212:215],v[212:215],v[76:79]
buffer_load_dwordx4 v16,s[20:23],s65 offen offset:0 sc1 lds
v_mfma_f32_16x16x32_bf16 v[72:75],a[216:219],v[216:219],v[72:75]
buffer_load_dwordx4 v16,s[20:23],s65 offen offset:2048 sc1 lds
v_mfma_f32_16x16x32_bf16 v[76:79],a[220:223],v[220:223],v[76:79]
s_xor_b32 m0,s72,50176
s_waitcnt lgkmcnt(4)
v_mfma_f32_16x16x32_bf16 v[72:75],a[224:227],v[224:227],v[72:75]
s_add_u32 s65,s89,98304
v_min3_u32 v27,v27,v160,v164
v_mfma_f32_16x16x32_bf16 v[76:79],a[228:231],v[228:231],v[76:79]
buffer_load_dwordx4 v16,s[20:23],s65 offen offset:0 sc1 lds
v_mfma_f32_16x16x32_bf16 v[72:75],a[232:235],v[232:235],v[72:75]
buffer_load_dwordx4 v16,s[20:23],s65 offen offset:2048 sc1 lds
v_mfma_f32_16x16x32_bf16 v[76:79],a[236:239],v[236:239],v[76:79]
v_min3_u32 v27,v27,v168,v172
s_waitcnt lgkmcnt(0)
v_mfma_f32_16x16x32_bf16 v[72:75],a[240:243],v[240:243],v[72:75]
v_min3_u32 v27,v27,v176,v180
v_min3_u32 v27,v27,v184,v188
v_mfma_f32_16x16x32_bf16 v[76:79],a[244:247],v[244:247],v[76:79]
v_min3_u32 v27,v27,v192,v196
v_min3_u32 v27,v27,v200,v204
v_min3_u32 v27,v27,v240,v244
v_mfma_f32_16x16x32_bf16 v[72:75],a[248:251],v[248:251],v[72:75]
v_min3_u32 v27,v27,v208,v212
v_min3_u32 v27,v27,v216,v220
v_mfma_f32_16x16x32_bf16 v[76:79],a[252:255],v[252:255],v[76:79]
v_min3_u32 v27,v27,v224,v228
v_min3_u32 v27,v27,v232,v236
v_min3_u32 v27,v27,v248,v252
v_mfma_f32_16x16x32_bf16 v[80:83],a[0:3],v[128:131],0
v_cmp_eq_u32 vcc,0,v27
s_cbranch_vccnz retry_289
v_mfma_f32_16x16x32_bf16 v[84:87],a[4:7],v[132:135],0
ds_bpermute_b32 v124,v41,v120
ds_bpermute_b32 v125,v41,v121
v_mfma_f32_16x16x32_bf16 v[80:83],a[8:11],v[136:139],v[80:83]
s_waitcnt lgkmcnt(0)
v_lshlrev_b32 v104,16,v124
v_mfma_f32_16x16x32_bf16 v[84:87],a[12:15],v[140:143],v[84:87]
v_and_b32 v105,s80,v124
v_lshlrev_b32 v106,16,v125
v_mfma_f32_16x16x32_bf16 v[80:83],a[16:19],v[144:147],v[80:83]
v_and_b32 v107,s80,v125
v_add_f32 v72,v72,v76
v_mfma_f32_16x16x32_bf16 v[84:87],a[20:23],v[148:151],v[84:87]
v_add_f32 v73,v73,v77
v_add_f32 v74,v74,v78
v_mfma_f32_16x16x32_bf16 v[80:83],a[24:27],v[152:155],v[80:83]
v_add_f32 v75,v75,v79
v_and_or_b32 v72,v72,-4,s48
v_mfma_f32_16x16x32_bf16 v[84:87],a[28:31],v[156:159],v[84:87]
s_add_u32 s64,s77,s33
v_mfma_f32_16x16x32_bf16 v[80:83],a[32:35],v[160:163],v[80:83]
buffer_store_dwordx4 v[72:75],v25,s[20:23],s64 offen offset:1024
v_mfma_f32_16x16x32_bf16 v[84:87],a[36:39],v[164:167],v[84:87]
v_mfma_f32_16x16x32_bf16 v[80:83],a[40:43],v[168:171],v[80:83]
v_mfma_f32_16x16x32_bf16 v[84:87],a[44:47],v[172:175],v[84:87]
v_mfma_f32_16x16x32_bf16 v[80:83],a[48:51],v[176:179],v[80:83]
v_mfma_f32_16x16x32_bf16 v[84:87],a[52:55],v[180:183],v[84:87]
v_mfma_f32_16x16x32_bf16 v[80:83],a[56:59],v[184:187],v[80:83]
v_mfma_f32_16x16x32_bf16 v[84:87],a[60:63],v[188:191],v[84:87]
v_mfma_f32_16x16x32_bf16 v[80:83],a[64:67],v[192:195],v[80:83]
buffer_load_dwordx4 v[96:99],v26,s[20:23],s77 offen offset:2048 sc1
v_mfma_f32_16x16x32_bf16 v[84:87],a[68:71],v[196:199],v[84:87]
buffer_load_dwordx4 v[100:103],v26,s[20:23],s77 offen offset:3072 sc1
v_mfma_f32_16x16x32_bf16 v[80:83],a[72:75],v[200:203],v[80:83]
v_mfma_f32_16x16x32_bf16 v[84:87],a[76:79],v[204:207],v[84:87]
v_mfma_f32_16x16x32_bf16 v[80:83],a[80:83],v[208:211],v[80:83]
v_mfma_f32_16x16x32_bf16 v[84:87],a[84:87],v[212:215],v[84:87]
v_mfma_f32_16x16x32_bf16 v[80:83],a[88:91],v[216:219],v[80:83]
v_mfma_f32_16x16x32_bf16 v[84:87],a[92:95],v[220:223],v[84:87]
v_mfma_f32_16x16x32_bf16 v[80:83],a[96:99],v[224:227],v[80:83]
v_mfma_f32_16x16x32_bf16 v[84:87],a[100:103],v[228:231],v[84:87]
v_mfma_f32_16x16x32_bf16 v[80:83],a[104:107],v[232:235],v[80:83]
buffer_load_dwordx4 v[92:95],v26,s[20:23],s77 offen offset:1024 sc1
v_mfma_f32_16x16x32_bf16 v[84:87],a[108:111],v[236:239],v[84:87]
v_mfma_f32_16x16x32_bf16 v[80:83],a[112:115],v[240:243],v[80:83]
v_mfma_f32_16x16x32_bf16 v[84:87],a[116:119],v[244:247],v[84:87]
v_mfma_f32_16x16x32_bf16 v[80:83],a[120:123],v[248:251],v[80:83]
v_mfma_f32_16x16x32_bf16 v[84:87],a[124:127],v[252:255],v[84:87]
s_branch epi_292
keep_301:
v_mfma_f32_16x16x32_bf16 v[68:71],a[228:231],v[228:231],v[68:71]
s_waitcnt vmcnt(1)
s_waitcnt lgkmcnt(10)
v_mfma_f32_16x16x32_bf16 v[64:67],a[104:107],v[232:235],v[64:67]
ds_read_b128 v[160:163],v17 offset:16384
ds_read_b128 v[164:167],v17 offset:18432
v_mfma_f32_16x16x32_bf16 v[68:71],a[232:235],v[232:235],v[68:71]
v_add_u32 v22,s71,-1
v_min3_u32 v27,v27,v232,v236
v_mfma_f32_16x16x32_bf16 v[64:67],a[108:111],v[236:239],v[64:67]
ds_read_b128 v[168:171],v17 offset:20480
v_mfma_f32_16x16x32_bf16 v[68:71],a[236:239],v[236:239],v[68:71]
s_waitcnt lgkmcnt(9)
v_mfma_f32_16x16x32_bf16 v[64:67],a[112:115],v[240:243],v[64:67]
ds_read_b128 v[172:175],v17 offset:22528
v_min3_u32 v27,v27,v240,v244
v_mfma_f32_16x16x32_bf16 v[68:71],a[240:243],v[240:243],v[68:71]
buffer_store_dword v22,v23,s[20:23],s97 offen sc1
v_mfma_f32_16x16x32_bf16 v[64:67],a[116:119],v[244:247],v[64:67]
ds_read_b128 v[176:179],v17 offset:24576
ds_read_b128 v[180:183],v17 offset:26624
v_mfma_f32_16x16x32_bf16 v[68:71],a[244:247],v[244:247],v[68:71]
s_mov_b32 s97,0x7fff0000
s_waitcnt lgkmcnt(7)
v_mfma_f32_16x16x32_bf16 v[64:67],a[120:123],v[248:251],v[64:67]
ds_read_b128 v[184:187],v17 offset:28672
v_min3_u32 v27,v27,v248,v252
v_mfma_f32_16x16x32_bf16 v[68:71],a[248:251],v[248:251],v[68:71]
v_mfma_f32_16x16x32_bf16 v[64:67],a[124:127],v[252:255],v[64:67]
ds_read_b128 v[188:191],v17 offset:30720
v_mfma_f32_16x16x32_bf16 v[68:71],a[252:255],v[252:255],v[68:71]
v_mfma_f32_16x16x32_bf16 v[72:75],a[128:131],v[128:131],0
v_cmp_eq_u32 vcc,0,v27
s_cbranch_vccnz retry_289
v_mfma_f32_16x16x32_bf16 v[76:79],a[132:135],v[132:135],0
v_min3_u32 v27,v27,v128,v132
v_mfma_f32_16x16x32_bf16 v[72:75],a[136:139],v[136:139],v[72:75]
ds_read_b128 v[192:195],v17 offset:32768
v_mfma_f32_16x16x32_bf16 v[76:79],a[140:143],v[140:143],v[76:79]
ds_read_b128 v[196:199],v17 offset:34816
s_waitcnt lgkmcnt(10)
v_mfma_f32_16x16x32_bf16 v[72:75],a[144:147],v[144:147],v[72:75]
ds_read_b128 v[200:203],v17 offset:36864
v_min3_u32 v27,v27,v136,v140
s_waitcnt vmcnt(1)
v_mfma_f32_16x16x32_bf16 v[76:79],a[148:151],v[148:151],v[76:79]
ds_read_b128 v[204:207],v17 offset:38912
v_min3_u32 v27,v27,v144,v148
v_and_or_b32 v64,v64,-4,s48
v_mfma_f32_16x16x32_bf16 v[72:75],a[152:155],v[152:155],v[72:75]
ds_read_b128 v[208:211],v17 offset:40960
s_add_u32 s64,s49,s34
v_mfma_f32_16x16x32_bf16 v[76:79],a[156:159],v[156:159],v[76:79]
v_min3_u32 v27,v27,v152,v156
s_waitcnt lgkmcnt(9)
v_mfma_f32_16x16x32_bf16 v[72:75],a[160:163],v[160:163],v[72:75]
ds_read_b128 v[212:215],v17 offset:43008
buffer_store_dwordx4 v[64:67],v25,s[20:23],s64 offen offset:2048
v_mfma_f32_16x16x32_bf16 v[76:79],a[164:167],v[164:167],v[76:79]
ds_read_b128 v[216:219],v17 offset:45056
v_min3_u32 v27,v27,v160,v164
v_and_or_b32 v68,v68,-4,s48
v_mfma_f32_16x16x32_bf16 v[72:75],a[168:171],v[168:171],v[72:75]
ds_read_b128 v[220:223],v17 offset:47104
s_add_u32 s64,s49,s35
v_mfma_f32_16x16x32_bf16 v[76:79],a[172:175],v[172:175],v[76:79]
ds_read_b128 v[224:227],v17 offset:49152
s_waitcnt lgkmcnt(9)
v_mfma_f32_16x16x32_bf16 v[72:75],a[176:179],v[176:179],v[72:75]
ds_read_b128 v[228:231],v17 offset:51200
v_min3_u32 v27,v27,v168,v172
v_mfma_f32_16x16x32_bf16 v[76:79],a[180:183],v[180:183],v[76:79]
v_min3_u32 v27,v27,v176,v180
buffer_store_dwordx4 v[68:71],v25,s[20:23],s64 offen offset:3072
v_mfma_f32_16x16x32_bf16 v[72:75],a[184:187],v[184:187],v[72:75]
ds_read_b128 v[232:235],v17 offset:53248
s_mov_b32 s49,0x7fff0000
v_mfma_f32_16x16x32_bf16 v[76:79],a[188:191],v[188:191],v[76:79]
ds_read_b128 v[236:239],v17 offset:55296
s_waitcnt lgkmcnt(8)
v_mfma_f32_16x16x32_bf16 v[72:75],a[192:195],v[192:195],v[72:75]
ds_read_b128 v[240:243],v17 offset:57344
v_min3_u32 v27,v27,v184,v188
v_mfma_f32_16x16x32_bf16 v[76:79],a[196:199],v[196:199],v[76:79]
ds_read_b128 v[244:247],v17 offset:59392
v_min3_u32 v27,v27,v192,v196
v_mfma_f32_16x16x32_bf16 v[72:75],a[200:203],v[200:203],v[72:75]
ds_read_b128 v[248:251],v17 offset:61440
ds_bpermute_b32 v124,v41,v120
v_mfma_f32_16x16x32_bf16 v[76:79],a[204:207],v[204:207],v[76:79]
v_min3_u32 v27,v27,v200,v204
s_waitcnt lgkmcnt(8)
v_mfma_f32_16x16x32_bf16 v[72:75],a[208:211],v[208:211],v[72:75]
ds_read_b128 v[252:255],v17 offset:63488
ds_bpermute_b32 v125,v41,v121
v_mfma_f32_16x16x32_bf16 v[76:79],a[212:215],v[212:215],v[76:79]
v_min3_u32 v27,v27,v208,v212
v_mfma_f32_16x16x32_bf16 v[72:75],a[216:219],v[216:219],v[72:75]
v_mfma_f32_16x16x32_bf16 v[76:79],a[220:223],v[220:223],v[76:79]
v_min3_u32 v27,v27,v216,v220
s_waitcnt lgkmcnt(6)
v_mfma_f32_16x16x32_bf16 v[72:75],a[224:227],v[224:227],v[72:75]
s_waitcnt lgkmcnt(0)
v_mfma_f32_16x16x32_bf16 v[76:79],a[228:231],v[228:231],v[76:79]
v_min3_u32 v27,v27,v224,v228
v_mfma_f32_16x16x32_bf16 v[72:75],a[232:235],v[232:235],v[72:75]
v_lshlrev_b32 v104,16,v124
v_mfma_f32_16x16x32_bf16 v[76:79],a[236:239],v[236:239],v[76:79]
v_min3_u32 v27,v27,v232,v236
v_mfma_f32_16x16x32_bf16 v[72:75],a[240:243],v[240:243],v[72:75]
v_mfma_f32_16x16x32_bf16 v[76:79],a[244:247],v[244:247],v[76:79]
v_min3_u32 v27,v27,v240,v244
v_mfma_f32_16x16x32_bf16 v[72:75],a[248:251],v[248:251],v[72:75]
v_and_b32 v105,s80,v124
v_mfma_f32_16x16x32_bf16 v[76:79],a[252:255],v[252:255],v[76:79]
v_min3_u32 v27,v27,v248,v252
v_mfma_f32_16x16x32_bf16 v[80:83],a[0:3],v[128:131],0
v_cmp_eq_u32 vcc,0,v27
s_cbranch_vccnz retry_289
v_mfma_f32_16x16x32_bf16 v[84:87],a[4:7],v[132:135],0
v_lshlrev_b32 v106,16,v125
v_mfma_f32_16x16x32_bf16 v[80:83],a[8:11],v[136:139],v[80:83]
v_mfma_f32_16x16x32_bf16 v[84:87],a[12:15],v[140:143],v[84:87]
v_mfma_f32_16x16x32_bf16 v[80:83],a[16:19],v[144:147],v[80:83]
v_and_b32 v107,s80,v125
v_add_f32 v72,v72,v76
v_mfma_f32_16x16x32_bf16 v[84:87],a[20:23],v[148:151],v[84:87]
v_add_f32 v73,v73,v77
v_add_f32 v74,v74,v78
v_mfma_f32_16x16x32_bf16 v[80:83],a[24:27],v[152:155],v[80:83]
v_add_f32 v75,v75,v79
v_and_or_b32 v72,v72,-4,s48
v_mfma_f32_16x16x32_bf16 v[84:87],a[28:31],v[156:159],v[84:87]
s_add_u32 s64,s77,s33
v_mfma_f32_16x16x32_bf16 v[80:83],a[32:35],v[160:163],v[80:83]
buffer_store_dwordx4 v[72:75],v25,s[20:23],s64 offen offset:1024
v_mfma_f32_16x16x32_bf16 v[84:87],a[36:39],v[164:167],v[84:87]
v_mfma_f32_16x16x32_bf16 v[80:83],a[40:43],v[168:171],v[80:83]
v_mfma_f32_16x16x32_bf16 v[84:87],a[44:47],v[172:175],v[84:87]
v_mfma_f32_16x16x32_bf16 v[80:83],a[48:51],v[176:179],v[80:83]
v_mfma_f32_16x16x32_bf16 v[84:87],a[52:55],v[180:183],v[84:87]
v_mfma_f32_16x16x32_bf16 v[80:83],a[56:59],v[184:187],v[80:83]
v_mfma_f32_16x16x32_bf16 v[84:87],a[60:63],v[188:191],v[84:87]
v_mfma_f32_16x16x32_bf16 v[80:83],a[64:67],v[192:195],v[80:83]
buffer_load_dwordx4 v[96:99],v26,s[20:23],s77 offen offset:2048 sc1
v_mfma_f32_16x16x32_bf16 v[84:87],a[68:71],v[196:199],v[84:87]
buffer_load_dwordx4 v[100:103],v26,s[20:23],s77 offen offset:3072 sc1
v_mfma_f32_16x16x32_bf16 v[80:83],a[72:75],v[200:203],v[80:83]
v_mfma_f32_16x16x32_bf16 v[84:87],a[76:79],v[204:207],v[84:87]
v_mfma_f32_16x16x32_bf16 v[80:83],a[80:83],v[208:211],v[80:83]
v_mfma_f32_16x16x32_bf16 v[84:87],a[84:87],v[212:215],v[84:87]
v_mfma_f32_16x16x32_bf16 v[80:83],a[88:91],v[216:219],v[80:83]
v_mfma_f32_16x16x32_bf16 v[84:87],a[92:95],v[220:223],v[84:87]
v_mfma_f32_16x16x32_bf16 v[80:83],a[96:99],v[224:227],v[80:83]
v_mfma_f32_16x16x32_bf16 v[84:87],a[100:103],v[228:231],v[84:87]
v_mfma_f32_16x16x32_bf16 v[80:83],a[104:107],v[232:235],v[80:83]
buffer_load_dwordx4 v[92:95],v26,s[20:23],s77 offen offset:1024 sc1
v_mfma_f32_16x16x32_bf16 v[84:87],a[108:111],v[236:239],v[84:87]
v_mfma_f32_16x16x32_bf16 v[80:83],a[112:115],v[240:243],v[80:83]
v_mfma_f32_16x16x32_bf16 v[84:87],a[116:119],v[244:247],v[84:87]
v_mfma_f32_16x16x32_bf16 v[80:83],a[120:123],v[248:251],v[80:83]
v_mfma_f32_16x16x32_bf16 v[84:87],a[124:127],v[252:255],v[84:87]
s_branch epi_292
both_293:
s_waitcnt vmcnt(15) lgkmcnt(0)
s_barrier
ds_read_b128 v[224:227],v18 offset:0
ds_read_b128 v[228:231],v18 offset:2048
ds_read_b128 v[232:235],v18 offset:4096
ds_read_b128 v[236:239],v18 offset:6144
ds_read_b128 v[240:243],v18 offset:8192
ds_read_b128 v[244:247],v18 offset:10240
ds_read_b128 v[248:251],v18 offset:12288
s_waitcnt lgkmcnt(5)
v_mfma_f32_16x16x32_bf16 v[64:67],a[0:3],v[224:227],0
s_add_u32 s96,s71,1
s_add_u32 s92,s71,2
v_min_u32 v27,v224,v228
v_mfma_f32_16x16x32_bf16 v[68:71],a[128:131],v[224:227],0
ds_read_b128 v[252:255],v18 offset:14336
s_add_u32 s88,s70,s75
v_mfma_f32_16x16x32_bf16 v[64:67],a[4:7],v[228:231],v[64:67]
s_add_u32 s88,s88,2097152
s_xor_b32 s88,s88,0x2000
v_mfma_f32_16x16x32_bf16 v[68:71],a[132:135],v[228:231],v[68:71]
ds_read_b128 v[224:227],v18 offset:16384
s_waitcnt lgkmcnt(5)
v_mfma_f32_16x16x32_bf16 v[64:67],a[8:11],v[232:235],v[64:67]
s_xor_b32 s89,s88,1024
v_min3_u32 v27,v27,v232,v236
v_mfma_f32_16x16x32_bf16 v[68:71],a[136:139],v[232:235],v[68:71]
ds_read_b128 v[228:231],v18 offset:18432
v_mfma_f32_16x16x32_bf16 v[64:67],a[12:15],v[236:239],v[64:67]
s_xor_b32 m0,s72,0
v_mfma_f32_16x16x32_bf16 v[68:71],a[140:143],v[236:239],v[68:71]
ds_read_b128 v[232:235],v18 offset:20480
s_waitcnt lgkmcnt(5)
v_mfma_f32_16x16x32_bf16 v[64:67],a[16:19],v[240:243],v[64:67]
s_add_u32 s65,s88,0
v_min3_u32 v27,v27,v240,v244
v_mfma_f32_16x16x32_bf16 v[68:71],a[144:147],v[240:243],v[68:71]
ds_read_b128 v[236:239],v18 offset:22528
v_mfma_f32_16x16x32_bf16 v[64:67],a[20:23],v[244:247],v[64:67]
buffer_load_dwordx4 v16,s[20:23],s65 offen offset:0 sc1 lds
v_mfma_f32_16x16x32_bf16 v[68:71],a[148:151],v[244:247],v[68:71]
ds_read_b128 v[240:243],v18 offset:24576
s_waitcnt lgkmcnt(5)
v_mfma_f32_16x16x32_bf16 v[64:67],a[24:27],v[248:251],v[64:67]
buffer_load_dwordx4 v16,s[20:23],s65 offen offset:2048 sc1 lds
v_mfma_f32_16x16x32_bf16 v[68:71],a[152:155],v[248:251],v[68:71]
ds_read_b128 v[244:247],v18 offset:26624
v_min3_u32 v27,v27,v248,v252
v_mfma_f32_16x16x32_bf16 v[64:67],a[28:31],v[252:255],v[64:67]
s_xor_b32 m0,s72,16384
v_mfma_f32_16x16x32_bf16 v[68:71],a[156:159],v[252:255],v[68:71]
ds_read_b128 v[248:251],v18 offset:28672
s_waitcnt lgkmcnt(5)
v_mfma_f32_16x16x32_bf16 v[64:67],a[32:35],v[224:227],v[64:67]
s_add_u32 s65,s88,32768
v_min3_u32 v27,v27,v224,v228
v_mfma_f32_16x16x32_bf16 v[68:71],a[160:163],v[224:227],v[68:71]
ds_read_b128 v[252:255],v18 offset:30720
v_mfma_f32_16x16x32_bf16 v[64:67],a[36:39],v[228:231],v[64:67]
s_waitcnt vmcnt(4)
buffer_load_dwordx4 v16,s[20:23],s65 offen offset:0 sc1 lds
v_mfma_f32_16x16x32_bf16 v[68:71],a[164:167],v[228:231],v[68:71]
ds_read_b128 v[224:227],v18 offset:32768
s_waitcnt lgkmcnt(5)
v_mfma_f32_16x16x32_bf16 v[64:67],a[40:43],v[232:235],v[64:67]
v_cmp_gt_u32 vcc,s96,v29
v_cmp_gt_u32 s[92:93],s92,v29
v_min3_u32 v27,v27,v232,v236
v_mfma_f32_16x16x32_bf16 v[68:71],a[168:171],v[232:235],v[68:71]
ds_read_b128 v[228:231],v18 offset:34816
buffer_load_dwordx4 v16,s[20:23],s65 offen offset:2048 sc1 lds
v_mfma_f32_16x16x32_bf16 v[64:67],a[44:47],v[236:239],v[64:67]
v_mov_b32 v44,vcc_lo
v_mov_b32 v45,s92
v_mfma_f32_16x16x32_bf16 v[68:71],a[172:175],v[236:239],v[68:71]
ds_read_b128 v[232:235],v18 offset:36864
s_xor_b32 m0,s72,32768
s_waitcnt lgkmcnt(5)
v_mfma_f32_16x16x32_bf16 v[64:67],a[48:51],v[240:243],v[64:67]
ds_write_b64 v46,v[44:45]
v_min3_u32 v27,v27,v240,v244
v_mfma_f32_16x16x32_bf16 v[68:71],a[176:179],v[240:243],v[68:71]
ds_read_b128 v[236:239],v18 offset:38912
s_add_u32 s65,s88,65536
v_mfma_f32_16x16x32_bf16 v[64:67],a[52:55],v[244:247],v[64:67]
buffer_load_dwordx2 v[120:121],v20,s[36:39],s78 offen
v_mfma_f32_16x16x32_bf16 v[68:71],a[180:183],v[244:247],v[68:71]
ds_read_b128 v[240:243],v18 offset:40960
s_waitcnt lgkmcnt(6)
v_mfma_f32_16x16x32_bf16 v[64:67],a[56:59],v[248:251],v[64:67]
buffer_load_dwordx4 v16,s[20:23],s65 offen offset:0 sc1 lds
v_mfma_f32_16x16x32_bf16 v[68:71],a[184:187],v[248:251],v[68:71]
ds_read_b128 v[244:247],v18 offset:43008
buffer_load_dwordx4 v16,s[20:23],s65 offen offset:2048 sc1 lds
v_mfma_f32_16x16x32_bf16 v[64:67],a[60:63],v[252:255],v[64:67]
v_min3_u32 v27,v27,v248,v252
v_mfma_f32_16x16x32_bf16 v[68:71],a[188:191],v[252:255],v[68:71]
ds_read_b128 v[248:251],v18 offset:45056
s_xor_b32 m0,s72,49152
s_waitcnt lgkmcnt(6)
v_mfma_f32_16x16x32_bf16 v[64:67],a[64:67],v[224:227],v[64:67]
v_min3_u32 v27,v27,v224,v228
v_mfma_f32_16x16x32_bf16 v[68:71],a[192:195],v[224:227],v[68:71]
ds_read_b128 v[252:255],v18 offset:47104
s_add_u32 s65,s88,98304
v_mfma_f32_16x16x32_bf16 v[64:67],a[68:71],v[228:231],v[64:67]
v_mfma_f32_16x16x32_bf16 v[68:71],a[196:199],v[228:231],v[68:71]
ds_read_b128 v[224:227],v18 offset:49152
s_waitcnt lgkmcnt(5)
v_mfma_f32_16x16x32_bf16 v[64:67],a[72:75],v[232:235],v[64:67]
buffer_load_dwordx4 v16,s[20:23],s65 offen offset:0 sc1 lds
v_mfma_f32_16x16x32_bf16 v[68:71],a[200:203],v[232:235],v[68:71]
ds_read_b128 v[228:231],v18 offset:51200
buffer_load_dwordx4 v16,s[20:23],s65 offen offset:2048 sc1 lds
v_mfma_f32_16x16x32_bf16 v[64:67],a[76:79],v[236:239],v[64:67]
v_min3_u32 v27,v27,v232,v236
v_mfma_f32_16x16x32_bf16 v[68:71],a[204:207],v[236:239],v[68:71]
ds_read_b128 v[232:235],v18 offset:53248
s_waitcnt lgkmcnt(5)
v_mfma_f32_16x16x32_bf16 v[64:67],a[80:83],v[240:243],v[64:67]
s_waitcnt vmcnt(16)
s_barrier
ds_read_b64 v[44:45],v47
ds_read_b128 v[128:131],v17 offset:0
ds_read_b128 v[132:135],v17 offset:2048
v_mfma_f32_16x16x32_bf16 v[68:71],a[208:211],v[240:243],v[68:71]
ds_read_b128 v[236:239],v18 offset:55296
s_xor_b32 m0,s72,1024
v_min3_u32 v27,v27,v240,v244
v_mfma_f32_16x16x32_bf16 v[64:67],a[84:87],v[244:247],v[64:67]
ds_read_b128 v[136:139],v17 offset:4096
s_add_u32 s65,s89,0
v_mfma_f32_16x16x32_bf16 v[68:71],a[212:215],v[244:247],v[68:71]
ds_read_b128 v[240:243],v18 offset:57344
s_waitcnt lgkmcnt(9)
v_mfma_f32_16x16x32_bf16 v[64:67],a[88:91],v[248:251],v[64:67]
ds_read_b128 v[140:143],v17 offset:6144
buffer_load_dwordx4 v16,s[20:23],s65 offen offset:0 sc1 lds
v_mfma_f32_16x16x32_bf16 v[68:71],a[216:219],v[248:251],v[68:71]
ds_read_b128 v[244:247],v18 offset:59392
v_min3_u32 v27,v27,v248,v252
v_mfma_f32_16x16x32_bf16 v[64:67],a[92:95],v[252:255],v[64:67]
ds_read_b128 v[144:147],v17 offset:8192
ds_read_b128 v[148:151],v17 offset:10240
v_mfma_f32_16x16x32_bf16 v[68:71],a[220:223],v[252:255],v[68:71]
ds_read_b128 v[248:251],v18 offset:61440
s_waitcnt lgkmcnt(12)
v_mfma_f32_16x16x32_bf16 v[64:67],a[96:99],v[224:227],v[64:67]
ds_read_b128 v[152:155],v17 offset:12288
s_waitcnt lgkmcnt(11)
v_min3_u32 v27,v27,v224,v228
v_mfma_f32_16x16x32_bf16 v[68:71],a[224:227],v[224:227],v[68:71]
ds_read_b128 v[252:255],v18 offset:63488
v_readfirstlane_b32 s93,v45
v_mfma_f32_16x16x32_bf16 v[64:67],a[100:103],v[228:231],v[64:67]
ds_read_b128 v[156:159],v17 offset:14336
buffer_load_dwordx4 v16,s[20:23],s65 offen offset:2048 sc1 lds
v_mfma_f32_16x16x32_bf16 v[68:71],a[228:231],v[228:231],v[68:71]
s_xor_b32 m0,s72,17408
s_add_u32 s65,s89,32768
s_waitcnt lgkmcnt(10)
v_mfma_f32_16x16x32_bf16 v[64:67],a[104:107],v[232:235],v[64:67]
ds_read_b128 v[160:163],v17 offset:16384
ds_read_b128 v[164:167],v17 offset:18432
v_min3_u32 v27,v27,v232,v236
v_mfma_f32_16x16x32_bf16 v[68:71],a[232:235],v[232:235],v[68:71]
buffer_load_dwordx4 v16,s[20:23],s65 offen offset:0 sc1 lds
s_waitcnt vmcnt(12)
v_mfma_f32_16x16x32_bf16 v[64:67],a[108:111],v[236:239],v[64:67]
ds_read_b128 v[168:171],v17 offset:20480
buffer_load_dwordx4 v16,s[20:23],s65 offen offset:2048 sc1 lds
v_mfma_f32_16x16x32_bf16 v[68:71],a[236:239],v[236:239],v[68:71]
v_add_u32 v22,s71,-1
s_waitcnt lgkmcnt(9)
v_mfma_f32_16x16x32_bf16 v[64:67],a[112:115],v[240:243],v[64:67]
ds_read_b128 v[172:175],v17 offset:22528
v_min3_u32 v27,v27,v240,v244
v_mfma_f32_16x16x32_bf16 v[68:71],a[240:243],v[240:243],v[68:71]
s_xor_b32 m0,s72,33792
buffer_store_dword v22,v23,s[20:23],s97 offen sc1
v_mfma_f32_16x16x32_bf16 v[64:67],a[116:119],v[244:247],v[64:67]
ds_read_b128 v[176:179],v17 offset:24576
ds_read_b128 v[180:183],v17 offset:26624
s_mov_b32 s97,0x7fff0000
v_mfma_f32_16x16x32_bf16 v[68:71],a[244:247],v[244:247],v[68:71]
s_add_u32 s65,s89,65536
s_waitcnt lgkmcnt(7)
v_mfma_f32_16x16x32_bf16 v[64:67],a[120:123],v[248:251],v[64:67]
ds_read_b128 v[184:187],v17 offset:28672
v_min3_u32 v27,v27,v248,v252
v_mfma_f32_16x16x32_bf16 v[68:71],a[248:251],v[248:251],v[68:71]
buffer_load_dwordx4 v16,s[20:23],s65 offen offset:0 sc1 lds
v_mfma_f32_16x16x32_bf16 v[64:67],a[124:127],v[252:255],v[64:67]
ds_read_b128 v[188:191],v17 offset:30720
v_mfma_f32_16x16x32_bf16 v[68:71],a[252:255],v[252:255],v[68:71]
buffer_load_dwordx4 v16,s[20:23],s65 offen offset:2048 sc1 lds
v_mfma_f32_16x16x32_bf16 v[72:75],a[128:131],v[128:131],0
v_cmp_eq_u32 vcc,0,v27
s_cbranch_vccnz retry_289
v_mfma_f32_16x16x32_bf16 v[76:79],a[132:135],v[132:135],0
s_xor_b32 m0,s72,50176
v_min3_u32 v27,v27,v128,v132
v_mfma_f32_16x16x32_bf16 v[72:75],a[136:139],v[136:139],v[72:75]
ds_read_b128 v[192:195],v17 offset:32768
v_mfma_f32_16x16x32_bf16 v[76:79],a[140:143],v[140:143],v[76:79]
ds_read_b128 v[196:199],v17 offset:34816
s_add_u32 s65,s89,98304
s_waitcnt lgkmcnt(10)
v_mfma_f32_16x16x32_bf16 v[72:75],a[144:147],v[144:147],v[72:75]
ds_read_b128 v[200:203],v17 offset:36864
v_min3_u32 v27,v27,v136,v140
s_waitcnt vmcnt(11)
v_mfma_f32_16x16x32_bf16 v[76:79],a[148:151],v[148:151],v[76:79]
ds_read_b128 v[204:207],v17 offset:38912
buffer_load_dwordx4 v16,s[20:23],s65 offen offset:0 sc1 lds
v_mfma_f32_16x16x32_bf16 v[72:75],a[152:155],v[152:155],v[72:75]
ds_read_b128 v[208:211],v17 offset:40960
v_min3_u32 v27,v27,v144,v148
v_and_or_b32 v64,v64,-4,s48
v_mfma_f32_16x16x32_bf16 v[76:79],a[156:159],v[156:159],v[76:79]
buffer_load_dwordx4 v16,s[20:23],s65 offen offset:2048 sc1 lds
s_waitcnt lgkmcnt(9)
v_mfma_f32_16x16x32_bf16 v[72:75],a[160:163],v[160:163],v[72:75]
ds_read_b128 v[212:215],v17 offset:43008
v_min3_u32 v27,v27,v152,v156
s_add_u32 s64,s49,s34
v_mfma_f32_16x16x32_bf16 v[76:79],a[164:167],v[164:167],v[76:79]
ds_read_b128 v[216:219],v17 offset:45056
v_min3_u32 v27,v27,v160,v164
v_mfma_f32_16x16x32_bf16 v[72:75],a[168:171],v[168:171],v[72:75]
ds_read_b128 v[220:223],v17 offset:47104
buffer_store_dwordx4 v[64:67],v25,s[20:23],s64 offen offset:2048
v_mfma_f32_16x16x32_bf16 v[76:79],a[172:175],v[172:175],v[76:79]
ds_read_b128 v[224:227],v17 offset:49152
v_and_or_b32 v68,v68,-4,s48
s_waitcnt lgkmcnt(9)
v_mfma_f32_16x16x32_bf16 v[72:75],a[176:179],v[176:179],v[72:75]
ds_read_b128 v[228:231],v17 offset:51200
v_min3_u32 v27,v27,v168,v172
s_add_u32 s64,s49,s35
v_mfma_f32_16x16x32_bf16 v[76:79],a[180:183],v[180:183],v[76:79]
v_min3_u32 v27,v27,v176,v180
buffer_store_dwordx4 v[68:71],v25,s[20:23],s64 offen offset:3072
v_mfma_f32_16x16x32_bf16 v[72:75],a[184:187],v[184:187],v[72:75]
ds_read_b128 v[232:235],v17 offset:53248
s_mov_b32 s49,0x7fff0000
v_mfma_f32_16x16x32_bf16 v[76:79],a[188:191],v[188:191],v[76:79]
ds_read_b128 v[236:239],v17 offset:55296
s_waitcnt lgkmcnt(8)
v_mfma_f32_16x16x32_bf16 v[72:75],a[192:195],v[192:195],v[72:75]
ds_read_b128 v[240:243],v17 offset:57344
v_min3_u32 v27,v27,v184,v188
v_mfma_f32_16x16x32_bf16 v[76:79],a[196:199],v[196:199],v[76:79]
ds_read_b128 v[244:247],v17 offset:59392
v_min3_u32 v27,v27,v192,v196
v_mfma_f32_16x16x32_bf16 v[72:75],a[200:203],v[200:203],v[72:75]
ds_read_b128 v[248:251],v17 offset:61440
ds_bpermute_b32 v124,v41,v120
v_mfma_f32_16x16x32_bf16 v[76:79],a[204:207],v[204:207],v[76:79]
v_min3_u32 v27,v27,v200,v204
s_waitcnt lgkmcnt(8)
v_mfma_f32_16x16x32_bf16 v[72:75],a[208:211],v[208:211],v[72:75]
ds_read_b128 v[252:255],v17 offset:63488
ds_bpermute_b32 v125,v41,v121
v_mfma_f32_16x16x32_bf16 v[76:79],a[212:215],v[212:215],v[76:79]
v_min3_u32 v27,v27,v208,v212
v_mfma_f32_16x16x32_bf16 v[72:75],a[216:219],v[216:219],v[72:75]
v_mfma_f32_16x16x32_bf16 v[76:79],a[220:223],v[220:223],v[76:79]
v_min3_u32 v27,v27,v216,v220
s_waitcnt lgkmcnt(6)
v_mfma_f32_16x16x32_bf16 v[72:75],a[224:227],v[224:227],v[72:75]
s_waitcnt lgkmcnt(0)
v_mfma_f32_16x16x32_bf16 v[76:79],a[228:231],v[228:231],v[76:79]
v_min3_u32 v27,v27,v224,v228
v_mfma_f32_16x16x32_bf16 v[72:75],a[232:235],v[232:235],v[72:75]
v_lshlrev_b32 v104,16,v124
v_mfma_f32_16x16x32_bf16 v[76:79],a[236:239],v[236:239],v[76:79]
v_min3_u32 v27,v27,v232,v236
v_mfma_f32_16x16x32_bf16 v[72:75],a[240:243],v[240:243],v[72:75]
v_mfma_f32_16x16x32_bf16 v[76:79],a[244:247],v[244:247],v[76:79]
v_min3_u32 v27,v27,v240,v244
v_mfma_f32_16x16x32_bf16 v[72:75],a[248:251],v[248:251],v[72:75]
v_and_b32 v105,s80,v124
v_mfma_f32_16x16x32_bf16 v[76:79],a[252:255],v[252:255],v[76:79]
v_min3_u32 v27,v27,v248,v252
v_mfma_f32_16x16x32_bf16 v[80:83],a[0:3],v[128:131],0
v_cmp_eq_u32 vcc,0,v27
s_cbranch_vccnz retry_289
v_mfma_f32_16x16x32_bf16 v[84:87],a[4:7],v[132:135],0
v_lshlrev_b32 v106,16,v125
v_mfma_f32_16x16x32_bf16 v[80:83],a[8:11],v[136:139],v[80:83]
v_mfma_f32_16x16x32_bf16 v[84:87],a[12:15],v[140:143],v[84:87]
v_mfma_f32_16x16x32_bf16 v[80:83],a[16:19],v[144:147],v[80:83]
v_and_b32 v107,s80,v125
v_add_f32 v72,v72,v76
v_mfma_f32_16x16x32_bf16 v[84:87],a[20:23],v[148:151],v[84:87]
v_add_f32 v73,v73,v77
v_add_f32 v74,v74,v78
v_mfma_f32_16x16x32_bf16 v[80:83],a[24:27],v[152:155],v[80:83]
v_add_f32 v75,v75,v79
v_and_or_b32 v72,v72,-4,s48
v_mfma_f32_16x16x32_bf16 v[84:87],a[28:31],v[156:159],v[84:87]
s_add_u32 s64,s77,s33
v_mfma_f32_16x16x32_bf16 v[80:83],a[32:35],v[160:163],v[80:83]
buffer_store_dwordx4 v[72:75],v25,s[20:23],s64 offen offset:1024
v_mfma_f32_16x16x32_bf16 v[84:87],a[36:39],v[164:167],v[84:87]
v_mfma_f32_16x16x32_bf16 v[80:83],a[40:43],v[168:171],v[80:83]
v_mfma_f32_16x16x32_bf16 v[84:87],a[44:47],v[172:175],v[84:87]
v_mfma_f32_16x16x32_bf16 v[80:83],a[48:51],v[176:179],v[80:83]
v_mfma_f32_16x16x32_bf16 v[84:87],a[52:55],v[180:183],v[84:87]
v_mfma_f32_16x16x32_bf16 v[80:83],a[56:59],v[184:187],v[80:83]
v_mfma_f32_16x16x32_bf16 v[84:87],a[60:63],v[188:191],v[84:87]
v_mfma_f32_16x16x32_bf16 v[80:83],a[64:67],v[192:195],v[80:83]
buffer_load_dwordx4 v[96:99],v26,s[20:23],s77 offen offset:2048 sc1
v_mfma_f32_16x16x32_bf16 v[84:87],a[68:71],v[196:199],v[84:87]
buffer_load_dwordx4 v[100:103],v26,s[20:23],s77 offen offset:3072 sc1
v_mfma_f32_16x16x32_bf16 v[80:83],a[72:75],v[200:203],v[80:83]
v_mfma_f32_16x16x32_bf16 v[84:87],a[76:79],v[204:207],v[84:87]
v_mfma_f32_16x16x32_bf16 v[80:83],a[80:83],v[208:211],v[80:83]
v_mfma_f32_16x16x32_bf16 v[84:87],a[84:87],v[212:215],v[84:87]
v_mfma_f32_16x16x32_bf16 v[80:83],a[88:91],v[216:219],v[80:83]
v_mfma_f32_16x16x32_bf16 v[84:87],a[92:95],v[220:223],v[84:87]
v_mfma_f32_16x16x32_bf16 v[80:83],a[96:99],v[224:227],v[80:83]
v_mfma_f32_16x16x32_bf16 v[84:87],a[100:103],v[228:231],v[84:87]
v_mfma_f32_16x16x32_bf16 v[80:83],a[104:107],v[232:235],v[80:83]
buffer_load_dwordx4 v[92:95],v26,s[20:23],s77 offen offset:1024 sc1
v_mfma_f32_16x16x32_bf16 v[84:87],a[108:111],v[236:239],v[84:87]
v_mfma_f32_16x16x32_bf16 v[80:83],a[112:115],v[240:243],v[80:83]
v_mfma_f32_16x16x32_bf16 v[84:87],a[116:119],v[244:247],v[84:87]
v_mfma_f32_16x16x32_bf16 v[80:83],a[120:123],v[248:251],v[80:83]
v_mfma_f32_16x16x32_bf16 v[84:87],a[124:127],v[252:255],v[84:87]
epi_292:
buffer_load_dword v29,v21,s[20:23],s87 offen sc1
s_nop 6
v_pk_add_f32 v[88:89],v[80:81],v[84:85]
v_pk_add_f32 v[90:91],v[82:83],v[86:87]
s_waitcnt vmcnt(1)
s_branch ic_304
ip_302:
buffer_load_dwordx4 v[92:95],v26,s[20:23],s77 offen offset:1024 sc1
buffer_load_dwordx4 v[96:99],v26,s[20:23],s77 offen offset:2048 sc1
buffer_load_dwordx4 v[100:103],v26,s[20:23],s77 offen offset:3072 sc1
s_waitcnt vmcnt(0)
ic_304:
v_bitop3_b32 v22,v92,v96,v100 bitop3:0x80
v_and_b32 v22,s48,v22
v_cmp_eq_u32 vcc,0,v22
s_cbranch_vccz ik_303
s_sub_u32 s90,s90,1
s_cmp_gt_i32 s90,0
s_cbranch_scc1 ip_302
ik_303:
v_pk_add_f32 v[88:89],v[88:89],v[92:93]
v_pk_add_f32 v[96:97],v[96:97],v[100:101]
v_pk_add_f32 v[90:91],v[90:91],v[94:95]
v_pk_add_f32 v[98:99],v[98:99],v[102:103]
v_pk_add_f32 v[88:89],v[88:89],v[96:97]
v_pk_add_f32 v[90:91],v[90:91],v[98:99]
v_pk_fma_f32 v[88:89],v[88:89],v[52:53],v[104:105]
v_pk_fma_f32 v[90:91],v[90:91],v[54:55],v[106:107]
v_cvt_pk_bf16_f32 v88,v88,v89
v_cvt_pk_bf16_f32 v89,v90,v91
v_max_u32 v88,1,v88
ds_bpermute_b32 v88,v40,v88
ds_bpermute_b32 v89,v40,v89
v_xor_b32 v18,0x10000,v18
s_xor_b32 s49,s77,524288
s_cselect_b32 s64,0,3
s_xor_b32 s48,s48,s64
s_waitcnt lgkmcnt(0)
buffer_store_dwordx2 v[88:89],v19,s[20:23],s70 offen sc1
s_mov_b32 s77,s49
s_add_u32 s78,s78,65536
s_cmp_gt_u32 s71,40
s_cselect_b32 s65,s73,0x7fff0000
s_cselect_b32 s97,0x7fff0000,s73
v_mov_b32 v22,s71
buffer_store_dword v22,v23,s[20:23],s65 offen sc1
next_299:
v_xor_b32 v17,0x10000,v17
s_xor_b32 s72,s72,0x10000
s_add_u32 s70,s70,2097152
s_xor_b32 s70,s70,0x2000
s_add_u32 s71,s71,1
s_cmp_le_u32 s71,64
s_cbranch_scc1 seg_290
s_endpgm
retry_289:
s_sub_u32 s90,s90,64
s_cmp_lt_i32 s90,0
s_cbranch_scc1 giveup_197
s_mov_b32 s83,1
s_waitcnt vmcnt(0) lgkmcnt(0)
s_barrier
s_branch seg_290
kslow_288:
s_add_u32 s64,s79,0
s_lshl_b32 s70,s64,21
s_lshl_b32 s64,s64,13
s_and_b32 s64,s64,0x2000
s_xor_b32 s64,s64,s62
s_add_u32 s70,s70,s64
s_add_u32 s70,s70,29360128
s_mov_b32 s83,1
s_mov_b32 s87,s74
s_cmp_eq_u32 s50,0
s_cselect_b32 s74,s74,0x7fff0000
v_mov_b32 v47,132096
s_lshl_b32 s64,s50,3
s_add_u32 s64,s64,132096
v_mov_b32 v46,s64
v_mov_b32 v29,0
s_mov_b32 s97,0x7fff0000
s_mov_b32 s69,1
s_mov_b32 s68,0
s_mov_b32 s52,0x30003
s_mov_b32 s53,s52
seg_308:
s_add_u32 s94,s70,s75
s_xor_b32 s95,s94,1024
s_xor_b32 s91,s72,0x10000
s_waitcnt vmcnt(2)
v_cmp_gt_u32 vcc,s71,v29
s_cbranch_vccz nb_312
s_waitcnt vmcnt(0)
v_add_u32 v22,s71,-1
buffer_store_dword v22,v23,s[20:23],s97 offen sc1
s_mov_b32 s97,0x7fff0000
s_cmp_lg_u32 s50,0
s_cbranch_scc1 nb_312
buffer_load_dword v32,v21,s[20:23],s74 offen sc1
s_sleep 2
pl_314:
buffer_load_dword v33,v21,s[20:23],s74 offen sc1
s_waitcnt vmcnt(1)
v_cmp_gt_u32 vcc,s71,v32
v_mov_b32 v29,v32
s_cbranch_vccz pok_315
buffer_load_dword v32,v21,s[20:23],s74 offen sc1
s_waitcnt vmcnt(1)
v_cmp_gt_u32 vcc,s71,v33
v_mov_b32 v29,v33
s_cbranch_vccz pok_315
s_sub_u32 s90,s90,1
s_cmp_gt_i32 s90,0
s_cbranch_scc1 pl_314
pok_315:
nb_312:
s_barrier
s_xor_b32 m0,s91,0
s_add_u32 s65,s94,0
buffer_load_dwordx4 v16,s[20:23],s65 offen offset:0 sc1 lds
buffer_load_dwordx4 v16,s[20:23],s65 offen offset:2048 sc1 lds
s_xor_b32 m0,s91,16384
s_add_u32 s65,s94,32768
buffer_load_dwordx4 v16,s[20:23],s65 offen offset:0 sc1 lds
buffer_load_dwordx4 v16,s[20:23],s65 offen offset:2048 sc1 lds
s_xor_b32 m0,s91,32768
s_add_u32 s65,s94,65536
buffer_load_dwordx4 v16,s[20:23],s65 offen offset:0 sc1 lds
buffer_load_dwordx4 v16,s[20:23],s65 offen offset:2048 sc1 lds
s_xor_b32 m0,s91,49152
s_add_u32 s65,s94,98304
buffer_load_dwordx4 v16,s[20:23],s65 offen offset:0 sc1 lds
buffer_load_dwordx4 v16,s[20:23],s65 offen offset:2048 sc1 lds
s_waitcnt vmcnt(8)
v_add_u32 v22,s71,-1
buffer_store_dword v22,v23,s[20:23],s97 offen sc1
s_mov_b32 s97,0x7fff0000
s_waitcnt vmcnt(7)
s_barrier
ds_read_b128 v[224:227],v18 offset:0
ds_read_b128 v[228:231],v18 offset:2048
ds_read_b128 v[232:235],v18 offset:4096
ds_read_b128 v[236:239],v18 offset:6144
ds_read_b128 v[240:243],v18 offset:8192
ds_read_b128 v[244:247],v18 offset:10240
ds_read_b128 v[248:251],v18 offset:12288
s_waitcnt lgkmcnt(5)
v_mfma_f32_16x16x32_bf16 v[64:67],a[0:3],v[224:227],0
s_xor_b32 m0,s91,1024
v_min_u32 v27,v224,v228
v_mfma_f32_16x16x32_bf16 v[68:71],a[128:131],v[224:227],0
ds_read_b128 v[252:255],v18 offset:14336
v_mfma_f32_16x16x32_bf16 v[64:67],a[4:7],v[228:231],v[64:67]
s_add_u32 s65,s95,0
v_mfma_f32_16x16x32_bf16 v[68:71],a[132:135],v[228:231],v[68:71]
s_waitcnt vmcnt(5)
s_barrier
ds_read_b128 v[224:227],v18 offset:16384
s_waitcnt lgkmcnt(5)
v_mfma_f32_16x16x32_bf16 v[64:67],a[8:11],v[232:235],v[64:67]
buffer_load_dwordx4 v16,s[20:23],s65 offen offset:0 sc1 lds
v_mfma_f32_16x16x32_bf16 v[68:71],a[136:139],v[232:235],v[68:71]
ds_read_b128 v[228:231],v18 offset:18432
v_min3_u32 v27,v27,v232,v236
v_mfma_f32_16x16x32_bf16 v[64:67],a[12:15],v[236:239],v[64:67]
buffer_load_dwordx4 v16,s[20:23],s65 offen offset:2048 sc1 lds
v_mfma_f32_16x16x32_bf16 v[68:71],a[140:143],v[236:239],v[68:71]
ds_read_b128 v[232:235],v18 offset:20480
s_waitcnt lgkmcnt(5)
v_mfma_f32_16x16x32_bf16 v[64:67],a[16:19],v[240:243],v[64:67]
s_xor_b32 m0,s91,17408
v_min3_u32 v27,v27,v240,v244
v_mfma_f32_16x16x32_bf16 v[68:71],a[144:147],v[240:243],v[68:71]
ds_read_b128 v[236:239],v18 offset:22528
v_mfma_f32_16x16x32_bf16 v[64:67],a[20:23],v[244:247],v[64:67]
s_add_u32 s65,s95,32768
v_mfma_f32_16x16x32_bf16 v[68:71],a[148:151],v[244:247],v[68:71]
ds_read_b128 v[240:243],v18 offset:24576
s_waitcnt lgkmcnt(5)
v_mfma_f32_16x16x32_bf16 v[64:67],a[24:27],v[248:251],v[64:67]
buffer_load_dwordx4 v16,s[20:23],s65 offen offset:0 sc1 lds
v_mfma_f32_16x16x32_bf16 v[68:71],a[152:155],v[248:251],v[68:71]
ds_read_b128 v[244:247],v18 offset:26624
v_min3_u32 v27,v27,v248,v252
v_mfma_f32_16x16x32_bf16 v[64:67],a[28:31],v[252:255],v[64:67]
buffer_load_dwordx4 v16,s[20:23],s65 offen offset:2048 sc1 lds
v_mfma_f32_16x16x32_bf16 v[68:71],a[156:159],v[252:255],v[68:71]
ds_read_b128 v[248:251],v18 offset:28672
s_waitcnt lgkmcnt(5)
v_mfma_f32_16x16x32_bf16 v[64:67],a[32:35],v[224:227],v[64:67]
s_xor_b32 m0,s91,33792
v_min3_u32 v27,v27,v224,v228
v_mfma_f32_16x16x32_bf16 v[68:71],a[160:163],v[224:227],v[68:71]
ds_read_b128 v[252:255],v18 offset:30720
v_mfma_f32_16x16x32_bf16 v[64:67],a[36:39],v[228:231],v[64:67]
s_add_u32 s65,s95,65536
v_mfma_f32_16x16x32_bf16 v[68:71],a[164:167],v[228:231],v[68:71]
s_waitcnt vmcnt(5)
s_barrier
ds_read_b128 v[224:227],v18 offset:32768
s_waitcnt lgkmcnt(5)
v_mfma_f32_16x16x32_bf16 v[64:67],a[40:43],v[232:235],v[64:67]
buffer_load_dwordx4 v16,s[20:23],s65 offen offset:0 sc1 lds
v_mfma_f32_16x16x32_bf16 v[68:71],a[168:171],v[232:235],v[68:71]
ds_read_b128 v[228:231],v18 offset:34816
v_min3_u32 v27,v27,v232,v236
v_mfma_f32_16x16x32_bf16 v[64:67],a[44:47],v[236:239],v[64:67]
buffer_load_dwordx4 v16,s[20:23],s65 offen offset:2048 sc1 lds
v_mfma_f32_16x16x32_bf16 v[68:71],a[172:175],v[236:239],v[68:71]
ds_read_b128 v[232:235],v18 offset:36864
s_waitcnt lgkmcnt(5)
v_mfma_f32_16x16x32_bf16 v[64:67],a[48:51],v[240:243],v[64:67]
s_xor_b32 m0,s91,50176
v_min3_u32 v27,v27,v240,v244
v_mfma_f32_16x16x32_bf16 v[68:71],a[176:179],v[240:243],v[68:71]
ds_read_b128 v[236:239],v18 offset:38912
v_mfma_f32_16x16x32_bf16 v[64:67],a[52:55],v[244:247],v[64:67]
s_add_u32 s65,s95,98304
v_mfma_f32_16x16x32_bf16 v[68:71],a[180:183],v[244:247],v[68:71]
ds_read_b128 v[240:243],v18 offset:40960
s_waitcnt lgkmcnt(5)
v_mfma_f32_16x16x32_bf16 v[64:67],a[56:59],v[248:251],v[64:67]
buffer_load_dwordx4 v16,s[20:23],s65 offen offset:0 sc1 lds
v_mfma_f32_16x16x32_bf16 v[68:71],a[184:187],v[248:251],v[68:71]
ds_read_b128 v[244:247],v18 offset:43008
v_min3_u32 v27,v27,v248,v252
v_mfma_f32_16x16x32_bf16 v[64:67],a[60:63],v[252:255],v[64:67]
buffer_load_dwordx4 v16,s[20:23],s65 offen offset:2048 sc1 lds
v_mfma_f32_16x16x32_bf16 v[68:71],a[188:191],v[252:255],v[68:71]
ds_read_b128 v[248:251],v18 offset:45056
s_waitcnt lgkmcnt(5)
v_mfma_f32_16x16x32_bf16 v[64:67],a[64:67],v[224:227],v[64:67]
v_min3_u32 v27,v27,v224,v228
s_add_u32 s88,s70,s75
v_mfma_f32_16x16x32_bf16 v[68:71],a[192:195],v[224:227],v[68:71]
ds_read_b128 v[252:255],v18 offset:47104
s_add_u32 s88,s88,2097152
v_mfma_f32_16x16x32_bf16 v[64:67],a[68:71],v[228:231],v[64:67]
buffer_load_dwordx2 v[120:121],v20,s[36:39],s78 offen
v_mfma_f32_16x16x32_bf16 v[68:71],a[196:199],v[228:231],v[68:71]
ds_read_b128 v[224:227],v18 offset:49152
s_waitcnt lgkmcnt(5)
v_mfma_f32_16x16x32_bf16 v[64:67],a[72:75],v[232:235],v[64:67]
v_min3_u32 v27,v27,v232,v236
s_xor_b32 s88,s88,0x2000
v_mfma_f32_16x16x32_bf16 v[68:71],a[200:203],v[232:235],v[68:71]
ds_read_b128 v[228:231],v18 offset:51200
s_xor_b32 s89,s88,1024
v_mfma_f32_16x16x32_bf16 v[64:67],a[76:79],v[236:239],v[64:67]
v_mfma_f32_16x16x32_bf16 v[68:71],a[204:207],v[236:239],v[68:71]
ds_read_b128 v[232:235],v18 offset:53248
s_waitcnt lgkmcnt(5)
v_mfma_f32_16x16x32_bf16 v[64:67],a[80:83],v[240:243],v[64:67]
s_waitcnt vmcnt(5)
s_barrier
ds_read_b128 v[128:131],v17 offset:0
ds_read_b128 v[132:135],v17 offset:2048
v_mfma_f32_16x16x32_bf16 v[68:71],a[208:211],v[240:243],v[68:71]
ds_read_b128 v[236:239],v18 offset:55296
v_min3_u32 v27,v27,v240,v244
v_mfma_f32_16x16x32_bf16 v[64:67],a[84:87],v[244:247],v[64:67]
ds_read_b128 v[136:139],v17 offset:4096
v_mfma_f32_16x16x32_bf16 v[68:71],a[212:215],v[244:247],v[68:71]
ds_read_b128 v[240:243],v18 offset:57344
s_waitcnt lgkmcnt(8)
v_mfma_f32_16x16x32_bf16 v[64:67],a[88:91],v[248:251],v[64:67]
ds_read_b128 v[140:143],v17 offset:6144
v_min3_u32 v27,v27,v248,v252
v_mfma_f32_16x16x32_bf16 v[68:71],a[216:219],v[248:251],v[68:71]
ds_read_b128 v[244:247],v18 offset:59392
v_mfma_f32_16x16x32_bf16 v[64:67],a[92:95],v[252:255],v[64:67]
ds_read_b128 v[144:147],v17 offset:8192
ds_read_b128 v[148:151],v17 offset:10240
v_mfma_f32_16x16x32_bf16 v[68:71],a[220:223],v[252:255],v[68:71]
ds_read_b128 v[248:251],v18 offset:61440
s_waitcnt lgkmcnt(11)
v_mfma_f32_16x16x32_bf16 v[64:67],a[96:99],v[224:227],v[64:67]
ds_read_b128 v[152:155],v17 offset:12288
v_min3_u32 v27,v27,v224,v228
v_mfma_f32_16x16x32_bf16 v[68:71],a[224:227],v[224:227],v[68:71]
ds_read_b128 v[252:255],v18 offset:63488
v_mfma_f32_16x16x32_bf16 v[64:67],a[100:103],v[228:231],v[64:67]
ds_read_b128 v[156:159],v17 offset:14336
v_mfma_f32_16x16x32_bf16 v[68:71],a[228:231],v[228:231],v[68:71]
s_waitcnt lgkmcnt(10)
v_mfma_f32_16x16x32_bf16 v[64:67],a[104:107],v[232:235],v[64:67]
ds_read_b128 v[160:163],v17 offset:16384
ds_read_b128 v[164:167],v17 offset:18432
v_mfma_f32_16x16x32_bf16 v[68:71],a[232:235],v[232:235],v[68:71]
v_min3_u32 v27,v27,v232,v236
v_mfma_f32_16x16x32_bf16 v[64:67],a[108:111],v[236:239],v[64:67]
ds_read_b128 v[168:171],v17 offset:20480
v_mfma_f32_16x16x32_bf16 v[68:71],a[236:239],v[236:239],v[68:71]
s_waitcnt lgkmcnt(9)
v_mfma_f32_16x16x32_bf16 v[64:67],a[112:115],v[240:243],v[64:67]
ds_read_b128 v[172:175],v17 offset:22528
v_min3_u32 v27,v27,v240,v244
v_mfma_f32_16x16x32_bf16 v[68:71],a[240:243],v[240:243],v[68:71]
v_mfma_f32_16x16x32_bf16 v[64:67],a[116:119],v[244:247],v[64:67]
ds_read_b128 v[176:179],v17 offset:24576
ds_read_b128 v[180:183],v17 offset:26624
v_mfma_f32_16x16x32_bf16 v[68:71],a[244:247],v[244:247],v[68:71]
s_waitcnt lgkmcnt(7)
v_mfma_f32_16x16x32_bf16 v[64:67],a[120:123],v[248:251],v[64:67]
ds_read_b128 v[184:187],v17 offset:28672
v_min3_u32 v27,v27,v248,v252
v_mfma_f32_16x16x32_bf16 v[68:71],a[248:251],v[248:251],v[68:71]
v_mfma_f32_16x16x32_bf16 v[64:67],a[124:127],v[252:255],v[64:67]
ds_read_b128 v[188:191],v17 offset:30720
v_mfma_f32_16x16x32_bf16 v[68:71],a[252:255],v[252:255],v[68:71]
v_mfma_f32_16x16x32_bf16 v[72:75],a[128:131],v[128:131],0
v_cmp_eq_u32 vcc,0,v27
s_cbranch_vccnz retry_307
v_mfma_f32_16x16x32_bf16 v[76:79],a[132:135],v[132:135],0
v_min3_u32 v27,v27,v128,v132
v_mfma_f32_16x16x32_bf16 v[72:75],a[136:139],v[136:139],v[72:75]
s_waitcnt vmcnt(1)
s_barrier
ds_read_b128 v[192:195],v17 offset:32768
v_mfma_f32_16x16x32_bf16 v[76:79],a[140:143],v[140:143],v[76:79]
ds_read_b128 v[196:199],v17 offset:34816
s_waitcnt lgkmcnt(10)
v_mfma_f32_16x16x32_bf16 v[72:75],a[144:147],v[144:147],v[72:75]
ds_read_b128 v[200:203],v17 offset:36864
v_min3_u32 v27,v27,v136,v140
s_waitcnt vmcnt(0)
v_mfma_f32_16x16x32_bf16 v[76:79],a[148:151],v[148:151],v[76:79]
ds_read_b128 v[204:207],v17 offset:38912
v_min3_u32 v27,v27,v144,v148
v_and_or_b32 v64,v64,-4,s48
v_mfma_f32_16x16x32_bf16 v[72:75],a[152:155],v[152:155],v[72:75]
ds_read_b128 v[208:211],v17 offset:40960
s_add_u32 s64,s49,s34
v_mfma_f32_16x16x32_bf16 v[76:79],a[156:159],v[156:159],v[76:79]
v_min3_u32 v27,v27,v152,v156
s_waitcnt lgkmcnt(9)
v_mfma_f32_16x16x32_bf16 v[72:75],a[160:163],v[160:163],v[72:75]
ds_read_b128 v[212:215],v17 offset:43008
buffer_store_dwordx4 v[64:67],v25,s[20:23],s64 offen offset:2048 sc1
v_mfma_f32_16x16x32_bf16 v[76:79],a[164:167],v[164:167],v[76:79]
ds_read_b128 v[216:219],v17 offset:45056
v_min3_u32 v27,v27,v160,v164
v_and_or_b32 v68,v68,-4,s48
v_mfma_f32_16x16x32_bf16 v[72:75],a[168:171],v[168:171],v[72:75]
ds_read_b128 v[220:223],v17 offset:47104
s_add_u32 s64,s49,s35
v_mfma_f32_16x16x32_bf16 v[76:79],a[172:175],v[172:175],v[76:79]
ds_read_b128 v[224:227],v17 offset:49152
s_waitcnt lgkmcnt(9)
v_mfma_f32_16x16x32_bf16 v[72:75],a[176:179],v[176:179],v[72:75]
ds_read_b128 v[228:231],v17 offset:51200
v_min3_u32 v27,v27,v168,v172
v_mfma_f32_16x16x32_bf16 v[76:79],a[180:183],v[180:183],v[76:79]
v_min3_u32 v27,v27,v176,v180
buffer_store_dwordx4 v[68:71],v25,s[20:23],s64 offen offset:3072 sc1
v_mfma_f32_16x16x32_bf16 v[72:75],a[184:187],v[184:187],v[72:75]
ds_read_b128 v[232:235],v17 offset:53248
s_mov_b32 s49,0x7fff0000
v_mfma_f32_16x16x32_bf16 v[76:79],a[188:191],v[188:191],v[76:79]
ds_read_b128 v[236:239],v17 offset:55296
s_waitcnt lgkmcnt(8)
v_mfma_f32_16x16x32_bf16 v[72:75],a[192:195],v[192:195],v[72:75]
ds_read_b128 v[240:243],v17 offset:57344
v_min3_u32 v27,v27,v184,v188
v_mfma_f32_16x16x32_bf16 v[76:79],a[196:199],v[196:199],v[76:79]
ds_read_b128 v[244:247],v17 offset:59392
v_min3_u32 v27,v27,v192,v196
v_mfma_f32_16x16x32_bf16 v[72:75],a[200:203],v[200:203],v[72:75]
ds_read_b128 v[248:251],v17 offset:61440
ds_bpermute_b32 v124,v41,v120
v_mfma_f32_16x16x32_bf16 v[76:79],a[204:207],v[204:207],v[76:79]
v_min3_u32 v27,v27,v200,v204
s_waitcnt lgkmcnt(8)
v_mfma_f32_16x16x32_bf16 v[72:75],a[208:211],v[208:211],v[72:75]
ds_read_b128 v[252:255],v17 offset:63488
ds_bpermute_b32 v125,v41,v121
v_mfma_f32_16x16x32_bf16 v[76:79],a[212:215],v[212:215],v[76:79]
v_min3_u32 v27,v27,v208,v212
v_mfma_f32_16x16x32_bf16 v[72:75],a[216:219],v[216:219],v[72:75]
v_mfma_f32_16x16x32_bf16 v[76:79],a[220:223],v[220:223],v[76:79]
v_min3_u32 v27,v27,v216,v220
s_waitcnt lgkmcnt(6)
v_mfma_f32_16x16x32_bf16 v[72:75],a[224:227],v[224:227],v[72:75]
s_waitcnt lgkmcnt(0)
v_mfma_f32_16x16x32_bf16 v[76:79],a[228:231],v[228:231],v[76:79]
v_min3_u32 v27,v27,v224,v228
v_mfma_f32_16x16x32_bf16 v[72:75],a[232:235],v[232:235],v[72:75]
v_lshlrev_b32 v104,16,v124
v_mfma_f32_16x16x32_bf16 v[76:79],a[236:239],v[236:239],v[76:79]
v_min3_u32 v27,v27,v232,v236
v_mfma_f32_16x16x32_bf16 v[72:75],a[240:243],v[240:243],v[72:75]
v_mfma_f32_16x16x32_bf16 v[76:79],a[244:247],v[244:247],v[76:79]
v_min3_u32 v27,v27,v240,v244
v_mfma_f32_16x16x32_bf16 v[72:75],a[248:251],v[248:251],v[72:75]
v_and_b32 v105,s80,v124
v_mfma_f32_16x16x32_bf16 v[76:79],a[252:255],v[252:255],v[76:79]
v_min3_u32 v27,v27,v248,v252
v_mfma_f32_16x16x32_bf16 v[80:83],a[0:3],v[128:131],0
v_cmp_eq_u32 vcc,0,v27
s_cbranch_vccnz retry_307
v_mfma_f32_16x16x32_bf16 v[84:87],a[4:7],v[132:135],0
v_lshlrev_b32 v106,16,v125
v_mfma_f32_16x16x32_bf16 v[80:83],a[8:11],v[136:139],v[80:83]
v_mfma_f32_16x16x32_bf16 v[84:87],a[12:15],v[140:143],v[84:87]
v_mfma_f32_16x16x32_bf16 v[80:83],a[16:19],v[144:147],v[80:83]
v_and_b32 v107,s80,v125
v_add_f32 v72,v72,v76
v_mfma_f32_16x16x32_bf16 v[84:87],a[20:23],v[148:151],v[84:87]
v_add_f32 v73,v73,v77
v_add_f32 v74,v74,v78
v_mfma_f32_16x16x32_bf16 v[80:83],a[24:27],v[152:155],v[80:83]
v_add_f32 v75,v75,v79
v_and_or_b32 v72,v72,-4,s48
v_mfma_f32_16x16x32_bf16 v[84:87],a[28:31],v[156:159],v[84:87]
s_add_u32 s64,s77,s33
v_mfma_f32_16x16x32_bf16 v[80:83],a[32:35],v[160:163],v[80:83]
buffer_store_dwordx4 v[72:75],v25,s[20:23],s64 offen offset:1024 sc1
v_mfma_f32_16x16x32_bf16 v[84:87],a[36:39],v[164:167],v[84:87]
v_mfma_f32_16x16x32_bf16 v[80:83],a[40:43],v[168:171],v[80:83]
v_mfma_f32_16x16x32_bf16 v[84:87],a[44:47],v[172:175],v[84:87]
v_mfma_f32_16x16x32_bf16 v[80:83],a[48:51],v[176:179],v[80:83]
v_mfma_f32_16x16x32_bf16 v[84:87],a[52:55],v[180:183],v[84:87]
v_mfma_f32_16x16x32_bf16 v[80:83],a[56:59],v[184:187],v[80:83]
v_mfma_f32_16x16x32_bf16 v[84:87],a[60:63],v[188:191],v[84:87]
v_mfma_f32_16x16x32_bf16 v[80:83],a[64:67],v[192:195],v[80:83]
buffer_load_dwordx4 v[96:99],v26,s[20:23],s77 offen offset:2048 sc1
v_mfma_f32_16x16x32_bf16 v[84:87],a[68:71],v[196:199],v[84:87]
buffer_load_dwordx4 v[100:103],v26,s[20:23],s77 offen offset:3072 sc1
v_mfma_f32_16x16x32_bf16 v[80:83],a[72:75],v[200:203],v[80:83]
v_mfma_f32_16x16x32_bf16 v[84:87],a[76:79],v[204:207],v[84:87]
v_mfma_f32_16x16x32_bf16 v[80:83],a[80:83],v[208:211],v[80:83]
v_mfma_f32_16x16x32_bf16 v[84:87],a[84:87],v[212:215],v[84:87]
v_mfma_f32_16x16x32_bf16 v[80:83],a[88:91],v[216:219],v[80:83]
v_mfma_f32_16x16x32_bf16 v[84:87],a[92:95],v[220:223],v[84:87]
v_mfma_f32_16x16x32_bf16 v[80:83],a[96:99],v[224:227],v[80:83]
v_mfma_f32_16x16x32_bf16 v[84:87],a[100:103],v[228:231],v[84:87]
v_mfma_f32_16x16x32_bf16 v[80:83],a[104:107],v[232:235],v[80:83]
buffer_load_dwordx4 v[92:95],v26,s[20:23],s77 offen offset:1024 sc1
v_mfma_f32_16x16x32_bf16 v[84:87],a[108:111],v[236:239],v[84:87]
v_mfma_f32_16x16x32_bf16 v[80:83],a[112:115],v[240:243],v[80:83]
v_mfma_f32_16x16x32_bf16 v[84:87],a[116:119],v[244:247],v[84:87]
v_mfma_f32_16x16x32_bf16 v[80:83],a[120:123],v[248:251],v[80:83]
v_mfma_f32_16x16x32_bf16 v[84:87],a[124:127],v[252:255],v[84:87]
epi_310:
buffer_load_dword v29,v21,s[20:23],s87 offen sc1
s_nop 6
v_pk_add_f32 v[88:89],v[80:81],v[84:85]
v_pk_add_f32 v[90:91],v[82:83],v[86:87]
s_waitcnt vmcnt(1)
s_branch ic_320
ip_318:
buffer_load_dwordx4 v[92:95],v26,s[20:23],s77 offen offset:1024 sc1
buffer_load_dwordx4 v[96:99],v26,s[20:23],s77 offen offset:2048 sc1
buffer_load_dwordx4 v[100:103],v26,s[20:23],s77 offen offset:3072 sc1
s_waitcnt vmcnt(0)
ic_320:
v_bitop3_b32 v22,v92,v96,v100 bitop3:0x80
v_and_b32 v22,s48,v22
v_cmp_eq_u32 vcc,0,v22
s_cbranch_vccz ik_319
s_sub_u32 s90,s90,1
s_cmp_gt_i32 s90,0
s_cbranch_scc1 ip_318
ik_319:
v_pk_add_f32 v[88:89],v[88:89],v[92:93]
v_pk_add_f32 v[96:97],v[96:97],v[100:101]
v_pk_add_f32 v[90:91],v[90:91],v[94:95]
v_pk_add_f32 v[98:99],v[98:99],v[102:103]
v_pk_add_f32 v[88:89],v[88:89],v[96:97]
v_pk_add_f32 v[90:91],v[90:91],v[98:99]
v_pk_fma_f32 v[88:89],v[88:89],v[52:53],v[104:105]
v_pk_fma_f32 v[90:91],v[90:91],v[54:55],v[106:107]
v_cvt_pk_bf16_f32 v88,v88,v89
v_cvt_pk_bf16_f32 v89,v90,v91
v_max_u32 v88,1,v88
ds_bpermute_b32 v88,v40,v88
ds_bpermute_b32 v89,v40,v89
v_xor_b32 v18,0x10000,v18
s_xor_b32 s49,s77,524288
s_cselect_b32 s64,0,3
s_xor_b32 s48,s48,s64
s_waitcnt lgkmcnt(0)
buffer_store_dwordx2 v[88:89],v19,s[20:23],s70 offen sc1
s_mov_b32 s77,s49
s_add_u32 s78,s78,65536
s_cmp_gt_u32 s71,40
s_cselect_b32 s65,s73,0x7fff0000
s_cselect_b32 s97,0x7fff0000,s73
v_mov_b32 v22,s71
buffer_store_dword v22,v23,s[20:23],s65 offen sc1
next_317:
v_xor_b32 v17,0x10000,v17
s_xor_b32 s72,s72,0x10000
s_add_u32 s70,s70,2097152
s_xor_b32 s70,s70,0x2000
s_add_u32 s71,s71,1
s_cmp_le_u32 s71,64
s_cbranch_scc1 seg_308
s_endpgm
retry_307:
s_sub_u32 s90,s90,64
s_cmp_lt_i32 s90,0
s_cbranch_scc1 giveup_197
s_mov_b32 s83,1
s_waitcnt vmcnt(0) lgkmcnt(0)
s_barrier
s_branch seg_308
r_w4_216:
s_load_dwordx2 s[4:5],s[0:1],88
s_load_dwordx2 s[6:7],s[0:1],112
s_lshr_b32 s41,s59,3
s_and_b32 s42,s59,7
s_mul_i32 s66,s41,1835008
s_lshl_b32 s64,s42,8
s_add_u32 s66,s66,s64
s_lshl_b32 s67,s50,1
s_and_b32 s64,s41,1
s_add_u32 s67,s67,s64
s_waitcnt lgkmcnt(0)
s_mov_b32 s32,s4
s_and_b32 s33,s5,0xffff
s_mov_b32 s34,0x700000
s_mov_b32 s35,0x20000
s_sub_u32 s36,s6,0x1000
s_subb_u32 s37,s7,0
s_and_b32 s37,s37,0xffff
s_mov_b32 s38,0x401000
s_mov_b32 s39,0x20000
v_lshrrev_b32 v5,2,v3
v_lshl_add_u32 v5,v4,2,v5
v_and_b32 v6,3,v3
v_lshlrev_b32 v6,3,v6
v_lshl_add_u32 v6,v5,8,v6
v_and_b32 v5,7,v5
v_xor_b32 v5,s67,v5
v_lshl_add_u32 v12,v5,5,v6
v_xor_b32 v13,32,v12
v_and_b32 v5,15,v1
v_and_b32 v6,3,v4
v_lshlrev_b32 v6,1,v6
v_xor_b32 v5,v5,v6
v_mul_u32_u24 v6,2048,v4
v_xor_b32 v7,0,v5
v_lshl_add_u32 v8,v7,4,v6
v_xor_b32 v7,8,v5
v_lshl_add_u32 v9,v7,4,v6
s_mul_i32 s74,s50,131072
s_add_u32 s74,s74,s66
s_lshl_b32 s75,s50,14
s_mul_i32 s76,s50,65536
s_add_u32 s76,s76,s66
s_lshl_b32 s77,s50,13
s_add_u32 s64,s74,0
s_add_u32 m0,s75,0
s_nop 0
buffer_load_dwordx4 v8,s[32:35],s64 offen nt lds
s_add_u32 s64,s74,8192
s_add_u32 m0,s75,1024
s_nop 0
buffer_load_dwordx4 v9,s[32:35],s64 offen nt lds
s_add_u32 s64,s74,16384
s_add_u32 m0,s75,2048
s_nop 0
buffer_load_dwordx4 v8,s[32:35],s64 offen nt lds
s_add_u32 s64,s74,24576
s_add_u32 m0,s75,3072
s_nop 0
buffer_load_dwordx4 v9,s[32:35],s64 offen nt lds
s_add_u32 s64,s74,32768
s_add_u32 m0,s75,4096
s_nop 0
buffer_load_dwordx4 v8,s[32:35],s64 offen nt lds
s_add_u32 s64,s74,40960
s_add_u32 m0,s75,5120
s_nop 0
buffer_load_dwordx4 v9,s[32:35],s64 offen nt lds
s_add_u32 s64,s74,49152
s_add_u32 m0,s75,6144
s_nop 0
buffer_load_dwordx4 v8,s[32:35],s64 offen nt lds
s_add_u32 s64,s74,57344
s_add_u32 m0,s75,7168
s_nop 0
buffer_load_dwordx4 v9,s[32:35],s64 offen nt lds
s_add_u32 s64,s74,65536
s_add_u32 m0,s75,8192
s_nop 0
buffer_load_dwordx4 v8,s[32:35],s64 offen nt lds
s_add_u32 s64,s74,73728
s_add_u32 m0,s75,9216
s_nop 0
buffer_load_dwordx4 v9,s[32:35],s64 offen nt lds
s_add_u32 s64,s74,81920
s_add_u32 m0,s75,10240
s_nop 0
buffer_load_dwordx4 v8,s[32:35],s64 offen nt lds
s_add_u32 s64,s74,90112
s_add_u32 m0,s75,11264
s_nop 0
buffer_load_dwordx4 v9,s[32:35],s64 offen nt lds
s_add_u32 s64,s74,98304
s_add_u32 m0,s75,12288
s_nop 0
buffer_load_dwordx4 v8,s[32:35],s64 offen nt lds
s_add_u32 s64,s74,106496
s_add_u32 m0,s75,13312
s_nop 0
buffer_load_dwordx4 v9,s[32:35],s64 offen nt lds
s_add_u32 s64,s74,114688
s_add_u32 m0,s75,14336
s_nop 0
buffer_load_dwordx4 v8,s[32:35],s64 offen nt lds
s_add_u32 s64,s74,122880
s_add_u32 m0,s75,15360
s_nop 0
buffer_load_dwordx4 v9,s[32:35],s64 offen nt lds
s_add_u32 s64,s74,524288
s_add_u32 m0,s75,65536
s_nop 0
buffer_load_dwordx4 v8,s[32:35],s64 offen nt lds
s_add_u32 s64,s74,532480
s_add_u32 m0,s75,66560
s_nop 0
buffer_load_dwordx4 v9,s[32:35],s64 offen nt lds
s_add_u32 s64,s74,540672
s_add_u32 m0,s75,67584
s_nop 0
buffer_load_dwordx4 v8,s[32:35],s64 offen nt lds
s_add_u32 s64,s74,548864
s_add_u32 m0,s75,68608
s_nop 0
buffer_load_dwordx4 v9,s[32:35],s64 offen nt lds
s_add_u32 s64,s74,557056
s_add_u32 m0,s75,69632
s_nop 0
buffer_load_dwordx4 v8,s[32:35],s64 offen nt lds
s_add_u32 s64,s74,565248
s_add_u32 m0,s75,70656
s_nop 0
buffer_load_dwordx4 v9,s[32:35],s64 offen nt lds
s_add_u32 s64,s74,573440
s_add_u32 m0,s75,71680
s_nop 0
buffer_load_dwordx4 v8,s[32:35],s64 offen nt lds
s_add_u32 s64,s74,581632
s_add_u32 m0,s75,72704
s_nop 0
buffer_load_dwordx4 v9,s[32:35],s64 offen nt lds
s_add_u32 s64,s74,589824
s_add_u32 m0,s75,73728
s_nop 0
buffer_load_dwordx4 v8,s[32:35],s64 offen nt lds
s_add_u32 s64,s74,598016
s_add_u32 m0,s75,74752
s_nop 0
buffer_load_dwordx4 v9,s[32:35],s64 offen nt lds
s_add_u32 s64,s74,606208
s_add_u32 m0,s75,75776
s_nop 0
buffer_load_dwordx4 v8,s[32:35],s64 offen nt lds
s_add_u32 s64,s74,614400
s_add_u32 m0,s75,76800
s_nop 0
buffer_load_dwordx4 v9,s[32:35],s64 offen nt lds
s_add_u32 s64,s74,622592
s_add_u32 m0,s75,77824
s_nop 0
buffer_load_dwordx4 v8,s[32:35],s64 offen nt lds
s_add_u32 s64,s74,630784
s_add_u32 m0,s75,78848
s_nop 0
buffer_load_dwordx4 v9,s[32:35],s64 offen nt lds
s_add_u32 s64,s74,638976
s_add_u32 m0,s75,79872
s_nop 0
buffer_load_dwordx4 v8,s[32:35],s64 offen nt lds
s_add_u32 s64,s74,647168
s_add_u32 m0,s75,80896
s_nop 0
buffer_load_dwordx4 v9,s[32:35],s64 offen nt lds
s_waitcnt vmcnt(16)
s_barrier
ds_read_b64_tr_b16 a[0:1],v12 offset:0
ds_read_b64_tr_b16 a[112:113],v13 offset:0
ds_read_b64_tr_b16 a[2:3],v12 offset:4096
ds_read_b64_tr_b16 a[114:115],v13 offset:4096
ds_read_b64_tr_b16 a[4:5],v12 offset:8192
ds_read_b64_tr_b16 a[116:117],v13 offset:8192
ds_read_b64_tr_b16 a[6:7],v12 offset:12288
ds_read_b64_tr_b16 a[118:119],v13 offset:12288
s_waitcnt lgkmcnt(4)
ds_read_b64_tr_b16 a[8:9],v12 offset:16384
ds_read_b64_tr_b16 a[120:121],v13 offset:16384
ds_read_b64_tr_b16 a[10:11],v12 offset:20480
ds_read_b64_tr_b16 a[122:123],v13 offset:20480
ds_read_b64_tr_b16 a[12:13],v12 offset:28672
ds_read_b64_tr_b16 a[124:125],v13 offset:28672
ds_read_b64_tr_b16 a[14:15],v12 offset:32768
ds_read_b64_tr_b16 a[126:127],v13 offset:32768
s_waitcnt lgkmcnt(4)
ds_read_b64_tr_b16 a[16:17],v12 offset:36864
ds_read_b64_tr_b16 a[128:129],v13 offset:36864
ds_read_b64_tr_b16 a[18:19],v12 offset:40960
ds_read_b64_tr_b16 a[130:131],v13 offset:40960
ds_read_b64_tr_b16 a[20:21],v12 offset:45056
ds_read_b64_tr_b16 a[132:133],v13 offset:45056
ds_read_b64_tr_b16 a[22:23],v12 offset:49152
ds_read_b64_tr_b16 a[134:135],v13 offset:49152
s_waitcnt lgkmcnt(4)
ds_read_b64_tr_b16 a[24:25],v12 offset:57344
ds_read_b64_tr_b16 a[136:137],v13 offset:57344
ds_read_b64_tr_b16 a[26:27],v12 offset:61440
ds_read_b64_tr_b16 a[138:139],v13 offset:61440
ds_read_b64_tr_b16 a[96:97],v12 offset:24576
ds_read_b64_tr_b16 a[208:209],v13 offset:24576
ds_read_b64_tr_b16 a[98:99],v12 offset:53248
ds_read_b64_tr_b16 a[210:211],v13 offset:53248
s_waitcnt lgkmcnt(4)
v_xor_b32 v12,0x10000,v12
v_xor_b32 v13,0x10000,v13
s_waitcnt lgkmcnt(0)
s_barrier
s_add_u32 s64,s74,1048576
s_add_u32 m0,s75,0
s_nop 0
buffer_load_dwordx4 v8,s[32:35],s64 offen nt lds
s_add_u32 s64,s74,1056768
s_add_u32 m0,s75,1024
s_nop 0
buffer_load_dwordx4 v9,s[32:35],s64 offen nt lds
s_add_u32 s64,s74,1064960
s_add_u32 m0,s75,2048
s_nop 0
buffer_load_dwordx4 v8,s[32:35],s64 offen nt lds
s_add_u32 s64,s74,1073152
s_add_u32 m0,s75,3072
s_nop 0
buffer_load_dwordx4 v9,s[32:35],s64 offen nt lds
s_add_u32 s64,s74,1081344
s_add_u32 m0,s75,4096
s_nop 0
buffer_load_dwordx4 v8,s[32:35],s64 offen nt lds
s_add_u32 s64,s74,1089536
s_add_u32 m0,s75,5120
s_nop 0
buffer_load_dwordx4 v9,s[32:35],s64 offen nt lds
s_add_u32 s64,s74,1097728
s_add_u32 m0,s75,6144
s_nop 0
buffer_load_dwordx4 v8,s[32:35],s64 offen nt lds
s_add_u32 s64,s74,1105920
s_add_u32 m0,s75,7168
s_nop 0
buffer_load_dwordx4 v9,s[32:35],s64 offen nt lds
s_add_u32 s64,s74,1114112
s_add_u32 m0,s75,8192
s_nop 0
buffer_load_dwordx4 v8,s[32:35],s64 offen nt lds
s_add_u32 s64,s74,1122304
s_add_u32 m0,s75,9216
s_nop 0
buffer_load_dwordx4 v9,s[32:35],s64 offen nt lds
s_add_u32 s64,s74,1130496
s_add_u32 m0,s75,10240
s_nop 0
buffer_load_dwordx4 v8,s[32:35],s64 offen nt lds
s_add_u32 s64,s74,1138688
s_add_u32 m0,s75,11264
s_nop 0
buffer_load_dwordx4 v9,s[32:35],s64 offen nt lds
s_add_u32 s64,s74,1146880
s_add_u32 m0,s75,12288
s_nop 0
buffer_load_dwordx4 v8,s[32:35],s64 offen nt lds
s_add_u32 s64,s74,1155072
s_add_u32 m0,s75,13312
s_nop 0
buffer_load_dwordx4 v9,s[32:35],s64 offen nt lds
s_add_u32 s64,s74,1163264
s_add_u32 m0,s75,14336
s_nop 0
buffer_load_dwordx4 v8,s[32:35],s64 offen nt lds
s_add_u32 s64,s74,1171456
s_add_u32 m0,s75,15360
s_nop 0
buffer_load_dwordx4 v9,s[32:35],s64 offen nt lds
s_waitcnt vmcnt(16)
s_barrier
ds_read_b64_tr_b16 a[28:29],v12 offset:0
ds_read_b64_tr_b16 a[140:141],v13 offset:0
ds_read_b64_tr_b16 a[30:31],v12 offset:4096
ds_read_b64_tr_b16 a[142:143],v13 offset:4096
ds_read_b64_tr_b16 a[32:33],v12 offset:8192
ds_read_b64_tr_b16 a[144:145],v13 offset:8192
ds_read_b64_tr_b16 a[34:35],v12 offset:12288
ds_read_b64_tr_b16 a[146:147],v13 offset:12288
s_waitcnt lgkmcnt(4)
ds_read_b64_tr_b16 a[36:37],v12 offset:20480
ds_read_b64_tr_b16 a[148:149],v13 offset:20480
ds_read_b64_tr_b16 a[38:39],v12 offset:24576
ds_read_b64_tr_b16 a[150:151],v13 offset:24576
ds_read_b64_tr_b16 a[40:41],v12 offset:28672
ds_read_b64_tr_b16 a[152:153],v13 offset:28672
ds_read_b64_tr_b16 a[42:43],v12 offset:32768
ds_read_b64_tr_b16 a[154:155],v13 offset:32768
s_waitcnt lgkmcnt(4)
ds_read_b64_tr_b16 a[44:45],v12 offset:36864
ds_read_b64_tr_b16 a[156:157],v13 offset:36864
ds_read_b64_tr_b16 a[46:47],v12 offset:40960
ds_read_b64_tr_b16 a[158:159],v13 offset:40960
ds_read_b64_tr_b16 a[48:49],v12 offset:49152
ds_read_b64_tr_b16 a[160:161],v13 offset:49152
ds_read_b64_tr_b16 a[50:51],v12 offset:53248
ds_read_b64_tr_b16 a[162:163],v13 offset:53248
s_waitcnt lgkmcnt(4)
ds_read_b64_tr_b16 a[52:53],v12 offset:57344
ds_read_b64_tr_b16 a[164:165],v13 offset:57344
ds_read_b64_tr_b16 a[54:55],v12 offset:61440
ds_read_b64_tr_b16 a[166:167],v13 offset:61440
ds_read_b64_tr_b16 a[100:101],v12 offset:16384
ds_read_b64_tr_b16 a[212:213],v13 offset:16384
ds_read_b64_tr_b16 a[102:103],v12 offset:45056
ds_read_b64_tr_b16 a[214:215],v13 offset:45056
s_waitcnt lgkmcnt(4)
v_xor_b32 v12,0x10000,v12
v_xor_b32 v13,0x10000,v13
s_waitcnt lgkmcnt(0)
s_barrier
s_add_u32 s64,s76,1572864
s_add_u32 m0,s77,65536
s_nop 0
buffer_load_dwordx4 v8,s[32:35],s64 offen nt lds
s_add_u32 s64,s76,1581056
s_add_u32 m0,s77,66560
s_nop 0
buffer_load_dwordx4 v9,s[32:35],s64 offen nt lds
s_add_u32 s64,s76,1589248
s_add_u32 m0,s77,67584
s_nop 0
buffer_load_dwordx4 v8,s[32:35],s64 offen nt lds
s_add_u32 s64,s76,1597440
s_add_u32 m0,s77,68608
s_nop 0
buffer_load_dwordx4 v9,s[32:35],s64 offen nt lds
s_add_u32 s64,s76,1605632
s_add_u32 m0,s77,69632
s_nop 0
buffer_load_dwordx4 v8,s[32:35],s64 offen nt lds
s_add_u32 s64,s76,1613824
s_add_u32 m0,s77,70656
s_nop 0
buffer_load_dwordx4 v9,s[32:35],s64 offen nt lds
s_add_u32 s64,s76,1622016
s_add_u32 m0,s77,71680
s_nop 0
buffer_load_dwordx4 v8,s[32:35],s64 offen nt lds
s_add_u32 s64,s76,1630208
s_add_u32 m0,s77,72704
s_nop 0
buffer_load_dwordx4 v9,s[32:35],s64 offen nt lds
s_waitcnt vmcnt(8)
s_barrier
ds_read_b64_tr_b16 a[56:57],v12 offset:0
ds_read_b64_tr_b16 a[168:169],v13 offset:0
ds_read_b64_tr_b16 a[58:59],v12 offset:4096
ds_read_b64_tr_b16 a[170:171],v13 offset:4096
ds_read_b64_tr_b16 a[60:61],v12 offset:12288
ds_read_b64_tr_b16 a[172:173],v13 offset:12288
ds_read_b64_tr_b16 a[62:63],v12 offset:16384
ds_read_b64_tr_b16 a[174:175],v13 offset:16384
s_waitcnt lgkmcnt(4)
ds_read_b64_tr_b16 a[64:65],v12 offset:20480
ds_read_b64_tr_b16 a[176:177],v13 offset:20480
ds_read_b64_tr_b16 a[66:67],v12 offset:24576
ds_read_b64_tr_b16 a[178:179],v13 offset:24576
ds_read_b64_tr_b16 a[68:69],v12 offset:28672
ds_read_b64_tr_b16 a[180:181],v13 offset:28672
ds_read_b64_tr_b16 a[70:71],v12 offset:32768
ds_read_b64_tr_b16 a[182:183],v13 offset:32768
s_waitcnt lgkmcnt(4)
ds_read_b64_tr_b16 a[72:73],v12 offset:40960
ds_read_b64_tr_b16 a[184:185],v13 offset:40960
ds_read_b64_tr_b16 a[74:75],v12 offset:45056
ds_read_b64_tr_b16 a[186:187],v13 offset:45056
ds_read_b64_tr_b16 a[76:77],v12 offset:49152
ds_read_b64_tr_b16 a[188:189],v13 offset:49152
ds_read_b64_tr_b16 a[78:79],v12 offset:53248
ds_read_b64_tr_b16 a[190:191],v13 offset:53248
s_waitcnt lgkmcnt(4)
ds_read_b64_tr_b16 a[80:81],v12 offset:57344
ds_read_b64_tr_b16 a[192:193],v13 offset:57344
ds_read_b64_tr_b16 a[82:83],v12 offset:61440
ds_read_b64_tr_b16 a[194:195],v13 offset:61440
ds_read_b64_tr_b16 a[104:105],v12 offset:8192
ds_read_b64_tr_b16 a[216:217],v13 offset:8192
ds_read_b64_tr_b16 a[106:107],v12 offset:36864
ds_read_b64_tr_b16 a[218:219],v13 offset:36864
s_waitcnt lgkmcnt(4)
v_xor_b32 v12,0x10000,v12
v_xor_b32 v13,0x10000,v13
s_waitcnt lgkmcnt(0)
s_barrier
s_waitcnt vmcnt(0)
s_barrier
ds_read_b64_tr_b16 a[84:85],v12 offset:4096
ds_read_b64_tr_b16 a[196:197],v13 offset:4096
ds_read_b64_tr_b16 a[86:87],v12 offset:8192
ds_read_b64_tr_b16 a[198:199],v13 offset:8192
ds_read_b64_tr_b16 a[88:89],v12 offset:12288
ds_read_b64_tr_b16 a[200:201],v13 offset:12288
ds_read_b64_tr_b16 a[90:91],v12 offset:16384
ds_read_b64_tr_b16 a[202:203],v13 offset:16384
s_waitcnt lgkmcnt(4)
ds_read_b64_tr_b16 a[92:93],v12 offset:20480
ds_read_b64_tr_b16 a[204:205],v13 offset:20480
ds_read_b64_tr_b16 a[94:95],v12 offset:24576
ds_read_b64_tr_b16 a[206:207],v13 offset:24576
ds_read_b64_tr_b16 a[108:109],v12 offset:0
ds_read_b64_tr_b16 a[220:221],v13 offset:0
ds_read_b64_tr_b16 a[110:111],v12 offset:28672
ds_read_b64_tr_b16 a[222:223],v13 offset:28672
s_waitcnt lgkmcnt(4)
v_xor_b32 v12,0x10000,v12
v_xor_b32 v13,0x10000,v13
s_waitcnt lgkmcnt(0)
s_barrier
v_and_b32 v21,1,v1
v_mul_u32_u24 v21,960,v21
s_mov_b32 s65,21052032
s_mov_b32 s66,1792
pl_323:
buffer_load_dword v22,v21,s[20:23],s65 offen sc1
s_waitcnt vmcnt(0)
v_cmp_gt_u32 vcc,s66,v22
s_cbranch_vccz pok_324
s_sleep 1
s_sub_u32 s90,s90,1
s_cmp_gt_i32 s90,0
s_cbranch_scc1 pl_323
pok_324:
s_lshr_b32 s43,s41,1
s_and_b32 s48,s41,1
s_lshl_b32 s64,s42,7
s_lshl_b32 s65,s50,5
s_add_u32 s64,s64,s65
s_lshl_b32 s65,s48,4
s_add_u32 s64,s64,s65
v_lshl_add_u32 v5,v4,2,s64
v_lshlrev_b32 v6,2,v5
s_mov_b32 s64,20480
buffer_load_dwordx4 v[52:55],v6,s[20:23],s64 offen sc1
v_lshlrev_b32 v10,1,v5
v_and_b32 v6,3,v1
v_sub_u32 v5,v6,v4
v_lshl_add_u32 v5,v5,3,v10
v_lshrrev_b32 v11,2,v1
v_lshl_add_u32 v40,v6,4,v11
v_lshlrev_b32 v40,2,v40
v_lshl_add_u32 v41,v3,2,v4
v_lshlrev_b32 v41,2,v41
s_lshl_b32 s64,s43,10
v_add_u32 v17,s64,v16
v_xor_b32 v18,1024,v17
s_xor_b32 s64,s64,1024
s_lshr_b32 s65,s50,1
s_and_b32 s66,s50,1
s_lshl_b32 s66,s66,12
s_add_u32 s66,s66,s64
s_lshl_b32 s72,s65,13
s_add_u32 s72,s72,s66
s_add_u32 s72,s72,0x10000
s_lshl_b32 s65,s65,14
s_add_u32 s75,s65,s66
s_add_u32 s75,s75,1327104
s_mul_i32 s64,s41,114688
s_add_u32 s75,s75,s64
s_cmp_lt_u32 s50,2
s_cselect_b32 s86,98304,0x40000000
s_lshl_b32 s76,s79,21
s_add_u32 s76,s76,27262976
s_mov_b32 s77,0
s_lshl_b32 s78,s79,16
s_mov_b32 s49,0
s_cmp_eq_u32 s79,0
s_mov_b32 s66,8577024
s_cselect_b32 s66,18874368,s66
s_lshl_b32 s64,s59,14
s_lshl_b32 s65,s50,12
s_add_u32 s65,s65,s66
s_add_u32 s64,s64,s65
v_add_u32 v26,s64,v16
s_lshl_b32 s64,s42,14
s_add_u32 s64,s64,s65
v_add_u32 v25,s64,v16
s_xor_b32 s33,s41,1
s_xor_b32 s34,s41,2
s_xor_b32 s35,s41,3
s_lshl_b32 s33,s33,17
s_lshl_b32 s34,s34,17
s_lshl_b32 s35,s35,17
v_and_b32 v21,7,v1
v_lshlrev_b32 v21,7,v21
v_bfe_u32 v6,v1,3,2
v_lshl_add_u32 v21,v6,2,v21
s_lshl_b32 s74,s41,10
s_add_u32 s74,s74,s63
s_lshl_b32 s64,s60,4
s_add_u32 s74,s74,s64
s_add_u32 s74,s74,20480
s_lshl_b32 s64,s43,4
v_add_u32 v6,s64,v11
v_lshl_add_u32 v19,v6,11,v5
v_add_u32 v6,s64,v11
v_add_u32 v6,30,v6
v_lshl_add_u32 v9,v6,7,v5
v_and_b32 v9,2047,v9
v_and_b32 v7,3,v6
v_lshl_add_u32 v7,v7,11,v9
v_bfe_u32 v8,v6,2,3
v_lshl_add_u32 v7,v8,14,v7
v_mov_b32 v8,0x2000
v_mov_b32 v9,2097152
v_cmp_gt_u32 vcc,32,v6
s_nop 1
v_cndmask_b32 v8,v9,v8,vcc
v_add_u32 v7,v7,v8
v_add_u32 v7,1048576,v7
v_xor_b32 v20,s62,v7
s_lshl_b32 s64,s42,14
s_lshl_b32 s65,s50,11
s_add_u32 s64,s64,s65
s_lshl_b32 s65,s43,10
s_add_u32 s64,s64,s65
s_lshl_b32 s65,s48,3
s_add_u32 s64,s64,s65
s_add_u32 s64,s64,1179648
v_add_u32 v24,s64,v16
s_mov_b32 s84,0xffffff00
s_or_b32 s64,s43,s79
s_cselect_b32 s84,-1,s84
s_mov_b32 s85,-1
s_mov_b32 s48,1
s_waitcnt vmcnt(0)
s_cmp_lg_u32 s56,0
s_cbranch_scc1 kslow_325
s_add_u32 s64,s79,0
s_lshl_b32 s70,s64,21
s_lshl_b32 s64,s64,13
s_and_b32 s64,s64,0x2000
s_xor_b32 s64,s64,s62
s_add_u32 s70,s70,s64
s_add_u32 s70,s70,29360128
s_mov_b32 s83,1
s_mov_b32 s87,s74
s_cmp_eq_u32 s50,0
s_cselect_b32 s74,s74,0x7fff0000
v_mov_b32 v47,132096
s_lshl_b32 s64,s50,3
s_add_u32 s64,s64,132096
v_mov_b32 v46,s64
v_mov_b32 v29,0
s_mov_b32 s97,0x7fff0000
s_mov_b32 s69,1
s_mov_b32 s68,0
s_mov_b32 s52,0x30003
s_mov_b32 s53,s52
seg_327:
s_cmp_eq_u32 s83,0
s_cbranch_scc1 ahead_328
s_add_u32 s94,s70,s75
s_xor_b32 s95,s94,1024
s_xor_b32 s91,s72,0x10000
s_cmp_eq_u32 s69,0
s_mov_b32 s69,1
s_cbranch_scc1 half2_332
s_waitcnt vmcnt(1)
v_cmp_gt_u32 vcc,s71,v29
s_cbranch_vccz nb_331
s_cmp_lg_u32 s50,0
s_cbranch_scc1 nb_331
buffer_load_dword v32,v21,s[20:23],s74 offen sc1
s_sleep 2
pl_333:
buffer_load_dword v33,v21,s[20:23],s74 offen sc1
s_waitcnt vmcnt(1)
v_cmp_gt_u32 vcc,s71,v32
v_mov_b32 v29,v32
s_cbranch_vccz pok_334
buffer_load_dword v32,v21,s[20:23],s74 offen sc1
s_waitcnt vmcnt(1)
v_cmp_gt_u32 vcc,s71,v33
v_mov_b32 v29,v33
s_cbranch_vccz pok_334
s_sub_u32 s90,s90,1
s_cmp_gt_i32 s90,0
s_cbranch_scc1 pl_333
pok_334:
nb_331:
s_cmp_eq_u32 s71,64
s_barrier
s_cbranch_scc1 half_335
s_xor_b32 m0,s91,0
s_add_u32 s65,s94,0
buffer_load_dwordx4 v16,s[20:23],s65 offen offset:0 sc1 lds
buffer_load_dwordx4 v16,s[20:23],s65 offen offset:2048 sc1 lds
s_xor_b32 m0,s91,16384
s_add_u32 s65,s94,32768
buffer_load_dwordx4 v16,s[20:23],s65 offen offset:0 sc1 lds
buffer_load_dwordx4 v16,s[20:23],s65 offen offset:2048 sc1 lds
s_xor_b32 m0,s91,32768
s_add_u32 s65,s94,65536
buffer_load_dwordx4 v16,s[20:23],s65 offen offset:0 sc1 lds
buffer_load_dwordx4 v16,s[20:23],s65 offen offset:2048 sc1 lds
s_xor_b32 m0,s91,49152
s_add_u32 s65,s94,s86
buffer_load_dwordx4 v16,s[20:23],s65 offen offset:0 sc1 lds
buffer_load_dwordx4 v16,s[20:23],s65 offen offset:2048 sc1 lds
s_waitcnt vmcnt(6)
s_barrier
ds_read_b128 v[224:227],v18 offset:0
ds_read_b128 v[228:231],v18 offset:2048
ds_read_b128 v[232:235],v18 offset:4096
ds_read_b128 v[236:239],v18 offset:6144
ds_read_b128 v[240:243],v18 offset:8192
ds_read_b128 v[244:247],v18 offset:10240
ds_read_b128 v[248:251],v18 offset:12288
s_waitcnt lgkmcnt(5)
v_mfma_f32_16x16x32_bf16 v[64:67],a[0:3],v[224:227],0
s_xor_b32 m0,s91,1024
s_add_u32 s96,s71,1
s_add_u32 s92,s71,2
v_min_u32 v27,v224,v228
v_mfma_f32_16x16x32_bf16 v[68:71],a[112:115],v[224:227],0
ds_read_b128 v[252:255],v18 offset:14336
s_cmp_eq_u32 s96,64
s_cselect_b32 s96,99,s96
v_mfma_f32_16x16x32_bf16 v[64:67],a[4:7],v[228:231],v[64:67]
s_add_u32 s65,s95,0
s_cmp_eq_u32 s92,64
s_cselect_b32 s92,99,s92
v_mfma_f32_16x16x32_bf16 v[68:71],a[116:119],v[228:231],v[68:71]
s_waitcnt vmcnt(4)
s_barrier
ds_read_b128 v[224:227],v18 offset:16384
s_waitcnt lgkmcnt(5)
v_mfma_f32_16x16x32_bf16 v[64:67],a[8:11],v[232:235],v[64:67]
buffer_load_dwordx4 v16,s[20:23],s65 offen offset:0 sc1 lds
v_mfma_f32_16x16x32_bf16 v[68:71],a[120:123],v[232:235],v[68:71]
ds_read_b128 v[228:231],v18 offset:18432
v_min3_u32 v27,v27,v232,v236
v_mfma_f32_16x16x32_bf16 v[64:67],a[12:15],v[236:239],v[64:67]
buffer_load_dwordx4 v16,s[20:23],s65 offen offset:2048 sc1 lds
v_mfma_f32_16x16x32_bf16 v[68:71],a[124:127],v[236:239],v[68:71]
ds_read_b128 v[232:235],v18 offset:20480
s_waitcnt lgkmcnt(5)
v_mfma_f32_16x16x32_bf16 v[64:67],a[16:19],v[240:243],v[64:67]
s_xor_b32 m0,s91,17408
v_min3_u32 v27,v27,v240,v244
v_mfma_f32_16x16x32_bf16 v[68:71],a[128:131],v[240:243],v[68:71]
ds_read_b128 v[236:239],v18 offset:22528
v_mfma_f32_16x16x32_bf16 v[64:67],a[20:23],v[244:247],v[64:67]
s_add_u32 s65,s95,32768
s_waitcnt vmcnt(63)
v_mfma_f32_16x16x32_bf16 v[68:71],a[132:135],v[244:247],v[68:71]
ds_read_b128 v[240:243],v18 offset:24576
s_waitcnt lgkmcnt(5)
v_mfma_f32_16x16x32_bf16 v[64:67],a[24:27],v[248:251],v[64:67]
buffer_load_dwordx4 v16,s[20:23],s65 offen offset:0 sc1 lds
v_min3_u32 v27,v27,v248,v252
v_mfma_f32_16x16x32_bf16 v[68:71],a[136:139],v[248:251],v[68:71]
ds_read_b128 v[244:247],v18 offset:26624
v_cmp_gt_u32 vcc,s96,v29
v_cmp_gt_u32 s[92:93],s92,v29
v_mfma_f32_16x16x32_bf16 v[64:67],a[28:31],v[252:255],v[64:67]
buffer_load_dwordx4 v16,s[20:23],s65 offen offset:2048 sc1 lds
v_mfma_f32_16x16x32_bf16 v[68:71],a[140:143],v[252:255],v[68:71]
ds_read_b128 v[248:251],v18 offset:28672
s_waitcnt lgkmcnt(5)
v_mfma_f32_16x16x32_bf16 v[64:67],a[32:35],v[224:227],v[64:67]
s_xor_b32 m0,s91,33792
v_mov_b32 v44,vcc_lo
v_mov_b32 v45,s92
v_mfma_f32_16x16x32_bf16 v[68:71],a[144:147],v[224:227],v[68:71]
ds_read_b128 v[252:255],v18 offset:30720
ds_write_b64 v46,v[44:45]
v_mfma_f32_16x16x32_bf16 v[64:67],a[36:39],v[228:231],v[64:67]
s_add_u32 s65,s95,65536
v_min3_u32 v27,v27,v224,v228
v_mfma_f32_16x16x32_bf16 v[68:71],a[148:151],v[228:231],v[68:71]
s_waitcnt vmcnt(4)
s_barrier
ds_read_b128 v[224:227],v18 offset:32768
s_waitcnt lgkmcnt(6)
v_mfma_f32_16x16x32_bf16 v[64:67],a[40:43],v[232:235],v[64:67]
buffer_load_dwordx4 v16,s[20:23],s65 offen offset:0 sc1 lds
s_add_u32 s88,s70,s75
v_mfma_f32_16x16x32_bf16 v[68:71],a[152:155],v[232:235],v[68:71]
ds_read_b128 v[228:231],v18 offset:34816
v_min3_u32 v27,v27,v232,v236
s_add_u32 s88,s88,2097152
v_mfma_f32_16x16x32_bf16 v[64:67],a[44:47],v[236:239],v[64:67]
buffer_load_dwordx4 v16,s[20:23],s65 offen offset:2048 sc1 lds
v_mfma_f32_16x16x32_bf16 v[68:71],a[156:159],v[236:239],v[68:71]
ds_read_b128 v[232:235],v18 offset:36864
s_waitcnt lgkmcnt(6)
v_mfma_f32_16x16x32_bf16 v[64:67],a[48:51],v[240:243],v[64:67]
s_xor_b32 m0,s91,50176
v_min3_u32 v27,v27,v240,v244
v_mfma_f32_16x16x32_bf16 v[68:71],a[160:163],v[240:243],v[68:71]
ds_read_b128 v[236:239],v18 offset:38912
s_xor_b32 s88,s88,0x2000
v_mfma_f32_16x16x32_bf16 v[64:67],a[52:55],v[244:247],v[64:67]
s_add_u32 s65,s95,s86
s_xor_b32 s89,s88,1024
v_mfma_f32_16x16x32_bf16 v[68:71],a[164:167],v[244:247],v[68:71]
ds_read_b128 v[240:243],v18 offset:40960
s_waitcnt lgkmcnt(6)
v_mfma_f32_16x16x32_bf16 v[64:67],a[56:59],v[248:251],v[64:67]
buffer_load_dwordx4 v16,s[20:23],s65 offen offset:0 sc1 lds
v_mfma_f32_16x16x32_bf16 v[68:71],a[168:171],v[248:251],v[68:71]
ds_read_b128 v[244:247],v18 offset:43008
v_min3_u32 v27,v27,v248,v252
v_mfma_f32_16x16x32_bf16 v[64:67],a[60:63],v[252:255],v[64:67]
buffer_load_dwordx4 v16,s[20:23],s65 offen offset:2048 sc1 lds
v_mfma_f32_16x16x32_bf16 v[68:71],a[172:175],v[252:255],v[68:71]
ds_read_b128 v[248:251],v18 offset:45056
s_waitcnt lgkmcnt(5)
v_mfma_f32_16x16x32_bf16 v[64:67],a[64:67],v[224:227],v[64:67]
s_waitcnt vmcnt(4)
s_barrier
ds_read_b64 v[44:45],v47
ds_read_b128 v[128:131],v17 offset:0
ds_read_b128 v[132:135],v17 offset:2048
v_mfma_f32_16x16x32_bf16 v[68:71],a[176:179],v[224:227],v[68:71]
ds_read_b128 v[252:255],v18 offset:47104
v_min3_u32 v27,v27,v224,v228
v_mfma_f32_16x16x32_bf16 v[64:67],a[68:71],v[228:231],v[64:67]
ds_read_b128 v[136:139],v17 offset:4096
buffer_load_dwordx2 v[120:121],v20,s[20:23],s76 offen sc1
v_mfma_f32_16x16x32_bf16 v[68:71],a[180:183],v[228:231],v[68:71]
ds_read_b128 v[224:227],v18 offset:49152
s_waitcnt lgkmcnt(9)
v_mfma_f32_16x16x32_bf16 v[64:67],a[72:75],v[232:235],v[64:67]
ds_read_b128 v[140:143],v17 offset:6144
v_min3_u32 v27,v27,v232,v236
v_mfma_f32_16x16x32_bf16 v[68:71],a[184:187],v[232:235],v[68:71]
ds_read_b128 v[228:231],v18 offset:51200
buffer_load_dwordx2 v[122:123],v24,s[20:23],s70 offen sc1
v_mfma_f32_16x16x32_bf16 v[64:67],a[76:79],v[236:239],v[64:67]
ds_read_b128 v[144:147],v17 offset:8192
ds_read_b128 v[148:151],v17 offset:10240
v_mfma_f32_16x16x32_bf16 v[68:71],a[188:191],v[236:239],v[68:71]
ds_read_b128 v[232:235],v18 offset:53248
s_waitcnt lgkmcnt(12)
v_mfma_f32_16x16x32_bf16 v[64:67],a[80:83],v[240:243],v[64:67]
ds_read_b128 v[152:155],v17 offset:12288
s_waitcnt lgkmcnt(11)
v_min3_u32 v27,v27,v240,v244
v_mfma_f32_16x16x32_bf16 v[68:71],a[192:195],v[240:243],v[68:71]
ds_read_b128 v[236:239],v18 offset:55296
v_readfirstlane_b32 s93,v45
v_mfma_f32_16x16x32_bf16 v[64:67],a[84:87],v[244:247],v[64:67]
ds_read_b128 v[156:159],v17 offset:14336
v_readfirstlane_b32 s83,v44
s_cmp_lg_u32 s83,0
s_cbranch_scc0 keep_337
v_mfma_f32_16x16x32_bf16 v[68:71],a[196:199],v[244:247],v[68:71]
s_waitcnt lgkmcnt(10)
v_mfma_f32_16x16x32_bf16 v[64:67],a[88:91],v[248:251],v[64:67]
ds_read_b128 v[160:163],v17 offset:16384
ds_read_b128 v[164:167],v17 offset:18432
v_mfma_f32_16x16x32_bf16 v[68:71],a[200:203],v[248:251],v[68:71]
v_min3_u32 v27,v27,v248,v252
v_mfma_f32_16x16x32_bf16 v[64:67],a[92:95],v[252:255],v[64:67]
ds_read_b128 v[168:171],v17 offset:20480
v_mfma_f32_16x16x32_bf16 v[68:71],a[204:207],v[252:255],v[68:71]
s_waitcnt lgkmcnt(9)
v_mfma_f32_16x16x32_bf16 v[64:67],a[96:99],v[224:227],v[64:67]
ds_read_b128 v[172:175],v17 offset:22528
v_min3_u32 v27,v27,v224,v228
v_mfma_f32_16x16x32_bf16 v[68:71],a[208:211],v[224:227],v[68:71]
v_min3_u32 v27,v27,v226,v230
v_mfma_f32_16x16x32_bf16 v[64:67],a[100:103],v[228:231],v[64:67]
ds_read_b128 v[176:179],v17 offset:24576
ds_read_b128 v[180:183],v17 offset:26624
v_mfma_f32_16x16x32_bf16 v[68:71],a[212:215],v[228:231],v[68:71]
s_waitcnt lgkmcnt(7)
v_mfma_f32_16x16x32_bf16 v[64:67],a[104:107],v[232:235],v[64:67]
ds_read_b128 v[184:187],v17 offset:28672
v_min3_u32 v27,v27,v232,v236
v_mfma_f32_16x16x32_bf16 v[68:71],a[216:219],v[232:235],v[68:71]
v_min3_u32 v27,v27,v234,v238
v_mfma_f32_16x16x32_bf16 v[64:67],a[108:111],v[236:239],v[64:67]
ds_read_b128 v[188:191],v17 offset:30720
v_mfma_f32_16x16x32_bf16 v[68:71],a[220:223],v[236:239],v[68:71]
v_mfma_f32_16x16x32_bf16 v[72:75],a[112:115],v[128:131],0
v_cmp_eq_u32 vcc,0,v27
s_cbranch_vccnz retry_326
v_mfma_f32_16x16x32_bf16 v[76:79],a[116:119],v[132:135],0
v_min3_u32 v27,v27,v128,v132
v_mfma_f32_16x16x32_bf16 v[72:75],a[120:123],v[136:139],v[72:75]
s_waitcnt vmcnt(2)
s_barrier
ds_read_b128 v[192:195],v17 offset:32768
v_mfma_f32_16x16x32_bf16 v[76:79],a[124:127],v[140:143],v[76:79]
ds_read_b128 v[196:199],v17 offset:34816
s_waitcnt lgkmcnt(10)
v_mfma_f32_16x16x32_bf16 v[72:75],a[128:131],v[144:147],v[72:75]
ds_read_b128 v[200:203],v17 offset:36864
v_min3_u32 v27,v27,v136,v140
s_waitcnt vmcnt(0)
v_mfma_f32_16x16x32_bf16 v[76:79],a[132:135],v[148:151],v[76:79]
ds_read_b128 v[204:207],v17 offset:38912
v_min3_u32 v27,v27,v144,v148
v_and_or_b32 v64,v64,-4,s48
v_mfma_f32_16x16x32_bf16 v[72:75],a[136:139],v[152:155],v[72:75]
ds_read_b128 v[208:211],v17 offset:40960
s_add_u32 s64,s49,s34
v_mfma_f32_16x16x32_bf16 v[76:79],a[140:143],v[156:159],v[76:79]
v_min3_u32 v27,v27,v152,v156
s_waitcnt lgkmcnt(9)
v_mfma_f32_16x16x32_bf16 v[72:75],a[144:147],v[160:163],v[72:75]
ds_read_b128 v[212:215],v17 offset:43008
buffer_store_dwordx4 v[64:67],v25,s[20:23],s64 offen offset:2048
v_mfma_f32_16x16x32_bf16 v[76:79],a[148:151],v[164:167],v[76:79]
ds_read_b128 v[216:219],v17 offset:45056
v_min3_u32 v27,v27,v160,v164
v_and_or_b32 v68,v68,-4,s48
v_mfma_f32_16x16x32_bf16 v[72:75],a[152:155],v[168:171],v[72:75]
ds_read_b128 v[220:223],v17 offset:47104
s_add_u32 s64,s49,s35
v_mfma_f32_16x16x32_bf16 v[76:79],a[156:159],v[172:175],v[76:79]
ds_read_b128 v[224:227],v17 offset:49152
s_waitcnt lgkmcnt(9)
v_mfma_f32_16x16x32_bf16 v[72:75],a[160:163],v[176:179],v[72:75]
ds_read_b128 v[228:231],v17 offset:51200
v_min3_u32 v27,v27,v168,v172
v_mfma_f32_16x16x32_bf16 v[76:79],a[164:167],v[180:183],v[76:79]
v_min3_u32 v27,v27,v176,v180
buffer_store_dwordx4 v[68:71],v25,s[20:23],s64 offen offset:3072
v_mfma_f32_16x16x32_bf16 v[72:75],a[168:171],v[184:187],v[72:75]
ds_read_b128 v[232:235],v17 offset:53248
s_mov_b32 s49,0x7fff0000
v_mfma_f32_16x16x32_bf16 v[76:79],a[172:175],v[188:191],v[76:79]
ds_read_b128 v[236:239],v17 offset:55296
s_waitcnt lgkmcnt(8)
v_mfma_f32_16x16x32_bf16 v[72:75],a[176:179],v[192:195],v[72:75]
v_min3_u32 v27,v27,v184,v188
v_mfma_f32_16x16x32_bf16 v[76:79],a[180:183],v[196:199],v[76:79]
v_min3_u32 v27,v27,v192,v196
ds_bpermute_b32 v124,v41,v120
v_mfma_f32_16x16x32_bf16 v[72:75],a[184:187],v[200:203],v[72:75]
v_mfma_f32_16x16x32_bf16 v[76:79],a[188:191],v[204:207],v[76:79]
v_min3_u32 v27,v27,v200,v204
s_waitcnt lgkmcnt(5)
v_mfma_f32_16x16x32_bf16 v[72:75],a[192:195],v[208:211],v[72:75]
ds_bpermute_b32 v125,v41,v121
v_mfma_f32_16x16x32_bf16 v[76:79],a[196:199],v[212:215],v[76:79]
v_min3_u32 v27,v27,v208,v212
v_lshlrev_b32 v108,16,v122
v_mfma_f32_16x16x32_bf16 v[72:75],a[200:203],v[216:219],v[72:75]
v_mfma_f32_16x16x32_bf16 v[76:79],a[204:207],v[220:223],v[76:79]
v_min3_u32 v27,v27,v216,v220
s_waitcnt lgkmcnt(2)
v_mfma_f32_16x16x32_bf16 v[72:75],a[208:211],v[224:227],v[72:75]
v_and_b32 v109,s80,v122
v_mfma_f32_16x16x32_bf16 v[76:79],a[212:215],v[228:231],v[76:79]
v_min3_u32 v27,v27,v224,v228
v_min3_u32 v27,v27,v226,v230
v_mfma_f32_16x16x32_bf16 v[72:75],a[216:219],v[232:235],v[72:75]
v_lshlrev_b32 v110,16,v123
v_mfma_f32_16x16x32_bf16 v[76:79],a[220:223],v[236:239],v[76:79]
v_min3_u32 v27,v27,v232,v236
v_min3_u32 v27,v27,v234,v238
v_mfma_f32_16x16x32_bf16 v[80:83],a[0:3],v[128:131],0
v_cmp_eq_u32 vcc,0,v27
s_cbranch_vccnz retry_326
v_mfma_f32_16x16x32_bf16 v[84:87],a[4:7],v[132:135],0
v_and_b32 v111,s80,v123
s_waitcnt lgkmcnt(0)
v_mfma_f32_16x16x32_bf16 v[80:83],a[8:11],v[136:139],v[80:83]
v_mfma_f32_16x16x32_bf16 v[84:87],a[12:15],v[140:143],v[84:87]
v_lshlrev_b32 v104,16,v124
v_mfma_f32_16x16x32_bf16 v[80:83],a[16:19],v[144:147],v[80:83]
v_add_f32 v72,v72,v76
v_add_f32 v73,v73,v77
v_mfma_f32_16x16x32_bf16 v[84:87],a[20:23],v[148:151],v[84:87]
v_and_b32 v105,s80,v124
v_add_f32 v74,v74,v78
v_mfma_f32_16x16x32_bf16 v[80:83],a[24:27],v[152:155],v[80:83]
v_add_f32 v75,v75,v79
v_and_or_b32 v72,v72,-4,s48
v_mfma_f32_16x16x32_bf16 v[84:87],a[28:31],v[156:159],v[84:87]
v_lshlrev_b32 v106,16,v125
s_add_u32 s64,s77,s33
v_mfma_f32_16x16x32_bf16 v[80:83],a[32:35],v[160:163],v[80:83]
buffer_store_dwordx4 v[72:75],v25,s[20:23],s64 offen offset:1024
v_mfma_f32_16x16x32_bf16 v[84:87],a[36:39],v[164:167],v[84:87]
v_and_b32 v107,s80,v125
v_mfma_f32_16x16x32_bf16 v[80:83],a[40:43],v[168:171],v[80:83]
v_mfma_f32_16x16x32_bf16 v[84:87],a[44:47],v[172:175],v[84:87]
v_mfma_f32_16x16x32_bf16 v[80:83],a[48:51],v[176:179],v[80:83]
buffer_load_dwordx4 v[96:99],v26,s[20:23],s77 offen offset:2048 sc1
v_mfma_f32_16x16x32_bf16 v[84:87],a[52:55],v[180:183],v[84:87]
buffer_load_dwordx4 v[100:103],v26,s[20:23],s77 offen offset:3072 sc1
v_mfma_f32_16x16x32_bf16 v[80:83],a[56:59],v[184:187],v[80:83]
v_mfma_f32_16x16x32_bf16 v[84:87],a[60:63],v[188:191],v[84:87]
v_mfma_f32_16x16x32_bf16 v[80:83],a[64:67],v[192:195],v[80:83]
v_mfma_f32_16x16x32_bf16 v[84:87],a[68:71],v[196:199],v[84:87]
v_mfma_f32_16x16x32_bf16 v[80:83],a[72:75],v[200:203],v[80:83]
v_mfma_f32_16x16x32_bf16 v[84:87],a[76:79],v[204:207],v[84:87]
v_mfma_f32_16x16x32_bf16 v[80:83],a[80:83],v[208:211],v[80:83]
v_mfma_f32_16x16x32_bf16 v[84:87],a[84:87],v[212:215],v[84:87]
v_mfma_f32_16x16x32_bf16 v[80:83],a[88:91],v[216:219],v[80:83]
buffer_load_dwordx4 v[92:95],v26,s[20:23],s77 offen offset:1024 sc1
v_mfma_f32_16x16x32_bf16 v[84:87],a[92:95],v[220:223],v[84:87]
v_mfma_f32_16x16x32_bf16 v[80:83],a[96:99],v[224:227],v[80:83]
v_mfma_f32_16x16x32_bf16 v[84:87],a[100:103],v[228:231],v[84:87]
v_mfma_f32_16x16x32_bf16 v[80:83],a[104:107],v[232:235],v[80:83]
v_mfma_f32_16x16x32_bf16 v[84:87],a[108:111],v[236:239],v[84:87]
s_branch epi_329
keep_337:
v_mfma_f32_16x16x32_bf16 v[68:71],a[196:199],v[244:247],v[68:71]
s_xor_b32 m0,s72,0
s_add_u32 s65,s88,0
s_waitcnt lgkmcnt(10)
v_mfma_f32_16x16x32_bf16 v[64:67],a[88:91],v[248:251],v[64:67]
ds_read_b128 v[160:163],v17 offset:16384
ds_read_b128 v[164:167],v17 offset:18432
v_min3_u32 v27,v27,v248,v252
v_mfma_f32_16x16x32_bf16 v[68:71],a[200:203],v[248:251],v[68:71]
buffer_load_dwordx4 v16,s[20:23],s65 offen offset:0 sc1 lds
v_mfma_f32_16x16x32_bf16 v[64:67],a[92:95],v[252:255],v[64:67]
ds_read_b128 v[168:171],v17 offset:20480
buffer_load_dwordx4 v16,s[20:23],s65 offen offset:2048 sc1 lds
v_mfma_f32_16x16x32_bf16 v[68:71],a[204:207],v[252:255],v[68:71]
s_xor_b32 m0,s72,16384
s_add_u32 s65,s88,32768
s_waitcnt lgkmcnt(9)
v_mfma_f32_16x16x32_bf16 v[64:67],a[96:99],v[224:227],v[64:67]
ds_read_b128 v[172:175],v17 offset:22528
buffer_load_dwordx4 v16,s[20:23],s65 offen offset:0 sc1 lds
v_min3_u32 v27,v27,v224,v228
v_mfma_f32_16x16x32_bf16 v[68:71],a[208:211],v[224:227],v[68:71]
buffer_load_dwordx4 v16,s[20:23],s65 offen offset:2048 sc1 lds
v_min3_u32 v27,v27,v226,v230
v_mfma_f32_16x16x32_bf16 v[64:67],a[100:103],v[228:231],v[64:67]
ds_read_b128 v[176:179],v17 offset:24576
ds_read_b128 v[180:183],v17 offset:26624
s_xor_b32 m0,s72,32768
v_mfma_f32_16x16x32_bf16 v[68:71],a[212:215],v[228:231],v[68:71]
s_add_u32 s65,s88,65536
s_waitcnt lgkmcnt(7)
v_mfma_f32_16x16x32_bf16 v[64:67],a[104:107],v[232:235],v[64:67]
ds_read_b128 v[184:187],v17 offset:28672
buffer_load_dwordx4 v16,s[20:23],s65 offen offset:0 sc1 lds
v_mfma_f32_16x16x32_bf16 v[68:71],a[216:219],v[232:235],v[68:71]
buffer_load_dwordx4 v16,s[20:23],s65 offen offset:2048 sc1 lds
v_min3_u32 v27,v27,v232,v236
v_mfma_f32_16x16x32_bf16 v[64:67],a[108:111],v[236:239],v[64:67]
ds_read_b128 v[188:191],v17 offset:30720
s_xor_b32 m0,s72,49152
v_min3_u32 v27,v27,v234,v238
v_mfma_f32_16x16x32_bf16 v[68:71],a[220:223],v[236:239],v[68:71]
s_add_u32 s65,s88,s86
v_mfma_f32_16x16x32_bf16 v[72:75],a[112:115],v[128:131],0
buffer_load_dwordx4 v16,s[20:23],s65 offen offset:0 sc1 lds
v_cmp_eq_u32 vcc,0,v27
s_cbranch_vccnz retry_326
v_mfma_f32_16x16x32_bf16 v[76:79],a[116:119],v[132:135],0
buffer_load_dwordx4 v16,s[20:23],s65 offen offset:2048 sc1 lds
v_mfma_f32_16x16x32_bf16 v[72:75],a[120:123],v[136:139],v[72:75]
s_waitcnt vmcnt(10)
s_barrier
ds_read_b128 v[192:195],v17 offset:32768
v_mfma_f32_16x16x32_bf16 v[76:79],a[124:127],v[140:143],v[76:79]
ds_read_b128 v[196:199],v17 offset:34816
s_xor_b32 m0,s72,1024
s_waitcnt lgkmcnt(10)
v_mfma_f32_16x16x32_bf16 v[72:75],a[128:131],v[144:147],v[72:75]
ds_read_b128 v[200:203],v17 offset:36864
s_add_u32 s65,s89,0
s_waitcnt vmcnt(8)
v_and_or_b32 v64,v64,-4,s48
v_mfma_f32_16x16x32_bf16 v[76:79],a[132:135],v[148:151],v[76:79]
ds_read_b128 v[204:207],v17 offset:38912
buffer_load_dwordx4 v16,s[20:23],s65 offen offset:0 sc1 lds
s_add_u32 s64,s49,s34
v_mfma_f32_16x16x32_bf16 v[72:75],a[136:139],v[152:155],v[72:75]
ds_read_b128 v[208:211],v17 offset:40960
buffer_load_dwordx4 v16,s[20:23],s65 offen offset:2048 sc1 lds
v_mfma_f32_16x16x32_bf16 v[76:79],a[140:143],v[156:159],v[76:79]
s_xor_b32 m0,s72,17408
s_add_u32 s65,s89,32768
s_waitcnt lgkmcnt(9)
v_mfma_f32_16x16x32_bf16 v[72:75],a[144:147],v[160:163],v[72:75]
ds_read_b128 v[212:215],v17 offset:43008
buffer_load_dwordx4 v16,s[20:23],s65 offen offset:0 sc1 lds
v_mfma_f32_16x16x32_bf16 v[76:79],a[148:151],v[164:167],v[76:79]
ds_read_b128 v[216:219],v17 offset:45056
buffer_load_dwordx4 v16,s[20:23],s65 offen offset:2048 sc1 lds
v_mfma_f32_16x16x32_bf16 v[72:75],a[152:155],v[168:171],v[72:75]
ds_read_b128 v[220:223],v17 offset:47104
s_xor_b32 m0,s72,33792
buffer_store_dwordx4 v[64:67],v25,s[20:23],s64 offen offset:2048
v_mfma_f32_16x16x32_bf16 v[76:79],a[156:159],v[172:175],v[76:79]
ds_read_b128 v[224:227],v17 offset:49152
v_and_or_b32 v68,v68,-4,s48
s_add_u32 s64,s49,s35
s_waitcnt lgkmcnt(9)
v_mfma_f32_16x16x32_bf16 v[72:75],a[160:163],v[176:179],v[72:75]
ds_read_b128 v[228:231],v17 offset:51200
s_add_u32 s65,s89,65536
buffer_store_dwordx4 v[68:71],v25,s[20:23],s64 offen offset:3072
v_mfma_f32_16x16x32_bf16 v[76:79],a[164:167],v[180:183],v[76:79]
buffer_load_dwordx4 v16,s[20:23],s65 offen offset:0 sc1 lds
s_mov_b32 s49,0x7fff0000
v_mfma_f32_16x16x32_bf16 v[72:75],a[168:171],v[184:187],v[72:75]
ds_read_b128 v[232:235],v17 offset:53248
v_min3_u32 v27,v27,v128,v132
v_mfma_f32_16x16x32_bf16 v[76:79],a[172:175],v[188:191],v[76:79]
ds_read_b128 v[236:239],v17 offset:55296
s_waitcnt lgkmcnt(8)
v_mfma_f32_16x16x32_bf16 v[72:75],a[176:179],v[192:195],v[72:75]
buffer_load_dwordx4 v16,s[20:23],s65 offen offset:2048 sc1 lds
v_mfma_f32_16x16x32_bf16 v[76:79],a[180:183],v[196:199],v[76:79]
s_xor_b32 m0,s72,50176
s_add_u32 s65,s89,s86
v_mfma_f32_16x16x32_bf16 v[72:75],a[184:187],v[200:203],v[72:75]
buffer_load_dwordx4 v16,s[20:23],s65 offen offset:0 sc1 lds
v_mfma_f32_16x16x32_bf16 v[76:79],a[188:191],v[204:207],v[76:79]
v_min3_u32 v27,v27,v136,v140
s_waitcnt lgkmcnt(4)
v_mfma_f32_16x16x32_bf16 v[72:75],a[192:195],v[208:211],v[72:75]
buffer_load_dwordx4 v16,s[20:23],s65 offen offset:2048 sc1 lds
v_mfma_f32_16x16x32_bf16 v[76:79],a[196:199],v[212:215],v[76:79]
v_min3_u32 v27,v27,v144,v148
v_min3_u32 v27,v27,v152,v156
v_mfma_f32_16x16x32_bf16 v[72:75],a[200:203],v[216:219],v[72:75]
v_min3_u32 v27,v27,v160,v164
v_min3_u32 v27,v27,v168,v172
v_mfma_f32_16x16x32_bf16 v[76:79],a[204:207],v[220:223],v[76:79]
v_min3_u32 v27,v27,v176,v180
s_waitcnt lgkmcnt(0)
v_mfma_f32_16x16x32_bf16 v[72:75],a[208:211],v[224:227],v[72:75]
v_min3_u32 v27,v27,v184,v188
v_min3_u32 v27,v27,v192,v196
v_mfma_f32_16x16x32_bf16 v[76:79],a[212:215],v[228:231],v[76:79]
v_min3_u32 v27,v27,v200,v204
v_min3_u32 v27,v27,v208,v212
v_mfma_f32_16x16x32_bf16 v[72:75],a[216:219],v[232:235],v[72:75]
v_min3_u32 v27,v27,v216,v220
v_min3_u32 v27,v27,v224,v228
v_mfma_f32_16x16x32_bf16 v[76:79],a[220:223],v[236:239],v[76:79]
v_min3_u32 v27,v27,v226,v230
v_min3_u32 v27,v27,v232,v236
v_min3_u32 v27,v27,v234,v238
v_mfma_f32_16x16x32_bf16 v[80:83],a[0:3],v[128:131],0
v_cmp_eq_u32 vcc,0,v27
s_cbranch_vccnz retry_326
v_mfma_f32_16x16x32_bf16 v[84:87],a[4:7],v[132:135],0
ds_bpermute_b32 v124,v41,v120
ds_bpermute_b32 v125,v41,v121
v_mfma_f32_16x16x32_bf16 v[80:83],a[8:11],v[136:139],v[80:83]
v_lshlrev_b32 v108,16,v122
v_and_b32 v109,s80,v122
v_mfma_f32_16x16x32_bf16 v[84:87],a[12:15],v[140:143],v[84:87]
v_lshlrev_b32 v110,16,v123
v_and_b32 v111,s80,v123
v_mfma_f32_16x16x32_bf16 v[80:83],a[16:19],v[144:147],v[80:83]
s_waitcnt lgkmcnt(0)
v_lshlrev_b32 v104,16,v124
v_mfma_f32_16x16x32_bf16 v[84:87],a[20:23],v[148:151],v[84:87]
v_and_b32 v105,s80,v124
v_add_f32 v72,v72,v76
v_mfma_f32_16x16x32_bf16 v[80:83],a[24:27],v[152:155],v[80:83]
v_add_f32 v73,v73,v77
v_add_f32 v74,v74,v78
v_mfma_f32_16x16x32_bf16 v[84:87],a[28:31],v[156:159],v[84:87]
v_lshlrev_b32 v106,16,v125
v_add_f32 v75,v75,v79
v_mfma_f32_16x16x32_bf16 v[80:83],a[32:35],v[160:163],v[80:83]
v_and_or_b32 v72,v72,-4,s48
s_add_u32 s64,s77,s33
v_mfma_f32_16x16x32_bf16 v[84:87],a[36:39],v[164:167],v[84:87]
v_and_b32 v107,s80,v125
v_mfma_f32_16x16x32_bf16 v[80:83],a[40:43],v[168:171],v[80:83]
buffer_store_dwordx4 v[72:75],v25,s[20:23],s64 offen offset:1024
v_mfma_f32_16x16x32_bf16 v[84:87],a[44:47],v[172:175],v[84:87]
v_mfma_f32_16x16x32_bf16 v[80:83],a[48:51],v[176:179],v[80:83]
buffer_load_dwordx4 v[96:99],v26,s[20:23],s77 offen offset:2048 sc1
v_mfma_f32_16x16x32_bf16 v[84:87],a[52:55],v[180:183],v[84:87]
buffer_load_dwordx4 v[100:103],v26,s[20:23],s77 offen offset:3072 sc1
v_mfma_f32_16x16x32_bf16 v[80:83],a[56:59],v[184:187],v[80:83]
v_mfma_f32_16x16x32_bf16 v[84:87],a[60:63],v[188:191],v[84:87]
v_mfma_f32_16x16x32_bf16 v[80:83],a[64:67],v[192:195],v[80:83]
v_mfma_f32_16x16x32_bf16 v[84:87],a[68:71],v[196:199],v[84:87]
v_mfma_f32_16x16x32_bf16 v[80:83],a[72:75],v[200:203],v[80:83]
v_mfma_f32_16x16x32_bf16 v[84:87],a[76:79],v[204:207],v[84:87]
v_mfma_f32_16x16x32_bf16 v[80:83],a[80:83],v[208:211],v[80:83]
v_mfma_f32_16x16x32_bf16 v[84:87],a[84:87],v[212:215],v[84:87]
v_mfma_f32_16x16x32_bf16 v[80:83],a[88:91],v[216:219],v[80:83]
buffer_load_dwordx4 v[92:95],v26,s[20:23],s77 offen offset:1024 sc1
v_mfma_f32_16x16x32_bf16 v[84:87],a[92:95],v[220:223],v[84:87]
v_mfma_f32_16x16x32_bf16 v[80:83],a[96:99],v[224:227],v[80:83]
v_mfma_f32_16x16x32_bf16 v[84:87],a[100:103],v[228:231],v[84:87]
v_mfma_f32_16x16x32_bf16 v[80:83],a[104:107],v[232:235],v[80:83]
v_mfma_f32_16x16x32_bf16 v[84:87],a[108:111],v[236:239],v[84:87]
s_branch epi_329
ahead_328:
s_cmp_eq_u32 s93,0
s_cbranch_scc1 both_330
s_waitcnt vmcnt(14) lgkmcnt(0)
s_barrier
ds_read_b128 v[224:227],v18 offset:0
ds_read_b128 v[228:231],v18 offset:2048
ds_read_b128 v[232:235],v18 offset:4096
ds_read_b128 v[236:239],v18 offset:6144
ds_read_b128 v[240:243],v18 offset:8192
ds_read_b128 v[244:247],v18 offset:10240
ds_read_b128 v[248:251],v18 offset:12288
s_waitcnt lgkmcnt(5)
v_mfma_f32_16x16x32_bf16 v[64:67],a[0:3],v[224:227],0
s_add_u32 s96,s71,1
s_add_u32 s92,s71,2
v_mfma_f32_16x16x32_bf16 v[68:71],a[112:115],v[224:227],0
ds_read_b128 v[252:255],v18 offset:14336
v_min_u32 v27,v224,v228
v_mfma_f32_16x16x32_bf16 v[64:67],a[4:7],v[228:231],v[64:67]
s_cmp_eq_u32 s96,64
s_cselect_b32 s96,99,s96
v_mfma_f32_16x16x32_bf16 v[68:71],a[116:119],v[228:231],v[68:71]
ds_read_b128 v[224:227],v18 offset:16384
s_waitcnt lgkmcnt(5)
v_mfma_f32_16x16x32_bf16 v[64:67],a[8:11],v[232:235],v[64:67]
s_cmp_eq_u32 s92,64
s_cselect_b32 s92,99,s92
v_mfma_f32_16x16x32_bf16 v[68:71],a[120:123],v[232:235],v[68:71]
ds_read_b128 v[228:231],v18 offset:18432
v_min3_u32 v27,v27,v232,v236
v_mfma_f32_16x16x32_bf16 v[64:67],a[12:15],v[236:239],v[64:67]
buffer_load_dwordx2 v[120:121],v20,s[20:23],s76 offen sc1
v_mfma_f32_16x16x32_bf16 v[68:71],a[124:127],v[236:239],v[68:71]
ds_read_b128 v[232:235],v18 offset:20480
s_waitcnt lgkmcnt(5)
v_mfma_f32_16x16x32_bf16 v[64:67],a[16:19],v[240:243],v[64:67]
v_min3_u32 v27,v27,v240,v244
v_mfma_f32_16x16x32_bf16 v[68:71],a[128:131],v[240:243],v[68:71]
ds_read_b128 v[236:239],v18 offset:22528
v_mfma_f32_16x16x32_bf16 v[64:67],a[20:23],v[244:247],v[64:67]
s_waitcnt vmcnt(2)
v_mfma_f32_16x16x32_bf16 v[68:71],a[132:135],v[244:247],v[68:71]
ds_read_b128 v[240:243],v18 offset:24576
s_waitcnt lgkmcnt(5)
v_mfma_f32_16x16x32_bf16 v[64:67],a[24:27],v[248:251],v[64:67]
v_cmp_gt_u32 vcc,s96,v29
v_cmp_gt_u32 s[92:93],s92,v29
v_mfma_f32_16x16x32_bf16 v[68:71],a[136:139],v[248:251],v[68:71]
ds_read_b128 v[244:247],v18 offset:26624
v_min3_u32 v27,v27,v248,v252
v_mfma_f32_16x16x32_bf16 v[64:67],a[28:31],v[252:255],v[64:67]
v_mov_b32 v44,vcc_lo
v_mov_b32 v45,s92
v_mfma_f32_16x16x32_bf16 v[68:71],a[140:143],v[252:255],v[68:71]
ds_read_b128 v[248:251],v18 offset:28672
s_waitcnt lgkmcnt(5)
v_mfma_f32_16x16x32_bf16 v[64:67],a[32:35],v[224:227],v[64:67]
ds_write_b64 v46,v[44:45]
v_min3_u32 v27,v27,v224,v228
v_mfma_f32_16x16x32_bf16 v[68:71],a[144:147],v[224:227],v[68:71]
ds_read_b128 v[252:255],v18 offset:30720
v_mfma_f32_16x16x32_bf16 v[64:67],a[36:39],v[228:231],v[64:67]
buffer_load_dwordx2 v[122:123],v24,s[20:23],s70 offen sc1
v_mfma_f32_16x16x32_bf16 v[68:71],a[148:151],v[228:231],v[68:71]
ds_read_b128 v[224:227],v18 offset:32768
s_waitcnt lgkmcnt(6)
v_mfma_f32_16x16x32_bf16 v[64:67],a[40:43],v[232:235],v[64:67]
v_min3_u32 v27,v27,v232,v236
s_add_u32 s88,s70,s75
v_mfma_f32_16x16x32_bf16 v[68:71],a[152:155],v[232:235],v[68:71]
ds_read_b128 v[228:231],v18 offset:34816
s_add_u32 s88,s88,2097152
v_mfma_f32_16x16x32_bf16 v[64:67],a[44:47],v[236:239],v[64:67]
s_xor_b32 s88,s88,0x2000
s_xor_b32 s89,s88,1024
v_mfma_f32_16x16x32_bf16 v[68:71],a[156:159],v[236:239],v[68:71]
ds_read_b128 v[232:235],v18 offset:36864
s_waitcnt lgkmcnt(6)
v_mfma_f32_16x16x32_bf16 v[64:67],a[48:51],v[240:243],v[64:67]
v_min3_u32 v27,v27,v240,v244
v_mfma_f32_16x16x32_bf16 v[68:71],a[160:163],v[240:243],v[68:71]
ds_read_b128 v[236:239],v18 offset:38912
v_mfma_f32_16x16x32_bf16 v[64:67],a[52:55],v[244:247],v[64:67]
v_mfma_f32_16x16x32_bf16 v[68:71],a[164:167],v[244:247],v[68:71]
ds_read_b128 v[240:243],v18 offset:40960
s_waitcnt lgkmcnt(5)
v_mfma_f32_16x16x32_bf16 v[64:67],a[56:59],v[248:251],v[64:67]
v_min3_u32 v27,v27,v248,v252
v_mfma_f32_16x16x32_bf16 v[68:71],a[168:171],v[248:251],v[68:71]
ds_read_b128 v[244:247],v18 offset:43008
v_mfma_f32_16x16x32_bf16 v[64:67],a[60:63],v[252:255],v[64:67]
v_mfma_f32_16x16x32_bf16 v[68:71],a[172:175],v[252:255],v[68:71]
ds_read_b128 v[248:251],v18 offset:45056
s_waitcnt lgkmcnt(5)
v_mfma_f32_16x16x32_bf16 v[64:67],a[64:67],v[224:227],v[64:67]
s_waitcnt vmcnt(8)
s_barrier
ds_read_b64 v[44:45],v47
ds_read_b128 v[128:131],v17 offset:0
ds_read_b128 v[132:135],v17 offset:2048
v_mfma_f32_16x16x32_bf16 v[68:71],a[176:179],v[224:227],v[68:71]
ds_read_b128 v[252:255],v18 offset:47104
v_min3_u32 v27,v27,v224,v228
v_mfma_f32_16x16x32_bf16 v[64:67],a[68:71],v[228:231],v[64:67]
ds_read_b128 v[136:139],v17 offset:4096
v_mfma_f32_16x16x32_bf16 v[68:71],a[180:183],v[228:231],v[68:71]
ds_read_b128 v[224:227],v18 offset:49152
s_waitcnt lgkmcnt(9)
v_mfma_f32_16x16x32_bf16 v[64:67],a[72:75],v[232:235],v[64:67]
ds_read_b128 v[140:143],v17 offset:6144
v_min3_u32 v27,v27,v232,v236
v_mfma_f32_16x16x32_bf16 v[68:71],a[184:187],v[232:235],v[68:71]
ds_read_b128 v[228:231],v18 offset:51200
v_mfma_f32_16x16x32_bf16 v[64:67],a[76:79],v[236:239],v[64:67]
ds_read_b128 v[144:147],v17 offset:8192
ds_read_b128 v[148:151],v17 offset:10240
v_mfma_f32_16x16x32_bf16 v[68:71],a[188:191],v[236:239],v[68:71]
ds_read_b128 v[232:235],v18 offset:53248
s_waitcnt lgkmcnt(12)
v_mfma_f32_16x16x32_bf16 v[64:67],a[80:83],v[240:243],v[64:67]
ds_read_b128 v[152:155],v17 offset:12288
s_waitcnt lgkmcnt(11)
v_min3_u32 v27,v27,v240,v244
v_mfma_f32_16x16x32_bf16 v[68:71],a[192:195],v[240:243],v[68:71]
ds_read_b128 v[236:239],v18 offset:55296
v_readfirstlane_b32 s93,v45
v_mfma_f32_16x16x32_bf16 v[64:67],a[84:87],v[244:247],v[64:67]
ds_read_b128 v[156:159],v17 offset:14336
v_readfirstlane_b32 s83,v44
s_cmp_lg_u32 s83,0
s_cbranch_scc1 keep_338
v_mfma_f32_16x16x32_bf16 v[68:71],a[196:199],v[244:247],v[68:71]
s_xor_b32 m0,s72,0
s_add_u32 s65,s88,0
s_waitcnt lgkmcnt(10)
v_mfma_f32_16x16x32_bf16 v[64:67],a[88:91],v[248:251],v[64:67]
ds_read_b128 v[160:163],v17 offset:16384
ds_read_b128 v[164:167],v17 offset:18432
v_min3_u32 v27,v27,v248,v252
v_mfma_f32_16x16x32_bf16 v[68:71],a[200:203],v[248:251],v[68:71]
buffer_load_dwordx4 v16,s[20:23],s65 offen offset:0 sc1 lds
v_mfma_f32_16x16x32_bf16 v[64:67],a[92:95],v[252:255],v[64:67]
ds_read_b128 v[168:171],v17 offset:20480
buffer_load_dwordx4 v16,s[20:23],s65 offen offset:2048 sc1 lds
v_mfma_f32_16x16x32_bf16 v[68:71],a[204:207],v[252:255],v[68:71]
s_xor_b32 m0,s72,16384
s_add_u32 s65,s88,32768
s_waitcnt lgkmcnt(9)
v_mfma_f32_16x16x32_bf16 v[64:67],a[96:99],v[224:227],v[64:67]
ds_read_b128 v[172:175],v17 offset:22528
buffer_load_dwordx4 v16,s[20:23],s65 offen offset:0 sc1 lds
v_min3_u32 v27,v27,v224,v228
v_mfma_f32_16x16x32_bf16 v[68:71],a[208:211],v[224:227],v[68:71]
buffer_load_dwordx4 v16,s[20:23],s65 offen offset:2048 sc1 lds
v_min3_u32 v27,v27,v226,v230
v_mfma_f32_16x16x32_bf16 v[64:67],a[100:103],v[228:231],v[64:67]
ds_read_b128 v[176:179],v17 offset:24576
ds_read_b128 v[180:183],v17 offset:26624
s_xor_b32 m0,s72,32768
v_mfma_f32_16x16x32_bf16 v[68:71],a[212:215],v[228:231],v[68:71]
s_add_u32 s65,s88,65536
s_waitcnt lgkmcnt(7)
v_mfma_f32_16x16x32_bf16 v[64:67],a[104:107],v[232:235],v[64:67]
ds_read_b128 v[184:187],v17 offset:28672
buffer_load_dwordx4 v16,s[20:23],s65 offen offset:0 sc1 lds
v_mfma_f32_16x16x32_bf16 v[68:71],a[216:219],v[232:235],v[68:71]
buffer_load_dwordx4 v16,s[20:23],s65 offen offset:2048 sc1 lds
v_min3_u32 v27,v27,v232,v236
v_mfma_f32_16x16x32_bf16 v[64:67],a[108:111],v[236:239],v[64:67]
ds_read_b128 v[188:191],v17 offset:30720
s_xor_b32 m0,s72,49152
v_min3_u32 v27,v27,v234,v238
v_mfma_f32_16x16x32_bf16 v[68:71],a[220:223],v[236:239],v[68:71]
s_add_u32 s65,s88,s86
v_mfma_f32_16x16x32_bf16 v[72:75],a[112:115],v[128:131],0
buffer_load_dwordx4 v16,s[20:23],s65 offen offset:0 sc1 lds
v_cmp_eq_u32 vcc,0,v27
s_cbranch_vccnz retry_326
v_mfma_f32_16x16x32_bf16 v[76:79],a[116:119],v[132:135],0
buffer_load_dwordx4 v16,s[20:23],s65 offen offset:2048 sc1 lds
v_mfma_f32_16x16x32_bf16 v[72:75],a[120:123],v[136:139],v[72:75]
ds_read_b128 v[192:195],v17 offset:32768
s_xor_b32 m0,s72,1024
v_mfma_f32_16x16x32_bf16 v[76:79],a[124:127],v[140:143],v[76:79]
ds_read_b128 v[196:199],v17 offset:34816
s_add_u32 s65,s89,0
s_waitcnt lgkmcnt(10)
v_mfma_f32_16x16x32_bf16 v[72:75],a[128:131],v[144:147],v[72:75]
ds_read_b128 v[200:203],v17 offset:36864
buffer_load_dwordx4 v16,s[20:23],s65 offen offset:0 sc1 lds
s_waitcnt vmcnt(9)
v_mfma_f32_16x16x32_bf16 v[76:79],a[132:135],v[148:151],v[76:79]
ds_read_b128 v[204:207],v17 offset:38912
buffer_load_dwordx4 v16,s[20:23],s65 offen offset:2048 sc1 lds
v_and_or_b32 v64,v64,-4,s48
v_mfma_f32_16x16x32_bf16 v[72:75],a[136:139],v[152:155],v[72:75]
ds_read_b128 v[208:211],v17 offset:40960
s_xor_b32 m0,s72,17408
s_add_u32 s64,s49,s34
v_mfma_f32_16x16x32_bf16 v[76:79],a[140:143],v[156:159],v[76:79]
s_add_u32 s65,s89,32768
buffer_store_dwordx4 v[64:67],v25,s[20:23],s64 offen offset:2048
s_waitcnt lgkmcnt(9)
v_mfma_f32_16x16x32_bf16 v[72:75],a[144:147],v[160:163],v[72:75]
ds_read_b128 v[212:215],v17 offset:43008
buffer_load_dwordx4 v16,s[20:23],s65 offen offset:0 sc1 lds
v_and_or_b32 v68,v68,-4,s48
v_mfma_f32_16x16x32_bf16 v[76:79],a[148:151],v[164:167],v[76:79]
ds_read_b128 v[216:219],v17 offset:45056
buffer_load_dwordx4 v16,s[20:23],s65 offen offset:2048 sc1 lds
s_add_u32 s64,s49,s35
v_mfma_f32_16x16x32_bf16 v[72:75],a[152:155],v[168:171],v[72:75]
ds_read_b128 v[220:223],v17 offset:47104
s_xor_b32 m0,s72,33792
buffer_store_dwordx4 v[68:71],v25,s[20:23],s64 offen offset:3072
v_mfma_f32_16x16x32_bf16 v[76:79],a[156:159],v[172:175],v[76:79]
ds_read_b128 v[224:227],v17 offset:49152
s_mov_b32 s49,0x7fff0000
s_waitcnt lgkmcnt(9)
v_mfma_f32_16x16x32_bf16 v[72:75],a[160:163],v[176:179],v[72:75]
ds_read_b128 v[228:231],v17 offset:51200
s_add_u32 s65,s89,65536
v_mfma_f32_16x16x32_bf16 v[76:79],a[164:167],v[180:183],v[76:79]
buffer_load_dwordx4 v16,s[20:23],s65 offen offset:0 sc1 lds
v_mfma_f32_16x16x32_bf16 v[72:75],a[168:171],v[184:187],v[72:75]
ds_read_b128 v[232:235],v17 offset:53248
v_min3_u32 v27,v27,v128,v132
v_mfma_f32_16x16x32_bf16 v[76:79],a[172:175],v[188:191],v[76:79]
ds_read_b128 v[236:239],v17 offset:55296
s_waitcnt lgkmcnt(8)
v_mfma_f32_16x16x32_bf16 v[72:75],a[176:179],v[192:195],v[72:75]
buffer_load_dwordx4 v16,s[20:23],s65 offen offset:2048 sc1 lds
v_mfma_f32_16x16x32_bf16 v[76:79],a[180:183],v[196:199],v[76:79]
s_xor_b32 m0,s72,50176
s_add_u32 s65,s89,s86
v_mfma_f32_16x16x32_bf16 v[72:75],a[184:187],v[200:203],v[72:75]
buffer_load_dwordx4 v16,s[20:23],s65 offen offset:0 sc1 lds
v_mfma_f32_16x16x32_bf16 v[76:79],a[188:191],v[204:207],v[76:79]
v_min3_u32 v27,v27,v136,v140
s_waitcnt lgkmcnt(4)
v_mfma_f32_16x16x32_bf16 v[72:75],a[192:195],v[208:211],v[72:75]
buffer_load_dwordx4 v16,s[20:23],s65 offen offset:2048 sc1 lds
v_mfma_f32_16x16x32_bf16 v[76:79],a[196:199],v[212:215],v[76:79]
v_min3_u32 v27,v27,v144,v148
v_min3_u32 v27,v27,v152,v156
v_mfma_f32_16x16x32_bf16 v[72:75],a[200:203],v[216:219],v[72:75]
v_min3_u32 v27,v27,v160,v164
v_min3_u32 v27,v27,v168,v172
v_mfma_f32_16x16x32_bf16 v[76:79],a[204:207],v[220:223],v[76:79]
v_min3_u32 v27,v27,v176,v180
s_waitcnt lgkmcnt(0)
v_mfma_f32_16x16x32_bf16 v[72:75],a[208:211],v[224:227],v[72:75]
v_min3_u32 v27,v27,v184,v188
v_min3_u32 v27,v27,v192,v196
v_mfma_f32_16x16x32_bf16 v[76:79],a[212:215],v[228:231],v[76:79]
v_min3_u32 v27,v27,v200,v204
v_min3_u32 v27,v27,v208,v212
v_mfma_f32_16x16x32_bf16 v[72:75],a[216:219],v[232:235],v[72:75]
v_min3_u32 v27,v27,v216,v220
v_min3_u32 v27,v27,v224,v228
v_mfma_f32_16x16x32_bf16 v[76:79],a[220:223],v[236:239],v[76:79]
v_min3_u32 v27,v27,v226,v230
v_min3_u32 v27,v27,v232,v236
v_min3_u32 v27,v27,v234,v238
v_mfma_f32_16x16x32_bf16 v[80:83],a[0:3],v[128:131],0
v_cmp_eq_u32 vcc,0,v27
s_cbranch_vccnz retry_326
v_mfma_f32_16x16x32_bf16 v[84:87],a[4:7],v[132:135],0
ds_bpermute_b32 v124,v41,v120
ds_bpermute_b32 v125,v41,v121
v_mfma_f32_16x16x32_bf16 v[80:83],a[8:11],v[136:139],v[80:83]
v_lshlrev_b32 v108,16,v122
v_and_b32 v109,s80,v122
v_mfma_f32_16x16x32_bf16 v[84:87],a[12:15],v[140:143],v[84:87]
v_lshlrev_b32 v110,16,v123
v_and_b32 v111,s80,v123
v_mfma_f32_16x16x32_bf16 v[80:83],a[16:19],v[144:147],v[80:83]
s_waitcnt lgkmcnt(0)
v_lshlrev_b32 v104,16,v124
v_mfma_f32_16x16x32_bf16 v[84:87],a[20:23],v[148:151],v[84:87]
v_and_b32 v105,s80,v124
v_add_f32 v72,v72,v76
v_mfma_f32_16x16x32_bf16 v[80:83],a[24:27],v[152:155],v[80:83]
v_add_f32 v73,v73,v77
v_add_f32 v74,v74,v78
v_mfma_f32_16x16x32_bf16 v[84:87],a[28:31],v[156:159],v[84:87]
v_lshlrev_b32 v106,16,v125
v_add_f32 v75,v75,v79
v_mfma_f32_16x16x32_bf16 v[80:83],a[32:35],v[160:163],v[80:83]
v_and_or_b32 v72,v72,-4,s48
s_add_u32 s64,s77,s33
v_mfma_f32_16x16x32_bf16 v[84:87],a[36:39],v[164:167],v[84:87]
v_and_b32 v107,s80,v125
v_mfma_f32_16x16x32_bf16 v[80:83],a[40:43],v[168:171],v[80:83]
buffer_store_dwordx4 v[72:75],v25,s[20:23],s64 offen offset:1024
v_mfma_f32_16x16x32_bf16 v[84:87],a[44:47],v[172:175],v[84:87]
v_mfma_f32_16x16x32_bf16 v[80:83],a[48:51],v[176:179],v[80:83]
buffer_load_dwordx4 v[96:99],v26,s[20:23],s77 offen offset:2048 sc1
v_mfma_f32_16x16x32_bf16 v[84:87],a[52:55],v[180:183],v[84:87]
buffer_load_dwordx4 v[100:103],v26,s[20:23],s77 offen offset:3072 sc1
v_mfma_f32_16x16x32_bf16 v[80:83],a[56:59],v[184:187],v[80:83]
v_mfma_f32_16x16x32_bf16 v[84:87],a[60:63],v[188:191],v[84:87]
v_mfma_f32_16x16x32_bf16 v[80:83],a[64:67],v[192:195],v[80:83]
v_mfma_f32_16x16x32_bf16 v[84:87],a[68:71],v[196:199],v[84:87]
v_mfma_f32_16x16x32_bf16 v[80:83],a[72:75],v[200:203],v[80:83]
v_mfma_f32_16x16x32_bf16 v[84:87],a[76:79],v[204:207],v[84:87]
v_mfma_f32_16x16x32_bf16 v[80:83],a[80:83],v[208:211],v[80:83]
v_mfma_f32_16x16x32_bf16 v[84:87],a[84:87],v[212:215],v[84:87]
v_mfma_f32_16x16x32_bf16 v[80:83],a[88:91],v[216:219],v[80:83]
buffer_load_dwordx4 v[92:95],v26,s[20:23],s77 offen offset:1024 sc1
v_mfma_f32_16x16x32_bf16 v[84:87],a[92:95],v[220:223],v[84:87]
v_mfma_f32_16x16x32_bf16 v[80:83],a[96:99],v[224:227],v[80:83]
v_mfma_f32_16x16x32_bf16 v[84:87],a[100:103],v[228:231],v[84:87]
v_mfma_f32_16x16x32_bf16 v[80:83],a[104:107],v[232:235],v[80:83]
v_mfma_f32_16x16x32_bf16 v[84:87],a[108:111],v[236:239],v[84:87]
s_branch epi_329
keep_338:
v_mfma_f32_16x16x32_bf16 v[68:71],a[196:199],v[244:247],v[68:71]
s_waitcnt lgkmcnt(10)
v_mfma_f32_16x16x32_bf16 v[64:67],a[88:91],v[248:251],v[64:67]
ds_read_b128 v[160:163],v17 offset:16384
ds_read_b128 v[164:167],v17 offset:18432
v_mfma_f32_16x16x32_bf16 v[68:71],a[200:203],v[248:251],v[68:71]
v_min3_u32 v27,v27,v248,v252
v_mfma_f32_16x16x32_bf16 v[64:67],a[92:95],v[252:255],v[64:67]
ds_read_b128 v[168:171],v17 offset:20480
v_mfma_f32_16x16x32_bf16 v[68:71],a[204:207],v[252:255],v[68:71]
s_waitcnt lgkmcnt(9)
v_mfma_f32_16x16x32_bf16 v[64:67],a[96:99],v[224:227],v[64:67]
ds_read_b128 v[172:175],v17 offset:22528
v_min3_u32 v27,v27,v224,v228
v_mfma_f32_16x16x32_bf16 v[68:71],a[208:211],v[224:227],v[68:71]
v_min3_u32 v27,v27,v226,v230
v_mfma_f32_16x16x32_bf16 v[64:67],a[100:103],v[228:231],v[64:67]
ds_read_b128 v[176:179],v17 offset:24576
ds_read_b128 v[180:183],v17 offset:26624
v_mfma_f32_16x16x32_bf16 v[68:71],a[212:215],v[228:231],v[68:71]
s_waitcnt lgkmcnt(7)
v_mfma_f32_16x16x32_bf16 v[64:67],a[104:107],v[232:235],v[64:67]
ds_read_b128 v[184:187],v17 offset:28672
v_min3_u32 v27,v27,v232,v236
v_mfma_f32_16x16x32_bf16 v[68:71],a[216:219],v[232:235],v[68:71]
v_min3_u32 v27,v27,v234,v238
v_mfma_f32_16x16x32_bf16 v[64:67],a[108:111],v[236:239],v[64:67]
ds_read_b128 v[188:191],v17 offset:30720
v_mfma_f32_16x16x32_bf16 v[68:71],a[220:223],v[236:239],v[68:71]
v_mfma_f32_16x16x32_bf16 v[72:75],a[112:115],v[128:131],0
v_cmp_eq_u32 vcc,0,v27
s_cbranch_vccnz retry_326
v_mfma_f32_16x16x32_bf16 v[76:79],a[116:119],v[132:135],0
v_min3_u32 v27,v27,v128,v132
v_mfma_f32_16x16x32_bf16 v[72:75],a[120:123],v[136:139],v[72:75]
ds_read_b128 v[192:195],v17 offset:32768
v_mfma_f32_16x16x32_bf16 v[76:79],a[124:127],v[140:143],v[76:79]
ds_read_b128 v[196:199],v17 offset:34816
s_waitcnt lgkmcnt(10)
v_mfma_f32_16x16x32_bf16 v[72:75],a[128:131],v[144:147],v[72:75]
ds_read_b128 v[200:203],v17 offset:36864
v_min3_u32 v27,v27,v136,v140
s_waitcnt vmcnt(0)
v_mfma_f32_16x16x32_bf16 v[76:79],a[132:135],v[148:151],v[76:79]
ds_read_b128 v[204:207],v17 offset:38912
v_min3_u32 v27,v27,v144,v148
v_and_or_b32 v64,v64,-4,s48
v_mfma_f32_16x16x32_bf16 v[72:75],a[136:139],v[152:155],v[72:75]
ds_read_b128 v[208:211],v17 offset:40960
s_add_u32 s64,s49,s34
v_mfma_f32_16x16x32_bf16 v[76:79],a[140:143],v[156:159],v[76:79]
v_min3_u32 v27,v27,v152,v156
s_waitcnt lgkmcnt(9)
v_mfma_f32_16x16x32_bf16 v[72:75],a[144:147],v[160:163],v[72:75]
ds_read_b128 v[212:215],v17 offset:43008
buffer_store_dwordx4 v[64:67],v25,s[20:23],s64 offen offset:2048
v_mfma_f32_16x16x32_bf16 v[76:79],a[148:151],v[164:167],v[76:79]
ds_read_b128 v[216:219],v17 offset:45056
v_min3_u32 v27,v27,v160,v164
v_and_or_b32 v68,v68,-4,s48
v_mfma_f32_16x16x32_bf16 v[72:75],a[152:155],v[168:171],v[72:75]
ds_read_b128 v[220:223],v17 offset:47104
s_add_u32 s64,s49,s35
v_mfma_f32_16x16x32_bf16 v[76:79],a[156:159],v[172:175],v[76:79]
ds_read_b128 v[224:227],v17 offset:49152
s_waitcnt lgkmcnt(9)
v_mfma_f32_16x16x32_bf16 v[72:75],a[160:163],v[176:179],v[72:75]
ds_read_b128 v[228:231],v17 offset:51200
v_min3_u32 v27,v27,v168,v172
v_mfma_f32_16x16x32_bf16 v[76:79],a[164:167],v[180:183],v[76:79]
v_min3_u32 v27,v27,v176,v180
buffer_store_dwordx4 v[68:71],v25,s[20:23],s64 offen offset:3072
v_mfma_f32_16x16x32_bf16 v[72:75],a[168:171],v[184:187],v[72:75]
ds_read_b128 v[232:235],v17 offset:53248
s_mov_b32 s49,0x7fff0000
v_mfma_f32_16x16x32_bf16 v[76:79],a[172:175],v[188:191],v[76:79]
ds_read_b128 v[236:239],v17 offset:55296
s_waitcnt lgkmcnt(8)
v_mfma_f32_16x16x32_bf16 v[72:75],a[176:179],v[192:195],v[72:75]
v_min3_u32 v27,v27,v184,v188
v_mfma_f32_16x16x32_bf16 v[76:79],a[180:183],v[196:199],v[76:79]
v_min3_u32 v27,v27,v192,v196
ds_bpermute_b32 v124,v41,v120
v_mfma_f32_16x16x32_bf16 v[72:75],a[184:187],v[200:203],v[72:75]
v_mfma_f32_16x16x32_bf16 v[76:79],a[188:191],v[204:207],v[76:79]
v_min3_u32 v27,v27,v200,v204
s_waitcnt lgkmcnt(5)
v_mfma_f32_16x16x32_bf16 v[72:75],a[192:195],v[208:211],v[72:75]
ds_bpermute_b32 v125,v41,v121
v_mfma_f32_16x16x32_bf16 v[76:79],a[196:199],v[212:215],v[76:79]
v_min3_u32 v27,v27,v208,v212
v_lshlrev_b32 v108,16,v122
v_mfma_f32_16x16x32_bf16 v[72:75],a[200:203],v[216:219],v[72:75]
v_mfma_f32_16x16x32_bf16 v[76:79],a[204:207],v[220:223],v[76:79]
v_min3_u32 v27,v27,v216,v220
s_waitcnt lgkmcnt(2)
v_mfma_f32_16x16x32_bf16 v[72:75],a[208:211],v[224:227],v[72:75]
v_and_b32 v109,s80,v122
v_mfma_f32_16x16x32_bf16 v[76:79],a[212:215],v[228:231],v[76:79]
v_min3_u32 v27,v27,v224,v228
v_min3_u32 v27,v27,v226,v230
v_mfma_f32_16x16x32_bf16 v[72:75],a[216:219],v[232:235],v[72:75]
v_lshlrev_b32 v110,16,v123
v_mfma_f32_16x16x32_bf16 v[76:79],a[220:223],v[236:239],v[76:79]
v_min3_u32 v27,v27,v232,v236
v_min3_u32 v27,v27,v234,v238
v_mfma_f32_16x16x32_bf16 v[80:83],a[0:3],v[128:131],0
v_cmp_eq_u32 vcc,0,v27
s_cbranch_vccnz retry_326
v_mfma_f32_16x16x32_bf16 v[84:87],a[4:7],v[132:135],0
v_and_b32 v111,s80,v123
s_waitcnt lgkmcnt(0)
v_mfma_f32_16x16x32_bf16 v[80:83],a[8:11],v[136:139],v[80:83]
v_mfma_f32_16x16x32_bf16 v[84:87],a[12:15],v[140:143],v[84:87]
v_lshlrev_b32 v104,16,v124
v_mfma_f32_16x16x32_bf16 v[80:83],a[16:19],v[144:147],v[80:83]
v_add_f32 v72,v72,v76
v_add_f32 v73,v73,v77
v_mfma_f32_16x16x32_bf16 v[84:87],a[20:23],v[148:151],v[84:87]
v_and_b32 v105,s80,v124
v_add_f32 v74,v74,v78
v_mfma_f32_16x16x32_bf16 v[80:83],a[24:27],v[152:155],v[80:83]
v_add_f32 v75,v75,v79
v_and_or_b32 v72,v72,-4,s48
v_mfma_f32_16x16x32_bf16 v[84:87],a[28:31],v[156:159],v[84:87]
v_lshlrev_b32 v106,16,v125
s_add_u32 s64,s77,s33
v_mfma_f32_16x16x32_bf16 v[80:83],a[32:35],v[160:163],v[80:83]
buffer_store_dwordx4 v[72:75],v25,s[20:23],s64 offen offset:1024
v_mfma_f32_16x16x32_bf16 v[84:87],a[36:39],v[164:167],v[84:87]
v_and_b32 v107,s80,v125
v_mfma_f32_16x16x32_bf16 v[80:83],a[40:43],v[168:171],v[80:83]
v_mfma_f32_16x16x32_bf16 v[84:87],a[44:47],v[172:175],v[84:87]
v_mfma_f32_16x16x32_bf16 v[80:83],a[48:51],v[176:179],v[80:83]
buffer_load_dwordx4 v[96:99],v26,s[20:23],s77 offen offset:2048 sc1
v_mfma_f32_16x16x32_bf16 v[84:87],a[52:55],v[180:183],v[84:87]
buffer_load_dwordx4 v[100:103],v26,s[20:23],s77 offen offset:3072 sc1
v_mfma_f32_16x16x32_bf16 v[80:83],a[56:59],v[184:187],v[80:83]
v_mfma_f32_16x16x32_bf16 v[84:87],a[60:63],v[188:191],v[84:87]
v_mfma_f32_16x16x32_bf16 v[80:83],a[64:67],v[192:195],v[80:83]
v_mfma_f32_16x16x32_bf16 v[84:87],a[68:71],v[196:199],v[84:87]
v_mfma_f32_16x16x32_bf16 v[80:83],a[72:75],v[200:203],v[80:83]
v_mfma_f32_16x16x32_bf16 v[84:87],a[76:79],v[204:207],v[84:87]
v_mfma_f32_16x16x32_bf16 v[80:83],a[80:83],v[208:211],v[80:83]
v_mfma_f32_16x16x32_bf16 v[84:87],a[84:87],v[212:215],v[84:87]
v_mfma_f32_16x16x32_bf16 v[80:83],a[88:91],v[216:219],v[80:83]
buffer_load_dwordx4 v[92:95],v26,s[20:23],s77 offen offset:1024 sc1
v_mfma_f32_16x16x32_bf16 v[84:87],a[92:95],v[220:223],v[84:87]
v_mfma_f32_16x16x32_bf16 v[80:83],a[96:99],v[224:227],v[80:83]
v_mfma_f32_16x16x32_bf16 v[84:87],a[100:103],v[228:231],v[84:87]
v_mfma_f32_16x16x32_bf16 v[80:83],a[104:107],v[232:235],v[80:83]
v_mfma_f32_16x16x32_bf16 v[84:87],a[108:111],v[236:239],v[84:87]
s_branch epi_329
both_330:
s_waitcnt vmcnt(14) lgkmcnt(0)
s_barrier
ds_read_b128 v[224:227],v18 offset:0
ds_read_b128 v[228:231],v18 offset:2048
ds_read_b128 v[232:235],v18 offset:4096
ds_read_b128 v[236:239],v18 offset:6144
ds_read_b128 v[240:243],v18 offset:8192
ds_read_b128 v[244:247],v18 offset:10240
ds_read_b128 v[248:251],v18 offset:12288
s_waitcnt lgkmcnt(5)
v_mfma_f32_16x16x32_bf16 v[64:67],a[0:3],v[224:227],0
s_add_u32 s96,s71,1
s_add_u32 s92,s71,2
s_add_u32 s88,s70,s75
v_mfma_f32_16x16x32_bf16 v[68:71],a[112:115],v[224:227],0
ds_read_b128 v[252:255],v18 offset:14336
s_add_u32 s88,s88,2097152
s_xor_b32 s88,s88,0x2000
v_mfma_f32_16x16x32_bf16 v[64:67],a[4:7],v[228:231],v[64:67]
s_cmp_eq_u32 s96,64
s_cselect_b32 s96,99,s96
v_min_u32 v27,v224,v228
v_mfma_f32_16x16x32_bf16 v[68:71],a[116:119],v[228:231],v[68:71]
ds_read_b128 v[224:227],v18 offset:16384
s_waitcnt lgkmcnt(5)
v_mfma_f32_16x16x32_bf16 v[64:67],a[8:11],v[232:235],v[64:67]
s_cmp_eq_u32 s92,64
s_cselect_b32 s92,99,s92
v_mfma_f32_16x16x32_bf16 v[68:71],a[120:123],v[232:235],v[68:71]
ds_read_b128 v[228:231],v18 offset:18432
s_xor_b32 s89,s88,1024
v_mfma_f32_16x16x32_bf16 v[64:67],a[12:15],v[236:239],v[64:67]
s_xor_b32 m0,s72,0
v_min3_u32 v27,v27,v232,v236
v_mfma_f32_16x16x32_bf16 v[68:71],a[124:127],v[236:239],v[68:71]
ds_read_b128 v[232:235],v18 offset:20480
s_add_u32 s65,s88,0
s_waitcnt lgkmcnt(5)
v_mfma_f32_16x16x32_bf16 v[64:67],a[16:19],v[240:243],v[64:67]
v_min3_u32 v27,v27,v240,v244
buffer_load_dwordx2 v[120:121],v20,s[20:23],s76 offen sc1
v_mfma_f32_16x16x32_bf16 v[68:71],a[128:131],v[240:243],v[68:71]
ds_read_b128 v[236:239],v18 offset:22528
buffer_load_dwordx4 v16,s[20:23],s65 offen offset:0 sc1 lds
v_mfma_f32_16x16x32_bf16 v[64:67],a[20:23],v[244:247],v[64:67]
s_waitcnt vmcnt(3)
v_mfma_f32_16x16x32_bf16 v[68:71],a[132:135],v[244:247],v[68:71]
ds_read_b128 v[240:243],v18 offset:24576
s_waitcnt lgkmcnt(5)
v_mfma_f32_16x16x32_bf16 v[64:67],a[24:27],v[248:251],v[64:67]
v_cmp_gt_u32 vcc,s96,v29
v_cmp_gt_u32 s[92:93],s92,v29
v_min3_u32 v27,v27,v248,v252
v_mfma_f32_16x16x32_bf16 v[68:71],a[136:139],v[248:251],v[68:71]
ds_read_b128 v[244:247],v18 offset:26624
buffer_load_dwordx4 v16,s[20:23],s65 offen offset:2048 sc1 lds
v_mfma_f32_16x16x32_bf16 v[64:67],a[28:31],v[252:255],v[64:67]
v_mov_b32 v44,vcc_lo
v_mov_b32 v45,s92
s_xor_b32 m0,s72,16384
v_mfma_f32_16x16x32_bf16 v[68:71],a[140:143],v[252:255],v[68:71]
ds_read_b128 v[248:251],v18 offset:28672
s_add_u32 s65,s88,32768
s_waitcnt lgkmcnt(5)
v_mfma_f32_16x16x32_bf16 v[64:67],a[32:35],v[224:227],v[64:67]
ds_write_b64 v46,v[44:45]
v_min3_u32 v27,v27,v224,v228
v_mfma_f32_16x16x32_bf16 v[68:71],a[144:147],v[224:227],v[68:71]
ds_read_b128 v[252:255],v18 offset:30720
buffer_load_dwordx4 v16,s[20:23],s65 offen offset:0 sc1 lds
v_mfma_f32_16x16x32_bf16 v[64:67],a[36:39],v[228:231],v[64:67]
buffer_load_dwordx4 v16,s[20:23],s65 offen offset:2048 sc1 lds
v_mfma_f32_16x16x32_bf16 v[68:71],a[148:151],v[228:231],v[68:71]
ds_read_b128 v[224:227],v18 offset:32768
s_waitcnt lgkmcnt(6)
v_mfma_f32_16x16x32_bf16 v[64:67],a[40:43],v[232:235],v[64:67]
s_xor_b32 m0,s72,32768
v_min3_u32 v27,v27,v232,v236
v_mfma_f32_16x16x32_bf16 v[68:71],a[152:155],v[232:235],v[68:71]
ds_read_b128 v[228:231],v18 offset:34816
v_mfma_f32_16x16x32_bf16 v[64:67],a[44:47],v[236:239],v[64:67]
s_add_u32 s65,s88,65536
v_mfma_f32_16x16x32_bf16 v[68:71],a[156:159],v[236:239],v[68:71]
ds_read_b128 v[232:235],v18 offset:36864
s_waitcnt lgkmcnt(6)
v_mfma_f32_16x16x32_bf16 v[64:67],a[48:51],v[240:243],v[64:67]
buffer_load_dwordx4 v16,s[20:23],s65 offen offset:0 sc1 lds
v_mfma_f32_16x16x32_bf16 v[68:71],a[160:163],v[240:243],v[68:71]
ds_read_b128 v[236:239],v18 offset:38912
v_min3_u32 v27,v27,v240,v244
v_mfma_f32_16x16x32_bf16 v[64:67],a[52:55],v[244:247],v[64:67]
buffer_load_dwordx4 v16,s[20:23],s65 offen offset:2048 sc1 lds
v_mfma_f32_16x16x32_bf16 v[68:71],a[164:167],v[244:247],v[68:71]
ds_read_b128 v[240:243],v18 offset:40960
s_waitcnt lgkmcnt(5)
v_mfma_f32_16x16x32_bf16 v[64:67],a[56:59],v[248:251],v[64:67]
s_xor_b32 m0,s72,49152
v_min3_u32 v27,v27,v248,v252
v_mfma_f32_16x16x32_bf16 v[68:71],a[168:171],v[248:251],v[68:71]
ds_read_b128 v[244:247],v18 offset:43008
s_add_u32 s65,s88,s86
v_mfma_f32_16x16x32_bf16 v[64:67],a[60:63],v[252:255],v[64:67]
buffer_load_dwordx2 v[122:123],v24,s[20:23],s70 offen sc1
v_mfma_f32_16x16x32_bf16 v[68:71],a[172:175],v[252:255],v[68:71]
ds_read_b128 v[248:251],v18 offset:45056
s_waitcnt lgkmcnt(5)
v_mfma_f32_16x16x32_bf16 v[64:67],a[64:67],v[224:227],v[64:67]
s_waitcnt vmcnt(14)
s_barrier
ds_read_b64 v[44:45],v47
ds_read_b128 v[128:131],v17 offset:0
ds_read_b128 v[132:135],v17 offset:2048
v_mfma_f32_16x16x32_bf16 v[68:71],a[176:179],v[224:227],v[68:71]
ds_read_b128 v[252:255],v18 offset:47104
buffer_load_dwordx4 v16,s[20:23],s65 offen offset:0 sc1 lds
v_min3_u32 v27,v27,v224,v228
v_mfma_f32_16x16x32_bf16 v[64:67],a[68:71],v[228:231],v[64:67]
ds_read_b128 v[136:139],v17 offset:4096
buffer_load_dwordx4 v16,s[20:23],s65 offen offset:2048 sc1 lds
v_mfma_f32_16x16x32_bf16 v[68:71],a[180:183],v[228:231],v[68:71]
ds_read_b128 v[224:227],v18 offset:49152
s_xor_b32 m0,s72,1024
s_waitcnt lgkmcnt(9)
v_mfma_f32_16x16x32_bf16 v[64:67],a[72:75],v[232:235],v[64:67]
ds_read_b128 v[140:143],v17 offset:6144
v_min3_u32 v27,v27,v232,v236
v_mfma_f32_16x16x32_bf16 v[68:71],a[184:187],v[232:235],v[68:71]
ds_read_b128 v[228:231],v18 offset:51200
s_add_u32 s65,s89,0
v_mfma_f32_16x16x32_bf16 v[64:67],a[76:79],v[236:239],v[64:67]
ds_read_b128 v[144:147],v17 offset:8192
ds_read_b128 v[148:151],v17 offset:10240
v_mfma_f32_16x16x32_bf16 v[68:71],a[188:191],v[236:239],v[68:71]
ds_read_b128 v[232:235],v18 offset:53248
s_waitcnt lgkmcnt(12)
v_mfma_f32_16x16x32_bf16 v[64:67],a[80:83],v[240:243],v[64:67]
ds_read_b128 v[152:155],v17 offset:12288
s_waitcnt lgkmcnt(11)
v_min3_u32 v27,v27,v240,v244
v_mfma_f32_16x16x32_bf16 v[68:71],a[192:195],v[240:243],v[68:71]
ds_read_b128 v[236:239],v18 offset:55296
v_readfirstlane_b32 s93,v45
v_mfma_f32_16x16x32_bf16 v[64:67],a[84:87],v[244:247],v[64:67]
ds_read_b128 v[156:159],v17 offset:14336
buffer_load_dwordx4 v16,s[20:23],s65 offen offset:0 sc1 lds
v_mfma_f32_16x16x32_bf16 v[68:71],a[196:199],v[244:247],v[68:71]
buffer_load_dwordx4 v16,s[20:23],s65 offen offset:2048 sc1 lds
s_waitcnt lgkmcnt(10)
v_mfma_f32_16x16x32_bf16 v[64:67],a[88:91],v[248:251],v[64:67]
ds_read_b128 v[160:163],v17 offset:16384
ds_read_b128 v[164:167],v17 offset:18432
s_xor_b32 m0,s72,17408
v_mfma_f32_16x16x32_bf16 v[68:71],a[200:203],v[248:251],v[68:71]
s_add_u32 s65,s89,32768
v_min3_u32 v27,v27,v248,v252
v_mfma_f32_16x16x32_bf16 v[64:67],a[92:95],v[252:255],v[64:67]
ds_read_b128 v[168:171],v17 offset:20480
buffer_load_dwordx4 v16,s[20:23],s65 offen offset:0 sc1 lds
v_mfma_f32_16x16x32_bf16 v[68:71],a[204:207],v[252:255],v[68:71]
s_waitcnt lgkmcnt(9)
v_mfma_f32_16x16x32_bf16 v[64:67],a[96:99],v[224:227],v[64:67]
ds_read_b128 v[172:175],v17 offset:22528
buffer_load_dwordx4 v16,s[20:23],s65 offen offset:2048 sc1 lds
v_mfma_f32_16x16x32_bf16 v[68:71],a[208:211],v[224:227],v[68:71]
v_min3_u32 v27,v27,v224,v228
v_min3_u32 v27,v27,v226,v230
v_mfma_f32_16x16x32_bf16 v[64:67],a[100:103],v[228:231],v[64:67]
ds_read_b128 v[176:179],v17 offset:24576
ds_read_b128 v[180:183],v17 offset:26624
s_xor_b32 m0,s72,33792
v_mfma_f32_16x16x32_bf16 v[68:71],a[212:215],v[228:231],v[68:71]
s_waitcnt lgkmcnt(7)
v_mfma_f32_16x16x32_bf16 v[64:67],a[104:107],v[232:235],v[64:67]
ds_read_b128 v[184:187],v17 offset:28672
s_add_u32 s65,s89,65536
v_min3_u32 v27,v27,v232,v236
v_mfma_f32_16x16x32_bf16 v[68:71],a[216:219],v[232:235],v[68:71]
buffer_load_dwordx4 v16,s[20:23],s65 offen offset:0 sc1 lds
v_mfma_f32_16x16x32_bf16 v[64:67],a[108:111],v[236:239],v[64:67]
ds_read_b128 v[188:191],v17 offset:30720
v_min3_u32 v27,v27,v234,v238
v_mfma_f32_16x16x32_bf16 v[68:71],a[220:223],v[236:239],v[68:71]
buffer_load_dwordx4 v16,s[20:23],s65 offen offset:2048 sc1 lds
v_mfma_f32_16x16x32_bf16 v[72:75],a[112:115],v[128:131],0
v_cmp_eq_u32 vcc,0,v27
s_cbranch_vccnz retry_326
v_mfma_f32_16x16x32_bf16 v[76:79],a[116:119],v[132:135],0
s_xor_b32 m0,s72,50176
v_min3_u32 v27,v27,v128,v132
v_mfma_f32_16x16x32_bf16 v[72:75],a[120:123],v[136:139],v[72:75]
ds_read_b128 v[192:195],v17 offset:32768
v_mfma_f32_16x16x32_bf16 v[76:79],a[124:127],v[140:143],v[76:79]
ds_read_b128 v[196:199],v17 offset:34816
s_add_u32 s65,s89,s86
s_waitcnt lgkmcnt(10)
v_mfma_f32_16x16x32_bf16 v[72:75],a[128:131],v[144:147],v[72:75]
ds_read_b128 v[200:203],v17 offset:36864
v_min3_u32 v27,v27,v136,v140
s_waitcnt vmcnt(8)
v_mfma_f32_16x16x32_bf16 v[76:79],a[132:135],v[148:151],v[76:79]
ds_read_b128 v[204:207],v17 offset:38912
buffer_load_dwordx4 v16,s[20:23],s65 offen offset:0 sc1 lds
v_mfma_f32_16x16x32_bf16 v[72:75],a[136:139],v[152:155],v[72:75]
ds_read_b128 v[208:211],v17 offset:40960
v_min3_u32 v27,v27,v144,v148
v_and_or_b32 v64,v64,-4,s48
v_mfma_f32_16x16x32_bf16 v[76:79],a[140:143],v[156:159],v[76:79]
buffer_load_dwordx4 v16,s[20:23],s65 offen offset:2048 sc1 lds
s_waitcnt lgkmcnt(9)
v_mfma_f32_16x16x32_bf16 v[72:75],a[144:147],v[160:163],v[72:75]
ds_read_b128 v[212:215],v17 offset:43008
v_min3_u32 v27,v27,v152,v156
s_add_u32 s64,s49,s34
v_mfma_f32_16x16x32_bf16 v[76:79],a[148:151],v[164:167],v[76:79]
ds_read_b128 v[216:219],v17 offset:45056
v_min3_u32 v27,v27,v160,v164
v_mfma_f32_16x16x32_bf16 v[72:75],a[152:155],v[168:171],v[72:75]
ds_read_b128 v[220:223],v17 offset:47104
buffer_store_dwordx4 v[64:67],v25,s[20:23],s64 offen offset:2048
v_mfma_f32_16x16x32_bf16 v[76:79],a[156:159],v[172:175],v[76:79]
ds_read_b128 v[224:227],v17 offset:49152
v_and_or_b32 v68,v68,-4,s48
s_waitcnt lgkmcnt(9)
v_mfma_f32_16x16x32_bf16 v[72:75],a[160:163],v[176:179],v[72:75]
ds_read_b128 v[228:231],v17 offset:51200
v_min3_u32 v27,v27,v168,v172
s_add_u32 s64,s49,s35
v_mfma_f32_16x16x32_bf16 v[76:79],a[164:167],v[180:183],v[76:79]
v_min3_u32 v27,v27,v176,v180
buffer_store_dwordx4 v[68:71],v25,s[20:23],s64 offen offset:3072
v_mfma_f32_16x16x32_bf16 v[72:75],a[168:171],v[184:187],v[72:75]
ds_read_b128 v[232:235],v17 offset:53248
s_mov_b32 s49,0x7fff0000
v_mfma_f32_16x16x32_bf16 v[76:79],a[172:175],v[188:191],v[76:79]
ds_read_b128 v[236:239],v17 offset:55296
s_waitcnt lgkmcnt(8)
v_mfma_f32_16x16x32_bf16 v[72:75],a[176:179],v[192:195],v[72:75]
v_min3_u32 v27,v27,v184,v188
v_mfma_f32_16x16x32_bf16 v[76:79],a[180:183],v[196:199],v[76:79]
v_min3_u32 v27,v27,v192,v196
ds_bpermute_b32 v124,v41,v120
v_mfma_f32_16x16x32_bf16 v[72:75],a[184:187],v[200:203],v[72:75]
v_mfma_f32_16x16x32_bf16 v[76:79],a[188:191],v[204:207],v[76:79]
v_min3_u32 v27,v27,v200,v204
s_waitcnt lgkmcnt(5)
v_mfma_f32_16x16x32_bf16 v[72:75],a[192:195],v[208:211],v[72:75]
ds_bpermute_b32 v125,v41,v121
v_mfma_f32_16x16x32_bf16 v[76:79],a[196:199],v[212:215],v[76:79]
v_min3_u32 v27,v27,v208,v212
v_lshlrev_b32 v108,16,v122
v_mfma_f32_16x16x32_bf16 v[72:75],a[200:203],v[216:219],v[72:75]
v_mfma_f32_16x16x32_bf16 v[76:79],a[204:207],v[220:223],v[76:79]
v_min3_u32 v27,v27,v216,v220
s_waitcnt lgkmcnt(2)
v_mfma_f32_16x16x32_bf16 v[72:75],a[208:211],v[224:227],v[72:75]
v_and_b32 v109,s80,v122
v_mfma_f32_16x16x32_bf16 v[76:79],a[212:215],v[228:231],v[76:79]
v_min3_u32 v27,v27,v224,v228
v_min3_u32 v27,v27,v226,v230
v_mfma_f32_16x16x32_bf16 v[72:75],a[216:219],v[232:235],v[72:75]
v_lshlrev_b32 v110,16,v123
v_mfma_f32_16x16x32_bf16 v[76:79],a[220:223],v[236:239],v[76:79]
v_min3_u32 v27,v27,v232,v236
v_min3_u32 v27,v27,v234,v238
v_mfma_f32_16x16x32_bf16 v[80:83],a[0:3],v[128:131],0
v_cmp_eq_u32 vcc,0,v27
s_cbranch_vccnz retry_326
v_mfma_f32_16x16x32_bf16 v[84:87],a[4:7],v[132:135],0
v_and_b32 v111,s80,v123
s_waitcnt lgkmcnt(0)
v_mfma_f32_16x16x32_bf16 v[80:83],a[8:11],v[136:139],v[80:83]
v_mfma_f32_16x16x32_bf16 v[84:87],a[12:15],v[140:143],v[84:87]
v_lshlrev_b32 v104,16,v124
v_mfma_f32_16x16x32_bf16 v[80:83],a[16:19],v[144:147],v[80:83]
v_add_f32 v72,v72,v76
v_add_f32 v73,v73,v77
v_mfma_f32_16x16x32_bf16 v[84:87],a[20:23],v[148:151],v[84:87]
v_and_b32 v105,s80,v124
v_add_f32 v74,v74,v78
v_mfma_f32_16x16x32_bf16 v[80:83],a[24:27],v[152:155],v[80:83]
v_add_f32 v75,v75,v79
v_and_or_b32 v72,v72,-4,s48
v_mfma_f32_16x16x32_bf16 v[84:87],a[28:31],v[156:159],v[84:87]
v_lshlrev_b32 v106,16,v125
s_add_u32 s64,s77,s33
v_mfma_f32_16x16x32_bf16 v[80:83],a[32:35],v[160:163],v[80:83]
buffer_store_dwordx4 v[72:75],v25,s[20:23],s64 offen offset:1024
v_mfma_f32_16x16x32_bf16 v[84:87],a[36:39],v[164:167],v[84:87]
v_and_b32 v107,s80,v125
v_mfma_f32_16x16x32_bf16 v[80:83],a[40:43],v[168:171],v[80:83]
v_mfma_f32_16x16x32_bf16 v[84:87],a[44:47],v[172:175],v[84:87]
v_mfma_f32_16x16x32_bf16 v[80:83],a[48:51],v[176:179],v[80:83]
buffer_load_dwordx4 v[96:99],v26,s[20:23],s77 offen offset:2048 sc1
v_mfma_f32_16x16x32_bf16 v[84:87],a[52:55],v[180:183],v[84:87]
buffer_load_dwordx4 v[100:103],v26,s[20:23],s77 offen offset:3072 sc1
v_mfma_f32_16x16x32_bf16 v[80:83],a[56:59],v[184:187],v[80:83]
v_mfma_f32_16x16x32_bf16 v[84:87],a[60:63],v[188:191],v[84:87]
v_mfma_f32_16x16x32_bf16 v[80:83],a[64:67],v[192:195],v[80:83]
v_mfma_f32_16x16x32_bf16 v[84:87],a[68:71],v[196:199],v[84:87]
v_mfma_f32_16x16x32_bf16 v[80:83],a[72:75],v[200:203],v[80:83]
v_mfma_f32_16x16x32_bf16 v[84:87],a[76:79],v[204:207],v[84:87]
v_mfma_f32_16x16x32_bf16 v[80:83],a[80:83],v[208:211],v[80:83]
v_mfma_f32_16x16x32_bf16 v[84:87],a[84:87],v[212:215],v[84:87]
v_mfma_f32_16x16x32_bf16 v[80:83],a[88:91],v[216:219],v[80:83]
buffer_load_dwordx4 v[92:95],v26,s[20:23],s77 offen offset:1024 sc1
v_mfma_f32_16x16x32_bf16 v[84:87],a[92:95],v[220:223],v[84:87]
v_mfma_f32_16x16x32_bf16 v[80:83],a[96:99],v[224:227],v[80:83]
v_mfma_f32_16x16x32_bf16 v[84:87],a[100:103],v[228:231],v[84:87]
v_mfma_f32_16x16x32_bf16 v[80:83],a[104:107],v[232:235],v[80:83]
v_mfma_f32_16x16x32_bf16 v[84:87],a[108:111],v[236:239],v[84:87]
epi_329:
buffer_load_dword v29,v21,s[20:23],s87 offen sc1
s_nop 6
v_pk_add_f32 v[88:89],v[80:81],v[84:85]
v_pk_add_f32 v[90:91],v[82:83],v[86:87]
v_pk_add_f32 v[88:89],v[88:89],v[108:109]
v_pk_add_f32 v[90:91],v[90:91],v[110:111]
s_waitcnt vmcnt(1)
s_branch ic_341
ip_339:
buffer_load_dwordx4 v[92:95],v26,s[20:23],s77 offen offset:1024 sc1
buffer_load_dwordx4 v[96:99],v26,s[20:23],s77 offen offset:2048 sc1
buffer_load_dwordx4 v[100:103],v26,s[20:23],s77 offen offset:3072 sc1
s_waitcnt vmcnt(0)
ic_341:
v_bitop3_b32 v22,v92,v96,v100 bitop3:0x80
v_and_b32 v22,s48,v22
v_cmp_eq_u32 vcc,0,v22
s_cbranch_vccz ik_340
s_sub_u32 s90,s90,1
s_cmp_gt_i32 s90,0
s_cbranch_scc1 ip_339
ik_340:
s_cmp_lg_u32 s71,65
s_cbranch_scc1 nl_342
buffer_load_dwordx4 v[132:135],v26,s[20:23],s40 offen offset:1024 sc1
buffer_load_dwordx4 v[136:139],v26,s[20:23],s40 offen offset:2048 sc1
buffer_load_dwordx4 v[140:143],v26,s[20:23],s40 offen offset:3072 sc1
nl_342:
v_pk_add_f32 v[88:89],v[88:89],v[92:93]
v_pk_add_f32 v[96:97],v[96:97],v[100:101]
v_pk_add_f32 v[90:91],v[90:91],v[94:95]
v_pk_add_f32 v[98:99],v[98:99],v[102:103]
v_pk_add_f32 v[88:89],v[88:89],v[96:97]
v_pk_add_f32 v[90:91],v[90:91],v[98:99]
v_pk_fma_f32 v[88:89],v[88:89],v[52:53],v[104:105]
v_pk_fma_f32 v[90:91],v[90:91],v[54:55],v[106:107]
v_cvt_pk_bf16_f32 v88,v88,v89
v_cvt_pk_bf16_f32 v89,v90,v91
ds_bpermute_b32 v88,v40,v88
ds_bpermute_b32 v89,v40,v89
v_xor_b32 v18,0x10000,v18
s_xor_b32 s49,s77,524288
s_cselect_b32 s64,0,3
s_xor_b32 s48,s48,s64
s_cmp_eq_u32 s71,63
s_cselect_b32 s64,0,0x2000
s_cselect_b32 s66,2,1
s_cmp_eq_u32 s71,64
s_cselect_b32 s66,-1,s66
v_xor_b32 v20,s64,v20
s_lshl_b32 s64,s66,21
s_add_u32 s76,s76,s64
s_lshl_b32 s66,s66,16
s_waitcnt lgkmcnt(0)
s_mov_b64 exec,s[84:85]
buffer_store_dwordx2 v[88:89],v19,s[36:39],s78 offen
s_mov_b64 exec,-1
s_mov_b64 s[84:85],-1
s_mov_b32 s77,s49
s_add_u32 s78,s78,s66
next_336:
v_xor_b32 v17,0x10000,v17
s_xor_b32 s72,s72,0x10000
s_add_u32 s70,s70,2097152
s_xor_b32 s70,s70,0x2000
s_add_u32 s71,s71,1
s_cmp_le_u32 s71,s57
s_cbranch_scc1 seg_327
s_cmp_lg_u32 s43,0
s_cbranch_scc1 hn_346
s_waitcnt vmcnt(1)
s_branch hc_345
hp_343:
buffer_load_dwordx4 v[132:135],v26,s[20:23],s40 offen offset:1024 sc1
buffer_load_dwordx4 v[136:139],v26,s[20:23],s40 offen offset:2048 sc1
buffer_load_dwordx4 v[140:143],v26,s[20:23],s40 offen offset:3072 sc1
s_waitcnt vmcnt(0)
hc_345:
v_bitop3_b32 v22,v132,v136,v140 bitop3:0x80
v_and_b32 v22,s60,v22
v_cmp_eq_u32 vcc,0,v22
s_cbranch_vccz hk_344
s_sub_u32 s90,s90,1
s_cmp_gt_i32 s90,0
s_cbranch_scc1 hp_343
hk_344:
v_pk_add_f32 v[112:113],v[112:113],v[132:133]
v_pk_add_f32 v[136:137],v[136:137],v[140:141]
v_pk_add_f32 v[114:115],v[114:115],v[134:135]
v_pk_add_f32 v[138:139],v[138:139],v[142:143]
v_pk_add_f32 v[112:113],v[112:113],v[136:137]
v_pk_add_f32 v[114:115],v[114:115],v[138:139]
v_pk_fma_f32 v[112:113],v[112:113],v[52:53],v[116:117]
v_pk_fma_f32 v[114:115],v[114:115],v[54:55],v[118:119]
v_cvt_pk_bf16_f32 v112,v112,v113
v_cvt_pk_bf16_f32 v113,v114,v115
ds_bpermute_b32 v112,v40,v112
ds_bpermute_b32 v113,v40,v113
s_mov_b32 s64,4194304
s_waitcnt lgkmcnt(0)
buffer_store_dwordx2 v[112:113],v19,s[36:39],s64 offen
hn_346:
s_endpgm
retry_326:
s_sub_u32 s90,s90,64
s_cmp_lt_i32 s90,0
s_cbranch_scc1 giveup_197
s_mov_b32 s83,1
s_waitcnt vmcnt(0) lgkmcnt(0)
s_barrier
s_branch seg_327
half_335:
s_cmp_eq_u32 s43,0
s_cbranch_scc1 hown_347
s_mov_b64 exec,s[52:53]
s_xor_b32 m0,s91,0
s_add_u32 s65,s94,0
buffer_load_dwordx4 v16,s[20:23],s65 offen offset:0 sc1 lds
buffer_load_dwordx4 v16,s[20:23],s65 offen offset:2048 sc1 lds
s_xor_b32 m0,s91,16384
s_add_u32 s65,s94,32768
buffer_load_dwordx4 v16,s[20:23],s65 offen offset:0 sc1 lds
buffer_load_dwordx4 v16,s[20:23],s65 offen offset:2048 sc1 lds
s_xor_b32 m0,s91,32768
s_add_u32 s65,s94,65536
buffer_load_dwordx4 v16,s[20:23],s65 offen offset:0 sc1 lds
buffer_load_dwordx4 v16,s[20:23],s65 offen offset:2048 sc1 lds
s_xor_b32 m0,s91,49152
s_add_u32 s65,s94,s86
buffer_load_dwordx4 v16,s[20:23],s65 offen offset:0 sc1 lds
buffer_load_dwordx4 v16,s[20:23],s65 offen offset:2048 sc1 lds
s_mov_b64 exec,-1
h2a_348:
s_waitcnt vmcnt(6)
s_barrier
ds_read_b128 v[224:227],v18 offset:0
ds_read_b128 v[228:231],v18 offset:2048
ds_read_b128 v[232:235],v18 offset:4096
ds_read_b128 v[236:239],v18 offset:6144
ds_read_b128 v[240:243],v18 offset:8192
ds_read_b128 v[244:247],v18 offset:10240
ds_read_b128 v[248:251],v18 offset:12288
s_waitcnt lgkmcnt(5)
v_mfma_f32_16x16x32_bf16 v[64:67],a[0:3],v[224:227],0
v_min_u32 v27,v224,v228
v_mfma_f32_16x16x32_bf16 v[68:71],a[112:115],v[224:227],0
ds_read_b128 v[252:255],v18 offset:14336
v_mfma_f32_16x16x32_bf16 v[64:67],a[4:7],v[228:231],v[64:67]
v_mfma_f32_16x16x32_bf16 v[68:71],a[116:119],v[228:231],v[68:71]
s_waitcnt vmcnt(4)
s_barrier
ds_read_b128 v[224:227],v18 offset:16384
s_waitcnt lgkmcnt(5)
v_mfma_f32_16x16x32_bf16 v[64:67],a[8:11],v[232:235],v[64:67]
v_min3_u32 v27,v27,v232,v236
v_mfma_f32_16x16x32_bf16 v[68:71],a[120:123],v[232:235],v[68:71]
ds_read_b128 v[228:231],v18 offset:18432
v_mfma_f32_16x16x32_bf16 v[64:67],a[12:15],v[236:239],v[64:67]
v_mfma_f32_16x16x32_bf16 v[68:71],a[124:127],v[236:239],v[68:71]
ds_read_b128 v[232:235],v18 offset:20480
s_waitcnt lgkmcnt(5)
v_mfma_f32_16x16x32_bf16 v[64:67],a[16:19],v[240:243],v[64:67]
v_min3_u32 v27,v27,v240,v244
v_mfma_f32_16x16x32_bf16 v[68:71],a[128:131],v[240:243],v[68:71]
ds_read_b128 v[236:239],v18 offset:22528
v_mfma_f32_16x16x32_bf16 v[64:67],a[20:23],v[244:247],v[64:67]
v_mfma_f32_16x16x32_bf16 v[68:71],a[132:135],v[244:247],v[68:71]
ds_read_b128 v[240:243],v18 offset:24576
s_waitcnt lgkmcnt(5)
v_mfma_f32_16x16x32_bf16 v[64:67],a[24:27],v[248:251],v[64:67]
v_min3_u32 v27,v27,v248,v252
v_mfma_f32_16x16x32_bf16 v[68:71],a[136:139],v[248:251],v[68:71]
ds_read_b128 v[244:247],v18 offset:26624
v_mfma_f32_16x16x32_bf16 v[64:67],a[28:31],v[252:255],v[64:67]
v_mfma_f32_16x16x32_bf16 v[68:71],a[140:143],v[252:255],v[68:71]
ds_read_b128 v[248:251],v18 offset:28672
s_waitcnt lgkmcnt(5)
v_mfma_f32_16x16x32_bf16 v[64:67],a[32:35],v[224:227],v[64:67]
v_min3_u32 v27,v27,v224,v228
v_mfma_f32_16x16x32_bf16 v[68:71],a[144:147],v[224:227],v[68:71]
ds_read_b128 v[252:255],v18 offset:30720
v_mfma_f32_16x16x32_bf16 v[64:67],a[36:39],v[228:231],v[64:67]
v_mfma_f32_16x16x32_bf16 v[68:71],a[148:151],v[228:231],v[68:71]
s_waitcnt vmcnt(0)
s_barrier
ds_read_b128 v[224:227],v18 offset:32768
s_waitcnt lgkmcnt(5)
v_mfma_f32_16x16x32_bf16 v[64:67],a[40:43],v[232:235],v[64:67]
v_min3_u32 v27,v27,v232,v236
v_mfma_f32_16x16x32_bf16 v[68:71],a[152:155],v[232:235],v[68:71]
ds_read_b128 v[228:231],v18 offset:34816
v_mfma_f32_16x16x32_bf16 v[64:67],a[44:47],v[236:239],v[64:67]
v_mfma_f32_16x16x32_bf16 v[68:71],a[156:159],v[236:239],v[68:71]
ds_read_b128 v[232:235],v18 offset:36864
s_waitcnt lgkmcnt(5)
v_mfma_f32_16x16x32_bf16 v[64:67],a[48:51],v[240:243],v[64:67]
v_min3_u32 v27,v27,v240,v244
v_mfma_f32_16x16x32_bf16 v[68:71],a[160:163],v[240:243],v[68:71]
ds_read_b128 v[236:239],v18 offset:38912
v_mfma_f32_16x16x32_bf16 v[64:67],a[52:55],v[244:247],v[64:67]
v_mfma_f32_16x16x32_bf16 v[68:71],a[164:167],v[244:247],v[68:71]
ds_read_b128 v[240:243],v18 offset:40960
s_waitcnt lgkmcnt(5)
v_mfma_f32_16x16x32_bf16 v[64:67],a[56:59],v[248:251],v[64:67]
v_min3_u32 v27,v27,v248,v252
v_mfma_f32_16x16x32_bf16 v[68:71],a[168:171],v[248:251],v[68:71]
ds_read_b128 v[244:247],v18 offset:43008
v_mfma_f32_16x16x32_bf16 v[64:67],a[60:63],v[252:255],v[64:67]
v_mfma_f32_16x16x32_bf16 v[68:71],a[172:175],v[252:255],v[68:71]
ds_read_b128 v[248:251],v18 offset:45056
s_waitcnt lgkmcnt(5)
v_mfma_f32_16x16x32_bf16 v[64:67],a[64:67],v[224:227],v[64:67]
v_min3_u32 v27,v27,v224,v228
v_mfma_f32_16x16x32_bf16 v[68:71],a[176:179],v[224:227],v[68:71]
ds_read_b128 v[252:255],v18 offset:47104
v_mfma_f32_16x16x32_bf16 v[64:67],a[68:71],v[228:231],v[64:67]
v_mfma_f32_16x16x32_bf16 v[68:71],a[180:183],v[228:231],v[68:71]
ds_read_b128 v[224:227],v18 offset:49152
s_waitcnt lgkmcnt(5)
v_mfma_f32_16x16x32_bf16 v[64:67],a[72:75],v[232:235],v[64:67]
v_min3_u32 v27,v27,v232,v236
v_mfma_f32_16x16x32_bf16 v[68:71],a[184:187],v[232:235],v[68:71]
ds_read_b128 v[228:231],v18 offset:51200
v_mfma_f32_16x16x32_bf16 v[64:67],a[76:79],v[236:239],v[64:67]
v_mfma_f32_16x16x32_bf16 v[68:71],a[188:191],v[236:239],v[68:71]
ds_read_b128 v[232:235],v18 offset:53248
s_waitcnt lgkmcnt(5)
v_mfma_f32_16x16x32_bf16 v[64:67],a[80:83],v[240:243],v[64:67]
v_min3_u32 v27,v27,v240,v244
v_mfma_f32_16x16x32_bf16 v[68:71],a[192:195],v[240:243],v[68:71]
ds_read_b128 v[236:239],v18 offset:55296
v_mfma_f32_16x16x32_bf16 v[64:67],a[84:87],v[244:247],v[64:67]
v_mfma_f32_16x16x32_bf16 v[68:71],a[196:199],v[244:247],v[68:71]
s_waitcnt lgkmcnt(4)
v_mfma_f32_16x16x32_bf16 v[64:67],a[88:91],v[248:251],v[64:67]
v_min3_u32 v27,v27,v248,v252
v_mfma_f32_16x16x32_bf16 v[68:71],a[200:203],v[248:251],v[68:71]
v_mfma_f32_16x16x32_bf16 v[64:67],a[92:95],v[252:255],v[64:67]
v_mfma_f32_16x16x32_bf16 v[68:71],a[204:207],v[252:255],v[68:71]
s_waitcnt lgkmcnt(2)
v_mfma_f32_16x16x32_bf16 v[64:67],a[96:99],v[224:227],v[64:67]
v_min3_u32 v27,v27,v224,v228
v_min3_u32 v27,v27,v226,v230
v_mfma_f32_16x16x32_bf16 v[68:71],a[208:211],v[224:227],v[68:71]
v_mfma_f32_16x16x32_bf16 v[64:67],a[100:103],v[228:231],v[64:67]
v_mfma_f32_16x16x32_bf16 v[68:71],a[212:215],v[228:231],v[68:71]
s_waitcnt lgkmcnt(0)
v_mfma_f32_16x16x32_bf16 v[64:67],a[104:107],v[232:235],v[64:67]
v_min3_u32 v27,v27,v232,v236
v_min3_u32 v27,v27,v234,v238
v_mfma_f32_16x16x32_bf16 v[68:71],a[216:219],v[232:235],v[68:71]
v_mfma_f32_16x16x32_bf16 v[64:67],a[108:111],v[236:239],v[64:67]
v_mfma_f32_16x16x32_bf16 v[68:71],a[220:223],v[236:239],v[68:71]
v_cmp_eq_u32 vcc,0,v27
s_and_b64 vcc,vcc,s[52:53]
s_cbranch_vccnz retry_326
buffer_load_dword v29,v21,s[20:23],s87 offen sc1
s_mov_b32 s40,0x7fff0000
s_nop 5
v_and_or_b32 v64,v64,-4,s48
s_add_u32 s64,s77,s34
buffer_store_dwordx4 v[64:67],v25,s[20:23],s64 offen offset:2048
v_and_or_b32 v68,v68,-4,s48
s_add_u32 s64,s77,s35
buffer_store_dwordx4 v[68:71],v25,s[20:23],s64 offen offset:3072
hjoin_350:
v_xor_b32 v18,0x10000,v18
s_xor_b32 s49,s77,524288
s_cselect_b32 s64,0,3
s_xor_b32 s48,s48,s64
v_xor_b32 v20,0x2000,v20
s_sub_u32 s76,s76,2097152
s_mov_b32 s77,s49
s_sub_u32 s78,s78,65536
s_branch next_336
half2_332:
s_cmp_eq_u32 s43,0
s_cbranch_scc1 h2b_349
s_branch h2a_348
hown_347:
s_mov_b64 exec,s[52:53]
s_xor_b32 m0,s91,1024
s_add_u32 s65,s95,0
buffer_load_dwordx4 v16,s[20:23],s65 offen offset:0 sc1 lds
buffer_load_dwordx4 v16,s[20:23],s65 offen offset:2048 sc1 lds
s_xor_b32 m0,s91,17408
s_add_u32 s65,s95,32768
buffer_load_dwordx4 v16,s[20:23],s65 offen offset:0 sc1 lds
buffer_load_dwordx4 v16,s[20:23],s65 offen offset:2048 sc1 lds
s_xor_b32 m0,s91,33792
s_add_u32 s65,s95,65536
buffer_load_dwordx4 v16,s[20:23],s65 offen offset:0 sc1 lds
buffer_load_dwordx4 v16,s[20:23],s65 offen offset:2048 sc1 lds
s_xor_b32 m0,s91,50176
s_add_u32 s65,s95,s86
buffer_load_dwordx4 v16,s[20:23],s65 offen offset:0 sc1 lds
buffer_load_dwordx4 v16,s[20:23],s65 offen offset:2048 sc1 lds
s_mov_b64 exec,-1
h2b_349:
buffer_load_dwordx2 v[120:121],v20,s[20:23],s76 offen sc1
buffer_load_dwordx2 v[122:123],v24,s[20:23],s70 offen sc1
s_waitcnt vmcnt(8)
s_barrier
ds_read_b128 v[128:131],v17 offset:0
ds_read_b128 v[132:135],v17 offset:2048
ds_read_b128 v[136:139],v17 offset:4096
ds_read_b128 v[140:143],v17 offset:6144
ds_read_b128 v[144:147],v17 offset:8192
ds_read_b128 v[148:151],v17 offset:10240
ds_read_b128 v[152:155],v17 offset:12288
s_waitcnt lgkmcnt(5)
v_mfma_f32_16x16x32_bf16 v[72:75],a[112:115],v[128:131],0
v_min_u32 v27,v128,v132
v_mfma_f32_16x16x32_bf16 v[80:83],a[0:3],v[128:131],0
ds_read_b128 v[156:159],v17 offset:14336
v_mfma_f32_16x16x32_bf16 v[76:79],a[116:119],v[132:135],0
v_mfma_f32_16x16x32_bf16 v[84:87],a[4:7],v[132:135],0
s_waitcnt vmcnt(6)
s_barrier
ds_read_b128 v[160:163],v17 offset:16384
s_waitcnt lgkmcnt(5)
v_mfma_f32_16x16x32_bf16 v[72:75],a[120:123],v[136:139],v[72:75]
v_min3_u32 v27,v27,v136,v140
v_mfma_f32_16x16x32_bf16 v[80:83],a[8:11],v[136:139],v[80:83]
ds_read_b128 v[164:167],v17 offset:18432
v_mfma_f32_16x16x32_bf16 v[76:79],a[124:127],v[140:143],v[76:79]
v_mfma_f32_16x16x32_bf16 v[84:87],a[12:15],v[140:143],v[84:87]
ds_read_b128 v[168:171],v17 offset:20480
s_waitcnt lgkmcnt(5)
v_mfma_f32_16x16x32_bf16 v[72:75],a[128:131],v[144:147],v[72:75]
v_min3_u32 v27,v27,v144,v148
v_mfma_f32_16x16x32_bf16 v[80:83],a[16:19],v[144:147],v[80:83]
ds_read_b128 v[172:175],v17 offset:22528
v_mfma_f32_16x16x32_bf16 v[76:79],a[132:135],v[148:151],v[76:79]
v_mfma_f32_16x16x32_bf16 v[84:87],a[20:23],v[148:151],v[84:87]
ds_read_b128 v[176:179],v17 offset:24576
s_waitcnt lgkmcnt(5)
v_mfma_f32_16x16x32_bf16 v[72:75],a[136:139],v[152:155],v[72:75]
v_min3_u32 v27,v27,v152,v156
v_mfma_f32_16x16x32_bf16 v[80:83],a[24:27],v[152:155],v[80:83]
ds_read_b128 v[180:183],v17 offset:26624
v_mfma_f32_16x16x32_bf16 v[76:79],a[140:143],v[156:159],v[76:79]
v_mfma_f32_16x16x32_bf16 v[84:87],a[28:31],v[156:159],v[84:87]
ds_read_b128 v[184:187],v17 offset:28672
s_waitcnt lgkmcnt(5)
v_mfma_f32_16x16x32_bf16 v[72:75],a[144:147],v[160:163],v[72:75]
v_min3_u32 v27,v27,v160,v164
v_mfma_f32_16x16x32_bf16 v[80:83],a[32:35],v[160:163],v[80:83]
ds_read_b128 v[188:191],v17 offset:30720
v_mfma_f32_16x16x32_bf16 v[76:79],a[148:151],v[164:167],v[76:79]
v_mfma_f32_16x16x32_bf16 v[84:87],a[36:39],v[164:167],v[84:87]
s_waitcnt vmcnt(2)
s_barrier
ds_read_b128 v[192:195],v17 offset:32768
s_waitcnt lgkmcnt(5)
v_mfma_f32_16x16x32_bf16 v[72:75],a[152:155],v[168:171],v[72:75]
v_min3_u32 v27,v27,v168,v172
v_mfma_f32_16x16x32_bf16 v[80:83],a[40:43],v[168:171],v[80:83]
ds_read_b128 v[196:199],v17 offset:34816
v_mfma_f32_16x16x32_bf16 v[76:79],a[156:159],v[172:175],v[76:79]
v_mfma_f32_16x16x32_bf16 v[84:87],a[44:47],v[172:175],v[84:87]
ds_read_b128 v[200:203],v17 offset:36864
s_waitcnt lgkmcnt(5)
v_mfma_f32_16x16x32_bf16 v[72:75],a[160:163],v[176:179],v[72:75]
v_min3_u32 v27,v27,v176,v180
v_mfma_f32_16x16x32_bf16 v[80:83],a[48:51],v[176:179],v[80:83]
ds_read_b128 v[204:207],v17 offset:38912
v_mfma_f32_16x16x32_bf16 v[76:79],a[164:167],v[180:183],v[76:79]
v_mfma_f32_16x16x32_bf16 v[84:87],a[52:55],v[180:183],v[84:87]
ds_read_b128 v[208:211],v17 offset:40960
s_waitcnt lgkmcnt(5)
v_mfma_f32_16x16x32_bf16 v[72:75],a[168:171],v[184:187],v[72:75]
v_min3_u32 v27,v27,v184,v188
v_mfma_f32_16x16x32_bf16 v[80:83],a[56:59],v[184:187],v[80:83]
ds_read_b128 v[212:215],v17 offset:43008
v_mfma_f32_16x16x32_bf16 v[76:79],a[172:175],v[188:191],v[76:79]
v_mfma_f32_16x16x32_bf16 v[84:87],a[60:63],v[188:191],v[84:87]
ds_read_b128 v[216:219],v17 offset:45056
s_waitcnt lgkmcnt(5)
v_mfma_f32_16x16x32_bf16 v[72:75],a[176:179],v[192:195],v[72:75]
v_min3_u32 v27,v27,v192,v196
s_waitcnt vmcnt(0)
v_mfma_f32_16x16x32_bf16 v[80:83],a[64:67],v[192:195],v[80:83]
ds_read_b128 v[220:223],v17 offset:47104
ds_bpermute_b32 v124,v41,v120
v_mfma_f32_16x16x32_bf16 v[76:79],a[180:183],v[196:199],v[76:79]
ds_bpermute_b32 v125,v41,v121
v_lshlrev_b32 v108,16,v122
v_mfma_f32_16x16x32_bf16 v[84:87],a[68:71],v[196:199],v[84:87]
ds_read_b128 v[224:227],v17 offset:49152
s_waitcnt lgkmcnt(7)
v_mfma_f32_16x16x32_bf16 v[72:75],a[184:187],v[200:203],v[72:75]
v_min3_u32 v27,v27,v200,v204
v_and_b32 v109,s80,v122
v_mfma_f32_16x16x32_bf16 v[80:83],a[72:75],v[200:203],v[80:83]
ds_read_b128 v[228:231],v17 offset:51200
v_lshlrev_b32 v110,16,v123
v_mfma_f32_16x16x32_bf16 v[76:79],a[188:191],v[204:207],v[76:79]
v_and_b32 v111,s80,v123
s_waitcnt lgkmcnt(2)
v_mfma_f32_16x16x32_bf16 v[84:87],a[76:79],v[204:207],v[84:87]
ds_read_b128 v[232:235],v17 offset:53248
v_mfma_f32_16x16x32_bf16 v[72:75],a[192:195],v[208:211],v[72:75]
v_min3_u32 v27,v27,v208,v212
v_lshlrev_b32 v104,16,v124
v_mfma_f32_16x16x32_bf16 v[80:83],a[80:83],v[208:211],v[80:83]
ds_read_b128 v[236:239],v17 offset:55296
v_and_b32 v105,s80,v124
v_mfma_f32_16x16x32_bf16 v[76:79],a[196:199],v[212:215],v[76:79]
v_lshlrev_b32 v106,16,v125
v_and_b32 v107,s80,v125
v_mfma_f32_16x16x32_bf16 v[84:87],a[84:87],v[212:215],v[84:87]
v_mfma_f32_16x16x32_bf16 v[72:75],a[200:203],v[216:219],v[72:75]
v_min3_u32 v27,v27,v216,v220
v_mfma_f32_16x16x32_bf16 v[80:83],a[88:91],v[216:219],v[80:83]
v_mfma_f32_16x16x32_bf16 v[76:79],a[204:207],v[220:223],v[76:79]
v_mfma_f32_16x16x32_bf16 v[84:87],a[92:95],v[220:223],v[84:87]
s_waitcnt lgkmcnt(2)
v_mfma_f32_16x16x32_bf16 v[72:75],a[208:211],v[224:227],v[72:75]
v_min3_u32 v27,v27,v224,v228
v_min3_u32 v27,v27,v226,v230
v_mfma_f32_16x16x32_bf16 v[80:83],a[96:99],v[224:227],v[80:83]
v_mfma_f32_16x16x32_bf16 v[76:79],a[212:215],v[228:231],v[76:79]
v_mfma_f32_16x16x32_bf16 v[84:87],a[100:103],v[228:231],v[84:87]
s_waitcnt lgkmcnt(0)
v_mfma_f32_16x16x32_bf16 v[72:75],a[216:219],v[232:235],v[72:75]
v_min3_u32 v27,v27,v232,v236
v_min3_u32 v27,v27,v234,v238
v_mfma_f32_16x16x32_bf16 v[80:83],a[104:107],v[232:235],v[80:83]
v_mfma_f32_16x16x32_bf16 v[76:79],a[220:223],v[236:239],v[76:79]
v_mfma_f32_16x16x32_bf16 v[84:87],a[108:111],v[236:239],v[84:87]
v_cmp_eq_u32 vcc,0,v27
s_and_b64 vcc,vcc,s[52:53]
s_cbranch_vccnz retry_326
buffer_load_dword v29,v21,s[20:23],s87 offen sc1
s_nop 6
v_add_f32 v72,v72,v76
v_add_f32 v73,v73,v77
v_add_f32 v74,v74,v78
v_add_f32 v75,v75,v79
v_and_or_b32 v72,v72,-4,s48
s_add_u32 s64,s77,s33
buffer_store_dwordx4 v[72:75],v25,s[20:23],s64 offen offset:1024
v_pk_add_f32 v[112:113],v[80:81],v[84:85]
v_pk_add_f32 v[112:113],v[112:113],v[108:109]
v_pk_add_f32 v[114:115],v[82:83],v[86:87]
v_pk_add_f32 v[114:115],v[114:115],v[110:111]
v_mov_b32 v116,v104
v_mov_b32 v117,v105
v_mov_b32 v118,v106
v_mov_b32 v119,v107
s_mov_b32 s40,s77
s_mov_b32 s60,s48
s_branch hjoin_350
kslow_325:
s_add_u32 s64,s79,0
s_lshl_b32 s70,s64,21
s_lshl_b32 s64,s64,13
s_and_b32 s64,s64,0x2000
s_xor_b32 s64,s64,s62
s_add_u32 s70,s70,s64
s_add_u32 s70,s70,29360128
s_mov_b32 s83,1
s_mov_b32 s87,s74
s_cmp_eq_u32 s50,0
s_cselect_b32 s74,s74,0x7fff0000
v_mov_b32 v47,132096
s_lshl_b32 s64,s50,3
s_add_u32 s64,s64,132096
v_mov_b32 v46,s64
v_mov_b32 v29,0
s_mov_b32 s97,0x7fff0000
s_mov_b32 s69,1
s_mov_b32 s68,0
s_mov_b32 s52,0x30003
s_mov_b32 s53,s52
seg_352:
s_add_u32 s94,s70,s75
s_xor_b32 s95,s94,1024
s_xor_b32 s91,s72,0x10000
s_cmp_eq_u32 s69,0
s_mov_b32 s69,1
s_cbranch_scc1 half2_357
s_waitcnt vmcnt(1)
v_cmp_gt_u32 vcc,s71,v29
s_cbranch_vccz nb_356
s_cmp_lg_u32 s50,0
s_cbranch_scc1 nb_356
buffer_load_dword v32,v21,s[20:23],s74 offen sc1
s_sleep 2
pl_358:
buffer_load_dword v33,v21,s[20:23],s74 offen sc1
s_waitcnt vmcnt(1)
v_cmp_gt_u32 vcc,s71,v32
v_mov_b32 v29,v32
s_cbranch_vccz pok_359
buffer_load_dword v32,v21,s[20:23],s74 offen sc1
s_waitcnt vmcnt(1)
v_cmp_gt_u32 vcc,s71,v33
v_mov_b32 v29,v33
s_cbranch_vccz pok_359
s_sub_u32 s90,s90,1
s_cmp_gt_i32 s90,0
s_cbranch_scc1 pl_358
pok_359:
nb_356:
s_cmp_eq_u32 s71,64
s_barrier
s_cbranch_scc1 half_360
s_xor_b32 m0,s91,0
s_add_u32 s65,s94,0
buffer_load_dwordx4 v16,s[20:23],s65 offen offset:0 sc1 lds
buffer_load_dwordx4 v16,s[20:23],s65 offen offset:2048 sc1 lds
s_xor_b32 m0,s91,16384
s_add_u32 s65,s94,32768
buffer_load_dwordx4 v16,s[20:23],s65 offen offset:0 sc1 lds
buffer_load_dwordx4 v16,s[20:23],s65 offen offset:2048 sc1 lds
s_xor_b32 m0,s91,32768
s_add_u32 s65,s94,65536
buffer_load_dwordx4 v16,s[20:23],s65 offen offset:0 sc1 lds
buffer_load_dwordx4 v16,s[20:23],s65 offen offset:2048 sc1 lds
s_xor_b32 m0,s91,49152
s_add_u32 s65,s94,s86
buffer_load_dwordx4 v16,s[20:23],s65 offen offset:0 sc1 lds
buffer_load_dwordx4 v16,s[20:23],s65 offen offset:2048 sc1 lds
s_waitcnt vmcnt(6)
s_barrier
ds_read_b128 v[224:227],v18 offset:0
ds_read_b128 v[228:231],v18 offset:2048
ds_read_b128 v[232:235],v18 offset:4096
ds_read_b128 v[236:239],v18 offset:6144
ds_read_b128 v[240:243],v18 offset:8192
ds_read_b128 v[244:247],v18 offset:10240
ds_read_b128 v[248:251],v18 offset:12288
s_waitcnt lgkmcnt(5)
v_mfma_f32_16x16x32_bf16 v[64:67],a[0:3],v[224:227],0
s_xor_b32 m0,s91,1024
v_min_u32 v27,v224,v228
v_mfma_f32_16x16x32_bf16 v[68:71],a[112:115],v[224:227],0
ds_read_b128 v[252:255],v18 offset:14336
v_mfma_f32_16x16x32_bf16 v[64:67],a[4:7],v[228:231],v[64:67]
s_add_u32 s65,s95,0
v_mfma_f32_16x16x32_bf16 v[68:71],a[116:119],v[228:231],v[68:71]
s_waitcnt vmcnt(4)
s_barrier
ds_read_b128 v[224:227],v18 offset:16384
s_waitcnt lgkmcnt(5)
v_mfma_f32_16x16x32_bf16 v[64:67],a[8:11],v[232:235],v[64:67]
buffer_load_dwordx4 v16,s[20:23],s65 offen offset:0 sc1 lds
v_mfma_f32_16x16x32_bf16 v[68:71],a[120:123],v[232:235],v[68:71]
ds_read_b128 v[228:231],v18 offset:18432
v_min3_u32 v27,v27,v232,v236
v_mfma_f32_16x16x32_bf16 v[64:67],a[12:15],v[236:239],v[64:67]
buffer_load_dwordx4 v16,s[20:23],s65 offen offset:2048 sc1 lds
v_mfma_f32_16x16x32_bf16 v[68:71],a[124:127],v[236:239],v[68:71]
ds_read_b128 v[232:235],v18 offset:20480
s_waitcnt lgkmcnt(5)
v_mfma_f32_16x16x32_bf16 v[64:67],a[16:19],v[240:243],v[64:67]
s_xor_b32 m0,s91,17408
v_min3_u32 v27,v27,v240,v244
v_mfma_f32_16x16x32_bf16 v[68:71],a[128:131],v[240:243],v[68:71]
ds_read_b128 v[236:239],v18 offset:22528
v_mfma_f32_16x16x32_bf16 v[64:67],a[20:23],v[244:247],v[64:67]
s_add_u32 s65,s95,32768
v_mfma_f32_16x16x32_bf16 v[68:71],a[132:135],v[244:247],v[68:71]
ds_read_b128 v[240:243],v18 offset:24576
s_waitcnt lgkmcnt(5)
v_mfma_f32_16x16x32_bf16 v[64:67],a[24:27],v[248:251],v[64:67]
buffer_load_dwordx4 v16,s[20:23],s65 offen offset:0 sc1 lds
v_mfma_f32_16x16x32_bf16 v[68:71],a[136:139],v[248:251],v[68:71]
ds_read_b128 v[244:247],v18 offset:26624
v_min3_u32 v27,v27,v248,v252
v_mfma_f32_16x16x32_bf16 v[64:67],a[28:31],v[252:255],v[64:67]
buffer_load_dwordx4 v16,s[20:23],s65 offen offset:2048 sc1 lds
v_mfma_f32_16x16x32_bf16 v[68:71],a[140:143],v[252:255],v[68:71]
ds_read_b128 v[248:251],v18 offset:28672
s_waitcnt lgkmcnt(5)
v_mfma_f32_16x16x32_bf16 v[64:67],a[32:35],v[224:227],v[64:67]
s_xor_b32 m0,s91,33792
v_min3_u32 v27,v27,v224,v228
v_mfma_f32_16x16x32_bf16 v[68:71],a[144:147],v[224:227],v[68:71]
ds_read_b128 v[252:255],v18 offset:30720
v_mfma_f32_16x16x32_bf16 v[64:67],a[36:39],v[228:231],v[64:67]
s_add_u32 s65,s95,65536
v_mfma_f32_16x16x32_bf16 v[68:71],a[148:151],v[228:231],v[68:71]
s_waitcnt vmcnt(4)
s_barrier
ds_read_b128 v[224:227],v18 offset:32768
s_waitcnt lgkmcnt(5)
v_mfma_f32_16x16x32_bf16 v[64:67],a[40:43],v[232:235],v[64:67]
buffer_load_dwordx4 v16,s[20:23],s65 offen offset:0 sc1 lds
s_add_u32 s88,s70,s75
v_mfma_f32_16x16x32_bf16 v[68:71],a[152:155],v[232:235],v[68:71]
ds_read_b128 v[228:231],v18 offset:34816
v_min3_u32 v27,v27,v232,v236
s_add_u32 s88,s88,2097152
v_mfma_f32_16x16x32_bf16 v[64:67],a[44:47],v[236:239],v[64:67]
buffer_load_dwordx4 v16,s[20:23],s65 offen offset:2048 sc1 lds
v_mfma_f32_16x16x32_bf16 v[68:71],a[156:159],v[236:239],v[68:71]
ds_read_b128 v[232:235],v18 offset:36864
s_waitcnt lgkmcnt(5)
v_mfma_f32_16x16x32_bf16 v[64:67],a[48:51],v[240:243],v[64:67]
s_xor_b32 m0,s91,50176
v_min3_u32 v27,v27,v240,v244
v_mfma_f32_16x16x32_bf16 v[68:71],a[160:163],v[240:243],v[68:71]
ds_read_b128 v[236:239],v18 offset:38912
s_xor_b32 s88,s88,0x2000
v_mfma_f32_16x16x32_bf16 v[64:67],a[52:55],v[244:247],v[64:67]
s_add_u32 s65,s95,s86
s_xor_b32 s89,s88,1024
v_mfma_f32_16x16x32_bf16 v[68:71],a[164:167],v[244:247],v[68:71]
ds_read_b128 v[240:243],v18 offset:40960
s_waitcnt lgkmcnt(5)
v_mfma_f32_16x16x32_bf16 v[64:67],a[56:59],v[248:251],v[64:67]
buffer_load_dwordx4 v16,s[20:23],s65 offen offset:0 sc1 lds
v_mfma_f32_16x16x32_bf16 v[68:71],a[168:171],v[248:251],v[68:71]
ds_read_b128 v[244:247],v18 offset:43008
v_min3_u32 v27,v27,v248,v252
v_mfma_f32_16x16x32_bf16 v[64:67],a[60:63],v[252:255],v[64:67]
buffer_load_dwordx4 v16,s[20:23],s65 offen offset:2048 sc1 lds
v_mfma_f32_16x16x32_bf16 v[68:71],a[172:175],v[252:255],v[68:71]
ds_read_b128 v[248:251],v18 offset:45056
s_waitcnt lgkmcnt(5)
v_mfma_f32_16x16x32_bf16 v[64:67],a[64:67],v[224:227],v[64:67]
s_waitcnt vmcnt(4)
s_barrier
ds_read_b128 v[128:131],v17 offset:0
ds_read_b128 v[132:135],v17 offset:2048
v_mfma_f32_16x16x32_bf16 v[68:71],a[176:179],v[224:227],v[68:71]
ds_read_b128 v[252:255],v18 offset:47104
v_min3_u32 v27,v27,v224,v228
v_mfma_f32_16x16x32_bf16 v[64:67],a[68:71],v[228:231],v[64:67]
ds_read_b128 v[136:139],v17 offset:4096
buffer_load_dwordx2 v[120:121],v20,s[20:23],s76 offen sc1
v_mfma_f32_16x16x32_bf16 v[68:71],a[180:183],v[228:231],v[68:71]
ds_read_b128 v[224:227],v18 offset:49152
s_waitcnt lgkmcnt(8)
v_mfma_f32_16x16x32_bf16 v[64:67],a[72:75],v[232:235],v[64:67]
ds_read_b128 v[140:143],v17 offset:6144
v_min3_u32 v27,v27,v232,v236
v_mfma_f32_16x16x32_bf16 v[68:71],a[184:187],v[232:235],v[68:71]
ds_read_b128 v[228:231],v18 offset:51200
buffer_load_dwordx2 v[122:123],v24,s[20:23],s70 offen sc1
v_mfma_f32_16x16x32_bf16 v[64:67],a[76:79],v[236:239],v[64:67]
ds_read_b128 v[144:147],v17 offset:8192
ds_read_b128 v[148:151],v17 offset:10240
v_mfma_f32_16x16x32_bf16 v[68:71],a[188:191],v[236:239],v[68:71]
ds_read_b128 v[232:235],v18 offset:53248
s_waitcnt lgkmcnt(11)
v_mfma_f32_16x16x32_bf16 v[64:67],a[80:83],v[240:243],v[64:67]
ds_read_b128 v[152:155],v17 offset:12288
v_min3_u32 v27,v27,v240,v244
v_mfma_f32_16x16x32_bf16 v[68:71],a[192:195],v[240:243],v[68:71]
ds_read_b128 v[236:239],v18 offset:55296
v_mfma_f32_16x16x32_bf16 v[64:67],a[84:87],v[244:247],v[64:67]
ds_read_b128 v[156:159],v17 offset:14336
v_mfma_f32_16x16x32_bf16 v[68:71],a[196:199],v[244:247],v[68:71]
s_waitcnt lgkmcnt(10)
v_mfma_f32_16x16x32_bf16 v[64:67],a[88:91],v[248:251],v[64:67]
ds_read_b128 v[160:163],v17 offset:16384
ds_read_b128 v[164:167],v17 offset:18432
v_mfma_f32_16x16x32_bf16 v[68:71],a[200:203],v[248:251],v[68:71]
v_min3_u32 v27,v27,v248,v252
v_mfma_f32_16x16x32_bf16 v[64:67],a[92:95],v[252:255],v[64:67]
ds_read_b128 v[168:171],v17 offset:20480
v_mfma_f32_16x16x32_bf16 v[68:71],a[204:207],v[252:255],v[68:71]
s_waitcnt lgkmcnt(9)
v_mfma_f32_16x16x32_bf16 v[64:67],a[96:99],v[224:227],v[64:67]
ds_read_b128 v[172:175],v17 offset:22528
v_min3_u32 v27,v27,v224,v228
v_mfma_f32_16x16x32_bf16 v[68:71],a[208:211],v[224:227],v[68:71]
v_min3_u32 v27,v27,v226,v230
v_mfma_f32_16x16x32_bf16 v[64:67],a[100:103],v[228:231],v[64:67]
ds_read_b128 v[176:179],v17 offset:24576
ds_read_b128 v[180:183],v17 offset:26624
v_mfma_f32_16x16x32_bf16 v[68:71],a[212:215],v[228:231],v[68:71]
s_waitcnt lgkmcnt(7)
v_mfma_f32_16x16x32_bf16 v[64:67],a[104:107],v[232:235],v[64:67]
ds_read_b128 v[184:187],v17 offset:28672
v_min3_u32 v27,v27,v232,v236
v_mfma_f32_16x16x32_bf16 v[68:71],a[216:219],v[232:235],v[68:71]
v_min3_u32 v27,v27,v234,v238
v_mfma_f32_16x16x32_bf16 v[64:67],a[108:111],v[236:239],v[64:67]
ds_read_b128 v[188:191],v17 offset:30720
v_mfma_f32_16x16x32_bf16 v[68:71],a[220:223],v[236:239],v[68:71]
v_mfma_f32_16x16x32_bf16 v[72:75],a[112:115],v[128:131],0
v_cmp_eq_u32 vcc,0,v27
s_cbranch_vccnz retry_351
v_mfma_f32_16x16x32_bf16 v[76:79],a[116:119],v[132:135],0
v_min3_u32 v27,v27,v128,v132
v_mfma_f32_16x16x32_bf16 v[72:75],a[120:123],v[136:139],v[72:75]
s_waitcnt vmcnt(2)
s_barrier
ds_read_b128 v[192:195],v17 offset:32768
v_mfma_f32_16x16x32_bf16 v[76:79],a[124:127],v[140:143],v[76:79]
ds_read_b128 v[196:199],v17 offset:34816
s_waitcnt lgkmcnt(10)
v_mfma_f32_16x16x32_bf16 v[72:75],a[128:131],v[144:147],v[72:75]
ds_read_b128 v[200:203],v17 offset:36864
v_min3_u32 v27,v27,v136,v140
s_waitcnt vmcnt(0)
v_mfma_f32_16x16x32_bf16 v[76:79],a[132:135],v[148:151],v[76:79]
ds_read_b128 v[204:207],v17 offset:38912
v_min3_u32 v27,v27,v144,v148
v_and_or_b32 v64,v64,-4,s48
v_mfma_f32_16x16x32_bf16 v[72:75],a[136:139],v[152:155],v[72:75]
ds_read_b128 v[208:211],v17 offset:40960
s_add_u32 s64,s49,s34
v_mfma_f32_16x16x32_bf16 v[76:79],a[140:143],v[156:159],v[76:79]
v_min3_u32 v27,v27,v152,v156
s_waitcnt lgkmcnt(9)
v_mfma_f32_16x16x32_bf16 v[72:75],a[144:147],v[160:163],v[72:75]
ds_read_b128 v[212:215],v17 offset:43008
buffer_store_dwordx4 v[64:67],v25,s[20:23],s64 offen offset:2048 sc1
v_mfma_f32_16x16x32_bf16 v[76:79],a[148:151],v[164:167],v[76:79]
ds_read_b128 v[216:219],v17 offset:45056
v_min3_u32 v27,v27,v160,v164
v_and_or_b32 v68,v68,-4,s48
v_mfma_f32_16x16x32_bf16 v[72:75],a[152:155],v[168:171],v[72:75]
ds_read_b128 v[220:223],v17 offset:47104
s_add_u32 s64,s49,s35
v_mfma_f32_16x16x32_bf16 v[76:79],a[156:159],v[172:175],v[76:79]
ds_read_b128 v[224:227],v17 offset:49152
s_waitcnt lgkmcnt(9)
v_mfma_f32_16x16x32_bf16 v[72:75],a[160:163],v[176:179],v[72:75]
ds_read_b128 v[228:231],v17 offset:51200
v_min3_u32 v27,v27,v168,v172
v_mfma_f32_16x16x32_bf16 v[76:79],a[164:167],v[180:183],v[76:79]
v_min3_u32 v27,v27,v176,v180
buffer_store_dwordx4 v[68:71],v25,s[20:23],s64 offen offset:3072 sc1
v_mfma_f32_16x16x32_bf16 v[72:75],a[168:171],v[184:187],v[72:75]
ds_read_b128 v[232:235],v17 offset:53248
s_mov_b32 s49,0x7fff0000
v_mfma_f32_16x16x32_bf16 v[76:79],a[172:175],v[188:191],v[76:79]
ds_read_b128 v[236:239],v17 offset:55296
s_waitcnt lgkmcnt(8)
v_mfma_f32_16x16x32_bf16 v[72:75],a[176:179],v[192:195],v[72:75]
v_min3_u32 v27,v27,v184,v188
v_mfma_f32_16x16x32_bf16 v[76:79],a[180:183],v[196:199],v[76:79]
v_min3_u32 v27,v27,v192,v196
ds_bpermute_b32 v124,v41,v120
v_mfma_f32_16x16x32_bf16 v[72:75],a[184:187],v[200:203],v[72:75]
v_mfma_f32_16x16x32_bf16 v[76:79],a[188:191],v[204:207],v[76:79]
v_min3_u32 v27,v27,v200,v204
s_waitcnt lgkmcnt(5)
v_mfma_f32_16x16x32_bf16 v[72:75],a[192:195],v[208:211],v[72:75]
ds_bpermute_b32 v125,v41,v121
v_mfma_f32_16x16x32_bf16 v[76:79],a[196:199],v[212:215],v[76:79]
v_min3_u32 v27,v27,v208,v212
v_lshlrev_b32 v108,16,v122
v_mfma_f32_16x16x32_bf16 v[72:75],a[200:203],v[216:219],v[72:75]
v_mfma_f32_16x16x32_bf16 v[76:79],a[204:207],v[220:223],v[76:79]
v_min3_u32 v27,v27,v216,v220
s_waitcnt lgkmcnt(2)
v_mfma_f32_16x16x32_bf16 v[72:75],a[208:211],v[224:227],v[72:75]
v_and_b32 v109,s80,v122
v_mfma_f32_16x16x32_bf16 v[76:79],a[212:215],v[228:231],v[76:79]
v_min3_u32 v27,v27,v224,v228
v_min3_u32 v27,v27,v226,v230
v_mfma_f32_16x16x32_bf16 v[72:75],a[216:219],v[232:235],v[72:75]
v_lshlrev_b32 v110,16,v123
v_mfma_f32_16x16x32_bf16 v[76:79],a[220:223],v[236:239],v[76:79]
v_min3_u32 v27,v27,v232,v236
v_min3_u32 v27,v27,v234,v238
v_mfma_f32_16x16x32_bf16 v[80:83],a[0:3],v[128:131],0
v_cmp_eq_u32 vcc,0,v27
s_cbranch_vccnz retry_351
v_mfma_f32_16x16x32_bf16 v[84:87],a[4:7],v[132:135],0
v_and_b32 v111,s80,v123
s_waitcnt lgkmcnt(0)
v_mfma_f32_16x16x32_bf16 v[80:83],a[8:11],v[136:139],v[80:83]
v_mfma_f32_16x16x32_bf16 v[84:87],a[12:15],v[140:143],v[84:87]
v_lshlrev_b32 v104,16,v124
v_mfma_f32_16x16x32_bf16 v[80:83],a[16:19],v[144:147],v[80:83]
v_add_f32 v72,v72,v76
v_add_f32 v73,v73,v77
v_mfma_f32_16x16x32_bf16 v[84:87],a[20:23],v[148:151],v[84:87]
v_and_b32 v105,s80,v124
v_add_f32 v74,v74,v78
v_mfma_f32_16x16x32_bf16 v[80:83],a[24:27],v[152:155],v[80:83]
v_add_f32 v75,v75,v79
v_and_or_b32 v72,v72,-4,s48
v_mfma_f32_16x16x32_bf16 v[84:87],a[28:31],v[156:159],v[84:87]
v_lshlrev_b32 v106,16,v125
s_add_u32 s64,s77,s33
v_mfma_f32_16x16x32_bf16 v[80:83],a[32:35],v[160:163],v[80:83]
buffer_store_dwordx4 v[72:75],v25,s[20:23],s64 offen offset:1024 sc1
v_mfma_f32_16x16x32_bf16 v[84:87],a[36:39],v[164:167],v[84:87]
v_and_b32 v107,s80,v125
v_mfma_f32_16x16x32_bf16 v[80:83],a[40:43],v[168:171],v[80:83]
v_mfma_f32_16x16x32_bf16 v[84:87],a[44:47],v[172:175],v[84:87]
v_mfma_f32_16x16x32_bf16 v[80:83],a[48:51],v[176:179],v[80:83]
buffer_load_dwordx4 v[96:99],v26,s[20:23],s77 offen offset:2048 sc1
v_mfma_f32_16x16x32_bf16 v[84:87],a[52:55],v[180:183],v[84:87]
buffer_load_dwordx4 v[100:103],v26,s[20:23],s77 offen offset:3072 sc1
v_mfma_f32_16x16x32_bf16 v[80:83],a[56:59],v[184:187],v[80:83]
v_mfma_f32_16x16x32_bf16 v[84:87],a[60:63],v[188:191],v[84:87]
v_mfma_f32_16x16x32_bf16 v[80:83],a[64:67],v[192:195],v[80:83]
v_mfma_f32_16x16x32_bf16 v[84:87],a[68:71],v[196:199],v[84:87]
v_mfma_f32_16x16x32_bf16 v[80:83],a[72:75],v[200:203],v[80:83]
v_mfma_f32_16x16x32_bf16 v[84:87],a[76:79],v[204:207],v[84:87]
v_mfma_f32_16x16x32_bf16 v[80:83],a[80:83],v[208:211],v[80:83]
v_mfma_f32_16x16x32_bf16 v[84:87],a[84:87],v[212:215],v[84:87]
v_mfma_f32_16x16x32_bf16 v[80:83],a[88:91],v[216:219],v[80:83]
buffer_load_dwordx4 v[92:95],v26,s[20:23],s77 offen offset:1024 sc1
v_mfma_f32_16x16x32_bf16 v[84:87],a[92:95],v[220:223],v[84:87]
v_mfma_f32_16x16x32_bf16 v[80:83],a[96:99],v[224:227],v[80:83]
v_mfma_f32_16x16x32_bf16 v[84:87],a[100:103],v[228:231],v[84:87]
v_mfma_f32_16x16x32_bf16 v[80:83],a[104:107],v[232:235],v[80:83]
v_mfma_f32_16x16x32_bf16 v[84:87],a[108:111],v[236:239],v[84:87]
epi_354:
buffer_load_dword v29,v21,s[20:23],s87 offen sc1
s_nop 6
v_pk_add_f32 v[88:89],v[80:81],v[84:85]
v_pk_add_f32 v[90:91],v[82:83],v[86:87]
v_pk_add_f32 v[88:89],v[88:89],v[108:109]
v_pk_add_f32 v[90:91],v[90:91],v[110:111]
s_waitcnt vmcnt(1)
s_branch ic_364
ip_362:
buffer_load_dwordx4 v[92:95],v26,s[20:23],s77 offen offset:1024 sc1
buffer_load_dwordx4 v[96:99],v26,s[20:23],s77 offen offset:2048 sc1
buffer_load_dwordx4 v[100:103],v26,s[20:23],s77 offen offset:3072 sc1
s_waitcnt vmcnt(0)
ic_364:
v_bitop3_b32 v22,v92,v96,v100 bitop3:0x80
v_and_b32 v22,s48,v22
v_cmp_eq_u32 vcc,0,v22
s_cbranch_vccz ik_363
s_sub_u32 s90,s90,1
s_cmp_gt_i32 s90,0
s_cbranch_scc1 ip_362
ik_363:
s_cmp_lg_u32 s71,65
s_cbranch_scc1 nl_365
buffer_load_dwordx4 v[132:135],v26,s[20:23],s40 offen offset:1024 sc1
buffer_load_dwordx4 v[136:139],v26,s[20:23],s40 offen offset:2048 sc1
buffer_load_dwordx4 v[140:143],v26,s[20:23],s40 offen offset:3072 sc1
nl_365:
v_pk_add_f32 v[88:89],v[88:89],v[92:93]
v_pk_add_f32 v[96:97],v[96:97],v[100:101]
v_pk_add_f32 v[90:91],v[90:91],v[94:95]
v_pk_add_f32 v[98:99],v[98:99],v[102:103]
v_pk_add_f32 v[88:89],v[88:89],v[96:97]
v_pk_add_f32 v[90:91],v[90:91],v[98:99]
v_pk_fma_f32 v[88:89],v[88:89],v[52:53],v[104:105]
v_pk_fma_f32 v[90:91],v[90:91],v[54:55],v[106:107]
v_cvt_pk_bf16_f32 v88,v88,v89
v_cvt_pk_bf16_f32 v89,v90,v91
ds_bpermute_b32 v88,v40,v88
ds_bpermute_b32 v89,v40,v89
v_xor_b32 v18,0x10000,v18
s_xor_b32 s49,s77,524288
s_cselect_b32 s64,0,3
s_xor_b32 s48,s48,s64
s_cmp_eq_u32 s71,63
s_cselect_b32 s64,0,0x2000
s_cselect_b32 s66,2,1
s_cmp_eq_u32 s71,64
s_cselect_b32 s66,-1,s66
v_xor_b32 v20,s64,v20
s_lshl_b32 s64,s66,21
s_add_u32 s76,s76,s64
s_lshl_b32 s66,s66,16
s_waitcnt lgkmcnt(0)
s_mov_b64 exec,s[84:85]
buffer_store_dwordx2 v[88:89],v19,s[36:39],s78 offen
s_mov_b64 exec,-1
s_mov_b64 s[84:85],-1
s_mov_b32 s77,s49
s_add_u32 s78,s78,s66
next_361:
v_xor_b32 v17,0x10000,v17
s_xor_b32 s72,s72,0x10000
s_add_u32 s70,s70,2097152
s_xor_b32 s70,s70,0x2000
s_add_u32 s71,s71,1
s_cmp_le_u32 s71,s57
s_cbranch_scc1 seg_352
s_cmp_lg_u32 s43,0
s_cbranch_scc1 hn_369
s_waitcnt vmcnt(1)
s_branch hc_368
hp_366:
buffer_load_dwordx4 v[132:135],v26,s[20:23],s40 offen offset:1024 sc1
buffer_load_dwordx4 v[136:139],v26,s[20:23],s40 offen offset:2048 sc1
buffer_load_dwordx4 v[140:143],v26,s[20:23],s40 offen offset:3072 sc1
s_waitcnt vmcnt(0)
hc_368:
v_bitop3_b32 v22,v132,v136,v140 bitop3:0x80
v_and_b32 v22,s60,v22
v_cmp_eq_u32 vcc,0,v22
s_cbranch_vccz hk_367
s_sub_u32 s90,s90,1
s_cmp_gt_i32 s90,0
s_cbranch_scc1 hp_366
hk_367:
v_pk_add_f32 v[112:113],v[112:113],v[132:133]
v_pk_add_f32 v[136:137],v[136:137],v[140:141]
v_pk_add_f32 v[114:115],v[114:115],v[134:135]
v_pk_add_f32 v[138:139],v[138:139],v[142:143]
v_pk_add_f32 v[112:113],v[112:113],v[136:137]
v_pk_add_f32 v[114:115],v[114:115],v[138:139]
v_pk_fma_f32 v[112:113],v[112:113],v[52:53],v[116:117]
v_pk_fma_f32 v[114:115],v[114:115],v[54:55],v[118:119]
v_cvt_pk_bf16_f32 v112,v112,v113
v_cvt_pk_bf16_f32 v113,v114,v115
ds_bpermute_b32 v112,v40,v112
ds_bpermute_b32 v113,v40,v113
s_mov_b32 s64,4194304
s_waitcnt lgkmcnt(0)
buffer_store_dwordx2 v[112:113],v19,s[36:39],s64 offen
hn_369:
s_endpgm
retry_351:
s_sub_u32 s90,s90,64
s_cmp_lt_i32 s90,0
s_cbranch_scc1 giveup_197
s_mov_b32 s83,1
s_waitcnt vmcnt(0) lgkmcnt(0)
s_barrier
s_branch seg_352
half_360:
s_cmp_eq_u32 s43,0
s_cbranch_scc1 hown_370
s_mov_b64 exec,s[52:53]
s_xor_b32 m0,s91,0
s_add_u32 s65,s94,0
buffer_load_dwordx4 v16,s[20:23],s65 offen offset:0 sc1 lds
buffer_load_dwordx4 v16,s[20:23],s65 offen offset:2048 sc1 lds
s_xor_b32 m0,s91,16384
s_add_u32 s65,s94,32768
buffer_load_dwordx4 v16,s[20:23],s65 offen offset:0 sc1 lds
buffer_load_dwordx4 v16,s[20:23],s65 offen offset:2048 sc1 lds
s_xor_b32 m0,s91,32768
s_add_u32 s65,s94,65536
buffer_load_dwordx4 v16,s[20:23],s65 offen offset:0 sc1 lds
buffer_load_dwordx4 v16,s[20:23],s65 offen offset:2048 sc1 lds
s_xor_b32 m0,s91,49152
s_add_u32 s65,s94,s86
buffer_load_dwordx4 v16,s[20:23],s65 offen offset:0 sc1 lds
buffer_load_dwordx4 v16,s[20:23],s65 offen offset:2048 sc1 lds
s_mov_b64 exec,-1
h2a_371:
s_waitcnt vmcnt(6)
s_barrier
ds_read_b128 v[224:227],v18 offset:0
ds_read_b128 v[228:231],v18 offset:2048
ds_read_b128 v[232:235],v18 offset:4096
ds_read_b128 v[236:239],v18 offset:6144
ds_read_b128 v[240:243],v18 offset:8192
ds_read_b128 v[244:247],v18 offset:10240
ds_read_b128 v[248:251],v18 offset:12288
s_waitcnt lgkmcnt(5)
v_mfma_f32_16x16x32_bf16 v[64:67],a[0:3],v[224:227],0
v_min_u32 v27,v224,v228
v_mfma_f32_16x16x32_bf16 v[68:71],a[112:115],v[224:227],0
ds_read_b128 v[252:255],v18 offset:14336
v_mfma_f32_16x16x32_bf16 v[64:67],a[4:7],v[228:231],v[64:67]
v_mfma_f32_16x16x32_bf16 v[68:71],a[116:119],v[228:231],v[68:71]
s_waitcnt vmcnt(4)
s_barrier
ds_read_b128 v[224:227],v18 offset:16384
s_waitcnt lgkmcnt(5)
v_mfma_f32_16x16x32_bf16 v[64:67],a[8:11],v[232:235],v[64:67]
v_min3_u32 v27,v27,v232,v236
v_mfma_f32_16x16x32_bf16 v[68:71],a[120:123],v[232:235],v[68:71]
ds_read_b128 v[228:231],v18 offset:18432
v_mfma_f32_16x16x32_bf16 v[64:67],a[12:15],v[236:239],v[64:67]
v_mfma_f32_16x16x32_bf16 v[68:71],a[124:127],v[236:239],v[68:71]
ds_read_b128 v[232:235],v18 offset:20480
s_waitcnt lgkmcnt(5)
v_mfma_f32_16x16x32_bf16 v[64:67],a[16:19],v[240:243],v[64:67]
v_min3_u32 v27,v27,v240,v244
v_mfma_f32_16x16x32_bf16 v[68:71],a[128:131],v[240:243],v[68:71]
ds_read_b128 v[236:239],v18 offset:22528
v_mfma_f32_16x16x32_bf16 v[64:67],a[20:23],v[244:247],v[64:67]
v_mfma_f32_16x16x32_bf16 v[68:71],a[132:135],v[244:247],v[68:71]
ds_read_b128 v[240:243],v18 offset:24576
s_waitcnt lgkmcnt(5)
v_mfma_f32_16x16x32_bf16 v[64:67],a[24:27],v[248:251],v[64:67]
v_min3_u32 v27,v27,v248,v252
v_mfma_f32_16x16x32_bf16 v[68:71],a[136:139],v[248:251],v[68:71]
ds_read_b128 v[244:247],v18 offset:26624
v_mfma_f32_16x16x32_bf16 v[64:67],a[28:31],v[252:255],v[64:67]
v_mfma_f32_16x16x32_bf16 v[68:71],a[140:143],v[252:255],v[68:71]
ds_read_b128 v[248:251],v18 offset:28672
s_waitcnt lgkmcnt(5)
v_mfma_f32_16x16x32_bf16 v[64:67],a[32:35],v[224:227],v[64:67]
v_min3_u32 v27,v27,v224,v228
v_mfma_f32_16x16x32_bf16 v[68:71],a[144:147],v[224:227],v[68:71]
ds_read_b128 v[252:255],v18 offset:30720
v_mfma_f32_16x16x32_bf16 v[64:67],a[36:39],v[228:231],v[64:67]
v_mfma_f32_16x16x32_bf16 v[68:71],a[148:151],v[228:231],v[68:71]
s_waitcnt vmcnt(0)
s_barrier
ds_read_b128 v[224:227],v18 offset:32768
s_waitcnt lgkmcnt(5)
v_mfma_f32_16x16x32_bf16 v[64:67],a[40:43],v[232:235],v[64:67]
v_min3_u32 v27,v27,v232,v236
v_mfma_f32_16x16x32_bf16 v[68:71],a[152:155],v[232:235],v[68:71]
ds_read_b128 v[228:231],v18 offset:34816
v_mfma_f32_16x16x32_bf16 v[64:67],a[44:47],v[236:239],v[64:67]
v_mfma_f32_16x16x32_bf16 v[68:71],a[156:159],v[236:239],v[68:71]
ds_read_b128 v[232:235],v18 offset:36864
s_waitcnt lgkmcnt(5)
v_mfma_f32_16x16x32_bf16 v[64:67],a[48:51],v[240:243],v[64:67]
v_min3_u32 v27,v27,v240,v244
v_mfma_f32_16x16x32_bf16 v[68:71],a[160:163],v[240:243],v[68:71]
ds_read_b128 v[236:239],v18 offset:38912
v_mfma_f32_16x16x32_bf16 v[64:67],a[52:55],v[244:247],v[64:67]
v_mfma_f32_16x16x32_bf16 v[68:71],a[164:167],v[244:247],v[68:71]
ds_read_b128 v[240:243],v18 offset:40960
s_waitcnt lgkmcnt(5)
v_mfma_f32_16x16x32_bf16 v[64:67],a[56:59],v[248:251],v[64:67]
v_min3_u32 v27,v27,v248,v252
v_mfma_f32_16x16x32_bf16 v[68:71],a[168:171],v[248:251],v[68:71]
ds_read_b128 v[244:247],v18 offset:43008
v_mfma_f32_16x16x32_bf16 v[64:67],a[60:63],v[252:255],v[64:67]
v_mfma_f32_16x16x32_bf16 v[68:71],a[172:175],v[252:255],v[68:71]
ds_read_b128 v[248:251],v18 offset:45056
s_waitcnt lgkmcnt(5)
v_mfma_f32_16x16x32_bf16 v[64:67],a[64:67],v[224:227],v[64:67]
v_min3_u32 v27,v27,v224,v228
v_mfma_f32_16x16x32_bf16 v[68:71],a[176:179],v[224:227],v[68:71]
ds_read_b128 v[252:255],v18 offset:47104
v_mfma_f32_16x16x32_bf16 v[64:67],a[68:71],v[228:231],v[64:67]
v_mfma_f32_16x16x32_bf16 v[68:71],a[180:183],v[228:231],v[68:71]
ds_read_b128 v[224:227],v18 offset:49152
s_waitcnt lgkmcnt(5)
v_mfma_f32_16x16x32_bf16 v[64:67],a[72:75],v[232:235],v[64:67]
v_min3_u32 v27,v27,v232,v236
v_mfma_f32_16x16x32_bf16 v[68:71],a[184:187],v[232:235],v[68:71]
ds_read_b128 v[228:231],v18 offset:51200
v_mfma_f32_16x16x32_bf16 v[64:67],a[76:79],v[236:239],v[64:67]
v_mfma_f32_16x16x32_bf16 v[68:71],a[188:191],v[236:239],v[68:71]
ds_read_b128 v[232:235],v18 offset:53248
s_waitcnt lgkmcnt(5)
v_mfma_f32_16x16x32_bf16 v[64:67],a[80:83],v[240:243],v[64:67]
v_min3_u32 v27,v27,v240,v244
v_mfma_f32_16x16x32_bf16 v[68:71],a[192:195],v[240:243],v[68:71]
ds_read_b128 v[236:239],v18 offset:55296
v_mfma_f32_16x16x32_bf16 v[64:67],a[84:87],v[244:247],v[64:67]
v_mfma_f32_16x16x32_bf16 v[68:71],a[196:199],v[244:247],v[68:71]
s_waitcnt lgkmcnt(4)
v_mfma_f32_16x16x32_bf16 v[64:67],a[88:91],v[248:251],v[64:67]
v_min3_u32 v27,v27,v248,v252
v_mfma_f32_16x16x32_bf16 v[68:71],a[200:203],v[248:251],v[68:71]
v_mfma_f32_16x16x32_bf16 v[64:67],a[92:95],v[252:255],v[64:67]
v_mfma_f32_16x16x32_bf16 v[68:71],a[204:207],v[252:255],v[68:71]
s_waitcnt lgkmcnt(2)
v_mfma_f32_16x16x32_bf16 v[64:67],a[96:99],v[224:227],v[64:67]
v_min3_u32 v27,v27,v224,v228
v_min3_u32 v27,v27,v226,v230
v_mfma_f32_16x16x32_bf16 v[68:71],a[208:211],v[224:227],v[68:71]
v_mfma_f32_16x16x32_bf16 v[64:67],a[100:103],v[228:231],v[64:67]
v_mfma_f32_16x16x32_bf16 v[68:71],a[212:215],v[228:231],v[68:71]
s_waitcnt lgkmcnt(0)
v_mfma_f32_16x16x32_bf16 v[64:67],a[104:107],v[232:235],v[64:67]
v_min3_u32 v27,v27,v232,v236
v_min3_u32 v27,v27,v234,v238
v_mfma_f32_16x16x32_bf16 v[68:71],a[216:219],v[232:235],v[68:71]
v_mfma_f32_16x16x32_bf16 v[64:67],a[108:111],v[236:239],v[64:67]
v_mfma_f32_16x16x32_bf16 v[68:71],a[220:223],v[236:239],v[68:71]
v_cmp_eq_u32 vcc,0,v27
s_and_b64 vcc,vcc,s[52:53]
s_cbranch_vccnz retry_351
buffer_load_dword v29,v21,s[20:23],s87 offen sc1
s_mov_b32 s40,0x7fff0000
s_nop 5
v_and_or_b32 v64,v64,-4,s48
s_add_u32 s64,s77,s34
buffer_store_dwordx4 v[64:67],v25,s[20:23],s64 offen offset:2048 sc1
v_and_or_b32 v68,v68,-4,s48
s_add_u32 s64,s77,s35
buffer_store_dwordx4 v[68:71],v25,s[20:23],s64 offen offset:3072 sc1
hjoin_373:
v_xor_b32 v18,0x10000,v18
s_xor_b32 s49,s77,524288
s_cselect_b32 s64,0,3
s_xor_b32 s48,s48,s64
v_xor_b32 v20,0x2000,v20
s_sub_u32 s76,s76,2097152
s_mov_b32 s77,s49
s_sub_u32 s78,s78,65536
s_branch next_361
half2_357:
s_cmp_eq_u32 s43,0
s_cbranch_scc1 h2b_372
s_branch h2a_371
hown_370:
s_mov_b64 exec,s[52:53]
s_xor_b32 m0,s91,1024
s_add_u32 s65,s95,0
buffer_load_dwordx4 v16,s[20:23],s65 offen offset:0 sc1 lds
buffer_load_dwordx4 v16,s[20:23],s65 offen offset:2048 sc1 lds
s_xor_b32 m0,s91,17408
s_add_u32 s65,s95,32768
buffer_load_dwordx4 v16,s[20:23],s65 offen offset:0 sc1 lds
buffer_load_dwordx4 v16,s[20:23],s65 offen offset:2048 sc1 lds
s_xor_b32 m0,s91,33792
s_add_u32 s65,s95,65536
buffer_load_dwordx4 v16,s[20:23],s65 offen offset:0 sc1 lds
buffer_load_dwordx4 v16,s[20:23],s65 offen offset:2048 sc1 lds
s_xor_b32 m0,s91,50176
s_add_u32 s65,s95,s86
buffer_load_dwordx4 v16,s[20:23],s65 offen offset:0 sc1 lds
buffer_load_dwordx4 v16,s[20:23],s65 offen offset:2048 sc1 lds
s_mov_b64 exec,-1
h2b_372:
buffer_load_dwordx2 v[120:121],v20,s[20:23],s76 offen sc1
buffer_load_dwordx2 v[122:123],v24,s[20:23],s70 offen sc1
s_waitcnt vmcnt(8)
s_barrier
ds_read_b128 v[128:131],v17 offset:0
ds_read_b128 v[132:135],v17 offset:2048
ds_read_b128 v[136:139],v17 offset:4096
ds_read_b128 v[140:143],v17 offset:6144
ds_read_b128 v[144:147],v17 offset:8192
ds_read_b128 v[148:151],v17 offset:10240
ds_read_b128 v[152:155],v17 offset:12288
s_waitcnt lgkmcnt(5)
v_mfma_f32_16x16x32_bf16 v[72:75],a[112:115],v[128:131],0
v_min_u32 v27,v128,v132
v_mfma_f32_16x16x32_bf16 v[80:83],a[0:3],v[128:131],0
ds_read_b128 v[156:159],v17 offset:14336
v_mfma_f32_16x16x32_bf16 v[76:79],a[116:119],v[132:135],0
v_mfma_f32_16x16x32_bf16 v[84:87],a[4:7],v[132:135],0
s_waitcnt vmcnt(6)
s_barrier
ds_read_b128 v[160:163],v17 offset:16384
s_waitcnt lgkmcnt(5)
v_mfma_f32_16x16x32_bf16 v[72:75],a[120:123],v[136:139],v[72:75]
v_min3_u32 v27,v27,v136,v140
v_mfma_f32_16x16x32_bf16 v[80:83],a[8:11],v[136:139],v[80:83]
ds_read_b128 v[164:167],v17 offset:18432
v_mfma_f32_16x16x32_bf16 v[76:79],a[124:127],v[140:143],v[76:79]
v_mfma_f32_16x16x32_bf16 v[84:87],a[12:15],v[140:143],v[84:87]
ds_read_b128 v[168:171],v17 offset:20480
s_waitcnt lgkmcnt(5)
v_mfma_f32_16x16x32_bf16 v[72:75],a[128:131],v[144:147],v[72:75]
v_min3_u32 v27,v27,v144,v148
v_mfma_f32_16x16x32_bf16 v[80:83],a[16:19],v[144:147],v[80:83]
ds_read_b128 v[172:175],v17 offset:22528
v_mfma_f32_16x16x32_bf16 v[76:79],a[132:135],v[148:151],v[76:79]
v_mfma_f32_16x16x32_bf16 v[84:87],a[20:23],v[148:151],v[84:87]
ds_read_b128 v[176:179],v17 offset:24576
s_waitcnt lgkmcnt(5)
v_mfma_f32_16x16x32_bf16 v[72:75],a[136:139],v[152:155],v[72:75]
v_min3_u32 v27,v27,v152,v156
v_mfma_f32_16x16x32_bf16 v[80:83],a[24:27],v[152:155],v[80:83]
ds_read_b128 v[180:183],v17 offset:26624
v_mfma_f32_16x16x32_bf16 v[76:79],a[140:143],v[156:159],v[76:79]
v_mfma_f32_16x16x32_bf16 v[84:87],a[28:31],v[156:159],v[84:87]
ds_read_b128 v[184:187],v17 offset:28672
s_waitcnt lgkmcnt(5)
v_mfma_f32_16x16x32_bf16 v[72:75],a[144:147],v[160:163],v[72:75]
v_min3_u32 v27,v27,v160,v164
v_mfma_f32_16x16x32_bf16 v[80:83],a[32:35],v[160:163],v[80:83]
ds_read_b128 v[188:191],v17 offset:30720
v_mfma_f32_16x16x32_bf16 v[76:79],a[148:151],v[164:167],v[76:79]
v_mfma_f32_16x16x32_bf16 v[84:87],a[36:39],v[164:167],v[84:87]
s_waitcnt vmcnt(2)
s_barrier
ds_read_b128 v[192:195],v17 offset:32768
s_waitcnt lgkmcnt(5)
v_mfma_f32_16x16x32_bf16 v[72:75],a[152:155],v[168:171],v[72:75]
v_min3_u32 v27,v27,v168,v172
v_mfma_f32_16x16x32_bf16 v[80:83],a[40:43],v[168:171],v[80:83]
ds_read_b128 v[196:199],v17 offset:34816
v_mfma_f32_16x16x32_bf16 v[76:79],a[156:159],v[172:175],v[76:79]
v_mfma_f32_16x16x32_bf16 v[84:87],a[44:47],v[172:175],v[84:87]
ds_read_b128 v[200:203],v17 offset:36864
s_waitcnt lgkmcnt(5)
v_mfma_f32_16x16x32_bf16 v[72:75],a[160:163],v[176:179],v[72:75]
v_min3_u32 v27,v27,v176,v180
v_mfma_f32_16x16x32_bf16 v[80:83],a[48:51],v[176:179],v[80:83]
ds_read_b128 v[204:207],v17 offset:38912
v_mfma_f32_16x16x32_bf16 v[76:79],a[164:167],v[180:183],v[76:79]
v_mfma_f32_16x16x32_bf16 v[84:87],a[52:55],v[180:183],v[84:87]
ds_read_b128 v[208:211],v17 offset:40960
s_waitcnt lgkmcnt(5)
v_mfma_f32_16x16x32_bf16 v[72:75],a[168:171],v[184:187],v[72:75]
v_min3_u32 v27,v27,v184,v188
v_mfma_f32_16x16x32_bf16 v[80:83],a[56:59],v[184:187],v[80:83]
ds_read_b128 v[212:215],v17 offset:43008
v_mfma_f32_16x16x32_bf16 v[76:79],a[172:175],v[188:191],v[76:79]
v_mfma_f32_16x16x32_bf16 v[84:87],a[60:63],v[188:191],v[84:87]
ds_read_b128 v[216:219],v17 offset:45056
s_waitcnt lgkmcnt(5)
v_mfma_f32_16x16x32_bf16 v[72:75],a[176:179],v[192:195],v[72:75]
v_min3_u32 v27,v27,v192,v196
s_waitcnt vmcnt(0)
v_mfma_f32_16x16x32_bf16 v[80:83],a[64:67],v[192:195],v[80:83]
ds_read_b128 v[220:223],v17 offset:47104
ds_bpermute_b32 v124,v41,v120
v_mfma_f32_16x16x32_bf16 v[76:79],a[180:183],v[196:199],v[76:79]
ds_bpermute_b32 v125,v41,v121
v_lshlrev_b32 v108,16,v122
v_mfma_f32_16x16x32_bf16 v[84:87],a[68:71],v[196:199],v[84:87]
ds_read_b128 v[224:227],v17 offset:49152
s_waitcnt lgkmcnt(7)
v_mfma_f32_16x16x32_bf16 v[72:75],a[184:187],v[200:203],v[72:75]
v_min3_u32 v27,v27,v200,v204
v_and_b32 v109,s80,v122
v_mfma_f32_16x16x32_bf16 v[80:83],a[72:75],v[200:203],v[80:83]
ds_read_b128 v[228:231],v17 offset:51200
v_lshlrev_b32 v110,16,v123
v_mfma_f32_16x16x32_bf16 v[76:79],a[188:191],v[204:207],v[76:79]
v_and_b32 v111,s80,v123
s_waitcnt lgkmcnt(2)
v_mfma_f32_16x16x32_bf16 v[84:87],a[76:79],v[204:207],v[84:87]
ds_read_b128 v[232:235],v17 offset:53248
v_mfma_f32_16x16x32_bf16 v[72:75],a[192:195],v[208:211],v[72:75]
v_min3_u32 v27,v27,v208,v212
v_lshlrev_b32 v104,16,v124
v_mfma_f32_16x16x32_bf16 v[80:83],a[80:83],v[208:211],v[80:83]
ds_read_b128 v[236:239],v17 offset:55296
v_and_b32 v105,s80,v124
v_mfma_f32_16x16x32_bf16 v[76:79],a[196:199],v[212:215],v[76:79]
v_lshlrev_b32 v106,16,v125
v_and_b32 v107,s80,v125
v_mfma_f32_16x16x32_bf16 v[84:87],a[84:87],v[212:215],v[84:87]
v_mfma_f32_16x16x32_bf16 v[72:75],a[200:203],v[216:219],v[72:75]
v_min3_u32 v27,v27,v216,v220
v_mfma_f32_16x16x32_bf16 v[80:83],a[88:91],v[216:219],v[80:83]
v_mfma_f32_16x16x32_bf16 v[76:79],a[204:207],v[220:223],v[76:79]
v_mfma_f32_16x16x32_bf16 v[84:87],a[92:95],v[220:223],v[84:87]
s_waitcnt lgkmcnt(2)
v_mfma_f32_16x16x32_bf16 v[72:75],a[208:211],v[224:227],v[72:75]
v_min3_u32 v27,v27,v224,v228
v_min3_u32 v27,v27,v226,v230
v_mfma_f32_16x16x32_bf16 v[80:83],a[96:99],v[224:227],v[80:83]
v_mfma_f32_16x16x32_bf16 v[76:79],a[212:215],v[228:231],v[76:79]
v_mfma_f32_16x16x32_bf16 v[84:87],a[100:103],v[228:231],v[84:87]
s_waitcnt lgkmcnt(0)
v_mfma_f32_16x16x32_bf16 v[72:75],a[216:219],v[232:235],v[72:75]
v_min3_u32 v27,v27,v232,v236
v_min3_u32 v27,v27,v234,v238
v_mfma_f32_16x16x32_bf16 v[80:83],a[104:107],v[232:235],v[80:83]
v_mfma_f32_16x16x32_bf16 v[76:79],a[220:223],v[236:239],v[76:79]
v_mfma_f32_16x16x32_bf16 v[84:87],a[108:111],v[236:239],v[84:87]
v_cmp_eq_u32 vcc,0,v27
s_and_b64 vcc,vcc,s[52:53]
s_cbranch_vccnz retry_351
buffer_load_dword v29,v21,s[20:23],s87 offen sc1
s_nop 6
v_add_f32 v72,v72,v76
v_add_f32 v73,v73,v77
v_add_f32 v74,v74,v78
v_add_f32 v75,v75,v79
v_and_or_b32 v72,v72,-4,s48
s_add_u32 s64,s77,s33
buffer_store_dwordx4 v[72:75],v25,s[20:23],s64 offen offset:1024 sc1
v_pk_add_f32 v[112:113],v[80:81],v[84:85]
v_pk_add_f32 v[112:113],v[112:113],v[108:109]
v_pk_add_f32 v[114:115],v[82:83],v[86:87]
v_pk_add_f32 v[114:115],v[114:115],v[110:111]
v_mov_b32 v116,v104
v_mov_b32 v117,v105
v_mov_b32 v118,v106
v_mov_b32 v119,v107
s_mov_b32 s40,s77
s_mov_b32 s60,s48
s_branch hjoin_373
r_w3_215:
s_load_dwordx2 s[4:5],s[0:1],80
s_mul_i32 s66,s59,224
s_lshl_b32 s67,s50,1
s_waitcnt lgkmcnt(0)
s_mov_b32 s32,s4
s_and_b32 s33,s5,0xffff
s_mov_b32 s34,0x700000
s_mov_b32 s35,0x20000
v_lshrrev_b32 v5,2,v3
v_lshl_add_u32 v5,v4,2,v5
v_and_b32 v6,3,v3
v_lshlrev_b32 v6,3,v6
v_lshl_add_u32 v6,v5,8,v6
v_and_b32 v5,7,v5
v_xor_b32 v5,s67,v5
v_lshl_add_u32 v12,v5,5,v6
v_xor_b32 v13,32,v12
v_and_b32 v5,15,v1
v_and_b32 v6,3,v4
v_lshlrev_b32 v6,1,v6
v_xor_b32 v5,v5,v6
v_mul_u32_u24 v6,7168,v4
v_xor_b32 v7,0,v5
v_lshl_add_u32 v8,v7,4,v6
v_xor_b32 v7,8,v5
v_lshl_add_u32 v9,v7,4,v6
s_mul_i32 s74,s50,458752
s_add_u32 s74,s74,s66
s_lshl_b32 s75,s50,14
s_mul_i32 s76,s50,229376
s_add_u32 s76,s76,s66
s_lshl_b32 s77,s50,13
s_add_u32 s64,s74,0
s_add_u32 m0,s75,0
s_nop 0
buffer_load_dwordx4 v8,s[32:35],s64 offen nt lds
s_add_u32 s64,s74,28672
s_add_u32 m0,s75,1024
s_nop 0
buffer_load_dwordx4 v9,s[32:35],s64 offen nt lds
s_add_u32 s64,s74,57344
s_add_u32 m0,s75,2048
s_nop 0
buffer_load_dwordx4 v8,s[32:35],s64 offen nt lds
s_add_u32 s64,s74,86016
s_add_u32 m0,s75,3072
s_nop 0
buffer_load_dwordx4 v9,s[32:35],s64 offen nt lds
s_add_u32 s64,s74,114688
s_add_u32 m0,s75,4096
s_nop 0
buffer_load_dwordx4 v8,s[32:35],s64 offen nt lds
s_add_u32 s64,s74,143360
s_add_u32 m0,s75,5120
s_nop 0
buffer_load_dwordx4 v9,s[32:35],s64 offen nt lds
s_add_u32 s64,s74,172032
s_add_u32 m0,s75,6144
s_nop 0
buffer_load_dwordx4 v8,s[32:35],s64 offen nt lds
s_add_u32 s64,s74,200704
s_add_u32 m0,s75,7168
s_nop 0
buffer_load_dwordx4 v9,s[32:35],s64 offen nt lds
s_add_u32 s64,s74,229376
s_add_u32 m0,s75,8192
s_nop 0
buffer_load_dwordx4 v8,s[32:35],s64 offen nt lds
s_add_u32 s64,s74,258048
s_add_u32 m0,s75,9216
s_nop 0
buffer_load_dwordx4 v9,s[32:35],s64 offen nt lds
s_add_u32 s64,s74,286720
s_add_u32 m0,s75,10240
s_nop 0
buffer_load_dwordx4 v8,s[32:35],s64 offen nt lds
s_add_u32 s64,s74,315392
s_add_u32 m0,s75,11264
s_nop 0
buffer_load_dwordx4 v9,s[32:35],s64 offen nt lds
s_add_u32 s64,s74,344064
s_add_u32 m0,s75,12288
s_nop 0
buffer_load_dwordx4 v8,s[32:35],s64 offen nt lds
s_add_u32 s64,s74,372736
s_add_u32 m0,s75,13312
s_nop 0
buffer_load_dwordx4 v9,s[32:35],s64 offen nt lds
s_add_u32 s64,s74,401408
s_add_u32 m0,s75,14336
s_nop 0
buffer_load_dwordx4 v8,s[32:35],s64 offen nt lds
s_add_u32 s64,s74,430080
s_add_u32 m0,s75,15360
s_nop 0
buffer_load_dwordx4 v9,s[32:35],s64 offen nt lds
s_add_u32 s64,s74,1835008
s_add_u32 m0,s75,65536
s_nop 0
buffer_load_dwordx4 v8,s[32:35],s64 offen nt lds
s_add_u32 s64,s74,1863680
s_add_u32 m0,s75,66560
s_nop 0
buffer_load_dwordx4 v9,s[32:35],s64 offen nt lds
s_add_u32 s64,s74,1892352
s_add_u32 m0,s75,67584
s_nop 0
buffer_load_dwordx4 v8,s[32:35],s64 offen nt lds
s_add_u32 s64,s74,1921024
s_add_u32 m0,s75,68608
s_nop 0
buffer_load_dwordx4 v9,s[32:35],s64 offen nt lds
s_add_u32 s64,s74,1949696
s_add_u32 m0,s75,69632
s_nop 0
buffer_load_dwordx4 v8,s[32:35],s64 offen nt lds
s_add_u32 s64,s74,1978368
s_add_u32 m0,s75,70656
s_nop 0
buffer_load_dwordx4 v9,s[32:35],s64 offen nt lds
s_add_u32 s64,s74,2007040
s_add_u32 m0,s75,71680
s_nop 0
buffer_load_dwordx4 v8,s[32:35],s64 offen nt lds
s_add_u32 s64,s74,2035712
s_add_u32 m0,s75,72704
s_nop 0
buffer_load_dwordx4 v9,s[32:35],s64 offen nt lds
s_add_u32 s64,s74,2064384
s_add_u32 m0,s75,73728
s_nop 0
buffer_load_dwordx4 v8,s[32:35],s64 offen nt lds
s_add_u32 s64,s74,2093056
s_add_u32 m0,s75,74752
s_nop 0
buffer_load_dwordx4 v9,s[32:35],s64 offen nt lds
s_add_u32 s64,s74,2121728
s_add_u32 m0,s75,75776
s_nop 0
buffer_load_dwordx4 v8,s[32:35],s64 offen nt lds
s_add_u32 s64,s74,2150400
s_add_u32 m0,s75,76800
s_nop 0
buffer_load_dwordx4 v9,s[32:35],s64 offen nt lds
s_add_u32 s64,s74,2179072
s_add_u32 m0,s75,77824
s_nop 0
buffer_load_dwordx4 v8,s[32:35],s64 offen nt lds
s_add_u32 s64,s74,2207744
s_add_u32 m0,s75,78848
s_nop 0
buffer_load_dwordx4 v9,s[32:35],s64 offen nt lds
s_add_u32 s64,s74,2236416
s_add_u32 m0,s75,79872
s_nop 0
buffer_load_dwordx4 v8,s[32:35],s64 offen nt lds
s_add_u32 s64,s74,2265088
s_add_u32 m0,s75,80896
s_nop 0
buffer_load_dwordx4 v9,s[32:35],s64 offen nt lds
s_waitcnt vmcnt(16)
s_barrier
ds_read_b64_tr_b16 a[0:1],v12 offset:0
ds_read_b64_tr_b16 a[128:129],v13 offset:0
ds_read_b64_tr_b16 a[2:3],v12 offset:4096
ds_read_b64_tr_b16 a[130:131],v13 offset:4096
ds_read_b64_tr_b16 a[4:5],v12 offset:8192
ds_read_b64_tr_b16 a[132:133],v13 offset:8192
ds_read_b64_tr_b16 a[6:7],v12 offset:12288
ds_read_b64_tr_b16 a[134:135],v13 offset:12288
s_waitcnt lgkmcnt(4)
ds_read_b64_tr_b16 a[8:9],v12 offset:16384
ds_read_b64_tr_b16 a[136:137],v13 offset:16384
ds_read_b64_tr_b16 a[10:11],v12 offset:20480
ds_read_b64_tr_b16 a[138:139],v13 offset:20480
ds_read_b64_tr_b16 a[12:13],v12 offset:24576
ds_read_b64_tr_b16 a[140:141],v13 offset:24576
ds_read_b64_tr_b16 a[14:15],v12 offset:28672
ds_read_b64_tr_b16 a[142:143],v13 offset:28672
s_waitcnt lgkmcnt(4)
ds_read_b64_tr_b16 a[16:17],v12 offset:32768
ds_read_b64_tr_b16 a[144:145],v13 offset:32768
ds_read_b64_tr_b16 a[18:19],v12 offset:36864
ds_read_b64_tr_b16 a[146:147],v13 offset:36864
ds_read_b64_tr_b16 a[20:21],v12 offset:40960
ds_read_b64_tr_b16 a[148:149],v13 offset:40960
ds_read_b64_tr_b16 a[22:23],v12 offset:45056
ds_read_b64_tr_b16 a[150:151],v13 offset:45056
s_waitcnt lgkmcnt(4)
ds_read_b64_tr_b16 a[24:25],v12 offset:49152
ds_read_b64_tr_b16 a[152:153],v13 offset:49152
ds_read_b64_tr_b16 a[26:27],v12 offset:53248
ds_read_b64_tr_b16 a[154:155],v13 offset:53248
ds_read_b64_tr_b16 a[28:29],v12 offset:57344
ds_read_b64_tr_b16 a[156:157],v13 offset:57344
ds_read_b64_tr_b16 a[30:31],v12 offset:61440
ds_read_b64_tr_b16 a[158:159],v13 offset:61440
s_waitcnt lgkmcnt(4)
v_xor_b32 v12,0x10000,v12
v_xor_b32 v13,0x10000,v13
s_waitcnt lgkmcnt(0)
s_barrier
s_add_u32 s64,s74,3670016
s_add_u32 m0,s75,0
s_nop 0
buffer_load_dwordx4 v8,s[32:35],s64 offen nt lds
s_add_u32 s64,s74,3698688
s_add_u32 m0,s75,1024
s_nop 0
buffer_load_dwordx4 v9,s[32:35],s64 offen nt lds
s_add_u32 s64,s74,3727360
s_add_u32 m0,s75,2048
s_nop 0
buffer_load_dwordx4 v8,s[32:35],s64 offen nt lds
s_add_u32 s64,s74,3756032
s_add_u32 m0,s75,3072
s_nop 0
buffer_load_dwordx4 v9,s[32:35],s64 offen nt lds
s_add_u32 s64,s74,3784704
s_add_u32 m0,s75,4096
s_nop 0
buffer_load_dwordx4 v8,s[32:35],s64 offen nt lds
s_add_u32 s64,s74,3813376
s_add_u32 m0,s75,5120
s_nop 0
buffer_load_dwordx4 v9,s[32:35],s64 offen nt lds
s_add_u32 s64,s74,3842048
s_add_u32 m0,s75,6144
s_nop 0
buffer_load_dwordx4 v8,s[32:35],s64 offen nt lds
s_add_u32 s64,s74,3870720
s_add_u32 m0,s75,7168
s_nop 0
buffer_load_dwordx4 v9,s[32:35],s64 offen nt lds
s_add_u32 s64,s74,3899392
s_add_u32 m0,s75,8192
s_nop 0
buffer_load_dwordx4 v8,s[32:35],s64 offen nt lds
s_add_u32 s64,s74,3928064
s_add_u32 m0,s75,9216
s_nop 0
buffer_load_dwordx4 v9,s[32:35],s64 offen nt lds
s_add_u32 s64,s74,3956736
s_add_u32 m0,s75,10240
s_nop 0
buffer_load_dwordx4 v8,s[32:35],s64 offen nt lds
s_add_u32 s64,s74,3985408
s_add_u32 m0,s75,11264
s_nop 0
buffer_load_dwordx4 v9,s[32:35],s64 offen nt lds
s_add_u32 s64,s74,4014080
s_add_u32 m0,s75,12288
s_nop 0
buffer_load_dwordx4 v8,s[32:35],s64 offen nt lds
s_add_u32 s64,s74,4042752
s_add_u32 m0,s75,13312
s_nop 0
buffer_load_dwordx4 v9,s[32:35],s64 offen nt lds
s_add_u32 s64,s74,4071424
s_add_u32 m0,s75,14336
s_nop 0
buffer_load_dwordx4 v8,s[32:35],s64 offen nt lds
s_add_u32 s64,s74,4100096
s_add_u32 m0,s75,15360
s_nop 0
buffer_load_dwordx4 v9,s[32:35],s64 offen nt lds
s_waitcnt vmcnt(16)
s_barrier
ds_read_b64_tr_b16 a[32:33],v12 offset:0
ds_read_b64_tr_b16 a[160:161],v13 offset:0
ds_read_b64_tr_b16 a[34:35],v12 offset:4096
ds_read_b64_tr_b16 a[162:163],v13 offset:4096
ds_read_b64_tr_b16 a[36:37],v12 offset:8192
ds_read_b64_tr_b16 a[164:165],v13 offset:8192
ds_read_b64_tr_b16 a[38:39],v12 offset:12288
ds_read_b64_tr_b16 a[166:167],v13 offset:12288
s_waitcnt lgkmcnt(4)
ds_read_b64_tr_b16 a[40:41],v12 offset:16384
ds_read_b64_tr_b16 a[168:169],v13 offset:16384
ds_read_b64_tr_b16 a[42:43],v12 offset:20480
ds_read_b64_tr_b16 a[170:171],v13 offset:20480
ds_read_b64_tr_b16 a[44:45],v12 offset:24576
ds_read_b64_tr_b16 a[172:173],v13 offset:24576
ds_read_b64_tr_b16 a[46:47],v12 offset:28672
ds_read_b64_tr_b16 a[174:175],v13 offset:28672
s_waitcnt lgkmcnt(4)
ds_read_b64_tr_b16 a[48:49],v12 offset:32768
ds_read_b64_tr_b16 a[176:177],v13 offset:32768
ds_read_b64_tr_b16 a[50:51],v12 offset:36864
ds_read_b64_tr_b16 a[178:179],v13 offset:36864
ds_read_b64_tr_b16 a[52:53],v12 offset:40960
ds_read_b64_tr_b16 a[180:181],v13 offset:40960
ds_read_b64_tr_b16 a[54:55],v12 offset:45056
ds_read_b64_tr_b16 a[182:183],v13 offset:45056
s_waitcnt lgkmcnt(4)
ds_read_b64_tr_b16 a[56:57],v12 offset:49152
ds_read_b64_tr_b16 a[184:185],v13 offset:49152
ds_read_b64_tr_b16 a[58:59],v12 offset:53248
ds_read_b64_tr_b16 a[186:187],v13 offset:53248
ds_read_b64_tr_b16 a[60:61],v12 offset:57344
ds_read_b64_tr_b16 a[188:189],v13 offset:57344
ds_read_b64_tr_b16 a[62:63],v12 offset:61440
ds_read_b64_tr_b16 a[190:191],v13 offset:61440
s_waitcnt lgkmcnt(4)
v_xor_b32 v12,0x10000,v12
v_xor_b32 v13,0x10000,v13
s_waitcnt lgkmcnt(0)
s_barrier
s_add_u32 s64,s74,5505024
s_add_u32 m0,s75,65536
s_nop 0
buffer_load_dwordx4 v8,s[32:35],s64 offen nt lds
s_add_u32 s64,s74,5533696
s_add_u32 m0,s75,66560
s_nop 0
buffer_load_dwordx4 v9,s[32:35],s64 offen nt lds
s_add_u32 s64,s74,5562368
s_add_u32 m0,s75,67584
s_nop 0
buffer_load_dwordx4 v8,s[32:35],s64 offen nt lds
s_add_u32 s64,s74,5591040
s_add_u32 m0,s75,68608
s_nop 0
buffer_load_dwordx4 v9,s[32:35],s64 offen nt lds
s_add_u32 s64,s74,5619712
s_add_u32 m0,s75,69632
s_nop 0
buffer_load_dwordx4 v8,s[32:35],s64 offen nt lds
s_add_u32 s64,s74,5648384
s_add_u32 m0,s75,70656
s_nop 0
buffer_load_dwordx4 v9,s[32:35],s64 offen nt lds
s_add_u32 s64,s74,5677056
s_add_u32 m0,s75,71680
s_nop 0
buffer_load_dwordx4 v8,s[32:35],s64 offen nt lds
s_add_u32 s64,s74,5705728
s_add_u32 m0,s75,72704
s_nop 0
buffer_load_dwordx4 v9,s[32:35],s64 offen nt lds
s_add_u32 s64,s74,5734400
s_add_u32 m0,s75,73728
s_nop 0
buffer_load_dwordx4 v8,s[32:35],s64 offen nt lds
s_add_u32 s64,s74,5763072
s_add_u32 m0,s75,74752
s_nop 0
buffer_load_dwordx4 v9,s[32:35],s64 offen nt lds
s_add_u32 s64,s74,5791744
s_add_u32 m0,s75,75776
s_nop 0
buffer_load_dwordx4 v8,s[32:35],s64 offen nt lds
s_add_u32 s64,s74,5820416
s_add_u32 m0,s75,76800
s_nop 0
buffer_load_dwordx4 v9,s[32:35],s64 offen nt lds
s_add_u32 s64,s74,5849088
s_add_u32 m0,s75,77824
s_nop 0
buffer_load_dwordx4 v8,s[32:35],s64 offen nt lds
s_add_u32 s64,s74,5877760
s_add_u32 m0,s75,78848
s_nop 0
buffer_load_dwordx4 v9,s[32:35],s64 offen nt lds
s_add_u32 s64,s74,5906432
s_add_u32 m0,s75,79872
s_nop 0
buffer_load_dwordx4 v8,s[32:35],s64 offen nt lds
s_add_u32 s64,s74,5935104
s_add_u32 m0,s75,80896
s_nop 0
buffer_load_dwordx4 v9,s[32:35],s64 offen nt lds
s_waitcnt vmcnt(16)
s_barrier
ds_read_b64_tr_b16 a[64:65],v12 offset:0
ds_read_b64_tr_b16 a[192:193],v13 offset:0
ds_read_b64_tr_b16 a[66:67],v12 offset:4096
ds_read_b64_tr_b16 a[194:195],v13 offset:4096
ds_read_b64_tr_b16 a[68:69],v12 offset:8192
ds_read_b64_tr_b16 a[196:197],v13 offset:8192
ds_read_b64_tr_b16 a[70:71],v12 offset:12288
ds_read_b64_tr_b16 a[198:199],v13 offset:12288
s_waitcnt lgkmcnt(4)
ds_read_b64_tr_b16 a[72:73],v12 offset:16384
ds_read_b64_tr_b16 a[200:201],v13 offset:16384
ds_read_b64_tr_b16 a[74:75],v12 offset:20480
ds_read_b64_tr_b16 a[202:203],v13 offset:20480
ds_read_b64_tr_b16 a[76:77],v12 offset:24576
ds_read_b64_tr_b16 a[204:205],v13 offset:24576
ds_read_b64_tr_b16 a[78:79],v12 offset:28672
ds_read_b64_tr_b16 a[206:207],v13 offset:28672
s_waitcnt lgkmcnt(4)
ds_read_b64_tr_b16 a[80:81],v12 offset:32768
ds_read_b64_tr_b16 a[208:209],v13 offset:32768
ds_read_b64_tr_b16 a[82:83],v12 offset:36864
ds_read_b64_tr_b16 a[210:211],v13 offset:36864
ds_read_b64_tr_b16 a[84:85],v12 offset:40960
ds_read_b64_tr_b16 a[212:213],v13 offset:40960
ds_read_b64_tr_b16 a[86:87],v12 offset:45056
ds_read_b64_tr_b16 a[214:215],v13 offset:45056
s_waitcnt lgkmcnt(4)
ds_read_b64_tr_b16 a[88:89],v12 offset:49152
ds_read_b64_tr_b16 a[216:217],v13 offset:49152
ds_read_b64_tr_b16 a[90:91],v12 offset:53248
ds_read_b64_tr_b16 a[218:219],v13 offset:53248
ds_read_b64_tr_b16 a[92:93],v12 offset:57344
ds_read_b64_tr_b16 a[220:221],v13 offset:57344
ds_read_b64_tr_b16 a[94:95],v12 offset:61440
ds_read_b64_tr_b16 a[222:223],v13 offset:61440
s_waitcnt lgkmcnt(4)
v_xor_b32 v12,0x10000,v12
v_xor_b32 v13,0x10000,v13
s_waitcnt lgkmcnt(0)
s_barrier
s_waitcnt vmcnt(0)
s_barrier
ds_read_b64_tr_b16 a[96:97],v12 offset:0
ds_read_b64_tr_b16 a[224:225],v13 offset:0
ds_read_b64_tr_b16 a[98:99],v12 offset:4096
ds_read_b64_tr_b16 a[226:227],v13 offset:4096
ds_read_b64_tr_b16 a[100:101],v12 offset:8192
ds_read_b64_tr_b16 a[228:229],v13 offset:8192
ds_read_b64_tr_b16 a[102:103],v12 offset:12288
ds_read_b64_tr_b16 a[230:231],v13 offset:12288
s_waitcnt lgkmcnt(4)
ds_read_b64_tr_b16 a[104:105],v12 offset:16384
ds_read_b64_tr_b16 a[232:233],v13 offset:16384
ds_read_b64_tr_b16 a[106:107],v12 offset:20480
ds_read_b64_tr_b16 a[234:235],v13 offset:20480
ds_read_b64_tr_b16 a[108:109],v12 offset:24576
ds_read_b64_tr_b16 a[236:237],v13 offset:24576
ds_read_b64_tr_b16 a[110:111],v12 offset:28672
ds_read_b64_tr_b16 a[238:239],v13 offset:28672
s_waitcnt lgkmcnt(4)
ds_read_b64_tr_b16 a[112:113],v12 offset:32768
ds_read_b64_tr_b16 a[240:241],v13 offset:32768
ds_read_b64_tr_b16 a[114:115],v12 offset:36864
ds_read_b64_tr_b16 a[242:243],v13 offset:36864
ds_read_b64_tr_b16 a[116:117],v12 offset:40960
ds_read_b64_tr_b16 a[244:245],v13 offset:40960
ds_read_b64_tr_b16 a[118:119],v12 offset:45056
ds_read_b64_tr_b16 a[246:247],v13 offset:45056
s_waitcnt lgkmcnt(4)
ds_read_b64_tr_b16 a[120:121],v12 offset:49152
ds_read_b64_tr_b16 a[248:249],v13 offset:49152
ds_read_b64_tr_b16 a[122:123],v12 offset:53248
ds_read_b64_tr_b16 a[250:251],v13 offset:53248
ds_read_b64_tr_b16 a[124:125],v12 offset:57344
ds_read_b64_tr_b16 a[252:253],v13 offset:57344
ds_read_b64_tr_b16 a[126:127],v12 offset:61440
ds_read_b64_tr_b16 a[254:255],v13 offset:61440
s_waitcnt lgkmcnt(4)
v_xor_b32 v12,0x10000,v12
v_xor_b32 v13,0x10000,v13
s_waitcnt lgkmcnt(0)
s_barrier
v_mov_b32 v88,0x3f803f80
v_mov_b32 v89,0x3f803f80
v_mov_b32 v90,0x3f803f80
v_mov_b32 v91,0x3f803f80
s_nop 1
v_mfma_f32_16x16x32_bf16 v[52:55],a[0:3],v[88:91],0
v_mfma_f32_16x16x32_bf16 v[56:59],a[128:131],v[88:91],0
v_mfma_f32_16x16x32_bf16 v[52:55],a[4:7],v[88:91],v[52:55]
v_mfma_f32_16x16x32_bf16 v[56:59],a[132:135],v[88:91],v[56:59]
v_mfma_f32_16x16x32_bf16 v[52:55],a[8:11],v[88:91],v[52:55]
v_mfma_f32_16x16x32_bf16 v[56:59],a[136:139],v[88:91],v[56:59]
v_mfma_f32_16x16x32_bf16 v[52:55],a[12:15],v[88:91],v[52:55]
v_mfma_f32_16x16x32_bf16 v[56:59],a[140:143],v[88:91],v[56:59]
v_mfma_f32_16x16x32_bf16 v[52:55],a[16:19],v[88:91],v[52:55]
v_mfma_f32_16x16x32_bf16 v[56:59],a[144:147],v[88:91],v[56:59]
v_mfma_f32_16x16x32_bf16 v[52:55],a[20:23],v[88:91],v[52:55]
v_mfma_f32_16x16x32_bf16 v[56:59],a[148:151],v[88:91],v[56:59]
v_mfma_f32_16x16x32_bf16 v[52:55],a[24:27],v[88:91],v[52:55]
v_mfma_f32_16x16x32_bf16 v[56:59],a[152:155],v[88:91],v[56:59]
v_mfma_f32_16x16x32_bf16 v[52:55],a[28:31],v[88:91],v[52:55]
v_mfma_f32_16x16x32_bf16 v[56:59],a[156:159],v[88:91],v[56:59]
v_mfma_f32_16x16x32_bf16 v[52:55],a[32:35],v[88:91],v[52:55]
v_mfma_f32_16x16x32_bf16 v[56:59],a[160:163],v[88:91],v[56:59]
v_mfma_f32_16x16x32_bf16 v[52:55],a[36:39],v[88:91],v[52:55]
v_mfma_f32_16x16x32_bf16 v[56:59],a[164:167],v[88:91],v[56:59]
v_mfma_f32_16x16x32_bf16 v[52:55],a[40:43],v[88:91],v[52:55]
v_mfma_f32_16x16x32_bf16 v[56:59],a[168:171],v[88:91],v[56:59]
v_mfma_f32_16x16x32_bf16 v[52:55],a[44:47],v[88:91],v[52:55]
v_mfma_f32_16x16x32_bf16 v[56:59],a[172:175],v[88:91],v[56:59]
v_mfma_f32_16x16x32_bf16 v[52:55],a[48:51],v[88:91],v[52:55]
v_mfma_f32_16x16x32_bf16 v[56:59],a[176:179],v[88:91],v[56:59]
v_mfma_f32_16x16x32_bf16 v[52:55],a[52:55],v[88:91],v[52:55]
v_mfma_f32_16x16x32_bf16 v[56:59],a[180:183],v[88:91],v[56:59]
v_mfma_f32_16x16x32_bf16 v[52:55],a[56:59],v[88:91],v[52:55]
v_mfma_f32_16x16x32_bf16 v[56:59],a[184:187],v[88:91],v[56:59]
v_mfma_f32_16x16x32_bf16 v[52:55],a[60:63],v[88:91],v[52:55]
v_mfma_f32_16x16x32_bf16 v[56:59],a[188:191],v[88:91],v[56:59]
v_mfma_f32_16x16x32_bf16 v[52:55],a[64:67],v[88:91],v[52:55]
v_mfma_f32_16x16x32_bf16 v[56:59],a[192:195],v[88:91],v[56:59]
v_mfma_f32_16x16x32_bf16 v[52:55],a[68:71],v[88:91],v[52:55]
v_mfma_f32_16x16x32_bf16 v[56:59],a[196:199],v[88:91],v[56:59]
v_mfma_f32_16x16x32_bf16 v[52:55],a[72:75],v[88:91],v[52:55]
v_mfma_f32_16x16x32_bf16 v[56:59],a[200:203],v[88:91],v[56:59]
v_mfma_f32_16x16x32_bf16 v[52:55],a[76:79],v[88:91],v[52:55]
v_mfma_f32_16x16x32_bf16 v[56:59],a[204:207],v[88:91],v[56:59]
v_mfma_f32_16x16x32_bf16 v[52:55],a[80:83],v[88:91],v[52:55]
v_mfma_f32_16x16x32_bf16 v[56:59],a[208:211],v[88:91],v[56:59]
v_mfma_f32_16x16x32_bf16 v[52:55],a[84:87],v[88:91],v[52:55]
v_mfma_f32_16x16x32_bf16 v[56:59],a[212:215],v[88:91],v[56:59]
v_mfma_f32_16x16x32_bf16 v[52:55],a[88:91],v[88:91],v[52:55]
v_mfma_f32_16x16x32_bf16 v[56:59],a[216:219],v[88:91],v[56:59]
v_mfma_f32_16x16x32_bf16 v[52:55],a[92:95],v[88:91],v[52:55]
v_mfma_f32_16x16x32_bf16 v[56:59],a[220:223],v[88:91],v[56:59]
v_mfma_f32_16x16x32_bf16 v[52:55],a[96:99],v[88:91],v[52:55]
v_mfma_f32_16x16x32_bf16 v[56:59],a[224:227],v[88:91],v[56:59]
v_mfma_f32_16x16x32_bf16 v[52:55],a[100:103],v[88:91],v[52:55]
v_mfma_f32_16x16x32_bf16 v[56:59],a[228:231],v[88:91],v[56:59]
v_mfma_f32_16x16x32_bf16 v[52:55],a[104:107],v[88:91],v[52:55]
v_mfma_f32_16x16x32_bf16 v[56:59],a[232:235],v[88:91],v[56:59]
v_mfma_f32_16x16x32_bf16 v[52:55],a[108:111],v[88:91],v[52:55]
v_mfma_f32_16x16x32_bf16 v[56:59],a[236:239],v[88:91],v[56:59]
v_mfma_f32_16x16x32_bf16 v[52:55],a[112:115],v[88:91],v[52:55]
v_mfma_f32_16x16x32_bf16 v[56:59],a[240:243],v[88:91],v[56:59]
v_mfma_f32_16x16x32_bf16 v[52:55],a[116:119],v[88:91],v[52:55]
v_mfma_f32_16x16x32_bf16 v[56:59],a[244:247],v[88:91],v[56:59]
v_mfma_f32_16x16x32_bf16 v[52:55],a[120:123],v[88:91],v[52:55]
v_mfma_f32_16x16x32_bf16 v[56:59],a[248:251],v[88:91],v[56:59]
v_mfma_f32_16x16x32_bf16 v[52:55],a[124:127],v[88:91],v[52:55]
v_mfma_f32_16x16x32_bf16 v[56:59],a[252:255],v[88:91],v[56:59]
v_and_b32 v21,1,v1
v_mul_u32_u24 v21,960,v21
s_mov_b32 s65,21052032
s_mov_b32 s66,1792
pl_374:
buffer_load_dword v22,v21,s[20:23],s65 offen sc1
s_waitcnt vmcnt(0)
v_cmp_gt_u32 vcc,s66,v22
s_cbranch_vccz pok_375
s_sleep 1
s_sub_u32 s90,s90,1
s_cmp_gt_i32 s90,0
s_cbranch_scc1 pl_374
pok_375:
s_mov_b32 s81,0xbdd2d3e8
v_mov_b32 v28,0xc0135761
s_lshr_b32 s41,s59,3
s_and_b32 s42,s59,7
s_mul_i32 s64,s42,3
s_add_u32 s64,s64,s50
s_lshr_b32 s65,s42,1
s_add_u32 s65,s65,24
s_cmp_eq_u32 s50,3
s_cselect_b32 s64,s65,s64
s_and_b32 s65,s42,1
s_lshl_b32 s65,s65,3
s_cmp_eq_u32 s50,3
s_cselect_b32 s65,s65,0
s_and_b32 s66,s64,3
s_lshl_b32 s66,s66,11
s_add_u32 s65,s65,s66
s_lshr_b32 s64,s64,2
s_mul_i32 s66,s41,7
s_add_u32 s64,s64,s66
s_add_u32 s64,s64,81
s_lshl_b32 s64,s64,14
s_add_u32 s64,s64,s65
v_add_u32 v18,s64,v16
v_mov_b32 v17,v16
v_lshlrev_b32 v19,4,v3
v_add_u32 v19,131072,v19
v_and_b32 v21,7,v1
v_lshlrev_b32 v21,7,v21
v_bfe_u32 v6,v1,3,2
v_lshl_add_u32 v21,v6,2,v21
s_add_u32 s74,s63,6144
s_add_u32 s74,s74,s60
s_lshl_b32 s73,s59,7
s_lshl_b32 s64,s50,2
s_add_u32 s73,s73,s64
s_add_u32 s73,s73,s63
s_add_u32 s73,s73,20480
s_lshl_b32 s64,s60,4
s_add_u32 s73,s73,s64
s_mov_b32 s82,0x3a800000
s_mov_b32 s64,0
s_lshr_b32 s65,s50,1
s_and_b32 s66,s50,1
s_lshl_b32 s66,s66,12
s_add_u32 s66,s66,s64
s_lshl_b32 s72,s65,13
s_add_u32 s72,s72,s66
s_add_u32 s72,s72,0x10000
s_lshl_b32 s65,s65,14
s_add_u32 s75,s65,s66
s_add_u32 s75,s75,1179648
s_cmp_eq_u32 s50,3
s_cbranch_scc1 w3b_376
s_add_u32 s64,s79,0
s_lshl_b32 s70,s64,21
s_lshl_b32 s64,s64,13
s_and_b32 s64,s64,0x2000
s_xor_b32 s64,s64,s62
s_add_u32 s70,s70,s64
s_add_u32 s70,s70,29360128
s_mov_b32 s83,1
s_mov_b32 s87,s74
s_cmp_eq_u32 s50,0
s_cselect_b32 s74,s74,0x7fff0000
v_mov_b32 v47,132096
s_lshl_b32 s64,s50,3
s_add_u32 s64,s64,132096
v_mov_b32 v46,s64
v_mov_b32 v29,0
s_mov_b32 s97,0x7fff0000
s_mov_b32 s69,1
s_mov_b32 s68,0
s_mov_b32 s52,0x30003
s_mov_b32 s53,s52
seg_378:
s_cmp_eq_u32 s83,0
s_cbranch_scc1 ahead_379
s_add_u32 s94,s70,s75
s_xor_b32 s95,s94,1024
s_xor_b32 s91,s72,0x10000
s_cmp_eq_u32 s69,0
s_mov_b32 s69,1
s_cbranch_scc1 half2_383
s_waitcnt vmcnt(2)
v_cmp_gt_u32 vcc,s71,v29
s_cbranch_vccz nb_382
s_waitcnt vmcnt(0)
v_add_u32 v22,s71,-1
buffer_store_dword v22,v23,s[20:23],s97 offen sc1
s_mov_b32 s97,0x7fff0000
s_cmp_lg_u32 s50,0
s_cbranch_scc1 nb_382
buffer_load_dword v32,v21,s[20:23],s74 offen sc1
s_sleep 2
pl_384:
buffer_load_dword v33,v21,s[20:23],s74 offen sc1
s_waitcnt vmcnt(1)
v_cmp_gt_u32 vcc,s71,v32
v_mov_b32 v29,v32
s_cbranch_vccz pok_385
buffer_load_dword v32,v21,s[20:23],s74 offen sc1
s_waitcnt vmcnt(1)
v_cmp_gt_u32 vcc,s71,v33
v_mov_b32 v29,v33
s_cbranch_vccz pok_385
s_sub_u32 s90,s90,1
s_cmp_gt_i32 s90,0
s_cbranch_scc1 pl_384
pok_385:
nb_382:
s_cmp_eq_u32 s71,64
s_barrier
s_cbranch_scc1 half_386
s_xor_b32 m0,s91,0
s_add_u32 s65,s94,0
buffer_load_dwordx4 v16,s[20:23],s65 offen offset:0 sc1 lds
buffer_load_dwordx4 v16,s[20:23],s65 offen offset:2048 sc1 lds
s_xor_b32 m0,s91,16384
s_add_u32 s65,s94,32768
buffer_load_dwordx4 v16,s[20:23],s65 offen offset:0 sc1 lds
buffer_load_dwordx4 v16,s[20:23],s65 offen offset:2048 sc1 lds
s_xor_b32 m0,s91,32768
s_add_u32 s65,s94,65536
buffer_load_dwordx4 v16,s[20:23],s65 offen offset:0 sc1 lds
buffer_load_dwordx4 v16,s[20:23],s65 offen offset:2048 sc1 lds
s_xor_b32 m0,s91,49152
s_add_u32 s65,s94,98304
buffer_load_dwordx4 v16,s[20:23],s65 offen offset:0 sc1 lds
buffer_load_dwordx4 v16,s[20:23],s65 offen offset:2048 sc1 lds
s_waitcnt vmcnt(8)
v_add_u32 v22,s71,-1
buffer_store_dword v22,v23,s[20:23],s97 offen sc1
s_mov_b32 s97,0x7fff0000
s_waitcnt vmcnt(7)
s_barrier
ds_read_b128 v[224:227],v17 offset:0
ds_read_b128 v[228:231],v17 offset:2048
ds_read_b128 v[232:235],v17 offset:4096
ds_read_b128 v[236:239],v17 offset:6144
ds_read_b128 v[240:243],v17 offset:8192
ds_read_b128 v[244:247],v17 offset:10240
ds_read_b128 v[248:251],v17 offset:12288
s_waitcnt lgkmcnt(5)
v_mfma_f32_16x16x32_bf16 v[64:67],a[0:3],v[224:227],0
s_xor_b32 m0,s91,1024
s_add_u32 s96,s71,1
s_add_u32 s92,s71,2
v_min_u32 v27,v224,v228
v_mfma_f32_16x16x32_bf16 v[72:75],a[128:131],v[224:227],0
ds_read_b128 v[252:255],v17 offset:14336
s_cmp_eq_u32 s96,64
s_cselect_b32 s96,99,s96
v_mfma_f32_16x16x32_bf16 v[64:67],a[4:7],v[228:231],v[64:67]
s_add_u32 s65,s95,0
s_cmp_eq_u32 s92,64
s_cselect_b32 s92,99,s92
v_mfma_f32_16x16x32_bf16 v[72:75],a[132:135],v[228:231],v[72:75]
s_waitcnt vmcnt(5)
s_barrier
ds_read_b128 v[224:227],v17 offset:16384
s_waitcnt lgkmcnt(5)
v_mfma_f32_16x16x32_bf16 v[64:67],a[8:11],v[232:235],v[64:67]
buffer_load_dwordx4 v16,s[20:23],s65 offen offset:0 sc1 lds
v_mfma_f32_16x16x32_bf16 v[72:75],a[136:139],v[232:235],v[72:75]
ds_read_b128 v[228:231],v17 offset:18432
v_min3_u32 v27,v27,v232,v236
v_mfma_f32_16x16x32_bf16 v[64:67],a[12:15],v[236:239],v[64:67]
buffer_load_dwordx4 v16,s[20:23],s65 offen offset:2048 sc1 lds
v_mfma_f32_16x16x32_bf16 v[72:75],a[140:143],v[236:239],v[72:75]
ds_read_b128 v[232:235],v17 offset:20480
s_waitcnt lgkmcnt(5)
v_mfma_f32_16x16x32_bf16 v[64:67],a[16:19],v[240:243],v[64:67]
s_xor_b32 m0,s91,17408
v_min3_u32 v27,v27,v240,v244
v_mfma_f32_16x16x32_bf16 v[72:75],a[144:147],v[240:243],v[72:75]
ds_read_b128 v[236:239],v17 offset:22528
v_mfma_f32_16x16x32_bf16 v[64:67],a[20:23],v[244:247],v[64:67]
s_add_u32 s65,s95,32768
v_mfma_f32_16x16x32_bf16 v[72:75],a[148:151],v[244:247],v[72:75]
ds_read_b128 v[240:243],v17 offset:24576
s_waitcnt lgkmcnt(5)
v_mfma_f32_16x16x32_bf16 v[64:67],a[24:27],v[248:251],v[64:67]
buffer_load_dwordx4 v16,s[20:23],s65 offen offset:0 sc1 lds
v_mfma_f32_16x16x32_bf16 v[72:75],a[152:155],v[248:251],v[72:75]
ds_read_b128 v[244:247],v17 offset:26624
v_min3_u32 v27,v27,v248,v252
v_mfma_f32_16x16x32_bf16 v[64:67],a[28:31],v[252:255],v[64:67]
buffer_load_dwordx4 v16,s[20:23],s65 offen offset:2048 sc1 lds
v_mfma_f32_16x16x32_bf16 v[72:75],a[156:159],v[252:255],v[72:75]
ds_read_b128 v[248:251],v17 offset:28672
s_waitcnt lgkmcnt(5)
v_mfma_f32_16x16x32_bf16 v[64:67],a[32:35],v[224:227],v[64:67]
s_xor_b32 m0,s91,33792
v_min3_u32 v27,v27,v224,v228
v_mfma_f32_16x16x32_bf16 v[72:75],a[160:163],v[224:227],v[72:75]
ds_read_b128 v[252:255],v17 offset:30720
v_mfma_f32_16x16x32_bf16 v[64:67],a[36:39],v[228:231],v[64:67]
s_add_u32 s65,s95,65536
v_mfma_f32_16x16x32_bf16 v[72:75],a[164:167],v[228:231],v[72:75]
s_waitcnt vmcnt(5)
s_barrier
ds_read_b128 v[224:227],v17 offset:32768
s_waitcnt lgkmcnt(5)
v_mfma_f32_16x16x32_bf16 v[64:67],a[40:43],v[232:235],v[64:67]
buffer_load_dwordx4 v16,s[20:23],s65 offen offset:0 sc1 lds
v_mfma_f32_16x16x32_bf16 v[72:75],a[168:171],v[232:235],v[72:75]
ds_read_b128 v[228:231],v17 offset:34816
v_min3_u32 v27,v27,v232,v236
v_mfma_f32_16x16x32_bf16 v[64:67],a[44:47],v[236:239],v[64:67]
buffer_load_dwordx4 v16,s[20:23],s65 offen offset:2048 sc1 lds
v_mfma_f32_16x16x32_bf16 v[72:75],a[172:175],v[236:239],v[72:75]
ds_read_b128 v[232:235],v17 offset:36864
s_waitcnt lgkmcnt(5)
v_mfma_f32_16x16x32_bf16 v[64:67],a[48:51],v[240:243],v[64:67]
s_xor_b32 m0,s91,50176
v_min3_u32 v27,v27,v240,v244
v_mfma_f32_16x16x32_bf16 v[72:75],a[176:179],v[240:243],v[72:75]
ds_read_b128 v[236:239],v17 offset:38912
v_mfma_f32_16x16x32_bf16 v[64:67],a[52:55],v[244:247],v[64:67]
s_add_u32 s65,s95,98304
v_mfma_f32_16x16x32_bf16 v[72:75],a[180:183],v[244:247],v[72:75]
ds_read_b128 v[240:243],v17 offset:40960
s_waitcnt lgkmcnt(5)
v_mfma_f32_16x16x32_bf16 v[64:67],a[56:59],v[248:251],v[64:67]
buffer_load_dwordx4 v16,s[20:23],s65 offen offset:0 sc1 lds
v_min3_u32 v27,v27,v248,v252
v_mfma_f32_16x16x32_bf16 v[72:75],a[184:187],v[248:251],v[72:75]
ds_read_b128 v[244:247],v17 offset:43008
s_waitcnt vmcnt(63)
v_mfma_f32_16x16x32_bf16 v[64:67],a[60:63],v[252:255],v[64:67]
buffer_load_dwordx4 v16,s[20:23],s65 offen offset:2048 sc1 lds
v_mfma_f32_16x16x32_bf16 v[72:75],a[188:191],v[252:255],v[72:75]
ds_read_b128 v[248:251],v17 offset:45056
s_waitcnt lgkmcnt(5)
v_mfma_f32_16x16x32_bf16 v[64:67],a[64:67],v[224:227],v[64:67]
v_cmp_gt_u32 vcc,s96,v29
v_cmp_gt_u32 s[92:93],s92,v29
v_mfma_f32_16x16x32_bf16 v[72:75],a[192:195],v[224:227],v[72:75]
ds_read_b128 v[252:255],v17 offset:47104
v_min3_u32 v27,v27,v224,v228
v_mfma_f32_16x16x32_bf16 v[64:67],a[68:71],v[228:231],v[64:67]
v_mov_b32 v44,vcc_lo
v_mov_b32 v45,s92
v_mfma_f32_16x16x32_bf16 v[72:75],a[196:199],v[228:231],v[72:75]
ds_read_b128 v[224:227],v17 offset:49152
s_waitcnt lgkmcnt(5)
v_mfma_f32_16x16x32_bf16 v[64:67],a[72:75],v[232:235],v[64:67]
ds_write_b64 v46,v[44:45]
v_min3_u32 v27,v27,v232,v236
v_mfma_f32_16x16x32_bf16 v[72:75],a[200:203],v[232:235],v[72:75]
ds_read_b128 v[228:231],v17 offset:51200
v_mfma_f32_16x16x32_bf16 v[64:67],a[76:79],v[236:239],v[64:67]
v_mfma_f32_16x16x32_bf16 v[72:75],a[204:207],v[236:239],v[72:75]
ds_read_b128 v[232:235],v17 offset:53248
s_waitcnt lgkmcnt(6)
v_mfma_f32_16x16x32_bf16 v[64:67],a[80:83],v[240:243],v[64:67]
v_min3_u32 v27,v27,v240,v244
s_add_u32 s88,s70,s75
v_mfma_f32_16x16x32_bf16 v[72:75],a[208:211],v[240:243],v[72:75]
ds_read_b128 v[236:239],v17 offset:55296
s_add_u32 s88,s88,2097152
v_mfma_f32_16x16x32_bf16 v[64:67],a[84:87],v[244:247],v[64:67]
s_xor_b32 s88,s88,0x2000
s_xor_b32 s89,s88,1024
v_mfma_f32_16x16x32_bf16 v[72:75],a[212:215],v[244:247],v[72:75]
ds_read_b128 v[240:243],v17 offset:57344
s_waitcnt lgkmcnt(6)
v_mfma_f32_16x16x32_bf16 v[64:67],a[88:91],v[248:251],v[64:67]
v_min3_u32 v27,v27,v248,v252
v_mfma_f32_16x16x32_bf16 v[72:75],a[216:219],v[248:251],v[72:75]
ds_read_b128 v[244:247],v17 offset:59392
v_mfma_f32_16x16x32_bf16 v[64:67],a[92:95],v[252:255],v[64:67]
v_mfma_f32_16x16x32_bf16 v[72:75],a[220:223],v[252:255],v[72:75]
ds_read_b128 v[248:251],v17 offset:61440
s_waitcnt lgkmcnt(5)
v_mfma_f32_16x16x32_bf16 v[64:67],a[96:99],v[224:227],v[64:67]
v_min3_u32 v27,v27,v224,v228
v_mfma_f32_16x16x32_bf16 v[72:75],a[224:227],v[224:227],v[72:75]
ds_read_b128 v[252:255],v17 offset:63488
v_mfma_f32_16x16x32_bf16 v[64:67],a[100:103],v[228:231],v[64:67]
v_mfma_f32_16x16x32_bf16 v[72:75],a[228:231],v[228:231],v[72:75]
s_waitcnt vmcnt(4)
s_barrier
ds_read_b64 v[44:45],v47
ds_read_b128 v[224:227],v17 offset:1024
s_waitcnt lgkmcnt(6)
v_mfma_f32_16x16x32_bf16 v[64:67],a[104:107],v[232:235],v[64:67]
v_min3_u32 v27,v27,v232,v236
ds_read_b128 v[124:127],v19 offset:256
v_mfma_f32_16x16x32_bf16 v[72:75],a[232:235],v[232:235],v[72:75]
ds_read_b128 v[228:231],v17 offset:3072
ds_read_b128 v[120:123],v19 offset:0
v_mfma_f32_16x16x32_bf16 v[64:67],a[108:111],v[236:239],v[64:67]
v_mfma_f32_16x16x32_bf16 v[72:75],a[236:239],v[236:239],v[72:75]
ds_read_b128 v[232:235],v17 offset:5120
s_waitcnt lgkmcnt(8)
v_mfma_f32_16x16x32_bf16 v[64:67],a[112:115],v[240:243],v[64:67]
v_min3_u32 v27,v27,v240,v244
v_mfma_f32_16x16x32_bf16 v[72:75],a[240:243],v[240:243],v[72:75]
ds_read_b128 v[236:239],v17 offset:7168
v_mfma_f32_16x16x32_bf16 v[64:67],a[116:119],v[244:247],v[64:67]
v_mfma_f32_16x16x32_bf16 v[72:75],a[244:247],v[244:247],v[72:75]
ds_read_b128 v[240:243],v17 offset:9216
s_waitcnt lgkmcnt(8)
v_mfma_f32_16x16x32_bf16 v[64:67],a[120:123],v[248:251],v[64:67]
s_waitcnt lgkmcnt(7)
v_readfirstlane_b32 s93,v45
v_mfma_f32_16x16x32_bf16 v[72:75],a[248:251],v[248:251],v[72:75]
ds_read_b128 v[244:247],v17 offset:11264
v_readfirstlane_b32 s83,v44
s_cmp_lg_u32 s83,0
s_cbranch_scc0 keep_388
v_mfma_f32_16x16x32_bf16 v[64:67],a[124:127],v[252:255],v[64:67]
v_min3_u32 v27,v27,v248,v252
v_mfma_f32_16x16x32_bf16 v[72:75],a[252:255],v[252:255],v[72:75]
ds_read_b128 v[248:251],v17 offset:13312
s_waitcnt lgkmcnt(6)
v_mfma_f32_16x16x32_bf16 v[68:71],a[0:3],v[224:227],0
v_cmp_eq_u32 vcc,0,v27
s_cbranch_vccnz retry_377
v_mfma_f32_16x16x32_bf16 v[76:79],a[128:131],v[224:227],0
ds_read_b128 v[252:255],v17 offset:15360
v_min3_u32 v27,v27,v224,v228
v_mfma_f32_16x16x32_bf16 v[68:71],a[4:7],v[228:231],v[68:71]
s_waitcnt lgkmcnt(6)
v_mfma_f32_16x16x32_bf16 v[76:79],a[132:135],v[228:231],v[76:79]
ds_read_b128 v[224:227],v17 offset:17408
s_waitcnt lgkmcnt(5)
v_mfma_f32_16x16x32_bf16 v[68:71],a[8:11],v[232:235],v[68:71]
v_min3_u32 v27,v27,v232,v236
v_fmac_f32 v64,v52,v120
v_fmac_f32 v72,v56,v120
v_mfma_f32_16x16x32_bf16 v[76:79],a[136:139],v[232:235],v[76:79]
ds_read_b128 v[228:231],v17 offset:19456
v_fmac_f32 v65,v53,v120
v_fmac_f32 v73,v57,v120
v_mfma_f32_16x16x32_bf16 v[68:71],a[12:15],v[236:239],v[68:71]
v_fmac_f32 v66,v54,v120
v_fmac_f32 v67,v55,v120
v_fmac_f32 v74,v58,v120
v_mfma_f32_16x16x32_bf16 v[76:79],a[140:143],v[236:239],v[76:79]
ds_read_b128 v[232:235],v17 offset:21504
v_fmac_f32 v75,v59,v120
s_waitcnt lgkmcnt(5)
v_mfma_f32_16x16x32_bf16 v[68:71],a[16:19],v[240:243],v[68:71]
v_min3_u32 v27,v27,v240,v244
v_mul_f32 v88,v64,v64
v_mul_f32 v92,v72,v72
v_mfma_f32_16x16x32_bf16 v[76:79],a[144:147],v[240:243],v[76:79]
ds_read_b128 v[236:239],v17 offset:23552
v_mul_f32 v89,v65,v65
v_mul_f32 v93,v73,v73
v_mfma_f32_16x16x32_bf16 v[68:71],a[20:23],v[244:247],v[68:71]
v_mul_f32 v90,v66,v66
v_mul_f32 v91,v67,v67
v_mul_f32 v94,v74,v74
v_mfma_f32_16x16x32_bf16 v[76:79],a[148:151],v[244:247],v[76:79]
ds_read_b128 v[240:243],v17 offset:25600
v_mul_f32 v95,v75,v75
s_waitcnt lgkmcnt(5)
v_mfma_f32_16x16x32_bf16 v[68:71],a[24:27],v[248:251],v[68:71]
v_min3_u32 v27,v27,v248,v252
v_fma_f32 v88,v88,v121,v122
v_fma_f32 v92,v92,v121,v122
v_mfma_f32_16x16x32_bf16 v[76:79],a[152:155],v[248:251],v[76:79]
ds_read_b128 v[244:247],v17 offset:27648
v_fma_f32 v89,v89,v121,v122
v_fma_f32 v93,v93,v121,v122
v_mfma_f32_16x16x32_bf16 v[68:71],a[28:31],v[252:255],v[68:71]
v_fma_f32 v90,v90,v121,v122
v_fma_f32 v91,v91,v121,v122
v_fma_f32 v94,v94,v121,v122
v_mfma_f32_16x16x32_bf16 v[76:79],a[156:159],v[252:255],v[76:79]
ds_read_b128 v[248:251],v17 offset:29696
v_fma_f32 v95,v95,v121,v122
s_waitcnt lgkmcnt(5)
v_mfma_f32_16x16x32_bf16 v[68:71],a[32:35],v[224:227],v[68:71]
v_min3_u32 v27,v27,v224,v228
v_mul_f32 v88,v88,v64
v_mul_f32 v92,v92,v72
v_mfma_f32_16x16x32_bf16 v[76:79],a[160:163],v[224:227],v[76:79]
ds_read_b128 v[252:255],v17 offset:31744
v_mul_f32 v89,v89,v65
v_mul_f32 v93,v93,v73
v_mfma_f32_16x16x32_bf16 v[68:71],a[36:39],v[228:231],v[68:71]
v_mul_f32 v90,v90,v66
v_mul_f32 v91,v91,v67
v_mul_f32 v94,v94,v74
v_mfma_f32_16x16x32_bf16 v[76:79],a[164:167],v[228:231],v[76:79]
s_waitcnt vmcnt(0)
s_barrier
ds_read_b128 v[224:227],v17 offset:33792
s_waitcnt lgkmcnt(5)
v_mfma_f32_16x16x32_bf16 v[68:71],a[40:43],v[232:235],v[68:71]
v_min3_u32 v27,v27,v232,v236
v_mul_f32 v95,v95,v75
v_mfma_f32_16x16x32_bf16 v[76:79],a[168:171],v[232:235],v[76:79]
ds_read_b128 v[228:231],v17 offset:35840
v_exp_f32 v92,v92
v_mfma_f32_16x16x32_bf16 v[68:71],a[44:47],v[236:239],v[68:71]
v_exp_f32 v88,v88
v_mfma_f32_16x16x32_bf16 v[76:79],a[172:175],v[236:239],v[76:79]
ds_read_b128 v[232:235],v17 offset:37888
s_waitcnt lgkmcnt(5)
v_mfma_f32_16x16x32_bf16 v[68:71],a[48:51],v[240:243],v[68:71]
v_min3_u32 v27,v27,v240,v244
v_exp_f32 v93,v93
v_mfma_f32_16x16x32_bf16 v[76:79],a[176:179],v[240:243],v[76:79]
ds_read_b128 v[236:239],v17 offset:39936
v_exp_f32 v94,v94
v_mfma_f32_16x16x32_bf16 v[68:71],a[52:55],v[244:247],v[68:71]
v_exp_f32 v89,v89
v_mfma_f32_16x16x32_bf16 v[76:79],a[180:183],v[244:247],v[76:79]
ds_read_b128 v[240:243],v17 offset:41984
s_waitcnt lgkmcnt(5)
v_mfma_f32_16x16x32_bf16 v[68:71],a[56:59],v[248:251],v[68:71]
v_min3_u32 v27,v27,v248,v252
v_exp_f32 v95,v95
v_mfma_f32_16x16x32_bf16 v[76:79],a[184:187],v[248:251],v[76:79]
ds_read_b128 v[244:247],v17 offset:44032
v_fma_f32 v92,v92,v123,v123
v_fma_f32 v93,v93,v123,v123
v_mfma_f32_16x16x32_bf16 v[68:71],a[60:63],v[252:255],v[68:71]
v_exp_f32 v90,v90
v_fma_f32 v94,v94,v123,v123
v_mfma_f32_16x16x32_bf16 v[76:79],a[188:191],v[252:255],v[76:79]
ds_read_b128 v[248:251],v17 offset:46080
v_fma_f32 v95,v95,v123,v123
s_waitcnt lgkmcnt(5)
v_mfma_f32_16x16x32_bf16 v[68:71],a[64:67],v[224:227],v[68:71]
v_min3_u32 v27,v27,v224,v228
v_rcp_f32 v92,v92
v_mfma_f32_16x16x32_bf16 v[76:79],a[192:195],v[224:227],v[76:79]
ds_read_b128 v[252:255],v17 offset:48128
v_rcp_f32 v93,v93
v_mfma_f32_16x16x32_bf16 v[68:71],a[68:71],v[228:231],v[68:71]
v_exp_f32 v91,v91
v_mfma_f32_16x16x32_bf16 v[76:79],a[196:199],v[228:231],v[76:79]
ds_read_b128 v[224:227],v17 offset:50176
s_waitcnt lgkmcnt(5)
v_mfma_f32_16x16x32_bf16 v[68:71],a[72:75],v[232:235],v[68:71]
v_min3_u32 v27,v27,v232,v236
v_fma_f32 v88,v88,v123,v123
v_mfma_f32_16x16x32_bf16 v[76:79],a[200:203],v[232:235],v[76:79]
ds_read_b128 v[228:231],v17 offset:52224
v_fma_f32 v89,v89,v123,v123
v_mfma_f32_16x16x32_bf16 v[68:71],a[76:79],v[236:239],v[68:71]
v_fma_f32 v90,v90,v123,v123
v_fma_f32 v91,v91,v123,v123
v_mfma_f32_16x16x32_bf16 v[76:79],a[204:207],v[236:239],v[76:79]
ds_read_b128 v[232:235],v17 offset:54272
s_waitcnt lgkmcnt(5)
v_mfma_f32_16x16x32_bf16 v[68:71],a[80:83],v[240:243],v[68:71]
v_min3_u32 v27,v27,v240,v244
v_rcp_f32 v94,v94
v_mfma_f32_16x16x32_bf16 v[76:79],a[208:211],v[240:243],v[76:79]
ds_read_b128 v[236:239],v17 offset:56320
v_rcp_f32 v95,v95
v_mfma_f32_16x16x32_bf16 v[68:71],a[84:87],v[244:247],v[68:71]
v_rcp_f32 v88,v88
v_mfma_f32_16x16x32_bf16 v[76:79],a[212:215],v[244:247],v[76:79]
ds_read_b128 v[240:243],v17 offset:58368
s_waitcnt lgkmcnt(5)
v_mfma_f32_16x16x32_bf16 v[68:71],a[88:91],v[248:251],v[68:71]
v_min3_u32 v27,v27,v248,v252
v_mul_f32 v92,v92,v72
v_mfma_f32_16x16x32_bf16 v[76:79],a[216:219],v[248:251],v[76:79]
ds_read_b128 v[244:247],v17 offset:60416
v_mul_f32 v93,v93,v73
v_mfma_f32_16x16x32_bf16 v[68:71],a[92:95],v[252:255],v[68:71]
v_rcp_f32 v89,v89
v_mfma_f32_16x16x32_bf16 v[76:79],a[220:223],v[252:255],v[76:79]
ds_read_b128 v[248:251],v17 offset:62464
s_waitcnt lgkmcnt(5)
v_mfma_f32_16x16x32_bf16 v[68:71],a[96:99],v[224:227],v[68:71]
v_min3_u32 v27,v27,v224,v228
v_mul_f32 v94,v94,v74
v_mfma_f32_16x16x32_bf16 v[76:79],a[224:227],v[224:227],v[76:79]
ds_read_b128 v[252:255],v17 offset:64512
v_mul_f32 v95,v95,v75
v_mfma_f32_16x16x32_bf16 v[68:71],a[100:103],v[228:231],v[68:71]
v_rcp_f32 v90,v90
v_mfma_f32_16x16x32_bf16 v[76:79],a[228:231],v[228:231],v[76:79]
s_waitcnt lgkmcnt(4)
v_mfma_f32_16x16x32_bf16 v[68:71],a[104:107],v[232:235],v[68:71]
v_min3_u32 v27,v27,v232,v236
v_mfma_f32_16x16x32_bf16 v[76:79],a[232:235],v[232:235],v[76:79]
v_rcp_f32 v91,v91
v_mfma_f32_16x16x32_bf16 v[68:71],a[108:111],v[236:239],v[68:71]
v_mul_f32 v88,v88,v64
v_mul_f32 v89,v89,v65
v_mfma_f32_16x16x32_bf16 v[76:79],a[236:239],v[236:239],v[76:79]
v_mul_f32 v90,v90,v66
s_waitcnt lgkmcnt(2)
v_mfma_f32_16x16x32_bf16 v[68:71],a[112:115],v[240:243],v[68:71]
v_min3_u32 v27,v27,v240,v244
v_mul_f32 v91,v91,v67
v_mfma_f32_16x16x32_bf16 v[76:79],a[240:243],v[240:243],v[76:79]
v_cvt_pk_bf16_f32 v96,v88,v89
v_cvt_pk_bf16_f32 v97,v90,v91
v_mfma_f32_16x16x32_bf16 v[68:71],a[116:119],v[244:247],v[68:71]
v_cvt_pk_bf16_f32 v98,v92,v93
v_cvt_pk_bf16_f32 v99,v94,v95
v_mfma_f32_16x16x32_bf16 v[76:79],a[244:247],v[244:247],v[76:79]
v_max_u32 v96,1,v96
s_waitcnt lgkmcnt(0)
v_mfma_f32_16x16x32_bf16 v[68:71],a[120:123],v[248:251],v[68:71]
v_min3_u32 v27,v27,v248,v252
v_mfma_f32_16x16x32_bf16 v[76:79],a[248:251],v[248:251],v[76:79]
buffer_store_dwordx4 v[96:99],v18,s[20:23],s70 offen offset:0 sc1
v_mfma_f32_16x16x32_bf16 v[68:71],a[124:127],v[252:255],v[68:71]
v_mfma_f32_16x16x32_bf16 v[76:79],a[252:255],v[252:255],v[76:79]
v_cmp_eq_u32 vcc,0,v27
s_cbranch_vccnz retry_377
s_branch epi_380
keep_388:
v_mfma_f32_16x16x32_bf16 v[64:67],a[124:127],v[252:255],v[64:67]
v_min3_u32 v27,v27,v248,v252
s_xor_b32 m0,s72,0
v_mfma_f32_16x16x32_bf16 v[72:75],a[252:255],v[252:255],v[72:75]
ds_read_b128 v[248:251],v17 offset:13312
s_add_u32 s65,s88,0
s_waitcnt lgkmcnt(6)
v_mfma_f32_16x16x32_bf16 v[68:71],a[0:3],v[224:227],0
buffer_load_dwordx4 v16,s[20:23],s65 offen offset:0 sc1 lds
v_min3_u32 v27,v27,v224,v228
v_mfma_f32_16x16x32_bf16 v[76:79],a[128:131],v[224:227],0
ds_read_b128 v[252:255],v17 offset:15360
buffer_load_dwordx4 v16,s[20:23],s65 offen offset:2048 sc1 lds
v_mfma_f32_16x16x32_bf16 v[68:71],a[4:7],v[228:231],v[68:71]
v_cmp_eq_u32 vcc,0,v27
s_cbranch_vccnz retry_377
s_waitcnt lgkmcnt(6)
v_mfma_f32_16x16x32_bf16 v[76:79],a[132:135],v[228:231],v[76:79]
ds_read_b128 v[224:227],v17 offset:17408
s_xor_b32 m0,s72,16384
s_waitcnt lgkmcnt(5)
v_mfma_f32_16x16x32_bf16 v[68:71],a[8:11],v[232:235],v[68:71]
s_add_u32 s65,s88,32768
v_min3_u32 v27,v27,v232,v236
v_fmac_f32 v64,v52,v120
v_fmac_f32 v72,v56,v120
v_mfma_f32_16x16x32_bf16 v[76:79],a[136:139],v[232:235],v[76:79]
ds_read_b128 v[228:231],v17 offset:19456
buffer_load_dwordx4 v16,s[20:23],s65 offen offset:0 sc1 lds
v_fmac_f32 v73,v57,v120
v_mfma_f32_16x16x32_bf16 v[68:71],a[12:15],v[236:239],v[68:71]
v_fmac_f32 v65,v53,v120
v_fmac_f32 v66,v54,v120
v_fmac_f32 v67,v55,v120
v_fmac_f32 v74,v58,v120
v_mfma_f32_16x16x32_bf16 v[76:79],a[140:143],v[236:239],v[76:79]
ds_read_b128 v[232:235],v17 offset:21504
v_mul_f32 v88,v64,v64
v_fmac_f32 v75,v59,v120
s_waitcnt lgkmcnt(5)
v_mfma_f32_16x16x32_bf16 v[68:71],a[16:19],v[240:243],v[68:71]
buffer_load_dwordx4 v16,s[20:23],s65 offen offset:2048 sc1 lds
s_xor_b32 m0,s72,32768
v_mul_f32 v92,v72,v72
v_mfma_f32_16x16x32_bf16 v[76:79],a[144:147],v[240:243],v[76:79]
ds_read_b128 v[236:239],v17 offset:23552
s_add_u32 s65,s88,65536
v_mul_f32 v89,v65,v65
v_mul_f32 v93,v73,v73
v_mfma_f32_16x16x32_bf16 v[68:71],a[20:23],v[244:247],v[68:71]
v_min3_u32 v27,v27,v240,v244
v_mul_f32 v90,v66,v66
v_mul_f32 v91,v67,v67
v_mul_f32 v94,v74,v74
v_mfma_f32_16x16x32_bf16 v[76:79],a[148:151],v[244:247],v[76:79]
ds_read_b128 v[240:243],v17 offset:25600
v_fma_f32 v88,v88,v121,v122
v_mul_f32 v95,v75,v75
s_waitcnt lgkmcnt(5)
v_mfma_f32_16x16x32_bf16 v[68:71],a[24:27],v[248:251],v[68:71]
buffer_load_dwordx4 v16,s[20:23],s65 offen offset:0 sc1 lds
v_fma_f32 v89,v89,v121,v122
v_fma_f32 v92,v92,v121,v122
v_mfma_f32_16x16x32_bf16 v[76:79],a[152:155],v[248:251],v[76:79]
ds_read_b128 v[244:247],v17 offset:27648
buffer_load_dwordx4 v16,s[20:23],s65 offen offset:2048 sc1 lds
v_fma_f32 v93,v93,v121,v122
v_mfma_f32_16x16x32_bf16 v[68:71],a[28:31],v[252:255],v[68:71]
s_xor_b32 m0,s72,49152
v_min3_u32 v27,v27,v248,v252
v_fma_f32 v90,v90,v121,v122
v_fma_f32 v94,v94,v121,v122
v_mfma_f32_16x16x32_bf16 v[76:79],a[156:159],v[252:255],v[76:79]
ds_read_b128 v[248:251],v17 offset:29696
s_add_u32 s65,s88,98304
v_fma_f32 v95,v95,v121,v122
s_waitcnt lgkmcnt(5)
v_mfma_f32_16x16x32_bf16 v[68:71],a[32:35],v[224:227],v[68:71]
buffer_load_dwordx4 v16,s[20:23],s65 offen offset:0 sc1 lds
v_fma_f32 v91,v91,v121,v122
v_mul_f32 v92,v92,v72
v_mfma_f32_16x16x32_bf16 v[76:79],a[160:163],v[224:227],v[76:79]
ds_read_b128 v[252:255],v17 offset:31744
v_min3_u32 v27,v27,v224,v228
v_mul_f32 v88,v88,v64
v_mul_f32 v93,v93,v73
v_mfma_f32_16x16x32_bf16 v[68:71],a[36:39],v[228:231],v[68:71]
buffer_load_dwordx4 v16,s[20:23],s65 offen offset:2048 sc1 lds
v_mul_f32 v89,v89,v65
v_mul_f32 v94,v94,v74
v_mfma_f32_16x16x32_bf16 v[76:79],a[164:167],v[228:231],v[76:79]
s_waitcnt vmcnt(8)
s_barrier
ds_read_b128 v[224:227],v17 offset:33792
s_waitcnt lgkmcnt(5)
v_mfma_f32_16x16x32_bf16 v[68:71],a[40:43],v[232:235],v[68:71]
s_xor_b32 m0,s72,1024
s_add_u32 s65,s89,0
v_mul_f32 v90,v90,v66
v_mul_f32 v95,v95,v75
v_mfma_f32_16x16x32_bf16 v[76:79],a[168:171],v[232:235],v[76:79]
ds_read_b128 v[228:231],v17 offset:35840
v_min3_u32 v27,v27,v232,v236
v_mul_f32 v91,v91,v67
v_mfma_f32_16x16x32_bf16 v[68:71],a[44:47],v[236:239],v[68:71]
buffer_load_dwordx4 v16,s[20:23],s65 offen offset:0 sc1 lds
v_exp_f32 v92,v92
v_mfma_f32_16x16x32_bf16 v[76:79],a[172:175],v[236:239],v[76:79]
ds_read_b128 v[232:235],v17 offset:37888
v_exp_f32 v93,v93
s_waitcnt lgkmcnt(5)
v_mfma_f32_16x16x32_bf16 v[68:71],a[48:51],v[240:243],v[68:71]
buffer_load_dwordx4 v16,s[20:23],s65 offen offset:2048 sc1 lds
v_exp_f32 v94,v94
v_mfma_f32_16x16x32_bf16 v[76:79],a[176:179],v[240:243],v[76:79]
ds_read_b128 v[236:239],v17 offset:39936
s_xor_b32 m0,s72,17408
v_exp_f32 v95,v95
v_mfma_f32_16x16x32_bf16 v[68:71],a[52:55],v[244:247],v[68:71]
s_add_u32 s65,s89,32768
v_min3_u32 v27,v27,v240,v244
v_fma_f32 v92,v92,v123,v123
v_fma_f32 v93,v93,v123,v123
v_mfma_f32_16x16x32_bf16 v[76:79],a[180:183],v[244:247],v[76:79]
ds_read_b128 v[240:243],v17 offset:41984
v_fma_f32 v94,v94,v123,v123
v_fma_f32 v95,v95,v123,v123
s_waitcnt lgkmcnt(5)
v_mfma_f32_16x16x32_bf16 v[68:71],a[56:59],v[248:251],v[68:71]
buffer_load_dwordx4 v16,s[20:23],s65 offen offset:0 sc1 lds
v_rcp_f32 v92,v92
v_mfma_f32_16x16x32_bf16 v[76:79],a[184:187],v[248:251],v[76:79]
ds_read_b128 v[244:247],v17 offset:44032
v_min3_u32 v27,v27,v248,v252
v_rcp_f32 v93,v93
v_mfma_f32_16x16x32_bf16 v[68:71],a[60:63],v[252:255],v[68:71]
buffer_load_dwordx4 v16,s[20:23],s65 offen offset:2048 sc1 lds
v_rcp_f32 v94,v94
v_mfma_f32_16x16x32_bf16 v[76:79],a[188:191],v[252:255],v[76:79]
ds_read_b128 v[248:251],v17 offset:46080
v_rcp_f32 v95,v95
s_waitcnt lgkmcnt(5)
v_mfma_f32_16x16x32_bf16 v[68:71],a[64:67],v[224:227],v[68:71]
s_xor_b32 m0,s72,33792
s_add_u32 s65,s89,65536
v_mul_f32 v92,v92,v72
v_mul_f32 v93,v93,v73
v_mfma_f32_16x16x32_bf16 v[76:79],a[192:195],v[224:227],v[76:79]
ds_read_b128 v[252:255],v17 offset:48128
v_min3_u32 v27,v27,v224,v228
v_mfma_f32_16x16x32_bf16 v[68:71],a[68:71],v[228:231],v[68:71]
buffer_load_dwordx4 v16,s[20:23],s65 offen offset:0 sc1 lds
v_mfma_f32_16x16x32_bf16 v[76:79],a[196:199],v[228:231],v[76:79]
ds_read_b128 v[224:227],v17 offset:50176
s_waitcnt lgkmcnt(5)
v_mfma_f32_16x16x32_bf16 v[68:71],a[72:75],v[232:235],v[68:71]
buffer_load_dwordx4 v16,s[20:23],s65 offen offset:2048 sc1 lds
v_mfma_f32_16x16x32_bf16 v[76:79],a[200:203],v[232:235],v[76:79]
ds_read_b128 v[228:231],v17 offset:52224
s_xor_b32 m0,s72,50176
v_mfma_f32_16x16x32_bf16 v[68:71],a[76:79],v[236:239],v[68:71]
s_add_u32 s65,s89,98304
v_min3_u32 v27,v27,v232,v236
v_mfma_f32_16x16x32_bf16 v[76:79],a[204:207],v[236:239],v[76:79]
ds_read_b128 v[232:235],v17 offset:54272
s_waitcnt lgkmcnt(5)
v_mfma_f32_16x16x32_bf16 v[68:71],a[80:83],v[240:243],v[68:71]
buffer_load_dwordx4 v16,s[20:23],s65 offen offset:0 sc1 lds
v_mfma_f32_16x16x32_bf16 v[76:79],a[208:211],v[240:243],v[76:79]
ds_read_b128 v[236:239],v17 offset:56320
v_min3_u32 v27,v27,v240,v244
v_mfma_f32_16x16x32_bf16 v[68:71],a[84:87],v[244:247],v[68:71]
buffer_load_dwordx4 v16,s[20:23],s65 offen offset:2048 sc1 lds
v_mfma_f32_16x16x32_bf16 v[76:79],a[212:215],v[244:247],v[76:79]
ds_read_b128 v[240:243],v17 offset:58368
s_waitcnt lgkmcnt(5)
v_mfma_f32_16x16x32_bf16 v[68:71],a[88:91],v[248:251],v[68:71]
v_min3_u32 v27,v27,v248,v252
v_exp_f32 v88,v88
v_mfma_f32_16x16x32_bf16 v[76:79],a[216:219],v[248:251],v[76:79]
ds_read_b128 v[244:247],v17 offset:60416
v_exp_f32 v89,v89
v_mfma_f32_16x16x32_bf16 v[68:71],a[92:95],v[252:255],v[68:71]
v_exp_f32 v90,v90
v_mfma_f32_16x16x32_bf16 v[76:79],a[220:223],v[252:255],v[76:79]
ds_read_b128 v[248:251],v17 offset:62464
s_waitcnt lgkmcnt(5)
v_mfma_f32_16x16x32_bf16 v[68:71],a[96:99],v[224:227],v[68:71]
v_min3_u32 v27,v27,v224,v228
v_exp_f32 v91,v91
v_mfma_f32_16x16x32_bf16 v[76:79],a[224:227],v[224:227],v[76:79]
ds_read_b128 v[252:255],v17 offset:64512
v_fma_f32 v88,v88,v123,v123
v_fma_f32 v89,v89,v123,v123
v_mfma_f32_16x16x32_bf16 v[68:71],a[100:103],v[228:231],v[68:71]
v_fma_f32 v90,v90,v123,v123
v_fma_f32 v91,v91,v123,v123
v_mfma_f32_16x16x32_bf16 v[76:79],a[228:231],v[228:231],v[76:79]
v_rcp_f32 v88,v88
s_waitcnt lgkmcnt(4)
v_mfma_f32_16x16x32_bf16 v[68:71],a[104:107],v[232:235],v[68:71]
v_min3_u32 v27,v27,v232,v236
v_rcp_f32 v89,v89
v_mfma_f32_16x16x32_bf16 v[76:79],a[232:235],v[232:235],v[76:79]
v_rcp_f32 v90,v90
v_mfma_f32_16x16x32_bf16 v[68:71],a[108:111],v[236:239],v[68:71]
v_rcp_f32 v91,v91
v_mfma_f32_16x16x32_bf16 v[76:79],a[236:239],v[236:239],v[76:79]
v_mul_f32 v88,v88,v64
s_waitcnt lgkmcnt(2)
v_mfma_f32_16x16x32_bf16 v[68:71],a[112:115],v[240:243],v[68:71]
v_min3_u32 v27,v27,v240,v244
v_mul_f32 v89,v89,v65
v_mfma_f32_16x16x32_bf16 v[76:79],a[240:243],v[240:243],v[76:79]
v_mul_f32 v90,v90,v66
v_mul_f32 v91,v91,v67
v_mfma_f32_16x16x32_bf16 v[68:71],a[116:119],v[244:247],v[68:71]
v_mul_f32 v94,v94,v74
v_mul_f32 v95,v95,v75
v_mfma_f32_16x16x32_bf16 v[76:79],a[244:247],v[244:247],v[76:79]
v_cvt_pk_bf16_f32 v96,v88,v89
s_waitcnt lgkmcnt(0)
v_mfma_f32_16x16x32_bf16 v[68:71],a[120:123],v[248:251],v[68:71]
v_min3_u32 v27,v27,v248,v252
v_cvt_pk_bf16_f32 v97,v90,v91
v_mfma_f32_16x16x32_bf16 v[76:79],a[248:251],v[248:251],v[76:79]
v_cvt_pk_bf16_f32 v98,v92,v93
v_cvt_pk_bf16_f32 v99,v94,v95
v_mfma_f32_16x16x32_bf16 v[68:71],a[124:127],v[252:255],v[68:71]
v_max_u32 v96,1,v96
v_mfma_f32_16x16x32_bf16 v[76:79],a[252:255],v[252:255],v[76:79]
buffer_store_dwordx4 v[96:99],v18,s[20:23],s70 offen offset:0 sc1
v_cmp_eq_u32 vcc,0,v27
s_cbranch_vccnz retry_377
s_branch epi_380
ahead_379:
s_cmp_eq_u32 s93,0
s_cbranch_scc1 both_381
s_waitcnt vmcnt(12) lgkmcnt(0)
s_barrier
ds_read_b128 v[224:227],v17 offset:0
ds_read_b128 v[228:231],v17 offset:2048
ds_read_b128 v[232:235],v17 offset:4096
ds_read_b128 v[236:239],v17 offset:6144
ds_read_b128 v[240:243],v17 offset:8192
ds_read_b128 v[244:247],v17 offset:10240
ds_read_b128 v[248:251],v17 offset:12288
s_waitcnt lgkmcnt(5)
v_mfma_f32_16x16x32_bf16 v[64:67],a[0:3],v[224:227],0
s_add_u32 s96,s71,1
s_add_u32 s92,s71,2
v_mfma_f32_16x16x32_bf16 v[72:75],a[128:131],v[224:227],0
ds_read_b128 v[252:255],v17 offset:14336
v_min_u32 v27,v224,v228
v_mfma_f32_16x16x32_bf16 v[64:67],a[4:7],v[228:231],v[64:67]
s_cmp_eq_u32 s96,64
s_cselect_b32 s96,99,s96
v_mfma_f32_16x16x32_bf16 v[72:75],a[132:135],v[228:231],v[72:75]
ds_read_b128 v[224:227],v17 offset:16384
s_waitcnt lgkmcnt(5)
v_mfma_f32_16x16x32_bf16 v[64:67],a[8:11],v[232:235],v[64:67]
s_cmp_eq_u32 s92,64
s_cselect_b32 s92,99,s92
v_mfma_f32_16x16x32_bf16 v[72:75],a[136:139],v[232:235],v[72:75]
ds_read_b128 v[228:231],v17 offset:18432
v_min3_u32 v27,v27,v232,v236
v_mfma_f32_16x16x32_bf16 v[64:67],a[12:15],v[236:239],v[64:67]
v_mfma_f32_16x16x32_bf16 v[72:75],a[140:143],v[236:239],v[72:75]
ds_read_b128 v[232:235],v17 offset:20480
s_waitcnt lgkmcnt(5)
v_mfma_f32_16x16x32_bf16 v[64:67],a[16:19],v[240:243],v[64:67]
v_min3_u32 v27,v27,v240,v244
v_mfma_f32_16x16x32_bf16 v[72:75],a[144:147],v[240:243],v[72:75]
ds_read_b128 v[236:239],v17 offset:22528
v_mfma_f32_16x16x32_bf16 v[64:67],a[20:23],v[244:247],v[64:67]
v_mfma_f32_16x16x32_bf16 v[72:75],a[148:151],v[244:247],v[72:75]
ds_read_b128 v[240:243],v17 offset:24576
s_waitcnt lgkmcnt(5)
v_mfma_f32_16x16x32_bf16 v[64:67],a[24:27],v[248:251],v[64:67]
v_min3_u32 v27,v27,v248,v252
v_mfma_f32_16x16x32_bf16 v[72:75],a[152:155],v[248:251],v[72:75]
ds_read_b128 v[244:247],v17 offset:26624
v_mfma_f32_16x16x32_bf16 v[64:67],a[28:31],v[252:255],v[64:67]
v_mfma_f32_16x16x32_bf16 v[72:75],a[156:159],v[252:255],v[72:75]
ds_read_b128 v[248:251],v17 offset:28672
s_waitcnt lgkmcnt(5)
v_mfma_f32_16x16x32_bf16 v[64:67],a[32:35],v[224:227],v[64:67]
v_min3_u32 v27,v27,v224,v228
v_mfma_f32_16x16x32_bf16 v[72:75],a[160:163],v[224:227],v[72:75]
ds_read_b128 v[252:255],v17 offset:30720
v_mfma_f32_16x16x32_bf16 v[64:67],a[36:39],v[228:231],v[64:67]
v_mfma_f32_16x16x32_bf16 v[72:75],a[164:167],v[228:231],v[72:75]
ds_read_b128 v[224:227],v17 offset:32768
s_waitcnt lgkmcnt(5)
v_mfma_f32_16x16x32_bf16 v[64:67],a[40:43],v[232:235],v[64:67]
v_min3_u32 v27,v27,v232,v236
v_mfma_f32_16x16x32_bf16 v[72:75],a[168:171],v[232:235],v[72:75]
ds_read_b128 v[228:231],v17 offset:34816
v_mfma_f32_16x16x32_bf16 v[64:67],a[44:47],v[236:239],v[64:67]
v_mfma_f32_16x16x32_bf16 v[72:75],a[172:175],v[236:239],v[72:75]
ds_read_b128 v[232:235],v17 offset:36864
s_waitcnt lgkmcnt(5)
v_mfma_f32_16x16x32_bf16 v[64:67],a[48:51],v[240:243],v[64:67]
v_min3_u32 v27,v27,v240,v244
v_mfma_f32_16x16x32_bf16 v[72:75],a[176:179],v[240:243],v[72:75]
ds_read_b128 v[236:239],v17 offset:38912
v_mfma_f32_16x16x32_bf16 v[64:67],a[52:55],v[244:247],v[64:67]
v_mfma_f32_16x16x32_bf16 v[72:75],a[180:183],v[244:247],v[72:75]
ds_read_b128 v[240:243],v17 offset:40960
s_waitcnt lgkmcnt(5)
v_mfma_f32_16x16x32_bf16 v[64:67],a[56:59],v[248:251],v[64:67]
v_min3_u32 v27,v27,v248,v252
v_mfma_f32_16x16x32_bf16 v[72:75],a[184:187],v[248:251],v[72:75]
ds_read_b128 v[244:247],v17 offset:43008
s_waitcnt vmcnt(2)
v_mfma_f32_16x16x32_bf16 v[64:67],a[60:63],v[252:255],v[64:67]
v_cmp_gt_u32 vcc,s96,v29
v_cmp_gt_u32 s[92:93],s92,v29
v_mfma_f32_16x16x32_bf16 v[72:75],a[188:191],v[252:255],v[72:75]
ds_read_b128 v[248:251],v17 offset:45056
s_waitcnt lgkmcnt(5)
v_mfma_f32_16x16x32_bf16 v[64:67],a[64:67],v[224:227],v[64:67]
v_mov_b32 v44,vcc_lo
v_mov_b32 v45,s92
v_mfma_f32_16x16x32_bf16 v[72:75],a[192:195],v[224:227],v[72:75]
ds_read_b128 v[252:255],v17 offset:47104
ds_write_b64 v46,v[44:45]
v_mfma_f32_16x16x32_bf16 v[64:67],a[68:71],v[228:231],v[64:67]
v_min3_u32 v27,v27,v224,v228
v_mfma_f32_16x16x32_bf16 v[72:75],a[196:199],v[228:231],v[72:75]
ds_read_b128 v[224:227],v17 offset:49152
s_waitcnt lgkmcnt(6)
v_mfma_f32_16x16x32_bf16 v[64:67],a[72:75],v[232:235],v[64:67]
v_min3_u32 v27,v27,v232,v236
v_mfma_f32_16x16x32_bf16 v[72:75],a[200:203],v[232:235],v[72:75]
ds_read_b128 v[228:231],v17 offset:51200
v_mfma_f32_16x16x32_bf16 v[64:67],a[76:79],v[236:239],v[64:67]
v_mfma_f32_16x16x32_bf16 v[72:75],a[204:207],v[236:239],v[72:75]
ds_read_b128 v[232:235],v17 offset:53248
s_waitcnt lgkmcnt(6)
v_mfma_f32_16x16x32_bf16 v[64:67],a[80:83],v[240:243],v[64:67]
v_min3_u32 v27,v27,v240,v244
s_add_u32 s88,s70,s75
v_mfma_f32_16x16x32_bf16 v[72:75],a[208:211],v[240:243],v[72:75]
ds_read_b128 v[236:239],v17 offset:55296
s_add_u32 s88,s88,2097152
v_mfma_f32_16x16x32_bf16 v[64:67],a[84:87],v[244:247],v[64:67]
s_xor_b32 s88,s88,0x2000
s_xor_b32 s89,s88,1024
v_mfma_f32_16x16x32_bf16 v[72:75],a[212:215],v[244:247],v[72:75]
ds_read_b128 v[240:243],v17 offset:57344
s_waitcnt lgkmcnt(6)
v_mfma_f32_16x16x32_bf16 v[64:67],a[88:91],v[248:251],v[64:67]
v_min3_u32 v27,v27,v248,v252
v_mfma_f32_16x16x32_bf16 v[72:75],a[216:219],v[248:251],v[72:75]
ds_read_b128 v[244:247],v17 offset:59392
v_mfma_f32_16x16x32_bf16 v[64:67],a[92:95],v[252:255],v[64:67]
v_mfma_f32_16x16x32_bf16 v[72:75],a[220:223],v[252:255],v[72:75]
ds_read_b128 v[248:251],v17 offset:61440
s_waitcnt lgkmcnt(5)
v_mfma_f32_16x16x32_bf16 v[64:67],a[96:99],v[224:227],v[64:67]
v_min3_u32 v27,v27,v224,v228
v_mfma_f32_16x16x32_bf16 v[72:75],a[224:227],v[224:227],v[72:75]
ds_read_b128 v[252:255],v17 offset:63488
v_mfma_f32_16x16x32_bf16 v[64:67],a[100:103],v[228:231],v[64:67]
s_waitcnt vmcnt(0)
v_add_u32 v22,s71,-1
v_mfma_f32_16x16x32_bf16 v[72:75],a[228:231],v[228:231],v[72:75]
s_waitcnt vmcnt(4)
s_barrier
ds_read_b64 v[44:45],v47
ds_read_b128 v[224:227],v17 offset:1024
s_waitcnt lgkmcnt(6)
v_mfma_f32_16x16x32_bf16 v[64:67],a[104:107],v[232:235],v[64:67]
v_min3_u32 v27,v27,v232,v236
ds_read_b128 v[124:127],v19 offset:256
v_mfma_f32_16x16x32_bf16 v[72:75],a[232:235],v[232:235],v[72:75]
ds_read_b128 v[228:231],v17 offset:3072
ds_read_b128 v[120:123],v19 offset:0
v_mfma_f32_16x16x32_bf16 v[64:67],a[108:111],v[236:239],v[64:67]
buffer_store_dword v22,v23,s[20:23],s97 offen sc1
v_mfma_f32_16x16x32_bf16 v[72:75],a[236:239],v[236:239],v[72:75]
ds_read_b128 v[232:235],v17 offset:5120
s_waitcnt lgkmcnt(8)
v_mfma_f32_16x16x32_bf16 v[64:67],a[112:115],v[240:243],v[64:67]
v_min3_u32 v27,v27,v240,v244
s_mov_b32 s97,0x7fff0000
v_mfma_f32_16x16x32_bf16 v[72:75],a[240:243],v[240:243],v[72:75]
ds_read_b128 v[236:239],v17 offset:7168
v_mfma_f32_16x16x32_bf16 v[64:67],a[116:119],v[244:247],v[64:67]
v_mfma_f32_16x16x32_bf16 v[72:75],a[244:247],v[244:247],v[72:75]
ds_read_b128 v[240:243],v17 offset:9216
s_waitcnt lgkmcnt(8)
v_mfma_f32_16x16x32_bf16 v[64:67],a[120:123],v[248:251],v[64:67]
s_waitcnt lgkmcnt(7)
v_readfirstlane_b32 s93,v45
v_mfma_f32_16x16x32_bf16 v[72:75],a[248:251],v[248:251],v[72:75]
ds_read_b128 v[244:247],v17 offset:11264
v_readfirstlane_b32 s83,v44
s_cmp_lg_u32 s83,0
s_cbranch_scc1 keep_389
v_mfma_f32_16x16x32_bf16 v[64:67],a[124:127],v[252:255],v[64:67]
v_min3_u32 v27,v27,v248,v252
s_xor_b32 m0,s72,0
v_mfma_f32_16x16x32_bf16 v[72:75],a[252:255],v[252:255],v[72:75]
ds_read_b128 v[248:251],v17 offset:13312
s_add_u32 s65,s88,0
s_waitcnt lgkmcnt(6)
v_mfma_f32_16x16x32_bf16 v[68:71],a[0:3],v[224:227],0
buffer_load_dwordx4 v16,s[20:23],s65 offen offset:0 sc1 lds
v_min3_u32 v27,v27,v224,v228
v_mfma_f32_16x16x32_bf16 v[76:79],a[128:131],v[224:227],0
ds_read_b128 v[252:255],v17 offset:15360
buffer_load_dwordx4 v16,s[20:23],s65 offen offset:2048 sc1 lds
v_mfma_f32_16x16x32_bf16 v[68:71],a[4:7],v[228:231],v[68:71]
v_cmp_eq_u32 vcc,0,v27
s_cbranch_vccnz retry_377
s_waitcnt lgkmcnt(6)
v_mfma_f32_16x16x32_bf16 v[76:79],a[132:135],v[228:231],v[76:79]
ds_read_b128 v[224:227],v17 offset:17408
s_xor_b32 m0,s72,16384
s_waitcnt lgkmcnt(5)
v_mfma_f32_16x16x32_bf16 v[68:71],a[8:11],v[232:235],v[68:71]
s_add_u32 s65,s88,32768
v_min3_u32 v27,v27,v232,v236
v_fmac_f32 v64,v52,v120
v_fmac_f32 v72,v56,v120
v_mfma_f32_16x16x32_bf16 v[76:79],a[136:139],v[232:235],v[76:79]
ds_read_b128 v[228:231],v17 offset:19456
buffer_load_dwordx4 v16,s[20:23],s65 offen offset:0 sc1 lds
v_fmac_f32 v73,v57,v120
v_mfma_f32_16x16x32_bf16 v[68:71],a[12:15],v[236:239],v[68:71]
v_fmac_f32 v65,v53,v120
v_fmac_f32 v66,v54,v120
v_fmac_f32 v67,v55,v120
v_fmac_f32 v74,v58,v120
v_mfma_f32_16x16x32_bf16 v[76:79],a[140:143],v[236:239],v[76:79]
ds_read_b128 v[232:235],v17 offset:21504
v_mul_f32 v88,v64,v64
v_fmac_f32 v75,v59,v120
s_waitcnt lgkmcnt(5)
v_mfma_f32_16x16x32_bf16 v[68:71],a[16:19],v[240:243],v[68:71]
buffer_load_dwordx4 v16,s[20:23],s65 offen offset:2048 sc1 lds
s_xor_b32 m0,s72,32768
v_mul_f32 v92,v72,v72
v_mfma_f32_16x16x32_bf16 v[76:79],a[144:147],v[240:243],v[76:79]
ds_read_b128 v[236:239],v17 offset:23552
s_add_u32 s65,s88,65536
v_mul_f32 v89,v65,v65
v_mul_f32 v93,v73,v73
v_mfma_f32_16x16x32_bf16 v[68:71],a[20:23],v[244:247],v[68:71]
v_min3_u32 v27,v27,v240,v244
v_mul_f32 v90,v66,v66
v_mul_f32 v91,v67,v67
v_mul_f32 v94,v74,v74
v_mfma_f32_16x16x32_bf16 v[76:79],a[148:151],v[244:247],v[76:79]
ds_read_b128 v[240:243],v17 offset:25600
v_fma_f32 v88,v88,v121,v122
v_mul_f32 v95,v75,v75
s_waitcnt lgkmcnt(5)
v_mfma_f32_16x16x32_bf16 v[68:71],a[24:27],v[248:251],v[68:71]
buffer_load_dwordx4 v16,s[20:23],s65 offen offset:0 sc1 lds
v_fma_f32 v89,v89,v121,v122
v_fma_f32 v92,v92,v121,v122
v_mfma_f32_16x16x32_bf16 v[76:79],a[152:155],v[248:251],v[76:79]
ds_read_b128 v[244:247],v17 offset:27648
buffer_load_dwordx4 v16,s[20:23],s65 offen offset:2048 sc1 lds
v_fma_f32 v93,v93,v121,v122
v_mfma_f32_16x16x32_bf16 v[68:71],a[28:31],v[252:255],v[68:71]
s_xor_b32 m0,s72,49152
v_min3_u32 v27,v27,v248,v252
v_fma_f32 v90,v90,v121,v122
v_fma_f32 v94,v94,v121,v122
v_mfma_f32_16x16x32_bf16 v[76:79],a[156:159],v[252:255],v[76:79]
ds_read_b128 v[248:251],v17 offset:29696
s_add_u32 s65,s88,98304
v_fma_f32 v95,v95,v121,v122
s_waitcnt lgkmcnt(5)
v_mfma_f32_16x16x32_bf16 v[68:71],a[32:35],v[224:227],v[68:71]
buffer_load_dwordx4 v16,s[20:23],s65 offen offset:0 sc1 lds
v_fma_f32 v91,v91,v121,v122
v_mul_f32 v92,v92,v72
v_mfma_f32_16x16x32_bf16 v[76:79],a[160:163],v[224:227],v[76:79]
ds_read_b128 v[252:255],v17 offset:31744
v_min3_u32 v27,v27,v224,v228
v_mul_f32 v88,v88,v64
v_mul_f32 v93,v93,v73
v_mfma_f32_16x16x32_bf16 v[68:71],a[36:39],v[228:231],v[68:71]
buffer_load_dwordx4 v16,s[20:23],s65 offen offset:2048 sc1 lds
v_mul_f32 v89,v89,v65
v_mul_f32 v94,v94,v74
v_mfma_f32_16x16x32_bf16 v[76:79],a[164:167],v[228:231],v[76:79]
ds_read_b128 v[224:227],v17 offset:33792
v_mul_f32 v90,v90,v66
v_mul_f32 v95,v95,v75
s_waitcnt lgkmcnt(5)
v_mfma_f32_16x16x32_bf16 v[68:71],a[40:43],v[232:235],v[68:71]
s_xor_b32 m0,s72,1024
s_add_u32 s65,s89,0
v_mul_f32 v91,v91,v67
v_mfma_f32_16x16x32_bf16 v[76:79],a[168:171],v[232:235],v[76:79]
ds_read_b128 v[228:231],v17 offset:35840
v_min3_u32 v27,v27,v232,v236
v_exp_f32 v92,v92
v_mfma_f32_16x16x32_bf16 v[68:71],a[44:47],v[236:239],v[68:71]
buffer_load_dwordx4 v16,s[20:23],s65 offen offset:0 sc1 lds
v_exp_f32 v93,v93
v_mfma_f32_16x16x32_bf16 v[76:79],a[172:175],v[236:239],v[76:79]
ds_read_b128 v[232:235],v17 offset:37888
v_exp_f32 v94,v94
s_waitcnt lgkmcnt(5)
v_mfma_f32_16x16x32_bf16 v[68:71],a[48:51],v[240:243],v[68:71]
buffer_load_dwordx4 v16,s[20:23],s65 offen offset:2048 sc1 lds
v_exp_f32 v95,v95
v_mfma_f32_16x16x32_bf16 v[76:79],a[176:179],v[240:243],v[76:79]
ds_read_b128 v[236:239],v17 offset:39936
s_xor_b32 m0,s72,17408
v_fma_f32 v92,v92,v123,v123
v_fma_f32 v93,v93,v123,v123
v_mfma_f32_16x16x32_bf16 v[68:71],a[52:55],v[244:247],v[68:71]
s_add_u32 s65,s89,32768
v_min3_u32 v27,v27,v240,v244
v_fma_f32 v94,v94,v123,v123
v_fma_f32 v95,v95,v123,v123
v_mfma_f32_16x16x32_bf16 v[76:79],a[180:183],v[244:247],v[76:79]
ds_read_b128 v[240:243],v17 offset:41984
v_rcp_f32 v92,v92
s_waitcnt lgkmcnt(5)
v_mfma_f32_16x16x32_bf16 v[68:71],a[56:59],v[248:251],v[68:71]
buffer_load_dwordx4 v16,s[20:23],s65 offen offset:0 sc1 lds
v_rcp_f32 v93,v93
v_mfma_f32_16x16x32_bf16 v[76:79],a[184:187],v[248:251],v[76:79]
ds_read_b128 v[244:247],v17 offset:44032
v_min3_u32 v27,v27,v248,v252
v_rcp_f32 v94,v94
v_mfma_f32_16x16x32_bf16 v[68:71],a[60:63],v[252:255],v[68:71]
buffer_load_dwordx4 v16,s[20:23],s65 offen offset:2048 sc1 lds
v_rcp_f32 v95,v95
v_mfma_f32_16x16x32_bf16 v[76:79],a[188:191],v[252:255],v[76:79]
ds_read_b128 v[248:251],v17 offset:46080
v_mul_f32 v92,v92,v72
v_mul_f32 v93,v93,v73
s_waitcnt lgkmcnt(5)
v_mfma_f32_16x16x32_bf16 v[68:71],a[64:67],v[224:227],v[68:71]
s_xor_b32 m0,s72,33792
s_add_u32 s65,s89,65536
v_mfma_f32_16x16x32_bf16 v[76:79],a[192:195],v[224:227],v[76:79]
ds_read_b128 v[252:255],v17 offset:48128
v_min3_u32 v27,v27,v224,v228
v_mfma_f32_16x16x32_bf16 v[68:71],a[68:71],v[228:231],v[68:71]
buffer_load_dwordx4 v16,s[20:23],s65 offen offset:0 sc1 lds
v_mfma_f32_16x16x32_bf16 v[76:79],a[196:199],v[228:231],v[76:79]
ds_read_b128 v[224:227],v17 offset:50176
s_waitcnt lgkmcnt(5)
v_mfma_f32_16x16x32_bf16 v[68:71],a[72:75],v[232:235],v[68:71]
buffer_load_dwordx4 v16,s[20:23],s65 offen offset:2048 sc1 lds
v_mfma_f32_16x16x32_bf16 v[76:79],a[200:203],v[232:235],v[76:79]
ds_read_b128 v[228:231],v17 offset:52224
s_xor_b32 m0,s72,50176
v_mfma_f32_16x16x32_bf16 v[68:71],a[76:79],v[236:239],v[68:71]
s_add_u32 s65,s89,98304
v_min3_u32 v27,v27,v232,v236
v_mfma_f32_16x16x32_bf16 v[76:79],a[204:207],v[236:239],v[76:79]
ds_read_b128 v[232:235],v17 offset:54272
s_waitcnt lgkmcnt(5)
v_mfma_f32_16x16x32_bf16 v[68:71],a[80:83],v[240:243],v[68:71]
buffer_load_dwordx4 v16,s[20:23],s65 offen offset:0 sc1 lds
v_mfma_f32_16x16x32_bf16 v[76:79],a[208:211],v[240:243],v[76:79]
ds_read_b128 v[236:239],v17 offset:56320
v_min3_u32 v27,v27,v240,v244
v_mfma_f32_16x16x32_bf16 v[68:71],a[84:87],v[244:247],v[68:71]
buffer_load_dwordx4 v16,s[20:23],s65 offen offset:2048 sc1 lds
v_mfma_f32_16x16x32_bf16 v[76:79],a[212:215],v[244:247],v[76:79]
ds_read_b128 v[240:243],v17 offset:58368
s_waitcnt lgkmcnt(5)
v_mfma_f32_16x16x32_bf16 v[68:71],a[88:91],v[248:251],v[68:71]
v_min3_u32 v27,v27,v248,v252
v_exp_f32 v88,v88
v_mfma_f32_16x16x32_bf16 v[76:79],a[216:219],v[248:251],v[76:79]
ds_read_b128 v[244:247],v17 offset:60416
v_exp_f32 v89,v89
v_mfma_f32_16x16x32_bf16 v[68:71],a[92:95],v[252:255],v[68:71]
v_exp_f32 v90,v90
v_mfma_f32_16x16x32_bf16 v[76:79],a[220:223],v[252:255],v[76:79]
ds_read_b128 v[248:251],v17 offset:62464
s_waitcnt lgkmcnt(5)
v_mfma_f32_16x16x32_bf16 v[68:71],a[96:99],v[224:227],v[68:71]
v_min3_u32 v27,v27,v224,v228
v_exp_f32 v91,v91
v_mfma_f32_16x16x32_bf16 v[76:79],a[224:227],v[224:227],v[76:79]
ds_read_b128 v[252:255],v17 offset:64512
v_fma_f32 v88,v88,v123,v123
v_fma_f32 v89,v89,v123,v123
v_mfma_f32_16x16x32_bf16 v[68:71],a[100:103],v[228:231],v[68:71]
v_fma_f32 v90,v90,v123,v123
v_fma_f32 v91,v91,v123,v123
v_mfma_f32_16x16x32_bf16 v[76:79],a[228:231],v[228:231],v[76:79]
v_rcp_f32 v88,v88
s_waitcnt lgkmcnt(4)
v_mfma_f32_16x16x32_bf16 v[68:71],a[104:107],v[232:235],v[68:71]
v_min3_u32 v27,v27,v232,v236
v_rcp_f32 v89,v89
v_mfma_f32_16x16x32_bf16 v[76:79],a[232:235],v[232:235],v[76:79]
v_rcp_f32 v90,v90
v_mfma_f32_16x16x32_bf16 v[68:71],a[108:111],v[236:239],v[68:71]
v_rcp_f32 v91,v91
v_mfma_f32_16x16x32_bf16 v[76:79],a[236:239],v[236:239],v[76:79]
v_mul_f32 v88,v88,v64
s_waitcnt lgkmcnt(2)
v_mfma_f32_16x16x32_bf16 v[68:71],a[112:115],v[240:243],v[68:71]
v_min3_u32 v27,v27,v240,v244
v_mul_f32 v89,v89,v65
v_mfma_f32_16x16x32_bf16 v[76:79],a[240:243],v[240:243],v[76:79]
v_mul_f32 v90,v90,v66
v_mul_f32 v91,v91,v67
v_mfma_f32_16x16x32_bf16 v[68:71],a[116:119],v[244:247],v[68:71]
v_mul_f32 v94,v94,v74
v_mul_f32 v95,v95,v75
v_mfma_f32_16x16x32_bf16 v[76:79],a[244:247],v[244:247],v[76:79]
v_cvt_pk_bf16_f32 v96,v88,v89
s_waitcnt lgkmcnt(0)
v_mfma_f32_16x16x32_bf16 v[68:71],a[120:123],v[248:251],v[68:71]
v_min3_u32 v27,v27,v248,v252
v_cvt_pk_bf16_f32 v97,v90,v91
v_mfma_f32_16x16x32_bf16 v[76:79],a[248:251],v[248:251],v[76:79]
v_cvt_pk_bf16_f32 v98,v92,v93
v_cvt_pk_bf16_f32 v99,v94,v95
v_mfma_f32_16x16x32_bf16 v[68:71],a[124:127],v[252:255],v[68:71]
v_max_u32 v96,1,v96
v_mfma_f32_16x16x32_bf16 v[76:79],a[252:255],v[252:255],v[76:79]
buffer_store_dwordx4 v[96:99],v18,s[20:23],s70 offen offset:0 sc1
v_cmp_eq_u32 vcc,0,v27
s_cbranch_vccnz retry_377
s_branch epi_380
keep_389:
v_mfma_f32_16x16x32_bf16 v[64:67],a[124:127],v[252:255],v[64:67]
v_min3_u32 v27,v27,v248,v252
v_mfma_f32_16x16x32_bf16 v[72:75],a[252:255],v[252:255],v[72:75]
ds_read_b128 v[248:251],v17 offset:13312
s_waitcnt lgkmcnt(6)
v_mfma_f32_16x16x32_bf16 v[68:71],a[0:3],v[224:227],0
v_cmp_eq_u32 vcc,0,v27
s_cbranch_vccnz retry_377
v_mfma_f32_16x16x32_bf16 v[76:79],a[128:131],v[224:227],0
ds_read_b128 v[252:255],v17 offset:15360
v_min3_u32 v27,v27,v224,v228
v_mfma_f32_16x16x32_bf16 v[68:71],a[4:7],v[228:231],v[68:71]
s_waitcnt lgkmcnt(6)
v_mfma_f32_16x16x32_bf16 v[76:79],a[132:135],v[228:231],v[76:79]
ds_read_b128 v[224:227],v17 offset:17408
s_waitcnt lgkmcnt(5)
v_mfma_f32_16x16x32_bf16 v[68:71],a[8:11],v[232:235],v[68:71]
v_min3_u32 v27,v27,v232,v236
v_fmac_f32 v64,v52,v120
v_fmac_f32 v72,v56,v120
v_mfma_f32_16x16x32_bf16 v[76:79],a[136:139],v[232:235],v[76:79]
ds_read_b128 v[228:231],v17 offset:19456
v_fmac_f32 v65,v53,v120
v_fmac_f32 v73,v57,v120
v_mfma_f32_16x16x32_bf16 v[68:71],a[12:15],v[236:239],v[68:71]
v_fmac_f32 v66,v54,v120
v_fmac_f32 v67,v55,v120
v_fmac_f32 v74,v58,v120
v_mfma_f32_16x16x32_bf16 v[76:79],a[140:143],v[236:239],v[76:79]
ds_read_b128 v[232:235],v17 offset:21504
v_fmac_f32 v75,v59,v120
s_waitcnt lgkmcnt(5)
v_mfma_f32_16x16x32_bf16 v[68:71],a[16:19],v[240:243],v[68:71]
v_min3_u32 v27,v27,v240,v244
v_mul_f32 v88,v64,v64
v_mul_f32 v92,v72,v72
v_mfma_f32_16x16x32_bf16 v[76:79],a[144:147],v[240:243],v[76:79]
ds_read_b128 v[236:239],v17 offset:23552
v_mul_f32 v89,v65,v65
v_mul_f32 v93,v73,v73
v_mfma_f32_16x16x32_bf16 v[68:71],a[20:23],v[244:247],v[68:71]
v_mul_f32 v90,v66,v66
v_mul_f32 v91,v67,v67
v_mul_f32 v94,v74,v74
v_mfma_f32_16x16x32_bf16 v[76:79],a[148:151],v[244:247],v[76:79]
ds_read_b128 v[240:243],v17 offset:25600
v_mul_f32 v95,v75,v75
s_waitcnt lgkmcnt(5)
v_mfma_f32_16x16x32_bf16 v[68:71],a[24:27],v[248:251],v[68:71]
v_min3_u32 v27,v27,v248,v252
v_fma_f32 v88,v88,v121,v122
v_fma_f32 v92,v92,v121,v122
v_mfma_f32_16x16x32_bf16 v[76:79],a[152:155],v[248:251],v[76:79]
ds_read_b128 v[244:247],v17 offset:27648
v_fma_f32 v89,v89,v121,v122
v_fma_f32 v93,v93,v121,v122
v_mfma_f32_16x16x32_bf16 v[68:71],a[28:31],v[252:255],v[68:71]
v_fma_f32 v90,v90,v121,v122
v_fma_f32 v91,v91,v121,v122
v_fma_f32 v94,v94,v121,v122
v_mfma_f32_16x16x32_bf16 v[76:79],a[156:159],v[252:255],v[76:79]
ds_read_b128 v[248:251],v17 offset:29696
v_fma_f32 v95,v95,v121,v122
s_waitcnt lgkmcnt(5)
v_mfma_f32_16x16x32_bf16 v[68:71],a[32:35],v[224:227],v[68:71]
v_min3_u32 v27,v27,v224,v228
v_mul_f32 v88,v88,v64
v_mul_f32 v92,v92,v72
v_mfma_f32_16x16x32_bf16 v[76:79],a[160:163],v[224:227],v[76:79]
ds_read_b128 v[252:255],v17 offset:31744
v_mul_f32 v89,v89,v65
v_mul_f32 v93,v93,v73
v_mfma_f32_16x16x32_bf16 v[68:71],a[36:39],v[228:231],v[68:71]
v_mul_f32 v90,v90,v66
v_mul_f32 v91,v91,v67
v_mul_f32 v94,v94,v74
v_mfma_f32_16x16x32_bf16 v[76:79],a[164:167],v[228:231],v[76:79]
ds_read_b128 v[224:227],v17 offset:33792
v_mul_f32 v95,v95,v75
s_waitcnt lgkmcnt(5)
v_mfma_f32_16x16x32_bf16 v[68:71],a[40:43],v[232:235],v[68:71]
v_min3_u32 v27,v27,v232,v236
v_exp_f32 v92,v92
v_mfma_f32_16x16x32_bf16 v[76:79],a[168:171],v[232:235],v[76:79]
ds_read_b128 v[228:231],v17 offset:35840
v_exp_f32 v93,v93
v_mfma_f32_16x16x32_bf16 v[68:71],a[44:47],v[236:239],v[68:71]
v_exp_f32 v88,v88
v_mfma_f32_16x16x32_bf16 v[76:79],a[172:175],v[236:239],v[76:79]
ds_read_b128 v[232:235],v17 offset:37888
s_waitcnt lgkmcnt(5)
v_mfma_f32_16x16x32_bf16 v[68:71],a[48:51],v[240:243],v[68:71]
v_min3_u32 v27,v27,v240,v244
v_exp_f32 v94,v94
v_mfma_f32_16x16x32_bf16 v[76:79],a[176:179],v[240:243],v[76:79]
ds_read_b128 v[236:239],v17 offset:39936
v_exp_f32 v95,v95
v_mfma_f32_16x16x32_bf16 v[68:71],a[52:55],v[244:247],v[68:71]
v_exp_f32 v89,v89
v_fma_f32 v92,v92,v123,v123
v_mfma_f32_16x16x32_bf16 v[76:79],a[180:183],v[244:247],v[76:79]
ds_read_b128 v[240:243],v17 offset:41984
v_fma_f32 v93,v93,v123,v123
s_waitcnt lgkmcnt(5)
v_mfma_f32_16x16x32_bf16 v[68:71],a[56:59],v[248:251],v[68:71]
v_min3_u32 v27,v27,v248,v252
v_fma_f32 v94,v94,v123,v123
v_fma_f32 v95,v95,v123,v123
v_mfma_f32_16x16x32_bf16 v[76:79],a[184:187],v[248:251],v[76:79]
ds_read_b128 v[244:247],v17 offset:44032
v_rcp_f32 v92,v92
v_mfma_f32_16x16x32_bf16 v[68:71],a[60:63],v[252:255],v[68:71]
v_exp_f32 v90,v90
v_mfma_f32_16x16x32_bf16 v[76:79],a[188:191],v[252:255],v[76:79]
ds_read_b128 v[248:251],v17 offset:46080
s_waitcnt lgkmcnt(5)
v_mfma_f32_16x16x32_bf16 v[68:71],a[64:67],v[224:227],v[68:71]
v_min3_u32 v27,v27,v224,v228
v_rcp_f32 v93,v93
v_mfma_f32_16x16x32_bf16 v[76:79],a[192:195],v[224:227],v[76:79]
ds_read_b128 v[252:255],v17 offset:48128
v_rcp_f32 v94,v94
v_mfma_f32_16x16x32_bf16 v[68:71],a[68:71],v[228:231],v[68:71]
v_exp_f32 v91,v91
v_mfma_f32_16x16x32_bf16 v[76:79],a[196:199],v[228:231],v[76:79]
ds_read_b128 v[224:227],v17 offset:50176
s_waitcnt lgkmcnt(5)
v_mfma_f32_16x16x32_bf16 v[68:71],a[72:75],v[232:235],v[68:71]
v_min3_u32 v27,v27,v232,v236
v_fma_f32 v88,v88,v123,v123
v_mfma_f32_16x16x32_bf16 v[76:79],a[200:203],v[232:235],v[76:79]
ds_read_b128 v[228:231],v17 offset:52224
v_fma_f32 v89,v89,v123,v123
v_mfma_f32_16x16x32_bf16 v[68:71],a[76:79],v[236:239],v[68:71]
v_fma_f32 v90,v90,v123,v123
v_fma_f32 v91,v91,v123,v123
v_mfma_f32_16x16x32_bf16 v[76:79],a[204:207],v[236:239],v[76:79]
ds_read_b128 v[232:235],v17 offset:54272
s_waitcnt lgkmcnt(5)
v_mfma_f32_16x16x32_bf16 v[68:71],a[80:83],v[240:243],v[68:71]
v_min3_u32 v27,v27,v240,v244
v_rcp_f32 v95,v95
v_mfma_f32_16x16x32_bf16 v[76:79],a[208:211],v[240:243],v[76:79]
ds_read_b128 v[236:239],v17 offset:56320
v_mul_f32 v92,v92,v72
v_mfma_f32_16x16x32_bf16 v[68:71],a[84:87],v[244:247],v[68:71]
v_rcp_f32 v88,v88
v_mfma_f32_16x16x32_bf16 v[76:79],a[212:215],v[244:247],v[76:79]
ds_read_b128 v[240:243],v17 offset:58368
s_waitcnt lgkmcnt(5)
v_mfma_f32_16x16x32_bf16 v[68:71],a[88:91],v[248:251],v[68:71]
v_min3_u32 v27,v27,v248,v252
v_mul_f32 v93,v93,v73
v_mfma_f32_16x16x32_bf16 v[76:79],a[216:219],v[248:251],v[76:79]
ds_read_b128 v[244:247],v17 offset:60416
v_mul_f32 v94,v94,v74
v_mfma_f32_16x16x32_bf16 v[68:71],a[92:95],v[252:255],v[68:71]
v_rcp_f32 v89,v89
v_mfma_f32_16x16x32_bf16 v[76:79],a[220:223],v[252:255],v[76:79]
ds_read_b128 v[248:251],v17 offset:62464
s_waitcnt lgkmcnt(5)
v_mfma_f32_16x16x32_bf16 v[68:71],a[96:99],v[224:227],v[68:71]
v_min3_u32 v27,v27,v224,v228
v_mul_f32 v95,v95,v75
v_mfma_f32_16x16x32_bf16 v[76:79],a[224:227],v[224:227],v[76:79]
ds_read_b128 v[252:255],v17 offset:64512
v_mfma_f32_16x16x32_bf16 v[68:71],a[100:103],v[228:231],v[68:71]
v_rcp_f32 v90,v90
v_mfma_f32_16x16x32_bf16 v[76:79],a[228:231],v[228:231],v[76:79]
s_waitcnt lgkmcnt(4)
v_mfma_f32_16x16x32_bf16 v[68:71],a[104:107],v[232:235],v[68:71]
v_min3_u32 v27,v27,v232,v236
v_mfma_f32_16x16x32_bf16 v[76:79],a[232:235],v[232:235],v[76:79]
v_rcp_f32 v91,v91
v_mfma_f32_16x16x32_bf16 v[68:71],a[108:111],v[236:239],v[68:71]
v_mul_f32 v88,v88,v64
v_mul_f32 v89,v89,v65
v_mfma_f32_16x16x32_bf16 v[76:79],a[236:239],v[236:239],v[76:79]
v_mul_f32 v90,v90,v66
s_waitcnt lgkmcnt(2)
v_mfma_f32_16x16x32_bf16 v[68:71],a[112:115],v[240:243],v[68:71]
v_min3_u32 v27,v27,v240,v244
v_mul_f32 v91,v91,v67
v_mfma_f32_16x16x32_bf16 v[76:79],a[240:243],v[240:243],v[76:79]
v_cvt_pk_bf16_f32 v96,v88,v89
v_cvt_pk_bf16_f32 v97,v90,v91
v_mfma_f32_16x16x32_bf16 v[68:71],a[116:119],v[244:247],v[68:71]
v_cvt_pk_bf16_f32 v98,v92,v93
v_cvt_pk_bf16_f32 v99,v94,v95
v_mfma_f32_16x16x32_bf16 v[76:79],a[244:247],v[244:247],v[76:79]
v_max_u32 v96,1,v96
s_waitcnt lgkmcnt(0)
v_mfma_f32_16x16x32_bf16 v[68:71],a[120:123],v[248:251],v[68:71]
v_min3_u32 v27,v27,v248,v252
v_mfma_f32_16x16x32_bf16 v[76:79],a[248:251],v[248:251],v[76:79]
buffer_store_dwordx4 v[96:99],v18,s[20:23],s70 offen offset:0 sc1
v_mfma_f32_16x16x32_bf16 v[68:71],a[124:127],v[252:255],v[68:71]
v_mfma_f32_16x16x32_bf16 v[76:79],a[252:255],v[252:255],v[76:79]
v_cmp_eq_u32 vcc,0,v27
s_cbranch_vccnz retry_377
s_branch epi_380
both_381:
s_waitcnt vmcnt(12) lgkmcnt(0)
s_barrier
ds_read_b128 v[224:227],v17 offset:0
ds_read_b128 v[228:231],v17 offset:2048
ds_read_b128 v[232:235],v17 offset:4096
ds_read_b128 v[236:239],v17 offset:6144
ds_read_b128 v[240:243],v17 offset:8192
ds_read_b128 v[244:247],v17 offset:10240
ds_read_b128 v[248:251],v17 offset:12288
s_waitcnt lgkmcnt(5)
v_mfma_f32_16x16x32_bf16 v[64:67],a[0:3],v[224:227],0
s_add_u32 s96,s71,1
s_add_u32 s92,s71,2
s_add_u32 s88,s70,s75
v_mfma_f32_16x16x32_bf16 v[72:75],a[128:131],v[224:227],0
ds_read_b128 v[252:255],v17 offset:14336
s_add_u32 s88,s88,2097152
s_xor_b32 s88,s88,0x2000
v_mfma_f32_16x16x32_bf16 v[64:67],a[4:7],v[228:231],v[64:67]
s_cmp_eq_u32 s96,64
s_cselect_b32 s96,99,s96
v_min_u32 v27,v224,v228
v_mfma_f32_16x16x32_bf16 v[72:75],a[132:135],v[228:231],v[72:75]
ds_read_b128 v[224:227],v17 offset:16384
s_waitcnt lgkmcnt(5)
v_mfma_f32_16x16x32_bf16 v[64:67],a[8:11],v[232:235],v[64:67]
s_cmp_eq_u32 s92,64
s_cselect_b32 s92,99,s92
v_mfma_f32_16x16x32_bf16 v[72:75],a[136:139],v[232:235],v[72:75]
ds_read_b128 v[228:231],v17 offset:18432
s_xor_b32 s89,s88,1024
v_mfma_f32_16x16x32_bf16 v[64:67],a[12:15],v[236:239],v[64:67]
s_xor_b32 m0,s72,0
v_min3_u32 v27,v27,v232,v236
v_mfma_f32_16x16x32_bf16 v[72:75],a[140:143],v[236:239],v[72:75]
ds_read_b128 v[232:235],v17 offset:20480
s_add_u32 s65,s88,0
s_waitcnt lgkmcnt(5)
v_mfma_f32_16x16x32_bf16 v[64:67],a[16:19],v[240:243],v[64:67]
v_min3_u32 v27,v27,v240,v244
v_mfma_f32_16x16x32_bf16 v[72:75],a[144:147],v[240:243],v[72:75]
ds_read_b128 v[236:239],v17 offset:22528
buffer_load_dwordx4 v16,s[20:23],s65 offen offset:0 sc1 lds
v_mfma_f32_16x16x32_bf16 v[64:67],a[20:23],v[244:247],v[64:67]
buffer_load_dwordx4 v16,s[20:23],s65 offen offset:2048 sc1 lds
v_mfma_f32_16x16x32_bf16 v[72:75],a[148:151],v[244:247],v[72:75]
ds_read_b128 v[240:243],v17 offset:24576
s_waitcnt lgkmcnt(5)
v_mfma_f32_16x16x32_bf16 v[64:67],a[24:27],v[248:251],v[64:67]
s_xor_b32 m0,s72,16384
v_min3_u32 v27,v27,v248,v252
v_mfma_f32_16x16x32_bf16 v[72:75],a[152:155],v[248:251],v[72:75]
ds_read_b128 v[244:247],v17 offset:26624
v_mfma_f32_16x16x32_bf16 v[64:67],a[28:31],v[252:255],v[64:67]
s_add_u32 s65,s88,32768
v_mfma_f32_16x16x32_bf16 v[72:75],a[156:159],v[252:255],v[72:75]
ds_read_b128 v[248:251],v17 offset:28672
s_waitcnt lgkmcnt(5)
v_mfma_f32_16x16x32_bf16 v[64:67],a[32:35],v[224:227],v[64:67]
buffer_load_dwordx4 v16,s[20:23],s65 offen offset:0 sc1 lds
v_mfma_f32_16x16x32_bf16 v[72:75],a[160:163],v[224:227],v[72:75]
ds_read_b128 v[252:255],v17 offset:30720
buffer_load_dwordx4 v16,s[20:23],s65 offen offset:2048 sc1 lds
v_mfma_f32_16x16x32_bf16 v[64:67],a[36:39],v[228:231],v[64:67]
v_min3_u32 v27,v27,v224,v228
v_mfma_f32_16x16x32_bf16 v[72:75],a[164:167],v[228:231],v[72:75]
ds_read_b128 v[224:227],v17 offset:32768
s_xor_b32 m0,s72,32768
s_waitcnt lgkmcnt(5)
v_mfma_f32_16x16x32_bf16 v[64:67],a[40:43],v[232:235],v[64:67]
s_add_u32 s65,s88,65536
v_min3_u32 v27,v27,v232,v236
v_mfma_f32_16x16x32_bf16 v[72:75],a[168:171],v[232:235],v[72:75]
ds_read_b128 v[228:231],v17 offset:34816
v_mfma_f32_16x16x32_bf16 v[64:67],a[44:47],v[236:239],v[64:67]
buffer_load_dwordx4 v16,s[20:23],s65 offen offset:0 sc1 lds
v_mfma_f32_16x16x32_bf16 v[72:75],a[172:175],v[236:239],v[72:75]
ds_read_b128 v[232:235],v17 offset:36864
s_waitcnt lgkmcnt(5)
v_mfma_f32_16x16x32_bf16 v[64:67],a[48:51],v[240:243],v[64:67]
buffer_load_dwordx4 v16,s[20:23],s65 offen offset:2048 sc1 lds
v_mfma_f32_16x16x32_bf16 v[72:75],a[176:179],v[240:243],v[72:75]
ds_read_b128 v[236:239],v17 offset:38912
s_xor_b32 m0,s72,49152
v_mfma_f32_16x16x32_bf16 v[64:67],a[52:55],v[244:247],v[64:67]
v_min3_u32 v27,v27,v240,v244
v_mfma_f32_16x16x32_bf16 v[72:75],a[180:183],v[244:247],v[72:75]
ds_read_b128 v[240:243],v17 offset:40960
s_add_u32 s65,s88,98304
s_waitcnt lgkmcnt(5)
v_mfma_f32_16x16x32_bf16 v[64:67],a[56:59],v[248:251],v[64:67]
buffer_load_dwordx4 v16,s[20:23],s65 offen offset:0 sc1 lds
v_min3_u32 v27,v27,v248,v252
v_mfma_f32_16x16x32_bf16 v[72:75],a[184:187],v[248:251],v[72:75]
ds_read_b128 v[244:247],v17 offset:43008
s_waitcnt vmcnt(9)
v_mfma_f32_16x16x32_bf16 v[64:67],a[60:63],v[252:255],v[64:67]
v_cmp_gt_u32 vcc,s96,v29
v_cmp_gt_u32 s[92:93],s92,v29
v_mfma_f32_16x16x32_bf16 v[72:75],a[188:191],v[252:255],v[72:75]
ds_read_b128 v[248:251],v17 offset:45056
s_waitcnt lgkmcnt(5)
v_mfma_f32_16x16x32_bf16 v[64:67],a[64:67],v[224:227],v[64:67]
v_mov_b32 v44,vcc_lo
v_mov_b32 v45,s92
v_min3_u32 v27,v27,v224,v228
v_mfma_f32_16x16x32_bf16 v[72:75],a[192:195],v[224:227],v[72:75]
ds_read_b128 v[252:255],v17 offset:47104
ds_write_b64 v46,v[44:45]
v_mfma_f32_16x16x32_bf16 v[64:67],a[68:71],v[228:231],v[64:67]
buffer_load_dwordx4 v16,s[20:23],s65 offen offset:2048 sc1 lds
v_mfma_f32_16x16x32_bf16 v[72:75],a[196:199],v[228:231],v[72:75]
ds_read_b128 v[224:227],v17 offset:49152
s_waitcnt lgkmcnt(6)
v_mfma_f32_16x16x32_bf16 v[64:67],a[72:75],v[232:235],v[64:67]
s_xor_b32 m0,s72,1024
s_add_u32 s65,s89,0
v_mfma_f32_16x16x32_bf16 v[72:75],a[200:203],v[232:235],v[72:75]
ds_read_b128 v[228:231],v17 offset:51200
v_min3_u32 v27,v27,v232,v236
v_mfma_f32_16x16x32_bf16 v[64:67],a[76:79],v[236:239],v[64:67]
buffer_load_dwordx4 v16,s[20:23],s65 offen offset:0 sc1 lds
v_mfma_f32_16x16x32_bf16 v[72:75],a[204:207],v[236:239],v[72:75]
ds_read_b128 v[232:235],v17 offset:53248
s_waitcnt lgkmcnt(6)
v_mfma_f32_16x16x32_bf16 v[64:67],a[80:83],v[240:243],v[64:67]
buffer_load_dwordx4 v16,s[20:23],s65 offen offset:2048 sc1 lds
v_mfma_f32_16x16x32_bf16 v[72:75],a[208:211],v[240:243],v[72:75]
ds_read_b128 v[236:239],v17 offset:55296
s_xor_b32 m0,s72,17408
v_mfma_f32_16x16x32_bf16 v[64:67],a[84:87],v[244:247],v[64:67]
s_add_u32 s65,s89,32768
v_min3_u32 v27,v27,v240,v244
v_mfma_f32_16x16x32_bf16 v[72:75],a[212:215],v[244:247],v[72:75]
ds_read_b128 v[240:243],v17 offset:57344
s_waitcnt lgkmcnt(6)
v_mfma_f32_16x16x32_bf16 v[64:67],a[88:91],v[248:251],v[64:67]
buffer_load_dwordx4 v16,s[20:23],s65 offen offset:0 sc1 lds
v_mfma_f32_16x16x32_bf16 v[72:75],a[216:219],v[248:251],v[72:75]
ds_read_b128 v[244:247],v17 offset:59392
v_min3_u32 v27,v27,v248,v252
v_mfma_f32_16x16x32_bf16 v[64:67],a[92:95],v[252:255],v[64:67]
buffer_load_dwordx4 v16,s[20:23],s65 offen offset:2048 sc1 lds
v_mfma_f32_16x16x32_bf16 v[72:75],a[220:223],v[252:255],v[72:75]
ds_read_b128 v[248:251],v17 offset:61440
s_waitcnt lgkmcnt(5)
v_mfma_f32_16x16x32_bf16 v[64:67],a[96:99],v[224:227],v[64:67]
s_xor_b32 m0,s72,33792
s_add_u32 s65,s89,65536
v_mfma_f32_16x16x32_bf16 v[72:75],a[224:227],v[224:227],v[72:75]
ds_read_b128 v[252:255],v17 offset:63488
v_min3_u32 v27,v27,v224,v228
v_mfma_f32_16x16x32_bf16 v[64:67],a[100:103],v[228:231],v[64:67]
buffer_load_dwordx4 v16,s[20:23],s65 offen offset:0 sc1 lds
s_waitcnt vmcnt(13)
v_add_u32 v22,s71,-1
v_mfma_f32_16x16x32_bf16 v[72:75],a[228:231],v[228:231],v[72:75]
s_waitcnt vmcnt(17)
s_barrier
ds_read_b64 v[44:45],v47
ds_read_b128 v[224:227],v17 offset:1024
s_waitcnt lgkmcnt(6)
v_mfma_f32_16x16x32_bf16 v[64:67],a[104:107],v[232:235],v[64:67]
buffer_load_dwordx4 v16,s[20:23],s65 offen offset:2048 sc1 lds
buffer_store_dword v22,v23,s[20:23],s97 offen sc1
v_mfma_f32_16x16x32_bf16 v[72:75],a[232:235],v[232:235],v[72:75]
ds_read_b128 v[228:231],v17 offset:3072
s_xor_b32 m0,s72,50176
s_mov_b32 s97,0x7fff0000
v_mfma_f32_16x16x32_bf16 v[64:67],a[108:111],v[236:239],v[64:67]
s_add_u32 s65,s89,98304
v_min3_u32 v27,v27,v232,v236
ds_read_b128 v[124:127],v19 offset:256
v_mfma_f32_16x16x32_bf16 v[72:75],a[236:239],v[236:239],v[72:75]
ds_read_b128 v[232:235],v17 offset:5120
ds_read_b128 v[120:123],v19 offset:0
s_waitcnt lgkmcnt(8)
v_mfma_f32_16x16x32_bf16 v[64:67],a[112:115],v[240:243],v[64:67]
buffer_load_dwordx4 v16,s[20:23],s65 offen offset:0 sc1 lds
v_mfma_f32_16x16x32_bf16 v[72:75],a[240:243],v[240:243],v[72:75]
ds_read_b128 v[236:239],v17 offset:7168
v_min3_u32 v27,v27,v240,v244
v_mfma_f32_16x16x32_bf16 v[64:67],a[116:119],v[244:247],v[64:67]
buffer_load_dwordx4 v16,s[20:23],s65 offen offset:2048 sc1 lds
v_mfma_f32_16x16x32_bf16 v[72:75],a[244:247],v[244:247],v[72:75]
ds_read_b128 v[240:243],v17 offset:9216
s_waitcnt lgkmcnt(8)
v_mfma_f32_16x16x32_bf16 v[64:67],a[120:123],v[248:251],v[64:67]
s_waitcnt lgkmcnt(7)
v_readfirstlane_b32 s93,v45
v_mfma_f32_16x16x32_bf16 v[72:75],a[248:251],v[248:251],v[72:75]
ds_read_b128 v[244:247],v17 offset:11264
v_min3_u32 v27,v27,v248,v252
v_mfma_f32_16x16x32_bf16 v[64:67],a[124:127],v[252:255],v[64:67]
v_mfma_f32_16x16x32_bf16 v[72:75],a[252:255],v[252:255],v[72:75]
ds_read_b128 v[248:251],v17 offset:13312
s_waitcnt lgkmcnt(7)
v_mfma_f32_16x16x32_bf16 v[68:71],a[0:3],v[224:227],0
v_cmp_eq_u32 vcc,0,v27
s_cbranch_vccnz retry_377
v_mfma_f32_16x16x32_bf16 v[76:79],a[128:131],v[224:227],0
ds_read_b128 v[252:255],v17 offset:15360
v_min3_u32 v27,v27,v224,v228
v_mfma_f32_16x16x32_bf16 v[68:71],a[4:7],v[228:231],v[68:71]
s_waitcnt lgkmcnt(5)
v_mfma_f32_16x16x32_bf16 v[76:79],a[132:135],v[228:231],v[76:79]
ds_read_b128 v[224:227],v17 offset:17408
s_waitcnt lgkmcnt(5)
v_mfma_f32_16x16x32_bf16 v[68:71],a[8:11],v[232:235],v[68:71]
v_min3_u32 v27,v27,v232,v236
v_fmac_f32 v64,v52,v120
v_fmac_f32 v72,v56,v120
v_mfma_f32_16x16x32_bf16 v[76:79],a[136:139],v[232:235],v[76:79]
ds_read_b128 v[228:231],v17 offset:19456
v_fmac_f32 v65,v53,v120
v_fmac_f32 v73,v57,v120
v_mfma_f32_16x16x32_bf16 v[68:71],a[12:15],v[236:239],v[68:71]
v_fmac_f32 v66,v54,v120
v_fmac_f32 v67,v55,v120
v_fmac_f32 v74,v58,v120
v_mfma_f32_16x16x32_bf16 v[76:79],a[140:143],v[236:239],v[76:79]
ds_read_b128 v[232:235],v17 offset:21504
v_fmac_f32 v75,v59,v120
s_waitcnt lgkmcnt(5)
v_mfma_f32_16x16x32_bf16 v[68:71],a[16:19],v[240:243],v[68:71]
v_min3_u32 v27,v27,v240,v244
v_mul_f32 v88,v64,v64
v_mul_f32 v92,v72,v72
v_mfma_f32_16x16x32_bf16 v[76:79],a[144:147],v[240:243],v[76:79]
ds_read_b128 v[236:239],v17 offset:23552
v_mul_f32 v89,v65,v65
v_mul_f32 v93,v73,v73
v_mfma_f32_16x16x32_bf16 v[68:71],a[20:23],v[244:247],v[68:71]
v_mul_f32 v90,v66,v66
v_mul_f32 v91,v67,v67
v_mul_f32 v94,v74,v74
v_mfma_f32_16x16x32_bf16 v[76:79],a[148:151],v[244:247],v[76:79]
ds_read_b128 v[240:243],v17 offset:25600
v_mul_f32 v95,v75,v75
s_waitcnt lgkmcnt(5)
v_mfma_f32_16x16x32_bf16 v[68:71],a[24:27],v[248:251],v[68:71]
v_min3_u32 v27,v27,v248,v252
v_fma_f32 v88,v88,v121,v122
v_fma_f32 v92,v92,v121,v122
v_mfma_f32_16x16x32_bf16 v[76:79],a[152:155],v[248:251],v[76:79]
ds_read_b128 v[244:247],v17 offset:27648
v_fma_f32 v89,v89,v121,v122
v_fma_f32 v93,v93,v121,v122
v_mfma_f32_16x16x32_bf16 v[68:71],a[28:31],v[252:255],v[68:71]
v_fma_f32 v90,v90,v121,v122
v_fma_f32 v91,v91,v121,v122
v_fma_f32 v94,v94,v121,v122
v_mfma_f32_16x16x32_bf16 v[76:79],a[156:159],v[252:255],v[76:79]
ds_read_b128 v[248:251],v17 offset:29696
v_fma_f32 v95,v95,v121,v122
s_waitcnt lgkmcnt(5)
v_mfma_f32_16x16x32_bf16 v[68:71],a[32:35],v[224:227],v[68:71]
v_min3_u32 v27,v27,v224,v228
v_mul_f32 v88,v88,v64
v_mul_f32 v92,v92,v72
v_mfma_f32_16x16x32_bf16 v[76:79],a[160:163],v[224:227],v[76:79]
ds_read_b128 v[252:255],v17 offset:31744
v_mul_f32 v89,v89,v65
v_mul_f32 v93,v93,v73
v_mfma_f32_16x16x32_bf16 v[68:71],a[36:39],v[228:231],v[68:71]
v_mul_f32 v90,v90,v66
v_mul_f32 v91,v91,v67
v_mul_f32 v94,v94,v74
v_mfma_f32_16x16x32_bf16 v[76:79],a[164:167],v[228:231],v[76:79]
ds_read_b128 v[224:227],v17 offset:33792
v_mul_f32 v95,v95,v75
s_waitcnt lgkmcnt(5)
v_mfma_f32_16x16x32_bf16 v[68:71],a[40:43],v[232:235],v[68:71]
v_min3_u32 v27,v27,v232,v236
v_exp_f32 v92,v92
v_mfma_f32_16x16x32_bf16 v[76:79],a[168:171],v[232:235],v[76:79]
ds_read_b128 v[228:231],v17 offset:35840
v_exp_f32 v93,v93
v_mfma_f32_16x16x32_bf16 v[68:71],a[44:47],v[236:239],v[68:71]
v_exp_f32 v88,v88
v_mfma_f32_16x16x32_bf16 v[76:79],a[172:175],v[236:239],v[76:79]
ds_read_b128 v[232:235],v17 offset:37888
s_waitcnt lgkmcnt(5)
v_mfma_f32_16x16x32_bf16 v[68:71],a[48:51],v[240:243],v[68:71]
v_min3_u32 v27,v27,v240,v244
v_exp_f32 v94,v94
v_mfma_f32_16x16x32_bf16 v[76:79],a[176:179],v[240:243],v[76:79]
ds_read_b128 v[236:239],v17 offset:39936
v_exp_f32 v95,v95
v_mfma_f32_16x16x32_bf16 v[68:71],a[52:55],v[244:247],v[68:71]
v_exp_f32 v89,v89
v_fma_f32 v92,v92,v123,v123
v_mfma_f32_16x16x32_bf16 v[76:79],a[180:183],v[244:247],v[76:79]
ds_read_b128 v[240:243],v17 offset:41984
v_fma_f32 v93,v93,v123,v123
s_waitcnt lgkmcnt(5)
v_mfma_f32_16x16x32_bf16 v[68:71],a[56:59],v[248:251],v[68:71]
v_min3_u32 v27,v27,v248,v252
v_fma_f32 v94,v94,v123,v123
v_fma_f32 v95,v95,v123,v123
v_mfma_f32_16x16x32_bf16 v[76:79],a[184:187],v[248:251],v[76:79]
ds_read_b128 v[244:247],v17 offset:44032
v_rcp_f32 v92,v92
v_mfma_f32_16x16x32_bf16 v[68:71],a[60:63],v[252:255],v[68:71]
v_exp_f32 v90,v90
v_mfma_f32_16x16x32_bf16 v[76:79],a[188:191],v[252:255],v[76:79]
ds_read_b128 v[248:251],v17 offset:46080
s_waitcnt lgkmcnt(5)
v_mfma_f32_16x16x32_bf16 v[68:71],a[64:67],v[224:227],v[68:71]
v_min3_u32 v27,v27,v224,v228
v_rcp_f32 v93,v93
v_mfma_f32_16x16x32_bf16 v[76:79],a[192:195],v[224:227],v[76:79]
ds_read_b128 v[252:255],v17 offset:48128
v_rcp_f32 v94,v94
v_mfma_f32_16x16x32_bf16 v[68:71],a[68:71],v[228:231],v[68:71]
v_exp_f32 v91,v91
v_mfma_f32_16x16x32_bf16 v[76:79],a[196:199],v[228:231],v[76:79]
ds_read_b128 v[224:227],v17 offset:50176
s_waitcnt lgkmcnt(5)
v_mfma_f32_16x16x32_bf16 v[68:71],a[72:75],v[232:235],v[68:71]
v_min3_u32 v27,v27,v232,v236
v_fma_f32 v88,v88,v123,v123
v_mfma_f32_16x16x32_bf16 v[76:79],a[200:203],v[232:235],v[76:79]
ds_read_b128 v[228:231],v17 offset:52224
v_fma_f32 v89,v89,v123,v123
v_mfma_f32_16x16x32_bf16 v[68:71],a[76:79],v[236:239],v[68:71]
v_fma_f32 v90,v90,v123,v123
v_fma_f32 v91,v91,v123,v123
v_mfma_f32_16x16x32_bf16 v[76:79],a[204:207],v[236:239],v[76:79]
ds_read_b128 v[232:235],v17 offset:54272
s_waitcnt lgkmcnt(5)
v_mfma_f32_16x16x32_bf16 v[68:71],a[80:83],v[240:243],v[68:71]
v_min3_u32 v27,v27,v240,v244
v_rcp_f32 v95,v95
v_mfma_f32_16x16x32_bf16 v[76:79],a[208:211],v[240:243],v[76:79]
ds_read_b128 v[236:239],v17 offset:56320
v_mul_f32 v92,v92,v72
v_mfma_f32_16x16x32_bf16 v[68:71],a[84:87],v[244:247],v[68:71]
v_rcp_f32 v88,v88
v_mfma_f32_16x16x32_bf16 v[76:79],a[212:215],v[244:247],v[76:79]
ds_read_b128 v[240:243],v17 offset:58368
s_waitcnt lgkmcnt(5)
v_mfma_f32_16x16x32_bf16 v[68:71],a[88:91],v[248:251],v[68:71]
v_min3_u32 v27,v27,v248,v252
v_mul_f32 v93,v93,v73
v_mfma_f32_16x16x32_bf16 v[76:79],a[216:219],v[248:251],v[76:79]
ds_read_b128 v[244:247],v17 offset:60416
v_mul_f32 v94,v94,v74
v_mfma_f32_16x16x32_bf16 v[68:71],a[92:95],v[252:255],v[68:71]
v_rcp_f32 v89,v89
v_mfma_f32_16x16x32_bf16 v[76:79],a[220:223],v[252:255],v[76:79]
ds_read_b128 v[248:251],v17 offset:62464
s_waitcnt lgkmcnt(5)
v_mfma_f32_16x16x32_bf16 v[68:71],a[96:99],v[224:227],v[68:71]
v_min3_u32 v27,v27,v224,v228
v_mul_f32 v95,v95,v75
v_mfma_f32_16x16x32_bf16 v[76:79],a[224:227],v[224:227],v[76:79]
ds_read_b128 v[252:255],v17 offset:64512
v_mfma_f32_16x16x32_bf16 v[68:71],a[100:103],v[228:231],v[68:71]
v_rcp_f32 v90,v90
v_mfma_f32_16x16x32_bf16 v[76:79],a[228:231],v[228:231],v[76:79]
s_waitcnt lgkmcnt(4)
v_mfma_f32_16x16x32_bf16 v[68:71],a[104:107],v[232:235],v[68:71]
v_min3_u32 v27,v27,v232,v236
v_mfma_f32_16x16x32_bf16 v[76:79],a[232:235],v[232:235],v[76:79]
v_rcp_f32 v91,v91
v_mfma_f32_16x16x32_bf16 v[68:71],a[108:111],v[236:239],v[68:71]
v_mul_f32 v88,v88,v64
v_mul_f32 v89,v89,v65
v_mfma_f32_16x16x32_bf16 v[76:79],a[236:239],v[236:239],v[76:79]
v_mul_f32 v90,v90,v66
s_waitcnt lgkmcnt(2)
v_mfma_f32_16x16x32_bf16 v[68:71],a[112:115],v[240:243],v[68:71]
v_min3_u32 v27,v27,v240,v244
v_mul_f32 v91,v91,v67
v_mfma_f32_16x16x32_bf16 v[76:79],a[240:243],v[240:243],v[76:79]
v_cvt_pk_bf16_f32 v96,v88,v89
v_cvt_pk_bf16_f32 v97,v90,v91
v_mfma_f32_16x16x32_bf16 v[68:71],a[116:119],v[244:247],v[68:71]
v_cvt_pk_bf16_f32 v98,v92,v93
v_cvt_pk_bf16_f32 v99,v94,v95
v_mfma_f32_16x16x32_bf16 v[76:79],a[244:247],v[244:247],v[76:79]
v_max_u32 v96,1,v96
s_waitcnt lgkmcnt(0)
v_mfma_f32_16x16x32_bf16 v[68:71],a[120:123],v[248:251],v[68:71]
v_min3_u32 v27,v27,v248,v252
v_mfma_f32_16x16x32_bf16 v[76:79],a[248:251],v[248:251],v[76:79]
buffer_store_dwordx4 v[96:99],v18,s[20:23],s70 offen offset:0 sc1
v_mfma_f32_16x16x32_bf16 v[68:71],a[124:127],v[252:255],v[68:71]
v_mfma_f32_16x16x32_bf16 v[76:79],a[252:255],v[252:255],v[76:79]
v_cmp_eq_u32 vcc,0,v27
s_cbranch_vccnz retry_377
epi_380:
buffer_load_dword v29,v21,s[20:23],s87 offen sc1
s_nop 3
v_pk_fma_f32 v[68:69],v[52:53],v[124:125],v[68:69] op_sel_hi:[1,0,1]
v_pk_fma_f32 v[70:71],v[54:55],v[124:125],v[70:71] op_sel_hi:[1,0,1]
v_pk_fma_f32 v[76:77],v[56:57],v[124:125],v[76:77] op_sel_hi:[1,0,1]
v_pk_fma_f32 v[78:79],v[58:59],v[124:125],v[78:79] op_sel_hi:[1,0,1]
v_pk_mul_f32 v[88:89],v[68:69],v[68:69]
v_pk_mul_f32 v[90:91],v[70:71],v[70:71]
v_pk_mul_f32 v[92:93],v[76:77],v[76:77]
v_pk_mul_f32 v[94:95],v[78:79],v[78:79]
v_pk_fma_f32 v[88:89],v[88:89],v[124:125],v[126:127] op_sel:[0,1,0] op_sel_hi:[1,1,0]
v_pk_fma_f32 v[90:91],v[90:91],v[124:125],v[126:127] op_sel:[0,1,0] op_sel_hi:[1,1,0]
v_pk_fma_f32 v[92:93],v[92:93],v[124:125],v[126:127] op_sel:[0,1,0] op_sel_hi:[1,1,0]
v_pk_fma_f32 v[94:95],v[94:95],v[124:125],v[126:127] op_sel:[0,1,0] op_sel_hi:[1,1,0]
v_pk_mul_f32 v[88:89],v[88:89],v[68:69]
v_pk_mul_f32 v[90:91],v[90:91],v[70:71]
v_pk_mul_f32 v[92:93],v[92:93],v[76:77]
v_pk_mul_f32 v[94:95],v[94:95],v[78:79]
v_exp_f32 v88,v88
v_exp_f32 v89,v89
v_exp_f32 v90,v90
v_exp_f32 v91,v91
v_exp_f32 v92,v92
v_exp_f32 v93,v93
v_exp_f32 v94,v94
s_cmp_gt_u32 s71,40
s_cselect_b32 s65,s73,0x7fff0000
s_cselect_b32 s97,0x7fff0000,s73
v_mov_b32 v22,s71
buffer_store_dword v22,v23,s[20:23],s65 offen sc1
v_exp_f32 v95,v95
v_pk_fma_f32 v[88:89],v[88:89],v[126:127],v[126:127] op_sel:[0,1,1] op_sel_hi:[1,1,1]
v_pk_fma_f32 v[90:91],v[90:91],v[126:127],v[126:127] op_sel:[0,1,1] op_sel_hi:[1,1,1]
v_pk_fma_f32 v[92:93],v[92:93],v[126:127],v[126:127] op_sel:[0,1,1] op_sel_hi:[1,1,1]
v_pk_fma_f32 v[94:95],v[94:95],v[126:127],v[126:127] op_sel:[0,1,1] op_sel_hi:[1,1,1]
v_rcp_f32 v88,v88
v_rcp_f32 v89,v89
v_rcp_f32 v90,v90
v_rcp_f32 v91,v91
v_rcp_f32 v92,v92
v_rcp_f32 v93,v93
v_rcp_f32 v94,v94
v_rcp_f32 v95,v95
v_pk_mul_f32 v[88:89],v[88:89],v[68:69]
v_pk_mul_f32 v[90:91],v[90:91],v[70:71]
v_pk_mul_f32 v[92:93],v[92:93],v[76:77]
v_pk_mul_f32 v[94:95],v[94:95],v[78:79]
v_cvt_pk_bf16_f32 v96,v88,v89
v_cvt_pk_bf16_f32 v97,v90,v91
v_cvt_pk_bf16_f32 v98,v92,v93
v_cvt_pk_bf16_f32 v99,v94,v95
v_max_u32 v96,1,v96
buffer_store_dwordx4 v[96:99],v18,s[20:23],s70 offen offset:1024 sc1
next_387:
v_xor_b32 v17,0x10000,v17
s_xor_b32 s72,s72,0x10000
s_add_u32 s70,s70,2097152
s_xor_b32 s70,s70,0x2000
s_add_u32 s71,s71,1
s_cmp_le_u32 s71,s57
s_cbranch_scc1 seg_378
s_endpgm
retry_377:
s_sub_u32 s90,s90,64
s_cmp_lt_i32 s90,0
s_cbranch_scc1 giveup_197
s_mov_b32 s83,1
s_waitcnt vmcnt(0) lgkmcnt(0)
s_barrier
s_branch seg_378
half_386:
s_mov_b64 exec,s[52:53]
s_xor_b32 m0,s91,0
s_add_u32 s65,s94,0
buffer_load_dwordx4 v16,s[20:23],s65 offen offset:0 sc1 lds
buffer_load_dwordx4 v16,s[20:23],s65 offen offset:2048 sc1 lds
s_xor_b32 m0,s91,16384
s_add_u32 s65,s94,32768
buffer_load_dwordx4 v16,s[20:23],s65 offen offset:0 sc1 lds
buffer_load_dwordx4 v16,s[20:23],s65 offen offset:2048 sc1 lds
s_xor_b32 m0,s91,32768
s_add_u32 s65,s94,65536
buffer_load_dwordx4 v16,s[20:23],s65 offen offset:0 sc1 lds
buffer_load_dwordx4 v16,s[20:23],s65 offen offset:2048 sc1 lds
s_xor_b32 m0,s91,49152
s_add_u32 s65,s94,98304
buffer_load_dwordx4 v16,s[20:23],s65 offen offset:0 sc1 lds
buffer_load_dwordx4 v16,s[20:23],s65 offen offset:2048 sc1 lds
s_mov_b64 exec,-1
s_waitcnt vmcnt(8)
v_add_u32 v22,s71,-1
buffer_store_dword v22,v23,s[20:23],s97 offen sc1
s_mov_b32 s97,0x7fff0000
half2_383:
s_waitcnt vmcnt(7)
s_barrier
ds_read_b128 v[224:227],v17 offset:0
ds_read_b128 v[228:231],v17 offset:2048
ds_read_b128 v[232:235],v17 offset:4096
ds_read_b128 v[236:239],v17 offset:6144
ds_read_b128 v[240:243],v17 offset:8192
ds_read_b128 v[244:247],v17 offset:10240
ds_read_b128 v[248:251],v17 offset:12288
s_waitcnt lgkmcnt(5)
v_mfma_f32_16x16x32_bf16 v[64:67],a[0:3],v[224:227],0
v_min_u32 v27,v224,v228
v_mfma_f32_16x16x32_bf16 v[72:75],a[128:131],v[224:227],0
ds_read_b128 v[252:255],v17 offset:14336
v_mfma_f32_16x16x32_bf16 v[64:67],a[4:7],v[228:231],v[64:67]
v_mfma_f32_16x16x32_bf16 v[72:75],a[132:135],v[228:231],v[72:75]
s_waitcnt vmcnt(5)
s_barrier
ds_read_b128 v[224:227],v17 offset:16384
s_waitcnt lgkmcnt(5)
v_mfma_f32_16x16x32_bf16 v[64:67],a[8:11],v[232:235],v[64:67]
v_min3_u32 v27,v27,v232,v236
v_mfma_f32_16x16x32_bf16 v[72:75],a[136:139],v[232:235],v[72:75]
ds_read_b128 v[228:231],v17 offset:18432
v_mfma_f32_16x16x32_bf16 v[64:67],a[12:15],v[236:239],v[64:67]
v_mfma_f32_16x16x32_bf16 v[72:75],a[140:143],v[236:239],v[72:75]
ds_read_b128 v[232:235],v17 offset:20480
s_waitcnt lgkmcnt(5)
v_mfma_f32_16x16x32_bf16 v[64:67],a[16:19],v[240:243],v[64:67]
v_min3_u32 v27,v27,v240,v244
v_mfma_f32_16x16x32_bf16 v[72:75],a[144:147],v[240:243],v[72:75]
ds_read_b128 v[236:239],v17 offset:22528
v_mfma_f32_16x16x32_bf16 v[64:67],a[20:23],v[244:247],v[64:67]
v_mfma_f32_16x16x32_bf16 v[72:75],a[148:151],v[244:247],v[72:75]
ds_read_b128 v[240:243],v17 offset:24576
s_waitcnt lgkmcnt(5)
v_mfma_f32_16x16x32_bf16 v[64:67],a[24:27],v[248:251],v[64:67]
v_min3_u32 v27,v27,v248,v252
v_mfma_f32_16x16x32_bf16 v[72:75],a[152:155],v[248:251],v[72:75]
ds_read_b128 v[244:247],v17 offset:26624
v_mfma_f32_16x16x32_bf16 v[64:67],a[28:31],v[252:255],v[64:67]
v_mfma_f32_16x16x32_bf16 v[72:75],a[156:159],v[252:255],v[72:75]
ds_read_b128 v[248:251],v17 offset:28672
s_waitcnt lgkmcnt(5)
v_mfma_f32_16x16x32_bf16 v[64:67],a[32:35],v[224:227],v[64:67]
v_min3_u32 v27,v27,v224,v228
v_mfma_f32_16x16x32_bf16 v[72:75],a[160:163],v[224:227],v[72:75]
ds_read_b128 v[252:255],v17 offset:30720
v_mfma_f32_16x16x32_bf16 v[64:67],a[36:39],v[228:231],v[64:67]
v_mfma_f32_16x16x32_bf16 v[72:75],a[164:167],v[228:231],v[72:75]
s_waitcnt vmcnt(1)
s_barrier
ds_read_b128 v[224:227],v17 offset:32768
s_waitcnt lgkmcnt(5)
v_mfma_f32_16x16x32_bf16 v[64:67],a[40:43],v[232:235],v[64:67]
v_min3_u32 v27,v27,v232,v236
v_mfma_f32_16x16x32_bf16 v[72:75],a[168:171],v[232:235],v[72:75]
ds_read_b128 v[228:231],v17 offset:34816
v_mfma_f32_16x16x32_bf16 v[64:67],a[44:47],v[236:239],v[64:67]
v_mfma_f32_16x16x32_bf16 v[72:75],a[172:175],v[236:239],v[72:75]
ds_read_b128 v[232:235],v17 offset:36864
s_waitcnt lgkmcnt(5)
v_mfma_f32_16x16x32_bf16 v[64:67],a[48:51],v[240:243],v[64:67]
v_min3_u32 v27,v27,v240,v244
v_mfma_f32_16x16x32_bf16 v[72:75],a[176:179],v[240:243],v[72:75]
ds_read_b128 v[236:239],v17 offset:38912
v_mfma_f32_16x16x32_bf16 v[64:67],a[52:55],v[244:247],v[64:67]
v_mfma_f32_16x16x32_bf16 v[72:75],a[180:183],v[244:247],v[72:75]
ds_read_b128 v[240:243],v17 offset:40960
s_waitcnt lgkmcnt(5)
v_mfma_f32_16x16x32_bf16 v[64:67],a[56:59],v[248:251],v[64:67]
v_min3_u32 v27,v27,v248,v252
v_mfma_f32_16x16x32_bf16 v[72:75],a[184:187],v[248:251],v[72:75]
ds_read_b128 v[244:247],v17 offset:43008
v_mfma_f32_16x16x32_bf16 v[64:67],a[60:63],v[252:255],v[64:67]
v_mfma_f32_16x16x32_bf16 v[72:75],a[188:191],v[252:255],v[72:75]
ds_read_b128 v[248:251],v17 offset:45056
s_waitcnt lgkmcnt(5)
v_mfma_f32_16x16x32_bf16 v[64:67],a[64:67],v[224:227],v[64:67]
v_min3_u32 v27,v27,v224,v228
v_mfma_f32_16x16x32_bf16 v[72:75],a[192:195],v[224:227],v[72:75]
ds_read_b128 v[252:255],v17 offset:47104
v_mfma_f32_16x16x32_bf16 v[64:67],a[68:71],v[228:231],v[64:67]
v_mfma_f32_16x16x32_bf16 v[72:75],a[196:199],v[228:231],v[72:75]
ds_read_b128 v[224:227],v17 offset:49152
s_waitcnt lgkmcnt(5)
v_mfma_f32_16x16x32_bf16 v[64:67],a[72:75],v[232:235],v[64:67]
v_min3_u32 v27,v27,v232,v236
v_mfma_f32_16x16x32_bf16 v[72:75],a[200:203],v[232:235],v[72:75]
ds_read_b128 v[228:231],v17 offset:51200
v_mfma_f32_16x16x32_bf16 v[64:67],a[76:79],v[236:239],v[64:67]
v_mfma_f32_16x16x32_bf16 v[72:75],a[204:207],v[236:239],v[72:75]
ds_read_b128 v[232:235],v17 offset:53248
s_waitcnt lgkmcnt(5)
v_mfma_f32_16x16x32_bf16 v[64:67],a[80:83],v[240:243],v[64:67]
v_min3_u32 v27,v27,v240,v244
v_mfma_f32_16x16x32_bf16 v[72:75],a[208:211],v[240:243],v[72:75]
ds_read_b128 v[236:239],v17 offset:55296
v_mfma_f32_16x16x32_bf16 v[64:67],a[84:87],v[244:247],v[64:67]
v_mfma_f32_16x16x32_bf16 v[72:75],a[212:215],v[244:247],v[72:75]
ds_read_b128 v[240:243],v17 offset:57344
s_waitcnt lgkmcnt(5)
v_mfma_f32_16x16x32_bf16 v[64:67],a[88:91],v[248:251],v[64:67]
v_min3_u32 v27,v27,v248,v252
v_mfma_f32_16x16x32_bf16 v[72:75],a[216:219],v[248:251],v[72:75]
ds_read_b128 v[244:247],v17 offset:59392
v_mfma_f32_16x16x32_bf16 v[64:67],a[92:95],v[252:255],v[64:67]
v_mfma_f32_16x16x32_bf16 v[72:75],a[220:223],v[252:255],v[72:75]
ds_read_b128 v[248:251],v17 offset:61440
s_waitcnt lgkmcnt(5)
v_mfma_f32_16x16x32_bf16 v[64:67],a[96:99],v[224:227],v[64:67]
v_min3_u32 v27,v27,v224,v228
v_mfma_f32_16x16x32_bf16 v[72:75],a[224:227],v[224:227],v[72:75]
s_barrier
ds_read_b128 v[252:255],v17 offset:63488
v_mfma_f32_16x16x32_bf16 v[64:67],a[100:103],v[228:231],v[64:67]
ds_read_b128 v[120:123],v19
v_mfma_f32_16x16x32_bf16 v[72:75],a[228:231],v[228:231],v[72:75]
s_waitcnt lgkmcnt(5)
v_mfma_f32_16x16x32_bf16 v[64:67],a[104:107],v[232:235],v[64:67]
v_min3_u32 v27,v27,v232,v236
v_mfma_f32_16x16x32_bf16 v[72:75],a[232:235],v[232:235],v[72:75]
v_mfma_f32_16x16x32_bf16 v[64:67],a[108:111],v[236:239],v[64:67]
v_mfma_f32_16x16x32_bf16 v[72:75],a[236:239],v[236:239],v[72:75]
s_waitcnt lgkmcnt(3)
v_mfma_f32_16x16x32_bf16 v[64:67],a[112:115],v[240:243],v[64:67]
v_min3_u32 v27,v27,v240,v244
v_mfma_f32_16x16x32_bf16 v[72:75],a[240:243],v[240:243],v[72:75]
v_mfma_f32_16x16x32_bf16 v[64:67],a[116:119],v[244:247],v[64:67]
v_mfma_f32_16x16x32_bf16 v[72:75],a[244:247],v[244:247],v[72:75]
s_waitcnt lgkmcnt(1)
v_mfma_f32_16x16x32_bf16 v[64:67],a[120:123],v[248:251],v[64:67]
v_min3_u32 v27,v27,v248,v252
v_mfma_f32_16x16x32_bf16 v[72:75],a[248:251],v[248:251],v[72:75]
v_mfma_f32_16x16x32_bf16 v[64:67],a[124:127],v[252:255],v[64:67]
v_mfma_f32_16x16x32_bf16 v[72:75],a[252:255],v[252:255],v[72:75]
v_cmp_eq_u32 vcc,0,v27
s_and_b64 vcc,vcc,s[52:53]
s_cbranch_vccnz retry_377
s_waitcnt lgkmcnt(0)
s_nop 3
v_pk_fma_f32 v[64:65],v[52:53],v[120:121],v[64:65] op_sel_hi:[1,0,1]
v_pk_fma_f32 v[66:67],v[54:55],v[120:121],v[66:67] op_sel_hi:[1,0,1]
v_pk_fma_f32 v[72:73],v[56:57],v[120:121],v[72:73] op_sel_hi:[1,0,1]
v_pk_fma_f32 v[74:75],v[58:59],v[120:121],v[74:75] op_sel_hi:[1,0,1]
v_pk_mul_f32 v[88:89],v[64:65],v[64:65]
v_pk_mul_f32 v[90:91],v[66:67],v[66:67]
buffer_load_dword v29,v21,s[20:23],s87 offen sc1
v_mov_b32 v22,s71
buffer_store_dword v22,v23,s[20:23],s73 offen sc1
v_pk_mul_f32 v[92:93],v[72:73],v[72:73]
v_pk_mul_f32 v[94:95],v[74:75],v[74:75]
v_pk_fma_f32 v[88:89],v[88:89],v[120:121],v[122:123] op_sel:[0,1,0] op_sel_hi:[1,1,0]
v_pk_fma_f32 v[90:91],v[90:91],v[120:121],v[122:123] op_sel:[0,1,0] op_sel_hi:[1,1,0]
v_pk_fma_f32 v[92:93],v[92:93],v[120:121],v[122:123] op_sel:[0,1,0] op_sel_hi:[1,1,0]
v_pk_fma_f32 v[94:95],v[94:95],v[120:121],v[122:123] op_sel:[0,1,0] op_sel_hi:[1,1,0]
v_pk_mul_f32 v[88:89],v[88:89],v[64:65]
v_pk_mul_f32 v[90:91],v[90:91],v[66:67]
v_pk_mul_f32 v[92:93],v[92:93],v[72:73]
v_pk_mul_f32 v[94:95],v[94:95],v[74:75]
v_exp_f32 v88,v88
v_exp_f32 v89,v89
v_exp_f32 v90,v90
v_exp_f32 v91,v91
v_exp_f32 v92,v92
v_exp_f32 v93,v93
v_exp_f32 v94,v94
v_exp_f32 v95,v95
v_pk_fma_f32 v[88:89],v[88:89],v[122:123],v[122:123] op_sel:[0,1,1] op_sel_hi:[1,1,1]
v_pk_fma_f32 v[90:91],v[90:91],v[122:123],v[122:123] op_sel:[0,1,1] op_sel_hi:[1,1,1]
v_pk_fma_f32 v[92:93],v[92:93],v[122:123],v[122:123] op_sel:[0,1,1] op_sel_hi:[1,1,1]
v_pk_fma_f32 v[94:95],v[94:95],v[122:123],v[122:123] op_sel:[0,1,1] op_sel_hi:[1,1,1]
v_rcp_f32 v88,v88
v_rcp_f32 v89,v89
v_rcp_f32 v90,v90
v_rcp_f32 v91,v91
v_rcp_f32 v92,v92
v_rcp_f32 v93,v93
v_rcp_f32 v94,v94
v_rcp_f32 v95,v95
v_pk_mul_f32 v[88:89],v[88:89],v[64:65]
v_pk_mul_f32 v[90:91],v[90:91],v[66:67]
v_pk_mul_f32 v[92:93],v[92:93],v[72:73]
v_pk_mul_f32 v[94:95],v[94:95],v[74:75]
v_cvt_pk_bf16_f32 v96,v88,v89
v_cvt_pk_bf16_f32 v97,v90,v91
v_cvt_pk_bf16_f32 v98,v92,v93
v_cvt_pk_bf16_f32 v99,v94,v95
v_max_u32 v96,1,v96
buffer_store_dwordx4 v[96:99],v18,s[20:23],s70 offen offset:0 sc1
s_branch next_387
w3b_376:
s_add_u32 s64,s79,0
s_lshl_b32 s70,s64,21
s_lshl_b32 s64,s64,13
s_and_b32 s64,s64,0x2000
s_xor_b32 s64,s64,s62
s_add_u32 s70,s70,s64
s_add_u32 s70,s70,29360128
s_mov_b32 s83,1
s_mov_b32 s87,s74
s_cmp_eq_u32 s50,0
s_cselect_b32 s74,s74,0x7fff0000
v_mov_b32 v47,132096
s_lshl_b32 s64,s50,3
s_add_u32 s64,s64,132096
v_mov_b32 v46,s64
v_mov_b32 v29,0
s_mov_b32 s97,0x7fff0000
s_mov_b32 s69,1
s_mov_b32 s68,0
s_mov_b32 s52,0x30003
s_mov_b32 s53,s52
seg_393:
s_cmp_eq_u32 s83,0
s_cbranch_scc1 ahead_394
s_add_u32 s94,s70,s75
s_xor_b32 s95,s94,1024
s_xor_b32 s91,s72,0x10000
s_cmp_eq_u32 s69,0
s_mov_b32 s69,1
s_cbranch_scc1 half2_398
s_waitcnt vmcnt(2)
v_cmp_gt_u32 vcc,s71,v29
s_cbranch_vccz nb_397
s_waitcnt vmcnt(0)
v_add_u32 v22,s71,-1
buffer_store_dword v22,v23,s[20:23],s97 offen sc1
s_mov_b32 s97,0x7fff0000
s_cmp_lg_u32 s50,0
s_cbranch_scc1 nb_397
buffer_load_dword v32,v21,s[20:23],s74 offen sc1
s_sleep 2
pl_399:
buffer_load_dword v33,v21,s[20:23],s74 offen sc1
s_waitcnt vmcnt(1)
v_cmp_gt_u32 vcc,s71,v32
v_mov_b32 v29,v32
s_cbranch_vccz pok_400
buffer_load_dword v32,v21,s[20:23],s74 offen sc1
s_waitcnt vmcnt(1)
v_cmp_gt_u32 vcc,s71,v33
v_mov_b32 v29,v33
s_cbranch_vccz pok_400
s_sub_u32 s90,s90,1
s_cmp_gt_i32 s90,0
s_cbranch_scc1 pl_399
pok_400:
nb_397:
s_cmp_eq_u32 s71,64
s_barrier
s_cbranch_scc1 half_401
s_xor_b32 m0,s91,0
s_add_u32 s65,s94,0
buffer_load_dwordx4 v16,s[20:23],s65 offen offset:0 sc1 lds
buffer_load_dwordx4 v16,s[20:23],s65 offen offset:2048 sc1 lds
s_xor_b32 m0,s91,16384
s_add_u32 s65,s94,32768
buffer_load_dwordx4 v16,s[20:23],s65 offen offset:0 sc1 lds
buffer_load_dwordx4 v16,s[20:23],s65 offen offset:2048 sc1 lds
s_xor_b32 m0,s91,32768
s_add_u32 s65,s94,65536
buffer_load_dwordx4 v16,s[20:23],s65 offen offset:0 sc1 lds
buffer_load_dwordx4 v16,s[20:23],s65 offen offset:2048 sc1 lds
s_xor_b32 m0,s91,49152
s_add_u32 s65,s94,98304
buffer_load_dwordx4 v16,s[20:23],s65 offen offset:0 sc1 lds
buffer_load_dwordx4 v16,s[20:23],s65 offen offset:2048 sc1 lds
s_add_u32 s66,s94,110592
buffer_load_dwordx4 v[128:131],v16,s[20:23],s66 offen offset:0 sc1
buffer_load_dwordx4 v[132:135],v16,s[20:23],s66 offen offset:1024 sc1
buffer_load_dwordx4 v[136:139],v16,s[20:23],s66 offen offset:2048 sc1
buffer_load_dwordx4 v[140:143],v16,s[20:23],s66 offen offset:3072 sc1
s_add_u32 s66,s94,114688
buffer_load_dwordx4 v[144:147],v16,s[20:23],s66 offen offset:0 sc1
buffer_load_dwordx4 v[148:151],v16,s[20:23],s66 offen offset:1024 sc1
buffer_load_dwordx4 v[152:155],v16,s[20:23],s66 offen offset:2048 sc1
buffer_load_dwordx4 v[156:159],v16,s[20:23],s66 offen offset:3072 sc1
s_waitcnt vmcnt(16)
v_add_u32 v22,s71,-1
buffer_store_dword v22,v23,s[20:23],s97 offen sc1
s_mov_b32 s97,0x7fff0000
s_waitcnt vmcnt(15)
s_barrier
ds_read_b128 v[224:227],v17 offset:0
ds_read_b128 v[228:231],v17 offset:2048
ds_read_b128 v[232:235],v17 offset:4096
ds_read_b128 v[236:239],v17 offset:6144
ds_read_b128 v[240:243],v17 offset:8192
ds_read_b128 v[244:247],v17 offset:10240
ds_read_b128 v[248:251],v17 offset:12288
s_waitcnt lgkmcnt(5)
v_mfma_f32_16x16x32_bf16 v[64:67],a[0:3],v[224:227],0
ds_read_b128 v[252:255],v17 offset:14336
s_xor_b32 m0,s91,1024
s_add_u32 s65,s95,0
buffer_load_dwordx4 v16,s[20:23],s65 offen offset:0 sc1 lds
buffer_load_dwordx4 v16,s[20:23],s65 offen offset:2048 sc1 lds
v_min_u32 v27,v224,v228
v_mfma_f32_16x16x32_bf16 v[72:75],a[4:7],v[228:231],0
s_waitcnt vmcnt(15)
s_barrier
ds_read_b128 v[224:227],v17 offset:16384
s_xor_b32 m0,s91,17408
s_add_u32 s65,s95,32768
s_waitcnt lgkmcnt(5)
v_mfma_f32_16x16x32_bf16 v[64:67],a[8:11],v[232:235],v[64:67]
ds_read_b128 v[228:231],v17 offset:18432
buffer_load_dwordx4 v16,s[20:23],s65 offen offset:0 sc1 lds
buffer_load_dwordx4 v16,s[20:23],s65 offen offset:2048 sc1 lds
s_xor_b32 m0,s91,33792
v_min3_u32 v27,v27,v232,v236
v_mfma_f32_16x16x32_bf16 v[72:75],a[12:15],v[236:239],v[72:75]
ds_read_b128 v[232:235],v17 offset:20480
s_add_u32 s65,s95,65536
buffer_load_dwordx4 v16,s[20:23],s65 offen offset:0 sc1 lds
s_waitcnt lgkmcnt(5)
v_mfma_f32_16x16x32_bf16 v[64:67],a[16:19],v[240:243],v[64:67]
ds_read_b128 v[236:239],v17 offset:22528
buffer_load_dwordx4 v16,s[20:23],s65 offen offset:2048 sc1 lds
s_xor_b32 m0,s91,50176
s_add_u32 s65,s95,98304
v_min3_u32 v27,v27,v240,v244
v_mfma_f32_16x16x32_bf16 v[72:75],a[20:23],v[244:247],v[72:75]
ds_read_b128 v[240:243],v17 offset:24576
buffer_load_dwordx4 v16,s[20:23],s65 offen offset:0 sc1 lds
buffer_load_dwordx4 v16,s[20:23],s65 offen offset:2048 sc1 lds
s_waitcnt lgkmcnt(5)
v_mfma_f32_16x16x32_bf16 v[64:67],a[24:27],v[248:251],v[64:67]
ds_read_b128 v[244:247],v17 offset:26624
v_min3_u32 v27,v27,v248,v252
v_mfma_f32_16x16x32_bf16 v[72:75],a[28:31],v[252:255],v[72:75]
ds_read_b128 v[248:251],v17 offset:28672
s_waitcnt lgkmcnt(5)
v_mfma_f32_16x16x32_bf16 v[64:67],a[32:35],v[224:227],v[64:67]
ds_read_b128 v[252:255],v17 offset:30720
v_min3_u32 v27,v27,v224,v228
v_mfma_f32_16x16x32_bf16 v[72:75],a[36:39],v[228:231],v[72:75]
s_waitcnt vmcnt(17)
s_barrier
ds_read_b128 v[224:227],v17 offset:32768
s_waitcnt lgkmcnt(5)
v_mfma_f32_16x16x32_bf16 v[64:67],a[40:43],v[232:235],v[64:67]
ds_read_b128 v[228:231],v17 offset:34816
v_min3_u32 v27,v27,v232,v236
v_mfma_f32_16x16x32_bf16 v[72:75],a[44:47],v[236:239],v[72:75]
ds_read_b128 v[232:235],v17 offset:36864
s_waitcnt lgkmcnt(5)
v_mfma_f32_16x16x32_bf16 v[64:67],a[48:51],v[240:243],v[64:67]
ds_read_b128 v[236:239],v17 offset:38912
v_min3_u32 v27,v27,v240,v244
v_mfma_f32_16x16x32_bf16 v[72:75],a[52:55],v[244:247],v[72:75]
ds_read_b128 v[240:243],v17 offset:40960
s_add_u32 s88,s70,s75
s_add_u32 s88,s88,2097152
s_xor_b32 s88,s88,0x2000
s_xor_b32 s89,s88,1024
s_waitcnt lgkmcnt(5)
v_mfma_f32_16x16x32_bf16 v[64:67],a[56:59],v[248:251],v[64:67]
ds_read_b128 v[244:247],v17 offset:43008
v_min3_u32 v27,v27,v248,v252
v_mfma_f32_16x16x32_bf16 v[72:75],a[60:63],v[252:255],v[72:75]
ds_read_b128 v[248:251],v17 offset:45056
s_waitcnt lgkmcnt(5)
v_mfma_f32_16x16x32_bf16 v[64:67],a[64:67],v[224:227],v[64:67]
ds_read_b128 v[252:255],v17 offset:47104
v_min3_u32 v27,v27,v224,v228
v_mfma_f32_16x16x32_bf16 v[72:75],a[68:71],v[228:231],v[72:75]
ds_read_b128 v[224:227],v17 offset:49152
s_waitcnt lgkmcnt(5)
v_mfma_f32_16x16x32_bf16 v[64:67],a[72:75],v[232:235],v[64:67]
ds_read_b128 v[228:231],v17 offset:51200
v_min3_u32 v27,v27,v232,v236
v_mfma_f32_16x16x32_bf16 v[72:75],a[76:79],v[236:239],v[72:75]
ds_read_b128 v[232:235],v17 offset:53248
s_waitcnt lgkmcnt(5)
v_mfma_f32_16x16x32_bf16 v[64:67],a[80:83],v[240:243],v[64:67]
ds_read_b128 v[236:239],v17 offset:55296
v_min3_u32 v27,v27,v240,v244
v_mfma_f32_16x16x32_bf16 v[72:75],a[84:87],v[244:247],v[72:75]
ds_read_b128 v[240:243],v17 offset:57344
s_waitcnt lgkmcnt(5)
v_mfma_f32_16x16x32_bf16 v[64:67],a[88:91],v[248:251],v[64:67]
ds_read_b128 v[244:247],v17 offset:59392
v_min3_u32 v27,v27,v248,v252
v_mfma_f32_16x16x32_bf16 v[72:75],a[92:95],v[252:255],v[72:75]
ds_read_b128 v[248:251],v17 offset:61440
s_waitcnt vmcnt(9)
stk_407:
v_min3_u32 v22,v129,v133,v137
v_min3_u32 v22,v22,v141,v145
v_min3_u32 v22,v22,v149,v153
v_min_u32 v22,v22,v157
v_cmp_eq_u32 vcc,0,v22
s_cmp_lt_i32 s90,0
s_cselect_b64 vcc,0,vcc
s_cbranch_vccnz str_408
v_pk_add_f32 v[88:89],v[128:129],v[144:145]
v_pk_add_f32 v[90:91],v[130:131],v[146:147]
v_pk_add_f32 v[92:93],v[132:133],v[148:149]
v_pk_add_f32 v[94:95],v[134:135],v[150:151]
v_pk_add_f32 v[96:97],v[136:137],v[152:153]
v_pk_add_f32 v[98:99],v[138:139],v[154:155]
v_pk_add_f32 v[100:101],v[140:141],v[156:157]
v_pk_add_f32 v[102:103],v[142:143],v[158:159]
v_pk_add_f32 v[88:89],v[88:89],v[96:97]
v_pk_add_f32 v[90:91],v[90:91],v[98:99]
v_pk_add_f32 v[92:93],v[92:93],v[100:101]
v_pk_add_f32 v[94:95],v[94:95],v[102:103]
v_pk_add_f32 v[88:89],v[88:89],v[92:93]
v_pk_add_f32 v[90:91],v[90:91],v[94:95]
v_mov_b32 v92,v88
v_mov_b32 v93,v89
v_mov_b32 v94,v90
v_mov_b32 v95,v91
v_permlane16_swap_b32 v92,v88
v_permlane16_swap_b32 v93,v89
v_permlane16_swap_b32 v94,v90
v_permlane16_swap_b32 v95,v91
v_pk_add_f32 v[88:89],v[88:89],v[92:93]
v_pk_add_f32 v[90:91],v[90:91],v[94:95]
v_mov_b32 v92,v88
v_mov_b32 v93,v89
s_waitcnt lgkmcnt(5)
v_mfma_f32_16x16x32_bf16 v[64:67],a[96:99],v[224:227],v[64:67]
ds_read_b128 v[252:255],v17 offset:63488
v_min3_u32 v27,v27,v224,v228
v_mov_b32 v94,v90
v_mov_b32 v95,v91
v_permlane32_swap_b32 v92,v88
v_permlane32_swap_b32 v93,v89
v_permlane32_swap_b32 v94,v90
v_permlane32_swap_b32 v95,v91
v_pk_add_f32 v[88:89],v[88:89],v[92:93]
v_pk_add_f32 v[90:91],v[90:91],v[94:95]
v_mul_f32 v120,0xba800000,v88
v_mul_f32 v124,0xba800000,v90
v_mul_f32 v92,v120,v120
v_mul_f32 v93,v124,v124
v_fma_f32 v92,v89,s82,-v92
v_fma_f32 v93,v91,s82,-v93
v_max_f32 v92,0,v92
v_max_f32 v93,0,v93
v_add_f32 v92,0x3727c5ac,v92
v_add_f32 v93,0x3727c5ac,v93
v_rsq_f32 v94,v92
v_rsq_f32 v95,v93
v_mul_f32 v123,v92,v94
v_mul_f32 v127,v93,v95
v_mul_f32 v122,v28,v94
v_mul_f32 v126,v28,v95
v_mul_f32 v92,v94,v94
v_mul_f32 v93,v95,v95
v_mul_f32 v94,s81,v94
v_mul_f32 v95,s81,v95
v_mul_f32 v121,v92,v94
v_mul_f32 v125,v93,v95
ds_write_b128 v19,v[120:123] offset:0
ds_write_b128 v19,v[124:127] offset:256
v_mfma_f32_16x16x32_bf16 v[72:75],a[100:103],v[228:231],v[72:75]
s_waitcnt vmcnt(4) lgkmcnt(0)
s_barrier
ds_read_b64 v[44:45],v47
ds_read_b128 v[224:227],v17 offset:1024
v_mfma_f32_16x16x32_bf16 v[64:67],a[104:107],v[232:235],v[64:67]
ds_read_b128 v[228:231],v17 offset:3072
v_min3_u32 v27,v27,v232,v236
v_mfma_f32_16x16x32_bf16 v[72:75],a[108:111],v[236:239],v[72:75]
ds_read_b128 v[232:235],v17 offset:5120
v_mfma_f32_16x16x32_bf16 v[64:67],a[112:115],v[240:243],v[64:67]
ds_read_b128 v[236:239],v17 offset:7168
v_min3_u32 v27,v27,v240,v244
v_mfma_f32_16x16x32_bf16 v[72:75],a[116:119],v[244:247],v[72:75]
ds_read_b128 v[240:243],v17 offset:9216
s_waitcnt lgkmcnt(5)
v_readfirstlane_b32 s93,v45
v_mfma_f32_16x16x32_bf16 v[64:67],a[120:123],v[248:251],v[64:67]
ds_read_b128 v[244:247],v17 offset:11264
v_readfirstlane_b32 s83,v44
s_cmp_lg_u32 s83,0
s_cbranch_scc0 keep_403
v_min3_u32 v27,v27,v248,v252
v_mfma_f32_16x16x32_bf16 v[72:75],a[124:127],v[252:255],v[72:75]
ds_read_b128 v[248:251],v17 offset:13312
s_waitcnt lgkmcnt(5)
v_mfma_f32_16x16x32_bf16 v[68:71],a[0:3],v[224:227],0
ds_read_b128 v[252:255],v17 offset:15360
v_cmp_eq_u32 vcc,0,v27
s_cbranch_vccnz retry_392
v_min3_u32 v27,v27,v224,v228
v_mfma_f32_16x16x32_bf16 v[76:79],a[4:7],v[228:231],0
ds_read_b128 v[224:227],v17 offset:17408
s_waitcnt lgkmcnt(5)
v_mfma_f32_16x16x32_bf16 v[68:71],a[8:11],v[232:235],v[68:71]
ds_read_b128 v[228:231],v17 offset:19456
v_min3_u32 v27,v27,v232,v236
v_mfma_f32_16x16x32_bf16 v[76:79],a[12:15],v[236:239],v[76:79]
ds_read_b128 v[232:235],v17 offset:21504
s_waitcnt lgkmcnt(5)
v_mfma_f32_16x16x32_bf16 v[68:71],a[16:19],v[240:243],v[68:71]
ds_read_b128 v[236:239],v17 offset:23552
v_min3_u32 v27,v27,v240,v244
v_add_f32 v64,v64,v72
v_add_f32 v65,v65,v73
v_add_f32 v66,v66,v74
v_add_f32 v67,v67,v75
v_mfma_f32_16x16x32_bf16 v[76:79],a[20:23],v[244:247],v[76:79]
ds_read_b128 v[240:243],v17 offset:25600
v_fmac_f32 v64,v52,v120
v_fmac_f32 v65,v53,v120
v_fmac_f32 v66,v54,v120
v_fmac_f32 v67,v55,v120
s_waitcnt lgkmcnt(5)
v_mfma_f32_16x16x32_bf16 v[68:71],a[24:27],v[248:251],v[68:71]
ds_read_b128 v[244:247],v17 offset:27648
v_min3_u32 v27,v27,v248,v252
v_mul_f32 v88,v64,v64
v_mul_f32 v89,v65,v65
v_mul_f32 v90,v66,v66
v_mul_f32 v91,v67,v67
v_mfma_f32_16x16x32_bf16 v[76:79],a[28:31],v[252:255],v[76:79]
ds_read_b128 v[248:251],v17 offset:29696
v_fma_f32 v88,v88,v121,v122
v_fma_f32 v89,v89,v121,v122
v_fma_f32 v90,v90,v121,v122
v_fma_f32 v91,v91,v121,v122
s_waitcnt lgkmcnt(5)
v_mfma_f32_16x16x32_bf16 v[68:71],a[32:35],v[224:227],v[68:71]
ds_read_b128 v[252:255],v17 offset:31744
v_min3_u32 v27,v27,v224,v228
v_mul_f32 v88,v88,v64
v_mul_f32 v89,v89,v65
v_mul_f32 v90,v90,v66
v_mul_f32 v91,v91,v67
v_mfma_f32_16x16x32_bf16 v[76:79],a[36:39],v[228:231],v[76:79]
s_waitcnt vmcnt(0)
s_barrier
ds_read_b128 v[224:227],v17 offset:33792
v_exp_f32 v88,v88
s_waitcnt lgkmcnt(5)
v_mfma_f32_16x16x32_bf16 v[68:71],a[40:43],v[232:235],v[68:71]
ds_read_b128 v[228:231],v17 offset:35840
v_min3_u32 v27,v27,v232,v236
v_exp_f32 v89,v89
v_exp_f32 v90,v90
v_mfma_f32_16x16x32_bf16 v[76:79],a[44:47],v[236:239],v[76:79]
ds_read_b128 v[232:235],v17 offset:37888
v_exp_f32 v91,v91
v_fma_f32 v88,v88,v123,v123
v_fma_f32 v89,v89,v123,v123
s_waitcnt lgkmcnt(5)
v_mfma_f32_16x16x32_bf16 v[68:71],a[48:51],v[240:243],v[68:71]
ds_read_b128 v[236:239],v17 offset:39936
v_min3_u32 v27,v27,v240,v244
v_fma_f32 v90,v90,v123,v123
v_fma_f32 v91,v91,v123,v123
v_rcp_f32 v88,v88
v_mfma_f32_16x16x32_bf16 v[76:79],a[52:55],v[244:247],v[76:79]
ds_read_b128 v[240:243],v17 offset:41984
v_rcp_f32 v89,v89
v_rcp_f32 v90,v90
s_waitcnt lgkmcnt(5)
v_mfma_f32_16x16x32_bf16 v[68:71],a[56:59],v[248:251],v[68:71]
ds_read_b128 v[244:247],v17 offset:44032
v_min3_u32 v27,v27,v248,v252
v_rcp_f32 v91,v91
v_mul_f32 v88,v88,v64
v_mul_f32 v89,v89,v65
v_mfma_f32_16x16x32_bf16 v[76:79],a[60:63],v[252:255],v[76:79]
ds_read_b128 v[248:251],v17 offset:46080
v_mul_f32 v90,v90,v66
v_mul_f32 v91,v91,v67
v_cvt_pk_bf16_f32 v96,v88,v89
v_cvt_pk_bf16_f32 v97,v90,v91
s_waitcnt lgkmcnt(5)
v_mfma_f32_16x16x32_bf16 v[68:71],a[64:67],v[224:227],v[68:71]
ds_read_b128 v[252:255],v17 offset:48128
v_min3_u32 v27,v27,v224,v228
v_max_u32 v96,1,v96
buffer_store_dwordx2 v[96:97],v18,s[20:23],s70 offen offset:0 sc1
v_mfma_f32_16x16x32_bf16 v[76:79],a[68:71],v[228:231],v[76:79]
ds_read_b128 v[224:227],v17 offset:50176
s_waitcnt lgkmcnt(5)
v_mfma_f32_16x16x32_bf16 v[68:71],a[72:75],v[232:235],v[68:71]
ds_read_b128 v[228:231],v17 offset:52224
v_min3_u32 v27,v27,v232,v236
v_mfma_f32_16x16x32_bf16 v[76:79],a[76:79],v[236:239],v[76:79]
ds_read_b128 v[232:235],v17 offset:54272
s_waitcnt lgkmcnt(5)
v_mfma_f32_16x16x32_bf16 v[68:71],a[80:83],v[240:243],v[68:71]
ds_read_b128 v[236:239],v17 offset:56320
v_min3_u32 v27,v27,v240,v244
v_mfma_f32_16x16x32_bf16 v[76:79],a[84:87],v[244:247],v[76:79]
ds_read_b128 v[240:243],v17 offset:58368
s_waitcnt lgkmcnt(5)
v_mfma_f32_16x16x32_bf16 v[68:71],a[88:91],v[248:251],v[68:71]
ds_read_b128 v[244:247],v17 offset:60416
v_min3_u32 v27,v27,v248,v252
v_mfma_f32_16x16x32_bf16 v[76:79],a[92:95],v[252:255],v[76:79]
ds_read_b128 v[248:251],v17 offset:62464
s_waitcnt lgkmcnt(5)
v_mfma_f32_16x16x32_bf16 v[68:71],a[96:99],v[224:227],v[68:71]
ds_read_b128 v[252:255],v17 offset:64512
v_min3_u32 v27,v27,v224,v228
v_mfma_f32_16x16x32_bf16 v[76:79],a[100:103],v[228:231],v[76:79]
s_waitcnt lgkmcnt(4)
v_mfma_f32_16x16x32_bf16 v[68:71],a[104:107],v[232:235],v[68:71]
v_min3_u32 v27,v27,v232,v236
v_mfma_f32_16x16x32_bf16 v[76:79],a[108:111],v[236:239],v[76:79]
s_waitcnt lgkmcnt(2)
v_mfma_f32_16x16x32_bf16 v[68:71],a[112:115],v[240:243],v[68:71]
v_min3_u32 v27,v27,v240,v244
v_mfma_f32_16x16x32_bf16 v[76:79],a[116:119],v[244:247],v[76:79]
s_waitcnt lgkmcnt(0)
v_mfma_f32_16x16x32_bf16 v[68:71],a[120:123],v[248:251],v[68:71]
v_min3_u32 v27,v27,v248,v252
v_mfma_f32_16x16x32_bf16 v[76:79],a[124:127],v[252:255],v[76:79]
v_cmp_eq_u32 vcc,0,v27
s_cbranch_vccnz retry_392
s_branch epi_395
keep_403:
v_min3_u32 v27,v27,v248,v252
v_mfma_f32_16x16x32_bf16 v[72:75],a[124:127],v[252:255],v[72:75]
ds_read_b128 v[248:251],v17 offset:13312
s_add_u32 s66,s88,110592
buffer_load_dwordx4 v[128:131],v16,s[20:23],s66 offen offset:0 sc1
buffer_load_dwordx4 v[132:135],v16,s[20:23],s66 offen offset:1024 sc1
s_waitcnt lgkmcnt(5)
v_mfma_f32_16x16x32_bf16 v[68:71],a[0:3],v[224:227],0
ds_read_b128 v[252:255],v17 offset:15360
v_cmp_eq_u32 vcc,0,v27
s_cbranch_vccnz retry_392
v_min3_u32 v27,v27,v224,v228
buffer_load_dwordx4 v[136:139],v16,s[20:23],s66 offen offset:2048 sc1
buffer_load_dwordx4 v[140:143],v16,s[20:23],s66 offen offset:3072 sc1
v_mfma_f32_16x16x32_bf16 v[76:79],a[4:7],v[228:231],0
ds_read_b128 v[224:227],v17 offset:17408
s_add_u32 s66,s88,114688
buffer_load_dwordx4 v[144:147],v16,s[20:23],s66 offen offset:0 sc1
buffer_load_dwordx4 v[148:151],v16,s[20:23],s66 offen offset:1024 sc1
s_waitcnt lgkmcnt(5)
v_mfma_f32_16x16x32_bf16 v[68:71],a[8:11],v[232:235],v[68:71]
ds_read_b128 v[228:231],v17 offset:19456
v_min3_u32 v27,v27,v232,v236
buffer_load_dwordx4 v[152:155],v16,s[20:23],s66 offen offset:2048 sc1
buffer_load_dwordx4 v[156:159],v16,s[20:23],s66 offen offset:3072 sc1
v_mfma_f32_16x16x32_bf16 v[76:79],a[12:15],v[236:239],v[76:79]
ds_read_b128 v[232:235],v17 offset:21504
s_xor_b32 m0,s72,0
s_add_u32 s65,s88,0
s_waitcnt lgkmcnt(5)
v_mfma_f32_16x16x32_bf16 v[68:71],a[16:19],v[240:243],v[68:71]
ds_read_b128 v[236:239],v17 offset:23552
v_min3_u32 v27,v27,v240,v244
v_add_f32 v64,v64,v72
v_add_f32 v65,v65,v73
v_add_f32 v66,v66,v74
v_add_f32 v67,v67,v75
buffer_load_dwordx4 v16,s[20:23],s65 offen offset:0 sc1 lds
v_mfma_f32_16x16x32_bf16 v[76:79],a[20:23],v[244:247],v[76:79]
ds_read_b128 v[240:243],v17 offset:25600
v_fmac_f32 v64,v52,v120
v_fmac_f32 v65,v53,v120
v_fmac_f32 v66,v54,v120
v_fmac_f32 v67,v55,v120
buffer_load_dwordx4 v16,s[20:23],s65 offen offset:2048 sc1 lds
s_waitcnt lgkmcnt(5)
v_mfma_f32_16x16x32_bf16 v[68:71],a[24:27],v[248:251],v[68:71]
ds_read_b128 v[244:247],v17 offset:27648
v_min3_u32 v27,v27,v248,v252
v_mul_f32 v88,v64,v64
v_mul_f32 v89,v65,v65
v_mul_f32 v90,v66,v66
v_mul_f32 v91,v67,v67
s_xor_b32 m0,s72,16384
s_add_u32 s65,s88,32768
v_mfma_f32_16x16x32_bf16 v[76:79],a[28:31],v[252:255],v[76:79]
ds_read_b128 v[248:251],v17 offset:29696
v_fma_f32 v88,v88,v121,v122
v_fma_f32 v89,v89,v121,v122
v_fma_f32 v90,v90,v121,v122
v_fma_f32 v91,v91,v121,v122
buffer_load_dwordx4 v16,s[20:23],s65 offen offset:0 sc1 lds
s_waitcnt lgkmcnt(5)
v_mfma_f32_16x16x32_bf16 v[68:71],a[32:35],v[224:227],v[68:71]
ds_read_b128 v[252:255],v17 offset:31744
v_min3_u32 v27,v27,v224,v228
v_mul_f32 v88,v88,v64
v_mul_f32 v89,v89,v65
v_mul_f32 v90,v90,v66
v_mul_f32 v91,v91,v67
buffer_load_dwordx4 v16,s[20:23],s65 offen offset:2048 sc1 lds
v_mfma_f32_16x16x32_bf16 v[76:79],a[36:39],v[228:231],v[76:79]
s_waitcnt vmcnt(12)
s_barrier
ds_read_b128 v[224:227],v17 offset:33792
v_exp_f32 v88,v88
s_xor_b32 m0,s72,32768
s_add_u32 s65,s88,65536
s_waitcnt lgkmcnt(5)
v_mfma_f32_16x16x32_bf16 v[68:71],a[40:43],v[232:235],v[68:71]
ds_read_b128 v[228:231],v17 offset:35840
v_min3_u32 v27,v27,v232,v236
v_exp_f32 v89,v89
v_exp_f32 v90,v90
buffer_load_dwordx4 v16,s[20:23],s65 offen offset:0 sc1 lds
v_mfma_f32_16x16x32_bf16 v[76:79],a[44:47],v[236:239],v[76:79]
ds_read_b128 v[232:235],v17 offset:37888
v_exp_f32 v91,v91
v_fma_f32 v88,v88,v123,v123
v_fma_f32 v89,v89,v123,v123
buffer_load_dwordx4 v16,s[20:23],s65 offen offset:2048 sc1 lds
s_waitcnt lgkmcnt(5)
v_mfma_f32_16x16x32_bf16 v[68:71],a[48:51],v[240:243],v[68:71]
ds_read_b128 v[236:239],v17 offset:39936
v_min3_u32 v27,v27,v240,v244
v_fma_f32 v90,v90,v123,v123
v_fma_f32 v91,v91,v123,v123
v_rcp_f32 v88,v88
s_xor_b32 m0,s72,49152
s_add_u32 s65,s88,98304
v_mfma_f32_16x16x32_bf16 v[76:79],a[52:55],v[244:247],v[76:79]
ds_read_b128 v[240:243],v17 offset:41984
v_rcp_f32 v89,v89
v_rcp_f32 v90,v90
buffer_load_dwordx4 v16,s[20:23],s65 offen offset:0 sc1 lds
s_waitcnt lgkmcnt(5)
v_mfma_f32_16x16x32_bf16 v[68:71],a[56:59],v[248:251],v[68:71]
ds_read_b128 v[244:247],v17 offset:44032
v_min3_u32 v27,v27,v248,v252
v_rcp_f32 v91,v91
v_mul_f32 v88,v88,v64
v_mul_f32 v89,v89,v65
buffer_load_dwordx4 v16,s[20:23],s65 offen offset:2048 sc1 lds
v_mfma_f32_16x16x32_bf16 v[76:79],a[60:63],v[252:255],v[76:79]
ds_read_b128 v[248:251],v17 offset:46080
v_mul_f32 v90,v90,v66
v_mul_f32 v91,v91,v67
v_cvt_pk_bf16_f32 v96,v88,v89
v_cvt_pk_bf16_f32 v97,v90,v91
s_waitcnt lgkmcnt(5)
v_mfma_f32_16x16x32_bf16 v[68:71],a[64:67],v[224:227],v[68:71]
ds_read_b128 v[252:255],v17 offset:48128
v_min3_u32 v27,v27,v224,v228
v_max_u32 v96,1,v96
buffer_store_dwordx2 v[96:97],v18,s[20:23],s70 offen offset:0 sc1
s_xor_b32 m0,s72,1024
v_mfma_f32_16x16x32_bf16 v[76:79],a[68:71],v[228:231],v[76:79]
ds_read_b128 v[224:227],v17 offset:50176
s_add_u32 s65,s89,0
buffer_load_dwordx4 v16,s[20:23],s65 offen offset:0 sc1 lds
s_waitcnt lgkmcnt(5)
v_mfma_f32_16x16x32_bf16 v[68:71],a[72:75],v[232:235],v[68:71]
ds_read_b128 v[228:231],v17 offset:52224
v_min3_u32 v27,v27,v232,v236
buffer_load_dwordx4 v16,s[20:23],s65 offen offset:2048 sc1 lds
s_xor_b32 m0,s72,17408
s_add_u32 s65,s89,32768
v_mfma_f32_16x16x32_bf16 v[76:79],a[76:79],v[236:239],v[76:79]
ds_read_b128 v[232:235],v17 offset:54272
buffer_load_dwordx4 v16,s[20:23],s65 offen offset:0 sc1 lds
buffer_load_dwordx4 v16,s[20:23],s65 offen offset:2048 sc1 lds
s_waitcnt lgkmcnt(5)
v_mfma_f32_16x16x32_bf16 v[68:71],a[80:83],v[240:243],v[68:71]
ds_read_b128 v[236:239],v17 offset:56320
v_min3_u32 v27,v27,v240,v244
s_xor_b32 m0,s72,33792
s_add_u32 s65,s89,65536
buffer_load_dwordx4 v16,s[20:23],s65 offen offset:0 sc1 lds
v_mfma_f32_16x16x32_bf16 v[76:79],a[84:87],v[244:247],v[76:79]
ds_read_b128 v[240:243],v17 offset:58368
buffer_load_dwordx4 v16,s[20:23],s65 offen offset:2048 sc1 lds
s_xor_b32 m0,s72,50176
s_add_u32 s65,s89,98304
s_waitcnt lgkmcnt(5)
v_mfma_f32_16x16x32_bf16 v[68:71],a[88:91],v[248:251],v[68:71]
ds_read_b128 v[244:247],v17 offset:60416
v_min3_u32 v27,v27,v248,v252
buffer_load_dwordx4 v16,s[20:23],s65 offen offset:0 sc1 lds
buffer_load_dwordx4 v16,s[20:23],s65 offen offset:2048 sc1 lds
v_mfma_f32_16x16x32_bf16 v[76:79],a[92:95],v[252:255],v[76:79]
ds_read_b128 v[248:251],v17 offset:62464
s_waitcnt lgkmcnt(5)
v_mfma_f32_16x16x32_bf16 v[68:71],a[96:99],v[224:227],v[68:71]
ds_read_b128 v[252:255],v17 offset:64512
v_min3_u32 v27,v27,v224,v228
v_mfma_f32_16x16x32_bf16 v[76:79],a[100:103],v[228:231],v[76:79]
s_waitcnt lgkmcnt(4)
v_mfma_f32_16x16x32_bf16 v[68:71],a[104:107],v[232:235],v[68:71]
v_min3_u32 v27,v27,v232,v236
v_mfma_f32_16x16x32_bf16 v[76:79],a[108:111],v[236:239],v[76:79]
s_waitcnt lgkmcnt(2)
v_mfma_f32_16x16x32_bf16 v[68:71],a[112:115],v[240:243],v[68:71]
v_min3_u32 v27,v27,v240,v244
v_mfma_f32_16x16x32_bf16 v[76:79],a[116:119],v[244:247],v[76:79]
s_waitcnt lgkmcnt(0)
v_mfma_f32_16x16x32_bf16 v[68:71],a[120:123],v[248:251],v[68:71]
v_min3_u32 v27,v27,v248,v252
v_mfma_f32_16x16x32_bf16 v[76:79],a[124:127],v[252:255],v[76:79]
v_cmp_eq_u32 vcc,0,v27
s_cbranch_vccnz retry_392
s_branch epi_395
ahead_394:
s_cmp_eq_u32 s93,0
s_cbranch_scc1 both_396
s_waitcnt vmcnt(11) lgkmcnt(0)
s_barrier
ds_read_b128 v[224:227],v17 offset:0
ds_read_b128 v[228:231],v17 offset:2048
ds_read_b128 v[232:235],v17 offset:4096
ds_read_b128 v[236:239],v17 offset:6144
ds_read_b128 v[240:243],v17 offset:8192
ds_read_b128 v[244:247],v17 offset:10240
ds_read_b128 v[248:251],v17 offset:12288
s_waitcnt lgkmcnt(5)
v_mfma_f32_16x16x32_bf16 v[64:67],a[0:3],v[224:227],0
ds_read_b128 v[252:255],v17 offset:14336
v_min_u32 v27,v224,v228
s_waitcnt vmcnt(12)
stk_409:
v_min3_u32 v22,v129,v133,v137
v_min3_u32 v22,v22,v141,v145
v_min3_u32 v22,v22,v149,v153
v_min_u32 v22,v22,v157
v_cmp_eq_u32 vcc,0,v22
s_cmp_lt_i32 s90,0
s_cselect_b64 vcc,0,vcc
s_cbranch_vccnz str_410
v_mfma_f32_16x16x32_bf16 v[72:75],a[4:7],v[228:231],0
ds_read_b128 v[224:227],v17 offset:16384
v_pk_add_f32 v[88:89],v[128:129],v[144:145]
v_pk_add_f32 v[90:91],v[130:131],v[146:147]
v_pk_add_f32 v[92:93],v[132:133],v[148:149]
v_pk_add_f32 v[94:95],v[134:135],v[150:151]
s_waitcnt lgkmcnt(5)
v_mfma_f32_16x16x32_bf16 v[64:67],a[8:11],v[232:235],v[64:67]
ds_read_b128 v[228:231],v17 offset:18432
v_min3_u32 v27,v27,v232,v236
v_pk_add_f32 v[96:97],v[136:137],v[152:153]
v_pk_add_f32 v[98:99],v[138:139],v[154:155]
v_pk_add_f32 v[100:101],v[140:141],v[156:157]
v_pk_add_f32 v[102:103],v[142:143],v[158:159]
v_mfma_f32_16x16x32_bf16 v[72:75],a[12:15],v[236:239],v[72:75]
ds_read_b128 v[232:235],v17 offset:20480
s_waitcnt lgkmcnt(5)
v_mfma_f32_16x16x32_bf16 v[64:67],a[16:19],v[240:243],v[64:67]
ds_read_b128 v[236:239],v17 offset:22528
v_min3_u32 v27,v27,v240,v244
v_pk_add_f32 v[88:89],v[88:89],v[96:97]
v_pk_add_f32 v[90:91],v[90:91],v[98:99]
v_pk_add_f32 v[92:93],v[92:93],v[100:101]
v_mfma_f32_16x16x32_bf16 v[72:75],a[20:23],v[244:247],v[72:75]
ds_read_b128 v[240:243],v17 offset:24576
v_pk_add_f32 v[94:95],v[94:95],v[102:103]
v_pk_add_f32 v[88:89],v[88:89],v[92:93]
v_pk_add_f32 v[90:91],v[90:91],v[94:95]
s_waitcnt lgkmcnt(5)
v_mfma_f32_16x16x32_bf16 v[64:67],a[24:27],v[248:251],v[64:67]
ds_read_b128 v[244:247],v17 offset:26624
v_min3_u32 v27,v27,v248,v252
v_mov_b32 v92,v88
v_mov_b32 v93,v89
v_mov_b32 v94,v90
v_mfma_f32_16x16x32_bf16 v[72:75],a[28:31],v[252:255],v[72:75]
ds_read_b128 v[248:251],v17 offset:28672
v_mov_b32 v95,v91
v_permlane16_swap_b32 v92,v88
v_permlane16_swap_b32 v93,v89
s_waitcnt lgkmcnt(5)
v_mfma_f32_16x16x32_bf16 v[64:67],a[32:35],v[224:227],v[64:67]
ds_read_b128 v[252:255],v17 offset:30720
v_min3_u32 v27,v27,v224,v228
v_permlane16_swap_b32 v94,v90
v_permlane16_swap_b32 v95,v91
v_mfma_f32_16x16x32_bf16 v[72:75],a[36:39],v[228:231],v[72:75]
ds_read_b128 v[224:227],v17 offset:32768
v_pk_add_f32 v[88:89],v[88:89],v[92:93]
v_pk_add_f32 v[90:91],v[90:91],v[94:95]
v_mov_b32 v92,v88
s_waitcnt lgkmcnt(5)
v_mfma_f32_16x16x32_bf16 v[64:67],a[40:43],v[232:235],v[64:67]
ds_read_b128 v[228:231],v17 offset:34816
v_min3_u32 v27,v27,v232,v236
v_mov_b32 v93,v89
v_mov_b32 v94,v90
v_mov_b32 v95,v91
v_mfma_f32_16x16x32_bf16 v[72:75],a[44:47],v[236:239],v[72:75]
ds_read_b128 v[232:235],v17 offset:36864
v_permlane32_swap_b32 v92,v88
v_permlane32_swap_b32 v93,v89
v_permlane32_swap_b32 v94,v90
s_waitcnt lgkmcnt(5)
v_mfma_f32_16x16x32_bf16 v[64:67],a[48:51],v[240:243],v[64:67]
ds_read_b128 v[236:239],v17 offset:38912
v_min3_u32 v27,v27,v240,v244
v_permlane32_swap_b32 v95,v91
v_pk_add_f32 v[88:89],v[88:89],v[92:93]
v_mfma_f32_16x16x32_bf16 v[72:75],a[52:55],v[244:247],v[72:75]
ds_read_b128 v[240:243],v17 offset:40960
v_pk_add_f32 v[90:91],v[90:91],v[94:95]
v_mul_f32 v120,0xba800000,v88
v_mul_f32 v124,0xba800000,v90
s_add_u32 s88,s70,s75
s_waitcnt lgkmcnt(5)
v_mfma_f32_16x16x32_bf16 v[64:67],a[56:59],v[248:251],v[64:67]
ds_read_b128 v[244:247],v17 offset:43008
v_min3_u32 v27,v27,v248,v252
v_mul_f32 v92,v120,v120
v_mul_f32 v93,v124,v124
v_fma_f32 v92,v89,s82,-v92
s_add_u32 s88,s88,2097152
v_mfma_f32_16x16x32_bf16 v[72:75],a[60:63],v[252:255],v[72:75]
ds_read_b128 v[248:251],v17 offset:45056
v_fma_f32 v93,v91,s82,-v93
v_max_f32 v92,0,v92
v_max_f32 v93,0,v93
s_xor_b32 s88,s88,0x2000
s_waitcnt lgkmcnt(5)
v_mfma_f32_16x16x32_bf16 v[64:67],a[64:67],v[224:227],v[64:67]
ds_read_b128 v[252:255],v17 offset:47104
v_min3_u32 v27,v27,v224,v228
v_add_f32 v92,0x3727c5ac,v92
v_add_f32 v93,0x3727c5ac,v93
v_rsq_f32 v94,v92
v_mfma_f32_16x16x32_bf16 v[72:75],a[68:71],v[228:231],v[72:75]
ds_read_b128 v[224:227],v17 offset:49152
v_rsq_f32 v95,v93
v_mul_f32 v123,v92,v94
s_xor_b32 s89,s88,1024
s_waitcnt lgkmcnt(5)
v_mfma_f32_16x16x32_bf16 v[64:67],a[72:75],v[232:235],v[64:67]
ds_read_b128 v[228:231],v17 offset:51200
v_min3_u32 v27,v27,v232,v236
v_mul_f32 v127,v93,v95
v_mul_f32 v122,v28,v94
v_mul_f32 v126,v28,v95
v_mfma_f32_16x16x32_bf16 v[72:75],a[76:79],v[236:239],v[72:75]
ds_read_b128 v[232:235],v17 offset:53248
v_mul_f32 v92,v94,v94
v_mul_f32 v93,v95,v95
v_mul_f32 v94,s81,v94
s_waitcnt lgkmcnt(5)
v_mfma_f32_16x16x32_bf16 v[64:67],a[80:83],v[240:243],v[64:67]
ds_read_b128 v[236:239],v17 offset:55296
v_min3_u32 v27,v27,v240,v244
v_mul_f32 v95,s81,v95
v_mul_f32 v121,v92,v94
v_mul_f32 v125,v93,v95
v_mfma_f32_16x16x32_bf16 v[72:75],a[84:87],v[244:247],v[72:75]
ds_read_b128 v[240:243],v17 offset:57344
ds_write_b128 v19,v[120:123] offset:0
ds_write_b128 v19,v[124:127] offset:256
s_waitcnt lgkmcnt(7)
v_mfma_f32_16x16x32_bf16 v[64:67],a[88:91],v[248:251],v[64:67]
ds_read_b128 v[244:247],v17 offset:59392
v_min3_u32 v27,v27,v248,v252
v_mfma_f32_16x16x32_bf16 v[72:75],a[92:95],v[252:255],v[72:75]
ds_read_b128 v[248:251],v17 offset:61440
s_waitcnt lgkmcnt(7)
v_mfma_f32_16x16x32_bf16 v[64:67],a[96:99],v[224:227],v[64:67]
ds_read_b128 v[252:255],v17 offset:63488
v_min3_u32 v27,v27,v224,v228
v_mfma_f32_16x16x32_bf16 v[72:75],a[100:103],v[228:231],v[72:75]
s_waitcnt vmcnt(3) lgkmcnt(0)
s_barrier
ds_read_b64 v[44:45],v47
ds_read_b128 v[224:227],v17 offset:1024
s_waitcnt vmcnt(0)
v_add_u32 v22,s71,-1
v_mfma_f32_16x16x32_bf16 v[64:67],a[104:107],v[232:235],v[64:67]
ds_read_b128 v[228:231],v17 offset:3072
v_min3_u32 v27,v27,v232,v236
buffer_store_dword v22,v23,s[20:23],s97 offen sc1
s_mov_b32 s97,0x7fff0000
v_mfma_f32_16x16x32_bf16 v[72:75],a[108:111],v[236:239],v[72:75]
ds_read_b128 v[232:235],v17 offset:5120
v_mfma_f32_16x16x32_bf16 v[64:67],a[112:115],v[240:243],v[64:67]
ds_read_b128 v[236:239],v17 offset:7168
v_min3_u32 v27,v27,v240,v244
v_mfma_f32_16x16x32_bf16 v[72:75],a[116:119],v[244:247],v[72:75]
ds_read_b128 v[240:243],v17 offset:9216
s_waitcnt lgkmcnt(5)
v_readfirstlane_b32 s93,v45
v_mfma_f32_16x16x32_bf16 v[64:67],a[120:123],v[248:251],v[64:67]
ds_read_b128 v[244:247],v17 offset:11264
v_readfirstlane_b32 s83,v44
s_cmp_lg_u32 s83,0
s_cbranch_scc1 keep_404
v_min3_u32 v27,v27,v248,v252
v_mfma_f32_16x16x32_bf16 v[72:75],a[124:127],v[252:255],v[72:75]
ds_read_b128 v[248:251],v17 offset:13312
s_add_u32 s66,s88,110592
buffer_load_dwordx4 v[128:131],v16,s[20:23],s66 offen offset:0 sc1
buffer_load_dwordx4 v[132:135],v16,s[20:23],s66 offen offset:1024 sc1
s_waitcnt lgkmcnt(5)
v_mfma_f32_16x16x32_bf16 v[68:71],a[0:3],v[224:227],0
ds_read_b128 v[252:255],v17 offset:15360
v_cmp_eq_u32 vcc,0,v27
s_cbranch_vccnz retry_392
v_min3_u32 v27,v27,v224,v228
buffer_load_dwordx4 v[136:139],v16,s[20:23],s66 offen offset:2048 sc1
buffer_load_dwordx4 v[140:143],v16,s[20:23],s66 offen offset:3072 sc1
v_mfma_f32_16x16x32_bf16 v[76:79],a[4:7],v[228:231],0
ds_read_b128 v[224:227],v17 offset:17408
s_add_u32 s66,s88,114688
buffer_load_dwordx4 v[144:147],v16,s[20:23],s66 offen offset:0 sc1
buffer_load_dwordx4 v[148:151],v16,s[20:23],s66 offen offset:1024 sc1
s_waitcnt lgkmcnt(5)
v_mfma_f32_16x16x32_bf16 v[68:71],a[8:11],v[232:235],v[68:71]
ds_read_b128 v[228:231],v17 offset:19456
v_min3_u32 v27,v27,v232,v236
buffer_load_dwordx4 v[152:155],v16,s[20:23],s66 offen offset:2048 sc1
buffer_load_dwordx4 v[156:159],v16,s[20:23],s66 offen offset:3072 sc1
v_mfma_f32_16x16x32_bf16 v[76:79],a[12:15],v[236:239],v[76:79]
ds_read_b128 v[232:235],v17 offset:21504
s_xor_b32 m0,s72,0
s_add_u32 s65,s88,0
s_waitcnt lgkmcnt(5)
v_mfma_f32_16x16x32_bf16 v[68:71],a[16:19],v[240:243],v[68:71]
ds_read_b128 v[236:239],v17 offset:23552
v_min3_u32 v27,v27,v240,v244
v_add_f32 v64,v64,v72
v_add_f32 v65,v65,v73
v_add_f32 v66,v66,v74
v_add_f32 v67,v67,v75
buffer_load_dwordx4 v16,s[20:23],s65 offen offset:0 sc1 lds
v_mfma_f32_16x16x32_bf16 v[76:79],a[20:23],v[244:247],v[76:79]
ds_read_b128 v[240:243],v17 offset:25600
v_fmac_f32 v64,v52,v120
v_fmac_f32 v65,v53,v120
v_fmac_f32 v66,v54,v120
v_fmac_f32 v67,v55,v120
buffer_load_dwordx4 v16,s[20:23],s65 offen offset:2048 sc1 lds
s_waitcnt lgkmcnt(5)
v_mfma_f32_16x16x32_bf16 v[68:71],a[24:27],v[248:251],v[68:71]
ds_read_b128 v[244:247],v17 offset:27648
v_min3_u32 v27,v27,v248,v252
v_mul_f32 v88,v64,v64
v_mul_f32 v89,v65,v65
v_mul_f32 v90,v66,v66
v_mul_f32 v91,v67,v67
s_xor_b32 m0,s72,16384
s_add_u32 s65,s88,32768
v_mfma_f32_16x16x32_bf16 v[76:79],a[28:31],v[252:255],v[76:79]
ds_read_b128 v[248:251],v17 offset:29696
v_fma_f32 v88,v88,v121,v122
v_fma_f32 v89,v89,v121,v122
v_fma_f32 v90,v90,v121,v122
v_fma_f32 v91,v91,v121,v122
buffer_load_dwordx4 v16,s[20:23],s65 offen offset:0 sc1 lds
s_waitcnt lgkmcnt(5)
v_mfma_f32_16x16x32_bf16 v[68:71],a[32:35],v[224:227],v[68:71]
ds_read_b128 v[252:255],v17 offset:31744
v_min3_u32 v27,v27,v224,v228
v_mul_f32 v88,v88,v64
v_mul_f32 v89,v89,v65
v_mul_f32 v90,v90,v66
v_mul_f32 v91,v91,v67
buffer_load_dwordx4 v16,s[20:23],s65 offen offset:2048 sc1 lds
v_mfma_f32_16x16x32_bf16 v[76:79],a[36:39],v[228:231],v[76:79]
ds_read_b128 v[224:227],v17 offset:33792
v_exp_f32 v88,v88
v_exp_f32 v89,v89
s_xor_b32 m0,s72,32768
s_add_u32 s65,s88,65536
s_waitcnt lgkmcnt(5)
v_mfma_f32_16x16x32_bf16 v[68:71],a[40:43],v[232:235],v[68:71]
ds_read_b128 v[228:231],v17 offset:35840
v_min3_u32 v27,v27,v232,v236
v_exp_f32 v90,v90
v_exp_f32 v91,v91
buffer_load_dwordx4 v16,s[20:23],s65 offen offset:0 sc1 lds
v_mfma_f32_16x16x32_bf16 v[76:79],a[44:47],v[236:239],v[76:79]
ds_read_b128 v[232:235],v17 offset:37888
v_fma_f32 v88,v88,v123,v123
v_fma_f32 v89,v89,v123,v123
v_fma_f32 v90,v90,v123,v123
v_fma_f32 v91,v91,v123,v123
buffer_load_dwordx4 v16,s[20:23],s65 offen offset:2048 sc1 lds
s_waitcnt lgkmcnt(5)
v_mfma_f32_16x16x32_bf16 v[68:71],a[48:51],v[240:243],v[68:71]
ds_read_b128 v[236:239],v17 offset:39936
v_min3_u32 v27,v27,v240,v244
v_rcp_f32 v88,v88
v_rcp_f32 v89,v89
s_xor_b32 m0,s72,49152
s_add_u32 s65,s88,98304
v_mfma_f32_16x16x32_bf16 v[76:79],a[52:55],v[244:247],v[76:79]
ds_read_b128 v[240:243],v17 offset:41984
v_rcp_f32 v90,v90
v_rcp_f32 v91,v91
buffer_load_dwordx4 v16,s[20:23],s65 offen offset:0 sc1 lds
s_waitcnt lgkmcnt(5)
v_mfma_f32_16x16x32_bf16 v[68:71],a[56:59],v[248:251],v[68:71]
ds_read_b128 v[244:247],v17 offset:44032
v_min3_u32 v27,v27,v248,v252
v_mul_f32 v88,v88,v64
v_mul_f32 v89,v89,v65
v_mul_f32 v90,v90,v66
v_mul_f32 v91,v91,v67
v_mfma_f32_16x16x32_bf16 v[76:79],a[60:63],v[252:255],v[76:79]
ds_read_b128 v[248:251],v17 offset:46080
v_cvt_pk_bf16_f32 v96,v88,v89
v_cvt_pk_bf16_f32 v97,v90,v91
v_max_u32 v96,1,v96
s_waitcnt lgkmcnt(5)
v_mfma_f32_16x16x32_bf16 v[68:71],a[64:67],v[224:227],v[68:71]
ds_read_b128 v[252:255],v17 offset:48128
v_min3_u32 v27,v27,v224,v228
buffer_store_dwordx2 v[96:97],v18,s[20:23],s70 offen offset:0 sc1
buffer_load_dwordx4 v16,s[20:23],s65 offen offset:2048 sc1 lds
v_mfma_f32_16x16x32_bf16 v[76:79],a[68:71],v[228:231],v[76:79]
ds_read_b128 v[224:227],v17 offset:50176
s_xor_b32 m0,s72,1024
s_add_u32 s65,s89,0
buffer_load_dwordx4 v16,s[20:23],s65 offen offset:0 sc1 lds
s_waitcnt lgkmcnt(5)
v_mfma_f32_16x16x32_bf16 v[68:71],a[72:75],v[232:235],v[68:71]
ds_read_b128 v[228:231],v17 offset:52224
v_min3_u32 v27,v27,v232,v236
buffer_load_dwordx4 v16,s[20:23],s65 offen offset:2048 sc1 lds
s_xor_b32 m0,s72,17408
s_add_u32 s65,s89,32768
v_mfma_f32_16x16x32_bf16 v[76:79],a[76:79],v[236:239],v[76:79]
ds_read_b128 v[232:235],v17 offset:54272
buffer_load_dwordx4 v16,s[20:23],s65 offen offset:0 sc1 lds
buffer_load_dwordx4 v16,s[20:23],s65 offen offset:2048 sc1 lds
s_waitcnt lgkmcnt(5)
v_mfma_f32_16x16x32_bf16 v[68:71],a[80:83],v[240:243],v[68:71]
ds_read_b128 v[236:239],v17 offset:56320
v_min3_u32 v27,v27,v240,v244
s_xor_b32 m0,s72,33792
s_add_u32 s65,s89,65536
buffer_load_dwordx4 v16,s[20:23],s65 offen offset:0 sc1 lds
v_mfma_f32_16x16x32_bf16 v[76:79],a[84:87],v[244:247],v[76:79]
ds_read_b128 v[240:243],v17 offset:58368
buffer_load_dwordx4 v16,s[20:23],s65 offen offset:2048 sc1 lds
s_xor_b32 m0,s72,50176
s_add_u32 s65,s89,98304
s_waitcnt lgkmcnt(5)
v_mfma_f32_16x16x32_bf16 v[68:71],a[88:91],v[248:251],v[68:71]
ds_read_b128 v[244:247],v17 offset:60416
v_min3_u32 v27,v27,v248,v252
buffer_load_dwordx4 v16,s[20:23],s65 offen offset:0 sc1 lds
buffer_load_dwordx4 v16,s[20:23],s65 offen offset:2048 sc1 lds
v_mfma_f32_16x16x32_bf16 v[76:79],a[92:95],v[252:255],v[76:79]
ds_read_b128 v[248:251],v17 offset:62464
s_waitcnt lgkmcnt(5)
v_mfma_f32_16x16x32_bf16 v[68:71],a[96:99],v[224:227],v[68:71]
ds_read_b128 v[252:255],v17 offset:64512
v_min3_u32 v27,v27,v224,v228
v_mfma_f32_16x16x32_bf16 v[76:79],a[100:103],v[228:231],v[76:79]
s_waitcnt lgkmcnt(4)
v_mfma_f32_16x16x32_bf16 v[68:71],a[104:107],v[232:235],v[68:71]
v_min3_u32 v27,v27,v232,v236
v_mfma_f32_16x16x32_bf16 v[76:79],a[108:111],v[236:239],v[76:79]
s_waitcnt lgkmcnt(2)
v_mfma_f32_16x16x32_bf16 v[68:71],a[112:115],v[240:243],v[68:71]
v_min3_u32 v27,v27,v240,v244
v_mfma_f32_16x16x32_bf16 v[76:79],a[116:119],v[244:247],v[76:79]
s_waitcnt lgkmcnt(0)
v_mfma_f32_16x16x32_bf16 v[68:71],a[120:123],v[248:251],v[68:71]
v_min3_u32 v27,v27,v248,v252
v_mfma_f32_16x16x32_bf16 v[76:79],a[124:127],v[252:255],v[76:79]
v_cmp_eq_u32 vcc,0,v27
s_cbranch_vccnz retry_392
s_branch epi_395
keep_404:
v_min3_u32 v27,v27,v248,v252
v_mfma_f32_16x16x32_bf16 v[72:75],a[124:127],v[252:255],v[72:75]
ds_read_b128 v[248:251],v17 offset:13312
s_waitcnt lgkmcnt(5)
v_mfma_f32_16x16x32_bf16 v[68:71],a[0:3],v[224:227],0
ds_read_b128 v[252:255],v17 offset:15360
v_cmp_eq_u32 vcc,0,v27
s_cbranch_vccnz retry_392
v_min3_u32 v27,v27,v224,v228
v_mfma_f32_16x16x32_bf16 v[76:79],a[4:7],v[228:231],0
ds_read_b128 v[224:227],v17 offset:17408
s_waitcnt lgkmcnt(5)
v_mfma_f32_16x16x32_bf16 v[68:71],a[8:11],v[232:235],v[68:71]
ds_read_b128 v[228:231],v17 offset:19456
v_min3_u32 v27,v27,v232,v236
v_mfma_f32_16x16x32_bf16 v[76:79],a[12:15],v[236:239],v[76:79]
ds_read_b128 v[232:235],v17 offset:21504
s_waitcnt lgkmcnt(5)
v_mfma_f32_16x16x32_bf16 v[68:71],a[16:19],v[240:243],v[68:71]
ds_read_b128 v[236:239],v17 offset:23552
v_min3_u32 v27,v27,v240,v244
v_add_f32 v64,v64,v72
v_add_f32 v65,v65,v73
v_add_f32 v66,v66,v74
v_add_f32 v67,v67,v75
v_mfma_f32_16x16x32_bf16 v[76:79],a[20:23],v[244:247],v[76:79]
ds_read_b128 v[240:243],v17 offset:25600
v_fmac_f32 v64,v52,v120
v_fmac_f32 v65,v53,v120
v_fmac_f32 v66,v54,v120
v_fmac_f32 v67,v55,v120
s_waitcnt lgkmcnt(5)
v_mfma_f32_16x16x32_bf16 v[68:71],a[24:27],v[248:251],v[68:71]
ds_read_b128 v[244:247],v17 offset:27648
v_min3_u32 v27,v27,v248,v252
v_mul_f32 v88,v64,v64
v_mul_f32 v89,v65,v65
v_mul_f32 v90,v66,v66
v_mul_f32 v91,v67,v67
v_mfma_f32_16x16x32_bf16 v[76:79],a[28:31],v[252:255],v[76:79]
ds_read_b128 v[248:251],v17 offset:29696
v_fma_f32 v88,v88,v121,v122
v_fma_f32 v89,v89,v121,v122
v_fma_f32 v90,v90,v121,v122
v_fma_f32 v91,v91,v121,v122
s_waitcnt lgkmcnt(5)
v_mfma_f32_16x16x32_bf16 v[68:71],a[32:35],v[224:227],v[68:71]
ds_read_b128 v[252:255],v17 offset:31744
v_min3_u32 v27,v27,v224,v228
v_mul_f32 v88,v88,v64
v_mul_f32 v89,v89,v65
v_mul_f32 v90,v90,v66
v_mul_f32 v91,v91,v67
v_mfma_f32_16x16x32_bf16 v[76:79],a[36:39],v[228:231],v[76:79]
ds_read_b128 v[224:227],v17 offset:33792
v_exp_f32 v88,v88
v_exp_f32 v89,v89
s_waitcnt lgkmcnt(5)
v_mfma_f32_16x16x32_bf16 v[68:71],a[40:43],v[232:235],v[68:71]
ds_read_b128 v[228:231],v17 offset:35840
v_min3_u32 v27,v27,v232,v236
v_exp_f32 v90,v90
v_exp_f32 v91,v91
v_mfma_f32_16x16x32_bf16 v[76:79],a[44:47],v[236:239],v[76:79]
ds_read_b128 v[232:235],v17 offset:37888
v_fma_f32 v88,v88,v123,v123
v_fma_f32 v89,v89,v123,v123
v_fma_f32 v90,v90,v123,v123
v_fma_f32 v91,v91,v123,v123
s_waitcnt lgkmcnt(5)
v_mfma_f32_16x16x32_bf16 v[68:71],a[48:51],v[240:243],v[68:71]
ds_read_b128 v[236:239],v17 offset:39936
v_min3_u32 v27,v27,v240,v244
v_rcp_f32 v88,v88
v_rcp_f32 v89,v89
v_mfma_f32_16x16x32_bf16 v[76:79],a[52:55],v[244:247],v[76:79]
ds_read_b128 v[240:243],v17 offset:41984
v_rcp_f32 v90,v90
v_rcp_f32 v91,v91
s_waitcnt lgkmcnt(5)
v_mfma_f32_16x16x32_bf16 v[68:71],a[56:59],v[248:251],v[68:71]
ds_read_b128 v[244:247],v17 offset:44032
v_min3_u32 v27,v27,v248,v252
v_mul_f32 v88,v88,v64
v_mul_f32 v89,v89,v65
v_mul_f32 v90,v90,v66
v_mul_f32 v91,v91,v67
v_mfma_f32_16x16x32_bf16 v[76:79],a[60:63],v[252:255],v[76:79]
ds_read_b128 v[248:251],v17 offset:46080
v_cvt_pk_bf16_f32 v96,v88,v89
v_cvt_pk_bf16_f32 v97,v90,v91
v_max_u32 v96,1,v96
s_waitcnt lgkmcnt(5)
v_mfma_f32_16x16x32_bf16 v[68:71],a[64:67],v[224:227],v[68:71]
ds_read_b128 v[252:255],v17 offset:48128
v_min3_u32 v27,v27,v224,v228
buffer_store_dwordx2 v[96:97],v18,s[20:23],s70 offen offset:0 sc1
v_mfma_f32_16x16x32_bf16 v[76:79],a[68:71],v[228:231],v[76:79]
ds_read_b128 v[224:227],v17 offset:50176
s_waitcnt lgkmcnt(5)
v_mfma_f32_16x16x32_bf16 v[68:71],a[72:75],v[232:235],v[68:71]
ds_read_b128 v[228:231],v17 offset:52224
v_min3_u32 v27,v27,v232,v236
v_mfma_f32_16x16x32_bf16 v[76:79],a[76:79],v[236:239],v[76:79]
ds_read_b128 v[232:235],v17 offset:54272
s_waitcnt lgkmcnt(5)
v_mfma_f32_16x16x32_bf16 v[68:71],a[80:83],v[240:243],v[68:71]
ds_read_b128 v[236:239],v17 offset:56320
v_min3_u32 v27,v27,v240,v244
v_mfma_f32_16x16x32_bf16 v[76:79],a[84:87],v[244:247],v[76:79]
ds_read_b128 v[240:243],v17 offset:58368
s_waitcnt lgkmcnt(5)
v_mfma_f32_16x16x32_bf16 v[68:71],a[88:91],v[248:251],v[68:71]
ds_read_b128 v[244:247],v17 offset:60416
v_min3_u32 v27,v27,v248,v252
v_mfma_f32_16x16x32_bf16 v[76:79],a[92:95],v[252:255],v[76:79]
ds_read_b128 v[248:251],v17 offset:62464
s_waitcnt lgkmcnt(5)
v_mfma_f32_16x16x32_bf16 v[68:71],a[96:99],v[224:227],v[68:71]
ds_read_b128 v[252:255],v17 offset:64512
v_min3_u32 v27,v27,v224,v228
v_mfma_f32_16x16x32_bf16 v[76:79],a[100:103],v[228:231],v[76:79]
s_waitcnt lgkmcnt(4)
v_mfma_f32_16x16x32_bf16 v[68:71],a[104:107],v[232:235],v[68:71]
v_min3_u32 v27,v27,v232,v236
v_mfma_f32_16x16x32_bf16 v[76:79],a[108:111],v[236:239],v[76:79]
s_waitcnt lgkmcnt(2)
v_mfma_f32_16x16x32_bf16 v[68:71],a[112:115],v[240:243],v[68:71]
v_min3_u32 v27,v27,v240,v244
v_mfma_f32_16x16x32_bf16 v[76:79],a[116:119],v[244:247],v[76:79]
s_waitcnt lgkmcnt(0)
v_mfma_f32_16x16x32_bf16 v[68:71],a[120:123],v[248:251],v[68:71]
v_min3_u32 v27,v27,v248,v252
v_mfma_f32_16x16x32_bf16 v[76:79],a[124:127],v[252:255],v[76:79]
v_cmp_eq_u32 vcc,0,v27
s_cbranch_vccnz retry_392
s_branch epi_395
both_396:
s_waitcnt vmcnt(11) lgkmcnt(0)
s_barrier
ds_read_b128 v[224:227],v17 offset:0
ds_read_b128 v[228:231],v17 offset:2048
ds_read_b128 v[232:235],v17 offset:4096
ds_read_b128 v[236:239],v17 offset:6144
ds_read_b128 v[240:243],v17 offset:8192
ds_read_b128 v[244:247],v17 offset:10240
ds_read_b128 v[248:251],v17 offset:12288
s_waitcnt lgkmcnt(5)
v_mfma_f32_16x16x32_bf16 v[64:67],a[0:3],v[224:227],0
ds_read_b128 v[252:255],v17 offset:14336
v_min_u32 v27,v224,v228
s_waitcnt vmcnt(12)
stk_411:
v_min3_u32 v22,v129,v133,v137
v_min3_u32 v22,v22,v141,v145
v_min3_u32 v22,v22,v149,v153
v_min_u32 v22,v22,v157
v_cmp_eq_u32 vcc,0,v22
s_cmp_lt_i32 s90,0
s_cselect_b64 vcc,0,vcc
s_cbranch_vccnz str_412
v_mfma_f32_16x16x32_bf16 v[72:75],a[4:7],v[228:231],0
ds_read_b128 v[224:227],v17 offset:16384
v_pk_add_f32 v[88:89],v[128:129],v[144:145]
v_pk_add_f32 v[90:91],v[130:131],v[146:147]
v_pk_add_f32 v[92:93],v[132:133],v[148:149]
v_pk_add_f32 v[94:95],v[134:135],v[150:151]
s_waitcnt lgkmcnt(5)
v_mfma_f32_16x16x32_bf16 v[64:67],a[8:11],v[232:235],v[64:67]
ds_read_b128 v[228:231],v17 offset:18432
v_min3_u32 v27,v27,v232,v236
v_pk_add_f32 v[96:97],v[136:137],v[152:153]
v_pk_add_f32 v[98:99],v[138:139],v[154:155]
v_pk_add_f32 v[100:101],v[140:141],v[156:157]
v_pk_add_f32 v[102:103],v[142:143],v[158:159]
v_mfma_f32_16x16x32_bf16 v[72:75],a[12:15],v[236:239],v[72:75]
ds_read_b128 v[232:235],v17 offset:20480
s_add_u32 s88,s70,s75
s_add_u32 s88,s88,2097152
s_xor_b32 s88,s88,0x2000
s_xor_b32 s89,s88,1024
s_waitcnt lgkmcnt(5)
v_mfma_f32_16x16x32_bf16 v[64:67],a[16:19],v[240:243],v[64:67]
ds_read_b128 v[236:239],v17 offset:22528
v_min3_u32 v27,v27,v240,v244
v_pk_add_f32 v[88:89],v[88:89],v[96:97]
v_pk_add_f32 v[90:91],v[90:91],v[98:99]
v_pk_add_f32 v[92:93],v[92:93],v[100:101]
v_mfma_f32_16x16x32_bf16 v[72:75],a[20:23],v[244:247],v[72:75]
ds_read_b128 v[240:243],v17 offset:24576
v_pk_add_f32 v[94:95],v[94:95],v[102:103]
v_pk_add_f32 v[88:89],v[88:89],v[92:93]
v_pk_add_f32 v[90:91],v[90:91],v[94:95]
s_waitcnt lgkmcnt(5)
v_mfma_f32_16x16x32_bf16 v[64:67],a[24:27],v[248:251],v[64:67]
ds_read_b128 v[244:247],v17 offset:26624
v_min3_u32 v27,v27,v248,v252
v_mov_b32 v92,v88
v_mov_b32 v93,v89
v_mov_b32 v94,v90
v_mfma_f32_16x16x32_bf16 v[72:75],a[28:31],v[252:255],v[72:75]
ds_read_b128 v[248:251],v17 offset:28672
v_mov_b32 v95,v91
v_permlane16_swap_b32 v92,v88
v_permlane16_swap_b32 v93,v89
s_waitcnt lgkmcnt(5)
v_mfma_f32_16x16x32_bf16 v[64:67],a[32:35],v[224:227],v[64:67]
ds_read_b128 v[252:255],v17 offset:30720
v_min3_u32 v27,v27,v224,v228
v_permlane16_swap_b32 v94,v90
v_permlane16_swap_b32 v95,v91
s_add_u32 s66,s88,110592
buffer_load_dwordx4 v[128:131],v16,s[20:23],s66 offen offset:0 sc1
v_mfma_f32_16x16x32_bf16 v[72:75],a[36:39],v[228:231],v[72:75]
ds_read_b128 v[224:227],v17 offset:32768
v_pk_add_f32 v[88:89],v[88:89],v[92:93]
v_pk_add_f32 v[90:91],v[90:91],v[94:95]
v_mov_b32 v92,v88
buffer_load_dwordx4 v[132:135],v16,s[20:23],s66 offen offset:1024 sc1
s_waitcnt lgkmcnt(5)
v_mfma_f32_16x16x32_bf16 v[64:67],a[40:43],v[232:235],v[64:67]
ds_read_b128 v[228:231],v17 offset:34816
v_min3_u32 v27,v27,v232,v236
v_mov_b32 v93,v89
v_mov_b32 v94,v90
v_mov_b32 v95,v91
buffer_load_dwordx4 v[136:139],v16,s[20:23],s66 offen offset:2048 sc1
v_mfma_f32_16x16x32_bf16 v[72:75],a[44:47],v[236:239],v[72:75]
ds_read_b128 v[232:235],v17 offset:36864
v_permlane32_swap_b32 v92,v88
v_permlane32_swap_b32 v93,v89
v_permlane32_swap_b32 v94,v90
buffer_load_dwordx4 v[140:143],v16,s[20:23],s66 offen offset:3072 sc1
s_waitcnt lgkmcnt(5)
v_mfma_f32_16x16x32_bf16 v[64:67],a[48:51],v[240:243],v[64:67]
ds_read_b128 v[236:239],v17 offset:38912
v_min3_u32 v27,v27,v240,v244
v_permlane32_swap_b32 v95,v91
v_pk_add_f32 v[88:89],v[88:89],v[92:93]
s_add_u32 s66,s88,114688
buffer_load_dwordx4 v[144:147],v16,s[20:23],s66 offen offset:0 sc1
v_mfma_f32_16x16x32_bf16 v[72:75],a[52:55],v[244:247],v[72:75]
ds_read_b128 v[240:243],v17 offset:40960
v_pk_add_f32 v[90:91],v[90:91],v[94:95]
v_mul_f32 v120,0xba800000,v88
v_mul_f32 v124,0xba800000,v90
buffer_load_dwordx4 v[148:151],v16,s[20:23],s66 offen offset:1024 sc1
s_waitcnt lgkmcnt(5)
v_mfma_f32_16x16x32_bf16 v[64:67],a[56:59],v[248:251],v[64:67]
ds_read_b128 v[244:247],v17 offset:43008
v_min3_u32 v27,v27,v248,v252
v_mul_f32 v92,v120,v120
v_mul_f32 v93,v124,v124
v_fma_f32 v92,v89,s82,-v92
buffer_load_dwordx4 v[152:155],v16,s[20:23],s66 offen offset:2048 sc1
v_mfma_f32_16x16x32_bf16 v[72:75],a[60:63],v[252:255],v[72:75]
ds_read_b128 v[248:251],v17 offset:45056
v_fma_f32 v93,v91,s82,-v93
v_max_f32 v92,0,v92
v_max_f32 v93,0,v93
buffer_load_dwordx4 v[156:159],v16,s[20:23],s66 offen offset:3072 sc1
s_waitcnt lgkmcnt(5)
v_mfma_f32_16x16x32_bf16 v[64:67],a[64:67],v[224:227],v[64:67]
ds_read_b128 v[252:255],v17 offset:47104
v_min3_u32 v27,v27,v224,v228
v_add_f32 v92,0x3727c5ac,v92
v_add_f32 v93,0x3727c5ac,v93
v_rsq_f32 v94,v92
s_xor_b32 m0,s72,0
v_mfma_f32_16x16x32_bf16 v[72:75],a[68:71],v[228:231],v[72:75]
ds_read_b128 v[224:227],v17 offset:49152
v_rsq_f32 v95,v93
v_mul_f32 v123,v92,v94
s_add_u32 s65,s88,0
s_waitcnt lgkmcnt(5)
v_mfma_f32_16x16x32_bf16 v[64:67],a[72:75],v[232:235],v[64:67]
ds_read_b128 v[228:231],v17 offset:51200
v_min3_u32 v27,v27,v232,v236
v_mul_f32 v127,v93,v95
v_mul_f32 v122,v28,v94
v_mul_f32 v126,v28,v95
buffer_load_dwordx4 v16,s[20:23],s65 offen offset:0 sc1 lds
v_mfma_f32_16x16x32_bf16 v[72:75],a[76:79],v[236:239],v[72:75]
ds_read_b128 v[232:235],v17 offset:53248
v_mul_f32 v92,v94,v94
v_mul_f32 v93,v95,v95
v_mul_f32 v94,s81,v94
buffer_load_dwordx4 v16,s[20:23],s65 offen offset:2048 sc1 lds
s_waitcnt lgkmcnt(5)
v_mfma_f32_16x16x32_bf16 v[64:67],a[80:83],v[240:243],v[64:67]
ds_read_b128 v[236:239],v17 offset:55296
v_min3_u32 v27,v27,v240,v244
v_mul_f32 v95,s81,v95
v_mul_f32 v121,v92,v94
v_mul_f32 v125,v93,v95
s_xor_b32 m0,s72,16384
v_mfma_f32_16x16x32_bf16 v[72:75],a[84:87],v[244:247],v[72:75]
ds_read_b128 v[240:243],v17 offset:57344
ds_write_b128 v19,v[120:123] offset:0
ds_write_b128 v19,v[124:127] offset:256
s_add_u32 s65,s88,32768
s_waitcnt lgkmcnt(7)
v_mfma_f32_16x16x32_bf16 v[64:67],a[88:91],v[248:251],v[64:67]
ds_read_b128 v[244:247],v17 offset:59392
v_min3_u32 v27,v27,v248,v252
buffer_load_dwordx4 v16,s[20:23],s65 offen offset:0 sc1 lds
buffer_load_dwordx4 v16,s[20:23],s65 offen offset:2048 sc1 lds
v_mfma_f32_16x16x32_bf16 v[72:75],a[92:95],v[252:255],v[72:75]
ds_read_b128 v[248:251],v17 offset:61440
s_xor_b32 m0,s72,32768
s_add_u32 s65,s88,65536
buffer_load_dwordx4 v16,s[20:23],s65 offen offset:0 sc1 lds
s_waitcnt lgkmcnt(7)
v_mfma_f32_16x16x32_bf16 v[64:67],a[96:99],v[224:227],v[64:67]
ds_read_b128 v[252:255],v17 offset:63488
v_min3_u32 v27,v27,v224,v228
buffer_load_dwordx4 v16,s[20:23],s65 offen offset:2048 sc1 lds
s_xor_b32 m0,s72,49152
s_add_u32 s65,s88,98304
v_mfma_f32_16x16x32_bf16 v[72:75],a[100:103],v[228:231],v[72:75]
s_waitcnt vmcnt(17) lgkmcnt(0)
s_barrier
ds_read_b64 v[44:45],v47
ds_read_b128 v[224:227],v17 offset:1024
s_waitcnt vmcnt(14)
v_add_u32 v22,s71,-1
v_mfma_f32_16x16x32_bf16 v[64:67],a[104:107],v[232:235],v[64:67]
ds_read_b128 v[228:231],v17 offset:3072
v_min3_u32 v27,v27,v232,v236
buffer_store_dword v22,v23,s[20:23],s97 offen sc1
s_mov_b32 s97,0x7fff0000
v_mfma_f32_16x16x32_bf16 v[72:75],a[108:111],v[236:239],v[72:75]
ds_read_b128 v[232:235],v17 offset:5120
buffer_load_dwordx4 v16,s[20:23],s65 offen offset:0 sc1 lds
buffer_load_dwordx4 v16,s[20:23],s65 offen offset:2048 sc1 lds
v_mfma_f32_16x16x32_bf16 v[64:67],a[112:115],v[240:243],v[64:67]
ds_read_b128 v[236:239],v17 offset:7168
v_min3_u32 v27,v27,v240,v244
s_xor_b32 m0,s72,1024
s_add_u32 s65,s89,0
buffer_load_dwordx4 v16,s[20:23],s65 offen offset:0 sc1 lds
v_mfma_f32_16x16x32_bf16 v[72:75],a[116:119],v[244:247],v[72:75]
ds_read_b128 v[240:243],v17 offset:9216
s_waitcnt lgkmcnt(5)
v_readfirstlane_b32 s93,v45
buffer_load_dwordx4 v16,s[20:23],s65 offen offset:2048 sc1 lds
v_mfma_f32_16x16x32_bf16 v[64:67],a[120:123],v[248:251],v[64:67]
ds_read_b128 v[244:247],v17 offset:11264
v_min3_u32 v27,v27,v248,v252
s_xor_b32 m0,s72,17408
s_add_u32 s65,s89,32768
buffer_load_dwordx4 v16,s[20:23],s65 offen offset:0 sc1 lds
v_mfma_f32_16x16x32_bf16 v[72:75],a[124:127],v[252:255],v[72:75]
ds_read_b128 v[248:251],v17 offset:13312
buffer_load_dwordx4 v16,s[20:23],s65 offen offset:2048 sc1 lds
s_xor_b32 m0,s72,33792
s_add_u32 s65,s89,65536
s_waitcnt lgkmcnt(5)
v_mfma_f32_16x16x32_bf16 v[68:71],a[0:3],v[224:227],0
ds_read_b128 v[252:255],v17 offset:15360
v_cmp_eq_u32 vcc,0,v27
s_cbranch_vccnz retry_392
v_min3_u32 v27,v27,v224,v228
buffer_load_dwordx4 v16,s[20:23],s65 offen offset:0 sc1 lds
v_mfma_f32_16x16x32_bf16 v[76:79],a[4:7],v[228:231],0
ds_read_b128 v[224:227],v17 offset:17408
buffer_load_dwordx4 v16,s[20:23],s65 offen offset:2048 sc1 lds
s_xor_b32 m0,s72,50176
s_add_u32 s65,s89,98304
s_waitcnt lgkmcnt(5)
v_mfma_f32_16x16x32_bf16 v[68:71],a[8:11],v[232:235],v[68:71]
ds_read_b128 v[228:231],v17 offset:19456
v_min3_u32 v27,v27,v232,v236
buffer_load_dwordx4 v16,s[20:23],s65 offen offset:0 sc1 lds
buffer_load_dwordx4 v16,s[20:23],s65 offen offset:2048 sc1 lds
v_mfma_f32_16x16x32_bf16 v[76:79],a[12:15],v[236:239],v[76:79]
ds_read_b128 v[232:235],v17 offset:21504
s_waitcnt lgkmcnt(5)
v_mfma_f32_16x16x32_bf16 v[68:71],a[16:19],v[240:243],v[68:71]
ds_read_b128 v[236:239],v17 offset:23552
v_min3_u32 v27,v27,v240,v244
v_add_f32 v64,v64,v72
v_add_f32 v65,v65,v73
v_add_f32 v66,v66,v74
v_add_f32 v67,v67,v75
v_mfma_f32_16x16x32_bf16 v[76:79],a[20:23],v[244:247],v[76:79]
ds_read_b128 v[240:243],v17 offset:25600
v_fmac_f32 v64,v52,v120
v_fmac_f32 v65,v53,v120
v_fmac_f32 v66,v54,v120
v_fmac_f32 v67,v55,v120
s_waitcnt lgkmcnt(5)
v_mfma_f32_16x16x32_bf16 v[68:71],a[24:27],v[248:251],v[68:71]
ds_read_b128 v[244:247],v17 offset:27648
v_min3_u32 v27,v27,v248,v252
v_mul_f32 v88,v64,v64
v_mul_f32 v89,v65,v65
v_mul_f32 v90,v66,v66
v_mul_f32 v91,v67,v67
v_mfma_f32_16x16x32_bf16 v[76:79],a[28:31],v[252:255],v[76:79]
ds_read_b128 v[248:251],v17 offset:29696
v_fma_f32 v88,v88,v121,v122
v_fma_f32 v89,v89,v121,v122
v_fma_f32 v90,v90,v121,v122
v_fma_f32 v91,v91,v121,v122
s_waitcnt lgkmcnt(5)
v_mfma_f32_16x16x32_bf16 v[68:71],a[32:35],v[224:227],v[68:71]
ds_read_b128 v[252:255],v17 offset:31744
v_min3_u32 v27,v27,v224,v228
v_mul_f32 v88,v88,v64
v_mul_f32 v89,v89,v65
v_mul_f32 v90,v90,v66
v_mul_f32 v91,v91,v67
v_mfma_f32_16x16x32_bf16 v[76:79],a[36:39],v[228:231],v[76:79]
ds_read_b128 v[224:227],v17 offset:33792
v_exp_f32 v88,v88
v_exp_f32 v89,v89
s_waitcnt lgkmcnt(5)
v_mfma_f32_16x16x32_bf16 v[68:71],a[40:43],v[232:235],v[68:71]
ds_read_b128 v[228:231],v17 offset:35840
v_min3_u32 v27,v27,v232,v236
v_exp_f32 v90,v90
v_exp_f32 v91,v91
v_mfma_f32_16x16x32_bf16 v[76:79],a[44:47],v[236:239],v[76:79]
ds_read_b128 v[232:235],v17 offset:37888
v_fma_f32 v88,v88,v123,v123
v_fma_f32 v89,v89,v123,v123
v_fma_f32 v90,v90,v123,v123
v_fma_f32 v91,v91,v123,v123
s_waitcnt lgkmcnt(5)
v_mfma_f32_16x16x32_bf16 v[68:71],a[48:51],v[240:243],v[68:71]
ds_read_b128 v[236:239],v17 offset:39936
v_min3_u32 v27,v27,v240,v244
v_rcp_f32 v88,v88
v_rcp_f32 v89,v89
v_mfma_f32_16x16x32_bf16 v[76:79],a[52:55],v[244:247],v[76:79]
ds_read_b128 v[240:243],v17 offset:41984
v_rcp_f32 v90,v90
v_rcp_f32 v91,v91
s_waitcnt lgkmcnt(5)
v_mfma_f32_16x16x32_bf16 v[68:71],a[56:59],v[248:251],v[68:71]
ds_read_b128 v[244:247],v17 offset:44032
v_min3_u32 v27,v27,v248,v252
v_mul_f32 v88,v88,v64
v_mul_f32 v89,v89,v65
v_mul_f32 v90,v90,v66
v_mul_f32 v91,v91,v67
v_mfma_f32_16x16x32_bf16 v[76:79],a[60:63],v[252:255],v[76:79]
ds_read_b128 v[248:251],v17 offset:46080
v_cvt_pk_bf16_f32 v96,v88,v89
v_cvt_pk_bf16_f32 v97,v90,v91
v_max_u32 v96,1,v96
s_waitcnt lgkmcnt(5)
v_mfma_f32_16x16x32_bf16 v[68:71],a[64:67],v[224:227],v[68:71]
ds_read_b128 v[252:255],v17 offset:48128
v_min3_u32 v27,v27,v224,v228
buffer_store_dwordx2 v[96:97],v18,s[20:23],s70 offen offset:0 sc1
v_mfma_f32_16x16x32_bf16 v[76:79],a[68:71],v[228:231],v[76:79]
ds_read_b128 v[224:227],v17 offset:50176
s_waitcnt lgkmcnt(5)
v_mfma_f32_16x16x32_bf16 v[68:71],a[72:75],v[232:235],v[68:71]
ds_read_b128 v[228:231],v17 offset:52224
v_min3_u32 v27,v27,v232,v236
v_mfma_f32_16x16x32_bf16 v[76:79],a[76:79],v[236:239],v[76:79]
ds_read_b128 v[232:235],v17 offset:54272
s_waitcnt lgkmcnt(5)
v_mfma_f32_16x16x32_bf16 v[68:71],a[80:83],v[240:243],v[68:71]
ds_read_b128 v[236:239],v17 offset:56320
v_min3_u32 v27,v27,v240,v244
v_mfma_f32_16x16x32_bf16 v[76:79],a[84:87],v[244:247],v[76:79]
ds_read_b128 v[240:243],v17 offset:58368
s_waitcnt lgkmcnt(5)
v_mfma_f32_16x16x32_bf16 v[68:71],a[88:91],v[248:251],v[68:71]
ds_read_b128 v[244:247],v17 offset:60416
v_min3_u32 v27,v27,v248,v252
v_mfma_f32_16x16x32_bf16 v[76:79],a[92:95],v[252:255],v[76:79]
ds_read_b128 v[248:251],v17 offset:62464
s_waitcnt lgkmcnt(5)
v_mfma_f32_16x16x32_bf16 v[68:71],a[96:99],v[224:227],v[68:71]
ds_read_b128 v[252:255],v17 offset:64512
v_min3_u32 v27,v27,v224,v228
v_mfma_f32_16x16x32_bf16 v[76:79],a[100:103],v[228:231],v[76:79]
s_waitcnt lgkmcnt(4)
v_mfma_f32_16x16x32_bf16 v[68:71],a[104:107],v[232:235],v[68:71]
v_min3_u32 v27,v27,v232,v236
v_mfma_f32_16x16x32_bf16 v[76:79],a[108:111],v[236:239],v[76:79]
s_waitcnt lgkmcnt(2)
v_mfma_f32_16x16x32_bf16 v[68:71],a[112:115],v[240:243],v[68:71]
v_min3_u32 v27,v27,v240,v244
v_mfma_f32_16x16x32_bf16 v[76:79],a[116:119],v[244:247],v[76:79]
s_waitcnt lgkmcnt(0)
v_mfma_f32_16x16x32_bf16 v[68:71],a[120:123],v[248:251],v[68:71]
v_min3_u32 v27,v27,v248,v252
v_mfma_f32_16x16x32_bf16 v[76:79],a[124:127],v[252:255],v[76:79]
v_cmp_eq_u32 vcc,0,v27
s_cbranch_vccnz retry_392
epi_395:
buffer_load_dword v29,v21,s[20:23],s87 offen sc1
s_nop 4
v_pk_add_f32 v[68:69],v[68:69],v[76:77]
v_pk_add_f32 v[70:71],v[70:71],v[78:79]
v_pk_fma_f32 v[68:69],v[52:53],v[124:125],v[68:69] op_sel_hi:[1,0,1]
v_pk_fma_f32 v[70:71],v[54:55],v[124:125],v[70:71] op_sel_hi:[1,0,1]
v_pk_mul_f32 v[88:89],v[68:69],v[68:69]
v_pk_mul_f32 v[90:91],v[70:71],v[70:71]
v_pk_fma_f32 v[88:89],v[88:89],v[124:125],v[126:127] op_sel:[0,1,0] op_sel_hi:[1,1,0]
v_pk_fma_f32 v[90:91],v[90:91],v[124:125],v[126:127] op_sel:[0,1,0] op_sel_hi:[1,1,0]
v_pk_mul_f32 v[88:89],v[88:89],v[68:69]
v_pk_mul_f32 v[90:91],v[90:91],v[70:71]
v_exp_f32 v88,v88
v_exp_f32 v89,v89
v_exp_f32 v90,v90
s_cmp_gt_u32 s71,40
s_cselect_b32 s65,s73,0x7fff0000
s_cselect_b32 s97,0x7fff0000,s73
v_mov_b32 v22,s71
buffer_store_dword v22,v23,s[20:23],s65 offen sc1
v_exp_f32 v91,v91
v_pk_fma_f32 v[88:89],v[88:89],v[126:127],v[126:127] op_sel:[0,1,1] op_sel_hi:[1,1,1]
v_pk_fma_f32 v[90:91],v[90:91],v[126:127],v[126:127] op_sel:[0,1,1] op_sel_hi:[1,1,1]
v_rcp_f32 v88,v88
v_rcp_f32 v89,v89
v_rcp_f32 v90,v90
v_rcp_f32 v91,v91
v_pk_mul_f32 v[88:89],v[88:89],v[68:69]
v_pk_mul_f32 v[90:91],v[90:91],v[70:71]
v_cvt_pk_bf16_f32 v96,v88,v89
v_cvt_pk_bf16_f32 v97,v90,v91
v_max_u32 v96,1,v96
buffer_store_dwordx2 v[96:97],v18,s[20:23],s70 offen offset:1024 sc1
next_402:
v_xor_b32 v17,0x10000,v17
s_xor_b32 s72,s72,0x10000
s_add_u32 s70,s70,2097152
s_xor_b32 s70,s70,0x2000
s_add_u32 s71,s71,1
s_cmp_le_u32 s71,s57
s_cbranch_scc1 seg_393
s_endpgm
retry_392:
s_sub_u32 s90,s90,64
s_cmp_lt_i32 s90,0
s_cbranch_scc1 giveup_197
s_mov_b32 s83,1
s_waitcnt vmcnt(0) lgkmcnt(0)
s_barrier
s_branch seg_393
half_401:
s_mov_b64 exec,s[52:53]
s_xor_b32 m0,s91,0
s_add_u32 s65,s94,0
buffer_load_dwordx4 v16,s[20:23],s65 offen offset:0 sc1 lds
buffer_load_dwordx4 v16,s[20:23],s65 offen offset:2048 sc1 lds
s_xor_b32 m0,s91,16384
s_add_u32 s65,s94,32768
buffer_load_dwordx4 v16,s[20:23],s65 offen offset:0 sc1 lds
buffer_load_dwordx4 v16,s[20:23],s65 offen offset:2048 sc1 lds
s_xor_b32 m0,s91,32768
s_add_u32 s65,s94,65536
buffer_load_dwordx4 v16,s[20:23],s65 offen offset:0 sc1 lds
buffer_load_dwordx4 v16,s[20:23],s65 offen offset:2048 sc1 lds
s_xor_b32 m0,s91,49152
s_add_u32 s65,s94,98304
buffer_load_dwordx4 v16,s[20:23],s65 offen offset:0 sc1 lds
buffer_load_dwordx4 v16,s[20:23],s65 offen offset:2048 sc1 lds
s_add_u32 s66,s94,110592
buffer_load_dwordx4 v[128:131],v16,s[20:23],s66 offen offset:0 sc1
buffer_load_dwordx4 v[132:135],v16,s[20:23],s66 offen offset:1024 sc1
buffer_load_dwordx4 v[136:139],v16,s[20:23],s66 offen offset:2048 sc1
buffer_load_dwordx4 v[140:143],v16,s[20:23],s66 offen offset:3072 sc1
s_add_u32 s66,s94,114688
buffer_load_dwordx4 v[144:147],v16,s[20:23],s66 offen offset:0 sc1
buffer_load_dwordx4 v[148:151],v16,s[20:23],s66 offen offset:1024 sc1
buffer_load_dwordx4 v[152:155],v16,s[20:23],s66 offen offset:2048 sc1
buffer_load_dwordx4 v[156:159],v16,s[20:23],s66 offen offset:3072 sc1
s_mov_b64 exec,-1
s_waitcnt vmcnt(16)
v_add_u32 v22,s71,-1
buffer_store_dword v22,v23,s[20:23],s97 offen sc1
s_mov_b32 s97,0x7fff0000
half2_398:
s_waitcnt vmcnt(15)
s_barrier
ds_read_b128 v[224:227],v17 offset:0
ds_read_b128 v[228:231],v17 offset:2048
ds_read_b128 v[232:235],v17 offset:4096
ds_read_b128 v[236:239],v17 offset:6144
ds_read_b128 v[240:243],v17 offset:8192
ds_read_b128 v[244:247],v17 offset:10240
ds_read_b128 v[248:251],v17 offset:12288
s_waitcnt lgkmcnt(5)
v_mfma_f32_16x16x32_bf16 v[64:67],a[0:3],v[224:227],0
ds_read_b128 v[252:255],v17 offset:14336
v_min_u32 v27,v224,v228
v_mfma_f32_16x16x32_bf16 v[72:75],a[4:7],v[228:231],0
s_waitcnt vmcnt(13)
s_barrier
ds_read_b128 v[224:227],v17 offset:16384
s_waitcnt lgkmcnt(5)
v_mfma_f32_16x16x32_bf16 v[64:67],a[8:11],v[232:235],v[64:67]
ds_read_b128 v[228:231],v17 offset:18432
v_min3_u32 v27,v27,v232,v236
v_mfma_f32_16x16x32_bf16 v[72:75],a[12:15],v[236:239],v[72:75]
ds_read_b128 v[232:235],v17 offset:20480
s_waitcnt lgkmcnt(5)
v_mfma_f32_16x16x32_bf16 v[64:67],a[16:19],v[240:243],v[64:67]
ds_read_b128 v[236:239],v17 offset:22528
v_min3_u32 v27,v27,v240,v244
v_mfma_f32_16x16x32_bf16 v[72:75],a[20:23],v[244:247],v[72:75]
ds_read_b128 v[240:243],v17 offset:24576
s_waitcnt lgkmcnt(5)
v_mfma_f32_16x16x32_bf16 v[64:67],a[24:27],v[248:251],v[64:67]
ds_read_b128 v[244:247],v17 offset:26624
v_min3_u32 v27,v27,v248,v252
v_mfma_f32_16x16x32_bf16 v[72:75],a[28:31],v[252:255],v[72:75]
ds_read_b128 v[248:251],v17 offset:28672
s_waitcnt lgkmcnt(5)
v_mfma_f32_16x16x32_bf16 v[64:67],a[32:35],v[224:227],v[64:67]
ds_read_b128 v[252:255],v17 offset:30720
v_min3_u32 v27,v27,v224,v228
v_mfma_f32_16x16x32_bf16 v[72:75],a[36:39],v[228:231],v[72:75]
s_waitcnt vmcnt(9)
s_barrier
ds_read_b128 v[224:227],v17 offset:32768
s_waitcnt lgkmcnt(5)
v_mfma_f32_16x16x32_bf16 v[64:67],a[40:43],v[232:235],v[64:67]
ds_read_b128 v[228:231],v17 offset:34816
v_min3_u32 v27,v27,v232,v236
v_mfma_f32_16x16x32_bf16 v[72:75],a[44:47],v[236:239],v[72:75]
ds_read_b128 v[232:235],v17 offset:36864
s_waitcnt lgkmcnt(5)
v_mfma_f32_16x16x32_bf16 v[64:67],a[48:51],v[240:243],v[64:67]
ds_read_b128 v[236:239],v17 offset:38912
v_min3_u32 v27,v27,v240,v244
s_waitcnt vmcnt(1)
stk_413:
v_min3_u32 v22,v129,v133,v137
v_min3_u32 v22,v22,v141,v145
v_min3_u32 v22,v22,v149,v153
v_min_u32 v22,v22,v157
v_cmp_eq_u32 vcc,0,v22
s_and_b64 vcc,vcc,s[52:53]
s_cmp_lt_i32 s90,0
s_cselect_b64 vcc,0,vcc
s_cbranch_vccnz str_414
v_mfma_f32_16x16x32_bf16 v[72:75],a[52:55],v[244:247],v[72:75]
ds_read_b128 v[240:243],v17 offset:40960
v_pk_add_f32 v[88:89],v[128:129],v[144:145]
v_pk_add_f32 v[90:91],v[130:131],v[146:147]
v_pk_add_f32 v[92:93],v[132:133],v[148:149]
v_pk_add_f32 v[94:95],v[134:135],v[150:151]
v_pk_add_f32 v[96:97],v[136:137],v[152:153]
v_pk_add_f32 v[98:99],v[138:139],v[154:155]
v_pk_add_f32 v[100:101],v[140:141],v[156:157]
v_pk_add_f32 v[102:103],v[142:143],v[158:159]
v_pk_add_f32 v[88:89],v[88:89],v[96:97]
v_pk_add_f32 v[90:91],v[90:91],v[98:99]
s_waitcnt lgkmcnt(5)
v_mfma_f32_16x16x32_bf16 v[64:67],a[56:59],v[248:251],v[64:67]
ds_read_b128 v[244:247],v17 offset:43008
v_min3_u32 v27,v27,v248,v252
v_pk_add_f32 v[92:93],v[92:93],v[100:101]
v_pk_add_f32 v[94:95],v[94:95],v[102:103]
v_pk_add_f32 v[88:89],v[88:89],v[92:93]
v_pk_add_f32 v[90:91],v[90:91],v[94:95]
v_mov_b32 v92,v88
v_mov_b32 v93,v89
v_mov_b32 v94,v90
v_mov_b32 v95,v91
v_permlane16_swap_b32 v92,v88
v_mfma_f32_16x16x32_bf16 v[72:75],a[60:63],v[252:255],v[72:75]
ds_read_b128 v[248:251],v17 offset:45056
v_permlane16_swap_b32 v93,v89
v_permlane16_swap_b32 v94,v90
v_permlane16_swap_b32 v95,v91
v_pk_add_f32 v[88:89],v[88:89],v[92:93]
v_pk_add_f32 v[90:91],v[90:91],v[94:95]
v_mov_b32 v92,v88
v_mov_b32 v93,v89
s_waitcnt lgkmcnt(5)
v_mfma_f32_16x16x32_bf16 v[64:67],a[64:67],v[224:227],v[64:67]
ds_read_b128 v[252:255],v17 offset:47104
v_min3_u32 v27,v27,v224,v228
v_mov_b32 v94,v90
v_mov_b32 v95,v91
v_permlane32_swap_b32 v92,v88
v_permlane32_swap_b32 v93,v89
v_permlane32_swap_b32 v94,v90
v_permlane32_swap_b32 v95,v91
v_mfma_f32_16x16x32_bf16 v[72:75],a[68:71],v[228:231],v[72:75]
ds_read_b128 v[224:227],v17 offset:49152
v_pk_add_f32 v[88:89],v[88:89],v[92:93]
v_pk_add_f32 v[90:91],v[90:91],v[94:95]
v_mul_f32 v120,0xba800000,v88
v_mul_f32 v124,0xba800000,v90
s_waitcnt lgkmcnt(5)
v_mfma_f32_16x16x32_bf16 v[64:67],a[72:75],v[232:235],v[64:67]
ds_read_b128 v[228:231],v17 offset:51200
v_min3_u32 v27,v27,v232,v236
v_mul_f32 v92,v120,v120
v_mul_f32 v93,v124,v124
v_fma_f32 v92,v89,s82,-v92
v_fma_f32 v93,v91,s82,-v93
v_mfma_f32_16x16x32_bf16 v[72:75],a[76:79],v[236:239],v[72:75]
ds_read_b128 v[232:235],v17 offset:53248
v_max_f32 v92,0,v92
v_max_f32 v93,0,v93
v_add_f32 v92,0x3727c5ac,v92
v_add_f32 v93,0x3727c5ac,v93
s_waitcnt lgkmcnt(5)
v_mfma_f32_16x16x32_bf16 v[64:67],a[80:83],v[240:243],v[64:67]
ds_read_b128 v[236:239],v17 offset:55296
v_min3_u32 v27,v27,v240,v244
v_rsq_f32 v94,v92
v_rsq_f32 v95,v93
v_mfma_f32_16x16x32_bf16 v[72:75],a[84:87],v[244:247],v[72:75]
ds_read_b128 v[240:243],v17 offset:57344
v_mul_f32 v123,v92,v94
v_mul_f32 v127,v93,v95
v_mul_f32 v122,v28,v94
v_mul_f32 v126,v28,v95
s_waitcnt lgkmcnt(5)
v_mfma_f32_16x16x32_bf16 v[64:67],a[88:91],v[248:251],v[64:67]
ds_read_b128 v[244:247],v17 offset:59392
v_min3_u32 v27,v27,v248,v252
v_mul_f32 v92,v94,v94
v_mul_f32 v93,v95,v95
v_mul_f32 v94,s81,v94
v_mul_f32 v95,s81,v95
v_mfma_f32_16x16x32_bf16 v[72:75],a[92:95],v[252:255],v[72:75]
ds_read_b128 v[248:251],v17 offset:61440
v_mul_f32 v121,v92,v94
v_mul_f32 v125,v93,v95
ds_write_b128 v19,v[120:123] offset:0
ds_write_b128 v19,v[124:127] offset:256
s_waitcnt lgkmcnt(7)
v_mfma_f32_16x16x32_bf16 v[64:67],a[96:99],v[224:227],v[64:67]
s_waitcnt lgkmcnt(0)
s_barrier
ds_read_b128 v[252:255],v17 offset:63488
v_min3_u32 v27,v27,v224,v228
v_mfma_f32_16x16x32_bf16 v[72:75],a[100:103],v[228:231],v[72:75]
v_mfma_f32_16x16x32_bf16 v[64:67],a[104:107],v[232:235],v[64:67]
v_min3_u32 v27,v27,v232,v236
v_mfma_f32_16x16x32_bf16 v[72:75],a[108:111],v[236:239],v[72:75]
v_mfma_f32_16x16x32_bf16 v[64:67],a[112:115],v[240:243],v[64:67]
v_min3_u32 v27,v27,v240,v244
v_mfma_f32_16x16x32_bf16 v[72:75],a[116:119],v[244:247],v[72:75]
s_waitcnt lgkmcnt(0)
v_mfma_f32_16x16x32_bf16 v[64:67],a[120:123],v[248:251],v[64:67]
v_min3_u32 v27,v27,v248,v252
v_mfma_f32_16x16x32_bf16 v[72:75],a[124:127],v[252:255],v[72:75]
v_cmp_eq_u32 vcc,0,v27
s_and_b64 vcc,vcc,s[52:53]
s_cbranch_vccnz retry_392
s_waitcnt lgkmcnt(0)
s_nop 3
v_pk_add_f32 v[64:65],v[64:65],v[72:73]
v_pk_add_f32 v[66:67],v[66:67],v[74:75]
v_pk_fma_f32 v[64:65],v[52:53],v[120:121],v[64:65] op_sel_hi:[1,0,1]
v_pk_fma_f32 v[66:67],v[54:55],v[120:121],v[66:67] op_sel_hi:[1,0,1]
v_pk_mul_f32 v[88:89],v[64:65],v[64:65]
v_pk_mul_f32 v[90:91],v[66:67],v[66:67]
buffer_load_dword v29,v21,s[20:23],s87 offen sc1
v_mov_b32 v22,s71
buffer_store_dword v22,v23,s[20:23],s73 offen sc1
v_pk_fma_f32 v[88:89],v[88:89],v[120:121],v[122:123] op_sel:[0,1,0] op_sel_hi:[1,1,0]
v_pk_fma_f32 v[90:91],v[90:91],v[120:121],v[122:123] op_sel:[0,1,0] op_sel_hi:[1,1,0]
v_pk_mul_f32 v[88:89],v[88:89],v[64:65]
v_pk_mul_f32 v[90:91],v[90:91],v[66:67]
v_exp_f32 v88,v88
v_exp_f32 v89,v89
v_exp_f32 v90,v90
v_exp_f32 v91,v91
v_pk_fma_f32 v[88:89],v[88:89],v[122:123],v[122:123] op_sel:[0,1,1] op_sel_hi:[1,1,1]
v_pk_fma_f32 v[90:91],v[90:91],v[122:123],v[122:123] op_sel:[0,1,1] op_sel_hi:[1,1,1]
v_rcp_f32 v88,v88
v_rcp_f32 v89,v89
v_rcp_f32 v90,v90
v_rcp_f32 v91,v91
v_pk_mul_f32 v[88:89],v[88:89],v[64:65]
v_pk_mul_f32 v[90:91],v[90:91],v[66:67]
v_cvt_pk_bf16_f32 v96,v88,v89
v_cvt_pk_bf16_f32 v97,v90,v91
v_max_u32 v96,1,v96
buffer_store_dwordx2 v[96:97],v18,s[20:23],s70 offen offset:0 sc1
s_branch next_402
str_408:
s_add_u32 s94,s70,s75
s_add_u32 s66,s94,110592
buffer_load_dwordx4 v[128:131],v16,s[20:23],s66 offen offset:0 sc1
buffer_load_dwordx4 v[132:135],v16,s[20:23],s66 offen offset:1024 sc1
buffer_load_dwordx4 v[136:139],v16,s[20:23],s66 offen offset:2048 sc1
buffer_load_dwordx4 v[140:143],v16,s[20:23],s66 offen offset:3072 sc1
s_add_u32 s66,s94,114688
buffer_load_dwordx4 v[144:147],v16,s[20:23],s66 offen offset:0 sc1
buffer_load_dwordx4 v[148:151],v16,s[20:23],s66 offen offset:1024 sc1
buffer_load_dwordx4 v[152:155],v16,s[20:23],s66 offen offset:2048 sc1
buffer_load_dwordx4 v[156:159],v16,s[20:23],s66 offen offset:3072 sc1
s_sub_u32 s90,s90,1
s_waitcnt vmcnt(0)
s_branch stk_407
str_410:
s_add_u32 s94,s70,s75
s_add_u32 s66,s94,110592
buffer_load_dwordx4 v[128:131],v16,s[20:23],s66 offen offset:0 sc1
buffer_load_dwordx4 v[132:135],v16,s[20:23],s66 offen offset:1024 sc1
buffer_load_dwordx4 v[136:139],v16,s[20:23],s66 offen offset:2048 sc1
buffer_load_dwordx4 v[140:143],v16,s[20:23],s66 offen offset:3072 sc1
s_add_u32 s66,s94,114688
buffer_load_dwordx4 v[144:147],v16,s[20:23],s66 offen offset:0 sc1
buffer_load_dwordx4 v[148:151],v16,s[20:23],s66 offen offset:1024 sc1
buffer_load_dwordx4 v[152:155],v16,s[20:23],s66 offen offset:2048 sc1
buffer_load_dwordx4 v[156:159],v16,s[20:23],s66 offen offset:3072 sc1
s_sub_u32 s90,s90,1
s_waitcnt vmcnt(0)
s_branch stk_409
str_412:
s_add_u32 s94,s70,s75
s_add_u32 s66,s94,110592
buffer_load_dwordx4 v[128:131],v16,s[20:23],s66 offen offset:0 sc1
buffer_load_dwordx4 v[132:135],v16,s[20:23],s66 offen offset:1024 sc1
buffer_load_dwordx4 v[136:139],v16,s[20:23],s66 offen offset:2048 sc1
buffer_load_dwordx4 v[140:143],v16,s[20:23],s66 offen offset:3072 sc1
s_add_u32 s66,s94,114688
buffer_load_dwordx4 v[144:147],v16,s[20:23],s66 offen offset:0 sc1
buffer_load_dwordx4 v[148:151],v16,s[20:23],s66 offen offset:1024 sc1
buffer_load_dwordx4 v[152:155],v16,s[20:23],s66 offen offset:2048 sc1
buffer_load_dwordx4 v[156:159],v16,s[20:23],s66 offen offset:3072 sc1
s_sub_u32 s90,s90,1
s_waitcnt vmcnt(0)
s_branch stk_411
str_414:
s_add_u32 s94,s70,s75
s_add_u32 s66,s94,110592
buffer_load_dwordx4 v[128:131],v16,s[20:23],s66 offen offset:0 sc1
buffer_load_dwordx4 v[132:135],v16,s[20:23],s66 offen offset:1024 sc1
buffer_load_dwordx4 v[136:139],v16,s[20:23],s66 offen offset:2048 sc1
buffer_load_dwordx4 v[140:143],v16,s[20:23],s66 offen offset:3072 sc1
s_add_u32 s66,s94,114688
buffer_load_dwordx4 v[144:147],v16,s[20:23],s66 offen offset:0 sc1
buffer_load_dwordx4 v[148:151],v16,s[20:23],s66 offen offset:1024 sc1
buffer_load_dwordx4 v[152:155],v16,s[20:23],s66 offen offset:2048 sc1
buffer_load_dwordx4 v[156:159],v16,s[20:23],s66 offen offset:3072 sc1
s_sub_u32 s90,s90,1
s_waitcnt vmcnt(0)
s_branch stk_413
giveup_197:
s_endpgm
code_end:
.section .rodata,"a"
.p2align 6
.amdhsa_kernel mega_kernel
  .amdhsa_next_free_vgpr 512
  .amdhsa_next_free_sgpr 102
  .amdhsa_accum_offset 256
  .amdhsa_group_segment_fixed_size 0
  .amdhsa_kernarg_size 136
  .amdhsa_user_sgpr_count 2
  .amdhsa_user_sgpr_kernarg_segment_ptr 1
  .amdhsa_system_sgpr_workgroup_id_x 1
.end_amdhsa_kernel
```

```asm
; @launch kernel=mega_kernel grid=(256,1,1) block=(256,1,1) lds=163840
.amdgcn_target "amdgcn-amd-amdhsa--gfx950"
.text
.globl mega_kernel
.p2align 8
.type mega_kernel,@function
mega_kernel:
s_cmp_ge_u32 s2,256
s_cbranch_scc1 done_1
s_load_dwordx4 s[16:19],s[0:1],120
s_load_dword s3,s[0:1],0
s_getpc_b64 s[4:5]
pc_2:
s_sub_u32 s8,s4,pc_2-mega_kernel
s_subb_u32 s9,s5,0
s_and_b32 s9,s9,0xffff
s_mov_b32 s10,code_end-mega_kernel
s_mov_b32 s11,0x20000
v_lshlrev_b32 v180,7,v0
v_cmp_gt_u32 vcc,64,v0
s_cbranch_vccnz nocpf_3
buffer_load_dword v181,v180,s[8:11],0 offen
s_mov_b32 s12,0x8000
buffer_load_dword v182,v180,s[8:11],s12 offen
s_lshr_b32 s12,s2,3
s_and_b32 s12,s12,7
s_add_u32 s12,s12,2
s_lshl_b32 s12,s12,15
buffer_load_dword v183,v180,s[8:11],s12 offen
nocpf_3:
v_and_b32 v1,63,v0
v_lshrrev_b32 v2,6,v0
s_getreg_b32 s51,hwreg(HW_REG_XCC_ID)
v_readfirstlane_b32 s50,v2
s_and_b32 s51,s51,7
s_waitcnt lgkmcnt(0)
s_mov_b32 s20,s18
s_and_b32 s21,s19,0xffff
s_mov_b32 s22,0x10000000
s_mov_b32 s23,0x20000
s_mov_b32 s44,s16
s_and_b32 s45,s17,0xffff
s_mov_b32 s46,0x100
s_mov_b32 s47,0x20000
s_mov_b32 s90,400000
s_mov_b32 s91,s50
v_mov_b32 v187,158976
s_cmp_lg_u32 s50,0
s_cbranch_scc1 norole_4
s_mov_b64 exec,1
v_mov_b32 v184,1
v_mov_b32 v185,0
s_and_b32 s52,s51,3
s_lshl_b32 s52,s52,2
s_lshr_b32 s53,s51,2
s_lshl_b32 s53,s53,7
s_add_u32 s52,s52,s53
buffer_atomic_add v184,v185,s[44:47],s52 offen sc0 sc1
s_mov_b64 exec,-1
buffer_load_dword v181,v180,s[8:11],0 offen
s_mov_b32 s12,0x8000
buffer_load_dword v182,v180,s[8:11],s12 offen
s_lshr_b32 s12,s2,3
s_and_b32 s12,s12,7
s_add_u32 s12,s12,2
s_lshl_b32 s12,s12,15
buffer_load_dword v183,v180,s[8:11],s12 offen
s_mov_b64 exec,1
s_waitcnt vmcnt(3)
ds_write_b32 v187,v184
s_waitcnt lgkmcnt(0)
s_mov_b64 exec,-1
norole_4:
s_barrier
ds_read_b32 v186,v187
s_waitcnt lgkmcnt(0)
v_readfirstlane_b32 s54,v186
s_mov_b32 s56,2
s_lshl_b32 s57,s51,5
s_add_u32 s57,s57,s54
s_cmp_lt_u32 s54,32
s_cselect_b32 s57,s57,999
s_cmp_ge_u32 s57,256
s_cbranch_scc1 verify_6
s_cmp_ge_u32 s57,128
s_cbranch_scc1 pre_8
setup_5:
s_load_dwordx8 s[4:11],s[0:1],8
s_load_dwordx2 s[12:13],s[0:1],40
v_and_b32 v3,15,v1
v_lshrrev_b32 v4,4,v1
v_lshlrev_b32 v16,4,v1
v_lshrrev_b32 v30,2,v1
v_and_b32 v31,3,v1
v_lshlrev_b32 v7,13,v30
v_lshl_add_u32 v7,v31,4,v7
v_lshlrev_b32 v8,11,v30
v_lshl_add_u32 v8,v31,4,v8
s_lshr_b32 s58,s57,5
s_and_b32 s59,s57,31
s_xor_b32 s60,s57,0
s_lshl_b32 s60,s60,6
s_lshl_b32 s61,s50,14
s_lshl_b32 s62,s50,21
s_add_u32 s62,s62,s60
s_lshl_b32 s63,s58,21
s_lshl_b32 s64,s50,19
s_add_u32 s63,s63,s64
s_xor_b32 s64,s59,0
s_lshl_b32 s64,s64,6
s_add_u32 s63,s63,s64
s_waitcnt lgkmcnt(0)
s_mov_b32 s28,s8
s_and_b32 s29,s9,0xffff
s_mov_b32 s30,0x800000
s_mov_b32 s31,0x20000
s_mov_b32 s32,s10
s_and_b32 s33,s11,0xffff
s_mov_b32 s34,0x800000
s_mov_b32 s35,0x20000
s_mov_b32 s36,s6
s_and_b32 s37,s7,0xffff
s_mov_b32 s38,0x800000
s_mov_b32 s39,0x20000
s_mov_b32 s40,s12
s_and_b32 s41,s13,0xffff
s_mov_b32 s42,0x800000
s_mov_b32 s43,0x20000
s_mov_b32 s8,s4
s_and_b32 s9,s5,0xffff
s_mov_b32 s10,0x4000
s_mov_b32 s11,0x20000
v_lshlrev_b32 v9,7,v3
v_lshl_add_u32 v10,v4,11,v9
v_lshl_add_u32 v9,v4,13,v9
s_lshl_b32 s64,s59,2
s_add_u32 s64,s64,s50
s_lshl_b32 s65,s64,16
s_lshl_b32 s66,s58,11
s_add_u32 s65,s65,s66
s_lshl_b32 s66,s64,14
s_lshl_b32 s67,s58,21
s_add_u32 s66,s66,s67
v_and_b32 v9,7,v1
v_lshrrev_b32 v10,3,v1
s_cmp_eq_u32 s58,3
s_cselect_b32 s64,15,3
v_mov_b32 v11,3
v_cmp_eq_u32 vcc,1,v10
s_nop 1
v_cndmask_b32 v11,v11,11,vcc
v_lshlrev_b32 v12,7,v11
v_lshl_add_u32 v12,v9,11,v12
v_mov_b32 v13,s64
v_cmp_eq_u32 vcc,2,v10
s_nop 1
v_cndmask_b32 v11,v11,v13,vcc
v_lshlrev_b32 v11,7,v11
v_lshl_add_u32 v11,v9,13,v11
v_mov_b32 v100,0
v_mov_b32 v101,0
v_mov_b32 v102,0
v_mov_b32 v103,0
s_mov_b32 s53,s65
s_mov_b32 s55,s66
v_and_b32 v22,7,v3
v_lshlrev_b32 v31,11,v22
v_lshl_add_u32 v31,v4,4,v31
s_lshr_b32 s64,s59,3
s_lshl_b32 s64,s64,14
s_and_b32 s65,s59,7
s_lshl_b32 s65,s65,10
s_add_u32 s64,s64,s65
s_lshl_b32 s65,s58,16
s_add_u32 s64,s64,s65
s_add_u32 s64,s64,31195136
s_lshr_b32 s65,s57,3
s_add_u32 s65,s65,96
s_lshl_b32 s65,s65,14
s_and_b32 s66,s57,7
s_lshl_b32 s66,s66,10
s_add_u32 s65,s65,s66
s_add_u32 s65,s65,29360128
v_add_u32 v206,s64,v16
v_add_u32 v207,s65,v16
s_and_b32 s64,s50,1
s_lshl_b32 s64,s64,21
s_lshr_b32 s65,s50,1
s_lshl_b32 s65,s65,13
s_add_u32 s64,s64,s65
buffer_store_dwordx4 v[100:103],v206,s[20:23],s64 offen sc1
buffer_store_dwordx4 v[100:103],v207,s[20:23],s64 offen sc1
s_lshl_b32 s64,s50,20
s_add_u32 s64,s64,23068672
s_cmp_lt_u32 s50,2
s_cselect_b32 s67,s64,0x7fff0000
s_lshl_b32 s65,s57,10
s_add_u32 s65,s65,131072
s_add_u32 s65,s65,s67
buffer_store_dwordx4 v[100:103],v16,s[20:23],s65 offen sc1
s_lshl_b32 s65,s57,9
s_add_u32 s65,s65,s67
s_add_u32 s66,s65,65536
s_mov_b32 exec_hi,0
buffer_store_dwordx4 v[100:103],v16,s[20:23],s65 offen sc1
buffer_store_dwordx4 v[100:103],v16,s[20:23],s66 offen sc1
s_lshl_b32 s65,s57,2
s_add_u32 s65,s65,s64
s_add_u32 s65,s65,524288
s_lshl_b32 s52,s57,7
s_add_u32 s52,s52,21168128
s_mov_b64 exec,1
buffer_store_dword v100,v100,s[20:23],s65 offen sc1
buffer_store_dword v100,v100,s[20:23],s65 offen offset:512 sc1
s_mov_b64 exec,15
buffer_store_dwordx4 v[100:103],v16,s[20:23],s52 offen sc1
s_mov_b64 exec,-1
s_mov_b32 s65,s53
s_mov_b32 s66,s55
v_mov_b32 v37,159008
ds_write_b128 v37,v[100:103]
s_add_u32 s64,s62,0
s_add_u32 m0,s61,0
s_nop 0
buffer_load_dwordx4 v7,s[28:31],s64 offen nt lds
s_add_u32 s64,s62,131072
s_add_u32 m0,s61,1024
s_nop 0
buffer_load_dwordx4 v7,s[28:31],s64 offen nt lds
s_add_u32 s64,s62,262144
s_add_u32 m0,s61,2048
s_nop 0
buffer_load_dwordx4 v7,s[28:31],s64 offen nt lds
s_add_u32 s64,s62,393216
s_add_u32 m0,s61,3072
s_nop 0
buffer_load_dwordx4 v7,s[28:31],s64 offen nt lds
s_add_u32 s64,s62,524288
s_add_u32 m0,s61,4096
s_nop 0
buffer_load_dwordx4 v7,s[28:31],s64 offen nt lds
s_add_u32 s64,s62,655360
s_add_u32 m0,s61,5120
s_nop 0
buffer_load_dwordx4 v7,s[28:31],s64 offen nt lds
s_add_u32 s64,s62,786432
s_add_u32 m0,s61,6144
s_nop 0
buffer_load_dwordx4 v7,s[28:31],s64 offen nt lds
s_add_u32 s64,s62,917504
s_add_u32 m0,s61,7168
s_nop 0
buffer_load_dwordx4 v7,s[28:31],s64 offen nt lds
s_waitcnt vmcnt(8) lgkmcnt(0)
s_barrier
s_cmp_lg_u32 s50,1
s_cbranch_scc1 ws_11
s_and_b32 s64,s56,1
s_lshl_b32 s64,s64,2
s_add_u32 s64,s64,36
s_mov_b64 exec,1
v_mov_b32 v184,1
v_mov_b32 v185,0
buffer_atomic_add v184,v185,s[44:47],s64 offen sc1
s_mov_b64 exec,-1
ws_11:
s_add_u32 s64,s62,1048576
s_add_u32 m0,s61,8192
s_nop 0
buffer_load_dwordx4 v7,s[28:31],s64 offen nt lds
s_add_u32 s64,s62,1179648
s_add_u32 m0,s61,9216
s_nop 0
buffer_load_dwordx4 v7,s[28:31],s64 offen nt lds
s_add_u32 s64,s62,1310720
s_add_u32 m0,s61,10240
s_nop 0
buffer_load_dwordx4 v7,s[28:31],s64 offen nt lds
s_add_u32 s64,s62,1441792
s_add_u32 m0,s61,11264
s_nop 0
buffer_load_dwordx4 v7,s[28:31],s64 offen nt lds
s_add_u32 s64,s62,1572864
s_add_u32 m0,s61,12288
s_nop 0
buffer_load_dwordx4 v7,s[28:31],s64 offen nt lds
s_add_u32 s64,s62,1703936
s_add_u32 m0,s61,13312
s_nop 0
buffer_load_dwordx4 v7,s[28:31],s64 offen nt lds
s_add_u32 s64,s62,1835008
s_add_u32 m0,s61,14336
s_nop 0
buffer_load_dwordx4 v7,s[28:31],s64 offen nt lds
s_add_u32 s64,s62,1966080
s_add_u32 m0,s61,15360
s_nop 0
buffer_load_dwordx4 v7,s[28:31],s64 offen nt lds
s_mov_b64 exec,0xffffff
buffer_load_dword v201,v11,s[32:35],s65 offen
buffer_load_dword v202,v11,s[36:39],s65 offen
s_mov_b64 exec,0xffff
buffer_load_dword v203,v12,s[40:43],s66 offen
s_mov_b64 exec,-1
s_add_u32 s64,s62,0
s_add_u32 m0,s61,65536
s_nop 0
buffer_load_dwordx4 v7,s[32:35],s64 offen nt lds
s_add_u32 s64,s62,131072
s_add_u32 m0,s61,66560
s_nop 0
buffer_load_dwordx4 v7,s[32:35],s64 offen nt lds
s_add_u32 s64,s62,262144
s_add_u32 m0,s61,67584
s_nop 0
buffer_load_dwordx4 v7,s[32:35],s64 offen nt lds
s_add_u32 s64,s62,393216
s_add_u32 m0,s61,68608
s_nop 0
buffer_load_dwordx4 v7,s[32:35],s64 offen nt lds
s_add_u32 s64,s62,524288
s_add_u32 m0,s61,69632
s_nop 0
buffer_load_dwordx4 v7,s[32:35],s64 offen nt lds
s_add_u32 s64,s62,655360
s_add_u32 m0,s61,70656
s_nop 0
buffer_load_dwordx4 v7,s[32:35],s64 offen nt lds
s_add_u32 s64,s62,786432
s_add_u32 m0,s61,71680
s_nop 0
buffer_load_dwordx4 v7,s[32:35],s64 offen nt lds
s_add_u32 s64,s62,917504
s_add_u32 m0,s61,72704
s_nop 0
buffer_load_dwordx4 v7,s[32:35],s64 offen nt lds
s_add_u32 s64,s62,1048576
s_add_u32 m0,s61,73728
s_nop 0
buffer_load_dwordx4 v7,s[32:35],s64 offen nt lds
s_add_u32 s64,s62,1179648
s_add_u32 m0,s61,74752
s_nop 0
buffer_load_dwordx4 v7,s[32:35],s64 offen nt lds
s_add_u32 s64,s62,1310720
s_add_u32 m0,s61,75776
s_nop 0
buffer_load_dwordx4 v7,s[32:35],s64 offen nt lds
s_add_u32 s64,s62,1441792
s_add_u32 m0,s61,76800
s_nop 0
buffer_load_dwordx4 v7,s[32:35],s64 offen nt lds
s_add_u32 s64,s62,1572864
s_add_u32 m0,s61,77824
s_nop 0
buffer_load_dwordx4 v7,s[32:35],s64 offen nt lds
s_add_u32 s64,s62,1703936
s_add_u32 m0,s61,78848
s_nop 0
buffer_load_dwordx4 v7,s[32:35],s64 offen nt lds
s_add_u32 s64,s62,1835008
s_add_u32 m0,s61,79872
s_nop 0
buffer_load_dwordx4 v7,s[32:35],s64 offen nt lds
s_add_u32 s64,s62,1966080
s_add_u32 m0,s61,80896
s_nop 0
buffer_load_dwordx4 v7,s[32:35],s64 offen nt lds
s_lshl_b32 s64,s59,6
buffer_load_dwordx4 v[216:219],v31,s[8:11],s64 offen
v_lshrrev_b32 v184,3,v3
v_bfe_u32 v185,v3,2,1
v_lshrrev_b32 v186,1,v4
v_and_b32 v187,1,v4
v_lshl_add_u32 v188,v184,3,v185
v_lshl_add_u32 v188,v186,4,v188
v_lshl_add_u32 v188,v187,2,v188
v_lshl_add_u32 v189,v184,2,v185
v_lshl_add_u32 v189,v186,3,v189
v_lshl_add_u32 v189,v187,4,v189
v_and_b32 v187,3,v3
v_lshlrev_b32 v187,3,v187
v_lshl_add_u32 v188,v188,6,v187
v_lshl_add_u32 v189,v189,6,v187
s_lshr_b32 s64,s50,1
s_lshl_b32 s64,s64,5
v_add_u32 v190,s64,v188
v_add_u32 v191,0x10000,v190
s_lshl_b32 s64,s64,10
v_add_u32 v192,s64,v189
s_add_u32 s64,s61,0x10000
v_add_u32 v193,s64,v16
s_add_u32 s68,s50,1
s_mov_b32 s69,0
s_waitcnt vmcnt(20)
s_barrier
s_lshl_b32 s64,s57,9
v_mov_b32 v194,s64
s_add_u32 s65,s64,65024
v_mov_b32 v195,s65
v_cmp_lt_u32 vcc,3,v1
s_nop 1
v_cndmask_b32 v194,v194,v195,vcc
s_lshl_b32 s65,s57,10
s_add_u32 s65,s65,130048
v_mov_b32 v195,s65
v_cmp_lt_u32 vcc,7,v1
s_nop 1
v_cndmask_b32 v194,v194,v195,vcc
s_lshl_b32 s65,s57,11
s_add_u32 s65,s65,260096
v_mov_b32 v195,s65
v_cmp_lt_u32 vcc,15,v1
s_nop 1
v_cndmask_b32 v194,v194,v195,vcc
v_lshl_add_u32 v194,v1,7,v194
s_lshl_b32 s65,s58,7
s_add_u32 s65,s65,524288
v_writelane_b32 v194,s65,32
s_add_u32 s65,s65,512
v_writelane_b32 v194,s65,33
s_lshl_b32 s64,s50,20
s_add_u32 s64,s64,23068672
s_mov_b32 exec_hi,3
buffer_load_dword v183,v194,s[20:23],s64 offen sc1
s_mov_b64 exec,-1
s_and_b32 s65,s50,1
s_lshl_b32 s14,s65,19
s_add_u32 s14,s14,s60
s_lshl_b32 s15,s65,19
s_sub_u32 s15,s63,s15
s_lshl_b32 s65,s65,13
s_add_u32 s65,s65,131072
v_mov_b32 v32,v8
v_add_u32 v33,s65,v16
v_add_u32 v34,s65,v189
v_mov_b32 v35,v7
v_add_u32 v36,131072,v190
v_mov_b32 v37,159008
s_bitcmp1_b32 s68,1
s_cbranch_scc0 ws_12
ds_read_b64_tr_b16 a[0:1],v190 offset:0
ds_read_b64_tr_b16 a[2:3],v190 offset:128
ds_read_b64_tr_b16 a[4:5],v190 offset:2048
ds_read_b64_tr_b16 a[6:7],v190 offset:2176
ds_read_b64_tr_b16 a[8:9],v190 offset:4096
ds_read_b64_tr_b16 a[10:11],v190 offset:4224
ds_read_b64_tr_b16 a[12:13],v190 offset:6144
ds_read_b64_tr_b16 a[14:15],v190 offset:6272
s_waitcnt lgkmcnt(0)
ds_read_b64_tr_b16 a[16:17],v190 offset:8192
ds_read_b64_tr_b16 a[18:19],v190 offset:8320
ds_read_b64_tr_b16 a[20:21],v190 offset:10240
ds_read_b64_tr_b16 a[22:23],v190 offset:10368
ds_read_b64_tr_b16 a[24:25],v190 offset:12288
ds_read_b64_tr_b16 a[26:27],v190 offset:12416
ds_read_b64_tr_b16 a[28:29],v190 offset:14336
ds_read_b64_tr_b16 a[30:31],v190 offset:14464
s_waitcnt lgkmcnt(0)
ds_read_b64_tr_b16 a[32:33],v190 offset:16384
ds_read_b64_tr_b16 a[34:35],v190 offset:16512
ds_read_b64_tr_b16 a[36:37],v190 offset:18432
ds_read_b64_tr_b16 a[38:39],v190 offset:18560
ds_read_b64_tr_b16 a[40:41],v190 offset:20480
ds_read_b64_tr_b16 a[42:43],v190 offset:20608
ds_read_b64_tr_b16 a[44:45],v190 offset:22528
ds_read_b64_tr_b16 a[46:47],v190 offset:22656
s_waitcnt lgkmcnt(0)
ds_read_b64_tr_b16 a[48:49],v190 offset:24576
ds_read_b64_tr_b16 a[50:51],v190 offset:24704
ds_read_b64_tr_b16 a[52:53],v190 offset:26624
ds_read_b64_tr_b16 a[54:55],v190 offset:26752
ds_read_b64_tr_b16 a[56:57],v190 offset:28672
ds_read_b64_tr_b16 a[58:59],v190 offset:28800
ds_read_b64_tr_b16 a[60:61],v190 offset:30720
ds_read_b64_tr_b16 a[62:63],v190 offset:30848
s_waitcnt lgkmcnt(0)
ds_read_b64_tr_b16 a[64:65],v190 offset:32768
ds_read_b64_tr_b16 a[66:67],v190 offset:32896
ds_read_b64_tr_b16 a[68:69],v190 offset:34816
ds_read_b64_tr_b16 a[70:71],v190 offset:34944
ds_read_b64_tr_b16 a[72:73],v190 offset:36864
ds_read_b64_tr_b16 a[74:75],v190 offset:36992
ds_read_b64_tr_b16 a[76:77],v190 offset:38912
ds_read_b64_tr_b16 a[78:79],v190 offset:39040
s_waitcnt lgkmcnt(0)
ds_read_b64_tr_b16 a[80:81],v190 offset:40960
ds_read_b64_tr_b16 a[82:83],v190 offset:41088
ds_read_b64_tr_b16 a[84:85],v190 offset:43008
ds_read_b64_tr_b16 a[86:87],v190 offset:43136
ds_read_b64_tr_b16 a[88:89],v190 offset:45056
ds_read_b64_tr_b16 a[90:91],v190 offset:45184
ds_read_b64_tr_b16 a[92:93],v190 offset:47104
ds_read_b64_tr_b16 a[94:95],v190 offset:47232
s_waitcnt lgkmcnt(0)
ds_read_b64_tr_b16 a[96:97],v190 offset:49152
ds_read_b64_tr_b16 a[98:99],v190 offset:49280
ds_read_b64_tr_b16 a[100:101],v190 offset:51200
ds_read_b64_tr_b16 a[102:103],v190 offset:51328
ds_read_b64_tr_b16 a[104:105],v190 offset:53248
ds_read_b64_tr_b16 a[106:107],v190 offset:53376
ds_read_b64_tr_b16 a[108:109],v190 offset:55296
ds_read_b64_tr_b16 a[110:111],v190 offset:55424
s_waitcnt lgkmcnt(0)
ds_read_b64_tr_b16 a[112:113],v190 offset:57344
ds_read_b64_tr_b16 a[114:115],v190 offset:57472
ds_read_b64_tr_b16 a[116:117],v190 offset:59392
ds_read_b64_tr_b16 a[118:119],v190 offset:59520
ds_read_b64_tr_b16 a[120:121],v190 offset:61440
ds_read_b64_tr_b16 a[122:123],v190 offset:61568
ds_read_b64_tr_b16 a[124:125],v190 offset:63488
ds_read_b64_tr_b16 a[126:127],v190 offset:63616
s_waitcnt lgkmcnt(0)
s_waitcnt vmcnt(0)
s_barrier
ds_read_b64_tr_b16 a[128:129],v191 offset:0
ds_read_b64_tr_b16 a[130:131],v191 offset:128
ds_read_b64_tr_b16 a[132:133],v191 offset:2048
ds_read_b64_tr_b16 a[134:135],v191 offset:2176
ds_read_b64_tr_b16 a[136:137],v191 offset:4096
ds_read_b64_tr_b16 a[138:139],v191 offset:4224
ds_read_b64_tr_b16 a[140:141],v191 offset:6144
ds_read_b64_tr_b16 a[142:143],v191 offset:6272
s_waitcnt lgkmcnt(0)
ds_read_b64_tr_b16 a[144:145],v191 offset:8192
ds_read_b64_tr_b16 a[146:147],v191 offset:8320
ds_read_b64_tr_b16 a[148:149],v191 offset:10240
ds_read_b64_tr_b16 a[150:151],v191 offset:10368
ds_read_b64_tr_b16 a[152:153],v191 offset:12288
ds_read_b64_tr_b16 a[154:155],v191 offset:12416
ds_read_b64_tr_b16 a[156:157],v191 offset:14336
ds_read_b64_tr_b16 a[158:159],v191 offset:14464
s_waitcnt lgkmcnt(0)
ds_read_b64_tr_b16 a[160:161],v191 offset:16384
ds_read_b64_tr_b16 a[162:163],v191 offset:16512
ds_read_b64_tr_b16 a[164:165],v191 offset:18432
ds_read_b64_tr_b16 a[166:167],v191 offset:18560
ds_read_b64_tr_b16 a[168:169],v191 offset:20480
ds_read_b64_tr_b16 a[170:171],v191 offset:20608
ds_read_b64_tr_b16 a[172:173],v191 offset:22528
ds_read_b64_tr_b16 a[174:175],v191 offset:22656
s_waitcnt lgkmcnt(0)
ds_read_b64_tr_b16 a[176:177],v191 offset:24576
ds_read_b64_tr_b16 a[178:179],v191 offset:24704
ds_read_b64_tr_b16 a[180:181],v191 offset:26624
ds_read_b64_tr_b16 a[182:183],v191 offset:26752
ds_read_b64_tr_b16 a[184:185],v191 offset:28672
ds_read_b64_tr_b16 a[186:187],v191 offset:28800
ds_read_b64_tr_b16 a[188:189],v191 offset:30720
ds_read_b64_tr_b16 a[190:191],v191 offset:30848
s_waitcnt lgkmcnt(0)
ds_read_b64_tr_b16 a[192:193],v191 offset:32768
ds_read_b64_tr_b16 a[194:195],v191 offset:32896
ds_read_b64_tr_b16 a[196:197],v191 offset:34816
ds_read_b64_tr_b16 a[198:199],v191 offset:34944
ds_read_b64_tr_b16 a[200:201],v191 offset:36864
ds_read_b64_tr_b16 a[202:203],v191 offset:36992
ds_read_b64_tr_b16 a[204:205],v191 offset:38912
ds_read_b64_tr_b16 a[206:207],v191 offset:39040
s_waitcnt lgkmcnt(0)
ds_read_b64_tr_b16 a[208:209],v191 offset:40960
ds_read_b64_tr_b16 a[210:211],v191 offset:41088
ds_read_b64_tr_b16 a[212:213],v191 offset:43008
ds_read_b64_tr_b16 a[214:215],v191 offset:43136
ds_read_b64_tr_b16 a[216:217],v191 offset:45056
ds_read_b64_tr_b16 a[218:219],v191 offset:45184
ds_read_b64_tr_b16 a[220:221],v191 offset:47104
ds_read_b64_tr_b16 a[222:223],v191 offset:47232
s_waitcnt lgkmcnt(0)
ds_read_b64_tr_b16 a[224:225],v191 offset:49152
ds_read_b64_tr_b16 a[226:227],v191 offset:49280
ds_read_b64_tr_b16 a[228:229],v191 offset:51200
ds_read_b64_tr_b16 a[230:231],v191 offset:51328
ds_read_b64_tr_b16 a[232:233],v191 offset:53248
ds_read_b64_tr_b16 a[234:235],v191 offset:53376
ds_read_b64_tr_b16 a[236:237],v191 offset:55296
ds_read_b64_tr_b16 a[238:239],v191 offset:55424
s_waitcnt lgkmcnt(0)
ds_read_b64_tr_b16 a[240:241],v191 offset:57344
ds_read_b64_tr_b16 a[242:243],v191 offset:57472
ds_read_b64_tr_b16 a[244:245],v191 offset:59392
ds_read_b64_tr_b16 a[246:247],v191 offset:59520
ds_read_b64_tr_b16 a[248:249],v191 offset:61440
ds_read_b64_tr_b16 a[250:251],v191 offset:61568
ds_read_b64_tr_b16 a[252:253],v191 offset:63488
ds_read_b64_tr_b16 a[254:255],v191 offset:63616
s_waitcnt lgkmcnt(0)
s_branch ws_14
ws_12:
s_add_u32 s64,s14,0
buffer_load_dwordx4 a[0:3],v35,s[36:39],s64 offen nt
s_add_u32 s64,s14,131072
buffer_load_dwordx4 a[4:7],v35,s[36:39],s64 offen nt
s_add_u32 s64,s14,262144
buffer_load_dwordx4 a[8:11],v35,s[36:39],s64 offen nt
s_add_u32 s64,s14,393216
buffer_load_dwordx4 a[12:15],v35,s[36:39],s64 offen nt
s_add_u32 s64,s14,1048576
buffer_load_dwordx4 a[16:19],v35,s[36:39],s64 offen nt
s_add_u32 s64,s14,1179648
buffer_load_dwordx4 a[20:23],v35,s[36:39],s64 offen nt
s_add_u32 s64,s14,1310720
buffer_load_dwordx4 a[24:27],v35,s[36:39],s64 offen nt
s_add_u32 s64,s14,1441792
buffer_load_dwordx4 a[28:31],v35,s[36:39],s64 offen nt
s_add_u32 s64,s14,2097152
buffer_load_dwordx4 a[32:35],v35,s[36:39],s64 offen nt
s_add_u32 s64,s14,2228224
buffer_load_dwordx4 a[36:39],v35,s[36:39],s64 offen nt
s_add_u32 s64,s14,2359296
buffer_load_dwordx4 a[40:43],v35,s[36:39],s64 offen nt
s_add_u32 s64,s14,2490368
buffer_load_dwordx4 a[44:47],v35,s[36:39],s64 offen nt
s_add_u32 s64,s14,3145728
buffer_load_dwordx4 a[48:51],v35,s[36:39],s64 offen nt
s_add_u32 s64,s14,3276800
buffer_load_dwordx4 a[52:55],v35,s[36:39],s64 offen nt
s_add_u32 s64,s14,3407872
buffer_load_dwordx4 a[56:59],v35,s[36:39],s64 offen nt
s_add_u32 s64,s14,3538944
buffer_load_dwordx4 a[60:63],v35,s[36:39],s64 offen nt
s_add_u32 s64,s14,4194304
buffer_load_dwordx4 a[64:67],v35,s[36:39],s64 offen nt
s_add_u32 s64,s14,4325376
buffer_load_dwordx4 a[68:71],v35,s[36:39],s64 offen nt
s_add_u32 s64,s14,4456448
buffer_load_dwordx4 a[72:75],v35,s[36:39],s64 offen nt
s_add_u32 s64,s14,4587520
buffer_load_dwordx4 a[76:79],v35,s[36:39],s64 offen nt
s_add_u32 s64,s14,5242880
buffer_load_dwordx4 a[80:83],v35,s[36:39],s64 offen nt
s_add_u32 s64,s14,5373952
buffer_load_dwordx4 a[84:87],v35,s[36:39],s64 offen nt
s_add_u32 s64,s14,5505024
buffer_load_dwordx4 a[88:91],v35,s[36:39],s64 offen nt
s_add_u32 s64,s14,5636096
buffer_load_dwordx4 a[92:95],v35,s[36:39],s64 offen nt
s_add_u32 s64,s14,6291456
buffer_load_dwordx4 a[96:99],v35,s[36:39],s64 offen nt
s_add_u32 s64,s14,6422528
buffer_load_dwordx4 a[100:103],v35,s[36:39],s64 offen nt
s_add_u32 s64,s14,6553600
buffer_load_dwordx4 a[104:107],v35,s[36:39],s64 offen nt
s_add_u32 s64,s14,6684672
buffer_load_dwordx4 a[108:111],v35,s[36:39],s64 offen nt
s_add_u32 s64,s14,7340032
buffer_load_dwordx4 a[112:115],v35,s[36:39],s64 offen nt
s_add_u32 s64,s14,7471104
buffer_load_dwordx4 a[116:119],v35,s[36:39],s64 offen nt
s_add_u32 s64,s14,7602176
buffer_load_dwordx4 a[120:123],v35,s[36:39],s64 offen nt
s_add_u32 s64,s14,7733248
buffer_load_dwordx4 a[124:127],v35,s[36:39],s64 offen nt
s_add_u32 s64,s15,0
buffer_load_dwordx4 a[128:131],v32,s[40:43],s64 offen nt
s_add_u32 s64,s15,32768
buffer_load_dwordx4 a[132:135],v32,s[40:43],s64 offen nt
s_add_u32 s64,s15,65536
buffer_load_dwordx4 a[136:139],v32,s[40:43],s64 offen nt
s_add_u32 s64,s15,98304
buffer_load_dwordx4 a[140:143],v32,s[40:43],s64 offen nt
s_add_u32 s64,s15,131072
buffer_load_dwordx4 a[144:147],v32,s[40:43],s64 offen nt
s_add_u32 s64,s15,163840
buffer_load_dwordx4 a[148:151],v32,s[40:43],s64 offen nt
s_add_u32 s64,s15,196608
buffer_load_dwordx4 a[152:155],v32,s[40:43],s64 offen nt
s_add_u32 s64,s15,229376
buffer_load_dwordx4 a[156:159],v32,s[40:43],s64 offen nt
s_add_u32 s64,s15,262144
buffer_load_dwordx4 a[160:163],v32,s[40:43],s64 offen nt
s_add_u32 s64,s15,294912
buffer_load_dwordx4 a[164:167],v32,s[40:43],s64 offen nt
s_add_u32 s64,s15,327680
buffer_load_dwordx4 a[168:171],v32,s[40:43],s64 offen nt
s_add_u32 s64,s15,360448
buffer_load_dwordx4 a[172:175],v32,s[40:43],s64 offen nt
s_waitcnt vmcnt(44)
s_barrier
ws_14:
v_mov_b32 v187,158976
s_cmp_lg_u32 s50,1
s_cbranch_scc1 sh0_17
s_mov_b32 s53,0
stl_18:
s_add_u32 s64,s52,32
s_buffer_load_dwordx8 s[72:79],s[20:23],s52 glc
s_buffer_load_dwordx8 s[80:87],s[20:23],s64 glc
s_waitcnt lgkmcnt(0)
s_min_u32 s72,s72,s80
s_min_u32 s73,s73,s81
s_min_u32 s74,s74,s82
s_min_u32 s75,s75,s83
s_min_u32 s76,s76,s84
s_min_u32 s77,s77,s85
s_min_u32 s78,s78,s86
s_min_u32 s79,s79,s87
s_min_u32 s72,s72,s76
s_min_u32 s73,s73,s77
s_min_u32 s74,s74,s78
s_min_u32 s75,s75,s79
s_min_u32 s72,s72,s74
s_min_u32 s73,s73,s75
s_min_u32 s64,s72,s73
s_mov_b32 s65,0
s_and_b32 s61,s64,1
s_lshl_b32 s61,s61,13
s_cmp_lg_u32 s64,0
s_cbranch_scc1 stok_19
s_sub_u32 s90,s90,1
s_cmp_lt_i32 s90,0
s_cbranch_scc1 stok_19
s_add_u32 s53,s53,1
s_and_b32 s64,s53,31
s_cbranch_scc1 stl_18
s_cmp_eq_u32 s56,1
s_cbranch_scc1 stl_18
v_and_b32 v184,3,v1
v_bfe_u32 v185,v1,2,1
v_lshlrev_b32 v184,2,v184
v_lshl_add_u32 v184,v185,7,v184
v_writelane_b32 v184,32,8
s_mov_b64 exec,0x1ff
vpoll_20:
buffer_load_dword v185,v184,s[44:47],0 offen sc1
s_waitcnt vmcnt(0)
vfirst_23:
v_readlane_b32 s92,v185,0
v_readlane_b32 s93,v185,1
v_readlane_b32 s94,v185,2
v_readlane_b32 s95,v185,3
v_readlane_b32 s96,v185,4
v_readlane_b32 s97,v185,5
v_readlane_b32 s98,v185,6
v_readlane_b32 s99,v185,7
v_readlane_b32 s61,v185,8
s_add_u32 s64,s92,s93
s_add_u32 s64,s64,s94
s_add_u32 s64,s64,s95
s_add_u32 s64,s64,s96
s_add_u32 s64,s64,s97
s_add_u32 s64,s64,s98
s_add_u32 s64,s64,s99
s_min_u32 s65,s92,s93
s_min_u32 s66,s94,s95
s_min_u32 s65,s65,s66
s_min_u32 s66,s96,s97
s_min_u32 s65,s65,s66
s_min_u32 s66,s98,s99
s_min_u32 s65,s65,s66
s_cmp_lt_u32 s65,32
s_cselect_b32 s65,1,0
s_cmp_lt_u32 s64,256
s_cbranch_scc1 vslp_22
s_branch vgot_21
vslp_22:
s_sleep 8
s_sub_u32 s90,s90,1
s_cmp_gt_i32 s90,0
s_cbranch_scc1 vpoll_20
vgot_21:
s_mov_b64 exec,-1
s_and_b32 s61,s61,1
s_lshl_b32 s61,s61,13
s_mov_b32 s66,s54
s_cmp_gt_u32 s51,0
s_cselect_b32 s64,s92,0
s_add_u32 s66,s66,s64
s_cmp_gt_u32 s51,1
s_cselect_b32 s64,s93,0
s_add_u32 s66,s66,s64
s_cmp_gt_u32 s51,2
s_cselect_b32 s64,s94,0
s_add_u32 s66,s66,s64
s_cmp_gt_u32 s51,3
s_cselect_b32 s64,s95,0
s_add_u32 s66,s66,s64
s_cmp_gt_u32 s51,4
s_cselect_b32 s64,s96,0
s_add_u32 s66,s66,s64
s_cmp_gt_u32 s51,5
s_cselect_b32 s64,s97,0
s_add_u32 s66,s66,s64
s_cmp_gt_u32 s51,6
s_cselect_b32 s64,s98,0
s_add_u32 s66,s66,s64
s_cmp_eq_u32 s65,0
s_cbranch_scc1 stl_18
stok_19:
v_mov_b32 v184,s65
v_mov_b32 v185,s66
v_mov_b32 v186,s61
ds_write_b96 v187,v[184:186] offset:16
s_waitcnt lgkmcnt(0)
sh0_17:
s_barrier
ds_read_b96 v[184:186],v187 offset:16
s_waitcnt lgkmcnt(0)
v_readfirstlane_b32 s65,v184
v_readfirstlane_b32 s66,v185
v_readfirstlane_b32 s61,v186
s_cmp_lg_u32 s65,0
s_cbranch_scc1 slowrole_10
s_and_b32 s56,s56,1
s_branch loops_7
pre_8:
s_sub_u32 s55,s57,128
s_load_dwordx4 s[4:7],s[0:1],96
s_load_dwordx2 s[8:9],s[0:1],0
v_and_b32 v1,63,v0
v_lshrrev_b32 v2,6,v0
v_and_b32 v3,7,v0
v_lshrrev_b32 v4,3,v0
v_mul_u32_u24 v5,12288,v4
v_lshl_add_u32 v5,v3,4,v5
v_lshlrev_b32 v6,1,v4
s_and_b32 s24,s55,31
s_lshr_b32 s25,s55,5
s_lshl_b32 s26,s24,7
s_mul_i32 s27,s25,3145728
s_add_u32 s26,s26,s27
s_lshl_b32 s27,s25,9
s_waitcnt lgkmcnt(0)
s_mov_b32 s12,s4
s_and_b32 s13,s5,0xffff
s_mov_b32 s14,0x800
s_mov_b32 s15,0x20000
s_mov_b32 s28,s6
s_and_b32 s29,s7,0xffff
s_mov_b32 s30,0xc00000
s_mov_b32 s31,0x20000
s_mov_b32 s32,s8
s_and_b32 s33,s9,0xffff
s_mov_b32 s34,0x400000
s_mov_b32 s35,0x20000
buffer_load_dwordx4 v[64:67],v5,s[28:31],s26 offen nt
s_add_u32 s26,s26,393216
buffer_load_dwordx4 v[68:71],v5,s[28:31],s26 offen nt
s_add_u32 s26,s26,393216
buffer_load_dwordx4 v[72:75],v5,s[28:31],s26 offen nt
s_add_u32 s26,s26,393216
buffer_load_dwordx4 v[76:79],v5,s[28:31],s26 offen nt
s_add_u32 s26,s26,393216
buffer_load_dwordx4 v[80:83],v5,s[28:31],s26 offen nt
s_add_u32 s26,s26,393216
buffer_load_dwordx4 v[84:87],v5,s[28:31],s26 offen nt
s_add_u32 s26,s26,393216
buffer_load_dwordx4 v[88:91],v5,s[28:31],s26 offen nt
s_add_u32 s26,s26,393216
buffer_load_dwordx4 v[92:95],v5,s[28:31],s26 offen nt
buffer_load_ushort v96,v6,s[12:15],s27 offen offset:0
buffer_load_ushort v97,v6,s[12:15],s27 offen offset:64
buffer_load_ushort v98,v6,s[12:15],s27 offen offset:128
buffer_load_ushort v99,v6,s[12:15],s27 offen offset:192
buffer_load_ushort v100,v6,s[12:15],s27 offen offset:256
buffer_load_ushort v101,v6,s[12:15],s27 offen offset:320
buffer_load_ushort v102,v6,s[12:15],s27 offen offset:384
buffer_load_ushort v103,v6,s[12:15],s27 offen offset:448
v_and_b32 v3,3,v1
v_lshrrev_b32 v4,2,v1
v_lshl_add_u32 v5,v2,2,v3
v_lshlrev_b32 v5,11,v5
v_lshl_add_u32 v5,v4,5,v5
s_lshl_b32 s36,s55,15
s_cmp_lt_u32 s55,16
s_cselect_b32 s42,s36,0x7fff0000
s_cselect_b32 s36,0x7fff0000,s36
buffer_load_dwordx4 v[8:11],v5,s[32:35],s42 offen offset:0
buffer_load_dwordx4 v[12:15],v5,s[32:35],s42 offen offset:16
buffer_load_dwordx4 v[16:19],v5,s[32:35],s42 offen offset:512
buffer_load_dwordx4 v[20:23],v5,s[32:35],s42 offen offset:528
buffer_load_dwordx4 v[24:27],v5,s[32:35],s42 offen offset:1024
buffer_load_dwordx4 v[28:31],v5,s[32:35],s42 offen offset:1040
buffer_load_dwordx4 v[32:35],v5,s[32:35],s42 offen offset:1536
buffer_load_dwordx4 v[36:39],v5,s[32:35],s42 offen offset:1552
v_lshrrev_b32 v6,1,v4
v_lshlrev_b32 v6,11,v6
v_and_b32 v7,1,v4
v_lshl_add_u32 v6,v7,9,v6
v_and_b32 v7,1,v2
v_lshl_add_u32 v6,v7,10,v6
v_lshrrev_b32 v7,1,v2
v_lshl_add_u32 v7,v7,2,v3
v_lshl_add_u32 v6,v7,4,v6
v_lshlrev_b32 v4,6,v4
s_lshr_b32 s37,s55,1
s_lshl_b32 s37,s37,16
s_and_b32 s38,s55,1
s_lshl_b32 s38,s38,7
s_add_u32 s37,s37,s38
s_add_u32 s37,s37,57344
s_mov_b32 s38,0xbfb8aa3b
s_mov_b32 s39,0xffff0000
s_cmp_lg_u32 s50,1
s_cbranch_scc1 nz_24
s_lshl_b32 s40,s55,9
s_add_u32 s40,s40,21037056
v_lshl_add_u32 v104,v1,4,s40
s_lshl_b32 s41,s55,7
s_add_u32 s41,s41,21102592
v_writelane_b32 v104,s41,32
v_mov_b32 v108,0
v_mov_b32 v109,0
v_mov_b32 v110,0
v_mov_b32 v111,0
s_mov_b32 exec_hi,1
buffer_store_dwordx4 v[108:111],v104,s[20:23],0 offen sc1
s_mov_b64 exec,-1
nz_24:
v_mov_b32 v112,0
v_mov_b32 v113,0
v_mov_b32 v114,0
v_mov_b32 v115,0
v_mov_b32 v116,0
v_mov_b32 v117,0
v_mov_b32 v118,0
v_mov_b32 v119,0
s_waitcnt vmcnt(8)
v_lshlrev_b32 v96,16,v96
v_mul_f32 v104,s38,v96
v_exp_f32 v104,v104
s_nop 0
v_add_f32 v104,1.0,v104
v_rcp_f32 v104,v104
s_nop 0
v_mul_f32 v104,v104,v96
v_cvt_pk_bf16_f32 v104,v104,v104
v_and_b32 v96,s39,v104
v_lshlrev_b32 v105,16,v64
v_and_b32 v106,s39,v64
v_fmac_f32 v112,v105,v96
v_fmac_f32 v113,v106,v96
v_lshlrev_b32 v105,16,v65
v_and_b32 v106,s39,v65
v_fmac_f32 v114,v105,v96
v_fmac_f32 v115,v106,v96
v_lshlrev_b32 v105,16,v66
v_and_b32 v106,s39,v66
v_fmac_f32 v116,v105,v96
v_fmac_f32 v117,v106,v96
v_lshlrev_b32 v105,16,v67
v_and_b32 v106,s39,v67
v_fmac_f32 v118,v105,v96
v_fmac_f32 v119,v106,v96
v_lshlrev_b32 v97,16,v97
v_mul_f32 v104,s38,v97
v_exp_f32 v104,v104
s_nop 0
v_add_f32 v104,1.0,v104
v_rcp_f32 v104,v104
s_nop 0
v_mul_f32 v104,v104,v97
v_cvt_pk_bf16_f32 v104,v104,v104
v_and_b32 v97,s39,v104
v_lshlrev_b32 v105,16,v68
v_and_b32 v106,s39,v68
v_fmac_f32 v112,v105,v97
v_fmac_f32 v113,v106,v97
v_lshlrev_b32 v105,16,v69
v_and_b32 v106,s39,v69
v_fmac_f32 v114,v105,v97
v_fmac_f32 v115,v106,v97
v_lshlrev_b32 v105,16,v70
v_and_b32 v106,s39,v70
v_fmac_f32 v116,v105,v97
v_fmac_f32 v117,v106,v97
v_lshlrev_b32 v105,16,v71
v_and_b32 v106,s39,v71
v_fmac_f32 v118,v105,v97
v_fmac_f32 v119,v106,v97
v_lshlrev_b32 v98,16,v98
v_mul_f32 v104,s38,v98
v_exp_f32 v104,v104
s_nop 0
v_add_f32 v104,1.0,v104
v_rcp_f32 v104,v104
s_nop 0
v_mul_f32 v104,v104,v98
v_cvt_pk_bf16_f32 v104,v104,v104
v_and_b32 v98,s39,v104
v_lshlrev_b32 v105,16,v72
v_and_b32 v106,s39,v72
v_fmac_f32 v112,v105,v98
v_fmac_f32 v113,v106,v98
v_lshlrev_b32 v105,16,v73
v_and_b32 v106,s39,v73
v_fmac_f32 v114,v105,v98
v_fmac_f32 v115,v106,v98
v_lshlrev_b32 v105,16,v74
v_and_b32 v106,s39,v74
v_fmac_f32 v116,v105,v98
v_fmac_f32 v117,v106,v98
v_lshlrev_b32 v105,16,v75
v_and_b32 v106,s39,v75
v_fmac_f32 v118,v105,v98
v_fmac_f32 v119,v106,v98
v_lshlrev_b32 v99,16,v99
v_mul_f32 v104,s38,v99
v_exp_f32 v104,v104
s_nop 0
v_add_f32 v104,1.0,v104
v_rcp_f32 v104,v104
s_nop 0
v_mul_f32 v104,v104,v99
v_cvt_pk_bf16_f32 v104,v104,v104
v_and_b32 v99,s39,v104
v_lshlrev_b32 v105,16,v76
v_and_b32 v106,s39,v76
v_fmac_f32 v112,v105,v99
v_fmac_f32 v113,v106,v99
v_lshlrev_b32 v105,16,v77
v_and_b32 v106,s39,v77
v_fmac_f32 v114,v105,v99
v_fmac_f32 v115,v106,v99
v_lshlrev_b32 v105,16,v78
v_and_b32 v106,s39,v78
v_fmac_f32 v116,v105,v99
v_fmac_f32 v117,v106,v99
v_lshlrev_b32 v105,16,v79
v_and_b32 v106,s39,v79
v_fmac_f32 v118,v105,v99
v_fmac_f32 v119,v106,v99
v_lshlrev_b32 v100,16,v100
v_mul_f32 v104,s38,v100
v_exp_f32 v104,v104
s_nop 0
v_add_f32 v104,1.0,v104
v_rcp_f32 v104,v104
s_nop 0
v_mul_f32 v104,v104,v100
v_cvt_pk_bf16_f32 v104,v104,v104
v_and_b32 v100,s39,v104
v_lshlrev_b32 v105,16,v80
v_and_b32 v106,s39,v80
v_fmac_f32 v112,v105,v100
v_fmac_f32 v113,v106,v100
v_lshlrev_b32 v105,16,v81
v_and_b32 v106,s39,v81
v_fmac_f32 v114,v105,v100
v_fmac_f32 v115,v106,v100
v_lshlrev_b32 v105,16,v82
v_and_b32 v106,s39,v82
v_fmac_f32 v116,v105,v100
v_fmac_f32 v117,v106,v100
v_lshlrev_b32 v105,16,v83
v_and_b32 v106,s39,v83
v_fmac_f32 v118,v105,v100
v_fmac_f32 v119,v106,v100
v_lshlrev_b32 v101,16,v101
v_mul_f32 v104,s38,v101
v_exp_f32 v104,v104
s_nop 0
v_add_f32 v104,1.0,v104
v_rcp_f32 v104,v104
s_nop 0
v_mul_f32 v104,v104,v101
v_cvt_pk_bf16_f32 v104,v104,v104
v_and_b32 v101,s39,v104
v_lshlrev_b32 v105,16,v84
v_and_b32 v106,s39,v84
v_fmac_f32 v112,v105,v101
v_fmac_f32 v113,v106,v101
v_lshlrev_b32 v105,16,v85
v_and_b32 v106,s39,v85
v_fmac_f32 v114,v105,v101
v_fmac_f32 v115,v106,v101
v_lshlrev_b32 v105,16,v86
v_and_b32 v106,s39,v86
v_fmac_f32 v116,v105,v101
v_fmac_f32 v117,v106,v101
v_lshlrev_b32 v105,16,v87
v_and_b32 v106,s39,v87
v_fmac_f32 v118,v105,v101
v_fmac_f32 v119,v106,v101
v_lshlrev_b32 v102,16,v102
v_mul_f32 v104,s38,v102
v_exp_f32 v104,v104
s_nop 0
v_add_f32 v104,1.0,v104
v_rcp_f32 v104,v104
s_nop 0
v_mul_f32 v104,v104,v102
v_cvt_pk_bf16_f32 v104,v104,v104
v_and_b32 v102,s39,v104
v_lshlrev_b32 v105,16,v88
v_and_b32 v106,s39,v88
v_fmac_f32 v112,v105,v102
v_fmac_f32 v113,v106,v102
v_lshlrev_b32 v105,16,v89
v_and_b32 v106,s39,v89
v_fmac_f32 v114,v105,v102
v_fmac_f32 v115,v106,v102
v_lshlrev_b32 v105,16,v90
v_and_b32 v106,s39,v90
v_fmac_f32 v116,v105,v102
v_fmac_f32 v117,v106,v102
v_lshlrev_b32 v105,16,v91
v_and_b32 v106,s39,v91
v_fmac_f32 v118,v105,v102
v_fmac_f32 v119,v106,v102
v_lshlrev_b32 v103,16,v103
v_mul_f32 v104,s38,v103
v_exp_f32 v104,v104
s_nop 0
v_add_f32 v104,1.0,v104
v_rcp_f32 v104,v104
s_nop 0
v_mul_f32 v104,v104,v103
v_cvt_pk_bf16_f32 v104,v104,v104
v_and_b32 v103,s39,v104
v_lshlrev_b32 v105,16,v92
v_and_b32 v106,s39,v92
v_fmac_f32 v112,v105,v103
v_fmac_f32 v113,v106,v103
v_lshlrev_b32 v105,16,v93
v_and_b32 v106,s39,v93
v_fmac_f32 v114,v105,v103
v_fmac_f32 v115,v106,v103
v_lshlrev_b32 v105,16,v94
v_and_b32 v106,s39,v94
v_fmac_f32 v116,v105,v103
v_fmac_f32 v117,v106,v103
v_lshlrev_b32 v105,16,v95
v_and_b32 v106,s39,v95
v_fmac_f32 v118,v105,v103
v_fmac_f32 v119,v106,v103
v_permlane32_swap_b32 v112,v116
v_permlane32_swap_b32 v113,v117
v_permlane32_swap_b32 v114,v118
v_permlane32_swap_b32 v115,v119
v_add_f32 v112,v112,v116
v_add_f32 v113,v113,v117
v_add_f32 v114,v114,v118
v_add_f32 v115,v115,v119
s_nop 0
v_permlane16_swap_b32 v112,v114
v_permlane16_swap_b32 v113,v115
v_add_f32 v112,v112,v114
v_add_f32 v113,v113,v115
s_nop 0
v_add_f32_dpp v112,v112,v112 row_ror:8 row_mask:0xf bank_mask:0xf
v_add_f32_dpp v113,v113,v113 row_ror:8 row_mask:0xf bank_mask:0xf
v_and_b32 v104,7,v1
v_lshlrev_b32 v104,5,v104
v_lshrrev_b32 v105,5,v1
v_lshl_add_u32 v104,v105,4,v104
v_bfe_u32 v105,v1,4,1
v_lshl_add_u32 v104,v105,3,v104
v_lshl_add_u32 v104,v2,8,v104
ds_write_b64 v104,v[112:113]
v_lshlrev_b32 v105,2,v1
s_lshl_b32 s40,s25,13
s_lshl_b32 s41,s24,8
s_add_u32 s40,s40,s41
s_add_u32 s40,s40,24576
s_waitcnt lgkmcnt(0)
s_barrier
s_cmp_lg_u32 s50,0
s_cbranch_scc1 m1n0_25
ds_read_b32 v112,v105 offset:0
ds_read_b32 v113,v105 offset:256
ds_read_b32 v114,v105 offset:512
ds_read_b32 v115,v105 offset:768
s_waitcnt lgkmcnt(0)
v_add_f32 v112,v112,v113
v_add_f32 v114,v114,v115
v_add_f32 v112,v112,v114
buffer_store_dword v112,v105,s[20:23],s40 offen sc1
m1n0_25:
s_waitcnt vmcnt(0)
s_barrier
s_cmp_lg_u32 s50,0
s_cbranch_scc1 post_9
s_mov_b64 exec,1
v_mov_b32 v184,1
v_mov_b32 v185,0
s_and_b32 s52,s56,1
s_lshl_b32 s52,s52,2
s_add_u32 s52,s52,160
buffer_atomic_add v184,v185,s[44:47],s52 offen sc0 sc1
s_waitcnt vmcnt(0)
v_readfirstlane_b32 s64,v184
s_mov_b64 exec,-1
s_cmp_eq_u32 s56,1
s_cbranch_scc1 post_9
s_cmp_lg_u32 s64,127
s_cbranch_scc1 post_9
v_and_b32 v184,3,v1
v_bfe_u32 v185,v1,2,1
v_lshlrev_b32 v184,2,v184
v_lshl_add_u32 v184,v185,7,v184
v_writelane_b32 v184,32,8
s_mov_b64 exec,0x1ff
vpoll_27:
buffer_load_dword v185,v184,s[44:47],0 offen sc1
s_waitcnt vmcnt(0)
vfirst_30:
v_readlane_b32 s92,v185,0
v_readlane_b32 s93,v185,1
v_readlane_b32 s94,v185,2
v_readlane_b32 s95,v185,3
v_readlane_b32 s96,v185,4
v_readlane_b32 s97,v185,5
v_readlane_b32 s98,v185,6
v_readlane_b32 s99,v185,7
v_readlane_b32 s61,v185,8
s_add_u32 s64,s92,s93
s_add_u32 s64,s64,s94
s_add_u32 s64,s64,s95
s_add_u32 s64,s64,s96
s_add_u32 s64,s64,s97
s_add_u32 s64,s64,s98
s_add_u32 s64,s64,s99
s_min_u32 s65,s92,s93
s_min_u32 s66,s94,s95
s_min_u32 s65,s65,s66
s_min_u32 s66,s96,s97
s_min_u32 s65,s65,s66
s_min_u32 s66,s98,s99
s_min_u32 s65,s65,s66
s_cmp_lt_u32 s65,32
s_cselect_b32 s65,1,0
s_cmp_lt_u32 s64,256
s_cbranch_scc1 vslp_29
s_branch vgot_28
vslp_29:
s_sleep 8
s_sub_u32 s90,s90,1
s_cmp_gt_i32 s90,0
s_cbranch_scc1 vpoll_27
vgot_28:
s_mov_b64 exec,-1
s_and_b32 s61,s61,1
s_lshl_b32 s61,s61,13
s_cmp_lg_u32 s65,0
s_cbranch_scc1 post_9
v_lshlrev_b32 v184,7,v1
v_mov_b32 v185,1
s_mov_b32 s64,21102592
s_mov_b32 s65,21110784
buffer_store_dword v185,v184,s[20:23],s64 offen sc1
buffer_store_dword v185,v184,s[20:23],s65 offen sc1
s_branch post_9
verify_6:
v_mov_b32 v187,158976
s_cmp_lg_u32 s50,0
s_cbranch_scc1 sh0_31
v_and_b32 v184,3,v1
v_bfe_u32 v185,v1,2,1
v_lshlrev_b32 v184,2,v184
v_lshl_add_u32 v184,v185,7,v184
v_writelane_b32 v184,32,8
s_mov_b64 exec,0x1ff
vpoll_32:
buffer_load_dword v185,v184,s[44:47],0 offen sc1
s_waitcnt vmcnt(0)
vfirst_35:
v_readlane_b32 s92,v185,0
v_readlane_b32 s93,v185,1
v_readlane_b32 s94,v185,2
v_readlane_b32 s95,v185,3
v_readlane_b32 s96,v185,4
v_readlane_b32 s97,v185,5
v_readlane_b32 s98,v185,6
v_readlane_b32 s99,v185,7
v_readlane_b32 s61,v185,8
s_add_u32 s64,s92,s93
s_add_u32 s64,s64,s94
s_add_u32 s64,s64,s95
s_add_u32 s64,s64,s96
s_add_u32 s64,s64,s97
s_add_u32 s64,s64,s98
s_add_u32 s64,s64,s99
s_min_u32 s65,s92,s93
s_min_u32 s66,s94,s95
s_min_u32 s65,s65,s66
s_min_u32 s66,s96,s97
s_min_u32 s65,s65,s66
s_min_u32 s66,s98,s99
s_min_u32 s65,s65,s66
s_cmp_lt_u32 s65,32
s_cselect_b32 s65,1,0
s_cmp_lt_u32 s64,256
s_cbranch_scc1 vslp_34
s_branch vgot_33
vslp_34:
s_sleep 8
s_sub_u32 s90,s90,1
s_cmp_gt_i32 s90,0
s_cbranch_scc1 vpoll_32
vgot_33:
s_mov_b64 exec,-1
s_and_b32 s61,s61,1
s_lshl_b32 s61,s61,13
s_mov_b32 s66,s54
s_cmp_gt_u32 s51,0
s_cselect_b32 s64,s92,0
s_add_u32 s66,s66,s64
s_cmp_gt_u32 s51,1
s_cselect_b32 s64,s93,0
s_add_u32 s66,s66,s64
s_cmp_gt_u32 s51,2
s_cselect_b32 s64,s94,0
s_add_u32 s66,s66,s64
s_cmp_gt_u32 s51,3
s_cselect_b32 s64,s95,0
s_add_u32 s66,s66,s64
s_cmp_gt_u32 s51,4
s_cselect_b32 s64,s96,0
s_add_u32 s66,s66,s64
s_cmp_gt_u32 s51,5
s_cselect_b32 s64,s97,0
s_add_u32 s66,s66,s64
s_cmp_gt_u32 s51,6
s_cselect_b32 s64,s98,0
s_add_u32 s66,s66,s64
v_mov_b32 v184,s65
v_mov_b32 v185,s66
v_mov_b32 v186,s61
ds_write_b96 v187,v[184:186] offset:16
s_waitcnt lgkmcnt(0)
sh0_31:
s_barrier
ds_read_b96 v[184:186],v187 offset:16
s_waitcnt lgkmcnt(0)
v_readfirstlane_b32 s65,v184
v_readfirstlane_b32 s66,v185
v_readfirstlane_b32 s61,v186
s_cmp_lg_u32 s65,0
s_cbranch_scc1 slowrole_10
s_mov_b32 s56,0
s_branch done_1
slowrole_10:
s_mov_b32 s57,s66
s_mov_b32 s56,1
s_waitcnt vmcnt(0)
s_barrier
s_cmp_ge_u32 s57,128
s_cbranch_scc1 pre_8
s_cmp_lg_u32 s50,0
s_cbranch_scc1 nadd_36
s_mov_b64 exec,1
v_mov_b32 v184,1
v_mov_b32 v185,0
s_mov_b32 s52,164
buffer_atomic_add v184,v185,s[44:47],s52 offen sc1
s_mov_b64 exec,-1
nadd_36:
s_branch setup_5
post_9:
s_cmp_lt_u32 s55,16
s_cbranch_scc1 xd_38
s_barrier
buffer_load_dwordx4 v[8:11],v5,s[32:35],s36 offen offset:0
buffer_load_dwordx4 v[12:15],v5,s[32:35],s36 offen offset:16
buffer_load_dwordx4 v[16:19],v5,s[32:35],s36 offen offset:512
buffer_load_dwordx4 v[20:23],v5,s[32:35],s36 offen offset:528
buffer_load_dwordx4 v[24:27],v5,s[32:35],s36 offen offset:1024
buffer_load_dwordx4 v[28:31],v5,s[32:35],s36 offen offset:1040
buffer_load_dwordx4 v[32:35],v5,s[32:35],s36 offen offset:1536
buffer_load_dwordx4 v[36:39],v5,s[32:35],s36 offen offset:1552
xd_38:
s_sub_u32 s65,s57,255
s_and_b32 s66,s56,1
s_or_b32 s65,s65,s66
s_or_b32 s65,s65,s50
s_cmp_lg_u32 s65,0
s_cbranch_scc1 nomeas_37
s_mov_b64 exec,1
v_mov_b32 v184,0
s_mov_b32 s52,20971520
s_mov_b32 s53,20979712
s_mov_b32 s70,0x7fffffff
s_mov_b32 s71,0x7fffffff
s_memtime s[72:73]
s_waitcnt lgkmcnt(0)
buffer_store_dword v184,v184,s[20:23],s52 offen sc1
s_waitcnt vmcnt(0)
s_memtime s[74:75]
s_waitcnt lgkmcnt(0)
s_sub_u32 s74,s74,s72
s_min_u32 s70,s70,s74
s_memtime s[72:73]
s_waitcnt lgkmcnt(0)
buffer_store_dword v184,v184,s[20:23],s53 offen sc1
s_waitcnt vmcnt(0)
s_memtime s[74:75]
s_waitcnt lgkmcnt(0)
s_sub_u32 s74,s74,s72
s_min_u32 s71,s71,s74
s_memtime s[72:73]
s_waitcnt lgkmcnt(0)
buffer_store_dword v184,v184,s[20:23],s52 offen sc1
s_waitcnt vmcnt(0)
s_memtime s[74:75]
s_waitcnt lgkmcnt(0)
s_sub_u32 s74,s74,s72
s_min_u32 s70,s70,s74
s_memtime s[72:73]
s_waitcnt lgkmcnt(0)
buffer_store_dword v184,v184,s[20:23],s53 offen sc1
s_waitcnt vmcnt(0)
s_memtime s[74:75]
s_waitcnt lgkmcnt(0)
s_sub_u32 s74,s74,s72
s_min_u32 s71,s71,s74
s_memtime s[72:73]
s_waitcnt lgkmcnt(0)
buffer_store_dword v184,v184,s[20:23],s52 offen sc1
s_waitcnt vmcnt(0)
s_memtime s[74:75]
s_waitcnt lgkmcnt(0)
s_sub_u32 s74,s74,s72
s_min_u32 s70,s70,s74
s_memtime s[72:73]
s_waitcnt lgkmcnt(0)
buffer_store_dword v184,v184,s[20:23],s53 offen sc1
s_waitcnt vmcnt(0)
s_memtime s[74:75]
s_waitcnt lgkmcnt(0)
s_sub_u32 s74,s74,s72
s_min_u32 s71,s71,s74
s_memtime s[72:73]
s_waitcnt lgkmcnt(0)
buffer_store_dword v184,v184,s[20:23],s52 offen sc1
s_waitcnt vmcnt(0)
s_memtime s[74:75]
s_waitcnt lgkmcnt(0)
s_sub_u32 s74,s74,s72
s_min_u32 s70,s70,s74
s_memtime s[72:73]
s_waitcnt lgkmcnt(0)
buffer_store_dword v184,v184,s[20:23],s53 offen sc1
s_waitcnt vmcnt(0)
s_memtime s[74:75]
s_waitcnt lgkmcnt(0)
s_sub_u32 s74,s74,s72
s_min_u32 s71,s71,s74
s_cmp_gt_u32 s71,s70
s_cselect_b32 s65,3,2
v_mov_b32 v185,s65
buffer_store_dword v185,v184,s[44:47],32 offen sc1
s_mov_b64 exec,-1
nomeas_37:
s_waitcnt vmcnt(0)
v_and_b32 v103,s39,v39
v_lshlrev_b32 v102,16,v39
v_and_b32 v101,s39,v38
v_lshlrev_b32 v100,16,v38
v_and_b32 v99,s39,v37
v_lshlrev_b32 v98,16,v37
v_and_b32 v97,s39,v36
v_lshlrev_b32 v96,16,v36
v_and_b32 v95,s39,v35
v_lshlrev_b32 v94,16,v35
v_and_b32 v93,s39,v34
v_lshlrev_b32 v92,16,v34
v_and_b32 v91,s39,v33
v_lshlrev_b32 v90,16,v33
v_and_b32 v89,s39,v32
v_lshlrev_b32 v88,16,v32
v_and_b32 v87,s39,v31
v_lshlrev_b32 v86,16,v31
v_and_b32 v85,s39,v30
v_lshlrev_b32 v84,16,v30
v_and_b32 v83,s39,v29
v_lshlrev_b32 v82,16,v29
v_and_b32 v81,s39,v28
v_lshlrev_b32 v80,16,v28
v_and_b32 v79,s39,v27
v_lshlrev_b32 v78,16,v27
v_and_b32 v77,s39,v26
v_lshlrev_b32 v76,16,v26
v_and_b32 v75,s39,v25
v_lshlrev_b32 v74,16,v25
v_and_b32 v73,s39,v24
v_lshlrev_b32 v72,16,v24
v_and_b32 v71,s39,v23
v_lshlrev_b32 v70,16,v23
v_and_b32 v69,s39,v22
v_lshlrev_b32 v68,16,v22
v_and_b32 v67,s39,v21
v_lshlrev_b32 v66,16,v21
v_and_b32 v65,s39,v20
v_lshlrev_b32 v64,16,v20
v_and_b32 v63,s39,v19
v_lshlrev_b32 v62,16,v19
v_and_b32 v61,s39,v18
v_lshlrev_b32 v60,16,v18
v_and_b32 v59,s39,v17
v_lshlrev_b32 v58,16,v17
v_and_b32 v57,s39,v16
v_lshlrev_b32 v56,16,v16
v_and_b32 v55,s39,v15
v_lshlrev_b32 v54,16,v15
v_and_b32 v53,s39,v14
v_lshlrev_b32 v52,16,v14
v_and_b32 v51,s39,v13
v_lshlrev_b32 v50,16,v13
v_and_b32 v49,s39,v12
v_lshlrev_b32 v48,16,v12
v_and_b32 v47,s39,v11
v_lshlrev_b32 v46,16,v11
v_and_b32 v45,s39,v10
v_lshlrev_b32 v44,16,v10
v_and_b32 v43,s39,v9
v_lshlrev_b32 v42,16,v9
v_and_b32 v41,s39,v8
v_lshlrev_b32 v40,16,v8
v_pk_add_f32 v[8:9],v[40:41],v[42:43]
v_pk_add_f32 v[10:11],v[44:45],v[46:47]
v_pk_add_f32 v[8:9],v[8:9],v[48:49]
v_pk_add_f32 v[10:11],v[10:11],v[50:51]
v_pk_add_f32 v[8:9],v[8:9],v[52:53]
v_pk_add_f32 v[10:11],v[10:11],v[54:55]
v_pk_add_f32 v[8:9],v[8:9],v[56:57]
v_pk_add_f32 v[10:11],v[10:11],v[58:59]
v_pk_add_f32 v[8:9],v[8:9],v[60:61]
v_pk_add_f32 v[10:11],v[10:11],v[62:63]
v_pk_add_f32 v[8:9],v[8:9],v[64:65]
v_pk_add_f32 v[10:11],v[10:11],v[66:67]
v_pk_add_f32 v[8:9],v[8:9],v[68:69]
v_pk_add_f32 v[10:11],v[10:11],v[70:71]
v_pk_add_f32 v[8:9],v[8:9],v[72:73]
v_pk_add_f32 v[10:11],v[10:11],v[74:75]
v_pk_add_f32 v[8:9],v[8:9],v[76:77]
v_pk_add_f32 v[10:11],v[10:11],v[78:79]
v_pk_add_f32 v[8:9],v[8:9],v[80:81]
v_pk_add_f32 v[10:11],v[10:11],v[82:83]
v_pk_add_f32 v[8:9],v[8:9],v[84:85]
v_pk_add_f32 v[10:11],v[10:11],v[86:87]
v_pk_add_f32 v[8:9],v[8:9],v[88:89]
v_pk_add_f32 v[10:11],v[10:11],v[90:91]
v_pk_add_f32 v[8:9],v[8:9],v[92:93]
v_pk_add_f32 v[10:11],v[10:11],v[94:95]
v_pk_add_f32 v[8:9],v[8:9],v[96:97]
v_pk_add_f32 v[10:11],v[10:11],v[98:99]
v_pk_add_f32 v[8:9],v[8:9],v[100:101]
v_pk_add_f32 v[10:11],v[10:11],v[102:103]
v_pk_add_f32 v[8:9],v[8:9],v[10:11]
v_add_f32 v8,v8,v9
s_nop 1
v_add_f32_dpp v8,v8,v8 row_ror:4 row_mask:0xf bank_mask:0xf
s_nop 1
v_add_f32_dpp v8,v8,v8 row_ror:8 row_mask:0xf bank_mask:0xf
v_mov_b32 v12,v8
s_nop 1
v_permlane16_swap_b32 v12,v8
v_add_f32 v8,v8,v12
v_mov_b32 v12,v8
s_nop 1
v_permlane32_swap_b32 v12,v8
v_add_f32 v8,v8,v12
v_mul_f32 v8,0xba800000,v8
v_pk_add_f32 v[40:41],v[40:41],v[8:9] op_sel_hi:[1,0]
v_pk_add_f32 v[42:43],v[42:43],v[8:9] op_sel_hi:[1,0]
v_pk_add_f32 v[44:45],v[44:45],v[8:9] op_sel_hi:[1,0]
v_pk_add_f32 v[46:47],v[46:47],v[8:9] op_sel_hi:[1,0]
v_pk_add_f32 v[48:49],v[48:49],v[8:9] op_sel_hi:[1,0]
v_pk_add_f32 v[50:51],v[50:51],v[8:9] op_sel_hi:[1,0]
v_pk_add_f32 v[52:53],v[52:53],v[8:9] op_sel_hi:[1,0]
v_pk_add_f32 v[54:55],v[54:55],v[8:9] op_sel_hi:[1,0]
v_pk_add_f32 v[56:57],v[56:57],v[8:9] op_sel_hi:[1,0]
v_pk_add_f32 v[58:59],v[58:59],v[8:9] op_sel_hi:[1,0]
v_pk_add_f32 v[60:61],v[60:61],v[8:9] op_sel_hi:[1,0]
v_pk_add_f32 v[62:63],v[62:63],v[8:9] op_sel_hi:[1,0]
v_pk_add_f32 v[64:65],v[64:65],v[8:9] op_sel_hi:[1,0]
v_pk_add_f32 v[66:67],v[66:67],v[8:9] op_sel_hi:[1,0]
v_pk_add_f32 v[68:69],v[68:69],v[8:9] op_sel_hi:[1,0]
v_pk_add_f32 v[70:71],v[70:71],v[8:9] op_sel_hi:[1,0]
v_pk_add_f32 v[72:73],v[72:73],v[8:9] op_sel_hi:[1,0]
v_pk_add_f32 v[74:75],v[74:75],v[8:9] op_sel_hi:[1,0]
v_pk_add_f32 v[76:77],v[76:77],v[8:9] op_sel_hi:[1,0]
v_pk_add_f32 v[78:79],v[78:79],v[8:9] op_sel_hi:[1,0]
v_pk_add_f32 v[80:81],v[80:81],v[8:9] op_sel_hi:[1,0]
v_pk_add_f32 v[82:83],v[82:83],v[8:9] op_sel_hi:[1,0]
v_pk_add_f32 v[84:85],v[84:85],v[8:9] op_sel_hi:[1,0]
v_pk_add_f32 v[86:87],v[86:87],v[8:9] op_sel_hi:[1,0]
v_pk_add_f32 v[88:89],v[88:89],v[8:9] op_sel_hi:[1,0]
v_pk_add_f32 v[90:91],v[90:91],v[8:9] op_sel_hi:[1,0]
v_pk_add_f32 v[92:93],v[92:93],v[8:9] op_sel_hi:[1,0]
v_pk_add_f32 v[94:95],v[94:95],v[8:9] op_sel_hi:[1,0]
v_pk_add_f32 v[96:97],v[96:97],v[8:9] op_sel_hi:[1,0]
v_pk_add_f32 v[98:99],v[98:99],v[8:9] op_sel_hi:[1,0]
v_pk_add_f32 v[100:101],v[100:101],v[8:9] op_sel_hi:[1,0]
v_pk_add_f32 v[102:103],v[102:103],v[8:9] op_sel_hi:[1,0]
v_pk_mul_f32 v[10:11],v[40:41],v[40:41]
v_pk_mul_f32 v[14:15],v[42:43],v[42:43]
v_pk_fma_f32 v[10:11],v[44:45],v[44:45],v[10:11]
v_pk_fma_f32 v[14:15],v[46:47],v[46:47],v[14:15]
v_pk_fma_f32 v[10:11],v[48:49],v[48:49],v[10:11]
v_pk_fma_f32 v[14:15],v[50:51],v[50:51],v[14:15]
v_pk_fma_f32 v[10:11],v[52:53],v[52:53],v[10:11]
v_pk_fma_f32 v[14:15],v[54:55],v[54:55],v[14:15]
v_pk_fma_f32 v[10:11],v[56:57],v[56:57],v[10:11]
v_pk_fma_f32 v[14:15],v[58:59],v[58:59],v[14:15]
v_pk_fma_f32 v[10:11],v[60:61],v[60:61],v[10:11]
v_pk_fma_f32 v[14:15],v[62:63],v[62:63],v[14:15]
v_pk_fma_f32 v[10:11],v[64:65],v[64:65],v[10:11]
v_pk_fma_f32 v[14:15],v[66:67],v[66:67],v[14:15]
v_pk_fma_f32 v[10:11],v[68:69],v[68:69],v[10:11]
v_pk_fma_f32 v[14:15],v[70:71],v[70:71],v[14:15]
v_pk_fma_f32 v[10:11],v[72:73],v[72:73],v[10:11]
v_pk_fma_f32 v[14:15],v[74:75],v[74:75],v[14:15]
v_pk_fma_f32 v[10:11],v[76:77],v[76:77],v[10:11]
v_pk_fma_f32 v[14:15],v[78:79],v[78:79],v[14:15]
v_pk_fma_f32 v[10:11],v[80:81],v[80:81],v[10:11]
v_pk_fma_f32 v[14:15],v[82:83],v[82:83],v[14:15]
v_pk_fma_f32 v[10:11],v[84:85],v[84:85],v[10:11]
v_pk_fma_f32 v[14:15],v[86:87],v[86:87],v[14:15]
v_pk_fma_f32 v[10:11],v[88:89],v[88:89],v[10:11]
v_pk_fma_f32 v[14:15],v[90:91],v[90:91],v[14:15]
v_pk_fma_f32 v[10:11],v[92:93],v[92:93],v[10:11]
v_pk_fma_f32 v[14:15],v[94:95],v[94:95],v[14:15]
v_pk_fma_f32 v[10:11],v[96:97],v[96:97],v[10:11]
v_pk_fma_f32 v[14:15],v[98:99],v[98:99],v[14:15]
v_pk_fma_f32 v[10:11],v[100:101],v[100:101],v[10:11]
v_pk_fma_f32 v[14:15],v[102:103],v[102:103],v[14:15]
v_pk_add_f32 v[10:11],v[10:11],v[14:15]
v_add_f32 v10,v10,v11
s_nop 1
v_add_f32_dpp v10,v10,v10 row_ror:4 row_mask:0xf bank_mask:0xf
s_nop 1
v_add_f32_dpp v10,v10,v10 row_ror:8 row_mask:0xf bank_mask:0xf
v_mov_b32 v12,v10
s_nop 1
v_permlane16_swap_b32 v12,v10
v_add_f32 v10,v10,v12
v_mov_b32 v12,v10
s_nop 1
v_permlane32_swap_b32 v12,v10
v_add_f32 v10,v10,v12
v_mov_b32 v12,0x3727c5ac
v_fmac_f32 v12,0x3a800000,v10
v_rsq_f32 v10,v12
s_nop 0
v_pk_mul_f32 v[40:41],v[40:41],v[10:11] op_sel_hi:[1,0]
v_pk_mul_f32 v[42:43],v[42:43],v[10:11] op_sel_hi:[1,0]
v_pk_mul_f32 v[44:45],v[44:45],v[10:11] op_sel_hi:[1,0]
v_pk_mul_f32 v[46:47],v[46:47],v[10:11] op_sel_hi:[1,0]
v_pk_mul_f32 v[48:49],v[48:49],v[10:11] op_sel_hi:[1,0]
v_pk_mul_f32 v[50:51],v[50:51],v[10:11] op_sel_hi:[1,0]
v_pk_mul_f32 v[52:53],v[52:53],v[10:11] op_sel_hi:[1,0]
v_pk_mul_f32 v[54:55],v[54:55],v[10:11] op_sel_hi:[1,0]
v_pk_mul_f32 v[56:57],v[56:57],v[10:11] op_sel_hi:[1,0]
v_pk_mul_f32 v[58:59],v[58:59],v[10:11] op_sel_hi:[1,0]
v_pk_mul_f32 v[60:61],v[60:61],v[10:11] op_sel_hi:[1,0]
v_pk_mul_f32 v[62:63],v[62:63],v[10:11] op_sel_hi:[1,0]
v_pk_mul_f32 v[64:65],v[64:65],v[10:11] op_sel_hi:[1,0]
v_pk_mul_f32 v[66:67],v[66:67],v[10:11] op_sel_hi:[1,0]
v_pk_mul_f32 v[68:69],v[68:69],v[10:11] op_sel_hi:[1,0]
v_pk_mul_f32 v[70:71],v[70:71],v[10:11] op_sel_hi:[1,0]
v_pk_mul_f32 v[72:73],v[72:73],v[10:11] op_sel_hi:[1,0]
v_pk_mul_f32 v[74:75],v[74:75],v[10:11] op_sel_hi:[1,0]
v_pk_mul_f32 v[76:77],v[76:77],v[10:11] op_sel_hi:[1,0]
v_pk_mul_f32 v[78:79],v[78:79],v[10:11] op_sel_hi:[1,0]
v_pk_mul_f32 v[80:81],v[80:81],v[10:11] op_sel_hi:[1,0]
v_pk_mul_f32 v[82:83],v[82:83],v[10:11] op_sel_hi:[1,0]
v_pk_mul_f32 v[84:85],v[84:85],v[10:11] op_sel_hi:[1,0]
v_pk_mul_f32 v[86:87],v[86:87],v[10:11] op_sel_hi:[1,0]
v_pk_mul_f32 v[88:89],v[88:89],v[10:11] op_sel_hi:[1,0]
v_pk_mul_f32 v[90:91],v[90:91],v[10:11] op_sel_hi:[1,0]
v_pk_mul_f32 v[92:93],v[92:93],v[10:11] op_sel_hi:[1,0]
v_pk_mul_f32 v[94:95],v[94:95],v[10:11] op_sel_hi:[1,0]
v_pk_mul_f32 v[96:97],v[96:97],v[10:11] op_sel_hi:[1,0]
v_pk_mul_f32 v[98:99],v[98:99],v[10:11] op_sel_hi:[1,0]
v_pk_mul_f32 v[100:101],v[100:101],v[10:11] op_sel_hi:[1,0]
v_pk_mul_f32 v[102:103],v[102:103],v[10:11] op_sel_hi:[1,0]
v_mov_b32 v187,158976
s_cmp_lg_u32 s50,0
s_cbranch_scc1 sh0_39
s_mov_b32 s65,0
s_cmp_eq_u32 s56,1
s_cbranch_scc1 m1s_40
s_lshl_b32 s52,s55,7
s_add_u32 s52,s52,21102592
s_mov_b32 s53,0
m1l_41:
v_mov_b32 v184,0
buffer_load_dword v185,v184,s[20:23],s52 offen sc1
s_waitcnt vmcnt(0)
v_readfirstlane_b32 s64,v185
s_mov_b32 s65,0
s_cmp_eq_u32 s64,1
s_cbranch_scc1 m1ok_42
s_sub_u32 s90,s90,1
s_cmp_lt_i32 s90,0
s_cbranch_scc1 m1ok_42
s_add_u32 s53,s53,1
s_and_b32 s64,s53,31
s_cbranch_scc1 m1l_41
v_and_b32 v184,3,v1
v_bfe_u32 v185,v1,2,1
v_lshlrev_b32 v184,2,v184
v_lshl_add_u32 v184,v185,7,v184
v_writelane_b32 v184,32,8
s_mov_b64 exec,0x1ff
vpoll_43:
buffer_load_dword v185,v184,s[44:47],0 offen sc1
s_waitcnt vmcnt(0)
vfirst_46:
v_readlane_b32 s92,v185,0
v_readlane_b32 s93,v185,1
v_readlane_b32 s94,v185,2
v_readlane_b32 s95,v185,3
v_readlane_b32 s96,v185,4
v_readlane_b32 s97,v185,5
v_readlane_b32 s98,v185,6
v_readlane_b32 s99,v185,7
v_readlane_b32 s61,v185,8
s_add_u32 s64,s92,s93
s_add_u32 s64,s64,s94
s_add_u32 s64,s64,s95
s_add_u32 s64,s64,s96
s_add_u32 s64,s64,s97
s_add_u32 s64,s64,s98
s_add_u32 s64,s64,s99
s_min_u32 s65,s92,s93
s_min_u32 s66,s94,s95
s_min_u32 s65,s65,s66
s_min_u32 s66,s96,s97
s_min_u32 s65,s65,s66
s_min_u32 s66,s98,s99
s_min_u32 s65,s65,s66
s_cmp_lt_u32 s65,32
s_cselect_b32 s65,1,0
s_cmp_lt_u32 s64,256
s_cbranch_scc1 vslp_45
s_branch vgot_44
vslp_45:
s_sleep 8
s_sub_u32 s90,s90,1
s_cmp_gt_i32 s90,0
s_cbranch_scc1 vpoll_43
vgot_44:
s_mov_b64 exec,-1
s_and_b32 s61,s61,1
s_lshl_b32 s61,s61,13
s_mov_b32 s66,s54
s_cmp_gt_u32 s51,0
s_cselect_b32 s64,s92,0
s_add_u32 s66,s66,s64
s_cmp_gt_u32 s51,1
s_cselect_b32 s64,s93,0
s_add_u32 s66,s66,s64
s_cmp_gt_u32 s51,2
s_cselect_b32 s64,s94,0
s_add_u32 s66,s66,s64
s_cmp_gt_u32 s51,3
s_cselect_b32 s64,s95,0
s_add_u32 s66,s66,s64
s_cmp_gt_u32 s51,4
s_cselect_b32 s64,s96,0
s_add_u32 s66,s66,s64
s_cmp_gt_u32 s51,5
s_cselect_b32 s64,s97,0
s_add_u32 s66,s66,s64
s_cmp_gt_u32 s51,6
s_cselect_b32 s64,s98,0
s_add_u32 s66,s66,s64
s_cmp_eq_u32 s65,0
s_cbranch_scc1 m1l_41
s_branch m1ok_42
m1s_40:
s_mov_b32 s53,256
s_mov_b32 s52,164
v_mov_b32 v184,0
dp_47:
buffer_load_dword v185,v184,s[44:47],s52 offen sc1
s_waitcnt vmcnt(0)
v_cmp_ne_u32 vcc,s53,v185
s_cbranch_vccz dpok_48
s_sleep 8
s_sub_u32 s90,s90,1
s_cmp_gt_i32 s90,0
s_cbranch_scc1 dp_47
dpok_48:
m1ok_42:
v_mov_b32 v184,s65
v_mov_b32 v185,s66
v_mov_b32 v186,s61
ds_write_b96 v187,v[184:186] offset:16
s_waitcnt lgkmcnt(0)
sh0_39:
s_barrier
ds_read_b96 v[184:186],v187 offset:16
s_waitcnt lgkmcnt(0)
v_readfirstlane_b32 s65,v184
v_readfirstlane_b32 s66,v185
v_readfirstlane_b32 s61,v186
s_cmp_lg_u32 s65,0
s_cbranch_scc1 slowrole_10
s_and_b32 s56,s56,1
s_lshl_b32 s53,s56,2
s_add_u32 s53,s53,4
v_mul_u32_u24 v241,s53,v1
s_lshr_b32 s53,s55,4
s_or_b32 s53,s53,s50
s_cselect_b32 s53,0x7fff0000,32
s_mov_b64 exec,3
buffer_load_dword v240,v241,s[44:47],s53 offen sc1
s_mov_b64 exec,-1
v_lshlrev_b32 v7,5,v0
s_mov_b32 s40,24576
buffer_load_dwordx4 v[104:107],v7,s[20:23],s40 offen offset:0 sc1
buffer_load_dwordx4 v[108:111],v7,s[20:23],s40 offen offset:16 sc1
s_add_u32 s40,s40,8192
buffer_load_dwordx4 v[112:115],v7,s[20:23],s40 offen offset:0 sc1
buffer_load_dwordx4 v[116:119],v7,s[20:23],s40 offen offset:16 sc1
s_add_u32 s40,s40,8192
buffer_load_dwordx4 v[120:123],v7,s[20:23],s40 offen offset:0 sc1
buffer_load_dwordx4 v[124:127],v7,s[20:23],s40 offen offset:16 sc1
s_add_u32 s40,s40,8192
buffer_load_dwordx4 v[128:131],v7,s[20:23],s40 offen offset:0 sc1
buffer_load_dwordx4 v[132:135],v7,s[20:23],s40 offen offset:16 sc1
v_mov_b32 v14,1.0
v_cmp_lt_u32 vcc,127,v0
s_nop 1
v_cndmask_b32 v14,0,v14,vcc
s_waitcnt vmcnt(0)
v_pk_add_f32 v[104:105],v[104:105],v[112:113]
v_pk_add_f32 v[120:121],v[120:121],v[128:129]
v_pk_add_f32 v[106:107],v[106:107],v[114:115]
v_pk_add_f32 v[122:123],v[122:123],v[130:131]
v_pk_add_f32 v[108:109],v[108:109],v[116:117]
v_pk_add_f32 v[124:125],v[124:125],v[132:133]
v_pk_add_f32 v[110:111],v[110:111],v[118:119]
v_pk_add_f32 v[126:127],v[126:127],v[134:135]
v_pk_add_f32 v[104:105],v[104:105],v[120:121]
v_pk_add_f32 v[106:107],v[106:107],v[122:123]
v_pk_add_f32 v[108:109],v[108:109],v[124:125]
v_pk_add_f32 v[110:111],v[110:111],v[126:127]
v_cvt_pk_bf16_f32 v112,v104,v105
v_cvt_pk_bf16_f32 v113,v106,v107
v_cvt_pk_bf16_f32 v114,v108,v109
v_cvt_pk_bf16_f32 v115,v110,v111
v_lshlrev_b32 v104,16,v112
v_and_b32 v105,s39,v112
v_lshlrev_b32 v106,16,v113
v_and_b32 v107,s39,v113
v_lshlrev_b32 v108,16,v114
v_and_b32 v109,s39,v114
v_lshlrev_b32 v110,16,v115
v_and_b32 v111,s39,v115
v_pk_add_f32 v[104:105],v[104:105],v[14:15] op_sel_hi:[1,0]
v_pk_add_f32 v[106:107],v[106:107],v[14:15] op_sel_hi:[1,0]
v_pk_add_f32 v[108:109],v[108:109],v[14:15] op_sel_hi:[1,0]
v_pk_add_f32 v[110:111],v[110:111],v[14:15] op_sel_hi:[1,0]
ds_write_b128 v7,v[104:107] offset:4096
ds_write_b128 v7,v[108:111] offset:4112
s_waitcnt lgkmcnt(0)
s_barrier
ds_read_b128 v[104:107],v4 offset:8192
ds_read_b128 v[168:171],v4 offset:4096
ds_read_b128 v[108:111],v4 offset:8208
ds_read_b128 v[172:175],v4 offset:4112
ds_read_b128 v[112:115],v4 offset:8224
ds_read_b128 v[176:179],v4 offset:4128
ds_read_b128 v[116:119],v4 offset:8240
ds_read_b128 v[180:183],v4 offset:4144
ds_read_b128 v[120:123],v4 offset:9216
ds_read_b128 v[184:187],v4 offset:5120
ds_read_b128 v[124:127],v4 offset:9232
ds_read_b128 v[188:191],v4 offset:5136
ds_read_b128 v[128:131],v4 offset:9248
ds_read_b128 v[192:195],v4 offset:5152
ds_read_b128 v[132:135],v4 offset:9264
ds_read_b128 v[196:199],v4 offset:5168
ds_read_b128 v[136:139],v4 offset:10240
ds_read_b128 v[200:203],v4 offset:6144
ds_read_b128 v[140:143],v4 offset:10256
ds_read_b128 v[204:207],v4 offset:6160
ds_read_b128 v[144:147],v4 offset:10272
ds_read_b128 v[208:211],v4 offset:6176
ds_read_b128 v[148:151],v4 offset:10288
ds_read_b128 v[212:215],v4 offset:6192
ds_read_b128 v[152:155],v4 offset:11264
ds_read_b128 v[216:219],v4 offset:7168
ds_read_b128 v[156:159],v4 offset:11280
ds_read_b128 v[220:223],v4 offset:7184
ds_read_b128 v[160:163],v4 offset:11296
ds_read_b128 v[224:227],v4 offset:7200
ds_read_b128 v[164:167],v4 offset:11312
ds_read_b128 v[228:231],v4 offset:7216
s_waitcnt lgkmcnt(15)
v_pk_fma_f32 v[40:41],v[40:41],v[104:105],v[168:169]
v_pk_fma_f32 v[42:43],v[42:43],v[106:107],v[170:171]
v_pk_fma_f32 v[44:45],v[44:45],v[108:109],v[172:173]
v_pk_fma_f32 v[46:47],v[46:47],v[110:111],v[174:175]
v_pk_fma_f32 v[48:49],v[48:49],v[112:113],v[176:177]
v_pk_fma_f32 v[50:51],v[50:51],v[114:115],v[178:179]
v_pk_fma_f32 v[52:53],v[52:53],v[116:117],v[180:181]
v_pk_fma_f32 v[54:55],v[54:55],v[118:119],v[182:183]
v_cvt_pk_bf16_f32 v16,v40,v41
v_cvt_pk_bf16_f32 v17,v48,v49
v_cvt_pk_bf16_f32 v18,v42,v43
v_cvt_pk_bf16_f32 v19,v50,v51
buffer_store_dwordx4 v[16:19],v6,s[20:23],s37 offen offset:0 sc1
v_cvt_pk_bf16_f32 v20,v44,v45
v_cvt_pk_bf16_f32 v21,v52,v53
v_cvt_pk_bf16_f32 v22,v46,v47
v_cvt_pk_bf16_f32 v23,v54,v55
buffer_store_dwordx4 v[20:23],v6,s[20:23],s37 offen offset:256 sc1
s_waitcnt lgkmcnt(15)
v_pk_fma_f32 v[56:57],v[56:57],v[120:121],v[184:185]
v_pk_fma_f32 v[58:59],v[58:59],v[122:123],v[186:187]
v_pk_fma_f32 v[60:61],v[60:61],v[124:125],v[188:189]
v_pk_fma_f32 v[62:63],v[62:63],v[126:127],v[190:191]
v_pk_fma_f32 v[64:65],v[64:65],v[128:129],v[192:193]
v_pk_fma_f32 v[66:67],v[66:67],v[130:131],v[194:195]
v_pk_fma_f32 v[68:69],v[68:69],v[132:133],v[196:197]
v_pk_fma_f32 v[70:71],v[70:71],v[134:135],v[198:199]
v_cvt_pk_bf16_f32 v24,v56,v57
v_cvt_pk_bf16_f32 v25,v64,v65
v_cvt_pk_bf16_f32 v26,v58,v59
v_cvt_pk_bf16_f32 v27,v66,v67
s_add_u32 s37,s37,16384
buffer_store_dwordx4 v[24:27],v6,s[20:23],s37 offen offset:0 sc1
v_cvt_pk_bf16_f32 v28,v60,v61
v_cvt_pk_bf16_f32 v29,v68,v69
v_cvt_pk_bf16_f32 v30,v62,v63
v_cvt_pk_bf16_f32 v31,v70,v71
buffer_store_dwordx4 v[28:31],v6,s[20:23],s37 offen offset:256 sc1
s_waitcnt lgkmcnt(8)
v_pk_fma_f32 v[72:73],v[72:73],v[136:137],v[200:201]
v_pk_fma_f32 v[74:75],v[74:75],v[138:139],v[202:203]
v_pk_fma_f32 v[76:77],v[76:77],v[140:141],v[204:205]
v_pk_fma_f32 v[78:79],v[78:79],v[142:143],v[206:207]
v_pk_fma_f32 v[80:81],v[80:81],v[144:145],v[208:209]
v_pk_fma_f32 v[82:83],v[82:83],v[146:147],v[210:211]
v_pk_fma_f32 v[84:85],v[84:85],v[148:149],v[212:213]
v_pk_fma_f32 v[86:87],v[86:87],v[150:151],v[214:215]
v_cvt_pk_bf16_f32 v16,v72,v73
v_cvt_pk_bf16_f32 v17,v80,v81
v_cvt_pk_bf16_f32 v18,v74,v75
v_cvt_pk_bf16_f32 v19,v82,v83
s_add_u32 s37,s37,16384
buffer_store_dwordx4 v[16:19],v6,s[20:23],s37 offen offset:0 sc1
v_cvt_pk_bf16_f32 v20,v76,v77
v_cvt_pk_bf16_f32 v21,v84,v85
v_cvt_pk_bf16_f32 v22,v78,v79
v_cvt_pk_bf16_f32 v23,v86,v87
buffer_store_dwordx4 v[20:23],v6,s[20:23],s37 offen offset:256 sc1
s_waitcnt lgkmcnt(0)
v_pk_fma_f32 v[88:89],v[88:89],v[152:153],v[216:217]
v_pk_fma_f32 v[90:91],v[90:91],v[154:155],v[218:219]
v_pk_fma_f32 v[92:93],v[92:93],v[156:157],v[220:221]
v_pk_fma_f32 v[94:95],v[94:95],v[158:159],v[222:223]
v_pk_fma_f32 v[96:97],v[96:97],v[160:161],v[224:225]
v_pk_fma_f32 v[98:99],v[98:99],v[162:163],v[226:227]
v_pk_fma_f32 v[100:101],v[100:101],v[164:165],v[228:229]
v_pk_fma_f32 v[102:103],v[102:103],v[166:167],v[230:231]
v_cvt_pk_bf16_f32 v24,v88,v89
v_cvt_pk_bf16_f32 v25,v96,v97
v_cvt_pk_bf16_f32 v26,v90,v91
v_cvt_pk_bf16_f32 v27,v98,v99
s_add_u32 s37,s37,16384
buffer_store_dwordx4 v[24:27],v6,s[20:23],s37 offen offset:0 sc1
v_cvt_pk_bf16_f32 v28,v92,v93
v_cvt_pk_bf16_f32 v29,v100,v101
v_cvt_pk_bf16_f32 v30,v94,v95
v_cvt_pk_bf16_f32 v31,v102,v103
buffer_store_dwordx4 v[28:31],v6,s[20:23],s37 offen offset:256 sc1
s_waitcnt vmcnt(0)
s_barrier
v_mov_b32 v187,158976
s_cmp_lg_u32 s50,0
s_cbranch_scc1 sh0_49
s_cmp_ge_u32 s55,16
s_cbranch_scc1 nodln_50
rdl_52:
v_readlane_b32 s64,v240,0
v_readlane_b32 s65,v240,1
s_cmp_eq_u32 s56,1
s_cselect_b32 s64,2,s64
s_cmp_eq_u32 s65,128
s_cselect_b32 s64,s64,0
s_cmp_lg_u32 s64,0
s_cbranch_scc1 rdok_53
s_mov_b64 exec,3
buffer_load_dword v240,v241,s[44:47],s53 offen sc1
s_mov_b64 exec,-1
s_sub_u32 s90,s90,1
s_cmp_gt_i32 s90,0
s_waitcnt vmcnt(0)
s_cbranch_scc1 rdl_52
rdok_53:
s_lshl_b32 s65,s55,2
v_lshl_add_u32 v184,v1,7,s65
v_mov_b32 v185,s64
s_mov_b32 s64,21168128
s_mov_b32 s65,21176320
buffer_store_dword v185,v184,s[20:23],s64 offen sc1
buffer_store_dword v185,v184,s[20:23],s65 offen sc1
nodln_50:
s_mov_b32 s61,0
s_cmp_eq_u32 s56,1
s_cbranch_scc1 nopar_51
v_mov_b32 v184,0
dp_54:
buffer_load_dword v185,v184,s[44:47],32 offen sc1
s_waitcnt vmcnt(0)
v_cmp_eq_u32 vcc,0,v185
s_cbranch_vccz dpok_55
s_sleep 4
s_sub_u32 s90,s90,1
s_cmp_gt_i32 s90,0
s_cbranch_scc1 dp_54
dpok_55:
v_readfirstlane_b32 s65,v185
s_and_b32 s65,s65,1
s_lshl_b32 s61,s65,13
nopar_51:
v_mov_b32 v184,s65
v_mov_b32 v185,s66
v_mov_b32 v186,s61
ds_write_b96 v187,v[184:186] offset:16
s_waitcnt lgkmcnt(0)
sh0_49:
s_barrier
ds_read_b96 v[184:186],v187 offset:16
s_waitcnt lgkmcnt(0)
v_readfirstlane_b32 s65,v184
v_readfirstlane_b32 s66,v185
v_readfirstlane_b32 s61,v186
s_sub_u32 s55,s57,128
s_cmp_lg_u32 s50,0
s_cbranch_scc1 nsig_56
s_lshr_b32 s95,s55,4
s_lshl_b32 s95,s95,6
s_add_u32 s95,s95,21052416
s_mov_b64 exec,1
v_mov_b32 v184,112
v_mov_b32 v185,0
buffer_atomic_add v184,v185,s[20:23],s95 offen sc1
s_mov_b64 exec,-1
nsig_56:
s_branch pipe_worker
loops_7:
s_lshl_b32 s64,s50,14
s_add_u32 m0,s64,0
s_add_u32 s65,s64,57344
buffer_load_dwordx4 v16,s[20:23],s65 offen offset:0 lds
buffer_load_dwordx4 v16,s[20:23],s65 offen offset:1024 lds
buffer_load_dwordx4 v16,s[20:23],s65 offen offset:2048 lds
buffer_load_dwordx4 v16,s[20:23],s65 offen offset:3072 lds
s_add_u32 m0,s64,4096
s_add_u32 s65,s64,61440
buffer_load_dwordx4 v16,s[20:23],s65 offen offset:0 lds
buffer_load_dwordx4 v16,s[20:23],s65 offen offset:1024 lds
buffer_load_dwordx4 v16,s[20:23],s65 offen offset:2048 lds
buffer_load_dwordx4 v16,s[20:23],s65 offen offset:3072 lds
s_add_u32 m0,s64,8192
s_add_u32 s65,s64,65536
buffer_load_dwordx4 v16,s[20:23],s65 offen offset:0 lds
buffer_load_dwordx4 v16,s[20:23],s65 offen offset:1024 lds
buffer_load_dwordx4 v16,s[20:23],s65 offen offset:2048 lds
buffer_load_dwordx4 v16,s[20:23],s65 offen offset:3072 lds
s_add_u32 m0,s64,12288
s_add_u32 s65,s64,69632
buffer_load_dwordx4 v16,s[20:23],s65 offen offset:0 lds
buffer_load_dwordx4 v16,s[20:23],s65 offen offset:1024 lds
buffer_load_dwordx4 v16,s[20:23],s65 offen offset:2048 lds
buffer_load_dwordx4 v16,s[20:23],s65 offen offset:3072 lds
s_add_u32 m0,s64,65536
s_add_u32 s65,s64,122880
buffer_load_dwordx4 v16,s[20:23],s65 offen offset:0 lds
buffer_load_dwordx4 v16,s[20:23],s65 offen offset:1024 lds
buffer_load_dwordx4 v16,s[20:23],s65 offen offset:2048 lds
buffer_load_dwordx4 v16,s[20:23],s65 offen offset:3072 lds
s_add_u32 m0,s64,69632
s_add_u32 s65,s64,126976
buffer_load_dwordx4 v16,s[20:23],s65 offen offset:0 lds
buffer_load_dwordx4 v16,s[20:23],s65 offen offset:1024 lds
buffer_load_dwordx4 v16,s[20:23],s65 offen offset:2048 lds
buffer_load_dwordx4 v16,s[20:23],s65 offen offset:3072 lds
s_add_u32 m0,s64,73728
s_add_u32 s65,s64,131072
buffer_load_dwordx4 v16,s[20:23],s65 offen offset:0 lds
buffer_load_dwordx4 v16,s[20:23],s65 offen offset:1024 lds
buffer_load_dwordx4 v16,s[20:23],s65 offen offset:2048 lds
buffer_load_dwordx4 v16,s[20:23],s65 offen offset:3072 lds
s_add_u32 m0,s64,77824
s_add_u32 s65,s64,135168
buffer_load_dwordx4 v16,s[20:23],s65 offen offset:0 lds
buffer_load_dwordx4 v16,s[20:23],s65 offen offset:1024 lds
buffer_load_dwordx4 v16,s[20:23],s65 offen offset:2048 lds
buffer_load_dwordx4 v16,s[20:23],s65 offen offset:3072 lds
s_mov_b64 s[24:25],s[20:21]
s_mov_b64 s[28:29],s[20:21]
s_mov_b32 s27,0x20000
s_mov_b32 s31,0x20000
s_cmp_eq_u32 s56,0
s_cselect_b32 s26,s22,0
s_cselect_b32 s30,0,s22
s_lshl_b32 s64,s58,14
s_add_u32 s64,s64,23068672
v_add_u32 v26,s64,v16
v_add_u32 v27,4096,v26
v_add_u32 v28,8192,v26
v_add_u32 v29,12288,v26
s_lshl_b32 s65,s59,9
s_add_u32 s66,s64,s65
s_lshl_b32 s64,s58,7
s_add_u32 s64,s64,23592960
v_and_b32 v18,31,v1
v_lshl_add_u32 v18,v18,2,s64
s_lshl_b32 s65,s59,2
s_add_u32 s64,s64,s65
v_mov_b32 v13,s64
v_mov_b32 v14,0x4444
v_mov_b32 v22,0xeeee
v_cmp_lt_u32 vcc,7,v3
s_nop 1
v_cndmask_b32 v14,v14,v22,vcc
v_and_b32 v22,1,v3
v_cmp_eq_u32 vcc,0,v22
v_mov_b32 v15,0x03020706
v_mov_b32 v23,0x05040100
v_cndmask_b32 v15,v15,v23,vcc
v_lshlrev_b32 v19,5,v22
v_lshl_add_u32 v19,v4,6,v19
v_lshrrev_b32 v23,1,v3
v_lshl_add_u32 v19,v23,2,v19
s_lshl_b32 s67,s57,10
s_add_u32 s67,s67,23199744
s_lshl_b32 s64,s50,2
s_lshr_b32 s64,0x1320,s64
s_and_b32 s64,s64,3
s_lshl_b32 s64,s64,8
s_add_u32 s64,s64,s67
v_add_u32 v19,s64,v19
v_add_u32 v24,131072,v16
v_mov_b32 v21,158720
v_mov_b32 v25,0
v_mov_b32 v20,v16
v_and_b32 v22,1,v4
v_lshrrev_b32 v23,1,v4
v_lshl_add_u32 v23,v23,4,v3
v_lshlrev_b32 v23,4,v23
v_lshl_add_u32 v23,v22,10,v23
s_lshr_b32 s64,s50,1
s_lshl_b32 s64,s64,9
v_add_u32 v23,s64,v23
s_lshr_b32 s64,s57,2
s_add_u32 s65,s64,32
s_lshl_b32 s65,s65,14
s_and_b32 s68,s57,3
s_lshl_b32 s68,s68,11
s_add_u32 s65,s65,s68
s_add_u32 s65,s65,29360128
v_add_u32 v17,s65,v23
s_lshl_b32 s69,s57,11
s_add_u32 s69,s69,23330816
v_add_u32 v2,s69,v23
s_mov_b32 s81,0x3e0293ee
s_mov_b32 s84,0xff00ff
s_mov_b32 s85,0xff00ff
s_mov_b32 s86,0x33333333
s_mov_b32 s87,0x33333333
s_mov_b32 s62,0x10000
s_mov_b32 s79,-2
ds_write_b32 v21,v25
ds_write_b32 v21,v25 offset:4
ds_write_b32 v21,v25 offset:8
ds_write_b32 v21,v25 offset:12
ds_write_b32 v21,v25 offset:16
ds_write_b32 v21,v25 offset:24
ds_write_b32 v21,v25 offset:28
v_mov_b32 v100,0
v_mov_b32 v101,0
v_mov_b32 v102,0
v_mov_b32 v103,0
s_lshr_b32 s64,s59,3
s_lshl_b32 s64,s64,14
s_and_b32 s65,s59,7
s_lshl_b32 s65,s65,10
s_add_u32 s64,s64,s65
s_lshl_b32 s65,s58,16
s_add_u32 s64,s64,s65
s_add_u32 s64,s64,31195136
v_add_u32 v8,s64,v16
s_cmp_eq_u32 s50,3
s_cbranch_scc1 w3_61
s_cmp_eq_u32 s50,1
s_cbranch_scc1 w1_59
s_cmp_eq_u32 s50,2
s_cbranch_scc1 w2_60
w0_58:
v_and_b32 v22,7,v3
v_lshrrev_b32 v23,2,v22
v_and_b32 v5,2,v22
v_or_b32 v23,v23,v5
v_and_b32 v5,1,v22
v_lshl_add_u32 v23,v23,1,v5
v_lshlrev_b32 v23,5,v23
v_lshrrev_b32 v5,3,v3
v_lshl_add_u32 v23,v5,9,v23
v_lshrrev_b32 v5,1,v4
v_lshl_add_u32 v23,v5,8,v23
v_and_b32 v5,1,v4
v_lshl_add_u32 v23,v5,4,v23
v_add_u32 v8,s67,v23
v_xor_b32 v9,1024,v8
v_xor_b32 v10,2048,v8
v_xor_b32 v11,3072,v8
v_lshlrev_b32 v31,4,v3
v_lshl_add_u32 v31,v5,3,v31
v_add_u32 v31,155648,v31
v_lshl_add_u32 v23,v4,3,v22
v_lshlrev_b32 v23,4,v23
v_add_u32 v12,155648,v23
v_add_u32 v30,s66,v23
v_cmp_gt_u32 vcc,8,v3
v_cmp_lt_u32 s[52:53],1,v4
s_and_b64 vcc,vcc,s[52:53]
v_mov_b32 v22,0xf149f2ca
v_cndmask_b32 v156,v22,0,vcc
v_mov_b32 v157,v156
v_mov_b32 v158,v156
v_mov_b32 v159,v156
v_add_u32 v2,s69,v16
v_xor_b32 v5,2048,v2
v_xor_b32 v6,4096,v2
v_xor_b32 v7,6144,v2
s_lshr_b32 s64,s57,3
s_add_u32 s64,s64,96
s_lshl_b32 s64,s64,14
s_and_b32 s65,s57,7
s_lshl_b32 s65,s65,10
s_add_u32 s64,s64,s65
s_add_u32 s64,s64,29360128
v_add_u32 v3,s64,v16
v_mov_b32 v136,0
v_mov_b32 v137,0
v_mov_b32 v138,0
v_mov_b32 v139,0
v_mov_b32 v140,0
v_mov_b32 v141,0
v_mov_b32 v142,0
v_mov_b32 v143,0
v_mov_b32 v144,0
v_mov_b32 v145,0
v_mov_b32 v146,0
v_mov_b32 v147,0
v_mov_b32 v152,0x3f803f80
v_mov_b32 v153,0x3f803f80
v_mov_b32 v154,0x3f803f80
v_mov_b32 v155,0x3f803f80
s_branch first_62
loop_63:
s_barrier
buffer_load_dword v248,v18,s[20:23],s70 offen offset:0 sc1
s_nop 15
s_nop 5
hl_65:
buffer_load_dword v249,v18,s[20:23],s70 offen offset:0 sc1
s_waitcnt vmcnt(1)
v_cmp_eq_u32 vcc,v25,v248
s_bcnt1_i32_b32 s64,vcc_lo
s_cmp_ge_u32 s64,8
s_cbranch_scc1 hg_66
buffer_load_dword v248,v18,s[20:23],s70 offen offset:0 sc1
s_waitcnt vmcnt(1)
v_cmp_eq_u32 vcc,v25,v249
s_bcnt1_i32_b32 s64,vcc_lo
s_cmp_ge_u32 s64,8
s_cbranch_scc1 hg_66
s_sub_u32 s90,s90,1
s_cmp_gt_i32 s90,0
s_cbranch_scc1 hl_65
hg_66:
buffer_load_dwordx4 v[32:35],v26,s[20:23],s70 offen offset:0 sc1
buffer_load_dwordx4 v[36:39],v26,s[20:23],s70 offen offset:1024 sc1
buffer_load_dwordx4 v[40:43],v26,s[20:23],s70 offen offset:2048 sc1
buffer_load_dwordx4 v[44:47],v26,s[20:23],s70 offen offset:3072 sc1
s_waitcnt vmcnt(3)
ds_write_b128 v24,v[32:35] offset:0
v_min3_u32 v22,v32,v33,v34
v_min_u32 v22,v22,v35
s_waitcnt vmcnt(2)
ds_write_b128 v24,v[36:39] offset:1024
v_min3_u32 v22,v22,v36,v37
v_min3_u32 v22,v22,v38,v39
s_waitcnt vmcnt(1)
ds_write_b128 v24,v[40:43] offset:2048
v_min3_u32 v22,v22,v40,v41
v_min3_u32 v22,v22,v42,v43
s_waitcnt vmcnt(0)
ds_write_b128 v24,v[44:47] offset:3072
v_min3_u32 v22,v22,v44,v45
v_min3_u32 v22,v22,v46,v47
v_cmp_eq_u32 vcc,0,v22
s_cbranch_vccnz art_67
abk_68:
v_smfmac_f32_16x16x64_bf16 v[176:179],v[32:35],a[0:7],v14
s_waitcnt lgkmcnt(0)
s_barrier
ds_read_b128 v[48:51],v24 offset:4096
ds_read_b128 v[52:55],v24 offset:5120
ds_read_b128 v[56:59],v24 offset:6144
ds_read_b128 v[60:63],v24 offset:7168
v_smfmac_f32_16x16x64_bf16 v[176:179],v[36:39],a[8:15],v14
ds_read_b128 v[64:67],v24 offset:8192
ds_read_b128 v[68:71],v24 offset:9216
v_smfmac_f32_16x16x64_bf16 v[176:179],v[40:43],a[16:23],v14
ds_read_b128 v[72:75],v24 offset:10240
ds_read_b128 v[76:79],v24 offset:11264
v_smfmac_f32_16x16x64_bf16 v[176:179],v[44:47],a[24:31],v14
ds_read_b128 v[80:83],v24 offset:12288
ds_read_b128 v[84:87],v24 offset:13312
s_waitcnt lgkmcnt(9)
v_smfmac_f32_16x16x64_bf16 v[176:179],v[48:51],a[32:39],v14
ds_read_b128 v[88:91],v24 offset:14336
s_waitcnt lgkmcnt(9)
v_smfmac_f32_16x16x64_bf16 v[176:179],v[52:55],a[40:47],v14
ds_read_b128 v[92:95],v24 offset:15360
s_waitcnt lgkmcnt(9)
v_smfmac_f32_16x16x64_bf16 v[176:179],v[56:59],a[48:55],v14
s_waitcnt lgkmcnt(8)
v_smfmac_f32_16x16x64_bf16 v[176:179],v[60:63],a[56:63],v14
s_waitcnt lgkmcnt(7)
v_smfmac_f32_16x16x64_bf16 v[176:179],v[64:67],a[64:71],v14
s_waitcnt lgkmcnt(6)
v_smfmac_f32_16x16x64_bf16 v[176:179],v[68:71],a[72:79],v14
s_waitcnt lgkmcnt(5)
v_smfmac_f32_16x16x64_bf16 v[176:179],v[72:75],a[80:87],v14
s_waitcnt lgkmcnt(4)
v_smfmac_f32_16x16x64_bf16 v[176:179],v[76:79],a[88:95],v14
s_waitcnt lgkmcnt(3)
v_smfmac_f32_16x16x64_bf16 v[176:179],v[80:83],a[96:103],v14
s_waitcnt lgkmcnt(2)
v_smfmac_f32_16x16x64_bf16 v[176:179],v[84:87],a[104:111],v14
s_waitcnt lgkmcnt(1)
v_smfmac_f32_16x16x64_bf16 v[176:179],v[88:91],a[112:119],v14
s_waitcnt lgkmcnt(0)
v_smfmac_f32_16x16x64_bf16 v[176:179],v[92:95],a[120:127],v14
s_nop 7
v_permlane32_swap_b32 v176,v178
v_permlane32_swap_b32 v177,v179
v_add_f32 v176,v176,v178
v_add_f32 v177,v177,v179
v_cvt_pk_bf16_f32 v216,v176,v177
s_nop 1
v_mov_b32_dpp v217,v216 quad_perm:[1,0,3,2] row_mask:0xf bank_mask:0xf
v_perm_b32 v216,v217,v216,v15
v_max_u32 v216,1,v216
buffer_store_dword v216,v19,s[24:27],s70 offen
buffer_store_dword v216,v19,s[28:31],s70 offen sc1
s_lshr_b32 s64,s70,9
v_add_u32 v22,s64,v24
s_cmp_eq_u32 s79,0
ds_read_b128 v[128:131],v22 offset:16384
ds_read_b128 v[132:135],v22 offset:17408
s_cbranch_scc1 kt0_69
kt0b_70:
s_nop 15
s_nop 12
buffer_load_dwordx4 v[32:35],v8,s[20:23],s70 offen sc1
buffer_load_dwordx4 v[36:39],v9,s[20:23],s70 offen sc1
buffer_load_dwordx4 v[40:43],v10,s[20:23],s70 offen sc1
buffer_load_dwordx4 v[44:47],v11,s[20:23],s70 offen sc1
s_nop 9
scp_71:
buffer_load_dwordx4 v[48:51],v8,s[20:23],s70 offen sc1
buffer_load_dwordx4 v[52:55],v9,s[20:23],s70 offen sc1
buffer_load_dwordx4 v[56:59],v10,s[20:23],s70 offen sc1
buffer_load_dwordx4 v[60:63],v11,s[20:23],s70 offen sc1
s_waitcnt vmcnt(4)
v_mfma_f32_16x16x32_bf16 v[168:171],v[32:35],v[32:35],v[156:159]
v_min3_u32 v22,v32,v33,v34
v_min3_u32 v22,v22,v35,v36
v_mfma_f32_16x16x32_bf16 v[164:167],v[100:103],v[32:35],0
v_min3_u32 v22,v22,v37,v38
v_min3_u32 v22,v22,v39,v40
v_mfma_f32_16x16x32_bf16 v[160:163],v[96:99],v[32:35],0
v_min3_u32 v22,v22,v41,v42
v_min3_u32 v22,v22,v43,v44
v_mfma_f32_16x16x32_bf16 v[168:171],v[36:39],v[36:39],v[168:171]
v_min3_u32 v22,v22,v45,v46
v_min_u32 v22,v22,v47
v_mfma_f32_16x16x32_bf16 v[164:167],v[108:111],v[36:39],v[164:167]
v_cmp_eq_u32 vcc,0,v22
s_cbranch_vccnz nx_73
v_mfma_f32_16x16x32_bf16 v[160:163],v[104:107],v[36:39],v[160:163]
v_mov_b32 v172,v32
v_mfma_f32_16x16x32_bf16 v[168:171],v[40:43],v[40:43],v[168:171]
v_mov_b32 v173,v33
v_mfma_f32_16x16x32_bf16 v[164:167],v[116:119],v[40:43],v[164:167]
v_mov_b32 v174,v34
v_mfma_f32_16x16x32_bf16 v[160:163],v[112:115],v[40:43],v[160:163]
v_mov_b32 v175,v35
v_mfma_f32_16x16x32_bf16 v[168:171],v[44:47],v[44:47],v[168:171]
v_mfma_f32_16x16x32_bf16 v[164:167],v[124:127],v[44:47],v[164:167]
v_mfma_f32_16x16x32_bf16 v[160:163],v[120:123],v[44:47],v[160:163]
s_nop 1
s_branch scok_72
nx_73:
buffer_load_dwordx4 v[32:35],v8,s[20:23],s70 offen sc1
buffer_load_dwordx4 v[36:39],v9,s[20:23],s70 offen sc1
buffer_load_dwordx4 v[40:43],v10,s[20:23],s70 offen sc1
buffer_load_dwordx4 v[44:47],v11,s[20:23],s70 offen sc1
s_waitcnt vmcnt(4)
v_mfma_f32_16x16x32_bf16 v[168:171],v[48:51],v[48:51],v[156:159]
v_min3_u32 v22,v48,v49,v50
v_min3_u32 v22,v22,v51,v52
v_mfma_f32_16x16x32_bf16 v[164:167],v[100:103],v[48:51],0
v_min3_u32 v22,v22,v53,v54
v_min3_u32 v22,v22,v55,v56
v_mfma_f32_16x16x32_bf16 v[160:163],v[96:99],v[48:51],0
v_min3_u32 v22,v22,v57,v58
v_min3_u32 v22,v22,v59,v60
v_mfma_f32_16x16x32_bf16 v[168:171],v[52:55],v[52:55],v[168:171]
v_min3_u32 v22,v22,v61,v62
v_min_u32 v22,v22,v63
v_mfma_f32_16x16x32_bf16 v[164:167],v[108:111],v[52:55],v[164:167]
v_cmp_eq_u32 vcc,0,v22
s_cbranch_vccnz nx_74
v_mfma_f32_16x16x32_bf16 v[160:163],v[104:107],v[52:55],v[160:163]
v_mov_b32 v172,v48
v_mfma_f32_16x16x32_bf16 v[168:171],v[56:59],v[56:59],v[168:171]
v_mov_b32 v173,v49
v_mfma_f32_16x16x32_bf16 v[164:167],v[116:119],v[56:59],v[164:167]
v_mov_b32 v174,v50
v_mfma_f32_16x16x32_bf16 v[160:163],v[112:115],v[56:59],v[160:163]
v_mov_b32 v175,v51
v_mfma_f32_16x16x32_bf16 v[168:171],v[60:63],v[60:63],v[168:171]
v_mfma_f32_16x16x32_bf16 v[164:167],v[124:127],v[60:63],v[164:167]
v_mfma_f32_16x16x32_bf16 v[160:163],v[120:123],v[60:63],v[160:163]
s_nop 1
s_branch scok_72
nx_74:
s_sub_u32 s90,s90,1
s_cmp_gt_i32 s90,0
s_cbranch_scc1 scp_71
s_nop 7
scok_72:
ds_read_b64 v[220:221],v21
ds_read_b64 v[136:137],v31
ds_read_b64 v[140:141],v31 offset:256
s_cmp_ge_u32 s79,62
s_cbranch_scc1 ke_76
keb_77:
v_max3_f32 v216,v168,v169,v170
v_mov_b32_dpp v160,v164 row_ror:8 row_mask:0xf bank_mask:0xc
v_mov_b32_dpp v161,v165 row_ror:8 row_mask:0xf bank_mask:0xc
v_mov_b32_dpp v162,v166 row_ror:8 row_mask:0xf bank_mask:0xc
v_mov_b32_dpp v163,v167 row_ror:8 row_mask:0xf bank_mask:0xc
v_max3_f32 v217,v171,v160,v161
v_max3_f32 v216,v216,v162,v163
v_max_f32 v216,v216,v217
s_nop 1
v_max_f32_dpp v216,v216,v216 row_ror:8 row_mask:0xf bank_mask:0xf
v_mov_b32 v217,v216
s_nop 1
v_permlane16_swap_b32 v217,v216
v_max_f32 v216,v216,v217
v_mov_b32 v217,v216
s_nop 1
v_permlane32_swap_b32 v217,v216
v_max_f32 v216,v216,v217
v_mul_f32 v216,s81,v216
v_fma_f32 v160,v160,s81,-v216
v_fma_f32 v161,v161,s81,-v216
v_fma_f32 v162,v162,s81,-v216
v_fma_f32 v163,v163,s81,-v216
v_fma_f32 v168,v168,s81,-v216
v_fma_f32 v169,v169,s81,-v216
v_fma_f32 v170,v170,s81,-v216
v_fma_f32 v171,v171,s81,-v216
v_exp_f32 v160,v160
v_exp_f32 v161,v161
v_exp_f32 v162,v162
v_exp_f32 v163,v163
v_exp_f32 v168,v168
v_exp_f32 v169,v169
v_exp_f32 v170,v170
v_exp_f32 v171,v171
v_cvt_pk_bf16_f32 v148,v160,v161
v_cvt_pk_bf16_f32 v149,v162,v163
v_cvt_pk_bf16_f32 v144,v168,v169
v_mov_b32_dpp v150,v148 row_ror:8 row_mask:0xf bank_mask:0xf
v_mov_b32_dpp v151,v149 row_ror:8 row_mask:0xf bank_mask:0xf
v_cvt_pk_bf16_f32 v145,v170,v171
s_waitcnt lgkmcnt(0)
v_min_u32 v220,v220,v221
v_mfma_f32_16x16x32_bf16 v[232:235],v[152:155],v[148:151],0
v_cmp_ne_u32 vcc,v220,v25
v_mfma_f32_16x16x32_bf16 v[232:235],v[152:155],v[144:147],v[232:235]
v_mfma_f32_16x16x32_bf16 v[224:227],v[128:131],v[148:151],0
v_mfma_f32_16x16x32_bf16 v[228:231],v[132:135],v[148:151],0
s_cbranch_vccnz vw_78
vb_79:
v_mfma_f32_16x16x32_bf16 v[224:227],v[136:139],v[144:147],v[224:227]
v_mfma_f32_16x16x32_bf16 v[228:231],v[140:143],v[144:147],v[228:231]
s_mov_b64 exec,s[84:85]
s_nop 1
v_rcp_f32 v236,v232
s_nop 2
v_pk_mul_f32 v[224:225],v[224:225],v[236:237] op_sel_hi:[1,0]
v_pk_mul_f32 v[226:227],v[226:227],v[236:237] op_sel_hi:[1,0]
v_pk_mul_f32 v[228:229],v[228:229],v[236:237] op_sel_hi:[1,0]
v_pk_mul_f32 v[230:231],v[230:231],v[236:237] op_sel_hi:[1,0]
v_cvt_pk_bf16_f32 v216,v224,v225
v_cvt_pk_bf16_f32 v217,v226,v227
v_cvt_pk_bf16_f32 v218,v228,v229
v_cvt_pk_bf16_f32 v219,v230,v231
v_max_u32 v216,1,v216
v_max_u32 v217,1,v217
v_max_u32 v218,1,v218
v_max_u32 v219,1,v219
buffer_store_dwordx4 v[216:219],v30,s[24:27],s71 offen
buffer_store_dwordx4 v[216:219],v30,s[28:31],s71 offen sc1
s_mov_b64 exec,1
buffer_store_dword v25,v13,s[24:27],s70 offen offset:512
buffer_store_dword v25,v13,s[28:31],s70 offen offset:512 sc1
s_mov_b64 exec,-1
ds_write_b32 v21,v25 offset:8
hl_80:
buffer_load_dword v248,v18,s[20:23],s70 offen offset:512 sc1
s_waitcnt vmcnt(0)
v_cmp_eq_u32 vcc,v25,v248
s_bcnt1_i32_b32 s64,vcc_lo
s_cmp_ge_u32 s64,16
s_cbranch_scc1 hg_81
s_sub_u32 s90,s90,1
s_cmp_gt_i32 s90,0
s_cbranch_scc1 hl_80
hg_81:
buffer_load_dwordx4 v[32:35],v26,s[20:23],s71 offen offset:0 sc1
buffer_load_dwordx4 v[36:39],v26,s[20:23],s71 offen offset:1024 sc1
buffer_load_dwordx4 v[40:43],v26,s[20:23],s71 offen offset:2048 sc1
buffer_load_dwordx4 v[44:47],v26,s[20:23],s71 offen offset:3072 sc1
buffer_load_dwordx4 v[48:51],v27,s[20:23],s71 offen offset:0 sc1
buffer_load_dwordx4 v[52:55],v27,s[20:23],s71 offen offset:1024 sc1
buffer_load_dwordx4 v[56:59],v27,s[20:23],s71 offen offset:2048 sc1
buffer_load_dwordx4 v[60:63],v27,s[20:23],s71 offen offset:3072 sc1
s_mov_b32 s68,0
s_waitcnt vmcnt(6)
v_smfmac_f32_16x16x64_bf16 v[184:187],v[32:35],a[128:135],v14
v_min3_u32 v22,v32,v33,v34
v_min3_u32 v22,v22,v35,v36
v_smfmac_f32_16x16x64_bf16 v[188:191],v[32:35],a[136:143],v14
v_min3_u32 v22,v22,v37,v38
v_smfmac_f32_16x16x64_bf16 v[184:187],v[36:39],a[144:151],v14
v_min_u32 v22,v22,v39
v_smfmac_f32_16x16x64_bf16 v[188:191],v[36:39],a[152:159],v14
v_cmp_eq_u32 s[52:53],0,v22
s_waitcnt vmcnt(4)
v_smfmac_f32_16x16x64_bf16 v[184:187],v[40:43],a[160:167],v14
v_min3_u32 v22,v40,v41,v42
s_cmp_lg_u64 s[52:53],0
v_smfmac_f32_16x16x64_bf16 v[188:191],v[40:43],a[168:175],v14
s_cbranch_scc1 ms_82
bk_83:
v_min3_u32 v22,v22,v43,v44
v_smfmac_f32_16x16x64_bf16 v[184:187],v[44:47],a[176:183],v14
v_min3_u32 v22,v22,v45,v46
v_min_u32 v22,v22,v47
v_smfmac_f32_16x16x64_bf16 v[188:191],v[44:47],a[184:191],v14
v_cmp_eq_u32 s[54:55],0,v22
s_waitcnt vmcnt(2)
v_smfmac_f32_16x16x64_bf16 v[184:187],v[48:51],a[192:199],v14
v_min3_u32 v22,v48,v49,v50
s_cmp_lg_u64 s[54:55],0
v_smfmac_f32_16x16x64_bf16 v[188:191],v[48:51],a[200:207],v14
s_cbranch_scc1 ms_84
bk_85:
v_min3_u32 v22,v22,v51,v52
v_smfmac_f32_16x16x64_bf16 v[184:187],v[52:55],a[208:215],v14
v_min3_u32 v22,v22,v53,v54
v_min_u32 v22,v22,v55
v_smfmac_f32_16x16x64_bf16 v[188:191],v[52:55],a[216:223],v14
v_cmp_eq_u32 s[52:53],0,v22
s_waitcnt vmcnt(0)
v_smfmac_f32_16x16x64_bf16 v[184:187],v[56:59],a[224:231],v14
v_min3_u32 v22,v56,v57,v58
s_cmp_lg_u64 s[52:53],0
v_smfmac_f32_16x16x64_bf16 v[188:191],v[56:59],a[232:239],v14
s_cbranch_scc1 ms_86
bk_87:
v_min3_u32 v22,v22,v59,v60
v_smfmac_f32_16x16x64_bf16 v[184:187],v[60:63],a[240:247],v14
v_min3_u32 v22,v22,v61,v62
v_min_u32 v22,v22,v63
v_smfmac_f32_16x16x64_bf16 v[188:191],v[60:63],a[248:255],v14
v_cmp_eq_u32 s[54:55],0,v22
s_cmp_lg_u64 s[54:55],0
s_cbranch_scc1 ms_90
bk_91:
s_cmp_lg_u32 s68,0
s_cbranch_scc1 rl2_92
fin_88:
s_nop 2
v_permlane32_swap_b32 v184,v188
v_permlane32_swap_b32 v185,v189
v_permlane32_swap_b32 v186,v190
v_permlane32_swap_b32 v187,v191
v_pk_add_f32 v[184:185],v[184:185],v[188:189]
v_pk_add_f32 v[186:187],v[186:187],v[190:191]
ds_write_b128 v24,v[184:187] offset:25600
ds_write_b32 v21,v25 offset:12
s_mov_b64 exec,s[84:85]
ds_read_b128 v[172:175],v12
s_mov_b64 exec,-1
ds_read_b64 v[220:221],v21 offset:24
buffer_load_dwordx4 v[96:99],v2,s[20:23],s72 offen offset:0 sc1
buffer_load_dwordx4 v[100:103],v2,s[20:23],s72 offen offset:1024 sc1
buffer_load_dwordx4 v[104:107],v5,s[20:23],s72 offen offset:0 sc1
buffer_load_dwordx4 v[108:111],v5,s[20:23],s72 offen offset:1024 sc1
buffer_load_dwordx4 v[112:115],v6,s[20:23],s72 offen offset:0 sc1
buffer_load_dwordx4 v[116:119],v6,s[20:23],s72 offen offset:1024 sc1
buffer_load_dwordx4 v[120:123],v7,s[20:23],s72 offen offset:0 sc1
buffer_load_dwordx4 v[124:127],v7,s[20:23],s72 offen offset:1024 sc1
s_waitcnt lgkmcnt(0)
v_min_u32 v220,v220,v221
v_cmp_ne_u32 vcc,v220,v25
s_cbranch_vccnz v2w_93
v2b_94:
buffer_store_dwordx4 v[172:175],v3,s[20:23],s77 offen sc1
s_xor_b32 s62,s62,0x10000
s_add_u32 s63,s79,1
s_and_b32 s64,s63,3
s_lshl_b32 s70,s64,20
s_add_u32 s65,s63,2
s_and_b32 s65,s65,3
s_lshl_b32 s73,s65,20
s_add_u32 s55,s63,3
s_lshl_b32 s78,s55,16
s_add_u32 s78,s78,57344
s_cmp_lt_u32 s55,64
s_cselect_b32 s78,s78,0x7fff0000
s_add_u32 s71,s70,65536
s_add_u32 s60,s63,1
s_and_b32 s60,s60,3
s_lshl_b32 s72,s60,20
v_mov_b32 v184,0
v_mov_b32 v185,0
v_mov_b32 v186,0
v_mov_b32 v187,0
v_mov_b32 v188,0
v_mov_b32 v189,0
v_mov_b32 v190,0
v_mov_b32 v191,0
s_lshl_b32 s77,s63,21
s_lshl_b32 s55,s63,13
s_and_b32 s55,s55,0x2000
s_xor_b32 s55,s55,s61
s_add_u32 s77,s77,s55
v_mov_b32 v176,0
v_mov_b32 v177,0
v_mov_b32 v178,0
v_mov_b32 v179,0
s_add_u32 s79,s79,1
v_add_u32 v25,1,v25
s_waitcnt vmcnt(0) lgkmcnt(0)
s_branch loop_63
last0_75:
wf_95:
ds_read_b32 v23,v21 offset:0
s_sub_u32 s90,s90,1
s_waitcnt lgkmcnt(0)
v_cmp_ne_u32 vcc,v23,v25
s_cmp_lt_i32 s90,0
s_cselect_b64 vcc,0,vcc
s_cbranch_vccnz wf_95
wf_96:
ds_read_b32 v23,v21 offset:4
s_sub_u32 s90,s90,1
s_waitcnt lgkmcnt(0)
v_cmp_ne_u32 vcc,v23,v25
s_cmp_lt_i32 s90,0
s_cselect_b64 vcc,0,vcc
s_cbranch_vccnz wf_96
s_mov_b64 exec,s[84:85]
ds_read_b128 v[172:175],v12
s_mov_b64 exec,-1
s_waitcnt lgkmcnt(0)
buffer_store_dwordx4 v[172:175],v3,s[20:23],s77 offen sc1
s_branch end_57
art_67:
s_sub_u32 s90,s90,1
s_cmp_lt_i32 s90,0
s_cbranch_scc1 abk_68
buffer_load_dwordx4 v[32:35],v26,s[20:23],s70 offen offset:0 sc1
buffer_load_dwordx4 v[36:39],v26,s[20:23],s70 offen offset:1024 sc1
buffer_load_dwordx4 v[40:43],v26,s[20:23],s70 offen offset:2048 sc1
buffer_load_dwordx4 v[44:47],v26,s[20:23],s70 offen offset:3072 sc1
s_waitcnt vmcnt(3)
ds_write_b128 v24,v[32:35] offset:0
v_min3_u32 v22,v32,v33,v34
v_min_u32 v22,v22,v35
s_waitcnt vmcnt(2)
ds_write_b128 v24,v[36:39] offset:1024
v_min3_u32 v22,v22,v36,v37
v_min3_u32 v22,v22,v38,v39
s_waitcnt vmcnt(1)
ds_write_b128 v24,v[40:43] offset:2048
v_min3_u32 v22,v22,v40,v41
v_min3_u32 v22,v22,v42,v43
s_waitcnt vmcnt(0)
ds_write_b128 v24,v[44:47] offset:3072
v_min3_u32 v22,v22,v44,v45
v_min3_u32 v22,v22,v46,v47
v_cmp_eq_u32 vcc,0,v22
s_cbranch_vccnz art_67
s_branch abk_68
kt0_69:
buffer_load_dwordx4 v[96:99],v2,s[20:23],s70 offen offset:0 sc1
buffer_load_dwordx4 v[100:103],v2,s[20:23],s70 offen offset:1024 sc1
buffer_load_dwordx4 v[104:107],v5,s[20:23],s70 offen offset:0 sc1
buffer_load_dwordx4 v[108:111],v5,s[20:23],s70 offen offset:1024 sc1
buffer_load_dwordx4 v[112:115],v6,s[20:23],s70 offen offset:0 sc1
buffer_load_dwordx4 v[116:119],v6,s[20:23],s70 offen offset:1024 sc1
buffer_load_dwordx4 v[120:123],v7,s[20:23],s70 offen offset:0 sc1
buffer_load_dwordx4 v[124:127],v7,s[20:23],s70 offen offset:1024 sc1
s_branch kt0b_70
ke_76:
s_cmp_eq_u32 s79,63
s_cbranch_scc1 last0_75
ds_read_b64 v[222:223],v21 offset:24
s_mov_b64 exec,s[84:85]
ds_read_b128 v[172:175],v12
s_mov_b64 exec,-1
s_waitcnt lgkmcnt(0)
v_min3_u32 v222,v222,v223,v220
v_min_u32 v222,v222,v221
v_cmp_ne_u32 vcc,v222,v25
s_cbranch_vccnz keb_77
buffer_store_dwordx4 v[172:175],v3,s[20:23],s77 offen sc1
s_mov_b32 s77,0x7fff0000
s_branch keb_77
vw_78:
wf_97:
ds_read_b32 v23,v21 offset:0
s_sub_u32 s90,s90,1
s_waitcnt lgkmcnt(0)
v_cmp_ne_u32 vcc,v23,v25
s_cmp_lt_i32 s90,0
s_cselect_b64 vcc,0,vcc
s_cbranch_vccnz wf_97
wf_98:
ds_read_b32 v23,v21 offset:4
s_sub_u32 s90,s90,1
s_waitcnt lgkmcnt(0)
v_cmp_ne_u32 vcc,v23,v25
s_cmp_lt_i32 s90,0
s_cselect_b64 vcc,0,vcc
s_cbranch_vccnz wf_98
ds_read_b64 v[220:221],v21
ds_read_b64 v[136:137],v31
ds_read_b64 v[140:141],v31 offset:256
s_waitcnt lgkmcnt(0)
s_branch vb_79
ms_82:
s_waitcnt vmcnt(0)
buffer_load_dwordx4 v[64:67],v26,s[20:23],s71 offen offset:0 sc1
buffer_load_dwordx4 v[68:71],v26,s[20:23],s71 offen offset:1024 sc1
s_bitset1_b32 s68,0
s_branch bk_83
ms_84:
s_waitcnt vmcnt(0)
buffer_load_dwordx4 v[72:75],v26,s[20:23],s71 offen offset:2048 sc1
buffer_load_dwordx4 v[76:79],v26,s[20:23],s71 offen offset:3072 sc1
s_bitset1_b32 s68,1
s_branch bk_85
ms_86:
s_waitcnt vmcnt(0)
buffer_load_dwordx4 v[80:83],v27,s[20:23],s71 offen offset:0 sc1
buffer_load_dwordx4 v[84:87],v27,s[20:23],s71 offen offset:1024 sc1
s_bitset1_b32 s68,2
s_branch bk_87
ms_90:
s_waitcnt vmcnt(0)
buffer_load_dwordx4 v[88:91],v27,s[20:23],s71 offen offset:2048 sc1
buffer_load_dwordx4 v[92:95],v27,s[20:23],s71 offen offset:3072 sc1
s_bitset1_b32 s68,3
s_branch bk_91
rl_89:
s_bitcmp1_b32 s68,0
s_cbranch_scc0 sk_99
buffer_load_dwordx4 v[64:67],v26,s[20:23],s71 offen offset:0 sc1
buffer_load_dwordx4 v[68:71],v26,s[20:23],s71 offen offset:1024 sc1
sk_99:
s_bitcmp1_b32 s68,1
s_cbranch_scc0 sk_100
buffer_load_dwordx4 v[72:75],v26,s[20:23],s71 offen offset:2048 sc1
buffer_load_dwordx4 v[76:79],v26,s[20:23],s71 offen offset:3072 sc1
sk_100:
s_bitcmp1_b32 s68,2
s_cbranch_scc0 sk_101
buffer_load_dwordx4 v[80:83],v27,s[20:23],s71 offen offset:0 sc1
buffer_load_dwordx4 v[84:87],v27,s[20:23],s71 offen offset:1024 sc1
sk_101:
s_bitcmp1_b32 s68,3
s_cbranch_scc0 sk_102
buffer_load_dwordx4 v[88:91],v27,s[20:23],s71 offen offset:2048 sc1
buffer_load_dwordx4 v[92:95],v27,s[20:23],s71 offen offset:3072 sc1
sk_102:
rl2_92:
s_sub_u32 s90,s90,1
s_cmp_lt_i32 s90,0
s_cbranch_scc1 fin_88
s_waitcnt vmcnt(0)
s_bitcmp1_b32 s68,0
s_cbranch_scc0 sk_103
v_min3_u32 v22,v64,v65,v66
v_min3_u32 v22,v22,v67,v68
v_min3_u32 v22,v22,v69,v70
v_min_u32 v22,v22,v71
v_cmp_eq_u32 vcc,0,v22
v_xor_b32 v64,v32,v64
v_xor_b32 v65,v33,v65
v_xor_b32 v66,v34,v66
v_xor_b32 v67,v35,v67
v_xor_b32 v68,v36,v68
v_xor_b32 v69,v37,v69
v_xor_b32 v70,v38,v70
v_xor_b32 v71,v39,v71
s_cbranch_vccnz nb_104
s_bitset0_b32 s68,0
v_smfmac_f32_16x16x64_bf16 v[184:187],v[64:67],a[128:135],v14
v_smfmac_f32_16x16x64_bf16 v[188:191],v[64:67],a[136:143],v14
v_smfmac_f32_16x16x64_bf16 v[184:187],v[68:71],a[144:151],v14
v_smfmac_f32_16x16x64_bf16 v[188:191],v[68:71],a[152:159],v14
nb_104:
sk_103:
s_bitcmp1_b32 s68,1
s_cbranch_scc0 sk_105
v_min3_u32 v22,v72,v73,v74
v_min3_u32 v22,v22,v75,v76
v_min3_u32 v22,v22,v77,v78
v_min_u32 v22,v22,v79
v_cmp_eq_u32 vcc,0,v22
v_xor_b32 v72,v40,v72
v_xor_b32 v73,v41,v73
v_xor_b32 v74,v42,v74
v_xor_b32 v75,v43,v75
v_xor_b32 v76,v44,v76
v_xor_b32 v77,v45,v77
v_xor_b32 v78,v46,v78
v_xor_b32 v79,v47,v79
s_cbranch_vccnz nb_106
s_bitset0_b32 s68,1
v_smfmac_f32_16x16x64_bf16 v[184:187],v[72:75],a[160:167],v14
v_smfmac_f32_16x16x64_bf16 v[188:191],v[72:75],a[168:175],v14
v_smfmac_f32_16x16x64_bf16 v[184:187],v[76:79],a[176:183],v14
v_smfmac_f32_16x16x64_bf16 v[188:191],v[76:79],a[184:191],v14
nb_106:
sk_105:
s_bitcmp1_b32 s68,2
s_cbranch_scc0 sk_107
v_min3_u32 v22,v80,v81,v82
v_min3_u32 v22,v22,v83,v84
v_min3_u32 v22,v22,v85,v86
v_min_u32 v22,v22,v87
v_cmp_eq_u32 vcc,0,v22
v_xor_b32 v80,v48,v80
v_xor_b32 v81,v49,v81
v_xor_b32 v82,v50,v82
v_xor_b32 v83,v51,v83
v_xor_b32 v84,v52,v84
v_xor_b32 v85,v53,v85
v_xor_b32 v86,v54,v86
v_xor_b32 v87,v55,v87
s_cbranch_vccnz nb_108
s_bitset0_b32 s68,2
v_smfmac_f32_16x16x64_bf16 v[184:187],v[80:83],a[192:199],v14
v_smfmac_f32_16x16x64_bf16 v[188:191],v[80:83],a[200:207],v14
v_smfmac_f32_16x16x64_bf16 v[184:187],v[84:87],a[208:215],v14
v_smfmac_f32_16x16x64_bf16 v[188:191],v[84:87],a[216:223],v14
nb_108:
sk_107:
s_bitcmp1_b32 s68,3
s_cbranch_scc0 sk_109
v_min3_u32 v22,v88,v89,v90
v_min3_u32 v22,v22,v91,v92
v_min3_u32 v22,v22,v93,v94
v_min_u32 v22,v22,v95
v_cmp_eq_u32 vcc,0,v22
v_xor_b32 v88,v56,v88
v_xor_b32 v89,v57,v89
v_xor_b32 v90,v58,v90
v_xor_b32 v91,v59,v91
v_xor_b32 v92,v60,v92
v_xor_b32 v93,v61,v93
v_xor_b32 v94,v62,v94
v_xor_b32 v95,v63,v95
s_cbranch_vccnz nb_110
s_bitset0_b32 s68,3
v_smfmac_f32_16x16x64_bf16 v[184:187],v[88:91],a[224:231],v14
v_smfmac_f32_16x16x64_bf16 v[188:191],v[88:91],a[232:239],v14
v_smfmac_f32_16x16x64_bf16 v[184:187],v[92:95],a[240:247],v14
v_smfmac_f32_16x16x64_bf16 v[188:191],v[92:95],a[248:255],v14
nb_110:
sk_109:
s_cmp_lg_u32 s68,0
s_cbranch_scc1 rl_89
s_nop 2
s_branch fin_88
v2w_93:
wf_111:
ds_read_b32 v23,v21 offset:24
s_sub_u32 s90,s90,1
s_waitcnt lgkmcnt(0)
v_cmp_ne_u32 vcc,v23,v25
s_cmp_lt_i32 s90,0
s_cselect_b64 vcc,0,vcc
s_cbranch_vccnz wf_111
wf_112:
ds_read_b32 v23,v21 offset:28
s_sub_u32 s90,s90,1
s_waitcnt lgkmcnt(0)
v_cmp_ne_u32 vcc,v23,v25
s_cmp_lt_i32 s90,0
s_cselect_b64 vcc,0,vcc
s_cbranch_vccnz wf_112
s_branch v2b_94
first_62:
s_waitcnt vmcnt(0) lgkmcnt(0)
s_barrier
s_add_u32 s64,s15,393216
buffer_load_dwordx4 a[176:179],v32,s[40:43],s64 offen nt
s_add_u32 s64,s15,425984
buffer_load_dwordx4 a[180:183],v32,s[40:43],s64 offen nt
s_add_u32 s64,s15,458752
buffer_load_dwordx4 a[184:187],v32,s[40:43],s64 offen nt
s_add_u32 s64,s15,491520
buffer_load_dwordx4 a[188:191],v32,s[40:43],s64 offen nt
s_add_u32 s64,s15,524288
buffer_load_dwordx4 a[192:195],v32,s[40:43],s64 offen nt
s_add_u32 s64,s15,557056
buffer_load_dwordx4 a[196:199],v32,s[40:43],s64 offen nt
s_add_u32 s64,s15,589824
buffer_load_dwordx4 a[200:203],v32,s[40:43],s64 offen nt
s_add_u32 s64,s15,622592
buffer_load_dwordx4 a[204:207],v32,s[40:43],s64 offen nt
s_add_u32 s64,s15,655360
buffer_load_dwordx4 a[208:211],v32,s[40:43],s64 offen nt
s_add_u32 s64,s15,688128
buffer_load_dwordx4 a[212:215],v32,s[40:43],s64 offen nt
s_add_u32 s64,s15,720896
buffer_load_dwordx4 a[216:219],v32,s[40:43],s64 offen nt
s_add_u32 s64,s15,753664
buffer_load_dwordx4 a[220:223],v32,s[40:43],s64 offen nt
s_add_u32 s64,s15,786432
buffer_load_dwordx4 a[224:227],v32,s[40:43],s64 offen nt
s_add_u32 s64,s15,819200
buffer_load_dwordx4 a[228:231],v32,s[40:43],s64 offen nt
s_add_u32 s64,s15,851968
buffer_load_dwordx4 a[232:235],v32,s[40:43],s64 offen nt
s_add_u32 s64,s15,884736
buffer_load_dwordx4 a[236:239],v32,s[40:43],s64 offen nt
s_add_u32 s64,s15,917504
buffer_load_dwordx4 a[240:243],v32,s[40:43],s64 offen nt
s_add_u32 s64,s15,950272
buffer_load_dwordx4 a[244:247],v32,s[40:43],s64 offen nt
s_add_u32 s64,s15,983040
buffer_load_dwordx4 a[248:251],v32,s[40:43],s64 offen nt
s_add_u32 s64,s15,1015808
buffer_load_dwordx4 a[252:255],v32,s[40:43],s64 offen nt
ds_write_b128 v33,a[0:3] offset:0
ds_write_b128 v33,a[4:7] offset:1024
ds_write_b128 v33,a[8:11] offset:2048
ds_write_b128 v33,a[12:15] offset:3072
s_waitcnt lgkmcnt(0)
v_mov_b32 v38,1
ds_write_b32 v37,v38 offset:0
qs_113:
ds_read_b32 v39,v37 offset:4
s_sub_u32 s90,s90,1
s_waitcnt lgkmcnt(0)
v_cmp_gt_u32 vcc,v38,v39
s_cmp_lt_i32 s90,0
s_cselect_b64 vcc,0,vcc
s_cbranch_vccnz qs_113
ds_read_b64_tr_b16 a[0:1],v36 offset:0
ds_read_b64_tr_b16 a[2:3],v36 offset:128
ds_read_b64_tr_b16 a[4:5],v36 offset:2048
ds_read_b64_tr_b16 a[6:7],v36 offset:2176
ds_read_b64_tr_b16 a[8:9],v36 offset:8192
ds_read_b64_tr_b16 a[10:11],v36 offset:8320
ds_read_b64_tr_b16 a[12:13],v36 offset:10240
ds_read_b64_tr_b16 a[14:15],v36 offset:10368
ds_write_b128 v33,a[16:19] offset:4096
ds_write_b128 v33,a[20:23] offset:5120
ds_write_b128 v33,a[24:27] offset:6144
ds_write_b128 v33,a[28:31] offset:7168
s_waitcnt lgkmcnt(0)
v_mov_b32 v38,2
ds_write_b32 v37,v38 offset:0
qs_114:
ds_read_b32 v39,v37 offset:4
s_sub_u32 s90,s90,1
s_waitcnt lgkmcnt(0)
v_cmp_gt_u32 vcc,v38,v39
s_cmp_lt_i32 s90,0
s_cselect_b64 vcc,0,vcc
s_cbranch_vccnz qs_114
ds_read_b64_tr_b16 a[16:17],v36 offset:4096
ds_read_b64_tr_b16 a[18:19],v36 offset:4224
ds_read_b64_tr_b16 a[20:21],v36 offset:6144
ds_read_b64_tr_b16 a[22:23],v36 offset:6272
ds_read_b64_tr_b16 a[24:25],v36 offset:12288
ds_read_b64_tr_b16 a[26:27],v36 offset:12416
ds_read_b64_tr_b16 a[28:29],v36 offset:14336
ds_read_b64_tr_b16 a[30:31],v36 offset:14464
ds_write_b128 v33,a[32:35] offset:0
ds_write_b128 v33,a[36:39] offset:1024
ds_write_b128 v33,a[40:43] offset:2048
ds_write_b128 v33,a[44:47] offset:3072
s_waitcnt lgkmcnt(0)
v_mov_b32 v38,3
ds_write_b32 v37,v38 offset:0
qs_115:
ds_read_b32 v39,v37 offset:4
s_sub_u32 s90,s90,1
s_waitcnt lgkmcnt(0)
v_cmp_gt_u32 vcc,v38,v39
s_cmp_lt_i32 s90,0
s_cselect_b64 vcc,0,vcc
s_cbranch_vccnz qs_115
ds_read_b64_tr_b16 a[32:33],v36 offset:0
ds_read_b64_tr_b16 a[34:35],v36 offset:128
ds_read_b64_tr_b16 a[36:37],v36 offset:2048
ds_read_b64_tr_b16 a[38:39],v36 offset:2176
ds_read_b64_tr_b16 a[40:41],v36 offset:8192
ds_read_b64_tr_b16 a[42:43],v36 offset:8320
ds_read_b64_tr_b16 a[44:45],v36 offset:10240
ds_read_b64_tr_b16 a[46:47],v36 offset:10368
ds_write_b128 v33,a[48:51] offset:4096
ds_write_b128 v33,a[52:55] offset:5120
ds_write_b128 v33,a[56:59] offset:6144
ds_write_b128 v33,a[60:63] offset:7168
s_waitcnt lgkmcnt(0)
v_mov_b32 v38,4
ds_write_b32 v37,v38 offset:0
qs_116:
ds_read_b32 v39,v37 offset:4
s_sub_u32 s90,s90,1
s_waitcnt lgkmcnt(0)
v_cmp_gt_u32 vcc,v38,v39
s_cmp_lt_i32 s90,0
s_cselect_b64 vcc,0,vcc
s_cbranch_vccnz qs_116
ds_read_b64_tr_b16 a[48:49],v36 offset:4096
ds_read_b64_tr_b16 a[50:51],v36 offset:4224
ds_read_b64_tr_b16 a[52:53],v36 offset:6144
ds_read_b64_tr_b16 a[54:55],v36 offset:6272
ds_read_b64_tr_b16 a[56:57],v36 offset:12288
ds_read_b64_tr_b16 a[58:59],v36 offset:12416
ds_read_b64_tr_b16 a[60:61],v36 offset:14336
ds_read_b64_tr_b16 a[62:63],v36 offset:14464
ds_write_b128 v33,a[64:67] offset:0
ds_write_b128 v33,a[68:71] offset:1024
ds_write_b128 v33,a[72:75] offset:2048
ds_write_b128 v33,a[76:79] offset:3072
s_waitcnt lgkmcnt(0)
v_mov_b32 v38,5
ds_write_b32 v37,v38 offset:0
qs_117:
ds_read_b32 v39,v37 offset:4
s_sub_u32 s90,s90,1
s_waitcnt lgkmcnt(0)
v_cmp_gt_u32 vcc,v38,v39
s_cmp_lt_i32 s90,0
s_cselect_b64 vcc,0,vcc
s_cbranch_vccnz qs_117
ds_read_b64_tr_b16 a[64:65],v36 offset:0
ds_read_b64_tr_b16 a[66:67],v36 offset:128
ds_read_b64_tr_b16 a[68:69],v36 offset:2048
ds_read_b64_tr_b16 a[70:71],v36 offset:2176
ds_read_b64_tr_b16 a[72:73],v36 offset:8192
ds_read_b64_tr_b16 a[74:75],v36 offset:8320
ds_read_b64_tr_b16 a[76:77],v36 offset:10240
ds_read_b64_tr_b16 a[78:79],v36 offset:10368
ds_write_b128 v33,a[80:83] offset:4096
ds_write_b128 v33,a[84:87] offset:5120
ds_write_b128 v33,a[88:91] offset:6144
ds_write_b128 v33,a[92:95] offset:7168
s_waitcnt lgkmcnt(0)
v_mov_b32 v38,6
ds_write_b32 v37,v38 offset:0
qs_118:
ds_read_b32 v39,v37 offset:4
s_sub_u32 s90,s90,1
s_waitcnt lgkmcnt(0)
v_cmp_gt_u32 vcc,v38,v39
s_cmp_lt_i32 s90,0
s_cselect_b64 vcc,0,vcc
s_cbranch_vccnz qs_118
ds_read_b64_tr_b16 a[80:81],v36 offset:4096
ds_read_b64_tr_b16 a[82:83],v36 offset:4224
ds_read_b64_tr_b16 a[84:85],v36 offset:6144
ds_read_b64_tr_b16 a[86:87],v36 offset:6272
ds_read_b64_tr_b16 a[88:89],v36 offset:12288
ds_read_b64_tr_b16 a[90:91],v36 offset:12416
ds_read_b64_tr_b16 a[92:93],v36 offset:14336
ds_read_b64_tr_b16 a[94:95],v36 offset:14464
ds_write_b128 v33,a[96:99] offset:0
ds_write_b128 v33,a[100:103] offset:1024
ds_write_b128 v33,a[104:107] offset:2048
ds_write_b128 v33,a[108:111] offset:3072
s_waitcnt lgkmcnt(0)
v_mov_b32 v38,7
ds_write_b32 v37,v38 offset:0
qs_119:
ds_read_b32 v39,v37 offset:4
s_sub_u32 s90,s90,1
s_waitcnt lgkmcnt(0)
v_cmp_gt_u32 vcc,v38,v39
s_cmp_lt_i32 s90,0
s_cselect_b64 vcc,0,vcc
s_cbranch_vccnz qs_119
ds_read_b64_tr_b16 a[96:97],v36 offset:0
ds_read_b64_tr_b16 a[98:99],v36 offset:128
ds_read_b64_tr_b16 a[100:101],v36 offset:2048
ds_read_b64_tr_b16 a[102:103],v36 offset:2176
ds_read_b64_tr_b16 a[104:105],v36 offset:8192
ds_read_b64_tr_b16 a[106:107],v36 offset:8320
ds_read_b64_tr_b16 a[108:109],v36 offset:10240
ds_read_b64_tr_b16 a[110:111],v36 offset:10368
ds_write_b128 v33,a[112:115] offset:4096
ds_write_b128 v33,a[116:119] offset:5120
ds_write_b128 v33,a[120:123] offset:6144
ds_write_b128 v33,a[124:127] offset:7168
s_waitcnt lgkmcnt(0)
v_mov_b32 v38,8
ds_write_b32 v37,v38 offset:0
qs_120:
ds_read_b32 v39,v37 offset:4
s_sub_u32 s90,s90,1
s_waitcnt lgkmcnt(0)
v_cmp_gt_u32 vcc,v38,v39
s_cmp_lt_i32 s90,0
s_cselect_b64 vcc,0,vcc
s_cbranch_vccnz qs_120
ds_read_b64_tr_b16 a[112:113],v36 offset:4096
ds_read_b64_tr_b16 a[114:115],v36 offset:4224
ds_read_b64_tr_b16 a[116:117],v36 offset:6144
ds_read_b64_tr_b16 a[118:119],v36 offset:6272
ds_read_b64_tr_b16 a[120:121],v36 offset:12288
ds_read_b64_tr_b16 a[122:123],v36 offset:12416
ds_read_b64_tr_b16 a[124:125],v36 offset:14336
ds_read_b64_tr_b16 a[126:127],v36 offset:14464
s_waitcnt lgkmcnt(0)
v_mov_b32 v38,9
ds_write_b32 v37,v38 offset:0
qs_121:
ds_read_b32 v39,v37 offset:4
s_sub_u32 s90,s90,1
s_waitcnt lgkmcnt(0)
v_cmp_gt_u32 vcc,v38,v39
s_cmp_lt_i32 s90,0
s_cselect_b64 vcc,0,vcc
s_cbranch_vccnz qs_121
ds_write_b128 v33,a[128:131] offset:0
ds_write_b128 v33,a[132:135] offset:1024
ds_write_b128 v33,a[136:139] offset:2048
ds_write_b128 v33,a[140:143] offset:3072
s_waitcnt lgkmcnt(0)
ds_read_b64_tr_b16 a[128:129],v34 offset:0
ds_read_b64_tr_b16 a[130:131],v34 offset:128
ds_read_b64_tr_b16 a[132:133],v34 offset:2048
ds_read_b64_tr_b16 a[134:135],v34 offset:2176
ds_read_b64_tr_b16 a[136:137],v34 offset:32
ds_read_b64_tr_b16 a[138:139],v34 offset:160
ds_read_b64_tr_b16 a[140:141],v34 offset:2080
ds_read_b64_tr_b16 a[142:143],v34 offset:2208
ds_write_b128 v33,a[144:147] offset:4096
ds_write_b128 v33,a[148:151] offset:5120
ds_write_b128 v33,a[152:155] offset:6144
ds_write_b128 v33,a[156:159] offset:7168
s_waitcnt lgkmcnt(0)
ds_read_b64_tr_b16 a[144:145],v34 offset:4096
ds_read_b64_tr_b16 a[146:147],v34 offset:4224
ds_read_b64_tr_b16 a[148:149],v34 offset:6144
ds_read_b64_tr_b16 a[150:151],v34 offset:6272
ds_read_b64_tr_b16 a[152:153],v34 offset:4128
ds_read_b64_tr_b16 a[154:155],v34 offset:4256
ds_read_b64_tr_b16 a[156:157],v34 offset:6176
ds_read_b64_tr_b16 a[158:159],v34 offset:6304
ds_write_b128 v33,a[160:163] offset:0
ds_write_b128 v33,a[164:167] offset:1024
ds_write_b128 v33,a[168:171] offset:2048
ds_write_b128 v33,a[172:175] offset:3072
s_waitcnt lgkmcnt(0)
ds_read_b64_tr_b16 a[160:161],v34 offset:0
ds_read_b64_tr_b16 a[162:163],v34 offset:128
ds_read_b64_tr_b16 a[164:165],v34 offset:2048
ds_read_b64_tr_b16 a[166:167],v34 offset:2176
ds_read_b64_tr_b16 a[168:169],v34 offset:32
ds_read_b64_tr_b16 a[170:171],v34 offset:160
ds_read_b64_tr_b16 a[172:173],v34 offset:2080
ds_read_b64_tr_b16 a[174:175],v34 offset:2208
free_122:
ds_read_b64 v[38:39],v37 offset:8
s_sub_u32 s90,s90,1
s_waitcnt lgkmcnt(0)
v_and_b32 v38,v38,v39
v_cmp_eq_u32 vcc,0,v38
s_cmp_lt_i32 s90,0
s_cselect_b64 vcc,0,vcc
s_cbranch_vccnz free_122
s_xor_b32 s64,s61,4194304
buffer_store_dwordx4 v[100:103],v206,s[20:23],s64 offen sc1
buffer_store_dwordx4 v[100:103],v207,s[20:23],s64 offen sc1
s_xor_b32 s64,s61,6299648
buffer_store_dwordx4 v[100:103],v206,s[20:23],s64 offen sc1
buffer_store_dwordx4 v[100:103],v207,s[20:23],s64 offen sc1
s_xor_b32 s64,s61,8388608
buffer_store_dwordx4 v[100:103],v206,s[20:23],s64 offen sc1
buffer_store_dwordx4 v[100:103],v207,s[20:23],s64 offen sc1
s_mov_b32 m0,0
s_mov_b32 s65,188416
buffer_load_dwordx4 v16,s[20:23],s65 offen offset:0 lds
buffer_load_dwordx4 v16,s[20:23],s65 offen offset:1024 lds
buffer_load_dwordx4 v16,s[20:23],s65 offen offset:2048 lds
buffer_load_dwordx4 v16,s[20:23],s65 offen offset:3072 lds
s_mov_b32 m0,4096
s_mov_b32 s65,192512
buffer_load_dwordx4 v16,s[20:23],s65 offen offset:0 lds
buffer_load_dwordx4 v16,s[20:23],s65 offen offset:1024 lds
buffer_load_dwordx4 v16,s[20:23],s65 offen offset:2048 lds
buffer_load_dwordx4 v16,s[20:23],s65 offen offset:3072 lds
s_mov_b32 m0,8192
s_mov_b32 s65,196608
buffer_load_dwordx4 v16,s[20:23],s65 offen offset:0 lds
buffer_load_dwordx4 v16,s[20:23],s65 offen offset:1024 lds
buffer_load_dwordx4 v16,s[20:23],s65 offen offset:2048 lds
buffer_load_dwordx4 v16,s[20:23],s65 offen offset:3072 lds
s_mov_b32 m0,12288
s_mov_b32 s65,200704
buffer_load_dwordx4 v16,s[20:23],s65 offen offset:0 lds
buffer_load_dwordx4 v16,s[20:23],s65 offen offset:1024 lds
buffer_load_dwordx4 v16,s[20:23],s65 offen offset:2048 lds
buffer_load_dwordx4 v16,s[20:23],s65 offen offset:3072 lds
s_mov_b32 m0,16384
s_mov_b32 s65,204800
buffer_load_dwordx4 v16,s[20:23],s65 offen offset:0 lds
buffer_load_dwordx4 v16,s[20:23],s65 offen offset:1024 lds
buffer_load_dwordx4 v16,s[20:23],s65 offen offset:2048 lds
buffer_load_dwordx4 v16,s[20:23],s65 offen offset:3072 lds
s_mov_b32 m0,20480
s_mov_b32 s65,208896
buffer_load_dwordx4 v16,s[20:23],s65 offen offset:0 lds
buffer_load_dwordx4 v16,s[20:23],s65 offen offset:1024 lds
buffer_load_dwordx4 v16,s[20:23],s65 offen offset:2048 lds
buffer_load_dwordx4 v16,s[20:23],s65 offen offset:3072 lds
s_mov_b32 m0,24576
s_mov_b32 s65,212992
buffer_load_dwordx4 v16,s[20:23],s65 offen offset:0 lds
buffer_load_dwordx4 v16,s[20:23],s65 offen offset:1024 lds
buffer_load_dwordx4 v16,s[20:23],s65 offen offset:2048 lds
buffer_load_dwordx4 v16,s[20:23],s65 offen offset:3072 lds
s_mov_b32 m0,28672
s_mov_b32 s65,217088
buffer_load_dwordx4 v16,s[20:23],s65 offen offset:0 lds
buffer_load_dwordx4 v16,s[20:23],s65 offen offset:1024 lds
buffer_load_dwordx4 v16,s[20:23],s65 offen offset:2048 lds
buffer_load_dwordx4 v16,s[20:23],s65 offen offset:3072 lds
s_waitcnt vmcnt(54)
ds_write_b128 v33,a[176:179] offset:4096
ds_write_b128 v33,a[180:183] offset:5120
ds_write_b128 v33,a[184:187] offset:6144
ds_write_b128 v33,a[188:191] offset:7168
s_waitcnt lgkmcnt(0)
ds_read_b64_tr_b16 a[176:177],v34 offset:4096
ds_read_b64_tr_b16 a[178:179],v34 offset:4224
ds_read_b64_tr_b16 a[180:181],v34 offset:6144
ds_read_b64_tr_b16 a[182:183],v34 offset:6272
ds_read_b64_tr_b16 a[184:185],v34 offset:4128
ds_read_b64_tr_b16 a[186:187],v34 offset:4256
ds_read_b64_tr_b16 a[188:189],v34 offset:6176
ds_read_b64_tr_b16 a[190:191],v34 offset:6304
s_waitcnt vmcnt(50)
ds_write_b128 v33,a[192:195] offset:0
ds_write_b128 v33,a[196:199] offset:1024
ds_write_b128 v33,a[200:203] offset:2048
ds_write_b128 v33,a[204:207] offset:3072
s_waitcnt lgkmcnt(0)
ds_read_b64_tr_b16 a[192:193],v34 offset:0
ds_read_b64_tr_b16 a[194:195],v34 offset:128
ds_read_b64_tr_b16 a[196:197],v34 offset:2048
ds_read_b64_tr_b16 a[198:199],v34 offset:2176
ds_read_b64_tr_b16 a[200:201],v34 offset:32
ds_read_b64_tr_b16 a[202:203],v34 offset:160
ds_read_b64_tr_b16 a[204:205],v34 offset:2080
ds_read_b64_tr_b16 a[206:207],v34 offset:2208
s_waitcnt vmcnt(46)
ds_write_b128 v33,a[208:211] offset:4096
ds_write_b128 v33,a[212:215] offset:5120
ds_write_b128 v33,a[216:219] offset:6144
ds_write_b128 v33,a[220:223] offset:7168
s_waitcnt lgkmcnt(0)
ds_read_b64_tr_b16 a[208:209],v34 offset:4096
ds_read_b64_tr_b16 a[210:211],v34 offset:4224
ds_read_b64_tr_b16 a[212:213],v34 offset:6144
ds_read_b64_tr_b16 a[214:215],v34 offset:6272
ds_read_b64_tr_b16 a[216:217],v34 offset:4128
ds_read_b64_tr_b16 a[218:219],v34 offset:4256
ds_read_b64_tr_b16 a[220:221],v34 offset:6176
ds_read_b64_tr_b16 a[222:223],v34 offset:6304
s_waitcnt vmcnt(42)
ds_write_b128 v33,a[224:227] offset:0
ds_write_b128 v33,a[228:231] offset:1024
ds_write_b128 v33,a[232:235] offset:2048
ds_write_b128 v33,a[236:239] offset:3072
s_waitcnt lgkmcnt(0)
ds_read_b64_tr_b16 a[224:225],v34 offset:0
ds_read_b64_tr_b16 a[226:227],v34 offset:128
ds_read_b64_tr_b16 a[228:229],v34 offset:2048
ds_read_b64_tr_b16 a[230:231],v34 offset:2176
ds_read_b64_tr_b16 a[232:233],v34 offset:32
ds_read_b64_tr_b16 a[234:235],v34 offset:160
ds_read_b64_tr_b16 a[236:237],v34 offset:2080
ds_read_b64_tr_b16 a[238:239],v34 offset:2208
s_waitcnt vmcnt(38)
ds_write_b128 v33,a[240:243] offset:4096
ds_write_b128 v33,a[244:247] offset:5120
ds_write_b128 v33,a[248:251] offset:6144
ds_write_b128 v33,a[252:255] offset:7168
s_waitcnt lgkmcnt(0)
ds_read_b64_tr_b16 a[240:241],v34 offset:4096
ds_read_b64_tr_b16 a[242:243],v34 offset:4224
ds_read_b64_tr_b16 a[244:245],v34 offset:6144
ds_read_b64_tr_b16 a[246:247],v34 offset:6272
ds_read_b64_tr_b16 a[248:249],v34 offset:4128
ds_read_b64_tr_b16 a[250:251],v34 offset:4256
ds_read_b64_tr_b16 a[252:253],v34 offset:6176
ds_read_b64_tr_b16 a[254:255],v34 offset:6304
s_mov_b32 s79,0
s_add_u32 s63,s79,0
s_and_b32 s64,s63,3
s_lshl_b32 s70,s64,20
s_add_u32 s65,s63,2
s_and_b32 s65,s65,3
s_lshl_b32 s73,s65,20
s_add_u32 s55,s63,3
s_lshl_b32 s78,s55,16
s_add_u32 s78,s78,57344
s_cmp_lt_u32 s55,64
s_cselect_b32 s78,s78,0x7fff0000
s_add_u32 s71,s70,65536
s_add_u32 s60,s63,1
s_and_b32 s60,s60,3
s_lshl_b32 s72,s60,20
v_mov_b32 v184,0
v_mov_b32 v185,0
v_mov_b32 v186,0
v_mov_b32 v187,0
v_mov_b32 v188,0
v_mov_b32 v189,0
v_mov_b32 v190,0
v_mov_b32 v191,0
s_lshl_b32 s77,s63,21
s_lshl_b32 s55,s63,13
s_and_b32 s55,s55,0x2000
s_xor_b32 s55,s55,s61
s_add_u32 s77,s77,s55
v_mov_b32 v176,0
v_mov_b32 v177,0
v_mov_b32 v178,0
v_mov_b32 v179,0
v_mov_b32 v25,1
s_waitcnt vmcnt(0) lgkmcnt(0)
s_barrier
s_branch loop_63
w1_59:
s_lshr_b32 s64,s57,2
s_add_u32 s64,s64,64
s_lshl_b32 s64,s64,14
s_add_u32 s64,s64,s68
s_add_u32 s64,s64,29360128
v_add_u32 v12,s64,v16
v_and_b32 v22,1,v4
v_lshrrev_b32 v23,1,v4
v_lshl_add_u32 v22,v22,1,v23
v_lshlrev_b32 v22,2,v22
v_lshl_add_u32 v22,v3,4,v22
v_add_u32 v31,155648,v22
v_add_u32 v8,s66,v16
v_add_u32 v9,s67,v16
v_mov_b32 v10,1792
v_mov_b32 v11,0
s_branch first_123
loop_124:
s_barrier
buffer_load_dword v248,v18,s[20:23],s70 offen offset:0 sc1
s_nop 15
s_nop 5
hl_126:
buffer_load_dword v249,v18,s[20:23],s70 offen offset:0 sc1
s_waitcnt vmcnt(1)
v_cmp_eq_u32 vcc,v25,v248
s_bcnt1_i32_b32 s64,vcc_lo
s_cmp_ge_u32 s64,8
s_cbranch_scc1 hg_127
buffer_load_dword v248,v18,s[20:23],s70 offen offset:0 sc1
s_waitcnt vmcnt(1)
v_cmp_eq_u32 vcc,v25,v249
s_bcnt1_i32_b32 s64,vcc_lo
s_cmp_ge_u32 s64,8
s_cbranch_scc1 hg_127
s_sub_u32 s90,s90,1
s_cmp_gt_i32 s90,0
s_cbranch_scc1 hl_126
hg_127:
buffer_load_dwordx4 v[48:51],v27,s[20:23],s70 offen offset:0 sc1
buffer_load_dwordx4 v[52:55],v27,s[20:23],s70 offen offset:1024 sc1
buffer_load_dwordx4 v[56:59],v27,s[20:23],s70 offen offset:2048 sc1
buffer_load_dwordx4 v[60:63],v27,s[20:23],s70 offen offset:3072 sc1
s_waitcnt vmcnt(3)
ds_write_b128 v24,v[48:51] offset:4096
v_min3_u32 v22,v48,v49,v50
v_min_u32 v22,v22,v51
s_waitcnt vmcnt(2)
ds_write_b128 v24,v[52:55] offset:5120
v_min3_u32 v22,v22,v52,v53
v_min3_u32 v22,v22,v54,v55
s_waitcnt vmcnt(1)
ds_write_b128 v24,v[56:59] offset:6144
v_min3_u32 v22,v22,v56,v57
v_min3_u32 v22,v22,v58,v59
s_waitcnt vmcnt(0)
ds_write_b128 v24,v[60:63] offset:7168
v_min3_u32 v22,v22,v60,v61
v_min3_u32 v22,v22,v62,v63
v_cmp_eq_u32 vcc,0,v22
s_cbranch_vccnz art_128
abk_129:
v_smfmac_f32_16x16x64_bf16 v[176:179],v[48:51],a[32:39],v14
s_waitcnt lgkmcnt(0)
s_barrier
ds_read_b128 v[64:67],v24 offset:8192
ds_read_b128 v[68:71],v24 offset:9216
ds_read_b128 v[72:75],v24 offset:10240
ds_read_b128 v[76:79],v24 offset:11264
buffer_store_dwordx4 v[212:215],v12,s[20:23],s76 offen sc1
v_smfmac_f32_16x16x64_bf16 v[176:179],v[52:55],a[40:47],v14
ds_read_b128 v[80:83],v24 offset:12288
ds_read_b128 v[84:87],v24 offset:13312
v_smfmac_f32_16x16x64_bf16 v[176:179],v[56:59],a[48:55],v14
ds_read_b128 v[88:91],v24 offset:14336
ds_read_b128 v[92:95],v24 offset:15360
v_smfmac_f32_16x16x64_bf16 v[176:179],v[60:63],a[56:63],v14
ds_read_b128 v[32:35],v24 offset:0
ds_read_b128 v[36:39],v24 offset:1024
s_waitcnt lgkmcnt(9)
v_smfmac_f32_16x16x64_bf16 v[176:179],v[64:67],a[64:71],v14
ds_read_b128 v[40:43],v24 offset:2048
s_waitcnt lgkmcnt(9)
v_smfmac_f32_16x16x64_bf16 v[176:179],v[68:71],a[72:79],v14
ds_read_b128 v[44:47],v24 offset:3072
s_waitcnt lgkmcnt(9)
v_smfmac_f32_16x16x64_bf16 v[176:179],v[72:75],a[80:87],v14
s_waitcnt lgkmcnt(8)
v_smfmac_f32_16x16x64_bf16 v[176:179],v[76:79],a[88:95],v14
s_waitcnt lgkmcnt(7)
v_smfmac_f32_16x16x64_bf16 v[176:179],v[80:83],a[96:103],v14
s_waitcnt lgkmcnt(6)
v_smfmac_f32_16x16x64_bf16 v[176:179],v[84:87],a[104:111],v14
s_waitcnt lgkmcnt(5)
v_smfmac_f32_16x16x64_bf16 v[176:179],v[88:91],a[112:119],v14
s_waitcnt lgkmcnt(4)
v_smfmac_f32_16x16x64_bf16 v[176:179],v[92:95],a[120:127],v14
s_waitcnt lgkmcnt(3)
v_smfmac_f32_16x16x64_bf16 v[176:179],v[32:35],a[0:7],v14
s_waitcnt lgkmcnt(2)
v_smfmac_f32_16x16x64_bf16 v[176:179],v[36:39],a[8:15],v14
s_waitcnt lgkmcnt(1)
v_smfmac_f32_16x16x64_bf16 v[176:179],v[40:43],a[16:23],v14
s_waitcnt lgkmcnt(0)
v_smfmac_f32_16x16x64_bf16 v[176:179],v[44:47],a[24:31],v14
v_smfmac_f32_16x16x64_bf16 v[180:183],v[32:35],a[128:135],v14
v_smfmac_f32_16x16x64_bf16 v[180:183],v[36:39],a[136:143],v14
s_nop 5
v_permlane32_swap_b32 v176,v178
v_permlane32_swap_b32 v177,v179
v_add_f32 v176,v176,v178
v_add_f32 v177,v177,v179
v_cvt_pk_bf16_f32 v216,v176,v177
s_nop 1
v_mov_b32_dpp v217,v216 quad_perm:[1,0,3,2] row_mask:0xf bank_mask:0xf
v_perm_b32 v216,v217,v216,v15
v_max_u32 v216,1,v216
buffer_store_dword v216,v19,s[24:27],s70 offen
buffer_store_dword v216,v19,s[28:31],s70 offen sc1
v_smfmac_f32_16x16x64_bf16 v[180:183],v[40:43],a[144:151],v14
v_smfmac_f32_16x16x64_bf16 v[180:183],v[44:47],a[152:159],v14
v_smfmac_f32_16x16x64_bf16 v[180:183],v[48:51],a[160:167],v14
v_smfmac_f32_16x16x64_bf16 v[180:183],v[52:55],a[168:175],v14
v_smfmac_f32_16x16x64_bf16 v[180:183],v[56:59],a[176:183],v14
v_smfmac_f32_16x16x64_bf16 v[180:183],v[60:63],a[184:191],v14
v_smfmac_f32_16x16x64_bf16 v[180:183],v[64:67],a[192:199],v14
v_smfmac_f32_16x16x64_bf16 v[180:183],v[68:71],a[200:207],v14
v_smfmac_f32_16x16x64_bf16 v[180:183],v[72:75],a[208:215],v14
v_smfmac_f32_16x16x64_bf16 v[180:183],v[76:79],a[216:223],v14
v_smfmac_f32_16x16x64_bf16 v[180:183],v[80:83],a[224:231],v14
v_smfmac_f32_16x16x64_bf16 v[180:183],v[84:87],a[232:239],v14
v_smfmac_f32_16x16x64_bf16 v[180:183],v[88:91],a[240:247],v14
v_smfmac_f32_16x16x64_bf16 v[180:183],v[92:95],a[248:255],v14
s_nop 7
v_permlane32_swap_b32 v180,v182
v_permlane32_swap_b32 v181,v183
v_add_f32 v180,v180,v182
v_add_f32 v181,v181,v183
v_cvt_pk_bf16_f32 v216,v180,v181
v_max_u32 v216,1,v216
ds_write_b32 v31,v216
ds_write_b32 v21,v25 offset:0
s_cmp_eq_u32 s79,63
s_cbranch_scc1 end_57
s_cmp_ge_i32 s79,62
s_cbranch_scc1 bgsk_131
ds_read_b128 v[64:67],v20 offset:0
ds_read_b128 v[68:71],v20 offset:1024
ds_read_b128 v[72:75],v20 offset:2048
s_waitcnt lgkmcnt(2)
v_mfma_f32_16x16x32_bf16 v[192:195],a[0:3],v[64:67],0
ds_read_b128 v[76:79],v20 offset:3072
v_mfma_f32_16x16x32_bf16 v[200:203],v[64:67],a[128:131],0
s_waitcnt lgkmcnt(2)
v_mfma_f32_16x16x32_bf16 v[196:199],a[0:3],v[68:71],0
ds_read_b128 v[64:67],v20 offset:4096
v_mfma_f32_16x16x32_bf16 v[204:207],v[68:71],a[128:131],0
s_waitcnt lgkmcnt(2)
v_mfma_f32_16x16x32_bf16 v[192:195],a[4:7],v[72:75],v[192:195]
ds_read_b128 v[68:71],v20 offset:5120
v_mfma_f32_16x16x32_bf16 v[200:203],v[72:75],a[132:135],v[200:203]
s_waitcnt lgkmcnt(2)
v_mfma_f32_16x16x32_bf16 v[196:199],a[4:7],v[76:79],v[196:199]
ds_read_b128 v[72:75],v20 offset:6144
v_mfma_f32_16x16x32_bf16 v[204:207],v[76:79],a[132:135],v[204:207]
s_waitcnt lgkmcnt(2)
v_mfma_f32_16x16x32_bf16 v[192:195],a[8:11],v[64:67],v[192:195]
ds_read_b128 v[76:79],v20 offset:7168
v_mfma_f32_16x16x32_bf16 v[200:203],v[64:67],a[136:139],v[200:203]
s_waitcnt lgkmcnt(2)
v_mfma_f32_16x16x32_bf16 v[196:199],a[8:11],v[68:71],v[196:199]
ds_read_b128 v[64:67],v20 offset:8192
v_mfma_f32_16x16x32_bf16 v[204:207],v[68:71],a[136:139],v[204:207]
s_waitcnt lgkmcnt(2)
v_mfma_f32_16x16x32_bf16 v[192:195],a[12:15],v[72:75],v[192:195]
ds_read_b128 v[68:71],v20 offset:9216
v_mfma_f32_16x16x32_bf16 v[200:203],v[72:75],a[140:143],v[200:203]
s_waitcnt lgkmcnt(2)
v_mfma_f32_16x16x32_bf16 v[196:199],a[12:15],v[76:79],v[196:199]
ds_read_b128 v[72:75],v20 offset:10240
v_mfma_f32_16x16x32_bf16 v[204:207],v[76:79],a[140:143],v[204:207]
s_add_u32 m0,s62,0
s_add_u32 s69,s78,0
s_waitcnt lgkmcnt(2)
v_mfma_f32_16x16x32_bf16 v[192:195],a[16:19],v[64:67],v[192:195]
ds_read_b128 v[76:79],v20 offset:11264
v_mfma_f32_16x16x32_bf16 v[200:203],v[64:67],a[144:147],v[200:203]
buffer_load_dwordx4 v16,s[20:23],s69 offen offset:0 lds
s_waitcnt lgkmcnt(2)
v_mfma_f32_16x16x32_bf16 v[196:199],a[16:19],v[68:71],v[196:199]
ds_read_b128 v[64:67],v20 offset:12288
v_mfma_f32_16x16x32_bf16 v[204:207],v[68:71],a[144:147],v[204:207]
buffer_load_dwordx4 v16,s[20:23],s69 offen offset:1024 lds
s_waitcnt lgkmcnt(2)
v_mfma_f32_16x16x32_bf16 v[192:195],a[20:23],v[72:75],v[192:195]
ds_read_b128 v[68:71],v20 offset:13312
v_mfma_f32_16x16x32_bf16 v[200:203],v[72:75],a[148:151],v[200:203]
buffer_load_dwordx4 v16,s[20:23],s69 offen offset:2048 lds
s_waitcnt lgkmcnt(2)
v_mfma_f32_16x16x32_bf16 v[196:199],a[20:23],v[76:79],v[196:199]
ds_read_b128 v[72:75],v20 offset:14336
v_mfma_f32_16x16x32_bf16 v[204:207],v[76:79],a[148:151],v[204:207]
buffer_load_dwordx4 v16,s[20:23],s69 offen offset:3072 lds
s_waitcnt lgkmcnt(2)
v_mfma_f32_16x16x32_bf16 v[192:195],a[24:27],v[64:67],v[192:195]
ds_read_b128 v[76:79],v20 offset:15360
v_mfma_f32_16x16x32_bf16 v[200:203],v[64:67],a[152:155],v[200:203]
s_add_u32 m0,s62,4096
s_add_u32 s69,s78,4096
s_waitcnt lgkmcnt(2)
v_mfma_f32_16x16x32_bf16 v[196:199],a[24:27],v[68:71],v[196:199]
ds_read_b128 v[64:67],v20 offset:16384
v_mfma_f32_16x16x32_bf16 v[204:207],v[68:71],a[152:155],v[204:207]
buffer_load_dwordx4 v16,s[20:23],s69 offen offset:0 lds
s_waitcnt lgkmcnt(2)
v_mfma_f32_16x16x32_bf16 v[192:195],a[28:31],v[72:75],v[192:195]
ds_read_b128 v[68:71],v20 offset:17408
v_mfma_f32_16x16x32_bf16 v[200:203],v[72:75],a[156:159],v[200:203]
buffer_load_dwordx4 v16,s[20:23],s69 offen offset:1024 lds
s_waitcnt lgkmcnt(2)
v_mfma_f32_16x16x32_bf16 v[196:199],a[28:31],v[76:79],v[196:199]
ds_read_b128 v[72:75],v20 offset:18432
v_mfma_f32_16x16x32_bf16 v[204:207],v[76:79],a[156:159],v[204:207]
buffer_load_dwordx4 v16,s[20:23],s69 offen offset:2048 lds
s_waitcnt lgkmcnt(2)
v_mfma_f32_16x16x32_bf16 v[192:195],a[32:35],v[64:67],v[192:195]
ds_read_b128 v[76:79],v20 offset:19456
v_mfma_f32_16x16x32_bf16 v[200:203],v[64:67],a[160:163],v[200:203]
buffer_load_dwordx4 v16,s[20:23],s69 offen offset:3072 lds
s_waitcnt lgkmcnt(2)
v_mfma_f32_16x16x32_bf16 v[196:199],a[32:35],v[68:71],v[196:199]
ds_read_b128 v[64:67],v20 offset:20480
v_mfma_f32_16x16x32_bf16 v[204:207],v[68:71],a[160:163],v[204:207]
s_add_u32 m0,s62,8192
s_add_u32 s69,s78,8192
s_waitcnt lgkmcnt(2)
v_mfma_f32_16x16x32_bf16 v[192:195],a[36:39],v[72:75],v[192:195]
ds_read_b128 v[68:71],v20 offset:21504
v_mfma_f32_16x16x32_bf16 v[200:203],v[72:75],a[164:167],v[200:203]
buffer_load_dwordx4 v16,s[20:23],s69 offen offset:0 lds
s_waitcnt lgkmcnt(2)
v_mfma_f32_16x16x32_bf16 v[196:199],a[36:39],v[76:79],v[196:199]
ds_read_b128 v[72:75],v20 offset:22528
v_mfma_f32_16x16x32_bf16 v[204:207],v[76:79],a[164:167],v[204:207]
buffer_load_dwordx4 v16,s[20:23],s69 offen offset:1024 lds
s_waitcnt lgkmcnt(2)
v_mfma_f32_16x16x32_bf16 v[192:195],a[40:43],v[64:67],v[192:195]
ds_read_b128 v[76:79],v20 offset:23552
v_mfma_f32_16x16x32_bf16 v[200:203],v[64:67],a[168:171],v[200:203]
buffer_load_dwordx4 v16,s[20:23],s69 offen offset:2048 lds
s_waitcnt lgkmcnt(2)
v_mfma_f32_16x16x32_bf16 v[196:199],a[40:43],v[68:71],v[196:199]
ds_read_b128 v[64:67],v20 offset:24576
v_mfma_f32_16x16x32_bf16 v[204:207],v[68:71],a[168:171],v[204:207]
buffer_load_dwordx4 v16,s[20:23],s69 offen offset:3072 lds
s_waitcnt lgkmcnt(2)
v_mfma_f32_16x16x32_bf16 v[192:195],a[44:47],v[72:75],v[192:195]
ds_read_b128 v[68:71],v20 offset:25600
v_mfma_f32_16x16x32_bf16 v[200:203],v[72:75],a[172:175],v[200:203]
s_add_u32 m0,s62,12288
s_add_u32 s69,s78,12288
s_waitcnt lgkmcnt(2)
v_mfma_f32_16x16x32_bf16 v[196:199],a[44:47],v[76:79],v[196:199]
ds_read_b128 v[72:75],v20 offset:26624
v_mfma_f32_16x16x32_bf16 v[204:207],v[76:79],a[172:175],v[204:207]
buffer_load_dwordx4 v16,s[20:23],s69 offen offset:0 lds
s_waitcnt lgkmcnt(2)
v_mfma_f32_16x16x32_bf16 v[192:195],a[48:51],v[64:67],v[192:195]
ds_read_b128 v[76:79],v20 offset:27648
v_mfma_f32_16x16x32_bf16 v[200:203],v[64:67],a[176:179],v[200:203]
buffer_load_dwordx4 v16,s[20:23],s69 offen offset:1024 lds
s_waitcnt lgkmcnt(2)
v_mfma_f32_16x16x32_bf16 v[196:199],a[48:51],v[68:71],v[196:199]
ds_read_b128 v[64:67],v20 offset:28672
v_mfma_f32_16x16x32_bf16 v[204:207],v[68:71],a[176:179],v[204:207]
buffer_load_dwordx4 v16,s[20:23],s69 offen offset:2048 lds
s_waitcnt lgkmcnt(2)
v_mfma_f32_16x16x32_bf16 v[192:195],a[52:55],v[72:75],v[192:195]
ds_read_b128 v[68:71],v20 offset:29696
v_mfma_f32_16x16x32_bf16 v[200:203],v[72:75],a[180:183],v[200:203]
buffer_load_dwordx4 v16,s[20:23],s69 offen offset:3072 lds
s_waitcnt lgkmcnt(2)
v_mfma_f32_16x16x32_bf16 v[196:199],a[52:55],v[76:79],v[196:199]
ds_read_b128 v[72:75],v20 offset:30720
v_mfma_f32_16x16x32_bf16 v[204:207],v[76:79],a[180:183],v[204:207]
s_waitcnt lgkmcnt(2)
v_mfma_f32_16x16x32_bf16 v[192:195],a[56:59],v[64:67],v[192:195]
ds_read_b128 v[76:79],v20 offset:31744
v_mfma_f32_16x16x32_bf16 v[200:203],v[64:67],a[184:187],v[200:203]
s_waitcnt lgkmcnt(2)
v_mfma_f32_16x16x32_bf16 v[196:199],a[56:59],v[68:71],v[196:199]
ds_read_b128 v[64:67],v20 offset:32768
v_mfma_f32_16x16x32_bf16 v[204:207],v[68:71],a[184:187],v[204:207]
s_waitcnt lgkmcnt(2)
v_mfma_f32_16x16x32_bf16 v[192:195],a[60:63],v[72:75],v[192:195]
ds_read_b128 v[68:71],v20 offset:33792
v_mfma_f32_16x16x32_bf16 v[200:203],v[72:75],a[188:191],v[200:203]
s_waitcnt lgkmcnt(2)
v_mfma_f32_16x16x32_bf16 v[196:199],a[60:63],v[76:79],v[196:199]
ds_read_b128 v[72:75],v20 offset:34816
v_mfma_f32_16x16x32_bf16 v[204:207],v[76:79],a[188:191],v[204:207]
s_waitcnt lgkmcnt(2)
v_mfma_f32_16x16x32_bf16 v[192:195],a[64:67],v[64:67],v[192:195]
ds_read_b128 v[76:79],v20 offset:35840
v_mfma_f32_16x16x32_bf16 v[200:203],v[64:67],a[192:195],v[200:203]
s_waitcnt lgkmcnt(2)
v_mfma_f32_16x16x32_bf16 v[196:199],a[64:67],v[68:71],v[196:199]
ds_read_b128 v[64:67],v20 offset:36864
v_mfma_f32_16x16x32_bf16 v[204:207],v[68:71],a[192:195],v[204:207]
s_waitcnt lgkmcnt(2)
v_mfma_f32_16x16x32_bf16 v[192:195],a[68:71],v[72:75],v[192:195]
ds_read_b128 v[68:71],v20 offset:37888
v_mfma_f32_16x16x32_bf16 v[200:203],v[72:75],a[196:199],v[200:203]
s_waitcnt lgkmcnt(2)
v_mfma_f32_16x16x32_bf16 v[196:199],a[68:71],v[76:79],v[196:199]
ds_read_b128 v[72:75],v20 offset:38912
v_mfma_f32_16x16x32_bf16 v[204:207],v[76:79],a[196:199],v[204:207]
s_waitcnt lgkmcnt(2)
v_mfma_f32_16x16x32_bf16 v[192:195],a[72:75],v[64:67],v[192:195]
ds_read_b128 v[76:79],v20 offset:39936
v_mfma_f32_16x16x32_bf16 v[200:203],v[64:67],a[200:203],v[200:203]
s_waitcnt lgkmcnt(2)
v_mfma_f32_16x16x32_bf16 v[196:199],a[72:75],v[68:71],v[196:199]
ds_read_b128 v[64:67],v20 offset:40960
v_mfma_f32_16x16x32_bf16 v[204:207],v[68:71],a[200:203],v[204:207]
s_waitcnt lgkmcnt(2)
v_mfma_f32_16x16x32_bf16 v[192:195],a[76:79],v[72:75],v[192:195]
ds_read_b128 v[68:71],v20 offset:41984
v_mfma_f32_16x16x32_bf16 v[200:203],v[72:75],a[204:207],v[200:203]
s_waitcnt lgkmcnt(2)
v_mfma_f32_16x16x32_bf16 v[196:199],a[76:79],v[76:79],v[196:199]
ds_read_b128 v[72:75],v20 offset:43008
v_mfma_f32_16x16x32_bf16 v[204:207],v[76:79],a[204:207],v[204:207]
s_waitcnt lgkmcnt(2)
v_mfma_f32_16x16x32_bf16 v[192:195],a[80:83],v[64:67],v[192:195]
ds_read_b128 v[76:79],v20 offset:44032
v_mfma_f32_16x16x32_bf16 v[200:203],v[64:67],a[208:211],v[200:203]
s_waitcnt lgkmcnt(2)
v_mfma_f32_16x16x32_bf16 v[196:199],a[80:83],v[68:71],v[196:199]
ds_read_b128 v[64:67],v20 offset:45056
v_mfma_f32_16x16x32_bf16 v[204:207],v[68:71],a[208:211],v[204:207]
s_waitcnt lgkmcnt(2)
v_mfma_f32_16x16x32_bf16 v[192:195],a[84:87],v[72:75],v[192:195]
ds_read_b128 v[68:71],v20 offset:46080
v_mfma_f32_16x16x32_bf16 v[200:203],v[72:75],a[212:215],v[200:203]
s_waitcnt lgkmcnt(2)
v_mfma_f32_16x16x32_bf16 v[196:199],a[84:87],v[76:79],v[196:199]
ds_read_b128 v[72:75],v20 offset:47104
v_mfma_f32_16x16x32_bf16 v[204:207],v[76:79],a[212:215],v[204:207]
s_waitcnt lgkmcnt(2)
v_mfma_f32_16x16x32_bf16 v[192:195],a[88:91],v[64:67],v[192:195]
ds_read_b128 v[76:79],v20 offset:48128
v_mfma_f32_16x16x32_bf16 v[200:203],v[64:67],a[216:219],v[200:203]
s_waitcnt lgkmcnt(2)
v_mfma_f32_16x16x32_bf16 v[196:199],a[88:91],v[68:71],v[196:199]
ds_read_b128 v[64:67],v20 offset:49152
v_mfma_f32_16x16x32_bf16 v[204:207],v[68:71],a[216:219],v[204:207]
s_waitcnt lgkmcnt(2)
v_mfma_f32_16x16x32_bf16 v[192:195],a[92:95],v[72:75],v[192:195]
ds_read_b128 v[68:71],v20 offset:50176
v_mfma_f32_16x16x32_bf16 v[200:203],v[72:75],a[220:223],v[200:203]
s_waitcnt lgkmcnt(2)
v_mfma_f32_16x16x32_bf16 v[196:199],a[92:95],v[76:79],v[196:199]
ds_read_b128 v[72:75],v20 offset:51200
v_mfma_f32_16x16x32_bf16 v[204:207],v[76:79],a[220:223],v[204:207]
s_waitcnt lgkmcnt(2)
v_mfma_f32_16x16x32_bf16 v[192:195],a[96:99],v[64:67],v[192:195]
ds_read_b128 v[76:79],v20 offset:52224
v_mfma_f32_16x16x32_bf16 v[200:203],v[64:67],a[224:227],v[200:203]
s_waitcnt lgkmcnt(2)
v_mfma_f32_16x16x32_bf16 v[196:199],a[96:99],v[68:71],v[196:199]
ds_read_b128 v[64:67],v20 offset:53248
v_mfma_f32_16x16x32_bf16 v[204:207],v[68:71],a[224:227],v[204:207]
s_waitcnt lgkmcnt(2)
v_mfma_f32_16x16x32_bf16 v[192:195],a[100:103],v[72:75],v[192:195]
ds_read_b128 v[68:71],v20 offset:54272
s_add_u32 m0,s62,32768
s_add_u32 s69,s78,32768
v_mfma_f32_16x16x32_bf16 v[200:203],v[72:75],a[228:231],v[200:203]
s_waitcnt lgkmcnt(2)
v_mfma_f32_16x16x32_bf16 v[196:199],a[100:103],v[76:79],v[196:199]
ds_read_b128 v[72:75],v20 offset:55296
buffer_load_dwordx4 v16,s[20:23],s69 offen offset:0 lds
v_mfma_f32_16x16x32_bf16 v[204:207],v[76:79],a[228:231],v[204:207]
s_waitcnt lgkmcnt(2)
v_mfma_f32_16x16x32_bf16 v[192:195],a[104:107],v[64:67],v[192:195]
ds_read_b128 v[76:79],v20 offset:56320
buffer_load_dwordx4 v16,s[20:23],s69 offen offset:1024 lds
v_mfma_f32_16x16x32_bf16 v[200:203],v[64:67],a[232:235],v[200:203]
s_waitcnt lgkmcnt(2)
v_mfma_f32_16x16x32_bf16 v[196:199],a[104:107],v[68:71],v[196:199]
ds_read_b128 v[64:67],v20 offset:57344
buffer_load_dwordx4 v16,s[20:23],s69 offen offset:2048 lds
v_mfma_f32_16x16x32_bf16 v[204:207],v[68:71],a[232:235],v[204:207]
s_waitcnt lgkmcnt(2)
v_mfma_f32_16x16x32_bf16 v[192:195],a[108:111],v[72:75],v[192:195]
ds_read_b128 v[68:71],v20 offset:58368
buffer_load_dwordx4 v16,s[20:23],s69 offen offset:3072 lds
v_mfma_f32_16x16x32_bf16 v[200:203],v[72:75],a[236:239],v[200:203]
s_waitcnt lgkmcnt(2)
v_mfma_f32_16x16x32_bf16 v[196:199],a[108:111],v[76:79],v[196:199]
ds_read_b128 v[72:75],v20 offset:59392
s_add_u32 m0,s62,36864
s_add_u32 s69,s78,36864
v_mfma_f32_16x16x32_bf16 v[204:207],v[76:79],a[236:239],v[204:207]
s_waitcnt lgkmcnt(2)
v_mfma_f32_16x16x32_bf16 v[192:195],a[112:115],v[64:67],v[192:195]
ds_read_b128 v[76:79],v20 offset:60416
buffer_load_dwordx4 v16,s[20:23],s69 offen offset:0 lds
v_mfma_f32_16x16x32_bf16 v[200:203],v[64:67],a[240:243],v[200:203]
s_waitcnt lgkmcnt(2)
v_mfma_f32_16x16x32_bf16 v[196:199],a[112:115],v[68:71],v[196:199]
ds_read_b128 v[64:67],v20 offset:61440
v_mfma_f32_16x16x32_bf16 v[204:207],v[68:71],a[240:243],v[204:207]
buffer_load_dwordx4 v16,s[20:23],s69 offen offset:1024 lds
s_waitcnt lgkmcnt(2)
v_mfma_f32_16x16x32_bf16 v[192:195],a[116:119],v[72:75],v[192:195]
ds_read_b128 v[68:71],v20 offset:62464
v_mfma_f32_16x16x32_bf16 v[200:203],v[72:75],a[244:247],v[200:203]
buffer_load_dwordx4 v16,s[20:23],s69 offen offset:2048 lds
s_waitcnt lgkmcnt(2)
v_mfma_f32_16x16x32_bf16 v[196:199],a[116:119],v[76:79],v[196:199]
ds_read_b128 v[72:75],v20 offset:63488
v_mfma_f32_16x16x32_bf16 v[204:207],v[76:79],a[244:247],v[204:207]
buffer_load_dwordx4 v16,s[20:23],s69 offen offset:3072 lds
s_waitcnt lgkmcnt(2)
v_mfma_f32_16x16x32_bf16 v[192:195],a[120:123],v[64:67],v[192:195]
ds_read_b128 v[76:79],v20 offset:64512
v_mfma_f32_16x16x32_bf16 v[200:203],v[64:67],a[248:251],v[200:203]
s_add_u32 m0,s62,40960
s_add_u32 s69,s78,40960
s_waitcnt lgkmcnt(2)
v_mfma_f32_16x16x32_bf16 v[196:199],a[120:123],v[68:71],v[196:199]
v_mfma_f32_16x16x32_bf16 v[204:207],v[68:71],a[248:251],v[204:207]
buffer_load_dwordx4 v16,s[20:23],s69 offen offset:0 lds
s_waitcnt lgkmcnt(1)
v_mfma_f32_16x16x32_bf16 v[192:195],a[124:127],v[72:75],v[192:195]
v_mfma_f32_16x16x32_bf16 v[200:203],v[72:75],a[252:255],v[200:203]
buffer_load_dwordx4 v16,s[20:23],s69 offen offset:1024 lds
s_waitcnt lgkmcnt(0)
v_mfma_f32_16x16x32_bf16 v[196:199],a[124:127],v[76:79],v[196:199]
v_mfma_f32_16x16x32_bf16 v[204:207],v[76:79],a[252:255],v[204:207]
s_waitcnt vmcnt(26)
ds_write_b32 v21,v25 offset:24
v_xor_b32 v20,0x10000,v20
s_xor_b32 s62,s62,0x10000
s_lshr_b32 s64,s73,9
v_add_u32 v22,s64,v24
v_cvt_pk_bf16_f32 v208,v192,v193
v_cvt_pk_bf16_f32 v209,v194,v195
v_cvt_pk_bf16_f32 v210,v196,v197
v_cvt_pk_bf16_f32 v211,v198,v199
v_cvt_pk_bf16_f32 v212,v200,v201
v_cvt_pk_bf16_f32 v213,v202,v203
v_cvt_pk_bf16_f32 v214,v204,v205
v_cvt_pk_bf16_f32 v215,v206,v207
v_permlane16_swap_b32 v208,v210
v_permlane16_swap_b32 v209,v211
buffer_store_dwordx4 v[208:211],v2,s[24:27],s73 offen
buffer_store_dwordx4 v[208:211],v2,s[28:31],s73 offen sc1
ds_write_b128 v22,v[212:215] offset:16384
buffer_store_dwordx4 v[208:211],v17,s[20:23],s12 offen sc1
bgx_130:
buffer_store_dwordx4 v[100:103],v9,s[24:27],s73 offen
buffer_store_dwordx4 v[100:103],v9,s[28:31],s73 offen sc1
s_mov_b32 exec_hi,0
buffer_store_dwordx4 v[100:103],v8,s[24:27],s73 offen
buffer_store_dwordx4 v[100:103],v8,s[24:27],s71 offen
buffer_store_dwordx4 v[100:103],v8,s[28:31],s73 offen sc1
buffer_store_dwordx4 v[100:103],v8,s[28:31],s71 offen sc1
s_mov_b64 exec,-1
s_waitcnt lgkmcnt(0)
s_add_u32 s63,s79,1
s_and_b32 s64,s63,3
s_lshl_b32 s70,s64,20
s_add_u32 s65,s63,2
s_and_b32 s65,s65,3
s_lshl_b32 s73,s65,20
s_add_u32 s55,s63,3
s_lshl_b32 s78,s55,16
s_add_u32 s78,s78,57344
s_cmp_lt_u32 s55,64
s_cselect_b32 s78,s78,0x7fff0000
s_add_u32 s60,s63,1
s_lshl_b32 s76,s60,21
s_lshl_b32 s55,s60,13
s_and_b32 s55,s55,0x2000
s_xor_b32 s55,s55,s61
s_add_u32 s76,s76,s55
s_cmp_lt_u32 s60,64
s_cselect_b32 s76,s76,0x7fff0000
s_add_u32 s60,s63,2
s_lshl_b32 s12,s60,21
s_lshl_b32 s55,s60,13
s_and_b32 s55,s55,0x2000
s_xor_b32 s55,s55,s61
s_add_u32 s12,s12,s55
s_cmp_lt_u32 s60,64
s_cselect_b32 s12,s12,0x7fff0000
s_add_u32 s71,s73,65536
v_mov_b32 v176,0
v_mov_b32 v177,0
v_mov_b32 v178,0
v_mov_b32 v179,0
v_mov_b32 v180,0
v_mov_b32 v181,0
v_mov_b32 v182,0
v_mov_b32 v183,0
s_add_u32 s79,s79,1
v_add_u32 v25,1,v25
s_waitcnt vmcnt(0)
s_branch loop_124
art_128:
s_sub_u32 s90,s90,1
s_cmp_lt_i32 s90,0
s_cbranch_scc1 abk_129
buffer_load_dwordx4 v[48:51],v27,s[20:23],s70 offen offset:0 sc1
buffer_load_dwordx4 v[52:55],v27,s[20:23],s70 offen offset:1024 sc1
buffer_load_dwordx4 v[56:59],v27,s[20:23],s70 offen offset:2048 sc1
buffer_load_dwordx4 v[60:63],v27,s[20:23],s70 offen offset:3072 sc1
s_waitcnt vmcnt(3)
ds_write_b128 v24,v[48:51] offset:4096
v_min3_u32 v22,v48,v49,v50
v_min_u32 v22,v22,v51
s_waitcnt vmcnt(2)
ds_write_b128 v24,v[52:55] offset:5120
v_min3_u32 v22,v22,v52,v53
v_min3_u32 v22,v22,v54,v55
s_waitcnt vmcnt(1)
ds_write_b128 v24,v[56:59] offset:6144
v_min3_u32 v22,v22,v56,v57
v_min3_u32 v22,v22,v58,v59
s_waitcnt vmcnt(0)
ds_write_b128 v24,v[60:63] offset:7168
v_min3_u32 v22,v22,v60,v61
v_min3_u32 v22,v22,v62,v63
v_cmp_eq_u32 vcc,0,v22
s_cbranch_vccnz art_128
s_branch abk_129
bgsk_131:
s_waitcnt vmcnt(0)
ds_write_b32 v21,v25 offset:24
s_branch bgx_130
first_123:
s_add_u32 s63,s79,0
s_and_b32 s64,s63,3
s_lshl_b32 s70,s64,20
s_add_u32 s65,s63,2
s_and_b32 s65,s65,3
s_lshl_b32 s73,s65,20
s_add_u32 s55,s63,3
s_lshl_b32 s78,s55,16
s_add_u32 s78,s78,57344
s_cmp_lt_u32 s55,64
s_cselect_b32 s78,s78,0x7fff0000
s_add_u32 s60,s63,1
s_lshl_b32 s76,s60,21
s_lshl_b32 s55,s60,13
s_and_b32 s55,s55,0x2000
s_xor_b32 s55,s55,s61
s_add_u32 s76,s76,s55
s_cmp_lt_u32 s60,64
s_cselect_b32 s76,s76,0x7fff0000
s_add_u32 s60,s63,2
s_lshl_b32 s12,s60,21
s_lshl_b32 s55,s60,13
s_and_b32 s55,s55,0x2000
s_xor_b32 s55,s55,s61
s_add_u32 s12,s12,s55
s_cmp_lt_u32 s60,64
s_cselect_b32 s12,s12,0x7fff0000
s_add_u32 s71,s73,65536
v_mov_b32 v176,0
v_mov_b32 v177,0
v_mov_b32 v178,0
v_mov_b32 v179,0
v_mov_b32 v180,0
v_mov_b32 v181,0
v_mov_b32 v182,0
v_mov_b32 v183,0
s_waitcnt vmcnt(0) lgkmcnt(0)
s_barrier
pn1_132:
ds_read_b128 v[64:67],v20 offset:0
ds_read_b128 v[68:71],v20 offset:1024
ds_read_b128 v[72:75],v20 offset:2048
s_waitcnt lgkmcnt(2)
v_mfma_f32_16x16x32_bf16 v[192:195],a[0:3],v[64:67],0
ds_read_b128 v[76:79],v20 offset:3072
v_mfma_f32_16x16x32_bf16 v[200:203],v[64:67],a[128:131],0
s_waitcnt lgkmcnt(2)
v_mfma_f32_16x16x32_bf16 v[196:199],a[0:3],v[68:71],0
ds_read_b128 v[64:67],v20 offset:4096
v_mfma_f32_16x16x32_bf16 v[204:207],v[68:71],a[128:131],0
s_waitcnt lgkmcnt(2)
v_mfma_f32_16x16x32_bf16 v[192:195],a[4:7],v[72:75],v[192:195]
ds_read_b128 v[68:71],v20 offset:5120
v_mfma_f32_16x16x32_bf16 v[200:203],v[72:75],a[132:135],v[200:203]
s_waitcnt lgkmcnt(2)
v_mfma_f32_16x16x32_bf16 v[196:199],a[4:7],v[76:79],v[196:199]
ds_read_b128 v[72:75],v20 offset:6144
v_mfma_f32_16x16x32_bf16 v[204:207],v[76:79],a[132:135],v[204:207]
s_waitcnt lgkmcnt(2)
v_mfma_f32_16x16x32_bf16 v[192:195],a[8:11],v[64:67],v[192:195]
ds_read_b128 v[76:79],v20 offset:7168
v_mfma_f32_16x16x32_bf16 v[200:203],v[64:67],a[136:139],v[200:203]
s_waitcnt lgkmcnt(2)
v_mfma_f32_16x16x32_bf16 v[196:199],a[8:11],v[68:71],v[196:199]
ds_read_b128 v[64:67],v20 offset:8192
v_mfma_f32_16x16x32_bf16 v[204:207],v[68:71],a[136:139],v[204:207]
s_waitcnt lgkmcnt(2)
v_mfma_f32_16x16x32_bf16 v[192:195],a[12:15],v[72:75],v[192:195]
ds_read_b128 v[68:71],v20 offset:9216
v_mfma_f32_16x16x32_bf16 v[200:203],v[72:75],a[140:143],v[200:203]
s_waitcnt lgkmcnt(2)
v_mfma_f32_16x16x32_bf16 v[196:199],a[12:15],v[76:79],v[196:199]
ds_read_b128 v[72:75],v20 offset:10240
v_mfma_f32_16x16x32_bf16 v[204:207],v[76:79],a[140:143],v[204:207]
s_waitcnt lgkmcnt(2)
v_mfma_f32_16x16x32_bf16 v[192:195],a[16:19],v[64:67],v[192:195]
ds_read_b128 v[76:79],v20 offset:11264
v_mfma_f32_16x16x32_bf16 v[200:203],v[64:67],a[144:147],v[200:203]
s_waitcnt lgkmcnt(2)
v_mfma_f32_16x16x32_bf16 v[196:199],a[16:19],v[68:71],v[196:199]
ds_read_b128 v[64:67],v20 offset:12288
v_mfma_f32_16x16x32_bf16 v[204:207],v[68:71],a[144:147],v[204:207]
s_waitcnt lgkmcnt(2)
v_mfma_f32_16x16x32_bf16 v[192:195],a[20:23],v[72:75],v[192:195]
ds_read_b128 v[68:71],v20 offset:13312
v_mfma_f32_16x16x32_bf16 v[200:203],v[72:75],a[148:151],v[200:203]
s_waitcnt lgkmcnt(2)
v_mfma_f32_16x16x32_bf16 v[196:199],a[20:23],v[76:79],v[196:199]
ds_read_b128 v[72:75],v20 offset:14336
v_mfma_f32_16x16x32_bf16 v[204:207],v[76:79],a[148:151],v[204:207]
s_waitcnt lgkmcnt(2)
v_mfma_f32_16x16x32_bf16 v[192:195],a[24:27],v[64:67],v[192:195]
ds_read_b128 v[76:79],v20 offset:15360
v_mfma_f32_16x16x32_bf16 v[200:203],v[64:67],a[152:155],v[200:203]
s_waitcnt lgkmcnt(2)
v_mfma_f32_16x16x32_bf16 v[196:199],a[24:27],v[68:71],v[196:199]
ds_read_b128 v[64:67],v20 offset:16384
v_mfma_f32_16x16x32_bf16 v[204:207],v[68:71],a[152:155],v[204:207]
s_waitcnt lgkmcnt(2)
v_mfma_f32_16x16x32_bf16 v[192:195],a[28:31],v[72:75],v[192:195]
ds_read_b128 v[68:71],v20 offset:17408
v_mfma_f32_16x16x32_bf16 v[200:203],v[72:75],a[156:159],v[200:203]
s_waitcnt lgkmcnt(2)
v_mfma_f32_16x16x32_bf16 v[196:199],a[28:31],v[76:79],v[196:199]
ds_read_b128 v[72:75],v20 offset:18432
v_mfma_f32_16x16x32_bf16 v[204:207],v[76:79],a[156:159],v[204:207]
s_waitcnt lgkmcnt(2)
v_mfma_f32_16x16x32_bf16 v[192:195],a[32:35],v[64:67],v[192:195]
ds_read_b128 v[76:79],v20 offset:19456
v_mfma_f32_16x16x32_bf16 v[200:203],v[64:67],a[160:163],v[200:203]
s_waitcnt lgkmcnt(2)
v_mfma_f32_16x16x32_bf16 v[196:199],a[32:35],v[68:71],v[196:199]
ds_read_b128 v[64:67],v20 offset:20480
v_mfma_f32_16x16x32_bf16 v[204:207],v[68:71],a[160:163],v[204:207]
s_waitcnt lgkmcnt(2)
v_mfma_f32_16x16x32_bf16 v[192:195],a[36:39],v[72:75],v[192:195]
ds_read_b128 v[68:71],v20 offset:21504
v_mfma_f32_16x16x32_bf16 v[200:203],v[72:75],a[164:167],v[200:203]
s_waitcnt lgkmcnt(2)
v_mfma_f32_16x16x32_bf16 v[196:199],a[36:39],v[76:79],v[196:199]
ds_read_b128 v[72:75],v20 offset:22528
v_mfma_f32_16x16x32_bf16 v[204:207],v[76:79],a[164:167],v[204:207]
s_waitcnt lgkmcnt(2)
v_mfma_f32_16x16x32_bf16 v[192:195],a[40:43],v[64:67],v[192:195]
ds_read_b128 v[76:79],v20 offset:23552
v_mfma_f32_16x16x32_bf16 v[200:203],v[64:67],a[168:171],v[200:203]
s_waitcnt lgkmcnt(2)
v_mfma_f32_16x16x32_bf16 v[196:199],a[40:43],v[68:71],v[196:199]
ds_read_b128 v[64:67],v20 offset:24576
v_mfma_f32_16x16x32_bf16 v[204:207],v[68:71],a[168:171],v[204:207]
s_waitcnt lgkmcnt(2)
v_mfma_f32_16x16x32_bf16 v[192:195],a[44:47],v[72:75],v[192:195]
ds_read_b128 v[68:71],v20 offset:25600
v_mfma_f32_16x16x32_bf16 v[200:203],v[72:75],a[172:175],v[200:203]
s_waitcnt lgkmcnt(2)
v_mfma_f32_16x16x32_bf16 v[196:199],a[44:47],v[76:79],v[196:199]
ds_read_b128 v[72:75],v20 offset:26624
v_mfma_f32_16x16x32_bf16 v[204:207],v[76:79],a[172:175],v[204:207]
s_waitcnt lgkmcnt(2)
v_mfma_f32_16x16x32_bf16 v[192:195],a[48:51],v[64:67],v[192:195]
ds_read_b128 v[76:79],v20 offset:27648
v_mfma_f32_16x16x32_bf16 v[200:203],v[64:67],a[176:179],v[200:203]
s_waitcnt lgkmcnt(2)
v_mfma_f32_16x16x32_bf16 v[196:199],a[48:51],v[68:71],v[196:199]
ds_read_b128 v[64:67],v20 offset:28672
v_mfma_f32_16x16x32_bf16 v[204:207],v[68:71],a[176:179],v[204:207]
s_waitcnt lgkmcnt(2)
v_mfma_f32_16x16x32_bf16 v[192:195],a[52:55],v[72:75],v[192:195]
ds_read_b128 v[68:71],v20 offset:29696
v_mfma_f32_16x16x32_bf16 v[200:203],v[72:75],a[180:183],v[200:203]
s_waitcnt lgkmcnt(2)
v_mfma_f32_16x16x32_bf16 v[196:199],a[52:55],v[76:79],v[196:199]
ds_read_b128 v[72:75],v20 offset:30720
v_mfma_f32_16x16x32_bf16 v[204:207],v[76:79],a[180:183],v[204:207]
s_waitcnt lgkmcnt(2)
v_mfma_f32_16x16x32_bf16 v[192:195],a[56:59],v[64:67],v[192:195]
ds_read_b128 v[76:79],v20 offset:31744
v_mfma_f32_16x16x32_bf16 v[200:203],v[64:67],a[184:187],v[200:203]
s_waitcnt lgkmcnt(2)
v_mfma_f32_16x16x32_bf16 v[196:199],a[56:59],v[68:71],v[196:199]
ds_read_b128 v[64:67],v20 offset:32768
v_mfma_f32_16x16x32_bf16 v[204:207],v[68:71],a[184:187],v[204:207]
s_waitcnt lgkmcnt(2)
v_mfma_f32_16x16x32_bf16 v[192:195],a[60:63],v[72:75],v[192:195]
ds_read_b128 v[68:71],v20 offset:33792
v_mfma_f32_16x16x32_bf16 v[200:203],v[72:75],a[188:191],v[200:203]
s_waitcnt lgkmcnt(2)
v_mfma_f32_16x16x32_bf16 v[196:199],a[60:63],v[76:79],v[196:199]
ds_read_b128 v[72:75],v20 offset:34816
v_mfma_f32_16x16x32_bf16 v[204:207],v[76:79],a[188:191],v[204:207]
s_waitcnt lgkmcnt(2)
v_mfma_f32_16x16x32_bf16 v[192:195],a[64:67],v[64:67],v[192:195]
ds_read_b128 v[76:79],v20 offset:35840
v_mfma_f32_16x16x32_bf16 v[200:203],v[64:67],a[192:195],v[200:203]
s_waitcnt lgkmcnt(2)
v_mfma_f32_16x16x32_bf16 v[196:199],a[64:67],v[68:71],v[196:199]
ds_read_b128 v[64:67],v20 offset:36864
v_mfma_f32_16x16x32_bf16 v[204:207],v[68:71],a[192:195],v[204:207]
s_waitcnt lgkmcnt(2)
v_mfma_f32_16x16x32_bf16 v[192:195],a[68:71],v[72:75],v[192:195]
ds_read_b128 v[68:71],v20 offset:37888
v_mfma_f32_16x16x32_bf16 v[200:203],v[72:75],a[196:199],v[200:203]
s_waitcnt lgkmcnt(2)
v_mfma_f32_16x16x32_bf16 v[196:199],a[68:71],v[76:79],v[196:199]
ds_read_b128 v[72:75],v20 offset:38912
v_mfma_f32_16x16x32_bf16 v[204:207],v[76:79],a[196:199],v[204:207]
s_waitcnt lgkmcnt(2)
v_mfma_f32_16x16x32_bf16 v[192:195],a[72:75],v[64:67],v[192:195]
ds_read_b128 v[76:79],v20 offset:39936
v_mfma_f32_16x16x32_bf16 v[200:203],v[64:67],a[200:203],v[200:203]
s_waitcnt lgkmcnt(2)
v_mfma_f32_16x16x32_bf16 v[196:199],a[72:75],v[68:71],v[196:199]
ds_read_b128 v[64:67],v20 offset:40960
v_mfma_f32_16x16x32_bf16 v[204:207],v[68:71],a[200:203],v[204:207]
s_waitcnt lgkmcnt(2)
v_mfma_f32_16x16x32_bf16 v[192:195],a[76:79],v[72:75],v[192:195]
ds_read_b128 v[68:71],v20 offset:41984
v_mfma_f32_16x16x32_bf16 v[200:203],v[72:75],a[204:207],v[200:203]
s_waitcnt lgkmcnt(2)
v_mfma_f32_16x16x32_bf16 v[196:199],a[76:79],v[76:79],v[196:199]
ds_read_b128 v[72:75],v20 offset:43008
v_mfma_f32_16x16x32_bf16 v[204:207],v[76:79],a[204:207],v[204:207]
s_waitcnt lgkmcnt(2)
v_mfma_f32_16x16x32_bf16 v[192:195],a[80:83],v[64:67],v[192:195]
ds_read_b128 v[76:79],v20 offset:44032
v_mfma_f32_16x16x32_bf16 v[200:203],v[64:67],a[208:211],v[200:203]
s_waitcnt lgkmcnt(2)
v_mfma_f32_16x16x32_bf16 v[196:199],a[80:83],v[68:71],v[196:199]
ds_read_b128 v[64:67],v20 offset:45056
v_mfma_f32_16x16x32_bf16 v[204:207],v[68:71],a[208:211],v[204:207]
s_waitcnt lgkmcnt(2)
v_mfma_f32_16x16x32_bf16 v[192:195],a[84:87],v[72:75],v[192:195]
ds_read_b128 v[68:71],v20 offset:46080
v_mfma_f32_16x16x32_bf16 v[200:203],v[72:75],a[212:215],v[200:203]
s_waitcnt lgkmcnt(2)
v_mfma_f32_16x16x32_bf16 v[196:199],a[84:87],v[76:79],v[196:199]
ds_read_b128 v[72:75],v20 offset:47104
v_mfma_f32_16x16x32_bf16 v[204:207],v[76:79],a[212:215],v[204:207]
s_waitcnt lgkmcnt(2)
v_mfma_f32_16x16x32_bf16 v[192:195],a[88:91],v[64:67],v[192:195]
ds_read_b128 v[76:79],v20 offset:48128
v_mfma_f32_16x16x32_bf16 v[200:203],v[64:67],a[216:219],v[200:203]
s_waitcnt lgkmcnt(2)
v_mfma_f32_16x16x32_bf16 v[196:199],a[88:91],v[68:71],v[196:199]
ds_read_b128 v[64:67],v20 offset:49152
v_mfma_f32_16x16x32_bf16 v[204:207],v[68:71],a[216:219],v[204:207]
s_waitcnt lgkmcnt(2)
v_mfma_f32_16x16x32_bf16 v[192:195],a[92:95],v[72:75],v[192:195]
ds_read_b128 v[68:71],v20 offset:50176
v_mfma_f32_16x16x32_bf16 v[200:203],v[72:75],a[220:223],v[200:203]
s_waitcnt lgkmcnt(2)
v_mfma_f32_16x16x32_bf16 v[196:199],a[92:95],v[76:79],v[196:199]
ds_read_b128 v[72:75],v20 offset:51200
v_mfma_f32_16x16x32_bf16 v[204:207],v[76:79],a[220:223],v[204:207]
s_waitcnt lgkmcnt(2)
v_mfma_f32_16x16x32_bf16 v[192:195],a[96:99],v[64:67],v[192:195]
ds_read_b128 v[76:79],v20 offset:52224
v_mfma_f32_16x16x32_bf16 v[200:203],v[64:67],a[224:227],v[200:203]
s_waitcnt lgkmcnt(2)
v_mfma_f32_16x16x32_bf16 v[196:199],a[96:99],v[68:71],v[196:199]
ds_read_b128 v[64:67],v20 offset:53248
v_mfma_f32_16x16x32_bf16 v[204:207],v[68:71],a[224:227],v[204:207]
s_waitcnt lgkmcnt(2)
v_mfma_f32_16x16x32_bf16 v[192:195],a[100:103],v[72:75],v[192:195]
ds_read_b128 v[68:71],v20 offset:54272
v_mfma_f32_16x16x32_bf16 v[200:203],v[72:75],a[228:231],v[200:203]
s_waitcnt lgkmcnt(2)
v_mfma_f32_16x16x32_bf16 v[196:199],a[100:103],v[76:79],v[196:199]
ds_read_b128 v[72:75],v20 offset:55296
v_mfma_f32_16x16x32_bf16 v[204:207],v[76:79],a[228:231],v[204:207]
s_waitcnt lgkmcnt(2)
v_mfma_f32_16x16x32_bf16 v[192:195],a[104:107],v[64:67],v[192:195]
ds_read_b128 v[76:79],v20 offset:56320
v_mfma_f32_16x16x32_bf16 v[200:203],v[64:67],a[232:235],v[200:203]
s_waitcnt lgkmcnt(2)
v_mfma_f32_16x16x32_bf16 v[196:199],a[104:107],v[68:71],v[196:199]
ds_read_b128 v[64:67],v20 offset:57344
v_mfma_f32_16x16x32_bf16 v[204:207],v[68:71],a[232:235],v[204:207]
s_waitcnt lgkmcnt(2)
v_mfma_f32_16x16x32_bf16 v[192:195],a[108:111],v[72:75],v[192:195]
ds_read_b128 v[68:71],v20 offset:58368
v_mfma_f32_16x16x32_bf16 v[200:203],v[72:75],a[236:239],v[200:203]
s_waitcnt lgkmcnt(2)
v_mfma_f32_16x16x32_bf16 v[196:199],a[108:111],v[76:79],v[196:199]
ds_read_b128 v[72:75],v20 offset:59392
v_mfma_f32_16x16x32_bf16 v[204:207],v[76:79],a[236:239],v[204:207]
s_waitcnt lgkmcnt(2)
v_mfma_f32_16x16x32_bf16 v[192:195],a[112:115],v[64:67],v[192:195]
ds_read_b128 v[76:79],v20 offset:60416
v_mfma_f32_16x16x32_bf16 v[200:203],v[64:67],a[240:243],v[200:203]
s_waitcnt lgkmcnt(2)
v_mfma_f32_16x16x32_bf16 v[196:199],a[112:115],v[68:71],v[196:199]
ds_read_b128 v[64:67],v20 offset:61440
v_mfma_f32_16x16x32_bf16 v[204:207],v[68:71],a[240:243],v[204:207]
s_waitcnt lgkmcnt(2)
v_mfma_f32_16x16x32_bf16 v[192:195],a[116:119],v[72:75],v[192:195]
ds_read_b128 v[68:71],v20 offset:62464
v_mfma_f32_16x16x32_bf16 v[200:203],v[72:75],a[244:247],v[200:203]
s_waitcnt lgkmcnt(2)
v_mfma_f32_16x16x32_bf16 v[196:199],a[116:119],v[76:79],v[196:199]
ds_read_b128 v[72:75],v20 offset:63488
v_mfma_f32_16x16x32_bf16 v[204:207],v[76:79],a[244:247],v[204:207]
s_waitcnt lgkmcnt(2)
v_mfma_f32_16x16x32_bf16 v[192:195],a[120:123],v[64:67],v[192:195]
ds_read_b128 v[76:79],v20 offset:64512
v_mfma_f32_16x16x32_bf16 v[200:203],v[64:67],a[248:251],v[200:203]
s_waitcnt lgkmcnt(2)
v_mfma_f32_16x16x32_bf16 v[196:199],a[120:123],v[68:71],v[196:199]
v_mfma_f32_16x16x32_bf16 v[204:207],v[68:71],a[248:251],v[204:207]
s_waitcnt lgkmcnt(1)
v_mfma_f32_16x16x32_bf16 v[192:195],a[124:127],v[72:75],v[192:195]
v_mfma_f32_16x16x32_bf16 v[200:203],v[72:75],a[252:255],v[200:203]
s_waitcnt lgkmcnt(0)
v_mfma_f32_16x16x32_bf16 v[196:199],a[124:127],v[76:79],v[196:199]
v_mfma_f32_16x16x32_bf16 v[204:207],v[76:79],a[252:255],v[204:207]
v_xor_b32 v20,0x10000,v20
s_xor_b32 s62,s62,0x10000
s_lshr_b32 s64,s73,9
v_add_u32 v22,s64,v24
v_cvt_pk_bf16_f32 v208,v192,v193
v_cvt_pk_bf16_f32 v209,v194,v195
s_nop 0
v_cvt_pk_bf16_f32 v210,v196,v197
v_cvt_pk_bf16_f32 v211,v198,v199
v_cvt_pk_bf16_f32 v212,v200,v201
v_cvt_pk_bf16_f32 v213,v202,v203
v_cvt_pk_bf16_f32 v214,v204,v205
v_cvt_pk_bf16_f32 v215,v206,v207
v_permlane16_swap_b32 v208,v210
v_permlane16_swap_b32 v209,v211
buffer_store_dwordx4 v[208:211],v2,s[24:27],s73 offen
buffer_store_dwordx4 v[208:211],v2,s[28:31],s73 offen sc1
ds_write_b128 v22,v[212:215] offset:16384
buffer_store_dwordx4 v[208:211],v17,s[20:23],s12 offen sc1
bgx_134:
s_add_u32 s63,s79,1
s_and_b32 s64,s63,3
s_lshl_b32 s70,s64,20
s_add_u32 s65,s63,2
s_and_b32 s65,s65,3
s_lshl_b32 s73,s65,20
s_add_u32 s55,s63,3
s_lshl_b32 s78,s55,16
s_add_u32 s78,s78,57344
s_cmp_lt_u32 s55,64
s_cselect_b32 s78,s78,0x7fff0000
s_add_u32 s60,s63,1
s_lshl_b32 s76,s60,21
s_lshl_b32 s55,s60,13
s_and_b32 s55,s55,0x2000
s_xor_b32 s55,s55,s61
s_add_u32 s76,s76,s55
s_cmp_lt_u32 s60,64
s_cselect_b32 s76,s76,0x7fff0000
s_add_u32 s60,s63,2
s_lshl_b32 s12,s60,21
s_lshl_b32 s55,s60,13
s_and_b32 s55,s55,0x2000
s_xor_b32 s55,s55,s61
s_add_u32 s12,s12,s55
s_cmp_lt_u32 s60,64
s_cselect_b32 s12,s12,0x7fff0000
s_add_u32 s71,s73,65536
v_mov_b32 v176,0
v_mov_b32 v177,0
v_mov_b32 v178,0
v_mov_b32 v179,0
v_mov_b32 v180,0
v_mov_b32 v181,0
v_mov_b32 v182,0
v_mov_b32 v183,0
s_add_u32 s79,s79,1
s_cmp_eq_u32 s79,0
s_cbranch_scc1 pn2_133
v_mov_b32 v38,1
ds_write_b32 v37,v38 offset:8
buffer_store_dwordx4 v[212:215],v12,s[20:23],s76 offen sc1
s_waitcnt lgkmcnt(0)
s_branch pn1_132
pn2_133:
v_mov_b32 v25,1
s_waitcnt vmcnt(1) lgkmcnt(0)
s_barrier
s_branch loop_124
w2_60:
s_lshr_b32 s64,s57,2
s_add_u32 s64,s64,64
s_lshl_b32 s64,s64,14
s_add_u32 s64,s64,s68
s_add_u32 s64,s64,29361152
v_add_u32 v12,s64,v16
v_and_b32 v22,1,v4
v_lshrrev_b32 v23,1,v4
v_lshl_add_u32 v22,v22,1,v23
v_lshlrev_b32 v22,2,v22
v_lshl_add_u32 v22,v3,4,v22
v_add_u32 v31,155904,v22
s_branch first_135
loop_136:
s_barrier
buffer_load_dword v248,v18,s[20:23],s70 offen offset:0 sc1
s_nop 15
s_nop 5
hl_138:
buffer_load_dword v249,v18,s[20:23],s70 offen offset:0 sc1
s_waitcnt vmcnt(1)
v_cmp_eq_u32 vcc,v25,v248
s_bcnt1_i32_b32 s64,vcc_lo
s_cmp_ge_u32 s64,8
s_cbranch_scc1 hg_139
buffer_load_dword v248,v18,s[20:23],s70 offen offset:0 sc1
s_waitcnt vmcnt(1)
v_cmp_eq_u32 vcc,v25,v249
s_bcnt1_i32_b32 s64,vcc_lo
s_cmp_ge_u32 s64,8
s_cbranch_scc1 hg_139
s_sub_u32 s90,s90,1
s_cmp_gt_i32 s90,0
s_cbranch_scc1 hl_138
hg_139:
buffer_load_dwordx4 v[64:67],v28,s[20:23],s70 offen offset:0 sc1
buffer_load_dwordx4 v[68:71],v28,s[20:23],s70 offen offset:1024 sc1
buffer_load_dwordx4 v[72:75],v28,s[20:23],s70 offen offset:2048 sc1
buffer_load_dwordx4 v[76:79],v28,s[20:23],s70 offen offset:3072 sc1
s_waitcnt vmcnt(3)
ds_write_b128 v24,v[64:67] offset:8192
v_min3_u32 v22,v64,v65,v66
v_min_u32 v22,v22,v67
s_waitcnt vmcnt(2)
ds_write_b128 v24,v[68:71] offset:9216
v_min3_u32 v22,v22,v68,v69
v_min3_u32 v22,v22,v70,v71
s_waitcnt vmcnt(1)
ds_write_b128 v24,v[72:75] offset:10240
v_min3_u32 v22,v22,v72,v73
v_min3_u32 v22,v22,v74,v75
s_waitcnt vmcnt(0)
ds_write_b128 v24,v[76:79] offset:11264
v_min3_u32 v22,v22,v76,v77
v_min3_u32 v22,v22,v78,v79
v_cmp_eq_u32 vcc,0,v22
s_cbranch_vccnz art_140
abk_141:
v_smfmac_f32_16x16x64_bf16 v[176:179],v[64:67],a[64:71],v14
s_waitcnt lgkmcnt(0)
s_barrier
ds_read_b128 v[80:83],v24 offset:12288
ds_read_b128 v[84:87],v24 offset:13312
ds_read_b128 v[88:91],v24 offset:14336
ds_read_b128 v[92:95],v24 offset:15360
buffer_store_dwordx4 v[212:215],v12,s[20:23],s76 offen sc1
v_smfmac_f32_16x16x64_bf16 v[176:179],v[68:71],a[72:79],v14
ds_read_b128 v[32:35],v24 offset:0
ds_read_b128 v[36:39],v24 offset:1024
v_smfmac_f32_16x16x64_bf16 v[176:179],v[72:75],a[80:87],v14
ds_read_b128 v[40:43],v24 offset:2048
ds_read_b128 v[44:47],v24 offset:3072
v_smfmac_f32_16x16x64_bf16 v[176:179],v[76:79],a[88:95],v14
ds_read_b128 v[48:51],v24 offset:4096
ds_read_b128 v[52:55],v24 offset:5120
s_waitcnt lgkmcnt(9)
v_smfmac_f32_16x16x64_bf16 v[176:179],v[80:83],a[96:103],v14
ds_read_b128 v[56:59],v24 offset:6144
s_waitcnt lgkmcnt(9)
v_smfmac_f32_16x16x64_bf16 v[176:179],v[84:87],a[104:111],v14
ds_read_b128 v[60:63],v24 offset:7168
s_waitcnt lgkmcnt(9)
v_smfmac_f32_16x16x64_bf16 v[176:179],v[88:91],a[112:119],v14
s_waitcnt lgkmcnt(8)
v_smfmac_f32_16x16x64_bf16 v[176:179],v[92:95],a[120:127],v14
s_waitcnt lgkmcnt(7)
v_smfmac_f32_16x16x64_bf16 v[176:179],v[32:35],a[0:7],v14
s_waitcnt lgkmcnt(6)
v_smfmac_f32_16x16x64_bf16 v[176:179],v[36:39],a[8:15],v14
s_waitcnt lgkmcnt(5)
v_smfmac_f32_16x16x64_bf16 v[176:179],v[40:43],a[16:23],v14
s_waitcnt lgkmcnt(4)
v_smfmac_f32_16x16x64_bf16 v[176:179],v[44:47],a[24:31],v14
s_waitcnt lgkmcnt(3)
v_smfmac_f32_16x16x64_bf16 v[176:179],v[48:51],a[32:39],v14
s_waitcnt lgkmcnt(2)
v_smfmac_f32_16x16x64_bf16 v[176:179],v[52:55],a[40:47],v14
s_waitcnt lgkmcnt(1)
v_smfmac_f32_16x16x64_bf16 v[176:179],v[56:59],a[48:55],v14
s_waitcnt lgkmcnt(0)
v_smfmac_f32_16x16x64_bf16 v[176:179],v[60:63],a[56:63],v14
v_smfmac_f32_16x16x64_bf16 v[180:183],v[32:35],a[128:135],v14
v_smfmac_f32_16x16x64_bf16 v[180:183],v[36:39],a[136:143],v14
s_nop 5
v_permlane32_swap_b32 v176,v178
v_permlane32_swap_b32 v177,v179
v_add_f32 v176,v176,v178
v_add_f32 v177,v177,v179
v_cvt_pk_bf16_f32 v216,v176,v177
s_nop 1
v_mov_b32_dpp v217,v216 quad_perm:[1,0,3,2] row_mask:0xf bank_mask:0xf
v_perm_b32 v216,v217,v216,v15
v_max_u32 v216,1,v216
buffer_store_dword v216,v19,s[24:27],s70 offen
buffer_store_dword v216,v19,s[28:31],s70 offen sc1
v_smfmac_f32_16x16x64_bf16 v[180:183],v[40:43],a[144:151],v14
v_smfmac_f32_16x16x64_bf16 v[180:183],v[44:47],a[152:159],v14
v_smfmac_f32_16x16x64_bf16 v[180:183],v[48:51],a[160:167],v14
v_smfmac_f32_16x16x64_bf16 v[180:183],v[52:55],a[168:175],v14
v_smfmac_f32_16x16x64_bf16 v[180:183],v[56:59],a[176:183],v14
v_smfmac_f32_16x16x64_bf16 v[180:183],v[60:63],a[184:191],v14
v_smfmac_f32_16x16x64_bf16 v[180:183],v[64:67],a[192:199],v14
v_smfmac_f32_16x16x64_bf16 v[180:183],v[68:71],a[200:207],v14
v_smfmac_f32_16x16x64_bf16 v[180:183],v[72:75],a[208:215],v14
v_smfmac_f32_16x16x64_bf16 v[180:183],v[76:79],a[216:223],v14
v_smfmac_f32_16x16x64_bf16 v[180:183],v[80:83],a[224:231],v14
v_smfmac_f32_16x16x64_bf16 v[180:183],v[84:87],a[232:239],v14
v_smfmac_f32_16x16x64_bf16 v[180:183],v[88:91],a[240:247],v14
v_smfmac_f32_16x16x64_bf16 v[180:183],v[92:95],a[248:255],v14
s_nop 7
v_permlane32_swap_b32 v180,v182
v_permlane32_swap_b32 v181,v183
v_add_f32 v180,v180,v182
v_add_f32 v181,v181,v183
v_cvt_pk_bf16_f32 v216,v180,v181
v_max_u32 v216,1,v216
ds_write_b32 v31,v216
ds_write_b32 v21,v25 offset:4
s_cmp_eq_u32 s79,63
s_cbranch_scc1 end_57
s_cmp_ge_i32 s79,62
s_cbranch_scc1 bgsk_143
ds_read_b128 v[64:67],v20 offset:0
ds_read_b128 v[68:71],v20 offset:1024
ds_read_b128 v[72:75],v20 offset:2048
s_waitcnt lgkmcnt(2)
v_mfma_f32_16x16x32_bf16 v[192:195],a[0:3],v[64:67],0
ds_read_b128 v[76:79],v20 offset:3072
v_mfma_f32_16x16x32_bf16 v[200:203],v[64:67],a[128:131],0
s_waitcnt lgkmcnt(2)
v_mfma_f32_16x16x32_bf16 v[196:199],a[0:3],v[68:71],0
ds_read_b128 v[64:67],v20 offset:4096
v_mfma_f32_16x16x32_bf16 v[204:207],v[68:71],a[128:131],0
s_waitcnt lgkmcnt(2)
v_mfma_f32_16x16x32_bf16 v[192:195],a[4:7],v[72:75],v[192:195]
ds_read_b128 v[68:71],v20 offset:5120
v_mfma_f32_16x16x32_bf16 v[200:203],v[72:75],a[132:135],v[200:203]
s_waitcnt lgkmcnt(2)
v_mfma_f32_16x16x32_bf16 v[196:199],a[4:7],v[76:79],v[196:199]
ds_read_b128 v[72:75],v20 offset:6144
v_mfma_f32_16x16x32_bf16 v[204:207],v[76:79],a[132:135],v[204:207]
s_waitcnt lgkmcnt(2)
v_mfma_f32_16x16x32_bf16 v[192:195],a[8:11],v[64:67],v[192:195]
ds_read_b128 v[76:79],v20 offset:7168
v_mfma_f32_16x16x32_bf16 v[200:203],v[64:67],a[136:139],v[200:203]
s_waitcnt lgkmcnt(2)
v_mfma_f32_16x16x32_bf16 v[196:199],a[8:11],v[68:71],v[196:199]
ds_read_b128 v[64:67],v20 offset:8192
v_mfma_f32_16x16x32_bf16 v[204:207],v[68:71],a[136:139],v[204:207]
s_waitcnt lgkmcnt(2)
v_mfma_f32_16x16x32_bf16 v[192:195],a[12:15],v[72:75],v[192:195]
ds_read_b128 v[68:71],v20 offset:9216
v_mfma_f32_16x16x32_bf16 v[200:203],v[72:75],a[140:143],v[200:203]
s_waitcnt lgkmcnt(2)
v_mfma_f32_16x16x32_bf16 v[196:199],a[12:15],v[76:79],v[196:199]
ds_read_b128 v[72:75],v20 offset:10240
v_mfma_f32_16x16x32_bf16 v[204:207],v[76:79],a[140:143],v[204:207]
s_add_u32 m0,s62,16384
s_add_u32 s69,s78,16384
s_waitcnt lgkmcnt(2)
v_mfma_f32_16x16x32_bf16 v[192:195],a[16:19],v[64:67],v[192:195]
ds_read_b128 v[76:79],v20 offset:11264
v_mfma_f32_16x16x32_bf16 v[200:203],v[64:67],a[144:147],v[200:203]
buffer_load_dwordx4 v16,s[20:23],s69 offen offset:0 lds
s_waitcnt lgkmcnt(2)
v_mfma_f32_16x16x32_bf16 v[196:199],a[16:19],v[68:71],v[196:199]
ds_read_b128 v[64:67],v20 offset:12288
v_mfma_f32_16x16x32_bf16 v[204:207],v[68:71],a[144:147],v[204:207]
buffer_load_dwordx4 v16,s[20:23],s69 offen offset:1024 lds
s_waitcnt lgkmcnt(2)
v_mfma_f32_16x16x32_bf16 v[192:195],a[20:23],v[72:75],v[192:195]
ds_read_b128 v[68:71],v20 offset:13312
v_mfma_f32_16x16x32_bf16 v[200:203],v[72:75],a[148:151],v[200:203]
buffer_load_dwordx4 v16,s[20:23],s69 offen offset:2048 lds
s_waitcnt lgkmcnt(2)
v_mfma_f32_16x16x32_bf16 v[196:199],a[20:23],v[76:79],v[196:199]
ds_read_b128 v[72:75],v20 offset:14336
v_mfma_f32_16x16x32_bf16 v[204:207],v[76:79],a[148:151],v[204:207]
buffer_load_dwordx4 v16,s[20:23],s69 offen offset:3072 lds
s_waitcnt lgkmcnt(2)
v_mfma_f32_16x16x32_bf16 v[192:195],a[24:27],v[64:67],v[192:195]
ds_read_b128 v[76:79],v20 offset:15360
v_mfma_f32_16x16x32_bf16 v[200:203],v[64:67],a[152:155],v[200:203]
s_add_u32 m0,s62,20480
s_add_u32 s69,s78,20480
s_waitcnt lgkmcnt(2)
v_mfma_f32_16x16x32_bf16 v[196:199],a[24:27],v[68:71],v[196:199]
ds_read_b128 v[64:67],v20 offset:16384
v_mfma_f32_16x16x32_bf16 v[204:207],v[68:71],a[152:155],v[204:207]
buffer_load_dwordx4 v16,s[20:23],s69 offen offset:0 lds
s_waitcnt lgkmcnt(2)
v_mfma_f32_16x16x32_bf16 v[192:195],a[28:31],v[72:75],v[192:195]
ds_read_b128 v[68:71],v20 offset:17408
v_mfma_f32_16x16x32_bf16 v[200:203],v[72:75],a[156:159],v[200:203]
buffer_load_dwordx4 v16,s[20:23],s69 offen offset:1024 lds
s_waitcnt lgkmcnt(2)
v_mfma_f32_16x16x32_bf16 v[196:199],a[28:31],v[76:79],v[196:199]
ds_read_b128 v[72:75],v20 offset:18432
v_mfma_f32_16x16x32_bf16 v[204:207],v[76:79],a[156:159],v[204:207]
buffer_load_dwordx4 v16,s[20:23],s69 offen offset:2048 lds
s_waitcnt lgkmcnt(2)
v_mfma_f32_16x16x32_bf16 v[192:195],a[32:35],v[64:67],v[192:195]
ds_read_b128 v[76:79],v20 offset:19456
v_mfma_f32_16x16x32_bf16 v[200:203],v[64:67],a[160:163],v[200:203]
buffer_load_dwordx4 v16,s[20:23],s69 offen offset:3072 lds
s_waitcnt lgkmcnt(2)
v_mfma_f32_16x16x32_bf16 v[196:199],a[32:35],v[68:71],v[196:199]
ds_read_b128 v[64:67],v20 offset:20480
v_mfma_f32_16x16x32_bf16 v[204:207],v[68:71],a[160:163],v[204:207]
s_add_u32 m0,s62,24576
s_add_u32 s69,s78,24576
s_waitcnt lgkmcnt(2)
v_mfma_f32_16x16x32_bf16 v[192:195],a[36:39],v[72:75],v[192:195]
ds_read_b128 v[68:71],v20 offset:21504
v_mfma_f32_16x16x32_bf16 v[200:203],v[72:75],a[164:167],v[200:203]
buffer_load_dwordx4 v16,s[20:23],s69 offen offset:0 lds
s_waitcnt lgkmcnt(2)
v_mfma_f32_16x16x32_bf16 v[196:199],a[36:39],v[76:79],v[196:199]
ds_read_b128 v[72:75],v20 offset:22528
v_mfma_f32_16x16x32_bf16 v[204:207],v[76:79],a[164:167],v[204:207]
buffer_load_dwordx4 v16,s[20:23],s69 offen offset:1024 lds
s_waitcnt lgkmcnt(2)
v_mfma_f32_16x16x32_bf16 v[192:195],a[40:43],v[64:67],v[192:195]
ds_read_b128 v[76:79],v20 offset:23552
v_mfma_f32_16x16x32_bf16 v[200:203],v[64:67],a[168:171],v[200:203]
buffer_load_dwordx4 v16,s[20:23],s69 offen offset:2048 lds
s_waitcnt lgkmcnt(2)
v_mfma_f32_16x16x32_bf16 v[196:199],a[40:43],v[68:71],v[196:199]
ds_read_b128 v[64:67],v20 offset:24576
v_mfma_f32_16x16x32_bf16 v[204:207],v[68:71],a[168:171],v[204:207]
buffer_load_dwordx4 v16,s[20:23],s69 offen offset:3072 lds
s_waitcnt lgkmcnt(2)
v_mfma_f32_16x16x32_bf16 v[192:195],a[44:47],v[72:75],v[192:195]
ds_read_b128 v[68:71],v20 offset:25600
v_mfma_f32_16x16x32_bf16 v[200:203],v[72:75],a[172:175],v[200:203]
s_add_u32 m0,s62,28672
s_add_u32 s69,s78,28672
s_waitcnt lgkmcnt(2)
v_mfma_f32_16x16x32_bf16 v[196:199],a[44:47],v[76:79],v[196:199]
ds_read_b128 v[72:75],v20 offset:26624
v_mfma_f32_16x16x32_bf16 v[204:207],v[76:79],a[172:175],v[204:207]
buffer_load_dwordx4 v16,s[20:23],s69 offen offset:0 lds
s_waitcnt lgkmcnt(2)
v_mfma_f32_16x16x32_bf16 v[192:195],a[48:51],v[64:67],v[192:195]
ds_read_b128 v[76:79],v20 offset:27648
v_mfma_f32_16x16x32_bf16 v[200:203],v[64:67],a[176:179],v[200:203]
buffer_load_dwordx4 v16,s[20:23],s69 offen offset:1024 lds
s_waitcnt lgkmcnt(2)
v_mfma_f32_16x16x32_bf16 v[196:199],a[48:51],v[68:71],v[196:199]
ds_read_b128 v[64:67],v20 offset:28672
v_mfma_f32_16x16x32_bf16 v[204:207],v[68:71],a[176:179],v[204:207]
buffer_load_dwordx4 v16,s[20:23],s69 offen offset:2048 lds
s_waitcnt lgkmcnt(2)
v_mfma_f32_16x16x32_bf16 v[192:195],a[52:55],v[72:75],v[192:195]
ds_read_b128 v[68:71],v20 offset:29696
v_mfma_f32_16x16x32_bf16 v[200:203],v[72:75],a[180:183],v[200:203]
buffer_load_dwordx4 v16,s[20:23],s69 offen offset:3072 lds
s_waitcnt lgkmcnt(2)
v_mfma_f32_16x16x32_bf16 v[196:199],a[52:55],v[76:79],v[196:199]
ds_read_b128 v[72:75],v20 offset:30720
v_mfma_f32_16x16x32_bf16 v[204:207],v[76:79],a[180:183],v[204:207]
s_waitcnt lgkmcnt(2)
v_mfma_f32_16x16x32_bf16 v[192:195],a[56:59],v[64:67],v[192:195]
ds_read_b128 v[76:79],v20 offset:31744
v_mfma_f32_16x16x32_bf16 v[200:203],v[64:67],a[184:187],v[200:203]
s_waitcnt lgkmcnt(2)
v_mfma_f32_16x16x32_bf16 v[196:199],a[56:59],v[68:71],v[196:199]
ds_read_b128 v[64:67],v20 offset:32768
v_mfma_f32_16x16x32_bf16 v[204:207],v[68:71],a[184:187],v[204:207]
s_waitcnt lgkmcnt(2)
v_mfma_f32_16x16x32_bf16 v[192:195],a[60:63],v[72:75],v[192:195]
ds_read_b128 v[68:71],v20 offset:33792
v_mfma_f32_16x16x32_bf16 v[200:203],v[72:75],a[188:191],v[200:203]
s_waitcnt lgkmcnt(2)
v_mfma_f32_16x16x32_bf16 v[196:199],a[60:63],v[76:79],v[196:199]
ds_read_b128 v[72:75],v20 offset:34816
v_mfma_f32_16x16x32_bf16 v[204:207],v[76:79],a[188:191],v[204:207]
s_waitcnt lgkmcnt(2)
v_mfma_f32_16x16x32_bf16 v[192:195],a[64:67],v[64:67],v[192:195]
ds_read_b128 v[76:79],v20 offset:35840
v_mfma_f32_16x16x32_bf16 v[200:203],v[64:67],a[192:195],v[200:203]
s_waitcnt lgkmcnt(2)
v_mfma_f32_16x16x32_bf16 v[196:199],a[64:67],v[68:71],v[196:199]
ds_read_b128 v[64:67],v20 offset:36864
v_mfma_f32_16x16x32_bf16 v[204:207],v[68:71],a[192:195],v[204:207]
s_waitcnt lgkmcnt(2)
v_mfma_f32_16x16x32_bf16 v[192:195],a[68:71],v[72:75],v[192:195]
ds_read_b128 v[68:71],v20 offset:37888
v_mfma_f32_16x16x32_bf16 v[200:203],v[72:75],a[196:199],v[200:203]
s_waitcnt lgkmcnt(2)
v_mfma_f32_16x16x32_bf16 v[196:199],a[68:71],v[76:79],v[196:199]
ds_read_b128 v[72:75],v20 offset:38912
v_mfma_f32_16x16x32_bf16 v[204:207],v[76:79],a[196:199],v[204:207]
s_waitcnt lgkmcnt(2)
v_mfma_f32_16x16x32_bf16 v[192:195],a[72:75],v[64:67],v[192:195]
ds_read_b128 v[76:79],v20 offset:39936
v_mfma_f32_16x16x32_bf16 v[200:203],v[64:67],a[200:203],v[200:203]
s_waitcnt lgkmcnt(2)
v_mfma_f32_16x16x32_bf16 v[196:199],a[72:75],v[68:71],v[196:199]
ds_read_b128 v[64:67],v20 offset:40960
v_mfma_f32_16x16x32_bf16 v[204:207],v[68:71],a[200:203],v[204:207]
s_waitcnt lgkmcnt(2)
v_mfma_f32_16x16x32_bf16 v[192:195],a[76:79],v[72:75],v[192:195]
ds_read_b128 v[68:71],v20 offset:41984
v_mfma_f32_16x16x32_bf16 v[200:203],v[72:75],a[204:207],v[200:203]
s_waitcnt lgkmcnt(2)
v_mfma_f32_16x16x32_bf16 v[196:199],a[76:79],v[76:79],v[196:199]
ds_read_b128 v[72:75],v20 offset:43008
v_mfma_f32_16x16x32_bf16 v[204:207],v[76:79],a[204:207],v[204:207]
s_waitcnt lgkmcnt(2)
v_mfma_f32_16x16x32_bf16 v[192:195],a[80:83],v[64:67],v[192:195]
ds_read_b128 v[76:79],v20 offset:44032
v_mfma_f32_16x16x32_bf16 v[200:203],v[64:67],a[208:211],v[200:203]
s_waitcnt lgkmcnt(2)
v_mfma_f32_16x16x32_bf16 v[196:199],a[80:83],v[68:71],v[196:199]
ds_read_b128 v[64:67],v20 offset:45056
v_mfma_f32_16x16x32_bf16 v[204:207],v[68:71],a[208:211],v[204:207]
s_waitcnt lgkmcnt(2)
v_mfma_f32_16x16x32_bf16 v[192:195],a[84:87],v[72:75],v[192:195]
ds_read_b128 v[68:71],v20 offset:46080
v_mfma_f32_16x16x32_bf16 v[200:203],v[72:75],a[212:215],v[200:203]
s_waitcnt lgkmcnt(2)
v_mfma_f32_16x16x32_bf16 v[196:199],a[84:87],v[76:79],v[196:199]
ds_read_b128 v[72:75],v20 offset:47104
v_mfma_f32_16x16x32_bf16 v[204:207],v[76:79],a[212:215],v[204:207]
s_waitcnt lgkmcnt(2)
v_mfma_f32_16x16x32_bf16 v[192:195],a[88:91],v[64:67],v[192:195]
ds_read_b128 v[76:79],v20 offset:48128
v_mfma_f32_16x16x32_bf16 v[200:203],v[64:67],a[216:219],v[200:203]
s_waitcnt lgkmcnt(2)
v_mfma_f32_16x16x32_bf16 v[196:199],a[88:91],v[68:71],v[196:199]
ds_read_b128 v[64:67],v20 offset:49152
v_mfma_f32_16x16x32_bf16 v[204:207],v[68:71],a[216:219],v[204:207]
s_waitcnt lgkmcnt(2)
v_mfma_f32_16x16x32_bf16 v[192:195],a[92:95],v[72:75],v[192:195]
ds_read_b128 v[68:71],v20 offset:50176
v_mfma_f32_16x16x32_bf16 v[200:203],v[72:75],a[220:223],v[200:203]
s_waitcnt lgkmcnt(2)
v_mfma_f32_16x16x32_bf16 v[196:199],a[92:95],v[76:79],v[196:199]
ds_read_b128 v[72:75],v20 offset:51200
v_mfma_f32_16x16x32_bf16 v[204:207],v[76:79],a[220:223],v[204:207]
s_waitcnt lgkmcnt(2)
v_mfma_f32_16x16x32_bf16 v[192:195],a[96:99],v[64:67],v[192:195]
ds_read_b128 v[76:79],v20 offset:52224
v_mfma_f32_16x16x32_bf16 v[200:203],v[64:67],a[224:227],v[200:203]
s_waitcnt lgkmcnt(2)
v_mfma_f32_16x16x32_bf16 v[196:199],a[96:99],v[68:71],v[196:199]
ds_read_b128 v[64:67],v20 offset:53248
v_mfma_f32_16x16x32_bf16 v[204:207],v[68:71],a[224:227],v[204:207]
s_waitcnt lgkmcnt(2)
v_mfma_f32_16x16x32_bf16 v[192:195],a[100:103],v[72:75],v[192:195]
ds_read_b128 v[68:71],v20 offset:54272
s_add_u32 m0,s62,43008
s_add_u32 s69,s78,43008
v_mfma_f32_16x16x32_bf16 v[200:203],v[72:75],a[228:231],v[200:203]
s_waitcnt lgkmcnt(2)
v_mfma_f32_16x16x32_bf16 v[196:199],a[100:103],v[76:79],v[196:199]
ds_read_b128 v[72:75],v20 offset:55296
buffer_load_dwordx4 v16,s[20:23],s69 offen offset:0 lds
v_mfma_f32_16x16x32_bf16 v[204:207],v[76:79],a[228:231],v[204:207]
s_waitcnt lgkmcnt(2)
v_mfma_f32_16x16x32_bf16 v[192:195],a[104:107],v[64:67],v[192:195]
ds_read_b128 v[76:79],v20 offset:56320
buffer_load_dwordx4 v16,s[20:23],s69 offen offset:1024 lds
v_mfma_f32_16x16x32_bf16 v[200:203],v[64:67],a[232:235],v[200:203]
s_waitcnt lgkmcnt(2)
v_mfma_f32_16x16x32_bf16 v[196:199],a[104:107],v[68:71],v[196:199]
ds_read_b128 v[64:67],v20 offset:57344
buffer_load_dwordx4 v16,s[20:23],s69 offen offset:2048 lds
v_mfma_f32_16x16x32_bf16 v[204:207],v[68:71],a[232:235],v[204:207]
s_waitcnt lgkmcnt(2)
v_mfma_f32_16x16x32_bf16 v[192:195],a[108:111],v[72:75],v[192:195]
ds_read_b128 v[68:71],v20 offset:58368
buffer_load_dwordx4 v16,s[20:23],s69 offen offset:3072 lds
v_mfma_f32_16x16x32_bf16 v[200:203],v[72:75],a[236:239],v[200:203]
s_waitcnt lgkmcnt(2)
v_mfma_f32_16x16x32_bf16 v[196:199],a[108:111],v[76:79],v[196:199]
ds_read_b128 v[72:75],v20 offset:59392
s_add_u32 m0,s62,47104
s_add_u32 s69,s78,47104
v_mfma_f32_16x16x32_bf16 v[204:207],v[76:79],a[236:239],v[204:207]
s_waitcnt lgkmcnt(2)
v_mfma_f32_16x16x32_bf16 v[192:195],a[112:115],v[64:67],v[192:195]
ds_read_b128 v[76:79],v20 offset:60416
buffer_load_dwordx4 v16,s[20:23],s69 offen offset:0 lds
v_mfma_f32_16x16x32_bf16 v[200:203],v[64:67],a[240:243],v[200:203]
s_waitcnt lgkmcnt(2)
v_mfma_f32_16x16x32_bf16 v[196:199],a[112:115],v[68:71],v[196:199]
ds_read_b128 v[64:67],v20 offset:61440
v_mfma_f32_16x16x32_bf16 v[204:207],v[68:71],a[240:243],v[204:207]
buffer_load_dwordx4 v16,s[20:23],s69 offen offset:1024 lds
s_waitcnt lgkmcnt(2)
v_mfma_f32_16x16x32_bf16 v[192:195],a[116:119],v[72:75],v[192:195]
ds_read_b128 v[68:71],v20 offset:62464
v_mfma_f32_16x16x32_bf16 v[200:203],v[72:75],a[244:247],v[200:203]
buffer_load_dwordx4 v16,s[20:23],s69 offen offset:2048 lds
s_waitcnt lgkmcnt(2)
v_mfma_f32_16x16x32_bf16 v[196:199],a[116:119],v[76:79],v[196:199]
ds_read_b128 v[72:75],v20 offset:63488
v_mfma_f32_16x16x32_bf16 v[204:207],v[76:79],a[244:247],v[204:207]
buffer_load_dwordx4 v16,s[20:23],s69 offen offset:3072 lds
s_waitcnt lgkmcnt(2)
v_mfma_f32_16x16x32_bf16 v[192:195],a[120:123],v[64:67],v[192:195]
ds_read_b128 v[76:79],v20 offset:64512
v_mfma_f32_16x16x32_bf16 v[200:203],v[64:67],a[248:251],v[200:203]
s_add_u32 m0,s62,51200
s_add_u32 s69,s78,51200
s_waitcnt lgkmcnt(2)
v_mfma_f32_16x16x32_bf16 v[196:199],a[120:123],v[68:71],v[196:199]
v_mfma_f32_16x16x32_bf16 v[204:207],v[68:71],a[248:251],v[204:207]
buffer_load_dwordx4 v16,s[20:23],s69 offen offset:0 lds
s_waitcnt lgkmcnt(1)
v_mfma_f32_16x16x32_bf16 v[192:195],a[124:127],v[72:75],v[192:195]
v_mfma_f32_16x16x32_bf16 v[200:203],v[72:75],a[252:255],v[200:203]
buffer_load_dwordx4 v16,s[20:23],s69 offen offset:1024 lds
s_waitcnt lgkmcnt(0)
v_mfma_f32_16x16x32_bf16 v[196:199],a[124:127],v[76:79],v[196:199]
v_mfma_f32_16x16x32_bf16 v[204:207],v[76:79],a[252:255],v[204:207]
s_waitcnt vmcnt(26)
ds_write_b32 v21,v25 offset:28
v_xor_b32 v20,0x10000,v20
s_xor_b32 s62,s62,0x10000
s_lshr_b32 s64,s73,9
v_add_u32 v22,s64,v24
v_cvt_pk_bf16_f32 v208,v192,v193
v_cvt_pk_bf16_f32 v209,v194,v195
v_cvt_pk_bf16_f32 v210,v196,v197
v_cvt_pk_bf16_f32 v211,v198,v199
v_cvt_pk_bf16_f32 v212,v200,v201
v_cvt_pk_bf16_f32 v213,v202,v203
v_cvt_pk_bf16_f32 v214,v204,v205
v_cvt_pk_bf16_f32 v215,v206,v207
v_permlane16_swap_b32 v208,v210
v_permlane16_swap_b32 v209,v211
buffer_store_dwordx4 v[208:211],v2,s[24:27],s73 offen
buffer_store_dwordx4 v[208:211],v2,s[28:31],s73 offen sc1
ds_write_b128 v22,v[212:215] offset:17408
buffer_store_dwordx4 v[208:211],v17,s[20:23],s12 offen sc1
bgx_142:
s_waitcnt lgkmcnt(0)
s_andn2_b32 s64,s79,0x14
s_cmp_eq_u32 s64,2
s_cbranch_scc1 late_144
lateb_145:
s_buffer_load_dword s48,s[20:23],s80 offset:0
s_buffer_load_dword s48,s[20:23],s80 offset:64
s_buffer_load_dword s48,s[20:23],s80 offset:128
s_buffer_load_dword s48,s[20:23],s80 offset:192
s_buffer_load_dword s48,s[20:23],s80 offset:256
s_buffer_load_dword s48,s[20:23],s80 offset:320
s_buffer_load_dword s48,s[20:23],s80 offset:384
s_buffer_load_dword s48,s[20:23],s80 offset:448
s_buffer_load_dword s48,s[20:23],s80 offset:512
s_buffer_load_dword s48,s[20:23],s80 offset:576
s_buffer_load_dword s48,s[20:23],s80 offset:640
s_buffer_load_dword s48,s[20:23],s80 offset:704
s_buffer_load_dword s48,s[20:23],s80 offset:768
s_buffer_load_dword s48,s[20:23],s80 offset:832
s_buffer_load_dword s48,s[20:23],s80 offset:896
s_buffer_load_dword s48,s[20:23],s80 offset:960
s_buffer_load_dword s48,s[20:23],s80 offset:1024
s_buffer_load_dword s48,s[20:23],s80 offset:1088
s_buffer_load_dword s48,s[20:23],s80 offset:1152
s_buffer_load_dword s48,s[20:23],s80 offset:1216
s_buffer_load_dword s48,s[20:23],s80 offset:1280
s_buffer_load_dword s48,s[20:23],s80 offset:1344
s_buffer_load_dword s48,s[20:23],s80 offset:1408
s_buffer_load_dword s48,s[20:23],s80 offset:1472
s_buffer_load_dword s48,s[20:23],s80 offset:1536
s_buffer_load_dword s48,s[20:23],s80 offset:1600
s_buffer_load_dword s48,s[20:23],s80 offset:1664
s_buffer_load_dword s48,s[20:23],s80 offset:1728
s_buffer_load_dword s48,s[20:23],s80 offset:1792
s_buffer_load_dword s48,s[20:23],s80 offset:1856
s_buffer_load_dword s48,s[20:23],s80 offset:1920
s_buffer_load_dword s48,s[20:23],s80 offset:1984
s_add_u32 s63,s79,1
s_and_b32 s64,s63,3
s_lshl_b32 s70,s64,20
s_add_u32 s65,s63,2
s_and_b32 s65,s65,3
s_lshl_b32 s73,s65,20
s_add_u32 s55,s63,3
s_lshl_b32 s78,s55,16
s_add_u32 s78,s78,57344
s_cmp_lt_u32 s55,64
s_cselect_b32 s78,s78,0x7fff0000
s_add_u32 s60,s63,1
s_lshl_b32 s76,s60,21
s_lshl_b32 s55,s60,13
s_and_b32 s55,s55,0x2000
s_xor_b32 s55,s55,s61
s_add_u32 s76,s76,s55
s_cmp_lt_u32 s60,64
s_cselect_b32 s76,s76,0x7fff0000
s_add_u32 s60,s63,2
s_lshl_b32 s12,s60,21
s_lshl_b32 s55,s60,13
s_and_b32 s55,s55,0x2000
s_xor_b32 s55,s55,s61
s_add_u32 s12,s12,s55
s_cmp_lt_u32 s60,64
s_cselect_b32 s12,s12,0x7fff0000
s_add_u32 s55,s63,5
s_min_u32 s55,s55,63
s_lshl_b32 s55,s55,16
s_lshl_b32 s60,s59,11
s_add_u32 s80,s55,s60
s_add_u32 s80,s80,57344
v_mov_b32 v176,0
v_mov_b32 v177,0
v_mov_b32 v178,0
v_mov_b32 v179,0
v_mov_b32 v180,0
v_mov_b32 v181,0
v_mov_b32 v182,0
v_mov_b32 v183,0
s_add_u32 s79,s79,1
v_add_u32 v25,1,v25
s_waitcnt vmcnt(0)
s_branch loop_136
art_140:
s_sub_u32 s90,s90,1
s_cmp_lt_i32 s90,0
s_cbranch_scc1 abk_141
buffer_load_dwordx4 v[64:67],v28,s[20:23],s70 offen offset:0 sc1
buffer_load_dwordx4 v[68:71],v28,s[20:23],s70 offen offset:1024 sc1
buffer_load_dwordx4 v[72:75],v28,s[20:23],s70 offen offset:2048 sc1
buffer_load_dwordx4 v[76:79],v28,s[20:23],s70 offen offset:3072 sc1
s_waitcnt vmcnt(3)
ds_write_b128 v24,v[64:67] offset:8192
v_min3_u32 v22,v64,v65,v66
v_min_u32 v22,v22,v67
s_waitcnt vmcnt(2)
ds_write_b128 v24,v[68:71] offset:9216
v_min3_u32 v22,v22,v68,v69
v_min3_u32 v22,v22,v70,v71
s_waitcnt vmcnt(1)
ds_write_b128 v24,v[72:75] offset:10240
v_min3_u32 v22,v22,v72,v73
v_min3_u32 v22,v22,v74,v75
s_waitcnt vmcnt(0)
ds_write_b128 v24,v[76:79] offset:11264
v_min3_u32 v22,v22,v76,v77
v_min3_u32 v22,v22,v78,v79
v_cmp_eq_u32 vcc,0,v22
s_cbranch_vccnz art_140
s_branch abk_141
bgsk_143:
s_waitcnt vmcnt(0)
ds_write_b32 v21,v25 offset:28
s_branch bgx_142
late_144:
s_cmp_eq_u32 s79,22
s_cbranch_scc1 lateb_145
v_lshlrev_b32 v184,2,v16
s_mov_b32 s52,21052416
s_mov_b32 s53,1792
s_lshr_b32 s64,s79,4
s_lshl_b32 s64,0x100,s64
s_cmp_eq_u32 s79,2
s_cselect_b32 exec_lo,0xff,s64
s_mov_b32 exec_hi,0
dp_146:
buffer_load_dword v185,v184,s[20:23],s52 offen sc1
s_waitcnt vmcnt(0)
v_cmp_ne_u32 vcc,s53,v185
s_cbranch_vccz dpok_147
s_sleep 2
s_sub_u32 s90,s90,1
s_cmp_gt_i32 s90,0
s_cbranch_scc1 dp_146
dpok_147:
s_mov_b64 exec,-1
s_branch lateb_145
first_135:
s_add_u32 s63,s79,0
s_and_b32 s64,s63,3
s_lshl_b32 s70,s64,20
s_add_u32 s65,s63,2
s_and_b32 s65,s65,3
s_lshl_b32 s73,s65,20
s_add_u32 s55,s63,3
s_lshl_b32 s78,s55,16
s_add_u32 s78,s78,57344
s_cmp_lt_u32 s55,64
s_cselect_b32 s78,s78,0x7fff0000
s_add_u32 s60,s63,1
s_lshl_b32 s76,s60,21
s_lshl_b32 s55,s60,13
s_and_b32 s55,s55,0x2000
s_xor_b32 s55,s55,s61
s_add_u32 s76,s76,s55
s_cmp_lt_u32 s60,64
s_cselect_b32 s76,s76,0x7fff0000
s_add_u32 s60,s63,2
s_lshl_b32 s12,s60,21
s_lshl_b32 s55,s60,13
s_and_b32 s55,s55,0x2000
s_xor_b32 s55,s55,s61
s_add_u32 s12,s12,s55
s_cmp_lt_u32 s60,64
s_cselect_b32 s12,s12,0x7fff0000
s_add_u32 s55,s63,5
s_min_u32 s55,s55,63
s_lshl_b32 s55,s55,16
s_lshl_b32 s60,s59,11
s_add_u32 s80,s55,s60
s_add_u32 s80,s80,57344
v_mov_b32 v176,0
v_mov_b32 v177,0
v_mov_b32 v178,0
v_mov_b32 v179,0
v_mov_b32 v180,0
v_mov_b32 v181,0
v_mov_b32 v182,0
v_mov_b32 v183,0
s_waitcnt vmcnt(0) lgkmcnt(0)
s_barrier
pn1_148:
ds_read_b128 v[64:67],v20 offset:0
ds_read_b128 v[68:71],v20 offset:1024
ds_read_b128 v[72:75],v20 offset:2048
s_waitcnt lgkmcnt(2)
v_mfma_f32_16x16x32_bf16 v[192:195],a[0:3],v[64:67],0
ds_read_b128 v[76:79],v20 offset:3072
v_mfma_f32_16x16x32_bf16 v[200:203],v[64:67],a[128:131],0
s_waitcnt lgkmcnt(2)
v_mfma_f32_16x16x32_bf16 v[196:199],a[0:3],v[68:71],0
ds_read_b128 v[64:67],v20 offset:4096
v_mfma_f32_16x16x32_bf16 v[204:207],v[68:71],a[128:131],0
s_waitcnt lgkmcnt(2)
v_mfma_f32_16x16x32_bf16 v[192:195],a[4:7],v[72:75],v[192:195]
ds_read_b128 v[68:71],v20 offset:5120
v_mfma_f32_16x16x32_bf16 v[200:203],v[72:75],a[132:135],v[200:203]
s_waitcnt lgkmcnt(2)
v_mfma_f32_16x16x32_bf16 v[196:199],a[4:7],v[76:79],v[196:199]
ds_read_b128 v[72:75],v20 offset:6144
v_mfma_f32_16x16x32_bf16 v[204:207],v[76:79],a[132:135],v[204:207]
s_waitcnt lgkmcnt(2)
v_mfma_f32_16x16x32_bf16 v[192:195],a[8:11],v[64:67],v[192:195]
ds_read_b128 v[76:79],v20 offset:7168
v_mfma_f32_16x16x32_bf16 v[200:203],v[64:67],a[136:139],v[200:203]
s_waitcnt lgkmcnt(2)
v_mfma_f32_16x16x32_bf16 v[196:199],a[8:11],v[68:71],v[196:199]
ds_read_b128 v[64:67],v20 offset:8192
v_mfma_f32_16x16x32_bf16 v[204:207],v[68:71],a[136:139],v[204:207]
s_waitcnt lgkmcnt(2)
v_mfma_f32_16x16x32_bf16 v[192:195],a[12:15],v[72:75],v[192:195]
ds_read_b128 v[68:71],v20 offset:9216
v_mfma_f32_16x16x32_bf16 v[200:203],v[72:75],a[140:143],v[200:203]
s_waitcnt lgkmcnt(2)
v_mfma_f32_16x16x32_bf16 v[196:199],a[12:15],v[76:79],v[196:199]
ds_read_b128 v[72:75],v20 offset:10240
v_mfma_f32_16x16x32_bf16 v[204:207],v[76:79],a[140:143],v[204:207]
s_waitcnt lgkmcnt(2)
v_mfma_f32_16x16x32_bf16 v[192:195],a[16:19],v[64:67],v[192:195]
ds_read_b128 v[76:79],v20 offset:11264
v_mfma_f32_16x16x32_bf16 v[200:203],v[64:67],a[144:147],v[200:203]
s_waitcnt lgkmcnt(2)
v_mfma_f32_16x16x32_bf16 v[196:199],a[16:19],v[68:71],v[196:199]
ds_read_b128 v[64:67],v20 offset:12288
v_mfma_f32_16x16x32_bf16 v[204:207],v[68:71],a[144:147],v[204:207]
s_waitcnt lgkmcnt(2)
v_mfma_f32_16x16x32_bf16 v[192:195],a[20:23],v[72:75],v[192:195]
ds_read_b128 v[68:71],v20 offset:13312
v_mfma_f32_16x16x32_bf16 v[200:203],v[72:75],a[148:151],v[200:203]
s_waitcnt lgkmcnt(2)
v_mfma_f32_16x16x32_bf16 v[196:199],a[20:23],v[76:79],v[196:199]
ds_read_b128 v[72:75],v20 offset:14336
v_mfma_f32_16x16x32_bf16 v[204:207],v[76:79],a[148:151],v[204:207]
s_waitcnt lgkmcnt(2)
v_mfma_f32_16x16x32_bf16 v[192:195],a[24:27],v[64:67],v[192:195]
ds_read_b128 v[76:79],v20 offset:15360
v_mfma_f32_16x16x32_bf16 v[200:203],v[64:67],a[152:155],v[200:203]
s_waitcnt lgkmcnt(2)
v_mfma_f32_16x16x32_bf16 v[196:199],a[24:27],v[68:71],v[196:199]
ds_read_b128 v[64:67],v20 offset:16384
v_mfma_f32_16x16x32_bf16 v[204:207],v[68:71],a[152:155],v[204:207]
s_waitcnt lgkmcnt(2)
v_mfma_f32_16x16x32_bf16 v[192:195],a[28:31],v[72:75],v[192:195]
ds_read_b128 v[68:71],v20 offset:17408
v_mfma_f32_16x16x32_bf16 v[200:203],v[72:75],a[156:159],v[200:203]
s_waitcnt lgkmcnt(2)
v_mfma_f32_16x16x32_bf16 v[196:199],a[28:31],v[76:79],v[196:199]
ds_read_b128 v[72:75],v20 offset:18432
v_mfma_f32_16x16x32_bf16 v[204:207],v[76:79],a[156:159],v[204:207]
s_waitcnt lgkmcnt(2)
v_mfma_f32_16x16x32_bf16 v[192:195],a[32:35],v[64:67],v[192:195]
ds_read_b128 v[76:79],v20 offset:19456
v_mfma_f32_16x16x32_bf16 v[200:203],v[64:67],a[160:163],v[200:203]
s_waitcnt lgkmcnt(2)
v_mfma_f32_16x16x32_bf16 v[196:199],a[32:35],v[68:71],v[196:199]
ds_read_b128 v[64:67],v20 offset:20480
v_mfma_f32_16x16x32_bf16 v[204:207],v[68:71],a[160:163],v[204:207]
s_waitcnt lgkmcnt(2)
v_mfma_f32_16x16x32_bf16 v[192:195],a[36:39],v[72:75],v[192:195]
ds_read_b128 v[68:71],v20 offset:21504
v_mfma_f32_16x16x32_bf16 v[200:203],v[72:75],a[164:167],v[200:203]
s_waitcnt lgkmcnt(2)
v_mfma_f32_16x16x32_bf16 v[196:199],a[36:39],v[76:79],v[196:199]
ds_read_b128 v[72:75],v20 offset:22528
v_mfma_f32_16x16x32_bf16 v[204:207],v[76:79],a[164:167],v[204:207]
s_waitcnt lgkmcnt(2)
v_mfma_f32_16x16x32_bf16 v[192:195],a[40:43],v[64:67],v[192:195]
ds_read_b128 v[76:79],v20 offset:23552
v_mfma_f32_16x16x32_bf16 v[200:203],v[64:67],a[168:171],v[200:203]
s_waitcnt lgkmcnt(2)
v_mfma_f32_16x16x32_bf16 v[196:199],a[40:43],v[68:71],v[196:199]
ds_read_b128 v[64:67],v20 offset:24576
v_mfma_f32_16x16x32_bf16 v[204:207],v[68:71],a[168:171],v[204:207]
s_waitcnt lgkmcnt(2)
v_mfma_f32_16x16x32_bf16 v[192:195],a[44:47],v[72:75],v[192:195]
ds_read_b128 v[68:71],v20 offset:25600
v_mfma_f32_16x16x32_bf16 v[200:203],v[72:75],a[172:175],v[200:203]
s_waitcnt lgkmcnt(2)
v_mfma_f32_16x16x32_bf16 v[196:199],a[44:47],v[76:79],v[196:199]
ds_read_b128 v[72:75],v20 offset:26624
v_mfma_f32_16x16x32_bf16 v[204:207],v[76:79],a[172:175],v[204:207]
s_waitcnt lgkmcnt(2)
v_mfma_f32_16x16x32_bf16 v[192:195],a[48:51],v[64:67],v[192:195]
ds_read_b128 v[76:79],v20 offset:27648
v_mfma_f32_16x16x32_bf16 v[200:203],v[64:67],a[176:179],v[200:203]
s_waitcnt lgkmcnt(2)
v_mfma_f32_16x16x32_bf16 v[196:199],a[48:51],v[68:71],v[196:199]
ds_read_b128 v[64:67],v20 offset:28672
v_mfma_f32_16x16x32_bf16 v[204:207],v[68:71],a[176:179],v[204:207]
s_waitcnt lgkmcnt(2)
v_mfma_f32_16x16x32_bf16 v[192:195],a[52:55],v[72:75],v[192:195]
ds_read_b128 v[68:71],v20 offset:29696
v_mfma_f32_16x16x32_bf16 v[200:203],v[72:75],a[180:183],v[200:203]
s_waitcnt lgkmcnt(2)
v_mfma_f32_16x16x32_bf16 v[196:199],a[52:55],v[76:79],v[196:199]
ds_read_b128 v[72:75],v20 offset:30720
v_mfma_f32_16x16x32_bf16 v[204:207],v[76:79],a[180:183],v[204:207]
s_waitcnt lgkmcnt(2)
v_mfma_f32_16x16x32_bf16 v[192:195],a[56:59],v[64:67],v[192:195]
ds_read_b128 v[76:79],v20 offset:31744
v_mfma_f32_16x16x32_bf16 v[200:203],v[64:67],a[184:187],v[200:203]
s_waitcnt lgkmcnt(2)
v_mfma_f32_16x16x32_bf16 v[196:199],a[56:59],v[68:71],v[196:199]
ds_read_b128 v[64:67],v20 offset:32768
v_mfma_f32_16x16x32_bf16 v[204:207],v[68:71],a[184:187],v[204:207]
s_waitcnt lgkmcnt(2)
v_mfma_f32_16x16x32_bf16 v[192:195],a[60:63],v[72:75],v[192:195]
ds_read_b128 v[68:71],v20 offset:33792
v_mfma_f32_16x16x32_bf16 v[200:203],v[72:75],a[188:191],v[200:203]
s_waitcnt lgkmcnt(2)
v_mfma_f32_16x16x32_bf16 v[196:199],a[60:63],v[76:79],v[196:199]
ds_read_b128 v[72:75],v20 offset:34816
v_mfma_f32_16x16x32_bf16 v[204:207],v[76:79],a[188:191],v[204:207]
s_waitcnt lgkmcnt(2)
v_mfma_f32_16x16x32_bf16 v[192:195],a[64:67],v[64:67],v[192:195]
ds_read_b128 v[76:79],v20 offset:35840
v_mfma_f32_16x16x32_bf16 v[200:203],v[64:67],a[192:195],v[200:203]
s_waitcnt lgkmcnt(2)
v_mfma_f32_16x16x32_bf16 v[196:199],a[64:67],v[68:71],v[196:199]
ds_read_b128 v[64:67],v20 offset:36864
v_mfma_f32_16x16x32_bf16 v[204:207],v[68:71],a[192:195],v[204:207]
s_waitcnt lgkmcnt(2)
v_mfma_f32_16x16x32_bf16 v[192:195],a[68:71],v[72:75],v[192:195]
ds_read_b128 v[68:71],v20 offset:37888
v_mfma_f32_16x16x32_bf16 v[200:203],v[72:75],a[196:199],v[200:203]
s_waitcnt lgkmcnt(2)
v_mfma_f32_16x16x32_bf16 v[196:199],a[68:71],v[76:79],v[196:199]
ds_read_b128 v[72:75],v20 offset:38912
v_mfma_f32_16x16x32_bf16 v[204:207],v[76:79],a[196:199],v[204:207]
s_waitcnt lgkmcnt(2)
v_mfma_f32_16x16x32_bf16 v[192:195],a[72:75],v[64:67],v[192:195]
ds_read_b128 v[76:79],v20 offset:39936
v_mfma_f32_16x16x32_bf16 v[200:203],v[64:67],a[200:203],v[200:203]
s_waitcnt lgkmcnt(2)
v_mfma_f32_16x16x32_bf16 v[196:199],a[72:75],v[68:71],v[196:199]
ds_read_b128 v[64:67],v20 offset:40960
v_mfma_f32_16x16x32_bf16 v[204:207],v[68:71],a[200:203],v[204:207]
s_waitcnt lgkmcnt(2)
v_mfma_f32_16x16x32_bf16 v[192:195],a[76:79],v[72:75],v[192:195]
ds_read_b128 v[68:71],v20 offset:41984
v_mfma_f32_16x16x32_bf16 v[200:203],v[72:75],a[204:207],v[200:203]
s_waitcnt lgkmcnt(2)
v_mfma_f32_16x16x32_bf16 v[196:199],a[76:79],v[76:79],v[196:199]
ds_read_b128 v[72:75],v20 offset:43008
v_mfma_f32_16x16x32_bf16 v[204:207],v[76:79],a[204:207],v[204:207]
s_waitcnt lgkmcnt(2)
v_mfma_f32_16x16x32_bf16 v[192:195],a[80:83],v[64:67],v[192:195]
ds_read_b128 v[76:79],v20 offset:44032
v_mfma_f32_16x16x32_bf16 v[200:203],v[64:67],a[208:211],v[200:203]
s_waitcnt lgkmcnt(2)
v_mfma_f32_16x16x32_bf16 v[196:199],a[80:83],v[68:71],v[196:199]
ds_read_b128 v[64:67],v20 offset:45056
v_mfma_f32_16x16x32_bf16 v[204:207],v[68:71],a[208:211],v[204:207]
s_waitcnt lgkmcnt(2)
v_mfma_f32_16x16x32_bf16 v[192:195],a[84:87],v[72:75],v[192:195]
ds_read_b128 v[68:71],v20 offset:46080
v_mfma_f32_16x16x32_bf16 v[200:203],v[72:75],a[212:215],v[200:203]
s_waitcnt lgkmcnt(2)
v_mfma_f32_16x16x32_bf16 v[196:199],a[84:87],v[76:79],v[196:199]
ds_read_b128 v[72:75],v20 offset:47104
v_mfma_f32_16x16x32_bf16 v[204:207],v[76:79],a[212:215],v[204:207]
s_waitcnt lgkmcnt(2)
v_mfma_f32_16x16x32_bf16 v[192:195],a[88:91],v[64:67],v[192:195]
ds_read_b128 v[76:79],v20 offset:48128
v_mfma_f32_16x16x32_bf16 v[200:203],v[64:67],a[216:219],v[200:203]
s_waitcnt lgkmcnt(2)
v_mfma_f32_16x16x32_bf16 v[196:199],a[88:91],v[68:71],v[196:199]
ds_read_b128 v[64:67],v20 offset:49152
v_mfma_f32_16x16x32_bf16 v[204:207],v[68:71],a[216:219],v[204:207]
s_waitcnt lgkmcnt(2)
v_mfma_f32_16x16x32_bf16 v[192:195],a[92:95],v[72:75],v[192:195]
ds_read_b128 v[68:71],v20 offset:50176
v_mfma_f32_16x16x32_bf16 v[200:203],v[72:75],a[220:223],v[200:203]
s_waitcnt lgkmcnt(2)
v_mfma_f32_16x16x32_bf16 v[196:199],a[92:95],v[76:79],v[196:199]
ds_read_b128 v[72:75],v20 offset:51200
v_mfma_f32_16x16x32_bf16 v[204:207],v[76:79],a[220:223],v[204:207]
s_waitcnt lgkmcnt(2)
v_mfma_f32_16x16x32_bf16 v[192:195],a[96:99],v[64:67],v[192:195]
ds_read_b128 v[76:79],v20 offset:52224
v_mfma_f32_16x16x32_bf16 v[200:203],v[64:67],a[224:227],v[200:203]
s_waitcnt lgkmcnt(2)
v_mfma_f32_16x16x32_bf16 v[196:199],a[96:99],v[68:71],v[196:199]
ds_read_b128 v[64:67],v20 offset:53248
v_mfma_f32_16x16x32_bf16 v[204:207],v[68:71],a[224:227],v[204:207]
s_waitcnt lgkmcnt(2)
v_mfma_f32_16x16x32_bf16 v[192:195],a[100:103],v[72:75],v[192:195]
ds_read_b128 v[68:71],v20 offset:54272
v_mfma_f32_16x16x32_bf16 v[200:203],v[72:75],a[228:231],v[200:203]
s_waitcnt lgkmcnt(2)
v_mfma_f32_16x16x32_bf16 v[196:199],a[100:103],v[76:79],v[196:199]
ds_read_b128 v[72:75],v20 offset:55296
v_mfma_f32_16x16x32_bf16 v[204:207],v[76:79],a[228:231],v[204:207]
s_waitcnt lgkmcnt(2)
v_mfma_f32_16x16x32_bf16 v[192:195],a[104:107],v[64:67],v[192:195]
ds_read_b128 v[76:79],v20 offset:56320
v_mfma_f32_16x16x32_bf16 v[200:203],v[64:67],a[232:235],v[200:203]
s_waitcnt lgkmcnt(2)
v_mfma_f32_16x16x32_bf16 v[196:199],a[104:107],v[68:71],v[196:199]
ds_read_b128 v[64:67],v20 offset:57344
v_mfma_f32_16x16x32_bf16 v[204:207],v[68:71],a[232:235],v[204:207]
s_waitcnt lgkmcnt(2)
v_mfma_f32_16x16x32_bf16 v[192:195],a[108:111],v[72:75],v[192:195]
ds_read_b128 v[68:71],v20 offset:58368
v_mfma_f32_16x16x32_bf16 v[200:203],v[72:75],a[236:239],v[200:203]
s_waitcnt lgkmcnt(2)
v_mfma_f32_16x16x32_bf16 v[196:199],a[108:111],v[76:79],v[196:199]
ds_read_b128 v[72:75],v20 offset:59392
v_mfma_f32_16x16x32_bf16 v[204:207],v[76:79],a[236:239],v[204:207]
s_waitcnt lgkmcnt(2)
v_mfma_f32_16x16x32_bf16 v[192:195],a[112:115],v[64:67],v[192:195]
ds_read_b128 v[76:79],v20 offset:60416
v_mfma_f32_16x16x32_bf16 v[200:203],v[64:67],a[240:243],v[200:203]
s_waitcnt lgkmcnt(2)
v_mfma_f32_16x16x32_bf16 v[196:199],a[112:115],v[68:71],v[196:199]
ds_read_b128 v[64:67],v20 offset:61440
v_mfma_f32_16x16x32_bf16 v[204:207],v[68:71],a[240:243],v[204:207]
s_waitcnt lgkmcnt(2)
v_mfma_f32_16x16x32_bf16 v[192:195],a[116:119],v[72:75],v[192:195]
ds_read_b128 v[68:71],v20 offset:62464
v_mfma_f32_16x16x32_bf16 v[200:203],v[72:75],a[244:247],v[200:203]
s_waitcnt lgkmcnt(2)
v_mfma_f32_16x16x32_bf16 v[196:199],a[116:119],v[76:79],v[196:199]
ds_read_b128 v[72:75],v20 offset:63488
v_mfma_f32_16x16x32_bf16 v[204:207],v[76:79],a[244:247],v[204:207]
s_waitcnt lgkmcnt(2)
v_mfma_f32_16x16x32_bf16 v[192:195],a[120:123],v[64:67],v[192:195]
ds_read_b128 v[76:79],v20 offset:64512
v_mfma_f32_16x16x32_bf16 v[200:203],v[64:67],a[248:251],v[200:203]
s_waitcnt lgkmcnt(2)
v_mfma_f32_16x16x32_bf16 v[196:199],a[120:123],v[68:71],v[196:199]
v_mfma_f32_16x16x32_bf16 v[204:207],v[68:71],a[248:251],v[204:207]
s_waitcnt lgkmcnt(1)
v_mfma_f32_16x16x32_bf16 v[192:195],a[124:127],v[72:75],v[192:195]
v_mfma_f32_16x16x32_bf16 v[200:203],v[72:75],a[252:255],v[200:203]
s_waitcnt lgkmcnt(0)
v_mfma_f32_16x16x32_bf16 v[196:199],a[124:127],v[76:79],v[196:199]
v_mfma_f32_16x16x32_bf16 v[204:207],v[76:79],a[252:255],v[204:207]
v_xor_b32 v20,0x10000,v20
s_xor_b32 s62,s62,0x10000
s_lshr_b32 s64,s73,9
v_add_u32 v22,s64,v24
v_cvt_pk_bf16_f32 v208,v192,v193
v_cvt_pk_bf16_f32 v209,v194,v195
s_nop 0
v_cvt_pk_bf16_f32 v210,v196,v197
v_cvt_pk_bf16_f32 v211,v198,v199
v_cvt_pk_bf16_f32 v212,v200,v201
v_cvt_pk_bf16_f32 v213,v202,v203
v_cvt_pk_bf16_f32 v214,v204,v205
v_cvt_pk_bf16_f32 v215,v206,v207
v_permlane16_swap_b32 v208,v210
v_permlane16_swap_b32 v209,v211
buffer_store_dwordx4 v[208:211],v2,s[24:27],s73 offen
buffer_store_dwordx4 v[208:211],v2,s[28:31],s73 offen sc1
ds_write_b128 v22,v[212:215] offset:17408
buffer_store_dwordx4 v[208:211],v17,s[20:23],s12 offen sc1
bgx_150:
s_add_u32 s63,s79,1
s_and_b32 s64,s63,3
s_lshl_b32 s70,s64,20
s_add_u32 s65,s63,2
s_and_b32 s65,s65,3
s_lshl_b32 s73,s65,20
s_add_u32 s55,s63,3
s_lshl_b32 s78,s55,16
s_add_u32 s78,s78,57344
s_cmp_lt_u32 s55,64
s_cselect_b32 s78,s78,0x7fff0000
s_add_u32 s60,s63,1
s_lshl_b32 s76,s60,21
s_lshl_b32 s55,s60,13
s_and_b32 s55,s55,0x2000
s_xor_b32 s55,s55,s61
s_add_u32 s76,s76,s55
s_cmp_lt_u32 s60,64
s_cselect_b32 s76,s76,0x7fff0000
s_add_u32 s60,s63,2
s_lshl_b32 s12,s60,21
s_lshl_b32 s55,s60,13
s_and_b32 s55,s55,0x2000
s_xor_b32 s55,s55,s61
s_add_u32 s12,s12,s55
s_cmp_lt_u32 s60,64
s_cselect_b32 s12,s12,0x7fff0000
s_add_u32 s55,s63,5
s_min_u32 s55,s55,63
s_lshl_b32 s55,s55,16
s_lshl_b32 s60,s59,11
s_add_u32 s80,s55,s60
s_add_u32 s80,s80,57344
v_mov_b32 v176,0
v_mov_b32 v177,0
v_mov_b32 v178,0
v_mov_b32 v179,0
v_mov_b32 v180,0
v_mov_b32 v181,0
v_mov_b32 v182,0
v_mov_b32 v183,0
s_add_u32 s79,s79,1
s_cmp_eq_u32 s79,0
s_cbranch_scc1 pn2_149
v_mov_b32 v38,1
ds_write_b32 v37,v38 offset:12
buffer_store_dwordx4 v[212:215],v12,s[20:23],s76 offen sc1
s_waitcnt lgkmcnt(0)
s_branch pn1_148
pn2_149:
v_mov_b32 v25,1
s_waitcnt vmcnt(1) lgkmcnt(0)
s_barrier
s_branch loop_136
w3_61:
v_xor_b32 v9,0x10000,v8
v_xor_b32 v10,0x20000,v8
v_xor_b32 v11,0x30000,v8
v_and_b32 v22,2,v4
v_lshrrev_b32 v23,3,v3
v_add_u32 v22,v22,v23
v_lshlrev_b32 v22,3,v22
v_and_b32 v23,1,v4
v_lshl_add_u32 v22,v23,2,v22
v_and_b32 v23,3,v3
v_add_u32 v22,v22,v23
v_lshlrev_b32 v22,4,v22
v_bfe_u32 v23,v3,2,1
v_lshl_add_u32 v22,v23,3,v22
v_add_u32 v30,s66,v22
v_and_b32 v22,7,v3
v_lshl_add_u32 v12,v4,3,v22
v_lshlrev_b32 v12,4,v12
v_add_u32 v12,s66,v12
s_branch first_151
loop_152:
s_barrier
buffer_load_dword v248,v18,s[20:23],s70 offen offset:0 sc1
s_nop 15
s_nop 5
hl_154:
buffer_load_dword v249,v18,s[20:23],s70 offen offset:0 sc1
s_waitcnt vmcnt(1)
v_cmp_eq_u32 vcc,v25,v248
s_bcnt1_i32_b32 s64,vcc_lo
s_cmp_ge_u32 s64,8
s_cbranch_scc1 hg_155
buffer_load_dword v248,v18,s[20:23],s70 offen offset:0 sc1
s_waitcnt vmcnt(1)
v_cmp_eq_u32 vcc,v25,v249
s_bcnt1_i32_b32 s64,vcc_lo
s_cmp_ge_u32 s64,8
s_cbranch_scc1 hg_155
s_sub_u32 s90,s90,1
s_cmp_gt_i32 s90,0
s_cbranch_scc1 hl_154
hg_155:
buffer_load_dwordx4 v[80:83],v29,s[20:23],s70 offen offset:0 sc1
buffer_load_dwordx4 v[84:87],v29,s[20:23],s70 offen offset:1024 sc1
buffer_load_dwordx4 v[88:91],v29,s[20:23],s70 offen offset:2048 sc1
buffer_load_dwordx4 v[92:95],v29,s[20:23],s70 offen offset:3072 sc1
s_waitcnt vmcnt(3)
ds_write_b128 v24,v[80:83] offset:12288
v_min3_u32 v22,v80,v81,v82
v_min_u32 v22,v22,v83
s_waitcnt vmcnt(2)
ds_write_b128 v24,v[84:87] offset:13312
v_min3_u32 v22,v22,v84,v85
v_min3_u32 v22,v22,v86,v87
s_waitcnt vmcnt(1)
ds_write_b128 v24,v[88:91] offset:14336
v_min3_u32 v22,v22,v88,v89
v_min3_u32 v22,v22,v90,v91
s_waitcnt vmcnt(0)
ds_write_b128 v24,v[92:95] offset:15360
v_min3_u32 v22,v22,v92,v93
v_min3_u32 v22,v22,v94,v95
v_cmp_eq_u32 vcc,0,v22
s_cbranch_vccnz art_156
abk_157:
v_smfmac_f32_16x16x64_bf16 v[176:179],v[80:83],a[96:103],v14
s_waitcnt lgkmcnt(0)
s_barrier
ds_read_b128 v[32:35],v24 offset:0
ds_read_b128 v[36:39],v24 offset:1024
ds_read_b128 v[40:43],v24 offset:2048
ds_read_b128 v[44:47],v24 offset:3072
v_smfmac_f32_16x16x64_bf16 v[176:179],v[84:87],a[104:111],v14
ds_read_b128 v[48:51],v24 offset:4096
ds_read_b128 v[52:55],v24 offset:5120
v_smfmac_f32_16x16x64_bf16 v[176:179],v[88:91],a[112:119],v14
ds_read_b128 v[56:59],v24 offset:6144
ds_read_b128 v[60:63],v24 offset:7168
v_smfmac_f32_16x16x64_bf16 v[176:179],v[92:95],a[120:127],v14
ds_read_b128 v[64:67],v24 offset:8192
ds_read_b128 v[68:71],v24 offset:9216
s_waitcnt lgkmcnt(9)
v_smfmac_f32_16x16x64_bf16 v[176:179],v[32:35],a[0:7],v14
ds_read_b128 v[72:75],v24 offset:10240
s_waitcnt lgkmcnt(9)
v_smfmac_f32_16x16x64_bf16 v[176:179],v[36:39],a[8:15],v14
ds_read_b128 v[76:79],v24 offset:11264
s_waitcnt lgkmcnt(9)
v_smfmac_f32_16x16x64_bf16 v[176:179],v[40:43],a[16:23],v14
s_waitcnt lgkmcnt(8)
v_smfmac_f32_16x16x64_bf16 v[176:179],v[44:47],a[24:31],v14
s_waitcnt lgkmcnt(7)
v_smfmac_f32_16x16x64_bf16 v[176:179],v[48:51],a[32:39],v14
s_waitcnt lgkmcnt(6)
v_smfmac_f32_16x16x64_bf16 v[176:179],v[52:55],a[40:47],v14
s_waitcnt lgkmcnt(5)
v_smfmac_f32_16x16x64_bf16 v[176:179],v[56:59],a[48:55],v14
s_waitcnt lgkmcnt(4)
v_smfmac_f32_16x16x64_bf16 v[176:179],v[60:63],a[56:63],v14
s_waitcnt lgkmcnt(3)
v_smfmac_f32_16x16x64_bf16 v[176:179],v[64:67],a[64:71],v14
s_waitcnt lgkmcnt(2)
v_smfmac_f32_16x16x64_bf16 v[176:179],v[68:71],a[72:79],v14
s_waitcnt lgkmcnt(1)
v_smfmac_f32_16x16x64_bf16 v[176:179],v[72:75],a[80:87],v14
s_waitcnt lgkmcnt(0)
v_smfmac_f32_16x16x64_bf16 v[176:179],v[76:79],a[88:95],v14
s_nop 7
v_permlane32_swap_b32 v176,v178
v_permlane32_swap_b32 v177,v179
v_add_f32 v176,v176,v178
v_add_f32 v177,v177,v179
v_cvt_pk_bf16_f32 v216,v176,v177
s_nop 1
v_mov_b32_dpp v217,v216 quad_perm:[1,0,3,2] row_mask:0xf bank_mask:0xf
v_perm_b32 v216,v217,v216,v15
v_max_u32 v216,1,v216
buffer_store_dword v216,v19,s[24:27],s70 offen
buffer_store_dword v216,v19,s[28:31],s70 offen sc1
s_cmp_eq_u32 s79,63
s_cbranch_scc1 end_57
s_nop 15
s_nop 15
s_nop 15
s_nop 11
s_add_u32 m0,s62,53248
s_add_u32 s69,s78,53248
buffer_load_dwordx4 v16,s[20:23],s69 offen offset:0 lds
s_nop 3
buffer_load_dwordx4 v16,s[20:23],s69 offen offset:1024 lds
s_nop 3
buffer_load_dwordx4 v16,s[20:23],s69 offen offset:2048 lds
s_nop 3
buffer_load_dwordx4 v16,s[20:23],s69 offen offset:3072 lds
s_nop 3
s_add_u32 m0,s62,57344
s_add_u32 s69,s78,57344
buffer_load_dwordx4 v16,s[20:23],s69 offen offset:0 lds
s_nop 3
buffer_load_dwordx4 v16,s[20:23],s69 offen offset:1024 lds
s_nop 3
buffer_load_dwordx4 v16,s[20:23],s69 offen offset:2048 lds
s_nop 3
buffer_load_dwordx4 v16,s[20:23],s69 offen offset:3072 lds
s_nop 3
s_add_u32 m0,s62,61440
s_add_u32 s69,s78,61440
buffer_load_dwordx4 v16,s[20:23],s69 offen offset:0 lds
s_nop 3
buffer_load_dwordx4 v16,s[20:23],s69 offen offset:1024 lds
s_nop 3
buffer_load_dwordx4 v16,s[20:23],s69 offen offset:2048 lds
s_nop 3
buffer_load_dwordx4 v16,s[20:23],s69 offen offset:3072 lds
s_nop 3
s_xor_b32 s62,s62,0x10000
wf_158:
ds_read_b32 v23,v21 offset:8
s_sub_u32 s90,s90,1
s_waitcnt lgkmcnt(0)
v_cmp_ne_u32 vcc,v23,v25
s_cmp_lt_i32 s90,0
s_cselect_b64 vcc,0,vcc
s_cbranch_vccnz wf_158
hl_159:
buffer_load_dword v248,v18,s[20:23],s70 offen offset:512 sc1
s_waitcnt vmcnt(0)
v_cmp_eq_u32 vcc,v25,v248
s_bcnt1_i32_b32 s64,vcc_lo
s_cmp_ge_u32 s64,16
s_cbranch_scc1 hg_160
s_sub_u32 s90,s90,1
s_cmp_gt_i32 s90,0
s_cbranch_scc1 hl_159
hg_160:
buffer_load_dwordx4 v[32:35],v28,s[20:23],s71 offen offset:0 sc1
buffer_load_dwordx4 v[36:39],v28,s[20:23],s71 offen offset:1024 sc1
buffer_load_dwordx4 v[40:43],v28,s[20:23],s71 offen offset:2048 sc1
buffer_load_dwordx4 v[44:47],v28,s[20:23],s71 offen offset:3072 sc1
buffer_load_dwordx4 v[48:51],v29,s[20:23],s71 offen offset:0 sc1
buffer_load_dwordx4 v[52:55],v29,s[20:23],s71 offen offset:1024 sc1
buffer_load_dwordx4 v[56:59],v29,s[20:23],s71 offen offset:2048 sc1
buffer_load_dwordx4 v[60:63],v29,s[20:23],s71 offen offset:3072 sc1
s_mov_b32 s68,0
s_waitcnt vmcnt(6)
v_smfmac_f32_16x16x64_bf16 v[184:187],v[32:35],a[128:135],v14
v_min3_u32 v22,v32,v33,v34
v_min3_u32 v22,v22,v35,v36
v_smfmac_f32_16x16x64_bf16 v[188:191],v[32:35],a[136:143],v14
v_min3_u32 v22,v22,v37,v38
v_smfmac_f32_16x16x64_bf16 v[184:187],v[36:39],a[144:151],v14
v_min_u32 v22,v22,v39
v_smfmac_f32_16x16x64_bf16 v[188:191],v[36:39],a[152:159],v14
v_cmp_eq_u32 s[52:53],0,v22
s_waitcnt vmcnt(4)
v_smfmac_f32_16x16x64_bf16 v[184:187],v[40:43],a[160:167],v14
v_min3_u32 v22,v40,v41,v42
s_cmp_lg_u64 s[52:53],0
v_smfmac_f32_16x16x64_bf16 v[188:191],v[40:43],a[168:175],v14
s_cbranch_scc1 ms_161
bk_162:
v_min3_u32 v22,v22,v43,v44
v_smfmac_f32_16x16x64_bf16 v[184:187],v[44:47],a[176:183],v14
v_min3_u32 v22,v22,v45,v46
v_min_u32 v22,v22,v47
v_smfmac_f32_16x16x64_bf16 v[188:191],v[44:47],a[184:191],v14
v_cmp_eq_u32 s[54:55],0,v22
s_waitcnt vmcnt(2)
v_smfmac_f32_16x16x64_bf16 v[184:187],v[48:51],a[192:199],v14
v_min3_u32 v22,v48,v49,v50
s_cmp_lg_u64 s[54:55],0
v_smfmac_f32_16x16x64_bf16 v[188:191],v[48:51],a[200:207],v14
s_cbranch_scc1 ms_163
bk_164:
v_min3_u32 v22,v22,v51,v52
v_smfmac_f32_16x16x64_bf16 v[184:187],v[52:55],a[208:215],v14
v_min3_u32 v22,v22,v53,v54
v_min_u32 v22,v22,v55
v_smfmac_f32_16x16x64_bf16 v[188:191],v[52:55],a[216:223],v14
v_cmp_eq_u32 s[52:53],0,v22
s_waitcnt vmcnt(0)
v_smfmac_f32_16x16x64_bf16 v[184:187],v[56:59],a[224:231],v14
v_min3_u32 v22,v56,v57,v58
s_cmp_lg_u64 s[52:53],0
v_smfmac_f32_16x16x64_bf16 v[188:191],v[56:59],a[232:239],v14
s_cbranch_scc1 ms_165
bk_166:
v_min3_u32 v22,v22,v59,v60
v_smfmac_f32_16x16x64_bf16 v[184:187],v[60:63],a[240:247],v14
v_min3_u32 v22,v22,v61,v62
v_min_u32 v22,v22,v63
v_smfmac_f32_16x16x64_bf16 v[188:191],v[60:63],a[248:255],v14
v_cmp_eq_u32 s[54:55],0,v22
s_cmp_lg_u64 s[54:55],0
s_cbranch_scc1 ms_169
bk_170:
s_cmp_lg_u32 s68,0
s_cbranch_scc1 rl2_171
fin_167:
s_nop 2
v_permlane32_swap_b32 v184,v188
v_permlane32_swap_b32 v185,v189
v_permlane32_swap_b32 v186,v190
v_permlane32_swap_b32 v187,v191
v_pk_add_f32 v[184:185],v[184:185],v[188:189]
v_pk_add_f32 v[186:187],v[186:187],v[190:191]
wf_172:
ds_read_b32 v23,v21 offset:12
ds_read_b128 v[216:219],v24 offset:25600
s_sub_u32 s90,s90,1
s_waitcnt lgkmcnt(0)
v_cmp_ne_u32 vcc,v23,v25
s_cmp_lt_i32 s90,0
s_cselect_b64 vcc,0,vcc
v_pk_add_f32 v[216:217],v[216:217],v[184:185]
v_pk_add_f32 v[218:219],v[218:219],v[186:187]
s_cbranch_vccnz wf_172
v_max_u32 v216,1,v216
v_max_u32 v217,1,v217
v_max_u32 v218,1,v218
v_max_u32 v219,1,v219
buffer_store_dwordx4 v[216:219],v8,s[20:23],s74 offen sc1
s_mov_b32 s88,s74
s_mov_b32 s89,s72
v_add_u32 v25,1,v25
s_add_u32 s63,s79,1
s_and_b32 s64,s63,3
s_lshl_b32 s70,s64,20
s_add_u32 s65,s63,2
s_and_b32 s65,s65,3
s_lshl_b32 s73,s65,20
s_add_u32 s55,s63,3
s_lshl_b32 s78,s55,16
s_add_u32 s78,s78,57344
s_cmp_lt_u32 s55,64
s_cselect_b32 s78,s78,0x7fff0000
s_add_u32 s71,s70,65536
s_add_u32 s60,s63,1
s_and_b32 s60,s60,3
s_lshl_b32 s72,s60,20
v_mov_b32 v184,0
v_mov_b32 v185,0
v_mov_b32 v186,0
v_mov_b32 v187,0
v_mov_b32 v188,0
v_mov_b32 v189,0
v_mov_b32 v190,0
v_mov_b32 v191,0
s_lshl_b32 s74,s63,21
s_lshl_b32 s55,s63,13
s_and_b32 s55,s55,0x2000
s_xor_b32 s55,s55,s61
s_add_u32 s74,s74,s55
v_mov_b32 v176,0
v_mov_b32 v177,0
v_mov_b32 v178,0
v_mov_b32 v179,0
s_nop 15
s_nop 15
s_nop 15
s_nop 15
s_nop 15
s_nop 15
s_nop 15
pp_173:
buffer_load_dwordx4 v[32:35],v9,s[20:23],s88 offen sc1
buffer_load_dwordx4 v[36:39],v10,s[20:23],s88 offen sc1
buffer_load_dwordx4 v[40:43],v11,s[20:23],s88 offen sc1
s_waitcnt vmcnt(2)
v_min3_u32 v22,v32,v33,v34
v_pk_add_f32 v[220:221],v[216:217],v[32:33]
v_pk_add_f32 v[222:223],v[218:219],v[34:35]
s_waitcnt vmcnt(0)
v_min3_u32 v22,v22,v35,v36
v_min3_u32 v22,v22,v37,v38
v_min3_u32 v22,v22,v39,v40
v_min3_u32 v22,v22,v41,v42
v_min_u32 v22,v22,v43
v_pk_add_f32 v[36:37],v[36:37],v[40:41]
v_cmp_eq_u32 vcc,0,v22
v_pk_add_f32 v[38:39],v[38:39],v[42:43]
s_cbranch_vccz pok_174
s_sub_u32 s90,s90,1
s_cmp_gt_i32 s90,0
s_cbranch_scc1 pp_173
pok_174:
v_pk_add_f32 v[220:221],v[220:221],v[36:37]
v_pk_add_f32 v[222:223],v[222:223],v[38:39]
s_mov_b64 vcc,s[86:87]
v_cvt_pk_bf16_f32 v216,v220,v221
v_cvt_pk_bf16_f32 v217,v222,v223
s_nop 0
v_mov_b32_dpp v218,v216 quad_perm:[1,0,3,2] row_mask:0xf bank_mask:0xf
v_mov_b32_dpp v219,v217 quad_perm:[1,0,3,2] row_mask:0xf bank_mask:0xf
v_perm_b32 v216,v218,v216,v15
v_perm_b32 v217,v219,v217,v15
s_nop 1
v_cndmask_b32_dpp v220,v217,v216,vcc quad_perm:[2,3,0,1] row_mask:0xf bank_mask:0xf
s_not_b64 vcc,vcc
v_cndmask_b32_dpp v221,v216,v217,vcc quad_perm:[2,3,0,1] row_mask:0xf bank_mask:0xf
v_max_u32 v220,1,v220
v_max_u32 v221,1,v221
buffer_store_dwordx2 v[220:221],v30,s[24:27],s89 offen
buffer_store_dwordx2 v[220:221],v30,s[28:31],s89 offen sc1
s_mov_b64 exec,1
buffer_store_dword v25,v13,s[24:27],s89 offen
buffer_store_dword v25,v13,s[28:31],s89 offen sc1
s_mov_b64 exec,-1
s_add_u32 s79,s79,1
s_branch loop_152
art_156:
s_sub_u32 s90,s90,1
s_cmp_lt_i32 s90,0
s_cbranch_scc1 abk_157
buffer_load_dwordx4 v[80:83],v29,s[20:23],s70 offen offset:0 sc1
buffer_load_dwordx4 v[84:87],v29,s[20:23],s70 offen offset:1024 sc1
buffer_load_dwordx4 v[88:91],v29,s[20:23],s70 offen offset:2048 sc1
buffer_load_dwordx4 v[92:95],v29,s[20:23],s70 offen offset:3072 sc1
s_waitcnt vmcnt(3)
ds_write_b128 v24,v[80:83] offset:12288
v_min3_u32 v22,v80,v81,v82
v_min_u32 v22,v22,v83
s_waitcnt vmcnt(2)
ds_write_b128 v24,v[84:87] offset:13312
v_min3_u32 v22,v22,v84,v85
v_min3_u32 v22,v22,v86,v87
s_waitcnt vmcnt(1)
ds_write_b128 v24,v[88:91] offset:14336
v_min3_u32 v22,v22,v88,v89
v_min3_u32 v22,v22,v90,v91
s_waitcnt vmcnt(0)
ds_write_b128 v24,v[92:95] offset:15360
v_min3_u32 v22,v22,v92,v93
v_min3_u32 v22,v22,v94,v95
v_cmp_eq_u32 vcc,0,v22
s_cbranch_vccnz art_156
s_branch abk_157
ms_161:
s_waitcnt vmcnt(0)
buffer_load_dwordx4 v[64:67],v28,s[20:23],s71 offen offset:0 sc1
buffer_load_dwordx4 v[68:71],v28,s[20:23],s71 offen offset:1024 sc1
s_bitset1_b32 s68,0
s_branch bk_162
ms_163:
s_waitcnt vmcnt(0)
buffer_load_dwordx4 v[72:75],v28,s[20:23],s71 offen offset:2048 sc1
buffer_load_dwordx4 v[76:79],v28,s[20:23],s71 offen offset:3072 sc1
s_bitset1_b32 s68,1
s_branch bk_164
ms_165:
s_waitcnt vmcnt(0)
buffer_load_dwordx4 v[80:83],v29,s[20:23],s71 offen offset:0 sc1
buffer_load_dwordx4 v[84:87],v29,s[20:23],s71 offen offset:1024 sc1
s_bitset1_b32 s68,2
s_branch bk_166
ms_169:
s_waitcnt vmcnt(0)
buffer_load_dwordx4 v[88:91],v29,s[20:23],s71 offen offset:2048 sc1
buffer_load_dwordx4 v[92:95],v29,s[20:23],s71 offen offset:3072 sc1
s_bitset1_b32 s68,3
s_branch bk_170
rl_168:
s_bitcmp1_b32 s68,0
s_cbranch_scc0 sk_175
buffer_load_dwordx4 v[64:67],v28,s[20:23],s71 offen offset:0 sc1
buffer_load_dwordx4 v[68:71],v28,s[20:23],s71 offen offset:1024 sc1
sk_175:
s_bitcmp1_b32 s68,1
s_cbranch_scc0 sk_176
buffer_load_dwordx4 v[72:75],v28,s[20:23],s71 offen offset:2048 sc1
buffer_load_dwordx4 v[76:79],v28,s[20:23],s71 offen offset:3072 sc1
sk_176:
s_bitcmp1_b32 s68,2
s_cbranch_scc0 sk_177
buffer_load_dwordx4 v[80:83],v29,s[20:23],s71 offen offset:0 sc1
buffer_load_dwordx4 v[84:87],v29,s[20:23],s71 offen offset:1024 sc1
sk_177:
s_bitcmp1_b32 s68,3
s_cbranch_scc0 sk_178
buffer_load_dwordx4 v[88:91],v29,s[20:23],s71 offen offset:2048 sc1
buffer_load_dwordx4 v[92:95],v29,s[20:23],s71 offen offset:3072 sc1
sk_178:
rl2_171:
s_sub_u32 s90,s90,1
s_cmp_lt_i32 s90,0
s_cbranch_scc1 fin_167
s_waitcnt vmcnt(0)
s_bitcmp1_b32 s68,0
s_cbranch_scc0 sk_179
v_min3_u32 v22,v64,v65,v66
v_min3_u32 v22,v22,v67,v68
v_min3_u32 v22,v22,v69,v70
v_min_u32 v22,v22,v71
v_cmp_eq_u32 vcc,0,v22
v_xor_b32 v64,v32,v64
v_xor_b32 v65,v33,v65
v_xor_b32 v66,v34,v66
v_xor_b32 v67,v35,v67
v_xor_b32 v68,v36,v68
v_xor_b32 v69,v37,v69
v_xor_b32 v70,v38,v70
v_xor_b32 v71,v39,v71
s_cbranch_vccnz nb_180
s_bitset0_b32 s68,0
v_smfmac_f32_16x16x64_bf16 v[184:187],v[64:67],a[128:135],v14
v_smfmac_f32_16x16x64_bf16 v[188:191],v[64:67],a[136:143],v14
v_smfmac_f32_16x16x64_bf16 v[184:187],v[68:71],a[144:151],v14
v_smfmac_f32_16x16x64_bf16 v[188:191],v[68:71],a[152:159],v14
nb_180:
sk_179:
s_bitcmp1_b32 s68,1
s_cbranch_scc0 sk_181
v_min3_u32 v22,v72,v73,v74
v_min3_u32 v22,v22,v75,v76
v_min3_u32 v22,v22,v77,v78
v_min_u32 v22,v22,v79
v_cmp_eq_u32 vcc,0,v22
v_xor_b32 v72,v40,v72
v_xor_b32 v73,v41,v73
v_xor_b32 v74,v42,v74
v_xor_b32 v75,v43,v75
v_xor_b32 v76,v44,v76
v_xor_b32 v77,v45,v77
v_xor_b32 v78,v46,v78
v_xor_b32 v79,v47,v79
s_cbranch_vccnz nb_182
s_bitset0_b32 s68,1
v_smfmac_f32_16x16x64_bf16 v[184:187],v[72:75],a[160:167],v14
v_smfmac_f32_16x16x64_bf16 v[188:191],v[72:75],a[168:175],v14
v_smfmac_f32_16x16x64_bf16 v[184:187],v[76:79],a[176:183],v14
v_smfmac_f32_16x16x64_bf16 v[188:191],v[76:79],a[184:191],v14
nb_182:
sk_181:
s_bitcmp1_b32 s68,2
s_cbranch_scc0 sk_183
v_min3_u32 v22,v80,v81,v82
v_min3_u32 v22,v22,v83,v84
v_min3_u32 v22,v22,v85,v86
v_min_u32 v22,v22,v87
v_cmp_eq_u32 vcc,0,v22
v_xor_b32 v80,v48,v80
v_xor_b32 v81,v49,v81
v_xor_b32 v82,v50,v82
v_xor_b32 v83,v51,v83
v_xor_b32 v84,v52,v84
v_xor_b32 v85,v53,v85
v_xor_b32 v86,v54,v86
v_xor_b32 v87,v55,v87
s_cbranch_vccnz nb_184
s_bitset0_b32 s68,2
v_smfmac_f32_16x16x64_bf16 v[184:187],v[80:83],a[192:199],v14
v_smfmac_f32_16x16x64_bf16 v[188:191],v[80:83],a[200:207],v14
v_smfmac_f32_16x16x64_bf16 v[184:187],v[84:87],a[208:215],v14
v_smfmac_f32_16x16x64_bf16 v[188:191],v[84:87],a[216:223],v14
nb_184:
sk_183:
s_bitcmp1_b32 s68,3
s_cbranch_scc0 sk_185
v_min3_u32 v22,v88,v89,v90
v_min3_u32 v22,v22,v91,v92
v_min3_u32 v22,v22,v93,v94
v_min_u32 v22,v22,v95
v_cmp_eq_u32 vcc,0,v22
v_xor_b32 v88,v56,v88
v_xor_b32 v89,v57,v89
v_xor_b32 v90,v58,v90
v_xor_b32 v91,v59,v91
v_xor_b32 v92,v60,v92
v_xor_b32 v93,v61,v93
v_xor_b32 v94,v62,v94
v_xor_b32 v95,v63,v95
s_cbranch_vccnz nb_186
s_bitset0_b32 s68,3
v_smfmac_f32_16x16x64_bf16 v[184:187],v[88:91],a[224:231],v14
v_smfmac_f32_16x16x64_bf16 v[188:191],v[88:91],a[232:239],v14
v_smfmac_f32_16x16x64_bf16 v[184:187],v[92:95],a[240:247],v14
v_smfmac_f32_16x16x64_bf16 v[188:191],v[92:95],a[248:255],v14
nb_186:
sk_185:
s_cmp_lg_u32 s68,0
s_cbranch_scc1 rl_168
s_nop 2
s_branch fin_167
first_151:
s_waitcnt vmcnt(0) lgkmcnt(0)
s_barrier
s_add_u32 s64,s15,393216
buffer_load_dwordx4 a[176:179],v32,s[40:43],s64 offen nt
s_add_u32 s64,s15,425984
buffer_load_dwordx4 a[180:183],v32,s[40:43],s64 offen nt
s_add_u32 s64,s15,458752
buffer_load_dwordx4 a[184:187],v32,s[40:43],s64 offen nt
s_add_u32 s64,s15,491520
buffer_load_dwordx4 a[188:191],v32,s[40:43],s64 offen nt
s_add_u32 s64,s15,524288
buffer_load_dwordx4 a[192:195],v32,s[40:43],s64 offen nt
s_add_u32 s64,s15,557056
buffer_load_dwordx4 a[196:199],v32,s[40:43],s64 offen nt
s_add_u32 s64,s15,589824
buffer_load_dwordx4 a[200:203],v32,s[40:43],s64 offen nt
s_add_u32 s64,s15,622592
buffer_load_dwordx4 a[204:207],v32,s[40:43],s64 offen nt
s_add_u32 s64,s15,655360
buffer_load_dwordx4 a[208:211],v32,s[40:43],s64 offen nt
s_add_u32 s64,s15,688128
buffer_load_dwordx4 a[212:215],v32,s[40:43],s64 offen nt
s_add_u32 s64,s15,720896
buffer_load_dwordx4 a[216:219],v32,s[40:43],s64 offen nt
s_add_u32 s64,s15,753664
buffer_load_dwordx4 a[220:223],v32,s[40:43],s64 offen nt
s_add_u32 s64,s15,786432
buffer_load_dwordx4 a[224:227],v32,s[40:43],s64 offen nt
s_add_u32 s64,s15,819200
buffer_load_dwordx4 a[228:231],v32,s[40:43],s64 offen nt
s_add_u32 s64,s15,851968
buffer_load_dwordx4 a[232:235],v32,s[40:43],s64 offen nt
s_add_u32 s64,s15,884736
buffer_load_dwordx4 a[236:239],v32,s[40:43],s64 offen nt
s_add_u32 s64,s15,917504
buffer_load_dwordx4 a[240:243],v32,s[40:43],s64 offen nt
s_add_u32 s64,s15,950272
buffer_load_dwordx4 a[244:247],v32,s[40:43],s64 offen nt
s_add_u32 s64,s15,983040
buffer_load_dwordx4 a[248:251],v32,s[40:43],s64 offen nt
s_add_u32 s64,s15,1015808
buffer_load_dwordx4 a[252:255],v32,s[40:43],s64 offen nt
ds_write_b128 v33,a[0:3] offset:0
ds_write_b128 v33,a[4:7] offset:1024
ds_write_b128 v33,a[8:11] offset:2048
ds_write_b128 v33,a[12:15] offset:3072
s_waitcnt lgkmcnt(0)
v_mov_b32 v38,1
ds_write_b32 v37,v38 offset:4
qs_187:
ds_read_b32 v39,v37 offset:0
s_sub_u32 s90,s90,1
s_waitcnt lgkmcnt(0)
v_cmp_gt_u32 vcc,v38,v39
s_cmp_lt_i32 s90,0
s_cselect_b64 vcc,0,vcc
s_cbranch_vccnz qs_187
ds_read_b64_tr_b16 a[0:1],v36 offset:0
ds_read_b64_tr_b16 a[2:3],v36 offset:128
ds_read_b64_tr_b16 a[4:5],v36 offset:2048
ds_read_b64_tr_b16 a[6:7],v36 offset:2176
ds_read_b64_tr_b16 a[8:9],v36 offset:8192
ds_read_b64_tr_b16 a[10:11],v36 offset:8320
ds_read_b64_tr_b16 a[12:13],v36 offset:10240
ds_read_b64_tr_b16 a[14:15],v36 offset:10368
ds_write_b128 v33,a[16:19] offset:4096
ds_write_b128 v33,a[20:23] offset:5120
ds_write_b128 v33,a[24:27] offset:6144
ds_write_b128 v33,a[28:31] offset:7168
s_waitcnt lgkmcnt(0)
v_mov_b32 v38,2
ds_write_b32 v37,v38 offset:4
qs_188:
ds_read_b32 v39,v37 offset:0
s_sub_u32 s90,s90,1
s_waitcnt lgkmcnt(0)
v_cmp_gt_u32 vcc,v38,v39
s_cmp_lt_i32 s90,0
s_cselect_b64 vcc,0,vcc
s_cbranch_vccnz qs_188
ds_read_b64_tr_b16 a[16:17],v36 offset:4096
ds_read_b64_tr_b16 a[18:19],v36 offset:4224
ds_read_b64_tr_b16 a[20:21],v36 offset:6144
ds_read_b64_tr_b16 a[22:23],v36 offset:6272
ds_read_b64_tr_b16 a[24:25],v36 offset:12288
ds_read_b64_tr_b16 a[26:27],v36 offset:12416
ds_read_b64_tr_b16 a[28:29],v36 offset:14336
ds_read_b64_tr_b16 a[30:31],v36 offset:14464
ds_write_b128 v33,a[32:35] offset:0
ds_write_b128 v33,a[36:39] offset:1024
ds_write_b128 v33,a[40:43] offset:2048
ds_write_b128 v33,a[44:47] offset:3072
s_waitcnt lgkmcnt(0)
v_mov_b32 v38,3
ds_write_b32 v37,v38 offset:4
qs_189:
ds_read_b32 v39,v37 offset:0
s_sub_u32 s90,s90,1
s_waitcnt lgkmcnt(0)
v_cmp_gt_u32 vcc,v38,v39
s_cmp_lt_i32 s90,0
s_cselect_b64 vcc,0,vcc
s_cbranch_vccnz qs_189
ds_read_b64_tr_b16 a[32:33],v36 offset:0
ds_read_b64_tr_b16 a[34:35],v36 offset:128
ds_read_b64_tr_b16 a[36:37],v36 offset:2048
ds_read_b64_tr_b16 a[38:39],v36 offset:2176
ds_read_b64_tr_b16 a[40:41],v36 offset:8192
ds_read_b64_tr_b16 a[42:43],v36 offset:8320
ds_read_b64_tr_b16 a[44:45],v36 offset:10240
ds_read_b64_tr_b16 a[46:47],v36 offset:10368
ds_write_b128 v33,a[48:51] offset:4096
ds_write_b128 v33,a[52:55] offset:5120
ds_write_b128 v33,a[56:59] offset:6144
ds_write_b128 v33,a[60:63] offset:7168
s_waitcnt lgkmcnt(0)
v_mov_b32 v38,4
ds_write_b32 v37,v38 offset:4
qs_190:
ds_read_b32 v39,v37 offset:0
s_sub_u32 s90,s90,1
s_waitcnt lgkmcnt(0)
v_cmp_gt_u32 vcc,v38,v39
s_cmp_lt_i32 s90,0
s_cselect_b64 vcc,0,vcc
s_cbranch_vccnz qs_190
ds_read_b64_tr_b16 a[48:49],v36 offset:4096
ds_read_b64_tr_b16 a[50:51],v36 offset:4224
ds_read_b64_tr_b16 a[52:53],v36 offset:6144
ds_read_b64_tr_b16 a[54:55],v36 offset:6272
ds_read_b64_tr_b16 a[56:57],v36 offset:12288
ds_read_b64_tr_b16 a[58:59],v36 offset:12416
ds_read_b64_tr_b16 a[60:61],v36 offset:14336
ds_read_b64_tr_b16 a[62:63],v36 offset:14464
ds_write_b128 v33,a[64:67] offset:0
ds_write_b128 v33,a[68:71] offset:1024
ds_write_b128 v33,a[72:75] offset:2048
ds_write_b128 v33,a[76:79] offset:3072
s_waitcnt lgkmcnt(0)
v_mov_b32 v38,5
ds_write_b32 v37,v38 offset:4
qs_191:
ds_read_b32 v39,v37 offset:0
s_sub_u32 s90,s90,1
s_waitcnt lgkmcnt(0)
v_cmp_gt_u32 vcc,v38,v39
s_cmp_lt_i32 s90,0
s_cselect_b64 vcc,0,vcc
s_cbranch_vccnz qs_191
ds_read_b64_tr_b16 a[64:65],v36 offset:0
ds_read_b64_tr_b16 a[66:67],v36 offset:128
ds_read_b64_tr_b16 a[68:69],v36 offset:2048
ds_read_b64_tr_b16 a[70:71],v36 offset:2176
ds_read_b64_tr_b16 a[72:73],v36 offset:8192
ds_read_b64_tr_b16 a[74:75],v36 offset:8320
ds_read_b64_tr_b16 a[76:77],v36 offset:10240
ds_read_b64_tr_b16 a[78:79],v36 offset:10368
ds_write_b128 v33,a[80:83] offset:4096
ds_write_b128 v33,a[84:87] offset:5120
ds_write_b128 v33,a[88:91] offset:6144
ds_write_b128 v33,a[92:95] offset:7168
s_waitcnt lgkmcnt(0)
v_mov_b32 v38,6
ds_write_b32 v37,v38 offset:4
qs_192:
ds_read_b32 v39,v37 offset:0
s_sub_u32 s90,s90,1
s_waitcnt lgkmcnt(0)
v_cmp_gt_u32 vcc,v38,v39
s_cmp_lt_i32 s90,0
s_cselect_b64 vcc,0,vcc
s_cbranch_vccnz qs_192
ds_read_b64_tr_b16 a[80:81],v36 offset:4096
ds_read_b64_tr_b16 a[82:83],v36 offset:4224
ds_read_b64_tr_b16 a[84:85],v36 offset:6144
ds_read_b64_tr_b16 a[86:87],v36 offset:6272
ds_read_b64_tr_b16 a[88:89],v36 offset:12288
ds_read_b64_tr_b16 a[90:91],v36 offset:12416
ds_read_b64_tr_b16 a[92:93],v36 offset:14336
ds_read_b64_tr_b16 a[94:95],v36 offset:14464
ds_write_b128 v33,a[96:99] offset:0
ds_write_b128 v33,a[100:103] offset:1024
ds_write_b128 v33,a[104:107] offset:2048
ds_write_b128 v33,a[108:111] offset:3072
s_waitcnt lgkmcnt(0)
v_mov_b32 v38,7
ds_write_b32 v37,v38 offset:4
qs_193:
ds_read_b32 v39,v37 offset:0
s_sub_u32 s90,s90,1
s_waitcnt lgkmcnt(0)
v_cmp_gt_u32 vcc,v38,v39
s_cmp_lt_i32 s90,0
s_cselect_b64 vcc,0,vcc
s_cbranch_vccnz qs_193
ds_read_b64_tr_b16 a[96:97],v36 offset:0
ds_read_b64_tr_b16 a[98:99],v36 offset:128
ds_read_b64_tr_b16 a[100:101],v36 offset:2048
ds_read_b64_tr_b16 a[102:103],v36 offset:2176
ds_read_b64_tr_b16 a[104:105],v36 offset:8192
ds_read_b64_tr_b16 a[106:107],v36 offset:8320
ds_read_b64_tr_b16 a[108:109],v36 offset:10240
ds_read_b64_tr_b16 a[110:111],v36 offset:10368
ds_write_b128 v33,a[112:115] offset:4096
ds_write_b128 v33,a[116:119] offset:5120
ds_write_b128 v33,a[120:123] offset:6144
ds_write_b128 v33,a[124:127] offset:7168
s_waitcnt lgkmcnt(0)
v_mov_b32 v38,8
ds_write_b32 v37,v38 offset:4
qs_194:
ds_read_b32 v39,v37 offset:0
s_sub_u32 s90,s90,1
s_waitcnt lgkmcnt(0)
v_cmp_gt_u32 vcc,v38,v39
s_cmp_lt_i32 s90,0
s_cselect_b64 vcc,0,vcc
s_cbranch_vccnz qs_194
ds_read_b64_tr_b16 a[112:113],v36 offset:4096
ds_read_b64_tr_b16 a[114:115],v36 offset:4224
ds_read_b64_tr_b16 a[116:117],v36 offset:6144
ds_read_b64_tr_b16 a[118:119],v36 offset:6272
ds_read_b64_tr_b16 a[120:121],v36 offset:12288
ds_read_b64_tr_b16 a[122:123],v36 offset:12416
ds_read_b64_tr_b16 a[124:125],v36 offset:14336
ds_read_b64_tr_b16 a[126:127],v36 offset:14464
s_waitcnt lgkmcnt(0)
v_mov_b32 v38,9
ds_write_b32 v37,v38 offset:4
qs_195:
ds_read_b32 v39,v37 offset:0
s_sub_u32 s90,s90,1
s_waitcnt lgkmcnt(0)
v_cmp_gt_u32 vcc,v38,v39
s_cmp_lt_i32 s90,0
s_cselect_b64 vcc,0,vcc
s_cbranch_vccnz qs_195
ds_write_b128 v33,a[128:131] offset:0
ds_write_b128 v33,a[132:135] offset:1024
ds_write_b128 v33,a[136:139] offset:2048
ds_write_b128 v33,a[140:143] offset:3072
s_waitcnt lgkmcnt(0)
ds_read_b64_tr_b16 a[128:129],v34 offset:0
ds_read_b64_tr_b16 a[130:131],v34 offset:128
ds_read_b64_tr_b16 a[132:133],v34 offset:2048
ds_read_b64_tr_b16 a[134:135],v34 offset:2176
ds_read_b64_tr_b16 a[136:137],v34 offset:32
ds_read_b64_tr_b16 a[138:139],v34 offset:160
ds_read_b64_tr_b16 a[140:141],v34 offset:2080
ds_read_b64_tr_b16 a[142:143],v34 offset:2208
ds_write_b128 v33,a[144:147] offset:4096
ds_write_b128 v33,a[148:151] offset:5120
ds_write_b128 v33,a[152:155] offset:6144
ds_write_b128 v33,a[156:159] offset:7168
s_waitcnt lgkmcnt(0)
ds_read_b64_tr_b16 a[144:145],v34 offset:4096
ds_read_b64_tr_b16 a[146:147],v34 offset:4224
ds_read_b64_tr_b16 a[148:149],v34 offset:6144
ds_read_b64_tr_b16 a[150:151],v34 offset:6272
ds_read_b64_tr_b16 a[152:153],v34 offset:4128
ds_read_b64_tr_b16 a[154:155],v34 offset:4256
ds_read_b64_tr_b16 a[156:157],v34 offset:6176
ds_read_b64_tr_b16 a[158:159],v34 offset:6304
ds_write_b128 v33,a[160:163] offset:0
ds_write_b128 v33,a[164:167] offset:1024
ds_write_b128 v33,a[168:171] offset:2048
ds_write_b128 v33,a[172:175] offset:3072
s_waitcnt lgkmcnt(0)
ds_read_b64_tr_b16 a[160:161],v34 offset:0
ds_read_b64_tr_b16 a[162:163],v34 offset:128
ds_read_b64_tr_b16 a[164:165],v34 offset:2048
ds_read_b64_tr_b16 a[166:167],v34 offset:2176
ds_read_b64_tr_b16 a[168:169],v34 offset:32
ds_read_b64_tr_b16 a[170:171],v34 offset:160
ds_read_b64_tr_b16 a[172:173],v34 offset:2080
ds_read_b64_tr_b16 a[174:175],v34 offset:2208
free_196:
ds_read_b64 v[38:39],v37 offset:8
s_sub_u32 s90,s90,1
s_waitcnt lgkmcnt(0)
v_and_b32 v38,v38,v39
v_cmp_eq_u32 vcc,0,v38
s_cmp_lt_i32 s90,0
s_cselect_b64 vcc,0,vcc
s_cbranch_vccnz free_196
s_xor_b32 s64,s61,10493952
buffer_store_dwordx4 v[100:103],v206,s[20:23],s64 offen sc1
buffer_store_dwordx4 v[100:103],v207,s[20:23],s64 offen sc1
s_xor_b32 s64,s61,12582912
buffer_store_dwordx4 v[100:103],v206,s[20:23],s64 offen sc1
buffer_store_dwordx4 v[100:103],v207,s[20:23],s64 offen sc1
s_xor_b32 s64,s61,14688256
buffer_store_dwordx4 v[100:103],v206,s[20:23],s64 offen sc1
buffer_store_dwordx4 v[100:103],v207,s[20:23],s64 offen sc1
s_mov_b32 m0,32768
s_mov_b32 s65,221184
buffer_load_dwordx4 v16,s[20:23],s65 offen offset:0 lds
buffer_load_dwordx4 v16,s[20:23],s65 offen offset:1024 lds
buffer_load_dwordx4 v16,s[20:23],s65 offen offset:2048 lds
buffer_load_dwordx4 v16,s[20:23],s65 offen offset:3072 lds
s_mov_b32 m0,36864
s_mov_b32 s65,225280
buffer_load_dwordx4 v16,s[20:23],s65 offen offset:0 lds
buffer_load_dwordx4 v16,s[20:23],s65 offen offset:1024 lds
buffer_load_dwordx4 v16,s[20:23],s65 offen offset:2048 lds
buffer_load_dwordx4 v16,s[20:23],s65 offen offset:3072 lds
s_mov_b32 m0,40960
s_mov_b32 s65,229376
buffer_load_dwordx4 v16,s[20:23],s65 offen offset:0 lds
buffer_load_dwordx4 v16,s[20:23],s65 offen offset:1024 lds
buffer_load_dwordx4 v16,s[20:23],s65 offen offset:2048 lds
buffer_load_dwordx4 v16,s[20:23],s65 offen offset:3072 lds
s_mov_b32 m0,45056
s_mov_b32 s65,233472
buffer_load_dwordx4 v16,s[20:23],s65 offen offset:0 lds
buffer_load_dwordx4 v16,s[20:23],s65 offen offset:1024 lds
buffer_load_dwordx4 v16,s[20:23],s65 offen offset:2048 lds
buffer_load_dwordx4 v16,s[20:23],s65 offen offset:3072 lds
s_mov_b32 m0,49152
s_mov_b32 s65,237568
buffer_load_dwordx4 v16,s[20:23],s65 offen offset:0 lds
buffer_load_dwordx4 v16,s[20:23],s65 offen offset:1024 lds
buffer_load_dwordx4 v16,s[20:23],s65 offen offset:2048 lds
buffer_load_dwordx4 v16,s[20:23],s65 offen offset:3072 lds
s_mov_b32 m0,53248
s_mov_b32 s65,241664
buffer_load_dwordx4 v16,s[20:23],s65 offen offset:0 lds
buffer_load_dwordx4 v16,s[20:23],s65 offen offset:1024 lds
buffer_load_dwordx4 v16,s[20:23],s65 offen offset:2048 lds
buffer_load_dwordx4 v16,s[20:23],s65 offen offset:3072 lds
s_mov_b32 m0,57344
s_mov_b32 s65,245760
buffer_load_dwordx4 v16,s[20:23],s65 offen offset:0 lds
buffer_load_dwordx4 v16,s[20:23],s65 offen offset:1024 lds
buffer_load_dwordx4 v16,s[20:23],s65 offen offset:2048 lds
buffer_load_dwordx4 v16,s[20:23],s65 offen offset:3072 lds
s_mov_b32 m0,61440
s_mov_b32 s65,249856
buffer_load_dwordx4 v16,s[20:23],s65 offen offset:0 lds
buffer_load_dwordx4 v16,s[20:23],s65 offen offset:1024 lds
buffer_load_dwordx4 v16,s[20:23],s65 offen offset:2048 lds
buffer_load_dwordx4 v16,s[20:23],s65 offen offset:3072 lds
s_waitcnt vmcnt(54)
ds_write_b128 v33,a[176:179] offset:4096
ds_write_b128 v33,a[180:183] offset:5120
ds_write_b128 v33,a[184:187] offset:6144
ds_write_b128 v33,a[188:191] offset:7168
s_waitcnt lgkmcnt(0)
ds_read_b64_tr_b16 a[176:177],v34 offset:4096
ds_read_b64_tr_b16 a[178:179],v34 offset:4224
ds_read_b64_tr_b16 a[180:181],v34 offset:6144
ds_read_b64_tr_b16 a[182:183],v34 offset:6272
ds_read_b64_tr_b16 a[184:185],v34 offset:4128
ds_read_b64_tr_b16 a[186:187],v34 offset:4256
ds_read_b64_tr_b16 a[188:189],v34 offset:6176
ds_read_b64_tr_b16 a[190:191],v34 offset:6304
s_waitcnt vmcnt(50)
ds_write_b128 v33,a[192:195] offset:0
ds_write_b128 v33,a[196:199] offset:1024
ds_write_b128 v33,a[200:203] offset:2048
ds_write_b128 v33,a[204:207] offset:3072
s_waitcnt lgkmcnt(0)
ds_read_b64_tr_b16 a[192:193],v34 offset:0
ds_read_b64_tr_b16 a[194:195],v34 offset:128
ds_read_b64_tr_b16 a[196:197],v34 offset:2048
ds_read_b64_tr_b16 a[198:199],v34 offset:2176
ds_read_b64_tr_b16 a[200:201],v34 offset:32
ds_read_b64_tr_b16 a[202:203],v34 offset:160
ds_read_b64_tr_b16 a[204:205],v34 offset:2080
ds_read_b64_tr_b16 a[206:207],v34 offset:2208
s_waitcnt vmcnt(46)
ds_write_b128 v33,a[208:211] offset:4096
ds_write_b128 v33,a[212:215] offset:5120
ds_write_b128 v33,a[216:219] offset:6144
ds_write_b128 v33,a[220:223] offset:7168
s_waitcnt lgkmcnt(0)
ds_read_b64_tr_b16 a[208:209],v34 offset:4096
ds_read_b64_tr_b16 a[210:211],v34 offset:4224
ds_read_b64_tr_b16 a[212:213],v34 offset:6144
ds_read_b64_tr_b16 a[214:215],v34 offset:6272
ds_read_b64_tr_b16 a[216:217],v34 offset:4128
ds_read_b64_tr_b16 a[218:219],v34 offset:4256
ds_read_b64_tr_b16 a[220:221],v34 offset:6176
ds_read_b64_tr_b16 a[222:223],v34 offset:6304
s_waitcnt vmcnt(42)
ds_write_b128 v33,a[224:227] offset:0
ds_write_b128 v33,a[228:231] offset:1024
ds_write_b128 v33,a[232:235] offset:2048
ds_write_b128 v33,a[236:239] offset:3072
s_waitcnt lgkmcnt(0)
ds_read_b64_tr_b16 a[224:225],v34 offset:0
ds_read_b64_tr_b16 a[226:227],v34 offset:128
ds_read_b64_tr_b16 a[228:229],v34 offset:2048
ds_read_b64_tr_b16 a[230:231],v34 offset:2176
ds_read_b64_tr_b16 a[232:233],v34 offset:32
ds_read_b64_tr_b16 a[234:235],v34 offset:160
ds_read_b64_tr_b16 a[236:237],v34 offset:2080
ds_read_b64_tr_b16 a[238:239],v34 offset:2208
s_waitcnt vmcnt(38)
ds_write_b128 v33,a[240:243] offset:4096
ds_write_b128 v33,a[244:247] offset:5120
ds_write_b128 v33,a[248:251] offset:6144
ds_write_b128 v33,a[252:255] offset:7168
s_waitcnt lgkmcnt(0)
ds_read_b64_tr_b16 a[240:241],v34 offset:4096
ds_read_b64_tr_b16 a[242:243],v34 offset:4224
ds_read_b64_tr_b16 a[244:245],v34 offset:6144
ds_read_b64_tr_b16 a[246:247],v34 offset:6272
ds_read_b64_tr_b16 a[248:249],v34 offset:4128
ds_read_b64_tr_b16 a[250:251],v34 offset:4256
ds_read_b64_tr_b16 a[252:253],v34 offset:6176
ds_read_b64_tr_b16 a[254:255],v34 offset:6304
s_mov_b32 s79,0
s_add_u32 s63,s79,0
s_and_b32 s64,s63,3
s_lshl_b32 s70,s64,20
s_add_u32 s65,s63,2
s_and_b32 s65,s65,3
s_lshl_b32 s73,s65,20
s_add_u32 s55,s63,3
s_lshl_b32 s78,s55,16
s_add_u32 s78,s78,57344
s_cmp_lt_u32 s55,64
s_cselect_b32 s78,s78,0x7fff0000
s_add_u32 s71,s70,65536
s_add_u32 s60,s63,1
s_and_b32 s60,s60,3
s_lshl_b32 s72,s60,20
v_mov_b32 v184,0
v_mov_b32 v185,0
v_mov_b32 v186,0
v_mov_b32 v187,0
v_mov_b32 v188,0
v_mov_b32 v189,0
v_mov_b32 v190,0
v_mov_b32 v191,0
s_lshl_b32 s74,s63,21
s_lshl_b32 s55,s63,13
s_and_b32 s55,s55,0x2000
s_xor_b32 s55,s55,s61
s_add_u32 s74,s74,s55
v_mov_b32 v176,0
v_mov_b32 v177,0
v_mov_b32 v178,0
v_mov_b32 v179,0
v_mov_b32 v25,1
s_waitcnt vmcnt(0) lgkmcnt(0)
s_barrier
v_max_u32 v216,1,v216
v_max_u32 v217,1,v217
v_max_u32 v218,1,v218
v_max_u32 v219,1,v219
s_mov_b64 exec,s[84:85]
buffer_store_dwordx4 v[216:219],v12,s[24:27],s70 offen
buffer_store_dwordx4 v[216:219],v12,s[28:31],s70 offen sc1
s_mov_b64 exec,1
buffer_store_dword v25,v13,s[24:27],s70 offen
buffer_store_dword v25,v13,s[28:31],s70 offen sc1
s_mov_b64 exec,-1
s_branch loop_152
end_57:
s_waitcnt vmcnt(0)
s_barrier
s_mov_b32 s50,s91
done_1:
s_endpgm
pipe_worker:
v_and_b32 v1,63,v0
v_and_b32 v3,15,v1
v_lshrrev_b32 v4,4,v1
v_lshlrev_b32 v16,4,v1
v_mov_b32 v48,0
v_mov_b32 v49,0
v_mov_b32 v50,0
v_mov_b32 v51,0
s_lshr_b32 s58,s55,5
s_and_b32 s59,s55,31
s_xor_b32 s62,s61,0x2000
s_add_u32 s63,s62,21053440
s_lshr_b32 s64,s59,4
s_and_b32 s59,s59,15
s_lshr_b32 s65,s58,1
s_lshl_b32 s65,s65,4
s_add_u32 s59,s59,s65
s_mul_i32 s65,s64,3
s_add_u32 s64,s64,1
s_sub_u32 s58,s58,1
s_cmp_lt_u32 s58,2
s_cselect_b32 s58,s64,s65
s_load_dwordx2 s[4:5],s[0:1],16
v_lshlrev_b32 v5,4,v0
s_lshl_b32 s64,s55,14
s_add_u32 s64,s64,17825792
buffer_store_dwordx4 v[48:51],v5,s[20:23],s64 offen sc1
s_add_u32 s64,s64,4096
buffer_store_dwordx4 v[48:51],v5,s[20:23],s64 offen sc1
s_add_u32 s64,s64,4096
buffer_store_dwordx4 v[48:51],v5,s[20:23],s64 offen sc1
s_add_u32 s64,s64,4096
buffer_store_dwordx4 v[48:51],v5,s[20:23],s64 offen sc1
s_add_u32 s64,s64,4096
s_lshl_b32 s64,s55,12
s_add_u32 s64,s64,8577024
buffer_store_dwordx4 v[48:51],v5,s[20:23],s64 offen sc1
s_lshr_b32 s79,s55,5
s_add_u32 s64,s79,8
s_lshl_b32 s93,s64,21
s_lshl_b32 s64,s64,13
s_and_b32 s64,s64,0x2000
s_xor_b32 s64,s64,s61
s_add_u32 s93,s93,s64
s_add_u32 s93,s93,29360128
s_and_b32 s64,s55,31
s_add_u32 s64,s64,96
s_lshl_b32 s64,s64,14
s_add_u32 s93,s93,s64
s_waitcnt lgkmcnt(0)
s_mov_b32 s32,s4
s_and_b32 s33,s5,0xffff
s_mov_b32 s34,0x800000
s_mov_b32 s35,0x20000
v_lshrrev_b32 v5,3,v3
v_bfe_u32 v6,v3,2,1
v_lshl_add_u32 v7,v5,3,v6
v_lshl_add_u32 v6,v5,2,v6
v_lshrrev_b32 v5,1,v4
v_lshl_add_u32 v7,v5,4,v7
v_and_b32 v5,1,v4
v_lshl_add_u32 v7,v5,2,v7
v_lshl_add_u32 v6,v5,1,v6
v_bfe_u32 v5,v3,1,1
s_lshl_b32 s64,s50,1
v_add_u32 v5,s64,v5
v_xor_b32 v5,v5,v6
v_lshlrev_b32 v5,5,v5
v_lshl_add_u32 v5,v7,8,v5
v_and_b32 v6,1,v3
v_lshl_add_u32 v12,v6,4,v5
s_lshl_b32 s66,s59,8
v_and_b32 v5,15,v1
v_and_b32 v6,1,v4
v_lshlrev_b32 v6,1,v6
v_xor_b32 v5,v5,v6
v_mul_u32_u24 v6,8192,v4
v_xor_b32 v7,0,v5
v_lshl_add_u32 v8,v7,4,v6
v_xor_b32 v7,4,v5
v_lshl_add_u32 v9,v7,4,v6
v_xor_b32 v7,8,v5
v_lshl_add_u32 v10,v7,4,v6
v_xor_b32 v7,12,v5
v_lshl_add_u32 v11,v7,4,v6
s_mul_i32 s74,s50,524288
s_add_u32 s74,s74,s66
s_lshl_b32 s75,s50,14
s_mul_i32 s76,s50,262144
s_add_u32 s76,s76,s66
s_lshl_b32 s77,s50,13
s_add_u32 s64,s74,0
s_add_u32 m0,s75,0
s_nop 0
buffer_load_dwordx4 v8,s[32:35],s64 offen nt lds
s_add_u32 s64,s74,32768
s_add_u32 m0,s75,1024
s_nop 0
buffer_load_dwordx4 v9,s[32:35],s64 offen nt lds
s_add_u32 s64,s74,65536
s_add_u32 m0,s75,2048
s_nop 0
buffer_load_dwordx4 v10,s[32:35],s64 offen nt lds
s_add_u32 s64,s74,98304
s_add_u32 m0,s75,3072
s_nop 0
buffer_load_dwordx4 v11,s[32:35],s64 offen nt lds
s_add_u32 s64,s74,131072
s_add_u32 m0,s75,4096
s_nop 0
buffer_load_dwordx4 v8,s[32:35],s64 offen nt lds
s_add_u32 s64,s74,163840
s_add_u32 m0,s75,5120
s_nop 0
buffer_load_dwordx4 v9,s[32:35],s64 offen nt lds
s_add_u32 s64,s74,196608
s_add_u32 m0,s75,6144
s_nop 0
buffer_load_dwordx4 v10,s[32:35],s64 offen nt lds
s_add_u32 s64,s74,229376
s_add_u32 m0,s75,7168
s_nop 0
buffer_load_dwordx4 v11,s[32:35],s64 offen nt lds
s_add_u32 s64,s74,262144
s_add_u32 m0,s75,8192
s_nop 0
buffer_load_dwordx4 v8,s[32:35],s64 offen nt lds
s_add_u32 s64,s74,294912
s_add_u32 m0,s75,9216
s_nop 0
buffer_load_dwordx4 v9,s[32:35],s64 offen nt lds
s_add_u32 s64,s74,327680
s_add_u32 m0,s75,10240
s_nop 0
buffer_load_dwordx4 v10,s[32:35],s64 offen nt lds
s_add_u32 s64,s74,360448
s_add_u32 m0,s75,11264
s_nop 0
buffer_load_dwordx4 v11,s[32:35],s64 offen nt lds
s_add_u32 s64,s74,393216
s_add_u32 m0,s75,12288
s_nop 0
buffer_load_dwordx4 v8,s[32:35],s64 offen nt lds
s_add_u32 s64,s74,425984
s_add_u32 m0,s75,13312
s_nop 0
buffer_load_dwordx4 v9,s[32:35],s64 offen nt lds
s_add_u32 s64,s74,458752
s_add_u32 m0,s75,14336
s_nop 0
buffer_load_dwordx4 v10,s[32:35],s64 offen nt lds
s_add_u32 s64,s74,491520
s_add_u32 m0,s75,15360
s_nop 0
buffer_load_dwordx4 v11,s[32:35],s64 offen nt lds
s_add_u32 s64,s74,2097152
s_add_u32 m0,s75,65536
s_nop 0
buffer_load_dwordx4 v8,s[32:35],s64 offen nt lds
s_add_u32 s64,s74,2129920
s_add_u32 m0,s75,66560
s_nop 0
buffer_load_dwordx4 v9,s[32:35],s64 offen nt lds
s_add_u32 s64,s74,2162688
s_add_u32 m0,s75,67584
s_nop 0
buffer_load_dwordx4 v10,s[32:35],s64 offen nt lds
s_add_u32 s64,s74,2195456
s_add_u32 m0,s75,68608
s_nop 0
buffer_load_dwordx4 v11,s[32:35],s64 offen nt lds
s_add_u32 s64,s74,2228224
s_add_u32 m0,s75,69632
s_nop 0
buffer_load_dwordx4 v8,s[32:35],s64 offen nt lds
s_add_u32 s64,s74,2260992
s_add_u32 m0,s75,70656
s_nop 0
buffer_load_dwordx4 v9,s[32:35],s64 offen nt lds
s_add_u32 s64,s74,2293760
s_add_u32 m0,s75,71680
s_nop 0
buffer_load_dwordx4 v10,s[32:35],s64 offen nt lds
s_add_u32 s64,s74,2326528
s_add_u32 m0,s75,72704
s_nop 0
buffer_load_dwordx4 v11,s[32:35],s64 offen nt lds
s_add_u32 s64,s74,2359296
s_add_u32 m0,s75,73728
s_nop 0
buffer_load_dwordx4 v8,s[32:35],s64 offen nt lds
s_add_u32 s64,s74,2392064
s_add_u32 m0,s75,74752
s_nop 0
buffer_load_dwordx4 v9,s[32:35],s64 offen nt lds
s_add_u32 s64,s74,2424832
s_add_u32 m0,s75,75776
s_nop 0
buffer_load_dwordx4 v10,s[32:35],s64 offen nt lds
s_add_u32 s64,s74,2457600
s_add_u32 m0,s75,76800
s_nop 0
buffer_load_dwordx4 v11,s[32:35],s64 offen nt lds
s_add_u32 s64,s74,2490368
s_add_u32 m0,s75,77824
s_nop 0
buffer_load_dwordx4 v8,s[32:35],s64 offen nt lds
s_add_u32 s64,s74,2523136
s_add_u32 m0,s75,78848
s_nop 0
buffer_load_dwordx4 v9,s[32:35],s64 offen nt lds
s_add_u32 s64,s74,2555904
s_add_u32 m0,s75,79872
s_nop 0
buffer_load_dwordx4 v10,s[32:35],s64 offen nt lds
s_add_u32 s64,s74,2588672
s_add_u32 m0,s75,80896
s_nop 0
buffer_load_dwordx4 v11,s[32:35],s64 offen nt lds
s_waitcnt vmcnt(16)
s_barrier
ds_read_b64_tr_b16 a[0:1],v12 offset:0
ds_read_b64_tr_b16 a[2:3],v12 offset:512
ds_read_b64_tr_b16 a[128:129],v12 offset:8
ds_read_b64_tr_b16 a[130:131],v12 offset:520
ds_read_b64_tr_b16 a[4:5],v12 offset:8192
ds_read_b64_tr_b16 a[6:7],v12 offset:8704
ds_read_b64_tr_b16 a[132:133],v12 offset:8200
ds_read_b64_tr_b16 a[134:135],v12 offset:8712
s_waitcnt lgkmcnt(4)
ds_read_b64_tr_b16 a[8:9],v12 offset:16384
ds_read_b64_tr_b16 a[10:11],v12 offset:16896
ds_read_b64_tr_b16 a[136:137],v12 offset:16392
ds_read_b64_tr_b16 a[138:139],v12 offset:16904
ds_read_b64_tr_b16 a[12:13],v12 offset:24576
ds_read_b64_tr_b16 a[14:15],v12 offset:25088
ds_read_b64_tr_b16 a[140:141],v12 offset:24584
ds_read_b64_tr_b16 a[142:143],v12 offset:25096
s_waitcnt lgkmcnt(4)
ds_read_b64_tr_b16 a[16:17],v12 offset:32768
ds_read_b64_tr_b16 a[18:19],v12 offset:33280
ds_read_b64_tr_b16 a[144:145],v12 offset:32776
ds_read_b64_tr_b16 a[146:147],v12 offset:33288
ds_read_b64_tr_b16 a[20:21],v12 offset:40960
ds_read_b64_tr_b16 a[22:23],v12 offset:41472
ds_read_b64_tr_b16 a[148:149],v12 offset:40968
ds_read_b64_tr_b16 a[150:151],v12 offset:41480
s_waitcnt lgkmcnt(4)
ds_read_b64_tr_b16 a[24:25],v12 offset:49152
ds_read_b64_tr_b16 a[26:27],v12 offset:49664
ds_read_b64_tr_b16 a[152:153],v12 offset:49160
ds_read_b64_tr_b16 a[154:155],v12 offset:49672
ds_read_b64_tr_b16 a[28:29],v12 offset:57344
ds_read_b64_tr_b16 a[30:31],v12 offset:57856
ds_read_b64_tr_b16 a[156:157],v12 offset:57352
ds_read_b64_tr_b16 a[158:159],v12 offset:57864
s_waitcnt lgkmcnt(4)
v_xor_b32 v12,0x10000,v12
s_waitcnt lgkmcnt(0)
s_barrier
s_add_u32 s64,s74,4194304
s_add_u32 m0,s75,0
s_nop 0
buffer_load_dwordx4 v8,s[32:35],s64 offen nt lds
s_add_u32 s64,s74,4227072
s_add_u32 m0,s75,1024
s_nop 0
buffer_load_dwordx4 v9,s[32:35],s64 offen nt lds
s_add_u32 s64,s74,4259840
s_add_u32 m0,s75,2048
s_nop 0
buffer_load_dwordx4 v10,s[32:35],s64 offen nt lds
s_add_u32 s64,s74,4292608
s_add_u32 m0,s75,3072
s_nop 0
buffer_load_dwordx4 v11,s[32:35],s64 offen nt lds
s_add_u32 s64,s74,4325376
s_add_u32 m0,s75,4096
s_nop 0
buffer_load_dwordx4 v8,s[32:35],s64 offen nt lds
s_add_u32 s64,s74,4358144
s_add_u32 m0,s75,5120
s_nop 0
buffer_load_dwordx4 v9,s[32:35],s64 offen nt lds
s_add_u32 s64,s74,4390912
s_add_u32 m0,s75,6144
s_nop 0
buffer_load_dwordx4 v10,s[32:35],s64 offen nt lds
s_add_u32 s64,s74,4423680
s_add_u32 m0,s75,7168
s_nop 0
buffer_load_dwordx4 v11,s[32:35],s64 offen nt lds
s_add_u32 s64,s74,4456448
s_add_u32 m0,s75,8192
s_nop 0
buffer_load_dwordx4 v8,s[32:35],s64 offen nt lds
s_add_u32 s64,s74,4489216
s_add_u32 m0,s75,9216
s_nop 0
buffer_load_dwordx4 v9,s[32:35],s64 offen nt lds
s_add_u32 s64,s74,4521984
s_add_u32 m0,s75,10240
s_nop 0
buffer_load_dwordx4 v10,s[32:35],s64 offen nt lds
s_add_u32 s64,s74,4554752
s_add_u32 m0,s75,11264
s_nop 0
buffer_load_dwordx4 v11,s[32:35],s64 offen nt lds
s_add_u32 s64,s74,4587520
s_add_u32 m0,s75,12288
s_nop 0
buffer_load_dwordx4 v8,s[32:35],s64 offen nt lds
s_add_u32 s64,s74,4620288
s_add_u32 m0,s75,13312
s_nop 0
buffer_load_dwordx4 v9,s[32:35],s64 offen nt lds
s_add_u32 s64,s74,4653056
s_add_u32 m0,s75,14336
s_nop 0
buffer_load_dwordx4 v10,s[32:35],s64 offen nt lds
s_add_u32 s64,s74,4685824
s_add_u32 m0,s75,15360
s_nop 0
buffer_load_dwordx4 v11,s[32:35],s64 offen nt lds
s_waitcnt vmcnt(16)
s_barrier
ds_read_b64_tr_b16 a[32:33],v12 offset:0
ds_read_b64_tr_b16 a[34:35],v12 offset:512
ds_read_b64_tr_b16 a[160:161],v12 offset:8
ds_read_b64_tr_b16 a[162:163],v12 offset:520
ds_read_b64_tr_b16 a[36:37],v12 offset:8192
ds_read_b64_tr_b16 a[38:39],v12 offset:8704
ds_read_b64_tr_b16 a[164:165],v12 offset:8200
ds_read_b64_tr_b16 a[166:167],v12 offset:8712
s_waitcnt lgkmcnt(4)
ds_read_b64_tr_b16 a[40:41],v12 offset:16384
ds_read_b64_tr_b16 a[42:43],v12 offset:16896
ds_read_b64_tr_b16 a[168:169],v12 offset:16392
ds_read_b64_tr_b16 a[170:171],v12 offset:16904
ds_read_b64_tr_b16 a[44:45],v12 offset:24576
ds_read_b64_tr_b16 a[46:47],v12 offset:25088
ds_read_b64_tr_b16 a[172:173],v12 offset:24584
ds_read_b64_tr_b16 a[174:175],v12 offset:25096
s_waitcnt lgkmcnt(4)
ds_read_b64_tr_b16 a[48:49],v12 offset:32768
ds_read_b64_tr_b16 a[50:51],v12 offset:33280
ds_read_b64_tr_b16 a[176:177],v12 offset:32776
ds_read_b64_tr_b16 a[178:179],v12 offset:33288
ds_read_b64_tr_b16 a[52:53],v12 offset:40960
ds_read_b64_tr_b16 a[54:55],v12 offset:41472
ds_read_b64_tr_b16 a[180:181],v12 offset:40968
ds_read_b64_tr_b16 a[182:183],v12 offset:41480
s_waitcnt lgkmcnt(4)
ds_read_b64_tr_b16 a[56:57],v12 offset:49152
ds_read_b64_tr_b16 a[58:59],v12 offset:49664
ds_read_b64_tr_b16 a[184:185],v12 offset:49160
ds_read_b64_tr_b16 a[186:187],v12 offset:49672
ds_read_b64_tr_b16 a[60:61],v12 offset:57344
ds_read_b64_tr_b16 a[62:63],v12 offset:57856
ds_read_b64_tr_b16 a[188:189],v12 offset:57352
ds_read_b64_tr_b16 a[190:191],v12 offset:57864
s_waitcnt lgkmcnt(4)
v_xor_b32 v12,0x10000,v12
s_waitcnt lgkmcnt(0)
s_barrier
s_add_u32 s64,s74,6291456
s_add_u32 m0,s75,65536
s_nop 0
buffer_load_dwordx4 v8,s[32:35],s64 offen nt lds
s_add_u32 s64,s74,6324224
s_add_u32 m0,s75,66560
s_nop 0
buffer_load_dwordx4 v9,s[32:35],s64 offen nt lds
s_add_u32 s64,s74,6356992
s_add_u32 m0,s75,67584
s_nop 0
buffer_load_dwordx4 v10,s[32:35],s64 offen nt lds
s_add_u32 s64,s74,6389760
s_add_u32 m0,s75,68608
s_nop 0
buffer_load_dwordx4 v11,s[32:35],s64 offen nt lds
s_add_u32 s64,s74,6422528
s_add_u32 m0,s75,69632
s_nop 0
buffer_load_dwordx4 v8,s[32:35],s64 offen nt lds
s_add_u32 s64,s74,6455296
s_add_u32 m0,s75,70656
s_nop 0
buffer_load_dwordx4 v9,s[32:35],s64 offen nt lds
s_add_u32 s64,s74,6488064
s_add_u32 m0,s75,71680
s_nop 0
buffer_load_dwordx4 v10,s[32:35],s64 offen nt lds
s_add_u32 s64,s74,6520832
s_add_u32 m0,s75,72704
s_nop 0
buffer_load_dwordx4 v11,s[32:35],s64 offen nt lds
s_add_u32 s64,s74,6553600
s_add_u32 m0,s75,73728
s_nop 0
buffer_load_dwordx4 v8,s[32:35],s64 offen nt lds
s_add_u32 s64,s74,6586368
s_add_u32 m0,s75,74752
s_nop 0
buffer_load_dwordx4 v9,s[32:35],s64 offen nt lds
s_add_u32 s64,s74,6619136
s_add_u32 m0,s75,75776
s_nop 0
buffer_load_dwordx4 v10,s[32:35],s64 offen nt lds
s_add_u32 s64,s74,6651904
s_add_u32 m0,s75,76800
s_nop 0
buffer_load_dwordx4 v11,s[32:35],s64 offen nt lds
s_add_u32 s64,s74,6684672
s_add_u32 m0,s75,77824
s_nop 0
buffer_load_dwordx4 v8,s[32:35],s64 offen nt lds
s_add_u32 s64,s74,6717440
s_add_u32 m0,s75,78848
s_nop 0
buffer_load_dwordx4 v9,s[32:35],s64 offen nt lds
s_add_u32 s64,s74,6750208
s_add_u32 m0,s75,79872
s_nop 0
buffer_load_dwordx4 v10,s[32:35],s64 offen nt lds
s_add_u32 s64,s74,6782976
s_add_u32 m0,s75,80896
s_nop 0
buffer_load_dwordx4 v11,s[32:35],s64 offen nt lds
s_waitcnt vmcnt(16)
s_barrier
ds_read_b64_tr_b16 a[64:65],v12 offset:0
ds_read_b64_tr_b16 a[66:67],v12 offset:512
ds_read_b64_tr_b16 a[192:193],v12 offset:8
ds_read_b64_tr_b16 a[194:195],v12 offset:520
ds_read_b64_tr_b16 a[68:69],v12 offset:8192
ds_read_b64_tr_b16 a[70:71],v12 offset:8704
ds_read_b64_tr_b16 a[196:197],v12 offset:8200
ds_read_b64_tr_b16 a[198:199],v12 offset:8712
s_waitcnt lgkmcnt(4)
ds_read_b64_tr_b16 a[72:73],v12 offset:16384
ds_read_b64_tr_b16 a[74:75],v12 offset:16896
ds_read_b64_tr_b16 a[200:201],v12 offset:16392
ds_read_b64_tr_b16 a[202:203],v12 offset:16904
ds_read_b64_tr_b16 a[76:77],v12 offset:24576
ds_read_b64_tr_b16 a[78:79],v12 offset:25088
ds_read_b64_tr_b16 a[204:205],v12 offset:24584
ds_read_b64_tr_b16 a[206:207],v12 offset:25096
s_waitcnt lgkmcnt(4)
ds_read_b64_tr_b16 a[80:81],v12 offset:32768
ds_read_b64_tr_b16 a[82:83],v12 offset:33280
ds_read_b64_tr_b16 a[208:209],v12 offset:32776
ds_read_b64_tr_b16 a[210:211],v12 offset:33288
ds_read_b64_tr_b16 a[84:85],v12 offset:40960
ds_read_b64_tr_b16 a[86:87],v12 offset:41472
ds_read_b64_tr_b16 a[212:213],v12 offset:40968
ds_read_b64_tr_b16 a[214:215],v12 offset:41480
s_waitcnt lgkmcnt(4)
ds_read_b64_tr_b16 a[88:89],v12 offset:49152
ds_read_b64_tr_b16 a[90:91],v12 offset:49664
ds_read_b64_tr_b16 a[216:217],v12 offset:49160
ds_read_b64_tr_b16 a[218:219],v12 offset:49672
ds_read_b64_tr_b16 a[92:93],v12 offset:57344
ds_read_b64_tr_b16 a[94:95],v12 offset:57856
ds_read_b64_tr_b16 a[220:221],v12 offset:57352
ds_read_b64_tr_b16 a[222:223],v12 offset:57864
s_waitcnt lgkmcnt(4)
v_xor_b32 v12,0x10000,v12
s_waitcnt lgkmcnt(0)
s_barrier
s_waitcnt vmcnt(0)
s_barrier
ds_read_b64_tr_b16 a[96:97],v12 offset:0
ds_read_b64_tr_b16 a[98:99],v12 offset:512
ds_read_b64_tr_b16 a[224:225],v12 offset:8
ds_read_b64_tr_b16 a[226:227],v12 offset:520
ds_read_b64_tr_b16 a[100:101],v12 offset:8192
ds_read_b64_tr_b16 a[102:103],v12 offset:8704
ds_read_b64_tr_b16 a[228:229],v12 offset:8200
ds_read_b64_tr_b16 a[230:231],v12 offset:8712
s_waitcnt lgkmcnt(4)
ds_read_b64_tr_b16 a[104:105],v12 offset:16384
ds_read_b64_tr_b16 a[106:107],v12 offset:16896
ds_read_b64_tr_b16 a[232:233],v12 offset:16392
ds_read_b64_tr_b16 a[234:235],v12 offset:16904
ds_read_b64_tr_b16 a[108:109],v12 offset:24576
ds_read_b64_tr_b16 a[110:111],v12 offset:25088
ds_read_b64_tr_b16 a[236:237],v12 offset:24584
ds_read_b64_tr_b16 a[238:239],v12 offset:25096
s_waitcnt lgkmcnt(4)
ds_read_b64_tr_b16 a[112:113],v12 offset:32768
ds_read_b64_tr_b16 a[114:115],v12 offset:33280
ds_read_b64_tr_b16 a[240:241],v12 offset:32776
ds_read_b64_tr_b16 a[242:243],v12 offset:33288
ds_read_b64_tr_b16 a[116:117],v12 offset:40960
ds_read_b64_tr_b16 a[118:119],v12 offset:41472
ds_read_b64_tr_b16 a[244:245],v12 offset:40968
ds_read_b64_tr_b16 a[246:247],v12 offset:41480
s_waitcnt lgkmcnt(4)
ds_read_b64_tr_b16 a[120:121],v12 offset:49152
ds_read_b64_tr_b16 a[122:123],v12 offset:49664
ds_read_b64_tr_b16 a[248:249],v12 offset:49160
ds_read_b64_tr_b16 a[250:251],v12 offset:49672
ds_read_b64_tr_b16 a[124:125],v12 offset:57344
ds_read_b64_tr_b16 a[126:127],v12 offset:57856
ds_read_b64_tr_b16 a[252:253],v12 offset:57352
ds_read_b64_tr_b16 a[254:255],v12 offset:57864
s_waitcnt lgkmcnt(4)
v_xor_b32 v12,0x10000,v12
s_waitcnt lgkmcnt(0)
s_barrier
v_and_b32 v21,7,v1
v_lshlrev_b32 v21,6,v21
s_mov_b32 s65,21052416
s_mov_b32 s66,1792
pl_200:
buffer_load_dword v22,v21,s[20:23],s65 offen sc1
s_waitcnt vmcnt(0)
v_cmp_gt_u32 vcc,s66,v22
s_cbranch_vccz pok_201
s_sleep 1
s_sub_u32 s90,s90,1
s_cmp_gt_i32 s90,0
s_cbranch_scc1 pl_200
pok_201:
s_lshl_b32 s72,s50,14
s_lshl_b32 s74,s58,16
s_add_u32 s74,s74,s72
s_add_u32 s74,s74,57344
v_mov_b32 v17,v16
s_lshl_b32 s64,s59,14
s_lshl_b32 s65,s50,11
s_add_u32 s64,s64,s65
v_add_u32 v18,s64,v16
s_lshl_b32 s73,s58,5
s_add_u32 s73,s73,s59
s_lshl_b32 s73,s73,2
s_add_u32 s73,s73,s63
v_lshlrev_b32 v24,4,v0
s_mov_b32 s79,s58
s_add_u32 m0,s72,0
s_add_u32 s65,s74,0
buffer_load_dwordx4 v16,s[20:23],s65 offen offset:0  lds
buffer_load_dwordx4 v16,s[20:23],s65 offen offset:1024  lds
buffer_load_dwordx4 v16,s[20:23],s65 offen offset:2048  lds
buffer_load_dwordx4 v16,s[20:23],s65 offen offset:3072  lds
s_add_u32 m0,s72,4096
s_add_u32 s65,s74,4096
buffer_load_dwordx4 v16,s[20:23],s65 offen offset:0  lds
buffer_load_dwordx4 v16,s[20:23],s65 offen offset:1024  lds
buffer_load_dwordx4 v16,s[20:23],s65 offen offset:2048  lds
buffer_load_dwordx4 v16,s[20:23],s65 offen offset:3072  lds
s_add_u32 m0,s72,8192
s_add_u32 s65,s74,8192
buffer_load_dwordx4 v16,s[20:23],s65 offen offset:0  lds
buffer_load_dwordx4 v16,s[20:23],s65 offen offset:1024  lds
buffer_load_dwordx4 v16,s[20:23],s65 offen offset:2048  lds
buffer_load_dwordx4 v16,s[20:23],s65 offen offset:3072  lds
s_add_u32 m0,s72,12288
s_add_u32 s65,s74,12288
buffer_load_dwordx4 v16,s[20:23],s65 offen offset:0  lds
buffer_load_dwordx4 v16,s[20:23],s65 offen offset:1024  lds
buffer_load_dwordx4 v16,s[20:23],s65 offen offset:2048  lds
buffer_load_dwordx4 v16,s[20:23],s65 offen offset:3072  lds
s_waitcnt vmcnt(0)
s_add_u32 s41,s58,55
s_sub_u32 s64,s58,1
s_cmp_lt_u32 s64,2
s_cselect_b32 s41,s41,64
s_lshl_b32 s76,s50,14
s_add_u32 s76,s76,57344
s_add_u32 s42,s55,32
s_lshl_b32 s42,s42,14
s_add_u32 s42,s42,113246208
s_xor_b32 s64,s62,0
s_add_u32 s42,s42,s64
s_sub_u32 s64,s42,2097152
s_xor_b32 s64,s64,0x2000
s_cmp_lt_u32 s55,104
s_cselect_b32 s64,s64,0x7fff0000
s_cmp_lt_u32 s55,96
s_cselect_b32 s42,s42,s64
s_cmp_lt_u32 s55,32
s_cselect_b32 s64,29360128,0
s_add_u32 s42,s42,s64
v_add_u32 v25,4096,v24
s_load_dwordx2 s[4:5],s[0:1],96
s_load_dwordx2 s[6:7],s[0:1],104
v_and_b32 v5,3,v0
v_lshrrev_b32 v6,2,v0
v_mul_u32_u24 v112,12288,v6
v_lshl_add_u32 v112,v5,4,v112
v_lshlrev_b32 v113,1,v6
s_add_u32 s43,s55,64
s_lshl_b32 s43,s43,6
s_mov_b32 s48,0
s_mov_b32 s80,0xffff0000
s_mov_b32 s81,0xbfb8aa3b
s_waitcnt lgkmcnt(0)
s_mov_b32 s12,s4
s_and_b32 s13,s5,0xffff
s_mov_b32 s14,0x800
s_mov_b32 s15,0x20000
s_mov_b32 s16,s6
s_and_b32 s17,s7,0xffff
s_mov_b32 s18,0xc00000
s_mov_b32 s19,0x20000
buffer_load_dwordx4 v[104:107],v112,s[16:19],s43 offen nt
buffer_load_ushort v108,v113,s[12:15],s48 offen
s_add_u32 s43,s43,786432
s_add_u32 s48,s48,128
buffer_load_dwordx4 v[116:119],v112,s[16:19],s43 offen nt
buffer_load_ushort v120,v113,s[12:15],s48 offen
s_add_u32 s43,s43,786432
s_add_u32 s48,s48,128
v_mov_b32 v96,0
v_mov_b32 v97,0
v_mov_b32 v98,0
v_mov_b32 v99,0
v_mov_b32 v100,0
v_mov_b32 v101,0
v_mov_b32 v102,0
v_mov_b32 v103,0
s_waitcnt vmcnt(0)
qloop_202:
s_lshr_b32 s64,s79,2
s_cmp_lg_u32 s64,4
s_cbranch_scc1 np2_204
s_waitcnt vmcnt(0)
s_barrier
s_cmp_lg_u32 s50,0
s_cbranch_scc1 ow_205
s_mov_b64 exec,1
v_mov_b32 v22,14
v_mov_b32 v23,0
s_mov_b32 s64,21052928
buffer_atomic_add v22,v23,s[20:23],s64 offen sc1
s_mov_b64 exec,-1
ow_205:
np2_204:
s_cmp_lg_u32 s79,s41
s_cbranch_scc1 npz_203
s_waitcnt vmcnt(0)
s_barrier
s_cmp_lg_u32 s50,0
s_cbranch_scc1 ow_206
s_mov_b64 exec,1
v_mov_b32 v22,14
v_mov_b32 v23,0
s_mov_b32 s64,21052992
buffer_atomic_add v22,v23,s[20:23],s64 offen sc1
s_mov_b64 exec,-1
ow_206:
s_cmp_lg_u32 s50,0
s_cbranch_scc1 ow_207
s_mov_b64 exec,1
v_mov_b32 v22,14
v_mov_b32 v23,0
buffer_store_dword v22,v23,s[20:23],s73 offen sc1
s_mov_b64 exec,-1
ow_207:
npz_203:
s_waitcnt vmcnt(10)
s_barrier
ds_read_b128 v[224:227],v17 offset:0
ds_read_b128 v[228:231],v17 offset:2048
ds_read_b128 v[232:235],v17 offset:4096
ds_read_b128 v[236:239],v17 offset:6144
ds_read_b128 v[240:243],v17 offset:8192
ds_read_b128 v[244:247],v17 offset:10240
ds_read_b128 v[248:251],v17 offset:12288
s_waitcnt lgkmcnt(5)
v_mfma_f32_16x16x32_bf16 v[64:67],a[0:3],v[224:227],0
s_xor_b32 s72,s72,0x10000
s_add_u32 s77,s79,2
v_mfma_f32_16x16x32_bf16 v[72:75],a[128:131],v[224:227],0
ds_read_b128 v[252:255],v17 offset:14336
s_cmp_lt_u32 s79,56
s_cselect_b32 s77,s41,s77
v_mfma_f32_16x16x32_bf16 v[64:67],a[4:7],v[228:231],v[64:67]
s_add_u32 s74,s79,4
s_cmp_lt_u32 s79,52
s_cselect_b32 s77,s74,s77
v_mfma_f32_16x16x32_bf16 v[72:75],a[132:135],v[228:231],v[72:75]
ds_read_b128 v[224:227],v17 offset:16384
v_lshlrev_b32 v108,16,v108
s_waitcnt lgkmcnt(5)
v_mfma_f32_16x16x32_bf16 v[64:67],a[8:11],v[232:235],v[64:67]
s_lshl_b32 s74,s77,16
s_add_u32 s74,s74,s76
v_mul_f32 v109,s81,v108
v_mfma_f32_16x16x32_bf16 v[72:75],a[136:139],v[232:235],v[72:75]
ds_read_b128 v[228:231],v17 offset:18432
s_add_u32 s64,s79,0
v_mfma_f32_16x16x32_bf16 v[64:67],a[12:15],v[236:239],v[64:67]
s_cmp_lt_u32 s77,64
s_cselect_b32 s74,s74,0x7fff0000
v_mfma_f32_16x16x32_bf16 v[72:75],a[140:143],v[236:239],v[72:75]
ds_read_b128 v[232:235],v17 offset:20480
s_waitcnt lgkmcnt(5)
v_mfma_f32_16x16x32_bf16 v[64:67],a[16:19],v[240:243],v[64:67]
s_add_u32 m0,s72,0
v_exp_f32 v109,v109
v_mfma_f32_16x16x32_bf16 v[72:75],a[144:147],v[240:243],v[72:75]
ds_read_b128 v[236:239],v17 offset:22528
v_add_f32 v109,1.0,v109
v_mfma_f32_16x16x32_bf16 v[64:67],a[20:23],v[244:247],v[64:67]
s_add_u32 s65,s74,0
s_lshl_b32 s70,s64,21
v_mfma_f32_16x16x32_bf16 v[72:75],a[148:151],v[244:247],v[72:75]
ds_read_b128 v[240:243],v17 offset:24576
s_waitcnt lgkmcnt(5)
v_mfma_f32_16x16x32_bf16 v[64:67],a[24:27],v[248:251],v[64:67]
v_rcp_f32 v109,v109
v_mfma_f32_16x16x32_bf16 v[72:75],a[152:155],v[248:251],v[72:75]
ds_read_b128 v[244:247],v17 offset:26624
v_mul_f32 v109,v109,v108
v_mfma_f32_16x16x32_bf16 v[64:67],a[28:31],v[252:255],v[64:67]
buffer_load_dwordx4 v16,s[20:23],s65 offen offset:0  lds
v_mfma_f32_16x16x32_bf16 v[72:75],a[156:159],v[252:255],v[72:75]
ds_read_b128 v[248:251],v17 offset:28672
s_waitcnt lgkmcnt(5)
v_mfma_f32_16x16x32_bf16 v[64:67],a[32:35],v[224:227],v[64:67]
buffer_load_dwordx4 v16,s[20:23],s65 offen offset:1024  lds
v_mfma_f32_16x16x32_bf16 v[72:75],a[160:163],v[224:227],v[72:75]
ds_read_b128 v[252:255],v17 offset:30720
s_lshl_b32 s64,s64,13
v_mfma_f32_16x16x32_bf16 v[64:67],a[36:39],v[228:231],v[64:67]
buffer_load_dwordx4 v16,s[20:23],s65 offen offset:2048  lds
v_mfma_f32_16x16x32_bf16 v[72:75],a[164:167],v[228:231],v[72:75]
ds_read_b128 v[224:227],v17 offset:32768
s_waitcnt lgkmcnt(5)
v_mfma_f32_16x16x32_bf16 v[64:67],a[40:43],v[232:235],v[64:67]
buffer_load_dwordx4 v16,s[20:23],s65 offen offset:3072  lds
v_mfma_f32_16x16x32_bf16 v[72:75],a[168:171],v[232:235],v[72:75]
ds_read_b128 v[228:231],v17 offset:34816
s_and_b32 s64,s64,0x2000
v_mfma_f32_16x16x32_bf16 v[64:67],a[44:47],v[236:239],v[64:67]
v_cvt_pk_bf16_f32 v109,v109,v109
v_and_b32 v108,s80,v109
v_mfma_f32_16x16x32_bf16 v[72:75],a[172:175],v[236:239],v[72:75]
ds_read_b128 v[232:235],v17 offset:36864
s_waitcnt lgkmcnt(5)
v_mfma_f32_16x16x32_bf16 v[64:67],a[48:51],v[240:243],v[64:67]
s_add_u32 m0,s72,4096
v_lshlrev_b32 v110,16,v104
v_mfma_f32_16x16x32_bf16 v[72:75],a[176:179],v[240:243],v[72:75]
ds_read_b128 v[236:239],v17 offset:38912
s_add_u32 s65,s74,4096
v_mfma_f32_16x16x32_bf16 v[64:67],a[52:55],v[244:247],v[64:67]
s_xor_b32 s64,s64,s62
v_and_b32 v111,s80,v104
v_mfma_f32_16x16x32_bf16 v[72:75],a[180:183],v[244:247],v[72:75]
ds_read_b128 v[240:243],v17 offset:40960
s_waitcnt lgkmcnt(5)
v_mfma_f32_16x16x32_bf16 v[64:67],a[56:59],v[248:251],v[64:67]
buffer_load_dwordx4 v16,s[20:23],s65 offen offset:0  lds
v_mfma_f32_16x16x32_bf16 v[72:75],a[184:187],v[248:251],v[72:75]
ds_read_b128 v[244:247],v17 offset:43008
v_fmac_f32 v96,v110,v108
v_mfma_f32_16x16x32_bf16 v[64:67],a[60:63],v[252:255],v[64:67]
buffer_load_dwordx4 v16,s[20:23],s65 offen offset:1024  lds
v_mfma_f32_16x16x32_bf16 v[72:75],a[188:191],v[252:255],v[72:75]
ds_read_b128 v[248:251],v17 offset:45056
s_waitcnt lgkmcnt(5)
v_mfma_f32_16x16x32_bf16 v[64:67],a[64:67],v[224:227],v[64:67]
s_add_u32 s70,s70,s64
v_fmac_f32 v97,v111,v108
v_mfma_f32_16x16x32_bf16 v[72:75],a[192:195],v[224:227],v[72:75]
ds_read_b128 v[252:255],v17 offset:47104
v_lshlrev_b32 v110,16,v105
v_mfma_f32_16x16x32_bf16 v[64:67],a[68:71],v[228:231],v[64:67]
buffer_load_dwordx4 v16,s[20:23],s65 offen offset:2048  lds
v_mfma_f32_16x16x32_bf16 v[72:75],a[196:199],v[228:231],v[72:75]
ds_read_b128 v[224:227],v17 offset:49152
s_waitcnt lgkmcnt(5)
v_mfma_f32_16x16x32_bf16 v[64:67],a[72:75],v[232:235],v[64:67]
buffer_load_dwordx4 v16,s[20:23],s65 offen offset:3072  lds
v_mfma_f32_16x16x32_bf16 v[72:75],a[200:203],v[232:235],v[72:75]
ds_read_b128 v[228:231],v17 offset:51200
s_add_u32 s70,s70,29360128
v_mfma_f32_16x16x32_bf16 v[64:67],a[76:79],v[236:239],v[64:67]
s_add_u32 m0,s72,8192
v_and_b32 v111,s80,v105
v_mfma_f32_16x16x32_bf16 v[72:75],a[204:207],v[236:239],v[72:75]
ds_read_b128 v[232:235],v17 offset:53248
s_waitcnt lgkmcnt(5)
v_mfma_f32_16x16x32_bf16 v[64:67],a[80:83],v[240:243],v[64:67]
s_add_u32 s65,s74,8192
v_fmac_f32 v98,v110,v108
v_mfma_f32_16x16x32_bf16 v[72:75],a[208:211],v[240:243],v[72:75]
ds_read_b128 v[236:239],v17 offset:55296
v_fmac_f32 v99,v111,v108
v_mfma_f32_16x16x32_bf16 v[64:67],a[84:87],v[244:247],v[64:67]
v_lshlrev_b32 v110,16,v106
v_and_b32 v111,s80,v106
v_mfma_f32_16x16x32_bf16 v[72:75],a[212:215],v[244:247],v[72:75]
ds_read_b128 v[240:243],v17 offset:57344
s_waitcnt lgkmcnt(5)
v_mfma_f32_16x16x32_bf16 v[64:67],a[88:91],v[248:251],v[64:67]
buffer_load_dwordx4 v16,s[20:23],s65 offen offset:0  lds
v_mfma_f32_16x16x32_bf16 v[72:75],a[216:219],v[248:251],v[72:75]
ds_read_b128 v[244:247],v17 offset:59392
v_fmac_f32 v100,v110,v108
v_mfma_f32_16x16x32_bf16 v[64:67],a[92:95],v[252:255],v[64:67]
buffer_load_dwordx4 v16,s[20:23],s65 offen offset:1024  lds
v_mfma_f32_16x16x32_bf16 v[72:75],a[220:223],v[252:255],v[72:75]
ds_read_b128 v[248:251],v17 offset:61440
s_waitcnt lgkmcnt(5)
v_mfma_f32_16x16x32_bf16 v[64:67],a[96:99],v[224:227],v[64:67]
buffer_load_dwordx4 v16,s[20:23],s65 offen offset:2048  lds
v_mfma_f32_16x16x32_bf16 v[72:75],a[224:227],v[224:227],v[72:75]
ds_read_b128 v[252:255],v17 offset:63488
v_fmac_f32 v101,v111,v108
v_mfma_f32_16x16x32_bf16 v[64:67],a[100:103],v[228:231],v[64:67]
buffer_load_dwordx4 v16,s[20:23],s65 offen offset:3072  lds
v_mfma_f32_16x16x32_bf16 v[72:75],a[228:231],v[228:231],v[72:75]
ds_read_b128 v[224:227],v17 offset:1024
s_waitcnt lgkmcnt(5)
v_mfma_f32_16x16x32_bf16 v[64:67],a[104:107],v[232:235],v[64:67]
v_lshlrev_b32 v110,16,v107
v_and_b32 v111,s80,v107
v_mfma_f32_16x16x32_bf16 v[72:75],a[232:235],v[232:235],v[72:75]
ds_read_b128 v[228:231],v17 offset:3072
s_add_u32 m0,s72,12288
v_mfma_f32_16x16x32_bf16 v[64:67],a[108:111],v[236:239],v[64:67]
v_fmac_f32 v102,v110,v108
v_fmac_f32 v103,v111,v108
v_mfma_f32_16x16x32_bf16 v[72:75],a[236:239],v[236:239],v[72:75]
ds_read_b128 v[232:235],v17 offset:5120
s_waitcnt lgkmcnt(5)
v_mfma_f32_16x16x32_bf16 v[64:67],a[112:115],v[240:243],v[64:67]
s_add_u32 s65,s74,12288
v_mfma_f32_16x16x32_bf16 v[72:75],a[240:243],v[240:243],v[72:75]
ds_read_b128 v[236:239],v17 offset:7168
v_mfma_f32_16x16x32_bf16 v[64:67],a[116:119],v[244:247],v[64:67]
buffer_load_dwordx4 v16,s[20:23],s65 offen offset:0  lds
v_mfma_f32_16x16x32_bf16 v[72:75],a[244:247],v[244:247],v[72:75]
ds_read_b128 v[240:243],v17 offset:9216
s_waitcnt lgkmcnt(5)
v_mfma_f32_16x16x32_bf16 v[64:67],a[120:123],v[248:251],v[64:67]
buffer_load_dwordx4 v16,s[20:23],s65 offen offset:1024  lds
v_mfma_f32_16x16x32_bf16 v[72:75],a[248:251],v[248:251],v[72:75]
ds_read_b128 v[244:247],v17 offset:11264
v_mfma_f32_16x16x32_bf16 v[64:67],a[124:127],v[252:255],v[64:67]
v_mfma_f32_16x16x32_bf16 v[72:75],a[252:255],v[252:255],v[72:75]
ds_read_b128 v[248:251],v17 offset:13312
s_waitcnt lgkmcnt(5)
v_mfma_f32_16x16x32_bf16 v[68:71],a[0:3],v[224:227],0
buffer_load_dwordx4 v16,s[20:23],s65 offen offset:2048  lds
v_mfma_f32_16x16x32_bf16 v[76:79],a[128:131],v[224:227],0
ds_read_b128 v[252:255],v17 offset:15360
v_mfma_f32_16x16x32_bf16 v[68:71],a[4:7],v[228:231],v[68:71]
buffer_load_dwordx4 v16,s[20:23],s65 offen offset:3072  lds
v_mfma_f32_16x16x32_bf16 v[76:79],a[132:135],v[228:231],v[76:79]
ds_read_b128 v[224:227],v17 offset:17408
s_waitcnt lgkmcnt(5)
v_mfma_f32_16x16x32_bf16 v[68:71],a[8:11],v[232:235],v[68:71]
v_cvt_pk_bf16_f32 v88,v64,v65
v_cvt_pk_bf16_f32 v89,v66,v67
v_cvt_pk_bf16_f32 v90,v72,v73
v_cvt_pk_bf16_f32 v91,v74,v75
v_mfma_f32_16x16x32_bf16 v[76:79],a[136:139],v[232:235],v[76:79]
ds_read_b128 v[228:231],v17 offset:19456
v_mfma_f32_16x16x32_bf16 v[68:71],a[12:15],v[236:239],v[68:71]
v_mfma_f32_16x16x32_bf16 v[76:79],a[140:143],v[236:239],v[76:79]
ds_read_b128 v[232:235],v17 offset:21504
s_waitcnt lgkmcnt(5)
v_mfma_f32_16x16x32_bf16 v[68:71],a[16:19],v[240:243],v[68:71]
buffer_store_dwordx4 v[88:91],v18,s[20:23],s70 offen offset:0 sc1
v_mfma_f32_16x16x32_bf16 v[76:79],a[144:147],v[240:243],v[76:79]
ds_read_b128 v[236:239],v17 offset:23552
v_mfma_f32_16x16x32_bf16 v[68:71],a[20:23],v[244:247],v[68:71]
buffer_load_dwordx4 v[104:107],v112,s[16:19],s43 offen nt
v_mfma_f32_16x16x32_bf16 v[76:79],a[148:151],v[244:247],v[76:79]
ds_read_b128 v[240:243],v17 offset:25600
s_waitcnt lgkmcnt(5)
v_mfma_f32_16x16x32_bf16 v[68:71],a[24:27],v[248:251],v[68:71]
buffer_load_ushort v108,v113,s[12:15],s48 offen
v_mfma_f32_16x16x32_bf16 v[76:79],a[152:155],v[248:251],v[76:79]
ds_read_b128 v[244:247],v17 offset:27648
v_mfma_f32_16x16x32_bf16 v[68:71],a[28:31],v[252:255],v[68:71]
v_mfma_f32_16x16x32_bf16 v[76:79],a[156:159],v[252:255],v[76:79]
ds_read_b128 v[248:251],v17 offset:29696
s_waitcnt lgkmcnt(5)
v_mfma_f32_16x16x32_bf16 v[68:71],a[32:35],v[224:227],v[68:71]
s_add_u32 s43,s43,786432
v_mfma_f32_16x16x32_bf16 v[76:79],a[160:163],v[224:227],v[76:79]
ds_read_b128 v[252:255],v17 offset:31744
v_mfma_f32_16x16x32_bf16 v[68:71],a[36:39],v[228:231],v[68:71]
s_add_u32 s48,s48,128
v_mfma_f32_16x16x32_bf16 v[76:79],a[164:167],v[228:231],v[76:79]
ds_read_b128 v[224:227],v17 offset:33792
s_waitcnt lgkmcnt(5)
v_mfma_f32_16x16x32_bf16 v[68:71],a[40:43],v[232:235],v[68:71]
v_mfma_f32_16x16x32_bf16 v[76:79],a[168:171],v[232:235],v[76:79]
ds_read_b128 v[228:231],v17 offset:35840
v_mfma_f32_16x16x32_bf16 v[68:71],a[44:47],v[236:239],v[68:71]
buffer_store_dwordx4 v[48:51],v24,s[20:23],s93 offen sc1
v_mfma_f32_16x16x32_bf16 v[76:79],a[172:175],v[236:239],v[76:79]
ds_read_b128 v[232:235],v17 offset:37888
s_waitcnt lgkmcnt(5)
v_mfma_f32_16x16x32_bf16 v[68:71],a[48:51],v[240:243],v[68:71]
buffer_store_dwordx4 v[48:51],v25,s[20:23],s93 offen sc1
v_mfma_f32_16x16x32_bf16 v[76:79],a[176:179],v[240:243],v[76:79]
ds_read_b128 v[236:239],v17 offset:39936
v_mfma_f32_16x16x32_bf16 v[68:71],a[52:55],v[244:247],v[68:71]
v_mfma_f32_16x16x32_bf16 v[76:79],a[180:183],v[244:247],v[76:79]
ds_read_b128 v[240:243],v17 offset:41984
s_waitcnt lgkmcnt(5)
v_mfma_f32_16x16x32_bf16 v[68:71],a[56:59],v[248:251],v[68:71]
s_add_u32 s93,s93,8388608
v_mfma_f32_16x16x32_bf16 v[76:79],a[184:187],v[248:251],v[76:79]
ds_read_b128 v[244:247],v17 offset:44032
v_mfma_f32_16x16x32_bf16 v[68:71],a[60:63],v[252:255],v[68:71]
s_cmp_lt_u32 s93,163577856
s_cselect_b32 s93,s93,0x7fff0000
v_mfma_f32_16x16x32_bf16 v[76:79],a[188:191],v[252:255],v[76:79]
ds_read_b128 v[248:251],v17 offset:46080
s_waitcnt lgkmcnt(5)
v_mfma_f32_16x16x32_bf16 v[68:71],a[64:67],v[224:227],v[68:71]
v_mfma_f32_16x16x32_bf16 v[76:79],a[192:195],v[224:227],v[76:79]
ds_read_b128 v[252:255],v17 offset:48128
v_mfma_f32_16x16x32_bf16 v[68:71],a[68:71],v[228:231],v[68:71]
buffer_store_dwordx4 v[48:51],v24,s[20:23],s42 offen sc1
v_mfma_f32_16x16x32_bf16 v[76:79],a[196:199],v[228:231],v[76:79]
ds_read_b128 v[224:227],v17 offset:50176
s_waitcnt lgkmcnt(5)
v_mfma_f32_16x16x32_bf16 v[68:71],a[72:75],v[232:235],v[68:71]
buffer_store_dwordx4 v[48:51],v25,s[20:23],s42 offen sc1
v_mfma_f32_16x16x32_bf16 v[76:79],a[200:203],v[232:235],v[76:79]
ds_read_b128 v[228:231],v17 offset:52224
v_mfma_f32_16x16x32_bf16 v[68:71],a[76:79],v[236:239],v[68:71]
s_add_u32 s42,s42,2097152
v_mfma_f32_16x16x32_bf16 v[76:79],a[204:207],v[236:239],v[76:79]
ds_read_b128 v[232:235],v17 offset:54272
s_waitcnt lgkmcnt(5)
v_mfma_f32_16x16x32_bf16 v[68:71],a[80:83],v[240:243],v[68:71]
v_mfma_f32_16x16x32_bf16 v[76:79],a[208:211],v[240:243],v[76:79]
ds_read_b128 v[236:239],v17 offset:56320
s_xor_b32 s42,s42,0x2000
v_mfma_f32_16x16x32_bf16 v[68:71],a[84:87],v[244:247],v[68:71]
v_mfma_f32_16x16x32_bf16 v[76:79],a[212:215],v[244:247],v[76:79]
ds_read_b128 v[240:243],v17 offset:58368
s_waitcnt lgkmcnt(5)
v_mfma_f32_16x16x32_bf16 v[68:71],a[88:91],v[248:251],v[68:71]
s_cmp_lt_u32 s42,165675008
s_cselect_b32 s42,s42,0x7fff0000
v_mfma_f32_16x16x32_bf16 v[76:79],a[216:219],v[248:251],v[76:79]
ds_read_b128 v[244:247],v17 offset:60416
v_mfma_f32_16x16x32_bf16 v[68:71],a[92:95],v[252:255],v[68:71]
v_mfma_f32_16x16x32_bf16 v[76:79],a[220:223],v[252:255],v[76:79]
ds_read_b128 v[248:251],v17 offset:62464
s_waitcnt lgkmcnt(5)
v_mfma_f32_16x16x32_bf16 v[68:71],a[96:99],v[224:227],v[68:71]
buffer_store_dwordx4 v[48:51],v24,s[20:23],s42 offen sc1
v_mfma_f32_16x16x32_bf16 v[76:79],a[224:227],v[224:227],v[76:79]
ds_read_b128 v[252:255],v17 offset:64512
v_mfma_f32_16x16x32_bf16 v[68:71],a[100:103],v[228:231],v[68:71]
buffer_store_dwordx4 v[48:51],v25,s[20:23],s42 offen sc1
v_mfma_f32_16x16x32_bf16 v[76:79],a[228:231],v[228:231],v[76:79]
s_waitcnt lgkmcnt(4)
v_mfma_f32_16x16x32_bf16 v[68:71],a[104:107],v[232:235],v[68:71]
v_mfma_f32_16x16x32_bf16 v[76:79],a[232:235],v[232:235],v[76:79]
s_add_u32 s42,s42,2097152
v_mfma_f32_16x16x32_bf16 v[68:71],a[108:111],v[236:239],v[68:71]
v_mfma_f32_16x16x32_bf16 v[76:79],a[236:239],v[236:239],v[76:79]
s_waitcnt lgkmcnt(2)
v_mfma_f32_16x16x32_bf16 v[68:71],a[112:115],v[240:243],v[68:71]
s_xor_b32 s42,s42,0x2000
v_mfma_f32_16x16x32_bf16 v[76:79],a[240:243],v[240:243],v[76:79]
v_mfma_f32_16x16x32_bf16 v[68:71],a[116:119],v[244:247],v[68:71]
v_mfma_f32_16x16x32_bf16 v[76:79],a[244:247],v[244:247],v[76:79]
s_waitcnt lgkmcnt(0)
v_mfma_f32_16x16x32_bf16 v[68:71],a[120:123],v[248:251],v[68:71]
s_cmp_lt_u32 s42,165675008
s_cselect_b32 s42,s42,0x7fff0000
v_mfma_f32_16x16x32_bf16 v[76:79],a[248:251],v[248:251],v[76:79]
v_mfma_f32_16x16x32_bf16 v[68:71],a[124:127],v[252:255],v[68:71]
v_mfma_f32_16x16x32_bf16 v[76:79],a[252:255],v[252:255],v[76:79]
v_xor_b32 v17,0x10000,v17
s_mov_b32 s79,s77
s_nop 4
v_cvt_pk_bf16_f32 v92,v68,v69
v_cvt_pk_bf16_f32 v93,v70,v71
v_cvt_pk_bf16_f32 v94,v76,v77
v_cvt_pk_bf16_f32 v95,v78,v79
buffer_store_dwordx4 v[92:95],v18,s[20:23],s70 offen offset:1024 sc1
s_waitcnt vmcnt(10)
s_barrier
ds_read_b128 v[224:227],v17 offset:0
ds_read_b128 v[228:231],v17 offset:2048
ds_read_b128 v[232:235],v17 offset:4096
ds_read_b128 v[236:239],v17 offset:6144
ds_read_b128 v[240:243],v17 offset:8192
ds_read_b128 v[244:247],v17 offset:10240
ds_read_b128 v[248:251],v17 offset:12288
s_waitcnt lgkmcnt(5)
v_mfma_f32_16x16x32_bf16 v[64:67],a[0:3],v[224:227],0
s_xor_b32 s72,s72,0x10000
s_add_u32 s77,s79,2
v_mfma_f32_16x16x32_bf16 v[72:75],a[128:131],v[224:227],0
ds_read_b128 v[252:255],v17 offset:14336
s_cmp_lt_u32 s79,56
s_cselect_b32 s77,s41,s77
v_mfma_f32_16x16x32_bf16 v[64:67],a[4:7],v[228:231],v[64:67]
s_add_u32 s74,s79,4
s_cmp_lt_u32 s79,52
s_cselect_b32 s77,s74,s77
v_mfma_f32_16x16x32_bf16 v[72:75],a[132:135],v[228:231],v[72:75]
ds_read_b128 v[224:227],v17 offset:16384
v_lshlrev_b32 v120,16,v120
s_waitcnt lgkmcnt(5)
v_mfma_f32_16x16x32_bf16 v[64:67],a[8:11],v[232:235],v[64:67]
s_lshl_b32 s74,s77,16
s_add_u32 s74,s74,s76
v_mul_f32 v109,s81,v120
v_mfma_f32_16x16x32_bf16 v[72:75],a[136:139],v[232:235],v[72:75]
ds_read_b128 v[228:231],v17 offset:18432
s_add_u32 s64,s79,0
v_mfma_f32_16x16x32_bf16 v[64:67],a[12:15],v[236:239],v[64:67]
s_cmp_lt_u32 s77,64
s_cselect_b32 s74,s74,0x7fff0000
v_mfma_f32_16x16x32_bf16 v[72:75],a[140:143],v[236:239],v[72:75]
ds_read_b128 v[232:235],v17 offset:20480
s_waitcnt lgkmcnt(5)
v_mfma_f32_16x16x32_bf16 v[64:67],a[16:19],v[240:243],v[64:67]
s_add_u32 m0,s72,0
v_exp_f32 v109,v109
v_mfma_f32_16x16x32_bf16 v[72:75],a[144:147],v[240:243],v[72:75]
ds_read_b128 v[236:239],v17 offset:22528
v_add_f32 v109,1.0,v109
v_mfma_f32_16x16x32_bf16 v[64:67],a[20:23],v[244:247],v[64:67]
s_add_u32 s65,s74,0
s_lshl_b32 s70,s64,21
v_mfma_f32_16x16x32_bf16 v[72:75],a[148:151],v[244:247],v[72:75]
ds_read_b128 v[240:243],v17 offset:24576
s_waitcnt lgkmcnt(5)
v_mfma_f32_16x16x32_bf16 v[64:67],a[24:27],v[248:251],v[64:67]
v_rcp_f32 v109,v109
v_mfma_f32_16x16x32_bf16 v[72:75],a[152:155],v[248:251],v[72:75]
ds_read_b128 v[244:247],v17 offset:26624
v_mul_f32 v109,v109,v120
v_mfma_f32_16x16x32_bf16 v[64:67],a[28:31],v[252:255],v[64:67]
buffer_load_dwordx4 v16,s[20:23],s65 offen offset:0  lds
v_mfma_f32_16x16x32_bf16 v[72:75],a[156:159],v[252:255],v[72:75]
ds_read_b128 v[248:251],v17 offset:28672
s_waitcnt lgkmcnt(5)
v_mfma_f32_16x16x32_bf16 v[64:67],a[32:35],v[224:227],v[64:67]
buffer_load_dwordx4 v16,s[20:23],s65 offen offset:1024  lds
v_mfma_f32_16x16x32_bf16 v[72:75],a[160:163],v[224:227],v[72:75]
ds_read_b128 v[252:255],v17 offset:30720
s_lshl_b32 s64,s64,13
v_mfma_f32_16x16x32_bf16 v[64:67],a[36:39],v[228:231],v[64:67]
buffer_load_dwordx4 v16,s[20:23],s65 offen offset:2048  lds
v_mfma_f32_16x16x32_bf16 v[72:75],a[164:167],v[228:231],v[72:75]
ds_read_b128 v[224:227],v17 offset:32768
s_waitcnt lgkmcnt(5)
v_mfma_f32_16x16x32_bf16 v[64:67],a[40:43],v[232:235],v[64:67]
buffer_load_dwordx4 v16,s[20:23],s65 offen offset:3072  lds
v_mfma_f32_16x16x32_bf16 v[72:75],a[168:171],v[232:235],v[72:75]
ds_read_b128 v[228:231],v17 offset:34816
s_and_b32 s64,s64,0x2000
v_mfma_f32_16x16x32_bf16 v[64:67],a[44:47],v[236:239],v[64:67]
v_cvt_pk_bf16_f32 v109,v109,v109
v_and_b32 v120,s80,v109
v_mfma_f32_16x16x32_bf16 v[72:75],a[172:175],v[236:239],v[72:75]
ds_read_b128 v[232:235],v17 offset:36864
s_waitcnt lgkmcnt(5)
v_mfma_f32_16x16x32_bf16 v[64:67],a[48:51],v[240:243],v[64:67]
s_add_u32 m0,s72,4096
v_lshlrev_b32 v110,16,v116
v_mfma_f32_16x16x32_bf16 v[72:75],a[176:179],v[240:243],v[72:75]
ds_read_b128 v[236:239],v17 offset:38912
s_add_u32 s65,s74,4096
v_mfma_f32_16x16x32_bf16 v[64:67],a[52:55],v[244:247],v[64:67]
s_xor_b32 s64,s64,s62
v_and_b32 v111,s80,v116
v_mfma_f32_16x16x32_bf16 v[72:75],a[180:183],v[244:247],v[72:75]
ds_read_b128 v[240:243],v17 offset:40960
s_waitcnt lgkmcnt(5)
v_mfma_f32_16x16x32_bf16 v[64:67],a[56:59],v[248:251],v[64:67]
buffer_load_dwordx4 v16,s[20:23],s65 offen offset:0  lds
v_mfma_f32_16x16x32_bf16 v[72:75],a[184:187],v[248:251],v[72:75]
ds_read_b128 v[244:247],v17 offset:43008
v_fmac_f32 v96,v110,v120
v_mfma_f32_16x16x32_bf16 v[64:67],a[60:63],v[252:255],v[64:67]
buffer_load_dwordx4 v16,s[20:23],s65 offen offset:1024  lds
v_mfma_f32_16x16x32_bf16 v[72:75],a[188:191],v[252:255],v[72:75]
ds_read_b128 v[248:251],v17 offset:45056
s_waitcnt lgkmcnt(5)
v_mfma_f32_16x16x32_bf16 v[64:67],a[64:67],v[224:227],v[64:67]
s_add_u32 s70,s70,s64
v_fmac_f32 v97,v111,v120
v_mfma_f32_16x16x32_bf16 v[72:75],a[192:195],v[224:227],v[72:75]
ds_read_b128 v[252:255],v17 offset:47104
v_lshlrev_b32 v110,16,v117
v_mfma_f32_16x16x32_bf16 v[64:67],a[68:71],v[228:231],v[64:67]
buffer_load_dwordx4 v16,s[20:23],s65 offen offset:2048  lds
v_mfma_f32_16x16x32_bf16 v[72:75],a[196:199],v[228:231],v[72:75]
ds_read_b128 v[224:227],v17 offset:49152
s_waitcnt lgkmcnt(5)
v_mfma_f32_16x16x32_bf16 v[64:67],a[72:75],v[232:235],v[64:67]
buffer_load_dwordx4 v16,s[20:23],s65 offen offset:3072  lds
v_mfma_f32_16x16x32_bf16 v[72:75],a[200:203],v[232:235],v[72:75]
ds_read_b128 v[228:231],v17 offset:51200
s_add_u32 s70,s70,29360128
v_mfma_f32_16x16x32_bf16 v[64:67],a[76:79],v[236:239],v[64:67]
s_add_u32 m0,s72,8192
v_and_b32 v111,s80,v117
v_mfma_f32_16x16x32_bf16 v[72:75],a[204:207],v[236:239],v[72:75]
ds_read_b128 v[232:235],v17 offset:53248
s_waitcnt lgkmcnt(5)
v_mfma_f32_16x16x32_bf16 v[64:67],a[80:83],v[240:243],v[64:67]
s_add_u32 s65,s74,8192
v_fmac_f32 v98,v110,v120
v_mfma_f32_16x16x32_bf16 v[72:75],a[208:211],v[240:243],v[72:75]
ds_read_b128 v[236:239],v17 offset:55296
v_fmac_f32 v99,v111,v120
v_mfma_f32_16x16x32_bf16 v[64:67],a[84:87],v[244:247],v[64:67]
v_lshlrev_b32 v110,16,v118
v_and_b32 v111,s80,v118
v_mfma_f32_16x16x32_bf16 v[72:75],a[212:215],v[244:247],v[72:75]
ds_read_b128 v[240:243],v17 offset:57344
s_waitcnt lgkmcnt(5)
v_mfma_f32_16x16x32_bf16 v[64:67],a[88:91],v[248:251],v[64:67]
buffer_load_dwordx4 v16,s[20:23],s65 offen offset:0  lds
v_mfma_f32_16x16x32_bf16 v[72:75],a[216:219],v[248:251],v[72:75]
ds_read_b128 v[244:247],v17 offset:59392
v_fmac_f32 v100,v110,v120
v_mfma_f32_16x16x32_bf16 v[64:67],a[92:95],v[252:255],v[64:67]
buffer_load_dwordx4 v16,s[20:23],s65 offen offset:1024  lds
v_mfma_f32_16x16x32_bf16 v[72:75],a[220:223],v[252:255],v[72:75]
ds_read_b128 v[248:251],v17 offset:61440
s_waitcnt lgkmcnt(5)
v_mfma_f32_16x16x32_bf16 v[64:67],a[96:99],v[224:227],v[64:67]
buffer_load_dwordx4 v16,s[20:23],s65 offen offset:2048  lds
v_mfma_f32_16x16x32_bf16 v[72:75],a[224:227],v[224:227],v[72:75]
ds_read_b128 v[252:255],v17 offset:63488
v_fmac_f32 v101,v111,v120
v_mfma_f32_16x16x32_bf16 v[64:67],a[100:103],v[228:231],v[64:67]
buffer_load_dwordx4 v16,s[20:23],s65 offen offset:3072  lds
v_mfma_f32_16x16x32_bf16 v[72:75],a[228:231],v[228:231],v[72:75]
ds_read_b128 v[224:227],v17 offset:1024
s_waitcnt lgkmcnt(5)
v_mfma_f32_16x16x32_bf16 v[64:67],a[104:107],v[232:235],v[64:67]
v_lshlrev_b32 v110,16,v119
v_and_b32 v111,s80,v119
v_mfma_f32_16x16x32_bf16 v[72:75],a[232:235],v[232:235],v[72:75]
ds_read_b128 v[228:231],v17 offset:3072
s_add_u32 m0,s72,12288
v_mfma_f32_16x16x32_bf16 v[64:67],a[108:111],v[236:239],v[64:67]
v_fmac_f32 v102,v110,v120
v_fmac_f32 v103,v111,v120
v_mfma_f32_16x16x32_bf16 v[72:75],a[236:239],v[236:239],v[72:75]
ds_read_b128 v[232:235],v17 offset:5120
s_waitcnt lgkmcnt(5)
v_mfma_f32_16x16x32_bf16 v[64:67],a[112:115],v[240:243],v[64:67]
s_add_u32 s65,s74,12288
v_mfma_f32_16x16x32_bf16 v[72:75],a[240:243],v[240:243],v[72:75]
ds_read_b128 v[236:239],v17 offset:7168
v_mfma_f32_16x16x32_bf16 v[64:67],a[116:119],v[244:247],v[64:67]
buffer_load_dwordx4 v16,s[20:23],s65 offen offset:0  lds
v_mfma_f32_16x16x32_bf16 v[72:75],a[244:247],v[244:247],v[72:75]
ds_read_b128 v[240:243],v17 offset:9216
s_waitcnt lgkmcnt(5)
v_mfma_f32_16x16x32_bf16 v[64:67],a[120:123],v[248:251],v[64:67]
buffer_load_dwordx4 v16,s[20:23],s65 offen offset:1024  lds
v_mfma_f32_16x16x32_bf16 v[72:75],a[248:251],v[248:251],v[72:75]
ds_read_b128 v[244:247],v17 offset:11264
v_mfma_f32_16x16x32_bf16 v[64:67],a[124:127],v[252:255],v[64:67]
v_mfma_f32_16x16x32_bf16 v[72:75],a[252:255],v[252:255],v[72:75]
ds_read_b128 v[248:251],v17 offset:13312
s_waitcnt lgkmcnt(5)
v_mfma_f32_16x16x32_bf16 v[68:71],a[0:3],v[224:227],0
buffer_load_dwordx4 v16,s[20:23],s65 offen offset:2048  lds
v_mfma_f32_16x16x32_bf16 v[76:79],a[128:131],v[224:227],0
ds_read_b128 v[252:255],v17 offset:15360
v_mfma_f32_16x16x32_bf16 v[68:71],a[4:7],v[228:231],v[68:71]
buffer_load_dwordx4 v16,s[20:23],s65 offen offset:3072  lds
v_mfma_f32_16x16x32_bf16 v[76:79],a[132:135],v[228:231],v[76:79]
ds_read_b128 v[224:227],v17 offset:17408
s_waitcnt lgkmcnt(5)
v_mfma_f32_16x16x32_bf16 v[68:71],a[8:11],v[232:235],v[68:71]
v_cvt_pk_bf16_f32 v88,v64,v65
v_cvt_pk_bf16_f32 v89,v66,v67
v_cvt_pk_bf16_f32 v90,v72,v73
v_cvt_pk_bf16_f32 v91,v74,v75
v_mfma_f32_16x16x32_bf16 v[76:79],a[136:139],v[232:235],v[76:79]
ds_read_b128 v[228:231],v17 offset:19456
v_mfma_f32_16x16x32_bf16 v[68:71],a[12:15],v[236:239],v[68:71]
v_mfma_f32_16x16x32_bf16 v[76:79],a[140:143],v[236:239],v[76:79]
ds_read_b128 v[232:235],v17 offset:21504
s_waitcnt lgkmcnt(5)
v_mfma_f32_16x16x32_bf16 v[68:71],a[16:19],v[240:243],v[68:71]
buffer_store_dwordx4 v[88:91],v18,s[20:23],s70 offen offset:0 sc1
v_mfma_f32_16x16x32_bf16 v[76:79],a[144:147],v[240:243],v[76:79]
ds_read_b128 v[236:239],v17 offset:23552
v_mfma_f32_16x16x32_bf16 v[68:71],a[20:23],v[244:247],v[68:71]
buffer_load_dwordx4 v[116:119],v112,s[16:19],s43 offen nt
v_mfma_f32_16x16x32_bf16 v[76:79],a[148:151],v[244:247],v[76:79]
ds_read_b128 v[240:243],v17 offset:25600
s_waitcnt lgkmcnt(5)
v_mfma_f32_16x16x32_bf16 v[68:71],a[24:27],v[248:251],v[68:71]
buffer_load_ushort v120,v113,s[12:15],s48 offen
v_mfma_f32_16x16x32_bf16 v[76:79],a[152:155],v[248:251],v[76:79]
ds_read_b128 v[244:247],v17 offset:27648
v_mfma_f32_16x16x32_bf16 v[68:71],a[28:31],v[252:255],v[68:71]
v_mfma_f32_16x16x32_bf16 v[76:79],a[156:159],v[252:255],v[76:79]
ds_read_b128 v[248:251],v17 offset:29696
s_waitcnt lgkmcnt(5)
v_mfma_f32_16x16x32_bf16 v[68:71],a[32:35],v[224:227],v[68:71]
s_add_u32 s43,s43,786432
v_mfma_f32_16x16x32_bf16 v[76:79],a[160:163],v[224:227],v[76:79]
ds_read_b128 v[252:255],v17 offset:31744
v_mfma_f32_16x16x32_bf16 v[68:71],a[36:39],v[228:231],v[68:71]
s_add_u32 s48,s48,128
v_mfma_f32_16x16x32_bf16 v[76:79],a[164:167],v[228:231],v[76:79]
ds_read_b128 v[224:227],v17 offset:33792
s_waitcnt lgkmcnt(5)
v_mfma_f32_16x16x32_bf16 v[68:71],a[40:43],v[232:235],v[68:71]
v_mfma_f32_16x16x32_bf16 v[76:79],a[168:171],v[232:235],v[76:79]
ds_read_b128 v[228:231],v17 offset:35840
v_mfma_f32_16x16x32_bf16 v[68:71],a[44:47],v[236:239],v[68:71]
buffer_store_dwordx4 v[48:51],v24,s[20:23],s93 offen sc1
v_mfma_f32_16x16x32_bf16 v[76:79],a[172:175],v[236:239],v[76:79]
ds_read_b128 v[232:235],v17 offset:37888
s_waitcnt lgkmcnt(5)
v_mfma_f32_16x16x32_bf16 v[68:71],a[48:51],v[240:243],v[68:71]
buffer_store_dwordx4 v[48:51],v25,s[20:23],s93 offen sc1
v_mfma_f32_16x16x32_bf16 v[76:79],a[176:179],v[240:243],v[76:79]
ds_read_b128 v[236:239],v17 offset:39936
v_mfma_f32_16x16x32_bf16 v[68:71],a[52:55],v[244:247],v[68:71]
v_mfma_f32_16x16x32_bf16 v[76:79],a[180:183],v[244:247],v[76:79]
ds_read_b128 v[240:243],v17 offset:41984
s_waitcnt lgkmcnt(5)
v_mfma_f32_16x16x32_bf16 v[68:71],a[56:59],v[248:251],v[68:71]
s_add_u32 s93,s93,8388608
v_mfma_f32_16x16x32_bf16 v[76:79],a[184:187],v[248:251],v[76:79]
ds_read_b128 v[244:247],v17 offset:44032
v_mfma_f32_16x16x32_bf16 v[68:71],a[60:63],v[252:255],v[68:71]
s_cmp_lt_u32 s93,163577856
s_cselect_b32 s93,s93,0x7fff0000
v_mfma_f32_16x16x32_bf16 v[76:79],a[188:191],v[252:255],v[76:79]
ds_read_b128 v[248:251],v17 offset:46080
s_waitcnt lgkmcnt(5)
v_mfma_f32_16x16x32_bf16 v[68:71],a[64:67],v[224:227],v[68:71]
v_mfma_f32_16x16x32_bf16 v[76:79],a[192:195],v[224:227],v[76:79]
ds_read_b128 v[252:255],v17 offset:48128
v_mfma_f32_16x16x32_bf16 v[68:71],a[68:71],v[228:231],v[68:71]
buffer_store_dwordx4 v[48:51],v24,s[20:23],s42 offen sc1
v_mfma_f32_16x16x32_bf16 v[76:79],a[196:199],v[228:231],v[76:79]
ds_read_b128 v[224:227],v17 offset:50176
s_waitcnt lgkmcnt(5)
v_mfma_f32_16x16x32_bf16 v[68:71],a[72:75],v[232:235],v[68:71]
buffer_store_dwordx4 v[48:51],v25,s[20:23],s42 offen sc1
v_mfma_f32_16x16x32_bf16 v[76:79],a[200:203],v[232:235],v[76:79]
ds_read_b128 v[228:231],v17 offset:52224
v_mfma_f32_16x16x32_bf16 v[68:71],a[76:79],v[236:239],v[68:71]
s_add_u32 s42,s42,2097152
v_mfma_f32_16x16x32_bf16 v[76:79],a[204:207],v[236:239],v[76:79]
ds_read_b128 v[232:235],v17 offset:54272
s_waitcnt lgkmcnt(5)
v_mfma_f32_16x16x32_bf16 v[68:71],a[80:83],v[240:243],v[68:71]
v_mfma_f32_16x16x32_bf16 v[76:79],a[208:211],v[240:243],v[76:79]
ds_read_b128 v[236:239],v17 offset:56320
s_xor_b32 s42,s42,0x2000
v_mfma_f32_16x16x32_bf16 v[68:71],a[84:87],v[244:247],v[68:71]
v_mfma_f32_16x16x32_bf16 v[76:79],a[212:215],v[244:247],v[76:79]
ds_read_b128 v[240:243],v17 offset:58368
s_waitcnt lgkmcnt(5)
v_mfma_f32_16x16x32_bf16 v[68:71],a[88:91],v[248:251],v[68:71]
s_cmp_lt_u32 s42,165675008
s_cselect_b32 s42,s42,0x7fff0000
v_mfma_f32_16x16x32_bf16 v[76:79],a[216:219],v[248:251],v[76:79]
ds_read_b128 v[244:247],v17 offset:60416
v_mfma_f32_16x16x32_bf16 v[68:71],a[92:95],v[252:255],v[68:71]
v_mfma_f32_16x16x32_bf16 v[76:79],a[220:223],v[252:255],v[76:79]
ds_read_b128 v[248:251],v17 offset:62464
s_waitcnt lgkmcnt(5)
v_mfma_f32_16x16x32_bf16 v[68:71],a[96:99],v[224:227],v[68:71]
buffer_store_dwordx4 v[48:51],v24,s[20:23],s42 offen sc1
v_mfma_f32_16x16x32_bf16 v[76:79],a[224:227],v[224:227],v[76:79]
ds_read_b128 v[252:255],v17 offset:64512
v_mfma_f32_16x16x32_bf16 v[68:71],a[100:103],v[228:231],v[68:71]
buffer_store_dwordx4 v[48:51],v25,s[20:23],s42 offen sc1
v_mfma_f32_16x16x32_bf16 v[76:79],a[228:231],v[228:231],v[76:79]
s_waitcnt lgkmcnt(4)
v_mfma_f32_16x16x32_bf16 v[68:71],a[104:107],v[232:235],v[68:71]
v_mfma_f32_16x16x32_bf16 v[76:79],a[232:235],v[232:235],v[76:79]
s_add_u32 s42,s42,2097152
v_mfma_f32_16x16x32_bf16 v[68:71],a[108:111],v[236:239],v[68:71]
v_mfma_f32_16x16x32_bf16 v[76:79],a[236:239],v[236:239],v[76:79]
s_waitcnt lgkmcnt(2)
v_mfma_f32_16x16x32_bf16 v[68:71],a[112:115],v[240:243],v[68:71]
s_xor_b32 s42,s42,0x2000
v_mfma_f32_16x16x32_bf16 v[76:79],a[240:243],v[240:243],v[76:79]
v_mfma_f32_16x16x32_bf16 v[68:71],a[116:119],v[244:247],v[68:71]
v_mfma_f32_16x16x32_bf16 v[76:79],a[244:247],v[244:247],v[76:79]
s_waitcnt lgkmcnt(0)
v_mfma_f32_16x16x32_bf16 v[68:71],a[120:123],v[248:251],v[68:71]
s_cmp_lt_u32 s42,165675008
s_cselect_b32 s42,s42,0x7fff0000
v_mfma_f32_16x16x32_bf16 v[76:79],a[248:251],v[248:251],v[76:79]
v_mfma_f32_16x16x32_bf16 v[68:71],a[124:127],v[252:255],v[68:71]
v_mfma_f32_16x16x32_bf16 v[76:79],a[252:255],v[252:255],v[76:79]
v_xor_b32 v17,0x10000,v17
s_mov_b32 s79,s77
s_nop 4
v_cvt_pk_bf16_f32 v92,v68,v69
v_cvt_pk_bf16_f32 v93,v70,v71
v_cvt_pk_bf16_f32 v94,v76,v77
v_cvt_pk_bf16_f32 v95,v78,v79
buffer_store_dwordx4 v[92:95],v18,s[20:23],s70 offen offset:1024 sc1
s_cmp_lt_u32 s79,64
s_cbranch_scc1 qloop_202
s_waitcnt vmcnt(0)
s_barrier
s_cmp_lg_u32 s41,64
s_cbranch_scc1 np3_208
s_cmp_lg_u32 s50,0
s_cbranch_scc1 ow_209
s_mov_b64 exec,1
v_mov_b32 v22,14
v_mov_b32 v23,0
s_mov_b32 s64,21052992
buffer_atomic_add v22,v23,s[20:23],s64 offen sc1
s_mov_b64 exec,-1
ow_209:
np3_208:
s_cmp_lg_u32 s50,0
s_cbranch_scc1 ow_210
s_mov_b64 exec,1
v_mov_b32 v22,18
v_mov_b32 v23,0
buffer_store_dword v22,v23,s[20:23],s73 offen sc1
s_mov_b64 exec,-1
ow_210:
v_lshlrev_b32 v108,16,v108
v_mul_f32 v109,s81,v108
v_exp_f32 v109,v109
s_nop 0
v_add_f32 v109,1.0,v109
v_rcp_f32 v109,v109
s_nop 0
v_mul_f32 v109,v109,v108
v_cvt_pk_bf16_f32 v109,v109,v109
v_and_b32 v108,s80,v109
v_lshlrev_b32 v110,16,v104
v_and_b32 v111,s80,v104
v_fmac_f32 v96,v110,v108
v_fmac_f32 v97,v111,v108
v_lshlrev_b32 v110,16,v105
v_and_b32 v111,s80,v105
v_fmac_f32 v98,v110,v108
v_fmac_f32 v99,v111,v108
v_lshlrev_b32 v110,16,v106
v_and_b32 v111,s80,v106
v_fmac_f32 v100,v110,v108
v_fmac_f32 v101,v111,v108
v_lshlrev_b32 v110,16,v107
v_and_b32 v111,s80,v107
v_fmac_f32 v102,v110,v108
v_fmac_f32 v103,v111,v108
v_lshlrev_b32 v120,16,v120
v_mul_f32 v109,s81,v120
v_exp_f32 v109,v109
s_nop 0
v_add_f32 v109,1.0,v109
v_rcp_f32 v109,v109
s_nop 0
v_mul_f32 v109,v109,v120
v_cvt_pk_bf16_f32 v109,v109,v109
v_and_b32 v120,s80,v109
v_lshlrev_b32 v110,16,v116
v_and_b32 v111,s80,v116
v_fmac_f32 v96,v110,v120
v_fmac_f32 v97,v111,v120
v_lshlrev_b32 v110,16,v117
v_and_b32 v111,s80,v117
v_fmac_f32 v98,v110,v120
v_fmac_f32 v99,v111,v120
v_lshlrev_b32 v110,16,v118
v_and_b32 v111,s80,v118
v_fmac_f32 v100,v110,v120
v_fmac_f32 v101,v111,v120
v_lshlrev_b32 v110,16,v119
v_and_b32 v111,s80,v119
v_fmac_f32 v102,v110,v120
v_fmac_f32 v103,v111,v120
v_lshlrev_b32 v5,5,v0
ds_write_b128 v5,v[96:99]
ds_write_b128 v5,v[100:103] offset:16
v_and_b32 v6,31,v0
v_lshrrev_b32 v7,5,v0
v_lshlrev_b32 v7,10,v7
v_lshl_add_u32 v7,v6,2,v7
s_waitcnt lgkmcnt(0)
s_barrier
ds_read_b32 v8,v7 offset:0
ds_read_b32 v9,v7 offset:128
ds_read_b32 v10,v7 offset:256
ds_read_b32 v11,v7 offset:384
ds_read_b32 v12,v7 offset:512
ds_read_b32 v13,v7 offset:640
ds_read_b32 v14,v7 offset:768
ds_read_b32 v15,v7 offset:896
s_waitcnt lgkmcnt(0)
v_add_f32 v8,v8,v9
v_add_f32 v8,v8,v10
v_add_f32 v8,v8,v11
v_add_f32 v8,v8,v12
v_add_f32 v8,v8,v13
v_add_f32 v8,v8,v14
v_add_f32 v8,v8,v15
v_lshlrev_b32 v5,2,v0
ds_write_b32 v5,v8 offset:8192
v_lshlrev_b32 v7,2,v6
s_waitcnt lgkmcnt(0)
s_barrier
ds_read_b32 v8,v7 offset:8192
ds_read_b32 v9,v7 offset:8320
ds_read_b32 v10,v7 offset:8448
ds_read_b32 v11,v7 offset:8576
ds_read_b32 v12,v7 offset:8704
ds_read_b32 v13,v7 offset:8832
ds_read_b32 v14,v7 offset:8960
ds_read_b32 v15,v7 offset:9088
s_waitcnt lgkmcnt(0)
v_add_f32 v8,v8,v9
v_add_f32 v8,v8,v10
v_add_f32 v8,v8,v11
v_add_f32 v8,v8,v12
v_add_f32 v8,v8,v13
v_add_f32 v8,v8,v14
v_add_f32 v8,v8,v15
v_cvt_pk_bf16_f32 v8,v8,v8
v_and_b32 v8,s80,v8
s_lshl_b32 s64,s55,7
s_add_u32 s64,s64,8192
s_cmp_lg_u32 s50,0
s_cbranch_scc1 ow_211
buffer_store_dword v8,v7,s[20:23],s64 offen sc1
ow_211:
s_waitcnt vmcnt(0)
s_barrier
s_cmp_lg_u32 s50,0
s_cbranch_scc1 ow_212
s_mov_b64 exec,1
v_mov_b32 v22,14
v_mov_b32 v23,0
s_mov_b32 s64,21052032
buffer_atomic_add v22,v23,s[20:23],s64 offen sc1
s_mov_b64 exec,-1
ow_212:
s_lshr_b32 s58,s55,5
s_and_b32 s59,s55,31
s_mov_b32 s57,65
s_mov_b32 s79,0
s_branch common_213
pipe_second:
s_cmp_ge_u32 s59,18
s_cbranch_scc1 giveup_197
s_getpc_b64 s[4:5]
pc2nd:
s_sub_u32 s8,s4,pc2nd-mega_kernel
s_subb_u32 s9,s5,0
s_and_b32 s9,s9,0xffff
s_mov_b32 s10,code_end-mega_kernel
s_mov_b32 s11,0x20000
s_lshl_b32 s12,s59,15
v_lshlrev_b32 v2,7,v0
buffer_load_dword v2,v2,s[8:11],s12 offen
s_add_u32 s55,s57,128
s_and_b32 s64,s59,1
s_lshl_b32 s65,s58,1
s_add_u32 s64,s64,s65
s_lshl_b32 s65,s59,2
s_and_b32 s65,s65,24
s_add_u32 s65,s65,s64
s_add_u32 s64,s64,24
s_cmp_ge_u32 s59,16
s_cselect_b32 s64,s64,s65
s_lshl_b32 s65,s58,3
s_add_u32 s65,s65,s59
s_lshr_b32 s58,s59,3
s_add_u32 s58,s58,1
s_cmp_lt_u32 s59,8
s_cselect_b32 s59,s65,s64
s_xor_b32 s62,s61,0x2000
s_add_u32 s63,s62,21053440
s_mov_b32 s57,65
s_mov_b32 s79,64
s_mov_b32 s90,400000
common_213:
v_and_b32 v1,63,v0
v_and_b32 v3,15,v1
v_lshrrev_b32 v4,4,v1
v_lshlrev_b32 v16,4,v1
v_mov_b32 v48,0
v_mov_b32 v49,0
v_mov_b32 v50,0
v_mov_b32 v51,0
s_mov_b64 s[24:25],s[20:21]
s_mov_b64 s[28:29],s[20:21]
s_mov_b32 s27,0x20000
s_mov_b32 s31,0x20000
s_cmp_eq_u32 s56,0
s_cselect_b32 s26,s22,0
s_cselect_b32 s30,0,s22
s_add_u32 s71,s79,1
s_lshl_b32 s60,s79,4
s_mov_b32 s98,0
s_mov_b32 s99,0
v_mov_b32 v29,0
v_cmp_eq_u32 vcc,0,v1
v_mov_b32 v23,0x40000000
s_nop 0
v_cndmask_b32 v23,v23,v48,vcc
s_mov_b32 s80,0xffff0000
s_cmp_eq_u32 s58,0
s_cbranch_scc1 r_wo_214
s_cmp_eq_u32 s58,1
s_cbranch_scc1 r_w3_215
s_cmp_eq_u32 s58,2
s_cbranch_scc1 r_w4_216
s_and_b32 s41,s59,15
s_cmp_lt_u32 s59,16
s_cbranch_scc1 r_at_219
s_cmp_ge_u32 s59,24
s_cbranch_scc1 r_w2_217
s_load_dwordx2 s[4:5],s[0:1],64
s_and_b32 s41,s59,7
s_lshl_b32 s66,s41,8
s_lshl_b32 s67,s50,1
s_waitcnt lgkmcnt(0)
s_mov_b32 s32,s4
s_and_b32 s33,s5,0xffff
s_mov_b32 s34,0x200000
s_mov_b32 s35,0x20000
v_lshrrev_b32 v5,2,v3
v_lshl_add_u32 v7,v4,3,v5
v_and_b32 v6,3,v3
v_lshlrev_b32 v6,3,v6
v_lshl_add_u32 v6,v7,8,v6
v_and_b32 v7,1,v4
v_lshl_add_u32 v5,v7,2,v5
v_xor_b32 v5,s67,v5
v_lshl_add_u32 v12,v5,5,v6
v_xor_b32 v13,32,v12
v_and_b32 v5,15,v1
v_and_b32 v6,3,v4
v_lshlrev_b32 v6,1,v6
v_xor_b32 v5,v5,v6
v_mul_u32_u24 v6,2048,v4
v_xor_b32 v7,0,v5
v_lshl_add_u32 v8,v7,4,v6
v_xor_b32 v7,8,v5
v_lshl_add_u32 v9,v7,4,v6
s_mul_i32 s74,s50,131072
s_add_u32 s74,s74,s66
s_lshl_b32 s75,s50,14
s_mul_i32 s76,s50,65536
s_add_u32 s76,s76,s66
s_lshl_b32 s77,s50,13
s_add_u32 s64,s74,0
s_add_u32 m0,s75,0
s_nop 0
buffer_load_dwordx4 v8,s[32:35],s64 offen nt lds
s_add_u32 s64,s74,8192
s_add_u32 m0,s75,1024
s_nop 0
buffer_load_dwordx4 v8,s[32:35],s64 offen nt lds
s_add_u32 s64,s74,16384
s_add_u32 m0,s75,2048
s_nop 0
buffer_load_dwordx4 v9,s[32:35],s64 offen nt lds
s_add_u32 s64,s74,24576
s_add_u32 m0,s75,3072
s_nop 0
buffer_load_dwordx4 v9,s[32:35],s64 offen nt lds
s_add_u32 s64,s74,32768
s_add_u32 m0,s75,4096
s_nop 0
buffer_load_dwordx4 v8,s[32:35],s64 offen nt lds
s_add_u32 s64,s74,40960
s_add_u32 m0,s75,5120
s_nop 0
buffer_load_dwordx4 v8,s[32:35],s64 offen nt lds
s_add_u32 s64,s74,49152
s_add_u32 m0,s75,6144
s_nop 0
buffer_load_dwordx4 v9,s[32:35],s64 offen nt lds
s_add_u32 s64,s74,57344
s_add_u32 m0,s75,7168
s_nop 0
buffer_load_dwordx4 v9,s[32:35],s64 offen nt lds
s_add_u32 s64,s74,65536
s_add_u32 m0,s75,8192
s_nop 0
buffer_load_dwordx4 v8,s[32:35],s64 offen nt lds
s_add_u32 s64,s74,73728
s_add_u32 m0,s75,9216
s_nop 0
buffer_load_dwordx4 v8,s[32:35],s64 offen nt lds
s_add_u32 s64,s74,81920
s_add_u32 m0,s75,10240
s_nop 0
buffer_load_dwordx4 v9,s[32:35],s64 offen nt lds
s_add_u32 s64,s74,90112
s_add_u32 m0,s75,11264
s_nop 0
buffer_load_dwordx4 v9,s[32:35],s64 offen nt lds
s_add_u32 s64,s74,98304
s_add_u32 m0,s75,12288
s_nop 0
buffer_load_dwordx4 v8,s[32:35],s64 offen nt lds
s_add_u32 s64,s74,106496
s_add_u32 m0,s75,13312
s_nop 0
buffer_load_dwordx4 v8,s[32:35],s64 offen nt lds
s_add_u32 s64,s74,114688
s_add_u32 m0,s75,14336
s_nop 0
buffer_load_dwordx4 v9,s[32:35],s64 offen nt lds
s_add_u32 s64,s74,122880
s_add_u32 m0,s75,15360
s_nop 0
buffer_load_dwordx4 v9,s[32:35],s64 offen nt lds
s_add_u32 s64,s74,524288
s_add_u32 m0,s75,65536
s_nop 0
buffer_load_dwordx4 v8,s[32:35],s64 offen nt lds
s_add_u32 s64,s74,532480
s_add_u32 m0,s75,66560
s_nop 0
buffer_load_dwordx4 v8,s[32:35],s64 offen nt lds
s_add_u32 s64,s74,540672
s_add_u32 m0,s75,67584
s_nop 0
buffer_load_dwordx4 v9,s[32:35],s64 offen nt lds
s_add_u32 s64,s74,548864
s_add_u32 m0,s75,68608
s_nop 0
buffer_load_dwordx4 v9,s[32:35],s64 offen nt lds
s_add_u32 s64,s74,557056
s_add_u32 m0,s75,69632
s_nop 0
buffer_load_dwordx4 v8,s[32:35],s64 offen nt lds
s_add_u32 s64,s74,565248
s_add_u32 m0,s75,70656
s_nop 0
buffer_load_dwordx4 v8,s[32:35],s64 offen nt lds
s_add_u32 s64,s74,573440
s_add_u32 m0,s75,71680
s_nop 0
buffer_load_dwordx4 v9,s[32:35],s64 offen nt lds
s_add_u32 s64,s74,581632
s_add_u32 m0,s75,72704
s_nop 0
buffer_load_dwordx4 v9,s[32:35],s64 offen nt lds
s_add_u32 s64,s74,589824
s_add_u32 m0,s75,73728
s_nop 0
buffer_load_dwordx4 v8,s[32:35],s64 offen nt lds
s_add_u32 s64,s74,598016
s_add_u32 m0,s75,74752
s_nop 0
buffer_load_dwordx4 v8,s[32:35],s64 offen nt lds
s_add_u32 s64,s74,606208
s_add_u32 m0,s75,75776
s_nop 0
buffer_load_dwordx4 v9,s[32:35],s64 offen nt lds
s_add_u32 s64,s74,614400
s_add_u32 m0,s75,76800
s_nop 0
buffer_load_dwordx4 v9,s[32:35],s64 offen nt lds
s_add_u32 s64,s74,622592
s_add_u32 m0,s75,77824
s_nop 0
buffer_load_dwordx4 v8,s[32:35],s64 offen nt lds
s_add_u32 s64,s74,630784
s_add_u32 m0,s75,78848
s_nop 0
buffer_load_dwordx4 v8,s[32:35],s64 offen nt lds
s_add_u32 s64,s74,638976
s_add_u32 m0,s75,79872
s_nop 0
buffer_load_dwordx4 v9,s[32:35],s64 offen nt lds
s_add_u32 s64,s74,647168
s_add_u32 m0,s75,80896
s_nop 0
buffer_load_dwordx4 v9,s[32:35],s64 offen nt lds
s_waitcnt vmcnt(16)
s_barrier
ds_read_b64_tr_b16 a[0:1],v12 offset:0
ds_read_b64_tr_b16 a[128:129],v13 offset:0
ds_read_b64_tr_b16 a[2:3],v12 offset:1024
ds_read_b64_tr_b16 a[130:131],v13 offset:1024
ds_read_b64_tr_b16 a[4:5],v12 offset:8192
ds_read_b64_tr_b16 a[132:133],v13 offset:8192
ds_read_b64_tr_b16 a[6:7],v12 offset:9216
ds_read_b64_tr_b16 a[134:135],v13 offset:9216
s_waitcnt lgkmcnt(4)
ds_read_b64_tr_b16 a[8:9],v12 offset:16384
ds_read_b64_tr_b16 a[136:137],v13 offset:16384
ds_read_b64_tr_b16 a[10:11],v12 offset:17408
ds_read_b64_tr_b16 a[138:139],v13 offset:17408
ds_read_b64_tr_b16 a[12:13],v12 offset:24576
ds_read_b64_tr_b16 a[140:141],v13 offset:24576
ds_read_b64_tr_b16 a[14:15],v12 offset:25600
ds_read_b64_tr_b16 a[142:143],v13 offset:25600
s_waitcnt lgkmcnt(4)
ds_read_b64_tr_b16 a[16:17],v12 offset:32768
ds_read_b64_tr_b16 a[144:145],v13 offset:32768
ds_read_b64_tr_b16 a[18:19],v12 offset:33792
ds_read_b64_tr_b16 a[146:147],v13 offset:33792
ds_read_b64_tr_b16 a[20:21],v12 offset:40960
ds_read_b64_tr_b16 a[148:149],v13 offset:40960
ds_read_b64_tr_b16 a[22:23],v12 offset:41984
ds_read_b64_tr_b16 a[150:151],v13 offset:41984
s_waitcnt lgkmcnt(4)
ds_read_b64_tr_b16 a[24:25],v12 offset:49152
ds_read_b64_tr_b16 a[152:153],v13 offset:49152
ds_read_b64_tr_b16 a[26:27],v12 offset:50176
ds_read_b64_tr_b16 a[154:155],v13 offset:50176
ds_read_b64_tr_b16 a[28:29],v12 offset:57344
ds_read_b64_tr_b16 a[156:157],v13 offset:57344
ds_read_b64_tr_b16 a[30:31],v12 offset:58368
ds_read_b64_tr_b16 a[158:159],v13 offset:58368
s_waitcnt lgkmcnt(4)
v_xor_b32 v12,0x10000,v12
v_xor_b32 v13,0x10000,v13
s_waitcnt lgkmcnt(0)
s_barrier
s_add_u32 s64,s74,1048576
s_add_u32 m0,s75,0
s_nop 0
buffer_load_dwordx4 v8,s[32:35],s64 offen nt lds
s_add_u32 s64,s74,1056768
s_add_u32 m0,s75,1024
s_nop 0
buffer_load_dwordx4 v8,s[32:35],s64 offen nt lds
s_add_u32 s64,s74,1064960
s_add_u32 m0,s75,2048
s_nop 0
buffer_load_dwordx4 v9,s[32:35],s64 offen nt lds
s_add_u32 s64,s74,1073152
s_add_u32 m0,s75,3072
s_nop 0
buffer_load_dwordx4 v9,s[32:35],s64 offen nt lds
s_add_u32 s64,s74,1081344
s_add_u32 m0,s75,4096
s_nop 0
buffer_load_dwordx4 v8,s[32:35],s64 offen nt lds
s_add_u32 s64,s74,1089536
s_add_u32 m0,s75,5120
s_nop 0
buffer_load_dwordx4 v8,s[32:35],s64 offen nt lds
s_add_u32 s64,s74,1097728
s_add_u32 m0,s75,6144
s_nop 0
buffer_load_dwordx4 v9,s[32:35],s64 offen nt lds
s_add_u32 s64,s74,1105920
s_add_u32 m0,s75,7168
s_nop 0
buffer_load_dwordx4 v9,s[32:35],s64 offen nt lds
s_add_u32 s64,s74,1114112
s_add_u32 m0,s75,8192
s_nop 0
buffer_load_dwordx4 v8,s[32:35],s64 offen nt lds
s_add_u32 s64,s74,1122304
s_add_u32 m0,s75,9216
s_nop 0
buffer_load_dwordx4 v8,s[32:35],s64 offen nt lds
s_add_u32 s64,s74,1130496
s_add_u32 m0,s75,10240
s_nop 0
buffer_load_dwordx4 v9,s[32:35],s64 offen nt lds
s_add_u32 s64,s74,1138688
s_add_u32 m0,s75,11264
s_nop 0
buffer_load_dwordx4 v9,s[32:35],s64 offen nt lds
s_add_u32 s64,s74,1146880
s_add_u32 m0,s75,12288
s_nop 0
buffer_load_dwordx4 v8,s[32:35],s64 offen nt lds
s_add_u32 s64,s74,1155072
s_add_u32 m0,s75,13312
s_nop 0
buffer_load_dwordx4 v8,s[32:35],s64 offen nt lds
s_add_u32 s64,s74,1163264
s_add_u32 m0,s75,14336
s_nop 0
buffer_load_dwordx4 v9,s[32:35],s64 offen nt lds
s_add_u32 s64,s74,1171456
s_add_u32 m0,s75,15360
s_nop 0
buffer_load_dwordx4 v9,s[32:35],s64 offen nt lds
s_waitcnt vmcnt(16)
s_barrier
ds_read_b64_tr_b16 a[32:33],v12 offset:0
ds_read_b64_tr_b16 a[160:161],v13 offset:0
ds_read_b64_tr_b16 a[34:35],v12 offset:1024
ds_read_b64_tr_b16 a[162:163],v13 offset:1024
ds_read_b64_tr_b16 a[36:37],v12 offset:8192
ds_read_b64_tr_b16 a[164:165],v13 offset:8192
ds_read_b64_tr_b16 a[38:39],v12 offset:9216
ds_read_b64_tr_b16 a[166:167],v13 offset:9216
s_waitcnt lgkmcnt(4)
ds_read_b64_tr_b16 a[40:41],v12 offset:16384
ds_read_b64_tr_b16 a[168:169],v13 offset:16384
ds_read_b64_tr_b16 a[42:43],v12 offset:17408
ds_read_b64_tr_b16 a[170:171],v13 offset:17408
ds_read_b64_tr_b16 a[44:45],v12 offset:24576
ds_read_b64_tr_b16 a[172:173],v13 offset:24576
ds_read_b64_tr_b16 a[46:47],v12 offset:25600
ds_read_b64_tr_b16 a[174:175],v13 offset:25600
s_waitcnt lgkmcnt(4)
ds_read_b64_tr_b16 a[48:49],v12 offset:32768
ds_read_b64_tr_b16 a[176:177],v13 offset:32768
ds_read_b64_tr_b16 a[50:51],v12 offset:33792
ds_read_b64_tr_b16 a[178:179],v13 offset:33792
ds_read_b64_tr_b16 a[52:53],v12 offset:40960
ds_read_b64_tr_b16 a[180:181],v13 offset:40960
ds_read_b64_tr_b16 a[54:55],v12 offset:41984
ds_read_b64_tr_b16 a[182:183],v13 offset:41984
s_waitcnt lgkmcnt(4)
ds_read_b64_tr_b16 a[56:57],v12 offset:49152
ds_read_b64_tr_b16 a[184:185],v13 offset:49152
ds_read_b64_tr_b16 a[58:59],v12 offset:50176
ds_read_b64_tr_b16 a[186:187],v13 offset:50176
ds_read_b64_tr_b16 a[60:61],v12 offset:57344
ds_read_b64_tr_b16 a[188:189],v13 offset:57344
ds_read_b64_tr_b16 a[62:63],v12 offset:58368
ds_read_b64_tr_b16 a[190:191],v13 offset:58368
s_waitcnt lgkmcnt(4)
v_xor_b32 v12,0x10000,v12
v_xor_b32 v13,0x10000,v13
s_waitcnt lgkmcnt(0)
s_barrier
s_add_u32 s64,s74,1572864
s_add_u32 m0,s75,65536
s_nop 0
buffer_load_dwordx4 v8,s[32:35],s64 offen nt lds
s_add_u32 s64,s74,1581056
s_add_u32 m0,s75,66560
s_nop 0
buffer_load_dwordx4 v8,s[32:35],s64 offen nt lds
s_add_u32 s64,s74,1589248
s_add_u32 m0,s75,67584
s_nop 0
buffer_load_dwordx4 v9,s[32:35],s64 offen nt lds
s_add_u32 s64,s74,1597440
s_add_u32 m0,s75,68608
s_nop 0
buffer_load_dwordx4 v9,s[32:35],s64 offen nt lds
s_add_u32 s64,s74,1605632
s_add_u32 m0,s75,69632
s_nop 0
buffer_load_dwordx4 v8,s[32:35],s64 offen nt lds
s_add_u32 s64,s74,1613824
s_add_u32 m0,s75,70656
s_nop 0
buffer_load_dwordx4 v8,s[32:35],s64 offen nt lds
s_add_u32 s64,s74,1622016
s_add_u32 m0,s75,71680
s_nop 0
buffer_load_dwordx4 v9,s[32:35],s64 offen nt lds
s_add_u32 s64,s74,1630208
s_add_u32 m0,s75,72704
s_nop 0
buffer_load_dwordx4 v9,s[32:35],s64 offen nt lds
s_add_u32 s64,s74,1638400
s_add_u32 m0,s75,73728
s_nop 0
buffer_load_dwordx4 v8,s[32:35],s64 offen nt lds
s_add_u32 s64,s74,1646592
s_add_u32 m0,s75,74752
s_nop 0
buffer_load_dwordx4 v8,s[32:35],s64 offen nt lds
s_add_u32 s64,s74,1654784
s_add_u32 m0,s75,75776
s_nop 0
buffer_load_dwordx4 v9,s[32:35],s64 offen nt lds
s_add_u32 s64,s74,1662976
s_add_u32 m0,s75,76800
s_nop 0
buffer_load_dwordx4 v9,s[32:35],s64 offen nt lds
s_add_u32 s64,s74,1671168
s_add_u32 m0,s75,77824
s_nop 0
buffer_load_dwordx4 v8,s[32:35],s64 offen nt lds
s_add_u32 s64,s74,1679360
s_add_u32 m0,s75,78848
s_nop 0
buffer_load_dwordx4 v8,s[32:35],s64 offen nt lds
s_add_u32 s64,s74,1687552
s_add_u32 m0,s75,79872
s_nop 0
buffer_load_dwordx4 v9,s[32:35],s64 offen nt lds
s_add_u32 s64,s74,1695744
s_add_u32 m0,s75,80896
s_nop 0
buffer_load_dwordx4 v9,s[32:35],s64 offen nt lds
s_waitcnt vmcnt(16)
s_barrier
ds_read_b64_tr_b16 a[64:65],v12 offset:0
ds_read_b64_tr_b16 a[192:193],v13 offset:0
ds_read_b64_tr_b16 a[66:67],v12 offset:1024
ds_read_b64_tr_b16 a[194:195],v13 offset:1024
ds_read_b64_tr_b16 a[68:69],v12 offset:8192
ds_read_b64_tr_b16 a[196:197],v13 offset:8192
ds_read_b64_tr_b16 a[70:71],v12 offset:9216
ds_read_b64_tr_b16 a[198:199],v13 offset:9216
s_waitcnt lgkmcnt(4)
ds_read_b64_tr_b16 a[72:73],v12 offset:16384
ds_read_b64_tr_b16 a[200:201],v13 offset:16384
ds_read_b64_tr_b16 a[74:75],v12 offset:17408
ds_read_b64_tr_b16 a[202:203],v13 offset:17408
ds_read_b64_tr_b16 a[76:77],v12 offset:24576
ds_read_b64_tr_b16 a[204:205],v13 offset:24576
ds_read_b64_tr_b16 a[78:79],v12 offset:25600
ds_read_b64_tr_b16 a[206:207],v13 offset:25600
s_waitcnt lgkmcnt(4)
ds_read_b64_tr_b16 a[80:81],v12 offset:32768
ds_read_b64_tr_b16 a[208:209],v13 offset:32768
ds_read_b64_tr_b16 a[82:83],v12 offset:33792
ds_read_b64_tr_b16 a[210:211],v13 offset:33792
ds_read_b64_tr_b16 a[84:85],v12 offset:40960
ds_read_b64_tr_b16 a[212:213],v13 offset:40960
ds_read_b64_tr_b16 a[86:87],v12 offset:41984
ds_read_b64_tr_b16 a[214:215],v13 offset:41984
s_waitcnt lgkmcnt(4)
ds_read_b64_tr_b16 a[88:89],v12 offset:49152
ds_read_b64_tr_b16 a[216:217],v13 offset:49152
ds_read_b64_tr_b16 a[90:91],v12 offset:50176
ds_read_b64_tr_b16 a[218:219],v13 offset:50176
ds_read_b64_tr_b16 a[92:93],v12 offset:57344
ds_read_b64_tr_b16 a[220:221],v13 offset:57344
ds_read_b64_tr_b16 a[94:95],v12 offset:58368
ds_read_b64_tr_b16 a[222:223],v13 offset:58368
s_waitcnt lgkmcnt(4)
v_xor_b32 v12,0x10000,v12
v_xor_b32 v13,0x10000,v13
s_waitcnt lgkmcnt(0)
s_barrier
s_waitcnt vmcnt(0)
s_barrier
ds_read_b64_tr_b16 a[96:97],v12 offset:0
ds_read_b64_tr_b16 a[224:225],v13 offset:0
ds_read_b64_tr_b16 a[98:99],v12 offset:1024
ds_read_b64_tr_b16 a[226:227],v13 offset:1024
ds_read_b64_tr_b16 a[100:101],v12 offset:8192
ds_read_b64_tr_b16 a[228:229],v13 offset:8192
ds_read_b64_tr_b16 a[102:103],v12 offset:9216
ds_read_b64_tr_b16 a[230:231],v13 offset:9216
s_waitcnt lgkmcnt(4)
ds_read_b64_tr_b16 a[104:105],v12 offset:16384
ds_read_b64_tr_b16 a[232:233],v13 offset:16384
ds_read_b64_tr_b16 a[106:107],v12 offset:17408
ds_read_b64_tr_b16 a[234:235],v13 offset:17408
ds_read_b64_tr_b16 a[108:109],v12 offset:24576
ds_read_b64_tr_b16 a[236:237],v13 offset:24576
ds_read_b64_tr_b16 a[110:111],v12 offset:25600
ds_read_b64_tr_b16 a[238:239],v13 offset:25600
s_waitcnt lgkmcnt(4)
ds_read_b64_tr_b16 a[112:113],v12 offset:32768
ds_read_b64_tr_b16 a[240:241],v13 offset:32768
ds_read_b64_tr_b16 a[114:115],v12 offset:33792
ds_read_b64_tr_b16 a[242:243],v13 offset:33792
ds_read_b64_tr_b16 a[116:117],v12 offset:40960
ds_read_b64_tr_b16 a[244:245],v13 offset:40960
ds_read_b64_tr_b16 a[118:119],v12 offset:41984
ds_read_b64_tr_b16 a[246:247],v13 offset:41984
s_waitcnt lgkmcnt(4)
ds_read_b64_tr_b16 a[120:121],v12 offset:49152
ds_read_b64_tr_b16 a[248:249],v13 offset:49152
ds_read_b64_tr_b16 a[122:123],v12 offset:50176
ds_read_b64_tr_b16 a[250:251],v13 offset:50176
ds_read_b64_tr_b16 a[124:125],v12 offset:57344
ds_read_b64_tr_b16 a[252:253],v13 offset:57344
ds_read_b64_tr_b16 a[126:127],v12 offset:58368
ds_read_b64_tr_b16 a[254:255],v13 offset:58368
s_waitcnt lgkmcnt(4)
v_xor_b32 v12,0x10000,v12
v_xor_b32 v13,0x10000,v13
s_waitcnt lgkmcnt(0)
s_barrier
v_and_b32 v21,1,v1
v_mul_u32_u24 v21,960,v21
s_mov_b32 s65,21052032
s_mov_b32 s66,1792
pl_220:
buffer_load_dword v22,v21,s[20:23],s65 offen sc1
s_waitcnt vmcnt(0)
v_cmp_gt_u32 vcc,s66,v22
s_cbranch_vccz pok_221
s_sleep 1
s_sub_u32 s90,s90,1
s_cmp_gt_i32 s90,0
s_cbranch_scc1 pl_220
pok_221:
s_mov_b32 s81,0xbdd2d3e8
v_mov_b32 v28,0xc0135761
v_mov_b32 v17,v16
v_and_b32 v21,31,v1
v_lshlrev_b32 v21,2,v21
s_mul_i32 s74,s79,40
s_add_u32 s74,s74,s63
s_add_u32 s74,s74,2560
s_lshl_b32 s42,s41,2
s_add_u32 s42,s42,s50
s_lshl_b32 s73,s41,4
s_lshl_b32 s64,s50,2
s_add_u32 s73,s73,s64
s_add_u32 s73,s73,s63
s_add_u32 s73,s73,3072
s_add_u32 s73,s73,s60
s_lshl_b32 s43,s50,11
s_lshl_b32 s78,s79,21
s_add_u32 s78,s78,29360128
s_mov_b32 s64,0
s_lshr_b32 s65,s50,1
s_and_b32 s66,s50,1
s_lshl_b32 s72,s65,13
s_lshl_b32 s64,s66,11
s_add_u32 s72,s72,s64
s_add_u32 s72,s72,0x10000
s_lshl_b32 s75,s66,15
s_lshl_b32 s64,s65,7
s_add_u32 s75,s75,s64
s_add_u32 s75,s75,1835008
s_lshl_b32 s64,s66,2
v_add_u32 v5,s64,v4
v_and_b32 v6,7,v1
v_xor_b32 v5,v5,v6
v_lshlrev_b32 v5,4,v5
v_bfe_u32 v6,v1,3,2
v_lshl_add_u32 v5,v6,11,v5
v_lshrrev_b32 v6,5,v1
v_lshl_add_u32 v42,v6,14,v5
v_lshrrev_b32 v5,1,v3
v_xor_b32 v5,v5,v4
v_lshlrev_b32 v5,4,v5
v_and_b32 v6,7,v3
v_lshl_add_u32 v5,v6,7,v5
v_lshrrev_b32 v6,3,v3
v_lshl_add_u32 v17,v6,11,v5
v_xor_b32 v43,64,v17
s_lshr_b32 s64,s41,1
s_lshl_b32 s64,s64,2
s_lshr_b32 s64,0x0413,s64
s_and_b32 s64,s64,7
s_add_u32 s65,s41,120
s_lshl_b32 s65,s65,14
s_add_u32 s65,s65,s43
v_lshl_add_u32 v7,v4,8,s65
v_mov_b32 v9,2105344
v_add_u32 v6,s64,v3
v_and_b32 v5,15,v6
v_lshl_add_u32 v5,v5,4,v7
v_bfe_u32 v8,v6,4,1
v_lshl_add_u32 v5,v8,10,v5
v_cmp_lt_u32 vcc,31,v6
s_nop 1
v_cndmask_b32 v8,0,v9,vcc
v_add_u32 v5,v5,v8
v_xor_b32 v18,s62,v5
s_add_u32 s64,s64,16
v_add_u32 v6,s64,v3
v_and_b32 v5,15,v6
v_lshl_add_u32 v5,v5,4,v7
v_bfe_u32 v8,v6,4,1
v_lshl_add_u32 v5,v8,10,v5
v_cmp_lt_u32 vcc,31,v6
s_nop 1
v_cndmask_b32 v8,0,v9,vcc
v_add_u32 v5,v5,v8
v_xor_b32 v19,s62,v5
s_add_u32 s64,s64,16
s_mov_b64 s[84:85],vcc
v_mov_b32 v88,1
v_mov_b32 v89,0
v_mov_b32 v90,0
v_mov_b32 v91,0
v_xor_b32 v5,0x2000,v19
s_mov_b32 s64,163577856
buffer_store_dwordx4 v[88:91],v18,s[20:23],s64 offen sc1
s_andn2_b64 exec,exec,s[84:85]
buffer_store_dwordx4 v[88:91],v19,s[20:23],s64 offen sc1
s_mov_b64 exec,-1
v_mov_b32 v6,0x7fff0000
v_cndmask_b32 v5,v6,v5,s[84:85]
s_mov_b32 s64,27262976
buffer_store_dwordx4 v[88:91],v5,s[20:23],s64 offen sc1
s_waitcnt vmcnt(0)
s_add_u32 s64,s79,0
s_lshl_b32 s70,s64,21
s_lshl_b32 s64,s64,13
s_and_b32 s64,s64,0x2000
s_xor_b32 s64,s64,s62
s_add_u32 s70,s70,s64
s_add_u32 s70,s70,29360128
s_mov_b32 s83,1
s_mov_b32 s87,s74
s_cmp_eq_u32 s50,0
s_cselect_b32 s74,s74,0x7fff0000
v_mov_b32 v47,132096
s_lshl_b32 s64,s50,3
s_add_u32 s64,s64,132096
v_mov_b32 v46,s64
v_mov_b32 v29,0
s_mov_b32 s97,0x7fff0000
s_mov_b32 s69,1
s_mov_b32 s68,0
s_mov_b32 s52,0x30003
s_mov_b32 s53,s52
seg_223:
s_cmp_eq_u32 s83,0
s_cbranch_scc1 ahead_224
s_add_u32 s94,s70,s75
s_add_u32 s95,s94,65536
s_xor_b32 s91,s72,0x10000
s_waitcnt vmcnt(3)
v_cmp_gt_u32 vcc,s71,v29
s_cbranch_vccz nb_227
s_waitcnt vmcnt(0)
v_add_u32 v22,s71,-1
buffer_store_dword v22,v23,s[24:27],s97 offen
buffer_store_dword v22,v23,s[28:31],s97 offen sc1
s_mov_b32 s97,0x7fff0000
s_cmp_lg_u32 s50,0
s_cbranch_scc1 nb_227
buffer_load_dword v32,v21,s[20:23],s74 offen sc1
s_sleep 2
pl_229:
buffer_load_dword v33,v21,s[20:23],s74 offen sc1
s_waitcnt vmcnt(1)
v_cmp_gt_u32 vcc,s71,v32
v_mov_b32 v29,v32
s_cbranch_vccz pok_230
buffer_load_dword v32,v21,s[20:23],s74 offen sc1
s_waitcnt vmcnt(1)
v_cmp_gt_u32 vcc,s71,v33
v_mov_b32 v29,v33
s_cbranch_vccz pok_230
s_sub_u32 s90,s90,1
s_cmp_gt_i32 s90,0
s_cbranch_scc1 pl_229
pok_230:
nb_227:
s_barrier
s_xor_b32 m0,s91,0
s_add_u32 s65,s94,0
buffer_load_dwordx4 v42,s[20:23],s65 offen offset:0 sc1 lds
buffer_load_dwordx4 v42,s[20:23],s65 offen offset:1024 sc1 lds
s_xor_b32 m0,s91,16384
s_add_u32 s65,s94,256
buffer_load_dwordx4 v42,s[20:23],s65 offen offset:0 sc1 lds
buffer_load_dwordx4 v42,s[20:23],s65 offen offset:1024 sc1 lds
s_xor_b32 m0,s91,32768
s_add_u32 s65,s94,512
buffer_load_dwordx4 v42,s[20:23],s65 offen offset:0 sc1 lds
buffer_load_dwordx4 v42,s[20:23],s65 offen offset:1024 sc1 lds
s_xor_b32 m0,s91,49152
s_add_u32 s65,s94,768
buffer_load_dwordx4 v42,s[20:23],s65 offen offset:0 sc1 lds
buffer_load_dwordx4 v42,s[20:23],s65 offen offset:1024 sc1 lds
s_waitcnt vmcnt(8)
v_add_u32 v22,s71,-1
buffer_store_dword v22,v23,s[24:27],s97 offen
buffer_store_dword v22,v23,s[28:31],s97 offen sc1
s_mov_b32 s97,0x7fff0000
s_waitcnt vmcnt(8)
s_barrier
ds_read_b128 v[224:227],v17 offset:0
ds_read_b128 v[228:231],v43 offset:0
ds_read_b128 v[232:235],v17 offset:8192
ds_read_b128 v[236:239],v43 offset:8192
ds_read_b128 v[240:243],v17 offset:1024
ds_read_b128 v[244:247],v43 offset:1024
ds_read_b128 v[248:251],v17 offset:9216
s_waitcnt lgkmcnt(5)
v_mfma_f32_16x16x32_bf16 v[64:67],a[0:3],v[224:227],0
s_xor_b32 m0,s91,4096
s_add_u32 s96,s71,1
v_mfma_f32_16x16x32_bf16 v[72:75],a[128:131],v[224:227],0
ds_read_b128 v[252:255],v43 offset:9216
s_add_u32 s92,s71,2
v_mfma_f32_16x16x32_bf16 v[64:67],a[4:7],v[228:231],v[64:67]
s_add_u32 s65,s95,0
v_min_u32 v27,v224,v228
v_mfma_f32_16x16x32_bf16 v[72:75],a[132:135],v[228:231],v[72:75]
s_waitcnt vmcnt(6)
s_barrier
ds_read_b128 v[224:227],v17 offset:16384
s_waitcnt lgkmcnt(5)
v_mfma_f32_16x16x32_bf16 v[64:67],a[8:11],v[232:235],v[64:67]
buffer_load_dwordx4 v42,s[20:23],s65 offen offset:0 sc1 lds
v_mfma_f32_16x16x32_bf16 v[72:75],a[136:139],v[232:235],v[72:75]
ds_read_b128 v[228:231],v43 offset:16384
v_min3_u32 v27,v27,v232,v236
v_mfma_f32_16x16x32_bf16 v[64:67],a[12:15],v[236:239],v[64:67]
buffer_load_dwordx4 v42,s[20:23],s65 offen offset:1024 sc1 lds
v_mfma_f32_16x16x32_bf16 v[72:75],a[140:143],v[236:239],v[72:75]
ds_read_b128 v[232:235],v17 offset:24576
s_waitcnt lgkmcnt(5)
v_mfma_f32_16x16x32_bf16 v[64:67],a[64:67],v[240:243],v[64:67]
s_xor_b32 m0,s91,20480
v_min3_u32 v27,v27,v240,v244
v_mfma_f32_16x16x32_bf16 v[72:75],a[192:195],v[240:243],v[72:75]
ds_read_b128 v[236:239],v43 offset:24576
v_mfma_f32_16x16x32_bf16 v[64:67],a[68:71],v[244:247],v[64:67]
s_add_u32 s65,s95,256
v_mfma_f32_16x16x32_bf16 v[72:75],a[196:199],v[244:247],v[72:75]
ds_read_b128 v[240:243],v17 offset:17408
s_waitcnt lgkmcnt(5)
v_mfma_f32_16x16x32_bf16 v[64:67],a[72:75],v[248:251],v[64:67]
buffer_load_dwordx4 v42,s[20:23],s65 offen offset:0 sc1 lds
v_mfma_f32_16x16x32_bf16 v[72:75],a[200:203],v[248:251],v[72:75]
ds_read_b128 v[244:247],v43 offset:17408
v_min3_u32 v27,v27,v248,v252
v_mfma_f32_16x16x32_bf16 v[64:67],a[76:79],v[252:255],v[64:67]
buffer_load_dwordx4 v42,s[20:23],s65 offen offset:1024 sc1 lds
v_mfma_f32_16x16x32_bf16 v[72:75],a[204:207],v[252:255],v[72:75]
ds_read_b128 v[248:251],v17 offset:25600
s_waitcnt lgkmcnt(5)
v_mfma_f32_16x16x32_bf16 v[64:67],a[16:19],v[224:227],v[64:67]
s_xor_b32 m0,s91,36864
v_min3_u32 v27,v27,v224,v228
v_mfma_f32_16x16x32_bf16 v[72:75],a[144:147],v[224:227],v[72:75]
ds_read_b128 v[252:255],v43 offset:25600
v_mfma_f32_16x16x32_bf16 v[64:67],a[20:23],v[228:231],v[64:67]
s_add_u32 s65,s95,512
v_mfma_f32_16x16x32_bf16 v[72:75],a[148:151],v[228:231],v[72:75]
s_waitcnt vmcnt(6)
s_barrier
ds_read_b128 v[224:227],v17 offset:32768
s_waitcnt lgkmcnt(5)
v_mfma_f32_16x16x32_bf16 v[64:67],a[24:27],v[232:235],v[64:67]
buffer_load_dwordx4 v42,s[20:23],s65 offen offset:0 sc1 lds
v_mfma_f32_16x16x32_bf16 v[72:75],a[152:155],v[232:235],v[72:75]
ds_read_b128 v[228:231],v43 offset:32768
v_min3_u32 v27,v27,v232,v236
v_mfma_f32_16x16x32_bf16 v[64:67],a[28:31],v[236:239],v[64:67]
buffer_load_dwordx4 v42,s[20:23],s65 offen offset:1024 sc1 lds
v_mfma_f32_16x16x32_bf16 v[72:75],a[156:159],v[236:239],v[72:75]
ds_read_b128 v[232:235],v17 offset:40960
s_waitcnt lgkmcnt(5)
v_mfma_f32_16x16x32_bf16 v[64:67],a[80:83],v[240:243],v[64:67]
s_xor_b32 m0,s91,53248
v_min3_u32 v27,v27,v240,v244
v_mfma_f32_16x16x32_bf16 v[72:75],a[208:211],v[240:243],v[72:75]
ds_read_b128 v[236:239],v43 offset:40960
v_mfma_f32_16x16x32_bf16 v[64:67],a[84:87],v[244:247],v[64:67]
s_add_u32 s65,s95,768
v_mfma_f32_16x16x32_bf16 v[72:75],a[212:215],v[244:247],v[72:75]
ds_read_b128 v[240:243],v17 offset:33792
s_waitcnt lgkmcnt(5)
v_mfma_f32_16x16x32_bf16 v[64:67],a[88:91],v[248:251],v[64:67]
buffer_load_dwordx4 v42,s[20:23],s65 offen offset:0 sc1 lds
v_min3_u32 v27,v27,v248,v252
v_mfma_f32_16x16x32_bf16 v[72:75],a[216:219],v[248:251],v[72:75]
ds_read_b128 v[244:247],v43 offset:33792
s_waitcnt vmcnt(63)
v_mfma_f32_16x16x32_bf16 v[64:67],a[92:95],v[252:255],v[64:67]
buffer_load_dwordx4 v42,s[20:23],s65 offen offset:1024 sc1 lds
v_mfma_f32_16x16x32_bf16 v[72:75],a[220:223],v[252:255],v[72:75]
ds_read_b128 v[248:251],v17 offset:41984
s_waitcnt lgkmcnt(5)
v_mfma_f32_16x16x32_bf16 v[64:67],a[32:35],v[224:227],v[64:67]
v_cmp_gt_u32 vcc,s96,v29
v_cmp_gt_u32 s[92:93],s92,v29
v_mfma_f32_16x16x32_bf16 v[72:75],a[160:163],v[224:227],v[72:75]
ds_read_b128 v[252:255],v43 offset:41984
v_min3_u32 v27,v27,v224,v228
v_mfma_f32_16x16x32_bf16 v[64:67],a[36:39],v[228:231],v[64:67]
v_mov_b32 v44,vcc_lo
v_mov_b32 v45,s92
v_mfma_f32_16x16x32_bf16 v[72:75],a[164:167],v[228:231],v[72:75]
ds_read_b128 v[224:227],v17 offset:49152
s_waitcnt lgkmcnt(5)
v_mfma_f32_16x16x32_bf16 v[64:67],a[40:43],v[232:235],v[64:67]
ds_write_b64 v46,v[44:45]
v_min3_u32 v27,v27,v232,v236
v_mfma_f32_16x16x32_bf16 v[72:75],a[168:171],v[232:235],v[72:75]
ds_read_b128 v[228:231],v43 offset:49152
v_mfma_f32_16x16x32_bf16 v[64:67],a[44:47],v[236:239],v[64:67]
v_mfma_f32_16x16x32_bf16 v[72:75],a[172:175],v[236:239],v[72:75]
ds_read_b128 v[232:235],v17 offset:57344
s_waitcnt lgkmcnt(6)
v_mfma_f32_16x16x32_bf16 v[64:67],a[96:99],v[240:243],v[64:67]
v_min3_u32 v27,v27,v240,v244
s_add_u32 s88,s70,s75
v_mfma_f32_16x16x32_bf16 v[72:75],a[224:227],v[240:243],v[72:75]
ds_read_b128 v[236:239],v43 offset:57344
s_add_u32 s88,s88,2097152
v_mfma_f32_16x16x32_bf16 v[64:67],a[100:103],v[244:247],v[64:67]
s_xor_b32 s88,s88,0x2000
s_add_u32 s89,s88,65536
v_mfma_f32_16x16x32_bf16 v[72:75],a[228:231],v[244:247],v[72:75]
ds_read_b128 v[240:243],v17 offset:50176
s_waitcnt lgkmcnt(6)
v_mfma_f32_16x16x32_bf16 v[64:67],a[104:107],v[248:251],v[64:67]
v_min3_u32 v27,v27,v248,v252
v_mfma_f32_16x16x32_bf16 v[72:75],a[232:235],v[248:251],v[72:75]
ds_read_b128 v[244:247],v43 offset:50176
v_mfma_f32_16x16x32_bf16 v[64:67],a[108:111],v[252:255],v[64:67]
v_mfma_f32_16x16x32_bf16 v[72:75],a[236:239],v[252:255],v[72:75]
ds_read_b128 v[248:251],v17 offset:58368
s_waitcnt lgkmcnt(5)
v_mfma_f32_16x16x32_bf16 v[64:67],a[48:51],v[224:227],v[64:67]
v_min3_u32 v27,v27,v224,v228
v_mfma_f32_16x16x32_bf16 v[72:75],a[176:179],v[224:227],v[72:75]
ds_read_b128 v[252:255],v43 offset:58368
v_mfma_f32_16x16x32_bf16 v[64:67],a[52:55],v[228:231],v[64:67]
v_mfma_f32_16x16x32_bf16 v[72:75],a[180:183],v[228:231],v[72:75]
s_waitcnt vmcnt(4)
s_barrier
ds_read_b64 v[44:45],v47
ds_read_b128 v[224:227],v17 offset:4096
s_waitcnt lgkmcnt(6)
v_mfma_f32_16x16x32_bf16 v[64:67],a[56:59],v[232:235],v[64:67]
v_min3_u32 v27,v27,v232,v236
v_mfma_f32_16x16x32_bf16 v[72:75],a[184:187],v[232:235],v[72:75]
ds_read_b128 v[228:231],v43 offset:4096
v_mfma_f32_16x16x32_bf16 v[64:67],a[60:63],v[236:239],v[64:67]
v_mfma_f32_16x16x32_bf16 v[72:75],a[188:191],v[236:239],v[72:75]
ds_read_b128 v[232:235],v17 offset:12288
s_waitcnt lgkmcnt(6)
v_mfma_f32_16x16x32_bf16 v[64:67],a[112:115],v[240:243],v[64:67]
v_min3_u32 v27,v27,v240,v244
v_mfma_f32_16x16x32_bf16 v[72:75],a[240:243],v[240:243],v[72:75]
ds_read_b128 v[236:239],v43 offset:12288
v_mfma_f32_16x16x32_bf16 v[64:67],a[116:119],v[244:247],v[64:67]
v_mfma_f32_16x16x32_bf16 v[72:75],a[244:247],v[244:247],v[72:75]
ds_read_b128 v[240:243],v17 offset:5120
s_waitcnt lgkmcnt(6)
v_mfma_f32_16x16x32_bf16 v[64:67],a[120:123],v[248:251],v[64:67]
s_waitcnt lgkmcnt(5)
v_readfirstlane_b32 s93,v45
v_mfma_f32_16x16x32_bf16 v[72:75],a[248:251],v[248:251],v[72:75]
ds_read_b128 v[244:247],v43 offset:5120
v_readfirstlane_b32 s83,v44
s_cmp_lg_u32 s83,0
s_cbranch_scc0 keep_233
v_mfma_f32_16x16x32_bf16 v[64:67],a[124:127],v[252:255],v[64:67]
v_min3_u32 v27,v27,v248,v252
v_mfma_f32_16x16x32_bf16 v[72:75],a[252:255],v[252:255],v[72:75]
ds_read_b128 v[248:251],v17 offset:13312
s_waitcnt lgkmcnt(5)
v_mfma_f32_16x16x32_bf16 v[68:71],a[0:3],v[224:227],0
v_cmp_eq_u32 vcc,0,v27
s_cbranch_vccnz retry_222
v_mfma_f32_16x16x32_bf16 v[76:79],a[128:131],v[224:227],0
ds_read_b128 v[252:255],v43 offset:13312
v_min3_u32 v27,v27,v224,v228
v_mfma_f32_16x16x32_bf16 v[68:71],a[4:7],v[228:231],v[68:71]
v_mfma_f32_16x16x32_bf16 v[76:79],a[132:135],v[228:231],v[76:79]
ds_read_b128 v[224:227],v17 offset:20480
s_waitcnt lgkmcnt(5)
v_mfma_f32_16x16x32_bf16 v[68:71],a[8:11],v[232:235],v[68:71]
v_min3_u32 v27,v27,v232,v236
v_mul_f32 v88,v64,v64
v_mul_f32 v92,v72,v72
v_mfma_f32_16x16x32_bf16 v[76:79],a[136:139],v[232:235],v[76:79]
ds_read_b128 v[228:231],v43 offset:20480
v_mul_f32 v89,v65,v65
v_mul_f32 v93,v73,v73
v_mfma_f32_16x16x32_bf16 v[68:71],a[12:15],v[236:239],v[68:71]
v_mul_f32 v90,v66,v66
v_mul_f32 v91,v67,v67
v_mul_f32 v94,v74,v74
v_mfma_f32_16x16x32_bf16 v[76:79],a[140:143],v[236:239],v[76:79]
ds_read_b128 v[232:235],v17 offset:28672
v_mul_f32 v95,v75,v75
s_waitcnt lgkmcnt(5)
v_mfma_f32_16x16x32_bf16 v[68:71],a[64:67],v[240:243],v[68:71]
v_min3_u32 v27,v27,v240,v244
v_fma_f32 v88,v88,s81,v28
v_fma_f32 v92,v92,s81,v28
v_mfma_f32_16x16x32_bf16 v[76:79],a[192:195],v[240:243],v[76:79]
ds_read_b128 v[236:239],v43 offset:28672
v_fma_f32 v89,v89,s81,v28
v_fma_f32 v93,v93,s81,v28
v_mfma_f32_16x16x32_bf16 v[68:71],a[68:71],v[244:247],v[68:71]
v_fma_f32 v90,v90,s81,v28
v_fma_f32 v91,v91,s81,v28
v_fma_f32 v94,v94,s81,v28
v_mfma_f32_16x16x32_bf16 v[76:79],a[196:199],v[244:247],v[76:79]
ds_read_b128 v[240:243],v17 offset:21504
v_fma_f32 v95,v95,s81,v28
s_waitcnt lgkmcnt(5)
v_mfma_f32_16x16x32_bf16 v[68:71],a[72:75],v[248:251],v[68:71]
v_min3_u32 v27,v27,v248,v252
v_mul_f32 v88,v88,v64
v_mul_f32 v92,v92,v72
v_mfma_f32_16x16x32_bf16 v[76:79],a[200:203],v[248:251],v[76:79]
ds_read_b128 v[244:247],v43 offset:21504
v_mul_f32 v89,v89,v65
v_mul_f32 v93,v93,v73
v_mfma_f32_16x16x32_bf16 v[68:71],a[76:79],v[252:255],v[68:71]
v_mul_f32 v90,v90,v66
v_mul_f32 v91,v91,v67
v_mul_f32 v94,v94,v74
v_mfma_f32_16x16x32_bf16 v[76:79],a[204:207],v[252:255],v[76:79]
ds_read_b128 v[248:251],v17 offset:29696
v_mul_f32 v95,v95,v75
s_waitcnt lgkmcnt(5)
v_mfma_f32_16x16x32_bf16 v[68:71],a[16:19],v[224:227],v[68:71]
v_min3_u32 v27,v27,v224,v228
v_exp_f32 v92,v92
v_mfma_f32_16x16x32_bf16 v[76:79],a[144:147],v[224:227],v[76:79]
ds_read_b128 v[252:255],v43 offset:29696
v_exp_f32 v93,v93
v_mfma_f32_16x16x32_bf16 v[68:71],a[20:23],v[228:231],v[68:71]
v_exp_f32 v88,v88
v_mfma_f32_16x16x32_bf16 v[76:79],a[148:151],v[228:231],v[76:79]
s_waitcnt vmcnt(0)
s_barrier
ds_read_b128 v[224:227],v17 offset:36864
s_waitcnt lgkmcnt(5)
v_mfma_f32_16x16x32_bf16 v[68:71],a[24:27],v[232:235],v[68:71]
v_min3_u32 v27,v27,v232,v236
v_exp_f32 v94,v94
v_mfma_f32_16x16x32_bf16 v[76:79],a[152:155],v[232:235],v[76:79]
ds_read_b128 v[228:231],v43 offset:36864
v_exp_f32 v95,v95
v_mfma_f32_16x16x32_bf16 v[68:71],a[28:31],v[236:239],v[68:71]
v_exp_f32 v89,v89
v_add_f32 v92,1.0,v92
v_mfma_f32_16x16x32_bf16 v[76:79],a[156:159],v[236:239],v[76:79]
ds_read_b128 v[232:235],v17 offset:45056
v_add_f32 v93,1.0,v93
s_waitcnt lgkmcnt(5)
v_mfma_f32_16x16x32_bf16 v[68:71],a[80:83],v[240:243],v[68:71]
v_min3_u32 v27,v27,v240,v244
v_add_f32 v94,1.0,v94
v_add_f32 v95,1.0,v95
v_mfma_f32_16x16x32_bf16 v[76:79],a[208:211],v[240:243],v[76:79]
ds_read_b128 v[236:239],v43 offset:45056
v_rcp_f32 v92,v92
v_mfma_f32_16x16x32_bf16 v[68:71],a[84:87],v[244:247],v[68:71]
v_exp_f32 v90,v90
v_mfma_f32_16x16x32_bf16 v[76:79],a[212:215],v[244:247],v[76:79]
ds_read_b128 v[240:243],v17 offset:37888
s_waitcnt lgkmcnt(5)
v_mfma_f32_16x16x32_bf16 v[68:71],a[88:91],v[248:251],v[68:71]
v_min3_u32 v27,v27,v248,v252
v_rcp_f32 v93,v93
v_mfma_f32_16x16x32_bf16 v[76:79],a[216:219],v[248:251],v[76:79]
ds_read_b128 v[244:247],v43 offset:37888
v_rcp_f32 v94,v94
v_mfma_f32_16x16x32_bf16 v[68:71],a[92:95],v[252:255],v[68:71]
v_exp_f32 v91,v91
v_mfma_f32_16x16x32_bf16 v[76:79],a[220:223],v[252:255],v[76:79]
ds_read_b128 v[248:251],v17 offset:46080
s_waitcnt lgkmcnt(5)
v_mfma_f32_16x16x32_bf16 v[68:71],a[32:35],v[224:227],v[68:71]
v_min3_u32 v27,v27,v224,v228
v_add_f32 v88,1.0,v88
v_mfma_f32_16x16x32_bf16 v[76:79],a[160:163],v[224:227],v[76:79]
ds_read_b128 v[252:255],v43 offset:46080
v_add_f32 v89,1.0,v89
v_mfma_f32_16x16x32_bf16 v[68:71],a[36:39],v[228:231],v[68:71]
v_add_f32 v90,1.0,v90
v_add_f32 v91,1.0,v91
v_mfma_f32_16x16x32_bf16 v[76:79],a[164:167],v[228:231],v[76:79]
ds_read_b128 v[224:227],v17 offset:53248
s_waitcnt lgkmcnt(5)
v_mfma_f32_16x16x32_bf16 v[68:71],a[40:43],v[232:235],v[68:71]
v_min3_u32 v27,v27,v232,v236
v_mfma_f32_16x16x32_bf16 v[76:79],a[168:171],v[232:235],v[76:79]
ds_read_b128 v[228:231],v43 offset:53248
v_mfma_f32_16x16x32_bf16 v[68:71],a[44:47],v[236:239],v[68:71]
v_rcp_f32 v88,v88
v_mfma_f32_16x16x32_bf16 v[76:79],a[172:175],v[236:239],v[76:79]
ds_read_b128 v[232:235],v17 offset:61440
s_waitcnt lgkmcnt(5)
v_mfma_f32_16x16x32_bf16 v[68:71],a[96:99],v[240:243],v[68:71]
v_min3_u32 v27,v27,v240,v244
v_mfma_f32_16x16x32_bf16 v[76:79],a[224:227],v[240:243],v[76:79]
ds_read_b128 v[236:239],v43 offset:61440
v_mfma_f32_16x16x32_bf16 v[68:71],a[100:103],v[244:247],v[68:71]
v_rcp_f32 v89,v89
v_mfma_f32_16x16x32_bf16 v[76:79],a[228:231],v[244:247],v[76:79]
ds_read_b128 v[240:243],v17 offset:54272
s_waitcnt lgkmcnt(5)
v_mfma_f32_16x16x32_bf16 v[68:71],a[104:107],v[248:251],v[68:71]
v_min3_u32 v27,v27,v248,v252
v_mfma_f32_16x16x32_bf16 v[76:79],a[232:235],v[248:251],v[76:79]
ds_read_b128 v[244:247],v43 offset:54272
v_mfma_f32_16x16x32_bf16 v[68:71],a[108:111],v[252:255],v[68:71]
v_rcp_f32 v90,v90
v_mfma_f32_16x16x32_bf16 v[76:79],a[236:239],v[252:255],v[76:79]
ds_read_b128 v[248:251],v17 offset:62464
s_waitcnt lgkmcnt(5)
v_mfma_f32_16x16x32_bf16 v[68:71],a[48:51],v[224:227],v[68:71]
v_min3_u32 v27,v27,v224,v228
v_mfma_f32_16x16x32_bf16 v[76:79],a[176:179],v[224:227],v[76:79]
ds_read_b128 v[252:255],v43 offset:62464
v_mfma_f32_16x16x32_bf16 v[68:71],a[52:55],v[228:231],v[68:71]
v_rcp_f32 v91,v91
v_mfma_f32_16x16x32_bf16 v[76:79],a[180:183],v[228:231],v[76:79]
v_mul_f32 v88,v88,v64
s_waitcnt lgkmcnt(4)
v_mfma_f32_16x16x32_bf16 v[68:71],a[56:59],v[232:235],v[68:71]
v_min3_u32 v27,v27,v232,v236
v_mul_f32 v89,v89,v65
v_mfma_f32_16x16x32_bf16 v[76:79],a[184:187],v[232:235],v[76:79]
v_mul_f32 v90,v90,v66
v_mul_f32 v91,v91,v67
v_mfma_f32_16x16x32_bf16 v[68:71],a[60:63],v[236:239],v[68:71]
v_rcp_f32 v95,v95
v_mfma_f32_16x16x32_bf16 v[76:79],a[188:191],v[236:239],v[76:79]
v_mul_f32 v92,v92,v72
s_waitcnt lgkmcnt(2)
v_mfma_f32_16x16x32_bf16 v[68:71],a[112:115],v[240:243],v[68:71]
v_min3_u32 v27,v27,v240,v244
v_mul_f32 v93,v93,v73
v_mfma_f32_16x16x32_bf16 v[76:79],a[240:243],v[240:243],v[76:79]
v_mul_f32 v94,v94,v74
v_mul_f32 v95,v95,v75
v_mfma_f32_16x16x32_bf16 v[68:71],a[116:119],v[244:247],v[68:71]
v_cvt_pk_bf16_f32 v96,v88,v89
v_cvt_pk_bf16_f32 v97,v90,v91
v_mfma_f32_16x16x32_bf16 v[76:79],a[244:247],v[244:247],v[76:79]
v_cvt_pk_bf16_f32 v98,v92,v93
s_waitcnt lgkmcnt(0)
v_mfma_f32_16x16x32_bf16 v[68:71],a[120:123],v[248:251],v[68:71]
v_min3_u32 v27,v27,v248,v252
v_cvt_pk_bf16_f32 v99,v94,v95
v_mfma_f32_16x16x32_bf16 v[76:79],a[248:251],v[248:251],v[76:79]
v_max_u32 v96,1,v96
v_mfma_f32_16x16x32_bf16 v[68:71],a[124:127],v[252:255],v[68:71]
buffer_store_dwordx4 v[96:99],v18,s[20:23],s78 offen sc1
v_mfma_f32_16x16x32_bf16 v[76:79],a[252:255],v[252:255],v[76:79]
v_cmp_eq_u32 vcc,0,v27
s_cbranch_vccnz retry_222
s_branch epi_225
keep_233:
v_mfma_f32_16x16x32_bf16 v[64:67],a[124:127],v[252:255],v[64:67]
v_min3_u32 v27,v27,v248,v252
s_xor_b32 m0,s72,0
v_mfma_f32_16x16x32_bf16 v[72:75],a[252:255],v[252:255],v[72:75]
ds_read_b128 v[248:251],v17 offset:13312
s_add_u32 s65,s88,0
s_waitcnt lgkmcnt(5)
v_mfma_f32_16x16x32_bf16 v[68:71],a[0:3],v[224:227],0
buffer_load_dwordx4 v42,s[20:23],s65 offen offset:0 sc1 lds
v_min3_u32 v27,v27,v224,v228
v_mfma_f32_16x16x32_bf16 v[76:79],a[128:131],v[224:227],0
ds_read_b128 v[252:255],v43 offset:13312
buffer_load_dwordx4 v42,s[20:23],s65 offen offset:1024 sc1 lds
v_mfma_f32_16x16x32_bf16 v[68:71],a[4:7],v[228:231],v[68:71]
v_cmp_eq_u32 vcc,0,v27
s_cbranch_vccnz retry_222
v_mfma_f32_16x16x32_bf16 v[76:79],a[132:135],v[228:231],v[76:79]
ds_read_b128 v[224:227],v17 offset:20480
s_xor_b32 m0,s72,16384
s_waitcnt lgkmcnt(5)
v_mfma_f32_16x16x32_bf16 v[68:71],a[8:11],v[232:235],v[68:71]
s_add_u32 s65,s88,256
v_min3_u32 v27,v27,v232,v236
v_mul_f32 v88,v64,v64
v_mul_f32 v92,v72,v72
v_mfma_f32_16x16x32_bf16 v[76:79],a[136:139],v[232:235],v[76:79]
ds_read_b128 v[228:231],v43 offset:20480
buffer_load_dwordx4 v42,s[20:23],s65 offen offset:0 sc1 lds
v_mul_f32 v93,v73,v73
v_mfma_f32_16x16x32_bf16 v[68:71],a[12:15],v[236:239],v[68:71]
v_mul_f32 v89,v65,v65
v_mul_f32 v90,v66,v66
v_mul_f32 v91,v67,v67
v_mul_f32 v94,v74,v74
v_mfma_f32_16x16x32_bf16 v[76:79],a[140:143],v[236:239],v[76:79]
ds_read_b128 v[232:235],v17 offset:28672
v_fma_f32 v88,v88,s81,v28
v_mul_f32 v95,v75,v75
s_waitcnt lgkmcnt(5)
v_mfma_f32_16x16x32_bf16 v[68:71],a[64:67],v[240:243],v[68:71]
buffer_load_dwordx4 v42,s[20:23],s65 offen offset:1024 sc1 lds
s_xor_b32 m0,s72,32768
v_fma_f32 v92,v92,s81,v28
v_mfma_f32_16x16x32_bf16 v[76:79],a[192:195],v[240:243],v[76:79]
ds_read_b128 v[236:239],v43 offset:28672
s_add_u32 s65,s88,512
v_fma_f32 v89,v89,s81,v28
v_fma_f32 v93,v93,s81,v28
v_mfma_f32_16x16x32_bf16 v[68:71],a[68:71],v[244:247],v[68:71]
v_min3_u32 v27,v27,v240,v244
v_fma_f32 v90,v90,s81,v28
v_fma_f32 v91,v91,s81,v28
v_fma_f32 v94,v94,s81,v28
v_mfma_f32_16x16x32_bf16 v[76:79],a[196:199],v[244:247],v[76:79]
ds_read_b128 v[240:243],v17 offset:21504
v_mul_f32 v88,v88,v64
v_fma_f32 v95,v95,s81,v28
s_waitcnt lgkmcnt(5)
v_mfma_f32_16x16x32_bf16 v[68:71],a[72:75],v[248:251],v[68:71]
buffer_load_dwordx4 v42,s[20:23],s65 offen offset:0 sc1 lds
v_mul_f32 v89,v89,v65
v_mul_f32 v92,v92,v72
v_mfma_f32_16x16x32_bf16 v[76:79],a[200:203],v[248:251],v[76:79]
ds_read_b128 v[244:247],v43 offset:21504
buffer_load_dwordx4 v42,s[20:23],s65 offen offset:1024 sc1 lds
v_mul_f32 v93,v93,v73
v_mfma_f32_16x16x32_bf16 v[68:71],a[76:79],v[252:255],v[68:71]
s_xor_b32 m0,s72,49152
v_min3_u32 v27,v27,v248,v252
v_mul_f32 v90,v90,v66
v_mul_f32 v94,v94,v74
v_mfma_f32_16x16x32_bf16 v[76:79],a[204:207],v[252:255],v[76:79]
ds_read_b128 v[248:251],v17 offset:29696
s_add_u32 s65,s88,768
v_mul_f32 v95,v95,v75
s_waitcnt lgkmcnt(5)
v_mfma_f32_16x16x32_bf16 v[68:71],a[16:19],v[224:227],v[68:71]
buffer_load_dwordx4 v42,s[20:23],s65 offen offset:0 sc1 lds
v_mul_f32 v91,v91,v67
v_mfma_f32_16x16x32_bf16 v[76:79],a[144:147],v[224:227],v[76:79]
ds_read_b128 v[252:255],v43 offset:29696
v_min3_u32 v27,v27,v224,v228
v_exp_f32 v92,v92
v_mfma_f32_16x16x32_bf16 v[68:71],a[20:23],v[228:231],v[68:71]
buffer_load_dwordx4 v42,s[20:23],s65 offen offset:1024 sc1 lds
v_exp_f32 v93,v93
v_mfma_f32_16x16x32_bf16 v[76:79],a[148:151],v[228:231],v[76:79]
s_waitcnt vmcnt(8)
s_barrier
ds_read_b128 v[224:227],v17 offset:36864
s_waitcnt lgkmcnt(5)
v_mfma_f32_16x16x32_bf16 v[68:71],a[24:27],v[232:235],v[68:71]
s_xor_b32 m0,s72,4096
s_add_u32 s65,s89,0
v_exp_f32 v94,v94
v_mfma_f32_16x16x32_bf16 v[76:79],a[152:155],v[232:235],v[76:79]
ds_read_b128 v[228:231],v43 offset:36864
v_min3_u32 v27,v27,v232,v236
v_exp_f32 v95,v95
v_mfma_f32_16x16x32_bf16 v[68:71],a[28:31],v[236:239],v[68:71]
buffer_load_dwordx4 v42,s[20:23],s65 offen offset:0 sc1 lds
v_add_f32 v92,1.0,v92
v_add_f32 v93,1.0,v93
v_mfma_f32_16x16x32_bf16 v[76:79],a[156:159],v[236:239],v[76:79]
ds_read_b128 v[232:235],v17 offset:45056
v_add_f32 v94,1.0,v94
v_add_f32 v95,1.0,v95
s_waitcnt lgkmcnt(5)
v_mfma_f32_16x16x32_bf16 v[68:71],a[80:83],v[240:243],v[68:71]
buffer_load_dwordx4 v42,s[20:23],s65 offen offset:1024 sc1 lds
v_rcp_f32 v92,v92
v_mfma_f32_16x16x32_bf16 v[76:79],a[208:211],v[240:243],v[76:79]
ds_read_b128 v[236:239],v43 offset:45056
s_xor_b32 m0,s72,20480
v_rcp_f32 v93,v93
v_mfma_f32_16x16x32_bf16 v[68:71],a[84:87],v[244:247],v[68:71]
s_add_u32 s65,s89,256
v_min3_u32 v27,v27,v240,v244
v_rcp_f32 v94,v94
v_mfma_f32_16x16x32_bf16 v[76:79],a[212:215],v[244:247],v[76:79]
ds_read_b128 v[240:243],v17 offset:37888
v_rcp_f32 v95,v95
s_waitcnt lgkmcnt(5)
v_mfma_f32_16x16x32_bf16 v[68:71],a[88:91],v[248:251],v[68:71]
buffer_load_dwordx4 v42,s[20:23],s65 offen offset:0 sc1 lds
v_mul_f32 v92,v92,v72
v_mul_f32 v93,v93,v73
v_mfma_f32_16x16x32_bf16 v[76:79],a[216:219],v[248:251],v[76:79]
ds_read_b128 v[244:247],v43 offset:37888
v_min3_u32 v27,v27,v248,v252
v_mfma_f32_16x16x32_bf16 v[68:71],a[92:95],v[252:255],v[68:71]
buffer_load_dwordx4 v42,s[20:23],s65 offen offset:1024 sc1 lds
v_mfma_f32_16x16x32_bf16 v[76:79],a[220:223],v[252:255],v[76:79]
ds_read_b128 v[248:251],v17 offset:46080
s_waitcnt lgkmcnt(5)
v_mfma_f32_16x16x32_bf16 v[68:71],a[32:35],v[224:227],v[68:71]
s_xor_b32 m0,s72,36864
s_add_u32 s65,s89,512
v_mfma_f32_16x16x32_bf16 v[76:79],a[160:163],v[224:227],v[76:79]
ds_read_b128 v[252:255],v43 offset:46080
v_min3_u32 v27,v27,v224,v228
v_mfma_f32_16x16x32_bf16 v[68:71],a[36:39],v[228:231],v[68:71]
buffer_load_dwordx4 v42,s[20:23],s65 offen offset:0 sc1 lds
v_mfma_f32_16x16x32_bf16 v[76:79],a[164:167],v[228:231],v[76:79]
ds_read_b128 v[224:227],v17 offset:53248
s_waitcnt lgkmcnt(5)
v_mfma_f32_16x16x32_bf16 v[68:71],a[40:43],v[232:235],v[68:71]
buffer_load_dwordx4 v42,s[20:23],s65 offen offset:1024 sc1 lds
v_mfma_f32_16x16x32_bf16 v[76:79],a[168:171],v[232:235],v[76:79]
ds_read_b128 v[228:231],v43 offset:53248
s_xor_b32 m0,s72,53248
v_mfma_f32_16x16x32_bf16 v[68:71],a[44:47],v[236:239],v[68:71]
s_add_u32 s65,s89,768
v_min3_u32 v27,v27,v232,v236
v_mfma_f32_16x16x32_bf16 v[76:79],a[172:175],v[236:239],v[76:79]
ds_read_b128 v[232:235],v17 offset:61440
s_waitcnt lgkmcnt(5)
v_mfma_f32_16x16x32_bf16 v[68:71],a[96:99],v[240:243],v[68:71]
buffer_load_dwordx4 v42,s[20:23],s65 offen offset:0 sc1 lds
v_mfma_f32_16x16x32_bf16 v[76:79],a[224:227],v[240:243],v[76:79]
ds_read_b128 v[236:239],v43 offset:61440
v_min3_u32 v27,v27,v240,v244
v_mfma_f32_16x16x32_bf16 v[68:71],a[100:103],v[244:247],v[68:71]
buffer_load_dwordx4 v42,s[20:23],s65 offen offset:1024 sc1 lds
v_mfma_f32_16x16x32_bf16 v[76:79],a[228:231],v[244:247],v[76:79]
ds_read_b128 v[240:243],v17 offset:54272
s_waitcnt lgkmcnt(5)
v_mfma_f32_16x16x32_bf16 v[68:71],a[104:107],v[248:251],v[68:71]
v_min3_u32 v27,v27,v248,v252
v_exp_f32 v88,v88
v_mfma_f32_16x16x32_bf16 v[76:79],a[232:235],v[248:251],v[76:79]
ds_read_b128 v[244:247],v43 offset:54272
v_exp_f32 v89,v89
v_mfma_f32_16x16x32_bf16 v[68:71],a[108:111],v[252:255],v[68:71]
v_exp_f32 v90,v90
v_mfma_f32_16x16x32_bf16 v[76:79],a[236:239],v[252:255],v[76:79]
ds_read_b128 v[248:251],v17 offset:62464
s_waitcnt lgkmcnt(5)
v_mfma_f32_16x16x32_bf16 v[68:71],a[48:51],v[224:227],v[68:71]
v_min3_u32 v27,v27,v224,v228
v_exp_f32 v91,v91
v_mfma_f32_16x16x32_bf16 v[76:79],a[176:179],v[224:227],v[76:79]
ds_read_b128 v[252:255],v43 offset:62464
v_add_f32 v88,1.0,v88
v_add_f32 v89,1.0,v89
v_mfma_f32_16x16x32_bf16 v[68:71],a[52:55],v[228:231],v[68:71]
v_add_f32 v90,1.0,v90
v_add_f32 v91,1.0,v91
v_mfma_f32_16x16x32_bf16 v[76:79],a[180:183],v[228:231],v[76:79]
v_rcp_f32 v88,v88
s_waitcnt lgkmcnt(4)
v_mfma_f32_16x16x32_bf16 v[68:71],a[56:59],v[232:235],v[68:71]
v_min3_u32 v27,v27,v232,v236
v_rcp_f32 v89,v89
v_mfma_f32_16x16x32_bf16 v[76:79],a[184:187],v[232:235],v[76:79]
v_rcp_f32 v90,v90
v_mfma_f32_16x16x32_bf16 v[68:71],a[60:63],v[236:239],v[68:71]
v_rcp_f32 v91,v91
v_mfma_f32_16x16x32_bf16 v[76:79],a[188:191],v[236:239],v[76:79]
v_mul_f32 v88,v88,v64
s_waitcnt lgkmcnt(2)
v_mfma_f32_16x16x32_bf16 v[68:71],a[112:115],v[240:243],v[68:71]
v_min3_u32 v27,v27,v240,v244
v_mul_f32 v89,v89,v65
v_mfma_f32_16x16x32_bf16 v[76:79],a[240:243],v[240:243],v[76:79]
v_mul_f32 v90,v90,v66
v_mul_f32 v91,v91,v67
v_mfma_f32_16x16x32_bf16 v[68:71],a[116:119],v[244:247],v[68:71]
v_mul_f32 v94,v94,v74
v_mul_f32 v95,v95,v75
v_mfma_f32_16x16x32_bf16 v[76:79],a[244:247],v[244:247],v[76:79]
v_cvt_pk_bf16_f32 v96,v88,v89
s_waitcnt lgkmcnt(0)
v_mfma_f32_16x16x32_bf16 v[68:71],a[120:123],v[248:251],v[68:71]
v_min3_u32 v27,v27,v248,v252
v_cvt_pk_bf16_f32 v97,v90,v91
v_mfma_f32_16x16x32_bf16 v[76:79],a[248:251],v[248:251],v[76:79]
v_cvt_pk_bf16_f32 v98,v92,v93
v_cvt_pk_bf16_f32 v99,v94,v95
v_mfma_f32_16x16x32_bf16 v[68:71],a[124:127],v[252:255],v[68:71]
v_max_u32 v96,1,v96
v_mfma_f32_16x16x32_bf16 v[76:79],a[252:255],v[252:255],v[76:79]
buffer_store_dwordx4 v[96:99],v18,s[20:23],s78 offen sc1
v_cmp_eq_u32 vcc,0,v27
s_cbranch_vccnz retry_222
s_branch epi_225
ahead_224:
s_cmp_eq_u32 s93,0
s_cbranch_scc1 both_226
s_waitcnt vmcnt(13) lgkmcnt(0)
s_barrier
ds_read_b128 v[224:227],v17 offset:0
ds_read_b128 v[228:231],v43 offset:0
ds_read_b128 v[232:235],v17 offset:8192
ds_read_b128 v[236:239],v43 offset:8192
ds_read_b128 v[240:243],v17 offset:1024
ds_read_b128 v[244:247],v43 offset:1024
ds_read_b128 v[248:251],v17 offset:9216
s_waitcnt lgkmcnt(5)
v_mfma_f32_16x16x32_bf16 v[64:67],a[0:3],v[224:227],0
s_add_u32 s96,s71,1
s_add_u32 s92,s71,2
v_mfma_f32_16x16x32_bf16 v[72:75],a[128:131],v[224:227],0
ds_read_b128 v[252:255],v43 offset:9216
v_min_u32 v27,v224,v228
v_mfma_f32_16x16x32_bf16 v[64:67],a[4:7],v[228:231],v[64:67]
v_mfma_f32_16x16x32_bf16 v[72:75],a[132:135],v[228:231],v[72:75]
ds_read_b128 v[224:227],v17 offset:16384
s_waitcnt lgkmcnt(5)
v_mfma_f32_16x16x32_bf16 v[64:67],a[8:11],v[232:235],v[64:67]
v_min3_u32 v27,v27,v232,v236
v_mfma_f32_16x16x32_bf16 v[72:75],a[136:139],v[232:235],v[72:75]
ds_read_b128 v[228:231],v43 offset:16384
v_mfma_f32_16x16x32_bf16 v[64:67],a[12:15],v[236:239],v[64:67]
v_mfma_f32_16x16x32_bf16 v[72:75],a[140:143],v[236:239],v[72:75]
ds_read_b128 v[232:235],v17 offset:24576
s_waitcnt lgkmcnt(5)
v_mfma_f32_16x16x32_bf16 v[64:67],a[64:67],v[240:243],v[64:67]
v_min3_u32 v27,v27,v240,v244
v_mfma_f32_16x16x32_bf16 v[72:75],a[192:195],v[240:243],v[72:75]
ds_read_b128 v[236:239],v43 offset:24576
v_mfma_f32_16x16x32_bf16 v[64:67],a[68:71],v[244:247],v[64:67]
v_mfma_f32_16x16x32_bf16 v[72:75],a[196:199],v[244:247],v[72:75]
ds_read_b128 v[240:243],v17 offset:17408
s_waitcnt lgkmcnt(5)
v_mfma_f32_16x16x32_bf16 v[64:67],a[72:75],v[248:251],v[64:67]
v_min3_u32 v27,v27,v248,v252
v_mfma_f32_16x16x32_bf16 v[72:75],a[200:203],v[248:251],v[72:75]
ds_read_b128 v[244:247],v43 offset:17408
v_mfma_f32_16x16x32_bf16 v[64:67],a[76:79],v[252:255],v[64:67]
v_mfma_f32_16x16x32_bf16 v[72:75],a[204:207],v[252:255],v[72:75]
ds_read_b128 v[248:251],v17 offset:25600
s_waitcnt lgkmcnt(5)
v_mfma_f32_16x16x32_bf16 v[64:67],a[16:19],v[224:227],v[64:67]
v_min3_u32 v27,v27,v224,v228
v_mfma_f32_16x16x32_bf16 v[72:75],a[144:147],v[224:227],v[72:75]
ds_read_b128 v[252:255],v43 offset:25600
v_mfma_f32_16x16x32_bf16 v[64:67],a[20:23],v[228:231],v[64:67]
v_mfma_f32_16x16x32_bf16 v[72:75],a[148:151],v[228:231],v[72:75]
ds_read_b128 v[224:227],v17 offset:32768
s_waitcnt lgkmcnt(5)
v_mfma_f32_16x16x32_bf16 v[64:67],a[24:27],v[232:235],v[64:67]
v_min3_u32 v27,v27,v232,v236
v_mfma_f32_16x16x32_bf16 v[72:75],a[152:155],v[232:235],v[72:75]
ds_read_b128 v[228:231],v43 offset:32768
v_mfma_f32_16x16x32_bf16 v[64:67],a[28:31],v[236:239],v[64:67]
v_mfma_f32_16x16x32_bf16 v[72:75],a[156:159],v[236:239],v[72:75]
ds_read_b128 v[232:235],v17 offset:40960
s_waitcnt lgkmcnt(5)
v_mfma_f32_16x16x32_bf16 v[64:67],a[80:83],v[240:243],v[64:67]
v_min3_u32 v27,v27,v240,v244
v_mfma_f32_16x16x32_bf16 v[72:75],a[208:211],v[240:243],v[72:75]
ds_read_b128 v[236:239],v43 offset:40960
v_mfma_f32_16x16x32_bf16 v[64:67],a[84:87],v[244:247],v[64:67]
v_mfma_f32_16x16x32_bf16 v[72:75],a[212:215],v[244:247],v[72:75]
ds_read_b128 v[240:243],v17 offset:33792
s_waitcnt lgkmcnt(5)
v_mfma_f32_16x16x32_bf16 v[64:67],a[88:91],v[248:251],v[64:67]
v_min3_u32 v27,v27,v248,v252
v_mfma_f32_16x16x32_bf16 v[72:75],a[216:219],v[248:251],v[72:75]
ds_read_b128 v[244:247],v43 offset:33792
s_waitcnt vmcnt(3)
v_mfma_f32_16x16x32_bf16 v[64:67],a[92:95],v[252:255],v[64:67]
v_cmp_gt_u32 vcc,s96,v29
v_cmp_gt_u32 s[92:93],s92,v29
v_mfma_f32_16x16x32_bf16 v[72:75],a[220:223],v[252:255],v[72:75]
ds_read_b128 v[248:251],v17 offset:41984
s_waitcnt lgkmcnt(5)
v_mfma_f32_16x16x32_bf16 v[64:67],a[32:35],v[224:227],v[64:67]
v_mov_b32 v44,vcc_lo
v_mov_b32 v45,s92
v_mfma_f32_16x16x32_bf16 v[72:75],a[160:163],v[224:227],v[72:75]
ds_read_b128 v[252:255],v43 offset:41984
ds_write_b64 v46,v[44:45]
v_mfma_f32_16x16x32_bf16 v[64:67],a[36:39],v[228:231],v[64:67]
v_min3_u32 v27,v27,v224,v228
v_mfma_f32_16x16x32_bf16 v[72:75],a[164:167],v[228:231],v[72:75]
ds_read_b128 v[224:227],v17 offset:49152
s_waitcnt lgkmcnt(6)
v_mfma_f32_16x16x32_bf16 v[64:67],a[40:43],v[232:235],v[64:67]
v_min3_u32 v27,v27,v232,v236
v_mfma_f32_16x16x32_bf16 v[72:75],a[168:171],v[232:235],v[72:75]
ds_read_b128 v[228:231],v43 offset:49152
v_mfma_f32_16x16x32_bf16 v[64:67],a[44:47],v[236:239],v[64:67]
v_mfma_f32_16x16x32_bf16 v[72:75],a[172:175],v[236:239],v[72:75]
ds_read_b128 v[232:235],v17 offset:57344
s_waitcnt lgkmcnt(6)
v_mfma_f32_16x16x32_bf16 v[64:67],a[96:99],v[240:243],v[64:67]
v_min3_u32 v27,v27,v240,v244
s_add_u32 s88,s70,s75
v_mfma_f32_16x16x32_bf16 v[72:75],a[224:227],v[240:243],v[72:75]
ds_read_b128 v[236:239],v43 offset:57344
s_add_u32 s88,s88,2097152
v_mfma_f32_16x16x32_bf16 v[64:67],a[100:103],v[244:247],v[64:67]
s_xor_b32 s88,s88,0x2000
s_add_u32 s89,s88,65536
v_mfma_f32_16x16x32_bf16 v[72:75],a[228:231],v[244:247],v[72:75]
ds_read_b128 v[240:243],v17 offset:50176
s_waitcnt lgkmcnt(6)
v_mfma_f32_16x16x32_bf16 v[64:67],a[104:107],v[248:251],v[64:67]
v_min3_u32 v27,v27,v248,v252
v_mfma_f32_16x16x32_bf16 v[72:75],a[232:235],v[248:251],v[72:75]
ds_read_b128 v[244:247],v43 offset:50176
v_mfma_f32_16x16x32_bf16 v[64:67],a[108:111],v[252:255],v[64:67]
v_mfma_f32_16x16x32_bf16 v[72:75],a[236:239],v[252:255],v[72:75]
ds_read_b128 v[248:251],v17 offset:58368
s_waitcnt lgkmcnt(5)
v_mfma_f32_16x16x32_bf16 v[64:67],a[48:51],v[224:227],v[64:67]
v_min3_u32 v27,v27,v224,v228
v_mfma_f32_16x16x32_bf16 v[72:75],a[176:179],v[224:227],v[72:75]
ds_read_b128 v[252:255],v43 offset:58368
v_mfma_f32_16x16x32_bf16 v[64:67],a[52:55],v[228:231],v[64:67]
s_waitcnt vmcnt(0)
v_add_u32 v22,s71,-1
v_mfma_f32_16x16x32_bf16 v[72:75],a[180:183],v[228:231],v[72:75]
s_waitcnt vmcnt(5)
s_barrier
ds_read_b64 v[44:45],v47
ds_read_b128 v[224:227],v17 offset:4096
s_waitcnt lgkmcnt(6)
v_mfma_f32_16x16x32_bf16 v[64:67],a[56:59],v[232:235],v[64:67]
v_min3_u32 v27,v27,v232,v236
buffer_store_dword v22,v23,s[24:27],s97 offen
v_mfma_f32_16x16x32_bf16 v[72:75],a[184:187],v[232:235],v[72:75]
ds_read_b128 v[228:231],v43 offset:4096
v_mfma_f32_16x16x32_bf16 v[64:67],a[60:63],v[236:239],v[64:67]
buffer_store_dword v22,v23,s[28:31],s97 offen sc1
v_mfma_f32_16x16x32_bf16 v[72:75],a[188:191],v[236:239],v[72:75]
ds_read_b128 v[232:235],v17 offset:12288
s_waitcnt lgkmcnt(6)
v_mfma_f32_16x16x32_bf16 v[64:67],a[112:115],v[240:243],v[64:67]
v_min3_u32 v27,v27,v240,v244
s_mov_b32 s97,0x7fff0000
v_mfma_f32_16x16x32_bf16 v[72:75],a[240:243],v[240:243],v[72:75]
ds_read_b128 v[236:239],v43 offset:12288
v_mfma_f32_16x16x32_bf16 v[64:67],a[116:119],v[244:247],v[64:67]
v_mfma_f32_16x16x32_bf16 v[72:75],a[244:247],v[244:247],v[72:75]
ds_read_b128 v[240:243],v17 offset:5120
s_waitcnt lgkmcnt(6)
v_mfma_f32_16x16x32_bf16 v[64:67],a[120:123],v[248:251],v[64:67]
s_waitcnt lgkmcnt(5)
v_readfirstlane_b32 s93,v45
v_mfma_f32_16x16x32_bf16 v[72:75],a[248:251],v[248:251],v[72:75]
ds_read_b128 v[244:247],v43 offset:5120
v_readfirstlane_b32 s83,v44
s_cmp_lg_u32 s83,0
s_cbranch_scc1 keep_234
v_mfma_f32_16x16x32_bf16 v[64:67],a[124:127],v[252:255],v[64:67]
v_min3_u32 v27,v27,v248,v252
s_xor_b32 m0,s72,0
v_mfma_f32_16x16x32_bf16 v[72:75],a[252:255],v[252:255],v[72:75]
ds_read_b128 v[248:251],v17 offset:13312
s_add_u32 s65,s88,0
s_waitcnt lgkmcnt(5)
v_mfma_f32_16x16x32_bf16 v[68:71],a[0:3],v[224:227],0
buffer_load_dwordx4 v42,s[20:23],s65 offen offset:0 sc1 lds
v_min3_u32 v27,v27,v224,v228
v_mfma_f32_16x16x32_bf16 v[76:79],a[128:131],v[224:227],0
ds_read_b128 v[252:255],v43 offset:13312
buffer_load_dwordx4 v42,s[20:23],s65 offen offset:1024 sc1 lds
v_mfma_f32_16x16x32_bf16 v[68:71],a[4:7],v[228:231],v[68:71]
v_cmp_eq_u32 vcc,0,v27
s_cbranch_vccnz retry_222
v_mfma_f32_16x16x32_bf16 v[76:79],a[132:135],v[228:231],v[76:79]
ds_read_b128 v[224:227],v17 offset:20480
s_xor_b32 m0,s72,16384
s_waitcnt lgkmcnt(5)
v_mfma_f32_16x16x32_bf16 v[68:71],a[8:11],v[232:235],v[68:71]
s_add_u32 s65,s88,256
v_min3_u32 v27,v27,v232,v236
v_mul_f32 v88,v64,v64
v_mul_f32 v92,v72,v72
v_mfma_f32_16x16x32_bf16 v[76:79],a[136:139],v[232:235],v[76:79]
ds_read_b128 v[228:231],v43 offset:20480
buffer_load_dwordx4 v42,s[20:23],s65 offen offset:0 sc1 lds
v_mul_f32 v93,v73,v73
v_mfma_f32_16x16x32_bf16 v[68:71],a[12:15],v[236:239],v[68:71]
v_mul_f32 v89,v65,v65
v_mul_f32 v90,v66,v66
v_mul_f32 v91,v67,v67
v_mul_f32 v94,v74,v74
v_mfma_f32_16x16x32_bf16 v[76:79],a[140:143],v[236:239],v[76:79]
ds_read_b128 v[232:235],v17 offset:28672
v_fma_f32 v88,v88,s81,v28
v_mul_f32 v95,v75,v75
s_waitcnt lgkmcnt(5)
v_mfma_f32_16x16x32_bf16 v[68:71],a[64:67],v[240:243],v[68:71]
buffer_load_dwordx4 v42,s[20:23],s65 offen offset:1024 sc1 lds
s_xor_b32 m0,s72,32768
v_fma_f32 v92,v92,s81,v28
v_mfma_f32_16x16x32_bf16 v[76:79],a[192:195],v[240:243],v[76:79]
ds_read_b128 v[236:239],v43 offset:28672
s_add_u32 s65,s88,512
v_fma_f32 v89,v89,s81,v28
v_fma_f32 v93,v93,s81,v28
v_mfma_f32_16x16x32_bf16 v[68:71],a[68:71],v[244:247],v[68:71]
v_min3_u32 v27,v27,v240,v244
v_fma_f32 v90,v90,s81,v28
v_fma_f32 v91,v91,s81,v28
v_fma_f32 v94,v94,s81,v28
v_mfma_f32_16x16x32_bf16 v[76:79],a[196:199],v[244:247],v[76:79]
ds_read_b128 v[240:243],v17 offset:21504
v_mul_f32 v88,v88,v64
v_fma_f32 v95,v95,s81,v28
s_waitcnt lgkmcnt(5)
v_mfma_f32_16x16x32_bf16 v[68:71],a[72:75],v[248:251],v[68:71]
buffer_load_dwordx4 v42,s[20:23],s65 offen offset:0 sc1 lds
v_mul_f32 v89,v89,v65
v_mul_f32 v92,v92,v72
v_mfma_f32_16x16x32_bf16 v[76:79],a[200:203],v[248:251],v[76:79]
ds_read_b128 v[244:247],v43 offset:21504
buffer_load_dwordx4 v42,s[20:23],s65 offen offset:1024 sc1 lds
v_mul_f32 v93,v93,v73
v_mfma_f32_16x16x32_bf16 v[68:71],a[76:79],v[252:255],v[68:71]
s_xor_b32 m0,s72,49152
v_min3_u32 v27,v27,v248,v252
v_mul_f32 v90,v90,v66
v_mul_f32 v94,v94,v74
v_mfma_f32_16x16x32_bf16 v[76:79],a[204:207],v[252:255],v[76:79]
ds_read_b128 v[248:251],v17 offset:29696
s_add_u32 s65,s88,768
v_mul_f32 v95,v95,v75
s_waitcnt lgkmcnt(5)
v_mfma_f32_16x16x32_bf16 v[68:71],a[16:19],v[224:227],v[68:71]
buffer_load_dwordx4 v42,s[20:23],s65 offen offset:0 sc1 lds
v_mul_f32 v91,v91,v67
v_mfma_f32_16x16x32_bf16 v[76:79],a[144:147],v[224:227],v[76:79]
ds_read_b128 v[252:255],v43 offset:29696
v_min3_u32 v27,v27,v224,v228
v_exp_f32 v92,v92
v_mfma_f32_16x16x32_bf16 v[68:71],a[20:23],v[228:231],v[68:71]
buffer_load_dwordx4 v42,s[20:23],s65 offen offset:1024 sc1 lds
v_exp_f32 v93,v93
v_mfma_f32_16x16x32_bf16 v[76:79],a[148:151],v[228:231],v[76:79]
ds_read_b128 v[224:227],v17 offset:36864
v_exp_f32 v94,v94
s_waitcnt lgkmcnt(5)
v_mfma_f32_16x16x32_bf16 v[68:71],a[24:27],v[232:235],v[68:71]
s_xor_b32 m0,s72,4096
s_add_u32 s65,s89,0
v_exp_f32 v95,v95
v_mfma_f32_16x16x32_bf16 v[76:79],a[152:155],v[232:235],v[76:79]
ds_read_b128 v[228:231],v43 offset:36864
v_min3_u32 v27,v27,v232,v236
v_add_f32 v92,1.0,v92
v_add_f32 v93,1.0,v93
v_mfma_f32_16x16x32_bf16 v[68:71],a[28:31],v[236:239],v[68:71]
buffer_load_dwordx4 v42,s[20:23],s65 offen offset:0 sc1 lds
v_add_f32 v94,1.0,v94
v_add_f32 v95,1.0,v95
v_mfma_f32_16x16x32_bf16 v[76:79],a[156:159],v[236:239],v[76:79]
ds_read_b128 v[232:235],v17 offset:45056
v_rcp_f32 v92,v92
s_waitcnt lgkmcnt(5)
v_mfma_f32_16x16x32_bf16 v[68:71],a[80:83],v[240:243],v[68:71]
buffer_load_dwordx4 v42,s[20:23],s65 offen offset:1024 sc1 lds
v_rcp_f32 v93,v93
v_mfma_f32_16x16x32_bf16 v[76:79],a[208:211],v[240:243],v[76:79]
ds_read_b128 v[236:239],v43 offset:45056
s_xor_b32 m0,s72,20480
v_rcp_f32 v94,v94
v_mfma_f32_16x16x32_bf16 v[68:71],a[84:87],v[244:247],v[68:71]
s_add_u32 s65,s89,256
v_min3_u32 v27,v27,v240,v244
v_rcp_f32 v95,v95
v_mfma_f32_16x16x32_bf16 v[76:79],a[212:215],v[244:247],v[76:79]
ds_read_b128 v[240:243],v17 offset:37888
v_mul_f32 v92,v92,v72
v_mul_f32 v93,v93,v73
s_waitcnt lgkmcnt(5)
v_mfma_f32_16x16x32_bf16 v[68:71],a[88:91],v[248:251],v[68:71]
buffer_load_dwordx4 v42,s[20:23],s65 offen offset:0 sc1 lds
v_mfma_f32_16x16x32_bf16 v[76:79],a[216:219],v[248:251],v[76:79]
ds_read_b128 v[244:247],v43 offset:37888
v_min3_u32 v27,v27,v248,v252
v_mfma_f32_16x16x32_bf16 v[68:71],a[92:95],v[252:255],v[68:71]
buffer_load_dwordx4 v42,s[20:23],s65 offen offset:1024 sc1 lds
v_mfma_f32_16x16x32_bf16 v[76:79],a[220:223],v[252:255],v[76:79]
ds_read_b128 v[248:251],v17 offset:46080
s_waitcnt lgkmcnt(5)
v_mfma_f32_16x16x32_bf16 v[68:71],a[32:35],v[224:227],v[68:71]
s_xor_b32 m0,s72,36864
s_add_u32 s65,s89,512
v_mfma_f32_16x16x32_bf16 v[76:79],a[160:163],v[224:227],v[76:79]
ds_read_b128 v[252:255],v43 offset:46080
v_min3_u32 v27,v27,v224,v228
v_mfma_f32_16x16x32_bf16 v[68:71],a[36:39],v[228:231],v[68:71]
buffer_load_dwordx4 v42,s[20:23],s65 offen offset:0 sc1 lds
v_mfma_f32_16x16x32_bf16 v[76:79],a[164:167],v[228:231],v[76:79]
ds_read_b128 v[224:227],v17 offset:53248
s_waitcnt lgkmcnt(5)
v_mfma_f32_16x16x32_bf16 v[68:71],a[40:43],v[232:235],v[68:71]
buffer_load_dwordx4 v42,s[20:23],s65 offen offset:1024 sc1 lds
v_mfma_f32_16x16x32_bf16 v[76:79],a[168:171],v[232:235],v[76:79]
ds_read_b128 v[228:231],v43 offset:53248
s_xor_b32 m0,s72,53248
v_mfma_f32_16x16x32_bf16 v[68:71],a[44:47],v[236:239],v[68:71]
s_add_u32 s65,s89,768
v_min3_u32 v27,v27,v232,v236
v_mfma_f32_16x16x32_bf16 v[76:79],a[172:175],v[236:239],v[76:79]
ds_read_b128 v[232:235],v17 offset:61440
s_waitcnt lgkmcnt(5)
v_mfma_f32_16x16x32_bf16 v[68:71],a[96:99],v[240:243],v[68:71]
buffer_load_dwordx4 v42,s[20:23],s65 offen offset:0 sc1 lds
v_mfma_f32_16x16x32_bf16 v[76:79],a[224:227],v[240:243],v[76:79]
ds_read_b128 v[236:239],v43 offset:61440
v_min3_u32 v27,v27,v240,v244
v_mfma_f32_16x16x32_bf16 v[68:71],a[100:103],v[244:247],v[68:71]
buffer_load_dwordx4 v42,s[20:23],s65 offen offset:1024 sc1 lds
v_mfma_f32_16x16x32_bf16 v[76:79],a[228:231],v[244:247],v[76:79]
ds_read_b128 v[240:243],v17 offset:54272
s_waitcnt lgkmcnt(5)
v_mfma_f32_16x16x32_bf16 v[68:71],a[104:107],v[248:251],v[68:71]
v_min3_u32 v27,v27,v248,v252
v_exp_f32 v88,v88
v_mfma_f32_16x16x32_bf16 v[76:79],a[232:235],v[248:251],v[76:79]
ds_read_b128 v[244:247],v43 offset:54272
v_exp_f32 v89,v89
v_mfma_f32_16x16x32_bf16 v[68:71],a[108:111],v[252:255],v[68:71]
v_exp_f32 v90,v90
v_mfma_f32_16x16x32_bf16 v[76:79],a[236:239],v[252:255],v[76:79]
ds_read_b128 v[248:251],v17 offset:62464
s_waitcnt lgkmcnt(5)
v_mfma_f32_16x16x32_bf16 v[68:71],a[48:51],v[224:227],v[68:71]
v_min3_u32 v27,v27,v224,v228
v_exp_f32 v91,v91
v_mfma_f32_16x16x32_bf16 v[76:79],a[176:179],v[224:227],v[76:79]
ds_read_b128 v[252:255],v43 offset:62464
v_add_f32 v88,1.0,v88
v_add_f32 v89,1.0,v89
v_mfma_f32_16x16x32_bf16 v[68:71],a[52:55],v[228:231],v[68:71]
v_add_f32 v90,1.0,v90
v_add_f32 v91,1.0,v91
v_mfma_f32_16x16x32_bf16 v[76:79],a[180:183],v[228:231],v[76:79]
v_rcp_f32 v88,v88
s_waitcnt lgkmcnt(4)
v_mfma_f32_16x16x32_bf16 v[68:71],a[56:59],v[232:235],v[68:71]
v_min3_u32 v27,v27,v232,v236
v_rcp_f32 v89,v89
v_mfma_f32_16x16x32_bf16 v[76:79],a[184:187],v[232:235],v[76:79]
v_rcp_f32 v90,v90
v_mfma_f32_16x16x32_bf16 v[68:71],a[60:63],v[236:239],v[68:71]
v_rcp_f32 v91,v91
v_mfma_f32_16x16x32_bf16 v[76:79],a[188:191],v[236:239],v[76:79]
v_mul_f32 v88,v88,v64
s_waitcnt lgkmcnt(2)
v_mfma_f32_16x16x32_bf16 v[68:71],a[112:115],v[240:243],v[68:71]
v_min3_u32 v27,v27,v240,v244
v_mul_f32 v89,v89,v65
v_mfma_f32_16x16x32_bf16 v[76:79],a[240:243],v[240:243],v[76:79]
v_mul_f32 v90,v90,v66
v_mul_f32 v91,v91,v67
v_mfma_f32_16x16x32_bf16 v[68:71],a[116:119],v[244:247],v[68:71]
v_mul_f32 v94,v94,v74
v_mul_f32 v95,v95,v75
v_mfma_f32_16x16x32_bf16 v[76:79],a[244:247],v[244:247],v[76:79]
v_cvt_pk_bf16_f32 v96,v88,v89
s_waitcnt lgkmcnt(0)
v_mfma_f32_16x16x32_bf16 v[68:71],a[120:123],v[248:251],v[68:71]
v_min3_u32 v27,v27,v248,v252
v_cvt_pk_bf16_f32 v97,v90,v91
v_mfma_f32_16x16x32_bf16 v[76:79],a[248:251],v[248:251],v[76:79]
v_cvt_pk_bf16_f32 v98,v92,v93
v_cvt_pk_bf16_f32 v99,v94,v95
v_mfma_f32_16x16x32_bf16 v[68:71],a[124:127],v[252:255],v[68:71]
v_max_u32 v96,1,v96
v_mfma_f32_16x16x32_bf16 v[76:79],a[252:255],v[252:255],v[76:79]
buffer_store_dwordx4 v[96:99],v18,s[20:23],s78 offen sc1
v_cmp_eq_u32 vcc,0,v27
s_cbranch_vccnz retry_222
s_branch epi_225
keep_234:
v_mfma_f32_16x16x32_bf16 v[64:67],a[124:127],v[252:255],v[64:67]
v_min3_u32 v27,v27,v248,v252
v_mfma_f32_16x16x32_bf16 v[72:75],a[252:255],v[252:255],v[72:75]
ds_read_b128 v[248:251],v17 offset:13312
s_waitcnt lgkmcnt(5)
v_mfma_f32_16x16x32_bf16 v[68:71],a[0:3],v[224:227],0
v_cmp_eq_u32 vcc,0,v27
s_cbranch_vccnz retry_222
v_mfma_f32_16x16x32_bf16 v[76:79],a[128:131],v[224:227],0
ds_read_b128 v[252:255],v43 offset:13312
v_min3_u32 v27,v27,v224,v228
v_mfma_f32_16x16x32_bf16 v[68:71],a[4:7],v[228:231],v[68:71]
v_mfma_f32_16x16x32_bf16 v[76:79],a[132:135],v[228:231],v[76:79]
ds_read_b128 v[224:227],v17 offset:20480
s_waitcnt lgkmcnt(5)
v_mfma_f32_16x16x32_bf16 v[68:71],a[8:11],v[232:235],v[68:71]
v_min3_u32 v27,v27,v232,v236
v_mul_f32 v88,v64,v64
v_mul_f32 v92,v72,v72
v_mfma_f32_16x16x32_bf16 v[76:79],a[136:139],v[232:235],v[76:79]
ds_read_b128 v[228:231],v43 offset:20480
v_mul_f32 v89,v65,v65
v_mul_f32 v93,v73,v73
v_mfma_f32_16x16x32_bf16 v[68:71],a[12:15],v[236:239],v[68:71]
v_mul_f32 v90,v66,v66
v_mul_f32 v91,v67,v67
v_mul_f32 v94,v74,v74
v_mfma_f32_16x16x32_bf16 v[76:79],a[140:143],v[236:239],v[76:79]
ds_read_b128 v[232:235],v17 offset:28672
v_mul_f32 v95,v75,v75
s_waitcnt lgkmcnt(5)
v_mfma_f32_16x16x32_bf16 v[68:71],a[64:67],v[240:243],v[68:71]
v_min3_u32 v27,v27,v240,v244
v_fma_f32 v88,v88,s81,v28
v_fma_f32 v92,v92,s81,v28
v_mfma_f32_16x16x32_bf16 v[76:79],a[192:195],v[240:243],v[76:79]
ds_read_b128 v[236:239],v43 offset:28672
v_fma_f32 v89,v89,s81,v28
v_fma_f32 v93,v93,s81,v28
v_mfma_f32_16x16x32_bf16 v[68:71],a[68:71],v[244:247],v[68:71]
v_fma_f32 v90,v90,s81,v28
v_fma_f32 v91,v91,s81,v28
v_fma_f32 v94,v94,s81,v28
v_mfma_f32_16x16x32_bf16 v[76:79],a[196:199],v[244:247],v[76:79]
ds_read_b128 v[240:243],v17 offset:21504
v_fma_f32 v95,v95,s81,v28
s_waitcnt lgkmcnt(5)
v_mfma_f32_16x16x32_bf16 v[68:71],a[72:75],v[248:251],v[68:71]
v_min3_u32 v27,v27,v248,v252
v_mul_f32 v88,v88,v64
v_mul_f32 v92,v92,v72
v_mfma_f32_16x16x32_bf16 v[76:79],a[200:203],v[248:251],v[76:79]
ds_read_b128 v[244:247],v43 offset:21504
v_mul_f32 v89,v89,v65
v_mul_f32 v93,v93,v73
v_mfma_f32_16x16x32_bf16 v[68:71],a[76:79],v[252:255],v[68:71]
v_mul_f32 v90,v90,v66
v_mul_f32 v91,v91,v67
v_mul_f32 v94,v94,v74
v_mfma_f32_16x16x32_bf16 v[76:79],a[204:207],v[252:255],v[76:79]
ds_read_b128 v[248:251],v17 offset:29696
v_mul_f32 v95,v95,v75
s_waitcnt lgkmcnt(5)
v_mfma_f32_16x16x32_bf16 v[68:71],a[16:19],v[224:227],v[68:71]
v_min3_u32 v27,v27,v224,v228
v_exp_f32 v92,v92
v_mfma_f32_16x16x32_bf16 v[76:79],a[144:147],v[224:227],v[76:79]
ds_read_b128 v[252:255],v43 offset:29696
v_exp_f32 v93,v93
v_mfma_f32_16x16x32_bf16 v[68:71],a[20:23],v[228:231],v[68:71]
v_exp_f32 v88,v88
v_mfma_f32_16x16x32_bf16 v[76:79],a[148:151],v[228:231],v[76:79]
ds_read_b128 v[224:227],v17 offset:36864
s_waitcnt lgkmcnt(5)
v_mfma_f32_16x16x32_bf16 v[68:71],a[24:27],v[232:235],v[68:71]
v_min3_u32 v27,v27,v232,v236
v_exp_f32 v94,v94
v_mfma_f32_16x16x32_bf16 v[76:79],a[152:155],v[232:235],v[76:79]
ds_read_b128 v[228:231],v43 offset:36864
v_exp_f32 v95,v95
v_mfma_f32_16x16x32_bf16 v[68:71],a[28:31],v[236:239],v[68:71]
v_exp_f32 v89,v89
v_add_f32 v92,1.0,v92
v_mfma_f32_16x16x32_bf16 v[76:79],a[156:159],v[236:239],v[76:79]
ds_read_b128 v[232:235],v17 offset:45056
v_add_f32 v93,1.0,v93
s_waitcnt lgkmcnt(5)
v_mfma_f32_16x16x32_bf16 v[68:71],a[80:83],v[240:243],v[68:71]
v_min3_u32 v27,v27,v240,v244
v_add_f32 v94,1.0,v94
v_add_f32 v95,1.0,v95
v_mfma_f32_16x16x32_bf16 v[76:79],a[208:211],v[240:243],v[76:79]
ds_read_b128 v[236:239],v43 offset:45056
v_rcp_f32 v92,v92
v_mfma_f32_16x16x32_bf16 v[68:71],a[84:87],v[244:247],v[68:71]
v_exp_f32 v90,v90
v_mfma_f32_16x16x32_bf16 v[76:79],a[212:215],v[244:247],v[76:79]
ds_read_b128 v[240:243],v17 offset:37888
s_waitcnt lgkmcnt(5)
v_mfma_f32_16x16x32_bf16 v[68:71],a[88:91],v[248:251],v[68:71]
v_min3_u32 v27,v27,v248,v252
v_rcp_f32 v93,v93
v_mfma_f32_16x16x32_bf16 v[76:79],a[216:219],v[248:251],v[76:79]
ds_read_b128 v[244:247],v43 offset:37888
v_rcp_f32 v94,v94
v_mfma_f32_16x16x32_bf16 v[68:71],a[92:95],v[252:255],v[68:71]
v_exp_f32 v91,v91
v_mfma_f32_16x16x32_bf16 v[76:79],a[220:223],v[252:255],v[76:79]
ds_read_b128 v[248:251],v17 offset:46080
s_waitcnt lgkmcnt(5)
v_mfma_f32_16x16x32_bf16 v[68:71],a[32:35],v[224:227],v[68:71]
v_min3_u32 v27,v27,v224,v228
v_add_f32 v88,1.0,v88
v_mfma_f32_16x16x32_bf16 v[76:79],a[160:163],v[224:227],v[76:79]
ds_read_b128 v[252:255],v43 offset:46080
v_add_f32 v89,1.0,v89
v_mfma_f32_16x16x32_bf16 v[68:71],a[36:39],v[228:231],v[68:71]
v_add_f32 v90,1.0,v90
v_add_f32 v91,1.0,v91
v_mfma_f32_16x16x32_bf16 v[76:79],a[164:167],v[228:231],v[76:79]
ds_read_b128 v[224:227],v17 offset:53248
s_waitcnt lgkmcnt(5)
v_mfma_f32_16x16x32_bf16 v[68:71],a[40:43],v[232:235],v[68:71]
v_min3_u32 v27,v27,v232,v236
v_mfma_f32_16x16x32_bf16 v[76:79],a[168:171],v[232:235],v[76:79]
ds_read_b128 v[228:231],v43 offset:53248
v_mfma_f32_16x16x32_bf16 v[68:71],a[44:47],v[236:239],v[68:71]
v_rcp_f32 v88,v88
v_mfma_f32_16x16x32_bf16 v[76:79],a[172:175],v[236:239],v[76:79]
ds_read_b128 v[232:235],v17 offset:61440
s_waitcnt lgkmcnt(5)
v_mfma_f32_16x16x32_bf16 v[68:71],a[96:99],v[240:243],v[68:71]
v_min3_u32 v27,v27,v240,v244
v_mfma_f32_16x16x32_bf16 v[76:79],a[224:227],v[240:243],v[76:79]
ds_read_b128 v[236:239],v43 offset:61440
v_mfma_f32_16x16x32_bf16 v[68:71],a[100:103],v[244:247],v[68:71]
v_rcp_f32 v89,v89
v_mfma_f32_16x16x32_bf16 v[76:79],a[228:231],v[244:247],v[76:79]
ds_read_b128 v[240:243],v17 offset:54272
s_waitcnt lgkmcnt(5)
v_mfma_f32_16x16x32_bf16 v[68:71],a[104:107],v[248:251],v[68:71]
v_min3_u32 v27,v27,v248,v252
v_mfma_f32_16x16x32_bf16 v[76:79],a[232:235],v[248:251],v[76:79]
ds_read_b128 v[244:247],v43 offset:54272
v_mfma_f32_16x16x32_bf16 v[68:71],a[108:111],v[252:255],v[68:71]
v_rcp_f32 v90,v90
v_mfma_f32_16x16x32_bf16 v[76:79],a[236:239],v[252:255],v[76:79]
ds_read_b128 v[248:251],v17 offset:62464
s_waitcnt lgkmcnt(5)
v_mfma_f32_16x16x32_bf16 v[68:71],a[48:51],v[224:227],v[68:71]
v_min3_u32 v27,v27,v224,v228
v_mfma_f32_16x16x32_bf16 v[76:79],a[176:179],v[224:227],v[76:79]
ds_read_b128 v[252:255],v43 offset:62464
v_mfma_f32_16x16x32_bf16 v[68:71],a[52:55],v[228:231],v[68:71]
v_rcp_f32 v91,v91
v_mfma_f32_16x16x32_bf16 v[76:79],a[180:183],v[228:231],v[76:79]
v_mul_f32 v88,v88,v64
s_waitcnt lgkmcnt(4)
v_mfma_f32_16x16x32_bf16 v[68:71],a[56:59],v[232:235],v[68:71]
v_min3_u32 v27,v27,v232,v236
v_mul_f32 v89,v89,v65
v_mfma_f32_16x16x32_bf16 v[76:79],a[184:187],v[232:235],v[76:79]
v_mul_f32 v90,v90,v66
v_mul_f32 v91,v91,v67
v_mfma_f32_16x16x32_bf16 v[68:71],a[60:63],v[236:239],v[68:71]
v_rcp_f32 v95,v95
v_mfma_f32_16x16x32_bf16 v[76:79],a[188:191],v[236:239],v[76:79]
v_mul_f32 v92,v92,v72
s_waitcnt lgkmcnt(2)
v_mfma_f32_16x16x32_bf16 v[68:71],a[112:115],v[240:243],v[68:71]
v_min3_u32 v27,v27,v240,v244
v_mul_f32 v93,v93,v73
v_mfma_f32_16x16x32_bf16 v[76:79],a[240:243],v[240:243],v[76:79]
v_mul_f32 v94,v94,v74
v_mul_f32 v95,v95,v75
v_mfma_f32_16x16x32_bf16 v[68:71],a[116:119],v[244:247],v[68:71]
v_cvt_pk_bf16_f32 v96,v88,v89
v_cvt_pk_bf16_f32 v97,v90,v91
v_mfma_f32_16x16x32_bf16 v[76:79],a[244:247],v[244:247],v[76:79]
v_cvt_pk_bf16_f32 v98,v92,v93
s_waitcnt lgkmcnt(0)
v_mfma_f32_16x16x32_bf16 v[68:71],a[120:123],v[248:251],v[68:71]
v_min3_u32 v27,v27,v248,v252
v_cvt_pk_bf16_f32 v99,v94,v95
v_mfma_f32_16x16x32_bf16 v[76:79],a[248:251],v[248:251],v[76:79]
v_max_u32 v96,1,v96
v_mfma_f32_16x16x32_bf16 v[68:71],a[124:127],v[252:255],v[68:71]
buffer_store_dwordx4 v[96:99],v18,s[20:23],s78 offen sc1
v_mfma_f32_16x16x32_bf16 v[76:79],a[252:255],v[252:255],v[76:79]
v_cmp_eq_u32 vcc,0,v27
s_cbranch_vccnz retry_222
s_branch epi_225
both_226:
s_waitcnt vmcnt(13) lgkmcnt(0)
s_barrier
ds_read_b128 v[224:227],v17 offset:0
ds_read_b128 v[228:231],v43 offset:0
ds_read_b128 v[232:235],v17 offset:8192
ds_read_b128 v[236:239],v43 offset:8192
ds_read_b128 v[240:243],v17 offset:1024
ds_read_b128 v[244:247],v43 offset:1024
ds_read_b128 v[248:251],v17 offset:9216
s_waitcnt lgkmcnt(5)
v_mfma_f32_16x16x32_bf16 v[64:67],a[0:3],v[224:227],0
s_add_u32 s96,s71,1
s_add_u32 s92,s71,2
v_min_u32 v27,v224,v228
v_mfma_f32_16x16x32_bf16 v[72:75],a[128:131],v[224:227],0
ds_read_b128 v[252:255],v43 offset:9216
s_add_u32 s88,s70,s75
v_mfma_f32_16x16x32_bf16 v[64:67],a[4:7],v[228:231],v[64:67]
s_add_u32 s88,s88,2097152
s_xor_b32 s88,s88,0x2000
v_mfma_f32_16x16x32_bf16 v[72:75],a[132:135],v[228:231],v[72:75]
ds_read_b128 v[224:227],v17 offset:16384
s_waitcnt lgkmcnt(5)
v_mfma_f32_16x16x32_bf16 v[64:67],a[8:11],v[232:235],v[64:67]
s_add_u32 s89,s88,65536
v_min3_u32 v27,v27,v232,v236
v_mfma_f32_16x16x32_bf16 v[72:75],a[136:139],v[232:235],v[72:75]
ds_read_b128 v[228:231],v43 offset:16384
v_mfma_f32_16x16x32_bf16 v[64:67],a[12:15],v[236:239],v[64:67]
s_xor_b32 m0,s72,0
v_mfma_f32_16x16x32_bf16 v[72:75],a[140:143],v[236:239],v[72:75]
ds_read_b128 v[232:235],v17 offset:24576
s_add_u32 s65,s88,0
s_waitcnt lgkmcnt(5)
v_mfma_f32_16x16x32_bf16 v[64:67],a[64:67],v[240:243],v[64:67]
v_min3_u32 v27,v27,v240,v244
v_mfma_f32_16x16x32_bf16 v[72:75],a[192:195],v[240:243],v[72:75]
ds_read_b128 v[236:239],v43 offset:24576
buffer_load_dwordx4 v42,s[20:23],s65 offen offset:0 sc1 lds
v_mfma_f32_16x16x32_bf16 v[64:67],a[68:71],v[244:247],v[64:67]
buffer_load_dwordx4 v42,s[20:23],s65 offen offset:1024 sc1 lds
v_mfma_f32_16x16x32_bf16 v[72:75],a[196:199],v[244:247],v[72:75]
ds_read_b128 v[240:243],v17 offset:17408
s_waitcnt lgkmcnt(5)
v_mfma_f32_16x16x32_bf16 v[64:67],a[72:75],v[248:251],v[64:67]
s_xor_b32 m0,s72,16384
v_min3_u32 v27,v27,v248,v252
v_mfma_f32_16x16x32_bf16 v[72:75],a[200:203],v[248:251],v[72:75]
ds_read_b128 v[244:247],v43 offset:17408
v_mfma_f32_16x16x32_bf16 v[64:67],a[76:79],v[252:255],v[64:67]
s_add_u32 s65,s88,256
v_mfma_f32_16x16x32_bf16 v[72:75],a[204:207],v[252:255],v[72:75]
ds_read_b128 v[248:251],v17 offset:25600
s_waitcnt lgkmcnt(5)
v_mfma_f32_16x16x32_bf16 v[64:67],a[16:19],v[224:227],v[64:67]
buffer_load_dwordx4 v42,s[20:23],s65 offen offset:0 sc1 lds
v_mfma_f32_16x16x32_bf16 v[72:75],a[144:147],v[224:227],v[72:75]
ds_read_b128 v[252:255],v43 offset:25600
buffer_load_dwordx4 v42,s[20:23],s65 offen offset:1024 sc1 lds
v_mfma_f32_16x16x32_bf16 v[64:67],a[20:23],v[228:231],v[64:67]
v_min3_u32 v27,v27,v224,v228
v_mfma_f32_16x16x32_bf16 v[72:75],a[148:151],v[228:231],v[72:75]
ds_read_b128 v[224:227],v17 offset:32768
s_xor_b32 m0,s72,32768
s_waitcnt lgkmcnt(5)
v_mfma_f32_16x16x32_bf16 v[64:67],a[24:27],v[232:235],v[64:67]
s_add_u32 s65,s88,512
v_min3_u32 v27,v27,v232,v236
v_mfma_f32_16x16x32_bf16 v[72:75],a[152:155],v[232:235],v[72:75]
ds_read_b128 v[228:231],v43 offset:32768
v_mfma_f32_16x16x32_bf16 v[64:67],a[28:31],v[236:239],v[64:67]
buffer_load_dwordx4 v42,s[20:23],s65 offen offset:0 sc1 lds
v_mfma_f32_16x16x32_bf16 v[72:75],a[156:159],v[236:239],v[72:75]
ds_read_b128 v[232:235],v17 offset:40960
s_waitcnt lgkmcnt(5)
v_mfma_f32_16x16x32_bf16 v[64:67],a[80:83],v[240:243],v[64:67]
buffer_load_dwordx4 v42,s[20:23],s65 offen offset:1024 sc1 lds
v_mfma_f32_16x16x32_bf16 v[72:75],a[208:211],v[240:243],v[72:75]
ds_read_b128 v[236:239],v43 offset:40960
s_xor_b32 m0,s72,49152
v_mfma_f32_16x16x32_bf16 v[64:67],a[84:87],v[244:247],v[64:67]
v_min3_u32 v27,v27,v240,v244
v_mfma_f32_16x16x32_bf16 v[72:75],a[212:215],v[244:247],v[72:75]
ds_read_b128 v[240:243],v17 offset:33792
s_add_u32 s65,s88,768
s_waitcnt lgkmcnt(5)
v_mfma_f32_16x16x32_bf16 v[64:67],a[88:91],v[248:251],v[64:67]
buffer_load_dwordx4 v42,s[20:23],s65 offen offset:0 sc1 lds
v_min3_u32 v27,v27,v248,v252
v_mfma_f32_16x16x32_bf16 v[72:75],a[216:219],v[248:251],v[72:75]
ds_read_b128 v[244:247],v43 offset:33792
s_waitcnt vmcnt(10)
v_mfma_f32_16x16x32_bf16 v[64:67],a[92:95],v[252:255],v[64:67]
v_cmp_gt_u32 vcc,s96,v29
v_cmp_gt_u32 s[92:93],s92,v29
v_mfma_f32_16x16x32_bf16 v[72:75],a[220:223],v[252:255],v[72:75]
ds_read_b128 v[248:251],v17 offset:41984
s_waitcnt lgkmcnt(5)
v_mfma_f32_16x16x32_bf16 v[64:67],a[32:35],v[224:227],v[64:67]
v_mov_b32 v44,vcc_lo
v_mov_b32 v45,s92
v_min3_u32 v27,v27,v224,v228
v_mfma_f32_16x16x32_bf16 v[72:75],a[160:163],v[224:227],v[72:75]
ds_read_b128 v[252:255],v43 offset:41984
ds_write_b64 v46,v[44:45]
v_mfma_f32_16x16x32_bf16 v[64:67],a[36:39],v[228:231],v[64:67]
buffer_load_dwordx4 v42,s[20:23],s65 offen offset:1024 sc1 lds
v_mfma_f32_16x16x32_bf16 v[72:75],a[164:167],v[228:231],v[72:75]
ds_read_b128 v[224:227],v17 offset:49152
s_waitcnt lgkmcnt(6)
v_mfma_f32_16x16x32_bf16 v[64:67],a[40:43],v[232:235],v[64:67]
s_xor_b32 m0,s72,4096
s_add_u32 s65,s89,0
v_mfma_f32_16x16x32_bf16 v[72:75],a[168:171],v[232:235],v[72:75]
ds_read_b128 v[228:231],v43 offset:49152
v_min3_u32 v27,v27,v232,v236
v_mfma_f32_16x16x32_bf16 v[64:67],a[44:47],v[236:239],v[64:67]
buffer_load_dwordx4 v42,s[20:23],s65 offen offset:0 sc1 lds
v_mfma_f32_16x16x32_bf16 v[72:75],a[172:175],v[236:239],v[72:75]
ds_read_b128 v[232:235],v17 offset:57344
s_waitcnt lgkmcnt(6)
v_mfma_f32_16x16x32_bf16 v[64:67],a[96:99],v[240:243],v[64:67]
buffer_load_dwordx4 v42,s[20:23],s65 offen offset:1024 sc1 lds
v_mfma_f32_16x16x32_bf16 v[72:75],a[224:227],v[240:243],v[72:75]
ds_read_b128 v[236:239],v43 offset:57344
s_xor_b32 m0,s72,20480
v_mfma_f32_16x16x32_bf16 v[64:67],a[100:103],v[244:247],v[64:67]
s_add_u32 s65,s89,256
v_min3_u32 v27,v27,v240,v244
v_mfma_f32_16x16x32_bf16 v[72:75],a[228:231],v[244:247],v[72:75]
ds_read_b128 v[240:243],v17 offset:50176
s_waitcnt lgkmcnt(6)
v_mfma_f32_16x16x32_bf16 v[64:67],a[104:107],v[248:251],v[64:67]
buffer_load_dwordx4 v42,s[20:23],s65 offen offset:0 sc1 lds
v_mfma_f32_16x16x32_bf16 v[72:75],a[232:235],v[248:251],v[72:75]
ds_read_b128 v[244:247],v43 offset:50176
v_min3_u32 v27,v27,v248,v252
v_mfma_f32_16x16x32_bf16 v[64:67],a[108:111],v[252:255],v[64:67]
buffer_load_dwordx4 v42,s[20:23],s65 offen offset:1024 sc1 lds
v_mfma_f32_16x16x32_bf16 v[72:75],a[236:239],v[252:255],v[72:75]
ds_read_b128 v[248:251],v17 offset:58368
s_waitcnt lgkmcnt(5)
v_mfma_f32_16x16x32_bf16 v[64:67],a[48:51],v[224:227],v[64:67]
s_xor_b32 m0,s72,36864
s_add_u32 s65,s89,512
v_mfma_f32_16x16x32_bf16 v[72:75],a[176:179],v[224:227],v[72:75]
ds_read_b128 v[252:255],v43 offset:58368
v_min3_u32 v27,v27,v224,v228
v_mfma_f32_16x16x32_bf16 v[64:67],a[52:55],v[228:231],v[64:67]
buffer_load_dwordx4 v42,s[20:23],s65 offen offset:0 sc1 lds
s_waitcnt vmcnt(13)
v_add_u32 v22,s71,-1
v_mfma_f32_16x16x32_bf16 v[72:75],a[180:183],v[228:231],v[72:75]
s_waitcnt vmcnt(18)
s_barrier
ds_read_b64 v[44:45],v47
ds_read_b128 v[224:227],v17 offset:4096
s_waitcnt lgkmcnt(6)
v_mfma_f32_16x16x32_bf16 v[64:67],a[56:59],v[232:235],v[64:67]
buffer_load_dwordx4 v42,s[20:23],s65 offen offset:1024 sc1 lds
buffer_store_dword v22,v23,s[24:27],s97 offen
v_mfma_f32_16x16x32_bf16 v[72:75],a[184:187],v[232:235],v[72:75]
ds_read_b128 v[228:231],v43 offset:4096
s_xor_b32 m0,s72,53248
buffer_store_dword v22,v23,s[28:31],s97 offen sc1
v_mfma_f32_16x16x32_bf16 v[64:67],a[60:63],v[236:239],v[64:67]
s_add_u32 s65,s89,768
v_min3_u32 v27,v27,v232,v236
s_mov_b32 s97,0x7fff0000
v_mfma_f32_16x16x32_bf16 v[72:75],a[188:191],v[236:239],v[72:75]
ds_read_b128 v[232:235],v17 offset:12288
s_waitcnt lgkmcnt(6)
v_mfma_f32_16x16x32_bf16 v[64:67],a[112:115],v[240:243],v[64:67]
buffer_load_dwordx4 v42,s[20:23],s65 offen offset:0 sc1 lds
v_mfma_f32_16x16x32_bf16 v[72:75],a[240:243],v[240:243],v[72:75]
ds_read_b128 v[236:239],v43 offset:12288
v_min3_u32 v27,v27,v240,v244
v_mfma_f32_16x16x32_bf16 v[64:67],a[116:119],v[244:247],v[64:67]
buffer_load_dwordx4 v42,s[20:23],s65 offen offset:1024 sc1 lds
v_mfma_f32_16x16x32_bf16 v[72:75],a[244:247],v[244:247],v[72:75]
ds_read_b128 v[240:243],v17 offset:5120
s_waitcnt lgkmcnt(6)
v_mfma_f32_16x16x32_bf16 v[64:67],a[120:123],v[248:251],v[64:67]
s_waitcnt lgkmcnt(5)
v_readfirstlane_b32 s93,v45
v_mfma_f32_16x16x32_bf16 v[72:75],a[248:251],v[248:251],v[72:75]
ds_read_b128 v[244:247],v43 offset:5120
v_min3_u32 v27,v27,v248,v252
v_mfma_f32_16x16x32_bf16 v[64:67],a[124:127],v[252:255],v[64:67]
v_mfma_f32_16x16x32_bf16 v[72:75],a[252:255],v[252:255],v[72:75]
ds_read_b128 v[248:251],v17 offset:13312
s_waitcnt lgkmcnt(5)
v_mfma_f32_16x16x32_bf16 v[68:71],a[0:3],v[224:227],0
v_cmp_eq_u32 vcc,0,v27
s_cbranch_vccnz retry_222
v_mfma_f32_16x16x32_bf16 v[76:79],a[128:131],v[224:227],0
ds_read_b128 v[252:255],v43 offset:13312
v_min3_u32 v27,v27,v224,v228
v_mfma_f32_16x16x32_bf16 v[68:71],a[4:7],v[228:231],v[68:71]
v_mfma_f32_16x16x32_bf16 v[76:79],a[132:135],v[228:231],v[76:79]
ds_read_b128 v[224:227],v17 offset:20480
s_waitcnt lgkmcnt(5)
v_mfma_f32_16x16x32_bf16 v[68:71],a[8:11],v[232:235],v[68:71]
v_min3_u32 v27,v27,v232,v236
v_mul_f32 v88,v64,v64
v_mul_f32 v92,v72,v72
v_mfma_f32_16x16x32_bf16 v[76:79],a[136:139],v[232:235],v[76:79]
ds_read_b128 v[228:231],v43 offset:20480
v_mul_f32 v89,v65,v65
v_mul_f32 v93,v73,v73
v_mfma_f32_16x16x32_bf16 v[68:71],a[12:15],v[236:239],v[68:71]
v_mul_f32 v90,v66,v66
v_mul_f32 v91,v67,v67
v_mul_f32 v94,v74,v74
v_mfma_f32_16x16x32_bf16 v[76:79],a[140:143],v[236:239],v[76:79]
ds_read_b128 v[232:235],v17 offset:28672
v_mul_f32 v95,v75,v75
s_waitcnt lgkmcnt(5)
v_mfma_f32_16x16x32_bf16 v[68:71],a[64:67],v[240:243],v[68:71]
v_min3_u32 v27,v27,v240,v244
v_fma_f32 v88,v88,s81,v28
v_fma_f32 v92,v92,s81,v28
v_mfma_f32_16x16x32_bf16 v[76:79],a[192:195],v[240:243],v[76:79]
ds_read_b128 v[236:239],v43 offset:28672
v_fma_f32 v89,v89,s81,v28
v_fma_f32 v93,v93,s81,v28
v_mfma_f32_16x16x32_bf16 v[68:71],a[68:71],v[244:247],v[68:71]
v_fma_f32 v90,v90,s81,v28
v_fma_f32 v91,v91,s81,v28
v_fma_f32 v94,v94,s81,v28
v_mfma_f32_16x16x32_bf16 v[76:79],a[196:199],v[244:247],v[76:79]
ds_read_b128 v[240:243],v17 offset:21504
v_fma_f32 v95,v95,s81,v28
s_waitcnt lgkmcnt(5)
v_mfma_f32_16x16x32_bf16 v[68:71],a[72:75],v[248:251],v[68:71]
v_min3_u32 v27,v27,v248,v252
v_mul_f32 v88,v88,v64
v_mul_f32 v92,v92,v72
v_mfma_f32_16x16x32_bf16 v[76:79],a[200:203],v[248:251],v[76:79]
ds_read_b128 v[244:247],v43 offset:21504
v_mul_f32 v89,v89,v65
v_mul_f32 v93,v93,v73
v_mfma_f32_16x16x32_bf16 v[68:71],a[76:79],v[252:255],v[68:71]
v_mul_f32 v90,v90,v66
v_mul_f32 v91,v91,v67
v_mul_f32 v94,v94,v74
v_mfma_f32_16x16x32_bf16 v[76:79],a[204:207],v[252:255],v[76:79]
ds_read_b128 v[248:251],v17 offset:29696
v_mul_f32 v95,v95,v75
s_waitcnt lgkmcnt(5)
v_mfma_f32_16x16x32_bf16 v[68:71],a[16:19],v[224:227],v[68:71]
v_min3_u32 v27,v27,v224,v228
v_exp_f32 v92,v92
v_mfma_f32_16x16x32_bf16 v[76:79],a[144:147],v[224:227],v[76:79]
ds_read_b128 v[252:255],v43 offset:29696
v_exp_f32 v93,v93
v_mfma_f32_16x16x32_bf16 v[68:71],a[20:23],v[228:231],v[68:71]
v_exp_f32 v88,v88
v_mfma_f32_16x16x32_bf16 v[76:79],a[148:151],v[228:231],v[76:79]
ds_read_b128 v[224:227],v17 offset:36864
s_waitcnt lgkmcnt(5)
v_mfma_f32_16x16x32_bf16 v[68:71],a[24:27],v[232:235],v[68:71]
v_min3_u32 v27,v27,v232,v236
v_exp_f32 v94,v94
v_mfma_f32_16x16x32_bf16 v[76:79],a[152:155],v[232:235],v[76:79]
ds_read_b128 v[228:231],v43 offset:36864
v_exp_f32 v95,v95
v_mfma_f32_16x16x32_bf16 v[68:71],a[28:31],v[236:239],v[68:71]
v_exp_f32 v89,v89
v_add_f32 v92,1.0,v92
v_mfma_f32_16x16x32_bf16 v[76:79],a[156:159],v[236:239],v[76:79]
ds_read_b128 v[232:235],v17 offset:45056
v_add_f32 v93,1.0,v93
s_waitcnt lgkmcnt(5)
v_mfma_f32_16x16x32_bf16 v[68:71],a[80:83],v[240:243],v[68:71]
v_min3_u32 v27,v27,v240,v244
v_add_f32 v94,1.0,v94
v_add_f32 v95,1.0,v95
v_mfma_f32_16x16x32_bf16 v[76:79],a[208:211],v[240:243],v[76:79]
ds_read_b128 v[236:239],v43 offset:45056
v_rcp_f32 v92,v92
v_mfma_f32_16x16x32_bf16 v[68:71],a[84:87],v[244:247],v[68:71]
v_exp_f32 v90,v90
v_mfma_f32_16x16x32_bf16 v[76:79],a[212:215],v[244:247],v[76:79]
ds_read_b128 v[240:243],v17 offset:37888
s_waitcnt lgkmcnt(5)
v_mfma_f32_16x16x32_bf16 v[68:71],a[88:91],v[248:251],v[68:71]
v_min3_u32 v27,v27,v248,v252
v_rcp_f32 v93,v93
v_mfma_f32_16x16x32_bf16 v[76:79],a[216:219],v[248:251],v[76:79]
ds_read_b128 v[244:247],v43 offset:37888
v_rcp_f32 v94,v94
v_mfma_f32_16x16x32_bf16 v[68:71],a[92:95],v[252:255],v[68:71]
v_exp_f32 v91,v91
v_mfma_f32_16x16x32_bf16 v[76:79],a[220:223],v[252:255],v[76:79]
ds_read_b128 v[248:251],v17 offset:46080
s_waitcnt lgkmcnt(5)
v_mfma_f32_16x16x32_bf16 v[68:71],a[32:35],v[224:227],v[68:71]
v_min3_u32 v27,v27,v224,v228
v_add_f32 v88,1.0,v88
v_mfma_f32_16x16x32_bf16 v[76:79],a[160:163],v[224:227],v[76:79]
ds_read_b128 v[252:255],v43 offset:46080
v_add_f32 v89,1.0,v89
v_mfma_f32_16x16x32_bf16 v[68:71],a[36:39],v[228:231],v[68:71]
v_add_f32 v90,1.0,v90
v_add_f32 v91,1.0,v91
v_mfma_f32_16x16x32_bf16 v[76:79],a[164:167],v[228:231],v[76:79]
ds_read_b128 v[224:227],v17 offset:53248
s_waitcnt lgkmcnt(5)
v_mfma_f32_16x16x32_bf16 v[68:71],a[40:43],v[232:235],v[68:71]
v_min3_u32 v27,v27,v232,v236
v_mfma_f32_16x16x32_bf16 v[76:79],a[168:171],v[232:235],v[76:79]
ds_read_b128 v[228:231],v43 offset:53248
v_mfma_f32_16x16x32_bf16 v[68:71],a[44:47],v[236:239],v[68:71]
v_rcp_f32 v88,v88
v_mfma_f32_16x16x32_bf16 v[76:79],a[172:175],v[236:239],v[76:79]
ds_read_b128 v[232:235],v17 offset:61440
s_waitcnt lgkmcnt(5)
v_mfma_f32_16x16x32_bf16 v[68:71],a[96:99],v[240:243],v[68:71]
v_min3_u32 v27,v27,v240,v244
v_mfma_f32_16x16x32_bf16 v[76:79],a[224:227],v[240:243],v[76:79]
ds_read_b128 v[236:239],v43 offset:61440
v_mfma_f32_16x16x32_bf16 v[68:71],a[100:103],v[244:247],v[68:71]
v_rcp_f32 v89,v89
v_mfma_f32_16x16x32_bf16 v[76:79],a[228:231],v[244:247],v[76:79]
ds_read_b128 v[240:243],v17 offset:54272
s_waitcnt lgkmcnt(5)
v_mfma_f32_16x16x32_bf16 v[68:71],a[104:107],v[248:251],v[68:71]
v_min3_u32 v27,v27,v248,v252
v_mfma_f32_16x16x32_bf16 v[76:79],a[232:235],v[248:251],v[76:79]
ds_read_b128 v[244:247],v43 offset:54272
v_mfma_f32_16x16x32_bf16 v[68:71],a[108:111],v[252:255],v[68:71]
v_rcp_f32 v90,v90
v_mfma_f32_16x16x32_bf16 v[76:79],a[236:239],v[252:255],v[76:79]
ds_read_b128 v[248:251],v17 offset:62464
s_waitcnt lgkmcnt(5)
v_mfma_f32_16x16x32_bf16 v[68:71],a[48:51],v[224:227],v[68:71]
v_min3_u32 v27,v27,v224,v228
v_mfma_f32_16x16x32_bf16 v[76:79],a[176:179],v[224:227],v[76:79]
ds_read_b128 v[252:255],v43 offset:62464
v_mfma_f32_16x16x32_bf16 v[68:71],a[52:55],v[228:231],v[68:71]
v_rcp_f32 v91,v91
v_mfma_f32_16x16x32_bf16 v[76:79],a[180:183],v[228:231],v[76:79]
v_mul_f32 v88,v88,v64
s_waitcnt lgkmcnt(4)
v_mfma_f32_16x16x32_bf16 v[68:71],a[56:59],v[232:235],v[68:71]
v_min3_u32 v27,v27,v232,v236
v_mul_f32 v89,v89,v65
v_mfma_f32_16x16x32_bf16 v[76:79],a[184:187],v[232:235],v[76:79]
v_mul_f32 v90,v90,v66
v_mul_f32 v91,v91,v67
v_mfma_f32_16x16x32_bf16 v[68:71],a[60:63],v[236:239],v[68:71]
v_rcp_f32 v95,v95
v_mfma_f32_16x16x32_bf16 v[76:79],a[188:191],v[236:239],v[76:79]
v_mul_f32 v92,v92,v72
s_waitcnt lgkmcnt(2)
v_mfma_f32_16x16x32_bf16 v[68:71],a[112:115],v[240:243],v[68:71]
v_min3_u32 v27,v27,v240,v244
v_mul_f32 v93,v93,v73
v_mfma_f32_16x16x32_bf16 v[76:79],a[240:243],v[240:243],v[76:79]
v_mul_f32 v94,v94,v74
v_mul_f32 v95,v95,v75
v_mfma_f32_16x16x32_bf16 v[68:71],a[116:119],v[244:247],v[68:71]
v_cvt_pk_bf16_f32 v96,v88,v89
v_cvt_pk_bf16_f32 v97,v90,v91
v_mfma_f32_16x16x32_bf16 v[76:79],a[244:247],v[244:247],v[76:79]
v_cvt_pk_bf16_f32 v98,v92,v93
s_waitcnt lgkmcnt(0)
v_mfma_f32_16x16x32_bf16 v[68:71],a[120:123],v[248:251],v[68:71]
v_min3_u32 v27,v27,v248,v252
v_cvt_pk_bf16_f32 v99,v94,v95
v_mfma_f32_16x16x32_bf16 v[76:79],a[248:251],v[248:251],v[76:79]
v_max_u32 v96,1,v96
v_mfma_f32_16x16x32_bf16 v[68:71],a[124:127],v[252:255],v[68:71]
buffer_store_dwordx4 v[96:99],v18,s[20:23],s78 offen sc1
v_mfma_f32_16x16x32_bf16 v[76:79],a[252:255],v[252:255],v[76:79]
v_cmp_eq_u32 vcc,0,v27
s_cbranch_vccnz retry_222
epi_225:
buffer_load_dword v29,v21,s[20:23],s87 offen sc1
s_cmp_gt_u32 s71,40
s_cselect_b32 s65,s73,0x7fff0000
s_cselect_b32 s97,0x7fff0000,s73
v_mov_b32 v22,s71
buffer_store_dword v22,v23,s[24:27],s65 offen
buffer_store_dword v22,v23,s[28:31],s65 offen sc1
v_pk_mul_f32 v[88:89],v[68:69],v[68:69]
v_pk_mul_f32 v[90:91],v[70:71],v[70:71]
v_pk_mul_f32 v[92:93],v[76:77],v[76:77]
v_pk_mul_f32 v[94:95],v[78:79],v[78:79]
v_pk_fma_f32 v[88:89],v[88:89],s[80:81],v[28:29] op_sel:[0,1,0] op_sel_hi:[1,1,0]
v_pk_fma_f32 v[90:91],v[90:91],s[80:81],v[28:29] op_sel:[0,1,0] op_sel_hi:[1,1,0]
v_pk_fma_f32 v[92:93],v[92:93],s[80:81],v[28:29] op_sel:[0,1,0] op_sel_hi:[1,1,0]
v_pk_fma_f32 v[94:95],v[94:95],s[80:81],v[28:29] op_sel:[0,1,0] op_sel_hi:[1,1,0]
v_pk_mul_f32 v[88:89],v[88:89],v[68:69]
v_pk_mul_f32 v[90:91],v[90:91],v[70:71]
v_pk_mul_f32 v[92:93],v[92:93],v[76:77]
v_pk_mul_f32 v[94:95],v[94:95],v[78:79]
v_exp_f32 v88,v88
v_exp_f32 v89,v89
v_exp_f32 v90,v90
v_exp_f32 v91,v91
v_exp_f32 v92,v92
v_exp_f32 v93,v93
v_exp_f32 v94,v94
v_exp_f32 v95,v95
v_pk_add_f32 v[88:89],v[88:89],1.0 op_sel_hi:[1,0]
v_pk_add_f32 v[90:91],v[90:91],1.0 op_sel_hi:[1,0]
v_pk_add_f32 v[92:93],v[92:93],1.0 op_sel_hi:[1,0]
v_pk_add_f32 v[94:95],v[94:95],1.0 op_sel_hi:[1,0]
v_rcp_f32 v88,v88
v_rcp_f32 v89,v89
v_rcp_f32 v90,v90
v_rcp_f32 v91,v91
v_rcp_f32 v92,v92
v_rcp_f32 v93,v93
v_rcp_f32 v94,v94
v_rcp_f32 v95,v95
v_pk_mul_f32 v[88:89],v[88:89],v[68:69]
v_pk_mul_f32 v[90:91],v[90:91],v[70:71]
v_pk_mul_f32 v[92:93],v[92:93],v[76:77]
v_pk_mul_f32 v[94:95],v[94:95],v[78:79]
v_cvt_pk_bf16_f32 v96,v88,v89
v_cvt_pk_bf16_f32 v97,v90,v91
v_cvt_pk_bf16_f32 v98,v92,v93
v_cvt_pk_bf16_f32 v99,v94,v95
v_max_u32 v96,1,v96
buffer_store_dwordx4 v[96:99],v19,s[20:23],s78 offen sc1
v_xor_b32 v18,0x2000,v18
v_xor_b32 v19,0x2000,v19
s_add_u32 s78,s78,2097152
next_232:
v_xor_b32 v43,0x10000,v43
v_xor_b32 v17,0x10000,v17
s_xor_b32 s72,s72,0x10000
s_add_u32 s70,s70,2097152
s_xor_b32 s70,s70,0x2000
s_add_u32 s71,s71,1
s_cmp_le_u32 s71,64
s_cbranch_scc1 seg_223
s_add_u32 s65,s73,2560
v_add_u32 v22,s71,-1
buffer_store_dword v22,v23,s[20:23],s65 offen sc1
s_endpgm
retry_222:
s_sub_u32 s90,s90,64
s_cmp_lt_i32 s90,0
s_cbranch_scc1 giveup_197
s_mov_b32 s83,1
s_waitcnt vmcnt(0) lgkmcnt(0)
s_barrier
s_branch seg_223
r_w2_217:
s_load_dwordx2 s[4:5],s[0:1],72
s_and_b32 s41,s59,7
s_lshl_b32 s66,s41,8
s_lshl_b32 s67,s50,1
s_waitcnt lgkmcnt(0)
s_mov_b32 s32,s4
s_and_b32 s33,s5,0xffff
s_mov_b32 s34,0x200000
s_mov_b32 s35,0x20000
v_lshrrev_b32 v5,2,v3
v_lshl_add_u32 v5,v4,2,v5
v_and_b32 v6,3,v3
v_lshlrev_b32 v6,3,v6
v_lshl_add_u32 v6,v5,8,v6
v_and_b32 v5,7,v5
v_xor_b32 v5,s67,v5
v_lshl_add_u32 v12,v5,5,v6
v_xor_b32 v13,32,v12
v_and_b32 v5,15,v1
v_and_b32 v6,3,v4
v_lshlrev_b32 v6,1,v6
v_xor_b32 v5,v5,v6
v_mul_u32_u24 v6,2048,v4
v_xor_b32 v7,0,v5
v_lshl_add_u32 v8,v7,4,v6
v_xor_b32 v7,8,v5
v_lshl_add_u32 v9,v7,4,v6
s_mul_i32 s74,s50,131072
s_add_u32 s74,s74,s66
s_lshl_b32 s75,s50,14
s_mul_i32 s76,s50,65536
s_add_u32 s76,s76,s66
s_lshl_b32 s77,s50,13
s_add_u32 s64,s74,0
s_add_u32 m0,s75,0
s_nop 0
buffer_load_dwordx4 v8,s[32:35],s64 offen nt lds
s_add_u32 s64,s74,8192
s_add_u32 m0,s75,1024
s_nop 0
buffer_load_dwordx4 v9,s[32:35],s64 offen nt lds
s_add_u32 s64,s74,16384
s_add_u32 m0,s75,2048
s_nop 0
buffer_load_dwordx4 v8,s[32:35],s64 offen nt lds
s_add_u32 s64,s74,24576
s_add_u32 m0,s75,3072
s_nop 0
buffer_load_dwordx4 v9,s[32:35],s64 offen nt lds
s_add_u32 s64,s74,32768
s_add_u32 m0,s75,4096
s_nop 0
buffer_load_dwordx4 v8,s[32:35],s64 offen nt lds
s_add_u32 s64,s74,40960
s_add_u32 m0,s75,5120
s_nop 0
buffer_load_dwordx4 v9,s[32:35],s64 offen nt lds
s_add_u32 s64,s74,49152
s_add_u32 m0,s75,6144
s_nop 0
buffer_load_dwordx4 v8,s[32:35],s64 offen nt lds
s_add_u32 s64,s74,57344
s_add_u32 m0,s75,7168
s_nop 0
buffer_load_dwordx4 v9,s[32:35],s64 offen nt lds
s_add_u32 s64,s74,65536
s_add_u32 m0,s75,8192
s_nop 0
buffer_load_dwordx4 v8,s[32:35],s64 offen nt lds
s_add_u32 s64,s74,73728
s_add_u32 m0,s75,9216
s_nop 0
buffer_load_dwordx4 v9,s[32:35],s64 offen nt lds
s_add_u32 s64,s74,81920
s_add_u32 m0,s75,10240
s_nop 0
buffer_load_dwordx4 v8,s[32:35],s64 offen nt lds
s_add_u32 s64,s74,90112
s_add_u32 m0,s75,11264
s_nop 0
buffer_load_dwordx4 v9,s[32:35],s64 offen nt lds
s_add_u32 s64,s74,98304
s_add_u32 m0,s75,12288
s_nop 0
buffer_load_dwordx4 v8,s[32:35],s64 offen nt lds
s_add_u32 s64,s74,106496
s_add_u32 m0,s75,13312
s_nop 0
buffer_load_dwordx4 v9,s[32:35],s64 offen nt lds
s_add_u32 s64,s74,114688
s_add_u32 m0,s75,14336
s_nop 0
buffer_load_dwordx4 v8,s[32:35],s64 offen nt lds
s_add_u32 s64,s74,122880
s_add_u32 m0,s75,15360
s_nop 0
buffer_load_dwordx4 v9,s[32:35],s64 offen nt lds
s_add_u32 s64,s74,524288
s_add_u32 m0,s75,65536
s_nop 0
buffer_load_dwordx4 v8,s[32:35],s64 offen nt lds
s_add_u32 s64,s74,532480
s_add_u32 m0,s75,66560
s_nop 0
buffer_load_dwordx4 v9,s[32:35],s64 offen nt lds
s_add_u32 s64,s74,540672
s_add_u32 m0,s75,67584
s_nop 0
buffer_load_dwordx4 v8,s[32:35],s64 offen nt lds
s_add_u32 s64,s74,548864
s_add_u32 m0,s75,68608
s_nop 0
buffer_load_dwordx4 v9,s[32:35],s64 offen nt lds
s_add_u32 s64,s74,557056
s_add_u32 m0,s75,69632
s_nop 0
buffer_load_dwordx4 v8,s[32:35],s64 offen nt lds
s_add_u32 s64,s74,565248
s_add_u32 m0,s75,70656
s_nop 0
buffer_load_dwordx4 v9,s[32:35],s64 offen nt lds
s_add_u32 s64,s74,573440
s_add_u32 m0,s75,71680
s_nop 0
buffer_load_dwordx4 v8,s[32:35],s64 offen nt lds
s_add_u32 s64,s74,581632
s_add_u32 m0,s75,72704
s_nop 0
buffer_load_dwordx4 v9,s[32:35],s64 offen nt lds
s_add_u32 s64,s74,589824
s_add_u32 m0,s75,73728
s_nop 0
buffer_load_dwordx4 v8,s[32:35],s64 offen nt lds
s_add_u32 s64,s74,598016
s_add_u32 m0,s75,74752
s_nop 0
buffer_load_dwordx4 v9,s[32:35],s64 offen nt lds
s_add_u32 s64,s74,606208
s_add_u32 m0,s75,75776
s_nop 0
buffer_load_dwordx4 v8,s[32:35],s64 offen nt lds
s_add_u32 s64,s74,614400
s_add_u32 m0,s75,76800
s_nop 0
buffer_load_dwordx4 v9,s[32:35],s64 offen nt lds
s_add_u32 s64,s74,622592
s_add_u32 m0,s75,77824
s_nop 0
buffer_load_dwordx4 v8,s[32:35],s64 offen nt lds
s_add_u32 s64,s74,630784
s_add_u32 m0,s75,78848
s_nop 0
buffer_load_dwordx4 v9,s[32:35],s64 offen nt lds
s_add_u32 s64,s74,638976
s_add_u32 m0,s75,79872
s_nop 0
buffer_load_dwordx4 v8,s[32:35],s64 offen nt lds
s_add_u32 s64,s74,647168
s_add_u32 m0,s75,80896
s_nop 0
buffer_load_dwordx4 v9,s[32:35],s64 offen nt lds
s_waitcnt vmcnt(16)
s_barrier
ds_read_b64_tr_b16 a[0:1],v12 offset:0
ds_read_b64_tr_b16 a[128:129],v13 offset:0
ds_read_b64_tr_b16 a[2:3],v12 offset:4096
ds_read_b64_tr_b16 a[130:131],v13 offset:4096
ds_read_b64_tr_b16 a[4:5],v12 offset:8192
ds_read_b64_tr_b16 a[132:133],v13 offset:8192
ds_read_b64_tr_b16 a[6:7],v12 offset:12288
ds_read_b64_tr_b16 a[134:135],v13 offset:12288
s_waitcnt lgkmcnt(4)
ds_read_b64_tr_b16 a[8:9],v12 offset:16384
ds_read_b64_tr_b16 a[136:137],v13 offset:16384
ds_read_b64_tr_b16 a[10:11],v12 offset:20480
ds_read_b64_tr_b16 a[138:139],v13 offset:20480
ds_read_b64_tr_b16 a[12:13],v12 offset:24576
ds_read_b64_tr_b16 a[140:141],v13 offset:24576
ds_read_b64_tr_b16 a[14:15],v12 offset:28672
ds_read_b64_tr_b16 a[142:143],v13 offset:28672
s_waitcnt lgkmcnt(4)
ds_read_b64_tr_b16 a[16:17],v12 offset:32768
ds_read_b64_tr_b16 a[144:145],v13 offset:32768
ds_read_b64_tr_b16 a[18:19],v12 offset:36864
ds_read_b64_tr_b16 a[146:147],v13 offset:36864
ds_read_b64_tr_b16 a[20:21],v12 offset:40960
ds_read_b64_tr_b16 a[148:149],v13 offset:40960
ds_read_b64_tr_b16 a[22:23],v12 offset:45056
ds_read_b64_tr_b16 a[150:151],v13 offset:45056
s_waitcnt lgkmcnt(4)
ds_read_b64_tr_b16 a[24:25],v12 offset:49152
ds_read_b64_tr_b16 a[152:153],v13 offset:49152
ds_read_b64_tr_b16 a[26:27],v12 offset:53248
ds_read_b64_tr_b16 a[154:155],v13 offset:53248
ds_read_b64_tr_b16 a[28:29],v12 offset:57344
ds_read_b64_tr_b16 a[156:157],v13 offset:57344
ds_read_b64_tr_b16 a[30:31],v12 offset:61440
ds_read_b64_tr_b16 a[158:159],v13 offset:61440
s_waitcnt lgkmcnt(4)
v_xor_b32 v12,0x10000,v12
v_xor_b32 v13,0x10000,v13
s_waitcnt lgkmcnt(0)
s_barrier
s_add_u32 s64,s74,1048576
s_add_u32 m0,s75,0
s_nop 0
buffer_load_dwordx4 v8,s[32:35],s64 offen nt lds
s_add_u32 s64,s74,1056768
s_add_u32 m0,s75,1024
s_nop 0
buffer_load_dwordx4 v9,s[32:35],s64 offen nt lds
s_add_u32 s64,s74,1064960
s_add_u32 m0,s75,2048
s_nop 0
buffer_load_dwordx4 v8,s[32:35],s64 offen nt lds
s_add_u32 s64,s74,1073152
s_add_u32 m0,s75,3072
s_nop 0
buffer_load_dwordx4 v9,s[32:35],s64 offen nt lds
s_add_u32 s64,s74,1081344
s_add_u32 m0,s75,4096
s_nop 0
buffer_load_dwordx4 v8,s[32:35],s64 offen nt lds
s_add_u32 s64,s74,1089536
s_add_u32 m0,s75,5120
s_nop 0
buffer_load_dwordx4 v9,s[32:35],s64 offen nt lds
s_add_u32 s64,s74,1097728
s_add_u32 m0,s75,6144
s_nop 0
buffer_load_dwordx4 v8,s[32:35],s64 offen nt lds
s_add_u32 s64,s74,1105920
s_add_u32 m0,s75,7168
s_nop 0
buffer_load_dwordx4 v9,s[32:35],s64 offen nt lds
s_add_u32 s64,s74,1114112
s_add_u32 m0,s75,8192
s_nop 0
buffer_load_dwordx4 v8,s[32:35],s64 offen nt lds
s_add_u32 s64,s74,1122304
s_add_u32 m0,s75,9216
s_nop 0
buffer_load_dwordx4 v9,s[32:35],s64 offen nt lds
s_add_u32 s64,s74,1130496
s_add_u32 m0,s75,10240
s_nop 0
buffer_load_dwordx4 v8,s[32:35],s64 offen nt lds
s_add_u32 s64,s74,1138688
s_add_u32 m0,s75,11264
s_nop 0
buffer_load_dwordx4 v9,s[32:35],s64 offen nt lds
s_add_u32 s64,s74,1146880
s_add_u32 m0,s75,12288
s_nop 0
buffer_load_dwordx4 v8,s[32:35],s64 offen nt lds
s_add_u32 s64,s74,1155072
s_add_u32 m0,s75,13312
s_nop 0
buffer_load_dwordx4 v9,s[32:35],s64 offen nt lds
s_add_u32 s64,s74,1163264
s_add_u32 m0,s75,14336
s_nop 0
buffer_load_dwordx4 v8,s[32:35],s64 offen nt lds
s_add_u32 s64,s74,1171456
s_add_u32 m0,s75,15360
s_nop 0
buffer_load_dwordx4 v9,s[32:35],s64 offen nt lds
s_waitcnt vmcnt(16)
s_barrier
ds_read_b64_tr_b16 a[32:33],v12 offset:0
ds_read_b64_tr_b16 a[160:161],v13 offset:0
ds_read_b64_tr_b16 a[34:35],v12 offset:4096
ds_read_b64_tr_b16 a[162:163],v13 offset:4096
ds_read_b64_tr_b16 a[36:37],v12 offset:8192
ds_read_b64_tr_b16 a[164:165],v13 offset:8192
ds_read_b64_tr_b16 a[38:39],v12 offset:12288
ds_read_b64_tr_b16 a[166:167],v13 offset:12288
s_waitcnt lgkmcnt(4)
ds_read_b64_tr_b16 a[40:41],v12 offset:16384
ds_read_b64_tr_b16 a[168:169],v13 offset:16384
ds_read_b64_tr_b16 a[42:43],v12 offset:20480
ds_read_b64_tr_b16 a[170:171],v13 offset:20480
ds_read_b64_tr_b16 a[44:45],v12 offset:24576
ds_read_b64_tr_b16 a[172:173],v13 offset:24576
ds_read_b64_tr_b16 a[46:47],v12 offset:28672
ds_read_b64_tr_b16 a[174:175],v13 offset:28672
s_waitcnt lgkmcnt(4)
ds_read_b64_tr_b16 a[48:49],v12 offset:32768
ds_read_b64_tr_b16 a[176:177],v13 offset:32768
ds_read_b64_tr_b16 a[50:51],v12 offset:36864
ds_read_b64_tr_b16 a[178:179],v13 offset:36864
ds_read_b64_tr_b16 a[52:53],v12 offset:40960
ds_read_b64_tr_b16 a[180:181],v13 offset:40960
ds_read_b64_tr_b16 a[54:55],v12 offset:45056
ds_read_b64_tr_b16 a[182:183],v13 offset:45056
s_waitcnt lgkmcnt(4)
ds_read_b64_tr_b16 a[56:57],v12 offset:49152
ds_read_b64_tr_b16 a[184:185],v13 offset:49152
ds_read_b64_tr_b16 a[58:59],v12 offset:53248
ds_read_b64_tr_b16 a[186:187],v13 offset:53248
ds_read_b64_tr_b16 a[60:61],v12 offset:57344
ds_read_b64_tr_b16 a[188:189],v13 offset:57344
ds_read_b64_tr_b16 a[62:63],v12 offset:61440
ds_read_b64_tr_b16 a[190:191],v13 offset:61440
s_waitcnt lgkmcnt(4)
v_xor_b32 v12,0x10000,v12
v_xor_b32 v13,0x10000,v13
s_waitcnt lgkmcnt(0)
s_barrier
s_add_u32 s64,s74,1572864
s_add_u32 m0,s75,65536
s_nop 0
buffer_load_dwordx4 v8,s[32:35],s64 offen nt lds
s_add_u32 s64,s74,1581056
s_add_u32 m0,s75,66560
s_nop 0
buffer_load_dwordx4 v9,s[32:35],s64 offen nt lds
s_add_u32 s64,s74,1589248
s_add_u32 m0,s75,67584
s_nop 0
buffer_load_dwordx4 v8,s[32:35],s64 offen nt lds
s_add_u32 s64,s74,1597440
s_add_u32 m0,s75,68608
s_nop 0
buffer_load_dwordx4 v9,s[32:35],s64 offen nt lds
s_add_u32 s64,s74,1605632
s_add_u32 m0,s75,69632
s_nop 0
buffer_load_dwordx4 v8,s[32:35],s64 offen nt lds
s_add_u32 s64,s74,1613824
s_add_u32 m0,s75,70656
s_nop 0
buffer_load_dwordx4 v9,s[32:35],s64 offen nt lds
s_add_u32 s64,s74,1622016
s_add_u32 m0,s75,71680
s_nop 0
buffer_load_dwordx4 v8,s[32:35],s64 offen nt lds
s_add_u32 s64,s74,1630208
s_add_u32 m0,s75,72704
s_nop 0
buffer_load_dwordx4 v9,s[32:35],s64 offen nt lds
s_add_u32 s64,s74,1638400
s_add_u32 m0,s75,73728
s_nop 0
buffer_load_dwordx4 v8,s[32:35],s64 offen nt lds
s_add_u32 s64,s74,1646592
s_add_u32 m0,s75,74752
s_nop 0
buffer_load_dwordx4 v9,s[32:35],s64 offen nt lds
s_add_u32 s64,s74,1654784
s_add_u32 m0,s75,75776
s_nop 0
buffer_load_dwordx4 v8,s[32:35],s64 offen nt lds
s_add_u32 s64,s74,1662976
s_add_u32 m0,s75,76800
s_nop 0
buffer_load_dwordx4 v9,s[32:35],s64 offen nt lds
s_add_u32 s64,s74,1671168
s_add_u32 m0,s75,77824
s_nop 0
buffer_load_dwordx4 v8,s[32:35],s64 offen nt lds
s_add_u32 s64,s74,1679360
s_add_u32 m0,s75,78848
s_nop 0
buffer_load_dwordx4 v9,s[32:35],s64 offen nt lds
s_add_u32 s64,s74,1687552
s_add_u32 m0,s75,79872
s_nop 0
buffer_load_dwordx4 v8,s[32:35],s64 offen nt lds
s_add_u32 s64,s74,1695744
s_add_u32 m0,s75,80896
s_nop 0
buffer_load_dwordx4 v9,s[32:35],s64 offen nt lds
s_waitcnt vmcnt(16)
s_barrier
ds_read_b64_tr_b16 a[64:65],v12 offset:0
ds_read_b64_tr_b16 a[192:193],v13 offset:0
ds_read_b64_tr_b16 a[66:67],v12 offset:4096
ds_read_b64_tr_b16 a[194:195],v13 offset:4096
ds_read_b64_tr_b16 a[68:69],v12 offset:8192
ds_read_b64_tr_b16 a[196:197],v13 offset:8192
ds_read_b64_tr_b16 a[70:71],v12 offset:12288
ds_read_b64_tr_b16 a[198:199],v13 offset:12288
s_waitcnt lgkmcnt(4)
ds_read_b64_tr_b16 a[72:73],v12 offset:16384
ds_read_b64_tr_b16 a[200:201],v13 offset:16384
ds_read_b64_tr_b16 a[74:75],v12 offset:20480
ds_read_b64_tr_b16 a[202:203],v13 offset:20480
ds_read_b64_tr_b16 a[76:77],v12 offset:24576
ds_read_b64_tr_b16 a[204:205],v13 offset:24576
ds_read_b64_tr_b16 a[78:79],v12 offset:28672
ds_read_b64_tr_b16 a[206:207],v13 offset:28672
s_waitcnt lgkmcnt(4)
ds_read_b64_tr_b16 a[80:81],v12 offset:32768
ds_read_b64_tr_b16 a[208:209],v13 offset:32768
ds_read_b64_tr_b16 a[82:83],v12 offset:36864
ds_read_b64_tr_b16 a[210:211],v13 offset:36864
ds_read_b64_tr_b16 a[84:85],v12 offset:40960
ds_read_b64_tr_b16 a[212:213],v13 offset:40960
ds_read_b64_tr_b16 a[86:87],v12 offset:45056
ds_read_b64_tr_b16 a[214:215],v13 offset:45056
s_waitcnt lgkmcnt(4)
ds_read_b64_tr_b16 a[88:89],v12 offset:49152
ds_read_b64_tr_b16 a[216:217],v13 offset:49152
ds_read_b64_tr_b16 a[90:91],v12 offset:53248
ds_read_b64_tr_b16 a[218:219],v13 offset:53248
ds_read_b64_tr_b16 a[92:93],v12 offset:57344
ds_read_b64_tr_b16 a[220:221],v13 offset:57344
ds_read_b64_tr_b16 a[94:95],v12 offset:61440
ds_read_b64_tr_b16 a[222:223],v13 offset:61440
s_waitcnt lgkmcnt(4)
v_xor_b32 v12,0x10000,v12
v_xor_b32 v13,0x10000,v13
s_waitcnt lgkmcnt(0)
s_barrier
s_waitcnt vmcnt(0)
s_barrier
ds_read_b64_tr_b16 a[96:97],v12 offset:0
ds_read_b64_tr_b16 a[224:225],v13 offset:0
ds_read_b64_tr_b16 a[98:99],v12 offset:4096
ds_read_b64_tr_b16 a[226:227],v13 offset:4096
ds_read_b64_tr_b16 a[100:101],v12 offset:8192
ds_read_b64_tr_b16 a[228:229],v13 offset:8192
ds_read_b64_tr_b16 a[102:103],v12 offset:12288
ds_read_b64_tr_b16 a[230:231],v13 offset:12288
s_waitcnt lgkmcnt(4)
ds_read_b64_tr_b16 a[104:105],v12 offset:16384
ds_read_b64_tr_b16 a[232:233],v13 offset:16384
ds_read_b64_tr_b16 a[106:107],v12 offset:20480
ds_read_b64_tr_b16 a[234:235],v13 offset:20480
ds_read_b64_tr_b16 a[108:109],v12 offset:24576
ds_read_b64_tr_b16 a[236:237],v13 offset:24576
ds_read_b64_tr_b16 a[110:111],v12 offset:28672
ds_read_b64_tr_b16 a[238:239],v13 offset:28672
s_waitcnt lgkmcnt(4)
ds_read_b64_tr_b16 a[112:113],v12 offset:32768
ds_read_b64_tr_b16 a[240:241],v13 offset:32768
ds_read_b64_tr_b16 a[114:115],v12 offset:36864
ds_read_b64_tr_b16 a[242:243],v13 offset:36864
ds_read_b64_tr_b16 a[116:117],v12 offset:40960
ds_read_b64_tr_b16 a[244:245],v13 offset:40960
ds_read_b64_tr_b16 a[118:119],v12 offset:45056
ds_read_b64_tr_b16 a[246:247],v13 offset:45056
s_waitcnt lgkmcnt(4)
ds_read_b64_tr_b16 a[120:121],v12 offset:49152
ds_read_b64_tr_b16 a[248:249],v13 offset:49152
ds_read_b64_tr_b16 a[122:123],v12 offset:53248
ds_read_b64_tr_b16 a[250:251],v13 offset:53248
ds_read_b64_tr_b16 a[124:125],v12 offset:57344
ds_read_b64_tr_b16 a[252:253],v13 offset:57344
ds_read_b64_tr_b16 a[126:127],v12 offset:61440
ds_read_b64_tr_b16 a[254:255],v13 offset:61440
s_waitcnt lgkmcnt(4)
v_xor_b32 v12,0x10000,v12
v_xor_b32 v13,0x10000,v13
s_waitcnt lgkmcnt(0)
s_barrier
v_and_b32 v21,1,v1
v_mul_u32_u24 v21,960,v21
s_mov_b32 s65,21052032
s_mov_b32 s66,1792
pl_237:
buffer_load_dword v22,v21,s[20:23],s65 offen sc1
s_waitcnt vmcnt(0)
v_cmp_gt_u32 vcc,s66,v22
s_cbranch_vccz pok_238
s_sleep 1
s_sub_u32 s90,s90,1
s_cmp_gt_i32 s90,0
s_cbranch_scc1 pl_237
pok_238:
s_mov_b32 s81,0xbdd2d3e8
v_mov_b32 v28,0xc0135761
v_mov_b32 v17,v16
v_and_b32 v21,31,v1
v_lshlrev_b32 v21,2,v21
s_mul_i32 s74,s79,40
s_add_u32 s74,s74,s63
s_add_u32 s74,s74,3072
s_lshl_b32 s42,s41,2
s_add_u32 s42,s42,s50
s_lshl_b32 s73,s41,7
s_lshl_b32 s64,s50,2
s_add_u32 s73,s73,s64
s_add_u32 s73,s73,s63
s_add_u32 s73,s73,6144
s_add_u32 s73,s73,s60
s_lshl_b32 s43,s50,11
s_lshl_b32 s78,s79,21
s_add_u32 s78,s78,27262976
s_mov_b32 s64,0
s_lshr_b32 s65,s50,1
s_and_b32 s66,s50,1
s_lshl_b32 s66,s66,12
s_add_u32 s66,s66,s64
s_lshl_b32 s72,s65,13
s_add_u32 s72,s72,s66
s_add_u32 s72,s72,0x10000
s_lshl_b32 s65,s65,14
s_add_u32 s75,s65,s66
s_add_u32 s75,s75,1966080
s_add_u32 s64,s41,72
s_lshl_b32 s64,s64,14
s_add_u32 s64,s64,s43
v_add_u32 v18,s64,v16
s_lshl_b32 s64,s42,8
s_add_u32 s64,s64,1310720
v_lshl_add_u32 v24,v3,4,s64
v_mov_b32 v5,0x40000000
v_cmp_gt_u32 vcc,16,v1
s_nop 1
v_cndmask_b32 v24,v5,v24,vcc
s_lshl_b32 s64,s42,6
v_and_b32 v5,3,v1
v_xor_b32 v5,v5,v4
v_lshl_add_u32 v5,v5,4,s64
v_lshrrev_b32 v11,2,v1
s_add_u32 s43,s43,133120
v_lshrrev_b32 v6,2,v3
v_lshrrev_b32 v7,1,v4
v_xor_b32 v6,v6,v7
v_lshlrev_b32 v6,4,v6
v_lshl_add_u32 v6,v3,6,v6
v_and_b32 v7,1,v4
v_lshl_add_u32 v6,v7,3,v6
v_add_u32 v40,s43,v6
v_xor_b32 v41,32,v40
v_add_u32 v6,30,v11
v_lshl_add_u32 v9,v6,7,v5
v_and_b32 v9,2047,v9
v_and_b32 v7,3,v6
v_lshl_add_u32 v7,v7,11,v9
v_bfe_u32 v8,v6,2,3
v_lshl_add_u32 v7,v8,14,v7
v_mov_b32 v8,0x2000
v_mov_b32 v9,2097152
v_cmp_gt_u32 vcc,32,v6
s_nop 1
v_cndmask_b32 v8,v9,v8,vcc
v_add_u32 v7,v7,v8
v_add_u32 v7,0,v7
v_xor_b32 v19,s62,v7
v_xor_b32 v19,0x2000,v19
v_add_u32 v6,46,v11
v_lshl_add_u32 v9,v6,7,v5
v_and_b32 v9,2047,v9
v_and_b32 v7,3,v6
v_lshl_add_u32 v7,v7,11,v9
v_bfe_u32 v8,v6,2,3
v_lshl_add_u32 v7,v8,14,v7
v_mov_b32 v8,0x2000
v_mov_b32 v9,2097152
v_cmp_gt_u32 vcc,32,v6
s_nop 1
v_cndmask_b32 v8,v9,v8,vcc
v_add_u32 v7,v7,v8
v_add_u32 v7,0,v7
v_xor_b32 v20,s62,v7
v_xor_b32 v20,0x2000,v20
s_add_u32 s64,s79,0
s_lshl_b32 s70,s64,21
s_lshl_b32 s64,s64,13
s_and_b32 s64,s64,0x2000
s_xor_b32 s64,s64,s62
s_add_u32 s70,s70,s64
s_add_u32 s70,s70,29360128
s_mov_b32 s83,1
s_mov_b32 s87,s74
s_cmp_eq_u32 s50,0
s_cselect_b32 s74,s74,0x7fff0000
v_mov_b32 v47,132096
s_lshl_b32 s64,s50,3
s_add_u32 s64,s64,132096
v_mov_b32 v46,s64
v_mov_b32 v29,0
s_mov_b32 s97,0x7fff0000
s_mov_b32 s69,1
s_mov_b32 s68,0
s_mov_b32 s52,0x30003
s_mov_b32 s53,s52
seg_240:
s_cmp_eq_u32 s83,0
s_cbranch_scc1 ahead_241
s_add_u32 s94,s70,s75
s_cmp_eq_u32 s71,65
s_cselect_b32 s64,2097152,0
s_cselect_b32 s65,0x2000,0
s_sub_u32 s94,s94,s64
s_xor_b32 s94,s94,s65
s_xor_b32 s95,s94,1024
s_xor_b32 s91,s72,0x10000
s_cmp_eq_u32 s69,0
s_mov_b32 s69,1
s_cbranch_scc1 half2_245
s_min_u32 s66,s71,64
s_waitcnt vmcnt(3)
v_cmp_gt_u32 vcc,s66,v29
s_cbranch_vccz nb_244
s_waitcnt vmcnt(0)
v_add_u32 v22,s71,-1
buffer_store_dword v22,v23,s[20:23],s97 offen sc1
s_mov_b32 s97,0x7fff0000
s_cmp_lg_u32 s50,0
s_cbranch_scc1 nb_244
buffer_load_dword v32,v21,s[20:23],s74 offen sc1
s_sleep 2
pl_246:
buffer_load_dword v33,v21,s[20:23],s74 offen sc1
s_waitcnt vmcnt(1)
v_cmp_gt_u32 vcc,s66,v32
v_mov_b32 v29,v32
s_cbranch_vccz pok_247
buffer_load_dword v32,v21,s[20:23],s74 offen sc1
s_waitcnt vmcnt(1)
v_cmp_gt_u32 vcc,s66,v33
v_mov_b32 v29,v33
s_cbranch_vccz pok_247
s_sub_u32 s90,s90,1
s_cmp_gt_i32 s90,0
s_cbranch_scc1 pl_246
pok_247:
nb_244:
s_cmp_eq_u32 s71,64
s_barrier
s_cbranch_scc1 half_248
s_xor_b32 m0,s91,0
s_add_u32 s65,s94,0
buffer_load_dwordx4 v16,s[20:23],s65 offen offset:0 sc1 lds
buffer_load_dwordx4 v16,s[20:23],s65 offen offset:2048 sc1 lds
s_xor_b32 m0,s91,16384
s_add_u32 s65,s94,32768
buffer_load_dwordx4 v16,s[20:23],s65 offen offset:0 sc1 lds
buffer_load_dwordx4 v16,s[20:23],s65 offen offset:2048 sc1 lds
s_xor_b32 m0,s91,32768
s_add_u32 s65,s94,65536
buffer_load_dwordx4 v16,s[20:23],s65 offen offset:0 sc1 lds
buffer_load_dwordx4 v16,s[20:23],s65 offen offset:2048 sc1 lds
s_xor_b32 m0,s91,49152
s_add_u32 s65,s94,98304
buffer_load_dwordx4 v16,s[20:23],s65 offen offset:0 sc1 lds
buffer_load_dwordx4 v16,s[20:23],s65 offen offset:2048 sc1 lds
s_waitcnt vmcnt(8)
v_add_u32 v22,s71,-1
buffer_store_dword v22,v23,s[20:23],s97 offen sc1
s_mov_b32 s97,0x7fff0000
s_waitcnt vmcnt(7)
s_barrier
ds_read_b128 v[224:227],v17 offset:0
ds_read_b128 v[228:231],v17 offset:2048
ds_read_b128 v[232:235],v17 offset:4096
ds_read_b128 v[236:239],v17 offset:6144
ds_read_b128 v[240:243],v17 offset:8192
ds_read_b128 v[244:247],v17 offset:10240
ds_read_b128 v[248:251],v17 offset:12288
s_waitcnt lgkmcnt(5)
v_mfma_f32_16x16x32_bf16 v[64:67],a[0:3],v[224:227],0
s_xor_b32 m0,s91,1024
s_add_u32 s96,s71,1
s_add_u32 s92,s71,2
v_min_u32 v27,v224,v228
v_mfma_f32_16x16x32_bf16 v[72:75],a[128:131],v[224:227],0
ds_read_b128 v[252:255],v17 offset:14336
s_cmp_eq_u32 s96,64
s_cselect_b32 s96,99,s96
v_mfma_f32_16x16x32_bf16 v[64:67],a[4:7],v[228:231],v[64:67]
s_add_u32 s65,s95,0
s_cmp_eq_u32 s92,64
s_cselect_b32 s92,99,s92
v_mfma_f32_16x16x32_bf16 v[72:75],a[132:135],v[228:231],v[72:75]
s_waitcnt vmcnt(5)
s_barrier
ds_read_b128 v[224:227],v17 offset:16384
s_waitcnt lgkmcnt(5)
v_mfma_f32_16x16x32_bf16 v[64:67],a[8:11],v[232:235],v[64:67]
buffer_load_dwordx4 v16,s[20:23],s65 offen offset:0 sc1 lds
v_min3_u32 v27,v27,v232,v236
v_mfma_f32_16x16x32_bf16 v[72:75],a[136:139],v[232:235],v[72:75]
ds_read_b128 v[228:231],v17 offset:18432
s_cmp_eq_u32 s96,65
s_cselect_b32 s96,64,s96
v_mfma_f32_16x16x32_bf16 v[64:67],a[12:15],v[236:239],v[64:67]
buffer_load_dwordx4 v16,s[20:23],s65 offen offset:2048 sc1 lds
v_mfma_f32_16x16x32_bf16 v[72:75],a[140:143],v[236:239],v[72:75]
ds_read_b128 v[232:235],v17 offset:20480
s_waitcnt lgkmcnt(5)
v_mfma_f32_16x16x32_bf16 v[64:67],a[16:19],v[240:243],v[64:67]
s_xor_b32 m0,s91,17408
v_min3_u32 v27,v27,v240,v244
v_mfma_f32_16x16x32_bf16 v[72:75],a[144:147],v[240:243],v[72:75]
ds_read_b128 v[236:239],v17 offset:22528
v_mfma_f32_16x16x32_bf16 v[64:67],a[20:23],v[244:247],v[64:67]
s_add_u32 s65,s95,32768
v_mfma_f32_16x16x32_bf16 v[72:75],a[148:151],v[244:247],v[72:75]
ds_read_b128 v[240:243],v17 offset:24576
s_waitcnt lgkmcnt(5)
v_mfma_f32_16x16x32_bf16 v[64:67],a[24:27],v[248:251],v[64:67]
buffer_load_dwordx4 v16,s[20:23],s65 offen offset:0 sc1 lds
v_mfma_f32_16x16x32_bf16 v[72:75],a[152:155],v[248:251],v[72:75]
ds_read_b128 v[244:247],v17 offset:26624
v_min3_u32 v27,v27,v248,v252
v_mfma_f32_16x16x32_bf16 v[64:67],a[28:31],v[252:255],v[64:67]
buffer_load_dwordx4 v16,s[20:23],s65 offen offset:2048 sc1 lds
v_mfma_f32_16x16x32_bf16 v[72:75],a[156:159],v[252:255],v[72:75]
ds_read_b128 v[248:251],v17 offset:28672
s_waitcnt lgkmcnt(5)
v_mfma_f32_16x16x32_bf16 v[64:67],a[32:35],v[224:227],v[64:67]
s_xor_b32 m0,s91,33792
v_min3_u32 v27,v27,v224,v228
v_mfma_f32_16x16x32_bf16 v[72:75],a[160:163],v[224:227],v[72:75]
ds_read_b128 v[252:255],v17 offset:30720
v_mfma_f32_16x16x32_bf16 v[64:67],a[36:39],v[228:231],v[64:67]
s_add_u32 s65,s95,65536
v_mfma_f32_16x16x32_bf16 v[72:75],a[164:167],v[228:231],v[72:75]
s_waitcnt vmcnt(5)
s_barrier
ds_read_b128 v[224:227],v17 offset:32768
s_waitcnt lgkmcnt(5)
v_mfma_f32_16x16x32_bf16 v[64:67],a[40:43],v[232:235],v[64:67]
buffer_load_dwordx4 v16,s[20:23],s65 offen offset:0 sc1 lds
v_mfma_f32_16x16x32_bf16 v[72:75],a[168:171],v[232:235],v[72:75]
ds_read_b128 v[228:231],v17 offset:34816
v_min3_u32 v27,v27,v232,v236
v_mfma_f32_16x16x32_bf16 v[64:67],a[44:47],v[236:239],v[64:67]
buffer_load_dwordx4 v16,s[20:23],s65 offen offset:2048 sc1 lds
v_mfma_f32_16x16x32_bf16 v[72:75],a[172:175],v[236:239],v[72:75]
ds_read_b128 v[232:235],v17 offset:36864
s_waitcnt lgkmcnt(5)
v_mfma_f32_16x16x32_bf16 v[64:67],a[48:51],v[240:243],v[64:67]
s_xor_b32 m0,s91,50176
v_min3_u32 v27,v27,v240,v244
v_mfma_f32_16x16x32_bf16 v[72:75],a[176:179],v[240:243],v[72:75]
ds_read_b128 v[236:239],v17 offset:38912
v_mfma_f32_16x16x32_bf16 v[64:67],a[52:55],v[244:247],v[64:67]
s_add_u32 s65,s95,98304
v_mfma_f32_16x16x32_bf16 v[72:75],a[180:183],v[244:247],v[72:75]
ds_read_b128 v[240:243],v17 offset:40960
s_waitcnt lgkmcnt(5)
v_mfma_f32_16x16x32_bf16 v[64:67],a[56:59],v[248:251],v[64:67]
buffer_load_dwordx4 v16,s[20:23],s65 offen offset:0 sc1 lds
v_min3_u32 v27,v27,v248,v252
v_mfma_f32_16x16x32_bf16 v[72:75],a[184:187],v[248:251],v[72:75]
ds_read_b128 v[244:247],v17 offset:43008
s_waitcnt vmcnt(63)
v_mfma_f32_16x16x32_bf16 v[64:67],a[60:63],v[252:255],v[64:67]
buffer_load_dwordx4 v16,s[20:23],s65 offen offset:2048 sc1 lds
v_mfma_f32_16x16x32_bf16 v[72:75],a[188:191],v[252:255],v[72:75]
ds_read_b128 v[248:251],v17 offset:45056
s_waitcnt lgkmcnt(5)
v_mfma_f32_16x16x32_bf16 v[64:67],a[64:67],v[224:227],v[64:67]
v_cmp_gt_u32 vcc,s96,v29
v_cmp_gt_u32 s[92:93],s92,v29
v_mfma_f32_16x16x32_bf16 v[72:75],a[192:195],v[224:227],v[72:75]
ds_read_b128 v[252:255],v17 offset:47104
v_min3_u32 v27,v27,v224,v228
v_mfma_f32_16x16x32_bf16 v[64:67],a[68:71],v[228:231],v[64:67]
v_mov_b32 v44,vcc_lo
v_mov_b32 v45,s92
s_add_u32 m0,s43,0
v_mfma_f32_16x16x32_bf16 v[72:75],a[196:199],v[228:231],v[72:75]
ds_read_b128 v[224:227],v17 offset:49152
s_waitcnt lgkmcnt(5)
v_mfma_f32_16x16x32_bf16 v[64:67],a[72:75],v[232:235],v[64:67]
ds_write_b64 v46,v[44:45]
v_min3_u32 v27,v27,v232,v236
v_mfma_f32_16x16x32_bf16 v[72:75],a[200:203],v[232:235],v[72:75]
ds_read_b128 v[228:231],v17 offset:51200
buffer_load_dwordx4 v19,s[20:23],s78 offen sc1 lds
v_mfma_f32_16x16x32_bf16 v[64:67],a[76:79],v[236:239],v[64:67]
s_add_u32 m0,s43,1024
s_nop 0
buffer_load_dwordx4 v20,s[20:23],s78 offen sc1 lds
v_mfma_f32_16x16x32_bf16 v[72:75],a[204:207],v[236:239],v[72:75]
ds_read_b128 v[232:235],v17 offset:53248
s_waitcnt lgkmcnt(6)
v_mfma_f32_16x16x32_bf16 v[64:67],a[80:83],v[240:243],v[64:67]
v_min3_u32 v27,v27,v240,v244
s_add_u32 s88,s70,s75
v_mfma_f32_16x16x32_bf16 v[72:75],a[208:211],v[240:243],v[72:75]
ds_read_b128 v[236:239],v17 offset:55296
s_add_u32 s88,s88,2097152
v_mfma_f32_16x16x32_bf16 v[64:67],a[84:87],v[244:247],v[64:67]
s_xor_b32 s88,s88,0x2000
s_xor_b32 s89,s88,1024
v_mfma_f32_16x16x32_bf16 v[72:75],a[212:215],v[244:247],v[72:75]
ds_read_b128 v[240:243],v17 offset:57344
s_waitcnt lgkmcnt(6)
v_mfma_f32_16x16x32_bf16 v[64:67],a[88:91],v[248:251],v[64:67]
v_min3_u32 v27,v27,v248,v252
v_mfma_f32_16x16x32_bf16 v[72:75],a[216:219],v[248:251],v[72:75]
ds_read_b128 v[244:247],v17 offset:59392
v_mfma_f32_16x16x32_bf16 v[64:67],a[92:95],v[252:255],v[64:67]
v_mfma_f32_16x16x32_bf16 v[72:75],a[220:223],v[252:255],v[72:75]
ds_read_b128 v[248:251],v17 offset:61440
s_waitcnt lgkmcnt(5)
v_mfma_f32_16x16x32_bf16 v[64:67],a[96:99],v[224:227],v[64:67]
v_min3_u32 v27,v27,v224,v228
v_mfma_f32_16x16x32_bf16 v[72:75],a[224:227],v[224:227],v[72:75]
ds_read_b128 v[252:255],v17 offset:63488
v_mfma_f32_16x16x32_bf16 v[64:67],a[100:103],v[228:231],v[64:67]
v_mfma_f32_16x16x32_bf16 v[72:75],a[228:231],v[228:231],v[72:75]
s_waitcnt vmcnt(6)
s_barrier
ds_read_b64 v[44:45],v47
ds_read_b128 v[224:227],v17 offset:1024
s_waitcnt lgkmcnt(6)
v_mfma_f32_16x16x32_bf16 v[64:67],a[104:107],v[232:235],v[64:67]
v_min3_u32 v27,v27,v232,v236
v_mfma_f32_16x16x32_bf16 v[72:75],a[232:235],v[232:235],v[72:75]
ds_read_b128 v[228:231],v17 offset:3072
v_mfma_f32_16x16x32_bf16 v[64:67],a[108:111],v[236:239],v[64:67]
s_waitcnt vmcnt(0)
ds_read_b64 v[120:121],v40 offset:0
v_mfma_f32_16x16x32_bf16 v[72:75],a[236:239],v[236:239],v[72:75]
ds_read_b128 v[232:235],v17 offset:5120
s_waitcnt lgkmcnt(7)
v_mfma_f32_16x16x32_bf16 v[64:67],a[112:115],v[240:243],v[64:67]
v_min3_u32 v27,v27,v240,v244
ds_read_b64 v[122:123],v41 offset:0
v_mfma_f32_16x16x32_bf16 v[72:75],a[240:243],v[240:243],v[72:75]
ds_read_b128 v[236:239],v17 offset:7168
ds_read_b64 v[124:125],v40 offset:1024
v_mfma_f32_16x16x32_bf16 v[64:67],a[116:119],v[244:247],v[64:67]
ds_read_b64 v[126:127],v41 offset:1024
v_mfma_f32_16x16x32_bf16 v[72:75],a[244:247],v[244:247],v[72:75]
ds_read_b128 v[240:243],v17 offset:9216
s_waitcnt lgkmcnt(10)
v_mfma_f32_16x16x32_bf16 v[64:67],a[120:123],v[248:251],v[64:67]
s_waitcnt lgkmcnt(9)
v_readfirstlane_b32 s93,v45
v_mfma_f32_16x16x32_bf16 v[72:75],a[248:251],v[248:251],v[72:75]
ds_read_b128 v[244:247],v17 offset:11264
v_readfirstlane_b32 s83,v44
s_cmp_lg_u32 s83,0
s_cbranch_scc0 keep_250
v_mfma_f32_16x16x32_bf16 v[64:67],a[124:127],v[252:255],v[64:67]
v_min3_u32 v27,v27,v248,v252
v_mfma_f32_16x16x32_bf16 v[72:75],a[252:255],v[252:255],v[72:75]
ds_read_b128 v[248:251],v17 offset:13312
s_waitcnt lgkmcnt(9)
v_mfma_f32_16x16x32_bf16 v[68:71],a[0:3],v[224:227],0
v_cmp_eq_u32 vcc,0,v27
s_cbranch_vccnz retry_239
v_mfma_f32_16x16x32_bf16 v[76:79],a[128:131],v[224:227],0
ds_read_b128 v[252:255],v17 offset:15360
v_min3_u32 v27,v27,v224,v228
v_mfma_f32_16x16x32_bf16 v[68:71],a[4:7],v[228:231],v[68:71]
v_mfma_f32_16x16x32_bf16 v[76:79],a[132:135],v[228:231],v[76:79]
ds_read_b128 v[224:227],v17 offset:17408
s_waitcnt lgkmcnt(7)
v_mfma_f32_16x16x32_bf16 v[68:71],a[8:11],v[232:235],v[68:71]
v_min3_u32 v27,v27,v232,v236
s_waitcnt lgkmcnt(5)
v_lshlrev_b32 v88,16,v120
v_mfma_f32_16x16x32_bf16 v[76:79],a[136:139],v[232:235],v[76:79]
ds_read_b128 v[228:231],v17 offset:19456
v_and_b32 v89,s80,v120
v_lshlrev_b32 v90,16,v121
v_mfma_f32_16x16x32_bf16 v[68:71],a[12:15],v[236:239],v[68:71]
v_and_b32 v91,s80,v121
v_lshlrev_b32 v92,16,v122
v_and_b32 v93,s80,v122
v_mfma_f32_16x16x32_bf16 v[76:79],a[140:143],v[236:239],v[76:79]
ds_read_b128 v[232:235],v17 offset:21504
v_lshlrev_b32 v94,16,v123
s_waitcnt lgkmcnt(5)
v_mfma_f32_16x16x32_bf16 v[68:71],a[16:19],v[240:243],v[68:71]
v_min3_u32 v27,v27,v240,v244
v_and_b32 v95,s80,v123
v_mfma_f32_16x16x32_bf16 v[76:79],a[144:147],v[240:243],v[76:79]
ds_read_b128 v[236:239],v17 offset:23552
v_add_f32 v88,v64,v88
v_mfma_f32_16x16x32_bf16 v[68:71],a[20:23],v[244:247],v[68:71]
v_add_f32 v89,v65,v89
v_add_f32 v90,v66,v90
v_mfma_f32_16x16x32_bf16 v[76:79],a[148:151],v[244:247],v[76:79]
ds_read_b128 v[240:243],v17 offset:25600
s_waitcnt lgkmcnt(5)
v_mfma_f32_16x16x32_bf16 v[68:71],a[24:27],v[248:251],v[68:71]
v_min3_u32 v27,v27,v248,v252
v_add_f32 v91,v67,v91
v_mfma_f32_16x16x32_bf16 v[76:79],a[152:155],v[248:251],v[76:79]
ds_read_b128 v[244:247],v17 offset:27648
v_add_f32 v92,v72,v92
v_mfma_f32_16x16x32_bf16 v[68:71],a[28:31],v[252:255],v[68:71]
v_add_f32 v93,v73,v93
v_add_f32 v94,v74,v94
v_mfma_f32_16x16x32_bf16 v[76:79],a[156:159],v[252:255],v[76:79]
ds_read_b128 v[248:251],v17 offset:29696
s_waitcnt lgkmcnt(5)
v_mfma_f32_16x16x32_bf16 v[68:71],a[32:35],v[224:227],v[68:71]
v_min3_u32 v27,v27,v224,v228
v_add_f32 v95,v75,v95
v_mfma_f32_16x16x32_bf16 v[76:79],a[160:163],v[224:227],v[76:79]
ds_read_b128 v[252:255],v17 offset:31744
v_cvt_pk_bf16_f32 v96,v88,v89
v_mfma_f32_16x16x32_bf16 v[68:71],a[36:39],v[228:231],v[68:71]
v_cvt_pk_bf16_f32 v97,v90,v91
v_cvt_pk_bf16_f32 v98,v92,v93
v_mfma_f32_16x16x32_bf16 v[76:79],a[164:167],v[228:231],v[76:79]
s_waitcnt vmcnt(2)
s_barrier
ds_read_b128 v[224:227],v17 offset:33792
s_waitcnt lgkmcnt(5)
v_mfma_f32_16x16x32_bf16 v[68:71],a[40:43],v[232:235],v[68:71]
v_min3_u32 v27,v27,v232,v236
v_cvt_pk_bf16_f32 v99,v94,v95
v_mfma_f32_16x16x32_bf16 v[76:79],a[168:171],v[232:235],v[76:79]
ds_read_b128 v[228:231],v17 offset:35840
v_max_u32 v96,1,v96
v_mfma_f32_16x16x32_bf16 v[68:71],a[44:47],v[236:239],v[68:71]
buffer_store_dwordx4 v[96:99],v18,s[20:23],s70 offen offset:0 sc1
v_mfma_f32_16x16x32_bf16 v[76:79],a[172:175],v[236:239],v[76:79]
ds_read_b128 v[232:235],v17 offset:37888
s_waitcnt lgkmcnt(5)
v_mfma_f32_16x16x32_bf16 v[68:71],a[48:51],v[240:243],v[68:71]
v_min3_u32 v27,v27,v240,v244
v_lshlrev_b32 v88,16,v96
v_mfma_f32_16x16x32_bf16 v[76:79],a[176:179],v[240:243],v[76:79]
ds_read_b128 v[236:239],v17 offset:39936
v_and_b32 v89,s80,v96
v_mfma_f32_16x16x32_bf16 v[68:71],a[52:55],v[244:247],v[68:71]
v_lshlrev_b32 v90,16,v97
v_and_b32 v91,s80,v97
v_mfma_f32_16x16x32_bf16 v[76:79],a[180:183],v[244:247],v[76:79]
ds_read_b128 v[240:243],v17 offset:41984
s_waitcnt lgkmcnt(5)
v_mfma_f32_16x16x32_bf16 v[68:71],a[56:59],v[248:251],v[68:71]
v_min3_u32 v27,v27,v248,v252
v_lshlrev_b32 v92,16,v98
v_mfma_f32_16x16x32_bf16 v[76:79],a[184:187],v[248:251],v[76:79]
ds_read_b128 v[244:247],v17 offset:44032
v_and_b32 v93,s80,v98
v_mfma_f32_16x16x32_bf16 v[68:71],a[60:63],v[252:255],v[68:71]
v_lshlrev_b32 v94,16,v99
v_and_b32 v95,s80,v99
v_mfma_f32_16x16x32_bf16 v[76:79],a[188:191],v[252:255],v[76:79]
ds_read_b128 v[248:251],v17 offset:46080
s_waitcnt lgkmcnt(5)
v_mfma_f32_16x16x32_bf16 v[68:71],a[64:67],v[224:227],v[68:71]
v_min3_u32 v27,v27,v224,v228
v_add_f32 v108,v88,v89
v_mfma_f32_16x16x32_bf16 v[76:79],a[192:195],v[224:227],v[76:79]
ds_read_b128 v[252:255],v17 offset:48128
v_mul_f32 v109,v88,v88
v_mfma_f32_16x16x32_bf16 v[68:71],a[68:71],v[228:231],v[68:71]
v_add_f32 v100,v90,v91
v_mul_f32 v101,v89,v89
v_mfma_f32_16x16x32_bf16 v[76:79],a[196:199],v[228:231],v[76:79]
ds_read_b128 v[224:227],v17 offset:50176
s_waitcnt lgkmcnt(5)
v_mfma_f32_16x16x32_bf16 v[68:71],a[72:75],v[232:235],v[68:71]
v_min3_u32 v27,v27,v232,v236
v_fmac_f32 v109,v90,v90
v_mfma_f32_16x16x32_bf16 v[76:79],a[200:203],v[232:235],v[76:79]
ds_read_b128 v[228:231],v17 offset:52224
v_fmac_f32 v101,v91,v91
v_mfma_f32_16x16x32_bf16 v[68:71],a[76:79],v[236:239],v[68:71]
v_fmac_f32 v109,v92,v92
v_fmac_f32 v101,v93,v93
v_mfma_f32_16x16x32_bf16 v[76:79],a[204:207],v[236:239],v[76:79]
ds_read_b128 v[232:235],v17 offset:54272
s_waitcnt lgkmcnt(5)
v_mfma_f32_16x16x32_bf16 v[68:71],a[80:83],v[240:243],v[68:71]
v_min3_u32 v27,v27,v240,v244
v_add_f32 v108,v108,v92
v_mfma_f32_16x16x32_bf16 v[76:79],a[208:211],v[240:243],v[76:79]
ds_read_b128 v[236:239],v17 offset:56320
v_add_f32 v100,v100,v93
v_mfma_f32_16x16x32_bf16 v[68:71],a[84:87],v[244:247],v[68:71]
v_fmac_f32 v109,v94,v94
v_fmac_f32 v101,v95,v95
v_mfma_f32_16x16x32_bf16 v[76:79],a[212:215],v[244:247],v[76:79]
ds_read_b128 v[240:243],v17 offset:58368
s_waitcnt lgkmcnt(5)
v_mfma_f32_16x16x32_bf16 v[68:71],a[88:91],v[248:251],v[68:71]
v_min3_u32 v27,v27,v248,v252
v_add_f32 v108,v108,v94
v_mfma_f32_16x16x32_bf16 v[76:79],a[216:219],v[248:251],v[76:79]
ds_read_b128 v[244:247],v17 offset:60416
v_add_f32 v100,v100,v95
v_mfma_f32_16x16x32_bf16 v[68:71],a[92:95],v[252:255],v[68:71]
v_add_f32 v108,v108,v100
v_add_f32 v109,v109,v101
v_mfma_f32_16x16x32_bf16 v[76:79],a[220:223],v[252:255],v[76:79]
ds_read_b128 v[248:251],v17 offset:62464
s_waitcnt lgkmcnt(5)
v_mfma_f32_16x16x32_bf16 v[68:71],a[96:99],v[224:227],v[68:71]
v_min3_u32 v27,v27,v224,v228
v_mov_b32 v100,v108
v_mfma_f32_16x16x32_bf16 v[76:79],a[224:227],v[224:227],v[76:79]
ds_read_b128 v[252:255],v17 offset:64512
v_mov_b32 v101,v109
v_mfma_f32_16x16x32_bf16 v[68:71],a[100:103],v[228:231],v[68:71]
v_permlane16_swap_b32 v100,v108
v_permlane16_swap_b32 v101,v109
v_mfma_f32_16x16x32_bf16 v[76:79],a[228:231],v[228:231],v[76:79]
v_add_f32 v108,v108,v100
s_waitcnt lgkmcnt(4)
v_mfma_f32_16x16x32_bf16 v[68:71],a[104:107],v[232:235],v[68:71]
v_min3_u32 v27,v27,v232,v236
v_add_f32 v109,v109,v101
v_mfma_f32_16x16x32_bf16 v[76:79],a[232:235],v[232:235],v[76:79]
v_mov_b32 v100,v108
v_mov_b32 v101,v109
v_mfma_f32_16x16x32_bf16 v[68:71],a[108:111],v[236:239],v[68:71]
v_permlane32_swap_b32 v100,v108
v_permlane32_swap_b32 v101,v109
v_mfma_f32_16x16x32_bf16 v[76:79],a[236:239],v[236:239],v[76:79]
v_add_f32 v108,v108,v100
s_waitcnt lgkmcnt(2)
v_mfma_f32_16x16x32_bf16 v[68:71],a[112:115],v[240:243],v[68:71]
v_min3_u32 v27,v27,v240,v244
v_add_f32 v109,v109,v101
v_mfma_f32_16x16x32_bf16 v[76:79],a[240:243],v[240:243],v[76:79]
v_min3_u32 v27,v27,v120,v122
v_min3_u32 v27,v27,v124,v126
v_mfma_f32_16x16x32_bf16 v[68:71],a[116:119],v[244:247],v[68:71]
v_lshlrev_b32 v32,16,v124
v_and_b32 v33,s80,v124
v_mfma_f32_16x16x32_bf16 v[76:79],a[244:247],v[244:247],v[76:79]
v_lshlrev_b32 v34,16,v125
s_waitcnt lgkmcnt(0)
v_mfma_f32_16x16x32_bf16 v[68:71],a[120:123],v[248:251],v[68:71]
v_min3_u32 v27,v27,v248,v252
v_and_b32 v35,s80,v125
v_mfma_f32_16x16x32_bf16 v[76:79],a[248:251],v[248:251],v[76:79]
v_lshlrev_b32 v36,16,v126
v_and_b32 v37,s80,v126
v_mfma_f32_16x16x32_bf16 v[68:71],a[124:127],v[252:255],v[68:71]
v_lshlrev_b32 v38,16,v127
v_and_b32 v39,s80,v127
v_mfma_f32_16x16x32_bf16 v[76:79],a[252:255],v[252:255],v[76:79]
v_cmp_eq_u32 vcc,0,v27
s_cbranch_vccnz retry_239
s_branch epi_242
keep_250:
v_mfma_f32_16x16x32_bf16 v[64:67],a[124:127],v[252:255],v[64:67]
v_min3_u32 v27,v27,v248,v252
s_xor_b32 m0,s72,0
v_mfma_f32_16x16x32_bf16 v[72:75],a[252:255],v[252:255],v[72:75]
ds_read_b128 v[248:251],v17 offset:13312
s_add_u32 s65,s88,0
s_waitcnt lgkmcnt(9)
v_mfma_f32_16x16x32_bf16 v[68:71],a[0:3],v[224:227],0
buffer_load_dwordx4 v16,s[20:23],s65 offen offset:0 sc1 lds
v_min3_u32 v27,v27,v224,v228
v_mfma_f32_16x16x32_bf16 v[76:79],a[128:131],v[224:227],0
ds_read_b128 v[252:255],v17 offset:15360
buffer_load_dwordx4 v16,s[20:23],s65 offen offset:2048 sc1 lds
v_mfma_f32_16x16x32_bf16 v[68:71],a[4:7],v[228:231],v[68:71]
v_cmp_eq_u32 vcc,0,v27
s_cbranch_vccnz retry_239
v_mfma_f32_16x16x32_bf16 v[76:79],a[132:135],v[228:231],v[76:79]
ds_read_b128 v[224:227],v17 offset:17408
s_xor_b32 m0,s72,16384
s_waitcnt lgkmcnt(7)
v_mfma_f32_16x16x32_bf16 v[68:71],a[8:11],v[232:235],v[68:71]
s_add_u32 s65,s88,32768
v_min3_u32 v27,v27,v232,v236
s_waitcnt lgkmcnt(5)
v_mfma_f32_16x16x32_bf16 v[76:79],a[136:139],v[232:235],v[76:79]
ds_read_b128 v[228:231],v17 offset:19456
buffer_load_dwordx4 v16,s[20:23],s65 offen offset:0 sc1 lds
v_mfma_f32_16x16x32_bf16 v[68:71],a[12:15],v[236:239],v[68:71]
v_lshlrev_b32 v88,16,v120
v_and_b32 v89,s80,v120
v_lshlrev_b32 v90,16,v121
v_mfma_f32_16x16x32_bf16 v[76:79],a[140:143],v[236:239],v[76:79]
ds_read_b128 v[232:235],v17 offset:21504
v_and_b32 v91,s80,v121
s_waitcnt lgkmcnt(5)
v_mfma_f32_16x16x32_bf16 v[68:71],a[16:19],v[240:243],v[68:71]
buffer_load_dwordx4 v16,s[20:23],s65 offen offset:2048 sc1 lds
s_xor_b32 m0,s72,32768
v_mfma_f32_16x16x32_bf16 v[76:79],a[144:147],v[240:243],v[76:79]
ds_read_b128 v[236:239],v17 offset:23552
s_add_u32 s65,s88,65536
v_lshlrev_b32 v92,16,v122
v_mfma_f32_16x16x32_bf16 v[68:71],a[20:23],v[244:247],v[68:71]
v_min3_u32 v27,v27,v240,v244
v_and_b32 v93,s80,v122
v_lshlrev_b32 v94,16,v123
v_mfma_f32_16x16x32_bf16 v[76:79],a[148:151],v[244:247],v[76:79]
ds_read_b128 v[240:243],v17 offset:25600
v_and_b32 v95,s80,v123
s_waitcnt lgkmcnt(5)
v_mfma_f32_16x16x32_bf16 v[68:71],a[24:27],v[248:251],v[68:71]
buffer_load_dwordx4 v16,s[20:23],s65 offen offset:0 sc1 lds
v_add_f32 v88,v64,v88
v_mfma_f32_16x16x32_bf16 v[76:79],a[152:155],v[248:251],v[76:79]
ds_read_b128 v[244:247],v17 offset:27648
buffer_load_dwordx4 v16,s[20:23],s65 offen offset:2048 sc1 lds
v_mfma_f32_16x16x32_bf16 v[68:71],a[28:31],v[252:255],v[68:71]
s_xor_b32 m0,s72,49152
v_min3_u32 v27,v27,v248,v252
v_add_f32 v89,v65,v89
v_mfma_f32_16x16x32_bf16 v[76:79],a[156:159],v[252:255],v[76:79]
ds_read_b128 v[248:251],v17 offset:29696
s_add_u32 s65,s88,98304
s_waitcnt lgkmcnt(5)
v_mfma_f32_16x16x32_bf16 v[68:71],a[32:35],v[224:227],v[68:71]
buffer_load_dwordx4 v16,s[20:23],s65 offen offset:0 sc1 lds
v_add_f32 v90,v66,v90
v_mfma_f32_16x16x32_bf16 v[76:79],a[160:163],v[224:227],v[76:79]
ds_read_b128 v[252:255],v17 offset:31744
v_min3_u32 v27,v27,v224,v228
v_add_f32 v91,v67,v91
v_mfma_f32_16x16x32_bf16 v[68:71],a[36:39],v[228:231],v[68:71]
buffer_load_dwordx4 v16,s[20:23],s65 offen offset:2048 sc1 lds
v_add_f32 v92,v72,v92
v_mfma_f32_16x16x32_bf16 v[76:79],a[164:167],v[228:231],v[76:79]
s_waitcnt vmcnt(10)
s_barrier
ds_read_b128 v[224:227],v17 offset:33792
s_waitcnt lgkmcnt(5)
v_mfma_f32_16x16x32_bf16 v[68:71],a[40:43],v[232:235],v[68:71]
s_xor_b32 m0,s72,1024
s_add_u32 s65,s89,0
v_add_f32 v93,v73,v93
v_mfma_f32_16x16x32_bf16 v[76:79],a[168:171],v[232:235],v[76:79]
ds_read_b128 v[228:231],v17 offset:35840
v_min3_u32 v27,v27,v232,v236
v_add_f32 v94,v74,v94
v_mfma_f32_16x16x32_bf16 v[68:71],a[44:47],v[236:239],v[68:71]
buffer_load_dwordx4 v16,s[20:23],s65 offen offset:0 sc1 lds
v_add_f32 v95,v75,v95
v_mfma_f32_16x16x32_bf16 v[76:79],a[172:175],v[236:239],v[76:79]
ds_read_b128 v[232:235],v17 offset:37888
v_cvt_pk_bf16_f32 v96,v88,v89
s_waitcnt lgkmcnt(5)
v_mfma_f32_16x16x32_bf16 v[68:71],a[48:51],v[240:243],v[68:71]
buffer_load_dwordx4 v16,s[20:23],s65 offen offset:2048 sc1 lds
v_cvt_pk_bf16_f32 v97,v90,v91
v_mfma_f32_16x16x32_bf16 v[76:79],a[176:179],v[240:243],v[76:79]
ds_read_b128 v[236:239],v17 offset:39936
s_xor_b32 m0,s72,17408
v_cvt_pk_bf16_f32 v98,v92,v93
v_mfma_f32_16x16x32_bf16 v[68:71],a[52:55],v[244:247],v[68:71]
s_add_u32 s65,s89,32768
v_min3_u32 v27,v27,v240,v244
v_cvt_pk_bf16_f32 v99,v94,v95
v_mfma_f32_16x16x32_bf16 v[76:79],a[180:183],v[244:247],v[76:79]
ds_read_b128 v[240:243],v17 offset:41984
v_max_u32 v96,1,v96
s_waitcnt lgkmcnt(5)
v_mfma_f32_16x16x32_bf16 v[68:71],a[56:59],v[248:251],v[68:71]
buffer_load_dwordx4 v16,s[20:23],s65 offen offset:0 sc1 lds
v_mfma_f32_16x16x32_bf16 v[76:79],a[184:187],v[248:251],v[76:79]
ds_read_b128 v[244:247],v17 offset:44032
v_min3_u32 v27,v27,v248,v252
v_mfma_f32_16x16x32_bf16 v[68:71],a[60:63],v[252:255],v[68:71]
buffer_load_dwordx4 v16,s[20:23],s65 offen offset:2048 sc1 lds
v_mfma_f32_16x16x32_bf16 v[76:79],a[188:191],v[252:255],v[76:79]
ds_read_b128 v[248:251],v17 offset:46080
s_waitcnt lgkmcnt(5)
v_mfma_f32_16x16x32_bf16 v[68:71],a[64:67],v[224:227],v[68:71]
s_xor_b32 m0,s72,33792
s_add_u32 s65,s89,65536
v_mfma_f32_16x16x32_bf16 v[76:79],a[192:195],v[224:227],v[76:79]
ds_read_b128 v[252:255],v17 offset:48128
v_min3_u32 v27,v27,v224,v228
v_mfma_f32_16x16x32_bf16 v[68:71],a[68:71],v[228:231],v[68:71]
buffer_load_dwordx4 v16,s[20:23],s65 offen offset:0 sc1 lds
v_mfma_f32_16x16x32_bf16 v[76:79],a[196:199],v[228:231],v[76:79]
ds_read_b128 v[224:227],v17 offset:50176
s_waitcnt lgkmcnt(5)
v_mfma_f32_16x16x32_bf16 v[68:71],a[72:75],v[232:235],v[68:71]
buffer_load_dwordx4 v16,s[20:23],s65 offen offset:2048 sc1 lds
v_mfma_f32_16x16x32_bf16 v[76:79],a[200:203],v[232:235],v[76:79]
ds_read_b128 v[228:231],v17 offset:52224
s_xor_b32 m0,s72,50176
v_mfma_f32_16x16x32_bf16 v[68:71],a[76:79],v[236:239],v[68:71]
s_add_u32 s65,s89,98304
v_min3_u32 v27,v27,v232,v236
v_mfma_f32_16x16x32_bf16 v[76:79],a[204:207],v[236:239],v[76:79]
ds_read_b128 v[232:235],v17 offset:54272
s_waitcnt lgkmcnt(5)
v_mfma_f32_16x16x32_bf16 v[68:71],a[80:83],v[240:243],v[68:71]
buffer_load_dwordx4 v16,s[20:23],s65 offen offset:0 sc1 lds
v_mfma_f32_16x16x32_bf16 v[76:79],a[208:211],v[240:243],v[76:79]
ds_read_b128 v[236:239],v17 offset:56320
v_min3_u32 v27,v27,v240,v244
v_mfma_f32_16x16x32_bf16 v[68:71],a[84:87],v[244:247],v[68:71]
buffer_load_dwordx4 v16,s[20:23],s65 offen offset:2048 sc1 lds
v_mfma_f32_16x16x32_bf16 v[76:79],a[212:215],v[244:247],v[76:79]
ds_read_b128 v[240:243],v17 offset:58368
s_waitcnt lgkmcnt(5)
v_mfma_f32_16x16x32_bf16 v[68:71],a[88:91],v[248:251],v[68:71]
v_min3_u32 v27,v27,v248,v252
buffer_store_dwordx4 v[96:99],v18,s[20:23],s70 offen offset:0 sc1
v_mfma_f32_16x16x32_bf16 v[76:79],a[216:219],v[248:251],v[76:79]
ds_read_b128 v[244:247],v17 offset:60416
v_lshlrev_b32 v88,16,v96
v_and_b32 v89,s80,v96
v_mfma_f32_16x16x32_bf16 v[68:71],a[92:95],v[252:255],v[68:71]
v_lshlrev_b32 v90,16,v97
v_and_b32 v91,s80,v97
v_lshlrev_b32 v92,16,v98
v_mfma_f32_16x16x32_bf16 v[76:79],a[220:223],v[252:255],v[76:79]
ds_read_b128 v[248:251],v17 offset:62464
v_and_b32 v93,s80,v98
s_waitcnt lgkmcnt(5)
v_mfma_f32_16x16x32_bf16 v[68:71],a[96:99],v[224:227],v[68:71]
v_min3_u32 v27,v27,v224,v228
v_lshlrev_b32 v94,16,v99
v_and_b32 v95,s80,v99
v_mfma_f32_16x16x32_bf16 v[76:79],a[224:227],v[224:227],v[76:79]
ds_read_b128 v[252:255],v17 offset:64512
v_add_f32 v108,v88,v89
v_mul_f32 v109,v88,v88
v_mfma_f32_16x16x32_bf16 v[68:71],a[100:103],v[228:231],v[68:71]
v_add_f32 v100,v90,v91
v_mul_f32 v101,v89,v89
v_fmac_f32 v109,v90,v90
v_mfma_f32_16x16x32_bf16 v[76:79],a[228:231],v[228:231],v[76:79]
v_fmac_f32 v101,v91,v91
v_fmac_f32 v109,v92,v92
s_waitcnt lgkmcnt(4)
v_mfma_f32_16x16x32_bf16 v[68:71],a[104:107],v[232:235],v[68:71]
v_min3_u32 v27,v27,v232,v236
v_fmac_f32 v101,v93,v93
v_add_f32 v108,v108,v92
v_mfma_f32_16x16x32_bf16 v[76:79],a[232:235],v[232:235],v[76:79]
v_add_f32 v100,v100,v93
v_fmac_f32 v109,v94,v94
v_fmac_f32 v101,v95,v95
v_mfma_f32_16x16x32_bf16 v[68:71],a[108:111],v[236:239],v[68:71]
v_add_f32 v108,v108,v94
v_add_f32 v100,v100,v95
v_add_f32 v108,v108,v100
v_mfma_f32_16x16x32_bf16 v[76:79],a[236:239],v[236:239],v[76:79]
v_add_f32 v109,v109,v101
v_mov_b32 v100,v108
s_waitcnt lgkmcnt(2)
v_mfma_f32_16x16x32_bf16 v[68:71],a[112:115],v[240:243],v[68:71]
v_min3_u32 v27,v27,v240,v244
v_mov_b32 v101,v109
v_permlane16_swap_b32 v100,v108
v_mfma_f32_16x16x32_bf16 v[76:79],a[240:243],v[240:243],v[76:79]
v_permlane16_swap_b32 v101,v109
v_add_f32 v108,v108,v100
v_add_f32 v109,v109,v101
v_mfma_f32_16x16x32_bf16 v[68:71],a[116:119],v[244:247],v[68:71]
v_mov_b32 v100,v108
v_mov_b32 v101,v109
s_nop 0
v_permlane32_swap_b32 v100,v108
v_mfma_f32_16x16x32_bf16 v[76:79],a[244:247],v[244:247],v[76:79]
v_permlane32_swap_b32 v101,v109
v_add_f32 v108,v108,v100
s_waitcnt lgkmcnt(0)
v_mfma_f32_16x16x32_bf16 v[68:71],a[120:123],v[248:251],v[68:71]
v_min3_u32 v27,v27,v248,v252
v_add_f32 v109,v109,v101
v_min3_u32 v27,v27,v120,v122
v_mfma_f32_16x16x32_bf16 v[76:79],a[248:251],v[248:251],v[76:79]
v_min3_u32 v27,v27,v124,v126
v_lshlrev_b32 v32,16,v124
v_and_b32 v33,s80,v124
v_mfma_f32_16x16x32_bf16 v[68:71],a[124:127],v[252:255],v[68:71]
v_lshlrev_b32 v34,16,v125
v_and_b32 v35,s80,v125
v_lshlrev_b32 v36,16,v126
v_mfma_f32_16x16x32_bf16 v[76:79],a[252:255],v[252:255],v[76:79]
v_and_b32 v37,s80,v126
v_lshlrev_b32 v38,16,v127
v_and_b32 v39,s80,v127
v_cmp_eq_u32 vcc,0,v27
s_cbranch_vccnz retry_239
s_branch epi_242
ahead_241:
s_cmp_eq_u32 s93,0
s_cbranch_scc1 both_243
s_waitcnt vmcnt(13) lgkmcnt(0)
s_barrier
ds_read_b128 v[224:227],v17 offset:0
ds_read_b128 v[228:231],v17 offset:2048
ds_read_b128 v[232:235],v17 offset:4096
ds_read_b128 v[236:239],v17 offset:6144
ds_read_b128 v[240:243],v17 offset:8192
ds_read_b128 v[244:247],v17 offset:10240
ds_read_b128 v[248:251],v17 offset:12288
s_waitcnt lgkmcnt(5)
v_mfma_f32_16x16x32_bf16 v[64:67],a[0:3],v[224:227],0
s_add_u32 s96,s71,1
s_add_u32 s92,s71,2
v_min_u32 v27,v224,v228
s_add_u32 m0,s43,0
v_mfma_f32_16x16x32_bf16 v[72:75],a[128:131],v[224:227],0
ds_read_b128 v[252:255],v17 offset:14336
s_cmp_eq_u32 s96,64
s_cselect_b32 s96,99,s96
v_mfma_f32_16x16x32_bf16 v[64:67],a[4:7],v[228:231],v[64:67]
s_cmp_eq_u32 s92,64
s_cselect_b32 s92,99,s92
buffer_load_dwordx4 v19,s[20:23],s78 offen sc1 lds
v_mfma_f32_16x16x32_bf16 v[72:75],a[132:135],v[228:231],v[72:75]
ds_read_b128 v[224:227],v17 offset:16384
s_add_u32 m0,s43,1024
s_waitcnt lgkmcnt(5)
v_mfma_f32_16x16x32_bf16 v[64:67],a[8:11],v[232:235],v[64:67]
s_cmp_eq_u32 s96,65
s_cselect_b32 s96,64,s96
buffer_load_dwordx4 v20,s[20:23],s78 offen sc1 lds
v_mfma_f32_16x16x32_bf16 v[72:75],a[136:139],v[232:235],v[72:75]
ds_read_b128 v[228:231],v17 offset:18432
v_min3_u32 v27,v27,v232,v236
v_mfma_f32_16x16x32_bf16 v[64:67],a[12:15],v[236:239],v[64:67]
v_mfma_f32_16x16x32_bf16 v[72:75],a[140:143],v[236:239],v[72:75]
ds_read_b128 v[232:235],v17 offset:20480
s_waitcnt lgkmcnt(5)
v_mfma_f32_16x16x32_bf16 v[64:67],a[16:19],v[240:243],v[64:67]
v_min3_u32 v27,v27,v240,v244
v_mfma_f32_16x16x32_bf16 v[72:75],a[144:147],v[240:243],v[72:75]
ds_read_b128 v[236:239],v17 offset:22528
v_mfma_f32_16x16x32_bf16 v[64:67],a[20:23],v[244:247],v[64:67]
v_mfma_f32_16x16x32_bf16 v[72:75],a[148:151],v[244:247],v[72:75]
ds_read_b128 v[240:243],v17 offset:24576
s_waitcnt lgkmcnt(5)
v_mfma_f32_16x16x32_bf16 v[64:67],a[24:27],v[248:251],v[64:67]
v_min3_u32 v27,v27,v248,v252
v_mfma_f32_16x16x32_bf16 v[72:75],a[152:155],v[248:251],v[72:75]
ds_read_b128 v[244:247],v17 offset:26624
v_mfma_f32_16x16x32_bf16 v[64:67],a[28:31],v[252:255],v[64:67]
v_mfma_f32_16x16x32_bf16 v[72:75],a[156:159],v[252:255],v[72:75]
ds_read_b128 v[248:251],v17 offset:28672
s_waitcnt lgkmcnt(5)
v_mfma_f32_16x16x32_bf16 v[64:67],a[32:35],v[224:227],v[64:67]
v_min3_u32 v27,v27,v224,v228
v_mfma_f32_16x16x32_bf16 v[72:75],a[160:163],v[224:227],v[72:75]
ds_read_b128 v[252:255],v17 offset:30720
v_mfma_f32_16x16x32_bf16 v[64:67],a[36:39],v[228:231],v[64:67]
v_mfma_f32_16x16x32_bf16 v[72:75],a[164:167],v[228:231],v[72:75]
ds_read_b128 v[224:227],v17 offset:32768
s_waitcnt lgkmcnt(5)
v_mfma_f32_16x16x32_bf16 v[64:67],a[40:43],v[232:235],v[64:67]
v_min3_u32 v27,v27,v232,v236
v_mfma_f32_16x16x32_bf16 v[72:75],a[168:171],v[232:235],v[72:75]
ds_read_b128 v[228:231],v17 offset:34816
v_mfma_f32_16x16x32_bf16 v[64:67],a[44:47],v[236:239],v[64:67]
v_mfma_f32_16x16x32_bf16 v[72:75],a[172:175],v[236:239],v[72:75]
ds_read_b128 v[232:235],v17 offset:36864
s_waitcnt lgkmcnt(5)
v_mfma_f32_16x16x32_bf16 v[64:67],a[48:51],v[240:243],v[64:67]
v_min3_u32 v27,v27,v240,v244
v_mfma_f32_16x16x32_bf16 v[72:75],a[176:179],v[240:243],v[72:75]
ds_read_b128 v[236:239],v17 offset:38912
v_mfma_f32_16x16x32_bf16 v[64:67],a[52:55],v[244:247],v[64:67]
v_mfma_f32_16x16x32_bf16 v[72:75],a[180:183],v[244:247],v[72:75]
ds_read_b128 v[240:243],v17 offset:40960
s_waitcnt lgkmcnt(5)
v_mfma_f32_16x16x32_bf16 v[64:67],a[56:59],v[248:251],v[64:67]
v_min3_u32 v27,v27,v248,v252
v_mfma_f32_16x16x32_bf16 v[72:75],a[184:187],v[248:251],v[72:75]
ds_read_b128 v[244:247],v17 offset:43008
s_waitcnt vmcnt(5)
v_mfma_f32_16x16x32_bf16 v[64:67],a[60:63],v[252:255],v[64:67]
v_cmp_gt_u32 vcc,s96,v29
v_cmp_gt_u32 s[92:93],s92,v29
v_mfma_f32_16x16x32_bf16 v[72:75],a[188:191],v[252:255],v[72:75]
ds_read_b128 v[248:251],v17 offset:45056
s_waitcnt lgkmcnt(5)
v_mfma_f32_16x16x32_bf16 v[64:67],a[64:67],v[224:227],v[64:67]
v_mov_b32 v44,vcc_lo
v_mov_b32 v45,s92
v_mfma_f32_16x16x32_bf16 v[72:75],a[192:195],v[224:227],v[72:75]
ds_read_b128 v[252:255],v17 offset:47104
ds_write_b64 v46,v[44:45]
v_mfma_f32_16x16x32_bf16 v[64:67],a[68:71],v[228:231],v[64:67]
v_min3_u32 v27,v27,v224,v228
v_mfma_f32_16x16x32_bf16 v[72:75],a[196:199],v[228:231],v[72:75]
ds_read_b128 v[224:227],v17 offset:49152
s_waitcnt lgkmcnt(6)
v_mfma_f32_16x16x32_bf16 v[64:67],a[72:75],v[232:235],v[64:67]
v_min3_u32 v27,v27,v232,v236
v_mfma_f32_16x16x32_bf16 v[72:75],a[200:203],v[232:235],v[72:75]
ds_read_b128 v[228:231],v17 offset:51200
v_mfma_f32_16x16x32_bf16 v[64:67],a[76:79],v[236:239],v[64:67]
v_mfma_f32_16x16x32_bf16 v[72:75],a[204:207],v[236:239],v[72:75]
ds_read_b128 v[232:235],v17 offset:53248
s_waitcnt lgkmcnt(6)
v_mfma_f32_16x16x32_bf16 v[64:67],a[80:83],v[240:243],v[64:67]
v_min3_u32 v27,v27,v240,v244
s_add_u32 s88,s70,s75
v_mfma_f32_16x16x32_bf16 v[72:75],a[208:211],v[240:243],v[72:75]
ds_read_b128 v[236:239],v17 offset:55296
s_add_u32 s88,s88,2097152
v_mfma_f32_16x16x32_bf16 v[64:67],a[84:87],v[244:247],v[64:67]
s_xor_b32 s88,s88,0x2000
s_xor_b32 s89,s88,1024
v_mfma_f32_16x16x32_bf16 v[72:75],a[212:215],v[244:247],v[72:75]
ds_read_b128 v[240:243],v17 offset:57344
s_waitcnt lgkmcnt(6)
v_mfma_f32_16x16x32_bf16 v[64:67],a[88:91],v[248:251],v[64:67]
v_min3_u32 v27,v27,v248,v252
v_mfma_f32_16x16x32_bf16 v[72:75],a[216:219],v[248:251],v[72:75]
ds_read_b128 v[244:247],v17 offset:59392
v_mfma_f32_16x16x32_bf16 v[64:67],a[92:95],v[252:255],v[64:67]
v_mfma_f32_16x16x32_bf16 v[72:75],a[220:223],v[252:255],v[72:75]
ds_read_b128 v[248:251],v17 offset:61440
s_waitcnt lgkmcnt(5)
v_mfma_f32_16x16x32_bf16 v[64:67],a[96:99],v[224:227],v[64:67]
v_min3_u32 v27,v27,v224,v228
v_mfma_f32_16x16x32_bf16 v[72:75],a[224:227],v[224:227],v[72:75]
ds_read_b128 v[252:255],v17 offset:63488
v_mfma_f32_16x16x32_bf16 v[64:67],a[100:103],v[228:231],v[64:67]
s_waitcnt vmcnt(2)
v_add_u32 v22,s71,-1
v_mfma_f32_16x16x32_bf16 v[72:75],a[228:231],v[228:231],v[72:75]
s_waitcnt vmcnt(7)
s_barrier
ds_read_b64 v[44:45],v47
ds_read_b128 v[224:227],v17 offset:1024
s_waitcnt lgkmcnt(6)
v_mfma_f32_16x16x32_bf16 v[64:67],a[104:107],v[232:235],v[64:67]
v_min3_u32 v27,v27,v232,v236
v_mfma_f32_16x16x32_bf16 v[72:75],a[232:235],v[232:235],v[72:75]
ds_read_b128 v[228:231],v17 offset:3072
v_mfma_f32_16x16x32_bf16 v[64:67],a[108:111],v[236:239],v[64:67]
buffer_store_dword v22,v23,s[20:23],s97 offen sc1
s_waitcnt vmcnt(1)
v_mfma_f32_16x16x32_bf16 v[72:75],a[236:239],v[236:239],v[72:75]
ds_read_b128 v[232:235],v17 offset:5120
s_waitcnt lgkmcnt(6)
v_mfma_f32_16x16x32_bf16 v[64:67],a[112:115],v[240:243],v[64:67]
v_min3_u32 v27,v27,v240,v244
s_mov_b32 s97,0x7fff0000
v_mfma_f32_16x16x32_bf16 v[72:75],a[240:243],v[240:243],v[72:75]
ds_read_b128 v[236:239],v17 offset:7168
ds_read_b64 v[120:121],v40 offset:0
v_mfma_f32_16x16x32_bf16 v[64:67],a[116:119],v[244:247],v[64:67]
ds_read_b64 v[122:123],v41 offset:0
ds_read_b64 v[124:125],v40 offset:1024
v_mfma_f32_16x16x32_bf16 v[72:75],a[244:247],v[244:247],v[72:75]
ds_read_b128 v[240:243],v17 offset:9216
s_waitcnt lgkmcnt(9)
v_mfma_f32_16x16x32_bf16 v[64:67],a[120:123],v[248:251],v[64:67]
s_waitcnt lgkmcnt(8)
v_readfirstlane_b32 s93,v45
v_mfma_f32_16x16x32_bf16 v[72:75],a[248:251],v[248:251],v[72:75]
ds_read_b128 v[244:247],v17 offset:11264
v_readfirstlane_b32 s83,v44
s_cmp_lg_u32 s83,0
s_cbranch_scc1 keep_251
v_mfma_f32_16x16x32_bf16 v[64:67],a[124:127],v[252:255],v[64:67]
v_min3_u32 v27,v27,v248,v252
ds_read_b64 v[126:127],v41 offset:1024
s_xor_b32 m0,s72,0
v_mfma_f32_16x16x32_bf16 v[72:75],a[252:255],v[252:255],v[72:75]
ds_read_b128 v[248:251],v17 offset:13312
s_add_u32 s65,s88,0
s_waitcnt lgkmcnt(9)
v_mfma_f32_16x16x32_bf16 v[68:71],a[0:3],v[224:227],0
buffer_load_dwordx4 v16,s[20:23],s65 offen offset:0 sc1 lds
v_min3_u32 v27,v27,v224,v228
v_mfma_f32_16x16x32_bf16 v[76:79],a[128:131],v[224:227],0
ds_read_b128 v[252:255],v17 offset:15360
buffer_load_dwordx4 v16,s[20:23],s65 offen offset:2048 sc1 lds
v_mfma_f32_16x16x32_bf16 v[68:71],a[4:7],v[228:231],v[68:71]
v_cmp_eq_u32 vcc,0,v27
s_cbranch_vccnz retry_239
v_mfma_f32_16x16x32_bf16 v[76:79],a[132:135],v[228:231],v[76:79]
ds_read_b128 v[224:227],v17 offset:17408
s_xor_b32 m0,s72,16384
s_waitcnt lgkmcnt(9)
v_mfma_f32_16x16x32_bf16 v[68:71],a[8:11],v[232:235],v[68:71]
s_add_u32 s65,s88,32768
v_min3_u32 v27,v27,v232,v236
s_waitcnt lgkmcnt(3)
v_mfma_f32_16x16x32_bf16 v[76:79],a[136:139],v[232:235],v[76:79]
ds_read_b128 v[228:231],v17 offset:19456
buffer_load_dwordx4 v16,s[20:23],s65 offen offset:0 sc1 lds
v_mfma_f32_16x16x32_bf16 v[68:71],a[12:15],v[236:239],v[68:71]
v_lshlrev_b32 v88,16,v120
v_and_b32 v89,s80,v120
v_lshlrev_b32 v90,16,v121
v_mfma_f32_16x16x32_bf16 v[76:79],a[140:143],v[236:239],v[76:79]
ds_read_b128 v[232:235],v17 offset:21504
v_and_b32 v91,s80,v121
v_mfma_f32_16x16x32_bf16 v[68:71],a[16:19],v[240:243],v[68:71]
buffer_load_dwordx4 v16,s[20:23],s65 offen offset:2048 sc1 lds
s_xor_b32 m0,s72,32768
v_mfma_f32_16x16x32_bf16 v[76:79],a[144:147],v[240:243],v[76:79]
ds_read_b128 v[236:239],v17 offset:23552
s_add_u32 s65,s88,65536
v_lshlrev_b32 v92,16,v122
v_mfma_f32_16x16x32_bf16 v[68:71],a[20:23],v[244:247],v[68:71]
v_min3_u32 v27,v27,v240,v244
v_and_b32 v93,s80,v122
v_lshlrev_b32 v94,16,v123
v_mfma_f32_16x16x32_bf16 v[76:79],a[148:151],v[244:247],v[76:79]
ds_read_b128 v[240:243],v17 offset:25600
v_and_b32 v95,s80,v123
s_waitcnt lgkmcnt(5)
v_mfma_f32_16x16x32_bf16 v[68:71],a[24:27],v[248:251],v[68:71]
buffer_load_dwordx4 v16,s[20:23],s65 offen offset:0 sc1 lds
v_add_f32 v88,v64,v88
v_mfma_f32_16x16x32_bf16 v[76:79],a[152:155],v[248:251],v[76:79]
ds_read_b128 v[244:247],v17 offset:27648
buffer_load_dwordx4 v16,s[20:23],s65 offen offset:2048 sc1 lds
v_mfma_f32_16x16x32_bf16 v[68:71],a[28:31],v[252:255],v[68:71]
s_xor_b32 m0,s72,49152
v_min3_u32 v27,v27,v248,v252
v_add_f32 v89,v65,v89
v_mfma_f32_16x16x32_bf16 v[76:79],a[156:159],v[252:255],v[76:79]
ds_read_b128 v[248:251],v17 offset:29696
s_add_u32 s65,s88,98304
s_waitcnt lgkmcnt(5)
v_mfma_f32_16x16x32_bf16 v[68:71],a[32:35],v[224:227],v[68:71]
buffer_load_dwordx4 v16,s[20:23],s65 offen offset:0 sc1 lds
v_add_f32 v90,v66,v90
v_mfma_f32_16x16x32_bf16 v[76:79],a[160:163],v[224:227],v[76:79]
ds_read_b128 v[252:255],v17 offset:31744
v_min3_u32 v27,v27,v224,v228
v_add_f32 v91,v67,v91
v_mfma_f32_16x16x32_bf16 v[68:71],a[36:39],v[228:231],v[68:71]
buffer_load_dwordx4 v16,s[20:23],s65 offen offset:2048 sc1 lds
v_add_f32 v92,v72,v92
v_mfma_f32_16x16x32_bf16 v[76:79],a[164:167],v[228:231],v[76:79]
ds_read_b128 v[224:227],v17 offset:33792
v_add_f32 v93,v73,v93
s_waitcnt lgkmcnt(5)
v_mfma_f32_16x16x32_bf16 v[68:71],a[40:43],v[232:235],v[68:71]
s_xor_b32 m0,s72,1024
s_add_u32 s65,s89,0
v_add_f32 v94,v74,v94
v_mfma_f32_16x16x32_bf16 v[76:79],a[168:171],v[232:235],v[76:79]
ds_read_b128 v[228:231],v17 offset:35840
v_min3_u32 v27,v27,v232,v236
v_add_f32 v95,v75,v95
v_mfma_f32_16x16x32_bf16 v[68:71],a[44:47],v[236:239],v[68:71]
buffer_load_dwordx4 v16,s[20:23],s65 offen offset:0 sc1 lds
v_cvt_pk_bf16_f32 v96,v88,v89
v_mfma_f32_16x16x32_bf16 v[76:79],a[172:175],v[236:239],v[76:79]
ds_read_b128 v[232:235],v17 offset:37888
v_cvt_pk_bf16_f32 v97,v90,v91
s_waitcnt lgkmcnt(5)
v_mfma_f32_16x16x32_bf16 v[68:71],a[48:51],v[240:243],v[68:71]
buffer_load_dwordx4 v16,s[20:23],s65 offen offset:2048 sc1 lds
v_cvt_pk_bf16_f32 v98,v92,v93
v_mfma_f32_16x16x32_bf16 v[76:79],a[176:179],v[240:243],v[76:79]
ds_read_b128 v[236:239],v17 offset:39936
s_xor_b32 m0,s72,17408
v_cvt_pk_bf16_f32 v99,v94,v95
v_mfma_f32_16x16x32_bf16 v[68:71],a[52:55],v[244:247],v[68:71]
s_add_u32 s65,s89,32768
v_min3_u32 v27,v27,v240,v244
v_max_u32 v96,1,v96
v_mfma_f32_16x16x32_bf16 v[76:79],a[180:183],v[244:247],v[76:79]
ds_read_b128 v[240:243],v17 offset:41984
s_waitcnt lgkmcnt(5)
v_mfma_f32_16x16x32_bf16 v[68:71],a[56:59],v[248:251],v[68:71]
buffer_load_dwordx4 v16,s[20:23],s65 offen offset:0 sc1 lds
v_mfma_f32_16x16x32_bf16 v[76:79],a[184:187],v[248:251],v[76:79]
ds_read_b128 v[244:247],v17 offset:44032
v_min3_u32 v27,v27,v248,v252
v_mfma_f32_16x16x32_bf16 v[68:71],a[60:63],v[252:255],v[68:71]
buffer_load_dwordx4 v16,s[20:23],s65 offen offset:2048 sc1 lds
v_mfma_f32_16x16x32_bf16 v[76:79],a[188:191],v[252:255],v[76:79]
ds_read_b128 v[248:251],v17 offset:46080
s_waitcnt lgkmcnt(5)
v_mfma_f32_16x16x32_bf16 v[68:71],a[64:67],v[224:227],v[68:71]
s_xor_b32 m0,s72,33792
s_add_u32 s65,s89,65536
v_mfma_f32_16x16x32_bf16 v[76:79],a[192:195],v[224:227],v[76:79]
ds_read_b128 v[252:255],v17 offset:48128
v_min3_u32 v27,v27,v224,v228
v_mfma_f32_16x16x32_bf16 v[68:71],a[68:71],v[228:231],v[68:71]
buffer_load_dwordx4 v16,s[20:23],s65 offen offset:0 sc1 lds
v_mfma_f32_16x16x32_bf16 v[76:79],a[196:199],v[228:231],v[76:79]
ds_read_b128 v[224:227],v17 offset:50176
s_waitcnt lgkmcnt(5)
v_mfma_f32_16x16x32_bf16 v[68:71],a[72:75],v[232:235],v[68:71]
buffer_load_dwordx4 v16,s[20:23],s65 offen offset:2048 sc1 lds
v_mfma_f32_16x16x32_bf16 v[76:79],a[200:203],v[232:235],v[76:79]
ds_read_b128 v[228:231],v17 offset:52224
s_xor_b32 m0,s72,50176
v_mfma_f32_16x16x32_bf16 v[68:71],a[76:79],v[236:239],v[68:71]
s_add_u32 s65,s89,98304
v_min3_u32 v27,v27,v232,v236
v_mfma_f32_16x16x32_bf16 v[76:79],a[204:207],v[236:239],v[76:79]
ds_read_b128 v[232:235],v17 offset:54272
s_waitcnt lgkmcnt(5)
v_mfma_f32_16x16x32_bf16 v[68:71],a[80:83],v[240:243],v[68:71]
buffer_load_dwordx4 v16,s[20:23],s65 offen offset:0 sc1 lds
v_mfma_f32_16x16x32_bf16 v[76:79],a[208:211],v[240:243],v[76:79]
ds_read_b128 v[236:239],v17 offset:56320
v_min3_u32 v27,v27,v240,v244
v_mfma_f32_16x16x32_bf16 v[68:71],a[84:87],v[244:247],v[68:71]
buffer_load_dwordx4 v16,s[20:23],s65 offen offset:2048 sc1 lds
v_mfma_f32_16x16x32_bf16 v[76:79],a[212:215],v[244:247],v[76:79]
ds_read_b128 v[240:243],v17 offset:58368
s_waitcnt lgkmcnt(5)
v_mfma_f32_16x16x32_bf16 v[68:71],a[88:91],v[248:251],v[68:71]
v_min3_u32 v27,v27,v248,v252
buffer_store_dwordx4 v[96:99],v18,s[20:23],s70 offen offset:0 sc1
v_mfma_f32_16x16x32_bf16 v[76:79],a[216:219],v[248:251],v[76:79]
ds_read_b128 v[244:247],v17 offset:60416
v_lshlrev_b32 v88,16,v96
v_and_b32 v89,s80,v96
v_mfma_f32_16x16x32_bf16 v[68:71],a[92:95],v[252:255],v[68:71]
v_lshlrev_b32 v90,16,v97
v_and_b32 v91,s80,v97
v_lshlrev_b32 v92,16,v98
v_mfma_f32_16x16x32_bf16 v[76:79],a[220:223],v[252:255],v[76:79]
ds_read_b128 v[248:251],v17 offset:62464
v_and_b32 v93,s80,v98
s_waitcnt lgkmcnt(5)
v_mfma_f32_16x16x32_bf16 v[68:71],a[96:99],v[224:227],v[68:71]
v_min3_u32 v27,v27,v224,v228
v_lshlrev_b32 v94,16,v99
v_and_b32 v95,s80,v99
v_mfma_f32_16x16x32_bf16 v[76:79],a[224:227],v[224:227],v[76:79]
ds_read_b128 v[252:255],v17 offset:64512
v_add_f32 v108,v88,v89
v_mul_f32 v109,v88,v88
v_mfma_f32_16x16x32_bf16 v[68:71],a[100:103],v[228:231],v[68:71]
v_add_f32 v100,v90,v91
v_mul_f32 v101,v89,v89
v_fmac_f32 v109,v90,v90
v_mfma_f32_16x16x32_bf16 v[76:79],a[228:231],v[228:231],v[76:79]
v_fmac_f32 v101,v91,v91
v_fmac_f32 v109,v92,v92
s_waitcnt lgkmcnt(4)
v_mfma_f32_16x16x32_bf16 v[68:71],a[104:107],v[232:235],v[68:71]
v_min3_u32 v27,v27,v232,v236
v_fmac_f32 v101,v93,v93
v_add_f32 v108,v108,v92
v_mfma_f32_16x16x32_bf16 v[76:79],a[232:235],v[232:235],v[76:79]
v_add_f32 v100,v100,v93
v_fmac_f32 v109,v94,v94
v_fmac_f32 v101,v95,v95
v_mfma_f32_16x16x32_bf16 v[68:71],a[108:111],v[236:239],v[68:71]
v_add_f32 v108,v108,v94
v_add_f32 v100,v100,v95
v_add_f32 v108,v108,v100
v_mfma_f32_16x16x32_bf16 v[76:79],a[236:239],v[236:239],v[76:79]
v_add_f32 v109,v109,v101
v_mov_b32 v100,v108
s_waitcnt lgkmcnt(2)
v_mfma_f32_16x16x32_bf16 v[68:71],a[112:115],v[240:243],v[68:71]
v_min3_u32 v27,v27,v240,v244
v_mov_b32 v101,v109
v_permlane16_swap_b32 v100,v108
v_mfma_f32_16x16x32_bf16 v[76:79],a[240:243],v[240:243],v[76:79]
v_permlane16_swap_b32 v101,v109
v_add_f32 v108,v108,v100
v_add_f32 v109,v109,v101
v_mfma_f32_16x16x32_bf16 v[68:71],a[116:119],v[244:247],v[68:71]
v_mov_b32 v100,v108
v_mov_b32 v101,v109
s_nop 0
v_permlane32_swap_b32 v100,v108
v_mfma_f32_16x16x32_bf16 v[76:79],a[244:247],v[244:247],v[76:79]
v_permlane32_swap_b32 v101,v109
v_add_f32 v108,v108,v100
s_waitcnt lgkmcnt(0)
v_mfma_f32_16x16x32_bf16 v[68:71],a[120:123],v[248:251],v[68:71]
v_min3_u32 v27,v27,v248,v252
v_add_f32 v109,v109,v101
v_min3_u32 v27,v27,v120,v122
v_mfma_f32_16x16x32_bf16 v[76:79],a[248:251],v[248:251],v[76:79]
v_min3_u32 v27,v27,v124,v126
v_lshlrev_b32 v32,16,v124
v_and_b32 v33,s80,v124
v_mfma_f32_16x16x32_bf16 v[68:71],a[124:127],v[252:255],v[68:71]
v_lshlrev_b32 v34,16,v125
v_and_b32 v35,s80,v125
v_lshlrev_b32 v36,16,v126
v_mfma_f32_16x16x32_bf16 v[76:79],a[252:255],v[252:255],v[76:79]
v_and_b32 v37,s80,v126
v_lshlrev_b32 v38,16,v127
v_and_b32 v39,s80,v127
v_cmp_eq_u32 vcc,0,v27
s_cbranch_vccnz retry_239
s_branch epi_242
keep_251:
v_mfma_f32_16x16x32_bf16 v[64:67],a[124:127],v[252:255],v[64:67]
v_min3_u32 v27,v27,v248,v252
ds_read_b64 v[126:127],v41 offset:1024
v_mfma_f32_16x16x32_bf16 v[72:75],a[252:255],v[252:255],v[72:75]
ds_read_b128 v[248:251],v17 offset:13312
s_waitcnt lgkmcnt(9)
v_mfma_f32_16x16x32_bf16 v[68:71],a[0:3],v[224:227],0
v_cmp_eq_u32 vcc,0,v27
s_cbranch_vccnz retry_239
v_mfma_f32_16x16x32_bf16 v[76:79],a[128:131],v[224:227],0
ds_read_b128 v[252:255],v17 offset:15360
v_min3_u32 v27,v27,v224,v228
v_mfma_f32_16x16x32_bf16 v[68:71],a[4:7],v[228:231],v[68:71]
v_mfma_f32_16x16x32_bf16 v[76:79],a[132:135],v[228:231],v[76:79]
ds_read_b128 v[224:227],v17 offset:17408
s_waitcnt lgkmcnt(9)
v_mfma_f32_16x16x32_bf16 v[68:71],a[8:11],v[232:235],v[68:71]
v_min3_u32 v27,v27,v232,v236
s_waitcnt lgkmcnt(3)
v_lshlrev_b32 v88,16,v120
v_mfma_f32_16x16x32_bf16 v[76:79],a[136:139],v[232:235],v[76:79]
ds_read_b128 v[228:231],v17 offset:19456
v_and_b32 v89,s80,v120
v_lshlrev_b32 v90,16,v121
v_mfma_f32_16x16x32_bf16 v[68:71],a[12:15],v[236:239],v[68:71]
v_and_b32 v91,s80,v121
v_lshlrev_b32 v92,16,v122
v_and_b32 v93,s80,v122
v_mfma_f32_16x16x32_bf16 v[76:79],a[140:143],v[236:239],v[76:79]
ds_read_b128 v[232:235],v17 offset:21504
v_lshlrev_b32 v94,16,v123
v_mfma_f32_16x16x32_bf16 v[68:71],a[16:19],v[240:243],v[68:71]
v_min3_u32 v27,v27,v240,v244
v_and_b32 v95,s80,v123
v_mfma_f32_16x16x32_bf16 v[76:79],a[144:147],v[240:243],v[76:79]
ds_read_b128 v[236:239],v17 offset:23552
v_add_f32 v88,v64,v88
v_mfma_f32_16x16x32_bf16 v[68:71],a[20:23],v[244:247],v[68:71]
v_add_f32 v89,v65,v89
v_add_f32 v90,v66,v90
v_mfma_f32_16x16x32_bf16 v[76:79],a[148:151],v[244:247],v[76:79]
ds_read_b128 v[240:243],v17 offset:25600
s_waitcnt lgkmcnt(5)
v_mfma_f32_16x16x32_bf16 v[68:71],a[24:27],v[248:251],v[68:71]
v_min3_u32 v27,v27,v248,v252
v_add_f32 v91,v67,v91
v_mfma_f32_16x16x32_bf16 v[76:79],a[152:155],v[248:251],v[76:79]
ds_read_b128 v[244:247],v17 offset:27648
v_add_f32 v92,v72,v92
v_mfma_f32_16x16x32_bf16 v[68:71],a[28:31],v[252:255],v[68:71]
v_add_f32 v93,v73,v93
v_add_f32 v94,v74,v94
v_mfma_f32_16x16x32_bf16 v[76:79],a[156:159],v[252:255],v[76:79]
ds_read_b128 v[248:251],v17 offset:29696
s_waitcnt lgkmcnt(5)
v_mfma_f32_16x16x32_bf16 v[68:71],a[32:35],v[224:227],v[68:71]
v_min3_u32 v27,v27,v224,v228
v_add_f32 v95,v75,v95
v_mfma_f32_16x16x32_bf16 v[76:79],a[160:163],v[224:227],v[76:79]
ds_read_b128 v[252:255],v17 offset:31744
v_cvt_pk_bf16_f32 v96,v88,v89
v_mfma_f32_16x16x32_bf16 v[68:71],a[36:39],v[228:231],v[68:71]
v_cvt_pk_bf16_f32 v97,v90,v91
v_cvt_pk_bf16_f32 v98,v92,v93
v_mfma_f32_16x16x32_bf16 v[76:79],a[164:167],v[228:231],v[76:79]
ds_read_b128 v[224:227],v17 offset:33792
s_waitcnt lgkmcnt(5)
v_mfma_f32_16x16x32_bf16 v[68:71],a[40:43],v[232:235],v[68:71]
v_min3_u32 v27,v27,v232,v236
v_cvt_pk_bf16_f32 v99,v94,v95
v_mfma_f32_16x16x32_bf16 v[76:79],a[168:171],v[232:235],v[76:79]
ds_read_b128 v[228:231],v17 offset:35840
v_max_u32 v96,1,v96
v_mfma_f32_16x16x32_bf16 v[68:71],a[44:47],v[236:239],v[68:71]
buffer_store_dwordx4 v[96:99],v18,s[20:23],s70 offen offset:0 sc1
v_mfma_f32_16x16x32_bf16 v[76:79],a[172:175],v[236:239],v[76:79]
ds_read_b128 v[232:235],v17 offset:37888
s_waitcnt lgkmcnt(5)
v_mfma_f32_16x16x32_bf16 v[68:71],a[48:51],v[240:243],v[68:71]
v_min3_u32 v27,v27,v240,v244
v_lshlrev_b32 v88,16,v96
v_mfma_f32_16x16x32_bf16 v[76:79],a[176:179],v[240:243],v[76:79]
ds_read_b128 v[236:239],v17 offset:39936
v_and_b32 v89,s80,v96
v_mfma_f32_16x16x32_bf16 v[68:71],a[52:55],v[244:247],v[68:71]
v_lshlrev_b32 v90,16,v97
v_and_b32 v91,s80,v97
v_mfma_f32_16x16x32_bf16 v[76:79],a[180:183],v[244:247],v[76:79]
ds_read_b128 v[240:243],v17 offset:41984
s_waitcnt lgkmcnt(5)
v_mfma_f32_16x16x32_bf16 v[68:71],a[56:59],v[248:251],v[68:71]
v_min3_u32 v27,v27,v248,v252
v_lshlrev_b32 v92,16,v98
v_mfma_f32_16x16x32_bf16 v[76:79],a[184:187],v[248:251],v[76:79]
ds_read_b128 v[244:247],v17 offset:44032
v_and_b32 v93,s80,v98
v_mfma_f32_16x16x32_bf16 v[68:71],a[60:63],v[252:255],v[68:71]
v_lshlrev_b32 v94,16,v99
v_and_b32 v95,s80,v99
v_mfma_f32_16x16x32_bf16 v[76:79],a[188:191],v[252:255],v[76:79]
ds_read_b128 v[248:251],v17 offset:46080
s_waitcnt lgkmcnt(5)
v_mfma_f32_16x16x32_bf16 v[68:71],a[64:67],v[224:227],v[68:71]
v_min3_u32 v27,v27,v224,v228
v_add_f32 v108,v88,v89
v_mfma_f32_16x16x32_bf16 v[76:79],a[192:195],v[224:227],v[76:79]
ds_read_b128 v[252:255],v17 offset:48128
v_mul_f32 v109,v88,v88
v_mfma_f32_16x16x32_bf16 v[68:71],a[68:71],v[228:231],v[68:71]
v_add_f32 v100,v90,v91
v_mul_f32 v101,v89,v89
v_mfma_f32_16x16x32_bf16 v[76:79],a[196:199],v[228:231],v[76:79]
ds_read_b128 v[224:227],v17 offset:50176
s_waitcnt lgkmcnt(5)
v_mfma_f32_16x16x32_bf16 v[68:71],a[72:75],v[232:235],v[68:71]
v_min3_u32 v27,v27,v232,v236
v_fmac_f32 v109,v90,v90
v_mfma_f32_16x16x32_bf16 v[76:79],a[200:203],v[232:235],v[76:79]
ds_read_b128 v[228:231],v17 offset:52224
v_fmac_f32 v101,v91,v91
v_mfma_f32_16x16x32_bf16 v[68:71],a[76:79],v[236:239],v[68:71]
v_fmac_f32 v109,v92,v92
v_fmac_f32 v101,v93,v93
v_mfma_f32_16x16x32_bf16 v[76:79],a[204:207],v[236:239],v[76:79]
ds_read_b128 v[232:235],v17 offset:54272
s_waitcnt lgkmcnt(5)
v_mfma_f32_16x16x32_bf16 v[68:71],a[80:83],v[240:243],v[68:71]
v_min3_u32 v27,v27,v240,v244
v_add_f32 v108,v108,v92
v_mfma_f32_16x16x32_bf16 v[76:79],a[208:211],v[240:243],v[76:79]
ds_read_b128 v[236:239],v17 offset:56320
v_add_f32 v100,v100,v93
v_mfma_f32_16x16x32_bf16 v[68:71],a[84:87],v[244:247],v[68:71]
v_fmac_f32 v109,v94,v94
v_fmac_f32 v101,v95,v95
v_mfma_f32_16x16x32_bf16 v[76:79],a[212:215],v[244:247],v[76:79]
ds_read_b128 v[240:243],v17 offset:58368
s_waitcnt lgkmcnt(5)
v_mfma_f32_16x16x32_bf16 v[68:71],a[88:91],v[248:251],v[68:71]
v_min3_u32 v27,v27,v248,v252
v_add_f32 v108,v108,v94
v_mfma_f32_16x16x32_bf16 v[76:79],a[216:219],v[248:251],v[76:79]
ds_read_b128 v[244:247],v17 offset:60416
v_add_f32 v100,v100,v95
v_mfma_f32_16x16x32_bf16 v[68:71],a[92:95],v[252:255],v[68:71]
v_add_f32 v108,v108,v100
v_add_f32 v109,v109,v101
v_mfma_f32_16x16x32_bf16 v[76:79],a[220:223],v[252:255],v[76:79]
ds_read_b128 v[248:251],v17 offset:62464
s_waitcnt lgkmcnt(5)
v_mfma_f32_16x16x32_bf16 v[68:71],a[96:99],v[224:227],v[68:71]
v_min3_u32 v27,v27,v224,v228
v_mov_b32 v100,v108
v_mfma_f32_16x16x32_bf16 v[76:79],a[224:227],v[224:227],v[76:79]
ds_read_b128 v[252:255],v17 offset:64512
v_mov_b32 v101,v109
v_mfma_f32_16x16x32_bf16 v[68:71],a[100:103],v[228:231],v[68:71]
v_permlane16_swap_b32 v100,v108
v_permlane16_swap_b32 v101,v109
v_mfma_f32_16x16x32_bf16 v[76:79],a[228:231],v[228:231],v[76:79]
v_add_f32 v108,v108,v100
s_waitcnt lgkmcnt(4)
v_mfma_f32_16x16x32_bf16 v[68:71],a[104:107],v[232:235],v[68:71]
v_min3_u32 v27,v27,v232,v236
v_add_f32 v109,v109,v101
v_mfma_f32_16x16x32_bf16 v[76:79],a[232:235],v[232:235],v[76:79]
v_mov_b32 v100,v108
v_mov_b32 v101,v109
v_mfma_f32_16x16x32_bf16 v[68:71],a[108:111],v[236:239],v[68:71]
v_permlane32_swap_b32 v100,v108
v_permlane32_swap_b32 v101,v109
v_mfma_f32_16x16x32_bf16 v[76:79],a[236:239],v[236:239],v[76:79]
v_add_f32 v108,v108,v100
s_waitcnt lgkmcnt(2)
v_mfma_f32_16x16x32_bf16 v[68:71],a[112:115],v[240:243],v[68:71]
v_min3_u32 v27,v27,v240,v244
v_add_f32 v109,v109,v101
v_mfma_f32_16x16x32_bf16 v[76:79],a[240:243],v[240:243],v[76:79]
v_min3_u32 v27,v27,v120,v122
v_min3_u32 v27,v27,v124,v126
v_mfma_f32_16x16x32_bf16 v[68:71],a[116:119],v[244:247],v[68:71]
v_lshlrev_b32 v32,16,v124
v_and_b32 v33,s80,v124
v_mfma_f32_16x16x32_bf16 v[76:79],a[244:247],v[244:247],v[76:79]
v_lshlrev_b32 v34,16,v125
s_waitcnt lgkmcnt(0)
v_mfma_f32_16x16x32_bf16 v[68:71],a[120:123],v[248:251],v[68:71]
v_min3_u32 v27,v27,v248,v252
v_and_b32 v35,s80,v125
v_mfma_f32_16x16x32_bf16 v[76:79],a[248:251],v[248:251],v[76:79]
v_lshlrev_b32 v36,16,v126
v_and_b32 v37,s80,v126
v_mfma_f32_16x16x32_bf16 v[68:71],a[124:127],v[252:255],v[68:71]
v_lshlrev_b32 v38,16,v127
v_and_b32 v39,s80,v127
v_mfma_f32_16x16x32_bf16 v[76:79],a[252:255],v[252:255],v[76:79]
v_cmp_eq_u32 vcc,0,v27
s_cbranch_vccnz retry_239
s_branch epi_242
both_243:
s_waitcnt vmcnt(13) lgkmcnt(0)
s_barrier
ds_read_b128 v[224:227],v17 offset:0
ds_read_b128 v[228:231],v17 offset:2048
ds_read_b128 v[232:235],v17 offset:4096
ds_read_b128 v[236:239],v17 offset:6144
ds_read_b128 v[240:243],v17 offset:8192
ds_read_b128 v[244:247],v17 offset:10240
ds_read_b128 v[248:251],v17 offset:12288
s_waitcnt lgkmcnt(5)
v_mfma_f32_16x16x32_bf16 v[64:67],a[0:3],v[224:227],0
s_add_u32 s96,s71,1
s_add_u32 s92,s71,2
s_add_u32 s88,s70,s75
v_min_u32 v27,v224,v228
s_add_u32 m0,s43,0
v_mfma_f32_16x16x32_bf16 v[72:75],a[128:131],v[224:227],0
ds_read_b128 v[252:255],v17 offset:14336
s_cmp_eq_u32 s96,64
s_cselect_b32 s96,99,s96
buffer_load_dwordx4 v19,s[20:23],s78 offen sc1 lds
v_mfma_f32_16x16x32_bf16 v[64:67],a[4:7],v[228:231],v[64:67]
s_cmp_eq_u32 s92,64
s_cselect_b32 s92,99,s92
s_add_u32 s88,s88,2097152
s_add_u32 m0,s43,1024
v_mfma_f32_16x16x32_bf16 v[72:75],a[132:135],v[228:231],v[72:75]
ds_read_b128 v[224:227],v17 offset:16384
s_xor_b32 s88,s88,0x2000
buffer_load_dwordx4 v20,s[20:23],s78 offen sc1 lds
s_waitcnt lgkmcnt(5)
v_mfma_f32_16x16x32_bf16 v[64:67],a[8:11],v[232:235],v[64:67]
s_cmp_eq_u32 s96,65
s_cselect_b32 s96,64,s96
v_mfma_f32_16x16x32_bf16 v[72:75],a[136:139],v[232:235],v[72:75]
ds_read_b128 v[228:231],v17 offset:18432
s_xor_b32 s89,s88,1024
v_mfma_f32_16x16x32_bf16 v[64:67],a[12:15],v[236:239],v[64:67]
s_xor_b32 m0,s72,0
v_min3_u32 v27,v27,v232,v236
v_mfma_f32_16x16x32_bf16 v[72:75],a[140:143],v[236:239],v[72:75]
ds_read_b128 v[232:235],v17 offset:20480
s_add_u32 s65,s88,0
s_waitcnt lgkmcnt(5)
v_mfma_f32_16x16x32_bf16 v[64:67],a[16:19],v[240:243],v[64:67]
v_min3_u32 v27,v27,v240,v244
v_mfma_f32_16x16x32_bf16 v[72:75],a[144:147],v[240:243],v[72:75]
ds_read_b128 v[236:239],v17 offset:22528
buffer_load_dwordx4 v16,s[20:23],s65 offen offset:0 sc1 lds
v_mfma_f32_16x16x32_bf16 v[64:67],a[20:23],v[244:247],v[64:67]
buffer_load_dwordx4 v16,s[20:23],s65 offen offset:2048 sc1 lds
v_mfma_f32_16x16x32_bf16 v[72:75],a[148:151],v[244:247],v[72:75]
ds_read_b128 v[240:243],v17 offset:24576
s_waitcnt lgkmcnt(5)
v_mfma_f32_16x16x32_bf16 v[64:67],a[24:27],v[248:251],v[64:67]
s_xor_b32 m0,s72,16384
v_min3_u32 v27,v27,v248,v252
v_mfma_f32_16x16x32_bf16 v[72:75],a[152:155],v[248:251],v[72:75]
ds_read_b128 v[244:247],v17 offset:26624
v_mfma_f32_16x16x32_bf16 v[64:67],a[28:31],v[252:255],v[64:67]
s_add_u32 s65,s88,32768
v_mfma_f32_16x16x32_bf16 v[72:75],a[156:159],v[252:255],v[72:75]
ds_read_b128 v[248:251],v17 offset:28672
s_waitcnt lgkmcnt(5)
v_mfma_f32_16x16x32_bf16 v[64:67],a[32:35],v[224:227],v[64:67]
buffer_load_dwordx4 v16,s[20:23],s65 offen offset:0 sc1 lds
v_mfma_f32_16x16x32_bf16 v[72:75],a[160:163],v[224:227],v[72:75]
ds_read_b128 v[252:255],v17 offset:30720
buffer_load_dwordx4 v16,s[20:23],s65 offen offset:2048 sc1 lds
v_mfma_f32_16x16x32_bf16 v[64:67],a[36:39],v[228:231],v[64:67]
v_min3_u32 v27,v27,v224,v228
v_mfma_f32_16x16x32_bf16 v[72:75],a[164:167],v[228:231],v[72:75]
ds_read_b128 v[224:227],v17 offset:32768
s_xor_b32 m0,s72,32768
s_waitcnt lgkmcnt(5)
v_mfma_f32_16x16x32_bf16 v[64:67],a[40:43],v[232:235],v[64:67]
s_add_u32 s65,s88,65536
v_min3_u32 v27,v27,v232,v236
v_mfma_f32_16x16x32_bf16 v[72:75],a[168:171],v[232:235],v[72:75]
ds_read_b128 v[228:231],v17 offset:34816
v_mfma_f32_16x16x32_bf16 v[64:67],a[44:47],v[236:239],v[64:67]
buffer_load_dwordx4 v16,s[20:23],s65 offen offset:0 sc1 lds
v_mfma_f32_16x16x32_bf16 v[72:75],a[172:175],v[236:239],v[72:75]
ds_read_b128 v[232:235],v17 offset:36864
s_waitcnt lgkmcnt(5)
v_mfma_f32_16x16x32_bf16 v[64:67],a[48:51],v[240:243],v[64:67]
buffer_load_dwordx4 v16,s[20:23],s65 offen offset:2048 sc1 lds
v_mfma_f32_16x16x32_bf16 v[72:75],a[176:179],v[240:243],v[72:75]
ds_read_b128 v[236:239],v17 offset:38912
s_xor_b32 m0,s72,49152
v_mfma_f32_16x16x32_bf16 v[64:67],a[52:55],v[244:247],v[64:67]
v_min3_u32 v27,v27,v240,v244
v_mfma_f32_16x16x32_bf16 v[72:75],a[180:183],v[244:247],v[72:75]
ds_read_b128 v[240:243],v17 offset:40960
s_add_u32 s65,s88,98304
s_waitcnt lgkmcnt(5)
v_mfma_f32_16x16x32_bf16 v[64:67],a[56:59],v[248:251],v[64:67]
buffer_load_dwordx4 v16,s[20:23],s65 offen offset:0 sc1 lds
v_min3_u32 v27,v27,v248,v252
v_mfma_f32_16x16x32_bf16 v[72:75],a[184:187],v[248:251],v[72:75]
ds_read_b128 v[244:247],v17 offset:43008
s_waitcnt vmcnt(12)
v_mfma_f32_16x16x32_bf16 v[64:67],a[60:63],v[252:255],v[64:67]
v_cmp_gt_u32 vcc,s96,v29
v_cmp_gt_u32 s[92:93],s92,v29
v_mfma_f32_16x16x32_bf16 v[72:75],a[188:191],v[252:255],v[72:75]
ds_read_b128 v[248:251],v17 offset:45056
s_waitcnt lgkmcnt(5)
v_mfma_f32_16x16x32_bf16 v[64:67],a[64:67],v[224:227],v[64:67]
v_mov_b32 v44,vcc_lo
v_mov_b32 v45,s92
v_min3_u32 v27,v27,v224,v228
v_mfma_f32_16x16x32_bf16 v[72:75],a[192:195],v[224:227],v[72:75]
ds_read_b128 v[252:255],v17 offset:47104
ds_write_b64 v46,v[44:45]
v_mfma_f32_16x16x32_bf16 v[64:67],a[68:71],v[228:231],v[64:67]
buffer_load_dwordx4 v16,s[20:23],s65 offen offset:2048 sc1 lds
v_mfma_f32_16x16x32_bf16 v[72:75],a[196:199],v[228:231],v[72:75]
ds_read_b128 v[224:227],v17 offset:49152
s_waitcnt lgkmcnt(6)
v_mfma_f32_16x16x32_bf16 v[64:67],a[72:75],v[232:235],v[64:67]
s_xor_b32 m0,s72,1024
s_add_u32 s65,s89,0
v_mfma_f32_16x16x32_bf16 v[72:75],a[200:203],v[232:235],v[72:75]
ds_read_b128 v[228:231],v17 offset:51200
v_min3_u32 v27,v27,v232,v236
v_mfma_f32_16x16x32_bf16 v[64:67],a[76:79],v[236:239],v[64:67]
buffer_load_dwordx4 v16,s[20:23],s65 offen offset:0 sc1 lds
v_mfma_f32_16x16x32_bf16 v[72:75],a[204:207],v[236:239],v[72:75]
ds_read_b128 v[232:235],v17 offset:53248
s_waitcnt lgkmcnt(6)
v_mfma_f32_16x16x32_bf16 v[64:67],a[80:83],v[240:243],v[64:67]
buffer_load_dwordx4 v16,s[20:23],s65 offen offset:2048 sc1 lds
v_mfma_f32_16x16x32_bf16 v[72:75],a[208:211],v[240:243],v[72:75]
ds_read_b128 v[236:239],v17 offset:55296
s_xor_b32 m0,s72,17408
v_mfma_f32_16x16x32_bf16 v[64:67],a[84:87],v[244:247],v[64:67]
s_add_u32 s65,s89,32768
v_min3_u32 v27,v27,v240,v244
v_mfma_f32_16x16x32_bf16 v[72:75],a[212:215],v[244:247],v[72:75]
ds_read_b128 v[240:243],v17 offset:57344
s_waitcnt lgkmcnt(6)
v_mfma_f32_16x16x32_bf16 v[64:67],a[88:91],v[248:251],v[64:67]
buffer_load_dwordx4 v16,s[20:23],s65 offen offset:0 sc1 lds
v_mfma_f32_16x16x32_bf16 v[72:75],a[216:219],v[248:251],v[72:75]
ds_read_b128 v[244:247],v17 offset:59392
v_min3_u32 v27,v27,v248,v252
v_mfma_f32_16x16x32_bf16 v[64:67],a[92:95],v[252:255],v[64:67]
buffer_load_dwordx4 v16,s[20:23],s65 offen offset:2048 sc1 lds
v_mfma_f32_16x16x32_bf16 v[72:75],a[220:223],v[252:255],v[72:75]
ds_read_b128 v[248:251],v17 offset:61440
s_waitcnt lgkmcnt(5)
v_mfma_f32_16x16x32_bf16 v[64:67],a[96:99],v[224:227],v[64:67]
s_xor_b32 m0,s72,33792
s_add_u32 s65,s89,65536
v_mfma_f32_16x16x32_bf16 v[72:75],a[224:227],v[224:227],v[72:75]
ds_read_b128 v[252:255],v17 offset:63488
v_min3_u32 v27,v27,v224,v228
v_mfma_f32_16x16x32_bf16 v[64:67],a[100:103],v[228:231],v[64:67]
buffer_load_dwordx4 v16,s[20:23],s65 offen offset:0 sc1 lds
s_waitcnt vmcnt(15)
v_add_u32 v22,s71,-1
v_mfma_f32_16x16x32_bf16 v[72:75],a[228:231],v[228:231],v[72:75]
s_waitcnt vmcnt(20)
s_barrier
ds_read_b64 v[44:45],v47
ds_read_b128 v[224:227],v17 offset:1024
s_waitcnt lgkmcnt(6)
v_mfma_f32_16x16x32_bf16 v[64:67],a[104:107],v[232:235],v[64:67]
buffer_load_dwordx4 v16,s[20:23],s65 offen offset:2048 sc1 lds
buffer_store_dword v22,v23,s[20:23],s97 offen sc1
v_mfma_f32_16x16x32_bf16 v[72:75],a[232:235],v[232:235],v[72:75]
ds_read_b128 v[228:231],v17 offset:3072
s_xor_b32 m0,s72,50176
s_mov_b32 s97,0x7fff0000
v_mfma_f32_16x16x32_bf16 v[64:67],a[108:111],v[236:239],v[64:67]
s_add_u32 s65,s89,98304
v_min3_u32 v27,v27,v232,v236
s_waitcnt vmcnt(15)
v_mfma_f32_16x16x32_bf16 v[72:75],a[236:239],v[236:239],v[72:75]
ds_read_b128 v[232:235],v17 offset:5120
ds_read_b64 v[120:121],v40 offset:0
s_waitcnt lgkmcnt(7)
v_mfma_f32_16x16x32_bf16 v[64:67],a[112:115],v[240:243],v[64:67]
buffer_load_dwordx4 v16,s[20:23],s65 offen offset:0 sc1 lds
ds_read_b64 v[122:123],v41 offset:0
v_mfma_f32_16x16x32_bf16 v[72:75],a[240:243],v[240:243],v[72:75]
ds_read_b128 v[236:239],v17 offset:7168
v_min3_u32 v27,v27,v240,v244
v_mfma_f32_16x16x32_bf16 v[64:67],a[116:119],v[244:247],v[64:67]
buffer_load_dwordx4 v16,s[20:23],s65 offen offset:2048 sc1 lds
v_mfma_f32_16x16x32_bf16 v[72:75],a[244:247],v[244:247],v[72:75]
ds_read_b128 v[240:243],v17 offset:9216
s_waitcnt lgkmcnt(8)
v_mfma_f32_16x16x32_bf16 v[64:67],a[120:123],v[248:251],v[64:67]
s_waitcnt lgkmcnt(7)
v_readfirstlane_b32 s93,v45
v_mfma_f32_16x16x32_bf16 v[72:75],a[248:251],v[248:251],v[72:75]
ds_read_b128 v[244:247],v17 offset:11264
v_min3_u32 v27,v27,v248,v252
v_mfma_f32_16x16x32_bf16 v[64:67],a[124:127],v[252:255],v[64:67]
ds_read_b64 v[124:125],v40 offset:1024
ds_read_b64 v[126:127],v41 offset:1024
v_mfma_f32_16x16x32_bf16 v[72:75],a[252:255],v[252:255],v[72:75]
ds_read_b128 v[248:251],v17 offset:13312
s_waitcnt lgkmcnt(9)
v_mfma_f32_16x16x32_bf16 v[68:71],a[0:3],v[224:227],0
v_cmp_eq_u32 vcc,0,v27
s_cbranch_vccnz retry_239
v_mfma_f32_16x16x32_bf16 v[76:79],a[128:131],v[224:227],0
ds_read_b128 v[252:255],v17 offset:15360
v_min3_u32 v27,v27,v224,v228
v_mfma_f32_16x16x32_bf16 v[68:71],a[4:7],v[228:231],v[68:71]
v_mfma_f32_16x16x32_bf16 v[76:79],a[132:135],v[228:231],v[76:79]
ds_read_b128 v[224:227],v17 offset:17408
s_waitcnt lgkmcnt(7)
v_mfma_f32_16x16x32_bf16 v[68:71],a[8:11],v[232:235],v[68:71]
v_min3_u32 v27,v27,v232,v236
s_waitcnt lgkmcnt(3)
v_lshlrev_b32 v88,16,v120
v_mfma_f32_16x16x32_bf16 v[76:79],a[136:139],v[232:235],v[76:79]
ds_read_b128 v[228:231],v17 offset:19456
v_and_b32 v89,s80,v120
v_lshlrev_b32 v90,16,v121
v_mfma_f32_16x16x32_bf16 v[68:71],a[12:15],v[236:239],v[68:71]
v_and_b32 v91,s80,v121
v_lshlrev_b32 v92,16,v122
v_and_b32 v93,s80,v122
v_mfma_f32_16x16x32_bf16 v[76:79],a[140:143],v[236:239],v[76:79]
ds_read_b128 v[232:235],v17 offset:21504
v_lshlrev_b32 v94,16,v123
v_mfma_f32_16x16x32_bf16 v[68:71],a[16:19],v[240:243],v[68:71]
v_min3_u32 v27,v27,v240,v244
v_and_b32 v95,s80,v123
v_mfma_f32_16x16x32_bf16 v[76:79],a[144:147],v[240:243],v[76:79]
ds_read_b128 v[236:239],v17 offset:23552
v_add_f32 v88,v64,v88
v_mfma_f32_16x16x32_bf16 v[68:71],a[20:23],v[244:247],v[68:71]
v_add_f32 v89,v65,v89
v_add_f32 v90,v66,v90
v_mfma_f32_16x16x32_bf16 v[76:79],a[148:151],v[244:247],v[76:79]
ds_read_b128 v[240:243],v17 offset:25600
s_waitcnt lgkmcnt(5)
v_mfma_f32_16x16x32_bf16 v[68:71],a[24:27],v[248:251],v[68:71]
v_min3_u32 v27,v27,v248,v252
v_add_f32 v91,v67,v91
v_mfma_f32_16x16x32_bf16 v[76:79],a[152:155],v[248:251],v[76:79]
ds_read_b128 v[244:247],v17 offset:27648
v_add_f32 v92,v72,v92
v_mfma_f32_16x16x32_bf16 v[68:71],a[28:31],v[252:255],v[68:71]
v_add_f32 v93,v73,v93
v_add_f32 v94,v74,v94
v_mfma_f32_16x16x32_bf16 v[76:79],a[156:159],v[252:255],v[76:79]
ds_read_b128 v[248:251],v17 offset:29696
s_waitcnt lgkmcnt(5)
v_mfma_f32_16x16x32_bf16 v[68:71],a[32:35],v[224:227],v[68:71]
v_min3_u32 v27,v27,v224,v228
v_add_f32 v95,v75,v95
v_mfma_f32_16x16x32_bf16 v[76:79],a[160:163],v[224:227],v[76:79]
ds_read_b128 v[252:255],v17 offset:31744
v_cvt_pk_bf16_f32 v96,v88,v89
v_mfma_f32_16x16x32_bf16 v[68:71],a[36:39],v[228:231],v[68:71]
v_cvt_pk_bf16_f32 v97,v90,v91
v_cvt_pk_bf16_f32 v98,v92,v93
v_mfma_f32_16x16x32_bf16 v[76:79],a[164:167],v[228:231],v[76:79]
ds_read_b128 v[224:227],v17 offset:33792
s_waitcnt lgkmcnt(5)
v_mfma_f32_16x16x32_bf16 v[68:71],a[40:43],v[232:235],v[68:71]
v_min3_u32 v27,v27,v232,v236
v_cvt_pk_bf16_f32 v99,v94,v95
v_mfma_f32_16x16x32_bf16 v[76:79],a[168:171],v[232:235],v[76:79]
ds_read_b128 v[228:231],v17 offset:35840
v_max_u32 v96,1,v96
v_mfma_f32_16x16x32_bf16 v[68:71],a[44:47],v[236:239],v[68:71]
buffer_store_dwordx4 v[96:99],v18,s[20:23],s70 offen offset:0 sc1
v_mfma_f32_16x16x32_bf16 v[76:79],a[172:175],v[236:239],v[76:79]
ds_read_b128 v[232:235],v17 offset:37888
s_waitcnt lgkmcnt(5)
v_mfma_f32_16x16x32_bf16 v[68:71],a[48:51],v[240:243],v[68:71]
v_min3_u32 v27,v27,v240,v244
v_lshlrev_b32 v88,16,v96
v_mfma_f32_16x16x32_bf16 v[76:79],a[176:179],v[240:243],v[76:79]
ds_read_b128 v[236:239],v17 offset:39936
v_and_b32 v89,s80,v96
v_mfma_f32_16x16x32_bf16 v[68:71],a[52:55],v[244:247],v[68:71]
v_lshlrev_b32 v90,16,v97
v_and_b32 v91,s80,v97
v_mfma_f32_16x16x32_bf16 v[76:79],a[180:183],v[244:247],v[76:79]
ds_read_b128 v[240:243],v17 offset:41984
s_waitcnt lgkmcnt(5)
v_mfma_f32_16x16x32_bf16 v[68:71],a[56:59],v[248:251],v[68:71]
v_min3_u32 v27,v27,v248,v252
v_lshlrev_b32 v92,16,v98
v_mfma_f32_16x16x32_bf16 v[76:79],a[184:187],v[248:251],v[76:79]
ds_read_b128 v[244:247],v17 offset:44032
v_and_b32 v93,s80,v98
v_mfma_f32_16x16x32_bf16 v[68:71],a[60:63],v[252:255],v[68:71]
v_lshlrev_b32 v94,16,v99
v_and_b32 v95,s80,v99
v_mfma_f32_16x16x32_bf16 v[76:79],a[188:191],v[252:255],v[76:79]
ds_read_b128 v[248:251],v17 offset:46080
s_waitcnt lgkmcnt(5)
v_mfma_f32_16x16x32_bf16 v[68:71],a[64:67],v[224:227],v[68:71]
v_min3_u32 v27,v27,v224,v228
v_add_f32 v108,v88,v89
v_mfma_f32_16x16x32_bf16 v[76:79],a[192:195],v[224:227],v[76:79]
ds_read_b128 v[252:255],v17 offset:48128
v_mul_f32 v109,v88,v88
v_mfma_f32_16x16x32_bf16 v[68:71],a[68:71],v[228:231],v[68:71]
v_add_f32 v100,v90,v91
v_mul_f32 v101,v89,v89
v_mfma_f32_16x16x32_bf16 v[76:79],a[196:199],v[228:231],v[76:79]
ds_read_b128 v[224:227],v17 offset:50176
s_waitcnt lgkmcnt(5)
v_mfma_f32_16x16x32_bf16 v[68:71],a[72:75],v[232:235],v[68:71]
v_min3_u32 v27,v27,v232,v236
v_fmac_f32 v109,v90,v90
v_mfma_f32_16x16x32_bf16 v[76:79],a[200:203],v[232:235],v[76:79]
ds_read_b128 v[228:231],v17 offset:52224
v_fmac_f32 v101,v91,v91
v_mfma_f32_16x16x32_bf16 v[68:71],a[76:79],v[236:239],v[68:71]
v_fmac_f32 v109,v92,v92
v_fmac_f32 v101,v93,v93
v_mfma_f32_16x16x32_bf16 v[76:79],a[204:207],v[236:239],v[76:79]
ds_read_b128 v[232:235],v17 offset:54272
s_waitcnt lgkmcnt(5)
v_mfma_f32_16x16x32_bf16 v[68:71],a[80:83],v[240:243],v[68:71]
v_min3_u32 v27,v27,v240,v244
v_add_f32 v108,v108,v92
v_mfma_f32_16x16x32_bf16 v[76:79],a[208:211],v[240:243],v[76:79]
ds_read_b128 v[236:239],v17 offset:56320
v_add_f32 v100,v100,v93
v_mfma_f32_16x16x32_bf16 v[68:71],a[84:87],v[244:247],v[68:71]
v_fmac_f32 v109,v94,v94
v_fmac_f32 v101,v95,v95
v_mfma_f32_16x16x32_bf16 v[76:79],a[212:215],v[244:247],v[76:79]
ds_read_b128 v[240:243],v17 offset:58368
s_waitcnt lgkmcnt(5)
v_mfma_f32_16x16x32_bf16 v[68:71],a[88:91],v[248:251],v[68:71]
v_min3_u32 v27,v27,v248,v252
v_add_f32 v108,v108,v94
v_mfma_f32_16x16x32_bf16 v[76:79],a[216:219],v[248:251],v[76:79]
ds_read_b128 v[244:247],v17 offset:60416
v_add_f32 v100,v100,v95
v_mfma_f32_16x16x32_bf16 v[68:71],a[92:95],v[252:255],v[68:71]
v_add_f32 v108,v108,v100
v_add_f32 v109,v109,v101
v_mfma_f32_16x16x32_bf16 v[76:79],a[220:223],v[252:255],v[76:79]
ds_read_b128 v[248:251],v17 offset:62464
s_waitcnt lgkmcnt(5)
v_mfma_f32_16x16x32_bf16 v[68:71],a[96:99],v[224:227],v[68:71]
v_min3_u32 v27,v27,v224,v228
v_mov_b32 v100,v108
v_mfma_f32_16x16x32_bf16 v[76:79],a[224:227],v[224:227],v[76:79]
ds_read_b128 v[252:255],v17 offset:64512
v_mov_b32 v101,v109
v_mfma_f32_16x16x32_bf16 v[68:71],a[100:103],v[228:231],v[68:71]
v_permlane16_swap_b32 v100,v108
v_permlane16_swap_b32 v101,v109
v_mfma_f32_16x16x32_bf16 v[76:79],a[228:231],v[228:231],v[76:79]
v_add_f32 v108,v108,v100
s_waitcnt lgkmcnt(4)
v_mfma_f32_16x16x32_bf16 v[68:71],a[104:107],v[232:235],v[68:71]
v_min3_u32 v27,v27,v232,v236
v_add_f32 v109,v109,v101
v_mfma_f32_16x16x32_bf16 v[76:79],a[232:235],v[232:235],v[76:79]
v_mov_b32 v100,v108
v_mov_b32 v101,v109
v_mfma_f32_16x16x32_bf16 v[68:71],a[108:111],v[236:239],v[68:71]
v_permlane32_swap_b32 v100,v108
v_permlane32_swap_b32 v101,v109
v_mfma_f32_16x16x32_bf16 v[76:79],a[236:239],v[236:239],v[76:79]
v_add_f32 v108,v108,v100
s_waitcnt lgkmcnt(2)
v_mfma_f32_16x16x32_bf16 v[68:71],a[112:115],v[240:243],v[68:71]
v_min3_u32 v27,v27,v240,v244
v_add_f32 v109,v109,v101
v_mfma_f32_16x16x32_bf16 v[76:79],a[240:243],v[240:243],v[76:79]
v_min3_u32 v27,v27,v120,v122
v_min3_u32 v27,v27,v124,v126
v_mfma_f32_16x16x32_bf16 v[68:71],a[116:119],v[244:247],v[68:71]
v_lshlrev_b32 v32,16,v124
v_and_b32 v33,s80,v124
v_mfma_f32_16x16x32_bf16 v[76:79],a[244:247],v[244:247],v[76:79]
v_lshlrev_b32 v34,16,v125
s_waitcnt lgkmcnt(0)
v_mfma_f32_16x16x32_bf16 v[68:71],a[120:123],v[248:251],v[68:71]
v_min3_u32 v27,v27,v248,v252
v_and_b32 v35,s80,v125
v_mfma_f32_16x16x32_bf16 v[76:79],a[248:251],v[248:251],v[76:79]
v_lshlrev_b32 v36,16,v126
v_and_b32 v37,s80,v126
v_mfma_f32_16x16x32_bf16 v[68:71],a[124:127],v[252:255],v[68:71]
v_lshlrev_b32 v38,16,v127
v_and_b32 v39,s80,v127
v_mfma_f32_16x16x32_bf16 v[76:79],a[252:255],v[252:255],v[76:79]
v_cmp_eq_u32 vcc,0,v27
s_cbranch_vccnz retry_239
epi_242:
buffer_load_dword v29,v21,s[20:23],s87 offen sc1
s_cmp_gt_u32 s71,40
s_cselect_b32 s65,s73,0x7fff0000
s_cselect_b32 s97,0x7fff0000,s73
v_mov_b32 v22,s71
buffer_store_dword v22,v23,s[20:23],s65 offen sc1
v_pk_add_f32 v[88:89],v[68:69],v[32:33]
v_pk_add_f32 v[90:91],v[70:71],v[34:35]
v_pk_add_f32 v[92:93],v[76:77],v[36:37]
v_pk_add_f32 v[94:95],v[78:79],v[38:39]
v_cvt_pk_bf16_f32 v96,v88,v89
v_cvt_pk_bf16_f32 v97,v90,v91
v_cvt_pk_bf16_f32 v98,v92,v93
v_cvt_pk_bf16_f32 v99,v94,v95
v_max_u32 v96,1,v96
buffer_store_dwordx4 v[96:99],v18,s[20:23],s70 offen offset:1024 sc1
v_lshlrev_b32 v88,16,v96
v_and_b32 v89,s80,v96
v_lshlrev_b32 v90,16,v97
v_and_b32 v91,s80,v97
v_lshlrev_b32 v92,16,v98
v_and_b32 v93,s80,v98
v_lshlrev_b32 v94,16,v99
v_and_b32 v95,s80,v99
v_pk_mul_f32 v[102:103],v[88:89],v[88:89]
v_pk_add_f32 v[100:101],v[88:89],v[90:91]
v_pk_mul_f32 v[106:107],v[90:91],v[90:91]
v_pk_add_f32 v[104:105],v[92:93],v[94:95]
v_pk_fma_f32 v[102:103],v[92:93],v[92:93],v[102:103]
v_pk_fma_f32 v[106:107],v[94:95],v[94:95],v[106:107]
v_pk_add_f32 v[100:101],v[100:101],v[104:105]
v_pk_add_f32 v[102:103],v[102:103],v[106:107]
v_add_f32 v110,v100,v101
v_add_f32 v111,v102,v103
v_mov_b32 v100,v110
v_mov_b32 v101,v111
s_nop 0
v_permlane16_swap_b32 v100,v110
v_permlane16_swap_b32 v101,v111
v_add_f32 v110,v110,v100
v_add_f32 v111,v111,v101
v_mov_b32 v100,v110
v_mov_b32 v101,v111
s_nop 0
v_permlane32_swap_b32 v100,v110
v_permlane32_swap_b32 v101,v111
v_add_f32 v110,v110,v100
v_add_f32 v111,v111,v101
v_max_u32 v109,1,v109
buffer_store_dwordx4 v[108:111],v24,s[20:23],s70 offen sc1
s_cmp_eq_u32 s71,63
s_cselect_b32 s64,0,0x2000
s_cselect_b32 s66,2,1
s_lshl_b32 s66,s66,21
s_add_u32 s78,s78,s66
v_xor_b32 v19,s64,v19
v_xor_b32 v20,s64,v20
next_249:
v_xor_b32 v17,0x10000,v17
s_xor_b32 s72,s72,0x10000
s_add_u32 s70,s70,2097152
s_xor_b32 s70,s70,0x2000
s_add_u32 s71,s71,1
s_cmp_le_u32 s71,s57
s_cbranch_scc1 seg_240
s_endpgm
retry_239:
s_sub_u32 s90,s90,64
s_cmp_lt_i32 s90,0
s_cbranch_scc1 giveup_197
s_mov_b32 s83,1
s_waitcnt vmcnt(0) lgkmcnt(0)
s_barrier
s_branch seg_240
half_248:
s_mov_b32 s88,s94
s_mov_b32 s89,s95
s_add_u32 s94,s94,2097152
s_xor_b32 s94,s94,0x2000
s_xor_b32 s95,s94,1024
s_mov_b64 exec,s[52:53]
s_xor_b32 m0,s91,0
s_add_u32 s65,s94,0
buffer_load_dwordx4 v16,s[20:23],s65 offen offset:0 sc1 lds
buffer_load_dwordx4 v16,s[20:23],s65 offen offset:2048 sc1 lds
s_xor_b32 m0,s91,16384
s_add_u32 s65,s94,32768
buffer_load_dwordx4 v16,s[20:23],s65 offen offset:0 sc1 lds
buffer_load_dwordx4 v16,s[20:23],s65 offen offset:2048 sc1 lds
s_xor_b32 m0,s91,32768
s_add_u32 s65,s94,65536
buffer_load_dwordx4 v16,s[20:23],s65 offen offset:0 sc1 lds
buffer_load_dwordx4 v16,s[20:23],s65 offen offset:2048 sc1 lds
s_xor_b32 m0,s91,49152
s_add_u32 s65,s94,98304
buffer_load_dwordx4 v16,s[20:23],s65 offen offset:0 sc1 lds
buffer_load_dwordx4 v16,s[20:23],s65 offen offset:2048 sc1 lds
s_mov_b64 exec,-1
s_add_u32 m0,s43,0
s_nop 0
buffer_load_dwordx4 v19,s[20:23],s78 offen sc1 lds
s_waitcnt vmcnt(9)
v_add_u32 v22,s71,-1
buffer_store_dword v22,v23,s[20:23],s97 offen sc1
s_mov_b32 s97,0x7fff0000
half2_245:
s_waitcnt vmcnt(8)
s_barrier
ds_read_b128 v[224:227],v17 offset:0
ds_read_b128 v[228:231],v17 offset:2048
ds_read_b128 v[232:235],v17 offset:4096
ds_read_b128 v[236:239],v17 offset:6144
ds_read_b128 v[240:243],v17 offset:8192
ds_read_b128 v[244:247],v17 offset:10240
ds_read_b128 v[248:251],v17 offset:12288
s_waitcnt lgkmcnt(5)
v_mfma_f32_16x16x32_bf16 v[64:67],a[0:3],v[224:227],0
s_xor_b32 m0,s72,0
v_min_u32 v27,v224,v228
v_mfma_f32_16x16x32_bf16 v[72:75],a[128:131],v[224:227],0
ds_read_b128 v[252:255],v17 offset:14336
s_add_u32 s65,s88,0
v_mfma_f32_16x16x32_bf16 v[64:67],a[4:7],v[228:231],v[64:67]
buffer_load_dwordx4 v16,s[20:23],s65 offen offset:0 sc1 lds
v_mfma_f32_16x16x32_bf16 v[72:75],a[132:135],v[228:231],v[72:75]
s_waitcnt vmcnt(7)
s_barrier
ds_read_b128 v[224:227],v17 offset:16384
s_waitcnt lgkmcnt(5)
v_mfma_f32_16x16x32_bf16 v[64:67],a[8:11],v[232:235],v[64:67]
buffer_load_dwordx4 v16,s[20:23],s65 offen offset:2048 sc1 lds
v_mfma_f32_16x16x32_bf16 v[72:75],a[136:139],v[232:235],v[72:75]
ds_read_b128 v[228:231],v17 offset:18432
s_xor_b32 m0,s72,16384
v_mfma_f32_16x16x32_bf16 v[64:67],a[12:15],v[236:239],v[64:67]
s_add_u32 s65,s88,32768
v_min3_u32 v27,v27,v232,v236
v_mfma_f32_16x16x32_bf16 v[72:75],a[140:143],v[236:239],v[72:75]
ds_read_b128 v[232:235],v17 offset:20480
s_waitcnt lgkmcnt(5)
v_mfma_f32_16x16x32_bf16 v[64:67],a[16:19],v[240:243],v[64:67]
buffer_load_dwordx4 v16,s[20:23],s65 offen offset:0 sc1 lds
v_mfma_f32_16x16x32_bf16 v[72:75],a[144:147],v[240:243],v[72:75]
ds_read_b128 v[236:239],v17 offset:22528
buffer_load_dwordx4 v16,s[20:23],s65 offen offset:2048 sc1 lds
v_mfma_f32_16x16x32_bf16 v[64:67],a[20:23],v[244:247],v[64:67]
s_xor_b32 m0,s72,32768
v_min3_u32 v27,v27,v240,v244
v_mfma_f32_16x16x32_bf16 v[72:75],a[148:151],v[244:247],v[72:75]
ds_read_b128 v[240:243],v17 offset:24576
s_add_u32 s65,s88,65536
s_waitcnt lgkmcnt(5)
v_mfma_f32_16x16x32_bf16 v[64:67],a[24:27],v[248:251],v[64:67]
buffer_load_dwordx4 v16,s[20:23],s65 offen offset:0 sc1 lds
v_mfma_f32_16x16x32_bf16 v[72:75],a[152:155],v[248:251],v[72:75]
ds_read_b128 v[244:247],v17 offset:26624
buffer_load_dwordx4 v16,s[20:23],s65 offen offset:2048 sc1 lds
v_mfma_f32_16x16x32_bf16 v[64:67],a[28:31],v[252:255],v[64:67]
v_min3_u32 v27,v27,v248,v252
v_mfma_f32_16x16x32_bf16 v[72:75],a[156:159],v[252:255],v[72:75]
ds_read_b128 v[248:251],v17 offset:28672
s_xor_b32 m0,s72,49152
s_waitcnt lgkmcnt(5)
v_mfma_f32_16x16x32_bf16 v[64:67],a[32:35],v[224:227],v[64:67]
s_add_u32 s65,s88,98304
v_min3_u32 v27,v27,v224,v228
v_mfma_f32_16x16x32_bf16 v[72:75],a[160:163],v[224:227],v[72:75]
ds_read_b128 v[252:255],v17 offset:30720
buffer_load_dwordx4 v16,s[20:23],s65 offen offset:0 sc1 lds
v_mfma_f32_16x16x32_bf16 v[64:67],a[36:39],v[228:231],v[64:67]
buffer_load_dwordx4 v16,s[20:23],s65 offen offset:2048 sc1 lds
v_mfma_f32_16x16x32_bf16 v[72:75],a[164:167],v[228:231],v[72:75]
s_waitcnt vmcnt(10)
s_barrier
ds_read_b128 v[224:227],v17 offset:32768
s_waitcnt lgkmcnt(5)
v_mfma_f32_16x16x32_bf16 v[64:67],a[40:43],v[232:235],v[64:67]
s_xor_b32 m0,s72,1024
v_min3_u32 v27,v27,v232,v236
v_mfma_f32_16x16x32_bf16 v[72:75],a[168:171],v[232:235],v[72:75]
ds_read_b128 v[228:231],v17 offset:34816
s_add_u32 s65,s89,0
v_mfma_f32_16x16x32_bf16 v[64:67],a[44:47],v[236:239],v[64:67]
buffer_load_dwordx4 v16,s[20:23],s65 offen offset:0 sc1 lds
v_mfma_f32_16x16x32_bf16 v[72:75],a[172:175],v[236:239],v[72:75]
ds_read_b128 v[232:235],v17 offset:36864
s_waitcnt lgkmcnt(5)
v_mfma_f32_16x16x32_bf16 v[64:67],a[48:51],v[240:243],v[64:67]
buffer_load_dwordx4 v16,s[20:23],s65 offen offset:2048 sc1 lds
v_mfma_f32_16x16x32_bf16 v[72:75],a[176:179],v[240:243],v[72:75]
ds_read_b128 v[236:239],v17 offset:38912
s_xor_b32 m0,s72,17408
v_mfma_f32_16x16x32_bf16 v[64:67],a[52:55],v[244:247],v[64:67]
s_add_u32 s65,s89,32768
v_min3_u32 v27,v27,v240,v244
v_mfma_f32_16x16x32_bf16 v[72:75],a[180:183],v[244:247],v[72:75]
ds_read_b128 v[240:243],v17 offset:40960
s_waitcnt lgkmcnt(5)
v_mfma_f32_16x16x32_bf16 v[64:67],a[56:59],v[248:251],v[64:67]
buffer_load_dwordx4 v16,s[20:23],s65 offen offset:0 sc1 lds
v_mfma_f32_16x16x32_bf16 v[72:75],a[184:187],v[248:251],v[72:75]
ds_read_b128 v[244:247],v17 offset:43008
v_min3_u32 v27,v27,v248,v252
v_mfma_f32_16x16x32_bf16 v[64:67],a[60:63],v[252:255],v[64:67]
buffer_load_dwordx4 v16,s[20:23],s65 offen offset:2048 sc1 lds
v_mfma_f32_16x16x32_bf16 v[72:75],a[188:191],v[252:255],v[72:75]
ds_read_b128 v[248:251],v17 offset:45056
s_waitcnt lgkmcnt(5)
v_mfma_f32_16x16x32_bf16 v[64:67],a[64:67],v[224:227],v[64:67]
s_xor_b32 m0,s72,33792
s_add_u32 s65,s89,65536
v_mfma_f32_16x16x32_bf16 v[72:75],a[192:195],v[224:227],v[72:75]
ds_read_b128 v[252:255],v17 offset:47104
v_min3_u32 v27,v27,v224,v228
v_mfma_f32_16x16x32_bf16 v[64:67],a[68:71],v[228:231],v[64:67]
buffer_load_dwordx4 v16,s[20:23],s65 offen offset:0 sc1 lds
v_mfma_f32_16x16x32_bf16 v[72:75],a[196:199],v[228:231],v[72:75]
ds_read_b128 v[224:227],v17 offset:49152
s_waitcnt lgkmcnt(5)
v_mfma_f32_16x16x32_bf16 v[64:67],a[72:75],v[232:235],v[64:67]
buffer_load_dwordx4 v16,s[20:23],s65 offen offset:2048 sc1 lds
v_mfma_f32_16x16x32_bf16 v[72:75],a[200:203],v[232:235],v[72:75]
ds_read_b128 v[228:231],v17 offset:51200
s_xor_b32 m0,s72,50176
v_mfma_f32_16x16x32_bf16 v[64:67],a[76:79],v[236:239],v[64:67]
s_add_u32 s65,s89,98304
v_min3_u32 v27,v27,v232,v236
v_mfma_f32_16x16x32_bf16 v[72:75],a[204:207],v[236:239],v[72:75]
ds_read_b128 v[232:235],v17 offset:53248
s_waitcnt lgkmcnt(5)
v_mfma_f32_16x16x32_bf16 v[64:67],a[80:83],v[240:243],v[64:67]
buffer_load_dwordx4 v16,s[20:23],s65 offen offset:0 sc1 lds
v_mfma_f32_16x16x32_bf16 v[72:75],a[208:211],v[240:243],v[72:75]
ds_read_b128 v[236:239],v17 offset:55296
v_min3_u32 v27,v27,v240,v244
v_mfma_f32_16x16x32_bf16 v[64:67],a[84:87],v[244:247],v[64:67]
buffer_load_dwordx4 v16,s[20:23],s65 offen offset:2048 sc1 lds
v_mfma_f32_16x16x32_bf16 v[72:75],a[212:215],v[244:247],v[72:75]
ds_read_b128 v[240:243],v17 offset:57344
s_waitcnt lgkmcnt(5)
v_mfma_f32_16x16x32_bf16 v[64:67],a[88:91],v[248:251],v[64:67]
v_min3_u32 v27,v27,v248,v252
v_mfma_f32_16x16x32_bf16 v[72:75],a[216:219],v[248:251],v[72:75]
ds_read_b128 v[244:247],v17 offset:59392
v_mfma_f32_16x16x32_bf16 v[64:67],a[92:95],v[252:255],v[64:67]
v_mfma_f32_16x16x32_bf16 v[72:75],a[220:223],v[252:255],v[72:75]
ds_read_b128 v[248:251],v17 offset:61440
s_waitcnt lgkmcnt(5)
v_mfma_f32_16x16x32_bf16 v[64:67],a[96:99],v[224:227],v[64:67]
v_min3_u32 v27,v27,v224,v228
v_mfma_f32_16x16x32_bf16 v[72:75],a[224:227],v[224:227],v[72:75]
ds_read_b128 v[252:255],v17 offset:63488
v_mfma_f32_16x16x32_bf16 v[64:67],a[100:103],v[228:231],v[64:67]
v_mfma_f32_16x16x32_bf16 v[72:75],a[228:231],v[228:231],v[72:75]
s_waitcnt lgkmcnt(4)
v_mfma_f32_16x16x32_bf16 v[64:67],a[104:107],v[232:235],v[64:67]
v_min3_u32 v27,v27,v232,v236
s_waitcnt vmcnt(17)
v_mfma_f32_16x16x32_bf16 v[72:75],a[232:235],v[232:235],v[72:75]
ds_read_b64 v[120:121],v40
ds_read_b64 v[122:123],v41
v_mfma_f32_16x16x32_bf16 v[64:67],a[108:111],v[236:239],v[64:67]
v_mfma_f32_16x16x32_bf16 v[72:75],a[236:239],v[236:239],v[72:75]
s_waitcnt lgkmcnt(4)
v_mfma_f32_16x16x32_bf16 v[64:67],a[112:115],v[240:243],v[64:67]
v_min3_u32 v27,v27,v240,v244
v_mfma_f32_16x16x32_bf16 v[72:75],a[240:243],v[240:243],v[72:75]
v_mfma_f32_16x16x32_bf16 v[64:67],a[116:119],v[244:247],v[64:67]
v_mfma_f32_16x16x32_bf16 v[72:75],a[244:247],v[244:247],v[72:75]
s_waitcnt lgkmcnt(2)
v_mfma_f32_16x16x32_bf16 v[64:67],a[120:123],v[248:251],v[64:67]
v_min3_u32 v27,v27,v248,v252
v_mfma_f32_16x16x32_bf16 v[72:75],a[248:251],v[248:251],v[72:75]
v_mfma_f32_16x16x32_bf16 v[64:67],a[124:127],v[252:255],v[64:67]
v_mfma_f32_16x16x32_bf16 v[72:75],a[252:255],v[252:255],v[72:75]
s_waitcnt lgkmcnt(0)
v_min3_u32 v27,v27,v120,v122
v_cmp_eq_u32 vcc,0,v27
s_and_b64 vcc,vcc,s[52:53]
s_cbranch_vccnz retry_239
v_mov_b32 v22,s71
buffer_store_dword v22,v23,s[20:23],s73 offen sc1
v_lshlrev_b32 v88,16,v120
v_and_b32 v89,s80,v120
v_lshlrev_b32 v90,16,v121
v_and_b32 v91,s80,v121
v_lshlrev_b32 v92,16,v122
v_and_b32 v93,s80,v122
v_lshlrev_b32 v94,16,v123
v_and_b32 v95,s80,v123
v_add_f32 v88,v64,v88
v_add_f32 v89,v65,v89
v_add_f32 v90,v66,v90
v_add_f32 v91,v67,v91
v_add_f32 v92,v72,v92
v_add_f32 v93,v73,v93
v_add_f32 v94,v74,v94
v_add_f32 v95,v75,v95
v_cvt_pk_bf16_f32 v96,v88,v89
v_cvt_pk_bf16_f32 v97,v90,v91
v_cvt_pk_bf16_f32 v98,v92,v93
v_cvt_pk_bf16_f32 v99,v94,v95
v_max_u32 v96,1,v96
buffer_store_dwordx4 v[96:99],v18,s[20:23],s70 offen offset:0 sc1
v_lshlrev_b32 v88,16,v96
v_and_b32 v89,s80,v96
v_lshlrev_b32 v90,16,v97
v_and_b32 v91,s80,v97
v_lshlrev_b32 v92,16,v98
v_and_b32 v93,s80,v98
v_lshlrev_b32 v94,16,v99
v_and_b32 v95,s80,v99
v_add_f32 v108,v88,v89
v_mul_f32 v109,v88,v88
v_add_f32 v100,v90,v91
v_mul_f32 v101,v89,v89
v_fmac_f32 v109,v90,v90
v_fmac_f32 v101,v91,v91
v_fmac_f32 v109,v92,v92
v_fmac_f32 v101,v93,v93
v_add_f32 v108,v108,v92
v_add_f32 v100,v100,v93
v_fmac_f32 v109,v94,v94
v_fmac_f32 v101,v95,v95
v_add_f32 v108,v108,v94
v_add_f32 v100,v100,v95
v_add_f32 v108,v108,v100
v_add_f32 v109,v109,v101
v_mov_b32 v100,v108
v_mov_b32 v101,v109
s_nop 0
v_permlane16_swap_b32 v100,v108
v_permlane16_swap_b32 v101,v109
v_add_f32 v108,v108,v100
v_add_f32 v109,v109,v101
v_mov_b32 v100,v108
v_mov_b32 v101,v109
s_nop 0
v_permlane32_swap_b32 v100,v108
v_permlane32_swap_b32 v101,v109
v_add_f32 v108,v108,v100
v_add_f32 v109,v109,v101
v_max_u32 v109,1,v109
buffer_store_dwordx4 v[108:111],v24,s[20:23],s70 offen sc1
v_xor_b32 v19,0x2000,v19
v_xor_b32 v20,0x2000,v20
s_sub_u32 s78,s78,2097152
v_mov_b32 v29,0
s_mov_b32 s83,0
s_mov_b32 s93,1
s_waitcnt vmcnt(3)
s_branch next_249
r_at_219:
v_mov_b32 v128,0
v_mov_b32 v129,0
v_mov_b32 v130,0
v_mov_b32 v131,0
s_cmp_ge_u32 s50,2
s_cbranch_scc1 r_ln_218
v_and_b32 v21,1,v1
v_mul_u32_u24 v21,64,v21
s_mov_b32 s65,21052928
s_mov_b32 s66,1792
pl_254:
buffer_load_dword v22,v21,s[20:23],s65 offen sc1
s_waitcnt vmcnt(0)
v_cmp_gt_u32 vcc,s66,v22
s_cbranch_vccz pok_255
s_sleep 1
s_sub_u32 s90,s90,1
s_cmp_gt_i32 s90,0
s_cbranch_scc1 pl_254
pok_255:
s_lshl_b32 s41,s41,1
s_add_u32 s41,s41,s50
v_and_b32 v21,3,v1
v_lshlrev_b32 v21,7,v21
s_lshl_b32 s65,s41,2
s_add_u32 s87,s65,s63
v_mov_b32 v99,v21
pl_256:
buffer_load_dword v22,v21,s[20:23],s87 offen sc1
s_waitcnt vmcnt(0)
v_cmp_gt_u32 vcc,14,v22
s_cbranch_vccz pok_257
s_sleep 1
s_sub_u32 s90,s90,1
s_cmp_gt_i32 s90,0
s_cbranch_scc1 pl_256
pok_257:
v_mov_b32 v21,s56
v_lshlrev_b32 v21,2,v21
s_mov_b32 s66,128
pl_258:
buffer_load_dword v22,v21,s[44:47],36 offen sc1
s_waitcnt vmcnt(0)
v_cmp_gt_u32 vcc,s66,v22
s_cbranch_vccz pok_259
s_sleep 1
s_sub_u32 s90,s90,1
s_cmp_gt_i32 s90,0
s_cbranch_scc1 pl_258
pok_259:
s_lshl_b32 s42,s41,14
s_lshr_b32 s43,s41,1
s_lshl_b32 s43,s43,14
s_and_b32 s64,s41,1
s_lshl_b32 s64,s64,12
s_add_u32 s43,s43,s64
s_add_u32 s43,s43,1572864
s_lshl_b32 s73,s41,7
s_add_u32 s73,s73,s63
s_add_u32 s73,s73,16384
v_lshrrev_b32 v6,3,v3
v_and_b32 v7,7,v3
v_lshl_add_u32 v6,v6,4,v7
v_lshlrev_b32 v6,4,v6
v_and_b32 v7,1,v4
v_lshl_add_u32 v6,v7,3,v6
v_lshrrev_b32 v8,2,v3
v_and_b32 v9,3,v3
v_lshl_add_u32 v8,v8,3,v9
s_mov_b32 s80,0x3e0293ee
v_mov_b32 v97,0xff800000
v_lshlrev_b32 v96,10,v1
v_lshlrev_b32 v98,3,v4
v_sub_u32 v98,v98,v8
v_cmp_lt_u32 s[48:49],1,v4
v_cmp_ge_i32 s[4:5],-7,v98
v_cmp_ge_i32 s[6:7],-6,v98
v_cmp_ge_i32 s[8:9],-5,v98
v_cmp_ge_i32 s[10:11],-4,v98
v_cmp_ge_i32 s[12:13],-3,v98
v_cmp_ge_i32 s[14:15],-2,v98
v_cmp_ge_i32 s[16:17],-1,v98
v_cmp_ge_i32 s[18:19],0,v98
v_cmp_ge_i32 s[32:33],1,v98
v_cmp_ge_i32 s[34:35],2,v98
v_cmp_ge_i32 s[36:37],3,v98
v_cmp_ge_i32 s[38:39],4,v98
s_add_u32 s64,s79,0
s_lshl_b32 s74,s64,21
s_lshl_b32 s64,s64,13
s_and_b32 s64,s64,0x2000
s_xor_b32 s64,s64,s61
s_add_u32 s74,s74,s64
s_add_u32 s74,s74,29360128
s_lshl_b32 s64,s50,2
s_add_u32 s64,s64,147456
v_mov_b32 v95,s64
ds_write_b32 v95,v128
s_add_u32 s66,s74,s43
kp_260:
s_add_u32 s78,s78,2
buffer_load_dwordx4 v[136:139],v16,s[20:23],s66 offen offset:0 sc1
buffer_load_dwordx4 v[140:143],v16,s[20:23],s66 offen offset:1024 sc1
buffer_load_dwordx4 v[144:147],v16,s[20:23],s66 offen offset:2048 sc1
buffer_load_dwordx4 v[148:151],v16,s[20:23],s66 offen offset:3072 sc1
s_waitcnt vmcnt(0)
kck_262:
v_min3_u32 v22,v136,v140,v144
v_min_u32 v22,v22,v148
v_cmp_eq_u32 vcc,0,v22
s_cbranch_vccz kok_261
s_sleep 1
s_sub_u32 s90,s90,1
s_cmp_gt_i32 s90,0
s_cbranch_scc1 kp_260
kok_261:
s_mov_b32 s78,0
s_add_u32 s64,s79,0
s_lshl_b32 s75,s64,21
s_lshl_b32 s64,s64,13
s_and_b32 s64,s64,0x2000
s_xor_b32 s64,s64,s61
s_add_u32 s75,s75,s64
s_add_u32 s75,s75,29360128
s_add_u32 s64,s79,0
s_lshl_b32 s76,s64,21
s_lshl_b32 s64,s64,13
s_and_b32 s64,s64,0x2000
s_xor_b32 s64,s64,s62
s_add_u32 s76,s76,s64
s_add_u32 s76,s76,29360128
s_add_u32 s77,s75,s43
s_add_u32 s75,s75,s42
s_add_u32 s76,s76,s42
s_add_u32 s65,s75,524288
buffer_load_dwordx4 a[32:35],v16,s[20:23],s65 offen offset:0 sc1
buffer_load_dwordx4 a[36:39],v16,s[20:23],s65 offen offset:1024 sc1
buffer_load_dwordx4 a[40:43],v16,s[20:23],s65 offen offset:2048 sc1
buffer_load_dwordx4 a[44:47],v16,s[20:23],s65 offen offset:3072 sc1
s_add_u32 s65,s75,528384
buffer_load_dwordx4 a[48:51],v16,s[20:23],s65 offen offset:0 sc1
buffer_load_dwordx4 a[52:55],v16,s[20:23],s65 offen offset:1024 sc1
buffer_load_dwordx4 a[56:59],v16,s[20:23],s65 offen offset:2048 sc1
buffer_load_dwordx4 a[60:63],v16,s[20:23],s65 offen offset:3072 sc1
s_add_u32 s65,s76,0
buffer_load_dwordx4 a[0:3],v16,s[20:23],s65 offen offset:0 sc1
buffer_load_dwordx4 a[4:7],v16,s[20:23],s65 offen offset:1024 sc1
buffer_load_dwordx4 a[8:11],v16,s[20:23],s65 offen offset:2048 sc1
buffer_load_dwordx4 a[12:15],v16,s[20:23],s65 offen offset:3072 sc1
s_add_u32 s65,s76,4096
buffer_load_dwordx4 a[16:19],v16,s[20:23],s65 offen offset:0 sc1
buffer_load_dwordx4 a[20:23],v16,s[20:23],s65 offen offset:1024 sc1
buffer_load_dwordx4 a[24:27],v16,s[20:23],s65 offen offset:2048 sc1
buffer_load_dwordx4 a[28:31],v16,s[20:23],s65 offen offset:3072 sc1
s_cmp_lt_u32 s79,58
s_cselect_b32 s78,s78,0
s_cmp_lg_u32 s78,0
s_cselect_b32 s66,0x7fff0000,s77
buffer_load_dwordx4 v[136:139],v16,s[20:23],s66 offen offset:0 sc1
buffer_load_dwordx4 v[140:143],v16,s[20:23],s66 offen offset:1024 sc1
buffer_load_dwordx4 v[144:147],v16,s[20:23],s66 offen offset:2048 sc1
buffer_load_dwordx4 v[148:151],v16,s[20:23],s66 offen offset:3072 sc1
s_add_u32 s65,s75,1048576
buffer_load_dwordx4 a[64:67],v16,s[20:23],s65 offen offset:0 sc1
buffer_load_dwordx4 a[68:71],v16,s[20:23],s65 offen offset:1024 sc1
buffer_load_dwordx4 a[72:75],v16,s[20:23],s65 offen offset:2048 sc1
buffer_load_dwordx4 a[76:79],v16,s[20:23],s65 offen offset:3072 sc1
s_add_u32 s65,s75,1052672
buffer_load_dwordx4 a[80:83],v16,s[20:23],s65 offen offset:0 sc1
buffer_load_dwordx4 a[84:87],v16,s[20:23],s65 offen offset:1024 sc1
buffer_load_dwordx4 a[88:91],v16,s[20:23],s65 offen offset:2048 sc1
buffer_load_dwordx4 a[92:95],v16,s[20:23],s65 offen offset:3072 sc1
s_waitcnt vmcnt(0)
aloop_263:
s_cmp_ge_u32 s79,44
s_cbranch_scc1 tk_265
tw_264:
ds_read_b32 v94,v95
s_waitcnt lgkmcnt(0)
v_readfirstlane_b32 s64,v94
s_add_u32 s64,s64,8
s_cmp_ge_u32 s64,s79
s_cbranch_scc1 tk_265
s_sleep 4
s_sub_u32 s90,s90,1
s_cmp_gt_i32 s90,0
s_cbranch_scc1 tw_264
tk_265:
s_add_u32 s64,s79,0
s_lshl_b32 s74,s64,21
s_lshl_b32 s64,s64,13
s_and_b32 s64,s64,0x2000
s_xor_b32 s64,s64,s61
s_add_u32 s74,s74,s64
s_add_u32 s74,s74,29360128
s_add_u32 s64,s79,0
s_lshl_b32 s70,s64,21
s_lshl_b32 s64,s64,13
s_and_b32 s64,s64,0x2000
s_xor_b32 s64,s64,s62
s_add_u32 s70,s70,s64
s_add_u32 s70,s70,29360128
s_waitcnt vmcnt(21)
v_mfma_f32_16x16x32_bf16 v[168:171],a[32:35],a[0:3],0
v_mfma_f32_16x16x32_bf16 v[172:175],a[36:39],a[0:3],0
v_mfma_f32_16x16x32_bf16 v[180:183],a[32:35],a[4:7],0
v_mfma_f32_16x16x32_bf16 v[184:187],a[36:39],a[4:7],0
v_mfma_f32_16x16x32_bf16 v[168:171],a[40:43],a[8:11],v[168:171]
v_mfma_f32_16x16x32_bf16 v[172:175],a[44:47],a[8:11],v[172:175]
v_mfma_f32_16x16x32_bf16 v[180:183],a[40:43],a[12:15],v[180:183]
v_mfma_f32_16x16x32_bf16 v[184:187],a[44:47],a[12:15],v[184:187]
v_mfma_f32_16x16x32_bf16 v[168:171],a[48:51],a[16:19],v[168:171]
v_mfma_f32_16x16x32_bf16 v[172:175],a[52:55],a[16:19],v[172:175]
v_mfma_f32_16x16x32_bf16 v[180:183],a[48:51],a[20:23],v[180:183]
v_mfma_f32_16x16x32_bf16 v[184:187],a[52:55],a[20:23],v[184:187]
v_mfma_f32_16x16x32_bf16 v[168:171],a[56:59],a[24:27],v[168:171]
v_mfma_f32_16x16x32_bf16 v[172:175],a[60:63],a[24:27],v[172:175]
v_mfma_f32_16x16x32_bf16 v[180:183],a[56:59],a[28:31],v[180:183]
v_mfma_f32_16x16x32_bf16 v[184:187],a[60:63],a[28:31],v[184:187]
s_nop 4
v_cndmask_b32 v168,v97,v168,s[18:19]
s_nop 0
v_cndmask_b32 v180,v97,v180,s[38:39]
v_cndmask_b32 v169,v97,v169,s[16:17]
v_cndmask_b32 v181,v97,v181,s[36:37]
v_cndmask_b32 v170,v97,v170,s[14:15]
v_cndmask_b32 v182,v97,v182,s[34:35]
v_cndmask_b32 v171,v97,v171,s[12:13]
v_cndmask_b32 v183,v97,v183,s[32:33]
v_cndmask_b32 v172,v97,v172,s[10:11]
v_cndmask_b32 v184,v97,v184,s[18:19]
v_cndmask_b32 v173,v97,v173,s[8:9]
v_cndmask_b32 v185,v97,v185,s[16:17]
v_cndmask_b32 v174,v97,v174,s[6:7]
v_cndmask_b32 v186,v97,v186,s[14:15]
v_cndmask_b32 v175,v97,v175,s[4:5]
v_cndmask_b32 v187,v97,v187,s[12:13]
v_max3_f32 v116,v168,v169,v170
v_max3_f32 v122,v180,v181,v182
v_max3_f32 v118,v171,v172,v173
v_max3_f32 v124,v183,v184,v185
v_max3_f32 v116,v116,v174,v175
v_max3_f32 v122,v122,v186,v187
v_max_f32 v116,v116,v118
v_max_f32 v122,v122,v124
v_mov_b32 v118,v116
v_mov_b32 v124,v122
s_nop 0
v_permlane16_swap_b32 v118,v116
v_permlane16_swap_b32 v124,v122
v_max_f32 v116,v116,v118
v_max_f32 v122,v122,v124
v_mov_b32 v118,v116
v_mov_b32 v124,v122
s_nop 0
v_permlane32_swap_b32 v118,v116
v_permlane32_swap_b32 v124,v122
v_max_f32 v116,v116,v118
v_max_f32 v122,v122,v124
v_mul_f32 v116,s80,v116
v_mul_f32 v122,s80,v122
v_fma_f32 v168,v168,s80,-v116
v_fma_f32 v180,v180,s80,-v122
v_fma_f32 v169,v169,s80,-v116
v_fma_f32 v181,v181,s80,-v122
v_fma_f32 v170,v170,s80,-v116
v_fma_f32 v182,v182,s80,-v122
v_fma_f32 v171,v171,s80,-v116
v_fma_f32 v183,v183,s80,-v122
v_fma_f32 v172,v172,s80,-v116
v_fma_f32 v184,v184,s80,-v122
v_fma_f32 v173,v173,s80,-v116
v_fma_f32 v185,v185,s80,-v122
v_fma_f32 v174,v174,s80,-v116
v_fma_f32 v186,v186,s80,-v122
v_fma_f32 v175,v175,s80,-v116
v_fma_f32 v187,v187,s80,-v122
v_exp_f32 v168,v168
v_exp_f32 v180,v180
v_exp_f32 v169,v169
v_exp_f32 v181,v181
v_exp_f32 v170,v170
v_exp_f32 v182,v182
v_exp_f32 v171,v171
v_exp_f32 v183,v183
v_exp_f32 v172,v172
v_exp_f32 v184,v184
v_exp_f32 v173,v173
v_exp_f32 v185,v185
v_exp_f32 v174,v174
v_exp_f32 v186,v186
v_exp_f32 v175,v175
v_exp_f32 v187,v187
v_add_f32 v117,v168,v169
v_add_f32 v123,v180,v181
v_add_f32 v119,v170,v171
v_add_f32 v125,v182,v183
v_add_f32 v117,v117,v172
v_add_f32 v123,v123,v184
v_add_f32 v119,v119,v173
v_add_f32 v125,v125,v185
v_add_f32 v117,v117,v174
v_add_f32 v123,v123,v186
v_add_f32 v119,v119,v175
v_add_f32 v125,v125,v187
v_add_f32 v117,v117,v119
v_add_f32 v123,v123,v125
v_mov_b32 v118,v117
v_mov_b32 v124,v123
s_nop 0
v_permlane16_swap_b32 v118,v117
v_permlane16_swap_b32 v124,v123
v_add_f32 v117,v117,v118
v_add_f32 v123,v123,v124
v_mov_b32 v118,v117
v_mov_b32 v124,v123
s_nop 0
v_permlane32_swap_b32 v118,v117
v_permlane32_swap_b32 v124,v123
v_add_f32 v117,v117,v118
v_add_f32 v123,v123,v124
s_cmp_gt_u32 s71,55
s_cselect_b32 s65,0x7fff0000,s73
s_waitcnt vmcnt(12)
v_add_u32 v22,s71,-1
buffer_store_dword v22,v23,s[20:23],s65 offen sc1
s_add_u32 s66,s74,s43
s_cmp_eq_u32 s78,0
s_cbranch_scc1 kx_269
s_cmp_eq_u32 s84,0
s_cselect_b32 s64,3,0
s_add_u32 s64,s64,s78
kbo_271:
s_sleep 2
s_sub_u32 s64,s64,1
s_cmp_gt_i32 s64,0
s_cbranch_scc1 kbo_271
s_cmp_lt_u32 s84,3
s_cselect_b32 s64,1,0
s_cmp_ge_u32 s84,4
s_subb_u32 s78,s78,2
s_add_u32 s84,s84,1
kpr_270:
s_mov_b64 exec,15
buffer_load_dword v22,v96,s[20:23],s66 offen sc1
s_waitcnt vmcnt(0)
v_cmp_eq_u32 vcc,0,v22
s_mov_b64 exec,-1
s_cbranch_vccz kp_266
s_add_u32 s78,s78,s64
s_mov_b32 s64,1
s_mov_b32 s84,0
s_sleep 1
s_sub_u32 s90,s90,1
s_cmp_gt_i32 s90,0
s_cbranch_scc1 kpr_270
s_branch kp_266
kx_269:
s_mov_b32 s84,0
s_waitcnt vmcnt(9)
s_branch kck_268
kp_266:
s_add_u32 s78,s78,2
buffer_load_dwordx4 v[136:139],v16,s[20:23],s66 offen offset:0 sc1
buffer_load_dwordx4 v[140:143],v16,s[20:23],s66 offen offset:1024 sc1
buffer_load_dwordx4 v[144:147],v16,s[20:23],s66 offen offset:2048 sc1
buffer_load_dwordx4 v[148:151],v16,s[20:23],s66 offen offset:3072 sc1
s_waitcnt vmcnt(0)
kck_268:
v_min3_u32 v22,v136,v140,v144
v_min_u32 v22,v22,v148
v_cmp_eq_u32 vcc,0,v22
s_cbranch_vccz kok_267
s_sleep 1
s_sub_u32 s90,s90,1
s_cmp_gt_i32 s90,0
s_cbranch_scc1 kp_266
kok_267:
s_min_u32 s78,s78,40
buffer_load_dwordx2 v[100:101],v6,s[20:23],s66 offen offset:0 sc1
buffer_load_dwordx2 v[102:103],v6,s[20:23],s66 offen offset:512 sc1
buffer_load_dwordx2 v[104:105],v6,s[20:23],s66 offen offset:1024 sc1
buffer_load_dwordx2 v[106:107],v6,s[20:23],s66 offen offset:1536 sc1
buffer_load_dwordx2 v[108:109],v6,s[20:23],s66 offen offset:2048 sc1
buffer_load_dwordx2 v[110:111],v6,s[20:23],s66 offen offset:2560 sc1
buffer_load_dwordx2 v[112:113],v6,s[20:23],s66 offen offset:3072 sc1
buffer_load_dwordx2 v[114:115],v6,s[20:23],s66 offen offset:3584 sc1
v_mfma_f32_16x16x32_bf16 v[176:179],v[136:139],a[0:3],0
v_mfma_f32_16x16x32_bf16 v[188:191],v[136:139],a[4:7],0
v_mfma_f32_16x16x32_bf16 v[176:179],v[140:143],a[8:11],v[176:179]
v_mfma_f32_16x16x32_bf16 v[188:191],v[140:143],a[12:15],v[188:191]
v_mfma_f32_16x16x32_bf16 v[176:179],v[144:147],a[16:19],v[176:179]
v_mfma_f32_16x16x32_bf16 v[188:191],v[144:147],a[20:23],v[188:191]
v_mfma_f32_16x16x32_bf16 v[176:179],v[148:151],a[24:27],v[176:179]
v_mfma_f32_16x16x32_bf16 v[188:191],v[148:151],a[28:31],v[188:191]
s_cmp_lg_u32 s79,55
s_cbranch_scc1 q2nd_272
pl_273:
buffer_load_dword v98,v99,s[20:23],s87 offen sc1
s_waitcnt vmcnt(0)
v_cmp_gt_u32 vcc,18,v98
s_cbranch_vccz pok_274
s_sleep 1
s_sub_u32 s90,s90,1
s_cmp_gt_i32 s90,0
s_cbranch_scc1 pl_273
pok_274:
q2nd_272:
s_add_u32 s64,s79,1
s_lshl_b32 s75,s64,21
s_lshl_b32 s64,s64,13
s_and_b32 s64,s64,0x2000
s_xor_b32 s64,s64,s61
s_add_u32 s75,s75,s64
s_add_u32 s75,s75,29360128
s_add_u32 s64,s79,1
s_lshl_b32 s76,s64,21
s_lshl_b32 s64,s64,13
s_and_b32 s64,s64,0x2000
s_xor_b32 s64,s64,s62
s_add_u32 s76,s76,s64
s_add_u32 s76,s76,29360128
s_add_u32 s77,s75,s43
s_add_u32 s75,s75,s42
s_add_u32 s76,s76,s42
s_cmp_lt_u32 s79,63
s_cselect_b32 s75,s75,0x7fff0000
s_cselect_b32 s76,s76,0x7fff0000
s_cselect_b32 s77,s77,0x7fff0000
s_add_u32 s65,s75,524288
buffer_load_dwordx4 a[32:35],v16,s[20:23],s65 offen offset:0 sc1
buffer_load_dwordx4 a[36:39],v16,s[20:23],s65 offen offset:1024 sc1
buffer_load_dwordx4 a[40:43],v16,s[20:23],s65 offen offset:2048 sc1
buffer_load_dwordx4 a[44:47],v16,s[20:23],s65 offen offset:3072 sc1
s_add_u32 s65,s75,528384
buffer_load_dwordx4 a[48:51],v16,s[20:23],s65 offen offset:0 sc1
buffer_load_dwordx4 a[52:55],v16,s[20:23],s65 offen offset:1024 sc1
buffer_load_dwordx4 a[56:59],v16,s[20:23],s65 offen offset:2048 sc1
buffer_load_dwordx4 a[60:63],v16,s[20:23],s65 offen offset:3072 sc1
s_add_u32 s65,s76,0
buffer_load_dwordx4 a[0:3],v16,s[20:23],s65 offen offset:0 sc1
buffer_load_dwordx4 a[4:7],v16,s[20:23],s65 offen offset:1024 sc1
buffer_load_dwordx4 a[8:11],v16,s[20:23],s65 offen offset:2048 sc1
buffer_load_dwordx4 a[12:15],v16,s[20:23],s65 offen offset:3072 sc1
s_add_u32 s65,s76,4096
buffer_load_dwordx4 a[16:19],v16,s[20:23],s65 offen offset:0 sc1
buffer_load_dwordx4 a[20:23],v16,s[20:23],s65 offen offset:1024 sc1
buffer_load_dwordx4 a[24:27],v16,s[20:23],s65 offen offset:2048 sc1
buffer_load_dwordx4 a[28:31],v16,s[20:23],s65 offen offset:3072 sc1
v_cndmask_b32 v176,v97,v176,s[48:49]
v_cndmask_b32 v188,v97,v188,s[48:49]
v_cndmask_b32 v177,v97,v177,s[48:49]
v_cndmask_b32 v189,v97,v189,s[48:49]
v_cndmask_b32 v178,v97,v178,s[48:49]
v_cndmask_b32 v190,v97,v190,s[48:49]
v_cndmask_b32 v179,v97,v179,s[48:49]
v_cndmask_b32 v191,v97,v191,s[48:49]
v_max3_f32 v119,v176,v177,v178
v_max3_f32 v125,v188,v189,v190
v_max_f32 v119,v119,v179
v_max_f32 v125,v125,v191
v_mov_b32 v118,v119
v_mov_b32 v124,v125
s_nop 0
v_permlane16_swap_b32 v118,v119
v_permlane16_swap_b32 v124,v125
v_max_f32 v119,v119,v118
v_max_f32 v125,v125,v124
v_mov_b32 v118,v119
v_mov_b32 v124,v125
s_nop 0
v_permlane32_swap_b32 v118,v119
v_permlane32_swap_b32 v124,v125
v_max_f32 v119,v119,v118
v_max_f32 v125,v125,v124
v_mul_f32 v119,s80,v119
v_mul_f32 v125,s80,v125
v_max_f32 v119,v119,v116
v_max_f32 v125,v125,v122
v_fma_f32 v176,v176,s80,-v119
v_fma_f32 v188,v188,s80,-v125
v_fma_f32 v177,v177,s80,-v119
v_fma_f32 v189,v189,s80,-v125
v_fma_f32 v178,v178,s80,-v119
v_fma_f32 v190,v190,s80,-v125
v_fma_f32 v179,v179,s80,-v119
v_fma_f32 v191,v191,s80,-v125
v_sub_f32 v116,v116,v119
v_sub_f32 v122,v122,v125
v_exp_f32 v176,v176
v_exp_f32 v188,v188
v_exp_f32 v177,v177
v_exp_f32 v189,v189
v_exp_f32 v178,v178
v_exp_f32 v190,v190
v_exp_f32 v179,v179
v_exp_f32 v191,v191
v_exp_f32 v116,v116
v_exp_f32 v122,v122
v_add_f32 v120,v176,v177
v_add_f32 v126,v188,v189
v_add_f32 v121,v178,v179
v_add_f32 v127,v190,v191
v_add_f32 v120,v120,v121
v_add_f32 v126,v126,v127
v_mov_b32 v118,v120
v_mov_b32 v124,v126
s_nop 0
v_permlane16_swap_b32 v118,v120
v_permlane16_swap_b32 v124,v126
v_add_f32 v120,v120,v118
v_add_f32 v126,v126,v124
v_mov_b32 v118,v120
v_mov_b32 v124,v126
s_nop 0
v_permlane32_swap_b32 v118,v120
v_permlane32_swap_b32 v124,v126
v_add_f32 v120,v120,v118
v_add_f32 v126,v126,v124
v_fmac_f32 v120,v117,v116
v_fmac_f32 v126,v123,v122
v_rcp_f32 v121,v120
v_rcp_f32 v127,v126
v_mul_f32 v119,v116,v121
v_mul_f32 v125,v122,v127
v_pk_mul_f32 v[168:169],v[168:169],v[118:119] op_sel:[0,1] op_sel_hi:[1,1]
v_pk_mul_f32 v[180:181],v[180:181],v[124:125] op_sel:[0,1] op_sel_hi:[1,1]
v_pk_mul_f32 v[170:171],v[170:171],v[118:119] op_sel:[0,1] op_sel_hi:[1,1]
v_pk_mul_f32 v[182:183],v[182:183],v[124:125] op_sel:[0,1] op_sel_hi:[1,1]
v_pk_mul_f32 v[172:173],v[172:173],v[118:119] op_sel:[0,1] op_sel_hi:[1,1]
v_pk_mul_f32 v[184:185],v[184:185],v[124:125] op_sel:[0,1] op_sel_hi:[1,1]
v_pk_mul_f32 v[174:175],v[174:175],v[118:119] op_sel:[0,1] op_sel_hi:[1,1]
v_pk_mul_f32 v[186:187],v[186:187],v[124:125] op_sel:[0,1] op_sel_hi:[1,1]
v_cvt_pk_bf16_f32 v48,v168,v169
v_cvt_pk_bf16_f32 v56,v180,v181
v_cvt_pk_bf16_f32 v49,v170,v171
v_cvt_pk_bf16_f32 v57,v182,v183
v_cvt_pk_bf16_f32 v50,v172,v173
v_cvt_pk_bf16_f32 v58,v184,v185
v_cvt_pk_bf16_f32 v51,v174,v175
v_cvt_pk_bf16_f32 v59,v186,v187
v_pk_mul_f32 v[176:177],v[176:177],v[120:121] op_sel:[0,1] op_sel_hi:[1,1]
v_pk_mul_f32 v[188:189],v[188:189],v[126:127] op_sel:[0,1] op_sel_hi:[1,1]
v_pk_mul_f32 v[178:179],v[178:179],v[120:121] op_sel:[0,1] op_sel_hi:[1,1]
v_pk_mul_f32 v[190:191],v[190:191],v[126:127] op_sel:[0,1] op_sel_hi:[1,1]
v_cvt_pk_bf16_f32 v52,v176,v177
v_cvt_pk_bf16_f32 v60,v188,v189
v_cvt_pk_bf16_f32 v53,v178,v179
v_cvt_pk_bf16_f32 v61,v190,v191
s_add_u32 s70,s70,s42
s_waitcnt vmcnt(24)
v_mfma_f32_16x16x32_bf16 v[192:195],a[64:67],v[48:51],0
v_mfma_f32_16x16x32_bf16 v[196:199],a[64:67],v[56:59],0
v_mfma_f32_16x16x32_bf16 v[200:203],a[68:71],v[48:51],0
v_mfma_f32_16x16x32_bf16 v[204:207],a[68:71],v[56:59],0
v_mfma_f32_16x16x32_bf16 v[208:211],a[72:75],v[48:51],0
v_mfma_f32_16x16x32_bf16 v[212:215],a[72:75],v[56:59],0
v_mfma_f32_16x16x32_bf16 v[216:219],a[76:79],v[48:51],0
v_mfma_f32_16x16x32_bf16 v[220:223],a[76:79],v[56:59],0
s_waitcnt vmcnt(16)
v_mfma_f32_16x16x16_bf16 v[192:195],v[100:101],v[52:53],v[192:195]
v_mfma_f32_16x16x16_bf16 v[196:199],v[100:101],v[60:61],v[196:199]
v_mfma_f32_16x16x16_bf16 v[200:203],v[102:103],v[52:53],v[200:203]
v_mfma_f32_16x16x16_bf16 v[204:207],v[102:103],v[60:61],v[204:207]
v_mfma_f32_16x16x32_bf16 v[224:227],a[80:83],v[48:51],0
v_mfma_f32_16x16x32_bf16 v[228:231],a[80:83],v[56:59],0
v_mfma_f32_16x16x32_bf16 v[232:235],a[84:87],v[48:51],0
v_mfma_f32_16x16x32_bf16 v[236:239],a[84:87],v[56:59],0
v_mfma_f32_16x16x16_bf16 v[208:211],v[104:105],v[52:53],v[208:211]
s_add_u32 s65,s70,524288
v_mfma_f32_16x16x16_bf16 v[212:215],v[104:105],v[60:61],v[212:215]
v_cvt_pk_bf16_f32 v64,v192,v193
v_cvt_pk_bf16_f32 v65,v194,v195
v_mfma_f32_16x16x16_bf16 v[216:219],v[106:107],v[52:53],v[216:219]
v_cvt_pk_bf16_f32 v66,v200,v201
v_mfma_f32_16x16x16_bf16 v[220:223],v[106:107],v[60:61],v[220:223]
v_cvt_pk_bf16_f32 v67,v202,v203
v_max_u32 v64,1,v64
v_mfma_f32_16x16x32_bf16 v[240:243],a[88:91],v[48:51],0
buffer_store_dwordx4 v[64:67],v16,s[20:23],s65 offen offset:0 sc1
v_cvt_pk_bf16_f32 v68,v196,v197
v_mfma_f32_16x16x32_bf16 v[244:247],a[88:91],v[56:59],0
v_cvt_pk_bf16_f32 v69,v198,v199
v_mfma_f32_16x16x32_bf16 v[248:251],a[92:95],v[48:51],0
v_cvt_pk_bf16_f32 v70,v204,v205
v_cvt_pk_bf16_f32 v71,v206,v207
v_mfma_f32_16x16x32_bf16 v[252:255],a[92:95],v[56:59],0
v_max_u32 v68,1,v68
buffer_store_dwordx4 v[68:71],v16,s[20:23],s65 offen offset:1024 sc1
v_mfma_f32_16x16x16_bf16 v[224:227],v[108:109],v[52:53],v[224:227]
v_cvt_pk_bf16_f32 v72,v208,v209
v_mfma_f32_16x16x16_bf16 v[228:231],v[108:109],v[60:61],v[228:231]
v_cvt_pk_bf16_f32 v73,v210,v211
v_cvt_pk_bf16_f32 v74,v216,v217
v_mfma_f32_16x16x16_bf16 v[232:235],v[110:111],v[52:53],v[232:235]
v_cvt_pk_bf16_f32 v75,v218,v219
v_mfma_f32_16x16x16_bf16 v[236:239],v[110:111],v[60:61],v[236:239]
v_max_u32 v72,1,v72
buffer_store_dwordx4 v[72:75],v16,s[20:23],s65 offen offset:2048 sc1
v_mfma_f32_16x16x16_bf16 v[240:243],v[112:113],v[52:53],v[240:243]
v_cvt_pk_bf16_f32 v76,v212,v213
v_mfma_f32_16x16x16_bf16 v[244:247],v[112:113],v[60:61],v[244:247]
v_cvt_pk_bf16_f32 v77,v214,v215
v_cvt_pk_bf16_f32 v78,v220,v221
v_mfma_f32_16x16x16_bf16 v[248:251],v[114:115],v[52:53],v[248:251]
v_cvt_pk_bf16_f32 v79,v222,v223
v_mfma_f32_16x16x16_bf16 v[252:255],v[114:115],v[60:61],v[252:255]
v_max_u32 v76,1,v76
buffer_store_dwordx4 v[76:79],v16,s[20:23],s65 offen offset:3072 sc1
s_cmp_gt_u32 s71,54
s_cselect_b32 s64,s73,0x7fff0000
v_mov_b32 v22,s71
buffer_store_dword v22,v23,s[20:23],s64 offen sc1
s_add_u32 s65,s70,528384
v_cvt_pk_bf16_f32 v64,v224,v225
v_cvt_pk_bf16_f32 v65,v226,v227
v_cvt_pk_bf16_f32 v66,v232,v233
v_cvt_pk_bf16_f32 v67,v234,v235
v_max_u32 v64,1,v64
buffer_store_dwordx4 v[64:67],v16,s[20:23],s65 offen offset:0 sc1
v_cvt_pk_bf16_f32 v68,v228,v229
v_cvt_pk_bf16_f32 v69,v230,v231
v_cvt_pk_bf16_f32 v70,v236,v237
v_cvt_pk_bf16_f32 v71,v238,v239
v_max_u32 v68,1,v68
buffer_store_dwordx4 v[68:71],v16,s[20:23],s65 offen offset:1024 sc1
v_cvt_pk_bf16_f32 v72,v240,v241
v_cvt_pk_bf16_f32 v73,v242,v243
v_cvt_pk_bf16_f32 v74,v248,v249
v_cvt_pk_bf16_f32 v75,v250,v251
v_max_u32 v72,1,v72
buffer_store_dwordx4 v[72:75],v16,s[20:23],s65 offen offset:2048 sc1
v_cvt_pk_bf16_f32 v76,v244,v245
v_cvt_pk_bf16_f32 v77,v246,v247
v_cvt_pk_bf16_f32 v78,v252,v253
v_cvt_pk_bf16_f32 v79,v254,v255
v_max_u32 v76,1,v76
buffer_store_dwordx4 v[76:79],v16,s[20:23],s65 offen offset:3072 sc1
s_cmp_lt_u32 s79,58
s_cselect_b32 s78,s78,0
s_cmp_lg_u32 s78,0
s_cselect_b32 s66,0x7fff0000,s77
buffer_load_dwordx4 v[136:139],v16,s[20:23],s66 offen offset:0 sc1
buffer_load_dwordx4 v[140:143],v16,s[20:23],s66 offen offset:1024 sc1
buffer_load_dwordx4 v[144:147],v16,s[20:23],s66 offen offset:2048 sc1
buffer_load_dwordx4 v[148:151],v16,s[20:23],s66 offen offset:3072 sc1
s_add_u32 s65,s75,1048576
buffer_load_dwordx4 a[64:67],v16,s[20:23],s65 offen offset:0 sc1
buffer_load_dwordx4 a[68:71],v16,s[20:23],s65 offen offset:1024 sc1
buffer_load_dwordx4 a[72:75],v16,s[20:23],s65 offen offset:2048 sc1
buffer_load_dwordx4 a[76:79],v16,s[20:23],s65 offen offset:3072 sc1
s_add_u32 s65,s75,1052672
buffer_load_dwordx4 a[80:83],v16,s[20:23],s65 offen offset:0 sc1
buffer_load_dwordx4 a[84:87],v16,s[20:23],s65 offen offset:1024 sc1
buffer_load_dwordx4 a[88:91],v16,s[20:23],s65 offen offset:2048 sc1
buffer_load_dwordx4 a[92:95],v16,s[20:23],s65 offen offset:3072 sc1
s_add_u32 s79,s79,1
s_add_u32 s71,s71,1
s_cmp_lt_u32 s79,64
s_cbranch_scc1 aloop_263
s_endpgm
r_ln_218:
v_and_b32 v21,1,v1
v_mul_u32_u24 v21,960,v21
s_mov_b32 s65,21052032
s_mov_b32 s66,1792
pl_275:
buffer_load_dword v22,v21,s[20:23],s65 offen sc1
s_waitcnt vmcnt(0)
v_cmp_gt_u32 vcc,s66,v22
s_cbranch_vccz pok_276
s_sleep 1
s_sub_u32 s90,s90,1
s_cmp_gt_i32 s90,0
s_cbranch_scc1 pl_275
pok_276:
s_lshl_b32 s41,s59,1
s_add_u32 s41,s41,s50
s_sub_u32 s41,s41,2
v_lshlrev_b32 v5,5,v1
s_mov_b32 s64,16384
buffer_load_dwordx4 v[40:43],v5,s[20:23],s64 offen offset:0 sc1
buffer_load_dwordx4 v[44:47],v5,s[20:23],s64 offen offset:16 sc1
buffer_load_dwordx4 v[48:51],v5,s[20:23],s64 offen offset:2048 sc1
buffer_load_dwordx4 v[52:55],v5,s[20:23],s64 offen offset:2064 sc1
s_mov_b32 s64,12288
buffer_load_dwordx4 v[56:59],v5,s[20:23],s64 offen offset:0 sc1
buffer_load_dwordx4 v[60:63],v5,s[20:23],s64 offen offset:16 sc1
buffer_load_dwordx4 v[64:67],v5,s[20:23],s64 offen offset:2048 sc1
buffer_load_dwordx4 v[68:71],v5,s[20:23],s64 offen offset:2064 sc1
s_lshr_b32 s64,s41,2
s_add_u32 s64,s64,64
s_lshl_b32 s64,s64,14
s_and_b32 s65,s41,3
s_lshl_b32 s65,s65,11
s_add_u32 s64,s64,s65
v_add_u32 v19,s64,v16
v_add_u32 v19,786432,v19
s_lshl_b32 s65,s41,7
v_add_u32 v5,s65,v16
v_and_b32 v5,2047,v5
v_add_u32 v17,s64,v5
v_xor_b32 v18,1024,v17
v_add_u32 v24,0xfff00000,v17
v_xor_b32 v25,1024,v24
v_lshlrev_b32 v21,2,v1
s_and_b32 s64,s41,4
s_lshl_b32 s64,s64,6
s_add_u32 s74,s63,s64
s_add_u32 s74,s74,2048
s_mov_b32 s83,1
s_lshl_b32 s73,s41,2
s_add_u32 s73,s73,s63
s_add_u32 s73,s73,2560
v_mov_b32 v8,1
v_mov_b32 v9,1
v_mov_b32 v10,1
v_mov_b32 v11,1
s_add_u32 s64,s62,27262976
s_xor_b32 s65,s62,0x2000
s_add_u32 s65,s65,163577856
buffer_store_dwordx4 v[8:11],v24,s[20:23],s64 offen sc1
buffer_store_dwordx4 v[8:11],v25,s[20:23],s64 offen sc1
buffer_store_dwordx4 v[8:11],v24,s[20:23],s65 offen sc1
buffer_store_dwordx4 v[8:11],v25,s[20:23],s65 offen sc1
s_mov_b32 s82,0x3a800000
s_waitcnt vmcnt(0)
v_add_f32 v40,1.0,v40
v_add_f32 v41,1.0,v41
v_add_f32 v42,1.0,v42
v_add_f32 v43,1.0,v43
v_add_f32 v44,1.0,v44
v_add_f32 v45,1.0,v45
v_add_f32 v46,1.0,v46
v_add_f32 v47,1.0,v47
v_add_f32 v48,1.0,v48
v_add_f32 v49,1.0,v49
v_add_f32 v50,1.0,v50
v_add_f32 v51,1.0,v51
v_add_f32 v52,1.0,v52
v_add_f32 v53,1.0,v53
v_add_f32 v54,1.0,v54
v_add_f32 v55,1.0,v55
s_lshl_b32 s64,s50,2
s_add_u32 s64,s64,147448
v_mov_b32 v7,s64
s_add_u32 s64,s79,0
s_lshl_b32 s70,s64,21
s_lshl_b32 s64,s64,13
s_and_b32 s64,s64,0x2000
s_xor_b32 s64,s64,s62
s_add_u32 s70,s70,s64
s_add_u32 s70,s70,29360128
lloop_277:
s_add_u32 s75,s70,2097152
s_xor_b32 s75,s75,0x2000
s_add_u32 s96,s71,1
s_cmp_eq_u32 s83,0
s_cbranch_scc1 lahead_280
s_cmp_gt_u32 s71,40
s_cbranch_scc1 xp_278
pl_282:
buffer_load_dword v29,v21,s[20:23],s74 offen sc1
s_waitcnt vmcnt(0)
v_cmp_gt_u32 vcc,s71,v29
s_cbranch_vccz pok_283
s_sleep 1
s_sub_u32 s90,s90,1
s_cmp_gt_i32 s90,0
s_cbranch_scc1 pl_282
pok_283:
xp_278:
buffer_load_dwordx4 v[8:11],v17,s[20:23],s70 offen sc1
buffer_load_dwordx4 v[12:15],v18,s[20:23],s70 offen sc1
s_waitcnt vmcnt(0)
v_min3_u32 v22,v8,v10,v12
v_min_u32 v22,v22,v14
v_cmp_eq_u32 vcc,0,v22
s_cbranch_vccz xk_279
s_sleep 1
s_sub_u32 s90,s90,1
s_cmp_gt_i32 s90,0
s_cbranch_scc1 xp_278
s_branch xk_279
lahead_280:
s_waitcnt vmcnt(6)
v_mov_b32 v8,v104
v_mov_b32 v9,v105
v_mov_b32 v10,v106
v_mov_b32 v11,v107
v_mov_b32 v12,v108
v_mov_b32 v13,v109
v_mov_b32 v14,v110
v_mov_b32 v15,v111
v_min3_u32 v22,v8,v10,v12
v_min_u32 v22,v22,v14
v_cmp_eq_u32 vcc,0,v22
s_cbranch_vccnz xp_278
xk_279:
v_cmp_gt_u32 vcc,s96,v29
s_or_b32 s83,vcc_lo,vcc_hi
s_cselect_b32 s76,0x7fff0000,s75
buffer_load_dwordx4 v[104:107],v17,s[20:23],s76 offen sc1
buffer_load_dwordx4 v[108:111],v18,s[20:23],s76 offen sc1
buffer_load_dword v29,v21,s[20:23],s74 offen sc1
v_lshlrev_b32 v80,16,v8
v_and_b32 v81,s80,v8
v_lshlrev_b32 v82,16,v9
v_and_b32 v83,s80,v9
v_lshlrev_b32 v84,16,v10
v_and_b32 v85,s80,v10
v_lshlrev_b32 v86,16,v11
v_and_b32 v87,s80,v11
v_lshlrev_b32 v88,16,v12
v_and_b32 v89,s80,v12
v_lshlrev_b32 v90,16,v13
v_and_b32 v91,s80,v13
v_lshlrev_b32 v92,16,v14
v_and_b32 v93,s80,v14
v_lshlrev_b32 v94,16,v15
v_and_b32 v95,s80,v15
v_pk_add_f32 v[96:97],v[80:81],v[82:83]
v_pk_mul_f32 v[100:101],v[80:81],v[80:81]
v_pk_add_f32 v[98:99],v[88:89],v[90:91]
v_pk_mul_f32 v[102:103],v[88:89],v[88:89]
v_pk_fma_f32 v[100:101],v[82:83],v[82:83],v[100:101]
v_pk_fma_f32 v[102:103],v[90:91],v[90:91],v[102:103]
v_pk_add_f32 v[96:97],v[96:97],v[84:85]
v_pk_fma_f32 v[100:101],v[84:85],v[84:85],v[100:101]
v_pk_add_f32 v[98:99],v[98:99],v[92:93]
v_pk_fma_f32 v[102:103],v[92:93],v[92:93],v[102:103]
v_pk_add_f32 v[96:97],v[96:97],v[86:87]
v_pk_fma_f32 v[100:101],v[86:87],v[86:87],v[100:101]
v_pk_add_f32 v[98:99],v[98:99],v[94:95]
v_pk_fma_f32 v[102:103],v[94:95],v[94:95],v[102:103]
v_pk_add_f32 v[96:97],v[96:97],v[98:99]
v_pk_add_f32 v[100:101],v[100:101],v[102:103]
v_add_f32 v96,v96,v97
v_add_f32 v97,v100,v101
s_nop 0
v_add_f32_dpp v96,v96,v96 quad_perm:[1,0,3,2] row_mask:0xf bank_mask:0xf
v_add_f32_dpp v97,v97,v97 quad_perm:[1,0,3,2] row_mask:0xf bank_mask:0xf
s_nop 0
v_add_f32_dpp v96,v96,v96 quad_perm:[2,3,0,1] row_mask:0xf bank_mask:0xf
v_add_f32_dpp v97,v97,v97 quad_perm:[2,3,0,1] row_mask:0xf bank_mask:0xf
s_nop 0
v_add_f32_dpp v96,v96,v96 row_half_mirror row_mask:0xf bank_mask:0xf
v_add_f32_dpp v97,v97,v97 row_half_mirror row_mask:0xf bank_mask:0xf
s_nop 0
v_add_f32_dpp v96,v96,v96 row_mirror row_mask:0xf bank_mask:0xf
v_add_f32_dpp v97,v97,v97 row_mirror row_mask:0xf bank_mask:0xf
v_mov_b32 v98,v96
v_mov_b32 v99,v97
s_nop 0
v_permlane16_swap_b32 v98,v96
v_permlane16_swap_b32 v99,v97
v_pk_add_f32 v[96:97],v[96:97],v[98:99]
v_mov_b32 v98,v96
v_mov_b32 v99,v97
s_nop 0
v_permlane32_swap_b32 v98,v96
v_permlane32_swap_b32 v99,v97
v_pk_add_f32 v[96:97],v[96:97],v[98:99]
v_mul_f32 v96,0xba800000,v96
v_mul_f32 v98,v96,v96
v_fma_f32 v98,v97,s82,-v98
v_max_f32 v98,0,v98
v_add_f32 v98,0x3727c5ac,v98
v_rsq_f32 v98,v98
s_nop 0
v_mul_f32 v96,v96,v98
v_pk_fma_f32 v[80:81],v[80:81],v[98:99],v[96:97] op_sel_hi:[1,0,0]
v_pk_fma_f32 v[82:83],v[82:83],v[98:99],v[96:97] op_sel_hi:[1,0,0]
v_pk_fma_f32 v[84:85],v[84:85],v[98:99],v[96:97] op_sel_hi:[1,0,0]
v_pk_fma_f32 v[86:87],v[86:87],v[98:99],v[96:97] op_sel_hi:[1,0,0]
v_pk_fma_f32 v[88:89],v[88:89],v[98:99],v[96:97] op_sel_hi:[1,0,0]
v_pk_fma_f32 v[90:91],v[90:91],v[98:99],v[96:97] op_sel_hi:[1,0,0]
v_pk_fma_f32 v[92:93],v[92:93],v[98:99],v[96:97] op_sel_hi:[1,0,0]
v_pk_fma_f32 v[94:95],v[94:95],v[98:99],v[96:97] op_sel_hi:[1,0,0]
v_pk_fma_f32 v[80:81],v[80:81],v[40:41],v[56:57]
v_pk_fma_f32 v[82:83],v[82:83],v[42:43],v[58:59]
v_pk_fma_f32 v[84:85],v[84:85],v[44:45],v[60:61]
v_pk_fma_f32 v[86:87],v[86:87],v[46:47],v[62:63]
v_pk_fma_f32 v[88:89],v[88:89],v[48:49],v[64:65]
v_pk_fma_f32 v[90:91],v[90:91],v[50:51],v[66:67]
v_pk_fma_f32 v[92:93],v[92:93],v[52:53],v[68:69]
v_pk_fma_f32 v[94:95],v[94:95],v[54:55],v[70:71]
v_cvt_pk_bf16_f32 v8,v80,v81
v_cvt_pk_bf16_f32 v9,v82,v83
v_cvt_pk_bf16_f32 v10,v84,v85
v_cvt_pk_bf16_f32 v11,v86,v87
v_cvt_pk_bf16_f32 v12,v88,v89
v_cvt_pk_bf16_f32 v13,v90,v91
v_cvt_pk_bf16_f32 v14,v92,v93
v_cvt_pk_bf16_f32 v15,v94,v95
v_max_u32 v8,1,v8
v_max_u32 v10,1,v10
v_max_u32 v12,1,v12
v_max_u32 v14,1,v14
s_xor_b32 s78,s70,0x2000
s_waitcnt vmcnt(3)
v_add_u32 v22,s71,-1
buffer_store_dword v22,v23,s[24:27],s73 offen
buffer_store_dword v22,v23,s[28:31],s73 offen sc1
buffer_store_dwordx4 v[8:11],v24,s[20:23],s78 offen sc1
buffer_store_dwordx4 v[12:15],v25,s[20:23],s78 offen sc1
v_lshlrev_b32 v80,16,v8
v_and_b32 v81,s80,v8
v_lshlrev_b32 v82,16,v9
v_and_b32 v83,s80,v9
v_lshlrev_b32 v84,16,v10
v_and_b32 v85,s80,v10
v_lshlrev_b32 v86,16,v11
v_and_b32 v87,s80,v11
v_lshlrev_b32 v88,16,v12
v_and_b32 v89,s80,v12
v_lshlrev_b32 v90,16,v13
v_and_b32 v91,s80,v13
v_lshlrev_b32 v92,16,v14
v_and_b32 v93,s80,v14
v_lshlrev_b32 v94,16,v15
v_and_b32 v95,s80,v15
v_pk_add_f32 v[96:97],v[80:81],v[82:83]
v_pk_mul_f32 v[100:101],v[80:81],v[80:81]
v_pk_add_f32 v[98:99],v[88:89],v[90:91]
v_pk_mul_f32 v[102:103],v[88:89],v[88:89]
v_pk_fma_f32 v[100:101],v[82:83],v[82:83],v[100:101]
v_pk_fma_f32 v[102:103],v[90:91],v[90:91],v[102:103]
v_pk_add_f32 v[96:97],v[96:97],v[84:85]
v_pk_fma_f32 v[100:101],v[84:85],v[84:85],v[100:101]
v_pk_add_f32 v[98:99],v[98:99],v[92:93]
v_pk_fma_f32 v[102:103],v[92:93],v[92:93],v[102:103]
v_pk_add_f32 v[96:97],v[96:97],v[86:87]
v_pk_fma_f32 v[100:101],v[86:87],v[86:87],v[100:101]
v_pk_add_f32 v[98:99],v[98:99],v[94:95]
v_pk_fma_f32 v[102:103],v[94:95],v[94:95],v[102:103]
v_pk_add_f32 v[96:97],v[96:97],v[98:99]
v_pk_add_f32 v[100:101],v[100:101],v[102:103]
v_add_f32 v96,v96,v97
v_add_f32 v97,v100,v101
s_nop 0
v_add_f32_dpp v96,v96,v96 quad_perm:[1,0,3,2] row_mask:0xf bank_mask:0xf
v_add_f32_dpp v97,v97,v97 quad_perm:[1,0,3,2] row_mask:0xf bank_mask:0xf
s_nop 0
v_add_f32_dpp v96,v96,v96 quad_perm:[2,3,0,1] row_mask:0xf bank_mask:0xf
v_add_f32_dpp v97,v97,v97 quad_perm:[2,3,0,1] row_mask:0xf bank_mask:0xf
s_nop 0
v_add_f32_dpp v96,v96,v96 row_half_mirror row_mask:0xf bank_mask:0xf
v_add_f32_dpp v97,v97,v97 row_half_mirror row_mask:0xf bank_mask:0xf
s_nop 0
v_add_f32_dpp v96,v96,v96 row_mirror row_mask:0xf bank_mask:0xf
v_add_f32_dpp v97,v97,v97 row_mirror row_mask:0xf bank_mask:0xf
v_mov_b32 v98,v96
v_mov_b32 v99,v97
s_nop 0
v_permlane16_swap_b32 v98,v96
v_permlane16_swap_b32 v99,v97
v_pk_add_f32 v[96:97],v[96:97],v[98:99]
v_mov_b32 v98,v96
v_mov_b32 v99,v97
s_nop 0
v_permlane32_swap_b32 v98,v96
v_permlane32_swap_b32 v99,v97
v_pk_add_f32 v[96:97],v[96:97],v[98:99]
v_mul_f32 v96,0xba800000,v96
v_mul_f32 v98,v96,v96
v_fma_f32 v98,v97,s82,-v98
v_max_f32 v98,0,v98
v_add_f32 v98,0x3727c5ac,v98
v_rsq_f32 v98,v98
s_nop 0
v_mul_f32 v96,v96,v98
v_pk_fma_f32 v[80:81],v[80:81],v[98:99],v[96:97] op_sel_hi:[1,0,0]
v_pk_fma_f32 v[82:83],v[82:83],v[98:99],v[96:97] op_sel_hi:[1,0,0]
v_pk_fma_f32 v[84:85],v[84:85],v[98:99],v[96:97] op_sel_hi:[1,0,0]
v_pk_fma_f32 v[86:87],v[86:87],v[98:99],v[96:97] op_sel_hi:[1,0,0]
v_pk_fma_f32 v[88:89],v[88:89],v[98:99],v[96:97] op_sel_hi:[1,0,0]
v_pk_fma_f32 v[90:91],v[90:91],v[98:99],v[96:97] op_sel_hi:[1,0,0]
v_pk_fma_f32 v[92:93],v[92:93],v[98:99],v[96:97] op_sel_hi:[1,0,0]
v_pk_fma_f32 v[94:95],v[94:95],v[98:99],v[96:97] op_sel_hi:[1,0,0]
v_cvt_pk_bf16_f32 v72,v80,v81
v_cvt_pk_bf16_f32 v73,v82,v83
v_cvt_pk_bf16_f32 v74,v84,v85
v_cvt_pk_bf16_f32 v75,v86,v87
v_cvt_pk_bf16_f32 v76,v88,v89
v_cvt_pk_bf16_f32 v77,v90,v91
v_cvt_pk_bf16_f32 v78,v92,v93
v_cvt_pk_bf16_f32 v79,v94,v95
v_max_u32 v72,1,v72
v_max_u32 v76,1,v76
buffer_store_dwordx4 v[72:75],v19,s[20:23],s70 offen sc1
buffer_store_dwordx4 v[76:79],v19,s[20:23],s70 offen offset:1024 sc1
s_cmp_gt_u32 s71,40
s_cbranch_scc1 fnow_284
s_cmp_eq_u32 s83,0
s_cbranch_scc1 flater_285
s_waitcnt vmcnt(0)
fnow_284:
v_mov_b32 v22,s71
buffer_store_dword v22,v23,s[24:27],s73 offen
buffer_store_dword v22,v23,s[28:31],s73 offen sc1
flater_285:
v_mov_b32 v6,s71
ds_write_b32 v7,v6
s_mov_b32 s70,s75
s_add_u32 s79,s79,1
s_add_u32 s71,s71,1
s_cmp_lt_u32 s79,64
s_cbranch_scc1 lloop_277
s_endpgm
r_wo_214:
s_load_dwordx2 s[4:5],s[0:1],40
s_load_dwordx2 s[6:7],s[0:1],0
s_lshr_b32 s41,s59,3
s_and_b32 s42,s59,7
s_mul_i32 s66,s41,2097152
s_lshl_b32 s64,s42,8
s_add_u32 s66,s66,s64
s_lshl_b32 s67,s50,1
s_and_b32 s64,s41,1
s_add_u32 s67,s67,s64
s_waitcnt lgkmcnt(0)
s_mov_b32 s32,s4
s_and_b32 s33,s5,0xffff
s_mov_b32 s34,0x800000
s_mov_b32 s35,0x20000
s_mov_b32 s36,s6
s_and_b32 s37,s7,0xffff
s_mov_b32 s38,0x400000
s_mov_b32 s39,0x20000
v_lshrrev_b32 v5,2,v3
v_lshl_add_u32 v5,v4,2,v5
v_and_b32 v6,3,v3
v_lshlrev_b32 v6,3,v6
v_lshl_add_u32 v6,v5,8,v6
v_and_b32 v5,7,v5
v_xor_b32 v5,s67,v5
v_lshl_add_u32 v12,v5,5,v6
v_xor_b32 v13,32,v12
v_and_b32 v5,15,v1
v_and_b32 v6,3,v4
v_lshlrev_b32 v6,1,v6
v_xor_b32 v5,v5,v6
v_mul_u32_u24 v6,2048,v4
v_xor_b32 v7,0,v5
v_lshl_add_u32 v8,v7,4,v6
v_xor_b32 v7,8,v5
v_lshl_add_u32 v9,v7,4,v6
s_mul_i32 s74,s50,131072
s_add_u32 s74,s74,s66
s_lshl_b32 s75,s50,14
s_mul_i32 s76,s50,65536
s_add_u32 s76,s76,s66
s_lshl_b32 s77,s50,13
s_add_u32 s64,s74,0
s_add_u32 m0,s75,0
s_nop 0
buffer_load_dwordx4 v8,s[32:35],s64 offen nt lds
s_add_u32 s64,s74,8192
s_add_u32 m0,s75,1024
s_nop 0
buffer_load_dwordx4 v9,s[32:35],s64 offen nt lds
s_add_u32 s64,s74,16384
s_add_u32 m0,s75,2048
s_nop 0
buffer_load_dwordx4 v8,s[32:35],s64 offen nt lds
s_add_u32 s64,s74,24576
s_add_u32 m0,s75,3072
s_nop 0
buffer_load_dwordx4 v9,s[32:35],s64 offen nt lds
s_add_u32 s64,s74,32768
s_add_u32 m0,s75,4096
s_nop 0
buffer_load_dwordx4 v8,s[32:35],s64 offen nt lds
s_add_u32 s64,s74,40960
s_add_u32 m0,s75,5120
s_nop 0
buffer_load_dwordx4 v9,s[32:35],s64 offen nt lds
s_add_u32 s64,s74,49152
s_add_u32 m0,s75,6144
s_nop 0
buffer_load_dwordx4 v8,s[32:35],s64 offen nt lds
s_add_u32 s64,s74,57344
s_add_u32 m0,s75,7168
s_nop 0
buffer_load_dwordx4 v9,s[32:35],s64 offen nt lds
s_add_u32 s64,s74,65536
s_add_u32 m0,s75,8192
s_nop 0
buffer_load_dwordx4 v8,s[32:35],s64 offen nt lds
s_add_u32 s64,s74,73728
s_add_u32 m0,s75,9216
s_nop 0
buffer_load_dwordx4 v9,s[32:35],s64 offen nt lds
s_add_u32 s64,s74,81920
s_add_u32 m0,s75,10240
s_nop 0
buffer_load_dwordx4 v8,s[32:35],s64 offen nt lds
s_add_u32 s64,s74,90112
s_add_u32 m0,s75,11264
s_nop 0
buffer_load_dwordx4 v9,s[32:35],s64 offen nt lds
s_add_u32 s64,s74,98304
s_add_u32 m0,s75,12288
s_nop 0
buffer_load_dwordx4 v8,s[32:35],s64 offen nt lds
s_add_u32 s64,s74,106496
s_add_u32 m0,s75,13312
s_nop 0
buffer_load_dwordx4 v9,s[32:35],s64 offen nt lds
s_add_u32 s64,s74,114688
s_add_u32 m0,s75,14336
s_nop 0
buffer_load_dwordx4 v8,s[32:35],s64 offen nt lds
s_add_u32 s64,s74,122880
s_add_u32 m0,s75,15360
s_nop 0
buffer_load_dwordx4 v9,s[32:35],s64 offen nt lds
s_add_u32 s64,s74,524288
s_add_u32 m0,s75,65536
s_nop 0
buffer_load_dwordx4 v8,s[32:35],s64 offen nt lds
s_add_u32 s64,s74,532480
s_add_u32 m0,s75,66560
s_nop 0
buffer_load_dwordx4 v9,s[32:35],s64 offen nt lds
s_add_u32 s64,s74,540672
s_add_u32 m0,s75,67584
s_nop 0
buffer_load_dwordx4 v8,s[32:35],s64 offen nt lds
s_add_u32 s64,s74,548864
s_add_u32 m0,s75,68608
s_nop 0
buffer_load_dwordx4 v9,s[32:35],s64 offen nt lds
s_add_u32 s64,s74,557056
s_add_u32 m0,s75,69632
s_nop 0
buffer_load_dwordx4 v8,s[32:35],s64 offen nt lds
s_add_u32 s64,s74,565248
s_add_u32 m0,s75,70656
s_nop 0
buffer_load_dwordx4 v9,s[32:35],s64 offen nt lds
s_add_u32 s64,s74,573440
s_add_u32 m0,s75,71680
s_nop 0
buffer_load_dwordx4 v8,s[32:35],s64 offen nt lds
s_add_u32 s64,s74,581632
s_add_u32 m0,s75,72704
s_nop 0
buffer_load_dwordx4 v9,s[32:35],s64 offen nt lds
s_add_u32 s64,s74,589824
s_add_u32 m0,s75,73728
s_nop 0
buffer_load_dwordx4 v8,s[32:35],s64 offen nt lds
s_add_u32 s64,s74,598016
s_add_u32 m0,s75,74752
s_nop 0
buffer_load_dwordx4 v9,s[32:35],s64 offen nt lds
s_add_u32 s64,s74,606208
s_add_u32 m0,s75,75776
s_nop 0
buffer_load_dwordx4 v8,s[32:35],s64 offen nt lds
s_add_u32 s64,s74,614400
s_add_u32 m0,s75,76800
s_nop 0
buffer_load_dwordx4 v9,s[32:35],s64 offen nt lds
s_add_u32 s64,s74,622592
s_add_u32 m0,s75,77824
s_nop 0
buffer_load_dwordx4 v8,s[32:35],s64 offen nt lds
s_add_u32 s64,s74,630784
s_add_u32 m0,s75,78848
s_nop 0
buffer_load_dwordx4 v9,s[32:35],s64 offen nt lds
s_add_u32 s64,s74,638976
s_add_u32 m0,s75,79872
s_nop 0
buffer_load_dwordx4 v8,s[32:35],s64 offen nt lds
s_add_u32 s64,s74,647168
s_add_u32 m0,s75,80896
s_nop 0
buffer_load_dwordx4 v9,s[32:35],s64 offen nt lds
s_waitcnt vmcnt(16)
s_barrier
ds_read_b64_tr_b16 a[0:1],v12 offset:0
ds_read_b64_tr_b16 a[128:129],v13 offset:0
ds_read_b64_tr_b16 a[2:3],v12 offset:4096
ds_read_b64_tr_b16 a[130:131],v13 offset:4096
ds_read_b64_tr_b16 a[4:5],v12 offset:8192
ds_read_b64_tr_b16 a[132:133],v13 offset:8192
ds_read_b64_tr_b16 a[6:7],v12 offset:12288
ds_read_b64_tr_b16 a[134:135],v13 offset:12288
s_waitcnt lgkmcnt(4)
ds_read_b64_tr_b16 a[8:9],v12 offset:16384
ds_read_b64_tr_b16 a[136:137],v13 offset:16384
ds_read_b64_tr_b16 a[10:11],v12 offset:20480
ds_read_b64_tr_b16 a[138:139],v13 offset:20480
ds_read_b64_tr_b16 a[12:13],v12 offset:24576
ds_read_b64_tr_b16 a[140:141],v13 offset:24576
ds_read_b64_tr_b16 a[14:15],v12 offset:28672
ds_read_b64_tr_b16 a[142:143],v13 offset:28672
s_waitcnt lgkmcnt(4)
ds_read_b64_tr_b16 a[16:17],v12 offset:32768
ds_read_b64_tr_b16 a[144:145],v13 offset:32768
ds_read_b64_tr_b16 a[18:19],v12 offset:36864
ds_read_b64_tr_b16 a[146:147],v13 offset:36864
ds_read_b64_tr_b16 a[20:21],v12 offset:40960
ds_read_b64_tr_b16 a[148:149],v13 offset:40960
ds_read_b64_tr_b16 a[22:23],v12 offset:45056
ds_read_b64_tr_b16 a[150:151],v13 offset:45056
s_waitcnt lgkmcnt(4)
ds_read_b64_tr_b16 a[24:25],v12 offset:49152
ds_read_b64_tr_b16 a[152:153],v13 offset:49152
ds_read_b64_tr_b16 a[26:27],v12 offset:53248
ds_read_b64_tr_b16 a[154:155],v13 offset:53248
ds_read_b64_tr_b16 a[28:29],v12 offset:57344
ds_read_b64_tr_b16 a[156:157],v13 offset:57344
ds_read_b64_tr_b16 a[30:31],v12 offset:61440
ds_read_b64_tr_b16 a[158:159],v13 offset:61440
s_waitcnt lgkmcnt(4)
v_xor_b32 v12,0x10000,v12
v_xor_b32 v13,0x10000,v13
s_waitcnt lgkmcnt(0)
s_barrier
s_add_u32 s64,s74,1048576
s_add_u32 m0,s75,0
s_nop 0
buffer_load_dwordx4 v8,s[32:35],s64 offen nt lds
s_add_u32 s64,s74,1056768
s_add_u32 m0,s75,1024
s_nop 0
buffer_load_dwordx4 v9,s[32:35],s64 offen nt lds
s_add_u32 s64,s74,1064960
s_add_u32 m0,s75,2048
s_nop 0
buffer_load_dwordx4 v8,s[32:35],s64 offen nt lds
s_add_u32 s64,s74,1073152
s_add_u32 m0,s75,3072
s_nop 0
buffer_load_dwordx4 v9,s[32:35],s64 offen nt lds
s_add_u32 s64,s74,1081344
s_add_u32 m0,s75,4096
s_nop 0
buffer_load_dwordx4 v8,s[32:35],s64 offen nt lds
s_add_u32 s64,s74,1089536
s_add_u32 m0,s75,5120
s_nop 0
buffer_load_dwordx4 v9,s[32:35],s64 offen nt lds
s_add_u32 s64,s74,1097728
s_add_u32 m0,s75,6144
s_nop 0
buffer_load_dwordx4 v8,s[32:35],s64 offen nt lds
s_add_u32 s64,s74,1105920
s_add_u32 m0,s75,7168
s_nop 0
buffer_load_dwordx4 v9,s[32:35],s64 offen nt lds
s_add_u32 s64,s74,1114112
s_add_u32 m0,s75,8192
s_nop 0
buffer_load_dwordx4 v8,s[32:35],s64 offen nt lds
s_add_u32 s64,s74,1122304
s_add_u32 m0,s75,9216
s_nop 0
buffer_load_dwordx4 v9,s[32:35],s64 offen nt lds
s_add_u32 s64,s74,1130496
s_add_u32 m0,s75,10240
s_nop 0
buffer_load_dwordx4 v8,s[32:35],s64 offen nt lds
s_add_u32 s64,s74,1138688
s_add_u32 m0,s75,11264
s_nop 0
buffer_load_dwordx4 v9,s[32:35],s64 offen nt lds
s_add_u32 s64,s74,1146880
s_add_u32 m0,s75,12288
s_nop 0
buffer_load_dwordx4 v8,s[32:35],s64 offen nt lds
s_add_u32 s64,s74,1155072
s_add_u32 m0,s75,13312
s_nop 0
buffer_load_dwordx4 v9,s[32:35],s64 offen nt lds
s_add_u32 s64,s74,1163264
s_add_u32 m0,s75,14336
s_nop 0
buffer_load_dwordx4 v8,s[32:35],s64 offen nt lds
s_add_u32 s64,s74,1171456
s_add_u32 m0,s75,15360
s_nop 0
buffer_load_dwordx4 v9,s[32:35],s64 offen nt lds
s_waitcnt vmcnt(16)
s_barrier
ds_read_b64_tr_b16 a[32:33],v12 offset:0
ds_read_b64_tr_b16 a[160:161],v13 offset:0
ds_read_b64_tr_b16 a[34:35],v12 offset:4096
ds_read_b64_tr_b16 a[162:163],v13 offset:4096
ds_read_b64_tr_b16 a[36:37],v12 offset:8192
ds_read_b64_tr_b16 a[164:165],v13 offset:8192
ds_read_b64_tr_b16 a[38:39],v12 offset:12288
ds_read_b64_tr_b16 a[166:167],v13 offset:12288
s_waitcnt lgkmcnt(4)
ds_read_b64_tr_b16 a[40:41],v12 offset:16384
ds_read_b64_tr_b16 a[168:169],v13 offset:16384
ds_read_b64_tr_b16 a[42:43],v12 offset:20480
ds_read_b64_tr_b16 a[170:171],v13 offset:20480
ds_read_b64_tr_b16 a[44:45],v12 offset:24576
ds_read_b64_tr_b16 a[172:173],v13 offset:24576
ds_read_b64_tr_b16 a[46:47],v12 offset:28672
ds_read_b64_tr_b16 a[174:175],v13 offset:28672
s_waitcnt lgkmcnt(4)
ds_read_b64_tr_b16 a[48:49],v12 offset:32768
ds_read_b64_tr_b16 a[176:177],v13 offset:32768
ds_read_b64_tr_b16 a[50:51],v12 offset:36864
ds_read_b64_tr_b16 a[178:179],v13 offset:36864
ds_read_b64_tr_b16 a[52:53],v12 offset:40960
ds_read_b64_tr_b16 a[180:181],v13 offset:40960
ds_read_b64_tr_b16 a[54:55],v12 offset:45056
ds_read_b64_tr_b16 a[182:183],v13 offset:45056
s_waitcnt lgkmcnt(4)
ds_read_b64_tr_b16 a[56:57],v12 offset:49152
ds_read_b64_tr_b16 a[184:185],v13 offset:49152
ds_read_b64_tr_b16 a[58:59],v12 offset:53248
ds_read_b64_tr_b16 a[186:187],v13 offset:53248
ds_read_b64_tr_b16 a[60:61],v12 offset:57344
ds_read_b64_tr_b16 a[188:189],v13 offset:57344
ds_read_b64_tr_b16 a[62:63],v12 offset:61440
ds_read_b64_tr_b16 a[190:191],v13 offset:61440
s_waitcnt lgkmcnt(4)
v_xor_b32 v12,0x10000,v12
v_xor_b32 v13,0x10000,v13
s_waitcnt lgkmcnt(0)
s_barrier
s_add_u32 s64,s74,1572864
s_add_u32 m0,s75,65536
s_nop 0
buffer_load_dwordx4 v8,s[32:35],s64 offen nt lds
s_add_u32 s64,s74,1581056
s_add_u32 m0,s75,66560
s_nop 0
buffer_load_dwordx4 v9,s[32:35],s64 offen nt lds
s_add_u32 s64,s74,1589248
s_add_u32 m0,s75,67584
s_nop 0
buffer_load_dwordx4 v8,s[32:35],s64 offen nt lds
s_add_u32 s64,s74,1597440
s_add_u32 m0,s75,68608
s_nop 0
buffer_load_dwordx4 v9,s[32:35],s64 offen nt lds
s_add_u32 s64,s74,1605632
s_add_u32 m0,s75,69632
s_nop 0
buffer_load_dwordx4 v8,s[32:35],s64 offen nt lds
s_add_u32 s64,s74,1613824
s_add_u32 m0,s75,70656
s_nop 0
buffer_load_dwordx4 v9,s[32:35],s64 offen nt lds
s_add_u32 s64,s74,1622016
s_add_u32 m0,s75,71680
s_nop 0
buffer_load_dwordx4 v8,s[32:35],s64 offen nt lds
s_add_u32 s64,s74,1630208
s_add_u32 m0,s75,72704
s_nop 0
buffer_load_dwordx4 v9,s[32:35],s64 offen nt lds
s_add_u32 s64,s74,1638400
s_add_u32 m0,s75,73728
s_nop 0
buffer_load_dwordx4 v8,s[32:35],s64 offen nt lds
s_add_u32 s64,s74,1646592
s_add_u32 m0,s75,74752
s_nop 0
buffer_load_dwordx4 v9,s[32:35],s64 offen nt lds
s_add_u32 s64,s74,1654784
s_add_u32 m0,s75,75776
s_nop 0
buffer_load_dwordx4 v8,s[32:35],s64 offen nt lds
s_add_u32 s64,s74,1662976
s_add_u32 m0,s75,76800
s_nop 0
buffer_load_dwordx4 v9,s[32:35],s64 offen nt lds
s_add_u32 s64,s74,1671168
s_add_u32 m0,s75,77824
s_nop 0
buffer_load_dwordx4 v8,s[32:35],s64 offen nt lds
s_add_u32 s64,s74,1679360
s_add_u32 m0,s75,78848
s_nop 0
buffer_load_dwordx4 v9,s[32:35],s64 offen nt lds
s_add_u32 s64,s74,1687552
s_add_u32 m0,s75,79872
s_nop 0
buffer_load_dwordx4 v8,s[32:35],s64 offen nt lds
s_add_u32 s64,s74,1695744
s_add_u32 m0,s75,80896
s_nop 0
buffer_load_dwordx4 v9,s[32:35],s64 offen nt lds
s_waitcnt vmcnt(16)
s_barrier
ds_read_b64_tr_b16 a[64:65],v12 offset:0
ds_read_b64_tr_b16 a[192:193],v13 offset:0
ds_read_b64_tr_b16 a[66:67],v12 offset:4096
ds_read_b64_tr_b16 a[194:195],v13 offset:4096
ds_read_b64_tr_b16 a[68:69],v12 offset:8192
ds_read_b64_tr_b16 a[196:197],v13 offset:8192
ds_read_b64_tr_b16 a[70:71],v12 offset:12288
ds_read_b64_tr_b16 a[198:199],v13 offset:12288
s_waitcnt lgkmcnt(4)
ds_read_b64_tr_b16 a[72:73],v12 offset:16384
ds_read_b64_tr_b16 a[200:201],v13 offset:16384
ds_read_b64_tr_b16 a[74:75],v12 offset:20480
ds_read_b64_tr_b16 a[202:203],v13 offset:20480
ds_read_b64_tr_b16 a[76:77],v12 offset:24576
ds_read_b64_tr_b16 a[204:205],v13 offset:24576
ds_read_b64_tr_b16 a[78:79],v12 offset:28672
ds_read_b64_tr_b16 a[206:207],v13 offset:28672
s_waitcnt lgkmcnt(4)
ds_read_b64_tr_b16 a[80:81],v12 offset:32768
ds_read_b64_tr_b16 a[208:209],v13 offset:32768
ds_read_b64_tr_b16 a[82:83],v12 offset:36864
ds_read_b64_tr_b16 a[210:211],v13 offset:36864
ds_read_b64_tr_b16 a[84:85],v12 offset:40960
ds_read_b64_tr_b16 a[212:213],v13 offset:40960
ds_read_b64_tr_b16 a[86:87],v12 offset:45056
ds_read_b64_tr_b16 a[214:215],v13 offset:45056
s_waitcnt lgkmcnt(4)
ds_read_b64_tr_b16 a[88:89],v12 offset:49152
ds_read_b64_tr_b16 a[216:217],v13 offset:49152
ds_read_b64_tr_b16 a[90:91],v12 offset:53248
ds_read_b64_tr_b16 a[218:219],v13 offset:53248
ds_read_b64_tr_b16 a[92:93],v12 offset:57344
ds_read_b64_tr_b16 a[220:221],v13 offset:57344
ds_read_b64_tr_b16 a[94:95],v12 offset:61440
ds_read_b64_tr_b16 a[222:223],v13 offset:61440
s_waitcnt lgkmcnt(4)
v_xor_b32 v12,0x10000,v12
v_xor_b32 v13,0x10000,v13
s_waitcnt lgkmcnt(0)
s_barrier
s_waitcnt vmcnt(0)
s_barrier
ds_read_b64_tr_b16 a[96:97],v12 offset:0
ds_read_b64_tr_b16 a[224:225],v13 offset:0
ds_read_b64_tr_b16 a[98:99],v12 offset:4096
ds_read_b64_tr_b16 a[226:227],v13 offset:4096
ds_read_b64_tr_b16 a[100:101],v12 offset:8192
ds_read_b64_tr_b16 a[228:229],v13 offset:8192
ds_read_b64_tr_b16 a[102:103],v12 offset:12288
ds_read_b64_tr_b16 a[230:231],v13 offset:12288
s_waitcnt lgkmcnt(4)
ds_read_b64_tr_b16 a[104:105],v12 offset:16384
ds_read_b64_tr_b16 a[232:233],v13 offset:16384
ds_read_b64_tr_b16 a[106:107],v12 offset:20480
ds_read_b64_tr_b16 a[234:235],v13 offset:20480
ds_read_b64_tr_b16 a[108:109],v12 offset:24576
ds_read_b64_tr_b16 a[236:237],v13 offset:24576
ds_read_b64_tr_b16 a[110:111],v12 offset:28672
ds_read_b64_tr_b16 a[238:239],v13 offset:28672
s_waitcnt lgkmcnt(4)
ds_read_b64_tr_b16 a[112:113],v12 offset:32768
ds_read_b64_tr_b16 a[240:241],v13 offset:32768
ds_read_b64_tr_b16 a[114:115],v12 offset:36864
ds_read_b64_tr_b16 a[242:243],v13 offset:36864
ds_read_b64_tr_b16 a[116:117],v12 offset:40960
ds_read_b64_tr_b16 a[244:245],v13 offset:40960
ds_read_b64_tr_b16 a[118:119],v12 offset:45056
ds_read_b64_tr_b16 a[246:247],v13 offset:45056
s_waitcnt lgkmcnt(4)
ds_read_b64_tr_b16 a[120:121],v12 offset:49152
ds_read_b64_tr_b16 a[248:249],v13 offset:49152
ds_read_b64_tr_b16 a[122:123],v12 offset:53248
ds_read_b64_tr_b16 a[250:251],v13 offset:53248
ds_read_b64_tr_b16 a[124:125],v12 offset:57344
ds_read_b64_tr_b16 a[252:253],v13 offset:57344
ds_read_b64_tr_b16 a[126:127],v12 offset:61440
ds_read_b64_tr_b16 a[254:255],v13 offset:61440
s_waitcnt lgkmcnt(4)
v_xor_b32 v12,0x10000,v12
v_xor_b32 v13,0x10000,v13
s_waitcnt lgkmcnt(0)
s_barrier
v_and_b32 v21,1,v1
v_mul_u32_u24 v21,960,v21
s_mov_b32 s65,21052032
s_mov_b32 s66,1792
pl_286:
buffer_load_dword v22,v21,s[20:23],s65 offen sc1
s_waitcnt vmcnt(0)
v_cmp_gt_u32 vcc,s66,v22
s_cbranch_vccz pok_287
s_sleep 1
s_sub_u32 s90,s90,1
s_cmp_gt_i32 s90,0
s_cbranch_scc1 pl_286
pok_287:
s_lshr_b32 s43,s41,1
s_and_b32 s48,s41,1
s_lshl_b32 s64,s42,7
s_lshl_b32 s65,s50,5
s_add_u32 s64,s64,s65
s_lshl_b32 s65,s48,4
s_add_u32 s64,s64,s65
v_lshl_add_u32 v5,v4,2,s64
v_lshlrev_b32 v6,2,v5
s_mov_b32 s64,8192
buffer_load_dwordx4 v[52:55],v6,s[20:23],s64 offen sc1
v_lshlrev_b32 v10,1,v5
v_and_b32 v6,3,v1
v_sub_u32 v5,v6,v4
v_lshl_add_u32 v5,v5,3,v10
v_lshrrev_b32 v11,2,v1
v_lshl_add_u32 v40,v6,4,v11
v_lshlrev_b32 v40,2,v40
v_lshl_add_u32 v41,v3,2,v4
v_lshlrev_b32 v41,2,v41
s_lshl_b32 s64,s43,10
v_add_u32 v17,s64,v16
v_xor_b32 v18,1024,v17
s_xor_b32 s64,s64,1024
s_lshr_b32 s65,s50,1
s_and_b32 s66,s50,1
s_lshl_b32 s66,s66,12
s_add_u32 s66,s66,s64
s_lshl_b32 s72,s65,13
s_add_u32 s72,s72,s66
s_add_u32 s72,s72,0x10000
s_lshl_b32 s65,s65,14
s_add_u32 s75,s65,s66
s_add_u32 s75,s75,524288
s_mul_i32 s64,s41,131072
s_add_u32 s75,s75,s64
s_cmp_lt_u32 s50,2
s_cselect_b32 s86,98304,0x40000000
s_lshl_b32 s76,s79,21
s_add_u32 s76,s76,27262976
s_mov_b32 s77,0
s_lshl_b32 s78,s79,16
s_mov_b32 s49,0
s_cmp_eq_u32 s79,0
s_mov_b32 s66,8577024
s_cselect_b32 s66,17825792,s66
s_lshl_b32 s64,s59,14
s_lshl_b32 s65,s50,12
s_add_u32 s65,s65,s66
s_add_u32 s64,s64,s65
v_add_u32 v26,s64,v16
s_lshl_b32 s64,s42,14
s_add_u32 s64,s64,s65
v_add_u32 v25,s64,v16
s_xor_b32 s33,s41,1
s_xor_b32 s34,s41,2
s_xor_b32 s35,s41,3
s_lshl_b32 s33,s33,17
s_lshl_b32 s34,s34,17
s_lshl_b32 s35,s35,17
v_and_b32 v21,7,v1
v_lshlrev_b32 v21,7,v21
v_bfe_u32 v6,v1,3,0
v_lshl_add_u32 v21,v6,2,v21
s_lshl_b32 s74,s41,10
s_add_u32 s74,s74,s63
s_lshl_b32 s64,s60,4
s_add_u32 s74,s74,s64
s_add_u32 s74,s74,16384
v_lshrrev_b32 v6,2,v11
v_and_b32 v7,3,v11
v_lshl_add_u32 v6,v6,1,s43
v_lshl_add_u32 v8,v6,2,v7
v_lshl_add_u32 v8,v8,7,v5
v_and_b32 v8,2047,v8
v_lshl_add_u32 v8,v7,11,v8
v_lshl_add_u32 v7,v7,11,v5
v_lshl_add_u32 v20,v6,13,v7
v_lshl_add_u32 v19,v6,14,v8
v_add_u32 v19,1048576,v19
s_lshl_b32 s73,s59,2
s_add_u32 s73,s73,s50
s_lshl_b32 s73,s73,2
s_add_u32 s73,s73,s63
s_add_u32 s73,s73,2048
s_mov_b32 s48,1
s_waitcnt vmcnt(0)
s_cmp_lg_u32 s56,0
s_cbranch_scc1 kslow_288
s_add_u32 s64,s79,0
s_lshl_b32 s70,s64,21
s_lshl_b32 s64,s64,13
s_and_b32 s64,s64,0x2000
s_xor_b32 s64,s64,s62
s_add_u32 s70,s70,s64
s_add_u32 s70,s70,29360128
s_mov_b32 s83,1
s_mov_b32 s87,s74
s_cmp_eq_u32 s50,0
s_cselect_b32 s74,s74,0x7fff0000
v_mov_b32 v47,132096
s_lshl_b32 s64,s50,3
s_add_u32 s64,s64,132096
v_mov_b32 v46,s64
v_mov_b32 v29,0
s_mov_b32 s97,0x7fff0000
s_mov_b32 s69,1
s_mov_b32 s68,0
s_mov_b32 s52,0x30003
s_mov_b32 s53,s52
seg_290:
s_cmp_eq_u32 s83,0
s_cbranch_scc1 ahead_291
s_add_u32 s94,s70,s75
s_xor_b32 s95,s94,1024
s_xor_b32 s91,s72,0x10000
s_waitcnt vmcnt(2)
v_cmp_gt_u32 vcc,s71,v29
s_cbranch_vccz nb_294
s_waitcnt vmcnt(0)
v_add_u32 v22,s71,-1
buffer_store_dword v22,v23,s[20:23],s97 offen sc1
s_mov_b32 s97,0x7fff0000
s_cmp_lg_u32 s50,0
s_cbranch_scc1 nb_294
buffer_load_dword v32,v21,s[20:23],s74 offen sc1
s_sleep 2
pl_296:
buffer_load_dword v33,v21,s[20:23],s74 offen sc1
s_waitcnt vmcnt(1)
v_cmp_gt_u32 vcc,s71,v32
v_mov_b32 v29,v32
s_cbranch_vccz pok_297
buffer_load_dword v32,v21,s[20:23],s74 offen sc1
s_waitcnt vmcnt(1)
v_cmp_gt_u32 vcc,s71,v33
v_mov_b32 v29,v33
s_cbranch_vccz pok_297
s_sub_u32 s90,s90,1
s_cmp_gt_i32 s90,0
s_cbranch_scc1 pl_296
pok_297:
nb_294:
s_barrier
s_xor_b32 m0,s91,0
s_add_u32 s65,s94,0
buffer_load_dwordx4 v16,s[20:23],s65 offen offset:0 sc1 lds
buffer_load_dwordx4 v16,s[20:23],s65 offen offset:2048 sc1 lds
s_xor_b32 m0,s91,16384
s_add_u32 s65,s94,32768
buffer_load_dwordx4 v16,s[20:23],s65 offen offset:0 sc1 lds
buffer_load_dwordx4 v16,s[20:23],s65 offen offset:2048 sc1 lds
s_xor_b32 m0,s91,32768
s_add_u32 s65,s94,65536
buffer_load_dwordx4 v16,s[20:23],s65 offen offset:0 sc1 lds
buffer_load_dwordx4 v16,s[20:23],s65 offen offset:2048 sc1 lds
s_xor_b32 m0,s91,49152
s_add_u32 s65,s94,98304
buffer_load_dwordx4 v16,s[20:23],s65 offen offset:0 sc1 lds
buffer_load_dwordx4 v16,s[20:23],s65 offen offset:2048 sc1 lds
s_waitcnt vmcnt(8)
v_add_u32 v22,s71,-1
buffer_store_dword v22,v23,s[20:23],s97 offen sc1
s_mov_b32 s97,0x7fff0000
s_waitcnt vmcnt(7)
s_barrier
ds_read_b128 v[224:227],v18 offset:0
ds_read_b128 v[228:231],v18 offset:2048
ds_read_b128 v[232:235],v18 offset:4096
ds_read_b128 v[236:239],v18 offset:6144
ds_read_b128 v[240:243],v18 offset:8192
ds_read_b128 v[244:247],v18 offset:10240
ds_read_b128 v[248:251],v18 offset:12288
s_waitcnt lgkmcnt(5)
v_mfma_f32_16x16x32_bf16 v[64:67],a[0:3],v[224:227],0
s_xor_b32 m0,s91,1024
s_add_u32 s96,s71,1
v_mfma_f32_16x16x32_bf16 v[68:71],a[128:131],v[224:227],0
ds_read_b128 v[252:255],v18 offset:14336
s_add_u32 s92,s71,2
v_mfma_f32_16x16x32_bf16 v[64:67],a[4:7],v[228:231],v[64:67]
s_add_u32 s65,s95,0
v_min_u32 v27,v224,v228
v_mfma_f32_16x16x32_bf16 v[68:71],a[132:135],v[228:231],v[68:71]
s_waitcnt vmcnt(5)
s_barrier
ds_read_b128 v[224:227],v18 offset:16384
s_waitcnt lgkmcnt(5)
v_mfma_f32_16x16x32_bf16 v[64:67],a[8:11],v[232:235],v[64:67]
buffer_load_dwordx4 v16,s[20:23],s65 offen offset:0 sc1 lds
v_mfma_f32_16x16x32_bf16 v[68:71],a[136:139],v[232:235],v[68:71]
ds_read_b128 v[228:231],v18 offset:18432
v_min3_u32 v27,v27,v232,v236
v_mfma_f32_16x16x32_bf16 v[64:67],a[12:15],v[236:239],v[64:67]
buffer_load_dwordx4 v16,s[20:23],s65 offen offset:2048 sc1 lds
v_mfma_f32_16x16x32_bf16 v[68:71],a[140:143],v[236:239],v[68:71]
ds_read_b128 v[232:235],v18 offset:20480
s_waitcnt lgkmcnt(5)
v_mfma_f32_16x16x32_bf16 v[64:67],a[16:19],v[240:243],v[64:67]
s_xor_b32 m0,s91,17408
v_min3_u32 v27,v27,v240,v244
v_mfma_f32_16x16x32_bf16 v[68:71],a[144:147],v[240:243],v[68:71]
ds_read_b128 v[236:239],v18 offset:22528
v_mfma_f32_16x16x32_bf16 v[64:67],a[20:23],v[244:247],v[64:67]
s_add_u32 s65,s95,32768
v_mfma_f32_16x16x32_bf16 v[68:71],a[148:151],v[244:247],v[68:71]
ds_read_b128 v[240:243],v18 offset:24576
s_waitcnt lgkmcnt(5)
v_mfma_f32_16x16x32_bf16 v[64:67],a[24:27],v[248:251],v[64:67]
buffer_load_dwordx4 v16,s[20:23],s65 offen offset:0 sc1 lds
v_mfma_f32_16x16x32_bf16 v[68:71],a[152:155],v[248:251],v[68:71]
ds_read_b128 v[244:247],v18 offset:26624
v_min3_u32 v27,v27,v248,v252
v_mfma_f32_16x16x32_bf16 v[64:67],a[28:31],v[252:255],v[64:67]
buffer_load_dwordx4 v16,s[20:23],s65 offen offset:2048 sc1 lds
v_mfma_f32_16x16x32_bf16 v[68:71],a[156:159],v[252:255],v[68:71]
ds_read_b128 v[248:251],v18 offset:28672
s_waitcnt lgkmcnt(5)
v_mfma_f32_16x16x32_bf16 v[64:67],a[32:35],v[224:227],v[64:67]
s_xor_b32 m0,s91,33792
v_min3_u32 v27,v27,v224,v228
v_mfma_f32_16x16x32_bf16 v[68:71],a[160:163],v[224:227],v[68:71]
ds_read_b128 v[252:255],v18 offset:30720
v_mfma_f32_16x16x32_bf16 v[64:67],a[36:39],v[228:231],v[64:67]
s_add_u32 s65,s95,65536
s_waitcnt vmcnt(63)
v_mfma_f32_16x16x32_bf16 v[68:71],a[164:167],v[228:231],v[68:71]
s_waitcnt vmcnt(5)
s_barrier
ds_read_b128 v[224:227],v18 offset:32768
s_waitcnt lgkmcnt(5)
v_mfma_f32_16x16x32_bf16 v[64:67],a[40:43],v[232:235],v[64:67]
buffer_load_dwordx4 v16,s[20:23],s65 offen offset:0 sc1 lds
v_min3_u32 v27,v27,v232,v236
v_mfma_f32_16x16x32_bf16 v[68:71],a[168:171],v[232:235],v[68:71]
ds_read_b128 v[228:231],v18 offset:34816
v_cmp_gt_u32 vcc,s96,v29
v_cmp_gt_u32 s[92:93],s92,v29
v_mfma_f32_16x16x32_bf16 v[64:67],a[44:47],v[236:239],v[64:67]
buffer_load_dwordx4 v16,s[20:23],s65 offen offset:2048 sc1 lds
v_mfma_f32_16x16x32_bf16 v[68:71],a[172:175],v[236:239],v[68:71]
ds_read_b128 v[232:235],v18 offset:36864
s_waitcnt lgkmcnt(5)
v_mfma_f32_16x16x32_bf16 v[64:67],a[48:51],v[240:243],v[64:67]
s_xor_b32 m0,s91,50176
v_mov_b32 v44,vcc_lo
v_mov_b32 v45,s92
v_mfma_f32_16x16x32_bf16 v[68:71],a[176:179],v[240:243],v[68:71]
ds_read_b128 v[236:239],v18 offset:38912
ds_write_b64 v46,v[44:45]
v_mfma_f32_16x16x32_bf16 v[64:67],a[52:55],v[244:247],v[64:67]
s_add_u32 s65,s95,98304
v_min3_u32 v27,v27,v240,v244
v_mfma_f32_16x16x32_bf16 v[68:71],a[180:183],v[244:247],v[68:71]
ds_read_b128 v[240:243],v18 offset:40960
s_waitcnt lgkmcnt(6)
v_mfma_f32_16x16x32_bf16 v[64:67],a[56:59],v[248:251],v[64:67]
buffer_load_dwordx4 v16,s[20:23],s65 offen offset:0 sc1 lds
v_mfma_f32_16x16x32_bf16 v[68:71],a[184:187],v[248:251],v[68:71]
ds_read_b128 v[244:247],v18 offset:43008
v_min3_u32 v27,v27,v248,v252
v_mfma_f32_16x16x32_bf16 v[64:67],a[60:63],v[252:255],v[64:67]
buffer_load_dwordx4 v16,s[20:23],s65 offen offset:2048 sc1 lds
v_mfma_f32_16x16x32_bf16 v[68:71],a[188:191],v[252:255],v[68:71]
ds_read_b128 v[248:251],v18 offset:45056
s_waitcnt lgkmcnt(6)
v_mfma_f32_16x16x32_bf16 v[64:67],a[64:67],v[224:227],v[64:67]
v_min3_u32 v27,v27,v224,v228
s_add_u32 s88,s70,s75
v_mfma_f32_16x16x32_bf16 v[68:71],a[192:195],v[224:227],v[68:71]
ds_read_b128 v[252:255],v18 offset:47104
s_add_u32 s88,s88,2097152
v_mfma_f32_16x16x32_bf16 v[64:67],a[68:71],v[228:231],v[64:67]
buffer_load_dwordx2 v[120:121],v20,s[36:39],s78 offen
v_mfma_f32_16x16x32_bf16 v[68:71],a[196:199],v[228:231],v[68:71]
ds_read_b128 v[224:227],v18 offset:49152
s_waitcnt lgkmcnt(6)
v_mfma_f32_16x16x32_bf16 v[64:67],a[72:75],v[232:235],v[64:67]
v_min3_u32 v27,v27,v232,v236
s_xor_b32 s88,s88,0x2000
v_mfma_f32_16x16x32_bf16 v[68:71],a[200:203],v[232:235],v[68:71]
ds_read_b128 v[228:231],v18 offset:51200
s_xor_b32 s89,s88,1024
v_mfma_f32_16x16x32_bf16 v[64:67],a[76:79],v[236:239],v[64:67]
v_mfma_f32_16x16x32_bf16 v[68:71],a[204:207],v[236:239],v[68:71]
ds_read_b128 v[232:235],v18 offset:53248
s_waitcnt lgkmcnt(5)
v_mfma_f32_16x16x32_bf16 v[64:67],a[80:83],v[240:243],v[64:67]
s_waitcnt vmcnt(5)
s_barrier
ds_read_b64 v[44:45],v47
ds_read_b128 v[128:131],v17 offset:0
ds_read_b128 v[132:135],v17 offset:2048
v_mfma_f32_16x16x32_bf16 v[68:71],a[208:211],v[240:243],v[68:71]
ds_read_b128 v[236:239],v18 offset:55296
v_min3_u32 v27,v27,v240,v244
v_mfma_f32_16x16x32_bf16 v[64:67],a[84:87],v[244:247],v[64:67]
ds_read_b128 v[136:139],v17 offset:4096
v_mfma_f32_16x16x32_bf16 v[68:71],a[212:215],v[244:247],v[68:71]
ds_read_b128 v[240:243],v18 offset:57344
s_waitcnt lgkmcnt(9)
v_mfma_f32_16x16x32_bf16 v[64:67],a[88:91],v[248:251],v[64:67]
ds_read_b128 v[140:143],v17 offset:6144
v_min3_u32 v27,v27,v248,v252
v_mfma_f32_16x16x32_bf16 v[68:71],a[216:219],v[248:251],v[68:71]
ds_read_b128 v[244:247],v18 offset:59392
v_mfma_f32_16x16x32_bf16 v[64:67],a[92:95],v[252:255],v[64:67]
ds_read_b128 v[144:147],v17 offset:8192
ds_read_b128 v[148:151],v17 offset:10240
v_mfma_f32_16x16x32_bf16 v[68:71],a[220:223],v[252:255],v[68:71]
ds_read_b128 v[248:251],v18 offset:61440
s_waitcnt lgkmcnt(12)
v_mfma_f32_16x16x32_bf16 v[64:67],a[96:99],v[224:227],v[64:67]
ds_read_b128 v[152:155],v17 offset:12288
s_waitcnt lgkmcnt(11)
v_min3_u32 v27,v27,v224,v228
v_mfma_f32_16x16x32_bf16 v[68:71],a[224:227],v[224:227],v[68:71]
ds_read_b128 v[252:255],v18 offset:63488
v_readfirstlane_b32 s93,v45
v_mfma_f32_16x16x32_bf16 v[64:67],a[100:103],v[228:231],v[64:67]
ds_read_b128 v[156:159],v17 offset:14336
v_readfirstlane_b32 s83,v44
s_cmp_lg_u32 s83,0
s_cbranch_scc0 keep_300
v_mfma_f32_16x16x32_bf16 v[68:71],a[228:231],v[228:231],v[68:71]
s_waitcnt lgkmcnt(10)
v_mfma_f32_16x16x32_bf16 v[64:67],a[104:107],v[232:235],v[64:67]
ds_read_b128 v[160:163],v17 offset:16384
ds_read_b128 v[164:167],v17 offset:18432
v_mfma_f32_16x16x32_bf16 v[68:71],a[232:235],v[232:235],v[68:71]
v_min3_u32 v27,v27,v232,v236
v_mfma_f32_16x16x32_bf16 v[64:67],a[108:111],v[236:239],v[64:67]
ds_read_b128 v[168:171],v17 offset:20480
v_mfma_f32_16x16x32_bf16 v[68:71],a[236:239],v[236:239],v[68:71]
s_waitcnt lgkmcnt(9)
v_mfma_f32_16x16x32_bf16 v[64:67],a[112:115],v[240:243],v[64:67]
ds_read_b128 v[172:175],v17 offset:22528
v_min3_u32 v27,v27,v240,v244
v_mfma_f32_16x16x32_bf16 v[68:71],a[240:243],v[240:243],v[68:71]
v_mfma_f32_16x16x32_bf16 v[64:67],a[116:119],v[244:247],v[64:67]
ds_read_b128 v[176:179],v17 offset:24576
ds_read_b128 v[180:183],v17 offset:26624
v_mfma_f32_16x16x32_bf16 v[68:71],a[244:247],v[244:247],v[68:71]
s_waitcnt lgkmcnt(7)
v_mfma_f32_16x16x32_bf16 v[64:67],a[120:123],v[248:251],v[64:67]
ds_read_b128 v[184:187],v17 offset:28672
v_min3_u32 v27,v27,v248,v252
v_mfma_f32_16x16x32_bf16 v[68:71],a[248:251],v[248:251],v[68:71]
v_mfma_f32_16x16x32_bf16 v[64:67],a[124:127],v[252:255],v[64:67]
ds_read_b128 v[188:191],v17 offset:30720
v_mfma_f32_16x16x32_bf16 v[68:71],a[252:255],v[252:255],v[68:71]
v_mfma_f32_16x16x32_bf16 v[72:75],a[128:131],v[128:131],0
v_cmp_eq_u32 vcc,0,v27
s_cbranch_vccnz retry_289
v_mfma_f32_16x16x32_bf16 v[76:79],a[132:135],v[132:135],0
v_min3_u32 v27,v27,v128,v132
v_mfma_f32_16x16x32_bf16 v[72:75],a[136:139],v[136:139],v[72:75]
s_waitcnt vmcnt(1)
s_barrier
ds_read_b128 v[192:195],v17 offset:32768
v_mfma_f32_16x16x32_bf16 v[76:79],a[140:143],v[140:143],v[76:79]
ds_read_b128 v[196:199],v17 offset:34816
s_waitcnt lgkmcnt(10)
v_mfma_f32_16x16x32_bf16 v[72:75],a[144:147],v[144:147],v[72:75]
ds_read_b128 v[200:203],v17 offset:36864
v_min3_u32 v27,v27,v136,v140
s_waitcnt vmcnt(0)
v_mfma_f32_16x16x32_bf16 v[76:79],a[148:151],v[148:151],v[76:79]
ds_read_b128 v[204:207],v17 offset:38912
v_min3_u32 v27,v27,v144,v148
v_and_or_b32 v64,v64,-4,s48
v_mfma_f32_16x16x32_bf16 v[72:75],a[152:155],v[152:155],v[72:75]
ds_read_b128 v[208:211],v17 offset:40960
s_add_u32 s64,s49,s34
v_mfma_f32_16x16x32_bf16 v[76:79],a[156:159],v[156:159],v[76:79]
v_min3_u32 v27,v27,v152,v156
s_waitcnt lgkmcnt(9)
v_mfma_f32_16x16x32_bf16 v[72:75],a[160:163],v[160:163],v[72:75]
ds_read_b128 v[212:215],v17 offset:43008
buffer_store_dwordx4 v[64:67],v25,s[20:23],s64 offen offset:2048
v_mfma_f32_16x16x32_bf16 v[76:79],a[164:167],v[164:167],v[76:79]
ds_read_b128 v[216:219],v17 offset:45056
v_min3_u32 v27,v27,v160,v164
v_and_or_b32 v68,v68,-4,s48
v_mfma_f32_16x16x32_bf16 v[72:75],a[168:171],v[168:171],v[72:75]
ds_read_b128 v[220:223],v17 offset:47104
s_add_u32 s64,s49,s35
v_mfma_f32_16x16x32_bf16 v[76:79],a[172:175],v[172:175],v[76:79]
ds_read_b128 v[224:227],v17 offset:49152
s_waitcnt lgkmcnt(9)
v_mfma_f32_16x16x32_bf16 v[72:75],a[176:179],v[176:179],v[72:75]
ds_read_b128 v[228:231],v17 offset:51200
v_min3_u32 v27,v27,v168,v172
v_mfma_f32_16x16x32_bf16 v[76:79],a[180:183],v[180:183],v[76:79]
v_min3_u32 v27,v27,v176,v180
buffer_store_dwordx4 v[68:71],v25,s[20:23],s64 offen offset:3072
v_mfma_f32_16x16x32_bf16 v[72:75],a[184:187],v[184:187],v[72:75]
ds_read_b128 v[232:235],v17 offset:53248
s_mov_b32 s49,0x7fff0000
v_mfma_f32_16x16x32_bf16 v[76:79],a[188:191],v[188:191],v[76:79]
ds_read_b128 v[236:239],v17 offset:55296
s_waitcnt lgkmcnt(8)
v_mfma_f32_16x16x32_bf16 v[72:75],a[192:195],v[192:195],v[72:75]
ds_read_b128 v[240:243],v17 offset:57344
v_min3_u32 v27,v27,v184,v188
v_mfma_f32_16x16x32_bf16 v[76:79],a[196:199],v[196:199],v[76:79]
ds_read_b128 v[244:247],v17 offset:59392
v_min3_u32 v27,v27,v192,v196
v_mfma_f32_16x16x32_bf16 v[72:75],a[200:203],v[200:203],v[72:75]
ds_read_b128 v[248:251],v17 offset:61440
ds_bpermute_b32 v124,v41,v120
v_mfma_f32_16x16x32_bf16 v[76:79],a[204:207],v[204:207],v[76:79]
v_min3_u32 v27,v27,v200,v204
s_waitcnt lgkmcnt(8)
v_mfma_f32_16x16x32_bf16 v[72:75],a[208:211],v[208:211],v[72:75]
ds_read_b128 v[252:255],v17 offset:63488
ds_bpermute_b32 v125,v41,v121
v_mfma_f32_16x16x32_bf16 v[76:79],a[212:215],v[212:215],v[76:79]
v_min3_u32 v27,v27,v208,v212
v_mfma_f32_16x16x32_bf16 v[72:75],a[216:219],v[216:219],v[72:75]
v_mfma_f32_16x16x32_bf16 v[76:79],a[220:223],v[220:223],v[76:79]
v_min3_u32 v27,v27,v216,v220
s_waitcnt lgkmcnt(6)
v_mfma_f32_16x16x32_bf16 v[72:75],a[224:227],v[224:227],v[72:75]
s_waitcnt lgkmcnt(0)
v_mfma_f32_16x16x32_bf16 v[76:79],a[228:231],v[228:231],v[76:79]
v_min3_u32 v27,v27,v224,v228
v_mfma_f32_16x16x32_bf16 v[72:75],a[232:235],v[232:235],v[72:75]
v_lshlrev_b32 v104,16,v124
v_mfma_f32_16x16x32_bf16 v[76:79],a[236:239],v[236:239],v[76:79]
v_min3_u32 v27,v27,v232,v236
v_mfma_f32_16x16x32_bf16 v[72:75],a[240:243],v[240:243],v[72:75]
v_mfma_f32_16x16x32_bf16 v[76:79],a[244:247],v[244:247],v[76:79]
v_min3_u32 v27,v27,v240,v244
v_mfma_f32_16x16x32_bf16 v[72:75],a[248:251],v[248:251],v[72:75]
v_and_b32 v105,s80,v124
v_mfma_f32_16x16x32_bf16 v[76:79],a[252:255],v[252:255],v[76:79]
v_min3_u32 v27,v27,v248,v252
v_mfma_f32_16x16x32_bf16 v[80:83],a[0:3],v[128:131],0
v_cmp_eq_u32 vcc,0,v27
s_cbranch_vccnz retry_289
v_mfma_f32_16x16x32_bf16 v[84:87],a[4:7],v[132:135],0
v_lshlrev_b32 v106,16,v125
v_mfma_f32_16x16x32_bf16 v[80:83],a[8:11],v[136:139],v[80:83]
v_mfma_f32_16x16x32_bf16 v[84:87],a[12:15],v[140:143],v[84:87]
v_mfma_f32_16x16x32_bf16 v[80:83],a[16:19],v[144:147],v[80:83]
v_and_b32 v107,s80,v125
v_add_f32 v72,v72,v76
v_mfma_f32_16x16x32_bf16 v[84:87],a[20:23],v[148:151],v[84:87]
v_add_f32 v73,v73,v77
v_add_f32 v74,v74,v78
v_mfma_f32_16x16x32_bf16 v[80:83],a[24:27],v[152:155],v[80:83]
v_add_f32 v75,v75,v79
v_and_or_b32 v72,v72,-4,s48
v_mfma_f32_16x16x32_bf16 v[84:87],a[28:31],v[156:159],v[84:87]
s_add_u32 s64,s77,s33
v_mfma_f32_16x16x32_bf16 v[80:83],a[32:35],v[160:163],v[80:83]
buffer_store_dwordx4 v[72:75],v25,s[20:23],s64 offen offset:1024
v_mfma_f32_16x16x32_bf16 v[84:87],a[36:39],v[164:167],v[84:87]
v_mfma_f32_16x16x32_bf16 v[80:83],a[40:43],v[168:171],v[80:83]
v_mfma_f32_16x16x32_bf16 v[84:87],a[44:47],v[172:175],v[84:87]
v_mfma_f32_16x16x32_bf16 v[80:83],a[48:51],v[176:179],v[80:83]
v_mfma_f32_16x16x32_bf16 v[84:87],a[52:55],v[180:183],v[84:87]
v_mfma_f32_16x16x32_bf16 v[80:83],a[56:59],v[184:187],v[80:83]
v_mfma_f32_16x16x32_bf16 v[84:87],a[60:63],v[188:191],v[84:87]
v_mfma_f32_16x16x32_bf16 v[80:83],a[64:67],v[192:195],v[80:83]
buffer_load_dwordx4 v[96:99],v26,s[20:23],s77 offen offset:2048 sc1
v_mfma_f32_16x16x32_bf16 v[84:87],a[68:71],v[196:199],v[84:87]
buffer_load_dwordx4 v[100:103],v26,s[20:23],s77 offen offset:3072 sc1
v_mfma_f32_16x16x32_bf16 v[80:83],a[72:75],v[200:203],v[80:83]
v_mfma_f32_16x16x32_bf16 v[84:87],a[76:79],v[204:207],v[84:87]
v_mfma_f32_16x16x32_bf16 v[80:83],a[80:83],v[208:211],v[80:83]
v_mfma_f32_16x16x32_bf16 v[84:87],a[84:87],v[212:215],v[84:87]
v_mfma_f32_16x16x32_bf16 v[80:83],a[88:91],v[216:219],v[80:83]
v_mfma_f32_16x16x32_bf16 v[84:87],a[92:95],v[220:223],v[84:87]
v_mfma_f32_16x16x32_bf16 v[80:83],a[96:99],v[224:227],v[80:83]
v_mfma_f32_16x16x32_bf16 v[84:87],a[100:103],v[228:231],v[84:87]
v_mfma_f32_16x16x32_bf16 v[80:83],a[104:107],v[232:235],v[80:83]
buffer_load_dwordx4 v[92:95],v26,s[20:23],s77 offen offset:1024 sc1
v_mfma_f32_16x16x32_bf16 v[84:87],a[108:111],v[236:239],v[84:87]
v_mfma_f32_16x16x32_bf16 v[80:83],a[112:115],v[240:243],v[80:83]
v_mfma_f32_16x16x32_bf16 v[84:87],a[116:119],v[244:247],v[84:87]
v_mfma_f32_16x16x32_bf16 v[80:83],a[120:123],v[248:251],v[80:83]
v_mfma_f32_16x16x32_bf16 v[84:87],a[124:127],v[252:255],v[84:87]
s_branch epi_292
keep_300:
v_mfma_f32_16x16x32_bf16 v[68:71],a[228:231],v[228:231],v[68:71]
s_xor_b32 m0,s72,0
s_waitcnt lgkmcnt(10)
v_mfma_f32_16x16x32_bf16 v[64:67],a[104:107],v[232:235],v[64:67]
ds_read_b128 v[160:163],v17 offset:16384
ds_read_b128 v[164:167],v17 offset:18432
s_add_u32 s65,s88,0
v_mfma_f32_16x16x32_bf16 v[68:71],a[232:235],v[232:235],v[68:71]
buffer_load_dwordx4 v16,s[20:23],s65 offen offset:0 sc1 lds
v_min3_u32 v27,v27,v232,v236
v_mfma_f32_16x16x32_bf16 v[64:67],a[108:111],v[236:239],v[64:67]
ds_read_b128 v[168:171],v17 offset:20480
buffer_load_dwordx4 v16,s[20:23],s65 offen offset:2048 sc1 lds
v_mfma_f32_16x16x32_bf16 v[68:71],a[236:239],v[236:239],v[68:71]
s_xor_b32 m0,s72,16384
s_waitcnt lgkmcnt(9)
v_mfma_f32_16x16x32_bf16 v[64:67],a[112:115],v[240:243],v[64:67]
ds_read_b128 v[172:175],v17 offset:22528
v_min3_u32 v27,v27,v240,v244
v_mfma_f32_16x16x32_bf16 v[68:71],a[240:243],v[240:243],v[68:71]
s_add_u32 s65,s88,32768
v_mfma_f32_16x16x32_bf16 v[64:67],a[116:119],v[244:247],v[64:67]
ds_read_b128 v[176:179],v17 offset:24576
ds_read_b128 v[180:183],v17 offset:26624
v_mfma_f32_16x16x32_bf16 v[68:71],a[244:247],v[244:247],v[68:71]
buffer_load_dwordx4 v16,s[20:23],s65 offen offset:0 sc1 lds
s_waitcnt lgkmcnt(7)
v_mfma_f32_16x16x32_bf16 v[64:67],a[120:123],v[248:251],v[64:67]
ds_read_b128 v[184:187],v17 offset:28672
buffer_load_dwordx4 v16,s[20:23],s65 offen offset:2048 sc1 lds
v_mfma_f32_16x16x32_bf16 v[68:71],a[248:251],v[248:251],v[68:71]
s_xor_b32 m0,s72,32768
s_add_u32 s65,s88,65536
v_mfma_f32_16x16x32_bf16 v[64:67],a[124:127],v[252:255],v[64:67]
ds_read_b128 v[188:191],v17 offset:30720
v_min3_u32 v27,v27,v248,v252
v_mfma_f32_16x16x32_bf16 v[68:71],a[252:255],v[252:255],v[68:71]
buffer_load_dwordx4 v16,s[20:23],s65 offen offset:0 sc1 lds
v_mfma_f32_16x16x32_bf16 v[72:75],a[128:131],v[128:131],0
buffer_load_dwordx4 v16,s[20:23],s65 offen offset:2048 sc1 lds
v_mfma_f32_16x16x32_bf16 v[76:79],a[132:135],v[132:135],0
s_xor_b32 m0,s72,49152
v_cmp_eq_u32 vcc,0,v27
s_cbranch_vccnz retry_289
v_mfma_f32_16x16x32_bf16 v[72:75],a[136:139],v[136:139],v[72:75]
s_waitcnt vmcnt(7)
s_barrier
ds_read_b128 v[192:195],v17 offset:32768
v_mfma_f32_16x16x32_bf16 v[76:79],a[140:143],v[140:143],v[76:79]
ds_read_b128 v[196:199],v17 offset:34816
s_add_u32 s65,s88,98304
s_waitcnt lgkmcnt(10)
v_mfma_f32_16x16x32_bf16 v[72:75],a[144:147],v[144:147],v[72:75]
ds_read_b128 v[200:203],v17 offset:36864
buffer_load_dwordx4 v16,s[20:23],s65 offen offset:0 sc1 lds
s_waitcnt vmcnt(7)
v_mfma_f32_16x16x32_bf16 v[76:79],a[148:151],v[148:151],v[76:79]
ds_read_b128 v[204:207],v17 offset:38912
buffer_load_dwordx4 v16,s[20:23],s65 offen offset:2048 sc1 lds
v_and_or_b32 v64,v64,-4,s48
v_mfma_f32_16x16x32_bf16 v[72:75],a[152:155],v[152:155],v[72:75]
ds_read_b128 v[208:211],v17 offset:40960
s_xor_b32 m0,s72,1024
s_add_u32 s64,s49,s34
v_mfma_f32_16x16x32_bf16 v[76:79],a[156:159],v[156:159],v[76:79]
s_add_u32 s65,s89,0
buffer_store_dwordx4 v[64:67],v25,s[20:23],s64 offen offset:2048
s_waitcnt lgkmcnt(9)
v_mfma_f32_16x16x32_bf16 v[72:75],a[160:163],v[160:163],v[72:75]
ds_read_b128 v[212:215],v17 offset:43008
buffer_load_dwordx4 v16,s[20:23],s65 offen offset:0 sc1 lds
v_and_or_b32 v68,v68,-4,s48
v_mfma_f32_16x16x32_bf16 v[76:79],a[164:167],v[164:167],v[76:79]
ds_read_b128 v[216:219],v17 offset:45056
v_min3_u32 v27,v27,v128,v132
s_add_u32 s64,s49,s35
v_mfma_f32_16x16x32_bf16 v[72:75],a[168:171],v[168:171],v[72:75]
ds_read_b128 v[220:223],v17 offset:47104
buffer_load_dwordx4 v16,s[20:23],s65 offen offset:2048 sc1 lds
v_mfma_f32_16x16x32_bf16 v[76:79],a[172:175],v[172:175],v[76:79]
ds_read_b128 v[224:227],v17 offset:49152
s_xor_b32 m0,s72,17408
s_waitcnt lgkmcnt(9)
v_mfma_f32_16x16x32_bf16 v[72:75],a[176:179],v[176:179],v[72:75]
ds_read_b128 v[228:231],v17 offset:51200
s_add_u32 s65,s89,32768
buffer_store_dwordx4 v[68:71],v25,s[20:23],s64 offen offset:3072
v_mfma_f32_16x16x32_bf16 v[76:79],a[180:183],v[180:183],v[76:79]
buffer_load_dwordx4 v16,s[20:23],s65 offen offset:0 sc1 lds
s_mov_b32 s49,0x7fff0000
v_mfma_f32_16x16x32_bf16 v[72:75],a[184:187],v[184:187],v[72:75]
ds_read_b128 v[232:235],v17 offset:53248
v_min3_u32 v27,v27,v136,v140
v_mfma_f32_16x16x32_bf16 v[76:79],a[188:191],v[188:191],v[76:79]
ds_read_b128 v[236:239],v17 offset:55296
s_waitcnt lgkmcnt(8)
v_mfma_f32_16x16x32_bf16 v[72:75],a[192:195],v[192:195],v[72:75]
ds_read_b128 v[240:243],v17 offset:57344
buffer_load_dwordx4 v16,s[20:23],s65 offen offset:2048 sc1 lds
v_mfma_f32_16x16x32_bf16 v[76:79],a[196:199],v[196:199],v[76:79]
ds_read_b128 v[244:247],v17 offset:59392
s_xor_b32 m0,s72,33792
v_mfma_f32_16x16x32_bf16 v[72:75],a[200:203],v[200:203],v[72:75]
ds_read_b128 v[248:251],v17 offset:61440
s_add_u32 s65,s89,65536
v_mfma_f32_16x16x32_bf16 v[76:79],a[204:207],v[204:207],v[76:79]
v_min3_u32 v27,v27,v144,v148
s_waitcnt lgkmcnt(7)
v_mfma_f32_16x16x32_bf16 v[72:75],a[208:211],v[208:211],v[72:75]
ds_read_b128 v[252:255],v17 offset:63488
v_min3_u32 v27,v27,v152,v156
v_mfma_f32_16x16x32_bf16 v[76:79],a[212:215],v[212:215],v[76:79]
buffer_load_dwordx4 v16,s[20:23],s65 offen offset:0 sc1 lds
v_mfma_f32_16x16x32_bf16 v[72:75],a[216:219],v[216:219],v[72:75]
buffer_load_dwordx4 v16,s[20:23],s65 offen offset:2048 sc1 lds
v_mfma_f32_16x16x32_bf16 v[76:79],a[220:223],v[220:223],v[76:79]
s_xor_b32 m0,s72,50176
s_waitcnt lgkmcnt(4)
v_mfma_f32_16x16x32_bf16 v[72:75],a[224:227],v[224:227],v[72:75]
s_add_u32 s65,s89,98304
v_min3_u32 v27,v27,v160,v164
v_mfma_f32_16x16x32_bf16 v[76:79],a[228:231],v[228:231],v[76:79]
buffer_load_dwordx4 v16,s[20:23],s65 offen offset:0 sc1 lds
v_mfma_f32_16x16x32_bf16 v[72:75],a[232:235],v[232:235],v[72:75]
buffer_load_dwordx4 v16,s[20:23],s65 offen offset:2048 sc1 lds
v_mfma_f32_16x16x32_bf16 v[76:79],a[236:239],v[236:239],v[76:79]
v_min3_u32 v27,v27,v168,v172
s_waitcnt lgkmcnt(0)
v_mfma_f32_16x16x32_bf16 v[72:75],a[240:243],v[240:243],v[72:75]
v_min3_u32 v27,v27,v176,v180
v_min3_u32 v27,v27,v184,v188
v_mfma_f32_16x16x32_bf16 v[76:79],a[244:247],v[244:247],v[76:79]
v_min3_u32 v27,v27,v192,v196
v_min3_u32 v27,v27,v200,v204
v_min3_u32 v27,v27,v240,v244
v_mfma_f32_16x16x32_bf16 v[72:75],a[248:251],v[248:251],v[72:75]
v_min3_u32 v27,v27,v208,v212
v_min3_u32 v27,v27,v216,v220
v_mfma_f32_16x16x32_bf16 v[76:79],a[252:255],v[252:255],v[76:79]
v_min3_u32 v27,v27,v224,v228
v_min3_u32 v27,v27,v232,v236
v_min3_u32 v27,v27,v248,v252
v_mfma_f32_16x16x32_bf16 v[80:83],a[0:3],v[128:131],0
v_cmp_eq_u32 vcc,0,v27
s_cbranch_vccnz retry_289
v_mfma_f32_16x16x32_bf16 v[84:87],a[4:7],v[132:135],0
ds_bpermute_b32 v124,v41,v120
ds_bpermute_b32 v125,v41,v121
v_mfma_f32_16x16x32_bf16 v[80:83],a[8:11],v[136:139],v[80:83]
s_waitcnt lgkmcnt(0)
v_lshlrev_b32 v104,16,v124
v_mfma_f32_16x16x32_bf16 v[84:87],a[12:15],v[140:143],v[84:87]
v_and_b32 v105,s80,v124
v_lshlrev_b32 v106,16,v125
v_mfma_f32_16x16x32_bf16 v[80:83],a[16:19],v[144:147],v[80:83]
v_and_b32 v107,s80,v125
v_add_f32 v72,v72,v76
v_mfma_f32_16x16x32_bf16 v[84:87],a[20:23],v[148:151],v[84:87]
v_add_f32 v73,v73,v77
v_add_f32 v74,v74,v78
v_mfma_f32_16x16x32_bf16 v[80:83],a[24:27],v[152:155],v[80:83]
v_add_f32 v75,v75,v79
v_and_or_b32 v72,v72,-4,s48
v_mfma_f32_16x16x32_bf16 v[84:87],a[28:31],v[156:159],v[84:87]
s_add_u32 s64,s77,s33
v_mfma_f32_16x16x32_bf16 v[80:83],a[32:35],v[160:163],v[80:83]
buffer_store_dwordx4 v[72:75],v25,s[20:23],s64 offen offset:1024
v_mfma_f32_16x16x32_bf16 v[84:87],a[36:39],v[164:167],v[84:87]
v_mfma_f32_16x16x32_bf16 v[80:83],a[40:43],v[168:171],v[80:83]
v_mfma_f32_16x16x32_bf16 v[84:87],a[44:47],v[172:175],v[84:87]
v_mfma_f32_16x16x32_bf16 v[80:83],a[48:51],v[176:179],v[80:83]
v_mfma_f32_16x16x32_bf16 v[84:87],a[52:55],v[180:183],v[84:87]
v_mfma_f32_16x16x32_bf16 v[80:83],a[56:59],v[184:187],v[80:83]
v_mfma_f32_16x16x32_bf16 v[84:87],a[60:63],v[188:191],v[84:87]
v_mfma_f32_16x16x32_bf16 v[80:83],a[64:67],v[192:195],v[80:83]
buffer_load_dwordx4 v[96:99],v26,s[20:23],s77 offen offset:2048 sc1
v_mfma_f32_16x16x32_bf16 v[84:87],a[68:71],v[196:199],v[84:87]
buffer_load_dwordx4 v[100:103],v26,s[20:23],s77 offen offset:3072 sc1
v_mfma_f32_16x16x32_bf16 v[80:83],a[72:75],v[200:203],v[80:83]
v_mfma_f32_16x16x32_bf16 v[84:87],a[76:79],v[204:207],v[84:87]
v_mfma_f32_16x16x32_bf16 v[80:83],a[80:83],v[208:211],v[80:83]
v_mfma_f32_16x16x32_bf16 v[84:87],a[84:87],v[212:215],v[84:87]
v_mfma_f32_16x16x32_bf16 v[80:83],a[88:91],v[216:219],v[80:83]
v_mfma_f32_16x16x32_bf16 v[84:87],a[92:95],v[220:223],v[84:87]
v_mfma_f32_16x16x32_bf16 v[80:83],a[96:99],v[224:227],v[80:83]
v_mfma_f32_16x16x32_bf16 v[84:87],a[100:103],v[228:231],v[84:87]
v_mfma_f32_16x16x32_bf16 v[80:83],a[104:107],v[232:235],v[80:83]
buffer_load_dwordx4 v[92:95],v26,s[20:23],s77 offen offset:1024 sc1
v_mfma_f32_16x16x32_bf16 v[84:87],a[108:111],v[236:239],v[84:87]
v_mfma_f32_16x16x32_bf16 v[80:83],a[112:115],v[240:243],v[80:83]
v_mfma_f32_16x16x32_bf16 v[84:87],a[116:119],v[244:247],v[84:87]
v_mfma_f32_16x16x32_bf16 v[80:83],a[120:123],v[248:251],v[80:83]
v_mfma_f32_16x16x32_bf16 v[84:87],a[124:127],v[252:255],v[84:87]
s_branch epi_292
ahead_291:
s_cmp_eq_u32 s93,0
s_cbranch_scc1 both_293
s_waitcnt vmcnt(15) lgkmcnt(0)
s_barrier
ds_read_b128 v[224:227],v18 offset:0
ds_read_b128 v[228:231],v18 offset:2048
ds_read_b128 v[232:235],v18 offset:4096
ds_read_b128 v[236:239],v18 offset:6144
ds_read_b128 v[240:243],v18 offset:8192
ds_read_b128 v[244:247],v18 offset:10240
ds_read_b128 v[248:251],v18 offset:12288
s_waitcnt lgkmcnt(5)
v_mfma_f32_16x16x32_bf16 v[64:67],a[0:3],v[224:227],0
s_add_u32 s96,s71,1
s_add_u32 s92,s71,2
v_mfma_f32_16x16x32_bf16 v[68:71],a[128:131],v[224:227],0
ds_read_b128 v[252:255],v18 offset:14336
v_min_u32 v27,v224,v228
v_mfma_f32_16x16x32_bf16 v[64:67],a[4:7],v[228:231],v[64:67]
buffer_load_dwordx2 v[120:121],v20,s[36:39],s78 offen
v_mfma_f32_16x16x32_bf16 v[68:71],a[132:135],v[228:231],v[68:71]
ds_read_b128 v[224:227],v18 offset:16384
s_waitcnt lgkmcnt(5)
v_mfma_f32_16x16x32_bf16 v[64:67],a[8:11],v[232:235],v[64:67]
v_min3_u32 v27,v27,v232,v236
v_mfma_f32_16x16x32_bf16 v[68:71],a[136:139],v[232:235],v[68:71]
ds_read_b128 v[228:231],v18 offset:18432
v_mfma_f32_16x16x32_bf16 v[64:67],a[12:15],v[236:239],v[64:67]
v_mfma_f32_16x16x32_bf16 v[68:71],a[140:143],v[236:239],v[68:71]
ds_read_b128 v[232:235],v18 offset:20480
s_waitcnt lgkmcnt(5)
v_mfma_f32_16x16x32_bf16 v[64:67],a[16:19],v[240:243],v[64:67]
v_min3_u32 v27,v27,v240,v244
v_mfma_f32_16x16x32_bf16 v[68:71],a[144:147],v[240:243],v[68:71]
ds_read_b128 v[236:239],v18 offset:22528
v_mfma_f32_16x16x32_bf16 v[64:67],a[20:23],v[244:247],v[64:67]
v_mfma_f32_16x16x32_bf16 v[68:71],a[148:151],v[244:247],v[68:71]
ds_read_b128 v[240:243],v18 offset:24576
s_waitcnt lgkmcnt(5)
v_mfma_f32_16x16x32_bf16 v[64:67],a[24:27],v[248:251],v[64:67]
v_min3_u32 v27,v27,v248,v252
v_mfma_f32_16x16x32_bf16 v[68:71],a[152:155],v[248:251],v[68:71]
ds_read_b128 v[244:247],v18 offset:26624
v_mfma_f32_16x16x32_bf16 v[64:67],a[28:31],v[252:255],v[64:67]
v_mfma_f32_16x16x32_bf16 v[68:71],a[156:159],v[252:255],v[68:71]
ds_read_b128 v[248:251],v18 offset:28672
s_waitcnt lgkmcnt(5)
v_mfma_f32_16x16x32_bf16 v[64:67],a[32:35],v[224:227],v[64:67]
v_min3_u32 v27,v27,v224,v228
v_mfma_f32_16x16x32_bf16 v[68:71],a[160:163],v[224:227],v[68:71]
ds_read_b128 v[252:255],v18 offset:30720
v_mfma_f32_16x16x32_bf16 v[64:67],a[36:39],v[228:231],v[64:67]
s_waitcnt vmcnt(3)
v_mfma_f32_16x16x32_bf16 v[68:71],a[164:167],v[228:231],v[68:71]
ds_read_b128 v[224:227],v18 offset:32768
s_waitcnt lgkmcnt(5)
v_mfma_f32_16x16x32_bf16 v[64:67],a[40:43],v[232:235],v[64:67]
v_cmp_gt_u32 vcc,s96,v29
v_cmp_gt_u32 s[92:93],s92,v29
v_mfma_f32_16x16x32_bf16 v[68:71],a[168:171],v[232:235],v[68:71]
ds_read_b128 v[228:231],v18 offset:34816
v_min3_u32 v27,v27,v232,v236
v_mfma_f32_16x16x32_bf16 v[64:67],a[44:47],v[236:239],v[64:67]
v_mov_b32 v44,vcc_lo
v_mov_b32 v45,s92
v_mfma_f32_16x16x32_bf16 v[68:71],a[172:175],v[236:239],v[68:71]
ds_read_b128 v[232:235],v18 offset:36864
s_waitcnt lgkmcnt(5)
v_mfma_f32_16x16x32_bf16 v[64:67],a[48:51],v[240:243],v[64:67]
ds_write_b64 v46,v[44:45]
v_min3_u32 v27,v27,v240,v244
v_mfma_f32_16x16x32_bf16 v[68:71],a[176:179],v[240:243],v[68:71]
ds_read_b128 v[236:239],v18 offset:38912
v_mfma_f32_16x16x32_bf16 v[64:67],a[52:55],v[244:247],v[64:67]
v_mfma_f32_16x16x32_bf16 v[68:71],a[180:183],v[244:247],v[68:71]
ds_read_b128 v[240:243],v18 offset:40960
s_waitcnt lgkmcnt(6)
v_mfma_f32_16x16x32_bf16 v[64:67],a[56:59],v[248:251],v[64:67]
v_min3_u32 v27,v27,v248,v252
s_add_u32 s88,s70,s75
v_mfma_f32_16x16x32_bf16 v[68:71],a[184:187],v[248:251],v[68:71]
ds_read_b128 v[244:247],v18 offset:43008
s_add_u32 s88,s88,2097152
v_mfma_f32_16x16x32_bf16 v[64:67],a[60:63],v[252:255],v[64:67]
s_xor_b32 s88,s88,0x2000
s_xor_b32 s89,s88,1024
v_mfma_f32_16x16x32_bf16 v[68:71],a[188:191],v[252:255],v[68:71]
ds_read_b128 v[248:251],v18 offset:45056
s_waitcnt lgkmcnt(6)
v_mfma_f32_16x16x32_bf16 v[64:67],a[64:67],v[224:227],v[64:67]
v_min3_u32 v27,v27,v224,v228
v_mfma_f32_16x16x32_bf16 v[68:71],a[192:195],v[224:227],v[68:71]
ds_read_b128 v[252:255],v18 offset:47104
v_mfma_f32_16x16x32_bf16 v[64:67],a[68:71],v[228:231],v[64:67]
v_mfma_f32_16x16x32_bf16 v[68:71],a[196:199],v[228:231],v[68:71]
ds_read_b128 v[224:227],v18 offset:49152
s_waitcnt lgkmcnt(5)
v_mfma_f32_16x16x32_bf16 v[64:67],a[72:75],v[232:235],v[64:67]
v_min3_u32 v27,v27,v232,v236
v_mfma_f32_16x16x32_bf16 v[68:71],a[200:203],v[232:235],v[68:71]
ds_read_b128 v[228:231],v18 offset:51200
v_mfma_f32_16x16x32_bf16 v[64:67],a[76:79],v[236:239],v[64:67]
v_mfma_f32_16x16x32_bf16 v[68:71],a[204:207],v[236:239],v[68:71]
ds_read_b128 v[232:235],v18 offset:53248
s_waitcnt lgkmcnt(5)
v_mfma_f32_16x16x32_bf16 v[64:67],a[80:83],v[240:243],v[64:67]
s_waitcnt vmcnt(8)
s_barrier
ds_read_b64 v[44:45],v47
ds_read_b128 v[128:131],v17 offset:0
ds_read_b128 v[132:135],v17 offset:2048
v_mfma_f32_16x16x32_bf16 v[68:71],a[208:211],v[240:243],v[68:71]
ds_read_b128 v[236:239],v18 offset:55296
v_min3_u32 v27,v27,v240,v244
v_mfma_f32_16x16x32_bf16 v[64:67],a[84:87],v[244:247],v[64:67]
ds_read_b128 v[136:139],v17 offset:4096
v_mfma_f32_16x16x32_bf16 v[68:71],a[212:215],v[244:247],v[68:71]
ds_read_b128 v[240:243],v18 offset:57344
s_waitcnt lgkmcnt(9)
v_mfma_f32_16x16x32_bf16 v[64:67],a[88:91],v[248:251],v[64:67]
ds_read_b128 v[140:143],v17 offset:6144
v_min3_u32 v27,v27,v248,v252
v_mfma_f32_16x16x32_bf16 v[68:71],a[216:219],v[248:251],v[68:71]
ds_read_b128 v[244:247],v18 offset:59392
v_mfma_f32_16x16x32_bf16 v[64:67],a[92:95],v[252:255],v[64:67]
ds_read_b128 v[144:147],v17 offset:8192
ds_read_b128 v[148:151],v17 offset:10240
v_mfma_f32_16x16x32_bf16 v[68:71],a[220:223],v[252:255],v[68:71]
ds_read_b128 v[248:251],v18 offset:61440
s_waitcnt lgkmcnt(12)
v_mfma_f32_16x16x32_bf16 v[64:67],a[96:99],v[224:227],v[64:67]
ds_read_b128 v[152:155],v17 offset:12288
s_waitcnt lgkmcnt(11)
v_min3_u32 v27,v27,v224,v228
v_mfma_f32_16x16x32_bf16 v[68:71],a[224:227],v[224:227],v[68:71]
ds_read_b128 v[252:255],v18 offset:63488
v_readfirstlane_b32 s93,v45
v_mfma_f32_16x16x32_bf16 v[64:67],a[100:103],v[228:231],v[64:67]
ds_read_b128 v[156:159],v17 offset:14336
v_readfirstlane_b32 s83,v44
s_cmp_lg_u32 s83,0
s_cbranch_scc1 keep_301
v_mfma_f32_16x16x32_bf16 v[68:71],a[228:231],v[228:231],v[68:71]
s_waitcnt vmcnt(1)
s_xor_b32 m0,s72,0
s_waitcnt lgkmcnt(10)
v_mfma_f32_16x16x32_bf16 v[64:67],a[104:107],v[232:235],v[64:67]
ds_read_b128 v[160:163],v17 offset:16384
ds_read_b128 v[164:167],v17 offset:18432
s_add_u32 s65,s88,0
v_min3_u32 v27,v27,v232,v236
v_mfma_f32_16x16x32_bf16 v[68:71],a[232:235],v[232:235],v[68:71]
v_add_u32 v22,s71,-1
buffer_load_dwordx4 v16,s[20:23],s65 offen offset:0 sc1 lds
v_mfma_f32_16x16x32_bf16 v[64:67],a[108:111],v[236:239],v[64:67]
ds_read_b128 v[168:171],v17 offset:20480
buffer_load_dwordx4 v16,s[20:23],s65 offen offset:2048 sc1 lds
v_mfma_f32_16x16x32_bf16 v[68:71],a[236:239],v[236:239],v[68:71]
s_xor_b32 m0,s72,16384
s_waitcnt lgkmcnt(9)
v_mfma_f32_16x16x32_bf16 v[64:67],a[112:115],v[240:243],v[64:67]
ds_read_b128 v[172:175],v17 offset:22528
v_min3_u32 v27,v27,v240,v244
v_mfma_f32_16x16x32_bf16 v[68:71],a[240:243],v[240:243],v[68:71]
buffer_store_dword v22,v23,s[20:23],s97 offen sc1
s_add_u32 s65,s88,32768
v_mfma_f32_16x16x32_bf16 v[64:67],a[116:119],v[244:247],v[64:67]
ds_read_b128 v[176:179],v17 offset:24576
ds_read_b128 v[180:183],v17 offset:26624
v_mfma_f32_16x16x32_bf16 v[68:71],a[244:247],v[244:247],v[68:71]
s_mov_b32 s97,0x7fff0000
s_waitcnt lgkmcnt(7)
v_mfma_f32_16x16x32_bf16 v[64:67],a[120:123],v[248:251],v[64:67]
ds_read_b128 v[184:187],v17 offset:28672
buffer_load_dwordx4 v16,s[20:23],s65 offen offset:0 sc1 lds
v_mfma_f32_16x16x32_bf16 v[68:71],a[248:251],v[248:251],v[68:71]
buffer_load_dwordx4 v16,s[20:23],s65 offen offset:2048 sc1 lds
s_xor_b32 m0,s72,32768
v_mfma_f32_16x16x32_bf16 v[64:67],a[124:127],v[252:255],v[64:67]
ds_read_b128 v[188:191],v17 offset:30720
s_add_u32 s65,s88,65536
v_min3_u32 v27,v27,v248,v252
v_mfma_f32_16x16x32_bf16 v[68:71],a[252:255],v[252:255],v[68:71]
buffer_load_dwordx4 v16,s[20:23],s65 offen offset:0 sc1 lds
v_mfma_f32_16x16x32_bf16 v[72:75],a[128:131],v[128:131],0
buffer_load_dwordx4 v16,s[20:23],s65 offen offset:2048 sc1 lds
v_mfma_f32_16x16x32_bf16 v[76:79],a[132:135],v[132:135],0
s_xor_b32 m0,s72,49152
v_cmp_eq_u32 vcc,0,v27
s_cbranch_vccnz retry_289
v_mfma_f32_16x16x32_bf16 v[72:75],a[136:139],v[136:139],v[72:75]
ds_read_b128 v[192:195],v17 offset:32768
s_add_u32 s65,s88,98304
v_mfma_f32_16x16x32_bf16 v[76:79],a[140:143],v[140:143],v[76:79]
ds_read_b128 v[196:199],v17 offset:34816
s_waitcnt lgkmcnt(10)
v_mfma_f32_16x16x32_bf16 v[72:75],a[144:147],v[144:147],v[72:75]
ds_read_b128 v[200:203],v17 offset:36864
buffer_load_dwordx4 v16,s[20:23],s65 offen offset:0 sc1 lds
s_waitcnt vmcnt(8)
v_mfma_f32_16x16x32_bf16 v[76:79],a[148:151],v[148:151],v[76:79]
ds_read_b128 v[204:207],v17 offset:38912
buffer_load_dwordx4 v16,s[20:23],s65 offen offset:2048 sc1 lds
v_and_or_b32 v64,v64,-4,s48
v_mfma_f32_16x16x32_bf16 v[72:75],a[152:155],v[152:155],v[72:75]
ds_read_b128 v[208:211],v17 offset:40960
s_xor_b32 m0,s72,1024
s_add_u32 s64,s49,s34
v_mfma_f32_16x16x32_bf16 v[76:79],a[156:159],v[156:159],v[76:79]
s_add_u32 s65,s89,0
buffer_store_dwordx4 v[64:67],v25,s[20:23],s64 offen offset:2048
s_waitcnt lgkmcnt(9)
v_mfma_f32_16x16x32_bf16 v[72:75],a[160:163],v[160:163],v[72:75]
ds_read_b128 v[212:215],v17 offset:43008
buffer_load_dwordx4 v16,s[20:23],s65 offen offset:0 sc1 lds
v_and_or_b32 v68,v68,-4,s48
v_mfma_f32_16x16x32_bf16 v[76:79],a[164:167],v[164:167],v[76:79]
ds_read_b128 v[216:219],v17 offset:45056
v_min3_u32 v27,v27,v128,v132
s_add_u32 s64,s49,s35
v_mfma_f32_16x16x32_bf16 v[72:75],a[168:171],v[168:171],v[72:75]
ds_read_b128 v[220:223],v17 offset:47104
buffer_load_dwordx4 v16,s[20:23],s65 offen offset:2048 sc1 lds
v_mfma_f32_16x16x32_bf16 v[76:79],a[172:175],v[172:175],v[76:79]
ds_read_b128 v[224:227],v17 offset:49152
s_xor_b32 m0,s72,17408
s_waitcnt lgkmcnt(9)
v_mfma_f32_16x16x32_bf16 v[72:75],a[176:179],v[176:179],v[72:75]
ds_read_b128 v[228:231],v17 offset:51200
s_add_u32 s65,s89,32768
buffer_store_dwordx4 v[68:71],v25,s[20:23],s64 offen offset:3072
v_mfma_f32_16x16x32_bf16 v[76:79],a[180:183],v[180:183],v[76:79]
buffer_load_dwordx4 v16,s[20:23],s65 offen offset:0 sc1 lds
s_mov_b32 s49,0x7fff0000
v_mfma_f32_16x16x32_bf16 v[72:75],a[184:187],v[184:187],v[72:75]
ds_read_b128 v[232:235],v17 offset:53248
v_min3_u32 v27,v27,v136,v140
v_mfma_f32_16x16x32_bf16 v[76:79],a[188:191],v[188:191],v[76:79]
ds_read_b128 v[236:239],v17 offset:55296
s_waitcnt lgkmcnt(8)
v_mfma_f32_16x16x32_bf16 v[72:75],a[192:195],v[192:195],v[72:75]
ds_read_b128 v[240:243],v17 offset:57344
buffer_load_dwordx4 v16,s[20:23],s65 offen offset:2048 sc1 lds
v_mfma_f32_16x16x32_bf16 v[76:79],a[196:199],v[196:199],v[76:79]
ds_read_b128 v[244:247],v17 offset:59392
s_xor_b32 m0,s72,33792
v_mfma_f32_16x16x32_bf16 v[72:75],a[200:203],v[200:203],v[72:75]
ds_read_b128 v[248:251],v17 offset:61440
s_add_u32 s65,s89,65536
v_mfma_f32_16x16x32_bf16 v[76:79],a[204:207],v[204:207],v[76:79]
v_min3_u32 v27,v27,v144,v148
s_waitcnt lgkmcnt(7)
v_mfma_f32_16x16x32_bf16 v[72:75],a[208:211],v[208:211],v[72:75]
ds_read_b128 v[252:255],v17 offset:63488
v_min3_u32 v27,v27,v152,v156
v_mfma_f32_16x16x32_bf16 v[76:79],a[212:215],v[212:215],v[76:79]
buffer_load_dwordx4 v16,s[20:23],s65 offen offset:0 sc1 lds
v_mfma_f32_16x16x32_bf16 v[72:75],a[216:219],v[216:219],v[72:75]
buffer_load_dwordx4 v16,s[20:23],s65 offen offset:2048 sc1 lds
v_mfma_f32_16x16x32_bf16 v[76:79],a[220:223],v[220:223],v[76:79]
s_xor_b32 m0,s72,50176
s_waitcnt lgkmcnt(4)
v_mfma_f32_16x16x32_bf16 v[72:75],a[224:227],v[224:227],v[72:75]
s_add_u32 s65,s89,98304
v_min3_u32 v27,v27,v160,v164
v_mfma_f32_16x16x32_bf16 v[76:79],a[228:231],v[228:231],v[76:79]
buffer_load_dwordx4 v16,s[20:23],s65 offen offset:0 sc1 lds
v_mfma_f32_16x16x32_bf16 v[72:75],a[232:235],v[232:235],v[72:75]
buffer_load_dwordx4 v16,s[20:23],s65 offen offset:2048 sc1 lds
v_mfma_f32_16x16x32_bf16 v[76:79],a[236:239],v[236:239],v[76:79]
v_min3_u32 v27,v27,v168,v172
s_waitcnt lgkmcnt(0)
v_mfma_f32_16x16x32_bf16 v[72:75],a[240:243],v[240:243],v[72:75]
v_min3_u32 v27,v27,v176,v180
v_min3_u32 v27,v27,v184,v188
v_mfma_f32_16x16x32_bf16 v[76:79],a[244:247],v[244:247],v[76:79]
v_min3_u32 v27,v27,v192,v196
v_min3_u32 v27,v27,v200,v204
v_min3_u32 v27,v27,v240,v244
v_mfma_f32_16x16x32_bf16 v[72:75],a[248:251],v[248:251],v[72:75]
v_min3_u32 v27,v27,v208,v212
v_min3_u32 v27,v27,v216,v220
v_mfma_f32_16x16x32_bf16 v[76:79],a[252:255],v[252:255],v[76:79]
v_min3_u32 v27,v27,v224,v228
v_min3_u32 v27,v27,v232,v236
v_min3_u32 v27,v27,v248,v252
v_mfma_f32_16x16x32_bf16 v[80:83],a[0:3],v[128:131],0
v_cmp_eq_u32 vcc,0,v27
s_cbranch_vccnz retry_289
v_mfma_f32_16x16x32_bf16 v[84:87],a[4:7],v[132:135],0
ds_bpermute_b32 v124,v41,v120
ds_bpermute_b32 v125,v41,v121
v_mfma_f32_16x16x32_bf16 v[80:83],a[8:11],v[136:139],v[80:83]
s_waitcnt lgkmcnt(0)
v_lshlrev_b32 v104,16,v124
v_mfma_f32_16x16x32_bf16 v[84:87],a[12:15],v[140:143],v[84:87]
v_and_b32 v105,s80,v124
v_lshlrev_b32 v106,16,v125
v_mfma_f32_16x16x32_bf16 v[80:83],a[16:19],v[144:147],v[80:83]
v_and_b32 v107,s80,v125
v_add_f32 v72,v72,v76
v_mfma_f32_16x16x32_bf16 v[84:87],a[20:23],v[148:151],v[84:87]
v_add_f32 v73,v73,v77
v_add_f32 v74,v74,v78
v_mfma_f32_16x16x32_bf16 v[80:83],a[24:27],v[152:155],v[80:83]
v_add_f32 v75,v75,v79
v_and_or_b32 v72,v72,-4,s48
v_mfma_f32_16x16x32_bf16 v[84:87],a[28:31],v[156:159],v[84:87]
s_add_u32 s64,s77,s33
v_mfma_f32_16x16x32_bf16 v[80:83],a[32:35],v[160:163],v[80:83]
buffer_store_dwordx4 v[72:75],v25,s[20:23],s64 offen offset:1024
v_mfma_f32_16x16x32_bf16 v[84:87],a[36:39],v[164:167],v[84:87]
v_mfma_f32_16x16x32_bf16 v[80:83],a[40:43],v[168:171],v[80:83]
v_mfma_f32_16x16x32_bf16 v[84:87],a[44:47],v[172:175],v[84:87]
v_mfma_f32_16x16x32_bf16 v[80:83],a[48:51],v[176:179],v[80:83]
v_mfma_f32_16x16x32_bf16 v[84:87],a[52:55],v[180:183],v[84:87]
v_mfma_f32_16x16x32_bf16 v[80:83],a[56:59],v[184:187],v[80:83]
v_mfma_f32_16x16x32_bf16 v[84:87],a[60:63],v[188:191],v[84:87]
v_mfma_f32_16x16x32_bf16 v[80:83],a[64:67],v[192:195],v[80:83]
buffer_load_dwordx4 v[96:99],v26,s[20:23],s77 offen offset:2048 sc1
v_mfma_f32_16x16x32_bf16 v[84:87],a[68:71],v[196:199],v[84:87]
buffer_load_dwordx4 v[100:103],v26,s[20:23],s77 offen offset:3072 sc1
v_mfma_f32_16x16x32_bf16 v[80:83],a[72:75],v[200:203],v[80:83]
v_mfma_f32_16x16x32_bf16 v[84:87],a[76:79],v[204:207],v[84:87]
v_mfma_f32_16x16x32_bf16 v[80:83],a[80:83],v[208:211],v[80:83]
v_mfma_f32_16x16x32_bf16 v[84:87],a[84:87],v[212:215],v[84:87]
v_mfma_f32_16x16x32_bf16 v[80:83],a[88:91],v[216:219],v[80:83]
v_mfma_f32_16x16x32_bf16 v[84:87],a[92:95],v[220:223],v[84:87]
v_mfma_f32_16x16x32_bf16 v[80:83],a[96:99],v[224:227],v[80:83]
v_mfma_f32_16x16x32_bf16 v[84:87],a[100:103],v[228:231],v[84:87]
v_mfma_f32_16x16x32_bf16 v[80:83],a[104:107],v[232:235],v[80:83]
buffer_load_dwordx4 v[92:95],v26,s[20:23],s77 offen offset:1024 sc1
v_mfma_f32_16x16x32_bf16 v[84:87],a[108:111],v[236:239],v[84:87]
v_mfma_f32_16x16x32_bf16 v[80:83],a[112:115],v[240:243],v[80:83]
v_mfma_f32_16x16x32_bf16 v[84:87],a[116:119],v[244:247],v[84:87]
v_mfma_f32_16x16x32_bf16 v[80:83],a[120:123],v[248:251],v[80:83]
v_mfma_f32_16x16x32_bf16 v[84:87],a[124:127],v[252:255],v[84:87]
s_branch epi_292
keep_301:
v_mfma_f32_16x16x32_bf16 v[68:71],a[228:231],v[228:231],v[68:71]
s_waitcnt vmcnt(1)
s_waitcnt lgkmcnt(10)
v_mfma_f32_16x16x32_bf16 v[64:67],a[104:107],v[232:235],v[64:67]
ds_read_b128 v[160:163],v17 offset:16384
ds_read_b128 v[164:167],v17 offset:18432
v_mfma_f32_16x16x32_bf16 v[68:71],a[232:235],v[232:235],v[68:71]
v_add_u32 v22,s71,-1
v_min3_u32 v27,v27,v232,v236
v_mfma_f32_16x16x32_bf16 v[64:67],a[108:111],v[236:239],v[64:67]
ds_read_b128 v[168:171],v17 offset:20480
v_mfma_f32_16x16x32_bf16 v[68:71],a[236:239],v[236:239],v[68:71]
s_waitcnt lgkmcnt(9)
v_mfma_f32_16x16x32_bf16 v[64:67],a[112:115],v[240:243],v[64:67]
ds_read_b128 v[172:175],v17 offset:22528
v_min3_u32 v27,v27,v240,v244
v_mfma_f32_16x16x32_bf16 v[68:71],a[240:243],v[240:243],v[68:71]
buffer_store_dword v22,v23,s[20:23],s97 offen sc1
v_mfma_f32_16x16x32_bf16 v[64:67],a[116:119],v[244:247],v[64:67]
ds_read_b128 v[176:179],v17 offset:24576
ds_read_b128 v[180:183],v17 offset:26624
v_mfma_f32_16x16x32_bf16 v[68:71],a[244:247],v[244:247],v[68:71]
s_mov_b32 s97,0x7fff0000
s_waitcnt lgkmcnt(7)
v_mfma_f32_16x16x32_bf16 v[64:67],a[120:123],v[248:251],v[64:67]
ds_read_b128 v[184:187],v17 offset:28672
v_min3_u32 v27,v27,v248,v252
v_mfma_f32_16x16x32_bf16 v[68:71],a[248:251],v[248:251],v[68:71]
v_mfma_f32_16x16x32_bf16 v[64:67],a[124:127],v[252:255],v[64:67]
ds_read_b128 v[188:191],v17 offset:30720
v_mfma_f32_16x16x32_bf16 v[68:71],a[252:255],v[252:255],v[68:71]
v_mfma_f32_16x16x32_bf16 v[72:75],a[128:131],v[128:131],0
v_cmp_eq_u32 vcc,0,v27
s_cbranch_vccnz retry_289
v_mfma_f32_16x16x32_bf16 v[76:79],a[132:135],v[132:135],0
v_min3_u32 v27,v27,v128,v132
v_mfma_f32_16x16x32_bf16 v[72:75],a[136:139],v[136:139],v[72:75]
ds_read_b128 v[192:195],v17 offset:32768
v_mfma_f32_16x16x32_bf16 v[76:79],a[140:143],v[140:143],v[76:79]
ds_read_b128 v[196:199],v17 offset:34816
s_waitcnt lgkmcnt(10)
v_mfma_f32_16x16x32_bf16 v[72:75],a[144:147],v[144:147],v[72:75]
ds_read_b128 v[200:203],v17 offset:36864
v_min3_u32 v27,v27,v136,v140
s_waitcnt vmcnt(1)
v_mfma_f32_16x16x32_bf16 v[76:79],a[148:151],v[148:151],v[76:79]
ds_read_b128 v[204:207],v17 offset:38912
v_min3_u32 v27,v27,v144,v148
v_and_or_b32 v64,v64,-4,s48
v_mfma_f32_16x16x32_bf16 v[72:75],a[152:155],v[152:155],v[72:75]
ds_read_b128 v[208:211],v17 offset:40960
s_add_u32 s64,s49,s34
v_mfma_f32_16x16x32_bf16 v[76:79],a[156:159],v[156:159],v[76:79]
v_min3_u32 v27,v27,v152,v156
s_waitcnt lgkmcnt(9)
v_mfma_f32_16x16x32_bf16 v[72:75],a[160:163],v[160:163],v[72:75]
ds_read_b128 v[212:215],v17 offset:43008
buffer_store_dwordx4 v[64:67],v25,s[20:23],s64 offen offset:2048
v_mfma_f32_16x16x32_bf16 v[76:79],a[164:167],v[164:167],v[76:79]
ds_read_b128 v[216:219],v17 offset:45056
v_min3_u32 v27,v27,v160,v164
v_and_or_b32 v68,v68,-4,s48
v_mfma_f32_16x16x32_bf16 v[72:75],a[168:171],v[168:171],v[72:75]
ds_read_b128 v[220:223],v17 offset:47104
s_add_u32 s64,s49,s35
v_mfma_f32_16x16x32_bf16 v[76:79],a[172:175],v[172:175],v[76:79]
ds_read_b128 v[224:227],v17 offset:49152
s_waitcnt lgkmcnt(9)
v_mfma_f32_16x16x32_bf16 v[72:75],a[176:179],v[176:179],v[72:75]
ds_read_b128 v[228:231],v17 offset:51200
v_min3_u32 v27,v27,v168,v172
v_mfma_f32_16x16x32_bf16 v[76:79],a[180:183],v[180:183],v[76:79]
v_min3_u32 v27,v27,v176,v180
buffer_store_dwordx4 v[68:71],v25,s[20:23],s64 offen offset:3072
v_mfma_f32_16x16x32_bf16 v[72:75],a[184:187],v[184:187],v[72:75]
ds_read_b128 v[232:235],v17 offset:53248
s_mov_b32 s49,0x7fff0000
v_mfma_f32_16x16x32_bf16 v[76:79],a[188:191],v[188:191],v[76:79]
ds_read_b128 v[236:239],v17 offset:55296
s_waitcnt lgkmcnt(8)
v_mfma_f32_16x16x32_bf16 v[72:75],a[192:195],v[192:195],v[72:75]
ds_read_b128 v[240:243],v17 offset:57344
v_min3_u32 v27,v27,v184,v188
v_mfma_f32_16x16x32_bf16 v[76:79],a[196:199],v[196:199],v[76:79]
ds_read_b128 v[244:247],v17 offset:59392
v_min3_u32 v27,v27,v192,v196
v_mfma_f32_16x16x32_bf16 v[72:75],a[200:203],v[200:203],v[72:75]
ds_read_b128 v[248:251],v17 offset:61440
ds_bpermute_b32 v124,v41,v120
v_mfma_f32_16x16x32_bf16 v[76:79],a[204:207],v[204:207],v[76:79]
v_min3_u32 v27,v27,v200,v204
s_waitcnt lgkmcnt(8)
v_mfma_f32_16x16x32_bf16 v[72:75],a[208:211],v[208:211],v[72:75]
ds_read_b128 v[252:255],v17 offset:63488
ds_bpermute_b32 v125,v41,v121
v_mfma_f32_16x16x32_bf16 v[76:79],a[212:215],v[212:215],v[76:79]
v_min3_u32 v27,v27,v208,v212
v_mfma_f32_16x16x32_bf16 v[72:75],a[216:219],v[216:219],v[72:75]
v_mfma_f32_16x16x32_bf16 v[76:79],a[220:223],v[220:223],v[76:79]
v_min3_u32 v27,v27,v216,v220
s_waitcnt lgkmcnt(6)
v_mfma_f32_16x16x32_bf16 v[72:75],a[224:227],v[224:227],v[72:75]
s_waitcnt lgkmcnt(0)
v_mfma_f32_16x16x32_bf16 v[76:79],a[228:231],v[228:231],v[76:79]
v_min3_u32 v27,v27,v224,v228
v_mfma_f32_16x16x32_bf16 v[72:75],a[232:235],v[232:235],v[72:75]
v_lshlrev_b32 v104,16,v124
v_mfma_f32_16x16x32_bf16 v[76:79],a[236:239],v[236:239],v[76:79]
v_min3_u32 v27,v27,v232,v236
v_mfma_f32_16x16x32_bf16 v[72:75],a[240:243],v[240:243],v[72:75]
v_mfma_f32_16x16x32_bf16 v[76:79],a[244:247],v[244:247],v[76:79]
v_min3_u32 v27,v27,v240,v244
v_mfma_f32_16x16x32_bf16 v[72:75],a[248:251],v[248:251],v[72:75]
v_and_b32 v105,s80,v124
v_mfma_f32_16x16x32_bf16 v[76:79],a[252:255],v[252:255],v[76:79]
v_min3_u32 v27,v27,v248,v252
v_mfma_f32_16x16x32_bf16 v[80:83],a[0:3],v[128:131],0
v_cmp_eq_u32 vcc,0,v27
s_cbranch_vccnz retry_289
v_mfma_f32_16x16x32_bf16 v[84:87],a[4:7],v[132:135],0
v_lshlrev_b32 v106,16,v125
v_mfma_f32_16x16x32_bf16 v[80:83],a[8:11],v[136:139],v[80:83]
v_mfma_f32_16x16x32_bf16 v[84:87],a[12:15],v[140:143],v[84:87]
v_mfma_f32_16x16x32_bf16 v[80:83],a[16:19],v[144:147],v[80:83]
v_and_b32 v107,s80,v125
v_add_f32 v72,v72,v76
v_mfma_f32_16x16x32_bf16 v[84:87],a[20:23],v[148:151],v[84:87]
v_add_f32 v73,v73,v77
v_add_f32 v74,v74,v78
v_mfma_f32_16x16x32_bf16 v[80:83],a[24:27],v[152:155],v[80:83]
v_add_f32 v75,v75,v79
v_and_or_b32 v72,v72,-4,s48
v_mfma_f32_16x16x32_bf16 v[84:87],a[28:31],v[156:159],v[84:87]
s_add_u32 s64,s77,s33
v_mfma_f32_16x16x32_bf16 v[80:83],a[32:35],v[160:163],v[80:83]
buffer_store_dwordx4 v[72:75],v25,s[20:23],s64 offen offset:1024
v_mfma_f32_16x16x32_bf16 v[84:87],a[36:39],v[164:167],v[84:87]
v_mfma_f32_16x16x32_bf16 v[80:83],a[40:43],v[168:171],v[80:83]
v_mfma_f32_16x16x32_bf16 v[84:87],a[44:47],v[172:175],v[84:87]
v_mfma_f32_16x16x32_bf16 v[80:83],a[48:51],v[176:179],v[80:83]
v_mfma_f32_16x16x32_bf16 v[84:87],a[52:55],v[180:183],v[84:87]
v_mfma_f32_16x16x32_bf16 v[80:83],a[56:59],v[184:187],v[80:83]
v_mfma_f32_16x16x32_bf16 v[84:87],a[60:63],v[188:191],v[84:87]
v_mfma_f32_16x16x32_bf16 v[80:83],a[64:67],v[192:195],v[80:83]
buffer_load_dwordx4 v[96:99],v26,s[20:23],s77 offen offset:2048 sc1
v_mfma_f32_16x16x32_bf16 v[84:87],a[68:71],v[196:199],v[84:87]
buffer_load_dwordx4 v[100:103],v26,s[20:23],s77 offen offset:3072 sc1
v_mfma_f32_16x16x32_bf16 v[80:83],a[72:75],v[200:203],v[80:83]
v_mfma_f32_16x16x32_bf16 v[84:87],a[76:79],v[204:207],v[84:87]
v_mfma_f32_16x16x32_bf16 v[80:83],a[80:83],v[208:211],v[80:83]
v_mfma_f32_16x16x32_bf16 v[84:87],a[84:87],v[212:215],v[84:87]
v_mfma_f32_16x16x32_bf16 v[80:83],a[88:91],v[216:219],v[80:83]
v_mfma_f32_16x16x32_bf16 v[84:87],a[92:95],v[220:223],v[84:87]
v_mfma_f32_16x16x32_bf16 v[80:83],a[96:99],v[224:227],v[80:83]
v_mfma_f32_16x16x32_bf16 v[84:87],a[100:103],v[228:231],v[84:87]
v_mfma_f32_16x16x32_bf16 v[80:83],a[104:107],v[232:235],v[80:83]
buffer_load_dwordx4 v[92:95],v26,s[20:23],s77 offen offset:1024 sc1
v_mfma_f32_16x16x32_bf16 v[84:87],a[108:111],v[236:239],v[84:87]
v_mfma_f32_16x16x32_bf16 v[80:83],a[112:115],v[240:243],v[80:83]
v_mfma_f32_16x16x32_bf16 v[84:87],a[116:119],v[244:247],v[84:87]
v_mfma_f32_16x16x32_bf16 v[80:83],a[120:123],v[248:251],v[80:83]
v_mfma_f32_16x16x32_bf16 v[84:87],a[124:127],v[252:255],v[84:87]
s_branch epi_292
both_293:
s_waitcnt vmcnt(15) lgkmcnt(0)
s_barrier
ds_read_b128 v[224:227],v18 offset:0
ds_read_b128 v[228:231],v18 offset:2048
ds_read_b128 v[232:235],v18 offset:4096
ds_read_b128 v[236:239],v18 offset:6144
ds_read_b128 v[240:243],v18 offset:8192
ds_read_b128 v[244:247],v18 offset:10240
ds_read_b128 v[248:251],v18 offset:12288
s_waitcnt lgkmcnt(5)
v_mfma_f32_16x16x32_bf16 v[64:67],a[0:3],v[224:227],0
s_add_u32 s96,s71,1
s_add_u32 s92,s71,2
v_min_u32 v27,v224,v228
v_mfma_f32_16x16x32_bf16 v[68:71],a[128:131],v[224:227],0
ds_read_b128 v[252:255],v18 offset:14336
s_add_u32 s88,s70,s75
v_mfma_f32_16x16x32_bf16 v[64:67],a[4:7],v[228:231],v[64:67]
s_add_u32 s88,s88,2097152
s_xor_b32 s88,s88,0x2000
v_mfma_f32_16x16x32_bf16 v[68:71],a[132:135],v[228:231],v[68:71]
ds_read_b128 v[224:227],v18 offset:16384
s_waitcnt lgkmcnt(5)
v_mfma_f32_16x16x32_bf16 v[64:67],a[8:11],v[232:235],v[64:67]
s_xor_b32 s89,s88,1024
v_min3_u32 v27,v27,v232,v236
v_mfma_f32_16x16x32_bf16 v[68:71],a[136:139],v[232:235],v[68:71]
ds_read_b128 v[228:231],v18 offset:18432
v_mfma_f32_16x16x32_bf16 v[64:67],a[12:15],v[236:239],v[64:67]
s_xor_b32 m0,s72,0
v_mfma_f32_16x16x32_bf16 v[68:71],a[140:143],v[236:239],v[68:71]
ds_read_b128 v[232:235],v18 offset:20480
s_waitcnt lgkmcnt(5)
v_mfma_f32_16x16x32_bf16 v[64:67],a[16:19],v[240:243],v[64:67]
s_add_u32 s65,s88,0
v_min3_u32 v27,v27,v240,v244
v_mfma_f32_16x16x32_bf16 v[68:71],a[144:147],v[240:243],v[68:71]
ds_read_b128 v[236:239],v18 offset:22528
v_mfma_f32_16x16x32_bf16 v[64:67],a[20:23],v[244:247],v[64:67]
buffer_load_dwordx4 v16,s[20:23],s65 offen offset:0 sc1 lds
v_mfma_f32_16x16x32_bf16 v[68:71],a[148:151],v[244:247],v[68:71]
ds_read_b128 v[240:243],v18 offset:24576
s_waitcnt lgkmcnt(5)
v_mfma_f32_16x16x32_bf16 v[64:67],a[24:27],v[248:251],v[64:67]
buffer_load_dwordx4 v16,s[20:23],s65 offen offset:2048 sc1 lds
v_mfma_f32_16x16x32_bf16 v[68:71],a[152:155],v[248:251],v[68:71]
ds_read_b128 v[244:247],v18 offset:26624
v_min3_u32 v27,v27,v248,v252
v_mfma_f32_16x16x32_bf16 v[64:67],a[28:31],v[252:255],v[64:67]
s_xor_b32 m0,s72,16384
v_mfma_f32_16x16x32_bf16 v[68:71],a[156:159],v[252:255],v[68:71]
ds_read_b128 v[248:251],v18 offset:28672
s_waitcnt lgkmcnt(5)
v_mfma_f32_16x16x32_bf16 v[64:67],a[32:35],v[224:227],v[64:67]
s_add_u32 s65,s88,32768
v_min3_u32 v27,v27,v224,v228
v_mfma_f32_16x16x32_bf16 v[68:71],a[160:163],v[224:227],v[68:71]
ds_read_b128 v[252:255],v18 offset:30720
v_mfma_f32_16x16x32_bf16 v[64:67],a[36:39],v[228:231],v[64:67]
s_waitcnt vmcnt(4)
buffer_load_dwordx4 v16,s[20:23],s65 offen offset:0 sc1 lds
v_mfma_f32_16x16x32_bf16 v[68:71],a[164:167],v[228:231],v[68:71]
ds_read_b128 v[224:227],v18 offset:32768
s_waitcnt lgkmcnt(5)
v_mfma_f32_16x16x32_bf16 v[64:67],a[40:43],v[232:235],v[64:67]
v_cmp_gt_u32 vcc,s96,v29
v_cmp_gt_u32 s[92:93],s92,v29
v_min3_u32 v27,v27,v232,v236
v_mfma_f32_16x16x32_bf16 v[68:71],a[168:171],v[232:235],v[68:71]
ds_read_b128 v[228:231],v18 offset:34816
buffer_load_dwordx4 v16,s[20:23],s65 offen offset:2048 sc1 lds
v_mfma_f32_16x16x32_bf16 v[64:67],a[44:47],v[236:239],v[64:67]
v_mov_b32 v44,vcc_lo
v_mov_b32 v45,s92
v_mfma_f32_16x16x32_bf16 v[68:71],a[172:175],v[236:239],v[68:71]
ds_read_b128 v[232:235],v18 offset:36864
s_xor_b32 m0,s72,32768
s_waitcnt lgkmcnt(5)
v_mfma_f32_16x16x32_bf16 v[64:67],a[48:51],v[240:243],v[64:67]
ds_write_b64 v46,v[44:45]
v_min3_u32 v27,v27,v240,v244
v_mfma_f32_16x16x32_bf16 v[68:71],a[176:179],v[240:243],v[68:71]
ds_read_b128 v[236:239],v18 offset:38912
s_add_u32 s65,s88,65536
v_mfma_f32_16x16x32_bf16 v[64:67],a[52:55],v[244:247],v[64:67]
buffer_load_dwordx2 v[120:121],v20,s[36:39],s78 offen
v_mfma_f32_16x16x32_bf16 v[68:71],a[180:183],v[244:247],v[68:71]
ds_read_b128 v[240:243],v18 offset:40960
s_waitcnt lgkmcnt(6)
v_mfma_f32_16x16x32_bf16 v[64:67],a[56:59],v[248:251],v[64:67]
buffer_load_dwordx4 v16,s[20:23],s65 offen offset:0 sc1 lds
v_mfma_f32_16x16x32_bf16 v[68:71],a[184:187],v[248:251],v[68:71]
ds_read_b128 v[244:247],v18 offset:43008
buffer_load_dwordx4 v16,s[20:23],s65 offen offset:2048 sc1 lds
v_mfma_f32_16x16x32_bf16 v[64:67],a[60:63],v[252:255],v[64:67]
v_min3_u32 v27,v27,v248,v252
v_mfma_f32_16x16x32_bf16 v[68:71],a[188:191],v[252:255],v[68:71]
ds_read_b128 v[248:251],v18 offset:45056
s_xor_b32 m0,s72,49152
s_waitcnt lgkmcnt(6)
v_mfma_f32_16x16x32_bf16 v[64:67],a[64:67],v[224:227],v[64:67]
v_min3_u32 v27,v27,v224,v228
v_mfma_f32_16x16x32_bf16 v[68:71],a[192:195],v[224:227],v[68:71]
ds_read_b128 v[252:255],v18 offset:47104
s_add_u32 s65,s88,98304
v_mfma_f32_16x16x32_bf16 v[64:67],a[68:71],v[228:231],v[64:67]
v_mfma_f32_16x16x32_bf16 v[68:71],a[196:199],v[228:231],v[68:71]
ds_read_b128 v[224:227],v18 offset:49152
s_waitcnt lgkmcnt(5)
v_mfma_f32_16x16x32_bf16 v[64:67],a[72:75],v[232:235],v[64:67]
buffer_load_dwordx4 v16,s[20:23],s65 offen offset:0 sc1 lds
v_mfma_f32_16x16x32_bf16 v[68:71],a[200:203],v[232:235],v[68:71]
ds_read_b128 v[228:231],v18 offset:51200
buffer_load_dwordx4 v16,s[20:23],s65 offen offset:2048 sc1 lds
v_mfma_f32_16x16x32_bf16 v[64:67],a[76:79],v[236:239],v[64:67]
v_min3_u32 v27,v27,v232,v236
v_mfma_f32_16x16x32_bf16 v[68:71],a[204:207],v[236:239],v[68:71]
ds_read_b128 v[232:235],v18 offset:53248
s_waitcnt lgkmcnt(5)
v_mfma_f32_16x16x32_bf16 v[64:67],a[80:83],v[240:243],v[64:67]
s_waitcnt vmcnt(16)
s_barrier
ds_read_b64 v[44:45],v47
ds_read_b128 v[128:131],v17 offset:0
ds_read_b128 v[132:135],v17 offset:2048
v_mfma_f32_16x16x32_bf16 v[68:71],a[208:211],v[240:243],v[68:71]
ds_read_b128 v[236:239],v18 offset:55296
s_xor_b32 m0,s72,1024
v_min3_u32 v27,v27,v240,v244
v_mfma_f32_16x16x32_bf16 v[64:67],a[84:87],v[244:247],v[64:67]
ds_read_b128 v[136:139],v17 offset:4096
s_add_u32 s65,s89,0
v_mfma_f32_16x16x32_bf16 v[68:71],a[212:215],v[244:247],v[68:71]
ds_read_b128 v[240:243],v18 offset:57344
s_waitcnt lgkmcnt(9)
v_mfma_f32_16x16x32_bf16 v[64:67],a[88:91],v[248:251],v[64:67]
ds_read_b128 v[140:143],v17 offset:6144
buffer_load_dwordx4 v16,s[20:23],s65 offen offset:0 sc1 lds
v_mfma_f32_16x16x32_bf16 v[68:71],a[216:219],v[248:251],v[68:71]
ds_read_b128 v[244:247],v18 offset:59392
v_min3_u32 v27,v27,v248,v252
v_mfma_f32_16x16x32_bf16 v[64:67],a[92:95],v[252:255],v[64:67]
ds_read_b128 v[144:147],v17 offset:8192
ds_read_b128 v[148:151],v17 offset:10240
v_mfma_f32_16x16x32_bf16 v[68:71],a[220:223],v[252:255],v[68:71]
ds_read_b128 v[248:251],v18 offset:61440
s_waitcnt lgkmcnt(12)
v_mfma_f32_16x16x32_bf16 v[64:67],a[96:99],v[224:227],v[64:67]
ds_read_b128 v[152:155],v17 offset:12288
s_waitcnt lgkmcnt(11)
v_min3_u32 v27,v27,v224,v228
v_mfma_f32_16x16x32_bf16 v[68:71],a[224:227],v[224:227],v[68:71]
ds_read_b128 v[252:255],v18 offset:63488
v_readfirstlane_b32 s93,v45
v_mfma_f32_16x16x32_bf16 v[64:67],a[100:103],v[228:231],v[64:67]
ds_read_b128 v[156:159],v17 offset:14336
buffer_load_dwordx4 v16,s[20:23],s65 offen offset:2048 sc1 lds
v_mfma_f32_16x16x32_bf16 v[68:71],a[228:231],v[228:231],v[68:71]
s_xor_b32 m0,s72,17408
s_add_u32 s65,s89,32768
s_waitcnt lgkmcnt(10)
v_mfma_f32_16x16x32_bf16 v[64:67],a[104:107],v[232:235],v[64:67]
ds_read_b128 v[160:163],v17 offset:16384
ds_read_b128 v[164:167],v17 offset:18432
v_min3_u32 v27,v27,v232,v236
v_mfma_f32_16x16x32_bf16 v[68:71],a[232:235],v[232:235],v[68:71]
buffer_load_dwordx4 v16,s[20:23],s65 offen offset:0 sc1 lds
s_waitcnt vmcnt(12)
v_mfma_f32_16x16x32_bf16 v[64:67],a[108:111],v[236:239],v[64:67]
ds_read_b128 v[168:171],v17 offset:20480
buffer_load_dwordx4 v16,s[20:23],s65 offen offset:2048 sc1 lds
v_mfma_f32_16x16x32_bf16 v[68:71],a[236:239],v[236:239],v[68:71]
v_add_u32 v22,s71,-1
s_waitcnt lgkmcnt(9)
v_mfma_f32_16x16x32_bf16 v[64:67],a[112:115],v[240:243],v[64:67]
ds_read_b128 v[172:175],v17 offset:22528
v_min3_u32 v27,v27,v240,v244
v_mfma_f32_16x16x32_bf16 v[68:71],a[240:243],v[240:243],v[68:71]
s_xor_b32 m0,s72,33792
buffer_store_dword v22,v23,s[20:23],s97 offen sc1
v_mfma_f32_16x16x32_bf16 v[64:67],a[116:119],v[244:247],v[64:67]
ds_read_b128 v[176:179],v17 offset:24576
ds_read_b128 v[180:183],v17 offset:26624
s_mov_b32 s97,0x7fff0000
v_mfma_f32_16x16x32_bf16 v[68:71],a[244:247],v[244:247],v[68:71]
s_add_u32 s65,s89,65536
s_waitcnt lgkmcnt(7)
v_mfma_f32_16x16x32_bf16 v[64:67],a[120:123],v[248:251],v[64:67]
ds_read_b128 v[184:187],v17 offset:28672
v_min3_u32 v27,v27,v248,v252
v_mfma_f32_16x16x32_bf16 v[68:71],a[248:251],v[248:251],v[68:71]
buffer_load_dwordx4 v16,s[20:23],s65 offen offset:0 sc1 lds
v_mfma_f32_16x16x32_bf16 v[64:67],a[124:127],v[252:255],v[64:67]
ds_read_b128 v[188:191],v17 offset:30720
v_mfma_f32_16x16x32_bf16 v[68:71],a[252:255],v[252:255],v[68:71]
buffer_load_dwordx4 v16,s[20:23],s65 offen offset:2048 sc1 lds
v_mfma_f32_16x16x32_bf16 v[72:75],a[128:131],v[128:131],0
v_cmp_eq_u32 vcc,0,v27
s_cbranch_vccnz retry_289
v_mfma_f32_16x16x32_bf16 v[76:79],a[132:135],v[132:135],0
s_xor_b32 m0,s72,50176
v_min3_u32 v27,v27,v128,v132
v_mfma_f32_16x16x32_bf16 v[72:75],a[136:139],v[136:139],v[72:75]
ds_read_b128 v[192:195],v17 offset:32768
v_mfma_f32_16x16x32_bf16 v[76:79],a[140:143],v[140:143],v[76:79]
ds_read_b128 v[196:199],v17 offset:34816
s_add_u32 s65,s89,98304
s_waitcnt lgkmcnt(10)
v_mfma_f32_16x16x32_bf16 v[72:75],a[144:147],v[144:147],v[72:75]
ds_read_b128 v[200:203],v17 offset:36864
v_min3_u32 v27,v27,v136,v140
s_waitcnt vmcnt(11)
v_mfma_f32_16x16x32_bf16 v[76:79],a[148:151],v[148:151],v[76:79]
ds_read_b128 v[204:207],v17 offset:38912
buffer_load_dwordx4 v16,s[20:23],s65 offen offset:0 sc1 lds
v_mfma_f32_16x16x32_bf16 v[72:75],a[152:155],v[152:155],v[72:75]
ds_read_b128 v[208:211],v17 offset:40960
v_min3_u32 v27,v27,v144,v148
v_and_or_b32 v64,v64,-4,s48
v_mfma_f32_16x16x32_bf16 v[76:79],a[156:159],v[156:159],v[76:79]
buffer_load_dwordx4 v16,s[20:23],s65 offen offset:2048 sc1 lds
s_waitcnt lgkmcnt(9)
v_mfma_f32_16x16x32_bf16 v[72:75],a[160:163],v[160:163],v[72:75]
ds_read_b128 v[212:215],v17 offset:43008
v_min3_u32 v27,v27,v152,v156
s_add_u32 s64,s49,s34
v_mfma_f32_16x16x32_bf16 v[76:79],a[164:167],v[164:167],v[76:79]
ds_read_b128 v[216:219],v17 offset:45056
v_min3_u32 v27,v27,v160,v164
v_mfma_f32_16x16x32_bf16 v[72:75],a[168:171],v[168:171],v[72:75]
ds_read_b128 v[220:223],v17 offset:47104
buffer_store_dwordx4 v[64:67],v25,s[20:23],s64 offen offset:2048
v_mfma_f32_16x16x32_bf16 v[76:79],a[172:175],v[172:175],v[76:79]
ds_read_b128 v[224:227],v17 offset:49152
v_and_or_b32 v68,v68,-4,s48
s_waitcnt lgkmcnt(9)
v_mfma_f32_16x16x32_bf16 v[72:75],a[176:179],v[176:179],v[72:75]
ds_read_b128 v[228:231],v17 offset:51200
v_min3_u32 v27,v27,v168,v172
s_add_u32 s64,s49,s35
v_mfma_f32_16x16x32_bf16 v[76:79],a[180:183],v[180:183],v[76:79]
v_min3_u32 v27,v27,v176,v180
buffer_store_dwordx4 v[68:71],v25,s[20:23],s64 offen offset:3072
v_mfma_f32_16x16x32_bf16 v[72:75],a[184:187],v[184:187],v[72:75]
ds_read_b128 v[232:235],v17 offset:53248
s_mov_b32 s49,0x7fff0000
v_mfma_f32_16x16x32_bf16 v[76:79],a[188:191],v[188:191],v[76:79]
ds_read_b128 v[236:239],v17 offset:55296
s_waitcnt lgkmcnt(8)
v_mfma_f32_16x16x32_bf16 v[72:75],a[192:195],v[192:195],v[72:75]
ds_read_b128 v[240:243],v17 offset:57344
v_min3_u32 v27,v27,v184,v188
v_mfma_f32_16x16x32_bf16 v[76:79],a[196:199],v[196:199],v[76:79]
ds_read_b128 v[244:247],v17 offset:59392
v_min3_u32 v27,v27,v192,v196
v_mfma_f32_16x16x32_bf16 v[72:75],a[200:203],v[200:203],v[72:75]
ds_read_b128 v[248:251],v17 offset:61440
ds_bpermute_b32 v124,v41,v120
v_mfma_f32_16x16x32_bf16 v[76:79],a[204:207],v[204:207],v[76:79]
v_min3_u32 v27,v27,v200,v204
s_waitcnt lgkmcnt(8)
v_mfma_f32_16x16x32_bf16 v[72:75],a[208:211],v[208:211],v[72:75]
ds_read_b128 v[252:255],v17 offset:63488
ds_bpermute_b32 v125,v41,v121
v_mfma_f32_16x16x32_bf16 v[76:79],a[212:215],v[212:215],v[76:79]
v_min3_u32 v27,v27,v208,v212
v_mfma_f32_16x16x32_bf16 v[72:75],a[216:219],v[216:219],v[72:75]
v_mfma_f32_16x16x32_bf16 v[76:79],a[220:223],v[220:223],v[76:79]
v_min3_u32 v27,v27,v216,v220
s_waitcnt lgkmcnt(6)
v_mfma_f32_16x16x32_bf16 v[72:75],a[224:227],v[224:227],v[72:75]
s_waitcnt lgkmcnt(0)
v_mfma_f32_16x16x32_bf16 v[76:79],a[228:231],v[228:231],v[76:79]
v_min3_u32 v27,v27,v224,v228
v_mfma_f32_16x16x32_bf16 v[72:75],a[232:235],v[232:235],v[72:75]
v_lshlrev_b32 v104,16,v124
v_mfma_f32_16x16x32_bf16 v[76:79],a[236:239],v[236:239],v[76:79]
v_min3_u32 v27,v27,v232,v236
v_mfma_f32_16x16x32_bf16 v[72:75],a[240:243],v[240:243],v[72:75]
v_mfma_f32_16x16x32_bf16 v[76:79],a[244:247],v[244:247],v[76:79]
v_min3_u32 v27,v27,v240,v244
v_mfma_f32_16x16x32_bf16 v[72:75],a[248:251],v[248:251],v[72:75]
v_and_b32 v105,s80,v124
v_mfma_f32_16x16x32_bf16 v[76:79],a[252:255],v[252:255],v[76:79]
v_min3_u32 v27,v27,v248,v252
v_mfma_f32_16x16x32_bf16 v[80:83],a[0:3],v[128:131],0
v_cmp_eq_u32 vcc,0,v27
s_cbranch_vccnz retry_289
v_mfma_f32_16x16x32_bf16 v[84:87],a[4:7],v[132:135],0
v_lshlrev_b32 v106,16,v125
v_mfma_f32_16x16x32_bf16 v[80:83],a[8:11],v[136:139],v[80:83]
v_mfma_f32_16x16x32_bf16 v[84:87],a[12:15],v[140:143],v[84:87]
v_mfma_f32_16x16x32_bf16 v[80:83],a[16:19],v[144:147],v[80:83]
v_and_b32 v107,s80,v125
v_add_f32 v72,v72,v76
v_mfma_f32_16x16x32_bf16 v[84:87],a[20:23],v[148:151],v[84:87]
v_add_f32 v73,v73,v77
v_add_f32 v74,v74,v78
v_mfma_f32_16x16x32_bf16 v[80:83],a[24:27],v[152:155],v[80:83]
v_add_f32 v75,v75,v79
v_and_or_b32 v72,v72,-4,s48
v_mfma_f32_16x16x32_bf16 v[84:87],a[28:31],v[156:159],v[84:87]
s_add_u32 s64,s77,s33
v_mfma_f32_16x16x32_bf16 v[80:83],a[32:35],v[160:163],v[80:83]
buffer_store_dwordx4 v[72:75],v25,s[20:23],s64 offen offset:1024
v_mfma_f32_16x16x32_bf16 v[84:87],a[36:39],v[164:167],v[84:87]
v_mfma_f32_16x16x32_bf16 v[80:83],a[40:43],v[168:171],v[80:83]
v_mfma_f32_16x16x32_bf16 v[84:87],a[44:47],v[172:175],v[84:87]
v_mfma_f32_16x16x32_bf16 v[80:83],a[48:51],v[176:179],v[80:83]
v_mfma_f32_16x16x32_bf16 v[84:87],a[52:55],v[180:183],v[84:87]
v_mfma_f32_16x16x32_bf16 v[80:83],a[56:59],v[184:187],v[80:83]
v_mfma_f32_16x16x32_bf16 v[84:87],a[60:63],v[188:191],v[84:87]
v_mfma_f32_16x16x32_bf16 v[80:83],a[64:67],v[192:195],v[80:83]
buffer_load_dwordx4 v[96:99],v26,s[20:23],s77 offen offset:2048 sc1
v_mfma_f32_16x16x32_bf16 v[84:87],a[68:71],v[196:199],v[84:87]
buffer_load_dwordx4 v[100:103],v26,s[20:23],s77 offen offset:3072 sc1
v_mfma_f32_16x16x32_bf16 v[80:83],a[72:75],v[200:203],v[80:83]
v_mfma_f32_16x16x32_bf16 v[84:87],a[76:79],v[204:207],v[84:87]
v_mfma_f32_16x16x32_bf16 v[80:83],a[80:83],v[208:211],v[80:83]
v_mfma_f32_16x16x32_bf16 v[84:87],a[84:87],v[212:215],v[84:87]
v_mfma_f32_16x16x32_bf16 v[80:83],a[88:91],v[216:219],v[80:83]
v_mfma_f32_16x16x32_bf16 v[84:87],a[92:95],v[220:223],v[84:87]
v_mfma_f32_16x16x32_bf16 v[80:83],a[96:99],v[224:227],v[80:83]
v_mfma_f32_16x16x32_bf16 v[84:87],a[100:103],v[228:231],v[84:87]
v_mfma_f32_16x16x32_bf16 v[80:83],a[104:107],v[232:235],v[80:83]
buffer_load_dwordx4 v[92:95],v26,s[20:23],s77 offen offset:1024 sc1
v_mfma_f32_16x16x32_bf16 v[84:87],a[108:111],v[236:239],v[84:87]
v_mfma_f32_16x16x32_bf16 v[80:83],a[112:115],v[240:243],v[80:83]
v_mfma_f32_16x16x32_bf16 v[84:87],a[116:119],v[244:247],v[84:87]
v_mfma_f32_16x16x32_bf16 v[80:83],a[120:123],v[248:251],v[80:83]
v_mfma_f32_16x16x32_bf16 v[84:87],a[124:127],v[252:255],v[84:87]
epi_292:
buffer_load_dword v29,v21,s[20:23],s87 offen sc1
s_nop 6
v_pk_add_f32 v[88:89],v[80:81],v[84:85]
v_pk_add_f32 v[90:91],v[82:83],v[86:87]
s_waitcnt vmcnt(1)
s_branch ic_304
ip_302:
buffer_load_dwordx4 v[92:95],v26,s[20:23],s77 offen offset:1024 sc1
buffer_load_dwordx4 v[96:99],v26,s[20:23],s77 offen offset:2048 sc1
buffer_load_dwordx4 v[100:103],v26,s[20:23],s77 offen offset:3072 sc1
s_waitcnt vmcnt(0)
ic_304:
v_bitop3_b32 v22,v92,v96,v100 bitop3:0x80
v_and_b32 v22,s48,v22
v_cmp_eq_u32 vcc,0,v22
s_cbranch_vccz ik_303
s_sub_u32 s90,s90,1
s_cmp_gt_i32 s90,0
s_cbranch_scc1 ip_302
ik_303:
v_pk_add_f32 v[88:89],v[88:89],v[92:93]
v_pk_add_f32 v[96:97],v[96:97],v[100:101]
v_pk_add_f32 v[90:91],v[90:91],v[94:95]
v_pk_add_f32 v[98:99],v[98:99],v[102:103]
v_pk_add_f32 v[88:89],v[88:89],v[96:97]
v_pk_add_f32 v[90:91],v[90:91],v[98:99]
v_pk_fma_f32 v[88:89],v[88:89],v[52:53],v[104:105]
v_pk_fma_f32 v[90:91],v[90:91],v[54:55],v[106:107]
v_cvt_pk_bf16_f32 v88,v88,v89
v_cvt_pk_bf16_f32 v89,v90,v91
v_max_u32 v88,1,v88
ds_bpermute_b32 v88,v40,v88
ds_bpermute_b32 v89,v40,v89
v_xor_b32 v18,0x10000,v18
s_xor_b32 s49,s77,524288
s_cselect_b32 s64,0,3
s_xor_b32 s48,s48,s64
s_waitcnt lgkmcnt(0)
buffer_store_dwordx2 v[88:89],v19,s[20:23],s70 offen sc1
s_mov_b32 s77,s49
s_add_u32 s78,s78,65536
s_cmp_gt_u32 s71,40
s_cselect_b32 s65,s73,0x7fff0000
s_cselect_b32 s97,0x7fff0000,s73
v_mov_b32 v22,s71
buffer_store_dword v22,v23,s[20:23],s65 offen sc1
next_299:
v_xor_b32 v17,0x10000,v17
s_xor_b32 s72,s72,0x10000
s_add_u32 s70,s70,2097152
s_xor_b32 s70,s70,0x2000
s_add_u32 s71,s71,1
s_cmp_le_u32 s71,64
s_cbranch_scc1 seg_290
s_endpgm
retry_289:
s_sub_u32 s90,s90,64
s_cmp_lt_i32 s90,0
s_cbranch_scc1 giveup_197
s_mov_b32 s83,1
s_waitcnt vmcnt(0) lgkmcnt(0)
s_barrier
s_branch seg_290
kslow_288:
s_add_u32 s64,s79,0
s_lshl_b32 s70,s64,21
s_lshl_b32 s64,s64,13
s_and_b32 s64,s64,0x2000
s_xor_b32 s64,s64,s62
s_add_u32 s70,s70,s64
s_add_u32 s70,s70,29360128
s_mov_b32 s83,1
s_mov_b32 s87,s74
s_cmp_eq_u32 s50,0
s_cselect_b32 s74,s74,0x7fff0000
v_mov_b32 v47,132096
s_lshl_b32 s64,s50,3
s_add_u32 s64,s64,132096
v_mov_b32 v46,s64
v_mov_b32 v29,0
s_mov_b32 s97,0x7fff0000
s_mov_b32 s69,1
s_mov_b32 s68,0
s_mov_b32 s52,0x30003
s_mov_b32 s53,s52
seg_308:
s_add_u32 s94,s70,s75
s_xor_b32 s95,s94,1024
s_xor_b32 s91,s72,0x10000
s_waitcnt vmcnt(2)
v_cmp_gt_u32 vcc,s71,v29
s_cbranch_vccz nb_312
s_waitcnt vmcnt(0)
v_add_u32 v22,s71,-1
buffer_store_dword v22,v23,s[20:23],s97 offen sc1
s_mov_b32 s97,0x7fff0000
s_cmp_lg_u32 s50,0
s_cbranch_scc1 nb_312
buffer_load_dword v32,v21,s[20:23],s74 offen sc1
s_sleep 2
pl_314:
buffer_load_dword v33,v21,s[20:23],s74 offen sc1
s_waitcnt vmcnt(1)
v_cmp_gt_u32 vcc,s71,v32
v_mov_b32 v29,v32
s_cbranch_vccz pok_315
buffer_load_dword v32,v21,s[20:23],s74 offen sc1
s_waitcnt vmcnt(1)
v_cmp_gt_u32 vcc,s71,v33
v_mov_b32 v29,v33
s_cbranch_vccz pok_315
s_sub_u32 s90,s90,1
s_cmp_gt_i32 s90,0
s_cbranch_scc1 pl_314
pok_315:
nb_312:
s_barrier
s_xor_b32 m0,s91,0
s_add_u32 s65,s94,0
buffer_load_dwordx4 v16,s[20:23],s65 offen offset:0 sc1 lds
buffer_load_dwordx4 v16,s[20:23],s65 offen offset:2048 sc1 lds
s_xor_b32 m0,s91,16384
s_add_u32 s65,s94,32768
buffer_load_dwordx4 v16,s[20:23],s65 offen offset:0 sc1 lds
buffer_load_dwordx4 v16,s[20:23],s65 offen offset:2048 sc1 lds
s_xor_b32 m0,s91,32768
s_add_u32 s65,s94,65536
buffer_load_dwordx4 v16,s[20:23],s65 offen offset:0 sc1 lds
buffer_load_dwordx4 v16,s[20:23],s65 offen offset:2048 sc1 lds
s_xor_b32 m0,s91,49152
s_add_u32 s65,s94,98304
buffer_load_dwordx4 v16,s[20:23],s65 offen offset:0 sc1 lds
buffer_load_dwordx4 v16,s[20:23],s65 offen offset:2048 sc1 lds
s_waitcnt vmcnt(8)
v_add_u32 v22,s71,-1
buffer_store_dword v22,v23,s[20:23],s97 offen sc1
s_mov_b32 s97,0x7fff0000
s_waitcnt vmcnt(7)
s_barrier
ds_read_b128 v[224:227],v18 offset:0
ds_read_b128 v[228:231],v18 offset:2048
ds_read_b128 v[232:235],v18 offset:4096
ds_read_b128 v[236:239],v18 offset:6144
ds_read_b128 v[240:243],v18 offset:8192
ds_read_b128 v[244:247],v18 offset:10240
ds_read_b128 v[248:251],v18 offset:12288
s_waitcnt lgkmcnt(5)
v_mfma_f32_16x16x32_bf16 v[64:67],a[0:3],v[224:227],0
s_xor_b32 m0,s91,1024
v_min_u32 v27,v224,v228
v_mfma_f32_16x16x32_bf16 v[68:71],a[128:131],v[224:227],0
ds_read_b128 v[252:255],v18 offset:14336
v_mfma_f32_16x16x32_bf16 v[64:67],a[4:7],v[228:231],v[64:67]
s_add_u32 s65,s95,0
v_mfma_f32_16x16x32_bf16 v[68:71],a[132:135],v[228:231],v[68:71]
s_waitcnt vmcnt(5)
s_barrier
ds_read_b128 v[224:227],v18 offset:16384
s_waitcnt lgkmcnt(5)
v_mfma_f32_16x16x32_bf16 v[64:67],a[8:11],v[232:235],v[64:67]
buffer_load_dwordx4 v16,s[20:23],s65 offen offset:0 sc1 lds
v_mfma_f32_16x16x32_bf16 v[68:71],a[136:139],v[232:235],v[68:71]
ds_read_b128 v[228:231],v18 offset:18432
v_min3_u32 v27,v27,v232,v236
v_mfma_f32_16x16x32_bf16 v[64:67],a[12:15],v[236:239],v[64:67]
buffer_load_dwordx4 v16,s[20:23],s65 offen offset:2048 sc1 lds
v_mfma_f32_16x16x32_bf16 v[68:71],a[140:143],v[236:239],v[68:71]
ds_read_b128 v[232:235],v18 offset:20480
s_waitcnt lgkmcnt(5)
v_mfma_f32_16x16x32_bf16 v[64:67],a[16:19],v[240:243],v[64:67]
s_xor_b32 m0,s91,17408
v_min3_u32 v27,v27,v240,v244
v_mfma_f32_16x16x32_bf16 v[68:71],a[144:147],v[240:243],v[68:71]
ds_read_b128 v[236:239],v18 offset:22528
v_mfma_f32_16x16x32_bf16 v[64:67],a[20:23],v[244:247],v[64:67]
s_add_u32 s65,s95,32768
v_mfma_f32_16x16x32_bf16 v[68:71],a[148:151],v[244:247],v[68:71]
ds_read_b128 v[240:243],v18 offset:24576
s_waitcnt lgkmcnt(5)
v_mfma_f32_16x16x32_bf16 v[64:67],a[24:27],v[248:251],v[64:67]
buffer_load_dwordx4 v16,s[20:23],s65 offen offset:0 sc1 lds
v_mfma_f32_16x16x32_bf16 v[68:71],a[152:155],v[248:251],v[68:71]
ds_read_b128 v[244:247],v18 offset:26624
v_min3_u32 v27,v27,v248,v252
v_mfma_f32_16x16x32_bf16 v[64:67],a[28:31],v[252:255],v[64:67]
buffer_load_dwordx4 v16,s[20:23],s65 offen offset:2048 sc1 lds
v_mfma_f32_16x16x32_bf16 v[68:71],a[156:159],v[252:255],v[68:71]
ds_read_b128 v[248:251],v18 offset:28672
s_waitcnt lgkmcnt(5)
v_mfma_f32_16x16x32_bf16 v[64:67],a[32:35],v[224:227],v[64:67]
s_xor_b32 m0,s91,33792
v_min3_u32 v27,v27,v224,v228
v_mfma_f32_16x16x32_bf16 v[68:71],a[160:163],v[224:227],v[68:71]
ds_read_b128 v[252:255],v18 offset:30720
v_mfma_f32_16x16x32_bf16 v[64:67],a[36:39],v[228:231],v[64:67]
s_add_u32 s65,s95,65536
v_mfma_f32_16x16x32_bf16 v[68:71],a[164:167],v[228:231],v[68:71]
s_waitcnt vmcnt(5)
s_barrier
ds_read_b128 v[224:227],v18 offset:32768
s_waitcnt lgkmcnt(5)
v_mfma_f32_16x16x32_bf16 v[64:67],a[40:43],v[232:235],v[64:67]
buffer_load_dwordx4 v16,s[20:23],s65 offen offset:0 sc1 lds
v_mfma_f32_16x16x32_bf16 v[68:71],a[168:171],v[232:235],v[68:71]
ds_read_b128 v[228:231],v18 offset:34816
v_min3_u32 v27,v27,v232,v236
v_mfma_f32_16x16x32_bf16 v[64:67],a[44:47],v[236:239],v[64:67]
buffer_load_dwordx4 v16,s[20:23],s65 offen offset:2048 sc1 lds
v_mfma_f32_16x16x32_bf16 v[68:71],a[172:175],v[236:239],v[68:71]
ds_read_b128 v[232:235],v18 offset:36864
s_waitcnt lgkmcnt(5)
v_mfma_f32_16x16x32_bf16 v[64:67],a[48:51],v[240:243],v[64:67]
s_xor_b32 m0,s91,50176
v_min3_u32 v27,v27,v240,v244
v_mfma_f32_16x16x32_bf16 v[68:71],a[176:179],v[240:243],v[68:71]
ds_read_b128 v[236:239],v18 offset:38912
v_mfma_f32_16x16x32_bf16 v[64:67],a[52:55],v[244:247],v[64:67]
s_add_u32 s65,s95,98304
v_mfma_f32_16x16x32_bf16 v[68:71],a[180:183],v[244:247],v[68:71]
ds_read_b128 v[240:243],v18 offset:40960
s_waitcnt lgkmcnt(5)
v_mfma_f32_16x16x32_bf16 v[64:67],a[56:59],v[248:251],v[64:67]
buffer_load_dwordx4 v16,s[20:23],s65 offen offset:0 sc1 lds
v_mfma_f32_16x16x32_bf16 v[68:71],a[184:187],v[248:251],v[68:71]
ds_read_b128 v[244:247],v18 offset:43008
v_min3_u32 v27,v27,v248,v252
v_mfma_f32_16x16x32_bf16 v[64:67],a[60:63],v[252:255],v[64:67]
buffer_load_dwordx4 v16,s[20:23],s65 offen offset:2048 sc1 lds
v_mfma_f32_16x16x32_bf16 v[68:71],a[188:191],v[252:255],v[68:71]
ds_read_b128 v[248:251],v18 offset:45056
s_waitcnt lgkmcnt(5)
v_mfma_f32_16x16x32_bf16 v[64:67],a[64:67],v[224:227],v[64:67]
v_min3_u32 v27,v27,v224,v228
s_add_u32 s88,s70,s75
v_mfma_f32_16x16x32_bf16 v[68:71],a[192:195],v[224:227],v[68:71]
ds_read_b128 v[252:255],v18 offset:47104
s_add_u32 s88,s88,2097152
v_mfma_f32_16x16x32_bf16 v[64:67],a[68:71],v[228:231],v[64:67]
buffer_load_dwordx2 v[120:121],v20,s[36:39],s78 offen
v_mfma_f32_16x16x32_bf16 v[68:71],a[196:199],v[228:231],v[68:71]
ds_read_b128 v[224:227],v18 offset:49152
s_waitcnt lgkmcnt(5)
v_mfma_f32_16x16x32_bf16 v[64:67],a[72:75],v[232:235],v[64:67]
v_min3_u32 v27,v27,v232,v236
s_xor_b32 s88,s88,0x2000
v_mfma_f32_16x16x32_bf16 v[68:71],a[200:203],v[232:235],v[68:71]
ds_read_b128 v[228:231],v18 offset:51200
s_xor_b32 s89,s88,1024
v_mfma_f32_16x16x32_bf16 v[64:67],a[76:79],v[236:239],v[64:67]
v_mfma_f32_16x16x32_bf16 v[68:71],a[204:207],v[236:239],v[68:71]
ds_read_b128 v[232:235],v18 offset:53248
s_waitcnt lgkmcnt(5)
v_mfma_f32_16x16x32_bf16 v[64:67],a[80:83],v[240:243],v[64:67]
s_waitcnt vmcnt(5)
s_barrier
ds_read_b128 v[128:131],v17 offset:0
ds_read_b128 v[132:135],v17 offset:2048
v_mfma_f32_16x16x32_bf16 v[68:71],a[208:211],v[240:243],v[68:71]
ds_read_b128 v[236:239],v18 offset:55296
v_min3_u32 v27,v27,v240,v244
v_mfma_f32_16x16x32_bf16 v[64:67],a[84:87],v[244:247],v[64:67]
ds_read_b128 v[136:139],v17 offset:4096
v_mfma_f32_16x16x32_bf16 v[68:71],a[212:215],v[244:247],v[68:71]
ds_read_b128 v[240:243],v18 offset:57344
s_waitcnt lgkmcnt(8)
v_mfma_f32_16x16x32_bf16 v[64:67],a[88:91],v[248:251],v[64:67]
ds_read_b128 v[140:143],v17 offset:6144
v_min3_u32 v27,v27,v248,v252
v_mfma_f32_16x16x32_bf16 v[68:71],a[216:219],v[248:251],v[68:71]
ds_read_b128 v[244:247],v18 offset:59392
v_mfma_f32_16x16x32_bf16 v[64:67],a[92:95],v[252:255],v[64:67]
ds_read_b128 v[144:147],v17 offset:8192
ds_read_b128 v[148:151],v17 offset:10240
v_mfma_f32_16x16x32_bf16 v[68:71],a[220:223],v[252:255],v[68:71]
ds_read_b128 v[248:251],v18 offset:61440
s_waitcnt lgkmcnt(11)
v_mfma_f32_16x16x32_bf16 v[64:67],a[96:99],v[224:227],v[64:67]
ds_read_b128 v[152:155],v17 offset:12288
v_min3_u32 v27,v27,v224,v228
v_mfma_f32_16x16x32_bf16 v[68:71],a[224:227],v[224:227],v[68:71]
ds_read_b128 v[252:255],v18 offset:63488
v_mfma_f32_16x16x32_bf16 v[64:67],a[100:103],v[228:231],v[64:67]
ds_read_b128 v[156:159],v17 offset:14336
v_mfma_f32_16x16x32_bf16 v[68:71],a[228:231],v[228:231],v[68:71]
s_waitcnt lgkmcnt(10)
v_mfma_f32_16x16x32_bf16 v[64:67],a[104:107],v[232:235],v[64:67]
ds_read_b128 v[160:163],v17 offset:16384
ds_read_b128 v[164:167],v17 offset:18432
v_mfma_f32_16x16x32_bf16 v[68:71],a[232:235],v[232:235],v[68:71]
v_min3_u32 v27,v27,v232,v236
v_mfma_f32_16x16x32_bf16 v[64:67],a[108:111],v[236:239],v[64:67]
ds_read_b128 v[168:171],v17 offset:20480
v_mfma_f32_16x16x32_bf16 v[68:71],a[236:239],v[236:239],v[68:71]
s_waitcnt lgkmcnt(9)
v_mfma_f32_16x16x32_bf16 v[64:67],a[112:115],v[240:243],v[64:67]
ds_read_b128 v[172:175],v17 offset:22528
v_min3_u32 v27,v27,v240,v244
v_mfma_f32_16x16x32_bf16 v[68:71],a[240:243],v[240:243],v[68:71]
v_mfma_f32_16x16x32_bf16 v[64:67],a[116:119],v[244:247],v[64:67]
ds_read_b128 v[176:179],v17 offset:24576
ds_read_b128 v[180:183],v17 offset:26624
v_mfma_f32_16x16x32_bf16 v[68:71],a[244:247],v[244:247],v[68:71]
s_waitcnt lgkmcnt(7)
v_mfma_f32_16x16x32_bf16 v[64:67],a[120:123],v[248:251],v[64:67]
ds_read_b128 v[184:187],v17 offset:28672
v_min3_u32 v27,v27,v248,v252
v_mfma_f32_16x16x32_bf16 v[68:71],a[248:251],v[248:251],v[68:71]
v_mfma_f32_16x16x32_bf16 v[64:67],a[124:127],v[252:255],v[64:67]
ds_read_b128 v[188:191],v17 offset:30720
v_mfma_f32_16x16x32_bf16 v[68:71],a[252:255],v[252:255],v[68:71]
v_mfma_f32_16x16x32_bf16 v[72:75],a[128:131],v[128:131],0
v_cmp_eq_u32 vcc,0,v27
s_cbranch_vccnz retry_307
v_mfma_f32_16x16x32_bf16 v[76:79],a[132:135],v[132:135],0
v_min3_u32 v27,v27,v128,v132
v_mfma_f32_16x16x32_bf16 v[72:75],a[136:139],v[136:139],v[72:75]
s_waitcnt vmcnt(1)
s_barrier
ds_read_b128 v[192:195],v17 offset:32768
v_mfma_f32_16x16x32_bf16 v[76:79],a[140:143],v[140:143],v[76:79]
ds_read_b128 v[196:199],v17 offset:34816
s_waitcnt lgkmcnt(10)
v_mfma_f32_16x16x32_bf16 v[72:75],a[144:147],v[144:147],v[72:75]
ds_read_b128 v[200:203],v17 offset:36864
v_min3_u32 v27,v27,v136,v140
s_waitcnt vmcnt(0)
v_mfma_f32_16x16x32_bf16 v[76:79],a[148:151],v[148:151],v[76:79]
ds_read_b128 v[204:207],v17 offset:38912
v_min3_u32 v27,v27,v144,v148
v_and_or_b32 v64,v64,-4,s48
v_mfma_f32_16x16x32_bf16 v[72:75],a[152:155],v[152:155],v[72:75]
ds_read_b128 v[208:211],v17 offset:40960
s_add_u32 s64,s49,s34
v_mfma_f32_16x16x32_bf16 v[76:79],a[156:159],v[156:159],v[76:79]
v_min3_u32 v27,v27,v152,v156
s_waitcnt lgkmcnt(9)
v_mfma_f32_16x16x32_bf16 v[72:75],a[160:163],v[160:163],v[72:75]
ds_read_b128 v[212:215],v17 offset:43008
buffer_store_dwordx4 v[64:67],v25,s[20:23],s64 offen offset:2048 sc1
v_mfma_f32_16x16x32_bf16 v[76:79],a[164:167],v[164:167],v[76:79]
ds_read_b128 v[216:219],v17 offset:45056
v_min3_u32 v27,v27,v160,v164
v_and_or_b32 v68,v68,-4,s48
v_mfma_f32_16x16x32_bf16 v[72:75],a[168:171],v[168:171],v[72:75]
ds_read_b128 v[220:223],v17 offset:47104
s_add_u32 s64,s49,s35
v_mfma_f32_16x16x32_bf16 v[76:79],a[172:175],v[172:175],v[76:79]
ds_read_b128 v[224:227],v17 offset:49152
s_waitcnt lgkmcnt(9)
v_mfma_f32_16x16x32_bf16 v[72:75],a[176:179],v[176:179],v[72:75]
ds_read_b128 v[228:231],v17 offset:51200
v_min3_u32 v27,v27,v168,v172
v_mfma_f32_16x16x32_bf16 v[76:79],a[180:183],v[180:183],v[76:79]
v_min3_u32 v27,v27,v176,v180
buffer_store_dwordx4 v[68:71],v25,s[20:23],s64 offen offset:3072 sc1
v_mfma_f32_16x16x32_bf16 v[72:75],a[184:187],v[184:187],v[72:75]
ds_read_b128 v[232:235],v17 offset:53248
s_mov_b32 s49,0x7fff0000
v_mfma_f32_16x16x32_bf16 v[76:79],a[188:191],v[188:191],v[76:79]
ds_read_b128 v[236:239],v17 offset:55296
s_waitcnt lgkmcnt(8)
v_mfma_f32_16x16x32_bf16 v[72:75],a[192:195],v[192:195],v[72:75]
ds_read_b128 v[240:243],v17 offset:57344
v_min3_u32 v27,v27,v184,v188
v_mfma_f32_16x16x32_bf16 v[76:79],a[196:199],v[196:199],v[76:79]
ds_read_b128 v[244:247],v17 offset:59392
v_min3_u32 v27,v27,v192,v196
v_mfma_f32_16x16x32_bf16 v[72:75],a[200:203],v[200:203],v[72:75]
ds_read_b128 v[248:251],v17 offset:61440
ds_bpermute_b32 v124,v41,v120
v_mfma_f32_16x16x32_bf16 v[76:79],a[204:207],v[204:207],v[76:79]
v_min3_u32 v27,v27,v200,v204
s_waitcnt lgkmcnt(8)
v_mfma_f32_16x16x32_bf16 v[72:75],a[208:211],v[208:211],v[72:75]
ds_read_b128 v[252:255],v17 offset:63488
ds_bpermute_b32 v125,v41,v121
v_mfma_f32_16x16x32_bf16 v[76:79],a[212:215],v[212:215],v[76:79]
v_min3_u32 v27,v27,v208,v212
v_mfma_f32_16x16x32_bf16 v[72:75],a[216:219],v[216:219],v[72:75]
v_mfma_f32_16x16x32_bf16 v[76:79],a[220:223],v[220:223],v[76:79]
v_min3_u32 v27,v27,v216,v220
s_waitcnt lgkmcnt(6)
v_mfma_f32_16x16x32_bf16 v[72:75],a[224:227],v[224:227],v[72:75]
s_waitcnt lgkmcnt(0)
v_mfma_f32_16x16x32_bf16 v[76:79],a[228:231],v[228:231],v[76:79]
v_min3_u32 v27,v27,v224,v228
v_mfma_f32_16x16x32_bf16 v[72:75],a[232:235],v[232:235],v[72:75]
v_lshlrev_b32 v104,16,v124
v_mfma_f32_16x16x32_bf16 v[76:79],a[236:239],v[236:239],v[76:79]
v_min3_u32 v27,v27,v232,v236
v_mfma_f32_16x16x32_bf16 v[72:75],a[240:243],v[240:243],v[72:75]
v_mfma_f32_16x16x32_bf16 v[76:79],a[244:247],v[244:247],v[76:79]
v_min3_u32 v27,v27,v240,v244
v_mfma_f32_16x16x32_bf16 v[72:75],a[248:251],v[248:251],v[72:75]
v_and_b32 v105,s80,v124
v_mfma_f32_16x16x32_bf16 v[76:79],a[252:255],v[252:255],v[76:79]
v_min3_u32 v27,v27,v248,v252
v_mfma_f32_16x16x32_bf16 v[80:83],a[0:3],v[128:131],0
v_cmp_eq_u32 vcc,0,v27
s_cbranch_vccnz retry_307
v_mfma_f32_16x16x32_bf16 v[84:87],a[4:7],v[132:135],0
v_lshlrev_b32 v106,16,v125
v_mfma_f32_16x16x32_bf16 v[80:83],a[8:11],v[136:139],v[80:83]
v_mfma_f32_16x16x32_bf16 v[84:87],a[12:15],v[140:143],v[84:87]
v_mfma_f32_16x16x32_bf16 v[80:83],a[16:19],v[144:147],v[80:83]
v_and_b32 v107,s80,v125
v_add_f32 v72,v72,v76
v_mfma_f32_16x16x32_bf16 v[84:87],a[20:23],v[148:151],v[84:87]
v_add_f32 v73,v73,v77
v_add_f32 v74,v74,v78
v_mfma_f32_16x16x32_bf16 v[80:83],a[24:27],v[152:155],v[80:83]
v_add_f32 v75,v75,v79
v_and_or_b32 v72,v72,-4,s48
v_mfma_f32_16x16x32_bf16 v[84:87],a[28:31],v[156:159],v[84:87]
s_add_u32 s64,s77,s33
v_mfma_f32_16x16x32_bf16 v[80:83],a[32:35],v[160:163],v[80:83]
buffer_store_dwordx4 v[72:75],v25,s[20:23],s64 offen offset:1024 sc1
v_mfma_f32_16x16x32_bf16 v[84:87],a[36:39],v[164:167],v[84:87]
v_mfma_f32_16x16x32_bf16 v[80:83],a[40:43],v[168:171],v[80:83]
v_mfma_f32_16x16x32_bf16 v[84:87],a[44:47],v[172:175],v[84:87]
v_mfma_f32_16x16x32_bf16 v[80:83],a[48:51],v[176:179],v[80:83]
v_mfma_f32_16x16x32_bf16 v[84:87],a[52:55],v[180:183],v[84:87]
v_mfma_f32_16x16x32_bf16 v[80:83],a[56:59],v[184:187],v[80:83]
v_mfma_f32_16x16x32_bf16 v[84:87],a[60:63],v[188:191],v[84:87]
v_mfma_f32_16x16x32_bf16 v[80:83],a[64:67],v[192:195],v[80:83]
buffer_load_dwordx4 v[96:99],v26,s[20:23],s77 offen offset:2048 sc1
v_mfma_f32_16x16x32_bf16 v[84:87],a[68:71],v[196:199],v[84:87]
buffer_load_dwordx4 v[100:103],v26,s[20:23],s77 offen offset:3072 sc1
v_mfma_f32_16x16x32_bf16 v[80:83],a[72:75],v[200:203],v[80:83]
v_mfma_f32_16x16x32_bf16 v[84:87],a[76:79],v[204:207],v[84:87]
v_mfma_f32_16x16x32_bf16 v[80:83],a[80:83],v[208:211],v[80:83]
v_mfma_f32_16x16x32_bf16 v[84:87],a[84:87],v[212:215],v[84:87]
v_mfma_f32_16x16x32_bf16 v[80:83],a[88:91],v[216:219],v[80:83]
v_mfma_f32_16x16x32_bf16 v[84:87],a[92:95],v[220:223],v[84:87]
v_mfma_f32_16x16x32_bf16 v[80:83],a[96:99],v[224:227],v[80:83]
v_mfma_f32_16x16x32_bf16 v[84:87],a[100:103],v[228:231],v[84:87]
v_mfma_f32_16x16x32_bf16 v[80:83],a[104:107],v[232:235],v[80:83]
buffer_load_dwordx4 v[92:95],v26,s[20:23],s77 offen offset:1024 sc1
v_mfma_f32_16x16x32_bf16 v[84:87],a[108:111],v[236:239],v[84:87]
v_mfma_f32_16x16x32_bf16 v[80:83],a[112:115],v[240:243],v[80:83]
v_mfma_f32_16x16x32_bf16 v[84:87],a[116:119],v[244:247],v[84:87]
v_mfma_f32_16x16x32_bf16 v[80:83],a[120:123],v[248:251],v[80:83]
v_mfma_f32_16x16x32_bf16 v[84:87],a[124:127],v[252:255],v[84:87]
epi_310:
buffer_load_dword v29,v21,s[20:23],s87 offen sc1
s_nop 6
v_pk_add_f32 v[88:89],v[80:81],v[84:85]
v_pk_add_f32 v[90:91],v[82:83],v[86:87]
s_waitcnt vmcnt(1)
s_branch ic_320
ip_318:
buffer_load_dwordx4 v[92:95],v26,s[20:23],s77 offen offset:1024 sc1
buffer_load_dwordx4 v[96:99],v26,s[20:23],s77 offen offset:2048 sc1
buffer_load_dwordx4 v[100:103],v26,s[20:23],s77 offen offset:3072 sc1
s_waitcnt vmcnt(0)
ic_320:
v_bitop3_b32 v22,v92,v96,v100 bitop3:0x80
v_and_b32 v22,s48,v22
v_cmp_eq_u32 vcc,0,v22
s_cbranch_vccz ik_319
s_sub_u32 s90,s90,1
s_cmp_gt_i32 s90,0
s_cbranch_scc1 ip_318
ik_319:
v_pk_add_f32 v[88:89],v[88:89],v[92:93]
v_pk_add_f32 v[96:97],v[96:97],v[100:101]
v_pk_add_f32 v[90:91],v[90:91],v[94:95]
v_pk_add_f32 v[98:99],v[98:99],v[102:103]
v_pk_add_f32 v[88:89],v[88:89],v[96:97]
v_pk_add_f32 v[90:91],v[90:91],v[98:99]
v_pk_fma_f32 v[88:89],v[88:89],v[52:53],v[104:105]
v_pk_fma_f32 v[90:91],v[90:91],v[54:55],v[106:107]
v_cvt_pk_bf16_f32 v88,v88,v89
v_cvt_pk_bf16_f32 v89,v90,v91
v_max_u32 v88,1,v88
ds_bpermute_b32 v88,v40,v88
ds_bpermute_b32 v89,v40,v89
v_xor_b32 v18,0x10000,v18
s_xor_b32 s49,s77,524288
s_cselect_b32 s64,0,3
s_xor_b32 s48,s48,s64
s_waitcnt lgkmcnt(0)
buffer_store_dwordx2 v[88:89],v19,s[20:23],s70 offen sc1
s_mov_b32 s77,s49
s_add_u32 s78,s78,65536
s_cmp_gt_u32 s71,40
s_cselect_b32 s65,s73,0x7fff0000
s_cselect_b32 s97,0x7fff0000,s73
v_mov_b32 v22,s71
buffer_store_dword v22,v23,s[20:23],s65 offen sc1
next_317:
v_xor_b32 v17,0x10000,v17
s_xor_b32 s72,s72,0x10000
s_add_u32 s70,s70,2097152
s_xor_b32 s70,s70,0x2000
s_add_u32 s71,s71,1
s_cmp_le_u32 s71,64
s_cbranch_scc1 seg_308
s_endpgm
retry_307:
s_sub_u32 s90,s90,64
s_cmp_lt_i32 s90,0
s_cbranch_scc1 giveup_197
s_mov_b32 s83,1
s_waitcnt vmcnt(0) lgkmcnt(0)
s_barrier
s_branch seg_308
r_w4_216:
s_load_dwordx2 s[4:5],s[0:1],88
s_load_dwordx2 s[6:7],s[0:1],112
s_lshr_b32 s41,s59,3
s_and_b32 s42,s59,7
s_mul_i32 s66,s41,1835008
s_lshl_b32 s64,s42,8
s_add_u32 s66,s66,s64
s_lshl_b32 s67,s50,1
s_and_b32 s64,s41,1
s_add_u32 s67,s67,s64
s_waitcnt lgkmcnt(0)
s_mov_b32 s32,s4
s_and_b32 s33,s5,0xffff
s_mov_b32 s34,0x700000
s_mov_b32 s35,0x20000
s_sub_u32 s36,s6,0x1000
s_subb_u32 s37,s7,0
s_and_b32 s37,s37,0xffff
s_mov_b32 s38,0x401000
s_mov_b32 s39,0x20000
v_lshrrev_b32 v5,2,v3
v_lshl_add_u32 v5,v4,2,v5
v_and_b32 v6,3,v3
v_lshlrev_b32 v6,3,v6
v_lshl_add_u32 v6,v5,8,v6
v_and_b32 v5,7,v5
v_xor_b32 v5,s67,v5
v_lshl_add_u32 v12,v5,5,v6
v_xor_b32 v13,32,v12
v_and_b32 v5,15,v1
v_and_b32 v6,3,v4
v_lshlrev_b32 v6,1,v6
v_xor_b32 v5,v5,v6
v_mul_u32_u24 v6,2048,v4
v_xor_b32 v7,0,v5
v_lshl_add_u32 v8,v7,4,v6
v_xor_b32 v7,8,v5
v_lshl_add_u32 v9,v7,4,v6
s_mul_i32 s74,s50,131072
s_add_u32 s74,s74,s66
s_lshl_b32 s75,s50,14
s_mul_i32 s76,s50,65536
s_add_u32 s76,s76,s66
s_lshl_b32 s77,s50,13
s_add_u32 s64,s74,0
s_add_u32 m0,s75,0
s_nop 0
buffer_load_dwordx4 v8,s[32:35],s64 offen nt lds
s_add_u32 s64,s74,8192
s_add_u32 m0,s75,1024
s_nop 0
buffer_load_dwordx4 v9,s[32:35],s64 offen nt lds
s_add_u32 s64,s74,16384
s_add_u32 m0,s75,2048
s_nop 0
buffer_load_dwordx4 v8,s[32:35],s64 offen nt lds
s_add_u32 s64,s74,24576
s_add_u32 m0,s75,3072
s_nop 0
buffer_load_dwordx4 v9,s[32:35],s64 offen nt lds
s_add_u32 s64,s74,32768
s_add_u32 m0,s75,4096
s_nop 0
buffer_load_dwordx4 v8,s[32:35],s64 offen nt lds
s_add_u32 s64,s74,40960
s_add_u32 m0,s75,5120
s_nop 0
buffer_load_dwordx4 v9,s[32:35],s64 offen nt lds
s_add_u32 s64,s74,49152
s_add_u32 m0,s75,6144
s_nop 0
buffer_load_dwordx4 v8,s[32:35],s64 offen nt lds
s_add_u32 s64,s74,57344
s_add_u32 m0,s75,7168
s_nop 0
buffer_load_dwordx4 v9,s[32:35],s64 offen nt lds
s_add_u32 s64,s74,65536
s_add_u32 m0,s75,8192
s_nop 0
buffer_load_dwordx4 v8,s[32:35],s64 offen nt lds
s_add_u32 s64,s74,73728
s_add_u32 m0,s75,9216
s_nop 0
buffer_load_dwordx4 v9,s[32:35],s64 offen nt lds
s_add_u32 s64,s74,81920
s_add_u32 m0,s75,10240
s_nop 0
buffer_load_dwordx4 v8,s[32:35],s64 offen nt lds
s_add_u32 s64,s74,90112
s_add_u32 m0,s75,11264
s_nop 0
buffer_load_dwordx4 v9,s[32:35],s64 offen nt lds
s_add_u32 s64,s74,98304
s_add_u32 m0,s75,12288
s_nop 0
buffer_load_dwordx4 v8,s[32:35],s64 offen nt lds
s_add_u32 s64,s74,106496
s_add_u32 m0,s75,13312
s_nop 0
buffer_load_dwordx4 v9,s[32:35],s64 offen nt lds
s_add_u32 s64,s74,114688
s_add_u32 m0,s75,14336
s_nop 0
buffer_load_dwordx4 v8,s[32:35],s64 offen nt lds
s_add_u32 s64,s74,122880
s_add_u32 m0,s75,15360
s_nop 0
buffer_load_dwordx4 v9,s[32:35],s64 offen nt lds
s_add_u32 s64,s74,524288
s_add_u32 m0,s75,65536
s_nop 0
buffer_load_dwordx4 v8,s[32:35],s64 offen nt lds
s_add_u32 s64,s74,532480
s_add_u32 m0,s75,66560
s_nop 0
buffer_load_dwordx4 v9,s[32:35],s64 offen nt lds
s_add_u32 s64,s74,540672
s_add_u32 m0,s75,67584
s_nop 0
buffer_load_dwordx4 v8,s[32:35],s64 offen nt lds
s_add_u32 s64,s74,548864
s_add_u32 m0,s75,68608
s_nop 0
buffer_load_dwordx4 v9,s[32:35],s64 offen nt lds
s_add_u32 s64,s74,557056
s_add_u32 m0,s75,69632
s_nop 0
buffer_load_dwordx4 v8,s[32:35],s64 offen nt lds
s_add_u32 s64,s74,565248
s_add_u32 m0,s75,70656
s_nop 0
buffer_load_dwordx4 v9,s[32:35],s64 offen nt lds
s_add_u32 s64,s74,573440
s_add_u32 m0,s75,71680
s_nop 0
buffer_load_dwordx4 v8,s[32:35],s64 offen nt lds
s_add_u32 s64,s74,581632
s_add_u32 m0,s75,72704
s_nop 0
buffer_load_dwordx4 v9,s[32:35],s64 offen nt lds
s_add_u32 s64,s74,589824
s_add_u32 m0,s75,73728
s_nop 0
buffer_load_dwordx4 v8,s[32:35],s64 offen nt lds
s_add_u32 s64,s74,598016
s_add_u32 m0,s75,74752
s_nop 0
buffer_load_dwordx4 v9,s[32:35],s64 offen nt lds
s_add_u32 s64,s74,606208
s_add_u32 m0,s75,75776
s_nop 0
buffer_load_dwordx4 v8,s[32:35],s64 offen nt lds
s_add_u32 s64,s74,614400
s_add_u32 m0,s75,76800
s_nop 0
buffer_load_dwordx4 v9,s[32:35],s64 offen nt lds
s_add_u32 s64,s74,622592
s_add_u32 m0,s75,77824
s_nop 0
buffer_load_dwordx4 v8,s[32:35],s64 offen nt lds
s_add_u32 s64,s74,630784
s_add_u32 m0,s75,78848
s_nop 0
buffer_load_dwordx4 v9,s[32:35],s64 offen nt lds
s_add_u32 s64,s74,638976
s_add_u32 m0,s75,79872
s_nop 0
buffer_load_dwordx4 v8,s[32:35],s64 offen nt lds
s_add_u32 s64,s74,647168
s_add_u32 m0,s75,80896
s_nop 0
buffer_load_dwordx4 v9,s[32:35],s64 offen nt lds
s_waitcnt vmcnt(16)
s_barrier
ds_read_b64_tr_b16 a[0:1],v12 offset:0
ds_read_b64_tr_b16 a[112:113],v13 offset:0
ds_read_b64_tr_b16 a[2:3],v12 offset:4096
ds_read_b64_tr_b16 a[114:115],v13 offset:4096
ds_read_b64_tr_b16 a[4:5],v12 offset:8192
ds_read_b64_tr_b16 a[116:117],v13 offset:8192
ds_read_b64_tr_b16 a[6:7],v12 offset:12288
ds_read_b64_tr_b16 a[118:119],v13 offset:12288
s_waitcnt lgkmcnt(4)
ds_read_b64_tr_b16 a[8:9],v12 offset:16384
ds_read_b64_tr_b16 a[120:121],v13 offset:16384
ds_read_b64_tr_b16 a[10:11],v12 offset:20480
ds_read_b64_tr_b16 a[122:123],v13 offset:20480
ds_read_b64_tr_b16 a[12:13],v12 offset:28672
ds_read_b64_tr_b16 a[124:125],v13 offset:28672
ds_read_b64_tr_b16 a[14:15],v12 offset:32768
ds_read_b64_tr_b16 a[126:127],v13 offset:32768
s_waitcnt lgkmcnt(4)
ds_read_b64_tr_b16 a[16:17],v12 offset:36864
ds_read_b64_tr_b16 a[128:129],v13 offset:36864
ds_read_b64_tr_b16 a[18:19],v12 offset:40960
ds_read_b64_tr_b16 a[130:131],v13 offset:40960
ds_read_b64_tr_b16 a[20:21],v12 offset:45056
ds_read_b64_tr_b16 a[132:133],v13 offset:45056
ds_read_b64_tr_b16 a[22:23],v12 offset:49152
ds_read_b64_tr_b16 a[134:135],v13 offset:49152
s_waitcnt lgkmcnt(4)
ds_read_b64_tr_b16 a[24:25],v12 offset:57344
ds_read_b64_tr_b16 a[136:137],v13 offset:57344
ds_read_b64_tr_b16 a[26:27],v12 offset:61440
ds_read_b64_tr_b16 a[138:139],v13 offset:61440
ds_read_b64_tr_b16 a[96:97],v12 offset:24576
ds_read_b64_tr_b16 a[208:209],v13 offset:24576
ds_read_b64_tr_b16 a[98:99],v12 offset:53248
ds_read_b64_tr_b16 a[210:211],v13 offset:53248
s_waitcnt lgkmcnt(4)
v_xor_b32 v12,0x10000,v12
v_xor_b32 v13,0x10000,v13
s_waitcnt lgkmcnt(0)
s_barrier
s_add_u32 s64,s74,1048576
s_add_u32 m0,s75,0
s_nop 0
buffer_load_dwordx4 v8,s[32:35],s64 offen nt lds
s_add_u32 s64,s74,1056768
s_add_u32 m0,s75,1024
s_nop 0
buffer_load_dwordx4 v9,s[32:35],s64 offen nt lds
s_add_u32 s64,s74,1064960
s_add_u32 m0,s75,2048
s_nop 0
buffer_load_dwordx4 v8,s[32:35],s64 offen nt lds
s_add_u32 s64,s74,1073152
s_add_u32 m0,s75,3072
s_nop 0
buffer_load_dwordx4 v9,s[32:35],s64 offen nt lds
s_add_u32 s64,s74,1081344
s_add_u32 m0,s75,4096
s_nop 0
buffer_load_dwordx4 v8,s[32:35],s64 offen nt lds
s_add_u32 s64,s74,1089536
s_add_u32 m0,s75,5120
s_nop 0
buffer_load_dwordx4 v9,s[32:35],s64 offen nt lds
s_add_u32 s64,s74,1097728
s_add_u32 m0,s75,6144
s_nop 0
buffer_load_dwordx4 v8,s[32:35],s64 offen nt lds
s_add_u32 s64,s74,1105920
s_add_u32 m0,s75,7168
s_nop 0
buffer_load_dwordx4 v9,s[32:35],s64 offen nt lds
s_add_u32 s64,s74,1114112
s_add_u32 m0,s75,8192
s_nop 0
buffer_load_dwordx4 v8,s[32:35],s64 offen nt lds
s_add_u32 s64,s74,1122304
s_add_u32 m0,s75,9216
s_nop 0
buffer_load_dwordx4 v9,s[32:35],s64 offen nt lds
s_add_u32 s64,s74,1130496
s_add_u32 m0,s75,10240
s_nop 0
buffer_load_dwordx4 v8,s[32:35],s64 offen nt lds
s_add_u32 s64,s74,1138688
s_add_u32 m0,s75,11264
s_nop 0
buffer_load_dwordx4 v9,s[32:35],s64 offen nt lds
s_add_u32 s64,s74,1146880
s_add_u32 m0,s75,12288
s_nop 0
buffer_load_dwordx4 v8,s[32:35],s64 offen nt lds
s_add_u32 s64,s74,1155072
s_add_u32 m0,s75,13312
s_nop 0
buffer_load_dwordx4 v9,s[32:35],s64 offen nt lds
s_add_u32 s64,s74,1163264
s_add_u32 m0,s75,14336
s_nop 0
buffer_load_dwordx4 v8,s[32:35],s64 offen nt lds
s_add_u32 s64,s74,1171456
s_add_u32 m0,s75,15360
s_nop 0
buffer_load_dwordx4 v9,s[32:35],s64 offen nt lds
s_waitcnt vmcnt(16)
s_barrier
ds_read_b64_tr_b16 a[28:29],v12 offset:0
ds_read_b64_tr_b16 a[140:141],v13 offset:0
ds_read_b64_tr_b16 a[30:31],v12 offset:4096
ds_read_b64_tr_b16 a[142:143],v13 offset:4096
ds_read_b64_tr_b16 a[32:33],v12 offset:8192
ds_read_b64_tr_b16 a[144:145],v13 offset:8192
ds_read_b64_tr_b16 a[34:35],v12 offset:12288
ds_read_b64_tr_b16 a[146:147],v13 offset:12288
s_waitcnt lgkmcnt(4)
ds_read_b64_tr_b16 a[36:37],v12 offset:20480
ds_read_b64_tr_b16 a[148:149],v13 offset:20480
ds_read_b64_tr_b16 a[38:39],v12 offset:24576
ds_read_b64_tr_b16 a[150:151],v13 offset:24576
ds_read_b64_tr_b16 a[40:41],v12 offset:28672
ds_read_b64_tr_b16 a[152:153],v13 offset:28672
ds_read_b64_tr_b16 a[42:43],v12 offset:32768
ds_read_b64_tr_b16 a[154:155],v13 offset:32768
s_waitcnt lgkmcnt(4)
ds_read_b64_tr_b16 a[44:45],v12 offset:36864
ds_read_b64_tr_b16 a[156:157],v13 offset:36864
ds_read_b64_tr_b16 a[46:47],v12 offset:40960
ds_read_b64_tr_b16 a[158:159],v13 offset:40960
ds_read_b64_tr_b16 a[48:49],v12 offset:49152
ds_read_b64_tr_b16 a[160:161],v13 offset:49152
ds_read_b64_tr_b16 a[50:51],v12 offset:53248
ds_read_b64_tr_b16 a[162:163],v13 offset:53248
s_waitcnt lgkmcnt(4)
ds_read_b64_tr_b16 a[52:53],v12 offset:57344
ds_read_b64_tr_b16 a[164:165],v13 offset:57344
ds_read_b64_tr_b16 a[54:55],v12 offset:61440
ds_read_b64_tr_b16 a[166:167],v13 offset:61440
ds_read_b64_tr_b16 a[100:101],v12 offset:16384
ds_read_b64_tr_b16 a[212:213],v13 offset:16384
ds_read_b64_tr_b16 a[102:103],v12 offset:45056
ds_read_b64_tr_b16 a[214:215],v13 offset:45056
s_waitcnt lgkmcnt(4)
v_xor_b32 v12,0x10000,v12
v_xor_b32 v13,0x10000,v13
s_waitcnt lgkmcnt(0)
s_barrier
s_add_u32 s64,s76,1572864
s_add_u32 m0,s77,65536
s_nop 0
buffer_load_dwordx4 v8,s[32:35],s64 offen nt lds
s_add_u32 s64,s76,1581056
s_add_u32 m0,s77,66560
s_nop 0
buffer_load_dwordx4 v9,s[32:35],s64 offen nt lds
s_add_u32 s64,s76,1589248
s_add_u32 m0,s77,67584
s_nop 0
buffer_load_dwordx4 v8,s[32:35],s64 offen nt lds
s_add_u32 s64,s76,1597440
s_add_u32 m0,s77,68608
s_nop 0
buffer_load_dwordx4 v9,s[32:35],s64 offen nt lds
s_add_u32 s64,s76,1605632
s_add_u32 m0,s77,69632
s_nop 0
buffer_load_dwordx4 v8,s[32:35],s64 offen nt lds
s_add_u32 s64,s76,1613824
s_add_u32 m0,s77,70656
s_nop 0
buffer_load_dwordx4 v9,s[32:35],s64 offen nt lds
s_add_u32 s64,s76,1622016
s_add_u32 m0,s77,71680
s_nop 0
buffer_load_dwordx4 v8,s[32:35],s64 offen nt lds
s_add_u32 s64,s76,1630208
s_add_u32 m0,s77,72704
s_nop 0
buffer_load_dwordx4 v9,s[32:35],s64 offen nt lds
s_waitcnt vmcnt(8)
s_barrier
ds_read_b64_tr_b16 a[56:57],v12 offset:0
ds_read_b64_tr_b16 a[168:169],v13 offset:0
ds_read_b64_tr_b16 a[58:59],v12 offset:4096
ds_read_b64_tr_b16 a[170:171],v13 offset:4096
ds_read_b64_tr_b16 a[60:61],v12 offset:12288
ds_read_b64_tr_b16 a[172:173],v13 offset:12288
ds_read_b64_tr_b16 a[62:63],v12 offset:16384
ds_read_b64_tr_b16 a[174:175],v13 offset:16384
s_waitcnt lgkmcnt(4)
ds_read_b64_tr_b16 a[64:65],v12 offset:20480
ds_read_b64_tr_b16 a[176:177],v13 offset:20480
ds_read_b64_tr_b16 a[66:67],v12 offset:24576
ds_read_b64_tr_b16 a[178:179],v13 offset:24576
ds_read_b64_tr_b16 a[68:69],v12 offset:28672
ds_read_b64_tr_b16 a[180:181],v13 offset:28672
ds_read_b64_tr_b16 a[70:71],v12 offset:32768
ds_read_b64_tr_b16 a[182:183],v13 offset:32768
s_waitcnt lgkmcnt(4)
ds_read_b64_tr_b16 a[72:73],v12 offset:40960
ds_read_b64_tr_b16 a[184:185],v13 offset:40960
ds_read_b64_tr_b16 a[74:75],v12 offset:45056
ds_read_b64_tr_b16 a[186:187],v13 offset:45056
ds_read_b64_tr_b16 a[76:77],v12 offset:49152
ds_read_b64_tr_b16 a[188:189],v13 offset:49152
ds_read_b64_tr_b16 a[78:79],v12 offset:53248
ds_read_b64_tr_b16 a[190:191],v13 offset:53248
s_waitcnt lgkmcnt(4)
ds_read_b64_tr_b16 a[80:81],v12 offset:57344
ds_read_b64_tr_b16 a[192:193],v13 offset:57344
ds_read_b64_tr_b16 a[82:83],v12 offset:61440
ds_read_b64_tr_b16 a[194:195],v13 offset:61440
ds_read_b64_tr_b16 a[104:105],v12 offset:8192
ds_read_b64_tr_b16 a[216:217],v13 offset:8192
ds_read_b64_tr_b16 a[106:107],v12 offset:36864
ds_read_b64_tr_b16 a[218:219],v13 offset:36864
s_waitcnt lgkmcnt(4)
v_xor_b32 v12,0x10000,v12
v_xor_b32 v13,0x10000,v13
s_waitcnt lgkmcnt(0)
s_barrier
s_waitcnt vmcnt(0)
s_barrier
ds_read_b64_tr_b16 a[84:85],v12 offset:4096
ds_read_b64_tr_b16 a[196:197],v13 offset:4096
ds_read_b64_tr_b16 a[86:87],v12 offset:8192
ds_read_b64_tr_b16 a[198:199],v13 offset:8192
ds_read_b64_tr_b16 a[88:89],v12 offset:12288
ds_read_b64_tr_b16 a[200:201],v13 offset:12288
ds_read_b64_tr_b16 a[90:91],v12 offset:16384
ds_read_b64_tr_b16 a[202:203],v13 offset:16384
s_waitcnt lgkmcnt(4)
ds_read_b64_tr_b16 a[92:93],v12 offset:20480
ds_read_b64_tr_b16 a[204:205],v13 offset:20480
ds_read_b64_tr_b16 a[94:95],v12 offset:24576
ds_read_b64_tr_b16 a[206:207],v13 offset:24576
ds_read_b64_tr_b16 a[108:109],v12 offset:0
ds_read_b64_tr_b16 a[220:221],v13 offset:0
ds_read_b64_tr_b16 a[110:111],v12 offset:28672
ds_read_b64_tr_b16 a[222:223],v13 offset:28672
s_waitcnt lgkmcnt(4)
v_xor_b32 v12,0x10000,v12
v_xor_b32 v13,0x10000,v13
s_waitcnt lgkmcnt(0)
s_barrier
v_and_b32 v21,1,v1
v_mul_u32_u24 v21,960,v21
s_mov_b32 s65,21052032
s_mov_b32 s66,1792
pl_323:
buffer_load_dword v22,v21,s[20:23],s65 offen sc1
s_waitcnt vmcnt(0)
v_cmp_gt_u32 vcc,s66,v22
s_cbranch_vccz pok_324
s_sleep 1
s_sub_u32 s90,s90,1
s_cmp_gt_i32 s90,0
s_cbranch_scc1 pl_323
pok_324:
s_lshr_b32 s43,s41,1
s_and_b32 s48,s41,1
s_lshl_b32 s64,s42,7
s_lshl_b32 s65,s50,5
s_add_u32 s64,s64,s65
s_lshl_b32 s65,s48,4
s_add_u32 s64,s64,s65
v_lshl_add_u32 v5,v4,2,s64
v_lshlrev_b32 v6,2,v5
s_mov_b32 s64,20480
buffer_load_dwordx4 v[52:55],v6,s[20:23],s64 offen sc1
v_lshlrev_b32 v10,1,v5
v_and_b32 v6,3,v1
v_sub_u32 v5,v6,v4
v_lshl_add_u32 v5,v5,3,v10
v_lshrrev_b32 v11,2,v1
v_lshl_add_u32 v40,v6,4,v11
v_lshlrev_b32 v40,2,v40
v_lshl_add_u32 v41,v3,2,v4
v_lshlrev_b32 v41,2,v41
s_lshl_b32 s64,s43,10
v_add_u32 v17,s64,v16
v_xor_b32 v18,1024,v17
s_xor_b32 s64,s64,1024
s_lshr_b32 s65,s50,1
s_and_b32 s66,s50,1
s_lshl_b32 s66,s66,12
s_add_u32 s66,s66,s64
s_lshl_b32 s72,s65,13
s_add_u32 s72,s72,s66
s_add_u32 s72,s72,0x10000
s_lshl_b32 s65,s65,14
s_add_u32 s75,s65,s66
s_add_u32 s75,s75,1327104
s_mul_i32 s64,s41,114688
s_add_u32 s75,s75,s64
s_cmp_lt_u32 s50,2
s_cselect_b32 s86,98304,0x40000000
s_lshl_b32 s76,s79,21
s_add_u32 s76,s76,27262976
s_mov_b32 s77,0
s_lshl_b32 s78,s79,16
s_mov_b32 s49,0
s_cmp_eq_u32 s79,0
s_mov_b32 s66,8577024
s_cselect_b32 s66,18874368,s66
s_lshl_b32 s64,s59,14
s_lshl_b32 s65,s50,12
s_add_u32 s65,s65,s66
s_add_u32 s64,s64,s65
v_add_u32 v26,s64,v16
s_lshl_b32 s64,s42,14
s_add_u32 s64,s64,s65
v_add_u32 v25,s64,v16
s_xor_b32 s33,s41,1
s_xor_b32 s34,s41,2
s_xor_b32 s35,s41,3
s_lshl_b32 s33,s33,17
s_lshl_b32 s34,s34,17
s_lshl_b32 s35,s35,17
v_and_b32 v21,7,v1
v_lshlrev_b32 v21,7,v21
v_bfe_u32 v6,v1,3,2
v_lshl_add_u32 v21,v6,2,v21
s_lshl_b32 s74,s41,10
s_add_u32 s74,s74,s63
s_lshl_b32 s64,s60,4
s_add_u32 s74,s74,s64
s_add_u32 s74,s74,20480
s_lshl_b32 s64,s43,4
v_add_u32 v6,s64,v11
v_lshl_add_u32 v19,v6,11,v5
v_add_u32 v6,s64,v11
v_add_u32 v6,30,v6
v_lshl_add_u32 v9,v6,7,v5
v_and_b32 v9,2047,v9
v_and_b32 v7,3,v6
v_lshl_add_u32 v7,v7,11,v9
v_bfe_u32 v8,v6,2,3
v_lshl_add_u32 v7,v8,14,v7
v_mov_b32 v8,0x2000
v_mov_b32 v9,2097152
v_cmp_gt_u32 vcc,32,v6
s_nop 1
v_cndmask_b32 v8,v9,v8,vcc
v_add_u32 v7,v7,v8
v_add_u32 v7,1048576,v7
v_xor_b32 v20,s62,v7
s_lshl_b32 s64,s42,14
s_lshl_b32 s65,s50,11
s_add_u32 s64,s64,s65
s_lshl_b32 s65,s43,10
s_add_u32 s64,s64,s65
s_lshl_b32 s65,s48,3
s_add_u32 s64,s64,s65
s_add_u32 s64,s64,1179648
v_add_u32 v24,s64,v16
s_mov_b32 s84,0xffffff00
s_or_b32 s64,s43,s79
s_cselect_b32 s84,-1,s84
s_mov_b32 s85,-1
s_mov_b32 s48,1
s_waitcnt vmcnt(0)
s_cmp_lg_u32 s56,0
s_cbranch_scc1 kslow_325
s_add_u32 s64,s79,0
s_lshl_b32 s70,s64,21
s_lshl_b32 s64,s64,13
s_and_b32 s64,s64,0x2000
s_xor_b32 s64,s64,s62
s_add_u32 s70,s70,s64
s_add_u32 s70,s70,29360128
s_mov_b32 s83,1
s_mov_b32 s87,s74
s_cmp_eq_u32 s50,0
s_cselect_b32 s74,s74,0x7fff0000
v_mov_b32 v47,132096
s_lshl_b32 s64,s50,3
s_add_u32 s64,s64,132096
v_mov_b32 v46,s64
v_mov_b32 v29,0
s_mov_b32 s97,0x7fff0000
s_mov_b32 s69,1
s_mov_b32 s68,0
s_mov_b32 s52,0x30003
s_mov_b32 s53,s52
seg_327:
s_cmp_eq_u32 s83,0
s_cbranch_scc1 ahead_328
s_add_u32 s94,s70,s75
s_xor_b32 s95,s94,1024
s_xor_b32 s91,s72,0x10000
s_cmp_eq_u32 s69,0
s_mov_b32 s69,1
s_cbranch_scc1 half2_332
s_waitcnt vmcnt(1)
v_cmp_gt_u32 vcc,s71,v29
s_cbranch_vccz nb_331
s_cmp_lg_u32 s50,0
s_cbranch_scc1 nb_331
buffer_load_dword v32,v21,s[20:23],s74 offen sc1
s_sleep 2
pl_333:
buffer_load_dword v33,v21,s[20:23],s74 offen sc1
s_waitcnt vmcnt(1)
v_cmp_gt_u32 vcc,s71,v32
v_mov_b32 v29,v32
s_cbranch_vccz pok_334
buffer_load_dword v32,v21,s[20:23],s74 offen sc1
s_waitcnt vmcnt(1)
v_cmp_gt_u32 vcc,s71,v33
v_mov_b32 v29,v33
s_cbranch_vccz pok_334
s_sub_u32 s90,s90,1
s_cmp_gt_i32 s90,0
s_cbranch_scc1 pl_333
pok_334:
nb_331:
s_cmp_eq_u32 s71,64
s_barrier
s_cbranch_scc1 half_335
s_xor_b32 m0,s91,0
s_add_u32 s65,s94,0
buffer_load_dwordx4 v16,s[20:23],s65 offen offset:0 sc1 lds
buffer_load_dwordx4 v16,s[20:23],s65 offen offset:2048 sc1 lds
s_xor_b32 m0,s91,16384
s_add_u32 s65,s94,32768
buffer_load_dwordx4 v16,s[20:23],s65 offen offset:0 sc1 lds
buffer_load_dwordx4 v16,s[20:23],s65 offen offset:2048 sc1 lds
s_xor_b32 m0,s91,32768
s_add_u32 s65,s94,65536
buffer_load_dwordx4 v16,s[20:23],s65 offen offset:0 sc1 lds
buffer_load_dwordx4 v16,s[20:23],s65 offen offset:2048 sc1 lds
s_xor_b32 m0,s91,49152
s_add_u32 s65,s94,s86
buffer_load_dwordx4 v16,s[20:23],s65 offen offset:0 sc1 lds
buffer_load_dwordx4 v16,s[20:23],s65 offen offset:2048 sc1 lds
s_waitcnt vmcnt(6)
s_barrier
ds_read_b128 v[224:227],v18 offset:0
ds_read_b128 v[228:231],v18 offset:2048
ds_read_b128 v[232:235],v18 offset:4096
ds_read_b128 v[236:239],v18 offset:6144
ds_read_b128 v[240:243],v18 offset:8192
ds_read_b128 v[244:247],v18 offset:10240
ds_read_b128 v[248:251],v18 offset:12288
s_waitcnt lgkmcnt(5)
v_mfma_f32_16x16x32_bf16 v[64:67],a[0:3],v[224:227],0
s_xor_b32 m0,s91,1024
s_add_u32 s96,s71,1
s_add_u32 s92,s71,2
v_min_u32 v27,v224,v228
v_mfma_f32_16x16x32_bf16 v[68:71],a[112:115],v[224:227],0
ds_read_b128 v[252:255],v18 offset:14336
s_cmp_eq_u32 s96,64
s_cselect_b32 s96,99,s96
v_mfma_f32_16x16x32_bf16 v[64:67],a[4:7],v[228:231],v[64:67]
s_add_u32 s65,s95,0
s_cmp_eq_u32 s92,64
s_cselect_b32 s92,99,s92
v_mfma_f32_16x16x32_bf16 v[68:71],a[116:119],v[228:231],v[68:71]
s_waitcnt vmcnt(4)
s_barrier
ds_read_b128 v[224:227],v18 offset:16384
s_waitcnt lgkmcnt(5)
v_mfma_f32_16x16x32_bf16 v[64:67],a[8:11],v[232:235],v[64:67]
buffer_load_dwordx4 v16,s[20:23],s65 offen offset:0 sc1 lds
v_mfma_f32_16x16x32_bf16 v[68:71],a[120:123],v[232:235],v[68:71]
ds_read_b128 v[228:231],v18 offset:18432
v_min3_u32 v27,v27,v232,v236
v_mfma_f32_16x16x32_bf16 v[64:67],a[12:15],v[236:239],v[64:67]
buffer_load_dwordx4 v16,s[20:23],s65 offen offset:2048 sc1 lds
v_mfma_f32_16x16x32_bf16 v[68:71],a[124:127],v[236:239],v[68:71]
ds_read_b128 v[232:235],v18 offset:20480
s_waitcnt lgkmcnt(5)
v_mfma_f32_16x16x32_bf16 v[64:67],a[16:19],v[240:243],v[64:67]
s_xor_b32 m0,s91,17408
v_min3_u32 v27,v27,v240,v244
v_mfma_f32_16x16x32_bf16 v[68:71],a[128:131],v[240:243],v[68:71]
ds_read_b128 v[236:239],v18 offset:22528
v_mfma_f32_16x16x32_bf16 v[64:67],a[20:23],v[244:247],v[64:67]
s_add_u32 s65,s95,32768
s_waitcnt vmcnt(63)
v_mfma_f32_16x16x32_bf16 v[68:71],a[132:135],v[244:247],v[68:71]
ds_read_b128 v[240:243],v18 offset:24576
s_waitcnt lgkmcnt(5)
v_mfma_f32_16x16x32_bf16 v[64:67],a[24:27],v[248:251],v[64:67]
buffer_load_dwordx4 v16,s[20:23],s65 offen offset:0 sc1 lds
v_min3_u32 v27,v27,v248,v252
v_mfma_f32_16x16x32_bf16 v[68:71],a[136:139],v[248:251],v[68:71]
ds_read_b128 v[244:247],v18 offset:26624
v_cmp_gt_u32 vcc,s96,v29
v_cmp_gt_u32 s[92:93],s92,v29
v_mfma_f32_16x16x32_bf16 v[64:67],a[28:31],v[252:255],v[64:67]
buffer_load_dwordx4 v16,s[20:23],s65 offen offset:2048 sc1 lds
v_mfma_f32_16x16x32_bf16 v[68:71],a[140:143],v[252:255],v[68:71]
ds_read_b128 v[248:251],v18 offset:28672
s_waitcnt lgkmcnt(5)
v_mfma_f32_16x16x32_bf16 v[64:67],a[32:35],v[224:227],v[64:67]
s_xor_b32 m0,s91,33792
v_mov_b32 v44,vcc_lo
v_mov_b32 v45,s92
v_mfma_f32_16x16x32_bf16 v[68:71],a[144:147],v[224:227],v[68:71]
ds_read_b128 v[252:255],v18 offset:30720
ds_write_b64 v46,v[44:45]
v_mfma_f32_16x16x32_bf16 v[64:67],a[36:39],v[228:231],v[64:67]
s_add_u32 s65,s95,65536
v_min3_u32 v27,v27,v224,v228
v_mfma_f32_16x16x32_bf16 v[68:71],a[148:151],v[228:231],v[68:71]
s_waitcnt vmcnt(4)
s_barrier
ds_read_b128 v[224:227],v18 offset:32768
s_waitcnt lgkmcnt(6)
v_mfma_f32_16x16x32_bf16 v[64:67],a[40:43],v[232:235],v[64:67]
buffer_load_dwordx4 v16,s[20:23],s65 offen offset:0 sc1 lds
s_add_u32 s88,s70,s75
v_mfma_f32_16x16x32_bf16 v[68:71],a[152:155],v[232:235],v[68:71]
ds_read_b128 v[228:231],v18 offset:34816
v_min3_u32 v27,v27,v232,v236
s_add_u32 s88,s88,2097152
v_mfma_f32_16x16x32_bf16 v[64:67],a[44:47],v[236:239],v[64:67]
buffer_load_dwordx4 v16,s[20:23],s65 offen offset:2048 sc1 lds
v_mfma_f32_16x16x32_bf16 v[68:71],a[156:159],v[236:239],v[68:71]
ds_read_b128 v[232:235],v18 offset:36864
s_waitcnt lgkmcnt(6)
v_mfma_f32_16x16x32_bf16 v[64:67],a[48:51],v[240:243],v[64:67]
s_xor_b32 m0,s91,50176
v_min3_u32 v27,v27,v240,v244
v_mfma_f32_16x16x32_bf16 v[68:71],a[160:163],v[240:243],v[68:71]
ds_read_b128 v[236:239],v18 offset:38912
s_xor_b32 s88,s88,0x2000
v_mfma_f32_16x16x32_bf16 v[64:67],a[52:55],v[244:247],v[64:67]
s_add_u32 s65,s95,s86
s_xor_b32 s89,s88,1024
v_mfma_f32_16x16x32_bf16 v[68:71],a[164:167],v[244:247],v[68:71]
ds_read_b128 v[240:243],v18 offset:40960
s_waitcnt lgkmcnt(6)
v_mfma_f32_16x16x32_bf16 v[64:67],a[56:59],v[248:251],v[64:67]
buffer_load_dwordx4 v16,s[20:23],s65 offen offset:0 sc1 lds
v_mfma_f32_16x16x32_bf16 v[68:71],a[168:171],v[248:251],v[68:71]
ds_read_b128 v[244:247],v18 offset:43008
v_min3_u32 v27,v27,v248,v252
v_mfma_f32_16x16x32_bf16 v[64:67],a[60:63],v[252:255],v[64:67]
buffer_load_dwordx4 v16,s[20:23],s65 offen offset:2048 sc1 lds
v_mfma_f32_16x16x32_bf16 v[68:71],a[172:175],v[252:255],v[68:71]
ds_read_b128 v[248:251],v18 offset:45056
s_waitcnt lgkmcnt(5)
v_mfma_f32_16x16x32_bf16 v[64:67],a[64:67],v[224:227],v[64:67]
s_waitcnt vmcnt(4)
s_barrier
ds_read_b64 v[44:45],v47
ds_read_b128 v[128:131],v17 offset:0
ds_read_b128 v[132:135],v17 offset:2048
v_mfma_f32_16x16x32_bf16 v[68:71],a[176:179],v[224:227],v[68:71]
ds_read_b128 v[252:255],v18 offset:47104
v_min3_u32 v27,v27,v224,v228
v_mfma_f32_16x16x32_bf16 v[64:67],a[68:71],v[228:231],v[64:67]
ds_read_b128 v[136:139],v17 offset:4096
buffer_load_dwordx2 v[120:121],v20,s[20:23],s76 offen sc1
v_mfma_f32_16x16x32_bf16 v[68:71],a[180:183],v[228:231],v[68:71]
ds_read_b128 v[224:227],v18 offset:49152
s_waitcnt lgkmcnt(9)
v_mfma_f32_16x16x32_bf16 v[64:67],a[72:75],v[232:235],v[64:67]
ds_read_b128 v[140:143],v17 offset:6144
v_min3_u32 v27,v27,v232,v236
v_mfma_f32_16x16x32_bf16 v[68:71],a[184:187],v[232:235],v[68:71]
ds_read_b128 v[228:231],v18 offset:51200
buffer_load_dwordx2 v[122:123],v24,s[20:23],s70 offen sc1
v_mfma_f32_16x16x32_bf16 v[64:67],a[76:79],v[236:239],v[64:67]
ds_read_b128 v[144:147],v17 offset:8192
ds_read_b128 v[148:151],v17 offset:10240
v_mfma_f32_16x16x32_bf16 v[68:71],a[188:191],v[236:239],v[68:71]
ds_read_b128 v[232:235],v18 offset:53248
s_waitcnt lgkmcnt(12)
v_mfma_f32_16x16x32_bf16 v[64:67],a[80:83],v[240:243],v[64:67]
ds_read_b128 v[152:155],v17 offset:12288
s_waitcnt lgkmcnt(11)
v_min3_u32 v27,v27,v240,v244
v_mfma_f32_16x16x32_bf16 v[68:71],a[192:195],v[240:243],v[68:71]
ds_read_b128 v[236:239],v18 offset:55296
v_readfirstlane_b32 s93,v45
v_mfma_f32_16x16x32_bf16 v[64:67],a[84:87],v[244:247],v[64:67]
ds_read_b128 v[156:159],v17 offset:14336
v_readfirstlane_b32 s83,v44
s_cmp_lg_u32 s83,0
s_cbranch_scc0 keep_337
v_mfma_f32_16x16x32_bf16 v[68:71],a[196:199],v[244:247],v[68:71]
s_waitcnt lgkmcnt(10)
v_mfma_f32_16x16x32_bf16 v[64:67],a[88:91],v[248:251],v[64:67]
ds_read_b128 v[160:163],v17 offset:16384
ds_read_b128 v[164:167],v17 offset:18432
v_mfma_f32_16x16x32_bf16 v[68:71],a[200:203],v[248:251],v[68:71]
v_min3_u32 v27,v27,v248,v252
v_mfma_f32_16x16x32_bf16 v[64:67],a[92:95],v[252:255],v[64:67]
ds_read_b128 v[168:171],v17 offset:20480
v_mfma_f32_16x16x32_bf16 v[68:71],a[204:207],v[252:255],v[68:71]
s_waitcnt lgkmcnt(9)
v_mfma_f32_16x16x32_bf16 v[64:67],a[96:99],v[224:227],v[64:67]
ds_read_b128 v[172:175],v17 offset:22528
v_min3_u32 v27,v27,v224,v228
v_mfma_f32_16x16x32_bf16 v[68:71],a[208:211],v[224:227],v[68:71]
v_min3_u32 v27,v27,v226,v230
v_mfma_f32_16x16x32_bf16 v[64:67],a[100:103],v[228:231],v[64:67]
ds_read_b128 v[176:179],v17 offset:24576
ds_read_b128 v[180:183],v17 offset:26624
v_mfma_f32_16x16x32_bf16 v[68:71],a[212:215],v[228:231],v[68:71]
s_waitcnt lgkmcnt(7)
v_mfma_f32_16x16x32_bf16 v[64:67],a[104:107],v[232:235],v[64:67]
ds_read_b128 v[184:187],v17 offset:28672
v_min3_u32 v27,v27,v232,v236
v_mfma_f32_16x16x32_bf16 v[68:71],a[216:219],v[232:235],v[68:71]
v_min3_u32 v27,v27,v234,v238
v_mfma_f32_16x16x32_bf16 v[64:67],a[108:111],v[236:239],v[64:67]
ds_read_b128 v[188:191],v17 offset:30720
v_mfma_f32_16x16x32_bf16 v[68:71],a[220:223],v[236:239],v[68:71]
v_mfma_f32_16x16x32_bf16 v[72:75],a[112:115],v[128:131],0
v_cmp_eq_u32 vcc,0,v27
s_cbranch_vccnz retry_326
v_mfma_f32_16x16x32_bf16 v[76:79],a[116:119],v[132:135],0
v_min3_u32 v27,v27,v128,v132
v_mfma_f32_16x16x32_bf16 v[72:75],a[120:123],v[136:139],v[72:75]
s_waitcnt vmcnt(2)
s_barrier
ds_read_b128 v[192:195],v17 offset:32768
v_mfma_f32_16x16x32_bf16 v[76:79],a[124:127],v[140:143],v[76:79]
ds_read_b128 v[196:199],v17 offset:34816
s_waitcnt lgkmcnt(10)
v_mfma_f32_16x16x32_bf16 v[72:75],a[128:131],v[144:147],v[72:75]
ds_read_b128 v[200:203],v17 offset:36864
v_min3_u32 v27,v27,v136,v140
s_waitcnt vmcnt(0)
v_mfma_f32_16x16x32_bf16 v[76:79],a[132:135],v[148:151],v[76:79]
ds_read_b128 v[204:207],v17 offset:38912
v_min3_u32 v27,v27,v144,v148
v_and_or_b32 v64,v64,-4,s48
v_mfma_f32_16x16x32_bf16 v[72:75],a[136:139],v[152:155],v[72:75]
ds_read_b128 v[208:211],v17 offset:40960
s_add_u32 s64,s49,s34
v_mfma_f32_16x16x32_bf16 v[76:79],a[140:143],v[156:159],v[76:79]
v_min3_u32 v27,v27,v152,v156
s_waitcnt lgkmcnt(9)
v_mfma_f32_16x16x32_bf16 v[72:75],a[144:147],v[160:163],v[72:75]
ds_read_b128 v[212:215],v17 offset:43008
buffer_store_dwordx4 v[64:67],v25,s[20:23],s64 offen offset:2048
v_mfma_f32_16x16x32_bf16 v[76:79],a[148:151],v[164:167],v[76:79]
ds_read_b128 v[216:219],v17 offset:45056
v_min3_u32 v27,v27,v160,v164
v_and_or_b32 v68,v68,-4,s48
v_mfma_f32_16x16x32_bf16 v[72:75],a[152:155],v[168:171],v[72:75]
ds_read_b128 v[220:223],v17 offset:47104
s_add_u32 s64,s49,s35
v_mfma_f32_16x16x32_bf16 v[76:79],a[156:159],v[172:175],v[76:79]
ds_read_b128 v[224:227],v17 offset:49152
s_waitcnt lgkmcnt(9)
v_mfma_f32_16x16x32_bf16 v[72:75],a[160:163],v[176:179],v[72:75]
ds_read_b128 v[228:231],v17 offset:51200
v_min3_u32 v27,v27,v168,v172
v_mfma_f32_16x16x32_bf16 v[76:79],a[164:167],v[180:183],v[76:79]
v_min3_u32 v27,v27,v176,v180
buffer_store_dwordx4 v[68:71],v25,s[20:23],s64 offen offset:3072
v_mfma_f32_16x16x32_bf16 v[72:75],a[168:171],v[184:187],v[72:75]
ds_read_b128 v[232:235],v17 offset:53248
s_mov_b32 s49,0x7fff0000
v_mfma_f32_16x16x32_bf16 v[76:79],a[172:175],v[188:191],v[76:79]
ds_read_b128 v[236:239],v17 offset:55296
s_waitcnt lgkmcnt(8)
v_mfma_f32_16x16x32_bf16 v[72:75],a[176:179],v[192:195],v[72:75]
v_min3_u32 v27,v27,v184,v188
v_mfma_f32_16x16x32_bf16 v[76:79],a[180:183],v[196:199],v[76:79]
v_min3_u32 v27,v27,v192,v196
ds_bpermute_b32 v124,v41,v120
v_mfma_f32_16x16x32_bf16 v[72:75],a[184:187],v[200:203],v[72:75]
v_mfma_f32_16x16x32_bf16 v[76:79],a[188:191],v[204:207],v[76:79]
v_min3_u32 v27,v27,v200,v204
s_waitcnt lgkmcnt(5)
v_mfma_f32_16x16x32_bf16 v[72:75],a[192:195],v[208:211],v[72:75]
ds_bpermute_b32 v125,v41,v121
v_mfma_f32_16x16x32_bf16 v[76:79],a[196:199],v[212:215],v[76:79]
v_min3_u32 v27,v27,v208,v212
v_lshlrev_b32 v108,16,v122
v_mfma_f32_16x16x32_bf16 v[72:75],a[200:203],v[216:219],v[72:75]
v_mfma_f32_16x16x32_bf16 v[76:79],a[204:207],v[220:223],v[76:79]
v_min3_u32 v27,v27,v216,v220
s_waitcnt lgkmcnt(2)
v_mfma_f32_16x16x32_bf16 v[72:75],a[208:211],v[224:227],v[72:75]
v_and_b32 v109,s80,v122
v_mfma_f32_16x16x32_bf16 v[76:79],a[212:215],v[228:231],v[76:79]
v_min3_u32 v27,v27,v224,v228
v_min3_u32 v27,v27,v226,v230
v_mfma_f32_16x16x32_bf16 v[72:75],a[216:219],v[232:235],v[72:75]
v_lshlrev_b32 v110,16,v123
v_mfma_f32_16x16x32_bf16 v[76:79],a[220:223],v[236:239],v[76:79]
v_min3_u32 v27,v27,v232,v236
v_min3_u32 v27,v27,v234,v238
v_mfma_f32_16x16x32_bf16 v[80:83],a[0:3],v[128:131],0
v_cmp_eq_u32 vcc,0,v27
s_cbranch_vccnz retry_326
v_mfma_f32_16x16x32_bf16 v[84:87],a[4:7],v[132:135],0
v_and_b32 v111,s80,v123
s_waitcnt lgkmcnt(0)
v_mfma_f32_16x16x32_bf16 v[80:83],a[8:11],v[136:139],v[80:83]
v_mfma_f32_16x16x32_bf16 v[84:87],a[12:15],v[140:143],v[84:87]
v_lshlrev_b32 v104,16,v124
v_mfma_f32_16x16x32_bf16 v[80:83],a[16:19],v[144:147],v[80:83]
v_add_f32 v72,v72,v76
v_add_f32 v73,v73,v77
v_mfma_f32_16x16x32_bf16 v[84:87],a[20:23],v[148:151],v[84:87]
v_and_b32 v105,s80,v124
v_add_f32 v74,v74,v78
v_mfma_f32_16x16x32_bf16 v[80:83],a[24:27],v[152:155],v[80:83]
v_add_f32 v75,v75,v79
v_and_or_b32 v72,v72,-4,s48
v_mfma_f32_16x16x32_bf16 v[84:87],a[28:31],v[156:159],v[84:87]
v_lshlrev_b32 v106,16,v125
s_add_u32 s64,s77,s33
v_mfma_f32_16x16x32_bf16 v[80:83],a[32:35],v[160:163],v[80:83]
buffer_store_dwordx4 v[72:75],v25,s[20:23],s64 offen offset:1024
v_mfma_f32_16x16x32_bf16 v[84:87],a[36:39],v[164:167],v[84:87]
v_and_b32 v107,s80,v125
v_mfma_f32_16x16x32_bf16 v[80:83],a[40:43],v[168:171],v[80:83]
v_mfma_f32_16x16x32_bf16 v[84:87],a[44:47],v[172:175],v[84:87]
v_mfma_f32_16x16x32_bf16 v[80:83],a[48:51],v[176:179],v[80:83]
buffer_load_dwordx4 v[96:99],v26,s[20:23],s77 offen offset:2048 sc1
v_mfma_f32_16x16x32_bf16 v[84:87],a[52:55],v[180:183],v[84:87]
buffer_load_dwordx4 v[100:103],v26,s[20:23],s77 offen offset:3072 sc1
v_mfma_f32_16x16x32_bf16 v[80:83],a[56:59],v[184:187],v[80:83]
v_mfma_f32_16x16x32_bf16 v[84:87],a[60:63],v[188:191],v[84:87]
v_mfma_f32_16x16x32_bf16 v[80:83],a[64:67],v[192:195],v[80:83]
v_mfma_f32_16x16x32_bf16 v[84:87],a[68:71],v[196:199],v[84:87]
v_mfma_f32_16x16x32_bf16 v[80:83],a[72:75],v[200:203],v[80:83]
v_mfma_f32_16x16x32_bf16 v[84:87],a[76:79],v[204:207],v[84:87]
v_mfma_f32_16x16x32_bf16 v[80:83],a[80:83],v[208:211],v[80:83]
v_mfma_f32_16x16x32_bf16 v[84:87],a[84:87],v[212:215],v[84:87]
v_mfma_f32_16x16x32_bf16 v[80:83],a[88:91],v[216:219],v[80:83]
buffer_load_dwordx4 v[92:95],v26,s[20:23],s77 offen offset:1024 sc1
v_mfma_f32_16x16x32_bf16 v[84:87],a[92:95],v[220:223],v[84:87]
v_mfma_f32_16x16x32_bf16 v[80:83],a[96:99],v[224:227],v[80:83]
v_mfma_f32_16x16x32_bf16 v[84:87],a[100:103],v[228:231],v[84:87]
v_mfma_f32_16x16x32_bf16 v[80:83],a[104:107],v[232:235],v[80:83]
v_mfma_f32_16x16x32_bf16 v[84:87],a[108:111],v[236:239],v[84:87]
s_branch epi_329
keep_337:
v_mfma_f32_16x16x32_bf16 v[68:71],a[196:199],v[244:247],v[68:71]
s_xor_b32 m0,s72,0
s_add_u32 s65,s88,0
s_waitcnt lgkmcnt(10)
v_mfma_f32_16x16x32_bf16 v[64:67],a[88:91],v[248:251],v[64:67]
ds_read_b128 v[160:163],v17 offset:16384
ds_read_b128 v[164:167],v17 offset:18432
v_min3_u32 v27,v27,v248,v252
v_mfma_f32_16x16x32_bf16 v[68:71],a[200:203],v[248:251],v[68:71]
buffer_load_dwordx4 v16,s[20:23],s65 offen offset:0 sc1 lds
v_mfma_f32_16x16x32_bf16 v[64:67],a[92:95],v[252:255],v[64:67]
ds_read_b128 v[168:171],v17 offset:20480
buffer_load_dwordx4 v16,s[20:23],s65 offen offset:2048 sc1 lds
v_mfma_f32_16x16x32_bf16 v[68:71],a[204:207],v[252:255],v[68:71]
s_xor_b32 m0,s72,16384
s_add_u32 s65,s88,32768
s_waitcnt lgkmcnt(9)
v_mfma_f32_16x16x32_bf16 v[64:67],a[96:99],v[224:227],v[64:67]
ds_read_b128 v[172:175],v17 offset:22528
buffer_load_dwordx4 v16,s[20:23],s65 offen offset:0 sc1 lds
v_min3_u32 v27,v27,v224,v228
v_mfma_f32_16x16x32_bf16 v[68:71],a[208:211],v[224:227],v[68:71]
buffer_load_dwordx4 v16,s[20:23],s65 offen offset:2048 sc1 lds
v_min3_u32 v27,v27,v226,v230
v_mfma_f32_16x16x32_bf16 v[64:67],a[100:103],v[228:231],v[64:67]
ds_read_b128 v[176:179],v17 offset:24576
ds_read_b128 v[180:183],v17 offset:26624
s_xor_b32 m0,s72,32768
v_mfma_f32_16x16x32_bf16 v[68:71],a[212:215],v[228:231],v[68:71]
s_add_u32 s65,s88,65536
s_waitcnt lgkmcnt(7)
v_mfma_f32_16x16x32_bf16 v[64:67],a[104:107],v[232:235],v[64:67]
ds_read_b128 v[184:187],v17 offset:28672
buffer_load_dwordx4 v16,s[20:23],s65 offen offset:0 sc1 lds
v_mfma_f32_16x16x32_bf16 v[68:71],a[216:219],v[232:235],v[68:71]
buffer_load_dwordx4 v16,s[20:23],s65 offen offset:2048 sc1 lds
v_min3_u32 v27,v27,v232,v236
v_mfma_f32_16x16x32_bf16 v[64:67],a[108:111],v[236:239],v[64:67]
ds_read_b128 v[188:191],v17 offset:30720
s_xor_b32 m0,s72,49152
v_min3_u32 v27,v27,v234,v238
v_mfma_f32_16x16x32_bf16 v[68:71],a[220:223],v[236:239],v[68:71]
s_add_u32 s65,s88,s86
v_mfma_f32_16x16x32_bf16 v[72:75],a[112:115],v[128:131],0
buffer_load_dwordx4 v16,s[20:23],s65 offen offset:0 sc1 lds
v_cmp_eq_u32 vcc,0,v27
s_cbranch_vccnz retry_326
v_mfma_f32_16x16x32_bf16 v[76:79],a[116:119],v[132:135],0
buffer_load_dwordx4 v16,s[20:23],s65 offen offset:2048 sc1 lds
v_mfma_f32_16x16x32_bf16 v[72:75],a[120:123],v[136:139],v[72:75]
s_waitcnt vmcnt(10)
s_barrier
ds_read_b128 v[192:195],v17 offset:32768
v_mfma_f32_16x16x32_bf16 v[76:79],a[124:127],v[140:143],v[76:79]
ds_read_b128 v[196:199],v17 offset:34816
s_xor_b32 m0,s72,1024
s_waitcnt lgkmcnt(10)
v_mfma_f32_16x16x32_bf16 v[72:75],a[128:131],v[144:147],v[72:75]
ds_read_b128 v[200:203],v17 offset:36864
s_add_u32 s65,s89,0
s_waitcnt vmcnt(8)
v_and_or_b32 v64,v64,-4,s48
v_mfma_f32_16x16x32_bf16 v[76:79],a[132:135],v[148:151],v[76:79]
ds_read_b128 v[204:207],v17 offset:38912
buffer_load_dwordx4 v16,s[20:23],s65 offen offset:0 sc1 lds
s_add_u32 s64,s49,s34
v_mfma_f32_16x16x32_bf16 v[72:75],a[136:139],v[152:155],v[72:75]
ds_read_b128 v[208:211],v17 offset:40960
buffer_load_dwordx4 v16,s[20:23],s65 offen offset:2048 sc1 lds
v_mfma_f32_16x16x32_bf16 v[76:79],a[140:143],v[156:159],v[76:79]
s_xor_b32 m0,s72,17408
s_add_u32 s65,s89,32768
s_waitcnt lgkmcnt(9)
v_mfma_f32_16x16x32_bf16 v[72:75],a[144:147],v[160:163],v[72:75]
ds_read_b128 v[212:215],v17 offset:43008
buffer_load_dwordx4 v16,s[20:23],s65 offen offset:0 sc1 lds
v_mfma_f32_16x16x32_bf16 v[76:79],a[148:151],v[164:167],v[76:79]
ds_read_b128 v[216:219],v17 offset:45056
buffer_load_dwordx4 v16,s[20:23],s65 offen offset:2048 sc1 lds
v_mfma_f32_16x16x32_bf16 v[72:75],a[152:155],v[168:171],v[72:75]
ds_read_b128 v[220:223],v17 offset:47104
s_xor_b32 m0,s72,33792
buffer_store_dwordx4 v[64:67],v25,s[20:23],s64 offen offset:2048
v_mfma_f32_16x16x32_bf16 v[76:79],a[156:159],v[172:175],v[76:79]
ds_read_b128 v[224:227],v17 offset:49152
v_and_or_b32 v68,v68,-4,s48
s_add_u32 s64,s49,s35
s_waitcnt lgkmcnt(9)
v_mfma_f32_16x16x32_bf16 v[72:75],a[160:163],v[176:179],v[72:75]
ds_read_b128 v[228:231],v17 offset:51200
s_add_u32 s65,s89,65536
buffer_store_dwordx4 v[68:71],v25,s[20:23],s64 offen offset:3072
v_mfma_f32_16x16x32_bf16 v[76:79],a[164:167],v[180:183],v[76:79]
buffer_load_dwordx4 v16,s[20:23],s65 offen offset:0 sc1 lds
s_mov_b32 s49,0x7fff0000
v_mfma_f32_16x16x32_bf16 v[72:75],a[168:171],v[184:187],v[72:75]
ds_read_b128 v[232:235],v17 offset:53248
v_min3_u32 v27,v27,v128,v132
v_mfma_f32_16x16x32_bf16 v[76:79],a[172:175],v[188:191],v[76:79]
ds_read_b128 v[236:239],v17 offset:55296
s_waitcnt lgkmcnt(8)
v_mfma_f32_16x16x32_bf16 v[72:75],a[176:179],v[192:195],v[72:75]
buffer_load_dwordx4 v16,s[20:23],s65 offen offset:2048 sc1 lds
v_mfma_f32_16x16x32_bf16 v[76:79],a[180:183],v[196:199],v[76:79]
s_xor_b32 m0,s72,50176
s_add_u32 s65,s89,s86
v_mfma_f32_16x16x32_bf16 v[72:75],a[184:187],v[200:203],v[72:75]
buffer_load_dwordx4 v16,s[20:23],s65 offen offset:0 sc1 lds
v_mfma_f32_16x16x32_bf16 v[76:79],a[188:191],v[204:207],v[76:79]
v_min3_u32 v27,v27,v136,v140
s_waitcnt lgkmcnt(4)
v_mfma_f32_16x16x32_bf16 v[72:75],a[192:195],v[208:211],v[72:75]
buffer_load_dwordx4 v16,s[20:23],s65 offen offset:2048 sc1 lds
v_mfma_f32_16x16x32_bf16 v[76:79],a[196:199],v[212:215],v[76:79]
v_min3_u32 v27,v27,v144,v148
v_min3_u32 v27,v27,v152,v156
v_mfma_f32_16x16x32_bf16 v[72:75],a[200:203],v[216:219],v[72:75]
v_min3_u32 v27,v27,v160,v164
v_min3_u32 v27,v27,v168,v172
v_mfma_f32_16x16x32_bf16 v[76:79],a[204:207],v[220:223],v[76:79]
v_min3_u32 v27,v27,v176,v180
s_waitcnt lgkmcnt(0)
v_mfma_f32_16x16x32_bf16 v[72:75],a[208:211],v[224:227],v[72:75]
v_min3_u32 v27,v27,v184,v188
v_min3_u32 v27,v27,v192,v196
v_mfma_f32_16x16x32_bf16 v[76:79],a[212:215],v[228:231],v[76:79]
v_min3_u32 v27,v27,v200,v204
v_min3_u32 v27,v27,v208,v212
v_mfma_f32_16x16x32_bf16 v[72:75],a[216:219],v[232:235],v[72:75]
v_min3_u32 v27,v27,v216,v220
v_min3_u32 v27,v27,v224,v228
v_mfma_f32_16x16x32_bf16 v[76:79],a[220:223],v[236:239],v[76:79]
v_min3_u32 v27,v27,v226,v230
v_min3_u32 v27,v27,v232,v236
v_min3_u32 v27,v27,v234,v238
v_mfma_f32_16x16x32_bf16 v[80:83],a[0:3],v[128:131],0
v_cmp_eq_u32 vcc,0,v27
s_cbranch_vccnz retry_326
v_mfma_f32_16x16x32_bf16 v[84:87],a[4:7],v[132:135],0
ds_bpermute_b32 v124,v41,v120
ds_bpermute_b32 v125,v41,v121
v_mfma_f32_16x16x32_bf16 v[80:83],a[8:11],v[136:139],v[80:83]
v_lshlrev_b32 v108,16,v122
v_and_b32 v109,s80,v122
v_mfma_f32_16x16x32_bf16 v[84:87],a[12:15],v[140:143],v[84:87]
v_lshlrev_b32 v110,16,v123
v_and_b32 v111,s80,v123
v_mfma_f32_16x16x32_bf16 v[80:83],a[16:19],v[144:147],v[80:83]
s_waitcnt lgkmcnt(0)
v_lshlrev_b32 v104,16,v124
v_mfma_f32_16x16x32_bf16 v[84:87],a[20:23],v[148:151],v[84:87]
v_and_b32 v105,s80,v124
v_add_f32 v72,v72,v76
v_mfma_f32_16x16x32_bf16 v[80:83],a[24:27],v[152:155],v[80:83]
v_add_f32 v73,v73,v77
v_add_f32 v74,v74,v78
v_mfma_f32_16x16x32_bf16 v[84:87],a[28:31],v[156:159],v[84:87]
v_lshlrev_b32 v106,16,v125
v_add_f32 v75,v75,v79
v_mfma_f32_16x16x32_bf16 v[80:83],a[32:35],v[160:163],v[80:83]
v_and_or_b32 v72,v72,-4,s48
s_add_u32 s64,s77,s33
v_mfma_f32_16x16x32_bf16 v[84:87],a[36:39],v[164:167],v[84:87]
v_and_b32 v107,s80,v125
v_mfma_f32_16x16x32_bf16 v[80:83],a[40:43],v[168:171],v[80:83]
buffer_store_dwordx4 v[72:75],v25,s[20:23],s64 offen offset:1024
v_mfma_f32_16x16x32_bf16 v[84:87],a[44:47],v[172:175],v[84:87]
v_mfma_f32_16x16x32_bf16 v[80:83],a[48:51],v[176:179],v[80:83]
buffer_load_dwordx4 v[96:99],v26,s[20:23],s77 offen offset:2048 sc1
v_mfma_f32_16x16x32_bf16 v[84:87],a[52:55],v[180:183],v[84:87]
buffer_load_dwordx4 v[100:103],v26,s[20:23],s77 offen offset:3072 sc1
v_mfma_f32_16x16x32_bf16 v[80:83],a[56:59],v[184:187],v[80:83]
v_mfma_f32_16x16x32_bf16 v[84:87],a[60:63],v[188:191],v[84:87]
v_mfma_f32_16x16x32_bf16 v[80:83],a[64:67],v[192:195],v[80:83]
v_mfma_f32_16x16x32_bf16 v[84:87],a[68:71],v[196:199],v[84:87]
v_mfma_f32_16x16x32_bf16 v[80:83],a[72:75],v[200:203],v[80:83]
v_mfma_f32_16x16x32_bf16 v[84:87],a[76:79],v[204:207],v[84:87]
v_mfma_f32_16x16x32_bf16 v[80:83],a[80:83],v[208:211],v[80:83]
v_mfma_f32_16x16x32_bf16 v[84:87],a[84:87],v[212:215],v[84:87]
v_mfma_f32_16x16x32_bf16 v[80:83],a[88:91],v[216:219],v[80:83]
buffer_load_dwordx4 v[92:95],v26,s[20:23],s77 offen offset:1024 sc1
v_mfma_f32_16x16x32_bf16 v[84:87],a[92:95],v[220:223],v[84:87]
v_mfma_f32_16x16x32_bf16 v[80:83],a[96:99],v[224:227],v[80:83]
v_mfma_f32_16x16x32_bf16 v[84:87],a[100:103],v[228:231],v[84:87]
v_mfma_f32_16x16x32_bf16 v[80:83],a[104:107],v[232:235],v[80:83]
v_mfma_f32_16x16x32_bf16 v[84:87],a[108:111],v[236:239],v[84:87]
s_branch epi_329
ahead_328:
s_cmp_eq_u32 s93,0
s_cbranch_scc1 both_330
s_waitcnt vmcnt(14) lgkmcnt(0)
s_barrier
ds_read_b128 v[224:227],v18 offset:0
ds_read_b128 v[228:231],v18 offset:2048
ds_read_b128 v[232:235],v18 offset:4096
ds_read_b128 v[236:239],v18 offset:6144
ds_read_b128 v[240:243],v18 offset:8192
ds_read_b128 v[244:247],v18 offset:10240
ds_read_b128 v[248:251],v18 offset:12288
s_waitcnt lgkmcnt(5)
v_mfma_f32_16x16x32_bf16 v[64:67],a[0:3],v[224:227],0
s_add_u32 s96,s71,1
s_add_u32 s92,s71,2
v_mfma_f32_16x16x32_bf16 v[68:71],a[112:115],v[224:227],0
ds_read_b128 v[252:255],v18 offset:14336
v_min_u32 v27,v224,v228
v_mfma_f32_16x16x32_bf16 v[64:67],a[4:7],v[228:231],v[64:67]
s_cmp_eq_u32 s96,64
s_cselect_b32 s96,99,s96
v_mfma_f32_16x16x32_bf16 v[68:71],a[116:119],v[228:231],v[68:71]
ds_read_b128 v[224:227],v18 offset:16384
s_waitcnt lgkmcnt(5)
v_mfma_f32_16x16x32_bf16 v[64:67],a[8:11],v[232:235],v[64:67]
s_cmp_eq_u32 s92,64
s_cselect_b32 s92,99,s92
v_mfma_f32_16x16x32_bf16 v[68:71],a[120:123],v[232:235],v[68:71]
ds_read_b128 v[228:231],v18 offset:18432
v_min3_u32 v27,v27,v232,v236
v_mfma_f32_16x16x32_bf16 v[64:67],a[12:15],v[236:239],v[64:67]
buffer_load_dwordx2 v[120:121],v20,s[20:23],s76 offen sc1
v_mfma_f32_16x16x32_bf16 v[68:71],a[124:127],v[236:239],v[68:71]
ds_read_b128 v[232:235],v18 offset:20480
s_waitcnt lgkmcnt(5)
v_mfma_f32_16x16x32_bf16 v[64:67],a[16:19],v[240:243],v[64:67]
v_min3_u32 v27,v27,v240,v244
v_mfma_f32_16x16x32_bf16 v[68:71],a[128:131],v[240:243],v[68:71]
ds_read_b128 v[236:239],v18 offset:22528
v_mfma_f32_16x16x32_bf16 v[64:67],a[20:23],v[244:247],v[64:67]
s_waitcnt vmcnt(2)
v_mfma_f32_16x16x32_bf16 v[68:71],a[132:135],v[244:247],v[68:71]
ds_read_b128 v[240:243],v18 offset:24576
s_waitcnt lgkmcnt(5)
v_mfma_f32_16x16x32_bf16 v[64:67],a[24:27],v[248:251],v[64:67]
v_cmp_gt_u32 vcc,s96,v29
v_cmp_gt_u32 s[92:93],s92,v29
v_mfma_f32_16x16x32_bf16 v[68:71],a[136:139],v[248:251],v[68:71]
ds_read_b128 v[244:247],v18 offset:26624
v_min3_u32 v27,v27,v248,v252
v_mfma_f32_16x16x32_bf16 v[64:67],a[28:31],v[252:255],v[64:67]
v_mov_b32 v44,vcc_lo
v_mov_b32 v45,s92
v_mfma_f32_16x16x32_bf16 v[68:71],a[140:143],v[252:255],v[68:71]
ds_read_b128 v[248:251],v18 offset:28672
s_waitcnt lgkmcnt(5)
v_mfma_f32_16x16x32_bf16 v[64:67],a[32:35],v[224:227],v[64:67]
ds_write_b64 v46,v[44:45]
v_min3_u32 v27,v27,v224,v228
v_mfma_f32_16x16x32_bf16 v[68:71],a[144:147],v[224:227],v[68:71]
ds_read_b128 v[252:255],v18 offset:30720
v_mfma_f32_16x16x32_bf16 v[64:67],a[36:39],v[228:231],v[64:67]
buffer_load_dwordx2 v[122:123],v24,s[20:23],s70 offen sc1
v_mfma_f32_16x16x32_bf16 v[68:71],a[148:151],v[228:231],v[68:71]
ds_read_b128 v[224:227],v18 offset:32768
s_waitcnt lgkmcnt(6)
v_mfma_f32_16x16x32_bf16 v[64:67],a[40:43],v[232:235],v[64:67]
v_min3_u32 v27,v27,v232,v236
s_add_u32 s88,s70,s75
v_mfma_f32_16x16x32_bf16 v[68:71],a[152:155],v[232:235],v[68:71]
ds_read_b128 v[228:231],v18 offset:34816
s_add_u32 s88,s88,2097152
v_mfma_f32_16x16x32_bf16 v[64:67],a[44:47],v[236:239],v[64:67]
s_xor_b32 s88,s88,0x2000
s_xor_b32 s89,s88,1024
v_mfma_f32_16x16x32_bf16 v[68:71],a[156:159],v[236:239],v[68:71]
ds_read_b128 v[232:235],v18 offset:36864
s_waitcnt lgkmcnt(6)
v_mfma_f32_16x16x32_bf16 v[64:67],a[48:51],v[240:243],v[64:67]
v_min3_u32 v27,v27,v240,v244
v_mfma_f32_16x16x32_bf16 v[68:71],a[160:163],v[240:243],v[68:71]
ds_read_b128 v[236:239],v18 offset:38912
v_mfma_f32_16x16x32_bf16 v[64:67],a[52:55],v[244:247],v[64:67]
v_mfma_f32_16x16x32_bf16 v[68:71],a[164:167],v[244:247],v[68:71]
ds_read_b128 v[240:243],v18 offset:40960
s_waitcnt lgkmcnt(5)
v_mfma_f32_16x16x32_bf16 v[64:67],a[56:59],v[248:251],v[64:67]
v_min3_u32 v27,v27,v248,v252
v_mfma_f32_16x16x32_bf16 v[68:71],a[168:171],v[248:251],v[68:71]
ds_read_b128 v[244:247],v18 offset:43008
v_mfma_f32_16x16x32_bf16 v[64:67],a[60:63],v[252:255],v[64:67]
v_mfma_f32_16x16x32_bf16 v[68:71],a[172:175],v[252:255],v[68:71]
ds_read_b128 v[248:251],v18 offset:45056
s_waitcnt lgkmcnt(5)
v_mfma_f32_16x16x32_bf16 v[64:67],a[64:67],v[224:227],v[64:67]
s_waitcnt vmcnt(8)
s_barrier
ds_read_b64 v[44:45],v47
ds_read_b128 v[128:131],v17 offset:0
ds_read_b128 v[132:135],v17 offset:2048
v_mfma_f32_16x16x32_bf16 v[68:71],a[176:179],v[224:227],v[68:71]
ds_read_b128 v[252:255],v18 offset:47104
v_min3_u32 v27,v27,v224,v228
v_mfma_f32_16x16x32_bf16 v[64:67],a[68:71],v[228:231],v[64:67]
ds_read_b128 v[136:139],v17 offset:4096
v_mfma_f32_16x16x32_bf16 v[68:71],a[180:183],v[228:231],v[68:71]
ds_read_b128 v[224:227],v18 offset:49152
s_waitcnt lgkmcnt(9)
v_mfma_f32_16x16x32_bf16 v[64:67],a[72:75],v[232:235],v[64:67]
ds_read_b128 v[140:143],v17 offset:6144
v_min3_u32 v27,v27,v232,v236
v_mfma_f32_16x16x32_bf16 v[68:71],a[184:187],v[232:235],v[68:71]
ds_read_b128 v[228:231],v18 offset:51200
v_mfma_f32_16x16x32_bf16 v[64:67],a[76:79],v[236:239],v[64:67]
ds_read_b128 v[144:147],v17 offset:8192
ds_read_b128 v[148:151],v17 offset:10240
v_mfma_f32_16x16x32_bf16 v[68:71],a[188:191],v[236:239],v[68:71]
ds_read_b128 v[232:235],v18 offset:53248
s_waitcnt lgkmcnt(12)
v_mfma_f32_16x16x32_bf16 v[64:67],a[80:83],v[240:243],v[64:67]
ds_read_b128 v[152:155],v17 offset:12288
s_waitcnt lgkmcnt(11)
v_min3_u32 v27,v27,v240,v244
v_mfma_f32_16x16x32_bf16 v[68:71],a[192:195],v[240:243],v[68:71]
ds_read_b128 v[236:239],v18 offset:55296
v_readfirstlane_b32 s93,v45
v_mfma_f32_16x16x32_bf16 v[64:67],a[84:87],v[244:247],v[64:67]
ds_read_b128 v[156:159],v17 offset:14336
v_readfirstlane_b32 s83,v44
s_cmp_lg_u32 s83,0
s_cbranch_scc1 keep_338
v_mfma_f32_16x16x32_bf16 v[68:71],a[196:199],v[244:247],v[68:71]
s_xor_b32 m0,s72,0
s_add_u32 s65,s88,0
s_waitcnt lgkmcnt(10)
v_mfma_f32_16x16x32_bf16 v[64:67],a[88:91],v[248:251],v[64:67]
ds_read_b128 v[160:163],v17 offset:16384
ds_read_b128 v[164:167],v17 offset:18432
v_min3_u32 v27,v27,v248,v252
v_mfma_f32_16x16x32_bf16 v[68:71],a[200:203],v[248:251],v[68:71]
buffer_load_dwordx4 v16,s[20:23],s65 offen offset:0 sc1 lds
v_mfma_f32_16x16x32_bf16 v[64:67],a[92:95],v[252:255],v[64:67]
ds_read_b128 v[168:171],v17 offset:20480
buffer_load_dwordx4 v16,s[20:23],s65 offen offset:2048 sc1 lds
v_mfma_f32_16x16x32_bf16 v[68:71],a[204:207],v[252:255],v[68:71]
s_xor_b32 m0,s72,16384
s_add_u32 s65,s88,32768
s_waitcnt lgkmcnt(9)
v_mfma_f32_16x16x32_bf16 v[64:67],a[96:99],v[224:227],v[64:67]
ds_read_b128 v[172:175],v17 offset:22528
buffer_load_dwordx4 v16,s[20:23],s65 offen offset:0 sc1 lds
v_min3_u32 v27,v27,v224,v228
v_mfma_f32_16x16x32_bf16 v[68:71],a[208:211],v[224:227],v[68:71]
buffer_load_dwordx4 v16,s[20:23],s65 offen offset:2048 sc1 lds
v_min3_u32 v27,v27,v226,v230
v_mfma_f32_16x16x32_bf16 v[64:67],a[100:103],v[228:231],v[64:67]
ds_read_b128 v[176:179],v17 offset:24576
ds_read_b128 v[180:183],v17 offset:26624
s_xor_b32 m0,s72,32768
v_mfma_f32_16x16x32_bf16 v[68:71],a[212:215],v[228:231],v[68:71]
s_add_u32 s65,s88,65536
s_waitcnt lgkmcnt(7)
v_mfma_f32_16x16x32_bf16 v[64:67],a[104:107],v[232:235],v[64:67]
ds_read_b128 v[184:187],v17 offset:28672
buffer_load_dwordx4 v16,s[20:23],s65 offen offset:0 sc1 lds
v_mfma_f32_16x16x32_bf16 v[68:71],a[216:219],v[232:235],v[68:71]
buffer_load_dwordx4 v16,s[20:23],s65 offen offset:2048 sc1 lds
v_min3_u32 v27,v27,v232,v236
v_mfma_f32_16x16x32_bf16 v[64:67],a[108:111],v[236:239],v[64:67]
ds_read_b128 v[188:191],v17 offset:30720
s_xor_b32 m0,s72,49152
v_min3_u32 v27,v27,v234,v238
v_mfma_f32_16x16x32_bf16 v[68:71],a[220:223],v[236:239],v[68:71]
s_add_u32 s65,s88,s86
v_mfma_f32_16x16x32_bf16 v[72:75],a[112:115],v[128:131],0
buffer_load_dwordx4 v16,s[20:23],s65 offen offset:0 sc1 lds
v_cmp_eq_u32 vcc,0,v27
s_cbranch_vccnz retry_326
v_mfma_f32_16x16x32_bf16 v[76:79],a[116:119],v[132:135],0
buffer_load_dwordx4 v16,s[20:23],s65 offen offset:2048 sc1 lds
v_mfma_f32_16x16x32_bf16 v[72:75],a[120:123],v[136:139],v[72:75]
ds_read_b128 v[192:195],v17 offset:32768
s_xor_b32 m0,s72,1024
v_mfma_f32_16x16x32_bf16 v[76:79],a[124:127],v[140:143],v[76:79]
ds_read_b128 v[196:199],v17 offset:34816
s_add_u32 s65,s89,0
s_waitcnt lgkmcnt(10)
v_mfma_f32_16x16x32_bf16 v[72:75],a[128:131],v[144:147],v[72:75]
ds_read_b128 v[200:203],v17 offset:36864
buffer_load_dwordx4 v16,s[20:23],s65 offen offset:0 sc1 lds
s_waitcnt vmcnt(9)
v_mfma_f32_16x16x32_bf16 v[76:79],a[132:135],v[148:151],v[76:79]
ds_read_b128 v[204:207],v17 offset:38912
buffer_load_dwordx4 v16,s[20:23],s65 offen offset:2048 sc1 lds
v_and_or_b32 v64,v64,-4,s48
v_mfma_f32_16x16x32_bf16 v[72:75],a[136:139],v[152:155],v[72:75]
ds_read_b128 v[208:211],v17 offset:40960
s_xor_b32 m0,s72,17408
s_add_u32 s64,s49,s34
v_mfma_f32_16x16x32_bf16 v[76:79],a[140:143],v[156:159],v[76:79]
s_add_u32 s65,s89,32768
buffer_store_dwordx4 v[64:67],v25,s[20:23],s64 offen offset:2048
s_waitcnt lgkmcnt(9)
v_mfma_f32_16x16x32_bf16 v[72:75],a[144:147],v[160:163],v[72:75]
ds_read_b128 v[212:215],v17 offset:43008
buffer_load_dwordx4 v16,s[20:23],s65 offen offset:0 sc1 lds
v_and_or_b32 v68,v68,-4,s48
v_mfma_f32_16x16x32_bf16 v[76:79],a[148:151],v[164:167],v[76:79]
ds_read_b128 v[216:219],v17 offset:45056
buffer_load_dwordx4 v16,s[20:23],s65 offen offset:2048 sc1 lds
s_add_u32 s64,s49,s35
v_mfma_f32_16x16x32_bf16 v[72:75],a[152:155],v[168:171],v[72:75]
ds_read_b128 v[220:223],v17 offset:47104
s_xor_b32 m0,s72,33792
buffer_store_dwordx4 v[68:71],v25,s[20:23],s64 offen offset:3072
v_mfma_f32_16x16x32_bf16 v[76:79],a[156:159],v[172:175],v[76:79]
ds_read_b128 v[224:227],v17 offset:49152
s_mov_b32 s49,0x7fff0000
s_waitcnt lgkmcnt(9)
v_mfma_f32_16x16x32_bf16 v[72:75],a[160:163],v[176:179],v[72:75]
ds_read_b128 v[228:231],v17 offset:51200
s_add_u32 s65,s89,65536
v_mfma_f32_16x16x32_bf16 v[76:79],a[164:167],v[180:183],v[76:79]
buffer_load_dwordx4 v16,s[20:23],s65 offen offset:0 sc1 lds
v_mfma_f32_16x16x32_bf16 v[72:75],a[168:171],v[184:187],v[72:75]
ds_read_b128 v[232:235],v17 offset:53248
v_min3_u32 v27,v27,v128,v132
v_mfma_f32_16x16x32_bf16 v[76:79],a[172:175],v[188:191],v[76:79]
ds_read_b128 v[236:239],v17 offset:55296
s_waitcnt lgkmcnt(8)
v_mfma_f32_16x16x32_bf16 v[72:75],a[176:179],v[192:195],v[72:75]
buffer_load_dwordx4 v16,s[20:23],s65 offen offset:2048 sc1 lds
v_mfma_f32_16x16x32_bf16 v[76:79],a[180:183],v[196:199],v[76:79]
s_xor_b32 m0,s72,50176
s_add_u32 s65,s89,s86
v_mfma_f32_16x16x32_bf16 v[72:75],a[184:187],v[200:203],v[72:75]
buffer_load_dwordx4 v16,s[20:23],s65 offen offset:0 sc1 lds
v_mfma_f32_16x16x32_bf16 v[76:79],a[188:191],v[204:207],v[76:79]
v_min3_u32 v27,v27,v136,v140
s_waitcnt lgkmcnt(4)
v_mfma_f32_16x16x32_bf16 v[72:75],a[192:195],v[208:211],v[72:75]
buffer_load_dwordx4 v16,s[20:23],s65 offen offset:2048 sc1 lds
v_mfma_f32_16x16x32_bf16 v[76:79],a[196:199],v[212:215],v[76:79]
v_min3_u32 v27,v27,v144,v148
v_min3_u32 v27,v27,v152,v156
v_mfma_f32_16x16x32_bf16 v[72:75],a[200:203],v[216:219],v[72:75]
v_min3_u32 v27,v27,v160,v164
v_min3_u32 v27,v27,v168,v172
v_mfma_f32_16x16x32_bf16 v[76:79],a[204:207],v[220:223],v[76:79]
v_min3_u32 v27,v27,v176,v180
s_waitcnt lgkmcnt(0)
v_mfma_f32_16x16x32_bf16 v[72:75],a[208:211],v[224:227],v[72:75]
v_min3_u32 v27,v27,v184,v188
v_min3_u32 v27,v27,v192,v196
v_mfma_f32_16x16x32_bf16 v[76:79],a[212:215],v[228:231],v[76:79]
v_min3_u32 v27,v27,v200,v204
v_min3_u32 v27,v27,v208,v212
v_mfma_f32_16x16x32_bf16 v[72:75],a[216:219],v[232:235],v[72:75]
v_min3_u32 v27,v27,v216,v220
v_min3_u32 v27,v27,v224,v228
v_mfma_f32_16x16x32_bf16 v[76:79],a[220:223],v[236:239],v[76:79]
v_min3_u32 v27,v27,v226,v230
v_min3_u32 v27,v27,v232,v236
v_min3_u32 v27,v27,v234,v238
v_mfma_f32_16x16x32_bf16 v[80:83],a[0:3],v[128:131],0
v_cmp_eq_u32 vcc,0,v27
s_cbranch_vccnz retry_326
v_mfma_f32_16x16x32_bf16 v[84:87],a[4:7],v[132:135],0
ds_bpermute_b32 v124,v41,v120
ds_bpermute_b32 v125,v41,v121
v_mfma_f32_16x16x32_bf16 v[80:83],a[8:11],v[136:139],v[80:83]
v_lshlrev_b32 v108,16,v122
v_and_b32 v109,s80,v122
v_mfma_f32_16x16x32_bf16 v[84:87],a[12:15],v[140:143],v[84:87]
v_lshlrev_b32 v110,16,v123
v_and_b32 v111,s80,v123
v_mfma_f32_16x16x32_bf16 v[80:83],a[16:19],v[144:147],v[80:83]
s_waitcnt lgkmcnt(0)
v_lshlrev_b32 v104,16,v124
v_mfma_f32_16x16x32_bf16 v[84:87],a[20:23],v[148:151],v[84:87]
v_and_b32 v105,s80,v124
v_add_f32 v72,v72,v76
v_mfma_f32_16x16x32_bf16 v[80:83],a[24:27],v[152:155],v[80:83]
v_add_f32 v73,v73,v77
v_add_f32 v74,v74,v78
v_mfma_f32_16x16x32_bf16 v[84:87],a[28:31],v[156:159],v[84:87]
v_lshlrev_b32 v106,16,v125
v_add_f32 v75,v75,v79
v_mfma_f32_16x16x32_bf16 v[80:83],a[32:35],v[160:163],v[80:83]
v_and_or_b32 v72,v72,-4,s48
s_add_u32 s64,s77,s33
v_mfma_f32_16x16x32_bf16 v[84:87],a[36:39],v[164:167],v[84:87]
v_and_b32 v107,s80,v125
v_mfma_f32_16x16x32_bf16 v[80:83],a[40:43],v[168:171],v[80:83]
buffer_store_dwordx4 v[72:75],v25,s[20:23],s64 offen offset:1024
v_mfma_f32_16x16x32_bf16 v[84:87],a[44:47],v[172:175],v[84:87]
v_mfma_f32_16x16x32_bf16 v[80:83],a[48:51],v[176:179],v[80:83]
buffer_load_dwordx4 v[96:99],v26,s[20:23],s77 offen offset:2048 sc1
v_mfma_f32_16x16x32_bf16 v[84:87],a[52:55],v[180:183],v[84:87]
buffer_load_dwordx4 v[100:103],v26,s[20:23],s77 offen offset:3072 sc1
v_mfma_f32_16x16x32_bf16 v[80:83],a[56:59],v[184:187],v[80:83]
v_mfma_f32_16x16x32_bf16 v[84:87],a[60:63],v[188:191],v[84:87]
v_mfma_f32_16x16x32_bf16 v[80:83],a[64:67],v[192:195],v[80:83]
v_mfma_f32_16x16x32_bf16 v[84:87],a[68:71],v[196:199],v[84:87]
v_mfma_f32_16x16x32_bf16 v[80:83],a[72:75],v[200:203],v[80:83]
v_mfma_f32_16x16x32_bf16 v[84:87],a[76:79],v[204:207],v[84:87]
v_mfma_f32_16x16x32_bf16 v[80:83],a[80:83],v[208:211],v[80:83]
v_mfma_f32_16x16x32_bf16 v[84:87],a[84:87],v[212:215],v[84:87]
v_mfma_f32_16x16x32_bf16 v[80:83],a[88:91],v[216:219],v[80:83]
buffer_load_dwordx4 v[92:95],v26,s[20:23],s77 offen offset:1024 sc1
v_mfma_f32_16x16x32_bf16 v[84:87],a[92:95],v[220:223],v[84:87]
v_mfma_f32_16x16x32_bf16 v[80:83],a[96:99],v[224:227],v[80:83]
v_mfma_f32_16x16x32_bf16 v[84:87],a[100:103],v[228:231],v[84:87]
v_mfma_f32_16x16x32_bf16 v[80:83],a[104:107],v[232:235],v[80:83]
v_mfma_f32_16x16x32_bf16 v[84:87],a[108:111],v[236:239],v[84:87]
s_branch epi_329
keep_338:
v_mfma_f32_16x16x32_bf16 v[68:71],a[196:199],v[244:247],v[68:71]
s_waitcnt lgkmcnt(10)
v_mfma_f32_16x16x32_bf16 v[64:67],a[88:91],v[248:251],v[64:67]
ds_read_b128 v[160:163],v17 offset:16384
ds_read_b128 v[164:167],v17 offset:18432
v_mfma_f32_16x16x32_bf16 v[68:71],a[200:203],v[248:251],v[68:71]
v_min3_u32 v27,v27,v248,v252
v_mfma_f32_16x16x32_bf16 v[64:67],a[92:95],v[252:255],v[64:67]
ds_read_b128 v[168:171],v17 offset:20480
v_mfma_f32_16x16x32_bf16 v[68:71],a[204:207],v[252:255],v[68:71]
s_waitcnt lgkmcnt(9)
v_mfma_f32_16x16x32_bf16 v[64:67],a[96:99],v[224:227],v[64:67]
ds_read_b128 v[172:175],v17 offset:22528
v_min3_u32 v27,v27,v224,v228
v_mfma_f32_16x16x32_bf16 v[68:71],a[208:211],v[224:227],v[68:71]
v_min3_u32 v27,v27,v226,v230
v_mfma_f32_16x16x32_bf16 v[64:67],a[100:103],v[228:231],v[64:67]
ds_read_b128 v[176:179],v17 offset:24576
ds_read_b128 v[180:183],v17 offset:26624
v_mfma_f32_16x16x32_bf16 v[68:71],a[212:215],v[228:231],v[68:71]
s_waitcnt lgkmcnt(7)
v_mfma_f32_16x16x32_bf16 v[64:67],a[104:107],v[232:235],v[64:67]
ds_read_b128 v[184:187],v17 offset:28672
v_min3_u32 v27,v27,v232,v236
v_mfma_f32_16x16x32_bf16 v[68:71],a[216:219],v[232:235],v[68:71]
v_min3_u32 v27,v27,v234,v238
v_mfma_f32_16x16x32_bf16 v[64:67],a[108:111],v[236:239],v[64:67]
ds_read_b128 v[188:191],v17 offset:30720
v_mfma_f32_16x16x32_bf16 v[68:71],a[220:223],v[236:239],v[68:71]
v_mfma_f32_16x16x32_bf16 v[72:75],a[112:115],v[128:131],0
v_cmp_eq_u32 vcc,0,v27
s_cbranch_vccnz retry_326
v_mfma_f32_16x16x32_bf16 v[76:79],a[116:119],v[132:135],0
v_min3_u32 v27,v27,v128,v132
v_mfma_f32_16x16x32_bf16 v[72:75],a[120:123],v[136:139],v[72:75]
ds_read_b128 v[192:195],v17 offset:32768
v_mfma_f32_16x16x32_bf16 v[76:79],a[124:127],v[140:143],v[76:79]
ds_read_b128 v[196:199],v17 offset:34816
s_waitcnt lgkmcnt(10)
v_mfma_f32_16x16x32_bf16 v[72:75],a[128:131],v[144:147],v[72:75]
ds_read_b128 v[200:203],v17 offset:36864
v_min3_u32 v27,v27,v136,v140
s_waitcnt vmcnt(0)
v_mfma_f32_16x16x32_bf16 v[76:79],a[132:135],v[148:151],v[76:79]
ds_read_b128 v[204:207],v17 offset:38912
v_min3_u32 v27,v27,v144,v148
v_and_or_b32 v64,v64,-4,s48
v_mfma_f32_16x16x32_bf16 v[72:75],a[136:139],v[152:155],v[72:75]
ds_read_b128 v[208:211],v17 offset:40960
s_add_u32 s64,s49,s34
v_mfma_f32_16x16x32_bf16 v[76:79],a[140:143],v[156:159],v[76:79]
v_min3_u32 v27,v27,v152,v156
s_waitcnt lgkmcnt(9)
v_mfma_f32_16x16x32_bf16 v[72:75],a[144:147],v[160:163],v[72:75]
ds_read_b128 v[212:215],v17 offset:43008
buffer_store_dwordx4 v[64:67],v25,s[20:23],s64 offen offset:2048
v_mfma_f32_16x16x32_bf16 v[76:79],a[148:151],v[164:167],v[76:79]
ds_read_b128 v[216:219],v17 offset:45056
v_min3_u32 v27,v27,v160,v164
v_and_or_b32 v68,v68,-4,s48
v_mfma_f32_16x16x32_bf16 v[72:75],a[152:155],v[168:171],v[72:75]
ds_read_b128 v[220:223],v17 offset:47104
s_add_u32 s64,s49,s35
v_mfma_f32_16x16x32_bf16 v[76:79],a[156:159],v[172:175],v[76:79]
ds_read_b128 v[224:227],v17 offset:49152
s_waitcnt lgkmcnt(9)
v_mfma_f32_16x16x32_bf16 v[72:75],a[160:163],v[176:179],v[72:75]
ds_read_b128 v[228:231],v17 offset:51200
v_min3_u32 v27,v27,v168,v172
v_mfma_f32_16x16x32_bf16 v[76:79],a[164:167],v[180:183],v[76:79]
v_min3_u32 v27,v27,v176,v180
buffer_store_dwordx4 v[68:71],v25,s[20:23],s64 offen offset:3072
v_mfma_f32_16x16x32_bf16 v[72:75],a[168:171],v[184:187],v[72:75]
ds_read_b128 v[232:235],v17 offset:53248
s_mov_b32 s49,0x7fff0000
v_mfma_f32_16x16x32_bf16 v[76:79],a[172:175],v[188:191],v[76:79]
ds_read_b128 v[236:239],v17 offset:55296
s_waitcnt lgkmcnt(8)
v_mfma_f32_16x16x32_bf16 v[72:75],a[176:179],v[192:195],v[72:75]
v_min3_u32 v27,v27,v184,v188
v_mfma_f32_16x16x32_bf16 v[76:79],a[180:183],v[196:199],v[76:79]
v_min3_u32 v27,v27,v192,v196
ds_bpermute_b32 v124,v41,v120
v_mfma_f32_16x16x32_bf16 v[72:75],a[184:187],v[200:203],v[72:75]
v_mfma_f32_16x16x32_bf16 v[76:79],a[188:191],v[204:207],v[76:79]
v_min3_u32 v27,v27,v200,v204
s_waitcnt lgkmcnt(5)
v_mfma_f32_16x16x32_bf16 v[72:75],a[192:195],v[208:211],v[72:75]
ds_bpermute_b32 v125,v41,v121
v_mfma_f32_16x16x32_bf16 v[76:79],a[196:199],v[212:215],v[76:79]
v_min3_u32 v27,v27,v208,v212
v_lshlrev_b32 v108,16,v122
v_mfma_f32_16x16x32_bf16 v[72:75],a[200:203],v[216:219],v[72:75]
v_mfma_f32_16x16x32_bf16 v[76:79],a[204:207],v[220:223],v[76:79]
v_min3_u32 v27,v27,v216,v220
s_waitcnt lgkmcnt(2)
v_mfma_f32_16x16x32_bf16 v[72:75],a[208:211],v[224:227],v[72:75]
v_and_b32 v109,s80,v122
v_mfma_f32_16x16x32_bf16 v[76:79],a[212:215],v[228:231],v[76:79]
v_min3_u32 v27,v27,v224,v228
v_min3_u32 v27,v27,v226,v230
v_mfma_f32_16x16x32_bf16 v[72:75],a[216:219],v[232:235],v[72:75]
v_lshlrev_b32 v110,16,v123
v_mfma_f32_16x16x32_bf16 v[76:79],a[220:223],v[236:239],v[76:79]
v_min3_u32 v27,v27,v232,v236
v_min3_u32 v27,v27,v234,v238
v_mfma_f32_16x16x32_bf16 v[80:83],a[0:3],v[128:131],0
v_cmp_eq_u32 vcc,0,v27
s_cbranch_vccnz retry_326
v_mfma_f32_16x16x32_bf16 v[84:87],a[4:7],v[132:135],0
v_and_b32 v111,s80,v123
s_waitcnt lgkmcnt(0)
v_mfma_f32_16x16x32_bf16 v[80:83],a[8:11],v[136:139],v[80:83]
v_mfma_f32_16x16x32_bf16 v[84:87],a[12:15],v[140:143],v[84:87]
v_lshlrev_b32 v104,16,v124
v_mfma_f32_16x16x32_bf16 v[80:83],a[16:19],v[144:147],v[80:83]
v_add_f32 v72,v72,v76
v_add_f32 v73,v73,v77
v_mfma_f32_16x16x32_bf16 v[84:87],a[20:23],v[148:151],v[84:87]
v_and_b32 v105,s80,v124
v_add_f32 v74,v74,v78
v_mfma_f32_16x16x32_bf16 v[80:83],a[24:27],v[152:155],v[80:83]
v_add_f32 v75,v75,v79
v_and_or_b32 v72,v72,-4,s48
v_mfma_f32_16x16x32_bf16 v[84:87],a[28:31],v[156:159],v[84:87]
v_lshlrev_b32 v106,16,v125
s_add_u32 s64,s77,s33
v_mfma_f32_16x16x32_bf16 v[80:83],a[32:35],v[160:163],v[80:83]
buffer_store_dwordx4 v[72:75],v25,s[20:23],s64 offen offset:1024
v_mfma_f32_16x16x32_bf16 v[84:87],a[36:39],v[164:167],v[84:87]
v_and_b32 v107,s80,v125
v_mfma_f32_16x16x32_bf16 v[80:83],a[40:43],v[168:171],v[80:83]
v_mfma_f32_16x16x32_bf16 v[84:87],a[44:47],v[172:175],v[84:87]
v_mfma_f32_16x16x32_bf16 v[80:83],a[48:51],v[176:179],v[80:83]
buffer_load_dwordx4 v[96:99],v26,s[20:23],s77 offen offset:2048 sc1
v_mfma_f32_16x16x32_bf16 v[84:87],a[52:55],v[180:183],v[84:87]
buffer_load_dwordx4 v[100:103],v26,s[20:23],s77 offen offset:3072 sc1
v_mfma_f32_16x16x32_bf16 v[80:83],a[56:59],v[184:187],v[80:83]
v_mfma_f32_16x16x32_bf16 v[84:87],a[60:63],v[188:191],v[84:87]
v_mfma_f32_16x16x32_bf16 v[80:83],a[64:67],v[192:195],v[80:83]
v_mfma_f32_16x16x32_bf16 v[84:87],a[68:71],v[196:199],v[84:87]
v_mfma_f32_16x16x32_bf16 v[80:83],a[72:75],v[200:203],v[80:83]
v_mfma_f32_16x16x32_bf16 v[84:87],a[76:79],v[204:207],v[84:87]
v_mfma_f32_16x16x32_bf16 v[80:83],a[80:83],v[208:211],v[80:83]
v_mfma_f32_16x16x32_bf16 v[84:87],a[84:87],v[212:215],v[84:87]
v_mfma_f32_16x16x32_bf16 v[80:83],a[88:91],v[216:219],v[80:83]
buffer_load_dwordx4 v[92:95],v26,s[20:23],s77 offen offset:1024 sc1
v_mfma_f32_16x16x32_bf16 v[84:87],a[92:95],v[220:223],v[84:87]
v_mfma_f32_16x16x32_bf16 v[80:83],a[96:99],v[224:227],v[80:83]
v_mfma_f32_16x16x32_bf16 v[84:87],a[100:103],v[228:231],v[84:87]
v_mfma_f32_16x16x32_bf16 v[80:83],a[104:107],v[232:235],v[80:83]
v_mfma_f32_16x16x32_bf16 v[84:87],a[108:111],v[236:239],v[84:87]
s_branch epi_329
both_330:
s_waitcnt vmcnt(14) lgkmcnt(0)
s_barrier
ds_read_b128 v[224:227],v18 offset:0
ds_read_b128 v[228:231],v18 offset:2048
ds_read_b128 v[232:235],v18 offset:4096
ds_read_b128 v[236:239],v18 offset:6144
ds_read_b128 v[240:243],v18 offset:8192
ds_read_b128 v[244:247],v18 offset:10240
ds_read_b128 v[248:251],v18 offset:12288
s_waitcnt lgkmcnt(5)
v_mfma_f32_16x16x32_bf16 v[64:67],a[0:3],v[224:227],0
s_add_u32 s96,s71,1
s_add_u32 s92,s71,2
s_add_u32 s88,s70,s75
v_mfma_f32_16x16x32_bf16 v[68:71],a[112:115],v[224:227],0
ds_read_b128 v[252:255],v18 offset:14336
s_add_u32 s88,s88,2097152
s_xor_b32 s88,s88,0x2000
v_mfma_f32_16x16x32_bf16 v[64:67],a[4:7],v[228:231],v[64:67]
s_cmp_eq_u32 s96,64
s_cselect_b32 s96,99,s96
v_min_u32 v27,v224,v228
v_mfma_f32_16x16x32_bf16 v[68:71],a[116:119],v[228:231],v[68:71]
ds_read_b128 v[224:227],v18 offset:16384
s_waitcnt lgkmcnt(5)
v_mfma_f32_16x16x32_bf16 v[64:67],a[8:11],v[232:235],v[64:67]
s_cmp_eq_u32 s92,64
s_cselect_b32 s92,99,s92
v_mfma_f32_16x16x32_bf16 v[68:71],a[120:123],v[232:235],v[68:71]
ds_read_b128 v[228:231],v18 offset:18432
s_xor_b32 s89,s88,1024
v_mfma_f32_16x16x32_bf16 v[64:67],a[12:15],v[236:239],v[64:67]
s_xor_b32 m0,s72,0
v_min3_u32 v27,v27,v232,v236
v_mfma_f32_16x16x32_bf16 v[68:71],a[124:127],v[236:239],v[68:71]
ds_read_b128 v[232:235],v18 offset:20480
s_add_u32 s65,s88,0
s_waitcnt lgkmcnt(5)
v_mfma_f32_16x16x32_bf16 v[64:67],a[16:19],v[240:243],v[64:67]
v_min3_u32 v27,v27,v240,v244
buffer_load_dwordx2 v[120:121],v20,s[20:23],s76 offen sc1
v_mfma_f32_16x16x32_bf16 v[68:71],a[128:131],v[240:243],v[68:71]
ds_read_b128 v[236:239],v18 offset:22528
buffer_load_dwordx4 v16,s[20:23],s65 offen offset:0 sc1 lds
v_mfma_f32_16x16x32_bf16 v[64:67],a[20:23],v[244:247],v[64:67]
s_waitcnt vmcnt(3)
v_mfma_f32_16x16x32_bf16 v[68:71],a[132:135],v[244:247],v[68:71]
ds_read_b128 v[240:243],v18 offset:24576
s_waitcnt lgkmcnt(5)
v_mfma_f32_16x16x32_bf16 v[64:67],a[24:27],v[248:251],v[64:67]
v_cmp_gt_u32 vcc,s96,v29
v_cmp_gt_u32 s[92:93],s92,v29
v_min3_u32 v27,v27,v248,v252
v_mfma_f32_16x16x32_bf16 v[68:71],a[136:139],v[248:251],v[68:71]
ds_read_b128 v[244:247],v18 offset:26624
buffer_load_dwordx4 v16,s[20:23],s65 offen offset:2048 sc1 lds
v_mfma_f32_16x16x32_bf16 v[64:67],a[28:31],v[252:255],v[64:67]
v_mov_b32 v44,vcc_lo
v_mov_b32 v45,s92
s_xor_b32 m0,s72,16384
v_mfma_f32_16x16x32_bf16 v[68:71],a[140:143],v[252:255],v[68:71]
ds_read_b128 v[248:251],v18 offset:28672
s_add_u32 s65,s88,32768
s_waitcnt lgkmcnt(5)
v_mfma_f32_16x16x32_bf16 v[64:67],a[32:35],v[224:227],v[64:67]
ds_write_b64 v46,v[44:45]
v_min3_u32 v27,v27,v224,v228
v_mfma_f32_16x16x32_bf16 v[68:71],a[144:147],v[224:227],v[68:71]
ds_read_b128 v[252:255],v18 offset:30720
buffer_load_dwordx4 v16,s[20:23],s65 offen offset:0 sc1 lds
v_mfma_f32_16x16x32_bf16 v[64:67],a[36:39],v[228:231],v[64:67]
buffer_load_dwordx4 v16,s[20:23],s65 offen offset:2048 sc1 lds
v_mfma_f32_16x16x32_bf16 v[68:71],a[148:151],v[228:231],v[68:71]
ds_read_b128 v[224:227],v18 offset:32768
s_waitcnt lgkmcnt(6)
v_mfma_f32_16x16x32_bf16 v[64:67],a[40:43],v[232:235],v[64:67]
s_xor_b32 m0,s72,32768
v_min3_u32 v27,v27,v232,v236
v_mfma_f32_16x16x32_bf16 v[68:71],a[152:155],v[232:235],v[68:71]
ds_read_b128 v[228:231],v18 offset:34816
v_mfma_f32_16x16x32_bf16 v[64:67],a[44:47],v[236:239],v[64:67]
s_add_u32 s65,s88,65536
v_mfma_f32_16x16x32_bf16 v[68:71],a[156:159],v[236:239],v[68:71]
ds_read_b128 v[232:235],v18 offset:36864
s_waitcnt lgkmcnt(6)
v_mfma_f32_16x16x32_bf16 v[64:67],a[48:51],v[240:243],v[64:67]
buffer_load_dwordx4 v16,s[20:23],s65 offen offset:0 sc1 lds
v_mfma_f32_16x16x32_bf16 v[68:71],a[160:163],v[240:243],v[68:71]
ds_read_b128 v[236:239],v18 offset:38912
v_min3_u32 v27,v27,v240,v244
v_mfma_f32_16x16x32_bf16 v[64:67],a[52:55],v[244:247],v[64:67]
buffer_load_dwordx4 v16,s[20:23],s65 offen offset:2048 sc1 lds
v_mfma_f32_16x16x32_bf16 v[68:71],a[164:167],v[244:247],v[68:71]
ds_read_b128 v[240:243],v18 offset:40960
s_waitcnt lgkmcnt(5)
v_mfma_f32_16x16x32_bf16 v[64:67],a[56:59],v[248:251],v[64:67]
s_xor_b32 m0,s72,49152
v_min3_u32 v27,v27,v248,v252
v_mfma_f32_16x16x32_bf16 v[68:71],a[168:171],v[248:251],v[68:71]
ds_read_b128 v[244:247],v18 offset:43008
s_add_u32 s65,s88,s86
v_mfma_f32_16x16x32_bf16 v[64:67],a[60:63],v[252:255],v[64:67]
buffer_load_dwordx2 v[122:123],v24,s[20:23],s70 offen sc1
v_mfma_f32_16x16x32_bf16 v[68:71],a[172:175],v[252:255],v[68:71]
ds_read_b128 v[248:251],v18 offset:45056
s_waitcnt lgkmcnt(5)
v_mfma_f32_16x16x32_bf16 v[64:67],a[64:67],v[224:227],v[64:67]
s_waitcnt vmcnt(14)
s_barrier
ds_read_b64 v[44:45],v47
ds_read_b128 v[128:131],v17 offset:0
ds_read_b128 v[132:135],v17 offset:2048
v_mfma_f32_16x16x32_bf16 v[68:71],a[176:179],v[224:227],v[68:71]
ds_read_b128 v[252:255],v18 offset:47104
buffer_load_dwordx4 v16,s[20:23],s65 offen offset:0 sc1 lds
v_min3_u32 v27,v27,v224,v228
v_mfma_f32_16x16x32_bf16 v[64:67],a[68:71],v[228:231],v[64:67]
ds_read_b128 v[136:139],v17 offset:4096
buffer_load_dwordx4 v16,s[20:23],s65 offen offset:2048 sc1 lds
v_mfma_f32_16x16x32_bf16 v[68:71],a[180:183],v[228:231],v[68:71]
ds_read_b128 v[224:227],v18 offset:49152
s_xor_b32 m0,s72,1024
s_waitcnt lgkmcnt(9)
v_mfma_f32_16x16x32_bf16 v[64:67],a[72:75],v[232:235],v[64:67]
ds_read_b128 v[140:143],v17 offset:6144
v_min3_u32 v27,v27,v232,v236
v_mfma_f32_16x16x32_bf16 v[68:71],a[184:187],v[232:235],v[68:71]
ds_read_b128 v[228:231],v18 offset:51200
s_add_u32 s65,s89,0
v_mfma_f32_16x16x32_bf16 v[64:67],a[76:79],v[236:239],v[64:67]
ds_read_b128 v[144:147],v17 offset:8192
ds_read_b128 v[148:151],v17 offset:10240
v_mfma_f32_16x16x32_bf16 v[68:71],a[188:191],v[236:239],v[68:71]
ds_read_b128 v[232:235],v18 offset:53248
s_waitcnt lgkmcnt(12)
v_mfma_f32_16x16x32_bf16 v[64:67],a[80:83],v[240:243],v[64:67]
ds_read_b128 v[152:155],v17 offset:12288
s_waitcnt lgkmcnt(11)
v_min3_u32 v27,v27,v240,v244
v_mfma_f32_16x16x32_bf16 v[68:71],a[192:195],v[240:243],v[68:71]
ds_read_b128 v[236:239],v18 offset:55296
v_readfirstlane_b32 s93,v45
v_mfma_f32_16x16x32_bf16 v[64:67],a[84:87],v[244:247],v[64:67]
ds_read_b128 v[156:159],v17 offset:14336
buffer_load_dwordx4 v16,s[20:23],s65 offen offset:0 sc1 lds
v_mfma_f32_16x16x32_bf16 v[68:71],a[196:199],v[244:247],v[68:71]
buffer_load_dwordx4 v16,s[20:23],s65 offen offset:2048 sc1 lds
s_waitcnt lgkmcnt(10)
v_mfma_f32_16x16x32_bf16 v[64:67],a[88:91],v[248:251],v[64:67]
ds_read_b128 v[160:163],v17 offset:16384
ds_read_b128 v[164:167],v17 offset:18432
s_xor_b32 m0,s72,17408
v_mfma_f32_16x16x32_bf16 v[68:71],a[200:203],v[248:251],v[68:71]
s_add_u32 s65,s89,32768
v_min3_u32 v27,v27,v248,v252
v_mfma_f32_16x16x32_bf16 v[64:67],a[92:95],v[252:255],v[64:67]
ds_read_b128 v[168:171],v17 offset:20480
buffer_load_dwordx4 v16,s[20:23],s65 offen offset:0 sc1 lds
v_mfma_f32_16x16x32_bf16 v[68:71],a[204:207],v[252:255],v[68:71]
s_waitcnt lgkmcnt(9)
v_mfma_f32_16x16x32_bf16 v[64:67],a[96:99],v[224:227],v[64:67]
ds_read_b128 v[172:175],v17 offset:22528
buffer_load_dwordx4 v16,s[20:23],s65 offen offset:2048 sc1 lds
v_mfma_f32_16x16x32_bf16 v[68:71],a[208:211],v[224:227],v[68:71]
v_min3_u32 v27,v27,v224,v228
v_min3_u32 v27,v27,v226,v230
v_mfma_f32_16x16x32_bf16 v[64:67],a[100:103],v[228:231],v[64:67]
ds_read_b128 v[176:179],v17 offset:24576
ds_read_b128 v[180:183],v17 offset:26624
s_xor_b32 m0,s72,33792
v_mfma_f32_16x16x32_bf16 v[68:71],a[212:215],v[228:231],v[68:71]
s_waitcnt lgkmcnt(7)
v_mfma_f32_16x16x32_bf16 v[64:67],a[104:107],v[232:235],v[64:67]
ds_read_b128 v[184:187],v17 offset:28672
s_add_u32 s65,s89,65536
v_min3_u32 v27,v27,v232,v236
v_mfma_f32_16x16x32_bf16 v[68:71],a[216:219],v[232:235],v[68:71]
buffer_load_dwordx4 v16,s[20:23],s65 offen offset:0 sc1 lds
v_mfma_f32_16x16x32_bf16 v[64:67],a[108:111],v[236:239],v[64:67]
ds_read_b128 v[188:191],v17 offset:30720
v_min3_u32 v27,v27,v234,v238
v_mfma_f32_16x16x32_bf16 v[68:71],a[220:223],v[236:239],v[68:71]
buffer_load_dwordx4 v16,s[20:23],s65 offen offset:2048 sc1 lds
v_mfma_f32_16x16x32_bf16 v[72:75],a[112:115],v[128:131],0
v_cmp_eq_u32 vcc,0,v27
s_cbranch_vccnz retry_326
v_mfma_f32_16x16x32_bf16 v[76:79],a[116:119],v[132:135],0
s_xor_b32 m0,s72,50176
v_min3_u32 v27,v27,v128,v132
v_mfma_f32_16x16x32_bf16 v[72:75],a[120:123],v[136:139],v[72:75]
ds_read_b128 v[192:195],v17 offset:32768
v_mfma_f32_16x16x32_bf16 v[76:79],a[124:127],v[140:143],v[76:79]
ds_read_b128 v[196:199],v17 offset:34816
s_add_u32 s65,s89,s86
s_waitcnt lgkmcnt(10)
v_mfma_f32_16x16x32_bf16 v[72:75],a[128:131],v[144:147],v[72:75]
ds_read_b128 v[200:203],v17 offset:36864
v_min3_u32 v27,v27,v136,v140
s_waitcnt vmcnt(8)
v_mfma_f32_16x16x32_bf16 v[76:79],a[132:135],v[148:151],v[76:79]
ds_read_b128 v[204:207],v17 offset:38912
buffer_load_dwordx4 v16,s[20:23],s65 offen offset:0 sc1 lds
v_mfma_f32_16x16x32_bf16 v[72:75],a[136:139],v[152:155],v[72:75]
ds_read_b128 v[208:211],v17 offset:40960
v_min3_u32 v27,v27,v144,v148
v_and_or_b32 v64,v64,-4,s48
v_mfma_f32_16x16x32_bf16 v[76:79],a[140:143],v[156:159],v[76:79]
buffer_load_dwordx4 v16,s[20:23],s65 offen offset:2048 sc1 lds
s_waitcnt lgkmcnt(9)
v_mfma_f32_16x16x32_bf16 v[72:75],a[144:147],v[160:163],v[72:75]
ds_read_b128 v[212:215],v17 offset:43008
v_min3_u32 v27,v27,v152,v156
s_add_u32 s64,s49,s34
v_mfma_f32_16x16x32_bf16 v[76:79],a[148:151],v[164:167],v[76:79]
ds_read_b128 v[216:219],v17 offset:45056
v_min3_u32 v27,v27,v160,v164
v_mfma_f32_16x16x32_bf16 v[72:75],a[152:155],v[168:171],v[72:75]
ds_read_b128 v[220:223],v17 offset:47104
buffer_store_dwordx4 v[64:67],v25,s[20:23],s64 offen offset:2048
v_mfma_f32_16x16x32_bf16 v[76:79],a[156:159],v[172:175],v[76:79]
ds_read_b128 v[224:227],v17 offset:49152
v_and_or_b32 v68,v68,-4,s48
s_waitcnt lgkmcnt(9)
v_mfma_f32_16x16x32_bf16 v[72:75],a[160:163],v[176:179],v[72:75]
ds_read_b128 v[228:231],v17 offset:51200
v_min3_u32 v27,v27,v168,v172
s_add_u32 s64,s49,s35
v_mfma_f32_16x16x32_bf16 v[76:79],a[164:167],v[180:183],v[76:79]
v_min3_u32 v27,v27,v176,v180
buffer_store_dwordx4 v[68:71],v25,s[20:23],s64 offen offset:3072
v_mfma_f32_16x16x32_bf16 v[72:75],a[168:171],v[184:187],v[72:75]
ds_read_b128 v[232:235],v17 offset:53248
s_mov_b32 s49,0x7fff0000
v_mfma_f32_16x16x32_bf16 v[76:79],a[172:175],v[188:191],v[76:79]
ds_read_b128 v[236:239],v17 offset:55296
s_waitcnt lgkmcnt(8)
v_mfma_f32_16x16x32_bf16 v[72:75],a[176:179],v[192:195],v[72:75]
v_min3_u32 v27,v27,v184,v188
v_mfma_f32_16x16x32_bf16 v[76:79],a[180:183],v[196:199],v[76:79]
v_min3_u32 v27,v27,v192,v196
ds_bpermute_b32 v124,v41,v120
v_mfma_f32_16x16x32_bf16 v[72:75],a[184:187],v[200:203],v[72:75]
v_mfma_f32_16x16x32_bf16 v[76:79],a[188:191],v[204:207],v[76:79]
v_min3_u32 v27,v27,v200,v204
s_waitcnt lgkmcnt(5)
v_mfma_f32_16x16x32_bf16 v[72:75],a[192:195],v[208:211],v[72:75]
ds_bpermute_b32 v125,v41,v121
v_mfma_f32_16x16x32_bf16 v[76:79],a[196:199],v[212:215],v[76:79]
v_min3_u32 v27,v27,v208,v212
v_lshlrev_b32 v108,16,v122
v_mfma_f32_16x16x32_bf16 v[72:75],a[200:203],v[216:219],v[72:75]
v_mfma_f32_16x16x32_bf16 v[76:79],a[204:207],v[220:223],v[76:79]
v_min3_u32 v27,v27,v216,v220
s_waitcnt lgkmcnt(2)
v_mfma_f32_16x16x32_bf16 v[72:75],a[208:211],v[224:227],v[72:75]
v_and_b32 v109,s80,v122
v_mfma_f32_16x16x32_bf16 v[76:79],a[212:215],v[228:231],v[76:79]
v_min3_u32 v27,v27,v224,v228
v_min3_u32 v27,v27,v226,v230
v_mfma_f32_16x16x32_bf16 v[72:75],a[216:219],v[232:235],v[72:75]
v_lshlrev_b32 v110,16,v123
v_mfma_f32_16x16x32_bf16 v[76:79],a[220:223],v[236:239],v[76:79]
v_min3_u32 v27,v27,v232,v236
v_min3_u32 v27,v27,v234,v238
v_mfma_f32_16x16x32_bf16 v[80:83],a[0:3],v[128:131],0
v_cmp_eq_u32 vcc,0,v27
s_cbranch_vccnz retry_326
v_mfma_f32_16x16x32_bf16 v[84:87],a[4:7],v[132:135],0
v_and_b32 v111,s80,v123
s_waitcnt lgkmcnt(0)
v_mfma_f32_16x16x32_bf16 v[80:83],a[8:11],v[136:139],v[80:83]
v_mfma_f32_16x16x32_bf16 v[84:87],a[12:15],v[140:143],v[84:87]
v_lshlrev_b32 v104,16,v124
v_mfma_f32_16x16x32_bf16 v[80:83],a[16:19],v[144:147],v[80:83]
v_add_f32 v72,v72,v76
v_add_f32 v73,v73,v77
v_mfma_f32_16x16x32_bf16 v[84:87],a[20:23],v[148:151],v[84:87]
v_and_b32 v105,s80,v124
v_add_f32 v74,v74,v78
v_mfma_f32_16x16x32_bf16 v[80:83],a[24:27],v[152:155],v[80:83]
v_add_f32 v75,v75,v79
v_and_or_b32 v72,v72,-4,s48
v_mfma_f32_16x16x32_bf16 v[84:87],a[28:31],v[156:159],v[84:87]
v_lshlrev_b32 v106,16,v125
s_add_u32 s64,s77,s33
v_mfma_f32_16x16x32_bf16 v[80:83],a[32:35],v[160:163],v[80:83]
buffer_store_dwordx4 v[72:75],v25,s[20:23],s64 offen offset:1024
v_mfma_f32_16x16x32_bf16 v[84:87],a[36:39],v[164:167],v[84:87]
v_and_b32 v107,s80,v125
v_mfma_f32_16x16x32_bf16 v[80:83],a[40:43],v[168:171],v[80:83]
v_mfma_f32_16x16x32_bf16 v[84:87],a[44:47],v[172:175],v[84:87]
v_mfma_f32_16x16x32_bf16 v[80:83],a[48:51],v[176:179],v[80:83]
buffer_load_dwordx4 v[96:99],v26,s[20:23],s77 offen offset:2048 sc1
v_mfma_f32_16x16x32_bf16 v[84:87],a[52:55],v[180:183],v[84:87]
buffer_load_dwordx4 v[100:103],v26,s[20:23],s77 offen offset:3072 sc1
v_mfma_f32_16x16x32_bf16 v[80:83],a[56:59],v[184:187],v[80:83]
v_mfma_f32_16x16x32_bf16 v[84:87],a[60:63],v[188:191],v[84:87]
v_mfma_f32_16x16x32_bf16 v[80:83],a[64:67],v[192:195],v[80:83]
v_mfma_f32_16x16x32_bf16 v[84:87],a[68:71],v[196:199],v[84:87]
v_mfma_f32_16x16x32_bf16 v[80:83],a[72:75],v[200:203],v[80:83]
v_mfma_f32_16x16x32_bf16 v[84:87],a[76:79],v[204:207],v[84:87]
v_mfma_f32_16x16x32_bf16 v[80:83],a[80:83],v[208:211],v[80:83]
v_mfma_f32_16x16x32_bf16 v[84:87],a[84:87],v[212:215],v[84:87]
v_mfma_f32_16x16x32_bf16 v[80:83],a[88:91],v[216:219],v[80:83]
buffer_load_dwordx4 v[92:95],v26,s[20:23],s77 offen offset:1024 sc1
v_mfma_f32_16x16x32_bf16 v[84:87],a[92:95],v[220:223],v[84:87]
v_mfma_f32_16x16x32_bf16 v[80:83],a[96:99],v[224:227],v[80:83]
v_mfma_f32_16x16x32_bf16 v[84:87],a[100:103],v[228:231],v[84:87]
v_mfma_f32_16x16x32_bf16 v[80:83],a[104:107],v[232:235],v[80:83]
v_mfma_f32_16x16x32_bf16 v[84:87],a[108:111],v[236:239],v[84:87]
epi_329:
buffer_load_dword v29,v21,s[20:23],s87 offen sc1
s_nop 6
v_pk_add_f32 v[88:89],v[80:81],v[84:85]
v_pk_add_f32 v[90:91],v[82:83],v[86:87]
v_pk_add_f32 v[88:89],v[88:89],v[108:109]
v_pk_add_f32 v[90:91],v[90:91],v[110:111]
s_waitcnt vmcnt(1)
s_branch ic_341
ip_339:
buffer_load_dwordx4 v[92:95],v26,s[20:23],s77 offen offset:1024 sc1
buffer_load_dwordx4 v[96:99],v26,s[20:23],s77 offen offset:2048 sc1
buffer_load_dwordx4 v[100:103],v26,s[20:23],s77 offen offset:3072 sc1
s_waitcnt vmcnt(0)
ic_341:
v_bitop3_b32 v22,v92,v96,v100 bitop3:0x80
v_and_b32 v22,s48,v22
v_cmp_eq_u32 vcc,0,v22
s_cbranch_vccz ik_340
s_sub_u32 s90,s90,1
s_cmp_gt_i32 s90,0
s_cbranch_scc1 ip_339
ik_340:
s_cmp_lg_u32 s71,65
s_cbranch_scc1 nl_342
buffer_load_dwordx4 v[132:135],v26,s[20:23],s40 offen offset:1024 sc1
buffer_load_dwordx4 v[136:139],v26,s[20:23],s40 offen offset:2048 sc1
buffer_load_dwordx4 v[140:143],v26,s[20:23],s40 offen offset:3072 sc1
nl_342:
v_pk_add_f32 v[88:89],v[88:89],v[92:93]
v_pk_add_f32 v[96:97],v[96:97],v[100:101]
v_pk_add_f32 v[90:91],v[90:91],v[94:95]
v_pk_add_f32 v[98:99],v[98:99],v[102:103]
v_pk_add_f32 v[88:89],v[88:89],v[96:97]
v_pk_add_f32 v[90:91],v[90:91],v[98:99]
v_pk_fma_f32 v[88:89],v[88:89],v[52:53],v[104:105]
v_pk_fma_f32 v[90:91],v[90:91],v[54:55],v[106:107]
v_cvt_pk_bf16_f32 v88,v88,v89
v_cvt_pk_bf16_f32 v89,v90,v91
ds_bpermute_b32 v88,v40,v88
ds_bpermute_b32 v89,v40,v89
v_xor_b32 v18,0x10000,v18
s_xor_b32 s49,s77,524288
s_cselect_b32 s64,0,3
s_xor_b32 s48,s48,s64
s_cmp_eq_u32 s71,63
s_cselect_b32 s64,0,0x2000
s_cselect_b32 s66,2,1
s_cmp_eq_u32 s71,64
s_cselect_b32 s66,-1,s66
v_xor_b32 v20,s64,v20
s_lshl_b32 s64,s66,21
s_add_u32 s76,s76,s64
s_lshl_b32 s66,s66,16
s_waitcnt lgkmcnt(0)
s_mov_b64 exec,s[84:85]
buffer_store_dwordx2 v[88:89],v19,s[36:39],s78 offen
s_mov_b64 exec,-1
s_mov_b64 s[84:85],-1
s_mov_b32 s77,s49
s_add_u32 s78,s78,s66
next_336:
v_xor_b32 v17,0x10000,v17
s_xor_b32 s72,s72,0x10000
s_add_u32 s70,s70,2097152
s_xor_b32 s70,s70,0x2000
s_add_u32 s71,s71,1
s_cmp_le_u32 s71,s57
s_cbranch_scc1 seg_327
s_cmp_lg_u32 s43,0
s_cbranch_scc1 hn_346
s_waitcnt vmcnt(1)
s_branch hc_345
hp_343:
buffer_load_dwordx4 v[132:135],v26,s[20:23],s40 offen offset:1024 sc1
buffer_load_dwordx4 v[136:139],v26,s[20:23],s40 offen offset:2048 sc1
buffer_load_dwordx4 v[140:143],v26,s[20:23],s40 offen offset:3072 sc1
s_waitcnt vmcnt(0)
hc_345:
v_bitop3_b32 v22,v132,v136,v140 bitop3:0x80
v_and_b32 v22,s60,v22
v_cmp_eq_u32 vcc,0,v22
s_cbranch_vccz hk_344
s_sub_u32 s90,s90,1
s_cmp_gt_i32 s90,0
s_cbranch_scc1 hp_343
hk_344:
v_pk_add_f32 v[112:113],v[112:113],v[132:133]
v_pk_add_f32 v[136:137],v[136:137],v[140:141]
v_pk_add_f32 v[114:115],v[114:115],v[134:135]
v_pk_add_f32 v[138:139],v[138:139],v[142:143]
v_pk_add_f32 v[112:113],v[112:113],v[136:137]
v_pk_add_f32 v[114:115],v[114:115],v[138:139]
v_pk_fma_f32 v[112:113],v[112:113],v[52:53],v[116:117]
v_pk_fma_f32 v[114:115],v[114:115],v[54:55],v[118:119]
v_cvt_pk_bf16_f32 v112,v112,v113
v_cvt_pk_bf16_f32 v113,v114,v115
ds_bpermute_b32 v112,v40,v112
ds_bpermute_b32 v113,v40,v113
s_mov_b32 s64,4194304
s_waitcnt lgkmcnt(0)
buffer_store_dwordx2 v[112:113],v19,s[36:39],s64 offen
hn_346:
s_endpgm
retry_326:
s_sub_u32 s90,s90,64
s_cmp_lt_i32 s90,0
s_cbranch_scc1 giveup_197
s_mov_b32 s83,1
s_waitcnt vmcnt(0) lgkmcnt(0)
s_barrier
s_branch seg_327
half_335:
s_cmp_eq_u32 s43,0
s_cbranch_scc1 hown_347
s_mov_b64 exec,s[52:53]
s_xor_b32 m0,s91,0
s_add_u32 s65,s94,0
buffer_load_dwordx4 v16,s[20:23],s65 offen offset:0 sc1 lds
buffer_load_dwordx4 v16,s[20:23],s65 offen offset:2048 sc1 lds
s_xor_b32 m0,s91,16384
s_add_u32 s65,s94,32768
buffer_load_dwordx4 v16,s[20:23],s65 offen offset:0 sc1 lds
buffer_load_dwordx4 v16,s[20:23],s65 offen offset:2048 sc1 lds
s_xor_b32 m0,s91,32768
s_add_u32 s65,s94,65536
buffer_load_dwordx4 v16,s[20:23],s65 offen offset:0 sc1 lds
buffer_load_dwordx4 v16,s[20:23],s65 offen offset:2048 sc1 lds
s_xor_b32 m0,s91,49152
s_add_u32 s65,s94,s86
buffer_load_dwordx4 v16,s[20:23],s65 offen offset:0 sc1 lds
buffer_load_dwordx4 v16,s[20:23],s65 offen offset:2048 sc1 lds
s_mov_b64 exec,-1
h2a_348:
s_waitcnt vmcnt(6)
s_barrier
ds_read_b128 v[224:227],v18 offset:0
ds_read_b128 v[228:231],v18 offset:2048
ds_read_b128 v[232:235],v18 offset:4096
ds_read_b128 v[236:239],v18 offset:6144
ds_read_b128 v[240:243],v18 offset:8192
ds_read_b128 v[244:247],v18 offset:10240
ds_read_b128 v[248:251],v18 offset:12288
s_waitcnt lgkmcnt(5)
v_mfma_f32_16x16x32_bf16 v[64:67],a[0:3],v[224:227],0
v_min_u32 v27,v224,v228
v_mfma_f32_16x16x32_bf16 v[68:71],a[112:115],v[224:227],0
ds_read_b128 v[252:255],v18 offset:14336
v_mfma_f32_16x16x32_bf16 v[64:67],a[4:7],v[228:231],v[64:67]
v_mfma_f32_16x16x32_bf16 v[68:71],a[116:119],v[228:231],v[68:71]
s_waitcnt vmcnt(4)
s_barrier
ds_read_b128 v[224:227],v18 offset:16384
s_waitcnt lgkmcnt(5)
v_mfma_f32_16x16x32_bf16 v[64:67],a[8:11],v[232:235],v[64:67]
v_min3_u32 v27,v27,v232,v236
v_mfma_f32_16x16x32_bf16 v[68:71],a[120:123],v[232:235],v[68:71]
ds_read_b128 v[228:231],v18 offset:18432
v_mfma_f32_16x16x32_bf16 v[64:67],a[12:15],v[236:239],v[64:67]
v_mfma_f32_16x16x32_bf16 v[68:71],a[124:127],v[236:239],v[68:71]
ds_read_b128 v[232:235],v18 offset:20480
s_waitcnt lgkmcnt(5)
v_mfma_f32_16x16x32_bf16 v[64:67],a[16:19],v[240:243],v[64:67]
v_min3_u32 v27,v27,v240,v244
v_mfma_f32_16x16x32_bf16 v[68:71],a[128:131],v[240:243],v[68:71]
ds_read_b128 v[236:239],v18 offset:22528
v_mfma_f32_16x16x32_bf16 v[64:67],a[20:23],v[244:247],v[64:67]
v_mfma_f32_16x16x32_bf16 v[68:71],a[132:135],v[244:247],v[68:71]
ds_read_b128 v[240:243],v18 offset:24576
s_waitcnt lgkmcnt(5)
v_mfma_f32_16x16x32_bf16 v[64:67],a[24:27],v[248:251],v[64:67]
v_min3_u32 v27,v27,v248,v252
v_mfma_f32_16x16x32_bf16 v[68:71],a[136:139],v[248:251],v[68:71]
ds_read_b128 v[244:247],v18 offset:26624
v_mfma_f32_16x16x32_bf16 v[64:67],a[28:31],v[252:255],v[64:67]
v_mfma_f32_16x16x32_bf16 v[68:71],a[140:143],v[252:255],v[68:71]
ds_read_b128 v[248:251],v18 offset:28672
s_waitcnt lgkmcnt(5)
v_mfma_f32_16x16x32_bf16 v[64:67],a[32:35],v[224:227],v[64:67]
v_min3_u32 v27,v27,v224,v228
v_mfma_f32_16x16x32_bf16 v[68:71],a[144:147],v[224:227],v[68:71]
ds_read_b128 v[252:255],v18 offset:30720
v_mfma_f32_16x16x32_bf16 v[64:67],a[36:39],v[228:231],v[64:67]
v_mfma_f32_16x16x32_bf16 v[68:71],a[148:151],v[228:231],v[68:71]
s_waitcnt vmcnt(0)
s_barrier
ds_read_b128 v[224:227],v18 offset:32768
s_waitcnt lgkmcnt(5)
v_mfma_f32_16x16x32_bf16 v[64:67],a[40:43],v[232:235],v[64:67]
v_min3_u32 v27,v27,v232,v236
v_mfma_f32_16x16x32_bf16 v[68:71],a[152:155],v[232:235],v[68:71]
ds_read_b128 v[228:231],v18 offset:34816
v_mfma_f32_16x16x32_bf16 v[64:67],a[44:47],v[236:239],v[64:67]
v_mfma_f32_16x16x32_bf16 v[68:71],a[156:159],v[236:239],v[68:71]
ds_read_b128 v[232:235],v18 offset:36864
s_waitcnt lgkmcnt(5)
v_mfma_f32_16x16x32_bf16 v[64:67],a[48:51],v[240:243],v[64:67]
v_min3_u32 v27,v27,v240,v244
v_mfma_f32_16x16x32_bf16 v[68:71],a[160:163],v[240:243],v[68:71]
ds_read_b128 v[236:239],v18 offset:38912
v_mfma_f32_16x16x32_bf16 v[64:67],a[52:55],v[244:247],v[64:67]
v_mfma_f32_16x16x32_bf16 v[68:71],a[164:167],v[244:247],v[68:71]
ds_read_b128 v[240:243],v18 offset:40960
s_waitcnt lgkmcnt(5)
v_mfma_f32_16x16x32_bf16 v[64:67],a[56:59],v[248:251],v[64:67]
v_min3_u32 v27,v27,v248,v252
v_mfma_f32_16x16x32_bf16 v[68:71],a[168:171],v[248:251],v[68:71]
ds_read_b128 v[244:247],v18 offset:43008
v_mfma_f32_16x16x32_bf16 v[64:67],a[60:63],v[252:255],v[64:67]
v_mfma_f32_16x16x32_bf16 v[68:71],a[172:175],v[252:255],v[68:71]
ds_read_b128 v[248:251],v18 offset:45056
s_waitcnt lgkmcnt(5)
v_mfma_f32_16x16x32_bf16 v[64:67],a[64:67],v[224:227],v[64:67]
v_min3_u32 v27,v27,v224,v228
v_mfma_f32_16x16x32_bf16 v[68:71],a[176:179],v[224:227],v[68:71]
ds_read_b128 v[252:255],v18 offset:47104
v_mfma_f32_16x16x32_bf16 v[64:67],a[68:71],v[228:231],v[64:67]
v_mfma_f32_16x16x32_bf16 v[68:71],a[180:183],v[228:231],v[68:71]
ds_read_b128 v[224:227],v18 offset:49152
s_waitcnt lgkmcnt(5)
v_mfma_f32_16x16x32_bf16 v[64:67],a[72:75],v[232:235],v[64:67]
v_min3_u32 v27,v27,v232,v236
v_mfma_f32_16x16x32_bf16 v[68:71],a[184:187],v[232:235],v[68:71]
ds_read_b128 v[228:231],v18 offset:51200
v_mfma_f32_16x16x32_bf16 v[64:67],a[76:79],v[236:239],v[64:67]
v_mfma_f32_16x16x32_bf16 v[68:71],a[188:191],v[236:239],v[68:71]
ds_read_b128 v[232:235],v18 offset:53248
s_waitcnt lgkmcnt(5)
v_mfma_f32_16x16x32_bf16 v[64:67],a[80:83],v[240:243],v[64:67]
v_min3_u32 v27,v27,v240,v244
v_mfma_f32_16x16x32_bf16 v[68:71],a[192:195],v[240:243],v[68:71]
ds_read_b128 v[236:239],v18 offset:55296
v_mfma_f32_16x16x32_bf16 v[64:67],a[84:87],v[244:247],v[64:67]
v_mfma_f32_16x16x32_bf16 v[68:71],a[196:199],v[244:247],v[68:71]
s_waitcnt lgkmcnt(4)
v_mfma_f32_16x16x32_bf16 v[64:67],a[88:91],v[248:251],v[64:67]
v_min3_u32 v27,v27,v248,v252
v_mfma_f32_16x16x32_bf16 v[68:71],a[200:203],v[248:251],v[68:71]
v_mfma_f32_16x16x32_bf16 v[64:67],a[92:95],v[252:255],v[64:67]
v_mfma_f32_16x16x32_bf16 v[68:71],a[204:207],v[252:255],v[68:71]
s_waitcnt lgkmcnt(2)
v_mfma_f32_16x16x32_bf16 v[64:67],a[96:99],v[224:227],v[64:67]
v_min3_u32 v27,v27,v224,v228
v_min3_u32 v27,v27,v226,v230
v_mfma_f32_16x16x32_bf16 v[68:71],a[208:211],v[224:227],v[68:71]
v_mfma_f32_16x16x32_bf16 v[64:67],a[100:103],v[228:231],v[64:67]
v_mfma_f32_16x16x32_bf16 v[68:71],a[212:215],v[228:231],v[68:71]
s_waitcnt lgkmcnt(0)
v_mfma_f32_16x16x32_bf16 v[64:67],a[104:107],v[232:235],v[64:67]
v_min3_u32 v27,v27,v232,v236
v_min3_u32 v27,v27,v234,v238
v_mfma_f32_16x16x32_bf16 v[68:71],a[216:219],v[232:235],v[68:71]
v_mfma_f32_16x16x32_bf16 v[64:67],a[108:111],v[236:239],v[64:67]
v_mfma_f32_16x16x32_bf16 v[68:71],a[220:223],v[236:239],v[68:71]
v_cmp_eq_u32 vcc,0,v27
s_and_b64 vcc,vcc,s[52:53]
s_cbranch_vccnz retry_326
buffer_load_dword v29,v21,s[20:23],s87 offen sc1
s_mov_b32 s40,0x7fff0000
s_nop 5
v_and_or_b32 v64,v64,-4,s48
s_add_u32 s64,s77,s34
buffer_store_dwordx4 v[64:67],v25,s[20:23],s64 offen offset:2048
v_and_or_b32 v68,v68,-4,s48
s_add_u32 s64,s77,s35
buffer_store_dwordx4 v[68:71],v25,s[20:23],s64 offen offset:3072
hjoin_350:
v_xor_b32 v18,0x10000,v18
s_xor_b32 s49,s77,524288
s_cselect_b32 s64,0,3
s_xor_b32 s48,s48,s64
v_xor_b32 v20,0x2000,v20
s_sub_u32 s76,s76,2097152
s_mov_b32 s77,s49
s_sub_u32 s78,s78,65536
s_branch next_336
half2_332:
s_cmp_eq_u32 s43,0
s_cbranch_scc1 h2b_349
s_branch h2a_348
hown_347:
s_mov_b64 exec,s[52:53]
s_xor_b32 m0,s91,1024
s_add_u32 s65,s95,0
buffer_load_dwordx4 v16,s[20:23],s65 offen offset:0 sc1 lds
buffer_load_dwordx4 v16,s[20:23],s65 offen offset:2048 sc1 lds
s_xor_b32 m0,s91,17408
s_add_u32 s65,s95,32768
buffer_load_dwordx4 v16,s[20:23],s65 offen offset:0 sc1 lds
buffer_load_dwordx4 v16,s[20:23],s65 offen offset:2048 sc1 lds
s_xor_b32 m0,s91,33792
s_add_u32 s65,s95,65536
buffer_load_dwordx4 v16,s[20:23],s65 offen offset:0 sc1 lds
buffer_load_dwordx4 v16,s[20:23],s65 offen offset:2048 sc1 lds
s_xor_b32 m0,s91,50176
s_add_u32 s65,s95,s86
buffer_load_dwordx4 v16,s[20:23],s65 offen offset:0 sc1 lds
buffer_load_dwordx4 v16,s[20:23],s65 offen offset:2048 sc1 lds
s_mov_b64 exec,-1
h2b_349:
buffer_load_dwordx2 v[120:121],v20,s[20:23],s76 offen sc1
buffer_load_dwordx2 v[122:123],v24,s[20:23],s70 offen sc1
s_waitcnt vmcnt(8)
s_barrier
ds_read_b128 v[128:131],v17 offset:0
ds_read_b128 v[132:135],v17 offset:2048
ds_read_b128 v[136:139],v17 offset:4096
ds_read_b128 v[140:143],v17 offset:6144
ds_read_b128 v[144:147],v17 offset:8192
ds_read_b128 v[148:151],v17 offset:10240
ds_read_b128 v[152:155],v17 offset:12288
s_waitcnt lgkmcnt(5)
v_mfma_f32_16x16x32_bf16 v[72:75],a[112:115],v[128:131],0
v_min_u32 v27,v128,v132
v_mfma_f32_16x16x32_bf16 v[80:83],a[0:3],v[128:131],0
ds_read_b128 v[156:159],v17 offset:14336
v_mfma_f32_16x16x32_bf16 v[76:79],a[116:119],v[132:135],0
v_mfma_f32_16x16x32_bf16 v[84:87],a[4:7],v[132:135],0
s_waitcnt vmcnt(6)
s_barrier
ds_read_b128 v[160:163],v17 offset:16384
s_waitcnt lgkmcnt(5)
v_mfma_f32_16x16x32_bf16 v[72:75],a[120:123],v[136:139],v[72:75]
v_min3_u32 v27,v27,v136,v140
v_mfma_f32_16x16x32_bf16 v[80:83],a[8:11],v[136:139],v[80:83]
ds_read_b128 v[164:167],v17 offset:18432
v_mfma_f32_16x16x32_bf16 v[76:79],a[124:127],v[140:143],v[76:79]
v_mfma_f32_16x16x32_bf16 v[84:87],a[12:15],v[140:143],v[84:87]
ds_read_b128 v[168:171],v17 offset:20480
s_waitcnt lgkmcnt(5)
v_mfma_f32_16x16x32_bf16 v[72:75],a[128:131],v[144:147],v[72:75]
v_min3_u32 v27,v27,v144,v148
v_mfma_f32_16x16x32_bf16 v[80:83],a[16:19],v[144:147],v[80:83]
ds_read_b128 v[172:175],v17 offset:22528
v_mfma_f32_16x16x32_bf16 v[76:79],a[132:135],v[148:151],v[76:79]
v_mfma_f32_16x16x32_bf16 v[84:87],a[20:23],v[148:151],v[84:87]
ds_read_b128 v[176:179],v17 offset:24576
s_waitcnt lgkmcnt(5)
v_mfma_f32_16x16x32_bf16 v[72:75],a[136:139],v[152:155],v[72:75]
v_min3_u32 v27,v27,v152,v156
v_mfma_f32_16x16x32_bf16 v[80:83],a[24:27],v[152:155],v[80:83]
ds_read_b128 v[180:183],v17 offset:26624
v_mfma_f32_16x16x32_bf16 v[76:79],a[140:143],v[156:159],v[76:79]
v_mfma_f32_16x16x32_bf16 v[84:87],a[28:31],v[156:159],v[84:87]
ds_read_b128 v[184:187],v17 offset:28672
s_waitcnt lgkmcnt(5)
v_mfma_f32_16x16x32_bf16 v[72:75],a[144:147],v[160:163],v[72:75]
v_min3_u32 v27,v27,v160,v164
v_mfma_f32_16x16x32_bf16 v[80:83],a[32:35],v[160:163],v[80:83]
ds_read_b128 v[188:191],v17 offset:30720
v_mfma_f32_16x16x32_bf16 v[76:79],a[148:151],v[164:167],v[76:79]
v_mfma_f32_16x16x32_bf16 v[84:87],a[36:39],v[164:167],v[84:87]
s_waitcnt vmcnt(2)
s_barrier
ds_read_b128 v[192:195],v17 offset:32768
s_waitcnt lgkmcnt(5)
v_mfma_f32_16x16x32_bf16 v[72:75],a[152:155],v[168:171],v[72:75]
v_min3_u32 v27,v27,v168,v172
v_mfma_f32_16x16x32_bf16 v[80:83],a[40:43],v[168:171],v[80:83]
ds_read_b128 v[196:199],v17 offset:34816
v_mfma_f32_16x16x32_bf16 v[76:79],a[156:159],v[172:175],v[76:79]
v_mfma_f32_16x16x32_bf16 v[84:87],a[44:47],v[172:175],v[84:87]
ds_read_b128 v[200:203],v17 offset:36864
s_waitcnt lgkmcnt(5)
v_mfma_f32_16x16x32_bf16 v[72:75],a[160:163],v[176:179],v[72:75]
v_min3_u32 v27,v27,v176,v180
v_mfma_f32_16x16x32_bf16 v[80:83],a[48:51],v[176:179],v[80:83]
ds_read_b128 v[204:207],v17 offset:38912
v_mfma_f32_16x16x32_bf16 v[76:79],a[164:167],v[180:183],v[76:79]
v_mfma_f32_16x16x32_bf16 v[84:87],a[52:55],v[180:183],v[84:87]
ds_read_b128 v[208:211],v17 offset:40960
s_waitcnt lgkmcnt(5)
v_mfma_f32_16x16x32_bf16 v[72:75],a[168:171],v[184:187],v[72:75]
v_min3_u32 v27,v27,v184,v188
v_mfma_f32_16x16x32_bf16 v[80:83],a[56:59],v[184:187],v[80:83]
ds_read_b128 v[212:215],v17 offset:43008
v_mfma_f32_16x16x32_bf16 v[76:79],a[172:175],v[188:191],v[76:79]
v_mfma_f32_16x16x32_bf16 v[84:87],a[60:63],v[188:191],v[84:87]
ds_read_b128 v[216:219],v17 offset:45056
s_waitcnt lgkmcnt(5)
v_mfma_f32_16x16x32_bf16 v[72:75],a[176:179],v[192:195],v[72:75]
v_min3_u32 v27,v27,v192,v196
s_waitcnt vmcnt(0)
v_mfma_f32_16x16x32_bf16 v[80:83],a[64:67],v[192:195],v[80:83]
ds_read_b128 v[220:223],v17 offset:47104
ds_bpermute_b32 v124,v41,v120
v_mfma_f32_16x16x32_bf16 v[76:79],a[180:183],v[196:199],v[76:79]
ds_bpermute_b32 v125,v41,v121
v_lshlrev_b32 v108,16,v122
v_mfma_f32_16x16x32_bf16 v[84:87],a[68:71],v[196:199],v[84:87]
ds_read_b128 v[224:227],v17 offset:49152
s_waitcnt lgkmcnt(7)
v_mfma_f32_16x16x32_bf16 v[72:75],a[184:187],v[200:203],v[72:75]
v_min3_u32 v27,v27,v200,v204
v_and_b32 v109,s80,v122
v_mfma_f32_16x16x32_bf16 v[80:83],a[72:75],v[200:203],v[80:83]
ds_read_b128 v[228:231],v17 offset:51200
v_lshlrev_b32 v110,16,v123
v_mfma_f32_16x16x32_bf16 v[76:79],a[188:191],v[204:207],v[76:79]
v_and_b32 v111,s80,v123
s_waitcnt lgkmcnt(2)
v_mfma_f32_16x16x32_bf16 v[84:87],a[76:79],v[204:207],v[84:87]
ds_read_b128 v[232:235],v17 offset:53248
v_mfma_f32_16x16x32_bf16 v[72:75],a[192:195],v[208:211],v[72:75]
v_min3_u32 v27,v27,v208,v212
v_lshlrev_b32 v104,16,v124
v_mfma_f32_16x16x32_bf16 v[80:83],a[80:83],v[208:211],v[80:83]
ds_read_b128 v[236:239],v17 offset:55296
v_and_b32 v105,s80,v124
v_mfma_f32_16x16x32_bf16 v[76:79],a[196:199],v[212:215],v[76:79]
v_lshlrev_b32 v106,16,v125
v_and_b32 v107,s80,v125
v_mfma_f32_16x16x32_bf16 v[84:87],a[84:87],v[212:215],v[84:87]
v_mfma_f32_16x16x32_bf16 v[72:75],a[200:203],v[216:219],v[72:75]
v_min3_u32 v27,v27,v216,v220
v_mfma_f32_16x16x32_bf16 v[80:83],a[88:91],v[216:219],v[80:83]
v_mfma_f32_16x16x32_bf16 v[76:79],a[204:207],v[220:223],v[76:79]
v_mfma_f32_16x16x32_bf16 v[84:87],a[92:95],v[220:223],v[84:87]
s_waitcnt lgkmcnt(2)
v_mfma_f32_16x16x32_bf16 v[72:75],a[208:211],v[224:227],v[72:75]
v_min3_u32 v27,v27,v224,v228
v_min3_u32 v27,v27,v226,v230
v_mfma_f32_16x16x32_bf16 v[80:83],a[96:99],v[224:227],v[80:83]
v_mfma_f32_16x16x32_bf16 v[76:79],a[212:215],v[228:231],v[76:79]
v_mfma_f32_16x16x32_bf16 v[84:87],a[100:103],v[228:231],v[84:87]
s_waitcnt lgkmcnt(0)
v_mfma_f32_16x16x32_bf16 v[72:75],a[216:219],v[232:235],v[72:75]
v_min3_u32 v27,v27,v232,v236
v_min3_u32 v27,v27,v234,v238
v_mfma_f32_16x16x32_bf16 v[80:83],a[104:107],v[232:235],v[80:83]
v_mfma_f32_16x16x32_bf16 v[76:79],a[220:223],v[236:239],v[76:79]
v_mfma_f32_16x16x32_bf16 v[84:87],a[108:111],v[236:239],v[84:87]
v_cmp_eq_u32 vcc,0,v27
s_and_b64 vcc,vcc,s[52:53]
s_cbranch_vccnz retry_326
buffer_load_dword v29,v21,s[20:23],s87 offen sc1
s_nop 6
v_add_f32 v72,v72,v76
v_add_f32 v73,v73,v77
v_add_f32 v74,v74,v78
v_add_f32 v75,v75,v79
v_and_or_b32 v72,v72,-4,s48
s_add_u32 s64,s77,s33
buffer_store_dwordx4 v[72:75],v25,s[20:23],s64 offen offset:1024
v_pk_add_f32 v[112:113],v[80:81],v[84:85]
v_pk_add_f32 v[112:113],v[112:113],v[108:109]
v_pk_add_f32 v[114:115],v[82:83],v[86:87]
v_pk_add_f32 v[114:115],v[114:115],v[110:111]
v_mov_b32 v116,v104
v_mov_b32 v117,v105
v_mov_b32 v118,v106
v_mov_b32 v119,v107
s_mov_b32 s40,s77
s_mov_b32 s60,s48
s_branch hjoin_350
kslow_325:
s_add_u32 s64,s79,0
s_lshl_b32 s70,s64,21
s_lshl_b32 s64,s64,13
s_and_b32 s64,s64,0x2000
s_xor_b32 s64,s64,s62
s_add_u32 s70,s70,s64
s_add_u32 s70,s70,29360128
s_mov_b32 s83,1
s_mov_b32 s87,s74
s_cmp_eq_u32 s50,0
s_cselect_b32 s74,s74,0x7fff0000
v_mov_b32 v47,132096
s_lshl_b32 s64,s50,3
s_add_u32 s64,s64,132096
v_mov_b32 v46,s64
v_mov_b32 v29,0
s_mov_b32 s97,0x7fff0000
s_mov_b32 s69,1
s_mov_b32 s68,0
s_mov_b32 s52,0x30003
s_mov_b32 s53,s52
seg_352:
s_add_u32 s94,s70,s75
s_xor_b32 s95,s94,1024
s_xor_b32 s91,s72,0x10000
s_cmp_eq_u32 s69,0
s_mov_b32 s69,1
s_cbranch_scc1 half2_357
s_waitcnt vmcnt(1)
v_cmp_gt_u32 vcc,s71,v29
s_cbranch_vccz nb_356
s_cmp_lg_u32 s50,0
s_cbranch_scc1 nb_356
buffer_load_dword v32,v21,s[20:23],s74 offen sc1
s_sleep 2
pl_358:
buffer_load_dword v33,v21,s[20:23],s74 offen sc1
s_waitcnt vmcnt(1)
v_cmp_gt_u32 vcc,s71,v32
v_mov_b32 v29,v32
s_cbranch_vccz pok_359
buffer_load_dword v32,v21,s[20:23],s74 offen sc1
s_waitcnt vmcnt(1)
v_cmp_gt_u32 vcc,s71,v33
v_mov_b32 v29,v33
s_cbranch_vccz pok_359
s_sub_u32 s90,s90,1
s_cmp_gt_i32 s90,0
s_cbranch_scc1 pl_358
pok_359:
nb_356:
s_cmp_eq_u32 s71,64
s_barrier
s_cbranch_scc1 half_360
s_xor_b32 m0,s91,0
s_add_u32 s65,s94,0
buffer_load_dwordx4 v16,s[20:23],s65 offen offset:0 sc1 lds
buffer_load_dwordx4 v16,s[20:23],s65 offen offset:2048 sc1 lds
s_xor_b32 m0,s91,16384
s_add_u32 s65,s94,32768
buffer_load_dwordx4 v16,s[20:23],s65 offen offset:0 sc1 lds
buffer_load_dwordx4 v16,s[20:23],s65 offen offset:2048 sc1 lds
s_xor_b32 m0,s91,32768
s_add_u32 s65,s94,65536
buffer_load_dwordx4 v16,s[20:23],s65 offen offset:0 sc1 lds
buffer_load_dwordx4 v16,s[20:23],s65 offen offset:2048 sc1 lds
s_xor_b32 m0,s91,49152
s_add_u32 s65,s94,s86
buffer_load_dwordx4 v16,s[20:23],s65 offen offset:0 sc1 lds
buffer_load_dwordx4 v16,s[20:23],s65 offen offset:2048 sc1 lds
s_waitcnt vmcnt(6)
s_barrier
ds_read_b128 v[224:227],v18 offset:0
ds_read_b128 v[228:231],v18 offset:2048
ds_read_b128 v[232:235],v18 offset:4096
ds_read_b128 v[236:239],v18 offset:6144
ds_read_b128 v[240:243],v18 offset:8192
ds_read_b128 v[244:247],v18 offset:10240
ds_read_b128 v[248:251],v18 offset:12288
s_waitcnt lgkmcnt(5)
v_mfma_f32_16x16x32_bf16 v[64:67],a[0:3],v[224:227],0
s_xor_b32 m0,s91,1024
v_min_u32 v27,v224,v228
v_mfma_f32_16x16x32_bf16 v[68:71],a[112:115],v[224:227],0
ds_read_b128 v[252:255],v18 offset:14336
v_mfma_f32_16x16x32_bf16 v[64:67],a[4:7],v[228:231],v[64:67]
s_add_u32 s65,s95,0
v_mfma_f32_16x16x32_bf16 v[68:71],a[116:119],v[228:231],v[68:71]
s_waitcnt vmcnt(4)
s_barrier
ds_read_b128 v[224:227],v18 offset:16384
s_waitcnt lgkmcnt(5)
v_mfma_f32_16x16x32_bf16 v[64:67],a[8:11],v[232:235],v[64:67]
buffer_load_dwordx4 v16,s[20:23],s65 offen offset:0 sc1 lds
v_mfma_f32_16x16x32_bf16 v[68:71],a[120:123],v[232:235],v[68:71]
ds_read_b128 v[228:231],v18 offset:18432
v_min3_u32 v27,v27,v232,v236
v_mfma_f32_16x16x32_bf16 v[64:67],a[12:15],v[236:239],v[64:67]
buffer_load_dwordx4 v16,s[20:23],s65 offen offset:2048 sc1 lds
v_mfma_f32_16x16x32_bf16 v[68:71],a[124:127],v[236:239],v[68:71]
ds_read_b128 v[232:235],v18 offset:20480
s_waitcnt lgkmcnt(5)
v_mfma_f32_16x16x32_bf16 v[64:67],a[16:19],v[240:243],v[64:67]
s_xor_b32 m0,s91,17408
v_min3_u32 v27,v27,v240,v244
v_mfma_f32_16x16x32_bf16 v[68:71],a[128:131],v[240:243],v[68:71]
ds_read_b128 v[236:239],v18 offset:22528
v_mfma_f32_16x16x32_bf16 v[64:67],a[20:23],v[244:247],v[64:67]
s_add_u32 s65,s95,32768
v_mfma_f32_16x16x32_bf16 v[68:71],a[132:135],v[244:247],v[68:71]
ds_read_b128 v[240:243],v18 offset:24576
s_waitcnt lgkmcnt(5)
v_mfma_f32_16x16x32_bf16 v[64:67],a[24:27],v[248:251],v[64:67]
buffer_load_dwordx4 v16,s[20:23],s65 offen offset:0 sc1 lds
v_mfma_f32_16x16x32_bf16 v[68:71],a[136:139],v[248:251],v[68:71]
ds_read_b128 v[244:247],v18 offset:26624
v_min3_u32 v27,v27,v248,v252
v_mfma_f32_16x16x32_bf16 v[64:67],a[28:31],v[252:255],v[64:67]
buffer_load_dwordx4 v16,s[20:23],s65 offen offset:2048 sc1 lds
v_mfma_f32_16x16x32_bf16 v[68:71],a[140:143],v[252:255],v[68:71]
ds_read_b128 v[248:251],v18 offset:28672
s_waitcnt lgkmcnt(5)
v_mfma_f32_16x16x32_bf16 v[64:67],a[32:35],v[224:227],v[64:67]
s_xor_b32 m0,s91,33792
v_min3_u32 v27,v27,v224,v228
v_mfma_f32_16x16x32_bf16 v[68:71],a[144:147],v[224:227],v[68:71]
ds_read_b128 v[252:255],v18 offset:30720
v_mfma_f32_16x16x32_bf16 v[64:67],a[36:39],v[228:231],v[64:67]
s_add_u32 s65,s95,65536
v_mfma_f32_16x16x32_bf16 v[68:71],a[148:151],v[228:231],v[68:71]
s_waitcnt vmcnt(4)
s_barrier
ds_read_b128 v[224:227],v18 offset:32768
s_waitcnt lgkmcnt(5)
v_mfma_f32_16x16x32_bf16 v[64:67],a[40:43],v[232:235],v[64:67]
buffer_load_dwordx4 v16,s[20:23],s65 offen offset:0 sc1 lds
s_add_u32 s88,s70,s75
v_mfma_f32_16x16x32_bf16 v[68:71],a[152:155],v[232:235],v[68:71]
ds_read_b128 v[228:231],v18 offset:34816
v_min3_u32 v27,v27,v232,v236
s_add_u32 s88,s88,2097152
v_mfma_f32_16x16x32_bf16 v[64:67],a[44:47],v[236:239],v[64:67]
buffer_load_dwordx4 v16,s[20:23],s65 offen offset:2048 sc1 lds
v_mfma_f32_16x16x32_bf16 v[68:71],a[156:159],v[236:239],v[68:71]
ds_read_b128 v[232:235],v18 offset:36864
s_waitcnt lgkmcnt(5)
v_mfma_f32_16x16x32_bf16 v[64:67],a[48:51],v[240:243],v[64:67]
s_xor_b32 m0,s91,50176
v_min3_u32 v27,v27,v240,v244
v_mfma_f32_16x16x32_bf16 v[68:71],a[160:163],v[240:243],v[68:71]
ds_read_b128 v[236:239],v18 offset:38912
s_xor_b32 s88,s88,0x2000
v_mfma_f32_16x16x32_bf16 v[64:67],a[52:55],v[244:247],v[64:67]
s_add_u32 s65,s95,s86
s_xor_b32 s89,s88,1024
v_mfma_f32_16x16x32_bf16 v[68:71],a[164:167],v[244:247],v[68:71]
ds_read_b128 v[240:243],v18 offset:40960
s_waitcnt lgkmcnt(5)
v_mfma_f32_16x16x32_bf16 v[64:67],a[56:59],v[248:251],v[64:67]
buffer_load_dwordx4 v16,s[20:23],s65 offen offset:0 sc1 lds
v_mfma_f32_16x16x32_bf16 v[68:71],a[168:171],v[248:251],v[68:71]
ds_read_b128 v[244:247],v18 offset:43008
v_min3_u32 v27,v27,v248,v252
v_mfma_f32_16x16x32_bf16 v[64:67],a[60:63],v[252:255],v[64:67]
buffer_load_dwordx4 v16,s[20:23],s65 offen offset:2048 sc1 lds
v_mfma_f32_16x16x32_bf16 v[68:71],a[172:175],v[252:255],v[68:71]
ds_read_b128 v[248:251],v18 offset:45056
s_waitcnt lgkmcnt(5)
v_mfma_f32_16x16x32_bf16 v[64:67],a[64:67],v[224:227],v[64:67]
s_waitcnt vmcnt(4)
s_barrier
ds_read_b128 v[128:131],v17 offset:0
ds_read_b128 v[132:135],v17 offset:2048
v_mfma_f32_16x16x32_bf16 v[68:71],a[176:179],v[224:227],v[68:71]
ds_read_b128 v[252:255],v18 offset:47104
v_min3_u32 v27,v27,v224,v228
v_mfma_f32_16x16x32_bf16 v[64:67],a[68:71],v[228:231],v[64:67]
ds_read_b128 v[136:139],v17 offset:4096
buffer_load_dwordx2 v[120:121],v20,s[20:23],s76 offen sc1
v_mfma_f32_16x16x32_bf16 v[68:71],a[180:183],v[228:231],v[68:71]
ds_read_b128 v[224:227],v18 offset:49152
s_waitcnt lgkmcnt(8)
v_mfma_f32_16x16x32_bf16 v[64:67],a[72:75],v[232:235],v[64:67]
ds_read_b128 v[140:143],v17 offset:6144
v_min3_u32 v27,v27,v232,v236
v_mfma_f32_16x16x32_bf16 v[68:71],a[184:187],v[232:235],v[68:71]
ds_read_b128 v[228:231],v18 offset:51200
buffer_load_dwordx2 v[122:123],v24,s[20:23],s70 offen sc1
v_mfma_f32_16x16x32_bf16 v[64:67],a[76:79],v[236:239],v[64:67]
ds_read_b128 v[144:147],v17 offset:8192
ds_read_b128 v[148:151],v17 offset:10240
v_mfma_f32_16x16x32_bf16 v[68:71],a[188:191],v[236:239],v[68:71]
ds_read_b128 v[232:235],v18 offset:53248
s_waitcnt lgkmcnt(11)
v_mfma_f32_16x16x32_bf16 v[64:67],a[80:83],v[240:243],v[64:67]
ds_read_b128 v[152:155],v17 offset:12288
v_min3_u32 v27,v27,v240,v244
v_mfma_f32_16x16x32_bf16 v[68:71],a[192:195],v[240:243],v[68:71]
ds_read_b128 v[236:239],v18 offset:55296
v_mfma_f32_16x16x32_bf16 v[64:67],a[84:87],v[244:247],v[64:67]
ds_read_b128 v[156:159],v17 offset:14336
v_mfma_f32_16x16x32_bf16 v[68:71],a[196:199],v[244:247],v[68:71]
s_waitcnt lgkmcnt(10)
v_mfma_f32_16x16x32_bf16 v[64:67],a[88:91],v[248:251],v[64:67]
ds_read_b128 v[160:163],v17 offset:16384
ds_read_b128 v[164:167],v17 offset:18432
v_mfma_f32_16x16x32_bf16 v[68:71],a[200:203],v[248:251],v[68:71]
v_min3_u32 v27,v27,v248,v252
v_mfma_f32_16x16x32_bf16 v[64:67],a[92:95],v[252:255],v[64:67]
ds_read_b128 v[168:171],v17 offset:20480
v_mfma_f32_16x16x32_bf16 v[68:71],a[204:207],v[252:255],v[68:71]
s_waitcnt lgkmcnt(9)
v_mfma_f32_16x16x32_bf16 v[64:67],a[96:99],v[224:227],v[64:67]
ds_read_b128 v[172:175],v17 offset:22528
v_min3_u32 v27,v27,v224,v228
v_mfma_f32_16x16x32_bf16 v[68:71],a[208:211],v[224:227],v[68:71]
v_min3_u32 v27,v27,v226,v230
v_mfma_f32_16x16x32_bf16 v[64:67],a[100:103],v[228:231],v[64:67]
ds_read_b128 v[176:179],v17 offset:24576
ds_read_b128 v[180:183],v17 offset:26624
v_mfma_f32_16x16x32_bf16 v[68:71],a[212:215],v[228:231],v[68:71]
s_waitcnt lgkmcnt(7)
v_mfma_f32_16x16x32_bf16 v[64:67],a[104:107],v[232:235],v[64:67]
ds_read_b128 v[184:187],v17 offset:28672
v_min3_u32 v27,v27,v232,v236
v_mfma_f32_16x16x32_bf16 v[68:71],a[216:219],v[232:235],v[68:71]
v_min3_u32 v27,v27,v234,v238
v_mfma_f32_16x16x32_bf16 v[64:67],a[108:111],v[236:239],v[64:67]
ds_read_b128 v[188:191],v17 offset:30720
v_mfma_f32_16x16x32_bf16 v[68:71],a[220:223],v[236:239],v[68:71]
v_mfma_f32_16x16x32_bf16 v[72:75],a[112:115],v[128:131],0
v_cmp_eq_u32 vcc,0,v27
s_cbranch_vccnz retry_351
v_mfma_f32_16x16x32_bf16 v[76:79],a[116:119],v[132:135],0
v_min3_u32 v27,v27,v128,v132
v_mfma_f32_16x16x32_bf16 v[72:75],a[120:123],v[136:139],v[72:75]
s_waitcnt vmcnt(2)
s_barrier
ds_read_b128 v[192:195],v17 offset:32768
v_mfma_f32_16x16x32_bf16 v[76:79],a[124:127],v[140:143],v[76:79]
ds_read_b128 v[196:199],v17 offset:34816
s_waitcnt lgkmcnt(10)
v_mfma_f32_16x16x32_bf16 v[72:75],a[128:131],v[144:147],v[72:75]
ds_read_b128 v[200:203],v17 offset:36864
v_min3_u32 v27,v27,v136,v140
s_waitcnt vmcnt(0)
v_mfma_f32_16x16x32_bf16 v[76:79],a[132:135],v[148:151],v[76:79]
ds_read_b128 v[204:207],v17 offset:38912
v_min3_u32 v27,v27,v144,v148
v_and_or_b32 v64,v64,-4,s48
v_mfma_f32_16x16x32_bf16 v[72:75],a[136:139],v[152:155],v[72:75]
ds_read_b128 v[208:211],v17 offset:40960
s_add_u32 s64,s49,s34
v_mfma_f32_16x16x32_bf16 v[76:79],a[140:143],v[156:159],v[76:79]
v_min3_u32 v27,v27,v152,v156
s_waitcnt lgkmcnt(9)
v_mfma_f32_16x16x32_bf16 v[72:75],a[144:147],v[160:163],v[72:75]
ds_read_b128 v[212:215],v17 offset:43008
buffer_store_dwordx4 v[64:67],v25,s[20:23],s64 offen offset:2048 sc1
v_mfma_f32_16x16x32_bf16 v[76:79],a[148:151],v[164:167],v[76:79]
ds_read_b128 v[216:219],v17 offset:45056
v_min3_u32 v27,v27,v160,v164
v_and_or_b32 v68,v68,-4,s48
v_mfma_f32_16x16x32_bf16 v[72:75],a[152:155],v[168:171],v[72:75]
ds_read_b128 v[220:223],v17 offset:47104
s_add_u32 s64,s49,s35
v_mfma_f32_16x16x32_bf16 v[76:79],a[156:159],v[172:175],v[76:79]
ds_read_b128 v[224:227],v17 offset:49152
s_waitcnt lgkmcnt(9)
v_mfma_f32_16x16x32_bf16 v[72:75],a[160:163],v[176:179],v[72:75]
ds_read_b128 v[228:231],v17 offset:51200
v_min3_u32 v27,v27,v168,v172
v_mfma_f32_16x16x32_bf16 v[76:79],a[164:167],v[180:183],v[76:79]
v_min3_u32 v27,v27,v176,v180
buffer_store_dwordx4 v[68:71],v25,s[20:23],s64 offen offset:3072 sc1
v_mfma_f32_16x16x32_bf16 v[72:75],a[168:171],v[184:187],v[72:75]
ds_read_b128 v[232:235],v17 offset:53248
s_mov_b32 s49,0x7fff0000
v_mfma_f32_16x16x32_bf16 v[76:79],a[172:175],v[188:191],v[76:79]
ds_read_b128 v[236:239],v17 offset:55296
s_waitcnt lgkmcnt(8)
v_mfma_f32_16x16x32_bf16 v[72:75],a[176:179],v[192:195],v[72:75]
v_min3_u32 v27,v27,v184,v188
v_mfma_f32_16x16x32_bf16 v[76:79],a[180:183],v[196:199],v[76:79]
v_min3_u32 v27,v27,v192,v196
ds_bpermute_b32 v124,v41,v120
v_mfma_f32_16x16x32_bf16 v[72:75],a[184:187],v[200:203],v[72:75]
v_mfma_f32_16x16x32_bf16 v[76:79],a[188:191],v[204:207],v[76:79]
v_min3_u32 v27,v27,v200,v204
s_waitcnt lgkmcnt(5)
v_mfma_f32_16x16x32_bf16 v[72:75],a[192:195],v[208:211],v[72:75]
ds_bpermute_b32 v125,v41,v121
v_mfma_f32_16x16x32_bf16 v[76:79],a[196:199],v[212:215],v[76:79]
v_min3_u32 v27,v27,v208,v212
v_lshlrev_b32 v108,16,v122
v_mfma_f32_16x16x32_bf16 v[72:75],a[200:203],v[216:219],v[72:75]
v_mfma_f32_16x16x32_bf16 v[76:79],a[204:207],v[220:223],v[76:79]
v_min3_u32 v27,v27,v216,v220
s_waitcnt lgkmcnt(2)
v_mfma_f32_16x16x32_bf16 v[72:75],a[208:211],v[224:227],v[72:75]
v_and_b32 v109,s80,v122
v_mfma_f32_16x16x32_bf16 v[76:79],a[212:215],v[228:231],v[76:79]
v_min3_u32 v27,v27,v224,v228
v_min3_u32 v27,v27,v226,v230
v_mfma_f32_16x16x32_bf16 v[72:75],a[216:219],v[232:235],v[72:75]
v_lshlrev_b32 v110,16,v123
v_mfma_f32_16x16x32_bf16 v[76:79],a[220:223],v[236:239],v[76:79]
v_min3_u32 v27,v27,v232,v236
v_min3_u32 v27,v27,v234,v238
v_mfma_f32_16x16x32_bf16 v[80:83],a[0:3],v[128:131],0
v_cmp_eq_u32 vcc,0,v27
s_cbranch_vccnz retry_351
v_mfma_f32_16x16x32_bf16 v[84:87],a[4:7],v[132:135],0
v_and_b32 v111,s80,v123
s_waitcnt lgkmcnt(0)
v_mfma_f32_16x16x32_bf16 v[80:83],a[8:11],v[136:139],v[80:83]
v_mfma_f32_16x16x32_bf16 v[84:87],a[12:15],v[140:143],v[84:87]
v_lshlrev_b32 v104,16,v124
v_mfma_f32_16x16x32_bf16 v[80:83],a[16:19],v[144:147],v[80:83]
v_add_f32 v72,v72,v76
v_add_f32 v73,v73,v77
v_mfma_f32_16x16x32_bf16 v[84:87],a[20:23],v[148:151],v[84:87]
v_and_b32 v105,s80,v124
v_add_f32 v74,v74,v78
v_mfma_f32_16x16x32_bf16 v[80:83],a[24:27],v[152:155],v[80:83]
v_add_f32 v75,v75,v79
v_and_or_b32 v72,v72,-4,s48
v_mfma_f32_16x16x32_bf16 v[84:87],a[28:31],v[156:159],v[84:87]
v_lshlrev_b32 v106,16,v125
s_add_u32 s64,s77,s33
v_mfma_f32_16x16x32_bf16 v[80:83],a[32:35],v[160:163],v[80:83]
buffer_store_dwordx4 v[72:75],v25,s[20:23],s64 offen offset:1024 sc1
v_mfma_f32_16x16x32_bf16 v[84:87],a[36:39],v[164:167],v[84:87]
v_and_b32 v107,s80,v125
v_mfma_f32_16x16x32_bf16 v[80:83],a[40:43],v[168:171],v[80:83]
v_mfma_f32_16x16x32_bf16 v[84:87],a[44:47],v[172:175],v[84:87]
v_mfma_f32_16x16x32_bf16 v[80:83],a[48:51],v[176:179],v[80:83]
buffer_load_dwordx4 v[96:99],v26,s[20:23],s77 offen offset:2048 sc1
v_mfma_f32_16x16x32_bf16 v[84:87],a[52:55],v[180:183],v[84:87]
buffer_load_dwordx4 v[100:103],v26,s[20:23],s77 offen offset:3072 sc1
v_mfma_f32_16x16x32_bf16 v[80:83],a[56:59],v[184:187],v[80:83]
v_mfma_f32_16x16x32_bf16 v[84:87],a[60:63],v[188:191],v[84:87]
v_mfma_f32_16x16x32_bf16 v[80:83],a[64:67],v[192:195],v[80:83]
v_mfma_f32_16x16x32_bf16 v[84:87],a[68:71],v[196:199],v[84:87]
v_mfma_f32_16x16x32_bf16 v[80:83],a[72:75],v[200:203],v[80:83]
v_mfma_f32_16x16x32_bf16 v[84:87],a[76:79],v[204:207],v[84:87]
v_mfma_f32_16x16x32_bf16 v[80:83],a[80:83],v[208:211],v[80:83]
v_mfma_f32_16x16x32_bf16 v[84:87],a[84:87],v[212:215],v[84:87]
v_mfma_f32_16x16x32_bf16 v[80:83],a[88:91],v[216:219],v[80:83]
buffer_load_dwordx4 v[92:95],v26,s[20:23],s77 offen offset:1024 sc1
v_mfma_f32_16x16x32_bf16 v[84:87],a[92:95],v[220:223],v[84:87]
v_mfma_f32_16x16x32_bf16 v[80:83],a[96:99],v[224:227],v[80:83]
v_mfma_f32_16x16x32_bf16 v[84:87],a[100:103],v[228:231],v[84:87]
v_mfma_f32_16x16x32_bf16 v[80:83],a[104:107],v[232:235],v[80:83]
v_mfma_f32_16x16x32_bf16 v[84:87],a[108:111],v[236:239],v[84:87]
epi_354:
buffer_load_dword v29,v21,s[20:23],s87 offen sc1
s_nop 6
v_pk_add_f32 v[88:89],v[80:81],v[84:85]
v_pk_add_f32 v[90:91],v[82:83],v[86:87]
v_pk_add_f32 v[88:89],v[88:89],v[108:109]
v_pk_add_f32 v[90:91],v[90:91],v[110:111]
s_waitcnt vmcnt(1)
s_branch ic_364
ip_362:
buffer_load_dwordx4 v[92:95],v26,s[20:23],s77 offen offset:1024 sc1
buffer_load_dwordx4 v[96:99],v26,s[20:23],s77 offen offset:2048 sc1
buffer_load_dwordx4 v[100:103],v26,s[20:23],s77 offen offset:3072 sc1
s_waitcnt vmcnt(0)
ic_364:
v_bitop3_b32 v22,v92,v96,v100 bitop3:0x80
v_and_b32 v22,s48,v22
v_cmp_eq_u32 vcc,0,v22
s_cbranch_vccz ik_363
s_sub_u32 s90,s90,1
s_cmp_gt_i32 s90,0
s_cbranch_scc1 ip_362
ik_363:
s_cmp_lg_u32 s71,65
s_cbranch_scc1 nl_365
buffer_load_dwordx4 v[132:135],v26,s[20:23],s40 offen offset:1024 sc1
buffer_load_dwordx4 v[136:139],v26,s[20:23],s40 offen offset:2048 sc1
buffer_load_dwordx4 v[140:143],v26,s[20:23],s40 offen offset:3072 sc1
nl_365:
v_pk_add_f32 v[88:89],v[88:89],v[92:93]
v_pk_add_f32 v[96:97],v[96:97],v[100:101]
v_pk_add_f32 v[90:91],v[90:91],v[94:95]
v_pk_add_f32 v[98:99],v[98:99],v[102:103]
v_pk_add_f32 v[88:89],v[88:89],v[96:97]
v_pk_add_f32 v[90:91],v[90:91],v[98:99]
v_pk_fma_f32 v[88:89],v[88:89],v[52:53],v[104:105]
v_pk_fma_f32 v[90:91],v[90:91],v[54:55],v[106:107]
v_cvt_pk_bf16_f32 v88,v88,v89
v_cvt_pk_bf16_f32 v89,v90,v91
ds_bpermute_b32 v88,v40,v88
ds_bpermute_b32 v89,v40,v89
v_xor_b32 v18,0x10000,v18
s_xor_b32 s49,s77,524288
s_cselect_b32 s64,0,3
s_xor_b32 s48,s48,s64
s_cmp_eq_u32 s71,63
s_cselect_b32 s64,0,0x2000
s_cselect_b32 s66,2,1
s_cmp_eq_u32 s71,64
s_cselect_b32 s66,-1,s66
v_xor_b32 v20,s64,v20
s_lshl_b32 s64,s66,21
s_add_u32 s76,s76,s64
s_lshl_b32 s66,s66,16
s_waitcnt lgkmcnt(0)
s_mov_b64 exec,s[84:85]
buffer_store_dwordx2 v[88:89],v19,s[36:39],s78 offen
s_mov_b64 exec,-1
s_mov_b64 s[84:85],-1
s_mov_b32 s77,s49
s_add_u32 s78,s78,s66
next_361:
v_xor_b32 v17,0x10000,v17
s_xor_b32 s72,s72,0x10000
s_add_u32 s70,s70,2097152
s_xor_b32 s70,s70,0x2000
s_add_u32 s71,s71,1
s_cmp_le_u32 s71,s57
s_cbranch_scc1 seg_352
s_cmp_lg_u32 s43,0
s_cbranch_scc1 hn_369
s_waitcnt vmcnt(1)
s_branch hc_368
hp_366:
buffer_load_dwordx4 v[132:135],v26,s[20:23],s40 offen offset:1024 sc1
buffer_load_dwordx4 v[136:139],v26,s[20:23],s40 offen offset:2048 sc1
buffer_load_dwordx4 v[140:143],v26,s[20:23],s40 offen offset:3072 sc1
s_waitcnt vmcnt(0)
hc_368:
v_bitop3_b32 v22,v132,v136,v140 bitop3:0x80
v_and_b32 v22,s60,v22
v_cmp_eq_u32 vcc,0,v22
s_cbranch_vccz hk_367
s_sub_u32 s90,s90,1
s_cmp_gt_i32 s90,0
s_cbranch_scc1 hp_366
hk_367:
v_pk_add_f32 v[112:113],v[112:113],v[132:133]
v_pk_add_f32 v[136:137],v[136:137],v[140:141]
v_pk_add_f32 v[114:115],v[114:115],v[134:135]
v_pk_add_f32 v[138:139],v[138:139],v[142:143]
v_pk_add_f32 v[112:113],v[112:113],v[136:137]
v_pk_add_f32 v[114:115],v[114:115],v[138:139]
v_pk_fma_f32 v[112:113],v[112:113],v[52:53],v[116:117]
v_pk_fma_f32 v[114:115],v[114:115],v[54:55],v[118:119]
v_cvt_pk_bf16_f32 v112,v112,v113
v_cvt_pk_bf16_f32 v113,v114,v115
ds_bpermute_b32 v112,v40,v112
ds_bpermute_b32 v113,v40,v113
s_mov_b32 s64,4194304
s_waitcnt lgkmcnt(0)
buffer_store_dwordx2 v[112:113],v19,s[36:39],s64 offen
hn_369:
s_endpgm
retry_351:
s_sub_u32 s90,s90,64
s_cmp_lt_i32 s90,0
s_cbranch_scc1 giveup_197
s_mov_b32 s83,1
s_waitcnt vmcnt(0) lgkmcnt(0)
s_barrier
s_branch seg_352
half_360:
s_cmp_eq_u32 s43,0
s_cbranch_scc1 hown_370
s_mov_b64 exec,s[52:53]
s_xor_b32 m0,s91,0
s_add_u32 s65,s94,0
buffer_load_dwordx4 v16,s[20:23],s65 offen offset:0 sc1 lds
buffer_load_dwordx4 v16,s[20:23],s65 offen offset:2048 sc1 lds
s_xor_b32 m0,s91,16384
s_add_u32 s65,s94,32768
buffer_load_dwordx4 v16,s[20:23],s65 offen offset:0 sc1 lds
buffer_load_dwordx4 v16,s[20:23],s65 offen offset:2048 sc1 lds
s_xor_b32 m0,s91,32768
s_add_u32 s65,s94,65536
buffer_load_dwordx4 v16,s[20:23],s65 offen offset:0 sc1 lds
buffer_load_dwordx4 v16,s[20:23],s65 offen offset:2048 sc1 lds
s_xor_b32 m0,s91,49152
s_add_u32 s65,s94,s86
buffer_load_dwordx4 v16,s[20:23],s65 offen offset:0 sc1 lds
buffer_load_dwordx4 v16,s[20:23],s65 offen offset:2048 sc1 lds
s_mov_b64 exec,-1
h2a_371:
s_waitcnt vmcnt(6)
s_barrier
ds_read_b128 v[224:227],v18 offset:0
ds_read_b128 v[228:231],v18 offset:2048
ds_read_b128 v[232:235],v18 offset:4096
ds_read_b128 v[236:239],v18 offset:6144
ds_read_b128 v[240:243],v18 offset:8192
ds_read_b128 v[244:247],v18 offset:10240
ds_read_b128 v[248:251],v18 offset:12288
s_waitcnt lgkmcnt(5)
v_mfma_f32_16x16x32_bf16 v[64:67],a[0:3],v[224:227],0
v_min_u32 v27,v224,v228
v_mfma_f32_16x16x32_bf16 v[68:71],a[112:115],v[224:227],0
ds_read_b128 v[252:255],v18 offset:14336
v_mfma_f32_16x16x32_bf16 v[64:67],a[4:7],v[228:231],v[64:67]
v_mfma_f32_16x16x32_bf16 v[68:71],a[116:119],v[228:231],v[68:71]
s_waitcnt vmcnt(4)
s_barrier
ds_read_b128 v[224:227],v18 offset:16384
s_waitcnt lgkmcnt(5)
v_mfma_f32_16x16x32_bf16 v[64:67],a[8:11],v[232:235],v[64:67]
v_min3_u32 v27,v27,v232,v236
v_mfma_f32_16x16x32_bf16 v[68:71],a[120:123],v[232:235],v[68:71]
ds_read_b128 v[228:231],v18 offset:18432
v_mfma_f32_16x16x32_bf16 v[64:67],a[12:15],v[236:239],v[64:67]
v_mfma_f32_16x16x32_bf16 v[68:71],a[124:127],v[236:239],v[68:71]
ds_read_b128 v[232:235],v18 offset:20480
s_waitcnt lgkmcnt(5)
v_mfma_f32_16x16x32_bf16 v[64:67],a[16:19],v[240:243],v[64:67]
v_min3_u32 v27,v27,v240,v244
v_mfma_f32_16x16x32_bf16 v[68:71],a[128:131],v[240:243],v[68:71]
ds_read_b128 v[236:239],v18 offset:22528
v_mfma_f32_16x16x32_bf16 v[64:67],a[20:23],v[244:247],v[64:67]
v_mfma_f32_16x16x32_bf16 v[68:71],a[132:135],v[244:247],v[68:71]
ds_read_b128 v[240:243],v18 offset:24576
s_waitcnt lgkmcnt(5)
v_mfma_f32_16x16x32_bf16 v[64:67],a[24:27],v[248:251],v[64:67]
v_min3_u32 v27,v27,v248,v252
v_mfma_f32_16x16x32_bf16 v[68:71],a[136:139],v[248:251],v[68:71]
ds_read_b128 v[244:247],v18 offset:26624
v_mfma_f32_16x16x32_bf16 v[64:67],a[28:31],v[252:255],v[64:67]
v_mfma_f32_16x16x32_bf16 v[68:71],a[140:143],v[252:255],v[68:71]
ds_read_b128 v[248:251],v18 offset:28672
s_waitcnt lgkmcnt(5)
v_mfma_f32_16x16x32_bf16 v[64:67],a[32:35],v[224:227],v[64:67]
v_min3_u32 v27,v27,v224,v228
v_mfma_f32_16x16x32_bf16 v[68:71],a[144:147],v[224:227],v[68:71]
ds_read_b128 v[252:255],v18 offset:30720
v_mfma_f32_16x16x32_bf16 v[64:67],a[36:39],v[228:231],v[64:67]
v_mfma_f32_16x16x32_bf16 v[68:71],a[148:151],v[228:231],v[68:71]
s_waitcnt vmcnt(0)
s_barrier
ds_read_b128 v[224:227],v18 offset:32768
s_waitcnt lgkmcnt(5)
v_mfma_f32_16x16x32_bf16 v[64:67],a[40:43],v[232:235],v[64:67]
v_min3_u32 v27,v27,v232,v236
v_mfma_f32_16x16x32_bf16 v[68:71],a[152:155],v[232:235],v[68:71]
ds_read_b128 v[228:231],v18 offset:34816
v_mfma_f32_16x16x32_bf16 v[64:67],a[44:47],v[236:239],v[64:67]
v_mfma_f32_16x16x32_bf16 v[68:71],a[156:159],v[236:239],v[68:71]
ds_read_b128 v[232:235],v18 offset:36864
s_waitcnt lgkmcnt(5)
v_mfma_f32_16x16x32_bf16 v[64:67],a[48:51],v[240:243],v[64:67]
v_min3_u32 v27,v27,v240,v244
v_mfma_f32_16x16x32_bf16 v[68:71],a[160:163],v[240:243],v[68:71]
ds_read_b128 v[236:239],v18 offset:38912
v_mfma_f32_16x16x32_bf16 v[64:67],a[52:55],v[244:247],v[64:67]
v_mfma_f32_16x16x32_bf16 v[68:71],a[164:167],v[244:247],v[68:71]
ds_read_b128 v[240:243],v18 offset:40960
s_waitcnt lgkmcnt(5)
v_mfma_f32_16x16x32_bf16 v[64:67],a[56:59],v[248:251],v[64:67]
v_min3_u32 v27,v27,v248,v252
v_mfma_f32_16x16x32_bf16 v[68:71],a[168:171],v[248:251],v[68:71]
ds_read_b128 v[244:247],v18 offset:43008
v_mfma_f32_16x16x32_bf16 v[64:67],a[60:63],v[252:255],v[64:67]
v_mfma_f32_16x16x32_bf16 v[68:71],a[172:175],v[252:255],v[68:71]
ds_read_b128 v[248:251],v18 offset:45056
s_waitcnt lgkmcnt(5)
v_mfma_f32_16x16x32_bf16 v[64:67],a[64:67],v[224:227],v[64:67]
v_min3_u32 v27,v27,v224,v228
v_mfma_f32_16x16x32_bf16 v[68:71],a[176:179],v[224:227],v[68:71]
ds_read_b128 v[252:255],v18 offset:47104
v_mfma_f32_16x16x32_bf16 v[64:67],a[68:71],v[228:231],v[64:67]
v_mfma_f32_16x16x32_bf16 v[68:71],a[180:183],v[228:231],v[68:71]
ds_read_b128 v[224:227],v18 offset:49152
s_waitcnt lgkmcnt(5)
v_mfma_f32_16x16x32_bf16 v[64:67],a[72:75],v[232:235],v[64:67]
v_min3_u32 v27,v27,v232,v236
v_mfma_f32_16x16x32_bf16 v[68:71],a[184:187],v[232:235],v[68:71]
ds_read_b128 v[228:231],v18 offset:51200
v_mfma_f32_16x16x32_bf16 v[64:67],a[76:79],v[236:239],v[64:67]
v_mfma_f32_16x16x32_bf16 v[68:71],a[188:191],v[236:239],v[68:71]
ds_read_b128 v[232:235],v18 offset:53248
s_waitcnt lgkmcnt(5)
v_mfma_f32_16x16x32_bf16 v[64:67],a[80:83],v[240:243],v[64:67]
v_min3_u32 v27,v27,v240,v244
v_mfma_f32_16x16x32_bf16 v[68:71],a[192:195],v[240:243],v[68:71]
ds_read_b128 v[236:239],v18 offset:55296
v_mfma_f32_16x16x32_bf16 v[64:67],a[84:87],v[244:247],v[64:67]
v_mfma_f32_16x16x32_bf16 v[68:71],a[196:199],v[244:247],v[68:71]
s_waitcnt lgkmcnt(4)
v_mfma_f32_16x16x32_bf16 v[64:67],a[88:91],v[248:251],v[64:67]
v_min3_u32 v27,v27,v248,v252
v_mfma_f32_16x16x32_bf16 v[68:71],a[200:203],v[248:251],v[68:71]
v_mfma_f32_16x16x32_bf16 v[64:67],a[92:95],v[252:255],v[64:67]
v_mfma_f32_16x16x32_bf16 v[68:71],a[204:207],v[252:255],v[68:71]
s_waitcnt lgkmcnt(2)
v_mfma_f32_16x16x32_bf16 v[64:67],a[96:99],v[224:227],v[64:67]
v_min3_u32 v27,v27,v224,v228
v_min3_u32 v27,v27,v226,v230
v_mfma_f32_16x16x32_bf16 v[68:71],a[208:211],v[224:227],v[68:71]
v_mfma_f32_16x16x32_bf16 v[64:67],a[100:103],v[228:231],v[64:67]
v_mfma_f32_16x16x32_bf16 v[68:71],a[212:215],v[228:231],v[68:71]
s_waitcnt lgkmcnt(0)
v_mfma_f32_16x16x32_bf16 v[64:67],a[104:107],v[232:235],v[64:67]
v_min3_u32 v27,v27,v232,v236
v_min3_u32 v27,v27,v234,v238
v_mfma_f32_16x16x32_bf16 v[68:71],a[216:219],v[232:235],v[68:71]
v_mfma_f32_16x16x32_bf16 v[64:67],a[108:111],v[236:239],v[64:67]
v_mfma_f32_16x16x32_bf16 v[68:71],a[220:223],v[236:239],v[68:71]
v_cmp_eq_u32 vcc,0,v27
s_and_b64 vcc,vcc,s[52:53]
s_cbranch_vccnz retry_351
buffer_load_dword v29,v21,s[20:23],s87 offen sc1
s_mov_b32 s40,0x7fff0000
s_nop 5
v_and_or_b32 v64,v64,-4,s48
s_add_u32 s64,s77,s34
buffer_store_dwordx4 v[64:67],v25,s[20:23],s64 offen offset:2048 sc1
v_and_or_b32 v68,v68,-4,s48
s_add_u32 s64,s77,s35
buffer_store_dwordx4 v[68:71],v25,s[20:23],s64 offen offset:3072 sc1
hjoin_373:
v_xor_b32 v18,0x10000,v18
s_xor_b32 s49,s77,524288
s_cselect_b32 s64,0,3
s_xor_b32 s48,s48,s64
v_xor_b32 v20,0x2000,v20
s_sub_u32 s76,s76,2097152
s_mov_b32 s77,s49
s_sub_u32 s78,s78,65536
s_branch next_361
half2_357:
s_cmp_eq_u32 s43,0
s_cbranch_scc1 h2b_372
s_branch h2a_371
hown_370:
s_mov_b64 exec,s[52:53]
s_xor_b32 m0,s91,1024
s_add_u32 s65,s95,0
buffer_load_dwordx4 v16,s[20:23],s65 offen offset:0 sc1 lds
buffer_load_dwordx4 v16,s[20:23],s65 offen offset:2048 sc1 lds
s_xor_b32 m0,s91,17408
s_add_u32 s65,s95,32768
buffer_load_dwordx4 v16,s[20:23],s65 offen offset:0 sc1 lds
buffer_load_dwordx4 v16,s[20:23],s65 offen offset:2048 sc1 lds
s_xor_b32 m0,s91,33792
s_add_u32 s65,s95,65536
buffer_load_dwordx4 v16,s[20:23],s65 offen offset:0 sc1 lds
buffer_load_dwordx4 v16,s[20:23],s65 offen offset:2048 sc1 lds
s_xor_b32 m0,s91,50176
s_add_u32 s65,s95,s86
buffer_load_dwordx4 v16,s[20:23],s65 offen offset:0 sc1 lds
buffer_load_dwordx4 v16,s[20:23],s65 offen offset:2048 sc1 lds
s_mov_b64 exec,-1
h2b_372:
buffer_load_dwordx2 v[120:121],v20,s[20:23],s76 offen sc1
buffer_load_dwordx2 v[122:123],v24,s[20:23],s70 offen sc1
s_waitcnt vmcnt(8)
s_barrier
ds_read_b128 v[128:131],v17 offset:0
ds_read_b128 v[132:135],v17 offset:2048
ds_read_b128 v[136:139],v17 offset:4096
ds_read_b128 v[140:143],v17 offset:6144
ds_read_b128 v[144:147],v17 offset:8192
ds_read_b128 v[148:151],v17 offset:10240
ds_read_b128 v[152:155],v17 offset:12288
s_waitcnt lgkmcnt(5)
v_mfma_f32_16x16x32_bf16 v[72:75],a[112:115],v[128:131],0
v_min_u32 v27,v128,v132
v_mfma_f32_16x16x32_bf16 v[80:83],a[0:3],v[128:131],0
ds_read_b128 v[156:159],v17 offset:14336
v_mfma_f32_16x16x32_bf16 v[76:79],a[116:119],v[132:135],0
v_mfma_f32_16x16x32_bf16 v[84:87],a[4:7],v[132:135],0
s_waitcnt vmcnt(6)
s_barrier
ds_read_b128 v[160:163],v17 offset:16384
s_waitcnt lgkmcnt(5)
v_mfma_f32_16x16x32_bf16 v[72:75],a[120:123],v[136:139],v[72:75]
v_min3_u32 v27,v27,v136,v140
v_mfma_f32_16x16x32_bf16 v[80:83],a[8:11],v[136:139],v[80:83]
ds_read_b128 v[164:167],v17 offset:18432
v_mfma_f32_16x16x32_bf16 v[76:79],a[124:127],v[140:143],v[76:79]
v_mfma_f32_16x16x32_bf16 v[84:87],a[12:15],v[140:143],v[84:87]
ds_read_b128 v[168:171],v17 offset:20480
s_waitcnt lgkmcnt(5)
v_mfma_f32_16x16x32_bf16 v[72:75],a[128:131],v[144:147],v[72:75]
v_min3_u32 v27,v27,v144,v148
v_mfma_f32_16x16x32_bf16 v[80:83],a[16:19],v[144:147],v[80:83]
ds_read_b128 v[172:175],v17 offset:22528
v_mfma_f32_16x16x32_bf16 v[76:79],a[132:135],v[148:151],v[76:79]
v_mfma_f32_16x16x32_bf16 v[84:87],a[20:23],v[148:151],v[84:87]
ds_read_b128 v[176:179],v17 offset:24576
s_waitcnt lgkmcnt(5)
v_mfma_f32_16x16x32_bf16 v[72:75],a[136:139],v[152:155],v[72:75]
v_min3_u32 v27,v27,v152,v156
v_mfma_f32_16x16x32_bf16 v[80:83],a[24:27],v[152:155],v[80:83]
ds_read_b128 v[180:183],v17 offset:26624
v_mfma_f32_16x16x32_bf16 v[76:79],a[140:143],v[156:159],v[76:79]
v_mfma_f32_16x16x32_bf16 v[84:87],a[28:31],v[156:159],v[84:87]
ds_read_b128 v[184:187],v17 offset:28672
s_waitcnt lgkmcnt(5)
v_mfma_f32_16x16x32_bf16 v[72:75],a[144:147],v[160:163],v[72:75]
v_min3_u32 v27,v27,v160,v164
v_mfma_f32_16x16x32_bf16 v[80:83],a[32:35],v[160:163],v[80:83]
ds_read_b128 v[188:191],v17 offset:30720
v_mfma_f32_16x16x32_bf16 v[76:79],a[148:151],v[164:167],v[76:79]
v_mfma_f32_16x16x32_bf16 v[84:87],a[36:39],v[164:167],v[84:87]
s_waitcnt vmcnt(2)
s_barrier
ds_read_b128 v[192:195],v17 offset:32768
s_waitcnt lgkmcnt(5)
v_mfma_f32_16x16x32_bf16 v[72:75],a[152:155],v[168:171],v[72:75]
v_min3_u32 v27,v27,v168,v172
v_mfma_f32_16x16x32_bf16 v[80:83],a[40:43],v[168:171],v[80:83]
ds_read_b128 v[196:199],v17 offset:34816
v_mfma_f32_16x16x32_bf16 v[76:79],a[156:159],v[172:175],v[76:79]
v_mfma_f32_16x16x32_bf16 v[84:87],a[44:47],v[172:175],v[84:87]
ds_read_b128 v[200:203],v17 offset:36864
s_waitcnt lgkmcnt(5)
v_mfma_f32_16x16x32_bf16 v[72:75],a[160:163],v[176:179],v[72:75]
v_min3_u32 v27,v27,v176,v180
v_mfma_f32_16x16x32_bf16 v[80:83],a[48:51],v[176:179],v[80:83]
ds_read_b128 v[204:207],v17 offset:38912
v_mfma_f32_16x16x32_bf16 v[76:79],a[164:167],v[180:183],v[76:79]
v_mfma_f32_16x16x32_bf16 v[84:87],a[52:55],v[180:183],v[84:87]
ds_read_b128 v[208:211],v17 offset:40960
s_waitcnt lgkmcnt(5)
v_mfma_f32_16x16x32_bf16 v[72:75],a[168:171],v[184:187],v[72:75]
v_min3_u32 v27,v27,v184,v188
v_mfma_f32_16x16x32_bf16 v[80:83],a[56:59],v[184:187],v[80:83]
ds_read_b128 v[212:215],v17 offset:43008
v_mfma_f32_16x16x32_bf16 v[76:79],a[172:175],v[188:191],v[76:79]
v_mfma_f32_16x16x32_bf16 v[84:87],a[60:63],v[188:191],v[84:87]
ds_read_b128 v[216:219],v17 offset:45056
s_waitcnt lgkmcnt(5)
v_mfma_f32_16x16x32_bf16 v[72:75],a[176:179],v[192:195],v[72:75]
v_min3_u32 v27,v27,v192,v196
s_waitcnt vmcnt(0)
v_mfma_f32_16x16x32_bf16 v[80:83],a[64:67],v[192:195],v[80:83]
ds_read_b128 v[220:223],v17 offset:47104
ds_bpermute_b32 v124,v41,v120
v_mfma_f32_16x16x32_bf16 v[76:79],a[180:183],v[196:199],v[76:79]
ds_bpermute_b32 v125,v41,v121
v_lshlrev_b32 v108,16,v122
v_mfma_f32_16x16x32_bf16 v[84:87],a[68:71],v[196:199],v[84:87]
ds_read_b128 v[224:227],v17 offset:49152
s_waitcnt lgkmcnt(7)
v_mfma_f32_16x16x32_bf16 v[72:75],a[184:187],v[200:203],v[72:75]
v_min3_u32 v27,v27,v200,v204
v_and_b32 v109,s80,v122
v_mfma_f32_16x16x32_bf16 v[80:83],a[72:75],v[200:203],v[80:83]
ds_read_b128 v[228:231],v17 offset:51200
v_lshlrev_b32 v110,16,v123
v_mfma_f32_16x16x32_bf16 v[76:79],a[188:191],v[204:207],v[76:79]
v_and_b32 v111,s80,v123
s_waitcnt lgkmcnt(2)
v_mfma_f32_16x16x32_bf16 v[84:87],a[76:79],v[204:207],v[84:87]
ds_read_b128 v[232:235],v17 offset:53248
v_mfma_f32_16x16x32_bf16 v[72:75],a[192:195],v[208:211],v[72:75]
v_min3_u32 v27,v27,v208,v212
v_lshlrev_b32 v104,16,v124
v_mfma_f32_16x16x32_bf16 v[80:83],a[80:83],v[208:211],v[80:83]
ds_read_b128 v[236:239],v17 offset:55296
v_and_b32 v105,s80,v124
v_mfma_f32_16x16x32_bf16 v[76:79],a[196:199],v[212:215],v[76:79]
v_lshlrev_b32 v106,16,v125
v_and_b32 v107,s80,v125
v_mfma_f32_16x16x32_bf16 v[84:87],a[84:87],v[212:215],v[84:87]
v_mfma_f32_16x16x32_bf16 v[72:75],a[200:203],v[216:219],v[72:75]
v_min3_u32 v27,v27,v216,v220
v_mfma_f32_16x16x32_bf16 v[80:83],a[88:91],v[216:219],v[80:83]
v_mfma_f32_16x16x32_bf16 v[76:79],a[204:207],v[220:223],v[76:79]
v_mfma_f32_16x16x32_bf16 v[84:87],a[92:95],v[220:223],v[84:87]
s_waitcnt lgkmcnt(2)
v_mfma_f32_16x16x32_bf16 v[72:75],a[208:211],v[224:227],v[72:75]
v_min3_u32 v27,v27,v224,v228
v_min3_u32 v27,v27,v226,v230
v_mfma_f32_16x16x32_bf16 v[80:83],a[96:99],v[224:227],v[80:83]
v_mfma_f32_16x16x32_bf16 v[76:79],a[212:215],v[228:231],v[76:79]
v_mfma_f32_16x16x32_bf16 v[84:87],a[100:103],v[228:231],v[84:87]
s_waitcnt lgkmcnt(0)
v_mfma_f32_16x16x32_bf16 v[72:75],a[216:219],v[232:235],v[72:75]
v_min3_u32 v27,v27,v232,v236
v_min3_u32 v27,v27,v234,v238
v_mfma_f32_16x16x32_bf16 v[80:83],a[104:107],v[232:235],v[80:83]
v_mfma_f32_16x16x32_bf16 v[76:79],a[220:223],v[236:239],v[76:79]
v_mfma_f32_16x16x32_bf16 v[84:87],a[108:111],v[236:239],v[84:87]
v_cmp_eq_u32 vcc,0,v27
s_and_b64 vcc,vcc,s[52:53]
s_cbranch_vccnz retry_351
buffer_load_dword v29,v21,s[20:23],s87 offen sc1
s_nop 6
v_add_f32 v72,v72,v76
v_add_f32 v73,v73,v77
v_add_f32 v74,v74,v78
v_add_f32 v75,v75,v79
v_and_or_b32 v72,v72,-4,s48
s_add_u32 s64,s77,s33
buffer_store_dwordx4 v[72:75],v25,s[20:23],s64 offen offset:1024 sc1
v_pk_add_f32 v[112:113],v[80:81],v[84:85]
v_pk_add_f32 v[112:113],v[112:113],v[108:109]
v_pk_add_f32 v[114:115],v[82:83],v[86:87]
v_pk_add_f32 v[114:115],v[114:115],v[110:111]
v_mov_b32 v116,v104
v_mov_b32 v117,v105
v_mov_b32 v118,v106
v_mov_b32 v119,v107
s_mov_b32 s40,s77
s_mov_b32 s60,s48
s_branch hjoin_373
r_w3_215:
s_load_dwordx2 s[4:5],s[0:1],80
s_mul_i32 s66,s59,224
s_lshl_b32 s67,s50,1
s_waitcnt lgkmcnt(0)
s_mov_b32 s32,s4
s_and_b32 s33,s5,0xffff
s_mov_b32 s34,0x700000
s_mov_b32 s35,0x20000
v_lshrrev_b32 v5,2,v3
v_lshl_add_u32 v5,v4,2,v5
v_and_b32 v6,3,v3
v_lshlrev_b32 v6,3,v6
v_lshl_add_u32 v6,v5,8,v6
v_and_b32 v5,7,v5
v_xor_b32 v5,s67,v5
v_lshl_add_u32 v12,v5,5,v6
v_xor_b32 v13,32,v12
v_and_b32 v5,15,v1
v_and_b32 v6,3,v4
v_lshlrev_b32 v6,1,v6
v_xor_b32 v5,v5,v6
v_mul_u32_u24 v6,7168,v4
v_xor_b32 v7,0,v5
v_lshl_add_u32 v8,v7,4,v6
v_xor_b32 v7,8,v5
v_lshl_add_u32 v9,v7,4,v6
s_mul_i32 s74,s50,458752
s_add_u32 s74,s74,s66
s_lshl_b32 s75,s50,14
s_mul_i32 s76,s50,229376
s_add_u32 s76,s76,s66
s_lshl_b32 s77,s50,13
s_add_u32 s64,s74,0
s_add_u32 m0,s75,0
s_nop 0
buffer_load_dwordx4 v8,s[32:35],s64 offen nt lds
s_add_u32 s64,s74,28672
s_add_u32 m0,s75,1024
s_nop 0
buffer_load_dwordx4 v9,s[32:35],s64 offen nt lds
s_add_u32 s64,s74,57344
s_add_u32 m0,s75,2048
s_nop 0
buffer_load_dwordx4 v8,s[32:35],s64 offen nt lds
s_add_u32 s64,s74,86016
s_add_u32 m0,s75,3072
s_nop 0
buffer_load_dwordx4 v9,s[32:35],s64 offen nt lds
s_add_u32 s64,s74,114688
s_add_u32 m0,s75,4096
s_nop 0
buffer_load_dwordx4 v8,s[32:35],s64 offen nt lds
s_add_u32 s64,s74,143360
s_add_u32 m0,s75,5120
s_nop 0
buffer_load_dwordx4 v9,s[32:35],s64 offen nt lds
s_add_u32 s64,s74,172032
s_add_u32 m0,s75,6144
s_nop 0
buffer_load_dwordx4 v8,s[32:35],s64 offen nt lds
s_add_u32 s64,s74,200704
s_add_u32 m0,s75,7168
s_nop 0
buffer_load_dwordx4 v9,s[32:35],s64 offen nt lds
s_add_u32 s64,s74,229376
s_add_u32 m0,s75,8192
s_nop 0
buffer_load_dwordx4 v8,s[32:35],s64 offen nt lds
s_add_u32 s64,s74,258048
s_add_u32 m0,s75,9216
s_nop 0
buffer_load_dwordx4 v9,s[32:35],s64 offen nt lds
s_add_u32 s64,s74,286720
s_add_u32 m0,s75,10240
s_nop 0
buffer_load_dwordx4 v8,s[32:35],s64 offen nt lds
s_add_u32 s64,s74,315392
s_add_u32 m0,s75,11264
s_nop 0
buffer_load_dwordx4 v9,s[32:35],s64 offen nt lds
s_add_u32 s64,s74,344064
s_add_u32 m0,s75,12288
s_nop 0
buffer_load_dwordx4 v8,s[32:35],s64 offen nt lds
s_add_u32 s64,s74,372736
s_add_u32 m0,s75,13312
s_nop 0
buffer_load_dwordx4 v9,s[32:35],s64 offen nt lds
s_add_u32 s64,s74,401408
s_add_u32 m0,s75,14336
s_nop 0
buffer_load_dwordx4 v8,s[32:35],s64 offen nt lds
s_add_u32 s64,s74,430080
s_add_u32 m0,s75,15360
s_nop 0
buffer_load_dwordx4 v9,s[32:35],s64 offen nt lds
s_add_u32 s64,s74,1835008
s_add_u32 m0,s75,65536
s_nop 0
buffer_load_dwordx4 v8,s[32:35],s64 offen nt lds
s_add_u32 s64,s74,1863680
s_add_u32 m0,s75,66560
s_nop 0
buffer_load_dwordx4 v9,s[32:35],s64 offen nt lds
s_add_u32 s64,s74,1892352
s_add_u32 m0,s75,67584
s_nop 0
buffer_load_dwordx4 v8,s[32:35],s64 offen nt lds
s_add_u32 s64,s74,1921024
s_add_u32 m0,s75,68608
s_nop 0
buffer_load_dwordx4 v9,s[32:35],s64 offen nt lds
s_add_u32 s64,s74,1949696
s_add_u32 m0,s75,69632
s_nop 0
buffer_load_dwordx4 v8,s[32:35],s64 offen nt lds
s_add_u32 s64,s74,1978368
s_add_u32 m0,s75,70656
s_nop 0
buffer_load_dwordx4 v9,s[32:35],s64 offen nt lds
s_add_u32 s64,s74,2007040
s_add_u32 m0,s75,71680
s_nop 0
buffer_load_dwordx4 v8,s[32:35],s64 offen nt lds
s_add_u32 s64,s74,2035712
s_add_u32 m0,s75,72704
s_nop 0
buffer_load_dwordx4 v9,s[32:35],s64 offen nt lds
s_add_u32 s64,s74,2064384
s_add_u32 m0,s75,73728
s_nop 0
buffer_load_dwordx4 v8,s[32:35],s64 offen nt lds
s_add_u32 s64,s74,2093056
s_add_u32 m0,s75,74752
s_nop 0
buffer_load_dwordx4 v9,s[32:35],s64 offen nt lds
s_add_u32 s64,s74,2121728
s_add_u32 m0,s75,75776
s_nop 0
buffer_load_dwordx4 v8,s[32:35],s64 offen nt lds
s_add_u32 s64,s74,2150400
s_add_u32 m0,s75,76800
s_nop 0
buffer_load_dwordx4 v9,s[32:35],s64 offen nt lds
s_add_u32 s64,s74,2179072
s_add_u32 m0,s75,77824
s_nop 0
buffer_load_dwordx4 v8,s[32:35],s64 offen nt lds
s_add_u32 s64,s74,2207744
s_add_u32 m0,s75,78848
s_nop 0
buffer_load_dwordx4 v9,s[32:35],s64 offen nt lds
s_add_u32 s64,s74,2236416
s_add_u32 m0,s75,79872
s_nop 0
buffer_load_dwordx4 v8,s[32:35],s64 offen nt lds
s_add_u32 s64,s74,2265088
s_add_u32 m0,s75,80896
s_nop 0
buffer_load_dwordx4 v9,s[32:35],s64 offen nt lds
s_waitcnt vmcnt(16)
s_barrier
ds_read_b64_tr_b16 a[0:1],v12 offset:0
ds_read_b64_tr_b16 a[128:129],v13 offset:0
ds_read_b64_tr_b16 a[2:3],v12 offset:4096
ds_read_b64_tr_b16 a[130:131],v13 offset:4096
ds_read_b64_tr_b16 a[4:5],v12 offset:8192
ds_read_b64_tr_b16 a[132:133],v13 offset:8192
ds_read_b64_tr_b16 a[6:7],v12 offset:12288
ds_read_b64_tr_b16 a[134:135],v13 offset:12288
s_waitcnt lgkmcnt(4)
ds_read_b64_tr_b16 a[8:9],v12 offset:16384
ds_read_b64_tr_b16 a[136:137],v13 offset:16384
ds_read_b64_tr_b16 a[10:11],v12 offset:20480
ds_read_b64_tr_b16 a[138:139],v13 offset:20480
ds_read_b64_tr_b16 a[12:13],v12 offset:24576
ds_read_b64_tr_b16 a[140:141],v13 offset:24576
ds_read_b64_tr_b16 a[14:15],v12 offset:28672
ds_read_b64_tr_b16 a[142:143],v13 offset:28672
s_waitcnt lgkmcnt(4)
ds_read_b64_tr_b16 a[16:17],v12 offset:32768
ds_read_b64_tr_b16 a[144:145],v13 offset:32768
ds_read_b64_tr_b16 a[18:19],v12 offset:36864
ds_read_b64_tr_b16 a[146:147],v13 offset:36864
ds_read_b64_tr_b16 a[20:21],v12 offset:40960
ds_read_b64_tr_b16 a[148:149],v13 offset:40960
ds_read_b64_tr_b16 a[22:23],v12 offset:45056
ds_read_b64_tr_b16 a[150:151],v13 offset:45056
s_waitcnt lgkmcnt(4)
ds_read_b64_tr_b16 a[24:25],v12 offset:49152
ds_read_b64_tr_b16 a[152:153],v13 offset:49152
ds_read_b64_tr_b16 a[26:27],v12 offset:53248
ds_read_b64_tr_b16 a[154:155],v13 offset:53248
ds_read_b64_tr_b16 a[28:29],v12 offset:57344
ds_read_b64_tr_b16 a[156:157],v13 offset:57344
ds_read_b64_tr_b16 a[30:31],v12 offset:61440
ds_read_b64_tr_b16 a[158:159],v13 offset:61440
s_waitcnt lgkmcnt(4)
v_xor_b32 v12,0x10000,v12
v_xor_b32 v13,0x10000,v13
s_waitcnt lgkmcnt(0)
s_barrier
s_add_u32 s64,s74,3670016
s_add_u32 m0,s75,0
s_nop 0
buffer_load_dwordx4 v8,s[32:35],s64 offen nt lds
s_add_u32 s64,s74,3698688
s_add_u32 m0,s75,1024
s_nop 0
buffer_load_dwordx4 v9,s[32:35],s64 offen nt lds
s_add_u32 s64,s74,3727360
s_add_u32 m0,s75,2048
s_nop 0
buffer_load_dwordx4 v8,s[32:35],s64 offen nt lds
s_add_u32 s64,s74,3756032
s_add_u32 m0,s75,3072
s_nop 0
buffer_load_dwordx4 v9,s[32:35],s64 offen nt lds
s_add_u32 s64,s74,3784704
s_add_u32 m0,s75,4096
s_nop 0
buffer_load_dwordx4 v8,s[32:35],s64 offen nt lds
s_add_u32 s64,s74,3813376
s_add_u32 m0,s75,5120
s_nop 0
buffer_load_dwordx4 v9,s[32:35],s64 offen nt lds
s_add_u32 s64,s74,3842048
s_add_u32 m0,s75,6144
s_nop 0
buffer_load_dwordx4 v8,s[32:35],s64 offen nt lds
s_add_u32 s64,s74,3870720
s_add_u32 m0,s75,7168
s_nop 0
buffer_load_dwordx4 v9,s[32:35],s64 offen nt lds
s_add_u32 s64,s74,3899392
s_add_u32 m0,s75,8192
s_nop 0
buffer_load_dwordx4 v8,s[32:35],s64 offen nt lds
s_add_u32 s64,s74,3928064
s_add_u32 m0,s75,9216
s_nop 0
buffer_load_dwordx4 v9,s[32:35],s64 offen nt lds
s_add_u32 s64,s74,3956736
s_add_u32 m0,s75,10240
s_nop 0
buffer_load_dwordx4 v8,s[32:35],s64 offen nt lds
s_add_u32 s64,s74,3985408
s_add_u32 m0,s75,11264
s_nop 0
buffer_load_dwordx4 v9,s[32:35],s64 offen nt lds
s_add_u32 s64,s74,4014080
s_add_u32 m0,s75,12288
s_nop 0
buffer_load_dwordx4 v8,s[32:35],s64 offen nt lds
s_add_u32 s64,s74,4042752
s_add_u32 m0,s75,13312
s_nop 0
buffer_load_dwordx4 v9,s[32:35],s64 offen nt lds
s_add_u32 s64,s74,4071424
s_add_u32 m0,s75,14336
s_nop 0
buffer_load_dwordx4 v8,s[32:35],s64 offen nt lds
s_add_u32 s64,s74,4100096
s_add_u32 m0,s75,15360
s_nop 0
buffer_load_dwordx4 v9,s[32:35],s64 offen nt lds
s_waitcnt vmcnt(16)
s_barrier
ds_read_b64_tr_b16 a[32:33],v12 offset:0
ds_read_b64_tr_b16 a[160:161],v13 offset:0
ds_read_b64_tr_b16 a[34:35],v12 offset:4096
ds_read_b64_tr_b16 a[162:163],v13 offset:4096
ds_read_b64_tr_b16 a[36:37],v12 offset:8192
ds_read_b64_tr_b16 a[164:165],v13 offset:8192
ds_read_b64_tr_b16 a[38:39],v12 offset:12288
ds_read_b64_tr_b16 a[166:167],v13 offset:12288
s_waitcnt lgkmcnt(4)
ds_read_b64_tr_b16 a[40:41],v12 offset:16384
ds_read_b64_tr_b16 a[168:169],v13 offset:16384
ds_read_b64_tr_b16 a[42:43],v12 offset:20480
ds_read_b64_tr_b16 a[170:171],v13 offset:20480
ds_read_b64_tr_b16 a[44:45],v12 offset:24576
ds_read_b64_tr_b16 a[172:173],v13 offset:24576
ds_read_b64_tr_b16 a[46:47],v12 offset:28672
ds_read_b64_tr_b16 a[174:175],v13 offset:28672
s_waitcnt lgkmcnt(4)
ds_read_b64_tr_b16 a[48:49],v12 offset:32768
ds_read_b64_tr_b16 a[176:177],v13 offset:32768
ds_read_b64_tr_b16 a[50:51],v12 offset:36864
ds_read_b64_tr_b16 a[178:179],v13 offset:36864
ds_read_b64_tr_b16 a[52:53],v12 offset:40960
ds_read_b64_tr_b16 a[180:181],v13 offset:40960
ds_read_b64_tr_b16 a[54:55],v12 offset:45056
ds_read_b64_tr_b16 a[182:183],v13 offset:45056
s_waitcnt lgkmcnt(4)
ds_read_b64_tr_b16 a[56:57],v12 offset:49152
ds_read_b64_tr_b16 a[184:185],v13 offset:49152
ds_read_b64_tr_b16 a[58:59],v12 offset:53248
ds_read_b64_tr_b16 a[186:187],v13 offset:53248
ds_read_b64_tr_b16 a[60:61],v12 offset:57344
ds_read_b64_tr_b16 a[188:189],v13 offset:57344
ds_read_b64_tr_b16 a[62:63],v12 offset:61440
ds_read_b64_tr_b16 a[190:191],v13 offset:61440
s_waitcnt lgkmcnt(4)
v_xor_b32 v12,0x10000,v12
v_xor_b32 v13,0x10000,v13
s_waitcnt lgkmcnt(0)
s_barrier
s_add_u32 s64,s74,5505024
s_add_u32 m0,s75,65536
s_nop 0
buffer_load_dwordx4 v8,s[32:35],s64 offen nt lds
s_add_u32 s64,s74,5533696
s_add_u32 m0,s75,66560
s_nop 0
buffer_load_dwordx4 v9,s[32:35],s64 offen nt lds
s_add_u32 s64,s74,5562368
s_add_u32 m0,s75,67584
s_nop 0
buffer_load_dwordx4 v8,s[32:35],s64 offen nt lds
s_add_u32 s64,s74,5591040
s_add_u32 m0,s75,68608
s_nop 0
buffer_load_dwordx4 v9,s[32:35],s64 offen nt lds
s_add_u32 s64,s74,5619712
s_add_u32 m0,s75,69632
s_nop 0
buffer_load_dwordx4 v8,s[32:35],s64 offen nt lds
s_add_u32 s64,s74,5648384
s_add_u32 m0,s75,70656
s_nop 0
buffer_load_dwordx4 v9,s[32:35],s64 offen nt lds
s_add_u32 s64,s74,5677056
s_add_u32 m0,s75,71680
s_nop 0
buffer_load_dwordx4 v8,s[32:35],s64 offen nt lds
s_add_u32 s64,s74,5705728
s_add_u32 m0,s75,72704
s_nop 0
buffer_load_dwordx4 v9,s[32:35],s64 offen nt lds
s_add_u32 s64,s74,5734400
s_add_u32 m0,s75,73728
s_nop 0
buffer_load_dwordx4 v8,s[32:35],s64 offen nt lds
s_add_u32 s64,s74,5763072
s_add_u32 m0,s75,74752
s_nop 0
buffer_load_dwordx4 v9,s[32:35],s64 offen nt lds
s_add_u32 s64,s74,5791744
s_add_u32 m0,s75,75776
s_nop 0
buffer_load_dwordx4 v8,s[32:35],s64 offen nt lds
s_add_u32 s64,s74,5820416
s_add_u32 m0,s75,76800
s_nop 0
buffer_load_dwordx4 v9,s[32:35],s64 offen nt lds
s_add_u32 s64,s74,5849088
s_add_u32 m0,s75,77824
s_nop 0
buffer_load_dwordx4 v8,s[32:35],s64 offen nt lds
s_add_u32 s64,s74,5877760
s_add_u32 m0,s75,78848
s_nop 0
buffer_load_dwordx4 v9,s[32:35],s64 offen nt lds
s_add_u32 s64,s74,5906432
s_add_u32 m0,s75,79872
s_nop 0
buffer_load_dwordx4 v8,s[32:35],s64 offen nt lds
s_add_u32 s64,s74,5935104
s_add_u32 m0,s75,80896
s_nop 0
buffer_load_dwordx4 v9,s[32:35],s64 offen nt lds
s_waitcnt vmcnt(16)
s_barrier
ds_read_b64_tr_b16 a[64:65],v12 offset:0
ds_read_b64_tr_b16 a[192:193],v13 offset:0
ds_read_b64_tr_b16 a[66:67],v12 offset:4096
ds_read_b64_tr_b16 a[194:195],v13 offset:4096
ds_read_b64_tr_b16 a[68:69],v12 offset:8192
ds_read_b64_tr_b16 a[196:197],v13 offset:8192
ds_read_b64_tr_b16 a[70:71],v12 offset:12288
ds_read_b64_tr_b16 a[198:199],v13 offset:12288
s_waitcnt lgkmcnt(4)
ds_read_b64_tr_b16 a[72:73],v12 offset:16384
ds_read_b64_tr_b16 a[200:201],v13 offset:16384
ds_read_b64_tr_b16 a[74:75],v12 offset:20480
ds_read_b64_tr_b16 a[202:203],v13 offset:20480
ds_read_b64_tr_b16 a[76:77],v12 offset:24576
ds_read_b64_tr_b16 a[204:205],v13 offset:24576
ds_read_b64_tr_b16 a[78:79],v12 offset:28672
ds_read_b64_tr_b16 a[206:207],v13 offset:28672
s_waitcnt lgkmcnt(4)
ds_read_b64_tr_b16 a[80:81],v12 offset:32768
ds_read_b64_tr_b16 a[208:209],v13 offset:32768
ds_read_b64_tr_b16 a[82:83],v12 offset:36864
ds_read_b64_tr_b16 a[210:211],v13 offset:36864
ds_read_b64_tr_b16 a[84:85],v12 offset:40960
ds_read_b64_tr_b16 a[212:213],v13 offset:40960
ds_read_b64_tr_b16 a[86:87],v12 offset:45056
ds_read_b64_tr_b16 a[214:215],v13 offset:45056
s_waitcnt lgkmcnt(4)
ds_read_b64_tr_b16 a[88:89],v12 offset:49152
ds_read_b64_tr_b16 a[216:217],v13 offset:49152
ds_read_b64_tr_b16 a[90:91],v12 offset:53248
ds_read_b64_tr_b16 a[218:219],v13 offset:53248
ds_read_b64_tr_b16 a[92:93],v12 offset:57344
ds_read_b64_tr_b16 a[220:221],v13 offset:57344
ds_read_b64_tr_b16 a[94:95],v12 offset:61440
ds_read_b64_tr_b16 a[222:223],v13 offset:61440
s_waitcnt lgkmcnt(4)
v_xor_b32 v12,0x10000,v12
v_xor_b32 v13,0x10000,v13
s_waitcnt lgkmcnt(0)
s_barrier
s_waitcnt vmcnt(0)
s_barrier
ds_read_b64_tr_b16 a[96:97],v12 offset:0
ds_read_b64_tr_b16 a[224:225],v13 offset:0
ds_read_b64_tr_b16 a[98:99],v12 offset:4096
ds_read_b64_tr_b16 a[226:227],v13 offset:4096
ds_read_b64_tr_b16 a[100:101],v12 offset:8192
ds_read_b64_tr_b16 a[228:229],v13 offset:8192
ds_read_b64_tr_b16 a[102:103],v12 offset:12288
ds_read_b64_tr_b16 a[230:231],v13 offset:12288
s_waitcnt lgkmcnt(4)
ds_read_b64_tr_b16 a[104:105],v12 offset:16384
ds_read_b64_tr_b16 a[232:233],v13 offset:16384
ds_read_b64_tr_b16 a[106:107],v12 offset:20480
ds_read_b64_tr_b16 a[234:235],v13 offset:20480
ds_read_b64_tr_b16 a[108:109],v12 offset:24576
ds_read_b64_tr_b16 a[236:237],v13 offset:24576
ds_read_b64_tr_b16 a[110:111],v12 offset:28672
ds_read_b64_tr_b16 a[238:239],v13 offset:28672
s_waitcnt lgkmcnt(4)
ds_read_b64_tr_b16 a[112:113],v12 offset:32768
ds_read_b64_tr_b16 a[240:241],v13 offset:32768
ds_read_b64_tr_b16 a[114:115],v12 offset:36864
ds_read_b64_tr_b16 a[242:243],v13 offset:36864
ds_read_b64_tr_b16 a[116:117],v12 offset:40960
ds_read_b64_tr_b16 a[244:245],v13 offset:40960
ds_read_b64_tr_b16 a[118:119],v12 offset:45056
ds_read_b64_tr_b16 a[246:247],v13 offset:45056
s_waitcnt lgkmcnt(4)
ds_read_b64_tr_b16 a[120:121],v12 offset:49152
ds_read_b64_tr_b16 a[248:249],v13 offset:49152
ds_read_b64_tr_b16 a[122:123],v12 offset:53248
ds_read_b64_tr_b16 a[250:251],v13 offset:53248
ds_read_b64_tr_b16 a[124:125],v12 offset:57344
ds_read_b64_tr_b16 a[252:253],v13 offset:57344
ds_read_b64_tr_b16 a[126:127],v12 offset:61440
ds_read_b64_tr_b16 a[254:255],v13 offset:61440
s_waitcnt lgkmcnt(4)
v_xor_b32 v12,0x10000,v12
v_xor_b32 v13,0x10000,v13
s_waitcnt lgkmcnt(0)
s_barrier
v_mov_b32 v88,0x3f803f80
v_mov_b32 v89,0x3f803f80
v_mov_b32 v90,0x3f803f80
v_mov_b32 v91,0x3f803f80
s_nop 1
v_mfma_f32_16x16x32_bf16 v[52:55],a[0:3],v[88:91],0
v_mfma_f32_16x16x32_bf16 v[56:59],a[128:131],v[88:91],0
v_mfma_f32_16x16x32_bf16 v[52:55],a[4:7],v[88:91],v[52:55]
v_mfma_f32_16x16x32_bf16 v[56:59],a[132:135],v[88:91],v[56:59]
v_mfma_f32_16x16x32_bf16 v[52:55],a[8:11],v[88:91],v[52:55]
v_mfma_f32_16x16x32_bf16 v[56:59],a[136:139],v[88:91],v[56:59]
v_mfma_f32_16x16x32_bf16 v[52:55],a[12:15],v[88:91],v[52:55]
v_mfma_f32_16x16x32_bf16 v[56:59],a[140:143],v[88:91],v[56:59]
v_mfma_f32_16x16x32_bf16 v[52:55],a[16:19],v[88:91],v[52:55]
v_mfma_f32_16x16x32_bf16 v[56:59],a[144:147],v[88:91],v[56:59]
v_mfma_f32_16x16x32_bf16 v[52:55],a[20:23],v[88:91],v[52:55]
v_mfma_f32_16x16x32_bf16 v[56:59],a[148:151],v[88:91],v[56:59]
v_mfma_f32_16x16x32_bf16 v[52:55],a[24:27],v[88:91],v[52:55]
v_mfma_f32_16x16x32_bf16 v[56:59],a[152:155],v[88:91],v[56:59]
v_mfma_f32_16x16x32_bf16 v[52:55],a[28:31],v[88:91],v[52:55]
v_mfma_f32_16x16x32_bf16 v[56:59],a[156:159],v[88:91],v[56:59]
v_mfma_f32_16x16x32_bf16 v[52:55],a[32:35],v[88:91],v[52:55]
v_mfma_f32_16x16x32_bf16 v[56:59],a[160:163],v[88:91],v[56:59]
v_mfma_f32_16x16x32_bf16 v[52:55],a[36:39],v[88:91],v[52:55]
v_mfma_f32_16x16x32_bf16 v[56:59],a[164:167],v[88:91],v[56:59]
v_mfma_f32_16x16x32_bf16 v[52:55],a[40:43],v[88:91],v[52:55]
v_mfma_f32_16x16x32_bf16 v[56:59],a[168:171],v[88:91],v[56:59]
v_mfma_f32_16x16x32_bf16 v[52:55],a[44:47],v[88:91],v[52:55]
v_mfma_f32_16x16x32_bf16 v[56:59],a[172:175],v[88:91],v[56:59]
v_mfma_f32_16x16x32_bf16 v[52:55],a[48:51],v[88:91],v[52:55]
v_mfma_f32_16x16x32_bf16 v[56:59],a[176:179],v[88:91],v[56:59]
v_mfma_f32_16x16x32_bf16 v[52:55],a[52:55],v[88:91],v[52:55]
v_mfma_f32_16x16x32_bf16 v[56:59],a[180:183],v[88:91],v[56:59]
v_mfma_f32_16x16x32_bf16 v[52:55],a[56:59],v[88:91],v[52:55]
v_mfma_f32_16x16x32_bf16 v[56:59],a[184:187],v[88:91],v[56:59]
v_mfma_f32_16x16x32_bf16 v[52:55],a[60:63],v[88:91],v[52:55]
v_mfma_f32_16x16x32_bf16 v[56:59],a[188:191],v[88:91],v[56:59]
v_mfma_f32_16x16x32_bf16 v[52:55],a[64:67],v[88:91],v[52:55]
v_mfma_f32_16x16x32_bf16 v[56:59],a[192:195],v[88:91],v[56:59]
v_mfma_f32_16x16x32_bf16 v[52:55],a[68:71],v[88:91],v[52:55]
v_mfma_f32_16x16x32_bf16 v[56:59],a[196:199],v[88:91],v[56:59]
v_mfma_f32_16x16x32_bf16 v[52:55],a[72:75],v[88:91],v[52:55]
v_mfma_f32_16x16x32_bf16 v[56:59],a[200:203],v[88:91],v[56:59]
v_mfma_f32_16x16x32_bf16 v[52:55],a[76:79],v[88:91],v[52:55]
v_mfma_f32_16x16x32_bf16 v[56:59],a[204:207],v[88:91],v[56:59]
v_mfma_f32_16x16x32_bf16 v[52:55],a[80:83],v[88:91],v[52:55]
v_mfma_f32_16x16x32_bf16 v[56:59],a[208:211],v[88:91],v[56:59]
v_mfma_f32_16x16x32_bf16 v[52:55],a[84:87],v[88:91],v[52:55]
v_mfma_f32_16x16x32_bf16 v[56:59],a[212:215],v[88:91],v[56:59]
v_mfma_f32_16x16x32_bf16 v[52:55],a[88:91],v[88:91],v[52:55]
v_mfma_f32_16x16x32_bf16 v[56:59],a[216:219],v[88:91],v[56:59]
v_mfma_f32_16x16x32_bf16 v[52:55],a[92:95],v[88:91],v[52:55]
v_mfma_f32_16x16x32_bf16 v[56:59],a[220:223],v[88:91],v[56:59]
v_mfma_f32_16x16x32_bf16 v[52:55],a[96:99],v[88:91],v[52:55]
v_mfma_f32_16x16x32_bf16 v[56:59],a[224:227],v[88:91],v[56:59]
v_mfma_f32_16x16x32_bf16 v[52:55],a[100:103],v[88:91],v[52:55]
v_mfma_f32_16x16x32_bf16 v[56:59],a[228:231],v[88:91],v[56:59]
v_mfma_f32_16x16x32_bf16 v[52:55],a[104:107],v[88:91],v[52:55]
v_mfma_f32_16x16x32_bf16 v[56:59],a[232:235],v[88:91],v[56:59]
v_mfma_f32_16x16x32_bf16 v[52:55],a[108:111],v[88:91],v[52:55]
v_mfma_f32_16x16x32_bf16 v[56:59],a[236:239],v[88:91],v[56:59]
v_mfma_f32_16x16x32_bf16 v[52:55],a[112:115],v[88:91],v[52:55]
v_mfma_f32_16x16x32_bf16 v[56:59],a[240:243],v[88:91],v[56:59]
v_mfma_f32_16x16x32_bf16 v[52:55],a[116:119],v[88:91],v[52:55]
v_mfma_f32_16x16x32_bf16 v[56:59],a[244:247],v[88:91],v[56:59]
v_mfma_f32_16x16x32_bf16 v[52:55],a[120:123],v[88:91],v[52:55]
v_mfma_f32_16x16x32_bf16 v[56:59],a[248:251],v[88:91],v[56:59]
v_mfma_f32_16x16x32_bf16 v[52:55],a[124:127],v[88:91],v[52:55]
v_mfma_f32_16x16x32_bf16 v[56:59],a[252:255],v[88:91],v[56:59]
v_and_b32 v21,1,v1
v_mul_u32_u24 v21,960,v21
s_mov_b32 s65,21052032
s_mov_b32 s66,1792
pl_374:
buffer_load_dword v22,v21,s[20:23],s65 offen sc1
s_waitcnt vmcnt(0)
v_cmp_gt_u32 vcc,s66,v22
s_cbranch_vccz pok_375
s_sleep 1
s_sub_u32 s90,s90,1
s_cmp_gt_i32 s90,0
s_cbranch_scc1 pl_374
pok_375:
s_mov_b32 s81,0xbdd2d3e8
v_mov_b32 v28,0xc0135761
s_lshr_b32 s41,s59,3
s_and_b32 s42,s59,7
s_mul_i32 s64,s42,3
s_add_u32 s64,s64,s50
s_lshr_b32 s65,s42,1
s_add_u32 s65,s65,24
s_cmp_eq_u32 s50,3
s_cselect_b32 s64,s65,s64
s_and_b32 s65,s42,1
s_lshl_b32 s65,s65,3
s_cmp_eq_u32 s50,3
s_cselect_b32 s65,s65,0
s_and_b32 s66,s64,3
s_lshl_b32 s66,s66,11
s_add_u32 s65,s65,s66
s_lshr_b32 s64,s64,2
s_mul_i32 s66,s41,7
s_add_u32 s64,s64,s66
s_add_u32 s64,s64,81
s_lshl_b32 s64,s64,14
s_add_u32 s64,s64,s65
v_add_u32 v18,s64,v16
v_mov_b32 v17,v16
v_lshlrev_b32 v19,4,v3
v_add_u32 v19,131072,v19
v_and_b32 v21,7,v1
v_lshlrev_b32 v21,7,v21
v_bfe_u32 v6,v1,3,2
v_lshl_add_u32 v21,v6,2,v21
s_add_u32 s74,s63,6144
s_add_u32 s74,s74,s60
s_lshl_b32 s73,s59,7
s_lshl_b32 s64,s50,2
s_add_u32 s73,s73,s64
s_add_u32 s73,s73,s63
s_add_u32 s73,s73,20480
s_lshl_b32 s64,s60,4
s_add_u32 s73,s73,s64
s_mov_b32 s82,0x3a800000
s_mov_b32 s64,0
s_lshr_b32 s65,s50,1
s_and_b32 s66,s50,1
s_lshl_b32 s66,s66,12
s_add_u32 s66,s66,s64
s_lshl_b32 s72,s65,13
s_add_u32 s72,s72,s66
s_add_u32 s72,s72,0x10000
s_lshl_b32 s65,s65,14
s_add_u32 s75,s65,s66
s_add_u32 s75,s75,1179648
s_cmp_eq_u32 s50,3
s_cbranch_scc1 w3b_376
s_add_u32 s64,s79,0
s_lshl_b32 s70,s64,21
s_lshl_b32 s64,s64,13
s_and_b32 s64,s64,0x2000
s_xor_b32 s64,s64,s62
s_add_u32 s70,s70,s64
s_add_u32 s70,s70,29360128
s_mov_b32 s83,1
s_mov_b32 s87,s74
s_cmp_eq_u32 s50,0
s_cselect_b32 s74,s74,0x7fff0000
v_mov_b32 v47,132096
s_lshl_b32 s64,s50,3
s_add_u32 s64,s64,132096
v_mov_b32 v46,s64
v_mov_b32 v29,0
s_mov_b32 s97,0x7fff0000
s_mov_b32 s69,1
s_mov_b32 s68,0
s_mov_b32 s52,0x30003
s_mov_b32 s53,s52
seg_378:
s_cmp_eq_u32 s83,0
s_cbranch_scc1 ahead_379
s_add_u32 s94,s70,s75
s_xor_b32 s95,s94,1024
s_xor_b32 s91,s72,0x10000
s_cmp_eq_u32 s69,0
s_mov_b32 s69,1
s_cbranch_scc1 half2_383
s_waitcnt vmcnt(2)
v_cmp_gt_u32 vcc,s71,v29
s_cbranch_vccz nb_382
s_waitcnt vmcnt(0)
v_add_u32 v22,s71,-1
buffer_store_dword v22,v23,s[20:23],s97 offen sc1
s_mov_b32 s97,0x7fff0000
s_cmp_lg_u32 s50,0
s_cbranch_scc1 nb_382
buffer_load_dword v32,v21,s[20:23],s74 offen sc1
s_sleep 2
pl_384:
buffer_load_dword v33,v21,s[20:23],s74 offen sc1
s_waitcnt vmcnt(1)
v_cmp_gt_u32 vcc,s71,v32
v_mov_b32 v29,v32
s_cbranch_vccz pok_385
buffer_load_dword v32,v21,s[20:23],s74 offen sc1
s_waitcnt vmcnt(1)
v_cmp_gt_u32 vcc,s71,v33
v_mov_b32 v29,v33
s_cbranch_vccz pok_385
s_sub_u32 s90,s90,1
s_cmp_gt_i32 s90,0
s_cbranch_scc1 pl_384
pok_385:
nb_382:
s_cmp_eq_u32 s71,64
s_barrier
s_cbranch_scc1 half_386
s_xor_b32 m0,s91,0
s_add_u32 s65,s94,0
buffer_load_dwordx4 v16,s[20:23],s65 offen offset:0 sc1 lds
buffer_load_dwordx4 v16,s[20:23],s65 offen offset:2048 sc1 lds
s_xor_b32 m0,s91,16384
s_add_u32 s65,s94,32768
buffer_load_dwordx4 v16,s[20:23],s65 offen offset:0 sc1 lds
buffer_load_dwordx4 v16,s[20:23],s65 offen offset:2048 sc1 lds
s_xor_b32 m0,s91,32768
s_add_u32 s65,s94,65536
buffer_load_dwordx4 v16,s[20:23],s65 offen offset:0 sc1 lds
buffer_load_dwordx4 v16,s[20:23],s65 offen offset:2048 sc1 lds
s_xor_b32 m0,s91,49152
s_add_u32 s65,s94,98304
buffer_load_dwordx4 v16,s[20:23],s65 offen offset:0 sc1 lds
buffer_load_dwordx4 v16,s[20:23],s65 offen offset:2048 sc1 lds
s_waitcnt vmcnt(8)
v_add_u32 v22,s71,-1
buffer_store_dword v22,v23,s[20:23],s97 offen sc1
s_mov_b32 s97,0x7fff0000
s_waitcnt vmcnt(7)
s_barrier
ds_read_b128 v[224:227],v17 offset:0
ds_read_b128 v[228:231],v17 offset:2048
ds_read_b128 v[232:235],v17 offset:4096
ds_read_b128 v[236:239],v17 offset:6144
ds_read_b128 v[240:243],v17 offset:8192
ds_read_b128 v[244:247],v17 offset:10240
ds_read_b128 v[248:251],v17 offset:12288
s_waitcnt lgkmcnt(5)
v_mfma_f32_16x16x32_bf16 v[64:67],a[0:3],v[224:227],0
s_xor_b32 m0,s91,1024
s_add_u32 s96,s71,1
s_add_u32 s92,s71,2
v_min_u32 v27,v224,v228
v_mfma_f32_16x16x32_bf16 v[72:75],a[128:131],v[224:227],0
ds_read_b128 v[252:255],v17 offset:14336
s_cmp_eq_u32 s96,64
s_cselect_b32 s96,99,s96
v_mfma_f32_16x16x32_bf16 v[64:67],a[4:7],v[228:231],v[64:67]
s_add_u32 s65,s95,0
s_cmp_eq_u32 s92,64
s_cselect_b32 s92,99,s92
v_mfma_f32_16x16x32_bf16 v[72:75],a[132:135],v[228:231],v[72:75]
s_waitcnt vmcnt(5)
s_barrier
ds_read_b128 v[224:227],v17 offset:16384
s_waitcnt lgkmcnt(5)
v_mfma_f32_16x16x32_bf16 v[64:67],a[8:11],v[232:235],v[64:67]
buffer_load_dwordx4 v16,s[20:23],s65 offen offset:0 sc1 lds
v_mfma_f32_16x16x32_bf16 v[72:75],a[136:139],v[232:235],v[72:75]
ds_read_b128 v[228:231],v17 offset:18432
v_min3_u32 v27,v27,v232,v236
v_mfma_f32_16x16x32_bf16 v[64:67],a[12:15],v[236:239],v[64:67]
buffer_load_dwordx4 v16,s[20:23],s65 offen offset:2048 sc1 lds
v_mfma_f32_16x16x32_bf16 v[72:75],a[140:143],v[236:239],v[72:75]
ds_read_b128 v[232:235],v17 offset:20480
s_waitcnt lgkmcnt(5)
v_mfma_f32_16x16x32_bf16 v[64:67],a[16:19],v[240:243],v[64:67]
s_xor_b32 m0,s91,17408
v_min3_u32 v27,v27,v240,v244
v_mfma_f32_16x16x32_bf16 v[72:75],a[144:147],v[240:243],v[72:75]
ds_read_b128 v[236:239],v17 offset:22528
v_mfma_f32_16x16x32_bf16 v[64:67],a[20:23],v[244:247],v[64:67]
s_add_u32 s65,s95,32768
v_mfma_f32_16x16x32_bf16 v[72:75],a[148:151],v[244:247],v[72:75]
ds_read_b128 v[240:243],v17 offset:24576
s_waitcnt lgkmcnt(5)
v_mfma_f32_16x16x32_bf16 v[64:67],a[24:27],v[248:251],v[64:67]
buffer_load_dwordx4 v16,s[20:23],s65 offen offset:0 sc1 lds
v_mfma_f32_16x16x32_bf16 v[72:75],a[152:155],v[248:251],v[72:75]
ds_read_b128 v[244:247],v17 offset:26624
v_min3_u32 v27,v27,v248,v252
v_mfma_f32_16x16x32_bf16 v[64:67],a[28:31],v[252:255],v[64:67]
buffer_load_dwordx4 v16,s[20:23],s65 offen offset:2048 sc1 lds
v_mfma_f32_16x16x32_bf16 v[72:75],a[156:159],v[252:255],v[72:75]
ds_read_b128 v[248:251],v17 offset:28672
s_waitcnt lgkmcnt(5)
v_mfma_f32_16x16x32_bf16 v[64:67],a[32:35],v[224:227],v[64:67]
s_xor_b32 m0,s91,33792
v_min3_u32 v27,v27,v224,v228
v_mfma_f32_16x16x32_bf16 v[72:75],a[160:163],v[224:227],v[72:75]
ds_read_b128 v[252:255],v17 offset:30720
v_mfma_f32_16x16x32_bf16 v[64:67],a[36:39],v[228:231],v[64:67]
s_add_u32 s65,s95,65536
v_mfma_f32_16x16x32_bf16 v[72:75],a[164:167],v[228:231],v[72:75]
s_waitcnt vmcnt(5)
s_barrier
ds_read_b128 v[224:227],v17 offset:32768
s_waitcnt lgkmcnt(5)
v_mfma_f32_16x16x32_bf16 v[64:67],a[40:43],v[232:235],v[64:67]
buffer_load_dwordx4 v16,s[20:23],s65 offen offset:0 sc1 lds
v_mfma_f32_16x16x32_bf16 v[72:75],a[168:171],v[232:235],v[72:75]
ds_read_b128 v[228:231],v17 offset:34816
v_min3_u32 v27,v27,v232,v236
v_mfma_f32_16x16x32_bf16 v[64:67],a[44:47],v[236:239],v[64:67]
buffer_load_dwordx4 v16,s[20:23],s65 offen offset:2048 sc1 lds
v_mfma_f32_16x16x32_bf16 v[72:75],a[172:175],v[236:239],v[72:75]
ds_read_b128 v[232:235],v17 offset:36864
s_waitcnt lgkmcnt(5)
v_mfma_f32_16x16x32_bf16 v[64:67],a[48:51],v[240:243],v[64:67]
s_xor_b32 m0,s91,50176
v_min3_u32 v27,v27,v240,v244
v_mfma_f32_16x16x32_bf16 v[72:75],a[176:179],v[240:243],v[72:75]
ds_read_b128 v[236:239],v17 offset:38912
v_mfma_f32_16x16x32_bf16 v[64:67],a[52:55],v[244:247],v[64:67]
s_add_u32 s65,s95,98304
v_mfma_f32_16x16x32_bf16 v[72:75],a[180:183],v[244:247],v[72:75]
ds_read_b128 v[240:243],v17 offset:40960
s_waitcnt lgkmcnt(5)
v_mfma_f32_16x16x32_bf16 v[64:67],a[56:59],v[248:251],v[64:67]
buffer_load_dwordx4 v16,s[20:23],s65 offen offset:0 sc1 lds
v_min3_u32 v27,v27,v248,v252
v_mfma_f32_16x16x32_bf16 v[72:75],a[184:187],v[248:251],v[72:75]
ds_read_b128 v[244:247],v17 offset:43008
s_waitcnt vmcnt(63)
v_mfma_f32_16x16x32_bf16 v[64:67],a[60:63],v[252:255],v[64:67]
buffer_load_dwordx4 v16,s[20:23],s65 offen offset:2048 sc1 lds
v_mfma_f32_16x16x32_bf16 v[72:75],a[188:191],v[252:255],v[72:75]
ds_read_b128 v[248:251],v17 offset:45056
s_waitcnt lgkmcnt(5)
v_mfma_f32_16x16x32_bf16 v[64:67],a[64:67],v[224:227],v[64:67]
v_cmp_gt_u32 vcc,s96,v29
v_cmp_gt_u32 s[92:93],s92,v29
v_mfma_f32_16x16x32_bf16 v[72:75],a[192:195],v[224:227],v[72:75]
ds_read_b128 v[252:255],v17 offset:47104
v_min3_u32 v27,v27,v224,v228
v_mfma_f32_16x16x32_bf16 v[64:67],a[68:71],v[228:231],v[64:67]
v_mov_b32 v44,vcc_lo
v_mov_b32 v45,s92
v_mfma_f32_16x16x32_bf16 v[72:75],a[196:199],v[228:231],v[72:75]
ds_read_b128 v[224:227],v17 offset:49152
s_waitcnt lgkmcnt(5)
v_mfma_f32_16x16x32_bf16 v[64:67],a[72:75],v[232:235],v[64:67]
ds_write_b64 v46,v[44:45]
v_min3_u32 v27,v27,v232,v236
v_mfma_f32_16x16x32_bf16 v[72:75],a[200:203],v[232:235],v[72:75]
ds_read_b128 v[228:231],v17 offset:51200
v_mfma_f32_16x16x32_bf16 v[64:67],a[76:79],v[236:239],v[64:67]
v_mfma_f32_16x16x32_bf16 v[72:75],a[204:207],v[236:239],v[72:75]
ds_read_b128 v[232:235],v17 offset:53248
s_waitcnt lgkmcnt(6)
v_mfma_f32_16x16x32_bf16 v[64:67],a[80:83],v[240:243],v[64:67]
v_min3_u32 v27,v27,v240,v244
s_add_u32 s88,s70,s75
v_mfma_f32_16x16x32_bf16 v[72:75],a[208:211],v[240:243],v[72:75]
ds_read_b128 v[236:239],v17 offset:55296
s_add_u32 s88,s88,2097152
v_mfma_f32_16x16x32_bf16 v[64:67],a[84:87],v[244:247],v[64:67]
s_xor_b32 s88,s88,0x2000
s_xor_b32 s89,s88,1024
v_mfma_f32_16x16x32_bf16 v[72:75],a[212:215],v[244:247],v[72:75]
ds_read_b128 v[240:243],v17 offset:57344
s_waitcnt lgkmcnt(6)
v_mfma_f32_16x16x32_bf16 v[64:67],a[88:91],v[248:251],v[64:67]
v_min3_u32 v27,v27,v248,v252
v_mfma_f32_16x16x32_bf16 v[72:75],a[216:219],v[248:251],v[72:75]
ds_read_b128 v[244:247],v17 offset:59392
v_mfma_f32_16x16x32_bf16 v[64:67],a[92:95],v[252:255],v[64:67]
v_mfma_f32_16x16x32_bf16 v[72:75],a[220:223],v[252:255],v[72:75]
ds_read_b128 v[248:251],v17 offset:61440
s_waitcnt lgkmcnt(5)
v_mfma_f32_16x16x32_bf16 v[64:67],a[96:99],v[224:227],v[64:67]
v_min3_u32 v27,v27,v224,v228
v_mfma_f32_16x16x32_bf16 v[72:75],a[224:227],v[224:227],v[72:75]
ds_read_b128 v[252:255],v17 offset:63488
v_mfma_f32_16x16x32_bf16 v[64:67],a[100:103],v[228:231],v[64:67]
v_mfma_f32_16x16x32_bf16 v[72:75],a[228:231],v[228:231],v[72:75]
s_waitcnt vmcnt(4)
s_barrier
ds_read_b64 v[44:45],v47
ds_read_b128 v[224:227],v17 offset:1024
s_waitcnt lgkmcnt(6)
v_mfma_f32_16x16x32_bf16 v[64:67],a[104:107],v[232:235],v[64:67]
v_min3_u32 v27,v27,v232,v236
ds_read_b128 v[124:127],v19 offset:256
v_mfma_f32_16x16x32_bf16 v[72:75],a[232:235],v[232:235],v[72:75]
ds_read_b128 v[228:231],v17 offset:3072
ds_read_b128 v[120:123],v19 offset:0
v_mfma_f32_16x16x32_bf16 v[64:67],a[108:111],v[236:239],v[64:67]
v_mfma_f32_16x16x32_bf16 v[72:75],a[236:239],v[236:239],v[72:75]
ds_read_b128 v[232:235],v17 offset:5120
s_waitcnt lgkmcnt(8)
v_mfma_f32_16x16x32_bf16 v[64:67],a[112:115],v[240:243],v[64:67]
v_min3_u32 v27,v27,v240,v244
v_mfma_f32_16x16x32_bf16 v[72:75],a[240:243],v[240:243],v[72:75]
ds_read_b128 v[236:239],v17 offset:7168
v_mfma_f32_16x16x32_bf16 v[64:67],a[116:119],v[244:247],v[64:67]
v_mfma_f32_16x16x32_bf16 v[72:75],a[244:247],v[244:247],v[72:75]
ds_read_b128 v[240:243],v17 offset:9216
s_waitcnt lgkmcnt(8)
v_mfma_f32_16x16x32_bf16 v[64:67],a[120:123],v[248:251],v[64:67]
s_waitcnt lgkmcnt(7)
v_readfirstlane_b32 s93,v45
v_mfma_f32_16x16x32_bf16 v[72:75],a[248:251],v[248:251],v[72:75]
ds_read_b128 v[244:247],v17 offset:11264
v_readfirstlane_b32 s83,v44
s_cmp_lg_u32 s83,0
s_cbranch_scc0 keep_388
v_mfma_f32_16x16x32_bf16 v[64:67],a[124:127],v[252:255],v[64:67]
v_min3_u32 v27,v27,v248,v252
v_mfma_f32_16x16x32_bf16 v[72:75],a[252:255],v[252:255],v[72:75]
ds_read_b128 v[248:251],v17 offset:13312
s_waitcnt lgkmcnt(6)
v_mfma_f32_16x16x32_bf16 v[68:71],a[0:3],v[224:227],0
v_cmp_eq_u32 vcc,0,v27
s_cbranch_vccnz retry_377
v_mfma_f32_16x16x32_bf16 v[76:79],a[128:131],v[224:227],0
ds_read_b128 v[252:255],v17 offset:15360
v_min3_u32 v27,v27,v224,v228
v_mfma_f32_16x16x32_bf16 v[68:71],a[4:7],v[228:231],v[68:71]
s_waitcnt lgkmcnt(6)
v_mfma_f32_16x16x32_bf16 v[76:79],a[132:135],v[228:231],v[76:79]
ds_read_b128 v[224:227],v17 offset:17408
s_waitcnt lgkmcnt(5)
v_mfma_f32_16x16x32_bf16 v[68:71],a[8:11],v[232:235],v[68:71]
v_min3_u32 v27,v27,v232,v236
v_fmac_f32 v64,v52,v120
v_fmac_f32 v72,v56,v120
v_mfma_f32_16x16x32_bf16 v[76:79],a[136:139],v[232:235],v[76:79]
ds_read_b128 v[228:231],v17 offset:19456
v_fmac_f32 v65,v53,v120
v_fmac_f32 v73,v57,v120
v_mfma_f32_16x16x32_bf16 v[68:71],a[12:15],v[236:239],v[68:71]
v_fmac_f32 v66,v54,v120
v_fmac_f32 v67,v55,v120
v_fmac_f32 v74,v58,v120
v_mfma_f32_16x16x32_bf16 v[76:79],a[140:143],v[236:239],v[76:79]
ds_read_b128 v[232:235],v17 offset:21504
v_fmac_f32 v75,v59,v120
s_waitcnt lgkmcnt(5)
v_mfma_f32_16x16x32_bf16 v[68:71],a[16:19],v[240:243],v[68:71]
v_min3_u32 v27,v27,v240,v244
v_mul_f32 v88,v64,v64
v_mul_f32 v92,v72,v72
v_mfma_f32_16x16x32_bf16 v[76:79],a[144:147],v[240:243],v[76:79]
ds_read_b128 v[236:239],v17 offset:23552
v_mul_f32 v89,v65,v65
v_mul_f32 v93,v73,v73
v_mfma_f32_16x16x32_bf16 v[68:71],a[20:23],v[244:247],v[68:71]
v_mul_f32 v90,v66,v66
v_mul_f32 v91,v67,v67
v_mul_f32 v94,v74,v74
v_mfma_f32_16x16x32_bf16 v[76:79],a[148:151],v[244:247],v[76:79]
ds_read_b128 v[240:243],v17 offset:25600
v_mul_f32 v95,v75,v75
s_waitcnt lgkmcnt(5)
v_mfma_f32_16x16x32_bf16 v[68:71],a[24:27],v[248:251],v[68:71]
v_min3_u32 v27,v27,v248,v252
v_fma_f32 v88,v88,v121,v122
v_fma_f32 v92,v92,v121,v122
v_mfma_f32_16x16x32_bf16 v[76:79],a[152:155],v[248:251],v[76:79]
ds_read_b128 v[244:247],v17 offset:27648
v_fma_f32 v89,v89,v121,v122
v_fma_f32 v93,v93,v121,v122
v_mfma_f32_16x16x32_bf16 v[68:71],a[28:31],v[252:255],v[68:71]
v_fma_f32 v90,v90,v121,v122
v_fma_f32 v91,v91,v121,v122
v_fma_f32 v94,v94,v121,v122
v_mfma_f32_16x16x32_bf16 v[76:79],a[156:159],v[252:255],v[76:79]
ds_read_b128 v[248:251],v17 offset:29696
v_fma_f32 v95,v95,v121,v122
s_waitcnt lgkmcnt(5)
v_mfma_f32_16x16x32_bf16 v[68:71],a[32:35],v[224:227],v[68:71]
v_min3_u32 v27,v27,v224,v228
v_mul_f32 v88,v88,v64
v_mul_f32 v92,v92,v72
v_mfma_f32_16x16x32_bf16 v[76:79],a[160:163],v[224:227],v[76:79]
ds_read_b128 v[252:255],v17 offset:31744
v_mul_f32 v89,v89,v65
v_mul_f32 v93,v93,v73
v_mfma_f32_16x16x32_bf16 v[68:71],a[36:39],v[228:231],v[68:71]
v_mul_f32 v90,v90,v66
v_mul_f32 v91,v91,v67
v_mul_f32 v94,v94,v74
v_mfma_f32_16x16x32_bf16 v[76:79],a[164:167],v[228:231],v[76:79]
s_waitcnt vmcnt(0)
s_barrier
ds_read_b128 v[224:227],v17 offset:33792
s_waitcnt lgkmcnt(5)
v_mfma_f32_16x16x32_bf16 v[68:71],a[40:43],v[232:235],v[68:71]
v_min3_u32 v27,v27,v232,v236
v_mul_f32 v95,v95,v75
v_mfma_f32_16x16x32_bf16 v[76:79],a[168:171],v[232:235],v[76:79]
ds_read_b128 v[228:231],v17 offset:35840
v_exp_f32 v92,v92
v_mfma_f32_16x16x32_bf16 v[68:71],a[44:47],v[236:239],v[68:71]
v_exp_f32 v88,v88
v_mfma_f32_16x16x32_bf16 v[76:79],a[172:175],v[236:239],v[76:79]
ds_read_b128 v[232:235],v17 offset:37888
s_waitcnt lgkmcnt(5)
v_mfma_f32_16x16x32_bf16 v[68:71],a[48:51],v[240:243],v[68:71]
v_min3_u32 v27,v27,v240,v244
v_exp_f32 v93,v93
v_mfma_f32_16x16x32_bf16 v[76:79],a[176:179],v[240:243],v[76:79]
ds_read_b128 v[236:239],v17 offset:39936
v_exp_f32 v94,v94
v_mfma_f32_16x16x32_bf16 v[68:71],a[52:55],v[244:247],v[68:71]
v_exp_f32 v89,v89
v_mfma_f32_16x16x32_bf16 v[76:79],a[180:183],v[244:247],v[76:79]
ds_read_b128 v[240:243],v17 offset:41984
s_waitcnt lgkmcnt(5)
v_mfma_f32_16x16x32_bf16 v[68:71],a[56:59],v[248:251],v[68:71]
v_min3_u32 v27,v27,v248,v252
v_exp_f32 v95,v95
v_mfma_f32_16x16x32_bf16 v[76:79],a[184:187],v[248:251],v[76:79]
ds_read_b128 v[244:247],v17 offset:44032
v_fma_f32 v92,v92,v123,v123
v_fma_f32 v93,v93,v123,v123
v_mfma_f32_16x16x32_bf16 v[68:71],a[60:63],v[252:255],v[68:71]
v_exp_f32 v90,v90
v_fma_f32 v94,v94,v123,v123
v_mfma_f32_16x16x32_bf16 v[76:79],a[188:191],v[252:255],v[76:79]
ds_read_b128 v[248:251],v17 offset:46080
v_fma_f32 v95,v95,v123,v123
s_waitcnt lgkmcnt(5)
v_mfma_f32_16x16x32_bf16 v[68:71],a[64:67],v[224:227],v[68:71]
v_min3_u32 v27,v27,v224,v228
v_rcp_f32 v92,v92
v_mfma_f32_16x16x32_bf16 v[76:79],a[192:195],v[224:227],v[76:79]
ds_read_b128 v[252:255],v17 offset:48128
v_rcp_f32 v93,v93
v_mfma_f32_16x16x32_bf16 v[68:71],a[68:71],v[228:231],v[68:71]
v_exp_f32 v91,v91
v_mfma_f32_16x16x32_bf16 v[76:79],a[196:199],v[228:231],v[76:79]
ds_read_b128 v[224:227],v17 offset:50176
s_waitcnt lgkmcnt(5)
v_mfma_f32_16x16x32_bf16 v[68:71],a[72:75],v[232:235],v[68:71]
v_min3_u32 v27,v27,v232,v236
v_fma_f32 v88,v88,v123,v123
v_mfma_f32_16x16x32_bf16 v[76:79],a[200:203],v[232:235],v[76:79]
ds_read_b128 v[228:231],v17 offset:52224
v_fma_f32 v89,v89,v123,v123
v_mfma_f32_16x16x32_bf16 v[68:71],a[76:79],v[236:239],v[68:71]
v_fma_f32 v90,v90,v123,v123
v_fma_f32 v91,v91,v123,v123
v_mfma_f32_16x16x32_bf16 v[76:79],a[204:207],v[236:239],v[76:79]
ds_read_b128 v[232:235],v17 offset:54272
s_waitcnt lgkmcnt(5)
v_mfma_f32_16x16x32_bf16 v[68:71],a[80:83],v[240:243],v[68:71]
v_min3_u32 v27,v27,v240,v244
v_rcp_f32 v94,v94
v_mfma_f32_16x16x32_bf16 v[76:79],a[208:211],v[240:243],v[76:79]
ds_read_b128 v[236:239],v17 offset:56320
v_rcp_f32 v95,v95
v_mfma_f32_16x16x32_bf16 v[68:71],a[84:87],v[244:247],v[68:71]
v_rcp_f32 v88,v88
v_mfma_f32_16x16x32_bf16 v[76:79],a[212:215],v[244:247],v[76:79]
ds_read_b128 v[240:243],v17 offset:58368
s_waitcnt lgkmcnt(5)
v_mfma_f32_16x16x32_bf16 v[68:71],a[88:91],v[248:251],v[68:71]
v_min3_u32 v27,v27,v248,v252
v_mul_f32 v92,v92,v72
v_mfma_f32_16x16x32_bf16 v[76:79],a[216:219],v[248:251],v[76:79]
ds_read_b128 v[244:247],v17 offset:60416
v_mul_f32 v93,v93,v73
v_mfma_f32_16x16x32_bf16 v[68:71],a[92:95],v[252:255],v[68:71]
v_rcp_f32 v89,v89
v_mfma_f32_16x16x32_bf16 v[76:79],a[220:223],v[252:255],v[76:79]
ds_read_b128 v[248:251],v17 offset:62464
s_waitcnt lgkmcnt(5)
v_mfma_f32_16x16x32_bf16 v[68:71],a[96:99],v[224:227],v[68:71]
v_min3_u32 v27,v27,v224,v228
v_mul_f32 v94,v94,v74
v_mfma_f32_16x16x32_bf16 v[76:79],a[224:227],v[224:227],v[76:79]
ds_read_b128 v[252:255],v17 offset:64512
v_mul_f32 v95,v95,v75
v_mfma_f32_16x16x32_bf16 v[68:71],a[100:103],v[228:231],v[68:71]
v_rcp_f32 v90,v90
v_mfma_f32_16x16x32_bf16 v[76:79],a[228:231],v[228:231],v[76:79]
s_waitcnt lgkmcnt(4)
v_mfma_f32_16x16x32_bf16 v[68:71],a[104:107],v[232:235],v[68:71]
v_min3_u32 v27,v27,v232,v236
v_mfma_f32_16x16x32_bf16 v[76:79],a[232:235],v[232:235],v[76:79]
v_rcp_f32 v91,v91
v_mfma_f32_16x16x32_bf16 v[68:71],a[108:111],v[236:239],v[68:71]
v_mul_f32 v88,v88,v64
v_mul_f32 v89,v89,v65
v_mfma_f32_16x16x32_bf16 v[76:79],a[236:239],v[236:239],v[76:79]
v_mul_f32 v90,v90,v66
s_waitcnt lgkmcnt(2)
v_mfma_f32_16x16x32_bf16 v[68:71],a[112:115],v[240:243],v[68:71]
v_min3_u32 v27,v27,v240,v244
v_mul_f32 v91,v91,v67
v_mfma_f32_16x16x32_bf16 v[76:79],a[240:243],v[240:243],v[76:79]
v_cvt_pk_bf16_f32 v96,v88,v89
v_cvt_pk_bf16_f32 v97,v90,v91
v_mfma_f32_16x16x32_bf16 v[68:71],a[116:119],v[244:247],v[68:71]
v_cvt_pk_bf16_f32 v98,v92,v93
v_cvt_pk_bf16_f32 v99,v94,v95
v_mfma_f32_16x16x32_bf16 v[76:79],a[244:247],v[244:247],v[76:79]
v_max_u32 v96,1,v96
s_waitcnt lgkmcnt(0)
v_mfma_f32_16x16x32_bf16 v[68:71],a[120:123],v[248:251],v[68:71]
v_min3_u32 v27,v27,v248,v252
v_mfma_f32_16x16x32_bf16 v[76:79],a[248:251],v[248:251],v[76:79]
buffer_store_dwordx4 v[96:99],v18,s[20:23],s70 offen offset:0 sc1
v_mfma_f32_16x16x32_bf16 v[68:71],a[124:127],v[252:255],v[68:71]
v_mfma_f32_16x16x32_bf16 v[76:79],a[252:255],v[252:255],v[76:79]
v_cmp_eq_u32 vcc,0,v27
s_cbranch_vccnz retry_377
s_branch epi_380
keep_388:
v_mfma_f32_16x16x32_bf16 v[64:67],a[124:127],v[252:255],v[64:67]
v_min3_u32 v27,v27,v248,v252
s_xor_b32 m0,s72,0
v_mfma_f32_16x16x32_bf16 v[72:75],a[252:255],v[252:255],v[72:75]
ds_read_b128 v[248:251],v17 offset:13312
s_add_u32 s65,s88,0
s_waitcnt lgkmcnt(6)
v_mfma_f32_16x16x32_bf16 v[68:71],a[0:3],v[224:227],0
buffer_load_dwordx4 v16,s[20:23],s65 offen offset:0 sc1 lds
v_min3_u32 v27,v27,v224,v228
v_mfma_f32_16x16x32_bf16 v[76:79],a[128:131],v[224:227],0
ds_read_b128 v[252:255],v17 offset:15360
buffer_load_dwordx4 v16,s[20:23],s65 offen offset:2048 sc1 lds
v_mfma_f32_16x16x32_bf16 v[68:71],a[4:7],v[228:231],v[68:71]
v_cmp_eq_u32 vcc,0,v27
s_cbranch_vccnz retry_377
s_waitcnt lgkmcnt(6)
v_mfma_f32_16x16x32_bf16 v[76:79],a[132:135],v[228:231],v[76:79]
ds_read_b128 v[224:227],v17 offset:17408
s_xor_b32 m0,s72,16384
s_waitcnt lgkmcnt(5)
v_mfma_f32_16x16x32_bf16 v[68:71],a[8:11],v[232:235],v[68:71]
s_add_u32 s65,s88,32768
v_min3_u32 v27,v27,v232,v236
v_fmac_f32 v64,v52,v120
v_fmac_f32 v72,v56,v120
v_mfma_f32_16x16x32_bf16 v[76:79],a[136:139],v[232:235],v[76:79]
ds_read_b128 v[228:231],v17 offset:19456
buffer_load_dwordx4 v16,s[20:23],s65 offen offset:0 sc1 lds
v_fmac_f32 v73,v57,v120
v_mfma_f32_16x16x32_bf16 v[68:71],a[12:15],v[236:239],v[68:71]
v_fmac_f32 v65,v53,v120
v_fmac_f32 v66,v54,v120
v_fmac_f32 v67,v55,v120
v_fmac_f32 v74,v58,v120
v_mfma_f32_16x16x32_bf16 v[76:79],a[140:143],v[236:239],v[76:79]
ds_read_b128 v[232:235],v17 offset:21504
v_mul_f32 v88,v64,v64
v_fmac_f32 v75,v59,v120
s_waitcnt lgkmcnt(5)
v_mfma_f32_16x16x32_bf16 v[68:71],a[16:19],v[240:243],v[68:71]
buffer_load_dwordx4 v16,s[20:23],s65 offen offset:2048 sc1 lds
s_xor_b32 m0,s72,32768
v_mul_f32 v92,v72,v72
v_mfma_f32_16x16x32_bf16 v[76:79],a[144:147],v[240:243],v[76:79]
ds_read_b128 v[236:239],v17 offset:23552
s_add_u32 s65,s88,65536
v_mul_f32 v89,v65,v65
v_mul_f32 v93,v73,v73
v_mfma_f32_16x16x32_bf16 v[68:71],a[20:23],v[244:247],v[68:71]
v_min3_u32 v27,v27,v240,v244
v_mul_f32 v90,v66,v66
v_mul_f32 v91,v67,v67
v_mul_f32 v94,v74,v74
v_mfma_f32_16x16x32_bf16 v[76:79],a[148:151],v[244:247],v[76:79]
ds_read_b128 v[240:243],v17 offset:25600
v_fma_f32 v88,v88,v121,v122
v_mul_f32 v95,v75,v75
s_waitcnt lgkmcnt(5)
v_mfma_f32_16x16x32_bf16 v[68:71],a[24:27],v[248:251],v[68:71]
buffer_load_dwordx4 v16,s[20:23],s65 offen offset:0 sc1 lds
v_fma_f32 v89,v89,v121,v122
v_fma_f32 v92,v92,v121,v122
v_mfma_f32_16x16x32_bf16 v[76:79],a[152:155],v[248:251],v[76:79]
ds_read_b128 v[244:247],v17 offset:27648
buffer_load_dwordx4 v16,s[20:23],s65 offen offset:2048 sc1 lds
v_fma_f32 v93,v93,v121,v122
v_mfma_f32_16x16x32_bf16 v[68:71],a[28:31],v[252:255],v[68:71]
s_xor_b32 m0,s72,49152
v_min3_u32 v27,v27,v248,v252
v_fma_f32 v90,v90,v121,v122
v_fma_f32 v94,v94,v121,v122
v_mfma_f32_16x16x32_bf16 v[76:79],a[156:159],v[252:255],v[76:79]
ds_read_b128 v[248:251],v17 offset:29696
s_add_u32 s65,s88,98304
v_fma_f32 v95,v95,v121,v122
s_waitcnt lgkmcnt(5)
v_mfma_f32_16x16x32_bf16 v[68:71],a[32:35],v[224:227],v[68:71]
buffer_load_dwordx4 v16,s[20:23],s65 offen offset:0 sc1 lds
v_fma_f32 v91,v91,v121,v122
v_mul_f32 v92,v92,v72
v_mfma_f32_16x16x32_bf16 v[76:79],a[160:163],v[224:227],v[76:79]
ds_read_b128 v[252:255],v17 offset:31744
v_min3_u32 v27,v27,v224,v228
v_mul_f32 v88,v88,v64
v_mul_f32 v93,v93,v73
v_mfma_f32_16x16x32_bf16 v[68:71],a[36:39],v[228:231],v[68:71]
buffer_load_dwordx4 v16,s[20:23],s65 offen offset:2048 sc1 lds
v_mul_f32 v89,v89,v65
v_mul_f32 v94,v94,v74
v_mfma_f32_16x16x32_bf16 v[76:79],a[164:167],v[228:231],v[76:79]
s_waitcnt vmcnt(8)
s_barrier
ds_read_b128 v[224:227],v17 offset:33792
s_waitcnt lgkmcnt(5)
v_mfma_f32_16x16x32_bf16 v[68:71],a[40:43],v[232:235],v[68:71]
s_xor_b32 m0,s72,1024
s_add_u32 s65,s89,0
v_mul_f32 v90,v90,v66
v_mul_f32 v95,v95,v75
v_mfma_f32_16x16x32_bf16 v[76:79],a[168:171],v[232:235],v[76:79]
ds_read_b128 v[228:231],v17 offset:35840
v_min3_u32 v27,v27,v232,v236
v_mul_f32 v91,v91,v67
v_mfma_f32_16x16x32_bf16 v[68:71],a[44:47],v[236:239],v[68:71]
buffer_load_dwordx4 v16,s[20:23],s65 offen offset:0 sc1 lds
v_exp_f32 v92,v92
v_mfma_f32_16x16x32_bf16 v[76:79],a[172:175],v[236:239],v[76:79]
ds_read_b128 v[232:235],v17 offset:37888
v_exp_f32 v93,v93
s_waitcnt lgkmcnt(5)
v_mfma_f32_16x16x32_bf16 v[68:71],a[48:51],v[240:243],v[68:71]
buffer_load_dwordx4 v16,s[20:23],s65 offen offset:2048 sc1 lds
v_exp_f32 v94,v94
v_mfma_f32_16x16x32_bf16 v[76:79],a[176:179],v[240:243],v[76:79]
ds_read_b128 v[236:239],v17 offset:39936
s_xor_b32 m0,s72,17408
v_exp_f32 v95,v95
v_mfma_f32_16x16x32_bf16 v[68:71],a[52:55],v[244:247],v[68:71]
s_add_u32 s65,s89,32768
v_min3_u32 v27,v27,v240,v244
v_fma_f32 v92,v92,v123,v123
v_fma_f32 v93,v93,v123,v123
v_mfma_f32_16x16x32_bf16 v[76:79],a[180:183],v[244:247],v[76:79]
ds_read_b128 v[240:243],v17 offset:41984
v_fma_f32 v94,v94,v123,v123
v_fma_f32 v95,v95,v123,v123
s_waitcnt lgkmcnt(5)
v_mfma_f32_16x16x32_bf16 v[68:71],a[56:59],v[248:251],v[68:71]
buffer_load_dwordx4 v16,s[20:23],s65 offen offset:0 sc1 lds
v_rcp_f32 v92,v92
v_mfma_f32_16x16x32_bf16 v[76:79],a[184:187],v[248:251],v[76:79]
ds_read_b128 v[244:247],v17 offset:44032
v_min3_u32 v27,v27,v248,v252
v_rcp_f32 v93,v93
v_mfma_f32_16x16x32_bf16 v[68:71],a[60:63],v[252:255],v[68:71]
buffer_load_dwordx4 v16,s[20:23],s65 offen offset:2048 sc1 lds
v_rcp_f32 v94,v94
v_mfma_f32_16x16x32_bf16 v[76:79],a[188:191],v[252:255],v[76:79]
ds_read_b128 v[248:251],v17 offset:46080
v_rcp_f32 v95,v95
s_waitcnt lgkmcnt(5)
v_mfma_f32_16x16x32_bf16 v[68:71],a[64:67],v[224:227],v[68:71]
s_xor_b32 m0,s72,33792
s_add_u32 s65,s89,65536
v_mul_f32 v92,v92,v72
v_mul_f32 v93,v93,v73
v_mfma_f32_16x16x32_bf16 v[76:79],a[192:195],v[224:227],v[76:79]
ds_read_b128 v[252:255],v17 offset:48128
v_min3_u32 v27,v27,v224,v228
v_mfma_f32_16x16x32_bf16 v[68:71],a[68:71],v[228:231],v[68:71]
buffer_load_dwordx4 v16,s[20:23],s65 offen offset:0 sc1 lds
v_mfma_f32_16x16x32_bf16 v[76:79],a[196:199],v[228:231],v[76:79]
ds_read_b128 v[224:227],v17 offset:50176
s_waitcnt lgkmcnt(5)
v_mfma_f32_16x16x32_bf16 v[68:71],a[72:75],v[232:235],v[68:71]
buffer_load_dwordx4 v16,s[20:23],s65 offen offset:2048 sc1 lds
v_mfma_f32_16x16x32_bf16 v[76:79],a[200:203],v[232:235],v[76:79]
ds_read_b128 v[228:231],v17 offset:52224
s_xor_b32 m0,s72,50176
v_mfma_f32_16x16x32_bf16 v[68:71],a[76:79],v[236:239],v[68:71]
s_add_u32 s65,s89,98304
v_min3_u32 v27,v27,v232,v236
v_mfma_f32_16x16x32_bf16 v[76:79],a[204:207],v[236:239],v[76:79]
ds_read_b128 v[232:235],v17 offset:54272
s_waitcnt lgkmcnt(5)
v_mfma_f32_16x16x32_bf16 v[68:71],a[80:83],v[240:243],v[68:71]
buffer_load_dwordx4 v16,s[20:23],s65 offen offset:0 sc1 lds
v_mfma_f32_16x16x32_bf16 v[76:79],a[208:211],v[240:243],v[76:79]
ds_read_b128 v[236:239],v17 offset:56320
v_min3_u32 v27,v27,v240,v244
v_mfma_f32_16x16x32_bf16 v[68:71],a[84:87],v[244:247],v[68:71]
buffer_load_dwordx4 v16,s[20:23],s65 offen offset:2048 sc1 lds
v_mfma_f32_16x16x32_bf16 v[76:79],a[212:215],v[244:247],v[76:79]
ds_read_b128 v[240:243],v17 offset:58368
s_waitcnt lgkmcnt(5)
v_mfma_f32_16x16x32_bf16 v[68:71],a[88:91],v[248:251],v[68:71]
v_min3_u32 v27,v27,v248,v252
v_exp_f32 v88,v88
v_mfma_f32_16x16x32_bf16 v[76:79],a[216:219],v[248:251],v[76:79]
ds_read_b128 v[244:247],v17 offset:60416
v_exp_f32 v89,v89
v_mfma_f32_16x16x32_bf16 v[68:71],a[92:95],v[252:255],v[68:71]
v_exp_f32 v90,v90
v_mfma_f32_16x16x32_bf16 v[76:79],a[220:223],v[252:255],v[76:79]
ds_read_b128 v[248:251],v17 offset:62464
s_waitcnt lgkmcnt(5)
v_mfma_f32_16x16x32_bf16 v[68:71],a[96:99],v[224:227],v[68:71]
v_min3_u32 v27,v27,v224,v228
v_exp_f32 v91,v91
v_mfma_f32_16x16x32_bf16 v[76:79],a[224:227],v[224:227],v[76:79]
ds_read_b128 v[252:255],v17 offset:64512
v_fma_f32 v88,v88,v123,v123
v_fma_f32 v89,v89,v123,v123
v_mfma_f32_16x16x32_bf16 v[68:71],a[100:103],v[228:231],v[68:71]
v_fma_f32 v90,v90,v123,v123
v_fma_f32 v91,v91,v123,v123
v_mfma_f32_16x16x32_bf16 v[76:79],a[228:231],v[228:231],v[76:79]
v_rcp_f32 v88,v88
s_waitcnt lgkmcnt(4)
v_mfma_f32_16x16x32_bf16 v[68:71],a[104:107],v[232:235],v[68:71]
v_min3_u32 v27,v27,v232,v236
v_rcp_f32 v89,v89
v_mfma_f32_16x16x32_bf16 v[76:79],a[232:235],v[232:235],v[76:79]
v_rcp_f32 v90,v90
v_mfma_f32_16x16x32_bf16 v[68:71],a[108:111],v[236:239],v[68:71]
v_rcp_f32 v91,v91
v_mfma_f32_16x16x32_bf16 v[76:79],a[236:239],v[236:239],v[76:79]
v_mul_f32 v88,v88,v64
s_waitcnt lgkmcnt(2)
v_mfma_f32_16x16x32_bf16 v[68:71],a[112:115],v[240:243],v[68:71]
v_min3_u32 v27,v27,v240,v244
v_mul_f32 v89,v89,v65
v_mfma_f32_16x16x32_bf16 v[76:79],a[240:243],v[240:243],v[76:79]
v_mul_f32 v90,v90,v66
v_mul_f32 v91,v91,v67
v_mfma_f32_16x16x32_bf16 v[68:71],a[116:119],v[244:247],v[68:71]
v_mul_f32 v94,v94,v74
v_mul_f32 v95,v95,v75
v_mfma_f32_16x16x32_bf16 v[76:79],a[244:247],v[244:247],v[76:79]
v_cvt_pk_bf16_f32 v96,v88,v89
s_waitcnt lgkmcnt(0)
v_mfma_f32_16x16x32_bf16 v[68:71],a[120:123],v[248:251],v[68:71]
v_min3_u32 v27,v27,v248,v252
v_cvt_pk_bf16_f32 v97,v90,v91
v_mfma_f32_16x16x32_bf16 v[76:79],a[248:251],v[248:251],v[76:79]
v_cvt_pk_bf16_f32 v98,v92,v93
v_cvt_pk_bf16_f32 v99,v94,v95
v_mfma_f32_16x16x32_bf16 v[68:71],a[124:127],v[252:255],v[68:71]
v_max_u32 v96,1,v96
v_mfma_f32_16x16x32_bf16 v[76:79],a[252:255],v[252:255],v[76:79]
buffer_store_dwordx4 v[96:99],v18,s[20:23],s70 offen offset:0 sc1
v_cmp_eq_u32 vcc,0,v27
s_cbranch_vccnz retry_377
s_branch epi_380
ahead_379:
s_cmp_eq_u32 s93,0
s_cbranch_scc1 both_381
s_waitcnt vmcnt(12) lgkmcnt(0)
s_barrier
ds_read_b128 v[224:227],v17 offset:0
ds_read_b128 v[228:231],v17 offset:2048
ds_read_b128 v[232:235],v17 offset:4096
ds_read_b128 v[236:239],v17 offset:6144
ds_read_b128 v[240:243],v17 offset:8192
ds_read_b128 v[244:247],v17 offset:10240
ds_read_b128 v[248:251],v17 offset:12288
s_waitcnt lgkmcnt(5)
v_mfma_f32_16x16x32_bf16 v[64:67],a[0:3],v[224:227],0
s_add_u32 s96,s71,1
s_add_u32 s92,s71,2
v_mfma_f32_16x16x32_bf16 v[72:75],a[128:131],v[224:227],0
ds_read_b128 v[252:255],v17 offset:14336
v_min_u32 v27,v224,v228
v_mfma_f32_16x16x32_bf16 v[64:67],a[4:7],v[228:231],v[64:67]
s_cmp_eq_u32 s96,64
s_cselect_b32 s96,99,s96
v_mfma_f32_16x16x32_bf16 v[72:75],a[132:135],v[228:231],v[72:75]
ds_read_b128 v[224:227],v17 offset:16384
s_waitcnt lgkmcnt(5)
v_mfma_f32_16x16x32_bf16 v[64:67],a[8:11],v[232:235],v[64:67]
s_cmp_eq_u32 s92,64
s_cselect_b32 s92,99,s92
v_mfma_f32_16x16x32_bf16 v[72:75],a[136:139],v[232:235],v[72:75]
ds_read_b128 v[228:231],v17 offset:18432
v_min3_u32 v27,v27,v232,v236
v_mfma_f32_16x16x32_bf16 v[64:67],a[12:15],v[236:239],v[64:67]
v_mfma_f32_16x16x32_bf16 v[72:75],a[140:143],v[236:239],v[72:75]
ds_read_b128 v[232:235],v17 offset:20480
s_waitcnt lgkmcnt(5)
v_mfma_f32_16x16x32_bf16 v[64:67],a[16:19],v[240:243],v[64:67]
v_min3_u32 v27,v27,v240,v244
v_mfma_f32_16x16x32_bf16 v[72:75],a[144:147],v[240:243],v[72:75]
ds_read_b128 v[236:239],v17 offset:22528
v_mfma_f32_16x16x32_bf16 v[64:67],a[20:23],v[244:247],v[64:67]
v_mfma_f32_16x16x32_bf16 v[72:75],a[148:151],v[244:247],v[72:75]
ds_read_b128 v[240:243],v17 offset:24576
s_waitcnt lgkmcnt(5)
v_mfma_f32_16x16x32_bf16 v[64:67],a[24:27],v[248:251],v[64:67]
v_min3_u32 v27,v27,v248,v252
v_mfma_f32_16x16x32_bf16 v[72:75],a[152:155],v[248:251],v[72:75]
ds_read_b128 v[244:247],v17 offset:26624
v_mfma_f32_16x16x32_bf16 v[64:67],a[28:31],v[252:255],v[64:67]
v_mfma_f32_16x16x32_bf16 v[72:75],a[156:159],v[252:255],v[72:75]
ds_read_b128 v[248:251],v17 offset:28672
s_waitcnt lgkmcnt(5)
v_mfma_f32_16x16x32_bf16 v[64:67],a[32:35],v[224:227],v[64:67]
v_min3_u32 v27,v27,v224,v228
v_mfma_f32_16x16x32_bf16 v[72:75],a[160:163],v[224:227],v[72:75]
ds_read_b128 v[252:255],v17 offset:30720
v_mfma_f32_16x16x32_bf16 v[64:67],a[36:39],v[228:231],v[64:67]
v_mfma_f32_16x16x32_bf16 v[72:75],a[164:167],v[228:231],v[72:75]
ds_read_b128 v[224:227],v17 offset:32768
s_waitcnt lgkmcnt(5)
v_mfma_f32_16x16x32_bf16 v[64:67],a[40:43],v[232:235],v[64:67]
v_min3_u32 v27,v27,v232,v236
v_mfma_f32_16x16x32_bf16 v[72:75],a[168:171],v[232:235],v[72:75]
ds_read_b128 v[228:231],v17 offset:34816
v_mfma_f32_16x16x32_bf16 v[64:67],a[44:47],v[236:239],v[64:67]
v_mfma_f32_16x16x32_bf16 v[72:75],a[172:175],v[236:239],v[72:75]
ds_read_b128 v[232:235],v17 offset:36864
s_waitcnt lgkmcnt(5)
v_mfma_f32_16x16x32_bf16 v[64:67],a[48:51],v[240:243],v[64:67]
v_min3_u32 v27,v27,v240,v244
v_mfma_f32_16x16x32_bf16 v[72:75],a[176:179],v[240:243],v[72:75]
ds_read_b128 v[236:239],v17 offset:38912
v_mfma_f32_16x16x32_bf16 v[64:67],a[52:55],v[244:247],v[64:67]
v_mfma_f32_16x16x32_bf16 v[72:75],a[180:183],v[244:247],v[72:75]
ds_read_b128 v[240:243],v17 offset:40960
s_waitcnt lgkmcnt(5)
v_mfma_f32_16x16x32_bf16 v[64:67],a[56:59],v[248:251],v[64:67]
v_min3_u32 v27,v27,v248,v252
v_mfma_f32_16x16x32_bf16 v[72:75],a[184:187],v[248:251],v[72:75]
ds_read_b128 v[244:247],v17 offset:43008
s_waitcnt vmcnt(2)
v_mfma_f32_16x16x32_bf16 v[64:67],a[60:63],v[252:255],v[64:67]
v_cmp_gt_u32 vcc,s96,v29
v_cmp_gt_u32 s[92:93],s92,v29
v_mfma_f32_16x16x32_bf16 v[72:75],a[188:191],v[252:255],v[72:75]
ds_read_b128 v[248:251],v17 offset:45056
s_waitcnt lgkmcnt(5)
v_mfma_f32_16x16x32_bf16 v[64:67],a[64:67],v[224:227],v[64:67]
v_mov_b32 v44,vcc_lo
v_mov_b32 v45,s92
v_mfma_f32_16x16x32_bf16 v[72:75],a[192:195],v[224:227],v[72:75]
ds_read_b128 v[252:255],v17 offset:47104
ds_write_b64 v46,v[44:45]
v_mfma_f32_16x16x32_bf16 v[64:67],a[68:71],v[228:231],v[64:67]
v_min3_u32 v27,v27,v224,v228
v_mfma_f32_16x16x32_bf16 v[72:75],a[196:199],v[228:231],v[72:75]
ds_read_b128 v[224:227],v17 offset:49152
s_waitcnt lgkmcnt(6)
v_mfma_f32_16x16x32_bf16 v[64:67],a[72:75],v[232:235],v[64:67]
v_min3_u32 v27,v27,v232,v236
v_mfma_f32_16x16x32_bf16 v[72:75],a[200:203],v[232:235],v[72:75]
ds_read_b128 v[228:231],v17 offset:51200
v_mfma_f32_16x16x32_bf16 v[64:67],a[76:79],v[236:239],v[64:67]
v_mfma_f32_16x16x32_bf16 v[72:75],a[204:207],v[236:239],v[72:75]
ds_read_b128 v[232:235],v17 offset:53248
s_waitcnt lgkmcnt(6)
v_mfma_f32_16x16x32_bf16 v[64:67],a[80:83],v[240:243],v[64:67]
v_min3_u32 v27,v27,v240,v244
s_add_u32 s88,s70,s75
v_mfma_f32_16x16x32_bf16 v[72:75],a[208:211],v[240:243],v[72:75]
ds_read_b128 v[236:239],v17 offset:55296
s_add_u32 s88,s88,2097152
v_mfma_f32_16x16x32_bf16 v[64:67],a[84:87],v[244:247],v[64:67]
s_xor_b32 s88,s88,0x2000
s_xor_b32 s89,s88,1024
v_mfma_f32_16x16x32_bf16 v[72:75],a[212:215],v[244:247],v[72:75]
ds_read_b128 v[240:243],v17 offset:57344
s_waitcnt lgkmcnt(6)
v_mfma_f32_16x16x32_bf16 v[64:67],a[88:91],v[248:251],v[64:67]
v_min3_u32 v27,v27,v248,v252
v_mfma_f32_16x16x32_bf16 v[72:75],a[216:219],v[248:251],v[72:75]
ds_read_b128 v[244:247],v17 offset:59392
v_mfma_f32_16x16x32_bf16 v[64:67],a[92:95],v[252:255],v[64:67]
v_mfma_f32_16x16x32_bf16 v[72:75],a[220:223],v[252:255],v[72:75]
ds_read_b128 v[248:251],v17 offset:61440
s_waitcnt lgkmcnt(5)
v_mfma_f32_16x16x32_bf16 v[64:67],a[96:99],v[224:227],v[64:67]
v_min3_u32 v27,v27,v224,v228
v_mfma_f32_16x16x32_bf16 v[72:75],a[224:227],v[224:227],v[72:75]
ds_read_b128 v[252:255],v17 offset:63488
v_mfma_f32_16x16x32_bf16 v[64:67],a[100:103],v[228:231],v[64:67]
s_waitcnt vmcnt(0)
v_add_u32 v22,s71,-1
v_mfma_f32_16x16x32_bf16 v[72:75],a[228:231],v[228:231],v[72:75]
s_waitcnt vmcnt(4)
s_barrier
ds_read_b64 v[44:45],v47
ds_read_b128 v[224:227],v17 offset:1024
s_waitcnt lgkmcnt(6)
v_mfma_f32_16x16x32_bf16 v[64:67],a[104:107],v[232:235],v[64:67]
v_min3_u32 v27,v27,v232,v236
ds_read_b128 v[124:127],v19 offset:256
v_mfma_f32_16x16x32_bf16 v[72:75],a[232:235],v[232:235],v[72:75]
ds_read_b128 v[228:231],v17 offset:3072
ds_read_b128 v[120:123],v19 offset:0
v_mfma_f32_16x16x32_bf16 v[64:67],a[108:111],v[236:239],v[64:67]
buffer_store_dword v22,v23,s[20:23],s97 offen sc1
v_mfma_f32_16x16x32_bf16 v[72:75],a[236:239],v[236:239],v[72:75]
ds_read_b128 v[232:235],v17 offset:5120
s_waitcnt lgkmcnt(8)
v_mfma_f32_16x16x32_bf16 v[64:67],a[112:115],v[240:243],v[64:67]
v_min3_u32 v27,v27,v240,v244
s_mov_b32 s97,0x7fff0000
v_mfma_f32_16x16x32_bf16 v[72:75],a[240:243],v[240:243],v[72:75]
ds_read_b128 v[236:239],v17 offset:7168
v_mfma_f32_16x16x32_bf16 v[64:67],a[116:119],v[244:247],v[64:67]
v_mfma_f32_16x16x32_bf16 v[72:75],a[244:247],v[244:247],v[72:75]
ds_read_b128 v[240:243],v17 offset:9216
s_waitcnt lgkmcnt(8)
v_mfma_f32_16x16x32_bf16 v[64:67],a[120:123],v[248:251],v[64:67]
s_waitcnt lgkmcnt(7)
v_readfirstlane_b32 s93,v45
v_mfma_f32_16x16x32_bf16 v[72:75],a[248:251],v[248:251],v[72:75]
ds_read_b128 v[244:247],v17 offset:11264
v_readfirstlane_b32 s83,v44
s_cmp_lg_u32 s83,0
s_cbranch_scc1 keep_389
v_mfma_f32_16x16x32_bf16 v[64:67],a[124:127],v[252:255],v[64:67]
v_min3_u32 v27,v27,v248,v252
s_xor_b32 m0,s72,0
v_mfma_f32_16x16x32_bf16 v[72:75],a[252:255],v[252:255],v[72:75]
ds_read_b128 v[248:251],v17 offset:13312
s_add_u32 s65,s88,0
s_waitcnt lgkmcnt(6)
v_mfma_f32_16x16x32_bf16 v[68:71],a[0:3],v[224:227],0
buffer_load_dwordx4 v16,s[20:23],s65 offen offset:0 sc1 lds
v_min3_u32 v27,v27,v224,v228
v_mfma_f32_16x16x32_bf16 v[76:79],a[128:131],v[224:227],0
ds_read_b128 v[252:255],v17 offset:15360
buffer_load_dwordx4 v16,s[20:23],s65 offen offset:2048 sc1 lds
v_mfma_f32_16x16x32_bf16 v[68:71],a[4:7],v[228:231],v[68:71]
v_cmp_eq_u32 vcc,0,v27
s_cbranch_vccnz retry_377
s_waitcnt lgkmcnt(6)
v_mfma_f32_16x16x32_bf16 v[76:79],a[132:135],v[228:231],v[76:79]
ds_read_b128 v[224:227],v17 offset:17408
s_xor_b32 m0,s72,16384
s_waitcnt lgkmcnt(5)
v_mfma_f32_16x16x32_bf16 v[68:71],a[8:11],v[232:235],v[68:71]
s_add_u32 s65,s88,32768
v_min3_u32 v27,v27,v232,v236
v_fmac_f32 v64,v52,v120
v_fmac_f32 v72,v56,v120
v_mfma_f32_16x16x32_bf16 v[76:79],a[136:139],v[232:235],v[76:79]
ds_read_b128 v[228:231],v17 offset:19456
buffer_load_dwordx4 v16,s[20:23],s65 offen offset:0 sc1 lds
v_fmac_f32 v73,v57,v120
v_mfma_f32_16x16x32_bf16 v[68:71],a[12:15],v[236:239],v[68:71]
v_fmac_f32 v65,v53,v120
v_fmac_f32 v66,v54,v120
v_fmac_f32 v67,v55,v120
v_fmac_f32 v74,v58,v120
v_mfma_f32_16x16x32_bf16 v[76:79],a[140:143],v[236:239],v[76:79]
ds_read_b128 v[232:235],v17 offset:21504
v_mul_f32 v88,v64,v64
v_fmac_f32 v75,v59,v120
s_waitcnt lgkmcnt(5)
v_mfma_f32_16x16x32_bf16 v[68:71],a[16:19],v[240:243],v[68:71]
buffer_load_dwordx4 v16,s[20:23],s65 offen offset:2048 sc1 lds
s_xor_b32 m0,s72,32768
v_mul_f32 v92,v72,v72
v_mfma_f32_16x16x32_bf16 v[76:79],a[144:147],v[240:243],v[76:79]
ds_read_b128 v[236:239],v17 offset:23552
s_add_u32 s65,s88,65536
v_mul_f32 v89,v65,v65
v_mul_f32 v93,v73,v73
v_mfma_f32_16x16x32_bf16 v[68:71],a[20:23],v[244:247],v[68:71]
v_min3_u32 v27,v27,v240,v244
v_mul_f32 v90,v66,v66
v_mul_f32 v91,v67,v67
v_mul_f32 v94,v74,v74
v_mfma_f32_16x16x32_bf16 v[76:79],a[148:151],v[244:247],v[76:79]
ds_read_b128 v[240:243],v17 offset:25600
v_fma_f32 v88,v88,v121,v122
v_mul_f32 v95,v75,v75
s_waitcnt lgkmcnt(5)
v_mfma_f32_16x16x32_bf16 v[68:71],a[24:27],v[248:251],v[68:71]
buffer_load_dwordx4 v16,s[20:23],s65 offen offset:0 sc1 lds
v_fma_f32 v89,v89,v121,v122
v_fma_f32 v92,v92,v121,v122
v_mfma_f32_16x16x32_bf16 v[76:79],a[152:155],v[248:251],v[76:79]
ds_read_b128 v[244:247],v17 offset:27648
buffer_load_dwordx4 v16,s[20:23],s65 offen offset:2048 sc1 lds
v_fma_f32 v93,v93,v121,v122
v_mfma_f32_16x16x32_bf16 v[68:71],a[28:31],v[252:255],v[68:71]
s_xor_b32 m0,s72,49152
v_min3_u32 v27,v27,v248,v252
v_fma_f32 v90,v90,v121,v122
v_fma_f32 v94,v94,v121,v122
v_mfma_f32_16x16x32_bf16 v[76:79],a[156:159],v[252:255],v[76:79]
ds_read_b128 v[248:251],v17 offset:29696
s_add_u32 s65,s88,98304
v_fma_f32 v95,v95,v121,v122
s_waitcnt lgkmcnt(5)
v_mfma_f32_16x16x32_bf16 v[68:71],a[32:35],v[224:227],v[68:71]
buffer_load_dwordx4 v16,s[20:23],s65 offen offset:0 sc1 lds
v_fma_f32 v91,v91,v121,v122
v_mul_f32 v92,v92,v72
v_mfma_f32_16x16x32_bf16 v[76:79],a[160:163],v[224:227],v[76:79]
ds_read_b128 v[252:255],v17 offset:31744
v_min3_u32 v27,v27,v224,v228
v_mul_f32 v88,v88,v64
v_mul_f32 v93,v93,v73
v_mfma_f32_16x16x32_bf16 v[68:71],a[36:39],v[228:231],v[68:71]
buffer_load_dwordx4 v16,s[20:23],s65 offen offset:2048 sc1 lds
v_mul_f32 v89,v89,v65
v_mul_f32 v94,v94,v74
v_mfma_f32_16x16x32_bf16 v[76:79],a[164:167],v[228:231],v[76:79]
ds_read_b128 v[224:227],v17 offset:33792
v_mul_f32 v90,v90,v66
v_mul_f32 v95,v95,v75
s_waitcnt lgkmcnt(5)
v_mfma_f32_16x16x32_bf16 v[68:71],a[40:43],v[232:235],v[68:71]
s_xor_b32 m0,s72,1024
s_add_u32 s65,s89,0
v_mul_f32 v91,v91,v67
v_mfma_f32_16x16x32_bf16 v[76:79],a[168:171],v[232:235],v[76:79]
ds_read_b128 v[228:231],v17 offset:35840
v_min3_u32 v27,v27,v232,v236
v_exp_f32 v92,v92
v_mfma_f32_16x16x32_bf16 v[68:71],a[44:47],v[236:239],v[68:71]
buffer_load_dwordx4 v16,s[20:23],s65 offen offset:0 sc1 lds
v_exp_f32 v93,v93
v_mfma_f32_16x16x32_bf16 v[76:79],a[172:175],v[236:239],v[76:79]
ds_read_b128 v[232:235],v17 offset:37888
v_exp_f32 v94,v94
s_waitcnt lgkmcnt(5)
v_mfma_f32_16x16x32_bf16 v[68:71],a[48:51],v[240:243],v[68:71]
buffer_load_dwordx4 v16,s[20:23],s65 offen offset:2048 sc1 lds
v_exp_f32 v95,v95
v_mfma_f32_16x16x32_bf16 v[76:79],a[176:179],v[240:243],v[76:79]
ds_read_b128 v[236:239],v17 offset:39936
s_xor_b32 m0,s72,17408
v_fma_f32 v92,v92,v123,v123
v_fma_f32 v93,v93,v123,v123
v_mfma_f32_16x16x32_bf16 v[68:71],a[52:55],v[244:247],v[68:71]
s_add_u32 s65,s89,32768
v_min3_u32 v27,v27,v240,v244
v_fma_f32 v94,v94,v123,v123
v_fma_f32 v95,v95,v123,v123
v_mfma_f32_16x16x32_bf16 v[76:79],a[180:183],v[244:247],v[76:79]
ds_read_b128 v[240:243],v17 offset:41984
v_rcp_f32 v92,v92
s_waitcnt lgkmcnt(5)
v_mfma_f32_16x16x32_bf16 v[68:71],a[56:59],v[248:251],v[68:71]
buffer_load_dwordx4 v16,s[20:23],s65 offen offset:0 sc1 lds
v_rcp_f32 v93,v93
v_mfma_f32_16x16x32_bf16 v[76:79],a[184:187],v[248:251],v[76:79]
ds_read_b128 v[244:247],v17 offset:44032
v_min3_u32 v27,v27,v248,v252
v_rcp_f32 v94,v94
v_mfma_f32_16x16x32_bf16 v[68:71],a[60:63],v[252:255],v[68:71]
buffer_load_dwordx4 v16,s[20:23],s65 offen offset:2048 sc1 lds
v_rcp_f32 v95,v95
v_mfma_f32_16x16x32_bf16 v[76:79],a[188:191],v[252:255],v[76:79]
ds_read_b128 v[248:251],v17 offset:46080
v_mul_f32 v92,v92,v72
v_mul_f32 v93,v93,v73
s_waitcnt lgkmcnt(5)
v_mfma_f32_16x16x32_bf16 v[68:71],a[64:67],v[224:227],v[68:71]
s_xor_b32 m0,s72,33792
s_add_u32 s65,s89,65536
v_mfma_f32_16x16x32_bf16 v[76:79],a[192:195],v[224:227],v[76:79]
ds_read_b128 v[252:255],v17 offset:48128
v_min3_u32 v27,v27,v224,v228
v_mfma_f32_16x16x32_bf16 v[68:71],a[68:71],v[228:231],v[68:71]
buffer_load_dwordx4 v16,s[20:23],s65 offen offset:0 sc1 lds
v_mfma_f32_16x16x32_bf16 v[76:79],a[196:199],v[228:231],v[76:79]
ds_read_b128 v[224:227],v17 offset:50176
s_waitcnt lgkmcnt(5)
v_mfma_f32_16x16x32_bf16 v[68:71],a[72:75],v[232:235],v[68:71]
buffer_load_dwordx4 v16,s[20:23],s65 offen offset:2048 sc1 lds
v_mfma_f32_16x16x32_bf16 v[76:79],a[200:203],v[232:235],v[76:79]
ds_read_b128 v[228:231],v17 offset:52224
s_xor_b32 m0,s72,50176
v_mfma_f32_16x16x32_bf16 v[68:71],a[76:79],v[236:239],v[68:71]
s_add_u32 s65,s89,98304
v_min3_u32 v27,v27,v232,v236
v_mfma_f32_16x16x32_bf16 v[76:79],a[204:207],v[236:239],v[76:79]
ds_read_b128 v[232:235],v17 offset:54272
s_waitcnt lgkmcnt(5)
v_mfma_f32_16x16x32_bf16 v[68:71],a[80:83],v[240:243],v[68:71]
buffer_load_dwordx4 v16,s[20:23],s65 offen offset:0 sc1 lds
v_mfma_f32_16x16x32_bf16 v[76:79],a[208:211],v[240:243],v[76:79]
ds_read_b128 v[236:239],v17 offset:56320
v_min3_u32 v27,v27,v240,v244
v_mfma_f32_16x16x32_bf16 v[68:71],a[84:87],v[244:247],v[68:71]
buffer_load_dwordx4 v16,s[20:23],s65 offen offset:2048 sc1 lds
v_mfma_f32_16x16x32_bf16 v[76:79],a[212:215],v[244:247],v[76:79]
ds_read_b128 v[240:243],v17 offset:58368
s_waitcnt lgkmcnt(5)
v_mfma_f32_16x16x32_bf16 v[68:71],a[88:91],v[248:251],v[68:71]
v_min3_u32 v27,v27,v248,v252
v_exp_f32 v88,v88
v_mfma_f32_16x16x32_bf16 v[76:79],a[216:219],v[248:251],v[76:79]
ds_read_b128 v[244:247],v17 offset:60416
v_exp_f32 v89,v89
v_mfma_f32_16x16x32_bf16 v[68:71],a[92:95],v[252:255],v[68:71]
v_exp_f32 v90,v90
v_mfma_f32_16x16x32_bf16 v[76:79],a[220:223],v[252:255],v[76:79]
ds_read_b128 v[248:251],v17 offset:62464
s_waitcnt lgkmcnt(5)
v_mfma_f32_16x16x32_bf16 v[68:71],a[96:99],v[224:227],v[68:71]
v_min3_u32 v27,v27,v224,v228
v_exp_f32 v91,v91
v_mfma_f32_16x16x32_bf16 v[76:79],a[224:227],v[224:227],v[76:79]
ds_read_b128 v[252:255],v17 offset:64512
v_fma_f32 v88,v88,v123,v123
v_fma_f32 v89,v89,v123,v123
v_mfma_f32_16x16x32_bf16 v[68:71],a[100:103],v[228:231],v[68:71]
v_fma_f32 v90,v90,v123,v123
v_fma_f32 v91,v91,v123,v123
v_mfma_f32_16x16x32_bf16 v[76:79],a[228:231],v[228:231],v[76:79]
v_rcp_f32 v88,v88
s_waitcnt lgkmcnt(4)
v_mfma_f32_16x16x32_bf16 v[68:71],a[104:107],v[232:235],v[68:71]
v_min3_u32 v27,v27,v232,v236
v_rcp_f32 v89,v89
v_mfma_f32_16x16x32_bf16 v[76:79],a[232:235],v[232:235],v[76:79]
v_rcp_f32 v90,v90
v_mfma_f32_16x16x32_bf16 v[68:71],a[108:111],v[236:239],v[68:71]
v_rcp_f32 v91,v91
v_mfma_f32_16x16x32_bf16 v[76:79],a[236:239],v[236:239],v[76:79]
v_mul_f32 v88,v88,v64
s_waitcnt lgkmcnt(2)
v_mfma_f32_16x16x32_bf16 v[68:71],a[112:115],v[240:243],v[68:71]
v_min3_u32 v27,v27,v240,v244
v_mul_f32 v89,v89,v65
v_mfma_f32_16x16x32_bf16 v[76:79],a[240:243],v[240:243],v[76:79]
v_mul_f32 v90,v90,v66
v_mul_f32 v91,v91,v67
v_mfma_f32_16x16x32_bf16 v[68:71],a[116:119],v[244:247],v[68:71]
v_mul_f32 v94,v94,v74
v_mul_f32 v95,v95,v75
v_mfma_f32_16x16x32_bf16 v[76:79],a[244:247],v[244:247],v[76:79]
v_cvt_pk_bf16_f32 v96,v88,v89
s_waitcnt lgkmcnt(0)
v_mfma_f32_16x16x32_bf16 v[68:71],a[120:123],v[248:251],v[68:71]
v_min3_u32 v27,v27,v248,v252
v_cvt_pk_bf16_f32 v97,v90,v91
v_mfma_f32_16x16x32_bf16 v[76:79],a[248:251],v[248:251],v[76:79]
v_cvt_pk_bf16_f32 v98,v92,v93
v_cvt_pk_bf16_f32 v99,v94,v95
v_mfma_f32_16x16x32_bf16 v[68:71],a[124:127],v[252:255],v[68:71]
v_max_u32 v96,1,v96
v_mfma_f32_16x16x32_bf16 v[76:79],a[252:255],v[252:255],v[76:79]
buffer_store_dwordx4 v[96:99],v18,s[20:23],s70 offen offset:0 sc1
v_cmp_eq_u32 vcc,0,v27
s_cbranch_vccnz retry_377
s_branch epi_380
keep_389:
v_mfma_f32_16x16x32_bf16 v[64:67],a[124:127],v[252:255],v[64:67]
v_min3_u32 v27,v27,v248,v252
v_mfma_f32_16x16x32_bf16 v[72:75],a[252:255],v[252:255],v[72:75]
ds_read_b128 v[248:251],v17 offset:13312
s_waitcnt lgkmcnt(6)
v_mfma_f32_16x16x32_bf16 v[68:71],a[0:3],v[224:227],0
v_cmp_eq_u32 vcc,0,v27
s_cbranch_vccnz retry_377
v_mfma_f32_16x16x32_bf16 v[76:79],a[128:131],v[224:227],0
ds_read_b128 v[252:255],v17 offset:15360
v_min3_u32 v27,v27,v224,v228
v_mfma_f32_16x16x32_bf16 v[68:71],a[4:7],v[228:231],v[68:71]
s_waitcnt lgkmcnt(6)
v_mfma_f32_16x16x32_bf16 v[76:79],a[132:135],v[228:231],v[76:79]
ds_read_b128 v[224:227],v17 offset:17408
s_waitcnt lgkmcnt(5)
v_mfma_f32_16x16x32_bf16 v[68:71],a[8:11],v[232:235],v[68:71]
v_min3_u32 v27,v27,v232,v236
v_fmac_f32 v64,v52,v120
v_fmac_f32 v72,v56,v120
v_mfma_f32_16x16x32_bf16 v[76:79],a[136:139],v[232:235],v[76:79]
ds_read_b128 v[228:231],v17 offset:19456
v_fmac_f32 v65,v53,v120
v_fmac_f32 v73,v57,v120
v_mfma_f32_16x16x32_bf16 v[68:71],a[12:15],v[236:239],v[68:71]
v_fmac_f32 v66,v54,v120
v_fmac_f32 v67,v55,v120
v_fmac_f32 v74,v58,v120
v_mfma_f32_16x16x32_bf16 v[76:79],a[140:143],v[236:239],v[76:79]
ds_read_b128 v[232:235],v17 offset:21504
v_fmac_f32 v75,v59,v120
s_waitcnt lgkmcnt(5)
v_mfma_f32_16x16x32_bf16 v[68:71],a[16:19],v[240:243],v[68:71]
v_min3_u32 v27,v27,v240,v244
v_mul_f32 v88,v64,v64
v_mul_f32 v92,v72,v72
v_mfma_f32_16x16x32_bf16 v[76:79],a[144:147],v[240:243],v[76:79]
ds_read_b128 v[236:239],v17 offset:23552
v_mul_f32 v89,v65,v65
v_mul_f32 v93,v73,v73
v_mfma_f32_16x16x32_bf16 v[68:71],a[20:23],v[244:247],v[68:71]
v_mul_f32 v90,v66,v66
v_mul_f32 v91,v67,v67
v_mul_f32 v94,v74,v74
v_mfma_f32_16x16x32_bf16 v[76:79],a[148:151],v[244:247],v[76:79]
ds_read_b128 v[240:243],v17 offset:25600
v_mul_f32 v95,v75,v75
s_waitcnt lgkmcnt(5)
v_mfma_f32_16x16x32_bf16 v[68:71],a[24:27],v[248:251],v[68:71]
v_min3_u32 v27,v27,v248,v252
v_fma_f32 v88,v88,v121,v122
v_fma_f32 v92,v92,v121,v122
v_mfma_f32_16x16x32_bf16 v[76:79],a[152:155],v[248:251],v[76:79]
ds_read_b128 v[244:247],v17 offset:27648
v_fma_f32 v89,v89,v121,v122
v_fma_f32 v93,v93,v121,v122
v_mfma_f32_16x16x32_bf16 v[68:71],a[28:31],v[252:255],v[68:71]
v_fma_f32 v90,v90,v121,v122
v_fma_f32 v91,v91,v121,v122
v_fma_f32 v94,v94,v121,v122
v_mfma_f32_16x16x32_bf16 v[76:79],a[156:159],v[252:255],v[76:79]
ds_read_b128 v[248:251],v17 offset:29696
v_fma_f32 v95,v95,v121,v122
s_waitcnt lgkmcnt(5)
v_mfma_f32_16x16x32_bf16 v[68:71],a[32:35],v[224:227],v[68:71]
v_min3_u32 v27,v27,v224,v228
v_mul_f32 v88,v88,v64
v_mul_f32 v92,v92,v72
v_mfma_f32_16x16x32_bf16 v[76:79],a[160:163],v[224:227],v[76:79]
ds_read_b128 v[252:255],v17 offset:31744
v_mul_f32 v89,v89,v65
v_mul_f32 v93,v93,v73
v_mfma_f32_16x16x32_bf16 v[68:71],a[36:39],v[228:231],v[68:71]
v_mul_f32 v90,v90,v66
v_mul_f32 v91,v91,v67
v_mul_f32 v94,v94,v74
v_mfma_f32_16x16x32_bf16 v[76:79],a[164:167],v[228:231],v[76:79]
ds_read_b128 v[224:227],v17 offset:33792
v_mul_f32 v95,v95,v75
s_waitcnt lgkmcnt(5)
v_mfma_f32_16x16x32_bf16 v[68:71],a[40:43],v[232:235],v[68:71]
v_min3_u32 v27,v27,v232,v236
v_exp_f32 v92,v92
v_mfma_f32_16x16x32_bf16 v[76:79],a[168:171],v[232:235],v[76:79]
ds_read_b128 v[228:231],v17 offset:35840
v_exp_f32 v93,v93
v_mfma_f32_16x16x32_bf16 v[68:71],a[44:47],v[236:239],v[68:71]
v_exp_f32 v88,v88
v_mfma_f32_16x16x32_bf16 v[76:79],a[172:175],v[236:239],v[76:79]
ds_read_b128 v[232:235],v17 offset:37888
s_waitcnt lgkmcnt(5)
v_mfma_f32_16x16x32_bf16 v[68:71],a[48:51],v[240:243],v[68:71]
v_min3_u32 v27,v27,v240,v244
v_exp_f32 v94,v94
v_mfma_f32_16x16x32_bf16 v[76:79],a[176:179],v[240:243],v[76:79]
ds_read_b128 v[236:239],v17 offset:39936
v_exp_f32 v95,v95
v_mfma_f32_16x16x32_bf16 v[68:71],a[52:55],v[244:247],v[68:71]
v_exp_f32 v89,v89
v_fma_f32 v92,v92,v123,v123
v_mfma_f32_16x16x32_bf16 v[76:79],a[180:183],v[244:247],v[76:79]
ds_read_b128 v[240:243],v17 offset:41984
v_fma_f32 v93,v93,v123,v123
s_waitcnt lgkmcnt(5)
v_mfma_f32_16x16x32_bf16 v[68:71],a[56:59],v[248:251],v[68:71]
v_min3_u32 v27,v27,v248,v252
v_fma_f32 v94,v94,v123,v123
v_fma_f32 v95,v95,v123,v123
v_mfma_f32_16x16x32_bf16 v[76:79],a[184:187],v[248:251],v[76:79]
ds_read_b128 v[244:247],v17 offset:44032
v_rcp_f32 v92,v92
v_mfma_f32_16x16x32_bf16 v[68:71],a[60:63],v[252:255],v[68:71]
v_exp_f32 v90,v90
v_mfma_f32_16x16x32_bf16 v[76:79],a[188:191],v[252:255],v[76:79]
ds_read_b128 v[248:251],v17 offset:46080
s_waitcnt lgkmcnt(5)
v_mfma_f32_16x16x32_bf16 v[68:71],a[64:67],v[224:227],v[68:71]
v_min3_u32 v27,v27,v224,v228
v_rcp_f32 v93,v93
v_mfma_f32_16x16x32_bf16 v[76:79],a[192:195],v[224:227],v[76:79]
ds_read_b128 v[252:255],v17 offset:48128
v_rcp_f32 v94,v94
v_mfma_f32_16x16x32_bf16 v[68:71],a[68:71],v[228:231],v[68:71]
v_exp_f32 v91,v91
v_mfma_f32_16x16x32_bf16 v[76:79],a[196:199],v[228:231],v[76:79]
ds_read_b128 v[224:227],v17 offset:50176
s_waitcnt lgkmcnt(5)
v_mfma_f32_16x16x32_bf16 v[68:71],a[72:75],v[232:235],v[68:71]
v_min3_u32 v27,v27,v232,v236
v_fma_f32 v88,v88,v123,v123
v_mfma_f32_16x16x32_bf16 v[76:79],a[200:203],v[232:235],v[76:79]
ds_read_b128 v[228:231],v17 offset:52224
v_fma_f32 v89,v89,v123,v123
v_mfma_f32_16x16x32_bf16 v[68:71],a[76:79],v[236:239],v[68:71]
v_fma_f32 v90,v90,v123,v123
v_fma_f32 v91,v91,v123,v123
v_mfma_f32_16x16x32_bf16 v[76:79],a[204:207],v[236:239],v[76:79]
ds_read_b128 v[232:235],v17 offset:54272
s_waitcnt lgkmcnt(5)
v_mfma_f32_16x16x32_bf16 v[68:71],a[80:83],v[240:243],v[68:71]
v_min3_u32 v27,v27,v240,v244
v_rcp_f32 v95,v95
v_mfma_f32_16x16x32_bf16 v[76:79],a[208:211],v[240:243],v[76:79]
ds_read_b128 v[236:239],v17 offset:56320
v_mul_f32 v92,v92,v72
v_mfma_f32_16x16x32_bf16 v[68:71],a[84:87],v[244:247],v[68:71]
v_rcp_f32 v88,v88
v_mfma_f32_16x16x32_bf16 v[76:79],a[212:215],v[244:247],v[76:79]
ds_read_b128 v[240:243],v17 offset:58368
s_waitcnt lgkmcnt(5)
v_mfma_f32_16x16x32_bf16 v[68:71],a[88:91],v[248:251],v[68:71]
v_min3_u32 v27,v27,v248,v252
v_mul_f32 v93,v93,v73
v_mfma_f32_16x16x32_bf16 v[76:79],a[216:219],v[248:251],v[76:79]
ds_read_b128 v[244:247],v17 offset:60416
v_mul_f32 v94,v94,v74
v_mfma_f32_16x16x32_bf16 v[68:71],a[92:95],v[252:255],v[68:71]
v_rcp_f32 v89,v89
v_mfma_f32_16x16x32_bf16 v[76:79],a[220:223],v[252:255],v[76:79]
ds_read_b128 v[248:251],v17 offset:62464
s_waitcnt lgkmcnt(5)
v_mfma_f32_16x16x32_bf16 v[68:71],a[96:99],v[224:227],v[68:71]
v_min3_u32 v27,v27,v224,v228
v_mul_f32 v95,v95,v75
v_mfma_f32_16x16x32_bf16 v[76:79],a[224:227],v[224:227],v[76:79]
ds_read_b128 v[252:255],v17 offset:64512
v_mfma_f32_16x16x32_bf16 v[68:71],a[100:103],v[228:231],v[68:71]
v_rcp_f32 v90,v90
v_mfma_f32_16x16x32_bf16 v[76:79],a[228:231],v[228:231],v[76:79]
s_waitcnt lgkmcnt(4)
v_mfma_f32_16x16x32_bf16 v[68:71],a[104:107],v[232:235],v[68:71]
v_min3_u32 v27,v27,v232,v236
v_mfma_f32_16x16x32_bf16 v[76:79],a[232:235],v[232:235],v[76:79]
v_rcp_f32 v91,v91
v_mfma_f32_16x16x32_bf16 v[68:71],a[108:111],v[236:239],v[68:71]
v_mul_f32 v88,v88,v64
v_mul_f32 v89,v89,v65
v_mfma_f32_16x16x32_bf16 v[76:79],a[236:239],v[236:239],v[76:79]
v_mul_f32 v90,v90,v66
s_waitcnt lgkmcnt(2)
v_mfma_f32_16x16x32_bf16 v[68:71],a[112:115],v[240:243],v[68:71]
v_min3_u32 v27,v27,v240,v244
v_mul_f32 v91,v91,v67
v_mfma_f32_16x16x32_bf16 v[76:79],a[240:243],v[240:243],v[76:79]
v_cvt_pk_bf16_f32 v96,v88,v89
v_cvt_pk_bf16_f32 v97,v90,v91
v_mfma_f32_16x16x32_bf16 v[68:71],a[116:119],v[244:247],v[68:71]
v_cvt_pk_bf16_f32 v98,v92,v93
v_cvt_pk_bf16_f32 v99,v94,v95
v_mfma_f32_16x16x32_bf16 v[76:79],a[244:247],v[244:247],v[76:79]
v_max_u32 v96,1,v96
s_waitcnt lgkmcnt(0)
v_mfma_f32_16x16x32_bf16 v[68:71],a[120:123],v[248:251],v[68:71]
v_min3_u32 v27,v27,v248,v252
v_mfma_f32_16x16x32_bf16 v[76:79],a[248:251],v[248:251],v[76:79]
buffer_store_dwordx4 v[96:99],v18,s[20:23],s70 offen offset:0 sc1
v_mfma_f32_16x16x32_bf16 v[68:71],a[124:127],v[252:255],v[68:71]
v_mfma_f32_16x16x32_bf16 v[76:79],a[252:255],v[252:255],v[76:79]
v_cmp_eq_u32 vcc,0,v27
s_cbranch_vccnz retry_377
s_branch epi_380
both_381:
s_waitcnt vmcnt(12) lgkmcnt(0)
s_barrier
ds_read_b128 v[224:227],v17 offset:0
ds_read_b128 v[228:231],v17 offset:2048
ds_read_b128 v[232:235],v17 offset:4096
ds_read_b128 v[236:239],v17 offset:6144
ds_read_b128 v[240:243],v17 offset:8192
ds_read_b128 v[244:247],v17 offset:10240
ds_read_b128 v[248:251],v17 offset:12288
s_waitcnt lgkmcnt(5)
v_mfma_f32_16x16x32_bf16 v[64:67],a[0:3],v[224:227],0
s_add_u32 s96,s71,1
s_add_u32 s92,s71,2
s_add_u32 s88,s70,s75
v_mfma_f32_16x16x32_bf16 v[72:75],a[128:131],v[224:227],0
ds_read_b128 v[252:255],v17 offset:14336
s_add_u32 s88,s88,2097152
s_xor_b32 s88,s88,0x2000
v_mfma_f32_16x16x32_bf16 v[64:67],a[4:7],v[228:231],v[64:67]
s_cmp_eq_u32 s96,64
s_cselect_b32 s96,99,s96
v_min_u32 v27,v224,v228
v_mfma_f32_16x16x32_bf16 v[72:75],a[132:135],v[228:231],v[72:75]
ds_read_b128 v[224:227],v17 offset:16384
s_waitcnt lgkmcnt(5)
v_mfma_f32_16x16x32_bf16 v[64:67],a[8:11],v[232:235],v[64:67]
s_cmp_eq_u32 s92,64
s_cselect_b32 s92,99,s92
v_mfma_f32_16x16x32_bf16 v[72:75],a[136:139],v[232:235],v[72:75]
ds_read_b128 v[228:231],v17 offset:18432
s_xor_b32 s89,s88,1024
v_mfma_f32_16x16x32_bf16 v[64:67],a[12:15],v[236:239],v[64:67]
s_xor_b32 m0,s72,0
v_min3_u32 v27,v27,v232,v236
v_mfma_f32_16x16x32_bf16 v[72:75],a[140:143],v[236:239],v[72:75]
ds_read_b128 v[232:235],v17 offset:20480
s_add_u32 s65,s88,0
s_waitcnt lgkmcnt(5)
v_mfma_f32_16x16x32_bf16 v[64:67],a[16:19],v[240:243],v[64:67]
v_min3_u32 v27,v27,v240,v244
v_mfma_f32_16x16x32_bf16 v[72:75],a[144:147],v[240:243],v[72:75]
ds_read_b128 v[236:239],v17 offset:22528
buffer_load_dwordx4 v16,s[20:23],s65 offen offset:0 sc1 lds
v_mfma_f32_16x16x32_bf16 v[64:67],a[20:23],v[244:247],v[64:67]
buffer_load_dwordx4 v16,s[20:23],s65 offen offset:2048 sc1 lds
v_mfma_f32_16x16x32_bf16 v[72:75],a[148:151],v[244:247],v[72:75]
ds_read_b128 v[240:243],v17 offset:24576
s_waitcnt lgkmcnt(5)
v_mfma_f32_16x16x32_bf16 v[64:67],a[24:27],v[248:251],v[64:67]
s_xor_b32 m0,s72,16384
v_min3_u32 v27,v27,v248,v252
v_mfma_f32_16x16x32_bf16 v[72:75],a[152:155],v[248:251],v[72:75]
ds_read_b128 v[244:247],v17 offset:26624
v_mfma_f32_16x16x32_bf16 v[64:67],a[28:31],v[252:255],v[64:67]
s_add_u32 s65,s88,32768
v_mfma_f32_16x16x32_bf16 v[72:75],a[156:159],v[252:255],v[72:75]
ds_read_b128 v[248:251],v17 offset:28672
s_waitcnt lgkmcnt(5)
v_mfma_f32_16x16x32_bf16 v[64:67],a[32:35],v[224:227],v[64:67]
buffer_load_dwordx4 v16,s[20:23],s65 offen offset:0 sc1 lds
v_mfma_f32_16x16x32_bf16 v[72:75],a[160:163],v[224:227],v[72:75]
ds_read_b128 v[252:255],v17 offset:30720
buffer_load_dwordx4 v16,s[20:23],s65 offen offset:2048 sc1 lds
v_mfma_f32_16x16x32_bf16 v[64:67],a[36:39],v[228:231],v[64:67]
v_min3_u32 v27,v27,v224,v228
v_mfma_f32_16x16x32_bf16 v[72:75],a[164:167],v[228:231],v[72:75]
ds_read_b128 v[224:227],v17 offset:32768
s_xor_b32 m0,s72,32768
s_waitcnt lgkmcnt(5)
v_mfma_f32_16x16x32_bf16 v[64:67],a[40:43],v[232:235],v[64:67]
s_add_u32 s65,s88,65536
v_min3_u32 v27,v27,v232,v236
v_mfma_f32_16x16x32_bf16 v[72:75],a[168:171],v[232:235],v[72:75]
ds_read_b128 v[228:231],v17 offset:34816
v_mfma_f32_16x16x32_bf16 v[64:67],a[44:47],v[236:239],v[64:67]
buffer_load_dwordx4 v16,s[20:23],s65 offen offset:0 sc1 lds
v_mfma_f32_16x16x32_bf16 v[72:75],a[172:175],v[236:239],v[72:75]
ds_read_b128 v[232:235],v17 offset:36864
s_waitcnt lgkmcnt(5)
v_mfma_f32_16x16x32_bf16 v[64:67],a[48:51],v[240:243],v[64:67]
buffer_load_dwordx4 v16,s[20:23],s65 offen offset:2048 sc1 lds
v_mfma_f32_16x16x32_bf16 v[72:75],a[176:179],v[240:243],v[72:75]
ds_read_b128 v[236:239],v17 offset:38912
s_xor_b32 m0,s72,49152
v_mfma_f32_16x16x32_bf16 v[64:67],a[52:55],v[244:247],v[64:67]
v_min3_u32 v27,v27,v240,v244
v_mfma_f32_16x16x32_bf16 v[72:75],a[180:183],v[244:247],v[72:75]
ds_read_b128 v[240:243],v17 offset:40960
s_add_u32 s65,s88,98304
s_waitcnt lgkmcnt(5)
v_mfma_f32_16x16x32_bf16 v[64:67],a[56:59],v[248:251],v[64:67]
buffer_load_dwordx4 v16,s[20:23],s65 offen offset:0 sc1 lds
v_min3_u32 v27,v27,v248,v252
v_mfma_f32_16x16x32_bf16 v[72:75],a[184:187],v[248:251],v[72:75]
ds_read_b128 v[244:247],v17 offset:43008
s_waitcnt vmcnt(9)
v_mfma_f32_16x16x32_bf16 v[64:67],a[60:63],v[252:255],v[64:67]
v_cmp_gt_u32 vcc,s96,v29
v_cmp_gt_u32 s[92:93],s92,v29
v_mfma_f32_16x16x32_bf16 v[72:75],a[188:191],v[252:255],v[72:75]
ds_read_b128 v[248:251],v17 offset:45056
s_waitcnt lgkmcnt(5)
v_mfma_f32_16x16x32_bf16 v[64:67],a[64:67],v[224:227],v[64:67]
v_mov_b32 v44,vcc_lo
v_mov_b32 v45,s92
v_min3_u32 v27,v27,v224,v228
v_mfma_f32_16x16x32_bf16 v[72:75],a[192:195],v[224:227],v[72:75]
ds_read_b128 v[252:255],v17 offset:47104
ds_write_b64 v46,v[44:45]
v_mfma_f32_16x16x32_bf16 v[64:67],a[68:71],v[228:231],v[64:67]
buffer_load_dwordx4 v16,s[20:23],s65 offen offset:2048 sc1 lds
v_mfma_f32_16x16x32_bf16 v[72:75],a[196:199],v[228:231],v[72:75]
ds_read_b128 v[224:227],v17 offset:49152
s_waitcnt lgkmcnt(6)
v_mfma_f32_16x16x32_bf16 v[64:67],a[72:75],v[232:235],v[64:67]
s_xor_b32 m0,s72,1024
s_add_u32 s65,s89,0
v_mfma_f32_16x16x32_bf16 v[72:75],a[200:203],v[232:235],v[72:75]
ds_read_b128 v[228:231],v17 offset:51200
v_min3_u32 v27,v27,v232,v236
v_mfma_f32_16x16x32_bf16 v[64:67],a[76:79],v[236:239],v[64:67]
buffer_load_dwordx4 v16,s[20:23],s65 offen offset:0 sc1 lds
v_mfma_f32_16x16x32_bf16 v[72:75],a[204:207],v[236:239],v[72:75]
ds_read_b128 v[232:235],v17 offset:53248
s_waitcnt lgkmcnt(6)
v_mfma_f32_16x16x32_bf16 v[64:67],a[80:83],v[240:243],v[64:67]
buffer_load_dwordx4 v16,s[20:23],s65 offen offset:2048 sc1 lds
v_mfma_f32_16x16x32_bf16 v[72:75],a[208:211],v[240:243],v[72:75]
ds_read_b128 v[236:239],v17 offset:55296
s_xor_b32 m0,s72,17408
v_mfma_f32_16x16x32_bf16 v[64:67],a[84:87],v[244:247],v[64:67]
s_add_u32 s65,s89,32768
v_min3_u32 v27,v27,v240,v244
v_mfma_f32_16x16x32_bf16 v[72:75],a[212:215],v[244:247],v[72:75]
ds_read_b128 v[240:243],v17 offset:57344
s_waitcnt lgkmcnt(6)
v_mfma_f32_16x16x32_bf16 v[64:67],a[88:91],v[248:251],v[64:67]
buffer_load_dwordx4 v16,s[20:23],s65 offen offset:0 sc1 lds
v_mfma_f32_16x16x32_bf16 v[72:75],a[216:219],v[248:251],v[72:75]
ds_read_b128 v[244:247],v17 offset:59392
v_min3_u32 v27,v27,v248,v252
v_mfma_f32_16x16x32_bf16 v[64:67],a[92:95],v[252:255],v[64:67]
buffer_load_dwordx4 v16,s[20:23],s65 offen offset:2048 sc1 lds
v_mfma_f32_16x16x32_bf16 v[72:75],a[220:223],v[252:255],v[72:75]
ds_read_b128 v[248:251],v17 offset:61440
s_waitcnt lgkmcnt(5)
v_mfma_f32_16x16x32_bf16 v[64:67],a[96:99],v[224:227],v[64:67]
s_xor_b32 m0,s72,33792
s_add_u32 s65,s89,65536
v_mfma_f32_16x16x32_bf16 v[72:75],a[224:227],v[224:227],v[72:75]
ds_read_b128 v[252:255],v17 offset:63488
v_min3_u32 v27,v27,v224,v228
v_mfma_f32_16x16x32_bf16 v[64:67],a[100:103],v[228:231],v[64:67]
buffer_load_dwordx4 v16,s[20:23],s65 offen offset:0 sc1 lds
s_waitcnt vmcnt(13)
v_add_u32 v22,s71,-1
v_mfma_f32_16x16x32_bf16 v[72:75],a[228:231],v[228:231],v[72:75]
s_waitcnt vmcnt(17)
s_barrier
ds_read_b64 v[44:45],v47
ds_read_b128 v[224:227],v17 offset:1024
s_waitcnt lgkmcnt(6)
v_mfma_f32_16x16x32_bf16 v[64:67],a[104:107],v[232:235],v[64:67]
buffer_load_dwordx4 v16,s[20:23],s65 offen offset:2048 sc1 lds
buffer_store_dword v22,v23,s[20:23],s97 offen sc1
v_mfma_f32_16x16x32_bf16 v[72:75],a[232:235],v[232:235],v[72:75]
ds_read_b128 v[228:231],v17 offset:3072
s_xor_b32 m0,s72,50176
s_mov_b32 s97,0x7fff0000
v_mfma_f32_16x16x32_bf16 v[64:67],a[108:111],v[236:239],v[64:67]
s_add_u32 s65,s89,98304
v_min3_u32 v27,v27,v232,v236
ds_read_b128 v[124:127],v19 offset:256
v_mfma_f32_16x16x32_bf16 v[72:75],a[236:239],v[236:239],v[72:75]
ds_read_b128 v[232:235],v17 offset:5120
ds_read_b128 v[120:123],v19 offset:0
s_waitcnt lgkmcnt(8)
v_mfma_f32_16x16x32_bf16 v[64:67],a[112:115],v[240:243],v[64:67]
buffer_load_dwordx4 v16,s[20:23],s65 offen offset:0 sc1 lds
v_mfma_f32_16x16x32_bf16 v[72:75],a[240:243],v[240:243],v[72:75]
ds_read_b128 v[236:239],v17 offset:7168
v_min3_u32 v27,v27,v240,v244
v_mfma_f32_16x16x32_bf16 v[64:67],a[116:119],v[244:247],v[64:67]
buffer_load_dwordx4 v16,s[20:23],s65 offen offset:2048 sc1 lds
v_mfma_f32_16x16x32_bf16 v[72:75],a[244:247],v[244:247],v[72:75]
ds_read_b128 v[240:243],v17 offset:9216
s_waitcnt lgkmcnt(8)
v_mfma_f32_16x16x32_bf16 v[64:67],a[120:123],v[248:251],v[64:67]
s_waitcnt lgkmcnt(7)
v_readfirstlane_b32 s93,v45
v_mfma_f32_16x16x32_bf16 v[72:75],a[248:251],v[248:251],v[72:75]
ds_read_b128 v[244:247],v17 offset:11264
v_min3_u32 v27,v27,v248,v252
v_mfma_f32_16x16x32_bf16 v[64:67],a[124:127],v[252:255],v[64:67]
v_mfma_f32_16x16x32_bf16 v[72:75],a[252:255],v[252:255],v[72:75]
ds_read_b128 v[248:251],v17 offset:13312
s_waitcnt lgkmcnt(7)
v_mfma_f32_16x16x32_bf16 v[68:71],a[0:3],v[224:227],0
v_cmp_eq_u32 vcc,0,v27
s_cbranch_vccnz retry_377
v_mfma_f32_16x16x32_bf16 v[76:79],a[128:131],v[224:227],0
ds_read_b128 v[252:255],v17 offset:15360
v_min3_u32 v27,v27,v224,v228
v_mfma_f32_16x16x32_bf16 v[68:71],a[4:7],v[228:231],v[68:71]
s_waitcnt lgkmcnt(5)
v_mfma_f32_16x16x32_bf16 v[76:79],a[132:135],v[228:231],v[76:79]
ds_read_b128 v[224:227],v17 offset:17408
s_waitcnt lgkmcnt(5)
v_mfma_f32_16x16x32_bf16 v[68:71],a[8:11],v[232:235],v[68:71]
v_min3_u32 v27,v27,v232,v236
v_fmac_f32 v64,v52,v120
v_fmac_f32 v72,v56,v120
v_mfma_f32_16x16x32_bf16 v[76:79],a[136:139],v[232:235],v[76:79]
ds_read_b128 v[228:231],v17 offset:19456
v_fmac_f32 v65,v53,v120
v_fmac_f32 v73,v57,v120
v_mfma_f32_16x16x32_bf16 v[68:71],a[12:15],v[236:239],v[68:71]
v_fmac_f32 v66,v54,v120
v_fmac_f32 v67,v55,v120
v_fmac_f32 v74,v58,v120
v_mfma_f32_16x16x32_bf16 v[76:79],a[140:143],v[236:239],v[76:79]
ds_read_b128 v[232:235],v17 offset:21504
v_fmac_f32 v75,v59,v120
s_waitcnt lgkmcnt(5)
v_mfma_f32_16x16x32_bf16 v[68:71],a[16:19],v[240:243],v[68:71]
v_min3_u32 v27,v27,v240,v244
v_mul_f32 v88,v64,v64
v_mul_f32 v92,v72,v72
v_mfma_f32_16x16x32_bf16 v[76:79],a[144:147],v[240:243],v[76:79]
ds_read_b128 v[236:239],v17 offset:23552
v_mul_f32 v89,v65,v65
v_mul_f32 v93,v73,v73
v_mfma_f32_16x16x32_bf16 v[68:71],a[20:23],v[244:247],v[68:71]
v_mul_f32 v90,v66,v66
v_mul_f32 v91,v67,v67
v_mul_f32 v94,v74,v74
v_mfma_f32_16x16x32_bf16 v[76:79],a[148:151],v[244:247],v[76:79]
ds_read_b128 v[240:243],v17 offset:25600
v_mul_f32 v95,v75,v75
s_waitcnt lgkmcnt(5)
v_mfma_f32_16x16x32_bf16 v[68:71],a[24:27],v[248:251],v[68:71]
v_min3_u32 v27,v27,v248,v252
v_fma_f32 v88,v88,v121,v122
v_fma_f32 v92,v92,v121,v122
v_mfma_f32_16x16x32_bf16 v[76:79],a[152:155],v[248:251],v[76:79]
ds_read_b128 v[244:247],v17 offset:27648
v_fma_f32 v89,v89,v121,v122
v_fma_f32 v93,v93,v121,v122
v_mfma_f32_16x16x32_bf16 v[68:71],a[28:31],v[252:255],v[68:71]
v_fma_f32 v90,v90,v121,v122
v_fma_f32 v91,v91,v121,v122
v_fma_f32 v94,v94,v121,v122
v_mfma_f32_16x16x32_bf16 v[76:79],a[156:159],v[252:255],v[76:79]
ds_read_b128 v[248:251],v17 offset:29696
v_fma_f32 v95,v95,v121,v122
s_waitcnt lgkmcnt(5)
v_mfma_f32_16x16x32_bf16 v[68:71],a[32:35],v[224:227],v[68:71]
v_min3_u32 v27,v27,v224,v228
v_mul_f32 v88,v88,v64
v_mul_f32 v92,v92,v72
v_mfma_f32_16x16x32_bf16 v[76:79],a[160:163],v[224:227],v[76:79]
ds_read_b128 v[252:255],v17 offset:31744
v_mul_f32 v89,v89,v65
v_mul_f32 v93,v93,v73
v_mfma_f32_16x16x32_bf16 v[68:71],a[36:39],v[228:231],v[68:71]
v_mul_f32 v90,v90,v66
v_mul_f32 v91,v91,v67
v_mul_f32 v94,v94,v74
v_mfma_f32_16x16x32_bf16 v[76:79],a[164:167],v[228:231],v[76:79]
ds_read_b128 v[224:227],v17 offset:33792
v_mul_f32 v95,v95,v75
s_waitcnt lgkmcnt(5)
v_mfma_f32_16x16x32_bf16 v[68:71],a[40:43],v[232:235],v[68:71]
v_min3_u32 v27,v27,v232,v236
v_exp_f32 v92,v92
v_mfma_f32_16x16x32_bf16 v[76:79],a[168:171],v[232:235],v[76:79]
ds_read_b128 v[228:231],v17 offset:35840
v_exp_f32 v93,v93
v_mfma_f32_16x16x32_bf16 v[68:71],a[44:47],v[236:239],v[68:71]
v_exp_f32 v88,v88
v_mfma_f32_16x16x32_bf16 v[76:79],a[172:175],v[236:239],v[76:79]
ds_read_b128 v[232:235],v17 offset:37888
s_waitcnt lgkmcnt(5)
v_mfma_f32_16x16x32_bf16 v[68:71],a[48:51],v[240:243],v[68:71]
v_min3_u32 v27,v27,v240,v244
v_exp_f32 v94,v94
v_mfma_f32_16x16x32_bf16 v[76:79],a[176:179],v[240:243],v[76:79]
ds_read_b128 v[236:239],v17 offset:39936
v_exp_f32 v95,v95
v_mfma_f32_16x16x32_bf16 v[68:71],a[52:55],v[244:247],v[68:71]
v_exp_f32 v89,v89
v_fma_f32 v92,v92,v123,v123
v_mfma_f32_16x16x32_bf16 v[76:79],a[180:183],v[244:247],v[76:79]
ds_read_b128 v[240:243],v17 offset:41984
v_fma_f32 v93,v93,v123,v123
s_waitcnt lgkmcnt(5)
v_mfma_f32_16x16x32_bf16 v[68:71],a[56:59],v[248:251],v[68:71]
v_min3_u32 v27,v27,v248,v252
v_fma_f32 v94,v94,v123,v123
v_fma_f32 v95,v95,v123,v123
v_mfma_f32_16x16x32_bf16 v[76:79],a[184:187],v[248:251],v[76:79]
ds_read_b128 v[244:247],v17 offset:44032
v_rcp_f32 v92,v92
v_mfma_f32_16x16x32_bf16 v[68:71],a[60:63],v[252:255],v[68:71]
v_exp_f32 v90,v90
v_mfma_f32_16x16x32_bf16 v[76:79],a[188:191],v[252:255],v[76:79]
ds_read_b128 v[248:251],v17 offset:46080
s_waitcnt lgkmcnt(5)
v_mfma_f32_16x16x32_bf16 v[68:71],a[64:67],v[224:227],v[68:71]
v_min3_u32 v27,v27,v224,v228
v_rcp_f32 v93,v93
v_mfma_f32_16x16x32_bf16 v[76:79],a[192:195],v[224:227],v[76:79]
ds_read_b128 v[252:255],v17 offset:48128
v_rcp_f32 v94,v94
v_mfma_f32_16x16x32_bf16 v[68:71],a[68:71],v[228:231],v[68:71]
v_exp_f32 v91,v91
v_mfma_f32_16x16x32_bf16 v[76:79],a[196:199],v[228:231],v[76:79]
ds_read_b128 v[224:227],v17 offset:50176
s_waitcnt lgkmcnt(5)
v_mfma_f32_16x16x32_bf16 v[68:71],a[72:75],v[232:235],v[68:71]
v_min3_u32 v27,v27,v232,v236
v_fma_f32 v88,v88,v123,v123
v_mfma_f32_16x16x32_bf16 v[76:79],a[200:203],v[232:235],v[76:79]
ds_read_b128 v[228:231],v17 offset:52224
v_fma_f32 v89,v89,v123,v123
v_mfma_f32_16x16x32_bf16 v[68:71],a[76:79],v[236:239],v[68:71]
v_fma_f32 v90,v90,v123,v123
v_fma_f32 v91,v91,v123,v123
v_mfma_f32_16x16x32_bf16 v[76:79],a[204:207],v[236:239],v[76:79]
ds_read_b128 v[232:235],v17 offset:54272
s_waitcnt lgkmcnt(5)
v_mfma_f32_16x16x32_bf16 v[68:71],a[80:83],v[240:243],v[68:71]
v_min3_u32 v27,v27,v240,v244
v_rcp_f32 v95,v95
v_mfma_f32_16x16x32_bf16 v[76:79],a[208:211],v[240:243],v[76:79]
ds_read_b128 v[236:239],v17 offset:56320
v_mul_f32 v92,v92,v72
v_mfma_f32_16x16x32_bf16 v[68:71],a[84:87],v[244:247],v[68:71]
v_rcp_f32 v88,v88
v_mfma_f32_16x16x32_bf16 v[76:79],a[212:215],v[244:247],v[76:79]
ds_read_b128 v[240:243],v17 offset:58368
s_waitcnt lgkmcnt(5)
v_mfma_f32_16x16x32_bf16 v[68:71],a[88:91],v[248:251],v[68:71]
v_min3_u32 v27,v27,v248,v252
v_mul_f32 v93,v93,v73
v_mfma_f32_16x16x32_bf16 v[76:79],a[216:219],v[248:251],v[76:79]
ds_read_b128 v[244:247],v17 offset:60416
v_mul_f32 v94,v94,v74
v_mfma_f32_16x16x32_bf16 v[68:71],a[92:95],v[252:255],v[68:71]
v_rcp_f32 v89,v89
v_mfma_f32_16x16x32_bf16 v[76:79],a[220:223],v[252:255],v[76:79]
ds_read_b128 v[248:251],v17 offset:62464
s_waitcnt lgkmcnt(5)
v_mfma_f32_16x16x32_bf16 v[68:71],a[96:99],v[224:227],v[68:71]
v_min3_u32 v27,v27,v224,v228
v_mul_f32 v95,v95,v75
v_mfma_f32_16x16x32_bf16 v[76:79],a[224:227],v[224:227],v[76:79]
ds_read_b128 v[252:255],v17 offset:64512
v_mfma_f32_16x16x32_bf16 v[68:71],a[100:103],v[228:231],v[68:71]
v_rcp_f32 v90,v90
v_mfma_f32_16x16x32_bf16 v[76:79],a[228:231],v[228:231],v[76:79]
s_waitcnt lgkmcnt(4)
v_mfma_f32_16x16x32_bf16 v[68:71],a[104:107],v[232:235],v[68:71]
v_min3_u32 v27,v27,v232,v236
v_mfma_f32_16x16x32_bf16 v[76:79],a[232:235],v[232:235],v[76:79]
v_rcp_f32 v91,v91
v_mfma_f32_16x16x32_bf16 v[68:71],a[108:111],v[236:239],v[68:71]
v_mul_f32 v88,v88,v64
v_mul_f32 v89,v89,v65
v_mfma_f32_16x16x32_bf16 v[76:79],a[236:239],v[236:239],v[76:79]
v_mul_f32 v90,v90,v66
s_waitcnt lgkmcnt(2)
v_mfma_f32_16x16x32_bf16 v[68:71],a[112:115],v[240:243],v[68:71]
v_min3_u32 v27,v27,v240,v244
v_mul_f32 v91,v91,v67
v_mfma_f32_16x16x32_bf16 v[76:79],a[240:243],v[240:243],v[76:79]
v_cvt_pk_bf16_f32 v96,v88,v89
v_cvt_pk_bf16_f32 v97,v90,v91
v_mfma_f32_16x16x32_bf16 v[68:71],a[116:119],v[244:247],v[68:71]
v_cvt_pk_bf16_f32 v98,v92,v93
v_cvt_pk_bf16_f32 v99,v94,v95
v_mfma_f32_16x16x32_bf16 v[76:79],a[244:247],v[244:247],v[76:79]
v_max_u32 v96,1,v96
s_waitcnt lgkmcnt(0)
v_mfma_f32_16x16x32_bf16 v[68:71],a[120:123],v[248:251],v[68:71]
v_min3_u32 v27,v27,v248,v252
v_mfma_f32_16x16x32_bf16 v[76:79],a[248:251],v[248:251],v[76:79]
buffer_store_dwordx4 v[96:99],v18,s[20:23],s70 offen offset:0 sc1
v_mfma_f32_16x16x32_bf16 v[68:71],a[124:127],v[252:255],v[68:71]
v_mfma_f32_16x16x32_bf16 v[76:79],a[252:255],v[252:255],v[76:79]
v_cmp_eq_u32 vcc,0,v27
s_cbranch_vccnz retry_377
epi_380:
buffer_load_dword v29,v21,s[20:23],s87 offen sc1
s_nop 3
v_pk_fma_f32 v[68:69],v[52:53],v[124:125],v[68:69] op_sel_hi:[1,0,1]
v_pk_fma_f32 v[70:71],v[54:55],v[124:125],v[70:71] op_sel_hi:[1,0,1]
v_pk_fma_f32 v[76:77],v[56:57],v[124:125],v[76:77] op_sel_hi:[1,0,1]
v_pk_fma_f32 v[78:79],v[58:59],v[124:125],v[78:79] op_sel_hi:[1,0,1]
v_pk_mul_f32 v[88:89],v[68:69],v[68:69]
v_pk_mul_f32 v[90:91],v[70:71],v[70:71]
v_pk_mul_f32 v[92:93],v[76:77],v[76:77]
v_pk_mul_f32 v[94:95],v[78:79],v[78:79]
v_pk_fma_f32 v[88:89],v[88:89],v[124:125],v[126:127] op_sel:[0,1,0] op_sel_hi:[1,1,0]
v_pk_fma_f32 v[90:91],v[90:91],v[124:125],v[126:127] op_sel:[0,1,0] op_sel_hi:[1,1,0]
v_pk_fma_f32 v[92:93],v[92:93],v[124:125],v[126:127] op_sel:[0,1,0] op_sel_hi:[1,1,0]
v_pk_fma_f32 v[94:95],v[94:95],v[124:125],v[126:127] op_sel:[0,1,0] op_sel_hi:[1,1,0]
v_pk_mul_f32 v[88:89],v[88:89],v[68:69]
v_pk_mul_f32 v[90:91],v[90:91],v[70:71]
v_pk_mul_f32 v[92:93],v[92:93],v[76:77]
v_pk_mul_f32 v[94:95],v[94:95],v[78:79]
v_exp_f32 v88,v88
v_exp_f32 v89,v89
v_exp_f32 v90,v90
v_exp_f32 v91,v91
v_exp_f32 v92,v92
v_exp_f32 v93,v93
v_exp_f32 v94,v94
s_cmp_gt_u32 s71,40
s_cselect_b32 s65,s73,0x7fff0000
s_cselect_b32 s97,0x7fff0000,s73
v_mov_b32 v22,s71
buffer_store_dword v22,v23,s[20:23],s65 offen sc1
v_exp_f32 v95,v95
v_pk_fma_f32 v[88:89],v[88:89],v[126:127],v[126:127] op_sel:[0,1,1] op_sel_hi:[1,1,1]
v_pk_fma_f32 v[90:91],v[90:91],v[126:127],v[126:127] op_sel:[0,1,1] op_sel_hi:[1,1,1]
v_pk_fma_f32 v[92:93],v[92:93],v[126:127],v[126:127] op_sel:[0,1,1] op_sel_hi:[1,1,1]
v_pk_fma_f32 v[94:95],v[94:95],v[126:127],v[126:127] op_sel:[0,1,1] op_sel_hi:[1,1,1]
v_rcp_f32 v88,v88
v_rcp_f32 v89,v89
v_rcp_f32 v90,v90
v_rcp_f32 v91,v91
v_rcp_f32 v92,v92
v_rcp_f32 v93,v93
v_rcp_f32 v94,v94
v_rcp_f32 v95,v95
v_pk_mul_f32 v[88:89],v[88:89],v[68:69]
v_pk_mul_f32 v[90:91],v[90:91],v[70:71]
v_pk_mul_f32 v[92:93],v[92:93],v[76:77]
v_pk_mul_f32 v[94:95],v[94:95],v[78:79]
v_cvt_pk_bf16_f32 v96,v88,v89
v_cvt_pk_bf16_f32 v97,v90,v91
v_cvt_pk_bf16_f32 v98,v92,v93
v_cvt_pk_bf16_f32 v99,v94,v95
v_max_u32 v96,1,v96
buffer_store_dwordx4 v[96:99],v18,s[20:23],s70 offen offset:1024 sc1
next_387:
v_xor_b32 v17,0x10000,v17
s_xor_b32 s72,s72,0x10000
s_add_u32 s70,s70,2097152
s_xor_b32 s70,s70,0x2000
s_add_u32 s71,s71,1
s_cmp_le_u32 s71,s57
s_cbranch_scc1 seg_378
s_endpgm
retry_377:
s_sub_u32 s90,s90,64
s_cmp_lt_i32 s90,0
s_cbranch_scc1 giveup_197
s_mov_b32 s83,1
s_waitcnt vmcnt(0) lgkmcnt(0)
s_barrier
s_branch seg_378
half_386:
s_mov_b64 exec,s[52:53]
s_xor_b32 m0,s91,0
s_add_u32 s65,s94,0
buffer_load_dwordx4 v16,s[20:23],s65 offen offset:0 sc1 lds
buffer_load_dwordx4 v16,s[20:23],s65 offen offset:2048 sc1 lds
s_xor_b32 m0,s91,16384
s_add_u32 s65,s94,32768
buffer_load_dwordx4 v16,s[20:23],s65 offen offset:0 sc1 lds
buffer_load_dwordx4 v16,s[20:23],s65 offen offset:2048 sc1 lds
s_xor_b32 m0,s91,32768
s_add_u32 s65,s94,65536
buffer_load_dwordx4 v16,s[20:23],s65 offen offset:0 sc1 lds
buffer_load_dwordx4 v16,s[20:23],s65 offen offset:2048 sc1 lds
s_xor_b32 m0,s91,49152
s_add_u32 s65,s94,98304
buffer_load_dwordx4 v16,s[20:23],s65 offen offset:0 sc1 lds
buffer_load_dwordx4 v16,s[20:23],s65 offen offset:2048 sc1 lds
s_mov_b64 exec,-1
s_waitcnt vmcnt(8)
v_add_u32 v22,s71,-1
buffer_store_dword v22,v23,s[20:23],s97 offen sc1
s_mov_b32 s97,0x7fff0000
half2_383:
s_waitcnt vmcnt(7)
s_barrier
ds_read_b128 v[224:227],v17 offset:0
ds_read_b128 v[228:231],v17 offset:2048
ds_read_b128 v[232:235],v17 offset:4096
ds_read_b128 v[236:239],v17 offset:6144
ds_read_b128 v[240:243],v17 offset:8192
ds_read_b128 v[244:247],v17 offset:10240
ds_read_b128 v[248:251],v17 offset:12288
s_waitcnt lgkmcnt(5)
v_mfma_f32_16x16x32_bf16 v[64:67],a[0:3],v[224:227],0
v_min_u32 v27,v224,v228
v_mfma_f32_16x16x32_bf16 v[72:75],a[128:131],v[224:227],0
ds_read_b128 v[252:255],v17 offset:14336
v_mfma_f32_16x16x32_bf16 v[64:67],a[4:7],v[228:231],v[64:67]
v_mfma_f32_16x16x32_bf16 v[72:75],a[132:135],v[228:231],v[72:75]
s_waitcnt vmcnt(5)
s_barrier
ds_read_b128 v[224:227],v17 offset:16384
s_waitcnt lgkmcnt(5)
v_mfma_f32_16x16x32_bf16 v[64:67],a[8:11],v[232:235],v[64:67]
v_min3_u32 v27,v27,v232,v236
v_mfma_f32_16x16x32_bf16 v[72:75],a[136:139],v[232:235],v[72:75]
ds_read_b128 v[228:231],v17 offset:18432
v_mfma_f32_16x16x32_bf16 v[64:67],a[12:15],v[236:239],v[64:67]
v_mfma_f32_16x16x32_bf16 v[72:75],a[140:143],v[236:239],v[72:75]
ds_read_b128 v[232:235],v17 offset:20480
s_waitcnt lgkmcnt(5)
v_mfma_f32_16x16x32_bf16 v[64:67],a[16:19],v[240:243],v[64:67]
v_min3_u32 v27,v27,v240,v244
v_mfma_f32_16x16x32_bf16 v[72:75],a[144:147],v[240:243],v[72:75]
ds_read_b128 v[236:239],v17 offset:22528
v_mfma_f32_16x16x32_bf16 v[64:67],a[20:23],v[244:247],v[64:67]
v_mfma_f32_16x16x32_bf16 v[72:75],a[148:151],v[244:247],v[72:75]
ds_read_b128 v[240:243],v17 offset:24576
s_waitcnt lgkmcnt(5)
v_mfma_f32_16x16x32_bf16 v[64:67],a[24:27],v[248:251],v[64:67]
v_min3_u32 v27,v27,v248,v252
v_mfma_f32_16x16x32_bf16 v[72:75],a[152:155],v[248:251],v[72:75]
ds_read_b128 v[244:247],v17 offset:26624
v_mfma_f32_16x16x32_bf16 v[64:67],a[28:31],v[252:255],v[64:67]
v_mfma_f32_16x16x32_bf16 v[72:75],a[156:159],v[252:255],v[72:75]
ds_read_b128 v[248:251],v17 offset:28672
s_waitcnt lgkmcnt(5)
v_mfma_f32_16x16x32_bf16 v[64:67],a[32:35],v[224:227],v[64:67]
v_min3_u32 v27,v27,v224,v228
v_mfma_f32_16x16x32_bf16 v[72:75],a[160:163],v[224:227],v[72:75]
ds_read_b128 v[252:255],v17 offset:30720
v_mfma_f32_16x16x32_bf16 v[64:67],a[36:39],v[228:231],v[64:67]
v_mfma_f32_16x16x32_bf16 v[72:75],a[164:167],v[228:231],v[72:75]
s_waitcnt vmcnt(1)
s_barrier
ds_read_b128 v[224:227],v17 offset:32768
s_waitcnt lgkmcnt(5)
v_mfma_f32_16x16x32_bf16 v[64:67],a[40:43],v[232:235],v[64:67]
v_min3_u32 v27,v27,v232,v236
v_mfma_f32_16x16x32_bf16 v[72:75],a[168:171],v[232:235],v[72:75]
ds_read_b128 v[228:231],v17 offset:34816
v_mfma_f32_16x16x32_bf16 v[64:67],a[44:47],v[236:239],v[64:67]
v_mfma_f32_16x16x32_bf16 v[72:75],a[172:175],v[236:239],v[72:75]
ds_read_b128 v[232:235],v17 offset:36864
s_waitcnt lgkmcnt(5)
v_mfma_f32_16x16x32_bf16 v[64:67],a[48:51],v[240:243],v[64:67]
v_min3_u32 v27,v27,v240,v244
v_mfma_f32_16x16x32_bf16 v[72:75],a[176:179],v[240:243],v[72:75]
ds_read_b128 v[236:239],v17 offset:38912
v_mfma_f32_16x16x32_bf16 v[64:67],a[52:55],v[244:247],v[64:67]
v_mfma_f32_16x16x32_bf16 v[72:75],a[180:183],v[244:247],v[72:75]
ds_read_b128 v[240:243],v17 offset:40960
s_waitcnt lgkmcnt(5)
v_mfma_f32_16x16x32_bf16 v[64:67],a[56:59],v[248:251],v[64:67]
v_min3_u32 v27,v27,v248,v252
v_mfma_f32_16x16x32_bf16 v[72:75],a[184:187],v[248:251],v[72:75]
ds_read_b128 v[244:247],v17 offset:43008
v_mfma_f32_16x16x32_bf16 v[64:67],a[60:63],v[252:255],v[64:67]
v_mfma_f32_16x16x32_bf16 v[72:75],a[188:191],v[252:255],v[72:75]
ds_read_b128 v[248:251],v17 offset:45056
s_waitcnt lgkmcnt(5)
v_mfma_f32_16x16x32_bf16 v[64:67],a[64:67],v[224:227],v[64:67]
v_min3_u32 v27,v27,v224,v228
v_mfma_f32_16x16x32_bf16 v[72:75],a[192:195],v[224:227],v[72:75]
ds_read_b128 v[252:255],v17 offset:47104
v_mfma_f32_16x16x32_bf16 v[64:67],a[68:71],v[228:231],v[64:67]
v_mfma_f32_16x16x32_bf16 v[72:75],a[196:199],v[228:231],v[72:75]
ds_read_b128 v[224:227],v17 offset:49152
s_waitcnt lgkmcnt(5)
v_mfma_f32_16x16x32_bf16 v[64:67],a[72:75],v[232:235],v[64:67]
v_min3_u32 v27,v27,v232,v236
v_mfma_f32_16x16x32_bf16 v[72:75],a[200:203],v[232:235],v[72:75]
ds_read_b128 v[228:231],v17 offset:51200
v_mfma_f32_16x16x32_bf16 v[64:67],a[76:79],v[236:239],v[64:67]
v_mfma_f32_16x16x32_bf16 v[72:75],a[204:207],v[236:239],v[72:75]
ds_read_b128 v[232:235],v17 offset:53248
s_waitcnt lgkmcnt(5)
v_mfma_f32_16x16x32_bf16 v[64:67],a[80:83],v[240:243],v[64:67]
v_min3_u32 v27,v27,v240,v244
v_mfma_f32_16x16x32_bf16 v[72:75],a[208:211],v[240:243],v[72:75]
ds_read_b128 v[236:239],v17 offset:55296
v_mfma_f32_16x16x32_bf16 v[64:67],a[84:87],v[244:247],v[64:67]
v_mfma_f32_16x16x32_bf16 v[72:75],a[212:215],v[244:247],v[72:75]
ds_read_b128 v[240:243],v17 offset:57344
s_waitcnt lgkmcnt(5)
v_mfma_f32_16x16x32_bf16 v[64:67],a[88:91],v[248:251],v[64:67]
v_min3_u32 v27,v27,v248,v252
v_mfma_f32_16x16x32_bf16 v[72:75],a[216:219],v[248:251],v[72:75]
ds_read_b128 v[244:247],v17 offset:59392
v_mfma_f32_16x16x32_bf16 v[64:67],a[92:95],v[252:255],v[64:67]
v_mfma_f32_16x16x32_bf16 v[72:75],a[220:223],v[252:255],v[72:75]
ds_read_b128 v[248:251],v17 offset:61440
s_waitcnt lgkmcnt(5)
v_mfma_f32_16x16x32_bf16 v[64:67],a[96:99],v[224:227],v[64:67]
v_min3_u32 v27,v27,v224,v228
v_mfma_f32_16x16x32_bf16 v[72:75],a[224:227],v[224:227],v[72:75]
s_barrier
ds_read_b128 v[252:255],v17 offset:63488
v_mfma_f32_16x16x32_bf16 v[64:67],a[100:103],v[228:231],v[64:67]
ds_read_b128 v[120:123],v19
v_mfma_f32_16x16x32_bf16 v[72:75],a[228:231],v[228:231],v[72:75]
s_waitcnt lgkmcnt(5)
v_mfma_f32_16x16x32_bf16 v[64:67],a[104:107],v[232:235],v[64:67]
v_min3_u32 v27,v27,v232,v236
v_mfma_f32_16x16x32_bf16 v[72:75],a[232:235],v[232:235],v[72:75]
v_mfma_f32_16x16x32_bf16 v[64:67],a[108:111],v[236:239],v[64:67]
v_mfma_f32_16x16x32_bf16 v[72:75],a[236:239],v[236:239],v[72:75]
s_waitcnt lgkmcnt(3)
v_mfma_f32_16x16x32_bf16 v[64:67],a[112:115],v[240:243],v[64:67]
v_min3_u32 v27,v27,v240,v244
v_mfma_f32_16x16x32_bf16 v[72:75],a[240:243],v[240:243],v[72:75]
v_mfma_f32_16x16x32_bf16 v[64:67],a[116:119],v[244:247],v[64:67]
v_mfma_f32_16x16x32_bf16 v[72:75],a[244:247],v[244:247],v[72:75]
s_waitcnt lgkmcnt(1)
v_mfma_f32_16x16x32_bf16 v[64:67],a[120:123],v[248:251],v[64:67]
v_min3_u32 v27,v27,v248,v252
v_mfma_f32_16x16x32_bf16 v[72:75],a[248:251],v[248:251],v[72:75]
v_mfma_f32_16x16x32_bf16 v[64:67],a[124:127],v[252:255],v[64:67]
v_mfma_f32_16x16x32_bf16 v[72:75],a[252:255],v[252:255],v[72:75]
v_cmp_eq_u32 vcc,0,v27
s_and_b64 vcc,vcc,s[52:53]
s_cbranch_vccnz retry_377
s_waitcnt lgkmcnt(0)
s_nop 3
v_pk_fma_f32 v[64:65],v[52:53],v[120:121],v[64:65] op_sel_hi:[1,0,1]
v_pk_fma_f32 v[66:67],v[54:55],v[120:121],v[66:67] op_sel_hi:[1,0,1]
v_pk_fma_f32 v[72:73],v[56:57],v[120:121],v[72:73] op_sel_hi:[1,0,1]
v_pk_fma_f32 v[74:75],v[58:59],v[120:121],v[74:75] op_sel_hi:[1,0,1]
v_pk_mul_f32 v[88:89],v[64:65],v[64:65]
v_pk_mul_f32 v[90:91],v[66:67],v[66:67]
buffer_load_dword v29,v21,s[20:23],s87 offen sc1
v_mov_b32 v22,s71
buffer_store_dword v22,v23,s[20:23],s73 offen sc1
v_pk_mul_f32 v[92:93],v[72:73],v[72:73]
v_pk_mul_f32 v[94:95],v[74:75],v[74:75]
v_pk_fma_f32 v[88:89],v[88:89],v[120:121],v[122:123] op_sel:[0,1,0] op_sel_hi:[1,1,0]
v_pk_fma_f32 v[90:91],v[90:91],v[120:121],v[122:123] op_sel:[0,1,0] op_sel_hi:[1,1,0]
v_pk_fma_f32 v[92:93],v[92:93],v[120:121],v[122:123] op_sel:[0,1,0] op_sel_hi:[1,1,0]
v_pk_fma_f32 v[94:95],v[94:95],v[120:121],v[122:123] op_sel:[0,1,0] op_sel_hi:[1,1,0]
v_pk_mul_f32 v[88:89],v[88:89],v[64:65]
v_pk_mul_f32 v[90:91],v[90:91],v[66:67]
v_pk_mul_f32 v[92:93],v[92:93],v[72:73]
v_pk_mul_f32 v[94:95],v[94:95],v[74:75]
v_exp_f32 v88,v88
v_exp_f32 v89,v89
v_exp_f32 v90,v90
v_exp_f32 v91,v91
v_exp_f32 v92,v92
v_exp_f32 v93,v93
v_exp_f32 v94,v94
v_exp_f32 v95,v95
v_pk_fma_f32 v[88:89],v[88:89],v[122:123],v[122:123] op_sel:[0,1,1] op_sel_hi:[1,1,1]
v_pk_fma_f32 v[90:91],v[90:91],v[122:123],v[122:123] op_sel:[0,1,1] op_sel_hi:[1,1,1]
v_pk_fma_f32 v[92:93],v[92:93],v[122:123],v[122:123] op_sel:[0,1,1] op_sel_hi:[1,1,1]
v_pk_fma_f32 v[94:95],v[94:95],v[122:123],v[122:123] op_sel:[0,1,1] op_sel_hi:[1,1,1]
v_rcp_f32 v88,v88
v_rcp_f32 v89,v89
v_rcp_f32 v90,v90
v_rcp_f32 v91,v91
v_rcp_f32 v92,v92
v_rcp_f32 v93,v93
v_rcp_f32 v94,v94
v_rcp_f32 v95,v95
v_pk_mul_f32 v[88:89],v[88:89],v[64:65]
v_pk_mul_f32 v[90:91],v[90:91],v[66:67]
v_pk_mul_f32 v[92:93],v[92:93],v[72:73]
v_pk_mul_f32 v[94:95],v[94:95],v[74:75]
v_cvt_pk_bf16_f32 v96,v88,v89
v_cvt_pk_bf16_f32 v97,v90,v91
v_cvt_pk_bf16_f32 v98,v92,v93
v_cvt_pk_bf16_f32 v99,v94,v95
v_max_u32 v96,1,v96
buffer_store_dwordx4 v[96:99],v18,s[20:23],s70 offen offset:0 sc1
s_branch next_387
w3b_376:
s_add_u32 s64,s79,0
s_lshl_b32 s70,s64,21
s_lshl_b32 s64,s64,13
s_and_b32 s64,s64,0x2000
s_xor_b32 s64,s64,s62
s_add_u32 s70,s70,s64
s_add_u32 s70,s70,29360128
s_mov_b32 s83,1
s_mov_b32 s87,s74
s_cmp_eq_u32 s50,0
s_cselect_b32 s74,s74,0x7fff0000
v_mov_b32 v47,132096
s_lshl_b32 s64,s50,3
s_add_u32 s64,s64,132096
v_mov_b32 v46,s64
v_mov_b32 v29,0
s_mov_b32 s97,0x7fff0000
s_mov_b32 s69,1
s_mov_b32 s68,0
s_mov_b32 s52,0x30003
s_mov_b32 s53,s52
seg_393:
s_cmp_eq_u32 s83,0
s_cbranch_scc1 ahead_394
s_add_u32 s94,s70,s75
s_xor_b32 s95,s94,1024
s_xor_b32 s91,s72,0x10000
s_cmp_eq_u32 s69,0
s_mov_b32 s69,1
s_cbranch_scc1 half2_398
s_waitcnt vmcnt(2)
v_cmp_gt_u32 vcc,s71,v29
s_cbranch_vccz nb_397
s_waitcnt vmcnt(0)
v_add_u32 v22,s71,-1
buffer_store_dword v22,v23,s[20:23],s97 offen sc1
s_mov_b32 s97,0x7fff0000
s_cmp_lg_u32 s50,0
s_cbranch_scc1 nb_397
buffer_load_dword v32,v21,s[20:23],s74 offen sc1
s_sleep 2
pl_399:
buffer_load_dword v33,v21,s[20:23],s74 offen sc1
s_waitcnt vmcnt(1)
v_cmp_gt_u32 vcc,s71,v32
v_mov_b32 v29,v32
s_cbranch_vccz pok_400
buffer_load_dword v32,v21,s[20:23],s74 offen sc1
s_waitcnt vmcnt(1)
v_cmp_gt_u32 vcc,s71,v33
v_mov_b32 v29,v33
s_cbranch_vccz pok_400
s_sub_u32 s90,s90,1
s_cmp_gt_i32 s90,0
s_cbranch_scc1 pl_399
pok_400:
nb_397:
s_cmp_eq_u32 s71,64
s_barrier
s_cbranch_scc1 half_401
s_xor_b32 m0,s91,0
s_add_u32 s65,s94,0
buffer_load_dwordx4 v16,s[20:23],s65 offen offset:0 sc1 lds
buffer_load_dwordx4 v16,s[20:23],s65 offen offset:2048 sc1 lds
s_xor_b32 m0,s91,16384
s_add_u32 s65,s94,32768
buffer_load_dwordx4 v16,s[20:23],s65 offen offset:0 sc1 lds
buffer_load_dwordx4 v16,s[20:23],s65 offen offset:2048 sc1 lds
s_xor_b32 m0,s91,32768
s_add_u32 s65,s94,65536
buffer_load_dwordx4 v16,s[20:23],s65 offen offset:0 sc1 lds
buffer_load_dwordx4 v16,s[20:23],s65 offen offset:2048 sc1 lds
s_xor_b32 m0,s91,49152
s_add_u32 s65,s94,98304
buffer_load_dwordx4 v16,s[20:23],s65 offen offset:0 sc1 lds
buffer_load_dwordx4 v16,s[20:23],s65 offen offset:2048 sc1 lds
s_add_u32 s66,s94,110592
buffer_load_dwordx4 v[128:131],v16,s[20:23],s66 offen offset:0 sc1
buffer_load_dwordx4 v[132:135],v16,s[20:23],s66 offen offset:1024 sc1
buffer_load_dwordx4 v[136:139],v16,s[20:23],s66 offen offset:2048 sc1
buffer_load_dwordx4 v[140:143],v16,s[20:23],s66 offen offset:3072 sc1
s_add_u32 s66,s94,114688
buffer_load_dwordx4 v[144:147],v16,s[20:23],s66 offen offset:0 sc1
buffer_load_dwordx4 v[148:151],v16,s[20:23],s66 offen offset:1024 sc1
buffer_load_dwordx4 v[152:155],v16,s[20:23],s66 offen offset:2048 sc1
buffer_load_dwordx4 v[156:159],v16,s[20:23],s66 offen offset:3072 sc1
s_waitcnt vmcnt(16)
v_add_u32 v22,s71,-1
buffer_store_dword v22,v23,s[20:23],s97 offen sc1
s_mov_b32 s97,0x7fff0000
s_waitcnt vmcnt(15)
s_barrier
ds_read_b128 v[224:227],v17 offset:0
ds_read_b128 v[228:231],v17 offset:2048
ds_read_b128 v[232:235],v17 offset:4096
ds_read_b128 v[236:239],v17 offset:6144
ds_read_b128 v[240:243],v17 offset:8192
ds_read_b128 v[244:247],v17 offset:10240
ds_read_b128 v[248:251],v17 offset:12288
s_waitcnt lgkmcnt(5)
v_mfma_f32_16x16x32_bf16 v[64:67],a[0:3],v[224:227],0
ds_read_b128 v[252:255],v17 offset:14336
s_xor_b32 m0,s91,1024
s_add_u32 s65,s95,0
buffer_load_dwordx4 v16,s[20:23],s65 offen offset:0 sc1 lds
buffer_load_dwordx4 v16,s[20:23],s65 offen offset:2048 sc1 lds
v_min_u32 v27,v224,v228
v_mfma_f32_16x16x32_bf16 v[72:75],a[4:7],v[228:231],0
s_waitcnt vmcnt(15)
s_barrier
ds_read_b128 v[224:227],v17 offset:16384
s_xor_b32 m0,s91,17408
s_add_u32 s65,s95,32768
s_waitcnt lgkmcnt(5)
v_mfma_f32_16x16x32_bf16 v[64:67],a[8:11],v[232:235],v[64:67]
ds_read_b128 v[228:231],v17 offset:18432
buffer_load_dwordx4 v16,s[20:23],s65 offen offset:0 sc1 lds
buffer_load_dwordx4 v16,s[20:23],s65 offen offset:2048 sc1 lds
s_xor_b32 m0,s91,33792
v_min3_u32 v27,v27,v232,v236
v_mfma_f32_16x16x32_bf16 v[72:75],a[12:15],v[236:239],v[72:75]
ds_read_b128 v[232:235],v17 offset:20480
s_add_u32 s65,s95,65536
buffer_load_dwordx4 v16,s[20:23],s65 offen offset:0 sc1 lds
s_waitcnt lgkmcnt(5)
v_mfma_f32_16x16x32_bf16 v[64:67],a[16:19],v[240:243],v[64:67]
ds_read_b128 v[236:239],v17 offset:22528
buffer_load_dwordx4 v16,s[20:23],s65 offen offset:2048 sc1 lds
s_xor_b32 m0,s91,50176
s_add_u32 s65,s95,98304
v_min3_u32 v27,v27,v240,v244
v_mfma_f32_16x16x32_bf16 v[72:75],a[20:23],v[244:247],v[72:75]
ds_read_b128 v[240:243],v17 offset:24576
buffer_load_dwordx4 v16,s[20:23],s65 offen offset:0 sc1 lds
buffer_load_dwordx4 v16,s[20:23],s65 offen offset:2048 sc1 lds
s_waitcnt lgkmcnt(5)
v_mfma_f32_16x16x32_bf16 v[64:67],a[24:27],v[248:251],v[64:67]
ds_read_b128 v[244:247],v17 offset:26624
v_min3_u32 v27,v27,v248,v252
v_mfma_f32_16x16x32_bf16 v[72:75],a[28:31],v[252:255],v[72:75]
ds_read_b128 v[248:251],v17 offset:28672
s_waitcnt lgkmcnt(5)
v_mfma_f32_16x16x32_bf16 v[64:67],a[32:35],v[224:227],v[64:67]
ds_read_b128 v[252:255],v17 offset:30720
v_min3_u32 v27,v27,v224,v228
v_mfma_f32_16x16x32_bf16 v[72:75],a[36:39],v[228:231],v[72:75]
s_waitcnt vmcnt(17)
s_barrier
ds_read_b128 v[224:227],v17 offset:32768
s_waitcnt lgkmcnt(5)
v_mfma_f32_16x16x32_bf16 v[64:67],a[40:43],v[232:235],v[64:67]
ds_read_b128 v[228:231],v17 offset:34816
v_min3_u32 v27,v27,v232,v236
v_mfma_f32_16x16x32_bf16 v[72:75],a[44:47],v[236:239],v[72:75]
ds_read_b128 v[232:235],v17 offset:36864
s_waitcnt lgkmcnt(5)
v_mfma_f32_16x16x32_bf16 v[64:67],a[48:51],v[240:243],v[64:67]
ds_read_b128 v[236:239],v17 offset:38912
v_min3_u32 v27,v27,v240,v244
v_mfma_f32_16x16x32_bf16 v[72:75],a[52:55],v[244:247],v[72:75]
ds_read_b128 v[240:243],v17 offset:40960
s_add_u32 s88,s70,s75
s_add_u32 s88,s88,2097152
s_xor_b32 s88,s88,0x2000
s_xor_b32 s89,s88,1024
s_waitcnt lgkmcnt(5)
v_mfma_f32_16x16x32_bf16 v[64:67],a[56:59],v[248:251],v[64:67]
ds_read_b128 v[244:247],v17 offset:43008
v_min3_u32 v27,v27,v248,v252
v_mfma_f32_16x16x32_bf16 v[72:75],a[60:63],v[252:255],v[72:75]
ds_read_b128 v[248:251],v17 offset:45056
s_waitcnt lgkmcnt(5)
v_mfma_f32_16x16x32_bf16 v[64:67],a[64:67],v[224:227],v[64:67]
ds_read_b128 v[252:255],v17 offset:47104
v_min3_u32 v27,v27,v224,v228
v_mfma_f32_16x16x32_bf16 v[72:75],a[68:71],v[228:231],v[72:75]
ds_read_b128 v[224:227],v17 offset:49152
s_waitcnt lgkmcnt(5)
v_mfma_f32_16x16x32_bf16 v[64:67],a[72:75],v[232:235],v[64:67]
ds_read_b128 v[228:231],v17 offset:51200
v_min3_u32 v27,v27,v232,v236
v_mfma_f32_16x16x32_bf16 v[72:75],a[76:79],v[236:239],v[72:75]
ds_read_b128 v[232:235],v17 offset:53248
s_waitcnt lgkmcnt(5)
v_mfma_f32_16x16x32_bf16 v[64:67],a[80:83],v[240:243],v[64:67]
ds_read_b128 v[236:239],v17 offset:55296
v_min3_u32 v27,v27,v240,v244
v_mfma_f32_16x16x32_bf16 v[72:75],a[84:87],v[244:247],v[72:75]
ds_read_b128 v[240:243],v17 offset:57344
s_waitcnt lgkmcnt(5)
v_mfma_f32_16x16x32_bf16 v[64:67],a[88:91],v[248:251],v[64:67]
ds_read_b128 v[244:247],v17 offset:59392
v_min3_u32 v27,v27,v248,v252
v_mfma_f32_16x16x32_bf16 v[72:75],a[92:95],v[252:255],v[72:75]
ds_read_b128 v[248:251],v17 offset:61440
s_waitcnt vmcnt(9)
stk_407:
v_min3_u32 v22,v129,v133,v137
v_min3_u32 v22,v22,v141,v145
v_min3_u32 v22,v22,v149,v153
v_min_u32 v22,v22,v157
v_cmp_eq_u32 vcc,0,v22
s_cmp_lt_i32 s90,0
s_cselect_b64 vcc,0,vcc
s_cbranch_vccnz str_408
v_pk_add_f32 v[88:89],v[128:129],v[144:145]
v_pk_add_f32 v[90:91],v[130:131],v[146:147]
v_pk_add_f32 v[92:93],v[132:133],v[148:149]
v_pk_add_f32 v[94:95],v[134:135],v[150:151]
v_pk_add_f32 v[96:97],v[136:137],v[152:153]
v_pk_add_f32 v[98:99],v[138:139],v[154:155]
v_pk_add_f32 v[100:101],v[140:141],v[156:157]
v_pk_add_f32 v[102:103],v[142:143],v[158:159]
v_pk_add_f32 v[88:89],v[88:89],v[96:97]
v_pk_add_f32 v[90:91],v[90:91],v[98:99]
v_pk_add_f32 v[92:93],v[92:93],v[100:101]
v_pk_add_f32 v[94:95],v[94:95],v[102:103]
v_pk_add_f32 v[88:89],v[88:89],v[92:93]
v_pk_add_f32 v[90:91],v[90:91],v[94:95]
v_mov_b32 v92,v88
v_mov_b32 v93,v89
v_mov_b32 v94,v90
v_mov_b32 v95,v91
v_permlane16_swap_b32 v92,v88
v_permlane16_swap_b32 v93,v89
v_permlane16_swap_b32 v94,v90
v_permlane16_swap_b32 v95,v91
v_pk_add_f32 v[88:89],v[88:89],v[92:93]
v_pk_add_f32 v[90:91],v[90:91],v[94:95]
v_mov_b32 v92,v88
v_mov_b32 v93,v89
s_waitcnt lgkmcnt(5)
v_mfma_f32_16x16x32_bf16 v[64:67],a[96:99],v[224:227],v[64:67]
ds_read_b128 v[252:255],v17 offset:63488
v_min3_u32 v27,v27,v224,v228
v_mov_b32 v94,v90
v_mov_b32 v95,v91
v_permlane32_swap_b32 v92,v88
v_permlane32_swap_b32 v93,v89
v_permlane32_swap_b32 v94,v90
v_permlane32_swap_b32 v95,v91
v_pk_add_f32 v[88:89],v[88:89],v[92:93]
v_pk_add_f32 v[90:91],v[90:91],v[94:95]
v_mul_f32 v120,0xba800000,v88
v_mul_f32 v124,0xba800000,v90
v_mul_f32 v92,v120,v120
v_mul_f32 v93,v124,v124
v_fma_f32 v92,v89,s82,-v92
v_fma_f32 v93,v91,s82,-v93
v_max_f32 v92,0,v92
v_max_f32 v93,0,v93
v_add_f32 v92,0x3727c5ac,v92
v_add_f32 v93,0x3727c5ac,v93
v_rsq_f32 v94,v92
v_rsq_f32 v95,v93
v_mul_f32 v123,v92,v94
v_mul_f32 v127,v93,v95
v_mul_f32 v122,v28,v94
v_mul_f32 v126,v28,v95
v_mul_f32 v92,v94,v94
v_mul_f32 v93,v95,v95
v_mul_f32 v94,s81,v94
v_mul_f32 v95,s81,v95
v_mul_f32 v121,v92,v94
v_mul_f32 v125,v93,v95
ds_write_b128 v19,v[120:123] offset:0
ds_write_b128 v19,v[124:127] offset:256
v_mfma_f32_16x16x32_bf16 v[72:75],a[100:103],v[228:231],v[72:75]
s_waitcnt vmcnt(4) lgkmcnt(0)
s_barrier
ds_read_b64 v[44:45],v47
ds_read_b128 v[224:227],v17 offset:1024
v_mfma_f32_16x16x32_bf16 v[64:67],a[104:107],v[232:235],v[64:67]
ds_read_b128 v[228:231],v17 offset:3072
v_min3_u32 v27,v27,v232,v236
v_mfma_f32_16x16x32_bf16 v[72:75],a[108:111],v[236:239],v[72:75]
ds_read_b128 v[232:235],v17 offset:5120
v_mfma_f32_16x16x32_bf16 v[64:67],a[112:115],v[240:243],v[64:67]
ds_read_b128 v[236:239],v17 offset:7168
v_min3_u32 v27,v27,v240,v244
v_mfma_f32_16x16x32_bf16 v[72:75],a[116:119],v[244:247],v[72:75]
ds_read_b128 v[240:243],v17 offset:9216
s_waitcnt lgkmcnt(5)
v_readfirstlane_b32 s93,v45
v_mfma_f32_16x16x32_bf16 v[64:67],a[120:123],v[248:251],v[64:67]
ds_read_b128 v[244:247],v17 offset:11264
v_readfirstlane_b32 s83,v44
s_cmp_lg_u32 s83,0
s_cbranch_scc0 keep_403
v_min3_u32 v27,v27,v248,v252
v_mfma_f32_16x16x32_bf16 v[72:75],a[124:127],v[252:255],v[72:75]
ds_read_b128 v[248:251],v17 offset:13312
s_waitcnt lgkmcnt(5)
v_mfma_f32_16x16x32_bf16 v[68:71],a[0:3],v[224:227],0
ds_read_b128 v[252:255],v17 offset:15360
v_cmp_eq_u32 vcc,0,v27
s_cbranch_vccnz retry_392
v_min3_u32 v27,v27,v224,v228
v_mfma_f32_16x16x32_bf16 v[76:79],a[4:7],v[228:231],0
ds_read_b128 v[224:227],v17 offset:17408
s_waitcnt lgkmcnt(5)
v_mfma_f32_16x16x32_bf16 v[68:71],a[8:11],v[232:235],v[68:71]
ds_read_b128 v[228:231],v17 offset:19456
v_min3_u32 v27,v27,v232,v236
v_mfma_f32_16x16x32_bf16 v[76:79],a[12:15],v[236:239],v[76:79]
ds_read_b128 v[232:235],v17 offset:21504
s_waitcnt lgkmcnt(5)
v_mfma_f32_16x16x32_bf16 v[68:71],a[16:19],v[240:243],v[68:71]
ds_read_b128 v[236:239],v17 offset:23552
v_min3_u32 v27,v27,v240,v244
v_add_f32 v64,v64,v72
v_add_f32 v65,v65,v73
v_add_f32 v66,v66,v74
v_add_f32 v67,v67,v75
v_mfma_f32_16x16x32_bf16 v[76:79],a[20:23],v[244:247],v[76:79]
ds_read_b128 v[240:243],v17 offset:25600
v_fmac_f32 v64,v52,v120
v_fmac_f32 v65,v53,v120
v_fmac_f32 v66,v54,v120
v_fmac_f32 v67,v55,v120
s_waitcnt lgkmcnt(5)
v_mfma_f32_16x16x32_bf16 v[68:71],a[24:27],v[248:251],v[68:71]
ds_read_b128 v[244:247],v17 offset:27648
v_min3_u32 v27,v27,v248,v252
v_mul_f32 v88,v64,v64
v_mul_f32 v89,v65,v65
v_mul_f32 v90,v66,v66
v_mul_f32 v91,v67,v67
v_mfma_f32_16x16x32_bf16 v[76:79],a[28:31],v[252:255],v[76:79]
ds_read_b128 v[248:251],v17 offset:29696
v_fma_f32 v88,v88,v121,v122
v_fma_f32 v89,v89,v121,v122
v_fma_f32 v90,v90,v121,v122
v_fma_f32 v91,v91,v121,v122
s_waitcnt lgkmcnt(5)
v_mfma_f32_16x16x32_bf16 v[68:71],a[32:35],v[224:227],v[68:71]
ds_read_b128 v[252:255],v17 offset:31744
v_min3_u32 v27,v27,v224,v228
v_mul_f32 v88,v88,v64
v_mul_f32 v89,v89,v65
v_mul_f32 v90,v90,v66
v_mul_f32 v91,v91,v67
v_mfma_f32_16x16x32_bf16 v[76:79],a[36:39],v[228:231],v[76:79]
s_waitcnt vmcnt(0)
s_barrier
ds_read_b128 v[224:227],v17 offset:33792
v_exp_f32 v88,v88
s_waitcnt lgkmcnt(5)
v_mfma_f32_16x16x32_bf16 v[68:71],a[40:43],v[232:235],v[68:71]
ds_read_b128 v[228:231],v17 offset:35840
v_min3_u32 v27,v27,v232,v236
v_exp_f32 v89,v89
v_exp_f32 v90,v90
v_mfma_f32_16x16x32_bf16 v[76:79],a[44:47],v[236:239],v[76:79]
ds_read_b128 v[232:235],v17 offset:37888
v_exp_f32 v91,v91
v_fma_f32 v88,v88,v123,v123
v_fma_f32 v89,v89,v123,v123
s_waitcnt lgkmcnt(5)
v_mfma_f32_16x16x32_bf16 v[68:71],a[48:51],v[240:243],v[68:71]
ds_read_b128 v[236:239],v17 offset:39936
v_min3_u32 v27,v27,v240,v244
v_fma_f32 v90,v90,v123,v123
v_fma_f32 v91,v91,v123,v123
v_rcp_f32 v88,v88
v_mfma_f32_16x16x32_bf16 v[76:79],a[52:55],v[244:247],v[76:79]
ds_read_b128 v[240:243],v17 offset:41984
v_rcp_f32 v89,v89
v_rcp_f32 v90,v90
s_waitcnt lgkmcnt(5)
v_mfma_f32_16x16x32_bf16 v[68:71],a[56:59],v[248:251],v[68:71]
ds_read_b128 v[244:247],v17 offset:44032
v_min3_u32 v27,v27,v248,v252
v_rcp_f32 v91,v91
v_mul_f32 v88,v88,v64
v_mul_f32 v89,v89,v65
v_mfma_f32_16x16x32_bf16 v[76:79],a[60:63],v[252:255],v[76:79]
ds_read_b128 v[248:251],v17 offset:46080
v_mul_f32 v90,v90,v66
v_mul_f32 v91,v91,v67
v_cvt_pk_bf16_f32 v96,v88,v89
v_cvt_pk_bf16_f32 v97,v90,v91
s_waitcnt lgkmcnt(5)
v_mfma_f32_16x16x32_bf16 v[68:71],a[64:67],v[224:227],v[68:71]
ds_read_b128 v[252:255],v17 offset:48128
v_min3_u32 v27,v27,v224,v228
v_max_u32 v96,1,v96
buffer_store_dwordx2 v[96:97],v18,s[20:23],s70 offen offset:0 sc1
v_mfma_f32_16x16x32_bf16 v[76:79],a[68:71],v[228:231],v[76:79]
ds_read_b128 v[224:227],v17 offset:50176
s_waitcnt lgkmcnt(5)
v_mfma_f32_16x16x32_bf16 v[68:71],a[72:75],v[232:235],v[68:71]
ds_read_b128 v[228:231],v17 offset:52224
v_min3_u32 v27,v27,v232,v236
v_mfma_f32_16x16x32_bf16 v[76:79],a[76:79],v[236:239],v[76:79]
ds_read_b128 v[232:235],v17 offset:54272
s_waitcnt lgkmcnt(5)
v_mfma_f32_16x16x32_bf16 v[68:71],a[80:83],v[240:243],v[68:71]
ds_read_b128 v[236:239],v17 offset:56320
v_min3_u32 v27,v27,v240,v244
v_mfma_f32_16x16x32_bf16 v[76:79],a[84:87],v[244:247],v[76:79]
ds_read_b128 v[240:243],v17 offset:58368
s_waitcnt lgkmcnt(5)
v_mfma_f32_16x16x32_bf16 v[68:71],a[88:91],v[248:251],v[68:71]
ds_read_b128 v[244:247],v17 offset:60416
v_min3_u32 v27,v27,v248,v252
v_mfma_f32_16x16x32_bf16 v[76:79],a[92:95],v[252:255],v[76:79]
ds_read_b128 v[248:251],v17 offset:62464
s_waitcnt lgkmcnt(5)
v_mfma_f32_16x16x32_bf16 v[68:71],a[96:99],v[224:227],v[68:71]
ds_read_b128 v[252:255],v17 offset:64512
v_min3_u32 v27,v27,v224,v228
v_mfma_f32_16x16x32_bf16 v[76:79],a[100:103],v[228:231],v[76:79]
s_waitcnt lgkmcnt(4)
v_mfma_f32_16x16x32_bf16 v[68:71],a[104:107],v[232:235],v[68:71]
v_min3_u32 v27,v27,v232,v236
v_mfma_f32_16x16x32_bf16 v[76:79],a[108:111],v[236:239],v[76:79]
s_waitcnt lgkmcnt(2)
v_mfma_f32_16x16x32_bf16 v[68:71],a[112:115],v[240:243],v[68:71]
v_min3_u32 v27,v27,v240,v244
v_mfma_f32_16x16x32_bf16 v[76:79],a[116:119],v[244:247],v[76:79]
s_waitcnt lgkmcnt(0)
v_mfma_f32_16x16x32_bf16 v[68:71],a[120:123],v[248:251],v[68:71]
v_min3_u32 v27,v27,v248,v252
v_mfma_f32_16x16x32_bf16 v[76:79],a[124:127],v[252:255],v[76:79]
v_cmp_eq_u32 vcc,0,v27
s_cbranch_vccnz retry_392
s_branch epi_395
keep_403:
v_min3_u32 v27,v27,v248,v252
v_mfma_f32_16x16x32_bf16 v[72:75],a[124:127],v[252:255],v[72:75]
ds_read_b128 v[248:251],v17 offset:13312
s_add_u32 s66,s88,110592
buffer_load_dwordx4 v[128:131],v16,s[20:23],s66 offen offset:0 sc1
buffer_load_dwordx4 v[132:135],v16,s[20:23],s66 offen offset:1024 sc1
s_waitcnt lgkmcnt(5)
v_mfma_f32_16x16x32_bf16 v[68:71],a[0:3],v[224:227],0
ds_read_b128 v[252:255],v17 offset:15360
v_cmp_eq_u32 vcc,0,v27
s_cbranch_vccnz retry_392
v_min3_u32 v27,v27,v224,v228
buffer_load_dwordx4 v[136:139],v16,s[20:23],s66 offen offset:2048 sc1
buffer_load_dwordx4 v[140:143],v16,s[20:23],s66 offen offset:3072 sc1
v_mfma_f32_16x16x32_bf16 v[76:79],a[4:7],v[228:231],0
ds_read_b128 v[224:227],v17 offset:17408
s_add_u32 s66,s88,114688
buffer_load_dwordx4 v[144:147],v16,s[20:23],s66 offen offset:0 sc1
buffer_load_dwordx4 v[148:151],v16,s[20:23],s66 offen offset:1024 sc1
s_waitcnt lgkmcnt(5)
v_mfma_f32_16x16x32_bf16 v[68:71],a[8:11],v[232:235],v[68:71]
ds_read_b128 v[228:231],v17 offset:19456
v_min3_u32 v27,v27,v232,v236
buffer_load_dwordx4 v[152:155],v16,s[20:23],s66 offen offset:2048 sc1
buffer_load_dwordx4 v[156:159],v16,s[20:23],s66 offen offset:3072 sc1
v_mfma_f32_16x16x32_bf16 v[76:79],a[12:15],v[236:239],v[76:79]
ds_read_b128 v[232:235],v17 offset:21504
s_xor_b32 m0,s72,0
s_add_u32 s65,s88,0
s_waitcnt lgkmcnt(5)
v_mfma_f32_16x16x32_bf16 v[68:71],a[16:19],v[240:243],v[68:71]
ds_read_b128 v[236:239],v17 offset:23552
v_min3_u32 v27,v27,v240,v244
v_add_f32 v64,v64,v72
v_add_f32 v65,v65,v73
v_add_f32 v66,v66,v74
v_add_f32 v67,v67,v75
buffer_load_dwordx4 v16,s[20:23],s65 offen offset:0 sc1 lds
v_mfma_f32_16x16x32_bf16 v[76:79],a[20:23],v[244:247],v[76:79]
ds_read_b128 v[240:243],v17 offset:25600
v_fmac_f32 v64,v52,v120
v_fmac_f32 v65,v53,v120
v_fmac_f32 v66,v54,v120
v_fmac_f32 v67,v55,v120
buffer_load_dwordx4 v16,s[20:23],s65 offen offset:2048 sc1 lds
s_waitcnt lgkmcnt(5)
v_mfma_f32_16x16x32_bf16 v[68:71],a[24:27],v[248:251],v[68:71]
ds_read_b128 v[244:247],v17 offset:27648
v_min3_u32 v27,v27,v248,v252
v_mul_f32 v88,v64,v64
v_mul_f32 v89,v65,v65
v_mul_f32 v90,v66,v66
v_mul_f32 v91,v67,v67
s_xor_b32 m0,s72,16384
s_add_u32 s65,s88,32768
v_mfma_f32_16x16x32_bf16 v[76:79],a[28:31],v[252:255],v[76:79]
ds_read_b128 v[248:251],v17 offset:29696
v_fma_f32 v88,v88,v121,v122
v_fma_f32 v89,v89,v121,v122
v_fma_f32 v90,v90,v121,v122
v_fma_f32 v91,v91,v121,v122
buffer_load_dwordx4 v16,s[20:23],s65 offen offset:0 sc1 lds
s_waitcnt lgkmcnt(5)
v_mfma_f32_16x16x32_bf16 v[68:71],a[32:35],v[224:227],v[68:71]
ds_read_b128 v[252:255],v17 offset:31744
v_min3_u32 v27,v27,v224,v228
v_mul_f32 v88,v88,v64
v_mul_f32 v89,v89,v65
v_mul_f32 v90,v90,v66
v_mul_f32 v91,v91,v67
buffer_load_dwordx4 v16,s[20:23],s65 offen offset:2048 sc1 lds
v_mfma_f32_16x16x32_bf16 v[76:79],a[36:39],v[228:231],v[76:79]
s_waitcnt vmcnt(12)
s_barrier
ds_read_b128 v[224:227],v17 offset:33792
v_exp_f32 v88,v88
s_xor_b32 m0,s72,32768
s_add_u32 s65,s88,65536
s_waitcnt lgkmcnt(5)
v_mfma_f32_16x16x32_bf16 v[68:71],a[40:43],v[232:235],v[68:71]
ds_read_b128 v[228:231],v17 offset:35840
v_min3_u32 v27,v27,v232,v236
v_exp_f32 v89,v89
v_exp_f32 v90,v90
buffer_load_dwordx4 v16,s[20:23],s65 offen offset:0 sc1 lds
v_mfma_f32_16x16x32_bf16 v[76:79],a[44:47],v[236:239],v[76:79]
ds_read_b128 v[232:235],v17 offset:37888
v_exp_f32 v91,v91
v_fma_f32 v88,v88,v123,v123
v_fma_f32 v89,v89,v123,v123
buffer_load_dwordx4 v16,s[20:23],s65 offen offset:2048 sc1 lds
s_waitcnt lgkmcnt(5)
v_mfma_f32_16x16x32_bf16 v[68:71],a[48:51],v[240:243],v[68:71]
ds_read_b128 v[236:239],v17 offset:39936
v_min3_u32 v27,v27,v240,v244
v_fma_f32 v90,v90,v123,v123
v_fma_f32 v91,v91,v123,v123
v_rcp_f32 v88,v88
s_xor_b32 m0,s72,49152
s_add_u32 s65,s88,98304
v_mfma_f32_16x16x32_bf16 v[76:79],a[52:55],v[244:247],v[76:79]
ds_read_b128 v[240:243],v17 offset:41984
v_rcp_f32 v89,v89
v_rcp_f32 v90,v90
buffer_load_dwordx4 v16,s[20:23],s65 offen offset:0 sc1 lds
s_waitcnt lgkmcnt(5)
v_mfma_f32_16x16x32_bf16 v[68:71],a[56:59],v[248:251],v[68:71]
ds_read_b128 v[244:247],v17 offset:44032
v_min3_u32 v27,v27,v248,v252
v_rcp_f32 v91,v91
v_mul_f32 v88,v88,v64
v_mul_f32 v89,v89,v65
buffer_load_dwordx4 v16,s[20:23],s65 offen offset:2048 sc1 lds
v_mfma_f32_16x16x32_bf16 v[76:79],a[60:63],v[252:255],v[76:79]
ds_read_b128 v[248:251],v17 offset:46080
v_mul_f32 v90,v90,v66
v_mul_f32 v91,v91,v67
v_cvt_pk_bf16_f32 v96,v88,v89
v_cvt_pk_bf16_f32 v97,v90,v91
s_waitcnt lgkmcnt(5)
v_mfma_f32_16x16x32_bf16 v[68:71],a[64:67],v[224:227],v[68:71]
ds_read_b128 v[252:255],v17 offset:48128
v_min3_u32 v27,v27,v224,v228
v_max_u32 v96,1,v96
buffer_store_dwordx2 v[96:97],v18,s[20:23],s70 offen offset:0 sc1
s_xor_b32 m0,s72,1024
v_mfma_f32_16x16x32_bf16 v[76:79],a[68:71],v[228:231],v[76:79]
ds_read_b128 v[224:227],v17 offset:50176
s_add_u32 s65,s89,0
buffer_load_dwordx4 v16,s[20:23],s65 offen offset:0 sc1 lds
s_waitcnt lgkmcnt(5)
v_mfma_f32_16x16x32_bf16 v[68:71],a[72:75],v[232:235],v[68:71]
ds_read_b128 v[228:231],v17 offset:52224
v_min3_u32 v27,v27,v232,v236
buffer_load_dwordx4 v16,s[20:23],s65 offen offset:2048 sc1 lds
s_xor_b32 m0,s72,17408
s_add_u32 s65,s89,32768
v_mfma_f32_16x16x32_bf16 v[76:79],a[76:79],v[236:239],v[76:79]
ds_read_b128 v[232:235],v17 offset:54272
buffer_load_dwordx4 v16,s[20:23],s65 offen offset:0 sc1 lds
buffer_load_dwordx4 v16,s[20:23],s65 offen offset:2048 sc1 lds
s_waitcnt lgkmcnt(5)
v_mfma_f32_16x16x32_bf16 v[68:71],a[80:83],v[240:243],v[68:71]
ds_read_b128 v[236:239],v17 offset:56320
v_min3_u32 v27,v27,v240,v244
s_xor_b32 m0,s72,33792
s_add_u32 s65,s89,65536
buffer_load_dwordx4 v16,s[20:23],s65 offen offset:0 sc1 lds
v_mfma_f32_16x16x32_bf16 v[76:79],a[84:87],v[244:247],v[76:79]
ds_read_b128 v[240:243],v17 offset:58368
buffer_load_dwordx4 v16,s[20:23],s65 offen offset:2048 sc1 lds
s_xor_b32 m0,s72,50176
s_add_u32 s65,s89,98304
s_waitcnt lgkmcnt(5)
v_mfma_f32_16x16x32_bf16 v[68:71],a[88:91],v[248:251],v[68:71]
ds_read_b128 v[244:247],v17 offset:60416
v_min3_u32 v27,v27,v248,v252
buffer_load_dwordx4 v16,s[20:23],s65 offen offset:0 sc1 lds
buffer_load_dwordx4 v16,s[20:23],s65 offen offset:2048 sc1 lds
v_mfma_f32_16x16x32_bf16 v[76:79],a[92:95],v[252:255],v[76:79]
ds_read_b128 v[248:251],v17 offset:62464
s_waitcnt lgkmcnt(5)
v_mfma_f32_16x16x32_bf16 v[68:71],a[96:99],v[224:227],v[68:71]
ds_read_b128 v[252:255],v17 offset:64512
v_min3_u32 v27,v27,v224,v228
v_mfma_f32_16x16x32_bf16 v[76:79],a[100:103],v[228:231],v[76:79]
s_waitcnt lgkmcnt(4)
v_mfma_f32_16x16x32_bf16 v[68:71],a[104:107],v[232:235],v[68:71]
v_min3_u32 v27,v27,v232,v236
v_mfma_f32_16x16x32_bf16 v[76:79],a[108:111],v[236:239],v[76:79]
s_waitcnt lgkmcnt(2)
v_mfma_f32_16x16x32_bf16 v[68:71],a[112:115],v[240:243],v[68:71]
v_min3_u32 v27,v27,v240,v244
v_mfma_f32_16x16x32_bf16 v[76:79],a[116:119],v[244:247],v[76:79]
s_waitcnt lgkmcnt(0)
v_mfma_f32_16x16x32_bf16 v[68:71],a[120:123],v[248:251],v[68:71]
v_min3_u32 v27,v27,v248,v252
v_mfma_f32_16x16x32_bf16 v[76:79],a[124:127],v[252:255],v[76:79]
v_cmp_eq_u32 vcc,0,v27
s_cbranch_vccnz retry_392
s_branch epi_395
ahead_394:
s_cmp_eq_u32 s93,0
s_cbranch_scc1 both_396
s_waitcnt vmcnt(11) lgkmcnt(0)
s_barrier
ds_read_b128 v[224:227],v17 offset:0
ds_read_b128 v[228:231],v17 offset:2048
ds_read_b128 v[232:235],v17 offset:4096
ds_read_b128 v[236:239],v17 offset:6144
ds_read_b128 v[240:243],v17 offset:8192
ds_read_b128 v[244:247],v17 offset:10240
ds_read_b128 v[248:251],v17 offset:12288
s_waitcnt lgkmcnt(5)
v_mfma_f32_16x16x32_bf16 v[64:67],a[0:3],v[224:227],0
ds_read_b128 v[252:255],v17 offset:14336
v_min_u32 v27,v224,v228
s_waitcnt vmcnt(12)
stk_409:
v_min3_u32 v22,v129,v133,v137
v_min3_u32 v22,v22,v141,v145
v_min3_u32 v22,v22,v149,v153
v_min_u32 v22,v22,v157
v_cmp_eq_u32 vcc,0,v22
s_cmp_lt_i32 s90,0
s_cselect_b64 vcc,0,vcc
s_cbranch_vccnz str_410
v_mfma_f32_16x16x32_bf16 v[72:75],a[4:7],v[228:231],0
ds_read_b128 v[224:227],v17 offset:16384
v_pk_add_f32 v[88:89],v[128:129],v[144:145]
v_pk_add_f32 v[90:91],v[130:131],v[146:147]
v_pk_add_f32 v[92:93],v[132:133],v[148:149]
v_pk_add_f32 v[94:95],v[134:135],v[150:151]
s_waitcnt lgkmcnt(5)
v_mfma_f32_16x16x32_bf16 v[64:67],a[8:11],v[232:235],v[64:67]
ds_read_b128 v[228:231],v17 offset:18432
v_min3_u32 v27,v27,v232,v236
v_pk_add_f32 v[96:97],v[136:137],v[152:153]
v_pk_add_f32 v[98:99],v[138:139],v[154:155]
v_pk_add_f32 v[100:101],v[140:141],v[156:157]
v_pk_add_f32 v[102:103],v[142:143],v[158:159]
v_mfma_f32_16x16x32_bf16 v[72:75],a[12:15],v[236:239],v[72:75]
ds_read_b128 v[232:235],v17 offset:20480
s_waitcnt lgkmcnt(5)
v_mfma_f32_16x16x32_bf16 v[64:67],a[16:19],v[240:243],v[64:67]
ds_read_b128 v[236:239],v17 offset:22528
v_min3_u32 v27,v27,v240,v244
v_pk_add_f32 v[88:89],v[88:89],v[96:97]
v_pk_add_f32 v[90:91],v[90:91],v[98:99]
v_pk_add_f32 v[92:93],v[92:93],v[100:101]
v_mfma_f32_16x16x32_bf16 v[72:75],a[20:23],v[244:247],v[72:75]
ds_read_b128 v[240:243],v17 offset:24576
v_pk_add_f32 v[94:95],v[94:95],v[102:103]
v_pk_add_f32 v[88:89],v[88:89],v[92:93]
v_pk_add_f32 v[90:91],v[90:91],v[94:95]
s_waitcnt lgkmcnt(5)
v_mfma_f32_16x16x32_bf16 v[64:67],a[24:27],v[248:251],v[64:67]
ds_read_b128 v[244:247],v17 offset:26624
v_min3_u32 v27,v27,v248,v252
v_mov_b32 v92,v88
v_mov_b32 v93,v89
v_mov_b32 v94,v90
v_mfma_f32_16x16x32_bf16 v[72:75],a[28:31],v[252:255],v[72:75]
ds_read_b128 v[248:251],v17 offset:28672
v_mov_b32 v95,v91
v_permlane16_swap_b32 v92,v88
v_permlane16_swap_b32 v93,v89
s_waitcnt lgkmcnt(5)
v_mfma_f32_16x16x32_bf16 v[64:67],a[32:35],v[224:227],v[64:67]
ds_read_b128 v[252:255],v17 offset:30720
v_min3_u32 v27,v27,v224,v228
v_permlane16_swap_b32 v94,v90
v_permlane16_swap_b32 v95,v91
v_mfma_f32_16x16x32_bf16 v[72:75],a[36:39],v[228:231],v[72:75]
ds_read_b128 v[224:227],v17 offset:32768
v_pk_add_f32 v[88:89],v[88:89],v[92:93]
v_pk_add_f32 v[90:91],v[90:91],v[94:95]
v_mov_b32 v92,v88
s_waitcnt lgkmcnt(5)
v_mfma_f32_16x16x32_bf16 v[64:67],a[40:43],v[232:235],v[64:67]
ds_read_b128 v[228:231],v17 offset:34816
v_min3_u32 v27,v27,v232,v236
v_mov_b32 v93,v89
v_mov_b32 v94,v90
v_mov_b32 v95,v91
v_mfma_f32_16x16x32_bf16 v[72:75],a[44:47],v[236:239],v[72:75]
ds_read_b128 v[232:235],v17 offset:36864
v_permlane32_swap_b32 v92,v88
v_permlane32_swap_b32 v93,v89
v_permlane32_swap_b32 v94,v90
s_waitcnt lgkmcnt(5)
v_mfma_f32_16x16x32_bf16 v[64:67],a[48:51],v[240:243],v[64:67]
ds_read_b128 v[236:239],v17 offset:38912
v_min3_u32 v27,v27,v240,v244
v_permlane32_swap_b32 v95,v91
v_pk_add_f32 v[88:89],v[88:89],v[92:93]
v_mfma_f32_16x16x32_bf16 v[72:75],a[52:55],v[244:247],v[72:75]
ds_read_b128 v[240:243],v17 offset:40960
v_pk_add_f32 v[90:91],v[90:91],v[94:95]
v_mul_f32 v120,0xba800000,v88
v_mul_f32 v124,0xba800000,v90
s_add_u32 s88,s70,s75
s_waitcnt lgkmcnt(5)
v_mfma_f32_16x16x32_bf16 v[64:67],a[56:59],v[248:251],v[64:67]
ds_read_b128 v[244:247],v17 offset:43008
v_min3_u32 v27,v27,v248,v252
v_mul_f32 v92,v120,v120
v_mul_f32 v93,v124,v124
v_fma_f32 v92,v89,s82,-v92
s_add_u32 s88,s88,2097152
v_mfma_f32_16x16x32_bf16 v[72:75],a[60:63],v[252:255],v[72:75]
ds_read_b128 v[248:251],v17 offset:45056
v_fma_f32 v93,v91,s82,-v93
v_max_f32 v92,0,v92
v_max_f32 v93,0,v93
s_xor_b32 s88,s88,0x2000
s_waitcnt lgkmcnt(5)
v_mfma_f32_16x16x32_bf16 v[64:67],a[64:67],v[224:227],v[64:67]
ds_read_b128 v[252:255],v17 offset:47104
v_min3_u32 v27,v27,v224,v228
v_add_f32 v92,0x3727c5ac,v92
v_add_f32 v93,0x3727c5ac,v93
v_rsq_f32 v94,v92
v_mfma_f32_16x16x32_bf16 v[72:75],a[68:71],v[228:231],v[72:75]
ds_read_b128 v[224:227],v17 offset:49152
v_rsq_f32 v95,v93
v_mul_f32 v123,v92,v94
s_xor_b32 s89,s88,1024
s_waitcnt lgkmcnt(5)
v_mfma_f32_16x16x32_bf16 v[64:67],a[72:75],v[232:235],v[64:67]
ds_read_b128 v[228:231],v17 offset:51200
v_min3_u32 v27,v27,v232,v236
v_mul_f32 v127,v93,v95
v_mul_f32 v122,v28,v94
v_mul_f32 v126,v28,v95
v_mfma_f32_16x16x32_bf16 v[72:75],a[76:79],v[236:239],v[72:75]
ds_read_b128 v[232:235],v17 offset:53248
v_mul_f32 v92,v94,v94
v_mul_f32 v93,v95,v95
v_mul_f32 v94,s81,v94
s_waitcnt lgkmcnt(5)
v_mfma_f32_16x16x32_bf16 v[64:67],a[80:83],v[240:243],v[64:67]
ds_read_b128 v[236:239],v17 offset:55296
v_min3_u32 v27,v27,v240,v244
v_mul_f32 v95,s81,v95
v_mul_f32 v121,v92,v94
v_mul_f32 v125,v93,v95
v_mfma_f32_16x16x32_bf16 v[72:75],a[84:87],v[244:247],v[72:75]
ds_read_b128 v[240:243],v17 offset:57344
ds_write_b128 v19,v[120:123] offset:0
ds_write_b128 v19,v[124:127] offset:256
s_waitcnt lgkmcnt(7)
v_mfma_f32_16x16x32_bf16 v[64:67],a[88:91],v[248:251],v[64:67]
ds_read_b128 v[244:247],v17 offset:59392
v_min3_u32 v27,v27,v248,v252
v_mfma_f32_16x16x32_bf16 v[72:75],a[92:95],v[252:255],v[72:75]
ds_read_b128 v[248:251],v17 offset:61440
s_waitcnt lgkmcnt(7)
v_mfma_f32_16x16x32_bf16 v[64:67],a[96:99],v[224:227],v[64:67]
ds_read_b128 v[252:255],v17 offset:63488
v_min3_u32 v27,v27,v224,v228
v_mfma_f32_16x16x32_bf16 v[72:75],a[100:103],v[228:231],v[72:75]
s_waitcnt vmcnt(3) lgkmcnt(0)
s_barrier
ds_read_b64 v[44:45],v47
ds_read_b128 v[224:227],v17 offset:1024
s_waitcnt vmcnt(0)
v_add_u32 v22,s71,-1
v_mfma_f32_16x16x32_bf16 v[64:67],a[104:107],v[232:235],v[64:67]
ds_read_b128 v[228:231],v17 offset:3072
v_min3_u32 v27,v27,v232,v236
buffer_store_dword v22,v23,s[20:23],s97 offen sc1
s_mov_b32 s97,0x7fff0000
v_mfma_f32_16x16x32_bf16 v[72:75],a[108:111],v[236:239],v[72:75]
ds_read_b128 v[232:235],v17 offset:5120
v_mfma_f32_16x16x32_bf16 v[64:67],a[112:115],v[240:243],v[64:67]
ds_read_b128 v[236:239],v17 offset:7168
v_min3_u32 v27,v27,v240,v244
v_mfma_f32_16x16x32_bf16 v[72:75],a[116:119],v[244:247],v[72:75]
ds_read_b128 v[240:243],v17 offset:9216
s_waitcnt lgkmcnt(5)
v_readfirstlane_b32 s93,v45
v_mfma_f32_16x16x32_bf16 v[64:67],a[120:123],v[248:251],v[64:67]
ds_read_b128 v[244:247],v17 offset:11264
v_readfirstlane_b32 s83,v44
s_cmp_lg_u32 s83,0
s_cbranch_scc1 keep_404
v_min3_u32 v27,v27,v248,v252
v_mfma_f32_16x16x32_bf16 v[72:75],a[124:127],v[252:255],v[72:75]
ds_read_b128 v[248:251],v17 offset:13312
s_add_u32 s66,s88,110592
buffer_load_dwordx4 v[128:131],v16,s[20:23],s66 offen offset:0 sc1
buffer_load_dwordx4 v[132:135],v16,s[20:23],s66 offen offset:1024 sc1
s_waitcnt lgkmcnt(5)
v_mfma_f32_16x16x32_bf16 v[68:71],a[0:3],v[224:227],0
ds_read_b128 v[252:255],v17 offset:15360
v_cmp_eq_u32 vcc,0,v27
s_cbranch_vccnz retry_392
v_min3_u32 v27,v27,v224,v228
buffer_load_dwordx4 v[136:139],v16,s[20:23],s66 offen offset:2048 sc1
buffer_load_dwordx4 v[140:143],v16,s[20:23],s66 offen offset:3072 sc1
v_mfma_f32_16x16x32_bf16 v[76:79],a[4:7],v[228:231],0
ds_read_b128 v[224:227],v17 offset:17408
s_add_u32 s66,s88,114688
buffer_load_dwordx4 v[144:147],v16,s[20:23],s66 offen offset:0 sc1
buffer_load_dwordx4 v[148:151],v16,s[20:23],s66 offen offset:1024 sc1
s_waitcnt lgkmcnt(5)
v_mfma_f32_16x16x32_bf16 v[68:71],a[8:11],v[232:235],v[68:71]
ds_read_b128 v[228:231],v17 offset:19456
v_min3_u32 v27,v27,v232,v236
buffer_load_dwordx4 v[152:155],v16,s[20:23],s66 offen offset:2048 sc1
buffer_load_dwordx4 v[156:159],v16,s[20:23],s66 offen offset:3072 sc1
v_mfma_f32_16x16x32_bf16 v[76:79],a[12:15],v[236:239],v[76:79]
ds_read_b128 v[232:235],v17 offset:21504
s_xor_b32 m0,s72,0
s_add_u32 s65,s88,0
s_waitcnt lgkmcnt(5)
v_mfma_f32_16x16x32_bf16 v[68:71],a[16:19],v[240:243],v[68:71]
ds_read_b128 v[236:239],v17 offset:23552
v_min3_u32 v27,v27,v240,v244
v_add_f32 v64,v64,v72
v_add_f32 v65,v65,v73
v_add_f32 v66,v66,v74
v_add_f32 v67,v67,v75
buffer_load_dwordx4 v16,s[20:23],s65 offen offset:0 sc1 lds
v_mfma_f32_16x16x32_bf16 v[76:79],a[20:23],v[244:247],v[76:79]
ds_read_b128 v[240:243],v17 offset:25600
v_fmac_f32 v64,v52,v120
v_fmac_f32 v65,v53,v120
v_fmac_f32 v66,v54,v120
v_fmac_f32 v67,v55,v120
buffer_load_dwordx4 v16,s[20:23],s65 offen offset:2048 sc1 lds
s_waitcnt lgkmcnt(5)
v_mfma_f32_16x16x32_bf16 v[68:71],a[24:27],v[248:251],v[68:71]
ds_read_b128 v[244:247],v17 offset:27648
v_min3_u32 v27,v27,v248,v252
v_mul_f32 v88,v64,v64
v_mul_f32 v89,v65,v65
v_mul_f32 v90,v66,v66
v_mul_f32 v91,v67,v67
s_xor_b32 m0,s72,16384
s_add_u32 s65,s88,32768
v_mfma_f32_16x16x32_bf16 v[76:79],a[28:31],v[252:255],v[76:79]
ds_read_b128 v[248:251],v17 offset:29696
v_fma_f32 v88,v88,v121,v122
v_fma_f32 v89,v89,v121,v122
v_fma_f32 v90,v90,v121,v122
v_fma_f32 v91,v91,v121,v122
buffer_load_dwordx4 v16,s[20:23],s65 offen offset:0 sc1 lds
s_waitcnt lgkmcnt(5)
v_mfma_f32_16x16x32_bf16 v[68:71],a[32:35],v[224:227],v[68:71]
ds_read_b128 v[252:255],v17 offset:31744
v_min3_u32 v27,v27,v224,v228
v_mul_f32 v88,v88,v64
v_mul_f32 v89,v89,v65
v_mul_f32 v90,v90,v66
v_mul_f32 v91,v91,v67
buffer_load_dwordx4 v16,s[20:23],s65 offen offset:2048 sc1 lds
v_mfma_f32_16x16x32_bf16 v[76:79],a[36:39],v[228:231],v[76:79]
ds_read_b128 v[224:227],v17 offset:33792
v_exp_f32 v88,v88
v_exp_f32 v89,v89
s_xor_b32 m0,s72,32768
s_add_u32 s65,s88,65536
s_waitcnt lgkmcnt(5)
v_mfma_f32_16x16x32_bf16 v[68:71],a[40:43],v[232:235],v[68:71]
ds_read_b128 v[228:231],v17 offset:35840
v_min3_u32 v27,v27,v232,v236
v_exp_f32 v90,v90
v_exp_f32 v91,v91
buffer_load_dwordx4 v16,s[20:23],s65 offen offset:0 sc1 lds
v_mfma_f32_16x16x32_bf16 v[76:79],a[44:47],v[236:239],v[76:79]
ds_read_b128 v[232:235],v17 offset:37888
v_fma_f32 v88,v88,v123,v123
v_fma_f32 v89,v89,v123,v123
v_fma_f32 v90,v90,v123,v123
v_fma_f32 v91,v91,v123,v123
buffer_load_dwordx4 v16,s[20:23],s65 offen offset:2048 sc1 lds
s_waitcnt lgkmcnt(5)
v_mfma_f32_16x16x32_bf16 v[68:71],a[48:51],v[240:243],v[68:71]
ds_read_b128 v[236:239],v17 offset:39936
v_min3_u32 v27,v27,v240,v244
v_rcp_f32 v88,v88
v_rcp_f32 v89,v89
s_xor_b32 m0,s72,49152
s_add_u32 s65,s88,98304
v_mfma_f32_16x16x32_bf16 v[76:79],a[52:55],v[244:247],v[76:79]
ds_read_b128 v[240:243],v17 offset:41984
v_rcp_f32 v90,v90
v_rcp_f32 v91,v91
buffer_load_dwordx4 v16,s[20:23],s65 offen offset:0 sc1 lds
s_waitcnt lgkmcnt(5)
v_mfma_f32_16x16x32_bf16 v[68:71],a[56:59],v[248:251],v[68:71]
ds_read_b128 v[244:247],v17 offset:44032
v_min3_u32 v27,v27,v248,v252
v_mul_f32 v88,v88,v64
v_mul_f32 v89,v89,v65
v_mul_f32 v90,v90,v66
v_mul_f32 v91,v91,v67
v_mfma_f32_16x16x32_bf16 v[76:79],a[60:63],v[252:255],v[76:79]
ds_read_b128 v[248:251],v17 offset:46080
v_cvt_pk_bf16_f32 v96,v88,v89
v_cvt_pk_bf16_f32 v97,v90,v91
v_max_u32 v96,1,v96
s_waitcnt lgkmcnt(5)
v_mfma_f32_16x16x32_bf16 v[68:71],a[64:67],v[224:227],v[68:71]
ds_read_b128 v[252:255],v17 offset:48128
v_min3_u32 v27,v27,v224,v228
buffer_store_dwordx2 v[96:97],v18,s[20:23],s70 offen offset:0 sc1
buffer_load_dwordx4 v16,s[20:23],s65 offen offset:2048 sc1 lds
v_mfma_f32_16x16x32_bf16 v[76:79],a[68:71],v[228:231],v[76:79]
ds_read_b128 v[224:227],v17 offset:50176
s_xor_b32 m0,s72,1024
s_add_u32 s65,s89,0
buffer_load_dwordx4 v16,s[20:23],s65 offen offset:0 sc1 lds
s_waitcnt lgkmcnt(5)
v_mfma_f32_16x16x32_bf16 v[68:71],a[72:75],v[232:235],v[68:71]
ds_read_b128 v[228:231],v17 offset:52224
v_min3_u32 v27,v27,v232,v236
buffer_load_dwordx4 v16,s[20:23],s65 offen offset:2048 sc1 lds
s_xor_b32 m0,s72,17408
s_add_u32 s65,s89,32768
v_mfma_f32_16x16x32_bf16 v[76:79],a[76:79],v[236:239],v[76:79]
ds_read_b128 v[232:235],v17 offset:54272
buffer_load_dwordx4 v16,s[20:23],s65 offen offset:0 sc1 lds
buffer_load_dwordx4 v16,s[20:23],s65 offen offset:2048 sc1 lds
s_waitcnt lgkmcnt(5)
v_mfma_f32_16x16x32_bf16 v[68:71],a[80:83],v[240:243],v[68:71]
ds_read_b128 v[236:239],v17 offset:56320
v_min3_u32 v27,v27,v240,v244
s_xor_b32 m0,s72,33792
s_add_u32 s65,s89,65536
buffer_load_dwordx4 v16,s[20:23],s65 offen offset:0 sc1 lds
v_mfma_f32_16x16x32_bf16 v[76:79],a[84:87],v[244:247],v[76:79]
ds_read_b128 v[240:243],v17 offset:58368
buffer_load_dwordx4 v16,s[20:23],s65 offen offset:2048 sc1 lds
s_xor_b32 m0,s72,50176
s_add_u32 s65,s89,98304
s_waitcnt lgkmcnt(5)
v_mfma_f32_16x16x32_bf16 v[68:71],a[88:91],v[248:251],v[68:71]
ds_read_b128 v[244:247],v17 offset:60416
v_min3_u32 v27,v27,v248,v252
buffer_load_dwordx4 v16,s[20:23],s65 offen offset:0 sc1 lds
buffer_load_dwordx4 v16,s[20:23],s65 offen offset:2048 sc1 lds
v_mfma_f32_16x16x32_bf16 v[76:79],a[92:95],v[252:255],v[76:79]
ds_read_b128 v[248:251],v17 offset:62464
s_waitcnt lgkmcnt(5)
v_mfma_f32_16x16x32_bf16 v[68:71],a[96:99],v[224:227],v[68:71]
ds_read_b128 v[252:255],v17 offset:64512
v_min3_u32 v27,v27,v224,v228
v_mfma_f32_16x16x32_bf16 v[76:79],a[100:103],v[228:231],v[76:79]
s_waitcnt lgkmcnt(4)
v_mfma_f32_16x16x32_bf16 v[68:71],a[104:107],v[232:235],v[68:71]
v_min3_u32 v27,v27,v232,v236
v_mfma_f32_16x16x32_bf16 v[76:79],a[108:111],v[236:239],v[76:79]
s_waitcnt lgkmcnt(2)
v_mfma_f32_16x16x32_bf16 v[68:71],a[112:115],v[240:243],v[68:71]
v_min3_u32 v27,v27,v240,v244
v_mfma_f32_16x16x32_bf16 v[76:79],a[116:119],v[244:247],v[76:79]
s_waitcnt lgkmcnt(0)
v_mfma_f32_16x16x32_bf16 v[68:71],a[120:123],v[248:251],v[68:71]
v_min3_u32 v27,v27,v248,v252
v_mfma_f32_16x16x32_bf16 v[76:79],a[124:127],v[252:255],v[76:79]
v_cmp_eq_u32 vcc,0,v27
s_cbranch_vccnz retry_392
s_branch epi_395
keep_404:
v_min3_u32 v27,v27,v248,v252
v_mfma_f32_16x16x32_bf16 v[72:75],a[124:127],v[252:255],v[72:75]
ds_read_b128 v[248:251],v17 offset:13312
s_waitcnt lgkmcnt(5)
v_mfma_f32_16x16x32_bf16 v[68:71],a[0:3],v[224:227],0
ds_read_b128 v[252:255],v17 offset:15360
v_cmp_eq_u32 vcc,0,v27
s_cbranch_vccnz retry_392
v_min3_u32 v27,v27,v224,v228
v_mfma_f32_16x16x32_bf16 v[76:79],a[4:7],v[228:231],0
ds_read_b128 v[224:227],v17 offset:17408
s_waitcnt lgkmcnt(5)
v_mfma_f32_16x16x32_bf16 v[68:71],a[8:11],v[232:235],v[68:71]
ds_read_b128 v[228:231],v17 offset:19456
v_min3_u32 v27,v27,v232,v236
v_mfma_f32_16x16x32_bf16 v[76:79],a[12:15],v[236:239],v[76:79]
ds_read_b128 v[232:235],v17 offset:21504
s_waitcnt lgkmcnt(5)
v_mfma_f32_16x16x32_bf16 v[68:71],a[16:19],v[240:243],v[68:71]
ds_read_b128 v[236:239],v17 offset:23552
v_min3_u32 v27,v27,v240,v244
v_add_f32 v64,v64,v72
v_add_f32 v65,v65,v73
v_add_f32 v66,v66,v74
v_add_f32 v67,v67,v75
v_mfma_f32_16x16x32_bf16 v[76:79],a[20:23],v[244:247],v[76:79]
ds_read_b128 v[240:243],v17 offset:25600
v_fmac_f32 v64,v52,v120
v_fmac_f32 v65,v53,v120
v_fmac_f32 v66,v54,v120
v_fmac_f32 v67,v55,v120
s_waitcnt lgkmcnt(5)
v_mfma_f32_16x16x32_bf16 v[68:71],a[24:27],v[248:251],v[68:71]
ds_read_b128 v[244:247],v17 offset:27648
v_min3_u32 v27,v27,v248,v252
v_mul_f32 v88,v64,v64
v_mul_f32 v89,v65,v65
v_mul_f32 v90,v66,v66
v_mul_f32 v91,v67,v67
v_mfma_f32_16x16x32_bf16 v[76:79],a[28:31],v[252:255],v[76:79]
ds_read_b128 v[248:251],v17 offset:29696
v_fma_f32 v88,v88,v121,v122
v_fma_f32 v89,v89,v121,v122
v_fma_f32 v90,v90,v121,v122
v_fma_f32 v91,v91,v121,v122
s_waitcnt lgkmcnt(5)
v_mfma_f32_16x16x32_bf16 v[68:71],a[32:35],v[224:227],v[68:71]
ds_read_b128 v[252:255],v17 offset:31744
v_min3_u32 v27,v27,v224,v228
v_mul_f32 v88,v88,v64
v_mul_f32 v89,v89,v65
v_mul_f32 v90,v90,v66
v_mul_f32 v91,v91,v67
v_mfma_f32_16x16x32_bf16 v[76:79],a[36:39],v[228:231],v[76:79]
ds_read_b128 v[224:227],v17 offset:33792
v_exp_f32 v88,v88
v_exp_f32 v89,v89
s_waitcnt lgkmcnt(5)
v_mfma_f32_16x16x32_bf16 v[68:71],a[40:43],v[232:235],v[68:71]
ds_read_b128 v[228:231],v17 offset:35840
v_min3_u32 v27,v27,v232,v236
v_exp_f32 v90,v90
v_exp_f32 v91,v91
v_mfma_f32_16x16x32_bf16 v[76:79],a[44:47],v[236:239],v[76:79]
ds_read_b128 v[232:235],v17 offset:37888
v_fma_f32 v88,v88,v123,v123
v_fma_f32 v89,v89,v123,v123
v_fma_f32 v90,v90,v123,v123
v_fma_f32 v91,v91,v123,v123
s_waitcnt lgkmcnt(5)
v_mfma_f32_16x16x32_bf16 v[68:71],a[48:51],v[240:243],v[68:71]
ds_read_b128 v[236:239],v17 offset:39936
v_min3_u32 v27,v27,v240,v244
v_rcp_f32 v88,v88
v_rcp_f32 v89,v89
v_mfma_f32_16x16x32_bf16 v[76:79],a[52:55],v[244:247],v[76:79]
ds_read_b128 v[240:243],v17 offset:41984
v_rcp_f32 v90,v90
v_rcp_f32 v91,v91
s_waitcnt lgkmcnt(5)
v_mfma_f32_16x16x32_bf16 v[68:71],a[56:59],v[248:251],v[68:71]
ds_read_b128 v[244:247],v17 offset:44032
v_min3_u32 v27,v27,v248,v252
v_mul_f32 v88,v88,v64
v_mul_f32 v89,v89,v65
v_mul_f32 v90,v90,v66
v_mul_f32 v91,v91,v67
v_mfma_f32_16x16x32_bf16 v[76:79],a[60:63],v[252:255],v[76:79]
ds_read_b128 v[248:251],v17 offset:46080
v_cvt_pk_bf16_f32 v96,v88,v89
v_cvt_pk_bf16_f32 v97,v90,v91
v_max_u32 v96,1,v96
s_waitcnt lgkmcnt(5)
v_mfma_f32_16x16x32_bf16 v[68:71],a[64:67],v[224:227],v[68:71]
ds_read_b128 v[252:255],v17 offset:48128
v_min3_u32 v27,v27,v224,v228
buffer_store_dwordx2 v[96:97],v18,s[20:23],s70 offen offset:0 sc1
v_mfma_f32_16x16x32_bf16 v[76:79],a[68:71],v[228:231],v[76:79]
ds_read_b128 v[224:227],v17 offset:50176
s_waitcnt lgkmcnt(5)
v_mfma_f32_16x16x32_bf16 v[68:71],a[72:75],v[232:235],v[68:71]
ds_read_b128 v[228:231],v17 offset:52224
v_min3_u32 v27,v27,v232,v236
v_mfma_f32_16x16x32_bf16 v[76:79],a[76:79],v[236:239],v[76:79]
ds_read_b128 v[232:235],v17 offset:54272
s_waitcnt lgkmcnt(5)
v_mfma_f32_16x16x32_bf16 v[68:71],a[80:83],v[240:243],v[68:71]
ds_read_b128 v[236:239],v17 offset:56320
v_min3_u32 v27,v27,v240,v244
v_mfma_f32_16x16x32_bf16 v[76:79],a[84:87],v[244:247],v[76:79]
ds_read_b128 v[240:243],v17 offset:58368
s_waitcnt lgkmcnt(5)
v_mfma_f32_16x16x32_bf16 v[68:71],a[88:91],v[248:251],v[68:71]
ds_read_b128 v[244:247],v17 offset:60416
v_min3_u32 v27,v27,v248,v252
v_mfma_f32_16x16x32_bf16 v[76:79],a[92:95],v[252:255],v[76:79]
ds_read_b128 v[248:251],v17 offset:62464
s_waitcnt lgkmcnt(5)
v_mfma_f32_16x16x32_bf16 v[68:71],a[96:99],v[224:227],v[68:71]
ds_read_b128 v[252:255],v17 offset:64512
v_min3_u32 v27,v27,v224,v228
v_mfma_f32_16x16x32_bf16 v[76:79],a[100:103],v[228:231],v[76:79]
s_waitcnt lgkmcnt(4)
v_mfma_f32_16x16x32_bf16 v[68:71],a[104:107],v[232:235],v[68:71]
v_min3_u32 v27,v27,v232,v236
v_mfma_f32_16x16x32_bf16 v[76:79],a[108:111],v[236:239],v[76:79]
s_waitcnt lgkmcnt(2)
v_mfma_f32_16x16x32_bf16 v[68:71],a[112:115],v[240:243],v[68:71]
v_min3_u32 v27,v27,v240,v244
v_mfma_f32_16x16x32_bf16 v[76:79],a[116:119],v[244:247],v[76:79]
s_waitcnt lgkmcnt(0)
v_mfma_f32_16x16x32_bf16 v[68:71],a[120:123],v[248:251],v[68:71]
v_min3_u32 v27,v27,v248,v252
v_mfma_f32_16x16x32_bf16 v[76:79],a[124:127],v[252:255],v[76:79]
v_cmp_eq_u32 vcc,0,v27
s_cbranch_vccnz retry_392
s_branch epi_395
both_396:
s_waitcnt vmcnt(11) lgkmcnt(0)
s_barrier
ds_read_b128 v[224:227],v17 offset:0
ds_read_b128 v[228:231],v17 offset:2048
ds_read_b128 v[232:235],v17 offset:4096
ds_read_b128 v[236:239],v17 offset:6144
ds_read_b128 v[240:243],v17 offset:8192
ds_read_b128 v[244:247],v17 offset:10240
ds_read_b128 v[248:251],v17 offset:12288
s_waitcnt lgkmcnt(5)
v_mfma_f32_16x16x32_bf16 v[64:67],a[0:3],v[224:227],0
ds_read_b128 v[252:255],v17 offset:14336
v_min_u32 v27,v224,v228
s_waitcnt vmcnt(12)
stk_411:
v_min3_u32 v22,v129,v133,v137
v_min3_u32 v22,v22,v141,v145
v_min3_u32 v22,v22,v149,v153
v_min_u32 v22,v22,v157
v_cmp_eq_u32 vcc,0,v22
s_cmp_lt_i32 s90,0
s_cselect_b64 vcc,0,vcc
s_cbranch_vccnz str_412
v_mfma_f32_16x16x32_bf16 v[72:75],a[4:7],v[228:231],0
ds_read_b128 v[224:227],v17 offset:16384
v_pk_add_f32 v[88:89],v[128:129],v[144:145]
v_pk_add_f32 v[90:91],v[130:131],v[146:147]
v_pk_add_f32 v[92:93],v[132:133],v[148:149]
v_pk_add_f32 v[94:95],v[134:135],v[150:151]
s_waitcnt lgkmcnt(5)
v_mfma_f32_16x16x32_bf16 v[64:67],a[8:11],v[232:235],v[64:67]
ds_read_b128 v[228:231],v17 offset:18432
v_min3_u32 v27,v27,v232,v236
v_pk_add_f32 v[96:97],v[136:137],v[152:153]
v_pk_add_f32 v[98:99],v[138:139],v[154:155]
v_pk_add_f32 v[100:101],v[140:141],v[156:157]
v_pk_add_f32 v[102:103],v[142:143],v[158:159]
v_mfma_f32_16x16x32_bf16 v[72:75],a[12:15],v[236:239],v[72:75]
ds_read_b128 v[232:235],v17 offset:20480
s_add_u32 s88,s70,s75
s_add_u32 s88,s88,2097152
s_xor_b32 s88,s88,0x2000
s_xor_b32 s89,s88,1024
s_waitcnt lgkmcnt(5)
v_mfma_f32_16x16x32_bf16 v[64:67],a[16:19],v[240:243],v[64:67]
ds_read_b128 v[236:239],v17 offset:22528
v_min3_u32 v27,v27,v240,v244
v_pk_add_f32 v[88:89],v[88:89],v[96:97]
v_pk_add_f32 v[90:91],v[90:91],v[98:99]
v_pk_add_f32 v[92:93],v[92:93],v[100:101]
v_mfma_f32_16x16x32_bf16 v[72:75],a[20:23],v[244:247],v[72:75]
ds_read_b128 v[240:243],v17 offset:24576
v_pk_add_f32 v[94:95],v[94:95],v[102:103]
v_pk_add_f32 v[88:89],v[88:89],v[92:93]
v_pk_add_f32 v[90:91],v[90:91],v[94:95]
s_waitcnt lgkmcnt(5)
v_mfma_f32_16x16x32_bf16 v[64:67],a[24:27],v[248:251],v[64:67]
ds_read_b128 v[244:247],v17 offset:26624
v_min3_u32 v27,v27,v248,v252
v_mov_b32 v92,v88
v_mov_b32 v93,v89
v_mov_b32 v94,v90
v_mfma_f32_16x16x32_bf16 v[72:75],a[28:31],v[252:255],v[72:75]
ds_read_b128 v[248:251],v17 offset:28672
v_mov_b32 v95,v91
v_permlane16_swap_b32 v92,v88
v_permlane16_swap_b32 v93,v89
s_waitcnt lgkmcnt(5)
v_mfma_f32_16x16x32_bf16 v[64:67],a[32:35],v[224:227],v[64:67]
ds_read_b128 v[252:255],v17 offset:30720
v_min3_u32 v27,v27,v224,v228
v_permlane16_swap_b32 v94,v90
v_permlane16_swap_b32 v95,v91
s_add_u32 s66,s88,110592
buffer_load_dwordx4 v[128:131],v16,s[20:23],s66 offen offset:0 sc1
v_mfma_f32_16x16x32_bf16 v[72:75],a[36:39],v[228:231],v[72:75]
ds_read_b128 v[224:227],v17 offset:32768
v_pk_add_f32 v[88:89],v[88:89],v[92:93]
v_pk_add_f32 v[90:91],v[90:91],v[94:95]
v_mov_b32 v92,v88
buffer_load_dwordx4 v[132:135],v16,s[20:23],s66 offen offset:1024 sc1
s_waitcnt lgkmcnt(5)
v_mfma_f32_16x16x32_bf16 v[64:67],a[40:43],v[232:235],v[64:67]
ds_read_b128 v[228:231],v17 offset:34816
v_min3_u32 v27,v27,v232,v236
v_mov_b32 v93,v89
v_mov_b32 v94,v90
v_mov_b32 v95,v91
buffer_load_dwordx4 v[136:139],v16,s[20:23],s66 offen offset:2048 sc1
v_mfma_f32_16x16x32_bf16 v[72:75],a[44:47],v[236:239],v[72:75]
ds_read_b128 v[232:235],v17 offset:36864
v_permlane32_swap_b32 v92,v88
v_permlane32_swap_b32 v93,v89
v_permlane32_swap_b32 v94,v90
buffer_load_dwordx4 v[140:143],v16,s[20:23],s66 offen offset:3072 sc1
s_waitcnt lgkmcnt(5)
v_mfma_f32_16x16x32_bf16 v[64:67],a[48:51],v[240:243],v[64:67]
ds_read_b128 v[236:239],v17 offset:38912
v_min3_u32 v27,v27,v240,v244
v_permlane32_swap_b32 v95,v91
v_pk_add_f32 v[88:89],v[88:89],v[92:93]
s_add_u32 s66,s88,114688
buffer_load_dwordx4 v[144:147],v16,s[20:23],s66 offen offset:0 sc1
v_mfma_f32_16x16x32_bf16 v[72:75],a[52:55],v[244:247],v[72:75]
ds_read_b128 v[240:243],v17 offset:40960
v_pk_add_f32 v[90:91],v[90:91],v[94:95]
v_mul_f32 v120,0xba800000,v88
v_mul_f32 v124,0xba800000,v90
buffer_load_dwordx4 v[148:151],v16,s[20:23],s66 offen offset:1024 sc1
s_waitcnt lgkmcnt(5)
v_mfma_f32_16x16x32_bf16 v[64:67],a[56:59],v[248:251],v[64:67]
ds_read_b128 v[244:247],v17 offset:43008
v_min3_u32 v27,v27,v248,v252
v_mul_f32 v92,v120,v120
v_mul_f32 v93,v124,v124
v_fma_f32 v92,v89,s82,-v92
buffer_load_dwordx4 v[152:155],v16,s[20:23],s66 offen offset:2048 sc1
v_mfma_f32_16x16x32_bf16 v[72:75],a[60:63],v[252:255],v[72:75]
ds_read_b128 v[248:251],v17 offset:45056
v_fma_f32 v93,v91,s82,-v93
v_max_f32 v92,0,v92
v_max_f32 v93,0,v93
buffer_load_dwordx4 v[156:159],v16,s[20:23],s66 offen offset:3072 sc1
s_waitcnt lgkmcnt(5)
v_mfma_f32_16x16x32_bf16 v[64:67],a[64:67],v[224:227],v[64:67]
ds_read_b128 v[252:255],v17 offset:47104
v_min3_u32 v27,v27,v224,v228
v_add_f32 v92,0x3727c5ac,v92
v_add_f32 v93,0x3727c5ac,v93
v_rsq_f32 v94,v92
s_xor_b32 m0,s72,0
v_mfma_f32_16x16x32_bf16 v[72:75],a[68:71],v[228:231],v[72:75]
ds_read_b128 v[224:227],v17 offset:49152
v_rsq_f32 v95,v93
v_mul_f32 v123,v92,v94
s_add_u32 s65,s88,0
s_waitcnt lgkmcnt(5)
v_mfma_f32_16x16x32_bf16 v[64:67],a[72:75],v[232:235],v[64:67]
ds_read_b128 v[228:231],v17 offset:51200
v_min3_u32 v27,v27,v232,v236
v_mul_f32 v127,v93,v95
v_mul_f32 v122,v28,v94
v_mul_f32 v126,v28,v95
buffer_load_dwordx4 v16,s[20:23],s65 offen offset:0 sc1 lds
v_mfma_f32_16x16x32_bf16 v[72:75],a[76:79],v[236:239],v[72:75]
ds_read_b128 v[232:235],v17 offset:53248
v_mul_f32 v92,v94,v94
v_mul_f32 v93,v95,v95
v_mul_f32 v94,s81,v94
buffer_load_dwordx4 v16,s[20:23],s65 offen offset:2048 sc1 lds
s_waitcnt lgkmcnt(5)
v_mfma_f32_16x16x32_bf16 v[64:67],a[80:83],v[240:243],v[64:67]
ds_read_b128 v[236:239],v17 offset:55296
v_min3_u32 v27,v27,v240,v244
v_mul_f32 v95,s81,v95
v_mul_f32 v121,v92,v94
v_mul_f32 v125,v93,v95
s_xor_b32 m0,s72,16384
v_mfma_f32_16x16x32_bf16 v[72:75],a[84:87],v[244:247],v[72:75]
ds_read_b128 v[240:243],v17 offset:57344
ds_write_b128 v19,v[120:123] offset:0
ds_write_b128 v19,v[124:127] offset:256
s_add_u32 s65,s88,32768
s_waitcnt lgkmcnt(7)
v_mfma_f32_16x16x32_bf16 v[64:67],a[88:91],v[248:251],v[64:67]
ds_read_b128 v[244:247],v17 offset:59392
v_min3_u32 v27,v27,v248,v252
buffer_load_dwordx4 v16,s[20:23],s65 offen offset:0 sc1 lds
buffer_load_dwordx4 v16,s[20:23],s65 offen offset:2048 sc1 lds
v_mfma_f32_16x16x32_bf16 v[72:75],a[92:95],v[252:255],v[72:75]
ds_read_b128 v[248:251],v17 offset:61440
s_xor_b32 m0,s72,32768
s_add_u32 s65,s88,65536
buffer_load_dwordx4 v16,s[20:23],s65 offen offset:0 sc1 lds
s_waitcnt lgkmcnt(7)
v_mfma_f32_16x16x32_bf16 v[64:67],a[96:99],v[224:227],v[64:67]
ds_read_b128 v[252:255],v17 offset:63488
v_min3_u32 v27,v27,v224,v228
buffer_load_dwordx4 v16,s[20:23],s65 offen offset:2048 sc1 lds
s_xor_b32 m0,s72,49152
s_add_u32 s65,s88,98304
v_mfma_f32_16x16x32_bf16 v[72:75],a[100:103],v[228:231],v[72:75]
s_waitcnt vmcnt(17) lgkmcnt(0)
s_barrier
ds_read_b64 v[44:45],v47
ds_read_b128 v[224:227],v17 offset:1024
s_waitcnt vmcnt(14)
v_add_u32 v22,s71,-1
v_mfma_f32_16x16x32_bf16 v[64:67],a[104:107],v[232:235],v[64:67]
ds_read_b128 v[228:231],v17 offset:3072
v_min3_u32 v27,v27,v232,v236
buffer_store_dword v22,v23,s[20:23],s97 offen sc1
s_mov_b32 s97,0x7fff0000
v_mfma_f32_16x16x32_bf16 v[72:75],a[108:111],v[236:239],v[72:75]
ds_read_b128 v[232:235],v17 offset:5120
buffer_load_dwordx4 v16,s[20:23],s65 offen offset:0 sc1 lds
buffer_load_dwordx4 v16,s[20:23],s65 offen offset:2048 sc1 lds
v_mfma_f32_16x16x32_bf16 v[64:67],a[112:115],v[240:243],v[64:67]
ds_read_b128 v[236:239],v17 offset:7168
v_min3_u32 v27,v27,v240,v244
s_xor_b32 m0,s72,1024
s_add_u32 s65,s89,0
buffer_load_dwordx4 v16,s[20:23],s65 offen offset:0 sc1 lds
v_mfma_f32_16x16x32_bf16 v[72:75],a[116:119],v[244:247],v[72:75]
ds_read_b128 v[240:243],v17 offset:9216
s_waitcnt lgkmcnt(5)
v_readfirstlane_b32 s93,v45
buffer_load_dwordx4 v16,s[20:23],s65 offen offset:2048 sc1 lds
v_mfma_f32_16x16x32_bf16 v[64:67],a[120:123],v[248:251],v[64:67]
ds_read_b128 v[244:247],v17 offset:11264
v_min3_u32 v27,v27,v248,v252
s_xor_b32 m0,s72,17408
s_add_u32 s65,s89,32768
buffer_load_dwordx4 v16,s[20:23],s65 offen offset:0 sc1 lds
v_mfma_f32_16x16x32_bf16 v[72:75],a[124:127],v[252:255],v[72:75]
ds_read_b128 v[248:251],v17 offset:13312
buffer_load_dwordx4 v16,s[20:23],s65 offen offset:2048 sc1 lds
s_xor_b32 m0,s72,33792
s_add_u32 s65,s89,65536
s_waitcnt lgkmcnt(5)
v_mfma_f32_16x16x32_bf16 v[68:71],a[0:3],v[224:227],0
ds_read_b128 v[252:255],v17 offset:15360
v_cmp_eq_u32 vcc,0,v27
s_cbranch_vccnz retry_392
v_min3_u32 v27,v27,v224,v228
buffer_load_dwordx4 v16,s[20:23],s65 offen offset:0 sc1 lds
v_mfma_f32_16x16x32_bf16 v[76:79],a[4:7],v[228:231],0
ds_read_b128 v[224:227],v17 offset:17408
buffer_load_dwordx4 v16,s[20:23],s65 offen offset:2048 sc1 lds
s_xor_b32 m0,s72,50176
s_add_u32 s65,s89,98304
s_waitcnt lgkmcnt(5)
v_mfma_f32_16x16x32_bf16 v[68:71],a[8:11],v[232:235],v[68:71]
ds_read_b128 v[228:231],v17 offset:19456
v_min3_u32 v27,v27,v232,v236
buffer_load_dwordx4 v16,s[20:23],s65 offen offset:0 sc1 lds
buffer_load_dwordx4 v16,s[20:23],s65 offen offset:2048 sc1 lds
v_mfma_f32_16x16x32_bf16 v[76:79],a[12:15],v[236:239],v[76:79]
ds_read_b128 v[232:235],v17 offset:21504
s_waitcnt lgkmcnt(5)
v_mfma_f32_16x16x32_bf16 v[68:71],a[16:19],v[240:243],v[68:71]
ds_read_b128 v[236:239],v17 offset:23552
v_min3_u32 v27,v27,v240,v244
v_add_f32 v64,v64,v72
v_add_f32 v65,v65,v73
v_add_f32 v66,v66,v74
v_add_f32 v67,v67,v75
v_mfma_f32_16x16x32_bf16 v[76:79],a[20:23],v[244:247],v[76:79]
ds_read_b128 v[240:243],v17 offset:25600
v_fmac_f32 v64,v52,v120
v_fmac_f32 v65,v53,v120
v_fmac_f32 v66,v54,v120
v_fmac_f32 v67,v55,v120
s_waitcnt lgkmcnt(5)
v_mfma_f32_16x16x32_bf16 v[68:71],a[24:27],v[248:251],v[68:71]
ds_read_b128 v[244:247],v17 offset:27648
v_min3_u32 v27,v27,v248,v252
v_mul_f32 v88,v64,v64
v_mul_f32 v89,v65,v65
v_mul_f32 v90,v66,v66
v_mul_f32 v91,v67,v67
v_mfma_f32_16x16x32_bf16 v[76:79],a[28:31],v[252:255],v[76:79]
ds_read_b128 v[248:251],v17 offset:29696
v_fma_f32 v88,v88,v121,v122
v_fma_f32 v89,v89,v121,v122
v_fma_f32 v90,v90,v121,v122
v_fma_f32 v91,v91,v121,v122
s_waitcnt lgkmcnt(5)
v_mfma_f32_16x16x32_bf16 v[68:71],a[32:35],v[224:227],v[68:71]
ds_read_b128 v[252:255],v17 offset:31744
v_min3_u32 v27,v27,v224,v228
v_mul_f32 v88,v88,v64
v_mul_f32 v89,v89,v65
v_mul_f32 v90,v90,v66
v_mul_f32 v91,v91,v67
v_mfma_f32_16x16x32_bf16 v[76:79],a[36:39],v[228:231],v[76:79]
ds_read_b128 v[224:227],v17 offset:33792
v_exp_f32 v88,v88
v_exp_f32 v89,v89
s_waitcnt lgkmcnt(5)
v_mfma_f32_16x16x32_bf16 v[68:71],a[40:43],v[232:235],v[68:71]
ds_read_b128 v[228:231],v17 offset:35840
v_min3_u32 v27,v27,v232,v236
v_exp_f32 v90,v90
v_exp_f32 v91,v91
v_mfma_f32_16x16x32_bf16 v[76:79],a[44:47],v[236:239],v[76:79]
ds_read_b128 v[232:235],v17 offset:37888
v_fma_f32 v88,v88,v123,v123
v_fma_f32 v89,v89,v123,v123
v_fma_f32 v90,v90,v123,v123
v_fma_f32 v91,v91,v123,v123
s_waitcnt lgkmcnt(5)
v_mfma_f32_16x16x32_bf16 v[68:71],a[48:51],v[240:243],v[68:71]
ds_read_b128 v[236:239],v17 offset:39936
v_min3_u32 v27,v27,v240,v244
v_rcp_f32 v88,v88
v_rcp_f32 v89,v89
v_mfma_f32_16x16x32_bf16 v[76:79],a[52:55],v[244:247],v[76:79]
ds_read_b128 v[240:243],v17 offset:41984
v_rcp_f32 v90,v90
v_rcp_f32 v91,v91
s_waitcnt lgkmcnt(5)
v_mfma_f32_16x16x32_bf16 v[68:71],a[56:59],v[248:251],v[68:71]
ds_read_b128 v[244:247],v17 offset:44032
v_min3_u32 v27,v27,v248,v252
v_mul_f32 v88,v88,v64
v_mul_f32 v89,v89,v65
v_mul_f32 v90,v90,v66
v_mul_f32 v91,v91,v67
v_mfma_f32_16x16x32_bf16 v[76:79],a[60:63],v[252:255],v[76:79]
ds_read_b128 v[248:251],v17 offset:46080
v_cvt_pk_bf16_f32 v96,v88,v89
v_cvt_pk_bf16_f32 v97,v90,v91
v_max_u32 v96,1,v96
s_waitcnt lgkmcnt(5)
v_mfma_f32_16x16x32_bf16 v[68:71],a[64:67],v[224:227],v[68:71]
ds_read_b128 v[252:255],v17 offset:48128
v_min3_u32 v27,v27,v224,v228
buffer_store_dwordx2 v[96:97],v18,s[20:23],s70 offen offset:0 sc1
v_mfma_f32_16x16x32_bf16 v[76:79],a[68:71],v[228:231],v[76:79]
ds_read_b128 v[224:227],v17 offset:50176
s_waitcnt lgkmcnt(5)
v_mfma_f32_16x16x32_bf16 v[68:71],a[72:75],v[232:235],v[68:71]
ds_read_b128 v[228:231],v17 offset:52224
v_min3_u32 v27,v27,v232,v236
v_mfma_f32_16x16x32_bf16 v[76:79],a[76:79],v[236:239],v[76:79]
ds_read_b128 v[232:235],v17 offset:54272
s_waitcnt lgkmcnt(5)
v_mfma_f32_16x16x32_bf16 v[68:71],a[80:83],v[240:243],v[68:71]
ds_read_b128 v[236:239],v17 offset:56320
v_min3_u32 v27,v27,v240,v244
v_mfma_f32_16x16x32_bf16 v[76:79],a[84:87],v[244:247],v[76:79]
ds_read_b128 v[240:243],v17 offset:58368
s_waitcnt lgkmcnt(5)
v_mfma_f32_16x16x32_bf16 v[68:71],a[88:91],v[248:251],v[68:71]
ds_read_b128 v[244:247],v17 offset:60416
v_min3_u32 v27,v27,v248,v252
v_mfma_f32_16x16x32_bf16 v[76:79],a[92:95],v[252:255],v[76:79]
ds_read_b128 v[248:251],v17 offset:62464
s_waitcnt lgkmcnt(5)
v_mfma_f32_16x16x32_bf16 v[68:71],a[96:99],v[224:227],v[68:71]
ds_read_b128 v[252:255],v17 offset:64512
v_min3_u32 v27,v27,v224,v228
v_mfma_f32_16x16x32_bf16 v[76:79],a[100:103],v[228:231],v[76:79]
s_waitcnt lgkmcnt(4)
v_mfma_f32_16x16x32_bf16 v[68:71],a[104:107],v[232:235],v[68:71]
v_min3_u32 v27,v27,v232,v236
v_mfma_f32_16x16x32_bf16 v[76:79],a[108:111],v[236:239],v[76:79]
s_waitcnt lgkmcnt(2)
v_mfma_f32_16x16x32_bf16 v[68:71],a[112:115],v[240:243],v[68:71]
v_min3_u32 v27,v27,v240,v244
v_mfma_f32_16x16x32_bf16 v[76:79],a[116:119],v[244:247],v[76:79]
s_waitcnt lgkmcnt(0)
v_mfma_f32_16x16x32_bf16 v[68:71],a[120:123],v[248:251],v[68:71]
v_min3_u32 v27,v27,v248,v252
v_mfma_f32_16x16x32_bf16 v[76:79],a[124:127],v[252:255],v[76:79]
v_cmp_eq_u32 vcc,0,v27
s_cbranch_vccnz retry_392
epi_395:
buffer_load_dword v29,v21,s[20:23],s87 offen sc1
s_nop 4
v_pk_add_f32 v[68:69],v[68:69],v[76:77]
v_pk_add_f32 v[70:71],v[70:71],v[78:79]
v_pk_fma_f32 v[68:69],v[52:53],v[124:125],v[68:69] op_sel_hi:[1,0,1]
v_pk_fma_f32 v[70:71],v[54:55],v[124:125],v[70:71] op_sel_hi:[1,0,1]
v_pk_mul_f32 v[88:89],v[68:69],v[68:69]
v_pk_mul_f32 v[90:91],v[70:71],v[70:71]
v_pk_fma_f32 v[88:89],v[88:89],v[124:125],v[126:127] op_sel:[0,1,0] op_sel_hi:[1,1,0]
v_pk_fma_f32 v[90:91],v[90:91],v[124:125],v[126:127] op_sel:[0,1,0] op_sel_hi:[1,1,0]
v_pk_mul_f32 v[88:89],v[88:89],v[68:69]
v_pk_mul_f32 v[90:91],v[90:91],v[70:71]
v_exp_f32 v88,v88
v_exp_f32 v89,v89
v_exp_f32 v90,v90
s_cmp_gt_u32 s71,40
s_cselect_b32 s65,s73,0x7fff0000
s_cselect_b32 s97,0x7fff0000,s73
v_mov_b32 v22,s71
buffer_store_dword v22,v23,s[20:23],s65 offen sc1
v_exp_f32 v91,v91
v_pk_fma_f32 v[88:89],v[88:89],v[126:127],v[126:127] op_sel:[0,1,1] op_sel_hi:[1,1,1]
v_pk_fma_f32 v[90:91],v[90:91],v[126:127],v[126:127] op_sel:[0,1,1] op_sel_hi:[1,1,1]
v_rcp_f32 v88,v88
v_rcp_f32 v89,v89
v_rcp_f32 v90,v90
v_rcp_f32 v91,v91
v_pk_mul_f32 v[88:89],v[88:89],v[68:69]
v_pk_mul_f32 v[90:91],v[90:91],v[70:71]
v_cvt_pk_bf16_f32 v96,v88,v89
v_cvt_pk_bf16_f32 v97,v90,v91
v_max_u32 v96,1,v96
buffer_store_dwordx2 v[96:97],v18,s[20:23],s70 offen offset:1024 sc1
next_402:
v_xor_b32 v17,0x10000,v17
s_xor_b32 s72,s72,0x10000
s_add_u32 s70,s70,2097152
s_xor_b32 s70,s70,0x2000
s_add_u32 s71,s71,1
s_cmp_le_u32 s71,s57
s_cbranch_scc1 seg_393
s_endpgm
retry_392:
s_sub_u32 s90,s90,64
s_cmp_lt_i32 s90,0
s_cbranch_scc1 giveup_197
s_mov_b32 s83,1
s_waitcnt vmcnt(0) lgkmcnt(0)
s_barrier
s_branch seg_393
half_401:
s_mov_b64 exec,s[52:53]
s_xor_b32 m0,s91,0
s_add_u32 s65,s94,0
buffer_load_dwordx4 v16,s[20:23],s65 offen offset:0 sc1 lds
buffer_load_dwordx4 v16,s[20:23],s65 offen offset:2048 sc1 lds
s_xor_b32 m0,s91,16384
s_add_u32 s65,s94,32768
buffer_load_dwordx4 v16,s[20:23],s65 offen offset:0 sc1 lds
buffer_load_dwordx4 v16,s[20:23],s65 offen offset:2048 sc1 lds
s_xor_b32 m0,s91,32768
s_add_u32 s65,s94,65536
buffer_load_dwordx4 v16,s[20:23],s65 offen offset:0 sc1 lds
buffer_load_dwordx4 v16,s[20:23],s65 offen offset:2048 sc1 lds
s_xor_b32 m0,s91,49152
s_add_u32 s65,s94,98304
buffer_load_dwordx4 v16,s[20:23],s65 offen offset:0 sc1 lds
buffer_load_dwordx4 v16,s[20:23],s65 offen offset:2048 sc1 lds
s_add_u32 s66,s94,110592
buffer_load_dwordx4 v[128:131],v16,s[20:23],s66 offen offset:0 sc1
buffer_load_dwordx4 v[132:135],v16,s[20:23],s66 offen offset:1024 sc1
buffer_load_dwordx4 v[136:139],v16,s[20:23],s66 offen offset:2048 sc1
buffer_load_dwordx4 v[140:143],v16,s[20:23],s66 offen offset:3072 sc1
s_add_u32 s66,s94,114688
buffer_load_dwordx4 v[144:147],v16,s[20:23],s66 offen offset:0 sc1
buffer_load_dwordx4 v[148:151],v16,s[20:23],s66 offen offset:1024 sc1
buffer_load_dwordx4 v[152:155],v16,s[20:23],s66 offen offset:2048 sc1
buffer_load_dwordx4 v[156:159],v16,s[20:23],s66 offen offset:3072 sc1
s_mov_b64 exec,-1
s_waitcnt vmcnt(16)
v_add_u32 v22,s71,-1
buffer_store_dword v22,v23,s[20:23],s97 offen sc1
s_mov_b32 s97,0x7fff0000
half2_398:
s_waitcnt vmcnt(15)
s_barrier
ds_read_b128 v[224:227],v17 offset:0
ds_read_b128 v[228:231],v17 offset:2048
ds_read_b128 v[232:235],v17 offset:4096
ds_read_b128 v[236:239],v17 offset:6144
ds_read_b128 v[240:243],v17 offset:8192
ds_read_b128 v[244:247],v17 offset:10240
ds_read_b128 v[248:251],v17 offset:12288
s_waitcnt lgkmcnt(5)
v_mfma_f32_16x16x32_bf16 v[64:67],a[0:3],v[224:227],0
ds_read_b128 v[252:255],v17 offset:14336
v_min_u32 v27,v224,v228
v_mfma_f32_16x16x32_bf16 v[72:75],a[4:7],v[228:231],0
s_waitcnt vmcnt(13)
s_barrier
ds_read_b128 v[224:227],v17 offset:16384
s_waitcnt lgkmcnt(5)
v_mfma_f32_16x16x32_bf16 v[64:67],a[8:11],v[232:235],v[64:67]
ds_read_b128 v[228:231],v17 offset:18432
v_min3_u32 v27,v27,v232,v236
v_mfma_f32_16x16x32_bf16 v[72:75],a[12:15],v[236:239],v[72:75]
ds_read_b128 v[232:235],v17 offset:20480
s_waitcnt lgkmcnt(5)
v_mfma_f32_16x16x32_bf16 v[64:67],a[16:19],v[240:243],v[64:67]
ds_read_b128 v[236:239],v17 offset:22528
v_min3_u32 v27,v27,v240,v244
v_mfma_f32_16x16x32_bf16 v[72:75],a[20:23],v[244:247],v[72:75]
ds_read_b128 v[240:243],v17 offset:24576
s_waitcnt lgkmcnt(5)
v_mfma_f32_16x16x32_bf16 v[64:67],a[24:27],v[248:251],v[64:67]
ds_read_b128 v[244:247],v17 offset:26624
v_min3_u32 v27,v27,v248,v252
v_mfma_f32_16x16x32_bf16 v[72:75],a[28:31],v[252:255],v[72:75]
ds_read_b128 v[248:251],v17 offset:28672
s_waitcnt lgkmcnt(5)
v_mfma_f32_16x16x32_bf16 v[64:67],a[32:35],v[224:227],v[64:67]
ds_read_b128 v[252:255],v17 offset:30720
v_min3_u32 v27,v27,v224,v228
v_mfma_f32_16x16x32_bf16 v[72:75],a[36:39],v[228:231],v[72:75]
s_waitcnt vmcnt(9)
s_barrier
ds_read_b128 v[224:227],v17 offset:32768
s_waitcnt lgkmcnt(5)
v_mfma_f32_16x16x32_bf16 v[64:67],a[40:43],v[232:235],v[64:67]
ds_read_b128 v[228:231],v17 offset:34816
v_min3_u32 v27,v27,v232,v236
v_mfma_f32_16x16x32_bf16 v[72:75],a[44:47],v[236:239],v[72:75]
ds_read_b128 v[232:235],v17 offset:36864
s_waitcnt lgkmcnt(5)
v_mfma_f32_16x16x32_bf16 v[64:67],a[48:51],v[240:243],v[64:67]
ds_read_b128 v[236:239],v17 offset:38912
v_min3_u32 v27,v27,v240,v244
s_waitcnt vmcnt(1)
stk_413:
v_min3_u32 v22,v129,v133,v137
v_min3_u32 v22,v22,v141,v145
v_min3_u32 v22,v22,v149,v153
v_min_u32 v22,v22,v157
v_cmp_eq_u32 vcc,0,v22
s_and_b64 vcc,vcc,s[52:53]
s_cmp_lt_i32 s90,0
s_cselect_b64 vcc,0,vcc
s_cbranch_vccnz str_414
v_mfma_f32_16x16x32_bf16 v[72:75],a[52:55],v[244:247],v[72:75]
ds_read_b128 v[240:243],v17 offset:40960
v_pk_add_f32 v[88:89],v[128:129],v[144:145]
v_pk_add_f32 v[90:91],v[130:131],v[146:147]
v_pk_add_f32 v[92:93],v[132:133],v[148:149]
v_pk_add_f32 v[94:95],v[134:135],v[150:151]
v_pk_add_f32 v[96:97],v[136:137],v[152:153]
v_pk_add_f32 v[98:99],v[138:139],v[154:155]
v_pk_add_f32 v[100:101],v[140:141],v[156:157]
v_pk_add_f32 v[102:103],v[142:143],v[158:159]
v_pk_add_f32 v[88:89],v[88:89],v[96:97]
v_pk_add_f32 v[90:91],v[90:91],v[98:99]
s_waitcnt lgkmcnt(5)
v_mfma_f32_16x16x32_bf16 v[64:67],a[56:59],v[248:251],v[64:67]
ds_read_b128 v[244:247],v17 offset:43008
v_min3_u32 v27,v27,v248,v252
v_pk_add_f32 v[92:93],v[92:93],v[100:101]
v_pk_add_f32 v[94:95],v[94:95],v[102:103]
v_pk_add_f32 v[88:89],v[88:89],v[92:93]
v_pk_add_f32 v[90:91],v[90:91],v[94:95]
v_mov_b32 v92,v88
v_mov_b32 v93,v89
v_mov_b32 v94,v90
v_mov_b32 v95,v91
v_permlane16_swap_b32 v92,v88
v_mfma_f32_16x16x32_bf16 v[72:75],a[60:63],v[252:255],v[72:75]
ds_read_b128 v[248:251],v17 offset:45056
v_permlane16_swap_b32 v93,v89
v_permlane16_swap_b32 v94,v90
v_permlane16_swap_b32 v95,v91
v_pk_add_f32 v[88:89],v[88:89],v[92:93]
v_pk_add_f32 v[90:91],v[90:91],v[94:95]
v_mov_b32 v92,v88
v_mov_b32 v93,v89
s_waitcnt lgkmcnt(5)
v_mfma_f32_16x16x32_bf16 v[64:67],a[64:67],v[224:227],v[64:67]
ds_read_b128 v[252:255],v17 offset:47104
v_min3_u32 v27,v27,v224,v228
v_mov_b32 v94,v90
v_mov_b32 v95,v91
v_permlane32_swap_b32 v92,v88
v_permlane32_swap_b32 v93,v89
v_permlane32_swap_b32 v94,v90
v_permlane32_swap_b32 v95,v91
v_mfma_f32_16x16x32_bf16 v[72:75],a[68:71],v[228:231],v[72:75]
ds_read_b128 v[224:227],v17 offset:49152
v_pk_add_f32 v[88:89],v[88:89],v[92:93]
v_pk_add_f32 v[90:91],v[90:91],v[94:95]
v_mul_f32 v120,0xba800000,v88
v_mul_f32 v124,0xba800000,v90
s_waitcnt lgkmcnt(5)
v_mfma_f32_16x16x32_bf16 v[64:67],a[72:75],v[232:235],v[64:67]
ds_read_b128 v[228:231],v17 offset:51200
v_min3_u32 v27,v27,v232,v236
v_mul_f32 v92,v120,v120
v_mul_f32 v93,v124,v124
v_fma_f32 v92,v89,s82,-v92
v_fma_f32 v93,v91,s82,-v93
v_mfma_f32_16x16x32_bf16 v[72:75],a[76:79],v[236:239],v[72:75]
ds_read_b128 v[232:235],v17 offset:53248
v_max_f32 v92,0,v92
v_max_f32 v93,0,v93
v_add_f32 v92,0x3727c5ac,v92
v_add_f32 v93,0x3727c5ac,v93
s_waitcnt lgkmcnt(5)
v_mfma_f32_16x16x32_bf16 v[64:67],a[80:83],v[240:243],v[64:67]
ds_read_b128 v[236:239],v17 offset:55296
v_min3_u32 v27,v27,v240,v244
v_rsq_f32 v94,v92
v_rsq_f32 v95,v93
v_mfma_f32_16x16x32_bf16 v[72:75],a[84:87],v[244:247],v[72:75]
ds_read_b128 v[240:243],v17 offset:57344
v_mul_f32 v123,v92,v94
v_mul_f32 v127,v93,v95
v_mul_f32 v122,v28,v94
v_mul_f32 v126,v28,v95
s_waitcnt lgkmcnt(5)
v_mfma_f32_16x16x32_bf16 v[64:67],a[88:91],v[248:251],v[64:67]
ds_read_b128 v[244:247],v17 offset:59392
v_min3_u32 v27,v27,v248,v252
v_mul_f32 v92,v94,v94
v_mul_f32 v93,v95,v95
v_mul_f32 v94,s81,v94
v_mul_f32 v95,s81,v95
v_mfma_f32_16x16x32_bf16 v[72:75],a[92:95],v[252:255],v[72:75]
ds_read_b128 v[248:251],v17 offset:61440
v_mul_f32 v121,v92,v94
v_mul_f32 v125,v93,v95
ds_write_b128 v19,v[120:123] offset:0
ds_write_b128 v19,v[124:127] offset:256
s_waitcnt lgkmcnt(7)
v_mfma_f32_16x16x32_bf16 v[64:67],a[96:99],v[224:227],v[64:67]
s_waitcnt lgkmcnt(0)
s_barrier
ds_read_b128 v[252:255],v17 offset:63488
v_min3_u32 v27,v27,v224,v228
v_mfma_f32_16x16x32_bf16 v[72:75],a[100:103],v[228:231],v[72:75]
v_mfma_f32_16x16x32_bf16 v[64:67],a[104:107],v[232:235],v[64:67]
v_min3_u32 v27,v27,v232,v236
v_mfma_f32_16x16x32_bf16 v[72:75],a[108:111],v[236:239],v[72:75]
v_mfma_f32_16x16x32_bf16 v[64:67],a[112:115],v[240:243],v[64:67]
v_min3_u32 v27,v27,v240,v244
v_mfma_f32_16x16x32_bf16 v[72:75],a[116:119],v[244:247],v[72:75]
s_waitcnt lgkmcnt(0)
v_mfma_f32_16x16x32_bf16 v[64:67],a[120:123],v[248:251],v[64:67]
v_min3_u32 v27,v27,v248,v252
v_mfma_f32_16x16x32_bf16 v[72:75],a[124:127],v[252:255],v[72:75]
v_cmp_eq_u32 vcc,0,v27
s_and_b64 vcc,vcc,s[52:53]
s_cbranch_vccnz retry_392
s_waitcnt lgkmcnt(0)
s_nop 3
v_pk_add_f32 v[64:65],v[64:65],v[72:73]
v_pk_add_f32 v[66:67],v[66:67],v[74:75]
v_pk_fma_f32 v[64:65],v[52:53],v[120:121],v[64:65] op_sel_hi:[1,0,1]
v_pk_fma_f32 v[66:67],v[54:55],v[120:121],v[66:67] op_sel_hi:[1,0,1]
v_pk_mul_f32 v[88:89],v[64:65],v[64:65]
v_pk_mul_f32 v[90:91],v[66:67],v[66:67]
buffer_load_dword v29,v21,s[20:23],s87 offen sc1
v_mov_b32 v22,s71
buffer_store_dword v22,v23,s[20:23],s73 offen sc1
v_pk_fma_f32 v[88:89],v[88:89],v[120:121],v[122:123] op_sel:[0,1,0] op_sel_hi:[1,1,0]
v_pk_fma_f32 v[90:91],v[90:91],v[120:121],v[122:123] op_sel:[0,1,0] op_sel_hi:[1,1,0]
v_pk_mul_f32 v[88:89],v[88:89],v[64:65]
v_pk_mul_f32 v[90:91],v[90:91],v[66:67]
v_exp_f32 v88,v88
v_exp_f32 v89,v89
v_exp_f32 v90,v90
v_exp_f32 v91,v91
v_pk_fma_f32 v[88:89],v[88:89],v[122:123],v[122:123] op_sel:[0,1,1] op_sel_hi:[1,1,1]
v_pk_fma_f32 v[90:91],v[90:91],v[122:123],v[122:123] op_sel:[0,1,1] op_sel_hi:[1,1,1]
v_rcp_f32 v88,v88
v_rcp_f32 v89,v89
v_rcp_f32 v90,v90
v_rcp_f32 v91,v91
v_pk_mul_f32 v[88:89],v[88:89],v[64:65]
v_pk_mul_f32 v[90:91],v[90:91],v[66:67]
v_cvt_pk_bf16_f32 v96,v88,v89
v_cvt_pk_bf16_f32 v97,v90,v91
v_max_u32 v96,1,v96
buffer_store_dwordx2 v[96:97],v18,s[20:23],s70 offen offset:0 sc1
s_branch next_402
str_408:
s_add_u32 s94,s70,s75
s_add_u32 s66,s94,110592
buffer_load_dwordx4 v[128:131],v16,s[20:23],s66 offen offset:0 sc1
buffer_load_dwordx4 v[132:135],v16,s[20:23],s66 offen offset:1024 sc1
buffer_load_dwordx4 v[136:139],v16,s[20:23],s66 offen offset:2048 sc1
buffer_load_dwordx4 v[140:143],v16,s[20:23],s66 offen offset:3072 sc1
s_add_u32 s66,s94,114688
buffer_load_dwordx4 v[144:147],v16,s[20:23],s66 offen offset:0 sc1
buffer_load_dwordx4 v[148:151],v16,s[20:23],s66 offen offset:1024 sc1
buffer_load_dwordx4 v[152:155],v16,s[20:23],s66 offen offset:2048 sc1
buffer_load_dwordx4 v[156:159],v16,s[20:23],s66 offen offset:3072 sc1
s_sub_u32 s90,s90,1
s_waitcnt vmcnt(0)
s_branch stk_407
str_410:
s_add_u32 s94,s70,s75
s_add_u32 s66,s94,110592
buffer_load_dwordx4 v[128:131],v16,s[20:23],s66 offen offset:0 sc1
buffer_load_dwordx4 v[132:135],v16,s[20:23],s66 offen offset:1024 sc1
buffer_load_dwordx4 v[136:139],v16,s[20:23],s66 offen offset:2048 sc1
buffer_load_dwordx4 v[140:143],v16,s[20:23],s66 offen offset:3072 sc1
s_add_u32 s66,s94,114688
buffer_load_dwordx4 v[144:147],v16,s[20:23],s66 offen offset:0 sc1
buffer_load_dwordx4 v[148:151],v16,s[20:23],s66 offen offset:1024 sc1
buffer_load_dwordx4 v[152:155],v16,s[20:23],s66 offen offset:2048 sc1
buffer_load_dwordx4 v[156:159],v16,s[20:23],s66 offen offset:3072 sc1
s_sub_u32 s90,s90,1
s_waitcnt vmcnt(0)
s_branch stk_409
str_412:
s_add_u32 s94,s70,s75
s_add_u32 s66,s94,110592
buffer_load_dwordx4 v[128:131],v16,s[20:23],s66 offen offset:0 sc1
buffer_load_dwordx4 v[132:135],v16,s[20:23],s66 offen offset:1024 sc1
buffer_load_dwordx4 v[136:139],v16,s[20:23],s66 offen offset:2048 sc1
buffer_load_dwordx4 v[140:143],v16,s[20:23],s66 offen offset:3072 sc1
s_add_u32 s66,s94,114688
buffer_load_dwordx4 v[144:147],v16,s[20:23],s66 offen offset:0 sc1
buffer_load_dwordx4 v[148:151],v16,s[20:23],s66 offen offset:1024 sc1
buffer_load_dwordx4 v[152:155],v16,s[20:23],s66 offen offset:2048 sc1
buffer_load_dwordx4 v[156:159],v16,s[20:23],s66 offen offset:3072 sc1
s_sub_u32 s90,s90,1
s_waitcnt vmcnt(0)
s_branch stk_411
str_414:
s_add_u32 s94,s70,s75
s_add_u32 s66,s94,110592
buffer_load_dwordx4 v[128:131],v16,s[20:23],s66 offen offset:0 sc1
buffer_load_dwordx4 v[132:135],v16,s[20:23],s66 offen offset:1024 sc1
buffer_load_dwordx4 v[136:139],v16,s[20:23],s66 offen offset:2048 sc1
buffer_load_dwordx4 v[140:143],v16,s[20:23],s66 offen offset:3072 sc1
s_add_u32 s66,s94,114688
buffer_load_dwordx4 v[144:147],v16,s[20:23],s66 offen offset:0 sc1
buffer_load_dwordx4 v[148:151],v16,s[20:23],s66 offen offset:1024 sc1
buffer_load_dwordx4 v[152:155],v16,s[20:23],s66 offen offset:2048 sc1
buffer_load_dwordx4 v[156:159],v16,s[20:23],s66 offen offset:3072 sc1
s_sub_u32 s90,s90,1
s_waitcnt vmcnt(0)
s_branch stk_413
giveup_197:
s_endpgm
code_end:
.section .rodata,"a"
.p2align 6
.amdhsa_kernel mega_kernel
  .amdhsa_next_free_vgpr 512
  .amdhsa_next_free_sgpr 102
  .amdhsa_accum_offset 256
  .amdhsa_group_segment_fixed_size 0
  .amdhsa_kernarg_size 136
  .amdhsa_user_sgpr_count 2
  .amdhsa_user_sgpr_kernarg_segment_ptr 1
  .amdhsa_system_sgpr_workgroup_id_x 1
.end_amdhsa_kernel
```

```asm
; @launch kernel=mega_kernel grid=(256,1,1) block=(256,1,1) lds=163840
.amdgcn_target "amdgcn-amd-amdhsa--gfx950"
.text
.globl mega_kernel
.p2align 8
.type mega_kernel,@function
mega_kernel:
s_cmp_ge_u32 s2,256
s_cbranch_scc1 done_1
s_load_dwordx4 s[16:19],s[0:1],120
s_load_dword s3,s[0:1],0
s_getpc_b64 s[4:5]
pc_2:
s_sub_u32 s8,s4,pc_2-mega_kernel
s_subb_u32 s9,s5,0
s_and_b32 s9,s9,0xffff
s_mov_b32 s10,code_end-mega_kernel
s_mov_b32 s11,0x20000
v_lshlrev_b32 v180,7,v0
v_cmp_gt_u32 vcc,64,v0
s_cbranch_vccnz nocpf_3
buffer_load_dword v181,v180,s[8:11],0 offen
s_mov_b32 s12,0x8000
buffer_load_dword v182,v180,s[8:11],s12 offen
s_lshr_b32 s12,s2,3
s_and_b32 s12,s12,7
s_add_u32 s12,s12,2
s_lshl_b32 s12,s12,15
buffer_load_dword v183,v180,s[8:11],s12 offen
nocpf_3:
v_and_b32 v1,63,v0
v_lshrrev_b32 v2,6,v0
s_getreg_b32 s51,hwreg(HW_REG_XCC_ID)
v_readfirstlane_b32 s50,v2
s_and_b32 s51,s51,7
s_waitcnt lgkmcnt(0)
s_mov_b32 s20,s18
s_and_b32 s21,s19,0xffff
s_mov_b32 s22,0x10000000
s_mov_b32 s23,0x20000
s_mov_b32 s44,s16
s_and_b32 s45,s17,0xffff
s_mov_b32 s46,0x100
s_mov_b32 s47,0x20000
s_mov_b32 s90,400000
s_mov_b32 s91,s50
v_mov_b32 v187,158976
s_cmp_lg_u32 s50,0
s_cbranch_scc1 norole_4
s_mov_b64 exec,1
v_mov_b32 v184,1
v_mov_b32 v185,0
s_and_b32 s52,s51,3
s_lshl_b32 s52,s52,2
s_lshr_b32 s53,s51,2
s_lshl_b32 s53,s53,7
s_add_u32 s52,s52,s53
buffer_atomic_add v184,v185,s[44:47],s52 offen sc0 sc1
s_mov_b64 exec,-1
buffer_load_dword v181,v180,s[8:11],0 offen
s_mov_b32 s12,0x8000
buffer_load_dword v182,v180,s[8:11],s12 offen
s_lshr_b32 s12,s2,3
s_and_b32 s12,s12,7
s_add_u32 s12,s12,2
s_lshl_b32 s12,s12,15
buffer_load_dword v183,v180,s[8:11],s12 offen
s_mov_b64 exec,1
s_waitcnt vmcnt(3)
ds_write_b32 v187,v184
s_waitcnt lgkmcnt(0)
s_mov_b64 exec,-1
norole_4:
s_barrier
ds_read_b32 v186,v187
s_waitcnt lgkmcnt(0)
v_readfirstlane_b32 s54,v186
s_mov_b32 s56,2
s_lshl_b32 s57,s51,5
s_add_u32 s57,s57,s54
s_cmp_lt_u32 s54,32
s_cselect_b32 s57,s57,999
s_cmp_ge_u32 s57,256
s_cbranch_scc1 verify_6
s_cmp_ge_u32 s57,128
s_cbranch_scc1 pre_8
setup_5:
s_load_dwordx8 s[4:11],s[0:1],8
s_load_dwordx2 s[12:13],s[0:1],40
v_and_b32 v3,15,v1
v_lshrrev_b32 v4,4,v1
v_lshlrev_b32 v16,4,v1
v_lshrrev_b32 v30,2,v1
v_and_b32 v31,3,v1
v_lshlrev_b32 v7,13,v30
v_lshl_add_u32 v7,v31,4,v7
v_lshlrev_b32 v8,11,v30
v_lshl_add_u32 v8,v31,4,v8
s_lshr_b32 s58,s57,5
s_and_b32 s59,s57,31
s_xor_b32 s60,s57,0
s_lshl_b32 s60,s60,6
s_lshl_b32 s61,s50,14
s_lshl_b32 s62,s50,21
s_add_u32 s62,s62,s60
s_lshl_b32 s63,s58,21
s_lshl_b32 s64,s50,19
s_add_u32 s63,s63,s64
s_xor_b32 s64,s59,0
s_lshl_b32 s64,s64,6
s_add_u32 s63,s63,s64
s_waitcnt lgkmcnt(0)
s_mov_b32 s28,s8
s_and_b32 s29,s9,0xffff
s_mov_b32 s30,0x800000
s_mov_b32 s31,0x20000
s_mov_b32 s32,s10
s_and_b32 s33,s11,0xffff
s_mov_b32 s34,0x800000
s_mov_b32 s35,0x20000
s_mov_b32 s36,s6
s_and_b32 s37,s7,0xffff
s_mov_b32 s38,0x800000
s_mov_b32 s39,0x20000
s_mov_b32 s40,s12
s_and_b32 s41,s13,0xffff
s_mov_b32 s42,0x800000
s_mov_b32 s43,0x20000
s_mov_b32 s8,s4
s_and_b32 s9,s5,0xffff
s_mov_b32 s10,0x4000
s_mov_b32 s11,0x20000
v_lshlrev_b32 v9,7,v3
v_lshl_add_u32 v10,v4,11,v9
v_lshl_add_u32 v9,v4,13,v9
s_lshl_b32 s64,s59,2
s_add_u32 s64,s64,s50
s_lshl_b32 s65,s64,16
s_lshl_b32 s66,s58,11
s_add_u32 s65,s65,s66
s_lshl_b32 s66,s64,14
s_lshl_b32 s67,s58,21
s_add_u32 s66,s66,s67
v_and_b32 v9,7,v1
v_lshrrev_b32 v10,3,v1
s_cmp_eq_u32 s58,3
s_cselect_b32 s64,15,3
v_mov_b32 v11,3
v_cmp_eq_u32 vcc,1,v10
s_nop 1
v_cndmask_b32 v11,v11,11,vcc
v_lshlrev_b32 v12,7,v11
v_lshl_add_u32 v12,v9,11,v12
v_mov_b32 v13,s64
v_cmp_eq_u32 vcc,2,v10
s_nop 1
v_cndmask_b32 v11,v11,v13,vcc
v_lshlrev_b32 v11,7,v11
v_lshl_add_u32 v11,v9,13,v11
v_mov_b32 v100,0
v_mov_b32 v101,0
v_mov_b32 v102,0
v_mov_b32 v103,0
s_mov_b32 s53,s65
s_mov_b32 s55,s66
v_and_b32 v22,7,v3
v_lshlrev_b32 v31,11,v22
v_lshl_add_u32 v31,v4,4,v31
s_lshr_b32 s64,s59,3
s_lshl_b32 s64,s64,14
s_and_b32 s65,s59,7
s_lshl_b32 s65,s65,10
s_add_u32 s64,s64,s65
s_lshl_b32 s65,s58,16
s_add_u32 s64,s64,s65
s_add_u32 s64,s64,31195136
s_lshr_b32 s65,s57,3
s_add_u32 s65,s65,96
s_lshl_b32 s65,s65,14
s_and_b32 s66,s57,7
s_lshl_b32 s66,s66,10
s_add_u32 s65,s65,s66
s_add_u32 s65,s65,29360128
v_add_u32 v206,s64,v16
v_add_u32 v207,s65,v16
s_and_b32 s64,s50,1
s_lshl_b32 s64,s64,21
s_lshr_b32 s65,s50,1
s_lshl_b32 s65,s65,13
s_add_u32 s64,s64,s65
buffer_store_dwordx4 v[100:103],v206,s[20:23],s64 offen sc1
buffer_store_dwordx4 v[100:103],v207,s[20:23],s64 offen sc1
s_lshl_b32 s64,s50,20
s_add_u32 s64,s64,23068672
s_cmp_lt_u32 s50,2
s_cselect_b32 s67,s64,0x7fff0000
s_lshl_b32 s65,s57,10
s_add_u32 s65,s65,131072
s_add_u32 s65,s65,s67
buffer_store_dwordx4 v[100:103],v16,s[20:23],s65 offen sc1
s_lshl_b32 s65,s57,9
s_add_u32 s65,s65,s67
s_add_u32 s66,s65,65536
s_mov_b32 exec_hi,0
buffer_store_dwordx4 v[100:103],v16,s[20:23],s65 offen sc1
buffer_store_dwordx4 v[100:103],v16,s[20:23],s66 offen sc1
s_lshl_b32 s65,s57,2
s_add_u32 s65,s65,s64
s_add_u32 s65,s65,524288
s_lshl_b32 s52,s57,7
s_add_u32 s52,s52,21168128
s_mov_b64 exec,1
buffer_store_dword v100,v100,s[20:23],s65 offen sc1
buffer_store_dword v100,v100,s[20:23],s65 offen offset:512 sc1
s_mov_b64 exec,15
buffer_store_dwordx4 v[100:103],v16,s[20:23],s52 offen sc1
s_mov_b64 exec,-1
s_mov_b32 s65,s53
s_mov_b32 s66,s55
v_mov_b32 v37,159008
ds_write_b128 v37,v[100:103]
s_add_u32 s64,s62,0
s_add_u32 m0,s61,0
s_nop 0
buffer_load_dwordx4 v7,s[28:31],s64 offen nt lds
s_add_u32 s64,s62,131072
s_add_u32 m0,s61,1024
s_nop 0
buffer_load_dwordx4 v7,s[28:31],s64 offen nt lds
s_add_u32 s64,s62,262144
s_add_u32 m0,s61,2048
s_nop 0
buffer_load_dwordx4 v7,s[28:31],s64 offen nt lds
s_add_u32 s64,s62,393216
s_add_u32 m0,s61,3072
s_nop 0
buffer_load_dwordx4 v7,s[28:31],s64 offen nt lds
s_add_u32 s64,s62,524288
s_add_u32 m0,s61,4096
s_nop 0
buffer_load_dwordx4 v7,s[28:31],s64 offen nt lds
s_add_u32 s64,s62,655360
s_add_u32 m0,s61,5120
s_nop 0
buffer_load_dwordx4 v7,s[28:31],s64 offen nt lds
s_add_u32 s64,s62,786432
s_add_u32 m0,s61,6144
s_nop 0
buffer_load_dwordx4 v7,s[28:31],s64 offen nt lds
s_add_u32 s64,s62,917504
s_add_u32 m0,s61,7168
s_nop 0
buffer_load_dwordx4 v7,s[28:31],s64 offen nt lds
s_waitcnt vmcnt(8) lgkmcnt(0)
s_barrier
s_cmp_lg_u32 s50,1
s_cbranch_scc1 ws_11
s_and_b32 s64,s56,1
s_lshl_b32 s64,s64,2
s_add_u32 s64,s64,36
s_mov_b64 exec,1
v_mov_b32 v184,1
v_mov_b32 v185,0
buffer_atomic_add v184,v185,s[44:47],s64 offen sc1
s_mov_b64 exec,-1
ws_11:
s_add_u32 s64,s62,1048576
s_add_u32 m0,s61,8192
s_nop 0
buffer_load_dwordx4 v7,s[28:31],s64 offen nt lds
s_add_u32 s64,s62,1179648
s_add_u32 m0,s61,9216
s_nop 0
buffer_load_dwordx4 v7,s[28:31],s64 offen nt lds
s_add_u32 s64,s62,1310720
s_add_u32 m0,s61,10240
s_nop 0
buffer_load_dwordx4 v7,s[28:31],s64 offen nt lds
s_add_u32 s64,s62,1441792
s_add_u32 m0,s61,11264
s_nop 0
buffer_load_dwordx4 v7,s[28:31],s64 offen nt lds
s_add_u32 s64,s62,1572864
s_add_u32 m0,s61,12288
s_nop 0
buffer_load_dwordx4 v7,s[28:31],s64 offen nt lds
s_add_u32 s64,s62,1703936
s_add_u32 m0,s61,13312
s_nop 0
buffer_load_dwordx4 v7,s[28:31],s64 offen nt lds
s_add_u32 s64,s62,1835008
s_add_u32 m0,s61,14336
s_nop 0
buffer_load_dwordx4 v7,s[28:31],s64 offen nt lds
s_add_u32 s64,s62,1966080
s_add_u32 m0,s61,15360
s_nop 0
buffer_load_dwordx4 v7,s[28:31],s64 offen nt lds
s_mov_b64 exec,0xffffff
buffer_load_dword v201,v11,s[32:35],s65 offen
buffer_load_dword v202,v11,s[36:39],s65 offen
s_mov_b64 exec,0xffff
buffer_load_dword v203,v12,s[40:43],s66 offen
s_mov_b64 exec,-1
s_add_u32 s64,s62,0
s_add_u32 m0,s61,65536
s_nop 0
buffer_load_dwordx4 v7,s[32:35],s64 offen nt lds
s_add_u32 s64,s62,131072
s_add_u32 m0,s61,66560
s_nop 0
buffer_load_dwordx4 v7,s[32:35],s64 offen nt lds
s_add_u32 s64,s62,262144
s_add_u32 m0,s61,67584
s_nop 0
buffer_load_dwordx4 v7,s[32:35],s64 offen nt lds
s_add_u32 s64,s62,393216
s_add_u32 m0,s61,68608
s_nop 0
buffer_load_dwordx4 v7,s[32:35],s64 offen nt lds
s_add_u32 s64,s62,524288
s_add_u32 m0,s61,69632
s_nop 0
buffer_load_dwordx4 v7,s[32:35],s64 offen nt lds
s_add_u32 s64,s62,655360
s_add_u32 m0,s61,70656
s_nop 0
buffer_load_dwordx4 v7,s[32:35],s64 offen nt lds
s_add_u32 s64,s62,786432
s_add_u32 m0,s61,71680
s_nop 0
buffer_load_dwordx4 v7,s[32:35],s64 offen nt lds
s_add_u32 s64,s62,917504
s_add_u32 m0,s61,72704
s_nop 0
buffer_load_dwordx4 v7,s[32:35],s64 offen nt lds
s_add_u32 s64,s62,1048576
s_add_u32 m0,s61,73728
s_nop 0
buffer_load_dwordx4 v7,s[32:35],s64 offen nt lds
s_add_u32 s64,s62,1179648
s_add_u32 m0,s61,74752
s_nop 0
buffer_load_dwordx4 v7,s[32:35],s64 offen nt lds
s_add_u32 s64,s62,1310720
s_add_u32 m0,s61,75776
s_nop 0
buffer_load_dwordx4 v7,s[32:35],s64 offen nt lds
s_add_u32 s64,s62,1441792
s_add_u32 m0,s61,76800
s_nop 0
buffer_load_dwordx4 v7,s[32:35],s64 offen nt lds
s_add_u32 s64,s62,1572864
s_add_u32 m0,s61,77824
s_nop 0
buffer_load_dwordx4 v7,s[32:35],s64 offen nt lds
s_add_u32 s64,s62,1703936
s_add_u32 m0,s61,78848
s_nop 0
buffer_load_dwordx4 v7,s[32:35],s64 offen nt lds
s_add_u32 s64,s62,1835008
s_add_u32 m0,s61,79872
s_nop 0
buffer_load_dwordx4 v7,s[32:35],s64 offen nt lds
s_add_u32 s64,s62,1966080
s_add_u32 m0,s61,80896
s_nop 0
buffer_load_dwordx4 v7,s[32:35],s64 offen nt lds
s_lshl_b32 s64,s59,6
buffer_load_dwordx4 v[216:219],v31,s[8:11],s64 offen
v_lshrrev_b32 v184,3,v3
v_bfe_u32 v185,v3,2,1
v_lshrrev_b32 v186,1,v4
v_and_b32 v187,1,v4
v_lshl_add_u32 v188,v184,3,v185
v_lshl_add_u32 v188,v186,4,v188
v_lshl_add_u32 v188,v187,2,v188
v_lshl_add_u32 v189,v184,2,v185
v_lshl_add_u32 v189,v186,3,v189
v_lshl_add_u32 v189,v187,4,v189
v_and_b32 v187,3,v3
v_lshlrev_b32 v187,3,v187
v_lshl_add_u32 v188,v188,6,v187
v_lshl_add_u32 v189,v189,6,v187
s_lshr_b32 s64,s50,1
s_lshl_b32 s64,s64,5
v_add_u32 v190,s64,v188
v_add_u32 v191,0x10000,v190
s_lshl_b32 s64,s64,10
v_add_u32 v192,s64,v189
s_add_u32 s64,s61,0x10000
v_add_u32 v193,s64,v16
s_add_u32 s68,s50,1
s_mov_b32 s69,0
s_waitcnt vmcnt(20)
s_barrier
s_lshl_b32 s64,s57,9
v_mov_b32 v194,s64
s_add_u32 s65,s64,65024
v_mov_b32 v195,s65
v_cmp_lt_u32 vcc,3,v1
s_nop 1
v_cndmask_b32 v194,v194,v195,vcc
s_lshl_b32 s65,s57,10
s_add_u32 s65,s65,130048
v_mov_b32 v195,s65
v_cmp_lt_u32 vcc,7,v1
s_nop 1
v_cndmask_b32 v194,v194,v195,vcc
s_lshl_b32 s65,s57,11
s_add_u32 s65,s65,260096
v_mov_b32 v195,s65
v_cmp_lt_u32 vcc,15,v1
s_nop 1
v_cndmask_b32 v194,v194,v195,vcc
v_lshl_add_u32 v194,v1,7,v194
s_lshl_b32 s65,s58,7
s_add_u32 s65,s65,524288
v_writelane_b32 v194,s65,32
s_add_u32 s65,s65,512
v_writelane_b32 v194,s65,33
s_lshl_b32 s64,s50,20
s_add_u32 s64,s64,23068672
s_mov_b32 exec_hi,3
buffer_load_dword v183,v194,s[20:23],s64 offen sc1
s_mov_b64 exec,-1
s_and_b32 s65,s50,1
s_lshl_b32 s14,s65,19
s_add_u32 s14,s14,s60
s_lshl_b32 s15,s65,19
s_sub_u32 s15,s63,s15
s_lshl_b32 s65,s65,13
s_add_u32 s65,s65,131072
v_mov_b32 v32,v8
v_add_u32 v33,s65,v16
v_add_u32 v34,s65,v189
v_mov_b32 v35,v7
v_add_u32 v36,131072,v190
v_mov_b32 v37,159008
s_bitcmp1_b32 s68,1
s_cbranch_scc0 ws_12
ds_read_b64_tr_b16 a[0:1],v190 offset:0
ds_read_b64_tr_b16 a[2:3],v190 offset:128
ds_read_b64_tr_b16 a[4:5],v190 offset:2048
ds_read_b64_tr_b16 a[6:7],v190 offset:2176
ds_read_b64_tr_b16 a[8:9],v190 offset:4096
ds_read_b64_tr_b16 a[10:11],v190 offset:4224
ds_read_b64_tr_b16 a[12:13],v190 offset:6144
ds_read_b64_tr_b16 a[14:15],v190 offset:6272
s_waitcnt lgkmcnt(0)
ds_read_b64_tr_b16 a[16:17],v190 offset:8192
ds_read_b64_tr_b16 a[18:19],v190 offset:8320
ds_read_b64_tr_b16 a[20:21],v190 offset:10240
ds_read_b64_tr_b16 a[22:23],v190 offset:10368
ds_read_b64_tr_b16 a[24:25],v190 offset:12288
ds_read_b64_tr_b16 a[26:27],v190 offset:12416
ds_read_b64_tr_b16 a[28:29],v190 offset:14336
ds_read_b64_tr_b16 a[30:31],v190 offset:14464
s_waitcnt lgkmcnt(0)
ds_read_b64_tr_b16 a[32:33],v190 offset:16384
ds_read_b64_tr_b16 a[34:35],v190 offset:16512
ds_read_b64_tr_b16 a[36:37],v190 offset:18432
ds_read_b64_tr_b16 a[38:39],v190 offset:18560
ds_read_b64_tr_b16 a[40:41],v190 offset:20480
ds_read_b64_tr_b16 a[42:43],v190 offset:20608
ds_read_b64_tr_b16 a[44:45],v190 offset:22528
ds_read_b64_tr_b16 a[46:47],v190 offset:22656
s_waitcnt lgkmcnt(0)
ds_read_b64_tr_b16 a[48:49],v190 offset:24576
ds_read_b64_tr_b16 a[50:51],v190 offset:24704
ds_read_b64_tr_b16 a[52:53],v190 offset:26624
ds_read_b64_tr_b16 a[54:55],v190 offset:26752
ds_read_b64_tr_b16 a[56:57],v190 offset:28672
ds_read_b64_tr_b16 a[58:59],v190 offset:28800
ds_read_b64_tr_b16 a[60:61],v190 offset:30720
ds_read_b64_tr_b16 a[62:63],v190 offset:30848
s_waitcnt lgkmcnt(0)
ds_read_b64_tr_b16 a[64:65],v190 offset:32768
ds_read_b64_tr_b16 a[66:67],v190 offset:32896
ds_read_b64_tr_b16 a[68:69],v190 offset:34816
ds_read_b64_tr_b16 a[70:71],v190 offset:34944
ds_read_b64_tr_b16 a[72:73],v190 offset:36864
ds_read_b64_tr_b16 a[74:75],v190 offset:36992
ds_read_b64_tr_b16 a[76:77],v190 offset:38912
ds_read_b64_tr_b16 a[78:79],v190 offset:39040
s_waitcnt lgkmcnt(0)
ds_read_b64_tr_b16 a[80:81],v190 offset:40960
ds_read_b64_tr_b16 a[82:83],v190 offset:41088
ds_read_b64_tr_b16 a[84:85],v190 offset:43008
ds_read_b64_tr_b16 a[86:87],v190 offset:43136
ds_read_b64_tr_b16 a[88:89],v190 offset:45056
ds_read_b64_tr_b16 a[90:91],v190 offset:45184
ds_read_b64_tr_b16 a[92:93],v190 offset:47104
ds_read_b64_tr_b16 a[94:95],v190 offset:47232
s_waitcnt lgkmcnt(0)
ds_read_b64_tr_b16 a[96:97],v190 offset:49152
ds_read_b64_tr_b16 a[98:99],v190 offset:49280
ds_read_b64_tr_b16 a[100:101],v190 offset:51200
ds_read_b64_tr_b16 a[102:103],v190 offset:51328
ds_read_b64_tr_b16 a[104:105],v190 offset:53248
ds_read_b64_tr_b16 a[106:107],v190 offset:53376
ds_read_b64_tr_b16 a[108:109],v190 offset:55296
ds_read_b64_tr_b16 a[110:111],v190 offset:55424
s_waitcnt lgkmcnt(0)
ds_read_b64_tr_b16 a[112:113],v190 offset:57344
ds_read_b64_tr_b16 a[114:115],v190 offset:57472
ds_read_b64_tr_b16 a[116:117],v190 offset:59392
ds_read_b64_tr_b16 a[118:119],v190 offset:59520
ds_read_b64_tr_b16 a[120:121],v190 offset:61440
ds_read_b64_tr_b16 a[122:123],v190 offset:61568
ds_read_b64_tr_b16 a[124:125],v190 offset:63488
ds_read_b64_tr_b16 a[126:127],v190 offset:63616
s_waitcnt lgkmcnt(0)
s_waitcnt vmcnt(0)
s_barrier
ds_read_b64_tr_b16 a[128:129],v191 offset:0
ds_read_b64_tr_b16 a[130:131],v191 offset:128
ds_read_b64_tr_b16 a[132:133],v191 offset:2048
ds_read_b64_tr_b16 a[134:135],v191 offset:2176
ds_read_b64_tr_b16 a[136:137],v191 offset:4096
ds_read_b64_tr_b16 a[138:139],v191 offset:4224
ds_read_b64_tr_b16 a[140:141],v191 offset:6144
ds_read_b64_tr_b16 a[142:143],v191 offset:6272
s_waitcnt lgkmcnt(0)
ds_read_b64_tr_b16 a[144:145],v191 offset:8192
ds_read_b64_tr_b16 a[146:147],v191 offset:8320
ds_read_b64_tr_b16 a[148:149],v191 offset:10240
ds_read_b64_tr_b16 a[150:151],v191 offset:10368
ds_read_b64_tr_b16 a[152:153],v191 offset:12288
ds_read_b64_tr_b16 a[154:155],v191 offset:12416
ds_read_b64_tr_b16 a[156:157],v191 offset:14336
ds_read_b64_tr_b16 a[158:159],v191 offset:14464
s_waitcnt lgkmcnt(0)
ds_read_b64_tr_b16 a[160:161],v191 offset:16384
ds_read_b64_tr_b16 a[162:163],v191 offset:16512
ds_read_b64_tr_b16 a[164:165],v191 offset:18432
ds_read_b64_tr_b16 a[166:167],v191 offset:18560
ds_read_b64_tr_b16 a[168:169],v191 offset:20480
ds_read_b64_tr_b16 a[170:171],v191 offset:20608
ds_read_b64_tr_b16 a[172:173],v191 offset:22528
ds_read_b64_tr_b16 a[174:175],v191 offset:22656
s_waitcnt lgkmcnt(0)
ds_read_b64_tr_b16 a[176:177],v191 offset:24576
ds_read_b64_tr_b16 a[178:179],v191 offset:24704
ds_read_b64_tr_b16 a[180:181],v191 offset:26624
ds_read_b64_tr_b16 a[182:183],v191 offset:26752
ds_read_b64_tr_b16 a[184:185],v191 offset:28672
ds_read_b64_tr_b16 a[186:187],v191 offset:28800
ds_read_b64_tr_b16 a[188:189],v191 offset:30720
ds_read_b64_tr_b16 a[190:191],v191 offset:30848
s_waitcnt lgkmcnt(0)
ds_read_b64_tr_b16 a[192:193],v191 offset:32768
ds_read_b64_tr_b16 a[194:195],v191 offset:32896
ds_read_b64_tr_b16 a[196:197],v191 offset:34816
ds_read_b64_tr_b16 a[198:199],v191 offset:34944
ds_read_b64_tr_b16 a[200:201],v191 offset:36864
ds_read_b64_tr_b16 a[202:203],v191 offset:36992
ds_read_b64_tr_b16 a[204:205],v191 offset:38912
ds_read_b64_tr_b16 a[206:207],v191 offset:39040
s_waitcnt lgkmcnt(0)
ds_read_b64_tr_b16 a[208:209],v191 offset:40960
ds_read_b64_tr_b16 a[210:211],v191 offset:41088
ds_read_b64_tr_b16 a[212:213],v191 offset:43008
ds_read_b64_tr_b16 a[214:215],v191 offset:43136
ds_read_b64_tr_b16 a[216:217],v191 offset:45056
ds_read_b64_tr_b16 a[218:219],v191 offset:45184
ds_read_b64_tr_b16 a[220:221],v191 offset:47104
ds_read_b64_tr_b16 a[222:223],v191 offset:47232
s_waitcnt lgkmcnt(0)
ds_read_b64_tr_b16 a[224:225],v191 offset:49152
ds_read_b64_tr_b16 a[226:227],v191 offset:49280
ds_read_b64_tr_b16 a[228:229],v191 offset:51200
ds_read_b64_tr_b16 a[230:231],v191 offset:51328
ds_read_b64_tr_b16 a[232:233],v191 offset:53248
ds_read_b64_tr_b16 a[234:235],v191 offset:53376
ds_read_b64_tr_b16 a[236:237],v191 offset:55296
ds_read_b64_tr_b16 a[238:239],v191 offset:55424
s_waitcnt lgkmcnt(0)
ds_read_b64_tr_b16 a[240:241],v191 offset:57344
ds_read_b64_tr_b16 a[242:243],v191 offset:57472
ds_read_b64_tr_b16 a[244:245],v191 offset:59392
ds_read_b64_tr_b16 a[246:247],v191 offset:59520
ds_read_b64_tr_b16 a[248:249],v191 offset:61440
ds_read_b64_tr_b16 a[250:251],v191 offset:61568
ds_read_b64_tr_b16 a[252:253],v191 offset:63488
ds_read_b64_tr_b16 a[254:255],v191 offset:63616
s_waitcnt lgkmcnt(0)
s_branch ws_14
ws_12:
s_add_u32 s64,s14,0
buffer_load_dwordx4 a[0:3],v35,s[36:39],s64 offen nt
s_add_u32 s64,s14,131072
buffer_load_dwordx4 a[4:7],v35,s[36:39],s64 offen nt
s_add_u32 s64,s14,262144
buffer_load_dwordx4 a[8:11],v35,s[36:39],s64 offen nt
s_add_u32 s64,s14,393216
buffer_load_dwordx4 a[12:15],v35,s[36:39],s64 offen nt
s_add_u32 s64,s14,1048576
buffer_load_dwordx4 a[16:19],v35,s[36:39],s64 offen nt
s_add_u32 s64,s14,1179648
buffer_load_dwordx4 a[20:23],v35,s[36:39],s64 offen nt
s_add_u32 s64,s14,1310720
buffer_load_dwordx4 a[24:27],v35,s[36:39],s64 offen nt
s_add_u32 s64,s14,1441792
buffer_load_dwordx4 a[28:31],v35,s[36:39],s64 offen nt
s_add_u32 s64,s14,2097152
buffer_load_dwordx4 a[32:35],v35,s[36:39],s64 offen nt
s_add_u32 s64,s14,2228224
buffer_load_dwordx4 a[36:39],v35,s[36:39],s64 offen nt
s_add_u32 s64,s14,2359296
buffer_load_dwordx4 a[40:43],v35,s[36:39],s64 offen nt
s_add_u32 s64,s14,2490368
buffer_load_dwordx4 a[44:47],v35,s[36:39],s64 offen nt
s_add_u32 s64,s14,3145728
buffer_load_dwordx4 a[48:51],v35,s[36:39],s64 offen nt
s_add_u32 s64,s14,3276800
buffer_load_dwordx4 a[52:55],v35,s[36:39],s64 offen nt
s_add_u32 s64,s14,3407872
buffer_load_dwordx4 a[56:59],v35,s[36:39],s64 offen nt
s_add_u32 s64,s14,3538944
buffer_load_dwordx4 a[60:63],v35,s[36:39],s64 offen nt
s_add_u32 s64,s14,4194304
buffer_load_dwordx4 a[64:67],v35,s[36:39],s64 offen nt
s_add_u32 s64,s14,4325376
buffer_load_dwordx4 a[68:71],v35,s[36:39],s64 offen nt
s_add_u32 s64,s14,4456448
buffer_load_dwordx4 a[72:75],v35,s[36:39],s64 offen nt
s_add_u32 s64,s14,4587520
buffer_load_dwordx4 a[76:79],v35,s[36:39],s64 offen nt
s_add_u32 s64,s14,5242880
buffer_load_dwordx4 a[80:83],v35,s[36:39],s64 offen nt
s_add_u32 s64,s14,5373952
buffer_load_dwordx4 a[84:87],v35,s[36:39],s64 offen nt
s_add_u32 s64,s14,5505024
buffer_load_dwordx4 a[88:91],v35,s[36:39],s64 offen nt
s_add_u32 s64,s14,5636096
buffer_load_dwordx4 a[92:95],v35,s[36:39],s64 offen nt
s_add_u32 s64,s14,6291456
buffer_load_dwordx4 a[96:99],v35,s[36:39],s64 offen nt
s_add_u32 s64,s14,6422528
buffer_load_dwordx4 a[100:103],v35,s[36:39],s64 offen nt
s_add_u32 s64,s14,6553600
buffer_load_dwordx4 a[104:107],v35,s[36:39],s64 offen nt
s_add_u32 s64,s14,6684672
buffer_load_dwordx4 a[108:111],v35,s[36:39],s64 offen nt
s_add_u32 s64,s14,7340032
buffer_load_dwordx4 a[112:115],v35,s[36:39],s64 offen nt
s_add_u32 s64,s14,7471104
buffer_load_dwordx4 a[116:119],v35,s[36:39],s64 offen nt
s_add_u32 s64,s14,7602176
buffer_load_dwordx4 a[120:123],v35,s[36:39],s64 offen nt
s_add_u32 s64,s14,7733248
buffer_load_dwordx4 a[124:127],v35,s[36:39],s64 offen nt
s_add_u32 s64,s15,0
buffer_load_dwordx4 a[128:131],v32,s[40:43],s64 offen nt
s_add_u32 s64,s15,32768
buffer_load_dwordx4 a[132:135],v32,s[40:43],s64 offen nt
s_add_u32 s64,s15,65536
buffer_load_dwordx4 a[136:139],v32,s[40:43],s64 offen nt
s_add_u32 s64,s15,98304
buffer_load_dwordx4 a[140:143],v32,s[40:43],s64 offen nt
s_add_u32 s64,s15,131072
buffer_load_dwordx4 a[144:147],v32,s[40:43],s64 offen nt
s_add_u32 s64,s15,163840
buffer_load_dwordx4 a[148:151],v32,s[40:43],s64 offen nt
s_add_u32 s64,s15,196608
buffer_load_dwordx4 a[152:155],v32,s[40:43],s64 offen nt
s_add_u32 s64,s15,229376
buffer_load_dwordx4 a[156:159],v32,s[40:43],s64 offen nt
s_add_u32 s64,s15,262144
buffer_load_dwordx4 a[160:163],v32,s[40:43],s64 offen nt
s_add_u32 s64,s15,294912
buffer_load_dwordx4 a[164:167],v32,s[40:43],s64 offen nt
s_add_u32 s64,s15,327680
buffer_load_dwordx4 a[168:171],v32,s[40:43],s64 offen nt
s_add_u32 s64,s15,360448
buffer_load_dwordx4 a[172:175],v32,s[40:43],s64 offen nt
s_waitcnt vmcnt(44)
s_barrier
ws_14:
v_mov_b32 v187,158976
s_cmp_lg_u32 s50,1
s_cbranch_scc1 sh0_17
s_mov_b32 s53,0
stl_18:
s_add_u32 s64,s52,32
s_buffer_load_dwordx8 s[72:79],s[20:23],s52 glc
s_buffer_load_dwordx8 s[80:87],s[20:23],s64 glc
s_waitcnt lgkmcnt(0)
s_min_u32 s72,s72,s80
s_min_u32 s73,s73,s81
s_min_u32 s74,s74,s82
s_min_u32 s75,s75,s83
s_min_u32 s76,s76,s84
s_min_u32 s77,s77,s85
s_min_u32 s78,s78,s86
s_min_u32 s79,s79,s87
s_min_u32 s72,s72,s76
s_min_u32 s73,s73,s77
s_min_u32 s74,s74,s78
s_min_u32 s75,s75,s79
s_min_u32 s72,s72,s74
s_min_u32 s73,s73,s75
s_min_u32 s64,s72,s73
s_mov_b32 s65,0
s_and_b32 s61,s64,1
s_lshl_b32 s61,s61,13
s_cmp_lg_u32 s64,0
s_cbranch_scc1 stok_19
s_sub_u32 s90,s90,1
s_cmp_lt_i32 s90,0
s_cbranch_scc1 stok_19
s_add_u32 s53,s53,1
s_and_b32 s64,s53,31
s_cbranch_scc1 stl_18
s_cmp_eq_u32 s56,1
s_cbranch_scc1 stl_18
v_and_b32 v184,3,v1
v_bfe_u32 v185,v1,2,1
v_lshlrev_b32 v184,2,v184
v_lshl_add_u32 v184,v185,7,v184
v_writelane_b32 v184,32,8
s_mov_b64 exec,0x1ff
vpoll_20:
buffer_load_dword v185,v184,s[44:47],0 offen sc1
s_waitcnt vmcnt(0)
vfirst_23:
v_readlane_b32 s92,v185,0
v_readlane_b32 s93,v185,1
v_readlane_b32 s94,v185,2
v_readlane_b32 s95,v185,3
v_readlane_b32 s96,v185,4
v_readlane_b32 s97,v185,5
v_readlane_b32 s98,v185,6
v_readlane_b32 s99,v185,7
v_readlane_b32 s61,v185,8
s_add_u32 s64,s92,s93
s_add_u32 s64,s64,s94
s_add_u32 s64,s64,s95
s_add_u32 s64,s64,s96
s_add_u32 s64,s64,s97
s_add_u32 s64,s64,s98
s_add_u32 s64,s64,s99
s_min_u32 s65,s92,s93
s_min_u32 s66,s94,s95
s_min_u32 s65,s65,s66
s_min_u32 s66,s96,s97
s_min_u32 s65,s65,s66
s_min_u32 s66,s98,s99
s_min_u32 s65,s65,s66
s_cmp_lt_u32 s65,32
s_cselect_b32 s65,1,0
s_cmp_lt_u32 s64,256
s_cbranch_scc1 vslp_22
s_branch vgot_21
vslp_22:
s_sleep 8
s_sub_u32 s90,s90,1
s_cmp_gt_i32 s90,0
s_cbranch_scc1 vpoll_20
vgot_21:
s_mov_b64 exec,-1
s_and_b32 s61,s61,1
s_lshl_b32 s61,s61,13
s_mov_b32 s66,s54
s_cmp_gt_u32 s51,0
s_cselect_b32 s64,s92,0
s_add_u32 s66,s66,s64
s_cmp_gt_u32 s51,1
s_cselect_b32 s64,s93,0
s_add_u32 s66,s66,s64
s_cmp_gt_u32 s51,2
s_cselect_b32 s64,s94,0
s_add_u32 s66,s66,s64
s_cmp_gt_u32 s51,3
s_cselect_b32 s64,s95,0
s_add_u32 s66,s66,s64
s_cmp_gt_u32 s51,4
s_cselect_b32 s64,s96,0
s_add_u32 s66,s66,s64
s_cmp_gt_u32 s51,5
s_cselect_b32 s64,s97,0
s_add_u32 s66,s66,s64
s_cmp_gt_u32 s51,6
s_cselect_b32 s64,s98,0
s_add_u32 s66,s66,s64
s_cmp_eq_u32 s65,0
s_cbranch_scc1 stl_18
stok_19:
v_mov_b32 v184,s65
v_mov_b32 v185,s66
v_mov_b32 v186,s61
ds_write_b96 v187,v[184:186] offset:16
s_waitcnt lgkmcnt(0)
sh0_17:
s_barrier
ds_read_b96 v[184:186],v187 offset:16
s_waitcnt lgkmcnt(0)
v_readfirstlane_b32 s65,v184
v_readfirstlane_b32 s66,v185
v_readfirstlane_b32 s61,v186
s_cmp_lg_u32 s65,0
s_cbranch_scc1 slowrole_10
s_and_b32 s56,s56,1
s_branch loops_7
pre_8:
s_sub_u32 s55,s57,128
s_load_dwordx4 s[4:7],s[0:1],96
s_load_dwordx2 s[8:9],s[0:1],0
v_and_b32 v1,63,v0
v_lshrrev_b32 v2,6,v0
v_and_b32 v3,7,v0
v_lshrrev_b32 v4,3,v0
v_mul_u32_u24 v5,12288,v4
v_lshl_add_u32 v5,v3,4,v5
v_lshlrev_b32 v6,1,v4
s_and_b32 s24,s55,31
s_lshr_b32 s25,s55,5
s_lshl_b32 s26,s24,7
s_mul_i32 s27,s25,3145728
s_add_u32 s26,s26,s27
s_lshl_b32 s27,s25,9
s_waitcnt lgkmcnt(0)
s_mov_b32 s12,s4
s_and_b32 s13,s5,0xffff
s_mov_b32 s14,0x800
s_mov_b32 s15,0x20000
s_mov_b32 s28,s6
s_and_b32 s29,s7,0xffff
s_mov_b32 s30,0xc00000
s_mov_b32 s31,0x20000
s_mov_b32 s32,s8
s_and_b32 s33,s9,0xffff
s_mov_b32 s34,0x400000
s_mov_b32 s35,0x20000
buffer_load_dwordx4 v[64:67],v5,s[28:31],s26 offen nt
s_add_u32 s26,s26,393216
buffer_load_dwordx4 v[68:71],v5,s[28:31],s26 offen nt
s_add_u32 s26,s26,393216
buffer_load_dwordx4 v[72:75],v5,s[28:31],s26 offen nt
s_add_u32 s26,s26,393216
buffer_load_dwordx4 v[76:79],v5,s[28:31],s26 offen nt
s_add_u32 s26,s26,393216
buffer_load_dwordx4 v[80:83],v5,s[28:31],s26 offen nt
s_add_u32 s26,s26,393216
buffer_load_dwordx4 v[84:87],v5,s[28:31],s26 offen nt
s_add_u32 s26,s26,393216
buffer_load_dwordx4 v[88:91],v5,s[28:31],s26 offen nt
s_add_u32 s26,s26,393216
buffer_load_dwordx4 v[92:95],v5,s[28:31],s26 offen nt
buffer_load_ushort v96,v6,s[12:15],s27 offen offset:0
buffer_load_ushort v97,v6,s[12:15],s27 offen offset:64
buffer_load_ushort v98,v6,s[12:15],s27 offen offset:128
buffer_load_ushort v99,v6,s[12:15],s27 offen offset:192
buffer_load_ushort v100,v6,s[12:15],s27 offen offset:256
buffer_load_ushort v101,v6,s[12:15],s27 offen offset:320
buffer_load_ushort v102,v6,s[12:15],s27 offen offset:384
buffer_load_ushort v103,v6,s[12:15],s27 offen offset:448
v_and_b32 v3,3,v1
v_lshrrev_b32 v4,2,v1
v_lshl_add_u32 v5,v2,2,v3
v_lshlrev_b32 v5,11,v5
v_lshl_add_u32 v5,v4,5,v5
s_lshl_b32 s36,s55,15
s_cmp_lt_u32 s55,16
s_cselect_b32 s42,s36,0x7fff0000
s_cselect_b32 s36,0x7fff0000,s36
buffer_load_dwordx4 v[8:11],v5,s[32:35],s42 offen offset:0
buffer_load_dwordx4 v[12:15],v5,s[32:35],s42 offen offset:16
buffer_load_dwordx4 v[16:19],v5,s[32:35],s42 offen offset:512
buffer_load_dwordx4 v[20:23],v5,s[32:35],s42 offen offset:528
buffer_load_dwordx4 v[24:27],v5,s[32:35],s42 offen offset:1024
buffer_load_dwordx4 v[28:31],v5,s[32:35],s42 offen offset:1040
buffer_load_dwordx4 v[32:35],v5,s[32:35],s42 offen offset:1536
buffer_load_dwordx4 v[36:39],v5,s[32:35],s42 offen offset:1552
v_lshrrev_b32 v6,1,v4
v_lshlrev_b32 v6,11,v6
v_and_b32 v7,1,v4
v_lshl_add_u32 v6,v7,9,v6
v_and_b32 v7,1,v2
v_lshl_add_u32 v6,v7,10,v6
v_lshrrev_b32 v7,1,v2
v_lshl_add_u32 v7,v7,2,v3
v_lshl_add_u32 v6,v7,4,v6
v_lshlrev_b32 v4,6,v4
s_lshr_b32 s37,s55,1
s_lshl_b32 s37,s37,16
s_and_b32 s38,s55,1
s_lshl_b32 s38,s38,7
s_add_u32 s37,s37,s38
s_add_u32 s37,s37,57344
s_mov_b32 s38,0xbfb8aa3b
s_mov_b32 s39,0xffff0000
s_cmp_lg_u32 s50,1
s_cbranch_scc1 nz_24
s_lshl_b32 s40,s55,9
s_add_u32 s40,s40,21037056
v_lshl_add_u32 v104,v1,4,s40
s_lshl_b32 s41,s55,7
s_add_u32 s41,s41,21102592
v_writelane_b32 v104,s41,32
v_mov_b32 v108,0
v_mov_b32 v109,0
v_mov_b32 v110,0
v_mov_b32 v111,0
s_mov_b32 exec_hi,1
buffer_store_dwordx4 v[108:111],v104,s[20:23],0 offen sc1
s_mov_b64 exec,-1
nz_24:
v_mov_b32 v112,0
v_mov_b32 v113,0
v_mov_b32 v114,0
v_mov_b32 v115,0
v_mov_b32 v116,0
v_mov_b32 v117,0
v_mov_b32 v118,0
v_mov_b32 v119,0
s_waitcnt vmcnt(8)
v_lshlrev_b32 v96,16,v96
v_mul_f32 v104,s38,v96
v_exp_f32 v104,v104
s_nop 0
v_add_f32 v104,1.0,v104
v_rcp_f32 v104,v104
s_nop 0
v_mul_f32 v104,v104,v96
v_cvt_pk_bf16_f32 v104,v104,v104
v_and_b32 v96,s39,v104
v_lshlrev_b32 v105,16,v64
v_and_b32 v106,s39,v64
v_fmac_f32 v112,v105,v96
v_fmac_f32 v113,v106,v96
v_lshlrev_b32 v105,16,v65
v_and_b32 v106,s39,v65
v_fmac_f32 v114,v105,v96
v_fmac_f32 v115,v106,v96
v_lshlrev_b32 v105,16,v66
v_and_b32 v106,s39,v66
v_fmac_f32 v116,v105,v96
v_fmac_f32 v117,v106,v96
v_lshlrev_b32 v105,16,v67
v_and_b32 v106,s39,v67
v_fmac_f32 v118,v105,v96
v_fmac_f32 v119,v106,v96
v_lshlrev_b32 v97,16,v97
v_mul_f32 v104,s38,v97
v_exp_f32 v104,v104
s_nop 0
v_add_f32 v104,1.0,v104
v_rcp_f32 v104,v104
s_nop 0
v_mul_f32 v104,v104,v97
v_cvt_pk_bf16_f32 v104,v104,v104
v_and_b32 v97,s39,v104
v_lshlrev_b32 v105,16,v68
v_and_b32 v106,s39,v68
v_fmac_f32 v112,v105,v97
v_fmac_f32 v113,v106,v97
v_lshlrev_b32 v105,16,v69
v_and_b32 v106,s39,v69
v_fmac_f32 v114,v105,v97
v_fmac_f32 v115,v106,v97
v_lshlrev_b32 v105,16,v70
v_and_b32 v106,s39,v70
v_fmac_f32 v116,v105,v97
v_fmac_f32 v117,v106,v97
v_lshlrev_b32 v105,16,v71
v_and_b32 v106,s39,v71
v_fmac_f32 v118,v105,v97
v_fmac_f32 v119,v106,v97
v_lshlrev_b32 v98,16,v98
v_mul_f32 v104,s38,v98
v_exp_f32 v104,v104
s_nop 0
v_add_f32 v104,1.0,v104
v_rcp_f32 v104,v104
s_nop 0
v_mul_f32 v104,v104,v98
v_cvt_pk_bf16_f32 v104,v104,v104
v_and_b32 v98,s39,v104
v_lshlrev_b32 v105,16,v72
v_and_b32 v106,s39,v72
v_fmac_f32 v112,v105,v98
v_fmac_f32 v113,v106,v98
v_lshlrev_b32 v105,16,v73
v_and_b32 v106,s39,v73
v_fmac_f32 v114,v105,v98
v_fmac_f32 v115,v106,v98
v_lshlrev_b32 v105,16,v74
v_and_b32 v106,s39,v74
v_fmac_f32 v116,v105,v98
v_fmac_f32 v117,v106,v98
v_lshlrev_b32 v105,16,v75
v_and_b32 v106,s39,v75
v_fmac_f32 v118,v105,v98
v_fmac_f32 v119,v106,v98
v_lshlrev_b32 v99,16,v99
v_mul_f32 v104,s38,v99
v_exp_f32 v104,v104
s_nop 0
v_add_f32 v104,1.0,v104
v_rcp_f32 v104,v104
s_nop 0
v_mul_f32 v104,v104,v99
v_cvt_pk_bf16_f32 v104,v104,v104
v_and_b32 v99,s39,v104
v_lshlrev_b32 v105,16,v76
v_and_b32 v106,s39,v76
v_fmac_f32 v112,v105,v99
v_fmac_f32 v113,v106,v99
v_lshlrev_b32 v105,16,v77
v_and_b32 v106,s39,v77
v_fmac_f32 v114,v105,v99
v_fmac_f32 v115,v106,v99
v_lshlrev_b32 v105,16,v78
v_and_b32 v106,s39,v78
v_fmac_f32 v116,v105,v99
v_fmac_f32 v117,v106,v99
v_lshlrev_b32 v105,16,v79
v_and_b32 v106,s39,v79
v_fmac_f32 v118,v105,v99
v_fmac_f32 v119,v106,v99
v_lshlrev_b32 v100,16,v100
v_mul_f32 v104,s38,v100
v_exp_f32 v104,v104
s_nop 0
v_add_f32 v104,1.0,v104
v_rcp_f32 v104,v104
s_nop 0
v_mul_f32 v104,v104,v100
v_cvt_pk_bf16_f32 v104,v104,v104
v_and_b32 v100,s39,v104
v_lshlrev_b32 v105,16,v80
v_and_b32 v106,s39,v80
v_fmac_f32 v112,v105,v100
v_fmac_f32 v113,v106,v100
v_lshlrev_b32 v105,16,v81
v_and_b32 v106,s39,v81
v_fmac_f32 v114,v105,v100
v_fmac_f32 v115,v106,v100
v_lshlrev_b32 v105,16,v82
v_and_b32 v106,s39,v82
v_fmac_f32 v116,v105,v100
v_fmac_f32 v117,v106,v100
v_lshlrev_b32 v105,16,v83
v_and_b32 v106,s39,v83
v_fmac_f32 v118,v105,v100
v_fmac_f32 v119,v106,v100
v_lshlrev_b32 v101,16,v101
v_mul_f32 v104,s38,v101
v_exp_f32 v104,v104
s_nop 0
v_add_f32 v104,1.0,v104
v_rcp_f32 v104,v104
s_nop 0
v_mul_f32 v104,v104,v101
v_cvt_pk_bf16_f32 v104,v104,v104
v_and_b32 v101,s39,v104
v_lshlrev_b32 v105,16,v84
v_and_b32 v106,s39,v84
v_fmac_f32 v112,v105,v101
v_fmac_f32 v113,v106,v101
v_lshlrev_b32 v105,16,v85
v_and_b32 v106,s39,v85
v_fmac_f32 v114,v105,v101
v_fmac_f32 v115,v106,v101
v_lshlrev_b32 v105,16,v86
v_and_b32 v106,s39,v86
v_fmac_f32 v116,v105,v101
v_fmac_f32 v117,v106,v101
v_lshlrev_b32 v105,16,v87
v_and_b32 v106,s39,v87
v_fmac_f32 v118,v105,v101
v_fmac_f32 v119,v106,v101
v_lshlrev_b32 v102,16,v102
v_mul_f32 v104,s38,v102
v_exp_f32 v104,v104
s_nop 0
v_add_f32 v104,1.0,v104
v_rcp_f32 v104,v104
s_nop 0
v_mul_f32 v104,v104,v102
v_cvt_pk_bf16_f32 v104,v104,v104
v_and_b32 v102,s39,v104
v_lshlrev_b32 v105,16,v88
v_and_b32 v106,s39,v88
v_fmac_f32 v112,v105,v102
v_fmac_f32 v113,v106,v102
v_lshlrev_b32 v105,16,v89
v_and_b32 v106,s39,v89
v_fmac_f32 v114,v105,v102
v_fmac_f32 v115,v106,v102
v_lshlrev_b32 v105,16,v90
v_and_b32 v106,s39,v90
v_fmac_f32 v116,v105,v102
v_fmac_f32 v117,v106,v102
v_lshlrev_b32 v105,16,v91
v_and_b32 v106,s39,v91
v_fmac_f32 v118,v105,v102
v_fmac_f32 v119,v106,v102
v_lshlrev_b32 v103,16,v103
v_mul_f32 v104,s38,v103
v_exp_f32 v104,v104
s_nop 0
v_add_f32 v104,1.0,v104
v_rcp_f32 v104,v104
s_nop 0
v_mul_f32 v104,v104,v103
v_cvt_pk_bf16_f32 v104,v104,v104
v_and_b32 v103,s39,v104
v_lshlrev_b32 v105,16,v92
v_and_b32 v106,s39,v92
v_fmac_f32 v112,v105,v103
v_fmac_f32 v113,v106,v103
v_lshlrev_b32 v105,16,v93
v_and_b32 v106,s39,v93
v_fmac_f32 v114,v105,v103
v_fmac_f32 v115,v106,v103
v_lshlrev_b32 v105,16,v94
v_and_b32 v106,s39,v94
v_fmac_f32 v116,v105,v103
v_fmac_f32 v117,v106,v103
v_lshlrev_b32 v105,16,v95
v_and_b32 v106,s39,v95
v_fmac_f32 v118,v105,v103
v_fmac_f32 v119,v106,v103
v_permlane32_swap_b32 v112,v116
v_permlane32_swap_b32 v113,v117
v_permlane32_swap_b32 v114,v118
v_permlane32_swap_b32 v115,v119
v_add_f32 v112,v112,v116
v_add_f32 v113,v113,v117
v_add_f32 v114,v114,v118
v_add_f32 v115,v115,v119
s_nop 0
v_permlane16_swap_b32 v112,v114
v_permlane16_swap_b32 v113,v115
v_add_f32 v112,v112,v114
v_add_f32 v113,v113,v115
s_nop 0
v_add_f32_dpp v112,v112,v112 row_ror:8 row_mask:0xf bank_mask:0xf
v_add_f32_dpp v113,v113,v113 row_ror:8 row_mask:0xf bank_mask:0xf
v_and_b32 v104,7,v1
v_lshlrev_b32 v104,5,v104
v_lshrrev_b32 v105,5,v1
v_lshl_add_u32 v104,v105,4,v104
v_bfe_u32 v105,v1,4,1
v_lshl_add_u32 v104,v105,3,v104
v_lshl_add_u32 v104,v2,8,v104
ds_write_b64 v104,v[112:113]
v_lshlrev_b32 v105,2,v1
s_lshl_b32 s40,s25,13
s_lshl_b32 s41,s24,8
s_add_u32 s40,s40,s41
s_add_u32 s40,s40,24576
s_waitcnt lgkmcnt(0)
s_barrier
s_cmp_lg_u32 s50,0
s_cbranch_scc1 m1n0_25
ds_read_b32 v112,v105 offset:0
ds_read_b32 v113,v105 offset:256
ds_read_b32 v114,v105 offset:512
ds_read_b32 v115,v105 offset:768
s_waitcnt lgkmcnt(0)
v_add_f32 v112,v112,v113
v_add_f32 v114,v114,v115
v_add_f32 v112,v112,v114
buffer_store_dword v112,v105,s[20:23],s40 offen sc1
m1n0_25:
s_waitcnt vmcnt(0)
s_barrier
s_cmp_lg_u32 s50,0
s_cbranch_scc1 post_9
s_mov_b64 exec,1
v_mov_b32 v184,1
v_mov_b32 v185,0
s_and_b32 s52,s56,1
s_lshl_b32 s52,s52,2
s_add_u32 s52,s52,160
buffer_atomic_add v184,v185,s[44:47],s52 offen sc0 sc1
s_waitcnt vmcnt(0)
v_readfirstlane_b32 s64,v184
s_mov_b64 exec,-1
s_cmp_eq_u32 s56,1
s_cbranch_scc1 post_9
s_cmp_lg_u32 s64,127
s_cbranch_scc1 post_9
v_and_b32 v184,3,v1
v_bfe_u32 v185,v1,2,1
v_lshlrev_b32 v184,2,v184
v_lshl_add_u32 v184,v185,7,v184
v_writelane_b32 v184,32,8
s_mov_b64 exec,0x1ff
vpoll_27:
buffer_load_dword v185,v184,s[44:47],0 offen sc1
s_waitcnt vmcnt(0)
vfirst_30:
v_readlane_b32 s92,v185,0
v_readlane_b32 s93,v185,1
v_readlane_b32 s94,v185,2
v_readlane_b32 s95,v185,3
v_readlane_b32 s96,v185,4
v_readlane_b32 s97,v185,5
v_readlane_b32 s98,v185,6
v_readlane_b32 s99,v185,7
v_readlane_b32 s61,v185,8
s_add_u32 s64,s92,s93
s_add_u32 s64,s64,s94
s_add_u32 s64,s64,s95
s_add_u32 s64,s64,s96
s_add_u32 s64,s64,s97
s_add_u32 s64,s64,s98
s_add_u32 s64,s64,s99
s_min_u32 s65,s92,s93
s_min_u32 s66,s94,s95
s_min_u32 s65,s65,s66
s_min_u32 s66,s96,s97
s_min_u32 s65,s65,s66
s_min_u32 s66,s98,s99
s_min_u32 s65,s65,s66
s_cmp_lt_u32 s65,32
s_cselect_b32 s65,1,0
s_cmp_lt_u32 s64,256
s_cbranch_scc1 vslp_29
s_branch vgot_28
vslp_29:
s_sleep 8
s_sub_u32 s90,s90,1
s_cmp_gt_i32 s90,0
s_cbranch_scc1 vpoll_27
vgot_28:
s_mov_b64 exec,-1
s_and_b32 s61,s61,1
s_lshl_b32 s61,s61,13
s_cmp_lg_u32 s65,0
s_cbranch_scc1 post_9
v_lshlrev_b32 v184,7,v1
v_mov_b32 v185,1
s_mov_b32 s64,21102592
s_mov_b32 s65,21110784
buffer_store_dword v185,v184,s[20:23],s64 offen sc1
buffer_store_dword v185,v184,s[20:23],s65 offen sc1
s_branch post_9
verify_6:
v_mov_b32 v187,158976
s_cmp_lg_u32 s50,0
s_cbranch_scc1 sh0_31
v_and_b32 v184,3,v1
v_bfe_u32 v185,v1,2,1
v_lshlrev_b32 v184,2,v184
v_lshl_add_u32 v184,v185,7,v184
v_writelane_b32 v184,32,8
s_mov_b64 exec,0x1ff
vpoll_32:
buffer_load_dword v185,v184,s[44:47],0 offen sc1
s_waitcnt vmcnt(0)
vfirst_35:
v_readlane_b32 s92,v185,0
v_readlane_b32 s93,v185,1
v_readlane_b32 s94,v185,2
v_readlane_b32 s95,v185,3
v_readlane_b32 s96,v185,4
v_readlane_b32 s97,v185,5
v_readlane_b32 s98,v185,6
v_readlane_b32 s99,v185,7
v_readlane_b32 s61,v185,8
s_add_u32 s64,s92,s93
s_add_u32 s64,s64,s94
s_add_u32 s64,s64,s95
s_add_u32 s64,s64,s96
s_add_u32 s64,s64,s97
s_add_u32 s64,s64,s98
s_add_u32 s64,s64,s99
s_min_u32 s65,s92,s93
s_min_u32 s66,s94,s95
s_min_u32 s65,s65,s66
s_min_u32 s66,s96,s97
s_min_u32 s65,s65,s66
s_min_u32 s66,s98,s99
s_min_u32 s65,s65,s66
s_cmp_lt_u32 s65,32
s_cselect_b32 s65,1,0
s_cmp_lt_u32 s64,256
s_cbranch_scc1 vslp_34
s_branch vgot_33
vslp_34:
s_sleep 8
s_sub_u32 s90,s90,1
s_cmp_gt_i32 s90,0
s_cbranch_scc1 vpoll_32
vgot_33:
s_mov_b64 exec,-1
s_and_b32 s61,s61,1
s_lshl_b32 s61,s61,13
s_mov_b32 s66,s54
s_cmp_gt_u32 s51,0
s_cselect_b32 s64,s92,0
s_add_u32 s66,s66,s64
s_cmp_gt_u32 s51,1
s_cselect_b32 s64,s93,0
s_add_u32 s66,s66,s64
s_cmp_gt_u32 s51,2
s_cselect_b32 s64,s94,0
s_add_u32 s66,s66,s64
s_cmp_gt_u32 s51,3
s_cselect_b32 s64,s95,0
s_add_u32 s66,s66,s64
s_cmp_gt_u32 s51,4
s_cselect_b32 s64,s96,0
s_add_u32 s66,s66,s64
s_cmp_gt_u32 s51,5
s_cselect_b32 s64,s97,0
s_add_u32 s66,s66,s64
s_cmp_gt_u32 s51,6
s_cselect_b32 s64,s98,0
s_add_u32 s66,s66,s64
v_mov_b32 v184,s65
v_mov_b32 v185,s66
v_mov_b32 v186,s61
ds_write_b96 v187,v[184:186] offset:16
s_waitcnt lgkmcnt(0)
sh0_31:
s_barrier
ds_read_b96 v[184:186],v187 offset:16
s_waitcnt lgkmcnt(0)
v_readfirstlane_b32 s65,v184
v_readfirstlane_b32 s66,v185
v_readfirstlane_b32 s61,v186
s_cmp_lg_u32 s65,0
s_cbranch_scc1 slowrole_10
s_mov_b32 s56,0
s_branch done_1
slowrole_10:
s_mov_b32 s57,s66
s_mov_b32 s56,1
s_waitcnt vmcnt(0)
s_barrier
s_cmp_ge_u32 s57,128
s_cbranch_scc1 pre_8
s_cmp_lg_u32 s50,0
s_cbranch_scc1 nadd_36
s_mov_b64 exec,1
v_mov_b32 v184,1
v_mov_b32 v185,0
s_mov_b32 s52,164
buffer_atomic_add v184,v185,s[44:47],s52 offen sc1
s_mov_b64 exec,-1
nadd_36:
s_branch setup_5
post_9:
s_cmp_lt_u32 s55,16
s_cbranch_scc1 xd_38
s_barrier
buffer_load_dwordx4 v[8:11],v5,s[32:35],s36 offen offset:0
buffer_load_dwordx4 v[12:15],v5,s[32:35],s36 offen offset:16
buffer_load_dwordx4 v[16:19],v5,s[32:35],s36 offen offset:512
buffer_load_dwordx4 v[20:23],v5,s[32:35],s36 offen offset:528
buffer_load_dwordx4 v[24:27],v5,s[32:35],s36 offen offset:1024
buffer_load_dwordx4 v[28:31],v5,s[32:35],s36 offen offset:1040
buffer_load_dwordx4 v[32:35],v5,s[32:35],s36 offen offset:1536
buffer_load_dwordx4 v[36:39],v5,s[32:35],s36 offen offset:1552
xd_38:
s_sub_u32 s65,s57,255
s_and_b32 s66,s56,1
s_or_b32 s65,s65,s66
s_or_b32 s65,s65,s50
s_cmp_lg_u32 s65,0
s_cbranch_scc1 nomeas_37
s_mov_b64 exec,1
v_mov_b32 v184,0
s_mov_b32 s52,20971520
s_mov_b32 s53,20979712
s_mov_b32 s70,0x7fffffff
s_mov_b32 s71,0x7fffffff
s_memtime s[72:73]
s_waitcnt lgkmcnt(0)
buffer_store_dword v184,v184,s[20:23],s52 offen sc1
s_waitcnt vmcnt(0)
s_memtime s[74:75]
s_waitcnt lgkmcnt(0)
s_sub_u32 s74,s74,s72
s_min_u32 s70,s70,s74
s_memtime s[72:73]
s_waitcnt lgkmcnt(0)
buffer_store_dword v184,v184,s[20:23],s53 offen sc1
s_waitcnt vmcnt(0)
s_memtime s[74:75]
s_waitcnt lgkmcnt(0)
s_sub_u32 s74,s74,s72
s_min_u32 s71,s71,s74
s_memtime s[72:73]
s_waitcnt lgkmcnt(0)
buffer_store_dword v184,v184,s[20:23],s52 offen sc1
s_waitcnt vmcnt(0)
s_memtime s[74:75]
s_waitcnt lgkmcnt(0)
s_sub_u32 s74,s74,s72
s_min_u32 s70,s70,s74
s_memtime s[72:73]
s_waitcnt lgkmcnt(0)
buffer_store_dword v184,v184,s[20:23],s53 offen sc1
s_waitcnt vmcnt(0)
s_memtime s[74:75]
s_waitcnt lgkmcnt(0)
s_sub_u32 s74,s74,s72
s_min_u32 s71,s71,s74
s_memtime s[72:73]
s_waitcnt lgkmcnt(0)
buffer_store_dword v184,v184,s[20:23],s52 offen sc1
s_waitcnt vmcnt(0)
s_memtime s[74:75]
s_waitcnt lgkmcnt(0)
s_sub_u32 s74,s74,s72
s_min_u32 s70,s70,s74
s_memtime s[72:73]
s_waitcnt lgkmcnt(0)
buffer_store_dword v184,v184,s[20:23],s53 offen sc1
s_waitcnt vmcnt(0)
s_memtime s[74:75]
s_waitcnt lgkmcnt(0)
s_sub_u32 s74,s74,s72
s_min_u32 s71,s71,s74
s_memtime s[72:73]
s_waitcnt lgkmcnt(0)
buffer_store_dword v184,v184,s[20:23],s52 offen sc1
s_waitcnt vmcnt(0)
s_memtime s[74:75]
s_waitcnt lgkmcnt(0)
s_sub_u32 s74,s74,s72
s_min_u32 s70,s70,s74
s_memtime s[72:73]
s_waitcnt lgkmcnt(0)
buffer_store_dword v184,v184,s[20:23],s53 offen sc1
s_waitcnt vmcnt(0)
s_memtime s[74:75]
s_waitcnt lgkmcnt(0)
s_sub_u32 s74,s74,s72
s_min_u32 s71,s71,s74
s_cmp_gt_u32 s71,s70
s_cselect_b32 s65,3,2
v_mov_b32 v185,s65
buffer_store_dword v185,v184,s[44:47],32 offen sc1
s_mov_b64 exec,-1
nomeas_37:
s_waitcnt vmcnt(0)
v_and_b32 v103,s39,v39
v_lshlrev_b32 v102,16,v39
v_and_b32 v101,s39,v38
v_lshlrev_b32 v100,16,v38
v_and_b32 v99,s39,v37
v_lshlrev_b32 v98,16,v37
v_and_b32 v97,s39,v36
v_lshlrev_b32 v96,16,v36
v_and_b32 v95,s39,v35
v_lshlrev_b32 v94,16,v35
v_and_b32 v93,s39,v34
v_lshlrev_b32 v92,16,v34
v_and_b32 v91,s39,v33
v_lshlrev_b32 v90,16,v33
v_and_b32 v89,s39,v32
v_lshlrev_b32 v88,16,v32
v_and_b32 v87,s39,v31
v_lshlrev_b32 v86,16,v31
v_and_b32 v85,s39,v30
v_lshlrev_b32 v84,16,v30
v_and_b32 v83,s39,v29
v_lshlrev_b32 v82,16,v29
v_and_b32 v81,s39,v28
v_lshlrev_b32 v80,16,v28
v_and_b32 v79,s39,v27
v_lshlrev_b32 v78,16,v27
v_and_b32 v77,s39,v26
v_lshlrev_b32 v76,16,v26
v_and_b32 v75,s39,v25
v_lshlrev_b32 v74,16,v25
v_and_b32 v73,s39,v24
v_lshlrev_b32 v72,16,v24
v_and_b32 v71,s39,v23
v_lshlrev_b32 v70,16,v23
v_and_b32 v69,s39,v22
v_lshlrev_b32 v68,16,v22
v_and_b32 v67,s39,v21
v_lshlrev_b32 v66,16,v21
v_and_b32 v65,s39,v20
v_lshlrev_b32 v64,16,v20
v_and_b32 v63,s39,v19
v_lshlrev_b32 v62,16,v19
v_and_b32 v61,s39,v18
v_lshlrev_b32 v60,16,v18
v_and_b32 v59,s39,v17
v_lshlrev_b32 v58,16,v17
v_and_b32 v57,s39,v16
v_lshlrev_b32 v56,16,v16
v_and_b32 v55,s39,v15
v_lshlrev_b32 v54,16,v15
v_and_b32 v53,s39,v14
v_lshlrev_b32 v52,16,v14
v_and_b32 v51,s39,v13
v_lshlrev_b32 v50,16,v13
v_and_b32 v49,s39,v12
v_lshlrev_b32 v48,16,v12
v_and_b32 v47,s39,v11
v_lshlrev_b32 v46,16,v11
v_and_b32 v45,s39,v10
v_lshlrev_b32 v44,16,v10
v_and_b32 v43,s39,v9
v_lshlrev_b32 v42,16,v9
v_and_b32 v41,s39,v8
v_lshlrev_b32 v40,16,v8
v_pk_add_f32 v[8:9],v[40:41],v[42:43]
v_pk_add_f32 v[10:11],v[44:45],v[46:47]
v_pk_add_f32 v[8:9],v[8:9],v[48:49]
v_pk_add_f32 v[10:11],v[10:11],v[50:51]
v_pk_add_f32 v[8:9],v[8:9],v[52:53]
v_pk_add_f32 v[10:11],v[10:11],v[54:55]
v_pk_add_f32 v[8:9],v[8:9],v[56:57]
v_pk_add_f32 v[10:11],v[10:11],v[58:59]
v_pk_add_f32 v[8:9],v[8:9],v[60:61]
v_pk_add_f32 v[10:11],v[10:11],v[62:63]
v_pk_add_f32 v[8:9],v[8:9],v[64:65]
v_pk_add_f32 v[10:11],v[10:11],v[66:67]
v_pk_add_f32 v[8:9],v[8:9],v[68:69]
v_pk_add_f32 v[10:11],v[10:11],v[70:71]
v_pk_add_f32 v[8:9],v[8:9],v[72:73]
v_pk_add_f32 v[10:11],v[10:11],v[74:75]
v_pk_add_f32 v[8:9],v[8:9],v[76:77]
v_pk_add_f32 v[10:11],v[10:11],v[78:79]
v_pk_add_f32 v[8:9],v[8:9],v[80:81]
v_pk_add_f32 v[10:11],v[10:11],v[82:83]
v_pk_add_f32 v[8:9],v[8:9],v[84:85]
v_pk_add_f32 v[10:11],v[10:11],v[86:87]
v_pk_add_f32 v[8:9],v[8:9],v[88:89]
v_pk_add_f32 v[10:11],v[10:11],v[90:91]
v_pk_add_f32 v[8:9],v[8:9],v[92:93]
v_pk_add_f32 v[10:11],v[10:11],v[94:95]
v_pk_add_f32 v[8:9],v[8:9],v[96:97]
v_pk_add_f32 v[10:11],v[10:11],v[98:99]
v_pk_add_f32 v[8:9],v[8:9],v[100:101]
v_pk_add_f32 v[10:11],v[10:11],v[102:103]
v_pk_add_f32 v[8:9],v[8:9],v[10:11]
v_add_f32 v8,v8,v9
s_nop 1
v_add_f32_dpp v8,v8,v8 row_ror:4 row_mask:0xf bank_mask:0xf
s_nop 1
v_add_f32_dpp v8,v8,v8 row_ror:8 row_mask:0xf bank_mask:0xf
v_mov_b32 v12,v8
s_nop 1
v_permlane16_swap_b32 v12,v8
v_add_f32 v8,v8,v12
v_mov_b32 v12,v8
s_nop 1
v_permlane32_swap_b32 v12,v8
v_add_f32 v8,v8,v12
v_mul_f32 v8,0xba800000,v8
v_pk_add_f32 v[40:41],v[40:41],v[8:9] op_sel_hi:[1,0]
v_pk_add_f32 v[42:43],v[42:43],v[8:9] op_sel_hi:[1,0]
v_pk_add_f32 v[44:45],v[44:45],v[8:9] op_sel_hi:[1,0]
v_pk_add_f32 v[46:47],v[46:47],v[8:9] op_sel_hi:[1,0]
v_pk_add_f32 v[48:49],v[48:49],v[8:9] op_sel_hi:[1,0]
v_pk_add_f32 v[50:51],v[50:51],v[8:9] op_sel_hi:[1,0]
v_pk_add_f32 v[52:53],v[52:53],v[8:9] op_sel_hi:[1,0]
v_pk_add_f32 v[54:55],v[54:55],v[8:9] op_sel_hi:[1,0]
v_pk_add_f32 v[56:57],v[56:57],v[8:9] op_sel_hi:[1,0]
v_pk_add_f32 v[58:59],v[58:59],v[8:9] op_sel_hi:[1,0]
v_pk_add_f32 v[60:61],v[60:61],v[8:9] op_sel_hi:[1,0]
v_pk_add_f32 v[62:63],v[62:63],v[8:9] op_sel_hi:[1,0]
v_pk_add_f32 v[64:65],v[64:65],v[8:9] op_sel_hi:[1,0]
v_pk_add_f32 v[66:67],v[66:67],v[8:9] op_sel_hi:[1,0]
v_pk_add_f32 v[68:69],v[68:69],v[8:9] op_sel_hi:[1,0]
v_pk_add_f32 v[70:71],v[70:71],v[8:9] op_sel_hi:[1,0]
v_pk_add_f32 v[72:73],v[72:73],v[8:9] op_sel_hi:[1,0]
v_pk_add_f32 v[74:75],v[74:75],v[8:9] op_sel_hi:[1,0]
v_pk_add_f32 v[76:77],v[76:77],v[8:9] op_sel_hi:[1,0]
v_pk_add_f32 v[78:79],v[78:79],v[8:9] op_sel_hi:[1,0]
v_pk_add_f32 v[80:81],v[80:81],v[8:9] op_sel_hi:[1,0]
v_pk_add_f32 v[82:83],v[82:83],v[8:9] op_sel_hi:[1,0]
v_pk_add_f32 v[84:85],v[84:85],v[8:9] op_sel_hi:[1,0]
v_pk_add_f32 v[86:87],v[86:87],v[8:9] op_sel_hi:[1,0]
v_pk_add_f32 v[88:89],v[88:89],v[8:9] op_sel_hi:[1,0]
v_pk_add_f32 v[90:91],v[90:91],v[8:9] op_sel_hi:[1,0]
v_pk_add_f32 v[92:93],v[92:93],v[8:9] op_sel_hi:[1,0]
v_pk_add_f32 v[94:95],v[94:95],v[8:9] op_sel_hi:[1,0]
v_pk_add_f32 v[96:97],v[96:97],v[8:9] op_sel_hi:[1,0]
v_pk_add_f32 v[98:99],v[98:99],v[8:9] op_sel_hi:[1,0]
v_pk_add_f32 v[100:101],v[100:101],v[8:9] op_sel_hi:[1,0]
v_pk_add_f32 v[102:103],v[102:103],v[8:9] op_sel_hi:[1,0]
v_pk_mul_f32 v[10:11],v[40:41],v[40:41]
v_pk_mul_f32 v[14:15],v[42:43],v[42:43]
v_pk_fma_f32 v[10:11],v[44:45],v[44:45],v[10:11]
v_pk_fma_f32 v[14:15],v[46:47],v[46:47],v[14:15]
v_pk_fma_f32 v[10:11],v[48:49],v[48:49],v[10:11]
v_pk_fma_f32 v[14:15],v[50:51],v[50:51],v[14:15]
v_pk_fma_f32 v[10:11],v[52:53],v[52:53],v[10:11]
v_pk_fma_f32 v[14:15],v[54:55],v[54:55],v[14:15]
v_pk_fma_f32 v[10:11],v[56:57],v[56:57],v[10:11]
v_pk_fma_f32 v[14:15],v[58:59],v[58:59],v[14:15]
v_pk_fma_f32 v[10:11],v[60:61],v[60:61],v[10:11]
v_pk_fma_f32 v[14:15],v[62:63],v[62:63],v[14:15]
v_pk_fma_f32 v[10:11],v[64:65],v[64:65],v[10:11]
v_pk_fma_f32 v[14:15],v[66:67],v[66:67],v[14:15]
v_pk_fma_f32 v[10:11],v[68:69],v[68:69],v[10:11]
v_pk_fma_f32 v[14:15],v[70:71],v[70:71],v[14:15]
v_pk_fma_f32 v[10:11],v[72:73],v[72:73],v[10:11]
v_pk_fma_f32 v[14:15],v[74:75],v[74:75],v[14:15]
v_pk_fma_f32 v[10:11],v[76:77],v[76:77],v[10:11]
v_pk_fma_f32 v[14:15],v[78:79],v[78:79],v[14:15]
v_pk_fma_f32 v[10:11],v[80:81],v[80:81],v[10:11]
v_pk_fma_f32 v[14:15],v[82:83],v[82:83],v[14:15]
v_pk_fma_f32 v[10:11],v[84:85],v[84:85],v[10:11]
v_pk_fma_f32 v[14:15],v[86:87],v[86:87],v[14:15]
v_pk_fma_f32 v[10:11],v[88:89],v[88:89],v[10:11]
v_pk_fma_f32 v[14:15],v[90:91],v[90:91],v[14:15]
v_pk_fma_f32 v[10:11],v[92:93],v[92:93],v[10:11]
v_pk_fma_f32 v[14:15],v[94:95],v[94:95],v[14:15]
v_pk_fma_f32 v[10:11],v[96:97],v[96:97],v[10:11]
v_pk_fma_f32 v[14:15],v[98:99],v[98:99],v[14:15]
v_pk_fma_f32 v[10:11],v[100:101],v[100:101],v[10:11]
v_pk_fma_f32 v[14:15],v[102:103],v[102:103],v[14:15]
v_pk_add_f32 v[10:11],v[10:11],v[14:15]
v_add_f32 v10,v10,v11
s_nop 1
v_add_f32_dpp v10,v10,v10 row_ror:4 row_mask:0xf bank_mask:0xf
s_nop 1
v_add_f32_dpp v10,v10,v10 row_ror:8 row_mask:0xf bank_mask:0xf
v_mov_b32 v12,v10
s_nop 1
v_permlane16_swap_b32 v12,v10
v_add_f32 v10,v10,v12
v_mov_b32 v12,v10
s_nop 1
v_permlane32_swap_b32 v12,v10
v_add_f32 v10,v10,v12
v_mov_b32 v12,0x3727c5ac
v_fmac_f32 v12,0x3a800000,v10
v_rsq_f32 v10,v12
s_nop 0
v_pk_mul_f32 v[40:41],v[40:41],v[10:11] op_sel_hi:[1,0]
v_pk_mul_f32 v[42:43],v[42:43],v[10:11] op_sel_hi:[1,0]
v_pk_mul_f32 v[44:45],v[44:45],v[10:11] op_sel_hi:[1,0]
v_pk_mul_f32 v[46:47],v[46:47],v[10:11] op_sel_hi:[1,0]
v_pk_mul_f32 v[48:49],v[48:49],v[10:11] op_sel_hi:[1,0]
v_pk_mul_f32 v[50:51],v[50:51],v[10:11] op_sel_hi:[1,0]
v_pk_mul_f32 v[52:53],v[52:53],v[10:11] op_sel_hi:[1,0]
v_pk_mul_f32 v[54:55],v[54:55],v[10:11] op_sel_hi:[1,0]
v_pk_mul_f32 v[56:57],v[56:57],v[10:11] op_sel_hi:[1,0]
v_pk_mul_f32 v[58:59],v[58:59],v[10:11] op_sel_hi:[1,0]
v_pk_mul_f32 v[60:61],v[60:61],v[10:11] op_sel_hi:[1,0]
v_pk_mul_f32 v[62:63],v[62:63],v[10:11] op_sel_hi:[1,0]
v_pk_mul_f32 v[64:65],v[64:65],v[10:11] op_sel_hi:[1,0]
v_pk_mul_f32 v[66:67],v[66:67],v[10:11] op_sel_hi:[1,0]
v_pk_mul_f32 v[68:69],v[68:69],v[10:11] op_sel_hi:[1,0]
v_pk_mul_f32 v[70:71],v[70:71],v[10:11] op_sel_hi:[1,0]
v_pk_mul_f32 v[72:73],v[72:73],v[10:11] op_sel_hi:[1,0]
v_pk_mul_f32 v[74:75],v[74:75],v[10:11] op_sel_hi:[1,0]
v_pk_mul_f32 v[76:77],v[76:77],v[10:11] op_sel_hi:[1,0]
v_pk_mul_f32 v[78:79],v[78:79],v[10:11] op_sel_hi:[1,0]
v_pk_mul_f32 v[80:81],v[80:81],v[10:11] op_sel_hi:[1,0]
v_pk_mul_f32 v[82:83],v[82:83],v[10:11] op_sel_hi:[1,0]
v_pk_mul_f32 v[84:85],v[84:85],v[10:11] op_sel_hi:[1,0]
v_pk_mul_f32 v[86:87],v[86:87],v[10:11] op_sel_hi:[1,0]
v_pk_mul_f32 v[88:89],v[88:89],v[10:11] op_sel_hi:[1,0]
v_pk_mul_f32 v[90:91],v[90:91],v[10:11] op_sel_hi:[1,0]
v_pk_mul_f32 v[92:93],v[92:93],v[10:11] op_sel_hi:[1,0]
v_pk_mul_f32 v[94:95],v[94:95],v[10:11] op_sel_hi:[1,0]
v_pk_mul_f32 v[96:97],v[96:97],v[10:11] op_sel_hi:[1,0]
v_pk_mul_f32 v[98:99],v[98:99],v[10:11] op_sel_hi:[1,0]
v_pk_mul_f32 v[100:101],v[100:101],v[10:11] op_sel_hi:[1,0]
v_pk_mul_f32 v[102:103],v[102:103],v[10:11] op_sel_hi:[1,0]
v_mov_b32 v187,158976
s_cmp_lg_u32 s50,0
s_cbranch_scc1 sh0_39
s_mov_b32 s65,0
s_cmp_eq_u32 s56,1
s_cbranch_scc1 m1s_40
s_lshl_b32 s52,s55,7
s_add_u32 s52,s52,21102592
s_mov_b32 s53,0
m1l_41:
v_mov_b32 v184,0
buffer_load_dword v185,v184,s[20:23],s52 offen sc1
s_waitcnt vmcnt(0)
v_readfirstlane_b32 s64,v185
s_mov_b32 s65,0
s_cmp_eq_u32 s64,1
s_cbranch_scc1 m1ok_42
s_sub_u32 s90,s90,1
s_cmp_lt_i32 s90,0
s_cbranch_scc1 m1ok_42
s_add_u32 s53,s53,1
s_and_b32 s64,s53,31
s_cbranch_scc1 m1l_41
v_and_b32 v184,3,v1
v_bfe_u32 v185,v1,2,1
v_lshlrev_b32 v184,2,v184
v_lshl_add_u32 v184,v185,7,v184
v_writelane_b32 v184,32,8
s_mov_b64 exec,0x1ff
vpoll_43:
buffer_load_dword v185,v184,s[44:47],0 offen sc1
s_waitcnt vmcnt(0)
vfirst_46:
v_readlane_b32 s92,v185,0
v_readlane_b32 s93,v185,1
v_readlane_b32 s94,v185,2
v_readlane_b32 s95,v185,3
v_readlane_b32 s96,v185,4
v_readlane_b32 s97,v185,5
v_readlane_b32 s98,v185,6
v_readlane_b32 s99,v185,7
v_readlane_b32 s61,v185,8
s_add_u32 s64,s92,s93
s_add_u32 s64,s64,s94
s_add_u32 s64,s64,s95
s_add_u32 s64,s64,s96
s_add_u32 s64,s64,s97
s_add_u32 s64,s64,s98
s_add_u32 s64,s64,s99
s_min_u32 s65,s92,s93
s_min_u32 s66,s94,s95
s_min_u32 s65,s65,s66
s_min_u32 s66,s96,s97
s_min_u32 s65,s65,s66
s_min_u32 s66,s98,s99
s_min_u32 s65,s65,s66
s_cmp_lt_u32 s65,32
s_cselect_b32 s65,1,0
s_cmp_lt_u32 s64,256
s_cbranch_scc1 vslp_45
s_branch vgot_44
vslp_45:
s_sleep 8
s_sub_u32 s90,s90,1
s_cmp_gt_i32 s90,0
s_cbranch_scc1 vpoll_43
vgot_44:
s_mov_b64 exec,-1
s_and_b32 s61,s61,1
s_lshl_b32 s61,s61,13
s_mov_b32 s66,s54
s_cmp_gt_u32 s51,0
s_cselect_b32 s64,s92,0
s_add_u32 s66,s66,s64
s_cmp_gt_u32 s51,1
s_cselect_b32 s64,s93,0
s_add_u32 s66,s66,s64
s_cmp_gt_u32 s51,2
s_cselect_b32 s64,s94,0
s_add_u32 s66,s66,s64
s_cmp_gt_u32 s51,3
s_cselect_b32 s64,s95,0
s_add_u32 s66,s66,s64
s_cmp_gt_u32 s51,4
s_cselect_b32 s64,s96,0
s_add_u32 s66,s66,s64
s_cmp_gt_u32 s51,5
s_cselect_b32 s64,s97,0
s_add_u32 s66,s66,s64
s_cmp_gt_u32 s51,6
s_cselect_b32 s64,s98,0
s_add_u32 s66,s66,s64
s_cmp_eq_u32 s65,0
s_cbranch_scc1 m1l_41
s_branch m1ok_42
m1s_40:
s_mov_b32 s53,256
s_mov_b32 s52,164
v_mov_b32 v184,0
dp_47:
buffer_load_dword v185,v184,s[44:47],s52 offen sc1
s_waitcnt vmcnt(0)
v_cmp_ne_u32 vcc,s53,v185
s_cbranch_vccz dpok_48
s_sleep 8
s_sub_u32 s90,s90,1
s_cmp_gt_i32 s90,0
s_cbranch_scc1 dp_47
dpok_48:
m1ok_42:
v_mov_b32 v184,s65
v_mov_b32 v185,s66
v_mov_b32 v186,s61
ds_write_b96 v187,v[184:186] offset:16
s_waitcnt lgkmcnt(0)
sh0_39:
s_barrier
ds_read_b96 v[184:186],v187 offset:16
s_waitcnt lgkmcnt(0)
v_readfirstlane_b32 s65,v184
v_readfirstlane_b32 s66,v185
v_readfirstlane_b32 s61,v186
s_cmp_lg_u32 s65,0
s_cbranch_scc1 slowrole_10
s_and_b32 s56,s56,1
s_lshl_b32 s53,s56,2
s_add_u32 s53,s53,4
v_mul_u32_u24 v241,s53,v1
s_lshr_b32 s53,s55,4
s_or_b32 s53,s53,s50
s_cselect_b32 s53,0x7fff0000,32
s_mov_b64 exec,3
buffer_load_dword v240,v241,s[44:47],s53 offen sc1
s_mov_b64 exec,-1
v_lshlrev_b32 v7,5,v0
s_mov_b32 s40,24576
buffer_load_dwordx4 v[104:107],v7,s[20:23],s40 offen offset:0 sc1
buffer_load_dwordx4 v[108:111],v7,s[20:23],s40 offen offset:16 sc1
s_add_u32 s40,s40,8192
buffer_load_dwordx4 v[112:115],v7,s[20:23],s40 offen offset:0 sc1
buffer_load_dwordx4 v[116:119],v7,s[20:23],s40 offen offset:16 sc1
s_add_u32 s40,s40,8192
buffer_load_dwordx4 v[120:123],v7,s[20:23],s40 offen offset:0 sc1
buffer_load_dwordx4 v[124:127],v7,s[20:23],s40 offen offset:16 sc1
s_add_u32 s40,s40,8192
buffer_load_dwordx4 v[128:131],v7,s[20:23],s40 offen offset:0 sc1
buffer_load_dwordx4 v[132:135],v7,s[20:23],s40 offen offset:16 sc1
v_mov_b32 v14,1.0
v_cmp_lt_u32 vcc,127,v0
s_nop 1
v_cndmask_b32 v14,0,v14,vcc
s_waitcnt vmcnt(0)
v_pk_add_f32 v[104:105],v[104:105],v[112:113]
v_pk_add_f32 v[120:121],v[120:121],v[128:129]
v_pk_add_f32 v[106:107],v[106:107],v[114:115]
v_pk_add_f32 v[122:123],v[122:123],v[130:131]
v_pk_add_f32 v[108:109],v[108:109],v[116:117]
v_pk_add_f32 v[124:125],v[124:125],v[132:133]
v_pk_add_f32 v[110:111],v[110:111],v[118:119]
v_pk_add_f32 v[126:127],v[126:127],v[134:135]
v_pk_add_f32 v[104:105],v[104:105],v[120:121]
v_pk_add_f32 v[106:107],v[106:107],v[122:123]
v_pk_add_f32 v[108:109],v[108:109],v[124:125]
v_pk_add_f32 v[110:111],v[110:111],v[126:127]
v_cvt_pk_bf16_f32 v112,v104,v105
v_cvt_pk_bf16_f32 v113,v106,v107
v_cvt_pk_bf16_f32 v114,v108,v109
v_cvt_pk_bf16_f32 v115,v110,v111
v_lshlrev_b32 v104,16,v112
v_and_b32 v105,s39,v112
v_lshlrev_b32 v106,16,v113
v_and_b32 v107,s39,v113
v_lshlrev_b32 v108,16,v114
v_and_b32 v109,s39,v114
v_lshlrev_b32 v110,16,v115
v_and_b32 v111,s39,v115
v_pk_add_f32 v[104:105],v[104:105],v[14:15] op_sel_hi:[1,0]
v_pk_add_f32 v[106:107],v[106:107],v[14:15] op_sel_hi:[1,0]
v_pk_add_f32 v[108:109],v[108:109],v[14:15] op_sel_hi:[1,0]
v_pk_add_f32 v[110:111],v[110:111],v[14:15] op_sel_hi:[1,0]
ds_write_b128 v7,v[104:107] offset:4096
ds_write_b128 v7,v[108:111] offset:4112
s_waitcnt lgkmcnt(0)
s_barrier
ds_read_b128 v[104:107],v4 offset:8192
ds_read_b128 v[168:171],v4 offset:4096
ds_read_b128 v[108:111],v4 offset:8208
ds_read_b128 v[172:175],v4 offset:4112
ds_read_b128 v[112:115],v4 offset:8224
ds_read_b128 v[176:179],v4 offset:4128
ds_read_b128 v[116:119],v4 offset:8240
ds_read_b128 v[180:183],v4 offset:4144
ds_read_b128 v[120:123],v4 offset:9216
ds_read_b128 v[184:187],v4 offset:5120
ds_read_b128 v[124:127],v4 offset:9232
ds_read_b128 v[188:191],v4 offset:5136
ds_read_b128 v[128:131],v4 offset:9248
ds_read_b128 v[192:195],v4 offset:5152
ds_read_b128 v[132:135],v4 offset:9264
ds_read_b128 v[196:199],v4 offset:5168
ds_read_b128 v[136:139],v4 offset:10240
ds_read_b128 v[200:203],v4 offset:6144
ds_read_b128 v[140:143],v4 offset:10256
ds_read_b128 v[204:207],v4 offset:6160
ds_read_b128 v[144:147],v4 offset:10272
ds_read_b128 v[208:211],v4 offset:6176
ds_read_b128 v[148:151],v4 offset:10288
ds_read_b128 v[212:215],v4 offset:6192
ds_read_b128 v[152:155],v4 offset:11264
ds_read_b128 v[216:219],v4 offset:7168
ds_read_b128 v[156:159],v4 offset:11280
ds_read_b128 v[220:223],v4 offset:7184
ds_read_b128 v[160:163],v4 offset:11296
ds_read_b128 v[224:227],v4 offset:7200
ds_read_b128 v[164:167],v4 offset:11312
ds_read_b128 v[228:231],v4 offset:7216
s_waitcnt lgkmcnt(15)
v_pk_fma_f32 v[40:41],v[40:41],v[104:105],v[168:169]
v_pk_fma_f32 v[42:43],v[42:43],v[106:107],v[170:171]
v_pk_fma_f32 v[44:45],v[44:45],v[108:109],v[172:173]
v_pk_fma_f32 v[46:47],v[46:47],v[110:111],v[174:175]
v_pk_fma_f32 v[48:49],v[48:49],v[112:113],v[176:177]
v_pk_fma_f32 v[50:51],v[50:51],v[114:115],v[178:179]
v_pk_fma_f32 v[52:53],v[52:53],v[116:117],v[180:181]
v_pk_fma_f32 v[54:55],v[54:55],v[118:119],v[182:183]
v_cvt_pk_bf16_f32 v16,v40,v41
v_cvt_pk_bf16_f32 v17,v48,v49
v_cvt_pk_bf16_f32 v18,v42,v43
v_cvt_pk_bf16_f32 v19,v50,v51
buffer_store_dwordx4 v[16:19],v6,s[20:23],s37 offen offset:0 sc1
v_cvt_pk_bf16_f32 v20,v44,v45
v_cvt_pk_bf16_f32 v21,v52,v53
v_cvt_pk_bf16_f32 v22,v46,v47
v_cvt_pk_bf16_f32 v23,v54,v55
buffer_store_dwordx4 v[20:23],v6,s[20:23],s37 offen offset:256 sc1
s_waitcnt lgkmcnt(15)
v_pk_fma_f32 v[56:57],v[56:57],v[120:121],v[184:185]
v_pk_fma_f32 v[58:59],v[58:59],v[122:123],v[186:187]
v_pk_fma_f32 v[60:61],v[60:61],v[124:125],v[188:189]
v_pk_fma_f32 v[62:63],v[62:63],v[126:127],v[190:191]
v_pk_fma_f32 v[64:65],v[64:65],v[128:129],v[192:193]
v_pk_fma_f32 v[66:67],v[66:67],v[130:131],v[194:195]
v_pk_fma_f32 v[68:69],v[68:69],v[132:133],v[196:197]
v_pk_fma_f32 v[70:71],v[70:71],v[134:135],v[198:199]
v_cvt_pk_bf16_f32 v24,v56,v57
v_cvt_pk_bf16_f32 v25,v64,v65
v_cvt_pk_bf16_f32 v26,v58,v59
v_cvt_pk_bf16_f32 v27,v66,v67
s_add_u32 s37,s37,16384
buffer_store_dwordx4 v[24:27],v6,s[20:23],s37 offen offset:0 sc1
v_cvt_pk_bf16_f32 v28,v60,v61
v_cvt_pk_bf16_f32 v29,v68,v69
v_cvt_pk_bf16_f32 v30,v62,v63
v_cvt_pk_bf16_f32 v31,v70,v71
buffer_store_dwordx4 v[28:31],v6,s[20:23],s37 offen offset:256 sc1
s_waitcnt lgkmcnt(8)
v_pk_fma_f32 v[72:73],v[72:73],v[136:137],v[200:201]
v_pk_fma_f32 v[74:75],v[74:75],v[138:139],v[202:203]
v_pk_fma_f32 v[76:77],v[76:77],v[140:141],v[204:205]
v_pk_fma_f32 v[78:79],v[78:79],v[142:143],v[206:207]
v_pk_fma_f32 v[80:81],v[80:81],v[144:145],v[208:209]
v_pk_fma_f32 v[82:83],v[82:83],v[146:147],v[210:211]
v_pk_fma_f32 v[84:85],v[84:85],v[148:149],v[212:213]
v_pk_fma_f32 v[86:87],v[86:87],v[150:151],v[214:215]
v_cvt_pk_bf16_f32 v16,v72,v73
v_cvt_pk_bf16_f32 v17,v80,v81
v_cvt_pk_bf16_f32 v18,v74,v75
v_cvt_pk_bf16_f32 v19,v82,v83
s_add_u32 s37,s37,16384
buffer_store_dwordx4 v[16:19],v6,s[20:23],s37 offen offset:0 sc1
v_cvt_pk_bf16_f32 v20,v76,v77
v_cvt_pk_bf16_f32 v21,v84,v85
v_cvt_pk_bf16_f32 v22,v78,v79
v_cvt_pk_bf16_f32 v23,v86,v87
buffer_store_dwordx4 v[20:23],v6,s[20:23],s37 offen offset:256 sc1
s_waitcnt lgkmcnt(0)
v_pk_fma_f32 v[88:89],v[88:89],v[152:153],v[216:217]
v_pk_fma_f32 v[90:91],v[90:91],v[154:155],v[218:219]
v_pk_fma_f32 v[92:93],v[92:93],v[156:157],v[220:221]
v_pk_fma_f32 v[94:95],v[94:95],v[158:159],v[222:223]
v_pk_fma_f32 v[96:97],v[96:97],v[160:161],v[224:225]
v_pk_fma_f32 v[98:99],v[98:99],v[162:163],v[226:227]
v_pk_fma_f32 v[100:101],v[100:101],v[164:165],v[228:229]
v_pk_fma_f32 v[102:103],v[102:103],v[166:167],v[230:231]
v_cvt_pk_bf16_f32 v24,v88,v89
v_cvt_pk_bf16_f32 v25,v96,v97
v_cvt_pk_bf16_f32 v26,v90,v91
v_cvt_pk_bf16_f32 v27,v98,v99
s_add_u32 s37,s37,16384
buffer_store_dwordx4 v[24:27],v6,s[20:23],s37 offen offset:0 sc1
v_cvt_pk_bf16_f32 v28,v92,v93
v_cvt_pk_bf16_f32 v29,v100,v101
v_cvt_pk_bf16_f32 v30,v94,v95
v_cvt_pk_bf16_f32 v31,v102,v103
buffer_store_dwordx4 v[28:31],v6,s[20:23],s37 offen offset:256 sc1
s_waitcnt vmcnt(0)
s_barrier
v_mov_b32 v187,158976
s_cmp_lg_u32 s50,0
s_cbranch_scc1 sh0_49
s_cmp_ge_u32 s55,16
s_cbranch_scc1 nodln_50
rdl_52:
v_readlane_b32 s64,v240,0
v_readlane_b32 s65,v240,1
s_cmp_eq_u32 s56,1
s_cselect_b32 s64,2,s64
s_cmp_eq_u32 s65,128
s_cselect_b32 s64,s64,0
s_cmp_lg_u32 s64,0
s_cbranch_scc1 rdok_53
s_mov_b64 exec,3
buffer_load_dword v240,v241,s[44:47],s53 offen sc1
s_mov_b64 exec,-1
s_sub_u32 s90,s90,1
s_cmp_gt_i32 s90,0
s_waitcnt vmcnt(0)
s_cbranch_scc1 rdl_52
rdok_53:
s_lshl_b32 s65,s55,2
v_lshl_add_u32 v184,v1,7,s65
v_mov_b32 v185,s64
s_mov_b32 s64,21168128
s_mov_b32 s65,21176320
buffer_store_dword v185,v184,s[20:23],s64 offen sc1
buffer_store_dword v185,v184,s[20:23],s65 offen sc1
nodln_50:
s_mov_b32 s61,0
s_cmp_eq_u32 s56,1
s_cbranch_scc1 nopar_51
v_mov_b32 v184,0
dp_54:
buffer_load_dword v185,v184,s[44:47],32 offen sc1
s_waitcnt vmcnt(0)
v_cmp_eq_u32 vcc,0,v185
s_cbranch_vccz dpok_55
s_sleep 4
s_sub_u32 s90,s90,1
s_cmp_gt_i32 s90,0
s_cbranch_scc1 dp_54
dpok_55:
v_readfirstlane_b32 s65,v185
s_and_b32 s65,s65,1
s_lshl_b32 s61,s65,13
nopar_51:
v_mov_b32 v184,s65
v_mov_b32 v185,s66
v_mov_b32 v186,s61
ds_write_b96 v187,v[184:186] offset:16
s_waitcnt lgkmcnt(0)
sh0_49:
s_barrier
ds_read_b96 v[184:186],v187 offset:16
s_waitcnt lgkmcnt(0)
v_readfirstlane_b32 s65,v184
v_readfirstlane_b32 s66,v185
v_readfirstlane_b32 s61,v186
s_sub_u32 s55,s57,128
s_cmp_lg_u32 s50,0
s_cbranch_scc1 nsig_56
s_lshr_b32 s95,s55,4
s_lshl_b32 s95,s95,6
s_add_u32 s95,s95,21052416
s_mov_b64 exec,1
v_mov_b32 v184,112
v_mov_b32 v185,0
buffer_atomic_add v184,v185,s[20:23],s95 offen sc1
s_mov_b64 exec,-1
nsig_56:
s_branch pipe_worker
loops_7:
s_lshl_b32 s64,s50,14
s_add_u32 m0,s64,0
s_add_u32 s65,s64,57344
buffer_load_dwordx4 v16,s[20:23],s65 offen offset:0 lds
buffer_load_dwordx4 v16,s[20:23],s65 offen offset:1024 lds
buffer_load_dwordx4 v16,s[20:23],s65 offen offset:2048 lds
buffer_load_dwordx4 v16,s[20:23],s65 offen offset:3072 lds
s_add_u32 m0,s64,4096
s_add_u32 s65,s64,61440
buffer_load_dwordx4 v16,s[20:23],s65 offen offset:0 lds
buffer_load_dwordx4 v16,s[20:23],s65 offen offset:1024 lds
buffer_load_dwordx4 v16,s[20:23],s65 offen offset:2048 lds
buffer_load_dwordx4 v16,s[20:23],s65 offen offset:3072 lds
s_add_u32 m0,s64,8192
s_add_u32 s65,s64,65536
buffer_load_dwordx4 v16,s[20:23],s65 offen offset:0 lds
buffer_load_dwordx4 v16,s[20:23],s65 offen offset:1024 lds
buffer_load_dwordx4 v16,s[20:23],s65 offen offset:2048 lds
buffer_load_dwordx4 v16,s[20:23],s65 offen offset:3072 lds
s_add_u32 m0,s64,12288
s_add_u32 s65,s64,69632
buffer_load_dwordx4 v16,s[20:23],s65 offen offset:0 lds
buffer_load_dwordx4 v16,s[20:23],s65 offen offset:1024 lds
buffer_load_dwordx4 v16,s[20:23],s65 offen offset:2048 lds
buffer_load_dwordx4 v16,s[20:23],s65 offen offset:3072 lds
s_add_u32 m0,s64,65536
s_add_u32 s65,s64,122880
buffer_load_dwordx4 v16,s[20:23],s65 offen offset:0 lds
buffer_load_dwordx4 v16,s[20:23],s65 offen offset:1024 lds
buffer_load_dwordx4 v16,s[20:23],s65 offen offset:2048 lds
buffer_load_dwordx4 v16,s[20:23],s65 offen offset:3072 lds
s_add_u32 m0,s64,69632
s_add_u32 s65,s64,126976
buffer_load_dwordx4 v16,s[20:23],s65 offen offset:0 lds
buffer_load_dwordx4 v16,s[20:23],s65 offen offset:1024 lds
buffer_load_dwordx4 v16,s[20:23],s65 offen offset:2048 lds
buffer_load_dwordx4 v16,s[20:23],s65 offen offset:3072 lds
s_add_u32 m0,s64,73728
s_add_u32 s65,s64,131072
buffer_load_dwordx4 v16,s[20:23],s65 offen offset:0 lds
buffer_load_dwordx4 v16,s[20:23],s65 offen offset:1024 lds
buffer_load_dwordx4 v16,s[20:23],s65 offen offset:2048 lds
buffer_load_dwordx4 v16,s[20:23],s65 offen offset:3072 lds
s_add_u32 m0,s64,77824
s_add_u32 s65,s64,135168
buffer_load_dwordx4 v16,s[20:23],s65 offen offset:0 lds
buffer_load_dwordx4 v16,s[20:23],s65 offen offset:1024 lds
buffer_load_dwordx4 v16,s[20:23],s65 offen offset:2048 lds
buffer_load_dwordx4 v16,s[20:23],s65 offen offset:3072 lds
s_mov_b64 s[24:25],s[20:21]
s_mov_b64 s[28:29],s[20:21]
s_mov_b32 s27,0x20000
s_mov_b32 s31,0x20000
s_cmp_eq_u32 s56,0
s_cselect_b32 s26,s22,0
s_cselect_b32 s30,0,s22
s_lshl_b32 s64,s58,14
s_add_u32 s64,s64,23068672
v_add_u32 v26,s64,v16
v_add_u32 v27,4096,v26
v_add_u32 v28,8192,v26
v_add_u32 v29,12288,v26
s_lshl_b32 s65,s59,9
s_add_u32 s66,s64,s65
s_lshl_b32 s64,s58,7
s_add_u32 s64,s64,23592960
v_and_b32 v18,31,v1
v_lshl_add_u32 v18,v18,2,s64
s_lshl_b32 s65,s59,2
s_add_u32 s64,s64,s65
v_mov_b32 v13,s64
v_mov_b32 v14,0x4444
v_mov_b32 v22,0xeeee
v_cmp_lt_u32 vcc,7,v3
s_nop 1
v_cndmask_b32 v14,v14,v22,vcc
v_and_b32 v22,1,v3
v_cmp_eq_u32 vcc,0,v22
v_mov_b32 v15,0x03020706
v_mov_b32 v23,0x05040100
v_cndmask_b32 v15,v15,v23,vcc
v_lshlrev_b32 v19,5,v22
v_lshl_add_u32 v19,v4,6,v19
v_lshrrev_b32 v23,1,v3
v_lshl_add_u32 v19,v23,2,v19
s_lshl_b32 s67,s57,10
s_add_u32 s67,s67,23199744
s_lshl_b32 s64,s50,2
s_lshr_b32 s64,0x1320,s64
s_and_b32 s64,s64,3
s_lshl_b32 s64,s64,8
s_add_u32 s64,s64,s67
v_add_u32 v19,s64,v19
v_add_u32 v24,131072,v16
v_mov_b32 v21,158720
v_mov_b32 v25,0
v_mov_b32 v20,v16
v_and_b32 v22,1,v4
v_lshrrev_b32 v23,1,v4
v_lshl_add_u32 v23,v23,4,v3
v_lshlrev_b32 v23,4,v23
v_lshl_add_u32 v23,v22,10,v23
s_lshr_b32 s64,s50,1
s_lshl_b32 s64,s64,9
v_add_u32 v23,s64,v23
s_lshr_b32 s64,s57,2
s_add_u32 s65,s64,32
s_lshl_b32 s65,s65,14
s_and_b32 s68,s57,3
s_lshl_b32 s68,s68,11
s_add_u32 s65,s65,s68
s_add_u32 s65,s65,29360128
v_add_u32 v17,s65,v23
s_lshl_b32 s69,s57,11
s_add_u32 s69,s69,23330816
v_add_u32 v2,s69,v23
s_mov_b32 s81,0x3e0293ee
s_mov_b32 s84,0xff00ff
s_mov_b32 s85,0xff00ff
s_mov_b32 s86,0x33333333
s_mov_b32 s87,0x33333333
s_mov_b32 s62,0x10000
s_mov_b32 s79,-2
ds_write_b32 v21,v25
ds_write_b32 v21,v25 offset:4
ds_write_b32 v21,v25 offset:8
ds_write_b32 v21,v25 offset:12
ds_write_b32 v21,v25 offset:16
ds_write_b32 v21,v25 offset:24
ds_write_b32 v21,v25 offset:28
v_mov_b32 v100,0
v_mov_b32 v101,0
v_mov_b32 v102,0
v_mov_b32 v103,0
s_lshr_b32 s64,s59,3
s_lshl_b32 s64,s64,14
s_and_b32 s65,s59,7
s_lshl_b32 s65,s65,10
s_add_u32 s64,s64,s65
s_lshl_b32 s65,s58,16
s_add_u32 s64,s64,s65
s_add_u32 s64,s64,31195136
v_add_u32 v8,s64,v16
s_cmp_eq_u32 s50,3
s_cbranch_scc1 w3_61
s_cmp_eq_u32 s50,1
s_cbranch_scc1 w1_59
s_cmp_eq_u32 s50,2
s_cbranch_scc1 w2_60
w0_58:
v_and_b32 v22,7,v3
v_lshrrev_b32 v23,2,v22
v_and_b32 v5,2,v22
v_or_b32 v23,v23,v5
v_and_b32 v5,1,v22
v_lshl_add_u32 v23,v23,1,v5
v_lshlrev_b32 v23,5,v23
v_lshrrev_b32 v5,3,v3
v_lshl_add_u32 v23,v5,9,v23
v_lshrrev_b32 v5,1,v4
v_lshl_add_u32 v23,v5,8,v23
v_and_b32 v5,1,v4
v_lshl_add_u32 v23,v5,4,v23
v_add_u32 v8,s67,v23
v_xor_b32 v9,1024,v8
v_xor_b32 v10,2048,v8
v_xor_b32 v11,3072,v8
v_lshlrev_b32 v31,4,v3
v_lshl_add_u32 v31,v5,3,v31
v_add_u32 v31,155648,v31
v_lshl_add_u32 v23,v4,3,v22
v_lshlrev_b32 v23,4,v23
v_add_u32 v12,155648,v23
v_add_u32 v30,s66,v23
v_cmp_gt_u32 vcc,8,v3
v_cmp_lt_u32 s[52:53],1,v4
s_and_b64 vcc,vcc,s[52:53]
v_mov_b32 v22,0xf149f2ca
v_cndmask_b32 v156,v22,0,vcc
v_mov_b32 v157,v156
v_mov_b32 v158,v156
v_mov_b32 v159,v156
v_add_u32 v2,s69,v16
v_xor_b32 v5,2048,v2
v_xor_b32 v6,4096,v2
v_xor_b32 v7,6144,v2
s_lshr_b32 s64,s57,3
s_add_u32 s64,s64,96
s_lshl_b32 s64,s64,14
s_and_b32 s65,s57,7
s_lshl_b32 s65,s65,10
s_add_u32 s64,s64,s65
s_add_u32 s64,s64,29360128
v_add_u32 v3,s64,v16
v_mov_b32 v136,0
v_mov_b32 v137,0
v_mov_b32 v138,0
v_mov_b32 v139,0
v_mov_b32 v140,0
v_mov_b32 v141,0
v_mov_b32 v142,0
v_mov_b32 v143,0
v_mov_b32 v144,0
v_mov_b32 v145,0
v_mov_b32 v146,0
v_mov_b32 v147,0
v_mov_b32 v152,0x3f803f80
v_mov_b32 v153,0x3f803f80
v_mov_b32 v154,0x3f803f80
v_mov_b32 v155,0x3f803f80
s_branch first_62
loop_63:
s_barrier
hl_65:
buffer_load_dword v248,v18,s[20:23],s70 offen offset:0 sc1
s_waitcnt vmcnt(0)
v_cmp_eq_u32 vcc,v25,v248
s_bcnt1_i32_b32 s64,vcc_lo
s_cmp_ge_u32 s64,8
s_cbranch_scc1 hg_66
s_sub_u32 s90,s90,1
s_cmp_gt_i32 s90,0
s_cbranch_scc1 hl_65
hg_66:
buffer_load_dwordx4 v[32:35],v26,s[20:23],s70 offen offset:0 sc1
buffer_load_dwordx4 v[36:39],v26,s[20:23],s70 offen offset:1024 sc1
buffer_load_dwordx4 v[40:43],v26,s[20:23],s70 offen offset:2048 sc1
buffer_load_dwordx4 v[44:47],v26,s[20:23],s70 offen offset:3072 sc1
s_waitcnt vmcnt(3)
ds_write_b128 v24,v[32:35] offset:0
v_min3_u32 v22,v32,v33,v34
v_min_u32 v22,v22,v35
s_waitcnt vmcnt(2)
ds_write_b128 v24,v[36:39] offset:1024
v_min3_u32 v22,v22,v36,v37
v_min3_u32 v22,v22,v38,v39
s_waitcnt vmcnt(1)
ds_write_b128 v24,v[40:43] offset:2048
v_min3_u32 v22,v22,v40,v41
v_min3_u32 v22,v22,v42,v43
s_waitcnt vmcnt(0)
ds_write_b128 v24,v[44:47] offset:3072
v_min3_u32 v22,v22,v44,v45
v_min3_u32 v22,v22,v46,v47
v_cmp_eq_u32 vcc,0,v22
s_cbranch_vccnz art_67
abk_68:
v_smfmac_f32_16x16x64_bf16 v[176:179],v[32:35],a[0:7],v14
s_waitcnt lgkmcnt(0)
s_barrier
ds_read_b128 v[48:51],v24 offset:4096
ds_read_b128 v[52:55],v24 offset:5120
ds_read_b128 v[56:59],v24 offset:6144
ds_read_b128 v[60:63],v24 offset:7168
v_smfmac_f32_16x16x64_bf16 v[176:179],v[36:39],a[8:15],v14
ds_read_b128 v[64:67],v24 offset:8192
ds_read_b128 v[68:71],v24 offset:9216
v_smfmac_f32_16x16x64_bf16 v[176:179],v[40:43],a[16:23],v14
ds_read_b128 v[72:75],v24 offset:10240
ds_read_b128 v[76:79],v24 offset:11264
v_smfmac_f32_16x16x64_bf16 v[176:179],v[44:47],a[24:31],v14
ds_read_b128 v[80:83],v24 offset:12288
ds_read_b128 v[84:87],v24 offset:13312
s_waitcnt lgkmcnt(9)
v_smfmac_f32_16x16x64_bf16 v[176:179],v[48:51],a[32:39],v14
ds_read_b128 v[88:91],v24 offset:14336
s_waitcnt lgkmcnt(9)
v_smfmac_f32_16x16x64_bf16 v[176:179],v[52:55],a[40:47],v14
ds_read_b128 v[92:95],v24 offset:15360
s_waitcnt lgkmcnt(9)
v_smfmac_f32_16x16x64_bf16 v[176:179],v[56:59],a[48:55],v14
s_waitcnt lgkmcnt(8)
v_smfmac_f32_16x16x64_bf16 v[176:179],v[60:63],a[56:63],v14
s_waitcnt lgkmcnt(7)
v_smfmac_f32_16x16x64_bf16 v[176:179],v[64:67],a[64:71],v14
s_waitcnt lgkmcnt(6)
v_smfmac_f32_16x16x64_bf16 v[176:179],v[68:71],a[72:79],v14
s_waitcnt lgkmcnt(5)
v_smfmac_f32_16x16x64_bf16 v[176:179],v[72:75],a[80:87],v14
s_waitcnt lgkmcnt(4)
v_smfmac_f32_16x16x64_bf16 v[176:179],v[76:79],a[88:95],v14
s_waitcnt lgkmcnt(3)
v_smfmac_f32_16x16x64_bf16 v[176:179],v[80:83],a[96:103],v14
s_waitcnt lgkmcnt(2)
v_smfmac_f32_16x16x64_bf16 v[176:179],v[84:87],a[104:111],v14
s_waitcnt lgkmcnt(1)
v_smfmac_f32_16x16x64_bf16 v[176:179],v[88:91],a[112:119],v14
s_waitcnt lgkmcnt(0)
v_smfmac_f32_16x16x64_bf16 v[176:179],v[92:95],a[120:127],v14
s_nop 7
v_permlane32_swap_b32 v176,v178
v_permlane32_swap_b32 v177,v179
v_add_f32 v176,v176,v178
v_add_f32 v177,v177,v179
v_cvt_pk_bf16_f32 v216,v176,v177
s_nop 1
v_mov_b32_dpp v217,v216 quad_perm:[1,0,3,2] row_mask:0xf bank_mask:0xf
v_perm_b32 v216,v217,v216,v15
v_max_u32 v216,1,v216
buffer_store_dword v216,v19,s[24:27],s70 offen
buffer_store_dword v216,v19,s[28:31],s70 offen sc1
s_lshr_b32 s64,s70,9
v_add_u32 v22,s64,v24
s_cmp_eq_u32 s79,0
ds_read_b128 v[128:131],v22 offset:16384
ds_read_b128 v[132:135],v22 offset:17408
s_cbranch_scc1 kt0_69
kt0b_70:
s_nop 15
s_nop 12
buffer_load_dwordx4 v[32:35],v8,s[20:23],s70 offen sc1
buffer_load_dwordx4 v[36:39],v9,s[20:23],s70 offen sc1
buffer_load_dwordx4 v[40:43],v10,s[20:23],s70 offen sc1
buffer_load_dwordx4 v[44:47],v11,s[20:23],s70 offen sc1
s_nop 9
scp_71:
buffer_load_dwordx4 v[48:51],v8,s[20:23],s70 offen sc1
buffer_load_dwordx4 v[52:55],v9,s[20:23],s70 offen sc1
buffer_load_dwordx4 v[56:59],v10,s[20:23],s70 offen sc1
buffer_load_dwordx4 v[60:63],v11,s[20:23],s70 offen sc1
s_waitcnt vmcnt(4)
v_mfma_f32_16x16x32_bf16 v[168:171],v[32:35],v[32:35],v[156:159]
v_min3_u32 v22,v32,v33,v34
v_min3_u32 v22,v22,v35,v36
v_mfma_f32_16x16x32_bf16 v[164:167],v[100:103],v[32:35],0
v_min3_u32 v22,v22,v37,v38
v_min3_u32 v22,v22,v39,v40
v_mfma_f32_16x16x32_bf16 v[160:163],v[96:99],v[32:35],0
v_min3_u32 v22,v22,v41,v42
v_min3_u32 v22,v22,v43,v44
v_mfma_f32_16x16x32_bf16 v[168:171],v[36:39],v[36:39],v[168:171]
v_min3_u32 v22,v22,v45,v46
v_min_u32 v22,v22,v47
v_mfma_f32_16x16x32_bf16 v[164:167],v[108:111],v[36:39],v[164:167]
v_cmp_eq_u32 vcc,0,v22
s_cbranch_vccnz nx_73
v_mfma_f32_16x16x32_bf16 v[160:163],v[104:107],v[36:39],v[160:163]
v_mov_b32 v172,v32
v_mfma_f32_16x16x32_bf16 v[168:171],v[40:43],v[40:43],v[168:171]
v_mov_b32 v173,v33
v_mfma_f32_16x16x32_bf16 v[164:167],v[116:119],v[40:43],v[164:167]
v_mov_b32 v174,v34
v_mfma_f32_16x16x32_bf16 v[160:163],v[112:115],v[40:43],v[160:163]
v_mov_b32 v175,v35
v_mfma_f32_16x16x32_bf16 v[168:171],v[44:47],v[44:47],v[168:171]
v_mfma_f32_16x16x32_bf16 v[164:167],v[124:127],v[44:47],v[164:167]
v_mfma_f32_16x16x32_bf16 v[160:163],v[120:123],v[44:47],v[160:163]
s_nop 1
s_branch scok_72
nx_73:
buffer_load_dwordx4 v[32:35],v8,s[20:23],s70 offen sc1
buffer_load_dwordx4 v[36:39],v9,s[20:23],s70 offen sc1
buffer_load_dwordx4 v[40:43],v10,s[20:23],s70 offen sc1
buffer_load_dwordx4 v[44:47],v11,s[20:23],s70 offen sc1
s_waitcnt vmcnt(4)
v_mfma_f32_16x16x32_bf16 v[168:171],v[48:51],v[48:51],v[156:159]
v_min3_u32 v22,v48,v49,v50
v_min3_u32 v22,v22,v51,v52
v_mfma_f32_16x16x32_bf16 v[164:167],v[100:103],v[48:51],0
v_min3_u32 v22,v22,v53,v54
v_min3_u32 v22,v22,v55,v56
v_mfma_f32_16x16x32_bf16 v[160:163],v[96:99],v[48:51],0
v_min3_u32 v22,v22,v57,v58
v_min3_u32 v22,v22,v59,v60
v_mfma_f32_16x16x32_bf16 v[168:171],v[52:55],v[52:55],v[168:171]
v_min3_u32 v22,v22,v61,v62
v_min_u32 v22,v22,v63
v_mfma_f32_16x16x32_bf16 v[164:167],v[108:111],v[52:55],v[164:167]
v_cmp_eq_u32 vcc,0,v22
s_cbranch_vccnz nx_74
v_mfma_f32_16x16x32_bf16 v[160:163],v[104:107],v[52:55],v[160:163]
v_mov_b32 v172,v48
v_mfma_f32_16x16x32_bf16 v[168:171],v[56:59],v[56:59],v[168:171]
v_mov_b32 v173,v49
v_mfma_f32_16x16x32_bf16 v[164:167],v[116:119],v[56:59],v[164:167]
v_mov_b32 v174,v50
v_mfma_f32_16x16x32_bf16 v[160:163],v[112:115],v[56:59],v[160:163]
v_mov_b32 v175,v51
v_mfma_f32_16x16x32_bf16 v[168:171],v[60:63],v[60:63],v[168:171]
v_mfma_f32_16x16x32_bf16 v[164:167],v[124:127],v[60:63],v[164:167]
v_mfma_f32_16x16x32_bf16 v[160:163],v[120:123],v[60:63],v[160:163]
s_nop 1
s_branch scok_72
nx_74:
s_sub_u32 s90,s90,1
s_cmp_gt_i32 s90,0
s_cbranch_scc1 scp_71
s_nop 7
scok_72:
ds_read_b64 v[220:221],v21
ds_read_b64 v[136:137],v31
ds_read_b64 v[140:141],v31 offset:256
s_cmp_ge_u32 s79,62
s_cbranch_scc1 ke_76
keb_77:
v_max3_f32 v216,v168,v169,v170
v_mov_b32_dpp v160,v164 row_ror:8 row_mask:0xf bank_mask:0xc
v_mov_b32_dpp v161,v165 row_ror:8 row_mask:0xf bank_mask:0xc
v_mov_b32_dpp v162,v166 row_ror:8 row_mask:0xf bank_mask:0xc
v_mov_b32_dpp v163,v167 row_ror:8 row_mask:0xf bank_mask:0xc
v_max3_f32 v217,v171,v160,v161
v_max3_f32 v216,v216,v162,v163
v_max_f32 v216,v216,v217
s_nop 1
v_max_f32_dpp v216,v216,v216 row_ror:8 row_mask:0xf bank_mask:0xf
v_mov_b32 v217,v216
s_nop 1
v_permlane16_swap_b32 v217,v216
v_max_f32 v216,v216,v217
v_mov_b32 v217,v216
s_nop 1
v_permlane32_swap_b32 v217,v216
v_max_f32 v216,v216,v217
v_mul_f32 v216,s81,v216
v_fma_f32 v160,v160,s81,-v216
v_fma_f32 v161,v161,s81,-v216
v_fma_f32 v162,v162,s81,-v216
v_fma_f32 v163,v163,s81,-v216
v_fma_f32 v168,v168,s81,-v216
v_fma_f32 v169,v169,s81,-v216
v_fma_f32 v170,v170,s81,-v216
v_fma_f32 v171,v171,s81,-v216
v_exp_f32 v160,v160
v_exp_f32 v161,v161
v_exp_f32 v162,v162
v_exp_f32 v163,v163
v_exp_f32 v168,v168
v_exp_f32 v169,v169
v_exp_f32 v170,v170
v_exp_f32 v171,v171
v_cvt_pk_bf16_f32 v148,v160,v161
v_cvt_pk_bf16_f32 v149,v162,v163
v_cvt_pk_bf16_f32 v144,v168,v169
v_mov_b32_dpp v150,v148 row_ror:8 row_mask:0xf bank_mask:0xf
v_mov_b32_dpp v151,v149 row_ror:8 row_mask:0xf bank_mask:0xf
v_cvt_pk_bf16_f32 v145,v170,v171
s_waitcnt lgkmcnt(0)
v_min_u32 v220,v220,v221
v_mfma_f32_16x16x32_bf16 v[232:235],v[152:155],v[148:151],0
v_cmp_ne_u32 vcc,v220,v25
v_mfma_f32_16x16x32_bf16 v[232:235],v[152:155],v[144:147],v[232:235]
v_mfma_f32_16x16x32_bf16 v[224:227],v[128:131],v[148:151],0
v_mfma_f32_16x16x32_bf16 v[228:231],v[132:135],v[148:151],0
s_cbranch_vccnz vw_78
vb_79:
v_mfma_f32_16x16x32_bf16 v[224:227],v[136:139],v[144:147],v[224:227]
v_mfma_f32_16x16x32_bf16 v[228:231],v[140:143],v[144:147],v[228:231]
s_mov_b64 exec,s[84:85]
s_nop 1
v_rcp_f32 v236,v232
s_nop 2
v_pk_mul_f32 v[224:225],v[224:225],v[236:237] op_sel_hi:[1,0]
v_pk_mul_f32 v[226:227],v[226:227],v[236:237] op_sel_hi:[1,0]
v_pk_mul_f32 v[228:229],v[228:229],v[236:237] op_sel_hi:[1,0]
v_pk_mul_f32 v[230:231],v[230:231],v[236:237] op_sel_hi:[1,0]
v_cvt_pk_bf16_f32 v216,v224,v225
v_cvt_pk_bf16_f32 v217,v226,v227
v_cvt_pk_bf16_f32 v218,v228,v229
v_cvt_pk_bf16_f32 v219,v230,v231
v_max_u32 v216,1,v216
v_max_u32 v217,1,v217
v_max_u32 v218,1,v218
v_max_u32 v219,1,v219
buffer_store_dwordx4 v[216:219],v30,s[24:27],s71 offen
buffer_store_dwordx4 v[216:219],v30,s[28:31],s71 offen sc1
s_mov_b64 exec,1
buffer_store_dword v25,v13,s[24:27],s70 offen offset:512
buffer_store_dword v25,v13,s[28:31],s70 offen offset:512 sc1
s_mov_b64 exec,-1
ds_write_b32 v21,v25 offset:8
hl_80:
buffer_load_dword v248,v18,s[20:23],s70 offen offset:512 sc1
s_waitcnt vmcnt(0)
v_cmp_eq_u32 vcc,v25,v248
s_bcnt1_i32_b32 s64,vcc_lo
s_cmp_ge_u32 s64,16
s_cbranch_scc1 hg_81
s_sub_u32 s90,s90,1
s_cmp_gt_i32 s90,0
s_cbranch_scc1 hl_80
hg_81:
buffer_load_dwordx4 v[32:35],v26,s[20:23],s71 offen offset:0 sc1
buffer_load_dwordx4 v[36:39],v26,s[20:23],s71 offen offset:1024 sc1
buffer_load_dwordx4 v[40:43],v26,s[20:23],s71 offen offset:2048 sc1
buffer_load_dwordx4 v[44:47],v26,s[20:23],s71 offen offset:3072 sc1
buffer_load_dwordx4 v[48:51],v27,s[20:23],s71 offen offset:0 sc1
buffer_load_dwordx4 v[52:55],v27,s[20:23],s71 offen offset:1024 sc1
buffer_load_dwordx4 v[56:59],v27,s[20:23],s71 offen offset:2048 sc1
buffer_load_dwordx4 v[60:63],v27,s[20:23],s71 offen offset:3072 sc1
s_mov_b32 s68,0
s_waitcnt vmcnt(6)
v_smfmac_f32_16x16x64_bf16 v[184:187],v[32:35],a[128:135],v14
v_min3_u32 v22,v32,v33,v34
v_min3_u32 v22,v22,v35,v36
v_smfmac_f32_16x16x64_bf16 v[188:191],v[32:35],a[136:143],v14
v_min3_u32 v22,v22,v37,v38
v_smfmac_f32_16x16x64_bf16 v[184:187],v[36:39],a[144:151],v14
v_min_u32 v22,v22,v39
v_smfmac_f32_16x16x64_bf16 v[188:191],v[36:39],a[152:159],v14
v_cmp_eq_u32 s[52:53],0,v22
s_waitcnt vmcnt(4)
v_smfmac_f32_16x16x64_bf16 v[184:187],v[40:43],a[160:167],v14
v_min3_u32 v22,v40,v41,v42
s_cmp_lg_u64 s[52:53],0
v_smfmac_f32_16x16x64_bf16 v[188:191],v[40:43],a[168:175],v14
s_cbranch_scc1 ms_82
bk_83:
v_min3_u32 v22,v22,v43,v44
v_smfmac_f32_16x16x64_bf16 v[184:187],v[44:47],a[176:183],v14
v_min3_u32 v22,v22,v45,v46
v_min_u32 v22,v22,v47
v_smfmac_f32_16x16x64_bf16 v[188:191],v[44:47],a[184:191],v14
v_cmp_eq_u32 s[54:55],0,v22
s_waitcnt vmcnt(2)
v_smfmac_f32_16x16x64_bf16 v[184:187],v[48:51],a[192:199],v14
v_min3_u32 v22,v48,v49,v50
s_cmp_lg_u64 s[54:55],0
v_smfmac_f32_16x16x64_bf16 v[188:191],v[48:51],a[200:207],v14
s_cbranch_scc1 ms_84
bk_85:
v_min3_u32 v22,v22,v51,v52
v_smfmac_f32_16x16x64_bf16 v[184:187],v[52:55],a[208:215],v14
v_min3_u32 v22,v22,v53,v54
v_min_u32 v22,v22,v55
v_smfmac_f32_16x16x64_bf16 v[188:191],v[52:55],a[216:223],v14
v_cmp_eq_u32 s[52:53],0,v22
s_waitcnt vmcnt(0)
v_smfmac_f32_16x16x64_bf16 v[184:187],v[56:59],a[224:231],v14
v_min3_u32 v22,v56,v57,v58
s_cmp_lg_u64 s[52:53],0
v_smfmac_f32_16x16x64_bf16 v[188:191],v[56:59],a[232:239],v14
s_cbranch_scc1 ms_86
bk_87:
v_min3_u32 v22,v22,v59,v60
v_smfmac_f32_16x16x64_bf16 v[184:187],v[60:63],a[240:247],v14
v_min3_u32 v22,v22,v61,v62
v_min_u32 v22,v22,v63
v_smfmac_f32_16x16x64_bf16 v[188:191],v[60:63],a[248:255],v14
v_cmp_eq_u32 s[54:55],0,v22
s_cmp_lg_u64 s[54:55],0
s_cbranch_scc1 ms_90
bk_91:
s_cmp_lg_u32 s68,0
s_cbranch_scc1 rl2_92
fin_88:
s_nop 2
v_permlane32_swap_b32 v184,v188
v_permlane32_swap_b32 v185,v189
v_permlane32_swap_b32 v186,v190
v_permlane32_swap_b32 v187,v191
v_pk_add_f32 v[184:185],v[184:185],v[188:189]
v_pk_add_f32 v[186:187],v[186:187],v[190:191]
ds_write_b128 v24,v[184:187] offset:25600
ds_write_b32 v21,v25 offset:12
s_mov_b64 exec,s[84:85]
ds_read_b128 v[172:175],v12
s_mov_b64 exec,-1
ds_read_b64 v[220:221],v21 offset:24
buffer_load_dwordx4 v[96:99],v2,s[20:23],s72 offen offset:0 sc1
buffer_load_dwordx4 v[100:103],v2,s[20:23],s72 offen offset:1024 sc1
buffer_load_dwordx4 v[104:107],v5,s[20:23],s72 offen offset:0 sc1
buffer_load_dwordx4 v[108:111],v5,s[20:23],s72 offen offset:1024 sc1
buffer_load_dwordx4 v[112:115],v6,s[20:23],s72 offen offset:0 sc1
buffer_load_dwordx4 v[116:119],v6,s[20:23],s72 offen offset:1024 sc1
buffer_load_dwordx4 v[120:123],v7,s[20:23],s72 offen offset:0 sc1
buffer_load_dwordx4 v[124:127],v7,s[20:23],s72 offen offset:1024 sc1
s_waitcnt lgkmcnt(0)
v_min_u32 v220,v220,v221
v_cmp_ne_u32 vcc,v220,v25
s_cbranch_vccnz v2w_93
v2b_94:
buffer_store_dwordx4 v[172:175],v3,s[20:23],s77 offen sc1
s_xor_b32 s62,s62,0x10000
s_add_u32 s63,s79,1
s_and_b32 s64,s63,3
s_lshl_b32 s70,s64,20
s_add_u32 s65,s63,2
s_and_b32 s65,s65,3
s_lshl_b32 s73,s65,20
s_add_u32 s55,s63,3
s_lshl_b32 s78,s55,16
s_add_u32 s78,s78,57344
s_cmp_lt_u32 s55,64
s_cselect_b32 s78,s78,0x7fff0000
s_add_u32 s71,s70,65536
s_add_u32 s60,s63,1
s_and_b32 s60,s60,3
s_lshl_b32 s72,s60,20
v_mov_b32 v184,0
v_mov_b32 v185,0
v_mov_b32 v186,0
v_mov_b32 v187,0
v_mov_b32 v188,0
v_mov_b32 v189,0
v_mov_b32 v190,0
v_mov_b32 v191,0
s_lshl_b32 s77,s63,21
s_lshl_b32 s55,s63,13
s_and_b32 s55,s55,0x2000
s_xor_b32 s55,s55,s61
s_add_u32 s77,s77,s55
v_mov_b32 v176,0
v_mov_b32 v177,0
v_mov_b32 v178,0
v_mov_b32 v179,0
s_add_u32 s79,s79,1
v_add_u32 v25,1,v25
s_waitcnt vmcnt(0) lgkmcnt(0)
s_branch loop_63
last0_75:
wf_95:
ds_read_b32 v23,v21 offset:0
s_sub_u32 s90,s90,1
s_waitcnt lgkmcnt(0)
v_cmp_ne_u32 vcc,v23,v25
s_cmp_lt_i32 s90,0
s_cselect_b64 vcc,0,vcc
s_cbranch_vccnz wf_95
wf_96:
ds_read_b32 v23,v21 offset:4
s_sub_u32 s90,s90,1
s_waitcnt lgkmcnt(0)
v_cmp_ne_u32 vcc,v23,v25
s_cmp_lt_i32 s90,0
s_cselect_b64 vcc,0,vcc
s_cbranch_vccnz wf_96
s_mov_b64 exec,s[84:85]
ds_read_b128 v[172:175],v12
s_mov_b64 exec,-1
s_waitcnt lgkmcnt(0)
buffer_store_dwordx4 v[172:175],v3,s[20:23],s77 offen sc1
s_branch end_57
art_67:
s_sub_u32 s90,s90,1
s_cmp_lt_i32 s90,0
s_cbranch_scc1 abk_68
buffer_load_dwordx4 v[32:35],v26,s[20:23],s70 offen offset:0 sc1
buffer_load_dwordx4 v[36:39],v26,s[20:23],s70 offen offset:1024 sc1
buffer_load_dwordx4 v[40:43],v26,s[20:23],s70 offen offset:2048 sc1
buffer_load_dwordx4 v[44:47],v26,s[20:23],s70 offen offset:3072 sc1
s_waitcnt vmcnt(3)
ds_write_b128 v24,v[32:35] offset:0
v_min3_u32 v22,v32,v33,v34
v_min_u32 v22,v22,v35
s_waitcnt vmcnt(2)
ds_write_b128 v24,v[36:39] offset:1024
v_min3_u32 v22,v22,v36,v37
v_min3_u32 v22,v22,v38,v39
s_waitcnt vmcnt(1)
ds_write_b128 v24,v[40:43] offset:2048
v_min3_u32 v22,v22,v40,v41
v_min3_u32 v22,v22,v42,v43
s_waitcnt vmcnt(0)
ds_write_b128 v24,v[44:47] offset:3072
v_min3_u32 v22,v22,v44,v45
v_min3_u32 v22,v22,v46,v47
v_cmp_eq_u32 vcc,0,v22
s_cbranch_vccnz art_67
s_branch abk_68
kt0_69:
buffer_load_dwordx4 v[96:99],v2,s[20:23],s70 offen offset:0 sc1
buffer_load_dwordx4 v[100:103],v2,s[20:23],s70 offen offset:1024 sc1
buffer_load_dwordx4 v[104:107],v5,s[20:23],s70 offen offset:0 sc1
buffer_load_dwordx4 v[108:111],v5,s[20:23],s70 offen offset:1024 sc1
buffer_load_dwordx4 v[112:115],v6,s[20:23],s70 offen offset:0 sc1
buffer_load_dwordx4 v[116:119],v6,s[20:23],s70 offen offset:1024 sc1
buffer_load_dwordx4 v[120:123],v7,s[20:23],s70 offen offset:0 sc1
buffer_load_dwordx4 v[124:127],v7,s[20:23],s70 offen offset:1024 sc1
s_branch kt0b_70
ke_76:
s_cmp_eq_u32 s79,63
s_cbranch_scc1 last0_75
ds_read_b64 v[222:223],v21 offset:24
s_mov_b64 exec,s[84:85]
ds_read_b128 v[172:175],v12
s_mov_b64 exec,-1
s_waitcnt lgkmcnt(0)
v_min3_u32 v222,v222,v223,v220
v_min_u32 v222,v222,v221
v_cmp_ne_u32 vcc,v222,v25
s_cbranch_vccnz keb_77
buffer_store_dwordx4 v[172:175],v3,s[20:23],s77 offen sc1
s_mov_b32 s77,0x7fff0000
s_branch keb_77
vw_78:
wf_97:
ds_read_b32 v23,v21 offset:0
s_sub_u32 s90,s90,1
s_waitcnt lgkmcnt(0)
v_cmp_ne_u32 vcc,v23,v25
s_cmp_lt_i32 s90,0
s_cselect_b64 vcc,0,vcc
s_cbranch_vccnz wf_97
wf_98:
ds_read_b32 v23,v21 offset:4
s_sub_u32 s90,s90,1
s_waitcnt lgkmcnt(0)
v_cmp_ne_u32 vcc,v23,v25
s_cmp_lt_i32 s90,0
s_cselect_b64 vcc,0,vcc
s_cbranch_vccnz wf_98
ds_read_b64 v[220:221],v21
ds_read_b64 v[136:137],v31
ds_read_b64 v[140:141],v31 offset:256
s_waitcnt lgkmcnt(0)
s_branch vb_79
ms_82:
s_waitcnt vmcnt(0)
buffer_load_dwordx4 v[64:67],v26,s[20:23],s71 offen offset:0 sc1
buffer_load_dwordx4 v[68:71],v26,s[20:23],s71 offen offset:1024 sc1
s_bitset1_b32 s68,0
s_branch bk_83
ms_84:
s_waitcnt vmcnt(0)
buffer_load_dwordx4 v[72:75],v26,s[20:23],s71 offen offset:2048 sc1
buffer_load_dwordx4 v[76:79],v26,s[20:23],s71 offen offset:3072 sc1
s_bitset1_b32 s68,1
s_branch bk_85
ms_86:
s_waitcnt vmcnt(0)
buffer_load_dwordx4 v[80:83],v27,s[20:23],s71 offen offset:0 sc1
buffer_load_dwordx4 v[84:87],v27,s[20:23],s71 offen offset:1024 sc1
s_bitset1_b32 s68,2
s_branch bk_87
ms_90:
s_waitcnt vmcnt(0)
buffer_load_dwordx4 v[88:91],v27,s[20:23],s71 offen offset:2048 sc1
buffer_load_dwordx4 v[92:95],v27,s[20:23],s71 offen offset:3072 sc1
s_bitset1_b32 s68,3
s_branch bk_91
rl_89:
s_bitcmp1_b32 s68,0
s_cbranch_scc0 sk_99
buffer_load_dwordx4 v[64:67],v26,s[20:23],s71 offen offset:0 sc1
buffer_load_dwordx4 v[68:71],v26,s[20:23],s71 offen offset:1024 sc1
sk_99:
s_bitcmp1_b32 s68,1
s_cbranch_scc0 sk_100
buffer_load_dwordx4 v[72:75],v26,s[20:23],s71 offen offset:2048 sc1
buffer_load_dwordx4 v[76:79],v26,s[20:23],s71 offen offset:3072 sc1
sk_100:
s_bitcmp1_b32 s68,2
s_cbranch_scc0 sk_101
buffer_load_dwordx4 v[80:83],v27,s[20:23],s71 offen offset:0 sc1
buffer_load_dwordx4 v[84:87],v27,s[20:23],s71 offen offset:1024 sc1
sk_101:
s_bitcmp1_b32 s68,3
s_cbranch_scc0 sk_102
buffer_load_dwordx4 v[88:91],v27,s[20:23],s71 offen offset:2048 sc1
buffer_load_dwordx4 v[92:95],v27,s[20:23],s71 offen offset:3072 sc1
sk_102:
rl2_92:
s_sub_u32 s90,s90,1
s_cmp_lt_i32 s90,0
s_cbranch_scc1 fin_88
s_waitcnt vmcnt(0)
s_bitcmp1_b32 s68,0
s_cbranch_scc0 sk_103
v_min3_u32 v22,v64,v65,v66
v_min3_u32 v22,v22,v67,v68
v_min3_u32 v22,v22,v69,v70
v_min_u32 v22,v22,v71
v_cmp_eq_u32 vcc,0,v22
v_xor_b32 v64,v32,v64
v_xor_b32 v65,v33,v65
v_xor_b32 v66,v34,v66
v_xor_b32 v67,v35,v67
v_xor_b32 v68,v36,v68
v_xor_b32 v69,v37,v69
v_xor_b32 v70,v38,v70
v_xor_b32 v71,v39,v71
s_cbranch_vccnz nb_104
s_bitset0_b32 s68,0
v_smfmac_f32_16x16x64_bf16 v[184:187],v[64:67],a[128:135],v14
v_smfmac_f32_16x16x64_bf16 v[188:191],v[64:67],a[136:143],v14
v_smfmac_f32_16x16x64_bf16 v[184:187],v[68:71],a[144:151],v14
v_smfmac_f32_16x16x64_bf16 v[188:191],v[68:71],a[152:159],v14
nb_104:
sk_103:
s_bitcmp1_b32 s68,1
s_cbranch_scc0 sk_105
v_min3_u32 v22,v72,v73,v74
v_min3_u32 v22,v22,v75,v76
v_min3_u32 v22,v22,v77,v78
v_min_u32 v22,v22,v79
v_cmp_eq_u32 vcc,0,v22
v_xor_b32 v72,v40,v72
v_xor_b32 v73,v41,v73
v_xor_b32 v74,v42,v74
v_xor_b32 v75,v43,v75
v_xor_b32 v76,v44,v76
v_xor_b32 v77,v45,v77
v_xor_b32 v78,v46,v78
v_xor_b32 v79,v47,v79
s_cbranch_vccnz nb_106
s_bitset0_b32 s68,1
v_smfmac_f32_16x16x64_bf16 v[184:187],v[72:75],a[160:167],v14
v_smfmac_f32_16x16x64_bf16 v[188:191],v[72:75],a[168:175],v14
v_smfmac_f32_16x16x64_bf16 v[184:187],v[76:79],a[176:183],v14
v_smfmac_f32_16x16x64_bf16 v[188:191],v[76:79],a[184:191],v14
nb_106:
sk_105:
s_bitcmp1_b32 s68,2
s_cbranch_scc0 sk_107
v_min3_u32 v22,v80,v81,v82
v_min3_u32 v22,v22,v83,v84
v_min3_u32 v22,v22,v85,v86
v_min_u32 v22,v22,v87
v_cmp_eq_u32 vcc,0,v22
v_xor_b32 v80,v48,v80
v_xor_b32 v81,v49,v81
v_xor_b32 v82,v50,v82
v_xor_b32 v83,v51,v83
v_xor_b32 v84,v52,v84
v_xor_b32 v85,v53,v85
v_xor_b32 v86,v54,v86
v_xor_b32 v87,v55,v87
s_cbranch_vccnz nb_108
s_bitset0_b32 s68,2
v_smfmac_f32_16x16x64_bf16 v[184:187],v[80:83],a[192:199],v14
v_smfmac_f32_16x16x64_bf16 v[188:191],v[80:83],a[200:207],v14
v_smfmac_f32_16x16x64_bf16 v[184:187],v[84:87],a[208:215],v14
v_smfmac_f32_16x16x64_bf16 v[188:191],v[84:87],a[216:223],v14
nb_108:
sk_107:
s_bitcmp1_b32 s68,3
s_cbranch_scc0 sk_109
v_min3_u32 v22,v88,v89,v90
v_min3_u32 v22,v22,v91,v92
v_min3_u32 v22,v22,v93,v94
v_min_u32 v22,v22,v95
v_cmp_eq_u32 vcc,0,v22
v_xor_b32 v88,v56,v88
v_xor_b32 v89,v57,v89
v_xor_b32 v90,v58,v90
v_xor_b32 v91,v59,v91
v_xor_b32 v92,v60,v92
v_xor_b32 v93,v61,v93
v_xor_b32 v94,v62,v94
v_xor_b32 v95,v63,v95
s_cbranch_vccnz nb_110
s_bitset0_b32 s68,3
v_smfmac_f32_16x16x64_bf16 v[184:187],v[88:91],a[224:231],v14
v_smfmac_f32_16x16x64_bf16 v[188:191],v[88:91],a[232:239],v14
v_smfmac_f32_16x16x64_bf16 v[184:187],v[92:95],a[240:247],v14
v_smfmac_f32_16x16x64_bf16 v[188:191],v[92:95],a[248:255],v14
nb_110:
sk_109:
s_cmp_lg_u32 s68,0
s_cbranch_scc1 rl_89
s_nop 2
s_branch fin_88
v2w_93:
wf_111:
ds_read_b32 v23,v21 offset:24
s_sub_u32 s90,s90,1
s_waitcnt lgkmcnt(0)
v_cmp_ne_u32 vcc,v23,v25
s_cmp_lt_i32 s90,0
s_cselect_b64 vcc,0,vcc
s_cbranch_vccnz wf_111
wf_112:
ds_read_b32 v23,v21 offset:28
s_sub_u32 s90,s90,1
s_waitcnt lgkmcnt(0)
v_cmp_ne_u32 vcc,v23,v25
s_cmp_lt_i32 s90,0
s_cselect_b64 vcc,0,vcc
s_cbranch_vccnz wf_112
s_branch v2b_94
first_62:
s_waitcnt vmcnt(0) lgkmcnt(0)
s_barrier
s_add_u32 s64,s15,393216
buffer_load_dwordx4 a[176:179],v32,s[40:43],s64 offen nt
s_add_u32 s64,s15,425984
buffer_load_dwordx4 a[180:183],v32,s[40:43],s64 offen nt
s_add_u32 s64,s15,458752
buffer_load_dwordx4 a[184:187],v32,s[40:43],s64 offen nt
s_add_u32 s64,s15,491520
buffer_load_dwordx4 a[188:191],v32,s[40:43],s64 offen nt
s_add_u32 s64,s15,524288
buffer_load_dwordx4 a[192:195],v32,s[40:43],s64 offen nt
s_add_u32 s64,s15,557056
buffer_load_dwordx4 a[196:199],v32,s[40:43],s64 offen nt
s_add_u32 s64,s15,589824
buffer_load_dwordx4 a[200:203],v32,s[40:43],s64 offen nt
s_add_u32 s64,s15,622592
buffer_load_dwordx4 a[204:207],v32,s[40:43],s64 offen nt
s_add_u32 s64,s15,655360
buffer_load_dwordx4 a[208:211],v32,s[40:43],s64 offen nt
s_add_u32 s64,s15,688128
buffer_load_dwordx4 a[212:215],v32,s[40:43],s64 offen nt
s_add_u32 s64,s15,720896
buffer_load_dwordx4 a[216:219],v32,s[40:43],s64 offen nt
s_add_u32 s64,s15,753664
buffer_load_dwordx4 a[220:223],v32,s[40:43],s64 offen nt
s_add_u32 s64,s15,786432
buffer_load_dwordx4 a[224:227],v32,s[40:43],s64 offen nt
s_add_u32 s64,s15,819200
buffer_load_dwordx4 a[228:231],v32,s[40:43],s64 offen nt
s_add_u32 s64,s15,851968
buffer_load_dwordx4 a[232:235],v32,s[40:43],s64 offen nt
s_add_u32 s64,s15,884736
buffer_load_dwordx4 a[236:239],v32,s[40:43],s64 offen nt
s_add_u32 s64,s15,917504
buffer_load_dwordx4 a[240:243],v32,s[40:43],s64 offen nt
s_add_u32 s64,s15,950272
buffer_load_dwordx4 a[244:247],v32,s[40:43],s64 offen nt
s_add_u32 s64,s15,983040
buffer_load_dwordx4 a[248:251],v32,s[40:43],s64 offen nt
s_add_u32 s64,s15,1015808
buffer_load_dwordx4 a[252:255],v32,s[40:43],s64 offen nt
ds_write_b128 v33,a[0:3] offset:0
ds_write_b128 v33,a[4:7] offset:1024
ds_write_b128 v33,a[8:11] offset:2048
ds_write_b128 v33,a[12:15] offset:3072
s_waitcnt lgkmcnt(0)
v_mov_b32 v38,1
ds_write_b32 v37,v38 offset:0
qs_113:
ds_read_b32 v39,v37 offset:4
s_sub_u32 s90,s90,1
s_waitcnt lgkmcnt(0)
v_cmp_gt_u32 vcc,v38,v39
s_cmp_lt_i32 s90,0
s_cselect_b64 vcc,0,vcc
s_cbranch_vccnz qs_113
ds_read_b64_tr_b16 a[0:1],v36 offset:0
ds_read_b64_tr_b16 a[2:3],v36 offset:128
ds_read_b64_tr_b16 a[4:5],v36 offset:2048
ds_read_b64_tr_b16 a[6:7],v36 offset:2176
ds_read_b64_tr_b16 a[8:9],v36 offset:8192
ds_read_b64_tr_b16 a[10:11],v36 offset:8320
ds_read_b64_tr_b16 a[12:13],v36 offset:10240
ds_read_b64_tr_b16 a[14:15],v36 offset:10368
ds_write_b128 v33,a[16:19] offset:4096
ds_write_b128 v33,a[20:23] offset:5120
ds_write_b128 v33,a[24:27] offset:6144
ds_write_b128 v33,a[28:31] offset:7168
s_waitcnt lgkmcnt(0)
v_mov_b32 v38,2
ds_write_b32 v37,v38 offset:0
qs_114:
ds_read_b32 v39,v37 offset:4
s_sub_u32 s90,s90,1
s_waitcnt lgkmcnt(0)
v_cmp_gt_u32 vcc,v38,v39
s_cmp_lt_i32 s90,0
s_cselect_b64 vcc,0,vcc
s_cbranch_vccnz qs_114
ds_read_b64_tr_b16 a[16:17],v36 offset:4096
ds_read_b64_tr_b16 a[18:19],v36 offset:4224
ds_read_b64_tr_b16 a[20:21],v36 offset:6144
ds_read_b64_tr_b16 a[22:23],v36 offset:6272
ds_read_b64_tr_b16 a[24:25],v36 offset:12288
ds_read_b64_tr_b16 a[26:27],v36 offset:12416
ds_read_b64_tr_b16 a[28:29],v36 offset:14336
ds_read_b64_tr_b16 a[30:31],v36 offset:14464
ds_write_b128 v33,a[32:35] offset:0
ds_write_b128 v33,a[36:39] offset:1024
ds_write_b128 v33,a[40:43] offset:2048
ds_write_b128 v33,a[44:47] offset:3072
s_waitcnt lgkmcnt(0)
v_mov_b32 v38,3
ds_write_b32 v37,v38 offset:0
qs_115:
ds_read_b32 v39,v37 offset:4
s_sub_u32 s90,s90,1
s_waitcnt lgkmcnt(0)
v_cmp_gt_u32 vcc,v38,v39
s_cmp_lt_i32 s90,0
s_cselect_b64 vcc,0,vcc
s_cbranch_vccnz qs_115
ds_read_b64_tr_b16 a[32:33],v36 offset:0
ds_read_b64_tr_b16 a[34:35],v36 offset:128
ds_read_b64_tr_b16 a[36:37],v36 offset:2048
ds_read_b64_tr_b16 a[38:39],v36 offset:2176
ds_read_b64_tr_b16 a[40:41],v36 offset:8192
ds_read_b64_tr_b16 a[42:43],v36 offset:8320
ds_read_b64_tr_b16 a[44:45],v36 offset:10240
ds_read_b64_tr_b16 a[46:47],v36 offset:10368
ds_write_b128 v33,a[48:51] offset:4096
ds_write_b128 v33,a[52:55] offset:5120
ds_write_b128 v33,a[56:59] offset:6144
ds_write_b128 v33,a[60:63] offset:7168
s_waitcnt lgkmcnt(0)
v_mov_b32 v38,4
ds_write_b32 v37,v38 offset:0
qs_116:
ds_read_b32 v39,v37 offset:4
s_sub_u32 s90,s90,1
s_waitcnt lgkmcnt(0)
v_cmp_gt_u32 vcc,v38,v39
s_cmp_lt_i32 s90,0
s_cselect_b64 vcc,0,vcc
s_cbranch_vccnz qs_116
ds_read_b64_tr_b16 a[48:49],v36 offset:4096
ds_read_b64_tr_b16 a[50:51],v36 offset:4224
ds_read_b64_tr_b16 a[52:53],v36 offset:6144
ds_read_b64_tr_b16 a[54:55],v36 offset:6272
ds_read_b64_tr_b16 a[56:57],v36 offset:12288
ds_read_b64_tr_b16 a[58:59],v36 offset:12416
ds_read_b64_tr_b16 a[60:61],v36 offset:14336
ds_read_b64_tr_b16 a[62:63],v36 offset:14464
ds_write_b128 v33,a[64:67] offset:0
ds_write_b128 v33,a[68:71] offset:1024
ds_write_b128 v33,a[72:75] offset:2048
ds_write_b128 v33,a[76:79] offset:3072
s_waitcnt lgkmcnt(0)
v_mov_b32 v38,5
ds_write_b32 v37,v38 offset:0
qs_117:
ds_read_b32 v39,v37 offset:4
s_sub_u32 s90,s90,1
s_waitcnt lgkmcnt(0)
v_cmp_gt_u32 vcc,v38,v39
s_cmp_lt_i32 s90,0
s_cselect_b64 vcc,0,vcc
s_cbranch_vccnz qs_117
ds_read_b64_tr_b16 a[64:65],v36 offset:0
ds_read_b64_tr_b16 a[66:67],v36 offset:128
ds_read_b64_tr_b16 a[68:69],v36 offset:2048
ds_read_b64_tr_b16 a[70:71],v36 offset:2176
ds_read_b64_tr_b16 a[72:73],v36 offset:8192
ds_read_b64_tr_b16 a[74:75],v36 offset:8320
ds_read_b64_tr_b16 a[76:77],v36 offset:10240
ds_read_b64_tr_b16 a[78:79],v36 offset:10368
ds_write_b128 v33,a[80:83] offset:4096
ds_write_b128 v33,a[84:87] offset:5120
ds_write_b128 v33,a[88:91] offset:6144
ds_write_b128 v33,a[92:95] offset:7168
s_waitcnt lgkmcnt(0)
v_mov_b32 v38,6
ds_write_b32 v37,v38 offset:0
qs_118:
ds_read_b32 v39,v37 offset:4
s_sub_u32 s90,s90,1
s_waitcnt lgkmcnt(0)
v_cmp_gt_u32 vcc,v38,v39
s_cmp_lt_i32 s90,0
s_cselect_b64 vcc,0,vcc
s_cbranch_vccnz qs_118
ds_read_b64_tr_b16 a[80:81],v36 offset:4096
ds_read_b64_tr_b16 a[82:83],v36 offset:4224
ds_read_b64_tr_b16 a[84:85],v36 offset:6144
ds_read_b64_tr_b16 a[86:87],v36 offset:6272
ds_read_b64_tr_b16 a[88:89],v36 offset:12288
ds_read_b64_tr_b16 a[90:91],v36 offset:12416
ds_read_b64_tr_b16 a[92:93],v36 offset:14336
ds_read_b64_tr_b16 a[94:95],v36 offset:14464
ds_write_b128 v33,a[96:99] offset:0
ds_write_b128 v33,a[100:103] offset:1024
ds_write_b128 v33,a[104:107] offset:2048
ds_write_b128 v33,a[108:111] offset:3072
s_waitcnt lgkmcnt(0)
v_mov_b32 v38,7
ds_write_b32 v37,v38 offset:0
qs_119:
ds_read_b32 v39,v37 offset:4
s_sub_u32 s90,s90,1
s_waitcnt lgkmcnt(0)
v_cmp_gt_u32 vcc,v38,v39
s_cmp_lt_i32 s90,0
s_cselect_b64 vcc,0,vcc
s_cbranch_vccnz qs_119
ds_read_b64_tr_b16 a[96:97],v36 offset:0
ds_read_b64_tr_b16 a[98:99],v36 offset:128
ds_read_b64_tr_b16 a[100:101],v36 offset:2048
ds_read_b64_tr_b16 a[102:103],v36 offset:2176
ds_read_b64_tr_b16 a[104:105],v36 offset:8192
ds_read_b64_tr_b16 a[106:107],v36 offset:8320
ds_read_b64_tr_b16 a[108:109],v36 offset:10240
ds_read_b64_tr_b16 a[110:111],v36 offset:10368
ds_write_b128 v33,a[112:115] offset:4096
ds_write_b128 v33,a[116:119] offset:5120
ds_write_b128 v33,a[120:123] offset:6144
ds_write_b128 v33,a[124:127] offset:7168
s_waitcnt lgkmcnt(0)
v_mov_b32 v38,8
ds_write_b32 v37,v38 offset:0
qs_120:
ds_read_b32 v39,v37 offset:4
s_sub_u32 s90,s90,1
s_waitcnt lgkmcnt(0)
v_cmp_gt_u32 vcc,v38,v39
s_cmp_lt_i32 s90,0
s_cselect_b64 vcc,0,vcc
s_cbranch_vccnz qs_120
ds_read_b64_tr_b16 a[112:113],v36 offset:4096
ds_read_b64_tr_b16 a[114:115],v36 offset:4224
ds_read_b64_tr_b16 a[116:117],v36 offset:6144
ds_read_b64_tr_b16 a[118:119],v36 offset:6272
ds_read_b64_tr_b16 a[120:121],v36 offset:12288
ds_read_b64_tr_b16 a[122:123],v36 offset:12416
ds_read_b64_tr_b16 a[124:125],v36 offset:14336
ds_read_b64_tr_b16 a[126:127],v36 offset:14464
s_waitcnt lgkmcnt(0)
v_mov_b32 v38,9
ds_write_b32 v37,v38 offset:0
qs_121:
ds_read_b32 v39,v37 offset:4
s_sub_u32 s90,s90,1
s_waitcnt lgkmcnt(0)
v_cmp_gt_u32 vcc,v38,v39
s_cmp_lt_i32 s90,0
s_cselect_b64 vcc,0,vcc
s_cbranch_vccnz qs_121
ds_write_b128 v33,a[128:131] offset:0
ds_write_b128 v33,a[132:135] offset:1024
ds_write_b128 v33,a[136:139] offset:2048
ds_write_b128 v33,a[140:143] offset:3072
s_waitcnt lgkmcnt(0)
ds_read_b64_tr_b16 a[128:129],v34 offset:0
ds_read_b64_tr_b16 a[130:131],v34 offset:128
ds_read_b64_tr_b16 a[132:133],v34 offset:2048
ds_read_b64_tr_b16 a[134:135],v34 offset:2176
ds_read_b64_tr_b16 a[136:137],v34 offset:32
ds_read_b64_tr_b16 a[138:139],v34 offset:160
ds_read_b64_tr_b16 a[140:141],v34 offset:2080
ds_read_b64_tr_b16 a[142:143],v34 offset:2208
ds_write_b128 v33,a[144:147] offset:4096
ds_write_b128 v33,a[148:151] offset:5120
ds_write_b128 v33,a[152:155] offset:6144
ds_write_b128 v33,a[156:159] offset:7168
s_waitcnt lgkmcnt(0)
ds_read_b64_tr_b16 a[144:145],v34 offset:4096
ds_read_b64_tr_b16 a[146:147],v34 offset:4224
ds_read_b64_tr_b16 a[148:149],v34 offset:6144
ds_read_b64_tr_b16 a[150:151],v34 offset:6272
ds_read_b64_tr_b16 a[152:153],v34 offset:4128
ds_read_b64_tr_b16 a[154:155],v34 offset:4256
ds_read_b64_tr_b16 a[156:157],v34 offset:6176
ds_read_b64_tr_b16 a[158:159],v34 offset:6304
ds_write_b128 v33,a[160:163] offset:0
ds_write_b128 v33,a[164:167] offset:1024
ds_write_b128 v33,a[168:171] offset:2048
ds_write_b128 v33,a[172:175] offset:3072
s_waitcnt lgkmcnt(0)
ds_read_b64_tr_b16 a[160:161],v34 offset:0
ds_read_b64_tr_b16 a[162:163],v34 offset:128
ds_read_b64_tr_b16 a[164:165],v34 offset:2048
ds_read_b64_tr_b16 a[166:167],v34 offset:2176
ds_read_b64_tr_b16 a[168:169],v34 offset:32
ds_read_b64_tr_b16 a[170:171],v34 offset:160
ds_read_b64_tr_b16 a[172:173],v34 offset:2080
ds_read_b64_tr_b16 a[174:175],v34 offset:2208
free_122:
ds_read_b64 v[38:39],v37 offset:8
s_sub_u32 s90,s90,1
s_waitcnt lgkmcnt(0)
v_and_b32 v38,v38,v39
v_cmp_eq_u32 vcc,0,v38
s_cmp_lt_i32 s90,0
s_cselect_b64 vcc,0,vcc
s_cbranch_vccnz free_122
s_xor_b32 s64,s61,4194304
buffer_store_dwordx4 v[100:103],v206,s[20:23],s64 offen sc1
buffer_store_dwordx4 v[100:103],v207,s[20:23],s64 offen sc1
s_xor_b32 s64,s61,6299648
buffer_store_dwordx4 v[100:103],v206,s[20:23],s64 offen sc1
buffer_store_dwordx4 v[100:103],v207,s[20:23],s64 offen sc1
s_xor_b32 s64,s61,8388608
buffer_store_dwordx4 v[100:103],v206,s[20:23],s64 offen sc1
buffer_store_dwordx4 v[100:103],v207,s[20:23],s64 offen sc1
s_mov_b32 m0,0
s_mov_b32 s65,188416
buffer_load_dwordx4 v16,s[20:23],s65 offen offset:0 lds
buffer_load_dwordx4 v16,s[20:23],s65 offen offset:1024 lds
buffer_load_dwordx4 v16,s[20:23],s65 offen offset:2048 lds
buffer_load_dwordx4 v16,s[20:23],s65 offen offset:3072 lds
s_mov_b32 m0,4096
s_mov_b32 s65,192512
buffer_load_dwordx4 v16,s[20:23],s65 offen offset:0 lds
buffer_load_dwordx4 v16,s[20:23],s65 offen offset:1024 lds
buffer_load_dwordx4 v16,s[20:23],s65 offen offset:2048 lds
buffer_load_dwordx4 v16,s[20:23],s65 offen offset:3072 lds
s_mov_b32 m0,8192
s_mov_b32 s65,196608
buffer_load_dwordx4 v16,s[20:23],s65 offen offset:0 lds
buffer_load_dwordx4 v16,s[20:23],s65 offen offset:1024 lds
buffer_load_dwordx4 v16,s[20:23],s65 offen offset:2048 lds
buffer_load_dwordx4 v16,s[20:23],s65 offen offset:3072 lds
s_mov_b32 m0,12288
s_mov_b32 s65,200704
buffer_load_dwordx4 v16,s[20:23],s65 offen offset:0 lds
buffer_load_dwordx4 v16,s[20:23],s65 offen offset:1024 lds
buffer_load_dwordx4 v16,s[20:23],s65 offen offset:2048 lds
buffer_load_dwordx4 v16,s[20:23],s65 offen offset:3072 lds
s_mov_b32 m0,16384
s_mov_b32 s65,204800
buffer_load_dwordx4 v16,s[20:23],s65 offen offset:0 lds
buffer_load_dwordx4 v16,s[20:23],s65 offen offset:1024 lds
buffer_load_dwordx4 v16,s[20:23],s65 offen offset:2048 lds
buffer_load_dwordx4 v16,s[20:23],s65 offen offset:3072 lds
s_mov_b32 m0,20480
s_mov_b32 s65,208896
buffer_load_dwordx4 v16,s[20:23],s65 offen offset:0 lds
buffer_load_dwordx4 v16,s[20:23],s65 offen offset:1024 lds
buffer_load_dwordx4 v16,s[20:23],s65 offen offset:2048 lds
buffer_load_dwordx4 v16,s[20:23],s65 offen offset:3072 lds
s_mov_b32 m0,24576
s_mov_b32 s65,212992
buffer_load_dwordx4 v16,s[20:23],s65 offen offset:0 lds
buffer_load_dwordx4 v16,s[20:23],s65 offen offset:1024 lds
buffer_load_dwordx4 v16,s[20:23],s65 offen offset:2048 lds
buffer_load_dwordx4 v16,s[20:23],s65 offen offset:3072 lds
s_mov_b32 m0,28672
s_mov_b32 s65,217088
buffer_load_dwordx4 v16,s[20:23],s65 offen offset:0 lds
buffer_load_dwordx4 v16,s[20:23],s65 offen offset:1024 lds
buffer_load_dwordx4 v16,s[20:23],s65 offen offset:2048 lds
buffer_load_dwordx4 v16,s[20:23],s65 offen offset:3072 lds
s_waitcnt vmcnt(54)
ds_write_b128 v33,a[176:179] offset:4096
ds_write_b128 v33,a[180:183] offset:5120
ds_write_b128 v33,a[184:187] offset:6144
ds_write_b128 v33,a[188:191] offset:7168
s_waitcnt lgkmcnt(0)
ds_read_b64_tr_b16 a[176:177],v34 offset:4096
ds_read_b64_tr_b16 a[178:179],v34 offset:4224
ds_read_b64_tr_b16 a[180:181],v34 offset:6144
ds_read_b64_tr_b16 a[182:183],v34 offset:6272
ds_read_b64_tr_b16 a[184:185],v34 offset:4128
ds_read_b64_tr_b16 a[186:187],v34 offset:4256
ds_read_b64_tr_b16 a[188:189],v34 offset:6176
ds_read_b64_tr_b16 a[190:191],v34 offset:6304
s_waitcnt vmcnt(50)
ds_write_b128 v33,a[192:195] offset:0
ds_write_b128 v33,a[196:199] offset:1024
ds_write_b128 v33,a[200:203] offset:2048
ds_write_b128 v33,a[204:207] offset:3072
s_waitcnt lgkmcnt(0)
ds_read_b64_tr_b16 a[192:193],v34 offset:0
ds_read_b64_tr_b16 a[194:195],v34 offset:128
ds_read_b64_tr_b16 a[196:197],v34 offset:2048
ds_read_b64_tr_b16 a[198:199],v34 offset:2176
ds_read_b64_tr_b16 a[200:201],v34 offset:32
ds_read_b64_tr_b16 a[202:203],v34 offset:160
ds_read_b64_tr_b16 a[204:205],v34 offset:2080
ds_read_b64_tr_b16 a[206:207],v34 offset:2208
s_waitcnt vmcnt(46)
ds_write_b128 v33,a[208:211] offset:4096
ds_write_b128 v33,a[212:215] offset:5120
ds_write_b128 v33,a[216:219] offset:6144
ds_write_b128 v33,a[220:223] offset:7168
s_waitcnt lgkmcnt(0)
ds_read_b64_tr_b16 a[208:209],v34 offset:4096
ds_read_b64_tr_b16 a[210:211],v34 offset:4224
ds_read_b64_tr_b16 a[212:213],v34 offset:6144
ds_read_b64_tr_b16 a[214:215],v34 offset:6272
ds_read_b64_tr_b16 a[216:217],v34 offset:4128
ds_read_b64_tr_b16 a[218:219],v34 offset:4256
ds_read_b64_tr_b16 a[220:221],v34 offset:6176
ds_read_b64_tr_b16 a[222:223],v34 offset:6304
s_waitcnt vmcnt(42)
ds_write_b128 v33,a[224:227] offset:0
ds_write_b128 v33,a[228:231] offset:1024
ds_write_b128 v33,a[232:235] offset:2048
ds_write_b128 v33,a[236:239] offset:3072
s_waitcnt lgkmcnt(0)
ds_read_b64_tr_b16 a[224:225],v34 offset:0
ds_read_b64_tr_b16 a[226:227],v34 offset:128
ds_read_b64_tr_b16 a[228:229],v34 offset:2048
ds_read_b64_tr_b16 a[230:231],v34 offset:2176
ds_read_b64_tr_b16 a[232:233],v34 offset:32
ds_read_b64_tr_b16 a[234:235],v34 offset:160
ds_read_b64_tr_b16 a[236:237],v34 offset:2080
ds_read_b64_tr_b16 a[238:239],v34 offset:2208
s_waitcnt vmcnt(38)
ds_write_b128 v33,a[240:243] offset:4096
ds_write_b128 v33,a[244:247] offset:5120
ds_write_b128 v33,a[248:251] offset:6144
ds_write_b128 v33,a[252:255] offset:7168
s_waitcnt lgkmcnt(0)
ds_read_b64_tr_b16 a[240:241],v34 offset:4096
ds_read_b64_tr_b16 a[242:243],v34 offset:4224
ds_read_b64_tr_b16 a[244:245],v34 offset:6144
ds_read_b64_tr_b16 a[246:247],v34 offset:6272
ds_read_b64_tr_b16 a[248:249],v34 offset:4128
ds_read_b64_tr_b16 a[250:251],v34 offset:4256
ds_read_b64_tr_b16 a[252:253],v34 offset:6176
ds_read_b64_tr_b16 a[254:255],v34 offset:6304
s_mov_b32 s79,0
s_add_u32 s63,s79,0
s_and_b32 s64,s63,3
s_lshl_b32 s70,s64,20
s_add_u32 s65,s63,2
s_and_b32 s65,s65,3
s_lshl_b32 s73,s65,20
s_add_u32 s55,s63,3
s_lshl_b32 s78,s55,16
s_add_u32 s78,s78,57344
s_cmp_lt_u32 s55,64
s_cselect_b32 s78,s78,0x7fff0000
s_add_u32 s71,s70,65536
s_add_u32 s60,s63,1
s_and_b32 s60,s60,3
s_lshl_b32 s72,s60,20
v_mov_b32 v184,0
v_mov_b32 v185,0
v_mov_b32 v186,0
v_mov_b32 v187,0
v_mov_b32 v188,0
v_mov_b32 v189,0
v_mov_b32 v190,0
v_mov_b32 v191,0
s_lshl_b32 s77,s63,21
s_lshl_b32 s55,s63,13
s_and_b32 s55,s55,0x2000
s_xor_b32 s55,s55,s61
s_add_u32 s77,s77,s55
v_mov_b32 v176,0
v_mov_b32 v177,0
v_mov_b32 v178,0
v_mov_b32 v179,0
v_mov_b32 v25,1
s_waitcnt vmcnt(0) lgkmcnt(0)
s_barrier
s_branch loop_63
w1_59:
s_lshr_b32 s64,s57,2
s_add_u32 s64,s64,64
s_lshl_b32 s64,s64,14
s_add_u32 s64,s64,s68
s_add_u32 s64,s64,29360128
v_add_u32 v12,s64,v16
v_and_b32 v22,1,v4
v_lshrrev_b32 v23,1,v4
v_lshl_add_u32 v22,v22,1,v23
v_lshlrev_b32 v22,2,v22
v_lshl_add_u32 v22,v3,4,v22
v_add_u32 v31,155648,v22
v_add_u32 v8,s66,v16
v_add_u32 v9,s67,v16
v_mov_b32 v10,1792
v_mov_b32 v11,0
s_branch first_123
loop_124:
s_barrier
hl_126:
buffer_load_dword v248,v18,s[20:23],s70 offen offset:0 sc1
s_waitcnt vmcnt(0)
v_cmp_eq_u32 vcc,v25,v248
s_bcnt1_i32_b32 s64,vcc_lo
s_cmp_ge_u32 s64,8
s_cbranch_scc1 hg_127
s_sub_u32 s90,s90,1
s_cmp_gt_i32 s90,0
s_cbranch_scc1 hl_126
hg_127:
buffer_load_dwordx4 v[48:51],v27,s[20:23],s70 offen offset:0 sc1
buffer_load_dwordx4 v[52:55],v27,s[20:23],s70 offen offset:1024 sc1
buffer_load_dwordx4 v[56:59],v27,s[20:23],s70 offen offset:2048 sc1
buffer_load_dwordx4 v[60:63],v27,s[20:23],s70 offen offset:3072 sc1
s_waitcnt vmcnt(3)
ds_write_b128 v24,v[48:51] offset:4096
v_min3_u32 v22,v48,v49,v50
v_min_u32 v22,v22,v51
s_waitcnt vmcnt(2)
ds_write_b128 v24,v[52:55] offset:5120
v_min3_u32 v22,v22,v52,v53
v_min3_u32 v22,v22,v54,v55
s_waitcnt vmcnt(1)
ds_write_b128 v24,v[56:59] offset:6144
v_min3_u32 v22,v22,v56,v57
v_min3_u32 v22,v22,v58,v59
s_waitcnt vmcnt(0)
ds_write_b128 v24,v[60:63] offset:7168
v_min3_u32 v22,v22,v60,v61
v_min3_u32 v22,v22,v62,v63
v_cmp_eq_u32 vcc,0,v22
s_cbranch_vccnz art_128
abk_129:
v_smfmac_f32_16x16x64_bf16 v[176:179],v[48:51],a[32:39],v14
s_waitcnt lgkmcnt(0)
s_barrier
ds_read_b128 v[64:67],v24 offset:8192
ds_read_b128 v[68:71],v24 offset:9216
ds_read_b128 v[72:75],v24 offset:10240
ds_read_b128 v[76:79],v24 offset:11264
buffer_store_dwordx4 v[212:215],v12,s[20:23],s76 offen sc1
v_smfmac_f32_16x16x64_bf16 v[176:179],v[52:55],a[40:47],v14
ds_read_b128 v[80:83],v24 offset:12288
ds_read_b128 v[84:87],v24 offset:13312
v_smfmac_f32_16x16x64_bf16 v[176:179],v[56:59],a[48:55],v14
ds_read_b128 v[88:91],v24 offset:14336
ds_read_b128 v[92:95],v24 offset:15360
v_smfmac_f32_16x16x64_bf16 v[176:179],v[60:63],a[56:63],v14
ds_read_b128 v[32:35],v24 offset:0
ds_read_b128 v[36:39],v24 offset:1024
s_waitcnt lgkmcnt(9)
v_smfmac_f32_16x16x64_bf16 v[176:179],v[64:67],a[64:71],v14
ds_read_b128 v[40:43],v24 offset:2048
s_waitcnt lgkmcnt(9)
v_smfmac_f32_16x16x64_bf16 v[176:179],v[68:71],a[72:79],v14
ds_read_b128 v[44:47],v24 offset:3072
s_waitcnt lgkmcnt(9)
v_smfmac_f32_16x16x64_bf16 v[176:179],v[72:75],a[80:87],v14
s_waitcnt lgkmcnt(8)
v_smfmac_f32_16x16x64_bf16 v[176:179],v[76:79],a[88:95],v14
s_waitcnt lgkmcnt(7)
v_smfmac_f32_16x16x64_bf16 v[176:179],v[80:83],a[96:103],v14
s_waitcnt lgkmcnt(6)
v_smfmac_f32_16x16x64_bf16 v[176:179],v[84:87],a[104:111],v14
s_waitcnt lgkmcnt(5)
v_smfmac_f32_16x16x64_bf16 v[176:179],v[88:91],a[112:119],v14
s_waitcnt lgkmcnt(4)
v_smfmac_f32_16x16x64_bf16 v[176:179],v[92:95],a[120:127],v14
s_waitcnt lgkmcnt(3)
v_smfmac_f32_16x16x64_bf16 v[176:179],v[32:35],a[0:7],v14
s_waitcnt lgkmcnt(2)
v_smfmac_f32_16x16x64_bf16 v[176:179],v[36:39],a[8:15],v14
s_waitcnt lgkmcnt(1)
v_smfmac_f32_16x16x64_bf16 v[176:179],v[40:43],a[16:23],v14
s_waitcnt lgkmcnt(0)
v_smfmac_f32_16x16x64_bf16 v[176:179],v[44:47],a[24:31],v14
v_smfmac_f32_16x16x64_bf16 v[180:183],v[32:35],a[128:135],v14
v_smfmac_f32_16x16x64_bf16 v[180:183],v[36:39],a[136:143],v14
s_nop 5
v_permlane32_swap_b32 v176,v178
v_permlane32_swap_b32 v177,v179
v_add_f32 v176,v176,v178
v_add_f32 v177,v177,v179
v_cvt_pk_bf16_f32 v216,v176,v177
s_nop 1
v_mov_b32_dpp v217,v216 quad_perm:[1,0,3,2] row_mask:0xf bank_mask:0xf
v_perm_b32 v216,v217,v216,v15
v_max_u32 v216,1,v216
buffer_store_dword v216,v19,s[24:27],s70 offen
buffer_store_dword v216,v19,s[28:31],s70 offen sc1
v_smfmac_f32_16x16x64_bf16 v[180:183],v[40:43],a[144:151],v14
v_smfmac_f32_16x16x64_bf16 v[180:183],v[44:47],a[152:159],v14
v_smfmac_f32_16x16x64_bf16 v[180:183],v[48:51],a[160:167],v14
v_smfmac_f32_16x16x64_bf16 v[180:183],v[52:55],a[168:175],v14
v_smfmac_f32_16x16x64_bf16 v[180:183],v[56:59],a[176:183],v14
v_smfmac_f32_16x16x64_bf16 v[180:183],v[60:63],a[184:191],v14
v_smfmac_f32_16x16x64_bf16 v[180:183],v[64:67],a[192:199],v14
v_smfmac_f32_16x16x64_bf16 v[180:183],v[68:71],a[200:207],v14
v_smfmac_f32_16x16x64_bf16 v[180:183],v[72:75],a[208:215],v14
v_smfmac_f32_16x16x64_bf16 v[180:183],v[76:79],a[216:223],v14
v_smfmac_f32_16x16x64_bf16 v[180:183],v[80:83],a[224:231],v14
v_smfmac_f32_16x16x64_bf16 v[180:183],v[84:87],a[232:239],v14
v_smfmac_f32_16x16x64_bf16 v[180:183],v[88:91],a[240:247],v14
v_smfmac_f32_16x16x64_bf16 v[180:183],v[92:95],a[248:255],v14
s_nop 7
v_permlane32_swap_b32 v180,v182
v_permlane32_swap_b32 v181,v183
v_add_f32 v180,v180,v182
v_add_f32 v181,v181,v183
v_cvt_pk_bf16_f32 v216,v180,v181
v_max_u32 v216,1,v216
ds_write_b32 v31,v216
ds_write_b32 v21,v25 offset:0
s_cmp_eq_u32 s79,63
s_cbranch_scc1 end_57
s_cmp_ge_i32 s79,62
s_cbranch_scc1 bgsk_131
ds_read_b128 v[64:67],v20 offset:0
ds_read_b128 v[68:71],v20 offset:1024
ds_read_b128 v[72:75],v20 offset:2048
s_waitcnt lgkmcnt(2)
v_mfma_f32_16x16x32_bf16 v[192:195],a[0:3],v[64:67],0
ds_read_b128 v[76:79],v20 offset:3072
v_mfma_f32_16x16x32_bf16 v[200:203],v[64:67],a[128:131],0
s_waitcnt lgkmcnt(2)
v_mfma_f32_16x16x32_bf16 v[196:199],a[0:3],v[68:71],0
ds_read_b128 v[64:67],v20 offset:4096
v_mfma_f32_16x16x32_bf16 v[204:207],v[68:71],a[128:131],0
s_waitcnt lgkmcnt(2)
v_mfma_f32_16x16x32_bf16 v[192:195],a[4:7],v[72:75],v[192:195]
ds_read_b128 v[68:71],v20 offset:5120
v_mfma_f32_16x16x32_bf16 v[200:203],v[72:75],a[132:135],v[200:203]
s_waitcnt lgkmcnt(2)
v_mfma_f32_16x16x32_bf16 v[196:199],a[4:7],v[76:79],v[196:199]
ds_read_b128 v[72:75],v20 offset:6144
v_mfma_f32_16x16x32_bf16 v[204:207],v[76:79],a[132:135],v[204:207]
s_waitcnt lgkmcnt(2)
v_mfma_f32_16x16x32_bf16 v[192:195],a[8:11],v[64:67],v[192:195]
ds_read_b128 v[76:79],v20 offset:7168
v_mfma_f32_16x16x32_bf16 v[200:203],v[64:67],a[136:139],v[200:203]
s_waitcnt lgkmcnt(2)
v_mfma_f32_16x16x32_bf16 v[196:199],a[8:11],v[68:71],v[196:199]
ds_read_b128 v[64:67],v20 offset:8192
v_mfma_f32_16x16x32_bf16 v[204:207],v[68:71],a[136:139],v[204:207]
s_waitcnt lgkmcnt(2)
v_mfma_f32_16x16x32_bf16 v[192:195],a[12:15],v[72:75],v[192:195]
ds_read_b128 v[68:71],v20 offset:9216
v_mfma_f32_16x16x32_bf16 v[200:203],v[72:75],a[140:143],v[200:203]
s_waitcnt lgkmcnt(2)
v_mfma_f32_16x16x32_bf16 v[196:199],a[12:15],v[76:79],v[196:199]
ds_read_b128 v[72:75],v20 offset:10240
v_mfma_f32_16x16x32_bf16 v[204:207],v[76:79],a[140:143],v[204:207]
s_add_u32 m0,s62,0
s_add_u32 s69,s78,0
s_waitcnt lgkmcnt(2)
v_mfma_f32_16x16x32_bf16 v[192:195],a[16:19],v[64:67],v[192:195]
ds_read_b128 v[76:79],v20 offset:11264
v_mfma_f32_16x16x32_bf16 v[200:203],v[64:67],a[144:147],v[200:203]
buffer_load_dwordx4 v16,s[20:23],s69 offen offset:0 lds
s_waitcnt lgkmcnt(2)
v_mfma_f32_16x16x32_bf16 v[196:199],a[16:19],v[68:71],v[196:199]
ds_read_b128 v[64:67],v20 offset:12288
v_mfma_f32_16x16x32_bf16 v[204:207],v[68:71],a[144:147],v[204:207]
buffer_load_dwordx4 v16,s[20:23],s69 offen offset:1024 lds
s_waitcnt lgkmcnt(2)
v_mfma_f32_16x16x32_bf16 v[192:195],a[20:23],v[72:75],v[192:195]
ds_read_b128 v[68:71],v20 offset:13312
v_mfma_f32_16x16x32_bf16 v[200:203],v[72:75],a[148:151],v[200:203]
buffer_load_dwordx4 v16,s[20:23],s69 offen offset:2048 lds
s_waitcnt lgkmcnt(2)
v_mfma_f32_16x16x32_bf16 v[196:199],a[20:23],v[76:79],v[196:199]
ds_read_b128 v[72:75],v20 offset:14336
v_mfma_f32_16x16x32_bf16 v[204:207],v[76:79],a[148:151],v[204:207]
buffer_load_dwordx4 v16,s[20:23],s69 offen offset:3072 lds
s_waitcnt lgkmcnt(2)
v_mfma_f32_16x16x32_bf16 v[192:195],a[24:27],v[64:67],v[192:195]
ds_read_b128 v[76:79],v20 offset:15360
v_mfma_f32_16x16x32_bf16 v[200:203],v[64:67],a[152:155],v[200:203]
s_add_u32 m0,s62,4096
s_add_u32 s69,s78,4096
s_waitcnt lgkmcnt(2)
v_mfma_f32_16x16x32_bf16 v[196:199],a[24:27],v[68:71],v[196:199]
ds_read_b128 v[64:67],v20 offset:16384
v_mfma_f32_16x16x32_bf16 v[204:207],v[68:71],a[152:155],v[204:207]
buffer_load_dwordx4 v16,s[20:23],s69 offen offset:0 lds
s_waitcnt lgkmcnt(2)
v_mfma_f32_16x16x32_bf16 v[192:195],a[28:31],v[72:75],v[192:195]
ds_read_b128 v[68:71],v20 offset:17408
v_mfma_f32_16x16x32_bf16 v[200:203],v[72:75],a[156:159],v[200:203]
buffer_load_dwordx4 v16,s[20:23],s69 offen offset:1024 lds
s_waitcnt lgkmcnt(2)
v_mfma_f32_16x16x32_bf16 v[196:199],a[28:31],v[76:79],v[196:199]
ds_read_b128 v[72:75],v20 offset:18432
v_mfma_f32_16x16x32_bf16 v[204:207],v[76:79],a[156:159],v[204:207]
buffer_load_dwordx4 v16,s[20:23],s69 offen offset:2048 lds
s_waitcnt lgkmcnt(2)
v_mfma_f32_16x16x32_bf16 v[192:195],a[32:35],v[64:67],v[192:195]
ds_read_b128 v[76:79],v20 offset:19456
v_mfma_f32_16x16x32_bf16 v[200:203],v[64:67],a[160:163],v[200:203]
buffer_load_dwordx4 v16,s[20:23],s69 offen offset:3072 lds
s_waitcnt lgkmcnt(2)
v_mfma_f32_16x16x32_bf16 v[196:199],a[32:35],v[68:71],v[196:199]
ds_read_b128 v[64:67],v20 offset:20480
v_mfma_f32_16x16x32_bf16 v[204:207],v[68:71],a[160:163],v[204:207]
s_add_u32 m0,s62,8192
s_add_u32 s69,s78,8192
s_waitcnt lgkmcnt(2)
v_mfma_f32_16x16x32_bf16 v[192:195],a[36:39],v[72:75],v[192:195]
ds_read_b128 v[68:71],v20 offset:21504
v_mfma_f32_16x16x32_bf16 v[200:203],v[72:75],a[164:167],v[200:203]
buffer_load_dwordx4 v16,s[20:23],s69 offen offset:0 lds
s_waitcnt lgkmcnt(2)
v_mfma_f32_16x16x32_bf16 v[196:199],a[36:39],v[76:79],v[196:199]
ds_read_b128 v[72:75],v20 offset:22528
v_mfma_f32_16x16x32_bf16 v[204:207],v[76:79],a[164:167],v[204:207]
buffer_load_dwordx4 v16,s[20:23],s69 offen offset:1024 lds
s_waitcnt lgkmcnt(2)
v_mfma_f32_16x16x32_bf16 v[192:195],a[40:43],v[64:67],v[192:195]
ds_read_b128 v[76:79],v20 offset:23552
v_mfma_f32_16x16x32_bf16 v[200:203],v[64:67],a[168:171],v[200:203]
buffer_load_dwordx4 v16,s[20:23],s69 offen offset:2048 lds
s_waitcnt lgkmcnt(2)
v_mfma_f32_16x16x32_bf16 v[196:199],a[40:43],v[68:71],v[196:199]
ds_read_b128 v[64:67],v20 offset:24576
v_mfma_f32_16x16x32_bf16 v[204:207],v[68:71],a[168:171],v[204:207]
buffer_load_dwordx4 v16,s[20:23],s69 offen offset:3072 lds
s_waitcnt lgkmcnt(2)
v_mfma_f32_16x16x32_bf16 v[192:195],a[44:47],v[72:75],v[192:195]
ds_read_b128 v[68:71],v20 offset:25600
v_mfma_f32_16x16x32_bf16 v[200:203],v[72:75],a[172:175],v[200:203]
s_add_u32 m0,s62,12288
s_add_u32 s69,s78,12288
s_waitcnt lgkmcnt(2)
v_mfma_f32_16x16x32_bf16 v[196:199],a[44:47],v[76:79],v[196:199]
ds_read_b128 v[72:75],v20 offset:26624
v_mfma_f32_16x16x32_bf16 v[204:207],v[76:79],a[172:175],v[204:207]
buffer_load_dwordx4 v16,s[20:23],s69 offen offset:0 lds
s_waitcnt lgkmcnt(2)
v_mfma_f32_16x16x32_bf16 v[192:195],a[48:51],v[64:67],v[192:195]
ds_read_b128 v[76:79],v20 offset:27648
v_mfma_f32_16x16x32_bf16 v[200:203],v[64:67],a[176:179],v[200:203]
buffer_load_dwordx4 v16,s[20:23],s69 offen offset:1024 lds
s_waitcnt lgkmcnt(2)
v_mfma_f32_16x16x32_bf16 v[196:199],a[48:51],v[68:71],v[196:199]
ds_read_b128 v[64:67],v20 offset:28672
v_mfma_f32_16x16x32_bf16 v[204:207],v[68:71],a[176:179],v[204:207]
buffer_load_dwordx4 v16,s[20:23],s69 offen offset:2048 lds
s_waitcnt lgkmcnt(2)
v_mfma_f32_16x16x32_bf16 v[192:195],a[52:55],v[72:75],v[192:195]
ds_read_b128 v[68:71],v20 offset:29696
v_mfma_f32_16x16x32_bf16 v[200:203],v[72:75],a[180:183],v[200:203]
buffer_load_dwordx4 v16,s[20:23],s69 offen offset:3072 lds
s_waitcnt lgkmcnt(2)
v_mfma_f32_16x16x32_bf16 v[196:199],a[52:55],v[76:79],v[196:199]
ds_read_b128 v[72:75],v20 offset:30720
v_mfma_f32_16x16x32_bf16 v[204:207],v[76:79],a[180:183],v[204:207]
s_waitcnt lgkmcnt(2)
v_mfma_f32_16x16x32_bf16 v[192:195],a[56:59],v[64:67],v[192:195]
ds_read_b128 v[76:79],v20 offset:31744
v_mfma_f32_16x16x32_bf16 v[200:203],v[64:67],a[184:187],v[200:203]
s_waitcnt lgkmcnt(2)
v_mfma_f32_16x16x32_bf16 v[196:199],a[56:59],v[68:71],v[196:199]
ds_read_b128 v[64:67],v20 offset:32768
v_mfma_f32_16x16x32_bf16 v[204:207],v[68:71],a[184:187],v[204:207]
s_waitcnt lgkmcnt(2)
v_mfma_f32_16x16x32_bf16 v[192:195],a[60:63],v[72:75],v[192:195]
ds_read_b128 v[68:71],v20 offset:33792
v_mfma_f32_16x16x32_bf16 v[200:203],v[72:75],a[188:191],v[200:203]
s_waitcnt lgkmcnt(2)
v_mfma_f32_16x16x32_bf16 v[196:199],a[60:63],v[76:79],v[196:199]
ds_read_b128 v[72:75],v20 offset:34816
v_mfma_f32_16x16x32_bf16 v[204:207],v[76:79],a[188:191],v[204:207]
s_waitcnt lgkmcnt(2)
v_mfma_f32_16x16x32_bf16 v[192:195],a[64:67],v[64:67],v[192:195]
ds_read_b128 v[76:79],v20 offset:35840
v_mfma_f32_16x16x32_bf16 v[200:203],v[64:67],a[192:195],v[200:203]
s_waitcnt lgkmcnt(2)
v_mfma_f32_16x16x32_bf16 v[196:199],a[64:67],v[68:71],v[196:199]
ds_read_b128 v[64:67],v20 offset:36864
v_mfma_f32_16x16x32_bf16 v[204:207],v[68:71],a[192:195],v[204:207]
s_waitcnt lgkmcnt(2)
v_mfma_f32_16x16x32_bf16 v[192:195],a[68:71],v[72:75],v[192:195]
ds_read_b128 v[68:71],v20 offset:37888
v_mfma_f32_16x16x32_bf16 v[200:203],v[72:75],a[196:199],v[200:203]
s_waitcnt lgkmcnt(2)
v_mfma_f32_16x16x32_bf16 v[196:199],a[68:71],v[76:79],v[196:199]
ds_read_b128 v[72:75],v20 offset:38912
v_mfma_f32_16x16x32_bf16 v[204:207],v[76:79],a[196:199],v[204:207]
s_waitcnt lgkmcnt(2)
v_mfma_f32_16x16x32_bf16 v[192:195],a[72:75],v[64:67],v[192:195]
ds_read_b128 v[76:79],v20 offset:39936
v_mfma_f32_16x16x32_bf16 v[200:203],v[64:67],a[200:203],v[200:203]
s_waitcnt lgkmcnt(2)
v_mfma_f32_16x16x32_bf16 v[196:199],a[72:75],v[68:71],v[196:199]
ds_read_b128 v[64:67],v20 offset:40960
v_mfma_f32_16x16x32_bf16 v[204:207],v[68:71],a[200:203],v[204:207]
s_waitcnt lgkmcnt(2)
v_mfma_f32_16x16x32_bf16 v[192:195],a[76:79],v[72:75],v[192:195]
ds_read_b128 v[68:71],v20 offset:41984
v_mfma_f32_16x16x32_bf16 v[200:203],v[72:75],a[204:207],v[200:203]
s_waitcnt lgkmcnt(2)
v_mfma_f32_16x16x32_bf16 v[196:199],a[76:79],v[76:79],v[196:199]
ds_read_b128 v[72:75],v20 offset:43008
v_mfma_f32_16x16x32_bf16 v[204:207],v[76:79],a[204:207],v[204:207]
s_waitcnt lgkmcnt(2)
v_mfma_f32_16x16x32_bf16 v[192:195],a[80:83],v[64:67],v[192:195]
ds_read_b128 v[76:79],v20 offset:44032
v_mfma_f32_16x16x32_bf16 v[200:203],v[64:67],a[208:211],v[200:203]
s_waitcnt lgkmcnt(2)
v_mfma_f32_16x16x32_bf16 v[196:199],a[80:83],v[68:71],v[196:199]
ds_read_b128 v[64:67],v20 offset:45056
v_mfma_f32_16x16x32_bf16 v[204:207],v[68:71],a[208:211],v[204:207]
s_waitcnt lgkmcnt(2)
v_mfma_f32_16x16x32_bf16 v[192:195],a[84:87],v[72:75],v[192:195]
ds_read_b128 v[68:71],v20 offset:46080
v_mfma_f32_16x16x32_bf16 v[200:203],v[72:75],a[212:215],v[200:203]
s_waitcnt lgkmcnt(2)
v_mfma_f32_16x16x32_bf16 v[196:199],a[84:87],v[76:79],v[196:199]
ds_read_b128 v[72:75],v20 offset:47104
v_mfma_f32_16x16x32_bf16 v[204:207],v[76:79],a[212:215],v[204:207]
s_waitcnt lgkmcnt(2)
v_mfma_f32_16x16x32_bf16 v[192:195],a[88:91],v[64:67],v[192:195]
ds_read_b128 v[76:79],v20 offset:48128
v_mfma_f32_16x16x32_bf16 v[200:203],v[64:67],a[216:219],v[200:203]
s_waitcnt lgkmcnt(2)
v_mfma_f32_16x16x32_bf16 v[196:199],a[88:91],v[68:71],v[196:199]
ds_read_b128 v[64:67],v20 offset:49152
v_mfma_f32_16x16x32_bf16 v[204:207],v[68:71],a[216:219],v[204:207]
s_waitcnt lgkmcnt(2)
v_mfma_f32_16x16x32_bf16 v[192:195],a[92:95],v[72:75],v[192:195]
ds_read_b128 v[68:71],v20 offset:50176
v_mfma_f32_16x16x32_bf16 v[200:203],v[72:75],a[220:223],v[200:203]
s_waitcnt lgkmcnt(2)
v_mfma_f32_16x16x32_bf16 v[196:199],a[92:95],v[76:79],v[196:199]
ds_read_b128 v[72:75],v20 offset:51200
v_mfma_f32_16x16x32_bf16 v[204:207],v[76:79],a[220:223],v[204:207]
s_waitcnt lgkmcnt(2)
v_mfma_f32_16x16x32_bf16 v[192:195],a[96:99],v[64:67],v[192:195]
ds_read_b128 v[76:79],v20 offset:52224
v_mfma_f32_16x16x32_bf16 v[200:203],v[64:67],a[224:227],v[200:203]
s_waitcnt lgkmcnt(2)
v_mfma_f32_16x16x32_bf16 v[196:199],a[96:99],v[68:71],v[196:199]
ds_read_b128 v[64:67],v20 offset:53248
v_mfma_f32_16x16x32_bf16 v[204:207],v[68:71],a[224:227],v[204:207]
s_waitcnt lgkmcnt(2)
v_mfma_f32_16x16x32_bf16 v[192:195],a[100:103],v[72:75],v[192:195]
ds_read_b128 v[68:71],v20 offset:54272
s_add_u32 m0,s62,32768
s_add_u32 s69,s78,32768
v_mfma_f32_16x16x32_bf16 v[200:203],v[72:75],a[228:231],v[200:203]
s_waitcnt lgkmcnt(2)
v_mfma_f32_16x16x32_bf16 v[196:199],a[100:103],v[76:79],v[196:199]
ds_read_b128 v[72:75],v20 offset:55296
buffer_load_dwordx4 v16,s[20:23],s69 offen offset:0 lds
v_mfma_f32_16x16x32_bf16 v[204:207],v[76:79],a[228:231],v[204:207]
s_waitcnt lgkmcnt(2)
v_mfma_f32_16x16x32_bf16 v[192:195],a[104:107],v[64:67],v[192:195]
ds_read_b128 v[76:79],v20 offset:56320
buffer_load_dwordx4 v16,s[20:23],s69 offen offset:1024 lds
v_mfma_f32_16x16x32_bf16 v[200:203],v[64:67],a[232:235],v[200:203]
s_waitcnt lgkmcnt(2)
v_mfma_f32_16x16x32_bf16 v[196:199],a[104:107],v[68:71],v[196:199]
ds_read_b128 v[64:67],v20 offset:57344
buffer_load_dwordx4 v16,s[20:23],s69 offen offset:2048 lds
v_mfma_f32_16x16x32_bf16 v[204:207],v[68:71],a[232:235],v[204:207]
s_waitcnt lgkmcnt(2)
v_mfma_f32_16x16x32_bf16 v[192:195],a[108:111],v[72:75],v[192:195]
ds_read_b128 v[68:71],v20 offset:58368
buffer_load_dwordx4 v16,s[20:23],s69 offen offset:3072 lds
v_mfma_f32_16x16x32_bf16 v[200:203],v[72:75],a[236:239],v[200:203]
s_waitcnt lgkmcnt(2)
v_mfma_f32_16x16x32_bf16 v[196:199],a[108:111],v[76:79],v[196:199]
ds_read_b128 v[72:75],v20 offset:59392
s_add_u32 m0,s62,36864
s_add_u32 s69,s78,36864
v_mfma_f32_16x16x32_bf16 v[204:207],v[76:79],a[236:239],v[204:207]
s_waitcnt lgkmcnt(2)
v_mfma_f32_16x16x32_bf16 v[192:195],a[112:115],v[64:67],v[192:195]
ds_read_b128 v[76:79],v20 offset:60416
buffer_load_dwordx4 v16,s[20:23],s69 offen offset:0 lds
v_mfma_f32_16x16x32_bf16 v[200:203],v[64:67],a[240:243],v[200:203]
s_waitcnt lgkmcnt(2)
v_mfma_f32_16x16x32_bf16 v[196:199],a[112:115],v[68:71],v[196:199]
ds_read_b128 v[64:67],v20 offset:61440
v_mfma_f32_16x16x32_bf16 v[204:207],v[68:71],a[240:243],v[204:207]
buffer_load_dwordx4 v16,s[20:23],s69 offen offset:1024 lds
s_waitcnt lgkmcnt(2)
v_mfma_f32_16x16x32_bf16 v[192:195],a[116:119],v[72:75],v[192:195]
ds_read_b128 v[68:71],v20 offset:62464
v_mfma_f32_16x16x32_bf16 v[200:203],v[72:75],a[244:247],v[200:203]
buffer_load_dwordx4 v16,s[20:23],s69 offen offset:2048 lds
s_waitcnt lgkmcnt(2)
v_mfma_f32_16x16x32_bf16 v[196:199],a[116:119],v[76:79],v[196:199]
ds_read_b128 v[72:75],v20 offset:63488
v_mfma_f32_16x16x32_bf16 v[204:207],v[76:79],a[244:247],v[204:207]
buffer_load_dwordx4 v16,s[20:23],s69 offen offset:3072 lds
s_waitcnt lgkmcnt(2)
v_mfma_f32_16x16x32_bf16 v[192:195],a[120:123],v[64:67],v[192:195]
ds_read_b128 v[76:79],v20 offset:64512
v_mfma_f32_16x16x32_bf16 v[200:203],v[64:67],a[248:251],v[200:203]
s_add_u32 m0,s62,40960
s_add_u32 s69,s78,40960
s_waitcnt lgkmcnt(2)
v_mfma_f32_16x16x32_bf16 v[196:199],a[120:123],v[68:71],v[196:199]
v_mfma_f32_16x16x32_bf16 v[204:207],v[68:71],a[248:251],v[204:207]
buffer_load_dwordx4 v16,s[20:23],s69 offen offset:0 lds
s_waitcnt lgkmcnt(1)
v_mfma_f32_16x16x32_bf16 v[192:195],a[124:127],v[72:75],v[192:195]
v_mfma_f32_16x16x32_bf16 v[200:203],v[72:75],a[252:255],v[200:203]
buffer_load_dwordx4 v16,s[20:23],s69 offen offset:1024 lds
s_waitcnt lgkmcnt(0)
v_mfma_f32_16x16x32_bf16 v[196:199],a[124:127],v[76:79],v[196:199]
v_mfma_f32_16x16x32_bf16 v[204:207],v[76:79],a[252:255],v[204:207]
s_waitcnt vmcnt(26)
ds_write_b32 v21,v25 offset:24
v_xor_b32 v20,0x10000,v20
s_xor_b32 s62,s62,0x10000
s_lshr_b32 s64,s73,9
v_add_u32 v22,s64,v24
v_cvt_pk_bf16_f32 v208,v192,v193
v_cvt_pk_bf16_f32 v209,v194,v195
v_cvt_pk_bf16_f32 v210,v196,v197
v_cvt_pk_bf16_f32 v211,v198,v199
v_cvt_pk_bf16_f32 v212,v200,v201
v_cvt_pk_bf16_f32 v213,v202,v203
v_cvt_pk_bf16_f32 v214,v204,v205
v_cvt_pk_bf16_f32 v215,v206,v207
v_permlane16_swap_b32 v208,v210
v_permlane16_swap_b32 v209,v211
buffer_store_dwordx4 v[208:211],v2,s[24:27],s73 offen
buffer_store_dwordx4 v[208:211],v2,s[28:31],s73 offen sc1
ds_write_b128 v22,v[212:215] offset:16384
buffer_store_dwordx4 v[208:211],v17,s[20:23],s12 offen sc1
bgx_130:
buffer_store_dwordx4 v[100:103],v9,s[24:27],s73 offen
buffer_store_dwordx4 v[100:103],v9,s[28:31],s73 offen sc1
s_mov_b32 exec_hi,0
buffer_store_dwordx4 v[100:103],v8,s[24:27],s73 offen
buffer_store_dwordx4 v[100:103],v8,s[24:27],s71 offen
buffer_store_dwordx4 v[100:103],v8,s[28:31],s73 offen sc1
buffer_store_dwordx4 v[100:103],v8,s[28:31],s71 offen sc1
s_mov_b64 exec,-1
s_waitcnt lgkmcnt(0)
s_add_u32 s63,s79,1
s_and_b32 s64,s63,3
s_lshl_b32 s70,s64,20
s_add_u32 s65,s63,2
s_and_b32 s65,s65,3
s_lshl_b32 s73,s65,20
s_add_u32 s55,s63,3
s_lshl_b32 s78,s55,16
s_add_u32 s78,s78,57344
s_cmp_lt_u32 s55,64
s_cselect_b32 s78,s78,0x7fff0000
s_add_u32 s60,s63,1
s_lshl_b32 s76,s60,21
s_lshl_b32 s55,s60,13
s_and_b32 s55,s55,0x2000
s_xor_b32 s55,s55,s61
s_add_u32 s76,s76,s55
s_cmp_lt_u32 s60,64
s_cselect_b32 s76,s76,0x7fff0000
s_add_u32 s60,s63,2
s_lshl_b32 s12,s60,21
s_lshl_b32 s55,s60,13
s_and_b32 s55,s55,0x2000
s_xor_b32 s55,s55,s61
s_add_u32 s12,s12,s55
s_cmp_lt_u32 s60,64
s_cselect_b32 s12,s12,0x7fff0000
s_add_u32 s71,s73,65536
v_mov_b32 v176,0
v_mov_b32 v177,0
v_mov_b32 v178,0
v_mov_b32 v179,0
v_mov_b32 v180,0
v_mov_b32 v181,0
v_mov_b32 v182,0
v_mov_b32 v183,0
s_add_u32 s79,s79,1
v_add_u32 v25,1,v25
s_waitcnt vmcnt(0)
s_branch loop_124
art_128:
s_sub_u32 s90,s90,1
s_cmp_lt_i32 s90,0
s_cbranch_scc1 abk_129
buffer_load_dwordx4 v[48:51],v27,s[20:23],s70 offen offset:0 sc1
buffer_load_dwordx4 v[52:55],v27,s[20:23],s70 offen offset:1024 sc1
buffer_load_dwordx4 v[56:59],v27,s[20:23],s70 offen offset:2048 sc1
buffer_load_dwordx4 v[60:63],v27,s[20:23],s70 offen offset:3072 sc1
s_waitcnt vmcnt(3)
ds_write_b128 v24,v[48:51] offset:4096
v_min3_u32 v22,v48,v49,v50
v_min_u32 v22,v22,v51
s_waitcnt vmcnt(2)
ds_write_b128 v24,v[52:55] offset:5120
v_min3_u32 v22,v22,v52,v53
v_min3_u32 v22,v22,v54,v55
s_waitcnt vmcnt(1)
ds_write_b128 v24,v[56:59] offset:6144
v_min3_u32 v22,v22,v56,v57
v_min3_u32 v22,v22,v58,v59
s_waitcnt vmcnt(0)
ds_write_b128 v24,v[60:63] offset:7168
v_min3_u32 v22,v22,v60,v61
v_min3_u32 v22,v22,v62,v63
v_cmp_eq_u32 vcc,0,v22
s_cbranch_vccnz art_128
s_branch abk_129
bgsk_131:
s_waitcnt vmcnt(0)
ds_write_b32 v21,v25 offset:24
s_branch bgx_130
first_123:
s_add_u32 s63,s79,0
s_and_b32 s64,s63,3
s_lshl_b32 s70,s64,20
s_add_u32 s65,s63,2
s_and_b32 s65,s65,3
s_lshl_b32 s73,s65,20
s_add_u32 s55,s63,3
s_lshl_b32 s78,s55,16
s_add_u32 s78,s78,57344
s_cmp_lt_u32 s55,64
s_cselect_b32 s78,s78,0x7fff0000
s_add_u32 s60,s63,1
s_lshl_b32 s76,s60,21
s_lshl_b32 s55,s60,13
s_and_b32 s55,s55,0x2000
s_xor_b32 s55,s55,s61
s_add_u32 s76,s76,s55
s_cmp_lt_u32 s60,64
s_cselect_b32 s76,s76,0x7fff0000
s_add_u32 s60,s63,2
s_lshl_b32 s12,s60,21
s_lshl_b32 s55,s60,13
s_and_b32 s55,s55,0x2000
s_xor_b32 s55,s55,s61
s_add_u32 s12,s12,s55
s_cmp_lt_u32 s60,64
s_cselect_b32 s12,s12,0x7fff0000
s_add_u32 s71,s73,65536
v_mov_b32 v176,0
v_mov_b32 v177,0
v_mov_b32 v178,0
v_mov_b32 v179,0
v_mov_b32 v180,0
v_mov_b32 v181,0
v_mov_b32 v182,0
v_mov_b32 v183,0
s_waitcnt vmcnt(0) lgkmcnt(0)
s_barrier
pn1_132:
ds_read_b128 v[64:67],v20 offset:0
ds_read_b128 v[68:71],v20 offset:1024
ds_read_b128 v[72:75],v20 offset:2048
s_waitcnt lgkmcnt(2)
v_mfma_f32_16x16x32_bf16 v[192:195],a[0:3],v[64:67],0
ds_read_b128 v[76:79],v20 offset:3072
v_mfma_f32_16x16x32_bf16 v[200:203],v[64:67],a[128:131],0
s_waitcnt lgkmcnt(2)
v_mfma_f32_16x16x32_bf16 v[196:199],a[0:3],v[68:71],0
ds_read_b128 v[64:67],v20 offset:4096
v_mfma_f32_16x16x32_bf16 v[204:207],v[68:71],a[128:131],0
s_waitcnt lgkmcnt(2)
v_mfma_f32_16x16x32_bf16 v[192:195],a[4:7],v[72:75],v[192:195]
ds_read_b128 v[68:71],v20 offset:5120
v_mfma_f32_16x16x32_bf16 v[200:203],v[72:75],a[132:135],v[200:203]
s_waitcnt lgkmcnt(2)
v_mfma_f32_16x16x32_bf16 v[196:199],a[4:7],v[76:79],v[196:199]
ds_read_b128 v[72:75],v20 offset:6144
v_mfma_f32_16x16x32_bf16 v[204:207],v[76:79],a[132:135],v[204:207]
s_waitcnt lgkmcnt(2)
v_mfma_f32_16x16x32_bf16 v[192:195],a[8:11],v[64:67],v[192:195]
ds_read_b128 v[76:79],v20 offset:7168
v_mfma_f32_16x16x32_bf16 v[200:203],v[64:67],a[136:139],v[200:203]
s_waitcnt lgkmcnt(2)
v_mfma_f32_16x16x32_bf16 v[196:199],a[8:11],v[68:71],v[196:199]
ds_read_b128 v[64:67],v20 offset:8192
v_mfma_f32_16x16x32_bf16 v[204:207],v[68:71],a[136:139],v[204:207]
s_waitcnt lgkmcnt(2)
v_mfma_f32_16x16x32_bf16 v[192:195],a[12:15],v[72:75],v[192:195]
ds_read_b128 v[68:71],v20 offset:9216
v_mfma_f32_16x16x32_bf16 v[200:203],v[72:75],a[140:143],v[200:203]
s_waitcnt lgkmcnt(2)
v_mfma_f32_16x16x32_bf16 v[196:199],a[12:15],v[76:79],v[196:199]
ds_read_b128 v[72:75],v20 offset:10240
v_mfma_f32_16x16x32_bf16 v[204:207],v[76:79],a[140:143],v[204:207]
s_waitcnt lgkmcnt(2)
v_mfma_f32_16x16x32_bf16 v[192:195],a[16:19],v[64:67],v[192:195]
ds_read_b128 v[76:79],v20 offset:11264
v_mfma_f32_16x16x32_bf16 v[200:203],v[64:67],a[144:147],v[200:203]
s_waitcnt lgkmcnt(2)
v_mfma_f32_16x16x32_bf16 v[196:199],a[16:19],v[68:71],v[196:199]
ds_read_b128 v[64:67],v20 offset:12288
v_mfma_f32_16x16x32_bf16 v[204:207],v[68:71],a[144:147],v[204:207]
s_waitcnt lgkmcnt(2)
v_mfma_f32_16x16x32_bf16 v[192:195],a[20:23],v[72:75],v[192:195]
ds_read_b128 v[68:71],v20 offset:13312
v_mfma_f32_16x16x32_bf16 v[200:203],v[72:75],a[148:151],v[200:203]
s_waitcnt lgkmcnt(2)
v_mfma_f32_16x16x32_bf16 v[196:199],a[20:23],v[76:79],v[196:199]
ds_read_b128 v[72:75],v20 offset:14336
v_mfma_f32_16x16x32_bf16 v[204:207],v[76:79],a[148:151],v[204:207]
s_waitcnt lgkmcnt(2)
v_mfma_f32_16x16x32_bf16 v[192:195],a[24:27],v[64:67],v[192:195]
ds_read_b128 v[76:79],v20 offset:15360
v_mfma_f32_16x16x32_bf16 v[200:203],v[64:67],a[152:155],v[200:203]
s_waitcnt lgkmcnt(2)
v_mfma_f32_16x16x32_bf16 v[196:199],a[24:27],v[68:71],v[196:199]
ds_read_b128 v[64:67],v20 offset:16384
v_mfma_f32_16x16x32_bf16 v[204:207],v[68:71],a[152:155],v[204:207]
s_waitcnt lgkmcnt(2)
v_mfma_f32_16x16x32_bf16 v[192:195],a[28:31],v[72:75],v[192:195]
ds_read_b128 v[68:71],v20 offset:17408
v_mfma_f32_16x16x32_bf16 v[200:203],v[72:75],a[156:159],v[200:203]
s_waitcnt lgkmcnt(2)
v_mfma_f32_16x16x32_bf16 v[196:199],a[28:31],v[76:79],v[196:199]
ds_read_b128 v[72:75],v20 offset:18432
v_mfma_f32_16x16x32_bf16 v[204:207],v[76:79],a[156:159],v[204:207]
s_waitcnt lgkmcnt(2)
v_mfma_f32_16x16x32_bf16 v[192:195],a[32:35],v[64:67],v[192:195]
ds_read_b128 v[76:79],v20 offset:19456
v_mfma_f32_16x16x32_bf16 v[200:203],v[64:67],a[160:163],v[200:203]
s_waitcnt lgkmcnt(2)
v_mfma_f32_16x16x32_bf16 v[196:199],a[32:35],v[68:71],v[196:199]
ds_read_b128 v[64:67],v20 offset:20480
v_mfma_f32_16x16x32_bf16 v[204:207],v[68:71],a[160:163],v[204:207]
s_waitcnt lgkmcnt(2)
v_mfma_f32_16x16x32_bf16 v[192:195],a[36:39],v[72:75],v[192:195]
ds_read_b128 v[68:71],v20 offset:21504
v_mfma_f32_16x16x32_bf16 v[200:203],v[72:75],a[164:167],v[200:203]
s_waitcnt lgkmcnt(2)
v_mfma_f32_16x16x32_bf16 v[196:199],a[36:39],v[76:79],v[196:199]
ds_read_b128 v[72:75],v20 offset:22528
v_mfma_f32_16x16x32_bf16 v[204:207],v[76:79],a[164:167],v[204:207]
s_waitcnt lgkmcnt(2)
v_mfma_f32_16x16x32_bf16 v[192:195],a[40:43],v[64:67],v[192:195]
ds_read_b128 v[76:79],v20 offset:23552
v_mfma_f32_16x16x32_bf16 v[200:203],v[64:67],a[168:171],v[200:203]
s_waitcnt lgkmcnt(2)
v_mfma_f32_16x16x32_bf16 v[196:199],a[40:43],v[68:71],v[196:199]
ds_read_b128 v[64:67],v20 offset:24576
v_mfma_f32_16x16x32_bf16 v[204:207],v[68:71],a[168:171],v[204:207]
s_waitcnt lgkmcnt(2)
v_mfma_f32_16x16x32_bf16 v[192:195],a[44:47],v[72:75],v[192:195]
ds_read_b128 v[68:71],v20 offset:25600
v_mfma_f32_16x16x32_bf16 v[200:203],v[72:75],a[172:175],v[200:203]
s_waitcnt lgkmcnt(2)
v_mfma_f32_16x16x32_bf16 v[196:199],a[44:47],v[76:79],v[196:199]
ds_read_b128 v[72:75],v20 offset:26624
v_mfma_f32_16x16x32_bf16 v[204:207],v[76:79],a[172:175],v[204:207]
s_waitcnt lgkmcnt(2)
v_mfma_f32_16x16x32_bf16 v[192:195],a[48:51],v[64:67],v[192:195]
ds_read_b128 v[76:79],v20 offset:27648
v_mfma_f32_16x16x32_bf16 v[200:203],v[64:67],a[176:179],v[200:203]
s_waitcnt lgkmcnt(2)
v_mfma_f32_16x16x32_bf16 v[196:199],a[48:51],v[68:71],v[196:199]
ds_read_b128 v[64:67],v20 offset:28672
v_mfma_f32_16x16x32_bf16 v[204:207],v[68:71],a[176:179],v[204:207]
s_waitcnt lgkmcnt(2)
v_mfma_f32_16x16x32_bf16 v[192:195],a[52:55],v[72:75],v[192:195]
ds_read_b128 v[68:71],v20 offset:29696
v_mfma_f32_16x16x32_bf16 v[200:203],v[72:75],a[180:183],v[200:203]
s_waitcnt lgkmcnt(2)
v_mfma_f32_16x16x32_bf16 v[196:199],a[52:55],v[76:79],v[196:199]
ds_read_b128 v[72:75],v20 offset:30720
v_mfma_f32_16x16x32_bf16 v[204:207],v[76:79],a[180:183],v[204:207]
s_waitcnt lgkmcnt(2)
v_mfma_f32_16x16x32_bf16 v[192:195],a[56:59],v[64:67],v[192:195]
ds_read_b128 v[76:79],v20 offset:31744
v_mfma_f32_16x16x32_bf16 v[200:203],v[64:67],a[184:187],v[200:203]
s_waitcnt lgkmcnt(2)
v_mfma_f32_16x16x32_bf16 v[196:199],a[56:59],v[68:71],v[196:199]
ds_read_b128 v[64:67],v20 offset:32768
v_mfma_f32_16x16x32_bf16 v[204:207],v[68:71],a[184:187],v[204:207]
s_waitcnt lgkmcnt(2)
v_mfma_f32_16x16x32_bf16 v[192:195],a[60:63],v[72:75],v[192:195]
ds_read_b128 v[68:71],v20 offset:33792
v_mfma_f32_16x16x32_bf16 v[200:203],v[72:75],a[188:191],v[200:203]
s_waitcnt lgkmcnt(2)
v_mfma_f32_16x16x32_bf16 v[196:199],a[60:63],v[76:79],v[196:199]
ds_read_b128 v[72:75],v20 offset:34816
v_mfma_f32_16x16x32_bf16 v[204:207],v[76:79],a[188:191],v[204:207]
s_waitcnt lgkmcnt(2)
v_mfma_f32_16x16x32_bf16 v[192:195],a[64:67],v[64:67],v[192:195]
ds_read_b128 v[76:79],v20 offset:35840
v_mfma_f32_16x16x32_bf16 v[200:203],v[64:67],a[192:195],v[200:203]
s_waitcnt lgkmcnt(2)
v_mfma_f32_16x16x32_bf16 v[196:199],a[64:67],v[68:71],v[196:199]
ds_read_b128 v[64:67],v20 offset:36864
v_mfma_f32_16x16x32_bf16 v[204:207],v[68:71],a[192:195],v[204:207]
s_waitcnt lgkmcnt(2)
v_mfma_f32_16x16x32_bf16 v[192:195],a[68:71],v[72:75],v[192:195]
ds_read_b128 v[68:71],v20 offset:37888
v_mfma_f32_16x16x32_bf16 v[200:203],v[72:75],a[196:199],v[200:203]
s_waitcnt lgkmcnt(2)
v_mfma_f32_16x16x32_bf16 v[196:199],a[68:71],v[76:79],v[196:199]
ds_read_b128 v[72:75],v20 offset:38912
v_mfma_f32_16x16x32_bf16 v[204:207],v[76:79],a[196:199],v[204:207]
s_waitcnt lgkmcnt(2)
v_mfma_f32_16x16x32_bf16 v[192:195],a[72:75],v[64:67],v[192:195]
ds_read_b128 v[76:79],v20 offset:39936
v_mfma_f32_16x16x32_bf16 v[200:203],v[64:67],a[200:203],v[200:203]
s_waitcnt lgkmcnt(2)
v_mfma_f32_16x16x32_bf16 v[196:199],a[72:75],v[68:71],v[196:199]
ds_read_b128 v[64:67],v20 offset:40960
v_mfma_f32_16x16x32_bf16 v[204:207],v[68:71],a[200:203],v[204:207]
s_waitcnt lgkmcnt(2)
v_mfma_f32_16x16x32_bf16 v[192:195],a[76:79],v[72:75],v[192:195]
ds_read_b128 v[68:71],v20 offset:41984
v_mfma_f32_16x16x32_bf16 v[200:203],v[72:75],a[204:207],v[200:203]
s_waitcnt lgkmcnt(2)
v_mfma_f32_16x16x32_bf16 v[196:199],a[76:79],v[76:79],v[196:199]
ds_read_b128 v[72:75],v20 offset:43008
v_mfma_f32_16x16x32_bf16 v[204:207],v[76:79],a[204:207],v[204:207]
s_waitcnt lgkmcnt(2)
v_mfma_f32_16x16x32_bf16 v[192:195],a[80:83],v[64:67],v[192:195]
ds_read_b128 v[76:79],v20 offset:44032
v_mfma_f32_16x16x32_bf16 v[200:203],v[64:67],a[208:211],v[200:203]
s_waitcnt lgkmcnt(2)
v_mfma_f32_16x16x32_bf16 v[196:199],a[80:83],v[68:71],v[196:199]
ds_read_b128 v[64:67],v20 offset:45056
v_mfma_f32_16x16x32_bf16 v[204:207],v[68:71],a[208:211],v[204:207]
s_waitcnt lgkmcnt(2)
v_mfma_f32_16x16x32_bf16 v[192:195],a[84:87],v[72:75],v[192:195]
ds_read_b128 v[68:71],v20 offset:46080
v_mfma_f32_16x16x32_bf16 v[200:203],v[72:75],a[212:215],v[200:203]
s_waitcnt lgkmcnt(2)
v_mfma_f32_16x16x32_bf16 v[196:199],a[84:87],v[76:79],v[196:199]
ds_read_b128 v[72:75],v20 offset:47104
v_mfma_f32_16x16x32_bf16 v[204:207],v[76:79],a[212:215],v[204:207]
s_waitcnt lgkmcnt(2)
v_mfma_f32_16x16x32_bf16 v[192:195],a[88:91],v[64:67],v[192:195]
ds_read_b128 v[76:79],v20 offset:48128
v_mfma_f32_16x16x32_bf16 v[200:203],v[64:67],a[216:219],v[200:203]
s_waitcnt lgkmcnt(2)
v_mfma_f32_16x16x32_bf16 v[196:199],a[88:91],v[68:71],v[196:199]
ds_read_b128 v[64:67],v20 offset:49152
v_mfma_f32_16x16x32_bf16 v[204:207],v[68:71],a[216:219],v[204:207]
s_waitcnt lgkmcnt(2)
v_mfma_f32_16x16x32_bf16 v[192:195],a[92:95],v[72:75],v[192:195]
ds_read_b128 v[68:71],v20 offset:50176
v_mfma_f32_16x16x32_bf16 v[200:203],v[72:75],a[220:223],v[200:203]
s_waitcnt lgkmcnt(2)
v_mfma_f32_16x16x32_bf16 v[196:199],a[92:95],v[76:79],v[196:199]
ds_read_b128 v[72:75],v20 offset:51200
v_mfma_f32_16x16x32_bf16 v[204:207],v[76:79],a[220:223],v[204:207]
s_waitcnt lgkmcnt(2)
v_mfma_f32_16x16x32_bf16 v[192:195],a[96:99],v[64:67],v[192:195]
ds_read_b128 v[76:79],v20 offset:52224
v_mfma_f32_16x16x32_bf16 v[200:203],v[64:67],a[224:227],v[200:203]
s_waitcnt lgkmcnt(2)
v_mfma_f32_16x16x32_bf16 v[196:199],a[96:99],v[68:71],v[196:199]
ds_read_b128 v[64:67],v20 offset:53248
v_mfma_f32_16x16x32_bf16 v[204:207],v[68:71],a[224:227],v[204:207]
s_waitcnt lgkmcnt(2)
v_mfma_f32_16x16x32_bf16 v[192:195],a[100:103],v[72:75],v[192:195]
ds_read_b128 v[68:71],v20 offset:54272
v_mfma_f32_16x16x32_bf16 v[200:203],v[72:75],a[228:231],v[200:203]
s_waitcnt lgkmcnt(2)
v_mfma_f32_16x16x32_bf16 v[196:199],a[100:103],v[76:79],v[196:199]
ds_read_b128 v[72:75],v20 offset:55296
v_mfma_f32_16x16x32_bf16 v[204:207],v[76:79],a[228:231],v[204:207]
s_waitcnt lgkmcnt(2)
v_mfma_f32_16x16x32_bf16 v[192:195],a[104:107],v[64:67],v[192:195]
ds_read_b128 v[76:79],v20 offset:56320
v_mfma_f32_16x16x32_bf16 v[200:203],v[64:67],a[232:235],v[200:203]
s_waitcnt lgkmcnt(2)
v_mfma_f32_16x16x32_bf16 v[196:199],a[104:107],v[68:71],v[196:199]
ds_read_b128 v[64:67],v20 offset:57344
v_mfma_f32_16x16x32_bf16 v[204:207],v[68:71],a[232:235],v[204:207]
s_waitcnt lgkmcnt(2)
v_mfma_f32_16x16x32_bf16 v[192:195],a[108:111],v[72:75],v[192:195]
ds_read_b128 v[68:71],v20 offset:58368
v_mfma_f32_16x16x32_bf16 v[200:203],v[72:75],a[236:239],v[200:203]
s_waitcnt lgkmcnt(2)
v_mfma_f32_16x16x32_bf16 v[196:199],a[108:111],v[76:79],v[196:199]
ds_read_b128 v[72:75],v20 offset:59392
v_mfma_f32_16x16x32_bf16 v[204:207],v[76:79],a[236:239],v[204:207]
s_waitcnt lgkmcnt(2)
v_mfma_f32_16x16x32_bf16 v[192:195],a[112:115],v[64:67],v[192:195]
ds_read_b128 v[76:79],v20 offset:60416
v_mfma_f32_16x16x32_bf16 v[200:203],v[64:67],a[240:243],v[200:203]
s_waitcnt lgkmcnt(2)
v_mfma_f32_16x16x32_bf16 v[196:199],a[112:115],v[68:71],v[196:199]
ds_read_b128 v[64:67],v20 offset:61440
v_mfma_f32_16x16x32_bf16 v[204:207],v[68:71],a[240:243],v[204:207]
s_waitcnt lgkmcnt(2)
v_mfma_f32_16x16x32_bf16 v[192:195],a[116:119],v[72:75],v[192:195]
ds_read_b128 v[68:71],v20 offset:62464
v_mfma_f32_16x16x32_bf16 v[200:203],v[72:75],a[244:247],v[200:203]
s_waitcnt lgkmcnt(2)
v_mfma_f32_16x16x32_bf16 v[196:199],a[116:119],v[76:79],v[196:199]
ds_read_b128 v[72:75],v20 offset:63488
v_mfma_f32_16x16x32_bf16 v[204:207],v[76:79],a[244:247],v[204:207]
s_waitcnt lgkmcnt(2)
v_mfma_f32_16x16x32_bf16 v[192:195],a[120:123],v[64:67],v[192:195]
ds_read_b128 v[76:79],v20 offset:64512
v_mfma_f32_16x16x32_bf16 v[200:203],v[64:67],a[248:251],v[200:203]
s_waitcnt lgkmcnt(2)
v_mfma_f32_16x16x32_bf16 v[196:199],a[120:123],v[68:71],v[196:199]
v_mfma_f32_16x16x32_bf16 v[204:207],v[68:71],a[248:251],v[204:207]
s_waitcnt lgkmcnt(1)
v_mfma_f32_16x16x32_bf16 v[192:195],a[124:127],v[72:75],v[192:195]
v_mfma_f32_16x16x32_bf16 v[200:203],v[72:75],a[252:255],v[200:203]
s_waitcnt lgkmcnt(0)
v_mfma_f32_16x16x32_bf16 v[196:199],a[124:127],v[76:79],v[196:199]
v_mfma_f32_16x16x32_bf16 v[204:207],v[76:79],a[252:255],v[204:207]
v_xor_b32 v20,0x10000,v20
s_xor_b32 s62,s62,0x10000
s_lshr_b32 s64,s73,9
v_add_u32 v22,s64,v24
v_cvt_pk_bf16_f32 v208,v192,v193
v_cvt_pk_bf16_f32 v209,v194,v195
s_nop 0
v_cvt_pk_bf16_f32 v210,v196,v197
v_cvt_pk_bf16_f32 v211,v198,v199
v_cvt_pk_bf16_f32 v212,v200,v201
v_cvt_pk_bf16_f32 v213,v202,v203
v_cvt_pk_bf16_f32 v214,v204,v205
v_cvt_pk_bf16_f32 v215,v206,v207
v_permlane16_swap_b32 v208,v210
v_permlane16_swap_b32 v209,v211
buffer_store_dwordx4 v[208:211],v2,s[24:27],s73 offen
buffer_store_dwordx4 v[208:211],v2,s[28:31],s73 offen sc1
ds_write_b128 v22,v[212:215] offset:16384
buffer_store_dwordx4 v[208:211],v17,s[20:23],s12 offen sc1
bgx_134:
s_add_u32 s63,s79,1
s_and_b32 s64,s63,3
s_lshl_b32 s70,s64,20
s_add_u32 s65,s63,2
s_and_b32 s65,s65,3
s_lshl_b32 s73,s65,20
s_add_u32 s55,s63,3
s_lshl_b32 s78,s55,16
s_add_u32 s78,s78,57344
s_cmp_lt_u32 s55,64
s_cselect_b32 s78,s78,0x7fff0000
s_add_u32 s60,s63,1
s_lshl_b32 s76,s60,21
s_lshl_b32 s55,s60,13
s_and_b32 s55,s55,0x2000
s_xor_b32 s55,s55,s61
s_add_u32 s76,s76,s55
s_cmp_lt_u32 s60,64
s_cselect_b32 s76,s76,0x7fff0000
s_add_u32 s60,s63,2
s_lshl_b32 s12,s60,21
s_lshl_b32 s55,s60,13
s_and_b32 s55,s55,0x2000
s_xor_b32 s55,s55,s61
s_add_u32 s12,s12,s55
s_cmp_lt_u32 s60,64
s_cselect_b32 s12,s12,0x7fff0000
s_add_u32 s71,s73,65536
v_mov_b32 v176,0
v_mov_b32 v177,0
v_mov_b32 v178,0
v_mov_b32 v179,0
v_mov_b32 v180,0
v_mov_b32 v181,0
v_mov_b32 v182,0
v_mov_b32 v183,0
s_add_u32 s79,s79,1
s_cmp_eq_u32 s79,0
s_cbranch_scc1 pn2_133
v_mov_b32 v38,1
ds_write_b32 v37,v38 offset:8
buffer_store_dwordx4 v[212:215],v12,s[20:23],s76 offen sc1
s_waitcnt lgkmcnt(0)
s_branch pn1_132
pn2_133:
v_mov_b32 v25,1
s_waitcnt vmcnt(1) lgkmcnt(0)
s_barrier
s_branch loop_124
w2_60:
s_lshr_b32 s64,s57,2
s_add_u32 s64,s64,64
s_lshl_b32 s64,s64,14
s_add_u32 s64,s64,s68
s_add_u32 s64,s64,29361152
v_add_u32 v12,s64,v16
v_and_b32 v22,1,v4
v_lshrrev_b32 v23,1,v4
v_lshl_add_u32 v22,v22,1,v23
v_lshlrev_b32 v22,2,v22
v_lshl_add_u32 v22,v3,4,v22
v_add_u32 v31,155904,v22
s_branch first_135
loop_136:
s_barrier
hl_138:
buffer_load_dword v248,v18,s[20:23],s70 offen offset:0 sc1
s_waitcnt vmcnt(0)
v_cmp_eq_u32 vcc,v25,v248
s_bcnt1_i32_b32 s64,vcc_lo
s_cmp_ge_u32 s64,8
s_cbranch_scc1 hg_139
s_sub_u32 s90,s90,1
s_cmp_gt_i32 s90,0
s_cbranch_scc1 hl_138
hg_139:
buffer_load_dwordx4 v[64:67],v28,s[20:23],s70 offen offset:0 sc1
buffer_load_dwordx4 v[68:71],v28,s[20:23],s70 offen offset:1024 sc1
buffer_load_dwordx4 v[72:75],v28,s[20:23],s70 offen offset:2048 sc1
buffer_load_dwordx4 v[76:79],v28,s[20:23],s70 offen offset:3072 sc1
s_waitcnt vmcnt(3)
ds_write_b128 v24,v[64:67] offset:8192
v_min3_u32 v22,v64,v65,v66
v_min_u32 v22,v22,v67
s_waitcnt vmcnt(2)
ds_write_b128 v24,v[68:71] offset:9216
v_min3_u32 v22,v22,v68,v69
v_min3_u32 v22,v22,v70,v71
s_waitcnt vmcnt(1)
ds_write_b128 v24,v[72:75] offset:10240
v_min3_u32 v22,v22,v72,v73
v_min3_u32 v22,v22,v74,v75
s_waitcnt vmcnt(0)
ds_write_b128 v24,v[76:79] offset:11264
v_min3_u32 v22,v22,v76,v77
v_min3_u32 v22,v22,v78,v79
v_cmp_eq_u32 vcc,0,v22
s_cbranch_vccnz art_140
abk_141:
v_smfmac_f32_16x16x64_bf16 v[176:179],v[64:67],a[64:71],v14
s_waitcnt lgkmcnt(0)
s_barrier
ds_read_b128 v[80:83],v24 offset:12288
ds_read_b128 v[84:87],v24 offset:13312
ds_read_b128 v[88:91],v24 offset:14336
ds_read_b128 v[92:95],v24 offset:15360
buffer_store_dwordx4 v[212:215],v12,s[20:23],s76 offen sc1
v_smfmac_f32_16x16x64_bf16 v[176:179],v[68:71],a[72:79],v14
ds_read_b128 v[32:35],v24 offset:0
ds_read_b128 v[36:39],v24 offset:1024
v_smfmac_f32_16x16x64_bf16 v[176:179],v[72:75],a[80:87],v14
ds_read_b128 v[40:43],v24 offset:2048
ds_read_b128 v[44:47],v24 offset:3072
v_smfmac_f32_16x16x64_bf16 v[176:179],v[76:79],a[88:95],v14
ds_read_b128 v[48:51],v24 offset:4096
ds_read_b128 v[52:55],v24 offset:5120
s_waitcnt lgkmcnt(9)
v_smfmac_f32_16x16x64_bf16 v[176:179],v[80:83],a[96:103],v14
ds_read_b128 v[56:59],v24 offset:6144
s_waitcnt lgkmcnt(9)
v_smfmac_f32_16x16x64_bf16 v[176:179],v[84:87],a[104:111],v14
ds_read_b128 v[60:63],v24 offset:7168
s_waitcnt lgkmcnt(9)
v_smfmac_f32_16x16x64_bf16 v[176:179],v[88:91],a[112:119],v14
s_waitcnt lgkmcnt(8)
v_smfmac_f32_16x16x64_bf16 v[176:179],v[92:95],a[120:127],v14
s_waitcnt lgkmcnt(7)
v_smfmac_f32_16x16x64_bf16 v[176:179],v[32:35],a[0:7],v14
s_waitcnt lgkmcnt(6)
v_smfmac_f32_16x16x64_bf16 v[176:179],v[36:39],a[8:15],v14
s_waitcnt lgkmcnt(5)
v_smfmac_f32_16x16x64_bf16 v[176:179],v[40:43],a[16:23],v14
s_waitcnt lgkmcnt(4)
v_smfmac_f32_16x16x64_bf16 v[176:179],v[44:47],a[24:31],v14
s_waitcnt lgkmcnt(3)
v_smfmac_f32_16x16x64_bf16 v[176:179],v[48:51],a[32:39],v14
s_waitcnt lgkmcnt(2)
v_smfmac_f32_16x16x64_bf16 v[176:179],v[52:55],a[40:47],v14
s_waitcnt lgkmcnt(1)
v_smfmac_f32_16x16x64_bf16 v[176:179],v[56:59],a[48:55],v14
s_waitcnt lgkmcnt(0)
v_smfmac_f32_16x16x64_bf16 v[176:179],v[60:63],a[56:63],v14
v_smfmac_f32_16x16x64_bf16 v[180:183],v[32:35],a[128:135],v14
v_smfmac_f32_16x16x64_bf16 v[180:183],v[36:39],a[136:143],v14
s_nop 5
v_permlane32_swap_b32 v176,v178
v_permlane32_swap_b32 v177,v179
v_add_f32 v176,v176,v178
v_add_f32 v177,v177,v179
v_cvt_pk_bf16_f32 v216,v176,v177
s_nop 1
v_mov_b32_dpp v217,v216 quad_perm:[1,0,3,2] row_mask:0xf bank_mask:0xf
v_perm_b32 v216,v217,v216,v15
v_max_u32 v216,1,v216
buffer_store_dword v216,v19,s[24:27],s70 offen
buffer_store_dword v216,v19,s[28:31],s70 offen sc1
v_smfmac_f32_16x16x64_bf16 v[180:183],v[40:43],a[144:151],v14
v_smfmac_f32_16x16x64_bf16 v[180:183],v[44:47],a[152:159],v14
v_smfmac_f32_16x16x64_bf16 v[180:183],v[48:51],a[160:167],v14
v_smfmac_f32_16x16x64_bf16 v[180:183],v[52:55],a[168:175],v14
v_smfmac_f32_16x16x64_bf16 v[180:183],v[56:59],a[176:183],v14
v_smfmac_f32_16x16x64_bf16 v[180:183],v[60:63],a[184:191],v14
v_smfmac_f32_16x16x64_bf16 v[180:183],v[64:67],a[192:199],v14
v_smfmac_f32_16x16x64_bf16 v[180:183],v[68:71],a[200:207],v14
v_smfmac_f32_16x16x64_bf16 v[180:183],v[72:75],a[208:215],v14
v_smfmac_f32_16x16x64_bf16 v[180:183],v[76:79],a[216:223],v14
v_smfmac_f32_16x16x64_bf16 v[180:183],v[80:83],a[224:231],v14
v_smfmac_f32_16x16x64_bf16 v[180:183],v[84:87],a[232:239],v14
v_smfmac_f32_16x16x64_bf16 v[180:183],v[88:91],a[240:247],v14
v_smfmac_f32_16x16x64_bf16 v[180:183],v[92:95],a[248:255],v14
s_nop 7
v_permlane32_swap_b32 v180,v182
v_permlane32_swap_b32 v181,v183
v_add_f32 v180,v180,v182
v_add_f32 v181,v181,v183
v_cvt_pk_bf16_f32 v216,v180,v181
v_max_u32 v216,1,v216
ds_write_b32 v31,v216
ds_write_b32 v21,v25 offset:4
s_cmp_eq_u32 s79,63
s_cbranch_scc1 end_57
s_cmp_ge_i32 s79,62
s_cbranch_scc1 bgsk_143
ds_read_b128 v[64:67],v20 offset:0
ds_read_b128 v[68:71],v20 offset:1024
ds_read_b128 v[72:75],v20 offset:2048
s_waitcnt lgkmcnt(2)
v_mfma_f32_16x16x32_bf16 v[192:195],a[0:3],v[64:67],0
ds_read_b128 v[76:79],v20 offset:3072
v_mfma_f32_16x16x32_bf16 v[200:203],v[64:67],a[128:131],0
s_waitcnt lgkmcnt(2)
v_mfma_f32_16x16x32_bf16 v[196:199],a[0:3],v[68:71],0
ds_read_b128 v[64:67],v20 offset:4096
v_mfma_f32_16x16x32_bf16 v[204:207],v[68:71],a[128:131],0
s_waitcnt lgkmcnt(2)
v_mfma_f32_16x16x32_bf16 v[192:195],a[4:7],v[72:75],v[192:195]
ds_read_b128 v[68:71],v20 offset:5120
v_mfma_f32_16x16x32_bf16 v[200:203],v[72:75],a[132:135],v[200:203]
s_waitcnt lgkmcnt(2)
v_mfma_f32_16x16x32_bf16 v[196:199],a[4:7],v[76:79],v[196:199]
ds_read_b128 v[72:75],v20 offset:6144
v_mfma_f32_16x16x32_bf16 v[204:207],v[76:79],a[132:135],v[204:207]
s_waitcnt lgkmcnt(2)
v_mfma_f32_16x16x32_bf16 v[192:195],a[8:11],v[64:67],v[192:195]
ds_read_b128 v[76:79],v20 offset:7168
v_mfma_f32_16x16x32_bf16 v[200:203],v[64:67],a[136:139],v[200:203]
s_waitcnt lgkmcnt(2)
v_mfma_f32_16x16x32_bf16 v[196:199],a[8:11],v[68:71],v[196:199]
ds_read_b128 v[64:67],v20 offset:8192
v_mfma_f32_16x16x32_bf16 v[204:207],v[68:71],a[136:139],v[204:207]
s_waitcnt lgkmcnt(2)
v_mfma_f32_16x16x32_bf16 v[192:195],a[12:15],v[72:75],v[192:195]
ds_read_b128 v[68:71],v20 offset:9216
v_mfma_f32_16x16x32_bf16 v[200:203],v[72:75],a[140:143],v[200:203]
s_waitcnt lgkmcnt(2)
v_mfma_f32_16x16x32_bf16 v[196:199],a[12:15],v[76:79],v[196:199]
ds_read_b128 v[72:75],v20 offset:10240
v_mfma_f32_16x16x32_bf16 v[204:207],v[76:79],a[140:143],v[204:207]
s_add_u32 m0,s62,16384
s_add_u32 s69,s78,16384
s_waitcnt lgkmcnt(2)
v_mfma_f32_16x16x32_bf16 v[192:195],a[16:19],v[64:67],v[192:195]
ds_read_b128 v[76:79],v20 offset:11264
v_mfma_f32_16x16x32_bf16 v[200:203],v[64:67],a[144:147],v[200:203]
buffer_load_dwordx4 v16,s[20:23],s69 offen offset:0 lds
s_waitcnt lgkmcnt(2)
v_mfma_f32_16x16x32_bf16 v[196:199],a[16:19],v[68:71],v[196:199]
ds_read_b128 v[64:67],v20 offset:12288
v_mfma_f32_16x16x32_bf16 v[204:207],v[68:71],a[144:147],v[204:207]
buffer_load_dwordx4 v16,s[20:23],s69 offen offset:1024 lds
s_waitcnt lgkmcnt(2)
v_mfma_f32_16x16x32_bf16 v[192:195],a[20:23],v[72:75],v[192:195]
ds_read_b128 v[68:71],v20 offset:13312
v_mfma_f32_16x16x32_bf16 v[200:203],v[72:75],a[148:151],v[200:203]
buffer_load_dwordx4 v16,s[20:23],s69 offen offset:2048 lds
s_waitcnt lgkmcnt(2)
v_mfma_f32_16x16x32_bf16 v[196:199],a[20:23],v[76:79],v[196:199]
ds_read_b128 v[72:75],v20 offset:14336
v_mfma_f32_16x16x32_bf16 v[204:207],v[76:79],a[148:151],v[204:207]
buffer_load_dwordx4 v16,s[20:23],s69 offen offset:3072 lds
s_waitcnt lgkmcnt(2)
v_mfma_f32_16x16x32_bf16 v[192:195],a[24:27],v[64:67],v[192:195]
ds_read_b128 v[76:79],v20 offset:15360
v_mfma_f32_16x16x32_bf16 v[200:203],v[64:67],a[152:155],v[200:203]
s_add_u32 m0,s62,20480
s_add_u32 s69,s78,20480
s_waitcnt lgkmcnt(2)
v_mfma_f32_16x16x32_bf16 v[196:199],a[24:27],v[68:71],v[196:199]
ds_read_b128 v[64:67],v20 offset:16384
v_mfma_f32_16x16x32_bf16 v[204:207],v[68:71],a[152:155],v[204:207]
buffer_load_dwordx4 v16,s[20:23],s69 offen offset:0 lds
s_waitcnt lgkmcnt(2)
v_mfma_f32_16x16x32_bf16 v[192:195],a[28:31],v[72:75],v[192:195]
ds_read_b128 v[68:71],v20 offset:17408
v_mfma_f32_16x16x32_bf16 v[200:203],v[72:75],a[156:159],v[200:203]
buffer_load_dwordx4 v16,s[20:23],s69 offen offset:1024 lds
s_waitcnt lgkmcnt(2)
v_mfma_f32_16x16x32_bf16 v[196:199],a[28:31],v[76:79],v[196:199]
ds_read_b128 v[72:75],v20 offset:18432
v_mfma_f32_16x16x32_bf16 v[204:207],v[76:79],a[156:159],v[204:207]
buffer_load_dwordx4 v16,s[20:23],s69 offen offset:2048 lds
s_waitcnt lgkmcnt(2)
v_mfma_f32_16x16x32_bf16 v[192:195],a[32:35],v[64:67],v[192:195]
ds_read_b128 v[76:79],v20 offset:19456
v_mfma_f32_16x16x32_bf16 v[200:203],v[64:67],a[160:163],v[200:203]
buffer_load_dwordx4 v16,s[20:23],s69 offen offset:3072 lds
s_waitcnt lgkmcnt(2)
v_mfma_f32_16x16x32_bf16 v[196:199],a[32:35],v[68:71],v[196:199]
ds_read_b128 v[64:67],v20 offset:20480
v_mfma_f32_16x16x32_bf16 v[204:207],v[68:71],a[160:163],v[204:207]
s_add_u32 m0,s62,24576
s_add_u32 s69,s78,24576
s_waitcnt lgkmcnt(2)
v_mfma_f32_16x16x32_bf16 v[192:195],a[36:39],v[72:75],v[192:195]
ds_read_b128 v[68:71],v20 offset:21504
v_mfma_f32_16x16x32_bf16 v[200:203],v[72:75],a[164:167],v[200:203]
buffer_load_dwordx4 v16,s[20:23],s69 offen offset:0 lds
s_waitcnt lgkmcnt(2)
v_mfma_f32_16x16x32_bf16 v[196:199],a[36:39],v[76:79],v[196:199]
ds_read_b128 v[72:75],v20 offset:22528
v_mfma_f32_16x16x32_bf16 v[204:207],v[76:79],a[164:167],v[204:207]
buffer_load_dwordx4 v16,s[20:23],s69 offen offset:1024 lds
s_waitcnt lgkmcnt(2)
v_mfma_f32_16x16x32_bf16 v[192:195],a[40:43],v[64:67],v[192:195]
ds_read_b128 v[76:79],v20 offset:23552
v_mfma_f32_16x16x32_bf16 v[200:203],v[64:67],a[168:171],v[200:203]
buffer_load_dwordx4 v16,s[20:23],s69 offen offset:2048 lds
s_waitcnt lgkmcnt(2)
v_mfma_f32_16x16x32_bf16 v[196:199],a[40:43],v[68:71],v[196:199]
ds_read_b128 v[64:67],v20 offset:24576
v_mfma_f32_16x16x32_bf16 v[204:207],v[68:71],a[168:171],v[204:207]
buffer_load_dwordx4 v16,s[20:23],s69 offen offset:3072 lds
s_waitcnt lgkmcnt(2)
v_mfma_f32_16x16x32_bf16 v[192:195],a[44:47],v[72:75],v[192:195]
ds_read_b128 v[68:71],v20 offset:25600
v_mfma_f32_16x16x32_bf16 v[200:203],v[72:75],a[172:175],v[200:203]
s_add_u32 m0,s62,28672
s_add_u32 s69,s78,28672
s_waitcnt lgkmcnt(2)
v_mfma_f32_16x16x32_bf16 v[196:199],a[44:47],v[76:79],v[196:199]
ds_read_b128 v[72:75],v20 offset:26624
v_mfma_f32_16x16x32_bf16 v[204:207],v[76:79],a[172:175],v[204:207]
buffer_load_dwordx4 v16,s[20:23],s69 offen offset:0 lds
s_waitcnt lgkmcnt(2)
v_mfma_f32_16x16x32_bf16 v[192:195],a[48:51],v[64:67],v[192:195]
ds_read_b128 v[76:79],v20 offset:27648
v_mfma_f32_16x16x32_bf16 v[200:203],v[64:67],a[176:179],v[200:203]
buffer_load_dwordx4 v16,s[20:23],s69 offen offset:1024 lds
s_waitcnt lgkmcnt(2)
v_mfma_f32_16x16x32_bf16 v[196:199],a[48:51],v[68:71],v[196:199]
ds_read_b128 v[64:67],v20 offset:28672
v_mfma_f32_16x16x32_bf16 v[204:207],v[68:71],a[176:179],v[204:207]
buffer_load_dwordx4 v16,s[20:23],s69 offen offset:2048 lds
s_waitcnt lgkmcnt(2)
v_mfma_f32_16x16x32_bf16 v[192:195],a[52:55],v[72:75],v[192:195]
ds_read_b128 v[68:71],v20 offset:29696
v_mfma_f32_16x16x32_bf16 v[200:203],v[72:75],a[180:183],v[200:203]
buffer_load_dwordx4 v16,s[20:23],s69 offen offset:3072 lds
s_waitcnt lgkmcnt(2)
v_mfma_f32_16x16x32_bf16 v[196:199],a[52:55],v[76:79],v[196:199]
ds_read_b128 v[72:75],v20 offset:30720
v_mfma_f32_16x16x32_bf16 v[204:207],v[76:79],a[180:183],v[204:207]
s_waitcnt lgkmcnt(2)
v_mfma_f32_16x16x32_bf16 v[192:195],a[56:59],v[64:67],v[192:195]
ds_read_b128 v[76:79],v20 offset:31744
v_mfma_f32_16x16x32_bf16 v[200:203],v[64:67],a[184:187],v[200:203]
s_waitcnt lgkmcnt(2)
v_mfma_f32_16x16x32_bf16 v[196:199],a[56:59],v[68:71],v[196:199]
ds_read_b128 v[64:67],v20 offset:32768
v_mfma_f32_16x16x32_bf16 v[204:207],v[68:71],a[184:187],v[204:207]
s_waitcnt lgkmcnt(2)
v_mfma_f32_16x16x32_bf16 v[192:195],a[60:63],v[72:75],v[192:195]
ds_read_b128 v[68:71],v20 offset:33792
v_mfma_f32_16x16x32_bf16 v[200:203],v[72:75],a[188:191],v[200:203]
s_waitcnt lgkmcnt(2)
v_mfma_f32_16x16x32_bf16 v[196:199],a[60:63],v[76:79],v[196:199]
ds_read_b128 v[72:75],v20 offset:34816
v_mfma_f32_16x16x32_bf16 v[204:207],v[76:79],a[188:191],v[204:207]
s_waitcnt lgkmcnt(2)
v_mfma_f32_16x16x32_bf16 v[192:195],a[64:67],v[64:67],v[192:195]
ds_read_b128 v[76:79],v20 offset:35840
v_mfma_f32_16x16x32_bf16 v[200:203],v[64:67],a[192:195],v[200:203]
s_waitcnt lgkmcnt(2)
v_mfma_f32_16x16x32_bf16 v[196:199],a[64:67],v[68:71],v[196:199]
ds_read_b128 v[64:67],v20 offset:36864
v_mfma_f32_16x16x32_bf16 v[204:207],v[68:71],a[192:195],v[204:207]
s_waitcnt lgkmcnt(2)
v_mfma_f32_16x16x32_bf16 v[192:195],a[68:71],v[72:75],v[192:195]
ds_read_b128 v[68:71],v20 offset:37888
v_mfma_f32_16x16x32_bf16 v[200:203],v[72:75],a[196:199],v[200:203]
s_waitcnt lgkmcnt(2)
v_mfma_f32_16x16x32_bf16 v[196:199],a[68:71],v[76:79],v[196:199]
ds_read_b128 v[72:75],v20 offset:38912
v_mfma_f32_16x16x32_bf16 v[204:207],v[76:79],a[196:199],v[204:207]
s_waitcnt lgkmcnt(2)
v_mfma_f32_16x16x32_bf16 v[192:195],a[72:75],v[64:67],v[192:195]
ds_read_b128 v[76:79],v20 offset:39936
v_mfma_f32_16x16x32_bf16 v[200:203],v[64:67],a[200:203],v[200:203]
s_waitcnt lgkmcnt(2)
v_mfma_f32_16x16x32_bf16 v[196:199],a[72:75],v[68:71],v[196:199]
ds_read_b128 v[64:67],v20 offset:40960
v_mfma_f32_16x16x32_bf16 v[204:207],v[68:71],a[200:203],v[204:207]
s_waitcnt lgkmcnt(2)
v_mfma_f32_16x16x32_bf16 v[192:195],a[76:79],v[72:75],v[192:195]
ds_read_b128 v[68:71],v20 offset:41984
v_mfma_f32_16x16x32_bf16 v[200:203],v[72:75],a[204:207],v[200:203]
s_waitcnt lgkmcnt(2)
v_mfma_f32_16x16x32_bf16 v[196:199],a[76:79],v[76:79],v[196:199]
ds_read_b128 v[72:75],v20 offset:43008
v_mfma_f32_16x16x32_bf16 v[204:207],v[76:79],a[204:207],v[204:207]
s_waitcnt lgkmcnt(2)
v_mfma_f32_16x16x32_bf16 v[192:195],a[80:83],v[64:67],v[192:195]
ds_read_b128 v[76:79],v20 offset:44032
v_mfma_f32_16x16x32_bf16 v[200:203],v[64:67],a[208:211],v[200:203]
s_waitcnt lgkmcnt(2)
v_mfma_f32_16x16x32_bf16 v[196:199],a[80:83],v[68:71],v[196:199]
ds_read_b128 v[64:67],v20 offset:45056
v_mfma_f32_16x16x32_bf16 v[204:207],v[68:71],a[208:211],v[204:207]
s_waitcnt lgkmcnt(2)
v_mfma_f32_16x16x32_bf16 v[192:195],a[84:87],v[72:75],v[192:195]
ds_read_b128 v[68:71],v20 offset:46080
v_mfma_f32_16x16x32_bf16 v[200:203],v[72:75],a[212:215],v[200:203]
s_waitcnt lgkmcnt(2)
v_mfma_f32_16x16x32_bf16 v[196:199],a[84:87],v[76:79],v[196:199]
ds_read_b128 v[72:75],v20 offset:47104
v_mfma_f32_16x16x32_bf16 v[204:207],v[76:79],a[212:215],v[204:207]
s_waitcnt lgkmcnt(2)
v_mfma_f32_16x16x32_bf16 v[192:195],a[88:91],v[64:67],v[192:195]
ds_read_b128 v[76:79],v20 offset:48128
v_mfma_f32_16x16x32_bf16 v[200:203],v[64:67],a[216:219],v[200:203]
s_waitcnt lgkmcnt(2)
v_mfma_f32_16x16x32_bf16 v[196:199],a[88:91],v[68:71],v[196:199]
ds_read_b128 v[64:67],v20 offset:49152
v_mfma_f32_16x16x32_bf16 v[204:207],v[68:71],a[216:219],v[204:207]
s_waitcnt lgkmcnt(2)
v_mfma_f32_16x16x32_bf16 v[192:195],a[92:95],v[72:75],v[192:195]
ds_read_b128 v[68:71],v20 offset:50176
v_mfma_f32_16x16x32_bf16 v[200:203],v[72:75],a[220:223],v[200:203]
s_waitcnt lgkmcnt(2)
v_mfma_f32_16x16x32_bf16 v[196:199],a[92:95],v[76:79],v[196:199]
ds_read_b128 v[72:75],v20 offset:51200
v_mfma_f32_16x16x32_bf16 v[204:207],v[76:79],a[220:223],v[204:207]
s_waitcnt lgkmcnt(2)
v_mfma_f32_16x16x32_bf16 v[192:195],a[96:99],v[64:67],v[192:195]
ds_read_b128 v[76:79],v20 offset:52224
v_mfma_f32_16x16x32_bf16 v[200:203],v[64:67],a[224:227],v[200:203]
s_waitcnt lgkmcnt(2)
v_mfma_f32_16x16x32_bf16 v[196:199],a[96:99],v[68:71],v[196:199]
ds_read_b128 v[64:67],v20 offset:53248
v_mfma_f32_16x16x32_bf16 v[204:207],v[68:71],a[224:227],v[204:207]
s_waitcnt lgkmcnt(2)
v_mfma_f32_16x16x32_bf16 v[192:195],a[100:103],v[72:75],v[192:195]
ds_read_b128 v[68:71],v20 offset:54272
s_add_u32 m0,s62,43008
s_add_u32 s69,s78,43008
v_mfma_f32_16x16x32_bf16 v[200:203],v[72:75],a[228:231],v[200:203]
s_waitcnt lgkmcnt(2)
v_mfma_f32_16x16x32_bf16 v[196:199],a[100:103],v[76:79],v[196:199]
ds_read_b128 v[72:75],v20 offset:55296
buffer_load_dwordx4 v16,s[20:23],s69 offen offset:0 lds
v_mfma_f32_16x16x32_bf16 v[204:207],v[76:79],a[228:231],v[204:207]
s_waitcnt lgkmcnt(2)
v_mfma_f32_16x16x32_bf16 v[192:195],a[104:107],v[64:67],v[192:195]
ds_read_b128 v[76:79],v20 offset:56320
buffer_load_dwordx4 v16,s[20:23],s69 offen offset:1024 lds
v_mfma_f32_16x16x32_bf16 v[200:203],v[64:67],a[232:235],v[200:203]
s_waitcnt lgkmcnt(2)
v_mfma_f32_16x16x32_bf16 v[196:199],a[104:107],v[68:71],v[196:199]
ds_read_b128 v[64:67],v20 offset:57344
buffer_load_dwordx4 v16,s[20:23],s69 offen offset:2048 lds
v_mfma_f32_16x16x32_bf16 v[204:207],v[68:71],a[232:235],v[204:207]
s_waitcnt lgkmcnt(2)
v_mfma_f32_16x16x32_bf16 v[192:195],a[108:111],v[72:75],v[192:195]
ds_read_b128 v[68:71],v20 offset:58368
buffer_load_dwordx4 v16,s[20:23],s69 offen offset:3072 lds
v_mfma_f32_16x16x32_bf16 v[200:203],v[72:75],a[236:239],v[200:203]
s_waitcnt lgkmcnt(2)
v_mfma_f32_16x16x32_bf16 v[196:199],a[108:111],v[76:79],v[196:199]
ds_read_b128 v[72:75],v20 offset:59392
s_add_u32 m0,s62,47104
s_add_u32 s69,s78,47104
v_mfma_f32_16x16x32_bf16 v[204:207],v[76:79],a[236:239],v[204:207]
s_waitcnt lgkmcnt(2)
v_mfma_f32_16x16x32_bf16 v[192:195],a[112:115],v[64:67],v[192:195]
ds_read_b128 v[76:79],v20 offset:60416
buffer_load_dwordx4 v16,s[20:23],s69 offen offset:0 lds
v_mfma_f32_16x16x32_bf16 v[200:203],v[64:67],a[240:243],v[200:203]
s_waitcnt lgkmcnt(2)
v_mfma_f32_16x16x32_bf16 v[196:199],a[112:115],v[68:71],v[196:199]
ds_read_b128 v[64:67],v20 offset:61440
v_mfma_f32_16x16x32_bf16 v[204:207],v[68:71],a[240:243],v[204:207]
buffer_load_dwordx4 v16,s[20:23],s69 offen offset:1024 lds
s_waitcnt lgkmcnt(2)
v_mfma_f32_16x16x32_bf16 v[192:195],a[116:119],v[72:75],v[192:195]
ds_read_b128 v[68:71],v20 offset:62464
v_mfma_f32_16x16x32_bf16 v[200:203],v[72:75],a[244:247],v[200:203]
buffer_load_dwordx4 v16,s[20:23],s69 offen offset:2048 lds
s_waitcnt lgkmcnt(2)
v_mfma_f32_16x16x32_bf16 v[196:199],a[116:119],v[76:79],v[196:199]
ds_read_b128 v[72:75],v20 offset:63488
v_mfma_f32_16x16x32_bf16 v[204:207],v[76:79],a[244:247],v[204:207]
buffer_load_dwordx4 v16,s[20:23],s69 offen offset:3072 lds
s_waitcnt lgkmcnt(2)
v_mfma_f32_16x16x32_bf16 v[192:195],a[120:123],v[64:67],v[192:195]
ds_read_b128 v[76:79],v20 offset:64512
v_mfma_f32_16x16x32_bf16 v[200:203],v[64:67],a[248:251],v[200:203]
s_add_u32 m0,s62,51200
s_add_u32 s69,s78,51200
s_waitcnt lgkmcnt(2)
v_mfma_f32_16x16x32_bf16 v[196:199],a[120:123],v[68:71],v[196:199]
v_mfma_f32_16x16x32_bf16 v[204:207],v[68:71],a[248:251],v[204:207]
buffer_load_dwordx4 v16,s[20:23],s69 offen offset:0 lds
s_waitcnt lgkmcnt(1)
v_mfma_f32_16x16x32_bf16 v[192:195],a[124:127],v[72:75],v[192:195]
v_mfma_f32_16x16x32_bf16 v[200:203],v[72:75],a[252:255],v[200:203]
buffer_load_dwordx4 v16,s[20:23],s69 offen offset:1024 lds
s_waitcnt lgkmcnt(0)
v_mfma_f32_16x16x32_bf16 v[196:199],a[124:127],v[76:79],v[196:199]
v_mfma_f32_16x16x32_bf16 v[204:207],v[76:79],a[252:255],v[204:207]
s_waitcnt vmcnt(26)
ds_write_b32 v21,v25 offset:28
v_xor_b32 v20,0x10000,v20
s_xor_b32 s62,s62,0x10000
s_lshr_b32 s64,s73,9
v_add_u32 v22,s64,v24
v_cvt_pk_bf16_f32 v208,v192,v193
v_cvt_pk_bf16_f32 v209,v194,v195
v_cvt_pk_bf16_f32 v210,v196,v197
v_cvt_pk_bf16_f32 v211,v198,v199
v_cvt_pk_bf16_f32 v212,v200,v201
v_cvt_pk_bf16_f32 v213,v202,v203
v_cvt_pk_bf16_f32 v214,v204,v205
v_cvt_pk_bf16_f32 v215,v206,v207
v_permlane16_swap_b32 v208,v210
v_permlane16_swap_b32 v209,v211
buffer_store_dwordx4 v[208:211],v2,s[24:27],s73 offen
buffer_store_dwordx4 v[208:211],v2,s[28:31],s73 offen sc1
ds_write_b128 v22,v[212:215] offset:17408
buffer_store_dwordx4 v[208:211],v17,s[20:23],s12 offen sc1
bgx_142:
s_waitcnt lgkmcnt(0)
s_andn2_b32 s64,s79,0x14
s_cmp_eq_u32 s64,2
s_cbranch_scc1 late_144
lateb_145:
s_buffer_load_dword s48,s[20:23],s80 offset:0
s_buffer_load_dword s48,s[20:23],s80 offset:64
s_buffer_load_dword s48,s[20:23],s80 offset:128
s_buffer_load_dword s48,s[20:23],s80 offset:192
s_buffer_load_dword s48,s[20:23],s80 offset:256
s_buffer_load_dword s48,s[20:23],s80 offset:320
s_buffer_load_dword s48,s[20:23],s80 offset:384
s_buffer_load_dword s48,s[20:23],s80 offset:448
s_buffer_load_dword s48,s[20:23],s80 offset:512
s_buffer_load_dword s48,s[20:23],s80 offset:576
s_buffer_load_dword s48,s[20:23],s80 offset:640
s_buffer_load_dword s48,s[20:23],s80 offset:704
s_buffer_load_dword s48,s[20:23],s80 offset:768
s_buffer_load_dword s48,s[20:23],s80 offset:832
s_buffer_load_dword s48,s[20:23],s80 offset:896
s_buffer_load_dword s48,s[20:23],s80 offset:960
s_buffer_load_dword s48,s[20:23],s80 offset:1024
s_buffer_load_dword s48,s[20:23],s80 offset:1088
s_buffer_load_dword s48,s[20:23],s80 offset:1152
s_buffer_load_dword s48,s[20:23],s80 offset:1216
s_buffer_load_dword s48,s[20:23],s80 offset:1280
s_buffer_load_dword s48,s[20:23],s80 offset:1344
s_buffer_load_dword s48,s[20:23],s80 offset:1408
s_buffer_load_dword s48,s[20:23],s80 offset:1472
s_buffer_load_dword s48,s[20:23],s80 offset:1536
s_buffer_load_dword s48,s[20:23],s80 offset:1600
s_buffer_load_dword s48,s[20:23],s80 offset:1664
s_buffer_load_dword s48,s[20:23],s80 offset:1728
s_buffer_load_dword s48,s[20:23],s80 offset:1792
s_buffer_load_dword s48,s[20:23],s80 offset:1856
s_buffer_load_dword s48,s[20:23],s80 offset:1920
s_buffer_load_dword s48,s[20:23],s80 offset:1984
s_add_u32 s63,s79,1
s_and_b32 s64,s63,3
s_lshl_b32 s70,s64,20
s_add_u32 s65,s63,2
s_and_b32 s65,s65,3
s_lshl_b32 s73,s65,20
s_add_u32 s55,s63,3
s_lshl_b32 s78,s55,16
s_add_u32 s78,s78,57344
s_cmp_lt_u32 s55,64
s_cselect_b32 s78,s78,0x7fff0000
s_add_u32 s60,s63,1
s_lshl_b32 s76,s60,21
s_lshl_b32 s55,s60,13
s_and_b32 s55,s55,0x2000
s_xor_b32 s55,s55,s61
s_add_u32 s76,s76,s55
s_cmp_lt_u32 s60,64
s_cselect_b32 s76,s76,0x7fff0000
s_add_u32 s60,s63,2
s_lshl_b32 s12,s60,21
s_lshl_b32 s55,s60,13
s_and_b32 s55,s55,0x2000
s_xor_b32 s55,s55,s61
s_add_u32 s12,s12,s55
s_cmp_lt_u32 s60,64
s_cselect_b32 s12,s12,0x7fff0000
s_add_u32 s55,s63,5
s_min_u32 s55,s55,63
s_lshl_b32 s55,s55,16
s_lshl_b32 s60,s59,11
s_add_u32 s80,s55,s60
s_add_u32 s80,s80,57344
v_mov_b32 v176,0
v_mov_b32 v177,0
v_mov_b32 v178,0
v_mov_b32 v179,0
v_mov_b32 v180,0
v_mov_b32 v181,0
v_mov_b32 v182,0
v_mov_b32 v183,0
s_add_u32 s79,s79,1
v_add_u32 v25,1,v25
s_waitcnt vmcnt(0)
s_branch loop_136
art_140:
s_sub_u32 s90,s90,1
s_cmp_lt_i32 s90,0
s_cbranch_scc1 abk_141
buffer_load_dwordx4 v[64:67],v28,s[20:23],s70 offen offset:0 sc1
buffer_load_dwordx4 v[68:71],v28,s[20:23],s70 offen offset:1024 sc1
buffer_load_dwordx4 v[72:75],v28,s[20:23],s70 offen offset:2048 sc1
buffer_load_dwordx4 v[76:79],v28,s[20:23],s70 offen offset:3072 sc1
s_waitcnt vmcnt(3)
ds_write_b128 v24,v[64:67] offset:8192
v_min3_u32 v22,v64,v65,v66
v_min_u32 v22,v22,v67
s_waitcnt vmcnt(2)
ds_write_b128 v24,v[68:71] offset:9216
v_min3_u32 v22,v22,v68,v69
v_min3_u32 v22,v22,v70,v71
s_waitcnt vmcnt(1)
ds_write_b128 v24,v[72:75] offset:10240
v_min3_u32 v22,v22,v72,v73
v_min3_u32 v22,v22,v74,v75
s_waitcnt vmcnt(0)
ds_write_b128 v24,v[76:79] offset:11264
v_min3_u32 v22,v22,v76,v77
v_min3_u32 v22,v22,v78,v79
v_cmp_eq_u32 vcc,0,v22
s_cbranch_vccnz art_140
s_branch abk_141
bgsk_143:
s_waitcnt vmcnt(0)
ds_write_b32 v21,v25 offset:28
s_branch bgx_142
late_144:
s_cmp_eq_u32 s79,22
s_cbranch_scc1 lateb_145
v_lshlrev_b32 v184,2,v16
s_mov_b32 s52,21052416
s_mov_b32 s53,1792
s_lshr_b32 s64,s79,4
s_lshl_b32 s64,0x100,s64
s_cmp_eq_u32 s79,2
s_cselect_b32 exec_lo,0xff,s64
s_mov_b32 exec_hi,0
dp_146:
buffer_load_dword v185,v184,s[20:23],s52 offen sc1
s_waitcnt vmcnt(0)
v_cmp_ne_u32 vcc,s53,v185
s_cbranch_vccz dpok_147
s_sleep 2
s_sub_u32 s90,s90,1
s_cmp_gt_i32 s90,0
s_cbranch_scc1 dp_146
dpok_147:
s_mov_b64 exec,-1
s_branch lateb_145
first_135:
s_add_u32 s63,s79,0
s_and_b32 s64,s63,3
s_lshl_b32 s70,s64,20
s_add_u32 s65,s63,2
s_and_b32 s65,s65,3
s_lshl_b32 s73,s65,20
s_add_u32 s55,s63,3
s_lshl_b32 s78,s55,16
s_add_u32 s78,s78,57344
s_cmp_lt_u32 s55,64
s_cselect_b32 s78,s78,0x7fff0000
s_add_u32 s60,s63,1
s_lshl_b32 s76,s60,21
s_lshl_b32 s55,s60,13
s_and_b32 s55,s55,0x2000
s_xor_b32 s55,s55,s61
s_add_u32 s76,s76,s55
s_cmp_lt_u32 s60,64
s_cselect_b32 s76,s76,0x7fff0000
s_add_u32 s60,s63,2
s_lshl_b32 s12,s60,21
s_lshl_b32 s55,s60,13
s_and_b32 s55,s55,0x2000
s_xor_b32 s55,s55,s61
s_add_u32 s12,s12,s55
s_cmp_lt_u32 s60,64
s_cselect_b32 s12,s12,0x7fff0000
s_add_u32 s55,s63,5
s_min_u32 s55,s55,63
s_lshl_b32 s55,s55,16
s_lshl_b32 s60,s59,11
s_add_u32 s80,s55,s60
s_add_u32 s80,s80,57344
v_mov_b32 v176,0
v_mov_b32 v177,0
v_mov_b32 v178,0
v_mov_b32 v179,0
v_mov_b32 v180,0
v_mov_b32 v181,0
v_mov_b32 v182,0
v_mov_b32 v183,0
s_waitcnt vmcnt(0) lgkmcnt(0)
s_barrier
pn1_148:
ds_read_b128 v[64:67],v20 offset:0
ds_read_b128 v[68:71],v20 offset:1024
ds_read_b128 v[72:75],v20 offset:2048
s_waitcnt lgkmcnt(2)
v_mfma_f32_16x16x32_bf16 v[192:195],a[0:3],v[64:67],0
ds_read_b128 v[76:79],v20 offset:3072
v_mfma_f32_16x16x32_bf16 v[200:203],v[64:67],a[128:131],0
s_waitcnt lgkmcnt(2)
v_mfma_f32_16x16x32_bf16 v[196:199],a[0:3],v[68:71],0
ds_read_b128 v[64:67],v20 offset:4096
v_mfma_f32_16x16x32_bf16 v[204:207],v[68:71],a[128:131],0
s_waitcnt lgkmcnt(2)
v_mfma_f32_16x16x32_bf16 v[192:195],a[4:7],v[72:75],v[192:195]
ds_read_b128 v[68:71],v20 offset:5120
v_mfma_f32_16x16x32_bf16 v[200:203],v[72:75],a[132:135],v[200:203]
s_waitcnt lgkmcnt(2)
v_mfma_f32_16x16x32_bf16 v[196:199],a[4:7],v[76:79],v[196:199]
ds_read_b128 v[72:75],v20 offset:6144
v_mfma_f32_16x16x32_bf16 v[204:207],v[76:79],a[132:135],v[204:207]
s_waitcnt lgkmcnt(2)
v_mfma_f32_16x16x32_bf16 v[192:195],a[8:11],v[64:67],v[192:195]
ds_read_b128 v[76:79],v20 offset:7168
v_mfma_f32_16x16x32_bf16 v[200:203],v[64:67],a[136:139],v[200:203]
s_waitcnt lgkmcnt(2)
v_mfma_f32_16x16x32_bf16 v[196:199],a[8:11],v[68:71],v[196:199]
ds_read_b128 v[64:67],v20 offset:8192
v_mfma_f32_16x16x32_bf16 v[204:207],v[68:71],a[136:139],v[204:207]
s_waitcnt lgkmcnt(2)
v_mfma_f32_16x16x32_bf16 v[192:195],a[12:15],v[72:75],v[192:195]
ds_read_b128 v[68:71],v20 offset:9216
v_mfma_f32_16x16x32_bf16 v[200:203],v[72:75],a[140:143],v[200:203]
s_waitcnt lgkmcnt(2)
v_mfma_f32_16x16x32_bf16 v[196:199],a[12:15],v[76:79],v[196:199]
ds_read_b128 v[72:75],v20 offset:10240
v_mfma_f32_16x16x32_bf16 v[204:207],v[76:79],a[140:143],v[204:207]
s_waitcnt lgkmcnt(2)
v_mfma_f32_16x16x32_bf16 v[192:195],a[16:19],v[64:67],v[192:195]
ds_read_b128 v[76:79],v20 offset:11264
v_mfma_f32_16x16x32_bf16 v[200:203],v[64:67],a[144:147],v[200:203]
s_waitcnt lgkmcnt(2)
v_mfma_f32_16x16x32_bf16 v[196:199],a[16:19],v[68:71],v[196:199]
ds_read_b128 v[64:67],v20 offset:12288
v_mfma_f32_16x16x32_bf16 v[204:207],v[68:71],a[144:147],v[204:207]
s_waitcnt lgkmcnt(2)
v_mfma_f32_16x16x32_bf16 v[192:195],a[20:23],v[72:75],v[192:195]
ds_read_b128 v[68:71],v20 offset:13312
v_mfma_f32_16x16x32_bf16 v[200:203],v[72:75],a[148:151],v[200:203]
s_waitcnt lgkmcnt(2)
v_mfma_f32_16x16x32_bf16 v[196:199],a[20:23],v[76:79],v[196:199]
ds_read_b128 v[72:75],v20 offset:14336
v_mfma_f32_16x16x32_bf16 v[204:207],v[76:79],a[148:151],v[204:207]
s_waitcnt lgkmcnt(2)
v_mfma_f32_16x16x32_bf16 v[192:195],a[24:27],v[64:67],v[192:195]
ds_read_b128 v[76:79],v20 offset:15360
v_mfma_f32_16x16x32_bf16 v[200:203],v[64:67],a[152:155],v[200:203]
s_waitcnt lgkmcnt(2)
v_mfma_f32_16x16x32_bf16 v[196:199],a[24:27],v[68:71],v[196:199]
ds_read_b128 v[64:67],v20 offset:16384
v_mfma_f32_16x16x32_bf16 v[204:207],v[68:71],a[152:155],v[204:207]
s_waitcnt lgkmcnt(2)
v_mfma_f32_16x16x32_bf16 v[192:195],a[28:31],v[72:75],v[192:195]
ds_read_b128 v[68:71],v20 offset:17408
v_mfma_f32_16x16x32_bf16 v[200:203],v[72:75],a[156:159],v[200:203]
s_waitcnt lgkmcnt(2)
v_mfma_f32_16x16x32_bf16 v[196:199],a[28:31],v[76:79],v[196:199]
ds_read_b128 v[72:75],v20 offset:18432
v_mfma_f32_16x16x32_bf16 v[204:207],v[76:79],a[156:159],v[204:207]
s_waitcnt lgkmcnt(2)
v_mfma_f32_16x16x32_bf16 v[192:195],a[32:35],v[64:67],v[192:195]
ds_read_b128 v[76:79],v20 offset:19456
v_mfma_f32_16x16x32_bf16 v[200:203],v[64:67],a[160:163],v[200:203]
s_waitcnt lgkmcnt(2)
v_mfma_f32_16x16x32_bf16 v[196:199],a[32:35],v[68:71],v[196:199]
ds_read_b128 v[64:67],v20 offset:20480
v_mfma_f32_16x16x32_bf16 v[204:207],v[68:71],a[160:163],v[204:207]
s_waitcnt lgkmcnt(2)
v_mfma_f32_16x16x32_bf16 v[192:195],a[36:39],v[72:75],v[192:195]
ds_read_b128 v[68:71],v20 offset:21504
v_mfma_f32_16x16x32_bf16 v[200:203],v[72:75],a[164:167],v[200:203]
s_waitcnt lgkmcnt(2)
v_mfma_f32_16x16x32_bf16 v[196:199],a[36:39],v[76:79],v[196:199]
ds_read_b128 v[72:75],v20 offset:22528
v_mfma_f32_16x16x32_bf16 v[204:207],v[76:79],a[164:167],v[204:207]
s_waitcnt lgkmcnt(2)
v_mfma_f32_16x16x32_bf16 v[192:195],a[40:43],v[64:67],v[192:195]
ds_read_b128 v[76:79],v20 offset:23552
v_mfma_f32_16x16x32_bf16 v[200:203],v[64:67],a[168:171],v[200:203]
s_waitcnt lgkmcnt(2)
v_mfma_f32_16x16x32_bf16 v[196:199],a[40:43],v[68:71],v[196:199]
ds_read_b128 v[64:67],v20 offset:24576
v_mfma_f32_16x16x32_bf16 v[204:207],v[68:71],a[168:171],v[204:207]
s_waitcnt lgkmcnt(2)
v_mfma_f32_16x16x32_bf16 v[192:195],a[44:47],v[72:75],v[192:195]
ds_read_b128 v[68:71],v20 offset:25600
v_mfma_f32_16x16x32_bf16 v[200:203],v[72:75],a[172:175],v[200:203]
s_waitcnt lgkmcnt(2)
v_mfma_f32_16x16x32_bf16 v[196:199],a[44:47],v[76:79],v[196:199]
ds_read_b128 v[72:75],v20 offset:26624
v_mfma_f32_16x16x32_bf16 v[204:207],v[76:79],a[172:175],v[204:207]
s_waitcnt lgkmcnt(2)
v_mfma_f32_16x16x32_bf16 v[192:195],a[48:51],v[64:67],v[192:195]
ds_read_b128 v[76:79],v20 offset:27648
v_mfma_f32_16x16x32_bf16 v[200:203],v[64:67],a[176:179],v[200:203]
s_waitcnt lgkmcnt(2)
v_mfma_f32_16x16x32_bf16 v[196:199],a[48:51],v[68:71],v[196:199]
ds_read_b128 v[64:67],v20 offset:28672
v_mfma_f32_16x16x32_bf16 v[204:207],v[68:71],a[176:179],v[204:207]
s_waitcnt lgkmcnt(2)
v_mfma_f32_16x16x32_bf16 v[192:195],a[52:55],v[72:75],v[192:195]
ds_read_b128 v[68:71],v20 offset:29696
v_mfma_f32_16x16x32_bf16 v[200:203],v[72:75],a[180:183],v[200:203]
s_waitcnt lgkmcnt(2)
v_mfma_f32_16x16x32_bf16 v[196:199],a[52:55],v[76:79],v[196:199]
ds_read_b128 v[72:75],v20 offset:30720
v_mfma_f32_16x16x32_bf16 v[204:207],v[76:79],a[180:183],v[204:207]
s_waitcnt lgkmcnt(2)
v_mfma_f32_16x16x32_bf16 v[192:195],a[56:59],v[64:67],v[192:195]
ds_read_b128 v[76:79],v20 offset:31744
v_mfma_f32_16x16x32_bf16 v[200:203],v[64:67],a[184:187],v[200:203]
s_waitcnt lgkmcnt(2)
v_mfma_f32_16x16x32_bf16 v[196:199],a[56:59],v[68:71],v[196:199]
ds_read_b128 v[64:67],v20 offset:32768
v_mfma_f32_16x16x32_bf16 v[204:207],v[68:71],a[184:187],v[204:207]
s_waitcnt lgkmcnt(2)
v_mfma_f32_16x16x32_bf16 v[192:195],a[60:63],v[72:75],v[192:195]
ds_read_b128 v[68:71],v20 offset:33792
v_mfma_f32_16x16x32_bf16 v[200:203],v[72:75],a[188:191],v[200:203]
s_waitcnt lgkmcnt(2)
v_mfma_f32_16x16x32_bf16 v[196:199],a[60:63],v[76:79],v[196:199]
ds_read_b128 v[72:75],v20 offset:34816
v_mfma_f32_16x16x32_bf16 v[204:207],v[76:79],a[188:191],v[204:207]
s_waitcnt lgkmcnt(2)
v_mfma_f32_16x16x32_bf16 v[192:195],a[64:67],v[64:67],v[192:195]
ds_read_b128 v[76:79],v20 offset:35840
v_mfma_f32_16x16x32_bf16 v[200:203],v[64:67],a[192:195],v[200:203]
s_waitcnt lgkmcnt(2)
v_mfma_f32_16x16x32_bf16 v[196:199],a[64:67],v[68:71],v[196:199]
ds_read_b128 v[64:67],v20 offset:36864
v_mfma_f32_16x16x32_bf16 v[204:207],v[68:71],a[192:195],v[204:207]
s_waitcnt lgkmcnt(2)
v_mfma_f32_16x16x32_bf16 v[192:195],a[68:71],v[72:75],v[192:195]
ds_read_b128 v[68:71],v20 offset:37888
v_mfma_f32_16x16x32_bf16 v[200:203],v[72:75],a[196:199],v[200:203]
s_waitcnt lgkmcnt(2)
v_mfma_f32_16x16x32_bf16 v[196:199],a[68:71],v[76:79],v[196:199]
ds_read_b128 v[72:75],v20 offset:38912
v_mfma_f32_16x16x32_bf16 v[204:207],v[76:79],a[196:199],v[204:207]
s_waitcnt lgkmcnt(2)
v_mfma_f32_16x16x32_bf16 v[192:195],a[72:75],v[64:67],v[192:195]
ds_read_b128 v[76:79],v20 offset:39936
v_mfma_f32_16x16x32_bf16 v[200:203],v[64:67],a[200:203],v[200:203]
s_waitcnt lgkmcnt(2)
v_mfma_f32_16x16x32_bf16 v[196:199],a[72:75],v[68:71],v[196:199]
ds_read_b128 v[64:67],v20 offset:40960
v_mfma_f32_16x16x32_bf16 v[204:207],v[68:71],a[200:203],v[204:207]
s_waitcnt lgkmcnt(2)
v_mfma_f32_16x16x32_bf16 v[192:195],a[76:79],v[72:75],v[192:195]
ds_read_b128 v[68:71],v20 offset:41984
v_mfma_f32_16x16x32_bf16 v[200:203],v[72:75],a[204:207],v[200:203]
s_waitcnt lgkmcnt(2)
v_mfma_f32_16x16x32_bf16 v[196:199],a[76:79],v[76:79],v[196:199]
ds_read_b128 v[72:75],v20 offset:43008
v_mfma_f32_16x16x32_bf16 v[204:207],v[76:79],a[204:207],v[204:207]
s_waitcnt lgkmcnt(2)
v_mfma_f32_16x16x32_bf16 v[192:195],a[80:83],v[64:67],v[192:195]
ds_read_b128 v[76:79],v20 offset:44032
v_mfma_f32_16x16x32_bf16 v[200:203],v[64:67],a[208:211],v[200:203]
s_waitcnt lgkmcnt(2)
v_mfma_f32_16x16x32_bf16 v[196:199],a[80:83],v[68:71],v[196:199]
ds_read_b128 v[64:67],v20 offset:45056
v_mfma_f32_16x16x32_bf16 v[204:207],v[68:71],a[208:211],v[204:207]
s_waitcnt lgkmcnt(2)
v_mfma_f32_16x16x32_bf16 v[192:195],a[84:87],v[72:75],v[192:195]
ds_read_b128 v[68:71],v20 offset:46080
v_mfma_f32_16x16x32_bf16 v[200:203],v[72:75],a[212:215],v[200:203]
s_waitcnt lgkmcnt(2)
v_mfma_f32_16x16x32_bf16 v[196:199],a[84:87],v[76:79],v[196:199]
ds_read_b128 v[72:75],v20 offset:47104
v_mfma_f32_16x16x32_bf16 v[204:207],v[76:79],a[212:215],v[204:207]
s_waitcnt lgkmcnt(2)
v_mfma_f32_16x16x32_bf16 v[192:195],a[88:91],v[64:67],v[192:195]
ds_read_b128 v[76:79],v20 offset:48128
v_mfma_f32_16x16x32_bf16 v[200:203],v[64:67],a[216:219],v[200:203]
s_waitcnt lgkmcnt(2)
v_mfma_f32_16x16x32_bf16 v[196:199],a[88:91],v[68:71],v[196:199]
ds_read_b128 v[64:67],v20 offset:49152
v_mfma_f32_16x16x32_bf16 v[204:207],v[68:71],a[216:219],v[204:207]
s_waitcnt lgkmcnt(2)
v_mfma_f32_16x16x32_bf16 v[192:195],a[92:95],v[72:75],v[192:195]
ds_read_b128 v[68:71],v20 offset:50176
v_mfma_f32_16x16x32_bf16 v[200:203],v[72:75],a[220:223],v[200:203]
s_waitcnt lgkmcnt(2)
v_mfma_f32_16x16x32_bf16 v[196:199],a[92:95],v[76:79],v[196:199]
ds_read_b128 v[72:75],v20 offset:51200
v_mfma_f32_16x16x32_bf16 v[204:207],v[76:79],a[220:223],v[204:207]
s_waitcnt lgkmcnt(2)
v_mfma_f32_16x16x32_bf16 v[192:195],a[96:99],v[64:67],v[192:195]
ds_read_b128 v[76:79],v20 offset:52224
v_mfma_f32_16x16x32_bf16 v[200:203],v[64:67],a[224:227],v[200:203]
s_waitcnt lgkmcnt(2)
v_mfma_f32_16x16x32_bf16 v[196:199],a[96:99],v[68:71],v[196:199]
ds_read_b128 v[64:67],v20 offset:53248
v_mfma_f32_16x16x32_bf16 v[204:207],v[68:71],a[224:227],v[204:207]
s_waitcnt lgkmcnt(2)
v_mfma_f32_16x16x32_bf16 v[192:195],a[100:103],v[72:75],v[192:195]
ds_read_b128 v[68:71],v20 offset:54272
v_mfma_f32_16x16x32_bf16 v[200:203],v[72:75],a[228:231],v[200:203]
s_waitcnt lgkmcnt(2)
v_mfma_f32_16x16x32_bf16 v[196:199],a[100:103],v[76:79],v[196:199]
ds_read_b128 v[72:75],v20 offset:55296
v_mfma_f32_16x16x32_bf16 v[204:207],v[76:79],a[228:231],v[204:207]
s_waitcnt lgkmcnt(2)
v_mfma_f32_16x16x32_bf16 v[192:195],a[104:107],v[64:67],v[192:195]
ds_read_b128 v[76:79],v20 offset:56320
v_mfma_f32_16x16x32_bf16 v[200:203],v[64:67],a[232:235],v[200:203]
s_waitcnt lgkmcnt(2)
v_mfma_f32_16x16x32_bf16 v[196:199],a[104:107],v[68:71],v[196:199]
ds_read_b128 v[64:67],v20 offset:57344
v_mfma_f32_16x16x32_bf16 v[204:207],v[68:71],a[232:235],v[204:207]
s_waitcnt lgkmcnt(2)
v_mfma_f32_16x16x32_bf16 v[192:195],a[108:111],v[72:75],v[192:195]
ds_read_b128 v[68:71],v20 offset:58368
v_mfma_f32_16x16x32_bf16 v[200:203],v[72:75],a[236:239],v[200:203]
s_waitcnt lgkmcnt(2)
v_mfma_f32_16x16x32_bf16 v[196:199],a[108:111],v[76:79],v[196:199]
ds_read_b128 v[72:75],v20 offset:59392
v_mfma_f32_16x16x32_bf16 v[204:207],v[76:79],a[236:239],v[204:207]
s_waitcnt lgkmcnt(2)
v_mfma_f32_16x16x32_bf16 v[192:195],a[112:115],v[64:67],v[192:195]
ds_read_b128 v[76:79],v20 offset:60416
v_mfma_f32_16x16x32_bf16 v[200:203],v[64:67],a[240:243],v[200:203]
s_waitcnt lgkmcnt(2)
v_mfma_f32_16x16x32_bf16 v[196:199],a[112:115],v[68:71],v[196:199]
ds_read_b128 v[64:67],v20 offset:61440
v_mfma_f32_16x16x32_bf16 v[204:207],v[68:71],a[240:243],v[204:207]
s_waitcnt lgkmcnt(2)
v_mfma_f32_16x16x32_bf16 v[192:195],a[116:119],v[72:75],v[192:195]
ds_read_b128 v[68:71],v20 offset:62464
v_mfma_f32_16x16x32_bf16 v[200:203],v[72:75],a[244:247],v[200:203]
s_waitcnt lgkmcnt(2)
v_mfma_f32_16x16x32_bf16 v[196:199],a[116:119],v[76:79],v[196:199]
ds_read_b128 v[72:75],v20 offset:63488
v_mfma_f32_16x16x32_bf16 v[204:207],v[76:79],a[244:247],v[204:207]
s_waitcnt lgkmcnt(2)
v_mfma_f32_16x16x32_bf16 v[192:195],a[120:123],v[64:67],v[192:195]
ds_read_b128 v[76:79],v20 offset:64512
v_mfma_f32_16x16x32_bf16 v[200:203],v[64:67],a[248:251],v[200:203]
s_waitcnt lgkmcnt(2)
v_mfma_f32_16x16x32_bf16 v[196:199],a[120:123],v[68:71],v[196:199]
v_mfma_f32_16x16x32_bf16 v[204:207],v[68:71],a[248:251],v[204:207]
s_waitcnt lgkmcnt(1)
v_mfma_f32_16x16x32_bf16 v[192:195],a[124:127],v[72:75],v[192:195]
v_mfma_f32_16x16x32_bf16 v[200:203],v[72:75],a[252:255],v[200:203]
s_waitcnt lgkmcnt(0)
v_mfma_f32_16x16x32_bf16 v[196:199],a[124:127],v[76:79],v[196:199]
v_mfma_f32_16x16x32_bf16 v[204:207],v[76:79],a[252:255],v[204:207]
v_xor_b32 v20,0x10000,v20
s_xor_b32 s62,s62,0x10000
s_lshr_b32 s64,s73,9
v_add_u32 v22,s64,v24
v_cvt_pk_bf16_f32 v208,v192,v193
v_cvt_pk_bf16_f32 v209,v194,v195
s_nop 0
v_cvt_pk_bf16_f32 v210,v196,v197
v_cvt_pk_bf16_f32 v211,v198,v199
v_cvt_pk_bf16_f32 v212,v200,v201
v_cvt_pk_bf16_f32 v213,v202,v203
v_cvt_pk_bf16_f32 v214,v204,v205
v_cvt_pk_bf16_f32 v215,v206,v207
v_permlane16_swap_b32 v208,v210
v_permlane16_swap_b32 v209,v211
buffer_store_dwordx4 v[208:211],v2,s[24:27],s73 offen
buffer_store_dwordx4 v[208:211],v2,s[28:31],s73 offen sc1
ds_write_b128 v22,v[212:215] offset:17408
buffer_store_dwordx4 v[208:211],v17,s[20:23],s12 offen sc1
bgx_150:
s_add_u32 s63,s79,1
s_and_b32 s64,s63,3
s_lshl_b32 s70,s64,20
s_add_u32 s65,s63,2
s_and_b32 s65,s65,3
s_lshl_b32 s73,s65,20
s_add_u32 s55,s63,3
s_lshl_b32 s78,s55,16
s_add_u32 s78,s78,57344
s_cmp_lt_u32 s55,64
s_cselect_b32 s78,s78,0x7fff0000
s_add_u32 s60,s63,1
s_lshl_b32 s76,s60,21
s_lshl_b32 s55,s60,13
s_and_b32 s55,s55,0x2000
s_xor_b32 s55,s55,s61
s_add_u32 s76,s76,s55
s_cmp_lt_u32 s60,64
s_cselect_b32 s76,s76,0x7fff0000
s_add_u32 s60,s63,2
s_lshl_b32 s12,s60,21
s_lshl_b32 s55,s60,13
s_and_b32 s55,s55,0x2000
s_xor_b32 s55,s55,s61
s_add_u32 s12,s12,s55
s_cmp_lt_u32 s60,64
s_cselect_b32 s12,s12,0x7fff0000
s_add_u32 s55,s63,5
s_min_u32 s55,s55,63
s_lshl_b32 s55,s55,16
s_lshl_b32 s60,s59,11
s_add_u32 s80,s55,s60
s_add_u32 s80,s80,57344
v_mov_b32 v176,0
v_mov_b32 v177,0
v_mov_b32 v178,0
v_mov_b32 v179,0
v_mov_b32 v180,0
v_mov_b32 v181,0
v_mov_b32 v182,0
v_mov_b32 v183,0
s_add_u32 s79,s79,1
s_cmp_eq_u32 s79,0
s_cbranch_scc1 pn2_149
v_mov_b32 v38,1
ds_write_b32 v37,v38 offset:12
buffer_store_dwordx4 v[212:215],v12,s[20:23],s76 offen sc1
s_waitcnt lgkmcnt(0)
s_branch pn1_148
pn2_149:
v_mov_b32 v25,1
s_waitcnt vmcnt(1) lgkmcnt(0)
s_barrier
s_branch loop_136
w3_61:
v_xor_b32 v9,0x10000,v8
v_xor_b32 v10,0x20000,v8
v_xor_b32 v11,0x30000,v8
v_and_b32 v22,2,v4
v_lshrrev_b32 v23,3,v3
v_add_u32 v22,v22,v23
v_lshlrev_b32 v22,3,v22
v_and_b32 v23,1,v4
v_lshl_add_u32 v22,v23,2,v22
v_and_b32 v23,3,v3
v_add_u32 v22,v22,v23
v_lshlrev_b32 v22,4,v22
v_bfe_u32 v23,v3,2,1
v_lshl_add_u32 v22,v23,3,v22
v_add_u32 v30,s66,v22
v_and_b32 v22,7,v3
v_lshl_add_u32 v12,v4,3,v22
v_lshlrev_b32 v12,4,v12
v_add_u32 v12,s66,v12
s_branch first_151
loop_152:
s_barrier
hl_154:
buffer_load_dword v248,v18,s[20:23],s70 offen offset:0 sc1
s_waitcnt vmcnt(0)
v_cmp_eq_u32 vcc,v25,v248
s_bcnt1_i32_b32 s64,vcc_lo
s_cmp_ge_u32 s64,8
s_cbranch_scc1 hg_155
s_sub_u32 s90,s90,1
s_cmp_gt_i32 s90,0
s_cbranch_scc1 hl_154
hg_155:
buffer_load_dwordx4 v[80:83],v29,s[20:23],s70 offen offset:0 sc1
buffer_load_dwordx4 v[84:87],v29,s[20:23],s70 offen offset:1024 sc1
buffer_load_dwordx4 v[88:91],v29,s[20:23],s70 offen offset:2048 sc1
buffer_load_dwordx4 v[92:95],v29,s[20:23],s70 offen offset:3072 sc1
s_waitcnt vmcnt(3)
ds_write_b128 v24,v[80:83] offset:12288
v_min3_u32 v22,v80,v81,v82
v_min_u32 v22,v22,v83
s_waitcnt vmcnt(2)
ds_write_b128 v24,v[84:87] offset:13312
v_min3_u32 v22,v22,v84,v85
v_min3_u32 v22,v22,v86,v87
s_waitcnt vmcnt(1)
ds_write_b128 v24,v[88:91] offset:14336
v_min3_u32 v22,v22,v88,v89
v_min3_u32 v22,v22,v90,v91
s_waitcnt vmcnt(0)
ds_write_b128 v24,v[92:95] offset:15360
v_min3_u32 v22,v22,v92,v93
v_min3_u32 v22,v22,v94,v95
v_cmp_eq_u32 vcc,0,v22
s_cbranch_vccnz art_156
abk_157:
v_smfmac_f32_16x16x64_bf16 v[176:179],v[80:83],a[96:103],v14
s_waitcnt lgkmcnt(0)
s_barrier
ds_read_b128 v[32:35],v24 offset:0
ds_read_b128 v[36:39],v24 offset:1024
ds_read_b128 v[40:43],v24 offset:2048
ds_read_b128 v[44:47],v24 offset:3072
v_smfmac_f32_16x16x64_bf16 v[176:179],v[84:87],a[104:111],v14
ds_read_b128 v[48:51],v24 offset:4096
ds_read_b128 v[52:55],v24 offset:5120
v_smfmac_f32_16x16x64_bf16 v[176:179],v[88:91],a[112:119],v14
ds_read_b128 v[56:59],v24 offset:6144
ds_read_b128 v[60:63],v24 offset:7168
v_smfmac_f32_16x16x64_bf16 v[176:179],v[92:95],a[120:127],v14
ds_read_b128 v[64:67],v24 offset:8192
ds_read_b128 v[68:71],v24 offset:9216
s_waitcnt lgkmcnt(9)
v_smfmac_f32_16x16x64_bf16 v[176:179],v[32:35],a[0:7],v14
ds_read_b128 v[72:75],v24 offset:10240
s_waitcnt lgkmcnt(9)
v_smfmac_f32_16x16x64_bf16 v[176:179],v[36:39],a[8:15],v14
ds_read_b128 v[76:79],v24 offset:11264
s_waitcnt lgkmcnt(9)
v_smfmac_f32_16x16x64_bf16 v[176:179],v[40:43],a[16:23],v14
s_waitcnt lgkmcnt(8)
v_smfmac_f32_16x16x64_bf16 v[176:179],v[44:47],a[24:31],v14
s_waitcnt lgkmcnt(7)
v_smfmac_f32_16x16x64_bf16 v[176:179],v[48:51],a[32:39],v14
s_waitcnt lgkmcnt(6)
v_smfmac_f32_16x16x64_bf16 v[176:179],v[52:55],a[40:47],v14
s_waitcnt lgkmcnt(5)
v_smfmac_f32_16x16x64_bf16 v[176:179],v[56:59],a[48:55],v14
s_waitcnt lgkmcnt(4)
v_smfmac_f32_16x16x64_bf16 v[176:179],v[60:63],a[56:63],v14
s_waitcnt lgkmcnt(3)
v_smfmac_f32_16x16x64_bf16 v[176:179],v[64:67],a[64:71],v14
s_waitcnt lgkmcnt(2)
v_smfmac_f32_16x16x64_bf16 v[176:179],v[68:71],a[72:79],v14
s_waitcnt lgkmcnt(1)
v_smfmac_f32_16x16x64_bf16 v[176:179],v[72:75],a[80:87],v14
s_waitcnt lgkmcnt(0)
v_smfmac_f32_16x16x64_bf16 v[176:179],v[76:79],a[88:95],v14
s_nop 7
v_permlane32_swap_b32 v176,v178
v_permlane32_swap_b32 v177,v179
v_add_f32 v176,v176,v178
v_add_f32 v177,v177,v179
v_cvt_pk_bf16_f32 v216,v176,v177
s_nop 1
v_mov_b32_dpp v217,v216 quad_perm:[1,0,3,2] row_mask:0xf bank_mask:0xf
v_perm_b32 v216,v217,v216,v15
v_max_u32 v216,1,v216
buffer_store_dword v216,v19,s[24:27],s70 offen
buffer_store_dword v216,v19,s[28:31],s70 offen sc1
s_cmp_eq_u32 s79,63
s_cbranch_scc1 end_57
s_nop 15
s_nop 15
s_nop 15
s_nop 11
s_add_u32 m0,s62,53248
s_add_u32 s69,s78,53248
buffer_load_dwordx4 v16,s[20:23],s69 offen offset:0 lds
s_nop 3
buffer_load_dwordx4 v16,s[20:23],s69 offen offset:1024 lds
s_nop 3
buffer_load_dwordx4 v16,s[20:23],s69 offen offset:2048 lds
s_nop 3
buffer_load_dwordx4 v16,s[20:23],s69 offen offset:3072 lds
s_nop 3
s_add_u32 m0,s62,57344
s_add_u32 s69,s78,57344
buffer_load_dwordx4 v16,s[20:23],s69 offen offset:0 lds
s_nop 3
buffer_load_dwordx4 v16,s[20:23],s69 offen offset:1024 lds
s_nop 3
buffer_load_dwordx4 v16,s[20:23],s69 offen offset:2048 lds
s_nop 3
buffer_load_dwordx4 v16,s[20:23],s69 offen offset:3072 lds
s_nop 3
s_add_u32 m0,s62,61440
s_add_u32 s69,s78,61440
buffer_load_dwordx4 v16,s[20:23],s69 offen offset:0 lds
s_nop 3
buffer_load_dwordx4 v16,s[20:23],s69 offen offset:1024 lds
s_nop 3
buffer_load_dwordx4 v16,s[20:23],s69 offen offset:2048 lds
s_nop 3
buffer_load_dwordx4 v16,s[20:23],s69 offen offset:3072 lds
s_nop 3
s_xor_b32 s62,s62,0x10000
wf_158:
ds_read_b32 v23,v21 offset:8
s_sub_u32 s90,s90,1
s_waitcnt lgkmcnt(0)
v_cmp_ne_u32 vcc,v23,v25
s_cmp_lt_i32 s90,0
s_cselect_b64 vcc,0,vcc
s_cbranch_vccnz wf_158
hl_159:
buffer_load_dword v248,v18,s[20:23],s70 offen offset:512 sc1
s_waitcnt vmcnt(0)
v_cmp_eq_u32 vcc,v25,v248
s_bcnt1_i32_b32 s64,vcc_lo
s_cmp_ge_u32 s64,16
s_cbranch_scc1 hg_160
s_sub_u32 s90,s90,1
s_cmp_gt_i32 s90,0
s_cbranch_scc1 hl_159
hg_160:
buffer_load_dwordx4 v[32:35],v28,s[20:23],s71 offen offset:0 sc1
buffer_load_dwordx4 v[36:39],v28,s[20:23],s71 offen offset:1024 sc1
buffer_load_dwordx4 v[40:43],v28,s[20:23],s71 offen offset:2048 sc1
buffer_load_dwordx4 v[44:47],v28,s[20:23],s71 offen offset:3072 sc1
buffer_load_dwordx4 v[48:51],v29,s[20:23],s71 offen offset:0 sc1
buffer_load_dwordx4 v[52:55],v29,s[20:23],s71 offen offset:1024 sc1
buffer_load_dwordx4 v[56:59],v29,s[20:23],s71 offen offset:2048 sc1
buffer_load_dwordx4 v[60:63],v29,s[20:23],s71 offen offset:3072 sc1
s_mov_b32 s68,0
s_waitcnt vmcnt(6)
v_smfmac_f32_16x16x64_bf16 v[184:187],v[32:35],a[128:135],v14
v_min3_u32 v22,v32,v33,v34
v_min3_u32 v22,v22,v35,v36
v_smfmac_f32_16x16x64_bf16 v[188:191],v[32:35],a[136:143],v14
v_min3_u32 v22,v22,v37,v38
v_smfmac_f32_16x16x64_bf16 v[184:187],v[36:39],a[144:151],v14
v_min_u32 v22,v22,v39
v_smfmac_f32_16x16x64_bf16 v[188:191],v[36:39],a[152:159],v14
v_cmp_eq_u32 s[52:53],0,v22
s_waitcnt vmcnt(4)
v_smfmac_f32_16x16x64_bf16 v[184:187],v[40:43],a[160:167],v14
v_min3_u32 v22,v40,v41,v42
s_cmp_lg_u64 s[52:53],0
v_smfmac_f32_16x16x64_bf16 v[188:191],v[40:43],a[168:175],v14
s_cbranch_scc1 ms_161
bk_162:
v_min3_u32 v22,v22,v43,v44
v_smfmac_f32_16x16x64_bf16 v[184:187],v[44:47],a[176:183],v14
v_min3_u32 v22,v22,v45,v46
v_min_u32 v22,v22,v47
v_smfmac_f32_16x16x64_bf16 v[188:191],v[44:47],a[184:191],v14
v_cmp_eq_u32 s[54:55],0,v22
s_waitcnt vmcnt(2)
v_smfmac_f32_16x16x64_bf16 v[184:187],v[48:51],a[192:199],v14
v_min3_u32 v22,v48,v49,v50
s_cmp_lg_u64 s[54:55],0
v_smfmac_f32_16x16x64_bf16 v[188:191],v[48:51],a[200:207],v14
s_cbranch_scc1 ms_163
bk_164:
v_min3_u32 v22,v22,v51,v52
v_smfmac_f32_16x16x64_bf16 v[184:187],v[52:55],a[208:215],v14
v_min3_u32 v22,v22,v53,v54
v_min_u32 v22,v22,v55
v_smfmac_f32_16x16x64_bf16 v[188:191],v[52:55],a[216:223],v14
v_cmp_eq_u32 s[52:53],0,v22
s_waitcnt vmcnt(0)
v_smfmac_f32_16x16x64_bf16 v[184:187],v[56:59],a[224:231],v14
v_min3_u32 v22,v56,v57,v58
s_cmp_lg_u64 s[52:53],0
v_smfmac_f32_16x16x64_bf16 v[188:191],v[56:59],a[232:239],v14
s_cbranch_scc1 ms_165
bk_166:
v_min3_u32 v22,v22,v59,v60
v_smfmac_f32_16x16x64_bf16 v[184:187],v[60:63],a[240:247],v14
v_min3_u32 v22,v22,v61,v62
v_min_u32 v22,v22,v63
v_smfmac_f32_16x16x64_bf16 v[188:191],v[60:63],a[248:255],v14
v_cmp_eq_u32 s[54:55],0,v22
s_cmp_lg_u64 s[54:55],0
s_cbranch_scc1 ms_169
bk_170:
s_cmp_lg_u32 s68,0
s_cbranch_scc1 rl2_171
fin_167:
s_nop 2
v_permlane32_swap_b32 v184,v188
v_permlane32_swap_b32 v185,v189
v_permlane32_swap_b32 v186,v190
v_permlane32_swap_b32 v187,v191
v_pk_add_f32 v[184:185],v[184:185],v[188:189]
v_pk_add_f32 v[186:187],v[186:187],v[190:191]
wf_172:
ds_read_b32 v23,v21 offset:12
ds_read_b128 v[216:219],v24 offset:25600
s_sub_u32 s90,s90,1
s_waitcnt lgkmcnt(0)
v_cmp_ne_u32 vcc,v23,v25
s_cmp_lt_i32 s90,0
s_cselect_b64 vcc,0,vcc
v_pk_add_f32 v[216:217],v[216:217],v[184:185]
v_pk_add_f32 v[218:219],v[218:219],v[186:187]
s_cbranch_vccnz wf_172
v_max_u32 v216,1,v216
v_max_u32 v217,1,v217
v_max_u32 v218,1,v218
v_max_u32 v219,1,v219
buffer_store_dwordx4 v[216:219],v8,s[20:23],s74 offen sc1
s_mov_b32 s88,s74
s_mov_b32 s89,s72
v_add_u32 v25,1,v25
s_add_u32 s63,s79,1
s_and_b32 s64,s63,3
s_lshl_b32 s70,s64,20
s_add_u32 s65,s63,2
s_and_b32 s65,s65,3
s_lshl_b32 s73,s65,20
s_add_u32 s55,s63,3
s_lshl_b32 s78,s55,16
s_add_u32 s78,s78,57344
s_cmp_lt_u32 s55,64
s_cselect_b32 s78,s78,0x7fff0000
s_add_u32 s71,s70,65536
s_add_u32 s60,s63,1
s_and_b32 s60,s60,3
s_lshl_b32 s72,s60,20
v_mov_b32 v184,0
v_mov_b32 v185,0
v_mov_b32 v186,0
v_mov_b32 v187,0
v_mov_b32 v188,0
v_mov_b32 v189,0
v_mov_b32 v190,0
v_mov_b32 v191,0
s_lshl_b32 s74,s63,21
s_lshl_b32 s55,s63,13
s_and_b32 s55,s55,0x2000
s_xor_b32 s55,s55,s61
s_add_u32 s74,s74,s55
v_mov_b32 v176,0
v_mov_b32 v177,0
v_mov_b32 v178,0
v_mov_b32 v179,0
s_nop 15
s_nop 15
s_nop 15
s_nop 15
s_nop 15
s_nop 15
s_nop 15
pp_173:
buffer_load_dwordx4 v[32:35],v9,s[20:23],s88 offen sc1
buffer_load_dwordx4 v[36:39],v10,s[20:23],s88 offen sc1
buffer_load_dwordx4 v[40:43],v11,s[20:23],s88 offen sc1
s_waitcnt vmcnt(2)
v_min3_u32 v22,v32,v33,v34
v_pk_add_f32 v[220:221],v[216:217],v[32:33]
v_pk_add_f32 v[222:223],v[218:219],v[34:35]
s_waitcnt vmcnt(0)
v_min3_u32 v22,v22,v35,v36
v_min3_u32 v22,v22,v37,v38
v_min3_u32 v22,v22,v39,v40
v_min3_u32 v22,v22,v41,v42
v_min_u32 v22,v22,v43
v_pk_add_f32 v[36:37],v[36:37],v[40:41]
v_cmp_eq_u32 vcc,0,v22
v_pk_add_f32 v[38:39],v[38:39],v[42:43]
s_cbranch_vccz pok_174
s_sub_u32 s90,s90,1
s_cmp_gt_i32 s90,0
s_cbranch_scc1 pp_173
pok_174:
v_pk_add_f32 v[220:221],v[220:221],v[36:37]
v_pk_add_f32 v[222:223],v[222:223],v[38:39]
s_mov_b64 vcc,s[86:87]
v_cvt_pk_bf16_f32 v216,v220,v221
v_cvt_pk_bf16_f32 v217,v222,v223
s_nop 0
v_mov_b32_dpp v218,v216 quad_perm:[1,0,3,2] row_mask:0xf bank_mask:0xf
v_mov_b32_dpp v219,v217 quad_perm:[1,0,3,2] row_mask:0xf bank_mask:0xf
v_perm_b32 v216,v218,v216,v15
v_perm_b32 v217,v219,v217,v15
s_nop 1
v_cndmask_b32_dpp v220,v217,v216,vcc quad_perm:[2,3,0,1] row_mask:0xf bank_mask:0xf
s_not_b64 vcc,vcc
v_cndmask_b32_dpp v221,v216,v217,vcc quad_perm:[2,3,0,1] row_mask:0xf bank_mask:0xf
v_max_u32 v220,1,v220
v_max_u32 v221,1,v221
buffer_store_dwordx2 v[220:221],v30,s[24:27],s89 offen
buffer_store_dwordx2 v[220:221],v30,s[28:31],s89 offen sc1
s_mov_b64 exec,1
buffer_store_dword v25,v13,s[24:27],s89 offen
buffer_store_dword v25,v13,s[28:31],s89 offen sc1
s_mov_b64 exec,-1
s_add_u32 s79,s79,1
s_branch loop_152
art_156:
s_sub_u32 s90,s90,1
s_cmp_lt_i32 s90,0
s_cbranch_scc1 abk_157
buffer_load_dwordx4 v[80:83],v29,s[20:23],s70 offen offset:0 sc1
buffer_load_dwordx4 v[84:87],v29,s[20:23],s70 offen offset:1024 sc1
buffer_load_dwordx4 v[88:91],v29,s[20:23],s70 offen offset:2048 sc1
buffer_load_dwordx4 v[92:95],v29,s[20:23],s70 offen offset:3072 sc1
s_waitcnt vmcnt(3)
ds_write_b128 v24,v[80:83] offset:12288
v_min3_u32 v22,v80,v81,v82
v_min_u32 v22,v22,v83
s_waitcnt vmcnt(2)
ds_write_b128 v24,v[84:87] offset:13312
v_min3_u32 v22,v22,v84,v85
v_min3_u32 v22,v22,v86,v87
s_waitcnt vmcnt(1)
ds_write_b128 v24,v[88:91] offset:14336
v_min3_u32 v22,v22,v88,v89
v_min3_u32 v22,v22,v90,v91
s_waitcnt vmcnt(0)
ds_write_b128 v24,v[92:95] offset:15360
v_min3_u32 v22,v22,v92,v93
v_min3_u32 v22,v22,v94,v95
v_cmp_eq_u32 vcc,0,v22
s_cbranch_vccnz art_156
s_branch abk_157
ms_161:
s_waitcnt vmcnt(0)
buffer_load_dwordx4 v[64:67],v28,s[20:23],s71 offen offset:0 sc1
buffer_load_dwordx4 v[68:71],v28,s[20:23],s71 offen offset:1024 sc1
s_bitset1_b32 s68,0
s_branch bk_162
ms_163:
s_waitcnt vmcnt(0)
buffer_load_dwordx4 v[72:75],v28,s[20:23],s71 offen offset:2048 sc1
buffer_load_dwordx4 v[76:79],v28,s[20:23],s71 offen offset:3072 sc1
s_bitset1_b32 s68,1
s_branch bk_164
ms_165:
s_waitcnt vmcnt(0)
buffer_load_dwordx4 v[80:83],v29,s[20:23],s71 offen offset:0 sc1
buffer_load_dwordx4 v[84:87],v29,s[20:23],s71 offen offset:1024 sc1
s_bitset1_b32 s68,2
s_branch bk_166
ms_169:
s_waitcnt vmcnt(0)
buffer_load_dwordx4 v[88:91],v29,s[20:23],s71 offen offset:2048 sc1
buffer_load_dwordx4 v[92:95],v29,s[20:23],s71 offen offset:3072 sc1
s_bitset1_b32 s68,3
s_branch bk_170
rl_168:
s_bitcmp1_b32 s68,0
s_cbranch_scc0 sk_175
buffer_load_dwordx4 v[64:67],v28,s[20:23],s71 offen offset:0 sc1
buffer_load_dwordx4 v[68:71],v28,s[20:23],s71 offen offset:1024 sc1
sk_175:
s_bitcmp1_b32 s68,1
s_cbranch_scc0 sk_176
buffer_load_dwordx4 v[72:75],v28,s[20:23],s71 offen offset:2048 sc1
buffer_load_dwordx4 v[76:79],v28,s[20:23],s71 offen offset:3072 sc1
sk_176:
s_bitcmp1_b32 s68,2
s_cbranch_scc0 sk_177
buffer_load_dwordx4 v[80:83],v29,s[20:23],s71 offen offset:0 sc1
buffer_load_dwordx4 v[84:87],v29,s[20:23],s71 offen offset:1024 sc1
sk_177:
s_bitcmp1_b32 s68,3
s_cbranch_scc0 sk_178
buffer_load_dwordx4 v[88:91],v29,s[20:23],s71 offen offset:2048 sc1
buffer_load_dwordx4 v[92:95],v29,s[20:23],s71 offen offset:3072 sc1
sk_178:
rl2_171:
s_sub_u32 s90,s90,1
s_cmp_lt_i32 s90,0
s_cbranch_scc1 fin_167
s_waitcnt vmcnt(0)
s_bitcmp1_b32 s68,0
s_cbranch_scc0 sk_179
v_min3_u32 v22,v64,v65,v66
v_min3_u32 v22,v22,v67,v68
v_min3_u32 v22,v22,v69,v70
v_min_u32 v22,v22,v71
v_cmp_eq_u32 vcc,0,v22
v_xor_b32 v64,v32,v64
v_xor_b32 v65,v33,v65
v_xor_b32 v66,v34,v66
v_xor_b32 v67,v35,v67
v_xor_b32 v68,v36,v68
v_xor_b32 v69,v37,v69
v_xor_b32 v70,v38,v70
v_xor_b32 v71,v39,v71
s_cbranch_vccnz nb_180
s_bitset0_b32 s68,0
v_smfmac_f32_16x16x64_bf16 v[184:187],v[64:67],a[128:135],v14
v_smfmac_f32_16x16x64_bf16 v[188:191],v[64:67],a[136:143],v14
v_smfmac_f32_16x16x64_bf16 v[184:187],v[68:71],a[144:151],v14
v_smfmac_f32_16x16x64_bf16 v[188:191],v[68:71],a[152:159],v14
nb_180:
sk_179:
s_bitcmp1_b32 s68,1
s_cbranch_scc0 sk_181
v_min3_u32 v22,v72,v73,v74
v_min3_u32 v22,v22,v75,v76
v_min3_u32 v22,v22,v77,v78
v_min_u32 v22,v22,v79
v_cmp_eq_u32 vcc,0,v22
v_xor_b32 v72,v40,v72
v_xor_b32 v73,v41,v73
v_xor_b32 v74,v42,v74
v_xor_b32 v75,v43,v75
v_xor_b32 v76,v44,v76
v_xor_b32 v77,v45,v77
v_xor_b32 v78,v46,v78
v_xor_b32 v79,v47,v79
s_cbranch_vccnz nb_182
s_bitset0_b32 s68,1
v_smfmac_f32_16x16x64_bf16 v[184:187],v[72:75],a[160:167],v14
v_smfmac_f32_16x16x64_bf16 v[188:191],v[72:75],a[168:175],v14
v_smfmac_f32_16x16x64_bf16 v[184:187],v[76:79],a[176:183],v14
v_smfmac_f32_16x16x64_bf16 v[188:191],v[76:79],a[184:191],v14
nb_182:
sk_181:
s_bitcmp1_b32 s68,2
s_cbranch_scc0 sk_183
v_min3_u32 v22,v80,v81,v82
v_min3_u32 v22,v22,v83,v84
v_min3_u32 v22,v22,v85,v86
v_min_u32 v22,v22,v87
v_cmp_eq_u32 vcc,0,v22
v_xor_b32 v80,v48,v80
v_xor_b32 v81,v49,v81
v_xor_b32 v82,v50,v82
v_xor_b32 v83,v51,v83
v_xor_b32 v84,v52,v84
v_xor_b32 v85,v53,v85
v_xor_b32 v86,v54,v86
v_xor_b32 v87,v55,v87
s_cbranch_vccnz nb_184
s_bitset0_b32 s68,2
v_smfmac_f32_16x16x64_bf16 v[184:187],v[80:83],a[192:199],v14
v_smfmac_f32_16x16x64_bf16 v[188:191],v[80:83],a[200:207],v14
v_smfmac_f32_16x16x64_bf16 v[184:187],v[84:87],a[208:215],v14
v_smfmac_f32_16x16x64_bf16 v[188:191],v[84:87],a[216:223],v14
nb_184:
sk_183:
s_bitcmp1_b32 s68,3
s_cbranch_scc0 sk_185
v_min3_u32 v22,v88,v89,v90
v_min3_u32 v22,v22,v91,v92
v_min3_u32 v22,v22,v93,v94
v_min_u32 v22,v22,v95
v_cmp_eq_u32 vcc,0,v22
v_xor_b32 v88,v56,v88
v_xor_b32 v89,v57,v89
v_xor_b32 v90,v58,v90
v_xor_b32 v91,v59,v91
v_xor_b32 v92,v60,v92
v_xor_b32 v93,v61,v93
v_xor_b32 v94,v62,v94
v_xor_b32 v95,v63,v95
s_cbranch_vccnz nb_186
s_bitset0_b32 s68,3
v_smfmac_f32_16x16x64_bf16 v[184:187],v[88:91],a[224:231],v14
v_smfmac_f32_16x16x64_bf16 v[188:191],v[88:91],a[232:239],v14
v_smfmac_f32_16x16x64_bf16 v[184:187],v[92:95],a[240:247],v14
v_smfmac_f32_16x16x64_bf16 v[188:191],v[92:95],a[248:255],v14
nb_186:
sk_185:
s_cmp_lg_u32 s68,0
s_cbranch_scc1 rl_168
s_nop 2
s_branch fin_167
first_151:
s_waitcnt vmcnt(0) lgkmcnt(0)
s_barrier
s_add_u32 s64,s15,393216
buffer_load_dwordx4 a[176:179],v32,s[40:43],s64 offen nt
s_add_u32 s64,s15,425984
buffer_load_dwordx4 a[180:183],v32,s[40:43],s64 offen nt
s_add_u32 s64,s15,458752
buffer_load_dwordx4 a[184:187],v32,s[40:43],s64 offen nt
s_add_u32 s64,s15,491520
buffer_load_dwordx4 a[188:191],v32,s[40:43],s64 offen nt
s_add_u32 s64,s15,524288
buffer_load_dwordx4 a[192:195],v32,s[40:43],s64 offen nt
s_add_u32 s64,s15,557056
buffer_load_dwordx4 a[196:199],v32,s[40:43],s64 offen nt
s_add_u32 s64,s15,589824
buffer_load_dwordx4 a[200:203],v32,s[40:43],s64 offen nt
s_add_u32 s64,s15,622592
buffer_load_dwordx4 a[204:207],v32,s[40:43],s64 offen nt
s_add_u32 s64,s15,655360
buffer_load_dwordx4 a[208:211],v32,s[40:43],s64 offen nt
s_add_u32 s64,s15,688128
buffer_load_dwordx4 a[212:215],v32,s[40:43],s64 offen nt
s_add_u32 s64,s15,720896
buffer_load_dwordx4 a[216:219],v32,s[40:43],s64 offen nt
s_add_u32 s64,s15,753664
buffer_load_dwordx4 a[220:223],v32,s[40:43],s64 offen nt
s_add_u32 s64,s15,786432
buffer_load_dwordx4 a[224:227],v32,s[40:43],s64 offen nt
s_add_u32 s64,s15,819200
buffer_load_dwordx4 a[228:231],v32,s[40:43],s64 offen nt
s_add_u32 s64,s15,851968
buffer_load_dwordx4 a[232:235],v32,s[40:43],s64 offen nt
s_add_u32 s64,s15,884736
buffer_load_dwordx4 a[236:239],v32,s[40:43],s64 offen nt
s_add_u32 s64,s15,917504
buffer_load_dwordx4 a[240:243],v32,s[40:43],s64 offen nt
s_add_u32 s64,s15,950272
buffer_load_dwordx4 a[244:247],v32,s[40:43],s64 offen nt
s_add_u32 s64,s15,983040
buffer_load_dwordx4 a[248:251],v32,s[40:43],s64 offen nt
s_add_u32 s64,s15,1015808
buffer_load_dwordx4 a[252:255],v32,s[40:43],s64 offen nt
ds_write_b128 v33,a[0:3] offset:0
ds_write_b128 v33,a[4:7] offset:1024
ds_write_b128 v33,a[8:11] offset:2048
ds_write_b128 v33,a[12:15] offset:3072
s_waitcnt lgkmcnt(0)
v_mov_b32 v38,1
ds_write_b32 v37,v38 offset:4
qs_187:
ds_read_b32 v39,v37 offset:0
s_sub_u32 s90,s90,1
s_waitcnt lgkmcnt(0)
v_cmp_gt_u32 vcc,v38,v39
s_cmp_lt_i32 s90,0
s_cselect_b64 vcc,0,vcc
s_cbranch_vccnz qs_187
ds_read_b64_tr_b16 a[0:1],v36 offset:0
ds_read_b64_tr_b16 a[2:3],v36 offset:128
ds_read_b64_tr_b16 a[4:5],v36 offset:2048
ds_read_b64_tr_b16 a[6:7],v36 offset:2176
ds_read_b64_tr_b16 a[8:9],v36 offset:8192
ds_read_b64_tr_b16 a[10:11],v36 offset:8320
ds_read_b64_tr_b16 a[12:13],v36 offset:10240
ds_read_b64_tr_b16 a[14:15],v36 offset:10368
ds_write_b128 v33,a[16:19] offset:4096
ds_write_b128 v33,a[20:23] offset:5120
ds_write_b128 v33,a[24:27] offset:6144
ds_write_b128 v33,a[28:31] offset:7168
s_waitcnt lgkmcnt(0)
v_mov_b32 v38,2
ds_write_b32 v37,v38 offset:4
qs_188:
ds_read_b32 v39,v37 offset:0
s_sub_u32 s90,s90,1
s_waitcnt lgkmcnt(0)
v_cmp_gt_u32 vcc,v38,v39
s_cmp_lt_i32 s90,0
s_cselect_b64 vcc,0,vcc
s_cbranch_vccnz qs_188
ds_read_b64_tr_b16 a[16:17],v36 offset:4096
ds_read_b64_tr_b16 a[18:19],v36 offset:4224
ds_read_b64_tr_b16 a[20:21],v36 offset:6144
ds_read_b64_tr_b16 a[22:23],v36 offset:6272
ds_read_b64_tr_b16 a[24:25],v36 offset:12288
ds_read_b64_tr_b16 a[26:27],v36 offset:12416
ds_read_b64_tr_b16 a[28:29],v36 offset:14336
ds_read_b64_tr_b16 a[30:31],v36 offset:14464
ds_write_b128 v33,a[32:35] offset:0
ds_write_b128 v33,a[36:39] offset:1024
ds_write_b128 v33,a[40:43] offset:2048
ds_write_b128 v33,a[44:47] offset:3072
s_waitcnt lgkmcnt(0)
v_mov_b32 v38,3
ds_write_b32 v37,v38 offset:4
qs_189:
ds_read_b32 v39,v37 offset:0
s_sub_u32 s90,s90,1
s_waitcnt lgkmcnt(0)
v_cmp_gt_u32 vcc,v38,v39
s_cmp_lt_i32 s90,0
s_cselect_b64 vcc,0,vcc
s_cbranch_vccnz qs_189
ds_read_b64_tr_b16 a[32:33],v36 offset:0
ds_read_b64_tr_b16 a[34:35],v36 offset:128
ds_read_b64_tr_b16 a[36:37],v36 offset:2048
ds_read_b64_tr_b16 a[38:39],v36 offset:2176
ds_read_b64_tr_b16 a[40:41],v36 offset:8192
ds_read_b64_tr_b16 a[42:43],v36 offset:8320
ds_read_b64_tr_b16 a[44:45],v36 offset:10240
ds_read_b64_tr_b16 a[46:47],v36 offset:10368
ds_write_b128 v33,a[48:51] offset:4096
ds_write_b128 v33,a[52:55] offset:5120
ds_write_b128 v33,a[56:59] offset:6144
ds_write_b128 v33,a[60:63] offset:7168
s_waitcnt lgkmcnt(0)
v_mov_b32 v38,4
ds_write_b32 v37,v38 offset:4
qs_190:
ds_read_b32 v39,v37 offset:0
s_sub_u32 s90,s90,1
s_waitcnt lgkmcnt(0)
v_cmp_gt_u32 vcc,v38,v39
s_cmp_lt_i32 s90,0
s_cselect_b64 vcc,0,vcc
s_cbranch_vccnz qs_190
ds_read_b64_tr_b16 a[48:49],v36 offset:4096
ds_read_b64_tr_b16 a[50:51],v36 offset:4224
ds_read_b64_tr_b16 a[52:53],v36 offset:6144
ds_read_b64_tr_b16 a[54:55],v36 offset:6272
ds_read_b64_tr_b16 a[56:57],v36 offset:12288
ds_read_b64_tr_b16 a[58:59],v36 offset:12416
ds_read_b64_tr_b16 a[60:61],v36 offset:14336
ds_read_b64_tr_b16 a[62:63],v36 offset:14464
ds_write_b128 v33,a[64:67] offset:0
ds_write_b128 v33,a[68:71] offset:1024
ds_write_b128 v33,a[72:75] offset:2048
ds_write_b128 v33,a[76:79] offset:3072
s_waitcnt lgkmcnt(0)
v_mov_b32 v38,5
ds_write_b32 v37,v38 offset:4
qs_191:
ds_read_b32 v39,v37 offset:0
s_sub_u32 s90,s90,1
s_waitcnt lgkmcnt(0)
v_cmp_gt_u32 vcc,v38,v39
s_cmp_lt_i32 s90,0
s_cselect_b64 vcc,0,vcc
s_cbranch_vccnz qs_191
ds_read_b64_tr_b16 a[64:65],v36 offset:0
ds_read_b64_tr_b16 a[66:67],v36 offset:128
ds_read_b64_tr_b16 a[68:69],v36 offset:2048
ds_read_b64_tr_b16 a[70:71],v36 offset:2176
ds_read_b64_tr_b16 a[72:73],v36 offset:8192
ds_read_b64_tr_b16 a[74:75],v36 offset:8320
ds_read_b64_tr_b16 a[76:77],v36 offset:10240
ds_read_b64_tr_b16 a[78:79],v36 offset:10368
ds_write_b128 v33,a[80:83] offset:4096
ds_write_b128 v33,a[84:87] offset:5120
ds_write_b128 v33,a[88:91] offset:6144
ds_write_b128 v33,a[92:95] offset:7168
s_waitcnt lgkmcnt(0)
v_mov_b32 v38,6
ds_write_b32 v37,v38 offset:4
qs_192:
ds_read_b32 v39,v37 offset:0
s_sub_u32 s90,s90,1
s_waitcnt lgkmcnt(0)
v_cmp_gt_u32 vcc,v38,v39
s_cmp_lt_i32 s90,0
s_cselect_b64 vcc,0,vcc
s_cbranch_vccnz qs_192
ds_read_b64_tr_b16 a[80:81],v36 offset:4096
ds_read_b64_tr_b16 a[82:83],v36 offset:4224
ds_read_b64_tr_b16 a[84:85],v36 offset:6144
ds_read_b64_tr_b16 a[86:87],v36 offset:6272
ds_read_b64_tr_b16 a[88:89],v36 offset:12288
ds_read_b64_tr_b16 a[90:91],v36 offset:12416
ds_read_b64_tr_b16 a[92:93],v36 offset:14336
ds_read_b64_tr_b16 a[94:95],v36 offset:14464
ds_write_b128 v33,a[96:99] offset:0
ds_write_b128 v33,a[100:103] offset:1024
ds_write_b128 v33,a[104:107] offset:2048
ds_write_b128 v33,a[108:111] offset:3072
s_waitcnt lgkmcnt(0)
v_mov_b32 v38,7
ds_write_b32 v37,v38 offset:4
qs_193:
ds_read_b32 v39,v37 offset:0
s_sub_u32 s90,s90,1
s_waitcnt lgkmcnt(0)
v_cmp_gt_u32 vcc,v38,v39
s_cmp_lt_i32 s90,0
s_cselect_b64 vcc,0,vcc
s_cbranch_vccnz qs_193
ds_read_b64_tr_b16 a[96:97],v36 offset:0
ds_read_b64_tr_b16 a[98:99],v36 offset:128
ds_read_b64_tr_b16 a[100:101],v36 offset:2048
ds_read_b64_tr_b16 a[102:103],v36 offset:2176
ds_read_b64_tr_b16 a[104:105],v36 offset:8192
ds_read_b64_tr_b16 a[106:107],v36 offset:8320
ds_read_b64_tr_b16 a[108:109],v36 offset:10240
ds_read_b64_tr_b16 a[110:111],v36 offset:10368
ds_write_b128 v33,a[112:115] offset:4096
ds_write_b128 v33,a[116:119] offset:5120
ds_write_b128 v33,a[120:123] offset:6144
ds_write_b128 v33,a[124:127] offset:7168
s_waitcnt lgkmcnt(0)
v_mov_b32 v38,8
ds_write_b32 v37,v38 offset:4
qs_194:
ds_read_b32 v39,v37 offset:0
s_sub_u32 s90,s90,1
s_waitcnt lgkmcnt(0)
v_cmp_gt_u32 vcc,v38,v39
s_cmp_lt_i32 s90,0
s_cselect_b64 vcc,0,vcc
s_cbranch_vccnz qs_194
ds_read_b64_tr_b16 a[112:113],v36 offset:4096
ds_read_b64_tr_b16 a[114:115],v36 offset:4224
ds_read_b64_tr_b16 a[116:117],v36 offset:6144
ds_read_b64_tr_b16 a[118:119],v36 offset:6272
ds_read_b64_tr_b16 a[120:121],v36 offset:12288
ds_read_b64_tr_b16 a[122:123],v36 offset:12416
ds_read_b64_tr_b16 a[124:125],v36 offset:14336
ds_read_b64_tr_b16 a[126:127],v36 offset:14464
s_waitcnt lgkmcnt(0)
v_mov_b32 v38,9
ds_write_b32 v37,v38 offset:4
qs_195:
ds_read_b32 v39,v37 offset:0
s_sub_u32 s90,s90,1
s_waitcnt lgkmcnt(0)
v_cmp_gt_u32 vcc,v38,v39
s_cmp_lt_i32 s90,0
s_cselect_b64 vcc,0,vcc
s_cbranch_vccnz qs_195
ds_write_b128 v33,a[128:131] offset:0
ds_write_b128 v33,a[132:135] offset:1024
ds_write_b128 v33,a[136:139] offset:2048
ds_write_b128 v33,a[140:143] offset:3072
s_waitcnt lgkmcnt(0)
ds_read_b64_tr_b16 a[128:129],v34 offset:0
ds_read_b64_tr_b16 a[130:131],v34 offset:128
ds_read_b64_tr_b16 a[132:133],v34 offset:2048
ds_read_b64_tr_b16 a[134:135],v34 offset:2176
ds_read_b64_tr_b16 a[136:137],v34 offset:32
ds_read_b64_tr_b16 a[138:139],v34 offset:160
ds_read_b64_tr_b16 a[140:141],v34 offset:2080
ds_read_b64_tr_b16 a[142:143],v34 offset:2208
ds_write_b128 v33,a[144:147] offset:4096
ds_write_b128 v33,a[148:151] offset:5120
ds_write_b128 v33,a[152:155] offset:6144
ds_write_b128 v33,a[156:159] offset:7168
s_waitcnt lgkmcnt(0)
ds_read_b64_tr_b16 a[144:145],v34 offset:4096
ds_read_b64_tr_b16 a[146:147],v34 offset:4224
ds_read_b64_tr_b16 a[148:149],v34 offset:6144
ds_read_b64_tr_b16 a[150:151],v34 offset:6272
ds_read_b64_tr_b16 a[152:153],v34 offset:4128
ds_read_b64_tr_b16 a[154:155],v34 offset:4256
ds_read_b64_tr_b16 a[156:157],v34 offset:6176
ds_read_b64_tr_b16 a[158:159],v34 offset:6304
ds_write_b128 v33,a[160:163] offset:0
ds_write_b128 v33,a[164:167] offset:1024
ds_write_b128 v33,a[168:171] offset:2048
ds_write_b128 v33,a[172:175] offset:3072
s_waitcnt lgkmcnt(0)
ds_read_b64_tr_b16 a[160:161],v34 offset:0
ds_read_b64_tr_b16 a[162:163],v34 offset:128
ds_read_b64_tr_b16 a[164:165],v34 offset:2048
ds_read_b64_tr_b16 a[166:167],v34 offset:2176
ds_read_b64_tr_b16 a[168:169],v34 offset:32
ds_read_b64_tr_b16 a[170:171],v34 offset:160
ds_read_b64_tr_b16 a[172:173],v34 offset:2080
ds_read_b64_tr_b16 a[174:175],v34 offset:2208
free_196:
ds_read_b64 v[38:39],v37 offset:8
s_sub_u32 s90,s90,1
s_waitcnt lgkmcnt(0)
v_and_b32 v38,v38,v39
v_cmp_eq_u32 vcc,0,v38
s_cmp_lt_i32 s90,0
s_cselect_b64 vcc,0,vcc
s_cbranch_vccnz free_196
s_xor_b32 s64,s61,10493952
buffer_store_dwordx4 v[100:103],v206,s[20:23],s64 offen sc1
buffer_store_dwordx4 v[100:103],v207,s[20:23],s64 offen sc1
s_xor_b32 s64,s61,12582912
buffer_store_dwordx4 v[100:103],v206,s[20:23],s64 offen sc1
buffer_store_dwordx4 v[100:103],v207,s[20:23],s64 offen sc1
s_xor_b32 s64,s61,14688256
buffer_store_dwordx4 v[100:103],v206,s[20:23],s64 offen sc1
buffer_store_dwordx4 v[100:103],v207,s[20:23],s64 offen sc1
s_mov_b32 m0,32768
s_mov_b32 s65,221184
buffer_load_dwordx4 v16,s[20:23],s65 offen offset:0 lds
buffer_load_dwordx4 v16,s[20:23],s65 offen offset:1024 lds
buffer_load_dwordx4 v16,s[20:23],s65 offen offset:2048 lds
buffer_load_dwordx4 v16,s[20:23],s65 offen offset:3072 lds
s_mov_b32 m0,36864
s_mov_b32 s65,225280
buffer_load_dwordx4 v16,s[20:23],s65 offen offset:0 lds
buffer_load_dwordx4 v16,s[20:23],s65 offen offset:1024 lds
buffer_load_dwordx4 v16,s[20:23],s65 offen offset:2048 lds
buffer_load_dwordx4 v16,s[20:23],s65 offen offset:3072 lds
s_mov_b32 m0,40960
s_mov_b32 s65,229376
buffer_load_dwordx4 v16,s[20:23],s65 offen offset:0 lds
buffer_load_dwordx4 v16,s[20:23],s65 offen offset:1024 lds
buffer_load_dwordx4 v16,s[20:23],s65 offen offset:2048 lds
buffer_load_dwordx4 v16,s[20:23],s65 offen offset:3072 lds
s_mov_b32 m0,45056
s_mov_b32 s65,233472
buffer_load_dwordx4 v16,s[20:23],s65 offen offset:0 lds
buffer_load_dwordx4 v16,s[20:23],s65 offen offset:1024 lds
buffer_load_dwordx4 v16,s[20:23],s65 offen offset:2048 lds
buffer_load_dwordx4 v16,s[20:23],s65 offen offset:3072 lds
s_mov_b32 m0,49152
s_mov_b32 s65,237568
buffer_load_dwordx4 v16,s[20:23],s65 offen offset:0 lds
buffer_load_dwordx4 v16,s[20:23],s65 offen offset:1024 lds
buffer_load_dwordx4 v16,s[20:23],s65 offen offset:2048 lds
buffer_load_dwordx4 v16,s[20:23],s65 offen offset:3072 lds
s_mov_b32 m0,53248
s_mov_b32 s65,241664
buffer_load_dwordx4 v16,s[20:23],s65 offen offset:0 lds
buffer_load_dwordx4 v16,s[20:23],s65 offen offset:1024 lds
buffer_load_dwordx4 v16,s[20:23],s65 offen offset:2048 lds
buffer_load_dwordx4 v16,s[20:23],s65 offen offset:3072 lds
s_mov_b32 m0,57344
s_mov_b32 s65,245760
buffer_load_dwordx4 v16,s[20:23],s65 offen offset:0 lds
buffer_load_dwordx4 v16,s[20:23],s65 offen offset:1024 lds
buffer_load_dwordx4 v16,s[20:23],s65 offen offset:2048 lds
buffer_load_dwordx4 v16,s[20:23],s65 offen offset:3072 lds
s_mov_b32 m0,61440
s_mov_b32 s65,249856
buffer_load_dwordx4 v16,s[20:23],s65 offen offset:0 lds
buffer_load_dwordx4 v16,s[20:23],s65 offen offset:1024 lds
buffer_load_dwordx4 v16,s[20:23],s65 offen offset:2048 lds
buffer_load_dwordx4 v16,s[20:23],s65 offen offset:3072 lds
s_waitcnt vmcnt(54)
ds_write_b128 v33,a[176:179] offset:4096
ds_write_b128 v33,a[180:183] offset:5120
ds_write_b128 v33,a[184:187] offset:6144
ds_write_b128 v33,a[188:191] offset:7168
s_waitcnt lgkmcnt(0)
ds_read_b64_tr_b16 a[176:177],v34 offset:4096
ds_read_b64_tr_b16 a[178:179],v34 offset:4224
ds_read_b64_tr_b16 a[180:181],v34 offset:6144
ds_read_b64_tr_b16 a[182:183],v34 offset:6272
ds_read_b64_tr_b16 a[184:185],v34 offset:4128
ds_read_b64_tr_b16 a[186:187],v34 offset:4256
ds_read_b64_tr_b16 a[188:189],v34 offset:6176
ds_read_b64_tr_b16 a[190:191],v34 offset:6304
s_waitcnt vmcnt(50)
ds_write_b128 v33,a[192:195] offset:0
ds_write_b128 v33,a[196:199] offset:1024
ds_write_b128 v33,a[200:203] offset:2048
ds_write_b128 v33,a[204:207] offset:3072
s_waitcnt lgkmcnt(0)
ds_read_b64_tr_b16 a[192:193],v34 offset:0
ds_read_b64_tr_b16 a[194:195],v34 offset:128
ds_read_b64_tr_b16 a[196:197],v34 offset:2048
ds_read_b64_tr_b16 a[198:199],v34 offset:2176
ds_read_b64_tr_b16 a[200:201],v34 offset:32
ds_read_b64_tr_b16 a[202:203],v34 offset:160
ds_read_b64_tr_b16 a[204:205],v34 offset:2080
ds_read_b64_tr_b16 a[206:207],v34 offset:2208
s_waitcnt vmcnt(46)
ds_write_b128 v33,a[208:211] offset:4096
ds_write_b128 v33,a[212:215] offset:5120
ds_write_b128 v33,a[216:219] offset:6144
ds_write_b128 v33,a[220:223] offset:7168
s_waitcnt lgkmcnt(0)
ds_read_b64_tr_b16 a[208:209],v34 offset:4096
ds_read_b64_tr_b16 a[210:211],v34 offset:4224
ds_read_b64_tr_b16 a[212:213],v34 offset:6144
ds_read_b64_tr_b16 a[214:215],v34 offset:6272
ds_read_b64_tr_b16 a[216:217],v34 offset:4128
ds_read_b64_tr_b16 a[218:219],v34 offset:4256
ds_read_b64_tr_b16 a[220:221],v34 offset:6176
ds_read_b64_tr_b16 a[222:223],v34 offset:6304
s_waitcnt vmcnt(42)
ds_write_b128 v33,a[224:227] offset:0
ds_write_b128 v33,a[228:231] offset:1024
ds_write_b128 v33,a[232:235] offset:2048
ds_write_b128 v33,a[236:239] offset:3072
s_waitcnt lgkmcnt(0)
ds_read_b64_tr_b16 a[224:225],v34 offset:0
ds_read_b64_tr_b16 a[226:227],v34 offset:128
ds_read_b64_tr_b16 a[228:229],v34 offset:2048
ds_read_b64_tr_b16 a[230:231],v34 offset:2176
ds_read_b64_tr_b16 a[232:233],v34 offset:32
ds_read_b64_tr_b16 a[234:235],v34 offset:160
ds_read_b64_tr_b16 a[236:237],v34 offset:2080
ds_read_b64_tr_b16 a[238:239],v34 offset:2208
s_waitcnt vmcnt(38)
ds_write_b128 v33,a[240:243] offset:4096
ds_write_b128 v33,a[244:247] offset:5120
ds_write_b128 v33,a[248:251] offset:6144
ds_write_b128 v33,a[252:255] offset:7168
s_waitcnt lgkmcnt(0)
ds_read_b64_tr_b16 a[240:241],v34 offset:4096
ds_read_b64_tr_b16 a[242:243],v34 offset:4224
ds_read_b64_tr_b16 a[244:245],v34 offset:6144
ds_read_b64_tr_b16 a[246:247],v34 offset:6272
ds_read_b64_tr_b16 a[248:249],v34 offset:4128
ds_read_b64_tr_b16 a[250:251],v34 offset:4256
ds_read_b64_tr_b16 a[252:253],v34 offset:6176
ds_read_b64_tr_b16 a[254:255],v34 offset:6304
s_mov_b32 s79,0
s_add_u32 s63,s79,0
s_and_b32 s64,s63,3
s_lshl_b32 s70,s64,20
s_add_u32 s65,s63,2
s_and_b32 s65,s65,3
s_lshl_b32 s73,s65,20
s_add_u32 s55,s63,3
s_lshl_b32 s78,s55,16
s_add_u32 s78,s78,57344
s_cmp_lt_u32 s55,64
s_cselect_b32 s78,s78,0x7fff0000
s_add_u32 s71,s70,65536
s_add_u32 s60,s63,1
s_and_b32 s60,s60,3
s_lshl_b32 s72,s60,20
v_mov_b32 v184,0
v_mov_b32 v185,0
v_mov_b32 v186,0
v_mov_b32 v187,0
v_mov_b32 v188,0
v_mov_b32 v189,0
v_mov_b32 v190,0
v_mov_b32 v191,0
s_lshl_b32 s74,s63,21
s_lshl_b32 s55,s63,13
s_and_b32 s55,s55,0x2000
s_xor_b32 s55,s55,s61
s_add_u32 s74,s74,s55
v_mov_b32 v176,0
v_mov_b32 v177,0
v_mov_b32 v178,0
v_mov_b32 v179,0
v_mov_b32 v25,1
s_waitcnt vmcnt(0) lgkmcnt(0)
s_barrier
v_max_u32 v216,1,v216
v_max_u32 v217,1,v217
v_max_u32 v218,1,v218
v_max_u32 v219,1,v219
s_mov_b64 exec,s[84:85]
buffer_store_dwordx4 v[216:219],v12,s[24:27],s70 offen
buffer_store_dwordx4 v[216:219],v12,s[28:31],s70 offen sc1
s_mov_b64 exec,1
buffer_store_dword v25,v13,s[24:27],s70 offen
buffer_store_dword v25,v13,s[28:31],s70 offen sc1
s_mov_b64 exec,-1
s_branch loop_152
end_57:
s_waitcnt vmcnt(0)
s_barrier
s_mov_b32 s50,s91
done_1:
s_endpgm
pipe_worker:
v_and_b32 v1,63,v0
v_and_b32 v3,15,v1
v_lshrrev_b32 v4,4,v1
v_lshlrev_b32 v16,4,v1
v_mov_b32 v48,0
v_mov_b32 v49,0
v_mov_b32 v50,0
v_mov_b32 v51,0
s_lshr_b32 s58,s55,5
s_and_b32 s59,s55,31
s_xor_b32 s62,s61,0x2000
s_add_u32 s63,s62,21053440
s_lshr_b32 s64,s59,4
s_and_b32 s59,s59,15
s_lshr_b32 s65,s58,1
s_lshl_b32 s65,s65,4
s_add_u32 s59,s59,s65
s_mul_i32 s65,s64,3
s_add_u32 s64,s64,1
s_sub_u32 s58,s58,1
s_cmp_lt_u32 s58,2
s_cselect_b32 s58,s64,s65
s_load_dwordx2 s[4:5],s[0:1],16
v_lshlrev_b32 v5,4,v0
s_lshl_b32 s64,s55,14
s_add_u32 s64,s64,17825792
buffer_store_dwordx4 v[48:51],v5,s[20:23],s64 offen sc1
s_add_u32 s64,s64,4096
buffer_store_dwordx4 v[48:51],v5,s[20:23],s64 offen sc1
s_add_u32 s64,s64,4096
buffer_store_dwordx4 v[48:51],v5,s[20:23],s64 offen sc1
s_add_u32 s64,s64,4096
buffer_store_dwordx4 v[48:51],v5,s[20:23],s64 offen sc1
s_add_u32 s64,s64,4096
s_lshl_b32 s64,s55,12
s_add_u32 s64,s64,8577024
buffer_store_dwordx4 v[48:51],v5,s[20:23],s64 offen sc1
s_lshr_b32 s79,s55,5
s_add_u32 s64,s79,8
s_lshl_b32 s93,s64,21
s_lshl_b32 s64,s64,13
s_and_b32 s64,s64,0x2000
s_xor_b32 s64,s64,s61
s_add_u32 s93,s93,s64
s_add_u32 s93,s93,29360128
s_and_b32 s64,s55,31
s_add_u32 s64,s64,96
s_lshl_b32 s64,s64,14
s_add_u32 s93,s93,s64
s_waitcnt lgkmcnt(0)
s_mov_b32 s32,s4
s_and_b32 s33,s5,0xffff
s_mov_b32 s34,0x800000
s_mov_b32 s35,0x20000
v_lshrrev_b32 v5,3,v3
v_bfe_u32 v6,v3,2,1
v_lshl_add_u32 v7,v5,3,v6
v_lshl_add_u32 v6,v5,2,v6
v_lshrrev_b32 v5,1,v4
v_lshl_add_u32 v7,v5,4,v7
v_and_b32 v5,1,v4
v_lshl_add_u32 v7,v5,2,v7
v_lshl_add_u32 v6,v5,1,v6
v_bfe_u32 v5,v3,1,1
s_lshl_b32 s64,s50,1
v_add_u32 v5,s64,v5
v_xor_b32 v5,v5,v6
v_lshlrev_b32 v5,5,v5
v_lshl_add_u32 v5,v7,8,v5
v_and_b32 v6,1,v3
v_lshl_add_u32 v12,v6,4,v5
s_lshl_b32 s66,s59,8
v_and_b32 v5,15,v1
v_and_b32 v6,1,v4
v_lshlrev_b32 v6,1,v6
v_xor_b32 v5,v5,v6
v_mul_u32_u24 v6,8192,v4
v_xor_b32 v7,0,v5
v_lshl_add_u32 v8,v7,4,v6
v_xor_b32 v7,4,v5
v_lshl_add_u32 v9,v7,4,v6
v_xor_b32 v7,8,v5
v_lshl_add_u32 v10,v7,4,v6
v_xor_b32 v7,12,v5
v_lshl_add_u32 v11,v7,4,v6
s_mul_i32 s74,s50,524288
s_add_u32 s74,s74,s66
s_lshl_b32 s75,s50,14
s_mul_i32 s76,s50,262144
s_add_u32 s76,s76,s66
s_lshl_b32 s77,s50,13
s_add_u32 s64,s74,0
s_add_u32 m0,s75,0
s_nop 0
buffer_load_dwordx4 v8,s[32:35],s64 offen nt lds
s_add_u32 s64,s74,32768
s_add_u32 m0,s75,1024
s_nop 0
buffer_load_dwordx4 v9,s[32:35],s64 offen nt lds
s_add_u32 s64,s74,65536
s_add_u32 m0,s75,2048
s_nop 0
buffer_load_dwordx4 v10,s[32:35],s64 offen nt lds
s_add_u32 s64,s74,98304
s_add_u32 m0,s75,3072
s_nop 0
buffer_load_dwordx4 v11,s[32:35],s64 offen nt lds
s_add_u32 s64,s74,131072
s_add_u32 m0,s75,4096
s_nop 0
buffer_load_dwordx4 v8,s[32:35],s64 offen nt lds
s_add_u32 s64,s74,163840
s_add_u32 m0,s75,5120
s_nop 0
buffer_load_dwordx4 v9,s[32:35],s64 offen nt lds
s_add_u32 s64,s74,196608
s_add_u32 m0,s75,6144
s_nop 0
buffer_load_dwordx4 v10,s[32:35],s64 offen nt lds
s_add_u32 s64,s74,229376
s_add_u32 m0,s75,7168
s_nop 0
buffer_load_dwordx4 v11,s[32:35],s64 offen nt lds
s_add_u32 s64,s74,262144
s_add_u32 m0,s75,8192
s_nop 0
buffer_load_dwordx4 v8,s[32:35],s64 offen nt lds
s_add_u32 s64,s74,294912
s_add_u32 m0,s75,9216
s_nop 0
buffer_load_dwordx4 v9,s[32:35],s64 offen nt lds
s_add_u32 s64,s74,327680
s_add_u32 m0,s75,10240
s_nop 0
buffer_load_dwordx4 v10,s[32:35],s64 offen nt lds
s_add_u32 s64,s74,360448
s_add_u32 m0,s75,11264
s_nop 0
buffer_load_dwordx4 v11,s[32:35],s64 offen nt lds
s_add_u32 s64,s74,393216
s_add_u32 m0,s75,12288
s_nop 0
buffer_load_dwordx4 v8,s[32:35],s64 offen nt lds
s_add_u32 s64,s74,425984
s_add_u32 m0,s75,13312
s_nop 0
buffer_load_dwordx4 v9,s[32:35],s64 offen nt lds
s_add_u32 s64,s74,458752
s_add_u32 m0,s75,14336
s_nop 0
buffer_load_dwordx4 v10,s[32:35],s64 offen nt lds
s_add_u32 s64,s74,491520
s_add_u32 m0,s75,15360
s_nop 0
buffer_load_dwordx4 v11,s[32:35],s64 offen nt lds
s_add_u32 s64,s74,2097152
s_add_u32 m0,s75,65536
s_nop 0
buffer_load_dwordx4 v8,s[32:35],s64 offen nt lds
s_add_u32 s64,s74,2129920
s_add_u32 m0,s75,66560
s_nop 0
buffer_load_dwordx4 v9,s[32:35],s64 offen nt lds
s_add_u32 s64,s74,2162688
s_add_u32 m0,s75,67584
s_nop 0
buffer_load_dwordx4 v10,s[32:35],s64 offen nt lds
s_add_u32 s64,s74,2195456
s_add_u32 m0,s75,68608
s_nop 0
buffer_load_dwordx4 v11,s[32:35],s64 offen nt lds
s_add_u32 s64,s74,2228224
s_add_u32 m0,s75,69632
s_nop 0
buffer_load_dwordx4 v8,s[32:35],s64 offen nt lds
s_add_u32 s64,s74,2260992
s_add_u32 m0,s75,70656
s_nop 0
buffer_load_dwordx4 v9,s[32:35],s64 offen nt lds
s_add_u32 s64,s74,2293760
s_add_u32 m0,s75,71680
s_nop 0
buffer_load_dwordx4 v10,s[32:35],s64 offen nt lds
s_add_u32 s64,s74,2326528
s_add_u32 m0,s75,72704
s_nop 0
buffer_load_dwordx4 v11,s[32:35],s64 offen nt lds
s_add_u32 s64,s74,2359296
s_add_u32 m0,s75,73728
s_nop 0
buffer_load_dwordx4 v8,s[32:35],s64 offen nt lds
s_add_u32 s64,s74,2392064
s_add_u32 m0,s75,74752
s_nop 0
buffer_load_dwordx4 v9,s[32:35],s64 offen nt lds
s_add_u32 s64,s74,2424832
s_add_u32 m0,s75,75776
s_nop 0
buffer_load_dwordx4 v10,s[32:35],s64 offen nt lds
s_add_u32 s64,s74,2457600
s_add_u32 m0,s75,76800
s_nop 0
buffer_load_dwordx4 v11,s[32:35],s64 offen nt lds
s_add_u32 s64,s74,2490368
s_add_u32 m0,s75,77824
s_nop 0
buffer_load_dwordx4 v8,s[32:35],s64 offen nt lds
s_add_u32 s64,s74,2523136
s_add_u32 m0,s75,78848
s_nop 0
buffer_load_dwordx4 v9,s[32:35],s64 offen nt lds
s_add_u32 s64,s74,2555904
s_add_u32 m0,s75,79872
s_nop 0
buffer_load_dwordx4 v10,s[32:35],s64 offen nt lds
s_add_u32 s64,s74,2588672
s_add_u32 m0,s75,80896
s_nop 0
buffer_load_dwordx4 v11,s[32:35],s64 offen nt lds
s_waitcnt vmcnt(16)
s_barrier
ds_read_b64_tr_b16 a[0:1],v12 offset:0
ds_read_b64_tr_b16 a[2:3],v12 offset:512
ds_read_b64_tr_b16 a[128:129],v12 offset:8
ds_read_b64_tr_b16 a[130:131],v12 offset:520
ds_read_b64_tr_b16 a[4:5],v12 offset:8192
ds_read_b64_tr_b16 a[6:7],v12 offset:8704
ds_read_b64_tr_b16 a[132:133],v12 offset:8200
ds_read_b64_tr_b16 a[134:135],v12 offset:8712
s_waitcnt lgkmcnt(4)
ds_read_b64_tr_b16 a[8:9],v12 offset:16384
ds_read_b64_tr_b16 a[10:11],v12 offset:16896
ds_read_b64_tr_b16 a[136:137],v12 offset:16392
ds_read_b64_tr_b16 a[138:139],v12 offset:16904
ds_read_b64_tr_b16 a[12:13],v12 offset:24576
ds_read_b64_tr_b16 a[14:15],v12 offset:25088
ds_read_b64_tr_b16 a[140:141],v12 offset:24584
ds_read_b64_tr_b16 a[142:143],v12 offset:25096
s_waitcnt lgkmcnt(4)
ds_read_b64_tr_b16 a[16:17],v12 offset:32768
ds_read_b64_tr_b16 a[18:19],v12 offset:33280
ds_read_b64_tr_b16 a[144:145],v12 offset:32776
ds_read_b64_tr_b16 a[146:147],v12 offset:33288
ds_read_b64_tr_b16 a[20:21],v12 offset:40960
ds_read_b64_tr_b16 a[22:23],v12 offset:41472
ds_read_b64_tr_b16 a[148:149],v12 offset:40968
ds_read_b64_tr_b16 a[150:151],v12 offset:41480
s_waitcnt lgkmcnt(4)
ds_read_b64_tr_b16 a[24:25],v12 offset:49152
ds_read_b64_tr_b16 a[26:27],v12 offset:49664
ds_read_b64_tr_b16 a[152:153],v12 offset:49160
ds_read_b64_tr_b16 a[154:155],v12 offset:49672
ds_read_b64_tr_b16 a[28:29],v12 offset:57344
ds_read_b64_tr_b16 a[30:31],v12 offset:57856
ds_read_b64_tr_b16 a[156:157],v12 offset:57352
ds_read_b64_tr_b16 a[158:159],v12 offset:57864
s_waitcnt lgkmcnt(4)
v_xor_b32 v12,0x10000,v12
s_waitcnt lgkmcnt(0)
s_barrier
s_add_u32 s64,s74,4194304
s_add_u32 m0,s75,0
s_nop 0
buffer_load_dwordx4 v8,s[32:35],s64 offen nt lds
s_add_u32 s64,s74,4227072
s_add_u32 m0,s75,1024
s_nop 0
buffer_load_dwordx4 v9,s[32:35],s64 offen nt lds
s_add_u32 s64,s74,4259840
s_add_u32 m0,s75,2048
s_nop 0
buffer_load_dwordx4 v10,s[32:35],s64 offen nt lds
s_add_u32 s64,s74,4292608
s_add_u32 m0,s75,3072
s_nop 0
buffer_load_dwordx4 v11,s[32:35],s64 offen nt lds
s_add_u32 s64,s74,4325376
s_add_u32 m0,s75,4096
s_nop 0
buffer_load_dwordx4 v8,s[32:35],s64 offen nt lds
s_add_u32 s64,s74,4358144
s_add_u32 m0,s75,5120
s_nop 0
buffer_load_dwordx4 v9,s[32:35],s64 offen nt lds
s_add_u32 s64,s74,4390912
s_add_u32 m0,s75,6144
s_nop 0
buffer_load_dwordx4 v10,s[32:35],s64 offen nt lds
s_add_u32 s64,s74,4423680
s_add_u32 m0,s75,7168
s_nop 0
buffer_load_dwordx4 v11,s[32:35],s64 offen nt lds
s_add_u32 s64,s74,4456448
s_add_u32 m0,s75,8192
s_nop 0
buffer_load_dwordx4 v8,s[32:35],s64 offen nt lds
s_add_u32 s64,s74,4489216
s_add_u32 m0,s75,9216
s_nop 0
buffer_load_dwordx4 v9,s[32:35],s64 offen nt lds
s_add_u32 s64,s74,4521984
s_add_u32 m0,s75,10240
s_nop 0
buffer_load_dwordx4 v10,s[32:35],s64 offen nt lds
s_add_u32 s64,s74,4554752
s_add_u32 m0,s75,11264
s_nop 0
buffer_load_dwordx4 v11,s[32:35],s64 offen nt lds
s_add_u32 s64,s74,4587520
s_add_u32 m0,s75,12288
s_nop 0
buffer_load_dwordx4 v8,s[32:35],s64 offen nt lds
s_add_u32 s64,s74,4620288
s_add_u32 m0,s75,13312
s_nop 0
buffer_load_dwordx4 v9,s[32:35],s64 offen nt lds
s_add_u32 s64,s74,4653056
s_add_u32 m0,s75,14336
s_nop 0
buffer_load_dwordx4 v10,s[32:35],s64 offen nt lds
s_add_u32 s64,s74,4685824
s_add_u32 m0,s75,15360
s_nop 0
buffer_load_dwordx4 v11,s[32:35],s64 offen nt lds
s_waitcnt vmcnt(16)
s_barrier
ds_read_b64_tr_b16 a[32:33],v12 offset:0
ds_read_b64_tr_b16 a[34:35],v12 offset:512
ds_read_b64_tr_b16 a[160:161],v12 offset:8
ds_read_b64_tr_b16 a[162:163],v12 offset:520
ds_read_b64_tr_b16 a[36:37],v12 offset:8192
ds_read_b64_tr_b16 a[38:39],v12 offset:8704
ds_read_b64_tr_b16 a[164:165],v12 offset:8200
ds_read_b64_tr_b16 a[166:167],v12 offset:8712
s_waitcnt lgkmcnt(4)
ds_read_b64_tr_b16 a[40:41],v12 offset:16384
ds_read_b64_tr_b16 a[42:43],v12 offset:16896
ds_read_b64_tr_b16 a[168:169],v12 offset:16392
ds_read_b64_tr_b16 a[170:171],v12 offset:16904
ds_read_b64_tr_b16 a[44:45],v12 offset:24576
ds_read_b64_tr_b16 a[46:47],v12 offset:25088
ds_read_b64_tr_b16 a[172:173],v12 offset:24584
ds_read_b64_tr_b16 a[174:175],v12 offset:25096
s_waitcnt lgkmcnt(4)
ds_read_b64_tr_b16 a[48:49],v12 offset:32768
ds_read_b64_tr_b16 a[50:51],v12 offset:33280
ds_read_b64_tr_b16 a[176:177],v12 offset:32776
ds_read_b64_tr_b16 a[178:179],v12 offset:33288
ds_read_b64_tr_b16 a[52:53],v12 offset:40960
ds_read_b64_tr_b16 a[54:55],v12 offset:41472
ds_read_b64_tr_b16 a[180:181],v12 offset:40968
ds_read_b64_tr_b16 a[182:183],v12 offset:41480
s_waitcnt lgkmcnt(4)
ds_read_b64_tr_b16 a[56:57],v12 offset:49152
ds_read_b64_tr_b16 a[58:59],v12 offset:49664
ds_read_b64_tr_b16 a[184:185],v12 offset:49160
ds_read_b64_tr_b16 a[186:187],v12 offset:49672
ds_read_b64_tr_b16 a[60:61],v12 offset:57344
ds_read_b64_tr_b16 a[62:63],v12 offset:57856
ds_read_b64_tr_b16 a[188:189],v12 offset:57352
ds_read_b64_tr_b16 a[190:191],v12 offset:57864
s_waitcnt lgkmcnt(4)
v_xor_b32 v12,0x10000,v12
s_waitcnt lgkmcnt(0)
s_barrier
s_add_u32 s64,s74,6291456
s_add_u32 m0,s75,65536
s_nop 0
buffer_load_dwordx4 v8,s[32:35],s64 offen nt lds
s_add_u32 s64,s74,6324224
s_add_u32 m0,s75,66560
s_nop 0
buffer_load_dwordx4 v9,s[32:35],s64 offen nt lds
s_add_u32 s64,s74,6356992
s_add_u32 m0,s75,67584
s_nop 0
buffer_load_dwordx4 v10,s[32:35],s64 offen nt lds
s_add_u32 s64,s74,6389760
s_add_u32 m0,s75,68608
s_nop 0
buffer_load_dwordx4 v11,s[32:35],s64 offen nt lds
s_add_u32 s64,s74,6422528
s_add_u32 m0,s75,69632
s_nop 0
buffer_load_dwordx4 v8,s[32:35],s64 offen nt lds
s_add_u32 s64,s74,6455296
s_add_u32 m0,s75,70656
s_nop 0
buffer_load_dwordx4 v9,s[32:35],s64 offen nt lds
s_add_u32 s64,s74,6488064
s_add_u32 m0,s75,71680
s_nop 0
buffer_load_dwordx4 v10,s[32:35],s64 offen nt lds
s_add_u32 s64,s74,6520832
s_add_u32 m0,s75,72704
s_nop 0
buffer_load_dwordx4 v11,s[32:35],s64 offen nt lds
s_add_u32 s64,s74,6553600
s_add_u32 m0,s75,73728
s_nop 0
buffer_load_dwordx4 v8,s[32:35],s64 offen nt lds
s_add_u32 s64,s74,6586368
s_add_u32 m0,s75,74752
s_nop 0
buffer_load_dwordx4 v9,s[32:35],s64 offen nt lds
s_add_u32 s64,s74,6619136
s_add_u32 m0,s75,75776
s_nop 0
buffer_load_dwordx4 v10,s[32:35],s64 offen nt lds
s_add_u32 s64,s74,6651904
s_add_u32 m0,s75,76800
s_nop 0
buffer_load_dwordx4 v11,s[32:35],s64 offen nt lds
s_add_u32 s64,s74,6684672
s_add_u32 m0,s75,77824
s_nop 0
buffer_load_dwordx4 v8,s[32:35],s64 offen nt lds
s_add_u32 s64,s74,6717440
s_add_u32 m0,s75,78848
s_nop 0
buffer_load_dwordx4 v9,s[32:35],s64 offen nt lds
s_add_u32 s64,s74,6750208
s_add_u32 m0,s75,79872
s_nop 0
buffer_load_dwordx4 v10,s[32:35],s64 offen nt lds
s_add_u32 s64,s74,6782976
s_add_u32 m0,s75,80896
s_nop 0
buffer_load_dwordx4 v11,s[32:35],s64 offen nt lds
s_waitcnt vmcnt(16)
s_barrier
ds_read_b64_tr_b16 a[64:65],v12 offset:0
ds_read_b64_tr_b16 a[66:67],v12 offset:512
ds_read_b64_tr_b16 a[192:193],v12 offset:8
ds_read_b64_tr_b16 a[194:195],v12 offset:520
ds_read_b64_tr_b16 a[68:69],v12 offset:8192
ds_read_b64_tr_b16 a[70:71],v12 offset:8704
ds_read_b64_tr_b16 a[196:197],v12 offset:8200
ds_read_b64_tr_b16 a[198:199],v12 offset:8712
s_waitcnt lgkmcnt(4)
ds_read_b64_tr_b16 a[72:73],v12 offset:16384
ds_read_b64_tr_b16 a[74:75],v12 offset:16896
ds_read_b64_tr_b16 a[200:201],v12 offset:16392
ds_read_b64_tr_b16 a[202:203],v12 offset:16904
ds_read_b64_tr_b16 a[76:77],v12 offset:24576
ds_read_b64_tr_b16 a[78:79],v12 offset:25088
ds_read_b64_tr_b16 a[204:205],v12 offset:24584
ds_read_b64_tr_b16 a[206:207],v12 offset:25096
s_waitcnt lgkmcnt(4)
ds_read_b64_tr_b16 a[80:81],v12 offset:32768
ds_read_b64_tr_b16 a[82:83],v12 offset:33280
ds_read_b64_tr_b16 a[208:209],v12 offset:32776
ds_read_b64_tr_b16 a[210:211],v12 offset:33288
ds_read_b64_tr_b16 a[84:85],v12 offset:40960
ds_read_b64_tr_b16 a[86:87],v12 offset:41472
ds_read_b64_tr_b16 a[212:213],v12 offset:40968
ds_read_b64_tr_b16 a[214:215],v12 offset:41480
s_waitcnt lgkmcnt(4)
ds_read_b64_tr_b16 a[88:89],v12 offset:49152
ds_read_b64_tr_b16 a[90:91],v12 offset:49664
ds_read_b64_tr_b16 a[216:217],v12 offset:49160
ds_read_b64_tr_b16 a[218:219],v12 offset:49672
ds_read_b64_tr_b16 a[92:93],v12 offset:57344
ds_read_b64_tr_b16 a[94:95],v12 offset:57856
ds_read_b64_tr_b16 a[220:221],v12 offset:57352
ds_read_b64_tr_b16 a[222:223],v12 offset:57864
s_waitcnt lgkmcnt(4)
v_xor_b32 v12,0x10000,v12
s_waitcnt lgkmcnt(0)
s_barrier
s_waitcnt vmcnt(0)
s_barrier
ds_read_b64_tr_b16 a[96:97],v12 offset:0
ds_read_b64_tr_b16 a[98:99],v12 offset:512
ds_read_b64_tr_b16 a[224:225],v12 offset:8
ds_read_b64_tr_b16 a[226:227],v12 offset:520
ds_read_b64_tr_b16 a[100:101],v12 offset:8192
ds_read_b64_tr_b16 a[102:103],v12 offset:8704
ds_read_b64_tr_b16 a[228:229],v12 offset:8200
ds_read_b64_tr_b16 a[230:231],v12 offset:8712
s_waitcnt lgkmcnt(4)
ds_read_b64_tr_b16 a[104:105],v12 offset:16384
ds_read_b64_tr_b16 a[106:107],v12 offset:16896
ds_read_b64_tr_b16 a[232:233],v12 offset:16392
ds_read_b64_tr_b16 a[234:235],v12 offset:16904
ds_read_b64_tr_b16 a[108:109],v12 offset:24576
ds_read_b64_tr_b16 a[110:111],v12 offset:25088
ds_read_b64_tr_b16 a[236:237],v12 offset:24584
ds_read_b64_tr_b16 a[238:239],v12 offset:25096
s_waitcnt lgkmcnt(4)
ds_read_b64_tr_b16 a[112:113],v12 offset:32768
ds_read_b64_tr_b16 a[114:115],v12 offset:33280
ds_read_b64_tr_b16 a[240:241],v12 offset:32776
ds_read_b64_tr_b16 a[242:243],v12 offset:33288
ds_read_b64_tr_b16 a[116:117],v12 offset:40960
ds_read_b64_tr_b16 a[118:119],v12 offset:41472
ds_read_b64_tr_b16 a[244:245],v12 offset:40968
ds_read_b64_tr_b16 a[246:247],v12 offset:41480
s_waitcnt lgkmcnt(4)
ds_read_b64_tr_b16 a[120:121],v12 offset:49152
ds_read_b64_tr_b16 a[122:123],v12 offset:49664
ds_read_b64_tr_b16 a[248:249],v12 offset:49160
ds_read_b64_tr_b16 a[250:251],v12 offset:49672
ds_read_b64_tr_b16 a[124:125],v12 offset:57344
ds_read_b64_tr_b16 a[126:127],v12 offset:57856
ds_read_b64_tr_b16 a[252:253],v12 offset:57352
ds_read_b64_tr_b16 a[254:255],v12 offset:57864
s_waitcnt lgkmcnt(4)
v_xor_b32 v12,0x10000,v12
s_waitcnt lgkmcnt(0)
s_barrier
v_and_b32 v21,7,v1
v_lshlrev_b32 v21,6,v21
s_mov_b32 s65,21052416
s_mov_b32 s66,1792
pl_200:
buffer_load_dword v22,v21,s[20:23],s65 offen sc1
s_waitcnt vmcnt(0)
v_cmp_gt_u32 vcc,s66,v22
s_cbranch_vccz pok_201
s_sleep 1
s_sub_u32 s90,s90,1
s_cmp_gt_i32 s90,0
s_cbranch_scc1 pl_200
pok_201:
s_lshl_b32 s72,s50,14
s_lshl_b32 s74,s58,16
s_add_u32 s74,s74,s72
s_add_u32 s74,s74,57344
v_mov_b32 v17,v16
s_lshl_b32 s64,s59,14
s_lshl_b32 s65,s50,11
s_add_u32 s64,s64,s65
v_add_u32 v18,s64,v16
s_lshl_b32 s73,s58,5
s_add_u32 s73,s73,s59
s_lshl_b32 s73,s73,2
s_add_u32 s73,s73,s63
v_lshlrev_b32 v24,4,v0
s_mov_b32 s79,s58
s_add_u32 m0,s72,0
s_add_u32 s65,s74,0
buffer_load_dwordx4 v16,s[20:23],s65 offen offset:0  lds
buffer_load_dwordx4 v16,s[20:23],s65 offen offset:1024  lds
buffer_load_dwordx4 v16,s[20:23],s65 offen offset:2048  lds
buffer_load_dwordx4 v16,s[20:23],s65 offen offset:3072  lds
s_add_u32 m0,s72,4096
s_add_u32 s65,s74,4096
buffer_load_dwordx4 v16,s[20:23],s65 offen offset:0  lds
buffer_load_dwordx4 v16,s[20:23],s65 offen offset:1024  lds
buffer_load_dwordx4 v16,s[20:23],s65 offen offset:2048  lds
buffer_load_dwordx4 v16,s[20:23],s65 offen offset:3072  lds
s_add_u32 m0,s72,8192
s_add_u32 s65,s74,8192
buffer_load_dwordx4 v16,s[20:23],s65 offen offset:0  lds
buffer_load_dwordx4 v16,s[20:23],s65 offen offset:1024  lds
buffer_load_dwordx4 v16,s[20:23],s65 offen offset:2048  lds
buffer_load_dwordx4 v16,s[20:23],s65 offen offset:3072  lds
s_add_u32 m0,s72,12288
s_add_u32 s65,s74,12288
buffer_load_dwordx4 v16,s[20:23],s65 offen offset:0  lds
buffer_load_dwordx4 v16,s[20:23],s65 offen offset:1024  lds
buffer_load_dwordx4 v16,s[20:23],s65 offen offset:2048  lds
buffer_load_dwordx4 v16,s[20:23],s65 offen offset:3072  lds
s_waitcnt vmcnt(0)
s_add_u32 s41,s58,55
s_sub_u32 s64,s58,1
s_cmp_lt_u32 s64,2
s_cselect_b32 s41,s41,64
s_lshl_b32 s76,s50,14
s_add_u32 s76,s76,57344
s_add_u32 s42,s55,32
s_lshl_b32 s42,s42,14
s_add_u32 s42,s42,113246208
s_xor_b32 s64,s62,0
s_add_u32 s42,s42,s64
s_sub_u32 s64,s42,2097152
s_xor_b32 s64,s64,0x2000
s_cmp_lt_u32 s55,104
s_cselect_b32 s64,s64,0x7fff0000
s_cmp_lt_u32 s55,96
s_cselect_b32 s42,s42,s64
s_cmp_lt_u32 s55,32
s_cselect_b32 s64,29360128,0
s_add_u32 s42,s42,s64
v_add_u32 v25,4096,v24
s_load_dwordx2 s[4:5],s[0:1],96
s_load_dwordx2 s[6:7],s[0:1],104
v_and_b32 v5,3,v0
v_lshrrev_b32 v6,2,v0
v_mul_u32_u24 v112,12288,v6
v_lshl_add_u32 v112,v5,4,v112
v_lshlrev_b32 v113,1,v6
s_add_u32 s43,s55,64
s_lshl_b32 s43,s43,6
s_mov_b32 s48,0
s_mov_b32 s80,0xffff0000
s_mov_b32 s81,0xbfb8aa3b
s_waitcnt lgkmcnt(0)
s_mov_b32 s12,s4
s_and_b32 s13,s5,0xffff
s_mov_b32 s14,0x800
s_mov_b32 s15,0x20000
s_mov_b32 s16,s6
s_and_b32 s17,s7,0xffff
s_mov_b32 s18,0xc00000
s_mov_b32 s19,0x20000
buffer_load_dwordx4 v[104:107],v112,s[16:19],s43 offen nt
buffer_load_ushort v108,v113,s[12:15],s48 offen
s_add_u32 s43,s43,786432
s_add_u32 s48,s48,128
buffer_load_dwordx4 v[116:119],v112,s[16:19],s43 offen nt
buffer_load_ushort v120,v113,s[12:15],s48 offen
s_add_u32 s43,s43,786432
s_add_u32 s48,s48,128
v_mov_b32 v96,0
v_mov_b32 v97,0
v_mov_b32 v98,0
v_mov_b32 v99,0
v_mov_b32 v100,0
v_mov_b32 v101,0
v_mov_b32 v102,0
v_mov_b32 v103,0
s_waitcnt vmcnt(0)
qloop_202:
s_lshr_b32 s64,s79,2
s_cmp_lg_u32 s64,4
s_cbranch_scc1 np2_204
s_waitcnt vmcnt(0)
s_barrier
s_cmp_lg_u32 s50,0
s_cbranch_scc1 ow_205
s_mov_b64 exec,1
v_mov_b32 v22,14
v_mov_b32 v23,0
s_mov_b32 s64,21052928
buffer_atomic_add v22,v23,s[20:23],s64 offen sc1
s_mov_b64 exec,-1
ow_205:
np2_204:
s_cmp_lg_u32 s79,s41
s_cbranch_scc1 npz_203
s_waitcnt vmcnt(0)
s_barrier
s_cmp_lg_u32 s50,0
s_cbranch_scc1 ow_206
s_mov_b64 exec,1
v_mov_b32 v22,14
v_mov_b32 v23,0
s_mov_b32 s64,21052992
buffer_atomic_add v22,v23,s[20:23],s64 offen sc1
s_mov_b64 exec,-1
ow_206:
s_cmp_lg_u32 s50,0
s_cbranch_scc1 ow_207
s_mov_b64 exec,1
v_mov_b32 v22,14
v_mov_b32 v23,0
buffer_store_dword v22,v23,s[20:23],s73 offen sc1
s_mov_b64 exec,-1
ow_207:
npz_203:
s_waitcnt vmcnt(10)
s_barrier
ds_read_b128 v[224:227],v17 offset:0
ds_read_b128 v[228:231],v17 offset:2048
ds_read_b128 v[232:235],v17 offset:4096
ds_read_b128 v[236:239],v17 offset:6144
ds_read_b128 v[240:243],v17 offset:8192
ds_read_b128 v[244:247],v17 offset:10240
ds_read_b128 v[248:251],v17 offset:12288
s_waitcnt lgkmcnt(5)
v_mfma_f32_16x16x32_bf16 v[64:67],a[0:3],v[224:227],0
s_xor_b32 s72,s72,0x10000
s_add_u32 s77,s79,2
v_mfma_f32_16x16x32_bf16 v[72:75],a[128:131],v[224:227],0
ds_read_b128 v[252:255],v17 offset:14336
s_cmp_lt_u32 s79,56
s_cselect_b32 s77,s41,s77
v_mfma_f32_16x16x32_bf16 v[64:67],a[4:7],v[228:231],v[64:67]
s_add_u32 s74,s79,4
s_cmp_lt_u32 s79,52
s_cselect_b32 s77,s74,s77
v_mfma_f32_16x16x32_bf16 v[72:75],a[132:135],v[228:231],v[72:75]
ds_read_b128 v[224:227],v17 offset:16384
v_lshlrev_b32 v108,16,v108
s_waitcnt lgkmcnt(5)
v_mfma_f32_16x16x32_bf16 v[64:67],a[8:11],v[232:235],v[64:67]
s_lshl_b32 s74,s77,16
s_add_u32 s74,s74,s76
v_mul_f32 v109,s81,v108
v_mfma_f32_16x16x32_bf16 v[72:75],a[136:139],v[232:235],v[72:75]
ds_read_b128 v[228:231],v17 offset:18432
s_add_u32 s64,s79,0
v_mfma_f32_16x16x32_bf16 v[64:67],a[12:15],v[236:239],v[64:67]
s_cmp_lt_u32 s77,64
s_cselect_b32 s74,s74,0x7fff0000
v_mfma_f32_16x16x32_bf16 v[72:75],a[140:143],v[236:239],v[72:75]
ds_read_b128 v[232:235],v17 offset:20480
s_waitcnt lgkmcnt(5)
v_mfma_f32_16x16x32_bf16 v[64:67],a[16:19],v[240:243],v[64:67]
s_add_u32 m0,s72,0
v_exp_f32 v109,v109
v_mfma_f32_16x16x32_bf16 v[72:75],a[144:147],v[240:243],v[72:75]
ds_read_b128 v[236:239],v17 offset:22528
v_add_f32 v109,1.0,v109
v_mfma_f32_16x16x32_bf16 v[64:67],a[20:23],v[244:247],v[64:67]
s_add_u32 s65,s74,0
s_lshl_b32 s70,s64,21
v_mfma_f32_16x16x32_bf16 v[72:75],a[148:151],v[244:247],v[72:75]
ds_read_b128 v[240:243],v17 offset:24576
s_waitcnt lgkmcnt(5)
v_mfma_f32_16x16x32_bf16 v[64:67],a[24:27],v[248:251],v[64:67]
v_rcp_f32 v109,v109
v_mfma_f32_16x16x32_bf16 v[72:75],a[152:155],v[248:251],v[72:75]
ds_read_b128 v[244:247],v17 offset:26624
v_mul_f32 v109,v109,v108
v_mfma_f32_16x16x32_bf16 v[64:67],a[28:31],v[252:255],v[64:67]
buffer_load_dwordx4 v16,s[20:23],s65 offen offset:0  lds
v_mfma_f32_16x16x32_bf16 v[72:75],a[156:159],v[252:255],v[72:75]
ds_read_b128 v[248:251],v17 offset:28672
s_waitcnt lgkmcnt(5)
v_mfma_f32_16x16x32_bf16 v[64:67],a[32:35],v[224:227],v[64:67]
buffer_load_dwordx4 v16,s[20:23],s65 offen offset:1024  lds
v_mfma_f32_16x16x32_bf16 v[72:75],a[160:163],v[224:227],v[72:75]
ds_read_b128 v[252:255],v17 offset:30720
s_lshl_b32 s64,s64,13
v_mfma_f32_16x16x32_bf16 v[64:67],a[36:39],v[228:231],v[64:67]
buffer_load_dwordx4 v16,s[20:23],s65 offen offset:2048  lds
v_mfma_f32_16x16x32_bf16 v[72:75],a[164:167],v[228:231],v[72:75]
ds_read_b128 v[224:227],v17 offset:32768
s_waitcnt lgkmcnt(5)
v_mfma_f32_16x16x32_bf16 v[64:67],a[40:43],v[232:235],v[64:67]
buffer_load_dwordx4 v16,s[20:23],s65 offen offset:3072  lds
v_mfma_f32_16x16x32_bf16 v[72:75],a[168:171],v[232:235],v[72:75]
ds_read_b128 v[228:231],v17 offset:34816
s_and_b32 s64,s64,0x2000
v_mfma_f32_16x16x32_bf16 v[64:67],a[44:47],v[236:239],v[64:67]
v_cvt_pk_bf16_f32 v109,v109,v109
v_and_b32 v108,s80,v109
v_mfma_f32_16x16x32_bf16 v[72:75],a[172:175],v[236:239],v[72:75]
ds_read_b128 v[232:235],v17 offset:36864
s_waitcnt lgkmcnt(5)
v_mfma_f32_16x16x32_bf16 v[64:67],a[48:51],v[240:243],v[64:67]
s_add_u32 m0,s72,4096
v_lshlrev_b32 v110,16,v104
v_mfma_f32_16x16x32_bf16 v[72:75],a[176:179],v[240:243],v[72:75]
ds_read_b128 v[236:239],v17 offset:38912
s_add_u32 s65,s74,4096
v_mfma_f32_16x16x32_bf16 v[64:67],a[52:55],v[244:247],v[64:67]
s_xor_b32 s64,s64,s62
v_and_b32 v111,s80,v104
v_mfma_f32_16x16x32_bf16 v[72:75],a[180:183],v[244:247],v[72:75]
ds_read_b128 v[240:243],v17 offset:40960
s_waitcnt lgkmcnt(5)
v_mfma_f32_16x16x32_bf16 v[64:67],a[56:59],v[248:251],v[64:67]
buffer_load_dwordx4 v16,s[20:23],s65 offen offset:0  lds
v_mfma_f32_16x16x32_bf16 v[72:75],a[184:187],v[248:251],v[72:75]
ds_read_b128 v[244:247],v17 offset:43008
v_fmac_f32 v96,v110,v108
v_mfma_f32_16x16x32_bf16 v[64:67],a[60:63],v[252:255],v[64:67]
buffer_load_dwordx4 v16,s[20:23],s65 offen offset:1024  lds
v_mfma_f32_16x16x32_bf16 v[72:75],a[188:191],v[252:255],v[72:75]
ds_read_b128 v[248:251],v17 offset:45056
s_waitcnt lgkmcnt(5)
v_mfma_f32_16x16x32_bf16 v[64:67],a[64:67],v[224:227],v[64:67]
s_add_u32 s70,s70,s64
v_fmac_f32 v97,v111,v108
v_mfma_f32_16x16x32_bf16 v[72:75],a[192:195],v[224:227],v[72:75]
ds_read_b128 v[252:255],v17 offset:47104
v_lshlrev_b32 v110,16,v105
v_mfma_f32_16x16x32_bf16 v[64:67],a[68:71],v[228:231],v[64:67]
buffer_load_dwordx4 v16,s[20:23],s65 offen offset:2048  lds
v_mfma_f32_16x16x32_bf16 v[72:75],a[196:199],v[228:231],v[72:75]
ds_read_b128 v[224:227],v17 offset:49152
s_waitcnt lgkmcnt(5)
v_mfma_f32_16x16x32_bf16 v[64:67],a[72:75],v[232:235],v[64:67]
buffer_load_dwordx4 v16,s[20:23],s65 offen offset:3072  lds
v_mfma_f32_16x16x32_bf16 v[72:75],a[200:203],v[232:235],v[72:75]
ds_read_b128 v[228:231],v17 offset:51200
s_add_u32 s70,s70,29360128
v_mfma_f32_16x16x32_bf16 v[64:67],a[76:79],v[236:239],v[64:67]
s_add_u32 m0,s72,8192
v_and_b32 v111,s80,v105
v_mfma_f32_16x16x32_bf16 v[72:75],a[204:207],v[236:239],v[72:75]
ds_read_b128 v[232:235],v17 offset:53248
s_waitcnt lgkmcnt(5)
v_mfma_f32_16x16x32_bf16 v[64:67],a[80:83],v[240:243],v[64:67]
s_add_u32 s65,s74,8192
v_fmac_f32 v98,v110,v108
v_mfma_f32_16x16x32_bf16 v[72:75],a[208:211],v[240:243],v[72:75]
ds_read_b128 v[236:239],v17 offset:55296
v_fmac_f32 v99,v111,v108
v_mfma_f32_16x16x32_bf16 v[64:67],a[84:87],v[244:247],v[64:67]
v_lshlrev_b32 v110,16,v106
v_and_b32 v111,s80,v106
v_mfma_f32_16x16x32_bf16 v[72:75],a[212:215],v[244:247],v[72:75]
ds_read_b128 v[240:243],v17 offset:57344
s_waitcnt lgkmcnt(5)
v_mfma_f32_16x16x32_bf16 v[64:67],a[88:91],v[248:251],v[64:67]
buffer_load_dwordx4 v16,s[20:23],s65 offen offset:0  lds
v_mfma_f32_16x16x32_bf16 v[72:75],a[216:219],v[248:251],v[72:75]
ds_read_b128 v[244:247],v17 offset:59392
v_fmac_f32 v100,v110,v108
v_mfma_f32_16x16x32_bf16 v[64:67],a[92:95],v[252:255],v[64:67]
buffer_load_dwordx4 v16,s[20:23],s65 offen offset:1024  lds
v_mfma_f32_16x16x32_bf16 v[72:75],a[220:223],v[252:255],v[72:75]
ds_read_b128 v[248:251],v17 offset:61440
s_waitcnt lgkmcnt(5)
v_mfma_f32_16x16x32_bf16 v[64:67],a[96:99],v[224:227],v[64:67]
buffer_load_dwordx4 v16,s[20:23],s65 offen offset:2048  lds
v_mfma_f32_16x16x32_bf16 v[72:75],a[224:227],v[224:227],v[72:75]
ds_read_b128 v[252:255],v17 offset:63488
v_fmac_f32 v101,v111,v108
v_mfma_f32_16x16x32_bf16 v[64:67],a[100:103],v[228:231],v[64:67]
buffer_load_dwordx4 v16,s[20:23],s65 offen offset:3072  lds
v_mfma_f32_16x16x32_bf16 v[72:75],a[228:231],v[228:231],v[72:75]
ds_read_b128 v[224:227],v17 offset:1024
s_waitcnt lgkmcnt(5)
v_mfma_f32_16x16x32_bf16 v[64:67],a[104:107],v[232:235],v[64:67]
v_lshlrev_b32 v110,16,v107
v_and_b32 v111,s80,v107
v_mfma_f32_16x16x32_bf16 v[72:75],a[232:235],v[232:235],v[72:75]
ds_read_b128 v[228:231],v17 offset:3072
s_add_u32 m0,s72,12288
v_mfma_f32_16x16x32_bf16 v[64:67],a[108:111],v[236:239],v[64:67]
v_fmac_f32 v102,v110,v108
v_fmac_f32 v103,v111,v108
v_mfma_f32_16x16x32_bf16 v[72:75],a[236:239],v[236:239],v[72:75]
ds_read_b128 v[232:235],v17 offset:5120
s_waitcnt lgkmcnt(5)
v_mfma_f32_16x16x32_bf16 v[64:67],a[112:115],v[240:243],v[64:67]
s_add_u32 s65,s74,12288
v_mfma_f32_16x16x32_bf16 v[72:75],a[240:243],v[240:243],v[72:75]
ds_read_b128 v[236:239],v17 offset:7168
v_mfma_f32_16x16x32_bf16 v[64:67],a[116:119],v[244:247],v[64:67]
buffer_load_dwordx4 v16,s[20:23],s65 offen offset:0  lds
v_mfma_f32_16x16x32_bf16 v[72:75],a[244:247],v[244:247],v[72:75]
ds_read_b128 v[240:243],v17 offset:9216
s_waitcnt lgkmcnt(5)
v_mfma_f32_16x16x32_bf16 v[64:67],a[120:123],v[248:251],v[64:67]
buffer_load_dwordx4 v16,s[20:23],s65 offen offset:1024  lds
v_mfma_f32_16x16x32_bf16 v[72:75],a[248:251],v[248:251],v[72:75]
ds_read_b128 v[244:247],v17 offset:11264
v_mfma_f32_16x16x32_bf16 v[64:67],a[124:127],v[252:255],v[64:67]
v_mfma_f32_16x16x32_bf16 v[72:75],a[252:255],v[252:255],v[72:75]
ds_read_b128 v[248:251],v17 offset:13312
s_waitcnt lgkmcnt(5)
v_mfma_f32_16x16x32_bf16 v[68:71],a[0:3],v[224:227],0
buffer_load_dwordx4 v16,s[20:23],s65 offen offset:2048  lds
v_mfma_f32_16x16x32_bf16 v[76:79],a[128:131],v[224:227],0
ds_read_b128 v[252:255],v17 offset:15360
v_mfma_f32_16x16x32_bf16 v[68:71],a[4:7],v[228:231],v[68:71]
buffer_load_dwordx4 v16,s[20:23],s65 offen offset:3072  lds
v_mfma_f32_16x16x32_bf16 v[76:79],a[132:135],v[228:231],v[76:79]
ds_read_b128 v[224:227],v17 offset:17408
s_waitcnt lgkmcnt(5)
v_mfma_f32_16x16x32_bf16 v[68:71],a[8:11],v[232:235],v[68:71]
v_cvt_pk_bf16_f32 v88,v64,v65
v_cvt_pk_bf16_f32 v89,v66,v67
v_cvt_pk_bf16_f32 v90,v72,v73
v_cvt_pk_bf16_f32 v91,v74,v75
v_mfma_f32_16x16x32_bf16 v[76:79],a[136:139],v[232:235],v[76:79]
ds_read_b128 v[228:231],v17 offset:19456
v_mfma_f32_16x16x32_bf16 v[68:71],a[12:15],v[236:239],v[68:71]
v_mfma_f32_16x16x32_bf16 v[76:79],a[140:143],v[236:239],v[76:79]
ds_read_b128 v[232:235],v17 offset:21504
s_waitcnt lgkmcnt(5)
v_mfma_f32_16x16x32_bf16 v[68:71],a[16:19],v[240:243],v[68:71]
buffer_store_dwordx4 v[88:91],v18,s[20:23],s70 offen offset:0 sc1
v_mfma_f32_16x16x32_bf16 v[76:79],a[144:147],v[240:243],v[76:79]
ds_read_b128 v[236:239],v17 offset:23552
v_mfma_f32_16x16x32_bf16 v[68:71],a[20:23],v[244:247],v[68:71]
buffer_load_dwordx4 v[104:107],v112,s[16:19],s43 offen nt
v_mfma_f32_16x16x32_bf16 v[76:79],a[148:151],v[244:247],v[76:79]
ds_read_b128 v[240:243],v17 offset:25600
s_waitcnt lgkmcnt(5)
v_mfma_f32_16x16x32_bf16 v[68:71],a[24:27],v[248:251],v[68:71]
buffer_load_ushort v108,v113,s[12:15],s48 offen
v_mfma_f32_16x16x32_bf16 v[76:79],a[152:155],v[248:251],v[76:79]
ds_read_b128 v[244:247],v17 offset:27648
v_mfma_f32_16x16x32_bf16 v[68:71],a[28:31],v[252:255],v[68:71]
v_mfma_f32_16x16x32_bf16 v[76:79],a[156:159],v[252:255],v[76:79]
ds_read_b128 v[248:251],v17 offset:29696
s_waitcnt lgkmcnt(5)
v_mfma_f32_16x16x32_bf16 v[68:71],a[32:35],v[224:227],v[68:71]
s_add_u32 s43,s43,786432
v_mfma_f32_16x16x32_bf16 v[76:79],a[160:163],v[224:227],v[76:79]
ds_read_b128 v[252:255],v17 offset:31744
v_mfma_f32_16x16x32_bf16 v[68:71],a[36:39],v[228:231],v[68:71]
s_add_u32 s48,s48,128
v_mfma_f32_16x16x32_bf16 v[76:79],a[164:167],v[228:231],v[76:79]
ds_read_b128 v[224:227],v17 offset:33792
s_waitcnt lgkmcnt(5)
v_mfma_f32_16x16x32_bf16 v[68:71],a[40:43],v[232:235],v[68:71]
v_mfma_f32_16x16x32_bf16 v[76:79],a[168:171],v[232:235],v[76:79]
ds_read_b128 v[228:231],v17 offset:35840
v_mfma_f32_16x16x32_bf16 v[68:71],a[44:47],v[236:239],v[68:71]
buffer_store_dwordx4 v[48:51],v24,s[20:23],s93 offen sc1
v_mfma_f32_16x16x32_bf16 v[76:79],a[172:175],v[236:239],v[76:79]
ds_read_b128 v[232:235],v17 offset:37888
s_waitcnt lgkmcnt(5)
v_mfma_f32_16x16x32_bf16 v[68:71],a[48:51],v[240:243],v[68:71]
buffer_store_dwordx4 v[48:51],v25,s[20:23],s93 offen sc1
v_mfma_f32_16x16x32_bf16 v[76:79],a[176:179],v[240:243],v[76:79]
ds_read_b128 v[236:239],v17 offset:39936
v_mfma_f32_16x16x32_bf16 v[68:71],a[52:55],v[244:247],v[68:71]
v_mfma_f32_16x16x32_bf16 v[76:79],a[180:183],v[244:247],v[76:79]
ds_read_b128 v[240:243],v17 offset:41984
s_waitcnt lgkmcnt(5)
v_mfma_f32_16x16x32_bf16 v[68:71],a[56:59],v[248:251],v[68:71]
s_add_u32 s93,s93,8388608
v_mfma_f32_16x16x32_bf16 v[76:79],a[184:187],v[248:251],v[76:79]
ds_read_b128 v[244:247],v17 offset:44032
v_mfma_f32_16x16x32_bf16 v[68:71],a[60:63],v[252:255],v[68:71]
s_cmp_lt_u32 s93,163577856
s_cselect_b32 s93,s93,0x7fff0000
v_mfma_f32_16x16x32_bf16 v[76:79],a[188:191],v[252:255],v[76:79]
ds_read_b128 v[248:251],v17 offset:46080
s_waitcnt lgkmcnt(5)
v_mfma_f32_16x16x32_bf16 v[68:71],a[64:67],v[224:227],v[68:71]
v_mfma_f32_16x16x32_bf16 v[76:79],a[192:195],v[224:227],v[76:79]
ds_read_b128 v[252:255],v17 offset:48128
v_mfma_f32_16x16x32_bf16 v[68:71],a[68:71],v[228:231],v[68:71]
buffer_store_dwordx4 v[48:51],v24,s[20:23],s42 offen sc1
v_mfma_f32_16x16x32_bf16 v[76:79],a[196:199],v[228:231],v[76:79]
ds_read_b128 v[224:227],v17 offset:50176
s_waitcnt lgkmcnt(5)
v_mfma_f32_16x16x32_bf16 v[68:71],a[72:75],v[232:235],v[68:71]
buffer_store_dwordx4 v[48:51],v25,s[20:23],s42 offen sc1
v_mfma_f32_16x16x32_bf16 v[76:79],a[200:203],v[232:235],v[76:79]
ds_read_b128 v[228:231],v17 offset:52224
v_mfma_f32_16x16x32_bf16 v[68:71],a[76:79],v[236:239],v[68:71]
s_add_u32 s42,s42,2097152
v_mfma_f32_16x16x32_bf16 v[76:79],a[204:207],v[236:239],v[76:79]
ds_read_b128 v[232:235],v17 offset:54272
s_waitcnt lgkmcnt(5)
v_mfma_f32_16x16x32_bf16 v[68:71],a[80:83],v[240:243],v[68:71]
v_mfma_f32_16x16x32_bf16 v[76:79],a[208:211],v[240:243],v[76:79]
ds_read_b128 v[236:239],v17 offset:56320
s_xor_b32 s42,s42,0x2000
v_mfma_f32_16x16x32_bf16 v[68:71],a[84:87],v[244:247],v[68:71]
v_mfma_f32_16x16x32_bf16 v[76:79],a[212:215],v[244:247],v[76:79]
ds_read_b128 v[240:243],v17 offset:58368
s_waitcnt lgkmcnt(5)
v_mfma_f32_16x16x32_bf16 v[68:71],a[88:91],v[248:251],v[68:71]
s_cmp_lt_u32 s42,165675008
s_cselect_b32 s42,s42,0x7fff0000
v_mfma_f32_16x16x32_bf16 v[76:79],a[216:219],v[248:251],v[76:79]
ds_read_b128 v[244:247],v17 offset:60416
v_mfma_f32_16x16x32_bf16 v[68:71],a[92:95],v[252:255],v[68:71]
v_mfma_f32_16x16x32_bf16 v[76:79],a[220:223],v[252:255],v[76:79]
ds_read_b128 v[248:251],v17 offset:62464
s_waitcnt lgkmcnt(5)
v_mfma_f32_16x16x32_bf16 v[68:71],a[96:99],v[224:227],v[68:71]
buffer_store_dwordx4 v[48:51],v24,s[20:23],s42 offen sc1
v_mfma_f32_16x16x32_bf16 v[76:79],a[224:227],v[224:227],v[76:79]
ds_read_b128 v[252:255],v17 offset:64512
v_mfma_f32_16x16x32_bf16 v[68:71],a[100:103],v[228:231],v[68:71]
buffer_store_dwordx4 v[48:51],v25,s[20:23],s42 offen sc1
v_mfma_f32_16x16x32_bf16 v[76:79],a[228:231],v[228:231],v[76:79]
s_waitcnt lgkmcnt(4)
v_mfma_f32_16x16x32_bf16 v[68:71],a[104:107],v[232:235],v[68:71]
v_mfma_f32_16x16x32_bf16 v[76:79],a[232:235],v[232:235],v[76:79]
s_add_u32 s42,s42,2097152
v_mfma_f32_16x16x32_bf16 v[68:71],a[108:111],v[236:239],v[68:71]
v_mfma_f32_16x16x32_bf16 v[76:79],a[236:239],v[236:239],v[76:79]
s_waitcnt lgkmcnt(2)
v_mfma_f32_16x16x32_bf16 v[68:71],a[112:115],v[240:243],v[68:71]
s_xor_b32 s42,s42,0x2000
v_mfma_f32_16x16x32_bf16 v[76:79],a[240:243],v[240:243],v[76:79]
v_mfma_f32_16x16x32_bf16 v[68:71],a[116:119],v[244:247],v[68:71]
v_mfma_f32_16x16x32_bf16 v[76:79],a[244:247],v[244:247],v[76:79]
s_waitcnt lgkmcnt(0)
v_mfma_f32_16x16x32_bf16 v[68:71],a[120:123],v[248:251],v[68:71]
s_cmp_lt_u32 s42,165675008
s_cselect_b32 s42,s42,0x7fff0000
v_mfma_f32_16x16x32_bf16 v[76:79],a[248:251],v[248:251],v[76:79]
v_mfma_f32_16x16x32_bf16 v[68:71],a[124:127],v[252:255],v[68:71]
v_mfma_f32_16x16x32_bf16 v[76:79],a[252:255],v[252:255],v[76:79]
v_xor_b32 v17,0x10000,v17
s_mov_b32 s79,s77
s_nop 4
v_cvt_pk_bf16_f32 v92,v68,v69
v_cvt_pk_bf16_f32 v93,v70,v71
v_cvt_pk_bf16_f32 v94,v76,v77
v_cvt_pk_bf16_f32 v95,v78,v79
buffer_store_dwordx4 v[92:95],v18,s[20:23],s70 offen offset:1024 sc1
s_waitcnt vmcnt(10)
s_barrier
ds_read_b128 v[224:227],v17 offset:0
ds_read_b128 v[228:231],v17 offset:2048
ds_read_b128 v[232:235],v17 offset:4096
ds_read_b128 v[236:239],v17 offset:6144
ds_read_b128 v[240:243],v17 offset:8192
ds_read_b128 v[244:247],v17 offset:10240
ds_read_b128 v[248:251],v17 offset:12288
s_waitcnt lgkmcnt(5)
v_mfma_f32_16x16x32_bf16 v[64:67],a[0:3],v[224:227],0
s_xor_b32 s72,s72,0x10000
s_add_u32 s77,s79,2
v_mfma_f32_16x16x32_bf16 v[72:75],a[128:131],v[224:227],0
ds_read_b128 v[252:255],v17 offset:14336
s_cmp_lt_u32 s79,56
s_cselect_b32 s77,s41,s77
v_mfma_f32_16x16x32_bf16 v[64:67],a[4:7],v[228:231],v[64:67]
s_add_u32 s74,s79,4
s_cmp_lt_u32 s79,52
s_cselect_b32 s77,s74,s77
v_mfma_f32_16x16x32_bf16 v[72:75],a[132:135],v[228:231],v[72:75]
ds_read_b128 v[224:227],v17 offset:16384
v_lshlrev_b32 v120,16,v120
s_waitcnt lgkmcnt(5)
v_mfma_f32_16x16x32_bf16 v[64:67],a[8:11],v[232:235],v[64:67]
s_lshl_b32 s74,s77,16
s_add_u32 s74,s74,s76
v_mul_f32 v109,s81,v120
v_mfma_f32_16x16x32_bf16 v[72:75],a[136:139],v[232:235],v[72:75]
ds_read_b128 v[228:231],v17 offset:18432
s_add_u32 s64,s79,0
v_mfma_f32_16x16x32_bf16 v[64:67],a[12:15],v[236:239],v[64:67]
s_cmp_lt_u32 s77,64
s_cselect_b32 s74,s74,0x7fff0000
v_mfma_f32_16x16x32_bf16 v[72:75],a[140:143],v[236:239],v[72:75]
ds_read_b128 v[232:235],v17 offset:20480
s_waitcnt lgkmcnt(5)
v_mfma_f32_16x16x32_bf16 v[64:67],a[16:19],v[240:243],v[64:67]
s_add_u32 m0,s72,0
v_exp_f32 v109,v109
v_mfma_f32_16x16x32_bf16 v[72:75],a[144:147],v[240:243],v[72:75]
ds_read_b128 v[236:239],v17 offset:22528
v_add_f32 v109,1.0,v109
v_mfma_f32_16x16x32_bf16 v[64:67],a[20:23],v[244:247],v[64:67]
s_add_u32 s65,s74,0
s_lshl_b32 s70,s64,21
v_mfma_f32_16x16x32_bf16 v[72:75],a[148:151],v[244:247],v[72:75]
ds_read_b128 v[240:243],v17 offset:24576
s_waitcnt lgkmcnt(5)
v_mfma_f32_16x16x32_bf16 v[64:67],a[24:27],v[248:251],v[64:67]
v_rcp_f32 v109,v109
v_mfma_f32_16x16x32_bf16 v[72:75],a[152:155],v[248:251],v[72:75]
ds_read_b128 v[244:247],v17 offset:26624
v_mul_f32 v109,v109,v120
v_mfma_f32_16x16x32_bf16 v[64:67],a[28:31],v[252:255],v[64:67]
buffer_load_dwordx4 v16,s[20:23],s65 offen offset:0  lds
v_mfma_f32_16x16x32_bf16 v[72:75],a[156:159],v[252:255],v[72:75]
ds_read_b128 v[248:251],v17 offset:28672
s_waitcnt lgkmcnt(5)
v_mfma_f32_16x16x32_bf16 v[64:67],a[32:35],v[224:227],v[64:67]
buffer_load_dwordx4 v16,s[20:23],s65 offen offset:1024  lds
v_mfma_f32_16x16x32_bf16 v[72:75],a[160:163],v[224:227],v[72:75]
ds_read_b128 v[252:255],v17 offset:30720
s_lshl_b32 s64,s64,13
v_mfma_f32_16x16x32_bf16 v[64:67],a[36:39],v[228:231],v[64:67]
buffer_load_dwordx4 v16,s[20:23],s65 offen offset:2048  lds
v_mfma_f32_16x16x32_bf16 v[72:75],a[164:167],v[228:231],v[72:75]
ds_read_b128 v[224:227],v17 offset:32768
s_waitcnt lgkmcnt(5)
v_mfma_f32_16x16x32_bf16 v[64:67],a[40:43],v[232:235],v[64:67]
buffer_load_dwordx4 v16,s[20:23],s65 offen offset:3072  lds
v_mfma_f32_16x16x32_bf16 v[72:75],a[168:171],v[232:235],v[72:75]
ds_read_b128 v[228:231],v17 offset:34816
s_and_b32 s64,s64,0x2000
v_mfma_f32_16x16x32_bf16 v[64:67],a[44:47],v[236:239],v[64:67]
v_cvt_pk_bf16_f32 v109,v109,v109
v_and_b32 v120,s80,v109
v_mfma_f32_16x16x32_bf16 v[72:75],a[172:175],v[236:239],v[72:75]
ds_read_b128 v[232:235],v17 offset:36864
s_waitcnt lgkmcnt(5)
v_mfma_f32_16x16x32_bf16 v[64:67],a[48:51],v[240:243],v[64:67]
s_add_u32 m0,s72,4096
v_lshlrev_b32 v110,16,v116
v_mfma_f32_16x16x32_bf16 v[72:75],a[176:179],v[240:243],v[72:75]
ds_read_b128 v[236:239],v17 offset:38912
s_add_u32 s65,s74,4096
v_mfma_f32_16x16x32_bf16 v[64:67],a[52:55],v[244:247],v[64:67]
s_xor_b32 s64,s64,s62
v_and_b32 v111,s80,v116
v_mfma_f32_16x16x32_bf16 v[72:75],a[180:183],v[244:247],v[72:75]
ds_read_b128 v[240:243],v17 offset:40960
s_waitcnt lgkmcnt(5)
v_mfma_f32_16x16x32_bf16 v[64:67],a[56:59],v[248:251],v[64:67]
buffer_load_dwordx4 v16,s[20:23],s65 offen offset:0  lds
v_mfma_f32_16x16x32_bf16 v[72:75],a[184:187],v[248:251],v[72:75]
ds_read_b128 v[244:247],v17 offset:43008
v_fmac_f32 v96,v110,v120
v_mfma_f32_16x16x32_bf16 v[64:67],a[60:63],v[252:255],v[64:67]
buffer_load_dwordx4 v16,s[20:23],s65 offen offset:1024  lds
v_mfma_f32_16x16x32_bf16 v[72:75],a[188:191],v[252:255],v[72:75]
ds_read_b128 v[248:251],v17 offset:45056
s_waitcnt lgkmcnt(5)
v_mfma_f32_16x16x32_bf16 v[64:67],a[64:67],v[224:227],v[64:67]
s_add_u32 s70,s70,s64
v_fmac_f32 v97,v111,v120
v_mfma_f32_16x16x32_bf16 v[72:75],a[192:195],v[224:227],v[72:75]
ds_read_b128 v[252:255],v17 offset:47104
v_lshlrev_b32 v110,16,v117
v_mfma_f32_16x16x32_bf16 v[64:67],a[68:71],v[228:231],v[64:67]
buffer_load_dwordx4 v16,s[20:23],s65 offen offset:2048  lds
v_mfma_f32_16x16x32_bf16 v[72:75],a[196:199],v[228:231],v[72:75]
ds_read_b128 v[224:227],v17 offset:49152
s_waitcnt lgkmcnt(5)
v_mfma_f32_16x16x32_bf16 v[64:67],a[72:75],v[232:235],v[64:67]
buffer_load_dwordx4 v16,s[20:23],s65 offen offset:3072  lds
v_mfma_f32_16x16x32_bf16 v[72:75],a[200:203],v[232:235],v[72:75]
ds_read_b128 v[228:231],v17 offset:51200
s_add_u32 s70,s70,29360128
v_mfma_f32_16x16x32_bf16 v[64:67],a[76:79],v[236:239],v[64:67]
s_add_u32 m0,s72,8192
v_and_b32 v111,s80,v117
v_mfma_f32_16x16x32_bf16 v[72:75],a[204:207],v[236:239],v[72:75]
ds_read_b128 v[232:235],v17 offset:53248
s_waitcnt lgkmcnt(5)
v_mfma_f32_16x16x32_bf16 v[64:67],a[80:83],v[240:243],v[64:67]
s_add_u32 s65,s74,8192
v_fmac_f32 v98,v110,v120
v_mfma_f32_16x16x32_bf16 v[72:75],a[208:211],v[240:243],v[72:75]
ds_read_b128 v[236:239],v17 offset:55296
v_fmac_f32 v99,v111,v120
v_mfma_f32_16x16x32_bf16 v[64:67],a[84:87],v[244:247],v[64:67]
v_lshlrev_b32 v110,16,v118
v_and_b32 v111,s80,v118
v_mfma_f32_16x16x32_bf16 v[72:75],a[212:215],v[244:247],v[72:75]
ds_read_b128 v[240:243],v17 offset:57344
s_waitcnt lgkmcnt(5)
v_mfma_f32_16x16x32_bf16 v[64:67],a[88:91],v[248:251],v[64:67]
buffer_load_dwordx4 v16,s[20:23],s65 offen offset:0  lds
v_mfma_f32_16x16x32_bf16 v[72:75],a[216:219],v[248:251],v[72:75]
ds_read_b128 v[244:247],v17 offset:59392
v_fmac_f32 v100,v110,v120
v_mfma_f32_16x16x32_bf16 v[64:67],a[92:95],v[252:255],v[64:67]
buffer_load_dwordx4 v16,s[20:23],s65 offen offset:1024  lds
v_mfma_f32_16x16x32_bf16 v[72:75],a[220:223],v[252:255],v[72:75]
ds_read_b128 v[248:251],v17 offset:61440
s_waitcnt lgkmcnt(5)
v_mfma_f32_16x16x32_bf16 v[64:67],a[96:99],v[224:227],v[64:67]
buffer_load_dwordx4 v16,s[20:23],s65 offen offset:2048  lds
v_mfma_f32_16x16x32_bf16 v[72:75],a[224:227],v[224:227],v[72:75]
ds_read_b128 v[252:255],v17 offset:63488
v_fmac_f32 v101,v111,v120
v_mfma_f32_16x16x32_bf16 v[64:67],a[100:103],v[228:231],v[64:67]
buffer_load_dwordx4 v16,s[20:23],s65 offen offset:3072  lds
v_mfma_f32_16x16x32_bf16 v[72:75],a[228:231],v[228:231],v[72:75]
ds_read_b128 v[224:227],v17 offset:1024
s_waitcnt lgkmcnt(5)
v_mfma_f32_16x16x32_bf16 v[64:67],a[104:107],v[232:235],v[64:67]
v_lshlrev_b32 v110,16,v119
v_and_b32 v111,s80,v119
v_mfma_f32_16x16x32_bf16 v[72:75],a[232:235],v[232:235],v[72:75]
ds_read_b128 v[228:231],v17 offset:3072
s_add_u32 m0,s72,12288
v_mfma_f32_16x16x32_bf16 v[64:67],a[108:111],v[236:239],v[64:67]
v_fmac_f32 v102,v110,v120
v_fmac_f32 v103,v111,v120
v_mfma_f32_16x16x32_bf16 v[72:75],a[236:239],v[236:239],v[72:75]
ds_read_b128 v[232:235],v17 offset:5120
s_waitcnt lgkmcnt(5)
v_mfma_f32_16x16x32_bf16 v[64:67],a[112:115],v[240:243],v[64:67]
s_add_u32 s65,s74,12288
v_mfma_f32_16x16x32_bf16 v[72:75],a[240:243],v[240:243],v[72:75]
ds_read_b128 v[236:239],v17 offset:7168
v_mfma_f32_16x16x32_bf16 v[64:67],a[116:119],v[244:247],v[64:67]
buffer_load_dwordx4 v16,s[20:23],s65 offen offset:0  lds
v_mfma_f32_16x16x32_bf16 v[72:75],a[244:247],v[244:247],v[72:75]
ds_read_b128 v[240:243],v17 offset:9216
s_waitcnt lgkmcnt(5)
v_mfma_f32_16x16x32_bf16 v[64:67],a[120:123],v[248:251],v[64:67]
buffer_load_dwordx4 v16,s[20:23],s65 offen offset:1024  lds
v_mfma_f32_16x16x32_bf16 v[72:75],a[248:251],v[248:251],v[72:75]
ds_read_b128 v[244:247],v17 offset:11264
v_mfma_f32_16x16x32_bf16 v[64:67],a[124:127],v[252:255],v[64:67]
v_mfma_f32_16x16x32_bf16 v[72:75],a[252:255],v[252:255],v[72:75]
ds_read_b128 v[248:251],v17 offset:13312
s_waitcnt lgkmcnt(5)
v_mfma_f32_16x16x32_bf16 v[68:71],a[0:3],v[224:227],0
buffer_load_dwordx4 v16,s[20:23],s65 offen offset:2048  lds
v_mfma_f32_16x16x32_bf16 v[76:79],a[128:131],v[224:227],0
ds_read_b128 v[252:255],v17 offset:15360
v_mfma_f32_16x16x32_bf16 v[68:71],a[4:7],v[228:231],v[68:71]
buffer_load_dwordx4 v16,s[20:23],s65 offen offset:3072  lds
v_mfma_f32_16x16x32_bf16 v[76:79],a[132:135],v[228:231],v[76:79]
ds_read_b128 v[224:227],v17 offset:17408
s_waitcnt lgkmcnt(5)
v_mfma_f32_16x16x32_bf16 v[68:71],a[8:11],v[232:235],v[68:71]
v_cvt_pk_bf16_f32 v88,v64,v65
v_cvt_pk_bf16_f32 v89,v66,v67
v_cvt_pk_bf16_f32 v90,v72,v73
v_cvt_pk_bf16_f32 v91,v74,v75
v_mfma_f32_16x16x32_bf16 v[76:79],a[136:139],v[232:235],v[76:79]
ds_read_b128 v[228:231],v17 offset:19456
v_mfma_f32_16x16x32_bf16 v[68:71],a[12:15],v[236:239],v[68:71]
v_mfma_f32_16x16x32_bf16 v[76:79],a[140:143],v[236:239],v[76:79]
ds_read_b128 v[232:235],v17 offset:21504
s_waitcnt lgkmcnt(5)
v_mfma_f32_16x16x32_bf16 v[68:71],a[16:19],v[240:243],v[68:71]
buffer_store_dwordx4 v[88:91],v18,s[20:23],s70 offen offset:0 sc1
v_mfma_f32_16x16x32_bf16 v[76:79],a[144:147],v[240:243],v[76:79]
ds_read_b128 v[236:239],v17 offset:23552
v_mfma_f32_16x16x32_bf16 v[68:71],a[20:23],v[244:247],v[68:71]
buffer_load_dwordx4 v[116:119],v112,s[16:19],s43 offen nt
v_mfma_f32_16x16x32_bf16 v[76:79],a[148:151],v[244:247],v[76:79]
ds_read_b128 v[240:243],v17 offset:25600
s_waitcnt lgkmcnt(5)
v_mfma_f32_16x16x32_bf16 v[68:71],a[24:27],v[248:251],v[68:71]
buffer_load_ushort v120,v113,s[12:15],s48 offen
v_mfma_f32_16x16x32_bf16 v[76:79],a[152:155],v[248:251],v[76:79]
ds_read_b128 v[244:247],v17 offset:27648
v_mfma_f32_16x16x32_bf16 v[68:71],a[28:31],v[252:255],v[68:71]
v_mfma_f32_16x16x32_bf16 v[76:79],a[156:159],v[252:255],v[76:79]
ds_read_b128 v[248:251],v17 offset:29696
s_waitcnt lgkmcnt(5)
v_mfma_f32_16x16x32_bf16 v[68:71],a[32:35],v[224:227],v[68:71]
s_add_u32 s43,s43,786432
v_mfma_f32_16x16x32_bf16 v[76:79],a[160:163],v[224:227],v[76:79]
ds_read_b128 v[252:255],v17 offset:31744
v_mfma_f32_16x16x32_bf16 v[68:71],a[36:39],v[228:231],v[68:71]
s_add_u32 s48,s48,128
v_mfma_f32_16x16x32_bf16 v[76:79],a[164:167],v[228:231],v[76:79]
ds_read_b128 v[224:227],v17 offset:33792
s_waitcnt lgkmcnt(5)
v_mfma_f32_16x16x32_bf16 v[68:71],a[40:43],v[232:235],v[68:71]
v_mfma_f32_16x16x32_bf16 v[76:79],a[168:171],v[232:235],v[76:79]
ds_read_b128 v[228:231],v17 offset:35840
v_mfma_f32_16x16x32_bf16 v[68:71],a[44:47],v[236:239],v[68:71]
buffer_store_dwordx4 v[48:51],v24,s[20:23],s93 offen sc1
v_mfma_f32_16x16x32_bf16 v[76:79],a[172:175],v[236:239],v[76:79]
ds_read_b128 v[232:235],v17 offset:37888
s_waitcnt lgkmcnt(5)
v_mfma_f32_16x16x32_bf16 v[68:71],a[48:51],v[240:243],v[68:71]
buffer_store_dwordx4 v[48:51],v25,s[20:23],s93 offen sc1
v_mfma_f32_16x16x32_bf16 v[76:79],a[176:179],v[240:243],v[76:79]
ds_read_b128 v[236:239],v17 offset:39936
v_mfma_f32_16x16x32_bf16 v[68:71],a[52:55],v[244:247],v[68:71]
v_mfma_f32_16x16x32_bf16 v[76:79],a[180:183],v[244:247],v[76:79]
ds_read_b128 v[240:243],v17 offset:41984
s_waitcnt lgkmcnt(5)
v_mfma_f32_16x16x32_bf16 v[68:71],a[56:59],v[248:251],v[68:71]
s_add_u32 s93,s93,8388608
v_mfma_f32_16x16x32_bf16 v[76:79],a[184:187],v[248:251],v[76:79]
ds_read_b128 v[244:247],v17 offset:44032
v_mfma_f32_16x16x32_bf16 v[68:71],a[60:63],v[252:255],v[68:71]
s_cmp_lt_u32 s93,163577856
s_cselect_b32 s93,s93,0x7fff0000
v_mfma_f32_16x16x32_bf16 v[76:79],a[188:191],v[252:255],v[76:79]
ds_read_b128 v[248:251],v17 offset:46080
s_waitcnt lgkmcnt(5)
v_mfma_f32_16x16x32_bf16 v[68:71],a[64:67],v[224:227],v[68:71]
v_mfma_f32_16x16x32_bf16 v[76:79],a[192:195],v[224:227],v[76:79]
ds_read_b128 v[252:255],v17 offset:48128
v_mfma_f32_16x16x32_bf16 v[68:71],a[68:71],v[228:231],v[68:71]
buffer_store_dwordx4 v[48:51],v24,s[20:23],s42 offen sc1
v_mfma_f32_16x16x32_bf16 v[76:79],a[196:199],v[228:231],v[76:79]
ds_read_b128 v[224:227],v17 offset:50176
s_waitcnt lgkmcnt(5)
v_mfma_f32_16x16x32_bf16 v[68:71],a[72:75],v[232:235],v[68:71]
buffer_store_dwordx4 v[48:51],v25,s[20:23],s42 offen sc1
v_mfma_f32_16x16x32_bf16 v[76:79],a[200:203],v[232:235],v[76:79]
ds_read_b128 v[228:231],v17 offset:52224
v_mfma_f32_16x16x32_bf16 v[68:71],a[76:79],v[236:239],v[68:71]
s_add_u32 s42,s42,2097152
v_mfma_f32_16x16x32_bf16 v[76:79],a[204:207],v[236:239],v[76:79]
ds_read_b128 v[232:235],v17 offset:54272
s_waitcnt lgkmcnt(5)
v_mfma_f32_16x16x32_bf16 v[68:71],a[80:83],v[240:243],v[68:71]
v_mfma_f32_16x16x32_bf16 v[76:79],a[208:211],v[240:243],v[76:79]
ds_read_b128 v[236:239],v17 offset:56320
s_xor_b32 s42,s42,0x2000
v_mfma_f32_16x16x32_bf16 v[68:71],a[84:87],v[244:247],v[68:71]
v_mfma_f32_16x16x32_bf16 v[76:79],a[212:215],v[244:247],v[76:79]
ds_read_b128 v[240:243],v17 offset:58368
s_waitcnt lgkmcnt(5)
v_mfma_f32_16x16x32_bf16 v[68:71],a[88:91],v[248:251],v[68:71]
s_cmp_lt_u32 s42,165675008
s_cselect_b32 s42,s42,0x7fff0000
v_mfma_f32_16x16x32_bf16 v[76:79],a[216:219],v[248:251],v[76:79]
ds_read_b128 v[244:247],v17 offset:60416
v_mfma_f32_16x16x32_bf16 v[68:71],a[92:95],v[252:255],v[68:71]
v_mfma_f32_16x16x32_bf16 v[76:79],a[220:223],v[252:255],v[76:79]
ds_read_b128 v[248:251],v17 offset:62464
s_waitcnt lgkmcnt(5)
v_mfma_f32_16x16x32_bf16 v[68:71],a[96:99],v[224:227],v[68:71]
buffer_store_dwordx4 v[48:51],v24,s[20:23],s42 offen sc1
v_mfma_f32_16x16x32_bf16 v[76:79],a[224:227],v[224:227],v[76:79]
ds_read_b128 v[252:255],v17 offset:64512
v_mfma_f32_16x16x32_bf16 v[68:71],a[100:103],v[228:231],v[68:71]
buffer_store_dwordx4 v[48:51],v25,s[20:23],s42 offen sc1
v_mfma_f32_16x16x32_bf16 v[76:79],a[228:231],v[228:231],v[76:79]
s_waitcnt lgkmcnt(4)
v_mfma_f32_16x16x32_bf16 v[68:71],a[104:107],v[232:235],v[68:71]
v_mfma_f32_16x16x32_bf16 v[76:79],a[232:235],v[232:235],v[76:79]
s_add_u32 s42,s42,2097152
v_mfma_f32_16x16x32_bf16 v[68:71],a[108:111],v[236:239],v[68:71]
v_mfma_f32_16x16x32_bf16 v[76:79],a[236:239],v[236:239],v[76:79]
s_waitcnt lgkmcnt(2)
v_mfma_f32_16x16x32_bf16 v[68:71],a[112:115],v[240:243],v[68:71]
s_xor_b32 s42,s42,0x2000
v_mfma_f32_16x16x32_bf16 v[76:79],a[240:243],v[240:243],v[76:79]
v_mfma_f32_16x16x32_bf16 v[68:71],a[116:119],v[244:247],v[68:71]
v_mfma_f32_16x16x32_bf16 v[76:79],a[244:247],v[244:247],v[76:79]
s_waitcnt lgkmcnt(0)
v_mfma_f32_16x16x32_bf16 v[68:71],a[120:123],v[248:251],v[68:71]
s_cmp_lt_u32 s42,165675008
s_cselect_b32 s42,s42,0x7fff0000
v_mfma_f32_16x16x32_bf16 v[76:79],a[248:251],v[248:251],v[76:79]
v_mfma_f32_16x16x32_bf16 v[68:71],a[124:127],v[252:255],v[68:71]
v_mfma_f32_16x16x32_bf16 v[76:79],a[252:255],v[252:255],v[76:79]
v_xor_b32 v17,0x10000,v17
s_mov_b32 s79,s77
s_nop 4
v_cvt_pk_bf16_f32 v92,v68,v69
v_cvt_pk_bf16_f32 v93,v70,v71
v_cvt_pk_bf16_f32 v94,v76,v77
v_cvt_pk_bf16_f32 v95,v78,v79
buffer_store_dwordx4 v[92:95],v18,s[20:23],s70 offen offset:1024 sc1
s_cmp_lt_u32 s79,64
s_cbranch_scc1 qloop_202
s_waitcnt vmcnt(0)
s_barrier
s_cmp_lg_u32 s41,64
s_cbranch_scc1 np3_208
s_cmp_lg_u32 s50,0
s_cbranch_scc1 ow_209
s_mov_b64 exec,1
v_mov_b32 v22,14
v_mov_b32 v23,0
s_mov_b32 s64,21052992
buffer_atomic_add v22,v23,s[20:23],s64 offen sc1
s_mov_b64 exec,-1
ow_209:
np3_208:
s_cmp_lg_u32 s50,0
s_cbranch_scc1 ow_210
s_mov_b64 exec,1
v_mov_b32 v22,18
v_mov_b32 v23,0
buffer_store_dword v22,v23,s[20:23],s73 offen sc1
s_mov_b64 exec,-1
ow_210:
v_lshlrev_b32 v108,16,v108
v_mul_f32 v109,s81,v108
v_exp_f32 v109,v109
s_nop 0
v_add_f32 v109,1.0,v109
v_rcp_f32 v109,v109
s_nop 0
v_mul_f32 v109,v109,v108
v_cvt_pk_bf16_f32 v109,v109,v109
v_and_b32 v108,s80,v109
v_lshlrev_b32 v110,16,v104
v_and_b32 v111,s80,v104
v_fmac_f32 v96,v110,v108
v_fmac_f32 v97,v111,v108
v_lshlrev_b32 v110,16,v105
v_and_b32 v111,s80,v105
v_fmac_f32 v98,v110,v108
v_fmac_f32 v99,v111,v108
v_lshlrev_b32 v110,16,v106
v_and_b32 v111,s80,v106
v_fmac_f32 v100,v110,v108
v_fmac_f32 v101,v111,v108
v_lshlrev_b32 v110,16,v107
v_and_b32 v111,s80,v107
v_fmac_f32 v102,v110,v108
v_fmac_f32 v103,v111,v108
v_lshlrev_b32 v120,16,v120
v_mul_f32 v109,s81,v120
v_exp_f32 v109,v109
s_nop 0
v_add_f32 v109,1.0,v109
v_rcp_f32 v109,v109
s_nop 0
v_mul_f32 v109,v109,v120
v_cvt_pk_bf16_f32 v109,v109,v109
v_and_b32 v120,s80,v109
v_lshlrev_b32 v110,16,v116
v_and_b32 v111,s80,v116
v_fmac_f32 v96,v110,v120
v_fmac_f32 v97,v111,v120
v_lshlrev_b32 v110,16,v117
v_and_b32 v111,s80,v117
v_fmac_f32 v98,v110,v120
v_fmac_f32 v99,v111,v120
v_lshlrev_b32 v110,16,v118
v_and_b32 v111,s80,v118
v_fmac_f32 v100,v110,v120
v_fmac_f32 v101,v111,v120
v_lshlrev_b32 v110,16,v119
v_and_b32 v111,s80,v119
v_fmac_f32 v102,v110,v120
v_fmac_f32 v103,v111,v120
v_lshlrev_b32 v5,5,v0
ds_write_b128 v5,v[96:99]
ds_write_b128 v5,v[100:103] offset:16
v_and_b32 v6,31,v0
v_lshrrev_b32 v7,5,v0
v_lshlrev_b32 v7,10,v7
v_lshl_add_u32 v7,v6,2,v7
s_waitcnt lgkmcnt(0)
s_barrier
ds_read_b32 v8,v7 offset:0
ds_read_b32 v9,v7 offset:128
ds_read_b32 v10,v7 offset:256
ds_read_b32 v11,v7 offset:384
ds_read_b32 v12,v7 offset:512
ds_read_b32 v13,v7 offset:640
ds_read_b32 v14,v7 offset:768
ds_read_b32 v15,v7 offset:896
s_waitcnt lgkmcnt(0)
v_add_f32 v8,v8,v9
v_add_f32 v8,v8,v10
v_add_f32 v8,v8,v11
v_add_f32 v8,v8,v12
v_add_f32 v8,v8,v13
v_add_f32 v8,v8,v14
v_add_f32 v8,v8,v15
v_lshlrev_b32 v5,2,v0
ds_write_b32 v5,v8 offset:8192
v_lshlrev_b32 v7,2,v6
s_waitcnt lgkmcnt(0)
s_barrier
ds_read_b32 v8,v7 offset:8192
ds_read_b32 v9,v7 offset:8320
ds_read_b32 v10,v7 offset:8448
ds_read_b32 v11,v7 offset:8576
ds_read_b32 v12,v7 offset:8704
ds_read_b32 v13,v7 offset:8832
ds_read_b32 v14,v7 offset:8960
ds_read_b32 v15,v7 offset:9088
s_waitcnt lgkmcnt(0)
v_add_f32 v8,v8,v9
v_add_f32 v8,v8,v10
v_add_f32 v8,v8,v11
v_add_f32 v8,v8,v12
v_add_f32 v8,v8,v13
v_add_f32 v8,v8,v14
v_add_f32 v8,v8,v15
v_cvt_pk_bf16_f32 v8,v8,v8
v_and_b32 v8,s80,v8
s_lshl_b32 s64,s55,7
s_add_u32 s64,s64,8192
s_cmp_lg_u32 s50,0
s_cbranch_scc1 ow_211
buffer_store_dword v8,v7,s[20:23],s64 offen sc1
ow_211:
s_waitcnt vmcnt(0)
s_barrier
s_cmp_lg_u32 s50,0
s_cbranch_scc1 ow_212
s_mov_b64 exec,1
v_mov_b32 v22,14
v_mov_b32 v23,0
s_mov_b32 s64,21052032
buffer_atomic_add v22,v23,s[20:23],s64 offen sc1
s_mov_b64 exec,-1
ow_212:
s_lshr_b32 s58,s55,5
s_and_b32 s59,s55,31
s_mov_b32 s57,65
s_mov_b32 s79,0
s_branch common_213
pipe_second:
s_cmp_ge_u32 s59,18
s_cbranch_scc1 giveup_197
s_getpc_b64 s[4:5]
pc2nd:
s_sub_u32 s8,s4,pc2nd-mega_kernel
s_subb_u32 s9,s5,0
s_and_b32 s9,s9,0xffff
s_mov_b32 s10,code_end-mega_kernel
s_mov_b32 s11,0x20000
s_lshl_b32 s12,s59,15
v_lshlrev_b32 v2,7,v0
buffer_load_dword v2,v2,s[8:11],s12 offen
s_add_u32 s55,s57,128
s_and_b32 s64,s59,1
s_lshl_b32 s65,s58,1
s_add_u32 s64,s64,s65
s_lshl_b32 s65,s59,2
s_and_b32 s65,s65,24
s_add_u32 s65,s65,s64
s_add_u32 s64,s64,24
s_cmp_ge_u32 s59,16
s_cselect_b32 s64,s64,s65
s_lshl_b32 s65,s58,3
s_add_u32 s65,s65,s59
s_lshr_b32 s58,s59,3
s_add_u32 s58,s58,1
s_cmp_lt_u32 s59,8
s_cselect_b32 s59,s65,s64
s_xor_b32 s62,s61,0x2000
s_add_u32 s63,s62,21053440
s_mov_b32 s57,65
s_mov_b32 s79,64
s_mov_b32 s90,400000
common_213:
v_and_b32 v1,63,v0
v_and_b32 v3,15,v1
v_lshrrev_b32 v4,4,v1
v_lshlrev_b32 v16,4,v1
v_mov_b32 v48,0
v_mov_b32 v49,0
v_mov_b32 v50,0
v_mov_b32 v51,0
s_mov_b64 s[24:25],s[20:21]
s_mov_b64 s[28:29],s[20:21]
s_mov_b32 s27,0x20000
s_mov_b32 s31,0x20000
s_cmp_eq_u32 s56,0
s_cselect_b32 s26,s22,0
s_cselect_b32 s30,0,s22
s_add_u32 s71,s79,1
s_lshl_b32 s60,s79,4
s_mov_b32 s98,0
s_mov_b32 s99,0
v_mov_b32 v29,0
v_cmp_eq_u32 vcc,0,v1
v_mov_b32 v23,0x40000000
s_nop 0
v_cndmask_b32 v23,v23,v48,vcc
s_mov_b32 s80,0xffff0000
s_cmp_eq_u32 s58,0
s_cbranch_scc1 r_wo_214
s_cmp_eq_u32 s58,1
s_cbranch_scc1 r_w3_215
s_cmp_eq_u32 s58,2
s_cbranch_scc1 r_w4_216
s_and_b32 s41,s59,15
s_cmp_lt_u32 s59,16
s_cbranch_scc1 r_at_219
s_cmp_ge_u32 s59,24
s_cbranch_scc1 r_w2_217
s_load_dwordx2 s[4:5],s[0:1],64
s_and_b32 s41,s59,7
s_lshl_b32 s66,s41,8
s_lshl_b32 s67,s50,1
s_waitcnt lgkmcnt(0)
s_mov_b32 s32,s4
s_and_b32 s33,s5,0xffff
s_mov_b32 s34,0x200000
s_mov_b32 s35,0x20000
v_lshrrev_b32 v5,2,v3
v_lshl_add_u32 v7,v4,3,v5
v_and_b32 v6,3,v3
v_lshlrev_b32 v6,3,v6
v_lshl_add_u32 v6,v7,8,v6
v_and_b32 v7,1,v4
v_lshl_add_u32 v5,v7,2,v5
v_xor_b32 v5,s67,v5
v_lshl_add_u32 v12,v5,5,v6
v_xor_b32 v13,32,v12
v_and_b32 v5,15,v1
v_and_b32 v6,3,v4
v_lshlrev_b32 v6,1,v6
v_xor_b32 v5,v5,v6
v_mul_u32_u24 v6,2048,v4
v_xor_b32 v7,0,v5
v_lshl_add_u32 v8,v7,4,v6
v_xor_b32 v7,8,v5
v_lshl_add_u32 v9,v7,4,v6
s_mul_i32 s74,s50,131072
s_add_u32 s74,s74,s66
s_lshl_b32 s75,s50,14
s_mul_i32 s76,s50,65536
s_add_u32 s76,s76,s66
s_lshl_b32 s77,s50,13
s_add_u32 s64,s74,0
s_add_u32 m0,s75,0
s_nop 0
buffer_load_dwordx4 v8,s[32:35],s64 offen nt lds
s_add_u32 s64,s74,8192
s_add_u32 m0,s75,1024
s_nop 0
buffer_load_dwordx4 v8,s[32:35],s64 offen nt lds
s_add_u32 s64,s74,16384
s_add_u32 m0,s75,2048
s_nop 0
buffer_load_dwordx4 v9,s[32:35],s64 offen nt lds
s_add_u32 s64,s74,24576
s_add_u32 m0,s75,3072
s_nop 0
buffer_load_dwordx4 v9,s[32:35],s64 offen nt lds
s_add_u32 s64,s74,32768
s_add_u32 m0,s75,4096
s_nop 0
buffer_load_dwordx4 v8,s[32:35],s64 offen nt lds
s_add_u32 s64,s74,40960
s_add_u32 m0,s75,5120
s_nop 0
buffer_load_dwordx4 v8,s[32:35],s64 offen nt lds
s_add_u32 s64,s74,49152
s_add_u32 m0,s75,6144
s_nop 0
buffer_load_dwordx4 v9,s[32:35],s64 offen nt lds
s_add_u32 s64,s74,57344
s_add_u32 m0,s75,7168
s_nop 0
buffer_load_dwordx4 v9,s[32:35],s64 offen nt lds
s_add_u32 s64,s74,65536
s_add_u32 m0,s75,8192
s_nop 0
buffer_load_dwordx4 v8,s[32:35],s64 offen nt lds
s_add_u32 s64,s74,73728
s_add_u32 m0,s75,9216
s_nop 0
buffer_load_dwordx4 v8,s[32:35],s64 offen nt lds
s_add_u32 s64,s74,81920
s_add_u32 m0,s75,10240
s_nop 0
buffer_load_dwordx4 v9,s[32:35],s64 offen nt lds
s_add_u32 s64,s74,90112
s_add_u32 m0,s75,11264
s_nop 0
buffer_load_dwordx4 v9,s[32:35],s64 offen nt lds
s_add_u32 s64,s74,98304
s_add_u32 m0,s75,12288
s_nop 0
buffer_load_dwordx4 v8,s[32:35],s64 offen nt lds
s_add_u32 s64,s74,106496
s_add_u32 m0,s75,13312
s_nop 0
buffer_load_dwordx4 v8,s[32:35],s64 offen nt lds
s_add_u32 s64,s74,114688
s_add_u32 m0,s75,14336
s_nop 0
buffer_load_dwordx4 v9,s[32:35],s64 offen nt lds
s_add_u32 s64,s74,122880
s_add_u32 m0,s75,15360
s_nop 0
buffer_load_dwordx4 v9,s[32:35],s64 offen nt lds
s_add_u32 s64,s74,524288
s_add_u32 m0,s75,65536
s_nop 0
buffer_load_dwordx4 v8,s[32:35],s64 offen nt lds
s_add_u32 s64,s74,532480
s_add_u32 m0,s75,66560
s_nop 0
buffer_load_dwordx4 v8,s[32:35],s64 offen nt lds
s_add_u32 s64,s74,540672
s_add_u32 m0,s75,67584
s_nop 0
buffer_load_dwordx4 v9,s[32:35],s64 offen nt lds
s_add_u32 s64,s74,548864
s_add_u32 m0,s75,68608
s_nop 0
buffer_load_dwordx4 v9,s[32:35],s64 offen nt lds
s_add_u32 s64,s74,557056
s_add_u32 m0,s75,69632
s_nop 0
buffer_load_dwordx4 v8,s[32:35],s64 offen nt lds
s_add_u32 s64,s74,565248
s_add_u32 m0,s75,70656
s_nop 0
buffer_load_dwordx4 v8,s[32:35],s64 offen nt lds
s_add_u32 s64,s74,573440
s_add_u32 m0,s75,71680
s_nop 0
buffer_load_dwordx4 v9,s[32:35],s64 offen nt lds
s_add_u32 s64,s74,581632
s_add_u32 m0,s75,72704
s_nop 0
buffer_load_dwordx4 v9,s[32:35],s64 offen nt lds
s_add_u32 s64,s74,589824
s_add_u32 m0,s75,73728
s_nop 0
buffer_load_dwordx4 v8,s[32:35],s64 offen nt lds
s_add_u32 s64,s74,598016
s_add_u32 m0,s75,74752
s_nop 0
buffer_load_dwordx4 v8,s[32:35],s64 offen nt lds
s_add_u32 s64,s74,606208
s_add_u32 m0,s75,75776
s_nop 0
buffer_load_dwordx4 v9,s[32:35],s64 offen nt lds
s_add_u32 s64,s74,614400
s_add_u32 m0,s75,76800
s_nop 0
buffer_load_dwordx4 v9,s[32:35],s64 offen nt lds
s_add_u32 s64,s74,622592
s_add_u32 m0,s75,77824
s_nop 0
buffer_load_dwordx4 v8,s[32:35],s64 offen nt lds
s_add_u32 s64,s74,630784
s_add_u32 m0,s75,78848
s_nop 0
buffer_load_dwordx4 v8,s[32:35],s64 offen nt lds
s_add_u32 s64,s74,638976
s_add_u32 m0,s75,79872
s_nop 0
buffer_load_dwordx4 v9,s[32:35],s64 offen nt lds
s_add_u32 s64,s74,647168
s_add_u32 m0,s75,80896
s_nop 0
buffer_load_dwordx4 v9,s[32:35],s64 offen nt lds
s_waitcnt vmcnt(16)
s_barrier
ds_read_b64_tr_b16 a[0:1],v12 offset:0
ds_read_b64_tr_b16 a[128:129],v13 offset:0
ds_read_b64_tr_b16 a[2:3],v12 offset:1024
ds_read_b64_tr_b16 a[130:131],v13 offset:1024
ds_read_b64_tr_b16 a[4:5],v12 offset:8192
ds_read_b64_tr_b16 a[132:133],v13 offset:8192
ds_read_b64_tr_b16 a[6:7],v12 offset:9216
ds_read_b64_tr_b16 a[134:135],v13 offset:9216
s_waitcnt lgkmcnt(4)
ds_read_b64_tr_b16 a[8:9],v12 offset:16384
ds_read_b64_tr_b16 a[136:137],v13 offset:16384
ds_read_b64_tr_b16 a[10:11],v12 offset:17408
ds_read_b64_tr_b16 a[138:139],v13 offset:17408
ds_read_b64_tr_b16 a[12:13],v12 offset:24576
ds_read_b64_tr_b16 a[140:141],v13 offset:24576
ds_read_b64_tr_b16 a[14:15],v12 offset:25600
ds_read_b64_tr_b16 a[142:143],v13 offset:25600
s_waitcnt lgkmcnt(4)
ds_read_b64_tr_b16 a[16:17],v12 offset:32768
ds_read_b64_tr_b16 a[144:145],v13 offset:32768
ds_read_b64_tr_b16 a[18:19],v12 offset:33792
ds_read_b64_tr_b16 a[146:147],v13 offset:33792
ds_read_b64_tr_b16 a[20:21],v12 offset:40960
ds_read_b64_tr_b16 a[148:149],v13 offset:40960
ds_read_b64_tr_b16 a[22:23],v12 offset:41984
ds_read_b64_tr_b16 a[150:151],v13 offset:41984
s_waitcnt lgkmcnt(4)
ds_read_b64_tr_b16 a[24:25],v12 offset:49152
ds_read_b64_tr_b16 a[152:153],v13 offset:49152
ds_read_b64_tr_b16 a[26:27],v12 offset:50176
ds_read_b64_tr_b16 a[154:155],v13 offset:50176
ds_read_b64_tr_b16 a[28:29],v12 offset:57344
ds_read_b64_tr_b16 a[156:157],v13 offset:57344
ds_read_b64_tr_b16 a[30:31],v12 offset:58368
ds_read_b64_tr_b16 a[158:159],v13 offset:58368
s_waitcnt lgkmcnt(4)
v_xor_b32 v12,0x10000,v12
v_xor_b32 v13,0x10000,v13
s_waitcnt lgkmcnt(0)
s_barrier
s_add_u32 s64,s74,1048576
s_add_u32 m0,s75,0
s_nop 0
buffer_load_dwordx4 v8,s[32:35],s64 offen nt lds
s_add_u32 s64,s74,1056768
s_add_u32 m0,s75,1024
s_nop 0
buffer_load_dwordx4 v8,s[32:35],s64 offen nt lds
s_add_u32 s64,s74,1064960
s_add_u32 m0,s75,2048
s_nop 0
buffer_load_dwordx4 v9,s[32:35],s64 offen nt lds
s_add_u32 s64,s74,1073152
s_add_u32 m0,s75,3072
s_nop 0
buffer_load_dwordx4 v9,s[32:35],s64 offen nt lds
s_add_u32 s64,s74,1081344
s_add_u32 m0,s75,4096
s_nop 0
buffer_load_dwordx4 v8,s[32:35],s64 offen nt lds
s_add_u32 s64,s74,1089536
s_add_u32 m0,s75,5120
s_nop 0
buffer_load_dwordx4 v8,s[32:35],s64 offen nt lds
s_add_u32 s64,s74,1097728
s_add_u32 m0,s75,6144
s_nop 0
buffer_load_dwordx4 v9,s[32:35],s64 offen nt lds
s_add_u32 s64,s74,1105920
s_add_u32 m0,s75,7168
s_nop 0
buffer_load_dwordx4 v9,s[32:35],s64 offen nt lds
s_add_u32 s64,s74,1114112
s_add_u32 m0,s75,8192
s_nop 0
buffer_load_dwordx4 v8,s[32:35],s64 offen nt lds
s_add_u32 s64,s74,1122304
s_add_u32 m0,s75,9216
s_nop 0
buffer_load_dwordx4 v8,s[32:35],s64 offen nt lds
s_add_u32 s64,s74,1130496
s_add_u32 m0,s75,10240
s_nop 0
buffer_load_dwordx4 v9,s[32:35],s64 offen nt lds
s_add_u32 s64,s74,1138688
s_add_u32 m0,s75,11264
s_nop 0
buffer_load_dwordx4 v9,s[32:35],s64 offen nt lds
s_add_u32 s64,s74,1146880
s_add_u32 m0,s75,12288
s_nop 0
buffer_load_dwordx4 v8,s[32:35],s64 offen nt lds
s_add_u32 s64,s74,1155072
s_add_u32 m0,s75,13312
s_nop 0
buffer_load_dwordx4 v8,s[32:35],s64 offen nt lds
s_add_u32 s64,s74,1163264
s_add_u32 m0,s75,14336
s_nop 0
buffer_load_dwordx4 v9,s[32:35],s64 offen nt lds
s_add_u32 s64,s74,1171456
s_add_u32 m0,s75,15360
s_nop 0
buffer_load_dwordx4 v9,s[32:35],s64 offen nt lds
s_waitcnt vmcnt(16)
s_barrier
ds_read_b64_tr_b16 a[32:33],v12 offset:0
ds_read_b64_tr_b16 a[160:161],v13 offset:0
ds_read_b64_tr_b16 a[34:35],v12 offset:1024
ds_read_b64_tr_b16 a[162:163],v13 offset:1024
ds_read_b64_tr_b16 a[36:37],v12 offset:8192
ds_read_b64_tr_b16 a[164:165],v13 offset:8192
ds_read_b64_tr_b16 a[38:39],v12 offset:9216
ds_read_b64_tr_b16 a[166:167],v13 offset:9216
s_waitcnt lgkmcnt(4)
ds_read_b64_tr_b16 a[40:41],v12 offset:16384
ds_read_b64_tr_b16 a[168:169],v13 offset:16384
ds_read_b64_tr_b16 a[42:43],v12 offset:17408
ds_read_b64_tr_b16 a[170:171],v13 offset:17408
ds_read_b64_tr_b16 a[44:45],v12 offset:24576
ds_read_b64_tr_b16 a[172:173],v13 offset:24576
ds_read_b64_tr_b16 a[46:47],v12 offset:25600
ds_read_b64_tr_b16 a[174:175],v13 offset:25600
s_waitcnt lgkmcnt(4)
ds_read_b64_tr_b16 a[48:49],v12 offset:32768
ds_read_b64_tr_b16 a[176:177],v13 offset:32768
ds_read_b64_tr_b16 a[50:51],v12 offset:33792
ds_read_b64_tr_b16 a[178:179],v13 offset:33792
ds_read_b64_tr_b16 a[52:53],v12 offset:40960
ds_read_b64_tr_b16 a[180:181],v13 offset:40960
ds_read_b64_tr_b16 a[54:55],v12 offset:41984
ds_read_b64_tr_b16 a[182:183],v13 offset:41984
s_waitcnt lgkmcnt(4)
ds_read_b64_tr_b16 a[56:57],v12 offset:49152
ds_read_b64_tr_b16 a[184:185],v13 offset:49152
ds_read_b64_tr_b16 a[58:59],v12 offset:50176
ds_read_b64_tr_b16 a[186:187],v13 offset:50176
ds_read_b64_tr_b16 a[60:61],v12 offset:57344
ds_read_b64_tr_b16 a[188:189],v13 offset:57344
ds_read_b64_tr_b16 a[62:63],v12 offset:58368
ds_read_b64_tr_b16 a[190:191],v13 offset:58368
s_waitcnt lgkmcnt(4)
v_xor_b32 v12,0x10000,v12
v_xor_b32 v13,0x10000,v13
s_waitcnt lgkmcnt(0)
s_barrier
s_add_u32 s64,s74,1572864
s_add_u32 m0,s75,65536
s_nop 0
buffer_load_dwordx4 v8,s[32:35],s64 offen nt lds
s_add_u32 s64,s74,1581056
s_add_u32 m0,s75,66560
s_nop 0
buffer_load_dwordx4 v8,s[32:35],s64 offen nt lds
s_add_u32 s64,s74,1589248
s_add_u32 m0,s75,67584
s_nop 0
buffer_load_dwordx4 v9,s[32:35],s64 offen nt lds
s_add_u32 s64,s74,1597440
s_add_u32 m0,s75,68608
s_nop 0
buffer_load_dwordx4 v9,s[32:35],s64 offen nt lds
s_add_u32 s64,s74,1605632
s_add_u32 m0,s75,69632
s_nop 0
buffer_load_dwordx4 v8,s[32:35],s64 offen nt lds
s_add_u32 s64,s74,1613824
s_add_u32 m0,s75,70656
s_nop 0
buffer_load_dwordx4 v8,s[32:35],s64 offen nt lds
s_add_u32 s64,s74,1622016
s_add_u32 m0,s75,71680
s_nop 0
buffer_load_dwordx4 v9,s[32:35],s64 offen nt lds
s_add_u32 s64,s74,1630208
s_add_u32 m0,s75,72704
s_nop 0
buffer_load_dwordx4 v9,s[32:35],s64 offen nt lds
s_add_u32 s64,s74,1638400
s_add_u32 m0,s75,73728
s_nop 0
buffer_load_dwordx4 v8,s[32:35],s64 offen nt lds
s_add_u32 s64,s74,1646592
s_add_u32 m0,s75,74752
s_nop 0
buffer_load_dwordx4 v8,s[32:35],s64 offen nt lds
s_add_u32 s64,s74,1654784
s_add_u32 m0,s75,75776
s_nop 0
buffer_load_dwordx4 v9,s[32:35],s64 offen nt lds
s_add_u32 s64,s74,1662976
s_add_u32 m0,s75,76800
s_nop 0
buffer_load_dwordx4 v9,s[32:35],s64 offen nt lds
s_add_u32 s64,s74,1671168
s_add_u32 m0,s75,77824
s_nop 0
buffer_load_dwordx4 v8,s[32:35],s64 offen nt lds
s_add_u32 s64,s74,1679360
s_add_u32 m0,s75,78848
s_nop 0
buffer_load_dwordx4 v8,s[32:35],s64 offen nt lds
s_add_u32 s64,s74,1687552
s_add_u32 m0,s75,79872
s_nop 0
buffer_load_dwordx4 v9,s[32:35],s64 offen nt lds
s_add_u32 s64,s74,1695744
s_add_u32 m0,s75,80896
s_nop 0
buffer_load_dwordx4 v9,s[32:35],s64 offen nt lds
s_waitcnt vmcnt(16)
s_barrier
ds_read_b64_tr_b16 a[64:65],v12 offset:0
ds_read_b64_tr_b16 a[192:193],v13 offset:0
ds_read_b64_tr_b16 a[66:67],v12 offset:1024
ds_read_b64_tr_b16 a[194:195],v13 offset:1024
ds_read_b64_tr_b16 a[68:69],v12 offset:8192
ds_read_b64_tr_b16 a[196:197],v13 offset:8192
ds_read_b64_tr_b16 a[70:71],v12 offset:9216
ds_read_b64_tr_b16 a[198:199],v13 offset:9216
s_waitcnt lgkmcnt(4)
ds_read_b64_tr_b16 a[72:73],v12 offset:16384
ds_read_b64_tr_b16 a[200:201],v13 offset:16384
ds_read_b64_tr_b16 a[74:75],v12 offset:17408
ds_read_b64_tr_b16 a[202:203],v13 offset:17408
ds_read_b64_tr_b16 a[76:77],v12 offset:24576
ds_read_b64_tr_b16 a[204:205],v13 offset:24576
ds_read_b64_tr_b16 a[78:79],v12 offset:25600
ds_read_b64_tr_b16 a[206:207],v13 offset:25600
s_waitcnt lgkmcnt(4)
ds_read_b64_tr_b16 a[80:81],v12 offset:32768
ds_read_b64_tr_b16 a[208:209],v13 offset:32768
ds_read_b64_tr_b16 a[82:83],v12 offset:33792
ds_read_b64_tr_b16 a[210:211],v13 offset:33792
ds_read_b64_tr_b16 a[84:85],v12 offset:40960
ds_read_b64_tr_b16 a[212:213],v13 offset:40960
ds_read_b64_tr_b16 a[86:87],v12 offset:41984
ds_read_b64_tr_b16 a[214:215],v13 offset:41984
s_waitcnt lgkmcnt(4)
ds_read_b64_tr_b16 a[88:89],v12 offset:49152
ds_read_b64_tr_b16 a[216:217],v13 offset:49152
ds_read_b64_tr_b16 a[90:91],v12 offset:50176
ds_read_b64_tr_b16 a[218:219],v13 offset:50176
ds_read_b64_tr_b16 a[92:93],v12 offset:57344
ds_read_b64_tr_b16 a[220:221],v13 offset:57344
ds_read_b64_tr_b16 a[94:95],v12 offset:58368
ds_read_b64_tr_b16 a[222:223],v13 offset:58368
s_waitcnt lgkmcnt(4)
v_xor_b32 v12,0x10000,v12
v_xor_b32 v13,0x10000,v13
s_waitcnt lgkmcnt(0)
s_barrier
s_waitcnt vmcnt(0)
s_barrier
ds_read_b64_tr_b16 a[96:97],v12 offset:0
ds_read_b64_tr_b16 a[224:225],v13 offset:0
ds_read_b64_tr_b16 a[98:99],v12 offset:1024
ds_read_b64_tr_b16 a[226:227],v13 offset:1024
ds_read_b64_tr_b16 a[100:101],v12 offset:8192
ds_read_b64_tr_b16 a[228:229],v13 offset:8192
ds_read_b64_tr_b16 a[102:103],v12 offset:9216
ds_read_b64_tr_b16 a[230:231],v13 offset:9216
s_waitcnt lgkmcnt(4)
ds_read_b64_tr_b16 a[104:105],v12 offset:16384
ds_read_b64_tr_b16 a[232:233],v13 offset:16384
ds_read_b64_tr_b16 a[106:107],v12 offset:17408
ds_read_b64_tr_b16 a[234:235],v13 offset:17408
ds_read_b64_tr_b16 a[108:109],v12 offset:24576
ds_read_b64_tr_b16 a[236:237],v13 offset:24576
ds_read_b64_tr_b16 a[110:111],v12 offset:25600
ds_read_b64_tr_b16 a[238:239],v13 offset:25600
s_waitcnt lgkmcnt(4)
ds_read_b64_tr_b16 a[112:113],v12 offset:32768
ds_read_b64_tr_b16 a[240:241],v13 offset:32768
ds_read_b64_tr_b16 a[114:115],v12 offset:33792
ds_read_b64_tr_b16 a[242:243],v13 offset:33792
ds_read_b64_tr_b16 a[116:117],v12 offset:40960
ds_read_b64_tr_b16 a[244:245],v13 offset:40960
ds_read_b64_tr_b16 a[118:119],v12 offset:41984
ds_read_b64_tr_b16 a[246:247],v13 offset:41984
s_waitcnt lgkmcnt(4)
ds_read_b64_tr_b16 a[120:121],v12 offset:49152
ds_read_b64_tr_b16 a[248:249],v13 offset:49152
ds_read_b64_tr_b16 a[122:123],v12 offset:50176
ds_read_b64_tr_b16 a[250:251],v13 offset:50176
ds_read_b64_tr_b16 a[124:125],v12 offset:57344
ds_read_b64_tr_b16 a[252:253],v13 offset:57344
ds_read_b64_tr_b16 a[126:127],v12 offset:58368
ds_read_b64_tr_b16 a[254:255],v13 offset:58368
s_waitcnt lgkmcnt(4)
v_xor_b32 v12,0x10000,v12
v_xor_b32 v13,0x10000,v13
s_waitcnt lgkmcnt(0)
s_barrier
v_and_b32 v21,1,v1
v_mul_u32_u24 v21,960,v21
s_mov_b32 s65,21052032
s_mov_b32 s66,1792
pl_220:
buffer_load_dword v22,v21,s[20:23],s65 offen sc1
s_waitcnt vmcnt(0)
v_cmp_gt_u32 vcc,s66,v22
s_cbranch_vccz pok_221
s_sleep 1
s_sub_u32 s90,s90,1
s_cmp_gt_i32 s90,0
s_cbranch_scc1 pl_220
pok_221:
s_mov_b32 s81,0xbdd2d3e8
v_mov_b32 v28,0xc0135761
v_mov_b32 v17,v16
v_and_b32 v21,31,v1
v_lshlrev_b32 v21,2,v21
s_mul_i32 s74,s79,40
s_add_u32 s74,s74,s63
s_add_u32 s74,s74,2560
s_lshl_b32 s42,s41,2
s_add_u32 s42,s42,s50
s_lshl_b32 s73,s41,4
s_lshl_b32 s64,s50,2
s_add_u32 s73,s73,s64
s_add_u32 s73,s73,s63
s_add_u32 s73,s73,3072
s_add_u32 s73,s73,s60
s_lshl_b32 s43,s50,11
s_lshl_b32 s78,s79,21
s_add_u32 s78,s78,29360128
s_mov_b32 s64,0
s_lshr_b32 s65,s50,1
s_and_b32 s66,s50,1
s_lshl_b32 s72,s65,13
s_lshl_b32 s64,s66,11
s_add_u32 s72,s72,s64
s_add_u32 s72,s72,0x10000
s_lshl_b32 s75,s66,15
s_lshl_b32 s64,s65,7
s_add_u32 s75,s75,s64
s_add_u32 s75,s75,1835008
s_lshl_b32 s64,s66,2
v_add_u32 v5,s64,v4
v_and_b32 v6,7,v1
v_xor_b32 v5,v5,v6
v_lshlrev_b32 v5,4,v5
v_bfe_u32 v6,v1,3,2
v_lshl_add_u32 v5,v6,11,v5
v_lshrrev_b32 v6,5,v1
v_lshl_add_u32 v42,v6,14,v5
v_lshrrev_b32 v5,1,v3
v_xor_b32 v5,v5,v4
v_lshlrev_b32 v5,4,v5
v_and_b32 v6,7,v3
v_lshl_add_u32 v5,v6,7,v5
v_lshrrev_b32 v6,3,v3
v_lshl_add_u32 v17,v6,11,v5
v_xor_b32 v43,64,v17
s_lshr_b32 s64,s41,1
s_lshl_b32 s64,s64,2
s_lshr_b32 s64,0x0413,s64
s_and_b32 s64,s64,7
s_add_u32 s65,s41,120
s_lshl_b32 s65,s65,14
s_add_u32 s65,s65,s43
v_lshl_add_u32 v7,v4,8,s65
v_mov_b32 v9,2105344
v_add_u32 v6,s64,v3
v_and_b32 v5,15,v6
v_lshl_add_u32 v5,v5,4,v7
v_bfe_u32 v8,v6,4,1
v_lshl_add_u32 v5,v8,10,v5
v_cmp_lt_u32 vcc,31,v6
s_nop 1
v_cndmask_b32 v8,0,v9,vcc
v_add_u32 v5,v5,v8
v_xor_b32 v18,s62,v5
s_add_u32 s64,s64,16
v_add_u32 v6,s64,v3
v_and_b32 v5,15,v6
v_lshl_add_u32 v5,v5,4,v7
v_bfe_u32 v8,v6,4,1
v_lshl_add_u32 v5,v8,10,v5
v_cmp_lt_u32 vcc,31,v6
s_nop 1
v_cndmask_b32 v8,0,v9,vcc
v_add_u32 v5,v5,v8
v_xor_b32 v19,s62,v5
s_add_u32 s64,s64,16
s_mov_b64 s[84:85],vcc
v_mov_b32 v88,1
v_mov_b32 v89,0
v_mov_b32 v90,0
v_mov_b32 v91,0
v_xor_b32 v5,0x2000,v19
s_mov_b32 s64,163577856
buffer_store_dwordx4 v[88:91],v18,s[20:23],s64 offen sc1
s_andn2_b64 exec,exec,s[84:85]
buffer_store_dwordx4 v[88:91],v19,s[20:23],s64 offen sc1
s_mov_b64 exec,-1
v_mov_b32 v6,0x7fff0000
v_cndmask_b32 v5,v6,v5,s[84:85]
s_mov_b32 s64,27262976
buffer_store_dwordx4 v[88:91],v5,s[20:23],s64 offen sc1
s_waitcnt vmcnt(0)
s_add_u32 s64,s79,0
s_lshl_b32 s70,s64,21
s_lshl_b32 s64,s64,13
s_and_b32 s64,s64,0x2000
s_xor_b32 s64,s64,s62
s_add_u32 s70,s70,s64
s_add_u32 s70,s70,29360128
s_mov_b32 s83,1
s_mov_b32 s87,s74
s_cmp_eq_u32 s50,0
s_cselect_b32 s74,s74,0x7fff0000
v_mov_b32 v47,132096
s_lshl_b32 s64,s50,3
s_add_u32 s64,s64,132096
v_mov_b32 v46,s64
v_mov_b32 v29,0
s_mov_b32 s97,0x7fff0000
s_mov_b32 s69,1
s_mov_b32 s68,0
s_mov_b32 s52,0x30003
s_mov_b32 s53,s52
seg_223:
s_cmp_eq_u32 s83,0
s_cbranch_scc1 ahead_224
s_add_u32 s94,s70,s75
s_add_u32 s95,s94,65536
s_xor_b32 s91,s72,0x10000
s_waitcnt vmcnt(3)
v_cmp_gt_u32 vcc,s71,v29
s_cbranch_vccz nb_227
s_waitcnt vmcnt(0)
v_add_u32 v22,s71,-1
buffer_store_dword v22,v23,s[24:27],s97 offen
buffer_store_dword v22,v23,s[28:31],s97 offen sc1
s_mov_b32 s97,0x7fff0000
s_cmp_lg_u32 s50,0
s_cbranch_scc1 nb_227
buffer_load_dword v32,v21,s[20:23],s74 offen sc1
s_sleep 2
pl_229:
buffer_load_dword v33,v21,s[20:23],s74 offen sc1
s_waitcnt vmcnt(1)
v_cmp_gt_u32 vcc,s71,v32
v_mov_b32 v29,v32
s_cbranch_vccz pok_230
buffer_load_dword v32,v21,s[20:23],s74 offen sc1
s_waitcnt vmcnt(1)
v_cmp_gt_u32 vcc,s71,v33
v_mov_b32 v29,v33
s_cbranch_vccz pok_230
s_sub_u32 s90,s90,1
s_cmp_gt_i32 s90,0
s_cbranch_scc1 pl_229
pok_230:
nb_227:
s_barrier
s_xor_b32 m0,s91,0
s_add_u32 s65,s94,0
buffer_load_dwordx4 v42,s[20:23],s65 offen offset:0 sc1 lds
buffer_load_dwordx4 v42,s[20:23],s65 offen offset:1024 sc1 lds
s_xor_b32 m0,s91,16384
s_add_u32 s65,s94,256
buffer_load_dwordx4 v42,s[20:23],s65 offen offset:0 sc1 lds
buffer_load_dwordx4 v42,s[20:23],s65 offen offset:1024 sc1 lds
s_xor_b32 m0,s91,32768
s_add_u32 s65,s94,512
buffer_load_dwordx4 v42,s[20:23],s65 offen offset:0 sc1 lds
buffer_load_dwordx4 v42,s[20:23],s65 offen offset:1024 sc1 lds
s_xor_b32 m0,s91,49152
s_add_u32 s65,s94,768
buffer_load_dwordx4 v42,s[20:23],s65 offen offset:0 sc1 lds
buffer_load_dwordx4 v42,s[20:23],s65 offen offset:1024 sc1 lds
s_waitcnt vmcnt(8)
v_add_u32 v22,s71,-1
buffer_store_dword v22,v23,s[24:27],s97 offen
buffer_store_dword v22,v23,s[28:31],s97 offen sc1
s_mov_b32 s97,0x7fff0000
s_waitcnt vmcnt(8)
s_barrier
ds_read_b128 v[224:227],v17 offset:0
ds_read_b128 v[228:231],v43 offset:0
ds_read_b128 v[232:235],v17 offset:8192
ds_read_b128 v[236:239],v43 offset:8192
ds_read_b128 v[240:243],v17 offset:1024
ds_read_b128 v[244:247],v43 offset:1024
ds_read_b128 v[248:251],v17 offset:9216
s_waitcnt lgkmcnt(5)
v_mfma_f32_16x16x32_bf16 v[64:67],a[0:3],v[224:227],0
s_xor_b32 m0,s91,4096
s_add_u32 s96,s71,1
v_mfma_f32_16x16x32_bf16 v[72:75],a[128:131],v[224:227],0
ds_read_b128 v[252:255],v43 offset:9216
s_add_u32 s92,s71,2
v_mfma_f32_16x16x32_bf16 v[64:67],a[4:7],v[228:231],v[64:67]
s_add_u32 s65,s95,0
v_min_u32 v27,v224,v228
v_mfma_f32_16x16x32_bf16 v[72:75],a[132:135],v[228:231],v[72:75]
s_waitcnt vmcnt(6)
s_barrier
ds_read_b128 v[224:227],v17 offset:16384
s_waitcnt lgkmcnt(5)
v_mfma_f32_16x16x32_bf16 v[64:67],a[8:11],v[232:235],v[64:67]
buffer_load_dwordx4 v42,s[20:23],s65 offen offset:0 sc1 lds
v_mfma_f32_16x16x32_bf16 v[72:75],a[136:139],v[232:235],v[72:75]
ds_read_b128 v[228:231],v43 offset:16384
v_min3_u32 v27,v27,v232,v236
v_mfma_f32_16x16x32_bf16 v[64:67],a[12:15],v[236:239],v[64:67]
buffer_load_dwordx4 v42,s[20:23],s65 offen offset:1024 sc1 lds
v_mfma_f32_16x16x32_bf16 v[72:75],a[140:143],v[236:239],v[72:75]
ds_read_b128 v[232:235],v17 offset:24576
s_waitcnt lgkmcnt(5)
v_mfma_f32_16x16x32_bf16 v[64:67],a[64:67],v[240:243],v[64:67]
s_xor_b32 m0,s91,20480
v_min3_u32 v27,v27,v240,v244
v_mfma_f32_16x16x32_bf16 v[72:75],a[192:195],v[240:243],v[72:75]
ds_read_b128 v[236:239],v43 offset:24576
v_mfma_f32_16x16x32_bf16 v[64:67],a[68:71],v[244:247],v[64:67]
s_add_u32 s65,s95,256
v_mfma_f32_16x16x32_bf16 v[72:75],a[196:199],v[244:247],v[72:75]
ds_read_b128 v[240:243],v17 offset:17408
s_waitcnt lgkmcnt(5)
v_mfma_f32_16x16x32_bf16 v[64:67],a[72:75],v[248:251],v[64:67]
buffer_load_dwordx4 v42,s[20:23],s65 offen offset:0 sc1 lds
v_mfma_f32_16x16x32_bf16 v[72:75],a[200:203],v[248:251],v[72:75]
ds_read_b128 v[244:247],v43 offset:17408
v_min3_u32 v27,v27,v248,v252
v_mfma_f32_16x16x32_bf16 v[64:67],a[76:79],v[252:255],v[64:67]
buffer_load_dwordx4 v42,s[20:23],s65 offen offset:1024 sc1 lds
v_mfma_f32_16x16x32_bf16 v[72:75],a[204:207],v[252:255],v[72:75]
ds_read_b128 v[248:251],v17 offset:25600
s_waitcnt lgkmcnt(5)
v_mfma_f32_16x16x32_bf16 v[64:67],a[16:19],v[224:227],v[64:67]
s_xor_b32 m0,s91,36864
v_min3_u32 v27,v27,v224,v228
v_mfma_f32_16x16x32_bf16 v[72:75],a[144:147],v[224:227],v[72:75]
ds_read_b128 v[252:255],v43 offset:25600
v_mfma_f32_16x16x32_bf16 v[64:67],a[20:23],v[228:231],v[64:67]
s_add_u32 s65,s95,512
v_mfma_f32_16x16x32_bf16 v[72:75],a[148:151],v[228:231],v[72:75]
s_waitcnt vmcnt(6)
s_barrier
ds_read_b128 v[224:227],v17 offset:32768
s_waitcnt lgkmcnt(5)
v_mfma_f32_16x16x32_bf16 v[64:67],a[24:27],v[232:235],v[64:67]
buffer_load_dwordx4 v42,s[20:23],s65 offen offset:0 sc1 lds
v_mfma_f32_16x16x32_bf16 v[72:75],a[152:155],v[232:235],v[72:75]
ds_read_b128 v[228:231],v43 offset:32768
v_min3_u32 v27,v27,v232,v236
v_mfma_f32_16x16x32_bf16 v[64:67],a[28:31],v[236:239],v[64:67]
buffer_load_dwordx4 v42,s[20:23],s65 offen offset:1024 sc1 lds
v_mfma_f32_16x16x32_bf16 v[72:75],a[156:159],v[236:239],v[72:75]
ds_read_b128 v[232:235],v17 offset:40960
s_waitcnt lgkmcnt(5)
v_mfma_f32_16x16x32_bf16 v[64:67],a[80:83],v[240:243],v[64:67]
s_xor_b32 m0,s91,53248
v_min3_u32 v27,v27,v240,v244
v_mfma_f32_16x16x32_bf16 v[72:75],a[208:211],v[240:243],v[72:75]
ds_read_b128 v[236:239],v43 offset:40960
v_mfma_f32_16x16x32_bf16 v[64:67],a[84:87],v[244:247],v[64:67]
s_add_u32 s65,s95,768
v_mfma_f32_16x16x32_bf16 v[72:75],a[212:215],v[244:247],v[72:75]
ds_read_b128 v[240:243],v17 offset:33792
s_waitcnt lgkmcnt(5)
v_mfma_f32_16x16x32_bf16 v[64:67],a[88:91],v[248:251],v[64:67]
buffer_load_dwordx4 v42,s[20:23],s65 offen offset:0 sc1 lds
v_min3_u32 v27,v27,v248,v252
v_mfma_f32_16x16x32_bf16 v[72:75],a[216:219],v[248:251],v[72:75]
ds_read_b128 v[244:247],v43 offset:33792
s_waitcnt vmcnt(63)
v_mfma_f32_16x16x32_bf16 v[64:67],a[92:95],v[252:255],v[64:67]
buffer_load_dwordx4 v42,s[20:23],s65 offen offset:1024 sc1 lds
v_mfma_f32_16x16x32_bf16 v[72:75],a[220:223],v[252:255],v[72:75]
ds_read_b128 v[248:251],v17 offset:41984
s_waitcnt lgkmcnt(5)
v_mfma_f32_16x16x32_bf16 v[64:67],a[32:35],v[224:227],v[64:67]
v_cmp_gt_u32 vcc,s96,v29
v_cmp_gt_u32 s[92:93],s92,v29
v_mfma_f32_16x16x32_bf16 v[72:75],a[160:163],v[224:227],v[72:75]
ds_read_b128 v[252:255],v43 offset:41984
v_min3_u32 v27,v27,v224,v228
v_mfma_f32_16x16x32_bf16 v[64:67],a[36:39],v[228:231],v[64:67]
v_mov_b32 v44,vcc_lo
v_mov_b32 v45,s92
v_mfma_f32_16x16x32_bf16 v[72:75],a[164:167],v[228:231],v[72:75]
ds_read_b128 v[224:227],v17 offset:49152
s_waitcnt lgkmcnt(5)
v_mfma_f32_16x16x32_bf16 v[64:67],a[40:43],v[232:235],v[64:67]
ds_write_b64 v46,v[44:45]
v_min3_u32 v27,v27,v232,v236
v_mfma_f32_16x16x32_bf16 v[72:75],a[168:171],v[232:235],v[72:75]
ds_read_b128 v[228:231],v43 offset:49152
v_mfma_f32_16x16x32_bf16 v[64:67],a[44:47],v[236:239],v[64:67]
v_mfma_f32_16x16x32_bf16 v[72:75],a[172:175],v[236:239],v[72:75]
ds_read_b128 v[232:235],v17 offset:57344
s_waitcnt lgkmcnt(6)
v_mfma_f32_16x16x32_bf16 v[64:67],a[96:99],v[240:243],v[64:67]
v_min3_u32 v27,v27,v240,v244
s_add_u32 s88,s70,s75
v_mfma_f32_16x16x32_bf16 v[72:75],a[224:227],v[240:243],v[72:75]
ds_read_b128 v[236:239],v43 offset:57344
s_add_u32 s88,s88,2097152
v_mfma_f32_16x16x32_bf16 v[64:67],a[100:103],v[244:247],v[64:67]
s_xor_b32 s88,s88,0x2000
s_add_u32 s89,s88,65536
v_mfma_f32_16x16x32_bf16 v[72:75],a[228:231],v[244:247],v[72:75]
ds_read_b128 v[240:243],v17 offset:50176
s_waitcnt lgkmcnt(6)
v_mfma_f32_16x16x32_bf16 v[64:67],a[104:107],v[248:251],v[64:67]
v_min3_u32 v27,v27,v248,v252
v_mfma_f32_16x16x32_bf16 v[72:75],a[232:235],v[248:251],v[72:75]
ds_read_b128 v[244:247],v43 offset:50176
v_mfma_f32_16x16x32_bf16 v[64:67],a[108:111],v[252:255],v[64:67]
v_mfma_f32_16x16x32_bf16 v[72:75],a[236:239],v[252:255],v[72:75]
ds_read_b128 v[248:251],v17 offset:58368
s_waitcnt lgkmcnt(5)
v_mfma_f32_16x16x32_bf16 v[64:67],a[48:51],v[224:227],v[64:67]
v_min3_u32 v27,v27,v224,v228
v_mfma_f32_16x16x32_bf16 v[72:75],a[176:179],v[224:227],v[72:75]
ds_read_b128 v[252:255],v43 offset:58368
v_mfma_f32_16x16x32_bf16 v[64:67],a[52:55],v[228:231],v[64:67]
v_mfma_f32_16x16x32_bf16 v[72:75],a[180:183],v[228:231],v[72:75]
s_waitcnt vmcnt(4)
s_barrier
ds_read_b64 v[44:45],v47
ds_read_b128 v[224:227],v17 offset:4096
s_waitcnt lgkmcnt(6)
v_mfma_f32_16x16x32_bf16 v[64:67],a[56:59],v[232:235],v[64:67]
v_min3_u32 v27,v27,v232,v236
v_mfma_f32_16x16x32_bf16 v[72:75],a[184:187],v[232:235],v[72:75]
ds_read_b128 v[228:231],v43 offset:4096
v_mfma_f32_16x16x32_bf16 v[64:67],a[60:63],v[236:239],v[64:67]
v_mfma_f32_16x16x32_bf16 v[72:75],a[188:191],v[236:239],v[72:75]
ds_read_b128 v[232:235],v17 offset:12288
s_waitcnt lgkmcnt(6)
v_mfma_f32_16x16x32_bf16 v[64:67],a[112:115],v[240:243],v[64:67]
v_min3_u32 v27,v27,v240,v244
v_mfma_f32_16x16x32_bf16 v[72:75],a[240:243],v[240:243],v[72:75]
ds_read_b128 v[236:239],v43 offset:12288
v_mfma_f32_16x16x32_bf16 v[64:67],a[116:119],v[244:247],v[64:67]
v_mfma_f32_16x16x32_bf16 v[72:75],a[244:247],v[244:247],v[72:75]
ds_read_b128 v[240:243],v17 offset:5120
s_waitcnt lgkmcnt(6)
v_mfma_f32_16x16x32_bf16 v[64:67],a[120:123],v[248:251],v[64:67]
s_waitcnt lgkmcnt(5)
v_readfirstlane_b32 s93,v45
v_mfma_f32_16x16x32_bf16 v[72:75],a[248:251],v[248:251],v[72:75]
ds_read_b128 v[244:247],v43 offset:5120
v_readfirstlane_b32 s83,v44
s_cmp_lg_u32 s83,0
s_cbranch_scc0 keep_233
v_mfma_f32_16x16x32_bf16 v[64:67],a[124:127],v[252:255],v[64:67]
v_min3_u32 v27,v27,v248,v252
v_mfma_f32_16x16x32_bf16 v[72:75],a[252:255],v[252:255],v[72:75]
ds_read_b128 v[248:251],v17 offset:13312
s_waitcnt lgkmcnt(5)
v_mfma_f32_16x16x32_bf16 v[68:71],a[0:3],v[224:227],0
v_cmp_eq_u32 vcc,0,v27
s_cbranch_vccnz retry_222
v_mfma_f32_16x16x32_bf16 v[76:79],a[128:131],v[224:227],0
ds_read_b128 v[252:255],v43 offset:13312
v_min3_u32 v27,v27,v224,v228
v_mfma_f32_16x16x32_bf16 v[68:71],a[4:7],v[228:231],v[68:71]
v_mfma_f32_16x16x32_bf16 v[76:79],a[132:135],v[228:231],v[76:79]
ds_read_b128 v[224:227],v17 offset:20480
s_waitcnt lgkmcnt(5)
v_mfma_f32_16x16x32_bf16 v[68:71],a[8:11],v[232:235],v[68:71]
v_min3_u32 v27,v27,v232,v236
v_mul_f32 v88,v64,v64
v_mul_f32 v92,v72,v72
v_mfma_f32_16x16x32_bf16 v[76:79],a[136:139],v[232:235],v[76:79]
ds_read_b128 v[228:231],v43 offset:20480
v_mul_f32 v89,v65,v65
v_mul_f32 v93,v73,v73
v_mfma_f32_16x16x32_bf16 v[68:71],a[12:15],v[236:239],v[68:71]
v_mul_f32 v90,v66,v66
v_mul_f32 v91,v67,v67
v_mul_f32 v94,v74,v74
v_mfma_f32_16x16x32_bf16 v[76:79],a[140:143],v[236:239],v[76:79]
ds_read_b128 v[232:235],v17 offset:28672
v_mul_f32 v95,v75,v75
s_waitcnt lgkmcnt(5)
v_mfma_f32_16x16x32_bf16 v[68:71],a[64:67],v[240:243],v[68:71]
v_min3_u32 v27,v27,v240,v244
v_fma_f32 v88,v88,s81,v28
v_fma_f32 v92,v92,s81,v28
v_mfma_f32_16x16x32_bf16 v[76:79],a[192:195],v[240:243],v[76:79]
ds_read_b128 v[236:239],v43 offset:28672
v_fma_f32 v89,v89,s81,v28
v_fma_f32 v93,v93,s81,v28
v_mfma_f32_16x16x32_bf16 v[68:71],a[68:71],v[244:247],v[68:71]
v_fma_f32 v90,v90,s81,v28
v_fma_f32 v91,v91,s81,v28
v_fma_f32 v94,v94,s81,v28
v_mfma_f32_16x16x32_bf16 v[76:79],a[196:199],v[244:247],v[76:79]
ds_read_b128 v[240:243],v17 offset:21504
v_fma_f32 v95,v95,s81,v28
s_waitcnt lgkmcnt(5)
v_mfma_f32_16x16x32_bf16 v[68:71],a[72:75],v[248:251],v[68:71]
v_min3_u32 v27,v27,v248,v252
v_mul_f32 v88,v88,v64
v_mul_f32 v92,v92,v72
v_mfma_f32_16x16x32_bf16 v[76:79],a[200:203],v[248:251],v[76:79]
ds_read_b128 v[244:247],v43 offset:21504
v_mul_f32 v89,v89,v65
v_mul_f32 v93,v93,v73
v_mfma_f32_16x16x32_bf16 v[68:71],a[76:79],v[252:255],v[68:71]
v_mul_f32 v90,v90,v66
v_mul_f32 v91,v91,v67
v_mul_f32 v94,v94,v74
v_mfma_f32_16x16x32_bf16 v[76:79],a[204:207],v[252:255],v[76:79]
ds_read_b128 v[248:251],v17 offset:29696
v_mul_f32 v95,v95,v75
s_waitcnt lgkmcnt(5)
v_mfma_f32_16x16x32_bf16 v[68:71],a[16:19],v[224:227],v[68:71]
v_min3_u32 v27,v27,v224,v228
v_exp_f32 v92,v92
v_mfma_f32_16x16x32_bf16 v[76:79],a[144:147],v[224:227],v[76:79]
ds_read_b128 v[252:255],v43 offset:29696
v_exp_f32 v93,v93
v_mfma_f32_16x16x32_bf16 v[68:71],a[20:23],v[228:231],v[68:71]
v_exp_f32 v88,v88
v_mfma_f32_16x16x32_bf16 v[76:79],a[148:151],v[228:231],v[76:79]
s_waitcnt vmcnt(0)
s_barrier
ds_read_b128 v[224:227],v17 offset:36864
s_waitcnt lgkmcnt(5)
v_mfma_f32_16x16x32_bf16 v[68:71],a[24:27],v[232:235],v[68:71]
v_min3_u32 v27,v27,v232,v236
v_exp_f32 v94,v94
v_mfma_f32_16x16x32_bf16 v[76:79],a[152:155],v[232:235],v[76:79]
ds_read_b128 v[228:231],v43 offset:36864
v_exp_f32 v95,v95
v_mfma_f32_16x16x32_bf16 v[68:71],a[28:31],v[236:239],v[68:71]
v_exp_f32 v89,v89
v_add_f32 v92,1.0,v92
v_mfma_f32_16x16x32_bf16 v[76:79],a[156:159],v[236:239],v[76:79]
ds_read_b128 v[232:235],v17 offset:45056
v_add_f32 v93,1.0,v93
s_waitcnt lgkmcnt(5)
v_mfma_f32_16x16x32_bf16 v[68:71],a[80:83],v[240:243],v[68:71]
v_min3_u32 v27,v27,v240,v244
v_add_f32 v94,1.0,v94
v_add_f32 v95,1.0,v95
v_mfma_f32_16x16x32_bf16 v[76:79],a[208:211],v[240:243],v[76:79]
ds_read_b128 v[236:239],v43 offset:45056
v_rcp_f32 v92,v92
v_mfma_f32_16x16x32_bf16 v[68:71],a[84:87],v[244:247],v[68:71]
v_exp_f32 v90,v90
v_mfma_f32_16x16x32_bf16 v[76:79],a[212:215],v[244:247],v[76:79]
ds_read_b128 v[240:243],v17 offset:37888
s_waitcnt lgkmcnt(5)
v_mfma_f32_16x16x32_bf16 v[68:71],a[88:91],v[248:251],v[68:71]
v_min3_u32 v27,v27,v248,v252
v_rcp_f32 v93,v93
v_mfma_f32_16x16x32_bf16 v[76:79],a[216:219],v[248:251],v[76:79]
ds_read_b128 v[244:247],v43 offset:37888
v_rcp_f32 v94,v94
v_mfma_f32_16x16x32_bf16 v[68:71],a[92:95],v[252:255],v[68:71]
v_exp_f32 v91,v91
v_mfma_f32_16x16x32_bf16 v[76:79],a[220:223],v[252:255],v[76:79]
ds_read_b128 v[248:251],v17 offset:46080
s_waitcnt lgkmcnt(5)
v_mfma_f32_16x16x32_bf16 v[68:71],a[32:35],v[224:227],v[68:71]
v_min3_u32 v27,v27,v224,v228
v_add_f32 v88,1.0,v88
v_mfma_f32_16x16x32_bf16 v[76:79],a[160:163],v[224:227],v[76:79]
ds_read_b128 v[252:255],v43 offset:46080
v_add_f32 v89,1.0,v89
v_mfma_f32_16x16x32_bf16 v[68:71],a[36:39],v[228:231],v[68:71]
v_add_f32 v90,1.0,v90
v_add_f32 v91,1.0,v91
v_mfma_f32_16x16x32_bf16 v[76:79],a[164:167],v[228:231],v[76:79]
ds_read_b128 v[224:227],v17 offset:53248
s_waitcnt lgkmcnt(5)
v_mfma_f32_16x16x32_bf16 v[68:71],a[40:43],v[232:235],v[68:71]
v_min3_u32 v27,v27,v232,v236
v_mfma_f32_16x16x32_bf16 v[76:79],a[168:171],v[232:235],v[76:79]
ds_read_b128 v[228:231],v43 offset:53248
v_mfma_f32_16x16x32_bf16 v[68:71],a[44:47],v[236:239],v[68:71]
v_rcp_f32 v88,v88
v_mfma_f32_16x16x32_bf16 v[76:79],a[172:175],v[236:239],v[76:79]
ds_read_b128 v[232:235],v17 offset:61440
s_waitcnt lgkmcnt(5)
v_mfma_f32_16x16x32_bf16 v[68:71],a[96:99],v[240:243],v[68:71]
v_min3_u32 v27,v27,v240,v244
v_mfma_f32_16x16x32_bf16 v[76:79],a[224:227],v[240:243],v[76:79]
ds_read_b128 v[236:239],v43 offset:61440
v_mfma_f32_16x16x32_bf16 v[68:71],a[100:103],v[244:247],v[68:71]
v_rcp_f32 v89,v89
v_mfma_f32_16x16x32_bf16 v[76:79],a[228:231],v[244:247],v[76:79]
ds_read_b128 v[240:243],v17 offset:54272
s_waitcnt lgkmcnt(5)
v_mfma_f32_16x16x32_bf16 v[68:71],a[104:107],v[248:251],v[68:71]
v_min3_u32 v27,v27,v248,v252
v_mfma_f32_16x16x32_bf16 v[76:79],a[232:235],v[248:251],v[76:79]
ds_read_b128 v[244:247],v43 offset:54272
v_mfma_f32_16x16x32_bf16 v[68:71],a[108:111],v[252:255],v[68:71]
v_rcp_f32 v90,v90
v_mfma_f32_16x16x32_bf16 v[76:79],a[236:239],v[252:255],v[76:79]
ds_read_b128 v[248:251],v17 offset:62464
s_waitcnt lgkmcnt(5)
v_mfma_f32_16x16x32_bf16 v[68:71],a[48:51],v[224:227],v[68:71]
v_min3_u32 v27,v27,v224,v228
v_mfma_f32_16x16x32_bf16 v[76:79],a[176:179],v[224:227],v[76:79]
ds_read_b128 v[252:255],v43 offset:62464
v_mfma_f32_16x16x32_bf16 v[68:71],a[52:55],v[228:231],v[68:71]
v_rcp_f32 v91,v91
v_mfma_f32_16x16x32_bf16 v[76:79],a[180:183],v[228:231],v[76:79]
v_mul_f32 v88,v88,v64
s_waitcnt lgkmcnt(4)
v_mfma_f32_16x16x32_bf16 v[68:71],a[56:59],v[232:235],v[68:71]
v_min3_u32 v27,v27,v232,v236
v_mul_f32 v89,v89,v65
v_mfma_f32_16x16x32_bf16 v[76:79],a[184:187],v[232:235],v[76:79]
v_mul_f32 v90,v90,v66
v_mul_f32 v91,v91,v67
v_mfma_f32_16x16x32_bf16 v[68:71],a[60:63],v[236:239],v[68:71]
v_rcp_f32 v95,v95
v_mfma_f32_16x16x32_bf16 v[76:79],a[188:191],v[236:239],v[76:79]
v_mul_f32 v92,v92,v72
s_waitcnt lgkmcnt(2)
v_mfma_f32_16x16x32_bf16 v[68:71],a[112:115],v[240:243],v[68:71]
v_min3_u32 v27,v27,v240,v244
v_mul_f32 v93,v93,v73
v_mfma_f32_16x16x32_bf16 v[76:79],a[240:243],v[240:243],v[76:79]
v_mul_f32 v94,v94,v74
v_mul_f32 v95,v95,v75
v_mfma_f32_16x16x32_bf16 v[68:71],a[116:119],v[244:247],v[68:71]
v_cvt_pk_bf16_f32 v96,v88,v89
v_cvt_pk_bf16_f32 v97,v90,v91
v_mfma_f32_16x16x32_bf16 v[76:79],a[244:247],v[244:247],v[76:79]
v_cvt_pk_bf16_f32 v98,v92,v93
s_waitcnt lgkmcnt(0)
v_mfma_f32_16x16x32_bf16 v[68:71],a[120:123],v[248:251],v[68:71]
v_min3_u32 v27,v27,v248,v252
v_cvt_pk_bf16_f32 v99,v94,v95
v_mfma_f32_16x16x32_bf16 v[76:79],a[248:251],v[248:251],v[76:79]
v_max_u32 v96,1,v96
v_mfma_f32_16x16x32_bf16 v[68:71],a[124:127],v[252:255],v[68:71]
buffer_store_dwordx4 v[96:99],v18,s[20:23],s78 offen sc1
v_mfma_f32_16x16x32_bf16 v[76:79],a[252:255],v[252:255],v[76:79]
v_cmp_eq_u32 vcc,0,v27
s_cbranch_vccnz retry_222
s_branch epi_225
keep_233:
v_mfma_f32_16x16x32_bf16 v[64:67],a[124:127],v[252:255],v[64:67]
v_min3_u32 v27,v27,v248,v252
s_xor_b32 m0,s72,0
v_mfma_f32_16x16x32_bf16 v[72:75],a[252:255],v[252:255],v[72:75]
ds_read_b128 v[248:251],v17 offset:13312
s_add_u32 s65,s88,0
s_waitcnt lgkmcnt(5)
v_mfma_f32_16x16x32_bf16 v[68:71],a[0:3],v[224:227],0
buffer_load_dwordx4 v42,s[20:23],s65 offen offset:0 sc1 lds
v_min3_u32 v27,v27,v224,v228
v_mfma_f32_16x16x32_bf16 v[76:79],a[128:131],v[224:227],0
ds_read_b128 v[252:255],v43 offset:13312
buffer_load_dwordx4 v42,s[20:23],s65 offen offset:1024 sc1 lds
v_mfma_f32_16x16x32_bf16 v[68:71],a[4:7],v[228:231],v[68:71]
v_cmp_eq_u32 vcc,0,v27
s_cbranch_vccnz retry_222
v_mfma_f32_16x16x32_bf16 v[76:79],a[132:135],v[228:231],v[76:79]
ds_read_b128 v[224:227],v17 offset:20480
s_xor_b32 m0,s72,16384
s_waitcnt lgkmcnt(5)
v_mfma_f32_16x16x32_bf16 v[68:71],a[8:11],v[232:235],v[68:71]
s_add_u32 s65,s88,256
v_min3_u32 v27,v27,v232,v236
v_mul_f32 v88,v64,v64
v_mul_f32 v92,v72,v72
v_mfma_f32_16x16x32_bf16 v[76:79],a[136:139],v[232:235],v[76:79]
ds_read_b128 v[228:231],v43 offset:20480
buffer_load_dwordx4 v42,s[20:23],s65 offen offset:0 sc1 lds
v_mul_f32 v93,v73,v73
v_mfma_f32_16x16x32_bf16 v[68:71],a[12:15],v[236:239],v[68:71]
v_mul_f32 v89,v65,v65
v_mul_f32 v90,v66,v66
v_mul_f32 v91,v67,v67
v_mul_f32 v94,v74,v74
v_mfma_f32_16x16x32_bf16 v[76:79],a[140:143],v[236:239],v[76:79]
ds_read_b128 v[232:235],v17 offset:28672
v_fma_f32 v88,v88,s81,v28
v_mul_f32 v95,v75,v75
s_waitcnt lgkmcnt(5)
v_mfma_f32_16x16x32_bf16 v[68:71],a[64:67],v[240:243],v[68:71]
buffer_load_dwordx4 v42,s[20:23],s65 offen offset:1024 sc1 lds
s_xor_b32 m0,s72,32768
v_fma_f32 v92,v92,s81,v28
v_mfma_f32_16x16x32_bf16 v[76:79],a[192:195],v[240:243],v[76:79]
ds_read_b128 v[236:239],v43 offset:28672
s_add_u32 s65,s88,512
v_fma_f32 v89,v89,s81,v28
v_fma_f32 v93,v93,s81,v28
v_mfma_f32_16x16x32_bf16 v[68:71],a[68:71],v[244:247],v[68:71]
v_min3_u32 v27,v27,v240,v244
v_fma_f32 v90,v90,s81,v28
v_fma_f32 v91,v91,s81,v28
v_fma_f32 v94,v94,s81,v28
v_mfma_f32_16x16x32_bf16 v[76:79],a[196:199],v[244:247],v[76:79]
ds_read_b128 v[240:243],v17 offset:21504
v_mul_f32 v88,v88,v64
v_fma_f32 v95,v95,s81,v28
s_waitcnt lgkmcnt(5)
v_mfma_f32_16x16x32_bf16 v[68:71],a[72:75],v[248:251],v[68:71]
buffer_load_dwordx4 v42,s[20:23],s65 offen offset:0 sc1 lds
v_mul_f32 v89,v89,v65
v_mul_f32 v92,v92,v72
v_mfma_f32_16x16x32_bf16 v[76:79],a[200:203],v[248:251],v[76:79]
ds_read_b128 v[244:247],v43 offset:21504
buffer_load_dwordx4 v42,s[20:23],s65 offen offset:1024 sc1 lds
v_mul_f32 v93,v93,v73
v_mfma_f32_16x16x32_bf16 v[68:71],a[76:79],v[252:255],v[68:71]
s_xor_b32 m0,s72,49152
v_min3_u32 v27,v27,v248,v252
v_mul_f32 v90,v90,v66
v_mul_f32 v94,v94,v74
v_mfma_f32_16x16x32_bf16 v[76:79],a[204:207],v[252:255],v[76:79]
ds_read_b128 v[248:251],v17 offset:29696
s_add_u32 s65,s88,768
v_mul_f32 v95,v95,v75
s_waitcnt lgkmcnt(5)
v_mfma_f32_16x16x32_bf16 v[68:71],a[16:19],v[224:227],v[68:71]
buffer_load_dwordx4 v42,s[20:23],s65 offen offset:0 sc1 lds
v_mul_f32 v91,v91,v67
v_mfma_f32_16x16x32_bf16 v[76:79],a[144:147],v[224:227],v[76:79]
ds_read_b128 v[252:255],v43 offset:29696
v_min3_u32 v27,v27,v224,v228
v_exp_f32 v92,v92
v_mfma_f32_16x16x32_bf16 v[68:71],a[20:23],v[228:231],v[68:71]
buffer_load_dwordx4 v42,s[20:23],s65 offen offset:1024 sc1 lds
v_exp_f32 v93,v93
v_mfma_f32_16x16x32_bf16 v[76:79],a[148:151],v[228:231],v[76:79]
s_waitcnt vmcnt(8)
s_barrier
ds_read_b128 v[224:227],v17 offset:36864
s_waitcnt lgkmcnt(5)
v_mfma_f32_16x16x32_bf16 v[68:71],a[24:27],v[232:235],v[68:71]
s_xor_b32 m0,s72,4096
s_add_u32 s65,s89,0
v_exp_f32 v94,v94
v_mfma_f32_16x16x32_bf16 v[76:79],a[152:155],v[232:235],v[76:79]
ds_read_b128 v[228:231],v43 offset:36864
v_min3_u32 v27,v27,v232,v236
v_exp_f32 v95,v95
v_mfma_f32_16x16x32_bf16 v[68:71],a[28:31],v[236:239],v[68:71]
buffer_load_dwordx4 v42,s[20:23],s65 offen offset:0 sc1 lds
v_add_f32 v92,1.0,v92
v_add_f32 v93,1.0,v93
v_mfma_f32_16x16x32_bf16 v[76:79],a[156:159],v[236:239],v[76:79]
ds_read_b128 v[232:235],v17 offset:45056
v_add_f32 v94,1.0,v94
v_add_f32 v95,1.0,v95
s_waitcnt lgkmcnt(5)
v_mfma_f32_16x16x32_bf16 v[68:71],a[80:83],v[240:243],v[68:71]
buffer_load_dwordx4 v42,s[20:23],s65 offen offset:1024 sc1 lds
v_rcp_f32 v92,v92
v_mfma_f32_16x16x32_bf16 v[76:79],a[208:211],v[240:243],v[76:79]
ds_read_b128 v[236:239],v43 offset:45056
s_xor_b32 m0,s72,20480
v_rcp_f32 v93,v93
v_mfma_f32_16x16x32_bf16 v[68:71],a[84:87],v[244:247],v[68:71]
s_add_u32 s65,s89,256
v_min3_u32 v27,v27,v240,v244
v_rcp_f32 v94,v94
v_mfma_f32_16x16x32_bf16 v[76:79],a[212:215],v[244:247],v[76:79]
ds_read_b128 v[240:243],v17 offset:37888
v_rcp_f32 v95,v95
s_waitcnt lgkmcnt(5)
v_mfma_f32_16x16x32_bf16 v[68:71],a[88:91],v[248:251],v[68:71]
buffer_load_dwordx4 v42,s[20:23],s65 offen offset:0 sc1 lds
v_mul_f32 v92,v92,v72
v_mul_f32 v93,v93,v73
v_mfma_f32_16x16x32_bf16 v[76:79],a[216:219],v[248:251],v[76:79]
ds_read_b128 v[244:247],v43 offset:37888
v_min3_u32 v27,v27,v248,v252
v_mfma_f32_16x16x32_bf16 v[68:71],a[92:95],v[252:255],v[68:71]
buffer_load_dwordx4 v42,s[20:23],s65 offen offset:1024 sc1 lds
v_mfma_f32_16x16x32_bf16 v[76:79],a[220:223],v[252:255],v[76:79]
ds_read_b128 v[248:251],v17 offset:46080
s_waitcnt lgkmcnt(5)
v_mfma_f32_16x16x32_bf16 v[68:71],a[32:35],v[224:227],v[68:71]
s_xor_b32 m0,s72,36864
s_add_u32 s65,s89,512
v_mfma_f32_16x16x32_bf16 v[76:79],a[160:163],v[224:227],v[76:79]
ds_read_b128 v[252:255],v43 offset:46080
v_min3_u32 v27,v27,v224,v228
v_mfma_f32_16x16x32_bf16 v[68:71],a[36:39],v[228:231],v[68:71]
buffer_load_dwordx4 v42,s[20:23],s65 offen offset:0 sc1 lds
v_mfma_f32_16x16x32_bf16 v[76:79],a[164:167],v[228:231],v[76:79]
ds_read_b128 v[224:227],v17 offset:53248
s_waitcnt lgkmcnt(5)
v_mfma_f32_16x16x32_bf16 v[68:71],a[40:43],v[232:235],v[68:71]
buffer_load_dwordx4 v42,s[20:23],s65 offen offset:1024 sc1 lds
v_mfma_f32_16x16x32_bf16 v[76:79],a[168:171],v[232:235],v[76:79]
ds_read_b128 v[228:231],v43 offset:53248
s_xor_b32 m0,s72,53248
v_mfma_f32_16x16x32_bf16 v[68:71],a[44:47],v[236:239],v[68:71]
s_add_u32 s65,s89,768
v_min3_u32 v27,v27,v232,v236
v_mfma_f32_16x16x32_bf16 v[76:79],a[172:175],v[236:239],v[76:79]
ds_read_b128 v[232:235],v17 offset:61440
s_waitcnt lgkmcnt(5)
v_mfma_f32_16x16x32_bf16 v[68:71],a[96:99],v[240:243],v[68:71]
buffer_load_dwordx4 v42,s[20:23],s65 offen offset:0 sc1 lds
v_mfma_f32_16x16x32_bf16 v[76:79],a[224:227],v[240:243],v[76:79]
ds_read_b128 v[236:239],v43 offset:61440
v_min3_u32 v27,v27,v240,v244
v_mfma_f32_16x16x32_bf16 v[68:71],a[100:103],v[244:247],v[68:71]
buffer_load_dwordx4 v42,s[20:23],s65 offen offset:1024 sc1 lds
v_mfma_f32_16x16x32_bf16 v[76:79],a[228:231],v[244:247],v[76:79]
ds_read_b128 v[240:243],v17 offset:54272
s_waitcnt lgkmcnt(5)
v_mfma_f32_16x16x32_bf16 v[68:71],a[104:107],v[248:251],v[68:71]
v_min3_u32 v27,v27,v248,v252
v_exp_f32 v88,v88
v_mfma_f32_16x16x32_bf16 v[76:79],a[232:235],v[248:251],v[76:79]
ds_read_b128 v[244:247],v43 offset:54272
v_exp_f32 v89,v89
v_mfma_f32_16x16x32_bf16 v[68:71],a[108:111],v[252:255],v[68:71]
v_exp_f32 v90,v90
v_mfma_f32_16x16x32_bf16 v[76:79],a[236:239],v[252:255],v[76:79]
ds_read_b128 v[248:251],v17 offset:62464
s_waitcnt lgkmcnt(5)
v_mfma_f32_16x16x32_bf16 v[68:71],a[48:51],v[224:227],v[68:71]
v_min3_u32 v27,v27,v224,v228
v_exp_f32 v91,v91
v_mfma_f32_16x16x32_bf16 v[76:79],a[176:179],v[224:227],v[76:79]
ds_read_b128 v[252:255],v43 offset:62464
v_add_f32 v88,1.0,v88
v_add_f32 v89,1.0,v89
v_mfma_f32_16x16x32_bf16 v[68:71],a[52:55],v[228:231],v[68:71]
v_add_f32 v90,1.0,v90
v_add_f32 v91,1.0,v91
v_mfma_f32_16x16x32_bf16 v[76:79],a[180:183],v[228:231],v[76:79]
v_rcp_f32 v88,v88
s_waitcnt lgkmcnt(4)
v_mfma_f32_16x16x32_bf16 v[68:71],a[56:59],v[232:235],v[68:71]
v_min3_u32 v27,v27,v232,v236
v_rcp_f32 v89,v89
v_mfma_f32_16x16x32_bf16 v[76:79],a[184:187],v[232:235],v[76:79]
v_rcp_f32 v90,v90
v_mfma_f32_16x16x32_bf16 v[68:71],a[60:63],v[236:239],v[68:71]
v_rcp_f32 v91,v91
v_mfma_f32_16x16x32_bf16 v[76:79],a[188:191],v[236:239],v[76:79]
v_mul_f32 v88,v88,v64
s_waitcnt lgkmcnt(2)
v_mfma_f32_16x16x32_bf16 v[68:71],a[112:115],v[240:243],v[68:71]
v_min3_u32 v27,v27,v240,v244
v_mul_f32 v89,v89,v65
v_mfma_f32_16x16x32_bf16 v[76:79],a[240:243],v[240:243],v[76:79]
v_mul_f32 v90,v90,v66
v_mul_f32 v91,v91,v67
v_mfma_f32_16x16x32_bf16 v[68:71],a[116:119],v[244:247],v[68:71]
v_mul_f32 v94,v94,v74
v_mul_f32 v95,v95,v75
v_mfma_f32_16x16x32_bf16 v[76:79],a[244:247],v[244:247],v[76:79]
v_cvt_pk_bf16_f32 v96,v88,v89
s_waitcnt lgkmcnt(0)
v_mfma_f32_16x16x32_bf16 v[68:71],a[120:123],v[248:251],v[68:71]
v_min3_u32 v27,v27,v248,v252
v_cvt_pk_bf16_f32 v97,v90,v91
v_mfma_f32_16x16x32_bf16 v[76:79],a[248:251],v[248:251],v[76:79]
v_cvt_pk_bf16_f32 v98,v92,v93
v_cvt_pk_bf16_f32 v99,v94,v95
v_mfma_f32_16x16x32_bf16 v[68:71],a[124:127],v[252:255],v[68:71]
v_max_u32 v96,1,v96
v_mfma_f32_16x16x32_bf16 v[76:79],a[252:255],v[252:255],v[76:79]
buffer_store_dwordx4 v[96:99],v18,s[20:23],s78 offen sc1
v_cmp_eq_u32 vcc,0,v27
s_cbranch_vccnz retry_222
s_branch epi_225
ahead_224:
s_cmp_eq_u32 s93,0
s_cbranch_scc1 both_226
s_waitcnt vmcnt(13) lgkmcnt(0)
s_barrier
ds_read_b128 v[224:227],v17 offset:0
ds_read_b128 v[228:231],v43 offset:0
ds_read_b128 v[232:235],v17 offset:8192
ds_read_b128 v[236:239],v43 offset:8192
ds_read_b128 v[240:243],v17 offset:1024
ds_read_b128 v[244:247],v43 offset:1024
ds_read_b128 v[248:251],v17 offset:9216
s_waitcnt lgkmcnt(5)
v_mfma_f32_16x16x32_bf16 v[64:67],a[0:3],v[224:227],0
s_add_u32 s96,s71,1
s_add_u32 s92,s71,2
v_mfma_f32_16x16x32_bf16 v[72:75],a[128:131],v[224:227],0
ds_read_b128 v[252:255],v43 offset:9216
v_min_u32 v27,v224,v228
v_mfma_f32_16x16x32_bf16 v[64:67],a[4:7],v[228:231],v[64:67]
v_mfma_f32_16x16x32_bf16 v[72:75],a[132:135],v[228:231],v[72:75]
ds_read_b128 v[224:227],v17 offset:16384
s_waitcnt lgkmcnt(5)
v_mfma_f32_16x16x32_bf16 v[64:67],a[8:11],v[232:235],v[64:67]
v_min3_u32 v27,v27,v232,v236
v_mfma_f32_16x16x32_bf16 v[72:75],a[136:139],v[232:235],v[72:75]
ds_read_b128 v[228:231],v43 offset:16384
v_mfma_f32_16x16x32_bf16 v[64:67],a[12:15],v[236:239],v[64:67]
v_mfma_f32_16x16x32_bf16 v[72:75],a[140:143],v[236:239],v[72:75]
ds_read_b128 v[232:235],v17 offset:24576
s_waitcnt lgkmcnt(5)
v_mfma_f32_16x16x32_bf16 v[64:67],a[64:67],v[240:243],v[64:67]
v_min3_u32 v27,v27,v240,v244
v_mfma_f32_16x16x32_bf16 v[72:75],a[192:195],v[240:243],v[72:75]
ds_read_b128 v[236:239],v43 offset:24576
v_mfma_f32_16x16x32_bf16 v[64:67],a[68:71],v[244:247],v[64:67]
v_mfma_f32_16x16x32_bf16 v[72:75],a[196:199],v[244:247],v[72:75]
ds_read_b128 v[240:243],v17 offset:17408
s_waitcnt lgkmcnt(5)
v_mfma_f32_16x16x32_bf16 v[64:67],a[72:75],v[248:251],v[64:67]
v_min3_u32 v27,v27,v248,v252
v_mfma_f32_16x16x32_bf16 v[72:75],a[200:203],v[248:251],v[72:75]
ds_read_b128 v[244:247],v43 offset:17408
v_mfma_f32_16x16x32_bf16 v[64:67],a[76:79],v[252:255],v[64:67]
v_mfma_f32_16x16x32_bf16 v[72:75],a[204:207],v[252:255],v[72:75]
ds_read_b128 v[248:251],v17 offset:25600
s_waitcnt lgkmcnt(5)
v_mfma_f32_16x16x32_bf16 v[64:67],a[16:19],v[224:227],v[64:67]
v_min3_u32 v27,v27,v224,v228
v_mfma_f32_16x16x32_bf16 v[72:75],a[144:147],v[224:227],v[72:75]
ds_read_b128 v[252:255],v43 offset:25600
v_mfma_f32_16x16x32_bf16 v[64:67],a[20:23],v[228:231],v[64:67]
v_mfma_f32_16x16x32_bf16 v[72:75],a[148:151],v[228:231],v[72:75]
ds_read_b128 v[224:227],v17 offset:32768
s_waitcnt lgkmcnt(5)
v_mfma_f32_16x16x32_bf16 v[64:67],a[24:27],v[232:235],v[64:67]
v_min3_u32 v27,v27,v232,v236
v_mfma_f32_16x16x32_bf16 v[72:75],a[152:155],v[232:235],v[72:75]
ds_read_b128 v[228:231],v43 offset:32768
v_mfma_f32_16x16x32_bf16 v[64:67],a[28:31],v[236:239],v[64:67]
v_mfma_f32_16x16x32_bf16 v[72:75],a[156:159],v[236:239],v[72:75]
ds_read_b128 v[232:235],v17 offset:40960
s_waitcnt lgkmcnt(5)
v_mfma_f32_16x16x32_bf16 v[64:67],a[80:83],v[240:243],v[64:67]
v_min3_u32 v27,v27,v240,v244
v_mfma_f32_16x16x32_bf16 v[72:75],a[208:211],v[240:243],v[72:75]
ds_read_b128 v[236:239],v43 offset:40960
v_mfma_f32_16x16x32_bf16 v[64:67],a[84:87],v[244:247],v[64:67]
v_mfma_f32_16x16x32_bf16 v[72:75],a[212:215],v[244:247],v[72:75]
ds_read_b128 v[240:243],v17 offset:33792
s_waitcnt lgkmcnt(5)
v_mfma_f32_16x16x32_bf16 v[64:67],a[88:91],v[248:251],v[64:67]
v_min3_u32 v27,v27,v248,v252
v_mfma_f32_16x16x32_bf16 v[72:75],a[216:219],v[248:251],v[72:75]
ds_read_b128 v[244:247],v43 offset:33792
s_waitcnt vmcnt(3)
v_mfma_f32_16x16x32_bf16 v[64:67],a[92:95],v[252:255],v[64:67]
v_cmp_gt_u32 vcc,s96,v29
v_cmp_gt_u32 s[92:93],s92,v29
v_mfma_f32_16x16x32_bf16 v[72:75],a[220:223],v[252:255],v[72:75]
ds_read_b128 v[248:251],v17 offset:41984
s_waitcnt lgkmcnt(5)
v_mfma_f32_16x16x32_bf16 v[64:67],a[32:35],v[224:227],v[64:67]
v_mov_b32 v44,vcc_lo
v_mov_b32 v45,s92
v_mfma_f32_16x16x32_bf16 v[72:75],a[160:163],v[224:227],v[72:75]
ds_read_b128 v[252:255],v43 offset:41984
ds_write_b64 v46,v[44:45]
v_mfma_f32_16x16x32_bf16 v[64:67],a[36:39],v[228:231],v[64:67]
v_min3_u32 v27,v27,v224,v228
v_mfma_f32_16x16x32_bf16 v[72:75],a[164:167],v[228:231],v[72:75]
ds_read_b128 v[224:227],v17 offset:49152
s_waitcnt lgkmcnt(6)
v_mfma_f32_16x16x32_bf16 v[64:67],a[40:43],v[232:235],v[64:67]
v_min3_u32 v27,v27,v232,v236
v_mfma_f32_16x16x32_bf16 v[72:75],a[168:171],v[232:235],v[72:75]
ds_read_b128 v[228:231],v43 offset:49152
v_mfma_f32_16x16x32_bf16 v[64:67],a[44:47],v[236:239],v[64:67]
v_mfma_f32_16x16x32_bf16 v[72:75],a[172:175],v[236:239],v[72:75]
ds_read_b128 v[232:235],v17 offset:57344
s_waitcnt lgkmcnt(6)
v_mfma_f32_16x16x32_bf16 v[64:67],a[96:99],v[240:243],v[64:67]
v_min3_u32 v27,v27,v240,v244
s_add_u32 s88,s70,s75
v_mfma_f32_16x16x32_bf16 v[72:75],a[224:227],v[240:243],v[72:75]
ds_read_b128 v[236:239],v43 offset:57344
s_add_u32 s88,s88,2097152
v_mfma_f32_16x16x32_bf16 v[64:67],a[100:103],v[244:247],v[64:67]
s_xor_b32 s88,s88,0x2000
s_add_u32 s89,s88,65536
v_mfma_f32_16x16x32_bf16 v[72:75],a[228:231],v[244:247],v[72:75]
ds_read_b128 v[240:243],v17 offset:50176
s_waitcnt lgkmcnt(6)
v_mfma_f32_16x16x32_bf16 v[64:67],a[104:107],v[248:251],v[64:67]
v_min3_u32 v27,v27,v248,v252
v_mfma_f32_16x16x32_bf16 v[72:75],a[232:235],v[248:251],v[72:75]
ds_read_b128 v[244:247],v43 offset:50176
v_mfma_f32_16x16x32_bf16 v[64:67],a[108:111],v[252:255],v[64:67]
v_mfma_f32_16x16x32_bf16 v[72:75],a[236:239],v[252:255],v[72:75]
ds_read_b128 v[248:251],v17 offset:58368
s_waitcnt lgkmcnt(5)
v_mfma_f32_16x16x32_bf16 v[64:67],a[48:51],v[224:227],v[64:67]
v_min3_u32 v27,v27,v224,v228
v_mfma_f32_16x16x32_bf16 v[72:75],a[176:179],v[224:227],v[72:75]
ds_read_b128 v[252:255],v43 offset:58368
v_mfma_f32_16x16x32_bf16 v[64:67],a[52:55],v[228:231],v[64:67]
s_waitcnt vmcnt(0)
v_add_u32 v22,s71,-1
v_mfma_f32_16x16x32_bf16 v[72:75],a[180:183],v[228:231],v[72:75]
s_waitcnt vmcnt(5)
s_barrier
ds_read_b64 v[44:45],v47
ds_read_b128 v[224:227],v17 offset:4096
s_waitcnt lgkmcnt(6)
v_mfma_f32_16x16x32_bf16 v[64:67],a[56:59],v[232:235],v[64:67]
v_min3_u32 v27,v27,v232,v236
buffer_store_dword v22,v23,s[24:27],s97 offen
v_mfma_f32_16x16x32_bf16 v[72:75],a[184:187],v[232:235],v[72:75]
ds_read_b128 v[228:231],v43 offset:4096
v_mfma_f32_16x16x32_bf16 v[64:67],a[60:63],v[236:239],v[64:67]
buffer_store_dword v22,v23,s[28:31],s97 offen sc1
v_mfma_f32_16x16x32_bf16 v[72:75],a[188:191],v[236:239],v[72:75]
ds_read_b128 v[232:235],v17 offset:12288
s_waitcnt lgkmcnt(6)
v_mfma_f32_16x16x32_bf16 v[64:67],a[112:115],v[240:243],v[64:67]
v_min3_u32 v27,v27,v240,v244
s_mov_b32 s97,0x7fff0000
v_mfma_f32_16x16x32_bf16 v[72:75],a[240:243],v[240:243],v[72:75]
ds_read_b128 v[236:239],v43 offset:12288
v_mfma_f32_16x16x32_bf16 v[64:67],a[116:119],v[244:247],v[64:67]
v_mfma_f32_16x16x32_bf16 v[72:75],a[244:247],v[244:247],v[72:75]
ds_read_b128 v[240:243],v17 offset:5120
s_waitcnt lgkmcnt(6)
v_mfma_f32_16x16x32_bf16 v[64:67],a[120:123],v[248:251],v[64:67]
s_waitcnt lgkmcnt(5)
v_readfirstlane_b32 s93,v45
v_mfma_f32_16x16x32_bf16 v[72:75],a[248:251],v[248:251],v[72:75]
ds_read_b128 v[244:247],v43 offset:5120
v_readfirstlane_b32 s83,v44
s_cmp_lg_u32 s83,0
s_cbranch_scc1 keep_234
v_mfma_f32_16x16x32_bf16 v[64:67],a[124:127],v[252:255],v[64:67]
v_min3_u32 v27,v27,v248,v252
s_xor_b32 m0,s72,0
v_mfma_f32_16x16x32_bf16 v[72:75],a[252:255],v[252:255],v[72:75]
ds_read_b128 v[248:251],v17 offset:13312
s_add_u32 s65,s88,0
s_waitcnt lgkmcnt(5)
v_mfma_f32_16x16x32_bf16 v[68:71],a[0:3],v[224:227],0
buffer_load_dwordx4 v42,s[20:23],s65 offen offset:0 sc1 lds
v_min3_u32 v27,v27,v224,v228
v_mfma_f32_16x16x32_bf16 v[76:79],a[128:131],v[224:227],0
ds_read_b128 v[252:255],v43 offset:13312
buffer_load_dwordx4 v42,s[20:23],s65 offen offset:1024 sc1 lds
v_mfma_f32_16x16x32_bf16 v[68:71],a[4:7],v[228:231],v[68:71]
v_cmp_eq_u32 vcc,0,v27
s_cbranch_vccnz retry_222
v_mfma_f32_16x16x32_bf16 v[76:79],a[132:135],v[228:231],v[76:79]
ds_read_b128 v[224:227],v17 offset:20480
s_xor_b32 m0,s72,16384
s_waitcnt lgkmcnt(5)
v_mfma_f32_16x16x32_bf16 v[68:71],a[8:11],v[232:235],v[68:71]
s_add_u32 s65,s88,256
v_min3_u32 v27,v27,v232,v236
v_mul_f32 v88,v64,v64
v_mul_f32 v92,v72,v72
v_mfma_f32_16x16x32_bf16 v[76:79],a[136:139],v[232:235],v[76:79]
ds_read_b128 v[228:231],v43 offset:20480
buffer_load_dwordx4 v42,s[20:23],s65 offen offset:0 sc1 lds
v_mul_f32 v93,v73,v73
v_mfma_f32_16x16x32_bf16 v[68:71],a[12:15],v[236:239],v[68:71]
v_mul_f32 v89,v65,v65
v_mul_f32 v90,v66,v66
v_mul_f32 v91,v67,v67
v_mul_f32 v94,v74,v74
v_mfma_f32_16x16x32_bf16 v[76:79],a[140:143],v[236:239],v[76:79]
ds_read_b128 v[232:235],v17 offset:28672
v_fma_f32 v88,v88,s81,v28
v_mul_f32 v95,v75,v75
s_waitcnt lgkmcnt(5)
v_mfma_f32_16x16x32_bf16 v[68:71],a[64:67],v[240:243],v[68:71]
buffer_load_dwordx4 v42,s[20:23],s65 offen offset:1024 sc1 lds
s_xor_b32 m0,s72,32768
v_fma_f32 v92,v92,s81,v28
v_mfma_f32_16x16x32_bf16 v[76:79],a[192:195],v[240:243],v[76:79]
ds_read_b128 v[236:239],v43 offset:28672
s_add_u32 s65,s88,512
v_fma_f32 v89,v89,s81,v28
v_fma_f32 v93,v93,s81,v28
v_mfma_f32_16x16x32_bf16 v[68:71],a[68:71],v[244:247],v[68:71]
v_min3_u32 v27,v27,v240,v244
v_fma_f32 v90,v90,s81,v28
v_fma_f32 v91,v91,s81,v28
v_fma_f32 v94,v94,s81,v28
v_mfma_f32_16x16x32_bf16 v[76:79],a[196:199],v[244:247],v[76:79]
ds_read_b128 v[240:243],v17 offset:21504
v_mul_f32 v88,v88,v64
v_fma_f32 v95,v95,s81,v28
s_waitcnt lgkmcnt(5)
v_mfma_f32_16x16x32_bf16 v[68:71],a[72:75],v[248:251],v[68:71]
buffer_load_dwordx4 v42,s[20:23],s65 offen offset:0 sc1 lds
v_mul_f32 v89,v89,v65
v_mul_f32 v92,v92,v72
v_mfma_f32_16x16x32_bf16 v[76:79],a[200:203],v[248:251],v[76:79]
ds_read_b128 v[244:247],v43 offset:21504
buffer_load_dwordx4 v42,s[20:23],s65 offen offset:1024 sc1 lds
v_mul_f32 v93,v93,v73
v_mfma_f32_16x16x32_bf16 v[68:71],a[76:79],v[252:255],v[68:71]
s_xor_b32 m0,s72,49152
v_min3_u32 v27,v27,v248,v252
v_mul_f32 v90,v90,v66
v_mul_f32 v94,v94,v74
v_mfma_f32_16x16x32_bf16 v[76:79],a[204:207],v[252:255],v[76:79]
ds_read_b128 v[248:251],v17 offset:29696
s_add_u32 s65,s88,768
v_mul_f32 v95,v95,v75
s_waitcnt lgkmcnt(5)
v_mfma_f32_16x16x32_bf16 v[68:71],a[16:19],v[224:227],v[68:71]
buffer_load_dwordx4 v42,s[20:23],s65 offen offset:0 sc1 lds
v_mul_f32 v91,v91,v67
v_mfma_f32_16x16x32_bf16 v[76:79],a[144:147],v[224:227],v[76:79]
ds_read_b128 v[252:255],v43 offset:29696
v_min3_u32 v27,v27,v224,v228
v_exp_f32 v92,v92
v_mfma_f32_16x16x32_bf16 v[68:71],a[20:23],v[228:231],v[68:71]
buffer_load_dwordx4 v42,s[20:23],s65 offen offset:1024 sc1 lds
v_exp_f32 v93,v93
v_mfma_f32_16x16x32_bf16 v[76:79],a[148:151],v[228:231],v[76:79]
ds_read_b128 v[224:227],v17 offset:36864
v_exp_f32 v94,v94
s_waitcnt lgkmcnt(5)
v_mfma_f32_16x16x32_bf16 v[68:71],a[24:27],v[232:235],v[68:71]
s_xor_b32 m0,s72,4096
s_add_u32 s65,s89,0
v_exp_f32 v95,v95
v_mfma_f32_16x16x32_bf16 v[76:79],a[152:155],v[232:235],v[76:79]
ds_read_b128 v[228:231],v43 offset:36864
v_min3_u32 v27,v27,v232,v236
v_add_f32 v92,1.0,v92
v_add_f32 v93,1.0,v93
v_mfma_f32_16x16x32_bf16 v[68:71],a[28:31],v[236:239],v[68:71]
buffer_load_dwordx4 v42,s[20:23],s65 offen offset:0 sc1 lds
v_add_f32 v94,1.0,v94
v_add_f32 v95,1.0,v95
v_mfma_f32_16x16x32_bf16 v[76:79],a[156:159],v[236:239],v[76:79]
ds_read_b128 v[232:235],v17 offset:45056
v_rcp_f32 v92,v92
s_waitcnt lgkmcnt(5)
v_mfma_f32_16x16x32_bf16 v[68:71],a[80:83],v[240:243],v[68:71]
buffer_load_dwordx4 v42,s[20:23],s65 offen offset:1024 sc1 lds
v_rcp_f32 v93,v93
v_mfma_f32_16x16x32_bf16 v[76:79],a[208:211],v[240:243],v[76:79]
ds_read_b128 v[236:239],v43 offset:45056
s_xor_b32 m0,s72,20480
v_rcp_f32 v94,v94
v_mfma_f32_16x16x32_bf16 v[68:71],a[84:87],v[244:247],v[68:71]
s_add_u32 s65,s89,256
v_min3_u32 v27,v27,v240,v244
v_rcp_f32 v95,v95
v_mfma_f32_16x16x32_bf16 v[76:79],a[212:215],v[244:247],v[76:79]
ds_read_b128 v[240:243],v17 offset:37888
v_mul_f32 v92,v92,v72
v_mul_f32 v93,v93,v73
s_waitcnt lgkmcnt(5)
v_mfma_f32_16x16x32_bf16 v[68:71],a[88:91],v[248:251],v[68:71]
buffer_load_dwordx4 v42,s[20:23],s65 offen offset:0 sc1 lds
v_mfma_f32_16x16x32_bf16 v[76:79],a[216:219],v[248:251],v[76:79]
ds_read_b128 v[244:247],v43 offset:37888
v_min3_u32 v27,v27,v248,v252
v_mfma_f32_16x16x32_bf16 v[68:71],a[92:95],v[252:255],v[68:71]
buffer_load_dwordx4 v42,s[20:23],s65 offen offset:1024 sc1 lds
v_mfma_f32_16x16x32_bf16 v[76:79],a[220:223],v[252:255],v[76:79]
ds_read_b128 v[248:251],v17 offset:46080
s_waitcnt lgkmcnt(5)
v_mfma_f32_16x16x32_bf16 v[68:71],a[32:35],v[224:227],v[68:71]
s_xor_b32 m0,s72,36864
s_add_u32 s65,s89,512
v_mfma_f32_16x16x32_bf16 v[76:79],a[160:163],v[224:227],v[76:79]
ds_read_b128 v[252:255],v43 offset:46080
v_min3_u32 v27,v27,v224,v228
v_mfma_f32_16x16x32_bf16 v[68:71],a[36:39],v[228:231],v[68:71]
buffer_load_dwordx4 v42,s[20:23],s65 offen offset:0 sc1 lds
v_mfma_f32_16x16x32_bf16 v[76:79],a[164:167],v[228:231],v[76:79]
ds_read_b128 v[224:227],v17 offset:53248
s_waitcnt lgkmcnt(5)
v_mfma_f32_16x16x32_bf16 v[68:71],a[40:43],v[232:235],v[68:71]
buffer_load_dwordx4 v42,s[20:23],s65 offen offset:1024 sc1 lds
v_mfma_f32_16x16x32_bf16 v[76:79],a[168:171],v[232:235],v[76:79]
ds_read_b128 v[228:231],v43 offset:53248
s_xor_b32 m0,s72,53248
v_mfma_f32_16x16x32_bf16 v[68:71],a[44:47],v[236:239],v[68:71]
s_add_u32 s65,s89,768
v_min3_u32 v27,v27,v232,v236
v_mfma_f32_16x16x32_bf16 v[76:79],a[172:175],v[236:239],v[76:79]
ds_read_b128 v[232:235],v17 offset:61440
s_waitcnt lgkmcnt(5)
v_mfma_f32_16x16x32_bf16 v[68:71],a[96:99],v[240:243],v[68:71]
buffer_load_dwordx4 v42,s[20:23],s65 offen offset:0 sc1 lds
v_mfma_f32_16x16x32_bf16 v[76:79],a[224:227],v[240:243],v[76:79]
ds_read_b128 v[236:239],v43 offset:61440
v_min3_u32 v27,v27,v240,v244
v_mfma_f32_16x16x32_bf16 v[68:71],a[100:103],v[244:247],v[68:71]
buffer_load_dwordx4 v42,s[20:23],s65 offen offset:1024 sc1 lds
v_mfma_f32_16x16x32_bf16 v[76:79],a[228:231],v[244:247],v[76:79]
ds_read_b128 v[240:243],v17 offset:54272
s_waitcnt lgkmcnt(5)
v_mfma_f32_16x16x32_bf16 v[68:71],a[104:107],v[248:251],v[68:71]
v_min3_u32 v27,v27,v248,v252
v_exp_f32 v88,v88
v_mfma_f32_16x16x32_bf16 v[76:79],a[232:235],v[248:251],v[76:79]
ds_read_b128 v[244:247],v43 offset:54272
v_exp_f32 v89,v89
v_mfma_f32_16x16x32_bf16 v[68:71],a[108:111],v[252:255],v[68:71]
v_exp_f32 v90,v90
v_mfma_f32_16x16x32_bf16 v[76:79],a[236:239],v[252:255],v[76:79]
ds_read_b128 v[248:251],v17 offset:62464
s_waitcnt lgkmcnt(5)
v_mfma_f32_16x16x32_bf16 v[68:71],a[48:51],v[224:227],v[68:71]
v_min3_u32 v27,v27,v224,v228
v_exp_f32 v91,v91
v_mfma_f32_16x16x32_bf16 v[76:79],a[176:179],v[224:227],v[76:79]
ds_read_b128 v[252:255],v43 offset:62464
v_add_f32 v88,1.0,v88
v_add_f32 v89,1.0,v89
v_mfma_f32_16x16x32_bf16 v[68:71],a[52:55],v[228:231],v[68:71]
v_add_f32 v90,1.0,v90
v_add_f32 v91,1.0,v91
v_mfma_f32_16x16x32_bf16 v[76:79],a[180:183],v[228:231],v[76:79]
v_rcp_f32 v88,v88
s_waitcnt lgkmcnt(4)
v_mfma_f32_16x16x32_bf16 v[68:71],a[56:59],v[232:235],v[68:71]
v_min3_u32 v27,v27,v232,v236
v_rcp_f32 v89,v89
v_mfma_f32_16x16x32_bf16 v[76:79],a[184:187],v[232:235],v[76:79]
v_rcp_f32 v90,v90
v_mfma_f32_16x16x32_bf16 v[68:71],a[60:63],v[236:239],v[68:71]
v_rcp_f32 v91,v91
v_mfma_f32_16x16x32_bf16 v[76:79],a[188:191],v[236:239],v[76:79]
v_mul_f32 v88,v88,v64
s_waitcnt lgkmcnt(2)
v_mfma_f32_16x16x32_bf16 v[68:71],a[112:115],v[240:243],v[68:71]
v_min3_u32 v27,v27,v240,v244
v_mul_f32 v89,v89,v65
v_mfma_f32_16x16x32_bf16 v[76:79],a[240:243],v[240:243],v[76:79]
v_mul_f32 v90,v90,v66
v_mul_f32 v91,v91,v67
v_mfma_f32_16x16x32_bf16 v[68:71],a[116:119],v[244:247],v[68:71]
v_mul_f32 v94,v94,v74
v_mul_f32 v95,v95,v75
v_mfma_f32_16x16x32_bf16 v[76:79],a[244:247],v[244:247],v[76:79]
v_cvt_pk_bf16_f32 v96,v88,v89
s_waitcnt lgkmcnt(0)
v_mfma_f32_16x16x32_bf16 v[68:71],a[120:123],v[248:251],v[68:71]
v_min3_u32 v27,v27,v248,v252
v_cvt_pk_bf16_f32 v97,v90,v91
v_mfma_f32_16x16x32_bf16 v[76:79],a[248:251],v[248:251],v[76:79]
v_cvt_pk_bf16_f32 v98,v92,v93
v_cvt_pk_bf16_f32 v99,v94,v95
v_mfma_f32_16x16x32_bf16 v[68:71],a[124:127],v[252:255],v[68:71]
v_max_u32 v96,1,v96
v_mfma_f32_16x16x32_bf16 v[76:79],a[252:255],v[252:255],v[76:79]
buffer_store_dwordx4 v[96:99],v18,s[20:23],s78 offen sc1
v_cmp_eq_u32 vcc,0,v27
s_cbranch_vccnz retry_222
s_branch epi_225
keep_234:
v_mfma_f32_16x16x32_bf16 v[64:67],a[124:127],v[252:255],v[64:67]
v_min3_u32 v27,v27,v248,v252
v_mfma_f32_16x16x32_bf16 v[72:75],a[252:255],v[252:255],v[72:75]
ds_read_b128 v[248:251],v17 offset:13312
s_waitcnt lgkmcnt(5)
v_mfma_f32_16x16x32_bf16 v[68:71],a[0:3],v[224:227],0
v_cmp_eq_u32 vcc,0,v27
s_cbranch_vccnz retry_222
v_mfma_f32_16x16x32_bf16 v[76:79],a[128:131],v[224:227],0
ds_read_b128 v[252:255],v43 offset:13312
v_min3_u32 v27,v27,v224,v228
v_mfma_f32_16x16x32_bf16 v[68:71],a[4:7],v[228:231],v[68:71]
v_mfma_f32_16x16x32_bf16 v[76:79],a[132:135],v[228:231],v[76:79]
ds_read_b128 v[224:227],v17 offset:20480
s_waitcnt lgkmcnt(5)
v_mfma_f32_16x16x32_bf16 v[68:71],a[8:11],v[232:235],v[68:71]
v_min3_u32 v27,v27,v232,v236
v_mul_f32 v88,v64,v64
v_mul_f32 v92,v72,v72
v_mfma_f32_16x16x32_bf16 v[76:79],a[136:139],v[232:235],v[76:79]
ds_read_b128 v[228:231],v43 offset:20480
v_mul_f32 v89,v65,v65
v_mul_f32 v93,v73,v73
v_mfma_f32_16x16x32_bf16 v[68:71],a[12:15],v[236:239],v[68:71]
v_mul_f32 v90,v66,v66
v_mul_f32 v91,v67,v67
v_mul_f32 v94,v74,v74
v_mfma_f32_16x16x32_bf16 v[76:79],a[140:143],v[236:239],v[76:79]
ds_read_b128 v[232:235],v17 offset:28672
v_mul_f32 v95,v75,v75
s_waitcnt lgkmcnt(5)
v_mfma_f32_16x16x32_bf16 v[68:71],a[64:67],v[240:243],v[68:71]
v_min3_u32 v27,v27,v240,v244
v_fma_f32 v88,v88,s81,v28
v_fma_f32 v92,v92,s81,v28
v_mfma_f32_16x16x32_bf16 v[76:79],a[192:195],v[240:243],v[76:79]
ds_read_b128 v[236:239],v43 offset:28672
v_fma_f32 v89,v89,s81,v28
v_fma_f32 v93,v93,s81,v28
v_mfma_f32_16x16x32_bf16 v[68:71],a[68:71],v[244:247],v[68:71]
v_fma_f32 v90,v90,s81,v28
v_fma_f32 v91,v91,s81,v28
v_fma_f32 v94,v94,s81,v28
v_mfma_f32_16x16x32_bf16 v[76:79],a[196:199],v[244:247],v[76:79]
ds_read_b128 v[240:243],v17 offset:21504
v_fma_f32 v95,v95,s81,v28
s_waitcnt lgkmcnt(5)
v_mfma_f32_16x16x32_bf16 v[68:71],a[72:75],v[248:251],v[68:71]
v_min3_u32 v27,v27,v248,v252
v_mul_f32 v88,v88,v64
v_mul_f32 v92,v92,v72
v_mfma_f32_16x16x32_bf16 v[76:79],a[200:203],v[248:251],v[76:79]
ds_read_b128 v[244:247],v43 offset:21504
v_mul_f32 v89,v89,v65
v_mul_f32 v93,v93,v73
v_mfma_f32_16x16x32_bf16 v[68:71],a[76:79],v[252:255],v[68:71]
v_mul_f32 v90,v90,v66
v_mul_f32 v91,v91,v67
v_mul_f32 v94,v94,v74
v_mfma_f32_16x16x32_bf16 v[76:79],a[204:207],v[252:255],v[76:79]
ds_read_b128 v[248:251],v17 offset:29696
v_mul_f32 v95,v95,v75
s_waitcnt lgkmcnt(5)
v_mfma_f32_16x16x32_bf16 v[68:71],a[16:19],v[224:227],v[68:71]
v_min3_u32 v27,v27,v224,v228
v_exp_f32 v92,v92
v_mfma_f32_16x16x32_bf16 v[76:79],a[144:147],v[224:227],v[76:79]
ds_read_b128 v[252:255],v43 offset:29696
v_exp_f32 v93,v93
v_mfma_f32_16x16x32_bf16 v[68:71],a[20:23],v[228:231],v[68:71]
v_exp_f32 v88,v88
v_mfma_f32_16x16x32_bf16 v[76:79],a[148:151],v[228:231],v[76:79]
ds_read_b128 v[224:227],v17 offset:36864
s_waitcnt lgkmcnt(5)
v_mfma_f32_16x16x32_bf16 v[68:71],a[24:27],v[232:235],v[68:71]
v_min3_u32 v27,v27,v232,v236
v_exp_f32 v94,v94
v_mfma_f32_16x16x32_bf16 v[76:79],a[152:155],v[232:235],v[76:79]
ds_read_b128 v[228:231],v43 offset:36864
v_exp_f32 v95,v95
v_mfma_f32_16x16x32_bf16 v[68:71],a[28:31],v[236:239],v[68:71]
v_exp_f32 v89,v89
v_add_f32 v92,1.0,v92
v_mfma_f32_16x16x32_bf16 v[76:79],a[156:159],v[236:239],v[76:79]
ds_read_b128 v[232:235],v17 offset:45056
v_add_f32 v93,1.0,v93
s_waitcnt lgkmcnt(5)
v_mfma_f32_16x16x32_bf16 v[68:71],a[80:83],v[240:243],v[68:71]
v_min3_u32 v27,v27,v240,v244
v_add_f32 v94,1.0,v94
v_add_f32 v95,1.0,v95
v_mfma_f32_16x16x32_bf16 v[76:79],a[208:211],v[240:243],v[76:79]
ds_read_b128 v[236:239],v43 offset:45056
v_rcp_f32 v92,v92
v_mfma_f32_16x16x32_bf16 v[68:71],a[84:87],v[244:247],v[68:71]
v_exp_f32 v90,v90
v_mfma_f32_16x16x32_bf16 v[76:79],a[212:215],v[244:247],v[76:79]
ds_read_b128 v[240:243],v17 offset:37888
s_waitcnt lgkmcnt(5)
v_mfma_f32_16x16x32_bf16 v[68:71],a[88:91],v[248:251],v[68:71]
v_min3_u32 v27,v27,v248,v252
v_rcp_f32 v93,v93
v_mfma_f32_16x16x32_bf16 v[76:79],a[216:219],v[248:251],v[76:79]
ds_read_b128 v[244:247],v43 offset:37888
v_rcp_f32 v94,v94
v_mfma_f32_16x16x32_bf16 v[68:71],a[92:95],v[252:255],v[68:71]
v_exp_f32 v91,v91
v_mfma_f32_16x16x32_bf16 v[76:79],a[220:223],v[252:255],v[76:79]
ds_read_b128 v[248:251],v17 offset:46080
s_waitcnt lgkmcnt(5)
v_mfma_f32_16x16x32_bf16 v[68:71],a[32:35],v[224:227],v[68:71]
v_min3_u32 v27,v27,v224,v228
v_add_f32 v88,1.0,v88
v_mfma_f32_16x16x32_bf16 v[76:79],a[160:163],v[224:227],v[76:79]
ds_read_b128 v[252:255],v43 offset:46080
v_add_f32 v89,1.0,v89
v_mfma_f32_16x16x32_bf16 v[68:71],a[36:39],v[228:231],v[68:71]
v_add_f32 v90,1.0,v90
v_add_f32 v91,1.0,v91
v_mfma_f32_16x16x32_bf16 v[76:79],a[164:167],v[228:231],v[76:79]
ds_read_b128 v[224:227],v17 offset:53248
s_waitcnt lgkmcnt(5)
v_mfma_f32_16x16x32_bf16 v[68:71],a[40:43],v[232:235],v[68:71]
v_min3_u32 v27,v27,v232,v236
v_mfma_f32_16x16x32_bf16 v[76:79],a[168:171],v[232:235],v[76:79]
ds_read_b128 v[228:231],v43 offset:53248
v_mfma_f32_16x16x32_bf16 v[68:71],a[44:47],v[236:239],v[68:71]
v_rcp_f32 v88,v88
v_mfma_f32_16x16x32_bf16 v[76:79],a[172:175],v[236:239],v[76:79]
ds_read_b128 v[232:235],v17 offset:61440
s_waitcnt lgkmcnt(5)
v_mfma_f32_16x16x32_bf16 v[68:71],a[96:99],v[240:243],v[68:71]
v_min3_u32 v27,v27,v240,v244
v_mfma_f32_16x16x32_bf16 v[76:79],a[224:227],v[240:243],v[76:79]
ds_read_b128 v[236:239],v43 offset:61440
v_mfma_f32_16x16x32_bf16 v[68:71],a[100:103],v[244:247],v[68:71]
v_rcp_f32 v89,v89
v_mfma_f32_16x16x32_bf16 v[76:79],a[228:231],v[244:247],v[76:79]
ds_read_b128 v[240:243],v17 offset:54272
s_waitcnt lgkmcnt(5)
v_mfma_f32_16x16x32_bf16 v[68:71],a[104:107],v[248:251],v[68:71]
v_min3_u32 v27,v27,v248,v252
v_mfma_f32_16x16x32_bf16 v[76:79],a[232:235],v[248:251],v[76:79]
ds_read_b128 v[244:247],v43 offset:54272
v_mfma_f32_16x16x32_bf16 v[68:71],a[108:111],v[252:255],v[68:71]
v_rcp_f32 v90,v90
v_mfma_f32_16x16x32_bf16 v[76:79],a[236:239],v[252:255],v[76:79]
ds_read_b128 v[248:251],v17 offset:62464
s_waitcnt lgkmcnt(5)
v_mfma_f32_16x16x32_bf16 v[68:71],a[48:51],v[224:227],v[68:71]
v_min3_u32 v27,v27,v224,v228
v_mfma_f32_16x16x32_bf16 v[76:79],a[176:179],v[224:227],v[76:79]
ds_read_b128 v[252:255],v43 offset:62464
v_mfma_f32_16x16x32_bf16 v[68:71],a[52:55],v[228:231],v[68:71]
v_rcp_f32 v91,v91
v_mfma_f32_16x16x32_bf16 v[76:79],a[180:183],v[228:231],v[76:79]
v_mul_f32 v88,v88,v64
s_waitcnt lgkmcnt(4)
v_mfma_f32_16x16x32_bf16 v[68:71],a[56:59],v[232:235],v[68:71]
v_min3_u32 v27,v27,v232,v236
v_mul_f32 v89,v89,v65
v_mfma_f32_16x16x32_bf16 v[76:79],a[184:187],v[232:235],v[76:79]
v_mul_f32 v90,v90,v66
v_mul_f32 v91,v91,v67
v_mfma_f32_16x16x32_bf16 v[68:71],a[60:63],v[236:239],v[68:71]
v_rcp_f32 v95,v95
v_mfma_f32_16x16x32_bf16 v[76:79],a[188:191],v[236:239],v[76:79]
v_mul_f32 v92,v92,v72
s_waitcnt lgkmcnt(2)
v_mfma_f32_16x16x32_bf16 v[68:71],a[112:115],v[240:243],v[68:71]
v_min3_u32 v27,v27,v240,v244
v_mul_f32 v93,v93,v73
v_mfma_f32_16x16x32_bf16 v[76:79],a[240:243],v[240:243],v[76:79]
v_mul_f32 v94,v94,v74
v_mul_f32 v95,v95,v75
v_mfma_f32_16x16x32_bf16 v[68:71],a[116:119],v[244:247],v[68:71]
v_cvt_pk_bf16_f32 v96,v88,v89
v_cvt_pk_bf16_f32 v97,v90,v91
v_mfma_f32_16x16x32_bf16 v[76:79],a[244:247],v[244:247],v[76:79]
v_cvt_pk_bf16_f32 v98,v92,v93
s_waitcnt lgkmcnt(0)
v_mfma_f32_16x16x32_bf16 v[68:71],a[120:123],v[248:251],v[68:71]
v_min3_u32 v27,v27,v248,v252
v_cvt_pk_bf16_f32 v99,v94,v95
v_mfma_f32_16x16x32_bf16 v[76:79],a[248:251],v[248:251],v[76:79]
v_max_u32 v96,1,v96
v_mfma_f32_16x16x32_bf16 v[68:71],a[124:127],v[252:255],v[68:71]
buffer_store_dwordx4 v[96:99],v18,s[20:23],s78 offen sc1
v_mfma_f32_16x16x32_bf16 v[76:79],a[252:255],v[252:255],v[76:79]
v_cmp_eq_u32 vcc,0,v27
s_cbranch_vccnz retry_222
s_branch epi_225
both_226:
s_waitcnt vmcnt(13) lgkmcnt(0)
s_barrier
ds_read_b128 v[224:227],v17 offset:0
ds_read_b128 v[228:231],v43 offset:0
ds_read_b128 v[232:235],v17 offset:8192
ds_read_b128 v[236:239],v43 offset:8192
ds_read_b128 v[240:243],v17 offset:1024
ds_read_b128 v[244:247],v43 offset:1024
ds_read_b128 v[248:251],v17 offset:9216
s_waitcnt lgkmcnt(5)
v_mfma_f32_16x16x32_bf16 v[64:67],a[0:3],v[224:227],0
s_add_u32 s96,s71,1
s_add_u32 s92,s71,2
v_min_u32 v27,v224,v228
v_mfma_f32_16x16x32_bf16 v[72:75],a[128:131],v[224:227],0
ds_read_b128 v[252:255],v43 offset:9216
s_add_u32 s88,s70,s75
v_mfma_f32_16x16x32_bf16 v[64:67],a[4:7],v[228:231],v[64:67]
s_add_u32 s88,s88,2097152
s_xor_b32 s88,s88,0x2000
v_mfma_f32_16x16x32_bf16 v[72:75],a[132:135],v[228:231],v[72:75]
ds_read_b128 v[224:227],v17 offset:16384
s_waitcnt lgkmcnt(5)
v_mfma_f32_16x16x32_bf16 v[64:67],a[8:11],v[232:235],v[64:67]
s_add_u32 s89,s88,65536
v_min3_u32 v27,v27,v232,v236
v_mfma_f32_16x16x32_bf16 v[72:75],a[136:139],v[232:235],v[72:75]
ds_read_b128 v[228:231],v43 offset:16384
v_mfma_f32_16x16x32_bf16 v[64:67],a[12:15],v[236:239],v[64:67]
s_xor_b32 m0,s72,0
v_mfma_f32_16x16x32_bf16 v[72:75],a[140:143],v[236:239],v[72:75]
ds_read_b128 v[232:235],v17 offset:24576
s_add_u32 s65,s88,0
s_waitcnt lgkmcnt(5)
v_mfma_f32_16x16x32_bf16 v[64:67],a[64:67],v[240:243],v[64:67]
v_min3_u32 v27,v27,v240,v244
v_mfma_f32_16x16x32_bf16 v[72:75],a[192:195],v[240:243],v[72:75]
ds_read_b128 v[236:239],v43 offset:24576
buffer_load_dwordx4 v42,s[20:23],s65 offen offset:0 sc1 lds
v_mfma_f32_16x16x32_bf16 v[64:67],a[68:71],v[244:247],v[64:67]
buffer_load_dwordx4 v42,s[20:23],s65 offen offset:1024 sc1 lds
v_mfma_f32_16x16x32_bf16 v[72:75],a[196:199],v[244:247],v[72:75]
ds_read_b128 v[240:243],v17 offset:17408
s_waitcnt lgkmcnt(5)
v_mfma_f32_16x16x32_bf16 v[64:67],a[72:75],v[248:251],v[64:67]
s_xor_b32 m0,s72,16384
v_min3_u32 v27,v27,v248,v252
v_mfma_f32_16x16x32_bf16 v[72:75],a[200:203],v[248:251],v[72:75]
ds_read_b128 v[244:247],v43 offset:17408
v_mfma_f32_16x16x32_bf16 v[64:67],a[76:79],v[252:255],v[64:67]
s_add_u32 s65,s88,256
v_mfma_f32_16x16x32_bf16 v[72:75],a[204:207],v[252:255],v[72:75]
ds_read_b128 v[248:251],v17 offset:25600
s_waitcnt lgkmcnt(5)
v_mfma_f32_16x16x32_bf16 v[64:67],a[16:19],v[224:227],v[64:67]
buffer_load_dwordx4 v42,s[20:23],s65 offen offset:0 sc1 lds
v_mfma_f32_16x16x32_bf16 v[72:75],a[144:147],v[224:227],v[72:75]
ds_read_b128 v[252:255],v43 offset:25600
buffer_load_dwordx4 v42,s[20:23],s65 offen offset:1024 sc1 lds
v_mfma_f32_16x16x32_bf16 v[64:67],a[20:23],v[228:231],v[64:67]
v_min3_u32 v27,v27,v224,v228
v_mfma_f32_16x16x32_bf16 v[72:75],a[148:151],v[228:231],v[72:75]
ds_read_b128 v[224:227],v17 offset:32768
s_xor_b32 m0,s72,32768
s_waitcnt lgkmcnt(5)
v_mfma_f32_16x16x32_bf16 v[64:67],a[24:27],v[232:235],v[64:67]
s_add_u32 s65,s88,512
v_min3_u32 v27,v27,v232,v236
v_mfma_f32_16x16x32_bf16 v[72:75],a[152:155],v[232:235],v[72:75]
ds_read_b128 v[228:231],v43 offset:32768
v_mfma_f32_16x16x32_bf16 v[64:67],a[28:31],v[236:239],v[64:67]
buffer_load_dwordx4 v42,s[20:23],s65 offen offset:0 sc1 lds
v_mfma_f32_16x16x32_bf16 v[72:75],a[156:159],v[236:239],v[72:75]
ds_read_b128 v[232:235],v17 offset:40960
s_waitcnt lgkmcnt(5)
v_mfma_f32_16x16x32_bf16 v[64:67],a[80:83],v[240:243],v[64:67]
buffer_load_dwordx4 v42,s[20:23],s65 offen offset:1024 sc1 lds
v_mfma_f32_16x16x32_bf16 v[72:75],a[208:211],v[240:243],v[72:75]
ds_read_b128 v[236:239],v43 offset:40960
s_xor_b32 m0,s72,49152
v_mfma_f32_16x16x32_bf16 v[64:67],a[84:87],v[244:247],v[64:67]
v_min3_u32 v27,v27,v240,v244
v_mfma_f32_16x16x32_bf16 v[72:75],a[212:215],v[244:247],v[72:75]
ds_read_b128 v[240:243],v17 offset:33792
s_add_u32 s65,s88,768
s_waitcnt lgkmcnt(5)
v_mfma_f32_16x16x32_bf16 v[64:67],a[88:91],v[248:251],v[64:67]
buffer_load_dwordx4 v42,s[20:23],s65 offen offset:0 sc1 lds
v_min3_u32 v27,v27,v248,v252
v_mfma_f32_16x16x32_bf16 v[72:75],a[216:219],v[248:251],v[72:75]
ds_read_b128 v[244:247],v43 offset:33792
s_waitcnt vmcnt(10)
v_mfma_f32_16x16x32_bf16 v[64:67],a[92:95],v[252:255],v[64:67]
v_cmp_gt_u32 vcc,s96,v29
v_cmp_gt_u32 s[92:93],s92,v29
v_mfma_f32_16x16x32_bf16 v[72:75],a[220:223],v[252:255],v[72:75]
ds_read_b128 v[248:251],v17 offset:41984
s_waitcnt lgkmcnt(5)
v_mfma_f32_16x16x32_bf16 v[64:67],a[32:35],v[224:227],v[64:67]
v_mov_b32 v44,vcc_lo
v_mov_b32 v45,s92
v_min3_u32 v27,v27,v224,v228
v_mfma_f32_16x16x32_bf16 v[72:75],a[160:163],v[224:227],v[72:75]
ds_read_b128 v[252:255],v43 offset:41984
ds_write_b64 v46,v[44:45]
v_mfma_f32_16x16x32_bf16 v[64:67],a[36:39],v[228:231],v[64:67]
buffer_load_dwordx4 v42,s[20:23],s65 offen offset:1024 sc1 lds
v_mfma_f32_16x16x32_bf16 v[72:75],a[164:167],v[228:231],v[72:75]
ds_read_b128 v[224:227],v17 offset:49152
s_waitcnt lgkmcnt(6)
v_mfma_f32_16x16x32_bf16 v[64:67],a[40:43],v[232:235],v[64:67]
s_xor_b32 m0,s72,4096
s_add_u32 s65,s89,0
v_mfma_f32_16x16x32_bf16 v[72:75],a[168:171],v[232:235],v[72:75]
ds_read_b128 v[228:231],v43 offset:49152
v_min3_u32 v27,v27,v232,v236
v_mfma_f32_16x16x32_bf16 v[64:67],a[44:47],v[236:239],v[64:67]
buffer_load_dwordx4 v42,s[20:23],s65 offen offset:0 sc1 lds
v_mfma_f32_16x16x32_bf16 v[72:75],a[172:175],v[236:239],v[72:75]
ds_read_b128 v[232:235],v17 offset:57344
s_waitcnt lgkmcnt(6)
v_mfma_f32_16x16x32_bf16 v[64:67],a[96:99],v[240:243],v[64:67]
buffer_load_dwordx4 v42,s[20:23],s65 offen offset:1024 sc1 lds
v_mfma_f32_16x16x32_bf16 v[72:75],a[224:227],v[240:243],v[72:75]
ds_read_b128 v[236:239],v43 offset:57344
s_xor_b32 m0,s72,20480
v_mfma_f32_16x16x32_bf16 v[64:67],a[100:103],v[244:247],v[64:67]
s_add_u32 s65,s89,256
v_min3_u32 v27,v27,v240,v244
v_mfma_f32_16x16x32_bf16 v[72:75],a[228:231],v[244:247],v[72:75]
ds_read_b128 v[240:243],v17 offset:50176
s_waitcnt lgkmcnt(6)
v_mfma_f32_16x16x32_bf16 v[64:67],a[104:107],v[248:251],v[64:67]
buffer_load_dwordx4 v42,s[20:23],s65 offen offset:0 sc1 lds
v_mfma_f32_16x16x32_bf16 v[72:75],a[232:235],v[248:251],v[72:75]
ds_read_b128 v[244:247],v43 offset:50176
v_min3_u32 v27,v27,v248,v252
v_mfma_f32_16x16x32_bf16 v[64:67],a[108:111],v[252:255],v[64:67]
buffer_load_dwordx4 v42,s[20:23],s65 offen offset:1024 sc1 lds
v_mfma_f32_16x16x32_bf16 v[72:75],a[236:239],v[252:255],v[72:75]
ds_read_b128 v[248:251],v17 offset:58368
s_waitcnt lgkmcnt(5)
v_mfma_f32_16x16x32_bf16 v[64:67],a[48:51],v[224:227],v[64:67]
s_xor_b32 m0,s72,36864
s_add_u32 s65,s89,512
v_mfma_f32_16x16x32_bf16 v[72:75],a[176:179],v[224:227],v[72:75]
ds_read_b128 v[252:255],v43 offset:58368
v_min3_u32 v27,v27,v224,v228
v_mfma_f32_16x16x32_bf16 v[64:67],a[52:55],v[228:231],v[64:67]
buffer_load_dwordx4 v42,s[20:23],s65 offen offset:0 sc1 lds
s_waitcnt vmcnt(13)
v_add_u32 v22,s71,-1
v_mfma_f32_16x16x32_bf16 v[72:75],a[180:183],v[228:231],v[72:75]
s_waitcnt vmcnt(18)
s_barrier
ds_read_b64 v[44:45],v47
ds_read_b128 v[224:227],v17 offset:4096
s_waitcnt lgkmcnt(6)
v_mfma_f32_16x16x32_bf16 v[64:67],a[56:59],v[232:235],v[64:67]
buffer_load_dwordx4 v42,s[20:23],s65 offen offset:1024 sc1 lds
buffer_store_dword v22,v23,s[24:27],s97 offen
v_mfma_f32_16x16x32_bf16 v[72:75],a[184:187],v[232:235],v[72:75]
ds_read_b128 v[228:231],v43 offset:4096
s_xor_b32 m0,s72,53248
buffer_store_dword v22,v23,s[28:31],s97 offen sc1
v_mfma_f32_16x16x32_bf16 v[64:67],a[60:63],v[236:239],v[64:67]
s_add_u32 s65,s89,768
v_min3_u32 v27,v27,v232,v236
s_mov_b32 s97,0x7fff0000
v_mfma_f32_16x16x32_bf16 v[72:75],a[188:191],v[236:239],v[72:75]
ds_read_b128 v[232:235],v17 offset:12288
s_waitcnt lgkmcnt(6)
v_mfma_f32_16x16x32_bf16 v[64:67],a[112:115],v[240:243],v[64:67]
buffer_load_dwordx4 v42,s[20:23],s65 offen offset:0 sc1 lds
v_mfma_f32_16x16x32_bf16 v[72:75],a[240:243],v[240:243],v[72:75]
ds_read_b128 v[236:239],v43 offset:12288
v_min3_u32 v27,v27,v240,v244
v_mfma_f32_16x16x32_bf16 v[64:67],a[116:119],v[244:247],v[64:67]
buffer_load_dwordx4 v42,s[20:23],s65 offen offset:1024 sc1 lds
v_mfma_f32_16x16x32_bf16 v[72:75],a[244:247],v[244:247],v[72:75]
ds_read_b128 v[240:243],v17 offset:5120
s_waitcnt lgkmcnt(6)
v_mfma_f32_16x16x32_bf16 v[64:67],a[120:123],v[248:251],v[64:67]
s_waitcnt lgkmcnt(5)
v_readfirstlane_b32 s93,v45
v_mfma_f32_16x16x32_bf16 v[72:75],a[248:251],v[248:251],v[72:75]
ds_read_b128 v[244:247],v43 offset:5120
v_min3_u32 v27,v27,v248,v252
v_mfma_f32_16x16x32_bf16 v[64:67],a[124:127],v[252:255],v[64:67]
v_mfma_f32_16x16x32_bf16 v[72:75],a[252:255],v[252:255],v[72:75]
ds_read_b128 v[248:251],v17 offset:13312
s_waitcnt lgkmcnt(5)
v_mfma_f32_16x16x32_bf16 v[68:71],a[0:3],v[224:227],0
v_cmp_eq_u32 vcc,0,v27
s_cbranch_vccnz retry_222
v_mfma_f32_16x16x32_bf16 v[76:79],a[128:131],v[224:227],0
ds_read_b128 v[252:255],v43 offset:13312
v_min3_u32 v27,v27,v224,v228
v_mfma_f32_16x16x32_bf16 v[68:71],a[4:7],v[228:231],v[68:71]
v_mfma_f32_16x16x32_bf16 v[76:79],a[132:135],v[228:231],v[76:79]
ds_read_b128 v[224:227],v17 offset:20480
s_waitcnt lgkmcnt(5)
v_mfma_f32_16x16x32_bf16 v[68:71],a[8:11],v[232:235],v[68:71]
v_min3_u32 v27,v27,v232,v236
v_mul_f32 v88,v64,v64
v_mul_f32 v92,v72,v72
v_mfma_f32_16x16x32_bf16 v[76:79],a[136:139],v[232:235],v[76:79]
ds_read_b128 v[228:231],v43 offset:20480
v_mul_f32 v89,v65,v65
v_mul_f32 v93,v73,v73
v_mfma_f32_16x16x32_bf16 v[68:71],a[12:15],v[236:239],v[68:71]
v_mul_f32 v90,v66,v66
v_mul_f32 v91,v67,v67
v_mul_f32 v94,v74,v74
v_mfma_f32_16x16x32_bf16 v[76:79],a[140:143],v[236:239],v[76:79]
ds_read_b128 v[232:235],v17 offset:28672
v_mul_f32 v95,v75,v75
s_waitcnt lgkmcnt(5)
v_mfma_f32_16x16x32_bf16 v[68:71],a[64:67],v[240:243],v[68:71]
v_min3_u32 v27,v27,v240,v244
v_fma_f32 v88,v88,s81,v28
v_fma_f32 v92,v92,s81,v28
v_mfma_f32_16x16x32_bf16 v[76:79],a[192:195],v[240:243],v[76:79]
ds_read_b128 v[236:239],v43 offset:28672
v_fma_f32 v89,v89,s81,v28
v_fma_f32 v93,v93,s81,v28
v_mfma_f32_16x16x32_bf16 v[68:71],a[68:71],v[244:247],v[68:71]
v_fma_f32 v90,v90,s81,v28
v_fma_f32 v91,v91,s81,v28
v_fma_f32 v94,v94,s81,v28
v_mfma_f32_16x16x32_bf16 v[76:79],a[196:199],v[244:247],v[76:79]
ds_read_b128 v[240:243],v17 offset:21504
v_fma_f32 v95,v95,s81,v28
s_waitcnt lgkmcnt(5)
v_mfma_f32_16x16x32_bf16 v[68:71],a[72:75],v[248:251],v[68:71]
v_min3_u32 v27,v27,v248,v252
v_mul_f32 v88,v88,v64
v_mul_f32 v92,v92,v72
v_mfma_f32_16x16x32_bf16 v[76:79],a[200:203],v[248:251],v[76:79]
ds_read_b128 v[244:247],v43 offset:21504
v_mul_f32 v89,v89,v65
v_mul_f32 v93,v93,v73
v_mfma_f32_16x16x32_bf16 v[68:71],a[76:79],v[252:255],v[68:71]
v_mul_f32 v90,v90,v66
v_mul_f32 v91,v91,v67
v_mul_f32 v94,v94,v74
v_mfma_f32_16x16x32_bf16 v[76:79],a[204:207],v[252:255],v[76:79]
ds_read_b128 v[248:251],v17 offset:29696
v_mul_f32 v95,v95,v75
s_waitcnt lgkmcnt(5)
v_mfma_f32_16x16x32_bf16 v[68:71],a[16:19],v[224:227],v[68:71]
v_min3_u32 v27,v27,v224,v228
v_exp_f32 v92,v92
v_mfma_f32_16x16x32_bf16 v[76:79],a[144:147],v[224:227],v[76:79]
ds_read_b128 v[252:255],v43 offset:29696
v_exp_f32 v93,v93
v_mfma_f32_16x16x32_bf16 v[68:71],a[20:23],v[228:231],v[68:71]
v_exp_f32 v88,v88
v_mfma_f32_16x16x32_bf16 v[76:79],a[148:151],v[228:231],v[76:79]
ds_read_b128 v[224:227],v17 offset:36864
s_waitcnt lgkmcnt(5)
v_mfma_f32_16x16x32_bf16 v[68:71],a[24:27],v[232:235],v[68:71]
v_min3_u32 v27,v27,v232,v236
v_exp_f32 v94,v94
v_mfma_f32_16x16x32_bf16 v[76:79],a[152:155],v[232:235],v[76:79]
ds_read_b128 v[228:231],v43 offset:36864
v_exp_f32 v95,v95
v_mfma_f32_16x16x32_bf16 v[68:71],a[28:31],v[236:239],v[68:71]
v_exp_f32 v89,v89
v_add_f32 v92,1.0,v92
v_mfma_f32_16x16x32_bf16 v[76:79],a[156:159],v[236:239],v[76:79]
ds_read_b128 v[232:235],v17 offset:45056
v_add_f32 v93,1.0,v93
s_waitcnt lgkmcnt(5)
v_mfma_f32_16x16x32_bf16 v[68:71],a[80:83],v[240:243],v[68:71]
v_min3_u32 v27,v27,v240,v244
v_add_f32 v94,1.0,v94
v_add_f32 v95,1.0,v95
v_mfma_f32_16x16x32_bf16 v[76:79],a[208:211],v[240:243],v[76:79]
ds_read_b128 v[236:239],v43 offset:45056
v_rcp_f32 v92,v92
v_mfma_f32_16x16x32_bf16 v[68:71],a[84:87],v[244:247],v[68:71]
v_exp_f32 v90,v90
v_mfma_f32_16x16x32_bf16 v[76:79],a[212:215],v[244:247],v[76:79]
ds_read_b128 v[240:243],v17 offset:37888
s_waitcnt lgkmcnt(5)
v_mfma_f32_16x16x32_bf16 v[68:71],a[88:91],v[248:251],v[68:71]
v_min3_u32 v27,v27,v248,v252
v_rcp_f32 v93,v93
v_mfma_f32_16x16x32_bf16 v[76:79],a[216:219],v[248:251],v[76:79]
ds_read_b128 v[244:247],v43 offset:37888
v_rcp_f32 v94,v94
v_mfma_f32_16x16x32_bf16 v[68:71],a[92:95],v[252:255],v[68:71]
v_exp_f32 v91,v91
v_mfma_f32_16x16x32_bf16 v[76:79],a[220:223],v[252:255],v[76:79]
ds_read_b128 v[248:251],v17 offset:46080
s_waitcnt lgkmcnt(5)
v_mfma_f32_16x16x32_bf16 v[68:71],a[32:35],v[224:227],v[68:71]
v_min3_u32 v27,v27,v224,v228
v_add_f32 v88,1.0,v88
v_mfma_f32_16x16x32_bf16 v[76:79],a[160:163],v[224:227],v[76:79]
ds_read_b128 v[252:255],v43 offset:46080
v_add_f32 v89,1.0,v89
v_mfma_f32_16x16x32_bf16 v[68:71],a[36:39],v[228:231],v[68:71]
v_add_f32 v90,1.0,v90
v_add_f32 v91,1.0,v91
v_mfma_f32_16x16x32_bf16 v[76:79],a[164:167],v[228:231],v[76:79]
ds_read_b128 v[224:227],v17 offset:53248
s_waitcnt lgkmcnt(5)
v_mfma_f32_16x16x32_bf16 v[68:71],a[40:43],v[232:235],v[68:71]
v_min3_u32 v27,v27,v232,v236
v_mfma_f32_16x16x32_bf16 v[76:79],a[168:171],v[232:235],v[76:79]
ds_read_b128 v[228:231],v43 offset:53248
v_mfma_f32_16x16x32_bf16 v[68:71],a[44:47],v[236:239],v[68:71]
v_rcp_f32 v88,v88
v_mfma_f32_16x16x32_bf16 v[76:79],a[172:175],v[236:239],v[76:79]
ds_read_b128 v[232:235],v17 offset:61440
s_waitcnt lgkmcnt(5)
v_mfma_f32_16x16x32_bf16 v[68:71],a[96:99],v[240:243],v[68:71]
v_min3_u32 v27,v27,v240,v244
v_mfma_f32_16x16x32_bf16 v[76:79],a[224:227],v[240:243],v[76:79]
ds_read_b128 v[236:239],v43 offset:61440
v_mfma_f32_16x16x32_bf16 v[68:71],a[100:103],v[244:247],v[68:71]
v_rcp_f32 v89,v89
v_mfma_f32_16x16x32_bf16 v[76:79],a[228:231],v[244:247],v[76:79]
ds_read_b128 v[240:243],v17 offset:54272
s_waitcnt lgkmcnt(5)
v_mfma_f32_16x16x32_bf16 v[68:71],a[104:107],v[248:251],v[68:71]
v_min3_u32 v27,v27,v248,v252
v_mfma_f32_16x16x32_bf16 v[76:79],a[232:235],v[248:251],v[76:79]
ds_read_b128 v[244:247],v43 offset:54272
v_mfma_f32_16x16x32_bf16 v[68:71],a[108:111],v[252:255],v[68:71]
v_rcp_f32 v90,v90
v_mfma_f32_16x16x32_bf16 v[76:79],a[236:239],v[252:255],v[76:79]
ds_read_b128 v[248:251],v17 offset:62464
s_waitcnt lgkmcnt(5)
v_mfma_f32_16x16x32_bf16 v[68:71],a[48:51],v[224:227],v[68:71]
v_min3_u32 v27,v27,v224,v228
v_mfma_f32_16x16x32_bf16 v[76:79],a[176:179],v[224:227],v[76:79]
ds_read_b128 v[252:255],v43 offset:62464
v_mfma_f32_16x16x32_bf16 v[68:71],a[52:55],v[228:231],v[68:71]
v_rcp_f32 v91,v91
v_mfma_f32_16x16x32_bf16 v[76:79],a[180:183],v[228:231],v[76:79]
v_mul_f32 v88,v88,v64
s_waitcnt lgkmcnt(4)
v_mfma_f32_16x16x32_bf16 v[68:71],a[56:59],v[232:235],v[68:71]
v_min3_u32 v27,v27,v232,v236
v_mul_f32 v89,v89,v65
v_mfma_f32_16x16x32_bf16 v[76:79],a[184:187],v[232:235],v[76:79]
v_mul_f32 v90,v90,v66
v_mul_f32 v91,v91,v67
v_mfma_f32_16x16x32_bf16 v[68:71],a[60:63],v[236:239],v[68:71]
v_rcp_f32 v95,v95
v_mfma_f32_16x16x32_bf16 v[76:79],a[188:191],v[236:239],v[76:79]
v_mul_f32 v92,v92,v72
s_waitcnt lgkmcnt(2)
v_mfma_f32_16x16x32_bf16 v[68:71],a[112:115],v[240:243],v[68:71]
v_min3_u32 v27,v27,v240,v244
v_mul_f32 v93,v93,v73
v_mfma_f32_16x16x32_bf16 v[76:79],a[240:243],v[240:243],v[76:79]
v_mul_f32 v94,v94,v74
v_mul_f32 v95,v95,v75
v_mfma_f32_16x16x32_bf16 v[68:71],a[116:119],v[244:247],v[68:71]
v_cvt_pk_bf16_f32 v96,v88,v89
v_cvt_pk_bf16_f32 v97,v90,v91
v_mfma_f32_16x16x32_bf16 v[76:79],a[244:247],v[244:247],v[76:79]
v_cvt_pk_bf16_f32 v98,v92,v93
s_waitcnt lgkmcnt(0)
v_mfma_f32_16x16x32_bf16 v[68:71],a[120:123],v[248:251],v[68:71]
v_min3_u32 v27,v27,v248,v252
v_cvt_pk_bf16_f32 v99,v94,v95
v_mfma_f32_16x16x32_bf16 v[76:79],a[248:251],v[248:251],v[76:79]
v_max_u32 v96,1,v96
v_mfma_f32_16x16x32_bf16 v[68:71],a[124:127],v[252:255],v[68:71]
buffer_store_dwordx4 v[96:99],v18,s[20:23],s78 offen sc1
v_mfma_f32_16x16x32_bf16 v[76:79],a[252:255],v[252:255],v[76:79]
v_cmp_eq_u32 vcc,0,v27
s_cbranch_vccnz retry_222
epi_225:
buffer_load_dword v29,v21,s[20:23],s87 offen sc1
s_cmp_gt_u32 s71,40
s_cselect_b32 s65,s73,0x7fff0000
s_cselect_b32 s97,0x7fff0000,s73
v_mov_b32 v22,s71
buffer_store_dword v22,v23,s[24:27],s65 offen
buffer_store_dword v22,v23,s[28:31],s65 offen sc1
v_pk_mul_f32 v[88:89],v[68:69],v[68:69]
v_pk_mul_f32 v[90:91],v[70:71],v[70:71]
v_pk_mul_f32 v[92:93],v[76:77],v[76:77]
v_pk_mul_f32 v[94:95],v[78:79],v[78:79]
v_pk_fma_f32 v[88:89],v[88:89],s[80:81],v[28:29] op_sel:[0,1,0] op_sel_hi:[1,1,0]
v_pk_fma_f32 v[90:91],v[90:91],s[80:81],v[28:29] op_sel:[0,1,0] op_sel_hi:[1,1,0]
v_pk_fma_f32 v[92:93],v[92:93],s[80:81],v[28:29] op_sel:[0,1,0] op_sel_hi:[1,1,0]
v_pk_fma_f32 v[94:95],v[94:95],s[80:81],v[28:29] op_sel:[0,1,0] op_sel_hi:[1,1,0]
v_pk_mul_f32 v[88:89],v[88:89],v[68:69]
v_pk_mul_f32 v[90:91],v[90:91],v[70:71]
v_pk_mul_f32 v[92:93],v[92:93],v[76:77]
v_pk_mul_f32 v[94:95],v[94:95],v[78:79]
v_exp_f32 v88,v88
v_exp_f32 v89,v89
v_exp_f32 v90,v90
v_exp_f32 v91,v91
v_exp_f32 v92,v92
v_exp_f32 v93,v93
v_exp_f32 v94,v94
v_exp_f32 v95,v95
v_pk_add_f32 v[88:89],v[88:89],1.0 op_sel_hi:[1,0]
v_pk_add_f32 v[90:91],v[90:91],1.0 op_sel_hi:[1,0]
v_pk_add_f32 v[92:93],v[92:93],1.0 op_sel_hi:[1,0]
v_pk_add_f32 v[94:95],v[94:95],1.0 op_sel_hi:[1,0]
v_rcp_f32 v88,v88
v_rcp_f32 v89,v89
v_rcp_f32 v90,v90
v_rcp_f32 v91,v91
v_rcp_f32 v92,v92
v_rcp_f32 v93,v93
v_rcp_f32 v94,v94
v_rcp_f32 v95,v95
v_pk_mul_f32 v[88:89],v[88:89],v[68:69]
v_pk_mul_f32 v[90:91],v[90:91],v[70:71]
v_pk_mul_f32 v[92:93],v[92:93],v[76:77]
v_pk_mul_f32 v[94:95],v[94:95],v[78:79]
v_cvt_pk_bf16_f32 v96,v88,v89
v_cvt_pk_bf16_f32 v97,v90,v91
v_cvt_pk_bf16_f32 v98,v92,v93
v_cvt_pk_bf16_f32 v99,v94,v95
v_max_u32 v96,1,v96
buffer_store_dwordx4 v[96:99],v19,s[20:23],s78 offen sc1
v_xor_b32 v18,0x2000,v18
v_xor_b32 v19,0x2000,v19
s_add_u32 s78,s78,2097152
next_232:
v_xor_b32 v43,0x10000,v43
v_xor_b32 v17,0x10000,v17
s_xor_b32 s72,s72,0x10000
s_add_u32 s70,s70,2097152
s_xor_b32 s70,s70,0x2000
s_add_u32 s71,s71,1
s_cmp_le_u32 s71,64
s_cbranch_scc1 seg_223
s_add_u32 s65,s73,2560
v_add_u32 v22,s71,-1
buffer_store_dword v22,v23,s[20:23],s65 offen sc1
s_endpgm
retry_222:
s_sub_u32 s90,s90,64
s_cmp_lt_i32 s90,0
s_cbranch_scc1 giveup_197
s_mov_b32 s83,1
s_waitcnt vmcnt(0) lgkmcnt(0)
s_barrier
s_branch seg_223
r_w2_217:
s_load_dwordx2 s[4:5],s[0:1],72
s_and_b32 s41,s59,7
s_lshl_b32 s66,s41,8
s_lshl_b32 s67,s50,1
s_waitcnt lgkmcnt(0)
s_mov_b32 s32,s4
s_and_b32 s33,s5,0xffff
s_mov_b32 s34,0x200000
s_mov_b32 s35,0x20000
v_lshrrev_b32 v5,2,v3
v_lshl_add_u32 v5,v4,2,v5
v_and_b32 v6,3,v3
v_lshlrev_b32 v6,3,v6
v_lshl_add_u32 v6,v5,8,v6
v_and_b32 v5,7,v5
v_xor_b32 v5,s67,v5
v_lshl_add_u32 v12,v5,5,v6
v_xor_b32 v13,32,v12
v_and_b32 v5,15,v1
v_and_b32 v6,3,v4
v_lshlrev_b32 v6,1,v6
v_xor_b32 v5,v5,v6
v_mul_u32_u24 v6,2048,v4
v_xor_b32 v7,0,v5
v_lshl_add_u32 v8,v7,4,v6
v_xor_b32 v7,8,v5
v_lshl_add_u32 v9,v7,4,v6
s_mul_i32 s74,s50,131072
s_add_u32 s74,s74,s66
s_lshl_b32 s75,s50,14
s_mul_i32 s76,s50,65536
s_add_u32 s76,s76,s66
s_lshl_b32 s77,s50,13
s_add_u32 s64,s74,0
s_add_u32 m0,s75,0
s_nop 0
buffer_load_dwordx4 v8,s[32:35],s64 offen nt lds
s_add_u32 s64,s74,8192
s_add_u32 m0,s75,1024
s_nop 0
buffer_load_dwordx4 v9,s[32:35],s64 offen nt lds
s_add_u32 s64,s74,16384
s_add_u32 m0,s75,2048
s_nop 0
buffer_load_dwordx4 v8,s[32:35],s64 offen nt lds
s_add_u32 s64,s74,24576
s_add_u32 m0,s75,3072
s_nop 0
buffer_load_dwordx4 v9,s[32:35],s64 offen nt lds
s_add_u32 s64,s74,32768
s_add_u32 m0,s75,4096
s_nop 0
buffer_load_dwordx4 v8,s[32:35],s64 offen nt lds
s_add_u32 s64,s74,40960
s_add_u32 m0,s75,5120
s_nop 0
buffer_load_dwordx4 v9,s[32:35],s64 offen nt lds
s_add_u32 s64,s74,49152
s_add_u32 m0,s75,6144
s_nop 0
buffer_load_dwordx4 v8,s[32:35],s64 offen nt lds
s_add_u32 s64,s74,57344
s_add_u32 m0,s75,7168
s_nop 0
buffer_load_dwordx4 v9,s[32:35],s64 offen nt lds
s_add_u32 s64,s74,65536
s_add_u32 m0,s75,8192
s_nop 0
buffer_load_dwordx4 v8,s[32:35],s64 offen nt lds
s_add_u32 s64,s74,73728
s_add_u32 m0,s75,9216
s_nop 0
buffer_load_dwordx4 v9,s[32:35],s64 offen nt lds
s_add_u32 s64,s74,81920
s_add_u32 m0,s75,10240
s_nop 0
buffer_load_dwordx4 v8,s[32:35],s64 offen nt lds
s_add_u32 s64,s74,90112
s_add_u32 m0,s75,11264
s_nop 0
buffer_load_dwordx4 v9,s[32:35],s64 offen nt lds
s_add_u32 s64,s74,98304
s_add_u32 m0,s75,12288
s_nop 0
buffer_load_dwordx4 v8,s[32:35],s64 offen nt lds
s_add_u32 s64,s74,106496
s_add_u32 m0,s75,13312
s_nop 0
buffer_load_dwordx4 v9,s[32:35],s64 offen nt lds
s_add_u32 s64,s74,114688
s_add_u32 m0,s75,14336
s_nop 0
buffer_load_dwordx4 v8,s[32:35],s64 offen nt lds
s_add_u32 s64,s74,122880
s_add_u32 m0,s75,15360
s_nop 0
buffer_load_dwordx4 v9,s[32:35],s64 offen nt lds
s_add_u32 s64,s74,524288
s_add_u32 m0,s75,65536
s_nop 0
buffer_load_dwordx4 v8,s[32:35],s64 offen nt lds
s_add_u32 s64,s74,532480
s_add_u32 m0,s75,66560
s_nop 0
buffer_load_dwordx4 v9,s[32:35],s64 offen nt lds
s_add_u32 s64,s74,540672
s_add_u32 m0,s75,67584
s_nop 0
buffer_load_dwordx4 v8,s[32:35],s64 offen nt lds
s_add_u32 s64,s74,548864
s_add_u32 m0,s75,68608
s_nop 0
buffer_load_dwordx4 v9,s[32:35],s64 offen nt lds
s_add_u32 s64,s74,557056
s_add_u32 m0,s75,69632
s_nop 0
buffer_load_dwordx4 v8,s[32:35],s64 offen nt lds
s_add_u32 s64,s74,565248
s_add_u32 m0,s75,70656
s_nop 0
buffer_load_dwordx4 v9,s[32:35],s64 offen nt lds
s_add_u32 s64,s74,573440
s_add_u32 m0,s75,71680
s_nop 0
buffer_load_dwordx4 v8,s[32:35],s64 offen nt lds
s_add_u32 s64,s74,581632
s_add_u32 m0,s75,72704
s_nop 0
buffer_load_dwordx4 v9,s[32:35],s64 offen nt lds
s_add_u32 s64,s74,589824
s_add_u32 m0,s75,73728
s_nop 0
buffer_load_dwordx4 v8,s[32:35],s64 offen nt lds
s_add_u32 s64,s74,598016
s_add_u32 m0,s75,74752
s_nop 0
buffer_load_dwordx4 v9,s[32:35],s64 offen nt lds
s_add_u32 s64,s74,606208
s_add_u32 m0,s75,75776
s_nop 0
buffer_load_dwordx4 v8,s[32:35],s64 offen nt lds
s_add_u32 s64,s74,614400
s_add_u32 m0,s75,76800
s_nop 0
buffer_load_dwordx4 v9,s[32:35],s64 offen nt lds
s_add_u32 s64,s74,622592
s_add_u32 m0,s75,77824
s_nop 0
buffer_load_dwordx4 v8,s[32:35],s64 offen nt lds
s_add_u32 s64,s74,630784
s_add_u32 m0,s75,78848
s_nop 0
buffer_load_dwordx4 v9,s[32:35],s64 offen nt lds
s_add_u32 s64,s74,638976
s_add_u32 m0,s75,79872
s_nop 0
buffer_load_dwordx4 v8,s[32:35],s64 offen nt lds
s_add_u32 s64,s74,647168
s_add_u32 m0,s75,80896
s_nop 0
buffer_load_dwordx4 v9,s[32:35],s64 offen nt lds
s_waitcnt vmcnt(16)
s_barrier
ds_read_b64_tr_b16 a[0:1],v12 offset:0
ds_read_b64_tr_b16 a[128:129],v13 offset:0
ds_read_b64_tr_b16 a[2:3],v12 offset:4096
ds_read_b64_tr_b16 a[130:131],v13 offset:4096
ds_read_b64_tr_b16 a[4:5],v12 offset:8192
ds_read_b64_tr_b16 a[132:133],v13 offset:8192
ds_read_b64_tr_b16 a[6:7],v12 offset:12288
ds_read_b64_tr_b16 a[134:135],v13 offset:12288
s_waitcnt lgkmcnt(4)
ds_read_b64_tr_b16 a[8:9],v12 offset:16384
ds_read_b64_tr_b16 a[136:137],v13 offset:16384
ds_read_b64_tr_b16 a[10:11],v12 offset:20480
ds_read_b64_tr_b16 a[138:139],v13 offset:20480
ds_read_b64_tr_b16 a[12:13],v12 offset:24576
ds_read_b64_tr_b16 a[140:141],v13 offset:24576
ds_read_b64_tr_b16 a[14:15],v12 offset:28672
ds_read_b64_tr_b16 a[142:143],v13 offset:28672
s_waitcnt lgkmcnt(4)
ds_read_b64_tr_b16 a[16:17],v12 offset:32768
ds_read_b64_tr_b16 a[144:145],v13 offset:32768
ds_read_b64_tr_b16 a[18:19],v12 offset:36864
ds_read_b64_tr_b16 a[146:147],v13 offset:36864
ds_read_b64_tr_b16 a[20:21],v12 offset:40960
ds_read_b64_tr_b16 a[148:149],v13 offset:40960
ds_read_b64_tr_b16 a[22:23],v12 offset:45056
ds_read_b64_tr_b16 a[150:151],v13 offset:45056
s_waitcnt lgkmcnt(4)
ds_read_b64_tr_b16 a[24:25],v12 offset:49152
ds_read_b64_tr_b16 a[152:153],v13 offset:49152
ds_read_b64_tr_b16 a[26:27],v12 offset:53248
ds_read_b64_tr_b16 a[154:155],v13 offset:53248
ds_read_b64_tr_b16 a[28:29],v12 offset:57344
ds_read_b64_tr_b16 a[156:157],v13 offset:57344
ds_read_b64_tr_b16 a[30:31],v12 offset:61440
ds_read_b64_tr_b16 a[158:159],v13 offset:61440
s_waitcnt lgkmcnt(4)
v_xor_b32 v12,0x10000,v12
v_xor_b32 v13,0x10000,v13
s_waitcnt lgkmcnt(0)
s_barrier
s_add_u32 s64,s74,1048576
s_add_u32 m0,s75,0
s_nop 0
buffer_load_dwordx4 v8,s[32:35],s64 offen nt lds
s_add_u32 s64,s74,1056768
s_add_u32 m0,s75,1024
s_nop 0
buffer_load_dwordx4 v9,s[32:35],s64 offen nt lds
s_add_u32 s64,s74,1064960
s_add_u32 m0,s75,2048
s_nop 0
buffer_load_dwordx4 v8,s[32:35],s64 offen nt lds
s_add_u32 s64,s74,1073152
s_add_u32 m0,s75,3072
s_nop 0
buffer_load_dwordx4 v9,s[32:35],s64 offen nt lds
s_add_u32 s64,s74,1081344
s_add_u32 m0,s75,4096
s_nop 0
buffer_load_dwordx4 v8,s[32:35],s64 offen nt lds
s_add_u32 s64,s74,1089536
s_add_u32 m0,s75,5120
s_nop 0
buffer_load_dwordx4 v9,s[32:35],s64 offen nt lds
s_add_u32 s64,s74,1097728
s_add_u32 m0,s75,6144
s_nop 0
buffer_load_dwordx4 v8,s[32:35],s64 offen nt lds
s_add_u32 s64,s74,1105920
s_add_u32 m0,s75,7168
s_nop 0
buffer_load_dwordx4 v9,s[32:35],s64 offen nt lds
s_add_u32 s64,s74,1114112
s_add_u32 m0,s75,8192
s_nop 0
buffer_load_dwordx4 v8,s[32:35],s64 offen nt lds
s_add_u32 s64,s74,1122304
s_add_u32 m0,s75,9216
s_nop 0
buffer_load_dwordx4 v9,s[32:35],s64 offen nt lds
s_add_u32 s64,s74,1130496
s_add_u32 m0,s75,10240
s_nop 0
buffer_load_dwordx4 v8,s[32:35],s64 offen nt lds
s_add_u32 s64,s74,1138688
s_add_u32 m0,s75,11264
s_nop 0
buffer_load_dwordx4 v9,s[32:35],s64 offen nt lds
s_add_u32 s64,s74,1146880
s_add_u32 m0,s75,12288
s_nop 0
buffer_load_dwordx4 v8,s[32:35],s64 offen nt lds
s_add_u32 s64,s74,1155072
s_add_u32 m0,s75,13312
s_nop 0
buffer_load_dwordx4 v9,s[32:35],s64 offen nt lds
s_add_u32 s64,s74,1163264
s_add_u32 m0,s75,14336
s_nop 0
buffer_load_dwordx4 v8,s[32:35],s64 offen nt lds
s_add_u32 s64,s74,1171456
s_add_u32 m0,s75,15360
s_nop 0
buffer_load_dwordx4 v9,s[32:35],s64 offen nt lds
s_waitcnt vmcnt(16)
s_barrier
ds_read_b64_tr_b16 a[32:33],v12 offset:0
ds_read_b64_tr_b16 a[160:161],v13 offset:0
ds_read_b64_tr_b16 a[34:35],v12 offset:4096
ds_read_b64_tr_b16 a[162:163],v13 offset:4096
ds_read_b64_tr_b16 a[36:37],v12 offset:8192
ds_read_b64_tr_b16 a[164:165],v13 offset:8192
ds_read_b64_tr_b16 a[38:39],v12 offset:12288
ds_read_b64_tr_b16 a[166:167],v13 offset:12288
s_waitcnt lgkmcnt(4)
ds_read_b64_tr_b16 a[40:41],v12 offset:16384
ds_read_b64_tr_b16 a[168:169],v13 offset:16384
ds_read_b64_tr_b16 a[42:43],v12 offset:20480
ds_read_b64_tr_b16 a[170:171],v13 offset:20480
ds_read_b64_tr_b16 a[44:45],v12 offset:24576
ds_read_b64_tr_b16 a[172:173],v13 offset:24576
ds_read_b64_tr_b16 a[46:47],v12 offset:28672
ds_read_b64_tr_b16 a[174:175],v13 offset:28672
s_waitcnt lgkmcnt(4)
ds_read_b64_tr_b16 a[48:49],v12 offset:32768
ds_read_b64_tr_b16 a[176:177],v13 offset:32768
ds_read_b64_tr_b16 a[50:51],v12 offset:36864
ds_read_b64_tr_b16 a[178:179],v13 offset:36864
ds_read_b64_tr_b16 a[52:53],v12 offset:40960
ds_read_b64_tr_b16 a[180:181],v13 offset:40960
ds_read_b64_tr_b16 a[54:55],v12 offset:45056
ds_read_b64_tr_b16 a[182:183],v13 offset:45056
s_waitcnt lgkmcnt(4)
ds_read_b64_tr_b16 a[56:57],v12 offset:49152
ds_read_b64_tr_b16 a[184:185],v13 offset:49152
ds_read_b64_tr_b16 a[58:59],v12 offset:53248
ds_read_b64_tr_b16 a[186:187],v13 offset:53248
ds_read_b64_tr_b16 a[60:61],v12 offset:57344
ds_read_b64_tr_b16 a[188:189],v13 offset:57344
ds_read_b64_tr_b16 a[62:63],v12 offset:61440
ds_read_b64_tr_b16 a[190:191],v13 offset:61440
s_waitcnt lgkmcnt(4)
v_xor_b32 v12,0x10000,v12
v_xor_b32 v13,0x10000,v13
s_waitcnt lgkmcnt(0)
s_barrier
s_add_u32 s64,s74,1572864
s_add_u32 m0,s75,65536
s_nop 0
buffer_load_dwordx4 v8,s[32:35],s64 offen nt lds
s_add_u32 s64,s74,1581056
s_add_u32 m0,s75,66560
s_nop 0
buffer_load_dwordx4 v9,s[32:35],s64 offen nt lds
s_add_u32 s64,s74,1589248
s_add_u32 m0,s75,67584
s_nop 0
buffer_load_dwordx4 v8,s[32:35],s64 offen nt lds
s_add_u32 s64,s74,1597440
s_add_u32 m0,s75,68608
s_nop 0
buffer_load_dwordx4 v9,s[32:35],s64 offen nt lds
s_add_u32 s64,s74,1605632
s_add_u32 m0,s75,69632
s_nop 0
buffer_load_dwordx4 v8,s[32:35],s64 offen nt lds
s_add_u32 s64,s74,1613824
s_add_u32 m0,s75,70656
s_nop 0
buffer_load_dwordx4 v9,s[32:35],s64 offen nt lds
s_add_u32 s64,s74,1622016
s_add_u32 m0,s75,71680
s_nop 0
buffer_load_dwordx4 v8,s[32:35],s64 offen nt lds
s_add_u32 s64,s74,1630208
s_add_u32 m0,s75,72704
s_nop 0
buffer_load_dwordx4 v9,s[32:35],s64 offen nt lds
s_add_u32 s64,s74,1638400
s_add_u32 m0,s75,73728
s_nop 0
buffer_load_dwordx4 v8,s[32:35],s64 offen nt lds
s_add_u32 s64,s74,1646592
s_add_u32 m0,s75,74752
s_nop 0
buffer_load_dwordx4 v9,s[32:35],s64 offen nt lds
s_add_u32 s64,s74,1654784
s_add_u32 m0,s75,75776
s_nop 0
buffer_load_dwordx4 v8,s[32:35],s64 offen nt lds
s_add_u32 s64,s74,1662976
s_add_u32 m0,s75,76800
s_nop 0
buffer_load_dwordx4 v9,s[32:35],s64 offen nt lds
s_add_u32 s64,s74,1671168
s_add_u32 m0,s75,77824
s_nop 0
buffer_load_dwordx4 v8,s[32:35],s64 offen nt lds
s_add_u32 s64,s74,1679360
s_add_u32 m0,s75,78848
s_nop 0
buffer_load_dwordx4 v9,s[32:35],s64 offen nt lds
s_add_u32 s64,s74,1687552
s_add_u32 m0,s75,79872
s_nop 0
buffer_load_dwordx4 v8,s[32:35],s64 offen nt lds
s_add_u32 s64,s74,1695744
s_add_u32 m0,s75,80896
s_nop 0
buffer_load_dwordx4 v9,s[32:35],s64 offen nt lds
s_waitcnt vmcnt(16)
s_barrier
ds_read_b64_tr_b16 a[64:65],v12 offset:0
ds_read_b64_tr_b16 a[192:193],v13 offset:0
ds_read_b64_tr_b16 a[66:67],v12 offset:4096
ds_read_b64_tr_b16 a[194:195],v13 offset:4096
ds_read_b64_tr_b16 a[68:69],v12 offset:8192
ds_read_b64_tr_b16 a[196:197],v13 offset:8192
ds_read_b64_tr_b16 a[70:71],v12 offset:12288
ds_read_b64_tr_b16 a[198:199],v13 offset:12288
s_waitcnt lgkmcnt(4)
ds_read_b64_tr_b16 a[72:73],v12 offset:16384
ds_read_b64_tr_b16 a[200:201],v13 offset:16384
ds_read_b64_tr_b16 a[74:75],v12 offset:20480
ds_read_b64_tr_b16 a[202:203],v13 offset:20480
ds_read_b64_tr_b16 a[76:77],v12 offset:24576
ds_read_b64_tr_b16 a[204:205],v13 offset:24576
ds_read_b64_tr_b16 a[78:79],v12 offset:28672
ds_read_b64_tr_b16 a[206:207],v13 offset:28672
s_waitcnt lgkmcnt(4)
ds_read_b64_tr_b16 a[80:81],v12 offset:32768
ds_read_b64_tr_b16 a[208:209],v13 offset:32768
ds_read_b64_tr_b16 a[82:83],v12 offset:36864
ds_read_b64_tr_b16 a[210:211],v13 offset:36864
ds_read_b64_tr_b16 a[84:85],v12 offset:40960
ds_read_b64_tr_b16 a[212:213],v13 offset:40960
ds_read_b64_tr_b16 a[86:87],v12 offset:45056
ds_read_b64_tr_b16 a[214:215],v13 offset:45056
s_waitcnt lgkmcnt(4)
ds_read_b64_tr_b16 a[88:89],v12 offset:49152
ds_read_b64_tr_b16 a[216:217],v13 offset:49152
ds_read_b64_tr_b16 a[90:91],v12 offset:53248
ds_read_b64_tr_b16 a[218:219],v13 offset:53248
ds_read_b64_tr_b16 a[92:93],v12 offset:57344
ds_read_b64_tr_b16 a[220:221],v13 offset:57344
ds_read_b64_tr_b16 a[94:95],v12 offset:61440
ds_read_b64_tr_b16 a[222:223],v13 offset:61440
s_waitcnt lgkmcnt(4)
v_xor_b32 v12,0x10000,v12
v_xor_b32 v13,0x10000,v13
s_waitcnt lgkmcnt(0)
s_barrier
s_waitcnt vmcnt(0)
s_barrier
ds_read_b64_tr_b16 a[96:97],v12 offset:0
ds_read_b64_tr_b16 a[224:225],v13 offset:0
ds_read_b64_tr_b16 a[98:99],v12 offset:4096
ds_read_b64_tr_b16 a[226:227],v13 offset:4096
ds_read_b64_tr_b16 a[100:101],v12 offset:8192
ds_read_b64_tr_b16 a[228:229],v13 offset:8192
ds_read_b64_tr_b16 a[102:103],v12 offset:12288
ds_read_b64_tr_b16 a[230:231],v13 offset:12288
s_waitcnt lgkmcnt(4)
ds_read_b64_tr_b16 a[104:105],v12 offset:16384
ds_read_b64_tr_b16 a[232:233],v13 offset:16384
ds_read_b64_tr_b16 a[106:107],v12 offset:20480
ds_read_b64_tr_b16 a[234:235],v13 offset:20480
ds_read_b64_tr_b16 a[108:109],v12 offset:24576
ds_read_b64_tr_b16 a[236:237],v13 offset:24576
ds_read_b64_tr_b16 a[110:111],v12 offset:28672
ds_read_b64_tr_b16 a[238:239],v13 offset:28672
s_waitcnt lgkmcnt(4)
ds_read_b64_tr_b16 a[112:113],v12 offset:32768
ds_read_b64_tr_b16 a[240:241],v13 offset:32768
ds_read_b64_tr_b16 a[114:115],v12 offset:36864
ds_read_b64_tr_b16 a[242:243],v13 offset:36864
ds_read_b64_tr_b16 a[116:117],v12 offset:40960
ds_read_b64_tr_b16 a[244:245],v13 offset:40960
ds_read_b64_tr_b16 a[118:119],v12 offset:45056
ds_read_b64_tr_b16 a[246:247],v13 offset:45056
s_waitcnt lgkmcnt(4)
ds_read_b64_tr_b16 a[120:121],v12 offset:49152
ds_read_b64_tr_b16 a[248:249],v13 offset:49152
ds_read_b64_tr_b16 a[122:123],v12 offset:53248
ds_read_b64_tr_b16 a[250:251],v13 offset:53248
ds_read_b64_tr_b16 a[124:125],v12 offset:57344
ds_read_b64_tr_b16 a[252:253],v13 offset:57344
ds_read_b64_tr_b16 a[126:127],v12 offset:61440
ds_read_b64_tr_b16 a[254:255],v13 offset:61440
s_waitcnt lgkmcnt(4)
v_xor_b32 v12,0x10000,v12
v_xor_b32 v13,0x10000,v13
s_waitcnt lgkmcnt(0)
s_barrier
v_and_b32 v21,1,v1
v_mul_u32_u24 v21,960,v21
s_mov_b32 s65,21052032
s_mov_b32 s66,1792
pl_237:
buffer_load_dword v22,v21,s[20:23],s65 offen sc1
s_waitcnt vmcnt(0)
v_cmp_gt_u32 vcc,s66,v22
s_cbranch_vccz pok_238
s_sleep 1
s_sub_u32 s90,s90,1
s_cmp_gt_i32 s90,0
s_cbranch_scc1 pl_237
pok_238:
s_mov_b32 s81,0xbdd2d3e8
v_mov_b32 v28,0xc0135761
v_mov_b32 v17,v16
v_and_b32 v21,31,v1
v_lshlrev_b32 v21,2,v21
s_mul_i32 s74,s79,40
s_add_u32 s74,s74,s63
s_add_u32 s74,s74,3072
s_lshl_b32 s42,s41,2
s_add_u32 s42,s42,s50
s_lshl_b32 s73,s41,7
s_lshl_b32 s64,s50,2
s_add_u32 s73,s73,s64
s_add_u32 s73,s73,s63
s_add_u32 s73,s73,6144
s_add_u32 s73,s73,s60
s_lshl_b32 s43,s50,11
s_lshl_b32 s78,s79,21
s_add_u32 s78,s78,27262976
s_mov_b32 s64,0
s_lshr_b32 s65,s50,1
s_and_b32 s66,s50,1
s_lshl_b32 s66,s66,12
s_add_u32 s66,s66,s64
s_lshl_b32 s72,s65,13
s_add_u32 s72,s72,s66
s_add_u32 s72,s72,0x10000
s_lshl_b32 s65,s65,14
s_add_u32 s75,s65,s66
s_add_u32 s75,s75,1966080
s_add_u32 s64,s41,72
s_lshl_b32 s64,s64,14
s_add_u32 s64,s64,s43
v_add_u32 v18,s64,v16
s_lshl_b32 s64,s42,8
s_add_u32 s64,s64,1310720
v_lshl_add_u32 v24,v3,4,s64
v_mov_b32 v5,0x40000000
v_cmp_gt_u32 vcc,16,v1
s_nop 1
v_cndmask_b32 v24,v5,v24,vcc
s_lshl_b32 s64,s42,6
v_and_b32 v5,3,v1
v_xor_b32 v5,v5,v4
v_lshl_add_u32 v5,v5,4,s64
v_lshrrev_b32 v11,2,v1
s_add_u32 s43,s43,133120
v_lshrrev_b32 v6,2,v3
v_lshrrev_b32 v7,1,v4
v_xor_b32 v6,v6,v7
v_lshlrev_b32 v6,4,v6
v_lshl_add_u32 v6,v3,6,v6
v_and_b32 v7,1,v4
v_lshl_add_u32 v6,v7,3,v6
v_add_u32 v40,s43,v6
v_xor_b32 v41,32,v40
v_add_u32 v6,30,v11
v_lshl_add_u32 v9,v6,7,v5
v_and_b32 v9,2047,v9
v_and_b32 v7,3,v6
v_lshl_add_u32 v7,v7,11,v9
v_bfe_u32 v8,v6,2,3
v_lshl_add_u32 v7,v8,14,v7
v_mov_b32 v8,0x2000
v_mov_b32 v9,2097152
v_cmp_gt_u32 vcc,32,v6
s_nop 1
v_cndmask_b32 v8,v9,v8,vcc
v_add_u32 v7,v7,v8
v_add_u32 v7,0,v7
v_xor_b32 v19,s62,v7
v_xor_b32 v19,0x2000,v19
v_add_u32 v6,46,v11
v_lshl_add_u32 v9,v6,7,v5
v_and_b32 v9,2047,v9
v_and_b32 v7,3,v6
v_lshl_add_u32 v7,v7,11,v9
v_bfe_u32 v8,v6,2,3
v_lshl_add_u32 v7,v8,14,v7
v_mov_b32 v8,0x2000
v_mov_b32 v9,2097152
v_cmp_gt_u32 vcc,32,v6
s_nop 1
v_cndmask_b32 v8,v9,v8,vcc
v_add_u32 v7,v7,v8
v_add_u32 v7,0,v7
v_xor_b32 v20,s62,v7
v_xor_b32 v20,0x2000,v20
s_add_u32 s64,s79,0
s_lshl_b32 s70,s64,21
s_lshl_b32 s64,s64,13
s_and_b32 s64,s64,0x2000
s_xor_b32 s64,s64,s62
s_add_u32 s70,s70,s64
s_add_u32 s70,s70,29360128
s_mov_b32 s83,1
s_mov_b32 s87,s74
s_cmp_eq_u32 s50,0
s_cselect_b32 s74,s74,0x7fff0000
v_mov_b32 v47,132096
s_lshl_b32 s64,s50,3
s_add_u32 s64,s64,132096
v_mov_b32 v46,s64
v_mov_b32 v29,0
s_mov_b32 s97,0x7fff0000
s_mov_b32 s69,1
s_mov_b32 s68,0
s_mov_b32 s52,0x30003
s_mov_b32 s53,s52
seg_240:
s_cmp_eq_u32 s83,0
s_cbranch_scc1 ahead_241
s_add_u32 s94,s70,s75
s_cmp_eq_u32 s71,65
s_cselect_b32 s64,2097152,0
s_cselect_b32 s65,0x2000,0
s_sub_u32 s94,s94,s64
s_xor_b32 s94,s94,s65
s_xor_b32 s95,s94,1024
s_xor_b32 s91,s72,0x10000
s_cmp_eq_u32 s69,0
s_mov_b32 s69,1
s_cbranch_scc1 half2_245
s_min_u32 s66,s71,64
s_waitcnt vmcnt(3)
v_cmp_gt_u32 vcc,s66,v29
s_cbranch_vccz nb_244
s_waitcnt vmcnt(0)
v_add_u32 v22,s71,-1
buffer_store_dword v22,v23,s[20:23],s97 offen sc1
s_mov_b32 s97,0x7fff0000
s_cmp_lg_u32 s50,0
s_cbranch_scc1 nb_244
buffer_load_dword v32,v21,s[20:23],s74 offen sc1
s_sleep 2
pl_246:
buffer_load_dword v33,v21,s[20:23],s74 offen sc1
s_waitcnt vmcnt(1)
v_cmp_gt_u32 vcc,s66,v32
v_mov_b32 v29,v32
s_cbranch_vccz pok_247
buffer_load_dword v32,v21,s[20:23],s74 offen sc1
s_waitcnt vmcnt(1)
v_cmp_gt_u32 vcc,s66,v33
v_mov_b32 v29,v33
s_cbranch_vccz pok_247
s_sub_u32 s90,s90,1
s_cmp_gt_i32 s90,0
s_cbranch_scc1 pl_246
pok_247:
nb_244:
s_cmp_eq_u32 s71,64
s_barrier
s_cbranch_scc1 half_248
s_xor_b32 m0,s91,0
s_add_u32 s65,s94,0
buffer_load_dwordx4 v16,s[20:23],s65 offen offset:0 sc1 lds
buffer_load_dwordx4 v16,s[20:23],s65 offen offset:2048 sc1 lds
s_xor_b32 m0,s91,16384
s_add_u32 s65,s94,32768
buffer_load_dwordx4 v16,s[20:23],s65 offen offset:0 sc1 lds
buffer_load_dwordx4 v16,s[20:23],s65 offen offset:2048 sc1 lds
s_xor_b32 m0,s91,32768
s_add_u32 s65,s94,65536
buffer_load_dwordx4 v16,s[20:23],s65 offen offset:0 sc1 lds
buffer_load_dwordx4 v16,s[20:23],s65 offen offset:2048 sc1 lds
s_xor_b32 m0,s91,49152
s_add_u32 s65,s94,98304
buffer_load_dwordx4 v16,s[20:23],s65 offen offset:0 sc1 lds
buffer_load_dwordx4 v16,s[20:23],s65 offen offset:2048 sc1 lds
s_waitcnt vmcnt(8)
v_add_u32 v22,s71,-1
buffer_store_dword v22,v23,s[20:23],s97 offen sc1
s_mov_b32 s97,0x7fff0000
s_waitcnt vmcnt(7)
s_barrier
ds_read_b128 v[224:227],v17 offset:0
ds_read_b128 v[228:231],v17 offset:2048
ds_read_b128 v[232:235],v17 offset:4096
ds_read_b128 v[236:239],v17 offset:6144
ds_read_b128 v[240:243],v17 offset:8192
ds_read_b128 v[244:247],v17 offset:10240
ds_read_b128 v[248:251],v17 offset:12288
s_waitcnt lgkmcnt(5)
v_mfma_f32_16x16x32_bf16 v[64:67],a[0:3],v[224:227],0
s_xor_b32 m0,s91,1024
s_add_u32 s96,s71,1
s_add_u32 s92,s71,2
v_min_u32 v27,v224,v228
v_mfma_f32_16x16x32_bf16 v[72:75],a[128:131],v[224:227],0
ds_read_b128 v[252:255],v17 offset:14336
s_cmp_eq_u32 s96,64
s_cselect_b32 s96,99,s96
v_mfma_f32_16x16x32_bf16 v[64:67],a[4:7],v[228:231],v[64:67]
s_add_u32 s65,s95,0
s_cmp_eq_u32 s92,64
s_cselect_b32 s92,99,s92
v_mfma_f32_16x16x32_bf16 v[72:75],a[132:135],v[228:231],v[72:75]
s_waitcnt vmcnt(5)
s_barrier
ds_read_b128 v[224:227],v17 offset:16384
s_waitcnt lgkmcnt(5)
v_mfma_f32_16x16x32_bf16 v[64:67],a[8:11],v[232:235],v[64:67]
buffer_load_dwordx4 v16,s[20:23],s65 offen offset:0 sc1 lds
v_min3_u32 v27,v27,v232,v236
v_mfma_f32_16x16x32_bf16 v[72:75],a[136:139],v[232:235],v[72:75]
ds_read_b128 v[228:231],v17 offset:18432
s_cmp_eq_u32 s96,65
s_cselect_b32 s96,64,s96
v_mfma_f32_16x16x32_bf16 v[64:67],a[12:15],v[236:239],v[64:67]
buffer_load_dwordx4 v16,s[20:23],s65 offen offset:2048 sc1 lds
v_mfma_f32_16x16x32_bf16 v[72:75],a[140:143],v[236:239],v[72:75]
ds_read_b128 v[232:235],v17 offset:20480
s_waitcnt lgkmcnt(5)
v_mfma_f32_16x16x32_bf16 v[64:67],a[16:19],v[240:243],v[64:67]
s_xor_b32 m0,s91,17408
v_min3_u32 v27,v27,v240,v244
v_mfma_f32_16x16x32_bf16 v[72:75],a[144:147],v[240:243],v[72:75]
ds_read_b128 v[236:239],v17 offset:22528
v_mfma_f32_16x16x32_bf16 v[64:67],a[20:23],v[244:247],v[64:67]
s_add_u32 s65,s95,32768
v_mfma_f32_16x16x32_bf16 v[72:75],a[148:151],v[244:247],v[72:75]
ds_read_b128 v[240:243],v17 offset:24576
s_waitcnt lgkmcnt(5)
v_mfma_f32_16x16x32_bf16 v[64:67],a[24:27],v[248:251],v[64:67]
buffer_load_dwordx4 v16,s[20:23],s65 offen offset:0 sc1 lds
v_mfma_f32_16x16x32_bf16 v[72:75],a[152:155],v[248:251],v[72:75]
ds_read_b128 v[244:247],v17 offset:26624
v_min3_u32 v27,v27,v248,v252
v_mfma_f32_16x16x32_bf16 v[64:67],a[28:31],v[252:255],v[64:67]
buffer_load_dwordx4 v16,s[20:23],s65 offen offset:2048 sc1 lds
v_mfma_f32_16x16x32_bf16 v[72:75],a[156:159],v[252:255],v[72:75]
ds_read_b128 v[248:251],v17 offset:28672
s_waitcnt lgkmcnt(5)
v_mfma_f32_16x16x32_bf16 v[64:67],a[32:35],v[224:227],v[64:67]
s_xor_b32 m0,s91,33792
v_min3_u32 v27,v27,v224,v228
v_mfma_f32_16x16x32_bf16 v[72:75],a[160:163],v[224:227],v[72:75]
ds_read_b128 v[252:255],v17 offset:30720
v_mfma_f32_16x16x32_bf16 v[64:67],a[36:39],v[228:231],v[64:67]
s_add_u32 s65,s95,65536
v_mfma_f32_16x16x32_bf16 v[72:75],a[164:167],v[228:231],v[72:75]
s_waitcnt vmcnt(5)
s_barrier
ds_read_b128 v[224:227],v17 offset:32768
s_waitcnt lgkmcnt(5)
v_mfma_f32_16x16x32_bf16 v[64:67],a[40:43],v[232:235],v[64:67]
buffer_load_dwordx4 v16,s[20:23],s65 offen offset:0 sc1 lds
v_mfma_f32_16x16x32_bf16 v[72:75],a[168:171],v[232:235],v[72:75]
ds_read_b128 v[228:231],v17 offset:34816
v_min3_u32 v27,v27,v232,v236
v_mfma_f32_16x16x32_bf16 v[64:67],a[44:47],v[236:239],v[64:67]
buffer_load_dwordx4 v16,s[20:23],s65 offen offset:2048 sc1 lds
v_mfma_f32_16x16x32_bf16 v[72:75],a[172:175],v[236:239],v[72:75]
ds_read_b128 v[232:235],v17 offset:36864
s_waitcnt lgkmcnt(5)
v_mfma_f32_16x16x32_bf16 v[64:67],a[48:51],v[240:243],v[64:67]
s_xor_b32 m0,s91,50176
v_min3_u32 v27,v27,v240,v244
v_mfma_f32_16x16x32_bf16 v[72:75],a[176:179],v[240:243],v[72:75]
ds_read_b128 v[236:239],v17 offset:38912
v_mfma_f32_16x16x32_bf16 v[64:67],a[52:55],v[244:247],v[64:67]
s_add_u32 s65,s95,98304
v_mfma_f32_16x16x32_bf16 v[72:75],a[180:183],v[244:247],v[72:75]
ds_read_b128 v[240:243],v17 offset:40960
s_waitcnt lgkmcnt(5)
v_mfma_f32_16x16x32_bf16 v[64:67],a[56:59],v[248:251],v[64:67]
buffer_load_dwordx4 v16,s[20:23],s65 offen offset:0 sc1 lds
v_min3_u32 v27,v27,v248,v252
v_mfma_f32_16x16x32_bf16 v[72:75],a[184:187],v[248:251],v[72:75]
ds_read_b128 v[244:247],v17 offset:43008
s_waitcnt vmcnt(63)
v_mfma_f32_16x16x32_bf16 v[64:67],a[60:63],v[252:255],v[64:67]
buffer_load_dwordx4 v16,s[20:23],s65 offen offset:2048 sc1 lds
v_mfma_f32_16x16x32_bf16 v[72:75],a[188:191],v[252:255],v[72:75]
ds_read_b128 v[248:251],v17 offset:45056
s_waitcnt lgkmcnt(5)
v_mfma_f32_16x16x32_bf16 v[64:67],a[64:67],v[224:227],v[64:67]
v_cmp_gt_u32 vcc,s96,v29
v_cmp_gt_u32 s[92:93],s92,v29
v_mfma_f32_16x16x32_bf16 v[72:75],a[192:195],v[224:227],v[72:75]
ds_read_b128 v[252:255],v17 offset:47104
v_min3_u32 v27,v27,v224,v228
v_mfma_f32_16x16x32_bf16 v[64:67],a[68:71],v[228:231],v[64:67]
v_mov_b32 v44,vcc_lo
v_mov_b32 v45,s92
s_add_u32 m0,s43,0
v_mfma_f32_16x16x32_bf16 v[72:75],a[196:199],v[228:231],v[72:75]
ds_read_b128 v[224:227],v17 offset:49152
s_waitcnt lgkmcnt(5)
v_mfma_f32_16x16x32_bf16 v[64:67],a[72:75],v[232:235],v[64:67]
ds_write_b64 v46,v[44:45]
v_min3_u32 v27,v27,v232,v236
v_mfma_f32_16x16x32_bf16 v[72:75],a[200:203],v[232:235],v[72:75]
ds_read_b128 v[228:231],v17 offset:51200
buffer_load_dwordx4 v19,s[20:23],s78 offen sc1 lds
v_mfma_f32_16x16x32_bf16 v[64:67],a[76:79],v[236:239],v[64:67]
s_add_u32 m0,s43,1024
s_nop 0
buffer_load_dwordx4 v20,s[20:23],s78 offen sc1 lds
v_mfma_f32_16x16x32_bf16 v[72:75],a[204:207],v[236:239],v[72:75]
ds_read_b128 v[232:235],v17 offset:53248
s_waitcnt lgkmcnt(6)
v_mfma_f32_16x16x32_bf16 v[64:67],a[80:83],v[240:243],v[64:67]
v_min3_u32 v27,v27,v240,v244
s_add_u32 s88,s70,s75
v_mfma_f32_16x16x32_bf16 v[72:75],a[208:211],v[240:243],v[72:75]
ds_read_b128 v[236:239],v17 offset:55296
s_add_u32 s88,s88,2097152
v_mfma_f32_16x16x32_bf16 v[64:67],a[84:87],v[244:247],v[64:67]
s_xor_b32 s88,s88,0x2000
s_xor_b32 s89,s88,1024
v_mfma_f32_16x16x32_bf16 v[72:75],a[212:215],v[244:247],v[72:75]
ds_read_b128 v[240:243],v17 offset:57344
s_waitcnt lgkmcnt(6)
v_mfma_f32_16x16x32_bf16 v[64:67],a[88:91],v[248:251],v[64:67]
v_min3_u32 v27,v27,v248,v252
v_mfma_f32_16x16x32_bf16 v[72:75],a[216:219],v[248:251],v[72:75]
ds_read_b128 v[244:247],v17 offset:59392
v_mfma_f32_16x16x32_bf16 v[64:67],a[92:95],v[252:255],v[64:67]
v_mfma_f32_16x16x32_bf16 v[72:75],a[220:223],v[252:255],v[72:75]
ds_read_b128 v[248:251],v17 offset:61440
s_waitcnt lgkmcnt(5)
v_mfma_f32_16x16x32_bf16 v[64:67],a[96:99],v[224:227],v[64:67]
v_min3_u32 v27,v27,v224,v228
v_mfma_f32_16x16x32_bf16 v[72:75],a[224:227],v[224:227],v[72:75]
ds_read_b128 v[252:255],v17 offset:63488
v_mfma_f32_16x16x32_bf16 v[64:67],a[100:103],v[228:231],v[64:67]
v_mfma_f32_16x16x32_bf16 v[72:75],a[228:231],v[228:231],v[72:75]
s_waitcnt vmcnt(6)
s_barrier
ds_read_b64 v[44:45],v47
ds_read_b128 v[224:227],v17 offset:1024
s_waitcnt lgkmcnt(6)
v_mfma_f32_16x16x32_bf16 v[64:67],a[104:107],v[232:235],v[64:67]
v_min3_u32 v27,v27,v232,v236
v_mfma_f32_16x16x32_bf16 v[72:75],a[232:235],v[232:235],v[72:75]
ds_read_b128 v[228:231],v17 offset:3072
v_mfma_f32_16x16x32_bf16 v[64:67],a[108:111],v[236:239],v[64:67]
s_waitcnt vmcnt(0)
ds_read_b64 v[120:121],v40 offset:0
v_mfma_f32_16x16x32_bf16 v[72:75],a[236:239],v[236:239],v[72:75]
ds_read_b128 v[232:235],v17 offset:5120
s_waitcnt lgkmcnt(7)
v_mfma_f32_16x16x32_bf16 v[64:67],a[112:115],v[240:243],v[64:67]
v_min3_u32 v27,v27,v240,v244
ds_read_b64 v[122:123],v41 offset:0
v_mfma_f32_16x16x32_bf16 v[72:75],a[240:243],v[240:243],v[72:75]
ds_read_b128 v[236:239],v17 offset:7168
ds_read_b64 v[124:125],v40 offset:1024
v_mfma_f32_16x16x32_bf16 v[64:67],a[116:119],v[244:247],v[64:67]
ds_read_b64 v[126:127],v41 offset:1024
v_mfma_f32_16x16x32_bf16 v[72:75],a[244:247],v[244:247],v[72:75]
ds_read_b128 v[240:243],v17 offset:9216
s_waitcnt lgkmcnt(10)
v_mfma_f32_16x16x32_bf16 v[64:67],a[120:123],v[248:251],v[64:67]
s_waitcnt lgkmcnt(9)
v_readfirstlane_b32 s93,v45
v_mfma_f32_16x16x32_bf16 v[72:75],a[248:251],v[248:251],v[72:75]
ds_read_b128 v[244:247],v17 offset:11264
v_readfirstlane_b32 s83,v44
s_cmp_lg_u32 s83,0
s_cbranch_scc0 keep_250
v_mfma_f32_16x16x32_bf16 v[64:67],a[124:127],v[252:255],v[64:67]
v_min3_u32 v27,v27,v248,v252
v_mfma_f32_16x16x32_bf16 v[72:75],a[252:255],v[252:255],v[72:75]
ds_read_b128 v[248:251],v17 offset:13312
s_waitcnt lgkmcnt(9)
v_mfma_f32_16x16x32_bf16 v[68:71],a[0:3],v[224:227],0
v_cmp_eq_u32 vcc,0,v27
s_cbranch_vccnz retry_239
v_mfma_f32_16x16x32_bf16 v[76:79],a[128:131],v[224:227],0
ds_read_b128 v[252:255],v17 offset:15360
v_min3_u32 v27,v27,v224,v228
v_mfma_f32_16x16x32_bf16 v[68:71],a[4:7],v[228:231],v[68:71]
v_mfma_f32_16x16x32_bf16 v[76:79],a[132:135],v[228:231],v[76:79]
ds_read_b128 v[224:227],v17 offset:17408
s_waitcnt lgkmcnt(7)
v_mfma_f32_16x16x32_bf16 v[68:71],a[8:11],v[232:235],v[68:71]
v_min3_u32 v27,v27,v232,v236
s_waitcnt lgkmcnt(5)
v_lshlrev_b32 v88,16,v120
v_mfma_f32_16x16x32_bf16 v[76:79],a[136:139],v[232:235],v[76:79]
ds_read_b128 v[228:231],v17 offset:19456
v_and_b32 v89,s80,v120
v_lshlrev_b32 v90,16,v121
v_mfma_f32_16x16x32_bf16 v[68:71],a[12:15],v[236:239],v[68:71]
v_and_b32 v91,s80,v121
v_lshlrev_b32 v92,16,v122
v_and_b32 v93,s80,v122
v_mfma_f32_16x16x32_bf16 v[76:79],a[140:143],v[236:239],v[76:79]
ds_read_b128 v[232:235],v17 offset:21504
v_lshlrev_b32 v94,16,v123
s_waitcnt lgkmcnt(5)
v_mfma_f32_16x16x32_bf16 v[68:71],a[16:19],v[240:243],v[68:71]
v_min3_u32 v27,v27,v240,v244
v_and_b32 v95,s80,v123
v_mfma_f32_16x16x32_bf16 v[76:79],a[144:147],v[240:243],v[76:79]
ds_read_b128 v[236:239],v17 offset:23552
v_add_f32 v88,v64,v88
v_mfma_f32_16x16x32_bf16 v[68:71],a[20:23],v[244:247],v[68:71]
v_add_f32 v89,v65,v89
v_add_f32 v90,v66,v90
v_mfma_f32_16x16x32_bf16 v[76:79],a[148:151],v[244:247],v[76:79]
ds_read_b128 v[240:243],v17 offset:25600
s_waitcnt lgkmcnt(5)
v_mfma_f32_16x16x32_bf16 v[68:71],a[24:27],v[248:251],v[68:71]
v_min3_u32 v27,v27,v248,v252
v_add_f32 v91,v67,v91
v_mfma_f32_16x16x32_bf16 v[76:79],a[152:155],v[248:251],v[76:79]
ds_read_b128 v[244:247],v17 offset:27648
v_add_f32 v92,v72,v92
v_mfma_f32_16x16x32_bf16 v[68:71],a[28:31],v[252:255],v[68:71]
v_add_f32 v93,v73,v93
v_add_f32 v94,v74,v94
v_mfma_f32_16x16x32_bf16 v[76:79],a[156:159],v[252:255],v[76:79]
ds_read_b128 v[248:251],v17 offset:29696
s_waitcnt lgkmcnt(5)
v_mfma_f32_16x16x32_bf16 v[68:71],a[32:35],v[224:227],v[68:71]
v_min3_u32 v27,v27,v224,v228
v_add_f32 v95,v75,v95
v_mfma_f32_16x16x32_bf16 v[76:79],a[160:163],v[224:227],v[76:79]
ds_read_b128 v[252:255],v17 offset:31744
v_cvt_pk_bf16_f32 v96,v88,v89
v_mfma_f32_16x16x32_bf16 v[68:71],a[36:39],v[228:231],v[68:71]
v_cvt_pk_bf16_f32 v97,v90,v91
v_cvt_pk_bf16_f32 v98,v92,v93
v_mfma_f32_16x16x32_bf16 v[76:79],a[164:167],v[228:231],v[76:79]
s_waitcnt vmcnt(2)
s_barrier
ds_read_b128 v[224:227],v17 offset:33792
s_waitcnt lgkmcnt(5)
v_mfma_f32_16x16x32_bf16 v[68:71],a[40:43],v[232:235],v[68:71]
v_min3_u32 v27,v27,v232,v236
v_cvt_pk_bf16_f32 v99,v94,v95
v_mfma_f32_16x16x32_bf16 v[76:79],a[168:171],v[232:235],v[76:79]
ds_read_b128 v[228:231],v17 offset:35840
v_max_u32 v96,1,v96
v_mfma_f32_16x16x32_bf16 v[68:71],a[44:47],v[236:239],v[68:71]
buffer_store_dwordx4 v[96:99],v18,s[20:23],s70 offen offset:0 sc1
v_mfma_f32_16x16x32_bf16 v[76:79],a[172:175],v[236:239],v[76:79]
ds_read_b128 v[232:235],v17 offset:37888
s_waitcnt lgkmcnt(5)
v_mfma_f32_16x16x32_bf16 v[68:71],a[48:51],v[240:243],v[68:71]
v_min3_u32 v27,v27,v240,v244
v_lshlrev_b32 v88,16,v96
v_mfma_f32_16x16x32_bf16 v[76:79],a[176:179],v[240:243],v[76:79]
ds_read_b128 v[236:239],v17 offset:39936
v_and_b32 v89,s80,v96
v_mfma_f32_16x16x32_bf16 v[68:71],a[52:55],v[244:247],v[68:71]
v_lshlrev_b32 v90,16,v97
v_and_b32 v91,s80,v97
v_mfma_f32_16x16x32_bf16 v[76:79],a[180:183],v[244:247],v[76:79]
ds_read_b128 v[240:243],v17 offset:41984
s_waitcnt lgkmcnt(5)
v_mfma_f32_16x16x32_bf16 v[68:71],a[56:59],v[248:251],v[68:71]
v_min3_u32 v27,v27,v248,v252
v_lshlrev_b32 v92,16,v98
v_mfma_f32_16x16x32_bf16 v[76:79],a[184:187],v[248:251],v[76:79]
ds_read_b128 v[244:247],v17 offset:44032
v_and_b32 v93,s80,v98
v_mfma_f32_16x16x32_bf16 v[68:71],a[60:63],v[252:255],v[68:71]
v_lshlrev_b32 v94,16,v99
v_and_b32 v95,s80,v99
v_mfma_f32_16x16x32_bf16 v[76:79],a[188:191],v[252:255],v[76:79]
ds_read_b128 v[248:251],v17 offset:46080
s_waitcnt lgkmcnt(5)
v_mfma_f32_16x16x32_bf16 v[68:71],a[64:67],v[224:227],v[68:71]
v_min3_u32 v27,v27,v224,v228
v_add_f32 v108,v88,v89
v_mfma_f32_16x16x32_bf16 v[76:79],a[192:195],v[224:227],v[76:79]
ds_read_b128 v[252:255],v17 offset:48128
v_mul_f32 v109,v88,v88
v_mfma_f32_16x16x32_bf16 v[68:71],a[68:71],v[228:231],v[68:71]
v_add_f32 v100,v90,v91
v_mul_f32 v101,v89,v89
v_mfma_f32_16x16x32_bf16 v[76:79],a[196:199],v[228:231],v[76:79]
ds_read_b128 v[224:227],v17 offset:50176
s_waitcnt lgkmcnt(5)
v_mfma_f32_16x16x32_bf16 v[68:71],a[72:75],v[232:235],v[68:71]
v_min3_u32 v27,v27,v232,v236
v_fmac_f32 v109,v90,v90
v_mfma_f32_16x16x32_bf16 v[76:79],a[200:203],v[232:235],v[76:79]
ds_read_b128 v[228:231],v17 offset:52224
v_fmac_f32 v101,v91,v91
v_mfma_f32_16x16x32_bf16 v[68:71],a[76:79],v[236:239],v[68:71]
v_fmac_f32 v109,v92,v92
v_fmac_f32 v101,v93,v93
v_mfma_f32_16x16x32_bf16 v[76:79],a[204:207],v[236:239],v[76:79]
ds_read_b128 v[232:235],v17 offset:54272
s_waitcnt lgkmcnt(5)
v_mfma_f32_16x16x32_bf16 v[68:71],a[80:83],v[240:243],v[68:71]
v_min3_u32 v27,v27,v240,v244
v_add_f32 v108,v108,v92
v_mfma_f32_16x16x32_bf16 v[76:79],a[208:211],v[240:243],v[76:79]
ds_read_b128 v[236:239],v17 offset:56320
v_add_f32 v100,v100,v93
v_mfma_f32_16x16x32_bf16 v[68:71],a[84:87],v[244:247],v[68:71]
v_fmac_f32 v109,v94,v94
v_fmac_f32 v101,v95,v95
v_mfma_f32_16x16x32_bf16 v[76:79],a[212:215],v[244:247],v[76:79]
ds_read_b128 v[240:243],v17 offset:58368
s_waitcnt lgkmcnt(5)
v_mfma_f32_16x16x32_bf16 v[68:71],a[88:91],v[248:251],v[68:71]
v_min3_u32 v27,v27,v248,v252
v_add_f32 v108,v108,v94
v_mfma_f32_16x16x32_bf16 v[76:79],a[216:219],v[248:251],v[76:79]
ds_read_b128 v[244:247],v17 offset:60416
v_add_f32 v100,v100,v95
v_mfma_f32_16x16x32_bf16 v[68:71],a[92:95],v[252:255],v[68:71]
v_add_f32 v108,v108,v100
v_add_f32 v109,v109,v101
v_mfma_f32_16x16x32_bf16 v[76:79],a[220:223],v[252:255],v[76:79]
ds_read_b128 v[248:251],v17 offset:62464
s_waitcnt lgkmcnt(5)
v_mfma_f32_16x16x32_bf16 v[68:71],a[96:99],v[224:227],v[68:71]
v_min3_u32 v27,v27,v224,v228
v_mov_b32 v100,v108
v_mfma_f32_16x16x32_bf16 v[76:79],a[224:227],v[224:227],v[76:79]
ds_read_b128 v[252:255],v17 offset:64512
v_mov_b32 v101,v109
v_mfma_f32_16x16x32_bf16 v[68:71],a[100:103],v[228:231],v[68:71]
v_permlane16_swap_b32 v100,v108
v_permlane16_swap_b32 v101,v109
v_mfma_f32_16x16x32_bf16 v[76:79],a[228:231],v[228:231],v[76:79]
v_add_f32 v108,v108,v100
s_waitcnt lgkmcnt(4)
v_mfma_f32_16x16x32_bf16 v[68:71],a[104:107],v[232:235],v[68:71]
v_min3_u32 v27,v27,v232,v236
v_add_f32 v109,v109,v101
v_mfma_f32_16x16x32_bf16 v[76:79],a[232:235],v[232:235],v[76:79]
v_mov_b32 v100,v108
v_mov_b32 v101,v109
v_mfma_f32_16x16x32_bf16 v[68:71],a[108:111],v[236:239],v[68:71]
v_permlane32_swap_b32 v100,v108
v_permlane32_swap_b32 v101,v109
v_mfma_f32_16x16x32_bf16 v[76:79],a[236:239],v[236:239],v[76:79]
v_add_f32 v108,v108,v100
s_waitcnt lgkmcnt(2)
v_mfma_f32_16x16x32_bf16 v[68:71],a[112:115],v[240:243],v[68:71]
v_min3_u32 v27,v27,v240,v244
v_add_f32 v109,v109,v101
v_mfma_f32_16x16x32_bf16 v[76:79],a[240:243],v[240:243],v[76:79]
v_min3_u32 v27,v27,v120,v122
v_min3_u32 v27,v27,v124,v126
v_mfma_f32_16x16x32_bf16 v[68:71],a[116:119],v[244:247],v[68:71]
v_lshlrev_b32 v32,16,v124
v_and_b32 v33,s80,v124
v_mfma_f32_16x16x32_bf16 v[76:79],a[244:247],v[244:247],v[76:79]
v_lshlrev_b32 v34,16,v125
s_waitcnt lgkmcnt(0)
v_mfma_f32_16x16x32_bf16 v[68:71],a[120:123],v[248:251],v[68:71]
v_min3_u32 v27,v27,v248,v252
v_and_b32 v35,s80,v125
v_mfma_f32_16x16x32_bf16 v[76:79],a[248:251],v[248:251],v[76:79]
v_lshlrev_b32 v36,16,v126
v_and_b32 v37,s80,v126
v_mfma_f32_16x16x32_bf16 v[68:71],a[124:127],v[252:255],v[68:71]
v_lshlrev_b32 v38,16,v127
v_and_b32 v39,s80,v127
v_mfma_f32_16x16x32_bf16 v[76:79],a[252:255],v[252:255],v[76:79]
v_cmp_eq_u32 vcc,0,v27
s_cbranch_vccnz retry_239
s_branch epi_242
keep_250:
v_mfma_f32_16x16x32_bf16 v[64:67],a[124:127],v[252:255],v[64:67]
v_min3_u32 v27,v27,v248,v252
s_xor_b32 m0,s72,0
v_mfma_f32_16x16x32_bf16 v[72:75],a[252:255],v[252:255],v[72:75]
ds_read_b128 v[248:251],v17 offset:13312
s_add_u32 s65,s88,0
s_waitcnt lgkmcnt(9)
v_mfma_f32_16x16x32_bf16 v[68:71],a[0:3],v[224:227],0
buffer_load_dwordx4 v16,s[20:23],s65 offen offset:0 sc1 lds
v_min3_u32 v27,v27,v224,v228
v_mfma_f32_16x16x32_bf16 v[76:79],a[128:131],v[224:227],0
ds_read_b128 v[252:255],v17 offset:15360
buffer_load_dwordx4 v16,s[20:23],s65 offen offset:2048 sc1 lds
v_mfma_f32_16x16x32_bf16 v[68:71],a[4:7],v[228:231],v[68:71]
v_cmp_eq_u32 vcc,0,v27
s_cbranch_vccnz retry_239
v_mfma_f32_16x16x32_bf16 v[76:79],a[132:135],v[228:231],v[76:79]
ds_read_b128 v[224:227],v17 offset:17408
s_xor_b32 m0,s72,16384
s_waitcnt lgkmcnt(7)
v_mfma_f32_16x16x32_bf16 v[68:71],a[8:11],v[232:235],v[68:71]
s_add_u32 s65,s88,32768
v_min3_u32 v27,v27,v232,v236
s_waitcnt lgkmcnt(5)
v_mfma_f32_16x16x32_bf16 v[76:79],a[136:139],v[232:235],v[76:79]
ds_read_b128 v[228:231],v17 offset:19456
buffer_load_dwordx4 v16,s[20:23],s65 offen offset:0 sc1 lds
v_mfma_f32_16x16x32_bf16 v[68:71],a[12:15],v[236:239],v[68:71]
v_lshlrev_b32 v88,16,v120
v_and_b32 v89,s80,v120
v_lshlrev_b32 v90,16,v121
v_mfma_f32_16x16x32_bf16 v[76:79],a[140:143],v[236:239],v[76:79]
ds_read_b128 v[232:235],v17 offset:21504
v_and_b32 v91,s80,v121
s_waitcnt lgkmcnt(5)
v_mfma_f32_16x16x32_bf16 v[68:71],a[16:19],v[240:243],v[68:71]
buffer_load_dwordx4 v16,s[20:23],s65 offen offset:2048 sc1 lds
s_xor_b32 m0,s72,32768
v_mfma_f32_16x16x32_bf16 v[76:79],a[144:147],v[240:243],v[76:79]
ds_read_b128 v[236:239],v17 offset:23552
s_add_u32 s65,s88,65536
v_lshlrev_b32 v92,16,v122
v_mfma_f32_16x16x32_bf16 v[68:71],a[20:23],v[244:247],v[68:71]
v_min3_u32 v27,v27,v240,v244
v_and_b32 v93,s80,v122
v_lshlrev_b32 v94,16,v123
v_mfma_f32_16x16x32_bf16 v[76:79],a[148:151],v[244:247],v[76:79]
ds_read_b128 v[240:243],v17 offset:25600
v_and_b32 v95,s80,v123
s_waitcnt lgkmcnt(5)
v_mfma_f32_16x16x32_bf16 v[68:71],a[24:27],v[248:251],v[68:71]
buffer_load_dwordx4 v16,s[20:23],s65 offen offset:0 sc1 lds
v_add_f32 v88,v64,v88
v_mfma_f32_16x16x32_bf16 v[76:79],a[152:155],v[248:251],v[76:79]
ds_read_b128 v[244:247],v17 offset:27648
buffer_load_dwordx4 v16,s[20:23],s65 offen offset:2048 sc1 lds
v_mfma_f32_16x16x32_bf16 v[68:71],a[28:31],v[252:255],v[68:71]
s_xor_b32 m0,s72,49152
v_min3_u32 v27,v27,v248,v252
v_add_f32 v89,v65,v89
v_mfma_f32_16x16x32_bf16 v[76:79],a[156:159],v[252:255],v[76:79]
ds_read_b128 v[248:251],v17 offset:29696
s_add_u32 s65,s88,98304
s_waitcnt lgkmcnt(5)
v_mfma_f32_16x16x32_bf16 v[68:71],a[32:35],v[224:227],v[68:71]
buffer_load_dwordx4 v16,s[20:23],s65 offen offset:0 sc1 lds
v_add_f32 v90,v66,v90
v_mfma_f32_16x16x32_bf16 v[76:79],a[160:163],v[224:227],v[76:79]
ds_read_b128 v[252:255],v17 offset:31744
v_min3_u32 v27,v27,v224,v228
v_add_f32 v91,v67,v91
v_mfma_f32_16x16x32_bf16 v[68:71],a[36:39],v[228:231],v[68:71]
buffer_load_dwordx4 v16,s[20:23],s65 offen offset:2048 sc1 lds
v_add_f32 v92,v72,v92
v_mfma_f32_16x16x32_bf16 v[76:79],a[164:167],v[228:231],v[76:79]
s_waitcnt vmcnt(10)
s_barrier
ds_read_b128 v[224:227],v17 offset:33792
s_waitcnt lgkmcnt(5)
v_mfma_f32_16x16x32_bf16 v[68:71],a[40:43],v[232:235],v[68:71]
s_xor_b32 m0,s72,1024
s_add_u32 s65,s89,0
v_add_f32 v93,v73,v93
v_mfma_f32_16x16x32_bf16 v[76:79],a[168:171],v[232:235],v[76:79]
ds_read_b128 v[228:231],v17 offset:35840
v_min3_u32 v27,v27,v232,v236
v_add_f32 v94,v74,v94
v_mfma_f32_16x16x32_bf16 v[68:71],a[44:47],v[236:239],v[68:71]
buffer_load_dwordx4 v16,s[20:23],s65 offen offset:0 sc1 lds
v_add_f32 v95,v75,v95
v_mfma_f32_16x16x32_bf16 v[76:79],a[172:175],v[236:239],v[76:79]
ds_read_b128 v[232:235],v17 offset:37888
v_cvt_pk_bf16_f32 v96,v88,v89
s_waitcnt lgkmcnt(5)
v_mfma_f32_16x16x32_bf16 v[68:71],a[48:51],v[240:243],v[68:71]
buffer_load_dwordx4 v16,s[20:23],s65 offen offset:2048 sc1 lds
v_cvt_pk_bf16_f32 v97,v90,v91
v_mfma_f32_16x16x32_bf16 v[76:79],a[176:179],v[240:243],v[76:79]
ds_read_b128 v[236:239],v17 offset:39936
s_xor_b32 m0,s72,17408
v_cvt_pk_bf16_f32 v98,v92,v93
v_mfma_f32_16x16x32_bf16 v[68:71],a[52:55],v[244:247],v[68:71]
s_add_u32 s65,s89,32768
v_min3_u32 v27,v27,v240,v244
v_cvt_pk_bf16_f32 v99,v94,v95
v_mfma_f32_16x16x32_bf16 v[76:79],a[180:183],v[244:247],v[76:79]
ds_read_b128 v[240:243],v17 offset:41984
v_max_u32 v96,1,v96
s_waitcnt lgkmcnt(5)
v_mfma_f32_16x16x32_bf16 v[68:71],a[56:59],v[248:251],v[68:71]
buffer_load_dwordx4 v16,s[20:23],s65 offen offset:0 sc1 lds
v_mfma_f32_16x16x32_bf16 v[76:79],a[184:187],v[248:251],v[76:79]
ds_read_b128 v[244:247],v17 offset:44032
v_min3_u32 v27,v27,v248,v252
v_mfma_f32_16x16x32_bf16 v[68:71],a[60:63],v[252:255],v[68:71]
buffer_load_dwordx4 v16,s[20:23],s65 offen offset:2048 sc1 lds
v_mfma_f32_16x16x32_bf16 v[76:79],a[188:191],v[252:255],v[76:79]
ds_read_b128 v[248:251],v17 offset:46080
s_waitcnt lgkmcnt(5)
v_mfma_f32_16x16x32_bf16 v[68:71],a[64:67],v[224:227],v[68:71]
s_xor_b32 m0,s72,33792
s_add_u32 s65,s89,65536
v_mfma_f32_16x16x32_bf16 v[76:79],a[192:195],v[224:227],v[76:79]
ds_read_b128 v[252:255],v17 offset:48128
v_min3_u32 v27,v27,v224,v228
v_mfma_f32_16x16x32_bf16 v[68:71],a[68:71],v[228:231],v[68:71]
buffer_load_dwordx4 v16,s[20:23],s65 offen offset:0 sc1 lds
v_mfma_f32_16x16x32_bf16 v[76:79],a[196:199],v[228:231],v[76:79]
ds_read_b128 v[224:227],v17 offset:50176
s_waitcnt lgkmcnt(5)
v_mfma_f32_16x16x32_bf16 v[68:71],a[72:75],v[232:235],v[68:71]
buffer_load_dwordx4 v16,s[20:23],s65 offen offset:2048 sc1 lds
v_mfma_f32_16x16x32_bf16 v[76:79],a[200:203],v[232:235],v[76:79]
ds_read_b128 v[228:231],v17 offset:52224
s_xor_b32 m0,s72,50176
v_mfma_f32_16x16x32_bf16 v[68:71],a[76:79],v[236:239],v[68:71]
s_add_u32 s65,s89,98304
v_min3_u32 v27,v27,v232,v236
v_mfma_f32_16x16x32_bf16 v[76:79],a[204:207],v[236:239],v[76:79]
ds_read_b128 v[232:235],v17 offset:54272
s_waitcnt lgkmcnt(5)
v_mfma_f32_16x16x32_bf16 v[68:71],a[80:83],v[240:243],v[68:71]
buffer_load_dwordx4 v16,s[20:23],s65 offen offset:0 sc1 lds
v_mfma_f32_16x16x32_bf16 v[76:79],a[208:211],v[240:243],v[76:79]
ds_read_b128 v[236:239],v17 offset:56320
v_min3_u32 v27,v27,v240,v244
v_mfma_f32_16x16x32_bf16 v[68:71],a[84:87],v[244:247],v[68:71]
buffer_load_dwordx4 v16,s[20:23],s65 offen offset:2048 sc1 lds
v_mfma_f32_16x16x32_bf16 v[76:79],a[212:215],v[244:247],v[76:79]
ds_read_b128 v[240:243],v17 offset:58368
s_waitcnt lgkmcnt(5)
v_mfma_f32_16x16x32_bf16 v[68:71],a[88:91],v[248:251],v[68:71]
v_min3_u32 v27,v27,v248,v252
buffer_store_dwordx4 v[96:99],v18,s[20:23],s70 offen offset:0 sc1
v_mfma_f32_16x16x32_bf16 v[76:79],a[216:219],v[248:251],v[76:79]
ds_read_b128 v[244:247],v17 offset:60416
v_lshlrev_b32 v88,16,v96
v_and_b32 v89,s80,v96
v_mfma_f32_16x16x32_bf16 v[68:71],a[92:95],v[252:255],v[68:71]
v_lshlrev_b32 v90,16,v97
v_and_b32 v91,s80,v97
v_lshlrev_b32 v92,16,v98
v_mfma_f32_16x16x32_bf16 v[76:79],a[220:223],v[252:255],v[76:79]
ds_read_b128 v[248:251],v17 offset:62464
v_and_b32 v93,s80,v98
s_waitcnt lgkmcnt(5)
v_mfma_f32_16x16x32_bf16 v[68:71],a[96:99],v[224:227],v[68:71]
v_min3_u32 v27,v27,v224,v228
v_lshlrev_b32 v94,16,v99
v_and_b32 v95,s80,v99
v_mfma_f32_16x16x32_bf16 v[76:79],a[224:227],v[224:227],v[76:79]
ds_read_b128 v[252:255],v17 offset:64512
v_add_f32 v108,v88,v89
v_mul_f32 v109,v88,v88
v_mfma_f32_16x16x32_bf16 v[68:71],a[100:103],v[228:231],v[68:71]
v_add_f32 v100,v90,v91
v_mul_f32 v101,v89,v89
v_fmac_f32 v109,v90,v90
v_mfma_f32_16x16x32_bf16 v[76:79],a[228:231],v[228:231],v[76:79]
v_fmac_f32 v101,v91,v91
v_fmac_f32 v109,v92,v92
s_waitcnt lgkmcnt(4)
v_mfma_f32_16x16x32_bf16 v[68:71],a[104:107],v[232:235],v[68:71]
v_min3_u32 v27,v27,v232,v236
v_fmac_f32 v101,v93,v93
v_add_f32 v108,v108,v92
v_mfma_f32_16x16x32_bf16 v[76:79],a[232:235],v[232:235],v[76:79]
v_add_f32 v100,v100,v93
v_fmac_f32 v109,v94,v94
v_fmac_f32 v101,v95,v95
v_mfma_f32_16x16x32_bf16 v[68:71],a[108:111],v[236:239],v[68:71]
v_add_f32 v108,v108,v94
v_add_f32 v100,v100,v95
v_add_f32 v108,v108,v100
v_mfma_f32_16x16x32_bf16 v[76:79],a[236:239],v[236:239],v[76:79]
v_add_f32 v109,v109,v101
v_mov_b32 v100,v108
s_waitcnt lgkmcnt(2)
v_mfma_f32_16x16x32_bf16 v[68:71],a[112:115],v[240:243],v[68:71]
v_min3_u32 v27,v27,v240,v244
v_mov_b32 v101,v109
v_permlane16_swap_b32 v100,v108
v_mfma_f32_16x16x32_bf16 v[76:79],a[240:243],v[240:243],v[76:79]
v_permlane16_swap_b32 v101,v109
v_add_f32 v108,v108,v100
v_add_f32 v109,v109,v101
v_mfma_f32_16x16x32_bf16 v[68:71],a[116:119],v[244:247],v[68:71]
v_mov_b32 v100,v108
v_mov_b32 v101,v109
s_nop 0
v_permlane32_swap_b32 v100,v108
v_mfma_f32_16x16x32_bf16 v[76:79],a[244:247],v[244:247],v[76:79]
v_permlane32_swap_b32 v101,v109
v_add_f32 v108,v108,v100
s_waitcnt lgkmcnt(0)
v_mfma_f32_16x16x32_bf16 v[68:71],a[120:123],v[248:251],v[68:71]
v_min3_u32 v27,v27,v248,v252
v_add_f32 v109,v109,v101
v_min3_u32 v27,v27,v120,v122
v_mfma_f32_16x16x32_bf16 v[76:79],a[248:251],v[248:251],v[76:79]
v_min3_u32 v27,v27,v124,v126
v_lshlrev_b32 v32,16,v124
v_and_b32 v33,s80,v124
v_mfma_f32_16x16x32_bf16 v[68:71],a[124:127],v[252:255],v[68:71]
v_lshlrev_b32 v34,16,v125
v_and_b32 v35,s80,v125
v_lshlrev_b32 v36,16,v126
v_mfma_f32_16x16x32_bf16 v[76:79],a[252:255],v[252:255],v[76:79]
v_and_b32 v37,s80,v126
v_lshlrev_b32 v38,16,v127
v_and_b32 v39,s80,v127
v_cmp_eq_u32 vcc,0,v27
s_cbranch_vccnz retry_239
s_branch epi_242
ahead_241:
s_cmp_eq_u32 s93,0
s_cbranch_scc1 both_243
s_waitcnt vmcnt(13) lgkmcnt(0)
s_barrier
ds_read_b128 v[224:227],v17 offset:0
ds_read_b128 v[228:231],v17 offset:2048
ds_read_b128 v[232:235],v17 offset:4096
ds_read_b128 v[236:239],v17 offset:6144
ds_read_b128 v[240:243],v17 offset:8192
ds_read_b128 v[244:247],v17 offset:10240
ds_read_b128 v[248:251],v17 offset:12288
s_waitcnt lgkmcnt(5)
v_mfma_f32_16x16x32_bf16 v[64:67],a[0:3],v[224:227],0
s_add_u32 s96,s71,1
s_add_u32 s92,s71,2
v_min_u32 v27,v224,v228
s_add_u32 m0,s43,0
v_mfma_f32_16x16x32_bf16 v[72:75],a[128:131],v[224:227],0
ds_read_b128 v[252:255],v17 offset:14336
s_cmp_eq_u32 s96,64
s_cselect_b32 s96,99,s96
v_mfma_f32_16x16x32_bf16 v[64:67],a[4:7],v[228:231],v[64:67]
s_cmp_eq_u32 s92,64
s_cselect_b32 s92,99,s92
buffer_load_dwordx4 v19,s[20:23],s78 offen sc1 lds
v_mfma_f32_16x16x32_bf16 v[72:75],a[132:135],v[228:231],v[72:75]
ds_read_b128 v[224:227],v17 offset:16384
s_add_u32 m0,s43,1024
s_waitcnt lgkmcnt(5)
v_mfma_f32_16x16x32_bf16 v[64:67],a[8:11],v[232:235],v[64:67]
s_cmp_eq_u32 s96,65
s_cselect_b32 s96,64,s96
buffer_load_dwordx4 v20,s[20:23],s78 offen sc1 lds
v_mfma_f32_16x16x32_bf16 v[72:75],a[136:139],v[232:235],v[72:75]
ds_read_b128 v[228:231],v17 offset:18432
v_min3_u32 v27,v27,v232,v236
v_mfma_f32_16x16x32_bf16 v[64:67],a[12:15],v[236:239],v[64:67]
v_mfma_f32_16x16x32_bf16 v[72:75],a[140:143],v[236:239],v[72:75]
ds_read_b128 v[232:235],v17 offset:20480
s_waitcnt lgkmcnt(5)
v_mfma_f32_16x16x32_bf16 v[64:67],a[16:19],v[240:243],v[64:67]
v_min3_u32 v27,v27,v240,v244
v_mfma_f32_16x16x32_bf16 v[72:75],a[144:147],v[240:243],v[72:75]
ds_read_b128 v[236:239],v17 offset:22528
v_mfma_f32_16x16x32_bf16 v[64:67],a[20:23],v[244:247],v[64:67]
v_mfma_f32_16x16x32_bf16 v[72:75],a[148:151],v[244:247],v[72:75]
ds_read_b128 v[240:243],v17 offset:24576
s_waitcnt lgkmcnt(5)
v_mfma_f32_16x16x32_bf16 v[64:67],a[24:27],v[248:251],v[64:67]
v_min3_u32 v27,v27,v248,v252
v_mfma_f32_16x16x32_bf16 v[72:75],a[152:155],v[248:251],v[72:75]
ds_read_b128 v[244:247],v17 offset:26624
v_mfma_f32_16x16x32_bf16 v[64:67],a[28:31],v[252:255],v[64:67]
v_mfma_f32_16x16x32_bf16 v[72:75],a[156:159],v[252:255],v[72:75]
ds_read_b128 v[248:251],v17 offset:28672
s_waitcnt lgkmcnt(5)
v_mfma_f32_16x16x32_bf16 v[64:67],a[32:35],v[224:227],v[64:67]
v_min3_u32 v27,v27,v224,v228
v_mfma_f32_16x16x32_bf16 v[72:75],a[160:163],v[224:227],v[72:75]
ds_read_b128 v[252:255],v17 offset:30720
v_mfma_f32_16x16x32_bf16 v[64:67],a[36:39],v[228:231],v[64:67]
v_mfma_f32_16x16x32_bf16 v[72:75],a[164:167],v[228:231],v[72:75]
ds_read_b128 v[224:227],v17 offset:32768
s_waitcnt lgkmcnt(5)
v_mfma_f32_16x16x32_bf16 v[64:67],a[40:43],v[232:235],v[64:67]
v_min3_u32 v27,v27,v232,v236
v_mfma_f32_16x16x32_bf16 v[72:75],a[168:171],v[232:235],v[72:75]
ds_read_b128 v[228:231],v17 offset:34816
v_mfma_f32_16x16x32_bf16 v[64:67],a[44:47],v[236:239],v[64:67]
v_mfma_f32_16x16x32_bf16 v[72:75],a[172:175],v[236:239],v[72:75]
ds_read_b128 v[232:235],v17 offset:36864
s_waitcnt lgkmcnt(5)
v_mfma_f32_16x16x32_bf16 v[64:67],a[48:51],v[240:243],v[64:67]
v_min3_u32 v27,v27,v240,v244
v_mfma_f32_16x16x32_bf16 v[72:75],a[176:179],v[240:243],v[72:75]
ds_read_b128 v[236:239],v17 offset:38912
v_mfma_f32_16x16x32_bf16 v[64:67],a[52:55],v[244:247],v[64:67]
v_mfma_f32_16x16x32_bf16 v[72:75],a[180:183],v[244:247],v[72:75]
ds_read_b128 v[240:243],v17 offset:40960
s_waitcnt lgkmcnt(5)
v_mfma_f32_16x16x32_bf16 v[64:67],a[56:59],v[248:251],v[64:67]
v_min3_u32 v27,v27,v248,v252
v_mfma_f32_16x16x32_bf16 v[72:75],a[184:187],v[248:251],v[72:75]
ds_read_b128 v[244:247],v17 offset:43008
s_waitcnt vmcnt(5)
v_mfma_f32_16x16x32_bf16 v[64:67],a[60:63],v[252:255],v[64:67]
v_cmp_gt_u32 vcc,s96,v29
v_cmp_gt_u32 s[92:93],s92,v29
v_mfma_f32_16x16x32_bf16 v[72:75],a[188:191],v[252:255],v[72:75]
ds_read_b128 v[248:251],v17 offset:45056
s_waitcnt lgkmcnt(5)
v_mfma_f32_16x16x32_bf16 v[64:67],a[64:67],v[224:227],v[64:67]
v_mov_b32 v44,vcc_lo
v_mov_b32 v45,s92
v_mfma_f32_16x16x32_bf16 v[72:75],a[192:195],v[224:227],v[72:75]
ds_read_b128 v[252:255],v17 offset:47104
ds_write_b64 v46,v[44:45]
v_mfma_f32_16x16x32_bf16 v[64:67],a[68:71],v[228:231],v[64:67]
v_min3_u32 v27,v27,v224,v228
v_mfma_f32_16x16x32_bf16 v[72:75],a[196:199],v[228:231],v[72:75]
ds_read_b128 v[224:227],v17 offset:49152
s_waitcnt lgkmcnt(6)
v_mfma_f32_16x16x32_bf16 v[64:67],a[72:75],v[232:235],v[64:67]
v_min3_u32 v27,v27,v232,v236
v_mfma_f32_16x16x32_bf16 v[72:75],a[200:203],v[232:235],v[72:75]
ds_read_b128 v[228:231],v17 offset:51200
v_mfma_f32_16x16x32_bf16 v[64:67],a[76:79],v[236:239],v[64:67]
v_mfma_f32_16x16x32_bf16 v[72:75],a[204:207],v[236:239],v[72:75]
ds_read_b128 v[232:235],v17 offset:53248
s_waitcnt lgkmcnt(6)
v_mfma_f32_16x16x32_bf16 v[64:67],a[80:83],v[240:243],v[64:67]
v_min3_u32 v27,v27,v240,v244
s_add_u32 s88,s70,s75
v_mfma_f32_16x16x32_bf16 v[72:75],a[208:211],v[240:243],v[72:75]
ds_read_b128 v[236:239],v17 offset:55296
s_add_u32 s88,s88,2097152
v_mfma_f32_16x16x32_bf16 v[64:67],a[84:87],v[244:247],v[64:67]
s_xor_b32 s88,s88,0x2000
s_xor_b32 s89,s88,1024
v_mfma_f32_16x16x32_bf16 v[72:75],a[212:215],v[244:247],v[72:75]
ds_read_b128 v[240:243],v17 offset:57344
s_waitcnt lgkmcnt(6)
v_mfma_f32_16x16x32_bf16 v[64:67],a[88:91],v[248:251],v[64:67]
v_min3_u32 v27,v27,v248,v252
v_mfma_f32_16x16x32_bf16 v[72:75],a[216:219],v[248:251],v[72:75]
ds_read_b128 v[244:247],v17 offset:59392
v_mfma_f32_16x16x32_bf16 v[64:67],a[92:95],v[252:255],v[64:67]
v_mfma_f32_16x16x32_bf16 v[72:75],a[220:223],v[252:255],v[72:75]
ds_read_b128 v[248:251],v17 offset:61440
s_waitcnt lgkmcnt(5)
v_mfma_f32_16x16x32_bf16 v[64:67],a[96:99],v[224:227],v[64:67]
v_min3_u32 v27,v27,v224,v228
v_mfma_f32_16x16x32_bf16 v[72:75],a[224:227],v[224:227],v[72:75]
ds_read_b128 v[252:255],v17 offset:63488
v_mfma_f32_16x16x32_bf16 v[64:67],a[100:103],v[228:231],v[64:67]
s_waitcnt vmcnt(2)
v_add_u32 v22,s71,-1
v_mfma_f32_16x16x32_bf16 v[72:75],a[228:231],v[228:231],v[72:75]
s_waitcnt vmcnt(7)
s_barrier
ds_read_b64 v[44:45],v47
ds_read_b128 v[224:227],v17 offset:1024
s_waitcnt lgkmcnt(6)
v_mfma_f32_16x16x32_bf16 v[64:67],a[104:107],v[232:235],v[64:67]
v_min3_u32 v27,v27,v232,v236
v_mfma_f32_16x16x32_bf16 v[72:75],a[232:235],v[232:235],v[72:75]
ds_read_b128 v[228:231],v17 offset:3072
v_mfma_f32_16x16x32_bf16 v[64:67],a[108:111],v[236:239],v[64:67]
buffer_store_dword v22,v23,s[20:23],s97 offen sc1
s_waitcnt vmcnt(1)
v_mfma_f32_16x16x32_bf16 v[72:75],a[236:239],v[236:239],v[72:75]
ds_read_b128 v[232:235],v17 offset:5120
s_waitcnt lgkmcnt(6)
v_mfma_f32_16x16x32_bf16 v[64:67],a[112:115],v[240:243],v[64:67]
v_min3_u32 v27,v27,v240,v244
s_mov_b32 s97,0x7fff0000
v_mfma_f32_16x16x32_bf16 v[72:75],a[240:243],v[240:243],v[72:75]
ds_read_b128 v[236:239],v17 offset:7168
ds_read_b64 v[120:121],v40 offset:0
v_mfma_f32_16x16x32_bf16 v[64:67],a[116:119],v[244:247],v[64:67]
ds_read_b64 v[122:123],v41 offset:0
ds_read_b64 v[124:125],v40 offset:1024
v_mfma_f32_16x16x32_bf16 v[72:75],a[244:247],v[244:247],v[72:75]
ds_read_b128 v[240:243],v17 offset:9216
s_waitcnt lgkmcnt(9)
v_mfma_f32_16x16x32_bf16 v[64:67],a[120:123],v[248:251],v[64:67]
s_waitcnt lgkmcnt(8)
v_readfirstlane_b32 s93,v45
v_mfma_f32_16x16x32_bf16 v[72:75],a[248:251],v[248:251],v[72:75]
ds_read_b128 v[244:247],v17 offset:11264
v_readfirstlane_b32 s83,v44
s_cmp_lg_u32 s83,0
s_cbranch_scc1 keep_251
v_mfma_f32_16x16x32_bf16 v[64:67],a[124:127],v[252:255],v[64:67]
v_min3_u32 v27,v27,v248,v252
ds_read_b64 v[126:127],v41 offset:1024
s_xor_b32 m0,s72,0
v_mfma_f32_16x16x32_bf16 v[72:75],a[252:255],v[252:255],v[72:75]
ds_read_b128 v[248:251],v17 offset:13312
s_add_u32 s65,s88,0
s_waitcnt lgkmcnt(9)
v_mfma_f32_16x16x32_bf16 v[68:71],a[0:3],v[224:227],0
buffer_load_dwordx4 v16,s[20:23],s65 offen offset:0 sc1 lds
v_min3_u32 v27,v27,v224,v228
v_mfma_f32_16x16x32_bf16 v[76:79],a[128:131],v[224:227],0
ds_read_b128 v[252:255],v17 offset:15360
buffer_load_dwordx4 v16,s[20:23],s65 offen offset:2048 sc1 lds
v_mfma_f32_16x16x32_bf16 v[68:71],a[4:7],v[228:231],v[68:71]
v_cmp_eq_u32 vcc,0,v27
s_cbranch_vccnz retry_239
v_mfma_f32_16x16x32_bf16 v[76:79],a[132:135],v[228:231],v[76:79]
ds_read_b128 v[224:227],v17 offset:17408
s_xor_b32 m0,s72,16384
s_waitcnt lgkmcnt(9)
v_mfma_f32_16x16x32_bf16 v[68:71],a[8:11],v[232:235],v[68:71]
s_add_u32 s65,s88,32768
v_min3_u32 v27,v27,v232,v236
s_waitcnt lgkmcnt(3)
v_mfma_f32_16x16x32_bf16 v[76:79],a[136:139],v[232:235],v[76:79]
ds_read_b128 v[228:231],v17 offset:19456
buffer_load_dwordx4 v16,s[20:23],s65 offen offset:0 sc1 lds
v_mfma_f32_16x16x32_bf16 v[68:71],a[12:15],v[236:239],v[68:71]
v_lshlrev_b32 v88,16,v120
v_and_b32 v89,s80,v120
v_lshlrev_b32 v90,16,v121
v_mfma_f32_16x16x32_bf16 v[76:79],a[140:143],v[236:239],v[76:79]
ds_read_b128 v[232:235],v17 offset:21504
v_and_b32 v91,s80,v121
v_mfma_f32_16x16x32_bf16 v[68:71],a[16:19],v[240:243],v[68:71]
buffer_load_dwordx4 v16,s[20:23],s65 offen offset:2048 sc1 lds
s_xor_b32 m0,s72,32768
v_mfma_f32_16x16x32_bf16 v[76:79],a[144:147],v[240:243],v[76:79]
ds_read_b128 v[236:239],v17 offset:23552
s_add_u32 s65,s88,65536
v_lshlrev_b32 v92,16,v122
v_mfma_f32_16x16x32_bf16 v[68:71],a[20:23],v[244:247],v[68:71]
v_min3_u32 v27,v27,v240,v244
v_and_b32 v93,s80,v122
v_lshlrev_b32 v94,16,v123
v_mfma_f32_16x16x32_bf16 v[76:79],a[148:151],v[244:247],v[76:79]
ds_read_b128 v[240:243],v17 offset:25600
v_and_b32 v95,s80,v123
s_waitcnt lgkmcnt(5)
v_mfma_f32_16x16x32_bf16 v[68:71],a[24:27],v[248:251],v[68:71]
buffer_load_dwordx4 v16,s[20:23],s65 offen offset:0 sc1 lds
v_add_f32 v88,v64,v88
v_mfma_f32_16x16x32_bf16 v[76:79],a[152:155],v[248:251],v[76:79]
ds_read_b128 v[244:247],v17 offset:27648
buffer_load_dwordx4 v16,s[20:23],s65 offen offset:2048 sc1 lds
v_mfma_f32_16x16x32_bf16 v[68:71],a[28:31],v[252:255],v[68:71]
s_xor_b32 m0,s72,49152
v_min3_u32 v27,v27,v248,v252
v_add_f32 v89,v65,v89
v_mfma_f32_16x16x32_bf16 v[76:79],a[156:159],v[252:255],v[76:79]
ds_read_b128 v[248:251],v17 offset:29696
s_add_u32 s65,s88,98304
s_waitcnt lgkmcnt(5)
v_mfma_f32_16x16x32_bf16 v[68:71],a[32:35],v[224:227],v[68:71]
buffer_load_dwordx4 v16,s[20:23],s65 offen offset:0 sc1 lds
v_add_f32 v90,v66,v90
v_mfma_f32_16x16x32_bf16 v[76:79],a[160:163],v[224:227],v[76:79]
ds_read_b128 v[252:255],v17 offset:31744
v_min3_u32 v27,v27,v224,v228
v_add_f32 v91,v67,v91
v_mfma_f32_16x16x32_bf16 v[68:71],a[36:39],v[228:231],v[68:71]
buffer_load_dwordx4 v16,s[20:23],s65 offen offset:2048 sc1 lds
v_add_f32 v92,v72,v92
v_mfma_f32_16x16x32_bf16 v[76:79],a[164:167],v[228:231],v[76:79]
ds_read_b128 v[224:227],v17 offset:33792
v_add_f32 v93,v73,v93
s_waitcnt lgkmcnt(5)
v_mfma_f32_16x16x32_bf16 v[68:71],a[40:43],v[232:235],v[68:71]
s_xor_b32 m0,s72,1024
s_add_u32 s65,s89,0
v_add_f32 v94,v74,v94
v_mfma_f32_16x16x32_bf16 v[76:79],a[168:171],v[232:235],v[76:79]
ds_read_b128 v[228:231],v17 offset:35840
v_min3_u32 v27,v27,v232,v236
v_add_f32 v95,v75,v95
v_mfma_f32_16x16x32_bf16 v[68:71],a[44:47],v[236:239],v[68:71]
buffer_load_dwordx4 v16,s[20:23],s65 offen offset:0 sc1 lds
v_cvt_pk_bf16_f32 v96,v88,v89
v_mfma_f32_16x16x32_bf16 v[76:79],a[172:175],v[236:239],v[76:79]
ds_read_b128 v[232:235],v17 offset:37888
v_cvt_pk_bf16_f32 v97,v90,v91
s_waitcnt lgkmcnt(5)
v_mfma_f32_16x16x32_bf16 v[68:71],a[48:51],v[240:243],v[68:71]
buffer_load_dwordx4 v16,s[20:23],s65 offen offset:2048 sc1 lds
v_cvt_pk_bf16_f32 v98,v92,v93
v_mfma_f32_16x16x32_bf16 v[76:79],a[176:179],v[240:243],v[76:79]
ds_read_b128 v[236:239],v17 offset:39936
s_xor_b32 m0,s72,17408
v_cvt_pk_bf16_f32 v99,v94,v95
v_mfma_f32_16x16x32_bf16 v[68:71],a[52:55],v[244:247],v[68:71]
s_add_u32 s65,s89,32768
v_min3_u32 v27,v27,v240,v244
v_max_u32 v96,1,v96
v_mfma_f32_16x16x32_bf16 v[76:79],a[180:183],v[244:247],v[76:79]
ds_read_b128 v[240:243],v17 offset:41984
s_waitcnt lgkmcnt(5)
v_mfma_f32_16x16x32_bf16 v[68:71],a[56:59],v[248:251],v[68:71]
buffer_load_dwordx4 v16,s[20:23],s65 offen offset:0 sc1 lds
v_mfma_f32_16x16x32_bf16 v[76:79],a[184:187],v[248:251],v[76:79]
ds_read_b128 v[244:247],v17 offset:44032
v_min3_u32 v27,v27,v248,v252
v_mfma_f32_16x16x32_bf16 v[68:71],a[60:63],v[252:255],v[68:71]
buffer_load_dwordx4 v16,s[20:23],s65 offen offset:2048 sc1 lds
v_mfma_f32_16x16x32_bf16 v[76:79],a[188:191],v[252:255],v[76:79]
ds_read_b128 v[248:251],v17 offset:46080
s_waitcnt lgkmcnt(5)
v_mfma_f32_16x16x32_bf16 v[68:71],a[64:67],v[224:227],v[68:71]
s_xor_b32 m0,s72,33792
s_add_u32 s65,s89,65536
v_mfma_f32_16x16x32_bf16 v[76:79],a[192:195],v[224:227],v[76:79]
ds_read_b128 v[252:255],v17 offset:48128
v_min3_u32 v27,v27,v224,v228
v_mfma_f32_16x16x32_bf16 v[68:71],a[68:71],v[228:231],v[68:71]
buffer_load_dwordx4 v16,s[20:23],s65 offen offset:0 sc1 lds
v_mfma_f32_16x16x32_bf16 v[76:79],a[196:199],v[228:231],v[76:79]
ds_read_b128 v[224:227],v17 offset:50176
s_waitcnt lgkmcnt(5)
v_mfma_f32_16x16x32_bf16 v[68:71],a[72:75],v[232:235],v[68:71]
buffer_load_dwordx4 v16,s[20:23],s65 offen offset:2048 sc1 lds
v_mfma_f32_16x16x32_bf16 v[76:79],a[200:203],v[232:235],v[76:79]
ds_read_b128 v[228:231],v17 offset:52224
s_xor_b32 m0,s72,50176
v_mfma_f32_16x16x32_bf16 v[68:71],a[76:79],v[236:239],v[68:71]
s_add_u32 s65,s89,98304
v_min3_u32 v27,v27,v232,v236
v_mfma_f32_16x16x32_bf16 v[76:79],a[204:207],v[236:239],v[76:79]
ds_read_b128 v[232:235],v17 offset:54272
s_waitcnt lgkmcnt(5)
v_mfma_f32_16x16x32_bf16 v[68:71],a[80:83],v[240:243],v[68:71]
buffer_load_dwordx4 v16,s[20:23],s65 offen offset:0 sc1 lds
v_mfma_f32_16x16x32_bf16 v[76:79],a[208:211],v[240:243],v[76:79]
ds_read_b128 v[236:239],v17 offset:56320
v_min3_u32 v27,v27,v240,v244
v_mfma_f32_16x16x32_bf16 v[68:71],a[84:87],v[244:247],v[68:71]
buffer_load_dwordx4 v16,s[20:23],s65 offen offset:2048 sc1 lds
v_mfma_f32_16x16x32_bf16 v[76:79],a[212:215],v[244:247],v[76:79]
ds_read_b128 v[240:243],v17 offset:58368
s_waitcnt lgkmcnt(5)
v_mfma_f32_16x16x32_bf16 v[68:71],a[88:91],v[248:251],v[68:71]
v_min3_u32 v27,v27,v248,v252
buffer_store_dwordx4 v[96:99],v18,s[20:23],s70 offen offset:0 sc1
v_mfma_f32_16x16x32_bf16 v[76:79],a[216:219],v[248:251],v[76:79]
ds_read_b128 v[244:247],v17 offset:60416
v_lshlrev_b32 v88,16,v96
v_and_b32 v89,s80,v96
v_mfma_f32_16x16x32_bf16 v[68:71],a[92:95],v[252:255],v[68:71]
v_lshlrev_b32 v90,16,v97
v_and_b32 v91,s80,v97
v_lshlrev_b32 v92,16,v98
v_mfma_f32_16x16x32_bf16 v[76:79],a[220:223],v[252:255],v[76:79]
ds_read_b128 v[248:251],v17 offset:62464
v_and_b32 v93,s80,v98
s_waitcnt lgkmcnt(5)
v_mfma_f32_16x16x32_bf16 v[68:71],a[96:99],v[224:227],v[68:71]
v_min3_u32 v27,v27,v224,v228
v_lshlrev_b32 v94,16,v99
v_and_b32 v95,s80,v99
v_mfma_f32_16x16x32_bf16 v[76:79],a[224:227],v[224:227],v[76:79]
ds_read_b128 v[252:255],v17 offset:64512
v_add_f32 v108,v88,v89
v_mul_f32 v109,v88,v88
v_mfma_f32_16x16x32_bf16 v[68:71],a[100:103],v[228:231],v[68:71]
v_add_f32 v100,v90,v91
v_mul_f32 v101,v89,v89
v_fmac_f32 v109,v90,v90
v_mfma_f32_16x16x32_bf16 v[76:79],a[228:231],v[228:231],v[76:79]
v_fmac_f32 v101,v91,v91
v_fmac_f32 v109,v92,v92
s_waitcnt lgkmcnt(4)
v_mfma_f32_16x16x32_bf16 v[68:71],a[104:107],v[232:235],v[68:71]
v_min3_u32 v27,v27,v232,v236
v_fmac_f32 v101,v93,v93
v_add_f32 v108,v108,v92
v_mfma_f32_16x16x32_bf16 v[76:79],a[232:235],v[232:235],v[76:79]
v_add_f32 v100,v100,v93
v_fmac_f32 v109,v94,v94
v_fmac_f32 v101,v95,v95
v_mfma_f32_16x16x32_bf16 v[68:71],a[108:111],v[236:239],v[68:71]
v_add_f32 v108,v108,v94
v_add_f32 v100,v100,v95
v_add_f32 v108,v108,v100
v_mfma_f32_16x16x32_bf16 v[76:79],a[236:239],v[236:239],v[76:79]
v_add_f32 v109,v109,v101
v_mov_b32 v100,v108
s_waitcnt lgkmcnt(2)
v_mfma_f32_16x16x32_bf16 v[68:71],a[112:115],v[240:243],v[68:71]
v_min3_u32 v27,v27,v240,v244
v_mov_b32 v101,v109
v_permlane16_swap_b32 v100,v108
v_mfma_f32_16x16x32_bf16 v[76:79],a[240:243],v[240:243],v[76:79]
v_permlane16_swap_b32 v101,v109
v_add_f32 v108,v108,v100
v_add_f32 v109,v109,v101
v_mfma_f32_16x16x32_bf16 v[68:71],a[116:119],v[244:247],v[68:71]
v_mov_b32 v100,v108
v_mov_b32 v101,v109
s_nop 0
v_permlane32_swap_b32 v100,v108
v_mfma_f32_16x16x32_bf16 v[76:79],a[244:247],v[244:247],v[76:79]
v_permlane32_swap_b32 v101,v109
v_add_f32 v108,v108,v100
s_waitcnt lgkmcnt(0)
v_mfma_f32_16x16x32_bf16 v[68:71],a[120:123],v[248:251],v[68:71]
v_min3_u32 v27,v27,v248,v252
v_add_f32 v109,v109,v101
v_min3_u32 v27,v27,v120,v122
v_mfma_f32_16x16x32_bf16 v[76:79],a[248:251],v[248:251],v[76:79]
v_min3_u32 v27,v27,v124,v126
v_lshlrev_b32 v32,16,v124
v_and_b32 v33,s80,v124
v_mfma_f32_16x16x32_bf16 v[68:71],a[124:127],v[252:255],v[68:71]
v_lshlrev_b32 v34,16,v125
v_and_b32 v35,s80,v125
v_lshlrev_b32 v36,16,v126
v_mfma_f32_16x16x32_bf16 v[76:79],a[252:255],v[252:255],v[76:79]
v_and_b32 v37,s80,v126
v_lshlrev_b32 v38,16,v127
v_and_b32 v39,s80,v127
v_cmp_eq_u32 vcc,0,v27
s_cbranch_vccnz retry_239
s_branch epi_242
keep_251:
v_mfma_f32_16x16x32_bf16 v[64:67],a[124:127],v[252:255],v[64:67]
v_min3_u32 v27,v27,v248,v252
ds_read_b64 v[126:127],v41 offset:1024
v_mfma_f32_16x16x32_bf16 v[72:75],a[252:255],v[252:255],v[72:75]
ds_read_b128 v[248:251],v17 offset:13312
s_waitcnt lgkmcnt(9)
v_mfma_f32_16x16x32_bf16 v[68:71],a[0:3],v[224:227],0
v_cmp_eq_u32 vcc,0,v27
s_cbranch_vccnz retry_239
v_mfma_f32_16x16x32_bf16 v[76:79],a[128:131],v[224:227],0
ds_read_b128 v[252:255],v17 offset:15360
v_min3_u32 v27,v27,v224,v228
v_mfma_f32_16x16x32_bf16 v[68:71],a[4:7],v[228:231],v[68:71]
v_mfma_f32_16x16x32_bf16 v[76:79],a[132:135],v[228:231],v[76:79]
ds_read_b128 v[224:227],v17 offset:17408
s_waitcnt lgkmcnt(9)
v_mfma_f32_16x16x32_bf16 v[68:71],a[8:11],v[232:235],v[68:71]
v_min3_u32 v27,v27,v232,v236
s_waitcnt lgkmcnt(3)
v_lshlrev_b32 v88,16,v120
v_mfma_f32_16x16x32_bf16 v[76:79],a[136:139],v[232:235],v[76:79]
ds_read_b128 v[228:231],v17 offset:19456
v_and_b32 v89,s80,v120
v_lshlrev_b32 v90,16,v121
v_mfma_f32_16x16x32_bf16 v[68:71],a[12:15],v[236:239],v[68:71]
v_and_b32 v91,s80,v121
v_lshlrev_b32 v92,16,v122
v_and_b32 v93,s80,v122
v_mfma_f32_16x16x32_bf16 v[76:79],a[140:143],v[236:239],v[76:79]
ds_read_b128 v[232:235],v17 offset:21504
v_lshlrev_b32 v94,16,v123
v_mfma_f32_16x16x32_bf16 v[68:71],a[16:19],v[240:243],v[68:71]
v_min3_u32 v27,v27,v240,v244
v_and_b32 v95,s80,v123
v_mfma_f32_16x16x32_bf16 v[76:79],a[144:147],v[240:243],v[76:79]
ds_read_b128 v[236:239],v17 offset:23552
v_add_f32 v88,v64,v88
v_mfma_f32_16x16x32_bf16 v[68:71],a[20:23],v[244:247],v[68:71]
v_add_f32 v89,v65,v89
v_add_f32 v90,v66,v90
v_mfma_f32_16x16x32_bf16 v[76:79],a[148:151],v[244:247],v[76:79]
ds_read_b128 v[240:243],v17 offset:25600
s_waitcnt lgkmcnt(5)
v_mfma_f32_16x16x32_bf16 v[68:71],a[24:27],v[248:251],v[68:71]
v_min3_u32 v27,v27,v248,v252
v_add_f32 v91,v67,v91
v_mfma_f32_16x16x32_bf16 v[76:79],a[152:155],v[248:251],v[76:79]
ds_read_b128 v[244:247],v17 offset:27648
v_add_f32 v92,v72,v92
v_mfma_f32_16x16x32_bf16 v[68:71],a[28:31],v[252:255],v[68:71]
v_add_f32 v93,v73,v93
v_add_f32 v94,v74,v94
v_mfma_f32_16x16x32_bf16 v[76:79],a[156:159],v[252:255],v[76:79]
ds_read_b128 v[248:251],v17 offset:29696
s_waitcnt lgkmcnt(5)
v_mfma_f32_16x16x32_bf16 v[68:71],a[32:35],v[224:227],v[68:71]
v_min3_u32 v27,v27,v224,v228
v_add_f32 v95,v75,v95
v_mfma_f32_16x16x32_bf16 v[76:79],a[160:163],v[224:227],v[76:79]
ds_read_b128 v[252:255],v17 offset:31744
v_cvt_pk_bf16_f32 v96,v88,v89
v_mfma_f32_16x16x32_bf16 v[68:71],a[36:39],v[228:231],v[68:71]
v_cvt_pk_bf16_f32 v97,v90,v91
v_cvt_pk_bf16_f32 v98,v92,v93
v_mfma_f32_16x16x32_bf16 v[76:79],a[164:167],v[228:231],v[76:79]
ds_read_b128 v[224:227],v17 offset:33792
s_waitcnt lgkmcnt(5)
v_mfma_f32_16x16x32_bf16 v[68:71],a[40:43],v[232:235],v[68:71]
v_min3_u32 v27,v27,v232,v236
v_cvt_pk_bf16_f32 v99,v94,v95
v_mfma_f32_16x16x32_bf16 v[76:79],a[168:171],v[232:235],v[76:79]
ds_read_b128 v[228:231],v17 offset:35840
v_max_u32 v96,1,v96
v_mfma_f32_16x16x32_bf16 v[68:71],a[44:47],v[236:239],v[68:71]
buffer_store_dwordx4 v[96:99],v18,s[20:23],s70 offen offset:0 sc1
v_mfma_f32_16x16x32_bf16 v[76:79],a[172:175],v[236:239],v[76:79]
ds_read_b128 v[232:235],v17 offset:37888
s_waitcnt lgkmcnt(5)
v_mfma_f32_16x16x32_bf16 v[68:71],a[48:51],v[240:243],v[68:71]
v_min3_u32 v27,v27,v240,v244
v_lshlrev_b32 v88,16,v96
v_mfma_f32_16x16x32_bf16 v[76:79],a[176:179],v[240:243],v[76:79]
ds_read_b128 v[236:239],v17 offset:39936
v_and_b32 v89,s80,v96
v_mfma_f32_16x16x32_bf16 v[68:71],a[52:55],v[244:247],v[68:71]
v_lshlrev_b32 v90,16,v97
v_and_b32 v91,s80,v97
v_mfma_f32_16x16x32_bf16 v[76:79],a[180:183],v[244:247],v[76:79]
ds_read_b128 v[240:243],v17 offset:41984
s_waitcnt lgkmcnt(5)
v_mfma_f32_16x16x32_bf16 v[68:71],a[56:59],v[248:251],v[68:71]
v_min3_u32 v27,v27,v248,v252
v_lshlrev_b32 v92,16,v98
v_mfma_f32_16x16x32_bf16 v[76:79],a[184:187],v[248:251],v[76:79]
ds_read_b128 v[244:247],v17 offset:44032
v_and_b32 v93,s80,v98
v_mfma_f32_16x16x32_bf16 v[68:71],a[60:63],v[252:255],v[68:71]
v_lshlrev_b32 v94,16,v99
v_and_b32 v95,s80,v99
v_mfma_f32_16x16x32_bf16 v[76:79],a[188:191],v[252:255],v[76:79]
ds_read_b128 v[248:251],v17 offset:46080
s_waitcnt lgkmcnt(5)
v_mfma_f32_16x16x32_bf16 v[68:71],a[64:67],v[224:227],v[68:71]
v_min3_u32 v27,v27,v224,v228
v_add_f32 v108,v88,v89
v_mfma_f32_16x16x32_bf16 v[76:79],a[192:195],v[224:227],v[76:79]
ds_read_b128 v[252:255],v17 offset:48128
v_mul_f32 v109,v88,v88
v_mfma_f32_16x16x32_bf16 v[68:71],a[68:71],v[228:231],v[68:71]
v_add_f32 v100,v90,v91
v_mul_f32 v101,v89,v89
v_mfma_f32_16x16x32_bf16 v[76:79],a[196:199],v[228:231],v[76:79]
ds_read_b128 v[224:227],v17 offset:50176
s_waitcnt lgkmcnt(5)
v_mfma_f32_16x16x32_bf16 v[68:71],a[72:75],v[232:235],v[68:71]
v_min3_u32 v27,v27,v232,v236
v_fmac_f32 v109,v90,v90
v_mfma_f32_16x16x32_bf16 v[76:79],a[200:203],v[232:235],v[76:79]
ds_read_b128 v[228:231],v17 offset:52224
v_fmac_f32 v101,v91,v91
v_mfma_f32_16x16x32_bf16 v[68:71],a[76:79],v[236:239],v[68:71]
v_fmac_f32 v109,v92,v92
v_fmac_f32 v101,v93,v93
v_mfma_f32_16x16x32_bf16 v[76:79],a[204:207],v[236:239],v[76:79]
ds_read_b128 v[232:235],v17 offset:54272
s_waitcnt lgkmcnt(5)
v_mfma_f32_16x16x32_bf16 v[68:71],a[80:83],v[240:243],v[68:71]
v_min3_u32 v27,v27,v240,v244
v_add_f32 v108,v108,v92
v_mfma_f32_16x16x32_bf16 v[76:79],a[208:211],v[240:243],v[76:79]
ds_read_b128 v[236:239],v17 offset:56320
v_add_f32 v100,v100,v93
v_mfma_f32_16x16x32_bf16 v[68:71],a[84:87],v[244:247],v[68:71]
v_fmac_f32 v109,v94,v94
v_fmac_f32 v101,v95,v95
v_mfma_f32_16x16x32_bf16 v[76:79],a[212:215],v[244:247],v[76:79]
ds_read_b128 v[240:243],v17 offset:58368
s_waitcnt lgkmcnt(5)
v_mfma_f32_16x16x32_bf16 v[68:71],a[88:91],v[248:251],v[68:71]
v_min3_u32 v27,v27,v248,v252
v_add_f32 v108,v108,v94
v_mfma_f32_16x16x32_bf16 v[76:79],a[216:219],v[248:251],v[76:79]
ds_read_b128 v[244:247],v17 offset:60416
v_add_f32 v100,v100,v95
v_mfma_f32_16x16x32_bf16 v[68:71],a[92:95],v[252:255],v[68:71]
v_add_f32 v108,v108,v100
v_add_f32 v109,v109,v101
v_mfma_f32_16x16x32_bf16 v[76:79],a[220:223],v[252:255],v[76:79]
ds_read_b128 v[248:251],v17 offset:62464
s_waitcnt lgkmcnt(5)
v_mfma_f32_16x16x32_bf16 v[68:71],a[96:99],v[224:227],v[68:71]
v_min3_u32 v27,v27,v224,v228
v_mov_b32 v100,v108
v_mfma_f32_16x16x32_bf16 v[76:79],a[224:227],v[224:227],v[76:79]
ds_read_b128 v[252:255],v17 offset:64512
v_mov_b32 v101,v109
v_mfma_f32_16x16x32_bf16 v[68:71],a[100:103],v[228:231],v[68:71]
v_permlane16_swap_b32 v100,v108
v_permlane16_swap_b32 v101,v109
v_mfma_f32_16x16x32_bf16 v[76:79],a[228:231],v[228:231],v[76:79]
v_add_f32 v108,v108,v100
s_waitcnt lgkmcnt(4)
v_mfma_f32_16x16x32_bf16 v[68:71],a[104:107],v[232:235],v[68:71]
v_min3_u32 v27,v27,v232,v236
v_add_f32 v109,v109,v101
v_mfma_f32_16x16x32_bf16 v[76:79],a[232:235],v[232:235],v[76:79]
v_mov_b32 v100,v108
v_mov_b32 v101,v109
v_mfma_f32_16x16x32_bf16 v[68:71],a[108:111],v[236:239],v[68:71]
v_permlane32_swap_b32 v100,v108
v_permlane32_swap_b32 v101,v109
v_mfma_f32_16x16x32_bf16 v[76:79],a[236:239],v[236:239],v[76:79]
v_add_f32 v108,v108,v100
s_waitcnt lgkmcnt(2)
v_mfma_f32_16x16x32_bf16 v[68:71],a[112:115],v[240:243],v[68:71]
v_min3_u32 v27,v27,v240,v244
v_add_f32 v109,v109,v101
v_mfma_f32_16x16x32_bf16 v[76:79],a[240:243],v[240:243],v[76:79]
v_min3_u32 v27,v27,v120,v122
v_min3_u32 v27,v27,v124,v126
v_mfma_f32_16x16x32_bf16 v[68:71],a[116:119],v[244:247],v[68:71]
v_lshlrev_b32 v32,16,v124
v_and_b32 v33,s80,v124
v_mfma_f32_16x16x32_bf16 v[76:79],a[244:247],v[244:247],v[76:79]
v_lshlrev_b32 v34,16,v125
s_waitcnt lgkmcnt(0)
v_mfma_f32_16x16x32_bf16 v[68:71],a[120:123],v[248:251],v[68:71]
v_min3_u32 v27,v27,v248,v252
v_and_b32 v35,s80,v125
v_mfma_f32_16x16x32_bf16 v[76:79],a[248:251],v[248:251],v[76:79]
v_lshlrev_b32 v36,16,v126
v_and_b32 v37,s80,v126
v_mfma_f32_16x16x32_bf16 v[68:71],a[124:127],v[252:255],v[68:71]
v_lshlrev_b32 v38,16,v127
v_and_b32 v39,s80,v127
v_mfma_f32_16x16x32_bf16 v[76:79],a[252:255],v[252:255],v[76:79]
v_cmp_eq_u32 vcc,0,v27
s_cbranch_vccnz retry_239
s_branch epi_242
both_243:
s_waitcnt vmcnt(13) lgkmcnt(0)
s_barrier
ds_read_b128 v[224:227],v17 offset:0
ds_read_b128 v[228:231],v17 offset:2048
ds_read_b128 v[232:235],v17 offset:4096
ds_read_b128 v[236:239],v17 offset:6144
ds_read_b128 v[240:243],v17 offset:8192
ds_read_b128 v[244:247],v17 offset:10240
ds_read_b128 v[248:251],v17 offset:12288
s_waitcnt lgkmcnt(5)
v_mfma_f32_16x16x32_bf16 v[64:67],a[0:3],v[224:227],0
s_add_u32 s96,s71,1
s_add_u32 s92,s71,2
s_add_u32 s88,s70,s75
v_min_u32 v27,v224,v228
s_add_u32 m0,s43,0
v_mfma_f32_16x16x32_bf16 v[72:75],a[128:131],v[224:227],0
ds_read_b128 v[252:255],v17 offset:14336
s_cmp_eq_u32 s96,64
s_cselect_b32 s96,99,s96
buffer_load_dwordx4 v19,s[20:23],s78 offen sc1 lds
v_mfma_f32_16x16x32_bf16 v[64:67],a[4:7],v[228:231],v[64:67]
s_cmp_eq_u32 s92,64
s_cselect_b32 s92,99,s92
s_add_u32 s88,s88,2097152
s_add_u32 m0,s43,1024
v_mfma_f32_16x16x32_bf16 v[72:75],a[132:135],v[228:231],v[72:75]
ds_read_b128 v[224:227],v17 offset:16384
s_xor_b32 s88,s88,0x2000
buffer_load_dwordx4 v20,s[20:23],s78 offen sc1 lds
s_waitcnt lgkmcnt(5)
v_mfma_f32_16x16x32_bf16 v[64:67],a[8:11],v[232:235],v[64:67]
s_cmp_eq_u32 s96,65
s_cselect_b32 s96,64,s96
v_mfma_f32_16x16x32_bf16 v[72:75],a[136:139],v[232:235],v[72:75]
ds_read_b128 v[228:231],v17 offset:18432
s_xor_b32 s89,s88,1024
v_mfma_f32_16x16x32_bf16 v[64:67],a[12:15],v[236:239],v[64:67]
s_xor_b32 m0,s72,0
v_min3_u32 v27,v27,v232,v236
v_mfma_f32_16x16x32_bf16 v[72:75],a[140:143],v[236:239],v[72:75]
ds_read_b128 v[232:235],v17 offset:20480
s_add_u32 s65,s88,0
s_waitcnt lgkmcnt(5)
v_mfma_f32_16x16x32_bf16 v[64:67],a[16:19],v[240:243],v[64:67]
v_min3_u32 v27,v27,v240,v244
v_mfma_f32_16x16x32_bf16 v[72:75],a[144:147],v[240:243],v[72:75]
ds_read_b128 v[236:239],v17 offset:22528
buffer_load_dwordx4 v16,s[20:23],s65 offen offset:0 sc1 lds
v_mfma_f32_16x16x32_bf16 v[64:67],a[20:23],v[244:247],v[64:67]
buffer_load_dwordx4 v16,s[20:23],s65 offen offset:2048 sc1 lds
v_mfma_f32_16x16x32_bf16 v[72:75],a[148:151],v[244:247],v[72:75]
ds_read_b128 v[240:243],v17 offset:24576
s_waitcnt lgkmcnt(5)
v_mfma_f32_16x16x32_bf16 v[64:67],a[24:27],v[248:251],v[64:67]
s_xor_b32 m0,s72,16384
v_min3_u32 v27,v27,v248,v252
v_mfma_f32_16x16x32_bf16 v[72:75],a[152:155],v[248:251],v[72:75]
ds_read_b128 v[244:247],v17 offset:26624
v_mfma_f32_16x16x32_bf16 v[64:67],a[28:31],v[252:255],v[64:67]
s_add_u32 s65,s88,32768
v_mfma_f32_16x16x32_bf16 v[72:75],a[156:159],v[252:255],v[72:75]
ds_read_b128 v[248:251],v17 offset:28672
s_waitcnt lgkmcnt(5)
v_mfma_f32_16x16x32_bf16 v[64:67],a[32:35],v[224:227],v[64:67]
buffer_load_dwordx4 v16,s[20:23],s65 offen offset:0 sc1 lds
v_mfma_f32_16x16x32_bf16 v[72:75],a[160:163],v[224:227],v[72:75]
ds_read_b128 v[252:255],v17 offset:30720
buffer_load_dwordx4 v16,s[20:23],s65 offen offset:2048 sc1 lds
v_mfma_f32_16x16x32_bf16 v[64:67],a[36:39],v[228:231],v[64:67]
v_min3_u32 v27,v27,v224,v228
v_mfma_f32_16x16x32_bf16 v[72:75],a[164:167],v[228:231],v[72:75]
ds_read_b128 v[224:227],v17 offset:32768
s_xor_b32 m0,s72,32768
s_waitcnt lgkmcnt(5)
v_mfma_f32_16x16x32_bf16 v[64:67],a[40:43],v[232:235],v[64:67]
s_add_u32 s65,s88,65536
v_min3_u32 v27,v27,v232,v236
v_mfma_f32_16x16x32_bf16 v[72:75],a[168:171],v[232:235],v[72:75]
ds_read_b128 v[228:231],v17 offset:34816
v_mfma_f32_16x16x32_bf16 v[64:67],a[44:47],v[236:239],v[64:67]
buffer_load_dwordx4 v16,s[20:23],s65 offen offset:0 sc1 lds
v_mfma_f32_16x16x32_bf16 v[72:75],a[172:175],v[236:239],v[72:75]
ds_read_b128 v[232:235],v17 offset:36864
s_waitcnt lgkmcnt(5)
v_mfma_f32_16x16x32_bf16 v[64:67],a[48:51],v[240:243],v[64:67]
buffer_load_dwordx4 v16,s[20:23],s65 offen offset:2048 sc1 lds
v_mfma_f32_16x16x32_bf16 v[72:75],a[176:179],v[240:243],v[72:75]
ds_read_b128 v[236:239],v17 offset:38912
s_xor_b32 m0,s72,49152
v_mfma_f32_16x16x32_bf16 v[64:67],a[52:55],v[244:247],v[64:67]
v_min3_u32 v27,v27,v240,v244
v_mfma_f32_16x16x32_bf16 v[72:75],a[180:183],v[244:247],v[72:75]
ds_read_b128 v[240:243],v17 offset:40960
s_add_u32 s65,s88,98304
s_waitcnt lgkmcnt(5)
v_mfma_f32_16x16x32_bf16 v[64:67],a[56:59],v[248:251],v[64:67]
buffer_load_dwordx4 v16,s[20:23],s65 offen offset:0 sc1 lds
v_min3_u32 v27,v27,v248,v252
v_mfma_f32_16x16x32_bf16 v[72:75],a[184:187],v[248:251],v[72:75]
ds_read_b128 v[244:247],v17 offset:43008
s_waitcnt vmcnt(12)
v_mfma_f32_16x16x32_bf16 v[64:67],a[60:63],v[252:255],v[64:67]
v_cmp_gt_u32 vcc,s96,v29
v_cmp_gt_u32 s[92:93],s92,v29
v_mfma_f32_16x16x32_bf16 v[72:75],a[188:191],v[252:255],v[72:75]
ds_read_b128 v[248:251],v17 offset:45056
s_waitcnt lgkmcnt(5)
v_mfma_f32_16x16x32_bf16 v[64:67],a[64:67],v[224:227],v[64:67]
v_mov_b32 v44,vcc_lo
v_mov_b32 v45,s92
v_min3_u32 v27,v27,v224,v228
v_mfma_f32_16x16x32_bf16 v[72:75],a[192:195],v[224:227],v[72:75]
ds_read_b128 v[252:255],v17 offset:47104
ds_write_b64 v46,v[44:45]
v_mfma_f32_16x16x32_bf16 v[64:67],a[68:71],v[228:231],v[64:67]
buffer_load_dwordx4 v16,s[20:23],s65 offen offset:2048 sc1 lds
v_mfma_f32_16x16x32_bf16 v[72:75],a[196:199],v[228:231],v[72:75]
ds_read_b128 v[224:227],v17 offset:49152
s_waitcnt lgkmcnt(6)
v_mfma_f32_16x16x32_bf16 v[64:67],a[72:75],v[232:235],v[64:67]
s_xor_b32 m0,s72,1024
s_add_u32 s65,s89,0
v_mfma_f32_16x16x32_bf16 v[72:75],a[200:203],v[232:235],v[72:75]
ds_read_b128 v[228:231],v17 offset:51200
v_min3_u32 v27,v27,v232,v236
v_mfma_f32_16x16x32_bf16 v[64:67],a[76:79],v[236:239],v[64:67]
buffer_load_dwordx4 v16,s[20:23],s65 offen offset:0 sc1 lds
v_mfma_f32_16x16x32_bf16 v[72:75],a[204:207],v[236:239],v[72:75]
ds_read_b128 v[232:235],v17 offset:53248
s_waitcnt lgkmcnt(6)
v_mfma_f32_16x16x32_bf16 v[64:67],a[80:83],v[240:243],v[64:67]
buffer_load_dwordx4 v16,s[20:23],s65 offen offset:2048 sc1 lds
v_mfma_f32_16x16x32_bf16 v[72:75],a[208:211],v[240:243],v[72:75]
ds_read_b128 v[236:239],v17 offset:55296
s_xor_b32 m0,s72,17408
v_mfma_f32_16x16x32_bf16 v[64:67],a[84:87],v[244:247],v[64:67]
s_add_u32 s65,s89,32768
v_min3_u32 v27,v27,v240,v244
v_mfma_f32_16x16x32_bf16 v[72:75],a[212:215],v[244:247],v[72:75]
ds_read_b128 v[240:243],v17 offset:57344
s_waitcnt lgkmcnt(6)
v_mfma_f32_16x16x32_bf16 v[64:67],a[88:91],v[248:251],v[64:67]
buffer_load_dwordx4 v16,s[20:23],s65 offen offset:0 sc1 lds
v_mfma_f32_16x16x32_bf16 v[72:75],a[216:219],v[248:251],v[72:75]
ds_read_b128 v[244:247],v17 offset:59392
v_min3_u32 v27,v27,v248,v252
v_mfma_f32_16x16x32_bf16 v[64:67],a[92:95],v[252:255],v[64:67]
buffer_load_dwordx4 v16,s[20:23],s65 offen offset:2048 sc1 lds
v_mfma_f32_16x16x32_bf16 v[72:75],a[220:223],v[252:255],v[72:75]
ds_read_b128 v[248:251],v17 offset:61440
s_waitcnt lgkmcnt(5)
v_mfma_f32_16x16x32_bf16 v[64:67],a[96:99],v[224:227],v[64:67]
s_xor_b32 m0,s72,33792
s_add_u32 s65,s89,65536
v_mfma_f32_16x16x32_bf16 v[72:75],a[224:227],v[224:227],v[72:75]
ds_read_b128 v[252:255],v17 offset:63488
v_min3_u32 v27,v27,v224,v228
v_mfma_f32_16x16x32_bf16 v[64:67],a[100:103],v[228:231],v[64:67]
buffer_load_dwordx4 v16,s[20:23],s65 offen offset:0 sc1 lds
s_waitcnt vmcnt(15)
v_add_u32 v22,s71,-1
v_mfma_f32_16x16x32_bf16 v[72:75],a[228:231],v[228:231],v[72:75]
s_waitcnt vmcnt(20)
s_barrier
ds_read_b64 v[44:45],v47
ds_read_b128 v[224:227],v17 offset:1024
s_waitcnt lgkmcnt(6)
v_mfma_f32_16x16x32_bf16 v[64:67],a[104:107],v[232:235],v[64:67]
buffer_load_dwordx4 v16,s[20:23],s65 offen offset:2048 sc1 lds
buffer_store_dword v22,v23,s[20:23],s97 offen sc1
v_mfma_f32_16x16x32_bf16 v[72:75],a[232:235],v[232:235],v[72:75]
ds_read_b128 v[228:231],v17 offset:3072
s_xor_b32 m0,s72,50176
s_mov_b32 s97,0x7fff0000
v_mfma_f32_16x16x32_bf16 v[64:67],a[108:111],v[236:239],v[64:67]
s_add_u32 s65,s89,98304
v_min3_u32 v27,v27,v232,v236
s_waitcnt vmcnt(15)
v_mfma_f32_16x16x32_bf16 v[72:75],a[236:239],v[236:239],v[72:75]
ds_read_b128 v[232:235],v17 offset:5120
ds_read_b64 v[120:121],v40 offset:0
s_waitcnt lgkmcnt(7)
v_mfma_f32_16x16x32_bf16 v[64:67],a[112:115],v[240:243],v[64:67]
buffer_load_dwordx4 v16,s[20:23],s65 offen offset:0 sc1 lds
ds_read_b64 v[122:123],v41 offset:0
v_mfma_f32_16x16x32_bf16 v[72:75],a[240:243],v[240:243],v[72:75]
ds_read_b128 v[236:239],v17 offset:7168
v_min3_u32 v27,v27,v240,v244
v_mfma_f32_16x16x32_bf16 v[64:67],a[116:119],v[244:247],v[64:67]
buffer_load_dwordx4 v16,s[20:23],s65 offen offset:2048 sc1 lds
v_mfma_f32_16x16x32_bf16 v[72:75],a[244:247],v[244:247],v[72:75]
ds_read_b128 v[240:243],v17 offset:9216
s_waitcnt lgkmcnt(8)
v_mfma_f32_16x16x32_bf16 v[64:67],a[120:123],v[248:251],v[64:67]
s_waitcnt lgkmcnt(7)
v_readfirstlane_b32 s93,v45
v_mfma_f32_16x16x32_bf16 v[72:75],a[248:251],v[248:251],v[72:75]
ds_read_b128 v[244:247],v17 offset:11264
v_min3_u32 v27,v27,v248,v252
v_mfma_f32_16x16x32_bf16 v[64:67],a[124:127],v[252:255],v[64:67]
ds_read_b64 v[124:125],v40 offset:1024
ds_read_b64 v[126:127],v41 offset:1024
v_mfma_f32_16x16x32_bf16 v[72:75],a[252:255],v[252:255],v[72:75]
ds_read_b128 v[248:251],v17 offset:13312
s_waitcnt lgkmcnt(9)
v_mfma_f32_16x16x32_bf16 v[68:71],a[0:3],v[224:227],0
v_cmp_eq_u32 vcc,0,v27
s_cbranch_vccnz retry_239
v_mfma_f32_16x16x32_bf16 v[76:79],a[128:131],v[224:227],0
ds_read_b128 v[252:255],v17 offset:15360
v_min3_u32 v27,v27,v224,v228
v_mfma_f32_16x16x32_bf16 v[68:71],a[4:7],v[228:231],v[68:71]
v_mfma_f32_16x16x32_bf16 v[76:79],a[132:135],v[228:231],v[76:79]
ds_read_b128 v[224:227],v17 offset:17408
s_waitcnt lgkmcnt(7)
v_mfma_f32_16x16x32_bf16 v[68:71],a[8:11],v[232:235],v[68:71]
v_min3_u32 v27,v27,v232,v236
s_waitcnt lgkmcnt(3)
v_lshlrev_b32 v88,16,v120
v_mfma_f32_16x16x32_bf16 v[76:79],a[136:139],v[232:235],v[76:79]
ds_read_b128 v[228:231],v17 offset:19456
v_and_b32 v89,s80,v120
v_lshlrev_b32 v90,16,v121
v_mfma_f32_16x16x32_bf16 v[68:71],a[12:15],v[236:239],v[68:71]
v_and_b32 v91,s80,v121
v_lshlrev_b32 v92,16,v122
v_and_b32 v93,s80,v122
v_mfma_f32_16x16x32_bf16 v[76:79],a[140:143],v[236:239],v[76:79]
ds_read_b128 v[232:235],v17 offset:21504
v_lshlrev_b32 v94,16,v123
v_mfma_f32_16x16x32_bf16 v[68:71],a[16:19],v[240:243],v[68:71]
v_min3_u32 v27,v27,v240,v244
v_and_b32 v95,s80,v123
v_mfma_f32_16x16x32_bf16 v[76:79],a[144:147],v[240:243],v[76:79]
ds_read_b128 v[236:239],v17 offset:23552
v_add_f32 v88,v64,v88
v_mfma_f32_16x16x32_bf16 v[68:71],a[20:23],v[244:247],v[68:71]
v_add_f32 v89,v65,v89
v_add_f32 v90,v66,v90
v_mfma_f32_16x16x32_bf16 v[76:79],a[148:151],v[244:247],v[76:79]
ds_read_b128 v[240:243],v17 offset:25600
s_waitcnt lgkmcnt(5)
v_mfma_f32_16x16x32_bf16 v[68:71],a[24:27],v[248:251],v[68:71]
v_min3_u32 v27,v27,v248,v252
v_add_f32 v91,v67,v91
v_mfma_f32_16x16x32_bf16 v[76:79],a[152:155],v[248:251],v[76:79]
ds_read_b128 v[244:247],v17 offset:27648
v_add_f32 v92,v72,v92
v_mfma_f32_16x16x32_bf16 v[68:71],a[28:31],v[252:255],v[68:71]
v_add_f32 v93,v73,v93
v_add_f32 v94,v74,v94
v_mfma_f32_16x16x32_bf16 v[76:79],a[156:159],v[252:255],v[76:79]
ds_read_b128 v[248:251],v17 offset:29696
s_waitcnt lgkmcnt(5)
v_mfma_f32_16x16x32_bf16 v[68:71],a[32:35],v[224:227],v[68:71]
v_min3_u32 v27,v27,v224,v228
v_add_f32 v95,v75,v95
v_mfma_f32_16x16x32_bf16 v[76:79],a[160:163],v[224:227],v[76:79]
ds_read_b128 v[252:255],v17 offset:31744
v_cvt_pk_bf16_f32 v96,v88,v89
v_mfma_f32_16x16x32_bf16 v[68:71],a[36:39],v[228:231],v[68:71]
v_cvt_pk_bf16_f32 v97,v90,v91
v_cvt_pk_bf16_f32 v98,v92,v93
v_mfma_f32_16x16x32_bf16 v[76:79],a[164:167],v[228:231],v[76:79]
ds_read_b128 v[224:227],v17 offset:33792
s_waitcnt lgkmcnt(5)
v_mfma_f32_16x16x32_bf16 v[68:71],a[40:43],v[232:235],v[68:71]
v_min3_u32 v27,v27,v232,v236
v_cvt_pk_bf16_f32 v99,v94,v95
v_mfma_f32_16x16x32_bf16 v[76:79],a[168:171],v[232:235],v[76:79]
ds_read_b128 v[228:231],v17 offset:35840
v_max_u32 v96,1,v96
v_mfma_f32_16x16x32_bf16 v[68:71],a[44:47],v[236:239],v[68:71]
buffer_store_dwordx4 v[96:99],v18,s[20:23],s70 offen offset:0 sc1
v_mfma_f32_16x16x32_bf16 v[76:79],a[172:175],v[236:239],v[76:79]
ds_read_b128 v[232:235],v17 offset:37888
s_waitcnt lgkmcnt(5)
v_mfma_f32_16x16x32_bf16 v[68:71],a[48:51],v[240:243],v[68:71]
v_min3_u32 v27,v27,v240,v244
v_lshlrev_b32 v88,16,v96
v_mfma_f32_16x16x32_bf16 v[76:79],a[176:179],v[240:243],v[76:79]
ds_read_b128 v[236:239],v17 offset:39936
v_and_b32 v89,s80,v96
v_mfma_f32_16x16x32_bf16 v[68:71],a[52:55],v[244:247],v[68:71]
v_lshlrev_b32 v90,16,v97
v_and_b32 v91,s80,v97
v_mfma_f32_16x16x32_bf16 v[76:79],a[180:183],v[244:247],v[76:79]
ds_read_b128 v[240:243],v17 offset:41984
s_waitcnt lgkmcnt(5)
v_mfma_f32_16x16x32_bf16 v[68:71],a[56:59],v[248:251],v[68:71]
v_min3_u32 v27,v27,v248,v252
v_lshlrev_b32 v92,16,v98
v_mfma_f32_16x16x32_bf16 v[76:79],a[184:187],v[248:251],v[76:79]
ds_read_b128 v[244:247],v17 offset:44032
v_and_b32 v93,s80,v98
v_mfma_f32_16x16x32_bf16 v[68:71],a[60:63],v[252:255],v[68:71]
v_lshlrev_b32 v94,16,v99
v_and_b32 v95,s80,v99
v_mfma_f32_16x16x32_bf16 v[76:79],a[188:191],v[252:255],v[76:79]
ds_read_b128 v[248:251],v17 offset:46080
s_waitcnt lgkmcnt(5)
v_mfma_f32_16x16x32_bf16 v[68:71],a[64:67],v[224:227],v[68:71]
v_min3_u32 v27,v27,v224,v228
v_add_f32 v108,v88,v89
v_mfma_f32_16x16x32_bf16 v[76:79],a[192:195],v[224:227],v[76:79]
ds_read_b128 v[252:255],v17 offset:48128
v_mul_f32 v109,v88,v88
v_mfma_f32_16x16x32_bf16 v[68:71],a[68:71],v[228:231],v[68:71]
v_add_f32 v100,v90,v91
v_mul_f32 v101,v89,v89
v_mfma_f32_16x16x32_bf16 v[76:79],a[196:199],v[228:231],v[76:79]
ds_read_b128 v[224:227],v17 offset:50176
s_waitcnt lgkmcnt(5)
v_mfma_f32_16x16x32_bf16 v[68:71],a[72:75],v[232:235],v[68:71]
v_min3_u32 v27,v27,v232,v236
v_fmac_f32 v109,v90,v90
v_mfma_f32_16x16x32_bf16 v[76:79],a[200:203],v[232:235],v[76:79]
ds_read_b128 v[228:231],v17 offset:52224
v_fmac_f32 v101,v91,v91
v_mfma_f32_16x16x32_bf16 v[68:71],a[76:79],v[236:239],v[68:71]
v_fmac_f32 v109,v92,v92
v_fmac_f32 v101,v93,v93
v_mfma_f32_16x16x32_bf16 v[76:79],a[204:207],v[236:239],v[76:79]
ds_read_b128 v[232:235],v17 offset:54272
s_waitcnt lgkmcnt(5)
v_mfma_f32_16x16x32_bf16 v[68:71],a[80:83],v[240:243],v[68:71]
v_min3_u32 v27,v27,v240,v244
v_add_f32 v108,v108,v92
v_mfma_f32_16x16x32_bf16 v[76:79],a[208:211],v[240:243],v[76:79]
ds_read_b128 v[236:239],v17 offset:56320
v_add_f32 v100,v100,v93
v_mfma_f32_16x16x32_bf16 v[68:71],a[84:87],v[244:247],v[68:71]
v_fmac_f32 v109,v94,v94
v_fmac_f32 v101,v95,v95
v_mfma_f32_16x16x32_bf16 v[76:79],a[212:215],v[244:247],v[76:79]
ds_read_b128 v[240:243],v17 offset:58368
s_waitcnt lgkmcnt(5)
v_mfma_f32_16x16x32_bf16 v[68:71],a[88:91],v[248:251],v[68:71]
v_min3_u32 v27,v27,v248,v252
v_add_f32 v108,v108,v94
v_mfma_f32_16x16x32_bf16 v[76:79],a[216:219],v[248:251],v[76:79]
ds_read_b128 v[244:247],v17 offset:60416
v_add_f32 v100,v100,v95
v_mfma_f32_16x16x32_bf16 v[68:71],a[92:95],v[252:255],v[68:71]
v_add_f32 v108,v108,v100
v_add_f32 v109,v109,v101
v_mfma_f32_16x16x32_bf16 v[76:79],a[220:223],v[252:255],v[76:79]
ds_read_b128 v[248:251],v17 offset:62464
s_waitcnt lgkmcnt(5)
v_mfma_f32_16x16x32_bf16 v[68:71],a[96:99],v[224:227],v[68:71]
v_min3_u32 v27,v27,v224,v228
v_mov_b32 v100,v108
v_mfma_f32_16x16x32_bf16 v[76:79],a[224:227],v[224:227],v[76:79]
ds_read_b128 v[252:255],v17 offset:64512
v_mov_b32 v101,v109
v_mfma_f32_16x16x32_bf16 v[68:71],a[100:103],v[228:231],v[68:71]
v_permlane16_swap_b32 v100,v108
v_permlane16_swap_b32 v101,v109
v_mfma_f32_16x16x32_bf16 v[76:79],a[228:231],v[228:231],v[76:79]
v_add_f32 v108,v108,v100
s_waitcnt lgkmcnt(4)
v_mfma_f32_16x16x32_bf16 v[68:71],a[104:107],v[232:235],v[68:71]
v_min3_u32 v27,v27,v232,v236
v_add_f32 v109,v109,v101
v_mfma_f32_16x16x32_bf16 v[76:79],a[232:235],v[232:235],v[76:79]
v_mov_b32 v100,v108
v_mov_b32 v101,v109
v_mfma_f32_16x16x32_bf16 v[68:71],a[108:111],v[236:239],v[68:71]
v_permlane32_swap_b32 v100,v108
v_permlane32_swap_b32 v101,v109
v_mfma_f32_16x16x32_bf16 v[76:79],a[236:239],v[236:239],v[76:79]
v_add_f32 v108,v108,v100
s_waitcnt lgkmcnt(2)
v_mfma_f32_16x16x32_bf16 v[68:71],a[112:115],v[240:243],v[68:71]
v_min3_u32 v27,v27,v240,v244
v_add_f32 v109,v109,v101
v_mfma_f32_16x16x32_bf16 v[76:79],a[240:243],v[240:243],v[76:79]
v_min3_u32 v27,v27,v120,v122
v_min3_u32 v27,v27,v124,v126
v_mfma_f32_16x16x32_bf16 v[68:71],a[116:119],v[244:247],v[68:71]
v_lshlrev_b32 v32,16,v124
v_and_b32 v33,s80,v124
v_mfma_f32_16x16x32_bf16 v[76:79],a[244:247],v[244:247],v[76:79]
v_lshlrev_b32 v34,16,v125
s_waitcnt lgkmcnt(0)
v_mfma_f32_16x16x32_bf16 v[68:71],a[120:123],v[248:251],v[68:71]
v_min3_u32 v27,v27,v248,v252
v_and_b32 v35,s80,v125
v_mfma_f32_16x16x32_bf16 v[76:79],a[248:251],v[248:251],v[76:79]
v_lshlrev_b32 v36,16,v126
v_and_b32 v37,s80,v126
v_mfma_f32_16x16x32_bf16 v[68:71],a[124:127],v[252:255],v[68:71]
v_lshlrev_b32 v38,16,v127
v_and_b32 v39,s80,v127
v_mfma_f32_16x16x32_bf16 v[76:79],a[252:255],v[252:255],v[76:79]
v_cmp_eq_u32 vcc,0,v27
s_cbranch_vccnz retry_239
epi_242:
buffer_load_dword v29,v21,s[20:23],s87 offen sc1
s_cmp_gt_u32 s71,40
s_cselect_b32 s65,s73,0x7fff0000
s_cselect_b32 s97,0x7fff0000,s73
v_mov_b32 v22,s71
buffer_store_dword v22,v23,s[20:23],s65 offen sc1
v_pk_add_f32 v[88:89],v[68:69],v[32:33]
v_pk_add_f32 v[90:91],v[70:71],v[34:35]
v_pk_add_f32 v[92:93],v[76:77],v[36:37]
v_pk_add_f32 v[94:95],v[78:79],v[38:39]
v_cvt_pk_bf16_f32 v96,v88,v89
v_cvt_pk_bf16_f32 v97,v90,v91
v_cvt_pk_bf16_f32 v98,v92,v93
v_cvt_pk_bf16_f32 v99,v94,v95
v_max_u32 v96,1,v96
buffer_store_dwordx4 v[96:99],v18,s[20:23],s70 offen offset:1024 sc1
v_lshlrev_b32 v88,16,v96
v_and_b32 v89,s80,v96
v_lshlrev_b32 v90,16,v97
v_and_b32 v91,s80,v97
v_lshlrev_b32 v92,16,v98
v_and_b32 v93,s80,v98
v_lshlrev_b32 v94,16,v99
v_and_b32 v95,s80,v99
v_pk_mul_f32 v[102:103],v[88:89],v[88:89]
v_pk_add_f32 v[100:101],v[88:89],v[90:91]
v_pk_mul_f32 v[106:107],v[90:91],v[90:91]
v_pk_add_f32 v[104:105],v[92:93],v[94:95]
v_pk_fma_f32 v[102:103],v[92:93],v[92:93],v[102:103]
v_pk_fma_f32 v[106:107],v[94:95],v[94:95],v[106:107]
v_pk_add_f32 v[100:101],v[100:101],v[104:105]
v_pk_add_f32 v[102:103],v[102:103],v[106:107]
v_add_f32 v110,v100,v101
v_add_f32 v111,v102,v103
v_mov_b32 v100,v110
v_mov_b32 v101,v111
s_nop 0
v_permlane16_swap_b32 v100,v110
v_permlane16_swap_b32 v101,v111
v_add_f32 v110,v110,v100
v_add_f32 v111,v111,v101
v_mov_b32 v100,v110
v_mov_b32 v101,v111
s_nop 0
v_permlane32_swap_b32 v100,v110
v_permlane32_swap_b32 v101,v111
v_add_f32 v110,v110,v100
v_add_f32 v111,v111,v101
v_max_u32 v109,1,v109
buffer_store_dwordx4 v[108:111],v24,s[20:23],s70 offen sc1
s_cmp_eq_u32 s71,63
s_cselect_b32 s64,0,0x2000
s_cselect_b32 s66,2,1
s_lshl_b32 s66,s66,21
s_add_u32 s78,s78,s66
v_xor_b32 v19,s64,v19
v_xor_b32 v20,s64,v20
next_249:
v_xor_b32 v17,0x10000,v17
s_xor_b32 s72,s72,0x10000
s_add_u32 s70,s70,2097152
s_xor_b32 s70,s70,0x2000
s_add_u32 s71,s71,1
s_cmp_le_u32 s71,s57
s_cbranch_scc1 seg_240
s_endpgm
retry_239:
s_sub_u32 s90,s90,64
s_cmp_lt_i32 s90,0
s_cbranch_scc1 giveup_197
s_mov_b32 s83,1
s_waitcnt vmcnt(0) lgkmcnt(0)
s_barrier
s_branch seg_240
half_248:
s_mov_b32 s88,s94
s_mov_b32 s89,s95
s_add_u32 s94,s94,2097152
s_xor_b32 s94,s94,0x2000
s_xor_b32 s95,s94,1024
s_mov_b64 exec,s[52:53]
s_xor_b32 m0,s91,0
s_add_u32 s65,s94,0
buffer_load_dwordx4 v16,s[20:23],s65 offen offset:0 sc1 lds
buffer_load_dwordx4 v16,s[20:23],s65 offen offset:2048 sc1 lds
s_xor_b32 m0,s91,16384
s_add_u32 s65,s94,32768
buffer_load_dwordx4 v16,s[20:23],s65 offen offset:0 sc1 lds
buffer_load_dwordx4 v16,s[20:23],s65 offen offset:2048 sc1 lds
s_xor_b32 m0,s91,32768
s_add_u32 s65,s94,65536
buffer_load_dwordx4 v16,s[20:23],s65 offen offset:0 sc1 lds
buffer_load_dwordx4 v16,s[20:23],s65 offen offset:2048 sc1 lds
s_xor_b32 m0,s91,49152
s_add_u32 s65,s94,98304
buffer_load_dwordx4 v16,s[20:23],s65 offen offset:0 sc1 lds
buffer_load_dwordx4 v16,s[20:23],s65 offen offset:2048 sc1 lds
s_mov_b64 exec,-1
s_add_u32 m0,s43,0
s_nop 0
buffer_load_dwordx4 v19,s[20:23],s78 offen sc1 lds
s_waitcnt vmcnt(9)
v_add_u32 v22,s71,-1
buffer_store_dword v22,v23,s[20:23],s97 offen sc1
s_mov_b32 s97,0x7fff0000
half2_245:
s_waitcnt vmcnt(8)
s_barrier
ds_read_b128 v[224:227],v17 offset:0
ds_read_b128 v[228:231],v17 offset:2048
ds_read_b128 v[232:235],v17 offset:4096
ds_read_b128 v[236:239],v17 offset:6144
ds_read_b128 v[240:243],v17 offset:8192
ds_read_b128 v[244:247],v17 offset:10240
ds_read_b128 v[248:251],v17 offset:12288
s_waitcnt lgkmcnt(5)
v_mfma_f32_16x16x32_bf16 v[64:67],a[0:3],v[224:227],0
s_xor_b32 m0,s72,0
v_min_u32 v27,v224,v228
v_mfma_f32_16x16x32_bf16 v[72:75],a[128:131],v[224:227],0
ds_read_b128 v[252:255],v17 offset:14336
s_add_u32 s65,s88,0
v_mfma_f32_16x16x32_bf16 v[64:67],a[4:7],v[228:231],v[64:67]
buffer_load_dwordx4 v16,s[20:23],s65 offen offset:0 sc1 lds
v_mfma_f32_16x16x32_bf16 v[72:75],a[132:135],v[228:231],v[72:75]
s_waitcnt vmcnt(7)
s_barrier
ds_read_b128 v[224:227],v17 offset:16384
s_waitcnt lgkmcnt(5)
v_mfma_f32_16x16x32_bf16 v[64:67],a[8:11],v[232:235],v[64:67]
buffer_load_dwordx4 v16,s[20:23],s65 offen offset:2048 sc1 lds
v_mfma_f32_16x16x32_bf16 v[72:75],a[136:139],v[232:235],v[72:75]
ds_read_b128 v[228:231],v17 offset:18432
s_xor_b32 m0,s72,16384
v_mfma_f32_16x16x32_bf16 v[64:67],a[12:15],v[236:239],v[64:67]
s_add_u32 s65,s88,32768
v_min3_u32 v27,v27,v232,v236
v_mfma_f32_16x16x32_bf16 v[72:75],a[140:143],v[236:239],v[72:75]
ds_read_b128 v[232:235],v17 offset:20480
s_waitcnt lgkmcnt(5)
v_mfma_f32_16x16x32_bf16 v[64:67],a[16:19],v[240:243],v[64:67]
buffer_load_dwordx4 v16,s[20:23],s65 offen offset:0 sc1 lds
v_mfma_f32_16x16x32_bf16 v[72:75],a[144:147],v[240:243],v[72:75]
ds_read_b128 v[236:239],v17 offset:22528
buffer_load_dwordx4 v16,s[20:23],s65 offen offset:2048 sc1 lds
v_mfma_f32_16x16x32_bf16 v[64:67],a[20:23],v[244:247],v[64:67]
s_xor_b32 m0,s72,32768
v_min3_u32 v27,v27,v240,v244
v_mfma_f32_16x16x32_bf16 v[72:75],a[148:151],v[244:247],v[72:75]
ds_read_b128 v[240:243],v17 offset:24576
s_add_u32 s65,s88,65536
s_waitcnt lgkmcnt(5)
v_mfma_f32_16x16x32_bf16 v[64:67],a[24:27],v[248:251],v[64:67]
buffer_load_dwordx4 v16,s[20:23],s65 offen offset:0 sc1 lds
v_mfma_f32_16x16x32_bf16 v[72:75],a[152:155],v[248:251],v[72:75]
ds_read_b128 v[244:247],v17 offset:26624
buffer_load_dwordx4 v16,s[20:23],s65 offen offset:2048 sc1 lds
v_mfma_f32_16x16x32_bf16 v[64:67],a[28:31],v[252:255],v[64:67]
v_min3_u32 v27,v27,v248,v252
v_mfma_f32_16x16x32_bf16 v[72:75],a[156:159],v[252:255],v[72:75]
ds_read_b128 v[248:251],v17 offset:28672
s_xor_b32 m0,s72,49152
s_waitcnt lgkmcnt(5)
v_mfma_f32_16x16x32_bf16 v[64:67],a[32:35],v[224:227],v[64:67]
s_add_u32 s65,s88,98304
v_min3_u32 v27,v27,v224,v228
v_mfma_f32_16x16x32_bf16 v[72:75],a[160:163],v[224:227],v[72:75]
ds_read_b128 v[252:255],v17 offset:30720
buffer_load_dwordx4 v16,s[20:23],s65 offen offset:0 sc1 lds
v_mfma_f32_16x16x32_bf16 v[64:67],a[36:39],v[228:231],v[64:67]
buffer_load_dwordx4 v16,s[20:23],s65 offen offset:2048 sc1 lds
v_mfma_f32_16x16x32_bf16 v[72:75],a[164:167],v[228:231],v[72:75]
s_waitcnt vmcnt(10)
s_barrier
ds_read_b128 v[224:227],v17 offset:32768
s_waitcnt lgkmcnt(5)
v_mfma_f32_16x16x32_bf16 v[64:67],a[40:43],v[232:235],v[64:67]
s_xor_b32 m0,s72,1024
v_min3_u32 v27,v27,v232,v236
v_mfma_f32_16x16x32_bf16 v[72:75],a[168:171],v[232:235],v[72:75]
ds_read_b128 v[228:231],v17 offset:34816
s_add_u32 s65,s89,0
v_mfma_f32_16x16x32_bf16 v[64:67],a[44:47],v[236:239],v[64:67]
buffer_load_dwordx4 v16,s[20:23],s65 offen offset:0 sc1 lds
v_mfma_f32_16x16x32_bf16 v[72:75],a[172:175],v[236:239],v[72:75]
ds_read_b128 v[232:235],v17 offset:36864
s_waitcnt lgkmcnt(5)
v_mfma_f32_16x16x32_bf16 v[64:67],a[48:51],v[240:243],v[64:67]
buffer_load_dwordx4 v16,s[20:23],s65 offen offset:2048 sc1 lds
v_mfma_f32_16x16x32_bf16 v[72:75],a[176:179],v[240:243],v[72:75]
ds_read_b128 v[236:239],v17 offset:38912
s_xor_b32 m0,s72,17408
v_mfma_f32_16x16x32_bf16 v[64:67],a[52:55],v[244:247],v[64:67]
s_add_u32 s65,s89,32768
v_min3_u32 v27,v27,v240,v244
v_mfma_f32_16x16x32_bf16 v[72:75],a[180:183],v[244:247],v[72:75]
ds_read_b128 v[240:243],v17 offset:40960
s_waitcnt lgkmcnt(5)
v_mfma_f32_16x16x32_bf16 v[64:67],a[56:59],v[248:251],v[64:67]
buffer_load_dwordx4 v16,s[20:23],s65 offen offset:0 sc1 lds
v_mfma_f32_16x16x32_bf16 v[72:75],a[184:187],v[248:251],v[72:75]
ds_read_b128 v[244:247],v17 offset:43008
v_min3_u32 v27,v27,v248,v252
v_mfma_f32_16x16x32_bf16 v[64:67],a[60:63],v[252:255],v[64:67]
buffer_load_dwordx4 v16,s[20:23],s65 offen offset:2048 sc1 lds
v_mfma_f32_16x16x32_bf16 v[72:75],a[188:191],v[252:255],v[72:75]
ds_read_b128 v[248:251],v17 offset:45056
s_waitcnt lgkmcnt(5)
v_mfma_f32_16x16x32_bf16 v[64:67],a[64:67],v[224:227],v[64:67]
s_xor_b32 m0,s72,33792
s_add_u32 s65,s89,65536
v_mfma_f32_16x16x32_bf16 v[72:75],a[192:195],v[224:227],v[72:75]
ds_read_b128 v[252:255],v17 offset:47104
v_min3_u32 v27,v27,v224,v228
v_mfma_f32_16x16x32_bf16 v[64:67],a[68:71],v[228:231],v[64:67]
buffer_load_dwordx4 v16,s[20:23],s65 offen offset:0 sc1 lds
v_mfma_f32_16x16x32_bf16 v[72:75],a[196:199],v[228:231],v[72:75]
ds_read_b128 v[224:227],v17 offset:49152
s_waitcnt lgkmcnt(5)
v_mfma_f32_16x16x32_bf16 v[64:67],a[72:75],v[232:235],v[64:67]
buffer_load_dwordx4 v16,s[20:23],s65 offen offset:2048 sc1 lds
v_mfma_f32_16x16x32_bf16 v[72:75],a[200:203],v[232:235],v[72:75]
ds_read_b128 v[228:231],v17 offset:51200
s_xor_b32 m0,s72,50176
v_mfma_f32_16x16x32_bf16 v[64:67],a[76:79],v[236:239],v[64:67]
s_add_u32 s65,s89,98304
v_min3_u32 v27,v27,v232,v236
v_mfma_f32_16x16x32_bf16 v[72:75],a[204:207],v[236:239],v[72:75]
ds_read_b128 v[232:235],v17 offset:53248
s_waitcnt lgkmcnt(5)
v_mfma_f32_16x16x32_bf16 v[64:67],a[80:83],v[240:243],v[64:67]
buffer_load_dwordx4 v16,s[20:23],s65 offen offset:0 sc1 lds
v_mfma_f32_16x16x32_bf16 v[72:75],a[208:211],v[240:243],v[72:75]
ds_read_b128 v[236:239],v17 offset:55296
v_min3_u32 v27,v27,v240,v244
v_mfma_f32_16x16x32_bf16 v[64:67],a[84:87],v[244:247],v[64:67]
buffer_load_dwordx4 v16,s[20:23],s65 offen offset:2048 sc1 lds
v_mfma_f32_16x16x32_bf16 v[72:75],a[212:215],v[244:247],v[72:75]
ds_read_b128 v[240:243],v17 offset:57344
s_waitcnt lgkmcnt(5)
v_mfma_f32_16x16x32_bf16 v[64:67],a[88:91],v[248:251],v[64:67]
v_min3_u32 v27,v27,v248,v252
v_mfma_f32_16x16x32_bf16 v[72:75],a[216:219],v[248:251],v[72:75]
ds_read_b128 v[244:247],v17 offset:59392
v_mfma_f32_16x16x32_bf16 v[64:67],a[92:95],v[252:255],v[64:67]
v_mfma_f32_16x16x32_bf16 v[72:75],a[220:223],v[252:255],v[72:75]
ds_read_b128 v[248:251],v17 offset:61440
s_waitcnt lgkmcnt(5)
v_mfma_f32_16x16x32_bf16 v[64:67],a[96:99],v[224:227],v[64:67]
v_min3_u32 v27,v27,v224,v228
v_mfma_f32_16x16x32_bf16 v[72:75],a[224:227],v[224:227],v[72:75]
ds_read_b128 v[252:255],v17 offset:63488
v_mfma_f32_16x16x32_bf16 v[64:67],a[100:103],v[228:231],v[64:67]
v_mfma_f32_16x16x32_bf16 v[72:75],a[228:231],v[228:231],v[72:75]
s_waitcnt lgkmcnt(4)
v_mfma_f32_16x16x32_bf16 v[64:67],a[104:107],v[232:235],v[64:67]
v_min3_u32 v27,v27,v232,v236
s_waitcnt vmcnt(17)
v_mfma_f32_16x16x32_bf16 v[72:75],a[232:235],v[232:235],v[72:75]
ds_read_b64 v[120:121],v40
ds_read_b64 v[122:123],v41
v_mfma_f32_16x16x32_bf16 v[64:67],a[108:111],v[236:239],v[64:67]
v_mfma_f32_16x16x32_bf16 v[72:75],a[236:239],v[236:239],v[72:75]
s_waitcnt lgkmcnt(4)
v_mfma_f32_16x16x32_bf16 v[64:67],a[112:115],v[240:243],v[64:67]
v_min3_u32 v27,v27,v240,v244
v_mfma_f32_16x16x32_bf16 v[72:75],a[240:243],v[240:243],v[72:75]
v_mfma_f32_16x16x32_bf16 v[64:67],a[116:119],v[244:247],v[64:67]
v_mfma_f32_16x16x32_bf16 v[72:75],a[244:247],v[244:247],v[72:75]
s_waitcnt lgkmcnt(2)
v_mfma_f32_16x16x32_bf16 v[64:67],a[120:123],v[248:251],v[64:67]
v_min3_u32 v27,v27,v248,v252
v_mfma_f32_16x16x32_bf16 v[72:75],a[248:251],v[248:251],v[72:75]
v_mfma_f32_16x16x32_bf16 v[64:67],a[124:127],v[252:255],v[64:67]
v_mfma_f32_16x16x32_bf16 v[72:75],a[252:255],v[252:255],v[72:75]
s_waitcnt lgkmcnt(0)
v_min3_u32 v27,v27,v120,v122
v_cmp_eq_u32 vcc,0,v27
s_and_b64 vcc,vcc,s[52:53]
s_cbranch_vccnz retry_239
v_mov_b32 v22,s71
buffer_store_dword v22,v23,s[20:23],s73 offen sc1
v_lshlrev_b32 v88,16,v120
v_and_b32 v89,s80,v120
v_lshlrev_b32 v90,16,v121
v_and_b32 v91,s80,v121
v_lshlrev_b32 v92,16,v122
v_and_b32 v93,s80,v122
v_lshlrev_b32 v94,16,v123
v_and_b32 v95,s80,v123
v_add_f32 v88,v64,v88
v_add_f32 v89,v65,v89
v_add_f32 v90,v66,v90
v_add_f32 v91,v67,v91
v_add_f32 v92,v72,v92
v_add_f32 v93,v73,v93
v_add_f32 v94,v74,v94
v_add_f32 v95,v75,v95
v_cvt_pk_bf16_f32 v96,v88,v89
v_cvt_pk_bf16_f32 v97,v90,v91
v_cvt_pk_bf16_f32 v98,v92,v93
v_cvt_pk_bf16_f32 v99,v94,v95
v_max_u32 v96,1,v96
buffer_store_dwordx4 v[96:99],v18,s[20:23],s70 offen offset:0 sc1
v_lshlrev_b32 v88,16,v96
v_and_b32 v89,s80,v96
v_lshlrev_b32 v90,16,v97
v_and_b32 v91,s80,v97
v_lshlrev_b32 v92,16,v98
v_and_b32 v93,s80,v98
v_lshlrev_b32 v94,16,v99
v_and_b32 v95,s80,v99
v_add_f32 v108,v88,v89
v_mul_f32 v109,v88,v88
v_add_f32 v100,v90,v91
v_mul_f32 v101,v89,v89
v_fmac_f32 v109,v90,v90
v_fmac_f32 v101,v91,v91
v_fmac_f32 v109,v92,v92
v_fmac_f32 v101,v93,v93
v_add_f32 v108,v108,v92
v_add_f32 v100,v100,v93
v_fmac_f32 v109,v94,v94
v_fmac_f32 v101,v95,v95
v_add_f32 v108,v108,v94
v_add_f32 v100,v100,v95
v_add_f32 v108,v108,v100
v_add_f32 v109,v109,v101
v_mov_b32 v100,v108
v_mov_b32 v101,v109
s_nop 0
v_permlane16_swap_b32 v100,v108
v_permlane16_swap_b32 v101,v109
v_add_f32 v108,v108,v100
v_add_f32 v109,v109,v101
v_mov_b32 v100,v108
v_mov_b32 v101,v109
s_nop 0
v_permlane32_swap_b32 v100,v108
v_permlane32_swap_b32 v101,v109
v_add_f32 v108,v108,v100
v_add_f32 v109,v109,v101
v_max_u32 v109,1,v109
buffer_store_dwordx4 v[108:111],v24,s[20:23],s70 offen sc1
v_xor_b32 v19,0x2000,v19
v_xor_b32 v20,0x2000,v20
s_sub_u32 s78,s78,2097152
v_mov_b32 v29,0
s_mov_b32 s83,0
s_mov_b32 s93,1
s_waitcnt vmcnt(3)
s_branch next_249
r_at_219:
v_mov_b32 v128,0
v_mov_b32 v129,0
v_mov_b32 v130,0
v_mov_b32 v131,0
s_cmp_ge_u32 s50,2
s_cbranch_scc1 r_ln_218
v_and_b32 v21,1,v1
v_mul_u32_u24 v21,64,v21
s_mov_b32 s65,21052928
s_mov_b32 s66,1792
pl_254:
buffer_load_dword v22,v21,s[20:23],s65 offen sc1
s_waitcnt vmcnt(0)
v_cmp_gt_u32 vcc,s66,v22
s_cbranch_vccz pok_255
s_sleep 1
s_sub_u32 s90,s90,1
s_cmp_gt_i32 s90,0
s_cbranch_scc1 pl_254
pok_255:
s_lshl_b32 s41,s41,1
s_add_u32 s41,s41,s50
v_and_b32 v21,3,v1
v_lshlrev_b32 v21,7,v21
s_lshl_b32 s65,s41,2
s_add_u32 s87,s65,s63
v_mov_b32 v99,v21
pl_256:
buffer_load_dword v22,v21,s[20:23],s87 offen sc1
s_waitcnt vmcnt(0)
v_cmp_gt_u32 vcc,14,v22
s_cbranch_vccz pok_257
s_sleep 1
s_sub_u32 s90,s90,1
s_cmp_gt_i32 s90,0
s_cbranch_scc1 pl_256
pok_257:
v_mov_b32 v21,s56
v_lshlrev_b32 v21,2,v21
s_mov_b32 s66,128
pl_258:
buffer_load_dword v22,v21,s[44:47],36 offen sc1
s_waitcnt vmcnt(0)
v_cmp_gt_u32 vcc,s66,v22
s_cbranch_vccz pok_259
s_sleep 1
s_sub_u32 s90,s90,1
s_cmp_gt_i32 s90,0
s_cbranch_scc1 pl_258
pok_259:
s_lshl_b32 s42,s41,14
s_lshr_b32 s43,s41,1
s_lshl_b32 s43,s43,14
s_and_b32 s64,s41,1
s_lshl_b32 s64,s64,12
s_add_u32 s43,s43,s64
s_add_u32 s43,s43,1572864
s_lshl_b32 s73,s41,7
s_add_u32 s73,s73,s63
s_add_u32 s73,s73,16384
v_lshrrev_b32 v6,3,v3
v_and_b32 v7,7,v3
v_lshl_add_u32 v6,v6,4,v7
v_lshlrev_b32 v6,4,v6
v_and_b32 v7,1,v4
v_lshl_add_u32 v6,v7,3,v6
v_lshrrev_b32 v8,2,v3
v_and_b32 v9,3,v3
v_lshl_add_u32 v8,v8,3,v9
s_mov_b32 s80,0x3e0293ee
v_mov_b32 v97,0xff800000
v_lshlrev_b32 v96,10,v1
v_lshlrev_b32 v98,3,v4
v_sub_u32 v98,v98,v8
v_cmp_lt_u32 s[48:49],1,v4
v_cmp_ge_i32 s[4:5],-7,v98
v_cmp_ge_i32 s[6:7],-6,v98
v_cmp_ge_i32 s[8:9],-5,v98
v_cmp_ge_i32 s[10:11],-4,v98
v_cmp_ge_i32 s[12:13],-3,v98
v_cmp_ge_i32 s[14:15],-2,v98
v_cmp_ge_i32 s[16:17],-1,v98
v_cmp_ge_i32 s[18:19],0,v98
v_cmp_ge_i32 s[32:33],1,v98
v_cmp_ge_i32 s[34:35],2,v98
v_cmp_ge_i32 s[36:37],3,v98
v_cmp_ge_i32 s[38:39],4,v98
s_add_u32 s64,s79,0
s_lshl_b32 s74,s64,21
s_lshl_b32 s64,s64,13
s_and_b32 s64,s64,0x2000
s_xor_b32 s64,s64,s61
s_add_u32 s74,s74,s64
s_add_u32 s74,s74,29360128
s_lshl_b32 s64,s50,2
s_add_u32 s64,s64,147456
v_mov_b32 v95,s64
ds_write_b32 v95,v128
s_add_u32 s66,s74,s43
kp_260:
s_add_u32 s78,s78,2
buffer_load_dwordx4 v[136:139],v16,s[20:23],s66 offen offset:0 sc1
buffer_load_dwordx4 v[140:143],v16,s[20:23],s66 offen offset:1024 sc1
buffer_load_dwordx4 v[144:147],v16,s[20:23],s66 offen offset:2048 sc1
buffer_load_dwordx4 v[148:151],v16,s[20:23],s66 offen offset:3072 sc1
s_waitcnt vmcnt(0)
kck_262:
v_min3_u32 v22,v136,v140,v144
v_min_u32 v22,v22,v148
v_cmp_eq_u32 vcc,0,v22
s_cbranch_vccz kok_261
s_sleep 1
s_sub_u32 s90,s90,1
s_cmp_gt_i32 s90,0
s_cbranch_scc1 kp_260
kok_261:
s_mov_b32 s78,0
s_add_u32 s64,s79,0
s_lshl_b32 s75,s64,21
s_lshl_b32 s64,s64,13
s_and_b32 s64,s64,0x2000
s_xor_b32 s64,s64,s61
s_add_u32 s75,s75,s64
s_add_u32 s75,s75,29360128
s_add_u32 s64,s79,0
s_lshl_b32 s76,s64,21
s_lshl_b32 s64,s64,13
s_and_b32 s64,s64,0x2000
s_xor_b32 s64,s64,s62
s_add_u32 s76,s76,s64
s_add_u32 s76,s76,29360128
s_add_u32 s77,s75,s43
s_add_u32 s75,s75,s42
s_add_u32 s76,s76,s42
s_add_u32 s65,s75,524288
buffer_load_dwordx4 a[32:35],v16,s[20:23],s65 offen offset:0 sc1
buffer_load_dwordx4 a[36:39],v16,s[20:23],s65 offen offset:1024 sc1
buffer_load_dwordx4 a[40:43],v16,s[20:23],s65 offen offset:2048 sc1
buffer_load_dwordx4 a[44:47],v16,s[20:23],s65 offen offset:3072 sc1
s_add_u32 s65,s75,528384
buffer_load_dwordx4 a[48:51],v16,s[20:23],s65 offen offset:0 sc1
buffer_load_dwordx4 a[52:55],v16,s[20:23],s65 offen offset:1024 sc1
buffer_load_dwordx4 a[56:59],v16,s[20:23],s65 offen offset:2048 sc1
buffer_load_dwordx4 a[60:63],v16,s[20:23],s65 offen offset:3072 sc1
s_add_u32 s65,s76,0
buffer_load_dwordx4 a[0:3],v16,s[20:23],s65 offen offset:0 sc1
buffer_load_dwordx4 a[4:7],v16,s[20:23],s65 offen offset:1024 sc1
buffer_load_dwordx4 a[8:11],v16,s[20:23],s65 offen offset:2048 sc1
buffer_load_dwordx4 a[12:15],v16,s[20:23],s65 offen offset:3072 sc1
s_add_u32 s65,s76,4096
buffer_load_dwordx4 a[16:19],v16,s[20:23],s65 offen offset:0 sc1
buffer_load_dwordx4 a[20:23],v16,s[20:23],s65 offen offset:1024 sc1
buffer_load_dwordx4 a[24:27],v16,s[20:23],s65 offen offset:2048 sc1
buffer_load_dwordx4 a[28:31],v16,s[20:23],s65 offen offset:3072 sc1
s_cmp_lt_u32 s79,58
s_cselect_b32 s78,s78,0
s_cmp_lg_u32 s78,0
s_cselect_b32 s66,0x7fff0000,s77
buffer_load_dwordx4 v[136:139],v16,s[20:23],s66 offen offset:0 sc1
buffer_load_dwordx4 v[140:143],v16,s[20:23],s66 offen offset:1024 sc1
buffer_load_dwordx4 v[144:147],v16,s[20:23],s66 offen offset:2048 sc1
buffer_load_dwordx4 v[148:151],v16,s[20:23],s66 offen offset:3072 sc1
s_add_u32 s65,s75,1048576
buffer_load_dwordx4 a[64:67],v16,s[20:23],s65 offen offset:0 sc1
buffer_load_dwordx4 a[68:71],v16,s[20:23],s65 offen offset:1024 sc1
buffer_load_dwordx4 a[72:75],v16,s[20:23],s65 offen offset:2048 sc1
buffer_load_dwordx4 a[76:79],v16,s[20:23],s65 offen offset:3072 sc1
s_add_u32 s65,s75,1052672
buffer_load_dwordx4 a[80:83],v16,s[20:23],s65 offen offset:0 sc1
buffer_load_dwordx4 a[84:87],v16,s[20:23],s65 offen offset:1024 sc1
buffer_load_dwordx4 a[88:91],v16,s[20:23],s65 offen offset:2048 sc1
buffer_load_dwordx4 a[92:95],v16,s[20:23],s65 offen offset:3072 sc1
s_waitcnt vmcnt(0)
aloop_263:
s_cmp_ge_u32 s79,44
s_cbranch_scc1 tk_265
tw_264:
ds_read_b32 v94,v95
s_waitcnt lgkmcnt(0)
v_readfirstlane_b32 s64,v94
s_add_u32 s64,s64,8
s_cmp_ge_u32 s64,s79
s_cbranch_scc1 tk_265
s_sleep 4
s_sub_u32 s90,s90,1
s_cmp_gt_i32 s90,0
s_cbranch_scc1 tw_264
tk_265:
s_add_u32 s64,s79,0
s_lshl_b32 s74,s64,21
s_lshl_b32 s64,s64,13
s_and_b32 s64,s64,0x2000
s_xor_b32 s64,s64,s61
s_add_u32 s74,s74,s64
s_add_u32 s74,s74,29360128
s_add_u32 s64,s79,0
s_lshl_b32 s70,s64,21
s_lshl_b32 s64,s64,13
s_and_b32 s64,s64,0x2000
s_xor_b32 s64,s64,s62
s_add_u32 s70,s70,s64
s_add_u32 s70,s70,29360128
s_waitcnt vmcnt(21)
v_mfma_f32_16x16x32_bf16 v[168:171],a[32:35],a[0:3],0
v_mfma_f32_16x16x32_bf16 v[172:175],a[36:39],a[0:3],0
v_mfma_f32_16x16x32_bf16 v[180:183],a[32:35],a[4:7],0
v_mfma_f32_16x16x32_bf16 v[184:187],a[36:39],a[4:7],0
v_mfma_f32_16x16x32_bf16 v[168:171],a[40:43],a[8:11],v[168:171]
v_mfma_f32_16x16x32_bf16 v[172:175],a[44:47],a[8:11],v[172:175]
v_mfma_f32_16x16x32_bf16 v[180:183],a[40:43],a[12:15],v[180:183]
v_mfma_f32_16x16x32_bf16 v[184:187],a[44:47],a[12:15],v[184:187]
v_mfma_f32_16x16x32_bf16 v[168:171],a[48:51],a[16:19],v[168:171]
v_mfma_f32_16x16x32_bf16 v[172:175],a[52:55],a[16:19],v[172:175]
v_mfma_f32_16x16x32_bf16 v[180:183],a[48:51],a[20:23],v[180:183]
v_mfma_f32_16x16x32_bf16 v[184:187],a[52:55],a[20:23],v[184:187]
v_mfma_f32_16x16x32_bf16 v[168:171],a[56:59],a[24:27],v[168:171]
v_mfma_f32_16x16x32_bf16 v[172:175],a[60:63],a[24:27],v[172:175]
v_mfma_f32_16x16x32_bf16 v[180:183],a[56:59],a[28:31],v[180:183]
v_mfma_f32_16x16x32_bf16 v[184:187],a[60:63],a[28:31],v[184:187]
s_nop 4
v_cndmask_b32 v168,v97,v168,s[18:19]
s_nop 0
v_cndmask_b32 v180,v97,v180,s[38:39]
v_cndmask_b32 v169,v97,v169,s[16:17]
v_cndmask_b32 v181,v97,v181,s[36:37]
v_cndmask_b32 v170,v97,v170,s[14:15]
v_cndmask_b32 v182,v97,v182,s[34:35]
v_cndmask_b32 v171,v97,v171,s[12:13]
v_cndmask_b32 v183,v97,v183,s[32:33]
v_cndmask_b32 v172,v97,v172,s[10:11]
v_cndmask_b32 v184,v97,v184,s[18:19]
v_cndmask_b32 v173,v97,v173,s[8:9]
v_cndmask_b32 v185,v97,v185,s[16:17]
v_cndmask_b32 v174,v97,v174,s[6:7]
v_cndmask_b32 v186,v97,v186,s[14:15]
v_cndmask_b32 v175,v97,v175,s[4:5]
v_cndmask_b32 v187,v97,v187,s[12:13]
v_max3_f32 v116,v168,v169,v170
v_max3_f32 v122,v180,v181,v182
v_max3_f32 v118,v171,v172,v173
v_max3_f32 v124,v183,v184,v185
v_max3_f32 v116,v116,v174,v175
v_max3_f32 v122,v122,v186,v187
v_max_f32 v116,v116,v118
v_max_f32 v122,v122,v124
v_mov_b32 v118,v116
v_mov_b32 v124,v122
s_nop 0
v_permlane16_swap_b32 v118,v116
v_permlane16_swap_b32 v124,v122
v_max_f32 v116,v116,v118
v_max_f32 v122,v122,v124
v_mov_b32 v118,v116
v_mov_b32 v124,v122
s_nop 0
v_permlane32_swap_b32 v118,v116
v_permlane32_swap_b32 v124,v122
v_max_f32 v116,v116,v118
v_max_f32 v122,v122,v124
v_mul_f32 v116,s80,v116
v_mul_f32 v122,s80,v122
v_fma_f32 v168,v168,s80,-v116
v_fma_f32 v180,v180,s80,-v122
v_fma_f32 v169,v169,s80,-v116
v_fma_f32 v181,v181,s80,-v122
v_fma_f32 v170,v170,s80,-v116
v_fma_f32 v182,v182,s80,-v122
v_fma_f32 v171,v171,s80,-v116
v_fma_f32 v183,v183,s80,-v122
v_fma_f32 v172,v172,s80,-v116
v_fma_f32 v184,v184,s80,-v122
v_fma_f32 v173,v173,s80,-v116
v_fma_f32 v185,v185,s80,-v122
v_fma_f32 v174,v174,s80,-v116
v_fma_f32 v186,v186,s80,-v122
v_fma_f32 v175,v175,s80,-v116
v_fma_f32 v187,v187,s80,-v122
v_exp_f32 v168,v168
v_exp_f32 v180,v180
v_exp_f32 v169,v169
v_exp_f32 v181,v181
v_exp_f32 v170,v170
v_exp_f32 v182,v182
v_exp_f32 v171,v171
v_exp_f32 v183,v183
v_exp_f32 v172,v172
v_exp_f32 v184,v184
v_exp_f32 v173,v173
v_exp_f32 v185,v185
v_exp_f32 v174,v174
v_exp_f32 v186,v186
v_exp_f32 v175,v175
v_exp_f32 v187,v187
v_add_f32 v117,v168,v169
v_add_f32 v123,v180,v181
v_add_f32 v119,v170,v171
v_add_f32 v125,v182,v183
v_add_f32 v117,v117,v172
v_add_f32 v123,v123,v184
v_add_f32 v119,v119,v173
v_add_f32 v125,v125,v185
v_add_f32 v117,v117,v174
v_add_f32 v123,v123,v186
v_add_f32 v119,v119,v175
v_add_f32 v125,v125,v187
v_add_f32 v117,v117,v119
v_add_f32 v123,v123,v125
v_mov_b32 v118,v117
v_mov_b32 v124,v123
s_nop 0
v_permlane16_swap_b32 v118,v117
v_permlane16_swap_b32 v124,v123
v_add_f32 v117,v117,v118
v_add_f32 v123,v123,v124
v_mov_b32 v118,v117
v_mov_b32 v124,v123
s_nop 0
v_permlane32_swap_b32 v118,v117
v_permlane32_swap_b32 v124,v123
v_add_f32 v117,v117,v118
v_add_f32 v123,v123,v124
s_cmp_gt_u32 s71,55
s_cselect_b32 s65,0x7fff0000,s73
s_waitcnt vmcnt(12)
v_add_u32 v22,s71,-1
buffer_store_dword v22,v23,s[20:23],s65 offen sc1
s_add_u32 s66,s74,s43
s_cmp_eq_u32 s78,0
s_cbranch_scc1 kx_269
s_cmp_eq_u32 s84,0
s_cselect_b32 s64,3,0
s_add_u32 s64,s64,s78
kbo_271:
s_sleep 2
s_sub_u32 s64,s64,1
s_cmp_gt_i32 s64,0
s_cbranch_scc1 kbo_271
s_cmp_lt_u32 s84,3
s_cselect_b32 s64,1,0
s_cmp_ge_u32 s84,4
s_subb_u32 s78,s78,2
s_add_u32 s84,s84,1
kpr_270:
s_mov_b64 exec,15
buffer_load_dword v22,v96,s[20:23],s66 offen sc1
s_waitcnt vmcnt(0)
v_cmp_eq_u32 vcc,0,v22
s_mov_b64 exec,-1
s_cbranch_vccz kp_266
s_add_u32 s78,s78,s64
s_mov_b32 s64,1
s_mov_b32 s84,0
s_sleep 1
s_sub_u32 s90,s90,1
s_cmp_gt_i32 s90,0
s_cbranch_scc1 kpr_270
s_branch kp_266
kx_269:
s_mov_b32 s84,0
s_waitcnt vmcnt(9)
s_branch kck_268
kp_266:
s_add_u32 s78,s78,2
buffer_load_dwordx4 v[136:139],v16,s[20:23],s66 offen offset:0 sc1
buffer_load_dwordx4 v[140:143],v16,s[20:23],s66 offen offset:1024 sc1
buffer_load_dwordx4 v[144:147],v16,s[20:23],s66 offen offset:2048 sc1
buffer_load_dwordx4 v[148:151],v16,s[20:23],s66 offen offset:3072 sc1
s_waitcnt vmcnt(0)
kck_268:
v_min3_u32 v22,v136,v140,v144
v_min_u32 v22,v22,v148
v_cmp_eq_u32 vcc,0,v22
s_cbranch_vccz kok_267
s_sleep 1
s_sub_u32 s90,s90,1
s_cmp_gt_i32 s90,0
s_cbranch_scc1 kp_266
kok_267:
s_min_u32 s78,s78,40
buffer_load_dwordx2 v[100:101],v6,s[20:23],s66 offen offset:0 sc1
buffer_load_dwordx2 v[102:103],v6,s[20:23],s66 offen offset:512 sc1
buffer_load_dwordx2 v[104:105],v6,s[20:23],s66 offen offset:1024 sc1
buffer_load_dwordx2 v[106:107],v6,s[20:23],s66 offen offset:1536 sc1
buffer_load_dwordx2 v[108:109],v6,s[20:23],s66 offen offset:2048 sc1
buffer_load_dwordx2 v[110:111],v6,s[20:23],s66 offen offset:2560 sc1
buffer_load_dwordx2 v[112:113],v6,s[20:23],s66 offen offset:3072 sc1
buffer_load_dwordx2 v[114:115],v6,s[20:23],s66 offen offset:3584 sc1
v_mfma_f32_16x16x32_bf16 v[176:179],v[136:139],a[0:3],0
v_mfma_f32_16x16x32_bf16 v[188:191],v[136:139],a[4:7],0
v_mfma_f32_16x16x32_bf16 v[176:179],v[140:143],a[8:11],v[176:179]
v_mfma_f32_16x16x32_bf16 v[188:191],v[140:143],a[12:15],v[188:191]
v_mfma_f32_16x16x32_bf16 v[176:179],v[144:147],a[16:19],v[176:179]
v_mfma_f32_16x16x32_bf16 v[188:191],v[144:147],a[20:23],v[188:191]
v_mfma_f32_16x16x32_bf16 v[176:179],v[148:151],a[24:27],v[176:179]
v_mfma_f32_16x16x32_bf16 v[188:191],v[148:151],a[28:31],v[188:191]
s_cmp_lg_u32 s79,55
s_cbranch_scc1 q2nd_272
pl_273:
buffer_load_dword v98,v99,s[20:23],s87 offen sc1
s_waitcnt vmcnt(0)
v_cmp_gt_u32 vcc,18,v98
s_cbranch_vccz pok_274
s_sleep 1
s_sub_u32 s90,s90,1
s_cmp_gt_i32 s90,0
s_cbranch_scc1 pl_273
pok_274:
q2nd_272:
s_add_u32 s64,s79,1
s_lshl_b32 s75,s64,21
s_lshl_b32 s64,s64,13
s_and_b32 s64,s64,0x2000
s_xor_b32 s64,s64,s61
s_add_u32 s75,s75,s64
s_add_u32 s75,s75,29360128
s_add_u32 s64,s79,1
s_lshl_b32 s76,s64,21
s_lshl_b32 s64,s64,13
s_and_b32 s64,s64,0x2000
s_xor_b32 s64,s64,s62
s_add_u32 s76,s76,s64
s_add_u32 s76,s76,29360128
s_add_u32 s77,s75,s43
s_add_u32 s75,s75,s42
s_add_u32 s76,s76,s42
s_cmp_lt_u32 s79,63
s_cselect_b32 s75,s75,0x7fff0000
s_cselect_b32 s76,s76,0x7fff0000
s_cselect_b32 s77,s77,0x7fff0000
s_add_u32 s65,s75,524288
buffer_load_dwordx4 a[32:35],v16,s[20:23],s65 offen offset:0 sc1
buffer_load_dwordx4 a[36:39],v16,s[20:23],s65 offen offset:1024 sc1
buffer_load_dwordx4 a[40:43],v16,s[20:23],s65 offen offset:2048 sc1
buffer_load_dwordx4 a[44:47],v16,s[20:23],s65 offen offset:3072 sc1
s_add_u32 s65,s75,528384
buffer_load_dwordx4 a[48:51],v16,s[20:23],s65 offen offset:0 sc1
buffer_load_dwordx4 a[52:55],v16,s[20:23],s65 offen offset:1024 sc1
buffer_load_dwordx4 a[56:59],v16,s[20:23],s65 offen offset:2048 sc1
buffer_load_dwordx4 a[60:63],v16,s[20:23],s65 offen offset:3072 sc1
s_add_u32 s65,s76,0
buffer_load_dwordx4 a[0:3],v16,s[20:23],s65 offen offset:0 sc1
buffer_load_dwordx4 a[4:7],v16,s[20:23],s65 offen offset:1024 sc1
buffer_load_dwordx4 a[8:11],v16,s[20:23],s65 offen offset:2048 sc1
buffer_load_dwordx4 a[12:15],v16,s[20:23],s65 offen offset:3072 sc1
s_add_u32 s65,s76,4096
buffer_load_dwordx4 a[16:19],v16,s[20:23],s65 offen offset:0 sc1
buffer_load_dwordx4 a[20:23],v16,s[20:23],s65 offen offset:1024 sc1
buffer_load_dwordx4 a[24:27],v16,s[20:23],s65 offen offset:2048 sc1
buffer_load_dwordx4 a[28:31],v16,s[20:23],s65 offen offset:3072 sc1
v_cndmask_b32 v176,v97,v176,s[48:49]
v_cndmask_b32 v188,v97,v188,s[48:49]
v_cndmask_b32 v177,v97,v177,s[48:49]
v_cndmask_b32 v189,v97,v189,s[48:49]
v_cndmask_b32 v178,v97,v178,s[48:49]
v_cndmask_b32 v190,v97,v190,s[48:49]
v_cndmask_b32 v179,v97,v179,s[48:49]
v_cndmask_b32 v191,v97,v191,s[48:49]
v_max3_f32 v119,v176,v177,v178
v_max3_f32 v125,v188,v189,v190
v_max_f32 v119,v119,v179
v_max_f32 v125,v125,v191
v_mov_b32 v118,v119
v_mov_b32 v124,v125
s_nop 0
v_permlane16_swap_b32 v118,v119
v_permlane16_swap_b32 v124,v125
v_max_f32 v119,v119,v118
v_max_f32 v125,v125,v124
v_mov_b32 v118,v119
v_mov_b32 v124,v125
s_nop 0
v_permlane32_swap_b32 v118,v119
v_permlane32_swap_b32 v124,v125
v_max_f32 v119,v119,v118
v_max_f32 v125,v125,v124
v_mul_f32 v119,s80,v119
v_mul_f32 v125,s80,v125
v_max_f32 v119,v119,v116
v_max_f32 v125,v125,v122
v_fma_f32 v176,v176,s80,-v119
v_fma_f32 v188,v188,s80,-v125
v_fma_f32 v177,v177,s80,-v119
v_fma_f32 v189,v189,s80,-v125
v_fma_f32 v178,v178,s80,-v119
v_fma_f32 v190,v190,s80,-v125
v_fma_f32 v179,v179,s80,-v119
v_fma_f32 v191,v191,s80,-v125
v_sub_f32 v116,v116,v119
v_sub_f32 v122,v122,v125
v_exp_f32 v176,v176
v_exp_f32 v188,v188
v_exp_f32 v177,v177
v_exp_f32 v189,v189
v_exp_f32 v178,v178
v_exp_f32 v190,v190
v_exp_f32 v179,v179
v_exp_f32 v191,v191
v_exp_f32 v116,v116
v_exp_f32 v122,v122
v_add_f32 v120,v176,v177
v_add_f32 v126,v188,v189
v_add_f32 v121,v178,v179
v_add_f32 v127,v190,v191
v_add_f32 v120,v120,v121
v_add_f32 v126,v126,v127
v_mov_b32 v118,v120
v_mov_b32 v124,v126
s_nop 0
v_permlane16_swap_b32 v118,v120
v_permlane16_swap_b32 v124,v126
v_add_f32 v120,v120,v118
v_add_f32 v126,v126,v124
v_mov_b32 v118,v120
v_mov_b32 v124,v126
s_nop 0
v_permlane32_swap_b32 v118,v120
v_permlane32_swap_b32 v124,v126
v_add_f32 v120,v120,v118
v_add_f32 v126,v126,v124
v_fmac_f32 v120,v117,v116
v_fmac_f32 v126,v123,v122
v_rcp_f32 v121,v120
v_rcp_f32 v127,v126
v_mul_f32 v119,v116,v121
v_mul_f32 v125,v122,v127
v_pk_mul_f32 v[168:169],v[168:169],v[118:119] op_sel:[0,1] op_sel_hi:[1,1]
v_pk_mul_f32 v[180:181],v[180:181],v[124:125] op_sel:[0,1] op_sel_hi:[1,1]
v_pk_mul_f32 v[170:171],v[170:171],v[118:119] op_sel:[0,1] op_sel_hi:[1,1]
v_pk_mul_f32 v[182:183],v[182:183],v[124:125] op_sel:[0,1] op_sel_hi:[1,1]
v_pk_mul_f32 v[172:173],v[172:173],v[118:119] op_sel:[0,1] op_sel_hi:[1,1]
v_pk_mul_f32 v[184:185],v[184:185],v[124:125] op_sel:[0,1] op_sel_hi:[1,1]
v_pk_mul_f32 v[174:175],v[174:175],v[118:119] op_sel:[0,1] op_sel_hi:[1,1]
v_pk_mul_f32 v[186:187],v[186:187],v[124:125] op_sel:[0,1] op_sel_hi:[1,1]
v_cvt_pk_bf16_f32 v48,v168,v169
v_cvt_pk_bf16_f32 v56,v180,v181
v_cvt_pk_bf16_f32 v49,v170,v171
v_cvt_pk_bf16_f32 v57,v182,v183
v_cvt_pk_bf16_f32 v50,v172,v173
v_cvt_pk_bf16_f32 v58,v184,v185
v_cvt_pk_bf16_f32 v51,v174,v175
v_cvt_pk_bf16_f32 v59,v186,v187
v_pk_mul_f32 v[176:177],v[176:177],v[120:121] op_sel:[0,1] op_sel_hi:[1,1]
v_pk_mul_f32 v[188:189],v[188:189],v[126:127] op_sel:[0,1] op_sel_hi:[1,1]
v_pk_mul_f32 v[178:179],v[178:179],v[120:121] op_sel:[0,1] op_sel_hi:[1,1]
v_pk_mul_f32 v[190:191],v[190:191],v[126:127] op_sel:[0,1] op_sel_hi:[1,1]
v_cvt_pk_bf16_f32 v52,v176,v177
v_cvt_pk_bf16_f32 v60,v188,v189
v_cvt_pk_bf16_f32 v53,v178,v179
v_cvt_pk_bf16_f32 v61,v190,v191
s_add_u32 s70,s70,s42
s_waitcnt vmcnt(24)
v_mfma_f32_16x16x32_bf16 v[192:195],a[64:67],v[48:51],0
v_mfma_f32_16x16x32_bf16 v[196:199],a[64:67],v[56:59],0
v_mfma_f32_16x16x32_bf16 v[200:203],a[68:71],v[48:51],0
v_mfma_f32_16x16x32_bf16 v[204:207],a[68:71],v[56:59],0
v_mfma_f32_16x16x32_bf16 v[208:211],a[72:75],v[48:51],0
v_mfma_f32_16x16x32_bf16 v[212:215],a[72:75],v[56:59],0
v_mfma_f32_16x16x32_bf16 v[216:219],a[76:79],v[48:51],0
v_mfma_f32_16x16x32_bf16 v[220:223],a[76:79],v[56:59],0
s_waitcnt vmcnt(16)
v_mfma_f32_16x16x16_bf16 v[192:195],v[100:101],v[52:53],v[192:195]
v_mfma_f32_16x16x16_bf16 v[196:199],v[100:101],v[60:61],v[196:199]
v_mfma_f32_16x16x16_bf16 v[200:203],v[102:103],v[52:53],v[200:203]
v_mfma_f32_16x16x16_bf16 v[204:207],v[102:103],v[60:61],v[204:207]
v_mfma_f32_16x16x32_bf16 v[224:227],a[80:83],v[48:51],0
v_mfma_f32_16x16x32_bf16 v[228:231],a[80:83],v[56:59],0
v_mfma_f32_16x16x32_bf16 v[232:235],a[84:87],v[48:51],0
v_mfma_f32_16x16x32_bf16 v[236:239],a[84:87],v[56:59],0
v_mfma_f32_16x16x16_bf16 v[208:211],v[104:105],v[52:53],v[208:211]
s_add_u32 s65,s70,524288
v_mfma_f32_16x16x16_bf16 v[212:215],v[104:105],v[60:61],v[212:215]
v_cvt_pk_bf16_f32 v64,v192,v193
v_cvt_pk_bf16_f32 v65,v194,v195
v_mfma_f32_16x16x16_bf16 v[216:219],v[106:107],v[52:53],v[216:219]
v_cvt_pk_bf16_f32 v66,v200,v201
v_mfma_f32_16x16x16_bf16 v[220:223],v[106:107],v[60:61],v[220:223]
v_cvt_pk_bf16_f32 v67,v202,v203
v_max_u32 v64,1,v64
v_mfma_f32_16x16x32_bf16 v[240:243],a[88:91],v[48:51],0
buffer_store_dwordx4 v[64:67],v16,s[20:23],s65 offen offset:0 sc1
v_cvt_pk_bf16_f32 v68,v196,v197
v_mfma_f32_16x16x32_bf16 v[244:247],a[88:91],v[56:59],0
v_cvt_pk_bf16_f32 v69,v198,v199
v_mfma_f32_16x16x32_bf16 v[248:251],a[92:95],v[48:51],0
v_cvt_pk_bf16_f32 v70,v204,v205
v_cvt_pk_bf16_f32 v71,v206,v207
v_mfma_f32_16x16x32_bf16 v[252:255],a[92:95],v[56:59],0
v_max_u32 v68,1,v68
buffer_store_dwordx4 v[68:71],v16,s[20:23],s65 offen offset:1024 sc1
v_mfma_f32_16x16x16_bf16 v[224:227],v[108:109],v[52:53],v[224:227]
v_cvt_pk_bf16_f32 v72,v208,v209
v_mfma_f32_16x16x16_bf16 v[228:231],v[108:109],v[60:61],v[228:231]
v_cvt_pk_bf16_f32 v73,v210,v211
v_cvt_pk_bf16_f32 v74,v216,v217
v_mfma_f32_16x16x16_bf16 v[232:235],v[110:111],v[52:53],v[232:235]
v_cvt_pk_bf16_f32 v75,v218,v219
v_mfma_f32_16x16x16_bf16 v[236:239],v[110:111],v[60:61],v[236:239]
v_max_u32 v72,1,v72
buffer_store_dwordx4 v[72:75],v16,s[20:23],s65 offen offset:2048 sc1
v_mfma_f32_16x16x16_bf16 v[240:243],v[112:113],v[52:53],v[240:243]
v_cvt_pk_bf16_f32 v76,v212,v213
v_mfma_f32_16x16x16_bf16 v[244:247],v[112:113],v[60:61],v[244:247]
v_cvt_pk_bf16_f32 v77,v214,v215
v_cvt_pk_bf16_f32 v78,v220,v221
v_mfma_f32_16x16x16_bf16 v[248:251],v[114:115],v[52:53],v[248:251]
v_cvt_pk_bf16_f32 v79,v222,v223
v_mfma_f32_16x16x16_bf16 v[252:255],v[114:115],v[60:61],v[252:255]
v_max_u32 v76,1,v76
buffer_store_dwordx4 v[76:79],v16,s[20:23],s65 offen offset:3072 sc1
s_cmp_gt_u32 s71,54
s_cselect_b32 s64,s73,0x7fff0000
v_mov_b32 v22,s71
buffer_store_dword v22,v23,s[20:23],s64 offen sc1
s_add_u32 s65,s70,528384
v_cvt_pk_bf16_f32 v64,v224,v225
v_cvt_pk_bf16_f32 v65,v226,v227
v_cvt_pk_bf16_f32 v66,v232,v233
v_cvt_pk_bf16_f32 v67,v234,v235
v_max_u32 v64,1,v64
buffer_store_dwordx4 v[64:67],v16,s[20:23],s65 offen offset:0 sc1
v_cvt_pk_bf16_f32 v68,v228,v229
v_cvt_pk_bf16_f32 v69,v230,v231
v_cvt_pk_bf16_f32 v70,v236,v237
v_cvt_pk_bf16_f32 v71,v238,v239
v_max_u32 v68,1,v68
buffer_store_dwordx4 v[68:71],v16,s[20:23],s65 offen offset:1024 sc1
v_cvt_pk_bf16_f32 v72,v240,v241
v_cvt_pk_bf16_f32 v73,v242,v243
v_cvt_pk_bf16_f32 v74,v248,v249
v_cvt_pk_bf16_f32 v75,v250,v251
v_max_u32 v72,1,v72
buffer_store_dwordx4 v[72:75],v16,s[20:23],s65 offen offset:2048 sc1
v_cvt_pk_bf16_f32 v76,v244,v245
v_cvt_pk_bf16_f32 v77,v246,v247
v_cvt_pk_bf16_f32 v78,v252,v253
v_cvt_pk_bf16_f32 v79,v254,v255
v_max_u32 v76,1,v76
buffer_store_dwordx4 v[76:79],v16,s[20:23],s65 offen offset:3072 sc1
s_cmp_lt_u32 s79,58
s_cselect_b32 s78,s78,0
s_cmp_lg_u32 s78,0
s_cselect_b32 s66,0x7fff0000,s77
buffer_load_dwordx4 v[136:139],v16,s[20:23],s66 offen offset:0 sc1
buffer_load_dwordx4 v[140:143],v16,s[20:23],s66 offen offset:1024 sc1
buffer_load_dwordx4 v[144:147],v16,s[20:23],s66 offen offset:2048 sc1
buffer_load_dwordx4 v[148:151],v16,s[20:23],s66 offen offset:3072 sc1
s_add_u32 s65,s75,1048576
buffer_load_dwordx4 a[64:67],v16,s[20:23],s65 offen offset:0 sc1
buffer_load_dwordx4 a[68:71],v16,s[20:23],s65 offen offset:1024 sc1
buffer_load_dwordx4 a[72:75],v16,s[20:23],s65 offen offset:2048 sc1
buffer_load_dwordx4 a[76:79],v16,s[20:23],s65 offen offset:3072 sc1
s_add_u32 s65,s75,1052672
buffer_load_dwordx4 a[80:83],v16,s[20:23],s65 offen offset:0 sc1
buffer_load_dwordx4 a[84:87],v16,s[20:23],s65 offen offset:1024 sc1
buffer_load_dwordx4 a[88:91],v16,s[20:23],s65 offen offset:2048 sc1
buffer_load_dwordx4 a[92:95],v16,s[20:23],s65 offen offset:3072 sc1
s_add_u32 s79,s79,1
s_add_u32 s71,s71,1
s_cmp_lt_u32 s79,64
s_cbranch_scc1 aloop_263
s_endpgm
r_ln_218:
v_and_b32 v21,1,v1
v_mul_u32_u24 v21,960,v21
s_mov_b32 s65,21052032
s_mov_b32 s66,1792
pl_275:
buffer_load_dword v22,v21,s[20:23],s65 offen sc1
s_waitcnt vmcnt(0)
v_cmp_gt_u32 vcc,s66,v22
s_cbranch_vccz pok_276
s_sleep 1
s_sub_u32 s90,s90,1
s_cmp_gt_i32 s90,0
s_cbranch_scc1 pl_275
pok_276:
s_lshl_b32 s41,s59,1
s_add_u32 s41,s41,s50
s_sub_u32 s41,s41,2
v_lshlrev_b32 v5,5,v1
s_mov_b32 s64,16384
buffer_load_dwordx4 v[40:43],v5,s[20:23],s64 offen offset:0 sc1
buffer_load_dwordx4 v[44:47],v5,s[20:23],s64 offen offset:16 sc1
buffer_load_dwordx4 v[48:51],v5,s[20:23],s64 offen offset:2048 sc1
buffer_load_dwordx4 v[52:55],v5,s[20:23],s64 offen offset:2064 sc1
s_mov_b32 s64,12288
buffer_load_dwordx4 v[56:59],v5,s[20:23],s64 offen offset:0 sc1
buffer_load_dwordx4 v[60:63],v5,s[20:23],s64 offen offset:16 sc1
buffer_load_dwordx4 v[64:67],v5,s[20:23],s64 offen offset:2048 sc1
buffer_load_dwordx4 v[68:71],v5,s[20:23],s64 offen offset:2064 sc1
s_lshr_b32 s64,s41,2
s_add_u32 s64,s64,64
s_lshl_b32 s64,s64,14
s_and_b32 s65,s41,3
s_lshl_b32 s65,s65,11
s_add_u32 s64,s64,s65
v_add_u32 v19,s64,v16
v_add_u32 v19,786432,v19
s_lshl_b32 s65,s41,7
v_add_u32 v5,s65,v16
v_and_b32 v5,2047,v5
v_add_u32 v17,s64,v5
v_xor_b32 v18,1024,v17
v_add_u32 v24,0xfff00000,v17
v_xor_b32 v25,1024,v24
v_lshlrev_b32 v21,2,v1
s_and_b32 s64,s41,4
s_lshl_b32 s64,s64,6
s_add_u32 s74,s63,s64
s_add_u32 s74,s74,2048
s_mov_b32 s83,1
s_lshl_b32 s73,s41,2
s_add_u32 s73,s73,s63
s_add_u32 s73,s73,2560
v_mov_b32 v8,1
v_mov_b32 v9,1
v_mov_b32 v10,1
v_mov_b32 v11,1
s_add_u32 s64,s62,27262976
s_xor_b32 s65,s62,0x2000
s_add_u32 s65,s65,163577856
buffer_store_dwordx4 v[8:11],v24,s[20:23],s64 offen sc1
buffer_store_dwordx4 v[8:11],v25,s[20:23],s64 offen sc1
buffer_store_dwordx4 v[8:11],v24,s[20:23],s65 offen sc1
buffer_store_dwordx4 v[8:11],v25,s[20:23],s65 offen sc1
s_mov_b32 s82,0x3a800000
s_waitcnt vmcnt(0)
v_add_f32 v40,1.0,v40
v_add_f32 v41,1.0,v41
v_add_f32 v42,1.0,v42
v_add_f32 v43,1.0,v43
v_add_f32 v44,1.0,v44
v_add_f32 v45,1.0,v45
v_add_f32 v46,1.0,v46
v_add_f32 v47,1.0,v47
v_add_f32 v48,1.0,v48
v_add_f32 v49,1.0,v49
v_add_f32 v50,1.0,v50
v_add_f32 v51,1.0,v51
v_add_f32 v52,1.0,v52
v_add_f32 v53,1.0,v53
v_add_f32 v54,1.0,v54
v_add_f32 v55,1.0,v55
s_lshl_b32 s64,s50,2
s_add_u32 s64,s64,147448
v_mov_b32 v7,s64
s_add_u32 s64,s79,0
s_lshl_b32 s70,s64,21
s_lshl_b32 s64,s64,13
s_and_b32 s64,s64,0x2000
s_xor_b32 s64,s64,s62
s_add_u32 s70,s70,s64
s_add_u32 s70,s70,29360128
lloop_277:
s_add_u32 s75,s70,2097152
s_xor_b32 s75,s75,0x2000
s_add_u32 s96,s71,1
s_cmp_eq_u32 s83,0
s_cbranch_scc1 lahead_280
s_cmp_gt_u32 s71,40
s_cbranch_scc1 xp_278
pl_282:
buffer_load_dword v29,v21,s[20:23],s74 offen sc1
s_waitcnt vmcnt(0)
v_cmp_gt_u32 vcc,s71,v29
s_cbranch_vccz pok_283
s_sleep 1
s_sub_u32 s90,s90,1
s_cmp_gt_i32 s90,0
s_cbranch_scc1 pl_282
pok_283:
xp_278:
buffer_load_dwordx4 v[8:11],v17,s[20:23],s70 offen sc1
buffer_load_dwordx4 v[12:15],v18,s[20:23],s70 offen sc1
s_waitcnt vmcnt(0)
v_min3_u32 v22,v8,v10,v12
v_min_u32 v22,v22,v14
v_cmp_eq_u32 vcc,0,v22
s_cbranch_vccz xk_279
s_sleep 1
s_sub_u32 s90,s90,1
s_cmp_gt_i32 s90,0
s_cbranch_scc1 xp_278
s_branch xk_279
lahead_280:
s_waitcnt vmcnt(6)
v_mov_b32 v8,v104
v_mov_b32 v9,v105
v_mov_b32 v10,v106
v_mov_b32 v11,v107
v_mov_b32 v12,v108
v_mov_b32 v13,v109
v_mov_b32 v14,v110
v_mov_b32 v15,v111
v_min3_u32 v22,v8,v10,v12
v_min_u32 v22,v22,v14
v_cmp_eq_u32 vcc,0,v22
s_cbranch_vccnz xp_278
xk_279:
v_cmp_gt_u32 vcc,s96,v29
s_or_b32 s83,vcc_lo,vcc_hi
s_cselect_b32 s76,0x7fff0000,s75
buffer_load_dwordx4 v[104:107],v17,s[20:23],s76 offen sc1
buffer_load_dwordx4 v[108:111],v18,s[20:23],s76 offen sc1
buffer_load_dword v29,v21,s[20:23],s74 offen sc1
v_lshlrev_b32 v80,16,v8
v_and_b32 v81,s80,v8
v_lshlrev_b32 v82,16,v9
v_and_b32 v83,s80,v9
v_lshlrev_b32 v84,16,v10
v_and_b32 v85,s80,v10
v_lshlrev_b32 v86,16,v11
v_and_b32 v87,s80,v11
v_lshlrev_b32 v88,16,v12
v_and_b32 v89,s80,v12
v_lshlrev_b32 v90,16,v13
v_and_b32 v91,s80,v13
v_lshlrev_b32 v92,16,v14
v_and_b32 v93,s80,v14
v_lshlrev_b32 v94,16,v15
v_and_b32 v95,s80,v15
v_pk_add_f32 v[96:97],v[80:81],v[82:83]
v_pk_mul_f32 v[100:101],v[80:81],v[80:81]
v_pk_add_f32 v[98:99],v[88:89],v[90:91]
v_pk_mul_f32 v[102:103],v[88:89],v[88:89]
v_pk_fma_f32 v[100:101],v[82:83],v[82:83],v[100:101]
v_pk_fma_f32 v[102:103],v[90:91],v[90:91],v[102:103]
v_pk_add_f32 v[96:97],v[96:97],v[84:85]
v_pk_fma_f32 v[100:101],v[84:85],v[84:85],v[100:101]
v_pk_add_f32 v[98:99],v[98:99],v[92:93]
v_pk_fma_f32 v[102:103],v[92:93],v[92:93],v[102:103]
v_pk_add_f32 v[96:97],v[96:97],v[86:87]
v_pk_fma_f32 v[100:101],v[86:87],v[86:87],v[100:101]
v_pk_add_f32 v[98:99],v[98:99],v[94:95]
v_pk_fma_f32 v[102:103],v[94:95],v[94:95],v[102:103]
v_pk_add_f32 v[96:97],v[96:97],v[98:99]
v_pk_add_f32 v[100:101],v[100:101],v[102:103]
v_add_f32 v96,v96,v97
v_add_f32 v97,v100,v101
s_nop 0
v_add_f32_dpp v96,v96,v96 quad_perm:[1,0,3,2] row_mask:0xf bank_mask:0xf
v_add_f32_dpp v97,v97,v97 quad_perm:[1,0,3,2] row_mask:0xf bank_mask:0xf
s_nop 0
v_add_f32_dpp v96,v96,v96 quad_perm:[2,3,0,1] row_mask:0xf bank_mask:0xf
v_add_f32_dpp v97,v97,v97 quad_perm:[2,3,0,1] row_mask:0xf bank_mask:0xf
s_nop 0
v_add_f32_dpp v96,v96,v96 row_half_mirror row_mask:0xf bank_mask:0xf
v_add_f32_dpp v97,v97,v97 row_half_mirror row_mask:0xf bank_mask:0xf
s_nop 0
v_add_f32_dpp v96,v96,v96 row_mirror row_mask:0xf bank_mask:0xf
v_add_f32_dpp v97,v97,v97 row_mirror row_mask:0xf bank_mask:0xf
v_mov_b32 v98,v96
v_mov_b32 v99,v97
s_nop 0
v_permlane16_swap_b32 v98,v96
v_permlane16_swap_b32 v99,v97
v_pk_add_f32 v[96:97],v[96:97],v[98:99]
v_mov_b32 v98,v96
v_mov_b32 v99,v97
s_nop 0
v_permlane32_swap_b32 v98,v96
v_permlane32_swap_b32 v99,v97
v_pk_add_f32 v[96:97],v[96:97],v[98:99]
v_mul_f32 v96,0xba800000,v96
v_mul_f32 v98,v96,v96
v_fma_f32 v98,v97,s82,-v98
v_max_f32 v98,0,v98
v_add_f32 v98,0x3727c5ac,v98
v_rsq_f32 v98,v98
s_nop 0
v_mul_f32 v96,v96,v98
v_pk_fma_f32 v[80:81],v[80:81],v[98:99],v[96:97] op_sel_hi:[1,0,0]
v_pk_fma_f32 v[82:83],v[82:83],v[98:99],v[96:97] op_sel_hi:[1,0,0]
v_pk_fma_f32 v[84:85],v[84:85],v[98:99],v[96:97] op_sel_hi:[1,0,0]
v_pk_fma_f32 v[86:87],v[86:87],v[98:99],v[96:97] op_sel_hi:[1,0,0]
v_pk_fma_f32 v[88:89],v[88:89],v[98:99],v[96:97] op_sel_hi:[1,0,0]
v_pk_fma_f32 v[90:91],v[90:91],v[98:99],v[96:97] op_sel_hi:[1,0,0]
v_pk_fma_f32 v[92:93],v[92:93],v[98:99],v[96:97] op_sel_hi:[1,0,0]
v_pk_fma_f32 v[94:95],v[94:95],v[98:99],v[96:97] op_sel_hi:[1,0,0]
v_pk_fma_f32 v[80:81],v[80:81],v[40:41],v[56:57]
v_pk_fma_f32 v[82:83],v[82:83],v[42:43],v[58:59]
v_pk_fma_f32 v[84:85],v[84:85],v[44:45],v[60:61]
v_pk_fma_f32 v[86:87],v[86:87],v[46:47],v[62:63]
v_pk_fma_f32 v[88:89],v[88:89],v[48:49],v[64:65]
v_pk_fma_f32 v[90:91],v[90:91],v[50:51],v[66:67]
v_pk_fma_f32 v[92:93],v[92:93],v[52:53],v[68:69]
v_pk_fma_f32 v[94:95],v[94:95],v[54:55],v[70:71]
v_cvt_pk_bf16_f32 v8,v80,v81
v_cvt_pk_bf16_f32 v9,v82,v83
v_cvt_pk_bf16_f32 v10,v84,v85
v_cvt_pk_bf16_f32 v11,v86,v87
v_cvt_pk_bf16_f32 v12,v88,v89
v_cvt_pk_bf16_f32 v13,v90,v91
v_cvt_pk_bf16_f32 v14,v92,v93
v_cvt_pk_bf16_f32 v15,v94,v95
v_max_u32 v8,1,v8
v_max_u32 v10,1,v10
v_max_u32 v12,1,v12
v_max_u32 v14,1,v14
s_xor_b32 s78,s70,0x2000
s_waitcnt vmcnt(3)
v_add_u32 v22,s71,-1
buffer_store_dword v22,v23,s[24:27],s73 offen
buffer_store_dword v22,v23,s[28:31],s73 offen sc1
buffer_store_dwordx4 v[8:11],v24,s[20:23],s78 offen sc1
buffer_store_dwordx4 v[12:15],v25,s[20:23],s78 offen sc1
v_lshlrev_b32 v80,16,v8
v_and_b32 v81,s80,v8
v_lshlrev_b32 v82,16,v9
v_and_b32 v83,s80,v9
v_lshlrev_b32 v84,16,v10
v_and_b32 v85,s80,v10
v_lshlrev_b32 v86,16,v11
v_and_b32 v87,s80,v11
v_lshlrev_b32 v88,16,v12
v_and_b32 v89,s80,v12
v_lshlrev_b32 v90,16,v13
v_and_b32 v91,s80,v13
v_lshlrev_b32 v92,16,v14
v_and_b32 v93,s80,v14
v_lshlrev_b32 v94,16,v15
v_and_b32 v95,s80,v15
v_pk_add_f32 v[96:97],v[80:81],v[82:83]
v_pk_mul_f32 v[100:101],v[80:81],v[80:81]
v_pk_add_f32 v[98:99],v[88:89],v[90:91]
v_pk_mul_f32 v[102:103],v[88:89],v[88:89]
v_pk_fma_f32 v[100:101],v[82:83],v[82:83],v[100:101]
v_pk_fma_f32 v[102:103],v[90:91],v[90:91],v[102:103]
v_pk_add_f32 v[96:97],v[96:97],v[84:85]
v_pk_fma_f32 v[100:101],v[84:85],v[84:85],v[100:101]
v_pk_add_f32 v[98:99],v[98:99],v[92:93]
v_pk_fma_f32 v[102:103],v[92:93],v[92:93],v[102:103]
v_pk_add_f32 v[96:97],v[96:97],v[86:87]
v_pk_fma_f32 v[100:101],v[86:87],v[86:87],v[100:101]
v_pk_add_f32 v[98:99],v[98:99],v[94:95]
v_pk_fma_f32 v[102:103],v[94:95],v[94:95],v[102:103]
v_pk_add_f32 v[96:97],v[96:97],v[98:99]
v_pk_add_f32 v[100:101],v[100:101],v[102:103]
v_add_f32 v96,v96,v97
v_add_f32 v97,v100,v101
s_nop 0
v_add_f32_dpp v96,v96,v96 quad_perm:[1,0,3,2] row_mask:0xf bank_mask:0xf
v_add_f32_dpp v97,v97,v97 quad_perm:[1,0,3,2] row_mask:0xf bank_mask:0xf
s_nop 0
v_add_f32_dpp v96,v96,v96 quad_perm:[2,3,0,1] row_mask:0xf bank_mask:0xf
v_add_f32_dpp v97,v97,v97 quad_perm:[2,3,0,1] row_mask:0xf bank_mask:0xf
s_nop 0
v_add_f32_dpp v96,v96,v96 row_half_mirror row_mask:0xf bank_mask:0xf
v_add_f32_dpp v97,v97,v97 row_half_mirror row_mask:0xf bank_mask:0xf
s_nop 0
v_add_f32_dpp v96,v96,v96 row_mirror row_mask:0xf bank_mask:0xf
v_add_f32_dpp v97,v97,v97 row_mirror row_mask:0xf bank_mask:0xf
v_mov_b32 v98,v96
v_mov_b32 v99,v97
s_nop 0
v_permlane16_swap_b32 v98,v96
v_permlane16_swap_b32 v99,v97
v_pk_add_f32 v[96:97],v[96:97],v[98:99]
v_mov_b32 v98,v96
v_mov_b32 v99,v97
s_nop 0
v_permlane32_swap_b32 v98,v96
v_permlane32_swap_b32 v99,v97
v_pk_add_f32 v[96:97],v[96:97],v[98:99]
v_mul_f32 v96,0xba800000,v96
v_mul_f32 v98,v96,v96
v_fma_f32 v98,v97,s82,-v98
v_max_f32 v98,0,v98
v_add_f32 v98,0x3727c5ac,v98
v_rsq_f32 v98,v98
s_nop 0
v_mul_f32 v96,v96,v98
v_pk_fma_f32 v[80:81],v[80:81],v[98:99],v[96:97] op_sel_hi:[1,0,0]
v_pk_fma_f32 v[82:83],v[82:83],v[98:99],v[96:97] op_sel_hi:[1,0,0]
v_pk_fma_f32 v[84:85],v[84:85],v[98:99],v[96:97] op_sel_hi:[1,0,0]
v_pk_fma_f32 v[86:87],v[86:87],v[98:99],v[96:97] op_sel_hi:[1,0,0]
v_pk_fma_f32 v[88:89],v[88:89],v[98:99],v[96:97] op_sel_hi:[1,0,0]
v_pk_fma_f32 v[90:91],v[90:91],v[98:99],v[96:97] op_sel_hi:[1,0,0]
v_pk_fma_f32 v[92:93],v[92:93],v[98:99],v[96:97] op_sel_hi:[1,0,0]
v_pk_fma_f32 v[94:95],v[94:95],v[98:99],v[96:97] op_sel_hi:[1,0,0]
v_cvt_pk_bf16_f32 v72,v80,v81
v_cvt_pk_bf16_f32 v73,v82,v83
v_cvt_pk_bf16_f32 v74,v84,v85
v_cvt_pk_bf16_f32 v75,v86,v87
v_cvt_pk_bf16_f32 v76,v88,v89
v_cvt_pk_bf16_f32 v77,v90,v91
v_cvt_pk_bf16_f32 v78,v92,v93
v_cvt_pk_bf16_f32 v79,v94,v95
v_max_u32 v72,1,v72
v_max_u32 v76,1,v76
buffer_store_dwordx4 v[72:75],v19,s[20:23],s70 offen sc1
buffer_store_dwordx4 v[76:79],v19,s[20:23],s70 offen offset:1024 sc1
s_cmp_gt_u32 s71,40
s_cbranch_scc1 fnow_284
s_cmp_eq_u32 s83,0
s_cbranch_scc1 flater_285
s_waitcnt vmcnt(0)
fnow_284:
v_mov_b32 v22,s71
buffer_store_dword v22,v23,s[24:27],s73 offen
buffer_store_dword v22,v23,s[28:31],s73 offen sc1
flater_285:
v_mov_b32 v6,s71
ds_write_b32 v7,v6
s_mov_b32 s70,s75
s_add_u32 s79,s79,1
s_add_u32 s71,s71,1
s_cmp_lt_u32 s79,64
s_cbranch_scc1 lloop_277
s_endpgm
r_wo_214:
s_load_dwordx2 s[4:5],s[0:1],40
s_load_dwordx2 s[6:7],s[0:1],0
s_lshr_b32 s41,s59,3
s_and_b32 s42,s59,7
s_mul_i32 s66,s41,2097152
s_lshl_b32 s64,s42,8
s_add_u32 s66,s66,s64
s_lshl_b32 s67,s50,1
s_and_b32 s64,s41,1
s_add_u32 s67,s67,s64
s_waitcnt lgkmcnt(0)
s_mov_b32 s32,s4
s_and_b32 s33,s5,0xffff
s_mov_b32 s34,0x800000
s_mov_b32 s35,0x20000
s_mov_b32 s36,s6
s_and_b32 s37,s7,0xffff
s_mov_b32 s38,0x400000
s_mov_b32 s39,0x20000
v_lshrrev_b32 v5,2,v3
v_lshl_add_u32 v5,v4,2,v5
v_and_b32 v6,3,v3
v_lshlrev_b32 v6,3,v6
v_lshl_add_u32 v6,v5,8,v6
v_and_b32 v5,7,v5
v_xor_b32 v5,s67,v5
v_lshl_add_u32 v12,v5,5,v6
v_xor_b32 v13,32,v12
v_and_b32 v5,15,v1
v_and_b32 v6,3,v4
v_lshlrev_b32 v6,1,v6
v_xor_b32 v5,v5,v6
v_mul_u32_u24 v6,2048,v4
v_xor_b32 v7,0,v5
v_lshl_add_u32 v8,v7,4,v6
v_xor_b32 v7,8,v5
v_lshl_add_u32 v9,v7,4,v6
s_mul_i32 s74,s50,131072
s_add_u32 s74,s74,s66
s_lshl_b32 s75,s50,14
s_mul_i32 s76,s50,65536
s_add_u32 s76,s76,s66
s_lshl_b32 s77,s50,13
s_add_u32 s64,s74,0
s_add_u32 m0,s75,0
s_nop 0
buffer_load_dwordx4 v8,s[32:35],s64 offen nt lds
s_add_u32 s64,s74,8192
s_add_u32 m0,s75,1024
s_nop 0
buffer_load_dwordx4 v9,s[32:35],s64 offen nt lds
s_add_u32 s64,s74,16384
s_add_u32 m0,s75,2048
s_nop 0
buffer_load_dwordx4 v8,s[32:35],s64 offen nt lds
s_add_u32 s64,s74,24576
s_add_u32 m0,s75,3072
s_nop 0
buffer_load_dwordx4 v9,s[32:35],s64 offen nt lds
s_add_u32 s64,s74,32768
s_add_u32 m0,s75,4096
s_nop 0
buffer_load_dwordx4 v8,s[32:35],s64 offen nt lds
s_add_u32 s64,s74,40960
s_add_u32 m0,s75,5120
s_nop 0
buffer_load_dwordx4 v9,s[32:35],s64 offen nt lds
s_add_u32 s64,s74,49152
s_add_u32 m0,s75,6144
s_nop 0
buffer_load_dwordx4 v8,s[32:35],s64 offen nt lds
s_add_u32 s64,s74,57344
s_add_u32 m0,s75,7168
s_nop 0
buffer_load_dwordx4 v9,s[32:35],s64 offen nt lds
s_add_u32 s64,s74,65536
s_add_u32 m0,s75,8192
s_nop 0
buffer_load_dwordx4 v8,s[32:35],s64 offen nt lds
s_add_u32 s64,s74,73728
s_add_u32 m0,s75,9216
s_nop 0
buffer_load_dwordx4 v9,s[32:35],s64 offen nt lds
s_add_u32 s64,s74,81920
s_add_u32 m0,s75,10240
s_nop 0
buffer_load_dwordx4 v8,s[32:35],s64 offen nt lds
s_add_u32 s64,s74,90112
s_add_u32 m0,s75,11264
s_nop 0
buffer_load_dwordx4 v9,s[32:35],s64 offen nt lds
s_add_u32 s64,s74,98304
s_add_u32 m0,s75,12288
s_nop 0
buffer_load_dwordx4 v8,s[32:35],s64 offen nt lds
s_add_u32 s64,s74,106496
s_add_u32 m0,s75,13312
s_nop 0
buffer_load_dwordx4 v9,s[32:35],s64 offen nt lds
s_add_u32 s64,s74,114688
s_add_u32 m0,s75,14336
s_nop 0
buffer_load_dwordx4 v8,s[32:35],s64 offen nt lds
s_add_u32 s64,s74,122880
s_add_u32 m0,s75,15360
s_nop 0
buffer_load_dwordx4 v9,s[32:35],s64 offen nt lds
s_add_u32 s64,s74,524288
s_add_u32 m0,s75,65536
s_nop 0
buffer_load_dwordx4 v8,s[32:35],s64 offen nt lds
s_add_u32 s64,s74,532480
s_add_u32 m0,s75,66560
s_nop 0
buffer_load_dwordx4 v9,s[32:35],s64 offen nt lds
s_add_u32 s64,s74,540672
s_add_u32 m0,s75,67584
s_nop 0
buffer_load_dwordx4 v8,s[32:35],s64 offen nt lds
s_add_u32 s64,s74,548864
s_add_u32 m0,s75,68608
s_nop 0
buffer_load_dwordx4 v9,s[32:35],s64 offen nt lds
s_add_u32 s64,s74,557056
s_add_u32 m0,s75,69632
s_nop 0
buffer_load_dwordx4 v8,s[32:35],s64 offen nt lds
s_add_u32 s64,s74,565248
s_add_u32 m0,s75,70656
s_nop 0
buffer_load_dwordx4 v9,s[32:35],s64 offen nt lds
s_add_u32 s64,s74,573440
s_add_u32 m0,s75,71680
s_nop 0
buffer_load_dwordx4 v8,s[32:35],s64 offen nt lds
s_add_u32 s64,s74,581632
s_add_u32 m0,s75,72704
s_nop 0
buffer_load_dwordx4 v9,s[32:35],s64 offen nt lds
s_add_u32 s64,s74,589824
s_add_u32 m0,s75,73728
s_nop 0
buffer_load_dwordx4 v8,s[32:35],s64 offen nt lds
s_add_u32 s64,s74,598016
s_add_u32 m0,s75,74752
s_nop 0
buffer_load_dwordx4 v9,s[32:35],s64 offen nt lds
s_add_u32 s64,s74,606208
s_add_u32 m0,s75,75776
s_nop 0
buffer_load_dwordx4 v8,s[32:35],s64 offen nt lds
s_add_u32 s64,s74,614400
s_add_u32 m0,s75,76800
s_nop 0
buffer_load_dwordx4 v9,s[32:35],s64 offen nt lds
s_add_u32 s64,s74,622592
s_add_u32 m0,s75,77824
s_nop 0
buffer_load_dwordx4 v8,s[32:35],s64 offen nt lds
s_add_u32 s64,s74,630784
s_add_u32 m0,s75,78848
s_nop 0
buffer_load_dwordx4 v9,s[32:35],s64 offen nt lds
s_add_u32 s64,s74,638976
s_add_u32 m0,s75,79872
s_nop 0
buffer_load_dwordx4 v8,s[32:35],s64 offen nt lds
s_add_u32 s64,s74,647168
s_add_u32 m0,s75,80896
s_nop 0
buffer_load_dwordx4 v9,s[32:35],s64 offen nt lds
s_waitcnt vmcnt(16)
s_barrier
ds_read_b64_tr_b16 a[0:1],v12 offset:0
ds_read_b64_tr_b16 a[128:129],v13 offset:0
ds_read_b64_tr_b16 a[2:3],v12 offset:4096
ds_read_b64_tr_b16 a[130:131],v13 offset:4096
ds_read_b64_tr_b16 a[4:5],v12 offset:8192
ds_read_b64_tr_b16 a[132:133],v13 offset:8192
ds_read_b64_tr_b16 a[6:7],v12 offset:12288
ds_read_b64_tr_b16 a[134:135],v13 offset:12288
s_waitcnt lgkmcnt(4)
ds_read_b64_tr_b16 a[8:9],v12 offset:16384
ds_read_b64_tr_b16 a[136:137],v13 offset:16384
ds_read_b64_tr_b16 a[10:11],v12 offset:20480
ds_read_b64_tr_b16 a[138:139],v13 offset:20480
ds_read_b64_tr_b16 a[12:13],v12 offset:24576
ds_read_b64_tr_b16 a[140:141],v13 offset:24576
ds_read_b64_tr_b16 a[14:15],v12 offset:28672
ds_read_b64_tr_b16 a[142:143],v13 offset:28672
s_waitcnt lgkmcnt(4)
ds_read_b64_tr_b16 a[16:17],v12 offset:32768
ds_read_b64_tr_b16 a[144:145],v13 offset:32768
ds_read_b64_tr_b16 a[18:19],v12 offset:36864
ds_read_b64_tr_b16 a[146:147],v13 offset:36864
ds_read_b64_tr_b16 a[20:21],v12 offset:40960
ds_read_b64_tr_b16 a[148:149],v13 offset:40960
ds_read_b64_tr_b16 a[22:23],v12 offset:45056
ds_read_b64_tr_b16 a[150:151],v13 offset:45056
s_waitcnt lgkmcnt(4)
ds_read_b64_tr_b16 a[24:25],v12 offset:49152
ds_read_b64_tr_b16 a[152:153],v13 offset:49152
ds_read_b64_tr_b16 a[26:27],v12 offset:53248
ds_read_b64_tr_b16 a[154:155],v13 offset:53248
ds_read_b64_tr_b16 a[28:29],v12 offset:57344
ds_read_b64_tr_b16 a[156:157],v13 offset:57344
ds_read_b64_tr_b16 a[30:31],v12 offset:61440
ds_read_b64_tr_b16 a[158:159],v13 offset:61440
s_waitcnt lgkmcnt(4)
v_xor_b32 v12,0x10000,v12
v_xor_b32 v13,0x10000,v13
s_waitcnt lgkmcnt(0)
s_barrier
s_add_u32 s64,s74,1048576
s_add_u32 m0,s75,0
s_nop 0
buffer_load_dwordx4 v8,s[32:35],s64 offen nt lds
s_add_u32 s64,s74,1056768
s_add_u32 m0,s75,1024
s_nop 0
buffer_load_dwordx4 v9,s[32:35],s64 offen nt lds
s_add_u32 s64,s74,1064960
s_add_u32 m0,s75,2048
s_nop 0
buffer_load_dwordx4 v8,s[32:35],s64 offen nt lds
s_add_u32 s64,s74,1073152
s_add_u32 m0,s75,3072
s_nop 0
buffer_load_dwordx4 v9,s[32:35],s64 offen nt lds
s_add_u32 s64,s74,1081344
s_add_u32 m0,s75,4096
s_nop 0
buffer_load_dwordx4 v8,s[32:35],s64 offen nt lds
s_add_u32 s64,s74,1089536
s_add_u32 m0,s75,5120
s_nop 0
buffer_load_dwordx4 v9,s[32:35],s64 offen nt lds
s_add_u32 s64,s74,1097728
s_add_u32 m0,s75,6144
s_nop 0
buffer_load_dwordx4 v8,s[32:35],s64 offen nt lds
s_add_u32 s64,s74,1105920
s_add_u32 m0,s75,7168
s_nop 0
buffer_load_dwordx4 v9,s[32:35],s64 offen nt lds
s_add_u32 s64,s74,1114112
s_add_u32 m0,s75,8192
s_nop 0
buffer_load_dwordx4 v8,s[32:35],s64 offen nt lds
s_add_u32 s64,s74,1122304
s_add_u32 m0,s75,9216
s_nop 0
buffer_load_dwordx4 v9,s[32:35],s64 offen nt lds
s_add_u32 s64,s74,1130496
s_add_u32 m0,s75,10240
s_nop 0
buffer_load_dwordx4 v8,s[32:35],s64 offen nt lds
s_add_u32 s64,s74,1138688
s_add_u32 m0,s75,11264
s_nop 0
buffer_load_dwordx4 v9,s[32:35],s64 offen nt lds
s_add_u32 s64,s74,1146880
s_add_u32 m0,s75,12288
s_nop 0
buffer_load_dwordx4 v8,s[32:35],s64 offen nt lds
s_add_u32 s64,s74,1155072
s_add_u32 m0,s75,13312
s_nop 0
buffer_load_dwordx4 v9,s[32:35],s64 offen nt lds
s_add_u32 s64,s74,1163264
s_add_u32 m0,s75,14336
s_nop 0
buffer_load_dwordx4 v8,s[32:35],s64 offen nt lds
s_add_u32 s64,s74,1171456
s_add_u32 m0,s75,15360
s_nop 0
buffer_load_dwordx4 v9,s[32:35],s64 offen nt lds
s_waitcnt vmcnt(16)
s_barrier
ds_read_b64_tr_b16 a[32:33],v12 offset:0
ds_read_b64_tr_b16 a[160:161],v13 offset:0
ds_read_b64_tr_b16 a[34:35],v12 offset:4096
ds_read_b64_tr_b16 a[162:163],v13 offset:4096
ds_read_b64_tr_b16 a[36:37],v12 offset:8192
ds_read_b64_tr_b16 a[164:165],v13 offset:8192
ds_read_b64_tr_b16 a[38:39],v12 offset:12288
ds_read_b64_tr_b16 a[166:167],v13 offset:12288
s_waitcnt lgkmcnt(4)
ds_read_b64_tr_b16 a[40:41],v12 offset:16384
ds_read_b64_tr_b16 a[168:169],v13 offset:16384
ds_read_b64_tr_b16 a[42:43],v12 offset:20480
ds_read_b64_tr_b16 a[170:171],v13 offset:20480
ds_read_b64_tr_b16 a[44:45],v12 offset:24576
ds_read_b64_tr_b16 a[172:173],v13 offset:24576
ds_read_b64_tr_b16 a[46:47],v12 offset:28672
ds_read_b64_tr_b16 a[174:175],v13 offset:28672
s_waitcnt lgkmcnt(4)
ds_read_b64_tr_b16 a[48:49],v12 offset:32768
ds_read_b64_tr_b16 a[176:177],v13 offset:32768
ds_read_b64_tr_b16 a[50:51],v12 offset:36864
ds_read_b64_tr_b16 a[178:179],v13 offset:36864
ds_read_b64_tr_b16 a[52:53],v12 offset:40960
ds_read_b64_tr_b16 a[180:181],v13 offset:40960
ds_read_b64_tr_b16 a[54:55],v12 offset:45056
ds_read_b64_tr_b16 a[182:183],v13 offset:45056
s_waitcnt lgkmcnt(4)
ds_read_b64_tr_b16 a[56:57],v12 offset:49152
ds_read_b64_tr_b16 a[184:185],v13 offset:49152
ds_read_b64_tr_b16 a[58:59],v12 offset:53248
ds_read_b64_tr_b16 a[186:187],v13 offset:53248
ds_read_b64_tr_b16 a[60:61],v12 offset:57344
ds_read_b64_tr_b16 a[188:189],v13 offset:57344
ds_read_b64_tr_b16 a[62:63],v12 offset:61440
ds_read_b64_tr_b16 a[190:191],v13 offset:61440
s_waitcnt lgkmcnt(4)
v_xor_b32 v12,0x10000,v12
v_xor_b32 v13,0x10000,v13
s_waitcnt lgkmcnt(0)
s_barrier
s_add_u32 s64,s74,1572864
s_add_u32 m0,s75,65536
s_nop 0
buffer_load_dwordx4 v8,s[32:35],s64 offen nt lds
s_add_u32 s64,s74,1581056
s_add_u32 m0,s75,66560
s_nop 0
buffer_load_dwordx4 v9,s[32:35],s64 offen nt lds
s_add_u32 s64,s74,1589248
s_add_u32 m0,s75,67584
s_nop 0
buffer_load_dwordx4 v8,s[32:35],s64 offen nt lds
s_add_u32 s64,s74,1597440
s_add_u32 m0,s75,68608
s_nop 0
buffer_load_dwordx4 v9,s[32:35],s64 offen nt lds
s_add_u32 s64,s74,1605632
s_add_u32 m0,s75,69632
s_nop 0
buffer_load_dwordx4 v8,s[32:35],s64 offen nt lds
s_add_u32 s64,s74,1613824
s_add_u32 m0,s75,70656
s_nop 0
buffer_load_dwordx4 v9,s[32:35],s64 offen nt lds
s_add_u32 s64,s74,1622016
s_add_u32 m0,s75,71680
s_nop 0
buffer_load_dwordx4 v8,s[32:35],s64 offen nt lds
s_add_u32 s64,s74,1630208
s_add_u32 m0,s75,72704
s_nop 0
buffer_load_dwordx4 v9,s[32:35],s64 offen nt lds
s_add_u32 s64,s74,1638400
s_add_u32 m0,s75,73728
s_nop 0
buffer_load_dwordx4 v8,s[32:35],s64 offen nt lds
s_add_u32 s64,s74,1646592
s_add_u32 m0,s75,74752
s_nop 0
buffer_load_dwordx4 v9,s[32:35],s64 offen nt lds
s_add_u32 s64,s74,1654784
s_add_u32 m0,s75,75776
s_nop 0
buffer_load_dwordx4 v8,s[32:35],s64 offen nt lds
s_add_u32 s64,s74,1662976
s_add_u32 m0,s75,76800
s_nop 0
buffer_load_dwordx4 v9,s[32:35],s64 offen nt lds
s_add_u32 s64,s74,1671168
s_add_u32 m0,s75,77824
s_nop 0
buffer_load_dwordx4 v8,s[32:35],s64 offen nt lds
s_add_u32 s64,s74,1679360
s_add_u32 m0,s75,78848
s_nop 0
buffer_load_dwordx4 v9,s[32:35],s64 offen nt lds
s_add_u32 s64,s74,1687552
s_add_u32 m0,s75,79872
s_nop 0
buffer_load_dwordx4 v8,s[32:35],s64 offen nt lds
s_add_u32 s64,s74,1695744
s_add_u32 m0,s75,80896
s_nop 0
buffer_load_dwordx4 v9,s[32:35],s64 offen nt lds
s_waitcnt vmcnt(16)
s_barrier
ds_read_b64_tr_b16 a[64:65],v12 offset:0
ds_read_b64_tr_b16 a[192:193],v13 offset:0
ds_read_b64_tr_b16 a[66:67],v12 offset:4096
ds_read_b64_tr_b16 a[194:195],v13 offset:4096
ds_read_b64_tr_b16 a[68:69],v12 offset:8192
ds_read_b64_tr_b16 a[196:197],v13 offset:8192
ds_read_b64_tr_b16 a[70:71],v12 offset:12288
ds_read_b64_tr_b16 a[198:199],v13 offset:12288
s_waitcnt lgkmcnt(4)
ds_read_b64_tr_b16 a[72:73],v12 offset:16384
ds_read_b64_tr_b16 a[200:201],v13 offset:16384
ds_read_b64_tr_b16 a[74:75],v12 offset:20480
ds_read_b64_tr_b16 a[202:203],v13 offset:20480
ds_read_b64_tr_b16 a[76:77],v12 offset:24576
ds_read_b64_tr_b16 a[204:205],v13 offset:24576
ds_read_b64_tr_b16 a[78:79],v12 offset:28672
ds_read_b64_tr_b16 a[206:207],v13 offset:28672
s_waitcnt lgkmcnt(4)
ds_read_b64_tr_b16 a[80:81],v12 offset:32768
ds_read_b64_tr_b16 a[208:209],v13 offset:32768
ds_read_b64_tr_b16 a[82:83],v12 offset:36864
ds_read_b64_tr_b16 a[210:211],v13 offset:36864
ds_read_b64_tr_b16 a[84:85],v12 offset:40960
ds_read_b64_tr_b16 a[212:213],v13 offset:40960
ds_read_b64_tr_b16 a[86:87],v12 offset:45056
ds_read_b64_tr_b16 a[214:215],v13 offset:45056
s_waitcnt lgkmcnt(4)
ds_read_b64_tr_b16 a[88:89],v12 offset:49152
ds_read_b64_tr_b16 a[216:217],v13 offset:49152
ds_read_b64_tr_b16 a[90:91],v12 offset:53248
ds_read_b64_tr_b16 a[218:219],v13 offset:53248
ds_read_b64_tr_b16 a[92:93],v12 offset:57344
ds_read_b64_tr_b16 a[220:221],v13 offset:57344
ds_read_b64_tr_b16 a[94:95],v12 offset:61440
ds_read_b64_tr_b16 a[222:223],v13 offset:61440
s_waitcnt lgkmcnt(4)
v_xor_b32 v12,0x10000,v12
v_xor_b32 v13,0x10000,v13
s_waitcnt lgkmcnt(0)
s_barrier
s_waitcnt vmcnt(0)
s_barrier
ds_read_b64_tr_b16 a[96:97],v12 offset:0
ds_read_b64_tr_b16 a[224:225],v13 offset:0
ds_read_b64_tr_b16 a[98:99],v12 offset:4096
ds_read_b64_tr_b16 a[226:227],v13 offset:4096
ds_read_b64_tr_b16 a[100:101],v12 offset:8192
ds_read_b64_tr_b16 a[228:229],v13 offset:8192
ds_read_b64_tr_b16 a[102:103],v12 offset:12288
ds_read_b64_tr_b16 a[230:231],v13 offset:12288
s_waitcnt lgkmcnt(4)
ds_read_b64_tr_b16 a[104:105],v12 offset:16384
ds_read_b64_tr_b16 a[232:233],v13 offset:16384
ds_read_b64_tr_b16 a[106:107],v12 offset:20480
ds_read_b64_tr_b16 a[234:235],v13 offset:20480
ds_read_b64_tr_b16 a[108:109],v12 offset:24576
ds_read_b64_tr_b16 a[236:237],v13 offset:24576
ds_read_b64_tr_b16 a[110:111],v12 offset:28672
ds_read_b64_tr_b16 a[238:239],v13 offset:28672
s_waitcnt lgkmcnt(4)
ds_read_b64_tr_b16 a[112:113],v12 offset:32768
ds_read_b64_tr_b16 a[240:241],v13 offset:32768
ds_read_b64_tr_b16 a[114:115],v12 offset:36864
ds_read_b64_tr_b16 a[242:243],v13 offset:36864
ds_read_b64_tr_b16 a[116:117],v12 offset:40960
ds_read_b64_tr_b16 a[244:245],v13 offset:40960
ds_read_b64_tr_b16 a[118:119],v12 offset:45056
ds_read_b64_tr_b16 a[246:247],v13 offset:45056
s_waitcnt lgkmcnt(4)
ds_read_b64_tr_b16 a[120:121],v12 offset:49152
ds_read_b64_tr_b16 a[248:249],v13 offset:49152
ds_read_b64_tr_b16 a[122:123],v12 offset:53248
ds_read_b64_tr_b16 a[250:251],v13 offset:53248
ds_read_b64_tr_b16 a[124:125],v12 offset:57344
ds_read_b64_tr_b16 a[252:253],v13 offset:57344
ds_read_b64_tr_b16 a[126:127],v12 offset:61440
ds_read_b64_tr_b16 a[254:255],v13 offset:61440
s_waitcnt lgkmcnt(4)
v_xor_b32 v12,0x10000,v12
v_xor_b32 v13,0x10000,v13
s_waitcnt lgkmcnt(0)
s_barrier
v_and_b32 v21,1,v1
v_mul_u32_u24 v21,960,v21
s_mov_b32 s65,21052032
s_mov_b32 s66,1792
pl_286:
buffer_load_dword v22,v21,s[20:23],s65 offen sc1
s_waitcnt vmcnt(0)
v_cmp_gt_u32 vcc,s66,v22
s_cbranch_vccz pok_287
s_sleep 1
s_sub_u32 s90,s90,1
s_cmp_gt_i32 s90,0
s_cbranch_scc1 pl_286
pok_287:
s_lshr_b32 s43,s41,1
s_and_b32 s48,s41,1
s_lshl_b32 s64,s42,7
s_lshl_b32 s65,s50,5
s_add_u32 s64,s64,s65
s_lshl_b32 s65,s48,4
s_add_u32 s64,s64,s65
v_lshl_add_u32 v5,v4,2,s64
v_lshlrev_b32 v6,2,v5
s_mov_b32 s64,8192
buffer_load_dwordx4 v[52:55],v6,s[20:23],s64 offen sc1
v_lshlrev_b32 v10,1,v5
v_and_b32 v6,3,v1
v_sub_u32 v5,v6,v4
v_lshl_add_u32 v5,v5,3,v10
v_lshrrev_b32 v11,2,v1
v_lshl_add_u32 v40,v6,4,v11
v_lshlrev_b32 v40,2,v40
v_lshl_add_u32 v41,v3,2,v4
v_lshlrev_b32 v41,2,v41
s_lshl_b32 s64,s43,10
v_add_u32 v17,s64,v16
v_xor_b32 v18,1024,v17
s_xor_b32 s64,s64,1024
s_lshr_b32 s65,s50,1
s_and_b32 s66,s50,1
s_lshl_b32 s66,s66,12
s_add_u32 s66,s66,s64
s_lshl_b32 s72,s65,13
s_add_u32 s72,s72,s66
s_add_u32 s72,s72,0x10000
s_lshl_b32 s65,s65,14
s_add_u32 s75,s65,s66
s_add_u32 s75,s75,524288
s_mul_i32 s64,s41,131072
s_add_u32 s75,s75,s64
s_cmp_lt_u32 s50,2
s_cselect_b32 s86,98304,0x40000000
s_lshl_b32 s76,s79,21
s_add_u32 s76,s76,27262976
s_mov_b32 s77,0
s_lshl_b32 s78,s79,16
s_mov_b32 s49,0
s_cmp_eq_u32 s79,0
s_mov_b32 s66,8577024
s_cselect_b32 s66,17825792,s66
s_lshl_b32 s64,s59,14
s_lshl_b32 s65,s50,12
s_add_u32 s65,s65,s66
s_add_u32 s64,s64,s65
v_add_u32 v26,s64,v16
s_lshl_b32 s64,s42,14
s_add_u32 s64,s64,s65
v_add_u32 v25,s64,v16
s_xor_b32 s33,s41,1
s_xor_b32 s34,s41,2
s_xor_b32 s35,s41,3
s_lshl_b32 s33,s33,17
s_lshl_b32 s34,s34,17
s_lshl_b32 s35,s35,17
v_and_b32 v21,7,v1
v_lshlrev_b32 v21,7,v21
v_bfe_u32 v6,v1,3,0
v_lshl_add_u32 v21,v6,2,v21
s_lshl_b32 s74,s41,10
s_add_u32 s74,s74,s63
s_lshl_b32 s64,s60,4
s_add_u32 s74,s74,s64
s_add_u32 s74,s74,16384
v_lshrrev_b32 v6,2,v11
v_and_b32 v7,3,v11
v_lshl_add_u32 v6,v6,1,s43
v_lshl_add_u32 v8,v6,2,v7
v_lshl_add_u32 v8,v8,7,v5
v_and_b32 v8,2047,v8
v_lshl_add_u32 v8,v7,11,v8
v_lshl_add_u32 v7,v7,11,v5
v_lshl_add_u32 v20,v6,13,v7
v_lshl_add_u32 v19,v6,14,v8
v_add_u32 v19,1048576,v19
s_lshl_b32 s73,s59,2
s_add_u32 s73,s73,s50
s_lshl_b32 s73,s73,2
s_add_u32 s73,s73,s63
s_add_u32 s73,s73,2048
s_mov_b32 s48,1
s_waitcnt vmcnt(0)
s_cmp_lg_u32 s56,0
s_cbranch_scc1 kslow_288
s_add_u32 s64,s79,0
s_lshl_b32 s70,s64,21
s_lshl_b32 s64,s64,13
s_and_b32 s64,s64,0x2000
s_xor_b32 s64,s64,s62
s_add_u32 s70,s70,s64
s_add_u32 s70,s70,29360128
s_mov_b32 s83,1
s_mov_b32 s87,s74
s_cmp_eq_u32 s50,0
s_cselect_b32 s74,s74,0x7fff0000
v_mov_b32 v47,132096
s_lshl_b32 s64,s50,3
s_add_u32 s64,s64,132096
v_mov_b32 v46,s64
v_mov_b32 v29,0
s_mov_b32 s97,0x7fff0000
s_mov_b32 s69,1
s_mov_b32 s68,0
s_mov_b32 s52,0x30003
s_mov_b32 s53,s52
seg_290:
s_cmp_eq_u32 s83,0
s_cbranch_scc1 ahead_291
s_add_u32 s94,s70,s75
s_xor_b32 s95,s94,1024
s_xor_b32 s91,s72,0x10000
s_waitcnt vmcnt(2)
v_cmp_gt_u32 vcc,s71,v29
s_cbranch_vccz nb_294
s_waitcnt vmcnt(0)
v_add_u32 v22,s71,-1
buffer_store_dword v22,v23,s[20:23],s97 offen sc1
s_mov_b32 s97,0x7fff0000
s_cmp_lg_u32 s50,0
s_cbranch_scc1 nb_294
buffer_load_dword v32,v21,s[20:23],s74 offen sc1
s_sleep 2
pl_296:
buffer_load_dword v33,v21,s[20:23],s74 offen sc1
s_waitcnt vmcnt(1)
v_cmp_gt_u32 vcc,s71,v32
v_mov_b32 v29,v32
s_cbranch_vccz pok_297
buffer_load_dword v32,v21,s[20:23],s74 offen sc1
s_waitcnt vmcnt(1)
v_cmp_gt_u32 vcc,s71,v33
v_mov_b32 v29,v33
s_cbranch_vccz pok_297
s_sub_u32 s90,s90,1
s_cmp_gt_i32 s90,0
s_cbranch_scc1 pl_296
pok_297:
nb_294:
s_barrier
s_xor_b32 m0,s91,0
s_add_u32 s65,s94,0
buffer_load_dwordx4 v16,s[20:23],s65 offen offset:0 sc1 lds
buffer_load_dwordx4 v16,s[20:23],s65 offen offset:2048 sc1 lds
s_xor_b32 m0,s91,16384
s_add_u32 s65,s94,32768
buffer_load_dwordx4 v16,s[20:23],s65 offen offset:0 sc1 lds
buffer_load_dwordx4 v16,s[20:23],s65 offen offset:2048 sc1 lds
s_xor_b32 m0,s91,32768
s_add_u32 s65,s94,65536
buffer_load_dwordx4 v16,s[20:23],s65 offen offset:0 sc1 lds
buffer_load_dwordx4 v16,s[20:23],s65 offen offset:2048 sc1 lds
s_xor_b32 m0,s91,49152
s_add_u32 s65,s94,98304
buffer_load_dwordx4 v16,s[20:23],s65 offen offset:0 sc1 lds
buffer_load_dwordx4 v16,s[20:23],s65 offen offset:2048 sc1 lds
s_waitcnt vmcnt(8)
v_add_u32 v22,s71,-1
buffer_store_dword v22,v23,s[20:23],s97 offen sc1
s_mov_b32 s97,0x7fff0000
s_waitcnt vmcnt(7)
s_barrier
ds_read_b128 v[224:227],v18 offset:0
ds_read_b128 v[228:231],v18 offset:2048
ds_read_b128 v[232:235],v18 offset:4096
ds_read_b128 v[236:239],v18 offset:6144
ds_read_b128 v[240:243],v18 offset:8192
ds_read_b128 v[244:247],v18 offset:10240
ds_read_b128 v[248:251],v18 offset:12288
s_waitcnt lgkmcnt(5)
v_mfma_f32_16x16x32_bf16 v[64:67],a[0:3],v[224:227],0
s_xor_b32 m0,s91,1024
s_add_u32 s96,s71,1
v_mfma_f32_16x16x32_bf16 v[68:71],a[128:131],v[224:227],0
ds_read_b128 v[252:255],v18 offset:14336
s_add_u32 s92,s71,2
v_mfma_f32_16x16x32_bf16 v[64:67],a[4:7],v[228:231],v[64:67]
s_add_u32 s65,s95,0
v_min_u32 v27,v224,v228
v_mfma_f32_16x16x32_bf16 v[68:71],a[132:135],v[228:231],v[68:71]
s_waitcnt vmcnt(5)
s_barrier
ds_read_b128 v[224:227],v18 offset:16384
s_waitcnt lgkmcnt(5)
v_mfma_f32_16x16x32_bf16 v[64:67],a[8:11],v[232:235],v[64:67]
buffer_load_dwordx4 v16,s[20:23],s65 offen offset:0 sc1 lds
v_mfma_f32_16x16x32_bf16 v[68:71],a[136:139],v[232:235],v[68:71]
ds_read_b128 v[228:231],v18 offset:18432
v_min3_u32 v27,v27,v232,v236
v_mfma_f32_16x16x32_bf16 v[64:67],a[12:15],v[236:239],v[64:67]
buffer_load_dwordx4 v16,s[20:23],s65 offen offset:2048 sc1 lds
v_mfma_f32_16x16x32_bf16 v[68:71],a[140:143],v[236:239],v[68:71]
ds_read_b128 v[232:235],v18 offset:20480
s_waitcnt lgkmcnt(5)
v_mfma_f32_16x16x32_bf16 v[64:67],a[16:19],v[240:243],v[64:67]
s_xor_b32 m0,s91,17408
v_min3_u32 v27,v27,v240,v244
v_mfma_f32_16x16x32_bf16 v[68:71],a[144:147],v[240:243],v[68:71]
ds_read_b128 v[236:239],v18 offset:22528
v_mfma_f32_16x16x32_bf16 v[64:67],a[20:23],v[244:247],v[64:67]
s_add_u32 s65,s95,32768
v_mfma_f32_16x16x32_bf16 v[68:71],a[148:151],v[244:247],v[68:71]
ds_read_b128 v[240:243],v18 offset:24576
s_waitcnt lgkmcnt(5)
v_mfma_f32_16x16x32_bf16 v[64:67],a[24:27],v[248:251],v[64:67]
buffer_load_dwordx4 v16,s[20:23],s65 offen offset:0 sc1 lds
v_mfma_f32_16x16x32_bf16 v[68:71],a[152:155],v[248:251],v[68:71]
ds_read_b128 v[244:247],v18 offset:26624
v_min3_u32 v27,v27,v248,v252
v_mfma_f32_16x16x32_bf16 v[64:67],a[28:31],v[252:255],v[64:67]
buffer_load_dwordx4 v16,s[20:23],s65 offen offset:2048 sc1 lds
v_mfma_f32_16x16x32_bf16 v[68:71],a[156:159],v[252:255],v[68:71]
ds_read_b128 v[248:251],v18 offset:28672
s_waitcnt lgkmcnt(5)
v_mfma_f32_16x16x32_bf16 v[64:67],a[32:35],v[224:227],v[64:67]
s_xor_b32 m0,s91,33792
v_min3_u32 v27,v27,v224,v228
v_mfma_f32_16x16x32_bf16 v[68:71],a[160:163],v[224:227],v[68:71]
ds_read_b128 v[252:255],v18 offset:30720
v_mfma_f32_16x16x32_bf16 v[64:67],a[36:39],v[228:231],v[64:67]
s_add_u32 s65,s95,65536
s_waitcnt vmcnt(63)
v_mfma_f32_16x16x32_bf16 v[68:71],a[164:167],v[228:231],v[68:71]
s_waitcnt vmcnt(5)
s_barrier
ds_read_b128 v[224:227],v18 offset:32768
s_waitcnt lgkmcnt(5)
v_mfma_f32_16x16x32_bf16 v[64:67],a[40:43],v[232:235],v[64:67]
buffer_load_dwordx4 v16,s[20:23],s65 offen offset:0 sc1 lds
v_min3_u32 v27,v27,v232,v236
v_mfma_f32_16x16x32_bf16 v[68:71],a[168:171],v[232:235],v[68:71]
ds_read_b128 v[228:231],v18 offset:34816
v_cmp_gt_u32 vcc,s96,v29
v_cmp_gt_u32 s[92:93],s92,v29
v_mfma_f32_16x16x32_bf16 v[64:67],a[44:47],v[236:239],v[64:67]
buffer_load_dwordx4 v16,s[20:23],s65 offen offset:2048 sc1 lds
v_mfma_f32_16x16x32_bf16 v[68:71],a[172:175],v[236:239],v[68:71]
ds_read_b128 v[232:235],v18 offset:36864
s_waitcnt lgkmcnt(5)
v_mfma_f32_16x16x32_bf16 v[64:67],a[48:51],v[240:243],v[64:67]
s_xor_b32 m0,s91,50176
v_mov_b32 v44,vcc_lo
v_mov_b32 v45,s92
v_mfma_f32_16x16x32_bf16 v[68:71],a[176:179],v[240:243],v[68:71]
ds_read_b128 v[236:239],v18 offset:38912
ds_write_b64 v46,v[44:45]
v_mfma_f32_16x16x32_bf16 v[64:67],a[52:55],v[244:247],v[64:67]
s_add_u32 s65,s95,98304
v_min3_u32 v27,v27,v240,v244
v_mfma_f32_16x16x32_bf16 v[68:71],a[180:183],v[244:247],v[68:71]
ds_read_b128 v[240:243],v18 offset:40960
s_waitcnt lgkmcnt(6)
v_mfma_f32_16x16x32_bf16 v[64:67],a[56:59],v[248:251],v[64:67]
buffer_load_dwordx4 v16,s[20:23],s65 offen offset:0 sc1 lds
v_mfma_f32_16x16x32_bf16 v[68:71],a[184:187],v[248:251],v[68:71]
ds_read_b128 v[244:247],v18 offset:43008
v_min3_u32 v27,v27,v248,v252
v_mfma_f32_16x16x32_bf16 v[64:67],a[60:63],v[252:255],v[64:67]
buffer_load_dwordx4 v16,s[20:23],s65 offen offset:2048 sc1 lds
v_mfma_f32_16x16x32_bf16 v[68:71],a[188:191],v[252:255],v[68:71]
ds_read_b128 v[248:251],v18 offset:45056
s_waitcnt lgkmcnt(6)
v_mfma_f32_16x16x32_bf16 v[64:67],a[64:67],v[224:227],v[64:67]
v_min3_u32 v27,v27,v224,v228
s_add_u32 s88,s70,s75
v_mfma_f32_16x16x32_bf16 v[68:71],a[192:195],v[224:227],v[68:71]
ds_read_b128 v[252:255],v18 offset:47104
s_add_u32 s88,s88,2097152
v_mfma_f32_16x16x32_bf16 v[64:67],a[68:71],v[228:231],v[64:67]
buffer_load_dwordx2 v[120:121],v20,s[36:39],s78 offen
v_mfma_f32_16x16x32_bf16 v[68:71],a[196:199],v[228:231],v[68:71]
ds_read_b128 v[224:227],v18 offset:49152
s_waitcnt lgkmcnt(6)
v_mfma_f32_16x16x32_bf16 v[64:67],a[72:75],v[232:235],v[64:67]
v_min3_u32 v27,v27,v232,v236
s_xor_b32 s88,s88,0x2000
v_mfma_f32_16x16x32_bf16 v[68:71],a[200:203],v[232:235],v[68:71]
ds_read_b128 v[228:231],v18 offset:51200
s_xor_b32 s89,s88,1024
v_mfma_f32_16x16x32_bf16 v[64:67],a[76:79],v[236:239],v[64:67]
v_mfma_f32_16x16x32_bf16 v[68:71],a[204:207],v[236:239],v[68:71]
ds_read_b128 v[232:235],v18 offset:53248
s_waitcnt lgkmcnt(5)
v_mfma_f32_16x16x32_bf16 v[64:67],a[80:83],v[240:243],v[64:67]
s_waitcnt vmcnt(5)
s_barrier
ds_read_b64 v[44:45],v47
ds_read_b128 v[128:131],v17 offset:0
ds_read_b128 v[132:135],v17 offset:2048
v_mfma_f32_16x16x32_bf16 v[68:71],a[208:211],v[240:243],v[68:71]
ds_read_b128 v[236:239],v18 offset:55296
v_min3_u32 v27,v27,v240,v244
v_mfma_f32_16x16x32_bf16 v[64:67],a[84:87],v[244:247],v[64:67]
ds_read_b128 v[136:139],v17 offset:4096
v_mfma_f32_16x16x32_bf16 v[68:71],a[212:215],v[244:247],v[68:71]
ds_read_b128 v[240:243],v18 offset:57344
s_waitcnt lgkmcnt(9)
v_mfma_f32_16x16x32_bf16 v[64:67],a[88:91],v[248:251],v[64:67]
ds_read_b128 v[140:143],v17 offset:6144
v_min3_u32 v27,v27,v248,v252
v_mfma_f32_16x16x32_bf16 v[68:71],a[216:219],v[248:251],v[68:71]
ds_read_b128 v[244:247],v18 offset:59392
v_mfma_f32_16x16x32_bf16 v[64:67],a[92:95],v[252:255],v[64:67]
ds_read_b128 v[144:147],v17 offset:8192
ds_read_b128 v[148:151],v17 offset:10240
v_mfma_f32_16x16x32_bf16 v[68:71],a[220:223],v[252:255],v[68:71]
ds_read_b128 v[248:251],v18 offset:61440
s_waitcnt lgkmcnt(12)
v_mfma_f32_16x16x32_bf16 v[64:67],a[96:99],v[224:227],v[64:67]
ds_read_b128 v[152:155],v17 offset:12288
s_waitcnt lgkmcnt(11)
v_min3_u32 v27,v27,v224,v228
v_mfma_f32_16x16x32_bf16 v[68:71],a[224:227],v[224:227],v[68:71]
ds_read_b128 v[252:255],v18 offset:63488
v_readfirstlane_b32 s93,v45
v_mfma_f32_16x16x32_bf16 v[64:67],a[100:103],v[228:231],v[64:67]
ds_read_b128 v[156:159],v17 offset:14336
v_readfirstlane_b32 s83,v44
s_cmp_lg_u32 s83,0
s_cbranch_scc0 keep_300
v_mfma_f32_16x16x32_bf16 v[68:71],a[228:231],v[228:231],v[68:71]
s_waitcnt lgkmcnt(10)
v_mfma_f32_16x16x32_bf16 v[64:67],a[104:107],v[232:235],v[64:67]
ds_read_b128 v[160:163],v17 offset:16384
ds_read_b128 v[164:167],v17 offset:18432
v_mfma_f32_16x16x32_bf16 v[68:71],a[232:235],v[232:235],v[68:71]
v_min3_u32 v27,v27,v232,v236
v_mfma_f32_16x16x32_bf16 v[64:67],a[108:111],v[236:239],v[64:67]
ds_read_b128 v[168:171],v17 offset:20480
v_mfma_f32_16x16x32_bf16 v[68:71],a[236:239],v[236:239],v[68:71]
s_waitcnt lgkmcnt(9)
v_mfma_f32_16x16x32_bf16 v[64:67],a[112:115],v[240:243],v[64:67]
ds_read_b128 v[172:175],v17 offset:22528
v_min3_u32 v27,v27,v240,v244
v_mfma_f32_16x16x32_bf16 v[68:71],a[240:243],v[240:243],v[68:71]
v_mfma_f32_16x16x32_bf16 v[64:67],a[116:119],v[244:247],v[64:67]
ds_read_b128 v[176:179],v17 offset:24576
ds_read_b128 v[180:183],v17 offset:26624
v_mfma_f32_16x16x32_bf16 v[68:71],a[244:247],v[244:247],v[68:71]
s_waitcnt lgkmcnt(7)
v_mfma_f32_16x16x32_bf16 v[64:67],a[120:123],v[248:251],v[64:67]
ds_read_b128 v[184:187],v17 offset:28672
v_min3_u32 v27,v27,v248,v252
v_mfma_f32_16x16x32_bf16 v[68:71],a[248:251],v[248:251],v[68:71]
v_mfma_f32_16x16x32_bf16 v[64:67],a[124:127],v[252:255],v[64:67]
ds_read_b128 v[188:191],v17 offset:30720
v_mfma_f32_16x16x32_bf16 v[68:71],a[252:255],v[252:255],v[68:71]
v_mfma_f32_16x16x32_bf16 v[72:75],a[128:131],v[128:131],0
v_cmp_eq_u32 vcc,0,v27
s_cbranch_vccnz retry_289
v_mfma_f32_16x16x32_bf16 v[76:79],a[132:135],v[132:135],0
v_min3_u32 v27,v27,v128,v132
v_mfma_f32_16x16x32_bf16 v[72:75],a[136:139],v[136:139],v[72:75]
s_waitcnt vmcnt(1)
s_barrier
ds_read_b128 v[192:195],v17 offset:32768
v_mfma_f32_16x16x32_bf16 v[76:79],a[140:143],v[140:143],v[76:79]
ds_read_b128 v[196:199],v17 offset:34816
s_waitcnt lgkmcnt(10)
v_mfma_f32_16x16x32_bf16 v[72:75],a[144:147],v[144:147],v[72:75]
ds_read_b128 v[200:203],v17 offset:36864
v_min3_u32 v27,v27,v136,v140
s_waitcnt vmcnt(0)
v_mfma_f32_16x16x32_bf16 v[76:79],a[148:151],v[148:151],v[76:79]
ds_read_b128 v[204:207],v17 offset:38912
v_min3_u32 v27,v27,v144,v148
v_and_or_b32 v64,v64,-4,s48
v_mfma_f32_16x16x32_bf16 v[72:75],a[152:155],v[152:155],v[72:75]
ds_read_b128 v[208:211],v17 offset:40960
s_add_u32 s64,s49,s34
v_mfma_f32_16x16x32_bf16 v[76:79],a[156:159],v[156:159],v[76:79]
v_min3_u32 v27,v27,v152,v156
s_waitcnt lgkmcnt(9)
v_mfma_f32_16x16x32_bf16 v[72:75],a[160:163],v[160:163],v[72:75]
ds_read_b128 v[212:215],v17 offset:43008
buffer_store_dwordx4 v[64:67],v25,s[20:23],s64 offen offset:2048
v_mfma_f32_16x16x32_bf16 v[76:79],a[164:167],v[164:167],v[76:79]
ds_read_b128 v[216:219],v17 offset:45056
v_min3_u32 v27,v27,v160,v164
v_and_or_b32 v68,v68,-4,s48
v_mfma_f32_16x16x32_bf16 v[72:75],a[168:171],v[168:171],v[72:75]
ds_read_b128 v[220:223],v17 offset:47104
s_add_u32 s64,s49,s35
v_mfma_f32_16x16x32_bf16 v[76:79],a[172:175],v[172:175],v[76:79]
ds_read_b128 v[224:227],v17 offset:49152
s_waitcnt lgkmcnt(9)
v_mfma_f32_16x16x32_bf16 v[72:75],a[176:179],v[176:179],v[72:75]
ds_read_b128 v[228:231],v17 offset:51200
v_min3_u32 v27,v27,v168,v172
v_mfma_f32_16x16x32_bf16 v[76:79],a[180:183],v[180:183],v[76:79]
v_min3_u32 v27,v27,v176,v180
buffer_store_dwordx4 v[68:71],v25,s[20:23],s64 offen offset:3072
v_mfma_f32_16x16x32_bf16 v[72:75],a[184:187],v[184:187],v[72:75]
ds_read_b128 v[232:235],v17 offset:53248
s_mov_b32 s49,0x7fff0000
v_mfma_f32_16x16x32_bf16 v[76:79],a[188:191],v[188:191],v[76:79]
ds_read_b128 v[236:239],v17 offset:55296
s_waitcnt lgkmcnt(8)
v_mfma_f32_16x16x32_bf16 v[72:75],a[192:195],v[192:195],v[72:75]
ds_read_b128 v[240:243],v17 offset:57344
v_min3_u32 v27,v27,v184,v188
v_mfma_f32_16x16x32_bf16 v[76:79],a[196:199],v[196:199],v[76:79]
ds_read_b128 v[244:247],v17 offset:59392
v_min3_u32 v27,v27,v192,v196
v_mfma_f32_16x16x32_bf16 v[72:75],a[200:203],v[200:203],v[72:75]
ds_read_b128 v[248:251],v17 offset:61440
ds_bpermute_b32 v124,v41,v120
v_mfma_f32_16x16x32_bf16 v[76:79],a[204:207],v[204:207],v[76:79]
v_min3_u32 v27,v27,v200,v204
s_waitcnt lgkmcnt(8)
v_mfma_f32_16x16x32_bf16 v[72:75],a[208:211],v[208:211],v[72:75]
ds_read_b128 v[252:255],v17 offset:63488
ds_bpermute_b32 v125,v41,v121
v_mfma_f32_16x16x32_bf16 v[76:79],a[212:215],v[212:215],v[76:79]
v_min3_u32 v27,v27,v208,v212
v_mfma_f32_16x16x32_bf16 v[72:75],a[216:219],v[216:219],v[72:75]
v_mfma_f32_16x16x32_bf16 v[76:79],a[220:223],v[220:223],v[76:79]
v_min3_u32 v27,v27,v216,v220
s_waitcnt lgkmcnt(6)
v_mfma_f32_16x16x32_bf16 v[72:75],a[224:227],v[224:227],v[72:75]
s_waitcnt lgkmcnt(0)
v_mfma_f32_16x16x32_bf16 v[76:79],a[228:231],v[228:231],v[76:79]
v_min3_u32 v27,v27,v224,v228
v_mfma_f32_16x16x32_bf16 v[72:75],a[232:235],v[232:235],v[72:75]
v_lshlrev_b32 v104,16,v124
v_mfma_f32_16x16x32_bf16 v[76:79],a[236:239],v[236:239],v[76:79]
v_min3_u32 v27,v27,v232,v236
v_mfma_f32_16x16x32_bf16 v[72:75],a[240:243],v[240:243],v[72:75]
v_mfma_f32_16x16x32_bf16 v[76:79],a[244:247],v[244:247],v[76:79]
v_min3_u32 v27,v27,v240,v244
v_mfma_f32_16x16x32_bf16 v[72:75],a[248:251],v[248:251],v[72:75]
v_and_b32 v105,s80,v124
v_mfma_f32_16x16x32_bf16 v[76:79],a[252:255],v[252:255],v[76:79]
v_min3_u32 v27,v27,v248,v252
v_mfma_f32_16x16x32_bf16 v[80:83],a[0:3],v[128:131],0
v_cmp_eq_u32 vcc,0,v27
s_cbranch_vccnz retry_289
v_mfma_f32_16x16x32_bf16 v[84:87],a[4:7],v[132:135],0
v_lshlrev_b32 v106,16,v125
v_mfma_f32_16x16x32_bf16 v[80:83],a[8:11],v[136:139],v[80:83]
v_mfma_f32_16x16x32_bf16 v[84:87],a[12:15],v[140:143],v[84:87]
v_mfma_f32_16x16x32_bf16 v[80:83],a[16:19],v[144:147],v[80:83]
v_and_b32 v107,s80,v125
v_add_f32 v72,v72,v76
v_mfma_f32_16x16x32_bf16 v[84:87],a[20:23],v[148:151],v[84:87]
v_add_f32 v73,v73,v77
v_add_f32 v74,v74,v78
v_mfma_f32_16x16x32_bf16 v[80:83],a[24:27],v[152:155],v[80:83]
v_add_f32 v75,v75,v79
v_and_or_b32 v72,v72,-4,s48
v_mfma_f32_16x16x32_bf16 v[84:87],a[28:31],v[156:159],v[84:87]
s_add_u32 s64,s77,s33
v_mfma_f32_16x16x32_bf16 v[80:83],a[32:35],v[160:163],v[80:83]
buffer_store_dwordx4 v[72:75],v25,s[20:23],s64 offen offset:1024
v_mfma_f32_16x16x32_bf16 v[84:87],a[36:39],v[164:167],v[84:87]
v_mfma_f32_16x16x32_bf16 v[80:83],a[40:43],v[168:171],v[80:83]
v_mfma_f32_16x16x32_bf16 v[84:87],a[44:47],v[172:175],v[84:87]
v_mfma_f32_16x16x32_bf16 v[80:83],a[48:51],v[176:179],v[80:83]
v_mfma_f32_16x16x32_bf16 v[84:87],a[52:55],v[180:183],v[84:87]
v_mfma_f32_16x16x32_bf16 v[80:83],a[56:59],v[184:187],v[80:83]
v_mfma_f32_16x16x32_bf16 v[84:87],a[60:63],v[188:191],v[84:87]
v_mfma_f32_16x16x32_bf16 v[80:83],a[64:67],v[192:195],v[80:83]
buffer_load_dwordx4 v[96:99],v26,s[20:23],s77 offen offset:2048 sc1
v_mfma_f32_16x16x32_bf16 v[84:87],a[68:71],v[196:199],v[84:87]
buffer_load_dwordx4 v[100:103],v26,s[20:23],s77 offen offset:3072 sc1
v_mfma_f32_16x16x32_bf16 v[80:83],a[72:75],v[200:203],v[80:83]
v_mfma_f32_16x16x32_bf16 v[84:87],a[76:79],v[204:207],v[84:87]
v_mfma_f32_16x16x32_bf16 v[80:83],a[80:83],v[208:211],v[80:83]
v_mfma_f32_16x16x32_bf16 v[84:87],a[84:87],v[212:215],v[84:87]
v_mfma_f32_16x16x32_bf16 v[80:83],a[88:91],v[216:219],v[80:83]
v_mfma_f32_16x16x32_bf16 v[84:87],a[92:95],v[220:223],v[84:87]
v_mfma_f32_16x16x32_bf16 v[80:83],a[96:99],v[224:227],v[80:83]
v_mfma_f32_16x16x32_bf16 v[84:87],a[100:103],v[228:231],v[84:87]
v_mfma_f32_16x16x32_bf16 v[80:83],a[104:107],v[232:235],v[80:83]
buffer_load_dwordx4 v[92:95],v26,s[20:23],s77 offen offset:1024 sc1
v_mfma_f32_16x16x32_bf16 v[84:87],a[108:111],v[236:239],v[84:87]
v_mfma_f32_16x16x32_bf16 v[80:83],a[112:115],v[240:243],v[80:83]
v_mfma_f32_16x16x32_bf16 v[84:87],a[116:119],v[244:247],v[84:87]
v_mfma_f32_16x16x32_bf16 v[80:83],a[120:123],v[248:251],v[80:83]
v_mfma_f32_16x16x32_bf16 v[84:87],a[124:127],v[252:255],v[84:87]
s_branch epi_292
keep_300:
v_mfma_f32_16x16x32_bf16 v[68:71],a[228:231],v[228:231],v[68:71]
s_xor_b32 m0,s72,0
s_waitcnt lgkmcnt(10)
v_mfma_f32_16x16x32_bf16 v[64:67],a[104:107],v[232:235],v[64:67]
ds_read_b128 v[160:163],v17 offset:16384
ds_read_b128 v[164:167],v17 offset:18432
s_add_u32 s65,s88,0
v_mfma_f32_16x16x32_bf16 v[68:71],a[232:235],v[232:235],v[68:71]
buffer_load_dwordx4 v16,s[20:23],s65 offen offset:0 sc1 lds
v_min3_u32 v27,v27,v232,v236
v_mfma_f32_16x16x32_bf16 v[64:67],a[108:111],v[236:239],v[64:67]
ds_read_b128 v[168:171],v17 offset:20480
buffer_load_dwordx4 v16,s[20:23],s65 offen offset:2048 sc1 lds
v_mfma_f32_16x16x32_bf16 v[68:71],a[236:239],v[236:239],v[68:71]
s_xor_b32 m0,s72,16384
s_waitcnt lgkmcnt(9)
v_mfma_f32_16x16x32_bf16 v[64:67],a[112:115],v[240:243],v[64:67]
ds_read_b128 v[172:175],v17 offset:22528
v_min3_u32 v27,v27,v240,v244
v_mfma_f32_16x16x32_bf16 v[68:71],a[240:243],v[240:243],v[68:71]
s_add_u32 s65,s88,32768
v_mfma_f32_16x16x32_bf16 v[64:67],a[116:119],v[244:247],v[64:67]
ds_read_b128 v[176:179],v17 offset:24576
ds_read_b128 v[180:183],v17 offset:26624
v_mfma_f32_16x16x32_bf16 v[68:71],a[244:247],v[244:247],v[68:71]
buffer_load_dwordx4 v16,s[20:23],s65 offen offset:0 sc1 lds
s_waitcnt lgkmcnt(7)
v_mfma_f32_16x16x32_bf16 v[64:67],a[120:123],v[248:251],v[64:67]
ds_read_b128 v[184:187],v17 offset:28672
buffer_load_dwordx4 v16,s[20:23],s65 offen offset:2048 sc1 lds
v_mfma_f32_16x16x32_bf16 v[68:71],a[248:251],v[248:251],v[68:71]
s_xor_b32 m0,s72,32768
s_add_u32 s65,s88,65536
v_mfma_f32_16x16x32_bf16 v[64:67],a[124:127],v[252:255],v[64:67]
ds_read_b128 v[188:191],v17 offset:30720
v_min3_u32 v27,v27,v248,v252
v_mfma_f32_16x16x32_bf16 v[68:71],a[252:255],v[252:255],v[68:71]
buffer_load_dwordx4 v16,s[20:23],s65 offen offset:0 sc1 lds
v_mfma_f32_16x16x32_bf16 v[72:75],a[128:131],v[128:131],0
buffer_load_dwordx4 v16,s[20:23],s65 offen offset:2048 sc1 lds
v_mfma_f32_16x16x32_bf16 v[76:79],a[132:135],v[132:135],0
s_xor_b32 m0,s72,49152
v_cmp_eq_u32 vcc,0,v27
s_cbranch_vccnz retry_289
v_mfma_f32_16x16x32_bf16 v[72:75],a[136:139],v[136:139],v[72:75]
s_waitcnt vmcnt(7)
s_barrier
ds_read_b128 v[192:195],v17 offset:32768
v_mfma_f32_16x16x32_bf16 v[76:79],a[140:143],v[140:143],v[76:79]
ds_read_b128 v[196:199],v17 offset:34816
s_add_u32 s65,s88,98304
s_waitcnt lgkmcnt(10)
v_mfma_f32_16x16x32_bf16 v[72:75],a[144:147],v[144:147],v[72:75]
ds_read_b128 v[200:203],v17 offset:36864
buffer_load_dwordx4 v16,s[20:23],s65 offen offset:0 sc1 lds
s_waitcnt vmcnt(7)
v_mfma_f32_16x16x32_bf16 v[76:79],a[148:151],v[148:151],v[76:79]
ds_read_b128 v[204:207],v17 offset:38912
buffer_load_dwordx4 v16,s[20:23],s65 offen offset:2048 sc1 lds
v_and_or_b32 v64,v64,-4,s48
v_mfma_f32_16x16x32_bf16 v[72:75],a[152:155],v[152:155],v[72:75]
ds_read_b128 v[208:211],v17 offset:40960
s_xor_b32 m0,s72,1024
s_add_u32 s64,s49,s34
v_mfma_f32_16x16x32_bf16 v[76:79],a[156:159],v[156:159],v[76:79]
s_add_u32 s65,s89,0
buffer_store_dwordx4 v[64:67],v25,s[20:23],s64 offen offset:2048
s_waitcnt lgkmcnt(9)
v_mfma_f32_16x16x32_bf16 v[72:75],a[160:163],v[160:163],v[72:75]
ds_read_b128 v[212:215],v17 offset:43008
buffer_load_dwordx4 v16,s[20:23],s65 offen offset:0 sc1 lds
v_and_or_b32 v68,v68,-4,s48
v_mfma_f32_16x16x32_bf16 v[76:79],a[164:167],v[164:167],v[76:79]
ds_read_b128 v[216:219],v17 offset:45056
v_min3_u32 v27,v27,v128,v132
s_add_u32 s64,s49,s35
v_mfma_f32_16x16x32_bf16 v[72:75],a[168:171],v[168:171],v[72:75]
ds_read_b128 v[220:223],v17 offset:47104
buffer_load_dwordx4 v16,s[20:23],s65 offen offset:2048 sc1 lds
v_mfma_f32_16x16x32_bf16 v[76:79],a[172:175],v[172:175],v[76:79]
ds_read_b128 v[224:227],v17 offset:49152
s_xor_b32 m0,s72,17408
s_waitcnt lgkmcnt(9)
v_mfma_f32_16x16x32_bf16 v[72:75],a[176:179],v[176:179],v[72:75]
ds_read_b128 v[228:231],v17 offset:51200
s_add_u32 s65,s89,32768
buffer_store_dwordx4 v[68:71],v25,s[20:23],s64 offen offset:3072
v_mfma_f32_16x16x32_bf16 v[76:79],a[180:183],v[180:183],v[76:79]
buffer_load_dwordx4 v16,s[20:23],s65 offen offset:0 sc1 lds
s_mov_b32 s49,0x7fff0000
v_mfma_f32_16x16x32_bf16 v[72:75],a[184:187],v[184:187],v[72:75]
ds_read_b128 v[232:235],v17 offset:53248
v_min3_u32 v27,v27,v136,v140
v_mfma_f32_16x16x32_bf16 v[76:79],a[188:191],v[188:191],v[76:79]
ds_read_b128 v[236:239],v17 offset:55296
s_waitcnt lgkmcnt(8)
v_mfma_f32_16x16x32_bf16 v[72:75],a[192:195],v[192:195],v[72:75]
ds_read_b128 v[240:243],v17 offset:57344
buffer_load_dwordx4 v16,s[20:23],s65 offen offset:2048 sc1 lds
v_mfma_f32_16x16x32_bf16 v[76:79],a[196:199],v[196:199],v[76:79]
ds_read_b128 v[244:247],v17 offset:59392
s_xor_b32 m0,s72,33792
v_mfma_f32_16x16x32_bf16 v[72:75],a[200:203],v[200:203],v[72:75]
ds_read_b128 v[248:251],v17 offset:61440
s_add_u32 s65,s89,65536
v_mfma_f32_16x16x32_bf16 v[76:79],a[204:207],v[204:207],v[76:79]
v_min3_u32 v27,v27,v144,v148
s_waitcnt lgkmcnt(7)
v_mfma_f32_16x16x32_bf16 v[72:75],a[208:211],v[208:211],v[72:75]
ds_read_b128 v[252:255],v17 offset:63488
v_min3_u32 v27,v27,v152,v156
v_mfma_f32_16x16x32_bf16 v[76:79],a[212:215],v[212:215],v[76:79]
buffer_load_dwordx4 v16,s[20:23],s65 offen offset:0 sc1 lds
v_mfma_f32_16x16x32_bf16 v[72:75],a[216:219],v[216:219],v[72:75]
buffer_load_dwordx4 v16,s[20:23],s65 offen offset:2048 sc1 lds
v_mfma_f32_16x16x32_bf16 v[76:79],a[220:223],v[220:223],v[76:79]
s_xor_b32 m0,s72,50176
s_waitcnt lgkmcnt(4)
v_mfma_f32_16x16x32_bf16 v[72:75],a[224:227],v[224:227],v[72:75]
s_add_u32 s65,s89,98304
v_min3_u32 v27,v27,v160,v164
v_mfma_f32_16x16x32_bf16 v[76:79],a[228:231],v[228:231],v[76:79]
buffer_load_dwordx4 v16,s[20:23],s65 offen offset:0 sc1 lds
v_mfma_f32_16x16x32_bf16 v[72:75],a[232:235],v[232:235],v[72:75]
buffer_load_dwordx4 v16,s[20:23],s65 offen offset:2048 sc1 lds
v_mfma_f32_16x16x32_bf16 v[76:79],a[236:239],v[236:239],v[76:79]
v_min3_u32 v27,v27,v168,v172
s_waitcnt lgkmcnt(0)
v_mfma_f32_16x16x32_bf16 v[72:75],a[240:243],v[240:243],v[72:75]
v_min3_u32 v27,v27,v176,v180
v_min3_u32 v27,v27,v184,v188
v_mfma_f32_16x16x32_bf16 v[76:79],a[244:247],v[244:247],v[76:79]
v_min3_u32 v27,v27,v192,v196
v_min3_u32 v27,v27,v200,v204
v_min3_u32 v27,v27,v240,v244
v_mfma_f32_16x16x32_bf16 v[72:75],a[248:251],v[248:251],v[72:75]
v_min3_u32 v27,v27,v208,v212
v_min3_u32 v27,v27,v216,v220
v_mfma_f32_16x16x32_bf16 v[76:79],a[252:255],v[252:255],v[76:79]
v_min3_u32 v27,v27,v224,v228
v_min3_u32 v27,v27,v232,v236
v_min3_u32 v27,v27,v248,v252
v_mfma_f32_16x16x32_bf16 v[80:83],a[0:3],v[128:131],0
v_cmp_eq_u32 vcc,0,v27
s_cbranch_vccnz retry_289
v_mfma_f32_16x16x32_bf16 v[84:87],a[4:7],v[132:135],0
ds_bpermute_b32 v124,v41,v120
ds_bpermute_b32 v125,v41,v121
v_mfma_f32_16x16x32_bf16 v[80:83],a[8:11],v[136:139],v[80:83]
s_waitcnt lgkmcnt(0)
v_lshlrev_b32 v104,16,v124
v_mfma_f32_16x16x32_bf16 v[84:87],a[12:15],v[140:143],v[84:87]
v_and_b32 v105,s80,v124
v_lshlrev_b32 v106,16,v125
v_mfma_f32_16x16x32_bf16 v[80:83],a[16:19],v[144:147],v[80:83]
v_and_b32 v107,s80,v125
v_add_f32 v72,v72,v76
v_mfma_f32_16x16x32_bf16 v[84:87],a[20:23],v[148:151],v[84:87]
v_add_f32 v73,v73,v77
v_add_f32 v74,v74,v78
v_mfma_f32_16x16x32_bf16 v[80:83],a[24:27],v[152:155],v[80:83]
v_add_f32 v75,v75,v79
v_and_or_b32 v72,v72,-4,s48
v_mfma_f32_16x16x32_bf16 v[84:87],a[28:31],v[156:159],v[84:87]
s_add_u32 s64,s77,s33
v_mfma_f32_16x16x32_bf16 v[80:83],a[32:35],v[160:163],v[80:83]
buffer_store_dwordx4 v[72:75],v25,s[20:23],s64 offen offset:1024
v_mfma_f32_16x16x32_bf16 v[84:87],a[36:39],v[164:167],v[84:87]
v_mfma_f32_16x16x32_bf16 v[80:83],a[40:43],v[168:171],v[80:83]
v_mfma_f32_16x16x32_bf16 v[84:87],a[44:47],v[172:175],v[84:87]
v_mfma_f32_16x16x32_bf16 v[80:83],a[48:51],v[176:179],v[80:83]
v_mfma_f32_16x16x32_bf16 v[84:87],a[52:55],v[180:183],v[84:87]
v_mfma_f32_16x16x32_bf16 v[80:83],a[56:59],v[184:187],v[80:83]
v_mfma_f32_16x16x32_bf16 v[84:87],a[60:63],v[188:191],v[84:87]
v_mfma_f32_16x16x32_bf16 v[80:83],a[64:67],v[192:195],v[80:83]
buffer_load_dwordx4 v[96:99],v26,s[20:23],s77 offen offset:2048 sc1
v_mfma_f32_16x16x32_bf16 v[84:87],a[68:71],v[196:199],v[84:87]
buffer_load_dwordx4 v[100:103],v26,s[20:23],s77 offen offset:3072 sc1
v_mfma_f32_16x16x32_bf16 v[80:83],a[72:75],v[200:203],v[80:83]
v_mfma_f32_16x16x32_bf16 v[84:87],a[76:79],v[204:207],v[84:87]
v_mfma_f32_16x16x32_bf16 v[80:83],a[80:83],v[208:211],v[80:83]
v_mfma_f32_16x16x32_bf16 v[84:87],a[84:87],v[212:215],v[84:87]
v_mfma_f32_16x16x32_bf16 v[80:83],a[88:91],v[216:219],v[80:83]
v_mfma_f32_16x16x32_bf16 v[84:87],a[92:95],v[220:223],v[84:87]
v_mfma_f32_16x16x32_bf16 v[80:83],a[96:99],v[224:227],v[80:83]
v_mfma_f32_16x16x32_bf16 v[84:87],a[100:103],v[228:231],v[84:87]
v_mfma_f32_16x16x32_bf16 v[80:83],a[104:107],v[232:235],v[80:83]
buffer_load_dwordx4 v[92:95],v26,s[20:23],s77 offen offset:1024 sc1
v_mfma_f32_16x16x32_bf16 v[84:87],a[108:111],v[236:239],v[84:87]
v_mfma_f32_16x16x32_bf16 v[80:83],a[112:115],v[240:243],v[80:83]
v_mfma_f32_16x16x32_bf16 v[84:87],a[116:119],v[244:247],v[84:87]
v_mfma_f32_16x16x32_bf16 v[80:83],a[120:123],v[248:251],v[80:83]
v_mfma_f32_16x16x32_bf16 v[84:87],a[124:127],v[252:255],v[84:87]
s_branch epi_292
ahead_291:
s_cmp_eq_u32 s93,0
s_cbranch_scc1 both_293
s_waitcnt vmcnt(15) lgkmcnt(0)
s_barrier
ds_read_b128 v[224:227],v18 offset:0
ds_read_b128 v[228:231],v18 offset:2048
ds_read_b128 v[232:235],v18 offset:4096
ds_read_b128 v[236:239],v18 offset:6144
ds_read_b128 v[240:243],v18 offset:8192
ds_read_b128 v[244:247],v18 offset:10240
ds_read_b128 v[248:251],v18 offset:12288
s_waitcnt lgkmcnt(5)
v_mfma_f32_16x16x32_bf16 v[64:67],a[0:3],v[224:227],0
s_add_u32 s96,s71,1
s_add_u32 s92,s71,2
v_mfma_f32_16x16x32_bf16 v[68:71],a[128:131],v[224:227],0
ds_read_b128 v[252:255],v18 offset:14336
v_min_u32 v27,v224,v228
v_mfma_f32_16x16x32_bf16 v[64:67],a[4:7],v[228:231],v[64:67]
buffer_load_dwordx2 v[120:121],v20,s[36:39],s78 offen
v_mfma_f32_16x16x32_bf16 v[68:71],a[132:135],v[228:231],v[68:71]
ds_read_b128 v[224:227],v18 offset:16384
s_waitcnt lgkmcnt(5)
v_mfma_f32_16x16x32_bf16 v[64:67],a[8:11],v[232:235],v[64:67]
v_min3_u32 v27,v27,v232,v236
v_mfma_f32_16x16x32_bf16 v[68:71],a[136:139],v[232:235],v[68:71]
ds_read_b128 v[228:231],v18 offset:18432
v_mfma_f32_16x16x32_bf16 v[64:67],a[12:15],v[236:239],v[64:67]
v_mfma_f32_16x16x32_bf16 v[68:71],a[140:143],v[236:239],v[68:71]
ds_read_b128 v[232:235],v18 offset:20480
s_waitcnt lgkmcnt(5)
v_mfma_f32_16x16x32_bf16 v[64:67],a[16:19],v[240:243],v[64:67]
v_min3_u32 v27,v27,v240,v244
v_mfma_f32_16x16x32_bf16 v[68:71],a[144:147],v[240:243],v[68:71]
ds_read_b128 v[236:239],v18 offset:22528
v_mfma_f32_16x16x32_bf16 v[64:67],a[20:23],v[244:247],v[64:67]
v_mfma_f32_16x16x32_bf16 v[68:71],a[148:151],v[244:247],v[68:71]
ds_read_b128 v[240:243],v18 offset:24576
s_waitcnt lgkmcnt(5)
v_mfma_f32_16x16x32_bf16 v[64:67],a[24:27],v[248:251],v[64:67]
v_min3_u32 v27,v27,v248,v252
v_mfma_f32_16x16x32_bf16 v[68:71],a[152:155],v[248:251],v[68:71]
ds_read_b128 v[244:247],v18 offset:26624
v_mfma_f32_16x16x32_bf16 v[64:67],a[28:31],v[252:255],v[64:67]
v_mfma_f32_16x16x32_bf16 v[68:71],a[156:159],v[252:255],v[68:71]
ds_read_b128 v[248:251],v18 offset:28672
s_waitcnt lgkmcnt(5)
v_mfma_f32_16x16x32_bf16 v[64:67],a[32:35],v[224:227],v[64:67]
v_min3_u32 v27,v27,v224,v228
v_mfma_f32_16x16x32_bf16 v[68:71],a[160:163],v[224:227],v[68:71]
ds_read_b128 v[252:255],v18 offset:30720
v_mfma_f32_16x16x32_bf16 v[64:67],a[36:39],v[228:231],v[64:67]
s_waitcnt vmcnt(3)
v_mfma_f32_16x16x32_bf16 v[68:71],a[164:167],v[228:231],v[68:71]
ds_read_b128 v[224:227],v18 offset:32768
s_waitcnt lgkmcnt(5)
v_mfma_f32_16x16x32_bf16 v[64:67],a[40:43],v[232:235],v[64:67]
v_cmp_gt_u32 vcc,s96,v29
v_cmp_gt_u32 s[92:93],s92,v29
v_mfma_f32_16x16x32_bf16 v[68:71],a[168:171],v[232:235],v[68:71]
ds_read_b128 v[228:231],v18 offset:34816
v_min3_u32 v27,v27,v232,v236
v_mfma_f32_16x16x32_bf16 v[64:67],a[44:47],v[236:239],v[64:67]
v_mov_b32 v44,vcc_lo
v_mov_b32 v45,s92
v_mfma_f32_16x16x32_bf16 v[68:71],a[172:175],v[236:239],v[68:71]
ds_read_b128 v[232:235],v18 offset:36864
s_waitcnt lgkmcnt(5)
v_mfma_f32_16x16x32_bf16 v[64:67],a[48:51],v[240:243],v[64:67]
ds_write_b64 v46,v[44:45]
v_min3_u32 v27,v27,v240,v244
v_mfma_f32_16x16x32_bf16 v[68:71],a[176:179],v[240:243],v[68:71]
ds_read_b128 v[236:239],v18 offset:38912
v_mfma_f32_16x16x32_bf16 v[64:67],a[52:55],v[244:247],v[64:67]
v_mfma_f32_16x16x32_bf16 v[68:71],a[180:183],v[244:247],v[68:71]
ds_read_b128 v[240:243],v18 offset:40960
s_waitcnt lgkmcnt(6)
v_mfma_f32_16x16x32_bf16 v[64:67],a[56:59],v[248:251],v[64:67]
v_min3_u32 v27,v27,v248,v252
s_add_u32 s88,s70,s75
v_mfma_f32_16x16x32_bf16 v[68:71],a[184:187],v[248:251],v[68:71]
ds_read_b128 v[244:247],v18 offset:43008
s_add_u32 s88,s88,2097152
v_mfma_f32_16x16x32_bf16 v[64:67],a[60:63],v[252:255],v[64:67]
s_xor_b32 s88,s88,0x2000
s_xor_b32 s89,s88,1024
v_mfma_f32_16x16x32_bf16 v[68:71],a[188:191],v[252:255],v[68:71]
ds_read_b128 v[248:251],v18 offset:45056
s_waitcnt lgkmcnt(6)
v_mfma_f32_16x16x32_bf16 v[64:67],a[64:67],v[224:227],v[64:67]
v_min3_u32 v27,v27,v224,v228
v_mfma_f32_16x16x32_bf16 v[68:71],a[192:195],v[224:227],v[68:71]
ds_read_b128 v[252:255],v18 offset:47104
v_mfma_f32_16x16x32_bf16 v[64:67],a[68:71],v[228:231],v[64:67]
v_mfma_f32_16x16x32_bf16 v[68:71],a[196:199],v[228:231],v[68:71]
ds_read_b128 v[224:227],v18 offset:49152
s_waitcnt lgkmcnt(5)
v_mfma_f32_16x16x32_bf16 v[64:67],a[72:75],v[232:235],v[64:67]
v_min3_u32 v27,v27,v232,v236
v_mfma_f32_16x16x32_bf16 v[68:71],a[200:203],v[232:235],v[68:71]
ds_read_b128 v[228:231],v18 offset:51200
v_mfma_f32_16x16x32_bf16 v[64:67],a[76:79],v[236:239],v[64:67]
v_mfma_f32_16x16x32_bf16 v[68:71],a[204:207],v[236:239],v[68:71]
ds_read_b128 v[232:235],v18 offset:53248
s_waitcnt lgkmcnt(5)
v_mfma_f32_16x16x32_bf16 v[64:67],a[80:83],v[240:243],v[64:67]
s_waitcnt vmcnt(8)
s_barrier
ds_read_b64 v[44:45],v47
ds_read_b128 v[128:131],v17 offset:0
ds_read_b128 v[132:135],v17 offset:2048
v_mfma_f32_16x16x32_bf16 v[68:71],a[208:211],v[240:243],v[68:71]
ds_read_b128 v[236:239],v18 offset:55296
v_min3_u32 v27,v27,v240,v244
v_mfma_f32_16x16x32_bf16 v[64:67],a[84:87],v[244:247],v[64:67]
ds_read_b128 v[136:139],v17 offset:4096
v_mfma_f32_16x16x32_bf16 v[68:71],a[212:215],v[244:247],v[68:71]
ds_read_b128 v[240:243],v18 offset:57344
s_waitcnt lgkmcnt(9)
v_mfma_f32_16x16x32_bf16 v[64:67],a[88:91],v[248:251],v[64:67]
ds_read_b128 v[140:143],v17 offset:6144
v_min3_u32 v27,v27,v248,v252
v_mfma_f32_16x16x32_bf16 v[68:71],a[216:219],v[248:251],v[68:71]
ds_read_b128 v[244:247],v18 offset:59392
v_mfma_f32_16x16x32_bf16 v[64:67],a[92:95],v[252:255],v[64:67]
ds_read_b128 v[144:147],v17 offset:8192
ds_read_b128 v[148:151],v17 offset:10240
v_mfma_f32_16x16x32_bf16 v[68:71],a[220:223],v[252:255],v[68:71]
ds_read_b128 v[248:251],v18 offset:61440
s_waitcnt lgkmcnt(12)
v_mfma_f32_16x16x32_bf16 v[64:67],a[96:99],v[224:227],v[64:67]
ds_read_b128 v[152:155],v17 offset:12288
s_waitcnt lgkmcnt(11)
v_min3_u32 v27,v27,v224,v228
v_mfma_f32_16x16x32_bf16 v[68:71],a[224:227],v[224:227],v[68:71]
ds_read_b128 v[252:255],v18 offset:63488
v_readfirstlane_b32 s93,v45
v_mfma_f32_16x16x32_bf16 v[64:67],a[100:103],v[228:231],v[64:67]
ds_read_b128 v[156:159],v17 offset:14336
v_readfirstlane_b32 s83,v44
s_cmp_lg_u32 s83,0
s_cbranch_scc1 keep_301
v_mfma_f32_16x16x32_bf16 v[68:71],a[228:231],v[228:231],v[68:71]
s_waitcnt vmcnt(1)
s_xor_b32 m0,s72,0
s_waitcnt lgkmcnt(10)
v_mfma_f32_16x16x32_bf16 v[64:67],a[104:107],v[232:235],v[64:67]
ds_read_b128 v[160:163],v17 offset:16384
ds_read_b128 v[164:167],v17 offset:18432
s_add_u32 s65,s88,0
v_min3_u32 v27,v27,v232,v236
v_mfma_f32_16x16x32_bf16 v[68:71],a[232:235],v[232:235],v[68:71]
v_add_u32 v22,s71,-1
buffer_load_dwordx4 v16,s[20:23],s65 offen offset:0 sc1 lds
v_mfma_f32_16x16x32_bf16 v[64:67],a[108:111],v[236:239],v[64:67]
ds_read_b128 v[168:171],v17 offset:20480
buffer_load_dwordx4 v16,s[20:23],s65 offen offset:2048 sc1 lds
v_mfma_f32_16x16x32_bf16 v[68:71],a[236:239],v[236:239],v[68:71]
s_xor_b32 m0,s72,16384
s_waitcnt lgkmcnt(9)
v_mfma_f32_16x16x32_bf16 v[64:67],a[112:115],v[240:243],v[64:67]
ds_read_b128 v[172:175],v17 offset:22528
v_min3_u32 v27,v27,v240,v244
v_mfma_f32_16x16x32_bf16 v[68:71],a[240:243],v[240:243],v[68:71]
buffer_store_dword v22,v23,s[20:23],s97 offen sc1
s_add_u32 s65,s88,32768
v_mfma_f32_16x16x32_bf16 v[64:67],a[116:119],v[244:247],v[64:67]
ds_read_b128 v[176:179],v17 offset:24576
ds_read_b128 v[180:183],v17 offset:26624
v_mfma_f32_16x16x32_bf16 v[68:71],a[244:247],v[244:247],v[68:71]
s_mov_b32 s97,0x7fff0000
s_waitcnt lgkmcnt(7)
v_mfma_f32_16x16x32_bf16 v[64:67],a[120:123],v[248:251],v[64:67]
ds_read_b128 v[184:187],v17 offset:28672
buffer_load_dwordx4 v16,s[20:23],s65 offen offset:0 sc1 lds
v_mfma_f32_16x16x32_bf16 v[68:71],a[248:251],v[248:251],v[68:71]
buffer_load_dwordx4 v16,s[20:23],s65 offen offset:2048 sc1 lds
s_xor_b32 m0,s72,32768
v_mfma_f32_16x16x32_bf16 v[64:67],a[124:127],v[252:255],v[64:67]
ds_read_b128 v[188:191],v17 offset:30720
s_add_u32 s65,s88,65536
v_min3_u32 v27,v27,v248,v252
v_mfma_f32_16x16x32_bf16 v[68:71],a[252:255],v[252:255],v[68:71]
buffer_load_dwordx4 v16,s[20:23],s65 offen offset:0 sc1 lds
v_mfma_f32_16x16x32_bf16 v[72:75],a[128:131],v[128:131],0
buffer_load_dwordx4 v16,s[20:23],s65 offen offset:2048 sc1 lds
v_mfma_f32_16x16x32_bf16 v[76:79],a[132:135],v[132:135],0
s_xor_b32 m0,s72,49152
v_cmp_eq_u32 vcc,0,v27
s_cbranch_vccnz retry_289
v_mfma_f32_16x16x32_bf16 v[72:75],a[136:139],v[136:139],v[72:75]
ds_read_b128 v[192:195],v17 offset:32768
s_add_u32 s65,s88,98304
v_mfma_f32_16x16x32_bf16 v[76:79],a[140:143],v[140:143],v[76:79]
ds_read_b128 v[196:199],v17 offset:34816
s_waitcnt lgkmcnt(10)
v_mfma_f32_16x16x32_bf16 v[72:75],a[144:147],v[144:147],v[72:75]
ds_read_b128 v[200:203],v17 offset:36864
buffer_load_dwordx4 v16,s[20:23],s65 offen offset:0 sc1 lds
s_waitcnt vmcnt(8)
v_mfma_f32_16x16x32_bf16 v[76:79],a[148:151],v[148:151],v[76:79]
ds_read_b128 v[204:207],v17 offset:38912
buffer_load_dwordx4 v16,s[20:23],s65 offen offset:2048 sc1 lds
v_and_or_b32 v64,v64,-4,s48
v_mfma_f32_16x16x32_bf16 v[72:75],a[152:155],v[152:155],v[72:75]
ds_read_b128 v[208:211],v17 offset:40960
s_xor_b32 m0,s72,1024
s_add_u32 s64,s49,s34
v_mfma_f32_16x16x32_bf16 v[76:79],a[156:159],v[156:159],v[76:79]
s_add_u32 s65,s89,0
buffer_store_dwordx4 v[64:67],v25,s[20:23],s64 offen offset:2048
s_waitcnt lgkmcnt(9)
v_mfma_f32_16x16x32_bf16 v[72:75],a[160:163],v[160:163],v[72:75]
ds_read_b128 v[212:215],v17 offset:43008
buffer_load_dwordx4 v16,s[20:23],s65 offen offset:0 sc1 lds
v_and_or_b32 v68,v68,-4,s48
v_mfma_f32_16x16x32_bf16 v[76:79],a[164:167],v[164:167],v[76:79]
ds_read_b128 v[216:219],v17 offset:45056
v_min3_u32 v27,v27,v128,v132
s_add_u32 s64,s49,s35
v_mfma_f32_16x16x32_bf16 v[72:75],a[168:171],v[168:171],v[72:75]
ds_read_b128 v[220:223],v17 offset:47104
buffer_load_dwordx4 v16,s[20:23],s65 offen offset:2048 sc1 lds
v_mfma_f32_16x16x32_bf16 v[76:79],a[172:175],v[172:175],v[76:79]
ds_read_b128 v[224:227],v17 offset:49152
s_xor_b32 m0,s72,17408
s_waitcnt lgkmcnt(9)
v_mfma_f32_16x16x32_bf16 v[72:75],a[176:179],v[176:179],v[72:75]
ds_read_b128 v[228:231],v17 offset:51200
s_add_u32 s65,s89,32768
buffer_store_dwordx4 v[68:71],v25,s[20:23],s64 offen offset:3072
v_mfma_f32_16x16x32_bf16 v[76:79],a[180:183],v[180:183],v[76:79]
buffer_load_dwordx4 v16,s[20:23],s65 offen offset:0 sc1 lds
s_mov_b32 s49,0x7fff0000
v_mfma_f32_16x16x32_bf16 v[72:75],a[184:187],v[184:187],v[72:75]
ds_read_b128 v[232:235],v17 offset:53248
v_min3_u32 v27,v27,v136,v140
v_mfma_f32_16x16x32_bf16 v[76:79],a[188:191],v[188:191],v[76:79]
ds_read_b128 v[236:239],v17 offset:55296
s_waitcnt lgkmcnt(8)
v_mfma_f32_16x16x32_bf16 v[72:75],a[192:195],v[192:195],v[72:75]
ds_read_b128 v[240:243],v17 offset:57344
buffer_load_dwordx4 v16,s[20:23],s65 offen offset:2048 sc1 lds
v_mfma_f32_16x16x32_bf16 v[76:79],a[196:199],v[196:199],v[76:79]
ds_read_b128 v[244:247],v17 offset:59392
s_xor_b32 m0,s72,33792
v_mfma_f32_16x16x32_bf16 v[72:75],a[200:203],v[200:203],v[72:75]
ds_read_b128 v[248:251],v17 offset:61440
s_add_u32 s65,s89,65536
v_mfma_f32_16x16x32_bf16 v[76:79],a[204:207],v[204:207],v[76:79]
v_min3_u32 v27,v27,v144,v148
s_waitcnt lgkmcnt(7)
v_mfma_f32_16x16x32_bf16 v[72:75],a[208:211],v[208:211],v[72:75]
ds_read_b128 v[252:255],v17 offset:63488
v_min3_u32 v27,v27,v152,v156
v_mfma_f32_16x16x32_bf16 v[76:79],a[212:215],v[212:215],v[76:79]
buffer_load_dwordx4 v16,s[20:23],s65 offen offset:0 sc1 lds
v_mfma_f32_16x16x32_bf16 v[72:75],a[216:219],v[216:219],v[72:75]
buffer_load_dwordx4 v16,s[20:23],s65 offen offset:2048 sc1 lds
v_mfma_f32_16x16x32_bf16 v[76:79],a[220:223],v[220:223],v[76:79]
s_xor_b32 m0,s72,50176
s_waitcnt lgkmcnt(4)
v_mfma_f32_16x16x32_bf16 v[72:75],a[224:227],v[224:227],v[72:75]
s_add_u32 s65,s89,98304
v_min3_u32 v27,v27,v160,v164
v_mfma_f32_16x16x32_bf16 v[76:79],a[228:231],v[228:231],v[76:79]
buffer_load_dwordx4 v16,s[20:23],s65 offen offset:0 sc1 lds
v_mfma_f32_16x16x32_bf16 v[72:75],a[232:235],v[232:235],v[72:75]
buffer_load_dwordx4 v16,s[20:23],s65 offen offset:2048 sc1 lds
v_mfma_f32_16x16x32_bf16 v[76:79],a[236:239],v[236:239],v[76:79]
v_min3_u32 v27,v27,v168,v172
s_waitcnt lgkmcnt(0)
v_mfma_f32_16x16x32_bf16 v[72:75],a[240:243],v[240:243],v[72:75]
v_min3_u32 v27,v27,v176,v180
v_min3_u32 v27,v27,v184,v188
v_mfma_f32_16x16x32_bf16 v[76:79],a[244:247],v[244:247],v[76:79]
v_min3_u32 v27,v27,v192,v196
v_min3_u32 v27,v27,v200,v204
v_min3_u32 v27,v27,v240,v244
v_mfma_f32_16x16x32_bf16 v[72:75],a[248:251],v[248:251],v[72:75]
v_min3_u32 v27,v27,v208,v212
v_min3_u32 v27,v27,v216,v220
v_mfma_f32_16x16x32_bf16 v[76:79],a[252:255],v[252:255],v[76:79]
v_min3_u32 v27,v27,v224,v228
v_min3_u32 v27,v27,v232,v236
v_min3_u32 v27,v27,v248,v252
v_mfma_f32_16x16x32_bf16 v[80:83],a[0:3],v[128:131],0
v_cmp_eq_u32 vcc,0,v27
s_cbranch_vccnz retry_289
v_mfma_f32_16x16x32_bf16 v[84:87],a[4:7],v[132:135],0
ds_bpermute_b32 v124,v41,v120
ds_bpermute_b32 v125,v41,v121
v_mfma_f32_16x16x32_bf16 v[80:83],a[8:11],v[136:139],v[80:83]
s_waitcnt lgkmcnt(0)
v_lshlrev_b32 v104,16,v124
v_mfma_f32_16x16x32_bf16 v[84:87],a[12:15],v[140:143],v[84:87]
v_and_b32 v105,s80,v124
v_lshlrev_b32 v106,16,v125
v_mfma_f32_16x16x32_bf16 v[80:83],a[16:19],v[144:147],v[80:83]
v_and_b32 v107,s80,v125
v_add_f32 v72,v72,v76
v_mfma_f32_16x16x32_bf16 v[84:87],a[20:23],v[148:151],v[84:87]
v_add_f32 v73,v73,v77
v_add_f32 v74,v74,v78
v_mfma_f32_16x16x32_bf16 v[80:83],a[24:27],v[152:155],v[80:83]
v_add_f32 v75,v75,v79
v_and_or_b32 v72,v72,-4,s48
v_mfma_f32_16x16x32_bf16 v[84:87],a[28:31],v[156:159],v[84:87]
s_add_u32 s64,s77,s33
v_mfma_f32_16x16x32_bf16 v[80:83],a[32:35],v[160:163],v[80:83]
buffer_store_dwordx4 v[72:75],v25,s[20:23],s64 offen offset:1024
v_mfma_f32_16x16x32_bf16 v[84:87],a[36:39],v[164:167],v[84:87]
v_mfma_f32_16x16x32_bf16 v[80:83],a[40:43],v[168:171],v[80:83]
v_mfma_f32_16x16x32_bf16 v[84:87],a[44:47],v[172:175],v[84:87]
v_mfma_f32_16x16x32_bf16 v[80:83],a[48:51],v[176:179],v[80:83]
v_mfma_f32_16x16x32_bf16 v[84:87],a[52:55],v[180:183],v[84:87]
v_mfma_f32_16x16x32_bf16 v[80:83],a[56:59],v[184:187],v[80:83]
v_mfma_f32_16x16x32_bf16 v[84:87],a[60:63],v[188:191],v[84:87]
v_mfma_f32_16x16x32_bf16 v[80:83],a[64:67],v[192:195],v[80:83]
buffer_load_dwordx4 v[96:99],v26,s[20:23],s77 offen offset:2048 sc1
v_mfma_f32_16x16x32_bf16 v[84:87],a[68:71],v[196:199],v[84:87]
buffer_load_dwordx4 v[100:103],v26,s[20:23],s77 offen offset:3072 sc1
v_mfma_f32_16x16x32_bf16 v[80:83],a[72:75],v[200:203],v[80:83]
v_mfma_f32_16x16x32_bf16 v[84:87],a[76:79],v[204:207],v[84:87]
v_mfma_f32_16x16x32_bf16 v[80:83],a[80:83],v[208:211],v[80:83]
v_mfma_f32_16x16x32_bf16 v[84:87],a[84:87],v[212:215],v[84:87]
v_mfma_f32_16x16x32_bf16 v[80:83],a[88:91],v[216:219],v[80:83]
v_mfma_f32_16x16x32_bf16 v[84:87],a[92:95],v[220:223],v[84:87]
v_mfma_f32_16x16x32_bf16 v[80:83],a[96:99],v[224:227],v[80:83]
v_mfma_f32_16x16x32_bf16 v[84:87],a[100:103],v[228:231],v[84:87]
v_mfma_f32_16x16x32_bf16 v[80:83],a[104:107],v[232:235],v[80:83]
buffer_load_dwordx4 v[92:95],v26,s[20:23],s77 offen offset:1024 sc1
v_mfma_f32_16x16x32_bf16 v[84:87],a[108:111],v[236:239],v[84:87]
v_mfma_f32_16x16x32_bf16 v[80:83],a[112:115],v[240:243],v[80:83]
v_mfma_f32_16x16x32_bf16 v[84:87],a[116:119],v[244:247],v[84:87]
v_mfma_f32_16x16x32_bf16 v[80:83],a[120:123],v[248:251],v[80:83]
v_mfma_f32_16x16x32_bf16 v[84:87],a[124:127],v[252:255],v[84:87]
s_branch epi_292
keep_301:
v_mfma_f32_16x16x32_bf16 v[68:71],a[228:231],v[228:231],v[68:71]
s_waitcnt vmcnt(1)
s_waitcnt lgkmcnt(10)
v_mfma_f32_16x16x32_bf16 v[64:67],a[104:107],v[232:235],v[64:67]
ds_read_b128 v[160:163],v17 offset:16384
ds_read_b128 v[164:167],v17 offset:18432
v_mfma_f32_16x16x32_bf16 v[68:71],a[232:235],v[232:235],v[68:71]
v_add_u32 v22,s71,-1
v_min3_u32 v27,v27,v232,v236
v_mfma_f32_16x16x32_bf16 v[64:67],a[108:111],v[236:239],v[64:67]
ds_read_b128 v[168:171],v17 offset:20480
v_mfma_f32_16x16x32_bf16 v[68:71],a[236:239],v[236:239],v[68:71]
s_waitcnt lgkmcnt(9)
v_mfma_f32_16x16x32_bf16 v[64:67],a[112:115],v[240:243],v[64:67]
ds_read_b128 v[172:175],v17 offset:22528
v_min3_u32 v27,v27,v240,v244
v_mfma_f32_16x16x32_bf16 v[68:71],a[240:243],v[240:243],v[68:71]
buffer_store_dword v22,v23,s[20:23],s97 offen sc1
v_mfma_f32_16x16x32_bf16 v[64:67],a[116:119],v[244:247],v[64:67]
ds_read_b128 v[176:179],v17 offset:24576
ds_read_b128 v[180:183],v17 offset:26624
v_mfma_f32_16x16x32_bf16 v[68:71],a[244:247],v[244:247],v[68:71]
s_mov_b32 s97,0x7fff0000
s_waitcnt lgkmcnt(7)
v_mfma_f32_16x16x32_bf16 v[64:67],a[120:123],v[248:251],v[64:67]
ds_read_b128 v[184:187],v17 offset:28672
v_min3_u32 v27,v27,v248,v252
v_mfma_f32_16x16x32_bf16 v[68:71],a[248:251],v[248:251],v[68:71]
v_mfma_f32_16x16x32_bf16 v[64:67],a[124:127],v[252:255],v[64:67]
ds_read_b128 v[188:191],v17 offset:30720
v_mfma_f32_16x16x32_bf16 v[68:71],a[252:255],v[252:255],v[68:71]
v_mfma_f32_16x16x32_bf16 v[72:75],a[128:131],v[128:131],0
v_cmp_eq_u32 vcc,0,v27
s_cbranch_vccnz retry_289
v_mfma_f32_16x16x32_bf16 v[76:79],a[132:135],v[132:135],0
v_min3_u32 v27,v27,v128,v132
v_mfma_f32_16x16x32_bf16 v[72:75],a[136:139],v[136:139],v[72:75]
ds_read_b128 v[192:195],v17 offset:32768
v_mfma_f32_16x16x32_bf16 v[76:79],a[140:143],v[140:143],v[76:79]
ds_read_b128 v[196:199],v17 offset:34816
s_waitcnt lgkmcnt(10)
v_mfma_f32_16x16x32_bf16 v[72:75],a[144:147],v[144:147],v[72:75]
ds_read_b128 v[200:203],v17 offset:36864
v_min3_u32 v27,v27,v136,v140
s_waitcnt vmcnt(1)
v_mfma_f32_16x16x32_bf16 v[76:79],a[148:151],v[148:151],v[76:79]
ds_read_b128 v[204:207],v17 offset:38912
v_min3_u32 v27,v27,v144,v148
v_and_or_b32 v64,v64,-4,s48
v_mfma_f32_16x16x32_bf16 v[72:75],a[152:155],v[152:155],v[72:75]
ds_read_b128 v[208:211],v17 offset:40960
s_add_u32 s64,s49,s34
v_mfma_f32_16x16x32_bf16 v[76:79],a[156:159],v[156:159],v[76:79]
v_min3_u32 v27,v27,v152,v156
s_waitcnt lgkmcnt(9)
v_mfma_f32_16x16x32_bf16 v[72:75],a[160:163],v[160:163],v[72:75]
ds_read_b128 v[212:215],v17 offset:43008
buffer_store_dwordx4 v[64:67],v25,s[20:23],s64 offen offset:2048
v_mfma_f32_16x16x32_bf16 v[76:79],a[164:167],v[164:167],v[76:79]
ds_read_b128 v[216:219],v17 offset:45056
v_min3_u32 v27,v27,v160,v164
v_and_or_b32 v68,v68,-4,s48
v_mfma_f32_16x16x32_bf16 v[72:75],a[168:171],v[168:171],v[72:75]
ds_read_b128 v[220:223],v17 offset:47104
s_add_u32 s64,s49,s35
v_mfma_f32_16x16x32_bf16 v[76:79],a[172:175],v[172:175],v[76:79]
ds_read_b128 v[224:227],v17 offset:49152
s_waitcnt lgkmcnt(9)
v_mfma_f32_16x16x32_bf16 v[72:75],a[176:179],v[176:179],v[72:75]
ds_read_b128 v[228:231],v17 offset:51200
v_min3_u32 v27,v27,v168,v172
v_mfma_f32_16x16x32_bf16 v[76:79],a[180:183],v[180:183],v[76:79]
v_min3_u32 v27,v27,v176,v180
buffer_store_dwordx4 v[68:71],v25,s[20:23],s64 offen offset:3072
v_mfma_f32_16x16x32_bf16 v[72:75],a[184:187],v[184:187],v[72:75]
ds_read_b128 v[232:235],v17 offset:53248
s_mov_b32 s49,0x7fff0000
v_mfma_f32_16x16x32_bf16 v[76:79],a[188:191],v[188:191],v[76:79]
ds_read_b128 v[236:239],v17 offset:55296
s_waitcnt lgkmcnt(8)
v_mfma_f32_16x16x32_bf16 v[72:75],a[192:195],v[192:195],v[72:75]
ds_read_b128 v[240:243],v17 offset:57344
v_min3_u32 v27,v27,v184,v188
v_mfma_f32_16x16x32_bf16 v[76:79],a[196:199],v[196:199],v[76:79]
ds_read_b128 v[244:247],v17 offset:59392
v_min3_u32 v27,v27,v192,v196
v_mfma_f32_16x16x32_bf16 v[72:75],a[200:203],v[200:203],v[72:75]
ds_read_b128 v[248:251],v17 offset:61440
ds_bpermute_b32 v124,v41,v120
v_mfma_f32_16x16x32_bf16 v[76:79],a[204:207],v[204:207],v[76:79]
v_min3_u32 v27,v27,v200,v204
s_waitcnt lgkmcnt(8)
v_mfma_f32_16x16x32_bf16 v[72:75],a[208:211],v[208:211],v[72:75]
ds_read_b128 v[252:255],v17 offset:63488
ds_bpermute_b32 v125,v41,v121
v_mfma_f32_16x16x32_bf16 v[76:79],a[212:215],v[212:215],v[76:79]
v_min3_u32 v27,v27,v208,v212
v_mfma_f32_16x16x32_bf16 v[72:75],a[216:219],v[216:219],v[72:75]
v_mfma_f32_16x16x32_bf16 v[76:79],a[220:223],v[220:223],v[76:79]
v_min3_u32 v27,v27,v216,v220
s_waitcnt lgkmcnt(6)
v_mfma_f32_16x16x32_bf16 v[72:75],a[224:227],v[224:227],v[72:75]
s_waitcnt lgkmcnt(0)
v_mfma_f32_16x16x32_bf16 v[76:79],a[228:231],v[228:231],v[76:79]
v_min3_u32 v27,v27,v224,v228
v_mfma_f32_16x16x32_bf16 v[72:75],a[232:235],v[232:235],v[72:75]
v_lshlrev_b32 v104,16,v124
v_mfma_f32_16x16x32_bf16 v[76:79],a[236:239],v[236:239],v[76:79]
v_min3_u32 v27,v27,v232,v236
v_mfma_f32_16x16x32_bf16 v[72:75],a[240:243],v[240:243],v[72:75]
v_mfma_f32_16x16x32_bf16 v[76:79],a[244:247],v[244:247],v[76:79]
v_min3_u32 v27,v27,v240,v244
v_mfma_f32_16x16x32_bf16 v[72:75],a[248:251],v[248:251],v[72:75]
v_and_b32 v105,s80,v124
v_mfma_f32_16x16x32_bf16 v[76:79],a[252:255],v[252:255],v[76:79]
v_min3_u32 v27,v27,v248,v252
v_mfma_f32_16x16x32_bf16 v[80:83],a[0:3],v[128:131],0
v_cmp_eq_u32 vcc,0,v27
s_cbranch_vccnz retry_289
v_mfma_f32_16x16x32_bf16 v[84:87],a[4:7],v[132:135],0
v_lshlrev_b32 v106,16,v125
v_mfma_f32_16x16x32_bf16 v[80:83],a[8:11],v[136:139],v[80:83]
v_mfma_f32_16x16x32_bf16 v[84:87],a[12:15],v[140:143],v[84:87]
v_mfma_f32_16x16x32_bf16 v[80:83],a[16:19],v[144:147],v[80:83]
v_and_b32 v107,s80,v125
v_add_f32 v72,v72,v76
v_mfma_f32_16x16x32_bf16 v[84:87],a[20:23],v[148:151],v[84:87]
v_add_f32 v73,v73,v77
v_add_f32 v74,v74,v78
v_mfma_f32_16x16x32_bf16 v[80:83],a[24:27],v[152:155],v[80:83]
v_add_f32 v75,v75,v79
v_and_or_b32 v72,v72,-4,s48
v_mfma_f32_16x16x32_bf16 v[84:87],a[28:31],v[156:159],v[84:87]
s_add_u32 s64,s77,s33
v_mfma_f32_16x16x32_bf16 v[80:83],a[32:35],v[160:163],v[80:83]
buffer_store_dwordx4 v[72:75],v25,s[20:23],s64 offen offset:1024
v_mfma_f32_16x16x32_bf16 v[84:87],a[36:39],v[164:167],v[84:87]
v_mfma_f32_16x16x32_bf16 v[80:83],a[40:43],v[168:171],v[80:83]
v_mfma_f32_16x16x32_bf16 v[84:87],a[44:47],v[172:175],v[84:87]
v_mfma_f32_16x16x32_bf16 v[80:83],a[48:51],v[176:179],v[80:83]
v_mfma_f32_16x16x32_bf16 v[84:87],a[52:55],v[180:183],v[84:87]
v_mfma_f32_16x16x32_bf16 v[80:83],a[56:59],v[184:187],v[80:83]
v_mfma_f32_16x16x32_bf16 v[84:87],a[60:63],v[188:191],v[84:87]
v_mfma_f32_16x16x32_bf16 v[80:83],a[64:67],v[192:195],v[80:83]
buffer_load_dwordx4 v[96:99],v26,s[20:23],s77 offen offset:2048 sc1
v_mfma_f32_16x16x32_bf16 v[84:87],a[68:71],v[196:199],v[84:87]
buffer_load_dwordx4 v[100:103],v26,s[20:23],s77 offen offset:3072 sc1
v_mfma_f32_16x16x32_bf16 v[80:83],a[72:75],v[200:203],v[80:83]
v_mfma_f32_16x16x32_bf16 v[84:87],a[76:79],v[204:207],v[84:87]
v_mfma_f32_16x16x32_bf16 v[80:83],a[80:83],v[208:211],v[80:83]
v_mfma_f32_16x16x32_bf16 v[84:87],a[84:87],v[212:215],v[84:87]
v_mfma_f32_16x16x32_bf16 v[80:83],a[88:91],v[216:219],v[80:83]
v_mfma_f32_16x16x32_bf16 v[84:87],a[92:95],v[220:223],v[84:87]
v_mfma_f32_16x16x32_bf16 v[80:83],a[96:99],v[224:227],v[80:83]
v_mfma_f32_16x16x32_bf16 v[84:87],a[100:103],v[228:231],v[84:87]
v_mfma_f32_16x16x32_bf16 v[80:83],a[104:107],v[232:235],v[80:83]
buffer_load_dwordx4 v[92:95],v26,s[20:23],s77 offen offset:1024 sc1
v_mfma_f32_16x16x32_bf16 v[84:87],a[108:111],v[236:239],v[84:87]
v_mfma_f32_16x16x32_bf16 v[80:83],a[112:115],v[240:243],v[80:83]
v_mfma_f32_16x16x32_bf16 v[84:87],a[116:119],v[244:247],v[84:87]
v_mfma_f32_16x16x32_bf16 v[80:83],a[120:123],v[248:251],v[80:83]
v_mfma_f32_16x16x32_bf16 v[84:87],a[124:127],v[252:255],v[84:87]
s_branch epi_292
both_293:
s_waitcnt vmcnt(15) lgkmcnt(0)
s_barrier
ds_read_b128 v[224:227],v18 offset:0
ds_read_b128 v[228:231],v18 offset:2048
ds_read_b128 v[232:235],v18 offset:4096
ds_read_b128 v[236:239],v18 offset:6144
ds_read_b128 v[240:243],v18 offset:8192
ds_read_b128 v[244:247],v18 offset:10240
ds_read_b128 v[248:251],v18 offset:12288
s_waitcnt lgkmcnt(5)
v_mfma_f32_16x16x32_bf16 v[64:67],a[0:3],v[224:227],0
s_add_u32 s96,s71,1
s_add_u32 s92,s71,2
v_min_u32 v27,v224,v228
v_mfma_f32_16x16x32_bf16 v[68:71],a[128:131],v[224:227],0
ds_read_b128 v[252:255],v18 offset:14336
s_add_u32 s88,s70,s75
v_mfma_f32_16x16x32_bf16 v[64:67],a[4:7],v[228:231],v[64:67]
s_add_u32 s88,s88,2097152
s_xor_b32 s88,s88,0x2000
v_mfma_f32_16x16x32_bf16 v[68:71],a[132:135],v[228:231],v[68:71]
ds_read_b128 v[224:227],v18 offset:16384
s_waitcnt lgkmcnt(5)
v_mfma_f32_16x16x32_bf16 v[64:67],a[8:11],v[232:235],v[64:67]
s_xor_b32 s89,s88,1024
v_min3_u32 v27,v27,v232,v236
v_mfma_f32_16x16x32_bf16 v[68:71],a[136:139],v[232:235],v[68:71]
ds_read_b128 v[228:231],v18 offset:18432
v_mfma_f32_16x16x32_bf16 v[64:67],a[12:15],v[236:239],v[64:67]
s_xor_b32 m0,s72,0
v_mfma_f32_16x16x32_bf16 v[68:71],a[140:143],v[236:239],v[68:71]
ds_read_b128 v[232:235],v18 offset:20480
s_waitcnt lgkmcnt(5)
v_mfma_f32_16x16x32_bf16 v[64:67],a[16:19],v[240:243],v[64:67]
s_add_u32 s65,s88,0
v_min3_u32 v27,v27,v240,v244
v_mfma_f32_16x16x32_bf16 v[68:71],a[144:147],v[240:243],v[68:71]
ds_read_b128 v[236:239],v18 offset:22528
v_mfma_f32_16x16x32_bf16 v[64:67],a[20:23],v[244:247],v[64:67]
buffer_load_dwordx4 v16,s[20:23],s65 offen offset:0 sc1 lds
v_mfma_f32_16x16x32_bf16 v[68:71],a[148:151],v[244:247],v[68:71]
ds_read_b128 v[240:243],v18 offset:24576
s_waitcnt lgkmcnt(5)
v_mfma_f32_16x16x32_bf16 v[64:67],a[24:27],v[248:251],v[64:67]
buffer_load_dwordx4 v16,s[20:23],s65 offen offset:2048 sc1 lds
v_mfma_f32_16x16x32_bf16 v[68:71],a[152:155],v[248:251],v[68:71]
ds_read_b128 v[244:247],v18 offset:26624
v_min3_u32 v27,v27,v248,v252
v_mfma_f32_16x16x32_bf16 v[64:67],a[28:31],v[252:255],v[64:67]
s_xor_b32 m0,s72,16384
v_mfma_f32_16x16x32_bf16 v[68:71],a[156:159],v[252:255],v[68:71]
ds_read_b128 v[248:251],v18 offset:28672
s_waitcnt lgkmcnt(5)
v_mfma_f32_16x16x32_bf16 v[64:67],a[32:35],v[224:227],v[64:67]
s_add_u32 s65,s88,32768
v_min3_u32 v27,v27,v224,v228
v_mfma_f32_16x16x32_bf16 v[68:71],a[160:163],v[224:227],v[68:71]
ds_read_b128 v[252:255],v18 offset:30720
v_mfma_f32_16x16x32_bf16 v[64:67],a[36:39],v[228:231],v[64:67]
s_waitcnt vmcnt(4)
buffer_load_dwordx4 v16,s[20:23],s65 offen offset:0 sc1 lds
v_mfma_f32_16x16x32_bf16 v[68:71],a[164:167],v[228:231],v[68:71]
ds_read_b128 v[224:227],v18 offset:32768
s_waitcnt lgkmcnt(5)
v_mfma_f32_16x16x32_bf16 v[64:67],a[40:43],v[232:235],v[64:67]
v_cmp_gt_u32 vcc,s96,v29
v_cmp_gt_u32 s[92:93],s92,v29
v_min3_u32 v27,v27,v232,v236
v_mfma_f32_16x16x32_bf16 v[68:71],a[168:171],v[232:235],v[68:71]
ds_read_b128 v[228:231],v18 offset:34816
buffer_load_dwordx4 v16,s[20:23],s65 offen offset:2048 sc1 lds
v_mfma_f32_16x16x32_bf16 v[64:67],a[44:47],v[236:239],v[64:67]
v_mov_b32 v44,vcc_lo
v_mov_b32 v45,s92
v_mfma_f32_16x16x32_bf16 v[68:71],a[172:175],v[236:239],v[68:71]
ds_read_b128 v[232:235],v18 offset:36864
s_xor_b32 m0,s72,32768
s_waitcnt lgkmcnt(5)
v_mfma_f32_16x16x32_bf16 v[64:67],a[48:51],v[240:243],v[64:67]
ds_write_b64 v46,v[44:45]
v_min3_u32 v27,v27,v240,v244
v_mfma_f32_16x16x32_bf16 v[68:71],a[176:179],v[240:243],v[68:71]
ds_read_b128 v[236:239],v18 offset:38912
s_add_u32 s65,s88,65536
v_mfma_f32_16x16x32_bf16 v[64:67],a[52:55],v[244:247],v[64:67]
buffer_load_dwordx2 v[120:121],v20,s[36:39],s78 offen
v_mfma_f32_16x16x32_bf16 v[68:71],a[180:183],v[244:247],v[68:71]
ds_read_b128 v[240:243],v18 offset:40960
s_waitcnt lgkmcnt(6)
v_mfma_f32_16x16x32_bf16 v[64:67],a[56:59],v[248:251],v[64:67]
buffer_load_dwordx4 v16,s[20:23],s65 offen offset:0 sc1 lds
v_mfma_f32_16x16x32_bf16 v[68:71],a[184:187],v[248:251],v[68:71]
ds_read_b128 v[244:247],v18 offset:43008
buffer_load_dwordx4 v16,s[20:23],s65 offen offset:2048 sc1 lds
v_mfma_f32_16x16x32_bf16 v[64:67],a[60:63],v[252:255],v[64:67]
v_min3_u32 v27,v27,v248,v252
v_mfma_f32_16x16x32_bf16 v[68:71],a[188:191],v[252:255],v[68:71]
ds_read_b128 v[248:251],v18 offset:45056
s_xor_b32 m0,s72,49152
s_waitcnt lgkmcnt(6)
v_mfma_f32_16x16x32_bf16 v[64:67],a[64:67],v[224:227],v[64:67]
v_min3_u32 v27,v27,v224,v228
v_mfma_f32_16x16x32_bf16 v[68:71],a[192:195],v[224:227],v[68:71]
ds_read_b128 v[252:255],v18 offset:47104
s_add_u32 s65,s88,98304
v_mfma_f32_16x16x32_bf16 v[64:67],a[68:71],v[228:231],v[64:67]
v_mfma_f32_16x16x32_bf16 v[68:71],a[196:199],v[228:231],v[68:71]
ds_read_b128 v[224:227],v18 offset:49152
s_waitcnt lgkmcnt(5)
v_mfma_f32_16x16x32_bf16 v[64:67],a[72:75],v[232:235],v[64:67]
buffer_load_dwordx4 v16,s[20:23],s65 offen offset:0 sc1 lds
v_mfma_f32_16x16x32_bf16 v[68:71],a[200:203],v[232:235],v[68:71]
ds_read_b128 v[228:231],v18 offset:51200
buffer_load_dwordx4 v16,s[20:23],s65 offen offset:2048 sc1 lds
v_mfma_f32_16x16x32_bf16 v[64:67],a[76:79],v[236:239],v[64:67]
v_min3_u32 v27,v27,v232,v236
v_mfma_f32_16x16x32_bf16 v[68:71],a[204:207],v[236:239],v[68:71]
ds_read_b128 v[232:235],v18 offset:53248
s_waitcnt lgkmcnt(5)
v_mfma_f32_16x16x32_bf16 v[64:67],a[80:83],v[240:243],v[64:67]
s_waitcnt vmcnt(16)
s_barrier
ds_read_b64 v[44:45],v47
ds_read_b128 v[128:131],v17 offset:0
ds_read_b128 v[132:135],v17 offset:2048
v_mfma_f32_16x16x32_bf16 v[68:71],a[208:211],v[240:243],v[68:71]
ds_read_b128 v[236:239],v18 offset:55296
s_xor_b32 m0,s72,1024
v_min3_u32 v27,v27,v240,v244
v_mfma_f32_16x16x32_bf16 v[64:67],a[84:87],v[244:247],v[64:67]
ds_read_b128 v[136:139],v17 offset:4096
s_add_u32 s65,s89,0
v_mfma_f32_16x16x32_bf16 v[68:71],a[212:215],v[244:247],v[68:71]
ds_read_b128 v[240:243],v18 offset:57344
s_waitcnt lgkmcnt(9)
v_mfma_f32_16x16x32_bf16 v[64:67],a[88:91],v[248:251],v[64:67]
ds_read_b128 v[140:143],v17 offset:6144
buffer_load_dwordx4 v16,s[20:23],s65 offen offset:0 sc1 lds
v_mfma_f32_16x16x32_bf16 v[68:71],a[216:219],v[248:251],v[68:71]
ds_read_b128 v[244:247],v18 offset:59392
v_min3_u32 v27,v27,v248,v252
v_mfma_f32_16x16x32_bf16 v[64:67],a[92:95],v[252:255],v[64:67]
ds_read_b128 v[144:147],v17 offset:8192
ds_read_b128 v[148:151],v17 offset:10240
v_mfma_f32_16x16x32_bf16 v[68:71],a[220:223],v[252:255],v[68:71]
ds_read_b128 v[248:251],v18 offset:61440
s_waitcnt lgkmcnt(12)
v_mfma_f32_16x16x32_bf16 v[64:67],a[96:99],v[224:227],v[64:67]
ds_read_b128 v[152:155],v17 offset:12288
s_waitcnt lgkmcnt(11)
v_min3_u32 v27,v27,v224,v228
v_mfma_f32_16x16x32_bf16 v[68:71],a[224:227],v[224:227],v[68:71]
ds_read_b128 v[252:255],v18 offset:63488
v_readfirstlane_b32 s93,v45
v_mfma_f32_16x16x32_bf16 v[64:67],a[100:103],v[228:231],v[64:67]
ds_read_b128 v[156:159],v17 offset:14336
buffer_load_dwordx4 v16,s[20:23],s65 offen offset:2048 sc1 lds
v_mfma_f32_16x16x32_bf16 v[68:71],a[228:231],v[228:231],v[68:71]
s_xor_b32 m0,s72,17408
s_add_u32 s65,s89,32768
s_waitcnt lgkmcnt(10)
v_mfma_f32_16x16x32_bf16 v[64:67],a[104:107],v[232:235],v[64:67]
ds_read_b128 v[160:163],v17 offset:16384
ds_read_b128 v[164:167],v17 offset:18432
v_min3_u32 v27,v27,v232,v236
v_mfma_f32_16x16x32_bf16 v[68:71],a[232:235],v[232:235],v[68:71]
buffer_load_dwordx4 v16,s[20:23],s65 offen offset:0 sc1 lds
s_waitcnt vmcnt(12)
v_mfma_f32_16x16x32_bf16 v[64:67],a[108:111],v[236:239],v[64:67]
ds_read_b128 v[168:171],v17 offset:20480
buffer_load_dwordx4 v16,s[20:23],s65 offen offset:2048 sc1 lds
v_mfma_f32_16x16x32_bf16 v[68:71],a[236:239],v[236:239],v[68:71]
v_add_u32 v22,s71,-1
s_waitcnt lgkmcnt(9)
v_mfma_f32_16x16x32_bf16 v[64:67],a[112:115],v[240:243],v[64:67]
ds_read_b128 v[172:175],v17 offset:22528
v_min3_u32 v27,v27,v240,v244
v_mfma_f32_16x16x32_bf16 v[68:71],a[240:243],v[240:243],v[68:71]
s_xor_b32 m0,s72,33792
buffer_store_dword v22,v23,s[20:23],s97 offen sc1
v_mfma_f32_16x16x32_bf16 v[64:67],a[116:119],v[244:247],v[64:67]
ds_read_b128 v[176:179],v17 offset:24576
ds_read_b128 v[180:183],v17 offset:26624
s_mov_b32 s97,0x7fff0000
v_mfma_f32_16x16x32_bf16 v[68:71],a[244:247],v[244:247],v[68:71]
s_add_u32 s65,s89,65536
s_waitcnt lgkmcnt(7)
v_mfma_f32_16x16x32_bf16 v[64:67],a[120:123],v[248:251],v[64:67]
ds_read_b128 v[184:187],v17 offset:28672
v_min3_u32 v27,v27,v248,v252
v_mfma_f32_16x16x32_bf16 v[68:71],a[248:251],v[248:251],v[68:71]
buffer_load_dwordx4 v16,s[20:23],s65 offen offset:0 sc1 lds
v_mfma_f32_16x16x32_bf16 v[64:67],a[124:127],v[252:255],v[64:67]
ds_read_b128 v[188:191],v17 offset:30720
v_mfma_f32_16x16x32_bf16 v[68:71],a[252:255],v[252:255],v[68:71]
buffer_load_dwordx4 v16,s[20:23],s65 offen offset:2048 sc1 lds
v_mfma_f32_16x16x32_bf16 v[72:75],a[128:131],v[128:131],0
v_cmp_eq_u32 vcc,0,v27
s_cbranch_vccnz retry_289
v_mfma_f32_16x16x32_bf16 v[76:79],a[132:135],v[132:135],0
s_xor_b32 m0,s72,50176
v_min3_u32 v27,v27,v128,v132
v_mfma_f32_16x16x32_bf16 v[72:75],a[136:139],v[136:139],v[72:75]
ds_read_b128 v[192:195],v17 offset:32768
v_mfma_f32_16x16x32_bf16 v[76:79],a[140:143],v[140:143],v[76:79]
ds_read_b128 v[196:199],v17 offset:34816
s_add_u32 s65,s89,98304
s_waitcnt lgkmcnt(10)
v_mfma_f32_16x16x32_bf16 v[72:75],a[144:147],v[144:147],v[72:75]
ds_read_b128 v[200:203],v17 offset:36864
v_min3_u32 v27,v27,v136,v140
s_waitcnt vmcnt(11)
v_mfma_f32_16x16x32_bf16 v[76:79],a[148:151],v[148:151],v[76:79]
ds_read_b128 v[204:207],v17 offset:38912
buffer_load_dwordx4 v16,s[20:23],s65 offen offset:0 sc1 lds
v_mfma_f32_16x16x32_bf16 v[72:75],a[152:155],v[152:155],v[72:75]
ds_read_b128 v[208:211],v17 offset:40960
v_min3_u32 v27,v27,v144,v148
v_and_or_b32 v64,v64,-4,s48
v_mfma_f32_16x16x32_bf16 v[76:79],a[156:159],v[156:159],v[76:79]
buffer_load_dwordx4 v16,s[20:23],s65 offen offset:2048 sc1 lds
s_waitcnt lgkmcnt(9)
v_mfma_f32_16x16x32_bf16 v[72:75],a[160:163],v[160:163],v[72:75]
ds_read_b128 v[212:215],v17 offset:43008
v_min3_u32 v27,v27,v152,v156
s_add_u32 s64,s49,s34
v_mfma_f32_16x16x32_bf16 v[76:79],a[164:167],v[164:167],v[76:79]
ds_read_b128 v[216:219],v17 offset:45056
v_min3_u32 v27,v27,v160,v164
v_mfma_f32_16x16x32_bf16 v[72:75],a[168:171],v[168:171],v[72:75]
ds_read_b128 v[220:223],v17 offset:47104
buffer_store_dwordx4 v[64:67],v25,s[20:23],s64 offen offset:2048
v_mfma_f32_16x16x32_bf16 v[76:79],a[172:175],v[172:175],v[76:79]
ds_read_b128 v[224:227],v17 offset:49152
v_and_or_b32 v68,v68,-4,s48
s_waitcnt lgkmcnt(9)
v_mfma_f32_16x16x32_bf16 v[72:75],a[176:179],v[176:179],v[72:75]
ds_read_b128 v[228:231],v17 offset:51200
v_min3_u32 v27,v27,v168,v172
s_add_u32 s64,s49,s35
v_mfma_f32_16x16x32_bf16 v[76:79],a[180:183],v[180:183],v[76:79]
v_min3_u32 v27,v27,v176,v180
buffer_store_dwordx4 v[68:71],v25,s[20:23],s64 offen offset:3072
v_mfma_f32_16x16x32_bf16 v[72:75],a[184:187],v[184:187],v[72:75]
ds_read_b128 v[232:235],v17 offset:53248
s_mov_b32 s49,0x7fff0000
v_mfma_f32_16x16x32_bf16 v[76:79],a[188:191],v[188:191],v[76:79]
ds_read_b128 v[236:239],v17 offset:55296
s_waitcnt lgkmcnt(8)
v_mfma_f32_16x16x32_bf16 v[72:75],a[192:195],v[192:195],v[72:75]
ds_read_b128 v[240:243],v17 offset:57344
v_min3_u32 v27,v27,v184,v188
v_mfma_f32_16x16x32_bf16 v[76:79],a[196:199],v[196:199],v[76:79]
ds_read_b128 v[244:247],v17 offset:59392
v_min3_u32 v27,v27,v192,v196
v_mfma_f32_16x16x32_bf16 v[72:75],a[200:203],v[200:203],v[72:75]
ds_read_b128 v[248:251],v17 offset:61440
ds_bpermute_b32 v124,v41,v120
v_mfma_f32_16x16x32_bf16 v[76:79],a[204:207],v[204:207],v[76:79]
v_min3_u32 v27,v27,v200,v204
s_waitcnt lgkmcnt(8)
v_mfma_f32_16x16x32_bf16 v[72:75],a[208:211],v[208:211],v[72:75]
ds_read_b128 v[252:255],v17 offset:63488
ds_bpermute_b32 v125,v41,v121
v_mfma_f32_16x16x32_bf16 v[76:79],a[212:215],v[212:215],v[76:79]
v_min3_u32 v27,v27,v208,v212
v_mfma_f32_16x16x32_bf16 v[72:75],a[216:219],v[216:219],v[72:75]
v_mfma_f32_16x16x32_bf16 v[76:79],a[220:223],v[220:223],v[76:79]
v_min3_u32 v27,v27,v216,v220
s_waitcnt lgkmcnt(6)
v_mfma_f32_16x16x32_bf16 v[72:75],a[224:227],v[224:227],v[72:75]
s_waitcnt lgkmcnt(0)
v_mfma_f32_16x16x32_bf16 v[76:79],a[228:231],v[228:231],v[76:79]
v_min3_u32 v27,v27,v224,v228
v_mfma_f32_16x16x32_bf16 v[72:75],a[232:235],v[232:235],v[72:75]
v_lshlrev_b32 v104,16,v124
v_mfma_f32_16x16x32_bf16 v[76:79],a[236:239],v[236:239],v[76:79]
v_min3_u32 v27,v27,v232,v236
v_mfma_f32_16x16x32_bf16 v[72:75],a[240:243],v[240:243],v[72:75]
v_mfma_f32_16x16x32_bf16 v[76:79],a[244:247],v[244:247],v[76:79]
v_min3_u32 v27,v27,v240,v244
v_mfma_f32_16x16x32_bf16 v[72:75],a[248:251],v[248:251],v[72:75]
v_and_b32 v105,s80,v124
v_mfma_f32_16x16x32_bf16 v[76:79],a[252:255],v[252:255],v[76:79]
v_min3_u32 v27,v27,v248,v252
v_mfma_f32_16x16x32_bf16 v[80:83],a[0:3],v[128:131],0
v_cmp_eq_u32 vcc,0,v27
s_cbranch_vccnz retry_289
v_mfma_f32_16x16x32_bf16 v[84:87],a[4:7],v[132:135],0
v_lshlrev_b32 v106,16,v125
v_mfma_f32_16x16x32_bf16 v[80:83],a[8:11],v[136:139],v[80:83]
v_mfma_f32_16x16x32_bf16 v[84:87],a[12:15],v[140:143],v[84:87]
v_mfma_f32_16x16x32_bf16 v[80:83],a[16:19],v[144:147],v[80:83]
v_and_b32 v107,s80,v125
v_add_f32 v72,v72,v76
v_mfma_f32_16x16x32_bf16 v[84:87],a[20:23],v[148:151],v[84:87]
v_add_f32 v73,v73,v77
v_add_f32 v74,v74,v78
v_mfma_f32_16x16x32_bf16 v[80:83],a[24:27],v[152:155],v[80:83]
v_add_f32 v75,v75,v79
v_and_or_b32 v72,v72,-4,s48
v_mfma_f32_16x16x32_bf16 v[84:87],a[28:31],v[156:159],v[84:87]
s_add_u32 s64,s77,s33
v_mfma_f32_16x16x32_bf16 v[80:83],a[32:35],v[160:163],v[80:83]
buffer_store_dwordx4 v[72:75],v25,s[20:23],s64 offen offset:1024
v_mfma_f32_16x16x32_bf16 v[84:87],a[36:39],v[164:167],v[84:87]
v_mfma_f32_16x16x32_bf16 v[80:83],a[40:43],v[168:171],v[80:83]
v_mfma_f32_16x16x32_bf16 v[84:87],a[44:47],v[172:175],v[84:87]
v_mfma_f32_16x16x32_bf16 v[80:83],a[48:51],v[176:179],v[80:83]
v_mfma_f32_16x16x32_bf16 v[84:87],a[52:55],v[180:183],v[84:87]
v_mfma_f32_16x16x32_bf16 v[80:83],a[56:59],v[184:187],v[80:83]
v_mfma_f32_16x16x32_bf16 v[84:87],a[60:63],v[188:191],v[84:87]
v_mfma_f32_16x16x32_bf16 v[80:83],a[64:67],v[192:195],v[80:83]
buffer_load_dwordx4 v[96:99],v26,s[20:23],s77 offen offset:2048 sc1
v_mfma_f32_16x16x32_bf16 v[84:87],a[68:71],v[196:199],v[84:87]
buffer_load_dwordx4 v[100:103],v26,s[20:23],s77 offen offset:3072 sc1
v_mfma_f32_16x16x32_bf16 v[80:83],a[72:75],v[200:203],v[80:83]
v_mfma_f32_16x16x32_bf16 v[84:87],a[76:79],v[204:207],v[84:87]
v_mfma_f32_16x16x32_bf16 v[80:83],a[80:83],v[208:211],v[80:83]
v_mfma_f32_16x16x32_bf16 v[84:87],a[84:87],v[212:215],v[84:87]
v_mfma_f32_16x16x32_bf16 v[80:83],a[88:91],v[216:219],v[80:83]
v_mfma_f32_16x16x32_bf16 v[84:87],a[92:95],v[220:223],v[84:87]
v_mfma_f32_16x16x32_bf16 v[80:83],a[96:99],v[224:227],v[80:83]
v_mfma_f32_16x16x32_bf16 v[84:87],a[100:103],v[228:231],v[84:87]
v_mfma_f32_16x16x32_bf16 v[80:83],a[104:107],v[232:235],v[80:83]
buffer_load_dwordx4 v[92:95],v26,s[20:23],s77 offen offset:1024 sc1
v_mfma_f32_16x16x32_bf16 v[84:87],a[108:111],v[236:239],v[84:87]
v_mfma_f32_16x16x32_bf16 v[80:83],a[112:115],v[240:243],v[80:83]
v_mfma_f32_16x16x32_bf16 v[84:87],a[116:119],v[244:247],v[84:87]
v_mfma_f32_16x16x32_bf16 v[80:83],a[120:123],v[248:251],v[80:83]
v_mfma_f32_16x16x32_bf16 v[84:87],a[124:127],v[252:255],v[84:87]
epi_292:
buffer_load_dword v29,v21,s[20:23],s87 offen sc1
s_nop 6
v_pk_add_f32 v[88:89],v[80:81],v[84:85]
v_pk_add_f32 v[90:91],v[82:83],v[86:87]
s_waitcnt vmcnt(1)
s_branch ic_304
ip_302:
buffer_load_dwordx4 v[92:95],v26,s[20:23],s77 offen offset:1024 sc1
buffer_load_dwordx4 v[96:99],v26,s[20:23],s77 offen offset:2048 sc1
buffer_load_dwordx4 v[100:103],v26,s[20:23],s77 offen offset:3072 sc1
s_waitcnt vmcnt(0)
ic_304:
v_bitop3_b32 v22,v92,v96,v100 bitop3:0x80
v_and_b32 v22,s48,v22
v_cmp_eq_u32 vcc,0,v22
s_cbranch_vccz ik_303
s_sub_u32 s90,s90,1
s_cmp_gt_i32 s90,0
s_cbranch_scc1 ip_302
ik_303:
v_pk_add_f32 v[88:89],v[88:89],v[92:93]
v_pk_add_f32 v[96:97],v[96:97],v[100:101]
v_pk_add_f32 v[90:91],v[90:91],v[94:95]
v_pk_add_f32 v[98:99],v[98:99],v[102:103]
v_pk_add_f32 v[88:89],v[88:89],v[96:97]
v_pk_add_f32 v[90:91],v[90:91],v[98:99]
v_pk_fma_f32 v[88:89],v[88:89],v[52:53],v[104:105]
v_pk_fma_f32 v[90:91],v[90:91],v[54:55],v[106:107]
v_cvt_pk_bf16_f32 v88,v88,v89
v_cvt_pk_bf16_f32 v89,v90,v91
v_max_u32 v88,1,v88
ds_bpermute_b32 v88,v40,v88
ds_bpermute_b32 v89,v40,v89
v_xor_b32 v18,0x10000,v18
s_xor_b32 s49,s77,524288
s_cselect_b32 s64,0,3
s_xor_b32 s48,s48,s64
s_waitcnt lgkmcnt(0)
buffer_store_dwordx2 v[88:89],v19,s[20:23],s70 offen sc1
s_mov_b32 s77,s49
s_add_u32 s78,s78,65536
s_cmp_gt_u32 s71,40
s_cselect_b32 s65,s73,0x7fff0000
s_cselect_b32 s97,0x7fff0000,s73
v_mov_b32 v22,s71
buffer_store_dword v22,v23,s[20:23],s65 offen sc1
next_299:
v_xor_b32 v17,0x10000,v17
s_xor_b32 s72,s72,0x10000
s_add_u32 s70,s70,2097152
s_xor_b32 s70,s70,0x2000
s_add_u32 s71,s71,1
s_cmp_le_u32 s71,64
s_cbranch_scc1 seg_290
s_endpgm
retry_289:
s_sub_u32 s90,s90,64
s_cmp_lt_i32 s90,0
s_cbranch_scc1 giveup_197
s_mov_b32 s83,1
s_waitcnt vmcnt(0) lgkmcnt(0)
s_barrier
s_branch seg_290
kslow_288:
s_add_u32 s64,s79,0
s_lshl_b32 s70,s64,21
s_lshl_b32 s64,s64,13
s_and_b32 s64,s64,0x2000
s_xor_b32 s64,s64,s62
s_add_u32 s70,s70,s64
s_add_u32 s70,s70,29360128
s_mov_b32 s83,1
s_mov_b32 s87,s74
s_cmp_eq_u32 s50,0
s_cselect_b32 s74,s74,0x7fff0000
v_mov_b32 v47,132096
s_lshl_b32 s64,s50,3
s_add_u32 s64,s64,132096
v_mov_b32 v46,s64
v_mov_b32 v29,0
s_mov_b32 s97,0x7fff0000
s_mov_b32 s69,1
s_mov_b32 s68,0
s_mov_b32 s52,0x30003
s_mov_b32 s53,s52
seg_308:
s_add_u32 s94,s70,s75
s_xor_b32 s95,s94,1024
s_xor_b32 s91,s72,0x10000
s_waitcnt vmcnt(2)
v_cmp_gt_u32 vcc,s71,v29
s_cbranch_vccz nb_312
s_waitcnt vmcnt(0)
v_add_u32 v22,s71,-1
buffer_store_dword v22,v23,s[20:23],s97 offen sc1
s_mov_b32 s97,0x7fff0000
s_cmp_lg_u32 s50,0
s_cbranch_scc1 nb_312
buffer_load_dword v32,v21,s[20:23],s74 offen sc1
s_sleep 2
pl_314:
buffer_load_dword v33,v21,s[20:23],s74 offen sc1
s_waitcnt vmcnt(1)
v_cmp_gt_u32 vcc,s71,v32
v_mov_b32 v29,v32
s_cbranch_vccz pok_315
buffer_load_dword v32,v21,s[20:23],s74 offen sc1
s_waitcnt vmcnt(1)
v_cmp_gt_u32 vcc,s71,v33
v_mov_b32 v29,v33
s_cbranch_vccz pok_315
s_sub_u32 s90,s90,1
s_cmp_gt_i32 s90,0
s_cbranch_scc1 pl_314
pok_315:
nb_312:
s_barrier
s_xor_b32 m0,s91,0
s_add_u32 s65,s94,0
buffer_load_dwordx4 v16,s[20:23],s65 offen offset:0 sc1 lds
buffer_load_dwordx4 v16,s[20:23],s65 offen offset:2048 sc1 lds
s_xor_b32 m0,s91,16384
s_add_u32 s65,s94,32768
buffer_load_dwordx4 v16,s[20:23],s65 offen offset:0 sc1 lds
buffer_load_dwordx4 v16,s[20:23],s65 offen offset:2048 sc1 lds
s_xor_b32 m0,s91,32768
s_add_u32 s65,s94,65536
buffer_load_dwordx4 v16,s[20:23],s65 offen offset:0 sc1 lds
buffer_load_dwordx4 v16,s[20:23],s65 offen offset:2048 sc1 lds
s_xor_b32 m0,s91,49152
s_add_u32 s65,s94,98304
buffer_load_dwordx4 v16,s[20:23],s65 offen offset:0 sc1 lds
buffer_load_dwordx4 v16,s[20:23],s65 offen offset:2048 sc1 lds
s_waitcnt vmcnt(8)
v_add_u32 v22,s71,-1
buffer_store_dword v22,v23,s[20:23],s97 offen sc1
s_mov_b32 s97,0x7fff0000
s_waitcnt vmcnt(7)
s_barrier
ds_read_b128 v[224:227],v18 offset:0
ds_read_b128 v[228:231],v18 offset:2048
ds_read_b128 v[232:235],v18 offset:4096
ds_read_b128 v[236:239],v18 offset:6144
ds_read_b128 v[240:243],v18 offset:8192
ds_read_b128 v[244:247],v18 offset:10240
ds_read_b128 v[248:251],v18 offset:12288
s_waitcnt lgkmcnt(5)
v_mfma_f32_16x16x32_bf16 v[64:67],a[0:3],v[224:227],0
s_xor_b32 m0,s91,1024
v_min_u32 v27,v224,v228
v_mfma_f32_16x16x32_bf16 v[68:71],a[128:131],v[224:227],0
ds_read_b128 v[252:255],v18 offset:14336
v_mfma_f32_16x16x32_bf16 v[64:67],a[4:7],v[228:231],v[64:67]
s_add_u32 s65,s95,0
v_mfma_f32_16x16x32_bf16 v[68:71],a[132:135],v[228:231],v[68:71]
s_waitcnt vmcnt(5)
s_barrier
ds_read_b128 v[224:227],v18 offset:16384
s_waitcnt lgkmcnt(5)
v_mfma_f32_16x16x32_bf16 v[64:67],a[8:11],v[232:235],v[64:67]
buffer_load_dwordx4 v16,s[20:23],s65 offen offset:0 sc1 lds
v_mfma_f32_16x16x32_bf16 v[68:71],a[136:139],v[232:235],v[68:71]
ds_read_b128 v[228:231],v18 offset:18432
v_min3_u32 v27,v27,v232,v236
v_mfma_f32_16x16x32_bf16 v[64:67],a[12:15],v[236:239],v[64:67]
buffer_load_dwordx4 v16,s[20:23],s65 offen offset:2048 sc1 lds
v_mfma_f32_16x16x32_bf16 v[68:71],a[140:143],v[236:239],v[68:71]
ds_read_b128 v[232:235],v18 offset:20480
s_waitcnt lgkmcnt(5)
v_mfma_f32_16x16x32_bf16 v[64:67],a[16:19],v[240:243],v[64:67]
s_xor_b32 m0,s91,17408
v_min3_u32 v27,v27,v240,v244
v_mfma_f32_16x16x32_bf16 v[68:71],a[144:147],v[240:243],v[68:71]
ds_read_b128 v[236:239],v18 offset:22528
v_mfma_f32_16x16x32_bf16 v[64:67],a[20:23],v[244:247],v[64:67]
s_add_u32 s65,s95,32768
v_mfma_f32_16x16x32_bf16 v[68:71],a[148:151],v[244:247],v[68:71]
ds_read_b128 v[240:243],v18 offset:24576
s_waitcnt lgkmcnt(5)
v_mfma_f32_16x16x32_bf16 v[64:67],a[24:27],v[248:251],v[64:67]
buffer_load_dwordx4 v16,s[20:23],s65 offen offset:0 sc1 lds
v_mfma_f32_16x16x32_bf16 v[68:71],a[152:155],v[248:251],v[68:71]
ds_read_b128 v[244:247],v18 offset:26624
v_min3_u32 v27,v27,v248,v252
v_mfma_f32_16x16x32_bf16 v[64:67],a[28:31],v[252:255],v[64:67]
buffer_load_dwordx4 v16,s[20:23],s65 offen offset:2048 sc1 lds
v_mfma_f32_16x16x32_bf16 v[68:71],a[156:159],v[252:255],v[68:71]
ds_read_b128 v[248:251],v18 offset:28672
s_waitcnt lgkmcnt(5)
v_mfma_f32_16x16x32_bf16 v[64:67],a[32:35],v[224:227],v[64:67]
s_xor_b32 m0,s91,33792
v_min3_u32 v27,v27,v224,v228
v_mfma_f32_16x16x32_bf16 v[68:71],a[160:163],v[224:227],v[68:71]
ds_read_b128 v[252:255],v18 offset:30720
v_mfma_f32_16x16x32_bf16 v[64:67],a[36:39],v[228:231],v[64:67]
s_add_u32 s65,s95,65536
v_mfma_f32_16x16x32_bf16 v[68:71],a[164:167],v[228:231],v[68:71]
s_waitcnt vmcnt(5)
s_barrier
ds_read_b128 v[224:227],v18 offset:32768
s_waitcnt lgkmcnt(5)
v_mfma_f32_16x16x32_bf16 v[64:67],a[40:43],v[232:235],v[64:67]
buffer_load_dwordx4 v16,s[20:23],s65 offen offset:0 sc1 lds
v_mfma_f32_16x16x32_bf16 v[68:71],a[168:171],v[232:235],v[68:71]
ds_read_b128 v[228:231],v18 offset:34816
v_min3_u32 v27,v27,v232,v236
v_mfma_f32_16x16x32_bf16 v[64:67],a[44:47],v[236:239],v[64:67]
buffer_load_dwordx4 v16,s[20:23],s65 offen offset:2048 sc1 lds
v_mfma_f32_16x16x32_bf16 v[68:71],a[172:175],v[236:239],v[68:71]
ds_read_b128 v[232:235],v18 offset:36864
s_waitcnt lgkmcnt(5)
v_mfma_f32_16x16x32_bf16 v[64:67],a[48:51],v[240:243],v[64:67]
s_xor_b32 m0,s91,50176
v_min3_u32 v27,v27,v240,v244
v_mfma_f32_16x16x32_bf16 v[68:71],a[176:179],v[240:243],v[68:71]
ds_read_b128 v[236:239],v18 offset:38912
v_mfma_f32_16x16x32_bf16 v[64:67],a[52:55],v[244:247],v[64:67]
s_add_u32 s65,s95,98304
v_mfma_f32_16x16x32_bf16 v[68:71],a[180:183],v[244:247],v[68:71]
ds_read_b128 v[240:243],v18 offset:40960
s_waitcnt lgkmcnt(5)
v_mfma_f32_16x16x32_bf16 v[64:67],a[56:59],v[248:251],v[64:67]
buffer_load_dwordx4 v16,s[20:23],s65 offen offset:0 sc1 lds
v_mfma_f32_16x16x32_bf16 v[68:71],a[184:187],v[248:251],v[68:71]
ds_read_b128 v[244:247],v18 offset:43008
v_min3_u32 v27,v27,v248,v252
v_mfma_f32_16x16x32_bf16 v[64:67],a[60:63],v[252:255],v[64:67]
buffer_load_dwordx4 v16,s[20:23],s65 offen offset:2048 sc1 lds
v_mfma_f32_16x16x32_bf16 v[68:71],a[188:191],v[252:255],v[68:71]
ds_read_b128 v[248:251],v18 offset:45056
s_waitcnt lgkmcnt(5)
v_mfma_f32_16x16x32_bf16 v[64:67],a[64:67],v[224:227],v[64:67]
v_min3_u32 v27,v27,v224,v228
s_add_u32 s88,s70,s75
v_mfma_f32_16x16x32_bf16 v[68:71],a[192:195],v[224:227],v[68:71]
ds_read_b128 v[252:255],v18 offset:47104
s_add_u32 s88,s88,2097152
v_mfma_f32_16x16x32_bf16 v[64:67],a[68:71],v[228:231],v[64:67]
buffer_load_dwordx2 v[120:121],v20,s[36:39],s78 offen
v_mfma_f32_16x16x32_bf16 v[68:71],a[196:199],v[228:231],v[68:71]
ds_read_b128 v[224:227],v18 offset:49152
s_waitcnt lgkmcnt(5)
v_mfma_f32_16x16x32_bf16 v[64:67],a[72:75],v[232:235],v[64:67]
v_min3_u32 v27,v27,v232,v236
s_xor_b32 s88,s88,0x2000
v_mfma_f32_16x16x32_bf16 v[68:71],a[200:203],v[232:235],v[68:71]
ds_read_b128 v[228:231],v18 offset:51200
s_xor_b32 s89,s88,1024
v_mfma_f32_16x16x32_bf16 v[64:67],a[76:79],v[236:239],v[64:67]
v_mfma_f32_16x16x32_bf16 v[68:71],a[204:207],v[236:239],v[68:71]
ds_read_b128 v[232:235],v18 offset:53248
s_waitcnt lgkmcnt(5)
v_mfma_f32_16x16x32_bf16 v[64:67],a[80:83],v[240:243],v[64:67]
s_waitcnt vmcnt(5)
s_barrier
ds_read_b128 v[128:131],v17 offset:0
ds_read_b128 v[132:135],v17 offset:2048
v_mfma_f32_16x16x32_bf16 v[68:71],a[208:211],v[240:243],v[68:71]
ds_read_b128 v[236:239],v18 offset:55296
v_min3_u32 v27,v27,v240,v244
v_mfma_f32_16x16x32_bf16 v[64:67],a[84:87],v[244:247],v[64:67]
ds_read_b128 v[136:139],v17 offset:4096
v_mfma_f32_16x16x32_bf16 v[68:71],a[212:215],v[244:247],v[68:71]
ds_read_b128 v[240:243],v18 offset:57344
s_waitcnt lgkmcnt(8)
v_mfma_f32_16x16x32_bf16 v[64:67],a[88:91],v[248:251],v[64:67]
ds_read_b128 v[140:143],v17 offset:6144
v_min3_u32 v27,v27,v248,v252
v_mfma_f32_16x16x32_bf16 v[68:71],a[216:219],v[248:251],v[68:71]
ds_read_b128 v[244:247],v18 offset:59392
v_mfma_f32_16x16x32_bf16 v[64:67],a[92:95],v[252:255],v[64:67]
ds_read_b128 v[144:147],v17 offset:8192
ds_read_b128 v[148:151],v17 offset:10240
v_mfma_f32_16x16x32_bf16 v[68:71],a[220:223],v[252:255],v[68:71]
ds_read_b128 v[248:251],v18 offset:61440
s_waitcnt lgkmcnt(11)
v_mfma_f32_16x16x32_bf16 v[64:67],a[96:99],v[224:227],v[64:67]
ds_read_b128 v[152:155],v17 offset:12288
v_min3_u32 v27,v27,v224,v228
v_mfma_f32_16x16x32_bf16 v[68:71],a[224:227],v[224:227],v[68:71]
ds_read_b128 v[252:255],v18 offset:63488
v_mfma_f32_16x16x32_bf16 v[64:67],a[100:103],v[228:231],v[64:67]
ds_read_b128 v[156:159],v17 offset:14336
v_mfma_f32_16x16x32_bf16 v[68:71],a[228:231],v[228:231],v[68:71]
s_waitcnt lgkmcnt(10)
v_mfma_f32_16x16x32_bf16 v[64:67],a[104:107],v[232:235],v[64:67]
ds_read_b128 v[160:163],v17 offset:16384
ds_read_b128 v[164:167],v17 offset:18432
v_mfma_f32_16x16x32_bf16 v[68:71],a[232:235],v[232:235],v[68:71]
v_min3_u32 v27,v27,v232,v236
v_mfma_f32_16x16x32_bf16 v[64:67],a[108:111],v[236:239],v[64:67]
ds_read_b128 v[168:171],v17 offset:20480
v_mfma_f32_16x16x32_bf16 v[68:71],a[236:239],v[236:239],v[68:71]
s_waitcnt lgkmcnt(9)
v_mfma_f32_16x16x32_bf16 v[64:67],a[112:115],v[240:243],v[64:67]
ds_read_b128 v[172:175],v17 offset:22528
v_min3_u32 v27,v27,v240,v244
v_mfma_f32_16x16x32_bf16 v[68:71],a[240:243],v[240:243],v[68:71]
v_mfma_f32_16x16x32_bf16 v[64:67],a[116:119],v[244:247],v[64:67]
ds_read_b128 v[176:179],v17 offset:24576
ds_read_b128 v[180:183],v17 offset:26624
v_mfma_f32_16x16x32_bf16 v[68:71],a[244:247],v[244:247],v[68:71]
s_waitcnt lgkmcnt(7)
v_mfma_f32_16x16x32_bf16 v[64:67],a[120:123],v[248:251],v[64:67]
ds_read_b128 v[184:187],v17 offset:28672
v_min3_u32 v27,v27,v248,v252
v_mfma_f32_16x16x32_bf16 v[68:71],a[248:251],v[248:251],v[68:71]
v_mfma_f32_16x16x32_bf16 v[64:67],a[124:127],v[252:255],v[64:67]
ds_read_b128 v[188:191],v17 offset:30720
v_mfma_f32_16x16x32_bf16 v[68:71],a[252:255],v[252:255],v[68:71]
v_mfma_f32_16x16x32_bf16 v[72:75],a[128:131],v[128:131],0
v_cmp_eq_u32 vcc,0,v27
s_cbranch_vccnz retry_307
v_mfma_f32_16x16x32_bf16 v[76:79],a[132:135],v[132:135],0
v_min3_u32 v27,v27,v128,v132
v_mfma_f32_16x16x32_bf16 v[72:75],a[136:139],v[136:139],v[72:75]
s_waitcnt vmcnt(1)
s_barrier
ds_read_b128 v[192:195],v17 offset:32768
v_mfma_f32_16x16x32_bf16 v[76:79],a[140:143],v[140:143],v[76:79]
ds_read_b128 v[196:199],v17 offset:34816
s_waitcnt lgkmcnt(10)
v_mfma_f32_16x16x32_bf16 v[72:75],a[144:147],v[144:147],v[72:75]
ds_read_b128 v[200:203],v17 offset:36864
v_min3_u32 v27,v27,v136,v140
s_waitcnt vmcnt(0)
v_mfma_f32_16x16x32_bf16 v[76:79],a[148:151],v[148:151],v[76:79]
ds_read_b128 v[204:207],v17 offset:38912
v_min3_u32 v27,v27,v144,v148
v_and_or_b32 v64,v64,-4,s48
v_mfma_f32_16x16x32_bf16 v[72:75],a[152:155],v[152:155],v[72:75]
ds_read_b128 v[208:211],v17 offset:40960
s_add_u32 s64,s49,s34
v_mfma_f32_16x16x32_bf16 v[76:79],a[156:159],v[156:159],v[76:79]
v_min3_u32 v27,v27,v152,v156
s_waitcnt lgkmcnt(9)
v_mfma_f32_16x16x32_bf16 v[72:75],a[160:163],v[160:163],v[72:75]
ds_read_b128 v[212:215],v17 offset:43008
buffer_store_dwordx4 v[64:67],v25,s[20:23],s64 offen offset:2048 sc1
v_mfma_f32_16x16x32_bf16 v[76:79],a[164:167],v[164:167],v[76:79]
ds_read_b128 v[216:219],v17 offset:45056
v_min3_u32 v27,v27,v160,v164
v_and_or_b32 v68,v68,-4,s48
v_mfma_f32_16x16x32_bf16 v[72:75],a[168:171],v[168:171],v[72:75]
ds_read_b128 v[220:223],v17 offset:47104
s_add_u32 s64,s49,s35
v_mfma_f32_16x16x32_bf16 v[76:79],a[172:175],v[172:175],v[76:79]
ds_read_b128 v[224:227],v17 offset:49152
s_waitcnt lgkmcnt(9)
v_mfma_f32_16x16x32_bf16 v[72:75],a[176:179],v[176:179],v[72:75]
ds_read_b128 v[228:231],v17 offset:51200
v_min3_u32 v27,v27,v168,v172
v_mfma_f32_16x16x32_bf16 v[76:79],a[180:183],v[180:183],v[76:79]
v_min3_u32 v27,v27,v176,v180
buffer_store_dwordx4 v[68:71],v25,s[20:23],s64 offen offset:3072 sc1
v_mfma_f32_16x16x32_bf16 v[72:75],a[184:187],v[184:187],v[72:75]
ds_read_b128 v[232:235],v17 offset:53248
s_mov_b32 s49,0x7fff0000
v_mfma_f32_16x16x32_bf16 v[76:79],a[188:191],v[188:191],v[76:79]
ds_read_b128 v[236:239],v17 offset:55296
s_waitcnt lgkmcnt(8)
v_mfma_f32_16x16x32_bf16 v[72:75],a[192:195],v[192:195],v[72:75]
ds_read_b128 v[240:243],v17 offset:57344
v_min3_u32 v27,v27,v184,v188
v_mfma_f32_16x16x32_bf16 v[76:79],a[196:199],v[196:199],v[76:79]
ds_read_b128 v[244:247],v17 offset:59392
v_min3_u32 v27,v27,v192,v196
v_mfma_f32_16x16x32_bf16 v[72:75],a[200:203],v[200:203],v[72:75]
ds_read_b128 v[248:251],v17 offset:61440
ds_bpermute_b32 v124,v41,v120
v_mfma_f32_16x16x32_bf16 v[76:79],a[204:207],v[204:207],v[76:79]
v_min3_u32 v27,v27,v200,v204
s_waitcnt lgkmcnt(8)
v_mfma_f32_16x16x32_bf16 v[72:75],a[208:211],v[208:211],v[72:75]
ds_read_b128 v[252:255],v17 offset:63488
ds_bpermute_b32 v125,v41,v121
v_mfma_f32_16x16x32_bf16 v[76:79],a[212:215],v[212:215],v[76:79]
v_min3_u32 v27,v27,v208,v212
v_mfma_f32_16x16x32_bf16 v[72:75],a[216:219],v[216:219],v[72:75]
v_mfma_f32_16x16x32_bf16 v[76:79],a[220:223],v[220:223],v[76:79]
v_min3_u32 v27,v27,v216,v220
s_waitcnt lgkmcnt(6)
v_mfma_f32_16x16x32_bf16 v[72:75],a[224:227],v[224:227],v[72:75]
s_waitcnt lgkmcnt(0)
v_mfma_f32_16x16x32_bf16 v[76:79],a[228:231],v[228:231],v[76:79]
v_min3_u32 v27,v27,v224,v228
v_mfma_f32_16x16x32_bf16 v[72:75],a[232:235],v[232:235],v[72:75]
v_lshlrev_b32 v104,16,v124
v_mfma_f32_16x16x32_bf16 v[76:79],a[236:239],v[236:239],v[76:79]
v_min3_u32 v27,v27,v232,v236
v_mfma_f32_16x16x32_bf16 v[72:75],a[240:243],v[240:243],v[72:75]
v_mfma_f32_16x16x32_bf16 v[76:79],a[244:247],v[244:247],v[76:79]
v_min3_u32 v27,v27,v240,v244
v_mfma_f32_16x16x32_bf16 v[72:75],a[248:251],v[248:251],v[72:75]
v_and_b32 v105,s80,v124
v_mfma_f32_16x16x32_bf16 v[76:79],a[252:255],v[252:255],v[76:79]
v_min3_u32 v27,v27,v248,v252
v_mfma_f32_16x16x32_bf16 v[80:83],a[0:3],v[128:131],0
v_cmp_eq_u32 vcc,0,v27
s_cbranch_vccnz retry_307
v_mfma_f32_16x16x32_bf16 v[84:87],a[4:7],v[132:135],0
v_lshlrev_b32 v106,16,v125
v_mfma_f32_16x16x32_bf16 v[80:83],a[8:11],v[136:139],v[80:83]
v_mfma_f32_16x16x32_bf16 v[84:87],a[12:15],v[140:143],v[84:87]
v_mfma_f32_16x16x32_bf16 v[80:83],a[16:19],v[144:147],v[80:83]
v_and_b32 v107,s80,v125
v_add_f32 v72,v72,v76
v_mfma_f32_16x16x32_bf16 v[84:87],a[20:23],v[148:151],v[84:87]
v_add_f32 v73,v73,v77
v_add_f32 v74,v74,v78
v_mfma_f32_16x16x32_bf16 v[80:83],a[24:27],v[152:155],v[80:83]
v_add_f32 v75,v75,v79
v_and_or_b32 v72,v72,-4,s48
v_mfma_f32_16x16x32_bf16 v[84:87],a[28:31],v[156:159],v[84:87]
s_add_u32 s64,s77,s33
v_mfma_f32_16x16x32_bf16 v[80:83],a[32:35],v[160:163],v[80:83]
buffer_store_dwordx4 v[72:75],v25,s[20:23],s64 offen offset:1024 sc1
v_mfma_f32_16x16x32_bf16 v[84:87],a[36:39],v[164:167],v[84:87]
v_mfma_f32_16x16x32_bf16 v[80:83],a[40:43],v[168:171],v[80:83]
v_mfma_f32_16x16x32_bf16 v[84:87],a[44:47],v[172:175],v[84:87]
v_mfma_f32_16x16x32_bf16 v[80:83],a[48:51],v[176:179],v[80:83]
v_mfma_f32_16x16x32_bf16 v[84:87],a[52:55],v[180:183],v[84:87]
v_mfma_f32_16x16x32_bf16 v[80:83],a[56:59],v[184:187],v[80:83]
v_mfma_f32_16x16x32_bf16 v[84:87],a[60:63],v[188:191],v[84:87]
v_mfma_f32_16x16x32_bf16 v[80:83],a[64:67],v[192:195],v[80:83]
buffer_load_dwordx4 v[96:99],v26,s[20:23],s77 offen offset:2048 sc1
v_mfma_f32_16x16x32_bf16 v[84:87],a[68:71],v[196:199],v[84:87]
buffer_load_dwordx4 v[100:103],v26,s[20:23],s77 offen offset:3072 sc1
v_mfma_f32_16x16x32_bf16 v[80:83],a[72:75],v[200:203],v[80:83]
v_mfma_f32_16x16x32_bf16 v[84:87],a[76:79],v[204:207],v[84:87]
v_mfma_f32_16x16x32_bf16 v[80:83],a[80:83],v[208:211],v[80:83]
v_mfma_f32_16x16x32_bf16 v[84:87],a[84:87],v[212:215],v[84:87]
v_mfma_f32_16x16x32_bf16 v[80:83],a[88:91],v[216:219],v[80:83]
v_mfma_f32_16x16x32_bf16 v[84:87],a[92:95],v[220:223],v[84:87]
v_mfma_f32_16x16x32_bf16 v[80:83],a[96:99],v[224:227],v[80:83]
v_mfma_f32_16x16x32_bf16 v[84:87],a[100:103],v[228:231],v[84:87]
v_mfma_f32_16x16x32_bf16 v[80:83],a[104:107],v[232:235],v[80:83]
buffer_load_dwordx4 v[92:95],v26,s[20:23],s77 offen offset:1024 sc1
v_mfma_f32_16x16x32_bf16 v[84:87],a[108:111],v[236:239],v[84:87]
v_mfma_f32_16x16x32_bf16 v[80:83],a[112:115],v[240:243],v[80:83]
v_mfma_f32_16x16x32_bf16 v[84:87],a[116:119],v[244:247],v[84:87]
v_mfma_f32_16x16x32_bf16 v[80:83],a[120:123],v[248:251],v[80:83]
v_mfma_f32_16x16x32_bf16 v[84:87],a[124:127],v[252:255],v[84:87]
epi_310:
buffer_load_dword v29,v21,s[20:23],s87 offen sc1
s_nop 6
v_pk_add_f32 v[88:89],v[80:81],v[84:85]
v_pk_add_f32 v[90:91],v[82:83],v[86:87]
s_waitcnt vmcnt(1)
s_branch ic_320
ip_318:
buffer_load_dwordx4 v[92:95],v26,s[20:23],s77 offen offset:1024 sc1
buffer_load_dwordx4 v[96:99],v26,s[20:23],s77 offen offset:2048 sc1
buffer_load_dwordx4 v[100:103],v26,s[20:23],s77 offen offset:3072 sc1
s_waitcnt vmcnt(0)
ic_320:
v_bitop3_b32 v22,v92,v96,v100 bitop3:0x80
v_and_b32 v22,s48,v22
v_cmp_eq_u32 vcc,0,v22
s_cbranch_vccz ik_319
s_sub_u32 s90,s90,1
s_cmp_gt_i32 s90,0
s_cbranch_scc1 ip_318
ik_319:
v_pk_add_f32 v[88:89],v[88:89],v[92:93]
v_pk_add_f32 v[96:97],v[96:97],v[100:101]
v_pk_add_f32 v[90:91],v[90:91],v[94:95]
v_pk_add_f32 v[98:99],v[98:99],v[102:103]
v_pk_add_f32 v[88:89],v[88:89],v[96:97]
v_pk_add_f32 v[90:91],v[90:91],v[98:99]
v_pk_fma_f32 v[88:89],v[88:89],v[52:53],v[104:105]
v_pk_fma_f32 v[90:91],v[90:91],v[54:55],v[106:107]
v_cvt_pk_bf16_f32 v88,v88,v89
v_cvt_pk_bf16_f32 v89,v90,v91
v_max_u32 v88,1,v88
ds_bpermute_b32 v88,v40,v88
ds_bpermute_b32 v89,v40,v89
v_xor_b32 v18,0x10000,v18
s_xor_b32 s49,s77,524288
s_cselect_b32 s64,0,3
s_xor_b32 s48,s48,s64
s_waitcnt lgkmcnt(0)
buffer_store_dwordx2 v[88:89],v19,s[20:23],s70 offen sc1
s_mov_b32 s77,s49
s_add_u32 s78,s78,65536
s_cmp_gt_u32 s71,40
s_cselect_b32 s65,s73,0x7fff0000
s_cselect_b32 s97,0x7fff0000,s73
v_mov_b32 v22,s71
buffer_store_dword v22,v23,s[20:23],s65 offen sc1
next_317:
v_xor_b32 v17,0x10000,v17
s_xor_b32 s72,s72,0x10000
s_add_u32 s70,s70,2097152
s_xor_b32 s70,s70,0x2000
s_add_u32 s71,s71,1
s_cmp_le_u32 s71,64
s_cbranch_scc1 seg_308
s_endpgm
retry_307:
s_sub_u32 s90,s90,64
s_cmp_lt_i32 s90,0
s_cbranch_scc1 giveup_197
s_mov_b32 s83,1
s_waitcnt vmcnt(0) lgkmcnt(0)
s_barrier
s_branch seg_308
r_w4_216:
s_load_dwordx2 s[4:5],s[0:1],88
s_load_dwordx2 s[6:7],s[0:1],112
s_lshr_b32 s41,s59,3
s_and_b32 s42,s59,7
s_mul_i32 s66,s41,1835008
s_lshl_b32 s64,s42,8
s_add_u32 s66,s66,s64
s_lshl_b32 s67,s50,1
s_and_b32 s64,s41,1
s_add_u32 s67,s67,s64
s_waitcnt lgkmcnt(0)
s_mov_b32 s32,s4
s_and_b32 s33,s5,0xffff
s_mov_b32 s34,0x700000
s_mov_b32 s35,0x20000
s_sub_u32 s36,s6,0x1000
s_subb_u32 s37,s7,0
s_and_b32 s37,s37,0xffff
s_mov_b32 s38,0x401000
s_mov_b32 s39,0x20000
v_lshrrev_b32 v5,2,v3
v_lshl_add_u32 v5,v4,2,v5
v_and_b32 v6,3,v3
v_lshlrev_b32 v6,3,v6
v_lshl_add_u32 v6,v5,8,v6
v_and_b32 v5,7,v5
v_xor_b32 v5,s67,v5
v_lshl_add_u32 v12,v5,5,v6
v_xor_b32 v13,32,v12
v_and_b32 v5,15,v1
v_and_b32 v6,3,v4
v_lshlrev_b32 v6,1,v6
v_xor_b32 v5,v5,v6
v_mul_u32_u24 v6,2048,v4
v_xor_b32 v7,0,v5
v_lshl_add_u32 v8,v7,4,v6
v_xor_b32 v7,8,v5
v_lshl_add_u32 v9,v7,4,v6
s_mul_i32 s74,s50,131072
s_add_u32 s74,s74,s66
s_lshl_b32 s75,s50,14
s_mul_i32 s76,s50,65536
s_add_u32 s76,s76,s66
s_lshl_b32 s77,s50,13
s_add_u32 s64,s74,0
s_add_u32 m0,s75,0
s_nop 0
buffer_load_dwordx4 v8,s[32:35],s64 offen nt lds
s_add_u32 s64,s74,8192
s_add_u32 m0,s75,1024
s_nop 0
buffer_load_dwordx4 v9,s[32:35],s64 offen nt lds
s_add_u32 s64,s74,16384
s_add_u32 m0,s75,2048
s_nop 0
buffer_load_dwordx4 v8,s[32:35],s64 offen nt lds
s_add_u32 s64,s74,24576
s_add_u32 m0,s75,3072
s_nop 0
buffer_load_dwordx4 v9,s[32:35],s64 offen nt lds
s_add_u32 s64,s74,32768
s_add_u32 m0,s75,4096
s_nop 0
buffer_load_dwordx4 v8,s[32:35],s64 offen nt lds
s_add_u32 s64,s74,40960
s_add_u32 m0,s75,5120
s_nop 0
buffer_load_dwordx4 v9,s[32:35],s64 offen nt lds
s_add_u32 s64,s74,49152
s_add_u32 m0,s75,6144
s_nop 0
buffer_load_dwordx4 v8,s[32:35],s64 offen nt lds
s_add_u32 s64,s74,57344
s_add_u32 m0,s75,7168
s_nop 0
buffer_load_dwordx4 v9,s[32:35],s64 offen nt lds
s_add_u32 s64,s74,65536
s_add_u32 m0,s75,8192
s_nop 0
buffer_load_dwordx4 v8,s[32:35],s64 offen nt lds
s_add_u32 s64,s74,73728
s_add_u32 m0,s75,9216
s_nop 0
buffer_load_dwordx4 v9,s[32:35],s64 offen nt lds
s_add_u32 s64,s74,81920
s_add_u32 m0,s75,10240
s_nop 0
buffer_load_dwordx4 v8,s[32:35],s64 offen nt lds
s_add_u32 s64,s74,90112
s_add_u32 m0,s75,11264
s_nop 0
buffer_load_dwordx4 v9,s[32:35],s64 offen nt lds
s_add_u32 s64,s74,98304
s_add_u32 m0,s75,12288
s_nop 0
buffer_load_dwordx4 v8,s[32:35],s64 offen nt lds
s_add_u32 s64,s74,106496
s_add_u32 m0,s75,13312
s_nop 0
buffer_load_dwordx4 v9,s[32:35],s64 offen nt lds
s_add_u32 s64,s74,114688
s_add_u32 m0,s75,14336
s_nop 0
buffer_load_dwordx4 v8,s[32:35],s64 offen nt lds
s_add_u32 s64,s74,122880
s_add_u32 m0,s75,15360
s_nop 0
buffer_load_dwordx4 v9,s[32:35],s64 offen nt lds
s_add_u32 s64,s74,524288
s_add_u32 m0,s75,65536
s_nop 0
buffer_load_dwordx4 v8,s[32:35],s64 offen nt lds
s_add_u32 s64,s74,532480
s_add_u32 m0,s75,66560
s_nop 0
buffer_load_dwordx4 v9,s[32:35],s64 offen nt lds
s_add_u32 s64,s74,540672
s_add_u32 m0,s75,67584
s_nop 0
buffer_load_dwordx4 v8,s[32:35],s64 offen nt lds
s_add_u32 s64,s74,548864
s_add_u32 m0,s75,68608
s_nop 0
buffer_load_dwordx4 v9,s[32:35],s64 offen nt lds
s_add_u32 s64,s74,557056
s_add_u32 m0,s75,69632
s_nop 0
buffer_load_dwordx4 v8,s[32:35],s64 offen nt lds
s_add_u32 s64,s74,565248
s_add_u32 m0,s75,70656
s_nop 0
buffer_load_dwordx4 v9,s[32:35],s64 offen nt lds
s_add_u32 s64,s74,573440
s_add_u32 m0,s75,71680
s_nop 0
buffer_load_dwordx4 v8,s[32:35],s64 offen nt lds
s_add_u32 s64,s74,581632
s_add_u32 m0,s75,72704
s_nop 0
buffer_load_dwordx4 v9,s[32:35],s64 offen nt lds
s_add_u32 s64,s74,589824
s_add_u32 m0,s75,73728
s_nop 0
buffer_load_dwordx4 v8,s[32:35],s64 offen nt lds
s_add_u32 s64,s74,598016
s_add_u32 m0,s75,74752
s_nop 0
buffer_load_dwordx4 v9,s[32:35],s64 offen nt lds
s_add_u32 s64,s74,606208
s_add_u32 m0,s75,75776
s_nop 0
buffer_load_dwordx4 v8,s[32:35],s64 offen nt lds
s_add_u32 s64,s74,614400
s_add_u32 m0,s75,76800
s_nop 0
buffer_load_dwordx4 v9,s[32:35],s64 offen nt lds
s_add_u32 s64,s74,622592
s_add_u32 m0,s75,77824
s_nop 0
buffer_load_dwordx4 v8,s[32:35],s64 offen nt lds
s_add_u32 s64,s74,630784
s_add_u32 m0,s75,78848
s_nop 0
buffer_load_dwordx4 v9,s[32:35],s64 offen nt lds
s_add_u32 s64,s74,638976
s_add_u32 m0,s75,79872
s_nop 0
buffer_load_dwordx4 v8,s[32:35],s64 offen nt lds
s_add_u32 s64,s74,647168
s_add_u32 m0,s75,80896
s_nop 0
buffer_load_dwordx4 v9,s[32:35],s64 offen nt lds
s_waitcnt vmcnt(16)
s_barrier
ds_read_b64_tr_b16 a[0:1],v12 offset:0
ds_read_b64_tr_b16 a[112:113],v13 offset:0
ds_read_b64_tr_b16 a[2:3],v12 offset:4096
ds_read_b64_tr_b16 a[114:115],v13 offset:4096
ds_read_b64_tr_b16 a[4:5],v12 offset:8192
ds_read_b64_tr_b16 a[116:117],v13 offset:8192
ds_read_b64_tr_b16 a[6:7],v12 offset:12288
ds_read_b64_tr_b16 a[118:119],v13 offset:12288
s_waitcnt lgkmcnt(4)
ds_read_b64_tr_b16 a[8:9],v12 offset:16384
ds_read_b64_tr_b16 a[120:121],v13 offset:16384
ds_read_b64_tr_b16 a[10:11],v12 offset:20480
ds_read_b64_tr_b16 a[122:123],v13 offset:20480
ds_read_b64_tr_b16 a[12:13],v12 offset:28672
ds_read_b64_tr_b16 a[124:125],v13 offset:28672
ds_read_b64_tr_b16 a[14:15],v12 offset:32768
ds_read_b64_tr_b16 a[126:127],v13 offset:32768
s_waitcnt lgkmcnt(4)
ds_read_b64_tr_b16 a[16:17],v12 offset:36864
ds_read_b64_tr_b16 a[128:129],v13 offset:36864
ds_read_b64_tr_b16 a[18:19],v12 offset:40960
ds_read_b64_tr_b16 a[130:131],v13 offset:40960
ds_read_b64_tr_b16 a[20:21],v12 offset:45056
ds_read_b64_tr_b16 a[132:133],v13 offset:45056
ds_read_b64_tr_b16 a[22:23],v12 offset:49152
ds_read_b64_tr_b16 a[134:135],v13 offset:49152
s_waitcnt lgkmcnt(4)
ds_read_b64_tr_b16 a[24:25],v12 offset:57344
ds_read_b64_tr_b16 a[136:137],v13 offset:57344
ds_read_b64_tr_b16 a[26:27],v12 offset:61440
ds_read_b64_tr_b16 a[138:139],v13 offset:61440
ds_read_b64_tr_b16 a[96:97],v12 offset:24576
ds_read_b64_tr_b16 a[208:209],v13 offset:24576
ds_read_b64_tr_b16 a[98:99],v12 offset:53248
ds_read_b64_tr_b16 a[210:211],v13 offset:53248
s_waitcnt lgkmcnt(4)
v_xor_b32 v12,0x10000,v12
v_xor_b32 v13,0x10000,v13
s_waitcnt lgkmcnt(0)
s_barrier
s_add_u32 s64,s74,1048576
s_add_u32 m0,s75,0
s_nop 0
buffer_load_dwordx4 v8,s[32:35],s64 offen nt lds
s_add_u32 s64,s74,1056768
s_add_u32 m0,s75,1024
s_nop 0
buffer_load_dwordx4 v9,s[32:35],s64 offen nt lds
s_add_u32 s64,s74,1064960
s_add_u32 m0,s75,2048
s_nop 0
buffer_load_dwordx4 v8,s[32:35],s64 offen nt lds
s_add_u32 s64,s74,1073152
s_add_u32 m0,s75,3072
s_nop 0
buffer_load_dwordx4 v9,s[32:35],s64 offen nt lds
s_add_u32 s64,s74,1081344
s_add_u32 m0,s75,4096
s_nop 0
buffer_load_dwordx4 v8,s[32:35],s64 offen nt lds
s_add_u32 s64,s74,1089536
s_add_u32 m0,s75,5120
s_nop 0
buffer_load_dwordx4 v9,s[32:35],s64 offen nt lds
s_add_u32 s64,s74,1097728
s_add_u32 m0,s75,6144
s_nop 0
buffer_load_dwordx4 v8,s[32:35],s64 offen nt lds
s_add_u32 s64,s74,1105920
s_add_u32 m0,s75,7168
s_nop 0
buffer_load_dwordx4 v9,s[32:35],s64 offen nt lds
s_add_u32 s64,s74,1114112
s_add_u32 m0,s75,8192
s_nop 0
buffer_load_dwordx4 v8,s[32:35],s64 offen nt lds
s_add_u32 s64,s74,1122304
s_add_u32 m0,s75,9216
s_nop 0
buffer_load_dwordx4 v9,s[32:35],s64 offen nt lds
s_add_u32 s64,s74,1130496
s_add_u32 m0,s75,10240
s_nop 0
buffer_load_dwordx4 v8,s[32:35],s64 offen nt lds
s_add_u32 s64,s74,1138688
s_add_u32 m0,s75,11264
s_nop 0
buffer_load_dwordx4 v9,s[32:35],s64 offen nt lds
s_add_u32 s64,s74,1146880
s_add_u32 m0,s75,12288
s_nop 0
buffer_load_dwordx4 v8,s[32:35],s64 offen nt lds
s_add_u32 s64,s74,1155072
s_add_u32 m0,s75,13312
s_nop 0
buffer_load_dwordx4 v9,s[32:35],s64 offen nt lds
s_add_u32 s64,s74,1163264
s_add_u32 m0,s75,14336
s_nop 0
buffer_load_dwordx4 v8,s[32:35],s64 offen nt lds
s_add_u32 s64,s74,1171456
s_add_u32 m0,s75,15360
s_nop 0
buffer_load_dwordx4 v9,s[32:35],s64 offen nt lds
s_waitcnt vmcnt(16)
s_barrier
ds_read_b64_tr_b16 a[28:29],v12 offset:0
ds_read_b64_tr_b16 a[140:141],v13 offset:0
ds_read_b64_tr_b16 a[30:31],v12 offset:4096
ds_read_b64_tr_b16 a[142:143],v13 offset:4096
ds_read_b64_tr_b16 a[32:33],v12 offset:8192
ds_read_b64_tr_b16 a[144:145],v13 offset:8192
ds_read_b64_tr_b16 a[34:35],v12 offset:12288
ds_read_b64_tr_b16 a[146:147],v13 offset:12288
s_waitcnt lgkmcnt(4)
ds_read_b64_tr_b16 a[36:37],v12 offset:20480
ds_read_b64_tr_b16 a[148:149],v13 offset:20480
ds_read_b64_tr_b16 a[38:39],v12 offset:24576
ds_read_b64_tr_b16 a[150:151],v13 offset:24576
ds_read_b64_tr_b16 a[40:41],v12 offset:28672
ds_read_b64_tr_b16 a[152:153],v13 offset:28672
ds_read_b64_tr_b16 a[42:43],v12 offset:32768
ds_read_b64_tr_b16 a[154:155],v13 offset:32768
s_waitcnt lgkmcnt(4)
ds_read_b64_tr_b16 a[44:45],v12 offset:36864
ds_read_b64_tr_b16 a[156:157],v13 offset:36864
ds_read_b64_tr_b16 a[46:47],v12 offset:40960
ds_read_b64_tr_b16 a[158:159],v13 offset:40960
ds_read_b64_tr_b16 a[48:49],v12 offset:49152
ds_read_b64_tr_b16 a[160:161],v13 offset:49152
ds_read_b64_tr_b16 a[50:51],v12 offset:53248
ds_read_b64_tr_b16 a[162:163],v13 offset:53248
s_waitcnt lgkmcnt(4)
ds_read_b64_tr_b16 a[52:53],v12 offset:57344
ds_read_b64_tr_b16 a[164:165],v13 offset:57344
ds_read_b64_tr_b16 a[54:55],v12 offset:61440
ds_read_b64_tr_b16 a[166:167],v13 offset:61440
ds_read_b64_tr_b16 a[100:101],v12 offset:16384
ds_read_b64_tr_b16 a[212:213],v13 offset:16384
ds_read_b64_tr_b16 a[102:103],v12 offset:45056
ds_read_b64_tr_b16 a[214:215],v13 offset:45056
s_waitcnt lgkmcnt(4)
v_xor_b32 v12,0x10000,v12
v_xor_b32 v13,0x10000,v13
s_waitcnt lgkmcnt(0)
s_barrier
s_add_u32 s64,s76,1572864
s_add_u32 m0,s77,65536
s_nop 0
buffer_load_dwordx4 v8,s[32:35],s64 offen nt lds
s_add_u32 s64,s76,1581056
s_add_u32 m0,s77,66560
s_nop 0
buffer_load_dwordx4 v9,s[32:35],s64 offen nt lds
s_add_u32 s64,s76,1589248
s_add_u32 m0,s77,67584
s_nop 0
buffer_load_dwordx4 v8,s[32:35],s64 offen nt lds
s_add_u32 s64,s76,1597440
s_add_u32 m0,s77,68608
s_nop 0
buffer_load_dwordx4 v9,s[32:35],s64 offen nt lds
s_add_u32 s64,s76,1605632
s_add_u32 m0,s77,69632
s_nop 0
buffer_load_dwordx4 v8,s[32:35],s64 offen nt lds
s_add_u32 s64,s76,1613824
s_add_u32 m0,s77,70656
s_nop 0
buffer_load_dwordx4 v9,s[32:35],s64 offen nt lds
s_add_u32 s64,s76,1622016
s_add_u32 m0,s77,71680
s_nop 0
buffer_load_dwordx4 v8,s[32:35],s64 offen nt lds
s_add_u32 s64,s76,1630208
s_add_u32 m0,s77,72704
s_nop 0
buffer_load_dwordx4 v9,s[32:35],s64 offen nt lds
s_waitcnt vmcnt(8)
s_barrier
ds_read_b64_tr_b16 a[56:57],v12 offset:0
ds_read_b64_tr_b16 a[168:169],v13 offset:0
ds_read_b64_tr_b16 a[58:59],v12 offset:4096
ds_read_b64_tr_b16 a[170:171],v13 offset:4096
ds_read_b64_tr_b16 a[60:61],v12 offset:12288
ds_read_b64_tr_b16 a[172:173],v13 offset:12288
ds_read_b64_tr_b16 a[62:63],v12 offset:16384
ds_read_b64_tr_b16 a[174:175],v13 offset:16384
s_waitcnt lgkmcnt(4)
ds_read_b64_tr_b16 a[64:65],v12 offset:20480
ds_read_b64_tr_b16 a[176:177],v13 offset:20480
ds_read_b64_tr_b16 a[66:67],v12 offset:24576
ds_read_b64_tr_b16 a[178:179],v13 offset:24576
ds_read_b64_tr_b16 a[68:69],v12 offset:28672
ds_read_b64_tr_b16 a[180:181],v13 offset:28672
ds_read_b64_tr_b16 a[70:71],v12 offset:32768
ds_read_b64_tr_b16 a[182:183],v13 offset:32768
s_waitcnt lgkmcnt(4)
ds_read_b64_tr_b16 a[72:73],v12 offset:40960
ds_read_b64_tr_b16 a[184:185],v13 offset:40960
ds_read_b64_tr_b16 a[74:75],v12 offset:45056
ds_read_b64_tr_b16 a[186:187],v13 offset:45056
ds_read_b64_tr_b16 a[76:77],v12 offset:49152
ds_read_b64_tr_b16 a[188:189],v13 offset:49152
ds_read_b64_tr_b16 a[78:79],v12 offset:53248
ds_read_b64_tr_b16 a[190:191],v13 offset:53248
s_waitcnt lgkmcnt(4)
ds_read_b64_tr_b16 a[80:81],v12 offset:57344
ds_read_b64_tr_b16 a[192:193],v13 offset:57344
ds_read_b64_tr_b16 a[82:83],v12 offset:61440
ds_read_b64_tr_b16 a[194:195],v13 offset:61440
ds_read_b64_tr_b16 a[104:105],v12 offset:8192
ds_read_b64_tr_b16 a[216:217],v13 offset:8192
ds_read_b64_tr_b16 a[106:107],v12 offset:36864
ds_read_b64_tr_b16 a[218:219],v13 offset:36864
s_waitcnt lgkmcnt(4)
v_xor_b32 v12,0x10000,v12
v_xor_b32 v13,0x10000,v13
s_waitcnt lgkmcnt(0)
s_barrier
s_waitcnt vmcnt(0)
s_barrier
ds_read_b64_tr_b16 a[84:85],v12 offset:4096
ds_read_b64_tr_b16 a[196:197],v13 offset:4096
ds_read_b64_tr_b16 a[86:87],v12 offset:8192
ds_read_b64_tr_b16 a[198:199],v13 offset:8192
ds_read_b64_tr_b16 a[88:89],v12 offset:12288
ds_read_b64_tr_b16 a[200:201],v13 offset:12288
ds_read_b64_tr_b16 a[90:91],v12 offset:16384
ds_read_b64_tr_b16 a[202:203],v13 offset:16384
s_waitcnt lgkmcnt(4)
ds_read_b64_tr_b16 a[92:93],v12 offset:20480
ds_read_b64_tr_b16 a[204:205],v13 offset:20480
ds_read_b64_tr_b16 a[94:95],v12 offset:24576
ds_read_b64_tr_b16 a[206:207],v13 offset:24576
ds_read_b64_tr_b16 a[108:109],v12 offset:0
ds_read_b64_tr_b16 a[220:221],v13 offset:0
ds_read_b64_tr_b16 a[110:111],v12 offset:28672
ds_read_b64_tr_b16 a[222:223],v13 offset:28672
s_waitcnt lgkmcnt(4)
v_xor_b32 v12,0x10000,v12
v_xor_b32 v13,0x10000,v13
s_waitcnt lgkmcnt(0)
s_barrier
v_and_b32 v21,1,v1
v_mul_u32_u24 v21,960,v21
s_mov_b32 s65,21052032
s_mov_b32 s66,1792
pl_323:
buffer_load_dword v22,v21,s[20:23],s65 offen sc1
s_waitcnt vmcnt(0)
v_cmp_gt_u32 vcc,s66,v22
s_cbranch_vccz pok_324
s_sleep 1
s_sub_u32 s90,s90,1
s_cmp_gt_i32 s90,0
s_cbranch_scc1 pl_323
pok_324:
s_lshr_b32 s43,s41,1
s_and_b32 s48,s41,1
s_lshl_b32 s64,s42,7
s_lshl_b32 s65,s50,5
s_add_u32 s64,s64,s65
s_lshl_b32 s65,s48,4
s_add_u32 s64,s64,s65
v_lshl_add_u32 v5,v4,2,s64
v_lshlrev_b32 v6,2,v5
s_mov_b32 s64,20480
buffer_load_dwordx4 v[52:55],v6,s[20:23],s64 offen sc1
v_lshlrev_b32 v10,1,v5
v_and_b32 v6,3,v1
v_sub_u32 v5,v6,v4
v_lshl_add_u32 v5,v5,3,v10
v_lshrrev_b32 v11,2,v1
v_lshl_add_u32 v40,v6,4,v11
v_lshlrev_b32 v40,2,v40
v_lshl_add_u32 v41,v3,2,v4
v_lshlrev_b32 v41,2,v41
s_lshl_b32 s64,s43,10
v_add_u32 v17,s64,v16
v_xor_b32 v18,1024,v17
s_xor_b32 s64,s64,1024
s_lshr_b32 s65,s50,1
s_and_b32 s66,s50,1
s_lshl_b32 s66,s66,12
s_add_u32 s66,s66,s64
s_lshl_b32 s72,s65,13
s_add_u32 s72,s72,s66
s_add_u32 s72,s72,0x10000
s_lshl_b32 s65,s65,14
s_add_u32 s75,s65,s66
s_add_u32 s75,s75,1327104
s_mul_i32 s64,s41,114688
s_add_u32 s75,s75,s64
s_cmp_lt_u32 s50,2
s_cselect_b32 s86,98304,0x40000000
s_lshl_b32 s76,s79,21
s_add_u32 s76,s76,27262976
s_mov_b32 s77,0
s_lshl_b32 s78,s79,16
s_mov_b32 s49,0
s_cmp_eq_u32 s79,0
s_mov_b32 s66,8577024
s_cselect_b32 s66,18874368,s66
s_lshl_b32 s64,s59,14
s_lshl_b32 s65,s50,12
s_add_u32 s65,s65,s66
s_add_u32 s64,s64,s65
v_add_u32 v26,s64,v16
s_lshl_b32 s64,s42,14
s_add_u32 s64,s64,s65
v_add_u32 v25,s64,v16
s_xor_b32 s33,s41,1
s_xor_b32 s34,s41,2
s_xor_b32 s35,s41,3
s_lshl_b32 s33,s33,17
s_lshl_b32 s34,s34,17
s_lshl_b32 s35,s35,17
v_and_b32 v21,7,v1
v_lshlrev_b32 v21,7,v21
v_bfe_u32 v6,v1,3,2
v_lshl_add_u32 v21,v6,2,v21
s_lshl_b32 s74,s41,10
s_add_u32 s74,s74,s63
s_lshl_b32 s64,s60,4
s_add_u32 s74,s74,s64
s_add_u32 s74,s74,20480
s_lshl_b32 s64,s43,4
v_add_u32 v6,s64,v11
v_lshl_add_u32 v19,v6,11,v5
v_add_u32 v6,s64,v11
v_add_u32 v6,30,v6
v_lshl_add_u32 v9,v6,7,v5
v_and_b32 v9,2047,v9
v_and_b32 v7,3,v6
v_lshl_add_u32 v7,v7,11,v9
v_bfe_u32 v8,v6,2,3
v_lshl_add_u32 v7,v8,14,v7
v_mov_b32 v8,0x2000
v_mov_b32 v9,2097152
v_cmp_gt_u32 vcc,32,v6
s_nop 1
v_cndmask_b32 v8,v9,v8,vcc
v_add_u32 v7,v7,v8
v_add_u32 v7,1048576,v7
v_xor_b32 v20,s62,v7
s_lshl_b32 s64,s42,14
s_lshl_b32 s65,s50,11
s_add_u32 s64,s64,s65
s_lshl_b32 s65,s43,10
s_add_u32 s64,s64,s65
s_lshl_b32 s65,s48,3
s_add_u32 s64,s64,s65
s_add_u32 s64,s64,1179648
v_add_u32 v24,s64,v16
s_mov_b32 s84,0xffffff00
s_or_b32 s64,s43,s79
s_cselect_b32 s84,-1,s84
s_mov_b32 s85,-1
s_mov_b32 s48,1
s_waitcnt vmcnt(0)
s_cmp_lg_u32 s56,0
s_cbranch_scc1 kslow_325
s_add_u32 s64,s79,0
s_lshl_b32 s70,s64,21
s_lshl_b32 s64,s64,13
s_and_b32 s64,s64,0x2000
s_xor_b32 s64,s64,s62
s_add_u32 s70,s70,s64
s_add_u32 s70,s70,29360128
s_mov_b32 s83,1
s_mov_b32 s87,s74
s_cmp_eq_u32 s50,0
s_cselect_b32 s74,s74,0x7fff0000
v_mov_b32 v47,132096
s_lshl_b32 s64,s50,3
s_add_u32 s64,s64,132096
v_mov_b32 v46,s64
v_mov_b32 v29,0
s_mov_b32 s97,0x7fff0000
s_mov_b32 s69,1
s_mov_b32 s68,0
s_mov_b32 s52,0x30003
s_mov_b32 s53,s52
seg_327:
s_cmp_eq_u32 s83,0
s_cbranch_scc1 ahead_328
s_add_u32 s94,s70,s75
s_xor_b32 s95,s94,1024
s_xor_b32 s91,s72,0x10000
s_cmp_eq_u32 s69,0
s_mov_b32 s69,1
s_cbranch_scc1 half2_332
s_waitcnt vmcnt(1)
v_cmp_gt_u32 vcc,s71,v29
s_cbranch_vccz nb_331
s_cmp_lg_u32 s50,0
s_cbranch_scc1 nb_331
buffer_load_dword v32,v21,s[20:23],s74 offen sc1
s_sleep 2
pl_333:
buffer_load_dword v33,v21,s[20:23],s74 offen sc1
s_waitcnt vmcnt(1)
v_cmp_gt_u32 vcc,s71,v32
v_mov_b32 v29,v32
s_cbranch_vccz pok_334
buffer_load_dword v32,v21,s[20:23],s74 offen sc1
s_waitcnt vmcnt(1)
v_cmp_gt_u32 vcc,s71,v33
v_mov_b32 v29,v33
s_cbranch_vccz pok_334
s_sub_u32 s90,s90,1
s_cmp_gt_i32 s90,0
s_cbranch_scc1 pl_333
pok_334:
nb_331:
s_cmp_eq_u32 s71,64
s_barrier
s_cbranch_scc1 half_335
s_xor_b32 m0,s91,0
s_add_u32 s65,s94,0
buffer_load_dwordx4 v16,s[20:23],s65 offen offset:0 sc1 lds
buffer_load_dwordx4 v16,s[20:23],s65 offen offset:2048 sc1 lds
s_xor_b32 m0,s91,16384
s_add_u32 s65,s94,32768
buffer_load_dwordx4 v16,s[20:23],s65 offen offset:0 sc1 lds
buffer_load_dwordx4 v16,s[20:23],s65 offen offset:2048 sc1 lds
s_xor_b32 m0,s91,32768
s_add_u32 s65,s94,65536
buffer_load_dwordx4 v16,s[20:23],s65 offen offset:0 sc1 lds
buffer_load_dwordx4 v16,s[20:23],s65 offen offset:2048 sc1 lds
s_xor_b32 m0,s91,49152
s_add_u32 s65,s94,s86
buffer_load_dwordx4 v16,s[20:23],s65 offen offset:0 sc1 lds
buffer_load_dwordx4 v16,s[20:23],s65 offen offset:2048 sc1 lds
s_waitcnt vmcnt(6)
s_barrier
ds_read_b128 v[224:227],v18 offset:0
ds_read_b128 v[228:231],v18 offset:2048
ds_read_b128 v[232:235],v18 offset:4096
ds_read_b128 v[236:239],v18 offset:6144
ds_read_b128 v[240:243],v18 offset:8192
ds_read_b128 v[244:247],v18 offset:10240
ds_read_b128 v[248:251],v18 offset:12288
s_waitcnt lgkmcnt(5)
v_mfma_f32_16x16x32_bf16 v[64:67],a[0:3],v[224:227],0
s_xor_b32 m0,s91,1024
s_add_u32 s96,s71,1
s_add_u32 s92,s71,2
v_min_u32 v27,v224,v228
v_mfma_f32_16x16x32_bf16 v[68:71],a[112:115],v[224:227],0
ds_read_b128 v[252:255],v18 offset:14336
s_cmp_eq_u32 s96,64
s_cselect_b32 s96,99,s96
v_mfma_f32_16x16x32_bf16 v[64:67],a[4:7],v[228:231],v[64:67]
s_add_u32 s65,s95,0
s_cmp_eq_u32 s92,64
s_cselect_b32 s92,99,s92
v_mfma_f32_16x16x32_bf16 v[68:71],a[116:119],v[228:231],v[68:71]
s_waitcnt vmcnt(4)
s_barrier
ds_read_b128 v[224:227],v18 offset:16384
s_waitcnt lgkmcnt(5)
v_mfma_f32_16x16x32_bf16 v[64:67],a[8:11],v[232:235],v[64:67]
buffer_load_dwordx4 v16,s[20:23],s65 offen offset:0 sc1 lds
v_mfma_f32_16x16x32_bf16 v[68:71],a[120:123],v[232:235],v[68:71]
ds_read_b128 v[228:231],v18 offset:18432
v_min3_u32 v27,v27,v232,v236
v_mfma_f32_16x16x32_bf16 v[64:67],a[12:15],v[236:239],v[64:67]
buffer_load_dwordx4 v16,s[20:23],s65 offen offset:2048 sc1 lds
v_mfma_f32_16x16x32_bf16 v[68:71],a[124:127],v[236:239],v[68:71]
ds_read_b128 v[232:235],v18 offset:20480
s_waitcnt lgkmcnt(5)
v_mfma_f32_16x16x32_bf16 v[64:67],a[16:19],v[240:243],v[64:67]
s_xor_b32 m0,s91,17408
v_min3_u32 v27,v27,v240,v244
v_mfma_f32_16x16x32_bf16 v[68:71],a[128:131],v[240:243],v[68:71]
ds_read_b128 v[236:239],v18 offset:22528
v_mfma_f32_16x16x32_bf16 v[64:67],a[20:23],v[244:247],v[64:67]
s_add_u32 s65,s95,32768
s_waitcnt vmcnt(63)
v_mfma_f32_16x16x32_bf16 v[68:71],a[132:135],v[244:247],v[68:71]
ds_read_b128 v[240:243],v18 offset:24576
s_waitcnt lgkmcnt(5)
v_mfma_f32_16x16x32_bf16 v[64:67],a[24:27],v[248:251],v[64:67]
buffer_load_dwordx4 v16,s[20:23],s65 offen offset:0 sc1 lds
v_min3_u32 v27,v27,v248,v252
v_mfma_f32_16x16x32_bf16 v[68:71],a[136:139],v[248:251],v[68:71]
ds_read_b128 v[244:247],v18 offset:26624
v_cmp_gt_u32 vcc,s96,v29
v_cmp_gt_u32 s[92:93],s92,v29
v_mfma_f32_16x16x32_bf16 v[64:67],a[28:31],v[252:255],v[64:67]
buffer_load_dwordx4 v16,s[20:23],s65 offen offset:2048 sc1 lds
v_mfma_f32_16x16x32_bf16 v[68:71],a[140:143],v[252:255],v[68:71]
ds_read_b128 v[248:251],v18 offset:28672
s_waitcnt lgkmcnt(5)
v_mfma_f32_16x16x32_bf16 v[64:67],a[32:35],v[224:227],v[64:67]
s_xor_b32 m0,s91,33792
v_mov_b32 v44,vcc_lo
v_mov_b32 v45,s92
v_mfma_f32_16x16x32_bf16 v[68:71],a[144:147],v[224:227],v[68:71]
ds_read_b128 v[252:255],v18 offset:30720
ds_write_b64 v46,v[44:45]
v_mfma_f32_16x16x32_bf16 v[64:67],a[36:39],v[228:231],v[64:67]
s_add_u32 s65,s95,65536
v_min3_u32 v27,v27,v224,v228
v_mfma_f32_16x16x32_bf16 v[68:71],a[148:151],v[228:231],v[68:71]
s_waitcnt vmcnt(4)
s_barrier
ds_read_b128 v[224:227],v18 offset:32768
s_waitcnt lgkmcnt(6)
v_mfma_f32_16x16x32_bf16 v[64:67],a[40:43],v[232:235],v[64:67]
buffer_load_dwordx4 v16,s[20:23],s65 offen offset:0 sc1 lds
s_add_u32 s88,s70,s75
v_mfma_f32_16x16x32_bf16 v[68:71],a[152:155],v[232:235],v[68:71]
ds_read_b128 v[228:231],v18 offset:34816
v_min3_u32 v27,v27,v232,v236
s_add_u32 s88,s88,2097152
v_mfma_f32_16x16x32_bf16 v[64:67],a[44:47],v[236:239],v[64:67]
buffer_load_dwordx4 v16,s[20:23],s65 offen offset:2048 sc1 lds
v_mfma_f32_16x16x32_bf16 v[68:71],a[156:159],v[236:239],v[68:71]
ds_read_b128 v[232:235],v18 offset:36864
s_waitcnt lgkmcnt(6)
v_mfma_f32_16x16x32_bf16 v[64:67],a[48:51],v[240:243],v[64:67]
s_xor_b32 m0,s91,50176
v_min3_u32 v27,v27,v240,v244
v_mfma_f32_16x16x32_bf16 v[68:71],a[160:163],v[240:243],v[68:71]
ds_read_b128 v[236:239],v18 offset:38912
s_xor_b32 s88,s88,0x2000
v_mfma_f32_16x16x32_bf16 v[64:67],a[52:55],v[244:247],v[64:67]
s_add_u32 s65,s95,s86
s_xor_b32 s89,s88,1024
v_mfma_f32_16x16x32_bf16 v[68:71],a[164:167],v[244:247],v[68:71]
ds_read_b128 v[240:243],v18 offset:40960
s_waitcnt lgkmcnt(6)
v_mfma_f32_16x16x32_bf16 v[64:67],a[56:59],v[248:251],v[64:67]
buffer_load_dwordx4 v16,s[20:23],s65 offen offset:0 sc1 lds
v_mfma_f32_16x16x32_bf16 v[68:71],a[168:171],v[248:251],v[68:71]
ds_read_b128 v[244:247],v18 offset:43008
v_min3_u32 v27,v27,v248,v252
v_mfma_f32_16x16x32_bf16 v[64:67],a[60:63],v[252:255],v[64:67]
buffer_load_dwordx4 v16,s[20:23],s65 offen offset:2048 sc1 lds
v_mfma_f32_16x16x32_bf16 v[68:71],a[172:175],v[252:255],v[68:71]
ds_read_b128 v[248:251],v18 offset:45056
s_waitcnt lgkmcnt(5)
v_mfma_f32_16x16x32_bf16 v[64:67],a[64:67],v[224:227],v[64:67]
s_waitcnt vmcnt(4)
s_barrier
ds_read_b64 v[44:45],v47
ds_read_b128 v[128:131],v17 offset:0
ds_read_b128 v[132:135],v17 offset:2048
v_mfma_f32_16x16x32_bf16 v[68:71],a[176:179],v[224:227],v[68:71]
ds_read_b128 v[252:255],v18 offset:47104
v_min3_u32 v27,v27,v224,v228
v_mfma_f32_16x16x32_bf16 v[64:67],a[68:71],v[228:231],v[64:67]
ds_read_b128 v[136:139],v17 offset:4096
buffer_load_dwordx2 v[120:121],v20,s[20:23],s76 offen sc1
v_mfma_f32_16x16x32_bf16 v[68:71],a[180:183],v[228:231],v[68:71]
ds_read_b128 v[224:227],v18 offset:49152
s_waitcnt lgkmcnt(9)
v_mfma_f32_16x16x32_bf16 v[64:67],a[72:75],v[232:235],v[64:67]
ds_read_b128 v[140:143],v17 offset:6144
v_min3_u32 v27,v27,v232,v236
v_mfma_f32_16x16x32_bf16 v[68:71],a[184:187],v[232:235],v[68:71]
ds_read_b128 v[228:231],v18 offset:51200
buffer_load_dwordx2 v[122:123],v24,s[20:23],s70 offen sc1
v_mfma_f32_16x16x32_bf16 v[64:67],a[76:79],v[236:239],v[64:67]
ds_read_b128 v[144:147],v17 offset:8192
ds_read_b128 v[148:151],v17 offset:10240
v_mfma_f32_16x16x32_bf16 v[68:71],a[188:191],v[236:239],v[68:71]
ds_read_b128 v[232:235],v18 offset:53248
s_waitcnt lgkmcnt(12)
v_mfma_f32_16x16x32_bf16 v[64:67],a[80:83],v[240:243],v[64:67]
ds_read_b128 v[152:155],v17 offset:12288
s_waitcnt lgkmcnt(11)
v_min3_u32 v27,v27,v240,v244
v_mfma_f32_16x16x32_bf16 v[68:71],a[192:195],v[240:243],v[68:71]
ds_read_b128 v[236:239],v18 offset:55296
v_readfirstlane_b32 s93,v45
v_mfma_f32_16x16x32_bf16 v[64:67],a[84:87],v[244:247],v[64:67]
ds_read_b128 v[156:159],v17 offset:14336
v_readfirstlane_b32 s83,v44
s_cmp_lg_u32 s83,0
s_cbranch_scc0 keep_337
v_mfma_f32_16x16x32_bf16 v[68:71],a[196:199],v[244:247],v[68:71]
s_waitcnt lgkmcnt(10)
v_mfma_f32_16x16x32_bf16 v[64:67],a[88:91],v[248:251],v[64:67]
ds_read_b128 v[160:163],v17 offset:16384
ds_read_b128 v[164:167],v17 offset:18432
v_mfma_f32_16x16x32_bf16 v[68:71],a[200:203],v[248:251],v[68:71]
v_min3_u32 v27,v27,v248,v252
v_mfma_f32_16x16x32_bf16 v[64:67],a[92:95],v[252:255],v[64:67]
ds_read_b128 v[168:171],v17 offset:20480
v_mfma_f32_16x16x32_bf16 v[68:71],a[204:207],v[252:255],v[68:71]
s_waitcnt lgkmcnt(9)
v_mfma_f32_16x16x32_bf16 v[64:67],a[96:99],v[224:227],v[64:67]
ds_read_b128 v[172:175],v17 offset:22528
v_min3_u32 v27,v27,v224,v228
v_mfma_f32_16x16x32_bf16 v[68:71],a[208:211],v[224:227],v[68:71]
v_min3_u32 v27,v27,v226,v230
v_mfma_f32_16x16x32_bf16 v[64:67],a[100:103],v[228:231],v[64:67]
ds_read_b128 v[176:179],v17 offset:24576
ds_read_b128 v[180:183],v17 offset:26624
v_mfma_f32_16x16x32_bf16 v[68:71],a[212:215],v[228:231],v[68:71]
s_waitcnt lgkmcnt(7)
v_mfma_f32_16x16x32_bf16 v[64:67],a[104:107],v[232:235],v[64:67]
ds_read_b128 v[184:187],v17 offset:28672
v_min3_u32 v27,v27,v232,v236
v_mfma_f32_16x16x32_bf16 v[68:71],a[216:219],v[232:235],v[68:71]
v_min3_u32 v27,v27,v234,v238
v_mfma_f32_16x16x32_bf16 v[64:67],a[108:111],v[236:239],v[64:67]
ds_read_b128 v[188:191],v17 offset:30720
v_mfma_f32_16x16x32_bf16 v[68:71],a[220:223],v[236:239],v[68:71]
v_mfma_f32_16x16x32_bf16 v[72:75],a[112:115],v[128:131],0
v_cmp_eq_u32 vcc,0,v27
s_cbranch_vccnz retry_326
v_mfma_f32_16x16x32_bf16 v[76:79],a[116:119],v[132:135],0
v_min3_u32 v27,v27,v128,v132
v_mfma_f32_16x16x32_bf16 v[72:75],a[120:123],v[136:139],v[72:75]
s_waitcnt vmcnt(2)
s_barrier
ds_read_b128 v[192:195],v17 offset:32768
v_mfma_f32_16x16x32_bf16 v[76:79],a[124:127],v[140:143],v[76:79]
ds_read_b128 v[196:199],v17 offset:34816
s_waitcnt lgkmcnt(10)
v_mfma_f32_16x16x32_bf16 v[72:75],a[128:131],v[144:147],v[72:75]
ds_read_b128 v[200:203],v17 offset:36864
v_min3_u32 v27,v27,v136,v140
s_waitcnt vmcnt(0)
v_mfma_f32_16x16x32_bf16 v[76:79],a[132:135],v[148:151],v[76:79]
ds_read_b128 v[204:207],v17 offset:38912
v_min3_u32 v27,v27,v144,v148
v_and_or_b32 v64,v64,-4,s48
v_mfma_f32_16x16x32_bf16 v[72:75],a[136:139],v[152:155],v[72:75]
ds_read_b128 v[208:211],v17 offset:40960
s_add_u32 s64,s49,s34
v_mfma_f32_16x16x32_bf16 v[76:79],a[140:143],v[156:159],v[76:79]
v_min3_u32 v27,v27,v152,v156
s_waitcnt lgkmcnt(9)
v_mfma_f32_16x16x32_bf16 v[72:75],a[144:147],v[160:163],v[72:75]
ds_read_b128 v[212:215],v17 offset:43008
buffer_store_dwordx4 v[64:67],v25,s[20:23],s64 offen offset:2048
v_mfma_f32_16x16x32_bf16 v[76:79],a[148:151],v[164:167],v[76:79]
ds_read_b128 v[216:219],v17 offset:45056
v_min3_u32 v27,v27,v160,v164
v_and_or_b32 v68,v68,-4,s48
v_mfma_f32_16x16x32_bf16 v[72:75],a[152:155],v[168:171],v[72:75]
ds_read_b128 v[220:223],v17 offset:47104
s_add_u32 s64,s49,s35
v_mfma_f32_16x16x32_bf16 v[76:79],a[156:159],v[172:175],v[76:79]
ds_read_b128 v[224:227],v17 offset:49152
s_waitcnt lgkmcnt(9)
v_mfma_f32_16x16x32_bf16 v[72:75],a[160:163],v[176:179],v[72:75]
ds_read_b128 v[228:231],v17 offset:51200
v_min3_u32 v27,v27,v168,v172
v_mfma_f32_16x16x32_bf16 v[76:79],a[164:167],v[180:183],v[76:79]
v_min3_u32 v27,v27,v176,v180
buffer_store_dwordx4 v[68:71],v25,s[20:23],s64 offen offset:3072
v_mfma_f32_16x16x32_bf16 v[72:75],a[168:171],v[184:187],v[72:75]
ds_read_b128 v[232:235],v17 offset:53248
s_mov_b32 s49,0x7fff0000
v_mfma_f32_16x16x32_bf16 v[76:79],a[172:175],v[188:191],v[76:79]
ds_read_b128 v[236:239],v17 offset:55296
s_waitcnt lgkmcnt(8)
v_mfma_f32_16x16x32_bf16 v[72:75],a[176:179],v[192:195],v[72:75]
v_min3_u32 v27,v27,v184,v188
v_mfma_f32_16x16x32_bf16 v[76:79],a[180:183],v[196:199],v[76:79]
v_min3_u32 v27,v27,v192,v196
ds_bpermute_b32 v124,v41,v120
v_mfma_f32_16x16x32_bf16 v[72:75],a[184:187],v[200:203],v[72:75]
v_mfma_f32_16x16x32_bf16 v[76:79],a[188:191],v[204:207],v[76:79]
v_min3_u32 v27,v27,v200,v204
s_waitcnt lgkmcnt(5)
v_mfma_f32_16x16x32_bf16 v[72:75],a[192:195],v[208:211],v[72:75]
ds_bpermute_b32 v125,v41,v121
v_mfma_f32_16x16x32_bf16 v[76:79],a[196:199],v[212:215],v[76:79]
v_min3_u32 v27,v27,v208,v212
v_lshlrev_b32 v108,16,v122
v_mfma_f32_16x16x32_bf16 v[72:75],a[200:203],v[216:219],v[72:75]
v_mfma_f32_16x16x32_bf16 v[76:79],a[204:207],v[220:223],v[76:79]
v_min3_u32 v27,v27,v216,v220
s_waitcnt lgkmcnt(2)
v_mfma_f32_16x16x32_bf16 v[72:75],a[208:211],v[224:227],v[72:75]
v_and_b32 v109,s80,v122
v_mfma_f32_16x16x32_bf16 v[76:79],a[212:215],v[228:231],v[76:79]
v_min3_u32 v27,v27,v224,v228
v_min3_u32 v27,v27,v226,v230
v_mfma_f32_16x16x32_bf16 v[72:75],a[216:219],v[232:235],v[72:75]
v_lshlrev_b32 v110,16,v123
v_mfma_f32_16x16x32_bf16 v[76:79],a[220:223],v[236:239],v[76:79]
v_min3_u32 v27,v27,v232,v236
v_min3_u32 v27,v27,v234,v238
v_mfma_f32_16x16x32_bf16 v[80:83],a[0:3],v[128:131],0
v_cmp_eq_u32 vcc,0,v27
s_cbranch_vccnz retry_326
v_mfma_f32_16x16x32_bf16 v[84:87],a[4:7],v[132:135],0
v_and_b32 v111,s80,v123
s_waitcnt lgkmcnt(0)
v_mfma_f32_16x16x32_bf16 v[80:83],a[8:11],v[136:139],v[80:83]
v_mfma_f32_16x16x32_bf16 v[84:87],a[12:15],v[140:143],v[84:87]
v_lshlrev_b32 v104,16,v124
v_mfma_f32_16x16x32_bf16 v[80:83],a[16:19],v[144:147],v[80:83]
v_add_f32 v72,v72,v76
v_add_f32 v73,v73,v77
v_mfma_f32_16x16x32_bf16 v[84:87],a[20:23],v[148:151],v[84:87]
v_and_b32 v105,s80,v124
v_add_f32 v74,v74,v78
v_mfma_f32_16x16x32_bf16 v[80:83],a[24:27],v[152:155],v[80:83]
v_add_f32 v75,v75,v79
v_and_or_b32 v72,v72,-4,s48
v_mfma_f32_16x16x32_bf16 v[84:87],a[28:31],v[156:159],v[84:87]
v_lshlrev_b32 v106,16,v125
s_add_u32 s64,s77,s33
v_mfma_f32_16x16x32_bf16 v[80:83],a[32:35],v[160:163],v[80:83]
buffer_store_dwordx4 v[72:75],v25,s[20:23],s64 offen offset:1024
v_mfma_f32_16x16x32_bf16 v[84:87],a[36:39],v[164:167],v[84:87]
v_and_b32 v107,s80,v125
v_mfma_f32_16x16x32_bf16 v[80:83],a[40:43],v[168:171],v[80:83]
v_mfma_f32_16x16x32_bf16 v[84:87],a[44:47],v[172:175],v[84:87]
v_mfma_f32_16x16x32_bf16 v[80:83],a[48:51],v[176:179],v[80:83]
buffer_load_dwordx4 v[96:99],v26,s[20:23],s77 offen offset:2048 sc1
v_mfma_f32_16x16x32_bf16 v[84:87],a[52:55],v[180:183],v[84:87]
buffer_load_dwordx4 v[100:103],v26,s[20:23],s77 offen offset:3072 sc1
v_mfma_f32_16x16x32_bf16 v[80:83],a[56:59],v[184:187],v[80:83]
v_mfma_f32_16x16x32_bf16 v[84:87],a[60:63],v[188:191],v[84:87]
v_mfma_f32_16x16x32_bf16 v[80:83],a[64:67],v[192:195],v[80:83]
v_mfma_f32_16x16x32_bf16 v[84:87],a[68:71],v[196:199],v[84:87]
v_mfma_f32_16x16x32_bf16 v[80:83],a[72:75],v[200:203],v[80:83]
v_mfma_f32_16x16x32_bf16 v[84:87],a[76:79],v[204:207],v[84:87]
v_mfma_f32_16x16x32_bf16 v[80:83],a[80:83],v[208:211],v[80:83]
v_mfma_f32_16x16x32_bf16 v[84:87],a[84:87],v[212:215],v[84:87]
v_mfma_f32_16x16x32_bf16 v[80:83],a[88:91],v[216:219],v[80:83]
buffer_load_dwordx4 v[92:95],v26,s[20:23],s77 offen offset:1024 sc1
v_mfma_f32_16x16x32_bf16 v[84:87],a[92:95],v[220:223],v[84:87]
v_mfma_f32_16x16x32_bf16 v[80:83],a[96:99],v[224:227],v[80:83]
v_mfma_f32_16x16x32_bf16 v[84:87],a[100:103],v[228:231],v[84:87]
v_mfma_f32_16x16x32_bf16 v[80:83],a[104:107],v[232:235],v[80:83]
v_mfma_f32_16x16x32_bf16 v[84:87],a[108:111],v[236:239],v[84:87]
s_branch epi_329
keep_337:
v_mfma_f32_16x16x32_bf16 v[68:71],a[196:199],v[244:247],v[68:71]
s_xor_b32 m0,s72,0
s_add_u32 s65,s88,0
s_waitcnt lgkmcnt(10)
v_mfma_f32_16x16x32_bf16 v[64:67],a[88:91],v[248:251],v[64:67]
ds_read_b128 v[160:163],v17 offset:16384
ds_read_b128 v[164:167],v17 offset:18432
v_min3_u32 v27,v27,v248,v252
v_mfma_f32_16x16x32_bf16 v[68:71],a[200:203],v[248:251],v[68:71]
buffer_load_dwordx4 v16,s[20:23],s65 offen offset:0 sc1 lds
v_mfma_f32_16x16x32_bf16 v[64:67],a[92:95],v[252:255],v[64:67]
ds_read_b128 v[168:171],v17 offset:20480
buffer_load_dwordx4 v16,s[20:23],s65 offen offset:2048 sc1 lds
v_mfma_f32_16x16x32_bf16 v[68:71],a[204:207],v[252:255],v[68:71]
s_xor_b32 m0,s72,16384
s_add_u32 s65,s88,32768
s_waitcnt lgkmcnt(9)
v_mfma_f32_16x16x32_bf16 v[64:67],a[96:99],v[224:227],v[64:67]
ds_read_b128 v[172:175],v17 offset:22528
buffer_load_dwordx4 v16,s[20:23],s65 offen offset:0 sc1 lds
v_min3_u32 v27,v27,v224,v228
v_mfma_f32_16x16x32_bf16 v[68:71],a[208:211],v[224:227],v[68:71]
buffer_load_dwordx4 v16,s[20:23],s65 offen offset:2048 sc1 lds
v_min3_u32 v27,v27,v226,v230
v_mfma_f32_16x16x32_bf16 v[64:67],a[100:103],v[228:231],v[64:67]
ds_read_b128 v[176:179],v17 offset:24576
ds_read_b128 v[180:183],v17 offset:26624
s_xor_b32 m0,s72,32768
v_mfma_f32_16x16x32_bf16 v[68:71],a[212:215],v[228:231],v[68:71]
s_add_u32 s65,s88,65536
s_waitcnt lgkmcnt(7)
v_mfma_f32_16x16x32_bf16 v[64:67],a[104:107],v[232:235],v[64:67]
ds_read_b128 v[184:187],v17 offset:28672
buffer_load_dwordx4 v16,s[20:23],s65 offen offset:0 sc1 lds
v_mfma_f32_16x16x32_bf16 v[68:71],a[216:219],v[232:235],v[68:71]
buffer_load_dwordx4 v16,s[20:23],s65 offen offset:2048 sc1 lds
v_min3_u32 v27,v27,v232,v236
v_mfma_f32_16x16x32_bf16 v[64:67],a[108:111],v[236:239],v[64:67]
ds_read_b128 v[188:191],v17 offset:30720
s_xor_b32 m0,s72,49152
v_min3_u32 v27,v27,v234,v238
v_mfma_f32_16x16x32_bf16 v[68:71],a[220:223],v[236:239],v[68:71]
s_add_u32 s65,s88,s86
v_mfma_f32_16x16x32_bf16 v[72:75],a[112:115],v[128:131],0
buffer_load_dwordx4 v16,s[20:23],s65 offen offset:0 sc1 lds
v_cmp_eq_u32 vcc,0,v27
s_cbranch_vccnz retry_326
v_mfma_f32_16x16x32_bf16 v[76:79],a[116:119],v[132:135],0
buffer_load_dwordx4 v16,s[20:23],s65 offen offset:2048 sc1 lds
v_mfma_f32_16x16x32_bf16 v[72:75],a[120:123],v[136:139],v[72:75]
s_waitcnt vmcnt(10)
s_barrier
ds_read_b128 v[192:195],v17 offset:32768
v_mfma_f32_16x16x32_bf16 v[76:79],a[124:127],v[140:143],v[76:79]
ds_read_b128 v[196:199],v17 offset:34816
s_xor_b32 m0,s72,1024
s_waitcnt lgkmcnt(10)
v_mfma_f32_16x16x32_bf16 v[72:75],a[128:131],v[144:147],v[72:75]
ds_read_b128 v[200:203],v17 offset:36864
s_add_u32 s65,s89,0
s_waitcnt vmcnt(8)
v_and_or_b32 v64,v64,-4,s48
v_mfma_f32_16x16x32_bf16 v[76:79],a[132:135],v[148:151],v[76:79]
ds_read_b128 v[204:207],v17 offset:38912
buffer_load_dwordx4 v16,s[20:23],s65 offen offset:0 sc1 lds
s_add_u32 s64,s49,s34
v_mfma_f32_16x16x32_bf16 v[72:75],a[136:139],v[152:155],v[72:75]
ds_read_b128 v[208:211],v17 offset:40960
buffer_load_dwordx4 v16,s[20:23],s65 offen offset:2048 sc1 lds
v_mfma_f32_16x16x32_bf16 v[76:79],a[140:143],v[156:159],v[76:79]
s_xor_b32 m0,s72,17408
s_add_u32 s65,s89,32768
s_waitcnt lgkmcnt(9)
v_mfma_f32_16x16x32_bf16 v[72:75],a[144:147],v[160:163],v[72:75]
ds_read_b128 v[212:215],v17 offset:43008
buffer_load_dwordx4 v16,s[20:23],s65 offen offset:0 sc1 lds
v_mfma_f32_16x16x32_bf16 v[76:79],a[148:151],v[164:167],v[76:79]
ds_read_b128 v[216:219],v17 offset:45056
buffer_load_dwordx4 v16,s[20:23],s65 offen offset:2048 sc1 lds
v_mfma_f32_16x16x32_bf16 v[72:75],a[152:155],v[168:171],v[72:75]
ds_read_b128 v[220:223],v17 offset:47104
s_xor_b32 m0,s72,33792
buffer_store_dwordx4 v[64:67],v25,s[20:23],s64 offen offset:2048
v_mfma_f32_16x16x32_bf16 v[76:79],a[156:159],v[172:175],v[76:79]
ds_read_b128 v[224:227],v17 offset:49152
v_and_or_b32 v68,v68,-4,s48
s_add_u32 s64,s49,s35
s_waitcnt lgkmcnt(9)
v_mfma_f32_16x16x32_bf16 v[72:75],a[160:163],v[176:179],v[72:75]
ds_read_b128 v[228:231],v17 offset:51200
s_add_u32 s65,s89,65536
buffer_store_dwordx4 v[68:71],v25,s[20:23],s64 offen offset:3072
v_mfma_f32_16x16x32_bf16 v[76:79],a[164:167],v[180:183],v[76:79]
buffer_load_dwordx4 v16,s[20:23],s65 offen offset:0 sc1 lds
s_mov_b32 s49,0x7fff0000
v_mfma_f32_16x16x32_bf16 v[72:75],a[168:171],v[184:187],v[72:75]
ds_read_b128 v[232:235],v17 offset:53248
v_min3_u32 v27,v27,v128,v132
v_mfma_f32_16x16x32_bf16 v[76:79],a[172:175],v[188:191],v[76:79]
ds_read_b128 v[236:239],v17 offset:55296
s_waitcnt lgkmcnt(8)
v_mfma_f32_16x16x32_bf16 v[72:75],a[176:179],v[192:195],v[72:75]
buffer_load_dwordx4 v16,s[20:23],s65 offen offset:2048 sc1 lds
v_mfma_f32_16x16x32_bf16 v[76:79],a[180:183],v[196:199],v[76:79]
s_xor_b32 m0,s72,50176
s_add_u32 s65,s89,s86
v_mfma_f32_16x16x32_bf16 v[72:75],a[184:187],v[200:203],v[72:75]
buffer_load_dwordx4 v16,s[20:23],s65 offen offset:0 sc1 lds
v_mfma_f32_16x16x32_bf16 v[76:79],a[188:191],v[204:207],v[76:79]
v_min3_u32 v27,v27,v136,v140
s_waitcnt lgkmcnt(4)
v_mfma_f32_16x16x32_bf16 v[72:75],a[192:195],v[208:211],v[72:75]
buffer_load_dwordx4 v16,s[20:23],s65 offen offset:2048 sc1 lds
v_mfma_f32_16x16x32_bf16 v[76:79],a[196:199],v[212:215],v[76:79]
v_min3_u32 v27,v27,v144,v148
v_min3_u32 v27,v27,v152,v156
v_mfma_f32_16x16x32_bf16 v[72:75],a[200:203],v[216:219],v[72:75]
v_min3_u32 v27,v27,v160,v164
v_min3_u32 v27,v27,v168,v172
v_mfma_f32_16x16x32_bf16 v[76:79],a[204:207],v[220:223],v[76:79]
v_min3_u32 v27,v27,v176,v180
s_waitcnt lgkmcnt(0)
v_mfma_f32_16x16x32_bf16 v[72:75],a[208:211],v[224:227],v[72:75]
v_min3_u32 v27,v27,v184,v188
v_min3_u32 v27,v27,v192,v196
v_mfma_f32_16x16x32_bf16 v[76:79],a[212:215],v[228:231],v[76:79]
v_min3_u32 v27,v27,v200,v204
v_min3_u32 v27,v27,v208,v212
v_mfma_f32_16x16x32_bf16 v[72:75],a[216:219],v[232:235],v[72:75]
v_min3_u32 v27,v27,v216,v220
v_min3_u32 v27,v27,v224,v228
v_mfma_f32_16x16x32_bf16 v[76:79],a[220:223],v[236:239],v[76:79]
v_min3_u32 v27,v27,v226,v230
v_min3_u32 v27,v27,v232,v236
v_min3_u32 v27,v27,v234,v238
v_mfma_f32_16x16x32_bf16 v[80:83],a[0:3],v[128:131],0
v_cmp_eq_u32 vcc,0,v27
s_cbranch_vccnz retry_326
v_mfma_f32_16x16x32_bf16 v[84:87],a[4:7],v[132:135],0
ds_bpermute_b32 v124,v41,v120
ds_bpermute_b32 v125,v41,v121
v_mfma_f32_16x16x32_bf16 v[80:83],a[8:11],v[136:139],v[80:83]
v_lshlrev_b32 v108,16,v122
v_and_b32 v109,s80,v122
v_mfma_f32_16x16x32_bf16 v[84:87],a[12:15],v[140:143],v[84:87]
v_lshlrev_b32 v110,16,v123
v_and_b32 v111,s80,v123
v_mfma_f32_16x16x32_bf16 v[80:83],a[16:19],v[144:147],v[80:83]
s_waitcnt lgkmcnt(0)
v_lshlrev_b32 v104,16,v124
v_mfma_f32_16x16x32_bf16 v[84:87],a[20:23],v[148:151],v[84:87]
v_and_b32 v105,s80,v124
v_add_f32 v72,v72,v76
v_mfma_f32_16x16x32_bf16 v[80:83],a[24:27],v[152:155],v[80:83]
v_add_f32 v73,v73,v77
v_add_f32 v74,v74,v78
v_mfma_f32_16x16x32_bf16 v[84:87],a[28:31],v[156:159],v[84:87]
v_lshlrev_b32 v106,16,v125
v_add_f32 v75,v75,v79
v_mfma_f32_16x16x32_bf16 v[80:83],a[32:35],v[160:163],v[80:83]
v_and_or_b32 v72,v72,-4,s48
s_add_u32 s64,s77,s33
v_mfma_f32_16x16x32_bf16 v[84:87],a[36:39],v[164:167],v[84:87]
v_and_b32 v107,s80,v125
v_mfma_f32_16x16x32_bf16 v[80:83],a[40:43],v[168:171],v[80:83]
buffer_store_dwordx4 v[72:75],v25,s[20:23],s64 offen offset:1024
v_mfma_f32_16x16x32_bf16 v[84:87],a[44:47],v[172:175],v[84:87]
v_mfma_f32_16x16x32_bf16 v[80:83],a[48:51],v[176:179],v[80:83]
buffer_load_dwordx4 v[96:99],v26,s[20:23],s77 offen offset:2048 sc1
v_mfma_f32_16x16x32_bf16 v[84:87],a[52:55],v[180:183],v[84:87]
buffer_load_dwordx4 v[100:103],v26,s[20:23],s77 offen offset:3072 sc1
v_mfma_f32_16x16x32_bf16 v[80:83],a[56:59],v[184:187],v[80:83]
v_mfma_f32_16x16x32_bf16 v[84:87],a[60:63],v[188:191],v[84:87]
v_mfma_f32_16x16x32_bf16 v[80:83],a[64:67],v[192:195],v[80:83]
v_mfma_f32_16x16x32_bf16 v[84:87],a[68:71],v[196:199],v[84:87]
v_mfma_f32_16x16x32_bf16 v[80:83],a[72:75],v[200:203],v[80:83]
v_mfma_f32_16x16x32_bf16 v[84:87],a[76:79],v[204:207],v[84:87]
v_mfma_f32_16x16x32_bf16 v[80:83],a[80:83],v[208:211],v[80:83]
v_mfma_f32_16x16x32_bf16 v[84:87],a[84:87],v[212:215],v[84:87]
v_mfma_f32_16x16x32_bf16 v[80:83],a[88:91],v[216:219],v[80:83]
buffer_load_dwordx4 v[92:95],v26,s[20:23],s77 offen offset:1024 sc1
v_mfma_f32_16x16x32_bf16 v[84:87],a[92:95],v[220:223],v[84:87]
v_mfma_f32_16x16x32_bf16 v[80:83],a[96:99],v[224:227],v[80:83]
v_mfma_f32_16x16x32_bf16 v[84:87],a[100:103],v[228:231],v[84:87]
v_mfma_f32_16x16x32_bf16 v[80:83],a[104:107],v[232:235],v[80:83]
v_mfma_f32_16x16x32_bf16 v[84:87],a[108:111],v[236:239],v[84:87]
s_branch epi_329
ahead_328:
s_cmp_eq_u32 s93,0
s_cbranch_scc1 both_330
s_waitcnt vmcnt(14) lgkmcnt(0)
s_barrier
ds_read_b128 v[224:227],v18 offset:0
ds_read_b128 v[228:231],v18 offset:2048
ds_read_b128 v[232:235],v18 offset:4096
ds_read_b128 v[236:239],v18 offset:6144
ds_read_b128 v[240:243],v18 offset:8192
ds_read_b128 v[244:247],v18 offset:10240
ds_read_b128 v[248:251],v18 offset:12288
s_waitcnt lgkmcnt(5)
v_mfma_f32_16x16x32_bf16 v[64:67],a[0:3],v[224:227],0
s_add_u32 s96,s71,1
s_add_u32 s92,s71,2
v_mfma_f32_16x16x32_bf16 v[68:71],a[112:115],v[224:227],0
ds_read_b128 v[252:255],v18 offset:14336
v_min_u32 v27,v224,v228
v_mfma_f32_16x16x32_bf16 v[64:67],a[4:7],v[228:231],v[64:67]
s_cmp_eq_u32 s96,64
s_cselect_b32 s96,99,s96
v_mfma_f32_16x16x32_bf16 v[68:71],a[116:119],v[228:231],v[68:71]
ds_read_b128 v[224:227],v18 offset:16384
s_waitcnt lgkmcnt(5)
v_mfma_f32_16x16x32_bf16 v[64:67],a[8:11],v[232:235],v[64:67]
s_cmp_eq_u32 s92,64
s_cselect_b32 s92,99,s92
v_mfma_f32_16x16x32_bf16 v[68:71],a[120:123],v[232:235],v[68:71]
ds_read_b128 v[228:231],v18 offset:18432
v_min3_u32 v27,v27,v232,v236
v_mfma_f32_16x16x32_bf16 v[64:67],a[12:15],v[236:239],v[64:67]
buffer_load_dwordx2 v[120:121],v20,s[20:23],s76 offen sc1
v_mfma_f32_16x16x32_bf16 v[68:71],a[124:127],v[236:239],v[68:71]
ds_read_b128 v[232:235],v18 offset:20480
s_waitcnt lgkmcnt(5)
v_mfma_f32_16x16x32_bf16 v[64:67],a[16:19],v[240:243],v[64:67]
v_min3_u32 v27,v27,v240,v244
v_mfma_f32_16x16x32_bf16 v[68:71],a[128:131],v[240:243],v[68:71]
ds_read_b128 v[236:239],v18 offset:22528
v_mfma_f32_16x16x32_bf16 v[64:67],a[20:23],v[244:247],v[64:67]
s_waitcnt vmcnt(2)
v_mfma_f32_16x16x32_bf16 v[68:71],a[132:135],v[244:247],v[68:71]
ds_read_b128 v[240:243],v18 offset:24576
s_waitcnt lgkmcnt(5)
v_mfma_f32_16x16x32_bf16 v[64:67],a[24:27],v[248:251],v[64:67]
v_cmp_gt_u32 vcc,s96,v29
v_cmp_gt_u32 s[92:93],s92,v29
v_mfma_f32_16x16x32_bf16 v[68:71],a[136:139],v[248:251],v[68:71]
ds_read_b128 v[244:247],v18 offset:26624
v_min3_u32 v27,v27,v248,v252
v_mfma_f32_16x16x32_bf16 v[64:67],a[28:31],v[252:255],v[64:67]
v_mov_b32 v44,vcc_lo
v_mov_b32 v45,s92
v_mfma_f32_16x16x32_bf16 v[68:71],a[140:143],v[252:255],v[68:71]
ds_read_b128 v[248:251],v18 offset:28672
s_waitcnt lgkmcnt(5)
v_mfma_f32_16x16x32_bf16 v[64:67],a[32:35],v[224:227],v[64:67]
ds_write_b64 v46,v[44:45]
v_min3_u32 v27,v27,v224,v228
v_mfma_f32_16x16x32_bf16 v[68:71],a[144:147],v[224:227],v[68:71]
ds_read_b128 v[252:255],v18 offset:30720
v_mfma_f32_16x16x32_bf16 v[64:67],a[36:39],v[228:231],v[64:67]
buffer_load_dwordx2 v[122:123],v24,s[20:23],s70 offen sc1
v_mfma_f32_16x16x32_bf16 v[68:71],a[148:151],v[228:231],v[68:71]
ds_read_b128 v[224:227],v18 offset:32768
s_waitcnt lgkmcnt(6)
v_mfma_f32_16x16x32_bf16 v[64:67],a[40:43],v[232:235],v[64:67]
v_min3_u32 v27,v27,v232,v236
s_add_u32 s88,s70,s75
v_mfma_f32_16x16x32_bf16 v[68:71],a[152:155],v[232:235],v[68:71]
ds_read_b128 v[228:231],v18 offset:34816
s_add_u32 s88,s88,2097152
v_mfma_f32_16x16x32_bf16 v[64:67],a[44:47],v[236:239],v[64:67]
s_xor_b32 s88,s88,0x2000
s_xor_b32 s89,s88,1024
v_mfma_f32_16x16x32_bf16 v[68:71],a[156:159],v[236:239],v[68:71]
ds_read_b128 v[232:235],v18 offset:36864
s_waitcnt lgkmcnt(6)
v_mfma_f32_16x16x32_bf16 v[64:67],a[48:51],v[240:243],v[64:67]
v_min3_u32 v27,v27,v240,v244
v_mfma_f32_16x16x32_bf16 v[68:71],a[160:163],v[240:243],v[68:71]
ds_read_b128 v[236:239],v18 offset:38912
v_mfma_f32_16x16x32_bf16 v[64:67],a[52:55],v[244:247],v[64:67]
v_mfma_f32_16x16x32_bf16 v[68:71],a[164:167],v[244:247],v[68:71]
ds_read_b128 v[240:243],v18 offset:40960
s_waitcnt lgkmcnt(5)
v_mfma_f32_16x16x32_bf16 v[64:67],a[56:59],v[248:251],v[64:67]
v_min3_u32 v27,v27,v248,v252
v_mfma_f32_16x16x32_bf16 v[68:71],a[168:171],v[248:251],v[68:71]
ds_read_b128 v[244:247],v18 offset:43008
v_mfma_f32_16x16x32_bf16 v[64:67],a[60:63],v[252:255],v[64:67]
v_mfma_f32_16x16x32_bf16 v[68:71],a[172:175],v[252:255],v[68:71]
ds_read_b128 v[248:251],v18 offset:45056
s_waitcnt lgkmcnt(5)
v_mfma_f32_16x16x32_bf16 v[64:67],a[64:67],v[224:227],v[64:67]
s_waitcnt vmcnt(8)
s_barrier
ds_read_b64 v[44:45],v47
ds_read_b128 v[128:131],v17 offset:0
ds_read_b128 v[132:135],v17 offset:2048
v_mfma_f32_16x16x32_bf16 v[68:71],a[176:179],v[224:227],v[68:71]
ds_read_b128 v[252:255],v18 offset:47104
v_min3_u32 v27,v27,v224,v228
v_mfma_f32_16x16x32_bf16 v[64:67],a[68:71],v[228:231],v[64:67]
ds_read_b128 v[136:139],v17 offset:4096
v_mfma_f32_16x16x32_bf16 v[68:71],a[180:183],v[228:231],v[68:71]
ds_read_b128 v[224:227],v18 offset:49152
s_waitcnt lgkmcnt(9)
v_mfma_f32_16x16x32_bf16 v[64:67],a[72:75],v[232:235],v[64:67]
ds_read_b128 v[140:143],v17 offset:6144
v_min3_u32 v27,v27,v232,v236
v_mfma_f32_16x16x32_bf16 v[68:71],a[184:187],v[232:235],v[68:71]
ds_read_b128 v[228:231],v18 offset:51200
v_mfma_f32_16x16x32_bf16 v[64:67],a[76:79],v[236:239],v[64:67]
ds_read_b128 v[144:147],v17 offset:8192
ds_read_b128 v[148:151],v17 offset:10240
v_mfma_f32_16x16x32_bf16 v[68:71],a[188:191],v[236:239],v[68:71]
ds_read_b128 v[232:235],v18 offset:53248
s_waitcnt lgkmcnt(12)
v_mfma_f32_16x16x32_bf16 v[64:67],a[80:83],v[240:243],v[64:67]
ds_read_b128 v[152:155],v17 offset:12288
s_waitcnt lgkmcnt(11)
v_min3_u32 v27,v27,v240,v244
v_mfma_f32_16x16x32_bf16 v[68:71],a[192:195],v[240:243],v[68:71]
ds_read_b128 v[236:239],v18 offset:55296
v_readfirstlane_b32 s93,v45
v_mfma_f32_16x16x32_bf16 v[64:67],a[84:87],v[244:247],v[64:67]
ds_read_b128 v[156:159],v17 offset:14336
v_readfirstlane_b32 s83,v44
s_cmp_lg_u32 s83,0
s_cbranch_scc1 keep_338
v_mfma_f32_16x16x32_bf16 v[68:71],a[196:199],v[244:247],v[68:71]
s_xor_b32 m0,s72,0
s_add_u32 s65,s88,0
s_waitcnt lgkmcnt(10)
v_mfma_f32_16x16x32_bf16 v[64:67],a[88:91],v[248:251],v[64:67]
ds_read_b128 v[160:163],v17 offset:16384
ds_read_b128 v[164:167],v17 offset:18432
v_min3_u32 v27,v27,v248,v252
v_mfma_f32_16x16x32_bf16 v[68:71],a[200:203],v[248:251],v[68:71]
buffer_load_dwordx4 v16,s[20:23],s65 offen offset:0 sc1 lds
v_mfma_f32_16x16x32_bf16 v[64:67],a[92:95],v[252:255],v[64:67]
ds_read_b128 v[168:171],v17 offset:20480
buffer_load_dwordx4 v16,s[20:23],s65 offen offset:2048 sc1 lds
v_mfma_f32_16x16x32_bf16 v[68:71],a[204:207],v[252:255],v[68:71]
s_xor_b32 m0,s72,16384
s_add_u32 s65,s88,32768
s_waitcnt lgkmcnt(9)
v_mfma_f32_16x16x32_bf16 v[64:67],a[96:99],v[224:227],v[64:67]
ds_read_b128 v[172:175],v17 offset:22528
buffer_load_dwordx4 v16,s[20:23],s65 offen offset:0 sc1 lds
v_min3_u32 v27,v27,v224,v228
v_mfma_f32_16x16x32_bf16 v[68:71],a[208:211],v[224:227],v[68:71]
buffer_load_dwordx4 v16,s[20:23],s65 offen offset:2048 sc1 lds
v_min3_u32 v27,v27,v226,v230
v_mfma_f32_16x16x32_bf16 v[64:67],a[100:103],v[228:231],v[64:67]
ds_read_b128 v[176:179],v17 offset:24576
ds_read_b128 v[180:183],v17 offset:26624
s_xor_b32 m0,s72,32768
v_mfma_f32_16x16x32_bf16 v[68:71],a[212:215],v[228:231],v[68:71]
s_add_u32 s65,s88,65536
s_waitcnt lgkmcnt(7)
v_mfma_f32_16x16x32_bf16 v[64:67],a[104:107],v[232:235],v[64:67]
ds_read_b128 v[184:187],v17 offset:28672
buffer_load_dwordx4 v16,s[20:23],s65 offen offset:0 sc1 lds
v_mfma_f32_16x16x32_bf16 v[68:71],a[216:219],v[232:235],v[68:71]
buffer_load_dwordx4 v16,s[20:23],s65 offen offset:2048 sc1 lds
v_min3_u32 v27,v27,v232,v236
v_mfma_f32_16x16x32_bf16 v[64:67],a[108:111],v[236:239],v[64:67]
ds_read_b128 v[188:191],v17 offset:30720
s_xor_b32 m0,s72,49152
v_min3_u32 v27,v27,v234,v238
v_mfma_f32_16x16x32_bf16 v[68:71],a[220:223],v[236:239],v[68:71]
s_add_u32 s65,s88,s86
v_mfma_f32_16x16x32_bf16 v[72:75],a[112:115],v[128:131],0
buffer_load_dwordx4 v16,s[20:23],s65 offen offset:0 sc1 lds
v_cmp_eq_u32 vcc,0,v27
s_cbranch_vccnz retry_326
v_mfma_f32_16x16x32_bf16 v[76:79],a[116:119],v[132:135],0
buffer_load_dwordx4 v16,s[20:23],s65 offen offset:2048 sc1 lds
v_mfma_f32_16x16x32_bf16 v[72:75],a[120:123],v[136:139],v[72:75]
ds_read_b128 v[192:195],v17 offset:32768
s_xor_b32 m0,s72,1024
v_mfma_f32_16x16x32_bf16 v[76:79],a[124:127],v[140:143],v[76:79]
ds_read_b128 v[196:199],v17 offset:34816
s_add_u32 s65,s89,0
s_waitcnt lgkmcnt(10)
v_mfma_f32_16x16x32_bf16 v[72:75],a[128:131],v[144:147],v[72:75]
ds_read_b128 v[200:203],v17 offset:36864
buffer_load_dwordx4 v16,s[20:23],s65 offen offset:0 sc1 lds
s_waitcnt vmcnt(9)
v_mfma_f32_16x16x32_bf16 v[76:79],a[132:135],v[148:151],v[76:79]
ds_read_b128 v[204:207],v17 offset:38912
buffer_load_dwordx4 v16,s[20:23],s65 offen offset:2048 sc1 lds
v_and_or_b32 v64,v64,-4,s48
v_mfma_f32_16x16x32_bf16 v[72:75],a[136:139],v[152:155],v[72:75]
ds_read_b128 v[208:211],v17 offset:40960
s_xor_b32 m0,s72,17408
s_add_u32 s64,s49,s34
v_mfma_f32_16x16x32_bf16 v[76:79],a[140:143],v[156:159],v[76:79]
s_add_u32 s65,s89,32768
buffer_store_dwordx4 v[64:67],v25,s[20:23],s64 offen offset:2048
s_waitcnt lgkmcnt(9)
v_mfma_f32_16x16x32_bf16 v[72:75],a[144:147],v[160:163],v[72:75]
ds_read_b128 v[212:215],v17 offset:43008
buffer_load_dwordx4 v16,s[20:23],s65 offen offset:0 sc1 lds
v_and_or_b32 v68,v68,-4,s48
v_mfma_f32_16x16x32_bf16 v[76:79],a[148:151],v[164:167],v[76:79]
ds_read_b128 v[216:219],v17 offset:45056
buffer_load_dwordx4 v16,s[20:23],s65 offen offset:2048 sc1 lds
s_add_u32 s64,s49,s35
v_mfma_f32_16x16x32_bf16 v[72:75],a[152:155],v[168:171],v[72:75]
ds_read_b128 v[220:223],v17 offset:47104
s_xor_b32 m0,s72,33792
buffer_store_dwordx4 v[68:71],v25,s[20:23],s64 offen offset:3072
v_mfma_f32_16x16x32_bf16 v[76:79],a[156:159],v[172:175],v[76:79]
ds_read_b128 v[224:227],v17 offset:49152
s_mov_b32 s49,0x7fff0000
s_waitcnt lgkmcnt(9)
v_mfma_f32_16x16x32_bf16 v[72:75],a[160:163],v[176:179],v[72:75]
ds_read_b128 v[228:231],v17 offset:51200
s_add_u32 s65,s89,65536
v_mfma_f32_16x16x32_bf16 v[76:79],a[164:167],v[180:183],v[76:79]
buffer_load_dwordx4 v16,s[20:23],s65 offen offset:0 sc1 lds
v_mfma_f32_16x16x32_bf16 v[72:75],a[168:171],v[184:187],v[72:75]
ds_read_b128 v[232:235],v17 offset:53248
v_min3_u32 v27,v27,v128,v132
v_mfma_f32_16x16x32_bf16 v[76:79],a[172:175],v[188:191],v[76:79]
ds_read_b128 v[236:239],v17 offset:55296
s_waitcnt lgkmcnt(8)
v_mfma_f32_16x16x32_bf16 v[72:75],a[176:179],v[192:195],v[72:75]
buffer_load_dwordx4 v16,s[20:23],s65 offen offset:2048 sc1 lds
v_mfma_f32_16x16x32_bf16 v[76:79],a[180:183],v[196:199],v[76:79]
s_xor_b32 m0,s72,50176
s_add_u32 s65,s89,s86
v_mfma_f32_16x16x32_bf16 v[72:75],a[184:187],v[200:203],v[72:75]
buffer_load_dwordx4 v16,s[20:23],s65 offen offset:0 sc1 lds
v_mfma_f32_16x16x32_bf16 v[76:79],a[188:191],v[204:207],v[76:79]
v_min3_u32 v27,v27,v136,v140
s_waitcnt lgkmcnt(4)
v_mfma_f32_16x16x32_bf16 v[72:75],a[192:195],v[208:211],v[72:75]
buffer_load_dwordx4 v16,s[20:23],s65 offen offset:2048 sc1 lds
v_mfma_f32_16x16x32_bf16 v[76:79],a[196:199],v[212:215],v[76:79]
v_min3_u32 v27,v27,v144,v148
v_min3_u32 v27,v27,v152,v156
v_mfma_f32_16x16x32_bf16 v[72:75],a[200:203],v[216:219],v[72:75]
v_min3_u32 v27,v27,v160,v164
v_min3_u32 v27,v27,v168,v172
v_mfma_f32_16x16x32_bf16 v[76:79],a[204:207],v[220:223],v[76:79]
v_min3_u32 v27,v27,v176,v180
s_waitcnt lgkmcnt(0)
v_mfma_f32_16x16x32_bf16 v[72:75],a[208:211],v[224:227],v[72:75]
v_min3_u32 v27,v27,v184,v188
v_min3_u32 v27,v27,v192,v196
v_mfma_f32_16x16x32_bf16 v[76:79],a[212:215],v[228:231],v[76:79]
v_min3_u32 v27,v27,v200,v204
v_min3_u32 v27,v27,v208,v212
v_mfma_f32_16x16x32_bf16 v[72:75],a[216:219],v[232:235],v[72:75]
v_min3_u32 v27,v27,v216,v220
v_min3_u32 v27,v27,v224,v228
v_mfma_f32_16x16x32_bf16 v[76:79],a[220:223],v[236:239],v[76:79]
v_min3_u32 v27,v27,v226,v230
v_min3_u32 v27,v27,v232,v236
v_min3_u32 v27,v27,v234,v238
v_mfma_f32_16x16x32_bf16 v[80:83],a[0:3],v[128:131],0
v_cmp_eq_u32 vcc,0,v27
s_cbranch_vccnz retry_326
v_mfma_f32_16x16x32_bf16 v[84:87],a[4:7],v[132:135],0
ds_bpermute_b32 v124,v41,v120
ds_bpermute_b32 v125,v41,v121
v_mfma_f32_16x16x32_bf16 v[80:83],a[8:11],v[136:139],v[80:83]
v_lshlrev_b32 v108,16,v122
v_and_b32 v109,s80,v122
v_mfma_f32_16x16x32_bf16 v[84:87],a[12:15],v[140:143],v[84:87]
v_lshlrev_b32 v110,16,v123
v_and_b32 v111,s80,v123
v_mfma_f32_16x16x32_bf16 v[80:83],a[16:19],v[144:147],v[80:83]
s_waitcnt lgkmcnt(0)
v_lshlrev_b32 v104,16,v124
v_mfma_f32_16x16x32_bf16 v[84:87],a[20:23],v[148:151],v[84:87]
v_and_b32 v105,s80,v124
v_add_f32 v72,v72,v76
v_mfma_f32_16x16x32_bf16 v[80:83],a[24:27],v[152:155],v[80:83]
v_add_f32 v73,v73,v77
v_add_f32 v74,v74,v78
v_mfma_f32_16x16x32_bf16 v[84:87],a[28:31],v[156:159],v[84:87]
v_lshlrev_b32 v106,16,v125
v_add_f32 v75,v75,v79
v_mfma_f32_16x16x32_bf16 v[80:83],a[32:35],v[160:163],v[80:83]
v_and_or_b32 v72,v72,-4,s48
s_add_u32 s64,s77,s33
v_mfma_f32_16x16x32_bf16 v[84:87],a[36:39],v[164:167],v[84:87]
v_and_b32 v107,s80,v125
v_mfma_f32_16x16x32_bf16 v[80:83],a[40:43],v[168:171],v[80:83]
buffer_store_dwordx4 v[72:75],v25,s[20:23],s64 offen offset:1024
v_mfma_f32_16x16x32_bf16 v[84:87],a[44:47],v[172:175],v[84:87]
v_mfma_f32_16x16x32_bf16 v[80:83],a[48:51],v[176:179],v[80:83]
buffer_load_dwordx4 v[96:99],v26,s[20:23],s77 offen offset:2048 sc1
v_mfma_f32_16x16x32_bf16 v[84:87],a[52:55],v[180:183],v[84:87]
buffer_load_dwordx4 v[100:103],v26,s[20:23],s77 offen offset:3072 sc1
v_mfma_f32_16x16x32_bf16 v[80:83],a[56:59],v[184:187],v[80:83]
v_mfma_f32_16x16x32_bf16 v[84:87],a[60:63],v[188:191],v[84:87]
v_mfma_f32_16x16x32_bf16 v[80:83],a[64:67],v[192:195],v[80:83]
v_mfma_f32_16x16x32_bf16 v[84:87],a[68:71],v[196:199],v[84:87]
v_mfma_f32_16x16x32_bf16 v[80:83],a[72:75],v[200:203],v[80:83]
v_mfma_f32_16x16x32_bf16 v[84:87],a[76:79],v[204:207],v[84:87]
v_mfma_f32_16x16x32_bf16 v[80:83],a[80:83],v[208:211],v[80:83]
v_mfma_f32_16x16x32_bf16 v[84:87],a[84:87],v[212:215],v[84:87]
v_mfma_f32_16x16x32_bf16 v[80:83],a[88:91],v[216:219],v[80:83]
buffer_load_dwordx4 v[92:95],v26,s[20:23],s77 offen offset:1024 sc1
v_mfma_f32_16x16x32_bf16 v[84:87],a[92:95],v[220:223],v[84:87]
v_mfma_f32_16x16x32_bf16 v[80:83],a[96:99],v[224:227],v[80:83]
v_mfma_f32_16x16x32_bf16 v[84:87],a[100:103],v[228:231],v[84:87]
v_mfma_f32_16x16x32_bf16 v[80:83],a[104:107],v[232:235],v[80:83]
v_mfma_f32_16x16x32_bf16 v[84:87],a[108:111],v[236:239],v[84:87]
s_branch epi_329
keep_338:
v_mfma_f32_16x16x32_bf16 v[68:71],a[196:199],v[244:247],v[68:71]
s_waitcnt lgkmcnt(10)
v_mfma_f32_16x16x32_bf16 v[64:67],a[88:91],v[248:251],v[64:67]
ds_read_b128 v[160:163],v17 offset:16384
ds_read_b128 v[164:167],v17 offset:18432
v_mfma_f32_16x16x32_bf16 v[68:71],a[200:203],v[248:251],v[68:71]
v_min3_u32 v27,v27,v248,v252
v_mfma_f32_16x16x32_bf16 v[64:67],a[92:95],v[252:255],v[64:67]
ds_read_b128 v[168:171],v17 offset:20480
v_mfma_f32_16x16x32_bf16 v[68:71],a[204:207],v[252:255],v[68:71]
s_waitcnt lgkmcnt(9)
v_mfma_f32_16x16x32_bf16 v[64:67],a[96:99],v[224:227],v[64:67]
ds_read_b128 v[172:175],v17 offset:22528
v_min3_u32 v27,v27,v224,v228
v_mfma_f32_16x16x32_bf16 v[68:71],a[208:211],v[224:227],v[68:71]
v_min3_u32 v27,v27,v226,v230
v_mfma_f32_16x16x32_bf16 v[64:67],a[100:103],v[228:231],v[64:67]
ds_read_b128 v[176:179],v17 offset:24576
ds_read_b128 v[180:183],v17 offset:26624
v_mfma_f32_16x16x32_bf16 v[68:71],a[212:215],v[228:231],v[68:71]
s_waitcnt lgkmcnt(7)
v_mfma_f32_16x16x32_bf16 v[64:67],a[104:107],v[232:235],v[64:67]
ds_read_b128 v[184:187],v17 offset:28672
v_min3_u32 v27,v27,v232,v236
v_mfma_f32_16x16x32_bf16 v[68:71],a[216:219],v[232:235],v[68:71]
v_min3_u32 v27,v27,v234,v238
v_mfma_f32_16x16x32_bf16 v[64:67],a[108:111],v[236:239],v[64:67]
ds_read_b128 v[188:191],v17 offset:30720
v_mfma_f32_16x16x32_bf16 v[68:71],a[220:223],v[236:239],v[68:71]
v_mfma_f32_16x16x32_bf16 v[72:75],a[112:115],v[128:131],0
v_cmp_eq_u32 vcc,0,v27
s_cbranch_vccnz retry_326
v_mfma_f32_16x16x32_bf16 v[76:79],a[116:119],v[132:135],0
v_min3_u32 v27,v27,v128,v132
v_mfma_f32_16x16x32_bf16 v[72:75],a[120:123],v[136:139],v[72:75]
ds_read_b128 v[192:195],v17 offset:32768
v_mfma_f32_16x16x32_bf16 v[76:79],a[124:127],v[140:143],v[76:79]
ds_read_b128 v[196:199],v17 offset:34816
s_waitcnt lgkmcnt(10)
v_mfma_f32_16x16x32_bf16 v[72:75],a[128:131],v[144:147],v[72:75]
ds_read_b128 v[200:203],v17 offset:36864
v_min3_u32 v27,v27,v136,v140
s_waitcnt vmcnt(0)
v_mfma_f32_16x16x32_bf16 v[76:79],a[132:135],v[148:151],v[76:79]
ds_read_b128 v[204:207],v17 offset:38912
v_min3_u32 v27,v27,v144,v148
v_and_or_b32 v64,v64,-4,s48
v_mfma_f32_16x16x32_bf16 v[72:75],a[136:139],v[152:155],v[72:75]
ds_read_b128 v[208:211],v17 offset:40960
s_add_u32 s64,s49,s34
v_mfma_f32_16x16x32_bf16 v[76:79],a[140:143],v[156:159],v[76:79]
v_min3_u32 v27,v27,v152,v156
s_waitcnt lgkmcnt(9)
v_mfma_f32_16x16x32_bf16 v[72:75],a[144:147],v[160:163],v[72:75]
ds_read_b128 v[212:215],v17 offset:43008
buffer_store_dwordx4 v[64:67],v25,s[20:23],s64 offen offset:2048
v_mfma_f32_16x16x32_bf16 v[76:79],a[148:151],v[164:167],v[76:79]
ds_read_b128 v[216:219],v17 offset:45056
v_min3_u32 v27,v27,v160,v164
v_and_or_b32 v68,v68,-4,s48
v_mfma_f32_16x16x32_bf16 v[72:75],a[152:155],v[168:171],v[72:75]
ds_read_b128 v[220:223],v17 offset:47104
s_add_u32 s64,s49,s35
v_mfma_f32_16x16x32_bf16 v[76:79],a[156:159],v[172:175],v[76:79]
ds_read_b128 v[224:227],v17 offset:49152
s_waitcnt lgkmcnt(9)
v_mfma_f32_16x16x32_bf16 v[72:75],a[160:163],v[176:179],v[72:75]
ds_read_b128 v[228:231],v17 offset:51200
v_min3_u32 v27,v27,v168,v172
v_mfma_f32_16x16x32_bf16 v[76:79],a[164:167],v[180:183],v[76:79]
v_min3_u32 v27,v27,v176,v180
buffer_store_dwordx4 v[68:71],v25,s[20:23],s64 offen offset:3072
v_mfma_f32_16x16x32_bf16 v[72:75],a[168:171],v[184:187],v[72:75]
ds_read_b128 v[232:235],v17 offset:53248
s_mov_b32 s49,0x7fff0000
v_mfma_f32_16x16x32_bf16 v[76:79],a[172:175],v[188:191],v[76:79]
ds_read_b128 v[236:239],v17 offset:55296
s_waitcnt lgkmcnt(8)
v_mfma_f32_16x16x32_bf16 v[72:75],a[176:179],v[192:195],v[72:75]
v_min3_u32 v27,v27,v184,v188
v_mfma_f32_16x16x32_bf16 v[76:79],a[180:183],v[196:199],v[76:79]
v_min3_u32 v27,v27,v192,v196
ds_bpermute_b32 v124,v41,v120
v_mfma_f32_16x16x32_bf16 v[72:75],a[184:187],v[200:203],v[72:75]
v_mfma_f32_16x16x32_bf16 v[76:79],a[188:191],v[204:207],v[76:79]
v_min3_u32 v27,v27,v200,v204
s_waitcnt lgkmcnt(5)
v_mfma_f32_16x16x32_bf16 v[72:75],a[192:195],v[208:211],v[72:75]
ds_bpermute_b32 v125,v41,v121
v_mfma_f32_16x16x32_bf16 v[76:79],a[196:199],v[212:215],v[76:79]
v_min3_u32 v27,v27,v208,v212
v_lshlrev_b32 v108,16,v122
v_mfma_f32_16x16x32_bf16 v[72:75],a[200:203],v[216:219],v[72:75]
v_mfma_f32_16x16x32_bf16 v[76:79],a[204:207],v[220:223],v[76:79]
v_min3_u32 v27,v27,v216,v220
s_waitcnt lgkmcnt(2)
v_mfma_f32_16x16x32_bf16 v[72:75],a[208:211],v[224:227],v[72:75]
v_and_b32 v109,s80,v122
v_mfma_f32_16x16x32_bf16 v[76:79],a[212:215],v[228:231],v[76:79]
v_min3_u32 v27,v27,v224,v228
v_min3_u32 v27,v27,v226,v230
v_mfma_f32_16x16x32_bf16 v[72:75],a[216:219],v[232:235],v[72:75]
v_lshlrev_b32 v110,16,v123
v_mfma_f32_16x16x32_bf16 v[76:79],a[220:223],v[236:239],v[76:79]
v_min3_u32 v27,v27,v232,v236
v_min3_u32 v27,v27,v234,v238
v_mfma_f32_16x16x32_bf16 v[80:83],a[0:3],v[128:131],0
v_cmp_eq_u32 vcc,0,v27
s_cbranch_vccnz retry_326
v_mfma_f32_16x16x32_bf16 v[84:87],a[4:7],v[132:135],0
v_and_b32 v111,s80,v123
s_waitcnt lgkmcnt(0)
v_mfma_f32_16x16x32_bf16 v[80:83],a[8:11],v[136:139],v[80:83]
v_mfma_f32_16x16x32_bf16 v[84:87],a[12:15],v[140:143],v[84:87]
v_lshlrev_b32 v104,16,v124
v_mfma_f32_16x16x32_bf16 v[80:83],a[16:19],v[144:147],v[80:83]
v_add_f32 v72,v72,v76
v_add_f32 v73,v73,v77
v_mfma_f32_16x16x32_bf16 v[84:87],a[20:23],v[148:151],v[84:87]
v_and_b32 v105,s80,v124
v_add_f32 v74,v74,v78
v_mfma_f32_16x16x32_bf16 v[80:83],a[24:27],v[152:155],v[80:83]
v_add_f32 v75,v75,v79
v_and_or_b32 v72,v72,-4,s48
v_mfma_f32_16x16x32_bf16 v[84:87],a[28:31],v[156:159],v[84:87]
v_lshlrev_b32 v106,16,v125
s_add_u32 s64,s77,s33
v_mfma_f32_16x16x32_bf16 v[80:83],a[32:35],v[160:163],v[80:83]
buffer_store_dwordx4 v[72:75],v25,s[20:23],s64 offen offset:1024
v_mfma_f32_16x16x32_bf16 v[84:87],a[36:39],v[164:167],v[84:87]
v_and_b32 v107,s80,v125
v_mfma_f32_16x16x32_bf16 v[80:83],a[40:43],v[168:171],v[80:83]
v_mfma_f32_16x16x32_bf16 v[84:87],a[44:47],v[172:175],v[84:87]
v_mfma_f32_16x16x32_bf16 v[80:83],a[48:51],v[176:179],v[80:83]
buffer_load_dwordx4 v[96:99],v26,s[20:23],s77 offen offset:2048 sc1
v_mfma_f32_16x16x32_bf16 v[84:87],a[52:55],v[180:183],v[84:87]
buffer_load_dwordx4 v[100:103],v26,s[20:23],s77 offen offset:3072 sc1
v_mfma_f32_16x16x32_bf16 v[80:83],a[56:59],v[184:187],v[80:83]
v_mfma_f32_16x16x32_bf16 v[84:87],a[60:63],v[188:191],v[84:87]
v_mfma_f32_16x16x32_bf16 v[80:83],a[64:67],v[192:195],v[80:83]
v_mfma_f32_16x16x32_bf16 v[84:87],a[68:71],v[196:199],v[84:87]
v_mfma_f32_16x16x32_bf16 v[80:83],a[72:75],v[200:203],v[80:83]
v_mfma_f32_16x16x32_bf16 v[84:87],a[76:79],v[204:207],v[84:87]
v_mfma_f32_16x16x32_bf16 v[80:83],a[80:83],v[208:211],v[80:83]
v_mfma_f32_16x16x32_bf16 v[84:87],a[84:87],v[212:215],v[84:87]
v_mfma_f32_16x16x32_bf16 v[80:83],a[88:91],v[216:219],v[80:83]
buffer_load_dwordx4 v[92:95],v26,s[20:23],s77 offen offset:1024 sc1
v_mfma_f32_16x16x32_bf16 v[84:87],a[92:95],v[220:223],v[84:87]
v_mfma_f32_16x16x32_bf16 v[80:83],a[96:99],v[224:227],v[80:83]
v_mfma_f32_16x16x32_bf16 v[84:87],a[100:103],v[228:231],v[84:87]
v_mfma_f32_16x16x32_bf16 v[80:83],a[104:107],v[232:235],v[80:83]
v_mfma_f32_16x16x32_bf16 v[84:87],a[108:111],v[236:239],v[84:87]
s_branch epi_329
both_330:
s_waitcnt vmcnt(14) lgkmcnt(0)
s_barrier
ds_read_b128 v[224:227],v18 offset:0
ds_read_b128 v[228:231],v18 offset:2048
ds_read_b128 v[232:235],v18 offset:4096
ds_read_b128 v[236:239],v18 offset:6144
ds_read_b128 v[240:243],v18 offset:8192
ds_read_b128 v[244:247],v18 offset:10240
ds_read_b128 v[248:251],v18 offset:12288
s_waitcnt lgkmcnt(5)
v_mfma_f32_16x16x32_bf16 v[64:67],a[0:3],v[224:227],0
s_add_u32 s96,s71,1
s_add_u32 s92,s71,2
s_add_u32 s88,s70,s75
v_mfma_f32_16x16x32_bf16 v[68:71],a[112:115],v[224:227],0
ds_read_b128 v[252:255],v18 offset:14336
s_add_u32 s88,s88,2097152
s_xor_b32 s88,s88,0x2000
v_mfma_f32_16x16x32_bf16 v[64:67],a[4:7],v[228:231],v[64:67]
s_cmp_eq_u32 s96,64
s_cselect_b32 s96,99,s96
v_min_u32 v27,v224,v228
v_mfma_f32_16x16x32_bf16 v[68:71],a[116:119],v[228:231],v[68:71]
ds_read_b128 v[224:227],v18 offset:16384
s_waitcnt lgkmcnt(5)
v_mfma_f32_16x16x32_bf16 v[64:67],a[8:11],v[232:235],v[64:67]
s_cmp_eq_u32 s92,64
s_cselect_b32 s92,99,s92
v_mfma_f32_16x16x32_bf16 v[68:71],a[120:123],v[232:235],v[68:71]
ds_read_b128 v[228:231],v18 offset:18432
s_xor_b32 s89,s88,1024
v_mfma_f32_16x16x32_bf16 v[64:67],a[12:15],v[236:239],v[64:67]
s_xor_b32 m0,s72,0
v_min3_u32 v27,v27,v232,v236
v_mfma_f32_16x16x32_bf16 v[68:71],a[124:127],v[236:239],v[68:71]
ds_read_b128 v[232:235],v18 offset:20480
s_add_u32 s65,s88,0
s_waitcnt lgkmcnt(5)
v_mfma_f32_16x16x32_bf16 v[64:67],a[16:19],v[240:243],v[64:67]
v_min3_u32 v27,v27,v240,v244
buffer_load_dwordx2 v[120:121],v20,s[20:23],s76 offen sc1
v_mfma_f32_16x16x32_bf16 v[68:71],a[128:131],v[240:243],v[68:71]
ds_read_b128 v[236:239],v18 offset:22528
buffer_load_dwordx4 v16,s[20:23],s65 offen offset:0 sc1 lds
v_mfma_f32_16x16x32_bf16 v[64:67],a[20:23],v[244:247],v[64:67]
s_waitcnt vmcnt(3)
v_mfma_f32_16x16x32_bf16 v[68:71],a[132:135],v[244:247],v[68:71]
ds_read_b128 v[240:243],v18 offset:24576
s_waitcnt lgkmcnt(5)
v_mfma_f32_16x16x32_bf16 v[64:67],a[24:27],v[248:251],v[64:67]
v_cmp_gt_u32 vcc,s96,v29
v_cmp_gt_u32 s[92:93],s92,v29
v_min3_u32 v27,v27,v248,v252
v_mfma_f32_16x16x32_bf16 v[68:71],a[136:139],v[248:251],v[68:71]
ds_read_b128 v[244:247],v18 offset:26624
buffer_load_dwordx4 v16,s[20:23],s65 offen offset:2048 sc1 lds
v_mfma_f32_16x16x32_bf16 v[64:67],a[28:31],v[252:255],v[64:67]
v_mov_b32 v44,vcc_lo
v_mov_b32 v45,s92
s_xor_b32 m0,s72,16384
v_mfma_f32_16x16x32_bf16 v[68:71],a[140:143],v[252:255],v[68:71]
ds_read_b128 v[248:251],v18 offset:28672
s_add_u32 s65,s88,32768
s_waitcnt lgkmcnt(5)
v_mfma_f32_16x16x32_bf16 v[64:67],a[32:35],v[224:227],v[64:67]
ds_write_b64 v46,v[44:45]
v_min3_u32 v27,v27,v224,v228
v_mfma_f32_16x16x32_bf16 v[68:71],a[144:147],v[224:227],v[68:71]
ds_read_b128 v[252:255],v18 offset:30720
buffer_load_dwordx4 v16,s[20:23],s65 offen offset:0 sc1 lds
v_mfma_f32_16x16x32_bf16 v[64:67],a[36:39],v[228:231],v[64:67]
buffer_load_dwordx4 v16,s[20:23],s65 offen offset:2048 sc1 lds
v_mfma_f32_16x16x32_bf16 v[68:71],a[148:151],v[228:231],v[68:71]
ds_read_b128 v[224:227],v18 offset:32768
s_waitcnt lgkmcnt(6)
v_mfma_f32_16x16x32_bf16 v[64:67],a[40:43],v[232:235],v[64:67]
s_xor_b32 m0,s72,32768
v_min3_u32 v27,v27,v232,v236
v_mfma_f32_16x16x32_bf16 v[68:71],a[152:155],v[232:235],v[68:71]
ds_read_b128 v[228:231],v18 offset:34816
v_mfma_f32_16x16x32_bf16 v[64:67],a[44:47],v[236:239],v[64:67]
s_add_u32 s65,s88,65536
v_mfma_f32_16x16x32_bf16 v[68:71],a[156:159],v[236:239],v[68:71]
ds_read_b128 v[232:235],v18 offset:36864
s_waitcnt lgkmcnt(6)
v_mfma_f32_16x16x32_bf16 v[64:67],a[48:51],v[240:243],v[64:67]
buffer_load_dwordx4 v16,s[20:23],s65 offen offset:0 sc1 lds
v_mfma_f32_16x16x32_bf16 v[68:71],a[160:163],v[240:243],v[68:71]
ds_read_b128 v[236:239],v18 offset:38912
v_min3_u32 v27,v27,v240,v244
v_mfma_f32_16x16x32_bf16 v[64:67],a[52:55],v[244:247],v[64:67]
buffer_load_dwordx4 v16,s[20:23],s65 offen offset:2048 sc1 lds
v_mfma_f32_16x16x32_bf16 v[68:71],a[164:167],v[244:247],v[68:71]
ds_read_b128 v[240:243],v18 offset:40960
s_waitcnt lgkmcnt(5)
v_mfma_f32_16x16x32_bf16 v[64:67],a[56:59],v[248:251],v[64:67]
s_xor_b32 m0,s72,49152
v_min3_u32 v27,v27,v248,v252
v_mfma_f32_16x16x32_bf16 v[68:71],a[168:171],v[248:251],v[68:71]
ds_read_b128 v[244:247],v18 offset:43008
s_add_u32 s65,s88,s86
v_mfma_f32_16x16x32_bf16 v[64:67],a[60:63],v[252:255],v[64:67]
buffer_load_dwordx2 v[122:123],v24,s[20:23],s70 offen sc1
v_mfma_f32_16x16x32_bf16 v[68:71],a[172:175],v[252:255],v[68:71]
ds_read_b128 v[248:251],v18 offset:45056
s_waitcnt lgkmcnt(5)
v_mfma_f32_16x16x32_bf16 v[64:67],a[64:67],v[224:227],v[64:67]
s_waitcnt vmcnt(14)
s_barrier
ds_read_b64 v[44:45],v47
ds_read_b128 v[128:131],v17 offset:0
ds_read_b128 v[132:135],v17 offset:2048
v_mfma_f32_16x16x32_bf16 v[68:71],a[176:179],v[224:227],v[68:71]
ds_read_b128 v[252:255],v18 offset:47104
buffer_load_dwordx4 v16,s[20:23],s65 offen offset:0 sc1 lds
v_min3_u32 v27,v27,v224,v228
v_mfma_f32_16x16x32_bf16 v[64:67],a[68:71],v[228:231],v[64:67]
ds_read_b128 v[136:139],v17 offset:4096
buffer_load_dwordx4 v16,s[20:23],s65 offen offset:2048 sc1 lds
v_mfma_f32_16x16x32_bf16 v[68:71],a[180:183],v[228:231],v[68:71]
ds_read_b128 v[224:227],v18 offset:49152
s_xor_b32 m0,s72,1024
s_waitcnt lgkmcnt(9)
v_mfma_f32_16x16x32_bf16 v[64:67],a[72:75],v[232:235],v[64:67]
ds_read_b128 v[140:143],v17 offset:6144
v_min3_u32 v27,v27,v232,v236
v_mfma_f32_16x16x32_bf16 v[68:71],a[184:187],v[232:235],v[68:71]
ds_read_b128 v[228:231],v18 offset:51200
s_add_u32 s65,s89,0
v_mfma_f32_16x16x32_bf16 v[64:67],a[76:79],v[236:239],v[64:67]
ds_read_b128 v[144:147],v17 offset:8192
ds_read_b128 v[148:151],v17 offset:10240
v_mfma_f32_16x16x32_bf16 v[68:71],a[188:191],v[236:239],v[68:71]
ds_read_b128 v[232:235],v18 offset:53248
s_waitcnt lgkmcnt(12)
v_mfma_f32_16x16x32_bf16 v[64:67],a[80:83],v[240:243],v[64:67]
ds_read_b128 v[152:155],v17 offset:12288
s_waitcnt lgkmcnt(11)
v_min3_u32 v27,v27,v240,v244
v_mfma_f32_16x16x32_bf16 v[68:71],a[192:195],v[240:243],v[68:71]
ds_read_b128 v[236:239],v18 offset:55296
v_readfirstlane_b32 s93,v45
v_mfma_f32_16x16x32_bf16 v[64:67],a[84:87],v[244:247],v[64:67]
ds_read_b128 v[156:159],v17 offset:14336
buffer_load_dwordx4 v16,s[20:23],s65 offen offset:0 sc1 lds
v_mfma_f32_16x16x32_bf16 v[68:71],a[196:199],v[244:247],v[68:71]
buffer_load_dwordx4 v16,s[20:23],s65 offen offset:2048 sc1 lds
s_waitcnt lgkmcnt(10)
v_mfma_f32_16x16x32_bf16 v[64:67],a[88:91],v[248:251],v[64:67]
ds_read_b128 v[160:163],v17 offset:16384
ds_read_b128 v[164:167],v17 offset:18432
s_xor_b32 m0,s72,17408
v_mfma_f32_16x16x32_bf16 v[68:71],a[200:203],v[248:251],v[68:71]
s_add_u32 s65,s89,32768
v_min3_u32 v27,v27,v248,v252
v_mfma_f32_16x16x32_bf16 v[64:67],a[92:95],v[252:255],v[64:67]
ds_read_b128 v[168:171],v17 offset:20480
buffer_load_dwordx4 v16,s[20:23],s65 offen offset:0 sc1 lds
v_mfma_f32_16x16x32_bf16 v[68:71],a[204:207],v[252:255],v[68:71]
s_waitcnt lgkmcnt(9)
v_mfma_f32_16x16x32_bf16 v[64:67],a[96:99],v[224:227],v[64:67]
ds_read_b128 v[172:175],v17 offset:22528
buffer_load_dwordx4 v16,s[20:23],s65 offen offset:2048 sc1 lds
v_mfma_f32_16x16x32_bf16 v[68:71],a[208:211],v[224:227],v[68:71]
v_min3_u32 v27,v27,v224,v228
v_min3_u32 v27,v27,v226,v230
v_mfma_f32_16x16x32_bf16 v[64:67],a[100:103],v[228:231],v[64:67]
ds_read_b128 v[176:179],v17 offset:24576
ds_read_b128 v[180:183],v17 offset:26624
s_xor_b32 m0,s72,33792
v_mfma_f32_16x16x32_bf16 v[68:71],a[212:215],v[228:231],v[68:71]
s_waitcnt lgkmcnt(7)
v_mfma_f32_16x16x32_bf16 v[64:67],a[104:107],v[232:235],v[64:67]
ds_read_b128 v[184:187],v17 offset:28672
s_add_u32 s65,s89,65536
v_min3_u32 v27,v27,v232,v236
v_mfma_f32_16x16x32_bf16 v[68:71],a[216:219],v[232:235],v[68:71]
buffer_load_dwordx4 v16,s[20:23],s65 offen offset:0 sc1 lds
v_mfma_f32_16x16x32_bf16 v[64:67],a[108:111],v[236:239],v[64:67]
ds_read_b128 v[188:191],v17 offset:30720
v_min3_u32 v27,v27,v234,v238
v_mfma_f32_16x16x32_bf16 v[68:71],a[220:223],v[236:239],v[68:71]
buffer_load_dwordx4 v16,s[20:23],s65 offen offset:2048 sc1 lds
v_mfma_f32_16x16x32_bf16 v[72:75],a[112:115],v[128:131],0
v_cmp_eq_u32 vcc,0,v27
s_cbranch_vccnz retry_326
v_mfma_f32_16x16x32_bf16 v[76:79],a[116:119],v[132:135],0
s_xor_b32 m0,s72,50176
v_min3_u32 v27,v27,v128,v132
v_mfma_f32_16x16x32_bf16 v[72:75],a[120:123],v[136:139],v[72:75]
ds_read_b128 v[192:195],v17 offset:32768
v_mfma_f32_16x16x32_bf16 v[76:79],a[124:127],v[140:143],v[76:79]
ds_read_b128 v[196:199],v17 offset:34816
s_add_u32 s65,s89,s86
s_waitcnt lgkmcnt(10)
v_mfma_f32_16x16x32_bf16 v[72:75],a[128:131],v[144:147],v[72:75]
ds_read_b128 v[200:203],v17 offset:36864
v_min3_u32 v27,v27,v136,v140
s_waitcnt vmcnt(8)
v_mfma_f32_16x16x32_bf16 v[76:79],a[132:135],v[148:151],v[76:79]
ds_read_b128 v[204:207],v17 offset:38912
buffer_load_dwordx4 v16,s[20:23],s65 offen offset:0 sc1 lds
v_mfma_f32_16x16x32_bf16 v[72:75],a[136:139],v[152:155],v[72:75]
ds_read_b128 v[208:211],v17 offset:40960
v_min3_u32 v27,v27,v144,v148
v_and_or_b32 v64,v64,-4,s48
v_mfma_f32_16x16x32_bf16 v[76:79],a[140:143],v[156:159],v[76:79]
buffer_load_dwordx4 v16,s[20:23],s65 offen offset:2048 sc1 lds
s_waitcnt lgkmcnt(9)
v_mfma_f32_16x16x32_bf16 v[72:75],a[144:147],v[160:163],v[72:75]
ds_read_b128 v[212:215],v17 offset:43008
v_min3_u32 v27,v27,v152,v156
s_add_u32 s64,s49,s34
v_mfma_f32_16x16x32_bf16 v[76:79],a[148:151],v[164:167],v[76:79]
ds_read_b128 v[216:219],v17 offset:45056
v_min3_u32 v27,v27,v160,v164
v_mfma_f32_16x16x32_bf16 v[72:75],a[152:155],v[168:171],v[72:75]
ds_read_b128 v[220:223],v17 offset:47104
buffer_store_dwordx4 v[64:67],v25,s[20:23],s64 offen offset:2048
v_mfma_f32_16x16x32_bf16 v[76:79],a[156:159],v[172:175],v[76:79]
ds_read_b128 v[224:227],v17 offset:49152
v_and_or_b32 v68,v68,-4,s48
s_waitcnt lgkmcnt(9)
v_mfma_f32_16x16x32_bf16 v[72:75],a[160:163],v[176:179],v[72:75]
ds_read_b128 v[228:231],v17 offset:51200
v_min3_u32 v27,v27,v168,v172
s_add_u32 s64,s49,s35
v_mfma_f32_16x16x32_bf16 v[76:79],a[164:167],v[180:183],v[76:79]
v_min3_u32 v27,v27,v176,v180
buffer_store_dwordx4 v[68:71],v25,s[20:23],s64 offen offset:3072
v_mfma_f32_16x16x32_bf16 v[72:75],a[168:171],v[184:187],v[72:75]
ds_read_b128 v[232:235],v17 offset:53248
s_mov_b32 s49,0x7fff0000
v_mfma_f32_16x16x32_bf16 v[76:79],a[172:175],v[188:191],v[76:79]
ds_read_b128 v[236:239],v17 offset:55296
s_waitcnt lgkmcnt(8)
v_mfma_f32_16x16x32_bf16 v[72:75],a[176:179],v[192:195],v[72:75]
v_min3_u32 v27,v27,v184,v188
v_mfma_f32_16x16x32_bf16 v[76:79],a[180:183],v[196:199],v[76:79]
v_min3_u32 v27,v27,v192,v196
ds_bpermute_b32 v124,v41,v120
v_mfma_f32_16x16x32_bf16 v[72:75],a[184:187],v[200:203],v[72:75]
v_mfma_f32_16x16x32_bf16 v[76:79],a[188:191],v[204:207],v[76:79]
v_min3_u32 v27,v27,v200,v204
s_waitcnt lgkmcnt(5)
v_mfma_f32_16x16x32_bf16 v[72:75],a[192:195],v[208:211],v[72:75]
ds_bpermute_b32 v125,v41,v121
v_mfma_f32_16x16x32_bf16 v[76:79],a[196:199],v[212:215],v[76:79]
v_min3_u32 v27,v27,v208,v212
v_lshlrev_b32 v108,16,v122
v_mfma_f32_16x16x32_bf16 v[72:75],a[200:203],v[216:219],v[72:75]
v_mfma_f32_16x16x32_bf16 v[76:79],a[204:207],v[220:223],v[76:79]
v_min3_u32 v27,v27,v216,v220
s_waitcnt lgkmcnt(2)
v_mfma_f32_16x16x32_bf16 v[72:75],a[208:211],v[224:227],v[72:75]
v_and_b32 v109,s80,v122
v_mfma_f32_16x16x32_bf16 v[76:79],a[212:215],v[228:231],v[76:79]
v_min3_u32 v27,v27,v224,v228
v_min3_u32 v27,v27,v226,v230
v_mfma_f32_16x16x32_bf16 v[72:75],a[216:219],v[232:235],v[72:75]
v_lshlrev_b32 v110,16,v123
v_mfma_f32_16x16x32_bf16 v[76:79],a[220:223],v[236:239],v[76:79]
v_min3_u32 v27,v27,v232,v236
v_min3_u32 v27,v27,v234,v238
v_mfma_f32_16x16x32_bf16 v[80:83],a[0:3],v[128:131],0
v_cmp_eq_u32 vcc,0,v27
s_cbranch_vccnz retry_326
v_mfma_f32_16x16x32_bf16 v[84:87],a[4:7],v[132:135],0
v_and_b32 v111,s80,v123
s_waitcnt lgkmcnt(0)
v_mfma_f32_16x16x32_bf16 v[80:83],a[8:11],v[136:139],v[80:83]
v_mfma_f32_16x16x32_bf16 v[84:87],a[12:15],v[140:143],v[84:87]
v_lshlrev_b32 v104,16,v124
v_mfma_f32_16x16x32_bf16 v[80:83],a[16:19],v[144:147],v[80:83]
v_add_f32 v72,v72,v76
v_add_f32 v73,v73,v77
v_mfma_f32_16x16x32_bf16 v[84:87],a[20:23],v[148:151],v[84:87]
v_and_b32 v105,s80,v124
v_add_f32 v74,v74,v78
v_mfma_f32_16x16x32_bf16 v[80:83],a[24:27],v[152:155],v[80:83]
v_add_f32 v75,v75,v79
v_and_or_b32 v72,v72,-4,s48
v_mfma_f32_16x16x32_bf16 v[84:87],a[28:31],v[156:159],v[84:87]
v_lshlrev_b32 v106,16,v125
s_add_u32 s64,s77,s33
v_mfma_f32_16x16x32_bf16 v[80:83],a[32:35],v[160:163],v[80:83]
buffer_store_dwordx4 v[72:75],v25,s[20:23],s64 offen offset:1024
v_mfma_f32_16x16x32_bf16 v[84:87],a[36:39],v[164:167],v[84:87]
v_and_b32 v107,s80,v125
v_mfma_f32_16x16x32_bf16 v[80:83],a[40:43],v[168:171],v[80:83]
v_mfma_f32_16x16x32_bf16 v[84:87],a[44:47],v[172:175],v[84:87]
v_mfma_f32_16x16x32_bf16 v[80:83],a[48:51],v[176:179],v[80:83]
buffer_load_dwordx4 v[96:99],v26,s[20:23],s77 offen offset:2048 sc1
v_mfma_f32_16x16x32_bf16 v[84:87],a[52:55],v[180:183],v[84:87]
buffer_load_dwordx4 v[100:103],v26,s[20:23],s77 offen offset:3072 sc1
v_mfma_f32_16x16x32_bf16 v[80:83],a[56:59],v[184:187],v[80:83]
v_mfma_f32_16x16x32_bf16 v[84:87],a[60:63],v[188:191],v[84:87]
v_mfma_f32_16x16x32_bf16 v[80:83],a[64:67],v[192:195],v[80:83]
v_mfma_f32_16x16x32_bf16 v[84:87],a[68:71],v[196:199],v[84:87]
v_mfma_f32_16x16x32_bf16 v[80:83],a[72:75],v[200:203],v[80:83]
v_mfma_f32_16x16x32_bf16 v[84:87],a[76:79],v[204:207],v[84:87]
v_mfma_f32_16x16x32_bf16 v[80:83],a[80:83],v[208:211],v[80:83]
v_mfma_f32_16x16x32_bf16 v[84:87],a[84:87],v[212:215],v[84:87]
v_mfma_f32_16x16x32_bf16 v[80:83],a[88:91],v[216:219],v[80:83]
buffer_load_dwordx4 v[92:95],v26,s[20:23],s77 offen offset:1024 sc1
v_mfma_f32_16x16x32_bf16 v[84:87],a[92:95],v[220:223],v[84:87]
v_mfma_f32_16x16x32_bf16 v[80:83],a[96:99],v[224:227],v[80:83]
v_mfma_f32_16x16x32_bf16 v[84:87],a[100:103],v[228:231],v[84:87]
v_mfma_f32_16x16x32_bf16 v[80:83],a[104:107],v[232:235],v[80:83]
v_mfma_f32_16x16x32_bf16 v[84:87],a[108:111],v[236:239],v[84:87]
epi_329:
buffer_load_dword v29,v21,s[20:23],s87 offen sc1
s_nop 6
v_pk_add_f32 v[88:89],v[80:81],v[84:85]
v_pk_add_f32 v[90:91],v[82:83],v[86:87]
v_pk_add_f32 v[88:89],v[88:89],v[108:109]
v_pk_add_f32 v[90:91],v[90:91],v[110:111]
s_waitcnt vmcnt(1)
s_branch ic_341
ip_339:
buffer_load_dwordx4 v[92:95],v26,s[20:23],s77 offen offset:1024 sc1
buffer_load_dwordx4 v[96:99],v26,s[20:23],s77 offen offset:2048 sc1
buffer_load_dwordx4 v[100:103],v26,s[20:23],s77 offen offset:3072 sc1
s_waitcnt vmcnt(0)
ic_341:
v_bitop3_b32 v22,v92,v96,v100 bitop3:0x80
v_and_b32 v22,s48,v22
v_cmp_eq_u32 vcc,0,v22
s_cbranch_vccz ik_340
s_sub_u32 s90,s90,1
s_cmp_gt_i32 s90,0
s_cbranch_scc1 ip_339
ik_340:
s_cmp_lg_u32 s71,65
s_cbranch_scc1 nl_342
buffer_load_dwordx4 v[132:135],v26,s[20:23],s40 offen offset:1024 sc1
buffer_load_dwordx4 v[136:139],v26,s[20:23],s40 offen offset:2048 sc1
buffer_load_dwordx4 v[140:143],v26,s[20:23],s40 offen offset:3072 sc1
nl_342:
v_pk_add_f32 v[88:89],v[88:89],v[92:93]
v_pk_add_f32 v[96:97],v[96:97],v[100:101]
v_pk_add_f32 v[90:91],v[90:91],v[94:95]
v_pk_add_f32 v[98:99],v[98:99],v[102:103]
v_pk_add_f32 v[88:89],v[88:89],v[96:97]
v_pk_add_f32 v[90:91],v[90:91],v[98:99]
v_pk_fma_f32 v[88:89],v[88:89],v[52:53],v[104:105]
v_pk_fma_f32 v[90:91],v[90:91],v[54:55],v[106:107]
v_cvt_pk_bf16_f32 v88,v88,v89
v_cvt_pk_bf16_f32 v89,v90,v91
ds_bpermute_b32 v88,v40,v88
ds_bpermute_b32 v89,v40,v89
v_xor_b32 v18,0x10000,v18
s_xor_b32 s49,s77,524288
s_cselect_b32 s64,0,3
s_xor_b32 s48,s48,s64
s_cmp_eq_u32 s71,63
s_cselect_b32 s64,0,0x2000
s_cselect_b32 s66,2,1
s_cmp_eq_u32 s71,64
s_cselect_b32 s66,-1,s66
v_xor_b32 v20,s64,v20
s_lshl_b32 s64,s66,21
s_add_u32 s76,s76,s64
s_lshl_b32 s66,s66,16
s_waitcnt lgkmcnt(0)
s_mov_b64 exec,s[84:85]
buffer_store_dwordx2 v[88:89],v19,s[36:39],s78 offen
s_mov_b64 exec,-1
s_mov_b64 s[84:85],-1
s_mov_b32 s77,s49
s_add_u32 s78,s78,s66
next_336:
v_xor_b32 v17,0x10000,v17
s_xor_b32 s72,s72,0x10000
s_add_u32 s70,s70,2097152
s_xor_b32 s70,s70,0x2000
s_add_u32 s71,s71,1
s_cmp_le_u32 s71,s57
s_cbranch_scc1 seg_327
s_cmp_lg_u32 s43,0
s_cbranch_scc1 hn_346
s_waitcnt vmcnt(1)
s_branch hc_345
hp_343:
buffer_load_dwordx4 v[132:135],v26,s[20:23],s40 offen offset:1024 sc1
buffer_load_dwordx4 v[136:139],v26,s[20:23],s40 offen offset:2048 sc1
buffer_load_dwordx4 v[140:143],v26,s[20:23],s40 offen offset:3072 sc1
s_waitcnt vmcnt(0)
hc_345:
v_bitop3_b32 v22,v132,v136,v140 bitop3:0x80
v_and_b32 v22,s60,v22
v_cmp_eq_u32 vcc,0,v22
s_cbranch_vccz hk_344
s_sub_u32 s90,s90,1
s_cmp_gt_i32 s90,0
s_cbranch_scc1 hp_343
hk_344:
v_pk_add_f32 v[112:113],v[112:113],v[132:133]
v_pk_add_f32 v[136:137],v[136:137],v[140:141]
v_pk_add_f32 v[114:115],v[114:115],v[134:135]
v_pk_add_f32 v[138:139],v[138:139],v[142:143]
v_pk_add_f32 v[112:113],v[112:113],v[136:137]
v_pk_add_f32 v[114:115],v[114:115],v[138:139]
v_pk_fma_f32 v[112:113],v[112:113],v[52:53],v[116:117]
v_pk_fma_f32 v[114:115],v[114:115],v[54:55],v[118:119]
v_cvt_pk_bf16_f32 v112,v112,v113
v_cvt_pk_bf16_f32 v113,v114,v115
ds_bpermute_b32 v112,v40,v112
ds_bpermute_b32 v113,v40,v113
s_mov_b32 s64,4194304
s_waitcnt lgkmcnt(0)
buffer_store_dwordx2 v[112:113],v19,s[36:39],s64 offen
hn_346:
s_endpgm
retry_326:
s_sub_u32 s90,s90,64
s_cmp_lt_i32 s90,0
s_cbranch_scc1 giveup_197
s_mov_b32 s83,1
s_waitcnt vmcnt(0) lgkmcnt(0)
s_barrier
s_branch seg_327
half_335:
s_cmp_eq_u32 s43,0
s_cbranch_scc1 hown_347
s_mov_b64 exec,s[52:53]
s_xor_b32 m0,s91,0
s_add_u32 s65,s94,0
buffer_load_dwordx4 v16,s[20:23],s65 offen offset:0 sc1 lds
buffer_load_dwordx4 v16,s[20:23],s65 offen offset:2048 sc1 lds
s_xor_b32 m0,s91,16384
s_add_u32 s65,s94,32768
buffer_load_dwordx4 v16,s[20:23],s65 offen offset:0 sc1 lds
buffer_load_dwordx4 v16,s[20:23],s65 offen offset:2048 sc1 lds
s_xor_b32 m0,s91,32768
s_add_u32 s65,s94,65536
buffer_load_dwordx4 v16,s[20:23],s65 offen offset:0 sc1 lds
buffer_load_dwordx4 v16,s[20:23],s65 offen offset:2048 sc1 lds
s_xor_b32 m0,s91,49152
s_add_u32 s65,s94,s86
buffer_load_dwordx4 v16,s[20:23],s65 offen offset:0 sc1 lds
buffer_load_dwordx4 v16,s[20:23],s65 offen offset:2048 sc1 lds
s_mov_b64 exec,-1
h2a_348:
s_waitcnt vmcnt(6)
s_barrier
ds_read_b128 v[224:227],v18 offset:0
ds_read_b128 v[228:231],v18 offset:2048
ds_read_b128 v[232:235],v18 offset:4096
ds_read_b128 v[236:239],v18 offset:6144
ds_read_b128 v[240:243],v18 offset:8192
ds_read_b128 v[244:247],v18 offset:10240
ds_read_b128 v[248:251],v18 offset:12288
s_waitcnt lgkmcnt(5)
v_mfma_f32_16x16x32_bf16 v[64:67],a[0:3],v[224:227],0
v_min_u32 v27,v224,v228
v_mfma_f32_16x16x32_bf16 v[68:71],a[112:115],v[224:227],0
ds_read_b128 v[252:255],v18 offset:14336
v_mfma_f32_16x16x32_bf16 v[64:67],a[4:7],v[228:231],v[64:67]
v_mfma_f32_16x16x32_bf16 v[68:71],a[116:119],v[228:231],v[68:71]
s_waitcnt vmcnt(4)
s_barrier
ds_read_b128 v[224:227],v18 offset:16384
s_waitcnt lgkmcnt(5)
v_mfma_f32_16x16x32_bf16 v[64:67],a[8:11],v[232:235],v[64:67]
v_min3_u32 v27,v27,v232,v236
v_mfma_f32_16x16x32_bf16 v[68:71],a[120:123],v[232:235],v[68:71]
ds_read_b128 v[228:231],v18 offset:18432
v_mfma_f32_16x16x32_bf16 v[64:67],a[12:15],v[236:239],v[64:67]
v_mfma_f32_16x16x32_bf16 v[68:71],a[124:127],v[236:239],v[68:71]
ds_read_b128 v[232:235],v18 offset:20480
s_waitcnt lgkmcnt(5)
v_mfma_f32_16x16x32_bf16 v[64:67],a[16:19],v[240:243],v[64:67]
v_min3_u32 v27,v27,v240,v244
v_mfma_f32_16x16x32_bf16 v[68:71],a[128:131],v[240:243],v[68:71]
ds_read_b128 v[236:239],v18 offset:22528
v_mfma_f32_16x16x32_bf16 v[64:67],a[20:23],v[244:247],v[64:67]
v_mfma_f32_16x16x32_bf16 v[68:71],a[132:135],v[244:247],v[68:71]
ds_read_b128 v[240:243],v18 offset:24576
s_waitcnt lgkmcnt(5)
v_mfma_f32_16x16x32_bf16 v[64:67],a[24:27],v[248:251],v[64:67]
v_min3_u32 v27,v27,v248,v252
v_mfma_f32_16x16x32_bf16 v[68:71],a[136:139],v[248:251],v[68:71]
ds_read_b128 v[244:247],v18 offset:26624
v_mfma_f32_16x16x32_bf16 v[64:67],a[28:31],v[252:255],v[64:67]
v_mfma_f32_16x16x32_bf16 v[68:71],a[140:143],v[252:255],v[68:71]
ds_read_b128 v[248:251],v18 offset:28672
s_waitcnt lgkmcnt(5)
v_mfma_f32_16x16x32_bf16 v[64:67],a[32:35],v[224:227],v[64:67]
v_min3_u32 v27,v27,v224,v228
v_mfma_f32_16x16x32_bf16 v[68:71],a[144:147],v[224:227],v[68:71]
ds_read_b128 v[252:255],v18 offset:30720
v_mfma_f32_16x16x32_bf16 v[64:67],a[36:39],v[228:231],v[64:67]
v_mfma_f32_16x16x32_bf16 v[68:71],a[148:151],v[228:231],v[68:71]
s_waitcnt vmcnt(0)
s_barrier
ds_read_b128 v[224:227],v18 offset:32768
s_waitcnt lgkmcnt(5)
v_mfma_f32_16x16x32_bf16 v[64:67],a[40:43],v[232:235],v[64:67]
v_min3_u32 v27,v27,v232,v236
v_mfma_f32_16x16x32_bf16 v[68:71],a[152:155],v[232:235],v[68:71]
ds_read_b128 v[228:231],v18 offset:34816
v_mfma_f32_16x16x32_bf16 v[64:67],a[44:47],v[236:239],v[64:67]
v_mfma_f32_16x16x32_bf16 v[68:71],a[156:159],v[236:239],v[68:71]
ds_read_b128 v[232:235],v18 offset:36864
s_waitcnt lgkmcnt(5)
v_mfma_f32_16x16x32_bf16 v[64:67],a[48:51],v[240:243],v[64:67]
v_min3_u32 v27,v27,v240,v244
v_mfma_f32_16x16x32_bf16 v[68:71],a[160:163],v[240:243],v[68:71]
ds_read_b128 v[236:239],v18 offset:38912
v_mfma_f32_16x16x32_bf16 v[64:67],a[52:55],v[244:247],v[64:67]
v_mfma_f32_16x16x32_bf16 v[68:71],a[164:167],v[244:247],v[68:71]
ds_read_b128 v[240:243],v18 offset:40960
s_waitcnt lgkmcnt(5)
v_mfma_f32_16x16x32_bf16 v[64:67],a[56:59],v[248:251],v[64:67]
v_min3_u32 v27,v27,v248,v252
v_mfma_f32_16x16x32_bf16 v[68:71],a[168:171],v[248:251],v[68:71]
ds_read_b128 v[244:247],v18 offset:43008
v_mfma_f32_16x16x32_bf16 v[64:67],a[60:63],v[252:255],v[64:67]
v_mfma_f32_16x16x32_bf16 v[68:71],a[172:175],v[252:255],v[68:71]
ds_read_b128 v[248:251],v18 offset:45056
s_waitcnt lgkmcnt(5)
v_mfma_f32_16x16x32_bf16 v[64:67],a[64:67],v[224:227],v[64:67]
v_min3_u32 v27,v27,v224,v228
v_mfma_f32_16x16x32_bf16 v[68:71],a[176:179],v[224:227],v[68:71]
ds_read_b128 v[252:255],v18 offset:47104
v_mfma_f32_16x16x32_bf16 v[64:67],a[68:71],v[228:231],v[64:67]
v_mfma_f32_16x16x32_bf16 v[68:71],a[180:183],v[228:231],v[68:71]
ds_read_b128 v[224:227],v18 offset:49152
s_waitcnt lgkmcnt(5)
v_mfma_f32_16x16x32_bf16 v[64:67],a[72:75],v[232:235],v[64:67]
v_min3_u32 v27,v27,v232,v236
v_mfma_f32_16x16x32_bf16 v[68:71],a[184:187],v[232:235],v[68:71]
ds_read_b128 v[228:231],v18 offset:51200
v_mfma_f32_16x16x32_bf16 v[64:67],a[76:79],v[236:239],v[64:67]
v_mfma_f32_16x16x32_bf16 v[68:71],a[188:191],v[236:239],v[68:71]
ds_read_b128 v[232:235],v18 offset:53248
s_waitcnt lgkmcnt(5)
v_mfma_f32_16x16x32_bf16 v[64:67],a[80:83],v[240:243],v[64:67]
v_min3_u32 v27,v27,v240,v244
v_mfma_f32_16x16x32_bf16 v[68:71],a[192:195],v[240:243],v[68:71]
ds_read_b128 v[236:239],v18 offset:55296
v_mfma_f32_16x16x32_bf16 v[64:67],a[84:87],v[244:247],v[64:67]
v_mfma_f32_16x16x32_bf16 v[68:71],a[196:199],v[244:247],v[68:71]
s_waitcnt lgkmcnt(4)
v_mfma_f32_16x16x32_bf16 v[64:67],a[88:91],v[248:251],v[64:67]
v_min3_u32 v27,v27,v248,v252
v_mfma_f32_16x16x32_bf16 v[68:71],a[200:203],v[248:251],v[68:71]
v_mfma_f32_16x16x32_bf16 v[64:67],a[92:95],v[252:255],v[64:67]
v_mfma_f32_16x16x32_bf16 v[68:71],a[204:207],v[252:255],v[68:71]
s_waitcnt lgkmcnt(2)
v_mfma_f32_16x16x32_bf16 v[64:67],a[96:99],v[224:227],v[64:67]
v_min3_u32 v27,v27,v224,v228
v_min3_u32 v27,v27,v226,v230
v_mfma_f32_16x16x32_bf16 v[68:71],a[208:211],v[224:227],v[68:71]
v_mfma_f32_16x16x32_bf16 v[64:67],a[100:103],v[228:231],v[64:67]
v_mfma_f32_16x16x32_bf16 v[68:71],a[212:215],v[228:231],v[68:71]
s_waitcnt lgkmcnt(0)
v_mfma_f32_16x16x32_bf16 v[64:67],a[104:107],v[232:235],v[64:67]
v_min3_u32 v27,v27,v232,v236
v_min3_u32 v27,v27,v234,v238
v_mfma_f32_16x16x32_bf16 v[68:71],a[216:219],v[232:235],v[68:71]
v_mfma_f32_16x16x32_bf16 v[64:67],a[108:111],v[236:239],v[64:67]
v_mfma_f32_16x16x32_bf16 v[68:71],a[220:223],v[236:239],v[68:71]
v_cmp_eq_u32 vcc,0,v27
s_and_b64 vcc,vcc,s[52:53]
s_cbranch_vccnz retry_326
buffer_load_dword v29,v21,s[20:23],s87 offen sc1
s_mov_b32 s40,0x7fff0000
s_nop 5
v_and_or_b32 v64,v64,-4,s48
s_add_u32 s64,s77,s34
buffer_store_dwordx4 v[64:67],v25,s[20:23],s64 offen offset:2048
v_and_or_b32 v68,v68,-4,s48
s_add_u32 s64,s77,s35
buffer_store_dwordx4 v[68:71],v25,s[20:23],s64 offen offset:3072
hjoin_350:
v_xor_b32 v18,0x10000,v18
s_xor_b32 s49,s77,524288
s_cselect_b32 s64,0,3
s_xor_b32 s48,s48,s64
v_xor_b32 v20,0x2000,v20
s_sub_u32 s76,s76,2097152
s_mov_b32 s77,s49
s_sub_u32 s78,s78,65536
s_branch next_336
half2_332:
s_cmp_eq_u32 s43,0
s_cbranch_scc1 h2b_349
s_branch h2a_348
hown_347:
s_mov_b64 exec,s[52:53]
s_xor_b32 m0,s91,1024
s_add_u32 s65,s95,0
buffer_load_dwordx4 v16,s[20:23],s65 offen offset:0 sc1 lds
buffer_load_dwordx4 v16,s[20:23],s65 offen offset:2048 sc1 lds
s_xor_b32 m0,s91,17408
s_add_u32 s65,s95,32768
buffer_load_dwordx4 v16,s[20:23],s65 offen offset:0 sc1 lds
buffer_load_dwordx4 v16,s[20:23],s65 offen offset:2048 sc1 lds
s_xor_b32 m0,s91,33792
s_add_u32 s65,s95,65536
buffer_load_dwordx4 v16,s[20:23],s65 offen offset:0 sc1 lds
buffer_load_dwordx4 v16,s[20:23],s65 offen offset:2048 sc1 lds
s_xor_b32 m0,s91,50176
s_add_u32 s65,s95,s86
buffer_load_dwordx4 v16,s[20:23],s65 offen offset:0 sc1 lds
buffer_load_dwordx4 v16,s[20:23],s65 offen offset:2048 sc1 lds
s_mov_b64 exec,-1
h2b_349:
buffer_load_dwordx2 v[120:121],v20,s[20:23],s76 offen sc1
buffer_load_dwordx2 v[122:123],v24,s[20:23],s70 offen sc1
s_waitcnt vmcnt(8)
s_barrier
ds_read_b128 v[128:131],v17 offset:0
ds_read_b128 v[132:135],v17 offset:2048
ds_read_b128 v[136:139],v17 offset:4096
ds_read_b128 v[140:143],v17 offset:6144
ds_read_b128 v[144:147],v17 offset:8192
ds_read_b128 v[148:151],v17 offset:10240
ds_read_b128 v[152:155],v17 offset:12288
s_waitcnt lgkmcnt(5)
v_mfma_f32_16x16x32_bf16 v[72:75],a[112:115],v[128:131],0
v_min_u32 v27,v128,v132
v_mfma_f32_16x16x32_bf16 v[80:83],a[0:3],v[128:131],0
ds_read_b128 v[156:159],v17 offset:14336
v_mfma_f32_16x16x32_bf16 v[76:79],a[116:119],v[132:135],0
v_mfma_f32_16x16x32_bf16 v[84:87],a[4:7],v[132:135],0
s_waitcnt vmcnt(6)
s_barrier
ds_read_b128 v[160:163],v17 offset:16384
s_waitcnt lgkmcnt(5)
v_mfma_f32_16x16x32_bf16 v[72:75],a[120:123],v[136:139],v[72:75]
v_min3_u32 v27,v27,v136,v140
v_mfma_f32_16x16x32_bf16 v[80:83],a[8:11],v[136:139],v[80:83]
ds_read_b128 v[164:167],v17 offset:18432
v_mfma_f32_16x16x32_bf16 v[76:79],a[124:127],v[140:143],v[76:79]
v_mfma_f32_16x16x32_bf16 v[84:87],a[12:15],v[140:143],v[84:87]
ds_read_b128 v[168:171],v17 offset:20480
s_waitcnt lgkmcnt(5)
v_mfma_f32_16x16x32_bf16 v[72:75],a[128:131],v[144:147],v[72:75]
v_min3_u32 v27,v27,v144,v148
v_mfma_f32_16x16x32_bf16 v[80:83],a[16:19],v[144:147],v[80:83]
ds_read_b128 v[172:175],v17 offset:22528
v_mfma_f32_16x16x32_bf16 v[76:79],a[132:135],v[148:151],v[76:79]
v_mfma_f32_16x16x32_bf16 v[84:87],a[20:23],v[148:151],v[84:87]
ds_read_b128 v[176:179],v17 offset:24576
s_waitcnt lgkmcnt(5)
v_mfma_f32_16x16x32_bf16 v[72:75],a[136:139],v[152:155],v[72:75]
v_min3_u32 v27,v27,v152,v156
v_mfma_f32_16x16x32_bf16 v[80:83],a[24:27],v[152:155],v[80:83]
ds_read_b128 v[180:183],v17 offset:26624
v_mfma_f32_16x16x32_bf16 v[76:79],a[140:143],v[156:159],v[76:79]
v_mfma_f32_16x16x32_bf16 v[84:87],a[28:31],v[156:159],v[84:87]
ds_read_b128 v[184:187],v17 offset:28672
s_waitcnt lgkmcnt(5)
v_mfma_f32_16x16x32_bf16 v[72:75],a[144:147],v[160:163],v[72:75]
v_min3_u32 v27,v27,v160,v164
v_mfma_f32_16x16x32_bf16 v[80:83],a[32:35],v[160:163],v[80:83]
ds_read_b128 v[188:191],v17 offset:30720
v_mfma_f32_16x16x32_bf16 v[76:79],a[148:151],v[164:167],v[76:79]
v_mfma_f32_16x16x32_bf16 v[84:87],a[36:39],v[164:167],v[84:87]
s_waitcnt vmcnt(2)
s_barrier
ds_read_b128 v[192:195],v17 offset:32768
s_waitcnt lgkmcnt(5)
v_mfma_f32_16x16x32_bf16 v[72:75],a[152:155],v[168:171],v[72:75]
v_min3_u32 v27,v27,v168,v172
v_mfma_f32_16x16x32_bf16 v[80:83],a[40:43],v[168:171],v[80:83]
ds_read_b128 v[196:199],v17 offset:34816
v_mfma_f32_16x16x32_bf16 v[76:79],a[156:159],v[172:175],v[76:79]
v_mfma_f32_16x16x32_bf16 v[84:87],a[44:47],v[172:175],v[84:87]
ds_read_b128 v[200:203],v17 offset:36864
s_waitcnt lgkmcnt(5)
v_mfma_f32_16x16x32_bf16 v[72:75],a[160:163],v[176:179],v[72:75]
v_min3_u32 v27,v27,v176,v180
v_mfma_f32_16x16x32_bf16 v[80:83],a[48:51],v[176:179],v[80:83]
ds_read_b128 v[204:207],v17 offset:38912
v_mfma_f32_16x16x32_bf16 v[76:79],a[164:167],v[180:183],v[76:79]
v_mfma_f32_16x16x32_bf16 v[84:87],a[52:55],v[180:183],v[84:87]
ds_read_b128 v[208:211],v17 offset:40960
s_waitcnt lgkmcnt(5)
v_mfma_f32_16x16x32_bf16 v[72:75],a[168:171],v[184:187],v[72:75]
v_min3_u32 v27,v27,v184,v188
v_mfma_f32_16x16x32_bf16 v[80:83],a[56:59],v[184:187],v[80:83]
ds_read_b128 v[212:215],v17 offset:43008
v_mfma_f32_16x16x32_bf16 v[76:79],a[172:175],v[188:191],v[76:79]
v_mfma_f32_16x16x32_bf16 v[84:87],a[60:63],v[188:191],v[84:87]
ds_read_b128 v[216:219],v17 offset:45056
s_waitcnt lgkmcnt(5)
v_mfma_f32_16x16x32_bf16 v[72:75],a[176:179],v[192:195],v[72:75]
v_min3_u32 v27,v27,v192,v196
s_waitcnt vmcnt(0)
v_mfma_f32_16x16x32_bf16 v[80:83],a[64:67],v[192:195],v[80:83]
ds_read_b128 v[220:223],v17 offset:47104
ds_bpermute_b32 v124,v41,v120
v_mfma_f32_16x16x32_bf16 v[76:79],a[180:183],v[196:199],v[76:79]
ds_bpermute_b32 v125,v41,v121
v_lshlrev_b32 v108,16,v122
v_mfma_f32_16x16x32_bf16 v[84:87],a[68:71],v[196:199],v[84:87]
ds_read_b128 v[224:227],v17 offset:49152
s_waitcnt lgkmcnt(7)
v_mfma_f32_16x16x32_bf16 v[72:75],a[184:187],v[200:203],v[72:75]
v_min3_u32 v27,v27,v200,v204
v_and_b32 v109,s80,v122
v_mfma_f32_16x16x32_bf16 v[80:83],a[72:75],v[200:203],v[80:83]
ds_read_b128 v[228:231],v17 offset:51200
v_lshlrev_b32 v110,16,v123
v_mfma_f32_16x16x32_bf16 v[76:79],a[188:191],v[204:207],v[76:79]
v_and_b32 v111,s80,v123
s_waitcnt lgkmcnt(2)
v_mfma_f32_16x16x32_bf16 v[84:87],a[76:79],v[204:207],v[84:87]
ds_read_b128 v[232:235],v17 offset:53248
v_mfma_f32_16x16x32_bf16 v[72:75],a[192:195],v[208:211],v[72:75]
v_min3_u32 v27,v27,v208,v212
v_lshlrev_b32 v104,16,v124
v_mfma_f32_16x16x32_bf16 v[80:83],a[80:83],v[208:211],v[80:83]
ds_read_b128 v[236:239],v17 offset:55296
v_and_b32 v105,s80,v124
v_mfma_f32_16x16x32_bf16 v[76:79],a[196:199],v[212:215],v[76:79]
v_lshlrev_b32 v106,16,v125
v_and_b32 v107,s80,v125
v_mfma_f32_16x16x32_bf16 v[84:87],a[84:87],v[212:215],v[84:87]
v_mfma_f32_16x16x32_bf16 v[72:75],a[200:203],v[216:219],v[72:75]
v_min3_u32 v27,v27,v216,v220
v_mfma_f32_16x16x32_bf16 v[80:83],a[88:91],v[216:219],v[80:83]
v_mfma_f32_16x16x32_bf16 v[76:79],a[204:207],v[220:223],v[76:79]
v_mfma_f32_16x16x32_bf16 v[84:87],a[92:95],v[220:223],v[84:87]
s_waitcnt lgkmcnt(2)
v_mfma_f32_16x16x32_bf16 v[72:75],a[208:211],v[224:227],v[72:75]
v_min3_u32 v27,v27,v224,v228
v_min3_u32 v27,v27,v226,v230
v_mfma_f32_16x16x32_bf16 v[80:83],a[96:99],v[224:227],v[80:83]
v_mfma_f32_16x16x32_bf16 v[76:79],a[212:215],v[228:231],v[76:79]
v_mfma_f32_16x16x32_bf16 v[84:87],a[100:103],v[228:231],v[84:87]
s_waitcnt lgkmcnt(0)
v_mfma_f32_16x16x32_bf16 v[72:75],a[216:219],v[232:235],v[72:75]
v_min3_u32 v27,v27,v232,v236
v_min3_u32 v27,v27,v234,v238
v_mfma_f32_16x16x32_bf16 v[80:83],a[104:107],v[232:235],v[80:83]
v_mfma_f32_16x16x32_bf16 v[76:79],a[220:223],v[236:239],v[76:79]
v_mfma_f32_16x16x32_bf16 v[84:87],a[108:111],v[236:239],v[84:87]
v_cmp_eq_u32 vcc,0,v27
s_and_b64 vcc,vcc,s[52:53]
s_cbranch_vccnz retry_326
buffer_load_dword v29,v21,s[20:23],s87 offen sc1
s_nop 6
v_add_f32 v72,v72,v76
v_add_f32 v73,v73,v77
v_add_f32 v74,v74,v78
v_add_f32 v75,v75,v79
v_and_or_b32 v72,v72,-4,s48
s_add_u32 s64,s77,s33
buffer_store_dwordx4 v[72:75],v25,s[20:23],s64 offen offset:1024
v_pk_add_f32 v[112:113],v[80:81],v[84:85]
v_pk_add_f32 v[112:113],v[112:113],v[108:109]
v_pk_add_f32 v[114:115],v[82:83],v[86:87]
v_pk_add_f32 v[114:115],v[114:115],v[110:111]
v_mov_b32 v116,v104
v_mov_b32 v117,v105
v_mov_b32 v118,v106
v_mov_b32 v119,v107
s_mov_b32 s40,s77
s_mov_b32 s60,s48
s_branch hjoin_350
kslow_325:
s_add_u32 s64,s79,0
s_lshl_b32 s70,s64,21
s_lshl_b32 s64,s64,13
s_and_b32 s64,s64,0x2000
s_xor_b32 s64,s64,s62
s_add_u32 s70,s70,s64
s_add_u32 s70,s70,29360128
s_mov_b32 s83,1
s_mov_b32 s87,s74
s_cmp_eq_u32 s50,0
s_cselect_b32 s74,s74,0x7fff0000
v_mov_b32 v47,132096
s_lshl_b32 s64,s50,3
s_add_u32 s64,s64,132096
v_mov_b32 v46,s64
v_mov_b32 v29,0
s_mov_b32 s97,0x7fff0000
s_mov_b32 s69,1
s_mov_b32 s68,0
s_mov_b32 s52,0x30003
s_mov_b32 s53,s52
seg_352:
s_add_u32 s94,s70,s75
s_xor_b32 s95,s94,1024
s_xor_b32 s91,s72,0x10000
s_cmp_eq_u32 s69,0
s_mov_b32 s69,1
s_cbranch_scc1 half2_357
s_waitcnt vmcnt(1)
v_cmp_gt_u32 vcc,s71,v29
s_cbranch_vccz nb_356
s_cmp_lg_u32 s50,0
s_cbranch_scc1 nb_356
buffer_load_dword v32,v21,s[20:23],s74 offen sc1
s_sleep 2
pl_358:
buffer_load_dword v33,v21,s[20:23],s74 offen sc1
s_waitcnt vmcnt(1)
v_cmp_gt_u32 vcc,s71,v32
v_mov_b32 v29,v32
s_cbranch_vccz pok_359
buffer_load_dword v32,v21,s[20:23],s74 offen sc1
s_waitcnt vmcnt(1)
v_cmp_gt_u32 vcc,s71,v33
v_mov_b32 v29,v33
s_cbranch_vccz pok_359
s_sub_u32 s90,s90,1
s_cmp_gt_i32 s90,0
s_cbranch_scc1 pl_358
pok_359:
nb_356:
s_cmp_eq_u32 s71,64
s_barrier
s_cbranch_scc1 half_360
s_xor_b32 m0,s91,0
s_add_u32 s65,s94,0
buffer_load_dwordx4 v16,s[20:23],s65 offen offset:0 sc1 lds
buffer_load_dwordx4 v16,s[20:23],s65 offen offset:2048 sc1 lds
s_xor_b32 m0,s91,16384
s_add_u32 s65,s94,32768
buffer_load_dwordx4 v16,s[20:23],s65 offen offset:0 sc1 lds
buffer_load_dwordx4 v16,s[20:23],s65 offen offset:2048 sc1 lds
s_xor_b32 m0,s91,32768
s_add_u32 s65,s94,65536
buffer_load_dwordx4 v16,s[20:23],s65 offen offset:0 sc1 lds
buffer_load_dwordx4 v16,s[20:23],s65 offen offset:2048 sc1 lds
s_xor_b32 m0,s91,49152
s_add_u32 s65,s94,s86
buffer_load_dwordx4 v16,s[20:23],s65 offen offset:0 sc1 lds
buffer_load_dwordx4 v16,s[20:23],s65 offen offset:2048 sc1 lds
s_waitcnt vmcnt(6)
s_barrier
ds_read_b128 v[224:227],v18 offset:0
ds_read_b128 v[228:231],v18 offset:2048
ds_read_b128 v[232:235],v18 offset:4096
ds_read_b128 v[236:239],v18 offset:6144
ds_read_b128 v[240:243],v18 offset:8192
ds_read_b128 v[244:247],v18 offset:10240
ds_read_b128 v[248:251],v18 offset:12288
s_waitcnt lgkmcnt(5)
v_mfma_f32_16x16x32_bf16 v[64:67],a[0:3],v[224:227],0
s_xor_b32 m0,s91,1024
v_min_u32 v27,v224,v228
v_mfma_f32_16x16x32_bf16 v[68:71],a[112:115],v[224:227],0
ds_read_b128 v[252:255],v18 offset:14336
v_mfma_f32_16x16x32_bf16 v[64:67],a[4:7],v[228:231],v[64:67]
s_add_u32 s65,s95,0
v_mfma_f32_16x16x32_bf16 v[68:71],a[116:119],v[228:231],v[68:71]
s_waitcnt vmcnt(4)
s_barrier
ds_read_b128 v[224:227],v18 offset:16384
s_waitcnt lgkmcnt(5)
v_mfma_f32_16x16x32_bf16 v[64:67],a[8:11],v[232:235],v[64:67]
buffer_load_dwordx4 v16,s[20:23],s65 offen offset:0 sc1 lds
v_mfma_f32_16x16x32_bf16 v[68:71],a[120:123],v[232:235],v[68:71]
ds_read_b128 v[228:231],v18 offset:18432
v_min3_u32 v27,v27,v232,v236
v_mfma_f32_16x16x32_bf16 v[64:67],a[12:15],v[236:239],v[64:67]
buffer_load_dwordx4 v16,s[20:23],s65 offen offset:2048 sc1 lds
v_mfma_f32_16x16x32_bf16 v[68:71],a[124:127],v[236:239],v[68:71]
ds_read_b128 v[232:235],v18 offset:20480
s_waitcnt lgkmcnt(5)
v_mfma_f32_16x16x32_bf16 v[64:67],a[16:19],v[240:243],v[64:67]
s_xor_b32 m0,s91,17408
v_min3_u32 v27,v27,v240,v244
v_mfma_f32_16x16x32_bf16 v[68:71],a[128:131],v[240:243],v[68:71]
ds_read_b128 v[236:239],v18 offset:22528
v_mfma_f32_16x16x32_bf16 v[64:67],a[20:23],v[244:247],v[64:67]
s_add_u32 s65,s95,32768
v_mfma_f32_16x16x32_bf16 v[68:71],a[132:135],v[244:247],v[68:71]
ds_read_b128 v[240:243],v18 offset:24576
s_waitcnt lgkmcnt(5)
v_mfma_f32_16x16x32_bf16 v[64:67],a[24:27],v[248:251],v[64:67]
buffer_load_dwordx4 v16,s[20:23],s65 offen offset:0 sc1 lds
v_mfma_f32_16x16x32_bf16 v[68:71],a[136:139],v[248:251],v[68:71]
ds_read_b128 v[244:247],v18 offset:26624
v_min3_u32 v27,v27,v248,v252
v_mfma_f32_16x16x32_bf16 v[64:67],a[28:31],v[252:255],v[64:67]
buffer_load_dwordx4 v16,s[20:23],s65 offen offset:2048 sc1 lds
v_mfma_f32_16x16x32_bf16 v[68:71],a[140:143],v[252:255],v[68:71]
ds_read_b128 v[248:251],v18 offset:28672
s_waitcnt lgkmcnt(5)
v_mfma_f32_16x16x32_bf16 v[64:67],a[32:35],v[224:227],v[64:67]
s_xor_b32 m0,s91,33792
v_min3_u32 v27,v27,v224,v228
v_mfma_f32_16x16x32_bf16 v[68:71],a[144:147],v[224:227],v[68:71]
ds_read_b128 v[252:255],v18 offset:30720
v_mfma_f32_16x16x32_bf16 v[64:67],a[36:39],v[228:231],v[64:67]
s_add_u32 s65,s95,65536
v_mfma_f32_16x16x32_bf16 v[68:71],a[148:151],v[228:231],v[68:71]
s_waitcnt vmcnt(4)
s_barrier
ds_read_b128 v[224:227],v18 offset:32768
s_waitcnt lgkmcnt(5)
v_mfma_f32_16x16x32_bf16 v[64:67],a[40:43],v[232:235],v[64:67]
buffer_load_dwordx4 v16,s[20:23],s65 offen offset:0 sc1 lds
s_add_u32 s88,s70,s75
v_mfma_f32_16x16x32_bf16 v[68:71],a[152:155],v[232:235],v[68:71]
ds_read_b128 v[228:231],v18 offset:34816
v_min3_u32 v27,v27,v232,v236
s_add_u32 s88,s88,2097152
v_mfma_f32_16x16x32_bf16 v[64:67],a[44:47],v[236:239],v[64:67]
buffer_load_dwordx4 v16,s[20:23],s65 offen offset:2048 sc1 lds
v_mfma_f32_16x16x32_bf16 v[68:71],a[156:159],v[236:239],v[68:71]
ds_read_b128 v[232:235],v18 offset:36864
s_waitcnt lgkmcnt(5)
v_mfma_f32_16x16x32_bf16 v[64:67],a[48:51],v[240:243],v[64:67]
s_xor_b32 m0,s91,50176
v_min3_u32 v27,v27,v240,v244
v_mfma_f32_16x16x32_bf16 v[68:71],a[160:163],v[240:243],v[68:71]
ds_read_b128 v[236:239],v18 offset:38912
s_xor_b32 s88,s88,0x2000
v_mfma_f32_16x16x32_bf16 v[64:67],a[52:55],v[244:247],v[64:67]
s_add_u32 s65,s95,s86
s_xor_b32 s89,s88,1024
v_mfma_f32_16x16x32_bf16 v[68:71],a[164:167],v[244:247],v[68:71]
ds_read_b128 v[240:243],v18 offset:40960
s_waitcnt lgkmcnt(5)
v_mfma_f32_16x16x32_bf16 v[64:67],a[56:59],v[248:251],v[64:67]
buffer_load_dwordx4 v16,s[20:23],s65 offen offset:0 sc1 lds
v_mfma_f32_16x16x32_bf16 v[68:71],a[168:171],v[248:251],v[68:71]
ds_read_b128 v[244:247],v18 offset:43008
v_min3_u32 v27,v27,v248,v252
v_mfma_f32_16x16x32_bf16 v[64:67],a[60:63],v[252:255],v[64:67]
buffer_load_dwordx4 v16,s[20:23],s65 offen offset:2048 sc1 lds
v_mfma_f32_16x16x32_bf16 v[68:71],a[172:175],v[252:255],v[68:71]
ds_read_b128 v[248:251],v18 offset:45056
s_waitcnt lgkmcnt(5)
v_mfma_f32_16x16x32_bf16 v[64:67],a[64:67],v[224:227],v[64:67]
s_waitcnt vmcnt(4)
s_barrier
ds_read_b128 v[128:131],v17 offset:0
ds_read_b128 v[132:135],v17 offset:2048
v_mfma_f32_16x16x32_bf16 v[68:71],a[176:179],v[224:227],v[68:71]
ds_read_b128 v[252:255],v18 offset:47104
v_min3_u32 v27,v27,v224,v228
v_mfma_f32_16x16x32_bf16 v[64:67],a[68:71],v[228:231],v[64:67]
ds_read_b128 v[136:139],v17 offset:4096
buffer_load_dwordx2 v[120:121],v20,s[20:23],s76 offen sc1
v_mfma_f32_16x16x32_bf16 v[68:71],a[180:183],v[228:231],v[68:71]
ds_read_b128 v[224:227],v18 offset:49152
s_waitcnt lgkmcnt(8)
v_mfma_f32_16x16x32_bf16 v[64:67],a[72:75],v[232:235],v[64:67]
ds_read_b128 v[140:143],v17 offset:6144
v_min3_u32 v27,v27,v232,v236
v_mfma_f32_16x16x32_bf16 v[68:71],a[184:187],v[232:235],v[68:71]
ds_read_b128 v[228:231],v18 offset:51200
buffer_load_dwordx2 v[122:123],v24,s[20:23],s70 offen sc1
v_mfma_f32_16x16x32_bf16 v[64:67],a[76:79],v[236:239],v[64:67]
ds_read_b128 v[144:147],v17 offset:8192
ds_read_b128 v[148:151],v17 offset:10240
v_mfma_f32_16x16x32_bf16 v[68:71],a[188:191],v[236:239],v[68:71]
ds_read_b128 v[232:235],v18 offset:53248
s_waitcnt lgkmcnt(11)
v_mfma_f32_16x16x32_bf16 v[64:67],a[80:83],v[240:243],v[64:67]
ds_read_b128 v[152:155],v17 offset:12288
v_min3_u32 v27,v27,v240,v244
v_mfma_f32_16x16x32_bf16 v[68:71],a[192:195],v[240:243],v[68:71]
ds_read_b128 v[236:239],v18 offset:55296
v_mfma_f32_16x16x32_bf16 v[64:67],a[84:87],v[244:247],v[64:67]
ds_read_b128 v[156:159],v17 offset:14336
v_mfma_f32_16x16x32_bf16 v[68:71],a[196:199],v[244:247],v[68:71]
s_waitcnt lgkmcnt(10)
v_mfma_f32_16x16x32_bf16 v[64:67],a[88:91],v[248:251],v[64:67]
ds_read_b128 v[160:163],v17 offset:16384
ds_read_b128 v[164:167],v17 offset:18432
v_mfma_f32_16x16x32_bf16 v[68:71],a[200:203],v[248:251],v[68:71]
v_min3_u32 v27,v27,v248,v252
v_mfma_f32_16x16x32_bf16 v[64:67],a[92:95],v[252:255],v[64:67]
ds_read_b128 v[168:171],v17 offset:20480
v_mfma_f32_16x16x32_bf16 v[68:71],a[204:207],v[252:255],v[68:71]
s_waitcnt lgkmcnt(9)
v_mfma_f32_16x16x32_bf16 v[64:67],a[96:99],v[224:227],v[64:67]
ds_read_b128 v[172:175],v17 offset:22528
v_min3_u32 v27,v27,v224,v228
v_mfma_f32_16x16x32_bf16 v[68:71],a[208:211],v[224:227],v[68:71]
v_min3_u32 v27,v27,v226,v230
v_mfma_f32_16x16x32_bf16 v[64:67],a[100:103],v[228:231],v[64:67]
ds_read_b128 v[176:179],v17 offset:24576
ds_read_b128 v[180:183],v17 offset:26624
v_mfma_f32_16x16x32_bf16 v[68:71],a[212:215],v[228:231],v[68:71]
s_waitcnt lgkmcnt(7)
v_mfma_f32_16x16x32_bf16 v[64:67],a[104:107],v[232:235],v[64:67]
ds_read_b128 v[184:187],v17 offset:28672
v_min3_u32 v27,v27,v232,v236
v_mfma_f32_16x16x32_bf16 v[68:71],a[216:219],v[232:235],v[68:71]
v_min3_u32 v27,v27,v234,v238
v_mfma_f32_16x16x32_bf16 v[64:67],a[108:111],v[236:239],v[64:67]
ds_read_b128 v[188:191],v17 offset:30720
v_mfma_f32_16x16x32_bf16 v[68:71],a[220:223],v[236:239],v[68:71]
v_mfma_f32_16x16x32_bf16 v[72:75],a[112:115],v[128:131],0
v_cmp_eq_u32 vcc,0,v27
s_cbranch_vccnz retry_351
v_mfma_f32_16x16x32_bf16 v[76:79],a[116:119],v[132:135],0
v_min3_u32 v27,v27,v128,v132
v_mfma_f32_16x16x32_bf16 v[72:75],a[120:123],v[136:139],v[72:75]
s_waitcnt vmcnt(2)
s_barrier
ds_read_b128 v[192:195],v17 offset:32768
v_mfma_f32_16x16x32_bf16 v[76:79],a[124:127],v[140:143],v[76:79]
ds_read_b128 v[196:199],v17 offset:34816
s_waitcnt lgkmcnt(10)
v_mfma_f32_16x16x32_bf16 v[72:75],a[128:131],v[144:147],v[72:75]
ds_read_b128 v[200:203],v17 offset:36864
v_min3_u32 v27,v27,v136,v140
s_waitcnt vmcnt(0)
v_mfma_f32_16x16x32_bf16 v[76:79],a[132:135],v[148:151],v[76:79]
ds_read_b128 v[204:207],v17 offset:38912
v_min3_u32 v27,v27,v144,v148
v_and_or_b32 v64,v64,-4,s48
v_mfma_f32_16x16x32_bf16 v[72:75],a[136:139],v[152:155],v[72:75]
ds_read_b128 v[208:211],v17 offset:40960
s_add_u32 s64,s49,s34
v_mfma_f32_16x16x32_bf16 v[76:79],a[140:143],v[156:159],v[76:79]
v_min3_u32 v27,v27,v152,v156
s_waitcnt lgkmcnt(9)
v_mfma_f32_16x16x32_bf16 v[72:75],a[144:147],v[160:163],v[72:75]
ds_read_b128 v[212:215],v17 offset:43008
buffer_store_dwordx4 v[64:67],v25,s[20:23],s64 offen offset:2048 sc1
v_mfma_f32_16x16x32_bf16 v[76:79],a[148:151],v[164:167],v[76:79]
ds_read_b128 v[216:219],v17 offset:45056
v_min3_u32 v27,v27,v160,v164
v_and_or_b32 v68,v68,-4,s48
v_mfma_f32_16x16x32_bf16 v[72:75],a[152:155],v[168:171],v[72:75]
ds_read_b128 v[220:223],v17 offset:47104
s_add_u32 s64,s49,s35
v_mfma_f32_16x16x32_bf16 v[76:79],a[156:159],v[172:175],v[76:79]
ds_read_b128 v[224:227],v17 offset:49152
s_waitcnt lgkmcnt(9)
v_mfma_f32_16x16x32_bf16 v[72:75],a[160:163],v[176:179],v[72:75]
ds_read_b128 v[228:231],v17 offset:51200
v_min3_u32 v27,v27,v168,v172
v_mfma_f32_16x16x32_bf16 v[76:79],a[164:167],v[180:183],v[76:79]
v_min3_u32 v27,v27,v176,v180
buffer_store_dwordx4 v[68:71],v25,s[20:23],s64 offen offset:3072 sc1
v_mfma_f32_16x16x32_bf16 v[72:75],a[168:171],v[184:187],v[72:75]
ds_read_b128 v[232:235],v17 offset:53248
s_mov_b32 s49,0x7fff0000
v_mfma_f32_16x16x32_bf16 v[76:79],a[172:175],v[188:191],v[76:79]
ds_read_b128 v[236:239],v17 offset:55296
s_waitcnt lgkmcnt(8)
v_mfma_f32_16x16x32_bf16 v[72:75],a[176:179],v[192:195],v[72:75]
v_min3_u32 v27,v27,v184,v188
v_mfma_f32_16x16x32_bf16 v[76:79],a[180:183],v[196:199],v[76:79]
v_min3_u32 v27,v27,v192,v196
ds_bpermute_b32 v124,v41,v120
v_mfma_f32_16x16x32_bf16 v[72:75],a[184:187],v[200:203],v[72:75]
v_mfma_f32_16x16x32_bf16 v[76:79],a[188:191],v[204:207],v[76:79]
v_min3_u32 v27,v27,v200,v204
s_waitcnt lgkmcnt(5)
v_mfma_f32_16x16x32_bf16 v[72:75],a[192:195],v[208:211],v[72:75]
ds_bpermute_b32 v125,v41,v121
v_mfma_f32_16x16x32_bf16 v[76:79],a[196:199],v[212:215],v[76:79]
v_min3_u32 v27,v27,v208,v212
v_lshlrev_b32 v108,16,v122
v_mfma_f32_16x16x32_bf16 v[72:75],a[200:203],v[216:219],v[72:75]
v_mfma_f32_16x16x32_bf16 v[76:79],a[204:207],v[220:223],v[76:79]
v_min3_u32 v27,v27,v216,v220
s_waitcnt lgkmcnt(2)
v_mfma_f32_16x16x32_bf16 v[72:75],a[208:211],v[224:227],v[72:75]
v_and_b32 v109,s80,v122
v_mfma_f32_16x16x32_bf16 v[76:79],a[212:215],v[228:231],v[76:79]
v_min3_u32 v27,v27,v224,v228
v_min3_u32 v27,v27,v226,v230
v_mfma_f32_16x16x32_bf16 v[72:75],a[216:219],v[232:235],v[72:75]
v_lshlrev_b32 v110,16,v123
v_mfma_f32_16x16x32_bf16 v[76:79],a[220:223],v[236:239],v[76:79]
v_min3_u32 v27,v27,v232,v236
v_min3_u32 v27,v27,v234,v238
v_mfma_f32_16x16x32_bf16 v[80:83],a[0:3],v[128:131],0
v_cmp_eq_u32 vcc,0,v27
s_cbranch_vccnz retry_351
v_mfma_f32_16x16x32_bf16 v[84:87],a[4:7],v[132:135],0
v_and_b32 v111,s80,v123
s_waitcnt lgkmcnt(0)
v_mfma_f32_16x16x32_bf16 v[80:83],a[8:11],v[136:139],v[80:83]
v_mfma_f32_16x16x32_bf16 v[84:87],a[12:15],v[140:143],v[84:87]
v_lshlrev_b32 v104,16,v124
v_mfma_f32_16x16x32_bf16 v[80:83],a[16:19],v[144:147],v[80:83]
v_add_f32 v72,v72,v76
v_add_f32 v73,v73,v77
v_mfma_f32_16x16x32_bf16 v[84:87],a[20:23],v[148:151],v[84:87]
v_and_b32 v105,s80,v124
v_add_f32 v74,v74,v78
v_mfma_f32_16x16x32_bf16 v[80:83],a[24:27],v[152:155],v[80:83]
v_add_f32 v75,v75,v79
v_and_or_b32 v72,v72,-4,s48
v_mfma_f32_16x16x32_bf16 v[84:87],a[28:31],v[156:159],v[84:87]
v_lshlrev_b32 v106,16,v125
s_add_u32 s64,s77,s33
v_mfma_f32_16x16x32_bf16 v[80:83],a[32:35],v[160:163],v[80:83]
buffer_store_dwordx4 v[72:75],v25,s[20:23],s64 offen offset:1024 sc1
v_mfma_f32_16x16x32_bf16 v[84:87],a[36:39],v[164:167],v[84:87]
v_and_b32 v107,s80,v125
v_mfma_f32_16x16x32_bf16 v[80:83],a[40:43],v[168:171],v[80:83]
v_mfma_f32_16x16x32_bf16 v[84:87],a[44:47],v[172:175],v[84:87]
v_mfma_f32_16x16x32_bf16 v[80:83],a[48:51],v[176:179],v[80:83]
buffer_load_dwordx4 v[96:99],v26,s[20:23],s77 offen offset:2048 sc1
v_mfma_f32_16x16x32_bf16 v[84:87],a[52:55],v[180:183],v[84:87]
buffer_load_dwordx4 v[100:103],v26,s[20:23],s77 offen offset:3072 sc1
v_mfma_f32_16x16x32_bf16 v[80:83],a[56:59],v[184:187],v[80:83]
v_mfma_f32_16x16x32_bf16 v[84:87],a[60:63],v[188:191],v[84:87]
v_mfma_f32_16x16x32_bf16 v[80:83],a[64:67],v[192:195],v[80:83]
v_mfma_f32_16x16x32_bf16 v[84:87],a[68:71],v[196:199],v[84:87]
v_mfma_f32_16x16x32_bf16 v[80:83],a[72:75],v[200:203],v[80:83]
v_mfma_f32_16x16x32_bf16 v[84:87],a[76:79],v[204:207],v[84:87]
v_mfma_f32_16x16x32_bf16 v[80:83],a[80:83],v[208:211],v[80:83]
v_mfma_f32_16x16x32_bf16 v[84:87],a[84:87],v[212:215],v[84:87]
v_mfma_f32_16x16x32_bf16 v[80:83],a[88:91],v[216:219],v[80:83]
buffer_load_dwordx4 v[92:95],v26,s[20:23],s77 offen offset:1024 sc1
v_mfma_f32_16x16x32_bf16 v[84:87],a[92:95],v[220:223],v[84:87]
v_mfma_f32_16x16x32_bf16 v[80:83],a[96:99],v[224:227],v[80:83]
v_mfma_f32_16x16x32_bf16 v[84:87],a[100:103],v[228:231],v[84:87]
v_mfma_f32_16x16x32_bf16 v[80:83],a[104:107],v[232:235],v[80:83]
v_mfma_f32_16x16x32_bf16 v[84:87],a[108:111],v[236:239],v[84:87]
epi_354:
buffer_load_dword v29,v21,s[20:23],s87 offen sc1
s_nop 6
v_pk_add_f32 v[88:89],v[80:81],v[84:85]
v_pk_add_f32 v[90:91],v[82:83],v[86:87]
v_pk_add_f32 v[88:89],v[88:89],v[108:109]
v_pk_add_f32 v[90:91],v[90:91],v[110:111]
s_waitcnt vmcnt(1)
s_branch ic_364
ip_362:
buffer_load_dwordx4 v[92:95],v26,s[20:23],s77 offen offset:1024 sc1
buffer_load_dwordx4 v[96:99],v26,s[20:23],s77 offen offset:2048 sc1
buffer_load_dwordx4 v[100:103],v26,s[20:23],s77 offen offset:3072 sc1
s_waitcnt vmcnt(0)
ic_364:
v_bitop3_b32 v22,v92,v96,v100 bitop3:0x80
v_and_b32 v22,s48,v22
v_cmp_eq_u32 vcc,0,v22
s_cbranch_vccz ik_363
s_sub_u32 s90,s90,1
s_cmp_gt_i32 s90,0
s_cbranch_scc1 ip_362
ik_363:
s_cmp_lg_u32 s71,65
s_cbranch_scc1 nl_365
buffer_load_dwordx4 v[132:135],v26,s[20:23],s40 offen offset:1024 sc1
buffer_load_dwordx4 v[136:139],v26,s[20:23],s40 offen offset:2048 sc1
buffer_load_dwordx4 v[140:143],v26,s[20:23],s40 offen offset:3072 sc1
nl_365:
v_pk_add_f32 v[88:89],v[88:89],v[92:93]
v_pk_add_f32 v[96:97],v[96:97],v[100:101]
v_pk_add_f32 v[90:91],v[90:91],v[94:95]
v_pk_add_f32 v[98:99],v[98:99],v[102:103]
v_pk_add_f32 v[88:89],v[88:89],v[96:97]
v_pk_add_f32 v[90:91],v[90:91],v[98:99]
v_pk_fma_f32 v[88:89],v[88:89],v[52:53],v[104:105]
v_pk_fma_f32 v[90:91],v[90:91],v[54:55],v[106:107]
v_cvt_pk_bf16_f32 v88,v88,v89
v_cvt_pk_bf16_f32 v89,v90,v91
ds_bpermute_b32 v88,v40,v88
ds_bpermute_b32 v89,v40,v89
v_xor_b32 v18,0x10000,v18
s_xor_b32 s49,s77,524288
s_cselect_b32 s64,0,3
s_xor_b32 s48,s48,s64
s_cmp_eq_u32 s71,63
s_cselect_b32 s64,0,0x2000
s_cselect_b32 s66,2,1
s_cmp_eq_u32 s71,64
s_cselect_b32 s66,-1,s66
v_xor_b32 v20,s64,v20
s_lshl_b32 s64,s66,21
s_add_u32 s76,s76,s64
s_lshl_b32 s66,s66,16
s_waitcnt lgkmcnt(0)
s_mov_b64 exec,s[84:85]
buffer_store_dwordx2 v[88:89],v19,s[36:39],s78 offen
s_mov_b64 exec,-1
s_mov_b64 s[84:85],-1
s_mov_b32 s77,s49
s_add_u32 s78,s78,s66
next_361:
v_xor_b32 v17,0x10000,v17
s_xor_b32 s72,s72,0x10000
s_add_u32 s70,s70,2097152
s_xor_b32 s70,s70,0x2000
s_add_u32 s71,s71,1
s_cmp_le_u32 s71,s57
s_cbranch_scc1 seg_352
s_cmp_lg_u32 s43,0
s_cbranch_scc1 hn_369
s_waitcnt vmcnt(1)
s_branch hc_368
hp_366:
buffer_load_dwordx4 v[132:135],v26,s[20:23],s40 offen offset:1024 sc1
buffer_load_dwordx4 v[136:139],v26,s[20:23],s40 offen offset:2048 sc1
buffer_load_dwordx4 v[140:143],v26,s[20:23],s40 offen offset:3072 sc1
s_waitcnt vmcnt(0)
hc_368:
v_bitop3_b32 v22,v132,v136,v140 bitop3:0x80
v_and_b32 v22,s60,v22
v_cmp_eq_u32 vcc,0,v22
s_cbranch_vccz hk_367
s_sub_u32 s90,s90,1
s_cmp_gt_i32 s90,0
s_cbranch_scc1 hp_366
hk_367:
v_pk_add_f32 v[112:113],v[112:113],v[132:133]
v_pk_add_f32 v[136:137],v[136:137],v[140:141]
v_pk_add_f32 v[114:115],v[114:115],v[134:135]
v_pk_add_f32 v[138:139],v[138:139],v[142:143]
v_pk_add_f32 v[112:113],v[112:113],v[136:137]
v_pk_add_f32 v[114:115],v[114:115],v[138:139]
v_pk_fma_f32 v[112:113],v[112:113],v[52:53],v[116:117]
v_pk_fma_f32 v[114:115],v[114:115],v[54:55],v[118:119]
v_cvt_pk_bf16_f32 v112,v112,v113
v_cvt_pk_bf16_f32 v113,v114,v115
ds_bpermute_b32 v112,v40,v112
ds_bpermute_b32 v113,v40,v113
s_mov_b32 s64,4194304
s_waitcnt lgkmcnt(0)
buffer_store_dwordx2 v[112:113],v19,s[36:39],s64 offen
hn_369:
s_endpgm
retry_351:
s_sub_u32 s90,s90,64
s_cmp_lt_i32 s90,0
s_cbranch_scc1 giveup_197
s_mov_b32 s83,1
s_waitcnt vmcnt(0) lgkmcnt(0)
s_barrier
s_branch seg_352
half_360:
s_cmp_eq_u32 s43,0
s_cbranch_scc1 hown_370
s_mov_b64 exec,s[52:53]
s_xor_b32 m0,s91,0
s_add_u32 s65,s94,0
buffer_load_dwordx4 v16,s[20:23],s65 offen offset:0 sc1 lds
buffer_load_dwordx4 v16,s[20:23],s65 offen offset:2048 sc1 lds
s_xor_b32 m0,s91,16384
s_add_u32 s65,s94,32768
buffer_load_dwordx4 v16,s[20:23],s65 offen offset:0 sc1 lds
buffer_load_dwordx4 v16,s[20:23],s65 offen offset:2048 sc1 lds
s_xor_b32 m0,s91,32768
s_add_u32 s65,s94,65536
buffer_load_dwordx4 v16,s[20:23],s65 offen offset:0 sc1 lds
buffer_load_dwordx4 v16,s[20:23],s65 offen offset:2048 sc1 lds
s_xor_b32 m0,s91,49152
s_add_u32 s65,s94,s86
buffer_load_dwordx4 v16,s[20:23],s65 offen offset:0 sc1 lds
buffer_load_dwordx4 v16,s[20:23],s65 offen offset:2048 sc1 lds
s_mov_b64 exec,-1
h2a_371:
s_waitcnt vmcnt(6)
s_barrier
ds_read_b128 v[224:227],v18 offset:0
ds_read_b128 v[228:231],v18 offset:2048
ds_read_b128 v[232:235],v18 offset:4096
ds_read_b128 v[236:239],v18 offset:6144
ds_read_b128 v[240:243],v18 offset:8192
ds_read_b128 v[244:247],v18 offset:10240
ds_read_b128 v[248:251],v18 offset:12288
s_waitcnt lgkmcnt(5)
v_mfma_f32_16x16x32_bf16 v[64:67],a[0:3],v[224:227],0
v_min_u32 v27,v224,v228
v_mfma_f32_16x16x32_bf16 v[68:71],a[112:115],v[224:227],0
ds_read_b128 v[252:255],v18 offset:14336
v_mfma_f32_16x16x32_bf16 v[64:67],a[4:7],v[228:231],v[64:67]
v_mfma_f32_16x16x32_bf16 v[68:71],a[116:119],v[228:231],v[68:71]
s_waitcnt vmcnt(4)
s_barrier
ds_read_b128 v[224:227],v18 offset:16384
s_waitcnt lgkmcnt(5)
v_mfma_f32_16x16x32_bf16 v[64:67],a[8:11],v[232:235],v[64:67]
v_min3_u32 v27,v27,v232,v236
v_mfma_f32_16x16x32_bf16 v[68:71],a[120:123],v[232:235],v[68:71]
ds_read_b128 v[228:231],v18 offset:18432
v_mfma_f32_16x16x32_bf16 v[64:67],a[12:15],v[236:239],v[64:67]
v_mfma_f32_16x16x32_bf16 v[68:71],a[124:127],v[236:239],v[68:71]
ds_read_b128 v[232:235],v18 offset:20480
s_waitcnt lgkmcnt(5)
v_mfma_f32_16x16x32_bf16 v[64:67],a[16:19],v[240:243],v[64:67]
v_min3_u32 v27,v27,v240,v244
v_mfma_f32_16x16x32_bf16 v[68:71],a[128:131],v[240:243],v[68:71]
ds_read_b128 v[236:239],v18 offset:22528
v_mfma_f32_16x16x32_bf16 v[64:67],a[20:23],v[244:247],v[64:67]
v_mfma_f32_16x16x32_bf16 v[68:71],a[132:135],v[244:247],v[68:71]
ds_read_b128 v[240:243],v18 offset:24576
s_waitcnt lgkmcnt(5)
v_mfma_f32_16x16x32_bf16 v[64:67],a[24:27],v[248:251],v[64:67]
v_min3_u32 v27,v27,v248,v252
v_mfma_f32_16x16x32_bf16 v[68:71],a[136:139],v[248:251],v[68:71]
ds_read_b128 v[244:247],v18 offset:26624
v_mfma_f32_16x16x32_bf16 v[64:67],a[28:31],v[252:255],v[64:67]
v_mfma_f32_16x16x32_bf16 v[68:71],a[140:143],v[252:255],v[68:71]
ds_read_b128 v[248:251],v18 offset:28672
s_waitcnt lgkmcnt(5)
v_mfma_f32_16x16x32_bf16 v[64:67],a[32:35],v[224:227],v[64:67]
v_min3_u32 v27,v27,v224,v228
v_mfma_f32_16x16x32_bf16 v[68:71],a[144:147],v[224:227],v[68:71]
ds_read_b128 v[252:255],v18 offset:30720
v_mfma_f32_16x16x32_bf16 v[64:67],a[36:39],v[228:231],v[64:67]
v_mfma_f32_16x16x32_bf16 v[68:71],a[148:151],v[228:231],v[68:71]
s_waitcnt vmcnt(0)
s_barrier
ds_read_b128 v[224:227],v18 offset:32768
s_waitcnt lgkmcnt(5)
v_mfma_f32_16x16x32_bf16 v[64:67],a[40:43],v[232:235],v[64:67]
v_min3_u32 v27,v27,v232,v236
v_mfma_f32_16x16x32_bf16 v[68:71],a[152:155],v[232:235],v[68:71]
ds_read_b128 v[228:231],v18 offset:34816
v_mfma_f32_16x16x32_bf16 v[64:67],a[44:47],v[236:239],v[64:67]
v_mfma_f32_16x16x32_bf16 v[68:71],a[156:159],v[236:239],v[68:71]
ds_read_b128 v[232:235],v18 offset:36864
s_waitcnt lgkmcnt(5)
v_mfma_f32_16x16x32_bf16 v[64:67],a[48:51],v[240:243],v[64:67]
v_min3_u32 v27,v27,v240,v244
v_mfma_f32_16x16x32_bf16 v[68:71],a[160:163],v[240:243],v[68:71]
ds_read_b128 v[236:239],v18 offset:38912
v_mfma_f32_16x16x32_bf16 v[64:67],a[52:55],v[244:247],v[64:67]
v_mfma_f32_16x16x32_bf16 v[68:71],a[164:167],v[244:247],v[68:71]
ds_read_b128 v[240:243],v18 offset:40960
s_waitcnt lgkmcnt(5)
v_mfma_f32_16x16x32_bf16 v[64:67],a[56:59],v[248:251],v[64:67]
v_min3_u32 v27,v27,v248,v252
v_mfma_f32_16x16x32_bf16 v[68:71],a[168:171],v[248:251],v[68:71]
ds_read_b128 v[244:247],v18 offset:43008
v_mfma_f32_16x16x32_bf16 v[64:67],a[60:63],v[252:255],v[64:67]
v_mfma_f32_16x16x32_bf16 v[68:71],a[172:175],v[252:255],v[68:71]
ds_read_b128 v[248:251],v18 offset:45056
s_waitcnt lgkmcnt(5)
v_mfma_f32_16x16x32_bf16 v[64:67],a[64:67],v[224:227],v[64:67]
v_min3_u32 v27,v27,v224,v228
v_mfma_f32_16x16x32_bf16 v[68:71],a[176:179],v[224:227],v[68:71]
ds_read_b128 v[252:255],v18 offset:47104
v_mfma_f32_16x16x32_bf16 v[64:67],a[68:71],v[228:231],v[64:67]
v_mfma_f32_16x16x32_bf16 v[68:71],a[180:183],v[228:231],v[68:71]
ds_read_b128 v[224:227],v18 offset:49152
s_waitcnt lgkmcnt(5)
v_mfma_f32_16x16x32_bf16 v[64:67],a[72:75],v[232:235],v[64:67]
v_min3_u32 v27,v27,v232,v236
v_mfma_f32_16x16x32_bf16 v[68:71],a[184:187],v[232:235],v[68:71]
ds_read_b128 v[228:231],v18 offset:51200
v_mfma_f32_16x16x32_bf16 v[64:67],a[76:79],v[236:239],v[64:67]
v_mfma_f32_16x16x32_bf16 v[68:71],a[188:191],v[236:239],v[68:71]
ds_read_b128 v[232:235],v18 offset:53248
s_waitcnt lgkmcnt(5)
v_mfma_f32_16x16x32_bf16 v[64:67],a[80:83],v[240:243],v[64:67]
v_min3_u32 v27,v27,v240,v244
v_mfma_f32_16x16x32_bf16 v[68:71],a[192:195],v[240:243],v[68:71]
ds_read_b128 v[236:239],v18 offset:55296
v_mfma_f32_16x16x32_bf16 v[64:67],a[84:87],v[244:247],v[64:67]
v_mfma_f32_16x16x32_bf16 v[68:71],a[196:199],v[244:247],v[68:71]
s_waitcnt lgkmcnt(4)
v_mfma_f32_16x16x32_bf16 v[64:67],a[88:91],v[248:251],v[64:67]
v_min3_u32 v27,v27,v248,v252
v_mfma_f32_16x16x32_bf16 v[68:71],a[200:203],v[248:251],v[68:71]
v_mfma_f32_16x16x32_bf16 v[64:67],a[92:95],v[252:255],v[64:67]
v_mfma_f32_16x16x32_bf16 v[68:71],a[204:207],v[252:255],v[68:71]
s_waitcnt lgkmcnt(2)
v_mfma_f32_16x16x32_bf16 v[64:67],a[96:99],v[224:227],v[64:67]
v_min3_u32 v27,v27,v224,v228
v_min3_u32 v27,v27,v226,v230
v_mfma_f32_16x16x32_bf16 v[68:71],a[208:211],v[224:227],v[68:71]
v_mfma_f32_16x16x32_bf16 v[64:67],a[100:103],v[228:231],v[64:67]
v_mfma_f32_16x16x32_bf16 v[68:71],a[212:215],v[228:231],v[68:71]
s_waitcnt lgkmcnt(0)
v_mfma_f32_16x16x32_bf16 v[64:67],a[104:107],v[232:235],v[64:67]
v_min3_u32 v27,v27,v232,v236
v_min3_u32 v27,v27,v234,v238
v_mfma_f32_16x16x32_bf16 v[68:71],a[216:219],v[232:235],v[68:71]
v_mfma_f32_16x16x32_bf16 v[64:67],a[108:111],v[236:239],v[64:67]
v_mfma_f32_16x16x32_bf16 v[68:71],a[220:223],v[236:239],v[68:71]
v_cmp_eq_u32 vcc,0,v27
s_and_b64 vcc,vcc,s[52:53]
s_cbranch_vccnz retry_351
buffer_load_dword v29,v21,s[20:23],s87 offen sc1
s_mov_b32 s40,0x7fff0000
s_nop 5
v_and_or_b32 v64,v64,-4,s48
s_add_u32 s64,s77,s34
buffer_store_dwordx4 v[64:67],v25,s[20:23],s64 offen offset:2048 sc1
v_and_or_b32 v68,v68,-4,s48
s_add_u32 s64,s77,s35
buffer_store_dwordx4 v[68:71],v25,s[20:23],s64 offen offset:3072 sc1
hjoin_373:
v_xor_b32 v18,0x10000,v18
s_xor_b32 s49,s77,524288
s_cselect_b32 s64,0,3
s_xor_b32 s48,s48,s64
v_xor_b32 v20,0x2000,v20
s_sub_u32 s76,s76,2097152
s_mov_b32 s77,s49
s_sub_u32 s78,s78,65536
s_branch next_361
half2_357:
s_cmp_eq_u32 s43,0
s_cbranch_scc1 h2b_372
s_branch h2a_371
hown_370:
s_mov_b64 exec,s[52:53]
s_xor_b32 m0,s91,1024
s_add_u32 s65,s95,0
buffer_load_dwordx4 v16,s[20:23],s65 offen offset:0 sc1 lds
buffer_load_dwordx4 v16,s[20:23],s65 offen offset:2048 sc1 lds
s_xor_b32 m0,s91,17408
s_add_u32 s65,s95,32768
buffer_load_dwordx4 v16,s[20:23],s65 offen offset:0 sc1 lds
buffer_load_dwordx4 v16,s[20:23],s65 offen offset:2048 sc1 lds
s_xor_b32 m0,s91,33792
s_add_u32 s65,s95,65536
buffer_load_dwordx4 v16,s[20:23],s65 offen offset:0 sc1 lds
buffer_load_dwordx4 v16,s[20:23],s65 offen offset:2048 sc1 lds
s_xor_b32 m0,s91,50176
s_add_u32 s65,s95,s86
buffer_load_dwordx4 v16,s[20:23],s65 offen offset:0 sc1 lds
buffer_load_dwordx4 v16,s[20:23],s65 offen offset:2048 sc1 lds
s_mov_b64 exec,-1
h2b_372:
buffer_load_dwordx2 v[120:121],v20,s[20:23],s76 offen sc1
buffer_load_dwordx2 v[122:123],v24,s[20:23],s70 offen sc1
s_waitcnt vmcnt(8)
s_barrier
ds_read_b128 v[128:131],v17 offset:0
ds_read_b128 v[132:135],v17 offset:2048
ds_read_b128 v[136:139],v17 offset:4096
ds_read_b128 v[140:143],v17 offset:6144
ds_read_b128 v[144:147],v17 offset:8192
ds_read_b128 v[148:151],v17 offset:10240
ds_read_b128 v[152:155],v17 offset:12288
s_waitcnt lgkmcnt(5)
v_mfma_f32_16x16x32_bf16 v[72:75],a[112:115],v[128:131],0
v_min_u32 v27,v128,v132
v_mfma_f32_16x16x32_bf16 v[80:83],a[0:3],v[128:131],0
ds_read_b128 v[156:159],v17 offset:14336
v_mfma_f32_16x16x32_bf16 v[76:79],a[116:119],v[132:135],0
v_mfma_f32_16x16x32_bf16 v[84:87],a[4:7],v[132:135],0
s_waitcnt vmcnt(6)
s_barrier
ds_read_b128 v[160:163],v17 offset:16384
s_waitcnt lgkmcnt(5)
v_mfma_f32_16x16x32_bf16 v[72:75],a[120:123],v[136:139],v[72:75]
v_min3_u32 v27,v27,v136,v140
v_mfma_f32_16x16x32_bf16 v[80:83],a[8:11],v[136:139],v[80:83]
ds_read_b128 v[164:167],v17 offset:18432
v_mfma_f32_16x16x32_bf16 v[76:79],a[124:127],v[140:143],v[76:79]
v_mfma_f32_16x16x32_bf16 v[84:87],a[12:15],v[140:143],v[84:87]
ds_read_b128 v[168:171],v17 offset:20480
s_waitcnt lgkmcnt(5)
v_mfma_f32_16x16x32_bf16 v[72:75],a[128:131],v[144:147],v[72:75]
v_min3_u32 v27,v27,v144,v148
v_mfma_f32_16x16x32_bf16 v[80:83],a[16:19],v[144:147],v[80:83]
ds_read_b128 v[172:175],v17 offset:22528
v_mfma_f32_16x16x32_bf16 v[76:79],a[132:135],v[148:151],v[76:79]
v_mfma_f32_16x16x32_bf16 v[84:87],a[20:23],v[148:151],v[84:87]
ds_read_b128 v[176:179],v17 offset:24576
s_waitcnt lgkmcnt(5)
v_mfma_f32_16x16x32_bf16 v[72:75],a[136:139],v[152:155],v[72:75]
v_min3_u32 v27,v27,v152,v156
v_mfma_f32_16x16x32_bf16 v[80:83],a[24:27],v[152:155],v[80:83]
ds_read_b128 v[180:183],v17 offset:26624
v_mfma_f32_16x16x32_bf16 v[76:79],a[140:143],v[156:159],v[76:79]
v_mfma_f32_16x16x32_bf16 v[84:87],a[28:31],v[156:159],v[84:87]
ds_read_b128 v[184:187],v17 offset:28672
s_waitcnt lgkmcnt(5)
v_mfma_f32_16x16x32_bf16 v[72:75],a[144:147],v[160:163],v[72:75]
v_min3_u32 v27,v27,v160,v164
v_mfma_f32_16x16x32_bf16 v[80:83],a[32:35],v[160:163],v[80:83]
ds_read_b128 v[188:191],v17 offset:30720
v_mfma_f32_16x16x32_bf16 v[76:79],a[148:151],v[164:167],v[76:79]
v_mfma_f32_16x16x32_bf16 v[84:87],a[36:39],v[164:167],v[84:87]
s_waitcnt vmcnt(2)
s_barrier
ds_read_b128 v[192:195],v17 offset:32768
s_waitcnt lgkmcnt(5)
v_mfma_f32_16x16x32_bf16 v[72:75],a[152:155],v[168:171],v[72:75]
v_min3_u32 v27,v27,v168,v172
v_mfma_f32_16x16x32_bf16 v[80:83],a[40:43],v[168:171],v[80:83]
ds_read_b128 v[196:199],v17 offset:34816
v_mfma_f32_16x16x32_bf16 v[76:79],a[156:159],v[172:175],v[76:79]
v_mfma_f32_16x16x32_bf16 v[84:87],a[44:47],v[172:175],v[84:87]
ds_read_b128 v[200:203],v17 offset:36864
s_waitcnt lgkmcnt(5)
v_mfma_f32_16x16x32_bf16 v[72:75],a[160:163],v[176:179],v[72:75]
v_min3_u32 v27,v27,v176,v180
v_mfma_f32_16x16x32_bf16 v[80:83],a[48:51],v[176:179],v[80:83]
ds_read_b128 v[204:207],v17 offset:38912
v_mfma_f32_16x16x32_bf16 v[76:79],a[164:167],v[180:183],v[76:79]
v_mfma_f32_16x16x32_bf16 v[84:87],a[52:55],v[180:183],v[84:87]
ds_read_b128 v[208:211],v17 offset:40960
s_waitcnt lgkmcnt(5)
v_mfma_f32_16x16x32_bf16 v[72:75],a[168:171],v[184:187],v[72:75]
v_min3_u32 v27,v27,v184,v188
v_mfma_f32_16x16x32_bf16 v[80:83],a[56:59],v[184:187],v[80:83]
ds_read_b128 v[212:215],v17 offset:43008
v_mfma_f32_16x16x32_bf16 v[76:79],a[172:175],v[188:191],v[76:79]
v_mfma_f32_16x16x32_bf16 v[84:87],a[60:63],v[188:191],v[84:87]
ds_read_b128 v[216:219],v17 offset:45056
s_waitcnt lgkmcnt(5)
v_mfma_f32_16x16x32_bf16 v[72:75],a[176:179],v[192:195],v[72:75]
v_min3_u32 v27,v27,v192,v196
s_waitcnt vmcnt(0)
v_mfma_f32_16x16x32_bf16 v[80:83],a[64:67],v[192:195],v[80:83]
ds_read_b128 v[220:223],v17 offset:47104
ds_bpermute_b32 v124,v41,v120
v_mfma_f32_16x16x32_bf16 v[76:79],a[180:183],v[196:199],v[76:79]
ds_bpermute_b32 v125,v41,v121
v_lshlrev_b32 v108,16,v122
v_mfma_f32_16x16x32_bf16 v[84:87],a[68:71],v[196:199],v[84:87]
ds_read_b128 v[224:227],v17 offset:49152
s_waitcnt lgkmcnt(7)
v_mfma_f32_16x16x32_bf16 v[72:75],a[184:187],v[200:203],v[72:75]
v_min3_u32 v27,v27,v200,v204
v_and_b32 v109,s80,v122
v_mfma_f32_16x16x32_bf16 v[80:83],a[72:75],v[200:203],v[80:83]
ds_read_b128 v[228:231],v17 offset:51200
v_lshlrev_b32 v110,16,v123
v_mfma_f32_16x16x32_bf16 v[76:79],a[188:191],v[204:207],v[76:79]
v_and_b32 v111,s80,v123
s_waitcnt lgkmcnt(2)
v_mfma_f32_16x16x32_bf16 v[84:87],a[76:79],v[204:207],v[84:87]
ds_read_b128 v[232:235],v17 offset:53248
v_mfma_f32_16x16x32_bf16 v[72:75],a[192:195],v[208:211],v[72:75]
v_min3_u32 v27,v27,v208,v212
v_lshlrev_b32 v104,16,v124
v_mfma_f32_16x16x32_bf16 v[80:83],a[80:83],v[208:211],v[80:83]
ds_read_b128 v[236:239],v17 offset:55296
v_and_b32 v105,s80,v124
v_mfma_f32_16x16x32_bf16 v[76:79],a[196:199],v[212:215],v[76:79]
v_lshlrev_b32 v106,16,v125
v_and_b32 v107,s80,v125
v_mfma_f32_16x16x32_bf16 v[84:87],a[84:87],v[212:215],v[84:87]
v_mfma_f32_16x16x32_bf16 v[72:75],a[200:203],v[216:219],v[72:75]
v_min3_u32 v27,v27,v216,v220
v_mfma_f32_16x16x32_bf16 v[80:83],a[88:91],v[216:219],v[80:83]
v_mfma_f32_16x16x32_bf16 v[76:79],a[204:207],v[220:223],v[76:79]
v_mfma_f32_16x16x32_bf16 v[84:87],a[92:95],v[220:223],v[84:87]
s_waitcnt lgkmcnt(2)
v_mfma_f32_16x16x32_bf16 v[72:75],a[208:211],v[224:227],v[72:75]
v_min3_u32 v27,v27,v224,v228
v_min3_u32 v27,v27,v226,v230
v_mfma_f32_16x16x32_bf16 v[80:83],a[96:99],v[224:227],v[80:83]
v_mfma_f32_16x16x32_bf16 v[76:79],a[212:215],v[228:231],v[76:79]
v_mfma_f32_16x16x32_bf16 v[84:87],a[100:103],v[228:231],v[84:87]
s_waitcnt lgkmcnt(0)
v_mfma_f32_16x16x32_bf16 v[72:75],a[216:219],v[232:235],v[72:75]
v_min3_u32 v27,v27,v232,v236
v_min3_u32 v27,v27,v234,v238
v_mfma_f32_16x16x32_bf16 v[80:83],a[104:107],v[232:235],v[80:83]
v_mfma_f32_16x16x32_bf16 v[76:79],a[220:223],v[236:239],v[76:79]
v_mfma_f32_16x16x32_bf16 v[84:87],a[108:111],v[236:239],v[84:87]
v_cmp_eq_u32 vcc,0,v27
s_and_b64 vcc,vcc,s[52:53]
s_cbranch_vccnz retry_351
buffer_load_dword v29,v21,s[20:23],s87 offen sc1
s_nop 6
v_add_f32 v72,v72,v76
v_add_f32 v73,v73,v77
v_add_f32 v74,v74,v78
v_add_f32 v75,v75,v79
v_and_or_b32 v72,v72,-4,s48
s_add_u32 s64,s77,s33
buffer_store_dwordx4 v[72:75],v25,s[20:23],s64 offen offset:1024 sc1
v_pk_add_f32 v[112:113],v[80:81],v[84:85]
v_pk_add_f32 v[112:113],v[112:113],v[108:109]
v_pk_add_f32 v[114:115],v[82:83],v[86:87]
v_pk_add_f32 v[114:115],v[114:115],v[110:111]
v_mov_b32 v116,v104
v_mov_b32 v117,v105
v_mov_b32 v118,v106
v_mov_b32 v119,v107
s_mov_b32 s40,s77
s_mov_b32 s60,s48
s_branch hjoin_373
r_w3_215:
s_load_dwordx2 s[4:5],s[0:1],80
s_mul_i32 s66,s59,224
s_lshl_b32 s67,s50,1
s_waitcnt lgkmcnt(0)
s_mov_b32 s32,s4
s_and_b32 s33,s5,0xffff
s_mov_b32 s34,0x700000
s_mov_b32 s35,0x20000
v_lshrrev_b32 v5,2,v3
v_lshl_add_u32 v5,v4,2,v5
v_and_b32 v6,3,v3
v_lshlrev_b32 v6,3,v6
v_lshl_add_u32 v6,v5,8,v6
v_and_b32 v5,7,v5
v_xor_b32 v5,s67,v5
v_lshl_add_u32 v12,v5,5,v6
v_xor_b32 v13,32,v12
v_and_b32 v5,15,v1
v_and_b32 v6,3,v4
v_lshlrev_b32 v6,1,v6
v_xor_b32 v5,v5,v6
v_mul_u32_u24 v6,7168,v4
v_xor_b32 v7,0,v5
v_lshl_add_u32 v8,v7,4,v6
v_xor_b32 v7,8,v5
v_lshl_add_u32 v9,v7,4,v6
s_mul_i32 s74,s50,458752
s_add_u32 s74,s74,s66
s_lshl_b32 s75,s50,14
s_mul_i32 s76,s50,229376
s_add_u32 s76,s76,s66
s_lshl_b32 s77,s50,13
s_add_u32 s64,s74,0
s_add_u32 m0,s75,0
s_nop 0
buffer_load_dwordx4 v8,s[32:35],s64 offen nt lds
s_add_u32 s64,s74,28672
s_add_u32 m0,s75,1024
s_nop 0
buffer_load_dwordx4 v9,s[32:35],s64 offen nt lds
s_add_u32 s64,s74,57344
s_add_u32 m0,s75,2048
s_nop 0
buffer_load_dwordx4 v8,s[32:35],s64 offen nt lds
s_add_u32 s64,s74,86016
s_add_u32 m0,s75,3072
s_nop 0
buffer_load_dwordx4 v9,s[32:35],s64 offen nt lds
s_add_u32 s64,s74,114688
s_add_u32 m0,s75,4096
s_nop 0
buffer_load_dwordx4 v8,s[32:35],s64 offen nt lds
s_add_u32 s64,s74,143360
s_add_u32 m0,s75,5120
s_nop 0
buffer_load_dwordx4 v9,s[32:35],s64 offen nt lds
s_add_u32 s64,s74,172032
s_add_u32 m0,s75,6144
s_nop 0
buffer_load_dwordx4 v8,s[32:35],s64 offen nt lds
s_add_u32 s64,s74,200704
s_add_u32 m0,s75,7168
s_nop 0
buffer_load_dwordx4 v9,s[32:35],s64 offen nt lds
s_add_u32 s64,s74,229376
s_add_u32 m0,s75,8192
s_nop 0
buffer_load_dwordx4 v8,s[32:35],s64 offen nt lds
s_add_u32 s64,s74,258048
s_add_u32 m0,s75,9216
s_nop 0
buffer_load_dwordx4 v9,s[32:35],s64 offen nt lds
s_add_u32 s64,s74,286720
s_add_u32 m0,s75,10240
s_nop 0
buffer_load_dwordx4 v8,s[32:35],s64 offen nt lds
s_add_u32 s64,s74,315392
s_add_u32 m0,s75,11264
s_nop 0
buffer_load_dwordx4 v9,s[32:35],s64 offen nt lds
s_add_u32 s64,s74,344064
s_add_u32 m0,s75,12288
s_nop 0
buffer_load_dwordx4 v8,s[32:35],s64 offen nt lds
s_add_u32 s64,s74,372736
s_add_u32 m0,s75,13312
s_nop 0
buffer_load_dwordx4 v9,s[32:35],s64 offen nt lds
s_add_u32 s64,s74,401408
s_add_u32 m0,s75,14336
s_nop 0
buffer_load_dwordx4 v8,s[32:35],s64 offen nt lds
s_add_u32 s64,s74,430080
s_add_u32 m0,s75,15360
s_nop 0
buffer_load_dwordx4 v9,s[32:35],s64 offen nt lds
s_add_u32 s64,s74,1835008
s_add_u32 m0,s75,65536
s_nop 0
buffer_load_dwordx4 v8,s[32:35],s64 offen nt lds
s_add_u32 s64,s74,1863680
s_add_u32 m0,s75,66560
s_nop 0
buffer_load_dwordx4 v9,s[32:35],s64 offen nt lds
s_add_u32 s64,s74,1892352
s_add_u32 m0,s75,67584
s_nop 0
buffer_load_dwordx4 v8,s[32:35],s64 offen nt lds
s_add_u32 s64,s74,1921024
s_add_u32 m0,s75,68608
s_nop 0
buffer_load_dwordx4 v9,s[32:35],s64 offen nt lds
s_add_u32 s64,s74,1949696
s_add_u32 m0,s75,69632
s_nop 0
buffer_load_dwordx4 v8,s[32:35],s64 offen nt lds
s_add_u32 s64,s74,1978368
s_add_u32 m0,s75,70656
s_nop 0
buffer_load_dwordx4 v9,s[32:35],s64 offen nt lds
s_add_u32 s64,s74,2007040
s_add_u32 m0,s75,71680
s_nop 0
buffer_load_dwordx4 v8,s[32:35],s64 offen nt lds
s_add_u32 s64,s74,2035712
s_add_u32 m0,s75,72704
s_nop 0
buffer_load_dwordx4 v9,s[32:35],s64 offen nt lds
s_add_u32 s64,s74,2064384
s_add_u32 m0,s75,73728
s_nop 0
buffer_load_dwordx4 v8,s[32:35],s64 offen nt lds
s_add_u32 s64,s74,2093056
s_add_u32 m0,s75,74752
s_nop 0
buffer_load_dwordx4 v9,s[32:35],s64 offen nt lds
s_add_u32 s64,s74,2121728
s_add_u32 m0,s75,75776
s_nop 0
buffer_load_dwordx4 v8,s[32:35],s64 offen nt lds
s_add_u32 s64,s74,2150400
s_add_u32 m0,s75,76800
s_nop 0
buffer_load_dwordx4 v9,s[32:35],s64 offen nt lds
s_add_u32 s64,s74,2179072
s_add_u32 m0,s75,77824
s_nop 0
buffer_load_dwordx4 v8,s[32:35],s64 offen nt lds
s_add_u32 s64,s74,2207744
s_add_u32 m0,s75,78848
s_nop 0
buffer_load_dwordx4 v9,s[32:35],s64 offen nt lds
s_add_u32 s64,s74,2236416
s_add_u32 m0,s75,79872
s_nop 0
buffer_load_dwordx4 v8,s[32:35],s64 offen nt lds
s_add_u32 s64,s74,2265088
s_add_u32 m0,s75,80896
s_nop 0
buffer_load_dwordx4 v9,s[32:35],s64 offen nt lds
s_waitcnt vmcnt(16)
s_barrier
ds_read_b64_tr_b16 a[0:1],v12 offset:0
ds_read_b64_tr_b16 a[128:129],v13 offset:0
ds_read_b64_tr_b16 a[2:3],v12 offset:4096
ds_read_b64_tr_b16 a[130:131],v13 offset:4096
ds_read_b64_tr_b16 a[4:5],v12 offset:8192
ds_read_b64_tr_b16 a[132:133],v13 offset:8192
ds_read_b64_tr_b16 a[6:7],v12 offset:12288
ds_read_b64_tr_b16 a[134:135],v13 offset:12288
s_waitcnt lgkmcnt(4)
ds_read_b64_tr_b16 a[8:9],v12 offset:16384
ds_read_b64_tr_b16 a[136:137],v13 offset:16384
ds_read_b64_tr_b16 a[10:11],v12 offset:20480
ds_read_b64_tr_b16 a[138:139],v13 offset:20480
ds_read_b64_tr_b16 a[12:13],v12 offset:24576
ds_read_b64_tr_b16 a[140:141],v13 offset:24576
ds_read_b64_tr_b16 a[14:15],v12 offset:28672
ds_read_b64_tr_b16 a[142:143],v13 offset:28672
s_waitcnt lgkmcnt(4)
ds_read_b64_tr_b16 a[16:17],v12 offset:32768
ds_read_b64_tr_b16 a[144:145],v13 offset:32768
ds_read_b64_tr_b16 a[18:19],v12 offset:36864
ds_read_b64_tr_b16 a[146:147],v13 offset:36864
ds_read_b64_tr_b16 a[20:21],v12 offset:40960
ds_read_b64_tr_b16 a[148:149],v13 offset:40960
ds_read_b64_tr_b16 a[22:23],v12 offset:45056
ds_read_b64_tr_b16 a[150:151],v13 offset:45056
s_waitcnt lgkmcnt(4)
ds_read_b64_tr_b16 a[24:25],v12 offset:49152
ds_read_b64_tr_b16 a[152:153],v13 offset:49152
ds_read_b64_tr_b16 a[26:27],v12 offset:53248
ds_read_b64_tr_b16 a[154:155],v13 offset:53248
ds_read_b64_tr_b16 a[28:29],v12 offset:57344
ds_read_b64_tr_b16 a[156:157],v13 offset:57344
ds_read_b64_tr_b16 a[30:31],v12 offset:61440
ds_read_b64_tr_b16 a[158:159],v13 offset:61440
s_waitcnt lgkmcnt(4)
v_xor_b32 v12,0x10000,v12
v_xor_b32 v13,0x10000,v13
s_waitcnt lgkmcnt(0)
s_barrier
s_add_u32 s64,s74,3670016
s_add_u32 m0,s75,0
s_nop 0
buffer_load_dwordx4 v8,s[32:35],s64 offen nt lds
s_add_u32 s64,s74,3698688
s_add_u32 m0,s75,1024
s_nop 0
buffer_load_dwordx4 v9,s[32:35],s64 offen nt lds
s_add_u32 s64,s74,3727360
s_add_u32 m0,s75,2048
s_nop 0
buffer_load_dwordx4 v8,s[32:35],s64 offen nt lds
s_add_u32 s64,s74,3756032
s_add_u32 m0,s75,3072
s_nop 0
buffer_load_dwordx4 v9,s[32:35],s64 offen nt lds
s_add_u32 s64,s74,3784704
s_add_u32 m0,s75,4096
s_nop 0
buffer_load_dwordx4 v8,s[32:35],s64 offen nt lds
s_add_u32 s64,s74,3813376
s_add_u32 m0,s75,5120
s_nop 0
buffer_load_dwordx4 v9,s[32:35],s64 offen nt lds
s_add_u32 s64,s74,3842048
s_add_u32 m0,s75,6144
s_nop 0
buffer_load_dwordx4 v8,s[32:35],s64 offen nt lds
s_add_u32 s64,s74,3870720
s_add_u32 m0,s75,7168
s_nop 0
buffer_load_dwordx4 v9,s[32:35],s64 offen nt lds
s_add_u32 s64,s74,3899392
s_add_u32 m0,s75,8192
s_nop 0
buffer_load_dwordx4 v8,s[32:35],s64 offen nt lds
s_add_u32 s64,s74,3928064
s_add_u32 m0,s75,9216
s_nop 0
buffer_load_dwordx4 v9,s[32:35],s64 offen nt lds
s_add_u32 s64,s74,3956736
s_add_u32 m0,s75,10240
s_nop 0
buffer_load_dwordx4 v8,s[32:35],s64 offen nt lds
s_add_u32 s64,s74,3985408
s_add_u32 m0,s75,11264
s_nop 0
buffer_load_dwordx4 v9,s[32:35],s64 offen nt lds
s_add_u32 s64,s74,4014080
s_add_u32 m0,s75,12288
s_nop 0
buffer_load_dwordx4 v8,s[32:35],s64 offen nt lds
s_add_u32 s64,s74,4042752
s_add_u32 m0,s75,13312
s_nop 0
buffer_load_dwordx4 v9,s[32:35],s64 offen nt lds
s_add_u32 s64,s74,4071424
s_add_u32 m0,s75,14336
s_nop 0
buffer_load_dwordx4 v8,s[32:35],s64 offen nt lds
s_add_u32 s64,s74,4100096
s_add_u32 m0,s75,15360
s_nop 0
buffer_load_dwordx4 v9,s[32:35],s64 offen nt lds
s_waitcnt vmcnt(16)
s_barrier
ds_read_b64_tr_b16 a[32:33],v12 offset:0
ds_read_b64_tr_b16 a[160:161],v13 offset:0
ds_read_b64_tr_b16 a[34:35],v12 offset:4096
ds_read_b64_tr_b16 a[162:163],v13 offset:4096
ds_read_b64_tr_b16 a[36:37],v12 offset:8192
ds_read_b64_tr_b16 a[164:165],v13 offset:8192
ds_read_b64_tr_b16 a[38:39],v12 offset:12288
ds_read_b64_tr_b16 a[166:167],v13 offset:12288
s_waitcnt lgkmcnt(4)
ds_read_b64_tr_b16 a[40:41],v12 offset:16384
ds_read_b64_tr_b16 a[168:169],v13 offset:16384
ds_read_b64_tr_b16 a[42:43],v12 offset:20480
ds_read_b64_tr_b16 a[170:171],v13 offset:20480
ds_read_b64_tr_b16 a[44:45],v12 offset:24576
ds_read_b64_tr_b16 a[172:173],v13 offset:24576
ds_read_b64_tr_b16 a[46:47],v12 offset:28672
ds_read_b64_tr_b16 a[174:175],v13 offset:28672
s_waitcnt lgkmcnt(4)
ds_read_b64_tr_b16 a[48:49],v12 offset:32768
ds_read_b64_tr_b16 a[176:177],v13 offset:32768
ds_read_b64_tr_b16 a[50:51],v12 offset:36864
ds_read_b64_tr_b16 a[178:179],v13 offset:36864
ds_read_b64_tr_b16 a[52:53],v12 offset:40960
ds_read_b64_tr_b16 a[180:181],v13 offset:40960
ds_read_b64_tr_b16 a[54:55],v12 offset:45056
ds_read_b64_tr_b16 a[182:183],v13 offset:45056
s_waitcnt lgkmcnt(4)
ds_read_b64_tr_b16 a[56:57],v12 offset:49152
ds_read_b64_tr_b16 a[184:185],v13 offset:49152
ds_read_b64_tr_b16 a[58:59],v12 offset:53248
ds_read_b64_tr_b16 a[186:187],v13 offset:53248
ds_read_b64_tr_b16 a[60:61],v12 offset:57344
ds_read_b64_tr_b16 a[188:189],v13 offset:57344
ds_read_b64_tr_b16 a[62:63],v12 offset:61440
ds_read_b64_tr_b16 a[190:191],v13 offset:61440
s_waitcnt lgkmcnt(4)
v_xor_b32 v12,0x10000,v12
v_xor_b32 v13,0x10000,v13
s_waitcnt lgkmcnt(0)
s_barrier
s_add_u32 s64,s74,5505024
s_add_u32 m0,s75,65536
s_nop 0
buffer_load_dwordx4 v8,s[32:35],s64 offen nt lds
s_add_u32 s64,s74,5533696
s_add_u32 m0,s75,66560
s_nop 0
buffer_load_dwordx4 v9,s[32:35],s64 offen nt lds
s_add_u32 s64,s74,5562368
s_add_u32 m0,s75,67584
s_nop 0
buffer_load_dwordx4 v8,s[32:35],s64 offen nt lds
s_add_u32 s64,s74,5591040
s_add_u32 m0,s75,68608
s_nop 0
buffer_load_dwordx4 v9,s[32:35],s64 offen nt lds
s_add_u32 s64,s74,5619712
s_add_u32 m0,s75,69632
s_nop 0
buffer_load_dwordx4 v8,s[32:35],s64 offen nt lds
s_add_u32 s64,s74,5648384
s_add_u32 m0,s75,70656
s_nop 0
buffer_load_dwordx4 v9,s[32:35],s64 offen nt lds
s_add_u32 s64,s74,5677056
s_add_u32 m0,s75,71680
s_nop 0
buffer_load_dwordx4 v8,s[32:35],s64 offen nt lds
s_add_u32 s64,s74,5705728
s_add_u32 m0,s75,72704
s_nop 0
buffer_load_dwordx4 v9,s[32:35],s64 offen nt lds
s_add_u32 s64,s74,5734400
s_add_u32 m0,s75,73728
s_nop 0
buffer_load_dwordx4 v8,s[32:35],s64 offen nt lds
s_add_u32 s64,s74,5763072
s_add_u32 m0,s75,74752
s_nop 0
buffer_load_dwordx4 v9,s[32:35],s64 offen nt lds
s_add_u32 s64,s74,5791744
s_add_u32 m0,s75,75776
s_nop 0
buffer_load_dwordx4 v8,s[32:35],s64 offen nt lds
s_add_u32 s64,s74,5820416
s_add_u32 m0,s75,76800
s_nop 0
buffer_load_dwordx4 v9,s[32:35],s64 offen nt lds
s_add_u32 s64,s74,5849088
s_add_u32 m0,s75,77824
s_nop 0
buffer_load_dwordx4 v8,s[32:35],s64 offen nt lds
s_add_u32 s64,s74,5877760
s_add_u32 m0,s75,78848
s_nop 0
buffer_load_dwordx4 v9,s[32:35],s64 offen nt lds
s_add_u32 s64,s74,5906432
s_add_u32 m0,s75,79872
s_nop 0
buffer_load_dwordx4 v8,s[32:35],s64 offen nt lds
s_add_u32 s64,s74,5935104
s_add_u32 m0,s75,80896
s_nop 0
buffer_load_dwordx4 v9,s[32:35],s64 offen nt lds
s_waitcnt vmcnt(16)
s_barrier
ds_read_b64_tr_b16 a[64:65],v12 offset:0
ds_read_b64_tr_b16 a[192:193],v13 offset:0
ds_read_b64_tr_b16 a[66:67],v12 offset:4096
ds_read_b64_tr_b16 a[194:195],v13 offset:4096
ds_read_b64_tr_b16 a[68:69],v12 offset:8192
ds_read_b64_tr_b16 a[196:197],v13 offset:8192
ds_read_b64_tr_b16 a[70:71],v12 offset:12288
ds_read_b64_tr_b16 a[198:199],v13 offset:12288
s_waitcnt lgkmcnt(4)
ds_read_b64_tr_b16 a[72:73],v12 offset:16384
ds_read_b64_tr_b16 a[200:201],v13 offset:16384
ds_read_b64_tr_b16 a[74:75],v12 offset:20480
ds_read_b64_tr_b16 a[202:203],v13 offset:20480
ds_read_b64_tr_b16 a[76:77],v12 offset:24576
ds_read_b64_tr_b16 a[204:205],v13 offset:24576
ds_read_b64_tr_b16 a[78:79],v12 offset:28672
ds_read_b64_tr_b16 a[206:207],v13 offset:28672
s_waitcnt lgkmcnt(4)
ds_read_b64_tr_b16 a[80:81],v12 offset:32768
ds_read_b64_tr_b16 a[208:209],v13 offset:32768
ds_read_b64_tr_b16 a[82:83],v12 offset:36864
ds_read_b64_tr_b16 a[210:211],v13 offset:36864
ds_read_b64_tr_b16 a[84:85],v12 offset:40960
ds_read_b64_tr_b16 a[212:213],v13 offset:40960
ds_read_b64_tr_b16 a[86:87],v12 offset:45056
ds_read_b64_tr_b16 a[214:215],v13 offset:45056
s_waitcnt lgkmcnt(4)
ds_read_b64_tr_b16 a[88:89],v12 offset:49152
ds_read_b64_tr_b16 a[216:217],v13 offset:49152
ds_read_b64_tr_b16 a[90:91],v12 offset:53248
ds_read_b64_tr_b16 a[218:219],v13 offset:53248
ds_read_b64_tr_b16 a[92:93],v12 offset:57344
ds_read_b64_tr_b16 a[220:221],v13 offset:57344
ds_read_b64_tr_b16 a[94:95],v12 offset:61440
ds_read_b64_tr_b16 a[222:223],v13 offset:61440
s_waitcnt lgkmcnt(4)
v_xor_b32 v12,0x10000,v12
v_xor_b32 v13,0x10000,v13
s_waitcnt lgkmcnt(0)
s_barrier
s_waitcnt vmcnt(0)
s_barrier
ds_read_b64_tr_b16 a[96:97],v12 offset:0
ds_read_b64_tr_b16 a[224:225],v13 offset:0
ds_read_b64_tr_b16 a[98:99],v12 offset:4096
ds_read_b64_tr_b16 a[226:227],v13 offset:4096
ds_read_b64_tr_b16 a[100:101],v12 offset:8192
ds_read_b64_tr_b16 a[228:229],v13 offset:8192
ds_read_b64_tr_b16 a[102:103],v12 offset:12288
ds_read_b64_tr_b16 a[230:231],v13 offset:12288
s_waitcnt lgkmcnt(4)
ds_read_b64_tr_b16 a[104:105],v12 offset:16384
ds_read_b64_tr_b16 a[232:233],v13 offset:16384
ds_read_b64_tr_b16 a[106:107],v12 offset:20480
ds_read_b64_tr_b16 a[234:235],v13 offset:20480
ds_read_b64_tr_b16 a[108:109],v12 offset:24576
ds_read_b64_tr_b16 a[236:237],v13 offset:24576
ds_read_b64_tr_b16 a[110:111],v12 offset:28672
ds_read_b64_tr_b16 a[238:239],v13 offset:28672
s_waitcnt lgkmcnt(4)
ds_read_b64_tr_b16 a[112:113],v12 offset:32768
ds_read_b64_tr_b16 a[240:241],v13 offset:32768
ds_read_b64_tr_b16 a[114:115],v12 offset:36864
ds_read_b64_tr_b16 a[242:243],v13 offset:36864
ds_read_b64_tr_b16 a[116:117],v12 offset:40960
ds_read_b64_tr_b16 a[244:245],v13 offset:40960
ds_read_b64_tr_b16 a[118:119],v12 offset:45056
ds_read_b64_tr_b16 a[246:247],v13 offset:45056
s_waitcnt lgkmcnt(4)
ds_read_b64_tr_b16 a[120:121],v12 offset:49152
ds_read_b64_tr_b16 a[248:249],v13 offset:49152
ds_read_b64_tr_b16 a[122:123],v12 offset:53248
ds_read_b64_tr_b16 a[250:251],v13 offset:53248
ds_read_b64_tr_b16 a[124:125],v12 offset:57344
ds_read_b64_tr_b16 a[252:253],v13 offset:57344
ds_read_b64_tr_b16 a[126:127],v12 offset:61440
ds_read_b64_tr_b16 a[254:255],v13 offset:61440
s_waitcnt lgkmcnt(4)
v_xor_b32 v12,0x10000,v12
v_xor_b32 v13,0x10000,v13
s_waitcnt lgkmcnt(0)
s_barrier
v_mov_b32 v88,0x3f803f80
v_mov_b32 v89,0x3f803f80
v_mov_b32 v90,0x3f803f80
v_mov_b32 v91,0x3f803f80
s_nop 1
v_mfma_f32_16x16x32_bf16 v[52:55],a[0:3],v[88:91],0
v_mfma_f32_16x16x32_bf16 v[56:59],a[128:131],v[88:91],0
v_mfma_f32_16x16x32_bf16 v[52:55],a[4:7],v[88:91],v[52:55]
v_mfma_f32_16x16x32_bf16 v[56:59],a[132:135],v[88:91],v[56:59]
v_mfma_f32_16x16x32_bf16 v[52:55],a[8:11],v[88:91],v[52:55]
v_mfma_f32_16x16x32_bf16 v[56:59],a[136:139],v[88:91],v[56:59]
v_mfma_f32_16x16x32_bf16 v[52:55],a[12:15],v[88:91],v[52:55]
v_mfma_f32_16x16x32_bf16 v[56:59],a[140:143],v[88:91],v[56:59]
v_mfma_f32_16x16x32_bf16 v[52:55],a[16:19],v[88:91],v[52:55]
v_mfma_f32_16x16x32_bf16 v[56:59],a[144:147],v[88:91],v[56:59]
v_mfma_f32_16x16x32_bf16 v[52:55],a[20:23],v[88:91],v[52:55]
v_mfma_f32_16x16x32_bf16 v[56:59],a[148:151],v[88:91],v[56:59]
v_mfma_f32_16x16x32_bf16 v[52:55],a[24:27],v[88:91],v[52:55]
v_mfma_f32_16x16x32_bf16 v[56:59],a[152:155],v[88:91],v[56:59]
v_mfma_f32_16x16x32_bf16 v[52:55],a[28:31],v[88:91],v[52:55]
v_mfma_f32_16x16x32_bf16 v[56:59],a[156:159],v[88:91],v[56:59]
v_mfma_f32_16x16x32_bf16 v[52:55],a[32:35],v[88:91],v[52:55]
v_mfma_f32_16x16x32_bf16 v[56:59],a[160:163],v[88:91],v[56:59]
v_mfma_f32_16x16x32_bf16 v[52:55],a[36:39],v[88:91],v[52:55]
v_mfma_f32_16x16x32_bf16 v[56:59],a[164:167],v[88:91],v[56:59]
v_mfma_f32_16x16x32_bf16 v[52:55],a[40:43],v[88:91],v[52:55]
v_mfma_f32_16x16x32_bf16 v[56:59],a[168:171],v[88:91],v[56:59]
v_mfma_f32_16x16x32_bf16 v[52:55],a[44:47],v[88:91],v[52:55]
v_mfma_f32_16x16x32_bf16 v[56:59],a[172:175],v[88:91],v[56:59]
v_mfma_f32_16x16x32_bf16 v[52:55],a[48:51],v[88:91],v[52:55]
v_mfma_f32_16x16x32_bf16 v[56:59],a[176:179],v[88:91],v[56:59]
v_mfma_f32_16x16x32_bf16 v[52:55],a[52:55],v[88:91],v[52:55]
v_mfma_f32_16x16x32_bf16 v[56:59],a[180:183],v[88:91],v[56:59]
v_mfma_f32_16x16x32_bf16 v[52:55],a[56:59],v[88:91],v[52:55]
v_mfma_f32_16x16x32_bf16 v[56:59],a[184:187],v[88:91],v[56:59]
v_mfma_f32_16x16x32_bf16 v[52:55],a[60:63],v[88:91],v[52:55]
v_mfma_f32_16x16x32_bf16 v[56:59],a[188:191],v[88:91],v[56:59]
v_mfma_f32_16x16x32_bf16 v[52:55],a[64:67],v[88:91],v[52:55]
v_mfma_f32_16x16x32_bf16 v[56:59],a[192:195],v[88:91],v[56:59]
v_mfma_f32_16x16x32_bf16 v[52:55],a[68:71],v[88:91],v[52:55]
v_mfma_f32_16x16x32_bf16 v[56:59],a[196:199],v[88:91],v[56:59]
v_mfma_f32_16x16x32_bf16 v[52:55],a[72:75],v[88:91],v[52:55]
v_mfma_f32_16x16x32_bf16 v[56:59],a[200:203],v[88:91],v[56:59]
v_mfma_f32_16x16x32_bf16 v[52:55],a[76:79],v[88:91],v[52:55]
v_mfma_f32_16x16x32_bf16 v[56:59],a[204:207],v[88:91],v[56:59]
v_mfma_f32_16x16x32_bf16 v[52:55],a[80:83],v[88:91],v[52:55]
v_mfma_f32_16x16x32_bf16 v[56:59],a[208:211],v[88:91],v[56:59]
v_mfma_f32_16x16x32_bf16 v[52:55],a[84:87],v[88:91],v[52:55]
v_mfma_f32_16x16x32_bf16 v[56:59],a[212:215],v[88:91],v[56:59]
v_mfma_f32_16x16x32_bf16 v[52:55],a[88:91],v[88:91],v[52:55]
v_mfma_f32_16x16x32_bf16 v[56:59],a[216:219],v[88:91],v[56:59]
v_mfma_f32_16x16x32_bf16 v[52:55],a[92:95],v[88:91],v[52:55]
v_mfma_f32_16x16x32_bf16 v[56:59],a[220:223],v[88:91],v[56:59]
v_mfma_f32_16x16x32_bf16 v[52:55],a[96:99],v[88:91],v[52:55]
v_mfma_f32_16x16x32_bf16 v[56:59],a[224:227],v[88:91],v[56:59]
v_mfma_f32_16x16x32_bf16 v[52:55],a[100:103],v[88:91],v[52:55]
v_mfma_f32_16x16x32_bf16 v[56:59],a[228:231],v[88:91],v[56:59]
v_mfma_f32_16x16x32_bf16 v[52:55],a[104:107],v[88:91],v[52:55]
v_mfma_f32_16x16x32_bf16 v[56:59],a[232:235],v[88:91],v[56:59]
v_mfma_f32_16x16x32_bf16 v[52:55],a[108:111],v[88:91],v[52:55]
v_mfma_f32_16x16x32_bf16 v[56:59],a[236:239],v[88:91],v[56:59]
v_mfma_f32_16x16x32_bf16 v[52:55],a[112:115],v[88:91],v[52:55]
v_mfma_f32_16x16x32_bf16 v[56:59],a[240:243],v[88:91],v[56:59]
v_mfma_f32_16x16x32_bf16 v[52:55],a[116:119],v[88:91],v[52:55]
v_mfma_f32_16x16x32_bf16 v[56:59],a[244:247],v[88:91],v[56:59]
v_mfma_f32_16x16x32_bf16 v[52:55],a[120:123],v[88:91],v[52:55]
v_mfma_f32_16x16x32_bf16 v[56:59],a[248:251],v[88:91],v[56:59]
v_mfma_f32_16x16x32_bf16 v[52:55],a[124:127],v[88:91],v[52:55]
v_mfma_f32_16x16x32_bf16 v[56:59],a[252:255],v[88:91],v[56:59]
v_and_b32 v21,1,v1
v_mul_u32_u24 v21,960,v21
s_mov_b32 s65,21052032
s_mov_b32 s66,1792
pl_374:
buffer_load_dword v22,v21,s[20:23],s65 offen sc1
s_waitcnt vmcnt(0)
v_cmp_gt_u32 vcc,s66,v22
s_cbranch_vccz pok_375
s_sleep 1
s_sub_u32 s90,s90,1
s_cmp_gt_i32 s90,0
s_cbranch_scc1 pl_374
pok_375:
s_mov_b32 s81,0xbdd2d3e8
v_mov_b32 v28,0xc0135761
s_lshr_b32 s41,s59,3
s_and_b32 s42,s59,7
s_mul_i32 s64,s42,3
s_add_u32 s64,s64,s50
s_lshr_b32 s65,s42,1
s_add_u32 s65,s65,24
s_cmp_eq_u32 s50,3
s_cselect_b32 s64,s65,s64
s_and_b32 s65,s42,1
s_lshl_b32 s65,s65,3
s_cmp_eq_u32 s50,3
s_cselect_b32 s65,s65,0
s_and_b32 s66,s64,3
s_lshl_b32 s66,s66,11
s_add_u32 s65,s65,s66
s_lshr_b32 s64,s64,2
s_mul_i32 s66,s41,7
s_add_u32 s64,s64,s66
s_add_u32 s64,s64,81
s_lshl_b32 s64,s64,14
s_add_u32 s64,s64,s65
v_add_u32 v18,s64,v16
v_mov_b32 v17,v16
v_lshlrev_b32 v19,4,v3
v_add_u32 v19,131072,v19
v_and_b32 v21,7,v1
v_lshlrev_b32 v21,7,v21
v_bfe_u32 v6,v1,3,2
v_lshl_add_u32 v21,v6,2,v21
s_add_u32 s74,s63,6144
s_add_u32 s74,s74,s60
s_lshl_b32 s73,s59,7
s_lshl_b32 s64,s50,2
s_add_u32 s73,s73,s64
s_add_u32 s73,s73,s63
s_add_u32 s73,s73,20480
s_lshl_b32 s64,s60,4
s_add_u32 s73,s73,s64
s_mov_b32 s82,0x3a800000
s_mov_b32 s64,0
s_lshr_b32 s65,s50,1
s_and_b32 s66,s50,1
s_lshl_b32 s66,s66,12
s_add_u32 s66,s66,s64
s_lshl_b32 s72,s65,13
s_add_u32 s72,s72,s66
s_add_u32 s72,s72,0x10000
s_lshl_b32 s65,s65,14
s_add_u32 s75,s65,s66
s_add_u32 s75,s75,1179648
s_cmp_eq_u32 s50,3
s_cbranch_scc1 w3b_376
s_add_u32 s64,s79,0
s_lshl_b32 s70,s64,21
s_lshl_b32 s64,s64,13
s_and_b32 s64,s64,0x2000
s_xor_b32 s64,s64,s62
s_add_u32 s70,s70,s64
s_add_u32 s70,s70,29360128
s_mov_b32 s83,1
s_mov_b32 s87,s74
s_cmp_eq_u32 s50,0
s_cselect_b32 s74,s74,0x7fff0000
v_mov_b32 v47,132096
s_lshl_b32 s64,s50,3
s_add_u32 s64,s64,132096
v_mov_b32 v46,s64
v_mov_b32 v29,0
s_mov_b32 s97,0x7fff0000
s_mov_b32 s69,1
s_mov_b32 s68,0
s_mov_b32 s52,0x30003
s_mov_b32 s53,s52
seg_378:
s_cmp_eq_u32 s83,0
s_cbranch_scc1 ahead_379
s_add_u32 s94,s70,s75
s_xor_b32 s95,s94,1024
s_xor_b32 s91,s72,0x10000
s_cmp_eq_u32 s69,0
s_mov_b32 s69,1
s_cbranch_scc1 half2_383
s_waitcnt vmcnt(2)
v_cmp_gt_u32 vcc,s71,v29
s_cbranch_vccz nb_382
s_waitcnt vmcnt(0)
v_add_u32 v22,s71,-1
buffer_store_dword v22,v23,s[20:23],s97 offen sc1
s_mov_b32 s97,0x7fff0000
s_cmp_lg_u32 s50,0
s_cbranch_scc1 nb_382
buffer_load_dword v32,v21,s[20:23],s74 offen sc1
s_sleep 2
pl_384:
buffer_load_dword v33,v21,s[20:23],s74 offen sc1
s_waitcnt vmcnt(1)
v_cmp_gt_u32 vcc,s71,v32
v_mov_b32 v29,v32
s_cbranch_vccz pok_385
buffer_load_dword v32,v21,s[20:23],s74 offen sc1
s_waitcnt vmcnt(1)
v_cmp_gt_u32 vcc,s71,v33
v_mov_b32 v29,v33
s_cbranch_vccz pok_385
s_sub_u32 s90,s90,1
s_cmp_gt_i32 s90,0
s_cbranch_scc1 pl_384
pok_385:
nb_382:
s_cmp_eq_u32 s71,64
s_barrier
s_cbranch_scc1 half_386
s_xor_b32 m0,s91,0
s_add_u32 s65,s94,0
buffer_load_dwordx4 v16,s[20:23],s65 offen offset:0 sc1 lds
buffer_load_dwordx4 v16,s[20:23],s65 offen offset:2048 sc1 lds
s_xor_b32 m0,s91,16384
s_add_u32 s65,s94,32768
buffer_load_dwordx4 v16,s[20:23],s65 offen offset:0 sc1 lds
buffer_load_dwordx4 v16,s[20:23],s65 offen offset:2048 sc1 lds
s_xor_b32 m0,s91,32768
s_add_u32 s65,s94,65536
buffer_load_dwordx4 v16,s[20:23],s65 offen offset:0 sc1 lds
buffer_load_dwordx4 v16,s[20:23],s65 offen offset:2048 sc1 lds
s_xor_b32 m0,s91,49152
s_add_u32 s65,s94,98304
buffer_load_dwordx4 v16,s[20:23],s65 offen offset:0 sc1 lds
buffer_load_dwordx4 v16,s[20:23],s65 offen offset:2048 sc1 lds
s_waitcnt vmcnt(8)
v_add_u32 v22,s71,-1
buffer_store_dword v22,v23,s[20:23],s97 offen sc1
s_mov_b32 s97,0x7fff0000
s_waitcnt vmcnt(7)
s_barrier
ds_read_b128 v[224:227],v17 offset:0
ds_read_b128 v[228:231],v17 offset:2048
ds_read_b128 v[232:235],v17 offset:4096
ds_read_b128 v[236:239],v17 offset:6144
ds_read_b128 v[240:243],v17 offset:8192
ds_read_b128 v[244:247],v17 offset:10240
ds_read_b128 v[248:251],v17 offset:12288
s_waitcnt lgkmcnt(5)
v_mfma_f32_16x16x32_bf16 v[64:67],a[0:3],v[224:227],0
s_xor_b32 m0,s91,1024
s_add_u32 s96,s71,1
s_add_u32 s92,s71,2
v_min_u32 v27,v224,v228
v_mfma_f32_16x16x32_bf16 v[72:75],a[128:131],v[224:227],0
ds_read_b128 v[252:255],v17 offset:14336
s_cmp_eq_u32 s96,64
s_cselect_b32 s96,99,s96
v_mfma_f32_16x16x32_bf16 v[64:67],a[4:7],v[228:231],v[64:67]
s_add_u32 s65,s95,0
s_cmp_eq_u32 s92,64
s_cselect_b32 s92,99,s92
v_mfma_f32_16x16x32_bf16 v[72:75],a[132:135],v[228:231],v[72:75]
s_waitcnt vmcnt(5)
s_barrier
ds_read_b128 v[224:227],v17 offset:16384
s_waitcnt lgkmcnt(5)
v_mfma_f32_16x16x32_bf16 v[64:67],a[8:11],v[232:235],v[64:67]
buffer_load_dwordx4 v16,s[20:23],s65 offen offset:0 sc1 lds
v_mfma_f32_16x16x32_bf16 v[72:75],a[136:139],v[232:235],v[72:75]
ds_read_b128 v[228:231],v17 offset:18432
v_min3_u32 v27,v27,v232,v236
v_mfma_f32_16x16x32_bf16 v[64:67],a[12:15],v[236:239],v[64:67]
buffer_load_dwordx4 v16,s[20:23],s65 offen offset:2048 sc1 lds
v_mfma_f32_16x16x32_bf16 v[72:75],a[140:143],v[236:239],v[72:75]
ds_read_b128 v[232:235],v17 offset:20480
s_waitcnt lgkmcnt(5)
v_mfma_f32_16x16x32_bf16 v[64:67],a[16:19],v[240:243],v[64:67]
s_xor_b32 m0,s91,17408
v_min3_u32 v27,v27,v240,v244
v_mfma_f32_16x16x32_bf16 v[72:75],a[144:147],v[240:243],v[72:75]
ds_read_b128 v[236:239],v17 offset:22528
v_mfma_f32_16x16x32_bf16 v[64:67],a[20:23],v[244:247],v[64:67]
s_add_u32 s65,s95,32768
v_mfma_f32_16x16x32_bf16 v[72:75],a[148:151],v[244:247],v[72:75]
ds_read_b128 v[240:243],v17 offset:24576
s_waitcnt lgkmcnt(5)
v_mfma_f32_16x16x32_bf16 v[64:67],a[24:27],v[248:251],v[64:67]
buffer_load_dwordx4 v16,s[20:23],s65 offen offset:0 sc1 lds
v_mfma_f32_16x16x32_bf16 v[72:75],a[152:155],v[248:251],v[72:75]
ds_read_b128 v[244:247],v17 offset:26624
v_min3_u32 v27,v27,v248,v252
v_mfma_f32_16x16x32_bf16 v[64:67],a[28:31],v[252:255],v[64:67]
buffer_load_dwordx4 v16,s[20:23],s65 offen offset:2048 sc1 lds
v_mfma_f32_16x16x32_bf16 v[72:75],a[156:159],v[252:255],v[72:75]
ds_read_b128 v[248:251],v17 offset:28672
s_waitcnt lgkmcnt(5)
v_mfma_f32_16x16x32_bf16 v[64:67],a[32:35],v[224:227],v[64:67]
s_xor_b32 m0,s91,33792
v_min3_u32 v27,v27,v224,v228
v_mfma_f32_16x16x32_bf16 v[72:75],a[160:163],v[224:227],v[72:75]
ds_read_b128 v[252:255],v17 offset:30720
v_mfma_f32_16x16x32_bf16 v[64:67],a[36:39],v[228:231],v[64:67]
s_add_u32 s65,s95,65536
v_mfma_f32_16x16x32_bf16 v[72:75],a[164:167],v[228:231],v[72:75]
s_waitcnt vmcnt(5)
s_barrier
ds_read_b128 v[224:227],v17 offset:32768
s_waitcnt lgkmcnt(5)
v_mfma_f32_16x16x32_bf16 v[64:67],a[40:43],v[232:235],v[64:67]
buffer_load_dwordx4 v16,s[20:23],s65 offen offset:0 sc1 lds
v_mfma_f32_16x16x32_bf16 v[72:75],a[168:171],v[232:235],v[72:75]
ds_read_b128 v[228:231],v17 offset:34816
v_min3_u32 v27,v27,v232,v236
v_mfma_f32_16x16x32_bf16 v[64:67],a[44:47],v[236:239],v[64:67]
buffer_load_dwordx4 v16,s[20:23],s65 offen offset:2048 sc1 lds
v_mfma_f32_16x16x32_bf16 v[72:75],a[172:175],v[236:239],v[72:75]
ds_read_b128 v[232:235],v17 offset:36864
s_waitcnt lgkmcnt(5)
v_mfma_f32_16x16x32_bf16 v[64:67],a[48:51],v[240:243],v[64:67]
s_xor_b32 m0,s91,50176
v_min3_u32 v27,v27,v240,v244
v_mfma_f32_16x16x32_bf16 v[72:75],a[176:179],v[240:243],v[72:75]
ds_read_b128 v[236:239],v17 offset:38912
v_mfma_f32_16x16x32_bf16 v[64:67],a[52:55],v[244:247],v[64:67]
s_add_u32 s65,s95,98304
v_mfma_f32_16x16x32_bf16 v[72:75],a[180:183],v[244:247],v[72:75]
ds_read_b128 v[240:243],v17 offset:40960
s_waitcnt lgkmcnt(5)
v_mfma_f32_16x16x32_bf16 v[64:67],a[56:59],v[248:251],v[64:67]
buffer_load_dwordx4 v16,s[20:23],s65 offen offset:0 sc1 lds
v_min3_u32 v27,v27,v248,v252
v_mfma_f32_16x16x32_bf16 v[72:75],a[184:187],v[248:251],v[72:75]
ds_read_b128 v[244:247],v17 offset:43008
s_waitcnt vmcnt(63)
v_mfma_f32_16x16x32_bf16 v[64:67],a[60:63],v[252:255],v[64:67]
buffer_load_dwordx4 v16,s[20:23],s65 offen offset:2048 sc1 lds
v_mfma_f32_16x16x32_bf16 v[72:75],a[188:191],v[252:255],v[72:75]
ds_read_b128 v[248:251],v17 offset:45056
s_waitcnt lgkmcnt(5)
v_mfma_f32_16x16x32_bf16 v[64:67],a[64:67],v[224:227],v[64:67]
v_cmp_gt_u32 vcc,s96,v29
v_cmp_gt_u32 s[92:93],s92,v29
v_mfma_f32_16x16x32_bf16 v[72:75],a[192:195],v[224:227],v[72:75]
ds_read_b128 v[252:255],v17 offset:47104
v_min3_u32 v27,v27,v224,v228
v_mfma_f32_16x16x32_bf16 v[64:67],a[68:71],v[228:231],v[64:67]
v_mov_b32 v44,vcc_lo
v_mov_b32 v45,s92
v_mfma_f32_16x16x32_bf16 v[72:75],a[196:199],v[228:231],v[72:75]
ds_read_b128 v[224:227],v17 offset:49152
s_waitcnt lgkmcnt(5)
v_mfma_f32_16x16x32_bf16 v[64:67],a[72:75],v[232:235],v[64:67]
ds_write_b64 v46,v[44:45]
v_min3_u32 v27,v27,v232,v236
v_mfma_f32_16x16x32_bf16 v[72:75],a[200:203],v[232:235],v[72:75]
ds_read_b128 v[228:231],v17 offset:51200
v_mfma_f32_16x16x32_bf16 v[64:67],a[76:79],v[236:239],v[64:67]
v_mfma_f32_16x16x32_bf16 v[72:75],a[204:207],v[236:239],v[72:75]
ds_read_b128 v[232:235],v17 offset:53248
s_waitcnt lgkmcnt(6)
v_mfma_f32_16x16x32_bf16 v[64:67],a[80:83],v[240:243],v[64:67]
v_min3_u32 v27,v27,v240,v244
s_add_u32 s88,s70,s75
v_mfma_f32_16x16x32_bf16 v[72:75],a[208:211],v[240:243],v[72:75]
ds_read_b128 v[236:239],v17 offset:55296
s_add_u32 s88,s88,2097152
v_mfma_f32_16x16x32_bf16 v[64:67],a[84:87],v[244:247],v[64:67]
s_xor_b32 s88,s88,0x2000
s_xor_b32 s89,s88,1024
v_mfma_f32_16x16x32_bf16 v[72:75],a[212:215],v[244:247],v[72:75]
ds_read_b128 v[240:243],v17 offset:57344
s_waitcnt lgkmcnt(6)
v_mfma_f32_16x16x32_bf16 v[64:67],a[88:91],v[248:251],v[64:67]
v_min3_u32 v27,v27,v248,v252
v_mfma_f32_16x16x32_bf16 v[72:75],a[216:219],v[248:251],v[72:75]
ds_read_b128 v[244:247],v17 offset:59392
v_mfma_f32_16x16x32_bf16 v[64:67],a[92:95],v[252:255],v[64:67]
v_mfma_f32_16x16x32_bf16 v[72:75],a[220:223],v[252:255],v[72:75]
ds_read_b128 v[248:251],v17 offset:61440
s_waitcnt lgkmcnt(5)
v_mfma_f32_16x16x32_bf16 v[64:67],a[96:99],v[224:227],v[64:67]
v_min3_u32 v27,v27,v224,v228
v_mfma_f32_16x16x32_bf16 v[72:75],a[224:227],v[224:227],v[72:75]
ds_read_b128 v[252:255],v17 offset:63488
v_mfma_f32_16x16x32_bf16 v[64:67],a[100:103],v[228:231],v[64:67]
v_mfma_f32_16x16x32_bf16 v[72:75],a[228:231],v[228:231],v[72:75]
s_waitcnt vmcnt(4)
s_barrier
ds_read_b64 v[44:45],v47
ds_read_b128 v[224:227],v17 offset:1024
s_waitcnt lgkmcnt(6)
v_mfma_f32_16x16x32_bf16 v[64:67],a[104:107],v[232:235],v[64:67]
v_min3_u32 v27,v27,v232,v236
ds_read_b128 v[124:127],v19 offset:256
v_mfma_f32_16x16x32_bf16 v[72:75],a[232:235],v[232:235],v[72:75]
ds_read_b128 v[228:231],v17 offset:3072
ds_read_b128 v[120:123],v19 offset:0
v_mfma_f32_16x16x32_bf16 v[64:67],a[108:111],v[236:239],v[64:67]
v_mfma_f32_16x16x32_bf16 v[72:75],a[236:239],v[236:239],v[72:75]
ds_read_b128 v[232:235],v17 offset:5120
s_waitcnt lgkmcnt(8)
v_mfma_f32_16x16x32_bf16 v[64:67],a[112:115],v[240:243],v[64:67]
v_min3_u32 v27,v27,v240,v244
v_mfma_f32_16x16x32_bf16 v[72:75],a[240:243],v[240:243],v[72:75]
ds_read_b128 v[236:239],v17 offset:7168
v_mfma_f32_16x16x32_bf16 v[64:67],a[116:119],v[244:247],v[64:67]
v_mfma_f32_16x16x32_bf16 v[72:75],a[244:247],v[244:247],v[72:75]
ds_read_b128 v[240:243],v17 offset:9216
s_waitcnt lgkmcnt(8)
v_mfma_f32_16x16x32_bf16 v[64:67],a[120:123],v[248:251],v[64:67]
s_waitcnt lgkmcnt(7)
v_readfirstlane_b32 s93,v45
v_mfma_f32_16x16x32_bf16 v[72:75],a[248:251],v[248:251],v[72:75]
ds_read_b128 v[244:247],v17 offset:11264
v_readfirstlane_b32 s83,v44
s_cmp_lg_u32 s83,0
s_cbranch_scc0 keep_388
v_mfma_f32_16x16x32_bf16 v[64:67],a[124:127],v[252:255],v[64:67]
v_min3_u32 v27,v27,v248,v252
v_mfma_f32_16x16x32_bf16 v[72:75],a[252:255],v[252:255],v[72:75]
ds_read_b128 v[248:251],v17 offset:13312
s_waitcnt lgkmcnt(6)
v_mfma_f32_16x16x32_bf16 v[68:71],a[0:3],v[224:227],0
v_cmp_eq_u32 vcc,0,v27
s_cbranch_vccnz retry_377
v_mfma_f32_16x16x32_bf16 v[76:79],a[128:131],v[224:227],0
ds_read_b128 v[252:255],v17 offset:15360
v_min3_u32 v27,v27,v224,v228
v_mfma_f32_16x16x32_bf16 v[68:71],a[4:7],v[228:231],v[68:71]
s_waitcnt lgkmcnt(6)
v_mfma_f32_16x16x32_bf16 v[76:79],a[132:135],v[228:231],v[76:79]
ds_read_b128 v[224:227],v17 offset:17408
s_waitcnt lgkmcnt(5)
v_mfma_f32_16x16x32_bf16 v[68:71],a[8:11],v[232:235],v[68:71]
v_min3_u32 v27,v27,v232,v236
v_fmac_f32 v64,v52,v120
v_fmac_f32 v72,v56,v120
v_mfma_f32_16x16x32_bf16 v[76:79],a[136:139],v[232:235],v[76:79]
ds_read_b128 v[228:231],v17 offset:19456
v_fmac_f32 v65,v53,v120
v_fmac_f32 v73,v57,v120
v_mfma_f32_16x16x32_bf16 v[68:71],a[12:15],v[236:239],v[68:71]
v_fmac_f32 v66,v54,v120
v_fmac_f32 v67,v55,v120
v_fmac_f32 v74,v58,v120
v_mfma_f32_16x16x32_bf16 v[76:79],a[140:143],v[236:239],v[76:79]
ds_read_b128 v[232:235],v17 offset:21504
v_fmac_f32 v75,v59,v120
s_waitcnt lgkmcnt(5)
v_mfma_f32_16x16x32_bf16 v[68:71],a[16:19],v[240:243],v[68:71]
v_min3_u32 v27,v27,v240,v244
v_mul_f32 v88,v64,v64
v_mul_f32 v92,v72,v72
v_mfma_f32_16x16x32_bf16 v[76:79],a[144:147],v[240:243],v[76:79]
ds_read_b128 v[236:239],v17 offset:23552
v_mul_f32 v89,v65,v65
v_mul_f32 v93,v73,v73
v_mfma_f32_16x16x32_bf16 v[68:71],a[20:23],v[244:247],v[68:71]
v_mul_f32 v90,v66,v66
v_mul_f32 v91,v67,v67
v_mul_f32 v94,v74,v74
v_mfma_f32_16x16x32_bf16 v[76:79],a[148:151],v[244:247],v[76:79]
ds_read_b128 v[240:243],v17 offset:25600
v_mul_f32 v95,v75,v75
s_waitcnt lgkmcnt(5)
v_mfma_f32_16x16x32_bf16 v[68:71],a[24:27],v[248:251],v[68:71]
v_min3_u32 v27,v27,v248,v252
v_fma_f32 v88,v88,v121,v122
v_fma_f32 v92,v92,v121,v122
v_mfma_f32_16x16x32_bf16 v[76:79],a[152:155],v[248:251],v[76:79]
ds_read_b128 v[244:247],v17 offset:27648
v_fma_f32 v89,v89,v121,v122
v_fma_f32 v93,v93,v121,v122
v_mfma_f32_16x16x32_bf16 v[68:71],a[28:31],v[252:255],v[68:71]
v_fma_f32 v90,v90,v121,v122
v_fma_f32 v91,v91,v121,v122
v_fma_f32 v94,v94,v121,v122
v_mfma_f32_16x16x32_bf16 v[76:79],a[156:159],v[252:255],v[76:79]
ds_read_b128 v[248:251],v17 offset:29696
v_fma_f32 v95,v95,v121,v122
s_waitcnt lgkmcnt(5)
v_mfma_f32_16x16x32_bf16 v[68:71],a[32:35],v[224:227],v[68:71]
v_min3_u32 v27,v27,v224,v228
v_mul_f32 v88,v88,v64
v_mul_f32 v92,v92,v72
v_mfma_f32_16x16x32_bf16 v[76:79],a[160:163],v[224:227],v[76:79]
ds_read_b128 v[252:255],v17 offset:31744
v_mul_f32 v89,v89,v65
v_mul_f32 v93,v93,v73
v_mfma_f32_16x16x32_bf16 v[68:71],a[36:39],v[228:231],v[68:71]
v_mul_f32 v90,v90,v66
v_mul_f32 v91,v91,v67
v_mul_f32 v94,v94,v74
v_mfma_f32_16x16x32_bf16 v[76:79],a[164:167],v[228:231],v[76:79]
s_waitcnt vmcnt(0)
s_barrier
ds_read_b128 v[224:227],v17 offset:33792
s_waitcnt lgkmcnt(5)
v_mfma_f32_16x16x32_bf16 v[68:71],a[40:43],v[232:235],v[68:71]
v_min3_u32 v27,v27,v232,v236
v_mul_f32 v95,v95,v75
v_mfma_f32_16x16x32_bf16 v[76:79],a[168:171],v[232:235],v[76:79]
ds_read_b128 v[228:231],v17 offset:35840
v_exp_f32 v92,v92
v_mfma_f32_16x16x32_bf16 v[68:71],a[44:47],v[236:239],v[68:71]
v_exp_f32 v88,v88
v_mfma_f32_16x16x32_bf16 v[76:79],a[172:175],v[236:239],v[76:79]
ds_read_b128 v[232:235],v17 offset:37888
s_waitcnt lgkmcnt(5)
v_mfma_f32_16x16x32_bf16 v[68:71],a[48:51],v[240:243],v[68:71]
v_min3_u32 v27,v27,v240,v244
v_exp_f32 v93,v93
v_mfma_f32_16x16x32_bf16 v[76:79],a[176:179],v[240:243],v[76:79]
ds_read_b128 v[236:239],v17 offset:39936
v_exp_f32 v94,v94
v_mfma_f32_16x16x32_bf16 v[68:71],a[52:55],v[244:247],v[68:71]
v_exp_f32 v89,v89
v_mfma_f32_16x16x32_bf16 v[76:79],a[180:183],v[244:247],v[76:79]
ds_read_b128 v[240:243],v17 offset:41984
s_waitcnt lgkmcnt(5)
v_mfma_f32_16x16x32_bf16 v[68:71],a[56:59],v[248:251],v[68:71]
v_min3_u32 v27,v27,v248,v252
v_exp_f32 v95,v95
v_mfma_f32_16x16x32_bf16 v[76:79],a[184:187],v[248:251],v[76:79]
ds_read_b128 v[244:247],v17 offset:44032
v_fma_f32 v92,v92,v123,v123
v_fma_f32 v93,v93,v123,v123
v_mfma_f32_16x16x32_bf16 v[68:71],a[60:63],v[252:255],v[68:71]
v_exp_f32 v90,v90
v_fma_f32 v94,v94,v123,v123
v_mfma_f32_16x16x32_bf16 v[76:79],a[188:191],v[252:255],v[76:79]
ds_read_b128 v[248:251],v17 offset:46080
v_fma_f32 v95,v95,v123,v123
s_waitcnt lgkmcnt(5)
v_mfma_f32_16x16x32_bf16 v[68:71],a[64:67],v[224:227],v[68:71]
v_min3_u32 v27,v27,v224,v228
v_rcp_f32 v92,v92
v_mfma_f32_16x16x32_bf16 v[76:79],a[192:195],v[224:227],v[76:79]
ds_read_b128 v[252:255],v17 offset:48128
v_rcp_f32 v93,v93
v_mfma_f32_16x16x32_bf16 v[68:71],a[68:71],v[228:231],v[68:71]
v_exp_f32 v91,v91
v_mfma_f32_16x16x32_bf16 v[76:79],a[196:199],v[228:231],v[76:79]
ds_read_b128 v[224:227],v17 offset:50176
s_waitcnt lgkmcnt(5)
v_mfma_f32_16x16x32_bf16 v[68:71],a[72:75],v[232:235],v[68:71]
v_min3_u32 v27,v27,v232,v236
v_fma_f32 v88,v88,v123,v123
v_mfma_f32_16x16x32_bf16 v[76:79],a[200:203],v[232:235],v[76:79]
ds_read_b128 v[228:231],v17 offset:52224
v_fma_f32 v89,v89,v123,v123
v_mfma_f32_16x16x32_bf16 v[68:71],a[76:79],v[236:239],v[68:71]
v_fma_f32 v90,v90,v123,v123
v_fma_f32 v91,v91,v123,v123
v_mfma_f32_16x16x32_bf16 v[76:79],a[204:207],v[236:239],v[76:79]
ds_read_b128 v[232:235],v17 offset:54272
s_waitcnt lgkmcnt(5)
v_mfma_f32_16x16x32_bf16 v[68:71],a[80:83],v[240:243],v[68:71]
v_min3_u32 v27,v27,v240,v244
v_rcp_f32 v94,v94
v_mfma_f32_16x16x32_bf16 v[76:79],a[208:211],v[240:243],v[76:79]
ds_read_b128 v[236:239],v17 offset:56320
v_rcp_f32 v95,v95
v_mfma_f32_16x16x32_bf16 v[68:71],a[84:87],v[244:247],v[68:71]
v_rcp_f32 v88,v88
v_mfma_f32_16x16x32_bf16 v[76:79],a[212:215],v[244:247],v[76:79]
ds_read_b128 v[240:243],v17 offset:58368
s_waitcnt lgkmcnt(5)
v_mfma_f32_16x16x32_bf16 v[68:71],a[88:91],v[248:251],v[68:71]
v_min3_u32 v27,v27,v248,v252
v_mul_f32 v92,v92,v72
v_mfma_f32_16x16x32_bf16 v[76:79],a[216:219],v[248:251],v[76:79]
ds_read_b128 v[244:247],v17 offset:60416
v_mul_f32 v93,v93,v73
v_mfma_f32_16x16x32_bf16 v[68:71],a[92:95],v[252:255],v[68:71]
v_rcp_f32 v89,v89
v_mfma_f32_16x16x32_bf16 v[76:79],a[220:223],v[252:255],v[76:79]
ds_read_b128 v[248:251],v17 offset:62464
s_waitcnt lgkmcnt(5)
v_mfma_f32_16x16x32_bf16 v[68:71],a[96:99],v[224:227],v[68:71]
v_min3_u32 v27,v27,v224,v228
v_mul_f32 v94,v94,v74
v_mfma_f32_16x16x32_bf16 v[76:79],a[224:227],v[224:227],v[76:79]
ds_read_b128 v[252:255],v17 offset:64512
v_mul_f32 v95,v95,v75
v_mfma_f32_16x16x32_bf16 v[68:71],a[100:103],v[228:231],v[68:71]
v_rcp_f32 v90,v90
v_mfma_f32_16x16x32_bf16 v[76:79],a[228:231],v[228:231],v[76:79]
s_waitcnt lgkmcnt(4)
v_mfma_f32_16x16x32_bf16 v[68:71],a[104:107],v[232:235],v[68:71]
v_min3_u32 v27,v27,v232,v236
v_mfma_f32_16x16x32_bf16 v[76:79],a[232:235],v[232:235],v[76:79]
v_rcp_f32 v91,v91
v_mfma_f32_16x16x32_bf16 v[68:71],a[108:111],v[236:239],v[68:71]
v_mul_f32 v88,v88,v64
v_mul_f32 v89,v89,v65
v_mfma_f32_16x16x32_bf16 v[76:79],a[236:239],v[236:239],v[76:79]
v_mul_f32 v90,v90,v66
s_waitcnt lgkmcnt(2)
v_mfma_f32_16x16x32_bf16 v[68:71],a[112:115],v[240:243],v[68:71]
v_min3_u32 v27,v27,v240,v244
v_mul_f32 v91,v91,v67
v_mfma_f32_16x16x32_bf16 v[76:79],a[240:243],v[240:243],v[76:79]
v_cvt_pk_bf16_f32 v96,v88,v89
v_cvt_pk_bf16_f32 v97,v90,v91
v_mfma_f32_16x16x32_bf16 v[68:71],a[116:119],v[244:247],v[68:71]
v_cvt_pk_bf16_f32 v98,v92,v93
v_cvt_pk_bf16_f32 v99,v94,v95
v_mfma_f32_16x16x32_bf16 v[76:79],a[244:247],v[244:247],v[76:79]
v_max_u32 v96,1,v96
s_waitcnt lgkmcnt(0)
v_mfma_f32_16x16x32_bf16 v[68:71],a[120:123],v[248:251],v[68:71]
v_min3_u32 v27,v27,v248,v252
v_mfma_f32_16x16x32_bf16 v[76:79],a[248:251],v[248:251],v[76:79]
buffer_store_dwordx4 v[96:99],v18,s[20:23],s70 offen offset:0 sc1
v_mfma_f32_16x16x32_bf16 v[68:71],a[124:127],v[252:255],v[68:71]
v_mfma_f32_16x16x32_bf16 v[76:79],a[252:255],v[252:255],v[76:79]
v_cmp_eq_u32 vcc,0,v27
s_cbranch_vccnz retry_377
s_branch epi_380
keep_388:
v_mfma_f32_16x16x32_bf16 v[64:67],a[124:127],v[252:255],v[64:67]
v_min3_u32 v27,v27,v248,v252
s_xor_b32 m0,s72,0
v_mfma_f32_16x16x32_bf16 v[72:75],a[252:255],v[252:255],v[72:75]
ds_read_b128 v[248:251],v17 offset:13312
s_add_u32 s65,s88,0
s_waitcnt lgkmcnt(6)
v_mfma_f32_16x16x32_bf16 v[68:71],a[0:3],v[224:227],0
buffer_load_dwordx4 v16,s[20:23],s65 offen offset:0 sc1 lds
v_min3_u32 v27,v27,v224,v228
v_mfma_f32_16x16x32_bf16 v[76:79],a[128:131],v[224:227],0
ds_read_b128 v[252:255],v17 offset:15360
buffer_load_dwordx4 v16,s[20:23],s65 offen offset:2048 sc1 lds
v_mfma_f32_16x16x32_bf16 v[68:71],a[4:7],v[228:231],v[68:71]
v_cmp_eq_u32 vcc,0,v27
s_cbranch_vccnz retry_377
s_waitcnt lgkmcnt(6)
v_mfma_f32_16x16x32_bf16 v[76:79],a[132:135],v[228:231],v[76:79]
ds_read_b128 v[224:227],v17 offset:17408
s_xor_b32 m0,s72,16384
s_waitcnt lgkmcnt(5)
v_mfma_f32_16x16x32_bf16 v[68:71],a[8:11],v[232:235],v[68:71]
s_add_u32 s65,s88,32768
v_min3_u32 v27,v27,v232,v236
v_fmac_f32 v64,v52,v120
v_fmac_f32 v72,v56,v120
v_mfma_f32_16x16x32_bf16 v[76:79],a[136:139],v[232:235],v[76:79]
ds_read_b128 v[228:231],v17 offset:19456
buffer_load_dwordx4 v16,s[20:23],s65 offen offset:0 sc1 lds
v_fmac_f32 v73,v57,v120
v_mfma_f32_16x16x32_bf16 v[68:71],a[12:15],v[236:239],v[68:71]
v_fmac_f32 v65,v53,v120
v_fmac_f32 v66,v54,v120
v_fmac_f32 v67,v55,v120
v_fmac_f32 v74,v58,v120
v_mfma_f32_16x16x32_bf16 v[76:79],a[140:143],v[236:239],v[76:79]
ds_read_b128 v[232:235],v17 offset:21504
v_mul_f32 v88,v64,v64
v_fmac_f32 v75,v59,v120
s_waitcnt lgkmcnt(5)
v_mfma_f32_16x16x32_bf16 v[68:71],a[16:19],v[240:243],v[68:71]
buffer_load_dwordx4 v16,s[20:23],s65 offen offset:2048 sc1 lds
s_xor_b32 m0,s72,32768
v_mul_f32 v92,v72,v72
v_mfma_f32_16x16x32_bf16 v[76:79],a[144:147],v[240:243],v[76:79]
ds_read_b128 v[236:239],v17 offset:23552
s_add_u32 s65,s88,65536
v_mul_f32 v89,v65,v65
v_mul_f32 v93,v73,v73
v_mfma_f32_16x16x32_bf16 v[68:71],a[20:23],v[244:247],v[68:71]
v_min3_u32 v27,v27,v240,v244
v_mul_f32 v90,v66,v66
v_mul_f32 v91,v67,v67
v_mul_f32 v94,v74,v74
v_mfma_f32_16x16x32_bf16 v[76:79],a[148:151],v[244:247],v[76:79]
ds_read_b128 v[240:243],v17 offset:25600
v_fma_f32 v88,v88,v121,v122
v_mul_f32 v95,v75,v75
s_waitcnt lgkmcnt(5)
v_mfma_f32_16x16x32_bf16 v[68:71],a[24:27],v[248:251],v[68:71]
buffer_load_dwordx4 v16,s[20:23],s65 offen offset:0 sc1 lds
v_fma_f32 v89,v89,v121,v122
v_fma_f32 v92,v92,v121,v122
v_mfma_f32_16x16x32_bf16 v[76:79],a[152:155],v[248:251],v[76:79]
ds_read_b128 v[244:247],v17 offset:27648
buffer_load_dwordx4 v16,s[20:23],s65 offen offset:2048 sc1 lds
v_fma_f32 v93,v93,v121,v122
v_mfma_f32_16x16x32_bf16 v[68:71],a[28:31],v[252:255],v[68:71]
s_xor_b32 m0,s72,49152
v_min3_u32 v27,v27,v248,v252
v_fma_f32 v90,v90,v121,v122
v_fma_f32 v94,v94,v121,v122
v_mfma_f32_16x16x32_bf16 v[76:79],a[156:159],v[252:255],v[76:79]
ds_read_b128 v[248:251],v17 offset:29696
s_add_u32 s65,s88,98304
v_fma_f32 v95,v95,v121,v122
s_waitcnt lgkmcnt(5)
v_mfma_f32_16x16x32_bf16 v[68:71],a[32:35],v[224:227],v[68:71]
buffer_load_dwordx4 v16,s[20:23],s65 offen offset:0 sc1 lds
v_fma_f32 v91,v91,v121,v122
v_mul_f32 v92,v92,v72
v_mfma_f32_16x16x32_bf16 v[76:79],a[160:163],v[224:227],v[76:79]
ds_read_b128 v[252:255],v17 offset:31744
v_min3_u32 v27,v27,v224,v228
v_mul_f32 v88,v88,v64
v_mul_f32 v93,v93,v73
v_mfma_f32_16x16x32_bf16 v[68:71],a[36:39],v[228:231],v[68:71]
buffer_load_dwordx4 v16,s[20:23],s65 offen offset:2048 sc1 lds
v_mul_f32 v89,v89,v65
v_mul_f32 v94,v94,v74
v_mfma_f32_16x16x32_bf16 v[76:79],a[164:167],v[228:231],v[76:79]
s_waitcnt vmcnt(8)
s_barrier
ds_read_b128 v[224:227],v17 offset:33792
s_waitcnt lgkmcnt(5)
v_mfma_f32_16x16x32_bf16 v[68:71],a[40:43],v[232:235],v[68:71]
s_xor_b32 m0,s72,1024
s_add_u32 s65,s89,0
v_mul_f32 v90,v90,v66
v_mul_f32 v95,v95,v75
v_mfma_f32_16x16x32_bf16 v[76:79],a[168:171],v[232:235],v[76:79]
ds_read_b128 v[228:231],v17 offset:35840
v_min3_u32 v27,v27,v232,v236
v_mul_f32 v91,v91,v67
v_mfma_f32_16x16x32_bf16 v[68:71],a[44:47],v[236:239],v[68:71]
buffer_load_dwordx4 v16,s[20:23],s65 offen offset:0 sc1 lds
v_exp_f32 v92,v92
v_mfma_f32_16x16x32_bf16 v[76:79],a[172:175],v[236:239],v[76:79]
ds_read_b128 v[232:235],v17 offset:37888
v_exp_f32 v93,v93
s_waitcnt lgkmcnt(5)
v_mfma_f32_16x16x32_bf16 v[68:71],a[48:51],v[240:243],v[68:71]
buffer_load_dwordx4 v16,s[20:23],s65 offen offset:2048 sc1 lds
v_exp_f32 v94,v94
v_mfma_f32_16x16x32_bf16 v[76:79],a[176:179],v[240:243],v[76:79]
ds_read_b128 v[236:239],v17 offset:39936
s_xor_b32 m0,s72,17408
v_exp_f32 v95,v95
v_mfma_f32_16x16x32_bf16 v[68:71],a[52:55],v[244:247],v[68:71]
s_add_u32 s65,s89,32768
v_min3_u32 v27,v27,v240,v244
v_fma_f32 v92,v92,v123,v123
v_fma_f32 v93,v93,v123,v123
v_mfma_f32_16x16x32_bf16 v[76:79],a[180:183],v[244:247],v[76:79]
ds_read_b128 v[240:243],v17 offset:41984
v_fma_f32 v94,v94,v123,v123
v_fma_f32 v95,v95,v123,v123
s_waitcnt lgkmcnt(5)
v_mfma_f32_16x16x32_bf16 v[68:71],a[56:59],v[248:251],v[68:71]
buffer_load_dwordx4 v16,s[20:23],s65 offen offset:0 sc1 lds
v_rcp_f32 v92,v92
v_mfma_f32_16x16x32_bf16 v[76:79],a[184:187],v[248:251],v[76:79]
ds_read_b128 v[244:247],v17 offset:44032
v_min3_u32 v27,v27,v248,v252
v_rcp_f32 v93,v93
v_mfma_f32_16x16x32_bf16 v[68:71],a[60:63],v[252:255],v[68:71]
buffer_load_dwordx4 v16,s[20:23],s65 offen offset:2048 sc1 lds
v_rcp_f32 v94,v94
v_mfma_f32_16x16x32_bf16 v[76:79],a[188:191],v[252:255],v[76:79]
ds_read_b128 v[248:251],v17 offset:46080
v_rcp_f32 v95,v95
s_waitcnt lgkmcnt(5)
v_mfma_f32_16x16x32_bf16 v[68:71],a[64:67],v[224:227],v[68:71]
s_xor_b32 m0,s72,33792
s_add_u32 s65,s89,65536
v_mul_f32 v92,v92,v72
v_mul_f32 v93,v93,v73
v_mfma_f32_16x16x32_bf16 v[76:79],a[192:195],v[224:227],v[76:79]
ds_read_b128 v[252:255],v17 offset:48128
v_min3_u32 v27,v27,v224,v228
v_mfma_f32_16x16x32_bf16 v[68:71],a[68:71],v[228:231],v[68:71]
buffer_load_dwordx4 v16,s[20:23],s65 offen offset:0 sc1 lds
v_mfma_f32_16x16x32_bf16 v[76:79],a[196:199],v[228:231],v[76:79]
ds_read_b128 v[224:227],v17 offset:50176
s_waitcnt lgkmcnt(5)
v_mfma_f32_16x16x32_bf16 v[68:71],a[72:75],v[232:235],v[68:71]
buffer_load_dwordx4 v16,s[20:23],s65 offen offset:2048 sc1 lds
v_mfma_f32_16x16x32_bf16 v[76:79],a[200:203],v[232:235],v[76:79]
ds_read_b128 v[228:231],v17 offset:52224
s_xor_b32 m0,s72,50176
v_mfma_f32_16x16x32_bf16 v[68:71],a[76:79],v[236:239],v[68:71]
s_add_u32 s65,s89,98304
v_min3_u32 v27,v27,v232,v236
v_mfma_f32_16x16x32_bf16 v[76:79],a[204:207],v[236:239],v[76:79]
ds_read_b128 v[232:235],v17 offset:54272
s_waitcnt lgkmcnt(5)
v_mfma_f32_16x16x32_bf16 v[68:71],a[80:83],v[240:243],v[68:71]
buffer_load_dwordx4 v16,s[20:23],s65 offen offset:0 sc1 lds
v_mfma_f32_16x16x32_bf16 v[76:79],a[208:211],v[240:243],v[76:79]
ds_read_b128 v[236:239],v17 offset:56320
v_min3_u32 v27,v27,v240,v244
v_mfma_f32_16x16x32_bf16 v[68:71],a[84:87],v[244:247],v[68:71]
buffer_load_dwordx4 v16,s[20:23],s65 offen offset:2048 sc1 lds
v_mfma_f32_16x16x32_bf16 v[76:79],a[212:215],v[244:247],v[76:79]
ds_read_b128 v[240:243],v17 offset:58368
s_waitcnt lgkmcnt(5)
v_mfma_f32_16x16x32_bf16 v[68:71],a[88:91],v[248:251],v[68:71]
v_min3_u32 v27,v27,v248,v252
v_exp_f32 v88,v88
v_mfma_f32_16x16x32_bf16 v[76:79],a[216:219],v[248:251],v[76:79]
ds_read_b128 v[244:247],v17 offset:60416
v_exp_f32 v89,v89
v_mfma_f32_16x16x32_bf16 v[68:71],a[92:95],v[252:255],v[68:71]
v_exp_f32 v90,v90
v_mfma_f32_16x16x32_bf16 v[76:79],a[220:223],v[252:255],v[76:79]
ds_read_b128 v[248:251],v17 offset:62464
s_waitcnt lgkmcnt(5)
v_mfma_f32_16x16x32_bf16 v[68:71],a[96:99],v[224:227],v[68:71]
v_min3_u32 v27,v27,v224,v228
v_exp_f32 v91,v91
v_mfma_f32_16x16x32_bf16 v[76:79],a[224:227],v[224:227],v[76:79]
ds_read_b128 v[252:255],v17 offset:64512
v_fma_f32 v88,v88,v123,v123
v_fma_f32 v89,v89,v123,v123
v_mfma_f32_16x16x32_bf16 v[68:71],a[100:103],v[228:231],v[68:71]
v_fma_f32 v90,v90,v123,v123
v_fma_f32 v91,v91,v123,v123
v_mfma_f32_16x16x32_bf16 v[76:79],a[228:231],v[228:231],v[76:79]
v_rcp_f32 v88,v88
s_waitcnt lgkmcnt(4)
v_mfma_f32_16x16x32_bf16 v[68:71],a[104:107],v[232:235],v[68:71]
v_min3_u32 v27,v27,v232,v236
v_rcp_f32 v89,v89
v_mfma_f32_16x16x32_bf16 v[76:79],a[232:235],v[232:235],v[76:79]
v_rcp_f32 v90,v90
v_mfma_f32_16x16x32_bf16 v[68:71],a[108:111],v[236:239],v[68:71]
v_rcp_f32 v91,v91
v_mfma_f32_16x16x32_bf16 v[76:79],a[236:239],v[236:239],v[76:79]
v_mul_f32 v88,v88,v64
s_waitcnt lgkmcnt(2)
v_mfma_f32_16x16x32_bf16 v[68:71],a[112:115],v[240:243],v[68:71]
v_min3_u32 v27,v27,v240,v244
v_mul_f32 v89,v89,v65
v_mfma_f32_16x16x32_bf16 v[76:79],a[240:243],v[240:243],v[76:79]
v_mul_f32 v90,v90,v66
v_mul_f32 v91,v91,v67
v_mfma_f32_16x16x32_bf16 v[68:71],a[116:119],v[244:247],v[68:71]
v_mul_f32 v94,v94,v74
v_mul_f32 v95,v95,v75
v_mfma_f32_16x16x32_bf16 v[76:79],a[244:247],v[244:247],v[76:79]
v_cvt_pk_bf16_f32 v96,v88,v89
s_waitcnt lgkmcnt(0)
v_mfma_f32_16x16x32_bf16 v[68:71],a[120:123],v[248:251],v[68:71]
v_min3_u32 v27,v27,v248,v252
v_cvt_pk_bf16_f32 v97,v90,v91
v_mfma_f32_16x16x32_bf16 v[76:79],a[248:251],v[248:251],v[76:79]
v_cvt_pk_bf16_f32 v98,v92,v93
v_cvt_pk_bf16_f32 v99,v94,v95
v_mfma_f32_16x16x32_bf16 v[68:71],a[124:127],v[252:255],v[68:71]
v_max_u32 v96,1,v96
v_mfma_f32_16x16x32_bf16 v[76:79],a[252:255],v[252:255],v[76:79]
buffer_store_dwordx4 v[96:99],v18,s[20:23],s70 offen offset:0 sc1
v_cmp_eq_u32 vcc,0,v27
s_cbranch_vccnz retry_377
s_branch epi_380
ahead_379:
s_cmp_eq_u32 s93,0
s_cbranch_scc1 both_381
s_waitcnt vmcnt(12) lgkmcnt(0)
s_barrier
ds_read_b128 v[224:227],v17 offset:0
ds_read_b128 v[228:231],v17 offset:2048
ds_read_b128 v[232:235],v17 offset:4096
ds_read_b128 v[236:239],v17 offset:6144
ds_read_b128 v[240:243],v17 offset:8192
ds_read_b128 v[244:247],v17 offset:10240
ds_read_b128 v[248:251],v17 offset:12288
s_waitcnt lgkmcnt(5)
v_mfma_f32_16x16x32_bf16 v[64:67],a[0:3],v[224:227],0
s_add_u32 s96,s71,1
s_add_u32 s92,s71,2
v_mfma_f32_16x16x32_bf16 v[72:75],a[128:131],v[224:227],0
ds_read_b128 v[252:255],v17 offset:14336
v_min_u32 v27,v224,v228
v_mfma_f32_16x16x32_bf16 v[64:67],a[4:7],v[228:231],v[64:67]
s_cmp_eq_u32 s96,64
s_cselect_b32 s96,99,s96
v_mfma_f32_16x16x32_bf16 v[72:75],a[132:135],v[228:231],v[72:75]
ds_read_b128 v[224:227],v17 offset:16384
s_waitcnt lgkmcnt(5)
v_mfma_f32_16x16x32_bf16 v[64:67],a[8:11],v[232:235],v[64:67]
s_cmp_eq_u32 s92,64
s_cselect_b32 s92,99,s92
v_mfma_f32_16x16x32_bf16 v[72:75],a[136:139],v[232:235],v[72:75]
ds_read_b128 v[228:231],v17 offset:18432
v_min3_u32 v27,v27,v232,v236
v_mfma_f32_16x16x32_bf16 v[64:67],a[12:15],v[236:239],v[64:67]
v_mfma_f32_16x16x32_bf16 v[72:75],a[140:143],v[236:239],v[72:75]
ds_read_b128 v[232:235],v17 offset:20480
s_waitcnt lgkmcnt(5)
v_mfma_f32_16x16x32_bf16 v[64:67],a[16:19],v[240:243],v[64:67]
v_min3_u32 v27,v27,v240,v244
v_mfma_f32_16x16x32_bf16 v[72:75],a[144:147],v[240:243],v[72:75]
ds_read_b128 v[236:239],v17 offset:22528
v_mfma_f32_16x16x32_bf16 v[64:67],a[20:23],v[244:247],v[64:67]
v_mfma_f32_16x16x32_bf16 v[72:75],a[148:151],v[244:247],v[72:75]
ds_read_b128 v[240:243],v17 offset:24576
s_waitcnt lgkmcnt(5)
v_mfma_f32_16x16x32_bf16 v[64:67],a[24:27],v[248:251],v[64:67]
v_min3_u32 v27,v27,v248,v252
v_mfma_f32_16x16x32_bf16 v[72:75],a[152:155],v[248:251],v[72:75]
ds_read_b128 v[244:247],v17 offset:26624
v_mfma_f32_16x16x32_bf16 v[64:67],a[28:31],v[252:255],v[64:67]
v_mfma_f32_16x16x32_bf16 v[72:75],a[156:159],v[252:255],v[72:75]
ds_read_b128 v[248:251],v17 offset:28672
s_waitcnt lgkmcnt(5)
v_mfma_f32_16x16x32_bf16 v[64:67],a[32:35],v[224:227],v[64:67]
v_min3_u32 v27,v27,v224,v228
v_mfma_f32_16x16x32_bf16 v[72:75],a[160:163],v[224:227],v[72:75]
ds_read_b128 v[252:255],v17 offset:30720
v_mfma_f32_16x16x32_bf16 v[64:67],a[36:39],v[228:231],v[64:67]
v_mfma_f32_16x16x32_bf16 v[72:75],a[164:167],v[228:231],v[72:75]
ds_read_b128 v[224:227],v17 offset:32768
s_waitcnt lgkmcnt(5)
v_mfma_f32_16x16x32_bf16 v[64:67],a[40:43],v[232:235],v[64:67]
v_min3_u32 v27,v27,v232,v236
v_mfma_f32_16x16x32_bf16 v[72:75],a[168:171],v[232:235],v[72:75]
ds_read_b128 v[228:231],v17 offset:34816
v_mfma_f32_16x16x32_bf16 v[64:67],a[44:47],v[236:239],v[64:67]
v_mfma_f32_16x16x32_bf16 v[72:75],a[172:175],v[236:239],v[72:75]
ds_read_b128 v[232:235],v17 offset:36864
s_waitcnt lgkmcnt(5)
v_mfma_f32_16x16x32_bf16 v[64:67],a[48:51],v[240:243],v[64:67]
v_min3_u32 v27,v27,v240,v244
v_mfma_f32_16x16x32_bf16 v[72:75],a[176:179],v[240:243],v[72:75]
ds_read_b128 v[236:239],v17 offset:38912
v_mfma_f32_16x16x32_bf16 v[64:67],a[52:55],v[244:247],v[64:67]
v_mfma_f32_16x16x32_bf16 v[72:75],a[180:183],v[244:247],v[72:75]
ds_read_b128 v[240:243],v17 offset:40960
s_waitcnt lgkmcnt(5)
v_mfma_f32_16x16x32_bf16 v[64:67],a[56:59],v[248:251],v[64:67]
v_min3_u32 v27,v27,v248,v252
v_mfma_f32_16x16x32_bf16 v[72:75],a[184:187],v[248:251],v[72:75]
ds_read_b128 v[244:247],v17 offset:43008
s_waitcnt vmcnt(2)
v_mfma_f32_16x16x32_bf16 v[64:67],a[60:63],v[252:255],v[64:67]
v_cmp_gt_u32 vcc,s96,v29
v_cmp_gt_u32 s[92:93],s92,v29
v_mfma_f32_16x16x32_bf16 v[72:75],a[188:191],v[252:255],v[72:75]
ds_read_b128 v[248:251],v17 offset:45056
s_waitcnt lgkmcnt(5)
v_mfma_f32_16x16x32_bf16 v[64:67],a[64:67],v[224:227],v[64:67]
v_mov_b32 v44,vcc_lo
v_mov_b32 v45,s92
v_mfma_f32_16x16x32_bf16 v[72:75],a[192:195],v[224:227],v[72:75]
ds_read_b128 v[252:255],v17 offset:47104
ds_write_b64 v46,v[44:45]
v_mfma_f32_16x16x32_bf16 v[64:67],a[68:71],v[228:231],v[64:67]
v_min3_u32 v27,v27,v224,v228
v_mfma_f32_16x16x32_bf16 v[72:75],a[196:199],v[228:231],v[72:75]
ds_read_b128 v[224:227],v17 offset:49152
s_waitcnt lgkmcnt(6)
v_mfma_f32_16x16x32_bf16 v[64:67],a[72:75],v[232:235],v[64:67]
v_min3_u32 v27,v27,v232,v236
v_mfma_f32_16x16x32_bf16 v[72:75],a[200:203],v[232:235],v[72:75]
ds_read_b128 v[228:231],v17 offset:51200
v_mfma_f32_16x16x32_bf16 v[64:67],a[76:79],v[236:239],v[64:67]
v_mfma_f32_16x16x32_bf16 v[72:75],a[204:207],v[236:239],v[72:75]
ds_read_b128 v[232:235],v17 offset:53248
s_waitcnt lgkmcnt(6)
v_mfma_f32_16x16x32_bf16 v[64:67],a[80:83],v[240:243],v[64:67]
v_min3_u32 v27,v27,v240,v244
s_add_u32 s88,s70,s75
v_mfma_f32_16x16x32_bf16 v[72:75],a[208:211],v[240:243],v[72:75]
ds_read_b128 v[236:239],v17 offset:55296
s_add_u32 s88,s88,2097152
v_mfma_f32_16x16x32_bf16 v[64:67],a[84:87],v[244:247],v[64:67]
s_xor_b32 s88,s88,0x2000
s_xor_b32 s89,s88,1024
v_mfma_f32_16x16x32_bf16 v[72:75],a[212:215],v[244:247],v[72:75]
ds_read_b128 v[240:243],v17 offset:57344
s_waitcnt lgkmcnt(6)
v_mfma_f32_16x16x32_bf16 v[64:67],a[88:91],v[248:251],v[64:67]
v_min3_u32 v27,v27,v248,v252
v_mfma_f32_16x16x32_bf16 v[72:75],a[216:219],v[248:251],v[72:75]
ds_read_b128 v[244:247],v17 offset:59392
v_mfma_f32_16x16x32_bf16 v[64:67],a[92:95],v[252:255],v[64:67]
v_mfma_f32_16x16x32_bf16 v[72:75],a[220:223],v[252:255],v[72:75]
ds_read_b128 v[248:251],v17 offset:61440
s_waitcnt lgkmcnt(5)
v_mfma_f32_16x16x32_bf16 v[64:67],a[96:99],v[224:227],v[64:67]
v_min3_u32 v27,v27,v224,v228
v_mfma_f32_16x16x32_bf16 v[72:75],a[224:227],v[224:227],v[72:75]
ds_read_b128 v[252:255],v17 offset:63488
v_mfma_f32_16x16x32_bf16 v[64:67],a[100:103],v[228:231],v[64:67]
s_waitcnt vmcnt(0)
v_add_u32 v22,s71,-1
v_mfma_f32_16x16x32_bf16 v[72:75],a[228:231],v[228:231],v[72:75]
s_waitcnt vmcnt(4)
s_barrier
ds_read_b64 v[44:45],v47
ds_read_b128 v[224:227],v17 offset:1024
s_waitcnt lgkmcnt(6)
v_mfma_f32_16x16x32_bf16 v[64:67],a[104:107],v[232:235],v[64:67]
v_min3_u32 v27,v27,v232,v236
ds_read_b128 v[124:127],v19 offset:256
v_mfma_f32_16x16x32_bf16 v[72:75],a[232:235],v[232:235],v[72:75]
ds_read_b128 v[228:231],v17 offset:3072
ds_read_b128 v[120:123],v19 offset:0
v_mfma_f32_16x16x32_bf16 v[64:67],a[108:111],v[236:239],v[64:67]
buffer_store_dword v22,v23,s[20:23],s97 offen sc1
v_mfma_f32_16x16x32_bf16 v[72:75],a[236:239],v[236:239],v[72:75]
ds_read_b128 v[232:235],v17 offset:5120
s_waitcnt lgkmcnt(8)
v_mfma_f32_16x16x32_bf16 v[64:67],a[112:115],v[240:243],v[64:67]
v_min3_u32 v27,v27,v240,v244
s_mov_b32 s97,0x7fff0000
v_mfma_f32_16x16x32_bf16 v[72:75],a[240:243],v[240:243],v[72:75]
ds_read_b128 v[236:239],v17 offset:7168
v_mfma_f32_16x16x32_bf16 v[64:67],a[116:119],v[244:247],v[64:67]
v_mfma_f32_16x16x32_bf16 v[72:75],a[244:247],v[244:247],v[72:75]
ds_read_b128 v[240:243],v17 offset:9216
s_waitcnt lgkmcnt(8)
v_mfma_f32_16x16x32_bf16 v[64:67],a[120:123],v[248:251],v[64:67]
s_waitcnt lgkmcnt(7)
v_readfirstlane_b32 s93,v45
v_mfma_f32_16x16x32_bf16 v[72:75],a[248:251],v[248:251],v[72:75]
ds_read_b128 v[244:247],v17 offset:11264
v_readfirstlane_b32 s83,v44
s_cmp_lg_u32 s83,0
s_cbranch_scc1 keep_389
v_mfma_f32_16x16x32_bf16 v[64:67],a[124:127],v[252:255],v[64:67]
v_min3_u32 v27,v27,v248,v252
s_xor_b32 m0,s72,0
v_mfma_f32_16x16x32_bf16 v[72:75],a[252:255],v[252:255],v[72:75]
ds_read_b128 v[248:251],v17 offset:13312
s_add_u32 s65,s88,0
s_waitcnt lgkmcnt(6)
v_mfma_f32_16x16x32_bf16 v[68:71],a[0:3],v[224:227],0
buffer_load_dwordx4 v16,s[20:23],s65 offen offset:0 sc1 lds
v_min3_u32 v27,v27,v224,v228
v_mfma_f32_16x16x32_bf16 v[76:79],a[128:131],v[224:227],0
ds_read_b128 v[252:255],v17 offset:15360
buffer_load_dwordx4 v16,s[20:23],s65 offen offset:2048 sc1 lds
v_mfma_f32_16x16x32_bf16 v[68:71],a[4:7],v[228:231],v[68:71]
v_cmp_eq_u32 vcc,0,v27
s_cbranch_vccnz retry_377
s_waitcnt lgkmcnt(6)
v_mfma_f32_16x16x32_bf16 v[76:79],a[132:135],v[228:231],v[76:79]
ds_read_b128 v[224:227],v17 offset:17408
s_xor_b32 m0,s72,16384
s_waitcnt lgkmcnt(5)
v_mfma_f32_16x16x32_bf16 v[68:71],a[8:11],v[232:235],v[68:71]
s_add_u32 s65,s88,32768
v_min3_u32 v27,v27,v232,v236
v_fmac_f32 v64,v52,v120
v_fmac_f32 v72,v56,v120
v_mfma_f32_16x16x32_bf16 v[76:79],a[136:139],v[232:235],v[76:79]
ds_read_b128 v[228:231],v17 offset:19456
buffer_load_dwordx4 v16,s[20:23],s65 offen offset:0 sc1 lds
v_fmac_f32 v73,v57,v120
v_mfma_f32_16x16x32_bf16 v[68:71],a[12:15],v[236:239],v[68:71]
v_fmac_f32 v65,v53,v120
v_fmac_f32 v66,v54,v120
v_fmac_f32 v67,v55,v120
v_fmac_f32 v74,v58,v120
v_mfma_f32_16x16x32_bf16 v[76:79],a[140:143],v[236:239],v[76:79]
ds_read_b128 v[232:235],v17 offset:21504
v_mul_f32 v88,v64,v64
v_fmac_f32 v75,v59,v120
s_waitcnt lgkmcnt(5)
v_mfma_f32_16x16x32_bf16 v[68:71],a[16:19],v[240:243],v[68:71]
buffer_load_dwordx4 v16,s[20:23],s65 offen offset:2048 sc1 lds
s_xor_b32 m0,s72,32768
v_mul_f32 v92,v72,v72
v_mfma_f32_16x16x32_bf16 v[76:79],a[144:147],v[240:243],v[76:79]
ds_read_b128 v[236:239],v17 offset:23552
s_add_u32 s65,s88,65536
v_mul_f32 v89,v65,v65
v_mul_f32 v93,v73,v73
v_mfma_f32_16x16x32_bf16 v[68:71],a[20:23],v[244:247],v[68:71]
v_min3_u32 v27,v27,v240,v244
v_mul_f32 v90,v66,v66
v_mul_f32 v91,v67,v67
v_mul_f32 v94,v74,v74
v_mfma_f32_16x16x32_bf16 v[76:79],a[148:151],v[244:247],v[76:79]
ds_read_b128 v[240:243],v17 offset:25600
v_fma_f32 v88,v88,v121,v122
v_mul_f32 v95,v75,v75
s_waitcnt lgkmcnt(5)
v_mfma_f32_16x16x32_bf16 v[68:71],a[24:27],v[248:251],v[68:71]
buffer_load_dwordx4 v16,s[20:23],s65 offen offset:0 sc1 lds
v_fma_f32 v89,v89,v121,v122
v_fma_f32 v92,v92,v121,v122
v_mfma_f32_16x16x32_bf16 v[76:79],a[152:155],v[248:251],v[76:79]
ds_read_b128 v[244:247],v17 offset:27648
buffer_load_dwordx4 v16,s[20:23],s65 offen offset:2048 sc1 lds
v_fma_f32 v93,v93,v121,v122
v_mfma_f32_16x16x32_bf16 v[68:71],a[28:31],v[252:255],v[68:71]
s_xor_b32 m0,s72,49152
v_min3_u32 v27,v27,v248,v252
v_fma_f32 v90,v90,v121,v122
v_fma_f32 v94,v94,v121,v122
v_mfma_f32_16x16x32_bf16 v[76:79],a[156:159],v[252:255],v[76:79]
ds_read_b128 v[248:251],v17 offset:29696
s_add_u32 s65,s88,98304
v_fma_f32 v95,v95,v121,v122
s_waitcnt lgkmcnt(5)
v_mfma_f32_16x16x32_bf16 v[68:71],a[32:35],v[224:227],v[68:71]
buffer_load_dwordx4 v16,s[20:23],s65 offen offset:0 sc1 lds
v_fma_f32 v91,v91,v121,v122
v_mul_f32 v92,v92,v72
v_mfma_f32_16x16x32_bf16 v[76:79],a[160:163],v[224:227],v[76:79]
ds_read_b128 v[252:255],v17 offset:31744
v_min3_u32 v27,v27,v224,v228
v_mul_f32 v88,v88,v64
v_mul_f32 v93,v93,v73
v_mfma_f32_16x16x32_bf16 v[68:71],a[36:39],v[228:231],v[68:71]
buffer_load_dwordx4 v16,s[20:23],s65 offen offset:2048 sc1 lds
v_mul_f32 v89,v89,v65
v_mul_f32 v94,v94,v74
v_mfma_f32_16x16x32_bf16 v[76:79],a[164:167],v[228:231],v[76:79]
ds_read_b128 v[224:227],v17 offset:33792
v_mul_f32 v90,v90,v66
v_mul_f32 v95,v95,v75
s_waitcnt lgkmcnt(5)
v_mfma_f32_16x16x32_bf16 v[68:71],a[40:43],v[232:235],v[68:71]
s_xor_b32 m0,s72,1024
s_add_u32 s65,s89,0
v_mul_f32 v91,v91,v67
v_mfma_f32_16x16x32_bf16 v[76:79],a[168:171],v[232:235],v[76:79]
ds_read_b128 v[228:231],v17 offset:35840
v_min3_u32 v27,v27,v232,v236
v_exp_f32 v92,v92
v_mfma_f32_16x16x32_bf16 v[68:71],a[44:47],v[236:239],v[68:71]
buffer_load_dwordx4 v16,s[20:23],s65 offen offset:0 sc1 lds
v_exp_f32 v93,v93
v_mfma_f32_16x16x32_bf16 v[76:79],a[172:175],v[236:239],v[76:79]
ds_read_b128 v[232:235],v17 offset:37888
v_exp_f32 v94,v94
s_waitcnt lgkmcnt(5)
v_mfma_f32_16x16x32_bf16 v[68:71],a[48:51],v[240:243],v[68:71]
buffer_load_dwordx4 v16,s[20:23],s65 offen offset:2048 sc1 lds
v_exp_f32 v95,v95
v_mfma_f32_16x16x32_bf16 v[76:79],a[176:179],v[240:243],v[76:79]
ds_read_b128 v[236:239],v17 offset:39936
s_xor_b32 m0,s72,17408
v_fma_f32 v92,v92,v123,v123
v_fma_f32 v93,v93,v123,v123
v_mfma_f32_16x16x32_bf16 v[68:71],a[52:55],v[244:247],v[68:71]
s_add_u32 s65,s89,32768
v_min3_u32 v27,v27,v240,v244
v_fma_f32 v94,v94,v123,v123
v_fma_f32 v95,v95,v123,v123
v_mfma_f32_16x16x32_bf16 v[76:79],a[180:183],v[244:247],v[76:79]
ds_read_b128 v[240:243],v17 offset:41984
v_rcp_f32 v92,v92
s_waitcnt lgkmcnt(5)
v_mfma_f32_16x16x32_bf16 v[68:71],a[56:59],v[248:251],v[68:71]
buffer_load_dwordx4 v16,s[20:23],s65 offen offset:0 sc1 lds
v_rcp_f32 v93,v93
v_mfma_f32_16x16x32_bf16 v[76:79],a[184:187],v[248:251],v[76:79]
ds_read_b128 v[244:247],v17 offset:44032
v_min3_u32 v27,v27,v248,v252
v_rcp_f32 v94,v94
v_mfma_f32_16x16x32_bf16 v[68:71],a[60:63],v[252:255],v[68:71]
buffer_load_dwordx4 v16,s[20:23],s65 offen offset:2048 sc1 lds
v_rcp_f32 v95,v95
v_mfma_f32_16x16x32_bf16 v[76:79],a[188:191],v[252:255],v[76:79]
ds_read_b128 v[248:251],v17 offset:46080
v_mul_f32 v92,v92,v72
v_mul_f32 v93,v93,v73
s_waitcnt lgkmcnt(5)
v_mfma_f32_16x16x32_bf16 v[68:71],a[64:67],v[224:227],v[68:71]
s_xor_b32 m0,s72,33792
s_add_u32 s65,s89,65536
v_mfma_f32_16x16x32_bf16 v[76:79],a[192:195],v[224:227],v[76:79]
ds_read_b128 v[252:255],v17 offset:48128
v_min3_u32 v27,v27,v224,v228
v_mfma_f32_16x16x32_bf16 v[68:71],a[68:71],v[228:231],v[68:71]
buffer_load_dwordx4 v16,s[20:23],s65 offen offset:0 sc1 lds
v_mfma_f32_16x16x32_bf16 v[76:79],a[196:199],v[228:231],v[76:79]
ds_read_b128 v[224:227],v17 offset:50176
s_waitcnt lgkmcnt(5)
v_mfma_f32_16x16x32_bf16 v[68:71],a[72:75],v[232:235],v[68:71]
buffer_load_dwordx4 v16,s[20:23],s65 offen offset:2048 sc1 lds
v_mfma_f32_16x16x32_bf16 v[76:79],a[200:203],v[232:235],v[76:79]
ds_read_b128 v[228:231],v17 offset:52224
s_xor_b32 m0,s72,50176
v_mfma_f32_16x16x32_bf16 v[68:71],a[76:79],v[236:239],v[68:71]
s_add_u32 s65,s89,98304
v_min3_u32 v27,v27,v232,v236
v_mfma_f32_16x16x32_bf16 v[76:79],a[204:207],v[236:239],v[76:79]
ds_read_b128 v[232:235],v17 offset:54272
s_waitcnt lgkmcnt(5)
v_mfma_f32_16x16x32_bf16 v[68:71],a[80:83],v[240:243],v[68:71]
buffer_load_dwordx4 v16,s[20:23],s65 offen offset:0 sc1 lds
v_mfma_f32_16x16x32_bf16 v[76:79],a[208:211],v[240:243],v[76:79]
ds_read_b128 v[236:239],v17 offset:56320
v_min3_u32 v27,v27,v240,v244
v_mfma_f32_16x16x32_bf16 v[68:71],a[84:87],v[244:247],v[68:71]
buffer_load_dwordx4 v16,s[20:23],s65 offen offset:2048 sc1 lds
v_mfma_f32_16x16x32_bf16 v[76:79],a[212:215],v[244:247],v[76:79]
ds_read_b128 v[240:243],v17 offset:58368
s_waitcnt lgkmcnt(5)
v_mfma_f32_16x16x32_bf16 v[68:71],a[88:91],v[248:251],v[68:71]
v_min3_u32 v27,v27,v248,v252
v_exp_f32 v88,v88
v_mfma_f32_16x16x32_bf16 v[76:79],a[216:219],v[248:251],v[76:79]
ds_read_b128 v[244:247],v17 offset:60416
v_exp_f32 v89,v89
v_mfma_f32_16x16x32_bf16 v[68:71],a[92:95],v[252:255],v[68:71]
v_exp_f32 v90,v90
v_mfma_f32_16x16x32_bf16 v[76:79],a[220:223],v[252:255],v[76:79]
ds_read_b128 v[248:251],v17 offset:62464
s_waitcnt lgkmcnt(5)
v_mfma_f32_16x16x32_bf16 v[68:71],a[96:99],v[224:227],v[68:71]
v_min3_u32 v27,v27,v224,v228
v_exp_f32 v91,v91
v_mfma_f32_16x16x32_bf16 v[76:79],a[224:227],v[224:227],v[76:79]
ds_read_b128 v[252:255],v17 offset:64512
v_fma_f32 v88,v88,v123,v123
v_fma_f32 v89,v89,v123,v123
v_mfma_f32_16x16x32_bf16 v[68:71],a[100:103],v[228:231],v[68:71]
v_fma_f32 v90,v90,v123,v123
v_fma_f32 v91,v91,v123,v123
v_mfma_f32_16x16x32_bf16 v[76:79],a[228:231],v[228:231],v[76:79]
v_rcp_f32 v88,v88
s_waitcnt lgkmcnt(4)
v_mfma_f32_16x16x32_bf16 v[68:71],a[104:107],v[232:235],v[68:71]
v_min3_u32 v27,v27,v232,v236
v_rcp_f32 v89,v89
v_mfma_f32_16x16x32_bf16 v[76:79],a[232:235],v[232:235],v[76:79]
v_rcp_f32 v90,v90
v_mfma_f32_16x16x32_bf16 v[68:71],a[108:111],v[236:239],v[68:71]
v_rcp_f32 v91,v91
v_mfma_f32_16x16x32_bf16 v[76:79],a[236:239],v[236:239],v[76:79]
v_mul_f32 v88,v88,v64
s_waitcnt lgkmcnt(2)
v_mfma_f32_16x16x32_bf16 v[68:71],a[112:115],v[240:243],v[68:71]
v_min3_u32 v27,v27,v240,v244
v_mul_f32 v89,v89,v65
v_mfma_f32_16x16x32_bf16 v[76:79],a[240:243],v[240:243],v[76:79]
v_mul_f32 v90,v90,v66
v_mul_f32 v91,v91,v67
v_mfma_f32_16x16x32_bf16 v[68:71],a[116:119],v[244:247],v[68:71]
v_mul_f32 v94,v94,v74
v_mul_f32 v95,v95,v75
v_mfma_f32_16x16x32_bf16 v[76:79],a[244:247],v[244:247],v[76:79]
v_cvt_pk_bf16_f32 v96,v88,v89
s_waitcnt lgkmcnt(0)
v_mfma_f32_16x16x32_bf16 v[68:71],a[120:123],v[248:251],v[68:71]
v_min3_u32 v27,v27,v248,v252
v_cvt_pk_bf16_f32 v97,v90,v91
v_mfma_f32_16x16x32_bf16 v[76:79],a[248:251],v[248:251],v[76:79]
v_cvt_pk_bf16_f32 v98,v92,v93
v_cvt_pk_bf16_f32 v99,v94,v95
v_mfma_f32_16x16x32_bf16 v[68:71],a[124:127],v[252:255],v[68:71]
v_max_u32 v96,1,v96
v_mfma_f32_16x16x32_bf16 v[76:79],a[252:255],v[252:255],v[76:79]
buffer_store_dwordx4 v[96:99],v18,s[20:23],s70 offen offset:0 sc1
v_cmp_eq_u32 vcc,0,v27
s_cbranch_vccnz retry_377
s_branch epi_380
keep_389:
v_mfma_f32_16x16x32_bf16 v[64:67],a[124:127],v[252:255],v[64:67]
v_min3_u32 v27,v27,v248,v252
v_mfma_f32_16x16x32_bf16 v[72:75],a[252:255],v[252:255],v[72:75]
ds_read_b128 v[248:251],v17 offset:13312
s_waitcnt lgkmcnt(6)
v_mfma_f32_16x16x32_bf16 v[68:71],a[0:3],v[224:227],0
v_cmp_eq_u32 vcc,0,v27
s_cbranch_vccnz retry_377
v_mfma_f32_16x16x32_bf16 v[76:79],a[128:131],v[224:227],0
ds_read_b128 v[252:255],v17 offset:15360
v_min3_u32 v27,v27,v224,v228
v_mfma_f32_16x16x32_bf16 v[68:71],a[4:7],v[228:231],v[68:71]
s_waitcnt lgkmcnt(6)
v_mfma_f32_16x16x32_bf16 v[76:79],a[132:135],v[228:231],v[76:79]
ds_read_b128 v[224:227],v17 offset:17408
s_waitcnt lgkmcnt(5)
v_mfma_f32_16x16x32_bf16 v[68:71],a[8:11],v[232:235],v[68:71]
v_min3_u32 v27,v27,v232,v236
v_fmac_f32 v64,v52,v120
v_fmac_f32 v72,v56,v120
v_mfma_f32_16x16x32_bf16 v[76:79],a[136:139],v[232:235],v[76:79]
ds_read_b128 v[228:231],v17 offset:19456
v_fmac_f32 v65,v53,v120
v_fmac_f32 v73,v57,v120
v_mfma_f32_16x16x32_bf16 v[68:71],a[12:15],v[236:239],v[68:71]
v_fmac_f32 v66,v54,v120
v_fmac_f32 v67,v55,v120
v_fmac_f32 v74,v58,v120
v_mfma_f32_16x16x32_bf16 v[76:79],a[140:143],v[236:239],v[76:79]
ds_read_b128 v[232:235],v17 offset:21504
v_fmac_f32 v75,v59,v120
s_waitcnt lgkmcnt(5)
v_mfma_f32_16x16x32_bf16 v[68:71],a[16:19],v[240:243],v[68:71]
v_min3_u32 v27,v27,v240,v244
v_mul_f32 v88,v64,v64
v_mul_f32 v92,v72,v72
v_mfma_f32_16x16x32_bf16 v[76:79],a[144:147],v[240:243],v[76:79]
ds_read_b128 v[236:239],v17 offset:23552
v_mul_f32 v89,v65,v65
v_mul_f32 v93,v73,v73
v_mfma_f32_16x16x32_bf16 v[68:71],a[20:23],v[244:247],v[68:71]
v_mul_f32 v90,v66,v66
v_mul_f32 v91,v67,v67
v_mul_f32 v94,v74,v74
v_mfma_f32_16x16x32_bf16 v[76:79],a[148:151],v[244:247],v[76:79]
ds_read_b128 v[240:243],v17 offset:25600
v_mul_f32 v95,v75,v75
s_waitcnt lgkmcnt(5)
v_mfma_f32_16x16x32_bf16 v[68:71],a[24:27],v[248:251],v[68:71]
v_min3_u32 v27,v27,v248,v252
v_fma_f32 v88,v88,v121,v122
v_fma_f32 v92,v92,v121,v122
v_mfma_f32_16x16x32_bf16 v[76:79],a[152:155],v[248:251],v[76:79]
ds_read_b128 v[244:247],v17 offset:27648
v_fma_f32 v89,v89,v121,v122
v_fma_f32 v93,v93,v121,v122
v_mfma_f32_16x16x32_bf16 v[68:71],a[28:31],v[252:255],v[68:71]
v_fma_f32 v90,v90,v121,v122
v_fma_f32 v91,v91,v121,v122
v_fma_f32 v94,v94,v121,v122
v_mfma_f32_16x16x32_bf16 v[76:79],a[156:159],v[252:255],v[76:79]
ds_read_b128 v[248:251],v17 offset:29696
v_fma_f32 v95,v95,v121,v122
s_waitcnt lgkmcnt(5)
v_mfma_f32_16x16x32_bf16 v[68:71],a[32:35],v[224:227],v[68:71]
v_min3_u32 v27,v27,v224,v228
v_mul_f32 v88,v88,v64
v_mul_f32 v92,v92,v72
v_mfma_f32_16x16x32_bf16 v[76:79],a[160:163],v[224:227],v[76:79]
ds_read_b128 v[252:255],v17 offset:31744
v_mul_f32 v89,v89,v65
v_mul_f32 v93,v93,v73
v_mfma_f32_16x16x32_bf16 v[68:71],a[36:39],v[228:231],v[68:71]
v_mul_f32 v90,v90,v66
v_mul_f32 v91,v91,v67
v_mul_f32 v94,v94,v74
v_mfma_f32_16x16x32_bf16 v[76:79],a[164:167],v[228:231],v[76:79]
ds_read_b128 v[224:227],v17 offset:33792
v_mul_f32 v95,v95,v75
s_waitcnt lgkmcnt(5)
v_mfma_f32_16x16x32_bf16 v[68:71],a[40:43],v[232:235],v[68:71]
v_min3_u32 v27,v27,v232,v236
v_exp_f32 v92,v92
v_mfma_f32_16x16x32_bf16 v[76:79],a[168:171],v[232:235],v[76:79]
ds_read_b128 v[228:231],v17 offset:35840
v_exp_f32 v93,v93
v_mfma_f32_16x16x32_bf16 v[68:71],a[44:47],v[236:239],v[68:71]
v_exp_f32 v88,v88
v_mfma_f32_16x16x32_bf16 v[76:79],a[172:175],v[236:239],v[76:79]
ds_read_b128 v[232:235],v17 offset:37888
s_waitcnt lgkmcnt(5)
v_mfma_f32_16x16x32_bf16 v[68:71],a[48:51],v[240:243],v[68:71]
v_min3_u32 v27,v27,v240,v244
v_exp_f32 v94,v94
v_mfma_f32_16x16x32_bf16 v[76:79],a[176:179],v[240:243],v[76:79]
ds_read_b128 v[236:239],v17 offset:39936
v_exp_f32 v95,v95
v_mfma_f32_16x16x32_bf16 v[68:71],a[52:55],v[244:247],v[68:71]
v_exp_f32 v89,v89
v_fma_f32 v92,v92,v123,v123
v_mfma_f32_16x16x32_bf16 v[76:79],a[180:183],v[244:247],v[76:79]
ds_read_b128 v[240:243],v17 offset:41984
v_fma_f32 v93,v93,v123,v123
s_waitcnt lgkmcnt(5)
v_mfma_f32_16x16x32_bf16 v[68:71],a[56:59],v[248:251],v[68:71]
v_min3_u32 v27,v27,v248,v252
v_fma_f32 v94,v94,v123,v123
v_fma_f32 v95,v95,v123,v123
v_mfma_f32_16x16x32_bf16 v[76:79],a[184:187],v[248:251],v[76:79]
ds_read_b128 v[244:247],v17 offset:44032
v_rcp_f32 v92,v92
v_mfma_f32_16x16x32_bf16 v[68:71],a[60:63],v[252:255],v[68:71]
v_exp_f32 v90,v90
v_mfma_f32_16x16x32_bf16 v[76:79],a[188:191],v[252:255],v[76:79]
ds_read_b128 v[248:251],v17 offset:46080
s_waitcnt lgkmcnt(5)
v_mfma_f32_16x16x32_bf16 v[68:71],a[64:67],v[224:227],v[68:71]
v_min3_u32 v27,v27,v224,v228
v_rcp_f32 v93,v93
v_mfma_f32_16x16x32_bf16 v[76:79],a[192:195],v[224:227],v[76:79]
ds_read_b128 v[252:255],v17 offset:48128
v_rcp_f32 v94,v94
v_mfma_f32_16x16x32_bf16 v[68:71],a[68:71],v[228:231],v[68:71]
v_exp_f32 v91,v91
v_mfma_f32_16x16x32_bf16 v[76:79],a[196:199],v[228:231],v[76:79]
ds_read_b128 v[224:227],v17 offset:50176
s_waitcnt lgkmcnt(5)
v_mfma_f32_16x16x32_bf16 v[68:71],a[72:75],v[232:235],v[68:71]
v_min3_u32 v27,v27,v232,v236
v_fma_f32 v88,v88,v123,v123
v_mfma_f32_16x16x32_bf16 v[76:79],a[200:203],v[232:235],v[76:79]
ds_read_b128 v[228:231],v17 offset:52224
v_fma_f32 v89,v89,v123,v123
v_mfma_f32_16x16x32_bf16 v[68:71],a[76:79],v[236:239],v[68:71]
v_fma_f32 v90,v90,v123,v123
v_fma_f32 v91,v91,v123,v123
v_mfma_f32_16x16x32_bf16 v[76:79],a[204:207],v[236:239],v[76:79]
ds_read_b128 v[232:235],v17 offset:54272
s_waitcnt lgkmcnt(5)
v_mfma_f32_16x16x32_bf16 v[68:71],a[80:83],v[240:243],v[68:71]
v_min3_u32 v27,v27,v240,v244
v_rcp_f32 v95,v95
v_mfma_f32_16x16x32_bf16 v[76:79],a[208:211],v[240:243],v[76:79]
ds_read_b128 v[236:239],v17 offset:56320
v_mul_f32 v92,v92,v72
v_mfma_f32_16x16x32_bf16 v[68:71],a[84:87],v[244:247],v[68:71]
v_rcp_f32 v88,v88
v_mfma_f32_16x16x32_bf16 v[76:79],a[212:215],v[244:247],v[76:79]
ds_read_b128 v[240:243],v17 offset:58368
s_waitcnt lgkmcnt(5)
v_mfma_f32_16x16x32_bf16 v[68:71],a[88:91],v[248:251],v[68:71]
v_min3_u32 v27,v27,v248,v252
v_mul_f32 v93,v93,v73
v_mfma_f32_16x16x32_bf16 v[76:79],a[216:219],v[248:251],v[76:79]
ds_read_b128 v[244:247],v17 offset:60416
v_mul_f32 v94,v94,v74
v_mfma_f32_16x16x32_bf16 v[68:71],a[92:95],v[252:255],v[68:71]
v_rcp_f32 v89,v89
v_mfma_f32_16x16x32_bf16 v[76:79],a[220:223],v[252:255],v[76:79]
ds_read_b128 v[248:251],v17 offset:62464
s_waitcnt lgkmcnt(5)
v_mfma_f32_16x16x32_bf16 v[68:71],a[96:99],v[224:227],v[68:71]
v_min3_u32 v27,v27,v224,v228
v_mul_f32 v95,v95,v75
v_mfma_f32_16x16x32_bf16 v[76:79],a[224:227],v[224:227],v[76:79]
ds_read_b128 v[252:255],v17 offset:64512
v_mfma_f32_16x16x32_bf16 v[68:71],a[100:103],v[228:231],v[68:71]
v_rcp_f32 v90,v90
v_mfma_f32_16x16x32_bf16 v[76:79],a[228:231],v[228:231],v[76:79]
s_waitcnt lgkmcnt(4)
v_mfma_f32_16x16x32_bf16 v[68:71],a[104:107],v[232:235],v[68:71]
v_min3_u32 v27,v27,v232,v236
v_mfma_f32_16x16x32_bf16 v[76:79],a[232:235],v[232:235],v[76:79]
v_rcp_f32 v91,v91
v_mfma_f32_16x16x32_bf16 v[68:71],a[108:111],v[236:239],v[68:71]
v_mul_f32 v88,v88,v64
v_mul_f32 v89,v89,v65
v_mfma_f32_16x16x32_bf16 v[76:79],a[236:239],v[236:239],v[76:79]
v_mul_f32 v90,v90,v66
s_waitcnt lgkmcnt(2)
v_mfma_f32_16x16x32_bf16 v[68:71],a[112:115],v[240:243],v[68:71]
v_min3_u32 v27,v27,v240,v244
v_mul_f32 v91,v91,v67
v_mfma_f32_16x16x32_bf16 v[76:79],a[240:243],v[240:243],v[76:79]
v_cvt_pk_bf16_f32 v96,v88,v89
v_cvt_pk_bf16_f32 v97,v90,v91
v_mfma_f32_16x16x32_bf16 v[68:71],a[116:119],v[244:247],v[68:71]
v_cvt_pk_bf16_f32 v98,v92,v93
v_cvt_pk_bf16_f32 v99,v94,v95
v_mfma_f32_16x16x32_bf16 v[76:79],a[244:247],v[244:247],v[76:79]
v_max_u32 v96,1,v96
s_waitcnt lgkmcnt(0)
v_mfma_f32_16x16x32_bf16 v[68:71],a[120:123],v[248:251],v[68:71]
v_min3_u32 v27,v27,v248,v252
v_mfma_f32_16x16x32_bf16 v[76:79],a[248:251],v[248:251],v[76:79]
buffer_store_dwordx4 v[96:99],v18,s[20:23],s70 offen offset:0 sc1
v_mfma_f32_16x16x32_bf16 v[68:71],a[124:127],v[252:255],v[68:71]
v_mfma_f32_16x16x32_bf16 v[76:79],a[252:255],v[252:255],v[76:79]
v_cmp_eq_u32 vcc,0,v27
s_cbranch_vccnz retry_377
s_branch epi_380
both_381:
s_waitcnt vmcnt(12) lgkmcnt(0)
s_barrier
ds_read_b128 v[224:227],v17 offset:0
ds_read_b128 v[228:231],v17 offset:2048
ds_read_b128 v[232:235],v17 offset:4096
ds_read_b128 v[236:239],v17 offset:6144
ds_read_b128 v[240:243],v17 offset:8192
ds_read_b128 v[244:247],v17 offset:10240
ds_read_b128 v[248:251],v17 offset:12288
s_waitcnt lgkmcnt(5)
v_mfma_f32_16x16x32_bf16 v[64:67],a[0:3],v[224:227],0
s_add_u32 s96,s71,1
s_add_u32 s92,s71,2
s_add_u32 s88,s70,s75
v_mfma_f32_16x16x32_bf16 v[72:75],a[128:131],v[224:227],0
ds_read_b128 v[252:255],v17 offset:14336
s_add_u32 s88,s88,2097152
s_xor_b32 s88,s88,0x2000
v_mfma_f32_16x16x32_bf16 v[64:67],a[4:7],v[228:231],v[64:67]
s_cmp_eq_u32 s96,64
s_cselect_b32 s96,99,s96
v_min_u32 v27,v224,v228
v_mfma_f32_16x16x32_bf16 v[72:75],a[132:135],v[228:231],v[72:75]
ds_read_b128 v[224:227],v17 offset:16384
s_waitcnt lgkmcnt(5)
v_mfma_f32_16x16x32_bf16 v[64:67],a[8:11],v[232:235],v[64:67]
s_cmp_eq_u32 s92,64
s_cselect_b32 s92,99,s92
v_mfma_f32_16x16x32_bf16 v[72:75],a[136:139],v[232:235],v[72:75]
ds_read_b128 v[228:231],v17 offset:18432
s_xor_b32 s89,s88,1024
v_mfma_f32_16x16x32_bf16 v[64:67],a[12:15],v[236:239],v[64:67]
s_xor_b32 m0,s72,0
v_min3_u32 v27,v27,v232,v236
v_mfma_f32_16x16x32_bf16 v[72:75],a[140:143],v[236:239],v[72:75]
ds_read_b128 v[232:235],v17 offset:20480
s_add_u32 s65,s88,0
s_waitcnt lgkmcnt(5)
v_mfma_f32_16x16x32_bf16 v[64:67],a[16:19],v[240:243],v[64:67]
v_min3_u32 v27,v27,v240,v244
v_mfma_f32_16x16x32_bf16 v[72:75],a[144:147],v[240:243],v[72:75]
ds_read_b128 v[236:239],v17 offset:22528
buffer_load_dwordx4 v16,s[20:23],s65 offen offset:0 sc1 lds
v_mfma_f32_16x16x32_bf16 v[64:67],a[20:23],v[244:247],v[64:67]
buffer_load_dwordx4 v16,s[20:23],s65 offen offset:2048 sc1 lds
v_mfma_f32_16x16x32_bf16 v[72:75],a[148:151],v[244:247],v[72:75]
ds_read_b128 v[240:243],v17 offset:24576
s_waitcnt lgkmcnt(5)
v_mfma_f32_16x16x32_bf16 v[64:67],a[24:27],v[248:251],v[64:67]
s_xor_b32 m0,s72,16384
v_min3_u32 v27,v27,v248,v252
v_mfma_f32_16x16x32_bf16 v[72:75],a[152:155],v[248:251],v[72:75]
ds_read_b128 v[244:247],v17 offset:26624
v_mfma_f32_16x16x32_bf16 v[64:67],a[28:31],v[252:255],v[64:67]
s_add_u32 s65,s88,32768
v_mfma_f32_16x16x32_bf16 v[72:75],a[156:159],v[252:255],v[72:75]
ds_read_b128 v[248:251],v17 offset:28672
s_waitcnt lgkmcnt(5)
v_mfma_f32_16x16x32_bf16 v[64:67],a[32:35],v[224:227],v[64:67]
buffer_load_dwordx4 v16,s[20:23],s65 offen offset:0 sc1 lds
v_mfma_f32_16x16x32_bf16 v[72:75],a[160:163],v[224:227],v[72:75]
ds_read_b128 v[252:255],v17 offset:30720
buffer_load_dwordx4 v16,s[20:23],s65 offen offset:2048 sc1 lds
v_mfma_f32_16x16x32_bf16 v[64:67],a[36:39],v[228:231],v[64:67]
v_min3_u32 v27,v27,v224,v228
v_mfma_f32_16x16x32_bf16 v[72:75],a[164:167],v[228:231],v[72:75]
ds_read_b128 v[224:227],v17 offset:32768
s_xor_b32 m0,s72,32768
s_waitcnt lgkmcnt(5)
v_mfma_f32_16x16x32_bf16 v[64:67],a[40:43],v[232:235],v[64:67]
s_add_u32 s65,s88,65536
v_min3_u32 v27,v27,v232,v236
v_mfma_f32_16x16x32_bf16 v[72:75],a[168:171],v[232:235],v[72:75]
ds_read_b128 v[228:231],v17 offset:34816
v_mfma_f32_16x16x32_bf16 v[64:67],a[44:47],v[236:239],v[64:67]
buffer_load_dwordx4 v16,s[20:23],s65 offen offset:0 sc1 lds
v_mfma_f32_16x16x32_bf16 v[72:75],a[172:175],v[236:239],v[72:75]
ds_read_b128 v[232:235],v17 offset:36864
s_waitcnt lgkmcnt(5)
v_mfma_f32_16x16x32_bf16 v[64:67],a[48:51],v[240:243],v[64:67]
buffer_load_dwordx4 v16,s[20:23],s65 offen offset:2048 sc1 lds
v_mfma_f32_16x16x32_bf16 v[72:75],a[176:179],v[240:243],v[72:75]
ds_read_b128 v[236:239],v17 offset:38912
s_xor_b32 m0,s72,49152
v_mfma_f32_16x16x32_bf16 v[64:67],a[52:55],v[244:247],v[64:67]
v_min3_u32 v27,v27,v240,v244
v_mfma_f32_16x16x32_bf16 v[72:75],a[180:183],v[244:247],v[72:75]
ds_read_b128 v[240:243],v17 offset:40960
s_add_u32 s65,s88,98304
s_waitcnt lgkmcnt(5)
v_mfma_f32_16x16x32_bf16 v[64:67],a[56:59],v[248:251],v[64:67]
buffer_load_dwordx4 v16,s[20:23],s65 offen offset:0 sc1 lds
v_min3_u32 v27,v27,v248,v252
v_mfma_f32_16x16x32_bf16 v[72:75],a[184:187],v[248:251],v[72:75]
ds_read_b128 v[244:247],v17 offset:43008
s_waitcnt vmcnt(9)
v_mfma_f32_16x16x32_bf16 v[64:67],a[60:63],v[252:255],v[64:67]
v_cmp_gt_u32 vcc,s96,v29
v_cmp_gt_u32 s[92:93],s92,v29
v_mfma_f32_16x16x32_bf16 v[72:75],a[188:191],v[252:255],v[72:75]
ds_read_b128 v[248:251],v17 offset:45056
s_waitcnt lgkmcnt(5)
v_mfma_f32_16x16x32_bf16 v[64:67],a[64:67],v[224:227],v[64:67]
v_mov_b32 v44,vcc_lo
v_mov_b32 v45,s92
v_min3_u32 v27,v27,v224,v228
v_mfma_f32_16x16x32_bf16 v[72:75],a[192:195],v[224:227],v[72:75]
ds_read_b128 v[252:255],v17 offset:47104
ds_write_b64 v46,v[44:45]
v_mfma_f32_16x16x32_bf16 v[64:67],a[68:71],v[228:231],v[64:67]
buffer_load_dwordx4 v16,s[20:23],s65 offen offset:2048 sc1 lds
v_mfma_f32_16x16x32_bf16 v[72:75],a[196:199],v[228:231],v[72:75]
ds_read_b128 v[224:227],v17 offset:49152
s_waitcnt lgkmcnt(6)
v_mfma_f32_16x16x32_bf16 v[64:67],a[72:75],v[232:235],v[64:67]
s_xor_b32 m0,s72,1024
s_add_u32 s65,s89,0
v_mfma_f32_16x16x32_bf16 v[72:75],a[200:203],v[232:235],v[72:75]
ds_read_b128 v[228:231],v17 offset:51200
v_min3_u32 v27,v27,v232,v236
v_mfma_f32_16x16x32_bf16 v[64:67],a[76:79],v[236:239],v[64:67]
buffer_load_dwordx4 v16,s[20:23],s65 offen offset:0 sc1 lds
v_mfma_f32_16x16x32_bf16 v[72:75],a[204:207],v[236:239],v[72:75]
ds_read_b128 v[232:235],v17 offset:53248
s_waitcnt lgkmcnt(6)
v_mfma_f32_16x16x32_bf16 v[64:67],a[80:83],v[240:243],v[64:67]
buffer_load_dwordx4 v16,s[20:23],s65 offen offset:2048 sc1 lds
v_mfma_f32_16x16x32_bf16 v[72:75],a[208:211],v[240:243],v[72:75]
ds_read_b128 v[236:239],v17 offset:55296
s_xor_b32 m0,s72,17408
v_mfma_f32_16x16x32_bf16 v[64:67],a[84:87],v[244:247],v[64:67]
s_add_u32 s65,s89,32768
v_min3_u32 v27,v27,v240,v244
v_mfma_f32_16x16x32_bf16 v[72:75],a[212:215],v[244:247],v[72:75]
ds_read_b128 v[240:243],v17 offset:57344
s_waitcnt lgkmcnt(6)
v_mfma_f32_16x16x32_bf16 v[64:67],a[88:91],v[248:251],v[64:67]
buffer_load_dwordx4 v16,s[20:23],s65 offen offset:0 sc1 lds
v_mfma_f32_16x16x32_bf16 v[72:75],a[216:219],v[248:251],v[72:75]
ds_read_b128 v[244:247],v17 offset:59392
v_min3_u32 v27,v27,v248,v252
v_mfma_f32_16x16x32_bf16 v[64:67],a[92:95],v[252:255],v[64:67]
buffer_load_dwordx4 v16,s[20:23],s65 offen offset:2048 sc1 lds
v_mfma_f32_16x16x32_bf16 v[72:75],a[220:223],v[252:255],v[72:75]
ds_read_b128 v[248:251],v17 offset:61440
s_waitcnt lgkmcnt(5)
v_mfma_f32_16x16x32_bf16 v[64:67],a[96:99],v[224:227],v[64:67]
s_xor_b32 m0,s72,33792
s_add_u32 s65,s89,65536
v_mfma_f32_16x16x32_bf16 v[72:75],a[224:227],v[224:227],v[72:75]
ds_read_b128 v[252:255],v17 offset:63488
v_min3_u32 v27,v27,v224,v228
v_mfma_f32_16x16x32_bf16 v[64:67],a[100:103],v[228:231],v[64:67]
buffer_load_dwordx4 v16,s[20:23],s65 offen offset:0 sc1 lds
s_waitcnt vmcnt(13)
v_add_u32 v22,s71,-1
v_mfma_f32_16x16x32_bf16 v[72:75],a[228:231],v[228:231],v[72:75]
s_waitcnt vmcnt(17)
s_barrier
ds_read_b64 v[44:45],v47
ds_read_b128 v[224:227],v17 offset:1024
s_waitcnt lgkmcnt(6)
v_mfma_f32_16x16x32_bf16 v[64:67],a[104:107],v[232:235],v[64:67]
buffer_load_dwordx4 v16,s[20:23],s65 offen offset:2048 sc1 lds
buffer_store_dword v22,v23,s[20:23],s97 offen sc1
v_mfma_f32_16x16x32_bf16 v[72:75],a[232:235],v[232:235],v[72:75]
ds_read_b128 v[228:231],v17 offset:3072
s_xor_b32 m0,s72,50176
s_mov_b32 s97,0x7fff0000
v_mfma_f32_16x16x32_bf16 v[64:67],a[108:111],v[236:239],v[64:67]
s_add_u32 s65,s89,98304
v_min3_u32 v27,v27,v232,v236
ds_read_b128 v[124:127],v19 offset:256
v_mfma_f32_16x16x32_bf16 v[72:75],a[236:239],v[236:239],v[72:75]
ds_read_b128 v[232:235],v17 offset:5120
ds_read_b128 v[120:123],v19 offset:0
s_waitcnt lgkmcnt(8)
v_mfma_f32_16x16x32_bf16 v[64:67],a[112:115],v[240:243],v[64:67]
buffer_load_dwordx4 v16,s[20:23],s65 offen offset:0 sc1 lds
v_mfma_f32_16x16x32_bf16 v[72:75],a[240:243],v[240:243],v[72:75]
ds_read_b128 v[236:239],v17 offset:7168
v_min3_u32 v27,v27,v240,v244
v_mfma_f32_16x16x32_bf16 v[64:67],a[116:119],v[244:247],v[64:67]
buffer_load_dwordx4 v16,s[20:23],s65 offen offset:2048 sc1 lds
v_mfma_f32_16x16x32_bf16 v[72:75],a[244:247],v[244:247],v[72:75]
ds_read_b128 v[240:243],v17 offset:9216
s_waitcnt lgkmcnt(8)
v_mfma_f32_16x16x32_bf16 v[64:67],a[120:123],v[248:251],v[64:67]
s_waitcnt lgkmcnt(7)
v_readfirstlane_b32 s93,v45
v_mfma_f32_16x16x32_bf16 v[72:75],a[248:251],v[248:251],v[72:75]
ds_read_b128 v[244:247],v17 offset:11264
v_min3_u32 v27,v27,v248,v252
v_mfma_f32_16x16x32_bf16 v[64:67],a[124:127],v[252:255],v[64:67]
v_mfma_f32_16x16x32_bf16 v[72:75],a[252:255],v[252:255],v[72:75]
ds_read_b128 v[248:251],v17 offset:13312
s_waitcnt lgkmcnt(7)
v_mfma_f32_16x16x32_bf16 v[68:71],a[0:3],v[224:227],0
v_cmp_eq_u32 vcc,0,v27
s_cbranch_vccnz retry_377
v_mfma_f32_16x16x32_bf16 v[76:79],a[128:131],v[224:227],0
ds_read_b128 v[252:255],v17 offset:15360
v_min3_u32 v27,v27,v224,v228
v_mfma_f32_16x16x32_bf16 v[68:71],a[4:7],v[228:231],v[68:71]
s_waitcnt lgkmcnt(5)
v_mfma_f32_16x16x32_bf16 v[76:79],a[132:135],v[228:231],v[76:79]
ds_read_b128 v[224:227],v17 offset:17408
s_waitcnt lgkmcnt(5)
v_mfma_f32_16x16x32_bf16 v[68:71],a[8:11],v[232:235],v[68:71]
v_min3_u32 v27,v27,v232,v236
v_fmac_f32 v64,v52,v120
v_fmac_f32 v72,v56,v120
v_mfma_f32_16x16x32_bf16 v[76:79],a[136:139],v[232:235],v[76:79]
ds_read_b128 v[228:231],v17 offset:19456
v_fmac_f32 v65,v53,v120
v_fmac_f32 v73,v57,v120
v_mfma_f32_16x16x32_bf16 v[68:71],a[12:15],v[236:239],v[68:71]
v_fmac_f32 v66,v54,v120
v_fmac_f32 v67,v55,v120
v_fmac_f32 v74,v58,v120
v_mfma_f32_16x16x32_bf16 v[76:79],a[140:143],v[236:239],v[76:79]
ds_read_b128 v[232:235],v17 offset:21504
v_fmac_f32 v75,v59,v120
s_waitcnt lgkmcnt(5)
v_mfma_f32_16x16x32_bf16 v[68:71],a[16:19],v[240:243],v[68:71]
v_min3_u32 v27,v27,v240,v244
v_mul_f32 v88,v64,v64
v_mul_f32 v92,v72,v72
v_mfma_f32_16x16x32_bf16 v[76:79],a[144:147],v[240:243],v[76:79]
ds_read_b128 v[236:239],v17 offset:23552
v_mul_f32 v89,v65,v65
v_mul_f32 v93,v73,v73
v_mfma_f32_16x16x32_bf16 v[68:71],a[20:23],v[244:247],v[68:71]
v_mul_f32 v90,v66,v66
v_mul_f32 v91,v67,v67
v_mul_f32 v94,v74,v74
v_mfma_f32_16x16x32_bf16 v[76:79],a[148:151],v[244:247],v[76:79]
ds_read_b128 v[240:243],v17 offset:25600
v_mul_f32 v95,v75,v75
s_waitcnt lgkmcnt(5)
v_mfma_f32_16x16x32_bf16 v[68:71],a[24:27],v[248:251],v[68:71]
v_min3_u32 v27,v27,v248,v252
v_fma_f32 v88,v88,v121,v122
v_fma_f32 v92,v92,v121,v122
v_mfma_f32_16x16x32_bf16 v[76:79],a[152:155],v[248:251],v[76:79]
ds_read_b128 v[244:247],v17 offset:27648
v_fma_f32 v89,v89,v121,v122
v_fma_f32 v93,v93,v121,v122
v_mfma_f32_16x16x32_bf16 v[68:71],a[28:31],v[252:255],v[68:71]
v_fma_f32 v90,v90,v121,v122
v_fma_f32 v91,v91,v121,v122
v_fma_f32 v94,v94,v121,v122
v_mfma_f32_16x16x32_bf16 v[76:79],a[156:159],v[252:255],v[76:79]
ds_read_b128 v[248:251],v17 offset:29696
v_fma_f32 v95,v95,v121,v122
s_waitcnt lgkmcnt(5)
v_mfma_f32_16x16x32_bf16 v[68:71],a[32:35],v[224:227],v[68:71]
v_min3_u32 v27,v27,v224,v228
v_mul_f32 v88,v88,v64
v_mul_f32 v92,v92,v72
v_mfma_f32_16x16x32_bf16 v[76:79],a[160:163],v[224:227],v[76:79]
ds_read_b128 v[252:255],v17 offset:31744
v_mul_f32 v89,v89,v65
v_mul_f32 v93,v93,v73
v_mfma_f32_16x16x32_bf16 v[68:71],a[36:39],v[228:231],v[68:71]
v_mul_f32 v90,v90,v66
v_mul_f32 v91,v91,v67
v_mul_f32 v94,v94,v74
v_mfma_f32_16x16x32_bf16 v[76:79],a[164:167],v[228:231],v[76:79]
ds_read_b128 v[224:227],v17 offset:33792
v_mul_f32 v95,v95,v75
s_waitcnt lgkmcnt(5)
v_mfma_f32_16x16x32_bf16 v[68:71],a[40:43],v[232:235],v[68:71]
v_min3_u32 v27,v27,v232,v236
v_exp_f32 v92,v92
v_mfma_f32_16x16x32_bf16 v[76:79],a[168:171],v[232:235],v[76:79]
ds_read_b128 v[228:231],v17 offset:35840
v_exp_f32 v93,v93
v_mfma_f32_16x16x32_bf16 v[68:71],a[44:47],v[236:239],v[68:71]
v_exp_f32 v88,v88
v_mfma_f32_16x16x32_bf16 v[76:79],a[172:175],v[236:239],v[76:79]
ds_read_b128 v[232:235],v17 offset:37888
s_waitcnt lgkmcnt(5)
v_mfma_f32_16x16x32_bf16 v[68:71],a[48:51],v[240:243],v[68:71]
v_min3_u32 v27,v27,v240,v244
v_exp_f32 v94,v94
v_mfma_f32_16x16x32_bf16 v[76:79],a[176:179],v[240:243],v[76:79]
ds_read_b128 v[236:239],v17 offset:39936
v_exp_f32 v95,v95
v_mfma_f32_16x16x32_bf16 v[68:71],a[52:55],v[244:247],v[68:71]
v_exp_f32 v89,v89
v_fma_f32 v92,v92,v123,v123
v_mfma_f32_16x16x32_bf16 v[76:79],a[180:183],v[244:247],v[76:79]
ds_read_b128 v[240:243],v17 offset:41984
v_fma_f32 v93,v93,v123,v123
s_waitcnt lgkmcnt(5)
v_mfma_f32_16x16x32_bf16 v[68:71],a[56:59],v[248:251],v[68:71]
v_min3_u32 v27,v27,v248,v252
v_fma_f32 v94,v94,v123,v123
v_fma_f32 v95,v95,v123,v123
v_mfma_f32_16x16x32_bf16 v[76:79],a[184:187],v[248:251],v[76:79]
ds_read_b128 v[244:247],v17 offset:44032
v_rcp_f32 v92,v92
v_mfma_f32_16x16x32_bf16 v[68:71],a[60:63],v[252:255],v[68:71]
v_exp_f32 v90,v90
v_mfma_f32_16x16x32_bf16 v[76:79],a[188:191],v[252:255],v[76:79]
ds_read_b128 v[248:251],v17 offset:46080
s_waitcnt lgkmcnt(5)
v_mfma_f32_16x16x32_bf16 v[68:71],a[64:67],v[224:227],v[68:71]
v_min3_u32 v27,v27,v224,v228
v_rcp_f32 v93,v93
v_mfma_f32_16x16x32_bf16 v[76:79],a[192:195],v[224:227],v[76:79]
ds_read_b128 v[252:255],v17 offset:48128
v_rcp_f32 v94,v94
v_mfma_f32_16x16x32_bf16 v[68:71],a[68:71],v[228:231],v[68:71]
v_exp_f32 v91,v91
v_mfma_f32_16x16x32_bf16 v[76:79],a[196:199],v[228:231],v[76:79]
ds_read_b128 v[224:227],v17 offset:50176
s_waitcnt lgkmcnt(5)
v_mfma_f32_16x16x32_bf16 v[68:71],a[72:75],v[232:235],v[68:71]
v_min3_u32 v27,v27,v232,v236
v_fma_f32 v88,v88,v123,v123
v_mfma_f32_16x16x32_bf16 v[76:79],a[200:203],v[232:235],v[76:79]
ds_read_b128 v[228:231],v17 offset:52224
v_fma_f32 v89,v89,v123,v123
v_mfma_f32_16x16x32_bf16 v[68:71],a[76:79],v[236:239],v[68:71]
v_fma_f32 v90,v90,v123,v123
v_fma_f32 v91,v91,v123,v123
v_mfma_f32_16x16x32_bf16 v[76:79],a[204:207],v[236:239],v[76:79]
ds_read_b128 v[232:235],v17 offset:54272
s_waitcnt lgkmcnt(5)
v_mfma_f32_16x16x32_bf16 v[68:71],a[80:83],v[240:243],v[68:71]
v_min3_u32 v27,v27,v240,v244
v_rcp_f32 v95,v95
v_mfma_f32_16x16x32_bf16 v[76:79],a[208:211],v[240:243],v[76:79]
ds_read_b128 v[236:239],v17 offset:56320
v_mul_f32 v92,v92,v72
v_mfma_f32_16x16x32_bf16 v[68:71],a[84:87],v[244:247],v[68:71]
v_rcp_f32 v88,v88
v_mfma_f32_16x16x32_bf16 v[76:79],a[212:215],v[244:247],v[76:79]
ds_read_b128 v[240:243],v17 offset:58368
s_waitcnt lgkmcnt(5)
v_mfma_f32_16x16x32_bf16 v[68:71],a[88:91],v[248:251],v[68:71]
v_min3_u32 v27,v27,v248,v252
v_mul_f32 v93,v93,v73
v_mfma_f32_16x16x32_bf16 v[76:79],a[216:219],v[248:251],v[76:79]
ds_read_b128 v[244:247],v17 offset:60416
v_mul_f32 v94,v94,v74
v_mfma_f32_16x16x32_bf16 v[68:71],a[92:95],v[252:255],v[68:71]
v_rcp_f32 v89,v89
v_mfma_f32_16x16x32_bf16 v[76:79],a[220:223],v[252:255],v[76:79]
ds_read_b128 v[248:251],v17 offset:62464
s_waitcnt lgkmcnt(5)
v_mfma_f32_16x16x32_bf16 v[68:71],a[96:99],v[224:227],v[68:71]
v_min3_u32 v27,v27,v224,v228
v_mul_f32 v95,v95,v75
v_mfma_f32_16x16x32_bf16 v[76:79],a[224:227],v[224:227],v[76:79]
ds_read_b128 v[252:255],v17 offset:64512
v_mfma_f32_16x16x32_bf16 v[68:71],a[100:103],v[228:231],v[68:71]
v_rcp_f32 v90,v90
v_mfma_f32_16x16x32_bf16 v[76:79],a[228:231],v[228:231],v[76:79]
s_waitcnt lgkmcnt(4)
v_mfma_f32_16x16x32_bf16 v[68:71],a[104:107],v[232:235],v[68:71]
v_min3_u32 v27,v27,v232,v236
v_mfma_f32_16x16x32_bf16 v[76:79],a[232:235],v[232:235],v[76:79]
v_rcp_f32 v91,v91
v_mfma_f32_16x16x32_bf16 v[68:71],a[108:111],v[236:239],v[68:71]
v_mul_f32 v88,v88,v64
v_mul_f32 v89,v89,v65
v_mfma_f32_16x16x32_bf16 v[76:79],a[236:239],v[236:239],v[76:79]
v_mul_f32 v90,v90,v66
s_waitcnt lgkmcnt(2)
v_mfma_f32_16x16x32_bf16 v[68:71],a[112:115],v[240:243],v[68:71]
v_min3_u32 v27,v27,v240,v244
v_mul_f32 v91,v91,v67
v_mfma_f32_16x16x32_bf16 v[76:79],a[240:243],v[240:243],v[76:79]
v_cvt_pk_bf16_f32 v96,v88,v89
v_cvt_pk_bf16_f32 v97,v90,v91
v_mfma_f32_16x16x32_bf16 v[68:71],a[116:119],v[244:247],v[68:71]
v_cvt_pk_bf16_f32 v98,v92,v93
v_cvt_pk_bf16_f32 v99,v94,v95
v_mfma_f32_16x16x32_bf16 v[76:79],a[244:247],v[244:247],v[76:79]
v_max_u32 v96,1,v96
s_waitcnt lgkmcnt(0)
v_mfma_f32_16x16x32_bf16 v[68:71],a[120:123],v[248:251],v[68:71]
v_min3_u32 v27,v27,v248,v252
v_mfma_f32_16x16x32_bf16 v[76:79],a[248:251],v[248:251],v[76:79]
buffer_store_dwordx4 v[96:99],v18,s[20:23],s70 offen offset:0 sc1
v_mfma_f32_16x16x32_bf16 v[68:71],a[124:127],v[252:255],v[68:71]
v_mfma_f32_16x16x32_bf16 v[76:79],a[252:255],v[252:255],v[76:79]
v_cmp_eq_u32 vcc,0,v27
s_cbranch_vccnz retry_377
epi_380:
buffer_load_dword v29,v21,s[20:23],s87 offen sc1
s_nop 3
v_pk_fma_f32 v[68:69],v[52:53],v[124:125],v[68:69] op_sel_hi:[1,0,1]
v_pk_fma_f32 v[70:71],v[54:55],v[124:125],v[70:71] op_sel_hi:[1,0,1]
v_pk_fma_f32 v[76:77],v[56:57],v[124:125],v[76:77] op_sel_hi:[1,0,1]
v_pk_fma_f32 v[78:79],v[58:59],v[124:125],v[78:79] op_sel_hi:[1,0,1]
v_pk_mul_f32 v[88:89],v[68:69],v[68:69]
v_pk_mul_f32 v[90:91],v[70:71],v[70:71]
v_pk_mul_f32 v[92:93],v[76:77],v[76:77]
v_pk_mul_f32 v[94:95],v[78:79],v[78:79]
v_pk_fma_f32 v[88:89],v[88:89],v[124:125],v[126:127] op_sel:[0,1,0] op_sel_hi:[1,1,0]
v_pk_fma_f32 v[90:91],v[90:91],v[124:125],v[126:127] op_sel:[0,1,0] op_sel_hi:[1,1,0]
v_pk_fma_f32 v[92:93],v[92:93],v[124:125],v[126:127] op_sel:[0,1,0] op_sel_hi:[1,1,0]
v_pk_fma_f32 v[94:95],v[94:95],v[124:125],v[126:127] op_sel:[0,1,0] op_sel_hi:[1,1,0]
v_pk_mul_f32 v[88:89],v[88:89],v[68:69]
v_pk_mul_f32 v[90:91],v[90:91],v[70:71]
v_pk_mul_f32 v[92:93],v[92:93],v[76:77]
v_pk_mul_f32 v[94:95],v[94:95],v[78:79]
v_exp_f32 v88,v88
v_exp_f32 v89,v89
v_exp_f32 v90,v90
v_exp_f32 v91,v91
v_exp_f32 v92,v92
v_exp_f32 v93,v93
v_exp_f32 v94,v94
s_cmp_gt_u32 s71,40
s_cselect_b32 s65,s73,0x7fff0000
s_cselect_b32 s97,0x7fff0000,s73
v_mov_b32 v22,s71
buffer_store_dword v22,v23,s[20:23],s65 offen sc1
v_exp_f32 v95,v95
v_pk_fma_f32 v[88:89],v[88:89],v[126:127],v[126:127] op_sel:[0,1,1] op_sel_hi:[1,1,1]
v_pk_fma_f32 v[90:91],v[90:91],v[126:127],v[126:127] op_sel:[0,1,1] op_sel_hi:[1,1,1]
v_pk_fma_f32 v[92:93],v[92:93],v[126:127],v[126:127] op_sel:[0,1,1] op_sel_hi:[1,1,1]
v_pk_fma_f32 v[94:95],v[94:95],v[126:127],v[126:127] op_sel:[0,1,1] op_sel_hi:[1,1,1]
v_rcp_f32 v88,v88
v_rcp_f32 v89,v89
v_rcp_f32 v90,v90
v_rcp_f32 v91,v91
v_rcp_f32 v92,v92
v_rcp_f32 v93,v93
v_rcp_f32 v94,v94
v_rcp_f32 v95,v95
v_pk_mul_f32 v[88:89],v[88:89],v[68:69]
v_pk_mul_f32 v[90:91],v[90:91],v[70:71]
v_pk_mul_f32 v[92:93],v[92:93],v[76:77]
v_pk_mul_f32 v[94:95],v[94:95],v[78:79]
v_cvt_pk_bf16_f32 v96,v88,v89
v_cvt_pk_bf16_f32 v97,v90,v91
v_cvt_pk_bf16_f32 v98,v92,v93
v_cvt_pk_bf16_f32 v99,v94,v95
v_max_u32 v96,1,v96
buffer_store_dwordx4 v[96:99],v18,s[20:23],s70 offen offset:1024 sc1
next_387:
v_xor_b32 v17,0x10000,v17
s_xor_b32 s72,s72,0x10000
s_add_u32 s70,s70,2097152
s_xor_b32 s70,s70,0x2000
s_add_u32 s71,s71,1
s_cmp_le_u32 s71,s57
s_cbranch_scc1 seg_378
s_endpgm
retry_377:
s_sub_u32 s90,s90,64
s_cmp_lt_i32 s90,0
s_cbranch_scc1 giveup_197
s_mov_b32 s83,1
s_waitcnt vmcnt(0) lgkmcnt(0)
s_barrier
s_branch seg_378
half_386:
s_mov_b64 exec,s[52:53]
s_xor_b32 m0,s91,0
s_add_u32 s65,s94,0
buffer_load_dwordx4 v16,s[20:23],s65 offen offset:0 sc1 lds
buffer_load_dwordx4 v16,s[20:23],s65 offen offset:2048 sc1 lds
s_xor_b32 m0,s91,16384
s_add_u32 s65,s94,32768
buffer_load_dwordx4 v16,s[20:23],s65 offen offset:0 sc1 lds
buffer_load_dwordx4 v16,s[20:23],s65 offen offset:2048 sc1 lds
s_xor_b32 m0,s91,32768
s_add_u32 s65,s94,65536
buffer_load_dwordx4 v16,s[20:23],s65 offen offset:0 sc1 lds
buffer_load_dwordx4 v16,s[20:23],s65 offen offset:2048 sc1 lds
s_xor_b32 m0,s91,49152
s_add_u32 s65,s94,98304
buffer_load_dwordx4 v16,s[20:23],s65 offen offset:0 sc1 lds
buffer_load_dwordx4 v16,s[20:23],s65 offen offset:2048 sc1 lds
s_mov_b64 exec,-1
s_waitcnt vmcnt(8)
v_add_u32 v22,s71,-1
buffer_store_dword v22,v23,s[20:23],s97 offen sc1
s_mov_b32 s97,0x7fff0000
half2_383:
s_waitcnt vmcnt(7)
s_barrier
ds_read_b128 v[224:227],v17 offset:0
ds_read_b128 v[228:231],v17 offset:2048
ds_read_b128 v[232:235],v17 offset:4096
ds_read_b128 v[236:239],v17 offset:6144
ds_read_b128 v[240:243],v17 offset:8192
ds_read_b128 v[244:247],v17 offset:10240
ds_read_b128 v[248:251],v17 offset:12288
s_waitcnt lgkmcnt(5)
v_mfma_f32_16x16x32_bf16 v[64:67],a[0:3],v[224:227],0
v_min_u32 v27,v224,v228
v_mfma_f32_16x16x32_bf16 v[72:75],a[128:131],v[224:227],0
ds_read_b128 v[252:255],v17 offset:14336
v_mfma_f32_16x16x32_bf16 v[64:67],a[4:7],v[228:231],v[64:67]
v_mfma_f32_16x16x32_bf16 v[72:75],a[132:135],v[228:231],v[72:75]
s_waitcnt vmcnt(5)
s_barrier
ds_read_b128 v[224:227],v17 offset:16384
s_waitcnt lgkmcnt(5)
v_mfma_f32_16x16x32_bf16 v[64:67],a[8:11],v[232:235],v[64:67]
v_min3_u32 v27,v27,v232,v236
v_mfma_f32_16x16x32_bf16 v[72:75],a[136:139],v[232:235],v[72:75]
ds_read_b128 v[228:231],v17 offset:18432
v_mfma_f32_16x16x32_bf16 v[64:67],a[12:15],v[236:239],v[64:67]
v_mfma_f32_16x16x32_bf16 v[72:75],a[140:143],v[236:239],v[72:75]
ds_read_b128 v[232:235],v17 offset:20480
s_waitcnt lgkmcnt(5)
v_mfma_f32_16x16x32_bf16 v[64:67],a[16:19],v[240:243],v[64:67]
v_min3_u32 v27,v27,v240,v244
v_mfma_f32_16x16x32_bf16 v[72:75],a[144:147],v[240:243],v[72:75]
ds_read_b128 v[236:239],v17 offset:22528
v_mfma_f32_16x16x32_bf16 v[64:67],a[20:23],v[244:247],v[64:67]
v_mfma_f32_16x16x32_bf16 v[72:75],a[148:151],v[244:247],v[72:75]
ds_read_b128 v[240:243],v17 offset:24576
s_waitcnt lgkmcnt(5)
v_mfma_f32_16x16x32_bf16 v[64:67],a[24:27],v[248:251],v[64:67]
v_min3_u32 v27,v27,v248,v252
v_mfma_f32_16x16x32_bf16 v[72:75],a[152:155],v[248:251],v[72:75]
ds_read_b128 v[244:247],v17 offset:26624
v_mfma_f32_16x16x32_bf16 v[64:67],a[28:31],v[252:255],v[64:67]
v_mfma_f32_16x16x32_bf16 v[72:75],a[156:159],v[252:255],v[72:75]
ds_read_b128 v[248:251],v17 offset:28672
s_waitcnt lgkmcnt(5)
v_mfma_f32_16x16x32_bf16 v[64:67],a[32:35],v[224:227],v[64:67]
v_min3_u32 v27,v27,v224,v228
v_mfma_f32_16x16x32_bf16 v[72:75],a[160:163],v[224:227],v[72:75]
ds_read_b128 v[252:255],v17 offset:30720
v_mfma_f32_16x16x32_bf16 v[64:67],a[36:39],v[228:231],v[64:67]
v_mfma_f32_16x16x32_bf16 v[72:75],a[164:167],v[228:231],v[72:75]
s_waitcnt vmcnt(1)
s_barrier
ds_read_b128 v[224:227],v17 offset:32768
s_waitcnt lgkmcnt(5)
v_mfma_f32_16x16x32_bf16 v[64:67],a[40:43],v[232:235],v[64:67]
v_min3_u32 v27,v27,v232,v236
v_mfma_f32_16x16x32_bf16 v[72:75],a[168:171],v[232:235],v[72:75]
ds_read_b128 v[228:231],v17 offset:34816
v_mfma_f32_16x16x32_bf16 v[64:67],a[44:47],v[236:239],v[64:67]
v_mfma_f32_16x16x32_bf16 v[72:75],a[172:175],v[236:239],v[72:75]
ds_read_b128 v[232:235],v17 offset:36864
s_waitcnt lgkmcnt(5)
v_mfma_f32_16x16x32_bf16 v[64:67],a[48:51],v[240:243],v[64:67]
v_min3_u32 v27,v27,v240,v244
v_mfma_f32_16x16x32_bf16 v[72:75],a[176:179],v[240:243],v[72:75]
ds_read_b128 v[236:239],v17 offset:38912
v_mfma_f32_16x16x32_bf16 v[64:67],a[52:55],v[244:247],v[64:67]
v_mfma_f32_16x16x32_bf16 v[72:75],a[180:183],v[244:247],v[72:75]
ds_read_b128 v[240:243],v17 offset:40960
s_waitcnt lgkmcnt(5)
v_mfma_f32_16x16x32_bf16 v[64:67],a[56:59],v[248:251],v[64:67]
v_min3_u32 v27,v27,v248,v252
v_mfma_f32_16x16x32_bf16 v[72:75],a[184:187],v[248:251],v[72:75]
ds_read_b128 v[244:247],v17 offset:43008
v_mfma_f32_16x16x32_bf16 v[64:67],a[60:63],v[252:255],v[64:67]
v_mfma_f32_16x16x32_bf16 v[72:75],a[188:191],v[252:255],v[72:75]
ds_read_b128 v[248:251],v17 offset:45056
s_waitcnt lgkmcnt(5)
v_mfma_f32_16x16x32_bf16 v[64:67],a[64:67],v[224:227],v[64:67]
v_min3_u32 v27,v27,v224,v228
v_mfma_f32_16x16x32_bf16 v[72:75],a[192:195],v[224:227],v[72:75]
ds_read_b128 v[252:255],v17 offset:47104
v_mfma_f32_16x16x32_bf16 v[64:67],a[68:71],v[228:231],v[64:67]
v_mfma_f32_16x16x32_bf16 v[72:75],a[196:199],v[228:231],v[72:75]
ds_read_b128 v[224:227],v17 offset:49152
s_waitcnt lgkmcnt(5)
v_mfma_f32_16x16x32_bf16 v[64:67],a[72:75],v[232:235],v[64:67]
v_min3_u32 v27,v27,v232,v236
v_mfma_f32_16x16x32_bf16 v[72:75],a[200:203],v[232:235],v[72:75]
ds_read_b128 v[228:231],v17 offset:51200
v_mfma_f32_16x16x32_bf16 v[64:67],a[76:79],v[236:239],v[64:67]
v_mfma_f32_16x16x32_bf16 v[72:75],a[204:207],v[236:239],v[72:75]
ds_read_b128 v[232:235],v17 offset:53248
s_waitcnt lgkmcnt(5)
v_mfma_f32_16x16x32_bf16 v[64:67],a[80:83],v[240:243],v[64:67]
v_min3_u32 v27,v27,v240,v244
v_mfma_f32_16x16x32_bf16 v[72:75],a[208:211],v[240:243],v[72:75]
ds_read_b128 v[236:239],v17 offset:55296
v_mfma_f32_16x16x32_bf16 v[64:67],a[84:87],v[244:247],v[64:67]
v_mfma_f32_16x16x32_bf16 v[72:75],a[212:215],v[244:247],v[72:75]
ds_read_b128 v[240:243],v17 offset:57344
s_waitcnt lgkmcnt(5)
v_mfma_f32_16x16x32_bf16 v[64:67],a[88:91],v[248:251],v[64:67]
v_min3_u32 v27,v27,v248,v252
v_mfma_f32_16x16x32_bf16 v[72:75],a[216:219],v[248:251],v[72:75]
ds_read_b128 v[244:247],v17 offset:59392
v_mfma_f32_16x16x32_bf16 v[64:67],a[92:95],v[252:255],v[64:67]
v_mfma_f32_16x16x32_bf16 v[72:75],a[220:223],v[252:255],v[72:75]
ds_read_b128 v[248:251],v17 offset:61440
s_waitcnt lgkmcnt(5)
v_mfma_f32_16x16x32_bf16 v[64:67],a[96:99],v[224:227],v[64:67]
v_min3_u32 v27,v27,v224,v228
v_mfma_f32_16x16x32_bf16 v[72:75],a[224:227],v[224:227],v[72:75]
s_barrier
ds_read_b128 v[252:255],v17 offset:63488
v_mfma_f32_16x16x32_bf16 v[64:67],a[100:103],v[228:231],v[64:67]
ds_read_b128 v[120:123],v19
v_mfma_f32_16x16x32_bf16 v[72:75],a[228:231],v[228:231],v[72:75]
s_waitcnt lgkmcnt(5)
v_mfma_f32_16x16x32_bf16 v[64:67],a[104:107],v[232:235],v[64:67]
v_min3_u32 v27,v27,v232,v236
v_mfma_f32_16x16x32_bf16 v[72:75],a[232:235],v[232:235],v[72:75]
v_mfma_f32_16x16x32_bf16 v[64:67],a[108:111],v[236:239],v[64:67]
v_mfma_f32_16x16x32_bf16 v[72:75],a[236:239],v[236:239],v[72:75]
s_waitcnt lgkmcnt(3)
v_mfma_f32_16x16x32_bf16 v[64:67],a[112:115],v[240:243],v[64:67]
v_min3_u32 v27,v27,v240,v244
v_mfma_f32_16x16x32_bf16 v[72:75],a[240:243],v[240:243],v[72:75]
v_mfma_f32_16x16x32_bf16 v[64:67],a[116:119],v[244:247],v[64:67]
v_mfma_f32_16x16x32_bf16 v[72:75],a[244:247],v[244:247],v[72:75]
s_waitcnt lgkmcnt(1)
v_mfma_f32_16x16x32_bf16 v[64:67],a[120:123],v[248:251],v[64:67]
v_min3_u32 v27,v27,v248,v252
v_mfma_f32_16x16x32_bf16 v[72:75],a[248:251],v[248:251],v[72:75]
v_mfma_f32_16x16x32_bf16 v[64:67],a[124:127],v[252:255],v[64:67]
v_mfma_f32_16x16x32_bf16 v[72:75],a[252:255],v[252:255],v[72:75]
v_cmp_eq_u32 vcc,0,v27
s_and_b64 vcc,vcc,s[52:53]
s_cbranch_vccnz retry_377
s_waitcnt lgkmcnt(0)
s_nop 3
v_pk_fma_f32 v[64:65],v[52:53],v[120:121],v[64:65] op_sel_hi:[1,0,1]
v_pk_fma_f32 v[66:67],v[54:55],v[120:121],v[66:67] op_sel_hi:[1,0,1]
v_pk_fma_f32 v[72:73],v[56:57],v[120:121],v[72:73] op_sel_hi:[1,0,1]
v_pk_fma_f32 v[74:75],v[58:59],v[120:121],v[74:75] op_sel_hi:[1,0,1]
v_pk_mul_f32 v[88:89],v[64:65],v[64:65]
v_pk_mul_f32 v[90:91],v[66:67],v[66:67]
buffer_load_dword v29,v21,s[20:23],s87 offen sc1
v_mov_b32 v22,s71
buffer_store_dword v22,v23,s[20:23],s73 offen sc1
v_pk_mul_f32 v[92:93],v[72:73],v[72:73]
v_pk_mul_f32 v[94:95],v[74:75],v[74:75]
v_pk_fma_f32 v[88:89],v[88:89],v[120:121],v[122:123] op_sel:[0,1,0] op_sel_hi:[1,1,0]
v_pk_fma_f32 v[90:91],v[90:91],v[120:121],v[122:123] op_sel:[0,1,0] op_sel_hi:[1,1,0]
v_pk_fma_f32 v[92:93],v[92:93],v[120:121],v[122:123] op_sel:[0,1,0] op_sel_hi:[1,1,0]
v_pk_fma_f32 v[94:95],v[94:95],v[120:121],v[122:123] op_sel:[0,1,0] op_sel_hi:[1,1,0]
v_pk_mul_f32 v[88:89],v[88:89],v[64:65]
v_pk_mul_f32 v[90:91],v[90:91],v[66:67]
v_pk_mul_f32 v[92:93],v[92:93],v[72:73]
v_pk_mul_f32 v[94:95],v[94:95],v[74:75]
v_exp_f32 v88,v88
v_exp_f32 v89,v89
v_exp_f32 v90,v90
v_exp_f32 v91,v91
v_exp_f32 v92,v92
v_exp_f32 v93,v93
v_exp_f32 v94,v94
v_exp_f32 v95,v95
v_pk_fma_f32 v[88:89],v[88:89],v[122:123],v[122:123] op_sel:[0,1,1] op_sel_hi:[1,1,1]
v_pk_fma_f32 v[90:91],v[90:91],v[122:123],v[122:123] op_sel:[0,1,1] op_sel_hi:[1,1,1]
v_pk_fma_f32 v[92:93],v[92:93],v[122:123],v[122:123] op_sel:[0,1,1] op_sel_hi:[1,1,1]
v_pk_fma_f32 v[94:95],v[94:95],v[122:123],v[122:123] op_sel:[0,1,1] op_sel_hi:[1,1,1]
v_rcp_f32 v88,v88
v_rcp_f32 v89,v89
v_rcp_f32 v90,v90
v_rcp_f32 v91,v91
v_rcp_f32 v92,v92
v_rcp_f32 v93,v93
v_rcp_f32 v94,v94
v_rcp_f32 v95,v95
v_pk_mul_f32 v[88:89],v[88:89],v[64:65]
v_pk_mul_f32 v[90:91],v[90:91],v[66:67]
v_pk_mul_f32 v[92:93],v[92:93],v[72:73]
v_pk_mul_f32 v[94:95],v[94:95],v[74:75]
v_cvt_pk_bf16_f32 v96,v88,v89
v_cvt_pk_bf16_f32 v97,v90,v91
v_cvt_pk_bf16_f32 v98,v92,v93
v_cvt_pk_bf16_f32 v99,v94,v95
v_max_u32 v96,1,v96
buffer_store_dwordx4 v[96:99],v18,s[20:23],s70 offen offset:0 sc1
s_branch next_387
w3b_376:
s_add_u32 s64,s79,0
s_lshl_b32 s70,s64,21
s_lshl_b32 s64,s64,13
s_and_b32 s64,s64,0x2000
s_xor_b32 s64,s64,s62
s_add_u32 s70,s70,s64
s_add_u32 s70,s70,29360128
s_mov_b32 s83,1
s_mov_b32 s87,s74
s_cmp_eq_u32 s50,0
s_cselect_b32 s74,s74,0x7fff0000
v_mov_b32 v47,132096
s_lshl_b32 s64,s50,3
s_add_u32 s64,s64,132096
v_mov_b32 v46,s64
v_mov_b32 v29,0
s_mov_b32 s97,0x7fff0000
s_mov_b32 s69,1
s_mov_b32 s68,0
s_mov_b32 s52,0x30003
s_mov_b32 s53,s52
seg_393:
s_cmp_eq_u32 s83,0
s_cbranch_scc1 ahead_394
s_add_u32 s94,s70,s75
s_xor_b32 s95,s94,1024
s_xor_b32 s91,s72,0x10000
s_cmp_eq_u32 s69,0
s_mov_b32 s69,1
s_cbranch_scc1 half2_398
s_waitcnt vmcnt(2)
v_cmp_gt_u32 vcc,s71,v29
s_cbranch_vccz nb_397
s_waitcnt vmcnt(0)
v_add_u32 v22,s71,-1
buffer_store_dword v22,v23,s[20:23],s97 offen sc1
s_mov_b32 s97,0x7fff0000
s_cmp_lg_u32 s50,0
s_cbranch_scc1 nb_397
buffer_load_dword v32,v21,s[20:23],s74 offen sc1
s_sleep 2
pl_399:
buffer_load_dword v33,v21,s[20:23],s74 offen sc1
s_waitcnt vmcnt(1)
v_cmp_gt_u32 vcc,s71,v32
v_mov_b32 v29,v32
s_cbranch_vccz pok_400
buffer_load_dword v32,v21,s[20:23],s74 offen sc1
s_waitcnt vmcnt(1)
v_cmp_gt_u32 vcc,s71,v33
v_mov_b32 v29,v33
s_cbranch_vccz pok_400
s_sub_u32 s90,s90,1
s_cmp_gt_i32 s90,0
s_cbranch_scc1 pl_399
pok_400:
nb_397:
s_cmp_eq_u32 s71,64
s_barrier
s_cbranch_scc1 half_401
s_xor_b32 m0,s91,0
s_add_u32 s65,s94,0
buffer_load_dwordx4 v16,s[20:23],s65 offen offset:0 sc1 lds
buffer_load_dwordx4 v16,s[20:23],s65 offen offset:2048 sc1 lds
s_xor_b32 m0,s91,16384
s_add_u32 s65,s94,32768
buffer_load_dwordx4 v16,s[20:23],s65 offen offset:0 sc1 lds
buffer_load_dwordx4 v16,s[20:23],s65 offen offset:2048 sc1 lds
s_xor_b32 m0,s91,32768
s_add_u32 s65,s94,65536
buffer_load_dwordx4 v16,s[20:23],s65 offen offset:0 sc1 lds
buffer_load_dwordx4 v16,s[20:23],s65 offen offset:2048 sc1 lds
s_xor_b32 m0,s91,49152
s_add_u32 s65,s94,98304
buffer_load_dwordx4 v16,s[20:23],s65 offen offset:0 sc1 lds
buffer_load_dwordx4 v16,s[20:23],s65 offen offset:2048 sc1 lds
s_add_u32 s66,s94,110592
buffer_load_dwordx4 v[128:131],v16,s[20:23],s66 offen offset:0 sc1
buffer_load_dwordx4 v[132:135],v16,s[20:23],s66 offen offset:1024 sc1
buffer_load_dwordx4 v[136:139],v16,s[20:23],s66 offen offset:2048 sc1
buffer_load_dwordx4 v[140:143],v16,s[20:23],s66 offen offset:3072 sc1
s_add_u32 s66,s94,114688
buffer_load_dwordx4 v[144:147],v16,s[20:23],s66 offen offset:0 sc1
buffer_load_dwordx4 v[148:151],v16,s[20:23],s66 offen offset:1024 sc1
buffer_load_dwordx4 v[152:155],v16,s[20:23],s66 offen offset:2048 sc1
buffer_load_dwordx4 v[156:159],v16,s[20:23],s66 offen offset:3072 sc1
s_waitcnt vmcnt(16)
v_add_u32 v22,s71,-1
buffer_store_dword v22,v23,s[20:23],s97 offen sc1
s_mov_b32 s97,0x7fff0000
s_waitcnt vmcnt(15)
s_barrier
ds_read_b128 v[224:227],v17 offset:0
ds_read_b128 v[228:231],v17 offset:2048
ds_read_b128 v[232:235],v17 offset:4096
ds_read_b128 v[236:239],v17 offset:6144
ds_read_b128 v[240:243],v17 offset:8192
ds_read_b128 v[244:247],v17 offset:10240
ds_read_b128 v[248:251],v17 offset:12288
s_waitcnt lgkmcnt(5)
v_mfma_f32_16x16x32_bf16 v[64:67],a[0:3],v[224:227],0
ds_read_b128 v[252:255],v17 offset:14336
s_xor_b32 m0,s91,1024
s_add_u32 s65,s95,0
buffer_load_dwordx4 v16,s[20:23],s65 offen offset:0 sc1 lds
buffer_load_dwordx4 v16,s[20:23],s65 offen offset:2048 sc1 lds
v_min_u32 v27,v224,v228
v_mfma_f32_16x16x32_bf16 v[72:75],a[4:7],v[228:231],0
s_waitcnt vmcnt(15)
s_barrier
ds_read_b128 v[224:227],v17 offset:16384
s_xor_b32 m0,s91,17408
s_add_u32 s65,s95,32768
s_waitcnt lgkmcnt(5)
v_mfma_f32_16x16x32_bf16 v[64:67],a[8:11],v[232:235],v[64:67]
ds_read_b128 v[228:231],v17 offset:18432
buffer_load_dwordx4 v16,s[20:23],s65 offen offset:0 sc1 lds
buffer_load_dwordx4 v16,s[20:23],s65 offen offset:2048 sc1 lds
s_xor_b32 m0,s91,33792
v_min3_u32 v27,v27,v232,v236
v_mfma_f32_16x16x32_bf16 v[72:75],a[12:15],v[236:239],v[72:75]
ds_read_b128 v[232:235],v17 offset:20480
s_add_u32 s65,s95,65536
buffer_load_dwordx4 v16,s[20:23],s65 offen offset:0 sc1 lds
s_waitcnt lgkmcnt(5)
v_mfma_f32_16x16x32_bf16 v[64:67],a[16:19],v[240:243],v[64:67]
ds_read_b128 v[236:239],v17 offset:22528
buffer_load_dwordx4 v16,s[20:23],s65 offen offset:2048 sc1 lds
s_xor_b32 m0,s91,50176
s_add_u32 s65,s95,98304
v_min3_u32 v27,v27,v240,v244
v_mfma_f32_16x16x32_bf16 v[72:75],a[20:23],v[244:247],v[72:75]
ds_read_b128 v[240:243],v17 offset:24576
buffer_load_dwordx4 v16,s[20:23],s65 offen offset:0 sc1 lds
buffer_load_dwordx4 v16,s[20:23],s65 offen offset:2048 sc1 lds
s_waitcnt lgkmcnt(5)
v_mfma_f32_16x16x32_bf16 v[64:67],a[24:27],v[248:251],v[64:67]
ds_read_b128 v[244:247],v17 offset:26624
v_min3_u32 v27,v27,v248,v252
v_mfma_f32_16x16x32_bf16 v[72:75],a[28:31],v[252:255],v[72:75]
ds_read_b128 v[248:251],v17 offset:28672
s_waitcnt lgkmcnt(5)
v_mfma_f32_16x16x32_bf16 v[64:67],a[32:35],v[224:227],v[64:67]
ds_read_b128 v[252:255],v17 offset:30720
v_min3_u32 v27,v27,v224,v228
v_mfma_f32_16x16x32_bf16 v[72:75],a[36:39],v[228:231],v[72:75]
s_waitcnt vmcnt(17)
s_barrier
ds_read_b128 v[224:227],v17 offset:32768
s_waitcnt lgkmcnt(5)
v_mfma_f32_16x16x32_bf16 v[64:67],a[40:43],v[232:235],v[64:67]
ds_read_b128 v[228:231],v17 offset:34816
v_min3_u32 v27,v27,v232,v236
v_mfma_f32_16x16x32_bf16 v[72:75],a[44:47],v[236:239],v[72:75]
ds_read_b128 v[232:235],v17 offset:36864
s_waitcnt lgkmcnt(5)
v_mfma_f32_16x16x32_bf16 v[64:67],a[48:51],v[240:243],v[64:67]
ds_read_b128 v[236:239],v17 offset:38912
v_min3_u32 v27,v27,v240,v244
v_mfma_f32_16x16x32_bf16 v[72:75],a[52:55],v[244:247],v[72:75]
ds_read_b128 v[240:243],v17 offset:40960
s_add_u32 s88,s70,s75
s_add_u32 s88,s88,2097152
s_xor_b32 s88,s88,0x2000
s_xor_b32 s89,s88,1024
s_waitcnt lgkmcnt(5)
v_mfma_f32_16x16x32_bf16 v[64:67],a[56:59],v[248:251],v[64:67]
ds_read_b128 v[244:247],v17 offset:43008
v_min3_u32 v27,v27,v248,v252
v_mfma_f32_16x16x32_bf16 v[72:75],a[60:63],v[252:255],v[72:75]
ds_read_b128 v[248:251],v17 offset:45056
s_waitcnt lgkmcnt(5)
v_mfma_f32_16x16x32_bf16 v[64:67],a[64:67],v[224:227],v[64:67]
ds_read_b128 v[252:255],v17 offset:47104
v_min3_u32 v27,v27,v224,v228
v_mfma_f32_16x16x32_bf16 v[72:75],a[68:71],v[228:231],v[72:75]
ds_read_b128 v[224:227],v17 offset:49152
s_waitcnt lgkmcnt(5)
v_mfma_f32_16x16x32_bf16 v[64:67],a[72:75],v[232:235],v[64:67]
ds_read_b128 v[228:231],v17 offset:51200
v_min3_u32 v27,v27,v232,v236
v_mfma_f32_16x16x32_bf16 v[72:75],a[76:79],v[236:239],v[72:75]
ds_read_b128 v[232:235],v17 offset:53248
s_waitcnt lgkmcnt(5)
v_mfma_f32_16x16x32_bf16 v[64:67],a[80:83],v[240:243],v[64:67]
ds_read_b128 v[236:239],v17 offset:55296
v_min3_u32 v27,v27,v240,v244
v_mfma_f32_16x16x32_bf16 v[72:75],a[84:87],v[244:247],v[72:75]
ds_read_b128 v[240:243],v17 offset:57344
s_waitcnt lgkmcnt(5)
v_mfma_f32_16x16x32_bf16 v[64:67],a[88:91],v[248:251],v[64:67]
ds_read_b128 v[244:247],v17 offset:59392
v_min3_u32 v27,v27,v248,v252
v_mfma_f32_16x16x32_bf16 v[72:75],a[92:95],v[252:255],v[72:75]
ds_read_b128 v[248:251],v17 offset:61440
s_waitcnt vmcnt(9)
stk_407:
v_min3_u32 v22,v129,v133,v137
v_min3_u32 v22,v22,v141,v145
v_min3_u32 v22,v22,v149,v153
v_min_u32 v22,v22,v157
v_cmp_eq_u32 vcc,0,v22
s_cmp_lt_i32 s90,0
s_cselect_b64 vcc,0,vcc
s_cbranch_vccnz str_408
v_pk_add_f32 v[88:89],v[128:129],v[144:145]
v_pk_add_f32 v[90:91],v[130:131],v[146:147]
v_pk_add_f32 v[92:93],v[132:133],v[148:149]
v_pk_add_f32 v[94:95],v[134:135],v[150:151]
v_pk_add_f32 v[96:97],v[136:137],v[152:153]
v_pk_add_f32 v[98:99],v[138:139],v[154:155]
v_pk_add_f32 v[100:101],v[140:141],v[156:157]
v_pk_add_f32 v[102:103],v[142:143],v[158:159]
v_pk_add_f32 v[88:89],v[88:89],v[96:97]
v_pk_add_f32 v[90:91],v[90:91],v[98:99]
v_pk_add_f32 v[92:93],v[92:93],v[100:101]
v_pk_add_f32 v[94:95],v[94:95],v[102:103]
v_pk_add_f32 v[88:89],v[88:89],v[92:93]
v_pk_add_f32 v[90:91],v[90:91],v[94:95]
v_mov_b32 v92,v88
v_mov_b32 v93,v89
v_mov_b32 v94,v90
v_mov_b32 v95,v91
v_permlane16_swap_b32 v92,v88
v_permlane16_swap_b32 v93,v89
v_permlane16_swap_b32 v94,v90
v_permlane16_swap_b32 v95,v91
v_pk_add_f32 v[88:89],v[88:89],v[92:93]
v_pk_add_f32 v[90:91],v[90:91],v[94:95]
v_mov_b32 v92,v88
v_mov_b32 v93,v89
s_waitcnt lgkmcnt(5)
v_mfma_f32_16x16x32_bf16 v[64:67],a[96:99],v[224:227],v[64:67]
ds_read_b128 v[252:255],v17 offset:63488
v_min3_u32 v27,v27,v224,v228
v_mov_b32 v94,v90
v_mov_b32 v95,v91
v_permlane32_swap_b32 v92,v88
v_permlane32_swap_b32 v93,v89
v_permlane32_swap_b32 v94,v90
v_permlane32_swap_b32 v95,v91
v_pk_add_f32 v[88:89],v[88:89],v[92:93]
v_pk_add_f32 v[90:91],v[90:91],v[94:95]
v_mul_f32 v120,0xba800000,v88
v_mul_f32 v124,0xba800000,v90
v_mul_f32 v92,v120,v120
v_mul_f32 v93,v124,v124
v_fma_f32 v92,v89,s82,-v92
v_fma_f32 v93,v91,s82,-v93
v_max_f32 v92,0,v92
v_max_f32 v93,0,v93
v_add_f32 v92,0x3727c5ac,v92
v_add_f32 v93,0x3727c5ac,v93
v_rsq_f32 v94,v92
v_rsq_f32 v95,v93
v_mul_f32 v123,v92,v94
v_mul_f32 v127,v93,v95
v_mul_f32 v122,v28,v94
v_mul_f32 v126,v28,v95
v_mul_f32 v92,v94,v94
v_mul_f32 v93,v95,v95
v_mul_f32 v94,s81,v94
v_mul_f32 v95,s81,v95
v_mul_f32 v121,v92,v94
v_mul_f32 v125,v93,v95
ds_write_b128 v19,v[120:123] offset:0
ds_write_b128 v19,v[124:127] offset:256
v_mfma_f32_16x16x32_bf16 v[72:75],a[100:103],v[228:231],v[72:75]
s_waitcnt vmcnt(4) lgkmcnt(0)
s_barrier
ds_read_b64 v[44:45],v47
ds_read_b128 v[224:227],v17 offset:1024
v_mfma_f32_16x16x32_bf16 v[64:67],a[104:107],v[232:235],v[64:67]
ds_read_b128 v[228:231],v17 offset:3072
v_min3_u32 v27,v27,v232,v236
v_mfma_f32_16x16x32_bf16 v[72:75],a[108:111],v[236:239],v[72:75]
ds_read_b128 v[232:235],v17 offset:5120
v_mfma_f32_16x16x32_bf16 v[64:67],a[112:115],v[240:243],v[64:67]
ds_read_b128 v[236:239],v17 offset:7168
v_min3_u32 v27,v27,v240,v244
v_mfma_f32_16x16x32_bf16 v[72:75],a[116:119],v[244:247],v[72:75]
ds_read_b128 v[240:243],v17 offset:9216
s_waitcnt lgkmcnt(5)
v_readfirstlane_b32 s93,v45
v_mfma_f32_16x16x32_bf16 v[64:67],a[120:123],v[248:251],v[64:67]
ds_read_b128 v[244:247],v17 offset:11264
v_readfirstlane_b32 s83,v44
s_cmp_lg_u32 s83,0
s_cbranch_scc0 keep_403
v_min3_u32 v27,v27,v248,v252
v_mfma_f32_16x16x32_bf16 v[72:75],a[124:127],v[252:255],v[72:75]
ds_read_b128 v[248:251],v17 offset:13312
s_waitcnt lgkmcnt(5)
v_mfma_f32_16x16x32_bf16 v[68:71],a[0:3],v[224:227],0
ds_read_b128 v[252:255],v17 offset:15360
v_cmp_eq_u32 vcc,0,v27
s_cbranch_vccnz retry_392
v_min3_u32 v27,v27,v224,v228
v_mfma_f32_16x16x32_bf16 v[76:79],a[4:7],v[228:231],0
ds_read_b128 v[224:227],v17 offset:17408
s_waitcnt lgkmcnt(5)
v_mfma_f32_16x16x32_bf16 v[68:71],a[8:11],v[232:235],v[68:71]
ds_read_b128 v[228:231],v17 offset:19456
v_min3_u32 v27,v27,v232,v236
v_mfma_f32_16x16x32_bf16 v[76:79],a[12:15],v[236:239],v[76:79]
ds_read_b128 v[232:235],v17 offset:21504
s_waitcnt lgkmcnt(5)
v_mfma_f32_16x16x32_bf16 v[68:71],a[16:19],v[240:243],v[68:71]
ds_read_b128 v[236:239],v17 offset:23552
v_min3_u32 v27,v27,v240,v244
v_add_f32 v64,v64,v72
v_add_f32 v65,v65,v73
v_add_f32 v66,v66,v74
v_add_f32 v67,v67,v75
v_mfma_f32_16x16x32_bf16 v[76:79],a[20:23],v[244:247],v[76:79]
ds_read_b128 v[240:243],v17 offset:25600
v_fmac_f32 v64,v52,v120
v_fmac_f32 v65,v53,v120
v_fmac_f32 v66,v54,v120
v_fmac_f32 v67,v55,v120
s_waitcnt lgkmcnt(5)
v_mfma_f32_16x16x32_bf16 v[68:71],a[24:27],v[248:251],v[68:71]
ds_read_b128 v[244:247],v17 offset:27648
v_min3_u32 v27,v27,v248,v252
v_mul_f32 v88,v64,v64
v_mul_f32 v89,v65,v65
v_mul_f32 v90,v66,v66
v_mul_f32 v91,v67,v67
v_mfma_f32_16x16x32_bf16 v[76:79],a[28:31],v[252:255],v[76:79]
ds_read_b128 v[248:251],v17 offset:29696
v_fma_f32 v88,v88,v121,v122
v_fma_f32 v89,v89,v121,v122
v_fma_f32 v90,v90,v121,v122
v_fma_f32 v91,v91,v121,v122
s_waitcnt lgkmcnt(5)
v_mfma_f32_16x16x32_bf16 v[68:71],a[32:35],v[224:227],v[68:71]
ds_read_b128 v[252:255],v17 offset:31744
v_min3_u32 v27,v27,v224,v228
v_mul_f32 v88,v88,v64
v_mul_f32 v89,v89,v65
v_mul_f32 v90,v90,v66
v_mul_f32 v91,v91,v67
v_mfma_f32_16x16x32_bf16 v[76:79],a[36:39],v[228:231],v[76:79]
s_waitcnt vmcnt(0)
s_barrier
ds_read_b128 v[224:227],v17 offset:33792
v_exp_f32 v88,v88
s_waitcnt lgkmcnt(5)
v_mfma_f32_16x16x32_bf16 v[68:71],a[40:43],v[232:235],v[68:71]
ds_read_b128 v[228:231],v17 offset:35840
v_min3_u32 v27,v27,v232,v236
v_exp_f32 v89,v89
v_exp_f32 v90,v90
v_mfma_f32_16x16x32_bf16 v[76:79],a[44:47],v[236:239],v[76:79]
ds_read_b128 v[232:235],v17 offset:37888
v_exp_f32 v91,v91
v_fma_f32 v88,v88,v123,v123
v_fma_f32 v89,v89,v123,v123
s_waitcnt lgkmcnt(5)
v_mfma_f32_16x16x32_bf16 v[68:71],a[48:51],v[240:243],v[68:71]
ds_read_b128 v[236:239],v17 offset:39936
v_min3_u32 v27,v27,v240,v244
v_fma_f32 v90,v90,v123,v123
v_fma_f32 v91,v91,v123,v123
v_rcp_f32 v88,v88
v_mfma_f32_16x16x32_bf16 v[76:79],a[52:55],v[244:247],v[76:79]
ds_read_b128 v[240:243],v17 offset:41984
v_rcp_f32 v89,v89
v_rcp_f32 v90,v90
s_waitcnt lgkmcnt(5)
v_mfma_f32_16x16x32_bf16 v[68:71],a[56:59],v[248:251],v[68:71]
ds_read_b128 v[244:247],v17 offset:44032
v_min3_u32 v27,v27,v248,v252
v_rcp_f32 v91,v91
v_mul_f32 v88,v88,v64
v_mul_f32 v89,v89,v65
v_mfma_f32_16x16x32_bf16 v[76:79],a[60:63],v[252:255],v[76:79]
ds_read_b128 v[248:251],v17 offset:46080
v_mul_f32 v90,v90,v66
v_mul_f32 v91,v91,v67
v_cvt_pk_bf16_f32 v96,v88,v89
v_cvt_pk_bf16_f32 v97,v90,v91
s_waitcnt lgkmcnt(5)
v_mfma_f32_16x16x32_bf16 v[68:71],a[64:67],v[224:227],v[68:71]
ds_read_b128 v[252:255],v17 offset:48128
v_min3_u32 v27,v27,v224,v228
v_max_u32 v96,1,v96
buffer_store_dwordx2 v[96:97],v18,s[20:23],s70 offen offset:0 sc1
v_mfma_f32_16x16x32_bf16 v[76:79],a[68:71],v[228:231],v[76:79]
ds_read_b128 v[224:227],v17 offset:50176
s_waitcnt lgkmcnt(5)
v_mfma_f32_16x16x32_bf16 v[68:71],a[72:75],v[232:235],v[68:71]
ds_read_b128 v[228:231],v17 offset:52224
v_min3_u32 v27,v27,v232,v236
v_mfma_f32_16x16x32_bf16 v[76:79],a[76:79],v[236:239],v[76:79]
ds_read_b128 v[232:235],v17 offset:54272
s_waitcnt lgkmcnt(5)
v_mfma_f32_16x16x32_bf16 v[68:71],a[80:83],v[240:243],v[68:71]
ds_read_b128 v[236:239],v17 offset:56320
v_min3_u32 v27,v27,v240,v244
v_mfma_f32_16x16x32_bf16 v[76:79],a[84:87],v[244:247],v[76:79]
ds_read_b128 v[240:243],v17 offset:58368
s_waitcnt lgkmcnt(5)
v_mfma_f32_16x16x32_bf16 v[68:71],a[88:91],v[248:251],v[68:71]
ds_read_b128 v[244:247],v17 offset:60416
v_min3_u32 v27,v27,v248,v252
v_mfma_f32_16x16x32_bf16 v[76:79],a[92:95],v[252:255],v[76:79]
ds_read_b128 v[248:251],v17 offset:62464
s_waitcnt lgkmcnt(5)
v_mfma_f32_16x16x32_bf16 v[68:71],a[96:99],v[224:227],v[68:71]
ds_read_b128 v[252:255],v17 offset:64512
v_min3_u32 v27,v27,v224,v228
v_mfma_f32_16x16x32_bf16 v[76:79],a[100:103],v[228:231],v[76:79]
s_waitcnt lgkmcnt(4)
v_mfma_f32_16x16x32_bf16 v[68:71],a[104:107],v[232:235],v[68:71]
v_min3_u32 v27,v27,v232,v236
v_mfma_f32_16x16x32_bf16 v[76:79],a[108:111],v[236:239],v[76:79]
s_waitcnt lgkmcnt(2)
v_mfma_f32_16x16x32_bf16 v[68:71],a[112:115],v[240:243],v[68:71]
v_min3_u32 v27,v27,v240,v244
v_mfma_f32_16x16x32_bf16 v[76:79],a[116:119],v[244:247],v[76:79]
s_waitcnt lgkmcnt(0)
v_mfma_f32_16x16x32_bf16 v[68:71],a[120:123],v[248:251],v[68:71]
v_min3_u32 v27,v27,v248,v252
v_mfma_f32_16x16x32_bf16 v[76:79],a[124:127],v[252:255],v[76:79]
v_cmp_eq_u32 vcc,0,v27
s_cbranch_vccnz retry_392
s_branch epi_395
keep_403:
v_min3_u32 v27,v27,v248,v252
v_mfma_f32_16x16x32_bf16 v[72:75],a[124:127],v[252:255],v[72:75]
ds_read_b128 v[248:251],v17 offset:13312
s_add_u32 s66,s88,110592
buffer_load_dwordx4 v[128:131],v16,s[20:23],s66 offen offset:0 sc1
buffer_load_dwordx4 v[132:135],v16,s[20:23],s66 offen offset:1024 sc1
s_waitcnt lgkmcnt(5)
v_mfma_f32_16x16x32_bf16 v[68:71],a[0:3],v[224:227],0
ds_read_b128 v[252:255],v17 offset:15360
v_cmp_eq_u32 vcc,0,v27
s_cbranch_vccnz retry_392
v_min3_u32 v27,v27,v224,v228
buffer_load_dwordx4 v[136:139],v16,s[20:23],s66 offen offset:2048 sc1
buffer_load_dwordx4 v[140:143],v16,s[20:23],s66 offen offset:3072 sc1
v_mfma_f32_16x16x32_bf16 v[76:79],a[4:7],v[228:231],0
ds_read_b128 v[224:227],v17 offset:17408
s_add_u32 s66,s88,114688
buffer_load_dwordx4 v[144:147],v16,s[20:23],s66 offen offset:0 sc1
buffer_load_dwordx4 v[148:151],v16,s[20:23],s66 offen offset:1024 sc1
s_waitcnt lgkmcnt(5)
v_mfma_f32_16x16x32_bf16 v[68:71],a[8:11],v[232:235],v[68:71]
ds_read_b128 v[228:231],v17 offset:19456
v_min3_u32 v27,v27,v232,v236
buffer_load_dwordx4 v[152:155],v16,s[20:23],s66 offen offset:2048 sc1
buffer_load_dwordx4 v[156:159],v16,s[20:23],s66 offen offset:3072 sc1
v_mfma_f32_16x16x32_bf16 v[76:79],a[12:15],v[236:239],v[76:79]
ds_read_b128 v[232:235],v17 offset:21504
s_xor_b32 m0,s72,0
s_add_u32 s65,s88,0
s_waitcnt lgkmcnt(5)
v_mfma_f32_16x16x32_bf16 v[68:71],a[16:19],v[240:243],v[68:71]
ds_read_b128 v[236:239],v17 offset:23552
v_min3_u32 v27,v27,v240,v244
v_add_f32 v64,v64,v72
v_add_f32 v65,v65,v73
v_add_f32 v66,v66,v74
v_add_f32 v67,v67,v75
buffer_load_dwordx4 v16,s[20:23],s65 offen offset:0 sc1 lds
v_mfma_f32_16x16x32_bf16 v[76:79],a[20:23],v[244:247],v[76:79]
ds_read_b128 v[240:243],v17 offset:25600
v_fmac_f32 v64,v52,v120
v_fmac_f32 v65,v53,v120
v_fmac_f32 v66,v54,v120
v_fmac_f32 v67,v55,v120
buffer_load_dwordx4 v16,s[20:23],s65 offen offset:2048 sc1 lds
s_waitcnt lgkmcnt(5)
v_mfma_f32_16x16x32_bf16 v[68:71],a[24:27],v[248:251],v[68:71]
ds_read_b128 v[244:247],v17 offset:27648
v_min3_u32 v27,v27,v248,v252
v_mul_f32 v88,v64,v64
v_mul_f32 v89,v65,v65
v_mul_f32 v90,v66,v66
v_mul_f32 v91,v67,v67
s_xor_b32 m0,s72,16384
s_add_u32 s65,s88,32768
v_mfma_f32_16x16x32_bf16 v[76:79],a[28:31],v[252:255],v[76:79]
ds_read_b128 v[248:251],v17 offset:29696
v_fma_f32 v88,v88,v121,v122
v_fma_f32 v89,v89,v121,v122
v_fma_f32 v90,v90,v121,v122
v_fma_f32 v91,v91,v121,v122
buffer_load_dwordx4 v16,s[20:23],s65 offen offset:0 sc1 lds
s_waitcnt lgkmcnt(5)
v_mfma_f32_16x16x32_bf16 v[68:71],a[32:35],v[224:227],v[68:71]
ds_read_b128 v[252:255],v17 offset:31744
v_min3_u32 v27,v27,v224,v228
v_mul_f32 v88,v88,v64
v_mul_f32 v89,v89,v65
v_mul_f32 v90,v90,v66
v_mul_f32 v91,v91,v67
buffer_load_dwordx4 v16,s[20:23],s65 offen offset:2048 sc1 lds
v_mfma_f32_16x16x32_bf16 v[76:79],a[36:39],v[228:231],v[76:79]
s_waitcnt vmcnt(12)
s_barrier
ds_read_b128 v[224:227],v17 offset:33792
v_exp_f32 v88,v88
s_xor_b32 m0,s72,32768
s_add_u32 s65,s88,65536
s_waitcnt lgkmcnt(5)
v_mfma_f32_16x16x32_bf16 v[68:71],a[40:43],v[232:235],v[68:71]
ds_read_b128 v[228:231],v17 offset:35840
v_min3_u32 v27,v27,v232,v236
v_exp_f32 v89,v89
v_exp_f32 v90,v90
buffer_load_dwordx4 v16,s[20:23],s65 offen offset:0 sc1 lds
v_mfma_f32_16x16x32_bf16 v[76:79],a[44:47],v[236:239],v[76:79]
ds_read_b128 v[232:235],v17 offset:37888
v_exp_f32 v91,v91
v_fma_f32 v88,v88,v123,v123
v_fma_f32 v89,v89,v123,v123
buffer_load_dwordx4 v16,s[20:23],s65 offen offset:2048 sc1 lds
s_waitcnt lgkmcnt(5)
v_mfma_f32_16x16x32_bf16 v[68:71],a[48:51],v[240:243],v[68:71]
ds_read_b128 v[236:239],v17 offset:39936
v_min3_u32 v27,v27,v240,v244
v_fma_f32 v90,v90,v123,v123
v_fma_f32 v91,v91,v123,v123
v_rcp_f32 v88,v88
s_xor_b32 m0,s72,49152
s_add_u32 s65,s88,98304
v_mfma_f32_16x16x32_bf16 v[76:79],a[52:55],v[244:247],v[76:79]
ds_read_b128 v[240:243],v17 offset:41984
v_rcp_f32 v89,v89
v_rcp_f32 v90,v90
buffer_load_dwordx4 v16,s[20:23],s65 offen offset:0 sc1 lds
s_waitcnt lgkmcnt(5)
v_mfma_f32_16x16x32_bf16 v[68:71],a[56:59],v[248:251],v[68:71]
ds_read_b128 v[244:247],v17 offset:44032
v_min3_u32 v27,v27,v248,v252
v_rcp_f32 v91,v91
v_mul_f32 v88,v88,v64
v_mul_f32 v89,v89,v65
buffer_load_dwordx4 v16,s[20:23],s65 offen offset:2048 sc1 lds
v_mfma_f32_16x16x32_bf16 v[76:79],a[60:63],v[252:255],v[76:79]
ds_read_b128 v[248:251],v17 offset:46080
v_mul_f32 v90,v90,v66
v_mul_f32 v91,v91,v67
v_cvt_pk_bf16_f32 v96,v88,v89
v_cvt_pk_bf16_f32 v97,v90,v91
s_waitcnt lgkmcnt(5)
v_mfma_f32_16x16x32_bf16 v[68:71],a[64:67],v[224:227],v[68:71]
ds_read_b128 v[252:255],v17 offset:48128
v_min3_u32 v27,v27,v224,v228
v_max_u32 v96,1,v96
buffer_store_dwordx2 v[96:97],v18,s[20:23],s70 offen offset:0 sc1
s_xor_b32 m0,s72,1024
v_mfma_f32_16x16x32_bf16 v[76:79],a[68:71],v[228:231],v[76:79]
ds_read_b128 v[224:227],v17 offset:50176
s_add_u32 s65,s89,0
buffer_load_dwordx4 v16,s[20:23],s65 offen offset:0 sc1 lds
s_waitcnt lgkmcnt(5)
v_mfma_f32_16x16x32_bf16 v[68:71],a[72:75],v[232:235],v[68:71]
ds_read_b128 v[228:231],v17 offset:52224
v_min3_u32 v27,v27,v232,v236
buffer_load_dwordx4 v16,s[20:23],s65 offen offset:2048 sc1 lds
s_xor_b32 m0,s72,17408
s_add_u32 s65,s89,32768
v_mfma_f32_16x16x32_bf16 v[76:79],a[76:79],v[236:239],v[76:79]
ds_read_b128 v[232:235],v17 offset:54272
buffer_load_dwordx4 v16,s[20:23],s65 offen offset:0 sc1 lds
buffer_load_dwordx4 v16,s[20:23],s65 offen offset:2048 sc1 lds
s_waitcnt lgkmcnt(5)
v_mfma_f32_16x16x32_bf16 v[68:71],a[80:83],v[240:243],v[68:71]
ds_read_b128 v[236:239],v17 offset:56320
v_min3_u32 v27,v27,v240,v244
s_xor_b32 m0,s72,33792
s_add_u32 s65,s89,65536
buffer_load_dwordx4 v16,s[20:23],s65 offen offset:0 sc1 lds
v_mfma_f32_16x16x32_bf16 v[76:79],a[84:87],v[244:247],v[76:79]
ds_read_b128 v[240:243],v17 offset:58368
buffer_load_dwordx4 v16,s[20:23],s65 offen offset:2048 sc1 lds
s_xor_b32 m0,s72,50176
s_add_u32 s65,s89,98304
s_waitcnt lgkmcnt(5)
v_mfma_f32_16x16x32_bf16 v[68:71],a[88:91],v[248:251],v[68:71]
ds_read_b128 v[244:247],v17 offset:60416
v_min3_u32 v27,v27,v248,v252
buffer_load_dwordx4 v16,s[20:23],s65 offen offset:0 sc1 lds
buffer_load_dwordx4 v16,s[20:23],s65 offen offset:2048 sc1 lds
v_mfma_f32_16x16x32_bf16 v[76:79],a[92:95],v[252:255],v[76:79]
ds_read_b128 v[248:251],v17 offset:62464
s_waitcnt lgkmcnt(5)
v_mfma_f32_16x16x32_bf16 v[68:71],a[96:99],v[224:227],v[68:71]
ds_read_b128 v[252:255],v17 offset:64512
v_min3_u32 v27,v27,v224,v228
v_mfma_f32_16x16x32_bf16 v[76:79],a[100:103],v[228:231],v[76:79]
s_waitcnt lgkmcnt(4)
v_mfma_f32_16x16x32_bf16 v[68:71],a[104:107],v[232:235],v[68:71]
v_min3_u32 v27,v27,v232,v236
v_mfma_f32_16x16x32_bf16 v[76:79],a[108:111],v[236:239],v[76:79]
s_waitcnt lgkmcnt(2)
v_mfma_f32_16x16x32_bf16 v[68:71],a[112:115],v[240:243],v[68:71]
v_min3_u32 v27,v27,v240,v244
v_mfma_f32_16x16x32_bf16 v[76:79],a[116:119],v[244:247],v[76:79]
s_waitcnt lgkmcnt(0)
v_mfma_f32_16x16x32_bf16 v[68:71],a[120:123],v[248:251],v[68:71]
v_min3_u32 v27,v27,v248,v252
v_mfma_f32_16x16x32_bf16 v[76:79],a[124:127],v[252:255],v[76:79]
v_cmp_eq_u32 vcc,0,v27
s_cbranch_vccnz retry_392
s_branch epi_395
ahead_394:
s_cmp_eq_u32 s93,0
s_cbranch_scc1 both_396
s_waitcnt vmcnt(11) lgkmcnt(0)
s_barrier
ds_read_b128 v[224:227],v17 offset:0
ds_read_b128 v[228:231],v17 offset:2048
ds_read_b128 v[232:235],v17 offset:4096
ds_read_b128 v[236:239],v17 offset:6144
ds_read_b128 v[240:243],v17 offset:8192
ds_read_b128 v[244:247],v17 offset:10240
ds_read_b128 v[248:251],v17 offset:12288
s_waitcnt lgkmcnt(5)
v_mfma_f32_16x16x32_bf16 v[64:67],a[0:3],v[224:227],0
ds_read_b128 v[252:255],v17 offset:14336
v_min_u32 v27,v224,v228
s_waitcnt vmcnt(12)
stk_409:
v_min3_u32 v22,v129,v133,v137
v_min3_u32 v22,v22,v141,v145
v_min3_u32 v22,v22,v149,v153
v_min_u32 v22,v22,v157
v_cmp_eq_u32 vcc,0,v22
s_cmp_lt_i32 s90,0
s_cselect_b64 vcc,0,vcc
s_cbranch_vccnz str_410
v_mfma_f32_16x16x32_bf16 v[72:75],a[4:7],v[228:231],0
ds_read_b128 v[224:227],v17 offset:16384
v_pk_add_f32 v[88:89],v[128:129],v[144:145]
v_pk_add_f32 v[90:91],v[130:131],v[146:147]
v_pk_add_f32 v[92:93],v[132:133],v[148:149]
v_pk_add_f32 v[94:95],v[134:135],v[150:151]
s_waitcnt lgkmcnt(5)
v_mfma_f32_16x16x32_bf16 v[64:67],a[8:11],v[232:235],v[64:67]
ds_read_b128 v[228:231],v17 offset:18432
v_min3_u32 v27,v27,v232,v236
v_pk_add_f32 v[96:97],v[136:137],v[152:153]
v_pk_add_f32 v[98:99],v[138:139],v[154:155]
v_pk_add_f32 v[100:101],v[140:141],v[156:157]
v_pk_add_f32 v[102:103],v[142:143],v[158:159]
v_mfma_f32_16x16x32_bf16 v[72:75],a[12:15],v[236:239],v[72:75]
ds_read_b128 v[232:235],v17 offset:20480
s_waitcnt lgkmcnt(5)
v_mfma_f32_16x16x32_bf16 v[64:67],a[16:19],v[240:243],v[64:67]
ds_read_b128 v[236:239],v17 offset:22528
v_min3_u32 v27,v27,v240,v244
v_pk_add_f32 v[88:89],v[88:89],v[96:97]
v_pk_add_f32 v[90:91],v[90:91],v[98:99]
v_pk_add_f32 v[92:93],v[92:93],v[100:101]
v_mfma_f32_16x16x32_bf16 v[72:75],a[20:23],v[244:247],v[72:75]
ds_read_b128 v[240:243],v17 offset:24576
v_pk_add_f32 v[94:95],v[94:95],v[102:103]
v_pk_add_f32 v[88:89],v[88:89],v[92:93]
v_pk_add_f32 v[90:91],v[90:91],v[94:95]
s_waitcnt lgkmcnt(5)
v_mfma_f32_16x16x32_bf16 v[64:67],a[24:27],v[248:251],v[64:67]
ds_read_b128 v[244:247],v17 offset:26624
v_min3_u32 v27,v27,v248,v252
v_mov_b32 v92,v88
v_mov_b32 v93,v89
v_mov_b32 v94,v90
v_mfma_f32_16x16x32_bf16 v[72:75],a[28:31],v[252:255],v[72:75]
ds_read_b128 v[248:251],v17 offset:28672
v_mov_b32 v95,v91
v_permlane16_swap_b32 v92,v88
v_permlane16_swap_b32 v93,v89
s_waitcnt lgkmcnt(5)
v_mfma_f32_16x16x32_bf16 v[64:67],a[32:35],v[224:227],v[64:67]
ds_read_b128 v[252:255],v17 offset:30720
v_min3_u32 v27,v27,v224,v228
v_permlane16_swap_b32 v94,v90
v_permlane16_swap_b32 v95,v91
v_mfma_f32_16x16x32_bf16 v[72:75],a[36:39],v[228:231],v[72:75]
ds_read_b128 v[224:227],v17 offset:32768
v_pk_add_f32 v[88:89],v[88:89],v[92:93]
v_pk_add_f32 v[90:91],v[90:91],v[94:95]
v_mov_b32 v92,v88
s_waitcnt lgkmcnt(5)
v_mfma_f32_16x16x32_bf16 v[64:67],a[40:43],v[232:235],v[64:67]
ds_read_b128 v[228:231],v17 offset:34816
v_min3_u32 v27,v27,v232,v236
v_mov_b32 v93,v89
v_mov_b32 v94,v90
v_mov_b32 v95,v91
v_mfma_f32_16x16x32_bf16 v[72:75],a[44:47],v[236:239],v[72:75]
ds_read_b128 v[232:235],v17 offset:36864
v_permlane32_swap_b32 v92,v88
v_permlane32_swap_b32 v93,v89
v_permlane32_swap_b32 v94,v90
s_waitcnt lgkmcnt(5)
v_mfma_f32_16x16x32_bf16 v[64:67],a[48:51],v[240:243],v[64:67]
ds_read_b128 v[236:239],v17 offset:38912
v_min3_u32 v27,v27,v240,v244
v_permlane32_swap_b32 v95,v91
v_pk_add_f32 v[88:89],v[88:89],v[92:93]
v_mfma_f32_16x16x32_bf16 v[72:75],a[52:55],v[244:247],v[72:75]
ds_read_b128 v[240:243],v17 offset:40960
v_pk_add_f32 v[90:91],v[90:91],v[94:95]
v_mul_f32 v120,0xba800000,v88
v_mul_f32 v124,0xba800000,v90
s_add_u32 s88,s70,s75
s_waitcnt lgkmcnt(5)
v_mfma_f32_16x16x32_bf16 v[64:67],a[56:59],v[248:251],v[64:67]
ds_read_b128 v[244:247],v17 offset:43008
v_min3_u32 v27,v27,v248,v252
v_mul_f32 v92,v120,v120
v_mul_f32 v93,v124,v124
v_fma_f32 v92,v89,s82,-v92
s_add_u32 s88,s88,2097152
v_mfma_f32_16x16x32_bf16 v[72:75],a[60:63],v[252:255],v[72:75]
ds_read_b128 v[248:251],v17 offset:45056
v_fma_f32 v93,v91,s82,-v93
v_max_f32 v92,0,v92
v_max_f32 v93,0,v93
s_xor_b32 s88,s88,0x2000
s_waitcnt lgkmcnt(5)
v_mfma_f32_16x16x32_bf16 v[64:67],a[64:67],v[224:227],v[64:67]
ds_read_b128 v[252:255],v17 offset:47104
v_min3_u32 v27,v27,v224,v228
v_add_f32 v92,0x3727c5ac,v92
v_add_f32 v93,0x3727c5ac,v93
v_rsq_f32 v94,v92
v_mfma_f32_16x16x32_bf16 v[72:75],a[68:71],v[228:231],v[72:75]
ds_read_b128 v[224:227],v17 offset:49152
v_rsq_f32 v95,v93
v_mul_f32 v123,v92,v94
s_xor_b32 s89,s88,1024
s_waitcnt lgkmcnt(5)
v_mfma_f32_16x16x32_bf16 v[64:67],a[72:75],v[232:235],v[64:67]
ds_read_b128 v[228:231],v17 offset:51200
v_min3_u32 v27,v27,v232,v236
v_mul_f32 v127,v93,v95
v_mul_f32 v122,v28,v94
v_mul_f32 v126,v28,v95
v_mfma_f32_16x16x32_bf16 v[72:75],a[76:79],v[236:239],v[72:75]
ds_read_b128 v[232:235],v17 offset:53248
v_mul_f32 v92,v94,v94
v_mul_f32 v93,v95,v95
v_mul_f32 v94,s81,v94
s_waitcnt lgkmcnt(5)
v_mfma_f32_16x16x32_bf16 v[64:67],a[80:83],v[240:243],v[64:67]
ds_read_b128 v[236:239],v17 offset:55296
v_min3_u32 v27,v27,v240,v244
v_mul_f32 v95,s81,v95
v_mul_f32 v121,v92,v94
v_mul_f32 v125,v93,v95
v_mfma_f32_16x16x32_bf16 v[72:75],a[84:87],v[244:247],v[72:75]
ds_read_b128 v[240:243],v17 offset:57344
ds_write_b128 v19,v[120:123] offset:0
ds_write_b128 v19,v[124:127] offset:256
s_waitcnt lgkmcnt(7)
v_mfma_f32_16x16x32_bf16 v[64:67],a[88:91],v[248:251],v[64:67]
ds_read_b128 v[244:247],v17 offset:59392
v_min3_u32 v27,v27,v248,v252
v_mfma_f32_16x16x32_bf16 v[72:75],a[92:95],v[252:255],v[72:75]
ds_read_b128 v[248:251],v17 offset:61440
s_waitcnt lgkmcnt(7)
v_mfma_f32_16x16x32_bf16 v[64:67],a[96:99],v[224:227],v[64:67]
ds_read_b128 v[252:255],v17 offset:63488
v_min3_u32 v27,v27,v224,v228
v_mfma_f32_16x16x32_bf16 v[72:75],a[100:103],v[228:231],v[72:75]
s_waitcnt vmcnt(3) lgkmcnt(0)
s_barrier
ds_read_b64 v[44:45],v47
ds_read_b128 v[224:227],v17 offset:1024
s_waitcnt vmcnt(0)
v_add_u32 v22,s71,-1
v_mfma_f32_16x16x32_bf16 v[64:67],a[104:107],v[232:235],v[64:67]
ds_read_b128 v[228:231],v17 offset:3072
v_min3_u32 v27,v27,v232,v236
buffer_store_dword v22,v23,s[20:23],s97 offen sc1
s_mov_b32 s97,0x7fff0000
v_mfma_f32_16x16x32_bf16 v[72:75],a[108:111],v[236:239],v[72:75]
ds_read_b128 v[232:235],v17 offset:5120
v_mfma_f32_16x16x32_bf16 v[64:67],a[112:115],v[240:243],v[64:67]
ds_read_b128 v[236:239],v17 offset:7168
v_min3_u32 v27,v27,v240,v244
v_mfma_f32_16x16x32_bf16 v[72:75],a[116:119],v[244:247],v[72:75]
ds_read_b128 v[240:243],v17 offset:9216
s_waitcnt lgkmcnt(5)
v_readfirstlane_b32 s93,v45
v_mfma_f32_16x16x32_bf16 v[64:67],a[120:123],v[248:251],v[64:67]
ds_read_b128 v[244:247],v17 offset:11264
v_readfirstlane_b32 s83,v44
s_cmp_lg_u32 s83,0
s_cbranch_scc1 keep_404
v_min3_u32 v27,v27,v248,v252
v_mfma_f32_16x16x32_bf16 v[72:75],a[124:127],v[252:255],v[72:75]
ds_read_b128 v[248:251],v17 offset:13312
s_add_u32 s66,s88,110592
buffer_load_dwordx4 v[128:131],v16,s[20:23],s66 offen offset:0 sc1
buffer_load_dwordx4 v[132:135],v16,s[20:23],s66 offen offset:1024 sc1
s_waitcnt lgkmcnt(5)
v_mfma_f32_16x16x32_bf16 v[68:71],a[0:3],v[224:227],0
ds_read_b128 v[252:255],v17 offset:15360
v_cmp_eq_u32 vcc,0,v27
s_cbranch_vccnz retry_392
v_min3_u32 v27,v27,v224,v228
buffer_load_dwordx4 v[136:139],v16,s[20:23],s66 offen offset:2048 sc1
buffer_load_dwordx4 v[140:143],v16,s[20:23],s66 offen offset:3072 sc1
v_mfma_f32_16x16x32_bf16 v[76:79],a[4:7],v[228:231],0
ds_read_b128 v[224:227],v17 offset:17408
s_add_u32 s66,s88,114688
buffer_load_dwordx4 v[144:147],v16,s[20:23],s66 offen offset:0 sc1
buffer_load_dwordx4 v[148:151],v16,s[20:23],s66 offen offset:1024 sc1
s_waitcnt lgkmcnt(5)
v_mfma_f32_16x16x32_bf16 v[68:71],a[8:11],v[232:235],v[68:71]
ds_read_b128 v[228:231],v17 offset:19456
v_min3_u32 v27,v27,v232,v236
buffer_load_dwordx4 v[152:155],v16,s[20:23],s66 offen offset:2048 sc1
buffer_load_dwordx4 v[156:159],v16,s[20:23],s66 offen offset:3072 sc1
v_mfma_f32_16x16x32_bf16 v[76:79],a[12:15],v[236:239],v[76:79]
ds_read_b128 v[232:235],v17 offset:21504
s_xor_b32 m0,s72,0
s_add_u32 s65,s88,0
s_waitcnt lgkmcnt(5)
v_mfma_f32_16x16x32_bf16 v[68:71],a[16:19],v[240:243],v[68:71]
ds_read_b128 v[236:239],v17 offset:23552
v_min3_u32 v27,v27,v240,v244
v_add_f32 v64,v64,v72
v_add_f32 v65,v65,v73
v_add_f32 v66,v66,v74
v_add_f32 v67,v67,v75
buffer_load_dwordx4 v16,s[20:23],s65 offen offset:0 sc1 lds
v_mfma_f32_16x16x32_bf16 v[76:79],a[20:23],v[244:247],v[76:79]
ds_read_b128 v[240:243],v17 offset:25600
v_fmac_f32 v64,v52,v120
v_fmac_f32 v65,v53,v120
v_fmac_f32 v66,v54,v120
v_fmac_f32 v67,v55,v120
buffer_load_dwordx4 v16,s[20:23],s65 offen offset:2048 sc1 lds
s_waitcnt lgkmcnt(5)
v_mfma_f32_16x16x32_bf16 v[68:71],a[24:27],v[248:251],v[68:71]
ds_read_b128 v[244:247],v17 offset:27648
v_min3_u32 v27,v27,v248,v252
v_mul_f32 v88,v64,v64
v_mul_f32 v89,v65,v65
v_mul_f32 v90,v66,v66
v_mul_f32 v91,v67,v67
s_xor_b32 m0,s72,16384
s_add_u32 s65,s88,32768
v_mfma_f32_16x16x32_bf16 v[76:79],a[28:31],v[252:255],v[76:79]
ds_read_b128 v[248:251],v17 offset:29696
v_fma_f32 v88,v88,v121,v122
v_fma_f32 v89,v89,v121,v122
v_fma_f32 v90,v90,v121,v122
v_fma_f32 v91,v91,v121,v122
buffer_load_dwordx4 v16,s[20:23],s65 offen offset:0 sc1 lds
s_waitcnt lgkmcnt(5)
v_mfma_f32_16x16x32_bf16 v[68:71],a[32:35],v[224:227],v[68:71]
ds_read_b128 v[252:255],v17 offset:31744
v_min3_u32 v27,v27,v224,v228
v_mul_f32 v88,v88,v64
v_mul_f32 v89,v89,v65
v_mul_f32 v90,v90,v66
v_mul_f32 v91,v91,v67
buffer_load_dwordx4 v16,s[20:23],s65 offen offset:2048 sc1 lds
v_mfma_f32_16x16x32_bf16 v[76:79],a[36:39],v[228:231],v[76:79]
ds_read_b128 v[224:227],v17 offset:33792
v_exp_f32 v88,v88
v_exp_f32 v89,v89
s_xor_b32 m0,s72,32768
s_add_u32 s65,s88,65536
s_waitcnt lgkmcnt(5)
v_mfma_f32_16x16x32_bf16 v[68:71],a[40:43],v[232:235],v[68:71]
ds_read_b128 v[228:231],v17 offset:35840
v_min3_u32 v27,v27,v232,v236
v_exp_f32 v90,v90
v_exp_f32 v91,v91
buffer_load_dwordx4 v16,s[20:23],s65 offen offset:0 sc1 lds
v_mfma_f32_16x16x32_bf16 v[76:79],a[44:47],v[236:239],v[76:79]
ds_read_b128 v[232:235],v17 offset:37888
v_fma_f32 v88,v88,v123,v123
v_fma_f32 v89,v89,v123,v123
v_fma_f32 v90,v90,v123,v123
v_fma_f32 v91,v91,v123,v123
buffer_load_dwordx4 v16,s[20:23],s65 offen offset:2048 sc1 lds
s_waitcnt lgkmcnt(5)
v_mfma_f32_16x16x32_bf16 v[68:71],a[48:51],v[240:243],v[68:71]
ds_read_b128 v[236:239],v17 offset:39936
v_min3_u32 v27,v27,v240,v244
v_rcp_f32 v88,v88
v_rcp_f32 v89,v89
s_xor_b32 m0,s72,49152
s_add_u32 s65,s88,98304
v_mfma_f32_16x16x32_bf16 v[76:79],a[52:55],v[244:247],v[76:79]
ds_read_b128 v[240:243],v17 offset:41984
v_rcp_f32 v90,v90
v_rcp_f32 v91,v91
buffer_load_dwordx4 v16,s[20:23],s65 offen offset:0 sc1 lds
s_waitcnt lgkmcnt(5)
v_mfma_f32_16x16x32_bf16 v[68:71],a[56:59],v[248:251],v[68:71]
ds_read_b128 v[244:247],v17 offset:44032
v_min3_u32 v27,v27,v248,v252
v_mul_f32 v88,v88,v64
v_mul_f32 v89,v89,v65
v_mul_f32 v90,v90,v66
v_mul_f32 v91,v91,v67
v_mfma_f32_16x16x32_bf16 v[76:79],a[60:63],v[252:255],v[76:79]
ds_read_b128 v[248:251],v17 offset:46080
v_cvt_pk_bf16_f32 v96,v88,v89
v_cvt_pk_bf16_f32 v97,v90,v91
v_max_u32 v96,1,v96
s_waitcnt lgkmcnt(5)
v_mfma_f32_16x16x32_bf16 v[68:71],a[64:67],v[224:227],v[68:71]
ds_read_b128 v[252:255],v17 offset:48128
v_min3_u32 v27,v27,v224,v228
buffer_store_dwordx2 v[96:97],v18,s[20:23],s70 offen offset:0 sc1
buffer_load_dwordx4 v16,s[20:23],s65 offen offset:2048 sc1 lds
v_mfma_f32_16x16x32_bf16 v[76:79],a[68:71],v[228:231],v[76:79]
ds_read_b128 v[224:227],v17 offset:50176
s_xor_b32 m0,s72,1024
s_add_u32 s65,s89,0
buffer_load_dwordx4 v16,s[20:23],s65 offen offset:0 sc1 lds
s_waitcnt lgkmcnt(5)
v_mfma_f32_16x16x32_bf16 v[68:71],a[72:75],v[232:235],v[68:71]
ds_read_b128 v[228:231],v17 offset:52224
v_min3_u32 v27,v27,v232,v236
buffer_load_dwordx4 v16,s[20:23],s65 offen offset:2048 sc1 lds
s_xor_b32 m0,s72,17408
s_add_u32 s65,s89,32768
v_mfma_f32_16x16x32_bf16 v[76:79],a[76:79],v[236:239],v[76:79]
ds_read_b128 v[232:235],v17 offset:54272
buffer_load_dwordx4 v16,s[20:23],s65 offen offset:0 sc1 lds
buffer_load_dwordx4 v16,s[20:23],s65 offen offset:2048 sc1 lds
s_waitcnt lgkmcnt(5)
v_mfma_f32_16x16x32_bf16 v[68:71],a[80:83],v[240:243],v[68:71]
ds_read_b128 v[236:239],v17 offset:56320
v_min3_u32 v27,v27,v240,v244
s_xor_b32 m0,s72,33792
s_add_u32 s65,s89,65536
buffer_load_dwordx4 v16,s[20:23],s65 offen offset:0 sc1 lds
v_mfma_f32_16x16x32_bf16 v[76:79],a[84:87],v[244:247],v[76:79]
ds_read_b128 v[240:243],v17 offset:58368
buffer_load_dwordx4 v16,s[20:23],s65 offen offset:2048 sc1 lds
s_xor_b32 m0,s72,50176
s_add_u32 s65,s89,98304
s_waitcnt lgkmcnt(5)
v_mfma_f32_16x16x32_bf16 v[68:71],a[88:91],v[248:251],v[68:71]
ds_read_b128 v[244:247],v17 offset:60416
v_min3_u32 v27,v27,v248,v252
buffer_load_dwordx4 v16,s[20:23],s65 offen offset:0 sc1 lds
buffer_load_dwordx4 v16,s[20:23],s65 offen offset:2048 sc1 lds
v_mfma_f32_16x16x32_bf16 v[76:79],a[92:95],v[252:255],v[76:79]
ds_read_b128 v[248:251],v17 offset:62464
s_waitcnt lgkmcnt(5)
v_mfma_f32_16x16x32_bf16 v[68:71],a[96:99],v[224:227],v[68:71]
ds_read_b128 v[252:255],v17 offset:64512
v_min3_u32 v27,v27,v224,v228
v_mfma_f32_16x16x32_bf16 v[76:79],a[100:103],v[228:231],v[76:79]
s_waitcnt lgkmcnt(4)
v_mfma_f32_16x16x32_bf16 v[68:71],a[104:107],v[232:235],v[68:71]
v_min3_u32 v27,v27,v232,v236
v_mfma_f32_16x16x32_bf16 v[76:79],a[108:111],v[236:239],v[76:79]
s_waitcnt lgkmcnt(2)
v_mfma_f32_16x16x32_bf16 v[68:71],a[112:115],v[240:243],v[68:71]
v_min3_u32 v27,v27,v240,v244
v_mfma_f32_16x16x32_bf16 v[76:79],a[116:119],v[244:247],v[76:79]
s_waitcnt lgkmcnt(0)
v_mfma_f32_16x16x32_bf16 v[68:71],a[120:123],v[248:251],v[68:71]
v_min3_u32 v27,v27,v248,v252
v_mfma_f32_16x16x32_bf16 v[76:79],a[124:127],v[252:255],v[76:79]
v_cmp_eq_u32 vcc,0,v27
s_cbranch_vccnz retry_392
s_branch epi_395
keep_404:
v_min3_u32 v27,v27,v248,v252
v_mfma_f32_16x16x32_bf16 v[72:75],a[124:127],v[252:255],v[72:75]
ds_read_b128 v[248:251],v17 offset:13312
s_waitcnt lgkmcnt(5)
v_mfma_f32_16x16x32_bf16 v[68:71],a[0:3],v[224:227],0
ds_read_b128 v[252:255],v17 offset:15360
v_cmp_eq_u32 vcc,0,v27
s_cbranch_vccnz retry_392
v_min3_u32 v27,v27,v224,v228
v_mfma_f32_16x16x32_bf16 v[76:79],a[4:7],v[228:231],0
ds_read_b128 v[224:227],v17 offset:17408
s_waitcnt lgkmcnt(5)
v_mfma_f32_16x16x32_bf16 v[68:71],a[8:11],v[232:235],v[68:71]
ds_read_b128 v[228:231],v17 offset:19456
v_min3_u32 v27,v27,v232,v236
v_mfma_f32_16x16x32_bf16 v[76:79],a[12:15],v[236:239],v[76:79]
ds_read_b128 v[232:235],v17 offset:21504
s_waitcnt lgkmcnt(5)
v_mfma_f32_16x16x32_bf16 v[68:71],a[16:19],v[240:243],v[68:71]
ds_read_b128 v[236:239],v17 offset:23552
v_min3_u32 v27,v27,v240,v244
v_add_f32 v64,v64,v72
v_add_f32 v65,v65,v73
v_add_f32 v66,v66,v74
v_add_f32 v67,v67,v75
v_mfma_f32_16x16x32_bf16 v[76:79],a[20:23],v[244:247],v[76:79]
ds_read_b128 v[240:243],v17 offset:25600
v_fmac_f32 v64,v52,v120
v_fmac_f32 v65,v53,v120
v_fmac_f32 v66,v54,v120
v_fmac_f32 v67,v55,v120
s_waitcnt lgkmcnt(5)
v_mfma_f32_16x16x32_bf16 v[68:71],a[24:27],v[248:251],v[68:71]
ds_read_b128 v[244:247],v17 offset:27648
v_min3_u32 v27,v27,v248,v252
v_mul_f32 v88,v64,v64
v_mul_f32 v89,v65,v65
v_mul_f32 v90,v66,v66
v_mul_f32 v91,v67,v67
v_mfma_f32_16x16x32_bf16 v[76:79],a[28:31],v[252:255],v[76:79]
ds_read_b128 v[248:251],v17 offset:29696
v_fma_f32 v88,v88,v121,v122
v_fma_f32 v89,v89,v121,v122
v_fma_f32 v90,v90,v121,v122
v_fma_f32 v91,v91,v121,v122
s_waitcnt lgkmcnt(5)
v_mfma_f32_16x16x32_bf16 v[68:71],a[32:35],v[224:227],v[68:71]
ds_read_b128 v[252:255],v17 offset:31744
v_min3_u32 v27,v27,v224,v228
v_mul_f32 v88,v88,v64
v_mul_f32 v89,v89,v65
v_mul_f32 v90,v90,v66
v_mul_f32 v91,v91,v67
v_mfma_f32_16x16x32_bf16 v[76:79],a[36:39],v[228:231],v[76:79]
ds_read_b128 v[224:227],v17 offset:33792
v_exp_f32 v88,v88
v_exp_f32 v89,v89
s_waitcnt lgkmcnt(5)
v_mfma_f32_16x16x32_bf16 v[68:71],a[40:43],v[232:235],v[68:71]
ds_read_b128 v[228:231],v17 offset:35840
v_min3_u32 v27,v27,v232,v236
v_exp_f32 v90,v90
v_exp_f32 v91,v91
v_mfma_f32_16x16x32_bf16 v[76:79],a[44:47],v[236:239],v[76:79]
ds_read_b128 v[232:235],v17 offset:37888
v_fma_f32 v88,v88,v123,v123
v_fma_f32 v89,v89,v123,v123
v_fma_f32 v90,v90,v123,v123
v_fma_f32 v91,v91,v123,v123
s_waitcnt lgkmcnt(5)
v_mfma_f32_16x16x32_bf16 v[68:71],a[48:51],v[240:243],v[68:71]
ds_read_b128 v[236:239],v17 offset:39936
v_min3_u32 v27,v27,v240,v244
v_rcp_f32 v88,v88
v_rcp_f32 v89,v89
v_mfma_f32_16x16x32_bf16 v[76:79],a[52:55],v[244:247],v[76:79]
ds_read_b128 v[240:243],v17 offset:41984
v_rcp_f32 v90,v90
v_rcp_f32 v91,v91
s_waitcnt lgkmcnt(5)
v_mfma_f32_16x16x32_bf16 v[68:71],a[56:59],v[248:251],v[68:71]
ds_read_b128 v[244:247],v17 offset:44032
v_min3_u32 v27,v27,v248,v252
v_mul_f32 v88,v88,v64
v_mul_f32 v89,v89,v65
v_mul_f32 v90,v90,v66
v_mul_f32 v91,v91,v67
v_mfma_f32_16x16x32_bf16 v[76:79],a[60:63],v[252:255],v[76:79]
ds_read_b128 v[248:251],v17 offset:46080
v_cvt_pk_bf16_f32 v96,v88,v89
v_cvt_pk_bf16_f32 v97,v90,v91
v_max_u32 v96,1,v96
s_waitcnt lgkmcnt(5)
v_mfma_f32_16x16x32_bf16 v[68:71],a[64:67],v[224:227],v[68:71]
ds_read_b128 v[252:255],v17 offset:48128
v_min3_u32 v27,v27,v224,v228
buffer_store_dwordx2 v[96:97],v18,s[20:23],s70 offen offset:0 sc1
v_mfma_f32_16x16x32_bf16 v[76:79],a[68:71],v[228:231],v[76:79]
ds_read_b128 v[224:227],v17 offset:50176
s_waitcnt lgkmcnt(5)
v_mfma_f32_16x16x32_bf16 v[68:71],a[72:75],v[232:235],v[68:71]
ds_read_b128 v[228:231],v17 offset:52224
v_min3_u32 v27,v27,v232,v236
v_mfma_f32_16x16x32_bf16 v[76:79],a[76:79],v[236:239],v[76:79]
ds_read_b128 v[232:235],v17 offset:54272
s_waitcnt lgkmcnt(5)
v_mfma_f32_16x16x32_bf16 v[68:71],a[80:83],v[240:243],v[68:71]
ds_read_b128 v[236:239],v17 offset:56320
v_min3_u32 v27,v27,v240,v244
v_mfma_f32_16x16x32_bf16 v[76:79],a[84:87],v[244:247],v[76:79]
ds_read_b128 v[240:243],v17 offset:58368
s_waitcnt lgkmcnt(5)
v_mfma_f32_16x16x32_bf16 v[68:71],a[88:91],v[248:251],v[68:71]
ds_read_b128 v[244:247],v17 offset:60416
v_min3_u32 v27,v27,v248,v252
v_mfma_f32_16x16x32_bf16 v[76:79],a[92:95],v[252:255],v[76:79]
ds_read_b128 v[248:251],v17 offset:62464
s_waitcnt lgkmcnt(5)
v_mfma_f32_16x16x32_bf16 v[68:71],a[96:99],v[224:227],v[68:71]
ds_read_b128 v[252:255],v17 offset:64512
v_min3_u32 v27,v27,v224,v228
v_mfma_f32_16x16x32_bf16 v[76:79],a[100:103],v[228:231],v[76:79]
s_waitcnt lgkmcnt(4)
v_mfma_f32_16x16x32_bf16 v[68:71],a[104:107],v[232:235],v[68:71]
v_min3_u32 v27,v27,v232,v236
v_mfma_f32_16x16x32_bf16 v[76:79],a[108:111],v[236:239],v[76:79]
s_waitcnt lgkmcnt(2)
v_mfma_f32_16x16x32_bf16 v[68:71],a[112:115],v[240:243],v[68:71]
v_min3_u32 v27,v27,v240,v244
v_mfma_f32_16x16x32_bf16 v[76:79],a[116:119],v[244:247],v[76:79]
s_waitcnt lgkmcnt(0)
v_mfma_f32_16x16x32_bf16 v[68:71],a[120:123],v[248:251],v[68:71]
v_min3_u32 v27,v27,v248,v252
v_mfma_f32_16x16x32_bf16 v[76:79],a[124:127],v[252:255],v[76:79]
v_cmp_eq_u32 vcc,0,v27
s_cbranch_vccnz retry_392
s_branch epi_395
both_396:
s_waitcnt vmcnt(11) lgkmcnt(0)
s_barrier
ds_read_b128 v[224:227],v17 offset:0
ds_read_b128 v[228:231],v17 offset:2048
ds_read_b128 v[232:235],v17 offset:4096
ds_read_b128 v[236:239],v17 offset:6144
ds_read_b128 v[240:243],v17 offset:8192
ds_read_b128 v[244:247],v17 offset:10240
ds_read_b128 v[248:251],v17 offset:12288
s_waitcnt lgkmcnt(5)
v_mfma_f32_16x16x32_bf16 v[64:67],a[0:3],v[224:227],0
ds_read_b128 v[252:255],v17 offset:14336
v_min_u32 v27,v224,v228
s_waitcnt vmcnt(12)
stk_411:
v_min3_u32 v22,v129,v133,v137
v_min3_u32 v22,v22,v141,v145
v_min3_u32 v22,v22,v149,v153
v_min_u32 v22,v22,v157
v_cmp_eq_u32 vcc,0,v22
s_cmp_lt_i32 s90,0
s_cselect_b64 vcc,0,vcc
s_cbranch_vccnz str_412
v_mfma_f32_16x16x32_bf16 v[72:75],a[4:7],v[228:231],0
ds_read_b128 v[224:227],v17 offset:16384
v_pk_add_f32 v[88:89],v[128:129],v[144:145]
v_pk_add_f32 v[90:91],v[130:131],v[146:147]
v_pk_add_f32 v[92:93],v[132:133],v[148:149]
v_pk_add_f32 v[94:95],v[134:135],v[150:151]
s_waitcnt lgkmcnt(5)
v_mfma_f32_16x16x32_bf16 v[64:67],a[8:11],v[232:235],v[64:67]
ds_read_b128 v[228:231],v17 offset:18432
v_min3_u32 v27,v27,v232,v236
v_pk_add_f32 v[96:97],v[136:137],v[152:153]
v_pk_add_f32 v[98:99],v[138:139],v[154:155]
v_pk_add_f32 v[100:101],v[140:141],v[156:157]
v_pk_add_f32 v[102:103],v[142:143],v[158:159]
v_mfma_f32_16x16x32_bf16 v[72:75],a[12:15],v[236:239],v[72:75]
ds_read_b128 v[232:235],v17 offset:20480
s_add_u32 s88,s70,s75
s_add_u32 s88,s88,2097152
s_xor_b32 s88,s88,0x2000
s_xor_b32 s89,s88,1024
s_waitcnt lgkmcnt(5)
v_mfma_f32_16x16x32_bf16 v[64:67],a[16:19],v[240:243],v[64:67]
ds_read_b128 v[236:239],v17 offset:22528
v_min3_u32 v27,v27,v240,v244
v_pk_add_f32 v[88:89],v[88:89],v[96:97]
v_pk_add_f32 v[90:91],v[90:91],v[98:99]
v_pk_add_f32 v[92:93],v[92:93],v[100:101]
v_mfma_f32_16x16x32_bf16 v[72:75],a[20:23],v[244:247],v[72:75]
ds_read_b128 v[240:243],v17 offset:24576
v_pk_add_f32 v[94:95],v[94:95],v[102:103]
v_pk_add_f32 v[88:89],v[88:89],v[92:93]
v_pk_add_f32 v[90:91],v[90:91],v[94:95]
s_waitcnt lgkmcnt(5)
v_mfma_f32_16x16x32_bf16 v[64:67],a[24:27],v[248:251],v[64:67]
ds_read_b128 v[244:247],v17 offset:26624
v_min3_u32 v27,v27,v248,v252
v_mov_b32 v92,v88
v_mov_b32 v93,v89
v_mov_b32 v94,v90
v_mfma_f32_16x16x32_bf16 v[72:75],a[28:31],v[252:255],v[72:75]
ds_read_b128 v[248:251],v17 offset:28672
v_mov_b32 v95,v91
v_permlane16_swap_b32 v92,v88
v_permlane16_swap_b32 v93,v89
s_waitcnt lgkmcnt(5)
v_mfma_f32_16x16x32_bf16 v[64:67],a[32:35],v[224:227],v[64:67]
ds_read_b128 v[252:255],v17 offset:30720
v_min3_u32 v27,v27,v224,v228
v_permlane16_swap_b32 v94,v90
v_permlane16_swap_b32 v95,v91
s_add_u32 s66,s88,110592
buffer_load_dwordx4 v[128:131],v16,s[20:23],s66 offen offset:0 sc1
v_mfma_f32_16x16x32_bf16 v[72:75],a[36:39],v[228:231],v[72:75]
ds_read_b128 v[224:227],v17 offset:32768
v_pk_add_f32 v[88:89],v[88:89],v[92:93]
v_pk_add_f32 v[90:91],v[90:91],v[94:95]
v_mov_b32 v92,v88
buffer_load_dwordx4 v[132:135],v16,s[20:23],s66 offen offset:1024 sc1
s_waitcnt lgkmcnt(5)
v_mfma_f32_16x16x32_bf16 v[64:67],a[40:43],v[232:235],v[64:67]
ds_read_b128 v[228:231],v17 offset:34816
v_min3_u32 v27,v27,v232,v236
v_mov_b32 v93,v89
v_mov_b32 v94,v90
v_mov_b32 v95,v91
buffer_load_dwordx4 v[136:139],v16,s[20:23],s66 offen offset:2048 sc1
v_mfma_f32_16x16x32_bf16 v[72:75],a[44:47],v[236:239],v[72:75]
ds_read_b128 v[232:235],v17 offset:36864
v_permlane32_swap_b32 v92,v88
v_permlane32_swap_b32 v93,v89
v_permlane32_swap_b32 v94,v90
buffer_load_dwordx4 v[140:143],v16,s[20:23],s66 offen offset:3072 sc1
s_waitcnt lgkmcnt(5)
v_mfma_f32_16x16x32_bf16 v[64:67],a[48:51],v[240:243],v[64:67]
ds_read_b128 v[236:239],v17 offset:38912
v_min3_u32 v27,v27,v240,v244
v_permlane32_swap_b32 v95,v91
v_pk_add_f32 v[88:89],v[88:89],v[92:93]
s_add_u32 s66,s88,114688
buffer_load_dwordx4 v[144:147],v16,s[20:23],s66 offen offset:0 sc1
v_mfma_f32_16x16x32_bf16 v[72:75],a[52:55],v[244:247],v[72:75]
ds_read_b128 v[240:243],v17 offset:40960
v_pk_add_f32 v[90:91],v[90:91],v[94:95]
v_mul_f32 v120,0xba800000,v88
v_mul_f32 v124,0xba800000,v90
buffer_load_dwordx4 v[148:151],v16,s[20:23],s66 offen offset:1024 sc1
s_waitcnt lgkmcnt(5)
v_mfma_f32_16x16x32_bf16 v[64:67],a[56:59],v[248:251],v[64:67]
ds_read_b128 v[244:247],v17 offset:43008
v_min3_u32 v27,v27,v248,v252
v_mul_f32 v92,v120,v120
v_mul_f32 v93,v124,v124
v_fma_f32 v92,v89,s82,-v92
buffer_load_dwordx4 v[152:155],v16,s[20:23],s66 offen offset:2048 sc1
v_mfma_f32_16x16x32_bf16 v[72:75],a[60:63],v[252:255],v[72:75]
ds_read_b128 v[248:251],v17 offset:45056
v_fma_f32 v93,v91,s82,-v93
v_max_f32 v92,0,v92
v_max_f32 v93,0,v93
buffer_load_dwordx4 v[156:159],v16,s[20:23],s66 offen offset:3072 sc1
s_waitcnt lgkmcnt(5)
v_mfma_f32_16x16x32_bf16 v[64:67],a[64:67],v[224:227],v[64:67]
ds_read_b128 v[252:255],v17 offset:47104
v_min3_u32 v27,v27,v224,v228
v_add_f32 v92,0x3727c5ac,v92
v_add_f32 v93,0x3727c5ac,v93
v_rsq_f32 v94,v92
s_xor_b32 m0,s72,0
v_mfma_f32_16x16x32_bf16 v[72:75],a[68:71],v[228:231],v[72:75]
ds_read_b128 v[224:227],v17 offset:49152
v_rsq_f32 v95,v93
v_mul_f32 v123,v92,v94
s_add_u32 s65,s88,0
s_waitcnt lgkmcnt(5)
v_mfma_f32_16x16x32_bf16 v[64:67],a[72:75],v[232:235],v[64:67]
ds_read_b128 v[228:231],v17 offset:51200
v_min3_u32 v27,v27,v232,v236
v_mul_f32 v127,v93,v95
v_mul_f32 v122,v28,v94
v_mul_f32 v126,v28,v95
buffer_load_dwordx4 v16,s[20:23],s65 offen offset:0 sc1 lds
v_mfma_f32_16x16x32_bf16 v[72:75],a[76:79],v[236:239],v[72:75]
ds_read_b128 v[232:235],v17 offset:53248
v_mul_f32 v92,v94,v94
v_mul_f32 v93,v95,v95
v_mul_f32 v94,s81,v94
buffer_load_dwordx4 v16,s[20:23],s65 offen offset:2048 sc1 lds
s_waitcnt lgkmcnt(5)
v_mfma_f32_16x16x32_bf16 v[64:67],a[80:83],v[240:243],v[64:67]
ds_read_b128 v[236:239],v17 offset:55296
v_min3_u32 v27,v27,v240,v244
v_mul_f32 v95,s81,v95
v_mul_f32 v121,v92,v94
v_mul_f32 v125,v93,v95
s_xor_b32 m0,s72,16384
v_mfma_f32_16x16x32_bf16 v[72:75],a[84:87],v[244:247],v[72:75]
ds_read_b128 v[240:243],v17 offset:57344
ds_write_b128 v19,v[120:123] offset:0
ds_write_b128 v19,v[124:127] offset:256
s_add_u32 s65,s88,32768
s_waitcnt lgkmcnt(7)
v_mfma_f32_16x16x32_bf16 v[64:67],a[88:91],v[248:251],v[64:67]
ds_read_b128 v[244:247],v17 offset:59392
v_min3_u32 v27,v27,v248,v252
buffer_load_dwordx4 v16,s[20:23],s65 offen offset:0 sc1 lds
buffer_load_dwordx4 v16,s[20:23],s65 offen offset:2048 sc1 lds
v_mfma_f32_16x16x32_bf16 v[72:75],a[92:95],v[252:255],v[72:75]
ds_read_b128 v[248:251],v17 offset:61440
s_xor_b32 m0,s72,32768
s_add_u32 s65,s88,65536
buffer_load_dwordx4 v16,s[20:23],s65 offen offset:0 sc1 lds
s_waitcnt lgkmcnt(7)
v_mfma_f32_16x16x32_bf16 v[64:67],a[96:99],v[224:227],v[64:67]
ds_read_b128 v[252:255],v17 offset:63488
v_min3_u32 v27,v27,v224,v228
buffer_load_dwordx4 v16,s[20:23],s65 offen offset:2048 sc1 lds
s_xor_b32 m0,s72,49152
s_add_u32 s65,s88,98304
v_mfma_f32_16x16x32_bf16 v[72:75],a[100:103],v[228:231],v[72:75]
s_waitcnt vmcnt(17) lgkmcnt(0)
s_barrier
ds_read_b64 v[44:45],v47
ds_read_b128 v[224:227],v17 offset:1024
s_waitcnt vmcnt(14)
v_add_u32 v22,s71,-1
v_mfma_f32_16x16x32_bf16 v[64:67],a[104:107],v[232:235],v[64:67]
ds_read_b128 v[228:231],v17 offset:3072
v_min3_u32 v27,v27,v232,v236
buffer_store_dword v22,v23,s[20:23],s97 offen sc1
s_mov_b32 s97,0x7fff0000
v_mfma_f32_16x16x32_bf16 v[72:75],a[108:111],v[236:239],v[72:75]
ds_read_b128 v[232:235],v17 offset:5120
buffer_load_dwordx4 v16,s[20:23],s65 offen offset:0 sc1 lds
buffer_load_dwordx4 v16,s[20:23],s65 offen offset:2048 sc1 lds
v_mfma_f32_16x16x32_bf16 v[64:67],a[112:115],v[240:243],v[64:67]
ds_read_b128 v[236:239],v17 offset:7168
v_min3_u32 v27,v27,v240,v244
s_xor_b32 m0,s72,1024
s_add_u32 s65,s89,0
buffer_load_dwordx4 v16,s[20:23],s65 offen offset:0 sc1 lds
v_mfma_f32_16x16x32_bf16 v[72:75],a[116:119],v[244:247],v[72:75]
ds_read_b128 v[240:243],v17 offset:9216
s_waitcnt lgkmcnt(5)
v_readfirstlane_b32 s93,v45
buffer_load_dwordx4 v16,s[20:23],s65 offen offset:2048 sc1 lds
v_mfma_f32_16x16x32_bf16 v[64:67],a[120:123],v[248:251],v[64:67]
ds_read_b128 v[244:247],v17 offset:11264
v_min3_u32 v27,v27,v248,v252
s_xor_b32 m0,s72,17408
s_add_u32 s65,s89,32768
buffer_load_dwordx4 v16,s[20:23],s65 offen offset:0 sc1 lds
v_mfma_f32_16x16x32_bf16 v[72:75],a[124:127],v[252:255],v[72:75]
ds_read_b128 v[248:251],v17 offset:13312
buffer_load_dwordx4 v16,s[20:23],s65 offen offset:2048 sc1 lds
s_xor_b32 m0,s72,33792
s_add_u32 s65,s89,65536
s_waitcnt lgkmcnt(5)
v_mfma_f32_16x16x32_bf16 v[68:71],a[0:3],v[224:227],0
ds_read_b128 v[252:255],v17 offset:15360
v_cmp_eq_u32 vcc,0,v27
s_cbranch_vccnz retry_392
v_min3_u32 v27,v27,v224,v228
buffer_load_dwordx4 v16,s[20:23],s65 offen offset:0 sc1 lds
v_mfma_f32_16x16x32_bf16 v[76:79],a[4:7],v[228:231],0
ds_read_b128 v[224:227],v17 offset:17408
buffer_load_dwordx4 v16,s[20:23],s65 offen offset:2048 sc1 lds
s_xor_b32 m0,s72,50176
s_add_u32 s65,s89,98304
s_waitcnt lgkmcnt(5)
v_mfma_f32_16x16x32_bf16 v[68:71],a[8:11],v[232:235],v[68:71]
ds_read_b128 v[228:231],v17 offset:19456
v_min3_u32 v27,v27,v232,v236
buffer_load_dwordx4 v16,s[20:23],s65 offen offset:0 sc1 lds
buffer_load_dwordx4 v16,s[20:23],s65 offen offset:2048 sc1 lds
v_mfma_f32_16x16x32_bf16 v[76:79],a[12:15],v[236:239],v[76:79]
ds_read_b128 v[232:235],v17 offset:21504
s_waitcnt lgkmcnt(5)
v_mfma_f32_16x16x32_bf16 v[68:71],a[16:19],v[240:243],v[68:71]
ds_read_b128 v[236:239],v17 offset:23552
v_min3_u32 v27,v27,v240,v244
v_add_f32 v64,v64,v72
v_add_f32 v65,v65,v73
v_add_f32 v66,v66,v74
v_add_f32 v67,v67,v75
v_mfma_f32_16x16x32_bf16 v[76:79],a[20:23],v[244:247],v[76:79]
ds_read_b128 v[240:243],v17 offset:25600
v_fmac_f32 v64,v52,v120
v_fmac_f32 v65,v53,v120
v_fmac_f32 v66,v54,v120
v_fmac_f32 v67,v55,v120
s_waitcnt lgkmcnt(5)
v_mfma_f32_16x16x32_bf16 v[68:71],a[24:27],v[248:251],v[68:71]
ds_read_b128 v[244:247],v17 offset:27648
v_min3_u32 v27,v27,v248,v252
v_mul_f32 v88,v64,v64
v_mul_f32 v89,v65,v65
v_mul_f32 v90,v66,v66
v_mul_f32 v91,v67,v67
v_mfma_f32_16x16x32_bf16 v[76:79],a[28:31],v[252:255],v[76:79]
ds_read_b128 v[248:251],v17 offset:29696
v_fma_f32 v88,v88,v121,v122
v_fma_f32 v89,v89,v121,v122
v_fma_f32 v90,v90,v121,v122
v_fma_f32 v91,v91,v121,v122
s_waitcnt lgkmcnt(5)
v_mfma_f32_16x16x32_bf16 v[68:71],a[32:35],v[224:227],v[68:71]
ds_read_b128 v[252:255],v17 offset:31744
v_min3_u32 v27,v27,v224,v228
v_mul_f32 v88,v88,v64
v_mul_f32 v89,v89,v65
v_mul_f32 v90,v90,v66
v_mul_f32 v91,v91,v67
v_mfma_f32_16x16x32_bf16 v[76:79],a[36:39],v[228:231],v[76:79]
ds_read_b128 v[224:227],v17 offset:33792
v_exp_f32 v88,v88
v_exp_f32 v89,v89
s_waitcnt lgkmcnt(5)
v_mfma_f32_16x16x32_bf16 v[68:71],a[40:43],v[232:235],v[68:71]
ds_read_b128 v[228:231],v17 offset:35840
v_min3_u32 v27,v27,v232,v236
v_exp_f32 v90,v90
v_exp_f32 v91,v91
v_mfma_f32_16x16x32_bf16 v[76:79],a[44:47],v[236:239],v[76:79]
ds_read_b128 v[232:235],v17 offset:37888
v_fma_f32 v88,v88,v123,v123
v_fma_f32 v89,v89,v123,v123
v_fma_f32 v90,v90,v123,v123
v_fma_f32 v91,v91,v123,v123
s_waitcnt lgkmcnt(5)
v_mfma_f32_16x16x32_bf16 v[68:71],a[48:51],v[240:243],v[68:71]
ds_read_b128 v[236:239],v17 offset:39936
v_min3_u32 v27,v27,v240,v244
v_rcp_f32 v88,v88
v_rcp_f32 v89,v89
v_mfma_f32_16x16x32_bf16 v[76:79],a[52:55],v[244:247],v[76:79]
ds_read_b128 v[240:243],v17 offset:41984
v_rcp_f32 v90,v90
v_rcp_f32 v91,v91
s_waitcnt lgkmcnt(5)
v_mfma_f32_16x16x32_bf16 v[68:71],a[56:59],v[248:251],v[68:71]
ds_read_b128 v[244:247],v17 offset:44032
v_min3_u32 v27,v27,v248,v252
v_mul_f32 v88,v88,v64
v_mul_f32 v89,v89,v65
v_mul_f32 v90,v90,v66
v_mul_f32 v91,v91,v67
v_mfma_f32_16x16x32_bf16 v[76:79],a[60:63],v[252:255],v[76:79]
ds_read_b128 v[248:251],v17 offset:46080
v_cvt_pk_bf16_f32 v96,v88,v89
v_cvt_pk_bf16_f32 v97,v90,v91
v_max_u32 v96,1,v96
s_waitcnt lgkmcnt(5)
v_mfma_f32_16x16x32_bf16 v[68:71],a[64:67],v[224:227],v[68:71]
ds_read_b128 v[252:255],v17 offset:48128
v_min3_u32 v27,v27,v224,v228
buffer_store_dwordx2 v[96:97],v18,s[20:23],s70 offen offset:0 sc1
v_mfma_f32_16x16x32_bf16 v[76:79],a[68:71],v[228:231],v[76:79]
ds_read_b128 v[224:227],v17 offset:50176
s_waitcnt lgkmcnt(5)
v_mfma_f32_16x16x32_bf16 v[68:71],a[72:75],v[232:235],v[68:71]
ds_read_b128 v[228:231],v17 offset:52224
v_min3_u32 v27,v27,v232,v236
v_mfma_f32_16x16x32_bf16 v[76:79],a[76:79],v[236:239],v[76:79]
ds_read_b128 v[232:235],v17 offset:54272
s_waitcnt lgkmcnt(5)
v_mfma_f32_16x16x32_bf16 v[68:71],a[80:83],v[240:243],v[68:71]
ds_read_b128 v[236:239],v17 offset:56320
v_min3_u32 v27,v27,v240,v244
v_mfma_f32_16x16x32_bf16 v[76:79],a[84:87],v[244:247],v[76:79]
ds_read_b128 v[240:243],v17 offset:58368
s_waitcnt lgkmcnt(5)
v_mfma_f32_16x16x32_bf16 v[68:71],a[88:91],v[248:251],v[68:71]
ds_read_b128 v[244:247],v17 offset:60416
v_min3_u32 v27,v27,v248,v252
v_mfma_f32_16x16x32_bf16 v[76:79],a[92:95],v[252:255],v[76:79]
ds_read_b128 v[248:251],v17 offset:62464
s_waitcnt lgkmcnt(5)
v_mfma_f32_16x16x32_bf16 v[68:71],a[96:99],v[224:227],v[68:71]
ds_read_b128 v[252:255],v17 offset:64512
v_min3_u32 v27,v27,v224,v228
v_mfma_f32_16x16x32_bf16 v[76:79],a[100:103],v[228:231],v[76:79]
s_waitcnt lgkmcnt(4)
v_mfma_f32_16x16x32_bf16 v[68:71],a[104:107],v[232:235],v[68:71]
v_min3_u32 v27,v27,v232,v236
v_mfma_f32_16x16x32_bf16 v[76:79],a[108:111],v[236:239],v[76:79]
s_waitcnt lgkmcnt(2)
v_mfma_f32_16x16x32_bf16 v[68:71],a[112:115],v[240:243],v[68:71]
v_min3_u32 v27,v27,v240,v244
v_mfma_f32_16x16x32_bf16 v[76:79],a[116:119],v[244:247],v[76:79]
s_waitcnt lgkmcnt(0)
v_mfma_f32_16x16x32_bf16 v[68:71],a[120:123],v[248:251],v[68:71]
v_min3_u32 v27,v27,v248,v252
v_mfma_f32_16x16x32_bf16 v[76:79],a[124:127],v[252:255],v[76:79]
v_cmp_eq_u32 vcc,0,v27
s_cbranch_vccnz retry_392
epi_395:
buffer_load_dword v29,v21,s[20:23],s87 offen sc1
s_nop 4
v_pk_add_f32 v[68:69],v[68:69],v[76:77]
v_pk_add_f32 v[70:71],v[70:71],v[78:79]
v_pk_fma_f32 v[68:69],v[52:53],v[124:125],v[68:69] op_sel_hi:[1,0,1]
v_pk_fma_f32 v[70:71],v[54:55],v[124:125],v[70:71] op_sel_hi:[1,0,1]
v_pk_mul_f32 v[88:89],v[68:69],v[68:69]
v_pk_mul_f32 v[90:91],v[70:71],v[70:71]
v_pk_fma_f32 v[88:89],v[88:89],v[124:125],v[126:127] op_sel:[0,1,0] op_sel_hi:[1,1,0]
v_pk_fma_f32 v[90:91],v[90:91],v[124:125],v[126:127] op_sel:[0,1,0] op_sel_hi:[1,1,0]
v_pk_mul_f32 v[88:89],v[88:89],v[68:69]
v_pk_mul_f32 v[90:91],v[90:91],v[70:71]
v_exp_f32 v88,v88
v_exp_f32 v89,v89
v_exp_f32 v90,v90
s_cmp_gt_u32 s71,40
s_cselect_b32 s65,s73,0x7fff0000
s_cselect_b32 s97,0x7fff0000,s73
v_mov_b32 v22,s71
buffer_store_dword v22,v23,s[20:23],s65 offen sc1
v_exp_f32 v91,v91
v_pk_fma_f32 v[88:89],v[88:89],v[126:127],v[126:127] op_sel:[0,1,1] op_sel_hi:[1,1,1]
v_pk_fma_f32 v[90:91],v[90:91],v[126:127],v[126:127] op_sel:[0,1,1] op_sel_hi:[1,1,1]
v_rcp_f32 v88,v88
v_rcp_f32 v89,v89
v_rcp_f32 v90,v90
v_rcp_f32 v91,v91
v_pk_mul_f32 v[88:89],v[88:89],v[68:69]
v_pk_mul_f32 v[90:91],v[90:91],v[70:71]
v_cvt_pk_bf16_f32 v96,v88,v89
v_cvt_pk_bf16_f32 v97,v90,v91
v_max_u32 v96,1,v96
buffer_store_dwordx2 v[96:97],v18,s[20:23],s70 offen offset:1024 sc1
next_402:
v_xor_b32 v17,0x10000,v17
s_xor_b32 s72,s72,0x10000
s_add_u32 s70,s70,2097152
s_xor_b32 s70,s70,0x2000
s_add_u32 s71,s71,1
s_cmp_le_u32 s71,s57
s_cbranch_scc1 seg_393
s_endpgm
retry_392:
s_sub_u32 s90,s90,64
s_cmp_lt_i32 s90,0
s_cbranch_scc1 giveup_197
s_mov_b32 s83,1
s_waitcnt vmcnt(0) lgkmcnt(0)
s_barrier
s_branch seg_393
half_401:
s_mov_b64 exec,s[52:53]
s_xor_b32 m0,s91,0
s_add_u32 s65,s94,0
buffer_load_dwordx4 v16,s[20:23],s65 offen offset:0 sc1 lds
buffer_load_dwordx4 v16,s[20:23],s65 offen offset:2048 sc1 lds
s_xor_b32 m0,s91,16384
s_add_u32 s65,s94,32768
buffer_load_dwordx4 v16,s[20:23],s65 offen offset:0 sc1 lds
buffer_load_dwordx4 v16,s[20:23],s65 offen offset:2048 sc1 lds
s_xor_b32 m0,s91,32768
s_add_u32 s65,s94,65536
buffer_load_dwordx4 v16,s[20:23],s65 offen offset:0 sc1 lds
buffer_load_dwordx4 v16,s[20:23],s65 offen offset:2048 sc1 lds
s_xor_b32 m0,s91,49152
s_add_u32 s65,s94,98304
buffer_load_dwordx4 v16,s[20:23],s65 offen offset:0 sc1 lds
buffer_load_dwordx4 v16,s[20:23],s65 offen offset:2048 sc1 lds
s_add_u32 s66,s94,110592
buffer_load_dwordx4 v[128:131],v16,s[20:23],s66 offen offset:0 sc1
buffer_load_dwordx4 v[132:135],v16,s[20:23],s66 offen offset:1024 sc1
buffer_load_dwordx4 v[136:139],v16,s[20:23],s66 offen offset:2048 sc1
buffer_load_dwordx4 v[140:143],v16,s[20:23],s66 offen offset:3072 sc1
s_add_u32 s66,s94,114688
buffer_load_dwordx4 v[144:147],v16,s[20:23],s66 offen offset:0 sc1
buffer_load_dwordx4 v[148:151],v16,s[20:23],s66 offen offset:1024 sc1
buffer_load_dwordx4 v[152:155],v16,s[20:23],s66 offen offset:2048 sc1
buffer_load_dwordx4 v[156:159],v16,s[20:23],s66 offen offset:3072 sc1
s_mov_b64 exec,-1
s_waitcnt vmcnt(16)
v_add_u32 v22,s71,-1
buffer_store_dword v22,v23,s[20:23],s97 offen sc1
s_mov_b32 s97,0x7fff0000
half2_398:
s_waitcnt vmcnt(15)
s_barrier
ds_read_b128 v[224:227],v17 offset:0
ds_read_b128 v[228:231],v17 offset:2048
ds_read_b128 v[232:235],v17 offset:4096
ds_read_b128 v[236:239],v17 offset:6144
ds_read_b128 v[240:243],v17 offset:8192
ds_read_b128 v[244:247],v17 offset:10240
ds_read_b128 v[248:251],v17 offset:12288
s_waitcnt lgkmcnt(5)
v_mfma_f32_16x16x32_bf16 v[64:67],a[0:3],v[224:227],0
ds_read_b128 v[252:255],v17 offset:14336
v_min_u32 v27,v224,v228
v_mfma_f32_16x16x32_bf16 v[72:75],a[4:7],v[228:231],0
s_waitcnt vmcnt(13)
s_barrier
ds_read_b128 v[224:227],v17 offset:16384
s_waitcnt lgkmcnt(5)
v_mfma_f32_16x16x32_bf16 v[64:67],a[8:11],v[232:235],v[64:67]
ds_read_b128 v[228:231],v17 offset:18432
v_min3_u32 v27,v27,v232,v236
v_mfma_f32_16x16x32_bf16 v[72:75],a[12:15],v[236:239],v[72:75]
ds_read_b128 v[232:235],v17 offset:20480
s_waitcnt lgkmcnt(5)
v_mfma_f32_16x16x32_bf16 v[64:67],a[16:19],v[240:243],v[64:67]
ds_read_b128 v[236:239],v17 offset:22528
v_min3_u32 v27,v27,v240,v244
v_mfma_f32_16x16x32_bf16 v[72:75],a[20:23],v[244:247],v[72:75]
ds_read_b128 v[240:243],v17 offset:24576
s_waitcnt lgkmcnt(5)
v_mfma_f32_16x16x32_bf16 v[64:67],a[24:27],v[248:251],v[64:67]
ds_read_b128 v[244:247],v17 offset:26624
v_min3_u32 v27,v27,v248,v252
v_mfma_f32_16x16x32_bf16 v[72:75],a[28:31],v[252:255],v[72:75]
ds_read_b128 v[248:251],v17 offset:28672
s_waitcnt lgkmcnt(5)
v_mfma_f32_16x16x32_bf16 v[64:67],a[32:35],v[224:227],v[64:67]
ds_read_b128 v[252:255],v17 offset:30720
v_min3_u32 v27,v27,v224,v228
v_mfma_f32_16x16x32_bf16 v[72:75],a[36:39],v[228:231],v[72:75]
s_waitcnt vmcnt(9)
s_barrier
ds_read_b128 v[224:227],v17 offset:32768
s_waitcnt lgkmcnt(5)
v_mfma_f32_16x16x32_bf16 v[64:67],a[40:43],v[232:235],v[64:67]
ds_read_b128 v[228:231],v17 offset:34816
v_min3_u32 v27,v27,v232,v236
v_mfma_f32_16x16x32_bf16 v[72:75],a[44:47],v[236:239],v[72:75]
ds_read_b128 v[232:235],v17 offset:36864
s_waitcnt lgkmcnt(5)
v_mfma_f32_16x16x32_bf16 v[64:67],a[48:51],v[240:243],v[64:67]
ds_read_b128 v[236:239],v17 offset:38912
v_min3_u32 v27,v27,v240,v244
s_waitcnt vmcnt(1)
stk_413:
v_min3_u32 v22,v129,v133,v137
v_min3_u32 v22,v22,v141,v145
v_min3_u32 v22,v22,v149,v153
v_min_u32 v22,v22,v157
v_cmp_eq_u32 vcc,0,v22
s_and_b64 vcc,vcc,s[52:53]
s_cmp_lt_i32 s90,0
s_cselect_b64 vcc,0,vcc
s_cbranch_vccnz str_414
v_mfma_f32_16x16x32_bf16 v[72:75],a[52:55],v[244:247],v[72:75]
ds_read_b128 v[240:243],v17 offset:40960
v_pk_add_f32 v[88:89],v[128:129],v[144:145]
v_pk_add_f32 v[90:91],v[130:131],v[146:147]
v_pk_add_f32 v[92:93],v[132:133],v[148:149]
v_pk_add_f32 v[94:95],v[134:135],v[150:151]
v_pk_add_f32 v[96:97],v[136:137],v[152:153]
v_pk_add_f32 v[98:99],v[138:139],v[154:155]
v_pk_add_f32 v[100:101],v[140:141],v[156:157]
v_pk_add_f32 v[102:103],v[142:143],v[158:159]
v_pk_add_f32 v[88:89],v[88:89],v[96:97]
v_pk_add_f32 v[90:91],v[90:91],v[98:99]
s_waitcnt lgkmcnt(5)
v_mfma_f32_16x16x32_bf16 v[64:67],a[56:59],v[248:251],v[64:67]
ds_read_b128 v[244:247],v17 offset:43008
v_min3_u32 v27,v27,v248,v252
v_pk_add_f32 v[92:93],v[92:93],v[100:101]
v_pk_add_f32 v[94:95],v[94:95],v[102:103]
v_pk_add_f32 v[88:89],v[88:89],v[92:93]
v_pk_add_f32 v[90:91],v[90:91],v[94:95]
v_mov_b32 v92,v88
v_mov_b32 v93,v89
v_mov_b32 v94,v90
v_mov_b32 v95,v91
v_permlane16_swap_b32 v92,v88
v_mfma_f32_16x16x32_bf16 v[72:75],a[60:63],v[252:255],v[72:75]
ds_read_b128 v[248:251],v17 offset:45056
v_permlane16_swap_b32 v93,v89
v_permlane16_swap_b32 v94,v90
v_permlane16_swap_b32 v95,v91
v_pk_add_f32 v[88:89],v[88:89],v[92:93]
v_pk_add_f32 v[90:91],v[90:91],v[94:95]
v_mov_b32 v92,v88
v_mov_b32 v93,v89
s_waitcnt lgkmcnt(5)
v_mfma_f32_16x16x32_bf16 v[64:67],a[64:67],v[224:227],v[64:67]
ds_read_b128 v[252:255],v17 offset:47104
v_min3_u32 v27,v27,v224,v228
v_mov_b32 v94,v90
v_mov_b32 v95,v91
v_permlane32_swap_b32 v92,v88
v_permlane32_swap_b32 v93,v89
v_permlane32_swap_b32 v94,v90
v_permlane32_swap_b32 v95,v91
v_mfma_f32_16x16x32_bf16 v[72:75],a[68:71],v[228:231],v[72:75]
ds_read_b128 v[224:227],v17 offset:49152
v_pk_add_f32 v[88:89],v[88:89],v[92:93]
v_pk_add_f32 v[90:91],v[90:91],v[94:95]
v_mul_f32 v120,0xba800000,v88
v_mul_f32 v124,0xba800000,v90
s_waitcnt lgkmcnt(5)
v_mfma_f32_16x16x32_bf16 v[64:67],a[72:75],v[232:235],v[64:67]
ds_read_b128 v[228:231],v17 offset:51200
v_min3_u32 v27,v27,v232,v236
v_mul_f32 v92,v120,v120
v_mul_f32 v93,v124,v124
v_fma_f32 v92,v89,s82,-v92
v_fma_f32 v93,v91,s82,-v93
v_mfma_f32_16x16x32_bf16 v[72:75],a[76:79],v[236:239],v[72:75]
ds_read_b128 v[232:235],v17 offset:53248
v_max_f32 v92,0,v92
v_max_f32 v93,0,v93
v_add_f32 v92,0x3727c5ac,v92
v_add_f32 v93,0x3727c5ac,v93
s_waitcnt lgkmcnt(5)
v_mfma_f32_16x16x32_bf16 v[64:67],a[80:83],v[240:243],v[64:67]
ds_read_b128 v[236:239],v17 offset:55296
v_min3_u32 v27,v27,v240,v244
v_rsq_f32 v94,v92
v_rsq_f32 v95,v93
v_mfma_f32_16x16x32_bf16 v[72:75],a[84:87],v[244:247],v[72:75]
ds_read_b128 v[240:243],v17 offset:57344
v_mul_f32 v123,v92,v94
v_mul_f32 v127,v93,v95
v_mul_f32 v122,v28,v94
v_mul_f32 v126,v28,v95
s_waitcnt lgkmcnt(5)
v_mfma_f32_16x16x32_bf16 v[64:67],a[88:91],v[248:251],v[64:67]
ds_read_b128 v[244:247],v17 offset:59392
v_min3_u32 v27,v27,v248,v252
v_mul_f32 v92,v94,v94
v_mul_f32 v93,v95,v95
v_mul_f32 v94,s81,v94
v_mul_f32 v95,s81,v95
v_mfma_f32_16x16x32_bf16 v[72:75],a[92:95],v[252:255],v[72:75]
ds_read_b128 v[248:251],v17 offset:61440
v_mul_f32 v121,v92,v94
v_mul_f32 v125,v93,v95
ds_write_b128 v19,v[120:123] offset:0
ds_write_b128 v19,v[124:127] offset:256
s_waitcnt lgkmcnt(7)
v_mfma_f32_16x16x32_bf16 v[64:67],a[96:99],v[224:227],v[64:67]
s_waitcnt lgkmcnt(0)
s_barrier
ds_read_b128 v[252:255],v17 offset:63488
v_min3_u32 v27,v27,v224,v228
v_mfma_f32_16x16x32_bf16 v[72:75],a[100:103],v[228:231],v[72:75]
v_mfma_f32_16x16x32_bf16 v[64:67],a[104:107],v[232:235],v[64:67]
v_min3_u32 v27,v27,v232,v236
v_mfma_f32_16x16x32_bf16 v[72:75],a[108:111],v[236:239],v[72:75]
v_mfma_f32_16x16x32_bf16 v[64:67],a[112:115],v[240:243],v[64:67]
v_min3_u32 v27,v27,v240,v244
v_mfma_f32_16x16x32_bf16 v[72:75],a[116:119],v[244:247],v[72:75]
s_waitcnt lgkmcnt(0)
v_mfma_f32_16x16x32_bf16 v[64:67],a[120:123],v[248:251],v[64:67]
v_min3_u32 v27,v27,v248,v252
v_mfma_f32_16x16x32_bf16 v[72:75],a[124:127],v[252:255],v[72:75]
v_cmp_eq_u32 vcc,0,v27
s_and_b64 vcc,vcc,s[52:53]
s_cbranch_vccnz retry_392
s_waitcnt lgkmcnt(0)
s_nop 3
v_pk_add_f32 v[64:65],v[64:65],v[72:73]
v_pk_add_f32 v[66:67],v[66:67],v[74:75]
v_pk_fma_f32 v[64:65],v[52:53],v[120:121],v[64:65] op_sel_hi:[1,0,1]
v_pk_fma_f32 v[66:67],v[54:55],v[120:121],v[66:67] op_sel_hi:[1,0,1]
v_pk_mul_f32 v[88:89],v[64:65],v[64:65]
v_pk_mul_f32 v[90:91],v[66:67],v[66:67]
buffer_load_dword v29,v21,s[20:23],s87 offen sc1
v_mov_b32 v22,s71
buffer_store_dword v22,v23,s[20:23],s73 offen sc1
v_pk_fma_f32 v[88:89],v[88:89],v[120:121],v[122:123] op_sel:[0,1,0] op_sel_hi:[1,1,0]
v_pk_fma_f32 v[90:91],v[90:91],v[120:121],v[122:123] op_sel:[0,1,0] op_sel_hi:[1,1,0]
v_pk_mul_f32 v[88:89],v[88:89],v[64:65]
v_pk_mul_f32 v[90:91],v[90:91],v[66:67]
v_exp_f32 v88,v88
v_exp_f32 v89,v89
v_exp_f32 v90,v90
v_exp_f32 v91,v91
v_pk_fma_f32 v[88:89],v[88:89],v[122:123],v[122:123] op_sel:[0,1,1] op_sel_hi:[1,1,1]
v_pk_fma_f32 v[90:91],v[90:91],v[122:123],v[122:123] op_sel:[0,1,1] op_sel_hi:[1,1,1]
v_rcp_f32 v88,v88
v_rcp_f32 v89,v89
v_rcp_f32 v90,v90
v_rcp_f32 v91,v91
v_pk_mul_f32 v[88:89],v[88:89],v[64:65]
v_pk_mul_f32 v[90:91],v[90:91],v[66:67]
v_cvt_pk_bf16_f32 v96,v88,v89
v_cvt_pk_bf16_f32 v97,v90,v91
v_max_u32 v96,1,v96
buffer_store_dwordx2 v[96:97],v18,s[20:23],s70 offen offset:0 sc1
s_branch next_402
str_408:
s_add_u32 s94,s70,s75
s_add_u32 s66,s94,110592
buffer_load_dwordx4 v[128:131],v16,s[20:23],s66 offen offset:0 sc1
buffer_load_dwordx4 v[132:135],v16,s[20:23],s66 offen offset:1024 sc1
buffer_load_dwordx4 v[136:139],v16,s[20:23],s66 offen offset:2048 sc1
buffer_load_dwordx4 v[140:143],v16,s[20:23],s66 offen offset:3072 sc1
s_add_u32 s66,s94,114688
buffer_load_dwordx4 v[144:147],v16,s[20:23],s66 offen offset:0 sc1
buffer_load_dwordx4 v[148:151],v16,s[20:23],s66 offen offset:1024 sc1
buffer_load_dwordx4 v[152:155],v16,s[20:23],s66 offen offset:2048 sc1
buffer_load_dwordx4 v[156:159],v16,s[20:23],s66 offen offset:3072 sc1
s_sub_u32 s90,s90,1
s_waitcnt vmcnt(0)
s_branch stk_407
str_410:
s_add_u32 s94,s70,s75
s_add_u32 s66,s94,110592
buffer_load_dwordx4 v[128:131],v16,s[20:23],s66 offen offset:0 sc1
buffer_load_dwordx4 v[132:135],v16,s[20:23],s66 offen offset:1024 sc1
buffer_load_dwordx4 v[136:139],v16,s[20:23],s66 offen offset:2048 sc1
buffer_load_dwordx4 v[140:143],v16,s[20:23],s66 offen offset:3072 sc1
s_add_u32 s66,s94,114688
buffer_load_dwordx4 v[144:147],v16,s[20:23],s66 offen offset:0 sc1
buffer_load_dwordx4 v[148:151],v16,s[20:23],s66 offen offset:1024 sc1
buffer_load_dwordx4 v[152:155],v16,s[20:23],s66 offen offset:2048 sc1
buffer_load_dwordx4 v[156:159],v16,s[20:23],s66 offen offset:3072 sc1
s_sub_u32 s90,s90,1
s_waitcnt vmcnt(0)
s_branch stk_409
str_412:
s_add_u32 s94,s70,s75
s_add_u32 s66,s94,110592
buffer_load_dwordx4 v[128:131],v16,s[20:23],s66 offen offset:0 sc1
buffer_load_dwordx4 v[132:135],v16,s[20:23],s66 offen offset:1024 sc1
buffer_load_dwordx4 v[136:139],v16,s[20:23],s66 offen offset:2048 sc1
buffer_load_dwordx4 v[140:143],v16,s[20:23],s66 offen offset:3072 sc1
s_add_u32 s66,s94,114688
buffer_load_dwordx4 v[144:147],v16,s[20:23],s66 offen offset:0 sc1
buffer_load_dwordx4 v[148:151],v16,s[20:23],s66 offen offset:1024 sc1
buffer_load_dwordx4 v[152:155],v16,s[20:23],s66 offen offset:2048 sc1
buffer_load_dwordx4 v[156:159],v16,s[20:23],s66 offen offset:3072 sc1
s_sub_u32 s90,s90,1
s_waitcnt vmcnt(0)
s_branch stk_411
str_414:
s_add_u32 s94,s70,s75
s_add_u32 s66,s94,110592
buffer_load_dwordx4 v[128:131],v16,s[20:23],s66 offen offset:0 sc1
buffer_load_dwordx4 v[132:135],v16,s[20:23],s66 offen offset:1024 sc1
buffer_load_dwordx4 v[136:139],v16,s[20:23],s66 offen offset:2048 sc1
buffer_load_dwordx4 v[140:143],v16,s[20:23],s66 offen offset:3072 sc1
s_add_u32 s66,s94,114688
buffer_load_dwordx4 v[144:147],v16,s[20:23],s66 offen offset:0 sc1
buffer_load_dwordx4 v[148:151],v16,s[20:23],s66 offen offset:1024 sc1
buffer_load_dwordx4 v[152:155],v16,s[20:23],s66 offen offset:2048 sc1
buffer_load_dwordx4 v[156:159],v16,s[20:23],s66 offen offset:3072 sc1
s_sub_u32 s90,s90,1
s_waitcnt vmcnt(0)
s_branch stk_413
giveup_197:
s_endpgm
code_end:
.section .rodata,"a"
.p2align 6
.amdhsa_kernel mega_kernel
  .amdhsa_next_free_vgpr 512
  .amdhsa_next_free_sgpr 102
  .amdhsa_accum_offset 256
  .amdhsa_group_segment_fixed_size 0
  .amdhsa_kernarg_size 136
  .amdhsa_user_sgpr_count 2
  .amdhsa_user_sgpr_kernarg_segment_ptr 1
  .amdhsa_system_sgpr_workgroup_id_x 1
.end_amdhsa_kernel
```
